```python
import torch

def _softmax(x, axis=-1):
    return torch.softmax(x, dim=axis)
def _gelu(x):
    return torch.nn.functional.gelu(x, approximate="tanh")
def _silu(x):
    return torch.nn.functional.silu(x)
def _sigmoid(x):
    return torch.sigmoid(x)
def _layernorm(x, axis=-1, eps=1e-5):
    m = x.mean(dim=axis, keepdim=True)
    v = x.var(dim=axis, keepdim=True, unbiased=False)
    return (x - m) / torch.sqrt(v + eps)
def _scatter_add(tgt, idx, src, axis=0):
    return tgt.clone().index_add_(axis, idx, src)
def _segment_sum(src, seg, n):
    out = torch.zeros((n,) + src.shape[1:], dtype=src.dtype)
    return out.index_add_(0, seg, src)
def _pad(x, pw):
    flat = tuple(v for pair in reversed(pw) for v in pair)
    return torch.nn.functional.pad(x, flat)

kernel_name = 'parallel_sum__compressed_kv_cla__moe_arch_mod__prompt'

def setup_inputs():

    _w = (lambda a: (lambda t: t.to(torch.bfloat16) if t.is_floating_point() else t)(torch.as_tensor(a)))
    def _A_setup():
        B, H, Sq, Sk, D, M = 1, 32, 2048, 2048, 128, 640
        Dc = 4 * D
        return {
            "x": _w((lambda *s: torch.randn(*s, dtype=torch.bfloat16) * 0.05)(B, Sq, M)),
            "c_kv": _w((lambda *s: torch.randn(*s, dtype=torch.bfloat16) * 1.6)(B, Sk, Dc)),
            "w_q": _w((lambda *s: torch.randn(*s, dtype=torch.bfloat16) * 0.8)(M, H, D) * (M ** -0.5)),
            "w_uk": _w((lambda *s: torch.randn(*s, dtype=torch.bfloat16) * 0.8)(Dc, H, D) * (Dc ** -0.5)),
            "w_uv": _w((lambda *s: torch.randn(*s, dtype=torch.bfloat16) * 1.6)(Dc, H, D) * (Dc ** -0.5)),
            "w_o": _w((lambda *s: torch.randn(*s, dtype=torch.bfloat16) * 1.6)(H, D, M) * ((H * D) ** -0.5)),
        }
    _A_in = _A_setup()

    def _B_setup():
        B, S, D, F, C = 1, 2048, 640, 1728, 8
        return {
            "x": _w((lambda *s: torch.randn(*s, dtype=torch.bfloat16) * 0.05)(B, S, D)),
            "w_r": _w((lambda *s: torch.randn(*s, dtype=torch.bfloat16) * 0.05)(D)),
            "w_gate": _w((lambda *s: torch.randn(*s, dtype=torch.bfloat16) * 0.05)(D, F)),
            "w_up": _w((lambda *s: torch.randn(*s, dtype=torch.bfloat16) * 0.05)(D, F)),
            "w_down": _w((lambda *s: torch.randn(*s, dtype=torch.bfloat16) * 0.05)(F, D)),
        }
    _B_in = _B_setup()

    return {
        "A_x": _A_in["x"],
        "A_c_kv": _A_in["c_kv"],
        "A_w_q": _A_in["w_q"],
        "A_w_uk": _A_in["w_uk"],
        "A_w_uv": _A_in["w_uv"],
        "A_w_o": _A_in["w_o"],
        "B_x": _B_in["x"],
        "B_w_r": _B_in["w_r"],
        "B_w_gate": _B_in["w_gate"],
        "B_w_up": _B_in["w_up"],
        "B_w_down": _B_in["w_down"],
    }

def reference(A_x, A_c_kv, A_w_q, A_w_uk, A_w_uv, A_w_o, B_x, B_w_r, B_w_gate, B_w_up, B_w_down):
    def _A_ref(x, c_kv, w_q, w_uk, w_uv, w_o):
        B, Sq, M = x.shape[0], x.shape[1], x.shape[2]
        Sk = c_kv.shape[1]
        H, D = w_q.shape[1], w_q.shape[2]
        q = torch.einsum("bqm,mhd->bhqd", x, w_q)
        k = torch.einsum("bkc,chd->bhkd", c_kv, w_uk)
        v = torch.einsum("bkc,chd->bhkd", c_kv, w_uv)
        scores = torch.einsum("bhqd,bhkd->bhqk", q, k) * (D ** -0.5)
        off = Sk - Sq
        qi = torch.arange(Sq)[:, None]
        kj = torch.arange(Sk)[None, :]
        cmask = kj <= (qi + off)
        scores = torch.where(cmask[None, None], scores, -1e9)
        p = _softmax(scores, axis=-1)
        ctx = torch.einsum("bhqk,bhkd->bhqd", p, v)
        return torch.einsum("bhqd,hdm->bqm", ctx, w_o)

    def _B_ref(x, w_r, w_gate, w_up, w_down):
        B, S, D = x.shape
        C = 8
        r = x @ w_r
        idx = torch.argsort(-r, axis=-1)[:, :C]
        idx_e = (lambda x, n, axis: torch.repeat_interleave(x, n, dim=axis))(idx.reshape(B, C, 1), D, axis=2)
        x_sel = (lambda x, i, axis: torch.take_along_dim(x, i, dim=axis))(x, idx_e, axis=1)
        g = _silu(x_sel @ w_gate)
        u = x_sel @ w_up
        y = (g * u) @ w_down
        r_sel = _sigmoid((lambda x, i, axis: torch.take_along_dim(x, i, dim=axis))(r, idx, axis=1))
        y = y * r_sel.reshape(B, C, 1)
        b_off = (torch.arange(B) * S).reshape(B, 1)
        flat_idx = (idx + b_off).reshape(B * C)
        zero = (x * 0.0).reshape(B * S, D)
        upd = _scatter_add(zero, flat_idx, y.reshape(B * C, D), axis=0)
        return x + upd.reshape(B, S, D)

    x = A_x
    xn = _layernorm(x, axis=-1)
    return x + _A_ref(xn, A_c_kv, A_w_q, A_w_uk, A_w_uv, A_w_o) + _B_ref(xn, B_w_r, B_w_gate, B_w_up, B_w_down)
```

```asm
; @launch kernel=k1_kernel grid=(256,1,1) block=(256,1,1) lds=151552
.amdgcn_target "amdgcn-amd-amdhsa--gfx950"
.text
.globl k1_kernel
.p2align 8
.type k1_kernel,@function
k1_kernel:
  s_cmp_ge_u32 s2, 256
  s_cbranch_scc1 k1_end
  s_load_dwordx4 s[4:7], s[0:1], 0
  s_load_dwordx4 s[8:11], s[0:1], 24
  s_load_dwordx2 s[12:13], s[0:1], 40
  s_load_dwordx2 s[14:15], s[0:1], 56
  s_load_dwordx2 s[16:17], s[0:1], 104
  v_lshrrev_b32 v2, 6, v0
  v_and_b32 v1, 63, v0
  v_readfirstlane_b32 s20, v2
  s_and_b32 s21, s2, 7
  s_lshl_b32 s21, s21, 2
  s_lshr_b32 s23, s2, 3
  s_and_b32 s23, s23, 3
  s_add_u32 s21, s21, s23
  s_lshr_b32 s22, s2, 5
  v_lshlrev_b32 v15, 4, v1
  v_lshrrev_b32 v16, 2, v1
  v_lshrrev_b32 v17, 5, v1
  v_mul_u32_u24 v17, 3, v17
  v_and_b32 v18, 3, v1
  v_xor_b32 v17, v17, v18
  v_lshlrev_b32 v17, 4, v17
  v_lshl_add_u32 v4, v16, 10, v17
  s_lshl_b32 s23, s20, 16
  v_add_u32 v4, s23, v4
  v_add_u32 v5, 15360, v4
  v_add_u32 v6, 30720, v4
  v_add_u32 v7, 46080, v4
  v_and_b32 v16, 3, v16
  v_lshrrev_b32 v17, 4, v1
  v_lshlrev_b32 v17, 6, v17
  v_lshl_add_u32 v16, v16, 13, v17
  s_and_b32 s23, s20, 1
  s_lshl_b32 s23, s23, 17
  v_add_u32 v16, s23, v16
  v_lshl_add_u32 v8, v18, 4, v16
  v_xor_b32 v18, 2, v18
  v_lshl_add_u32 v10, v18, 4, v16
  v_add_u32 v9, 31744, v8
  v_add_u32 v11, 95232, v10
  v_add_u32 v10, 63488, v10
  s_waitcnt lgkmcnt(0)
  s_lshl_b32 s23, s22, 18
  s_add_u32 s6, s6, s23
  s_addc_u32 s7, s7, 0
  s_mov_b32 s32, s6
  s_mov_b32 s33, s7
  s_mov_b32 s34, 262144
  s_mov_b32 s35, 0x20000
  s_cmp_ge_u32 s20, 2
  s_cselect_b32 s8, s10, s8
  s_cselect_b32 s9, s11, s9
  s_lshl_b32 s23, s21, 8
  s_add_u32 s8, s8, s23
  s_addc_u32 s9, s9, 0
  s_mov_b32 s36, s8
  s_mov_b32 s37, s9
  s_mov_b32 s38, 0
  s_mov_b32 s39, 0x20000
  s_sub_u32 s38, 4194304, s23
  s_mov_b32 s40, s16
  s_mov_b32 s41, s17
  s_mov_b32 s42, 67108864
  s_mov_b32 s43, 0x20000
  s_mov_b32 s44, s4
  s_mov_b32 s45, s5
  s_mov_b32 s46, 2621440
  s_mov_b32 s47, 0x20000
  s_mov_b32 s48, s14
  s_mov_b32 s49, s15
  s_mov_b32 s50, 1280
  s_mov_b32 s51, 0x20000
  s_mov_b32 s52, s12
  s_mov_b32 s53, s13
  s_mov_b32 s54, 5242880
  s_mov_b32 s55, 0x20000
  s_lshl_b32 s24, s20, 12
  s_mov_b32 s26, 0
  s_mov_b32 s27, 0
  s_mov_b32 m0, s24
  s_nop 0
  buffer_load_dwordx4 v4, s[32:35], s26 offen offset:0 lds
  buffer_load_dwordx4 v5, s[32:35], s26 offen offset:1024 lds
  buffer_load_dwordx4 v6, s[32:35], s26 offen offset:2048 lds
  buffer_load_dwordx4 v7, s[32:35], s26 offen offset:3072 lds
  s_add_u32 m0, s24, 16384
  s_nop 0
  buffer_load_dwordx4 v8, s[36:39], s27 offen offset:0 lds
  buffer_load_dwordx4 v9, s[36:39], s27 offen offset:1024 lds
  buffer_load_dwordx4 v10, s[36:39], s27 offen offset:2048 lds
  buffer_load_dwordx4 v11, s[36:39], s27 offen offset:3072 lds
  s_add_u32 s26, s26, 64
  s_add_u32 s27, s27, 262144
  s_add_u32 s24, s24, 32768
  s_and_b32 s24, s24, 0x1ffff
  v_and_b32 v208, 31, v1
  v_lshrrev_b32 v209, 5, v1
  s_lshl_b32 s23, s2, 2
  s_add_u32 s23, s23, s20
  s_lshl_b32 s23, s23, 1
  v_add_u32 v209, s23, v209
  v_lshlrev_b32 v212, 4, v208
  v_mul_u32_u24 v210, 1280, v209
  v_add_u32 v210, v210, v212
  v_cmp_gt_u32 s[56:57], 16, v208
  v_mov_b32 v211, 0x40000000
  s_nop 0
  v_cndmask_b32 v211, v211, v210, s[56:57]
  buffer_load_dwordx4 v[160:163], v210, s[44:47], 0 offen
  buffer_load_dwordx4 v[164:167], v210, s[44:47], 0 offen offset:512
  buffer_load_dwordx4 v[168:171], v211, s[44:47], 0 offen offset:1024
  buffer_load_dwordx4 v[172:175], v212, s[48:51], 0 offen offset:0
  buffer_load_dwordx4 v[176:179], v212, s[48:51], 0 offen offset:512
  buffer_load_dwordx4 v[180:183], v212, s[48:51], 0 offen offset:1024
  s_mov_b32 m0, s24
  s_nop 0
  buffer_load_dwordx4 v4, s[32:35], s26 offen offset:0 lds
  buffer_load_dwordx4 v5, s[32:35], s26 offen offset:1024 lds
  buffer_load_dwordx4 v6, s[32:35], s26 offen offset:2048 lds
  buffer_load_dwordx4 v7, s[32:35], s26 offen offset:3072 lds
  s_add_u32 m0, s24, 16384
  s_nop 0
  buffer_load_dwordx4 v8, s[36:39], s27 offen offset:0 lds
  buffer_load_dwordx4 v9, s[36:39], s27 offen offset:1024 lds
  buffer_load_dwordx4 v10, s[36:39], s27 offen offset:2048 lds
  buffer_load_dwordx4 v11, s[36:39], s27 offen offset:3072 lds
  s_add_u32 s26, s26, 64
  s_add_u32 s27, s27, 262144
  s_add_u32 s24, s24, 32768
  s_and_b32 s24, s24, 0x1ffff
  s_mov_b32 m0, s24
  s_nop 0
  buffer_load_dwordx4 v4, s[32:35], s26 offen offset:0 lds
  buffer_load_dwordx4 v5, s[32:35], s26 offen offset:1024 lds
  buffer_load_dwordx4 v6, s[32:35], s26 offen offset:2048 lds
  buffer_load_dwordx4 v7, s[32:35], s26 offen offset:3072 lds
  s_add_u32 m0, s24, 16384
  s_nop 0
  buffer_load_dwordx4 v8, s[36:39], s27 offen offset:0 lds
  buffer_load_dwordx4 v9, s[36:39], s27 offen offset:1024 lds
  buffer_load_dwordx4 v10, s[36:39], s27 offen offset:2048 lds
  buffer_load_dwordx4 v11, s[36:39], s27 offen offset:3072 lds
  s_add_u32 s26, s26, 64
  s_add_u32 s27, s27, 262144
  s_add_u32 s24, s24, 32768
  s_and_b32 s24, s24, 0x1ffff
  s_mov_b32 m0, s24
  s_nop 0
  buffer_load_dwordx4 v4, s[32:35], s26 offen offset:0 lds
  buffer_load_dwordx4 v5, s[32:35], s26 offen offset:1024 lds
  buffer_load_dwordx4 v6, s[32:35], s26 offen offset:2048 lds
  buffer_load_dwordx4 v7, s[32:35], s26 offen offset:3072 lds
  s_add_u32 m0, s24, 16384
  s_nop 0
  buffer_load_dwordx4 v8, s[36:39], s27 offen offset:0 lds
  buffer_load_dwordx4 v9, s[36:39], s27 offen offset:1024 lds
  buffer_load_dwordx4 v10, s[36:39], s27 offen offset:2048 lds
  buffer_load_dwordx4 v11, s[36:39], s27 offen offset:3072 lds
  s_add_u32 s26, s26, 64
  s_add_u32 s27, s27, 262144
  s_add_u32 s24, s24, 32768
  s_and_b32 s24, s24, 0x1ffff
  s_and_b32 s29, s2, 1
  s_lshl_b32 s29, s29, 2
  s_add_u32 s29, s29, s20
  s_lshr_b32 s30, s2, 1
  s_mul_i32 s23, s30, 40960
  s_mul_i32 s31, s29, 160
  s_add_u32 s23, s23, s31
  s_mul_i32 s31, s20, 5120
  s_add_u32 s31, s31, 131072
  v_add_u32 v16, 0, v1
  v_mul_u32_u24 v17, 6554, v16
  v_lshrrev_b32 v17, 16, v17
  v_mul_u32_u24 v17, 1120, v17
  v_lshl_add_u32 v17, v16, 4, v17
  s_add_u32 m0, s31, 0
  s_nop 0
  buffer_load_dwordx4 v17, s[52:55], s23 offen lds
  v_add_u32 v16, 64, v1
  v_mul_u32_u24 v17, 6554, v16
  v_lshrrev_b32 v17, 16, v17
  v_mul_u32_u24 v17, 1120, v17
  v_lshl_add_u32 v17, v16, 4, v17
  s_add_u32 m0, s31, 1024
  s_nop 0
  buffer_load_dwordx4 v17, s[52:55], s23 offen lds
  v_add_u32 v16, 128, v1
  v_mul_u32_u24 v17, 6554, v16
  v_lshrrev_b32 v17, 16, v17
  v_mul_u32_u24 v17, 1120, v17
  v_lshl_add_u32 v17, v16, 4, v17
  s_add_u32 m0, s31, 2048
  s_nop 0
  buffer_load_dwordx4 v17, s[52:55], s23 offen lds
  v_add_u32 v16, 192, v1
  v_mul_u32_u24 v17, 6554, v16
  v_lshrrev_b32 v17, 16, v17
  v_mul_u32_u24 v17, 1120, v17
  v_lshl_add_u32 v17, v16, 4, v17
  s_add_u32 m0, s31, 3072
  s_nop 0
  buffer_load_dwordx4 v17, s[52:55], s23 offen lds
  v_add_u32 v16, 256, v1
  v_mul_u32_u24 v17, 6554, v16
  v_lshrrev_b32 v17, 16, v17
  v_mul_u32_u24 v17, 1120, v17
  v_lshl_add_u32 v17, v16, 4, v17
  s_add_u32 m0, s31, 4096
  s_nop 0
  buffer_load_dwordx4 v17, s[52:55], s23 offen lds
  v_mov_b32 v20, 0
  v_mov_b32 v21, 0
  v_mov_b32 v22, 0
  v_mov_b32 v23, 0
  v_and_b32 v16, 15, v1
  v_lshrrev_b32 v17, 4, v1
  v_lshrrev_b32 v18, 3, v16
  v_mul_u32_u24 v18, 3, v18
  v_xor_b32 v18, v18, v17
  v_lshlrev_b32 v18, 4, v18
  v_lshl_add_u32 v12, v16, 6, v18
  s_and_b32 s23, s20, 1
  s_lshl_b32 s23, s23, 13
  v_add_u32 v12, s23, v12
  v_mfma_f32_32x32x16_bf16 a[0:15], v[20:23], v[20:23], 0
  v_mfma_f32_32x32x16_bf16 a[16:31], v[20:23], v[20:23], 0
  v_mfma_f32_32x32x16_bf16 a[32:47], v[20:23], v[20:23], 0
  v_mfma_f32_32x32x16_bf16 a[48:63], v[20:23], v[20:23], 0
  v_mfma_f32_32x32x16_bf16 a[64:79], v[20:23], v[20:23], 0
  v_mfma_f32_32x32x16_bf16 a[80:95], v[20:23], v[20:23], 0
  v_mfma_f32_32x32x16_bf16 a[96:111], v[20:23], v[20:23], 0
  v_mfma_f32_32x32x16_bf16 a[112:127], v[20:23], v[20:23], 0
  v_mfma_f32_32x32x16_bf16 a[128:143], v[20:23], v[20:23], 0
  v_mfma_f32_32x32x16_bf16 a[144:159], v[20:23], v[20:23], 0
  v_mfma_f32_32x32x16_bf16 a[160:175], v[20:23], v[20:23], 0
  v_mfma_f32_32x32x16_bf16 a[176:191], v[20:23], v[20:23], 0
  v_mfma_f32_32x32x16_bf16 a[192:207], v[20:23], v[20:23], 0
  v_mfma_f32_32x32x16_bf16 a[208:223], v[20:23], v[20:23], 0
  v_mfma_f32_32x32x16_bf16 a[224:239], v[20:23], v[20:23], 0
  v_mfma_f32_32x32x16_bf16 a[240:255], v[20:23], v[20:23], 0
  v_lshrrev_b32 v18, 2, v16
  v_lshlrev_b32 v18, 6, v18
  v_lshl_add_u32 v18, v17, 11, v18
  v_and_b32 v19, 1, v1
  v_lshl_add_u32 v18, v19, 3, v18
  v_bfe_u32 v19, v1, 1, 1
  v_and_b32 v17, 1, v17
  v_lshl_or_b32 v19, v17, 1, v19
  s_lshr_b32 s23, s20, 1
  s_lshl_b32 s23, s23, 13
  s_add_u32 s23, s23, 16384
  v_add_u32 v18, s23, v18
  v_lshl_add_u32 v13, v19, 4, v18
  v_xor_b32 v14, 32, v13
  s_waitcnt vmcnt(29)
  v_lshlrev_b32 v184, 16, v160
  v_and_b32 v185, 0xffff0000, v160
  v_lshlrev_b32 v186, 16, v161
  v_and_b32 v187, 0xffff0000, v161
  v_lshlrev_b32 v188, 16, v162
  v_and_b32 v189, 0xffff0000, v162
  v_lshlrev_b32 v190, 16, v163
  v_and_b32 v191, 0xffff0000, v163
  v_lshlrev_b32 v192, 16, v164
  v_and_b32 v193, 0xffff0000, v164
  v_lshlrev_b32 v194, 16, v165
  v_and_b32 v195, 0xffff0000, v165
  v_lshlrev_b32 v196, 16, v166
  v_and_b32 v197, 0xffff0000, v166
  v_lshlrev_b32 v198, 16, v167
  v_and_b32 v199, 0xffff0000, v167
  v_lshlrev_b32 v200, 16, v168
  v_and_b32 v201, 0xffff0000, v168
  v_lshlrev_b32 v202, 16, v169
  v_and_b32 v203, 0xffff0000, v169
  v_lshlrev_b32 v204, 16, v170
  v_and_b32 v205, 0xffff0000, v170
  v_lshlrev_b32 v206, 16, v171
  v_and_b32 v207, 0xffff0000, v171
  v_add_f32 v213, v184, v185
  v_add_f32 v214, v186, v187
  v_add_f32 v213, v213, v188
  v_add_f32 v214, v214, v189
  v_add_f32 v213, v213, v190
  v_add_f32 v214, v214, v191
  v_add_f32 v213, v213, v192
  v_add_f32 v214, v214, v193
  v_add_f32 v213, v213, v194
  v_add_f32 v214, v214, v195
  v_add_f32 v213, v213, v196
  v_add_f32 v214, v214, v197
  v_add_f32 v213, v213, v198
  v_add_f32 v214, v214, v199
  v_add_f32 v213, v213, v200
  v_add_f32 v214, v214, v201
  v_add_f32 v213, v213, v202
  v_add_f32 v214, v214, v203
  v_add_f32 v213, v213, v204
  v_add_f32 v214, v214, v205
  v_add_f32 v213, v213, v206
  v_add_f32 v214, v214, v207
  v_add_f32 v213, v213, v214
  s_nop 1
  v_add_f32_dpp v213, v213, v213 quad_perm:[1,0,3,2] row_mask:0xf bank_mask:0xf
  s_nop 1
  v_add_f32_dpp v213, v213, v213 quad_perm:[2,3,0,1] row_mask:0xf bank_mask:0xf
  s_nop 1
  v_add_f32_dpp v213, v213, v213 row_half_mirror row_mask:0xf bank_mask:0xf
  s_nop 1
  v_add_f32_dpp v213, v213, v213 row_mirror row_mask:0xf bank_mask:0xf
  v_mov_b32 v214, v213
  s_nop 1
  v_permlane16_swap_b32 v213, v214
  v_add_f32 v213, v213, v214
  v_mul_f32 v215, 0x3acccccd, v213
  v_mov_b32 v218, 0
  v_mov_b32 v213, 0
  v_sub_f32 v16, v184, v215
  v_fmac_f32 v218, v16, v16
  v_sub_f32 v17, v185, v215
  v_fmac_f32 v218, v17, v17
  v_sub_f32 v18, v186, v215
  v_fmac_f32 v218, v18, v18
  v_sub_f32 v19, v187, v215
  v_fmac_f32 v218, v19, v19
  v_sub_f32 v16, v188, v215
  v_fmac_f32 v218, v16, v16
  v_sub_f32 v17, v189, v215
  v_fmac_f32 v218, v17, v17
  v_sub_f32 v18, v190, v215
  v_fmac_f32 v218, v18, v18
  v_sub_f32 v19, v191, v215
  v_fmac_f32 v218, v19, v19
  v_sub_f32 v16, v192, v215
  v_fmac_f32 v218, v16, v16
  v_sub_f32 v17, v193, v215
  v_fmac_f32 v218, v17, v17
  v_sub_f32 v18, v194, v215
  v_fmac_f32 v218, v18, v18
  v_sub_f32 v19, v195, v215
  v_fmac_f32 v218, v19, v19
  v_sub_f32 v16, v196, v215
  v_fmac_f32 v218, v16, v16
  v_sub_f32 v17, v197, v215
  v_fmac_f32 v218, v17, v17
  v_sub_f32 v18, v198, v215
  v_fmac_f32 v218, v18, v18
  v_sub_f32 v19, v199, v215
  v_fmac_f32 v218, v19, v19
  v_sub_f32 v16, v200, v215
  v_fmac_f32 v213, v16, v16
  v_sub_f32 v17, v201, v215
  v_fmac_f32 v213, v17, v17
  v_sub_f32 v18, v202, v215
  v_fmac_f32 v213, v18, v18
  v_sub_f32 v19, v203, v215
  v_fmac_f32 v213, v19, v19
  v_sub_f32 v16, v204, v215
  v_fmac_f32 v213, v16, v16
  v_sub_f32 v17, v205, v215
  v_fmac_f32 v213, v17, v17
  v_sub_f32 v18, v206, v215
  v_fmac_f32 v213, v18, v18
  v_sub_f32 v19, v207, v215
  v_fmac_f32 v213, v19, v19
  v_cndmask_b32 v213, 0, v213, s[56:57]
  v_add_f32 v213, v213, v218
  s_nop 1
  v_add_f32_dpp v213, v213, v213 quad_perm:[1,0,3,2] row_mask:0xf bank_mask:0xf
  s_nop 1
  v_add_f32_dpp v213, v213, v213 quad_perm:[2,3,0,1] row_mask:0xf bank_mask:0xf
  s_nop 1
  v_add_f32_dpp v213, v213, v213 row_half_mirror row_mask:0xf bank_mask:0xf
  s_nop 1
  v_add_f32_dpp v213, v213, v213 row_mirror row_mask:0xf bank_mask:0xf
  v_mov_b32 v214, v213
  s_nop 1
  v_permlane16_swap_b32 v213, v214
  v_add_f32 v213, v213, v214
  v_mul_f32 v213, 0x3acccccd, v213
  v_cvt_pk_bf16_f32 v213, v213, v213
  v_and_b32 v213, 0xffff0000, v213
  v_add_f32 v213, 0x3727c5ac, v213
  v_cvt_pk_bf16_f32 v213, v213, v213
  v_and_b32 v213, 0xffff0000, v213
  v_sqrt_f32 v213, v213
  v_mov_b32 v216, v215
  v_cvt_pk_bf16_f32 v213, v213, v213
  v_and_b32 v213, 0xffff0000, v213
  v_rcp_f32 v217, v213
  v_cvt_pk_bf16_f32 v216, v216, v216
  v_and_b32 v216, 0xffff0000, v216
  v_mov_b32 v218, 0
  v_sub_f32 v184, v184, v216
  v_sub_f32 v185, v185, v216
  v_cvt_pk_bf16_f32 v16, v184, v185
  v_lshlrev_b32 v184, 16, v16
  v_and_b32 v185, 0xffff0000, v16
  v_mul_f32 v184, v184, v217
  v_mul_f32 v185, v185, v217
  v_cvt_pk_bf16_f32 v160, v184, v185
  v_lshlrev_b32 v184, 16, v160
  v_and_b32 v185, 0xffff0000, v160
  v_lshlrev_b32 v17, 16, v172
  v_and_b32 v18, 0xffff0000, v172
  v_fmac_f32 v218, v184, v17
  v_fmac_f32 v218, v185, v18
  v_sub_f32 v186, v186, v216
  v_sub_f32 v187, v187, v216
  v_cvt_pk_bf16_f32 v16, v186, v187
  v_lshlrev_b32 v186, 16, v16
  v_and_b32 v187, 0xffff0000, v16
  v_mul_f32 v186, v186, v217
  v_mul_f32 v187, v187, v217
  v_cvt_pk_bf16_f32 v161, v186, v187
  v_lshlrev_b32 v186, 16, v161
  v_and_b32 v187, 0xffff0000, v161
  v_lshlrev_b32 v17, 16, v173
  v_and_b32 v18, 0xffff0000, v173
  v_fmac_f32 v218, v186, v17
  v_fmac_f32 v218, v187, v18
  v_sub_f32 v188, v188, v216
  v_sub_f32 v189, v189, v216
  v_cvt_pk_bf16_f32 v16, v188, v189
  v_lshlrev_b32 v188, 16, v16
  v_and_b32 v189, 0xffff0000, v16
  v_mul_f32 v188, v188, v217
  v_mul_f32 v189, v189, v217
  v_cvt_pk_bf16_f32 v162, v188, v189
  v_lshlrev_b32 v188, 16, v162
  v_and_b32 v189, 0xffff0000, v162
  v_lshlrev_b32 v17, 16, v174
  v_and_b32 v18, 0xffff0000, v174
  v_fmac_f32 v218, v188, v17
  v_fmac_f32 v218, v189, v18
  v_sub_f32 v190, v190, v216
  v_sub_f32 v191, v191, v216
  v_cvt_pk_bf16_f32 v16, v190, v191
  v_lshlrev_b32 v190, 16, v16
  v_and_b32 v191, 0xffff0000, v16
  v_mul_f32 v190, v190, v217
  v_mul_f32 v191, v191, v217
  v_cvt_pk_bf16_f32 v163, v190, v191
  v_lshlrev_b32 v190, 16, v163
  v_and_b32 v191, 0xffff0000, v163
  v_lshlrev_b32 v17, 16, v175
  v_and_b32 v18, 0xffff0000, v175
  v_fmac_f32 v218, v190, v17
  v_fmac_f32 v218, v191, v18
  v_sub_f32 v192, v192, v216
  v_sub_f32 v193, v193, v216
  v_cvt_pk_bf16_f32 v16, v192, v193
  v_lshlrev_b32 v192, 16, v16
  v_and_b32 v193, 0xffff0000, v16
  v_mul_f32 v192, v192, v217
  v_mul_f32 v193, v193, v217
  v_cvt_pk_bf16_f32 v164, v192, v193
  v_lshlrev_b32 v192, 16, v164
  v_and_b32 v193, 0xffff0000, v164
  v_lshlrev_b32 v17, 16, v176
  v_and_b32 v18, 0xffff0000, v176
  v_fmac_f32 v218, v192, v17
  v_fmac_f32 v218, v193, v18
  v_sub_f32 v194, v194, v216
  v_sub_f32 v195, v195, v216
  v_cvt_pk_bf16_f32 v16, v194, v195
  v_lshlrev_b32 v194, 16, v16
  v_and_b32 v195, 0xffff0000, v16
  v_mul_f32 v194, v194, v217
  v_mul_f32 v195, v195, v217
  v_cvt_pk_bf16_f32 v165, v194, v195
  v_lshlrev_b32 v194, 16, v165
  v_and_b32 v195, 0xffff0000, v165
  v_lshlrev_b32 v17, 16, v177
  v_and_b32 v18, 0xffff0000, v177
  v_fmac_f32 v218, v194, v17
  v_fmac_f32 v218, v195, v18
  v_sub_f32 v196, v196, v216
  v_sub_f32 v197, v197, v216
  v_cvt_pk_bf16_f32 v16, v196, v197
  v_lshlrev_b32 v196, 16, v16
  v_and_b32 v197, 0xffff0000, v16
  v_mul_f32 v196, v196, v217
  v_mul_f32 v197, v197, v217
  v_cvt_pk_bf16_f32 v166, v196, v197
  v_lshlrev_b32 v196, 16, v166
  v_and_b32 v197, 0xffff0000, v166
  v_lshlrev_b32 v17, 16, v178
  v_and_b32 v18, 0xffff0000, v178
  v_fmac_f32 v218, v196, v17
  v_fmac_f32 v218, v197, v18
  v_sub_f32 v198, v198, v216
  v_sub_f32 v199, v199, v216
  v_cvt_pk_bf16_f32 v16, v198, v199
  v_lshlrev_b32 v198, 16, v16
  v_and_b32 v199, 0xffff0000, v16
  v_mul_f32 v198, v198, v217
  v_mul_f32 v199, v199, v217
  v_cvt_pk_bf16_f32 v167, v198, v199
  v_lshlrev_b32 v198, 16, v167
  v_and_b32 v199, 0xffff0000, v167
  v_lshlrev_b32 v17, 16, v179
  v_and_b32 v18, 0xffff0000, v179
  v_fmac_f32 v218, v198, v17
  v_fmac_f32 v218, v199, v18
  v_sub_f32 v200, v200, v216
  v_sub_f32 v201, v201, v216
  v_cvt_pk_bf16_f32 v16, v200, v201
  v_lshlrev_b32 v200, 16, v16
  v_and_b32 v201, 0xffff0000, v16
  v_mul_f32 v200, v200, v217
  v_mul_f32 v201, v201, v217
  v_cvt_pk_bf16_f32 v168, v200, v201
  v_lshlrev_b32 v200, 16, v168
  v_and_b32 v201, 0xffff0000, v168
  v_lshlrev_b32 v17, 16, v180
  v_and_b32 v18, 0xffff0000, v180
  v_fmac_f32 v218, v200, v17
  v_fmac_f32 v218, v201, v18
  v_sub_f32 v202, v202, v216
  v_sub_f32 v203, v203, v216
  v_cvt_pk_bf16_f32 v16, v202, v203
  v_lshlrev_b32 v202, 16, v16
  v_and_b32 v203, 0xffff0000, v16
  v_mul_f32 v202, v202, v217
  v_mul_f32 v203, v203, v217
  v_cvt_pk_bf16_f32 v169, v202, v203
  v_lshlrev_b32 v202, 16, v169
  v_and_b32 v203, 0xffff0000, v169
  v_lshlrev_b32 v17, 16, v181
  v_and_b32 v18, 0xffff0000, v181
  v_fmac_f32 v218, v202, v17
  v_fmac_f32 v218, v203, v18
  v_sub_f32 v204, v204, v216
  v_sub_f32 v205, v205, v216
  v_cvt_pk_bf16_f32 v16, v204, v205
  v_lshlrev_b32 v204, 16, v16
  v_and_b32 v205, 0xffff0000, v16
  v_mul_f32 v204, v204, v217
  v_mul_f32 v205, v205, v217
  v_cvt_pk_bf16_f32 v170, v204, v205
  v_lshlrev_b32 v204, 16, v170
  v_and_b32 v205, 0xffff0000, v170
  v_lshlrev_b32 v17, 16, v182
  v_and_b32 v18, 0xffff0000, v182
  v_fmac_f32 v218, v204, v17
  v_fmac_f32 v218, v205, v18
  v_sub_f32 v206, v206, v216
  v_sub_f32 v207, v207, v216
  v_cvt_pk_bf16_f32 v16, v206, v207
  v_lshlrev_b32 v206, 16, v16
  v_and_b32 v207, 0xffff0000, v16
  v_mul_f32 v206, v206, v217
  v_mul_f32 v207, v207, v217
  v_cvt_pk_bf16_f32 v171, v206, v207
  v_lshlrev_b32 v206, 16, v171
  v_and_b32 v207, 0xffff0000, v171
  v_lshlrev_b32 v17, 16, v183
  v_and_b32 v18, 0xffff0000, v183
  v_fmac_f32 v218, v206, v17
  v_fmac_f32 v218, v207, v18
  v_lshrrev_b32 v16, 4, v209
  v_mul_u32_u24 v16, 20480, v16
  v_and_b32 v17, 15, v209
  v_lshl_add_u32 v16, v17, 4, v16
  v_lshl_add_u32 v210, v208, 8, v16
  v_add_u32 v17, 8192, v210
  v_add_u32 v18, 16384, v210
  v_mov_b32 v19, 0x40000000
  v_cndmask_b32 v18, v19, v18, s[56:57]
  buffer_store_dwordx4 v[160:163], v210, s[40:43], 0 offen
  buffer_store_dwordx4 v[164:167], v17, s[40:43], 0 offen
  buffer_store_dwordx4 v[168:171], v18, s[40:43], 0 offen
  s_nop 1
  v_add_f32_dpp v218, v218, v218 quad_perm:[1,0,3,2] row_mask:0xf bank_mask:0xf
  s_nop 1
  v_add_f32_dpp v218, v218, v218 quad_perm:[2,3,0,1] row_mask:0xf bank_mask:0xf
  s_nop 1
  v_add_f32_dpp v218, v218, v218 row_half_mirror row_mask:0xf bank_mask:0xf
  s_nop 1
  v_add_f32_dpp v218, v218, v218 row_mirror row_mask:0xf bank_mask:0xf
  v_mov_b32 v214, v218
  s_nop 1
  v_permlane16_swap_b32 v218, v214
  v_add_f32 v218, v218, v214
  v_cvt_pk_bf16_f32 v218, v218, v218
  v_and_b32 v218, 0xffff0000, v218
  v_ashrrev_i32 v214, 31, v218
  v_or_b32 v214, 0x80000000, v214
  v_xor_b32 v218, v218, v214
  v_and_b32 v218, 0xffff0000, v218
  v_sub_u32 v214, 0xffff, v209
  v_or_b32 v218, v218, v214
  v_lshlrev_b32 v214, 2, v209
  v_add_u32 v214, 2621440, v214
  v_cmp_eq_u32 vcc, 0, v208
  s_nop 1
  v_cndmask_b32 v214, v19, v214, vcc
  buffer_store_dword v218, v214, s[40:43], 0 offen
  s_barrier
  s_mov_b32 s28, 0
  s_cmp_ge_u32 s20, 2
  s_cbranch_scc1 k1_roleV
  ds_read_b128 v[96:99], v12 offset:0
  ds_read_b128 v[100:103], v12 offset:1024
  ds_read_b128 v[104:107], v12 offset:2048
  ds_read_b128 v[108:111], v12 offset:3072
  ds_read_b128 v[112:115], v12 offset:4096
  ds_read_b128 v[116:119], v12 offset:5120
  ds_read_b128 v[120:123], v12 offset:6144
  ds_read_b128 v[124:127], v12 offset:7168
  ds_read_b64_tr_b16 v[32:33], v13 offset:0
  ds_read_b64_tr_b16 v[34:35], v13 offset:1024
  ds_read_b64_tr_b16 v[36:37], v14 offset:0
  ds_read_b64_tr_b16 v[38:39], v14 offset:1024
  ds_read_b64_tr_b16 v[40:41], v13 offset:256
  ds_read_b64_tr_b16 v[42:43], v13 offset:1280
  ds_read_b64_tr_b16 v[44:45], v14 offset:256
  ds_read_b64_tr_b16 v[46:47], v14 offset:1280
  ds_read_b64_tr_b16 v[48:49], v13 offset:512
  ds_read_b64_tr_b16 v[50:51], v13 offset:1536
  ds_read_b64_tr_b16 v[52:53], v14 offset:512
  ds_read_b64_tr_b16 v[54:55], v14 offset:1536
  ds_read_b64_tr_b16 v[56:57], v13 offset:768
  ds_read_b64_tr_b16 v[58:59], v13 offset:1792
  ds_read_b64_tr_b16 v[60:61], v14 offset:768
  ds_read_b64_tr_b16 v[62:63], v14 offset:1792
  s_waitcnt lgkmcnt(0)
.p2align 6
k1_loopK:
  v_mfma_f32_16x16x32_bf16 a[0:3], v[32:35], v[96:99], a[0:3]
  s_waitcnt vmcnt(16)
  v_mfma_f32_16x16x32_bf16 a[4:7], v[32:35], v[100:103], a[4:7]
  s_barrier
  v_mfma_f32_16x16x32_bf16 a[8:11], v[32:35], v[104:107], a[8:11]
  s_mov_b32 m0, s24
  ds_read_b64_tr_b16 v[64:65], v13 offset:32768
  v_mfma_f32_16x16x32_bf16 a[12:15], v[32:35], v[108:111], a[12:15]
  buffer_load_dwordx4 v4, s[32:35], s26 offen offset:0 lds
  v_mfma_f32_16x16x32_bf16 a[16:19], v[32:35], v[112:115], a[16:19]
  ds_read_b64_tr_b16 v[66:67], v13 offset:33792
  v_mfma_f32_16x16x32_bf16 a[20:23], v[32:35], v[116:119], a[20:23]
  v_mfma_f32_16x16x32_bf16 a[24:27], v[32:35], v[120:123], a[24:27]
  ds_read_b128 v[128:131], v12 offset:32768
  v_mfma_f32_16x16x32_bf16 a[28:31], v[32:35], v[124:127], a[28:31]
  v_mfma_f32_16x16x32_bf16 a[32:35], v[36:39], v[96:99], a[32:35]
  ds_read_b64_tr_b16 v[68:69], v14 offset:32768
  v_mfma_f32_16x16x32_bf16 a[36:39], v[36:39], v[100:103], a[36:39]
  buffer_load_dwordx4 v5, s[32:35], s26 offen offset:1024 lds
  v_mfma_f32_16x16x32_bf16 a[40:43], v[36:39], v[104:107], a[40:43]
  ds_read_b64_tr_b16 v[70:71], v14 offset:33792
  v_mfma_f32_16x16x32_bf16 a[44:47], v[36:39], v[108:111], a[44:47]
  v_mfma_f32_16x16x32_bf16 a[48:51], v[36:39], v[112:115], a[48:51]
  ds_read_b128 v[132:135], v12 offset:33792
  v_mfma_f32_16x16x32_bf16 a[52:55], v[36:39], v[116:119], a[52:55]
  v_mfma_f32_16x16x32_bf16 a[56:59], v[36:39], v[120:123], a[56:59]
  ds_read_b64_tr_b16 v[72:73], v13 offset:33024
  v_mfma_f32_16x16x32_bf16 a[60:63], v[36:39], v[124:127], a[60:63]
  buffer_load_dwordx4 v6, s[32:35], s26 offen offset:2048 lds
  v_mfma_f32_16x16x32_bf16 a[64:67], v[40:43], v[96:99], a[64:67]
  ds_read_b64_tr_b16 v[74:75], v13 offset:34048
  v_mfma_f32_16x16x32_bf16 a[68:71], v[40:43], v[100:103], a[68:71]
  v_mfma_f32_16x16x32_bf16 a[72:75], v[40:43], v[104:107], a[72:75]
  ds_read_b128 v[136:139], v12 offset:34816
  v_mfma_f32_16x16x32_bf16 a[76:79], v[40:43], v[108:111], a[76:79]
  v_mfma_f32_16x16x32_bf16 a[80:83], v[40:43], v[112:115], a[80:83]
  ds_read_b64_tr_b16 v[76:77], v14 offset:33024
  v_mfma_f32_16x16x32_bf16 a[84:87], v[40:43], v[116:119], a[84:87]
  buffer_load_dwordx4 v7, s[32:35], s26 offen offset:3072 lds
  v_mfma_f32_16x16x32_bf16 a[88:91], v[40:43], v[120:123], a[88:91]
  ds_read_b64_tr_b16 v[78:79], v14 offset:34048
  v_mfma_f32_16x16x32_bf16 a[92:95], v[40:43], v[124:127], a[92:95]
  v_mfma_f32_16x16x32_bf16 a[96:99], v[44:47], v[96:99], a[96:99]
  ds_read_b128 v[140:143], v12 offset:35840
  v_mfma_f32_16x16x32_bf16 a[100:103], v[44:47], v[100:103], a[100:103]
  v_mfma_f32_16x16x32_bf16 a[104:107], v[44:47], v[104:107], a[104:107]
  s_add_u32 m0, s24, 16384
  ds_read_b64_tr_b16 v[80:81], v13 offset:33280
  v_mfma_f32_16x16x32_bf16 a[108:111], v[44:47], v[108:111], a[108:111]
  buffer_load_dwordx4 v8, s[36:39], s27 offen offset:0 lds
  v_mfma_f32_16x16x32_bf16 a[112:115], v[44:47], v[112:115], a[112:115]
  ds_read_b64_tr_b16 v[82:83], v13 offset:34304
  v_mfma_f32_16x16x32_bf16 a[116:119], v[44:47], v[116:119], a[116:119]
  v_mfma_f32_16x16x32_bf16 a[120:123], v[44:47], v[120:123], a[120:123]
  ds_read_b128 v[144:147], v12 offset:36864
  v_mfma_f32_16x16x32_bf16 a[124:127], v[44:47], v[124:127], a[124:127]
  v_mfma_f32_16x16x32_bf16 a[128:131], v[48:51], v[96:99], a[128:131]
  ds_read_b64_tr_b16 v[84:85], v14 offset:33280
  v_mfma_f32_16x16x32_bf16 a[132:135], v[48:51], v[100:103], a[132:135]
  buffer_load_dwordx4 v9, s[36:39], s27 offen offset:1024 lds
  v_mfma_f32_16x16x32_bf16 a[136:139], v[48:51], v[104:107], a[136:139]
  ds_read_b64_tr_b16 v[86:87], v14 offset:34304
  v_mfma_f32_16x16x32_bf16 a[140:143], v[48:51], v[108:111], a[140:143]
  v_mfma_f32_16x16x32_bf16 a[144:147], v[48:51], v[112:115], a[144:147]
  ds_read_b128 v[148:151], v12 offset:37888
  v_mfma_f32_16x16x32_bf16 a[148:151], v[48:51], v[116:119], a[148:151]
  v_mfma_f32_16x16x32_bf16 a[152:155], v[48:51], v[120:123], a[152:155]
  ds_read_b64_tr_b16 v[88:89], v13 offset:33536
  v_mfma_f32_16x16x32_bf16 a[156:159], v[48:51], v[124:127], a[156:159]
  buffer_load_dwordx4 v10, s[36:39], s27 offen offset:2048 lds
  v_mfma_f32_16x16x32_bf16 a[160:163], v[52:55], v[96:99], a[160:163]
  ds_read_b64_tr_b16 v[90:91], v13 offset:34560
  v_mfma_f32_16x16x32_bf16 a[164:167], v[52:55], v[100:103], a[164:167]
  v_mfma_f32_16x16x32_bf16 a[168:171], v[52:55], v[104:107], a[168:171]
  ds_read_b128 v[152:155], v12 offset:38912
  v_mfma_f32_16x16x32_bf16 a[172:175], v[52:55], v[108:111], a[172:175]
  v_mfma_f32_16x16x32_bf16 a[176:179], v[52:55], v[112:115], a[176:179]
  ds_read_b64_tr_b16 v[92:93], v14 offset:33536
  v_mfma_f32_16x16x32_bf16 a[180:183], v[52:55], v[116:119], a[180:183]
  buffer_load_dwordx4 v11, s[36:39], s27 offen offset:3072 lds
  v_mfma_f32_16x16x32_bf16 a[184:187], v[52:55], v[120:123], a[184:187]
  ds_read_b64_tr_b16 v[94:95], v14 offset:34560
  v_mfma_f32_16x16x32_bf16 a[188:191], v[52:55], v[124:127], a[188:191]
  v_mfma_f32_16x16x32_bf16 a[192:195], v[56:59], v[96:99], a[192:195]
  s_add_u32 s26, s26, 64
  ds_read_b128 v[156:159], v12 offset:39936
  v_mfma_f32_16x16x32_bf16 a[196:199], v[56:59], v[100:103], a[196:199]
  s_add_u32 s27, s27, 262144
  v_mfma_f32_16x16x32_bf16 a[200:203], v[56:59], v[104:107], a[200:203]
  s_add_u32 s24, s24, 32768
  v_mfma_f32_16x16x32_bf16 a[204:207], v[56:59], v[108:111], a[204:207]
  s_and_b32 s24, s24, 0x1ffff
  v_mfma_f32_16x16x32_bf16 a[208:211], v[56:59], v[112:115], a[208:211]
  v_xor_b32 v12, 0x10000, v12
  v_mfma_f32_16x16x32_bf16 a[212:215], v[56:59], v[116:119], a[212:215]
  v_xor_b32 v13, 0x10000, v13
  v_mfma_f32_16x16x32_bf16 a[216:219], v[56:59], v[120:123], a[216:219]
  v_xor_b32 v14, 0x10000, v14
  v_mfma_f32_16x16x32_bf16 a[220:223], v[56:59], v[124:127], a[220:223]
  v_mfma_f32_16x16x32_bf16 a[224:227], v[60:63], v[96:99], a[224:227]
  v_mfma_f32_16x16x32_bf16 a[228:231], v[60:63], v[100:103], a[228:231]
  v_mfma_f32_16x16x32_bf16 a[232:235], v[60:63], v[104:107], a[232:235]
  v_mfma_f32_16x16x32_bf16 a[236:239], v[60:63], v[108:111], a[236:239]
  v_mfma_f32_16x16x32_bf16 a[240:243], v[60:63], v[112:115], a[240:243]
  v_mfma_f32_16x16x32_bf16 a[244:247], v[60:63], v[116:119], a[244:247]
  v_mfma_f32_16x16x32_bf16 a[248:251], v[60:63], v[120:123], a[248:251]
  v_mfma_f32_16x16x32_bf16 a[252:255], v[60:63], v[124:127], a[252:255]
  s_waitcnt lgkmcnt(0)
  v_mfma_f32_16x16x32_bf16 a[0:3], v[64:67], v[128:131], a[0:3]
  s_waitcnt vmcnt(16)
  v_mfma_f32_16x16x32_bf16 a[4:7], v[64:67], v[132:135], a[4:7]
  s_barrier
  v_mfma_f32_16x16x32_bf16 a[8:11], v[64:67], v[136:139], a[8:11]
  s_mov_b32 m0, s24
  ds_read_b64_tr_b16 v[32:33], v13 offset:0
  v_mfma_f32_16x16x32_bf16 a[12:15], v[64:67], v[140:143], a[12:15]
  buffer_load_dwordx4 v4, s[32:35], s26 offen offset:0 lds
  v_mfma_f32_16x16x32_bf16 a[16:19], v[64:67], v[144:147], a[16:19]
  ds_read_b64_tr_b16 v[34:35], v13 offset:1024
  v_mfma_f32_16x16x32_bf16 a[20:23], v[64:67], v[148:151], a[20:23]
  v_mfma_f32_16x16x32_bf16 a[24:27], v[64:67], v[152:155], a[24:27]
  ds_read_b128 v[96:99], v12 offset:0
  v_mfma_f32_16x16x32_bf16 a[28:31], v[64:67], v[156:159], a[28:31]
  v_mfma_f32_16x16x32_bf16 a[32:35], v[68:71], v[128:131], a[32:35]
  ds_read_b64_tr_b16 v[36:37], v14 offset:0
  v_mfma_f32_16x16x32_bf16 a[36:39], v[68:71], v[132:135], a[36:39]
  buffer_load_dwordx4 v5, s[32:35], s26 offen offset:1024 lds
  v_mfma_f32_16x16x32_bf16 a[40:43], v[68:71], v[136:139], a[40:43]
  ds_read_b64_tr_b16 v[38:39], v14 offset:1024
  v_mfma_f32_16x16x32_bf16 a[44:47], v[68:71], v[140:143], a[44:47]
  v_mfma_f32_16x16x32_bf16 a[48:51], v[68:71], v[144:147], a[48:51]
  ds_read_b128 v[100:103], v12 offset:1024
  v_mfma_f32_16x16x32_bf16 a[52:55], v[68:71], v[148:151], a[52:55]
  v_mfma_f32_16x16x32_bf16 a[56:59], v[68:71], v[152:155], a[56:59]
  ds_read_b64_tr_b16 v[40:41], v13 offset:256
  v_mfma_f32_16x16x32_bf16 a[60:63], v[68:71], v[156:159], a[60:63]
  buffer_load_dwordx4 v6, s[32:35], s26 offen offset:2048 lds
  v_mfma_f32_16x16x32_bf16 a[64:67], v[72:75], v[128:131], a[64:67]
  ds_read_b64_tr_b16 v[42:43], v13 offset:1280
  v_mfma_f32_16x16x32_bf16 a[68:71], v[72:75], v[132:135], a[68:71]
  v_mfma_f32_16x16x32_bf16 a[72:75], v[72:75], v[136:139], a[72:75]
  ds_read_b128 v[104:107], v12 offset:2048
  v_mfma_f32_16x16x32_bf16 a[76:79], v[72:75], v[140:143], a[76:79]
  v_mfma_f32_16x16x32_bf16 a[80:83], v[72:75], v[144:147], a[80:83]
  ds_read_b64_tr_b16 v[44:45], v14 offset:256
  v_mfma_f32_16x16x32_bf16 a[84:87], v[72:75], v[148:151], a[84:87]
  buffer_load_dwordx4 v7, s[32:35], s26 offen offset:3072 lds
  v_mfma_f32_16x16x32_bf16 a[88:91], v[72:75], v[152:155], a[88:91]
  ds_read_b64_tr_b16 v[46:47], v14 offset:1280
  v_mfma_f32_16x16x32_bf16 a[92:95], v[72:75], v[156:159], a[92:95]
  v_mfma_f32_16x16x32_bf16 a[96:99], v[76:79], v[128:131], a[96:99]
  ds_read_b128 v[108:111], v12 offset:3072
  v_mfma_f32_16x16x32_bf16 a[100:103], v[76:79], v[132:135], a[100:103]
  v_mfma_f32_16x16x32_bf16 a[104:107], v[76:79], v[136:139], a[104:107]
  s_add_u32 m0, s24, 16384
  ds_read_b64_tr_b16 v[48:49], v13 offset:512
  v_mfma_f32_16x16x32_bf16 a[108:111], v[76:79], v[140:143], a[108:111]
  buffer_load_dwordx4 v8, s[36:39], s27 offen offset:0 lds
  v_mfma_f32_16x16x32_bf16 a[112:115], v[76:79], v[144:147], a[112:115]
  ds_read_b64_tr_b16 v[50:51], v13 offset:1536
  v_mfma_f32_16x16x32_bf16 a[116:119], v[76:79], v[148:151], a[116:119]
  v_mfma_f32_16x16x32_bf16 a[120:123], v[76:79], v[152:155], a[120:123]
  ds_read_b128 v[112:115], v12 offset:4096
  v_mfma_f32_16x16x32_bf16 a[124:127], v[76:79], v[156:159], a[124:127]
  v_mfma_f32_16x16x32_bf16 a[128:131], v[80:83], v[128:131], a[128:131]
  ds_read_b64_tr_b16 v[52:53], v14 offset:512
  v_mfma_f32_16x16x32_bf16 a[132:135], v[80:83], v[132:135], a[132:135]
  buffer_load_dwordx4 v9, s[36:39], s27 offen offset:1024 lds
  v_mfma_f32_16x16x32_bf16 a[136:139], v[80:83], v[136:139], a[136:139]
  ds_read_b64_tr_b16 v[54:55], v14 offset:1536
  v_mfma_f32_16x16x32_bf16 a[140:143], v[80:83], v[140:143], a[140:143]
  v_mfma_f32_16x16x32_bf16 a[144:147], v[80:83], v[144:147], a[144:147]
  ds_read_b128 v[116:119], v12 offset:5120
  v_mfma_f32_16x16x32_bf16 a[148:151], v[80:83], v[148:151], a[148:151]
  v_mfma_f32_16x16x32_bf16 a[152:155], v[80:83], v[152:155], a[152:155]
  ds_read_b64_tr_b16 v[56:57], v13 offset:768
  v_mfma_f32_16x16x32_bf16 a[156:159], v[80:83], v[156:159], a[156:159]
  buffer_load_dwordx4 v10, s[36:39], s27 offen offset:2048 lds
  v_mfma_f32_16x16x32_bf16 a[160:163], v[84:87], v[128:131], a[160:163]
  ds_read_b64_tr_b16 v[58:59], v13 offset:1792
  v_mfma_f32_16x16x32_bf16 a[164:167], v[84:87], v[132:135], a[164:167]
  v_mfma_f32_16x16x32_bf16 a[168:171], v[84:87], v[136:139], a[168:171]
  ds_read_b128 v[120:123], v12 offset:6144
  v_mfma_f32_16x16x32_bf16 a[172:175], v[84:87], v[140:143], a[172:175]
  v_mfma_f32_16x16x32_bf16 a[176:179], v[84:87], v[144:147], a[176:179]
  ds_read_b64_tr_b16 v[60:61], v14 offset:768
  v_mfma_f32_16x16x32_bf16 a[180:183], v[84:87], v[148:151], a[180:183]
  buffer_load_dwordx4 v11, s[36:39], s27 offen offset:3072 lds
  v_mfma_f32_16x16x32_bf16 a[184:187], v[84:87], v[152:155], a[184:187]
  ds_read_b64_tr_b16 v[62:63], v14 offset:1792
  v_mfma_f32_16x16x32_bf16 a[188:191], v[84:87], v[156:159], a[188:191]
  v_mfma_f32_16x16x32_bf16 a[192:195], v[88:91], v[128:131], a[192:195]
  s_add_u32 s26, s26, 64
  ds_read_b128 v[124:127], v12 offset:7168
  v_mfma_f32_16x16x32_bf16 a[196:199], v[88:91], v[132:135], a[196:199]
  s_add_u32 s27, s27, 262144
  v_mfma_f32_16x16x32_bf16 a[200:203], v[88:91], v[136:139], a[200:203]
  s_add_u32 s24, s24, 32768
  v_mfma_f32_16x16x32_bf16 a[204:207], v[88:91], v[140:143], a[204:207]
  s_and_b32 s24, s24, 0x1ffff
  v_mfma_f32_16x16x32_bf16 a[208:211], v[88:91], v[144:147], a[208:211]
  v_mfma_f32_16x16x32_bf16 a[212:215], v[88:91], v[148:151], a[212:215]
  v_mfma_f32_16x16x32_bf16 a[216:219], v[88:91], v[152:155], a[216:219]
  s_add_u32 s28, s28, 1
  v_mfma_f32_16x16x32_bf16 a[220:223], v[88:91], v[156:159], a[220:223]
  s_cmp_ge_u32 s28, 6
  v_mfma_f32_16x16x32_bf16 a[224:227], v[92:95], v[128:131], a[224:227]
  s_cselect_b32 s34, 0, s34
  v_mfma_f32_16x16x32_bf16 a[228:231], v[92:95], v[132:135], a[228:231]
  s_cselect_b32 s38, 0, s38
  v_mfma_f32_16x16x32_bf16 a[232:235], v[92:95], v[136:139], a[232:235]
  v_mfma_f32_16x16x32_bf16 a[236:239], v[92:95], v[140:143], a[236:239]
  v_mfma_f32_16x16x32_bf16 a[240:243], v[92:95], v[144:147], a[240:243]
  v_mfma_f32_16x16x32_bf16 a[244:247], v[92:95], v[148:151], a[244:247]
  s_cmp_lt_u32 s28, 8
  v_mfma_f32_16x16x32_bf16 a[248:251], v[92:95], v[152:155], a[248:251]
  s_waitcnt lgkmcnt(0)
  v_mfma_f32_16x16x32_bf16 a[252:255], v[92:95], v[156:159], a[252:255]
  s_cbranch_scc1 k1_loopK
  s_mov_b32 s60, 2048
  s_mov_b32 s61, 8192
  s_mov_b32 s62, 16777216
  s_branch k1_epi
k1_roleV:
  ds_read_b128 v[32:35], v12 offset:0
  ds_read_b128 v[36:39], v12 offset:1024
  ds_read_b128 v[40:43], v12 offset:2048
  ds_read_b128 v[44:47], v12 offset:3072
  ds_read_b128 v[48:51], v12 offset:4096
  ds_read_b128 v[52:55], v12 offset:5120
  ds_read_b128 v[56:59], v12 offset:6144
  ds_read_b128 v[60:63], v12 offset:7168
  ds_read_b64_tr_b16 v[96:97], v13 offset:0
  ds_read_b64_tr_b16 v[98:99], v13 offset:1024
  ds_read_b64_tr_b16 v[100:101], v14 offset:0
  ds_read_b64_tr_b16 v[102:103], v14 offset:1024
  ds_read_b64_tr_b16 v[104:105], v13 offset:256
  ds_read_b64_tr_b16 v[106:107], v13 offset:1280
  ds_read_b64_tr_b16 v[108:109], v14 offset:256
  ds_read_b64_tr_b16 v[110:111], v14 offset:1280
  ds_read_b64_tr_b16 v[112:113], v13 offset:512
  ds_read_b64_tr_b16 v[114:115], v13 offset:1536
  ds_read_b64_tr_b16 v[116:117], v14 offset:512
  ds_read_b64_tr_b16 v[118:119], v14 offset:1536
  ds_read_b64_tr_b16 v[120:121], v13 offset:768
  ds_read_b64_tr_b16 v[122:123], v13 offset:1792
  ds_read_b64_tr_b16 v[124:125], v14 offset:768
  ds_read_b64_tr_b16 v[126:127], v14 offset:1792
  s_waitcnt lgkmcnt(0)
.p2align 6
k1_loopV:
  v_mfma_f32_16x16x32_bf16 a[0:3], v[32:35], v[96:99], a[0:3]
  s_waitcnt vmcnt(16)
  v_mfma_f32_16x16x32_bf16 a[4:7], v[32:35], v[100:103], a[4:7]
  s_barrier
  v_mfma_f32_16x16x32_bf16 a[8:11], v[32:35], v[104:107], a[8:11]
  s_mov_b32 m0, s24
  ds_read_b64_tr_b16 v[128:129], v13 offset:32768
  v_mfma_f32_16x16x32_bf16 a[12:15], v[32:35], v[108:111], a[12:15]
  buffer_load_dwordx4 v4, s[32:35], s26 offen offset:0 lds
  v_mfma_f32_16x16x32_bf16 a[16:19], v[32:35], v[112:115], a[16:19]
  ds_read_b64_tr_b16 v[130:131], v13 offset:33792
  v_mfma_f32_16x16x32_bf16 a[20:23], v[32:35], v[116:119], a[20:23]
  v_mfma_f32_16x16x32_bf16 a[24:27], v[32:35], v[120:123], a[24:27]
  ds_read_b128 v[64:67], v12 offset:32768
  v_mfma_f32_16x16x32_bf16 a[28:31], v[32:35], v[124:127], a[28:31]
  v_mfma_f32_16x16x32_bf16 a[32:35], v[36:39], v[96:99], a[32:35]
  ds_read_b64_tr_b16 v[132:133], v14 offset:32768
  v_mfma_f32_16x16x32_bf16 a[36:39], v[36:39], v[100:103], a[36:39]
  buffer_load_dwordx4 v5, s[32:35], s26 offen offset:1024 lds
  v_mfma_f32_16x16x32_bf16 a[40:43], v[36:39], v[104:107], a[40:43]
  ds_read_b64_tr_b16 v[134:135], v14 offset:33792
  v_mfma_f32_16x16x32_bf16 a[44:47], v[36:39], v[108:111], a[44:47]
  v_mfma_f32_16x16x32_bf16 a[48:51], v[36:39], v[112:115], a[48:51]
  ds_read_b128 v[68:71], v12 offset:33792
  v_mfma_f32_16x16x32_bf16 a[52:55], v[36:39], v[116:119], a[52:55]
  v_mfma_f32_16x16x32_bf16 a[56:59], v[36:39], v[120:123], a[56:59]
  ds_read_b64_tr_b16 v[136:137], v13 offset:33024
  v_mfma_f32_16x16x32_bf16 a[60:63], v[36:39], v[124:127], a[60:63]
  buffer_load_dwordx4 v6, s[32:35], s26 offen offset:2048 lds
  v_mfma_f32_16x16x32_bf16 a[64:67], v[40:43], v[96:99], a[64:67]
  ds_read_b64_tr_b16 v[138:139], v13 offset:34048
  v_mfma_f32_16x16x32_bf16 a[68:71], v[40:43], v[100:103], a[68:71]
  v_mfma_f32_16x16x32_bf16 a[72:75], v[40:43], v[104:107], a[72:75]
  ds_read_b128 v[72:75], v12 offset:34816
  v_mfma_f32_16x16x32_bf16 a[76:79], v[40:43], v[108:111], a[76:79]
  v_mfma_f32_16x16x32_bf16 a[80:83], v[40:43], v[112:115], a[80:83]
  ds_read_b64_tr_b16 v[140:141], v14 offset:33024
  v_mfma_f32_16x16x32_bf16 a[84:87], v[40:43], v[116:119], a[84:87]
  buffer_load_dwordx4 v7, s[32:35], s26 offen offset:3072 lds
  v_mfma_f32_16x16x32_bf16 a[88:91], v[40:43], v[120:123], a[88:91]
  ds_read_b64_tr_b16 v[142:143], v14 offset:34048
  v_mfma_f32_16x16x32_bf16 a[92:95], v[40:43], v[124:127], a[92:95]
  v_mfma_f32_16x16x32_bf16 a[96:99], v[44:47], v[96:99], a[96:99]
  ds_read_b128 v[76:79], v12 offset:35840
  v_mfma_f32_16x16x32_bf16 a[100:103], v[44:47], v[100:103], a[100:103]
  v_mfma_f32_16x16x32_bf16 a[104:107], v[44:47], v[104:107], a[104:107]
  s_add_u32 m0, s24, 16384
  ds_read_b64_tr_b16 v[144:145], v13 offset:33280
  v_mfma_f32_16x16x32_bf16 a[108:111], v[44:47], v[108:111], a[108:111]
  buffer_load_dwordx4 v8, s[36:39], s27 offen offset:0 lds
  v_mfma_f32_16x16x32_bf16 a[112:115], v[44:47], v[112:115], a[112:115]
  ds_read_b64_tr_b16 v[146:147], v13 offset:34304
  v_mfma_f32_16x16x32_bf16 a[116:119], v[44:47], v[116:119], a[116:119]
  v_mfma_f32_16x16x32_bf16 a[120:123], v[44:47], v[120:123], a[120:123]
  ds_read_b128 v[80:83], v12 offset:36864
  v_mfma_f32_16x16x32_bf16 a[124:127], v[44:47], v[124:127], a[124:127]
  v_mfma_f32_16x16x32_bf16 a[128:131], v[48:51], v[96:99], a[128:131]
  ds_read_b64_tr_b16 v[148:149], v14 offset:33280
  v_mfma_f32_16x16x32_bf16 a[132:135], v[48:51], v[100:103], a[132:135]
  buffer_load_dwordx4 v9, s[36:39], s27 offen offset:1024 lds
  v_mfma_f32_16x16x32_bf16 a[136:139], v[48:51], v[104:107], a[136:139]
  ds_read_b64_tr_b16 v[150:151], v14 offset:34304
  v_mfma_f32_16x16x32_bf16 a[140:143], v[48:51], v[108:111], a[140:143]
  v_mfma_f32_16x16x32_bf16 a[144:147], v[48:51], v[112:115], a[144:147]
  ds_read_b128 v[84:87], v12 offset:37888
  v_mfma_f32_16x16x32_bf16 a[148:151], v[48:51], v[116:119], a[148:151]
  v_mfma_f32_16x16x32_bf16 a[152:155], v[48:51], v[120:123], a[152:155]
  ds_read_b64_tr_b16 v[152:153], v13 offset:33536
  v_mfma_f32_16x16x32_bf16 a[156:159], v[48:51], v[124:127], a[156:159]
  buffer_load_dwordx4 v10, s[36:39], s27 offen offset:2048 lds
  v_mfma_f32_16x16x32_bf16 a[160:163], v[52:55], v[96:99], a[160:163]
  ds_read_b64_tr_b16 v[154:155], v13 offset:34560
  v_mfma_f32_16x16x32_bf16 a[164:167], v[52:55], v[100:103], a[164:167]
  v_mfma_f32_16x16x32_bf16 a[168:171], v[52:55], v[104:107], a[168:171]
  ds_read_b128 v[88:91], v12 offset:38912
  v_mfma_f32_16x16x32_bf16 a[172:175], v[52:55], v[108:111], a[172:175]
  v_mfma_f32_16x16x32_bf16 a[176:179], v[52:55], v[112:115], a[176:179]
  ds_read_b64_tr_b16 v[156:157], v14 offset:33536
  v_mfma_f32_16x16x32_bf16 a[180:183], v[52:55], v[116:119], a[180:183]
  buffer_load_dwordx4 v11, s[36:39], s27 offen offset:3072 lds
  v_mfma_f32_16x16x32_bf16 a[184:187], v[52:55], v[120:123], a[184:187]
  ds_read_b64_tr_b16 v[158:159], v14 offset:34560
  v_mfma_f32_16x16x32_bf16 a[188:191], v[52:55], v[124:127], a[188:191]
  v_mfma_f32_16x16x32_bf16 a[192:195], v[56:59], v[96:99], a[192:195]
  s_add_u32 s26, s26, 64
  ds_read_b128 v[92:95], v12 offset:39936
  v_mfma_f32_16x16x32_bf16 a[196:199], v[56:59], v[100:103], a[196:199]
  s_add_u32 s27, s27, 262144
  v_mfma_f32_16x16x32_bf16 a[200:203], v[56:59], v[104:107], a[200:203]
  s_add_u32 s24, s24, 32768
  v_mfma_f32_16x16x32_bf16 a[204:207], v[56:59], v[108:111], a[204:207]
  s_and_b32 s24, s24, 0x1ffff
  v_mfma_f32_16x16x32_bf16 a[208:211], v[56:59], v[112:115], a[208:211]
  v_xor_b32 v12, 0x10000, v12
  v_mfma_f32_16x16x32_bf16 a[212:215], v[56:59], v[116:119], a[212:215]
  v_xor_b32 v13, 0x10000, v13
  v_mfma_f32_16x16x32_bf16 a[216:219], v[56:59], v[120:123], a[216:219]
  v_xor_b32 v14, 0x10000, v14
  v_mfma_f32_16x16x32_bf16 a[220:223], v[56:59], v[124:127], a[220:223]
  v_mfma_f32_16x16x32_bf16 a[224:227], v[60:63], v[96:99], a[224:227]
  v_mfma_f32_16x16x32_bf16 a[228:231], v[60:63], v[100:103], a[228:231]
  v_mfma_f32_16x16x32_bf16 a[232:235], v[60:63], v[104:107], a[232:235]
  v_mfma_f32_16x16x32_bf16 a[236:239], v[60:63], v[108:111], a[236:239]
  v_mfma_f32_16x16x32_bf16 a[240:243], v[60:63], v[112:115], a[240:243]
  v_mfma_f32_16x16x32_bf16 a[244:247], v[60:63], v[116:119], a[244:247]
  v_mfma_f32_16x16x32_bf16 a[248:251], v[60:63], v[120:123], a[248:251]
  v_mfma_f32_16x16x32_bf16 a[252:255], v[60:63], v[124:127], a[252:255]
  s_waitcnt lgkmcnt(0)
  v_mfma_f32_16x16x32_bf16 a[0:3], v[64:67], v[128:131], a[0:3]
  s_waitcnt vmcnt(16)
  v_mfma_f32_16x16x32_bf16 a[4:7], v[64:67], v[132:135], a[4:7]
  s_barrier
  v_mfma_f32_16x16x32_bf16 a[8:11], v[64:67], v[136:139], a[8:11]
  s_mov_b32 m0, s24
  ds_read_b64_tr_b16 v[96:97], v13 offset:0
  v_mfma_f32_16x16x32_bf16 a[12:15], v[64:67], v[140:143], a[12:15]
  buffer_load_dwordx4 v4, s[32:35], s26 offen offset:0 lds
  v_mfma_f32_16x16x32_bf16 a[16:19], v[64:67], v[144:147], a[16:19]
  ds_read_b64_tr_b16 v[98:99], v13 offset:1024
  v_mfma_f32_16x16x32_bf16 a[20:23], v[64:67], v[148:151], a[20:23]
  v_mfma_f32_16x16x32_bf16 a[24:27], v[64:67], v[152:155], a[24:27]
  ds_read_b128 v[32:35], v12 offset:0
  v_mfma_f32_16x16x32_bf16 a[28:31], v[64:67], v[156:159], a[28:31]
  v_mfma_f32_16x16x32_bf16 a[32:35], v[68:71], v[128:131], a[32:35]
  ds_read_b64_tr_b16 v[100:101], v14 offset:0
  v_mfma_f32_16x16x32_bf16 a[36:39], v[68:71], v[132:135], a[36:39]
  buffer_load_dwordx4 v5, s[32:35], s26 offen offset:1024 lds
  v_mfma_f32_16x16x32_bf16 a[40:43], v[68:71], v[136:139], a[40:43]
  ds_read_b64_tr_b16 v[102:103], v14 offset:1024
  v_mfma_f32_16x16x32_bf16 a[44:47], v[68:71], v[140:143], a[44:47]
  v_mfma_f32_16x16x32_bf16 a[48:51], v[68:71], v[144:147], a[48:51]
  ds_read_b128 v[36:39], v12 offset:1024
  v_mfma_f32_16x16x32_bf16 a[52:55], v[68:71], v[148:151], a[52:55]
  v_mfma_f32_16x16x32_bf16 a[56:59], v[68:71], v[152:155], a[56:59]
  ds_read_b64_tr_b16 v[104:105], v13 offset:256
  v_mfma_f32_16x16x32_bf16 a[60:63], v[68:71], v[156:159], a[60:63]
  buffer_load_dwordx4 v6, s[32:35], s26 offen offset:2048 lds
  v_mfma_f32_16x16x32_bf16 a[64:67], v[72:75], v[128:131], a[64:67]
  ds_read_b64_tr_b16 v[106:107], v13 offset:1280
  v_mfma_f32_16x16x32_bf16 a[68:71], v[72:75], v[132:135], a[68:71]
  v_mfma_f32_16x16x32_bf16 a[72:75], v[72:75], v[136:139], a[72:75]
  ds_read_b128 v[40:43], v12 offset:2048
  v_mfma_f32_16x16x32_bf16 a[76:79], v[72:75], v[140:143], a[76:79]
  v_mfma_f32_16x16x32_bf16 a[80:83], v[72:75], v[144:147], a[80:83]
  ds_read_b64_tr_b16 v[108:109], v14 offset:256
  v_mfma_f32_16x16x32_bf16 a[84:87], v[72:75], v[148:151], a[84:87]
  buffer_load_dwordx4 v7, s[32:35], s26 offen offset:3072 lds
  v_mfma_f32_16x16x32_bf16 a[88:91], v[72:75], v[152:155], a[88:91]
  ds_read_b64_tr_b16 v[110:111], v14 offset:1280
  v_mfma_f32_16x16x32_bf16 a[92:95], v[72:75], v[156:159], a[92:95]
  v_mfma_f32_16x16x32_bf16 a[96:99], v[76:79], v[128:131], a[96:99]
  ds_read_b128 v[44:47], v12 offset:3072
  v_mfma_f32_16x16x32_bf16 a[100:103], v[76:79], v[132:135], a[100:103]
  v_mfma_f32_16x16x32_bf16 a[104:107], v[76:79], v[136:139], a[104:107]
  s_add_u32 m0, s24, 16384
  ds_read_b64_tr_b16 v[112:113], v13 offset:512
  v_mfma_f32_16x16x32_bf16 a[108:111], v[76:79], v[140:143], a[108:111]
  buffer_load_dwordx4 v8, s[36:39], s27 offen offset:0 lds
  v_mfma_f32_16x16x32_bf16 a[112:115], v[76:79], v[144:147], a[112:115]
  ds_read_b64_tr_b16 v[114:115], v13 offset:1536
  v_mfma_f32_16x16x32_bf16 a[116:119], v[76:79], v[148:151], a[116:119]
  v_mfma_f32_16x16x32_bf16 a[120:123], v[76:79], v[152:155], a[120:123]
  ds_read_b128 v[48:51], v12 offset:4096
  v_mfma_f32_16x16x32_bf16 a[124:127], v[76:79], v[156:159], a[124:127]
  v_mfma_f32_16x16x32_bf16 a[128:131], v[80:83], v[128:131], a[128:131]
  ds_read_b64_tr_b16 v[116:117], v14 offset:512
  v_mfma_f32_16x16x32_bf16 a[132:135], v[80:83], v[132:135], a[132:135]
  buffer_load_dwordx4 v9, s[36:39], s27 offen offset:1024 lds
  v_mfma_f32_16x16x32_bf16 a[136:139], v[80:83], v[136:139], a[136:139]
  ds_read_b64_tr_b16 v[118:119], v14 offset:1536
  v_mfma_f32_16x16x32_bf16 a[140:143], v[80:83], v[140:143], a[140:143]
  v_mfma_f32_16x16x32_bf16 a[144:147], v[80:83], v[144:147], a[144:147]
  ds_read_b128 v[52:55], v12 offset:5120
  v_mfma_f32_16x16x32_bf16 a[148:151], v[80:83], v[148:151], a[148:151]
  v_mfma_f32_16x16x32_bf16 a[152:155], v[80:83], v[152:155], a[152:155]
  ds_read_b64_tr_b16 v[120:121], v13 offset:768
  v_mfma_f32_16x16x32_bf16 a[156:159], v[80:83], v[156:159], a[156:159]
  buffer_load_dwordx4 v10, s[36:39], s27 offen offset:2048 lds
  v_mfma_f32_16x16x32_bf16 a[160:163], v[84:87], v[128:131], a[160:163]
  ds_read_b64_tr_b16 v[122:123], v13 offset:1792
  v_mfma_f32_16x16x32_bf16 a[164:167], v[84:87], v[132:135], a[164:167]
  v_mfma_f32_16x16x32_bf16 a[168:171], v[84:87], v[136:139], a[168:171]
  ds_read_b128 v[56:59], v12 offset:6144
  v_mfma_f32_16x16x32_bf16 a[172:175], v[84:87], v[140:143], a[172:175]
  v_mfma_f32_16x16x32_bf16 a[176:179], v[84:87], v[144:147], a[176:179]
  ds_read_b64_tr_b16 v[124:125], v14 offset:768
  v_mfma_f32_16x16x32_bf16 a[180:183], v[84:87], v[148:151], a[180:183]
  buffer_load_dwordx4 v11, s[36:39], s27 offen offset:3072 lds
  v_mfma_f32_16x16x32_bf16 a[184:187], v[84:87], v[152:155], a[184:187]
  ds_read_b64_tr_b16 v[126:127], v14 offset:1792
  v_mfma_f32_16x16x32_bf16 a[188:191], v[84:87], v[156:159], a[188:191]
  v_mfma_f32_16x16x32_bf16 a[192:195], v[88:91], v[128:131], a[192:195]
  s_add_u32 s26, s26, 64
  ds_read_b128 v[60:63], v12 offset:7168
  v_mfma_f32_16x16x32_bf16 a[196:199], v[88:91], v[132:135], a[196:199]
  s_add_u32 s27, s27, 262144
  v_mfma_f32_16x16x32_bf16 a[200:203], v[88:91], v[136:139], a[200:203]
  s_add_u32 s24, s24, 32768
  v_mfma_f32_16x16x32_bf16 a[204:207], v[88:91], v[140:143], a[204:207]
  s_and_b32 s24, s24, 0x1ffff
  v_mfma_f32_16x16x32_bf16 a[208:211], v[88:91], v[144:147], a[208:211]
  v_mfma_f32_16x16x32_bf16 a[212:215], v[88:91], v[148:151], a[212:215]
  v_mfma_f32_16x16x32_bf16 a[216:219], v[88:91], v[152:155], a[216:219]
  s_add_u32 s28, s28, 1
  v_mfma_f32_16x16x32_bf16 a[220:223], v[88:91], v[156:159], a[220:223]
  s_cmp_ge_u32 s28, 6
  v_mfma_f32_16x16x32_bf16 a[224:227], v[92:95], v[128:131], a[224:227]
  s_cselect_b32 s34, 0, s34
  v_mfma_f32_16x16x32_bf16 a[228:231], v[92:95], v[132:135], a[228:231]
  s_cselect_b32 s38, 0, s38
  v_mfma_f32_16x16x32_bf16 a[232:235], v[92:95], v[136:139], a[232:235]
  v_mfma_f32_16x16x32_bf16 a[236:239], v[92:95], v[140:143], a[236:239]
  v_mfma_f32_16x16x32_bf16 a[240:243], v[92:95], v[144:147], a[240:243]
  v_mfma_f32_16x16x32_bf16 a[244:247], v[92:95], v[148:151], a[244:247]
  s_cmp_lt_u32 s28, 8
  v_mfma_f32_16x16x32_bf16 a[248:251], v[92:95], v[152:155], a[248:251]
  s_waitcnt lgkmcnt(0)
  v_mfma_f32_16x16x32_bf16 a[252:255], v[92:95], v[156:159], a[252:255]
  s_cbranch_scc1 k1_loopV
  s_mov_b32 s60, 8192
  s_mov_b32 s61, 2048
  s_mov_b32 s62, 33554432
k1_epi:
  s_lshl_b32 s23, s21, 19
  s_add_u32 s62, s62, s23
  s_lshl_b32 s23, s22, 16
  s_add_u32 s62, s62, s23
  s_and_b32 s23, s20, 1
  s_lshl_b32 s23, s23, 15
  s_add_u32 s62, s62, s23
  s_nop 4
  s_mov_b32 s63, s62
  s_add_u32 s62, s62, s60
  v_accvgpr_read_b32 v36, a0
  v_accvgpr_read_b32 v37, a1
  v_accvgpr_read_b32 v38, a2
  v_accvgpr_read_b32 v39, a3
  v_accvgpr_read_b32 v40, a32
  v_accvgpr_read_b32 v41, a33
  v_accvgpr_read_b32 v42, a34
  v_accvgpr_read_b32 v43, a35
  v_cvt_pk_bf16_f32 v32, v36, v37
  v_cvt_pk_bf16_f32 v33, v38, v39
  v_cvt_pk_bf16_f32 v34, v40, v41
  v_cvt_pk_bf16_f32 v35, v42, v43
  buffer_store_dwordx4 v[32:35], v15, s[40:43], s63 offen offset:0
  v_accvgpr_read_b32 v48, a4
  v_accvgpr_read_b32 v49, a5
  v_accvgpr_read_b32 v50, a6
  v_accvgpr_read_b32 v51, a7
  v_accvgpr_read_b32 v52, a36
  v_accvgpr_read_b32 v53, a37
  v_accvgpr_read_b32 v54, a38
  v_accvgpr_read_b32 v55, a39
  v_cvt_pk_bf16_f32 v44, v48, v49
  v_cvt_pk_bf16_f32 v45, v50, v51
  v_cvt_pk_bf16_f32 v46, v52, v53
  v_cvt_pk_bf16_f32 v47, v54, v55
  buffer_store_dwordx4 v[44:47], v15, s[40:43], s63 offen offset:1024
  s_add_u32 s63, s63, s61
  v_accvgpr_read_b32 v60, a8
  v_accvgpr_read_b32 v61, a9
  v_accvgpr_read_b32 v62, a10
  v_accvgpr_read_b32 v63, a11
  v_accvgpr_read_b32 v64, a40
  v_accvgpr_read_b32 v65, a41
  v_accvgpr_read_b32 v66, a42
  v_accvgpr_read_b32 v67, a43
  v_cvt_pk_bf16_f32 v56, v60, v61
  v_cvt_pk_bf16_f32 v57, v62, v63
  v_cvt_pk_bf16_f32 v58, v64, v65
  v_cvt_pk_bf16_f32 v59, v66, v67
  buffer_store_dwordx4 v[56:59], v15, s[40:43], s63 offen offset:0
  v_accvgpr_read_b32 v72, a12
  v_accvgpr_read_b32 v73, a13
  v_accvgpr_read_b32 v74, a14
  v_accvgpr_read_b32 v75, a15
  v_accvgpr_read_b32 v76, a44
  v_accvgpr_read_b32 v77, a45
  v_accvgpr_read_b32 v78, a46
  v_accvgpr_read_b32 v79, a47
  v_cvt_pk_bf16_f32 v68, v72, v73
  v_cvt_pk_bf16_f32 v69, v74, v75
  v_cvt_pk_bf16_f32 v70, v76, v77
  v_cvt_pk_bf16_f32 v71, v78, v79
  buffer_store_dwordx4 v[68:71], v15, s[40:43], s63 offen offset:1024
  s_add_u32 s63, s63, s61
  v_accvgpr_read_b32 v84, a16
  v_accvgpr_read_b32 v85, a17
  v_accvgpr_read_b32 v86, a18
  v_accvgpr_read_b32 v87, a19
  v_accvgpr_read_b32 v88, a48
  v_accvgpr_read_b32 v89, a49
  v_accvgpr_read_b32 v90, a50
  v_accvgpr_read_b32 v91, a51
  v_cvt_pk_bf16_f32 v80, v84, v85
  v_cvt_pk_bf16_f32 v81, v86, v87
  v_cvt_pk_bf16_f32 v82, v88, v89
  v_cvt_pk_bf16_f32 v83, v90, v91
  buffer_store_dwordx4 v[80:83], v15, s[40:43], s63 offen offset:0
  v_accvgpr_read_b32 v96, a20
  v_accvgpr_read_b32 v97, a21
  v_accvgpr_read_b32 v98, a22
  v_accvgpr_read_b32 v99, a23
  v_accvgpr_read_b32 v100, a52
  v_accvgpr_read_b32 v101, a53
  v_accvgpr_read_b32 v102, a54
  v_accvgpr_read_b32 v103, a55
  v_cvt_pk_bf16_f32 v92, v96, v97
  v_cvt_pk_bf16_f32 v93, v98, v99
  v_cvt_pk_bf16_f32 v94, v100, v101
  v_cvt_pk_bf16_f32 v95, v102, v103
  buffer_store_dwordx4 v[92:95], v15, s[40:43], s63 offen offset:1024
  s_add_u32 s63, s63, s61
  v_accvgpr_read_b32 v108, a24
  v_accvgpr_read_b32 v109, a25
  v_accvgpr_read_b32 v110, a26
  v_accvgpr_read_b32 v111, a27
  v_accvgpr_read_b32 v112, a56
  v_accvgpr_read_b32 v113, a57
  v_accvgpr_read_b32 v114, a58
  v_accvgpr_read_b32 v115, a59
  v_cvt_pk_bf16_f32 v104, v108, v109
  v_cvt_pk_bf16_f32 v105, v110, v111
  v_cvt_pk_bf16_f32 v106, v112, v113
  v_cvt_pk_bf16_f32 v107, v114, v115
  buffer_store_dwordx4 v[104:107], v15, s[40:43], s63 offen offset:0
  v_accvgpr_read_b32 v120, a28
  v_accvgpr_read_b32 v121, a29
  v_accvgpr_read_b32 v122, a30
  v_accvgpr_read_b32 v123, a31
  v_accvgpr_read_b32 v124, a60
  v_accvgpr_read_b32 v125, a61
  v_accvgpr_read_b32 v126, a62
  v_accvgpr_read_b32 v127, a63
  v_cvt_pk_bf16_f32 v116, v120, v121
  v_cvt_pk_bf16_f32 v117, v122, v123
  v_cvt_pk_bf16_f32 v118, v124, v125
  v_cvt_pk_bf16_f32 v119, v126, v127
  buffer_store_dwordx4 v[116:119], v15, s[40:43], s63 offen offset:1024
  s_mov_b32 s63, s62
  s_add_u32 s62, s62, s60
  v_accvgpr_read_b32 v36, a64
  v_accvgpr_read_b32 v37, a65
  v_accvgpr_read_b32 v38, a66
  v_accvgpr_read_b32 v39, a67
  v_accvgpr_read_b32 v40, a96
  v_accvgpr_read_b32 v41, a97
  v_accvgpr_read_b32 v42, a98
  v_accvgpr_read_b32 v43, a99
  v_cvt_pk_bf16_f32 v32, v36, v37
  v_cvt_pk_bf16_f32 v33, v38, v39
  v_cvt_pk_bf16_f32 v34, v40, v41
  v_cvt_pk_bf16_f32 v35, v42, v43
  buffer_store_dwordx4 v[32:35], v15, s[40:43], s63 offen offset:0
  v_accvgpr_read_b32 v48, a68
  v_accvgpr_read_b32 v49, a69
  v_accvgpr_read_b32 v50, a70
  v_accvgpr_read_b32 v51, a71
  v_accvgpr_read_b32 v52, a100
  v_accvgpr_read_b32 v53, a101
  v_accvgpr_read_b32 v54, a102
  v_accvgpr_read_b32 v55, a103
  v_cvt_pk_bf16_f32 v44, v48, v49
  v_cvt_pk_bf16_f32 v45, v50, v51
  v_cvt_pk_bf16_f32 v46, v52, v53
  v_cvt_pk_bf16_f32 v47, v54, v55
  buffer_store_dwordx4 v[44:47], v15, s[40:43], s63 offen offset:1024
  s_add_u32 s63, s63, s61
  v_accvgpr_read_b32 v60, a72
  v_accvgpr_read_b32 v61, a73
  v_accvgpr_read_b32 v62, a74
  v_accvgpr_read_b32 v63, a75
  v_accvgpr_read_b32 v64, a104
  v_accvgpr_read_b32 v65, a105
  v_accvgpr_read_b32 v66, a106
  v_accvgpr_read_b32 v67, a107
  v_cvt_pk_bf16_f32 v56, v60, v61
  v_cvt_pk_bf16_f32 v57, v62, v63
  v_cvt_pk_bf16_f32 v58, v64, v65
  v_cvt_pk_bf16_f32 v59, v66, v67
  buffer_store_dwordx4 v[56:59], v15, s[40:43], s63 offen offset:0
  v_accvgpr_read_b32 v72, a76
  v_accvgpr_read_b32 v73, a77
  v_accvgpr_read_b32 v74, a78
  v_accvgpr_read_b32 v75, a79
  v_accvgpr_read_b32 v76, a108
  v_accvgpr_read_b32 v77, a109
  v_accvgpr_read_b32 v78, a110
  v_accvgpr_read_b32 v79, a111
  v_cvt_pk_bf16_f32 v68, v72, v73
  v_cvt_pk_bf16_f32 v69, v74, v75
  v_cvt_pk_bf16_f32 v70, v76, v77
  v_cvt_pk_bf16_f32 v71, v78, v79
  buffer_store_dwordx4 v[68:71], v15, s[40:43], s63 offen offset:1024
  s_add_u32 s63, s63, s61
  v_accvgpr_read_b32 v84, a80
  v_accvgpr_read_b32 v85, a81
  v_accvgpr_read_b32 v86, a82
  v_accvgpr_read_b32 v87, a83
  v_accvgpr_read_b32 v88, a112
  v_accvgpr_read_b32 v89, a113
  v_accvgpr_read_b32 v90, a114
  v_accvgpr_read_b32 v91, a115
  v_cvt_pk_bf16_f32 v80, v84, v85
  v_cvt_pk_bf16_f32 v81, v86, v87
  v_cvt_pk_bf16_f32 v82, v88, v89
  v_cvt_pk_bf16_f32 v83, v90, v91
  buffer_store_dwordx4 v[80:83], v15, s[40:43], s63 offen offset:0
  v_accvgpr_read_b32 v96, a84
  v_accvgpr_read_b32 v97, a85
  v_accvgpr_read_b32 v98, a86
  v_accvgpr_read_b32 v99, a87
  v_accvgpr_read_b32 v100, a116
  v_accvgpr_read_b32 v101, a117
  v_accvgpr_read_b32 v102, a118
  v_accvgpr_read_b32 v103, a119
  v_cvt_pk_bf16_f32 v92, v96, v97
  v_cvt_pk_bf16_f32 v93, v98, v99
  v_cvt_pk_bf16_f32 v94, v100, v101
  v_cvt_pk_bf16_f32 v95, v102, v103
  buffer_store_dwordx4 v[92:95], v15, s[40:43], s63 offen offset:1024
  s_add_u32 s63, s63, s61
  v_accvgpr_read_b32 v108, a88
  v_accvgpr_read_b32 v109, a89
  v_accvgpr_read_b32 v110, a90
  v_accvgpr_read_b32 v111, a91
  v_accvgpr_read_b32 v112, a120
  v_accvgpr_read_b32 v113, a121
  v_accvgpr_read_b32 v114, a122
  v_accvgpr_read_b32 v115, a123
  v_cvt_pk_bf16_f32 v104, v108, v109
  v_cvt_pk_bf16_f32 v105, v110, v111
  v_cvt_pk_bf16_f32 v106, v112, v113
  v_cvt_pk_bf16_f32 v107, v114, v115
  buffer_store_dwordx4 v[104:107], v15, s[40:43], s63 offen offset:0
  v_accvgpr_read_b32 v120, a92
  v_accvgpr_read_b32 v121, a93
  v_accvgpr_read_b32 v122, a94
  v_accvgpr_read_b32 v123, a95
  v_accvgpr_read_b32 v124, a124
  v_accvgpr_read_b32 v125, a125
  v_accvgpr_read_b32 v126, a126
  v_accvgpr_read_b32 v127, a127
  v_cvt_pk_bf16_f32 v116, v120, v121
  v_cvt_pk_bf16_f32 v117, v122, v123
  v_cvt_pk_bf16_f32 v118, v124, v125
  v_cvt_pk_bf16_f32 v119, v126, v127
  buffer_store_dwordx4 v[116:119], v15, s[40:43], s63 offen offset:1024
  s_mov_b32 s63, s62
  s_add_u32 s62, s62, s60
  v_accvgpr_read_b32 v36, a128
  v_accvgpr_read_b32 v37, a129
  v_accvgpr_read_b32 v38, a130
  v_accvgpr_read_b32 v39, a131
  v_accvgpr_read_b32 v40, a160
  v_accvgpr_read_b32 v41, a161
  v_accvgpr_read_b32 v42, a162
  v_accvgpr_read_b32 v43, a163
  v_cvt_pk_bf16_f32 v32, v36, v37
  v_cvt_pk_bf16_f32 v33, v38, v39
  v_cvt_pk_bf16_f32 v34, v40, v41
  v_cvt_pk_bf16_f32 v35, v42, v43
  buffer_store_dwordx4 v[32:35], v15, s[40:43], s63 offen offset:0
  v_accvgpr_read_b32 v48, a132
  v_accvgpr_read_b32 v49, a133
  v_accvgpr_read_b32 v50, a134
  v_accvgpr_read_b32 v51, a135
  v_accvgpr_read_b32 v52, a164
  v_accvgpr_read_b32 v53, a165
  v_accvgpr_read_b32 v54, a166
  v_accvgpr_read_b32 v55, a167
  v_cvt_pk_bf16_f32 v44, v48, v49
  v_cvt_pk_bf16_f32 v45, v50, v51
  v_cvt_pk_bf16_f32 v46, v52, v53
  v_cvt_pk_bf16_f32 v47, v54, v55
  buffer_store_dwordx4 v[44:47], v15, s[40:43], s63 offen offset:1024
  s_add_u32 s63, s63, s61
  v_accvgpr_read_b32 v60, a136
  v_accvgpr_read_b32 v61, a137
  v_accvgpr_read_b32 v62, a138
  v_accvgpr_read_b32 v63, a139
  v_accvgpr_read_b32 v64, a168
  v_accvgpr_read_b32 v65, a169
  v_accvgpr_read_b32 v66, a170
  v_accvgpr_read_b32 v67, a171
  v_cvt_pk_bf16_f32 v56, v60, v61
  v_cvt_pk_bf16_f32 v57, v62, v63
  v_cvt_pk_bf16_f32 v58, v64, v65
  v_cvt_pk_bf16_f32 v59, v66, v67
  buffer_store_dwordx4 v[56:59], v15, s[40:43], s63 offen offset:0
  v_accvgpr_read_b32 v72, a140
  v_accvgpr_read_b32 v73, a141
  v_accvgpr_read_b32 v74, a142
  v_accvgpr_read_b32 v75, a143
  v_accvgpr_read_b32 v76, a172
  v_accvgpr_read_b32 v77, a173
  v_accvgpr_read_b32 v78, a174
  v_accvgpr_read_b32 v79, a175
  v_cvt_pk_bf16_f32 v68, v72, v73
  v_cvt_pk_bf16_f32 v69, v74, v75
  v_cvt_pk_bf16_f32 v70, v76, v77
  v_cvt_pk_bf16_f32 v71, v78, v79
  buffer_store_dwordx4 v[68:71], v15, s[40:43], s63 offen offset:1024
  s_add_u32 s63, s63, s61
  v_accvgpr_read_b32 v84, a144
  v_accvgpr_read_b32 v85, a145
  v_accvgpr_read_b32 v86, a146
  v_accvgpr_read_b32 v87, a147
  v_accvgpr_read_b32 v88, a176
  v_accvgpr_read_b32 v89, a177
  v_accvgpr_read_b32 v90, a178
  v_accvgpr_read_b32 v91, a179
  v_cvt_pk_bf16_f32 v80, v84, v85
  v_cvt_pk_bf16_f32 v81, v86, v87
  v_cvt_pk_bf16_f32 v82, v88, v89
  v_cvt_pk_bf16_f32 v83, v90, v91
  buffer_store_dwordx4 v[80:83], v15, s[40:43], s63 offen offset:0
  v_accvgpr_read_b32 v96, a148
  v_accvgpr_read_b32 v97, a149
  v_accvgpr_read_b32 v98, a150
  v_accvgpr_read_b32 v99, a151
  v_accvgpr_read_b32 v100, a180
  v_accvgpr_read_b32 v101, a181
  v_accvgpr_read_b32 v102, a182
  v_accvgpr_read_b32 v103, a183
  v_cvt_pk_bf16_f32 v92, v96, v97
  v_cvt_pk_bf16_f32 v93, v98, v99
  v_cvt_pk_bf16_f32 v94, v100, v101
  v_cvt_pk_bf16_f32 v95, v102, v103
  buffer_store_dwordx4 v[92:95], v15, s[40:43], s63 offen offset:1024
  s_add_u32 s63, s63, s61
  v_accvgpr_read_b32 v108, a152
  v_accvgpr_read_b32 v109, a153
  v_accvgpr_read_b32 v110, a154
  v_accvgpr_read_b32 v111, a155
  v_accvgpr_read_b32 v112, a184
  v_accvgpr_read_b32 v113, a185
  v_accvgpr_read_b32 v114, a186
  v_accvgpr_read_b32 v115, a187
  v_cvt_pk_bf16_f32 v104, v108, v109
  v_cvt_pk_bf16_f32 v105, v110, v111
  v_cvt_pk_bf16_f32 v106, v112, v113
  v_cvt_pk_bf16_f32 v107, v114, v115
  buffer_store_dwordx4 v[104:107], v15, s[40:43], s63 offen offset:0
  v_accvgpr_read_b32 v120, a156
  v_accvgpr_read_b32 v121, a157
  v_accvgpr_read_b32 v122, a158
  v_accvgpr_read_b32 v123, a159
  v_accvgpr_read_b32 v124, a188
  v_accvgpr_read_b32 v125, a189
  v_accvgpr_read_b32 v126, a190
  v_accvgpr_read_b32 v127, a191
  v_cvt_pk_bf16_f32 v116, v120, v121
  v_cvt_pk_bf16_f32 v117, v122, v123
  v_cvt_pk_bf16_f32 v118, v124, v125
  v_cvt_pk_bf16_f32 v119, v126, v127
  buffer_store_dwordx4 v[116:119], v15, s[40:43], s63 offen offset:1024
  s_mov_b32 s63, s62
  s_add_u32 s62, s62, s60
  v_accvgpr_read_b32 v36, a192
  v_accvgpr_read_b32 v37, a193
  v_accvgpr_read_b32 v38, a194
  v_accvgpr_read_b32 v39, a195
  v_accvgpr_read_b32 v40, a224
  v_accvgpr_read_b32 v41, a225
  v_accvgpr_read_b32 v42, a226
  v_accvgpr_read_b32 v43, a227
  v_cvt_pk_bf16_f32 v32, v36, v37
  v_cvt_pk_bf16_f32 v33, v38, v39
  v_cvt_pk_bf16_f32 v34, v40, v41
  v_cvt_pk_bf16_f32 v35, v42, v43
  buffer_store_dwordx4 v[32:35], v15, s[40:43], s63 offen offset:0
  v_accvgpr_read_b32 v48, a196
  v_accvgpr_read_b32 v49, a197
  v_accvgpr_read_b32 v50, a198
  v_accvgpr_read_b32 v51, a199
  v_accvgpr_read_b32 v52, a228
  v_accvgpr_read_b32 v53, a229
  v_accvgpr_read_b32 v54, a230
  v_accvgpr_read_b32 v55, a231
  v_cvt_pk_bf16_f32 v44, v48, v49
  v_cvt_pk_bf16_f32 v45, v50, v51
  v_cvt_pk_bf16_f32 v46, v52, v53
  v_cvt_pk_bf16_f32 v47, v54, v55
  buffer_store_dwordx4 v[44:47], v15, s[40:43], s63 offen offset:1024
  s_add_u32 s63, s63, s61
  v_accvgpr_read_b32 v60, a200
  v_accvgpr_read_b32 v61, a201
  v_accvgpr_read_b32 v62, a202
  v_accvgpr_read_b32 v63, a203
  v_accvgpr_read_b32 v64, a232
  v_accvgpr_read_b32 v65, a233
  v_accvgpr_read_b32 v66, a234
  v_accvgpr_read_b32 v67, a235
  v_cvt_pk_bf16_f32 v56, v60, v61
  v_cvt_pk_bf16_f32 v57, v62, v63
  v_cvt_pk_bf16_f32 v58, v64, v65
  v_cvt_pk_bf16_f32 v59, v66, v67
  buffer_store_dwordx4 v[56:59], v15, s[40:43], s63 offen offset:0
  v_accvgpr_read_b32 v72, a204
  v_accvgpr_read_b32 v73, a205
  v_accvgpr_read_b32 v74, a206
  v_accvgpr_read_b32 v75, a207
  v_accvgpr_read_b32 v76, a236
  v_accvgpr_read_b32 v77, a237
  v_accvgpr_read_b32 v78, a238
  v_accvgpr_read_b32 v79, a239
  v_cvt_pk_bf16_f32 v68, v72, v73
  v_cvt_pk_bf16_f32 v69, v74, v75
  v_cvt_pk_bf16_f32 v70, v76, v77
  v_cvt_pk_bf16_f32 v71, v78, v79
  buffer_store_dwordx4 v[68:71], v15, s[40:43], s63 offen offset:1024
  s_add_u32 s63, s63, s61
  v_accvgpr_read_b32 v84, a208
  v_accvgpr_read_b32 v85, a209
  v_accvgpr_read_b32 v86, a210
  v_accvgpr_read_b32 v87, a211
  v_accvgpr_read_b32 v88, a240
  v_accvgpr_read_b32 v89, a241
  v_accvgpr_read_b32 v90, a242
  v_accvgpr_read_b32 v91, a243
  v_cvt_pk_bf16_f32 v80, v84, v85
  v_cvt_pk_bf16_f32 v81, v86, v87
  v_cvt_pk_bf16_f32 v82, v88, v89
  v_cvt_pk_bf16_f32 v83, v90, v91
  buffer_store_dwordx4 v[80:83], v15, s[40:43], s63 offen offset:0
  v_accvgpr_read_b32 v96, a212
  v_accvgpr_read_b32 v97, a213
  v_accvgpr_read_b32 v98, a214
  v_accvgpr_read_b32 v99, a215
  v_accvgpr_read_b32 v100, a244
  v_accvgpr_read_b32 v101, a245
  v_accvgpr_read_b32 v102, a246
  v_accvgpr_read_b32 v103, a247
  v_cvt_pk_bf16_f32 v92, v96, v97
  v_cvt_pk_bf16_f32 v93, v98, v99
  v_cvt_pk_bf16_f32 v94, v100, v101
  v_cvt_pk_bf16_f32 v95, v102, v103
  buffer_store_dwordx4 v[92:95], v15, s[40:43], s63 offen offset:1024
  s_add_u32 s63, s63, s61
  v_accvgpr_read_b32 v108, a216
  v_accvgpr_read_b32 v109, a217
  v_accvgpr_read_b32 v110, a218
  v_accvgpr_read_b32 v111, a219
  v_accvgpr_read_b32 v112, a248
  v_accvgpr_read_b32 v113, a249
  v_accvgpr_read_b32 v114, a250
  v_accvgpr_read_b32 v115, a251
  v_cvt_pk_bf16_f32 v104, v108, v109
  v_cvt_pk_bf16_f32 v105, v110, v111
  v_cvt_pk_bf16_f32 v106, v112, v113
  v_cvt_pk_bf16_f32 v107, v114, v115
  buffer_store_dwordx4 v[104:107], v15, s[40:43], s63 offen offset:0
  v_accvgpr_read_b32 v120, a220
  v_accvgpr_read_b32 v121, a221
  v_accvgpr_read_b32 v122, a222
  v_accvgpr_read_b32 v123, a223
  v_accvgpr_read_b32 v124, a252
  v_accvgpr_read_b32 v125, a253
  v_accvgpr_read_b32 v126, a254
  v_accvgpr_read_b32 v127, a255
  v_cvt_pk_bf16_f32 v116, v120, v121
  v_cvt_pk_bf16_f32 v117, v122, v123
  v_cvt_pk_bf16_f32 v118, v124, v125
  v_cvt_pk_bf16_f32 v119, v126, v127
  buffer_store_dwordx4 v[116:119], v15, s[40:43], s63 offen offset:1024
  v_lshrrev_b32 v16, 2, v1
  v_mul_u32_u24 v16, 160, v16
  v_and_b32 v17, 3, v1
  v_lshl_add_u32 v16, v17, 3, v16
  v_add_u32 v16, s31, v16
  ds_read_b64_tr_b16 v[160:161], v16 offset:0
  ds_read_b64_tr_b16 v[162:163], v16 offset:2560
  ds_read_b64_tr_b16 v[164:165], v16 offset:32
  ds_read_b64_tr_b16 v[166:167], v16 offset:2592
  ds_read_b64_tr_b16 v[168:169], v16 offset:64
  ds_read_b64_tr_b16 v[170:171], v16 offset:2624
  ds_read_b64_tr_b16 v[172:173], v16 offset:96
  ds_read_b64_tr_b16 v[174:175], v16 offset:2656
  ds_read_b64_tr_b16 v[176:177], v16 offset:128
  ds_read_b64_tr_b16 v[178:179], v16 offset:2688
  s_lshl_b32 s23, s29, 7
  s_add_u32 s23, s23, s30
  s_mul_i32 s23, s23, 5120
  s_add_u32 s23, s23, 4194304
  s_add_u32 s31, s23, 4096
  s_waitcnt lgkmcnt(0)
  buffer_store_dwordx4 v[160:163], v15, s[40:43], s23 offen offset:0
  buffer_store_dwordx4 v[164:167], v15, s[40:43], s23 offen offset:1024
  buffer_store_dwordx4 v[168:171], v15, s[40:43], s23 offen offset:2048
  buffer_store_dwordx4 v[172:175], v15, s[40:43], s23 offen offset:3072
  buffer_store_dwordx4 v[176:179], v15, s[40:43], s31 offen offset:0
k1_end:
  s_endpgm
.section .rodata,"a"
.p2align 6
.amdhsa_kernel k1_kernel
  .amdhsa_next_free_vgpr 512
  .amdhsa_next_free_sgpr 102
  .amdhsa_accum_offset 256
  .amdhsa_group_segment_fixed_size 0
  .amdhsa_kernarg_size 112
  .amdhsa_user_sgpr_count 2
  .amdhsa_user_sgpr_kernarg_segment_ptr 1
  .amdhsa_system_sgpr_workgroup_id_x 1
  .amdhsa_float_denorm_mode_32 3
.end_amdhsa_kernel
.text
```

```asm
; @launch kernel=k1_kernel grid=(256,1,1) block=(256,1,1) lds=151552
; @launch kernel=k2_kernel grid=(256,1,1) block=(256,1,1) lds=131072
; @launch kernel=k3_kernel grid=(256,1,1) block=(256,1,1) lds=111616
.amdgcn_target "amdgcn-amd-amdhsa--gfx950"
.text
.globl k1_kernel
.p2align 8
.type k1_kernel,@function
k1_kernel:
  s_cmp_ge_u32 s2, 256
  s_cbranch_scc1 k1_end
  s_load_dwordx4 s[4:7], s[0:1], 0
  s_load_dwordx4 s[8:11], s[0:1], 24
  s_load_dwordx2 s[12:13], s[0:1], 40
  s_load_dwordx2 s[14:15], s[0:1], 56
  s_load_dwordx2 s[16:17], s[0:1], 104
  v_lshrrev_b32 v2, 6, v0
  v_and_b32 v1, 63, v0
  v_readfirstlane_b32 s20, v2
  s_and_b32 s21, s2, 7
  s_lshl_b32 s21, s21, 2
  s_lshr_b32 s23, s2, 3
  s_and_b32 s23, s23, 3
  s_add_u32 s21, s21, s23
  s_lshr_b32 s22, s2, 5
  v_lshlrev_b32 v15, 4, v1
  v_lshrrev_b32 v16, 2, v1
  v_lshrrev_b32 v17, 5, v1
  v_mul_u32_u24 v17, 3, v17
  v_and_b32 v18, 3, v1
  v_xor_b32 v17, v17, v18
  v_lshlrev_b32 v17, 4, v17
  v_lshl_add_u32 v4, v16, 10, v17
  s_lshl_b32 s23, s20, 16
  v_add_u32 v4, s23, v4
  v_add_u32 v5, 15360, v4
  v_add_u32 v6, 30720, v4
  v_add_u32 v7, 46080, v4
  v_and_b32 v16, 3, v16
  v_lshrrev_b32 v17, 4, v1
  v_lshlrev_b32 v17, 6, v17
  v_lshl_add_u32 v16, v16, 13, v17
  s_and_b32 s23, s20, 1
  s_lshl_b32 s23, s23, 17
  v_add_u32 v16, s23, v16
  v_lshl_add_u32 v8, v18, 4, v16
  v_xor_b32 v18, 2, v18
  v_lshl_add_u32 v10, v18, 4, v16
  v_add_u32 v9, 31744, v8
  v_add_u32 v11, 95232, v10
  v_add_u32 v10, 63488, v10
  s_waitcnt lgkmcnt(0)
  s_lshl_b32 s23, s22, 18
  s_add_u32 s6, s6, s23
  s_addc_u32 s7, s7, 0
  s_mov_b32 s32, s6
  s_mov_b32 s33, s7
  s_mov_b32 s34, 262144
  s_mov_b32 s35, 0x20000
  s_cmp_ge_u32 s20, 2
  s_cselect_b32 s8, s10, s8
  s_cselect_b32 s9, s11, s9
  s_lshl_b32 s23, s21, 8
  s_add_u32 s8, s8, s23
  s_addc_u32 s9, s9, 0
  s_mov_b32 s36, s8
  s_mov_b32 s37, s9
  s_mov_b32 s38, 0
  s_mov_b32 s39, 0x20000
  s_sub_u32 s38, 4194304, s23
  s_mov_b32 s40, s16
  s_mov_b32 s41, s17
  s_mov_b32 s42, 67108864
  s_mov_b32 s43, 0x20000
  s_mov_b32 s44, s4
  s_mov_b32 s45, s5
  s_mov_b32 s46, 2621440
  s_mov_b32 s47, 0x20000
  s_mov_b32 s48, s14
  s_mov_b32 s49, s15
  s_mov_b32 s50, 1280
  s_mov_b32 s51, 0x20000
  s_mov_b32 s52, s12
  s_mov_b32 s53, s13
  s_mov_b32 s54, 5242880
  s_mov_b32 s55, 0x20000
  s_lshl_b32 s24, s20, 12
  s_mov_b32 s26, 0
  s_mov_b32 s27, 0
  s_mov_b32 m0, s24
  s_nop 0
  buffer_load_dwordx4 v4, s[32:35], s26 offen offset:0 lds
  buffer_load_dwordx4 v5, s[32:35], s26 offen offset:1024 lds
  buffer_load_dwordx4 v6, s[32:35], s26 offen offset:2048 lds
  buffer_load_dwordx4 v7, s[32:35], s26 offen offset:3072 lds
  s_add_u32 m0, s24, 16384
  s_nop 0
  buffer_load_dwordx4 v8, s[36:39], s27 offen offset:0 lds
  buffer_load_dwordx4 v9, s[36:39], s27 offen offset:1024 lds
  buffer_load_dwordx4 v10, s[36:39], s27 offen offset:2048 lds
  buffer_load_dwordx4 v11, s[36:39], s27 offen offset:3072 lds
  s_add_u32 s26, s26, 64
  s_add_u32 s27, s27, 262144
  s_add_u32 s24, s24, 32768
  s_and_b32 s24, s24, 0x1ffff
  v_and_b32 v208, 31, v1
  v_lshrrev_b32 v209, 5, v1
  s_lshl_b32 s23, s2, 2
  s_add_u32 s23, s23, s20
  s_lshl_b32 s23, s23, 1
  v_add_u32 v209, s23, v209
  v_lshlrev_b32 v212, 4, v208
  v_mul_u32_u24 v210, 1280, v209
  v_add_u32 v210, v210, v212
  v_cmp_gt_u32 s[56:57], 16, v208
  v_mov_b32 v211, 0x40000000
  s_nop 0
  v_cndmask_b32 v211, v211, v210, s[56:57]
  buffer_load_dwordx4 v[160:163], v210, s[44:47], 0 offen
  buffer_load_dwordx4 v[164:167], v210, s[44:47], 0 offen offset:512
  buffer_load_dwordx4 v[168:171], v211, s[44:47], 0 offen offset:1024
  buffer_load_dwordx4 v[172:175], v212, s[48:51], 0 offen offset:0
  buffer_load_dwordx4 v[176:179], v212, s[48:51], 0 offen offset:512
  buffer_load_dwordx4 v[180:183], v212, s[48:51], 0 offen offset:1024
  s_mov_b32 m0, s24
  s_nop 0
  buffer_load_dwordx4 v4, s[32:35], s26 offen offset:0 lds
  buffer_load_dwordx4 v5, s[32:35], s26 offen offset:1024 lds
  buffer_load_dwordx4 v6, s[32:35], s26 offen offset:2048 lds
  buffer_load_dwordx4 v7, s[32:35], s26 offen offset:3072 lds
  s_add_u32 m0, s24, 16384
  s_nop 0
  buffer_load_dwordx4 v8, s[36:39], s27 offen offset:0 lds
  buffer_load_dwordx4 v9, s[36:39], s27 offen offset:1024 lds
  buffer_load_dwordx4 v10, s[36:39], s27 offen offset:2048 lds
  buffer_load_dwordx4 v11, s[36:39], s27 offen offset:3072 lds
  s_add_u32 s26, s26, 64
  s_add_u32 s27, s27, 262144
  s_add_u32 s24, s24, 32768
  s_and_b32 s24, s24, 0x1ffff
  s_mov_b32 m0, s24
  s_nop 0
  buffer_load_dwordx4 v4, s[32:35], s26 offen offset:0 lds
  buffer_load_dwordx4 v5, s[32:35], s26 offen offset:1024 lds
  buffer_load_dwordx4 v6, s[32:35], s26 offen offset:2048 lds
  buffer_load_dwordx4 v7, s[32:35], s26 offen offset:3072 lds
  s_add_u32 m0, s24, 16384
  s_nop 0
  buffer_load_dwordx4 v8, s[36:39], s27 offen offset:0 lds
  buffer_load_dwordx4 v9, s[36:39], s27 offen offset:1024 lds
  buffer_load_dwordx4 v10, s[36:39], s27 offen offset:2048 lds
  buffer_load_dwordx4 v11, s[36:39], s27 offen offset:3072 lds
  s_add_u32 s26, s26, 64
  s_add_u32 s27, s27, 262144
  s_add_u32 s24, s24, 32768
  s_and_b32 s24, s24, 0x1ffff
  s_mov_b32 m0, s24
  s_nop 0
  buffer_load_dwordx4 v4, s[32:35], s26 offen offset:0 lds
  buffer_load_dwordx4 v5, s[32:35], s26 offen offset:1024 lds
  buffer_load_dwordx4 v6, s[32:35], s26 offen offset:2048 lds
  buffer_load_dwordx4 v7, s[32:35], s26 offen offset:3072 lds
  s_add_u32 m0, s24, 16384
  s_nop 0
  buffer_load_dwordx4 v8, s[36:39], s27 offen offset:0 lds
  buffer_load_dwordx4 v9, s[36:39], s27 offen offset:1024 lds
  buffer_load_dwordx4 v10, s[36:39], s27 offen offset:2048 lds
  buffer_load_dwordx4 v11, s[36:39], s27 offen offset:3072 lds
  s_add_u32 s26, s26, 64
  s_add_u32 s27, s27, 262144
  s_add_u32 s24, s24, 32768
  s_and_b32 s24, s24, 0x1ffff
  s_and_b32 s29, s2, 1
  s_lshl_b32 s29, s29, 2
  s_add_u32 s29, s29, s20
  s_lshr_b32 s30, s2, 1
  s_mul_i32 s23, s30, 40960
  s_mul_i32 s31, s29, 160
  s_add_u32 s23, s23, s31
  s_mul_i32 s31, s20, 5120
  s_add_u32 s31, s31, 131072
  v_add_u32 v16, 0, v1
  v_mul_u32_u24 v17, 6554, v16
  v_lshrrev_b32 v17, 16, v17
  v_mul_u32_u24 v17, 1120, v17
  v_lshl_add_u32 v17, v16, 4, v17
  s_add_u32 m0, s31, 0
  s_nop 0
  buffer_load_dwordx4 v17, s[52:55], s23 offen lds
  v_add_u32 v16, 64, v1
  v_mul_u32_u24 v17, 6554, v16
  v_lshrrev_b32 v17, 16, v17
  v_mul_u32_u24 v17, 1120, v17
  v_lshl_add_u32 v17, v16, 4, v17
  s_add_u32 m0, s31, 1024
  s_nop 0
  buffer_load_dwordx4 v17, s[52:55], s23 offen lds
  v_add_u32 v16, 128, v1
  v_mul_u32_u24 v17, 6554, v16
  v_lshrrev_b32 v17, 16, v17
  v_mul_u32_u24 v17, 1120, v17
  v_lshl_add_u32 v17, v16, 4, v17
  s_add_u32 m0, s31, 2048
  s_nop 0
  buffer_load_dwordx4 v17, s[52:55], s23 offen lds
  v_add_u32 v16, 192, v1
  v_mul_u32_u24 v17, 6554, v16
  v_lshrrev_b32 v17, 16, v17
  v_mul_u32_u24 v17, 1120, v17
  v_lshl_add_u32 v17, v16, 4, v17
  s_add_u32 m0, s31, 3072
  s_nop 0
  buffer_load_dwordx4 v17, s[52:55], s23 offen lds
  v_add_u32 v16, 256, v1
  v_mul_u32_u24 v17, 6554, v16
  v_lshrrev_b32 v17, 16, v17
  v_mul_u32_u24 v17, 1120, v17
  v_lshl_add_u32 v17, v16, 4, v17
  s_add_u32 m0, s31, 4096
  s_nop 0
  buffer_load_dwordx4 v17, s[52:55], s23 offen lds
  v_mov_b32 v20, 0
  v_mov_b32 v21, 0
  v_mov_b32 v22, 0
  v_mov_b32 v23, 0
  v_and_b32 v16, 15, v1
  v_lshrrev_b32 v17, 4, v1
  v_lshrrev_b32 v18, 3, v16
  v_mul_u32_u24 v18, 3, v18
  v_xor_b32 v18, v18, v17
  v_lshlrev_b32 v18, 4, v18
  v_lshl_add_u32 v12, v16, 6, v18
  s_and_b32 s23, s20, 1
  s_lshl_b32 s23, s23, 13
  v_add_u32 v12, s23, v12
  v_mfma_f32_32x32x16_bf16 a[0:15], v[20:23], v[20:23], 0
  v_mfma_f32_32x32x16_bf16 a[16:31], v[20:23], v[20:23], 0
  v_mfma_f32_32x32x16_bf16 a[32:47], v[20:23], v[20:23], 0
  v_mfma_f32_32x32x16_bf16 a[48:63], v[20:23], v[20:23], 0
  v_mfma_f32_32x32x16_bf16 a[64:79], v[20:23], v[20:23], 0
  v_mfma_f32_32x32x16_bf16 a[80:95], v[20:23], v[20:23], 0
  v_mfma_f32_32x32x16_bf16 a[96:111], v[20:23], v[20:23], 0
  v_mfma_f32_32x32x16_bf16 a[112:127], v[20:23], v[20:23], 0
  v_mfma_f32_32x32x16_bf16 a[128:143], v[20:23], v[20:23], 0
  v_mfma_f32_32x32x16_bf16 a[144:159], v[20:23], v[20:23], 0
  v_mfma_f32_32x32x16_bf16 a[160:175], v[20:23], v[20:23], 0
  v_mfma_f32_32x32x16_bf16 a[176:191], v[20:23], v[20:23], 0
  v_mfma_f32_32x32x16_bf16 a[192:207], v[20:23], v[20:23], 0
  v_mfma_f32_32x32x16_bf16 a[208:223], v[20:23], v[20:23], 0
  v_mfma_f32_32x32x16_bf16 a[224:239], v[20:23], v[20:23], 0
  v_mfma_f32_32x32x16_bf16 a[240:255], v[20:23], v[20:23], 0
  v_lshrrev_b32 v18, 2, v16
  v_lshlrev_b32 v18, 6, v18
  v_lshl_add_u32 v18, v17, 11, v18
  v_and_b32 v19, 1, v1
  v_lshl_add_u32 v18, v19, 3, v18
  v_bfe_u32 v19, v1, 1, 1
  v_and_b32 v17, 1, v17
  v_lshl_or_b32 v19, v17, 1, v19
  s_lshr_b32 s23, s20, 1
  s_lshl_b32 s23, s23, 13
  s_add_u32 s23, s23, 16384
  v_add_u32 v18, s23, v18
  v_lshl_add_u32 v13, v19, 4, v18
  v_xor_b32 v14, 32, v13
  s_waitcnt vmcnt(29)
  v_lshlrev_b32 v184, 16, v160
  v_and_b32 v185, 0xffff0000, v160
  v_lshlrev_b32 v186, 16, v161
  v_and_b32 v187, 0xffff0000, v161
  v_lshlrev_b32 v188, 16, v162
  v_and_b32 v189, 0xffff0000, v162
  v_lshlrev_b32 v190, 16, v163
  v_and_b32 v191, 0xffff0000, v163
  v_lshlrev_b32 v192, 16, v164
  v_and_b32 v193, 0xffff0000, v164
  v_lshlrev_b32 v194, 16, v165
  v_and_b32 v195, 0xffff0000, v165
  v_lshlrev_b32 v196, 16, v166
  v_and_b32 v197, 0xffff0000, v166
  v_lshlrev_b32 v198, 16, v167
  v_and_b32 v199, 0xffff0000, v167
  v_lshlrev_b32 v200, 16, v168
  v_and_b32 v201, 0xffff0000, v168
  v_lshlrev_b32 v202, 16, v169
  v_and_b32 v203, 0xffff0000, v169
  v_lshlrev_b32 v204, 16, v170
  v_and_b32 v205, 0xffff0000, v170
  v_lshlrev_b32 v206, 16, v171
  v_and_b32 v207, 0xffff0000, v171
  v_add_f32 v213, v184, v185
  v_add_f32 v214, v186, v187
  v_add_f32 v213, v213, v188
  v_add_f32 v214, v214, v189
  v_add_f32 v213, v213, v190
  v_add_f32 v214, v214, v191
  v_add_f32 v213, v213, v192
  v_add_f32 v214, v214, v193
  v_add_f32 v213, v213, v194
  v_add_f32 v214, v214, v195
  v_add_f32 v213, v213, v196
  v_add_f32 v214, v214, v197
  v_add_f32 v213, v213, v198
  v_add_f32 v214, v214, v199
  v_add_f32 v213, v213, v200
  v_add_f32 v214, v214, v201
  v_add_f32 v213, v213, v202
  v_add_f32 v214, v214, v203
  v_add_f32 v213, v213, v204
  v_add_f32 v214, v214, v205
  v_add_f32 v213, v213, v206
  v_add_f32 v214, v214, v207
  v_add_f32 v213, v213, v214
  s_nop 1
  v_add_f32_dpp v213, v213, v213 quad_perm:[1,0,3,2] row_mask:0xf bank_mask:0xf
  s_nop 1
  v_add_f32_dpp v213, v213, v213 quad_perm:[2,3,0,1] row_mask:0xf bank_mask:0xf
  s_nop 1
  v_add_f32_dpp v213, v213, v213 row_half_mirror row_mask:0xf bank_mask:0xf
  s_nop 1
  v_add_f32_dpp v213, v213, v213 row_mirror row_mask:0xf bank_mask:0xf
  v_mov_b32 v214, v213
  s_nop 1
  v_permlane16_swap_b32 v213, v214
  v_add_f32 v213, v213, v214
  v_mul_f32 v215, 0x3acccccd, v213
  v_mov_b32 v218, 0
  v_mov_b32 v213, 0
  v_sub_f32 v16, v184, v215
  v_fmac_f32 v218, v16, v16
  v_sub_f32 v17, v185, v215
  v_fmac_f32 v218, v17, v17
  v_sub_f32 v18, v186, v215
  v_fmac_f32 v218, v18, v18
  v_sub_f32 v19, v187, v215
  v_fmac_f32 v218, v19, v19
  v_sub_f32 v16, v188, v215
  v_fmac_f32 v218, v16, v16
  v_sub_f32 v17, v189, v215
  v_fmac_f32 v218, v17, v17
  v_sub_f32 v18, v190, v215
  v_fmac_f32 v218, v18, v18
  v_sub_f32 v19, v191, v215
  v_fmac_f32 v218, v19, v19
  v_sub_f32 v16, v192, v215
  v_fmac_f32 v218, v16, v16
  v_sub_f32 v17, v193, v215
  v_fmac_f32 v218, v17, v17
  v_sub_f32 v18, v194, v215
  v_fmac_f32 v218, v18, v18
  v_sub_f32 v19, v195, v215
  v_fmac_f32 v218, v19, v19
  v_sub_f32 v16, v196, v215
  v_fmac_f32 v218, v16, v16
  v_sub_f32 v17, v197, v215
  v_fmac_f32 v218, v17, v17
  v_sub_f32 v18, v198, v215
  v_fmac_f32 v218, v18, v18
  v_sub_f32 v19, v199, v215
  v_fmac_f32 v218, v19, v19
  v_sub_f32 v16, v200, v215
  v_fmac_f32 v213, v16, v16
  v_sub_f32 v17, v201, v215
  v_fmac_f32 v213, v17, v17
  v_sub_f32 v18, v202, v215
  v_fmac_f32 v213, v18, v18
  v_sub_f32 v19, v203, v215
  v_fmac_f32 v213, v19, v19
  v_sub_f32 v16, v204, v215
  v_fmac_f32 v213, v16, v16
  v_sub_f32 v17, v205, v215
  v_fmac_f32 v213, v17, v17
  v_sub_f32 v18, v206, v215
  v_fmac_f32 v213, v18, v18
  v_sub_f32 v19, v207, v215
  v_fmac_f32 v213, v19, v19
  v_cndmask_b32 v213, 0, v213, s[56:57]
  v_add_f32 v213, v213, v218
  s_nop 1
  v_add_f32_dpp v213, v213, v213 quad_perm:[1,0,3,2] row_mask:0xf bank_mask:0xf
  s_nop 1
  v_add_f32_dpp v213, v213, v213 quad_perm:[2,3,0,1] row_mask:0xf bank_mask:0xf
  s_nop 1
  v_add_f32_dpp v213, v213, v213 row_half_mirror row_mask:0xf bank_mask:0xf
  s_nop 1
  v_add_f32_dpp v213, v213, v213 row_mirror row_mask:0xf bank_mask:0xf
  v_mov_b32 v214, v213
  s_nop 1
  v_permlane16_swap_b32 v213, v214
  v_add_f32 v213, v213, v214
  v_mul_f32 v213, 0x3acccccd, v213
  v_cvt_pk_bf16_f32 v213, v213, v213
  v_and_b32 v213, 0xffff0000, v213
  v_add_f32 v213, 0x3727c5ac, v213
  v_cvt_pk_bf16_f32 v213, v213, v213
  v_and_b32 v213, 0xffff0000, v213
  v_sqrt_f32 v213, v213
  v_mov_b32 v216, v215
  v_cvt_pk_bf16_f32 v213, v213, v213
  v_and_b32 v213, 0xffff0000, v213
  v_rcp_f32 v217, v213
  v_cvt_pk_bf16_f32 v216, v216, v216
  v_and_b32 v216, 0xffff0000, v216
  v_mov_b32 v218, 0
  v_sub_f32 v184, v184, v216
  v_sub_f32 v185, v185, v216
  v_cvt_pk_bf16_f32 v16, v184, v185
  v_lshlrev_b32 v184, 16, v16
  v_and_b32 v185, 0xffff0000, v16
  v_mul_f32 v184, v184, v217
  v_mul_f32 v185, v185, v217
  v_cvt_pk_bf16_f32 v160, v184, v185
  v_lshlrev_b32 v184, 16, v160
  v_and_b32 v185, 0xffff0000, v160
  v_lshlrev_b32 v17, 16, v172
  v_and_b32 v18, 0xffff0000, v172
  v_fmac_f32 v218, v184, v17
  v_fmac_f32 v218, v185, v18
  v_sub_f32 v186, v186, v216
  v_sub_f32 v187, v187, v216
  v_cvt_pk_bf16_f32 v16, v186, v187
  v_lshlrev_b32 v186, 16, v16
  v_and_b32 v187, 0xffff0000, v16
  v_mul_f32 v186, v186, v217
  v_mul_f32 v187, v187, v217
  v_cvt_pk_bf16_f32 v161, v186, v187
  v_lshlrev_b32 v186, 16, v161
  v_and_b32 v187, 0xffff0000, v161
  v_lshlrev_b32 v17, 16, v173
  v_and_b32 v18, 0xffff0000, v173
  v_fmac_f32 v218, v186, v17
  v_fmac_f32 v218, v187, v18
  v_sub_f32 v188, v188, v216
  v_sub_f32 v189, v189, v216
  v_cvt_pk_bf16_f32 v16, v188, v189
  v_lshlrev_b32 v188, 16, v16
  v_and_b32 v189, 0xffff0000, v16
  v_mul_f32 v188, v188, v217
  v_mul_f32 v189, v189, v217
  v_cvt_pk_bf16_f32 v162, v188, v189
  v_lshlrev_b32 v188, 16, v162
  v_and_b32 v189, 0xffff0000, v162
  v_lshlrev_b32 v17, 16, v174
  v_and_b32 v18, 0xffff0000, v174
  v_fmac_f32 v218, v188, v17
  v_fmac_f32 v218, v189, v18
  v_sub_f32 v190, v190, v216
  v_sub_f32 v191, v191, v216
  v_cvt_pk_bf16_f32 v16, v190, v191
  v_lshlrev_b32 v190, 16, v16
  v_and_b32 v191, 0xffff0000, v16
  v_mul_f32 v190, v190, v217
  v_mul_f32 v191, v191, v217
  v_cvt_pk_bf16_f32 v163, v190, v191
  v_lshlrev_b32 v190, 16, v163
  v_and_b32 v191, 0xffff0000, v163
  v_lshlrev_b32 v17, 16, v175
  v_and_b32 v18, 0xffff0000, v175
  v_fmac_f32 v218, v190, v17
  v_fmac_f32 v218, v191, v18
  v_sub_f32 v192, v192, v216
  v_sub_f32 v193, v193, v216
  v_cvt_pk_bf16_f32 v16, v192, v193
  v_lshlrev_b32 v192, 16, v16
  v_and_b32 v193, 0xffff0000, v16
  v_mul_f32 v192, v192, v217
  v_mul_f32 v193, v193, v217
  v_cvt_pk_bf16_f32 v164, v192, v193
  v_lshlrev_b32 v192, 16, v164
  v_and_b32 v193, 0xffff0000, v164
  v_lshlrev_b32 v17, 16, v176
  v_and_b32 v18, 0xffff0000, v176
  v_fmac_f32 v218, v192, v17
  v_fmac_f32 v218, v193, v18
  v_sub_f32 v194, v194, v216
  v_sub_f32 v195, v195, v216
  v_cvt_pk_bf16_f32 v16, v194, v195
  v_lshlrev_b32 v194, 16, v16
  v_and_b32 v195, 0xffff0000, v16
  v_mul_f32 v194, v194, v217
  v_mul_f32 v195, v195, v217
  v_cvt_pk_bf16_f32 v165, v194, v195
  v_lshlrev_b32 v194, 16, v165
  v_and_b32 v195, 0xffff0000, v165
  v_lshlrev_b32 v17, 16, v177
  v_and_b32 v18, 0xffff0000, v177
  v_fmac_f32 v218, v194, v17
  v_fmac_f32 v218, v195, v18
  v_sub_f32 v196, v196, v216
  v_sub_f32 v197, v197, v216
  v_cvt_pk_bf16_f32 v16, v196, v197
  v_lshlrev_b32 v196, 16, v16
  v_and_b32 v197, 0xffff0000, v16
  v_mul_f32 v196, v196, v217
  v_mul_f32 v197, v197, v217
  v_cvt_pk_bf16_f32 v166, v196, v197
  v_lshlrev_b32 v196, 16, v166
  v_and_b32 v197, 0xffff0000, v166
  v_lshlrev_b32 v17, 16, v178
  v_and_b32 v18, 0xffff0000, v178
  v_fmac_f32 v218, v196, v17
  v_fmac_f32 v218, v197, v18
  v_sub_f32 v198, v198, v216
  v_sub_f32 v199, v199, v216
  v_cvt_pk_bf16_f32 v16, v198, v199
  v_lshlrev_b32 v198, 16, v16
  v_and_b32 v199, 0xffff0000, v16
  v_mul_f32 v198, v198, v217
  v_mul_f32 v199, v199, v217
  v_cvt_pk_bf16_f32 v167, v198, v199
  v_lshlrev_b32 v198, 16, v167
  v_and_b32 v199, 0xffff0000, v167
  v_lshlrev_b32 v17, 16, v179
  v_and_b32 v18, 0xffff0000, v179
  v_fmac_f32 v218, v198, v17
  v_fmac_f32 v218, v199, v18
  v_sub_f32 v200, v200, v216
  v_sub_f32 v201, v201, v216
  v_cvt_pk_bf16_f32 v16, v200, v201
  v_lshlrev_b32 v200, 16, v16
  v_and_b32 v201, 0xffff0000, v16
  v_mul_f32 v200, v200, v217
  v_mul_f32 v201, v201, v217
  v_cvt_pk_bf16_f32 v168, v200, v201
  v_lshlrev_b32 v200, 16, v168
  v_and_b32 v201, 0xffff0000, v168
  v_lshlrev_b32 v17, 16, v180
  v_and_b32 v18, 0xffff0000, v180
  v_fmac_f32 v218, v200, v17
  v_fmac_f32 v218, v201, v18
  v_sub_f32 v202, v202, v216
  v_sub_f32 v203, v203, v216
  v_cvt_pk_bf16_f32 v16, v202, v203
  v_lshlrev_b32 v202, 16, v16
  v_and_b32 v203, 0xffff0000, v16
  v_mul_f32 v202, v202, v217
  v_mul_f32 v203, v203, v217
  v_cvt_pk_bf16_f32 v169, v202, v203
  v_lshlrev_b32 v202, 16, v169
  v_and_b32 v203, 0xffff0000, v169
  v_lshlrev_b32 v17, 16, v181
  v_and_b32 v18, 0xffff0000, v181
  v_fmac_f32 v218, v202, v17
  v_fmac_f32 v218, v203, v18
  v_sub_f32 v204, v204, v216
  v_sub_f32 v205, v205, v216
  v_cvt_pk_bf16_f32 v16, v204, v205
  v_lshlrev_b32 v204, 16, v16
  v_and_b32 v205, 0xffff0000, v16
  v_mul_f32 v204, v204, v217
  v_mul_f32 v205, v205, v217
  v_cvt_pk_bf16_f32 v170, v204, v205
  v_lshlrev_b32 v204, 16, v170
  v_and_b32 v205, 0xffff0000, v170
  v_lshlrev_b32 v17, 16, v182
  v_and_b32 v18, 0xffff0000, v182
  v_fmac_f32 v218, v204, v17
  v_fmac_f32 v218, v205, v18
  v_sub_f32 v206, v206, v216
  v_sub_f32 v207, v207, v216
  v_cvt_pk_bf16_f32 v16, v206, v207
  v_lshlrev_b32 v206, 16, v16
  v_and_b32 v207, 0xffff0000, v16
  v_mul_f32 v206, v206, v217
  v_mul_f32 v207, v207, v217
  v_cvt_pk_bf16_f32 v171, v206, v207
  v_lshlrev_b32 v206, 16, v171
  v_and_b32 v207, 0xffff0000, v171
  v_lshlrev_b32 v17, 16, v183
  v_and_b32 v18, 0xffff0000, v183
  v_fmac_f32 v218, v206, v17
  v_fmac_f32 v218, v207, v18
  v_lshrrev_b32 v16, 4, v209
  v_mul_u32_u24 v16, 20480, v16
  v_and_b32 v17, 15, v209
  v_lshl_add_u32 v16, v17, 4, v16
  v_lshl_add_u32 v210, v208, 8, v16
  v_add_u32 v17, 8192, v210
  v_add_u32 v18, 16384, v210
  v_mov_b32 v19, 0x40000000
  v_cndmask_b32 v18, v19, v18, s[56:57]
  buffer_store_dwordx4 v[160:163], v210, s[40:43], 0 offen
  buffer_store_dwordx4 v[164:167], v17, s[40:43], 0 offen
  buffer_store_dwordx4 v[168:171], v18, s[40:43], 0 offen
  s_nop 1
  v_add_f32_dpp v218, v218, v218 quad_perm:[1,0,3,2] row_mask:0xf bank_mask:0xf
  s_nop 1
  v_add_f32_dpp v218, v218, v218 quad_perm:[2,3,0,1] row_mask:0xf bank_mask:0xf
  s_nop 1
  v_add_f32_dpp v218, v218, v218 row_half_mirror row_mask:0xf bank_mask:0xf
  s_nop 1
  v_add_f32_dpp v218, v218, v218 row_mirror row_mask:0xf bank_mask:0xf
  v_mov_b32 v214, v218
  s_nop 1
  v_permlane16_swap_b32 v218, v214
  v_add_f32 v218, v218, v214
  v_cvt_pk_bf16_f32 v218, v218, v218
  v_and_b32 v218, 0xffff0000, v218
  v_ashrrev_i32 v214, 31, v218
  v_or_b32 v214, 0x80000000, v214
  v_xor_b32 v218, v218, v214
  v_and_b32 v218, 0xffff0000, v218
  v_sub_u32 v214, 0xffff, v209
  v_or_b32 v218, v218, v214
  v_lshlrev_b32 v214, 2, v209
  v_add_u32 v214, 2621440, v214
  v_cmp_eq_u32 vcc, 0, v208
  s_nop 1
  v_cndmask_b32 v214, v19, v214, vcc
  buffer_store_dword v218, v214, s[40:43], 0 offen
  s_barrier
  s_mov_b32 s28, 0
  s_cmp_ge_u32 s20, 2
  s_cbranch_scc1 k1_roleV
  ds_read_b128 v[96:99], v12 offset:0
  ds_read_b128 v[100:103], v12 offset:1024
  ds_read_b128 v[104:107], v12 offset:2048
  ds_read_b128 v[108:111], v12 offset:3072
  ds_read_b128 v[112:115], v12 offset:4096
  ds_read_b128 v[116:119], v12 offset:5120
  ds_read_b128 v[120:123], v12 offset:6144
  ds_read_b128 v[124:127], v12 offset:7168
  ds_read_b64_tr_b16 v[32:33], v13 offset:0
  ds_read_b64_tr_b16 v[34:35], v13 offset:1024
  ds_read_b64_tr_b16 v[36:37], v14 offset:0
  ds_read_b64_tr_b16 v[38:39], v14 offset:1024
  ds_read_b64_tr_b16 v[40:41], v13 offset:256
  ds_read_b64_tr_b16 v[42:43], v13 offset:1280
  ds_read_b64_tr_b16 v[44:45], v14 offset:256
  ds_read_b64_tr_b16 v[46:47], v14 offset:1280
  ds_read_b64_tr_b16 v[48:49], v13 offset:512
  ds_read_b64_tr_b16 v[50:51], v13 offset:1536
  ds_read_b64_tr_b16 v[52:53], v14 offset:512
  ds_read_b64_tr_b16 v[54:55], v14 offset:1536
  ds_read_b64_tr_b16 v[56:57], v13 offset:768
  ds_read_b64_tr_b16 v[58:59], v13 offset:1792
  ds_read_b64_tr_b16 v[60:61], v14 offset:768
  ds_read_b64_tr_b16 v[62:63], v14 offset:1792
  s_waitcnt lgkmcnt(0)
.p2align 6
k1_loopK:
  v_mfma_f32_16x16x32_bf16 a[0:3], v[32:35], v[96:99], a[0:3]
  s_waitcnt vmcnt(16)
  v_mfma_f32_16x16x32_bf16 a[4:7], v[32:35], v[100:103], a[4:7]
  s_barrier
  v_mfma_f32_16x16x32_bf16 a[8:11], v[32:35], v[104:107], a[8:11]
  s_mov_b32 m0, s24
  ds_read_b64_tr_b16 v[64:65], v13 offset:32768
  v_mfma_f32_16x16x32_bf16 a[12:15], v[32:35], v[108:111], a[12:15]
  buffer_load_dwordx4 v4, s[32:35], s26 offen offset:0 lds
  v_mfma_f32_16x16x32_bf16 a[16:19], v[32:35], v[112:115], a[16:19]
  ds_read_b64_tr_b16 v[66:67], v13 offset:33792
  v_mfma_f32_16x16x32_bf16 a[20:23], v[32:35], v[116:119], a[20:23]
  v_mfma_f32_16x16x32_bf16 a[24:27], v[32:35], v[120:123], a[24:27]
  ds_read_b128 v[128:131], v12 offset:32768
  v_mfma_f32_16x16x32_bf16 a[28:31], v[32:35], v[124:127], a[28:31]
  v_mfma_f32_16x16x32_bf16 a[32:35], v[36:39], v[96:99], a[32:35]
  ds_read_b64_tr_b16 v[68:69], v14 offset:32768
  v_mfma_f32_16x16x32_bf16 a[36:39], v[36:39], v[100:103], a[36:39]
  buffer_load_dwordx4 v5, s[32:35], s26 offen offset:1024 lds
  v_mfma_f32_16x16x32_bf16 a[40:43], v[36:39], v[104:107], a[40:43]
  ds_read_b64_tr_b16 v[70:71], v14 offset:33792
  v_mfma_f32_16x16x32_bf16 a[44:47], v[36:39], v[108:111], a[44:47]
  v_mfma_f32_16x16x32_bf16 a[48:51], v[36:39], v[112:115], a[48:51]
  ds_read_b128 v[132:135], v12 offset:33792
  v_mfma_f32_16x16x32_bf16 a[52:55], v[36:39], v[116:119], a[52:55]
  v_mfma_f32_16x16x32_bf16 a[56:59], v[36:39], v[120:123], a[56:59]
  ds_read_b64_tr_b16 v[72:73], v13 offset:33024
  v_mfma_f32_16x16x32_bf16 a[60:63], v[36:39], v[124:127], a[60:63]
  buffer_load_dwordx4 v6, s[32:35], s26 offen offset:2048 lds
  v_mfma_f32_16x16x32_bf16 a[64:67], v[40:43], v[96:99], a[64:67]
  ds_read_b64_tr_b16 v[74:75], v13 offset:34048
  v_mfma_f32_16x16x32_bf16 a[68:71], v[40:43], v[100:103], a[68:71]
  v_mfma_f32_16x16x32_bf16 a[72:75], v[40:43], v[104:107], a[72:75]
  ds_read_b128 v[136:139], v12 offset:34816
  v_mfma_f32_16x16x32_bf16 a[76:79], v[40:43], v[108:111], a[76:79]
  v_mfma_f32_16x16x32_bf16 a[80:83], v[40:43], v[112:115], a[80:83]
  ds_read_b64_tr_b16 v[76:77], v14 offset:33024
  v_mfma_f32_16x16x32_bf16 a[84:87], v[40:43], v[116:119], a[84:87]
  buffer_load_dwordx4 v7, s[32:35], s26 offen offset:3072 lds
  v_mfma_f32_16x16x32_bf16 a[88:91], v[40:43], v[120:123], a[88:91]
  ds_read_b64_tr_b16 v[78:79], v14 offset:34048
  v_mfma_f32_16x16x32_bf16 a[92:95], v[40:43], v[124:127], a[92:95]
  v_mfma_f32_16x16x32_bf16 a[96:99], v[44:47], v[96:99], a[96:99]
  ds_read_b128 v[140:143], v12 offset:35840
  v_mfma_f32_16x16x32_bf16 a[100:103], v[44:47], v[100:103], a[100:103]
  v_mfma_f32_16x16x32_bf16 a[104:107], v[44:47], v[104:107], a[104:107]
  s_add_u32 m0, s24, 16384
  ds_read_b64_tr_b16 v[80:81], v13 offset:33280
  v_mfma_f32_16x16x32_bf16 a[108:111], v[44:47], v[108:111], a[108:111]
  buffer_load_dwordx4 v8, s[36:39], s27 offen offset:0 lds
  v_mfma_f32_16x16x32_bf16 a[112:115], v[44:47], v[112:115], a[112:115]
  ds_read_b64_tr_b16 v[82:83], v13 offset:34304
  v_mfma_f32_16x16x32_bf16 a[116:119], v[44:47], v[116:119], a[116:119]
  v_mfma_f32_16x16x32_bf16 a[120:123], v[44:47], v[120:123], a[120:123]
  ds_read_b128 v[144:147], v12 offset:36864
  v_mfma_f32_16x16x32_bf16 a[124:127], v[44:47], v[124:127], a[124:127]
  v_mfma_f32_16x16x32_bf16 a[128:131], v[48:51], v[96:99], a[128:131]
  ds_read_b64_tr_b16 v[84:85], v14 offset:33280
  v_mfma_f32_16x16x32_bf16 a[132:135], v[48:51], v[100:103], a[132:135]
  buffer_load_dwordx4 v9, s[36:39], s27 offen offset:1024 lds
  v_mfma_f32_16x16x32_bf16 a[136:139], v[48:51], v[104:107], a[136:139]
  ds_read_b64_tr_b16 v[86:87], v14 offset:34304
  v_mfma_f32_16x16x32_bf16 a[140:143], v[48:51], v[108:111], a[140:143]
  v_mfma_f32_16x16x32_bf16 a[144:147], v[48:51], v[112:115], a[144:147]
  ds_read_b128 v[148:151], v12 offset:37888
  v_mfma_f32_16x16x32_bf16 a[148:151], v[48:51], v[116:119], a[148:151]
  v_mfma_f32_16x16x32_bf16 a[152:155], v[48:51], v[120:123], a[152:155]
  ds_read_b64_tr_b16 v[88:89], v13 offset:33536
  v_mfma_f32_16x16x32_bf16 a[156:159], v[48:51], v[124:127], a[156:159]
  buffer_load_dwordx4 v10, s[36:39], s27 offen offset:2048 lds
  v_mfma_f32_16x16x32_bf16 a[160:163], v[52:55], v[96:99], a[160:163]
  ds_read_b64_tr_b16 v[90:91], v13 offset:34560
  v_mfma_f32_16x16x32_bf16 a[164:167], v[52:55], v[100:103], a[164:167]
  v_mfma_f32_16x16x32_bf16 a[168:171], v[52:55], v[104:107], a[168:171]
  ds_read_b128 v[152:155], v12 offset:38912
  v_mfma_f32_16x16x32_bf16 a[172:175], v[52:55], v[108:111], a[172:175]
  v_mfma_f32_16x16x32_bf16 a[176:179], v[52:55], v[112:115], a[176:179]
  ds_read_b64_tr_b16 v[92:93], v14 offset:33536
  v_mfma_f32_16x16x32_bf16 a[180:183], v[52:55], v[116:119], a[180:183]
  buffer_load_dwordx4 v11, s[36:39], s27 offen offset:3072 lds
  v_mfma_f32_16x16x32_bf16 a[184:187], v[52:55], v[120:123], a[184:187]
  ds_read_b64_tr_b16 v[94:95], v14 offset:34560
  v_mfma_f32_16x16x32_bf16 a[188:191], v[52:55], v[124:127], a[188:191]
  v_mfma_f32_16x16x32_bf16 a[192:195], v[56:59], v[96:99], a[192:195]
  s_add_u32 s26, s26, 64
  ds_read_b128 v[156:159], v12 offset:39936
  v_mfma_f32_16x16x32_bf16 a[196:199], v[56:59], v[100:103], a[196:199]
  s_add_u32 s27, s27, 262144
  v_mfma_f32_16x16x32_bf16 a[200:203], v[56:59], v[104:107], a[200:203]
  s_add_u32 s24, s24, 32768
  v_mfma_f32_16x16x32_bf16 a[204:207], v[56:59], v[108:111], a[204:207]
  s_and_b32 s24, s24, 0x1ffff
  v_mfma_f32_16x16x32_bf16 a[208:211], v[56:59], v[112:115], a[208:211]
  v_xor_b32 v12, 0x10000, v12
  v_mfma_f32_16x16x32_bf16 a[212:215], v[56:59], v[116:119], a[212:215]
  v_xor_b32 v13, 0x10000, v13
  v_mfma_f32_16x16x32_bf16 a[216:219], v[56:59], v[120:123], a[216:219]
  v_xor_b32 v14, 0x10000, v14
  v_mfma_f32_16x16x32_bf16 a[220:223], v[56:59], v[124:127], a[220:223]
  v_mfma_f32_16x16x32_bf16 a[224:227], v[60:63], v[96:99], a[224:227]
  v_mfma_f32_16x16x32_bf16 a[228:231], v[60:63], v[100:103], a[228:231]
  v_mfma_f32_16x16x32_bf16 a[232:235], v[60:63], v[104:107], a[232:235]
  v_mfma_f32_16x16x32_bf16 a[236:239], v[60:63], v[108:111], a[236:239]
  v_mfma_f32_16x16x32_bf16 a[240:243], v[60:63], v[112:115], a[240:243]
  v_mfma_f32_16x16x32_bf16 a[244:247], v[60:63], v[116:119], a[244:247]
  v_mfma_f32_16x16x32_bf16 a[248:251], v[60:63], v[120:123], a[248:251]
  v_mfma_f32_16x16x32_bf16 a[252:255], v[60:63], v[124:127], a[252:255]
  s_waitcnt lgkmcnt(0)
  v_mfma_f32_16x16x32_bf16 a[0:3], v[64:67], v[128:131], a[0:3]
  s_waitcnt vmcnt(16)
  v_mfma_f32_16x16x32_bf16 a[4:7], v[64:67], v[132:135], a[4:7]
  s_barrier
  v_mfma_f32_16x16x32_bf16 a[8:11], v[64:67], v[136:139], a[8:11]
  s_mov_b32 m0, s24
  ds_read_b64_tr_b16 v[32:33], v13 offset:0
  v_mfma_f32_16x16x32_bf16 a[12:15], v[64:67], v[140:143], a[12:15]
  buffer_load_dwordx4 v4, s[32:35], s26 offen offset:0 lds
  v_mfma_f32_16x16x32_bf16 a[16:19], v[64:67], v[144:147], a[16:19]
  ds_read_b64_tr_b16 v[34:35], v13 offset:1024
  v_mfma_f32_16x16x32_bf16 a[20:23], v[64:67], v[148:151], a[20:23]
  v_mfma_f32_16x16x32_bf16 a[24:27], v[64:67], v[152:155], a[24:27]
  ds_read_b128 v[96:99], v12 offset:0
  v_mfma_f32_16x16x32_bf16 a[28:31], v[64:67], v[156:159], a[28:31]
  v_mfma_f32_16x16x32_bf16 a[32:35], v[68:71], v[128:131], a[32:35]
  ds_read_b64_tr_b16 v[36:37], v14 offset:0
  v_mfma_f32_16x16x32_bf16 a[36:39], v[68:71], v[132:135], a[36:39]
  buffer_load_dwordx4 v5, s[32:35], s26 offen offset:1024 lds
  v_mfma_f32_16x16x32_bf16 a[40:43], v[68:71], v[136:139], a[40:43]
  ds_read_b64_tr_b16 v[38:39], v14 offset:1024
  v_mfma_f32_16x16x32_bf16 a[44:47], v[68:71], v[140:143], a[44:47]
  v_mfma_f32_16x16x32_bf16 a[48:51], v[68:71], v[144:147], a[48:51]
  ds_read_b128 v[100:103], v12 offset:1024
  v_mfma_f32_16x16x32_bf16 a[52:55], v[68:71], v[148:151], a[52:55]
  v_mfma_f32_16x16x32_bf16 a[56:59], v[68:71], v[152:155], a[56:59]
  ds_read_b64_tr_b16 v[40:41], v13 offset:256
  v_mfma_f32_16x16x32_bf16 a[60:63], v[68:71], v[156:159], a[60:63]
  buffer_load_dwordx4 v6, s[32:35], s26 offen offset:2048 lds
  v_mfma_f32_16x16x32_bf16 a[64:67], v[72:75], v[128:131], a[64:67]
  ds_read_b64_tr_b16 v[42:43], v13 offset:1280
  v_mfma_f32_16x16x32_bf16 a[68:71], v[72:75], v[132:135], a[68:71]
  v_mfma_f32_16x16x32_bf16 a[72:75], v[72:75], v[136:139], a[72:75]
  ds_read_b128 v[104:107], v12 offset:2048
  v_mfma_f32_16x16x32_bf16 a[76:79], v[72:75], v[140:143], a[76:79]
  v_mfma_f32_16x16x32_bf16 a[80:83], v[72:75], v[144:147], a[80:83]
  ds_read_b64_tr_b16 v[44:45], v14 offset:256
  v_mfma_f32_16x16x32_bf16 a[84:87], v[72:75], v[148:151], a[84:87]
  buffer_load_dwordx4 v7, s[32:35], s26 offen offset:3072 lds
  v_mfma_f32_16x16x32_bf16 a[88:91], v[72:75], v[152:155], a[88:91]
  ds_read_b64_tr_b16 v[46:47], v14 offset:1280
  v_mfma_f32_16x16x32_bf16 a[92:95], v[72:75], v[156:159], a[92:95]
  v_mfma_f32_16x16x32_bf16 a[96:99], v[76:79], v[128:131], a[96:99]
  ds_read_b128 v[108:111], v12 offset:3072
  v_mfma_f32_16x16x32_bf16 a[100:103], v[76:79], v[132:135], a[100:103]
  v_mfma_f32_16x16x32_bf16 a[104:107], v[76:79], v[136:139], a[104:107]
  s_add_u32 m0, s24, 16384
  ds_read_b64_tr_b16 v[48:49], v13 offset:512
  v_mfma_f32_16x16x32_bf16 a[108:111], v[76:79], v[140:143], a[108:111]
  buffer_load_dwordx4 v8, s[36:39], s27 offen offset:0 lds
  v_mfma_f32_16x16x32_bf16 a[112:115], v[76:79], v[144:147], a[112:115]
  ds_read_b64_tr_b16 v[50:51], v13 offset:1536
  v_mfma_f32_16x16x32_bf16 a[116:119], v[76:79], v[148:151], a[116:119]
  v_mfma_f32_16x16x32_bf16 a[120:123], v[76:79], v[152:155], a[120:123]
  ds_read_b128 v[112:115], v12 offset:4096
  v_mfma_f32_16x16x32_bf16 a[124:127], v[76:79], v[156:159], a[124:127]
  v_mfma_f32_16x16x32_bf16 a[128:131], v[80:83], v[128:131], a[128:131]
  ds_read_b64_tr_b16 v[52:53], v14 offset:512
  v_mfma_f32_16x16x32_bf16 a[132:135], v[80:83], v[132:135], a[132:135]
  buffer_load_dwordx4 v9, s[36:39], s27 offen offset:1024 lds
  v_mfma_f32_16x16x32_bf16 a[136:139], v[80:83], v[136:139], a[136:139]
  ds_read_b64_tr_b16 v[54:55], v14 offset:1536
  v_mfma_f32_16x16x32_bf16 a[140:143], v[80:83], v[140:143], a[140:143]
  v_mfma_f32_16x16x32_bf16 a[144:147], v[80:83], v[144:147], a[144:147]
  ds_read_b128 v[116:119], v12 offset:5120
  v_mfma_f32_16x16x32_bf16 a[148:151], v[80:83], v[148:151], a[148:151]
  v_mfma_f32_16x16x32_bf16 a[152:155], v[80:83], v[152:155], a[152:155]
  ds_read_b64_tr_b16 v[56:57], v13 offset:768
  v_mfma_f32_16x16x32_bf16 a[156:159], v[80:83], v[156:159], a[156:159]
  buffer_load_dwordx4 v10, s[36:39], s27 offen offset:2048 lds
  v_mfma_f32_16x16x32_bf16 a[160:163], v[84:87], v[128:131], a[160:163]
  ds_read_b64_tr_b16 v[58:59], v13 offset:1792
  v_mfma_f32_16x16x32_bf16 a[164:167], v[84:87], v[132:135], a[164:167]
  v_mfma_f32_16x16x32_bf16 a[168:171], v[84:87], v[136:139], a[168:171]
  ds_read_b128 v[120:123], v12 offset:6144
  v_mfma_f32_16x16x32_bf16 a[172:175], v[84:87], v[140:143], a[172:175]
  v_mfma_f32_16x16x32_bf16 a[176:179], v[84:87], v[144:147], a[176:179]
  ds_read_b64_tr_b16 v[60:61], v14 offset:768
  v_mfma_f32_16x16x32_bf16 a[180:183], v[84:87], v[148:151], a[180:183]
  buffer_load_dwordx4 v11, s[36:39], s27 offen offset:3072 lds
  v_mfma_f32_16x16x32_bf16 a[184:187], v[84:87], v[152:155], a[184:187]
  ds_read_b64_tr_b16 v[62:63], v14 offset:1792
  v_mfma_f32_16x16x32_bf16 a[188:191], v[84:87], v[156:159], a[188:191]
  v_mfma_f32_16x16x32_bf16 a[192:195], v[88:91], v[128:131], a[192:195]
  s_add_u32 s26, s26, 64
  ds_read_b128 v[124:127], v12 offset:7168
  v_mfma_f32_16x16x32_bf16 a[196:199], v[88:91], v[132:135], a[196:199]
  s_add_u32 s27, s27, 262144
  v_mfma_f32_16x16x32_bf16 a[200:203], v[88:91], v[136:139], a[200:203]
  s_add_u32 s24, s24, 32768
  v_mfma_f32_16x16x32_bf16 a[204:207], v[88:91], v[140:143], a[204:207]
  s_and_b32 s24, s24, 0x1ffff
  v_mfma_f32_16x16x32_bf16 a[208:211], v[88:91], v[144:147], a[208:211]
  v_mfma_f32_16x16x32_bf16 a[212:215], v[88:91], v[148:151], a[212:215]
  v_mfma_f32_16x16x32_bf16 a[216:219], v[88:91], v[152:155], a[216:219]
  s_add_u32 s28, s28, 1
  v_mfma_f32_16x16x32_bf16 a[220:223], v[88:91], v[156:159], a[220:223]
  s_cmp_ge_u32 s28, 6
  v_mfma_f32_16x16x32_bf16 a[224:227], v[92:95], v[128:131], a[224:227]
  s_cselect_b32 s34, 0, s34
  v_mfma_f32_16x16x32_bf16 a[228:231], v[92:95], v[132:135], a[228:231]
  s_cselect_b32 s38, 0, s38
  v_mfma_f32_16x16x32_bf16 a[232:235], v[92:95], v[136:139], a[232:235]
  v_mfma_f32_16x16x32_bf16 a[236:239], v[92:95], v[140:143], a[236:239]
  v_mfma_f32_16x16x32_bf16 a[240:243], v[92:95], v[144:147], a[240:243]
  v_mfma_f32_16x16x32_bf16 a[244:247], v[92:95], v[148:151], a[244:247]
  s_cmp_lt_u32 s28, 8
  v_mfma_f32_16x16x32_bf16 a[248:251], v[92:95], v[152:155], a[248:251]
  s_waitcnt lgkmcnt(0)
  v_mfma_f32_16x16x32_bf16 a[252:255], v[92:95], v[156:159], a[252:255]
  s_cbranch_scc1 k1_loopK
  s_mov_b32 s60, 2048
  s_mov_b32 s61, 8192
  s_mov_b32 s62, 16777216
  s_branch k1_epi
k1_roleV:
  ds_read_b128 v[32:35], v12 offset:0
  ds_read_b128 v[36:39], v12 offset:1024
  ds_read_b128 v[40:43], v12 offset:2048
  ds_read_b128 v[44:47], v12 offset:3072
  ds_read_b128 v[48:51], v12 offset:4096
  ds_read_b128 v[52:55], v12 offset:5120
  ds_read_b128 v[56:59], v12 offset:6144
  ds_read_b128 v[60:63], v12 offset:7168
  ds_read_b64_tr_b16 v[96:97], v13 offset:0
  ds_read_b64_tr_b16 v[98:99], v13 offset:1024
  ds_read_b64_tr_b16 v[100:101], v14 offset:0
  ds_read_b64_tr_b16 v[102:103], v14 offset:1024
  ds_read_b64_tr_b16 v[104:105], v13 offset:256
  ds_read_b64_tr_b16 v[106:107], v13 offset:1280
  ds_read_b64_tr_b16 v[108:109], v14 offset:256
  ds_read_b64_tr_b16 v[110:111], v14 offset:1280
  ds_read_b64_tr_b16 v[112:113], v13 offset:512
  ds_read_b64_tr_b16 v[114:115], v13 offset:1536
  ds_read_b64_tr_b16 v[116:117], v14 offset:512
  ds_read_b64_tr_b16 v[118:119], v14 offset:1536
  ds_read_b64_tr_b16 v[120:121], v13 offset:768
  ds_read_b64_tr_b16 v[122:123], v13 offset:1792
  ds_read_b64_tr_b16 v[124:125], v14 offset:768
  ds_read_b64_tr_b16 v[126:127], v14 offset:1792
  s_waitcnt lgkmcnt(0)
.p2align 6
k1_loopV:
  v_mfma_f32_16x16x32_bf16 a[0:3], v[32:35], v[96:99], a[0:3]
  s_waitcnt vmcnt(16)
  v_mfma_f32_16x16x32_bf16 a[4:7], v[32:35], v[100:103], a[4:7]
  s_barrier
  v_mfma_f32_16x16x32_bf16 a[8:11], v[32:35], v[104:107], a[8:11]
  s_mov_b32 m0, s24
  ds_read_b64_tr_b16 v[128:129], v13 offset:32768
  v_mfma_f32_16x16x32_bf16 a[12:15], v[32:35], v[108:111], a[12:15]
  buffer_load_dwordx4 v4, s[32:35], s26 offen offset:0 lds
  v_mfma_f32_16x16x32_bf16 a[16:19], v[32:35], v[112:115], a[16:19]
  ds_read_b64_tr_b16 v[130:131], v13 offset:33792
  v_mfma_f32_16x16x32_bf16 a[20:23], v[32:35], v[116:119], a[20:23]
  v_mfma_f32_16x16x32_bf16 a[24:27], v[32:35], v[120:123], a[24:27]
  ds_read_b128 v[64:67], v12 offset:32768
  v_mfma_f32_16x16x32_bf16 a[28:31], v[32:35], v[124:127], a[28:31]
  v_mfma_f32_16x16x32_bf16 a[32:35], v[36:39], v[96:99], a[32:35]
  ds_read_b64_tr_b16 v[132:133], v14 offset:32768
  v_mfma_f32_16x16x32_bf16 a[36:39], v[36:39], v[100:103], a[36:39]
  buffer_load_dwordx4 v5, s[32:35], s26 offen offset:1024 lds
  v_mfma_f32_16x16x32_bf16 a[40:43], v[36:39], v[104:107], a[40:43]
  ds_read_b64_tr_b16 v[134:135], v14 offset:33792
  v_mfma_f32_16x16x32_bf16 a[44:47], v[36:39], v[108:111], a[44:47]
  v_mfma_f32_16x16x32_bf16 a[48:51], v[36:39], v[112:115], a[48:51]
  ds_read_b128 v[68:71], v12 offset:33792
  v_mfma_f32_16x16x32_bf16 a[52:55], v[36:39], v[116:119], a[52:55]
  v_mfma_f32_16x16x32_bf16 a[56:59], v[36:39], v[120:123], a[56:59]
  ds_read_b64_tr_b16 v[136:137], v13 offset:33024
  v_mfma_f32_16x16x32_bf16 a[60:63], v[36:39], v[124:127], a[60:63]
  buffer_load_dwordx4 v6, s[32:35], s26 offen offset:2048 lds
  v_mfma_f32_16x16x32_bf16 a[64:67], v[40:43], v[96:99], a[64:67]
  ds_read_b64_tr_b16 v[138:139], v13 offset:34048
  v_mfma_f32_16x16x32_bf16 a[68:71], v[40:43], v[100:103], a[68:71]
  v_mfma_f32_16x16x32_bf16 a[72:75], v[40:43], v[104:107], a[72:75]
  ds_read_b128 v[72:75], v12 offset:34816
  v_mfma_f32_16x16x32_bf16 a[76:79], v[40:43], v[108:111], a[76:79]
  v_mfma_f32_16x16x32_bf16 a[80:83], v[40:43], v[112:115], a[80:83]
  ds_read_b64_tr_b16 v[140:141], v14 offset:33024
  v_mfma_f32_16x16x32_bf16 a[84:87], v[40:43], v[116:119], a[84:87]
  buffer_load_dwordx4 v7, s[32:35], s26 offen offset:3072 lds
  v_mfma_f32_16x16x32_bf16 a[88:91], v[40:43], v[120:123], a[88:91]
  ds_read_b64_tr_b16 v[142:143], v14 offset:34048
  v_mfma_f32_16x16x32_bf16 a[92:95], v[40:43], v[124:127], a[92:95]
  v_mfma_f32_16x16x32_bf16 a[96:99], v[44:47], v[96:99], a[96:99]
  ds_read_b128 v[76:79], v12 offset:35840
  v_mfma_f32_16x16x32_bf16 a[100:103], v[44:47], v[100:103], a[100:103]
  v_mfma_f32_16x16x32_bf16 a[104:107], v[44:47], v[104:107], a[104:107]
  s_add_u32 m0, s24, 16384
  ds_read_b64_tr_b16 v[144:145], v13 offset:33280
  v_mfma_f32_16x16x32_bf16 a[108:111], v[44:47], v[108:111], a[108:111]
  buffer_load_dwordx4 v8, s[36:39], s27 offen offset:0 lds
  v_mfma_f32_16x16x32_bf16 a[112:115], v[44:47], v[112:115], a[112:115]
  ds_read_b64_tr_b16 v[146:147], v13 offset:34304
  v_mfma_f32_16x16x32_bf16 a[116:119], v[44:47], v[116:119], a[116:119]
  v_mfma_f32_16x16x32_bf16 a[120:123], v[44:47], v[120:123], a[120:123]
  ds_read_b128 v[80:83], v12 offset:36864
  v_mfma_f32_16x16x32_bf16 a[124:127], v[44:47], v[124:127], a[124:127]
  v_mfma_f32_16x16x32_bf16 a[128:131], v[48:51], v[96:99], a[128:131]
  ds_read_b64_tr_b16 v[148:149], v14 offset:33280
  v_mfma_f32_16x16x32_bf16 a[132:135], v[48:51], v[100:103], a[132:135]
  buffer_load_dwordx4 v9, s[36:39], s27 offen offset:1024 lds
  v_mfma_f32_16x16x32_bf16 a[136:139], v[48:51], v[104:107], a[136:139]
  ds_read_b64_tr_b16 v[150:151], v14 offset:34304
  v_mfma_f32_16x16x32_bf16 a[140:143], v[48:51], v[108:111], a[140:143]
  v_mfma_f32_16x16x32_bf16 a[144:147], v[48:51], v[112:115], a[144:147]
  ds_read_b128 v[84:87], v12 offset:37888
  v_mfma_f32_16x16x32_bf16 a[148:151], v[48:51], v[116:119], a[148:151]
  v_mfma_f32_16x16x32_bf16 a[152:155], v[48:51], v[120:123], a[152:155]
  ds_read_b64_tr_b16 v[152:153], v13 offset:33536
  v_mfma_f32_16x16x32_bf16 a[156:159], v[48:51], v[124:127], a[156:159]
  buffer_load_dwordx4 v10, s[36:39], s27 offen offset:2048 lds
  v_mfma_f32_16x16x32_bf16 a[160:163], v[52:55], v[96:99], a[160:163]
  ds_read_b64_tr_b16 v[154:155], v13 offset:34560
  v_mfma_f32_16x16x32_bf16 a[164:167], v[52:55], v[100:103], a[164:167]
  v_mfma_f32_16x16x32_bf16 a[168:171], v[52:55], v[104:107], a[168:171]
  ds_read_b128 v[88:91], v12 offset:38912
  v_mfma_f32_16x16x32_bf16 a[172:175], v[52:55], v[108:111], a[172:175]
  v_mfma_f32_16x16x32_bf16 a[176:179], v[52:55], v[112:115], a[176:179]
  ds_read_b64_tr_b16 v[156:157], v14 offset:33536
  v_mfma_f32_16x16x32_bf16 a[180:183], v[52:55], v[116:119], a[180:183]
  buffer_load_dwordx4 v11, s[36:39], s27 offen offset:3072 lds
  v_mfma_f32_16x16x32_bf16 a[184:187], v[52:55], v[120:123], a[184:187]
  ds_read_b64_tr_b16 v[158:159], v14 offset:34560
  v_mfma_f32_16x16x32_bf16 a[188:191], v[52:55], v[124:127], a[188:191]
  v_mfma_f32_16x16x32_bf16 a[192:195], v[56:59], v[96:99], a[192:195]
  s_add_u32 s26, s26, 64
  ds_read_b128 v[92:95], v12 offset:39936
  v_mfma_f32_16x16x32_bf16 a[196:199], v[56:59], v[100:103], a[196:199]
  s_add_u32 s27, s27, 262144
  v_mfma_f32_16x16x32_bf16 a[200:203], v[56:59], v[104:107], a[200:203]
  s_add_u32 s24, s24, 32768
  v_mfma_f32_16x16x32_bf16 a[204:207], v[56:59], v[108:111], a[204:207]
  s_and_b32 s24, s24, 0x1ffff
  v_mfma_f32_16x16x32_bf16 a[208:211], v[56:59], v[112:115], a[208:211]
  v_xor_b32 v12, 0x10000, v12
  v_mfma_f32_16x16x32_bf16 a[212:215], v[56:59], v[116:119], a[212:215]
  v_xor_b32 v13, 0x10000, v13
  v_mfma_f32_16x16x32_bf16 a[216:219], v[56:59], v[120:123], a[216:219]
  v_xor_b32 v14, 0x10000, v14
  v_mfma_f32_16x16x32_bf16 a[220:223], v[56:59], v[124:127], a[220:223]
  v_mfma_f32_16x16x32_bf16 a[224:227], v[60:63], v[96:99], a[224:227]
  v_mfma_f32_16x16x32_bf16 a[228:231], v[60:63], v[100:103], a[228:231]
  v_mfma_f32_16x16x32_bf16 a[232:235], v[60:63], v[104:107], a[232:235]
  v_mfma_f32_16x16x32_bf16 a[236:239], v[60:63], v[108:111], a[236:239]
  v_mfma_f32_16x16x32_bf16 a[240:243], v[60:63], v[112:115], a[240:243]
  v_mfma_f32_16x16x32_bf16 a[244:247], v[60:63], v[116:119], a[244:247]
  v_mfma_f32_16x16x32_bf16 a[248:251], v[60:63], v[120:123], a[248:251]
  v_mfma_f32_16x16x32_bf16 a[252:255], v[60:63], v[124:127], a[252:255]
  s_waitcnt lgkmcnt(0)
  v_mfma_f32_16x16x32_bf16 a[0:3], v[64:67], v[128:131], a[0:3]
  s_waitcnt vmcnt(16)
  v_mfma_f32_16x16x32_bf16 a[4:7], v[64:67], v[132:135], a[4:7]
  s_barrier
  v_mfma_f32_16x16x32_bf16 a[8:11], v[64:67], v[136:139], a[8:11]
  s_mov_b32 m0, s24
  ds_read_b64_tr_b16 v[96:97], v13 offset:0
  v_mfma_f32_16x16x32_bf16 a[12:15], v[64:67], v[140:143], a[12:15]
  buffer_load_dwordx4 v4, s[32:35], s26 offen offset:0 lds
  v_mfma_f32_16x16x32_bf16 a[16:19], v[64:67], v[144:147], a[16:19]
  ds_read_b64_tr_b16 v[98:99], v13 offset:1024
  v_mfma_f32_16x16x32_bf16 a[20:23], v[64:67], v[148:151], a[20:23]
  v_mfma_f32_16x16x32_bf16 a[24:27], v[64:67], v[152:155], a[24:27]
  ds_read_b128 v[32:35], v12 offset:0
  v_mfma_f32_16x16x32_bf16 a[28:31], v[64:67], v[156:159], a[28:31]
  v_mfma_f32_16x16x32_bf16 a[32:35], v[68:71], v[128:131], a[32:35]
  ds_read_b64_tr_b16 v[100:101], v14 offset:0
  v_mfma_f32_16x16x32_bf16 a[36:39], v[68:71], v[132:135], a[36:39]
  buffer_load_dwordx4 v5, s[32:35], s26 offen offset:1024 lds
  v_mfma_f32_16x16x32_bf16 a[40:43], v[68:71], v[136:139], a[40:43]
  ds_read_b64_tr_b16 v[102:103], v14 offset:1024
  v_mfma_f32_16x16x32_bf16 a[44:47], v[68:71], v[140:143], a[44:47]
  v_mfma_f32_16x16x32_bf16 a[48:51], v[68:71], v[144:147], a[48:51]
  ds_read_b128 v[36:39], v12 offset:1024
  v_mfma_f32_16x16x32_bf16 a[52:55], v[68:71], v[148:151], a[52:55]
  v_mfma_f32_16x16x32_bf16 a[56:59], v[68:71], v[152:155], a[56:59]
  ds_read_b64_tr_b16 v[104:105], v13 offset:256
  v_mfma_f32_16x16x32_bf16 a[60:63], v[68:71], v[156:159], a[60:63]
  buffer_load_dwordx4 v6, s[32:35], s26 offen offset:2048 lds
  v_mfma_f32_16x16x32_bf16 a[64:67], v[72:75], v[128:131], a[64:67]
  ds_read_b64_tr_b16 v[106:107], v13 offset:1280
  v_mfma_f32_16x16x32_bf16 a[68:71], v[72:75], v[132:135], a[68:71]
  v_mfma_f32_16x16x32_bf16 a[72:75], v[72:75], v[136:139], a[72:75]
  ds_read_b128 v[40:43], v12 offset:2048
  v_mfma_f32_16x16x32_bf16 a[76:79], v[72:75], v[140:143], a[76:79]
  v_mfma_f32_16x16x32_bf16 a[80:83], v[72:75], v[144:147], a[80:83]
  ds_read_b64_tr_b16 v[108:109], v14 offset:256
  v_mfma_f32_16x16x32_bf16 a[84:87], v[72:75], v[148:151], a[84:87]
  buffer_load_dwordx4 v7, s[32:35], s26 offen offset:3072 lds
  v_mfma_f32_16x16x32_bf16 a[88:91], v[72:75], v[152:155], a[88:91]
  ds_read_b64_tr_b16 v[110:111], v14 offset:1280
  v_mfma_f32_16x16x32_bf16 a[92:95], v[72:75], v[156:159], a[92:95]
  v_mfma_f32_16x16x32_bf16 a[96:99], v[76:79], v[128:131], a[96:99]
  ds_read_b128 v[44:47], v12 offset:3072
  v_mfma_f32_16x16x32_bf16 a[100:103], v[76:79], v[132:135], a[100:103]
  v_mfma_f32_16x16x32_bf16 a[104:107], v[76:79], v[136:139], a[104:107]
  s_add_u32 m0, s24, 16384
  ds_read_b64_tr_b16 v[112:113], v13 offset:512
  v_mfma_f32_16x16x32_bf16 a[108:111], v[76:79], v[140:143], a[108:111]
  buffer_load_dwordx4 v8, s[36:39], s27 offen offset:0 lds
  v_mfma_f32_16x16x32_bf16 a[112:115], v[76:79], v[144:147], a[112:115]
  ds_read_b64_tr_b16 v[114:115], v13 offset:1536
  v_mfma_f32_16x16x32_bf16 a[116:119], v[76:79], v[148:151], a[116:119]
  v_mfma_f32_16x16x32_bf16 a[120:123], v[76:79], v[152:155], a[120:123]
  ds_read_b128 v[48:51], v12 offset:4096
  v_mfma_f32_16x16x32_bf16 a[124:127], v[76:79], v[156:159], a[124:127]
  v_mfma_f32_16x16x32_bf16 a[128:131], v[80:83], v[128:131], a[128:131]
  ds_read_b64_tr_b16 v[116:117], v14 offset:512
  v_mfma_f32_16x16x32_bf16 a[132:135], v[80:83], v[132:135], a[132:135]
  buffer_load_dwordx4 v9, s[36:39], s27 offen offset:1024 lds
  v_mfma_f32_16x16x32_bf16 a[136:139], v[80:83], v[136:139], a[136:139]
  ds_read_b64_tr_b16 v[118:119], v14 offset:1536
  v_mfma_f32_16x16x32_bf16 a[140:143], v[80:83], v[140:143], a[140:143]
  v_mfma_f32_16x16x32_bf16 a[144:147], v[80:83], v[144:147], a[144:147]
  ds_read_b128 v[52:55], v12 offset:5120
  v_mfma_f32_16x16x32_bf16 a[148:151], v[80:83], v[148:151], a[148:151]
  v_mfma_f32_16x16x32_bf16 a[152:155], v[80:83], v[152:155], a[152:155]
  ds_read_b64_tr_b16 v[120:121], v13 offset:768
  v_mfma_f32_16x16x32_bf16 a[156:159], v[80:83], v[156:159], a[156:159]
  buffer_load_dwordx4 v10, s[36:39], s27 offen offset:2048 lds
  v_mfma_f32_16x16x32_bf16 a[160:163], v[84:87], v[128:131], a[160:163]
  ds_read_b64_tr_b16 v[122:123], v13 offset:1792
  v_mfma_f32_16x16x32_bf16 a[164:167], v[84:87], v[132:135], a[164:167]
  v_mfma_f32_16x16x32_bf16 a[168:171], v[84:87], v[136:139], a[168:171]
  ds_read_b128 v[56:59], v12 offset:6144
  v_mfma_f32_16x16x32_bf16 a[172:175], v[84:87], v[140:143], a[172:175]
  v_mfma_f32_16x16x32_bf16 a[176:179], v[84:87], v[144:147], a[176:179]
  ds_read_b64_tr_b16 v[124:125], v14 offset:768
  v_mfma_f32_16x16x32_bf16 a[180:183], v[84:87], v[148:151], a[180:183]
  buffer_load_dwordx4 v11, s[36:39], s27 offen offset:3072 lds
  v_mfma_f32_16x16x32_bf16 a[184:187], v[84:87], v[152:155], a[184:187]
  ds_read_b64_tr_b16 v[126:127], v14 offset:1792
  v_mfma_f32_16x16x32_bf16 a[188:191], v[84:87], v[156:159], a[188:191]
  v_mfma_f32_16x16x32_bf16 a[192:195], v[88:91], v[128:131], a[192:195]
  s_add_u32 s26, s26, 64
  ds_read_b128 v[60:63], v12 offset:7168
  v_mfma_f32_16x16x32_bf16 a[196:199], v[88:91], v[132:135], a[196:199]
  s_add_u32 s27, s27, 262144
  v_mfma_f32_16x16x32_bf16 a[200:203], v[88:91], v[136:139], a[200:203]
  s_add_u32 s24, s24, 32768
  v_mfma_f32_16x16x32_bf16 a[204:207], v[88:91], v[140:143], a[204:207]
  s_and_b32 s24, s24, 0x1ffff
  v_mfma_f32_16x16x32_bf16 a[208:211], v[88:91], v[144:147], a[208:211]
  v_mfma_f32_16x16x32_bf16 a[212:215], v[88:91], v[148:151], a[212:215]
  v_mfma_f32_16x16x32_bf16 a[216:219], v[88:91], v[152:155], a[216:219]
  s_add_u32 s28, s28, 1
  v_mfma_f32_16x16x32_bf16 a[220:223], v[88:91], v[156:159], a[220:223]
  s_cmp_ge_u32 s28, 6
  v_mfma_f32_16x16x32_bf16 a[224:227], v[92:95], v[128:131], a[224:227]
  s_cselect_b32 s34, 0, s34
  v_mfma_f32_16x16x32_bf16 a[228:231], v[92:95], v[132:135], a[228:231]
  s_cselect_b32 s38, 0, s38
  v_mfma_f32_16x16x32_bf16 a[232:235], v[92:95], v[136:139], a[232:235]
  v_mfma_f32_16x16x32_bf16 a[236:239], v[92:95], v[140:143], a[236:239]
  v_mfma_f32_16x16x32_bf16 a[240:243], v[92:95], v[144:147], a[240:243]
  v_mfma_f32_16x16x32_bf16 a[244:247], v[92:95], v[148:151], a[244:247]
  s_cmp_lt_u32 s28, 8
  v_mfma_f32_16x16x32_bf16 a[248:251], v[92:95], v[152:155], a[248:251]
  s_waitcnt lgkmcnt(0)
  v_mfma_f32_16x16x32_bf16 a[252:255], v[92:95], v[156:159], a[252:255]
  s_cbranch_scc1 k1_loopV
  s_mov_b32 s60, 8192
  s_mov_b32 s61, 2048
  s_mov_b32 s62, 33554432
k1_epi:
  s_lshl_b32 s23, s21, 19
  s_add_u32 s62, s62, s23
  s_lshl_b32 s23, s22, 16
  s_add_u32 s62, s62, s23
  s_and_b32 s23, s20, 1
  s_lshl_b32 s23, s23, 15
  s_add_u32 s62, s62, s23
  s_nop 4
  s_mov_b32 s63, s62
  s_add_u32 s62, s62, s60
  v_accvgpr_read_b32 v36, a0
  v_accvgpr_read_b32 v37, a1
  v_accvgpr_read_b32 v38, a2
  v_accvgpr_read_b32 v39, a3
  v_accvgpr_read_b32 v40, a32
  v_accvgpr_read_b32 v41, a33
  v_accvgpr_read_b32 v42, a34
  v_accvgpr_read_b32 v43, a35
  v_cvt_pk_bf16_f32 v32, v36, v37
  v_cvt_pk_bf16_f32 v33, v38, v39
  v_cvt_pk_bf16_f32 v34, v40, v41
  v_cvt_pk_bf16_f32 v35, v42, v43
  buffer_store_dwordx4 v[32:35], v15, s[40:43], s63 offen offset:0
  v_accvgpr_read_b32 v48, a4
  v_accvgpr_read_b32 v49, a5
  v_accvgpr_read_b32 v50, a6
  v_accvgpr_read_b32 v51, a7
  v_accvgpr_read_b32 v52, a36
  v_accvgpr_read_b32 v53, a37
  v_accvgpr_read_b32 v54, a38
  v_accvgpr_read_b32 v55, a39
  v_cvt_pk_bf16_f32 v44, v48, v49
  v_cvt_pk_bf16_f32 v45, v50, v51
  v_cvt_pk_bf16_f32 v46, v52, v53
  v_cvt_pk_bf16_f32 v47, v54, v55
  buffer_store_dwordx4 v[44:47], v15, s[40:43], s63 offen offset:1024
  s_add_u32 s63, s63, s61
  v_accvgpr_read_b32 v60, a8
  v_accvgpr_read_b32 v61, a9
  v_accvgpr_read_b32 v62, a10
  v_accvgpr_read_b32 v63, a11
  v_accvgpr_read_b32 v64, a40
  v_accvgpr_read_b32 v65, a41
  v_accvgpr_read_b32 v66, a42
  v_accvgpr_read_b32 v67, a43
  v_cvt_pk_bf16_f32 v56, v60, v61
  v_cvt_pk_bf16_f32 v57, v62, v63
  v_cvt_pk_bf16_f32 v58, v64, v65
  v_cvt_pk_bf16_f32 v59, v66, v67
  buffer_store_dwordx4 v[56:59], v15, s[40:43], s63 offen offset:0
  v_accvgpr_read_b32 v72, a12
  v_accvgpr_read_b32 v73, a13
  v_accvgpr_read_b32 v74, a14
  v_accvgpr_read_b32 v75, a15
  v_accvgpr_read_b32 v76, a44
  v_accvgpr_read_b32 v77, a45
  v_accvgpr_read_b32 v78, a46
  v_accvgpr_read_b32 v79, a47
  v_cvt_pk_bf16_f32 v68, v72, v73
  v_cvt_pk_bf16_f32 v69, v74, v75
  v_cvt_pk_bf16_f32 v70, v76, v77
  v_cvt_pk_bf16_f32 v71, v78, v79
  buffer_store_dwordx4 v[68:71], v15, s[40:43], s63 offen offset:1024
  s_add_u32 s63, s63, s61
  v_accvgpr_read_b32 v84, a16
  v_accvgpr_read_b32 v85, a17
  v_accvgpr_read_b32 v86, a18
  v_accvgpr_read_b32 v87, a19
  v_accvgpr_read_b32 v88, a48
  v_accvgpr_read_b32 v89, a49
  v_accvgpr_read_b32 v90, a50
  v_accvgpr_read_b32 v91, a51
  v_cvt_pk_bf16_f32 v80, v84, v85
  v_cvt_pk_bf16_f32 v81, v86, v87
  v_cvt_pk_bf16_f32 v82, v88, v89
  v_cvt_pk_bf16_f32 v83, v90, v91
  buffer_store_dwordx4 v[80:83], v15, s[40:43], s63 offen offset:0
  v_accvgpr_read_b32 v96, a20
  v_accvgpr_read_b32 v97, a21
  v_accvgpr_read_b32 v98, a22
  v_accvgpr_read_b32 v99, a23
  v_accvgpr_read_b32 v100, a52
  v_accvgpr_read_b32 v101, a53
  v_accvgpr_read_b32 v102, a54
  v_accvgpr_read_b32 v103, a55
  v_cvt_pk_bf16_f32 v92, v96, v97
  v_cvt_pk_bf16_f32 v93, v98, v99
  v_cvt_pk_bf16_f32 v94, v100, v101
  v_cvt_pk_bf16_f32 v95, v102, v103
  buffer_store_dwordx4 v[92:95], v15, s[40:43], s63 offen offset:1024
  s_add_u32 s63, s63, s61
  v_accvgpr_read_b32 v108, a24
  v_accvgpr_read_b32 v109, a25
  v_accvgpr_read_b32 v110, a26
  v_accvgpr_read_b32 v111, a27
  v_accvgpr_read_b32 v112, a56
  v_accvgpr_read_b32 v113, a57
  v_accvgpr_read_b32 v114, a58
  v_accvgpr_read_b32 v115, a59
  v_cvt_pk_bf16_f32 v104, v108, v109
  v_cvt_pk_bf16_f32 v105, v110, v111
  v_cvt_pk_bf16_f32 v106, v112, v113
  v_cvt_pk_bf16_f32 v107, v114, v115
  buffer_store_dwordx4 v[104:107], v15, s[40:43], s63 offen offset:0
  v_accvgpr_read_b32 v120, a28
  v_accvgpr_read_b32 v121, a29
  v_accvgpr_read_b32 v122, a30
  v_accvgpr_read_b32 v123, a31
  v_accvgpr_read_b32 v124, a60
  v_accvgpr_read_b32 v125, a61
  v_accvgpr_read_b32 v126, a62
  v_accvgpr_read_b32 v127, a63
  v_cvt_pk_bf16_f32 v116, v120, v121
  v_cvt_pk_bf16_f32 v117, v122, v123
  v_cvt_pk_bf16_f32 v118, v124, v125
  v_cvt_pk_bf16_f32 v119, v126, v127
  buffer_store_dwordx4 v[116:119], v15, s[40:43], s63 offen offset:1024
  s_mov_b32 s63, s62
  s_add_u32 s62, s62, s60
  v_accvgpr_read_b32 v36, a64
  v_accvgpr_read_b32 v37, a65
  v_accvgpr_read_b32 v38, a66
  v_accvgpr_read_b32 v39, a67
  v_accvgpr_read_b32 v40, a96
  v_accvgpr_read_b32 v41, a97
  v_accvgpr_read_b32 v42, a98
  v_accvgpr_read_b32 v43, a99
  v_cvt_pk_bf16_f32 v32, v36, v37
  v_cvt_pk_bf16_f32 v33, v38, v39
  v_cvt_pk_bf16_f32 v34, v40, v41
  v_cvt_pk_bf16_f32 v35, v42, v43
  buffer_store_dwordx4 v[32:35], v15, s[40:43], s63 offen offset:0
  v_accvgpr_read_b32 v48, a68
  v_accvgpr_read_b32 v49, a69
  v_accvgpr_read_b32 v50, a70
  v_accvgpr_read_b32 v51, a71
  v_accvgpr_read_b32 v52, a100
  v_accvgpr_read_b32 v53, a101
  v_accvgpr_read_b32 v54, a102
  v_accvgpr_read_b32 v55, a103
  v_cvt_pk_bf16_f32 v44, v48, v49
  v_cvt_pk_bf16_f32 v45, v50, v51
  v_cvt_pk_bf16_f32 v46, v52, v53
  v_cvt_pk_bf16_f32 v47, v54, v55
  buffer_store_dwordx4 v[44:47], v15, s[40:43], s63 offen offset:1024
  s_add_u32 s63, s63, s61
  v_accvgpr_read_b32 v60, a72
  v_accvgpr_read_b32 v61, a73
  v_accvgpr_read_b32 v62, a74
  v_accvgpr_read_b32 v63, a75
  v_accvgpr_read_b32 v64, a104
  v_accvgpr_read_b32 v65, a105
  v_accvgpr_read_b32 v66, a106
  v_accvgpr_read_b32 v67, a107
  v_cvt_pk_bf16_f32 v56, v60, v61
  v_cvt_pk_bf16_f32 v57, v62, v63
  v_cvt_pk_bf16_f32 v58, v64, v65
  v_cvt_pk_bf16_f32 v59, v66, v67
  buffer_store_dwordx4 v[56:59], v15, s[40:43], s63 offen offset:0
  v_accvgpr_read_b32 v72, a76
  v_accvgpr_read_b32 v73, a77
  v_accvgpr_read_b32 v74, a78
  v_accvgpr_read_b32 v75, a79
  v_accvgpr_read_b32 v76, a108
  v_accvgpr_read_b32 v77, a109
  v_accvgpr_read_b32 v78, a110
  v_accvgpr_read_b32 v79, a111
  v_cvt_pk_bf16_f32 v68, v72, v73
  v_cvt_pk_bf16_f32 v69, v74, v75
  v_cvt_pk_bf16_f32 v70, v76, v77
  v_cvt_pk_bf16_f32 v71, v78, v79
  buffer_store_dwordx4 v[68:71], v15, s[40:43], s63 offen offset:1024
  s_add_u32 s63, s63, s61
  v_accvgpr_read_b32 v84, a80
  v_accvgpr_read_b32 v85, a81
  v_accvgpr_read_b32 v86, a82
  v_accvgpr_read_b32 v87, a83
  v_accvgpr_read_b32 v88, a112
  v_accvgpr_read_b32 v89, a113
  v_accvgpr_read_b32 v90, a114
  v_accvgpr_read_b32 v91, a115
  v_cvt_pk_bf16_f32 v80, v84, v85
  v_cvt_pk_bf16_f32 v81, v86, v87
  v_cvt_pk_bf16_f32 v82, v88, v89
  v_cvt_pk_bf16_f32 v83, v90, v91
  buffer_store_dwordx4 v[80:83], v15, s[40:43], s63 offen offset:0
  v_accvgpr_read_b32 v96, a84
  v_accvgpr_read_b32 v97, a85
  v_accvgpr_read_b32 v98, a86
  v_accvgpr_read_b32 v99, a87
  v_accvgpr_read_b32 v100, a116
  v_accvgpr_read_b32 v101, a117
  v_accvgpr_read_b32 v102, a118
  v_accvgpr_read_b32 v103, a119
  v_cvt_pk_bf16_f32 v92, v96, v97
  v_cvt_pk_bf16_f32 v93, v98, v99
  v_cvt_pk_bf16_f32 v94, v100, v101
  v_cvt_pk_bf16_f32 v95, v102, v103
  buffer_store_dwordx4 v[92:95], v15, s[40:43], s63 offen offset:1024
  s_add_u32 s63, s63, s61
  v_accvgpr_read_b32 v108, a88
  v_accvgpr_read_b32 v109, a89
  v_accvgpr_read_b32 v110, a90
  v_accvgpr_read_b32 v111, a91
  v_accvgpr_read_b32 v112, a120
  v_accvgpr_read_b32 v113, a121
  v_accvgpr_read_b32 v114, a122
  v_accvgpr_read_b32 v115, a123
  v_cvt_pk_bf16_f32 v104, v108, v109
  v_cvt_pk_bf16_f32 v105, v110, v111
  v_cvt_pk_bf16_f32 v106, v112, v113
  v_cvt_pk_bf16_f32 v107, v114, v115
  buffer_store_dwordx4 v[104:107], v15, s[40:43], s63 offen offset:0
  v_accvgpr_read_b32 v120, a92
  v_accvgpr_read_b32 v121, a93
  v_accvgpr_read_b32 v122, a94
  v_accvgpr_read_b32 v123, a95
  v_accvgpr_read_b32 v124, a124
  v_accvgpr_read_b32 v125, a125
  v_accvgpr_read_b32 v126, a126
  v_accvgpr_read_b32 v127, a127
  v_cvt_pk_bf16_f32 v116, v120, v121
  v_cvt_pk_bf16_f32 v117, v122, v123
  v_cvt_pk_bf16_f32 v118, v124, v125
  v_cvt_pk_bf16_f32 v119, v126, v127
  buffer_store_dwordx4 v[116:119], v15, s[40:43], s63 offen offset:1024
  s_mov_b32 s63, s62
  s_add_u32 s62, s62, s60
  v_accvgpr_read_b32 v36, a128
  v_accvgpr_read_b32 v37, a129
  v_accvgpr_read_b32 v38, a130
  v_accvgpr_read_b32 v39, a131
  v_accvgpr_read_b32 v40, a160
  v_accvgpr_read_b32 v41, a161
  v_accvgpr_read_b32 v42, a162
  v_accvgpr_read_b32 v43, a163
  v_cvt_pk_bf16_f32 v32, v36, v37
  v_cvt_pk_bf16_f32 v33, v38, v39
  v_cvt_pk_bf16_f32 v34, v40, v41
  v_cvt_pk_bf16_f32 v35, v42, v43
  buffer_store_dwordx4 v[32:35], v15, s[40:43], s63 offen offset:0
  v_accvgpr_read_b32 v48, a132
  v_accvgpr_read_b32 v49, a133
  v_accvgpr_read_b32 v50, a134
  v_accvgpr_read_b32 v51, a135
  v_accvgpr_read_b32 v52, a164
  v_accvgpr_read_b32 v53, a165
  v_accvgpr_read_b32 v54, a166
  v_accvgpr_read_b32 v55, a167
  v_cvt_pk_bf16_f32 v44, v48, v49
  v_cvt_pk_bf16_f32 v45, v50, v51
  v_cvt_pk_bf16_f32 v46, v52, v53
  v_cvt_pk_bf16_f32 v47, v54, v55
  buffer_store_dwordx4 v[44:47], v15, s[40:43], s63 offen offset:1024
  s_add_u32 s63, s63, s61
  v_accvgpr_read_b32 v60, a136
  v_accvgpr_read_b32 v61, a137
  v_accvgpr_read_b32 v62, a138
  v_accvgpr_read_b32 v63, a139
  v_accvgpr_read_b32 v64, a168
  v_accvgpr_read_b32 v65, a169
  v_accvgpr_read_b32 v66, a170
  v_accvgpr_read_b32 v67, a171
  v_cvt_pk_bf16_f32 v56, v60, v61
  v_cvt_pk_bf16_f32 v57, v62, v63
  v_cvt_pk_bf16_f32 v58, v64, v65
  v_cvt_pk_bf16_f32 v59, v66, v67
  buffer_store_dwordx4 v[56:59], v15, s[40:43], s63 offen offset:0
  v_accvgpr_read_b32 v72, a140
  v_accvgpr_read_b32 v73, a141
  v_accvgpr_read_b32 v74, a142
  v_accvgpr_read_b32 v75, a143
  v_accvgpr_read_b32 v76, a172
  v_accvgpr_read_b32 v77, a173
  v_accvgpr_read_b32 v78, a174
  v_accvgpr_read_b32 v79, a175
  v_cvt_pk_bf16_f32 v68, v72, v73
  v_cvt_pk_bf16_f32 v69, v74, v75
  v_cvt_pk_bf16_f32 v70, v76, v77
  v_cvt_pk_bf16_f32 v71, v78, v79
  buffer_store_dwordx4 v[68:71], v15, s[40:43], s63 offen offset:1024
  s_add_u32 s63, s63, s61
  v_accvgpr_read_b32 v84, a144
  v_accvgpr_read_b32 v85, a145
  v_accvgpr_read_b32 v86, a146
  v_accvgpr_read_b32 v87, a147
  v_accvgpr_read_b32 v88, a176
  v_accvgpr_read_b32 v89, a177
  v_accvgpr_read_b32 v90, a178
  v_accvgpr_read_b32 v91, a179
  v_cvt_pk_bf16_f32 v80, v84, v85
  v_cvt_pk_bf16_f32 v81, v86, v87
  v_cvt_pk_bf16_f32 v82, v88, v89
  v_cvt_pk_bf16_f32 v83, v90, v91
  buffer_store_dwordx4 v[80:83], v15, s[40:43], s63 offen offset:0
  v_accvgpr_read_b32 v96, a148
  v_accvgpr_read_b32 v97, a149
  v_accvgpr_read_b32 v98, a150
  v_accvgpr_read_b32 v99, a151
  v_accvgpr_read_b32 v100, a180
  v_accvgpr_read_b32 v101, a181
  v_accvgpr_read_b32 v102, a182
  v_accvgpr_read_b32 v103, a183
  v_cvt_pk_bf16_f32 v92, v96, v97
  v_cvt_pk_bf16_f32 v93, v98, v99
  v_cvt_pk_bf16_f32 v94, v100, v101
  v_cvt_pk_bf16_f32 v95, v102, v103
  buffer_store_dwordx4 v[92:95], v15, s[40:43], s63 offen offset:1024
  s_add_u32 s63, s63, s61
  v_accvgpr_read_b32 v108, a152
  v_accvgpr_read_b32 v109, a153
  v_accvgpr_read_b32 v110, a154
  v_accvgpr_read_b32 v111, a155
  v_accvgpr_read_b32 v112, a184
  v_accvgpr_read_b32 v113, a185
  v_accvgpr_read_b32 v114, a186
  v_accvgpr_read_b32 v115, a187
  v_cvt_pk_bf16_f32 v104, v108, v109
  v_cvt_pk_bf16_f32 v105, v110, v111
  v_cvt_pk_bf16_f32 v106, v112, v113
  v_cvt_pk_bf16_f32 v107, v114, v115
  buffer_store_dwordx4 v[104:107], v15, s[40:43], s63 offen offset:0
  v_accvgpr_read_b32 v120, a156
  v_accvgpr_read_b32 v121, a157
  v_accvgpr_read_b32 v122, a158
  v_accvgpr_read_b32 v123, a159
  v_accvgpr_read_b32 v124, a188
  v_accvgpr_read_b32 v125, a189
  v_accvgpr_read_b32 v126, a190
  v_accvgpr_read_b32 v127, a191
  v_cvt_pk_bf16_f32 v116, v120, v121
  v_cvt_pk_bf16_f32 v117, v122, v123
  v_cvt_pk_bf16_f32 v118, v124, v125
  v_cvt_pk_bf16_f32 v119, v126, v127
  buffer_store_dwordx4 v[116:119], v15, s[40:43], s63 offen offset:1024
  s_mov_b32 s63, s62
  s_add_u32 s62, s62, s60
  v_accvgpr_read_b32 v36, a192
  v_accvgpr_read_b32 v37, a193
  v_accvgpr_read_b32 v38, a194
  v_accvgpr_read_b32 v39, a195
  v_accvgpr_read_b32 v40, a224
  v_accvgpr_read_b32 v41, a225
  v_accvgpr_read_b32 v42, a226
  v_accvgpr_read_b32 v43, a227
  v_cvt_pk_bf16_f32 v32, v36, v37
  v_cvt_pk_bf16_f32 v33, v38, v39
  v_cvt_pk_bf16_f32 v34, v40, v41
  v_cvt_pk_bf16_f32 v35, v42, v43
  buffer_store_dwordx4 v[32:35], v15, s[40:43], s63 offen offset:0
  v_accvgpr_read_b32 v48, a196
  v_accvgpr_read_b32 v49, a197
  v_accvgpr_read_b32 v50, a198
  v_accvgpr_read_b32 v51, a199
  v_accvgpr_read_b32 v52, a228
  v_accvgpr_read_b32 v53, a229
  v_accvgpr_read_b32 v54, a230
  v_accvgpr_read_b32 v55, a231
  v_cvt_pk_bf16_f32 v44, v48, v49
  v_cvt_pk_bf16_f32 v45, v50, v51
  v_cvt_pk_bf16_f32 v46, v52, v53
  v_cvt_pk_bf16_f32 v47, v54, v55
  buffer_store_dwordx4 v[44:47], v15, s[40:43], s63 offen offset:1024
  s_add_u32 s63, s63, s61
  v_accvgpr_read_b32 v60, a200
  v_accvgpr_read_b32 v61, a201
  v_accvgpr_read_b32 v62, a202
  v_accvgpr_read_b32 v63, a203
  v_accvgpr_read_b32 v64, a232
  v_accvgpr_read_b32 v65, a233
  v_accvgpr_read_b32 v66, a234
  v_accvgpr_read_b32 v67, a235
  v_cvt_pk_bf16_f32 v56, v60, v61
  v_cvt_pk_bf16_f32 v57, v62, v63
  v_cvt_pk_bf16_f32 v58, v64, v65
  v_cvt_pk_bf16_f32 v59, v66, v67
  buffer_store_dwordx4 v[56:59], v15, s[40:43], s63 offen offset:0
  v_accvgpr_read_b32 v72, a204
  v_accvgpr_read_b32 v73, a205
  v_accvgpr_read_b32 v74, a206
  v_accvgpr_read_b32 v75, a207
  v_accvgpr_read_b32 v76, a236
  v_accvgpr_read_b32 v77, a237
  v_accvgpr_read_b32 v78, a238
  v_accvgpr_read_b32 v79, a239
  v_cvt_pk_bf16_f32 v68, v72, v73
  v_cvt_pk_bf16_f32 v69, v74, v75
  v_cvt_pk_bf16_f32 v70, v76, v77
  v_cvt_pk_bf16_f32 v71, v78, v79
  buffer_store_dwordx4 v[68:71], v15, s[40:43], s63 offen offset:1024
  s_add_u32 s63, s63, s61
  v_accvgpr_read_b32 v84, a208
  v_accvgpr_read_b32 v85, a209
  v_accvgpr_read_b32 v86, a210
  v_accvgpr_read_b32 v87, a211
  v_accvgpr_read_b32 v88, a240
  v_accvgpr_read_b32 v89, a241
  v_accvgpr_read_b32 v90, a242
  v_accvgpr_read_b32 v91, a243
  v_cvt_pk_bf16_f32 v80, v84, v85
  v_cvt_pk_bf16_f32 v81, v86, v87
  v_cvt_pk_bf16_f32 v82, v88, v89
  v_cvt_pk_bf16_f32 v83, v90, v91
  buffer_store_dwordx4 v[80:83], v15, s[40:43], s63 offen offset:0
  v_accvgpr_read_b32 v96, a212
  v_accvgpr_read_b32 v97, a213
  v_accvgpr_read_b32 v98, a214
  v_accvgpr_read_b32 v99, a215
  v_accvgpr_read_b32 v100, a244
  v_accvgpr_read_b32 v101, a245
  v_accvgpr_read_b32 v102, a246
  v_accvgpr_read_b32 v103, a247
  v_cvt_pk_bf16_f32 v92, v96, v97
  v_cvt_pk_bf16_f32 v93, v98, v99
  v_cvt_pk_bf16_f32 v94, v100, v101
  v_cvt_pk_bf16_f32 v95, v102, v103
  buffer_store_dwordx4 v[92:95], v15, s[40:43], s63 offen offset:1024
  s_add_u32 s63, s63, s61
  v_accvgpr_read_b32 v108, a216
  v_accvgpr_read_b32 v109, a217
  v_accvgpr_read_b32 v110, a218
  v_accvgpr_read_b32 v111, a219
  v_accvgpr_read_b32 v112, a248
  v_accvgpr_read_b32 v113, a249
  v_accvgpr_read_b32 v114, a250
  v_accvgpr_read_b32 v115, a251
  v_cvt_pk_bf16_f32 v104, v108, v109
  v_cvt_pk_bf16_f32 v105, v110, v111
  v_cvt_pk_bf16_f32 v106, v112, v113
  v_cvt_pk_bf16_f32 v107, v114, v115
  buffer_store_dwordx4 v[104:107], v15, s[40:43], s63 offen offset:0
  v_accvgpr_read_b32 v120, a220
  v_accvgpr_read_b32 v121, a221
  v_accvgpr_read_b32 v122, a222
  v_accvgpr_read_b32 v123, a223
  v_accvgpr_read_b32 v124, a252
  v_accvgpr_read_b32 v125, a253
  v_accvgpr_read_b32 v126, a254
  v_accvgpr_read_b32 v127, a255
  v_cvt_pk_bf16_f32 v116, v120, v121
  v_cvt_pk_bf16_f32 v117, v122, v123
  v_cvt_pk_bf16_f32 v118, v124, v125
  v_cvt_pk_bf16_f32 v119, v126, v127
  buffer_store_dwordx4 v[116:119], v15, s[40:43], s63 offen offset:1024
  v_lshrrev_b32 v16, 2, v1
  v_mul_u32_u24 v16, 160, v16
  v_and_b32 v17, 3, v1
  v_lshl_add_u32 v16, v17, 3, v16
  v_add_u32 v16, s31, v16
  ds_read_b64_tr_b16 v[160:161], v16 offset:0
  ds_read_b64_tr_b16 v[162:163], v16 offset:2560
  ds_read_b64_tr_b16 v[164:165], v16 offset:32
  ds_read_b64_tr_b16 v[166:167], v16 offset:2592
  ds_read_b64_tr_b16 v[168:169], v16 offset:64
  ds_read_b64_tr_b16 v[170:171], v16 offset:2624
  ds_read_b64_tr_b16 v[172:173], v16 offset:96
  ds_read_b64_tr_b16 v[174:175], v16 offset:2656
  ds_read_b64_tr_b16 v[176:177], v16 offset:128
  ds_read_b64_tr_b16 v[178:179], v16 offset:2688
  s_lshl_b32 s23, s29, 7
  s_add_u32 s23, s23, s30
  s_mul_i32 s23, s23, 5120
  s_add_u32 s23, s23, 4194304
  s_add_u32 s31, s23, 4096
  s_waitcnt lgkmcnt(0)
  buffer_store_dwordx4 v[160:163], v15, s[40:43], s23 offen offset:0
  buffer_store_dwordx4 v[164:167], v15, s[40:43], s23 offen offset:1024
  buffer_store_dwordx4 v[168:171], v15, s[40:43], s23 offen offset:2048
  buffer_store_dwordx4 v[172:175], v15, s[40:43], s23 offen offset:3072
  buffer_store_dwordx4 v[176:179], v15, s[40:43], s31 offen offset:0
k1_end:
  s_endpgm
.section .rodata,"a"
.p2align 6
.amdhsa_kernel k1_kernel
  .amdhsa_next_free_vgpr 512
  .amdhsa_next_free_sgpr 102
  .amdhsa_accum_offset 256
  .amdhsa_group_segment_fixed_size 0
  .amdhsa_kernarg_size 112
  .amdhsa_user_sgpr_count 2
  .amdhsa_user_sgpr_kernarg_segment_ptr 1
  .amdhsa_system_sgpr_workgroup_id_x 1
  .amdhsa_float_denorm_mode_32 3
.end_amdhsa_kernel
.text
.globl k2_kernel
.p2align 8
.type k2_kernel,@function
k2_kernel:
  s_cmp_ge_u32 s2, 256
  s_cbranch_scc1 k2_end
  s_load_dwordx2 s[4:5], s[0:1], 16
  s_load_dwordx2 s[16:17], s[0:1], 104
  v_lshrrev_b32 v16, 6, v0
  v_and_b32 v1, 63, v0
  v_readfirstlane_b32 s20, v16
  s_and_b32 s21, s2, 7
  s_lshl_b32 s21, s21, 2
  s_lshr_b32 s23, s2, 3
  s_and_b32 s23, s23, 3
  s_add_u32 s21, s21, s23
  s_lshr_b32 s22, s2, 5
  v_lshlrev_b32 v2, 4, v1
  v_bfe_u32 v16, v1, 2, 2
  v_lshrrev_b32 v17, 4, v1
  v_lshlrev_b32 v17, 6, v17
  v_lshl_add_u32 v16, v16, 13, v17
  s_lshl_b32 s23, s20, 17
  v_add_u32 v16, s23, v16
  v_and_b32 v18, 3, v1
  v_lshl_add_u32 v8, v18, 4, v16
  v_xor_b32 v18, 2, v18
  v_lshl_add_u32 v10, v18, 4, v16
  v_add_u32 v9, 31744, v8
  v_add_u32 v11, 95232, v10
  v_add_u32 v10, 63488, v10
  s_lshl_b32 s23, s22, 2
  s_add_u32 s23, s23, s20
  s_mul_i32 s64, s23, 40960
  s_add_u32 s65, s64, 20480
  s_sub_u32 s30, 15, s22
  s_lshl_b32 s23, s30, 2
  s_add_u32 s23, s23, s20
  s_mul_i32 s66, s23, 40960
  s_add_u32 s67, s66, 20480
  s_waitcnt lgkmcnt(0)
  s_lshl_b32 s23, s21, 8
  s_add_u32 s4, s4, s23
  s_addc_u32 s5, s5, 0
  s_mov_b32 s32, s4
  s_mov_b32 s33, s5
  s_mov_b32 s34, 0
  s_mov_b32 s35, 0x20000
  s_sub_u32 s34, 5242880, s23
  s_mov_b32 s36, s16
  s_mov_b32 s37, s17
  s_mov_b32 s38, 2621440
  s_mov_b32 s39, 0x20000
  s_mov_b32 s40, s16
  s_mov_b32 s41, s17
  s_mov_b32 s42, 67108864
  s_mov_b32 s43, 0x20000
  s_lshl_b32 s24, s20, 12
  s_add_u32 s24, s24, 16384
  s_mov_b32 s26, 0
  s_mov_b32 m0, s24
  s_nop 0
  buffer_load_dwordx4 v8, s[32:35], s26 offen offset:0 lds
  buffer_load_dwordx4 v9, s[32:35], s26 offen offset:1024 lds
  buffer_load_dwordx4 v10, s[32:35], s26 offen offset:2048 lds
  buffer_load_dwordx4 v11, s[32:35], s26 offen offset:3072 lds
  s_add_u32 s26, s26, 524288
  s_add_u32 s24, s24, 32768
  s_and_b32 s24, s24, 0x1ffff
  buffer_load_dwordx4 a[192:195], v2, s[36:39], s64 offen offset:0
  buffer_load_dwordx4 a[196:199], v2, s[36:39], s65 offen offset:0
  buffer_load_dwordx4 a[200:203], v2, s[36:39], s66 offen offset:0
  buffer_load_dwordx4 a[204:207], v2, s[36:39], s67 offen offset:0
  s_mov_b32 m0, s24
  s_nop 0
  buffer_load_dwordx4 v8, s[32:35], s26 offen offset:0 lds
  buffer_load_dwordx4 v9, s[32:35], s26 offen offset:1024 lds
  buffer_load_dwordx4 v10, s[32:35], s26 offen offset:2048 lds
  buffer_load_dwordx4 v11, s[32:35], s26 offen offset:3072 lds
  s_add_u32 s26, s26, 524288
  s_add_u32 s24, s24, 32768
  s_and_b32 s24, s24, 0x1ffff
  buffer_load_dwordx4 a[208:211], v2, s[36:39], s64 offen offset:1024
  buffer_load_dwordx4 a[212:215], v2, s[36:39], s65 offen offset:1024
  buffer_load_dwordx4 a[216:219], v2, s[36:39], s66 offen offset:1024
  buffer_load_dwordx4 a[220:223], v2, s[36:39], s67 offen offset:1024
  buffer_load_dwordx4 a[224:227], v2, s[36:39], s64 offen offset:2048
  buffer_load_dwordx4 a[228:231], v2, s[36:39], s65 offen offset:2048
  buffer_load_dwordx4 a[232:235], v2, s[36:39], s66 offen offset:2048
  buffer_load_dwordx4 a[236:239], v2, s[36:39], s67 offen offset:2048
  s_mov_b32 m0, s24
  s_nop 0
  buffer_load_dwordx4 v8, s[32:35], s26 offen offset:0 lds
  buffer_load_dwordx4 v9, s[32:35], s26 offen offset:1024 lds
  buffer_load_dwordx4 v10, s[32:35], s26 offen offset:2048 lds
  buffer_load_dwordx4 v11, s[32:35], s26 offen offset:3072 lds
  s_add_u32 s26, s26, 524288
  s_add_u32 s24, s24, 32768
  s_and_b32 s24, s24, 0x1ffff
  buffer_load_dwordx4 a[240:243], v2, s[36:39], s64 offen offset:3072
  buffer_load_dwordx4 a[244:247], v2, s[36:39], s65 offen offset:3072
  buffer_load_dwordx4 a[248:251], v2, s[36:39], s66 offen offset:3072
  buffer_load_dwordx4 a[252:255], v2, s[36:39], s67 offen offset:3072
  s_mov_b32 m0, s24
  s_nop 0
  buffer_load_dwordx4 v8, s[32:35], s26 offen offset:0 lds
  buffer_load_dwordx4 v9, s[32:35], s26 offen offset:1024 lds
  buffer_load_dwordx4 v10, s[32:35], s26 offen offset:2048 lds
  buffer_load_dwordx4 v11, s[32:35], s26 offen offset:3072 lds
  s_add_u32 s26, s26, 524288
  s_add_u32 s24, s24, 32768
  s_and_b32 s24, s24, 0x1ffff
  s_add_u32 s64, s64, 4096
  s_add_u32 s65, s65, 4096
  s_add_u32 s66, s66, 4096
  s_add_u32 s67, s67, 4096
  s_lshl_b32 s23, s21, 19
  s_add_u32 s23, s23, 16777216
  s_add_u32 s6, s16, s23
  s_addc_u32 s7, s17, 0
  s_add_u32 s8, s6, 16777216
  s_addc_u32 s9, s7, 0
  s_sub_u32 s23, 16, s22
  s_lshl_b32 s23, s23, 15
  s_mov_b32 s44, s6
  s_mov_b32 s45, s7
  s_mov_b32 s46, s23
  s_mov_b32 s47, 0x20000
  s_mov_b32 s48, s8
  s_mov_b32 s49, s9
  s_mov_b32 s50, s23
  s_mov_b32 s51, 0x20000
  v_mov_b32 v20, 0
  v_mov_b32 v21, 0
  v_mov_b32 v22, 0
  v_mov_b32 v23, 0
  v_bfe_u32 v18, v1, 2, 2
  v_lshlrev_b32 v18, 6, v18
  v_lshrrev_b32 v17, 4, v1
  v_lshl_add_u32 v18, v17, 11, v18
  v_and_b32 v19, 1, v1
  v_lshl_add_u32 v18, v19, 3, v18
  v_bfe_u32 v19, v1, 1, 1
  v_and_b32 v16, 1, v17
  v_lshl_or_b32 v19, v16, 1, v19
  v_add_u32 v18, 16384, v18
  v_lshl_add_u32 v12, v19, 4, v18
  v_xor_b32 v13, 32, v12
  v_mfma_f32_32x32x16_bf16 v[96:111], v[20:23], v[20:23], 0
  v_mfma_f32_32x32x16_bf16 v[112:127], v[20:23], v[20:23], 0
  v_mfma_f32_32x32x16_bf16 v[128:143], v[20:23], v[20:23], 0
  v_mfma_f32_32x32x16_bf16 v[144:159], v[20:23], v[20:23], 0
  v_mfma_f32_32x32x16_bf16 v[160:175], v[20:23], v[20:23], 0
  v_mfma_f32_32x32x16_bf16 v[176:191], v[20:23], v[20:23], 0
  v_mfma_f32_32x32x16_bf16 v[192:207], v[20:23], v[20:23], 0
  v_mfma_f32_32x32x16_bf16 v[208:223], v[20:23], v[20:23], 0
  v_mfma_f32_32x32x16_bf16 a[0:15], v[20:23], v[20:23], 0
  v_mfma_f32_32x32x16_bf16 a[16:31], v[20:23], v[20:23], 0
  v_mfma_f32_32x32x16_bf16 a[32:47], v[20:23], v[20:23], 0
  v_mfma_f32_32x32x16_bf16 a[48:63], v[20:23], v[20:23], 0
  v_mfma_f32_32x32x16_bf16 a[64:79], v[20:23], v[20:23], 0
  v_mfma_f32_32x32x16_bf16 a[80:95], v[20:23], v[20:23], 0
  v_mfma_f32_32x32x16_bf16 a[96:111], v[20:23], v[20:23], 0
  v_mfma_f32_32x32x16_bf16 a[112:127], v[20:23], v[20:23], 0
  v_and_b32 v16, 15, v1
  v_lshlrev_b32 v17, 2, v17
  v_sub_u32 v16, v16, v17
  v_cmp_le_i32 s[68:69], 0, v16
  v_cmp_le_i32 s[70:71], 1, v16
  v_cmp_le_i32 s[72:73], 2, v16
  v_cmp_le_i32 s[74:75], 3, v16
  v_mov_b32 v4, 0xff800000
  s_mov_b32 s81, 0x47800000
  v_mov_b32 v228, 0
  v_mov_b32 v229, 0
  v_mov_b32 v230, 0
  v_mov_b32 v231, 0
  s_waitcnt vmcnt(24)
  s_barrier
  ds_read_b64_tr_b16 v[32:33], v12 offset:0
  ds_read_b64_tr_b16 v[34:35], v12 offset:1024
  ds_read_b64_tr_b16 v[36:37], v13 offset:0
  ds_read_b64_tr_b16 v[38:39], v13 offset:1024
  ds_read_b64_tr_b16 v[40:41], v12 offset:256
  ds_read_b64_tr_b16 v[42:43], v12 offset:1280
  ds_read_b64_tr_b16 v[44:45], v13 offset:256
  ds_read_b64_tr_b16 v[46:47], v13 offset:1280
  ds_read_b64_tr_b16 v[48:49], v12 offset:512
  ds_read_b64_tr_b16 v[50:51], v12 offset:1536
  ds_read_b64_tr_b16 v[52:53], v13 offset:512
  ds_read_b64_tr_b16 v[54:55], v13 offset:1536
  ds_read_b64_tr_b16 v[56:57], v12 offset:768
  ds_read_b64_tr_b16 v[58:59], v12 offset:1792
  ds_read_b64_tr_b16 v[60:61], v13 offset:768
  ds_read_b64_tr_b16 v[62:63], v13 offset:1792
  s_mov_b32 s28, 0
  s_waitcnt lgkmcnt(0)
.p2align 6
k2_qloop:
  v_mfma_f32_16x16x32_bf16 v[96:99], v[32:35], a[192:195], v[96:99]
  v_mfma_f32_16x16x32_bf16 v[112:115], v[36:39], a[192:195], v[112:115]
  ds_read_b64_tr_b16 v[64:65], v12 offset:8192
  v_mfma_f32_16x16x32_bf16 v[128:131], v[40:43], a[192:195], v[128:131]
  ds_read_b64_tr_b16 v[66:67], v12 offset:9216
  v_mfma_f32_16x16x32_bf16 v[144:147], v[44:47], a[192:195], v[144:147]
  ds_read_b64_tr_b16 v[68:69], v13 offset:8192
  v_mfma_f32_16x16x32_bf16 v[160:163], v[48:51], a[192:195], v[160:163]
  ds_read_b64_tr_b16 v[70:71], v13 offset:9216
  v_mfma_f32_16x16x32_bf16 v[176:179], v[52:55], a[192:195], v[176:179]
  ds_read_b64_tr_b16 v[72:73], v12 offset:8448
  v_mfma_f32_16x16x32_bf16 v[192:195], v[56:59], a[192:195], v[192:195]
  ds_read_b64_tr_b16 v[74:75], v12 offset:9472
  v_mfma_f32_16x16x32_bf16 v[208:211], v[60:63], a[192:195], v[208:211]
  buffer_load_dwordx4 a[192:195], v2, s[36:39], s64 offen offset:0
  v_mfma_f32_16x16x32_bf16 v[100:103], v[32:35], a[196:199], v[100:103]
  ds_read_b64_tr_b16 v[76:77], v13 offset:8448
  v_mfma_f32_16x16x32_bf16 v[116:119], v[36:39], a[196:199], v[116:119]
  ds_read_b64_tr_b16 v[78:79], v13 offset:9472
  v_mfma_f32_16x16x32_bf16 v[132:135], v[40:43], a[196:199], v[132:135]
  ds_read_b64_tr_b16 v[80:81], v12 offset:8704
  v_mfma_f32_16x16x32_bf16 v[148:151], v[44:47], a[196:199], v[148:151]
  v_mfma_f32_16x16x32_bf16 v[164:167], v[48:51], a[196:199], v[164:167]
  ds_read_b64_tr_b16 v[82:83], v12 offset:9728
  v_mfma_f32_16x16x32_bf16 v[180:183], v[52:55], a[196:199], v[180:183]
  ds_read_b64_tr_b16 v[84:85], v13 offset:8704
  v_mfma_f32_16x16x32_bf16 v[196:199], v[56:59], a[196:199], v[196:199]
  ds_read_b64_tr_b16 v[86:87], v13 offset:9728
  v_mfma_f32_16x16x32_bf16 v[212:215], v[60:63], a[196:199], v[212:215]
  buffer_load_dwordx4 a[196:199], v2, s[36:39], s65 offen offset:0
  v_mfma_f32_16x16x32_bf16 v[104:107], v[32:35], a[200:203], v[104:107]
  ds_read_b64_tr_b16 v[88:89], v12 offset:8960
  v_mfma_f32_16x16x32_bf16 v[120:123], v[36:39], a[200:203], v[120:123]
  ds_read_b64_tr_b16 v[90:91], v12 offset:9984
  v_mfma_f32_16x16x32_bf16 v[136:139], v[40:43], a[200:203], v[136:139]
  ds_read_b64_tr_b16 v[92:93], v13 offset:8960
  v_mfma_f32_16x16x32_bf16 v[152:155], v[44:47], a[200:203], v[152:155]
  v_mfma_f32_16x16x32_bf16 v[168:171], v[48:51], a[200:203], v[168:171]
  ds_read_b64_tr_b16 v[94:95], v13 offset:9984
  v_mfma_f32_16x16x32_bf16 v[184:187], v[52:55], a[200:203], v[184:187]
  v_mfma_f32_16x16x32_bf16 v[200:203], v[56:59], a[200:203], v[200:203]
  v_mfma_f32_16x16x32_bf16 v[216:219], v[60:63], a[200:203], v[216:219]
  buffer_load_dwordx4 a[200:203], v2, s[36:39], s66 offen offset:0
  v_mfma_f32_16x16x32_bf16 v[108:111], v[32:35], a[204:207], v[108:111]
  v_mfma_f32_16x16x32_bf16 v[124:127], v[36:39], a[204:207], v[124:127]
  v_mfma_f32_16x16x32_bf16 v[140:143], v[40:43], a[204:207], v[140:143]
  v_mfma_f32_16x16x32_bf16 v[156:159], v[44:47], a[204:207], v[156:159]
  v_mfma_f32_16x16x32_bf16 v[172:175], v[48:51], a[204:207], v[172:175]
  v_mfma_f32_16x16x32_bf16 v[188:191], v[52:55], a[204:207], v[188:191]
  v_mfma_f32_16x16x32_bf16 v[204:207], v[56:59], a[204:207], v[204:207]
  v_mfma_f32_16x16x32_bf16 v[220:223], v[60:63], a[204:207], v[220:223]
  s_waitcnt vmcnt(15) lgkmcnt(0)
  buffer_load_dwordx4 a[204:207], v2, s[36:39], s67 offen offset:0
  v_mfma_f32_16x16x32_bf16 v[96:99], v[64:67], a[208:211], v[96:99]
  s_barrier
  v_mfma_f32_16x16x32_bf16 v[112:115], v[68:71], a[208:211], v[112:115]
  ds_read_b64_tr_b16 v[32:33], v12 offset:32768
  v_mfma_f32_16x16x32_bf16 v[128:131], v[72:75], a[208:211], v[128:131]
  ds_read_b64_tr_b16 v[34:35], v12 offset:33792
  v_mfma_f32_16x16x32_bf16 v[144:147], v[76:79], a[208:211], v[144:147]
  ds_read_b64_tr_b16 v[36:37], v13 offset:32768
  v_mfma_f32_16x16x32_bf16 v[160:163], v[80:83], a[208:211], v[160:163]
  ds_read_b64_tr_b16 v[38:39], v13 offset:33792
  v_mfma_f32_16x16x32_bf16 v[176:179], v[84:87], a[208:211], v[176:179]
  ds_read_b64_tr_b16 v[40:41], v12 offset:33024
  v_mfma_f32_16x16x32_bf16 v[192:195], v[88:91], a[208:211], v[192:195]
  ds_read_b64_tr_b16 v[42:43], v12 offset:34048
  v_mfma_f32_16x16x32_bf16 v[208:211], v[92:95], a[208:211], v[208:211]
  buffer_load_dwordx4 a[208:211], v2, s[36:39], s64 offen offset:1024
  v_mfma_f32_16x16x32_bf16 v[100:103], v[64:67], a[212:215], v[100:103]
  ds_read_b64_tr_b16 v[44:45], v13 offset:33024
  v_mfma_f32_16x16x32_bf16 v[116:119], v[68:71], a[212:215], v[116:119]
  ds_read_b64_tr_b16 v[46:47], v13 offset:34048
  v_mfma_f32_16x16x32_bf16 v[132:135], v[72:75], a[212:215], v[132:135]
  s_mov_b32 m0, s24
  ds_read_b64_tr_b16 v[48:49], v12 offset:33280
  v_mfma_f32_16x16x32_bf16 v[148:151], v[76:79], a[212:215], v[148:151]
  buffer_load_dwordx4 v8, s[32:35], s26 offen offset:0 lds
  v_mfma_f32_16x16x32_bf16 v[164:167], v[80:83], a[212:215], v[164:167]
  ds_read_b64_tr_b16 v[50:51], v12 offset:34304
  v_mfma_f32_16x16x32_bf16 v[180:183], v[84:87], a[212:215], v[180:183]
  ds_read_b64_tr_b16 v[52:53], v13 offset:33280
  v_mfma_f32_16x16x32_bf16 v[196:199], v[88:91], a[212:215], v[196:199]
  ds_read_b64_tr_b16 v[54:55], v13 offset:34304
  v_mfma_f32_16x16x32_bf16 v[212:215], v[92:95], a[212:215], v[212:215]
  buffer_load_dwordx4 a[212:215], v2, s[36:39], s65 offen offset:1024
  v_mfma_f32_16x16x32_bf16 v[104:107], v[64:67], a[216:219], v[104:107]
  ds_read_b64_tr_b16 v[56:57], v12 offset:33536
  v_mfma_f32_16x16x32_bf16 v[120:123], v[68:71], a[216:219], v[120:123]
  ds_read_b64_tr_b16 v[58:59], v12 offset:34560
  v_mfma_f32_16x16x32_bf16 v[136:139], v[72:75], a[216:219], v[136:139]
  ds_read_b64_tr_b16 v[60:61], v13 offset:33536
  v_mfma_f32_16x16x32_bf16 v[152:155], v[76:79], a[216:219], v[152:155]
  buffer_load_dwordx4 v9, s[32:35], s26 offen offset:1024 lds
  v_mfma_f32_16x16x32_bf16 v[168:171], v[80:83], a[216:219], v[168:171]
  ds_read_b64_tr_b16 v[62:63], v13 offset:34560
  v_mfma_f32_16x16x32_bf16 v[184:187], v[84:87], a[216:219], v[184:187]
  v_mfma_f32_16x16x32_bf16 v[200:203], v[88:91], a[216:219], v[200:203]
  buffer_load_dwordx4 v10, s[32:35], s26 offen offset:2048 lds
  v_mfma_f32_16x16x32_bf16 v[216:219], v[92:95], a[216:219], v[216:219]
  buffer_load_dwordx4 a[216:219], v2, s[36:39], s66 offen offset:1024
  v_mfma_f32_16x16x32_bf16 v[108:111], v[64:67], a[220:223], v[108:111]
  v_mfma_f32_16x16x32_bf16 v[124:127], v[68:71], a[220:223], v[124:127]
  v_mfma_f32_16x16x32_bf16 v[140:143], v[72:75], a[220:223], v[140:143]
  v_mfma_f32_16x16x32_bf16 v[156:159], v[76:79], a[220:223], v[156:159]
  buffer_load_dwordx4 v11, s[32:35], s26 offen offset:3072 lds
  v_mfma_f32_16x16x32_bf16 v[172:175], v[80:83], a[220:223], v[172:175]
  s_add_u32 s26, s26, 524288
  v_mfma_f32_16x16x32_bf16 v[188:191], v[84:87], a[220:223], v[188:191]
  s_add_u32 s24, s24, 32768
  v_mfma_f32_16x16x32_bf16 v[204:207], v[88:91], a[220:223], v[204:207]
  s_and_b32 s24, s24, 0x1ffff
  v_mfma_f32_16x16x32_bf16 v[220:223], v[92:95], a[220:223], v[220:223]
  s_waitcnt vmcnt(19) lgkmcnt(0)
  buffer_load_dwordx4 a[220:223], v2, s[36:39], s67 offen offset:1024
  v_mfma_f32_16x16x32_bf16 v[96:99], v[32:35], a[224:227], v[96:99]
  v_mfma_f32_16x16x32_bf16 v[112:115], v[36:39], a[224:227], v[112:115]
  ds_read_b64_tr_b16 v[64:65], v12 offset:40960
  v_mfma_f32_16x16x32_bf16 v[128:131], v[40:43], a[224:227], v[128:131]
  ds_read_b64_tr_b16 v[66:67], v12 offset:41984
  v_mfma_f32_16x16x32_bf16 v[144:147], v[44:47], a[224:227], v[144:147]
  ds_read_b64_tr_b16 v[68:69], v13 offset:40960
  v_mfma_f32_16x16x32_bf16 v[160:163], v[48:51], a[224:227], v[160:163]
  ds_read_b64_tr_b16 v[70:71], v13 offset:41984
  v_mfma_f32_16x16x32_bf16 v[176:179], v[52:55], a[224:227], v[176:179]
  ds_read_b64_tr_b16 v[72:73], v12 offset:41216
  v_mfma_f32_16x16x32_bf16 v[192:195], v[56:59], a[224:227], v[192:195]
  ds_read_b64_tr_b16 v[74:75], v12 offset:42240
  v_mfma_f32_16x16x32_bf16 v[208:211], v[60:63], a[224:227], v[208:211]
  buffer_load_dwordx4 a[224:227], v2, s[36:39], s64 offen offset:2048
  v_mfma_f32_16x16x32_bf16 v[100:103], v[32:35], a[228:231], v[100:103]
  ds_read_b64_tr_b16 v[76:77], v13 offset:41216
  v_mfma_f32_16x16x32_bf16 v[116:119], v[36:39], a[228:231], v[116:119]
  ds_read_b64_tr_b16 v[78:79], v13 offset:42240
  v_mfma_f32_16x16x32_bf16 v[132:135], v[40:43], a[228:231], v[132:135]
  ds_read_b64_tr_b16 v[80:81], v12 offset:41472
  v_mfma_f32_16x16x32_bf16 v[148:151], v[44:47], a[228:231], v[148:151]
  v_mfma_f32_16x16x32_bf16 v[164:167], v[48:51], a[228:231], v[164:167]
  ds_read_b64_tr_b16 v[82:83], v12 offset:42496
  v_mfma_f32_16x16x32_bf16 v[180:183], v[52:55], a[228:231], v[180:183]
  ds_read_b64_tr_b16 v[84:85], v13 offset:41472
  v_mfma_f32_16x16x32_bf16 v[196:199], v[56:59], a[228:231], v[196:199]
  ds_read_b64_tr_b16 v[86:87], v13 offset:42496
  v_mfma_f32_16x16x32_bf16 v[212:215], v[60:63], a[228:231], v[212:215]
  buffer_load_dwordx4 a[228:231], v2, s[36:39], s65 offen offset:2048
  v_mfma_f32_16x16x32_bf16 v[104:107], v[32:35], a[232:235], v[104:107]
  ds_read_b64_tr_b16 v[88:89], v12 offset:41728
  v_mfma_f32_16x16x32_bf16 v[120:123], v[36:39], a[232:235], v[120:123]
  ds_read_b64_tr_b16 v[90:91], v12 offset:42752
  v_mfma_f32_16x16x32_bf16 v[136:139], v[40:43], a[232:235], v[136:139]
  ds_read_b64_tr_b16 v[92:93], v13 offset:41728
  v_mfma_f32_16x16x32_bf16 v[152:155], v[44:47], a[232:235], v[152:155]
  v_mfma_f32_16x16x32_bf16 v[168:171], v[48:51], a[232:235], v[168:171]
  ds_read_b64_tr_b16 v[94:95], v13 offset:42752
  v_mfma_f32_16x16x32_bf16 v[184:187], v[52:55], a[232:235], v[184:187]
  v_mfma_f32_16x16x32_bf16 v[200:203], v[56:59], a[232:235], v[200:203]
  v_mfma_f32_16x16x32_bf16 v[216:219], v[60:63], a[232:235], v[216:219]
  buffer_load_dwordx4 a[232:235], v2, s[36:39], s66 offen offset:2048
  v_mfma_f32_16x16x32_bf16 v[108:111], v[32:35], a[236:239], v[108:111]
  s_add_u32 s28, s28, 1
  v_xor_b32 v12, 0x10000, v12
  v_mfma_f32_16x16x32_bf16 v[124:127], v[36:39], a[236:239], v[124:127]
  v_xor_b32 v13, 0x10000, v13
  v_mfma_f32_16x16x32_bf16 v[140:143], v[40:43], a[236:239], v[140:143]
  v_mfma_f32_16x16x32_bf16 v[156:159], v[44:47], a[236:239], v[156:159]
  v_mfma_f32_16x16x32_bf16 v[172:175], v[48:51], a[236:239], v[172:175]
  v_mfma_f32_16x16x32_bf16 v[188:191], v[52:55], a[236:239], v[188:191]
  v_mfma_f32_16x16x32_bf16 v[204:207], v[56:59], a[236:239], v[204:207]
  v_mfma_f32_16x16x32_bf16 v[220:223], v[60:63], a[236:239], v[220:223]
  s_waitcnt vmcnt(15) lgkmcnt(0)
  buffer_load_dwordx4 a[236:239], v2, s[36:39], s67 offen offset:2048
  v_mfma_f32_16x16x32_bf16 v[96:99], v[64:67], a[240:243], v[96:99]
  s_barrier
  v_mfma_f32_16x16x32_bf16 v[112:115], v[68:71], a[240:243], v[112:115]
  ds_read_b64_tr_b16 v[32:33], v12 offset:0
  v_mfma_f32_16x16x32_bf16 v[128:131], v[72:75], a[240:243], v[128:131]
  ds_read_b64_tr_b16 v[34:35], v12 offset:1024
  v_mfma_f32_16x16x32_bf16 v[144:147], v[76:79], a[240:243], v[144:147]
  ds_read_b64_tr_b16 v[36:37], v13 offset:0
  v_mfma_f32_16x16x32_bf16 v[160:163], v[80:83], a[240:243], v[160:163]
  ds_read_b64_tr_b16 v[38:39], v13 offset:1024
  v_mfma_f32_16x16x32_bf16 v[176:179], v[84:87], a[240:243], v[176:179]
  ds_read_b64_tr_b16 v[40:41], v12 offset:256
  v_mfma_f32_16x16x32_bf16 v[192:195], v[88:91], a[240:243], v[192:195]
  ds_read_b64_tr_b16 v[42:43], v12 offset:1280
  v_mfma_f32_16x16x32_bf16 v[208:211], v[92:95], a[240:243], v[208:211]
  buffer_load_dwordx4 a[240:243], v2, s[36:39], s64 offen offset:3072
  v_mfma_f32_16x16x32_bf16 v[100:103], v[64:67], a[244:247], v[100:103]
  s_add_u32 s64, s64, 4096
  ds_read_b64_tr_b16 v[44:45], v13 offset:256
  v_mfma_f32_16x16x32_bf16 v[116:119], v[68:71], a[244:247], v[116:119]
  ds_read_b64_tr_b16 v[46:47], v13 offset:1280
  v_mfma_f32_16x16x32_bf16 v[132:135], v[72:75], a[244:247], v[132:135]
  s_mov_b32 m0, s24
  ds_read_b64_tr_b16 v[48:49], v12 offset:512
  v_mfma_f32_16x16x32_bf16 v[148:151], v[76:79], a[244:247], v[148:151]
  buffer_load_dwordx4 v8, s[32:35], s26 offen offset:0 lds
  v_mfma_f32_16x16x32_bf16 v[164:167], v[80:83], a[244:247], v[164:167]
  ds_read_b64_tr_b16 v[50:51], v12 offset:1536
  v_mfma_f32_16x16x32_bf16 v[180:183], v[84:87], a[244:247], v[180:183]
  ds_read_b64_tr_b16 v[52:53], v13 offset:512
  v_mfma_f32_16x16x32_bf16 v[196:199], v[88:91], a[244:247], v[196:199]
  ds_read_b64_tr_b16 v[54:55], v13 offset:1536
  v_mfma_f32_16x16x32_bf16 v[212:215], v[92:95], a[244:247], v[212:215]
  buffer_load_dwordx4 a[244:247], v2, s[36:39], s65 offen offset:3072
  v_mfma_f32_16x16x32_bf16 v[104:107], v[64:67], a[248:251], v[104:107]
  s_add_u32 s65, s65, 4096
  ds_read_b64_tr_b16 v[56:57], v12 offset:768
  v_mfma_f32_16x16x32_bf16 v[120:123], v[68:71], a[248:251], v[120:123]
  ds_read_b64_tr_b16 v[58:59], v12 offset:1792
  v_mfma_f32_16x16x32_bf16 v[136:139], v[72:75], a[248:251], v[136:139]
  ds_read_b64_tr_b16 v[60:61], v13 offset:768
  v_mfma_f32_16x16x32_bf16 v[152:155], v[76:79], a[248:251], v[152:155]
  buffer_load_dwordx4 v9, s[32:35], s26 offen offset:1024 lds
  v_mfma_f32_16x16x32_bf16 v[168:171], v[80:83], a[248:251], v[168:171]
  ds_read_b64_tr_b16 v[62:63], v13 offset:1792
  v_mfma_f32_16x16x32_bf16 v[184:187], v[84:87], a[248:251], v[184:187]
  v_mfma_f32_16x16x32_bf16 v[200:203], v[88:91], a[248:251], v[200:203]
  buffer_load_dwordx4 v10, s[32:35], s26 offen offset:2048 lds
  v_mfma_f32_16x16x32_bf16 v[216:219], v[92:95], a[248:251], v[216:219]
  buffer_load_dwordx4 a[248:251], v2, s[36:39], s66 offen offset:3072
  v_mfma_f32_16x16x32_bf16 v[108:111], v[64:67], a[252:255], v[108:111]
  s_add_u32 s66, s66, 4096
  v_mfma_f32_16x16x32_bf16 v[124:127], v[68:71], a[252:255], v[124:127]
  v_mfma_f32_16x16x32_bf16 v[140:143], v[72:75], a[252:255], v[140:143]
  v_mfma_f32_16x16x32_bf16 v[156:159], v[76:79], a[252:255], v[156:159]
  buffer_load_dwordx4 v11, s[32:35], s26 offen offset:3072 lds
  v_mfma_f32_16x16x32_bf16 v[172:175], v[80:83], a[252:255], v[172:175]
  s_add_u32 s26, s26, 524288
  v_mfma_f32_16x16x32_bf16 v[188:191], v[84:87], a[252:255], v[188:191]
  s_add_u32 s24, s24, 32768
  v_mfma_f32_16x16x32_bf16 v[204:207], v[88:91], a[252:255], v[204:207]
  s_and_b32 s24, s24, 0x1ffff
  v_mfma_f32_16x16x32_bf16 v[220:223], v[92:95], a[252:255], v[220:223]
  s_waitcnt vmcnt(19) lgkmcnt(0)
  buffer_load_dwordx4 a[252:255], v2, s[36:39], s67 offen offset:3072
  s_add_u32 s67, s67, 4096
  s_cmp_ge_u32 s28, 4
  s_cselect_b32 s38, 0, s38
  s_cmp_lt_u32 s28, 5
  s_cbranch_scc1 k2_qloop
  s_waitcnt vmcnt(0)
  s_barrier
  s_and_b32 s23, s20, 1
  s_lshl_b32 s23, s23, 12
  s_cmp_lt_u32 s20, 2
  s_cselect_b32 s24, 106496, 0
  s_add_u32 s24, s24, s23
  s_lshl_b32 s26, s20, 12
  s_mov_b32 s27, s26
  s_add_u32 s25, s26, 49152
  s_mov_b32 m0, s24
  s_nop 0
  buffer_load_dwordx4 v2, s[44:47], s26 offen offset:0 lds
  buffer_load_dwordx4 v2, s[44:47], s26 offen offset:1024 lds
  buffer_load_dwordx4 v2, s[44:47], s26 offen offset:2048 lds
  buffer_load_dwordx4 v2, s[44:47], s26 offen offset:3072 lds
  s_add_u32 s26, s26, 16384
  s_add_u32 s24, s24, 32768
  s_and_b32 s24, s24, 0x1ffff
  s_mov_b32 m0, s24
  s_nop 0
  buffer_load_dwordx4 v2, s[44:47], s26 offen offset:0 lds
  buffer_load_dwordx4 v2, s[44:47], s26 offen offset:1024 lds
  buffer_load_dwordx4 v2, s[44:47], s26 offen offset:2048 lds
  buffer_load_dwordx4 v2, s[44:47], s26 offen offset:3072 lds
  s_add_u32 s26, s26, 16384
  s_add_u32 s24, s24, 32768
  s_and_b32 s24, s24, 0x1ffff
  s_mov_b32 m0, s24
  s_nop 0
  buffer_load_dwordx4 v2, s[44:47], s26 offen offset:0 lds
  buffer_load_dwordx4 v2, s[44:47], s26 offen offset:1024 lds
  buffer_load_dwordx4 v2, s[44:47], s26 offen offset:2048 lds
  buffer_load_dwordx4 v2, s[44:47], s26 offen offset:3072 lds
  s_add_u32 s26, s26, 16384
  s_add_u32 s24, s24, 32768
  s_and_b32 s24, s24, 0x1ffff
  s_mov_b32 m0, s25
  s_nop 0
  buffer_load_dwordx4 v2, s[48:51], s27 offen offset:0 lds
  buffer_load_dwordx4 v2, s[48:51], s27 offen offset:1024 lds
  buffer_load_dwordx4 v2, s[48:51], s27 offen offset:2048 lds
  buffer_load_dwordx4 v2, s[48:51], s27 offen offset:3072 lds
  s_add_u32 s27, s27, 16384
  s_add_u32 s25, s25, 32768
  s_and_b32 s25, s25, 0x1ffff
  s_mov_b32 m0, s25
  s_nop 0
  buffer_load_dwordx4 v2, s[48:51], s27 offen offset:0 lds
  buffer_load_dwordx4 v2, s[48:51], s27 offen offset:1024 lds
  buffer_load_dwordx4 v2, s[48:51], s27 offen offset:2048 lds
  buffer_load_dwordx4 v2, s[48:51], s27 offen offset:3072 lds
  s_add_u32 s27, s27, 16384
  s_add_u32 s25, s25, 32768
  s_and_b32 s25, s25, 0x1ffff
  v_mov_b32 v16, 0x3e0293ee
  v_mov_b32 v17, 0x3e0293ee
  v_pk_mul_f32 v[96:97], v[96:97], v[16:17]
  v_pk_mul_f32 v[98:99], v[98:99], v[16:17]
  v_cvt_pk_bf16_f32 v32, v96, v97
  v_cvt_pk_bf16_f32 v33, v98, v99
  v_pk_mul_f32 v[112:113], v[112:113], v[16:17]
  v_pk_mul_f32 v[114:115], v[114:115], v[16:17]
  v_cvt_pk_bf16_f32 v34, v112, v113
  v_cvt_pk_bf16_f32 v35, v114, v115
  v_pk_mul_f32 v[100:101], v[100:101], v[16:17]
  v_pk_mul_f32 v[102:103], v[102:103], v[16:17]
  v_cvt_pk_bf16_f32 v36, v100, v101
  v_cvt_pk_bf16_f32 v37, v102, v103
  v_pk_mul_f32 v[116:117], v[116:117], v[16:17]
  v_pk_mul_f32 v[118:119], v[118:119], v[16:17]
  v_cvt_pk_bf16_f32 v38, v116, v117
  v_cvt_pk_bf16_f32 v39, v118, v119
  v_pk_mul_f32 v[128:129], v[128:129], v[16:17]
  v_pk_mul_f32 v[130:131], v[130:131], v[16:17]
  v_cvt_pk_bf16_f32 v40, v128, v129
  v_cvt_pk_bf16_f32 v41, v130, v131
  v_pk_mul_f32 v[144:145], v[144:145], v[16:17]
  v_pk_mul_f32 v[146:147], v[146:147], v[16:17]
  v_cvt_pk_bf16_f32 v42, v144, v145
  v_cvt_pk_bf16_f32 v43, v146, v147
  v_pk_mul_f32 v[132:133], v[132:133], v[16:17]
  v_pk_mul_f32 v[134:135], v[134:135], v[16:17]
  v_cvt_pk_bf16_f32 v44, v132, v133
  v_cvt_pk_bf16_f32 v45, v134, v135
  v_pk_mul_f32 v[148:149], v[148:149], v[16:17]
  v_pk_mul_f32 v[150:151], v[150:151], v[16:17]
  v_cvt_pk_bf16_f32 v46, v148, v149
  v_cvt_pk_bf16_f32 v47, v150, v151
  v_pk_mul_f32 v[160:161], v[160:161], v[16:17]
  v_pk_mul_f32 v[162:163], v[162:163], v[16:17]
  v_cvt_pk_bf16_f32 v48, v160, v161
  v_cvt_pk_bf16_f32 v49, v162, v163
  v_pk_mul_f32 v[176:177], v[176:177], v[16:17]
  v_pk_mul_f32 v[178:179], v[178:179], v[16:17]
  v_cvt_pk_bf16_f32 v50, v176, v177
  v_cvt_pk_bf16_f32 v51, v178, v179
  v_pk_mul_f32 v[164:165], v[164:165], v[16:17]
  v_pk_mul_f32 v[166:167], v[166:167], v[16:17]
  v_cvt_pk_bf16_f32 v52, v164, v165
  v_cvt_pk_bf16_f32 v53, v166, v167
  v_pk_mul_f32 v[180:181], v[180:181], v[16:17]
  v_pk_mul_f32 v[182:183], v[182:183], v[16:17]
  v_cvt_pk_bf16_f32 v54, v180, v181
  v_cvt_pk_bf16_f32 v55, v182, v183
  v_pk_mul_f32 v[192:193], v[192:193], v[16:17]
  v_pk_mul_f32 v[194:195], v[194:195], v[16:17]
  v_cvt_pk_bf16_f32 v56, v192, v193
  v_cvt_pk_bf16_f32 v57, v194, v195
  v_pk_mul_f32 v[208:209], v[208:209], v[16:17]
  v_pk_mul_f32 v[210:211], v[210:211], v[16:17]
  v_cvt_pk_bf16_f32 v58, v208, v209
  v_cvt_pk_bf16_f32 v59, v210, v211
  v_pk_mul_f32 v[196:197], v[196:197], v[16:17]
  v_pk_mul_f32 v[198:199], v[198:199], v[16:17]
  v_cvt_pk_bf16_f32 v60, v196, v197
  v_cvt_pk_bf16_f32 v61, v198, v199
  v_pk_mul_f32 v[212:213], v[212:213], v[16:17]
  v_pk_mul_f32 v[214:215], v[214:215], v[16:17]
  v_cvt_pk_bf16_f32 v62, v212, v213
  v_cvt_pk_bf16_f32 v63, v214, v215
  v_pk_mul_f32 v[104:105], v[104:105], v[16:17]
  v_pk_mul_f32 v[106:107], v[106:107], v[16:17]
  v_cvt_pk_bf16_f32 v64, v104, v105
  v_cvt_pk_bf16_f32 v65, v106, v107
  v_pk_mul_f32 v[120:121], v[120:121], v[16:17]
  v_pk_mul_f32 v[122:123], v[122:123], v[16:17]
  v_cvt_pk_bf16_f32 v66, v120, v121
  v_cvt_pk_bf16_f32 v67, v122, v123
  v_pk_mul_f32 v[108:109], v[108:109], v[16:17]
  v_pk_mul_f32 v[110:111], v[110:111], v[16:17]
  v_cvt_pk_bf16_f32 v68, v108, v109
  v_cvt_pk_bf16_f32 v69, v110, v111
  v_pk_mul_f32 v[124:125], v[124:125], v[16:17]
  v_pk_mul_f32 v[126:127], v[126:127], v[16:17]
  v_cvt_pk_bf16_f32 v70, v124, v125
  v_cvt_pk_bf16_f32 v71, v126, v127
  v_pk_mul_f32 v[136:137], v[136:137], v[16:17]
  v_pk_mul_f32 v[138:139], v[138:139], v[16:17]
  v_cvt_pk_bf16_f32 v72, v136, v137
  v_cvt_pk_bf16_f32 v73, v138, v139
  v_pk_mul_f32 v[152:153], v[152:153], v[16:17]
  v_pk_mul_f32 v[154:155], v[154:155], v[16:17]
  v_cvt_pk_bf16_f32 v74, v152, v153
  v_cvt_pk_bf16_f32 v75, v154, v155
  v_pk_mul_f32 v[140:141], v[140:141], v[16:17]
  v_pk_mul_f32 v[142:143], v[142:143], v[16:17]
  v_cvt_pk_bf16_f32 v76, v140, v141
  v_cvt_pk_bf16_f32 v77, v142, v143
  v_pk_mul_f32 v[156:157], v[156:157], v[16:17]
  v_pk_mul_f32 v[158:159], v[158:159], v[16:17]
  v_cvt_pk_bf16_f32 v78, v156, v157
  v_cvt_pk_bf16_f32 v79, v158, v159
  v_pk_mul_f32 v[168:169], v[168:169], v[16:17]
  v_pk_mul_f32 v[170:171], v[170:171], v[16:17]
  v_cvt_pk_bf16_f32 v80, v168, v169
  v_cvt_pk_bf16_f32 v81, v170, v171
  v_pk_mul_f32 v[184:185], v[184:185], v[16:17]
  v_pk_mul_f32 v[186:187], v[186:187], v[16:17]
  v_cvt_pk_bf16_f32 v82, v184, v185
  v_cvt_pk_bf16_f32 v83, v186, v187
  v_pk_mul_f32 v[172:173], v[172:173], v[16:17]
  v_pk_mul_f32 v[174:175], v[174:175], v[16:17]
  v_cvt_pk_bf16_f32 v84, v172, v173
  v_cvt_pk_bf16_f32 v85, v174, v175
  v_pk_mul_f32 v[188:189], v[188:189], v[16:17]
  v_pk_mul_f32 v[190:191], v[190:191], v[16:17]
  v_cvt_pk_bf16_f32 v86, v188, v189
  v_cvt_pk_bf16_f32 v87, v190, v191
  v_pk_mul_f32 v[200:201], v[200:201], v[16:17]
  v_pk_mul_f32 v[202:203], v[202:203], v[16:17]
  v_cvt_pk_bf16_f32 v88, v200, v201
  v_cvt_pk_bf16_f32 v89, v202, v203
  v_pk_mul_f32 v[216:217], v[216:217], v[16:17]
  v_pk_mul_f32 v[218:219], v[218:219], v[16:17]
  v_cvt_pk_bf16_f32 v90, v216, v217
  v_cvt_pk_bf16_f32 v91, v218, v219
  v_pk_mul_f32 v[204:205], v[204:205], v[16:17]
  v_pk_mul_f32 v[206:207], v[206:207], v[16:17]
  v_cvt_pk_bf16_f32 v92, v204, v205
  v_cvt_pk_bf16_f32 v93, v206, v207
  v_pk_mul_f32 v[220:221], v[220:221], v[16:17]
  v_pk_mul_f32 v[222:223], v[222:223], v[16:17]
  v_cvt_pk_bf16_f32 v94, v220, v221
  v_cvt_pk_bf16_f32 v95, v222, v223
  s_add_u32 s23, s20, 1
  s_lshr_b32 s23, s23, 1
  s_lshl_b32 s28, s22, 1
  s_add_u32 s28, s28, s23
  s_lshl_b32 s23, s22, 2
  s_sub_u32 s29, 28, s23
  s_and_b32 s23, s20, 1
  s_add_u32 s29, s29, s23
  v_mov_b32 v3, v2
  v_add_u32 v18, 106496, v2
  s_waitcnt vmcnt(12)
  s_barrier
  ds_read_b128 a[128:131], v18 offset:0
  ds_read_b128 a[132:135], v18 offset:1024
  ds_read_b128 a[136:139], v18 offset:2048
  ds_read_b128 a[140:143], v18 offset:3072
  ds_read_b128 a[144:147], v18 offset:4096
  ds_read_b128 a[148:151], v18 offset:5120
  ds_read_b128 a[152:155], v18 offset:6144
  ds_read_b128 a[156:159], v18 offset:7168
  s_waitcnt lgkmcnt(4)
  v_mfma_f32_16x16x32_bf16 v[96:99], a[128:131], v[32:35], 0
  v_mfma_f32_16x16x32_bf16 v[104:107], a[128:131], v[36:39], 0
  v_mfma_f32_16x16x32_bf16 v[128:131], a[128:131], v[64:67], 0
  v_mfma_f32_16x16x32_bf16 v[136:139], a[128:131], v[68:71], 0
  s_mov_b32 m0, s24
  ds_read_b128 a[128:131], v3 offset:0
  v_mfma_f32_16x16x32_bf16 v[100:103], a[132:135], v[32:35], 0
  buffer_load_dwordx4 v2, s[44:47], s26 offen offset:0 lds
  v_mfma_f32_16x16x32_bf16 v[108:111], a[132:135], v[36:39], 0
  v_mfma_f32_16x16x32_bf16 v[132:135], a[132:135], v[64:67], 0
  v_mfma_f32_16x16x32_bf16 v[140:143], a[132:135], v[68:71], 0
  ds_read_b128 a[132:135], v3 offset:1024
  v_mfma_f32_16x16x32_bf16 v[96:99], a[136:139], v[40:43], v[96:99]
  v_mfma_f32_16x16x32_bf16 v[104:107], a[136:139], v[44:47], v[104:107]
  v_mfma_f32_16x16x32_bf16 v[128:131], a[136:139], v[72:75], v[128:131]
  buffer_load_dwordx4 v2, s[44:47], s26 offen offset:1024 lds
  v_mfma_f32_16x16x32_bf16 v[136:139], a[136:139], v[76:79], v[136:139]
  ds_read_b128 a[136:139], v3 offset:2048
  v_mfma_f32_16x16x32_bf16 v[100:103], a[140:143], v[40:43], v[100:103]
  v_mfma_f32_16x16x32_bf16 v[108:111], a[140:143], v[44:47], v[108:111]
  v_mfma_f32_16x16x32_bf16 v[132:135], a[140:143], v[72:75], v[132:135]
  v_mfma_f32_16x16x32_bf16 v[140:143], a[140:143], v[76:79], v[140:143]
  s_waitcnt lgkmcnt(3)
  ds_read_b128 a[140:143], v3 offset:3072
  v_mfma_f32_16x16x32_bf16 v[96:99], a[144:147], v[48:51], v[96:99]
  v_mfma_f32_16x16x32_bf16 v[104:107], a[144:147], v[52:55], v[104:107]
  v_mfma_f32_16x16x32_bf16 v[128:131], a[144:147], v[80:83], v[128:131]
  buffer_load_dwordx4 v2, s[44:47], s26 offen offset:2048 lds
  v_mfma_f32_16x16x32_bf16 v[136:139], a[144:147], v[84:87], v[136:139]
  ds_read_b128 a[144:147], v3 offset:4096
  v_mfma_f32_16x16x32_bf16 v[100:103], a[148:151], v[48:51], v[100:103]
  v_mfma_f32_16x16x32_bf16 v[108:111], a[148:151], v[52:55], v[108:111]
  v_mfma_f32_16x16x32_bf16 v[132:135], a[148:151], v[80:83], v[132:135]
  v_mfma_f32_16x16x32_bf16 v[140:143], a[148:151], v[84:87], v[140:143]
  ds_read_b128 a[148:151], v3 offset:5120
  v_mfma_f32_16x16x32_bf16 v[96:99], a[152:155], v[56:59], v[96:99]
  buffer_load_dwordx4 v2, s[44:47], s26 offen offset:3072 lds
  v_mfma_f32_16x16x32_bf16 v[104:107], a[152:155], v[60:63], v[104:107]
  s_add_u32 s26, s26, 16384
  v_mfma_f32_16x16x32_bf16 v[128:131], a[152:155], v[88:91], v[128:131]
  s_add_u32 s24, s24, 32768
  v_mfma_f32_16x16x32_bf16 v[136:139], a[152:155], v[92:95], v[136:139]
  s_and_b32 s24, s24, 0x1ffff
  ds_read_b128 a[152:155], v3 offset:6144
  v_mfma_f32_16x16x32_bf16 v[100:103], a[156:159], v[56:59], v[100:103]
  v_mfma_f32_16x16x32_bf16 v[108:111], a[156:159], v[60:63], v[108:111]
  v_mfma_f32_16x16x32_bf16 v[132:135], a[156:159], v[88:91], v[132:135]
  v_mfma_f32_16x16x32_bf16 v[140:143], a[156:159], v[92:95], v[140:143]
  s_waitcnt lgkmcnt(3)
  ds_read_b128 a[156:159], v3 offset:7168
  s_nop 7
  s_cmp_lg_u32 s28, 0
  s_cbranch_scc1 k2_nomask0
  v_cndmask_b32 v96, v4, v96, s[68:69]
  v_cndmask_b32 v97, v4, v97, s[70:71]
  v_cndmask_b32 v98, v4, v98, s[72:73]
  v_cndmask_b32 v99, v4, v99, s[74:75]
  v_mov_b32 v100, v4
  v_mov_b32 v101, v4
  v_mov_b32 v102, v4
  v_mov_b32 v103, v4
  v_cndmask_b32 v108, v4, v108, s[68:69]
  v_cndmask_b32 v109, v4, v109, s[70:71]
  v_cndmask_b32 v110, v4, v110, s[72:73]
  v_cndmask_b32 v111, v4, v111, s[74:75]
k2_nomask0:
  v_max3_f32 v16, v96, v97, v98
  v_max3_f32 v16, v16, v99, v100
  v_max3_f32 v16, v16, v101, v102
  v_max_f32 v16, v16, v103
  v_max3_f32 v17, v104, v105, v106
  v_max3_f32 v17, v17, v107, v108
  v_max3_f32 v17, v17, v109, v110
  v_max_f32 v17, v17, v111
  v_max3_f32 v18, v128, v129, v130
  v_max3_f32 v18, v18, v131, v132
  v_max3_f32 v18, v18, v133, v134
  v_max_f32 v18, v18, v135
  v_max3_f32 v19, v136, v137, v138
  v_max3_f32 v19, v19, v139, v140
  v_max3_f32 v19, v19, v141, v142
  v_max_f32 v19, v19, v143
  v_mov_b32 v20, v16
  v_mov_b32 v21, v17
  v_mov_b32 v22, v18
  v_mov_b32 v23, v19
  s_nop 0
  v_permlane16_swap_b32 v16, v20
  v_permlane16_swap_b32 v17, v21
  v_permlane16_swap_b32 v18, v22
  v_permlane16_swap_b32 v19, v23
  v_max_f32 v16, v16, v20
  v_max_f32 v17, v17, v21
  v_max_f32 v18, v18, v22
  v_max_f32 v19, v19, v23
  v_mov_b32 v20, v16
  v_mov_b32 v21, v17
  v_mov_b32 v22, v18
  v_mov_b32 v23, v19
  s_nop 0
  v_permlane32_swap_b32 v16, v20
  v_permlane32_swap_b32 v17, v21
  v_permlane32_swap_b32 v18, v22
  v_permlane32_swap_b32 v19, v23
  v_max_f32 v16, v16, v20
  v_max_f32 v17, v17, v21
  v_max_f32 v18, v18, v22
  v_max_f32 v19, v19, v23
  v_sub_f32 v192, 0, v16
  v_sub_f32 v193, 0, v16
  v_sub_f32 v194, 0, v16
  v_sub_f32 v195, 0, v16
  v_sub_f32 v196, 0, v17
  v_sub_f32 v197, 0, v17
  v_sub_f32 v198, 0, v17
  v_sub_f32 v199, 0, v17
  v_sub_f32 v200, 0, v18
  v_sub_f32 v201, 0, v18
  v_sub_f32 v202, 0, v18
  v_sub_f32 v203, 0, v18
  v_sub_f32 v204, 0, v19
  v_sub_f32 v205, 0, v19
  v_sub_f32 v206, 0, v19
  v_sub_f32 v207, 0, v19
  v_sub_f32 v96, v96, v16
  v_sub_f32 v97, v97, v16
  v_sub_f32 v98, v98, v16
  v_sub_f32 v99, v99, v16
  v_sub_f32 v100, v100, v16
  v_sub_f32 v101, v101, v16
  v_sub_f32 v102, v102, v16
  v_sub_f32 v103, v103, v16
  v_sub_f32 v104, v104, v17
  v_sub_f32 v105, v105, v17
  v_sub_f32 v106, v106, v17
  v_sub_f32 v107, v107, v17
  v_sub_f32 v108, v108, v17
  v_sub_f32 v109, v109, v17
  v_sub_f32 v110, v110, v17
  v_sub_f32 v111, v111, v17
  v_sub_f32 v128, v128, v18
  v_sub_f32 v129, v129, v18
  v_sub_f32 v130, v130, v18
  v_sub_f32 v131, v131, v18
  v_sub_f32 v132, v132, v18
  v_sub_f32 v133, v133, v18
  v_sub_f32 v134, v134, v18
  v_sub_f32 v135, v135, v18
  v_sub_f32 v136, v136, v19
  v_sub_f32 v137, v137, v19
  v_sub_f32 v138, v138, v19
  v_sub_f32 v139, v139, v19
  v_sub_f32 v140, v140, v19
  v_sub_f32 v141, v141, v19
  v_sub_f32 v142, v142, v19
  v_sub_f32 v143, v143, v19
  v_mfma_f32_16x16x32_bf16 v[112:115], a[128:131], v[32:35], v[192:195]
  v_exp_f32 v208, v96
  v_exp_f32 v209, v97
  v_mfma_f32_16x16x32_bf16 v[120:123], a[128:131], v[36:39], v[196:199]
  v_exp_f32 v210, v98
  v_exp_f32 v211, v99
  v_mfma_f32_16x16x32_bf16 v[144:147], a[128:131], v[64:67], v[200:203]
  v_exp_f32 v212, v100
  v_exp_f32 v213, v101
  v_mfma_f32_16x16x32_bf16 v[152:155], a[128:131], v[68:71], v[204:207]
  s_mov_b32 m0, s25
  ds_read_b128 a[128:131], v3 offset:8192
  v_exp_f32 v214, v102
  v_add_f32 v224, v208, v209
  v_mfma_f32_16x16x32_bf16 v[116:119], a[132:135], v[32:35], v[192:195]
  buffer_load_dwordx4 v2, s[48:51], s27 offen offset:0 lds
  v_exp_f32 v215, v103
  v_cvt_pk_bf16_f32 v160, v208, v209
  v_mfma_f32_16x16x32_bf16 v[124:127], a[132:135], v[36:39], v[196:199]
  v_exp_f32 v208, v104
  v_add_f32 v224, v224, v210
  v_add_f32 v224, v224, v211
  v_mfma_f32_16x16x32_bf16 v[148:151], a[132:135], v[64:67], v[200:203]
  v_exp_f32 v209, v105
  v_cvt_pk_bf16_f32 v161, v210, v211
  v_add_f32 v224, v224, v212
  v_mfma_f32_16x16x32_bf16 v[156:159], a[132:135], v[68:71], v[204:207]
  ds_read_b128 a[132:135], v3 offset:9216
  v_exp_f32 v210, v106
  v_mfma_f32_16x16x32_bf16 v[112:115], a[136:139], v[40:43], v[112:115]
  v_exp_f32 v211, v107
  v_add_f32 v224, v224, v213
  v_cvt_pk_bf16_f32 v162, v212, v213
  v_mfma_f32_16x16x32_bf16 v[120:123], a[136:139], v[44:47], v[120:123]
  v_exp_f32 v212, v108
  v_add_f32 v224, v224, v214
  v_add_f32 v224, v224, v215
  v_mfma_f32_16x16x32_bf16 v[144:147], a[136:139], v[72:75], v[144:147]
  buffer_load_dwordx4 v2, s[48:51], s27 offen offset:1024 lds
  v_exp_f32 v213, v109
  v_cvt_pk_bf16_f32 v163, v214, v215
  v_mfma_f32_16x16x32_bf16 v[152:155], a[136:139], v[76:79], v[152:155]
  ds_read_b128 a[136:139], v3 offset:10240
  v_exp_f32 v214, v110
  v_add_f32 v225, v208, v209
  v_mfma_f32_16x16x32_bf16 v[116:119], a[140:143], v[40:43], v[116:119]
  v_exp_f32 v215, v111
  v_exp_f32 v216, v128
  v_mfma_f32_16x16x32_bf16 v[124:127], a[140:143], v[44:47], v[124:127]
  v_exp_f32 v217, v129
  v_exp_f32 v218, v130
  v_mfma_f32_16x16x32_bf16 v[148:151], a[140:143], v[72:75], v[148:151]
  v_exp_f32 v219, v131
  v_exp_f32 v220, v132
  v_mfma_f32_16x16x32_bf16 v[156:159], a[140:143], v[76:79], v[156:159]
  s_waitcnt lgkmcnt(3)
  ds_read_b128 a[140:143], v3 offset:11264
  v_exp_f32 v221, v133
  v_cvt_pk_bf16_f32 v164, v208, v209
  v_mfma_f32_16x16x32_bf16 v[112:115], a[144:147], v[48:51], v[112:115]
  v_exp_f32 v222, v134
  v_exp_f32 v223, v135
  v_mfma_f32_16x16x32_bf16 v[120:123], a[144:147], v[52:55], v[120:123]
  v_add_f32 v225, v225, v210
  v_add_f32 v225, v225, v211
  v_cvt_pk_bf16_f32 v165, v210, v211
  v_add_f32 v225, v225, v212
  v_mfma_f32_16x16x32_bf16 v[144:147], a[144:147], v[80:83], v[144:147]
  buffer_load_dwordx4 v2, s[48:51], s27 offen offset:2048 lds
  v_add_f32 v225, v225, v213
  v_cvt_pk_bf16_f32 v166, v212, v213
  v_add_f32 v225, v225, v214
  v_mfma_f32_16x16x32_bf16 v[152:155], a[144:147], v[84:87], v[152:155]
  ds_read_b128 a[144:147], v3 offset:12288
  v_add_f32 v225, v225, v215
  v_cvt_pk_bf16_f32 v167, v214, v215
  v_add_f32 v226, v216, v217
  v_mfma_f32_16x16x32_bf16 v[116:119], a[148:151], v[48:51], v[116:119]
  v_cvt_pk_bf16_f32 v176, v216, v217
  v_exp_f32 v216, v136
  v_add_f32 v226, v226, v218
  v_mfma_f32_16x16x32_bf16 v[124:127], a[148:151], v[52:55], v[124:127]
  v_exp_f32 v217, v137
  v_add_f32 v226, v226, v219
  v_cvt_pk_bf16_f32 v177, v218, v219
  v_mfma_f32_16x16x32_bf16 v[148:151], a[148:151], v[80:83], v[148:151]
  v_exp_f32 v218, v138
  v_add_f32 v226, v226, v220
  v_add_f32 v226, v226, v221
  v_mfma_f32_16x16x32_bf16 v[156:159], a[148:151], v[84:87], v[156:159]
  ds_read_b128 a[148:151], v3 offset:13312
  v_exp_f32 v219, v139
  v_mfma_f32_16x16x32_bf16 v[112:115], a[152:155], v[56:59], v[112:115]
  buffer_load_dwordx4 v2, s[48:51], s27 offen offset:3072 lds
  v_cvt_pk_bf16_f32 v178, v220, v221
  v_exp_f32 v220, v140
  v_mfma_f32_16x16x32_bf16 v[120:123], a[152:155], v[60:63], v[120:123]
  s_add_u32 s27, s27, 16384
  v_add_f32 v226, v226, v222
  v_add_f32 v226, v226, v223
  v_cvt_pk_bf16_f32 v179, v222, v223
  v_add_f32 v227, v216, v217
  v_mfma_f32_16x16x32_bf16 v[144:147], a[152:155], v[88:91], v[144:147]
  s_add_u32 s25, s25, 32768
  v_exp_f32 v221, v141
  v_cvt_pk_bf16_f32 v180, v216, v217
  v_add_f32 v227, v227, v218
  v_mfma_f32_16x16x32_bf16 v[152:155], a[152:155], v[92:95], v[152:155]
  s_and_b32 s25, s25, 0x1ffff
  ds_read_b128 a[152:155], v3 offset:14336
  v_add_f32 v227, v227, v219
  v_cvt_pk_bf16_f32 v181, v218, v219
  v_max3_f32 v5, v224, v225, v226
  v_mfma_f32_16x16x32_bf16 v[116:119], a[156:159], v[56:59], v[116:119]
  v_exp_f32 v222, v142
  v_add_f32 v227, v227, v220
  v_add_f32 v227, v227, v221
  v_mfma_f32_16x16x32_bf16 v[124:127], a[156:159], v[60:63], v[124:127]
  v_exp_f32 v223, v143
  v_cvt_pk_bf16_f32 v182, v220, v221
  v_add_f32 v227, v227, v222
  v_mfma_f32_16x16x32_bf16 v[148:151], a[156:159], v[88:91], v[148:151]
  v_add_f32 v227, v227, v223
  v_cvt_pk_bf16_f32 v183, v222, v223
  v_max_f32 v5, v5, v227
  v_cmp_lt_f32 vcc, s81, v5
  v_mfma_f32_16x16x32_bf16 v[156:159], a[156:159], v[92:95], v[156:159]
  s_waitcnt lgkmcnt(3)
  s_cbranch_vccnz k2_stub0
k2_back0:
  ds_read_b128 a[156:159], v3 offset:15360
  v_add_f32 v228, v228, v224
  v_add_f32 v229, v229, v225
  v_add_f32 v230, v230, v226
  v_add_f32 v231, v231, v227
  v_add_u32 v3, 32768, v3
  v_and_b32 v3, 0x1ffff, v3
  s_cmp_eq_u32 s28, 0
  s_cbranch_scc1 k2_AV
  s_sub_u32 s28, s28, 1
  s_cmp_eq_u32 s28, 0
  s_cbranch_scc1 k2_Aexit
.p2align 6
k2_DD:
  v_mfma_f32_16x16x32_bf16 v[96:99], a[128:131], v[32:35], v[192:195]
  s_waitcnt vmcnt(12)
  v_exp_f32 v208, v112
  v_mfma_f32_16x16x32_bf16 v[104:107], a[128:131], v[36:39], v[196:199]
  s_barrier
  v_exp_f32 v209, v113
  v_mfma_f32_16x16x32_bf16 v[128:131], a[128:131], v[64:67], v[200:203]
  ds_read_b128 a[160:163], v3 offset:16384
  v_add_f32 v224, v208, v209
  v_mfma_f32_16x16x32_bf16 v[136:139], a[128:131], v[68:71], v[204:207]
  v_exp_f32 v210, v114
  v_mfma_f32_16x16x32_bf16 v[100:103], a[132:135], v[32:35], v[192:195]
  ds_read_b128 a[164:167], v3 offset:17408
  v_cvt_pk_bf16_f32 v168, v208, v209
  v_mfma_f32_16x16x32_bf16 v[108:111], a[132:135], v[36:39], v[196:199]
  s_mov_b32 m0, s24
  v_exp_f32 v211, v115
  v_mfma_f32_16x16x32_bf16 v[132:135], a[132:135], v[64:67], v[200:203]
  buffer_load_dwordx4 v2, s[44:47], s26 offen offset:0 lds
  v_add_f32 v224, v224, v210
  v_add_f32 v224, v224, v211
  v_mfma_f32_16x16x32_bf16 v[140:143], a[132:135], v[68:71], v[204:207]
  v_exp_f32 v212, v116
  v_mfma_f32_16x16x32_bf16 v[96:99], a[136:139], v[40:43], v[96:99]
  ds_read_b128 a[168:171], v3 offset:18432
  v_cvt_pk_bf16_f32 v169, v210, v211
  v_mfma_f32_16x16x32_bf16 v[104:107], a[136:139], v[44:47], v[104:107]
  v_exp_f32 v213, v117
  v_mfma_f32_16x16x32_bf16 v[128:131], a[136:139], v[72:75], v[128:131]
  v_exp_f32 v214, v118
  v_mfma_f32_16x16x32_bf16 v[136:139], a[136:139], v[76:79], v[136:139]
  v_exp_f32 v215, v119
  v_mfma_f32_16x16x32_bf16 v[100:103], a[140:143], v[40:43], v[100:103]
  ds_read_b128 a[172:175], v3 offset:19456
  v_add_f32 v224, v224, v212
  v_mfma_f32_16x16x32_bf16 v[108:111], a[140:143], v[44:47], v[108:111]
  v_exp_f32 v208, v120
  v_mfma_f32_16x16x32_bf16 v[132:135], a[140:143], v[72:75], v[132:135]
  v_exp_f32 v209, v121
  v_mfma_f32_16x16x32_bf16 v[140:143], a[140:143], v[76:79], v[140:143]
  s_waitcnt lgkmcnt(4)
  v_exp_f32 v210, v122
  v_mfma_f32_16x16x32_bf16 v[96:99], a[144:147], v[48:51], v[96:99]
  ds_read_b128 a[176:179], v3 offset:20480
  v_add_f32 v224, v224, v213
  v_mfma_f32_16x16x32_bf16 v[104:107], a[144:147], v[52:55], v[104:107]
  v_exp_f32 v211, v123
  v_mfma_f32_16x16x32_bf16 v[128:131], a[144:147], v[80:83], v[128:131]
  v_cvt_pk_bf16_f32 v170, v212, v213
  v_add_f32 v224, v224, v214
  v_add_f32 v224, v224, v215
  v_mfma_f32_16x16x32_bf16 v[136:139], a[144:147], v[84:87], v[136:139]
  v_exp_f32 v212, v124
  v_mfma_f32_16x16x32_bf16 v[100:103], a[148:151], v[48:51], v[100:103]
  ds_read_b128 a[180:183], v3 offset:21504
  v_cvt_pk_bf16_f32 v171, v214, v215
  v_mfma_f32_16x16x32_bf16 v[108:111], a[148:151], v[52:55], v[108:111]
  v_exp_f32 v213, v125
  v_mfma_f32_16x16x32_bf16 v[132:135], a[148:151], v[80:83], v[132:135]
  buffer_load_dwordx4 v2, s[44:47], s26 offen offset:1024 lds
  v_add_f32 v225, v208, v209
  v_mfma_f32_16x16x32_bf16 v[140:143], a[148:151], v[84:87], v[140:143]
  v_exp_f32 v214, v126
  v_mfma_f32_16x16x32_bf16 v[96:99], a[152:155], v[56:59], v[96:99]
  ds_read_b128 a[184:187], v3 offset:22528
  v_cvt_pk_bf16_f32 v172, v208, v209
  v_mfma_f32_16x16x32_bf16 v[104:107], a[152:155], v[60:63], v[104:107]
  v_exp_f32 v215, v127
  v_mfma_f32_16x16x32_bf16 v[128:131], a[152:155], v[88:91], v[128:131]
  v_exp_f32 v216, v144
  v_mfma_f32_16x16x32_bf16 v[136:139], a[152:155], v[92:95], v[136:139]
  v_exp_f32 v217, v145
  v_mfma_f32_16x16x32_bf16 v[100:103], a[156:159], v[56:59], v[100:103]
  ds_read_b128 a[188:191], v3 offset:23552
  v_add_f32 v225, v225, v210
  v_mfma_f32_16x16x32_bf16 v[108:111], a[156:159], v[60:63], v[108:111]
  v_exp_f32 v218, v146
  v_mfma_f32_16x16x32_bf16 v[132:135], a[156:159], v[88:91], v[132:135]
  v_exp_f32 v219, v147
  v_mfma_f32_16x16x32_bf16 v[140:143], a[156:159], v[92:95], v[140:143]
  s_waitcnt lgkmcnt(4)
  v_exp_f32 v220, v148
  v_add_f32 v225, v225, v211
  v_mfma_f32_16x16x32_bf16 a[0:3], a[160:163], v[160:163], a[0:3]
  ds_read_b128 a[128:131], v3 offset:0
  v_cvt_pk_bf16_f32 v173, v210, v211
  v_mfma_f32_16x16x32_bf16 a[4:7], a[160:163], v[164:167], a[4:7]
  v_exp_f32 v221, v149
  v_mfma_f32_16x16x32_bf16 a[64:67], a[160:163], v[176:179], a[64:67]
  v_exp_f32 v222, v150
  v_mfma_f32_16x16x32_bf16 a[68:71], a[160:163], v[180:183], a[68:71]
  v_exp_f32 v223, v151
  v_mfma_f32_16x16x32_bf16 a[8:11], a[164:167], v[160:163], a[8:11]
  ds_read_b128 a[132:135], v3 offset:1024
  v_add_f32 v225, v225, v212
  v_mfma_f32_16x16x32_bf16 a[12:15], a[164:167], v[164:167], a[12:15]
  v_add_f32 v225, v225, v213
  v_cvt_pk_bf16_f32 v174, v212, v213
  v_mfma_f32_16x16x32_bf16 a[72:75], a[164:167], v[176:179], a[72:75]
  buffer_load_dwordx4 v2, s[44:47], s26 offen offset:2048 lds
  v_add_f32 v225, v225, v214
  v_mfma_f32_16x16x32_bf16 a[76:79], a[164:167], v[180:183], a[76:79]
  v_add_f32 v225, v225, v215
  v_cvt_pk_bf16_f32 v175, v214, v215
  v_mfma_f32_16x16x32_bf16 a[16:19], a[168:171], v[160:163], a[16:19]
  ds_read_b128 a[136:139], v3 offset:2048
  v_add_f32 v226, v216, v217
  v_mfma_f32_16x16x32_bf16 a[20:23], a[168:171], v[164:167], a[20:23]
  v_cvt_pk_bf16_f32 v184, v216, v217
  v_add_f32 v226, v226, v218
  v_mfma_f32_16x16x32_bf16 a[80:83], a[168:171], v[176:179], a[80:83]
  v_exp_f32 v216, v152
  v_mfma_f32_16x16x32_bf16 a[84:87], a[168:171], v[180:183], a[84:87]
  v_exp_f32 v217, v153
  v_mfma_f32_16x16x32_bf16 a[24:27], a[172:175], v[160:163], a[24:27]
  ds_read_b128 a[140:143], v3 offset:3072
  v_add_f32 v226, v226, v219
  v_cvt_pk_bf16_f32 v185, v218, v219
  v_mfma_f32_16x16x32_bf16 a[28:31], a[172:175], v[164:167], a[28:31]
  v_exp_f32 v218, v154
  v_mfma_f32_16x16x32_bf16 a[88:91], a[172:175], v[176:179], a[88:91]
  v_add_f32 v226, v226, v220
  v_add_f32 v226, v226, v221
  v_mfma_f32_16x16x32_bf16 a[92:95], a[172:175], v[180:183], a[92:95]
  s_waitcnt lgkmcnt(4)
  v_exp_f32 v219, v155
  v_mfma_f32_16x16x32_bf16 a[32:35], a[176:179], v[160:163], a[32:35]
  ds_read_b128 a[144:147], v3 offset:4096
  v_cvt_pk_bf16_f32 v186, v220, v221
  v_mfma_f32_16x16x32_bf16 a[36:39], a[176:179], v[164:167], a[36:39]
  v_exp_f32 v220, v156
  v_mfma_f32_16x16x32_bf16 a[96:99], a[176:179], v[176:179], a[96:99]
  v_add_f32 v226, v226, v222
  v_add_f32 v226, v226, v223
  v_mfma_f32_16x16x32_bf16 a[100:103], a[176:179], v[180:183], a[100:103]
  v_exp_f32 v221, v157
  v_mfma_f32_16x16x32_bf16 a[40:43], a[180:183], v[160:163], a[40:43]
  ds_read_b128 a[148:151], v3 offset:5120
  v_cvt_pk_bf16_f32 v187, v222, v223
  v_mfma_f32_16x16x32_bf16 a[44:47], a[180:183], v[164:167], a[44:47]
  v_exp_f32 v222, v158
  v_mfma_f32_16x16x32_bf16 a[104:107], a[180:183], v[176:179], a[104:107]
  buffer_load_dwordx4 v2, s[44:47], s26 offen offset:3072 lds
  v_add_f32 v227, v216, v217
  v_mfma_f32_16x16x32_bf16 a[108:111], a[180:183], v[180:183], a[108:111]
  s_add_u32 s26, s26, 16384
  v_exp_f32 v223, v159
  v_mfma_f32_16x16x32_bf16 a[48:51], a[184:187], v[160:163], a[48:51]
  s_add_u32 s24, s24, 32768
  ds_read_b128 a[152:155], v3 offset:6144
  v_cvt_pk_bf16_f32 v188, v216, v217
  v_add_f32 v227, v227, v218
  v_mfma_f32_16x16x32_bf16 a[52:55], a[184:187], v[164:167], a[52:55]
  s_and_b32 s24, s24, 0x1ffff
  v_add_f32 v227, v227, v219
  v_cvt_pk_bf16_f32 v189, v218, v219
  v_mfma_f32_16x16x32_bf16 a[112:115], a[184:187], v[176:179], a[112:115]
  v_max3_f32 v5, v224, v225, v226
  v_add_f32 v227, v227, v220
  v_mfma_f32_16x16x32_bf16 a[116:119], a[184:187], v[180:183], a[116:119]
  v_add_f32 v227, v227, v221
  v_cvt_pk_bf16_f32 v190, v220, v221
  v_mfma_f32_16x16x32_bf16 a[56:59], a[188:191], v[160:163], a[56:59]
  ds_read_b128 a[156:159], v3 offset:7168
  v_add_f32 v227, v227, v222
  v_mfma_f32_16x16x32_bf16 a[60:63], a[188:191], v[164:167], a[60:63]
  v_add_f32 v227, v227, v223
  v_cvt_pk_bf16_f32 v191, v222, v223
  v_mfma_f32_16x16x32_bf16 a[120:123], a[188:191], v[176:179], a[120:123]
  s_waitcnt lgkmcnt(4)
  v_max_f32 v5, v5, v227
  v_cmp_lt_f32 vcc, s81, v5
  v_mfma_f32_16x16x32_bf16 a[124:127], a[188:191], v[180:183], a[124:127]
  s_cbranch_vccnz k2_stub1
k2_back1:
  v_add_f32 v228, v228, v224
  v_add_f32 v229, v229, v225
  v_add_f32 v230, v230, v226
  v_add_f32 v231, v231, v227
  v_mfma_f32_16x16x32_bf16 v[112:115], a[128:131], v[32:35], v[192:195]
  ds_read_b128 a[160:163], v3 offset:24576
  v_exp_f32 v208, v96
  v_mfma_f32_16x16x32_bf16 v[120:123], a[128:131], v[36:39], v[196:199]
  v_exp_f32 v209, v97
  v_mfma_f32_16x16x32_bf16 v[144:147], a[128:131], v[64:67], v[200:203]
  v_exp_f32 v210, v98
  v_mfma_f32_16x16x32_bf16 v[152:155], a[128:131], v[68:71], v[204:207]
  v_exp_f32 v211, v99
  v_mfma_f32_16x16x32_bf16 v[116:119], a[132:135], v[32:35], v[192:195]
  ds_read_b128 a[164:167], v3 offset:25600
  v_mfma_f32_16x16x32_bf16 v[124:127], a[132:135], v[36:39], v[196:199]
  s_mov_b32 m0, s25
  v_exp_f32 v212, v100
  v_mfma_f32_16x16x32_bf16 v[148:151], a[132:135], v[64:67], v[200:203]
  buffer_load_dwordx4 v2, s[48:51], s27 offen offset:0 lds
  v_add_f32 v224, v208, v209
  v_cvt_pk_bf16_f32 v160, v208, v209
  v_mfma_f32_16x16x32_bf16 v[156:159], a[132:135], v[68:71], v[204:207]
  v_exp_f32 v213, v101
  v_mfma_f32_16x16x32_bf16 v[112:115], a[136:139], v[40:43], v[112:115]
  ds_read_b128 a[168:171], v3 offset:26624
  v_add_f32 v224, v224, v210
  v_mfma_f32_16x16x32_bf16 v[120:123], a[136:139], v[44:47], v[120:123]
  v_exp_f32 v214, v102
  v_mfma_f32_16x16x32_bf16 v[144:147], a[136:139], v[72:75], v[144:147]
  v_exp_f32 v215, v103
  v_mfma_f32_16x16x32_bf16 v[152:155], a[136:139], v[76:79], v[152:155]
  v_exp_f32 v208, v104
  v_mfma_f32_16x16x32_bf16 v[116:119], a[140:143], v[40:43], v[116:119]
  ds_read_b128 a[172:175], v3 offset:27648
  v_add_f32 v224, v224, v211
  v_mfma_f32_16x16x32_bf16 v[124:127], a[140:143], v[44:47], v[124:127]
  v_exp_f32 v209, v105
  v_mfma_f32_16x16x32_bf16 v[148:151], a[140:143], v[72:75], v[148:151]
  v_cvt_pk_bf16_f32 v161, v210, v211
  v_add_f32 v224, v224, v212
  v_mfma_f32_16x16x32_bf16 v[156:159], a[140:143], v[76:79], v[156:159]
  s_waitcnt lgkmcnt(4)
  v_exp_f32 v210, v106
  v_mfma_f32_16x16x32_bf16 v[112:115], a[144:147], v[48:51], v[112:115]
  ds_read_b128 a[176:179], v3 offset:28672
  v_add_f32 v224, v224, v213
  v_mfma_f32_16x16x32_bf16 v[120:123], a[144:147], v[52:55], v[120:123]
  v_exp_f32 v211, v107
  v_mfma_f32_16x16x32_bf16 v[144:147], a[144:147], v[80:83], v[144:147]
  v_cvt_pk_bf16_f32 v162, v212, v213
  v_add_f32 v224, v224, v214
  v_add_f32 v224, v224, v215
  v_mfma_f32_16x16x32_bf16 v[152:155], a[144:147], v[84:87], v[152:155]
  v_exp_f32 v212, v108
  v_mfma_f32_16x16x32_bf16 v[116:119], a[148:151], v[48:51], v[116:119]
  ds_read_b128 a[180:183], v3 offset:29696
  v_cvt_pk_bf16_f32 v163, v214, v215
  v_mfma_f32_16x16x32_bf16 v[124:127], a[148:151], v[52:55], v[124:127]
  v_exp_f32 v213, v109
  v_mfma_f32_16x16x32_bf16 v[148:151], a[148:151], v[80:83], v[148:151]
  buffer_load_dwordx4 v2, s[48:51], s27 offen offset:1024 lds
  v_add_f32 v225, v208, v209
  v_mfma_f32_16x16x32_bf16 v[156:159], a[148:151], v[84:87], v[156:159]
  v_exp_f32 v214, v110
  v_mfma_f32_16x16x32_bf16 v[112:115], a[152:155], v[56:59], v[112:115]
  ds_read_b128 a[184:187], v3 offset:30720
  v_cvt_pk_bf16_f32 v164, v208, v209
  v_mfma_f32_16x16x32_bf16 v[120:123], a[152:155], v[60:63], v[120:123]
  v_exp_f32 v215, v111
  v_mfma_f32_16x16x32_bf16 v[144:147], a[152:155], v[88:91], v[144:147]
  v_exp_f32 v216, v128
  v_mfma_f32_16x16x32_bf16 v[152:155], a[152:155], v[92:95], v[152:155]
  v_exp_f32 v217, v129
  v_mfma_f32_16x16x32_bf16 v[116:119], a[156:159], v[56:59], v[116:119]
  ds_read_b128 a[188:191], v3 offset:31744
  v_add_f32 v225, v225, v210
  v_mfma_f32_16x16x32_bf16 v[124:127], a[156:159], v[60:63], v[124:127]
  v_exp_f32 v218, v130
  v_mfma_f32_16x16x32_bf16 v[148:151], a[156:159], v[88:91], v[148:151]
  v_exp_f32 v219, v131
  v_mfma_f32_16x16x32_bf16 v[156:159], a[156:159], v[92:95], v[156:159]
  s_waitcnt lgkmcnt(4)
  v_exp_f32 v220, v132
  v_add_f32 v225, v225, v211
  v_mfma_f32_16x16x32_bf16 a[0:3], a[160:163], v[168:171], a[0:3]
  ds_read_b128 a[128:131], v3 offset:8192
  v_cvt_pk_bf16_f32 v165, v210, v211
  v_mfma_f32_16x16x32_bf16 a[4:7], a[160:163], v[172:175], a[4:7]
  v_exp_f32 v221, v133
  v_mfma_f32_16x16x32_bf16 a[64:67], a[160:163], v[184:187], a[64:67]
  v_exp_f32 v222, v134
  v_mfma_f32_16x16x32_bf16 a[68:71], a[160:163], v[188:191], a[68:71]
  v_exp_f32 v223, v135
  v_mfma_f32_16x16x32_bf16 a[8:11], a[164:167], v[168:171], a[8:11]
  ds_read_b128 a[132:135], v3 offset:9216
  v_add_f32 v225, v225, v212
  v_mfma_f32_16x16x32_bf16 a[12:15], a[164:167], v[172:175], a[12:15]
  v_add_f32 v225, v225, v213
  v_cvt_pk_bf16_f32 v166, v212, v213
  v_mfma_f32_16x16x32_bf16 a[72:75], a[164:167], v[184:187], a[72:75]
  buffer_load_dwordx4 v2, s[48:51], s27 offen offset:2048 lds
  v_add_f32 v225, v225, v214
  v_mfma_f32_16x16x32_bf16 a[76:79], a[164:167], v[188:191], a[76:79]
  v_add_f32 v225, v225, v215
  v_cvt_pk_bf16_f32 v167, v214, v215
  v_mfma_f32_16x16x32_bf16 a[16:19], a[168:171], v[168:171], a[16:19]
  ds_read_b128 a[136:139], v3 offset:10240
  v_add_f32 v226, v216, v217
  v_mfma_f32_16x16x32_bf16 a[20:23], a[168:171], v[172:175], a[20:23]
  v_cvt_pk_bf16_f32 v176, v216, v217
  v_add_f32 v226, v226, v218
  v_mfma_f32_16x16x32_bf16 a[80:83], a[168:171], v[184:187], a[80:83]
  v_exp_f32 v216, v136
  v_mfma_f32_16x16x32_bf16 a[84:87], a[168:171], v[188:191], a[84:87]
  v_exp_f32 v217, v137
  v_mfma_f32_16x16x32_bf16 a[24:27], a[172:175], v[168:171], a[24:27]
  ds_read_b128 a[140:143], v3 offset:11264
  v_add_f32 v226, v226, v219
  v_cvt_pk_bf16_f32 v177, v218, v219
  v_mfma_f32_16x16x32_bf16 a[28:31], a[172:175], v[172:175], a[28:31]
  v_exp_f32 v218, v138
  v_mfma_f32_16x16x32_bf16 a[88:91], a[172:175], v[184:187], a[88:91]
  v_add_f32 v226, v226, v220
  v_add_f32 v226, v226, v221
  v_mfma_f32_16x16x32_bf16 a[92:95], a[172:175], v[188:191], a[92:95]
  s_waitcnt lgkmcnt(4)
  v_exp_f32 v219, v139
  v_mfma_f32_16x16x32_bf16 a[32:35], a[176:179], v[168:171], a[32:35]
  ds_read_b128 a[144:147], v3 offset:12288
  v_cvt_pk_bf16_f32 v178, v220, v221
  v_mfma_f32_16x16x32_bf16 a[36:39], a[176:179], v[172:175], a[36:39]
  v_exp_f32 v220, v140
  v_mfma_f32_16x16x32_bf16 a[96:99], a[176:179], v[184:187], a[96:99]
  v_add_f32 v226, v226, v222
  v_add_f32 v226, v226, v223
  v_mfma_f32_16x16x32_bf16 a[100:103], a[176:179], v[188:191], a[100:103]
  v_exp_f32 v221, v141
  v_mfma_f32_16x16x32_bf16 a[40:43], a[180:183], v[168:171], a[40:43]
  ds_read_b128 a[148:151], v3 offset:13312
  v_cvt_pk_bf16_f32 v179, v222, v223
  v_mfma_f32_16x16x32_bf16 a[44:47], a[180:183], v[172:175], a[44:47]
  v_exp_f32 v222, v142
  v_mfma_f32_16x16x32_bf16 a[104:107], a[180:183], v[184:187], a[104:107]
  buffer_load_dwordx4 v2, s[48:51], s27 offen offset:3072 lds
  v_add_f32 v227, v216, v217
  v_mfma_f32_16x16x32_bf16 a[108:111], a[180:183], v[188:191], a[108:111]
  s_add_u32 s27, s27, 16384
  v_exp_f32 v223, v143
  v_mfma_f32_16x16x32_bf16 a[48:51], a[184:187], v[168:171], a[48:51]
  s_add_u32 s25, s25, 32768
  ds_read_b128 a[152:155], v3 offset:14336
  v_cvt_pk_bf16_f32 v180, v216, v217
  v_add_f32 v227, v227, v218
  v_mfma_f32_16x16x32_bf16 a[52:55], a[184:187], v[172:175], a[52:55]
  s_and_b32 s25, s25, 0x1ffff
  v_add_f32 v227, v227, v219
  v_cvt_pk_bf16_f32 v181, v218, v219
  v_mfma_f32_16x16x32_bf16 a[112:115], a[184:187], v[184:187], a[112:115]
  v_max3_f32 v5, v224, v225, v226
  v_add_f32 v227, v227, v220
  v_mfma_f32_16x16x32_bf16 a[116:119], a[184:187], v[188:191], a[116:119]
  v_add_f32 v227, v227, v221
  v_cvt_pk_bf16_f32 v182, v220, v221
  v_mfma_f32_16x16x32_bf16 a[56:59], a[188:191], v[168:171], a[56:59]
  ds_read_b128 a[156:159], v3 offset:15360
  v_add_f32 v227, v227, v222
  v_mfma_f32_16x16x32_bf16 a[60:63], a[188:191], v[172:175], a[60:63]
  s_sub_u32 s28, s28, 1
  v_add_f32 v227, v227, v223
  v_cvt_pk_bf16_f32 v183, v222, v223
  v_mfma_f32_16x16x32_bf16 a[120:123], a[188:191], v[184:187], a[120:123]
  s_waitcnt lgkmcnt(4)
  v_max_f32 v5, v5, v227
  v_cmp_lt_f32 vcc, s81, v5
  v_mfma_f32_16x16x32_bf16 a[124:127], a[188:191], v[188:191], a[124:127]
  s_cbranch_vccnz k2_stub2
k2_back2:
  v_add_f32 v228, v228, v224
  v_add_f32 v229, v229, v225
  v_add_f32 v230, v230, v226
  v_add_f32 v231, v231, v227
  v_add_u32 v3, 32768, v3
  v_and_b32 v3, 0x1ffff, v3
  s_cmp_lg_u32 s28, 0
  s_cbranch_scc1 k2_DD
k2_Aexit:
  s_bitcmp1_b32 s20, 0
  s_cbranch_scc1 k2_Aodd
  v_mfma_f32_16x16x32_bf16 v[96:99], a[128:131], v[32:35], v[192:195]
  s_waitcnt vmcnt(12)
  v_exp_f32 v208, v112
  v_mfma_f32_16x16x32_bf16 v[104:107], a[128:131], v[36:39], v[196:199]
  s_barrier
  v_exp_f32 v209, v113
  v_mfma_f32_16x16x32_bf16 v[128:131], a[128:131], v[64:67], v[200:203]
  ds_read_b128 a[160:163], v3 offset:16384
  v_add_f32 v224, v208, v209
  v_mfma_f32_16x16x32_bf16 v[136:139], a[128:131], v[68:71], v[204:207]
  v_exp_f32 v210, v114
  v_mfma_f32_16x16x32_bf16 v[100:103], a[132:135], v[32:35], v[192:195]
  ds_read_b128 a[164:167], v3 offset:17408
  v_cvt_pk_bf16_f32 v168, v208, v209
  v_mfma_f32_16x16x32_bf16 v[108:111], a[132:135], v[36:39], v[196:199]
  s_mov_b32 m0, s24
  v_exp_f32 v211, v115
  v_mfma_f32_16x16x32_bf16 v[132:135], a[132:135], v[64:67], v[200:203]
  buffer_load_dwordx4 v2, s[44:47], s26 offen offset:0 lds
  v_add_f32 v224, v224, v210
  v_add_f32 v224, v224, v211
  v_mfma_f32_16x16x32_bf16 v[140:143], a[132:135], v[68:71], v[204:207]
  v_exp_f32 v212, v116
  v_mfma_f32_16x16x32_bf16 v[96:99], a[136:139], v[40:43], v[96:99]
  ds_read_b128 a[168:171], v3 offset:18432
  v_cvt_pk_bf16_f32 v169, v210, v211
  v_mfma_f32_16x16x32_bf16 v[104:107], a[136:139], v[44:47], v[104:107]
  v_exp_f32 v213, v117
  v_mfma_f32_16x16x32_bf16 v[128:131], a[136:139], v[72:75], v[128:131]
  v_exp_f32 v214, v118
  v_mfma_f32_16x16x32_bf16 v[136:139], a[136:139], v[76:79], v[136:139]
  v_exp_f32 v215, v119
  v_mfma_f32_16x16x32_bf16 v[100:103], a[140:143], v[40:43], v[100:103]
  ds_read_b128 a[172:175], v3 offset:19456
  v_add_f32 v224, v224, v212
  v_mfma_f32_16x16x32_bf16 v[108:111], a[140:143], v[44:47], v[108:111]
  v_exp_f32 v208, v120
  v_mfma_f32_16x16x32_bf16 v[132:135], a[140:143], v[72:75], v[132:135]
  v_exp_f32 v209, v121
  v_mfma_f32_16x16x32_bf16 v[140:143], a[140:143], v[76:79], v[140:143]
  s_waitcnt lgkmcnt(4)
  v_exp_f32 v210, v122
  v_mfma_f32_16x16x32_bf16 v[96:99], a[144:147], v[48:51], v[96:99]
  ds_read_b128 a[176:179], v3 offset:20480
  v_add_f32 v224, v224, v213
  v_mfma_f32_16x16x32_bf16 v[104:107], a[144:147], v[52:55], v[104:107]
  v_exp_f32 v211, v123
  v_mfma_f32_16x16x32_bf16 v[128:131], a[144:147], v[80:83], v[128:131]
  v_cvt_pk_bf16_f32 v170, v212, v213
  v_add_f32 v224, v224, v214
  v_add_f32 v224, v224, v215
  v_mfma_f32_16x16x32_bf16 v[136:139], a[144:147], v[84:87], v[136:139]
  v_exp_f32 v212, v124
  v_mfma_f32_16x16x32_bf16 v[100:103], a[148:151], v[48:51], v[100:103]
  ds_read_b128 a[180:183], v3 offset:21504
  v_cvt_pk_bf16_f32 v171, v214, v215
  v_mfma_f32_16x16x32_bf16 v[108:111], a[148:151], v[52:55], v[108:111]
  v_exp_f32 v213, v125
  v_mfma_f32_16x16x32_bf16 v[132:135], a[148:151], v[80:83], v[132:135]
  buffer_load_dwordx4 v2, s[44:47], s26 offen offset:1024 lds
  v_add_f32 v225, v208, v209
  v_mfma_f32_16x16x32_bf16 v[140:143], a[148:151], v[84:87], v[140:143]
  v_exp_f32 v214, v126
  v_mfma_f32_16x16x32_bf16 v[96:99], a[152:155], v[56:59], v[96:99]
  ds_read_b128 a[184:187], v3 offset:22528
  v_cvt_pk_bf16_f32 v172, v208, v209
  v_mfma_f32_16x16x32_bf16 v[104:107], a[152:155], v[60:63], v[104:107]
  v_exp_f32 v215, v127
  v_mfma_f32_16x16x32_bf16 v[128:131], a[152:155], v[88:91], v[128:131]
  v_exp_f32 v216, v144
  v_mfma_f32_16x16x32_bf16 v[136:139], a[152:155], v[92:95], v[136:139]
  v_exp_f32 v217, v145
  v_mfma_f32_16x16x32_bf16 v[100:103], a[156:159], v[56:59], v[100:103]
  ds_read_b128 a[188:191], v3 offset:23552
  v_add_f32 v225, v225, v210
  v_mfma_f32_16x16x32_bf16 v[108:111], a[156:159], v[60:63], v[108:111]
  v_exp_f32 v218, v146
  v_mfma_f32_16x16x32_bf16 v[132:135], a[156:159], v[88:91], v[132:135]
  v_exp_f32 v219, v147
  v_mfma_f32_16x16x32_bf16 v[140:143], a[156:159], v[92:95], v[140:143]
  s_waitcnt lgkmcnt(4)
  v_exp_f32 v220, v148
  v_add_f32 v225, v225, v211
  v_mfma_f32_16x16x32_bf16 a[0:3], a[160:163], v[160:163], a[0:3]
  ds_read_b128 a[128:131], v3 offset:0
  v_cvt_pk_bf16_f32 v173, v210, v211
  v_mfma_f32_16x16x32_bf16 a[4:7], a[160:163], v[164:167], a[4:7]
  v_exp_f32 v221, v149
  v_mfma_f32_16x16x32_bf16 a[64:67], a[160:163], v[176:179], a[64:67]
  v_exp_f32 v222, v150
  v_mfma_f32_16x16x32_bf16 a[68:71], a[160:163], v[180:183], a[68:71]
  v_exp_f32 v223, v151
  v_mfma_f32_16x16x32_bf16 a[8:11], a[164:167], v[160:163], a[8:11]
  ds_read_b128 a[132:135], v3 offset:1024
  v_add_f32 v225, v225, v212
  v_mfma_f32_16x16x32_bf16 a[12:15], a[164:167], v[164:167], a[12:15]
  v_add_f32 v225, v225, v213
  v_cvt_pk_bf16_f32 v174, v212, v213
  v_mfma_f32_16x16x32_bf16 a[72:75], a[164:167], v[176:179], a[72:75]
  buffer_load_dwordx4 v2, s[44:47], s26 offen offset:2048 lds
  v_add_f32 v225, v225, v214
  v_mfma_f32_16x16x32_bf16 a[76:79], a[164:167], v[180:183], a[76:79]
  v_add_f32 v225, v225, v215
  v_cvt_pk_bf16_f32 v175, v214, v215
  v_mfma_f32_16x16x32_bf16 a[16:19], a[168:171], v[160:163], a[16:19]
  ds_read_b128 a[136:139], v3 offset:2048
  v_add_f32 v226, v216, v217
  v_mfma_f32_16x16x32_bf16 a[20:23], a[168:171], v[164:167], a[20:23]
  v_cvt_pk_bf16_f32 v184, v216, v217
  v_add_f32 v226, v226, v218
  v_mfma_f32_16x16x32_bf16 a[80:83], a[168:171], v[176:179], a[80:83]
  v_exp_f32 v216, v152
  v_mfma_f32_16x16x32_bf16 a[84:87], a[168:171], v[180:183], a[84:87]
  v_exp_f32 v217, v153
  v_mfma_f32_16x16x32_bf16 a[24:27], a[172:175], v[160:163], a[24:27]
  ds_read_b128 a[140:143], v3 offset:3072
  v_add_f32 v226, v226, v219
  v_cvt_pk_bf16_f32 v185, v218, v219
  v_mfma_f32_16x16x32_bf16 a[28:31], a[172:175], v[164:167], a[28:31]
  v_exp_f32 v218, v154
  v_mfma_f32_16x16x32_bf16 a[88:91], a[172:175], v[176:179], a[88:91]
  v_add_f32 v226, v226, v220
  v_add_f32 v226, v226, v221
  v_mfma_f32_16x16x32_bf16 a[92:95], a[172:175], v[180:183], a[92:95]
  s_waitcnt lgkmcnt(4)
  v_exp_f32 v219, v155
  v_mfma_f32_16x16x32_bf16 a[32:35], a[176:179], v[160:163], a[32:35]
  ds_read_b128 a[144:147], v3 offset:4096
  v_cvt_pk_bf16_f32 v186, v220, v221
  v_mfma_f32_16x16x32_bf16 a[36:39], a[176:179], v[164:167], a[36:39]
  v_exp_f32 v220, v156
  v_mfma_f32_16x16x32_bf16 a[96:99], a[176:179], v[176:179], a[96:99]
  v_add_f32 v226, v226, v222
  v_add_f32 v226, v226, v223
  v_mfma_f32_16x16x32_bf16 a[100:103], a[176:179], v[180:183], a[100:103]
  v_exp_f32 v221, v157
  v_mfma_f32_16x16x32_bf16 a[40:43], a[180:183], v[160:163], a[40:43]
  ds_read_b128 a[148:151], v3 offset:5120
  v_cvt_pk_bf16_f32 v187, v222, v223
  v_mfma_f32_16x16x32_bf16 a[44:47], a[180:183], v[164:167], a[44:47]
  v_exp_f32 v222, v158
  v_mfma_f32_16x16x32_bf16 a[104:107], a[180:183], v[176:179], a[104:107]
  buffer_load_dwordx4 v2, s[44:47], s26 offen offset:3072 lds
  v_add_f32 v227, v216, v217
  v_mfma_f32_16x16x32_bf16 a[108:111], a[180:183], v[180:183], a[108:111]
  s_add_u32 s26, s26, 16384
  v_exp_f32 v223, v159
  v_mfma_f32_16x16x32_bf16 a[48:51], a[184:187], v[160:163], a[48:51]
  s_add_u32 s24, s24, 32768
  ds_read_b128 a[152:155], v3 offset:6144
  v_cvt_pk_bf16_f32 v188, v216, v217
  v_add_f32 v227, v227, v218
  v_mfma_f32_16x16x32_bf16 a[52:55], a[184:187], v[164:167], a[52:55]
  s_and_b32 s24, s24, 0x1ffff
  v_add_f32 v227, v227, v219
  v_cvt_pk_bf16_f32 v189, v218, v219
  v_mfma_f32_16x16x32_bf16 a[112:115], a[184:187], v[176:179], a[112:115]
  v_max3_f32 v5, v224, v225, v226
  v_add_f32 v227, v227, v220
  v_mfma_f32_16x16x32_bf16 a[116:119], a[184:187], v[180:183], a[116:119]
  v_add_f32 v227, v227, v221
  v_cvt_pk_bf16_f32 v190, v220, v221
  v_mfma_f32_16x16x32_bf16 a[56:59], a[188:191], v[160:163], a[56:59]
  ds_read_b128 a[156:159], v3 offset:7168
  v_add_f32 v227, v227, v222
  v_mfma_f32_16x16x32_bf16 a[60:63], a[188:191], v[164:167], a[60:63]
  v_add_f32 v227, v227, v223
  v_cvt_pk_bf16_f32 v191, v222, v223
  v_mfma_f32_16x16x32_bf16 a[120:123], a[188:191], v[176:179], a[120:123]
  s_waitcnt lgkmcnt(4)
  v_max_f32 v5, v5, v227
  v_cmp_lt_f32 vcc, s81, v5
  v_mfma_f32_16x16x32_bf16 a[124:127], a[188:191], v[180:183], a[124:127]
  s_cbranch_vccnz k2_stub3
k2_back3:
  v_add_f32 v228, v228, v224
  v_add_f32 v229, v229, v225
  v_add_f32 v230, v230, v226
  v_add_f32 v231, v231, v227
  v_mfma_f32_16x16x32_bf16 v[144:147], a[128:131], v[64:67], v[200:203]
  ds_read_b128 a[160:163], v3 offset:24576
  v_cndmask_b32 v96, v4, v96, s[68:69]
  v_cndmask_b32 v97, v4, v97, s[70:71]
  v_mfma_f32_16x16x32_bf16 v[152:155], a[128:131], v[68:71], v[204:207]
  v_cndmask_b32 v98, v4, v98, s[72:73]
  v_cndmask_b32 v99, v4, v99, s[74:75]
  v_mov_b32 v100, v4
  v_mfma_f32_16x16x32_bf16 v[148:151], a[132:135], v[64:67], v[200:203]
  ds_read_b128 a[164:167], v3 offset:25600
  v_mov_b32 v101, v4
  v_mov_b32 v102, v4
  v_mfma_f32_16x16x32_bf16 v[156:159], a[132:135], v[68:71], v[204:207]
  v_mov_b32 v103, v4
  v_cndmask_b32 v108, v4, v108, s[68:69]
  v_cndmask_b32 v109, v4, v109, s[70:71]
  v_mfma_f32_16x16x32_bf16 v[144:147], a[136:139], v[72:75], v[144:147]
  ds_read_b128 a[168:171], v3 offset:26624
  v_cndmask_b32 v110, v4, v110, s[72:73]
  v_cndmask_b32 v111, v4, v111, s[74:75]
  v_mfma_f32_16x16x32_bf16 v[152:155], a[136:139], v[76:79], v[152:155]
  s_mov_b32 m0, s25
  v_exp_f32 v208, v96
  v_exp_f32 v209, v97
  v_mfma_f32_16x16x32_bf16 v[148:151], a[140:143], v[72:75], v[148:151]
  ds_read_b128 a[172:175], v3 offset:27648
  buffer_load_dwordx4 v2, s[48:51], s27 offen offset:0 lds
  v_mfma_f32_16x16x32_bf16 v[156:159], a[140:143], v[76:79], v[156:159]
  s_waitcnt lgkmcnt(4)
  v_exp_f32 v210, v98
  v_add_f32 v224, v208, v209
  v_mfma_f32_16x16x32_bf16 v[144:147], a[144:147], v[80:83], v[144:147]
  ds_read_b128 a[176:179], v3 offset:28672
  v_exp_f32 v211, v99
  v_mfma_f32_16x16x32_bf16 v[152:155], a[144:147], v[84:87], v[152:155]
  v_exp_f32 v212, v100
  v_cvt_pk_bf16_f32 v160, v208, v209
  v_mfma_f32_16x16x32_bf16 v[148:151], a[148:151], v[80:83], v[148:151]
  ds_read_b128 a[180:183], v3 offset:29696
  v_exp_f32 v213, v101
  v_mfma_f32_16x16x32_bf16 v[156:159], a[148:151], v[84:87], v[156:159]
  v_exp_f32 v214, v102
  v_add_f32 v224, v224, v210
  v_add_f32 v224, v224, v211
  v_mfma_f32_16x16x32_bf16 v[144:147], a[152:155], v[88:91], v[144:147]
  ds_read_b128 a[184:187], v3 offset:30720
  v_cvt_pk_bf16_f32 v161, v210, v211
  v_add_f32 v224, v224, v212
  v_mfma_f32_16x16x32_bf16 v[152:155], a[152:155], v[92:95], v[152:155]
  v_exp_f32 v215, v103
  v_add_f32 v224, v224, v213
  v_mfma_f32_16x16x32_bf16 v[148:151], a[156:159], v[88:91], v[148:151]
  ds_read_b128 a[188:191], v3 offset:31744
  v_cvt_pk_bf16_f32 v162, v212, v213
  v_add_f32 v224, v224, v214
  v_mfma_f32_16x16x32_bf16 v[156:159], a[156:159], v[92:95], v[156:159]
  s_waitcnt lgkmcnt(4)
  v_exp_f32 v208, v104
  v_add_f32 v224, v224, v215
  v_mfma_f32_16x16x32_bf16 a[0:3], a[160:163], v[168:171], a[0:3]
  ds_read_b128 a[128:131], v3 offset:8192
  v_cvt_pk_bf16_f32 v163, v214, v215
  v_exp_f32 v209, v105
  v_mfma_f32_16x16x32_bf16 a[4:7], a[160:163], v[172:175], a[4:7]
  v_exp_f32 v210, v106
  v_mfma_f32_16x16x32_bf16 a[64:67], a[160:163], v[184:187], a[64:67]
  buffer_load_dwordx4 v2, s[48:51], s27 offen offset:1024 lds
  v_exp_f32 v211, v107
  v_mfma_f32_16x16x32_bf16 a[68:71], a[160:163], v[188:191], a[68:71]
  v_exp_f32 v212, v108
  v_add_f32 v225, v208, v209
  v_mfma_f32_16x16x32_bf16 a[8:11], a[164:167], v[168:171], a[8:11]
  ds_read_b128 a[132:135], v3 offset:9216
  v_exp_f32 v213, v109
  v_mfma_f32_16x16x32_bf16 a[12:15], a[164:167], v[172:175], a[12:15]
  v_exp_f32 v214, v110
  v_cvt_pk_bf16_f32 v164, v208, v209
  v_mfma_f32_16x16x32_bf16 a[72:75], a[164:167], v[184:187], a[72:75]
  v_exp_f32 v215, v111
  v_add_f32 v225, v225, v210
  v_mfma_f32_16x16x32_bf16 a[76:79], a[164:167], v[188:191], a[76:79]
  v_exp_f32 v216, v128
  v_add_f32 v225, v225, v211
  v_mfma_f32_16x16x32_bf16 a[16:19], a[168:171], v[168:171], a[16:19]
  ds_read_b128 a[136:139], v3 offset:10240
  v_exp_f32 v217, v129
  v_mfma_f32_16x16x32_bf16 a[20:23], a[168:171], v[172:175], a[20:23]
  v_exp_f32 v218, v130
  v_cvt_pk_bf16_f32 v165, v210, v211
  v_mfma_f32_16x16x32_bf16 a[80:83], a[168:171], v[184:187], a[80:83]
  v_exp_f32 v219, v131
  v_add_f32 v225, v225, v212
  v_mfma_f32_16x16x32_bf16 a[84:87], a[168:171], v[188:191], a[84:87]
  v_exp_f32 v220, v132
  v_add_f32 v225, v225, v213
  v_mfma_f32_16x16x32_bf16 a[24:27], a[172:175], v[168:171], a[24:27]
  ds_read_b128 a[140:143], v3 offset:11264
  v_exp_f32 v221, v133
  v_mfma_f32_16x16x32_bf16 a[28:31], a[172:175], v[172:175], a[28:31]
  v_exp_f32 v222, v134
  v_cvt_pk_bf16_f32 v166, v212, v213
  v_mfma_f32_16x16x32_bf16 a[88:91], a[172:175], v[184:187], a[88:91]
  buffer_load_dwordx4 v2, s[48:51], s27 offen offset:2048 lds
  v_exp_f32 v223, v135
  v_mfma_f32_16x16x32_bf16 a[92:95], a[172:175], v[188:191], a[92:95]
  s_waitcnt lgkmcnt(4)
  v_add_f32 v225, v225, v214
  v_add_f32 v225, v225, v215
  v_cvt_pk_bf16_f32 v167, v214, v215
  v_mfma_f32_16x16x32_bf16 a[32:35], a[176:179], v[168:171], a[32:35]
  ds_read_b128 a[144:147], v3 offset:12288
  v_add_f32 v226, v216, v217
  v_cvt_pk_bf16_f32 v176, v216, v217
  v_mfma_f32_16x16x32_bf16 a[36:39], a[176:179], v[172:175], a[36:39]
  v_exp_f32 v216, v136
  v_add_f32 v226, v226, v218
  v_mfma_f32_16x16x32_bf16 a[96:99], a[176:179], v[184:187], a[96:99]
  v_exp_f32 v217, v137
  v_add_f32 v226, v226, v219
  v_mfma_f32_16x16x32_bf16 a[100:103], a[176:179], v[188:191], a[100:103]
  v_cvt_pk_bf16_f32 v177, v218, v219
  v_add_f32 v226, v226, v220
  v_add_f32 v226, v226, v221
  v_cvt_pk_bf16_f32 v178, v220, v221
  v_mfma_f32_16x16x32_bf16 a[40:43], a[180:183], v[168:171], a[40:43]
  ds_read_b128 a[148:151], v3 offset:13312
  v_add_f32 v226, v226, v222
  v_add_f32 v226, v226, v223
  v_mfma_f32_16x16x32_bf16 a[44:47], a[180:183], v[172:175], a[44:47]
  v_exp_f32 v218, v138
  v_cvt_pk_bf16_f32 v179, v222, v223
  v_mfma_f32_16x16x32_bf16 a[104:107], a[180:183], v[184:187], a[104:107]
  v_exp_f32 v219, v139
  v_add_f32 v227, v216, v217
  v_mfma_f32_16x16x32_bf16 a[108:111], a[180:183], v[188:191], a[108:111]
  v_exp_f32 v220, v140
  v_cvt_pk_bf16_f32 v180, v216, v217
  v_mfma_f32_16x16x32_bf16 a[48:51], a[184:187], v[168:171], a[48:51]
  ds_read_b128 a[152:155], v3 offset:14336
  v_add_f32 v227, v227, v218
  v_add_f32 v227, v227, v219
  v_mfma_f32_16x16x32_bf16 a[52:55], a[184:187], v[172:175], a[52:55]
  v_exp_f32 v221, v141
  v_cvt_pk_bf16_f32 v181, v218, v219
  v_mfma_f32_16x16x32_bf16 a[112:115], a[184:187], v[184:187], a[112:115]
  buffer_load_dwordx4 v2, s[48:51], s27 offen offset:3072 lds
  v_max3_f32 v5, v224, v225, v226
  v_add_f32 v227, v227, v220
  v_mfma_f32_16x16x32_bf16 a[116:119], a[184:187], v[188:191], a[116:119]
  s_add_u32 s27, s27, 16384
  v_exp_f32 v222, v142
  v_add_f32 v227, v227, v221
  v_mfma_f32_16x16x32_bf16 a[56:59], a[188:191], v[168:171], a[56:59]
  s_add_u32 s25, s25, 32768
  ds_read_b128 a[156:159], v3 offset:15360
  v_cvt_pk_bf16_f32 v182, v220, v221
  v_add_f32 v227, v227, v222
  v_mfma_f32_16x16x32_bf16 a[60:63], a[188:191], v[172:175], a[60:63]
  s_and_b32 s25, s25, 0x1ffff
  v_exp_f32 v223, v143
  v_mfma_f32_16x16x32_bf16 a[120:123], a[188:191], v[184:187], a[120:123]
  s_waitcnt lgkmcnt(4)
  v_add_f32 v227, v227, v223
  v_cvt_pk_bf16_f32 v183, v222, v223
  v_max_f32 v5, v5, v227
  v_cmp_lt_f32 vcc, s81, v5
  v_mfma_f32_16x16x32_bf16 a[124:127], a[188:191], v[188:191], a[124:127]
  s_cbranch_vccnz k2_stub4
k2_back4:
  v_add_f32 v228, v228, v224
  v_add_f32 v229, v229, v225
  v_add_f32 v230, v230, v226
  v_add_f32 v231, v231, v227
  v_add_u32 v3, 32768, v3
  v_and_b32 v3, 0x1ffff, v3
k2_AV:
  v_mfma_f32_16x16x32_bf16 v[128:131], a[128:131], v[64:67], v[200:203]
  s_waitcnt vmcnt(12)
  v_exp_f32 v216, v144
  v_mfma_f32_16x16x32_bf16 v[136:139], a[128:131], v[68:71], v[204:207]
  s_barrier
  v_exp_f32 v217, v145
  v_mfma_f32_16x16x32_bf16 v[132:135], a[132:135], v[64:67], v[200:203]
  ds_read_b128 a[160:163], v3 offset:16384
  ds_read_b128 a[164:167], v3 offset:17408
  v_mfma_f32_16x16x32_bf16 v[140:143], a[132:135], v[68:71], v[204:207]
  v_exp_f32 v218, v146
  v_mfma_f32_16x16x32_bf16 v[128:131], a[136:139], v[72:75], v[128:131]
  ds_read_b128 a[168:171], v3 offset:18432
  v_add_f32 v226, v216, v217
  v_mfma_f32_16x16x32_bf16 v[136:139], a[136:139], v[76:79], v[136:139]
  s_mov_b32 m0, s24
  v_exp_f32 v219, v147
  v_mfma_f32_16x16x32_bf16 v[132:135], a[140:143], v[72:75], v[132:135]
  ds_read_b128 a[172:175], v3 offset:19456
  buffer_load_dwordx4 v2, s[44:47], s26 offen offset:0 lds
  v_mfma_f32_16x16x32_bf16 v[140:143], a[140:143], v[76:79], v[140:143]
  s_waitcnt lgkmcnt(4)
  v_exp_f32 v220, v148
  v_mfma_f32_16x16x32_bf16 v[128:131], a[144:147], v[80:83], v[128:131]
  ds_read_b128 a[176:179], v3 offset:20480
  v_cvt_pk_bf16_f32 v184, v216, v217
  v_mfma_f32_16x16x32_bf16 v[136:139], a[144:147], v[84:87], v[136:139]
  v_exp_f32 v221, v149
  v_mfma_f32_16x16x32_bf16 v[132:135], a[148:151], v[80:83], v[132:135]
  ds_read_b128 a[180:183], v3 offset:21504
  v_add_f32 v226, v226, v218
  v_mfma_f32_16x16x32_bf16 v[140:143], a[148:151], v[84:87], v[140:143]
  v_exp_f32 v222, v150
  v_mfma_f32_16x16x32_bf16 v[128:131], a[152:155], v[88:91], v[128:131]
  ds_read_b128 a[184:187], v3 offset:22528
  v_add_f32 v226, v226, v219
  v_mfma_f32_16x16x32_bf16 v[136:139], a[152:155], v[92:95], v[136:139]
  v_exp_f32 v223, v151
  v_mfma_f32_16x16x32_bf16 v[132:135], a[156:159], v[88:91], v[132:135]
  ds_read_b128 a[188:191], v3 offset:23552
  v_cvt_pk_bf16_f32 v185, v218, v219
  v_mfma_f32_16x16x32_bf16 v[140:143], a[156:159], v[92:95], v[140:143]
  s_waitcnt lgkmcnt(4)
  v_exp_f32 v216, v152
  v_mfma_f32_16x16x32_bf16 a[0:3], a[160:163], v[160:163], a[0:3]
  ds_read_b128 a[128:131], v3 offset:0
  v_add_f32 v226, v226, v220
  v_mfma_f32_16x16x32_bf16 a[4:7], a[160:163], v[164:167], a[4:7]
  v_exp_f32 v217, v153
  v_mfma_f32_16x16x32_bf16 a[64:67], a[160:163], v[176:179], a[64:67]
  buffer_load_dwordx4 v2, s[44:47], s26 offen offset:1024 lds
  v_add_f32 v226, v226, v221
  v_mfma_f32_16x16x32_bf16 a[68:71], a[160:163], v[180:183], a[68:71]
  v_exp_f32 v218, v154
  v_mfma_f32_16x16x32_bf16 a[8:11], a[164:167], v[160:163], a[8:11]
  ds_read_b128 a[132:135], v3 offset:1024
  v_cvt_pk_bf16_f32 v186, v220, v221
  v_mfma_f32_16x16x32_bf16 a[12:15], a[164:167], v[164:167], a[12:15]
  v_exp_f32 v219, v155
  v_mfma_f32_16x16x32_bf16 a[72:75], a[164:167], v[176:179], a[72:75]
  v_exp_f32 v220, v156
  v_mfma_f32_16x16x32_bf16 a[76:79], a[164:167], v[180:183], a[76:79]
  v_add_f32 v226, v226, v222
  v_add_f32 v226, v226, v223
  v_mfma_f32_16x16x32_bf16 a[16:19], a[168:171], v[160:163], a[16:19]
  ds_read_b128 a[136:139], v3 offset:2048
  v_cvt_pk_bf16_f32 v187, v222, v223
  v_mfma_f32_16x16x32_bf16 a[20:23], a[168:171], v[164:167], a[20:23]
  v_exp_f32 v221, v157
  v_mfma_f32_16x16x32_bf16 a[80:83], a[168:171], v[176:179], a[80:83]
  v_exp_f32 v222, v158
  v_mfma_f32_16x16x32_bf16 a[84:87], a[168:171], v[180:183], a[84:87]
  v_exp_f32 v223, v159
  v_mfma_f32_16x16x32_bf16 a[24:27], a[172:175], v[160:163], a[24:27]
  ds_read_b128 a[140:143], v3 offset:3072
  v_add_f32 v227, v216, v217
  v_mfma_f32_16x16x32_bf16 a[28:31], a[172:175], v[164:167], a[28:31]
  v_cvt_pk_bf16_f32 v188, v216, v217
  v_add_f32 v227, v227, v218
  v_mfma_f32_16x16x32_bf16 a[88:91], a[172:175], v[176:179], a[88:91]
  buffer_load_dwordx4 v2, s[44:47], s26 offen offset:2048 lds
  v_add_f32 v227, v227, v219
  v_mfma_f32_16x16x32_bf16 a[92:95], a[172:175], v[180:183], a[92:95]
  s_waitcnt lgkmcnt(4)
  v_cvt_pk_bf16_f32 v189, v218, v219
  v_add_f32 v227, v227, v220
  v_mfma_f32_16x16x32_bf16 a[32:35], a[176:179], v[160:163], a[32:35]
  ds_read_b128 a[144:147], v3 offset:4096
  v_add_f32 v227, v227, v221
  v_mfma_f32_16x16x32_bf16 a[36:39], a[176:179], v[164:167], a[36:39]
  v_cvt_pk_bf16_f32 v190, v220, v221
  v_add_f32 v227, v227, v222
  v_mfma_f32_16x16x32_bf16 a[96:99], a[176:179], v[176:179], a[96:99]
  v_add_f32 v227, v227, v223
  v_cvt_pk_bf16_f32 v191, v222, v223
  v_mfma_f32_16x16x32_bf16 a[100:103], a[176:179], v[180:183], a[100:103]
  v_max_f32 v5, v226, v227
  v_cmp_lt_f32 vcc, s81, v5
  v_mfma_f32_16x16x32_bf16 a[40:43], a[180:183], v[160:163], a[40:43]
  ds_read_b128 a[148:151], v3 offset:5120
  v_mfma_f32_16x16x32_bf16 a[44:47], a[180:183], v[164:167], a[44:47]
  v_mfma_f32_16x16x32_bf16 a[104:107], a[180:183], v[176:179], a[104:107]
  v_mfma_f32_16x16x32_bf16 a[108:111], a[180:183], v[180:183], a[108:111]
  v_mfma_f32_16x16x32_bf16 a[48:51], a[184:187], v[160:163], a[48:51]
  ds_read_b128 a[152:155], v3 offset:6144
  v_mfma_f32_16x16x32_bf16 a[52:55], a[184:187], v[164:167], a[52:55]
  v_mfma_f32_16x16x32_bf16 a[112:115], a[184:187], v[176:179], a[112:115]
  buffer_load_dwordx4 v2, s[44:47], s26 offen offset:3072 lds
  v_mfma_f32_16x16x32_bf16 a[116:119], a[184:187], v[180:183], a[116:119]
  s_add_u32 s26, s26, 16384
  v_mfma_f32_16x16x32_bf16 a[56:59], a[188:191], v[160:163], a[56:59]
  s_add_u32 s24, s24, 32768
  ds_read_b128 a[156:159], v3 offset:7168
  v_mfma_f32_16x16x32_bf16 a[60:63], a[188:191], v[164:167], a[60:63]
  s_and_b32 s24, s24, 0x1ffff
  v_mfma_f32_16x16x32_bf16 a[120:123], a[188:191], v[176:179], a[120:123]
  s_waitcnt lgkmcnt(4)
  v_mfma_f32_16x16x32_bf16 a[124:127], a[188:191], v[180:183], a[124:127]
  s_cbranch_vccnz k2_stub5
k2_back5:
  v_add_f32 v230, v230, v226
  v_add_f32 v231, v231, v227
  v_mfma_f32_16x16x32_bf16 v[144:147], a[128:131], v[64:67], v[200:203]
  ds_read_b128 a[160:163], v3 offset:24576
  v_exp_f32 v216, v128
  v_mfma_f32_16x16x32_bf16 v[152:155], a[128:131], v[68:71], v[204:207]
  v_exp_f32 v217, v129
  v_mfma_f32_16x16x32_bf16 v[148:151], a[132:135], v[64:67], v[200:203]
  ds_read_b128 a[164:167], v3 offset:25600
  v_add_f32 v226, v216, v217
  v_mfma_f32_16x16x32_bf16 v[156:159], a[132:135], v[68:71], v[204:207]
  s_mov_b32 m0, s25
  v_exp_f32 v218, v130
  v_cvt_pk_bf16_f32 v176, v216, v217
  v_mfma_f32_16x16x32_bf16 v[144:147], a[136:139], v[72:75], v[144:147]
  ds_read_b128 a[168:171], v3 offset:26624
  buffer_load_dwordx4 v2, s[48:51], s27 offen offset:0 lds
  v_mfma_f32_16x16x32_bf16 v[152:155], a[136:139], v[76:79], v[152:155]
  v_exp_f32 v219, v131
  v_add_f32 v226, v226, v218
  v_mfma_f32_16x16x32_bf16 v[148:151], a[140:143], v[72:75], v[148:151]
  ds_read_b128 a[172:175], v3 offset:27648
  v_add_f32 v226, v226, v219
  v_mfma_f32_16x16x32_bf16 v[156:159], a[140:143], v[76:79], v[156:159]
  s_waitcnt lgkmcnt(4)
  v_exp_f32 v220, v132
  v_cvt_pk_bf16_f32 v177, v218, v219
  v_mfma_f32_16x16x32_bf16 v[144:147], a[144:147], v[80:83], v[144:147]
  ds_read_b128 a[176:179], v3 offset:28672
  v_add_f32 v226, v226, v220
  v_mfma_f32_16x16x32_bf16 v[152:155], a[144:147], v[84:87], v[152:155]
  v_exp_f32 v221, v133
  v_exp_f32 v222, v134
  v_mfma_f32_16x16x32_bf16 v[148:151], a[148:151], v[80:83], v[148:151]
  ds_read_b128 a[180:183], v3 offset:29696
  buffer_load_dwordx4 v2, s[48:51], s27 offen offset:1024 lds
  v_mfma_f32_16x16x32_bf16 v[156:159], a[148:151], v[84:87], v[156:159]
  v_exp_f32 v223, v135
  v_mfma_f32_16x16x32_bf16 v[144:147], a[152:155], v[88:91], v[144:147]
  ds_read_b128 a[184:187], v3 offset:30720
  v_add_f32 v226, v226, v221
  v_mfma_f32_16x16x32_bf16 v[152:155], a[152:155], v[92:95], v[152:155]
  v_exp_f32 v216, v136
  v_mfma_f32_16x16x32_bf16 v[148:151], a[156:159], v[88:91], v[148:151]
  ds_read_b128 a[188:191], v3 offset:31744
  v_cvt_pk_bf16_f32 v178, v220, v221
  v_add_f32 v226, v226, v222
  v_mfma_f32_16x16x32_bf16 v[156:159], a[156:159], v[92:95], v[156:159]
  s_waitcnt lgkmcnt(4)
  v_exp_f32 v217, v137
  v_mfma_f32_16x16x32_bf16 a[64:67], a[160:163], v[184:187], a[64:67]
  ds_read_b128 a[128:131], v3 offset:8192
  v_add_f32 v226, v226, v223
  v_cvt_pk_bf16_f32 v179, v222, v223
  v_mfma_f32_16x16x32_bf16 a[68:71], a[160:163], v[188:191], a[68:71]
  v_exp_f32 v218, v138
  v_mfma_f32_16x16x32_bf16 a[72:75], a[164:167], v[184:187], a[72:75]
  ds_read_b128 a[132:135], v3 offset:9216
  buffer_load_dwordx4 v2, s[48:51], s27 offen offset:2048 lds
  v_add_f32 v227, v216, v217
  v_mfma_f32_16x16x32_bf16 a[76:79], a[164:167], v[188:191], a[76:79]
  v_exp_f32 v219, v139
  v_mfma_f32_16x16x32_bf16 a[80:83], a[168:171], v[184:187], a[80:83]
  ds_read_b128 a[136:139], v3 offset:10240
  v_cvt_pk_bf16_f32 v180, v216, v217
  v_mfma_f32_16x16x32_bf16 a[84:87], a[168:171], v[188:191], a[84:87]
  v_exp_f32 v220, v140
  v_add_f32 v227, v227, v218
  v_mfma_f32_16x16x32_bf16 a[88:91], a[172:175], v[184:187], a[88:91]
  ds_read_b128 a[140:143], v3 offset:11264
  v_add_f32 v227, v227, v219
  v_mfma_f32_16x16x32_bf16 a[92:95], a[172:175], v[188:191], a[92:95]
  s_waitcnt lgkmcnt(4)
  v_exp_f32 v221, v141
  v_cvt_pk_bf16_f32 v181, v218, v219
  v_mfma_f32_16x16x32_bf16 a[96:99], a[176:179], v[184:187], a[96:99]
  ds_read_b128 a[144:147], v3 offset:12288
  buffer_load_dwordx4 v2, s[48:51], s27 offen offset:3072 lds
  v_mfma_f32_16x16x32_bf16 a[100:103], a[176:179], v[188:191], a[100:103]
  s_add_u32 s27, s27, 16384
  v_exp_f32 v222, v142
  v_add_f32 v227, v227, v220
  v_mfma_f32_16x16x32_bf16 a[104:107], a[180:183], v[184:187], a[104:107]
  s_add_u32 s25, s25, 32768
  ds_read_b128 a[148:151], v3 offset:13312
  v_add_f32 v227, v227, v221
  v_mfma_f32_16x16x32_bf16 a[108:111], a[180:183], v[188:191], a[108:111]
  s_and_b32 s25, s25, 0x1ffff
  v_exp_f32 v223, v143
  v_cvt_pk_bf16_f32 v182, v220, v221
  v_mfma_f32_16x16x32_bf16 a[112:115], a[184:187], v[184:187], a[112:115]
  ds_read_b128 a[152:155], v3 offset:14336
  v_add_f32 v227, v227, v222
  v_mfma_f32_16x16x32_bf16 a[116:119], a[184:187], v[188:191], a[116:119]
  v_add_f32 v227, v227, v223
  v_cvt_pk_bf16_f32 v183, v222, v223
  v_max_f32 v5, v226, v227
  v_mfma_f32_16x16x32_bf16 a[120:123], a[188:191], v[184:187], a[120:123]
  s_waitcnt lgkmcnt(3)
  ds_read_b128 a[156:159], v3 offset:15360
  v_cmp_lt_f32 vcc, s81, v5
  v_mfma_f32_16x16x32_bf16 a[124:127], a[188:191], v[188:191], a[124:127]
  s_cbranch_vccnz k2_stub6
k2_back6:
  v_add_f32 v230, v230, v226
  v_add_f32 v231, v231, v227
  v_add_u32 v3, 32768, v3
  v_and_b32 v3, 0x1ffff, v3
  s_branch k2_SSpre
k2_Aodd:
  v_mfma_f32_16x16x32_bf16 v[128:131], a[128:131], v[64:67], v[200:203]
  s_waitcnt vmcnt(12)
  v_cndmask_b32 v112, v4, v112, s[68:69]
  v_cndmask_b32 v113, v4, v113, s[70:71]
  v_cndmask_b32 v114, v4, v114, s[72:73]
  v_mfma_f32_16x16x32_bf16 v[136:139], a[128:131], v[68:71], v[204:207]
  s_barrier
  v_cndmask_b32 v115, v4, v115, s[74:75]
  v_mov_b32 v116, v4
  v_mov_b32 v117, v4
  v_mfma_f32_16x16x32_bf16 v[132:135], a[132:135], v[64:67], v[200:203]
  ds_read_b128 a[160:163], v3 offset:16384
  ds_read_b128 a[164:167], v3 offset:17408
  v_mov_b32 v118, v4
  v_mfma_f32_16x16x32_bf16 v[140:143], a[132:135], v[68:71], v[204:207]
  v_mov_b32 v119, v4
  v_cndmask_b32 v124, v4, v124, s[68:69]
  v_cndmask_b32 v125, v4, v125, s[70:71]
  v_mfma_f32_16x16x32_bf16 v[128:131], a[136:139], v[72:75], v[128:131]
  ds_read_b128 a[168:171], v3 offset:18432
  v_cndmask_b32 v126, v4, v126, s[72:73]
  v_cndmask_b32 v127, v4, v127, s[74:75]
  v_mfma_f32_16x16x32_bf16 v[136:139], a[136:139], v[76:79], v[136:139]
  s_mov_b32 m0, s24
  v_exp_f32 v208, v112
  v_exp_f32 v209, v113
  v_mfma_f32_16x16x32_bf16 v[132:135], a[140:143], v[72:75], v[132:135]
  ds_read_b128 a[172:175], v3 offset:19456
  buffer_load_dwordx4 v2, s[44:47], s26 offen offset:0 lds
  v_mfma_f32_16x16x32_bf16 v[140:143], a[140:143], v[76:79], v[140:143]
  s_waitcnt lgkmcnt(4)
  v_exp_f32 v210, v114
  v_add_f32 v224, v208, v209
  v_mfma_f32_16x16x32_bf16 v[128:131], a[144:147], v[80:83], v[128:131]
  ds_read_b128 a[176:179], v3 offset:20480
  v_exp_f32 v211, v115
  v_mfma_f32_16x16x32_bf16 v[136:139], a[144:147], v[84:87], v[136:139]
  v_exp_f32 v212, v116
  v_cvt_pk_bf16_f32 v168, v208, v209
  v_mfma_f32_16x16x32_bf16 v[132:135], a[148:151], v[80:83], v[132:135]
  ds_read_b128 a[180:183], v3 offset:21504
  v_exp_f32 v213, v117
  v_mfma_f32_16x16x32_bf16 v[140:143], a[148:151], v[84:87], v[140:143]
  v_exp_f32 v214, v118
  v_add_f32 v224, v224, v210
  v_add_f32 v224, v224, v211
  v_mfma_f32_16x16x32_bf16 v[128:131], a[152:155], v[88:91], v[128:131]
  ds_read_b128 a[184:187], v3 offset:22528
  v_cvt_pk_bf16_f32 v169, v210, v211
  v_add_f32 v224, v224, v212
  v_mfma_f32_16x16x32_bf16 v[136:139], a[152:155], v[92:95], v[136:139]
  v_exp_f32 v215, v119
  v_add_f32 v224, v224, v213
  v_mfma_f32_16x16x32_bf16 v[132:135], a[156:159], v[88:91], v[132:135]
  ds_read_b128 a[188:191], v3 offset:23552
  v_cvt_pk_bf16_f32 v170, v212, v213
  v_add_f32 v224, v224, v214
  v_mfma_f32_16x16x32_bf16 v[140:143], a[156:159], v[92:95], v[140:143]
  s_waitcnt lgkmcnt(4)
  v_exp_f32 v208, v120
  v_add_f32 v224, v224, v215
  v_mfma_f32_16x16x32_bf16 a[0:3], a[160:163], v[160:163], a[0:3]
  ds_read_b128 a[128:131], v3 offset:0
  v_cvt_pk_bf16_f32 v171, v214, v215
  v_exp_f32 v209, v121
  v_mfma_f32_16x16x32_bf16 a[4:7], a[160:163], v[164:167], a[4:7]
  v_exp_f32 v210, v122
  v_mfma_f32_16x16x32_bf16 a[64:67], a[160:163], v[176:179], a[64:67]
  buffer_load_dwordx4 v2, s[44:47], s26 offen offset:1024 lds
  v_exp_f32 v211, v123
  v_mfma_f32_16x16x32_bf16 a[68:71], a[160:163], v[180:183], a[68:71]
  v_exp_f32 v212, v124
  v_add_f32 v225, v208, v209
  v_mfma_f32_16x16x32_bf16 a[8:11], a[164:167], v[160:163], a[8:11]
  ds_read_b128 a[132:135], v3 offset:1024
  v_exp_f32 v213, v125
  v_mfma_f32_16x16x32_bf16 a[12:15], a[164:167], v[164:167], a[12:15]
  v_exp_f32 v214, v126
  v_cvt_pk_bf16_f32 v172, v208, v209
  v_mfma_f32_16x16x32_bf16 a[72:75], a[164:167], v[176:179], a[72:75]
  v_exp_f32 v215, v127
  v_add_f32 v225, v225, v210
  v_mfma_f32_16x16x32_bf16 a[76:79], a[164:167], v[180:183], a[76:79]
  v_exp_f32 v216, v144
  v_add_f32 v225, v225, v211
  v_mfma_f32_16x16x32_bf16 a[16:19], a[168:171], v[160:163], a[16:19]
  ds_read_b128 a[136:139], v3 offset:2048
  v_exp_f32 v217, v145
  v_mfma_f32_16x16x32_bf16 a[20:23], a[168:171], v[164:167], a[20:23]
  v_exp_f32 v218, v146
  v_cvt_pk_bf16_f32 v173, v210, v211
  v_mfma_f32_16x16x32_bf16 a[80:83], a[168:171], v[176:179], a[80:83]
  v_exp_f32 v219, v147
  v_add_f32 v225, v225, v212
  v_mfma_f32_16x16x32_bf16 a[84:87], a[168:171], v[180:183], a[84:87]
  v_exp_f32 v220, v148
  v_add_f32 v225, v225, v213
  v_mfma_f32_16x16x32_bf16 a[24:27], a[172:175], v[160:163], a[24:27]
  ds_read_b128 a[140:143], v3 offset:3072
  v_exp_f32 v221, v149
  v_mfma_f32_16x16x32_bf16 a[28:31], a[172:175], v[164:167], a[28:31]
  v_exp_f32 v222, v150
  v_cvt_pk_bf16_f32 v174, v212, v213
  v_mfma_f32_16x16x32_bf16 a[88:91], a[172:175], v[176:179], a[88:91]
  buffer_load_dwordx4 v2, s[44:47], s26 offen offset:2048 lds
  v_exp_f32 v223, v151
  v_mfma_f32_16x16x32_bf16 a[92:95], a[172:175], v[180:183], a[92:95]
  s_waitcnt lgkmcnt(4)
  v_add_f32 v225, v225, v214
  v_add_f32 v225, v225, v215
  v_cvt_pk_bf16_f32 v175, v214, v215
  v_mfma_f32_16x16x32_bf16 a[32:35], a[176:179], v[160:163], a[32:35]
  ds_read_b128 a[144:147], v3 offset:4096
  v_add_f32 v226, v216, v217
  v_cvt_pk_bf16_f32 v184, v216, v217
  v_mfma_f32_16x16x32_bf16 a[36:39], a[176:179], v[164:167], a[36:39]
  v_exp_f32 v216, v152
  v_add_f32 v226, v226, v218
  v_mfma_f32_16x16x32_bf16 a[96:99], a[176:179], v[176:179], a[96:99]
  v_exp_f32 v217, v153
  v_add_f32 v226, v226, v219
  v_mfma_f32_16x16x32_bf16 a[100:103], a[176:179], v[180:183], a[100:103]
  v_cvt_pk_bf16_f32 v185, v218, v219
  v_add_f32 v226, v226, v220
  v_add_f32 v226, v226, v221
  v_cvt_pk_bf16_f32 v186, v220, v221
  v_mfma_f32_16x16x32_bf16 a[40:43], a[180:183], v[160:163], a[40:43]
  ds_read_b128 a[148:151], v3 offset:5120
  v_add_f32 v226, v226, v222
  v_add_f32 v226, v226, v223
  v_mfma_f32_16x16x32_bf16 a[44:47], a[180:183], v[164:167], a[44:47]
  v_exp_f32 v218, v154
  v_cvt_pk_bf16_f32 v187, v222, v223
  v_mfma_f32_16x16x32_bf16 a[104:107], a[180:183], v[176:179], a[104:107]
  v_exp_f32 v219, v155
  v_add_f32 v227, v216, v217
  v_mfma_f32_16x16x32_bf16 a[108:111], a[180:183], v[180:183], a[108:111]
  v_exp_f32 v220, v156
  v_cvt_pk_bf16_f32 v188, v216, v217
  v_mfma_f32_16x16x32_bf16 a[48:51], a[184:187], v[160:163], a[48:51]
  ds_read_b128 a[152:155], v3 offset:6144
  v_add_f32 v227, v227, v218
  v_add_f32 v227, v227, v219
  v_mfma_f32_16x16x32_bf16 a[52:55], a[184:187], v[164:167], a[52:55]
  v_exp_f32 v221, v157
  v_cvt_pk_bf16_f32 v189, v218, v219
  v_mfma_f32_16x16x32_bf16 a[112:115], a[184:187], v[176:179], a[112:115]
  buffer_load_dwordx4 v2, s[44:47], s26 offen offset:3072 lds
  v_max3_f32 v5, v224, v225, v226
  v_add_f32 v227, v227, v220
  v_mfma_f32_16x16x32_bf16 a[116:119], a[184:187], v[180:183], a[116:119]
  s_add_u32 s26, s26, 16384
  v_exp_f32 v222, v158
  v_add_f32 v227, v227, v221
  v_mfma_f32_16x16x32_bf16 a[56:59], a[188:191], v[160:163], a[56:59]
  s_add_u32 s24, s24, 32768
  ds_read_b128 a[156:159], v3 offset:7168
  v_cvt_pk_bf16_f32 v190, v220, v221
  v_add_f32 v227, v227, v222
  v_mfma_f32_16x16x32_bf16 a[60:63], a[188:191], v[164:167], a[60:63]
  s_and_b32 s24, s24, 0x1ffff
  v_exp_f32 v223, v159
  v_mfma_f32_16x16x32_bf16 a[120:123], a[188:191], v[176:179], a[120:123]
  s_waitcnt lgkmcnt(4)
  v_add_f32 v227, v227, v223
  v_cvt_pk_bf16_f32 v191, v222, v223
  v_max_f32 v5, v5, v227
  v_cmp_lt_f32 vcc, s81, v5
  v_mfma_f32_16x16x32_bf16 a[124:127], a[188:191], v[180:183], a[124:127]
  s_cbranch_vccnz k2_stub7
k2_back7:
  v_add_f32 v228, v228, v224
  v_add_f32 v229, v229, v225
  v_add_f32 v230, v230, v226
  v_add_f32 v231, v231, v227
  v_mfma_f32_16x16x32_bf16 v[144:147], a[128:131], v[64:67], v[200:203]
  ds_read_b128 a[160:163], v3 offset:24576
  v_exp_f32 v216, v128
  v_mfma_f32_16x16x32_bf16 v[152:155], a[128:131], v[68:71], v[204:207]
  v_exp_f32 v217, v129
  v_mfma_f32_16x16x32_bf16 v[148:151], a[132:135], v[64:67], v[200:203]
  ds_read_b128 a[164:167], v3 offset:25600
  v_mfma_f32_16x16x32_bf16 v[156:159], a[132:135], v[68:71], v[204:207]
  v_exp_f32 v218, v130
  v_mfma_f32_16x16x32_bf16 v[144:147], a[136:139], v[72:75], v[144:147]
  ds_read_b128 a[168:171], v3 offset:26624
  v_add_f32 v226, v216, v217
  v_mfma_f32_16x16x32_bf16 v[152:155], a[136:139], v[76:79], v[152:155]
  s_mov_b32 m0, s25
  v_exp_f32 v219, v131
  v_mfma_f32_16x16x32_bf16 v[148:151], a[140:143], v[72:75], v[148:151]
  ds_read_b128 a[172:175], v3 offset:27648
  buffer_load_dwordx4 v2, s[48:51], s27 offen offset:0 lds
  v_mfma_f32_16x16x32_bf16 v[156:159], a[140:143], v[76:79], v[156:159]
  s_waitcnt lgkmcnt(4)
  v_exp_f32 v220, v132
  v_mfma_f32_16x16x32_bf16 v[144:147], a[144:147], v[80:83], v[144:147]
  ds_read_b128 a[176:179], v3 offset:28672
  v_cvt_pk_bf16_f32 v176, v216, v217
  v_mfma_f32_16x16x32_bf16 v[152:155], a[144:147], v[84:87], v[152:155]
  v_exp_f32 v221, v133
  v_mfma_f32_16x16x32_bf16 v[148:151], a[148:151], v[80:83], v[148:151]
  ds_read_b128 a[180:183], v3 offset:29696
  v_add_f32 v226, v226, v218
  v_mfma_f32_16x16x32_bf16 v[156:159], a[148:151], v[84:87], v[156:159]
  v_exp_f32 v222, v134
  v_mfma_f32_16x16x32_bf16 v[144:147], a[152:155], v[88:91], v[144:147]
  ds_read_b128 a[184:187], v3 offset:30720
  v_add_f32 v226, v226, v219
  v_mfma_f32_16x16x32_bf16 v[152:155], a[152:155], v[92:95], v[152:155]
  v_exp_f32 v223, v135
  v_mfma_f32_16x16x32_bf16 v[148:151], a[156:159], v[88:91], v[148:151]
  ds_read_b128 a[188:191], v3 offset:31744
  v_cvt_pk_bf16_f32 v177, v218, v219
  v_mfma_f32_16x16x32_bf16 v[156:159], a[156:159], v[92:95], v[156:159]
  s_waitcnt lgkmcnt(4)
  v_exp_f32 v216, v136
  v_mfma_f32_16x16x32_bf16 a[0:3], a[160:163], v[168:171], a[0:3]
  ds_read_b128 a[128:131], v3 offset:8192
  v_add_f32 v226, v226, v220
  v_mfma_f32_16x16x32_bf16 a[4:7], a[160:163], v[172:175], a[4:7]
  v_exp_f32 v217, v137
  v_mfma_f32_16x16x32_bf16 a[64:67], a[160:163], v[184:187], a[64:67]
  buffer_load_dwordx4 v2, s[48:51], s27 offen offset:1024 lds
  v_add_f32 v226, v226, v221
  v_mfma_f32_16x16x32_bf16 a[68:71], a[160:163], v[188:191], a[68:71]
  v_exp_f32 v218, v138
  v_mfma_f32_16x16x32_bf16 a[8:11], a[164:167], v[168:171], a[8:11]
  ds_read_b128 a[132:135], v3 offset:9216
  v_cvt_pk_bf16_f32 v178, v220, v221
  v_mfma_f32_16x16x32_bf16 a[12:15], a[164:167], v[172:175], a[12:15]
  v_exp_f32 v219, v139
  v_mfma_f32_16x16x32_bf16 a[72:75], a[164:167], v[184:187], a[72:75]
  v_exp_f32 v220, v140
  v_mfma_f32_16x16x32_bf16 a[76:79], a[164:167], v[188:191], a[76:79]
  v_add_f32 v226, v226, v222
  v_add_f32 v226, v226, v223
  v_mfma_f32_16x16x32_bf16 a[16:19], a[168:171], v[168:171], a[16:19]
  ds_read_b128 a[136:139], v3 offset:10240
  v_cvt_pk_bf16_f32 v179, v222, v223
  v_mfma_f32_16x16x32_bf16 a[20:23], a[168:171], v[172:175], a[20:23]
  v_exp_f32 v221, v141
  v_mfma_f32_16x16x32_bf16 a[80:83], a[168:171], v[184:187], a[80:83]
  v_exp_f32 v222, v142
  v_mfma_f32_16x16x32_bf16 a[84:87], a[168:171], v[188:191], a[84:87]
  v_exp_f32 v223, v143
  v_mfma_f32_16x16x32_bf16 a[24:27], a[172:175], v[168:171], a[24:27]
  ds_read_b128 a[140:143], v3 offset:11264
  v_add_f32 v227, v216, v217
  v_mfma_f32_16x16x32_bf16 a[28:31], a[172:175], v[172:175], a[28:31]
  v_cvt_pk_bf16_f32 v180, v216, v217
  v_add_f32 v227, v227, v218
  v_mfma_f32_16x16x32_bf16 a[88:91], a[172:175], v[184:187], a[88:91]
  buffer_load_dwordx4 v2, s[48:51], s27 offen offset:2048 lds
  v_add_f32 v227, v227, v219
  v_mfma_f32_16x16x32_bf16 a[92:95], a[172:175], v[188:191], a[92:95]
  s_waitcnt lgkmcnt(4)
  v_cvt_pk_bf16_f32 v181, v218, v219
  v_add_f32 v227, v227, v220
  v_mfma_f32_16x16x32_bf16 a[32:35], a[176:179], v[168:171], a[32:35]
  ds_read_b128 a[144:147], v3 offset:12288
  v_add_f32 v227, v227, v221
  v_mfma_f32_16x16x32_bf16 a[36:39], a[176:179], v[172:175], a[36:39]
  v_cvt_pk_bf16_f32 v182, v220, v221
  v_add_f32 v227, v227, v222
  v_mfma_f32_16x16x32_bf16 a[96:99], a[176:179], v[184:187], a[96:99]
  v_add_f32 v227, v227, v223
  v_cvt_pk_bf16_f32 v183, v222, v223
  v_mfma_f32_16x16x32_bf16 a[100:103], a[176:179], v[188:191], a[100:103]
  v_max_f32 v5, v226, v227
  v_cmp_lt_f32 vcc, s81, v5
  v_mfma_f32_16x16x32_bf16 a[40:43], a[180:183], v[168:171], a[40:43]
  ds_read_b128 a[148:151], v3 offset:13312
  v_mfma_f32_16x16x32_bf16 a[44:47], a[180:183], v[172:175], a[44:47]
  v_mfma_f32_16x16x32_bf16 a[104:107], a[180:183], v[184:187], a[104:107]
  v_mfma_f32_16x16x32_bf16 a[108:111], a[180:183], v[188:191], a[108:111]
  v_mfma_f32_16x16x32_bf16 a[48:51], a[184:187], v[168:171], a[48:51]
  ds_read_b128 a[152:155], v3 offset:14336
  v_mfma_f32_16x16x32_bf16 a[52:55], a[184:187], v[172:175], a[52:55]
  v_mfma_f32_16x16x32_bf16 a[112:115], a[184:187], v[184:187], a[112:115]
  buffer_load_dwordx4 v2, s[48:51], s27 offen offset:3072 lds
  v_mfma_f32_16x16x32_bf16 a[116:119], a[184:187], v[188:191], a[116:119]
  s_add_u32 s27, s27, 16384
  v_mfma_f32_16x16x32_bf16 a[56:59], a[188:191], v[168:171], a[56:59]
  s_add_u32 s25, s25, 32768
  ds_read_b128 a[156:159], v3 offset:15360
  v_mfma_f32_16x16x32_bf16 a[60:63], a[188:191], v[172:175], a[60:63]
  s_and_b32 s25, s25, 0x1ffff
  v_mfma_f32_16x16x32_bf16 a[120:123], a[188:191], v[184:187], a[120:123]
  s_waitcnt lgkmcnt(4)
  v_mfma_f32_16x16x32_bf16 a[124:127], a[188:191], v[188:191], a[124:127]
  s_cbranch_vccnz k2_stub8
k2_back8:
  v_add_f32 v230, v230, v226
  v_add_f32 v231, v231, v227
  v_add_u32 v3, 32768, v3
  v_and_b32 v3, 0x1ffff, v3
k2_SSpre:
  s_cmp_eq_u32 s29, 0
  s_cbranch_scc1 k2_Bexit
.p2align 6
k2_SS:
  v_mfma_f32_16x16x32_bf16 v[128:131], a[128:131], v[64:67], v[200:203]
  s_waitcnt vmcnt(12)
  v_exp_f32 v216, v144
  v_mfma_f32_16x16x32_bf16 v[136:139], a[128:131], v[68:71], v[204:207]
  s_barrier
  v_exp_f32 v217, v145
  v_exp_f32 v218, v146
  v_mfma_f32_16x16x32_bf16 v[132:135], a[132:135], v[64:67], v[200:203]
  ds_read_b128 a[160:163], v3 offset:16384
  ds_read_b128 a[164:167], v3 offset:17408
  v_mfma_f32_16x16x32_bf16 v[140:143], a[132:135], v[68:71], v[204:207]
  s_mov_b32 m0, s24
  v_exp_f32 v219, v147
  v_mfma_f32_16x16x32_bf16 v[128:131], a[136:139], v[72:75], v[128:131]
  ds_read_b128 a[168:171], v3 offset:18432
  buffer_load_dwordx4 v2, s[44:47], s26 offen offset:0 lds
  v_mfma_f32_16x16x32_bf16 v[136:139], a[136:139], v[76:79], v[136:139]
  v_exp_f32 v220, v148
  v_add_f32 v226, v216, v217
  v_mfma_f32_16x16x32_bf16 v[132:135], a[140:143], v[72:75], v[132:135]
  ds_read_b128 a[172:175], v3 offset:19456
  v_cvt_pk_bf16_f32 v184, v216, v217
  v_mfma_f32_16x16x32_bf16 v[140:143], a[140:143], v[76:79], v[140:143]
  s_waitcnt lgkmcnt(4)
  v_exp_f32 v221, v149
  v_add_f32 v226, v226, v218
  v_mfma_f32_16x16x32_bf16 v[128:131], a[144:147], v[80:83], v[128:131]
  ds_read_b128 a[176:179], v3 offset:20480
  v_add_f32 v226, v226, v219
  v_mfma_f32_16x16x32_bf16 v[136:139], a[144:147], v[84:87], v[136:139]
  v_exp_f32 v222, v150
  v_cvt_pk_bf16_f32 v185, v218, v219
  v_mfma_f32_16x16x32_bf16 v[132:135], a[148:151], v[80:83], v[132:135]
  ds_read_b128 a[180:183], v3 offset:21504
  buffer_load_dwordx4 v2, s[44:47], s26 offen offset:1024 lds
  v_mfma_f32_16x16x32_bf16 v[140:143], a[148:151], v[84:87], v[140:143]
  v_exp_f32 v223, v151
  v_mfma_f32_16x16x32_bf16 v[128:131], a[152:155], v[88:91], v[128:131]
  ds_read_b128 a[184:187], v3 offset:22528
  v_add_f32 v226, v226, v220
  v_add_f32 v226, v226, v221
  v_mfma_f32_16x16x32_bf16 v[136:139], a[152:155], v[92:95], v[136:139]
  v_exp_f32 v216, v152
  v_mfma_f32_16x16x32_bf16 v[132:135], a[156:159], v[88:91], v[132:135]
  ds_read_b128 a[188:191], v3 offset:23552
  v_cvt_pk_bf16_f32 v186, v220, v221
  v_add_f32 v226, v226, v222
  v_mfma_f32_16x16x32_bf16 v[140:143], a[156:159], v[92:95], v[140:143]
  s_waitcnt lgkmcnt(4)
  v_exp_f32 v217, v153
  v_mfma_f32_16x16x32_bf16 a[64:67], a[160:163], v[176:179], a[64:67]
  ds_read_b128 a[128:131], v3 offset:0
  v_add_f32 v226, v226, v223
  v_cvt_pk_bf16_f32 v187, v222, v223
  v_mfma_f32_16x16x32_bf16 a[68:71], a[160:163], v[180:183], a[68:71]
  v_exp_f32 v218, v154
  v_mfma_f32_16x16x32_bf16 a[72:75], a[164:167], v[176:179], a[72:75]
  ds_read_b128 a[132:135], v3 offset:1024
  buffer_load_dwordx4 v2, s[44:47], s26 offen offset:2048 lds
  v_add_f32 v227, v216, v217
  v_mfma_f32_16x16x32_bf16 a[76:79], a[164:167], v[180:183], a[76:79]
  v_exp_f32 v219, v155
  v_mfma_f32_16x16x32_bf16 a[80:83], a[168:171], v[176:179], a[80:83]
  ds_read_b128 a[136:139], v3 offset:2048
  v_cvt_pk_bf16_f32 v188, v216, v217
  v_mfma_f32_16x16x32_bf16 a[84:87], a[168:171], v[180:183], a[84:87]
  v_exp_f32 v220, v156
  v_add_f32 v227, v227, v218
  v_mfma_f32_16x16x32_bf16 a[88:91], a[172:175], v[176:179], a[88:91]
  ds_read_b128 a[140:143], v3 offset:3072
  v_add_f32 v227, v227, v219
  v_mfma_f32_16x16x32_bf16 a[92:95], a[172:175], v[180:183], a[92:95]
  s_waitcnt lgkmcnt(4)
  v_exp_f32 v221, v157
  v_cvt_pk_bf16_f32 v189, v218, v219
  v_mfma_f32_16x16x32_bf16 a[96:99], a[176:179], v[176:179], a[96:99]
  ds_read_b128 a[144:147], v3 offset:4096
  buffer_load_dwordx4 v2, s[44:47], s26 offen offset:3072 lds
  v_mfma_f32_16x16x32_bf16 a[100:103], a[176:179], v[180:183], a[100:103]
  s_add_u32 s26, s26, 16384
  v_exp_f32 v222, v158
  v_add_f32 v227, v227, v220
  v_mfma_f32_16x16x32_bf16 a[104:107], a[180:183], v[176:179], a[104:107]
  s_add_u32 s24, s24, 32768
  ds_read_b128 a[148:151], v3 offset:5120
  v_add_f32 v227, v227, v221
  v_mfma_f32_16x16x32_bf16 a[108:111], a[180:183], v[180:183], a[108:111]
  s_and_b32 s24, s24, 0x1ffff
  v_exp_f32 v223, v159
  v_cvt_pk_bf16_f32 v190, v220, v221
  v_mfma_f32_16x16x32_bf16 a[112:115], a[184:187], v[176:179], a[112:115]
  ds_read_b128 a[152:155], v3 offset:6144
  v_add_f32 v227, v227, v222
  v_mfma_f32_16x16x32_bf16 a[116:119], a[184:187], v[180:183], a[116:119]
  v_add_f32 v227, v227, v223
  v_cvt_pk_bf16_f32 v191, v222, v223
  v_max_f32 v5, v226, v227
  v_mfma_f32_16x16x32_bf16 a[120:123], a[188:191], v[176:179], a[120:123]
  s_waitcnt lgkmcnt(3)
  ds_read_b128 a[156:159], v3 offset:7168
  v_cmp_lt_f32 vcc, s81, v5
  v_mfma_f32_16x16x32_bf16 a[124:127], a[188:191], v[180:183], a[124:127]
  s_cbranch_vccnz k2_stub9
k2_back9:
  v_add_f32 v230, v230, v226
  v_add_f32 v231, v231, v227
  v_mfma_f32_16x16x32_bf16 v[144:147], a[128:131], v[64:67], v[200:203]
  ds_read_b128 a[160:163], v3 offset:24576
  v_exp_f32 v216, v128
  v_mfma_f32_16x16x32_bf16 v[152:155], a[128:131], v[68:71], v[204:207]
  v_exp_f32 v217, v129
  v_mfma_f32_16x16x32_bf16 v[148:151], a[132:135], v[64:67], v[200:203]
  ds_read_b128 a[164:167], v3 offset:25600
  v_add_f32 v226, v216, v217
  v_mfma_f32_16x16x32_bf16 v[156:159], a[132:135], v[68:71], v[204:207]
  s_mov_b32 m0, s25
  v_exp_f32 v218, v130
  v_cvt_pk_bf16_f32 v176, v216, v217
  v_mfma_f32_16x16x32_bf16 v[144:147], a[136:139], v[72:75], v[144:147]
  ds_read_b128 a[168:171], v3 offset:26624
  buffer_load_dwordx4 v2, s[48:51], s27 offen offset:0 lds
  v_mfma_f32_16x16x32_bf16 v[152:155], a[136:139], v[76:79], v[152:155]
  v_exp_f32 v219, v131
  v_add_f32 v226, v226, v218
  v_mfma_f32_16x16x32_bf16 v[148:151], a[140:143], v[72:75], v[148:151]
  ds_read_b128 a[172:175], v3 offset:27648
  v_add_f32 v226, v226, v219
  v_mfma_f32_16x16x32_bf16 v[156:159], a[140:143], v[76:79], v[156:159]
  s_waitcnt lgkmcnt(4)
  v_exp_f32 v220, v132
  v_cvt_pk_bf16_f32 v177, v218, v219
  v_mfma_f32_16x16x32_bf16 v[144:147], a[144:147], v[80:83], v[144:147]
  ds_read_b128 a[176:179], v3 offset:28672
  v_add_f32 v226, v226, v220
  v_mfma_f32_16x16x32_bf16 v[152:155], a[144:147], v[84:87], v[152:155]
  v_exp_f32 v221, v133
  v_exp_f32 v222, v134
  v_mfma_f32_16x16x32_bf16 v[148:151], a[148:151], v[80:83], v[148:151]
  ds_read_b128 a[180:183], v3 offset:29696
  buffer_load_dwordx4 v2, s[48:51], s27 offen offset:1024 lds
  v_mfma_f32_16x16x32_bf16 v[156:159], a[148:151], v[84:87], v[156:159]
  v_exp_f32 v223, v135
  v_mfma_f32_16x16x32_bf16 v[144:147], a[152:155], v[88:91], v[144:147]
  ds_read_b128 a[184:187], v3 offset:30720
  v_add_f32 v226, v226, v221
  v_mfma_f32_16x16x32_bf16 v[152:155], a[152:155], v[92:95], v[152:155]
  v_exp_f32 v216, v136
  v_mfma_f32_16x16x32_bf16 v[148:151], a[156:159], v[88:91], v[148:151]
  ds_read_b128 a[188:191], v3 offset:31744
  v_cvt_pk_bf16_f32 v178, v220, v221
  v_add_f32 v226, v226, v222
  v_mfma_f32_16x16x32_bf16 v[156:159], a[156:159], v[92:95], v[156:159]
  s_waitcnt lgkmcnt(4)
  v_exp_f32 v217, v137
  v_mfma_f32_16x16x32_bf16 a[64:67], a[160:163], v[184:187], a[64:67]
  ds_read_b128 a[128:131], v3 offset:8192
  v_add_f32 v226, v226, v223
  v_cvt_pk_bf16_f32 v179, v222, v223
  v_mfma_f32_16x16x32_bf16 a[68:71], a[160:163], v[188:191], a[68:71]
  v_exp_f32 v218, v138
  v_mfma_f32_16x16x32_bf16 a[72:75], a[164:167], v[184:187], a[72:75]
  ds_read_b128 a[132:135], v3 offset:9216
  buffer_load_dwordx4 v2, s[48:51], s27 offen offset:2048 lds
  v_add_f32 v227, v216, v217
  v_mfma_f32_16x16x32_bf16 a[76:79], a[164:167], v[188:191], a[76:79]
  v_exp_f32 v219, v139
  v_mfma_f32_16x16x32_bf16 a[80:83], a[168:171], v[184:187], a[80:83]
  ds_read_b128 a[136:139], v3 offset:10240
  v_cvt_pk_bf16_f32 v180, v216, v217
  v_mfma_f32_16x16x32_bf16 a[84:87], a[168:171], v[188:191], a[84:87]
  v_exp_f32 v220, v140
  v_add_f32 v227, v227, v218
  v_mfma_f32_16x16x32_bf16 a[88:91], a[172:175], v[184:187], a[88:91]
  ds_read_b128 a[140:143], v3 offset:11264
  v_add_f32 v227, v227, v219
  v_mfma_f32_16x16x32_bf16 a[92:95], a[172:175], v[188:191], a[92:95]
  s_waitcnt lgkmcnt(4)
  v_exp_f32 v221, v141
  v_cvt_pk_bf16_f32 v181, v218, v219
  v_mfma_f32_16x16x32_bf16 a[96:99], a[176:179], v[184:187], a[96:99]
  ds_read_b128 a[144:147], v3 offset:12288
  buffer_load_dwordx4 v2, s[48:51], s27 offen offset:3072 lds
  v_mfma_f32_16x16x32_bf16 a[100:103], a[176:179], v[188:191], a[100:103]
  s_add_u32 s27, s27, 16384
  v_exp_f32 v222, v142
  v_add_f32 v227, v227, v220
  v_mfma_f32_16x16x32_bf16 a[104:107], a[180:183], v[184:187], a[104:107]
  s_add_u32 s25, s25, 32768
  ds_read_b128 a[148:151], v3 offset:13312
  v_add_f32 v227, v227, v221
  v_mfma_f32_16x16x32_bf16 a[108:111], a[180:183], v[188:191], a[108:111]
  s_and_b32 s25, s25, 0x1ffff
  v_exp_f32 v223, v143
  v_cvt_pk_bf16_f32 v182, v220, v221
  v_mfma_f32_16x16x32_bf16 a[112:115], a[184:187], v[184:187], a[112:115]
  ds_read_b128 a[152:155], v3 offset:14336
  v_add_f32 v227, v227, v222
  v_mfma_f32_16x16x32_bf16 a[116:119], a[184:187], v[188:191], a[116:119]
  s_sub_u32 s29, s29, 1
  v_add_f32 v227, v227, v223
  v_cvt_pk_bf16_f32 v183, v222, v223
  v_max_f32 v5, v226, v227
  v_mfma_f32_16x16x32_bf16 a[120:123], a[188:191], v[184:187], a[120:123]
  s_waitcnt lgkmcnt(3)
  ds_read_b128 a[156:159], v3 offset:15360
  v_cmp_lt_f32 vcc, s81, v5
  v_mfma_f32_16x16x32_bf16 a[124:127], a[188:191], v[188:191], a[124:127]
  s_cbranch_vccnz k2_stub10
k2_back10:
  v_add_f32 v230, v230, v226
  v_add_f32 v231, v231, v227
  v_add_u32 v3, 32768, v3
  v_and_b32 v3, 0x1ffff, v3
  s_cmp_lg_u32 s29, 0
  s_cbranch_scc1 k2_SS
k2_Bexit:
  s_bitcmp1_b32 s20, 0
  s_cbranch_scc1 k2_Bodd
  v_mfma_f32_16x16x32_bf16 v[128:131], a[128:131], v[64:67], v[200:203]
  s_waitcnt vmcnt(0)
  v_exp_f32 v216, v144
  v_mfma_f32_16x16x32_bf16 v[136:139], a[128:131], v[68:71], v[204:207]
  s_barrier
  v_exp_f32 v217, v145
  v_mfma_f32_16x16x32_bf16 v[132:135], a[132:135], v[64:67], v[200:203]
  ds_read_b128 a[160:163], v3 offset:16384
  ds_read_b128 a[164:167], v3 offset:17408
  v_mfma_f32_16x16x32_bf16 v[140:143], a[132:135], v[68:71], v[204:207]
  v_exp_f32 v218, v146
  v_mfma_f32_16x16x32_bf16 v[128:131], a[136:139], v[72:75], v[128:131]
  ds_read_b128 a[168:171], v3 offset:18432
  v_add_f32 v226, v216, v217
  v_mfma_f32_16x16x32_bf16 v[136:139], a[136:139], v[76:79], v[136:139]
  v_exp_f32 v219, v147
  v_mfma_f32_16x16x32_bf16 v[132:135], a[140:143], v[72:75], v[132:135]
  ds_read_b128 a[172:175], v3 offset:19456
  v_cvt_pk_bf16_f32 v184, v216, v217
  v_mfma_f32_16x16x32_bf16 v[140:143], a[140:143], v[76:79], v[140:143]
  s_waitcnt lgkmcnt(4)
  v_exp_f32 v220, v148
  v_add_f32 v226, v226, v218
  v_mfma_f32_16x16x32_bf16 v[128:131], a[144:147], v[80:83], v[128:131]
  ds_read_b128 a[176:179], v3 offset:20480
  v_add_f32 v226, v226, v219
  v_mfma_f32_16x16x32_bf16 v[136:139], a[144:147], v[84:87], v[136:139]
  v_exp_f32 v221, v149
  v_mfma_f32_16x16x32_bf16 v[132:135], a[148:151], v[80:83], v[132:135]
  ds_read_b128 a[180:183], v3 offset:21504
  v_cvt_pk_bf16_f32 v185, v218, v219
  v_mfma_f32_16x16x32_bf16 v[140:143], a[148:151], v[84:87], v[140:143]
  v_exp_f32 v222, v150
  v_mfma_f32_16x16x32_bf16 v[128:131], a[152:155], v[88:91], v[128:131]
  ds_read_b128 a[184:187], v3 offset:22528
  v_add_f32 v226, v226, v220
  v_mfma_f32_16x16x32_bf16 v[136:139], a[152:155], v[92:95], v[136:139]
  v_exp_f32 v223, v151
  v_mfma_f32_16x16x32_bf16 v[132:135], a[156:159], v[88:91], v[132:135]
  ds_read_b128 a[188:191], v3 offset:23552
  v_add_f32 v226, v226, v221
  v_mfma_f32_16x16x32_bf16 v[140:143], a[156:159], v[92:95], v[140:143]
  s_waitcnt lgkmcnt(4)
  v_exp_f32 v216, v152
  v_mfma_f32_16x16x32_bf16 a[64:67], a[160:163], v[176:179], a[64:67]
  v_exp_f32 v217, v153
  v_mfma_f32_16x16x32_bf16 a[68:71], a[160:163], v[180:183], a[68:71]
  v_exp_f32 v218, v154
  v_mfma_f32_16x16x32_bf16 a[72:75], a[164:167], v[176:179], a[72:75]
  v_exp_f32 v219, v155
  v_mfma_f32_16x16x32_bf16 a[76:79], a[164:167], v[180:183], a[76:79]
  v_cvt_pk_bf16_f32 v186, v220, v221
  v_add_f32 v226, v226, v222
  v_mfma_f32_16x16x32_bf16 a[80:83], a[168:171], v[176:179], a[80:83]
  v_exp_f32 v220, v156
  v_mfma_f32_16x16x32_bf16 a[84:87], a[168:171], v[180:183], a[84:87]
  v_exp_f32 v221, v157
  v_mfma_f32_16x16x32_bf16 a[88:91], a[172:175], v[176:179], a[88:91]
  v_add_f32 v226, v226, v223
  v_cvt_pk_bf16_f32 v187, v222, v223
  v_mfma_f32_16x16x32_bf16 a[92:95], a[172:175], v[180:183], a[92:95]
  s_waitcnt lgkmcnt(0)
  v_exp_f32 v222, v158
  v_add_f32 v227, v216, v217
  v_mfma_f32_16x16x32_bf16 a[96:99], a[176:179], v[176:179], a[96:99]
  v_exp_f32 v223, v159
  v_mfma_f32_16x16x32_bf16 a[100:103], a[176:179], v[180:183], a[100:103]
  v_cvt_pk_bf16_f32 v188, v216, v217
  v_add_f32 v227, v227, v218
  v_mfma_f32_16x16x32_bf16 a[104:107], a[180:183], v[176:179], a[104:107]
  v_add_f32 v227, v227, v219
  v_cvt_pk_bf16_f32 v189, v218, v219
  v_mfma_f32_16x16x32_bf16 a[108:111], a[180:183], v[180:183], a[108:111]
  v_add_f32 v227, v227, v220
  v_add_f32 v227, v227, v221
  v_mfma_f32_16x16x32_bf16 a[112:115], a[184:187], v[176:179], a[112:115]
  v_cvt_pk_bf16_f32 v190, v220, v221
  v_add_f32 v227, v227, v222
  v_mfma_f32_16x16x32_bf16 a[116:119], a[184:187], v[180:183], a[116:119]
  v_add_f32 v227, v227, v223
  v_cvt_pk_bf16_f32 v191, v222, v223
  v_mfma_f32_16x16x32_bf16 a[120:123], a[188:191], v[176:179], a[120:123]
  v_max_f32 v5, v226, v227
  v_cmp_lt_f32 vcc, s81, v5
  v_mfma_f32_16x16x32_bf16 a[124:127], a[188:191], v[180:183], a[124:127]
  s_cbranch_vccnz k2_stub11
k2_back11:
  v_add_f32 v230, v230, v226
  v_add_f32 v231, v231, v227
  ds_read_b128 a[160:163], v3 offset:24576
  ds_read_b128 a[164:167], v3 offset:25600
  ds_read_b128 a[168:171], v3 offset:26624
  ds_read_b128 a[172:175], v3 offset:27648
  ds_read_b128 a[176:179], v3 offset:28672
  ds_read_b128 a[180:183], v3 offset:29696
  ds_read_b128 a[184:187], v3 offset:30720
  ds_read_b128 a[188:191], v3 offset:31744
  v_cndmask_b32 v128, v4, v128, s[68:69]
  v_cndmask_b32 v129, v4, v129, s[70:71]
  v_cndmask_b32 v130, v4, v130, s[72:73]
  v_cndmask_b32 v131, v4, v131, s[74:75]
  v_mov_b32 v132, v4
  v_mov_b32 v133, v4
  v_mov_b32 v134, v4
  v_mov_b32 v135, v4
  v_cndmask_b32 v140, v4, v140, s[68:69]
  v_cndmask_b32 v141, v4, v141, s[70:71]
  v_cndmask_b32 v142, v4, v142, s[72:73]
  v_cndmask_b32 v143, v4, v143, s[74:75]
  v_exp_f32 v216, v128
  v_exp_f32 v217, v129
  v_exp_f32 v218, v130
  v_exp_f32 v219, v131
  v_exp_f32 v220, v132
  v_exp_f32 v221, v133
  v_exp_f32 v222, v134
  v_exp_f32 v223, v135
  v_add_f32 v226, v216, v217
  v_cvt_pk_bf16_f32 v176, v216, v217
  s_waitcnt lgkmcnt(4)
  v_mfma_f32_16x16x32_bf16 a[64:67], a[160:163], v[184:187], a[64:67]
  v_exp_f32 v216, v136
  v_add_f32 v226, v226, v218
  v_mfma_f32_16x16x32_bf16 a[68:71], a[160:163], v[188:191], a[68:71]
  v_exp_f32 v217, v137
  v_mfma_f32_16x16x32_bf16 a[72:75], a[164:167], v[184:187], a[72:75]
  v_add_f32 v226, v226, v219
  v_cvt_pk_bf16_f32 v177, v218, v219
  v_add_f32 v226, v226, v220
  v_mfma_f32_16x16x32_bf16 a[76:79], a[164:167], v[188:191], a[76:79]
  v_exp_f32 v218, v138
  v_mfma_f32_16x16x32_bf16 a[80:83], a[168:171], v[184:187], a[80:83]
  v_exp_f32 v219, v139
  v_add_f32 v226, v226, v221
  v_mfma_f32_16x16x32_bf16 a[84:87], a[168:171], v[188:191], a[84:87]
  v_cvt_pk_bf16_f32 v178, v220, v221
  v_add_f32 v226, v226, v222
  v_mfma_f32_16x16x32_bf16 a[88:91], a[172:175], v[184:187], a[88:91]
  v_exp_f32 v220, v140
  v_add_f32 v226, v226, v223
  v_mfma_f32_16x16x32_bf16 a[92:95], a[172:175], v[188:191], a[92:95]
  s_waitcnt lgkmcnt(0)
  v_exp_f32 v221, v141
  v_mfma_f32_16x16x32_bf16 a[96:99], a[176:179], v[184:187], a[96:99]
  v_cvt_pk_bf16_f32 v179, v222, v223
  v_add_f32 v227, v216, v217
  v_cvt_pk_bf16_f32 v180, v216, v217
  v_mfma_f32_16x16x32_bf16 a[100:103], a[176:179], v[188:191], a[100:103]
  v_exp_f32 v222, v142
  v_mfma_f32_16x16x32_bf16 a[104:107], a[180:183], v[184:187], a[104:107]
  v_exp_f32 v223, v143
  v_add_f32 v227, v227, v218
  v_mfma_f32_16x16x32_bf16 a[108:111], a[180:183], v[188:191], a[108:111]
  v_add_f32 v227, v227, v219
  v_cvt_pk_bf16_f32 v181, v218, v219
  v_mfma_f32_16x16x32_bf16 a[112:115], a[184:187], v[184:187], a[112:115]
  v_add_f32 v227, v227, v220
  v_add_f32 v227, v227, v221
  v_cvt_pk_bf16_f32 v182, v220, v221
  v_mfma_f32_16x16x32_bf16 a[116:119], a[184:187], v[188:191], a[116:119]
  v_add_f32 v227, v227, v222
  v_add_f32 v227, v227, v223
  v_mfma_f32_16x16x32_bf16 a[120:123], a[188:191], v[184:187], a[120:123]
  v_cvt_pk_bf16_f32 v183, v222, v223
  v_max_f32 v5, v226, v227
  v_cmp_lt_f32 vcc, s81, v5
  v_mfma_f32_16x16x32_bf16 a[124:127], a[188:191], v[188:191], a[124:127]
  s_cbranch_vccnz k2_stub12
k2_back12:
  v_add_f32 v230, v230, v226
  v_add_f32 v231, v231, v227
  v_add_u32 v3, 32768, v3
  v_and_b32 v3, 0x1ffff, v3
  s_waitcnt vmcnt(0)
  s_barrier
  ds_read_b128 a[160:163], v3 offset:16384
  ds_read_b128 a[164:167], v3 offset:17408
  ds_read_b128 a[168:171], v3 offset:18432
  ds_read_b128 a[172:175], v3 offset:19456
  ds_read_b128 a[176:179], v3 offset:20480
  ds_read_b128 a[180:183], v3 offset:21504
  ds_read_b128 a[184:187], v3 offset:22528
  ds_read_b128 a[188:191], v3 offset:23552
  s_waitcnt lgkmcnt(4)
  v_mfma_f32_16x16x32_bf16 a[64:67], a[160:163], v[176:179], a[64:67]
  v_mfma_f32_16x16x32_bf16 a[68:71], a[160:163], v[180:183], a[68:71]
  v_mfma_f32_16x16x32_bf16 a[72:75], a[164:167], v[176:179], a[72:75]
  v_mfma_f32_16x16x32_bf16 a[76:79], a[164:167], v[180:183], a[76:79]
  v_mfma_f32_16x16x32_bf16 a[80:83], a[168:171], v[176:179], a[80:83]
  v_mfma_f32_16x16x32_bf16 a[84:87], a[168:171], v[180:183], a[84:87]
  v_mfma_f32_16x16x32_bf16 a[88:91], a[172:175], v[176:179], a[88:91]
  v_mfma_f32_16x16x32_bf16 a[92:95], a[172:175], v[180:183], a[92:95]
  s_waitcnt lgkmcnt(0)
  v_mfma_f32_16x16x32_bf16 a[96:99], a[176:179], v[176:179], a[96:99]
  v_mfma_f32_16x16x32_bf16 a[100:103], a[176:179], v[180:183], a[100:103]
  v_mfma_f32_16x16x32_bf16 a[104:107], a[180:183], v[176:179], a[104:107]
  v_mfma_f32_16x16x32_bf16 a[108:111], a[180:183], v[180:183], a[108:111]
  v_mfma_f32_16x16x32_bf16 a[112:115], a[184:187], v[176:179], a[112:115]
  v_mfma_f32_16x16x32_bf16 a[116:119], a[184:187], v[180:183], a[116:119]
  v_mfma_f32_16x16x32_bf16 a[120:123], a[188:191], v[176:179], a[120:123]
  v_mfma_f32_16x16x32_bf16 a[124:127], a[188:191], v[180:183], a[124:127]
  s_branch k2_Bdone
k2_Bodd:
  s_waitcnt vmcnt(0)
  s_barrier
  ds_read_b128 a[160:163], v3 offset:16384
  ds_read_b128 a[164:167], v3 offset:17408
  ds_read_b128 a[168:171], v3 offset:18432
  ds_read_b128 a[172:175], v3 offset:19456
  ds_read_b128 a[176:179], v3 offset:20480
  ds_read_b128 a[180:183], v3 offset:21504
  ds_read_b128 a[184:187], v3 offset:22528
  ds_read_b128 a[188:191], v3 offset:23552
  v_cndmask_b32 v144, v4, v144, s[68:69]
  v_cndmask_b32 v145, v4, v145, s[70:71]
  v_cndmask_b32 v146, v4, v146, s[72:73]
  v_cndmask_b32 v147, v4, v147, s[74:75]
  v_mov_b32 v148, v4
  v_mov_b32 v149, v4
  v_mov_b32 v150, v4
  v_mov_b32 v151, v4
  v_cndmask_b32 v156, v4, v156, s[68:69]
  v_cndmask_b32 v157, v4, v157, s[70:71]
  v_cndmask_b32 v158, v4, v158, s[72:73]
  v_cndmask_b32 v159, v4, v159, s[74:75]
  v_exp_f32 v216, v144
  v_exp_f32 v217, v145
  v_exp_f32 v218, v146
  v_exp_f32 v219, v147
  v_exp_f32 v220, v148
  v_exp_f32 v221, v149
  v_exp_f32 v222, v150
  v_exp_f32 v223, v151
  v_add_f32 v226, v216, v217
  v_cvt_pk_bf16_f32 v184, v216, v217
  s_waitcnt lgkmcnt(4)
  v_mfma_f32_16x16x32_bf16 a[64:67], a[160:163], v[176:179], a[64:67]
  v_exp_f32 v216, v152
  v_add_f32 v226, v226, v218
  v_mfma_f32_16x16x32_bf16 a[68:71], a[160:163], v[180:183], a[68:71]
  v_exp_f32 v217, v153
  v_mfma_f32_16x16x32_bf16 a[72:75], a[164:167], v[176:179], a[72:75]
  v_add_f32 v226, v226, v219
  v_cvt_pk_bf16_f32 v185, v218, v219
  v_add_f32 v226, v226, v220
  v_mfma_f32_16x16x32_bf16 a[76:79], a[164:167], v[180:183], a[76:79]
  v_exp_f32 v218, v154
  v_mfma_f32_16x16x32_bf16 a[80:83], a[168:171], v[176:179], a[80:83]
  v_exp_f32 v219, v155
  v_add_f32 v226, v226, v221
  v_mfma_f32_16x16x32_bf16 a[84:87], a[168:171], v[180:183], a[84:87]
  v_cvt_pk_bf16_f32 v186, v220, v221
  v_add_f32 v226, v226, v222
  v_mfma_f32_16x16x32_bf16 a[88:91], a[172:175], v[176:179], a[88:91]
  v_exp_f32 v220, v156
  v_add_f32 v226, v226, v223
  v_mfma_f32_16x16x32_bf16 a[92:95], a[172:175], v[180:183], a[92:95]
  s_waitcnt lgkmcnt(0)
  v_exp_f32 v221, v157
  v_mfma_f32_16x16x32_bf16 a[96:99], a[176:179], v[176:179], a[96:99]
  v_cvt_pk_bf16_f32 v187, v222, v223
  v_add_f32 v227, v216, v217
  v_cvt_pk_bf16_f32 v188, v216, v217
  v_mfma_f32_16x16x32_bf16 a[100:103], a[176:179], v[180:183], a[100:103]
  v_exp_f32 v222, v158
  v_mfma_f32_16x16x32_bf16 a[104:107], a[180:183], v[176:179], a[104:107]
  v_exp_f32 v223, v159
  v_add_f32 v227, v227, v218
  v_mfma_f32_16x16x32_bf16 a[108:111], a[180:183], v[180:183], a[108:111]
  v_add_f32 v227, v227, v219
  v_cvt_pk_bf16_f32 v189, v218, v219
  v_mfma_f32_16x16x32_bf16 a[112:115], a[184:187], v[176:179], a[112:115]
  v_add_f32 v227, v227, v220
  v_add_f32 v227, v227, v221
  v_cvt_pk_bf16_f32 v190, v220, v221
  v_mfma_f32_16x16x32_bf16 a[116:119], a[184:187], v[180:183], a[116:119]
  v_add_f32 v227, v227, v222
  v_add_f32 v227, v227, v223
  v_mfma_f32_16x16x32_bf16 a[120:123], a[188:191], v[176:179], a[120:123]
  v_cvt_pk_bf16_f32 v191, v222, v223
  v_max_f32 v5, v226, v227
  v_cmp_lt_f32 vcc, s81, v5
  v_mfma_f32_16x16x32_bf16 a[124:127], a[188:191], v[180:183], a[124:127]
  s_cbranch_vccnz k2_stub13
k2_back13:
  v_add_f32 v230, v230, v226
  v_add_f32 v231, v231, v227
  ds_read_b128 a[160:163], v3 offset:24576
  ds_read_b128 a[164:167], v3 offset:25600
  ds_read_b128 a[168:171], v3 offset:26624
  ds_read_b128 a[172:175], v3 offset:27648
  ds_read_b128 a[176:179], v3 offset:28672
  ds_read_b128 a[180:183], v3 offset:29696
  ds_read_b128 a[184:187], v3 offset:30720
  ds_read_b128 a[188:191], v3 offset:31744
  s_waitcnt lgkmcnt(4)
  v_mfma_f32_16x16x32_bf16 a[64:67], a[160:163], v[184:187], a[64:67]
  v_mfma_f32_16x16x32_bf16 a[68:71], a[160:163], v[188:191], a[68:71]
  v_mfma_f32_16x16x32_bf16 a[72:75], a[164:167], v[184:187], a[72:75]
  v_mfma_f32_16x16x32_bf16 a[76:79], a[164:167], v[188:191], a[76:79]
  v_mfma_f32_16x16x32_bf16 a[80:83], a[168:171], v[184:187], a[80:83]
  v_mfma_f32_16x16x32_bf16 a[84:87], a[168:171], v[188:191], a[84:87]
  v_mfma_f32_16x16x32_bf16 a[88:91], a[172:175], v[184:187], a[88:91]
  v_mfma_f32_16x16x32_bf16 a[92:95], a[172:175], v[188:191], a[92:95]
  s_waitcnt lgkmcnt(0)
  v_mfma_f32_16x16x32_bf16 a[96:99], a[176:179], v[184:187], a[96:99]
  v_mfma_f32_16x16x32_bf16 a[100:103], a[176:179], v[188:191], a[100:103]
  v_mfma_f32_16x16x32_bf16 a[104:107], a[180:183], v[184:187], a[104:107]
  v_mfma_f32_16x16x32_bf16 a[108:111], a[180:183], v[188:191], a[108:111]
  v_mfma_f32_16x16x32_bf16 a[112:115], a[184:187], v[184:187], a[112:115]
  v_mfma_f32_16x16x32_bf16 a[116:119], a[184:187], v[188:191], a[116:119]
  v_mfma_f32_16x16x32_bf16 a[120:123], a[188:191], v[184:187], a[120:123]
  v_mfma_f32_16x16x32_bf16 a[124:127], a[188:191], v[188:191], a[124:127]
  v_add_u32 v3, 32768, v3
  v_and_b32 v3, 0x1ffff, v3
k2_Bdone:
  s_cmp_ge_u32 s20, 2
  s_cbranch_scc1 k2_epi
  s_barrier
k2_epi:
  v_mov_b32 v20, v228
  v_mov_b32 v21, v229
  v_mov_b32 v22, v230
  v_mov_b32 v23, v231
  s_nop 0
  v_permlane16_swap_b32 v228, v20
  v_permlane16_swap_b32 v229, v21
  v_permlane16_swap_b32 v230, v22
  v_permlane16_swap_b32 v231, v23
  v_add_f32 v228, v228, v20
  v_add_f32 v229, v229, v21
  v_add_f32 v230, v230, v22
  v_add_f32 v231, v231, v23
  v_mov_b32 v20, v228
  v_mov_b32 v21, v229
  v_mov_b32 v22, v230
  v_mov_b32 v23, v231
  s_nop 0
  v_permlane32_swap_b32 v228, v20
  v_permlane32_swap_b32 v229, v21
  v_permlane32_swap_b32 v230, v22
  v_permlane32_swap_b32 v231, v23
  v_add_f32 v228, v228, v20
  v_add_f32 v229, v229, v21
  v_add_f32 v230, v230, v22
  v_add_f32 v231, v231, v23
  v_rcp_f32 v16, v228
  v_rcp_f32 v18, v229
  v_rcp_f32 v20, v230
  v_rcp_f32 v22, v231
  s_nop 0
  v_mov_b32 v17, v16
  v_mov_b32 v19, v18
  v_mov_b32 v21, v20
  v_mov_b32 v23, v22
  s_lshl_b32 s23, s22, 2
  s_add_u32 s23, s23, s20
  s_lshl_b32 s23, s23, 18
  s_lshl_b32 s31, s21, 12
  s_add_u32 s31, s31, 50331648
  s_add_u32 s64, s23, s31
  s_add_u32 s65, s64, 131072
  s_lshl_b32 s23, s30, 2
  s_add_u32 s23, s23, s20
  s_lshl_b32 s23, s23, 18
  s_add_u32 s66, s23, s31
  s_add_u32 s67, s66, 131072
  v_accvgpr_read_b32 v36, a0
  v_accvgpr_read_b32 v37, a1
  v_accvgpr_read_b32 v38, a2
  v_accvgpr_read_b32 v39, a3
  v_accvgpr_read_b32 v40, a8
  v_accvgpr_read_b32 v41, a9
  v_accvgpr_read_b32 v42, a10
  v_accvgpr_read_b32 v43, a11
  v_pk_mul_f32 v[36:37], v[36:37], v[16:17]
  v_pk_mul_f32 v[38:39], v[38:39], v[16:17]
  v_pk_mul_f32 v[40:41], v[40:41], v[16:17]
  v_pk_mul_f32 v[42:43], v[42:43], v[16:17]
  v_cvt_pk_bf16_f32 v32, v36, v37
  v_cvt_pk_bf16_f32 v33, v38, v39
  v_cvt_pk_bf16_f32 v34, v40, v41
  v_cvt_pk_bf16_f32 v35, v42, v43
  buffer_store_dwordx4 v[32:35], v2, s[40:43], s64 offen offset:0
  v_accvgpr_read_b32 v48, a16
  v_accvgpr_read_b32 v49, a17
  v_accvgpr_read_b32 v50, a18
  v_accvgpr_read_b32 v51, a19
  v_accvgpr_read_b32 v52, a24
  v_accvgpr_read_b32 v53, a25
  v_accvgpr_read_b32 v54, a26
  v_accvgpr_read_b32 v55, a27
  v_pk_mul_f32 v[48:49], v[48:49], v[16:17]
  v_pk_mul_f32 v[50:51], v[50:51], v[16:17]
  v_pk_mul_f32 v[52:53], v[52:53], v[16:17]
  v_pk_mul_f32 v[54:55], v[54:55], v[16:17]
  v_cvt_pk_bf16_f32 v44, v48, v49
  v_cvt_pk_bf16_f32 v45, v50, v51
  v_cvt_pk_bf16_f32 v46, v52, v53
  v_cvt_pk_bf16_f32 v47, v54, v55
  buffer_store_dwordx4 v[44:47], v2, s[40:43], s64 offen offset:1024
  v_accvgpr_read_b32 v60, a32
  v_accvgpr_read_b32 v61, a33
  v_accvgpr_read_b32 v62, a34
  v_accvgpr_read_b32 v63, a35
  v_accvgpr_read_b32 v64, a40
  v_accvgpr_read_b32 v65, a41
  v_accvgpr_read_b32 v66, a42
  v_accvgpr_read_b32 v67, a43
  v_pk_mul_f32 v[60:61], v[60:61], v[16:17]
  v_pk_mul_f32 v[62:63], v[62:63], v[16:17]
  v_pk_mul_f32 v[64:65], v[64:65], v[16:17]
  v_pk_mul_f32 v[66:67], v[66:67], v[16:17]
  v_cvt_pk_bf16_f32 v56, v60, v61
  v_cvt_pk_bf16_f32 v57, v62, v63
  v_cvt_pk_bf16_f32 v58, v64, v65
  v_cvt_pk_bf16_f32 v59, v66, v67
  buffer_store_dwordx4 v[56:59], v2, s[40:43], s64 offen offset:2048
  v_accvgpr_read_b32 v72, a48
  v_accvgpr_read_b32 v73, a49
  v_accvgpr_read_b32 v74, a50
  v_accvgpr_read_b32 v75, a51
  v_accvgpr_read_b32 v76, a56
  v_accvgpr_read_b32 v77, a57
  v_accvgpr_read_b32 v78, a58
  v_accvgpr_read_b32 v79, a59
  v_pk_mul_f32 v[72:73], v[72:73], v[16:17]
  v_pk_mul_f32 v[74:75], v[74:75], v[16:17]
  v_pk_mul_f32 v[76:77], v[76:77], v[16:17]
  v_pk_mul_f32 v[78:79], v[78:79], v[16:17]
  v_cvt_pk_bf16_f32 v68, v72, v73
  v_cvt_pk_bf16_f32 v69, v74, v75
  v_cvt_pk_bf16_f32 v70, v76, v77
  v_cvt_pk_bf16_f32 v71, v78, v79
  buffer_store_dwordx4 v[68:71], v2, s[40:43], s64 offen offset:3072
  v_accvgpr_read_b32 v84, a4
  v_accvgpr_read_b32 v85, a5
  v_accvgpr_read_b32 v86, a6
  v_accvgpr_read_b32 v87, a7
  v_accvgpr_read_b32 v88, a12
  v_accvgpr_read_b32 v89, a13
  v_accvgpr_read_b32 v90, a14
  v_accvgpr_read_b32 v91, a15
  v_pk_mul_f32 v[84:85], v[84:85], v[18:19]
  v_pk_mul_f32 v[86:87], v[86:87], v[18:19]
  v_pk_mul_f32 v[88:89], v[88:89], v[18:19]
  v_pk_mul_f32 v[90:91], v[90:91], v[18:19]
  v_cvt_pk_bf16_f32 v80, v84, v85
  v_cvt_pk_bf16_f32 v81, v86, v87
  v_cvt_pk_bf16_f32 v82, v88, v89
  v_cvt_pk_bf16_f32 v83, v90, v91
  buffer_store_dwordx4 v[80:83], v2, s[40:43], s65 offen offset:0
  v_accvgpr_read_b32 v96, a20
  v_accvgpr_read_b32 v97, a21
  v_accvgpr_read_b32 v98, a22
  v_accvgpr_read_b32 v99, a23
  v_accvgpr_read_b32 v100, a28
  v_accvgpr_read_b32 v101, a29
  v_accvgpr_read_b32 v102, a30
  v_accvgpr_read_b32 v103, a31
  v_pk_mul_f32 v[96:97], v[96:97], v[18:19]
  v_pk_mul_f32 v[98:99], v[98:99], v[18:19]
  v_pk_mul_f32 v[100:101], v[100:101], v[18:19]
  v_pk_mul_f32 v[102:103], v[102:103], v[18:19]
  v_cvt_pk_bf16_f32 v92, v96, v97
  v_cvt_pk_bf16_f32 v93, v98, v99
  v_cvt_pk_bf16_f32 v94, v100, v101
  v_cvt_pk_bf16_f32 v95, v102, v103
  buffer_store_dwordx4 v[92:95], v2, s[40:43], s65 offen offset:1024
  v_accvgpr_read_b32 v108, a36
  v_accvgpr_read_b32 v109, a37
  v_accvgpr_read_b32 v110, a38
  v_accvgpr_read_b32 v111, a39
  v_accvgpr_read_b32 v112, a44
  v_accvgpr_read_b32 v113, a45
  v_accvgpr_read_b32 v114, a46
  v_accvgpr_read_b32 v115, a47
  v_pk_mul_f32 v[108:109], v[108:109], v[18:19]
  v_pk_mul_f32 v[110:111], v[110:111], v[18:19]
  v_pk_mul_f32 v[112:113], v[112:113], v[18:19]
  v_pk_mul_f32 v[114:115], v[114:115], v[18:19]
  v_cvt_pk_bf16_f32 v104, v108, v109
  v_cvt_pk_bf16_f32 v105, v110, v111
  v_cvt_pk_bf16_f32 v106, v112, v113
  v_cvt_pk_bf16_f32 v107, v114, v115
  buffer_store_dwordx4 v[104:107], v2, s[40:43], s65 offen offset:2048
  v_accvgpr_read_b32 v120, a52
  v_accvgpr_read_b32 v121, a53
  v_accvgpr_read_b32 v122, a54
  v_accvgpr_read_b32 v123, a55
  v_accvgpr_read_b32 v124, a60
  v_accvgpr_read_b32 v125, a61
  v_accvgpr_read_b32 v126, a62
  v_accvgpr_read_b32 v127, a63
  v_pk_mul_f32 v[120:121], v[120:121], v[18:19]
  v_pk_mul_f32 v[122:123], v[122:123], v[18:19]
  v_pk_mul_f32 v[124:125], v[124:125], v[18:19]
  v_pk_mul_f32 v[126:127], v[126:127], v[18:19]
  v_cvt_pk_bf16_f32 v116, v120, v121
  v_cvt_pk_bf16_f32 v117, v122, v123
  v_cvt_pk_bf16_f32 v118, v124, v125
  v_cvt_pk_bf16_f32 v119, v126, v127
  buffer_store_dwordx4 v[116:119], v2, s[40:43], s65 offen offset:3072
  v_accvgpr_read_b32 v36, a64
  v_accvgpr_read_b32 v37, a65
  v_accvgpr_read_b32 v38, a66
  v_accvgpr_read_b32 v39, a67
  v_accvgpr_read_b32 v40, a72
  v_accvgpr_read_b32 v41, a73
  v_accvgpr_read_b32 v42, a74
  v_accvgpr_read_b32 v43, a75
  v_pk_mul_f32 v[36:37], v[36:37], v[20:21]
  v_pk_mul_f32 v[38:39], v[38:39], v[20:21]
  v_pk_mul_f32 v[40:41], v[40:41], v[20:21]
  v_pk_mul_f32 v[42:43], v[42:43], v[20:21]
  v_cvt_pk_bf16_f32 v32, v36, v37
  v_cvt_pk_bf16_f32 v33, v38, v39
  v_cvt_pk_bf16_f32 v34, v40, v41
  v_cvt_pk_bf16_f32 v35, v42, v43
  buffer_store_dwordx4 v[32:35], v2, s[40:43], s66 offen offset:0
  v_accvgpr_read_b32 v48, a80
  v_accvgpr_read_b32 v49, a81
  v_accvgpr_read_b32 v50, a82
  v_accvgpr_read_b32 v51, a83
  v_accvgpr_read_b32 v52, a88
  v_accvgpr_read_b32 v53, a89
  v_accvgpr_read_b32 v54, a90
  v_accvgpr_read_b32 v55, a91
  v_pk_mul_f32 v[48:49], v[48:49], v[20:21]
  v_pk_mul_f32 v[50:51], v[50:51], v[20:21]
  v_pk_mul_f32 v[52:53], v[52:53], v[20:21]
  v_pk_mul_f32 v[54:55], v[54:55], v[20:21]
  v_cvt_pk_bf16_f32 v44, v48, v49
  v_cvt_pk_bf16_f32 v45, v50, v51
  v_cvt_pk_bf16_f32 v46, v52, v53
  v_cvt_pk_bf16_f32 v47, v54, v55
  buffer_store_dwordx4 v[44:47], v2, s[40:43], s66 offen offset:1024
  v_accvgpr_read_b32 v60, a96
  v_accvgpr_read_b32 v61, a97
  v_accvgpr_read_b32 v62, a98
  v_accvgpr_read_b32 v63, a99
  v_accvgpr_read_b32 v64, a104
  v_accvgpr_read_b32 v65, a105
  v_accvgpr_read_b32 v66, a106
  v_accvgpr_read_b32 v67, a107
  v_pk_mul_f32 v[60:61], v[60:61], v[20:21]
  v_pk_mul_f32 v[62:63], v[62:63], v[20:21]
  v_pk_mul_f32 v[64:65], v[64:65], v[20:21]
  v_pk_mul_f32 v[66:67], v[66:67], v[20:21]
  v_cvt_pk_bf16_f32 v56, v60, v61
  v_cvt_pk_bf16_f32 v57, v62, v63
  v_cvt_pk_bf16_f32 v58, v64, v65
  v_cvt_pk_bf16_f32 v59, v66, v67
  buffer_store_dwordx4 v[56:59], v2, s[40:43], s66 offen offset:2048
  v_accvgpr_read_b32 v72, a112
  v_accvgpr_read_b32 v73, a113
  v_accvgpr_read_b32 v74, a114
  v_accvgpr_read_b32 v75, a115
  v_accvgpr_read_b32 v76, a120
  v_accvgpr_read_b32 v77, a121
  v_accvgpr_read_b32 v78, a122
  v_accvgpr_read_b32 v79, a123
  v_pk_mul_f32 v[72:73], v[72:73], v[20:21]
  v_pk_mul_f32 v[74:75], v[74:75], v[20:21]
  v_pk_mul_f32 v[76:77], v[76:77], v[20:21]
  v_pk_mul_f32 v[78:79], v[78:79], v[20:21]
  v_cvt_pk_bf16_f32 v68, v72, v73
  v_cvt_pk_bf16_f32 v69, v74, v75
  v_cvt_pk_bf16_f32 v70, v76, v77
  v_cvt_pk_bf16_f32 v71, v78, v79
  buffer_store_dwordx4 v[68:71], v2, s[40:43], s66 offen offset:3072
  v_accvgpr_read_b32 v84, a68
  v_accvgpr_read_b32 v85, a69
  v_accvgpr_read_b32 v86, a70
  v_accvgpr_read_b32 v87, a71
  v_accvgpr_read_b32 v88, a76
  v_accvgpr_read_b32 v89, a77
  v_accvgpr_read_b32 v90, a78
  v_accvgpr_read_b32 v91, a79
  v_pk_mul_f32 v[84:85], v[84:85], v[22:23]
  v_pk_mul_f32 v[86:87], v[86:87], v[22:23]
  v_pk_mul_f32 v[88:89], v[88:89], v[22:23]
  v_pk_mul_f32 v[90:91], v[90:91], v[22:23]
  v_cvt_pk_bf16_f32 v80, v84, v85
  v_cvt_pk_bf16_f32 v81, v86, v87
  v_cvt_pk_bf16_f32 v82, v88, v89
  v_cvt_pk_bf16_f32 v83, v90, v91
  buffer_store_dwordx4 v[80:83], v2, s[40:43], s67 offen offset:0
  v_accvgpr_read_b32 v96, a84
  v_accvgpr_read_b32 v97, a85
  v_accvgpr_read_b32 v98, a86
  v_accvgpr_read_b32 v99, a87
  v_accvgpr_read_b32 v100, a92
  v_accvgpr_read_b32 v101, a93
  v_accvgpr_read_b32 v102, a94
  v_accvgpr_read_b32 v103, a95
  v_pk_mul_f32 v[96:97], v[96:97], v[22:23]
  v_pk_mul_f32 v[98:99], v[98:99], v[22:23]
  v_pk_mul_f32 v[100:101], v[100:101], v[22:23]
  v_pk_mul_f32 v[102:103], v[102:103], v[22:23]
  v_cvt_pk_bf16_f32 v92, v96, v97
  v_cvt_pk_bf16_f32 v93, v98, v99
  v_cvt_pk_bf16_f32 v94, v100, v101
  v_cvt_pk_bf16_f32 v95, v102, v103
  buffer_store_dwordx4 v[92:95], v2, s[40:43], s67 offen offset:1024
  v_accvgpr_read_b32 v108, a100
  v_accvgpr_read_b32 v109, a101
  v_accvgpr_read_b32 v110, a102
  v_accvgpr_read_b32 v111, a103
  v_accvgpr_read_b32 v112, a108
  v_accvgpr_read_b32 v113, a109
  v_accvgpr_read_b32 v114, a110
  v_accvgpr_read_b32 v115, a111
  v_pk_mul_f32 v[108:109], v[108:109], v[22:23]
  v_pk_mul_f32 v[110:111], v[110:111], v[22:23]
  v_pk_mul_f32 v[112:113], v[112:113], v[22:23]
  v_pk_mul_f32 v[114:115], v[114:115], v[22:23]
  v_cvt_pk_bf16_f32 v104, v108, v109
  v_cvt_pk_bf16_f32 v105, v110, v111
  v_cvt_pk_bf16_f32 v106, v112, v113
  v_cvt_pk_bf16_f32 v107, v114, v115
  buffer_store_dwordx4 v[104:107], v2, s[40:43], s67 offen offset:2048
  v_accvgpr_read_b32 v120, a116
  v_accvgpr_read_b32 v121, a117
  v_accvgpr_read_b32 v122, a118
  v_accvgpr_read_b32 v123, a119
  v_accvgpr_read_b32 v124, a124
  v_accvgpr_read_b32 v125, a125
  v_accvgpr_read_b32 v126, a126
  v_accvgpr_read_b32 v127, a127
  v_pk_mul_f32 v[120:121], v[120:121], v[22:23]
  v_pk_mul_f32 v[122:123], v[122:123], v[22:23]
  v_pk_mul_f32 v[124:125], v[124:125], v[22:23]
  v_pk_mul_f32 v[126:127], v[126:127], v[22:23]
  v_cvt_pk_bf16_f32 v116, v120, v121
  v_cvt_pk_bf16_f32 v117, v122, v123
  v_cvt_pk_bf16_f32 v118, v124, v125
  v_cvt_pk_bf16_f32 v119, v126, v127
  buffer_store_dwordx4 v[116:119], v2, s[40:43], s67 offen offset:3072
  s_cmp_lt_u32 s2, 192
  s_cbranch_scc1 k2_end
  s_cmp_ge_u32 s2, 246
  s_cbranch_scc1 k2_end
  s_load_dwordx4 s[4:7], s[0:1], 64
  s_load_dwordx2 s[8:9], s[0:1], 80
  s_sub_u32 s82, s2, 192
  s_mov_b32 s23, 2621440
  s_mov_b32 s31, 2625536
  buffer_load_dwordx4 v[128:131], v2, s[40:43], s23 offen offset:0
  buffer_load_dwordx4 v[132:135], v2, s[40:43], s23 offen offset:1024
  buffer_load_dwordx4 v[136:139], v2, s[40:43], s23 offen offset:2048
  buffer_load_dwordx4 v[140:143], v2, s[40:43], s23 offen offset:3072
  buffer_load_dwordx4 v[144:147], v2, s[40:43], s31 offen offset:0
  buffer_load_dwordx4 v[148:151], v2, s[40:43], s31 offen offset:1024
  buffer_load_dwordx4 v[152:155], v2, s[40:43], s31 offen offset:2048
  buffer_load_dwordx4 v[156:159], v2, s[40:43], s31 offen offset:3072
  v_lshrrev_b32 v16, 2, v1
  v_mul_u32_u24 v17, 3456, v16
  v_and_b32 v18, 3, v1
  v_lshl_add_u32 v17, v18, 4, v17
  s_waitcnt lgkmcnt(0)
  s_mov_b32 s52, s4
  s_mov_b32 s53, s5
  s_mov_b32 s54, 2211840
  s_mov_b32 s55, 0x20000
  s_mov_b32 s56, s6
  s_mov_b32 s57, s7
  s_mov_b32 s58, 2211840
  s_mov_b32 s59, 0x20000
  s_mov_b32 s60, s8
  s_mov_b32 s61, s9
  s_mov_b32 s62, 2211840
  s_mov_b32 s63, 0x20000
  s_mul_i32 s23, s20, 552960
  s_lshl_b32 s31, s82, 6
  s_add_u32 s23, s23, s31
  s_mul_i32 s24, s20, 10240
  s_mul_i32 s25, s82, 40960
  s_add_u32 s25, s25, s24
  s_mov_b32 s26, 10
  s_barrier
k2_fdma:
  s_mov_b32 m0, s24
  s_nop 0
  buffer_load_dwordx4 v17, s[52:55], s23 offen lds
  s_add_u32 m0, s24, 40960
  s_nop 0
  buffer_load_dwordx4 v17, s[56:59], s23 offen lds
  s_add_u32 m0, s24, 81920
  s_nop 0
  buffer_load_dwordx4 v2, s[60:63], s25 offen lds
  s_add_u32 s23, s23, 55296
  s_add_u32 s24, s24, 1024
  s_add_u32 s25, s25, 1024
  s_sub_u32 s26, s26, 1
  s_cmp_lg_u32 s26, 0
  s_cbranch_scc1 k2_fdma
  v_mov_b32 v21, 0
  v_mov_b32 v22, 0
  v_and_b32 v23, 7, v1
  s_mov_b32 s26, 0
  s_waitcnt vmcnt(30)
k2_top:
  v_max3_u32 v20, v128, v129, v130
  v_max3_u32 v24, v131, v132, v133
  v_max3_u32 v20, v20, v134, v135
  v_max3_u32 v24, v24, v136, v137
  v_max3_u32 v20, v20, v138, v139
  v_max3_u32 v24, v24, v140, v141
  v_max3_u32 v20, v20, v142, v143
  v_max3_u32 v24, v24, v144, v145
  v_max3_u32 v20, v20, v146, v147
  v_max3_u32 v24, v24, v148, v149
  v_max3_u32 v20, v20, v150, v151
  v_max3_u32 v24, v24, v152, v153
  v_max3_u32 v20, v20, v154, v155
  v_max3_u32 v24, v24, v156, v157
  v_max3_u32 v20, v20, v158, v159
  v_max_u32 v20, v20, v24
  s_nop 1
  v_max_u32_dpp v20, v20, v20 quad_perm:[1,0,3,2] row_mask:0xf bank_mask:0xf
  s_nop 1
  v_max_u32_dpp v20, v20, v20 quad_perm:[2,3,0,1] row_mask:0xf bank_mask:0xf
  s_nop 1
  v_max_u32_dpp v20, v20, v20 row_half_mirror row_mask:0xf bank_mask:0xf
  s_nop 1
  v_max_u32_dpp v20, v20, v20 row_mirror row_mask:0xf bank_mask:0xf
  v_mov_b32 v24, v20
  s_nop 1
  v_permlane16_swap_b32 v20, v24
  v_max_u32 v20, v20, v24
  v_mov_b32 v24, v20
  s_nop 1
  v_permlane32_swap_b32 v20, v24
  v_max_u32 v20, v20, v24
  v_add_u32 v21, v21, v20
  v_cmp_eq_u32 vcc, s26, v23
  v_sub_u32 v128, v128, v20
  v_sub_u32 v129, v129, v20
  v_sub_u32 v130, v130, v20
  v_sub_u32 v131, v131, v20
  v_sub_u32 v132, v132, v20
  v_sub_u32 v133, v133, v20
  v_sub_u32 v134, v134, v20
  v_sub_u32 v135, v135, v20
  v_sub_u32 v136, v136, v20
  v_sub_u32 v137, v137, v20
  v_sub_u32 v138, v138, v20
  v_sub_u32 v139, v139, v20
  v_sub_u32 v140, v140, v20
  v_sub_u32 v141, v141, v20
  v_sub_u32 v142, v142, v20
  v_sub_u32 v143, v143, v20
  v_sub_u32 v144, v144, v20
  v_sub_u32 v145, v145, v20
  v_sub_u32 v146, v146, v20
  v_sub_u32 v147, v147, v20
  v_sub_u32 v148, v148, v20
  v_sub_u32 v149, v149, v20
  v_sub_u32 v150, v150, v20
  v_sub_u32 v151, v151, v20
  v_sub_u32 v152, v152, v20
  v_sub_u32 v153, v153, v20
  v_sub_u32 v154, v154, v20
  v_sub_u32 v155, v155, v20
  v_sub_u32 v156, v156, v20
  v_sub_u32 v157, v157, v20
  v_sub_u32 v158, v158, v20
  v_sub_u32 v159, v159, v20
  v_cndmask_b32 v22, v22, v21, vcc
  s_add_u32 s26, s26, 1
  s_cmp_lt_u32 s26, 8
  s_cbranch_scc1 k2_top
  v_and_b32 v25, 0xffff, v22
  v_sub_u32 v25, 0xffff, v25
  v_and_b32 v25, 2047, v25
  v_lshrrev_b32 v27, 4, v25
  v_mul_u32_u24 v27, 20480, v27
  v_and_b32 v24, 15, v25
  v_lshl_add_u32 v27, v24, 4, v27
  v_lshrrev_b32 v24, 4, v1
  v_lshl_add_u32 v27, v24, 8, v27
  s_mov_b32 s23, 0
  buffer_load_dwordx4 v[32:35], v27, s[40:43], s23 offen offset:0
  buffer_load_dwordx4 v[36:39], v27, s[40:43], s23 offen offset:1024
  buffer_load_dwordx4 v[40:43], v27, s[40:43], s23 offen offset:2048
  buffer_load_dwordx4 v[44:47], v27, s[40:43], s23 offen offset:3072
  s_mov_b32 s23, 4096
  buffer_load_dwordx4 v[48:51], v27, s[40:43], s23 offen offset:0
  buffer_load_dwordx4 v[52:55], v27, s[40:43], s23 offen offset:1024
  buffer_load_dwordx4 v[56:59], v27, s[40:43], s23 offen offset:2048
  buffer_load_dwordx4 v[60:63], v27, s[40:43], s23 offen offset:3072
  s_mov_b32 s23, 8192
  buffer_load_dwordx4 v[64:67], v27, s[40:43], s23 offen offset:0
  buffer_load_dwordx4 v[68:71], v27, s[40:43], s23 offen offset:1024
  buffer_load_dwordx4 v[72:75], v27, s[40:43], s23 offen offset:2048
  buffer_load_dwordx4 v[76:79], v27, s[40:43], s23 offen offset:3072
  s_mov_b32 s23, 12288
  buffer_load_dwordx4 v[80:83], v27, s[40:43], s23 offen offset:0
  buffer_load_dwordx4 v[84:87], v27, s[40:43], s23 offen offset:1024
  buffer_load_dwordx4 v[88:91], v27, s[40:43], s23 offen offset:2048
  buffer_load_dwordx4 v[92:95], v27, s[40:43], s23 offen offset:3072
  s_mov_b32 s23, 16384
  buffer_load_dwordx4 v[96:99], v27, s[40:43], s23 offen offset:0
  buffer_load_dwordx4 v[100:103], v27, s[40:43], s23 offen offset:1024
  buffer_load_dwordx4 v[104:107], v27, s[40:43], s23 offen offset:2048
  buffer_load_dwordx4 v[108:111], v27, s[40:43], s23 offen offset:3072
  v_ashrrev_i32 v20, 31, v22
  v_not_b32 v20, v20
  v_or_b32 v20, 0x80000000, v20
  v_xor_b32 v26, v22, v20
  v_and_b32 v26, 0xffff0000, v26
  v_mul_f32 v26, 0xbfb8aa3b, v26
  v_exp_f32 v26, v26
  s_nop 0
  v_add_f32 v26, 1.0, v26
  v_rcp_f32 v26, v26
  s_nop 0
  v_cvt_pk_bf16_f32 v26, v26, v26
  v_and_b32 v26, 0xffff0000, v26
  v_lshlrev_b32 v20, 2, v1
  v_add_u32 v20, 2629632, v20
  v_mov_b32 v21, 0x40000000
  s_add_u32 s23, s82, s20
  s_cmp_eq_u32 s23, 0
  s_cselect_b32 s23, 8, 0
  v_cmp_gt_u32 vcc, s23, v1
  s_nop 1
  v_cndmask_b32 v20, v21, v20, vcc
  buffer_store_dword v25, v20, s[40:43], 0 offen
  buffer_store_dword v26, v20, s[40:43], 0 offen offset:32
  v_lshl_add_u32 v28, v24, 2, v16
  v_lshlrev_b32 v28, 6, v28
  v_lshl_add_u32 v28, v18, 3, v28
  s_lshr_b32 s23, s20, 1
  s_mul_i32 s23, s23, 40960
  s_and_b32 s31, s20, 1
  s_lshl_b32 s31, s31, 5
  s_add_u32 s23, s23, s31
  v_add_u32 v28, s23, v28
  v_mul_u32_u24 v29, 1280, v16
  v_lshl_add_u32 v29, v18, 3, v29
  s_mul_i32 s23, s20, 320
  s_add_u32 s23, s23, 81920
  v_add_u32 v29, s23, v29
  s_lshl_b32 s23, s20, 10
  s_add_u32 s23, s23, 122880
  v_add_u32 v30, s23, v2
  s_waitcnt vmcnt(0)
  s_barrier
  ds_read_b64_tr_b16 v[112:113], v28 offset:0
  ds_read_b64_tr_b16 v[114:115], v28 offset:256
  ds_read_b64_tr_b16 v[116:117], v28 offset:2048
  ds_read_b64_tr_b16 v[118:119], v28 offset:2304
  ds_read_b64_tr_b16 v[120:121], v28 offset:4096
  ds_read_b64_tr_b16 v[122:123], v28 offset:4352
  ds_read_b64_tr_b16 v[124:125], v28 offset:6144
  ds_read_b64_tr_b16 v[126:127], v28 offset:6400
  ds_read_b64_tr_b16 v[128:129], v28 offset:8192
  ds_read_b64_tr_b16 v[130:131], v28 offset:8448
  ds_read_b64_tr_b16 v[132:133], v28 offset:10240
  ds_read_b64_tr_b16 v[134:135], v28 offset:10496
  ds_read_b64_tr_b16 v[136:137], v28 offset:12288
  ds_read_b64_tr_b16 v[138:139], v28 offset:12544
  ds_read_b64_tr_b16 v[140:141], v28 offset:14336
  ds_read_b64_tr_b16 v[142:143], v28 offset:14592
  ds_read_b64_tr_b16 v[144:145], v28 offset:16384
  ds_read_b64_tr_b16 v[146:147], v28 offset:16640
  ds_read_b64_tr_b16 v[148:149], v28 offset:18432
  ds_read_b64_tr_b16 v[150:151], v28 offset:18688
  ds_read_b64_tr_b16 v[152:153], v28 offset:20480
  ds_read_b64_tr_b16 v[154:155], v28 offset:20736
  ds_read_b64_tr_b16 v[156:157], v28 offset:22528
  ds_read_b64_tr_b16 v[158:159], v28 offset:22784
  ds_read_b64_tr_b16 v[160:161], v28 offset:24576
  ds_read_b64_tr_b16 v[162:163], v28 offset:24832
  ds_read_b64_tr_b16 v[164:165], v28 offset:26624
  ds_read_b64_tr_b16 v[166:167], v28 offset:26880
  ds_read_b64_tr_b16 v[168:169], v28 offset:28672
  ds_read_b64_tr_b16 v[170:171], v28 offset:28928
  ds_read_b64_tr_b16 v[172:173], v28 offset:30720
  ds_read_b64_tr_b16 v[174:175], v28 offset:30976
  ds_read_b64_tr_b16 v[176:177], v28 offset:32768
  ds_read_b64_tr_b16 v[178:179], v28 offset:33024
  ds_read_b64_tr_b16 v[180:181], v28 offset:34816
  ds_read_b64_tr_b16 v[182:183], v28 offset:35072
  ds_read_b64_tr_b16 v[184:185], v28 offset:36864
  ds_read_b64_tr_b16 v[186:187], v28 offset:37120
  ds_read_b64_tr_b16 v[188:189], v28 offset:38912
  ds_read_b64_tr_b16 v[190:191], v28 offset:39168
  s_waitcnt lgkmcnt(0)
  ds_read_b64_tr_b16 v[192:193], v29 offset:0
  ds_read_b64_tr_b16 v[194:195], v29 offset:20480
  ds_read_b64_tr_b16 v[196:197], v29 offset:32
  ds_read_b64_tr_b16 v[198:199], v29 offset:20512
  ds_read_b64_tr_b16 v[200:201], v29 offset:64
  ds_read_b64_tr_b16 v[202:203], v29 offset:20544
  ds_read_b64_tr_b16 v[204:205], v29 offset:96
  ds_read_b64_tr_b16 v[206:207], v29 offset:20576
  ds_read_b64_tr_b16 v[208:209], v29 offset:128
  ds_read_b64_tr_b16 v[210:211], v29 offset:20608
  ds_read_b64_tr_b16 v[212:213], v29 offset:160
  ds_read_b64_tr_b16 v[214:215], v29 offset:20640
  ds_read_b64_tr_b16 v[216:217], v29 offset:192
  ds_read_b64_tr_b16 v[218:219], v29 offset:20672
  ds_read_b64_tr_b16 v[220:221], v29 offset:224
  ds_read_b64_tr_b16 v[222:223], v29 offset:20704
  ds_read_b64_tr_b16 v[224:225], v29 offset:256
  ds_read_b64_tr_b16 v[226:227], v29 offset:20736
  ds_read_b64_tr_b16 v[228:229], v29 offset:288
  ds_read_b64_tr_b16 v[230:231], v29 offset:20768
  v_mfma_f32_16x16x32_bf16 v[232:235], v[112:115], v[32:35], 0
  v_mfma_f32_16x16x32_bf16 v[232:235], v[116:119], v[36:39], v[232:235]
  v_mfma_f32_16x16x32_bf16 v[232:235], v[120:123], v[40:43], v[232:235]
  v_mfma_f32_16x16x32_bf16 v[232:235], v[124:127], v[44:47], v[232:235]
  v_mfma_f32_16x16x32_bf16 v[232:235], v[128:131], v[48:51], v[232:235]
  v_mfma_f32_16x16x32_bf16 v[232:235], v[132:135], v[52:55], v[232:235]
  v_mfma_f32_16x16x32_bf16 v[232:235], v[136:139], v[56:59], v[232:235]
  v_mfma_f32_16x16x32_bf16 v[232:235], v[140:143], v[60:63], v[232:235]
  v_mfma_f32_16x16x32_bf16 v[232:235], v[144:147], v[64:67], v[232:235]
  v_mfma_f32_16x16x32_bf16 v[232:235], v[148:151], v[68:71], v[232:235]
  v_mfma_f32_16x16x32_bf16 v[232:235], v[152:155], v[72:75], v[232:235]
  v_mfma_f32_16x16x32_bf16 v[232:235], v[156:159], v[76:79], v[232:235]
  v_mfma_f32_16x16x32_bf16 v[232:235], v[160:163], v[80:83], v[232:235]
  v_mfma_f32_16x16x32_bf16 v[232:235], v[164:167], v[84:87], v[232:235]
  v_mfma_f32_16x16x32_bf16 v[232:235], v[168:171], v[88:91], v[232:235]
  v_mfma_f32_16x16x32_bf16 v[232:235], v[172:175], v[92:95], v[232:235]
  v_mfma_f32_16x16x32_bf16 v[232:235], v[176:179], v[96:99], v[232:235]
  v_mfma_f32_16x16x32_bf16 v[232:235], v[180:183], v[100:103], v[232:235]
  v_mfma_f32_16x16x32_bf16 v[232:235], v[184:187], v[104:107], v[232:235]
  v_mfma_f32_16x16x32_bf16 v[232:235], v[188:191], v[108:111], v[232:235]
  s_nop 7
  ds_write_b128 v30, v[232:235]
  v_add_u32 v30, 122880, v2
  s_waitcnt lgkmcnt(0)
  s_barrier
  ds_read_b128 v[32:35], v30 offset:0
  ds_read_b128 v[36:39], v30 offset:1024
  ds_read_b128 v[40:43], v30 offset:2048
  ds_read_b128 v[44:47], v30 offset:3072
  v_and_b32 v20, 15, v1
  v_mul_u32_u24 v28, 2560, v20
  v_lshl_add_u32 v28, v24, 4, v28
  v_cmp_gt_u32 vcc, 8, v20
  s_mul_i32 s23, s82, 20480
  s_mul_i32 s31, s20, 640
  v_cndmask_b32 v28, v21, v28, vcc
  s_add_u32 s23, s23, s31
  s_add_u32 s23, s23, 2686976
  s_waitcnt lgkmcnt(0)
  v_cvt_pk_bf16_f32 v32, v32, v32
  v_and_b32 v32, 0xffff0000, v32
  v_cvt_pk_bf16_f32 v33, v33, v33
  v_and_b32 v33, 0xffff0000, v33
  v_cvt_pk_bf16_f32 v34, v34, v34
  v_and_b32 v34, 0xffff0000, v34
  v_cvt_pk_bf16_f32 v35, v35, v35
  v_and_b32 v35, 0xffff0000, v35
  v_cvt_pk_bf16_f32 v36, v36, v36
  v_and_b32 v36, 0xffff0000, v36
  v_cvt_pk_bf16_f32 v37, v37, v37
  v_and_b32 v37, 0xffff0000, v37
  v_cvt_pk_bf16_f32 v38, v38, v38
  v_and_b32 v38, 0xffff0000, v38
  v_cvt_pk_bf16_f32 v39, v39, v39
  v_and_b32 v39, 0xffff0000, v39
  v_cvt_pk_bf16_f32 v40, v40, v40
  v_and_b32 v40, 0xffff0000, v40
  v_cvt_pk_bf16_f32 v41, v41, v41
  v_and_b32 v41, 0xffff0000, v41
  v_cvt_pk_bf16_f32 v42, v42, v42
  v_and_b32 v42, 0xffff0000, v42
  v_cvt_pk_bf16_f32 v43, v43, v43
  v_and_b32 v43, 0xffff0000, v43
  v_cvt_pk_bf16_f32 v44, v44, v44
  v_and_b32 v44, 0xffff0000, v44
  v_cvt_pk_bf16_f32 v45, v45, v45
  v_and_b32 v45, 0xffff0000, v45
  v_cvt_pk_bf16_f32 v46, v46, v46
  v_and_b32 v46, 0xffff0000, v46
  v_cvt_pk_bf16_f32 v47, v47, v47
  v_and_b32 v47, 0xffff0000, v47
  v_mul_f32 v48, 0xbfb8aa3b, v32
  v_mul_f32 v49, 0xbfb8aa3b, v33
  v_mul_f32 v50, 0xbfb8aa3b, v34
  v_mul_f32 v51, 0xbfb8aa3b, v35
  v_mul_f32 v52, 0xbfb8aa3b, v36
  v_mul_f32 v53, 0xbfb8aa3b, v37
  v_mul_f32 v54, 0xbfb8aa3b, v38
  v_mul_f32 v55, 0xbfb8aa3b, v39
  v_exp_f32 v48, v48
  v_exp_f32 v49, v49
  v_exp_f32 v50, v50
  v_exp_f32 v51, v51
  v_exp_f32 v52, v52
  v_exp_f32 v53, v53
  v_exp_f32 v54, v54
  v_exp_f32 v55, v55
  v_add_f32 v48, 1.0, v48
  v_add_f32 v49, 1.0, v49
  v_add_f32 v50, 1.0, v50
  v_add_f32 v51, 1.0, v51
  v_add_f32 v52, 1.0, v52
  v_add_f32 v53, 1.0, v53
  v_add_f32 v54, 1.0, v54
  v_add_f32 v55, 1.0, v55
  v_rcp_f32 v48, v48
  v_rcp_f32 v49, v49
  v_rcp_f32 v50, v50
  v_rcp_f32 v51, v51
  v_rcp_f32 v52, v52
  v_rcp_f32 v53, v53
  v_rcp_f32 v54, v54
  v_rcp_f32 v55, v55
  v_mul_f32 v32, v32, v48
  v_mul_f32 v33, v33, v49
  v_mul_f32 v34, v34, v50
  v_mul_f32 v35, v35, v51
  v_mul_f32 v36, v36, v52
  v_mul_f32 v37, v37, v53
  v_mul_f32 v38, v38, v54
  v_mul_f32 v39, v39, v55
  v_cvt_pk_bf16_f32 v32, v32, v32
  v_and_b32 v32, 0xffff0000, v32
  v_cvt_pk_bf16_f32 v33, v33, v33
  v_and_b32 v33, 0xffff0000, v33
  v_cvt_pk_bf16_f32 v34, v34, v34
  v_and_b32 v34, 0xffff0000, v34
  v_cvt_pk_bf16_f32 v35, v35, v35
  v_and_b32 v35, 0xffff0000, v35
  v_cvt_pk_bf16_f32 v36, v36, v36
  v_and_b32 v36, 0xffff0000, v36
  v_cvt_pk_bf16_f32 v37, v37, v37
  v_and_b32 v37, 0xffff0000, v37
  v_cvt_pk_bf16_f32 v38, v38, v38
  v_and_b32 v38, 0xffff0000, v38
  v_cvt_pk_bf16_f32 v39, v39, v39
  v_and_b32 v39, 0xffff0000, v39
  v_mul_f32 v32, v32, v40
  v_mul_f32 v33, v33, v41
  v_mul_f32 v34, v34, v42
  v_mul_f32 v35, v35, v43
  v_mul_f32 v36, v36, v44
  v_mul_f32 v37, v37, v45
  v_mul_f32 v38, v38, v46
  v_mul_f32 v39, v39, v47
  v_cvt_pk_bf16_f32 v56, v32, v33
  v_cvt_pk_bf16_f32 v57, v34, v35
  v_cvt_pk_bf16_f32 v58, v36, v37
  v_cvt_pk_bf16_f32 v59, v38, v39
  s_nop 1
  v_mfma_f32_16x16x32_bf16 v[64:67], v[192:195], v[56:59], 0
  v_mfma_f32_16x16x32_bf16 v[68:71], v[196:199], v[56:59], 0
  v_mfma_f32_16x16x32_bf16 v[72:75], v[200:203], v[56:59], 0
  v_mfma_f32_16x16x32_bf16 v[76:79], v[204:207], v[56:59], 0
  v_mfma_f32_16x16x32_bf16 v[80:83], v[208:211], v[56:59], 0
  v_mfma_f32_16x16x32_bf16 v[84:87], v[212:215], v[56:59], 0
  v_mfma_f32_16x16x32_bf16 v[88:91], v[216:219], v[56:59], 0
  v_mfma_f32_16x16x32_bf16 v[92:95], v[220:223], v[56:59], 0
  v_mfma_f32_16x16x32_bf16 v[96:99], v[224:227], v[56:59], 0
  v_mfma_f32_16x16x32_bf16 v[100:103], v[228:231], v[56:59], 0
  s_nop 7
  buffer_store_dwordx4 v[64:67], v28, s[40:43], s23 offen offset:0
  buffer_store_dwordx4 v[68:71], v28, s[40:43], s23 offen offset:64
  buffer_store_dwordx4 v[72:75], v28, s[40:43], s23 offen offset:128
  buffer_store_dwordx4 v[76:79], v28, s[40:43], s23 offen offset:192
  buffer_store_dwordx4 v[80:83], v28, s[40:43], s23 offen offset:256
  buffer_store_dwordx4 v[84:87], v28, s[40:43], s23 offen offset:320
  buffer_store_dwordx4 v[88:91], v28, s[40:43], s23 offen offset:384
  buffer_store_dwordx4 v[92:95], v28, s[40:43], s23 offen offset:448
  buffer_store_dwordx4 v[96:99], v28, s[40:43], s23 offen offset:512
  buffer_store_dwordx4 v[100:103], v28, s[40:43], s23 offen offset:576
k2_end:
  s_endpgm
k2_stub0:
  s_call_b64 s[76:77], k2_rare00
  s_call_b64 s[76:77], k2_rare10
  s_branch k2_back0
k2_stub1:
  s_call_b64 s[76:77], k2_rare01
  s_call_b64 s[76:77], k2_rare11
  s_branch k2_back1
k2_stub2:
  s_call_b64 s[76:77], k2_rare00
  s_call_b64 s[76:77], k2_rare10
  s_branch k2_back2
k2_stub3:
  s_call_b64 s[76:77], k2_rare01
  s_call_b64 s[76:77], k2_rare11
  s_branch k2_back3
k2_stub4:
  s_call_b64 s[76:77], k2_rare00
  s_call_b64 s[76:77], k2_rare10
  s_branch k2_back4
k2_stub5:
  s_call_b64 s[76:77], k2_rare11
  s_branch k2_back5
k2_stub6:
  s_call_b64 s[76:77], k2_rare10
  s_branch k2_back6
k2_stub7:
  s_call_b64 s[76:77], k2_rare01
  s_call_b64 s[76:77], k2_rare11
  s_branch k2_back7
k2_stub8:
  s_call_b64 s[76:77], k2_rare10
  s_branch k2_back8
k2_stub9:
  s_call_b64 s[76:77], k2_rare11
  s_branch k2_back9
k2_stub10:
  s_call_b64 s[76:77], k2_rare10
  s_branch k2_back10
k2_stub11:
  s_call_b64 s[76:77], k2_rare11
  s_branch k2_back11
k2_stub12:
  s_call_b64 s[76:77], k2_rare10
  s_branch k2_back12
k2_stub13:
  s_call_b64 s[76:77], k2_rare11
  s_branch k2_back13
k2_rare00:
  s_nop 7
  v_max3_f32 v16, v96, v97, v98
  v_max3_f32 v16, v16, v99, v100
  v_max3_f32 v16, v16, v101, v102
  v_max3_f32 v16, v16, v103, 0
  v_mov_b32 v18, v16
  s_nop 1
  v_permlane16_swap_b32 v16, v18
  v_max_f32 v16, v16, v18
  v_mov_b32 v18, v16
  s_nop 1
  v_permlane32_swap_b32 v16, v18
  v_max_f32 v16, v16, v18
  v_sub_f32 v96, v96, v16
  v_sub_f32 v112, v112, v16
  v_sub_f32 v97, v97, v16
  v_sub_f32 v113, v113, v16
  v_sub_f32 v98, v98, v16
  v_sub_f32 v114, v114, v16
  v_sub_f32 v99, v99, v16
  v_sub_f32 v115, v115, v16
  v_sub_f32 v100, v100, v16
  v_sub_f32 v116, v116, v16
  v_sub_f32 v101, v101, v16
  v_sub_f32 v117, v117, v16
  v_sub_f32 v102, v102, v16
  v_sub_f32 v118, v118, v16
  v_sub_f32 v103, v103, v16
  v_sub_f32 v119, v119, v16
  v_max3_f32 v17, v104, v105, v106
  v_max3_f32 v17, v17, v107, v108
  v_max3_f32 v17, v17, v109, v110
  v_max3_f32 v17, v17, v111, 0
  v_mov_b32 v18, v17
  s_nop 1
  v_permlane16_swap_b32 v17, v18
  v_max_f32 v17, v17, v18
  v_mov_b32 v18, v17
  s_nop 1
  v_permlane32_swap_b32 v17, v18
  v_max_f32 v17, v17, v18
  v_sub_f32 v104, v104, v17
  v_sub_f32 v120, v120, v17
  v_sub_f32 v105, v105, v17
  v_sub_f32 v121, v121, v17
  v_sub_f32 v106, v106, v17
  v_sub_f32 v122, v122, v17
  v_sub_f32 v107, v107, v17
  v_sub_f32 v123, v123, v17
  v_sub_f32 v108, v108, v17
  v_sub_f32 v124, v124, v17
  v_sub_f32 v109, v109, v17
  v_sub_f32 v125, v125, v17
  v_sub_f32 v110, v110, v17
  v_sub_f32 v126, v126, v17
  v_sub_f32 v111, v111, v17
  v_sub_f32 v127, v127, v17
  s_call_b64 s[78:79], k2_resc0
  v_exp_f32 v208, v96
  v_exp_f32 v209, v97
  v_exp_f32 v210, v98
  v_add_f32 v224, v208, v209
  v_cvt_pk_bf16_f32 v160, v208, v209
  v_exp_f32 v211, v99
  v_add_f32 v224, v224, v210
  v_exp_f32 v212, v100
  v_add_f32 v224, v224, v211
  v_cvt_pk_bf16_f32 v161, v210, v211
  v_exp_f32 v213, v101
  v_add_f32 v224, v224, v212
  v_exp_f32 v214, v102
  v_add_f32 v224, v224, v213
  v_cvt_pk_bf16_f32 v162, v212, v213
  v_exp_f32 v215, v103
  v_add_f32 v224, v224, v214
  v_exp_f32 v208, v104
  v_add_f32 v224, v224, v215
  v_cvt_pk_bf16_f32 v163, v214, v215
  v_exp_f32 v209, v105
  v_exp_f32 v210, v106
  v_add_f32 v225, v208, v209
  v_cvt_pk_bf16_f32 v164, v208, v209
  v_exp_f32 v211, v107
  v_add_f32 v225, v225, v210
  v_exp_f32 v212, v108
  v_add_f32 v225, v225, v211
  v_cvt_pk_bf16_f32 v165, v210, v211
  v_exp_f32 v213, v109
  v_add_f32 v225, v225, v212
  v_exp_f32 v214, v110
  v_add_f32 v225, v225, v213
  v_cvt_pk_bf16_f32 v166, v212, v213
  v_exp_f32 v215, v111
  v_add_f32 v225, v225, v214
  s_nop 0
  v_add_f32 v225, v225, v215
  v_cvt_pk_bf16_f32 v167, v214, v215
  s_nop 1
  s_setpc_b64 s[76:77]
k2_rare01:
  s_nop 7
  v_max3_f32 v16, v112, v113, v114
  v_max3_f32 v16, v16, v115, v116
  v_max3_f32 v16, v16, v117, v118
  v_max3_f32 v16, v16, v119, 0
  v_mov_b32 v18, v16
  s_nop 1
  v_permlane16_swap_b32 v16, v18
  v_max_f32 v16, v16, v18
  v_mov_b32 v18, v16
  s_nop 1
  v_permlane32_swap_b32 v16, v18
  v_max_f32 v16, v16, v18
  v_sub_f32 v112, v112, v16
  v_sub_f32 v96, v96, v16
  v_sub_f32 v113, v113, v16
  v_sub_f32 v97, v97, v16
  v_sub_f32 v114, v114, v16
  v_sub_f32 v98, v98, v16
  v_sub_f32 v115, v115, v16
  v_sub_f32 v99, v99, v16
  v_sub_f32 v116, v116, v16
  v_sub_f32 v100, v100, v16
  v_sub_f32 v117, v117, v16
  v_sub_f32 v101, v101, v16
  v_sub_f32 v118, v118, v16
  v_sub_f32 v102, v102, v16
  v_sub_f32 v119, v119, v16
  v_sub_f32 v103, v103, v16
  v_max3_f32 v17, v120, v121, v122
  v_max3_f32 v17, v17, v123, v124
  v_max3_f32 v17, v17, v125, v126
  v_max3_f32 v17, v17, v127, 0
  v_mov_b32 v18, v17
  s_nop 1
  v_permlane16_swap_b32 v17, v18
  v_max_f32 v17, v17, v18
  v_mov_b32 v18, v17
  s_nop 1
  v_permlane32_swap_b32 v17, v18
  v_max_f32 v17, v17, v18
  v_sub_f32 v120, v120, v17
  v_sub_f32 v104, v104, v17
  v_sub_f32 v121, v121, v17
  v_sub_f32 v105, v105, v17
  v_sub_f32 v122, v122, v17
  v_sub_f32 v106, v106, v17
  v_sub_f32 v123, v123, v17
  v_sub_f32 v107, v107, v17
  v_sub_f32 v124, v124, v17
  v_sub_f32 v108, v108, v17
  v_sub_f32 v125, v125, v17
  v_sub_f32 v109, v109, v17
  v_sub_f32 v126, v126, v17
  v_sub_f32 v110, v110, v17
  v_sub_f32 v127, v127, v17
  v_sub_f32 v111, v111, v17
  s_call_b64 s[78:79], k2_resc0
  v_exp_f32 v208, v112
  v_exp_f32 v209, v113
  v_exp_f32 v210, v114
  v_add_f32 v224, v208, v209
  v_cvt_pk_bf16_f32 v168, v208, v209
  v_exp_f32 v211, v115
  v_add_f32 v224, v224, v210
  v_exp_f32 v212, v116
  v_add_f32 v224, v224, v211
  v_cvt_pk_bf16_f32 v169, v210, v211
  v_exp_f32 v213, v117
  v_add_f32 v224, v224, v212
  v_exp_f32 v214, v118
  v_add_f32 v224, v224, v213
  v_cvt_pk_bf16_f32 v170, v212, v213
  v_exp_f32 v215, v119
  v_add_f32 v224, v224, v214
  v_exp_f32 v208, v120
  v_add_f32 v224, v224, v215
  v_cvt_pk_bf16_f32 v171, v214, v215
  v_exp_f32 v209, v121
  v_exp_f32 v210, v122
  v_add_f32 v225, v208, v209
  v_cvt_pk_bf16_f32 v172, v208, v209
  v_exp_f32 v211, v123
  v_add_f32 v225, v225, v210
  v_exp_f32 v212, v124
  v_add_f32 v225, v225, v211
  v_cvt_pk_bf16_f32 v173, v210, v211
  v_exp_f32 v213, v125
  v_add_f32 v225, v225, v212
  v_exp_f32 v214, v126
  v_add_f32 v225, v225, v213
  v_cvt_pk_bf16_f32 v174, v212, v213
  v_exp_f32 v215, v127
  v_add_f32 v225, v225, v214
  s_nop 0
  v_add_f32 v225, v225, v215
  v_cvt_pk_bf16_f32 v175, v214, v215
  s_nop 1
  s_setpc_b64 s[76:77]
k2_resc0:
  v_sub_f32 v192, v192, v16
  v_sub_f32 v193, v193, v16
  v_sub_f32 v194, v194, v16
  v_sub_f32 v195, v195, v16
  v_exp_f32 v18, -v16
  v_sub_f32 v196, v196, v17
  v_sub_f32 v197, v197, v17
  v_sub_f32 v198, v198, v17
  v_sub_f32 v199, v199, v17
  v_exp_f32 v19, -v17
  s_nop 0
  v_mul_f32 v228, v228, v18
  v_mul_f32 v229, v229, v19
  v_accvgpr_read_b32 v20, a0
  v_accvgpr_read_b32 v21, a1
  v_accvgpr_read_b32 v22, a2
  v_accvgpr_read_b32 v23, a3
  v_mul_f32 v20, v20, v18
  v_mul_f32 v21, v21, v18
  v_mul_f32 v22, v22, v18
  v_mul_f32 v23, v23, v18
  v_accvgpr_write_b32 a0, v20
  v_accvgpr_write_b32 a1, v21
  v_accvgpr_write_b32 a2, v22
  v_accvgpr_write_b32 a3, v23
  v_accvgpr_read_b32 v20, a4
  v_accvgpr_read_b32 v21, a5
  v_accvgpr_read_b32 v22, a6
  v_accvgpr_read_b32 v23, a7
  v_mul_f32 v20, v20, v19
  v_mul_f32 v21, v21, v19
  v_mul_f32 v22, v22, v19
  v_mul_f32 v23, v23, v19
  v_accvgpr_write_b32 a4, v20
  v_accvgpr_write_b32 a5, v21
  v_accvgpr_write_b32 a6, v22
  v_accvgpr_write_b32 a7, v23
  v_accvgpr_read_b32 v20, a8
  v_accvgpr_read_b32 v21, a9
  v_accvgpr_read_b32 v22, a10
  v_accvgpr_read_b32 v23, a11
  v_mul_f32 v20, v20, v18
  v_mul_f32 v21, v21, v18
  v_mul_f32 v22, v22, v18
  v_mul_f32 v23, v23, v18
  v_accvgpr_write_b32 a8, v20
  v_accvgpr_write_b32 a9, v21
  v_accvgpr_write_b32 a10, v22
  v_accvgpr_write_b32 a11, v23
  v_accvgpr_read_b32 v20, a12
  v_accvgpr_read_b32 v21, a13
  v_accvgpr_read_b32 v22, a14
  v_accvgpr_read_b32 v23, a15
  v_mul_f32 v20, v20, v19
  v_mul_f32 v21, v21, v19
  v_mul_f32 v22, v22, v19
  v_mul_f32 v23, v23, v19
  v_accvgpr_write_b32 a12, v20
  v_accvgpr_write_b32 a13, v21
  v_accvgpr_write_b32 a14, v22
  v_accvgpr_write_b32 a15, v23
  v_accvgpr_read_b32 v20, a16
  v_accvgpr_read_b32 v21, a17
  v_accvgpr_read_b32 v22, a18
  v_accvgpr_read_b32 v23, a19
  v_mul_f32 v20, v20, v18
  v_mul_f32 v21, v21, v18
  v_mul_f32 v22, v22, v18
  v_mul_f32 v23, v23, v18
  v_accvgpr_write_b32 a16, v20
  v_accvgpr_write_b32 a17, v21
  v_accvgpr_write_b32 a18, v22
  v_accvgpr_write_b32 a19, v23
  v_accvgpr_read_b32 v20, a20
  v_accvgpr_read_b32 v21, a21
  v_accvgpr_read_b32 v22, a22
  v_accvgpr_read_b32 v23, a23
  v_mul_f32 v20, v20, v19
  v_mul_f32 v21, v21, v19
  v_mul_f32 v22, v22, v19
  v_mul_f32 v23, v23, v19
  v_accvgpr_write_b32 a20, v20
  v_accvgpr_write_b32 a21, v21
  v_accvgpr_write_b32 a22, v22
  v_accvgpr_write_b32 a23, v23
  v_accvgpr_read_b32 v20, a24
  v_accvgpr_read_b32 v21, a25
  v_accvgpr_read_b32 v22, a26
  v_accvgpr_read_b32 v23, a27
  v_mul_f32 v20, v20, v18
  v_mul_f32 v21, v21, v18
  v_mul_f32 v22, v22, v18
  v_mul_f32 v23, v23, v18
  v_accvgpr_write_b32 a24, v20
  v_accvgpr_write_b32 a25, v21
  v_accvgpr_write_b32 a26, v22
  v_accvgpr_write_b32 a27, v23
  v_accvgpr_read_b32 v20, a28
  v_accvgpr_read_b32 v21, a29
  v_accvgpr_read_b32 v22, a30
  v_accvgpr_read_b32 v23, a31
  v_mul_f32 v20, v20, v19
  v_mul_f32 v21, v21, v19
  v_mul_f32 v22, v22, v19
  v_mul_f32 v23, v23, v19
  v_accvgpr_write_b32 a28, v20
  v_accvgpr_write_b32 a29, v21
  v_accvgpr_write_b32 a30, v22
  v_accvgpr_write_b32 a31, v23
  v_accvgpr_read_b32 v20, a32
  v_accvgpr_read_b32 v21, a33
  v_accvgpr_read_b32 v22, a34
  v_accvgpr_read_b32 v23, a35
  v_mul_f32 v20, v20, v18
  v_mul_f32 v21, v21, v18
  v_mul_f32 v22, v22, v18
  v_mul_f32 v23, v23, v18
  v_accvgpr_write_b32 a32, v20
  v_accvgpr_write_b32 a33, v21
  v_accvgpr_write_b32 a34, v22
  v_accvgpr_write_b32 a35, v23
  v_accvgpr_read_b32 v20, a36
  v_accvgpr_read_b32 v21, a37
  v_accvgpr_read_b32 v22, a38
  v_accvgpr_read_b32 v23, a39
  v_mul_f32 v20, v20, v19
  v_mul_f32 v21, v21, v19
  v_mul_f32 v22, v22, v19
  v_mul_f32 v23, v23, v19
  v_accvgpr_write_b32 a36, v20
  v_accvgpr_write_b32 a37, v21
  v_accvgpr_write_b32 a38, v22
  v_accvgpr_write_b32 a39, v23
  v_accvgpr_read_b32 v20, a40
  v_accvgpr_read_b32 v21, a41
  v_accvgpr_read_b32 v22, a42
  v_accvgpr_read_b32 v23, a43
  v_mul_f32 v20, v20, v18
  v_mul_f32 v21, v21, v18
  v_mul_f32 v22, v22, v18
  v_mul_f32 v23, v23, v18
  v_accvgpr_write_b32 a40, v20
  v_accvgpr_write_b32 a41, v21
  v_accvgpr_write_b32 a42, v22
  v_accvgpr_write_b32 a43, v23
  v_accvgpr_read_b32 v20, a44
  v_accvgpr_read_b32 v21, a45
  v_accvgpr_read_b32 v22, a46
  v_accvgpr_read_b32 v23, a47
  v_mul_f32 v20, v20, v19
  v_mul_f32 v21, v21, v19
  v_mul_f32 v22, v22, v19
  v_mul_f32 v23, v23, v19
  v_accvgpr_write_b32 a44, v20
  v_accvgpr_write_b32 a45, v21
  v_accvgpr_write_b32 a46, v22
  v_accvgpr_write_b32 a47, v23
  v_accvgpr_read_b32 v20, a48
  v_accvgpr_read_b32 v21, a49
  v_accvgpr_read_b32 v22, a50
  v_accvgpr_read_b32 v23, a51
  v_mul_f32 v20, v20, v18
  v_mul_f32 v21, v21, v18
  v_mul_f32 v22, v22, v18
  v_mul_f32 v23, v23, v18
  v_accvgpr_write_b32 a48, v20
  v_accvgpr_write_b32 a49, v21
  v_accvgpr_write_b32 a50, v22
  v_accvgpr_write_b32 a51, v23
  v_accvgpr_read_b32 v20, a52
  v_accvgpr_read_b32 v21, a53
  v_accvgpr_read_b32 v22, a54
  v_accvgpr_read_b32 v23, a55
  v_mul_f32 v20, v20, v19
  v_mul_f32 v21, v21, v19
  v_mul_f32 v22, v22, v19
  v_mul_f32 v23, v23, v19
  v_accvgpr_write_b32 a52, v20
  v_accvgpr_write_b32 a53, v21
  v_accvgpr_write_b32 a54, v22
  v_accvgpr_write_b32 a55, v23
  v_accvgpr_read_b32 v20, a56
  v_accvgpr_read_b32 v21, a57
  v_accvgpr_read_b32 v22, a58
  v_accvgpr_read_b32 v23, a59
  v_mul_f32 v20, v20, v18
  v_mul_f32 v21, v21, v18
  v_mul_f32 v22, v22, v18
  v_mul_f32 v23, v23, v18
  v_accvgpr_write_b32 a56, v20
  v_accvgpr_write_b32 a57, v21
  v_accvgpr_write_b32 a58, v22
  v_accvgpr_write_b32 a59, v23
  v_accvgpr_read_b32 v20, a60
  v_accvgpr_read_b32 v21, a61
  v_accvgpr_read_b32 v22, a62
  v_accvgpr_read_b32 v23, a63
  v_mul_f32 v20, v20, v19
  v_mul_f32 v21, v21, v19
  v_mul_f32 v22, v22, v19
  v_mul_f32 v23, v23, v19
  v_accvgpr_write_b32 a60, v20
  v_accvgpr_write_b32 a61, v21
  v_accvgpr_write_b32 a62, v22
  v_accvgpr_write_b32 a63, v23
  s_setpc_b64 s[78:79]
k2_rare10:
  s_nop 7
  v_max3_f32 v16, v128, v129, v130
  v_max3_f32 v16, v16, v131, v132
  v_max3_f32 v16, v16, v133, v134
  v_max3_f32 v16, v16, v135, 0
  v_mov_b32 v18, v16
  s_nop 1
  v_permlane16_swap_b32 v16, v18
  v_max_f32 v16, v16, v18
  v_mov_b32 v18, v16
  s_nop 1
  v_permlane32_swap_b32 v16, v18
  v_max_f32 v16, v16, v18
  v_sub_f32 v128, v128, v16
  v_sub_f32 v144, v144, v16
  v_sub_f32 v129, v129, v16
  v_sub_f32 v145, v145, v16
  v_sub_f32 v130, v130, v16
  v_sub_f32 v146, v146, v16
  v_sub_f32 v131, v131, v16
  v_sub_f32 v147, v147, v16
  v_sub_f32 v132, v132, v16
  v_sub_f32 v148, v148, v16
  v_sub_f32 v133, v133, v16
  v_sub_f32 v149, v149, v16
  v_sub_f32 v134, v134, v16
  v_sub_f32 v150, v150, v16
  v_sub_f32 v135, v135, v16
  v_sub_f32 v151, v151, v16
  v_max3_f32 v17, v136, v137, v138
  v_max3_f32 v17, v17, v139, v140
  v_max3_f32 v17, v17, v141, v142
  v_max3_f32 v17, v17, v143, 0
  v_mov_b32 v18, v17
  s_nop 1
  v_permlane16_swap_b32 v17, v18
  v_max_f32 v17, v17, v18
  v_mov_b32 v18, v17
  s_nop 1
  v_permlane32_swap_b32 v17, v18
  v_max_f32 v17, v17, v18
  v_sub_f32 v136, v136, v17
  v_sub_f32 v152, v152, v17
  v_sub_f32 v137, v137, v17
  v_sub_f32 v153, v153, v17
  v_sub_f32 v138, v138, v17
  v_sub_f32 v154, v154, v17
  v_sub_f32 v139, v139, v17
  v_sub_f32 v155, v155, v17
  v_sub_f32 v140, v140, v17
  v_sub_f32 v156, v156, v17
  v_sub_f32 v141, v141, v17
  v_sub_f32 v157, v157, v17
  v_sub_f32 v142, v142, v17
  v_sub_f32 v158, v158, v17
  v_sub_f32 v143, v143, v17
  v_sub_f32 v159, v159, v17
  s_call_b64 s[78:79], k2_resc1
  v_exp_f32 v216, v128
  v_exp_f32 v217, v129
  v_exp_f32 v218, v130
  v_add_f32 v226, v216, v217
  v_cvt_pk_bf16_f32 v176, v216, v217
  v_exp_f32 v219, v131
  v_add_f32 v226, v226, v218
  v_exp_f32 v220, v132
  v_add_f32 v226, v226, v219
  v_cvt_pk_bf16_f32 v177, v218, v219
  v_exp_f32 v221, v133
  v_add_f32 v226, v226, v220
  v_exp_f32 v222, v134
  v_add_f32 v226, v226, v221
  v_cvt_pk_bf16_f32 v178, v220, v221
  v_exp_f32 v223, v135
  v_add_f32 v226, v226, v222
  v_exp_f32 v216, v136
  v_add_f32 v226, v226, v223
  v_cvt_pk_bf16_f32 v179, v222, v223
  v_exp_f32 v217, v137
  v_exp_f32 v218, v138
  v_add_f32 v227, v216, v217
  v_cvt_pk_bf16_f32 v180, v216, v217
  v_exp_f32 v219, v139
  v_add_f32 v227, v227, v218
  v_exp_f32 v220, v140
  v_add_f32 v227, v227, v219
  v_cvt_pk_bf16_f32 v181, v218, v219
  v_exp_f32 v221, v141
  v_add_f32 v227, v227, v220
  v_exp_f32 v222, v142
  v_add_f32 v227, v227, v221
  v_cvt_pk_bf16_f32 v182, v220, v221
  v_exp_f32 v223, v143
  v_add_f32 v227, v227, v222
  s_nop 0
  v_add_f32 v227, v227, v223
  v_cvt_pk_bf16_f32 v183, v222, v223
  s_nop 1
  s_setpc_b64 s[76:77]
k2_rare11:
  s_nop 7
  v_max3_f32 v16, v144, v145, v146
  v_max3_f32 v16, v16, v147, v148
  v_max3_f32 v16, v16, v149, v150
  v_max3_f32 v16, v16, v151, 0
  v_mov_b32 v18, v16
  s_nop 1
  v_permlane16_swap_b32 v16, v18
  v_max_f32 v16, v16, v18
  v_mov_b32 v18, v16
  s_nop 1
  v_permlane32_swap_b32 v16, v18
  v_max_f32 v16, v16, v18
  v_sub_f32 v144, v144, v16
  v_sub_f32 v128, v128, v16
  v_sub_f32 v145, v145, v16
  v_sub_f32 v129, v129, v16
  v_sub_f32 v146, v146, v16
  v_sub_f32 v130, v130, v16
  v_sub_f32 v147, v147, v16
  v_sub_f32 v131, v131, v16
  v_sub_f32 v148, v148, v16
  v_sub_f32 v132, v132, v16
  v_sub_f32 v149, v149, v16
  v_sub_f32 v133, v133, v16
  v_sub_f32 v150, v150, v16
  v_sub_f32 v134, v134, v16
  v_sub_f32 v151, v151, v16
  v_sub_f32 v135, v135, v16
  v_max3_f32 v17, v152, v153, v154
  v_max3_f32 v17, v17, v155, v156
  v_max3_f32 v17, v17, v157, v158
  v_max3_f32 v17, v17, v159, 0
  v_mov_b32 v18, v17
  s_nop 1
  v_permlane16_swap_b32 v17, v18
  v_max_f32 v17, v17, v18
  v_mov_b32 v18, v17
  s_nop 1
  v_permlane32_swap_b32 v17, v18
  v_max_f32 v17, v17, v18
  v_sub_f32 v152, v152, v17
  v_sub_f32 v136, v136, v17
  v_sub_f32 v153, v153, v17
  v_sub_f32 v137, v137, v17
  v_sub_f32 v154, v154, v17
  v_sub_f32 v138, v138, v17
  v_sub_f32 v155, v155, v17
  v_sub_f32 v139, v139, v17
  v_sub_f32 v156, v156, v17
  v_sub_f32 v140, v140, v17
  v_sub_f32 v157, v157, v17
  v_sub_f32 v141, v141, v17
  v_sub_f32 v158, v158, v17
  v_sub_f32 v142, v142, v17
  v_sub_f32 v159, v159, v17
  v_sub_f32 v143, v143, v17
  s_call_b64 s[78:79], k2_resc1
  v_exp_f32 v216, v144
  v_exp_f32 v217, v145
  v_exp_f32 v218, v146
  v_add_f32 v226, v216, v217
  v_cvt_pk_bf16_f32 v184, v216, v217
  v_exp_f32 v219, v147
  v_add_f32 v226, v226, v218
  v_exp_f32 v220, v148
  v_add_f32 v226, v226, v219
  v_cvt_pk_bf16_f32 v185, v218, v219
  v_exp_f32 v221, v149
  v_add_f32 v226, v226, v220
  v_exp_f32 v222, v150
  v_add_f32 v226, v226, v221
  v_cvt_pk_bf16_f32 v186, v220, v221
  v_exp_f32 v223, v151
  v_add_f32 v226, v226, v222
  v_exp_f32 v216, v152
  v_add_f32 v226, v226, v223
  v_cvt_pk_bf16_f32 v187, v222, v223
  v_exp_f32 v217, v153
  v_exp_f32 v218, v154
  v_add_f32 v227, v216, v217
  v_cvt_pk_bf16_f32 v188, v216, v217
  v_exp_f32 v219, v155
  v_add_f32 v227, v227, v218
  v_exp_f32 v220, v156
  v_add_f32 v227, v227, v219
  v_cvt_pk_bf16_f32 v189, v218, v219
  v_exp_f32 v221, v157
  v_add_f32 v227, v227, v220
  v_exp_f32 v222, v158
  v_add_f32 v227, v227, v221
  v_cvt_pk_bf16_f32 v190, v220, v221
  v_exp_f32 v223, v159
  v_add_f32 v227, v227, v222
  s_nop 0
  v_add_f32 v227, v227, v223
  v_cvt_pk_bf16_f32 v191, v222, v223
  s_nop 1
  s_setpc_b64 s[76:77]
k2_resc1:
  v_sub_f32 v200, v200, v16
  v_sub_f32 v201, v201, v16
  v_sub_f32 v202, v202, v16
  v_sub_f32 v203, v203, v16
  v_exp_f32 v18, -v16
  v_sub_f32 v204, v204, v17
  v_sub_f32 v205, v205, v17
  v_sub_f32 v206, v206, v17
  v_sub_f32 v207, v207, v17
  v_exp_f32 v19, -v17
  s_nop 0
  v_mul_f32 v230, v230, v18
  v_mul_f32 v231, v231, v19
  v_accvgpr_read_b32 v20, a64
  v_accvgpr_read_b32 v21, a65
  v_accvgpr_read_b32 v22, a66
  v_accvgpr_read_b32 v23, a67
  v_mul_f32 v20, v20, v18
  v_mul_f32 v21, v21, v18
  v_mul_f32 v22, v22, v18
  v_mul_f32 v23, v23, v18
  v_accvgpr_write_b32 a64, v20
  v_accvgpr_write_b32 a65, v21
  v_accvgpr_write_b32 a66, v22
  v_accvgpr_write_b32 a67, v23
  v_accvgpr_read_b32 v20, a68
  v_accvgpr_read_b32 v21, a69
  v_accvgpr_read_b32 v22, a70
  v_accvgpr_read_b32 v23, a71
  v_mul_f32 v20, v20, v19
  v_mul_f32 v21, v21, v19
  v_mul_f32 v22, v22, v19
  v_mul_f32 v23, v23, v19
  v_accvgpr_write_b32 a68, v20
  v_accvgpr_write_b32 a69, v21
  v_accvgpr_write_b32 a70, v22
  v_accvgpr_write_b32 a71, v23
  v_accvgpr_read_b32 v20, a72
  v_accvgpr_read_b32 v21, a73
  v_accvgpr_read_b32 v22, a74
  v_accvgpr_read_b32 v23, a75
  v_mul_f32 v20, v20, v18
  v_mul_f32 v21, v21, v18
  v_mul_f32 v22, v22, v18
  v_mul_f32 v23, v23, v18
  v_accvgpr_write_b32 a72, v20
  v_accvgpr_write_b32 a73, v21
  v_accvgpr_write_b32 a74, v22
  v_accvgpr_write_b32 a75, v23
  v_accvgpr_read_b32 v20, a76
  v_accvgpr_read_b32 v21, a77
  v_accvgpr_read_b32 v22, a78
  v_accvgpr_read_b32 v23, a79
  v_mul_f32 v20, v20, v19
  v_mul_f32 v21, v21, v19
  v_mul_f32 v22, v22, v19
  v_mul_f32 v23, v23, v19
  v_accvgpr_write_b32 a76, v20
  v_accvgpr_write_b32 a77, v21
  v_accvgpr_write_b32 a78, v22
  v_accvgpr_write_b32 a79, v23
  v_accvgpr_read_b32 v20, a80
  v_accvgpr_read_b32 v21, a81
  v_accvgpr_read_b32 v22, a82
  v_accvgpr_read_b32 v23, a83
  v_mul_f32 v20, v20, v18
  v_mul_f32 v21, v21, v18
  v_mul_f32 v22, v22, v18
  v_mul_f32 v23, v23, v18
  v_accvgpr_write_b32 a80, v20
  v_accvgpr_write_b32 a81, v21
  v_accvgpr_write_b32 a82, v22
  v_accvgpr_write_b32 a83, v23
  v_accvgpr_read_b32 v20, a84
  v_accvgpr_read_b32 v21, a85
  v_accvgpr_read_b32 v22, a86
  v_accvgpr_read_b32 v23, a87
  v_mul_f32 v20, v20, v19
  v_mul_f32 v21, v21, v19
  v_mul_f32 v22, v22, v19
  v_mul_f32 v23, v23, v19
  v_accvgpr_write_b32 a84, v20
  v_accvgpr_write_b32 a85, v21
  v_accvgpr_write_b32 a86, v22
  v_accvgpr_write_b32 a87, v23
  v_accvgpr_read_b32 v20, a88
  v_accvgpr_read_b32 v21, a89
  v_accvgpr_read_b32 v22, a90
  v_accvgpr_read_b32 v23, a91
  v_mul_f32 v20, v20, v18
  v_mul_f32 v21, v21, v18
  v_mul_f32 v22, v22, v18
  v_mul_f32 v23, v23, v18
  v_accvgpr_write_b32 a88, v20
  v_accvgpr_write_b32 a89, v21
  v_accvgpr_write_b32 a90, v22
  v_accvgpr_write_b32 a91, v23
  v_accvgpr_read_b32 v20, a92
  v_accvgpr_read_b32 v21, a93
  v_accvgpr_read_b32 v22, a94
  v_accvgpr_read_b32 v23, a95
  v_mul_f32 v20, v20, v19
  v_mul_f32 v21, v21, v19
  v_mul_f32 v22, v22, v19
  v_mul_f32 v23, v23, v19
  v_accvgpr_write_b32 a92, v20
  v_accvgpr_write_b32 a93, v21
  v_accvgpr_write_b32 a94, v22
  v_accvgpr_write_b32 a95, v23
  v_accvgpr_read_b32 v20, a96
  v_accvgpr_read_b32 v21, a97
  v_accvgpr_read_b32 v22, a98
  v_accvgpr_read_b32 v23, a99
  v_mul_f32 v20, v20, v18
  v_mul_f32 v21, v21, v18
  v_mul_f32 v22, v22, v18
  v_mul_f32 v23, v23, v18
  v_accvgpr_write_b32 a96, v20
  v_accvgpr_write_b32 a97, v21
  v_accvgpr_write_b32 a98, v22
  v_accvgpr_write_b32 a99, v23
  v_accvgpr_read_b32 v20, a100
  v_accvgpr_read_b32 v21, a101
  v_accvgpr_read_b32 v22, a102
  v_accvgpr_read_b32 v23, a103
  v_mul_f32 v20, v20, v19
  v_mul_f32 v21, v21, v19
  v_mul_f32 v22, v22, v19
  v_mul_f32 v23, v23, v19
  v_accvgpr_write_b32 a100, v20
  v_accvgpr_write_b32 a101, v21
  v_accvgpr_write_b32 a102, v22
  v_accvgpr_write_b32 a103, v23
  v_accvgpr_read_b32 v20, a104
  v_accvgpr_read_b32 v21, a105
  v_accvgpr_read_b32 v22, a106
  v_accvgpr_read_b32 v23, a107
  v_mul_f32 v20, v20, v18
  v_mul_f32 v21, v21, v18
  v_mul_f32 v22, v22, v18
  v_mul_f32 v23, v23, v18
  v_accvgpr_write_b32 a104, v20
  v_accvgpr_write_b32 a105, v21
  v_accvgpr_write_b32 a106, v22
  v_accvgpr_write_b32 a107, v23
  v_accvgpr_read_b32 v20, a108
  v_accvgpr_read_b32 v21, a109
  v_accvgpr_read_b32 v22, a110
  v_accvgpr_read_b32 v23, a111
  v_mul_f32 v20, v20, v19
  v_mul_f32 v21, v21, v19
  v_mul_f32 v22, v22, v19
  v_mul_f32 v23, v23, v19
  v_accvgpr_write_b32 a108, v20
  v_accvgpr_write_b32 a109, v21
  v_accvgpr_write_b32 a110, v22
  v_accvgpr_write_b32 a111, v23
  v_accvgpr_read_b32 v20, a112
  v_accvgpr_read_b32 v21, a113
  v_accvgpr_read_b32 v22, a114
  v_accvgpr_read_b32 v23, a115
  v_mul_f32 v20, v20, v18
  v_mul_f32 v21, v21, v18
  v_mul_f32 v22, v22, v18
  v_mul_f32 v23, v23, v18
  v_accvgpr_write_b32 a112, v20
  v_accvgpr_write_b32 a113, v21
  v_accvgpr_write_b32 a114, v22
  v_accvgpr_write_b32 a115, v23
  v_accvgpr_read_b32 v20, a116
  v_accvgpr_read_b32 v21, a117
  v_accvgpr_read_b32 v22, a118
  v_accvgpr_read_b32 v23, a119
  v_mul_f32 v20, v20, v19
  v_mul_f32 v21, v21, v19
  v_mul_f32 v22, v22, v19
  v_mul_f32 v23, v23, v19
  v_accvgpr_write_b32 a116, v20
  v_accvgpr_write_b32 a117, v21
  v_accvgpr_write_b32 a118, v22
  v_accvgpr_write_b32 a119, v23
  v_accvgpr_read_b32 v20, a120
  v_accvgpr_read_b32 v21, a121
  v_accvgpr_read_b32 v22, a122
  v_accvgpr_read_b32 v23, a123
  v_mul_f32 v20, v20, v18
  v_mul_f32 v21, v21, v18
  v_mul_f32 v22, v22, v18
  v_mul_f32 v23, v23, v18
  v_accvgpr_write_b32 a120, v20
  v_accvgpr_write_b32 a121, v21
  v_accvgpr_write_b32 a122, v22
  v_accvgpr_write_b32 a123, v23
  v_accvgpr_read_b32 v20, a124
  v_accvgpr_read_b32 v21, a125
  v_accvgpr_read_b32 v22, a126
  v_accvgpr_read_b32 v23, a127
  v_mul_f32 v20, v20, v19
  v_mul_f32 v21, v21, v19
  v_mul_f32 v22, v22, v19
  v_mul_f32 v23, v23, v19
  v_accvgpr_write_b32 a124, v20
  v_accvgpr_write_b32 a125, v21
  v_accvgpr_write_b32 a126, v22
  v_accvgpr_write_b32 a127, v23
  s_setpc_b64 s[78:79]
.section .rodata,"a"
.p2align 6
.amdhsa_kernel k2_kernel
  .amdhsa_next_free_vgpr 512
  .amdhsa_next_free_sgpr 102
  .amdhsa_accum_offset 256
  .amdhsa_group_segment_fixed_size 0
  .amdhsa_kernarg_size 112
  .amdhsa_user_sgpr_count 2
  .amdhsa_user_sgpr_kernarg_segment_ptr 1
  .amdhsa_system_sgpr_workgroup_id_x 1
  .amdhsa_float_denorm_mode_32 3
.end_amdhsa_kernel
.text
.globl k3_kernel
.p2align 8
.type k3_kernel,@function
k3_kernel:
  s_cmp_ge_u32 s2, 256
  s_cbranch_scc1 k3_end
  s_load_dwordx2 s[4:5], s[0:1], 0
  s_load_dwordx2 s[6:7], s[0:1], 88
  s_load_dwordx2 s[16:17], s[0:1], 104
  v_lshrrev_b32 v4, 6, v0
  v_and_b32 v1, 63, v0
  v_readfirstlane_b32 s20, v4
  s_and_b32 s21, s2, 7
  s_lshl_b32 s21, s21, 2
  s_lshr_b32 s23, s2, 3
  s_and_b32 s23, s23, 3
  s_add_u32 s21, s21, s23
  s_lshr_b32 s22, s2, 5
  v_lshlrev_b32 v2, 4, v1
  s_lshl_b32 s48, s21, 19
  s_lshl_b32 s23, s20, 15
  s_add_u32 s48, s48, s23
  s_add_u32 s48, s48, 50331648
  s_add_u32 s49, s48, 131072
  s_add_u32 s50, s48, 262144
  s_add_u32 s51, s48, 393216
  s_lshl_b32 s23, s22, 2
  s_add_u32 s23, s23, s20
  s_mul_i32 s52, s23, 163840
  s_add_u32 s52, s52, 4194304
  s_add_u32 s53, s52, 4096
  s_add_u32 s54, s52, 8192
  s_add_u32 s55, s52, 12288
  s_add_u32 s56, s52, 16384
  s_waitcnt lgkmcnt(0)
  s_mov_b32 s32, s16
  s_mov_b32 s33, s17
  s_mov_b32 s34, 67108864
  s_mov_b32 s35, 0x20000
  s_mov_b32 s36, s16
  s_mov_b32 s37, s17
  s_mov_b32 s38, 67108864
  s_mov_b32 s39, 0x20000
  s_mov_b32 s40, s4
  s_mov_b32 s41, s5
  s_mov_b32 s42, 2621440
  s_mov_b32 s43, 0x20000
  s_mov_b32 s44, s6
  s_mov_b32 s45, s7
  s_mov_b32 s46, 2621440
  s_mov_b32 s47, 0x20000
  s_add_u32 s18, s16, 2629632
  s_addc_u32 s19, s17, 0
  s_load_dwordx16 s[64:79], s[18:19], 0
  buffer_load_dwordx4 v[100:103], v2, s[32:35], s52 offen offset:0
  buffer_load_dwordx4 v[104:107], v2, s[32:35], s52 offen offset:1024
  buffer_load_dwordx4 v[108:111], v2, s[32:35], s52 offen offset:2048
  buffer_load_dwordx4 v[112:115], v2, s[32:35], s52 offen offset:3072
  buffer_load_dwordx4 v[116:119], v2, s[32:35], s53 offen offset:0
  buffer_load_dwordx4 v[120:123], v2, s[32:35], s48 offen offset:0
  buffer_load_dwordx4 v[124:127], v2, s[32:35], s49 offen offset:0
  buffer_load_dwordx4 v[128:131], v2, s[32:35], s50 offen offset:0
  buffer_load_dwordx4 v[132:135], v2, s[32:35], s51 offen offset:0
  buffer_load_dwordx4 v[136:139], v2, s[32:35], s53 offen offset:1024
  buffer_load_dwordx4 v[140:143], v2, s[32:35], s53 offen offset:2048
  buffer_load_dwordx4 v[144:147], v2, s[32:35], s53 offen offset:3072
  buffer_load_dwordx4 v[148:151], v2, s[32:35], s54 offen offset:0
  buffer_load_dwordx4 v[152:155], v2, s[32:35], s54 offen offset:1024
  buffer_load_dwordx4 v[156:159], v2, s[32:35], s48 offen offset:1024
  buffer_load_dwordx4 v[160:163], v2, s[32:35], s49 offen offset:1024
  buffer_load_dwordx4 v[164:167], v2, s[32:35], s50 offen offset:1024
  buffer_load_dwordx4 v[168:171], v2, s[32:35], s51 offen offset:1024
  buffer_load_dwordx4 v[172:175], v2, s[32:35], s54 offen offset:2048
  buffer_load_dwordx4 v[176:179], v2, s[32:35], s54 offen offset:3072
  buffer_load_dwordx4 v[180:183], v2, s[32:35], s55 offen offset:0
  buffer_load_dwordx4 v[184:187], v2, s[32:35], s55 offen offset:1024
  buffer_load_dwordx4 v[188:191], v2, s[32:35], s55 offen offset:2048
  buffer_load_dwordx4 v[192:195], v2, s[32:35], s48 offen offset:2048
  buffer_load_dwordx4 v[196:199], v2, s[32:35], s49 offen offset:2048
  buffer_load_dwordx4 v[200:203], v2, s[32:35], s50 offen offset:2048
  buffer_load_dwordx4 v[204:207], v2, s[32:35], s51 offen offset:2048
  buffer_load_dwordx4 v[208:211], v2, s[32:35], s55 offen offset:3072
  buffer_load_dwordx4 v[212:215], v2, s[32:35], s56 offen offset:0
  buffer_load_dwordx4 v[216:219], v2, s[32:35], s56 offen offset:1024
  buffer_load_dwordx4 v[220:223], v2, s[32:35], s56 offen offset:2048
  buffer_load_dwordx4 v[224:227], v2, s[32:35], s56 offen offset:3072
  buffer_load_dwordx4 v[228:231], v2, s[32:35], s48 offen offset:3072
  buffer_load_dwordx4 v[232:235], v2, s[32:35], s49 offen offset:3072
  buffer_load_dwordx4 v[236:239], v2, s[32:35], s50 offen offset:3072
  buffer_load_dwordx4 v[240:243], v2, s[32:35], s51 offen offset:3072
  s_add_u32 s48, s48, 4096
  s_add_u32 s49, s49, 4096
  s_add_u32 s50, s50, 4096
  s_add_u32 s51, s51, 4096
  s_add_u32 s52, s52, 20480
  s_add_u32 s53, s53, 20480
  s_add_u32 s54, s54, 20480
  s_add_u32 s55, s55, 20480
  s_add_u32 s56, s56, 20480
  v_mov_b32 v8, 0
  v_mov_b32 v9, 0
  v_mov_b32 v10, 0
  v_mov_b32 v11, 0
  v_lshlrev_b32 v4, 4, v0
  v_add_u32 v4, 86016, v4
  v_mfma_f32_32x32x16_bf16 v[20:35], v[8:11], v[8:11], 0
  v_mfma_f32_32x32x16_bf16 v[36:51], v[8:11], v[8:11], 0
  v_mfma_f32_32x32x16_bf16 v[52:67], v[8:11], v[8:11], 0
  v_mfma_f32_32x32x16_bf16 v[68:83], v[8:11], v[8:11], 0
  v_mfma_f32_32x32x16_bf16 v[84:99], v[8:11], v[8:11], 0
  ds_write_b128 v4, v[8:11] offset:0
  ds_write_b128 v4, v[8:11] offset:4096
  ds_write_b128 v4, v[8:11] offset:8192
  ds_write_b128 v4, v[8:11] offset:12288
  ds_write_b128 v4, v[8:11] offset:16384
  ds_write_b128 v4, v[8:11] offset:20480
  s_lshl_b32 s25, s21, 6
  s_mul_i32 s26, s22, 160
  s_mul_i32 s27, s22, 2560
  v_add_u32 v4, 0, v0
  v_mul_u32_u24 v5, 6554, v4
  v_lshrrev_b32 v5, 16, v5
  v_mul_u32_u24 v6, 10, v5
  v_sub_u32 v6, v4, v6
  v_mul_u32_u24 v15, 336, v5
  v_lshl_add_u32 v15, v6, 5, v15
  v_add_u32 v5, s25, v5
  v_mul_u32_u24 v12, 1280, v5
  v_lshl_add_u32 v12, v6, 4, v12
  v_add_u32 v12, s26, v12
  v_lshrrev_b32 v7, 4, v5
  v_mul_u32_u24 v7, 20480, v7
  v_and_b32 v5, 15, v5
  v_lshl_add_u32 v7, v5, 4, v7
  v_lshl_add_u32 v244, v6, 8, v7
  v_add_u32 v4, 256, v0
  v_mul_u32_u24 v5, 6554, v4
  v_lshrrev_b32 v5, 16, v5
  v_mul_u32_u24 v6, 10, v5
  v_sub_u32 v6, v4, v6
  v_mul_u32_u24 v16, 336, v5
  v_lshl_add_u32 v16, v6, 5, v16
  v_add_u32 v5, s25, v5
  v_mul_u32_u24 v13, 1280, v5
  v_lshl_add_u32 v13, v6, 4, v13
  v_add_u32 v13, s26, v13
  v_lshrrev_b32 v7, 4, v5
  v_mul_u32_u24 v7, 20480, v7
  v_and_b32 v5, 15, v5
  v_lshl_add_u32 v7, v5, 4, v7
  v_lshl_add_u32 v245, v6, 8, v7
  v_add_u32 v4, 512, v0
  v_mul_u32_u24 v5, 6554, v4
  v_lshrrev_b32 v5, 16, v5
  v_mul_u32_u24 v6, 10, v5
  v_sub_u32 v6, v4, v6
  v_mul_u32_u24 v17, 336, v5
  v_lshl_add_u32 v17, v6, 5, v17
  v_add_u32 v5, s25, v5
  v_mul_u32_u24 v14, 1280, v5
  v_lshl_add_u32 v14, v6, 4, v14
  v_add_u32 v14, s26, v14
  v_lshrrev_b32 v7, 4, v5
  v_mul_u32_u24 v7, 20480, v7
  v_and_b32 v5, 15, v5
  v_lshl_add_u32 v7, v5, 4, v7
  v_lshl_add_u32 v246, v6, 8, v7
  v_cmp_gt_u32 vcc, 128, v0
  v_mov_b32 v4, 0x40000000
  v_mov_b32 v5, 0
  v_cndmask_b32 v14, v4, v14, vcc
  v_cndmask_b32 v246, v4, v246, vcc
  v_cndmask_b32 v17, v5, v17, vcc
  s_waitcnt lgkmcnt(0)
  s_barrier
  s_mov_b32 s28, s64
  s_mov_b32 s30, s72
  s_cmp_eq_u32 s20, 1
  s_cselect_b32 s28, s66, s28
  s_cselect_b32 s30, s74, s30
  s_cmp_eq_u32 s20, 2
  s_cselect_b32 s28, s68, s28
  s_cselect_b32 s30, s76, s30
  s_cmp_eq_u32 s20, 3
  s_cselect_b32 s28, s70, s28
  s_cselect_b32 s30, s78, s30
  s_mov_b32 s29, s65
  s_mov_b32 s31, s73
  s_cmp_eq_u32 s20, 1
  s_cselect_b32 s29, s67, s29
  s_cselect_b32 s31, s75, s31
  s_cmp_eq_u32 s20, 2
  s_cselect_b32 s29, s69, s29
  s_cselect_b32 s31, s77, s31
  s_cmp_eq_u32 s20, 3
  s_cselect_b32 s29, s71, s29
  s_cselect_b32 s31, s79, s31
  s_sub_u32 s23, s28, s25
  s_cmp_ge_u32 s23, 64
  s_cbranch_scc1 k3_nosel0
  v_mul_u32_u24 v4, 3277, v1
  v_lshrrev_b32 v4, 16, v4
  v_mul_u32_u24 v5, 20, v4
  v_sub_u32 v5, v1, v5
  v_lshlrev_b32 v5, 4, v5
  v_mul_u32_u24 v6, 368640, v4
  v_add_u32 v6, v6, v5
  v_cmp_gt_u32 vcc, 3, v4
  v_mov_b32 v7, 0x40000000
  s_lshl_b32 s58, s20, 1
  v_cndmask_b32 v6, v7, v6, vcc
  s_add_u32 s58, s58, 0
  s_mul_i32 s58, s58, 2560
  s_mul_i32 s59, s22, 320
  s_add_u32 s58, s58, s59
  s_add_u32 s58, s58, 2686976
  s_mov_b32 s59, 9
  v_mov_b32 v8, 0
  v_mov_b32 v9, 0
  v_mov_b32 v10, 0
  v_mov_b32 v11, 0
k3_yl0:
  buffer_load_dwordx4 v[248:251], v6, s[36:39], s58 offen
  s_add_u32 s58, s58, 20480
  buffer_load_dwordx4 v[252:255], v6, s[36:39], s58 offen
  s_add_u32 s58, s58, 20480
  s_waitcnt vmcnt(0)
  v_add_f32 v8, v8, v248
  v_add_f32 v9, v9, v249
  v_add_f32 v10, v10, v250
  v_add_f32 v11, v11, v251
  v_add_f32 v8, v8, v252
  v_add_f32 v9, v9, v253
  v_add_f32 v10, v10, v254
  v_add_f32 v11, v11, v255
  s_sub_u32 s59, s59, 1
  s_cmp_lg_u32 s59, 0
  s_cbranch_scc1 k3_yl0
  s_lshl_b32 s58, s20, 10
  s_add_u32 s58, s58, 107520
  v_add_u32 v7, s58, v2
  ds_write_b128 v7, v[8:11]
  v_add_u32 v7, s58, v5
  s_waitcnt lgkmcnt(0)
  ds_read_b128 v[8:11], v7
  ds_read_b128 v[248:251], v7 offset:320
  ds_read_b128 v[252:255], v7 offset:640
  s_mul_i32 s23, s23, 336
  s_add_u32 s23, s23, 86016
  v_add_u32 v7, s23, v5
  s_waitcnt lgkmcnt(0)
  v_add_f32 v8, v8, v248
  v_add_f32 v8, v8, v252
  v_cvt_pk_bf16_f32 v8, v8, v8
  v_and_b32 v8, 0xffff0000, v8
  v_mul_f32 v8, s30, v8
  v_cvt_pk_bf16_f32 v8, v8, v8
  v_and_b32 v8, 0xffff0000, v8
  v_add_f32 v9, v9, v249
  v_add_f32 v9, v9, v253
  v_cvt_pk_bf16_f32 v9, v9, v9
  v_and_b32 v9, 0xffff0000, v9
  v_mul_f32 v9, s30, v9
  v_cvt_pk_bf16_f32 v9, v9, v9
  v_and_b32 v9, 0xffff0000, v9
  v_add_f32 v10, v10, v250
  v_add_f32 v10, v10, v254
  v_cvt_pk_bf16_f32 v10, v10, v10
  v_and_b32 v10, 0xffff0000, v10
  v_mul_f32 v10, s30, v10
  v_cvt_pk_bf16_f32 v10, v10, v10
  v_and_b32 v10, 0xffff0000, v10
  v_add_f32 v11, v11, v251
  v_add_f32 v11, v11, v255
  v_cvt_pk_bf16_f32 v11, v11, v11
  v_and_b32 v11, 0xffff0000, v11
  v_mul_f32 v11, s30, v11
  v_cvt_pk_bf16_f32 v11, v11, v11
  v_and_b32 v11, 0xffff0000, v11
  ds_write_b128 v7, v[8:11]
  s_waitcnt lgkmcnt(0)
k3_nosel0:
  s_sub_u32 s23, s29, s25
  s_cmp_ge_u32 s23, 64
  s_cbranch_scc1 k3_nosel1
  v_mul_u32_u24 v4, 3277, v1
  v_lshrrev_b32 v4, 16, v4
  v_mul_u32_u24 v5, 20, v4
  v_sub_u32 v5, v1, v5
  v_lshlrev_b32 v5, 4, v5
  v_mul_u32_u24 v6, 368640, v4
  v_add_u32 v6, v6, v5
  v_cmp_gt_u32 vcc, 3, v4
  v_mov_b32 v7, 0x40000000
  s_lshl_b32 s58, s20, 1
  v_cndmask_b32 v6, v7, v6, vcc
  s_add_u32 s58, s58, 1
  s_mul_i32 s58, s58, 2560
  s_mul_i32 s59, s22, 320
  s_add_u32 s58, s58, s59
  s_add_u32 s58, s58, 2686976
  s_mov_b32 s59, 9
  v_mov_b32 v8, 0
  v_mov_b32 v9, 0
  v_mov_b32 v10, 0
  v_mov_b32 v11, 0
k3_yl1:
  buffer_load_dwordx4 v[248:251], v6, s[36:39], s58 offen
  s_add_u32 s58, s58, 20480
  buffer_load_dwordx4 v[252:255], v6, s[36:39], s58 offen
  s_add_u32 s58, s58, 20480
  s_waitcnt vmcnt(0)
  v_add_f32 v8, v8, v248
  v_add_f32 v9, v9, v249
  v_add_f32 v10, v10, v250
  v_add_f32 v11, v11, v251
  v_add_f32 v8, v8, v252
  v_add_f32 v9, v9, v253
  v_add_f32 v10, v10, v254
  v_add_f32 v11, v11, v255
  s_sub_u32 s59, s59, 1
  s_cmp_lg_u32 s59, 0
  s_cbranch_scc1 k3_yl1
  s_lshl_b32 s58, s20, 10
  s_add_u32 s58, s58, 107520
  v_add_u32 v7, s58, v2
  ds_write_b128 v7, v[8:11]
  v_add_u32 v7, s58, v5
  s_waitcnt lgkmcnt(0)
  ds_read_b128 v[8:11], v7
  ds_read_b128 v[248:251], v7 offset:320
  ds_read_b128 v[252:255], v7 offset:640
  s_mul_i32 s23, s23, 336
  s_add_u32 s23, s23, 86016
  v_add_u32 v7, s23, v5
  s_waitcnt lgkmcnt(0)
  v_add_f32 v8, v8, v248
  v_add_f32 v8, v8, v252
  v_cvt_pk_bf16_f32 v8, v8, v8
  v_and_b32 v8, 0xffff0000, v8
  v_mul_f32 v8, s31, v8
  v_cvt_pk_bf16_f32 v8, v8, v8
  v_and_b32 v8, 0xffff0000, v8
  v_add_f32 v9, v9, v249
  v_add_f32 v9, v9, v253
  v_cvt_pk_bf16_f32 v9, v9, v9
  v_and_b32 v9, 0xffff0000, v9
  v_mul_f32 v9, s31, v9
  v_cvt_pk_bf16_f32 v9, v9, v9
  v_and_b32 v9, 0xffff0000, v9
  v_add_f32 v10, v10, v250
  v_add_f32 v10, v10, v254
  v_cvt_pk_bf16_f32 v10, v10, v10
  v_and_b32 v10, 0xffff0000, v10
  v_mul_f32 v10, s31, v10
  v_cvt_pk_bf16_f32 v10, v10, v10
  v_and_b32 v10, 0xffff0000, v10
  v_add_f32 v11, v11, v251
  v_add_f32 v11, v11, v255
  v_cvt_pk_bf16_f32 v11, v11, v11
  v_and_b32 v11, 0xffff0000, v11
  v_mul_f32 v11, s31, v11
  v_cvt_pk_bf16_f32 v11, v11, v11
  v_and_b32 v11, 0xffff0000, v11
  ds_write_b128 v7, v[8:11]
  s_waitcnt lgkmcnt(0)
k3_nosel1:
  s_mov_b32 s24, 0
  s_waitcnt vmcnt(27)
.p2align 6
k3_loop:
  v_mfma_f32_16x16x32_bf16 v[20:23], v[100:103], v[120:123], v[20:23]
  v_mfma_f32_16x16x32_bf16 v[24:27], v[100:103], v[124:127], v[24:27]
  v_mfma_f32_16x16x32_bf16 v[28:31], v[100:103], v[128:131], v[28:31]
  v_mfma_f32_16x16x32_bf16 v[32:35], v[100:103], v[132:135], v[32:35]
  buffer_load_dwordx4 v[100:103], v2, s[32:35], s52 offen offset:0
  v_mfma_f32_16x16x32_bf16 v[36:39], v[104:107], v[120:123], v[36:39]
  v_mfma_f32_16x16x32_bf16 v[40:43], v[104:107], v[124:127], v[40:43]
  v_mfma_f32_16x16x32_bf16 v[44:47], v[104:107], v[128:131], v[44:47]
  v_mfma_f32_16x16x32_bf16 v[48:51], v[104:107], v[132:135], v[48:51]
  buffer_load_dwordx4 v[104:107], v2, s[32:35], s52 offen offset:1024
  v_mfma_f32_16x16x32_bf16 v[52:55], v[108:111], v[120:123], v[52:55]
  v_mfma_f32_16x16x32_bf16 v[56:59], v[108:111], v[124:127], v[56:59]
  v_mfma_f32_16x16x32_bf16 v[60:63], v[108:111], v[128:131], v[60:63]
  v_mfma_f32_16x16x32_bf16 v[64:67], v[108:111], v[132:135], v[64:67]
  buffer_load_dwordx4 v[108:111], v2, s[32:35], s52 offen offset:2048
  v_mfma_f32_16x16x32_bf16 v[68:71], v[112:115], v[120:123], v[68:71]
  v_mfma_f32_16x16x32_bf16 v[72:75], v[112:115], v[124:127], v[72:75]
  v_mfma_f32_16x16x32_bf16 v[76:79], v[112:115], v[128:131], v[76:79]
  v_mfma_f32_16x16x32_bf16 v[80:83], v[112:115], v[132:135], v[80:83]
  buffer_load_dwordx4 v[112:115], v2, s[32:35], s52 offen offset:3072
  v_mfma_f32_16x16x32_bf16 v[84:87], v[116:119], v[120:123], v[84:87]
  buffer_load_dwordx4 v[120:123], v2, s[32:35], s48 offen offset:0
  v_mfma_f32_16x16x32_bf16 v[88:91], v[116:119], v[124:127], v[88:91]
  buffer_load_dwordx4 v[124:127], v2, s[32:35], s49 offen offset:0
  v_mfma_f32_16x16x32_bf16 v[92:95], v[116:119], v[128:131], v[92:95]
  buffer_load_dwordx4 v[128:131], v2, s[32:35], s50 offen offset:0
  v_mfma_f32_16x16x32_bf16 v[96:99], v[116:119], v[132:135], v[96:99]
  buffer_load_dwordx4 v[116:119], v2, s[32:35], s53 offen offset:0
  buffer_load_dwordx4 v[132:135], v2, s[32:35], s51 offen offset:0
  s_waitcnt vmcnt(27)
  v_mfma_f32_16x16x32_bf16 v[20:23], v[136:139], v[156:159], v[20:23]
  v_mfma_f32_16x16x32_bf16 v[24:27], v[136:139], v[160:163], v[24:27]
  v_mfma_f32_16x16x32_bf16 v[28:31], v[136:139], v[164:167], v[28:31]
  v_mfma_f32_16x16x32_bf16 v[32:35], v[136:139], v[168:171], v[32:35]
  buffer_load_dwordx4 v[136:139], v2, s[32:35], s53 offen offset:1024
  v_mfma_f32_16x16x32_bf16 v[36:39], v[140:143], v[156:159], v[36:39]
  v_mfma_f32_16x16x32_bf16 v[40:43], v[140:143], v[160:163], v[40:43]
  v_mfma_f32_16x16x32_bf16 v[44:47], v[140:143], v[164:167], v[44:47]
  v_mfma_f32_16x16x32_bf16 v[48:51], v[140:143], v[168:171], v[48:51]
  buffer_load_dwordx4 v[140:143], v2, s[32:35], s53 offen offset:2048
  v_mfma_f32_16x16x32_bf16 v[52:55], v[144:147], v[156:159], v[52:55]
  v_mfma_f32_16x16x32_bf16 v[56:59], v[144:147], v[160:163], v[56:59]
  v_mfma_f32_16x16x32_bf16 v[60:63], v[144:147], v[164:167], v[60:63]
  v_mfma_f32_16x16x32_bf16 v[64:67], v[144:147], v[168:171], v[64:67]
  buffer_load_dwordx4 v[144:147], v2, s[32:35], s53 offen offset:3072
  v_mfma_f32_16x16x32_bf16 v[68:71], v[148:151], v[156:159], v[68:71]
  v_mfma_f32_16x16x32_bf16 v[72:75], v[148:151], v[160:163], v[72:75]
  v_mfma_f32_16x16x32_bf16 v[76:79], v[148:151], v[164:167], v[76:79]
  v_mfma_f32_16x16x32_bf16 v[80:83], v[148:151], v[168:171], v[80:83]
  buffer_load_dwordx4 v[148:151], v2, s[32:35], s54 offen offset:0
  v_mfma_f32_16x16x32_bf16 v[84:87], v[152:155], v[156:159], v[84:87]
  buffer_load_dwordx4 v[156:159], v2, s[32:35], s48 offen offset:1024
  v_mfma_f32_16x16x32_bf16 v[88:91], v[152:155], v[160:163], v[88:91]
  buffer_load_dwordx4 v[160:163], v2, s[32:35], s49 offen offset:1024
  v_mfma_f32_16x16x32_bf16 v[92:95], v[152:155], v[164:167], v[92:95]
  buffer_load_dwordx4 v[164:167], v2, s[32:35], s50 offen offset:1024
  v_mfma_f32_16x16x32_bf16 v[96:99], v[152:155], v[168:171], v[96:99]
  buffer_load_dwordx4 v[152:155], v2, s[32:35], s54 offen offset:1024
  buffer_load_dwordx4 v[168:171], v2, s[32:35], s51 offen offset:1024
  s_waitcnt vmcnt(27)
  v_mfma_f32_16x16x32_bf16 v[20:23], v[172:175], v[192:195], v[20:23]
  v_mfma_f32_16x16x32_bf16 v[24:27], v[172:175], v[196:199], v[24:27]
  v_mfma_f32_16x16x32_bf16 v[28:31], v[172:175], v[200:203], v[28:31]
  v_mfma_f32_16x16x32_bf16 v[32:35], v[172:175], v[204:207], v[32:35]
  buffer_load_dwordx4 v[172:175], v2, s[32:35], s54 offen offset:2048
  v_mfma_f32_16x16x32_bf16 v[36:39], v[176:179], v[192:195], v[36:39]
  v_mfma_f32_16x16x32_bf16 v[40:43], v[176:179], v[196:199], v[40:43]
  v_mfma_f32_16x16x32_bf16 v[44:47], v[176:179], v[200:203], v[44:47]
  v_mfma_f32_16x16x32_bf16 v[48:51], v[176:179], v[204:207], v[48:51]
  buffer_load_dwordx4 v[176:179], v2, s[32:35], s54 offen offset:3072
  v_mfma_f32_16x16x32_bf16 v[52:55], v[180:183], v[192:195], v[52:55]
  v_mfma_f32_16x16x32_bf16 v[56:59], v[180:183], v[196:199], v[56:59]
  v_mfma_f32_16x16x32_bf16 v[60:63], v[180:183], v[200:203], v[60:63]
  v_mfma_f32_16x16x32_bf16 v[64:67], v[180:183], v[204:207], v[64:67]
  buffer_load_dwordx4 v[180:183], v2, s[32:35], s55 offen offset:0
  v_mfma_f32_16x16x32_bf16 v[68:71], v[184:187], v[192:195], v[68:71]
  v_mfma_f32_16x16x32_bf16 v[72:75], v[184:187], v[196:199], v[72:75]
  v_mfma_f32_16x16x32_bf16 v[76:79], v[184:187], v[200:203], v[76:79]
  v_mfma_f32_16x16x32_bf16 v[80:83], v[184:187], v[204:207], v[80:83]
  buffer_load_dwordx4 v[184:187], v2, s[32:35], s55 offen offset:1024
  v_mfma_f32_16x16x32_bf16 v[84:87], v[188:191], v[192:195], v[84:87]
  buffer_load_dwordx4 v[192:195], v2, s[32:35], s48 offen offset:2048
  v_mfma_f32_16x16x32_bf16 v[88:91], v[188:191], v[196:199], v[88:91]
  buffer_load_dwordx4 v[196:199], v2, s[32:35], s49 offen offset:2048
  v_mfma_f32_16x16x32_bf16 v[92:95], v[188:191], v[200:203], v[92:95]
  buffer_load_dwordx4 v[200:203], v2, s[32:35], s50 offen offset:2048
  v_mfma_f32_16x16x32_bf16 v[96:99], v[188:191], v[204:207], v[96:99]
  buffer_load_dwordx4 v[188:191], v2, s[32:35], s55 offen offset:2048
  buffer_load_dwordx4 v[204:207], v2, s[32:35], s51 offen offset:2048
  s_waitcnt vmcnt(27)
  v_mfma_f32_16x16x32_bf16 v[20:23], v[208:211], v[228:231], v[20:23]
  v_mfma_f32_16x16x32_bf16 v[24:27], v[208:211], v[232:235], v[24:27]
  v_mfma_f32_16x16x32_bf16 v[28:31], v[208:211], v[236:239], v[28:31]
  v_mfma_f32_16x16x32_bf16 v[32:35], v[208:211], v[240:243], v[32:35]
  buffer_load_dwordx4 v[208:211], v2, s[32:35], s55 offen offset:3072
  v_mfma_f32_16x16x32_bf16 v[36:39], v[212:215], v[228:231], v[36:39]
  s_add_u32 s52, s52, 20480
  v_mfma_f32_16x16x32_bf16 v[40:43], v[212:215], v[232:235], v[40:43]
  s_add_u32 s53, s53, 20480
  v_mfma_f32_16x16x32_bf16 v[44:47], v[212:215], v[236:239], v[44:47]
  s_add_u32 s54, s54, 20480
  v_mfma_f32_16x16x32_bf16 v[48:51], v[212:215], v[240:243], v[48:51]
  s_add_u32 s55, s55, 20480
  buffer_load_dwordx4 v[212:215], v2, s[32:35], s56 offen offset:0
  v_mfma_f32_16x16x32_bf16 v[52:55], v[216:219], v[228:231], v[52:55]
  s_add_u32 s24, s24, 1
  v_mfma_f32_16x16x32_bf16 v[56:59], v[216:219], v[232:235], v[56:59]
  v_mfma_f32_16x16x32_bf16 v[60:63], v[216:219], v[236:239], v[60:63]
  v_mfma_f32_16x16x32_bf16 v[64:67], v[216:219], v[240:243], v[64:67]
  buffer_load_dwordx4 v[216:219], v2, s[32:35], s56 offen offset:1024
  v_mfma_f32_16x16x32_bf16 v[68:71], v[220:223], v[228:231], v[68:71]
  v_mfma_f32_16x16x32_bf16 v[72:75], v[220:223], v[232:235], v[72:75]
  v_mfma_f32_16x16x32_bf16 v[76:79], v[220:223], v[236:239], v[76:79]
  v_mfma_f32_16x16x32_bf16 v[80:83], v[220:223], v[240:243], v[80:83]
  buffer_load_dwordx4 v[220:223], v2, s[32:35], s56 offen offset:2048
  v_mfma_f32_16x16x32_bf16 v[84:87], v[224:227], v[228:231], v[84:87]
  buffer_load_dwordx4 v[228:231], v2, s[32:35], s48 offen offset:3072
  v_mfma_f32_16x16x32_bf16 v[88:91], v[224:227], v[232:235], v[88:91]
  buffer_load_dwordx4 v[232:235], v2, s[32:35], s49 offen offset:3072
  v_mfma_f32_16x16x32_bf16 v[92:95], v[224:227], v[236:239], v[92:95]
  buffer_load_dwordx4 v[236:239], v2, s[32:35], s50 offen offset:3072
  v_mfma_f32_16x16x32_bf16 v[96:99], v[224:227], v[240:243], v[96:99]
  buffer_load_dwordx4 v[224:227], v2, s[32:35], s56 offen offset:3072
  buffer_load_dwordx4 v[240:243], v2, s[32:35], s51 offen offset:3072
  s_add_u32 s48, s48, 4096
  s_add_u32 s49, s49, 4096
  s_add_u32 s50, s50, 4096
  s_add_u32 s51, s51, 4096
  s_add_u32 s56, s56, 20480
  s_cmp_ge_u32 s24, 7
  s_cselect_b32 s34, 0, s34
  s_cmp_lt_u32 s24, 8
  s_waitcnt vmcnt(27)
  s_cbranch_scc1 k3_loop
  s_waitcnt vmcnt(0)
  buffer_load_dwordx4 v[100:103], v12, s[40:43], 0 offen
  buffer_load_dwordx4 v[112:115], v244, s[36:39], s27 offen
  buffer_load_dwordx4 v[104:107], v13, s[40:43], 0 offen
  buffer_load_dwordx4 v[116:119], v245, s[36:39], s27 offen
  buffer_load_dwordx4 v[108:111], v14, s[40:43], 0 offen
  buffer_load_dwordx4 v[120:123], v246, s[36:39], s27 offen
  v_and_b32 v4, 15, v1
  v_mul_u32_u24 v4, 336, v4
  v_lshrrev_b32 v5, 4, v1
  v_lshl_add_u32 v4, v5, 4, v4
  s_mul_i32 s23, s20, 21504
  v_add_u32 v4, s23, v4
  ds_write_b128 v4, v[20:23] offset:0
  ds_write_b128 v4, v[24:27] offset:5376
  ds_write_b128 v4, v[28:31] offset:10752
  ds_write_b128 v4, v[32:35] offset:16128
  ds_write_b128 v4, v[36:39] offset:64
  ds_write_b128 v4, v[40:43] offset:5440
  ds_write_b128 v4, v[44:47] offset:10816
  ds_write_b128 v4, v[48:51] offset:16192
  ds_write_b128 v4, v[52:55] offset:128
  ds_write_b128 v4, v[56:59] offset:5504
  ds_write_b128 v4, v[60:63] offset:10880
  ds_write_b128 v4, v[64:67] offset:16256
  ds_write_b128 v4, v[68:71] offset:192
  ds_write_b128 v4, v[72:75] offset:5568
  ds_write_b128 v4, v[76:79] offset:10944
  ds_write_b128 v4, v[80:83] offset:16320
  ds_write_b128 v4, v[84:87] offset:256
  ds_write_b128 v4, v[88:91] offset:5632
  ds_write_b128 v4, v[92:95] offset:11008
  ds_write_b128 v4, v[96:99] offset:16384
  s_waitcnt lgkmcnt(0)
  s_barrier
  v_add_u32 v4, 64512, v15
  v_add_u32 v5, 64512, v16
  v_add_u32 v6, 64512, v17
  ds_read_b128 v[128:131], v15 offset:0
  ds_read_b128 v[132:135], v15 offset:16
  ds_read_b128 v[136:139], v15 offset:21504
  ds_read_b128 v[140:143], v15 offset:21520
  ds_read_b128 v[144:147], v15 offset:43008
  ds_read_b128 v[148:151], v15 offset:43024
  ds_read_b128 v[152:155], v4 offset:0
  ds_read_b128 v[156:159], v4 offset:16
  ds_read_b128 v[160:163], v4 offset:21504
  ds_read_b128 v[164:167], v4 offset:21520
  ds_read_b128 v[168:171], v16 offset:0
  ds_read_b128 v[172:175], v16 offset:16
  ds_read_b128 v[176:179], v16 offset:21504
  ds_read_b128 v[180:183], v16 offset:21520
  ds_read_b128 v[184:187], v16 offset:43008
  ds_read_b128 v[188:191], v16 offset:43024
  ds_read_b128 v[192:195], v5 offset:0
  ds_read_b128 v[196:199], v5 offset:16
  ds_read_b128 v[200:203], v5 offset:21504
  ds_read_b128 v[204:207], v5 offset:21520
  ds_read_b128 v[208:211], v17 offset:0
  ds_read_b128 v[212:215], v17 offset:16
  ds_read_b128 v[216:219], v17 offset:21504
  ds_read_b128 v[220:223], v17 offset:21520
  ds_read_b128 v[224:227], v17 offset:43008
  ds_read_b128 v[228:231], v17 offset:43024
  ds_read_b128 v[232:235], v6 offset:0
  ds_read_b128 v[236:239], v6 offset:16
  ds_read_b128 v[240:243], v6 offset:21504
  ds_read_b128 v[244:247], v6 offset:21520
  s_waitcnt vmcnt(4) lgkmcnt(15)
  s_waitcnt lgkmcnt(10)
  v_add_f32 v128, v128, v136
  v_add_f32 v144, v144, v152
  v_add_f32 v129, v129, v137
  v_add_f32 v145, v145, v153
  v_add_f32 v130, v130, v138
  v_add_f32 v146, v146, v154
  v_add_f32 v131, v131, v139
  v_add_f32 v147, v147, v155
  v_add_f32 v132, v132, v140
  v_add_f32 v148, v148, v156
  v_add_f32 v133, v133, v141
  v_add_f32 v149, v149, v157
  v_add_f32 v134, v134, v142
  v_add_f32 v150, v150, v158
  v_add_f32 v135, v135, v143
  v_add_f32 v151, v151, v159
  v_add_f32 v128, v128, v144
  v_add_f32 v129, v129, v145
  v_add_f32 v130, v130, v146
  v_add_f32 v131, v131, v147
  v_add_f32 v132, v132, v148
  v_add_f32 v133, v133, v149
  v_add_f32 v134, v134, v150
  v_add_f32 v135, v135, v151
  v_cvt_pk_bf16_f32 v136, v128, v129
  v_lshlrev_b32 v138, 16, v100
  v_and_b32 v139, 0xffff0000, v100
  v_and_b32 v137, 0xffff0000, v136
  v_lshlrev_b32 v136, 16, v136
  v_add_f32 v136, v136, v138
  v_add_f32 v137, v137, v139
  v_cvt_pk_bf16_f32 v136, v136, v137
  v_lshlrev_b32 v138, 16, v112
  v_and_b32 v139, 0xffff0000, v112
  v_add_f32 v138, v138, v160
  v_add_f32 v139, v139, v161
  v_cvt_pk_bf16_f32 v138, v138, v139
  v_and_b32 v137, 0xffff0000, v136
  v_lshlrev_b32 v136, 16, v136
  v_and_b32 v139, 0xffff0000, v138
  v_lshlrev_b32 v138, 16, v138
  v_add_f32 v136, v136, v138
  v_add_f32 v137, v137, v139
  v_cvt_pk_bf16_f32 v140, v136, v137
  v_cvt_pk_bf16_f32 v136, v130, v131
  v_lshlrev_b32 v138, 16, v101
  v_and_b32 v139, 0xffff0000, v101
  v_and_b32 v137, 0xffff0000, v136
  v_lshlrev_b32 v136, 16, v136
  v_add_f32 v136, v136, v138
  v_add_f32 v137, v137, v139
  v_cvt_pk_bf16_f32 v136, v136, v137
  v_lshlrev_b32 v138, 16, v113
  v_and_b32 v139, 0xffff0000, v113
  v_add_f32 v138, v138, v162
  v_add_f32 v139, v139, v163
  v_cvt_pk_bf16_f32 v138, v138, v139
  v_and_b32 v137, 0xffff0000, v136
  v_lshlrev_b32 v136, 16, v136
  v_and_b32 v139, 0xffff0000, v138
  v_lshlrev_b32 v138, 16, v138
  v_add_f32 v136, v136, v138
  v_add_f32 v137, v137, v139
  v_cvt_pk_bf16_f32 v141, v136, v137
  v_cvt_pk_bf16_f32 v136, v132, v133
  v_lshlrev_b32 v138, 16, v102
  v_and_b32 v139, 0xffff0000, v102
  v_and_b32 v137, 0xffff0000, v136
  v_lshlrev_b32 v136, 16, v136
  v_add_f32 v136, v136, v138
  v_add_f32 v137, v137, v139
  v_cvt_pk_bf16_f32 v136, v136, v137
  v_lshlrev_b32 v138, 16, v114
  v_and_b32 v139, 0xffff0000, v114
  v_add_f32 v138, v138, v164
  v_add_f32 v139, v139, v165
  v_cvt_pk_bf16_f32 v138, v138, v139
  v_and_b32 v137, 0xffff0000, v136
  v_lshlrev_b32 v136, 16, v136
  v_and_b32 v139, 0xffff0000, v138
  v_lshlrev_b32 v138, 16, v138
  v_add_f32 v136, v136, v138
  v_add_f32 v137, v137, v139
  v_cvt_pk_bf16_f32 v142, v136, v137
  v_cvt_pk_bf16_f32 v136, v134, v135
  v_lshlrev_b32 v138, 16, v103
  v_and_b32 v139, 0xffff0000, v103
  v_and_b32 v137, 0xffff0000, v136
  v_lshlrev_b32 v136, 16, v136
  v_add_f32 v136, v136, v138
  v_add_f32 v137, v137, v139
  v_cvt_pk_bf16_f32 v136, v136, v137
  v_lshlrev_b32 v138, 16, v115
  v_and_b32 v139, 0xffff0000, v115
  v_add_f32 v138, v138, v166
  v_add_f32 v139, v139, v167
  v_cvt_pk_bf16_f32 v138, v138, v139
  v_and_b32 v137, 0xffff0000, v136
  v_lshlrev_b32 v136, 16, v136
  v_and_b32 v139, 0xffff0000, v138
  v_lshlrev_b32 v138, 16, v138
  v_add_f32 v136, v136, v138
  v_add_f32 v137, v137, v139
  v_cvt_pk_bf16_f32 v143, v136, v137
  buffer_store_dwordx4 v[140:143], v12, s[44:47], 0 offen
  s_waitcnt vmcnt(3) lgkmcnt(10)
  v_add_f32 v168, v168, v176
  v_add_f32 v184, v184, v192
  v_add_f32 v169, v169, v177
  v_add_f32 v185, v185, v193
  v_add_f32 v170, v170, v178
  v_add_f32 v186, v186, v194
  v_add_f32 v171, v171, v179
  v_add_f32 v187, v187, v195
  v_add_f32 v172, v172, v180
  v_add_f32 v188, v188, v196
  v_add_f32 v173, v173, v181
  v_add_f32 v189, v189, v197
  v_add_f32 v174, v174, v182
  v_add_f32 v190, v190, v198
  v_add_f32 v175, v175, v183
  v_add_f32 v191, v191, v199
  v_add_f32 v168, v168, v184
  v_add_f32 v169, v169, v185
  v_add_f32 v170, v170, v186
  v_add_f32 v171, v171, v187
  v_add_f32 v172, v172, v188
  v_add_f32 v173, v173, v189
  v_add_f32 v174, v174, v190
  v_add_f32 v175, v175, v191
  v_cvt_pk_bf16_f32 v176, v168, v169
  v_lshlrev_b32 v178, 16, v104
  v_and_b32 v179, 0xffff0000, v104
  v_and_b32 v177, 0xffff0000, v176
  v_lshlrev_b32 v176, 16, v176
  v_add_f32 v176, v176, v178
  v_add_f32 v177, v177, v179
  v_cvt_pk_bf16_f32 v176, v176, v177
  v_lshlrev_b32 v178, 16, v116
  v_and_b32 v179, 0xffff0000, v116
  v_add_f32 v178, v178, v200
  v_add_f32 v179, v179, v201
  v_cvt_pk_bf16_f32 v178, v178, v179
  v_and_b32 v177, 0xffff0000, v176
  v_lshlrev_b32 v176, 16, v176
  v_and_b32 v179, 0xffff0000, v178
  v_lshlrev_b32 v178, 16, v178
  v_add_f32 v176, v176, v178
  v_add_f32 v177, v177, v179
  v_cvt_pk_bf16_f32 v180, v176, v177
  v_cvt_pk_bf16_f32 v176, v170, v171
  v_lshlrev_b32 v178, 16, v105
  v_and_b32 v179, 0xffff0000, v105
  v_and_b32 v177, 0xffff0000, v176
  v_lshlrev_b32 v176, 16, v176
  v_add_f32 v176, v176, v178
  v_add_f32 v177, v177, v179
  v_cvt_pk_bf16_f32 v176, v176, v177
  v_lshlrev_b32 v178, 16, v117
  v_and_b32 v179, 0xffff0000, v117
  v_add_f32 v178, v178, v202
  v_add_f32 v179, v179, v203
  v_cvt_pk_bf16_f32 v178, v178, v179
  v_and_b32 v177, 0xffff0000, v176
  v_lshlrev_b32 v176, 16, v176
  v_and_b32 v179, 0xffff0000, v178
  v_lshlrev_b32 v178, 16, v178
  v_add_f32 v176, v176, v178
  v_add_f32 v177, v177, v179
  v_cvt_pk_bf16_f32 v181, v176, v177
  v_cvt_pk_bf16_f32 v176, v172, v173
  v_lshlrev_b32 v178, 16, v106
  v_and_b32 v179, 0xffff0000, v106
  v_and_b32 v177, 0xffff0000, v176
  v_lshlrev_b32 v176, 16, v176
  v_add_f32 v176, v176, v178
  v_add_f32 v177, v177, v179
  v_cvt_pk_bf16_f32 v176, v176, v177
  v_lshlrev_b32 v178, 16, v118
  v_and_b32 v179, 0xffff0000, v118
  v_add_f32 v178, v178, v204
  v_add_f32 v179, v179, v205
  v_cvt_pk_bf16_f32 v178, v178, v179
  v_and_b32 v177, 0xffff0000, v176
  v_lshlrev_b32 v176, 16, v176
  v_and_b32 v179, 0xffff0000, v178
  v_lshlrev_b32 v178, 16, v178
  v_add_f32 v176, v176, v178
  v_add_f32 v177, v177, v179
  v_cvt_pk_bf16_f32 v182, v176, v177
  v_cvt_pk_bf16_f32 v176, v174, v175
  v_lshlrev_b32 v178, 16, v107
  v_and_b32 v179, 0xffff0000, v107
  v_and_b32 v177, 0xffff0000, v176
  v_lshlrev_b32 v176, 16, v176
  v_add_f32 v176, v176, v178
  v_add_f32 v177, v177, v179
  v_cvt_pk_bf16_f32 v176, v176, v177
  v_lshlrev_b32 v178, 16, v119
  v_and_b32 v179, 0xffff0000, v119
  v_add_f32 v178, v178, v206
  v_add_f32 v179, v179, v207
  v_cvt_pk_bf16_f32 v178, v178, v179
  v_and_b32 v177, 0xffff0000, v176
  v_lshlrev_b32 v176, 16, v176
  v_and_b32 v179, 0xffff0000, v178
  v_lshlrev_b32 v178, 16, v178
  v_add_f32 v176, v176, v178
  v_add_f32 v177, v177, v179
  v_cvt_pk_bf16_f32 v183, v176, v177
  buffer_store_dwordx4 v[180:183], v13, s[44:47], 0 offen
  s_waitcnt vmcnt(2) lgkmcnt(0)
  v_add_f32 v208, v208, v216
  v_add_f32 v224, v224, v232
  v_add_f32 v209, v209, v217
  v_add_f32 v225, v225, v233
  v_add_f32 v210, v210, v218
  v_add_f32 v226, v226, v234
  v_add_f32 v211, v211, v219
  v_add_f32 v227, v227, v235
  v_add_f32 v212, v212, v220
  v_add_f32 v228, v228, v236
  v_add_f32 v213, v213, v221
  v_add_f32 v229, v229, v237
  v_add_f32 v214, v214, v222
  v_add_f32 v230, v230, v238
  v_add_f32 v215, v215, v223
  v_add_f32 v231, v231, v239
  v_add_f32 v208, v208, v224
  v_add_f32 v209, v209, v225
  v_add_f32 v210, v210, v226
  v_add_f32 v211, v211, v227
  v_add_f32 v212, v212, v228
  v_add_f32 v213, v213, v229
  v_add_f32 v214, v214, v230
  v_add_f32 v215, v215, v231
  v_cvt_pk_bf16_f32 v216, v208, v209
  v_lshlrev_b32 v218, 16, v108
  v_and_b32 v219, 0xffff0000, v108
  v_and_b32 v217, 0xffff0000, v216
  v_lshlrev_b32 v216, 16, v216
  v_add_f32 v216, v216, v218
  v_add_f32 v217, v217, v219
  v_cvt_pk_bf16_f32 v216, v216, v217
  v_lshlrev_b32 v218, 16, v120
  v_and_b32 v219, 0xffff0000, v120
  v_add_f32 v218, v218, v240
  v_add_f32 v219, v219, v241
  v_cvt_pk_bf16_f32 v218, v218, v219
  v_and_b32 v217, 0xffff0000, v216
  v_lshlrev_b32 v216, 16, v216
  v_and_b32 v219, 0xffff0000, v218
  v_lshlrev_b32 v218, 16, v218
  v_add_f32 v216, v216, v218
  v_add_f32 v217, v217, v219
  v_cvt_pk_bf16_f32 v220, v216, v217
  v_cvt_pk_bf16_f32 v216, v210, v211
  v_lshlrev_b32 v218, 16, v109
  v_and_b32 v219, 0xffff0000, v109
  v_and_b32 v217, 0xffff0000, v216
  v_lshlrev_b32 v216, 16, v216
  v_add_f32 v216, v216, v218
  v_add_f32 v217, v217, v219
  v_cvt_pk_bf16_f32 v216, v216, v217
  v_lshlrev_b32 v218, 16, v121
  v_and_b32 v219, 0xffff0000, v121
  v_add_f32 v218, v218, v242
  v_add_f32 v219, v219, v243
  v_cvt_pk_bf16_f32 v218, v218, v219
  v_and_b32 v217, 0xffff0000, v216
  v_lshlrev_b32 v216, 16, v216
  v_and_b32 v219, 0xffff0000, v218
  v_lshlrev_b32 v218, 16, v218
  v_add_f32 v216, v216, v218
  v_add_f32 v217, v217, v219
  v_cvt_pk_bf16_f32 v221, v216, v217
  v_cvt_pk_bf16_f32 v216, v212, v213
  v_lshlrev_b32 v218, 16, v110
  v_and_b32 v219, 0xffff0000, v110
  v_and_b32 v217, 0xffff0000, v216
  v_lshlrev_b32 v216, 16, v216
  v_add_f32 v216, v216, v218
  v_add_f32 v217, v217, v219
  v_cvt_pk_bf16_f32 v216, v216, v217
  v_lshlrev_b32 v218, 16, v122
  v_and_b32 v219, 0xffff0000, v122
  v_add_f32 v218, v218, v244
  v_add_f32 v219, v219, v245
  v_cvt_pk_bf16_f32 v218, v218, v219
  v_and_b32 v217, 0xffff0000, v216
  v_lshlrev_b32 v216, 16, v216
  v_and_b32 v219, 0xffff0000, v218
  v_lshlrev_b32 v218, 16, v218
  v_add_f32 v216, v216, v218
  v_add_f32 v217, v217, v219
  v_cvt_pk_bf16_f32 v222, v216, v217
  v_cvt_pk_bf16_f32 v216, v214, v215
  v_lshlrev_b32 v218, 16, v111
  v_and_b32 v219, 0xffff0000, v111
  v_and_b32 v217, 0xffff0000, v216
  v_lshlrev_b32 v216, 16, v216
  v_add_f32 v216, v216, v218
  v_add_f32 v217, v217, v219
  v_cvt_pk_bf16_f32 v216, v216, v217
  v_lshlrev_b32 v218, 16, v123
  v_and_b32 v219, 0xffff0000, v123
  v_add_f32 v218, v218, v246
  v_add_f32 v219, v219, v247
  v_cvt_pk_bf16_f32 v218, v218, v219
  v_and_b32 v217, 0xffff0000, v216
  v_lshlrev_b32 v216, 16, v216
  v_and_b32 v219, 0xffff0000, v218
  v_lshlrev_b32 v218, 16, v218
  v_add_f32 v216, v216, v218
  v_add_f32 v217, v217, v219
  v_cvt_pk_bf16_f32 v223, v216, v217
  buffer_store_dwordx4 v[220:223], v14, s[44:47], 0 offen
k3_end:
  s_endpgm
.section .rodata,"a"
.p2align 6
.amdhsa_kernel k3_kernel
  .amdhsa_next_free_vgpr 256
  .amdhsa_next_free_sgpr 102
  .amdhsa_accum_offset 256
  .amdhsa_group_segment_fixed_size 0
  .amdhsa_kernarg_size 112
  .amdhsa_user_sgpr_count 2
  .amdhsa_user_sgpr_kernarg_segment_ptr 1
  .amdhsa_system_sgpr_workgroup_id_x 1
  .amdhsa_float_denorm_mode_32 3
.end_amdhsa_kernel
.text
```

```asm
; @launch kernel=fa_kernel grid=(256,1,1) block=(256,1,1) lds=163840
; @launch kernel=k3_kernel grid=(256,1,1) block=(256,1,1) lds=111616
.amdgcn_target "amdgcn-amd-amdhsa--gfx950"
.text
.globl fa_kernel
.p2align 8
.type fa_kernel,@function
fa_kernel:
  s_cmp_ge_u32 s2, 256
  s_cbranch_scc1 fa_end
  s_load_dwordx4 s[4:7], s[0:1], 0
  s_load_dwordx4 s[8:11], s[0:1], 24
  s_load_dwordx2 s[12:13], s[0:1], 40
  s_load_dwordx2 s[14:15], s[0:1], 56
  s_load_dwordx4 s[16:19], s[0:1], 96
  s_load_dwordx2 s[60:61], s[0:1], 16
  v_lshrrev_b32 v16, 6, v0
  v_and_b32 v1, 63, v0
  v_readfirstlane_b32 s20, v16
  s_and_b32 s21, s2, 7
  s_lshl_b32 s21, s21, 2
  s_lshr_b32 s23, s2, 3
  s_and_b32 s23, s23, 3
  s_add_u32 s21, s21, s23
  s_lshr_b32 s22, s2, 5
  v_lshlrev_b32 v2, 4, v1
  v_lshrrev_b32 v16, 2, v1
  v_lshrrev_b32 v17, 5, v1
  v_mul_u32_u24 v17, 3, v17
  v_and_b32 v18, 3, v1
  v_xor_b32 v17, v17, v18
  v_lshlrev_b32 v17, 4, v17
  v_lshl_add_u32 v224, v16, 10, v17
  s_lshl_b32 s23, s20, 16
  v_add_u32 v224, s23, v224
  v_add_u32 v225, 15360, v224
  v_add_u32 v226, 30720, v224
  v_add_u32 v227, 46080, v224
  v_and_b32 v16, 3, v16
  v_lshrrev_b32 v17, 4, v1
  v_lshlrev_b32 v17, 6, v17
  v_lshl_add_u32 v16, v16, 13, v17
  s_and_b32 s23, s20, 1
  s_lshl_b32 s23, s23, 17
  v_add_u32 v16, s23, v16
  v_lshl_add_u32 v8, v18, 4, v16
  v_xor_b32 v18, 2, v18
  v_lshl_add_u32 v10, v18, 4, v16
  v_add_u32 v9, 31744, v8
  v_add_u32 v11, 95232, v10
  v_add_u32 v10, 63488, v10
  s_waitcnt lgkmcnt(0)
  s_lshl_b32 s23, s22, 18
  s_add_u32 s62, s6, s23
  s_addc_u32 s63, s7, 0
  s_mov_b32 s32, s62
  s_mov_b32 s33, s63
  s_mov_b32 s34, 262144
  s_mov_b32 s35, 0x20000
  s_cmp_ge_u32 s20, 2
  s_cselect_b32 s62, s10, s8
  s_cselect_b32 s63, s11, s9
  s_lshl_b32 s23, s21, 8
  s_add_u32 s62, s62, s23
  s_addc_u32 s63, s63, 0
  s_mov_b32 s36, s62
  s_mov_b32 s37, s63
  s_mov_b32 s38, 0
  s_mov_b32 s39, 0x20000
  s_sub_u32 s38, 4194304, s23
  s_add_u32 s60, s60, s23
  s_addc_u32 s61, s61, 0
  s_lshl_b32 s24, s20, 12
  s_mov_b32 s26, 0
  s_mov_b32 s27, 0
  s_mov_b32 s25, 262144
  s_mov_b32 m0, s24
  s_nop 0
  buffer_load_dwordx4 v224, s[32:35], s26 offen offset:0 lds
  buffer_load_dwordx4 v225, s[32:35], s26 offen offset:1024 lds
  buffer_load_dwordx4 v226, s[32:35], s26 offen offset:2048 lds
  buffer_load_dwordx4 v227, s[32:35], s26 offen offset:3072 lds
  s_add_u32 m0, s24, 16384
  s_nop 0
  buffer_load_dwordx4 v8, s[36:39], s27 offen offset:0 lds
  buffer_load_dwordx4 v9, s[36:39], s27 offen offset:1024 lds
  buffer_load_dwordx4 v10, s[36:39], s27 offen offset:2048 lds
  buffer_load_dwordx4 v11, s[36:39], s27 offen offset:3072 lds
  s_add_u32 s26, s26, 64
  s_add_u32 s27, s27, s25
  s_add_u32 s24, s24, 32768
  s_and_b32 s24, s24, 0x1ffff
  s_mov_b32 s40, s18
  s_mov_b32 s41, s19
  s_mov_b32 s42, 67108864
  s_mov_b32 s43, 0x20000
  s_mov_b32 s44, s4
  s_mov_b32 s45, s5
  s_mov_b32 s46, 2621440
  s_mov_b32 s47, 0x20000
  s_mov_b32 s48, s14
  s_mov_b32 s49, s15
  s_mov_b32 s50, 1280
  s_mov_b32 s51, 0x20000
  s_mov_b32 s52, s12
  s_mov_b32 s53, s13
  s_mov_b32 s54, 5242880
  s_mov_b32 s55, 0x20000
  s_mov_b32 s56, s16
  s_mov_b32 s57, s17
  s_mov_b32 s58, 256
  s_mov_b32 s59, 0x20000
  v_and_b32 v208, 31, v1
  v_lshrrev_b32 v209, 5, v1
  s_lshl_b32 s23, s2, 2
  s_add_u32 s23, s23, s20
  s_lshl_b32 s23, s23, 1
  v_add_u32 v209, s23, v209
  v_lshlrev_b32 v212, 4, v208
  v_mul_u32_u24 v210, 1280, v209
  v_add_u32 v210, v210, v212
  v_cmp_gt_u32 s[64:65], 16, v208
  v_mov_b32 v211, 1073741824
  s_nop 0
  v_cndmask_b32 v211, v211, v210, s[64:65]
  buffer_load_dwordx4 v[160:163], v210, s[44:47], 0 offen
  buffer_load_dwordx4 v[164:167], v210, s[44:47], 0 offen offset:512
  buffer_load_dwordx4 v[168:171], v211, s[44:47], 0 offen offset:1024
  buffer_load_dwordx4 v[172:175], v212, s[48:51], 0 offen offset:0
  buffer_load_dwordx4 v[176:179], v212, s[48:51], 0 offen offset:512
  buffer_load_dwordx4 v[180:183], v212, s[48:51], 0 offen offset:1024
  s_mov_b32 m0, s24
  s_nop 0
  buffer_load_dwordx4 v224, s[32:35], s26 offen offset:0 lds
  buffer_load_dwordx4 v225, s[32:35], s26 offen offset:1024 lds
  buffer_load_dwordx4 v226, s[32:35], s26 offen offset:2048 lds
  buffer_load_dwordx4 v227, s[32:35], s26 offen offset:3072 lds
  s_add_u32 m0, s24, 16384
  s_nop 0
  buffer_load_dwordx4 v8, s[36:39], s27 offen offset:0 lds
  buffer_load_dwordx4 v9, s[36:39], s27 offen offset:1024 lds
  buffer_load_dwordx4 v10, s[36:39], s27 offen offset:2048 lds
  buffer_load_dwordx4 v11, s[36:39], s27 offen offset:3072 lds
  s_add_u32 s26, s26, 64
  s_add_u32 s27, s27, s25
  s_add_u32 s24, s24, 32768
  s_and_b32 s24, s24, 0x1ffff
  s_lshr_b32 s23, s2, 3
  s_and_b32 s23, s23, 3
  s_lshl_b32 s23, s23, 2
  s_add_u32 s23, s23, s20
  s_lshl_b32 s23, s23, 14
  v_lshlrev_b32 v16, 7, v1
  s_add_u32 s31, s23, 8192
  buffer_load_dword v230, v16, s[32:35], s23 offen
  buffer_load_dword v231, v16, s[32:35], s31 offen
  v_lshrrev_b32 v17, 1, v1
  v_lshlrev_b32 v17, 13, v17
  v_and_b32 v18, 1, v1
  v_lshl_add_u32 v17, v18, 7, v17
  s_lshl_b32 s23, s22, 1
  s_and_b32 s31, s20, 1
  s_add_u32 s23, s23, s31
  s_lshl_b32 s23, s23, 18
  buffer_load_dword v232, v17, s[36:39], s23 offen
  s_lshl_b32 s23, s20, 5
  s_add_u32 s23, s23, s21
  s_lshl_b32 s23, s23, 2
  s_add_u32 s23, s23, 2641920
  s_lshl_b32 s31, s22, 9
  s_add_u32 s66, s23, s31
  s_sub_u32 s31, 7680, s31
  s_add_u32 s67, s23, s31
  s_lshl_b32 s23, s21, 7
  s_lshl_b32 s31, s22, 2
  s_add_u32 s23, s23, s31
  s_add_u32 s82, s23, 2637824
  s_and_b32 s23, s2, 63
  s_lshl_b32 s23, s23, 2
  s_add_u32 s23, s23, 2650112
  s_cmp_ge_u32 s2, 192
  s_cselect_b32 s23, s23, 1073741824
  s_cmp_eq_u32 s2, 255
  s_cselect_b32 s31, 2650368, 1073741824
  s_cmp_eq_u32 s20, 1
  s_cselect_b32 s31, s23, s31
  s_cmp_eq_u32 s20, 0
  s_cselect_b32 s31, s82, s31
  v_mov_b32 v16, 1073741824
  v_mov_b32 v229, 0
  v_writelane_b32 v16, s66, 0
  v_writelane_b32 v16, s67, 1
  v_writelane_b32 v16, s31, 2
  buffer_store_dword v229, v16, s[40:43], 0 offen sc1
  s_mov_b32 s80, s66
  s_mov_b32 s3, s67
  v_mov_b32 v20, 0
  v_mov_b32 v21, 0
  v_mov_b32 v22, 0
  v_mov_b32 v23, 0
  v_and_b32 v16, 15, v1
  v_lshrrev_b32 v17, 4, v1
  v_lshrrev_b32 v18, 3, v16
  v_mul_u32_u24 v18, 3, v18
  v_xor_b32 v18, v18, v17
  v_lshlrev_b32 v18, 4, v18
  v_lshl_add_u32 v14, v16, 6, v18
  s_and_b32 s23, s20, 1
  s_lshl_b32 s23, s23, 13
  v_add_u32 v14, s23, v14
  v_mfma_f32_32x32x16_bf16 a[0:15], v[20:23], v[20:23], 0
  v_mfma_f32_32x32x16_bf16 a[16:31], v[20:23], v[20:23], 0
  v_mfma_f32_32x32x16_bf16 a[32:47], v[20:23], v[20:23], 0
  v_mfma_f32_32x32x16_bf16 a[48:63], v[20:23], v[20:23], 0
  v_mfma_f32_32x32x16_bf16 a[64:79], v[20:23], v[20:23], 0
  v_mfma_f32_32x32x16_bf16 a[80:95], v[20:23], v[20:23], 0
  v_mfma_f32_32x32x16_bf16 a[96:111], v[20:23], v[20:23], 0
  v_mfma_f32_32x32x16_bf16 a[112:127], v[20:23], v[20:23], 0
  v_mfma_f32_32x32x16_bf16 a[128:143], v[20:23], v[20:23], 0
  v_mfma_f32_32x32x16_bf16 a[144:159], v[20:23], v[20:23], 0
  v_mfma_f32_32x32x16_bf16 a[160:175], v[20:23], v[20:23], 0
  v_mfma_f32_32x32x16_bf16 a[176:191], v[20:23], v[20:23], 0
  v_mfma_f32_32x32x16_bf16 a[192:207], v[20:23], v[20:23], 0
  v_mfma_f32_32x32x16_bf16 a[208:223], v[20:23], v[20:23], 0
  v_mfma_f32_32x32x16_bf16 a[224:239], v[20:23], v[20:23], 0
  v_mfma_f32_32x32x16_bf16 a[240:255], v[20:23], v[20:23], 0
  v_lshrrev_b32 v18, 2, v16
  v_lshlrev_b32 v18, 6, v18
  v_lshl_add_u32 v18, v17, 11, v18
  v_and_b32 v19, 1, v1
  v_lshl_add_u32 v18, v19, 3, v18
  v_bfe_u32 v19, v1, 1, 1
  v_and_b32 v17, 1, v17
  v_lshl_or_b32 v19, v17, 1, v19
  s_lshr_b32 s23, s20, 1
  s_lshl_b32 s23, s23, 13
  s_add_u32 s23, s23, 16384
  v_add_u32 v18, s23, v18
  v_lshl_add_u32 v12, v19, 4, v18
  v_xor_b32 v13, 32, v12
  s_waitcnt vmcnt(12)
  v_lshlrev_b32 v184, 16, v160
  v_and_b32 v185, 0xffff0000, v160
  v_lshlrev_b32 v186, 16, v161
  v_and_b32 v187, 0xffff0000, v161
  v_lshlrev_b32 v188, 16, v162
  v_and_b32 v189, 0xffff0000, v162
  v_lshlrev_b32 v190, 16, v163
  v_and_b32 v191, 0xffff0000, v163
  v_lshlrev_b32 v192, 16, v164
  v_and_b32 v193, 0xffff0000, v164
  v_lshlrev_b32 v194, 16, v165
  v_and_b32 v195, 0xffff0000, v165
  v_lshlrev_b32 v196, 16, v166
  v_and_b32 v197, 0xffff0000, v166
  v_lshlrev_b32 v198, 16, v167
  v_and_b32 v199, 0xffff0000, v167
  v_lshlrev_b32 v200, 16, v168
  v_and_b32 v201, 0xffff0000, v168
  v_lshlrev_b32 v202, 16, v169
  v_and_b32 v203, 0xffff0000, v169
  v_lshlrev_b32 v204, 16, v170
  v_and_b32 v205, 0xffff0000, v170
  v_lshlrev_b32 v206, 16, v171
  v_and_b32 v207, 0xffff0000, v171
  v_add_f32 v213, v184, v185
  v_add_f32 v214, v186, v187
  v_add_f32 v213, v213, v188
  v_add_f32 v214, v214, v189
  v_add_f32 v213, v213, v190
  v_add_f32 v214, v214, v191
  v_add_f32 v213, v213, v192
  v_add_f32 v214, v214, v193
  v_add_f32 v213, v213, v194
  v_add_f32 v214, v214, v195
  v_add_f32 v213, v213, v196
  v_add_f32 v214, v214, v197
  v_add_f32 v213, v213, v198
  v_add_f32 v214, v214, v199
  v_add_f32 v213, v213, v200
  v_add_f32 v214, v214, v201
  v_add_f32 v213, v213, v202
  v_add_f32 v214, v214, v203
  v_add_f32 v213, v213, v204
  v_add_f32 v214, v214, v205
  v_add_f32 v213, v213, v206
  v_add_f32 v214, v214, v207
  v_add_f32 v213, v213, v214
  s_nop 1
  v_add_f32_dpp v213, v213, v213 quad_perm:[1,0,3,2] row_mask:0xf bank_mask:0xf
  s_nop 1
  v_add_f32_dpp v213, v213, v213 quad_perm:[2,3,0,1] row_mask:0xf bank_mask:0xf
  s_nop 1
  v_add_f32_dpp v213, v213, v213 row_half_mirror row_mask:0xf bank_mask:0xf
  s_nop 1
  v_add_f32_dpp v213, v213, v213 row_mirror row_mask:0xf bank_mask:0xf
  v_mov_b32 v214, v213
  s_nop 1
  v_permlane16_swap_b32 v213, v214
  v_add_f32 v213, v213, v214
  v_mul_f32 v215, 0x3acccccd, v213
  v_mov_b32 v218, 0
  v_mov_b32 v213, 0
  v_sub_f32 v16, v184, v215
  v_fmac_f32 v218, v16, v16
  v_sub_f32 v17, v185, v215
  v_fmac_f32 v218, v17, v17
  v_sub_f32 v18, v186, v215
  v_fmac_f32 v218, v18, v18
  v_sub_f32 v19, v187, v215
  v_fmac_f32 v218, v19, v19
  v_sub_f32 v16, v188, v215
  v_fmac_f32 v218, v16, v16
  v_sub_f32 v17, v189, v215
  v_fmac_f32 v218, v17, v17
  v_sub_f32 v18, v190, v215
  v_fmac_f32 v218, v18, v18
  v_sub_f32 v19, v191, v215
  v_fmac_f32 v218, v19, v19
  v_sub_f32 v16, v192, v215
  v_fmac_f32 v218, v16, v16
  v_sub_f32 v17, v193, v215
  v_fmac_f32 v218, v17, v17
  v_sub_f32 v18, v194, v215
  v_fmac_f32 v218, v18, v18
  v_sub_f32 v19, v195, v215
  v_fmac_f32 v218, v19, v19
  v_sub_f32 v16, v196, v215
  v_fmac_f32 v218, v16, v16
  v_sub_f32 v17, v197, v215
  v_fmac_f32 v218, v17, v17
  v_sub_f32 v18, v198, v215
  v_fmac_f32 v218, v18, v18
  v_sub_f32 v19, v199, v215
  v_fmac_f32 v218, v19, v19
  v_sub_f32 v16, v200, v215
  v_fmac_f32 v213, v16, v16
  v_sub_f32 v17, v201, v215
  v_fmac_f32 v213, v17, v17
  v_sub_f32 v18, v202, v215
  v_fmac_f32 v213, v18, v18
  v_sub_f32 v19, v203, v215
  v_fmac_f32 v213, v19, v19
  v_sub_f32 v16, v204, v215
  v_fmac_f32 v213, v16, v16
  v_sub_f32 v17, v205, v215
  v_fmac_f32 v213, v17, v17
  v_sub_f32 v18, v206, v215
  v_fmac_f32 v213, v18, v18
  v_sub_f32 v19, v207, v215
  v_fmac_f32 v213, v19, v19
  v_cndmask_b32 v213, 0, v213, s[64:65]
  v_add_f32 v213, v213, v218
  s_nop 1
  v_add_f32_dpp v213, v213, v213 quad_perm:[1,0,3,2] row_mask:0xf bank_mask:0xf
  s_nop 1
  v_add_f32_dpp v213, v213, v213 quad_perm:[2,3,0,1] row_mask:0xf bank_mask:0xf
  s_nop 1
  v_add_f32_dpp v213, v213, v213 row_half_mirror row_mask:0xf bank_mask:0xf
  s_nop 1
  v_add_f32_dpp v213, v213, v213 row_mirror row_mask:0xf bank_mask:0xf
  v_mov_b32 v214, v213
  s_nop 1
  v_permlane16_swap_b32 v213, v214
  v_add_f32 v213, v213, v214
  v_mul_f32 v213, 0x3acccccd, v213
  v_cvt_pk_bf16_f32 v213, v213, v213
  v_and_b32 v213, 0xffff0000, v213
  v_add_f32 v213, 0x3727c5ac, v213
  v_cvt_pk_bf16_f32 v213, v213, v213
  v_and_b32 v213, 0xffff0000, v213
  v_sqrt_f32 v213, v213
  v_mov_b32 v216, v215
  v_cvt_pk_bf16_f32 v213, v213, v213
  v_and_b32 v213, 0xffff0000, v213
  v_rcp_f32 v217, v213
  v_cvt_pk_bf16_f32 v216, v216, v216
  v_and_b32 v216, 0xffff0000, v216
  v_mov_b32 v218, 0
  v_sub_f32 v184, v184, v216
  v_sub_f32 v185, v185, v216
  v_cvt_pk_bf16_f32 v16, v184, v185
  v_lshlrev_b32 v184, 16, v16
  v_and_b32 v185, 0xffff0000, v16
  v_mul_f32 v184, v184, v217
  v_mul_f32 v185, v185, v217
  v_cvt_pk_bf16_f32 v160, v184, v185
  v_lshlrev_b32 v184, 16, v160
  v_and_b32 v185, 0xffff0000, v160
  v_lshlrev_b32 v17, 16, v172
  v_and_b32 v18, 0xffff0000, v172
  v_fmac_f32 v218, v184, v17
  v_fmac_f32 v218, v185, v18
  v_sub_f32 v186, v186, v216
  v_sub_f32 v187, v187, v216
  v_cvt_pk_bf16_f32 v16, v186, v187
  v_lshlrev_b32 v186, 16, v16
  v_and_b32 v187, 0xffff0000, v16
  v_mul_f32 v186, v186, v217
  v_mul_f32 v187, v187, v217
  v_cvt_pk_bf16_f32 v161, v186, v187
  v_lshlrev_b32 v186, 16, v161
  v_and_b32 v187, 0xffff0000, v161
  v_lshlrev_b32 v17, 16, v173
  v_and_b32 v18, 0xffff0000, v173
  v_fmac_f32 v218, v186, v17
  v_fmac_f32 v218, v187, v18
  v_sub_f32 v188, v188, v216
  v_sub_f32 v189, v189, v216
  v_cvt_pk_bf16_f32 v16, v188, v189
  v_lshlrev_b32 v188, 16, v16
  v_and_b32 v189, 0xffff0000, v16
  v_mul_f32 v188, v188, v217
  v_mul_f32 v189, v189, v217
  v_cvt_pk_bf16_f32 v162, v188, v189
  v_lshlrev_b32 v188, 16, v162
  v_and_b32 v189, 0xffff0000, v162
  v_lshlrev_b32 v17, 16, v174
  v_and_b32 v18, 0xffff0000, v174
  v_fmac_f32 v218, v188, v17
  v_fmac_f32 v218, v189, v18
  v_sub_f32 v190, v190, v216
  v_sub_f32 v191, v191, v216
  v_cvt_pk_bf16_f32 v16, v190, v191
  v_lshlrev_b32 v190, 16, v16
  v_and_b32 v191, 0xffff0000, v16
  v_mul_f32 v190, v190, v217
  v_mul_f32 v191, v191, v217
  v_cvt_pk_bf16_f32 v163, v190, v191
  v_lshlrev_b32 v190, 16, v163
  v_and_b32 v191, 0xffff0000, v163
  v_lshlrev_b32 v17, 16, v175
  v_and_b32 v18, 0xffff0000, v175
  v_fmac_f32 v218, v190, v17
  v_fmac_f32 v218, v191, v18
  v_sub_f32 v192, v192, v216
  v_sub_f32 v193, v193, v216
  v_cvt_pk_bf16_f32 v16, v192, v193
  v_lshlrev_b32 v192, 16, v16
  v_and_b32 v193, 0xffff0000, v16
  v_mul_f32 v192, v192, v217
  v_mul_f32 v193, v193, v217
  v_cvt_pk_bf16_f32 v164, v192, v193
  v_lshlrev_b32 v192, 16, v164
  v_and_b32 v193, 0xffff0000, v164
  v_lshlrev_b32 v17, 16, v176
  v_and_b32 v18, 0xffff0000, v176
  v_fmac_f32 v218, v192, v17
  v_fmac_f32 v218, v193, v18
  v_sub_f32 v194, v194, v216
  v_sub_f32 v195, v195, v216
  v_cvt_pk_bf16_f32 v16, v194, v195
  v_lshlrev_b32 v194, 16, v16
  v_and_b32 v195, 0xffff0000, v16
  v_mul_f32 v194, v194, v217
  v_mul_f32 v195, v195, v217
  v_cvt_pk_bf16_f32 v165, v194, v195
  v_lshlrev_b32 v194, 16, v165
  v_and_b32 v195, 0xffff0000, v165
  v_lshlrev_b32 v17, 16, v177
  v_and_b32 v18, 0xffff0000, v177
  v_fmac_f32 v218, v194, v17
  v_fmac_f32 v218, v195, v18
  v_sub_f32 v196, v196, v216
  v_sub_f32 v197, v197, v216
  v_cvt_pk_bf16_f32 v16, v196, v197
  v_lshlrev_b32 v196, 16, v16
  v_and_b32 v197, 0xffff0000, v16
  v_mul_f32 v196, v196, v217
  v_mul_f32 v197, v197, v217
  v_cvt_pk_bf16_f32 v166, v196, v197
  v_lshlrev_b32 v196, 16, v166
  v_and_b32 v197, 0xffff0000, v166
  v_lshlrev_b32 v17, 16, v178
  v_and_b32 v18, 0xffff0000, v178
  v_fmac_f32 v218, v196, v17
  v_fmac_f32 v218, v197, v18
  v_sub_f32 v198, v198, v216
  v_sub_f32 v199, v199, v216
  v_cvt_pk_bf16_f32 v16, v198, v199
  v_lshlrev_b32 v198, 16, v16
  v_and_b32 v199, 0xffff0000, v16
  v_mul_f32 v198, v198, v217
  v_mul_f32 v199, v199, v217
  v_cvt_pk_bf16_f32 v167, v198, v199
  v_lshlrev_b32 v198, 16, v167
  v_and_b32 v199, 0xffff0000, v167
  v_lshlrev_b32 v17, 16, v179
  v_and_b32 v18, 0xffff0000, v179
  v_fmac_f32 v218, v198, v17
  v_fmac_f32 v218, v199, v18
  v_sub_f32 v200, v200, v216
  v_sub_f32 v201, v201, v216
  v_cvt_pk_bf16_f32 v16, v200, v201
  v_lshlrev_b32 v200, 16, v16
  v_and_b32 v201, 0xffff0000, v16
  v_mul_f32 v200, v200, v217
  v_mul_f32 v201, v201, v217
  v_cvt_pk_bf16_f32 v168, v200, v201
  v_lshlrev_b32 v200, 16, v168
  v_and_b32 v201, 0xffff0000, v168
  v_lshlrev_b32 v17, 16, v180
  v_and_b32 v18, 0xffff0000, v180
  v_fmac_f32 v218, v200, v17
  v_fmac_f32 v218, v201, v18
  v_sub_f32 v202, v202, v216
  v_sub_f32 v203, v203, v216
  v_cvt_pk_bf16_f32 v16, v202, v203
  v_lshlrev_b32 v202, 16, v16
  v_and_b32 v203, 0xffff0000, v16
  v_mul_f32 v202, v202, v217
  v_mul_f32 v203, v203, v217
  v_cvt_pk_bf16_f32 v169, v202, v203
  v_lshlrev_b32 v202, 16, v169
  v_and_b32 v203, 0xffff0000, v169
  v_lshlrev_b32 v17, 16, v181
  v_and_b32 v18, 0xffff0000, v181
  v_fmac_f32 v218, v202, v17
  v_fmac_f32 v218, v203, v18
  v_sub_f32 v204, v204, v216
  v_sub_f32 v205, v205, v216
  v_cvt_pk_bf16_f32 v16, v204, v205
  v_lshlrev_b32 v204, 16, v16
  v_and_b32 v205, 0xffff0000, v16
  v_mul_f32 v204, v204, v217
  v_mul_f32 v205, v205, v217
  v_cvt_pk_bf16_f32 v170, v204, v205
  v_lshlrev_b32 v204, 16, v170
  v_and_b32 v205, 0xffff0000, v170
  v_lshlrev_b32 v17, 16, v182
  v_and_b32 v18, 0xffff0000, v182
  v_fmac_f32 v218, v204, v17
  v_fmac_f32 v218, v205, v18
  v_sub_f32 v206, v206, v216
  v_sub_f32 v207, v207, v216
  v_cvt_pk_bf16_f32 v16, v206, v207
  v_lshlrev_b32 v206, 16, v16
  v_and_b32 v207, 0xffff0000, v16
  v_mul_f32 v206, v206, v217
  v_mul_f32 v207, v207, v217
  v_cvt_pk_bf16_f32 v171, v206, v207
  v_lshlrev_b32 v206, 16, v171
  v_and_b32 v207, 0xffff0000, v171
  v_lshlrev_b32 v17, 16, v183
  v_and_b32 v18, 0xffff0000, v183
  v_fmac_f32 v218, v206, v17
  v_fmac_f32 v218, v207, v18
  v_and_b32 v16, 7, v209
  v_lshlrev_b32 v16, 4, v16
  v_lshl_add_u32 v16, v208, 7, v16
  v_add_u32 v16, 151552, v16
  ds_write_b128 v16, v[160:163] offset:0
  ds_write_b128 v16, v[164:167] offset:4096
  ds_write_b128 v16, v[168:171] offset:8192
  s_nop 1
  v_add_f32_dpp v218, v218, v218 quad_perm:[1,0,3,2] row_mask:0xf bank_mask:0xf
  s_nop 1
  v_add_f32_dpp v218, v218, v218 quad_perm:[2,3,0,1] row_mask:0xf bank_mask:0xf
  s_nop 1
  v_add_f32_dpp v218, v218, v218 row_half_mirror row_mask:0xf bank_mask:0xf
  s_nop 1
  v_add_f32_dpp v218, v218, v218 row_mirror row_mask:0xf bank_mask:0xf
  v_mov_b32 v214, v218
  s_nop 1
  v_permlane16_swap_b32 v218, v214
  v_add_f32 v218, v218, v214
  v_cvt_pk_bf16_f32 v218, v218, v218
  v_and_b32 v218, 0xffff0000, v218
  v_ashrrev_i32 v214, 31, v218
  v_or_b32 v214, 0x80000000, v214
  v_xor_b32 v218, v218, v214
  v_and_b32 v218, 0xffff0000, v218
  v_sub_u32 v214, 0xffff, v209
  v_or_b32 v218, v218, v214
  v_lshlrev_b32 v214, 2, v209
  v_add_u32 v214, 2621440, v214
  v_mov_b32 v19, 1073741824
  v_cmp_eq_u32 vcc, 0, v208
  v_lshlrev_b32 v16, 4, v0
  v_add_u32 v16, 151552, v16
  v_cndmask_b32 v214, v19, v214, vcc
  buffer_store_dword v218, v214, s[40:43], 0 offen sc1
  v_lshrrev_b32 v17, 3, v0
  v_and_b32 v18, 7, v0
  v_lshlrev_b32 v18, 4, v18
  v_lshl_add_u32 v17, v17, 8, v18
  v_cmp_gt_u32 vcc, 128, v0
  s_lshr_b32 s23, s2, 1
  s_mul_i32 s23, s23, 20480
  s_and_b32 s31, s2, 1
  s_lshl_b32 s31, s31, 7
  s_add_u32 s23, s23, s31
  v_cndmask_b32 v18, v19, v17, vcc
  s_add_u32 s31, s23, 8192
  s_add_u32 s62, s23, 16384
  s_waitcnt lgkmcnt(0)
  s_barrier
  ds_read_b128 v[160:163], v16 offset:0
  ds_read_b128 v[164:167], v16 offset:4096
  ds_read_b128 v[168:171], v16 offset:8192
  s_mov_b32 s28, 0
  s_waitcnt lgkmcnt(0)
  buffer_store_dwordx4 v[160:163], v17, s[40:43], s23 offen sc1
  buffer_store_dwordx4 v[164:167], v17, s[40:43], s31 offen sc1
  buffer_store_dwordx4 v[168:171], v18, s[40:43], s62 offen sc1
  s_mov_b32 m0, s24
  s_nop 0
  buffer_load_dwordx4 v224, s[32:35], s26 offen offset:0 lds
  buffer_load_dwordx4 v225, s[32:35], s26 offen offset:1024 lds
  buffer_load_dwordx4 v226, s[32:35], s26 offen offset:2048 lds
  buffer_load_dwordx4 v227, s[32:35], s26 offen offset:3072 lds
  s_add_u32 m0, s24, 16384
  s_nop 0
  buffer_load_dwordx4 v8, s[36:39], s27 offen offset:0 lds
  buffer_load_dwordx4 v9, s[36:39], s27 offen offset:1024 lds
  buffer_load_dwordx4 v10, s[36:39], s27 offen offset:2048 lds
  buffer_load_dwordx4 v11, s[36:39], s27 offen offset:3072 lds
  s_add_u32 s26, s26, 64
  s_add_u32 s27, s27, s25
  s_add_u32 s24, s24, 32768
  s_and_b32 s24, s24, 0x1ffff
  s_mov_b32 m0, s24
  s_nop 0
  buffer_load_dwordx4 v224, s[32:35], s26 offen offset:0 lds
  buffer_load_dwordx4 v225, s[32:35], s26 offen offset:1024 lds
  buffer_load_dwordx4 v226, s[32:35], s26 offen offset:2048 lds
  buffer_load_dwordx4 v227, s[32:35], s26 offen offset:3072 lds
  s_add_u32 m0, s24, 16384
  s_nop 0
  buffer_load_dwordx4 v8, s[36:39], s27 offen offset:0 lds
  buffer_load_dwordx4 v9, s[36:39], s27 offen offset:1024 lds
  buffer_load_dwordx4 v10, s[36:39], s27 offen offset:2048 lds
  buffer_load_dwordx4 v11, s[36:39], s27 offen offset:3072 lds
  s_add_u32 s26, s26, 64
  s_add_u32 s27, s27, s25
  s_add_u32 s24, s24, 32768
  s_and_b32 s24, s24, 0x1ffff
  s_cmp_ge_u32 s20, 2
  s_cbranch_scc1 fa_roleV
  ds_read_b128 v[96:99], v14 offset:0
  ds_read_b128 v[100:103], v14 offset:1024
  ds_read_b128 v[104:107], v14 offset:2048
  ds_read_b128 v[108:111], v14 offset:3072
  ds_read_b128 v[112:115], v14 offset:4096
  ds_read_b128 v[116:119], v14 offset:5120
  ds_read_b128 v[120:123], v14 offset:6144
  ds_read_b128 v[124:127], v14 offset:7168
  ds_read_b64_tr_b16 v[32:33], v12 offset:0
  ds_read_b64_tr_b16 v[34:35], v12 offset:1024
  ds_read_b64_tr_b16 v[36:37], v13 offset:0
  ds_read_b64_tr_b16 v[38:39], v13 offset:1024
  ds_read_b64_tr_b16 v[40:41], v12 offset:256
  ds_read_b64_tr_b16 v[42:43], v12 offset:1280
  ds_read_b64_tr_b16 v[44:45], v13 offset:256
  ds_read_b64_tr_b16 v[46:47], v13 offset:1280
  ds_read_b64_tr_b16 v[48:49], v12 offset:512
  ds_read_b64_tr_b16 v[50:51], v12 offset:1536
  ds_read_b64_tr_b16 v[52:53], v13 offset:512
  ds_read_b64_tr_b16 v[54:55], v13 offset:1536
  ds_read_b64_tr_b16 v[56:57], v12 offset:768
  ds_read_b64_tr_b16 v[58:59], v12 offset:1792
  ds_read_b64_tr_b16 v[60:61], v13 offset:768
  ds_read_b64_tr_b16 v[62:63], v13 offset:1792
  s_cmp_eq_u32 0, 0
  s_waitcnt lgkmcnt(0)
.p2align 6
fa_loopK:
  v_mfma_f32_16x16x32_bf16 a[0:3], v[32:35], v[96:99], a[0:3]
  s_waitcnt vmcnt(16)
  v_mfma_f32_16x16x32_bf16 a[4:7], v[32:35], v[100:103], a[4:7]
  s_barrier
  v_mfma_f32_16x16x32_bf16 a[8:11], v[32:35], v[104:107], a[8:11]
  s_bitcmp1_b32 0x41, s28
  ds_read_b64_tr_b16 v[64:65], v12 offset:32768
  v_mfma_f32_16x16x32_bf16 a[12:15], v[32:35], v[108:111], a[12:15]
  s_cbranch_scc1 fa_p1stubK
fa_p1backK:
  v_mfma_f32_16x16x32_bf16 a[16:19], v[32:35], v[112:115], a[16:19]
  s_mov_b32 m0, s24
  ds_read_b64_tr_b16 v[66:67], v12 offset:33792
  v_mfma_f32_16x16x32_bf16 a[20:23], v[32:35], v[116:119], a[20:23]
  buffer_load_dwordx4 v224, s[32:35], s26 offen offset:0 lds
  v_mfma_f32_16x16x32_bf16 a[24:27], v[32:35], v[120:123], a[24:27]
  ds_read_b128 v[128:131], v14 offset:32768
  v_mfma_f32_16x16x32_bf16 a[28:31], v[32:35], v[124:127], a[28:31]
  v_mfma_f32_16x16x32_bf16 a[32:35], v[36:39], v[96:99], a[32:35]
  ds_read_b64_tr_b16 v[68:69], v13 offset:32768
  v_mfma_f32_16x16x32_bf16 a[36:39], v[36:39], v[100:103], a[36:39]
  v_mfma_f32_16x16x32_bf16 a[40:43], v[36:39], v[104:107], a[40:43]
  ds_read_b64_tr_b16 v[70:71], v13 offset:33792
  v_mfma_f32_16x16x32_bf16 a[44:47], v[36:39], v[108:111], a[44:47]
  buffer_load_dwordx4 v225, s[32:35], s26 offen offset:1024 lds
  v_mfma_f32_16x16x32_bf16 a[48:51], v[36:39], v[112:115], a[48:51]
  ds_read_b128 v[132:135], v14 offset:33792
  v_mfma_f32_16x16x32_bf16 a[52:55], v[36:39], v[116:119], a[52:55]
  v_mfma_f32_16x16x32_bf16 a[56:59], v[36:39], v[120:123], a[56:59]
  ds_read_b64_tr_b16 v[72:73], v12 offset:33024
  v_mfma_f32_16x16x32_bf16 a[60:63], v[36:39], v[124:127], a[60:63]
  v_mfma_f32_16x16x32_bf16 a[64:67], v[40:43], v[96:99], a[64:67]
  ds_read_b64_tr_b16 v[74:75], v12 offset:34048
  v_mfma_f32_16x16x32_bf16 a[68:71], v[40:43], v[100:103], a[68:71]
  buffer_load_dwordx4 v226, s[32:35], s26 offen offset:2048 lds
  v_mfma_f32_16x16x32_bf16 a[72:75], v[40:43], v[104:107], a[72:75]
  ds_read_b128 v[136:139], v14 offset:34816
  v_mfma_f32_16x16x32_bf16 a[76:79], v[40:43], v[108:111], a[76:79]
  v_mfma_f32_16x16x32_bf16 a[80:83], v[40:43], v[112:115], a[80:83]
  ds_read_b64_tr_b16 v[76:77], v13 offset:33024
  v_mfma_f32_16x16x32_bf16 a[84:87], v[40:43], v[116:119], a[84:87]
  v_mfma_f32_16x16x32_bf16 a[88:91], v[40:43], v[120:123], a[88:91]
  ds_read_b64_tr_b16 v[78:79], v13 offset:34048
  v_mfma_f32_16x16x32_bf16 a[92:95], v[40:43], v[124:127], a[92:95]
  buffer_load_dwordx4 v227, s[32:35], s26 offen offset:3072 lds
  v_mfma_f32_16x16x32_bf16 a[96:99], v[44:47], v[96:99], a[96:99]
  ds_read_b128 v[140:143], v14 offset:35840
  v_mfma_f32_16x16x32_bf16 a[100:103], v[44:47], v[100:103], a[100:103]
  v_mfma_f32_16x16x32_bf16 a[104:107], v[44:47], v[104:107], a[104:107]
  ds_read_b64_tr_b16 v[80:81], v12 offset:33280
  v_mfma_f32_16x16x32_bf16 a[108:111], v[44:47], v[108:111], a[108:111]
  v_mfma_f32_16x16x32_bf16 a[112:115], v[44:47], v[112:115], a[112:115]
  s_add_u32 m0, s24, 16384
  ds_read_b64_tr_b16 v[82:83], v12 offset:34304
  v_mfma_f32_16x16x32_bf16 a[116:119], v[44:47], v[116:119], a[116:119]
  buffer_load_dwordx4 v8, s[36:39], s27 offen offset:0 lds
  v_mfma_f32_16x16x32_bf16 a[120:123], v[44:47], v[120:123], a[120:123]
  ds_read_b128 v[144:147], v14 offset:36864
  v_mfma_f32_16x16x32_bf16 a[124:127], v[44:47], v[124:127], a[124:127]
  v_mfma_f32_16x16x32_bf16 a[128:131], v[48:51], v[96:99], a[128:131]
  ds_read_b64_tr_b16 v[84:85], v13 offset:33280
  v_mfma_f32_16x16x32_bf16 a[132:135], v[48:51], v[100:103], a[132:135]
  v_mfma_f32_16x16x32_bf16 a[136:139], v[48:51], v[104:107], a[136:139]
  ds_read_b64_tr_b16 v[86:87], v13 offset:34304
  v_mfma_f32_16x16x32_bf16 a[140:143], v[48:51], v[108:111], a[140:143]
  buffer_load_dwordx4 v9, s[36:39], s27 offen offset:1024 lds
  v_mfma_f32_16x16x32_bf16 a[144:147], v[48:51], v[112:115], a[144:147]
  ds_read_b128 v[148:151], v14 offset:37888
  v_mfma_f32_16x16x32_bf16 a[148:151], v[48:51], v[116:119], a[148:151]
  v_mfma_f32_16x16x32_bf16 a[152:155], v[48:51], v[120:123], a[152:155]
  ds_read_b64_tr_b16 v[88:89], v12 offset:33536
  v_mfma_f32_16x16x32_bf16 a[156:159], v[48:51], v[124:127], a[156:159]
  v_mfma_f32_16x16x32_bf16 a[160:163], v[52:55], v[96:99], a[160:163]
  ds_read_b64_tr_b16 v[90:91], v12 offset:34560
  v_mfma_f32_16x16x32_bf16 a[164:167], v[52:55], v[100:103], a[164:167]
  buffer_load_dwordx4 v10, s[36:39], s27 offen offset:2048 lds
  v_mfma_f32_16x16x32_bf16 a[168:171], v[52:55], v[104:107], a[168:171]
  ds_read_b128 v[152:155], v14 offset:38912
  v_mfma_f32_16x16x32_bf16 a[172:175], v[52:55], v[108:111], a[172:175]
  v_mfma_f32_16x16x32_bf16 a[176:179], v[52:55], v[112:115], a[176:179]
  ds_read_b64_tr_b16 v[92:93], v13 offset:33536
  v_mfma_f32_16x16x32_bf16 a[180:183], v[52:55], v[116:119], a[180:183]
  v_mfma_f32_16x16x32_bf16 a[184:187], v[52:55], v[120:123], a[184:187]
  ds_read_b64_tr_b16 v[94:95], v13 offset:34560
  v_mfma_f32_16x16x32_bf16 a[188:191], v[52:55], v[124:127], a[188:191]
  buffer_load_dwordx4 v11, s[36:39], s27 offen offset:3072 lds
  v_mfma_f32_16x16x32_bf16 a[192:195], v[56:59], v[96:99], a[192:195]
  s_add_u32 s26, s26, 64
  ds_read_b128 v[156:159], v14 offset:39936
  v_mfma_f32_16x16x32_bf16 a[196:199], v[56:59], v[100:103], a[196:199]
  s_add_u32 s27, s27, s25
  v_mfma_f32_16x16x32_bf16 a[200:203], v[56:59], v[104:107], a[200:203]
  s_add_u32 s24, s24, 32768
  v_mfma_f32_16x16x32_bf16 a[204:207], v[56:59], v[108:111], a[204:207]
  s_and_b32 s24, s24, 0x1ffff
  v_mfma_f32_16x16x32_bf16 a[208:211], v[56:59], v[112:115], a[208:211]
  v_xor_b32 v14, 0x10000, v14
  v_mfma_f32_16x16x32_bf16 a[212:215], v[56:59], v[116:119], a[212:215]
  v_xor_b32 v12, 0x10000, v12
  v_mfma_f32_16x16x32_bf16 a[216:219], v[56:59], v[120:123], a[216:219]
  v_xor_b32 v13, 0x10000, v13
  v_mfma_f32_16x16x32_bf16 a[220:223], v[56:59], v[124:127], a[220:223]
  v_mfma_f32_16x16x32_bf16 a[224:227], v[60:63], v[96:99], a[224:227]
  v_mfma_f32_16x16x32_bf16 a[228:231], v[60:63], v[100:103], a[228:231]
  v_mfma_f32_16x16x32_bf16 a[232:235], v[60:63], v[104:107], a[232:235]
  v_mfma_f32_16x16x32_bf16 a[236:239], v[60:63], v[108:111], a[236:239]
  v_mfma_f32_16x16x32_bf16 a[240:243], v[60:63], v[112:115], a[240:243]
  v_mfma_f32_16x16x32_bf16 a[244:247], v[60:63], v[116:119], a[244:247]
  v_mfma_f32_16x16x32_bf16 a[248:251], v[60:63], v[120:123], a[248:251]
  v_mfma_f32_16x16x32_bf16 a[252:255], v[60:63], v[124:127], a[252:255]
  s_waitcnt lgkmcnt(0)
  v_mfma_f32_16x16x32_bf16 a[0:3], v[64:67], v[128:131], a[0:3]
  s_waitcnt vmcnt(16)
  v_mfma_f32_16x16x32_bf16 a[4:7], v[64:67], v[132:135], a[4:7]
  s_barrier
  v_mfma_f32_16x16x32_bf16 a[8:11], v[64:67], v[136:139], a[8:11]
  ds_read_b64_tr_b16 v[32:33], v12 offset:0
  v_mfma_f32_16x16x32_bf16 a[12:15], v[64:67], v[140:143], a[12:15]
  v_mfma_f32_16x16x32_bf16 a[16:19], v[64:67], v[144:147], a[16:19]
  s_mov_b32 m0, s24
  ds_read_b64_tr_b16 v[34:35], v12 offset:1024
  v_mfma_f32_16x16x32_bf16 a[20:23], v[64:67], v[148:151], a[20:23]
  buffer_load_dwordx4 v224, s[32:35], s26 offen offset:0 lds
  v_mfma_f32_16x16x32_bf16 a[24:27], v[64:67], v[152:155], a[24:27]
  ds_read_b128 v[96:99], v14 offset:0
  v_mfma_f32_16x16x32_bf16 a[28:31], v[64:67], v[156:159], a[28:31]
  v_mfma_f32_16x16x32_bf16 a[32:35], v[68:71], v[128:131], a[32:35]
  ds_read_b64_tr_b16 v[36:37], v13 offset:0
  v_mfma_f32_16x16x32_bf16 a[36:39], v[68:71], v[132:135], a[36:39]
  v_mfma_f32_16x16x32_bf16 a[40:43], v[68:71], v[136:139], a[40:43]
  ds_read_b64_tr_b16 v[38:39], v13 offset:1024
  v_mfma_f32_16x16x32_bf16 a[44:47], v[68:71], v[140:143], a[44:47]
  buffer_load_dwordx4 v225, s[32:35], s26 offen offset:1024 lds
  v_mfma_f32_16x16x32_bf16 a[48:51], v[68:71], v[144:147], a[48:51]
  ds_read_b128 v[100:103], v14 offset:1024
  v_mfma_f32_16x16x32_bf16 a[52:55], v[68:71], v[148:151], a[52:55]
  v_mfma_f32_16x16x32_bf16 a[56:59], v[68:71], v[152:155], a[56:59]
  ds_read_b64_tr_b16 v[40:41], v12 offset:256
  v_mfma_f32_16x16x32_bf16 a[60:63], v[68:71], v[156:159], a[60:63]
  v_mfma_f32_16x16x32_bf16 a[64:67], v[72:75], v[128:131], a[64:67]
  ds_read_b64_tr_b16 v[42:43], v12 offset:1280
  v_mfma_f32_16x16x32_bf16 a[68:71], v[72:75], v[132:135], a[68:71]
  buffer_load_dwordx4 v226, s[32:35], s26 offen offset:2048 lds
  v_mfma_f32_16x16x32_bf16 a[72:75], v[72:75], v[136:139], a[72:75]
  ds_read_b128 v[104:107], v14 offset:2048
  v_mfma_f32_16x16x32_bf16 a[76:79], v[72:75], v[140:143], a[76:79]
  v_mfma_f32_16x16x32_bf16 a[80:83], v[72:75], v[144:147], a[80:83]
  ds_read_b64_tr_b16 v[44:45], v13 offset:256
  v_mfma_f32_16x16x32_bf16 a[84:87], v[72:75], v[148:151], a[84:87]
  v_mfma_f32_16x16x32_bf16 a[88:91], v[72:75], v[152:155], a[88:91]
  ds_read_b64_tr_b16 v[46:47], v13 offset:1280
  v_mfma_f32_16x16x32_bf16 a[92:95], v[72:75], v[156:159], a[92:95]
  buffer_load_dwordx4 v227, s[32:35], s26 offen offset:3072 lds
  v_mfma_f32_16x16x32_bf16 a[96:99], v[76:79], v[128:131], a[96:99]
  ds_read_b128 v[108:111], v14 offset:3072
  v_mfma_f32_16x16x32_bf16 a[100:103], v[76:79], v[132:135], a[100:103]
  v_mfma_f32_16x16x32_bf16 a[104:107], v[76:79], v[136:139], a[104:107]
  ds_read_b64_tr_b16 v[48:49], v12 offset:512
  v_mfma_f32_16x16x32_bf16 a[108:111], v[76:79], v[140:143], a[108:111]
  v_mfma_f32_16x16x32_bf16 a[112:115], v[76:79], v[144:147], a[112:115]
  s_add_u32 m0, s24, 16384
  ds_read_b64_tr_b16 v[50:51], v12 offset:1536
  v_mfma_f32_16x16x32_bf16 a[116:119], v[76:79], v[148:151], a[116:119]
  buffer_load_dwordx4 v8, s[36:39], s27 offen offset:0 lds
  v_mfma_f32_16x16x32_bf16 a[120:123], v[76:79], v[152:155], a[120:123]
  ds_read_b128 v[112:115], v14 offset:4096
  v_mfma_f32_16x16x32_bf16 a[124:127], v[76:79], v[156:159], a[124:127]
  v_mfma_f32_16x16x32_bf16 a[128:131], v[80:83], v[128:131], a[128:131]
  ds_read_b64_tr_b16 v[52:53], v13 offset:512
  v_mfma_f32_16x16x32_bf16 a[132:135], v[80:83], v[132:135], a[132:135]
  v_mfma_f32_16x16x32_bf16 a[136:139], v[80:83], v[136:139], a[136:139]
  ds_read_b64_tr_b16 v[54:55], v13 offset:1536
  v_mfma_f32_16x16x32_bf16 a[140:143], v[80:83], v[140:143], a[140:143]
  buffer_load_dwordx4 v9, s[36:39], s27 offen offset:1024 lds
  v_mfma_f32_16x16x32_bf16 a[144:147], v[80:83], v[144:147], a[144:147]
  ds_read_b128 v[116:119], v14 offset:5120
  v_mfma_f32_16x16x32_bf16 a[148:151], v[80:83], v[148:151], a[148:151]
  v_mfma_f32_16x16x32_bf16 a[152:155], v[80:83], v[152:155], a[152:155]
  ds_read_b64_tr_b16 v[56:57], v12 offset:768
  v_mfma_f32_16x16x32_bf16 a[156:159], v[80:83], v[156:159], a[156:159]
  v_mfma_f32_16x16x32_bf16 a[160:163], v[84:87], v[128:131], a[160:163]
  ds_read_b64_tr_b16 v[58:59], v12 offset:1792
  v_mfma_f32_16x16x32_bf16 a[164:167], v[84:87], v[132:135], a[164:167]
  buffer_load_dwordx4 v10, s[36:39], s27 offen offset:2048 lds
  v_mfma_f32_16x16x32_bf16 a[168:171], v[84:87], v[136:139], a[168:171]
  ds_read_b128 v[120:123], v14 offset:6144
  v_mfma_f32_16x16x32_bf16 a[172:175], v[84:87], v[140:143], a[172:175]
  v_mfma_f32_16x16x32_bf16 a[176:179], v[84:87], v[144:147], a[176:179]
  ds_read_b64_tr_b16 v[60:61], v13 offset:768
  v_mfma_f32_16x16x32_bf16 a[180:183], v[84:87], v[148:151], a[180:183]
  v_mfma_f32_16x16x32_bf16 a[184:187], v[84:87], v[152:155], a[184:187]
  ds_read_b64_tr_b16 v[62:63], v13 offset:1792
  v_mfma_f32_16x16x32_bf16 a[188:191], v[84:87], v[156:159], a[188:191]
  buffer_load_dwordx4 v11, s[36:39], s27 offen offset:3072 lds
  v_mfma_f32_16x16x32_bf16 a[192:195], v[88:91], v[128:131], a[192:195]
  s_add_u32 s26, s26, 64
  ds_read_b128 v[124:127], v14 offset:7168
  v_mfma_f32_16x16x32_bf16 a[196:199], v[88:91], v[132:135], a[196:199]
  s_add_u32 s27, s27, s25
  v_mfma_f32_16x16x32_bf16 a[200:203], v[88:91], v[136:139], a[200:203]
  s_add_u32 s24, s24, 32768
  v_mfma_f32_16x16x32_bf16 a[204:207], v[88:91], v[140:143], a[204:207]
  s_and_b32 s24, s24, 0x1ffff
  v_mfma_f32_16x16x32_bf16 a[208:211], v[88:91], v[144:147], a[208:211]
  v_mfma_f32_16x16x32_bf16 a[212:215], v[88:91], v[148:151], a[212:215]
  v_mfma_f32_16x16x32_bf16 a[216:219], v[88:91], v[152:155], a[216:219]
  s_add_u32 s28, s28, 1
  v_mfma_f32_16x16x32_bf16 a[220:223], v[88:91], v[156:159], a[220:223]
  v_mfma_f32_16x16x32_bf16 a[224:227], v[92:95], v[128:131], a[224:227]
  v_mfma_f32_16x16x32_bf16 a[228:231], v[92:95], v[132:135], a[228:231]
  v_mfma_f32_16x16x32_bf16 a[232:235], v[92:95], v[136:139], a[232:235]
  v_mfma_f32_16x16x32_bf16 a[236:239], v[92:95], v[140:143], a[236:239]
  v_mfma_f32_16x16x32_bf16 a[240:243], v[92:95], v[144:147], a[240:243]
  v_mfma_f32_16x16x32_bf16 a[244:247], v[92:95], v[148:151], a[244:247]
  s_cmp_lt_u32 s28, 8
  v_mfma_f32_16x16x32_bf16 a[248:251], v[92:95], v[152:155], a[248:251]
  s_waitcnt lgkmcnt(0)
  v_mfma_f32_16x16x32_bf16 a[252:255], v[92:95], v[156:159], a[252:255]
  s_cbranch_scc1 fa_loopK
  s_mov_b32 s70, 2048
  s_mov_b32 s71, 8192
  s_mov_b32 s72, 16777216
  s_branch fa_p1epi
fa_roleV:
  ds_read_b128 v[32:35], v14 offset:0
  ds_read_b128 v[36:39], v14 offset:1024
  ds_read_b128 v[40:43], v14 offset:2048
  ds_read_b128 v[44:47], v14 offset:3072
  ds_read_b128 v[48:51], v14 offset:4096
  ds_read_b128 v[52:55], v14 offset:5120
  ds_read_b128 v[56:59], v14 offset:6144
  ds_read_b128 v[60:63], v14 offset:7168
  ds_read_b64_tr_b16 v[96:97], v12 offset:0
  ds_read_b64_tr_b16 v[98:99], v12 offset:1024
  ds_read_b64_tr_b16 v[100:101], v13 offset:0
  ds_read_b64_tr_b16 v[102:103], v13 offset:1024
  ds_read_b64_tr_b16 v[104:105], v12 offset:256
  ds_read_b64_tr_b16 v[106:107], v12 offset:1280
  ds_read_b64_tr_b16 v[108:109], v13 offset:256
  ds_read_b64_tr_b16 v[110:111], v13 offset:1280
  ds_read_b64_tr_b16 v[112:113], v12 offset:512
  ds_read_b64_tr_b16 v[114:115], v12 offset:1536
  ds_read_b64_tr_b16 v[116:117], v13 offset:512
  ds_read_b64_tr_b16 v[118:119], v13 offset:1536
  ds_read_b64_tr_b16 v[120:121], v12 offset:768
  ds_read_b64_tr_b16 v[122:123], v12 offset:1792
  ds_read_b64_tr_b16 v[124:125], v13 offset:768
  ds_read_b64_tr_b16 v[126:127], v13 offset:1792
  s_cmp_eq_u32 0, 0
  s_waitcnt lgkmcnt(0)
.p2align 6
fa_loopV:
  v_mfma_f32_16x16x32_bf16 a[0:3], v[32:35], v[96:99], a[0:3]
  s_waitcnt vmcnt(16)
  v_mfma_f32_16x16x32_bf16 a[4:7], v[32:35], v[100:103], a[4:7]
  s_barrier
  v_mfma_f32_16x16x32_bf16 a[8:11], v[32:35], v[104:107], a[8:11]
  s_bitcmp1_b32 0x41, s28
  ds_read_b64_tr_b16 v[128:129], v12 offset:32768
  v_mfma_f32_16x16x32_bf16 a[12:15], v[32:35], v[108:111], a[12:15]
  s_cbranch_scc1 fa_p1stubV
fa_p1backV:
  v_mfma_f32_16x16x32_bf16 a[16:19], v[32:35], v[112:115], a[16:19]
  s_mov_b32 m0, s24
  ds_read_b64_tr_b16 v[130:131], v12 offset:33792
  v_mfma_f32_16x16x32_bf16 a[20:23], v[32:35], v[116:119], a[20:23]
  buffer_load_dwordx4 v224, s[32:35], s26 offen offset:0 lds
  v_mfma_f32_16x16x32_bf16 a[24:27], v[32:35], v[120:123], a[24:27]
  ds_read_b128 v[64:67], v14 offset:32768
  v_mfma_f32_16x16x32_bf16 a[28:31], v[32:35], v[124:127], a[28:31]
  v_mfma_f32_16x16x32_bf16 a[32:35], v[36:39], v[96:99], a[32:35]
  ds_read_b64_tr_b16 v[132:133], v13 offset:32768
  v_mfma_f32_16x16x32_bf16 a[36:39], v[36:39], v[100:103], a[36:39]
  v_mfma_f32_16x16x32_bf16 a[40:43], v[36:39], v[104:107], a[40:43]
  ds_read_b64_tr_b16 v[134:135], v13 offset:33792
  v_mfma_f32_16x16x32_bf16 a[44:47], v[36:39], v[108:111], a[44:47]
  buffer_load_dwordx4 v225, s[32:35], s26 offen offset:1024 lds
  v_mfma_f32_16x16x32_bf16 a[48:51], v[36:39], v[112:115], a[48:51]
  ds_read_b128 v[68:71], v14 offset:33792
  v_mfma_f32_16x16x32_bf16 a[52:55], v[36:39], v[116:119], a[52:55]
  v_mfma_f32_16x16x32_bf16 a[56:59], v[36:39], v[120:123], a[56:59]
  ds_read_b64_tr_b16 v[136:137], v12 offset:33024
  v_mfma_f32_16x16x32_bf16 a[60:63], v[36:39], v[124:127], a[60:63]
  v_mfma_f32_16x16x32_bf16 a[64:67], v[40:43], v[96:99], a[64:67]
  ds_read_b64_tr_b16 v[138:139], v12 offset:34048
  v_mfma_f32_16x16x32_bf16 a[68:71], v[40:43], v[100:103], a[68:71]
  buffer_load_dwordx4 v226, s[32:35], s26 offen offset:2048 lds
  v_mfma_f32_16x16x32_bf16 a[72:75], v[40:43], v[104:107], a[72:75]
  ds_read_b128 v[72:75], v14 offset:34816
  v_mfma_f32_16x16x32_bf16 a[76:79], v[40:43], v[108:111], a[76:79]
  v_mfma_f32_16x16x32_bf16 a[80:83], v[40:43], v[112:115], a[80:83]
  ds_read_b64_tr_b16 v[140:141], v13 offset:33024
  v_mfma_f32_16x16x32_bf16 a[84:87], v[40:43], v[116:119], a[84:87]
  v_mfma_f32_16x16x32_bf16 a[88:91], v[40:43], v[120:123], a[88:91]
  ds_read_b64_tr_b16 v[142:143], v13 offset:34048
  v_mfma_f32_16x16x32_bf16 a[92:95], v[40:43], v[124:127], a[92:95]
  buffer_load_dwordx4 v227, s[32:35], s26 offen offset:3072 lds
  v_mfma_f32_16x16x32_bf16 a[96:99], v[44:47], v[96:99], a[96:99]
  ds_read_b128 v[76:79], v14 offset:35840
  v_mfma_f32_16x16x32_bf16 a[100:103], v[44:47], v[100:103], a[100:103]
  v_mfma_f32_16x16x32_bf16 a[104:107], v[44:47], v[104:107], a[104:107]
  ds_read_b64_tr_b16 v[144:145], v12 offset:33280
  v_mfma_f32_16x16x32_bf16 a[108:111], v[44:47], v[108:111], a[108:111]
  v_mfma_f32_16x16x32_bf16 a[112:115], v[44:47], v[112:115], a[112:115]
  s_add_u32 m0, s24, 16384
  ds_read_b64_tr_b16 v[146:147], v12 offset:34304
  v_mfma_f32_16x16x32_bf16 a[116:119], v[44:47], v[116:119], a[116:119]
  buffer_load_dwordx4 v8, s[36:39], s27 offen offset:0 lds
  v_mfma_f32_16x16x32_bf16 a[120:123], v[44:47], v[120:123], a[120:123]
  ds_read_b128 v[80:83], v14 offset:36864
  v_mfma_f32_16x16x32_bf16 a[124:127], v[44:47], v[124:127], a[124:127]
  v_mfma_f32_16x16x32_bf16 a[128:131], v[48:51], v[96:99], a[128:131]
  ds_read_b64_tr_b16 v[148:149], v13 offset:33280
  v_mfma_f32_16x16x32_bf16 a[132:135], v[48:51], v[100:103], a[132:135]
  v_mfma_f32_16x16x32_bf16 a[136:139], v[48:51], v[104:107], a[136:139]
  ds_read_b64_tr_b16 v[150:151], v13 offset:34304
  v_mfma_f32_16x16x32_bf16 a[140:143], v[48:51], v[108:111], a[140:143]
  buffer_load_dwordx4 v9, s[36:39], s27 offen offset:1024 lds
  v_mfma_f32_16x16x32_bf16 a[144:147], v[48:51], v[112:115], a[144:147]
  ds_read_b128 v[84:87], v14 offset:37888
  v_mfma_f32_16x16x32_bf16 a[148:151], v[48:51], v[116:119], a[148:151]
  v_mfma_f32_16x16x32_bf16 a[152:155], v[48:51], v[120:123], a[152:155]
  ds_read_b64_tr_b16 v[152:153], v12 offset:33536
  v_mfma_f32_16x16x32_bf16 a[156:159], v[48:51], v[124:127], a[156:159]
  v_mfma_f32_16x16x32_bf16 a[160:163], v[52:55], v[96:99], a[160:163]
  ds_read_b64_tr_b16 v[154:155], v12 offset:34560
  v_mfma_f32_16x16x32_bf16 a[164:167], v[52:55], v[100:103], a[164:167]
  buffer_load_dwordx4 v10, s[36:39], s27 offen offset:2048 lds
  v_mfma_f32_16x16x32_bf16 a[168:171], v[52:55], v[104:107], a[168:171]
  ds_read_b128 v[88:91], v14 offset:38912
  v_mfma_f32_16x16x32_bf16 a[172:175], v[52:55], v[108:111], a[172:175]
  v_mfma_f32_16x16x32_bf16 a[176:179], v[52:55], v[112:115], a[176:179]
  ds_read_b64_tr_b16 v[156:157], v13 offset:33536
  v_mfma_f32_16x16x32_bf16 a[180:183], v[52:55], v[116:119], a[180:183]
  v_mfma_f32_16x16x32_bf16 a[184:187], v[52:55], v[120:123], a[184:187]
  ds_read_b64_tr_b16 v[158:159], v13 offset:34560
  v_mfma_f32_16x16x32_bf16 a[188:191], v[52:55], v[124:127], a[188:191]
  buffer_load_dwordx4 v11, s[36:39], s27 offen offset:3072 lds
  v_mfma_f32_16x16x32_bf16 a[192:195], v[56:59], v[96:99], a[192:195]
  s_add_u32 s26, s26, 64
  ds_read_b128 v[92:95], v14 offset:39936
  v_mfma_f32_16x16x32_bf16 a[196:199], v[56:59], v[100:103], a[196:199]
  s_add_u32 s27, s27, s25
  v_mfma_f32_16x16x32_bf16 a[200:203], v[56:59], v[104:107], a[200:203]
  s_add_u32 s24, s24, 32768
  v_mfma_f32_16x16x32_bf16 a[204:207], v[56:59], v[108:111], a[204:207]
  s_and_b32 s24, s24, 0x1ffff
  v_mfma_f32_16x16x32_bf16 a[208:211], v[56:59], v[112:115], a[208:211]
  v_xor_b32 v14, 0x10000, v14
  v_mfma_f32_16x16x32_bf16 a[212:215], v[56:59], v[116:119], a[212:215]
  v_xor_b32 v12, 0x10000, v12
  v_mfma_f32_16x16x32_bf16 a[216:219], v[56:59], v[120:123], a[216:219]
  v_xor_b32 v13, 0x10000, v13
  v_mfma_f32_16x16x32_bf16 a[220:223], v[56:59], v[124:127], a[220:223]
  v_mfma_f32_16x16x32_bf16 a[224:227], v[60:63], v[96:99], a[224:227]
  v_mfma_f32_16x16x32_bf16 a[228:231], v[60:63], v[100:103], a[228:231]
  v_mfma_f32_16x16x32_bf16 a[232:235], v[60:63], v[104:107], a[232:235]
  v_mfma_f32_16x16x32_bf16 a[236:239], v[60:63], v[108:111], a[236:239]
  v_mfma_f32_16x16x32_bf16 a[240:243], v[60:63], v[112:115], a[240:243]
  v_mfma_f32_16x16x32_bf16 a[244:247], v[60:63], v[116:119], a[244:247]
  v_mfma_f32_16x16x32_bf16 a[248:251], v[60:63], v[120:123], a[248:251]
  v_mfma_f32_16x16x32_bf16 a[252:255], v[60:63], v[124:127], a[252:255]
  s_waitcnt lgkmcnt(0)
  v_mfma_f32_16x16x32_bf16 a[0:3], v[64:67], v[128:131], a[0:3]
  s_waitcnt vmcnt(16)
  v_mfma_f32_16x16x32_bf16 a[4:7], v[64:67], v[132:135], a[4:7]
  s_barrier
  v_mfma_f32_16x16x32_bf16 a[8:11], v[64:67], v[136:139], a[8:11]
  ds_read_b64_tr_b16 v[96:97], v12 offset:0
  v_mfma_f32_16x16x32_bf16 a[12:15], v[64:67], v[140:143], a[12:15]
  v_mfma_f32_16x16x32_bf16 a[16:19], v[64:67], v[144:147], a[16:19]
  s_mov_b32 m0, s24
  ds_read_b64_tr_b16 v[98:99], v12 offset:1024
  v_mfma_f32_16x16x32_bf16 a[20:23], v[64:67], v[148:151], a[20:23]
  buffer_load_dwordx4 v224, s[32:35], s26 offen offset:0 lds
  v_mfma_f32_16x16x32_bf16 a[24:27], v[64:67], v[152:155], a[24:27]
  ds_read_b128 v[32:35], v14 offset:0
  v_mfma_f32_16x16x32_bf16 a[28:31], v[64:67], v[156:159], a[28:31]
  v_mfma_f32_16x16x32_bf16 a[32:35], v[68:71], v[128:131], a[32:35]
  ds_read_b64_tr_b16 v[100:101], v13 offset:0
  v_mfma_f32_16x16x32_bf16 a[36:39], v[68:71], v[132:135], a[36:39]
  v_mfma_f32_16x16x32_bf16 a[40:43], v[68:71], v[136:139], a[40:43]
  ds_read_b64_tr_b16 v[102:103], v13 offset:1024
  v_mfma_f32_16x16x32_bf16 a[44:47], v[68:71], v[140:143], a[44:47]
  buffer_load_dwordx4 v225, s[32:35], s26 offen offset:1024 lds
  v_mfma_f32_16x16x32_bf16 a[48:51], v[68:71], v[144:147], a[48:51]
  ds_read_b128 v[36:39], v14 offset:1024
  v_mfma_f32_16x16x32_bf16 a[52:55], v[68:71], v[148:151], a[52:55]
  v_mfma_f32_16x16x32_bf16 a[56:59], v[68:71], v[152:155], a[56:59]
  ds_read_b64_tr_b16 v[104:105], v12 offset:256
  v_mfma_f32_16x16x32_bf16 a[60:63], v[68:71], v[156:159], a[60:63]
  v_mfma_f32_16x16x32_bf16 a[64:67], v[72:75], v[128:131], a[64:67]
  ds_read_b64_tr_b16 v[106:107], v12 offset:1280
  v_mfma_f32_16x16x32_bf16 a[68:71], v[72:75], v[132:135], a[68:71]
  buffer_load_dwordx4 v226, s[32:35], s26 offen offset:2048 lds
  v_mfma_f32_16x16x32_bf16 a[72:75], v[72:75], v[136:139], a[72:75]
  ds_read_b128 v[40:43], v14 offset:2048
  v_mfma_f32_16x16x32_bf16 a[76:79], v[72:75], v[140:143], a[76:79]
  v_mfma_f32_16x16x32_bf16 a[80:83], v[72:75], v[144:147], a[80:83]
  ds_read_b64_tr_b16 v[108:109], v13 offset:256
  v_mfma_f32_16x16x32_bf16 a[84:87], v[72:75], v[148:151], a[84:87]
  v_mfma_f32_16x16x32_bf16 a[88:91], v[72:75], v[152:155], a[88:91]
  ds_read_b64_tr_b16 v[110:111], v13 offset:1280
  v_mfma_f32_16x16x32_bf16 a[92:95], v[72:75], v[156:159], a[92:95]
  buffer_load_dwordx4 v227, s[32:35], s26 offen offset:3072 lds
  v_mfma_f32_16x16x32_bf16 a[96:99], v[76:79], v[128:131], a[96:99]
  ds_read_b128 v[44:47], v14 offset:3072
  v_mfma_f32_16x16x32_bf16 a[100:103], v[76:79], v[132:135], a[100:103]
  v_mfma_f32_16x16x32_bf16 a[104:107], v[76:79], v[136:139], a[104:107]
  ds_read_b64_tr_b16 v[112:113], v12 offset:512
  v_mfma_f32_16x16x32_bf16 a[108:111], v[76:79], v[140:143], a[108:111]
  v_mfma_f32_16x16x32_bf16 a[112:115], v[76:79], v[144:147], a[112:115]
  s_add_u32 m0, s24, 16384
  ds_read_b64_tr_b16 v[114:115], v12 offset:1536
  v_mfma_f32_16x16x32_bf16 a[116:119], v[76:79], v[148:151], a[116:119]
  buffer_load_dwordx4 v8, s[36:39], s27 offen offset:0 lds
  v_mfma_f32_16x16x32_bf16 a[120:123], v[76:79], v[152:155], a[120:123]
  ds_read_b128 v[48:51], v14 offset:4096
  v_mfma_f32_16x16x32_bf16 a[124:127], v[76:79], v[156:159], a[124:127]
  v_mfma_f32_16x16x32_bf16 a[128:131], v[80:83], v[128:131], a[128:131]
  ds_read_b64_tr_b16 v[116:117], v13 offset:512
  v_mfma_f32_16x16x32_bf16 a[132:135], v[80:83], v[132:135], a[132:135]
  v_mfma_f32_16x16x32_bf16 a[136:139], v[80:83], v[136:139], a[136:139]
  ds_read_b64_tr_b16 v[118:119], v13 offset:1536
  v_mfma_f32_16x16x32_bf16 a[140:143], v[80:83], v[140:143], a[140:143]
  buffer_load_dwordx4 v9, s[36:39], s27 offen offset:1024 lds
  v_mfma_f32_16x16x32_bf16 a[144:147], v[80:83], v[144:147], a[144:147]
  ds_read_b128 v[52:55], v14 offset:5120
  v_mfma_f32_16x16x32_bf16 a[148:151], v[80:83], v[148:151], a[148:151]
  v_mfma_f32_16x16x32_bf16 a[152:155], v[80:83], v[152:155], a[152:155]
  ds_read_b64_tr_b16 v[120:121], v12 offset:768
  v_mfma_f32_16x16x32_bf16 a[156:159], v[80:83], v[156:159], a[156:159]
  v_mfma_f32_16x16x32_bf16 a[160:163], v[84:87], v[128:131], a[160:163]
  ds_read_b64_tr_b16 v[122:123], v12 offset:1792
  v_mfma_f32_16x16x32_bf16 a[164:167], v[84:87], v[132:135], a[164:167]
  buffer_load_dwordx4 v10, s[36:39], s27 offen offset:2048 lds
  v_mfma_f32_16x16x32_bf16 a[168:171], v[84:87], v[136:139], a[168:171]
  ds_read_b128 v[56:59], v14 offset:6144
  v_mfma_f32_16x16x32_bf16 a[172:175], v[84:87], v[140:143], a[172:175]
  v_mfma_f32_16x16x32_bf16 a[176:179], v[84:87], v[144:147], a[176:179]
  ds_read_b64_tr_b16 v[124:125], v13 offset:768
  v_mfma_f32_16x16x32_bf16 a[180:183], v[84:87], v[148:151], a[180:183]
  v_mfma_f32_16x16x32_bf16 a[184:187], v[84:87], v[152:155], a[184:187]
  ds_read_b64_tr_b16 v[126:127], v13 offset:1792
  v_mfma_f32_16x16x32_bf16 a[188:191], v[84:87], v[156:159], a[188:191]
  buffer_load_dwordx4 v11, s[36:39], s27 offen offset:3072 lds
  v_mfma_f32_16x16x32_bf16 a[192:195], v[88:91], v[128:131], a[192:195]
  s_add_u32 s26, s26, 64
  ds_read_b128 v[60:63], v14 offset:7168
  v_mfma_f32_16x16x32_bf16 a[196:199], v[88:91], v[132:135], a[196:199]
  s_add_u32 s27, s27, s25
  v_mfma_f32_16x16x32_bf16 a[200:203], v[88:91], v[136:139], a[200:203]
  s_add_u32 s24, s24, 32768
  v_mfma_f32_16x16x32_bf16 a[204:207], v[88:91], v[140:143], a[204:207]
  s_and_b32 s24, s24, 0x1ffff
  v_mfma_f32_16x16x32_bf16 a[208:211], v[88:91], v[144:147], a[208:211]
  v_mfma_f32_16x16x32_bf16 a[212:215], v[88:91], v[148:151], a[212:215]
  v_mfma_f32_16x16x32_bf16 a[216:219], v[88:91], v[152:155], a[216:219]
  s_add_u32 s28, s28, 1
  v_mfma_f32_16x16x32_bf16 a[220:223], v[88:91], v[156:159], a[220:223]
  v_mfma_f32_16x16x32_bf16 a[224:227], v[92:95], v[128:131], a[224:227]
  v_mfma_f32_16x16x32_bf16 a[228:231], v[92:95], v[132:135], a[228:231]
  v_mfma_f32_16x16x32_bf16 a[232:235], v[92:95], v[136:139], a[232:235]
  v_mfma_f32_16x16x32_bf16 a[236:239], v[92:95], v[140:143], a[236:239]
  v_mfma_f32_16x16x32_bf16 a[240:243], v[92:95], v[144:147], a[240:243]
  v_mfma_f32_16x16x32_bf16 a[244:247], v[92:95], v[148:151], a[244:247]
  s_cmp_lt_u32 s28, 8
  v_mfma_f32_16x16x32_bf16 a[248:251], v[92:95], v[152:155], a[248:251]
  s_waitcnt lgkmcnt(0)
  v_mfma_f32_16x16x32_bf16 a[252:255], v[92:95], v[156:159], a[252:255]
  s_cbranch_scc1 fa_loopV
  s_mov_b32 s70, 8192
  s_mov_b32 s71, 2048
  s_mov_b32 s72, 33554432
fa_p1epi:
  s_lshl_b32 s23, s21, 19
  s_add_u32 s72, s72, s23
  s_lshl_b32 s23, s22, 16
  s_add_u32 s72, s72, s23
  s_and_b32 s23, s20, 1
  s_lshl_b32 s23, s23, 15
  s_add_u32 s72, s72, s23
  s_lshl_b32 s23, s22, 2
  s_add_u32 s23, s23, s20
  s_mul_i32 s64, s23, 40960
  s_add_u32 s65, s64, 20480
  s_sub_u32 s23, 15, s22
  s_lshl_b32 s23, s23, 2
  s_add_u32 s23, s23, s20
  s_mul_i32 s66, s23, 40960
  s_add_u32 s67, s66, 20480
  s_mov_b32 s32, s18
  s_mov_b32 s33, s19
  s_mov_b32 s34, 2621440
  s_mov_b32 s35, 0x20000
  s_mul_i32 s73, s70, 3
  s_add_u32 s73, s73, s72
  v_accvgpr_read_b32 v100, a192
  v_accvgpr_read_b32 v101, a193
  v_accvgpr_read_b32 v102, a194
  v_accvgpr_read_b32 v103, a195
  v_accvgpr_read_b32 v104, a224
  v_accvgpr_read_b32 v105, a225
  v_accvgpr_read_b32 v106, a226
  v_accvgpr_read_b32 v107, a227
  v_cvt_pk_bf16_f32 v96, v100, v101
  v_cvt_pk_bf16_f32 v97, v102, v103
  v_cvt_pk_bf16_f32 v98, v104, v105
  v_cvt_pk_bf16_f32 v99, v106, v107
  buffer_store_dwordx4 v[96:99], v2, s[40:43], s73 offen offset:0 sc1
  v_accvgpr_read_b32 v112, a196
  v_accvgpr_read_b32 v113, a197
  v_accvgpr_read_b32 v114, a198
  v_accvgpr_read_b32 v115, a199
  v_accvgpr_read_b32 v116, a228
  v_accvgpr_read_b32 v117, a229
  v_accvgpr_read_b32 v118, a230
  v_accvgpr_read_b32 v119, a231
  v_cvt_pk_bf16_f32 v108, v112, v113
  v_cvt_pk_bf16_f32 v109, v114, v115
  v_cvt_pk_bf16_f32 v110, v116, v117
  v_cvt_pk_bf16_f32 v111, v118, v119
  buffer_store_dwordx4 v[108:111], v2, s[40:43], s73 offen offset:1024 sc1
  s_add_u32 s73, s73, s71
  v_accvgpr_read_b32 v124, a200
  v_accvgpr_read_b32 v125, a201
  v_accvgpr_read_b32 v126, a202
  v_accvgpr_read_b32 v127, a203
  v_accvgpr_read_b32 v128, a232
  v_accvgpr_read_b32 v129, a233
  v_accvgpr_read_b32 v130, a234
  v_accvgpr_read_b32 v131, a235
  v_cvt_pk_bf16_f32 v120, v124, v125
  v_cvt_pk_bf16_f32 v121, v126, v127
  v_cvt_pk_bf16_f32 v122, v128, v129
  v_cvt_pk_bf16_f32 v123, v130, v131
  buffer_store_dwordx4 v[120:123], v2, s[40:43], s73 offen offset:0 sc1
  v_accvgpr_read_b32 v136, a204
  v_accvgpr_read_b32 v137, a205
  v_accvgpr_read_b32 v138, a206
  v_accvgpr_read_b32 v139, a207
  v_accvgpr_read_b32 v140, a236
  v_accvgpr_read_b32 v141, a237
  v_accvgpr_read_b32 v142, a238
  v_accvgpr_read_b32 v143, a239
  v_cvt_pk_bf16_f32 v132, v136, v137
  v_cvt_pk_bf16_f32 v133, v138, v139
  v_cvt_pk_bf16_f32 v134, v140, v141
  v_cvt_pk_bf16_f32 v135, v142, v143
  buffer_store_dwordx4 v[132:135], v2, s[40:43], s73 offen offset:1024 sc1
  s_add_u32 s73, s73, s71
  v_accvgpr_read_b32 v148, a208
  v_accvgpr_read_b32 v149, a209
  v_accvgpr_read_b32 v150, a210
  v_accvgpr_read_b32 v151, a211
  v_accvgpr_read_b32 v152, a240
  v_accvgpr_read_b32 v153, a241
  v_accvgpr_read_b32 v154, a242
  v_accvgpr_read_b32 v155, a243
  v_cvt_pk_bf16_f32 v144, v148, v149
  v_cvt_pk_bf16_f32 v145, v150, v151
  v_cvt_pk_bf16_f32 v146, v152, v153
  v_cvt_pk_bf16_f32 v147, v154, v155
  buffer_store_dwordx4 v[144:147], v2, s[40:43], s73 offen offset:0 sc1
  v_accvgpr_read_b32 v160, a212
  v_accvgpr_read_b32 v161, a213
  v_accvgpr_read_b32 v162, a214
  v_accvgpr_read_b32 v163, a215
  v_accvgpr_read_b32 v164, a244
  v_accvgpr_read_b32 v165, a245
  v_accvgpr_read_b32 v166, a246
  v_accvgpr_read_b32 v167, a247
  v_cvt_pk_bf16_f32 v156, v160, v161
  v_cvt_pk_bf16_f32 v157, v162, v163
  v_cvt_pk_bf16_f32 v158, v164, v165
  v_cvt_pk_bf16_f32 v159, v166, v167
  buffer_store_dwordx4 v[156:159], v2, s[40:43], s73 offen offset:1024 sc1
  s_add_u32 s73, s73, s71
  v_accvgpr_read_b32 v172, a216
  v_accvgpr_read_b32 v173, a217
  v_accvgpr_read_b32 v174, a218
  v_accvgpr_read_b32 v175, a219
  v_accvgpr_read_b32 v176, a248
  v_accvgpr_read_b32 v177, a249
  v_accvgpr_read_b32 v178, a250
  v_accvgpr_read_b32 v179, a251
  v_cvt_pk_bf16_f32 v168, v172, v173
  v_cvt_pk_bf16_f32 v169, v174, v175
  v_cvt_pk_bf16_f32 v170, v176, v177
  v_cvt_pk_bf16_f32 v171, v178, v179
  buffer_store_dwordx4 v[168:171], v2, s[40:43], s73 offen offset:0 sc1
  v_accvgpr_read_b32 v184, a220
  v_accvgpr_read_b32 v185, a221
  v_accvgpr_read_b32 v186, a222
  v_accvgpr_read_b32 v187, a223
  v_accvgpr_read_b32 v188, a252
  v_accvgpr_read_b32 v189, a253
  v_accvgpr_read_b32 v190, a254
  v_accvgpr_read_b32 v191, a255
  v_cvt_pk_bf16_f32 v180, v184, v185
  v_cvt_pk_bf16_f32 v181, v186, v187
  v_cvt_pk_bf16_f32 v182, v188, v189
  v_cvt_pk_bf16_f32 v183, v190, v191
  buffer_store_dwordx4 v[180:183], v2, s[40:43], s73 offen offset:1024 sc1
  v_cmp_gt_u32 vcc, 0x100, v228
  s_cbranch_vccz fa_ln_ok
  s_mov_b32 s83, 200000
fa_ln_spin:
  s_sleep 4
  buffer_load_dword v228, v229, s[56:59], 0 offen sc1
  s_waitcnt vmcnt(0)
  v_cmp_gt_u32 vcc, 0x100, v228
  s_cbranch_vccz fa_ln_ok
  s_sub_u32 s83, s83, 1
  s_cmp_lg_u32 s83, 0
  s_cbranch_scc1 fa_ln_spin
fa_ln_ok:
  buffer_load_dwordx4 a[192:195], v2, s[32:35], s64 offen offset:0 sc1
  buffer_load_dwordx4 a[196:199], v2, s[32:35], s65 offen offset:0 sc1
  buffer_load_dwordx4 a[200:203], v2, s[32:35], s66 offen offset:0 sc1
  buffer_load_dwordx4 a[204:207], v2, s[32:35], s67 offen offset:0 sc1
  buffer_load_dwordx4 a[208:211], v2, s[32:35], s64 offen offset:1024 sc1
  buffer_load_dwordx4 a[212:215], v2, s[32:35], s65 offen offset:1024 sc1
  buffer_load_dwordx4 a[216:219], v2, s[32:35], s66 offen offset:1024 sc1
  buffer_load_dwordx4 a[220:223], v2, s[32:35], s67 offen offset:1024 sc1
  buffer_load_dwordx4 a[224:227], v2, s[32:35], s64 offen offset:2048 sc1
  buffer_load_dwordx4 a[228:231], v2, s[32:35], s65 offen offset:2048 sc1
  buffer_load_dwordx4 a[232:235], v2, s[32:35], s66 offen offset:2048 sc1
  buffer_load_dwordx4 a[236:239], v2, s[32:35], s67 offen offset:2048 sc1
  buffer_load_dwordx4 a[240:243], v2, s[32:35], s64 offen offset:3072 sc1
  buffer_load_dwordx4 a[244:247], v2, s[32:35], s65 offen offset:3072 sc1
  buffer_load_dwordx4 a[248:251], v2, s[32:35], s66 offen offset:3072 sc1
  buffer_load_dwordx4 a[252:255], v2, s[32:35], s67 offen offset:3072 sc1
  s_add_u32 s64, s64, 4096
  s_add_u32 s65, s65, 4096
  s_add_u32 s66, s66, 4096
  s_add_u32 s67, s67, 4096
  v_lshrrev_b32 v16, 2, v1
  v_mul_u32_u24 v16, 160, v16
  v_and_b32 v17, 3, v1
  v_lshl_add_u32 v16, v17, 3, v16
  v_add_u32 v16, s31, v16
  ds_read_b64_tr_b16 v[200:201], v16 offset:0
  ds_read_b64_tr_b16 v[202:203], v16 offset:2560
  ds_read_b64_tr_b16 v[204:205], v16 offset:32
  ds_read_b64_tr_b16 v[206:207], v16 offset:2592
  ds_read_b64_tr_b16 v[208:209], v16 offset:64
  ds_read_b64_tr_b16 v[210:211], v16 offset:2624
  ds_read_b64_tr_b16 v[212:213], v16 offset:96
  ds_read_b64_tr_b16 v[214:215], v16 offset:2656
  ds_read_b64_tr_b16 v[216:217], v16 offset:128
  ds_read_b64_tr_b16 v[218:219], v16 offset:2688
  s_mul_i32 s73, s70, 0
  s_add_u32 s73, s73, s72
  v_accvgpr_read_b32 v100, a0
  v_accvgpr_read_b32 v101, a1
  v_accvgpr_read_b32 v102, a2
  v_accvgpr_read_b32 v103, a3
  v_accvgpr_read_b32 v104, a32
  v_accvgpr_read_b32 v105, a33
  v_accvgpr_read_b32 v106, a34
  v_accvgpr_read_b32 v107, a35
  v_cvt_pk_bf16_f32 v96, v100, v101
  v_cvt_pk_bf16_f32 v97, v102, v103
  v_cvt_pk_bf16_f32 v98, v104, v105
  v_cvt_pk_bf16_f32 v99, v106, v107
  buffer_store_dwordx4 v[96:99], v2, s[40:43], s73 offen offset:0 sc1
  v_accvgpr_read_b32 v112, a4
  v_accvgpr_read_b32 v113, a5
  v_accvgpr_read_b32 v114, a6
  v_accvgpr_read_b32 v115, a7
  v_accvgpr_read_b32 v116, a36
  v_accvgpr_read_b32 v117, a37
  v_accvgpr_read_b32 v118, a38
  v_accvgpr_read_b32 v119, a39
  v_cvt_pk_bf16_f32 v108, v112, v113
  v_cvt_pk_bf16_f32 v109, v114, v115
  v_cvt_pk_bf16_f32 v110, v116, v117
  v_cvt_pk_bf16_f32 v111, v118, v119
  buffer_store_dwordx4 v[108:111], v2, s[40:43], s73 offen offset:1024 sc1
  s_add_u32 s73, s73, s71
  v_accvgpr_read_b32 v124, a8
  v_accvgpr_read_b32 v125, a9
  v_accvgpr_read_b32 v126, a10
  v_accvgpr_read_b32 v127, a11
  v_accvgpr_read_b32 v128, a40
  v_accvgpr_read_b32 v129, a41
  v_accvgpr_read_b32 v130, a42
  v_accvgpr_read_b32 v131, a43
  v_cvt_pk_bf16_f32 v120, v124, v125
  v_cvt_pk_bf16_f32 v121, v126, v127
  v_cvt_pk_bf16_f32 v122, v128, v129
  v_cvt_pk_bf16_f32 v123, v130, v131
  buffer_store_dwordx4 v[120:123], v2, s[40:43], s73 offen offset:0 sc1
  v_accvgpr_read_b32 v136, a12
  v_accvgpr_read_b32 v137, a13
  v_accvgpr_read_b32 v138, a14
  v_accvgpr_read_b32 v139, a15
  v_accvgpr_read_b32 v140, a44
  v_accvgpr_read_b32 v141, a45
  v_accvgpr_read_b32 v142, a46
  v_accvgpr_read_b32 v143, a47
  v_cvt_pk_bf16_f32 v132, v136, v137
  v_cvt_pk_bf16_f32 v133, v138, v139
  v_cvt_pk_bf16_f32 v134, v140, v141
  v_cvt_pk_bf16_f32 v135, v142, v143
  buffer_store_dwordx4 v[132:135], v2, s[40:43], s73 offen offset:1024 sc1
  s_add_u32 s73, s73, s71
  v_accvgpr_read_b32 v148, a16
  v_accvgpr_read_b32 v149, a17
  v_accvgpr_read_b32 v150, a18
  v_accvgpr_read_b32 v151, a19
  v_accvgpr_read_b32 v152, a48
  v_accvgpr_read_b32 v153, a49
  v_accvgpr_read_b32 v154, a50
  v_accvgpr_read_b32 v155, a51
  v_cvt_pk_bf16_f32 v144, v148, v149
  v_cvt_pk_bf16_f32 v145, v150, v151
  v_cvt_pk_bf16_f32 v146, v152, v153
  v_cvt_pk_bf16_f32 v147, v154, v155
  buffer_store_dwordx4 v[144:147], v2, s[40:43], s73 offen offset:0 sc1
  v_accvgpr_read_b32 v160, a20
  v_accvgpr_read_b32 v161, a21
  v_accvgpr_read_b32 v162, a22
  v_accvgpr_read_b32 v163, a23
  v_accvgpr_read_b32 v164, a52
  v_accvgpr_read_b32 v165, a53
  v_accvgpr_read_b32 v166, a54
  v_accvgpr_read_b32 v167, a55
  v_cvt_pk_bf16_f32 v156, v160, v161
  v_cvt_pk_bf16_f32 v157, v162, v163
  v_cvt_pk_bf16_f32 v158, v164, v165
  v_cvt_pk_bf16_f32 v159, v166, v167
  buffer_store_dwordx4 v[156:159], v2, s[40:43], s73 offen offset:1024 sc1
  s_add_u32 s73, s73, s71
  v_accvgpr_read_b32 v172, a24
  v_accvgpr_read_b32 v173, a25
  v_accvgpr_read_b32 v174, a26
  v_accvgpr_read_b32 v175, a27
  v_accvgpr_read_b32 v176, a56
  v_accvgpr_read_b32 v177, a57
  v_accvgpr_read_b32 v178, a58
  v_accvgpr_read_b32 v179, a59
  v_cvt_pk_bf16_f32 v168, v172, v173
  v_cvt_pk_bf16_f32 v169, v174, v175
  v_cvt_pk_bf16_f32 v170, v176, v177
  v_cvt_pk_bf16_f32 v171, v178, v179
  buffer_store_dwordx4 v[168:171], v2, s[40:43], s73 offen offset:0 sc1
  v_accvgpr_read_b32 v184, a28
  v_accvgpr_read_b32 v185, a29
  v_accvgpr_read_b32 v186, a30
  v_accvgpr_read_b32 v187, a31
  v_accvgpr_read_b32 v188, a60
  v_accvgpr_read_b32 v189, a61
  v_accvgpr_read_b32 v190, a62
  v_accvgpr_read_b32 v191, a63
  v_cvt_pk_bf16_f32 v180, v184, v185
  v_cvt_pk_bf16_f32 v181, v186, v187
  v_cvt_pk_bf16_f32 v182, v188, v189
  v_cvt_pk_bf16_f32 v183, v190, v191
  buffer_store_dwordx4 v[180:183], v2, s[40:43], s73 offen offset:1024 sc1
  s_lshl_b32 s23, s29, 7
  s_add_u32 s23, s23, s30
  s_mul_i32 s23, s23, 5120
  s_add_u32 s23, s23, 4194304
  s_add_u32 s31, s23, 4096
  s_waitcnt lgkmcnt(0)
  buffer_store_dwordx4 v[200:203], v2, s[40:43], s23 offen offset:0 sc1
  buffer_store_dwordx4 v[204:207], v2, s[40:43], s23 offen offset:1024 sc1
  buffer_store_dwordx4 v[208:211], v2, s[40:43], s23 offen offset:2048 sc1
  buffer_store_dwordx4 v[212:215], v2, s[40:43], s23 offen offset:3072 sc1
  buffer_store_dwordx4 v[216:219], v2, s[40:43], s31 offen offset:0 sc1
  s_mul_i32 s73, s70, 1
  s_add_u32 s73, s73, s72
  v_accvgpr_read_b32 v100, a64
  v_accvgpr_read_b32 v101, a65
  v_accvgpr_read_b32 v102, a66
  v_accvgpr_read_b32 v103, a67
  v_accvgpr_read_b32 v104, a96
  v_accvgpr_read_b32 v105, a97
  v_accvgpr_read_b32 v106, a98
  v_accvgpr_read_b32 v107, a99
  v_cvt_pk_bf16_f32 v96, v100, v101
  v_cvt_pk_bf16_f32 v97, v102, v103
  v_cvt_pk_bf16_f32 v98, v104, v105
  v_cvt_pk_bf16_f32 v99, v106, v107
  buffer_store_dwordx4 v[96:99], v2, s[40:43], s73 offen offset:0 sc1
  v_accvgpr_read_b32 v112, a68
  v_accvgpr_read_b32 v113, a69
  v_accvgpr_read_b32 v114, a70
  v_accvgpr_read_b32 v115, a71
  v_accvgpr_read_b32 v116, a100
  v_accvgpr_read_b32 v117, a101
  v_accvgpr_read_b32 v118, a102
  v_accvgpr_read_b32 v119, a103
  v_cvt_pk_bf16_f32 v108, v112, v113
  v_cvt_pk_bf16_f32 v109, v114, v115
  v_cvt_pk_bf16_f32 v110, v116, v117
  v_cvt_pk_bf16_f32 v111, v118, v119
  buffer_store_dwordx4 v[108:111], v2, s[40:43], s73 offen offset:1024 sc1
  s_add_u32 s73, s73, s71
  v_accvgpr_read_b32 v124, a72
  v_accvgpr_read_b32 v125, a73
  v_accvgpr_read_b32 v126, a74
  v_accvgpr_read_b32 v127, a75
  v_accvgpr_read_b32 v128, a104
  v_accvgpr_read_b32 v129, a105
  v_accvgpr_read_b32 v130, a106
  v_accvgpr_read_b32 v131, a107
  v_cvt_pk_bf16_f32 v120, v124, v125
  v_cvt_pk_bf16_f32 v121, v126, v127
  v_cvt_pk_bf16_f32 v122, v128, v129
  v_cvt_pk_bf16_f32 v123, v130, v131
  buffer_store_dwordx4 v[120:123], v2, s[40:43], s73 offen offset:0 sc1
  v_accvgpr_read_b32 v136, a76
  v_accvgpr_read_b32 v137, a77
  v_accvgpr_read_b32 v138, a78
  v_accvgpr_read_b32 v139, a79
  v_accvgpr_read_b32 v140, a108
  v_accvgpr_read_b32 v141, a109
  v_accvgpr_read_b32 v142, a110
  v_accvgpr_read_b32 v143, a111
  v_cvt_pk_bf16_f32 v132, v136, v137
  v_cvt_pk_bf16_f32 v133, v138, v139
  v_cvt_pk_bf16_f32 v134, v140, v141
  v_cvt_pk_bf16_f32 v135, v142, v143
  buffer_store_dwordx4 v[132:135], v2, s[40:43], s73 offen offset:1024 sc1
  s_add_u32 s73, s73, s71
  v_accvgpr_read_b32 v148, a80
  v_accvgpr_read_b32 v149, a81
  v_accvgpr_read_b32 v150, a82
  v_accvgpr_read_b32 v151, a83
  v_accvgpr_read_b32 v152, a112
  v_accvgpr_read_b32 v153, a113
  v_accvgpr_read_b32 v154, a114
  v_accvgpr_read_b32 v155, a115
  v_cvt_pk_bf16_f32 v144, v148, v149
  v_cvt_pk_bf16_f32 v145, v150, v151
  v_cvt_pk_bf16_f32 v146, v152, v153
  v_cvt_pk_bf16_f32 v147, v154, v155
  buffer_store_dwordx4 v[144:147], v2, s[40:43], s73 offen offset:0 sc1
  v_accvgpr_read_b32 v160, a84
  v_accvgpr_read_b32 v161, a85
  v_accvgpr_read_b32 v162, a86
  v_accvgpr_read_b32 v163, a87
  v_accvgpr_read_b32 v164, a116
  v_accvgpr_read_b32 v165, a117
  v_accvgpr_read_b32 v166, a118
  v_accvgpr_read_b32 v167, a119
  v_cvt_pk_bf16_f32 v156, v160, v161
  v_cvt_pk_bf16_f32 v157, v162, v163
  v_cvt_pk_bf16_f32 v158, v164, v165
  v_cvt_pk_bf16_f32 v159, v166, v167
  buffer_store_dwordx4 v[156:159], v2, s[40:43], s73 offen offset:1024 sc1
  s_add_u32 s73, s73, s71
  v_accvgpr_read_b32 v172, a88
  v_accvgpr_read_b32 v173, a89
  v_accvgpr_read_b32 v174, a90
  v_accvgpr_read_b32 v175, a91
  v_accvgpr_read_b32 v176, a120
  v_accvgpr_read_b32 v177, a121
  v_accvgpr_read_b32 v178, a122
  v_accvgpr_read_b32 v179, a123
  v_cvt_pk_bf16_f32 v168, v172, v173
  v_cvt_pk_bf16_f32 v169, v174, v175
  v_cvt_pk_bf16_f32 v170, v176, v177
  v_cvt_pk_bf16_f32 v171, v178, v179
  buffer_store_dwordx4 v[168:171], v2, s[40:43], s73 offen offset:0 sc1
  v_accvgpr_read_b32 v184, a92
  v_accvgpr_read_b32 v185, a93
  v_accvgpr_read_b32 v186, a94
  v_accvgpr_read_b32 v187, a95
  v_accvgpr_read_b32 v188, a124
  v_accvgpr_read_b32 v189, a125
  v_accvgpr_read_b32 v190, a126
  v_accvgpr_read_b32 v191, a127
  v_cvt_pk_bf16_f32 v180, v184, v185
  v_cvt_pk_bf16_f32 v181, v186, v187
  v_cvt_pk_bf16_f32 v182, v188, v189
  v_cvt_pk_bf16_f32 v183, v190, v191
  buffer_store_dwordx4 v[180:183], v2, s[40:43], s73 offen offset:1024 sc1
  s_mul_i32 s73, s70, 2
  s_add_u32 s73, s73, s72
  v_accvgpr_read_b32 v100, a128
  v_accvgpr_read_b32 v101, a129
  v_accvgpr_read_b32 v102, a130
  v_accvgpr_read_b32 v103, a131
  v_accvgpr_read_b32 v104, a160
  v_accvgpr_read_b32 v105, a161
  v_accvgpr_read_b32 v106, a162
  v_accvgpr_read_b32 v107, a163
  v_cvt_pk_bf16_f32 v96, v100, v101
  v_cvt_pk_bf16_f32 v97, v102, v103
  v_cvt_pk_bf16_f32 v98, v104, v105
  v_cvt_pk_bf16_f32 v99, v106, v107
  buffer_store_dwordx4 v[96:99], v2, s[40:43], s73 offen offset:0 sc1
  v_accvgpr_read_b32 v112, a132
  v_accvgpr_read_b32 v113, a133
  v_accvgpr_read_b32 v114, a134
  v_accvgpr_read_b32 v115, a135
  v_accvgpr_read_b32 v116, a164
  v_accvgpr_read_b32 v117, a165
  v_accvgpr_read_b32 v118, a166
  v_accvgpr_read_b32 v119, a167
  v_cvt_pk_bf16_f32 v108, v112, v113
  v_cvt_pk_bf16_f32 v109, v114, v115
  v_cvt_pk_bf16_f32 v110, v116, v117
  v_cvt_pk_bf16_f32 v111, v118, v119
  buffer_store_dwordx4 v[108:111], v2, s[40:43], s73 offen offset:1024 sc1
  s_add_u32 s73, s73, s71
  v_accvgpr_read_b32 v124, a136
  v_accvgpr_read_b32 v125, a137
  v_accvgpr_read_b32 v126, a138
  v_accvgpr_read_b32 v127, a139
  v_accvgpr_read_b32 v128, a168
  v_accvgpr_read_b32 v129, a169
  v_accvgpr_read_b32 v130, a170
  v_accvgpr_read_b32 v131, a171
  v_cvt_pk_bf16_f32 v120, v124, v125
  v_cvt_pk_bf16_f32 v121, v126, v127
  v_cvt_pk_bf16_f32 v122, v128, v129
  v_cvt_pk_bf16_f32 v123, v130, v131
  buffer_store_dwordx4 v[120:123], v2, s[40:43], s73 offen offset:0 sc1
  v_accvgpr_read_b32 v136, a140
  v_accvgpr_read_b32 v137, a141
  v_accvgpr_read_b32 v138, a142
  v_accvgpr_read_b32 v139, a143
  v_accvgpr_read_b32 v140, a172
  v_accvgpr_read_b32 v141, a173
  v_accvgpr_read_b32 v142, a174
  v_accvgpr_read_b32 v143, a175
  v_cvt_pk_bf16_f32 v132, v136, v137
  v_cvt_pk_bf16_f32 v133, v138, v139
  v_cvt_pk_bf16_f32 v134, v140, v141
  v_cvt_pk_bf16_f32 v135, v142, v143
  buffer_store_dwordx4 v[132:135], v2, s[40:43], s73 offen offset:1024 sc1
  s_add_u32 s73, s73, s71
  v_accvgpr_read_b32 v148, a144
  v_accvgpr_read_b32 v149, a145
  v_accvgpr_read_b32 v150, a146
  v_accvgpr_read_b32 v151, a147
  v_accvgpr_read_b32 v152, a176
  v_accvgpr_read_b32 v153, a177
  v_accvgpr_read_b32 v154, a178
  v_accvgpr_read_b32 v155, a179
  v_cvt_pk_bf16_f32 v144, v148, v149
  v_cvt_pk_bf16_f32 v145, v150, v151
  v_cvt_pk_bf16_f32 v146, v152, v153
  v_cvt_pk_bf16_f32 v147, v154, v155
  buffer_store_dwordx4 v[144:147], v2, s[40:43], s73 offen offset:0 sc1
  v_accvgpr_read_b32 v160, a148
  v_accvgpr_read_b32 v161, a149
  v_accvgpr_read_b32 v162, a150
  v_accvgpr_read_b32 v163, a151
  v_accvgpr_read_b32 v164, a180
  v_accvgpr_read_b32 v165, a181
  v_accvgpr_read_b32 v166, a182
  v_accvgpr_read_b32 v167, a183
  v_cvt_pk_bf16_f32 v156, v160, v161
  v_cvt_pk_bf16_f32 v157, v162, v163
  v_cvt_pk_bf16_f32 v158, v164, v165
  v_cvt_pk_bf16_f32 v159, v166, v167
  buffer_store_dwordx4 v[156:159], v2, s[40:43], s73 offen offset:1024 sc1
  s_add_u32 s73, s73, s71
  v_accvgpr_read_b32 v172, a152
  v_accvgpr_read_b32 v173, a153
  v_accvgpr_read_b32 v174, a154
  v_accvgpr_read_b32 v175, a155
  v_accvgpr_read_b32 v176, a184
  v_accvgpr_read_b32 v177, a185
  v_accvgpr_read_b32 v178, a186
  v_accvgpr_read_b32 v179, a187
  v_cvt_pk_bf16_f32 v168, v172, v173
  v_cvt_pk_bf16_f32 v169, v174, v175
  v_cvt_pk_bf16_f32 v170, v176, v177
  v_cvt_pk_bf16_f32 v171, v178, v179
  buffer_store_dwordx4 v[168:171], v2, s[40:43], s73 offen offset:0 sc1
  v_accvgpr_read_b32 v184, a156
  v_accvgpr_read_b32 v185, a157
  v_accvgpr_read_b32 v186, a158
  v_accvgpr_read_b32 v187, a159
  v_accvgpr_read_b32 v188, a188
  v_accvgpr_read_b32 v189, a189
  v_accvgpr_read_b32 v190, a190
  v_accvgpr_read_b32 v191, a191
  v_cvt_pk_bf16_f32 v180, v184, v185
  v_cvt_pk_bf16_f32 v181, v186, v187
  v_cvt_pk_bf16_f32 v182, v188, v189
  v_cvt_pk_bf16_f32 v183, v190, v191
  buffer_store_dwordx4 v[180:183], v2, s[40:43], s73 offen offset:1024 sc1
  s_cmp_lg_u32 s2, 255
  s_cbranch_scc1 fa_notop
  s_cmp_lg_u32 s20, 0
  s_cbranch_scc1 fa_notop
  s_mov_b32 s23, 2621440
  s_mov_b32 s31, 2625536
  buffer_load_dwordx4 v[32:35], v2, s[40:43], s23 offen offset:0 sc1
  buffer_load_dwordx4 v[36:39], v2, s[40:43], s23 offen offset:1024 sc1
  buffer_load_dwordx4 v[40:43], v2, s[40:43], s23 offen offset:2048 sc1
  buffer_load_dwordx4 v[44:47], v2, s[40:43], s23 offen offset:3072 sc1
  buffer_load_dwordx4 v[48:51], v2, s[40:43], s31 offen offset:0 sc1
  buffer_load_dwordx4 v[52:55], v2, s[40:43], s31 offen offset:1024 sc1
  buffer_load_dwordx4 v[56:59], v2, s[40:43], s31 offen offset:2048 sc1
  buffer_load_dwordx4 v[60:63], v2, s[40:43], s31 offen offset:3072 sc1
  v_mov_b32 v21, 0
  v_mov_b32 v22, 0
  v_and_b32 v23, 7, v1
  s_mov_b32 s23, 0
  s_waitcnt vmcnt(0)
fa_top:
  v_max3_u32 v20, v32, v33, v34
  v_max3_u32 v24, v35, v36, v37
  v_max3_u32 v20, v20, v38, v39
  v_max3_u32 v24, v24, v40, v41
  v_max3_u32 v20, v20, v42, v43
  v_max3_u32 v24, v24, v44, v45
  v_max3_u32 v20, v20, v46, v47
  v_max3_u32 v24, v24, v48, v49
  v_max3_u32 v20, v20, v50, v51
  v_max3_u32 v24, v24, v52, v53
  v_max3_u32 v20, v20, v54, v55
  v_max3_u32 v24, v24, v56, v57
  v_max3_u32 v20, v20, v58, v59
  v_max3_u32 v24, v24, v60, v61
  v_max3_u32 v20, v20, v62, v63
  v_max_u32 v20, v20, v24
  s_nop 1
  v_max_u32_dpp v20, v20, v20 quad_perm:[1,0,3,2] row_mask:0xf bank_mask:0xf
  s_nop 1
  v_max_u32_dpp v20, v20, v20 quad_perm:[2,3,0,1] row_mask:0xf bank_mask:0xf
  s_nop 1
  v_max_u32_dpp v20, v20, v20 row_half_mirror row_mask:0xf bank_mask:0xf
  s_nop 1
  v_max_u32_dpp v20, v20, v20 row_mirror row_mask:0xf bank_mask:0xf
  v_mov_b32 v24, v20
  s_nop 1
  v_permlane16_swap_b32 v20, v24
  v_max_u32 v20, v20, v24
  v_mov_b32 v24, v20
  s_nop 1
  v_permlane32_swap_b32 v20, v24
  v_max_u32 v20, v20, v24
  v_add_u32 v21, v21, v20
  v_cmp_eq_u32 vcc, s23, v23
  v_sub_u32 v32, v32, v20
  v_sub_u32 v33, v33, v20
  v_sub_u32 v34, v34, v20
  v_sub_u32 v35, v35, v20
  v_sub_u32 v36, v36, v20
  v_sub_u32 v37, v37, v20
  v_sub_u32 v38, v38, v20
  v_sub_u32 v39, v39, v20
  v_sub_u32 v40, v40, v20
  v_sub_u32 v41, v41, v20
  v_sub_u32 v42, v42, v20
  v_sub_u32 v43, v43, v20
  v_sub_u32 v44, v44, v20
  v_sub_u32 v45, v45, v20
  v_sub_u32 v46, v46, v20
  v_sub_u32 v47, v47, v20
  v_sub_u32 v48, v48, v20
  v_sub_u32 v49, v49, v20
  v_sub_u32 v50, v50, v20
  v_sub_u32 v51, v51, v20
  v_sub_u32 v52, v52, v20
  v_sub_u32 v53, v53, v20
  v_sub_u32 v54, v54, v20
  v_sub_u32 v55, v55, v20
  v_sub_u32 v56, v56, v20
  v_sub_u32 v57, v57, v20
  v_sub_u32 v58, v58, v20
  v_sub_u32 v59, v59, v20
  v_sub_u32 v60, v60, v20
  v_sub_u32 v61, v61, v20
  v_sub_u32 v62, v62, v20
  v_sub_u32 v63, v63, v20
  v_cndmask_b32 v22, v22, v21, vcc
  s_add_u32 s23, s23, 1
  s_cmp_lt_u32 s23, 8
  s_cbranch_scc1 fa_top
  v_and_b32 v25, 0xffff, v22
  v_sub_u32 v25, 0xffff, v25
  v_and_b32 v25, 2047, v25
  v_ashrrev_i32 v20, 31, v22
  v_not_b32 v20, v20
  v_or_b32 v20, 0x80000000, v20
  v_xor_b32 v26, v22, v20
  v_and_b32 v26, 0xffff0000, v26
  v_mul_f32 v26, 0xbfb8aa3b, v26
  v_exp_f32 v26, v26
  s_nop 0
  v_add_f32 v26, 1.0, v26
  v_rcp_f32 v26, v26
  s_nop 0
  v_cvt_pk_bf16_f32 v26, v26, v26
  v_and_b32 v26, 0xffff0000, v26
  v_lshlrev_b32 v20, 2, v1
  v_add_u32 v20, 2629632, v20
  v_mov_b32 v21, 1073741824
  v_cmp_gt_u32 vcc, 8, v1
  s_nop 1
  v_cndmask_b32 v20, v21, v20, vcc
  buffer_store_dword v25, v20, s[40:43], 0 offen sc1
  buffer_store_dword v26, v20, s[40:43], 0 offen offset:32 sc1
  s_mov_b32 s23, 2650368
  v_mov_b32 v24, 1
  v_writelane_b32 v21, s23, 0
  s_waitcnt vmcnt(0)
  buffer_store_dword v24, v21, s[40:43], 0 offen sc1
fa_notop:
  s_lshr_b32 s23, s20, 1
  s_lshl_b32 s23, s23, 13
  v_subrev_u32 v12, s23, v12
  v_subrev_u32 v13, s23, v13
  v_mov_b32 v20, 0
  v_mov_b32 v21, 0
  v_mov_b32 v22, 0
  v_mov_b32 v23, 0
  s_lshl_b32 s23, s21, 19
  s_add_u32 s23, s23, 16777216
  s_add_u32 s6, s18, s23
  s_addc_u32 s7, s19, 0
  s_add_u32 s8, s6, 16777216
  s_addc_u32 s9, s7, 0
  s_sub_u32 s23, 16, s22
  s_lshl_b32 s23, s23, 15
  s_mov_b32 s44, s6
  s_mov_b32 s45, s7
  s_mov_b32 s46, s23
  s_mov_b32 s47, 0x20000
  s_mov_b32 s48, s8
  s_mov_b32 s49, s9
  s_mov_b32 s50, s23
  s_mov_b32 s51, 0x20000
  v_mfma_f32_32x32x16_bf16 v[96:111], v[20:23], v[20:23], 0
  v_mfma_f32_32x32x16_bf16 v[112:127], v[20:23], v[20:23], 0
  v_mfma_f32_32x32x16_bf16 v[128:143], v[20:23], v[20:23], 0
  v_mfma_f32_32x32x16_bf16 v[144:159], v[20:23], v[20:23], 0
  v_mfma_f32_32x32x16_bf16 v[160:175], v[20:23], v[20:23], 0
  v_mfma_f32_32x32x16_bf16 v[176:191], v[20:23], v[20:23], 0
  v_mfma_f32_32x32x16_bf16 v[192:207], v[20:23], v[20:23], 0
  v_mfma_f32_32x32x16_bf16 v[208:223], v[20:23], v[20:23], 0
  v_mfma_f32_32x32x16_bf16 a[0:15], v[20:23], v[20:23], 0
  v_mfma_f32_32x32x16_bf16 a[16:31], v[20:23], v[20:23], 0
  v_mfma_f32_32x32x16_bf16 a[32:47], v[20:23], v[20:23], 0
  v_mfma_f32_32x32x16_bf16 a[48:63], v[20:23], v[20:23], 0
  v_mfma_f32_32x32x16_bf16 a[64:79], v[20:23], v[20:23], 0
  v_mfma_f32_32x32x16_bf16 a[80:95], v[20:23], v[20:23], 0
  v_mfma_f32_32x32x16_bf16 a[96:111], v[20:23], v[20:23], 0
  v_mfma_f32_32x32x16_bf16 a[112:127], v[20:23], v[20:23], 0
  v_and_b32 v16, 15, v1
  v_lshrrev_b32 v17, 4, v1
  v_lshlrev_b32 v17, 2, v17
  v_sub_u32 v16, v16, v17
  v_cmp_le_i32 s[68:69], 0, v16
  v_cmp_le_i32 s[70:71], 1, v16
  v_cmp_le_i32 s[72:73], 2, v16
  v_cmp_le_i32 s[74:75], 3, v16
  v_mov_b32 v4, 0xff800000
  s_mov_b32 s81, 0x47800000
  v_and_b32 v230, 7, v1
  v_lshlrev_b32 v230, 2, v230
  s_lshl_b32 s23, s21, 7
  s_add_u32 s23, s23, 2637824
  v_add_u32 v230, s23, v230
  s_cmp_ge_u32 s2, 192
  s_cselect_b32 s23, 2650368, s23
  s_nop 0
  v_writelane_b32 v230, s23, 8
  s_waitcnt vmcnt(29)
  s_barrier
  ds_read_b64_tr_b16 v[32:33], v12 offset:0
  ds_read_b64_tr_b16 v[34:35], v12 offset:1024
  ds_read_b64_tr_b16 v[36:37], v13 offset:0
  ds_read_b64_tr_b16 v[38:39], v13 offset:1024
  ds_read_b64_tr_b16 v[40:41], v12 offset:256
  ds_read_b64_tr_b16 v[42:43], v12 offset:1280
  ds_read_b64_tr_b16 v[44:45], v13 offset:256
  ds_read_b64_tr_b16 v[46:47], v13 offset:1280
  ds_read_b64_tr_b16 v[48:49], v12 offset:512
  ds_read_b64_tr_b16 v[50:51], v12 offset:1536
  ds_read_b64_tr_b16 v[52:53], v13 offset:512
  ds_read_b64_tr_b16 v[54:55], v13 offset:1536
  ds_read_b64_tr_b16 v[56:57], v12 offset:768
  ds_read_b64_tr_b16 v[58:59], v12 offset:1792
  ds_read_b64_tr_b16 v[60:61], v13 offset:768
  ds_read_b64_tr_b16 v[62:63], v13 offset:1792
  s_mov_b32 s29, 0
  s_waitcnt lgkmcnt(0)
.p2align 6
fa_qloop:
  v_mfma_f32_16x16x32_bf16 v[96:99], v[32:35], a[192:195], v[96:99]
  v_mfma_f32_16x16x32_bf16 v[112:115], v[36:39], a[192:195], v[112:115]
  ds_read_b64_tr_b16 v[64:65], v12 offset:8192
  v_mfma_f32_16x16x32_bf16 v[128:131], v[40:43], a[192:195], v[128:131]
  ds_read_b64_tr_b16 v[66:67], v12 offset:9216
  v_mfma_f32_16x16x32_bf16 v[144:147], v[44:47], a[192:195], v[144:147]
  ds_read_b64_tr_b16 v[68:69], v13 offset:8192
  v_mfma_f32_16x16x32_bf16 v[160:163], v[48:51], a[192:195], v[160:163]
  ds_read_b64_tr_b16 v[70:71], v13 offset:9216
  v_mfma_f32_16x16x32_bf16 v[176:179], v[52:55], a[192:195], v[176:179]
  ds_read_b64_tr_b16 v[72:73], v12 offset:8448
  v_mfma_f32_16x16x32_bf16 v[192:195], v[56:59], a[192:195], v[192:195]
  ds_read_b64_tr_b16 v[74:75], v12 offset:9472
  v_mfma_f32_16x16x32_bf16 v[208:211], v[60:63], a[192:195], v[208:211]
  buffer_load_dwordx4 a[192:195], v2, s[32:35], s64 offen offset:0 sc1
  v_mfma_f32_16x16x32_bf16 v[100:103], v[32:35], a[196:199], v[100:103]
  ds_read_b64_tr_b16 v[76:77], v13 offset:8448
  v_mfma_f32_16x16x32_bf16 v[116:119], v[36:39], a[196:199], v[116:119]
  ds_read_b64_tr_b16 v[78:79], v13 offset:9472
  v_mfma_f32_16x16x32_bf16 v[132:135], v[40:43], a[196:199], v[132:135]
  ds_read_b64_tr_b16 v[80:81], v12 offset:8704
  v_mfma_f32_16x16x32_bf16 v[148:151], v[44:47], a[196:199], v[148:151]
  v_mfma_f32_16x16x32_bf16 v[164:167], v[48:51], a[196:199], v[164:167]
  ds_read_b64_tr_b16 v[82:83], v12 offset:9728
  v_mfma_f32_16x16x32_bf16 v[180:183], v[52:55], a[196:199], v[180:183]
  ds_read_b64_tr_b16 v[84:85], v13 offset:8704
  v_mfma_f32_16x16x32_bf16 v[196:199], v[56:59], a[196:199], v[196:199]
  ds_read_b64_tr_b16 v[86:87], v13 offset:9728
  v_mfma_f32_16x16x32_bf16 v[212:215], v[60:63], a[196:199], v[212:215]
  buffer_load_dwordx4 a[196:199], v2, s[32:35], s65 offen offset:0 sc1
  v_mfma_f32_16x16x32_bf16 v[104:107], v[32:35], a[200:203], v[104:107]
  ds_read_b64_tr_b16 v[88:89], v12 offset:8960
  v_mfma_f32_16x16x32_bf16 v[120:123], v[36:39], a[200:203], v[120:123]
  ds_read_b64_tr_b16 v[90:91], v12 offset:9984
  v_mfma_f32_16x16x32_bf16 v[136:139], v[40:43], a[200:203], v[136:139]
  ds_read_b64_tr_b16 v[92:93], v13 offset:8960
  v_mfma_f32_16x16x32_bf16 v[152:155], v[44:47], a[200:203], v[152:155]
  v_mfma_f32_16x16x32_bf16 v[168:171], v[48:51], a[200:203], v[168:171]
  ds_read_b64_tr_b16 v[94:95], v13 offset:9984
  v_mfma_f32_16x16x32_bf16 v[184:187], v[52:55], a[200:203], v[184:187]
  v_mfma_f32_16x16x32_bf16 v[200:203], v[56:59], a[200:203], v[200:203]
  v_mfma_f32_16x16x32_bf16 v[216:219], v[60:63], a[200:203], v[216:219]
  buffer_load_dwordx4 a[200:203], v2, s[32:35], s66 offen offset:0 sc1
  v_mfma_f32_16x16x32_bf16 v[108:111], v[32:35], a[204:207], v[108:111]
  v_mfma_f32_16x16x32_bf16 v[124:127], v[36:39], a[204:207], v[124:127]
  v_mfma_f32_16x16x32_bf16 v[140:143], v[40:43], a[204:207], v[140:143]
  v_mfma_f32_16x16x32_bf16 v[156:159], v[44:47], a[204:207], v[156:159]
  v_mfma_f32_16x16x32_bf16 v[172:175], v[48:51], a[204:207], v[172:175]
  v_mfma_f32_16x16x32_bf16 v[188:191], v[52:55], a[204:207], v[188:191]
  s_cmp_eq_u32 s29, 0
  v_mfma_f32_16x16x32_bf16 v[204:207], v[56:59], a[204:207], v[204:207]
  s_waitcnt lgkmcnt(0)
  v_mfma_f32_16x16x32_bf16 v[220:223], v[60:63], a[204:207], v[220:223]
  s_cbranch_scc1 fa_qskip0
  s_waitcnt vmcnt(15)
fa_qskip0:
  buffer_load_dwordx4 a[204:207], v2, s[32:35], s67 offen offset:0 sc1
  v_mfma_f32_16x16x32_bf16 v[96:99], v[64:67], a[208:211], v[96:99]
  s_barrier
  v_mfma_f32_16x16x32_bf16 v[112:115], v[68:71], a[208:211], v[112:115]
  ds_read_b64_tr_b16 v[32:33], v12 offset:32768
  v_mfma_f32_16x16x32_bf16 v[128:131], v[72:75], a[208:211], v[128:131]
  s_bitcmp1_b32 0x1a, s29
  ds_read_b64_tr_b16 v[34:35], v12 offset:33792
  v_mfma_f32_16x16x32_bf16 v[144:147], v[76:79], a[208:211], v[144:147]
  s_cbranch_scc1 fa_qstub
fa_qback:
  ds_read_b64_tr_b16 v[36:37], v13 offset:32768
  v_mfma_f32_16x16x32_bf16 v[160:163], v[80:83], a[208:211], v[160:163]
  ds_read_b64_tr_b16 v[38:39], v13 offset:33792
  v_mfma_f32_16x16x32_bf16 v[176:179], v[84:87], a[208:211], v[176:179]
  ds_read_b64_tr_b16 v[40:41], v12 offset:33024
  v_mfma_f32_16x16x32_bf16 v[192:195], v[88:91], a[208:211], v[192:195]
  ds_read_b64_tr_b16 v[42:43], v12 offset:34048
  v_mfma_f32_16x16x32_bf16 v[208:211], v[92:95], a[208:211], v[208:211]
  buffer_load_dwordx4 a[208:211], v2, s[32:35], s64 offen offset:1024 sc1
  v_mfma_f32_16x16x32_bf16 v[100:103], v[64:67], a[212:215], v[100:103]
  ds_read_b64_tr_b16 v[44:45], v13 offset:33024
  v_mfma_f32_16x16x32_bf16 v[116:119], v[68:71], a[212:215], v[116:119]
  ds_read_b64_tr_b16 v[46:47], v13 offset:34048
  v_mfma_f32_16x16x32_bf16 v[132:135], v[72:75], a[212:215], v[132:135]
  s_add_u32 m0, s24, 16384
  ds_read_b64_tr_b16 v[48:49], v12 offset:33280
  v_mfma_f32_16x16x32_bf16 v[148:151], v[76:79], a[212:215], v[148:151]
  buffer_load_dwordx4 v8, s[36:39], s27 offen offset:0 lds
  v_mfma_f32_16x16x32_bf16 v[164:167], v[80:83], a[212:215], v[164:167]
  ds_read_b64_tr_b16 v[50:51], v12 offset:34304
  v_mfma_f32_16x16x32_bf16 v[180:183], v[84:87], a[212:215], v[180:183]
  ds_read_b64_tr_b16 v[52:53], v13 offset:33280
  v_mfma_f32_16x16x32_bf16 v[196:199], v[88:91], a[212:215], v[196:199]
  ds_read_b64_tr_b16 v[54:55], v13 offset:34304
  v_mfma_f32_16x16x32_bf16 v[212:215], v[92:95], a[212:215], v[212:215]
  buffer_load_dwordx4 a[212:215], v2, s[32:35], s65 offen offset:1024 sc1
  v_mfma_f32_16x16x32_bf16 v[104:107], v[64:67], a[216:219], v[104:107]
  ds_read_b64_tr_b16 v[56:57], v12 offset:33536
  v_mfma_f32_16x16x32_bf16 v[120:123], v[68:71], a[216:219], v[120:123]
  ds_read_b64_tr_b16 v[58:59], v12 offset:34560
  v_mfma_f32_16x16x32_bf16 v[136:139], v[72:75], a[216:219], v[136:139]
  ds_read_b64_tr_b16 v[60:61], v13 offset:33536
  v_mfma_f32_16x16x32_bf16 v[152:155], v[76:79], a[216:219], v[152:155]
  buffer_load_dwordx4 v9, s[36:39], s27 offen offset:1024 lds
  v_mfma_f32_16x16x32_bf16 v[168:171], v[80:83], a[216:219], v[168:171]
  ds_read_b64_tr_b16 v[62:63], v13 offset:34560
  v_mfma_f32_16x16x32_bf16 v[184:187], v[84:87], a[216:219], v[184:187]
  v_mfma_f32_16x16x32_bf16 v[200:203], v[88:91], a[216:219], v[200:203]
  buffer_load_dwordx4 v10, s[36:39], s27 offen offset:2048 lds
  v_mfma_f32_16x16x32_bf16 v[216:219], v[92:95], a[216:219], v[216:219]
  buffer_load_dwordx4 a[216:219], v2, s[32:35], s66 offen offset:1024 sc1
  v_mfma_f32_16x16x32_bf16 v[108:111], v[64:67], a[220:223], v[108:111]
  v_mfma_f32_16x16x32_bf16 v[124:127], v[68:71], a[220:223], v[124:127]
  buffer_load_dwordx4 v11, s[36:39], s27 offen offset:3072 lds
  v_mfma_f32_16x16x32_bf16 v[140:143], v[72:75], a[220:223], v[140:143]
  s_add_u32 s27, s27, 524288
  v_mfma_f32_16x16x32_bf16 v[156:159], v[76:79], a[220:223], v[156:159]
  s_add_u32 s24, s24, 32768
  v_mfma_f32_16x16x32_bf16 v[172:175], v[80:83], a[220:223], v[172:175]
  s_and_b32 s24, s24, 0x1ffff
  v_mfma_f32_16x16x32_bf16 v[188:191], v[84:87], a[220:223], v[188:191]
  s_cmp_eq_u32 s29, 0
  v_mfma_f32_16x16x32_bf16 v[204:207], v[88:91], a[220:223], v[204:207]
  s_waitcnt lgkmcnt(0)
  v_mfma_f32_16x16x32_bf16 v[220:223], v[92:95], a[220:223], v[220:223]
  s_cbranch_scc1 fa_qskip1
  s_waitcnt vmcnt(19)
fa_qskip1:
  buffer_load_dwordx4 a[220:223], v2, s[32:35], s67 offen offset:1024 sc1
  v_mfma_f32_16x16x32_bf16 v[96:99], v[32:35], a[224:227], v[96:99]
  v_mfma_f32_16x16x32_bf16 v[112:115], v[36:39], a[224:227], v[112:115]
  ds_read_b64_tr_b16 v[64:65], v12 offset:40960
  v_mfma_f32_16x16x32_bf16 v[128:131], v[40:43], a[224:227], v[128:131]
  ds_read_b64_tr_b16 v[66:67], v12 offset:41984
  v_mfma_f32_16x16x32_bf16 v[144:147], v[44:47], a[224:227], v[144:147]
  ds_read_b64_tr_b16 v[68:69], v13 offset:40960
  v_mfma_f32_16x16x32_bf16 v[160:163], v[48:51], a[224:227], v[160:163]
  ds_read_b64_tr_b16 v[70:71], v13 offset:41984
  v_mfma_f32_16x16x32_bf16 v[176:179], v[52:55], a[224:227], v[176:179]
  ds_read_b64_tr_b16 v[72:73], v12 offset:41216
  v_mfma_f32_16x16x32_bf16 v[192:195], v[56:59], a[224:227], v[192:195]
  ds_read_b64_tr_b16 v[74:75], v12 offset:42240
  v_mfma_f32_16x16x32_bf16 v[208:211], v[60:63], a[224:227], v[208:211]
  buffer_load_dwordx4 a[224:227], v2, s[32:35], s64 offen offset:2048 sc1
  v_mfma_f32_16x16x32_bf16 v[100:103], v[32:35], a[228:231], v[100:103]
  ds_read_b64_tr_b16 v[76:77], v13 offset:41216
  v_mfma_f32_16x16x32_bf16 v[116:119], v[36:39], a[228:231], v[116:119]
  ds_read_b64_tr_b16 v[78:79], v13 offset:42240
  v_mfma_f32_16x16x32_bf16 v[132:135], v[40:43], a[228:231], v[132:135]
  ds_read_b64_tr_b16 v[80:81], v12 offset:41472
  v_mfma_f32_16x16x32_bf16 v[148:151], v[44:47], a[228:231], v[148:151]
  v_mfma_f32_16x16x32_bf16 v[164:167], v[48:51], a[228:231], v[164:167]
  ds_read_b64_tr_b16 v[82:83], v12 offset:42496
  v_mfma_f32_16x16x32_bf16 v[180:183], v[52:55], a[228:231], v[180:183]
  ds_read_b64_tr_b16 v[84:85], v13 offset:41472
  v_mfma_f32_16x16x32_bf16 v[196:199], v[56:59], a[228:231], v[196:199]
  ds_read_b64_tr_b16 v[86:87], v13 offset:42496
  v_mfma_f32_16x16x32_bf16 v[212:215], v[60:63], a[228:231], v[212:215]
  buffer_load_dwordx4 a[228:231], v2, s[32:35], s65 offen offset:2048 sc1
  v_mfma_f32_16x16x32_bf16 v[104:107], v[32:35], a[232:235], v[104:107]
  ds_read_b64_tr_b16 v[88:89], v12 offset:41728
  v_mfma_f32_16x16x32_bf16 v[120:123], v[36:39], a[232:235], v[120:123]
  ds_read_b64_tr_b16 v[90:91], v12 offset:42752
  v_mfma_f32_16x16x32_bf16 v[136:139], v[40:43], a[232:235], v[136:139]
  ds_read_b64_tr_b16 v[92:93], v13 offset:41728
  v_mfma_f32_16x16x32_bf16 v[152:155], v[44:47], a[232:235], v[152:155]
  v_mfma_f32_16x16x32_bf16 v[168:171], v[48:51], a[232:235], v[168:171]
  ds_read_b64_tr_b16 v[94:95], v13 offset:42752
  v_mfma_f32_16x16x32_bf16 v[184:187], v[52:55], a[232:235], v[184:187]
  v_mfma_f32_16x16x32_bf16 v[200:203], v[56:59], a[232:235], v[200:203]
  v_mfma_f32_16x16x32_bf16 v[216:219], v[60:63], a[232:235], v[216:219]
  buffer_load_dwordx4 a[232:235], v2, s[32:35], s66 offen offset:2048 sc1
  v_mfma_f32_16x16x32_bf16 v[108:111], v[32:35], a[236:239], v[108:111]
  v_xor_b32 v12, 0x10000, v12
  v_mfma_f32_16x16x32_bf16 v[124:127], v[36:39], a[236:239], v[124:127]
  v_xor_b32 v13, 0x10000, v13
  v_mfma_f32_16x16x32_bf16 v[140:143], v[40:43], a[236:239], v[140:143]
  v_mfma_f32_16x16x32_bf16 v[156:159], v[44:47], a[236:239], v[156:159]
  v_mfma_f32_16x16x32_bf16 v[172:175], v[48:51], a[236:239], v[172:175]
  v_mfma_f32_16x16x32_bf16 v[188:191], v[52:55], a[236:239], v[188:191]
  s_cmp_eq_u32 s29, 0
  v_mfma_f32_16x16x32_bf16 v[204:207], v[56:59], a[236:239], v[204:207]
  s_waitcnt lgkmcnt(0)
  v_mfma_f32_16x16x32_bf16 v[220:223], v[60:63], a[236:239], v[220:223]
  s_cbranch_scc1 fa_qskip2
  s_waitcnt vmcnt(15)
fa_qskip2:
  buffer_load_dwordx4 a[236:239], v2, s[32:35], s67 offen offset:2048 sc1
  v_mfma_f32_16x16x32_bf16 v[96:99], v[64:67], a[240:243], v[96:99]
  s_barrier
  v_mfma_f32_16x16x32_bf16 v[112:115], v[68:71], a[240:243], v[112:115]
  ds_read_b64_tr_b16 v[32:33], v12 offset:0
  v_mfma_f32_16x16x32_bf16 v[128:131], v[72:75], a[240:243], v[128:131]
  ds_read_b64_tr_b16 v[34:35], v12 offset:1024
  v_mfma_f32_16x16x32_bf16 v[144:147], v[76:79], a[240:243], v[144:147]
  ds_read_b64_tr_b16 v[36:37], v13 offset:0
  v_mfma_f32_16x16x32_bf16 v[160:163], v[80:83], a[240:243], v[160:163]
  s_add_u32 s29, s29, 1
  ds_read_b64_tr_b16 v[38:39], v13 offset:1024
  v_mfma_f32_16x16x32_bf16 v[176:179], v[84:87], a[240:243], v[176:179]
  ds_read_b64_tr_b16 v[40:41], v12 offset:256
  v_mfma_f32_16x16x32_bf16 v[192:195], v[88:91], a[240:243], v[192:195]
  ds_read_b64_tr_b16 v[42:43], v12 offset:1280
  v_mfma_f32_16x16x32_bf16 v[208:211], v[92:95], a[240:243], v[208:211]
  buffer_load_dwordx4 a[240:243], v2, s[32:35], s64 offen offset:3072 sc1
  v_mfma_f32_16x16x32_bf16 v[100:103], v[64:67], a[244:247], v[100:103]
  s_add_u32 s64, s64, 4096
  ds_read_b64_tr_b16 v[44:45], v13 offset:256
  v_mfma_f32_16x16x32_bf16 v[116:119], v[68:71], a[244:247], v[116:119]
  ds_read_b64_tr_b16 v[46:47], v13 offset:1280
  v_mfma_f32_16x16x32_bf16 v[132:135], v[72:75], a[244:247], v[132:135]
  s_add_u32 m0, s24, 16384
  ds_read_b64_tr_b16 v[48:49], v12 offset:512
  v_mfma_f32_16x16x32_bf16 v[148:151], v[76:79], a[244:247], v[148:151]
  buffer_load_dwordx4 v8, s[36:39], s27 offen offset:0 lds
  v_mfma_f32_16x16x32_bf16 v[164:167], v[80:83], a[244:247], v[164:167]
  ds_read_b64_tr_b16 v[50:51], v12 offset:1536
  v_mfma_f32_16x16x32_bf16 v[180:183], v[84:87], a[244:247], v[180:183]
  ds_read_b64_tr_b16 v[52:53], v13 offset:512
  v_mfma_f32_16x16x32_bf16 v[196:199], v[88:91], a[244:247], v[196:199]
  ds_read_b64_tr_b16 v[54:55], v13 offset:1536
  v_mfma_f32_16x16x32_bf16 v[212:215], v[92:95], a[244:247], v[212:215]
  buffer_load_dwordx4 a[244:247], v2, s[32:35], s65 offen offset:3072 sc1
  v_mfma_f32_16x16x32_bf16 v[104:107], v[64:67], a[248:251], v[104:107]
  s_add_u32 s65, s65, 4096
  ds_read_b64_tr_b16 v[56:57], v12 offset:768
  v_mfma_f32_16x16x32_bf16 v[120:123], v[68:71], a[248:251], v[120:123]
  ds_read_b64_tr_b16 v[58:59], v12 offset:1792
  v_mfma_f32_16x16x32_bf16 v[136:139], v[72:75], a[248:251], v[136:139]
  ds_read_b64_tr_b16 v[60:61], v13 offset:768
  v_mfma_f32_16x16x32_bf16 v[152:155], v[76:79], a[248:251], v[152:155]
  buffer_load_dwordx4 v9, s[36:39], s27 offen offset:1024 lds
  v_mfma_f32_16x16x32_bf16 v[168:171], v[80:83], a[248:251], v[168:171]
  ds_read_b64_tr_b16 v[62:63], v13 offset:1792
  v_mfma_f32_16x16x32_bf16 v[184:187], v[84:87], a[248:251], v[184:187]
  v_mfma_f32_16x16x32_bf16 v[200:203], v[88:91], a[248:251], v[200:203]
  buffer_load_dwordx4 v10, s[36:39], s27 offen offset:2048 lds
  v_mfma_f32_16x16x32_bf16 v[216:219], v[92:95], a[248:251], v[216:219]
  buffer_load_dwordx4 a[248:251], v2, s[32:35], s66 offen offset:3072 sc1
  v_mfma_f32_16x16x32_bf16 v[108:111], v[64:67], a[252:255], v[108:111]
  s_add_u32 s66, s66, 4096
  v_mfma_f32_16x16x32_bf16 v[124:127], v[68:71], a[252:255], v[124:127]
  buffer_load_dwordx4 v11, s[36:39], s27 offen offset:3072 lds
  v_mfma_f32_16x16x32_bf16 v[140:143], v[72:75], a[252:255], v[140:143]
  s_add_u32 s27, s27, 524288
  v_mfma_f32_16x16x32_bf16 v[156:159], v[76:79], a[252:255], v[156:159]
  s_add_u32 s24, s24, 32768
  v_mfma_f32_16x16x32_bf16 v[172:175], v[80:83], a[252:255], v[172:175]
  s_and_b32 s24, s24, 0x1ffff
  v_mfma_f32_16x16x32_bf16 v[188:191], v[84:87], a[252:255], v[188:191]
  v_mfma_f32_16x16x32_bf16 v[204:207], v[88:91], a[252:255], v[204:207]
  v_mfma_f32_16x16x32_bf16 v[220:223], v[92:95], a[252:255], v[220:223]
  s_waitcnt vmcnt(19) lgkmcnt(0)
  buffer_load_dwordx4 a[252:255], v2, s[32:35], s67 offen offset:3072 sc1
  s_add_u32 s67, s67, 4096
  s_cmp_ge_u32 s29, 4
  s_cselect_b32 s34, 0, s34
  s_cmp_lt_u32 s29, 5
  s_cbranch_scc1 fa_qloop
  s_waitcnt vmcnt(0)
  s_barrier
  s_mov_b32 s24, s60
  s_mov_b32 s26, s61
  s_lshl_b32 s27, s20, 12
  s_add_u32 s25, s27, 49152
  v_add_u32 v18, 106496, v2
  s_mov_b32 m0, s25
  s_nop 0
  buffer_load_dwordx4 v2, s[48:51], s27 offen offset:0 sc1 lds
  buffer_load_dwordx4 v2, s[48:51], s27 offen offset:1024 sc1 lds
  buffer_load_dwordx4 v2, s[48:51], s27 offen offset:2048 sc1 lds
  buffer_load_dwordx4 v2, s[48:51], s27 offen offset:3072 sc1 lds
  s_add_u32 s27, s27, 16384
  s_add_u32 s25, s25, 32768
  s_and_b32 s25, s25, 0x1ffff
  s_mov_b32 m0, s25
  s_nop 0
  buffer_load_dwordx4 v2, s[48:51], s27 offen offset:0 sc1 lds
  buffer_load_dwordx4 v2, s[48:51], s27 offen offset:1024 sc1 lds
  buffer_load_dwordx4 v2, s[48:51], s27 offen offset:2048 sc1 lds
  buffer_load_dwordx4 v2, s[48:51], s27 offen offset:3072 sc1 lds
  s_add_u32 s27, s27, 16384
  s_add_u32 s25, s25, 32768
  s_and_b32 s25, s25, 0x1ffff
  ds_read_b128 a[128:131], v18 offset:0
  ds_read_b128 a[132:135], v18 offset:1024
  ds_read_b128 a[136:139], v18 offset:2048
  ds_read_b128 a[140:143], v18 offset:3072
  ds_read_b128 a[144:147], v18 offset:4096
  ds_read_b128 a[148:151], v18 offset:5120
  ds_read_b128 a[152:155], v18 offset:6144
  ds_read_b128 a[156:159], v18 offset:7168
  s_cmp_lt_u32 s2, 192
  s_cbranch_scc1 fa_noxs
  v_and_b32 v228, 2047, v228
  v_lshrrev_b32 v16, 4, v228
  v_mul_u32_u24 v16, 20480, v16
  v_and_b32 v17, 15, v228
  v_lshl_add_u32 v16, v17, 4, v16
  v_lshrrev_b32 v17, 4, v1
  v_lshl_add_u32 v16, v17, 8, v16
  s_mul_i32 s23, s20, 5120
  s_add_u32 m0, s23, 131072
  s_add_u32 s31, s23, 4096
  buffer_load_dwordx4 v16, s[40:43], s23 offen offset:0 sc1 lds
  buffer_load_dwordx4 v16, s[40:43], s23 offen offset:1024 sc1 lds
  buffer_load_dwordx4 v16, s[40:43], s23 offen offset:2048 sc1 lds
  buffer_load_dwordx4 v16, s[40:43], s23 offen offset:3072 sc1 lds
  s_add_u32 m0, s31, 131072
  s_nop 0
  buffer_load_dwordx4 v16, s[40:43], s31 offen sc1 lds
  s_load_dwordx4 s[4:7], s[0:1], 64
  s_load_dwordx2 s[8:9], s[0:1], 80
  s_waitcnt lgkmcnt(0)
  s_mov_b32 s32, s4
  s_mov_b32 s33, s5
  s_mov_b32 s34, 2211840
  s_mov_b32 s35, 0x20000
  s_mov_b32 s36, s6
  s_mov_b32 s37, s7
  s_mov_b32 s38, 2211840
  s_mov_b32 s39, 0x20000
  s_mov_b32 s60, s8
  s_mov_b32 s61, s9
  s_mov_b32 s62, 2211840
  s_mov_b32 s63, 0x20000
  s_sub_u32 s23, s2, 192
  s_lshl_b32 s31, s23, 6
  s_mul_i32 s10, s20, 552960
  s_add_u32 s31, s31, s10
  v_mul_u32_u24 v19, 3456, v1
  s_mul_i32 s23, s23, 40960
  s_mul_i32 s10, s20, 10240
  s_add_u32 s23, s23, s10
  v_lshlrev_b32 v20, 7, v1
  buffer_load_dword v232, v19, s[32:35], s31 offen
  buffer_load_dword v233, v19, s[36:39], s31 offen
  s_add_u32 s31, s31, 221184
  buffer_load_dword v232, v19, s[32:35], s31 offen
  buffer_load_dword v233, v19, s[36:39], s31 offen
  s_add_u32 s31, s31, 110592
  buffer_load_dword v232, v19, s[32:35], s31 offen
  buffer_load_dword v233, v19, s[36:39], s31 offen
  s_add_u32 s31, s31, 110592
  buffer_load_dword v234, v20, s[60:63], s23 offen
  buffer_load_dword v235, v20, s[60:63], s23 offen offset:2048
fa_noxs:
  v_mov_b32 v16, 0x3e0293ee
  v_mov_b32 v17, 0x3e0293ee
  v_pk_mul_f32 v[96:97], v[96:97], v[16:17]
  v_pk_mul_f32 v[98:99], v[98:99], v[16:17]
  v_cvt_pk_bf16_f32 v32, v96, v97
  v_cvt_pk_bf16_f32 v33, v98, v99
  v_pk_mul_f32 v[112:113], v[112:113], v[16:17]
  v_pk_mul_f32 v[114:115], v[114:115], v[16:17]
  v_cvt_pk_bf16_f32 v34, v112, v113
  v_cvt_pk_bf16_f32 v35, v114, v115
  v_pk_mul_f32 v[100:101], v[100:101], v[16:17]
  v_pk_mul_f32 v[102:103], v[102:103], v[16:17]
  v_cvt_pk_bf16_f32 v36, v100, v101
  v_cvt_pk_bf16_f32 v37, v102, v103
  v_pk_mul_f32 v[116:117], v[116:117], v[16:17]
  v_pk_mul_f32 v[118:119], v[118:119], v[16:17]
  v_cvt_pk_bf16_f32 v38, v116, v117
  v_cvt_pk_bf16_f32 v39, v118, v119
  v_pk_mul_f32 v[128:129], v[128:129], v[16:17]
  v_pk_mul_f32 v[130:131], v[130:131], v[16:17]
  v_cvt_pk_bf16_f32 v40, v128, v129
  v_cvt_pk_bf16_f32 v41, v130, v131
  v_pk_mul_f32 v[144:145], v[144:145], v[16:17]
  v_pk_mul_f32 v[146:147], v[146:147], v[16:17]
  v_cvt_pk_bf16_f32 v42, v144, v145
  v_cvt_pk_bf16_f32 v43, v146, v147
  v_pk_mul_f32 v[132:133], v[132:133], v[16:17]
  v_pk_mul_f32 v[134:135], v[134:135], v[16:17]
  v_cvt_pk_bf16_f32 v44, v132, v133
  v_cvt_pk_bf16_f32 v45, v134, v135
  v_pk_mul_f32 v[148:149], v[148:149], v[16:17]
  v_pk_mul_f32 v[150:151], v[150:151], v[16:17]
  v_cvt_pk_bf16_f32 v46, v148, v149
  v_cvt_pk_bf16_f32 v47, v150, v151
  v_pk_mul_f32 v[160:161], v[160:161], v[16:17]
  v_pk_mul_f32 v[162:163], v[162:163], v[16:17]
  v_cvt_pk_bf16_f32 v48, v160, v161
  v_cvt_pk_bf16_f32 v49, v162, v163
  v_pk_mul_f32 v[176:177], v[176:177], v[16:17]
  v_pk_mul_f32 v[178:179], v[178:179], v[16:17]
  v_cvt_pk_bf16_f32 v50, v176, v177
  v_cvt_pk_bf16_f32 v51, v178, v179
  v_pk_mul_f32 v[164:165], v[164:165], v[16:17]
  v_pk_mul_f32 v[166:167], v[166:167], v[16:17]
  v_cvt_pk_bf16_f32 v52, v164, v165
  v_cvt_pk_bf16_f32 v53, v166, v167
  v_pk_mul_f32 v[180:181], v[180:181], v[16:17]
  v_pk_mul_f32 v[182:183], v[182:183], v[16:17]
  v_cvt_pk_bf16_f32 v54, v180, v181
  v_cvt_pk_bf16_f32 v55, v182, v183
  v_pk_mul_f32 v[192:193], v[192:193], v[16:17]
  v_pk_mul_f32 v[194:195], v[194:195], v[16:17]
  v_cvt_pk_bf16_f32 v56, v192, v193
  v_cvt_pk_bf16_f32 v57, v194, v195
  v_pk_mul_f32 v[208:209], v[208:209], v[16:17]
  v_pk_mul_f32 v[210:211], v[210:211], v[16:17]
  v_cvt_pk_bf16_f32 v58, v208, v209
  v_cvt_pk_bf16_f32 v59, v210, v211
  v_pk_mul_f32 v[196:197], v[196:197], v[16:17]
  v_pk_mul_f32 v[198:199], v[198:199], v[16:17]
  v_cvt_pk_bf16_f32 v60, v196, v197
  v_cvt_pk_bf16_f32 v61, v198, v199
  v_pk_mul_f32 v[212:213], v[212:213], v[16:17]
  v_pk_mul_f32 v[214:215], v[214:215], v[16:17]
  v_cvt_pk_bf16_f32 v62, v212, v213
  v_cvt_pk_bf16_f32 v63, v214, v215
  v_pk_mul_f32 v[104:105], v[104:105], v[16:17]
  v_pk_mul_f32 v[106:107], v[106:107], v[16:17]
  v_cvt_pk_bf16_f32 v64, v104, v105
  v_cvt_pk_bf16_f32 v65, v106, v107
  v_pk_mul_f32 v[120:121], v[120:121], v[16:17]
  v_pk_mul_f32 v[122:123], v[122:123], v[16:17]
  v_cvt_pk_bf16_f32 v66, v120, v121
  v_cvt_pk_bf16_f32 v67, v122, v123
  v_pk_mul_f32 v[108:109], v[108:109], v[16:17]
  v_pk_mul_f32 v[110:111], v[110:111], v[16:17]
  v_cvt_pk_bf16_f32 v68, v108, v109
  v_cvt_pk_bf16_f32 v69, v110, v111
  v_pk_mul_f32 v[124:125], v[124:125], v[16:17]
  v_pk_mul_f32 v[126:127], v[126:127], v[16:17]
  v_cvt_pk_bf16_f32 v70, v124, v125
  v_cvt_pk_bf16_f32 v71, v126, v127
  v_pk_mul_f32 v[136:137], v[136:137], v[16:17]
  v_pk_mul_f32 v[138:139], v[138:139], v[16:17]
  v_cvt_pk_bf16_f32 v72, v136, v137
  v_cvt_pk_bf16_f32 v73, v138, v139
  v_pk_mul_f32 v[152:153], v[152:153], v[16:17]
  v_pk_mul_f32 v[154:155], v[154:155], v[16:17]
  v_cvt_pk_bf16_f32 v74, v152, v153
  v_cvt_pk_bf16_f32 v75, v154, v155
  v_pk_mul_f32 v[140:141], v[140:141], v[16:17]
  v_pk_mul_f32 v[142:143], v[142:143], v[16:17]
  v_cvt_pk_bf16_f32 v76, v140, v141
  v_cvt_pk_bf16_f32 v77, v142, v143
  v_pk_mul_f32 v[156:157], v[156:157], v[16:17]
  v_pk_mul_f32 v[158:159], v[158:159], v[16:17]
  v_cvt_pk_bf16_f32 v78, v156, v157
  v_cvt_pk_bf16_f32 v79, v158, v159
  v_pk_mul_f32 v[168:169], v[168:169], v[16:17]
  v_pk_mul_f32 v[170:171], v[170:171], v[16:17]
  v_cvt_pk_bf16_f32 v80, v168, v169
  v_cvt_pk_bf16_f32 v81, v170, v171
  v_pk_mul_f32 v[184:185], v[184:185], v[16:17]
  v_pk_mul_f32 v[186:187], v[186:187], v[16:17]
  v_cvt_pk_bf16_f32 v82, v184, v185
  v_cvt_pk_bf16_f32 v83, v186, v187
  v_pk_mul_f32 v[172:173], v[172:173], v[16:17]
  v_pk_mul_f32 v[174:175], v[174:175], v[16:17]
  v_cvt_pk_bf16_f32 v84, v172, v173
  v_cvt_pk_bf16_f32 v85, v174, v175
  v_pk_mul_f32 v[188:189], v[188:189], v[16:17]
  v_pk_mul_f32 v[190:191], v[190:191], v[16:17]
  v_cvt_pk_bf16_f32 v86, v188, v189
  v_cvt_pk_bf16_f32 v87, v190, v191
  v_pk_mul_f32 v[200:201], v[200:201], v[16:17]
  v_pk_mul_f32 v[202:203], v[202:203], v[16:17]
  v_cvt_pk_bf16_f32 v88, v200, v201
  v_cvt_pk_bf16_f32 v89, v202, v203
  v_pk_mul_f32 v[216:217], v[216:217], v[16:17]
  v_pk_mul_f32 v[218:219], v[218:219], v[16:17]
  v_cvt_pk_bf16_f32 v90, v216, v217
  v_cvt_pk_bf16_f32 v91, v218, v219
  v_pk_mul_f32 v[204:205], v[204:205], v[16:17]
  v_pk_mul_f32 v[206:207], v[206:207], v[16:17]
  v_cvt_pk_bf16_f32 v92, v204, v205
  v_cvt_pk_bf16_f32 v93, v206, v207
  v_pk_mul_f32 v[220:221], v[220:221], v[16:17]
  v_pk_mul_f32 v[222:223], v[222:223], v[16:17]
  v_cvt_pk_bf16_f32 v94, v220, v221
  v_cvt_pk_bf16_f32 v95, v222, v223
  v_mov_b32 v228, 0
  v_mov_b32 v229, 0
  v_mov_b32 v230, 0
  v_mov_b32 v231, 0
  s_add_u32 s23, s20, 1
  s_lshr_b32 s23, s23, 1
  s_lshl_b32 s28, s22, 1
  s_add_u32 s28, s28, s23
  s_lshl_b32 s23, s22, 2
  s_sub_u32 s29, 28, s23
  s_and_b32 s23, s20, 1
  s_add_u32 s29, s29, s23
  v_mov_b32 v3, v2
  s_waitcnt lgkmcnt(0)
  v_mfma_f32_16x16x32_bf16 v[96:99], a[128:131], v[32:35], 0
  v_mfma_f32_16x16x32_bf16 v[104:107], a[128:131], v[36:39], 0
  v_mfma_f32_16x16x32_bf16 v[128:131], a[128:131], v[64:67], 0
  v_mfma_f32_16x16x32_bf16 v[136:139], a[128:131], v[68:71], 0
  s_mov_b32 m0, s24
  ds_read_b128 a[128:131], v3 offset:0
  v_mfma_f32_16x16x32_bf16 v[100:103], a[132:135], v[32:35], 0
  buffer_load_dwordx4 v2, s[44:47], s26 offen offset:0 sc1 lds
  v_mfma_f32_16x16x32_bf16 v[108:111], a[132:135], v[36:39], 0
  v_mfma_f32_16x16x32_bf16 v[132:135], a[132:135], v[64:67], 0
  v_mfma_f32_16x16x32_bf16 v[140:143], a[132:135], v[68:71], 0
  ds_read_b128 a[132:135], v3 offset:1024
  v_mfma_f32_16x16x32_bf16 v[96:99], a[136:139], v[40:43], v[96:99]
  v_mfma_f32_16x16x32_bf16 v[104:107], a[136:139], v[44:47], v[104:107]
  v_mfma_f32_16x16x32_bf16 v[128:131], a[136:139], v[72:75], v[128:131]
  buffer_load_dwordx4 v2, s[44:47], s26 offen offset:1024 sc1 lds
  v_mfma_f32_16x16x32_bf16 v[136:139], a[136:139], v[76:79], v[136:139]
  ds_read_b128 a[136:139], v3 offset:2048
  v_mfma_f32_16x16x32_bf16 v[100:103], a[140:143], v[40:43], v[100:103]
  v_mfma_f32_16x16x32_bf16 v[108:111], a[140:143], v[44:47], v[108:111]
  v_mfma_f32_16x16x32_bf16 v[132:135], a[140:143], v[72:75], v[132:135]
  v_mfma_f32_16x16x32_bf16 v[140:143], a[140:143], v[76:79], v[140:143]
  s_waitcnt lgkmcnt(3)
  ds_read_b128 a[140:143], v3 offset:3072
  v_mfma_f32_16x16x32_bf16 v[96:99], a[144:147], v[48:51], v[96:99]
  v_mfma_f32_16x16x32_bf16 v[104:107], a[144:147], v[52:55], v[104:107]
  v_mfma_f32_16x16x32_bf16 v[128:131], a[144:147], v[80:83], v[128:131]
  buffer_load_dwordx4 v2, s[44:47], s26 offen offset:2048 sc1 lds
  v_mfma_f32_16x16x32_bf16 v[136:139], a[144:147], v[84:87], v[136:139]
  ds_read_b128 a[144:147], v3 offset:4096
  v_mfma_f32_16x16x32_bf16 v[100:103], a[148:151], v[48:51], v[100:103]
  v_mfma_f32_16x16x32_bf16 v[108:111], a[148:151], v[52:55], v[108:111]
  v_mfma_f32_16x16x32_bf16 v[132:135], a[148:151], v[80:83], v[132:135]
  v_mfma_f32_16x16x32_bf16 v[140:143], a[148:151], v[84:87], v[140:143]
  ds_read_b128 a[148:151], v3 offset:5120
  v_mfma_f32_16x16x32_bf16 v[96:99], a[152:155], v[56:59], v[96:99]
  buffer_load_dwordx4 v2, s[44:47], s26 offen offset:3072 sc1 lds
  v_mfma_f32_16x16x32_bf16 v[104:107], a[152:155], v[60:63], v[104:107]
  s_add_u32 s26, s26, 16384
  v_mfma_f32_16x16x32_bf16 v[128:131], a[152:155], v[88:91], v[128:131]
  s_add_u32 s24, s24, 32768
  v_mfma_f32_16x16x32_bf16 v[136:139], a[152:155], v[92:95], v[136:139]
  s_and_b32 s24, s24, 0x1ffff
  ds_read_b128 a[152:155], v3 offset:6144
  v_mfma_f32_16x16x32_bf16 v[100:103], a[156:159], v[56:59], v[100:103]
  v_mfma_f32_16x16x32_bf16 v[108:111], a[156:159], v[60:63], v[108:111]
  v_mfma_f32_16x16x32_bf16 v[132:135], a[156:159], v[88:91], v[132:135]
  v_mfma_f32_16x16x32_bf16 v[140:143], a[156:159], v[92:95], v[140:143]
  s_waitcnt lgkmcnt(3)
  ds_read_b128 a[156:159], v3 offset:7168
  s_nop 7
  s_cmp_lg_u32 s28, 0
  s_cbranch_scc1 fa_nomask0
  v_cndmask_b32 v96, v4, v96, s[68:69]
  v_cndmask_b32 v97, v4, v97, s[70:71]
  v_cndmask_b32 v98, v4, v98, s[72:73]
  v_cndmask_b32 v99, v4, v99, s[74:75]
  v_mov_b32 v100, v4
  v_mov_b32 v101, v4
  v_mov_b32 v102, v4
  v_mov_b32 v103, v4
  v_cndmask_b32 v108, v4, v108, s[68:69]
  v_cndmask_b32 v109, v4, v109, s[70:71]
  v_cndmask_b32 v110, v4, v110, s[72:73]
  v_cndmask_b32 v111, v4, v111, s[74:75]
fa_nomask0:
  v_max3_f32 v16, v96, v97, v98
  v_max3_f32 v16, v16, v99, v100
  v_max3_f32 v16, v16, v101, v102
  v_max_f32 v16, v16, v103
  v_max3_f32 v17, v104, v105, v106
  v_max3_f32 v17, v17, v107, v108
  v_max3_f32 v17, v17, v109, v110
  v_max_f32 v17, v17, v111
  v_max3_f32 v18, v128, v129, v130
  v_max3_f32 v18, v18, v131, v132
  v_max3_f32 v18, v18, v133, v134
  v_max_f32 v18, v18, v135
  v_max3_f32 v19, v136, v137, v138
  v_max3_f32 v19, v19, v139, v140
  v_max3_f32 v19, v19, v141, v142
  v_max_f32 v19, v19, v143
  v_mov_b32 v20, v16
  v_mov_b32 v21, v17
  v_mov_b32 v22, v18
  v_mov_b32 v23, v19
  s_nop 0
  v_permlane16_swap_b32 v16, v20
  v_permlane16_swap_b32 v17, v21
  v_permlane16_swap_b32 v18, v22
  v_permlane16_swap_b32 v19, v23
  v_max_f32 v16, v16, v20
  v_max_f32 v17, v17, v21
  v_max_f32 v18, v18, v22
  v_max_f32 v19, v19, v23
  v_mov_b32 v20, v16
  v_mov_b32 v21, v17
  v_mov_b32 v22, v18
  v_mov_b32 v23, v19
  s_nop 0
  v_permlane32_swap_b32 v16, v20
  v_permlane32_swap_b32 v17, v21
  v_permlane32_swap_b32 v18, v22
  v_permlane32_swap_b32 v19, v23
  v_max_f32 v16, v16, v20
  v_max_f32 v17, v17, v21
  v_max_f32 v18, v18, v22
  v_max_f32 v19, v19, v23
  v_sub_f32 v192, 0, v16
  v_sub_f32 v193, 0, v16
  v_sub_f32 v194, 0, v16
  v_sub_f32 v195, 0, v16
  v_sub_f32 v196, 0, v17
  v_sub_f32 v197, 0, v17
  v_sub_f32 v198, 0, v17
  v_sub_f32 v199, 0, v17
  v_sub_f32 v200, 0, v18
  v_sub_f32 v201, 0, v18
  v_sub_f32 v202, 0, v18
  v_sub_f32 v203, 0, v18
  v_sub_f32 v204, 0, v19
  v_sub_f32 v205, 0, v19
  v_sub_f32 v206, 0, v19
  v_sub_f32 v207, 0, v19
  v_sub_f32 v96, v96, v16
  v_sub_f32 v97, v97, v16
  v_sub_f32 v98, v98, v16
  v_sub_f32 v99, v99, v16
  v_sub_f32 v100, v100, v16
  v_sub_f32 v101, v101, v16
  v_sub_f32 v102, v102, v16
  v_sub_f32 v103, v103, v16
  v_sub_f32 v104, v104, v17
  v_sub_f32 v105, v105, v17
  v_sub_f32 v106, v106, v17
  v_sub_f32 v107, v107, v17
  v_sub_f32 v108, v108, v17
  v_sub_f32 v109, v109, v17
  v_sub_f32 v110, v110, v17
  v_sub_f32 v111, v111, v17
  v_sub_f32 v128, v128, v18
  v_sub_f32 v129, v129, v18
  v_sub_f32 v130, v130, v18
  v_sub_f32 v131, v131, v18
  v_sub_f32 v132, v132, v18
  v_sub_f32 v133, v133, v18
  v_sub_f32 v134, v134, v18
  v_sub_f32 v135, v135, v18
  v_sub_f32 v136, v136, v19
  v_sub_f32 v137, v137, v19
  v_sub_f32 v138, v138, v19
  v_sub_f32 v139, v139, v19
  v_sub_f32 v140, v140, v19
  v_sub_f32 v141, v141, v19
  v_sub_f32 v142, v142, v19
  v_sub_f32 v143, v143, v19
  v_mfma_f32_16x16x32_bf16 v[112:115], a[128:131], v[32:35], v[192:195]
  v_exp_f32 v208, v96
  v_exp_f32 v209, v97
  v_mfma_f32_16x16x32_bf16 v[120:123], a[128:131], v[36:39], v[196:199]
  v_exp_f32 v210, v98
  v_exp_f32 v211, v99
  v_mfma_f32_16x16x32_bf16 v[144:147], a[128:131], v[64:67], v[200:203]
  v_exp_f32 v212, v100
  v_exp_f32 v213, v101
  v_mfma_f32_16x16x32_bf16 v[152:155], a[128:131], v[68:71], v[204:207]
  s_mov_b32 m0, s25
  ds_read_b128 a[128:131], v3 offset:8192
  v_exp_f32 v214, v102
  v_add_f32 v224, v208, v209
  v_mfma_f32_16x16x32_bf16 v[116:119], a[132:135], v[32:35], v[192:195]
  buffer_load_dwordx4 v2, s[48:51], s27 offen offset:0 sc1 lds
  v_exp_f32 v215, v103
  v_cvt_pk_bf16_f32 v160, v208, v209
  v_mfma_f32_16x16x32_bf16 v[124:127], a[132:135], v[36:39], v[196:199]
  v_exp_f32 v208, v104
  v_add_f32 v224, v224, v210
  v_add_f32 v224, v224, v211
  v_mfma_f32_16x16x32_bf16 v[148:151], a[132:135], v[64:67], v[200:203]
  v_exp_f32 v209, v105
  v_cvt_pk_bf16_f32 v161, v210, v211
  v_add_f32 v224, v224, v212
  v_mfma_f32_16x16x32_bf16 v[156:159], a[132:135], v[68:71], v[204:207]
  ds_read_b128 a[132:135], v3 offset:9216
  v_exp_f32 v210, v106
  v_mfma_f32_16x16x32_bf16 v[112:115], a[136:139], v[40:43], v[112:115]
  v_exp_f32 v211, v107
  v_add_f32 v224, v224, v213
  v_cvt_pk_bf16_f32 v162, v212, v213
  v_mfma_f32_16x16x32_bf16 v[120:123], a[136:139], v[44:47], v[120:123]
  v_exp_f32 v212, v108
  v_add_f32 v224, v224, v214
  v_add_f32 v224, v224, v215
  v_mfma_f32_16x16x32_bf16 v[144:147], a[136:139], v[72:75], v[144:147]
  buffer_load_dwordx4 v2, s[48:51], s27 offen offset:1024 sc1 lds
  v_exp_f32 v213, v109
  v_cvt_pk_bf16_f32 v163, v214, v215
  v_mfma_f32_16x16x32_bf16 v[152:155], a[136:139], v[76:79], v[152:155]
  ds_read_b128 a[136:139], v3 offset:10240
  v_exp_f32 v214, v110
  v_add_f32 v225, v208, v209
  v_mfma_f32_16x16x32_bf16 v[116:119], a[140:143], v[40:43], v[116:119]
  v_exp_f32 v215, v111
  v_exp_f32 v216, v128
  v_mfma_f32_16x16x32_bf16 v[124:127], a[140:143], v[44:47], v[124:127]
  v_exp_f32 v217, v129
  v_exp_f32 v218, v130
  v_mfma_f32_16x16x32_bf16 v[148:151], a[140:143], v[72:75], v[148:151]
  v_exp_f32 v219, v131
  v_exp_f32 v220, v132
  v_mfma_f32_16x16x32_bf16 v[156:159], a[140:143], v[76:79], v[156:159]
  s_waitcnt lgkmcnt(3)
  ds_read_b128 a[140:143], v3 offset:11264
  v_exp_f32 v221, v133
  v_cvt_pk_bf16_f32 v164, v208, v209
  v_mfma_f32_16x16x32_bf16 v[112:115], a[144:147], v[48:51], v[112:115]
  v_exp_f32 v222, v134
  v_exp_f32 v223, v135
  v_mfma_f32_16x16x32_bf16 v[120:123], a[144:147], v[52:55], v[120:123]
  v_add_f32 v225, v225, v210
  v_add_f32 v225, v225, v211
  v_cvt_pk_bf16_f32 v165, v210, v211
  v_add_f32 v225, v225, v212
  v_mfma_f32_16x16x32_bf16 v[144:147], a[144:147], v[80:83], v[144:147]
  buffer_load_dwordx4 v2, s[48:51], s27 offen offset:2048 sc1 lds
  v_add_f32 v225, v225, v213
  v_cvt_pk_bf16_f32 v166, v212, v213
  v_add_f32 v225, v225, v214
  v_mfma_f32_16x16x32_bf16 v[152:155], a[144:147], v[84:87], v[152:155]
  ds_read_b128 a[144:147], v3 offset:12288
  v_add_f32 v225, v225, v215
  v_cvt_pk_bf16_f32 v167, v214, v215
  v_add_f32 v226, v216, v217
  v_mfma_f32_16x16x32_bf16 v[116:119], a[148:151], v[48:51], v[116:119]
  v_cvt_pk_bf16_f32 v176, v216, v217
  v_exp_f32 v216, v136
  v_add_f32 v226, v226, v218
  v_mfma_f32_16x16x32_bf16 v[124:127], a[148:151], v[52:55], v[124:127]
  v_exp_f32 v217, v137
  v_add_f32 v226, v226, v219
  v_cvt_pk_bf16_f32 v177, v218, v219
  v_mfma_f32_16x16x32_bf16 v[148:151], a[148:151], v[80:83], v[148:151]
  v_exp_f32 v218, v138
  v_add_f32 v226, v226, v220
  v_add_f32 v226, v226, v221
  v_mfma_f32_16x16x32_bf16 v[156:159], a[148:151], v[84:87], v[156:159]
  ds_read_b128 a[148:151], v3 offset:13312
  v_exp_f32 v219, v139
  v_mfma_f32_16x16x32_bf16 v[112:115], a[152:155], v[56:59], v[112:115]
  buffer_load_dwordx4 v2, s[48:51], s27 offen offset:3072 sc1 lds
  v_cvt_pk_bf16_f32 v178, v220, v221
  v_exp_f32 v220, v140
  v_mfma_f32_16x16x32_bf16 v[120:123], a[152:155], v[60:63], v[120:123]
  s_add_u32 s27, s27, 16384
  v_add_f32 v226, v226, v222
  v_add_f32 v226, v226, v223
  v_cvt_pk_bf16_f32 v179, v222, v223
  v_add_f32 v227, v216, v217
  v_mfma_f32_16x16x32_bf16 v[144:147], a[152:155], v[88:91], v[144:147]
  s_add_u32 s25, s25, 32768
  v_exp_f32 v221, v141
  v_cvt_pk_bf16_f32 v180, v216, v217
  v_add_f32 v227, v227, v218
  v_mfma_f32_16x16x32_bf16 v[152:155], a[152:155], v[92:95], v[152:155]
  s_and_b32 s25, s25, 0x1ffff
  ds_read_b128 a[152:155], v3 offset:14336
  v_add_f32 v227, v227, v219
  v_cvt_pk_bf16_f32 v181, v218, v219
  v_max3_f32 v5, v224, v225, v226
  v_mfma_f32_16x16x32_bf16 v[116:119], a[156:159], v[56:59], v[116:119]
  v_exp_f32 v222, v142
  v_add_f32 v227, v227, v220
  v_add_f32 v227, v227, v221
  v_mfma_f32_16x16x32_bf16 v[124:127], a[156:159], v[60:63], v[124:127]
  v_exp_f32 v223, v143
  v_cvt_pk_bf16_f32 v182, v220, v221
  v_add_f32 v227, v227, v222
  v_mfma_f32_16x16x32_bf16 v[148:151], a[156:159], v[88:91], v[148:151]
  v_add_f32 v227, v227, v223
  v_cvt_pk_bf16_f32 v183, v222, v223
  v_max_f32 v5, v5, v227
  v_cmp_lt_f32 vcc, s81, v5
  v_mfma_f32_16x16x32_bf16 v[156:159], a[156:159], v[92:95], v[156:159]
  s_waitcnt lgkmcnt(3)
  s_cbranch_vccnz fa_stub0
fa_back0:
  ds_read_b128 a[156:159], v3 offset:15360
  v_add_f32 v228, v228, v224
  v_add_f32 v229, v229, v225
  v_add_f32 v230, v230, v226
  v_add_f32 v231, v231, v227
  v_add_u32 v3, 32768, v3
  v_and_b32 v3, 0x1ffff, v3
  s_cmp_eq_u32 s28, 0
  s_cbranch_scc1 fa_AV
  s_sub_u32 s28, s28, 1
  s_cmp_eq_u32 s28, 0
  s_cbranch_scc1 fa_Aexit
.p2align 6
fa_DD:
  v_mfma_f32_16x16x32_bf16 v[96:99], a[128:131], v[32:35], v[192:195]
  s_waitcnt vmcnt(12)
  v_exp_f32 v208, v112
  v_mfma_f32_16x16x32_bf16 v[104:107], a[128:131], v[36:39], v[196:199]
  s_barrier
  v_exp_f32 v209, v113
  v_mfma_f32_16x16x32_bf16 v[128:131], a[128:131], v[64:67], v[200:203]
  ds_read_b128 a[160:163], v3 offset:16384
  v_add_f32 v224, v208, v209
  v_mfma_f32_16x16x32_bf16 v[136:139], a[128:131], v[68:71], v[204:207]
  v_exp_f32 v210, v114
  v_mfma_f32_16x16x32_bf16 v[100:103], a[132:135], v[32:35], v[192:195]
  ds_read_b128 a[164:167], v3 offset:17408
  v_cvt_pk_bf16_f32 v168, v208, v209
  v_mfma_f32_16x16x32_bf16 v[108:111], a[132:135], v[36:39], v[196:199]
  s_mov_b32 m0, s24
  v_exp_f32 v211, v115
  v_mfma_f32_16x16x32_bf16 v[132:135], a[132:135], v[64:67], v[200:203]
  buffer_load_dwordx4 v2, s[44:47], s26 offen offset:0 sc1 lds
  v_add_f32 v224, v224, v210
  v_add_f32 v224, v224, v211
  v_mfma_f32_16x16x32_bf16 v[140:143], a[132:135], v[68:71], v[204:207]
  v_exp_f32 v212, v116
  v_mfma_f32_16x16x32_bf16 v[96:99], a[136:139], v[40:43], v[96:99]
  ds_read_b128 a[168:171], v3 offset:18432
  v_cvt_pk_bf16_f32 v169, v210, v211
  v_mfma_f32_16x16x32_bf16 v[104:107], a[136:139], v[44:47], v[104:107]
  v_exp_f32 v213, v117
  v_mfma_f32_16x16x32_bf16 v[128:131], a[136:139], v[72:75], v[128:131]
  v_exp_f32 v214, v118
  v_mfma_f32_16x16x32_bf16 v[136:139], a[136:139], v[76:79], v[136:139]
  v_exp_f32 v215, v119
  v_mfma_f32_16x16x32_bf16 v[100:103], a[140:143], v[40:43], v[100:103]
  ds_read_b128 a[172:175], v3 offset:19456
  v_add_f32 v224, v224, v212
  v_mfma_f32_16x16x32_bf16 v[108:111], a[140:143], v[44:47], v[108:111]
  v_exp_f32 v208, v120
  v_mfma_f32_16x16x32_bf16 v[132:135], a[140:143], v[72:75], v[132:135]
  v_exp_f32 v209, v121
  v_mfma_f32_16x16x32_bf16 v[140:143], a[140:143], v[76:79], v[140:143]
  s_waitcnt lgkmcnt(4)
  v_exp_f32 v210, v122
  v_mfma_f32_16x16x32_bf16 v[96:99], a[144:147], v[48:51], v[96:99]
  ds_read_b128 a[176:179], v3 offset:20480
  v_add_f32 v224, v224, v213
  v_mfma_f32_16x16x32_bf16 v[104:107], a[144:147], v[52:55], v[104:107]
  v_exp_f32 v211, v123
  v_mfma_f32_16x16x32_bf16 v[128:131], a[144:147], v[80:83], v[128:131]
  v_cvt_pk_bf16_f32 v170, v212, v213
  v_add_f32 v224, v224, v214
  v_add_f32 v224, v224, v215
  v_mfma_f32_16x16x32_bf16 v[136:139], a[144:147], v[84:87], v[136:139]
  v_exp_f32 v212, v124
  v_mfma_f32_16x16x32_bf16 v[100:103], a[148:151], v[48:51], v[100:103]
  ds_read_b128 a[180:183], v3 offset:21504
  v_cvt_pk_bf16_f32 v171, v214, v215
  v_mfma_f32_16x16x32_bf16 v[108:111], a[148:151], v[52:55], v[108:111]
  v_exp_f32 v213, v125
  v_mfma_f32_16x16x32_bf16 v[132:135], a[148:151], v[80:83], v[132:135]
  buffer_load_dwordx4 v2, s[44:47], s26 offen offset:1024 sc1 lds
  v_add_f32 v225, v208, v209
  v_mfma_f32_16x16x32_bf16 v[140:143], a[148:151], v[84:87], v[140:143]
  v_exp_f32 v214, v126
  v_mfma_f32_16x16x32_bf16 v[96:99], a[152:155], v[56:59], v[96:99]
  ds_read_b128 a[184:187], v3 offset:22528
  v_cvt_pk_bf16_f32 v172, v208, v209
  v_mfma_f32_16x16x32_bf16 v[104:107], a[152:155], v[60:63], v[104:107]
  v_exp_f32 v215, v127
  v_mfma_f32_16x16x32_bf16 v[128:131], a[152:155], v[88:91], v[128:131]
  v_exp_f32 v216, v144
  v_mfma_f32_16x16x32_bf16 v[136:139], a[152:155], v[92:95], v[136:139]
  v_exp_f32 v217, v145
  v_mfma_f32_16x16x32_bf16 v[100:103], a[156:159], v[56:59], v[100:103]
  ds_read_b128 a[188:191], v3 offset:23552
  v_add_f32 v225, v225, v210
  v_mfma_f32_16x16x32_bf16 v[108:111], a[156:159], v[60:63], v[108:111]
  v_exp_f32 v218, v146
  v_mfma_f32_16x16x32_bf16 v[132:135], a[156:159], v[88:91], v[132:135]
  v_exp_f32 v219, v147
  v_mfma_f32_16x16x32_bf16 v[140:143], a[156:159], v[92:95], v[140:143]
  s_waitcnt lgkmcnt(4)
  v_exp_f32 v220, v148
  v_add_f32 v225, v225, v211
  v_mfma_f32_16x16x32_bf16 a[0:3], a[160:163], v[160:163], a[0:3]
  ds_read_b128 a[128:131], v3 offset:0
  v_cvt_pk_bf16_f32 v173, v210, v211
  v_mfma_f32_16x16x32_bf16 a[4:7], a[160:163], v[164:167], a[4:7]
  v_exp_f32 v221, v149
  v_mfma_f32_16x16x32_bf16 a[64:67], a[160:163], v[176:179], a[64:67]
  v_exp_f32 v222, v150
  v_mfma_f32_16x16x32_bf16 a[68:71], a[160:163], v[180:183], a[68:71]
  v_exp_f32 v223, v151
  v_mfma_f32_16x16x32_bf16 a[8:11], a[164:167], v[160:163], a[8:11]
  ds_read_b128 a[132:135], v3 offset:1024
  v_add_f32 v225, v225, v212
  v_mfma_f32_16x16x32_bf16 a[12:15], a[164:167], v[164:167], a[12:15]
  v_add_f32 v225, v225, v213
  v_cvt_pk_bf16_f32 v174, v212, v213
  v_mfma_f32_16x16x32_bf16 a[72:75], a[164:167], v[176:179], a[72:75]
  buffer_load_dwordx4 v2, s[44:47], s26 offen offset:2048 sc1 lds
  v_add_f32 v225, v225, v214
  v_mfma_f32_16x16x32_bf16 a[76:79], a[164:167], v[180:183], a[76:79]
  v_add_f32 v225, v225, v215
  v_cvt_pk_bf16_f32 v175, v214, v215
  v_mfma_f32_16x16x32_bf16 a[16:19], a[168:171], v[160:163], a[16:19]
  ds_read_b128 a[136:139], v3 offset:2048
  v_add_f32 v226, v216, v217
  v_mfma_f32_16x16x32_bf16 a[20:23], a[168:171], v[164:167], a[20:23]
  v_cvt_pk_bf16_f32 v184, v216, v217
  v_add_f32 v226, v226, v218
  v_mfma_f32_16x16x32_bf16 a[80:83], a[168:171], v[176:179], a[80:83]
  v_exp_f32 v216, v152
  v_mfma_f32_16x16x32_bf16 a[84:87], a[168:171], v[180:183], a[84:87]
  v_exp_f32 v217, v153
  v_mfma_f32_16x16x32_bf16 a[24:27], a[172:175], v[160:163], a[24:27]
  ds_read_b128 a[140:143], v3 offset:3072
  v_add_f32 v226, v226, v219
  v_cvt_pk_bf16_f32 v185, v218, v219
  v_mfma_f32_16x16x32_bf16 a[28:31], a[172:175], v[164:167], a[28:31]
  v_exp_f32 v218, v154
  v_mfma_f32_16x16x32_bf16 a[88:91], a[172:175], v[176:179], a[88:91]
  v_add_f32 v226, v226, v220
  v_add_f32 v226, v226, v221
  v_mfma_f32_16x16x32_bf16 a[92:95], a[172:175], v[180:183], a[92:95]
  s_waitcnt lgkmcnt(4)
  v_exp_f32 v219, v155
  v_mfma_f32_16x16x32_bf16 a[32:35], a[176:179], v[160:163], a[32:35]
  ds_read_b128 a[144:147], v3 offset:4096
  v_cvt_pk_bf16_f32 v186, v220, v221
  v_mfma_f32_16x16x32_bf16 a[36:39], a[176:179], v[164:167], a[36:39]
  v_exp_f32 v220, v156
  v_mfma_f32_16x16x32_bf16 a[96:99], a[176:179], v[176:179], a[96:99]
  v_add_f32 v226, v226, v222
  v_add_f32 v226, v226, v223
  v_mfma_f32_16x16x32_bf16 a[100:103], a[176:179], v[180:183], a[100:103]
  v_exp_f32 v221, v157
  v_mfma_f32_16x16x32_bf16 a[40:43], a[180:183], v[160:163], a[40:43]
  ds_read_b128 a[148:151], v3 offset:5120
  v_cvt_pk_bf16_f32 v187, v222, v223
  v_mfma_f32_16x16x32_bf16 a[44:47], a[180:183], v[164:167], a[44:47]
  v_exp_f32 v222, v158
  v_mfma_f32_16x16x32_bf16 a[104:107], a[180:183], v[176:179], a[104:107]
  buffer_load_dwordx4 v2, s[44:47], s26 offen offset:3072 sc1 lds
  v_add_f32 v227, v216, v217
  v_mfma_f32_16x16x32_bf16 a[108:111], a[180:183], v[180:183], a[108:111]
  s_add_u32 s26, s26, 16384
  v_exp_f32 v223, v159
  v_mfma_f32_16x16x32_bf16 a[48:51], a[184:187], v[160:163], a[48:51]
  s_add_u32 s24, s24, 32768
  ds_read_b128 a[152:155], v3 offset:6144
  v_cvt_pk_bf16_f32 v188, v216, v217
  v_add_f32 v227, v227, v218
  v_mfma_f32_16x16x32_bf16 a[52:55], a[184:187], v[164:167], a[52:55]
  s_and_b32 s24, s24, 0x1ffff
  v_add_f32 v227, v227, v219
  v_cvt_pk_bf16_f32 v189, v218, v219
  v_mfma_f32_16x16x32_bf16 a[112:115], a[184:187], v[176:179], a[112:115]
  v_max3_f32 v5, v224, v225, v226
  v_add_f32 v227, v227, v220
  v_mfma_f32_16x16x32_bf16 a[116:119], a[184:187], v[180:183], a[116:119]
  v_add_f32 v227, v227, v221
  v_cvt_pk_bf16_f32 v190, v220, v221
  v_mfma_f32_16x16x32_bf16 a[56:59], a[188:191], v[160:163], a[56:59]
  ds_read_b128 a[156:159], v3 offset:7168
  v_add_f32 v227, v227, v222
  v_mfma_f32_16x16x32_bf16 a[60:63], a[188:191], v[164:167], a[60:63]
  v_add_f32 v227, v227, v223
  v_cvt_pk_bf16_f32 v191, v222, v223
  v_mfma_f32_16x16x32_bf16 a[120:123], a[188:191], v[176:179], a[120:123]
  s_waitcnt lgkmcnt(4)
  v_max_f32 v5, v5, v227
  v_cmp_lt_f32 vcc, s81, v5
  v_mfma_f32_16x16x32_bf16 a[124:127], a[188:191], v[180:183], a[124:127]
  s_cbranch_vccnz fa_stub1
fa_back1:
  v_add_f32 v228, v228, v224
  v_add_f32 v229, v229, v225
  v_add_f32 v230, v230, v226
  v_add_f32 v231, v231, v227
  v_mfma_f32_16x16x32_bf16 v[112:115], a[128:131], v[32:35], v[192:195]
  ds_read_b128 a[160:163], v3 offset:24576
  v_exp_f32 v208, v96
  v_mfma_f32_16x16x32_bf16 v[120:123], a[128:131], v[36:39], v[196:199]
  v_exp_f32 v209, v97
  v_mfma_f32_16x16x32_bf16 v[144:147], a[128:131], v[64:67], v[200:203]
  v_exp_f32 v210, v98
  v_mfma_f32_16x16x32_bf16 v[152:155], a[128:131], v[68:71], v[204:207]
  v_exp_f32 v211, v99
  v_mfma_f32_16x16x32_bf16 v[116:119], a[132:135], v[32:35], v[192:195]
  ds_read_b128 a[164:167], v3 offset:25600
  v_mfma_f32_16x16x32_bf16 v[124:127], a[132:135], v[36:39], v[196:199]
  s_mov_b32 m0, s25
  v_exp_f32 v212, v100
  v_mfma_f32_16x16x32_bf16 v[148:151], a[132:135], v[64:67], v[200:203]
  buffer_load_dwordx4 v2, s[48:51], s27 offen offset:0 sc1 lds
  v_add_f32 v224, v208, v209
  v_cvt_pk_bf16_f32 v160, v208, v209
  v_mfma_f32_16x16x32_bf16 v[156:159], a[132:135], v[68:71], v[204:207]
  v_exp_f32 v213, v101
  v_mfma_f32_16x16x32_bf16 v[112:115], a[136:139], v[40:43], v[112:115]
  ds_read_b128 a[168:171], v3 offset:26624
  v_add_f32 v224, v224, v210
  v_mfma_f32_16x16x32_bf16 v[120:123], a[136:139], v[44:47], v[120:123]
  v_exp_f32 v214, v102
  v_mfma_f32_16x16x32_bf16 v[144:147], a[136:139], v[72:75], v[144:147]
  v_exp_f32 v215, v103
  v_mfma_f32_16x16x32_bf16 v[152:155], a[136:139], v[76:79], v[152:155]
  v_exp_f32 v208, v104
  v_mfma_f32_16x16x32_bf16 v[116:119], a[140:143], v[40:43], v[116:119]
  ds_read_b128 a[172:175], v3 offset:27648
  v_add_f32 v224, v224, v211
  v_mfma_f32_16x16x32_bf16 v[124:127], a[140:143], v[44:47], v[124:127]
  v_exp_f32 v209, v105
  v_mfma_f32_16x16x32_bf16 v[148:151], a[140:143], v[72:75], v[148:151]
  v_cvt_pk_bf16_f32 v161, v210, v211
  v_add_f32 v224, v224, v212
  v_mfma_f32_16x16x32_bf16 v[156:159], a[140:143], v[76:79], v[156:159]
  s_waitcnt lgkmcnt(4)
  v_exp_f32 v210, v106
  v_mfma_f32_16x16x32_bf16 v[112:115], a[144:147], v[48:51], v[112:115]
  ds_read_b128 a[176:179], v3 offset:28672
  v_add_f32 v224, v224, v213
  v_mfma_f32_16x16x32_bf16 v[120:123], a[144:147], v[52:55], v[120:123]
  v_exp_f32 v211, v107
  v_mfma_f32_16x16x32_bf16 v[144:147], a[144:147], v[80:83], v[144:147]
  v_cvt_pk_bf16_f32 v162, v212, v213
  v_add_f32 v224, v224, v214
  v_add_f32 v224, v224, v215
  v_mfma_f32_16x16x32_bf16 v[152:155], a[144:147], v[84:87], v[152:155]
  v_exp_f32 v212, v108
  v_mfma_f32_16x16x32_bf16 v[116:119], a[148:151], v[48:51], v[116:119]
  ds_read_b128 a[180:183], v3 offset:29696
  v_cvt_pk_bf16_f32 v163, v214, v215
  v_mfma_f32_16x16x32_bf16 v[124:127], a[148:151], v[52:55], v[124:127]
  v_exp_f32 v213, v109
  v_mfma_f32_16x16x32_bf16 v[148:151], a[148:151], v[80:83], v[148:151]
  buffer_load_dwordx4 v2, s[48:51], s27 offen offset:1024 sc1 lds
  v_add_f32 v225, v208, v209
  v_mfma_f32_16x16x32_bf16 v[156:159], a[148:151], v[84:87], v[156:159]
  v_exp_f32 v214, v110
  v_mfma_f32_16x16x32_bf16 v[112:115], a[152:155], v[56:59], v[112:115]
  ds_read_b128 a[184:187], v3 offset:30720
  v_cvt_pk_bf16_f32 v164, v208, v209
  v_mfma_f32_16x16x32_bf16 v[120:123], a[152:155], v[60:63], v[120:123]
  v_exp_f32 v215, v111
  v_mfma_f32_16x16x32_bf16 v[144:147], a[152:155], v[88:91], v[144:147]
  v_exp_f32 v216, v128
  v_mfma_f32_16x16x32_bf16 v[152:155], a[152:155], v[92:95], v[152:155]
  v_exp_f32 v217, v129
  v_mfma_f32_16x16x32_bf16 v[116:119], a[156:159], v[56:59], v[116:119]
  ds_read_b128 a[188:191], v3 offset:31744
  v_add_f32 v225, v225, v210
  v_mfma_f32_16x16x32_bf16 v[124:127], a[156:159], v[60:63], v[124:127]
  v_exp_f32 v218, v130
  v_mfma_f32_16x16x32_bf16 v[148:151], a[156:159], v[88:91], v[148:151]
  v_exp_f32 v219, v131
  v_mfma_f32_16x16x32_bf16 v[156:159], a[156:159], v[92:95], v[156:159]
  s_waitcnt lgkmcnt(4)
  v_exp_f32 v220, v132
  v_add_f32 v225, v225, v211
  v_mfma_f32_16x16x32_bf16 a[0:3], a[160:163], v[168:171], a[0:3]
  ds_read_b128 a[128:131], v3 offset:8192
  v_cvt_pk_bf16_f32 v165, v210, v211
  v_mfma_f32_16x16x32_bf16 a[4:7], a[160:163], v[172:175], a[4:7]
  v_exp_f32 v221, v133
  v_mfma_f32_16x16x32_bf16 a[64:67], a[160:163], v[184:187], a[64:67]
  v_exp_f32 v222, v134
  v_mfma_f32_16x16x32_bf16 a[68:71], a[160:163], v[188:191], a[68:71]
  v_exp_f32 v223, v135
  v_mfma_f32_16x16x32_bf16 a[8:11], a[164:167], v[168:171], a[8:11]
  ds_read_b128 a[132:135], v3 offset:9216
  v_add_f32 v225, v225, v212
  v_mfma_f32_16x16x32_bf16 a[12:15], a[164:167], v[172:175], a[12:15]
  v_add_f32 v225, v225, v213
  v_cvt_pk_bf16_f32 v166, v212, v213
  v_mfma_f32_16x16x32_bf16 a[72:75], a[164:167], v[184:187], a[72:75]
  buffer_load_dwordx4 v2, s[48:51], s27 offen offset:2048 sc1 lds
  v_add_f32 v225, v225, v214
  v_mfma_f32_16x16x32_bf16 a[76:79], a[164:167], v[188:191], a[76:79]
  v_add_f32 v225, v225, v215
  v_cvt_pk_bf16_f32 v167, v214, v215
  v_mfma_f32_16x16x32_bf16 a[16:19], a[168:171], v[168:171], a[16:19]
  ds_read_b128 a[136:139], v3 offset:10240
  v_add_f32 v226, v216, v217
  v_mfma_f32_16x16x32_bf16 a[20:23], a[168:171], v[172:175], a[20:23]
  v_cvt_pk_bf16_f32 v176, v216, v217
  v_add_f32 v226, v226, v218
  v_mfma_f32_16x16x32_bf16 a[80:83], a[168:171], v[184:187], a[80:83]
  v_exp_f32 v216, v136
  v_mfma_f32_16x16x32_bf16 a[84:87], a[168:171], v[188:191], a[84:87]
  v_exp_f32 v217, v137
  v_mfma_f32_16x16x32_bf16 a[24:27], a[172:175], v[168:171], a[24:27]
  ds_read_b128 a[140:143], v3 offset:11264
  v_add_f32 v226, v226, v219
  v_cvt_pk_bf16_f32 v177, v218, v219
  v_mfma_f32_16x16x32_bf16 a[28:31], a[172:175], v[172:175], a[28:31]
  v_exp_f32 v218, v138
  v_mfma_f32_16x16x32_bf16 a[88:91], a[172:175], v[184:187], a[88:91]
  v_add_f32 v226, v226, v220
  v_add_f32 v226, v226, v221
  v_mfma_f32_16x16x32_bf16 a[92:95], a[172:175], v[188:191], a[92:95]
  s_waitcnt lgkmcnt(4)
  v_exp_f32 v219, v139
  v_mfma_f32_16x16x32_bf16 a[32:35], a[176:179], v[168:171], a[32:35]
  ds_read_b128 a[144:147], v3 offset:12288
  v_cvt_pk_bf16_f32 v178, v220, v221
  v_mfma_f32_16x16x32_bf16 a[36:39], a[176:179], v[172:175], a[36:39]
  v_exp_f32 v220, v140
  v_mfma_f32_16x16x32_bf16 a[96:99], a[176:179], v[184:187], a[96:99]
  v_add_f32 v226, v226, v222
  v_add_f32 v226, v226, v223
  v_mfma_f32_16x16x32_bf16 a[100:103], a[176:179], v[188:191], a[100:103]
  v_exp_f32 v221, v141
  v_mfma_f32_16x16x32_bf16 a[40:43], a[180:183], v[168:171], a[40:43]
  ds_read_b128 a[148:151], v3 offset:13312
  v_cvt_pk_bf16_f32 v179, v222, v223
  v_mfma_f32_16x16x32_bf16 a[44:47], a[180:183], v[172:175], a[44:47]
  v_exp_f32 v222, v142
  v_mfma_f32_16x16x32_bf16 a[104:107], a[180:183], v[184:187], a[104:107]
  buffer_load_dwordx4 v2, s[48:51], s27 offen offset:3072 sc1 lds
  v_add_f32 v227, v216, v217
  v_mfma_f32_16x16x32_bf16 a[108:111], a[180:183], v[188:191], a[108:111]
  s_add_u32 s27, s27, 16384
  v_exp_f32 v223, v143
  v_mfma_f32_16x16x32_bf16 a[48:51], a[184:187], v[168:171], a[48:51]
  s_add_u32 s25, s25, 32768
  ds_read_b128 a[152:155], v3 offset:14336
  v_cvt_pk_bf16_f32 v180, v216, v217
  v_add_f32 v227, v227, v218
  v_mfma_f32_16x16x32_bf16 a[52:55], a[184:187], v[172:175], a[52:55]
  s_and_b32 s25, s25, 0x1ffff
  v_add_f32 v227, v227, v219
  v_cvt_pk_bf16_f32 v181, v218, v219
  v_mfma_f32_16x16x32_bf16 a[112:115], a[184:187], v[184:187], a[112:115]
  v_max3_f32 v5, v224, v225, v226
  v_add_f32 v227, v227, v220
  v_mfma_f32_16x16x32_bf16 a[116:119], a[184:187], v[188:191], a[116:119]
  v_add_f32 v227, v227, v221
  v_cvt_pk_bf16_f32 v182, v220, v221
  v_mfma_f32_16x16x32_bf16 a[56:59], a[188:191], v[168:171], a[56:59]
  ds_read_b128 a[156:159], v3 offset:15360
  v_add_f32 v227, v227, v222
  v_mfma_f32_16x16x32_bf16 a[60:63], a[188:191], v[172:175], a[60:63]
  s_sub_u32 s28, s28, 1
  v_add_f32 v227, v227, v223
  v_cvt_pk_bf16_f32 v183, v222, v223
  v_mfma_f32_16x16x32_bf16 a[120:123], a[188:191], v[184:187], a[120:123]
  s_waitcnt lgkmcnt(4)
  v_max_f32 v5, v5, v227
  v_cmp_lt_f32 vcc, s81, v5
  v_mfma_f32_16x16x32_bf16 a[124:127], a[188:191], v[188:191], a[124:127]
  s_cbranch_vccnz fa_stub2
fa_back2:
  v_add_f32 v228, v228, v224
  v_add_f32 v229, v229, v225
  v_add_f32 v230, v230, v226
  v_add_f32 v231, v231, v227
  v_add_u32 v3, 32768, v3
  v_and_b32 v3, 0x1ffff, v3
  s_cmp_lg_u32 s28, 0
  s_cbranch_scc1 fa_DD
fa_Aexit:
  s_bitcmp1_b32 s20, 0
  s_cbranch_scc1 fa_Aodd
  v_mfma_f32_16x16x32_bf16 v[96:99], a[128:131], v[32:35], v[192:195]
  s_waitcnt vmcnt(12)
  v_exp_f32 v208, v112
  v_mfma_f32_16x16x32_bf16 v[104:107], a[128:131], v[36:39], v[196:199]
  s_barrier
  v_exp_f32 v209, v113
  v_mfma_f32_16x16x32_bf16 v[128:131], a[128:131], v[64:67], v[200:203]
  ds_read_b128 a[160:163], v3 offset:16384
  v_add_f32 v224, v208, v209
  v_mfma_f32_16x16x32_bf16 v[136:139], a[128:131], v[68:71], v[204:207]
  v_exp_f32 v210, v114
  v_mfma_f32_16x16x32_bf16 v[100:103], a[132:135], v[32:35], v[192:195]
  ds_read_b128 a[164:167], v3 offset:17408
  v_cvt_pk_bf16_f32 v168, v208, v209
  v_mfma_f32_16x16x32_bf16 v[108:111], a[132:135], v[36:39], v[196:199]
  s_mov_b32 m0, s24
  v_exp_f32 v211, v115
  v_mfma_f32_16x16x32_bf16 v[132:135], a[132:135], v[64:67], v[200:203]
  buffer_load_dwordx4 v2, s[44:47], s26 offen offset:0 sc1 lds
  v_add_f32 v224, v224, v210
  v_add_f32 v224, v224, v211
  v_mfma_f32_16x16x32_bf16 v[140:143], a[132:135], v[68:71], v[204:207]
  v_exp_f32 v212, v116
  v_mfma_f32_16x16x32_bf16 v[96:99], a[136:139], v[40:43], v[96:99]
  ds_read_b128 a[168:171], v3 offset:18432
  v_cvt_pk_bf16_f32 v169, v210, v211
  v_mfma_f32_16x16x32_bf16 v[104:107], a[136:139], v[44:47], v[104:107]
  v_exp_f32 v213, v117
  v_mfma_f32_16x16x32_bf16 v[128:131], a[136:139], v[72:75], v[128:131]
  v_exp_f32 v214, v118
  v_mfma_f32_16x16x32_bf16 v[136:139], a[136:139], v[76:79], v[136:139]
  v_exp_f32 v215, v119
  v_mfma_f32_16x16x32_bf16 v[100:103], a[140:143], v[40:43], v[100:103]
  ds_read_b128 a[172:175], v3 offset:19456
  v_add_f32 v224, v224, v212
  v_mfma_f32_16x16x32_bf16 v[108:111], a[140:143], v[44:47], v[108:111]
  v_exp_f32 v208, v120
  v_mfma_f32_16x16x32_bf16 v[132:135], a[140:143], v[72:75], v[132:135]
  v_exp_f32 v209, v121
  v_mfma_f32_16x16x32_bf16 v[140:143], a[140:143], v[76:79], v[140:143]
  s_waitcnt lgkmcnt(4)
  v_exp_f32 v210, v122
  v_mfma_f32_16x16x32_bf16 v[96:99], a[144:147], v[48:51], v[96:99]
  ds_read_b128 a[176:179], v3 offset:20480
  v_add_f32 v224, v224, v213
  v_mfma_f32_16x16x32_bf16 v[104:107], a[144:147], v[52:55], v[104:107]
  v_exp_f32 v211, v123
  v_mfma_f32_16x16x32_bf16 v[128:131], a[144:147], v[80:83], v[128:131]
  v_cvt_pk_bf16_f32 v170, v212, v213
  v_add_f32 v224, v224, v214
  v_add_f32 v224, v224, v215
  v_mfma_f32_16x16x32_bf16 v[136:139], a[144:147], v[84:87], v[136:139]
  v_exp_f32 v212, v124
  v_mfma_f32_16x16x32_bf16 v[100:103], a[148:151], v[48:51], v[100:103]
  ds_read_b128 a[180:183], v3 offset:21504
  v_cvt_pk_bf16_f32 v171, v214, v215
  v_mfma_f32_16x16x32_bf16 v[108:111], a[148:151], v[52:55], v[108:111]
  v_exp_f32 v213, v125
  v_mfma_f32_16x16x32_bf16 v[132:135], a[148:151], v[80:83], v[132:135]
  buffer_load_dwordx4 v2, s[44:47], s26 offen offset:1024 sc1 lds
  v_add_f32 v225, v208, v209
  v_mfma_f32_16x16x32_bf16 v[140:143], a[148:151], v[84:87], v[140:143]
  v_exp_f32 v214, v126
  v_mfma_f32_16x16x32_bf16 v[96:99], a[152:155], v[56:59], v[96:99]
  ds_read_b128 a[184:187], v3 offset:22528
  v_cvt_pk_bf16_f32 v172, v208, v209
  v_mfma_f32_16x16x32_bf16 v[104:107], a[152:155], v[60:63], v[104:107]
  v_exp_f32 v215, v127
  v_mfma_f32_16x16x32_bf16 v[128:131], a[152:155], v[88:91], v[128:131]
  v_exp_f32 v216, v144
  v_mfma_f32_16x16x32_bf16 v[136:139], a[152:155], v[92:95], v[136:139]
  v_exp_f32 v217, v145
  v_mfma_f32_16x16x32_bf16 v[100:103], a[156:159], v[56:59], v[100:103]
  ds_read_b128 a[188:191], v3 offset:23552
  v_add_f32 v225, v225, v210
  v_mfma_f32_16x16x32_bf16 v[108:111], a[156:159], v[60:63], v[108:111]
  v_exp_f32 v218, v146
  v_mfma_f32_16x16x32_bf16 v[132:135], a[156:159], v[88:91], v[132:135]
  v_exp_f32 v219, v147
  v_mfma_f32_16x16x32_bf16 v[140:143], a[156:159], v[92:95], v[140:143]
  s_waitcnt lgkmcnt(4)
  v_exp_f32 v220, v148
  v_add_f32 v225, v225, v211
  v_mfma_f32_16x16x32_bf16 a[0:3], a[160:163], v[160:163], a[0:3]
  ds_read_b128 a[128:131], v3 offset:0
  v_cvt_pk_bf16_f32 v173, v210, v211
  v_mfma_f32_16x16x32_bf16 a[4:7], a[160:163], v[164:167], a[4:7]
  v_exp_f32 v221, v149
  v_mfma_f32_16x16x32_bf16 a[64:67], a[160:163], v[176:179], a[64:67]
  v_exp_f32 v222, v150
  v_mfma_f32_16x16x32_bf16 a[68:71], a[160:163], v[180:183], a[68:71]
  v_exp_f32 v223, v151
  v_mfma_f32_16x16x32_bf16 a[8:11], a[164:167], v[160:163], a[8:11]
  ds_read_b128 a[132:135], v3 offset:1024
  v_add_f32 v225, v225, v212
  v_mfma_f32_16x16x32_bf16 a[12:15], a[164:167], v[164:167], a[12:15]
  v_add_f32 v225, v225, v213
  v_cvt_pk_bf16_f32 v174, v212, v213
  v_mfma_f32_16x16x32_bf16 a[72:75], a[164:167], v[176:179], a[72:75]
  buffer_load_dwordx4 v2, s[44:47], s26 offen offset:2048 sc1 lds
  v_add_f32 v225, v225, v214
  v_mfma_f32_16x16x32_bf16 a[76:79], a[164:167], v[180:183], a[76:79]
  v_add_f32 v225, v225, v215
  v_cvt_pk_bf16_f32 v175, v214, v215
  v_mfma_f32_16x16x32_bf16 a[16:19], a[168:171], v[160:163], a[16:19]
  ds_read_b128 a[136:139], v3 offset:2048
  v_add_f32 v226, v216, v217
  v_mfma_f32_16x16x32_bf16 a[20:23], a[168:171], v[164:167], a[20:23]
  v_cvt_pk_bf16_f32 v184, v216, v217
  v_add_f32 v226, v226, v218
  v_mfma_f32_16x16x32_bf16 a[80:83], a[168:171], v[176:179], a[80:83]
  v_exp_f32 v216, v152
  v_mfma_f32_16x16x32_bf16 a[84:87], a[168:171], v[180:183], a[84:87]
  v_exp_f32 v217, v153
  v_mfma_f32_16x16x32_bf16 a[24:27], a[172:175], v[160:163], a[24:27]
  ds_read_b128 a[140:143], v3 offset:3072
  v_add_f32 v226, v226, v219
  v_cvt_pk_bf16_f32 v185, v218, v219
  v_mfma_f32_16x16x32_bf16 a[28:31], a[172:175], v[164:167], a[28:31]
  v_exp_f32 v218, v154
  v_mfma_f32_16x16x32_bf16 a[88:91], a[172:175], v[176:179], a[88:91]
  v_add_f32 v226, v226, v220
  v_add_f32 v226, v226, v221
  v_mfma_f32_16x16x32_bf16 a[92:95], a[172:175], v[180:183], a[92:95]
  s_waitcnt lgkmcnt(4)
  v_exp_f32 v219, v155
  v_mfma_f32_16x16x32_bf16 a[32:35], a[176:179], v[160:163], a[32:35]
  ds_read_b128 a[144:147], v3 offset:4096
  v_cvt_pk_bf16_f32 v186, v220, v221
  v_mfma_f32_16x16x32_bf16 a[36:39], a[176:179], v[164:167], a[36:39]
  v_exp_f32 v220, v156
  v_mfma_f32_16x16x32_bf16 a[96:99], a[176:179], v[176:179], a[96:99]
  v_add_f32 v226, v226, v222
  v_add_f32 v226, v226, v223
  v_mfma_f32_16x16x32_bf16 a[100:103], a[176:179], v[180:183], a[100:103]
  v_exp_f32 v221, v157
  v_mfma_f32_16x16x32_bf16 a[40:43], a[180:183], v[160:163], a[40:43]
  ds_read_b128 a[148:151], v3 offset:5120
  v_cvt_pk_bf16_f32 v187, v222, v223
  v_mfma_f32_16x16x32_bf16 a[44:47], a[180:183], v[164:167], a[44:47]
  v_exp_f32 v222, v158
  v_mfma_f32_16x16x32_bf16 a[104:107], a[180:183], v[176:179], a[104:107]
  buffer_load_dwordx4 v2, s[44:47], s26 offen offset:3072 sc1 lds
  v_add_f32 v227, v216, v217
  v_mfma_f32_16x16x32_bf16 a[108:111], a[180:183], v[180:183], a[108:111]
  s_add_u32 s26, s26, 16384
  v_exp_f32 v223, v159
  v_mfma_f32_16x16x32_bf16 a[48:51], a[184:187], v[160:163], a[48:51]
  s_add_u32 s24, s24, 32768
  ds_read_b128 a[152:155], v3 offset:6144
  v_cvt_pk_bf16_f32 v188, v216, v217
  v_add_f32 v227, v227, v218
  v_mfma_f32_16x16x32_bf16 a[52:55], a[184:187], v[164:167], a[52:55]
  s_and_b32 s24, s24, 0x1ffff
  v_add_f32 v227, v227, v219
  v_cvt_pk_bf16_f32 v189, v218, v219
  v_mfma_f32_16x16x32_bf16 a[112:115], a[184:187], v[176:179], a[112:115]
  v_max3_f32 v5, v224, v225, v226
  v_add_f32 v227, v227, v220
  v_mfma_f32_16x16x32_bf16 a[116:119], a[184:187], v[180:183], a[116:119]
  v_add_f32 v227, v227, v221
  v_cvt_pk_bf16_f32 v190, v220, v221
  v_mfma_f32_16x16x32_bf16 a[56:59], a[188:191], v[160:163], a[56:59]
  ds_read_b128 a[156:159], v3 offset:7168
  v_add_f32 v227, v227, v222
  v_mfma_f32_16x16x32_bf16 a[60:63], a[188:191], v[164:167], a[60:63]
  v_add_f32 v227, v227, v223
  v_cvt_pk_bf16_f32 v191, v222, v223
  v_mfma_f32_16x16x32_bf16 a[120:123], a[188:191], v[176:179], a[120:123]
  s_waitcnt lgkmcnt(4)
  v_max_f32 v5, v5, v227
  v_cmp_lt_f32 vcc, s81, v5
  v_mfma_f32_16x16x32_bf16 a[124:127], a[188:191], v[180:183], a[124:127]
  s_cbranch_vccnz fa_stub3
fa_back3:
  v_add_f32 v228, v228, v224
  v_add_f32 v229, v229, v225
  v_add_f32 v230, v230, v226
  v_add_f32 v231, v231, v227
  v_mfma_f32_16x16x32_bf16 v[144:147], a[128:131], v[64:67], v[200:203]
  ds_read_b128 a[160:163], v3 offset:24576
  v_cndmask_b32 v96, v4, v96, s[68:69]
  v_cndmask_b32 v97, v4, v97, s[70:71]
  v_mfma_f32_16x16x32_bf16 v[152:155], a[128:131], v[68:71], v[204:207]
  v_cndmask_b32 v98, v4, v98, s[72:73]
  v_cndmask_b32 v99, v4, v99, s[74:75]
  v_mov_b32 v100, v4
  v_mfma_f32_16x16x32_bf16 v[148:151], a[132:135], v[64:67], v[200:203]
  ds_read_b128 a[164:167], v3 offset:25600
  v_mov_b32 v101, v4
  v_mov_b32 v102, v4
  v_mfma_f32_16x16x32_bf16 v[156:159], a[132:135], v[68:71], v[204:207]
  v_mov_b32 v103, v4
  v_cndmask_b32 v108, v4, v108, s[68:69]
  v_cndmask_b32 v109, v4, v109, s[70:71]
  v_mfma_f32_16x16x32_bf16 v[144:147], a[136:139], v[72:75], v[144:147]
  ds_read_b128 a[168:171], v3 offset:26624
  v_cndmask_b32 v110, v4, v110, s[72:73]
  v_cndmask_b32 v111, v4, v111, s[74:75]
  v_mfma_f32_16x16x32_bf16 v[152:155], a[136:139], v[76:79], v[152:155]
  s_mov_b32 m0, s25
  v_exp_f32 v208, v96
  v_exp_f32 v209, v97
  v_mfma_f32_16x16x32_bf16 v[148:151], a[140:143], v[72:75], v[148:151]
  ds_read_b128 a[172:175], v3 offset:27648
  buffer_load_dwordx4 v2, s[48:51], s27 offen offset:0 sc1 lds
  v_mfma_f32_16x16x32_bf16 v[156:159], a[140:143], v[76:79], v[156:159]
  s_waitcnt lgkmcnt(4)
  v_exp_f32 v210, v98
  v_add_f32 v224, v208, v209
  v_mfma_f32_16x16x32_bf16 v[144:147], a[144:147], v[80:83], v[144:147]
  ds_read_b128 a[176:179], v3 offset:28672
  v_exp_f32 v211, v99
  v_mfma_f32_16x16x32_bf16 v[152:155], a[144:147], v[84:87], v[152:155]
  v_exp_f32 v212, v100
  v_cvt_pk_bf16_f32 v160, v208, v209
  v_mfma_f32_16x16x32_bf16 v[148:151], a[148:151], v[80:83], v[148:151]
  ds_read_b128 a[180:183], v3 offset:29696
  v_exp_f32 v213, v101
  v_mfma_f32_16x16x32_bf16 v[156:159], a[148:151], v[84:87], v[156:159]
  v_exp_f32 v214, v102
  v_add_f32 v224, v224, v210
  v_add_f32 v224, v224, v211
  v_mfma_f32_16x16x32_bf16 v[144:147], a[152:155], v[88:91], v[144:147]
  ds_read_b128 a[184:187], v3 offset:30720
  v_cvt_pk_bf16_f32 v161, v210, v211
  v_add_f32 v224, v224, v212
  v_mfma_f32_16x16x32_bf16 v[152:155], a[152:155], v[92:95], v[152:155]
  v_exp_f32 v215, v103
  v_add_f32 v224, v224, v213
  v_mfma_f32_16x16x32_bf16 v[148:151], a[156:159], v[88:91], v[148:151]
  ds_read_b128 a[188:191], v3 offset:31744
  v_cvt_pk_bf16_f32 v162, v212, v213
  v_add_f32 v224, v224, v214
  v_mfma_f32_16x16x32_bf16 v[156:159], a[156:159], v[92:95], v[156:159]
  s_waitcnt lgkmcnt(4)
  v_exp_f32 v208, v104
  v_add_f32 v224, v224, v215
  v_mfma_f32_16x16x32_bf16 a[0:3], a[160:163], v[168:171], a[0:3]
  ds_read_b128 a[128:131], v3 offset:8192
  v_cvt_pk_bf16_f32 v163, v214, v215
  v_exp_f32 v209, v105
  v_mfma_f32_16x16x32_bf16 a[4:7], a[160:163], v[172:175], a[4:7]
  v_exp_f32 v210, v106
  v_mfma_f32_16x16x32_bf16 a[64:67], a[160:163], v[184:187], a[64:67]
  buffer_load_dwordx4 v2, s[48:51], s27 offen offset:1024 sc1 lds
  v_exp_f32 v211, v107
  v_mfma_f32_16x16x32_bf16 a[68:71], a[160:163], v[188:191], a[68:71]
  v_exp_f32 v212, v108
  v_add_f32 v225, v208, v209
  v_mfma_f32_16x16x32_bf16 a[8:11], a[164:167], v[168:171], a[8:11]
  ds_read_b128 a[132:135], v3 offset:9216
  v_exp_f32 v213, v109
  v_mfma_f32_16x16x32_bf16 a[12:15], a[164:167], v[172:175], a[12:15]
  v_exp_f32 v214, v110
  v_cvt_pk_bf16_f32 v164, v208, v209
  v_mfma_f32_16x16x32_bf16 a[72:75], a[164:167], v[184:187], a[72:75]
  v_exp_f32 v215, v111
  v_add_f32 v225, v225, v210
  v_mfma_f32_16x16x32_bf16 a[76:79], a[164:167], v[188:191], a[76:79]
  v_exp_f32 v216, v128
  v_add_f32 v225, v225, v211
  v_mfma_f32_16x16x32_bf16 a[16:19], a[168:171], v[168:171], a[16:19]
  ds_read_b128 a[136:139], v3 offset:10240
  v_exp_f32 v217, v129
  v_mfma_f32_16x16x32_bf16 a[20:23], a[168:171], v[172:175], a[20:23]
  v_exp_f32 v218, v130
  v_cvt_pk_bf16_f32 v165, v210, v211
  v_mfma_f32_16x16x32_bf16 a[80:83], a[168:171], v[184:187], a[80:83]
  v_exp_f32 v219, v131
  v_add_f32 v225, v225, v212
  v_mfma_f32_16x16x32_bf16 a[84:87], a[168:171], v[188:191], a[84:87]
  v_exp_f32 v220, v132
  v_add_f32 v225, v225, v213
  v_mfma_f32_16x16x32_bf16 a[24:27], a[172:175], v[168:171], a[24:27]
  ds_read_b128 a[140:143], v3 offset:11264
  v_exp_f32 v221, v133
  v_mfma_f32_16x16x32_bf16 a[28:31], a[172:175], v[172:175], a[28:31]
  v_exp_f32 v222, v134
  v_cvt_pk_bf16_f32 v166, v212, v213
  v_mfma_f32_16x16x32_bf16 a[88:91], a[172:175], v[184:187], a[88:91]
  buffer_load_dwordx4 v2, s[48:51], s27 offen offset:2048 sc1 lds
  v_exp_f32 v223, v135
  v_mfma_f32_16x16x32_bf16 a[92:95], a[172:175], v[188:191], a[92:95]
  s_waitcnt lgkmcnt(4)
  v_add_f32 v225, v225, v214
  v_add_f32 v225, v225, v215
  v_cvt_pk_bf16_f32 v167, v214, v215
  v_mfma_f32_16x16x32_bf16 a[32:35], a[176:179], v[168:171], a[32:35]
  ds_read_b128 a[144:147], v3 offset:12288
  v_add_f32 v226, v216, v217
  v_cvt_pk_bf16_f32 v176, v216, v217
  v_mfma_f32_16x16x32_bf16 a[36:39], a[176:179], v[172:175], a[36:39]
  v_exp_f32 v216, v136
  v_add_f32 v226, v226, v218
  v_mfma_f32_16x16x32_bf16 a[96:99], a[176:179], v[184:187], a[96:99]
  v_exp_f32 v217, v137
  v_add_f32 v226, v226, v219
  v_mfma_f32_16x16x32_bf16 a[100:103], a[176:179], v[188:191], a[100:103]
  v_cvt_pk_bf16_f32 v177, v218, v219
  v_add_f32 v226, v226, v220
  v_add_f32 v226, v226, v221
  v_cvt_pk_bf16_f32 v178, v220, v221
  v_mfma_f32_16x16x32_bf16 a[40:43], a[180:183], v[168:171], a[40:43]
  ds_read_b128 a[148:151], v3 offset:13312
  v_add_f32 v226, v226, v222
  v_add_f32 v226, v226, v223
  v_mfma_f32_16x16x32_bf16 a[44:47], a[180:183], v[172:175], a[44:47]
  v_exp_f32 v218, v138
  v_cvt_pk_bf16_f32 v179, v222, v223
  v_mfma_f32_16x16x32_bf16 a[104:107], a[180:183], v[184:187], a[104:107]
  v_exp_f32 v219, v139
  v_add_f32 v227, v216, v217
  v_mfma_f32_16x16x32_bf16 a[108:111], a[180:183], v[188:191], a[108:111]
  v_exp_f32 v220, v140
  v_cvt_pk_bf16_f32 v180, v216, v217
  v_mfma_f32_16x16x32_bf16 a[48:51], a[184:187], v[168:171], a[48:51]
  ds_read_b128 a[152:155], v3 offset:14336
  v_add_f32 v227, v227, v218
  v_add_f32 v227, v227, v219
  v_mfma_f32_16x16x32_bf16 a[52:55], a[184:187], v[172:175], a[52:55]
  v_exp_f32 v221, v141
  v_cvt_pk_bf16_f32 v181, v218, v219
  v_mfma_f32_16x16x32_bf16 a[112:115], a[184:187], v[184:187], a[112:115]
  buffer_load_dwordx4 v2, s[48:51], s27 offen offset:3072 sc1 lds
  v_max3_f32 v5, v224, v225, v226
  v_add_f32 v227, v227, v220
  v_mfma_f32_16x16x32_bf16 a[116:119], a[184:187], v[188:191], a[116:119]
  s_add_u32 s27, s27, 16384
  v_exp_f32 v222, v142
  v_add_f32 v227, v227, v221
  v_mfma_f32_16x16x32_bf16 a[56:59], a[188:191], v[168:171], a[56:59]
  s_add_u32 s25, s25, 32768
  ds_read_b128 a[156:159], v3 offset:15360
  v_cvt_pk_bf16_f32 v182, v220, v221
  v_add_f32 v227, v227, v222
  v_mfma_f32_16x16x32_bf16 a[60:63], a[188:191], v[172:175], a[60:63]
  s_and_b32 s25, s25, 0x1ffff
  v_exp_f32 v223, v143
  v_mfma_f32_16x16x32_bf16 a[120:123], a[188:191], v[184:187], a[120:123]
  s_waitcnt lgkmcnt(4)
  v_add_f32 v227, v227, v223
  v_cvt_pk_bf16_f32 v183, v222, v223
  v_max_f32 v5, v5, v227
  v_cmp_lt_f32 vcc, s81, v5
  v_mfma_f32_16x16x32_bf16 a[124:127], a[188:191], v[188:191], a[124:127]
  s_cbranch_vccnz fa_stub4
fa_back4:
  v_add_f32 v228, v228, v224
  v_add_f32 v229, v229, v225
  v_add_f32 v230, v230, v226
  v_add_f32 v231, v231, v227
  v_add_u32 v3, 32768, v3
  v_and_b32 v3, 0x1ffff, v3
fa_AV:
  v_mfma_f32_16x16x32_bf16 v[128:131], a[128:131], v[64:67], v[200:203]
  s_waitcnt vmcnt(12)
  v_exp_f32 v216, v144
  v_mfma_f32_16x16x32_bf16 v[136:139], a[128:131], v[68:71], v[204:207]
  s_barrier
  v_exp_f32 v217, v145
  v_mfma_f32_16x16x32_bf16 v[132:135], a[132:135], v[64:67], v[200:203]
  ds_read_b128 a[160:163], v3 offset:16384
  ds_read_b128 a[164:167], v3 offset:17408
  v_mfma_f32_16x16x32_bf16 v[140:143], a[132:135], v[68:71], v[204:207]
  v_exp_f32 v218, v146
  v_mfma_f32_16x16x32_bf16 v[128:131], a[136:139], v[72:75], v[128:131]
  ds_read_b128 a[168:171], v3 offset:18432
  v_add_f32 v226, v216, v217
  v_mfma_f32_16x16x32_bf16 v[136:139], a[136:139], v[76:79], v[136:139]
  s_mov_b32 m0, s24
  v_exp_f32 v219, v147
  v_mfma_f32_16x16x32_bf16 v[132:135], a[140:143], v[72:75], v[132:135]
  ds_read_b128 a[172:175], v3 offset:19456
  buffer_load_dwordx4 v2, s[44:47], s26 offen offset:0 sc1 lds
  v_mfma_f32_16x16x32_bf16 v[140:143], a[140:143], v[76:79], v[140:143]
  s_waitcnt lgkmcnt(4)
  v_exp_f32 v220, v148
  v_mfma_f32_16x16x32_bf16 v[128:131], a[144:147], v[80:83], v[128:131]
  ds_read_b128 a[176:179], v3 offset:20480
  v_cvt_pk_bf16_f32 v184, v216, v217
  v_mfma_f32_16x16x32_bf16 v[136:139], a[144:147], v[84:87], v[136:139]
  v_exp_f32 v221, v149
  v_mfma_f32_16x16x32_bf16 v[132:135], a[148:151], v[80:83], v[132:135]
  ds_read_b128 a[180:183], v3 offset:21504
  v_add_f32 v226, v226, v218
  v_mfma_f32_16x16x32_bf16 v[140:143], a[148:151], v[84:87], v[140:143]
  v_exp_f32 v222, v150
  v_mfma_f32_16x16x32_bf16 v[128:131], a[152:155], v[88:91], v[128:131]
  ds_read_b128 a[184:187], v3 offset:22528
  v_add_f32 v226, v226, v219
  v_mfma_f32_16x16x32_bf16 v[136:139], a[152:155], v[92:95], v[136:139]
  v_exp_f32 v223, v151
  v_mfma_f32_16x16x32_bf16 v[132:135], a[156:159], v[88:91], v[132:135]
  ds_read_b128 a[188:191], v3 offset:23552
  v_cvt_pk_bf16_f32 v185, v218, v219
  v_mfma_f32_16x16x32_bf16 v[140:143], a[156:159], v[92:95], v[140:143]
  s_waitcnt lgkmcnt(4)
  v_exp_f32 v216, v152
  v_mfma_f32_16x16x32_bf16 a[0:3], a[160:163], v[160:163], a[0:3]
  ds_read_b128 a[128:131], v3 offset:0
  v_add_f32 v226, v226, v220
  v_mfma_f32_16x16x32_bf16 a[4:7], a[160:163], v[164:167], a[4:7]
  v_exp_f32 v217, v153
  v_mfma_f32_16x16x32_bf16 a[64:67], a[160:163], v[176:179], a[64:67]
  buffer_load_dwordx4 v2, s[44:47], s26 offen offset:1024 sc1 lds
  v_add_f32 v226, v226, v221
  v_mfma_f32_16x16x32_bf16 a[68:71], a[160:163], v[180:183], a[68:71]
  v_exp_f32 v218, v154
  v_mfma_f32_16x16x32_bf16 a[8:11], a[164:167], v[160:163], a[8:11]
  ds_read_b128 a[132:135], v3 offset:1024
  v_cvt_pk_bf16_f32 v186, v220, v221
  v_mfma_f32_16x16x32_bf16 a[12:15], a[164:167], v[164:167], a[12:15]
  v_exp_f32 v219, v155
  v_mfma_f32_16x16x32_bf16 a[72:75], a[164:167], v[176:179], a[72:75]
  v_exp_f32 v220, v156
  v_mfma_f32_16x16x32_bf16 a[76:79], a[164:167], v[180:183], a[76:79]
  v_add_f32 v226, v226, v222
  v_add_f32 v226, v226, v223
  v_mfma_f32_16x16x32_bf16 a[16:19], a[168:171], v[160:163], a[16:19]
  ds_read_b128 a[136:139], v3 offset:2048
  v_cvt_pk_bf16_f32 v187, v222, v223
  v_mfma_f32_16x16x32_bf16 a[20:23], a[168:171], v[164:167], a[20:23]
  v_exp_f32 v221, v157
  v_mfma_f32_16x16x32_bf16 a[80:83], a[168:171], v[176:179], a[80:83]
  v_exp_f32 v222, v158
  v_mfma_f32_16x16x32_bf16 a[84:87], a[168:171], v[180:183], a[84:87]
  v_exp_f32 v223, v159
  v_mfma_f32_16x16x32_bf16 a[24:27], a[172:175], v[160:163], a[24:27]
  ds_read_b128 a[140:143], v3 offset:3072
  v_add_f32 v227, v216, v217
  v_mfma_f32_16x16x32_bf16 a[28:31], a[172:175], v[164:167], a[28:31]
  v_cvt_pk_bf16_f32 v188, v216, v217
  v_add_f32 v227, v227, v218
  v_mfma_f32_16x16x32_bf16 a[88:91], a[172:175], v[176:179], a[88:91]
  buffer_load_dwordx4 v2, s[44:47], s26 offen offset:2048 sc1 lds
  v_add_f32 v227, v227, v219
  v_mfma_f32_16x16x32_bf16 a[92:95], a[172:175], v[180:183], a[92:95]
  s_waitcnt lgkmcnt(4)
  v_cvt_pk_bf16_f32 v189, v218, v219
  v_add_f32 v227, v227, v220
  v_mfma_f32_16x16x32_bf16 a[32:35], a[176:179], v[160:163], a[32:35]
  ds_read_b128 a[144:147], v3 offset:4096
  v_add_f32 v227, v227, v221
  v_mfma_f32_16x16x32_bf16 a[36:39], a[176:179], v[164:167], a[36:39]
  v_cvt_pk_bf16_f32 v190, v220, v221
  v_add_f32 v227, v227, v222
  v_mfma_f32_16x16x32_bf16 a[96:99], a[176:179], v[176:179], a[96:99]
  v_add_f32 v227, v227, v223
  v_cvt_pk_bf16_f32 v191, v222, v223
  v_mfma_f32_16x16x32_bf16 a[100:103], a[176:179], v[180:183], a[100:103]
  v_max_f32 v5, v226, v227
  v_cmp_lt_f32 vcc, s81, v5
  v_mfma_f32_16x16x32_bf16 a[40:43], a[180:183], v[160:163], a[40:43]
  ds_read_b128 a[148:151], v3 offset:5120
  v_mfma_f32_16x16x32_bf16 a[44:47], a[180:183], v[164:167], a[44:47]
  v_mfma_f32_16x16x32_bf16 a[104:107], a[180:183], v[176:179], a[104:107]
  v_mfma_f32_16x16x32_bf16 a[108:111], a[180:183], v[180:183], a[108:111]
  v_mfma_f32_16x16x32_bf16 a[48:51], a[184:187], v[160:163], a[48:51]
  ds_read_b128 a[152:155], v3 offset:6144
  v_mfma_f32_16x16x32_bf16 a[52:55], a[184:187], v[164:167], a[52:55]
  v_mfma_f32_16x16x32_bf16 a[112:115], a[184:187], v[176:179], a[112:115]
  buffer_load_dwordx4 v2, s[44:47], s26 offen offset:3072 sc1 lds
  v_mfma_f32_16x16x32_bf16 a[116:119], a[184:187], v[180:183], a[116:119]
  s_add_u32 s26, s26, 16384
  v_mfma_f32_16x16x32_bf16 a[56:59], a[188:191], v[160:163], a[56:59]
  s_add_u32 s24, s24, 32768
  ds_read_b128 a[156:159], v3 offset:7168
  v_mfma_f32_16x16x32_bf16 a[60:63], a[188:191], v[164:167], a[60:63]
  s_and_b32 s24, s24, 0x1ffff
  v_mfma_f32_16x16x32_bf16 a[120:123], a[188:191], v[176:179], a[120:123]
  s_waitcnt lgkmcnt(4)
  v_mfma_f32_16x16x32_bf16 a[124:127], a[188:191], v[180:183], a[124:127]
  s_cbranch_vccnz fa_stub5
fa_back5:
  v_add_f32 v230, v230, v226
  v_add_f32 v231, v231, v227
  v_mfma_f32_16x16x32_bf16 v[144:147], a[128:131], v[64:67], v[200:203]
  ds_read_b128 a[160:163], v3 offset:24576
  v_exp_f32 v216, v128
  v_mfma_f32_16x16x32_bf16 v[152:155], a[128:131], v[68:71], v[204:207]
  v_exp_f32 v217, v129
  v_mfma_f32_16x16x32_bf16 v[148:151], a[132:135], v[64:67], v[200:203]
  ds_read_b128 a[164:167], v3 offset:25600
  v_add_f32 v226, v216, v217
  v_mfma_f32_16x16x32_bf16 v[156:159], a[132:135], v[68:71], v[204:207]
  s_mov_b32 m0, s25
  v_exp_f32 v218, v130
  v_cvt_pk_bf16_f32 v176, v216, v217
  v_mfma_f32_16x16x32_bf16 v[144:147], a[136:139], v[72:75], v[144:147]
  ds_read_b128 a[168:171], v3 offset:26624
  buffer_load_dwordx4 v2, s[48:51], s27 offen offset:0 sc1 lds
  v_mfma_f32_16x16x32_bf16 v[152:155], a[136:139], v[76:79], v[152:155]
  v_exp_f32 v219, v131
  v_add_f32 v226, v226, v218
  v_mfma_f32_16x16x32_bf16 v[148:151], a[140:143], v[72:75], v[148:151]
  ds_read_b128 a[172:175], v3 offset:27648
  v_add_f32 v226, v226, v219
  v_mfma_f32_16x16x32_bf16 v[156:159], a[140:143], v[76:79], v[156:159]
  s_waitcnt lgkmcnt(4)
  v_exp_f32 v220, v132
  v_cvt_pk_bf16_f32 v177, v218, v219
  v_mfma_f32_16x16x32_bf16 v[144:147], a[144:147], v[80:83], v[144:147]
  ds_read_b128 a[176:179], v3 offset:28672
  v_add_f32 v226, v226, v220
  v_mfma_f32_16x16x32_bf16 v[152:155], a[144:147], v[84:87], v[152:155]
  v_exp_f32 v221, v133
  v_exp_f32 v222, v134
  v_mfma_f32_16x16x32_bf16 v[148:151], a[148:151], v[80:83], v[148:151]
  ds_read_b128 a[180:183], v3 offset:29696
  buffer_load_dwordx4 v2, s[48:51], s27 offen offset:1024 sc1 lds
  v_mfma_f32_16x16x32_bf16 v[156:159], a[148:151], v[84:87], v[156:159]
  v_exp_f32 v223, v135
  v_mfma_f32_16x16x32_bf16 v[144:147], a[152:155], v[88:91], v[144:147]
  ds_read_b128 a[184:187], v3 offset:30720
  v_add_f32 v226, v226, v221
  v_mfma_f32_16x16x32_bf16 v[152:155], a[152:155], v[92:95], v[152:155]
  v_exp_f32 v216, v136
  v_mfma_f32_16x16x32_bf16 v[148:151], a[156:159], v[88:91], v[148:151]
  ds_read_b128 a[188:191], v3 offset:31744
  v_cvt_pk_bf16_f32 v178, v220, v221
  v_add_f32 v226, v226, v222
  v_mfma_f32_16x16x32_bf16 v[156:159], a[156:159], v[92:95], v[156:159]
  s_waitcnt lgkmcnt(4)
  v_exp_f32 v217, v137
  v_mfma_f32_16x16x32_bf16 a[64:67], a[160:163], v[184:187], a[64:67]
  ds_read_b128 a[128:131], v3 offset:8192
  v_add_f32 v226, v226, v223
  v_cvt_pk_bf16_f32 v179, v222, v223
  v_mfma_f32_16x16x32_bf16 a[68:71], a[160:163], v[188:191], a[68:71]
  v_exp_f32 v218, v138
  v_mfma_f32_16x16x32_bf16 a[72:75], a[164:167], v[184:187], a[72:75]
  ds_read_b128 a[132:135], v3 offset:9216
  buffer_load_dwordx4 v2, s[48:51], s27 offen offset:2048 sc1 lds
  v_add_f32 v227, v216, v217
  v_mfma_f32_16x16x32_bf16 a[76:79], a[164:167], v[188:191], a[76:79]
  v_exp_f32 v219, v139
  v_mfma_f32_16x16x32_bf16 a[80:83], a[168:171], v[184:187], a[80:83]
  ds_read_b128 a[136:139], v3 offset:10240
  v_cvt_pk_bf16_f32 v180, v216, v217
  v_mfma_f32_16x16x32_bf16 a[84:87], a[168:171], v[188:191], a[84:87]
  v_exp_f32 v220, v140
  v_add_f32 v227, v227, v218
  v_mfma_f32_16x16x32_bf16 a[88:91], a[172:175], v[184:187], a[88:91]
  ds_read_b128 a[140:143], v3 offset:11264
  v_add_f32 v227, v227, v219
  v_mfma_f32_16x16x32_bf16 a[92:95], a[172:175], v[188:191], a[92:95]
  s_waitcnt lgkmcnt(4)
  v_exp_f32 v221, v141
  v_cvt_pk_bf16_f32 v181, v218, v219
  v_mfma_f32_16x16x32_bf16 a[96:99], a[176:179], v[184:187], a[96:99]
  ds_read_b128 a[144:147], v3 offset:12288
  buffer_load_dwordx4 v2, s[48:51], s27 offen offset:3072 sc1 lds
  v_mfma_f32_16x16x32_bf16 a[100:103], a[176:179], v[188:191], a[100:103]
  s_add_u32 s27, s27, 16384
  v_exp_f32 v222, v142
  v_add_f32 v227, v227, v220
  v_mfma_f32_16x16x32_bf16 a[104:107], a[180:183], v[184:187], a[104:107]
  s_add_u32 s25, s25, 32768
  ds_read_b128 a[148:151], v3 offset:13312
  v_add_f32 v227, v227, v221
  v_mfma_f32_16x16x32_bf16 a[108:111], a[180:183], v[188:191], a[108:111]
  s_and_b32 s25, s25, 0x1ffff
  v_exp_f32 v223, v143
  v_cvt_pk_bf16_f32 v182, v220, v221
  v_mfma_f32_16x16x32_bf16 a[112:115], a[184:187], v[184:187], a[112:115]
  ds_read_b128 a[152:155], v3 offset:14336
  v_add_f32 v227, v227, v222
  v_mfma_f32_16x16x32_bf16 a[116:119], a[184:187], v[188:191], a[116:119]
  v_add_f32 v227, v227, v223
  v_cvt_pk_bf16_f32 v183, v222, v223
  v_max_f32 v5, v226, v227
  v_mfma_f32_16x16x32_bf16 a[120:123], a[188:191], v[184:187], a[120:123]
  s_waitcnt lgkmcnt(3)
  ds_read_b128 a[156:159], v3 offset:15360
  v_cmp_lt_f32 vcc, s81, v5
  v_mfma_f32_16x16x32_bf16 a[124:127], a[188:191], v[188:191], a[124:127]
  s_cbranch_vccnz fa_stub6
fa_back6:
  v_add_f32 v230, v230, v226
  v_add_f32 v231, v231, v227
  v_add_u32 v3, 32768, v3
  v_and_b32 v3, 0x1ffff, v3
  s_branch fa_SSpre
fa_Aodd:
  v_mfma_f32_16x16x32_bf16 v[128:131], a[128:131], v[64:67], v[200:203]
  s_waitcnt vmcnt(12)
  v_cndmask_b32 v112, v4, v112, s[68:69]
  v_cndmask_b32 v113, v4, v113, s[70:71]
  v_cndmask_b32 v114, v4, v114, s[72:73]
  v_mfma_f32_16x16x32_bf16 v[136:139], a[128:131], v[68:71], v[204:207]
  s_barrier
  v_cndmask_b32 v115, v4, v115, s[74:75]
  v_mov_b32 v116, v4
  v_mov_b32 v117, v4
  v_mfma_f32_16x16x32_bf16 v[132:135], a[132:135], v[64:67], v[200:203]
  ds_read_b128 a[160:163], v3 offset:16384
  ds_read_b128 a[164:167], v3 offset:17408
  v_mov_b32 v118, v4
  v_mfma_f32_16x16x32_bf16 v[140:143], a[132:135], v[68:71], v[204:207]
  v_mov_b32 v119, v4
  v_cndmask_b32 v124, v4, v124, s[68:69]
  v_cndmask_b32 v125, v4, v125, s[70:71]
  v_mfma_f32_16x16x32_bf16 v[128:131], a[136:139], v[72:75], v[128:131]
  ds_read_b128 a[168:171], v3 offset:18432
  v_cndmask_b32 v126, v4, v126, s[72:73]
  v_cndmask_b32 v127, v4, v127, s[74:75]
  v_mfma_f32_16x16x32_bf16 v[136:139], a[136:139], v[76:79], v[136:139]
  s_mov_b32 m0, s24
  v_exp_f32 v208, v112
  v_exp_f32 v209, v113
  v_mfma_f32_16x16x32_bf16 v[132:135], a[140:143], v[72:75], v[132:135]
  ds_read_b128 a[172:175], v3 offset:19456
  buffer_load_dwordx4 v2, s[44:47], s26 offen offset:0 sc1 lds
  v_mfma_f32_16x16x32_bf16 v[140:143], a[140:143], v[76:79], v[140:143]
  s_waitcnt lgkmcnt(4)
  v_exp_f32 v210, v114
  v_add_f32 v224, v208, v209
  v_mfma_f32_16x16x32_bf16 v[128:131], a[144:147], v[80:83], v[128:131]
  ds_read_b128 a[176:179], v3 offset:20480
  v_exp_f32 v211, v115
  v_mfma_f32_16x16x32_bf16 v[136:139], a[144:147], v[84:87], v[136:139]
  v_exp_f32 v212, v116
  v_cvt_pk_bf16_f32 v168, v208, v209
  v_mfma_f32_16x16x32_bf16 v[132:135], a[148:151], v[80:83], v[132:135]
  ds_read_b128 a[180:183], v3 offset:21504
  v_exp_f32 v213, v117
  v_mfma_f32_16x16x32_bf16 v[140:143], a[148:151], v[84:87], v[140:143]
  v_exp_f32 v214, v118
  v_add_f32 v224, v224, v210
  v_add_f32 v224, v224, v211
  v_mfma_f32_16x16x32_bf16 v[128:131], a[152:155], v[88:91], v[128:131]
  ds_read_b128 a[184:187], v3 offset:22528
  v_cvt_pk_bf16_f32 v169, v210, v211
  v_add_f32 v224, v224, v212
  v_mfma_f32_16x16x32_bf16 v[136:139], a[152:155], v[92:95], v[136:139]
  v_exp_f32 v215, v119
  v_add_f32 v224, v224, v213
  v_mfma_f32_16x16x32_bf16 v[132:135], a[156:159], v[88:91], v[132:135]
  ds_read_b128 a[188:191], v3 offset:23552
  v_cvt_pk_bf16_f32 v170, v212, v213
  v_add_f32 v224, v224, v214
  v_mfma_f32_16x16x32_bf16 v[140:143], a[156:159], v[92:95], v[140:143]
  s_waitcnt lgkmcnt(4)
  v_exp_f32 v208, v120
  v_add_f32 v224, v224, v215
  v_mfma_f32_16x16x32_bf16 a[0:3], a[160:163], v[160:163], a[0:3]
  ds_read_b128 a[128:131], v3 offset:0
  v_cvt_pk_bf16_f32 v171, v214, v215
  v_exp_f32 v209, v121
  v_mfma_f32_16x16x32_bf16 a[4:7], a[160:163], v[164:167], a[4:7]
  v_exp_f32 v210, v122
  v_mfma_f32_16x16x32_bf16 a[64:67], a[160:163], v[176:179], a[64:67]
  buffer_load_dwordx4 v2, s[44:47], s26 offen offset:1024 sc1 lds
  v_exp_f32 v211, v123
  v_mfma_f32_16x16x32_bf16 a[68:71], a[160:163], v[180:183], a[68:71]
  v_exp_f32 v212, v124
  v_add_f32 v225, v208, v209
  v_mfma_f32_16x16x32_bf16 a[8:11], a[164:167], v[160:163], a[8:11]
  ds_read_b128 a[132:135], v3 offset:1024
  v_exp_f32 v213, v125
  v_mfma_f32_16x16x32_bf16 a[12:15], a[164:167], v[164:167], a[12:15]
  v_exp_f32 v214, v126
  v_cvt_pk_bf16_f32 v172, v208, v209
  v_mfma_f32_16x16x32_bf16 a[72:75], a[164:167], v[176:179], a[72:75]
  v_exp_f32 v215, v127
  v_add_f32 v225, v225, v210
  v_mfma_f32_16x16x32_bf16 a[76:79], a[164:167], v[180:183], a[76:79]
  v_exp_f32 v216, v144
  v_add_f32 v225, v225, v211
  v_mfma_f32_16x16x32_bf16 a[16:19], a[168:171], v[160:163], a[16:19]
  ds_read_b128 a[136:139], v3 offset:2048
  v_exp_f32 v217, v145
  v_mfma_f32_16x16x32_bf16 a[20:23], a[168:171], v[164:167], a[20:23]
  v_exp_f32 v218, v146
  v_cvt_pk_bf16_f32 v173, v210, v211
  v_mfma_f32_16x16x32_bf16 a[80:83], a[168:171], v[176:179], a[80:83]
  v_exp_f32 v219, v147
  v_add_f32 v225, v225, v212
  v_mfma_f32_16x16x32_bf16 a[84:87], a[168:171], v[180:183], a[84:87]
  v_exp_f32 v220, v148
  v_add_f32 v225, v225, v213
  v_mfma_f32_16x16x32_bf16 a[24:27], a[172:175], v[160:163], a[24:27]
  ds_read_b128 a[140:143], v3 offset:3072
  v_exp_f32 v221, v149
  v_mfma_f32_16x16x32_bf16 a[28:31], a[172:175], v[164:167], a[28:31]
  v_exp_f32 v222, v150
  v_cvt_pk_bf16_f32 v174, v212, v213
  v_mfma_f32_16x16x32_bf16 a[88:91], a[172:175], v[176:179], a[88:91]
  buffer_load_dwordx4 v2, s[44:47], s26 offen offset:2048 sc1 lds
  v_exp_f32 v223, v151
  v_mfma_f32_16x16x32_bf16 a[92:95], a[172:175], v[180:183], a[92:95]
  s_waitcnt lgkmcnt(4)
  v_add_f32 v225, v225, v214
  v_add_f32 v225, v225, v215
  v_cvt_pk_bf16_f32 v175, v214, v215
  v_mfma_f32_16x16x32_bf16 a[32:35], a[176:179], v[160:163], a[32:35]
  ds_read_b128 a[144:147], v3 offset:4096
  v_add_f32 v226, v216, v217
  v_cvt_pk_bf16_f32 v184, v216, v217
  v_mfma_f32_16x16x32_bf16 a[36:39], a[176:179], v[164:167], a[36:39]
  v_exp_f32 v216, v152
  v_add_f32 v226, v226, v218
  v_mfma_f32_16x16x32_bf16 a[96:99], a[176:179], v[176:179], a[96:99]
  v_exp_f32 v217, v153
  v_add_f32 v226, v226, v219
  v_mfma_f32_16x16x32_bf16 a[100:103], a[176:179], v[180:183], a[100:103]
  v_cvt_pk_bf16_f32 v185, v218, v219
  v_add_f32 v226, v226, v220
  v_add_f32 v226, v226, v221
  v_cvt_pk_bf16_f32 v186, v220, v221
  v_mfma_f32_16x16x32_bf16 a[40:43], a[180:183], v[160:163], a[40:43]
  ds_read_b128 a[148:151], v3 offset:5120
  v_add_f32 v226, v226, v222
  v_add_f32 v226, v226, v223
  v_mfma_f32_16x16x32_bf16 a[44:47], a[180:183], v[164:167], a[44:47]
  v_exp_f32 v218, v154
  v_cvt_pk_bf16_f32 v187, v222, v223
  v_mfma_f32_16x16x32_bf16 a[104:107], a[180:183], v[176:179], a[104:107]
  v_exp_f32 v219, v155
  v_add_f32 v227, v216, v217
  v_mfma_f32_16x16x32_bf16 a[108:111], a[180:183], v[180:183], a[108:111]
  v_exp_f32 v220, v156
  v_cvt_pk_bf16_f32 v188, v216, v217
  v_mfma_f32_16x16x32_bf16 a[48:51], a[184:187], v[160:163], a[48:51]
  ds_read_b128 a[152:155], v3 offset:6144
  v_add_f32 v227, v227, v218
  v_add_f32 v227, v227, v219
  v_mfma_f32_16x16x32_bf16 a[52:55], a[184:187], v[164:167], a[52:55]
  v_exp_f32 v221, v157
  v_cvt_pk_bf16_f32 v189, v218, v219
  v_mfma_f32_16x16x32_bf16 a[112:115], a[184:187], v[176:179], a[112:115]
  buffer_load_dwordx4 v2, s[44:47], s26 offen offset:3072 sc1 lds
  v_max3_f32 v5, v224, v225, v226
  v_add_f32 v227, v227, v220
  v_mfma_f32_16x16x32_bf16 a[116:119], a[184:187], v[180:183], a[116:119]
  s_add_u32 s26, s26, 16384
  v_exp_f32 v222, v158
  v_add_f32 v227, v227, v221
  v_mfma_f32_16x16x32_bf16 a[56:59], a[188:191], v[160:163], a[56:59]
  s_add_u32 s24, s24, 32768
  ds_read_b128 a[156:159], v3 offset:7168
  v_cvt_pk_bf16_f32 v190, v220, v221
  v_add_f32 v227, v227, v222
  v_mfma_f32_16x16x32_bf16 a[60:63], a[188:191], v[164:167], a[60:63]
  s_and_b32 s24, s24, 0x1ffff
  v_exp_f32 v223, v159
  v_mfma_f32_16x16x32_bf16 a[120:123], a[188:191], v[176:179], a[120:123]
  s_waitcnt lgkmcnt(4)
  v_add_f32 v227, v227, v223
  v_cvt_pk_bf16_f32 v191, v222, v223
  v_max_f32 v5, v5, v227
  v_cmp_lt_f32 vcc, s81, v5
  v_mfma_f32_16x16x32_bf16 a[124:127], a[188:191], v[180:183], a[124:127]
  s_cbranch_vccnz fa_stub7
fa_back7:
  v_add_f32 v228, v228, v224
  v_add_f32 v229, v229, v225
  v_add_f32 v230, v230, v226
  v_add_f32 v231, v231, v227
  v_mfma_f32_16x16x32_bf16 v[144:147], a[128:131], v[64:67], v[200:203]
  ds_read_b128 a[160:163], v3 offset:24576
  v_exp_f32 v216, v128
  v_mfma_f32_16x16x32_bf16 v[152:155], a[128:131], v[68:71], v[204:207]
  v_exp_f32 v217, v129
  v_mfma_f32_16x16x32_bf16 v[148:151], a[132:135], v[64:67], v[200:203]
  ds_read_b128 a[164:167], v3 offset:25600
  v_mfma_f32_16x16x32_bf16 v[156:159], a[132:135], v[68:71], v[204:207]
  v_exp_f32 v218, v130
  v_mfma_f32_16x16x32_bf16 v[144:147], a[136:139], v[72:75], v[144:147]
  ds_read_b128 a[168:171], v3 offset:26624
  v_add_f32 v226, v216, v217
  v_mfma_f32_16x16x32_bf16 v[152:155], a[136:139], v[76:79], v[152:155]
  s_mov_b32 m0, s25
  v_exp_f32 v219, v131
  v_mfma_f32_16x16x32_bf16 v[148:151], a[140:143], v[72:75], v[148:151]
  ds_read_b128 a[172:175], v3 offset:27648
  buffer_load_dwordx4 v2, s[48:51], s27 offen offset:0 sc1 lds
  v_mfma_f32_16x16x32_bf16 v[156:159], a[140:143], v[76:79], v[156:159]
  s_waitcnt lgkmcnt(4)
  v_exp_f32 v220, v132
  v_mfma_f32_16x16x32_bf16 v[144:147], a[144:147], v[80:83], v[144:147]
  ds_read_b128 a[176:179], v3 offset:28672
  v_cvt_pk_bf16_f32 v176, v216, v217
  v_mfma_f32_16x16x32_bf16 v[152:155], a[144:147], v[84:87], v[152:155]
  v_exp_f32 v221, v133
  v_mfma_f32_16x16x32_bf16 v[148:151], a[148:151], v[80:83], v[148:151]
  ds_read_b128 a[180:183], v3 offset:29696
  v_add_f32 v226, v226, v218
  v_mfma_f32_16x16x32_bf16 v[156:159], a[148:151], v[84:87], v[156:159]
  v_exp_f32 v222, v134
  v_mfma_f32_16x16x32_bf16 v[144:147], a[152:155], v[88:91], v[144:147]
  ds_read_b128 a[184:187], v3 offset:30720
  v_add_f32 v226, v226, v219
  v_mfma_f32_16x16x32_bf16 v[152:155], a[152:155], v[92:95], v[152:155]
  v_exp_f32 v223, v135
  v_mfma_f32_16x16x32_bf16 v[148:151], a[156:159], v[88:91], v[148:151]
  ds_read_b128 a[188:191], v3 offset:31744
  v_cvt_pk_bf16_f32 v177, v218, v219
  v_mfma_f32_16x16x32_bf16 v[156:159], a[156:159], v[92:95], v[156:159]
  s_waitcnt lgkmcnt(4)
  v_exp_f32 v216, v136
  v_mfma_f32_16x16x32_bf16 a[0:3], a[160:163], v[168:171], a[0:3]
  ds_read_b128 a[128:131], v3 offset:8192
  v_add_f32 v226, v226, v220
  v_mfma_f32_16x16x32_bf16 a[4:7], a[160:163], v[172:175], a[4:7]
  v_exp_f32 v217, v137
  v_mfma_f32_16x16x32_bf16 a[64:67], a[160:163], v[184:187], a[64:67]
  buffer_load_dwordx4 v2, s[48:51], s27 offen offset:1024 sc1 lds
  v_add_f32 v226, v226, v221
  v_mfma_f32_16x16x32_bf16 a[68:71], a[160:163], v[188:191], a[68:71]
  v_exp_f32 v218, v138
  v_mfma_f32_16x16x32_bf16 a[8:11], a[164:167], v[168:171], a[8:11]
  ds_read_b128 a[132:135], v3 offset:9216
  v_cvt_pk_bf16_f32 v178, v220, v221
  v_mfma_f32_16x16x32_bf16 a[12:15], a[164:167], v[172:175], a[12:15]
  v_exp_f32 v219, v139
  v_mfma_f32_16x16x32_bf16 a[72:75], a[164:167], v[184:187], a[72:75]
  v_exp_f32 v220, v140
  v_mfma_f32_16x16x32_bf16 a[76:79], a[164:167], v[188:191], a[76:79]
  v_add_f32 v226, v226, v222
  v_add_f32 v226, v226, v223
  v_mfma_f32_16x16x32_bf16 a[16:19], a[168:171], v[168:171], a[16:19]
  ds_read_b128 a[136:139], v3 offset:10240
  v_cvt_pk_bf16_f32 v179, v222, v223
  v_mfma_f32_16x16x32_bf16 a[20:23], a[168:171], v[172:175], a[20:23]
  v_exp_f32 v221, v141
  v_mfma_f32_16x16x32_bf16 a[80:83], a[168:171], v[184:187], a[80:83]
  v_exp_f32 v222, v142
  v_mfma_f32_16x16x32_bf16 a[84:87], a[168:171], v[188:191], a[84:87]
  v_exp_f32 v223, v143
  v_mfma_f32_16x16x32_bf16 a[24:27], a[172:175], v[168:171], a[24:27]
  ds_read_b128 a[140:143], v3 offset:11264
  v_add_f32 v227, v216, v217
  v_mfma_f32_16x16x32_bf16 a[28:31], a[172:175], v[172:175], a[28:31]
  v_cvt_pk_bf16_f32 v180, v216, v217
  v_add_f32 v227, v227, v218
  v_mfma_f32_16x16x32_bf16 a[88:91], a[172:175], v[184:187], a[88:91]
  buffer_load_dwordx4 v2, s[48:51], s27 offen offset:2048 sc1 lds
  v_add_f32 v227, v227, v219
  v_mfma_f32_16x16x32_bf16 a[92:95], a[172:175], v[188:191], a[92:95]
  s_waitcnt lgkmcnt(4)
  v_cvt_pk_bf16_f32 v181, v218, v219
  v_add_f32 v227, v227, v220
  v_mfma_f32_16x16x32_bf16 a[32:35], a[176:179], v[168:171], a[32:35]
  ds_read_b128 a[144:147], v3 offset:12288
  v_add_f32 v227, v227, v221
  v_mfma_f32_16x16x32_bf16 a[36:39], a[176:179], v[172:175], a[36:39]
  v_cvt_pk_bf16_f32 v182, v220, v221
  v_add_f32 v227, v227, v222
  v_mfma_f32_16x16x32_bf16 a[96:99], a[176:179], v[184:187], a[96:99]
  v_add_f32 v227, v227, v223
  v_cvt_pk_bf16_f32 v183, v222, v223
  v_mfma_f32_16x16x32_bf16 a[100:103], a[176:179], v[188:191], a[100:103]
  v_max_f32 v5, v226, v227
  v_cmp_lt_f32 vcc, s81, v5
  v_mfma_f32_16x16x32_bf16 a[40:43], a[180:183], v[168:171], a[40:43]
  ds_read_b128 a[148:151], v3 offset:13312
  v_mfma_f32_16x16x32_bf16 a[44:47], a[180:183], v[172:175], a[44:47]
  v_mfma_f32_16x16x32_bf16 a[104:107], a[180:183], v[184:187], a[104:107]
  v_mfma_f32_16x16x32_bf16 a[108:111], a[180:183], v[188:191], a[108:111]
  v_mfma_f32_16x16x32_bf16 a[48:51], a[184:187], v[168:171], a[48:51]
  ds_read_b128 a[152:155], v3 offset:14336
  v_mfma_f32_16x16x32_bf16 a[52:55], a[184:187], v[172:175], a[52:55]
  v_mfma_f32_16x16x32_bf16 a[112:115], a[184:187], v[184:187], a[112:115]
  buffer_load_dwordx4 v2, s[48:51], s27 offen offset:3072 sc1 lds
  v_mfma_f32_16x16x32_bf16 a[116:119], a[184:187], v[188:191], a[116:119]
  s_add_u32 s27, s27, 16384
  v_mfma_f32_16x16x32_bf16 a[56:59], a[188:191], v[168:171], a[56:59]
  s_add_u32 s25, s25, 32768
  ds_read_b128 a[156:159], v3 offset:15360
  v_mfma_f32_16x16x32_bf16 a[60:63], a[188:191], v[172:175], a[60:63]
  s_and_b32 s25, s25, 0x1ffff
  v_mfma_f32_16x16x32_bf16 a[120:123], a[188:191], v[184:187], a[120:123]
  s_waitcnt lgkmcnt(4)
  v_mfma_f32_16x16x32_bf16 a[124:127], a[188:191], v[188:191], a[124:127]
  s_cbranch_vccnz fa_stub8
fa_back8:
  v_add_f32 v230, v230, v226
  v_add_f32 v231, v231, v227
  v_add_u32 v3, 32768, v3
  v_and_b32 v3, 0x1ffff, v3
fa_SSpre:
  s_cmp_eq_u32 s29, 0
  s_cbranch_scc1 fa_Bexit
.p2align 6
fa_SS:
  v_mfma_f32_16x16x32_bf16 v[128:131], a[128:131], v[64:67], v[200:203]
  s_waitcnt vmcnt(12)
  v_exp_f32 v216, v144
  v_mfma_f32_16x16x32_bf16 v[136:139], a[128:131], v[68:71], v[204:207]
  s_barrier
  v_exp_f32 v217, v145
  v_exp_f32 v218, v146
  v_mfma_f32_16x16x32_bf16 v[132:135], a[132:135], v[64:67], v[200:203]
  ds_read_b128 a[160:163], v3 offset:16384
  ds_read_b128 a[164:167], v3 offset:17408
  v_mfma_f32_16x16x32_bf16 v[140:143], a[132:135], v[68:71], v[204:207]
  s_mov_b32 m0, s24
  v_exp_f32 v219, v147
  v_mfma_f32_16x16x32_bf16 v[128:131], a[136:139], v[72:75], v[128:131]
  ds_read_b128 a[168:171], v3 offset:18432
  buffer_load_dwordx4 v2, s[44:47], s26 offen offset:0 sc1 lds
  v_mfma_f32_16x16x32_bf16 v[136:139], a[136:139], v[76:79], v[136:139]
  v_exp_f32 v220, v148
  v_add_f32 v226, v216, v217
  v_mfma_f32_16x16x32_bf16 v[132:135], a[140:143], v[72:75], v[132:135]
  ds_read_b128 a[172:175], v3 offset:19456
  v_cvt_pk_bf16_f32 v184, v216, v217
  v_mfma_f32_16x16x32_bf16 v[140:143], a[140:143], v[76:79], v[140:143]
  s_waitcnt lgkmcnt(4)
  v_exp_f32 v221, v149
  v_add_f32 v226, v226, v218
  v_mfma_f32_16x16x32_bf16 v[128:131], a[144:147], v[80:83], v[128:131]
  ds_read_b128 a[176:179], v3 offset:20480
  v_add_f32 v226, v226, v219
  v_mfma_f32_16x16x32_bf16 v[136:139], a[144:147], v[84:87], v[136:139]
  v_exp_f32 v222, v150
  v_cvt_pk_bf16_f32 v185, v218, v219
  v_mfma_f32_16x16x32_bf16 v[132:135], a[148:151], v[80:83], v[132:135]
  ds_read_b128 a[180:183], v3 offset:21504
  buffer_load_dwordx4 v2, s[44:47], s26 offen offset:1024 sc1 lds
  v_mfma_f32_16x16x32_bf16 v[140:143], a[148:151], v[84:87], v[140:143]
  v_exp_f32 v223, v151
  v_mfma_f32_16x16x32_bf16 v[128:131], a[152:155], v[88:91], v[128:131]
  ds_read_b128 a[184:187], v3 offset:22528
  v_add_f32 v226, v226, v220
  v_add_f32 v226, v226, v221
  v_mfma_f32_16x16x32_bf16 v[136:139], a[152:155], v[92:95], v[136:139]
  v_exp_f32 v216, v152
  v_mfma_f32_16x16x32_bf16 v[132:135], a[156:159], v[88:91], v[132:135]
  ds_read_b128 a[188:191], v3 offset:23552
  v_cvt_pk_bf16_f32 v186, v220, v221
  v_add_f32 v226, v226, v222
  v_mfma_f32_16x16x32_bf16 v[140:143], a[156:159], v[92:95], v[140:143]
  s_waitcnt lgkmcnt(4)
  v_exp_f32 v217, v153
  v_mfma_f32_16x16x32_bf16 a[64:67], a[160:163], v[176:179], a[64:67]
  ds_read_b128 a[128:131], v3 offset:0
  v_add_f32 v226, v226, v223
  v_cvt_pk_bf16_f32 v187, v222, v223
  v_mfma_f32_16x16x32_bf16 a[68:71], a[160:163], v[180:183], a[68:71]
  v_exp_f32 v218, v154
  v_mfma_f32_16x16x32_bf16 a[72:75], a[164:167], v[176:179], a[72:75]
  ds_read_b128 a[132:135], v3 offset:1024
  buffer_load_dwordx4 v2, s[44:47], s26 offen offset:2048 sc1 lds
  v_add_f32 v227, v216, v217
  v_mfma_f32_16x16x32_bf16 a[76:79], a[164:167], v[180:183], a[76:79]
  v_exp_f32 v219, v155
  v_mfma_f32_16x16x32_bf16 a[80:83], a[168:171], v[176:179], a[80:83]
  ds_read_b128 a[136:139], v3 offset:2048
  v_cvt_pk_bf16_f32 v188, v216, v217
  v_mfma_f32_16x16x32_bf16 a[84:87], a[168:171], v[180:183], a[84:87]
  v_exp_f32 v220, v156
  v_add_f32 v227, v227, v218
  v_mfma_f32_16x16x32_bf16 a[88:91], a[172:175], v[176:179], a[88:91]
  ds_read_b128 a[140:143], v3 offset:3072
  v_add_f32 v227, v227, v219
  v_mfma_f32_16x16x32_bf16 a[92:95], a[172:175], v[180:183], a[92:95]
  s_waitcnt lgkmcnt(4)
  v_exp_f32 v221, v157
  v_cvt_pk_bf16_f32 v189, v218, v219
  v_mfma_f32_16x16x32_bf16 a[96:99], a[176:179], v[176:179], a[96:99]
  ds_read_b128 a[144:147], v3 offset:4096
  buffer_load_dwordx4 v2, s[44:47], s26 offen offset:3072 sc1 lds
  v_mfma_f32_16x16x32_bf16 a[100:103], a[176:179], v[180:183], a[100:103]
  s_add_u32 s26, s26, 16384
  v_exp_f32 v222, v158
  v_add_f32 v227, v227, v220
  v_mfma_f32_16x16x32_bf16 a[104:107], a[180:183], v[176:179], a[104:107]
  s_add_u32 s24, s24, 32768
  ds_read_b128 a[148:151], v3 offset:5120
  v_add_f32 v227, v227, v221
  v_mfma_f32_16x16x32_bf16 a[108:111], a[180:183], v[180:183], a[108:111]
  s_and_b32 s24, s24, 0x1ffff
  v_exp_f32 v223, v159
  v_cvt_pk_bf16_f32 v190, v220, v221
  v_mfma_f32_16x16x32_bf16 a[112:115], a[184:187], v[176:179], a[112:115]
  ds_read_b128 a[152:155], v3 offset:6144
  v_add_f32 v227, v227, v222
  v_mfma_f32_16x16x32_bf16 a[116:119], a[184:187], v[180:183], a[116:119]
  v_add_f32 v227, v227, v223
  v_cvt_pk_bf16_f32 v191, v222, v223
  v_max_f32 v5, v226, v227
  v_mfma_f32_16x16x32_bf16 a[120:123], a[188:191], v[176:179], a[120:123]
  s_waitcnt lgkmcnt(3)
  ds_read_b128 a[156:159], v3 offset:7168
  v_cmp_lt_f32 vcc, s81, v5
  v_mfma_f32_16x16x32_bf16 a[124:127], a[188:191], v[180:183], a[124:127]
  s_cbranch_vccnz fa_stub9
fa_back9:
  v_add_f32 v230, v230, v226
  v_add_f32 v231, v231, v227
  v_mfma_f32_16x16x32_bf16 v[144:147], a[128:131], v[64:67], v[200:203]
  ds_read_b128 a[160:163], v3 offset:24576
  v_exp_f32 v216, v128
  v_mfma_f32_16x16x32_bf16 v[152:155], a[128:131], v[68:71], v[204:207]
  v_exp_f32 v217, v129
  v_mfma_f32_16x16x32_bf16 v[148:151], a[132:135], v[64:67], v[200:203]
  ds_read_b128 a[164:167], v3 offset:25600
  v_add_f32 v226, v216, v217
  v_mfma_f32_16x16x32_bf16 v[156:159], a[132:135], v[68:71], v[204:207]
  s_mov_b32 m0, s25
  v_exp_f32 v218, v130
  v_cvt_pk_bf16_f32 v176, v216, v217
  v_mfma_f32_16x16x32_bf16 v[144:147], a[136:139], v[72:75], v[144:147]
  ds_read_b128 a[168:171], v3 offset:26624
  buffer_load_dwordx4 v2, s[48:51], s27 offen offset:0 sc1 lds
  v_mfma_f32_16x16x32_bf16 v[152:155], a[136:139], v[76:79], v[152:155]
  v_exp_f32 v219, v131
  v_add_f32 v226, v226, v218
  v_mfma_f32_16x16x32_bf16 v[148:151], a[140:143], v[72:75], v[148:151]
  ds_read_b128 a[172:175], v3 offset:27648
  v_add_f32 v226, v226, v219
  v_mfma_f32_16x16x32_bf16 v[156:159], a[140:143], v[76:79], v[156:159]
  s_waitcnt lgkmcnt(4)
  v_exp_f32 v220, v132
  v_cvt_pk_bf16_f32 v177, v218, v219
  v_mfma_f32_16x16x32_bf16 v[144:147], a[144:147], v[80:83], v[144:147]
  ds_read_b128 a[176:179], v3 offset:28672
  v_add_f32 v226, v226, v220
  v_mfma_f32_16x16x32_bf16 v[152:155], a[144:147], v[84:87], v[152:155]
  v_exp_f32 v221, v133
  v_exp_f32 v222, v134
  v_mfma_f32_16x16x32_bf16 v[148:151], a[148:151], v[80:83], v[148:151]
  ds_read_b128 a[180:183], v3 offset:29696
  buffer_load_dwordx4 v2, s[48:51], s27 offen offset:1024 sc1 lds
  v_mfma_f32_16x16x32_bf16 v[156:159], a[148:151], v[84:87], v[156:159]
  v_exp_f32 v223, v135
  v_mfma_f32_16x16x32_bf16 v[144:147], a[152:155], v[88:91], v[144:147]
  ds_read_b128 a[184:187], v3 offset:30720
  v_add_f32 v226, v226, v221
  v_mfma_f32_16x16x32_bf16 v[152:155], a[152:155], v[92:95], v[152:155]
  v_exp_f32 v216, v136
  v_mfma_f32_16x16x32_bf16 v[148:151], a[156:159], v[88:91], v[148:151]
  ds_read_b128 a[188:191], v3 offset:31744
  v_cvt_pk_bf16_f32 v178, v220, v221
  v_add_f32 v226, v226, v222
  v_mfma_f32_16x16x32_bf16 v[156:159], a[156:159], v[92:95], v[156:159]
  s_waitcnt lgkmcnt(4)
  v_exp_f32 v217, v137
  v_mfma_f32_16x16x32_bf16 a[64:67], a[160:163], v[184:187], a[64:67]
  ds_read_b128 a[128:131], v3 offset:8192
  v_add_f32 v226, v226, v223
  v_cvt_pk_bf16_f32 v179, v222, v223
  v_mfma_f32_16x16x32_bf16 a[68:71], a[160:163], v[188:191], a[68:71]
  v_exp_f32 v218, v138
  v_mfma_f32_16x16x32_bf16 a[72:75], a[164:167], v[184:187], a[72:75]
  ds_read_b128 a[132:135], v3 offset:9216
  buffer_load_dwordx4 v2, s[48:51], s27 offen offset:2048 sc1 lds
  v_add_f32 v227, v216, v217
  v_mfma_f32_16x16x32_bf16 a[76:79], a[164:167], v[188:191], a[76:79]
  v_exp_f32 v219, v139
  v_mfma_f32_16x16x32_bf16 a[80:83], a[168:171], v[184:187], a[80:83]
  ds_read_b128 a[136:139], v3 offset:10240
  v_cvt_pk_bf16_f32 v180, v216, v217
  v_mfma_f32_16x16x32_bf16 a[84:87], a[168:171], v[188:191], a[84:87]
  v_exp_f32 v220, v140
  v_add_f32 v227, v227, v218
  v_mfma_f32_16x16x32_bf16 a[88:91], a[172:175], v[184:187], a[88:91]
  ds_read_b128 a[140:143], v3 offset:11264
  v_add_f32 v227, v227, v219
  v_mfma_f32_16x16x32_bf16 a[92:95], a[172:175], v[188:191], a[92:95]
  s_waitcnt lgkmcnt(4)
  v_exp_f32 v221, v141
  v_cvt_pk_bf16_f32 v181, v218, v219
  v_mfma_f32_16x16x32_bf16 a[96:99], a[176:179], v[184:187], a[96:99]
  ds_read_b128 a[144:147], v3 offset:12288
  buffer_load_dwordx4 v2, s[48:51], s27 offen offset:3072 sc1 lds
  v_mfma_f32_16x16x32_bf16 a[100:103], a[176:179], v[188:191], a[100:103]
  s_add_u32 s27, s27, 16384
  v_exp_f32 v222, v142
  v_add_f32 v227, v227, v220
  v_mfma_f32_16x16x32_bf16 a[104:107], a[180:183], v[184:187], a[104:107]
  s_add_u32 s25, s25, 32768
  ds_read_b128 a[148:151], v3 offset:13312
  v_add_f32 v227, v227, v221
  v_mfma_f32_16x16x32_bf16 a[108:111], a[180:183], v[188:191], a[108:111]
  s_and_b32 s25, s25, 0x1ffff
  v_exp_f32 v223, v143
  v_cvt_pk_bf16_f32 v182, v220, v221
  v_mfma_f32_16x16x32_bf16 a[112:115], a[184:187], v[184:187], a[112:115]
  ds_read_b128 a[152:155], v3 offset:14336
  v_add_f32 v227, v227, v222
  v_mfma_f32_16x16x32_bf16 a[116:119], a[184:187], v[188:191], a[116:119]
  s_sub_u32 s29, s29, 1
  v_add_f32 v227, v227, v223
  v_cvt_pk_bf16_f32 v183, v222, v223
  v_max_f32 v5, v226, v227
  v_mfma_f32_16x16x32_bf16 a[120:123], a[188:191], v[184:187], a[120:123]
  s_waitcnt lgkmcnt(3)
  ds_read_b128 a[156:159], v3 offset:15360
  v_cmp_lt_f32 vcc, s81, v5
  v_mfma_f32_16x16x32_bf16 a[124:127], a[188:191], v[188:191], a[124:127]
  s_cbranch_vccnz fa_stub10
fa_back10:
  v_add_f32 v230, v230, v226
  v_add_f32 v231, v231, v227
  v_add_u32 v3, 32768, v3
  v_and_b32 v3, 0x1ffff, v3
  s_cmp_lg_u32 s29, 0
  s_cbranch_scc1 fa_SS
fa_Bexit:
  s_bitcmp1_b32 s20, 0
  s_cbranch_scc1 fa_Bodd
  v_mfma_f32_16x16x32_bf16 v[128:131], a[128:131], v[64:67], v[200:203]
  s_waitcnt vmcnt(0)
  v_exp_f32 v216, v144
  v_mfma_f32_16x16x32_bf16 v[136:139], a[128:131], v[68:71], v[204:207]
  s_barrier
  v_exp_f32 v217, v145
  v_mfma_f32_16x16x32_bf16 v[132:135], a[132:135], v[64:67], v[200:203]
  ds_read_b128 a[160:163], v3 offset:16384
  ds_read_b128 a[164:167], v3 offset:17408
  v_mfma_f32_16x16x32_bf16 v[140:143], a[132:135], v[68:71], v[204:207]
  v_exp_f32 v218, v146
  v_mfma_f32_16x16x32_bf16 v[128:131], a[136:139], v[72:75], v[128:131]
  ds_read_b128 a[168:171], v3 offset:18432
  v_add_f32 v226, v216, v217
  v_mfma_f32_16x16x32_bf16 v[136:139], a[136:139], v[76:79], v[136:139]
  v_exp_f32 v219, v147
  v_mfma_f32_16x16x32_bf16 v[132:135], a[140:143], v[72:75], v[132:135]
  ds_read_b128 a[172:175], v3 offset:19456
  v_cvt_pk_bf16_f32 v184, v216, v217
  v_mfma_f32_16x16x32_bf16 v[140:143], a[140:143], v[76:79], v[140:143]
  s_waitcnt lgkmcnt(4)
  v_exp_f32 v220, v148
  v_add_f32 v226, v226, v218
  v_mfma_f32_16x16x32_bf16 v[128:131], a[144:147], v[80:83], v[128:131]
  ds_read_b128 a[176:179], v3 offset:20480
  v_add_f32 v226, v226, v219
  v_mfma_f32_16x16x32_bf16 v[136:139], a[144:147], v[84:87], v[136:139]
  v_exp_f32 v221, v149
  v_mfma_f32_16x16x32_bf16 v[132:135], a[148:151], v[80:83], v[132:135]
  ds_read_b128 a[180:183], v3 offset:21504
  v_cvt_pk_bf16_f32 v185, v218, v219
  v_mfma_f32_16x16x32_bf16 v[140:143], a[148:151], v[84:87], v[140:143]
  v_exp_f32 v222, v150
  v_mfma_f32_16x16x32_bf16 v[128:131], a[152:155], v[88:91], v[128:131]
  ds_read_b128 a[184:187], v3 offset:22528
  v_add_f32 v226, v226, v220
  v_mfma_f32_16x16x32_bf16 v[136:139], a[152:155], v[92:95], v[136:139]
  v_exp_f32 v223, v151
  v_mfma_f32_16x16x32_bf16 v[132:135], a[156:159], v[88:91], v[132:135]
  ds_read_b128 a[188:191], v3 offset:23552
  v_add_f32 v226, v226, v221
  v_mfma_f32_16x16x32_bf16 v[140:143], a[156:159], v[92:95], v[140:143]
  s_waitcnt lgkmcnt(4)
  v_exp_f32 v216, v152
  v_mfma_f32_16x16x32_bf16 a[64:67], a[160:163], v[176:179], a[64:67]
  v_exp_f32 v217, v153
  v_mfma_f32_16x16x32_bf16 a[68:71], a[160:163], v[180:183], a[68:71]
  v_exp_f32 v218, v154
  v_mfma_f32_16x16x32_bf16 a[72:75], a[164:167], v[176:179], a[72:75]
  v_exp_f32 v219, v155
  v_mfma_f32_16x16x32_bf16 a[76:79], a[164:167], v[180:183], a[76:79]
  v_cvt_pk_bf16_f32 v186, v220, v221
  v_add_f32 v226, v226, v222
  v_mfma_f32_16x16x32_bf16 a[80:83], a[168:171], v[176:179], a[80:83]
  v_exp_f32 v220, v156
  v_mfma_f32_16x16x32_bf16 a[84:87], a[168:171], v[180:183], a[84:87]
  v_exp_f32 v221, v157
  v_mfma_f32_16x16x32_bf16 a[88:91], a[172:175], v[176:179], a[88:91]
  v_add_f32 v226, v226, v223
  v_cvt_pk_bf16_f32 v187, v222, v223
  v_mfma_f32_16x16x32_bf16 a[92:95], a[172:175], v[180:183], a[92:95]
  s_waitcnt lgkmcnt(0)
  v_exp_f32 v222, v158
  v_add_f32 v227, v216, v217
  v_mfma_f32_16x16x32_bf16 a[96:99], a[176:179], v[176:179], a[96:99]
  v_exp_f32 v223, v159
  v_mfma_f32_16x16x32_bf16 a[100:103], a[176:179], v[180:183], a[100:103]
  v_cvt_pk_bf16_f32 v188, v216, v217
  v_add_f32 v227, v227, v218
  v_mfma_f32_16x16x32_bf16 a[104:107], a[180:183], v[176:179], a[104:107]
  v_add_f32 v227, v227, v219
  v_cvt_pk_bf16_f32 v189, v218, v219
  v_mfma_f32_16x16x32_bf16 a[108:111], a[180:183], v[180:183], a[108:111]
  v_add_f32 v227, v227, v220
  v_add_f32 v227, v227, v221
  v_mfma_f32_16x16x32_bf16 a[112:115], a[184:187], v[176:179], a[112:115]
  v_cvt_pk_bf16_f32 v190, v220, v221
  v_add_f32 v227, v227, v222
  v_mfma_f32_16x16x32_bf16 a[116:119], a[184:187], v[180:183], a[116:119]
  v_add_f32 v227, v227, v223
  v_cvt_pk_bf16_f32 v191, v222, v223
  v_mfma_f32_16x16x32_bf16 a[120:123], a[188:191], v[176:179], a[120:123]
  v_max_f32 v5, v226, v227
  v_cmp_lt_f32 vcc, s81, v5
  v_mfma_f32_16x16x32_bf16 a[124:127], a[188:191], v[180:183], a[124:127]
  s_cbranch_vccnz fa_stub11
fa_back11:
  v_add_f32 v230, v230, v226
  v_add_f32 v231, v231, v227
  ds_read_b128 a[160:163], v3 offset:24576
  ds_read_b128 a[164:167], v3 offset:25600
  ds_read_b128 a[168:171], v3 offset:26624
  ds_read_b128 a[172:175], v3 offset:27648
  ds_read_b128 a[176:179], v3 offset:28672
  ds_read_b128 a[180:183], v3 offset:29696
  ds_read_b128 a[184:187], v3 offset:30720
  ds_read_b128 a[188:191], v3 offset:31744
  v_cndmask_b32 v128, v4, v128, s[68:69]
  v_cndmask_b32 v129, v4, v129, s[70:71]
  v_cndmask_b32 v130, v4, v130, s[72:73]
  v_cndmask_b32 v131, v4, v131, s[74:75]
  v_mov_b32 v132, v4
  v_mov_b32 v133, v4
  v_mov_b32 v134, v4
  v_mov_b32 v135, v4
  v_cndmask_b32 v140, v4, v140, s[68:69]
  v_cndmask_b32 v141, v4, v141, s[70:71]
  v_cndmask_b32 v142, v4, v142, s[72:73]
  v_cndmask_b32 v143, v4, v143, s[74:75]
  v_exp_f32 v216, v128
  v_exp_f32 v217, v129
  v_exp_f32 v218, v130
  v_exp_f32 v219, v131
  v_exp_f32 v220, v132
  v_exp_f32 v221, v133
  v_exp_f32 v222, v134
  v_exp_f32 v223, v135
  v_add_f32 v226, v216, v217
  v_cvt_pk_bf16_f32 v176, v216, v217
  s_waitcnt lgkmcnt(4)
  v_mfma_f32_16x16x32_bf16 a[64:67], a[160:163], v[184:187], a[64:67]
  v_exp_f32 v216, v136
  v_add_f32 v226, v226, v218
  v_mfma_f32_16x16x32_bf16 a[68:71], a[160:163], v[188:191], a[68:71]
  v_exp_f32 v217, v137
  v_mfma_f32_16x16x32_bf16 a[72:75], a[164:167], v[184:187], a[72:75]
  v_add_f32 v226, v226, v219
  v_cvt_pk_bf16_f32 v177, v218, v219
  v_add_f32 v226, v226, v220
  v_mfma_f32_16x16x32_bf16 a[76:79], a[164:167], v[188:191], a[76:79]
  v_exp_f32 v218, v138
  v_mfma_f32_16x16x32_bf16 a[80:83], a[168:171], v[184:187], a[80:83]
  v_exp_f32 v219, v139
  v_add_f32 v226, v226, v221
  v_mfma_f32_16x16x32_bf16 a[84:87], a[168:171], v[188:191], a[84:87]
  v_cvt_pk_bf16_f32 v178, v220, v221
  v_add_f32 v226, v226, v222
  v_mfma_f32_16x16x32_bf16 a[88:91], a[172:175], v[184:187], a[88:91]
  v_exp_f32 v220, v140
  v_add_f32 v226, v226, v223
  v_mfma_f32_16x16x32_bf16 a[92:95], a[172:175], v[188:191], a[92:95]
  s_waitcnt lgkmcnt(0)
  v_exp_f32 v221, v141
  v_mfma_f32_16x16x32_bf16 a[96:99], a[176:179], v[184:187], a[96:99]
  v_cvt_pk_bf16_f32 v179, v222, v223
  v_add_f32 v227, v216, v217
  v_cvt_pk_bf16_f32 v180, v216, v217
  v_mfma_f32_16x16x32_bf16 a[100:103], a[176:179], v[188:191], a[100:103]
  v_exp_f32 v222, v142
  v_mfma_f32_16x16x32_bf16 a[104:107], a[180:183], v[184:187], a[104:107]
  v_exp_f32 v223, v143
  v_add_f32 v227, v227, v218
  v_mfma_f32_16x16x32_bf16 a[108:111], a[180:183], v[188:191], a[108:111]
  v_add_f32 v227, v227, v219
  v_cvt_pk_bf16_f32 v181, v218, v219
  v_mfma_f32_16x16x32_bf16 a[112:115], a[184:187], v[184:187], a[112:115]
  v_add_f32 v227, v227, v220
  v_add_f32 v227, v227, v221
  v_cvt_pk_bf16_f32 v182, v220, v221
  v_mfma_f32_16x16x32_bf16 a[116:119], a[184:187], v[188:191], a[116:119]
  v_add_f32 v227, v227, v222
  v_add_f32 v227, v227, v223
  v_mfma_f32_16x16x32_bf16 a[120:123], a[188:191], v[184:187], a[120:123]
  v_cvt_pk_bf16_f32 v183, v222, v223
  v_max_f32 v5, v226, v227
  v_cmp_lt_f32 vcc, s81, v5
  v_mfma_f32_16x16x32_bf16 a[124:127], a[188:191], v[188:191], a[124:127]
  s_cbranch_vccnz fa_stub12
fa_back12:
  v_add_f32 v230, v230, v226
  v_add_f32 v231, v231, v227
  v_add_u32 v3, 32768, v3
  v_and_b32 v3, 0x1ffff, v3
  s_waitcnt vmcnt(0)
  s_barrier
  ds_read_b128 a[160:163], v3 offset:16384
  ds_read_b128 a[164:167], v3 offset:17408
  ds_read_b128 a[168:171], v3 offset:18432
  ds_read_b128 a[172:175], v3 offset:19456
  ds_read_b128 a[176:179], v3 offset:20480
  ds_read_b128 a[180:183], v3 offset:21504
  ds_read_b128 a[184:187], v3 offset:22528
  ds_read_b128 a[188:191], v3 offset:23552
  s_waitcnt lgkmcnt(4)
  v_mfma_f32_16x16x32_bf16 a[64:67], a[160:163], v[176:179], a[64:67]
  v_mfma_f32_16x16x32_bf16 a[68:71], a[160:163], v[180:183], a[68:71]
  v_mfma_f32_16x16x32_bf16 a[72:75], a[164:167], v[176:179], a[72:75]
  v_mfma_f32_16x16x32_bf16 a[76:79], a[164:167], v[180:183], a[76:79]
  v_mfma_f32_16x16x32_bf16 a[80:83], a[168:171], v[176:179], a[80:83]
  v_mfma_f32_16x16x32_bf16 a[84:87], a[168:171], v[180:183], a[84:87]
  v_mfma_f32_16x16x32_bf16 a[88:91], a[172:175], v[176:179], a[88:91]
  v_mfma_f32_16x16x32_bf16 a[92:95], a[172:175], v[180:183], a[92:95]
  s_waitcnt lgkmcnt(0)
  v_mfma_f32_16x16x32_bf16 a[96:99], a[176:179], v[176:179], a[96:99]
  v_mfma_f32_16x16x32_bf16 a[100:103], a[176:179], v[180:183], a[100:103]
  v_mfma_f32_16x16x32_bf16 a[104:107], a[180:183], v[176:179], a[104:107]
  v_mfma_f32_16x16x32_bf16 a[108:111], a[180:183], v[180:183], a[108:111]
  v_mfma_f32_16x16x32_bf16 a[112:115], a[184:187], v[176:179], a[112:115]
  v_mfma_f32_16x16x32_bf16 a[116:119], a[184:187], v[180:183], a[116:119]
  v_mfma_f32_16x16x32_bf16 a[120:123], a[188:191], v[176:179], a[120:123]
  v_mfma_f32_16x16x32_bf16 a[124:127], a[188:191], v[180:183], a[124:127]
  s_branch fa_Bdone
fa_Bodd:
  s_waitcnt vmcnt(0)
  s_barrier
  ds_read_b128 a[160:163], v3 offset:16384
  ds_read_b128 a[164:167], v3 offset:17408
  ds_read_b128 a[168:171], v3 offset:18432
  ds_read_b128 a[172:175], v3 offset:19456
  ds_read_b128 a[176:179], v3 offset:20480
  ds_read_b128 a[180:183], v3 offset:21504
  ds_read_b128 a[184:187], v3 offset:22528
  ds_read_b128 a[188:191], v3 offset:23552
  v_cndmask_b32 v144, v4, v144, s[68:69]
  v_cndmask_b32 v145, v4, v145, s[70:71]
  v_cndmask_b32 v146, v4, v146, s[72:73]
  v_cndmask_b32 v147, v4, v147, s[74:75]
  v_mov_b32 v148, v4
  v_mov_b32 v149, v4
  v_mov_b32 v150, v4
  v_mov_b32 v151, v4
  v_cndmask_b32 v156, v4, v156, s[68:69]
  v_cndmask_b32 v157, v4, v157, s[70:71]
  v_cndmask_b32 v158, v4, v158, s[72:73]
  v_cndmask_b32 v159, v4, v159, s[74:75]
  v_exp_f32 v216, v144
  v_exp_f32 v217, v145
  v_exp_f32 v218, v146
  v_exp_f32 v219, v147
  v_exp_f32 v220, v148
  v_exp_f32 v221, v149
  v_exp_f32 v222, v150
  v_exp_f32 v223, v151
  v_add_f32 v226, v216, v217
  v_cvt_pk_bf16_f32 v184, v216, v217
  s_waitcnt lgkmcnt(4)
  v_mfma_f32_16x16x32_bf16 a[64:67], a[160:163], v[176:179], a[64:67]
  v_exp_f32 v216, v152
  v_add_f32 v226, v226, v218
  v_mfma_f32_16x16x32_bf16 a[68:71], a[160:163], v[180:183], a[68:71]
  v_exp_f32 v217, v153
  v_mfma_f32_16x16x32_bf16 a[72:75], a[164:167], v[176:179], a[72:75]
  v_add_f32 v226, v226, v219
  v_cvt_pk_bf16_f32 v185, v218, v219
  v_add_f32 v226, v226, v220
  v_mfma_f32_16x16x32_bf16 a[76:79], a[164:167], v[180:183], a[76:79]
  v_exp_f32 v218, v154
  v_mfma_f32_16x16x32_bf16 a[80:83], a[168:171], v[176:179], a[80:83]
  v_exp_f32 v219, v155
  v_add_f32 v226, v226, v221
  v_mfma_f32_16x16x32_bf16 a[84:87], a[168:171], v[180:183], a[84:87]
  v_cvt_pk_bf16_f32 v186, v220, v221
  v_add_f32 v226, v226, v222
  v_mfma_f32_16x16x32_bf16 a[88:91], a[172:175], v[176:179], a[88:91]
  v_exp_f32 v220, v156
  v_add_f32 v226, v226, v223
  v_mfma_f32_16x16x32_bf16 a[92:95], a[172:175], v[180:183], a[92:95]
  s_waitcnt lgkmcnt(0)
  v_exp_f32 v221, v157
  v_mfma_f32_16x16x32_bf16 a[96:99], a[176:179], v[176:179], a[96:99]
  v_cvt_pk_bf16_f32 v187, v222, v223
  v_add_f32 v227, v216, v217
  v_cvt_pk_bf16_f32 v188, v216, v217
  v_mfma_f32_16x16x32_bf16 a[100:103], a[176:179], v[180:183], a[100:103]
  v_exp_f32 v222, v158
  v_mfma_f32_16x16x32_bf16 a[104:107], a[180:183], v[176:179], a[104:107]
  v_exp_f32 v223, v159
  v_add_f32 v227, v227, v218
  v_mfma_f32_16x16x32_bf16 a[108:111], a[180:183], v[180:183], a[108:111]
  v_add_f32 v227, v227, v219
  v_cvt_pk_bf16_f32 v189, v218, v219
  v_mfma_f32_16x16x32_bf16 a[112:115], a[184:187], v[176:179], a[112:115]
  v_add_f32 v227, v227, v220
  v_add_f32 v227, v227, v221
  v_cvt_pk_bf16_f32 v190, v220, v221
  v_mfma_f32_16x16x32_bf16 a[116:119], a[184:187], v[180:183], a[116:119]
  v_add_f32 v227, v227, v222
  v_add_f32 v227, v227, v223
  v_mfma_f32_16x16x32_bf16 a[120:123], a[188:191], v[176:179], a[120:123]
  v_cvt_pk_bf16_f32 v191, v222, v223
  v_max_f32 v5, v226, v227
  v_cmp_lt_f32 vcc, s81, v5
  v_mfma_f32_16x16x32_bf16 a[124:127], a[188:191], v[180:183], a[124:127]
  s_cbranch_vccnz fa_stub13
fa_back13:
  v_add_f32 v230, v230, v226
  v_add_f32 v231, v231, v227
  ds_read_b128 a[160:163], v3 offset:24576
  ds_read_b128 a[164:167], v3 offset:25600
  ds_read_b128 a[168:171], v3 offset:26624
  ds_read_b128 a[172:175], v3 offset:27648
  ds_read_b128 a[176:179], v3 offset:28672
  ds_read_b128 a[180:183], v3 offset:29696
  ds_read_b128 a[184:187], v3 offset:30720
  ds_read_b128 a[188:191], v3 offset:31744
  s_waitcnt lgkmcnt(4)
  v_mfma_f32_16x16x32_bf16 a[64:67], a[160:163], v[184:187], a[64:67]
  v_mfma_f32_16x16x32_bf16 a[68:71], a[160:163], v[188:191], a[68:71]
  v_mfma_f32_16x16x32_bf16 a[72:75], a[164:167], v[184:187], a[72:75]
  v_mfma_f32_16x16x32_bf16 a[76:79], a[164:167], v[188:191], a[76:79]
  v_mfma_f32_16x16x32_bf16 a[80:83], a[168:171], v[184:187], a[80:83]
  v_mfma_f32_16x16x32_bf16 a[84:87], a[168:171], v[188:191], a[84:87]
  v_mfma_f32_16x16x32_bf16 a[88:91], a[172:175], v[184:187], a[88:91]
  v_mfma_f32_16x16x32_bf16 a[92:95], a[172:175], v[188:191], a[92:95]
  s_waitcnt lgkmcnt(0)
  v_mfma_f32_16x16x32_bf16 a[96:99], a[176:179], v[184:187], a[96:99]
  v_mfma_f32_16x16x32_bf16 a[100:103], a[176:179], v[188:191], a[100:103]
  v_mfma_f32_16x16x32_bf16 a[104:107], a[180:183], v[184:187], a[104:107]
  v_mfma_f32_16x16x32_bf16 a[108:111], a[180:183], v[188:191], a[108:111]
  v_mfma_f32_16x16x32_bf16 a[112:115], a[184:187], v[184:187], a[112:115]
  v_mfma_f32_16x16x32_bf16 a[116:119], a[184:187], v[188:191], a[116:119]
  v_mfma_f32_16x16x32_bf16 a[120:123], a[188:191], v[184:187], a[120:123]
  v_mfma_f32_16x16x32_bf16 a[124:127], a[188:191], v[188:191], a[124:127]
  v_add_u32 v3, 32768, v3
  v_and_b32 v3, 0x1ffff, v3
fa_Bdone:
  s_cmp_ge_u32 s20, 2
  s_cbranch_scc1 fa_epi
  s_barrier
fa_epi:
  v_mov_b32 v20, v228
  v_mov_b32 v21, v229
  v_mov_b32 v22, v230
  v_mov_b32 v23, v231
  s_nop 0
  v_permlane16_swap_b32 v228, v20
  v_permlane16_swap_b32 v229, v21
  v_permlane16_swap_b32 v230, v22
  v_permlane16_swap_b32 v231, v23
  v_add_f32 v228, v228, v20
  v_add_f32 v229, v229, v21
  v_add_f32 v230, v230, v22
  v_add_f32 v231, v231, v23
  v_mov_b32 v20, v228
  v_mov_b32 v21, v229
  v_mov_b32 v22, v230
  v_mov_b32 v23, v231
  s_nop 0
  v_permlane32_swap_b32 v228, v20
  v_permlane32_swap_b32 v229, v21
  v_permlane32_swap_b32 v230, v22
  v_permlane32_swap_b32 v231, v23
  v_add_f32 v228, v228, v20
  v_add_f32 v229, v229, v21
  v_add_f32 v230, v230, v22
  v_add_f32 v231, v231, v23
  v_rcp_f32 v16, v228
  v_rcp_f32 v18, v229
  v_rcp_f32 v20, v230
  v_rcp_f32 v22, v231
  s_nop 0
  v_mov_b32 v17, v16
  v_mov_b32 v19, v18
  v_mov_b32 v21, v20
  v_mov_b32 v23, v22
  s_lshl_b32 s23, s22, 2
  s_add_u32 s23, s23, s20
  s_lshl_b32 s23, s23, 18
  s_lshl_b32 s31, s21, 12
  s_add_u32 s31, s31, 50331648
  s_add_u32 s64, s23, s31
  s_add_u32 s65, s64, 131072
  s_sub_u32 s23, 15, s22
  s_lshl_b32 s23, s23, 2
  s_add_u32 s23, s23, s20
  s_lshl_b32 s23, s23, 18
  s_add_u32 s66, s23, s31
  s_add_u32 s67, s66, 131072
  v_accvgpr_read_b32 v36, a0
  v_accvgpr_read_b32 v37, a1
  v_accvgpr_read_b32 v38, a2
  v_accvgpr_read_b32 v39, a3
  v_accvgpr_read_b32 v40, a8
  v_accvgpr_read_b32 v41, a9
  v_accvgpr_read_b32 v42, a10
  v_accvgpr_read_b32 v43, a11
  v_pk_mul_f32 v[36:37], v[36:37], v[16:17]
  v_pk_mul_f32 v[38:39], v[38:39], v[16:17]
  v_pk_mul_f32 v[40:41], v[40:41], v[16:17]
  v_pk_mul_f32 v[42:43], v[42:43], v[16:17]
  v_cvt_pk_bf16_f32 v32, v36, v37
  v_cvt_pk_bf16_f32 v33, v38, v39
  v_cvt_pk_bf16_f32 v34, v40, v41
  v_cvt_pk_bf16_f32 v35, v42, v43
  buffer_store_dwordx4 v[32:35], v2, s[40:43], s64 offen offset:0 sc1
  v_accvgpr_read_b32 v48, a16
  v_accvgpr_read_b32 v49, a17
  v_accvgpr_read_b32 v50, a18
  v_accvgpr_read_b32 v51, a19
  v_accvgpr_read_b32 v52, a24
  v_accvgpr_read_b32 v53, a25
  v_accvgpr_read_b32 v54, a26
  v_accvgpr_read_b32 v55, a27
  v_pk_mul_f32 v[48:49], v[48:49], v[16:17]
  v_pk_mul_f32 v[50:51], v[50:51], v[16:17]
  v_pk_mul_f32 v[52:53], v[52:53], v[16:17]
  v_pk_mul_f32 v[54:55], v[54:55], v[16:17]
  v_cvt_pk_bf16_f32 v44, v48, v49
  v_cvt_pk_bf16_f32 v45, v50, v51
  v_cvt_pk_bf16_f32 v46, v52, v53
  v_cvt_pk_bf16_f32 v47, v54, v55
  buffer_store_dwordx4 v[44:47], v2, s[40:43], s64 offen offset:1024 sc1
  v_accvgpr_read_b32 v60, a32
  v_accvgpr_read_b32 v61, a33
  v_accvgpr_read_b32 v62, a34
  v_accvgpr_read_b32 v63, a35
  v_accvgpr_read_b32 v64, a40
  v_accvgpr_read_b32 v65, a41
  v_accvgpr_read_b32 v66, a42
  v_accvgpr_read_b32 v67, a43
  v_pk_mul_f32 v[60:61], v[60:61], v[16:17]
  v_pk_mul_f32 v[62:63], v[62:63], v[16:17]
  v_pk_mul_f32 v[64:65], v[64:65], v[16:17]
  v_pk_mul_f32 v[66:67], v[66:67], v[16:17]
  v_cvt_pk_bf16_f32 v56, v60, v61
  v_cvt_pk_bf16_f32 v57, v62, v63
  v_cvt_pk_bf16_f32 v58, v64, v65
  v_cvt_pk_bf16_f32 v59, v66, v67
  buffer_store_dwordx4 v[56:59], v2, s[40:43], s64 offen offset:2048 sc1
  v_accvgpr_read_b32 v72, a48
  v_accvgpr_read_b32 v73, a49
  v_accvgpr_read_b32 v74, a50
  v_accvgpr_read_b32 v75, a51
  v_accvgpr_read_b32 v76, a56
  v_accvgpr_read_b32 v77, a57
  v_accvgpr_read_b32 v78, a58
  v_accvgpr_read_b32 v79, a59
  v_pk_mul_f32 v[72:73], v[72:73], v[16:17]
  v_pk_mul_f32 v[74:75], v[74:75], v[16:17]
  v_pk_mul_f32 v[76:77], v[76:77], v[16:17]
  v_pk_mul_f32 v[78:79], v[78:79], v[16:17]
  v_cvt_pk_bf16_f32 v68, v72, v73
  v_cvt_pk_bf16_f32 v69, v74, v75
  v_cvt_pk_bf16_f32 v70, v76, v77
  v_cvt_pk_bf16_f32 v71, v78, v79
  buffer_store_dwordx4 v[68:71], v2, s[40:43], s64 offen offset:3072 sc1
  v_accvgpr_read_b32 v84, a4
  v_accvgpr_read_b32 v85, a5
  v_accvgpr_read_b32 v86, a6
  v_accvgpr_read_b32 v87, a7
  v_accvgpr_read_b32 v88, a12
  v_accvgpr_read_b32 v89, a13
  v_accvgpr_read_b32 v90, a14
  v_accvgpr_read_b32 v91, a15
  v_pk_mul_f32 v[84:85], v[84:85], v[18:19]
  v_pk_mul_f32 v[86:87], v[86:87], v[18:19]
  v_pk_mul_f32 v[88:89], v[88:89], v[18:19]
  v_pk_mul_f32 v[90:91], v[90:91], v[18:19]
  v_cvt_pk_bf16_f32 v80, v84, v85
  v_cvt_pk_bf16_f32 v81, v86, v87
  v_cvt_pk_bf16_f32 v82, v88, v89
  v_cvt_pk_bf16_f32 v83, v90, v91
  buffer_store_dwordx4 v[80:83], v2, s[40:43], s65 offen offset:0 sc1
  v_accvgpr_read_b32 v96, a20
  v_accvgpr_read_b32 v97, a21
  v_accvgpr_read_b32 v98, a22
  v_accvgpr_read_b32 v99, a23
  v_accvgpr_read_b32 v100, a28
  v_accvgpr_read_b32 v101, a29
  v_accvgpr_read_b32 v102, a30
  v_accvgpr_read_b32 v103, a31
  v_pk_mul_f32 v[96:97], v[96:97], v[18:19]
  v_pk_mul_f32 v[98:99], v[98:99], v[18:19]
  v_pk_mul_f32 v[100:101], v[100:101], v[18:19]
  v_pk_mul_f32 v[102:103], v[102:103], v[18:19]
  v_cvt_pk_bf16_f32 v92, v96, v97
  v_cvt_pk_bf16_f32 v93, v98, v99
  v_cvt_pk_bf16_f32 v94, v100, v101
  v_cvt_pk_bf16_f32 v95, v102, v103
  buffer_store_dwordx4 v[92:95], v2, s[40:43], s65 offen offset:1024 sc1
  v_accvgpr_read_b32 v108, a36
  v_accvgpr_read_b32 v109, a37
  v_accvgpr_read_b32 v110, a38
  v_accvgpr_read_b32 v111, a39
  v_accvgpr_read_b32 v112, a44
  v_accvgpr_read_b32 v113, a45
  v_accvgpr_read_b32 v114, a46
  v_accvgpr_read_b32 v115, a47
  v_pk_mul_f32 v[108:109], v[108:109], v[18:19]
  v_pk_mul_f32 v[110:111], v[110:111], v[18:19]
  v_pk_mul_f32 v[112:113], v[112:113], v[18:19]
  v_pk_mul_f32 v[114:115], v[114:115], v[18:19]
  v_cvt_pk_bf16_f32 v104, v108, v109
  v_cvt_pk_bf16_f32 v105, v110, v111
  v_cvt_pk_bf16_f32 v106, v112, v113
  v_cvt_pk_bf16_f32 v107, v114, v115
  buffer_store_dwordx4 v[104:107], v2, s[40:43], s65 offen offset:2048 sc1
  v_accvgpr_read_b32 v120, a52
  v_accvgpr_read_b32 v121, a53
  v_accvgpr_read_b32 v122, a54
  v_accvgpr_read_b32 v123, a55
  v_accvgpr_read_b32 v124, a60
  v_accvgpr_read_b32 v125, a61
  v_accvgpr_read_b32 v126, a62
  v_accvgpr_read_b32 v127, a63
  v_pk_mul_f32 v[120:121], v[120:121], v[18:19]
  v_pk_mul_f32 v[122:123], v[122:123], v[18:19]
  v_pk_mul_f32 v[124:125], v[124:125], v[18:19]
  v_pk_mul_f32 v[126:127], v[126:127], v[18:19]
  v_cvt_pk_bf16_f32 v116, v120, v121
  v_cvt_pk_bf16_f32 v117, v122, v123
  v_cvt_pk_bf16_f32 v118, v124, v125
  v_cvt_pk_bf16_f32 v119, v126, v127
  buffer_store_dwordx4 v[116:119], v2, s[40:43], s65 offen offset:3072 sc1
  v_accvgpr_read_b32 v36, a64
  v_accvgpr_read_b32 v37, a65
  v_accvgpr_read_b32 v38, a66
  v_accvgpr_read_b32 v39, a67
  v_accvgpr_read_b32 v40, a72
  v_accvgpr_read_b32 v41, a73
  v_accvgpr_read_b32 v42, a74
  v_accvgpr_read_b32 v43, a75
  v_pk_mul_f32 v[36:37], v[36:37], v[20:21]
  v_pk_mul_f32 v[38:39], v[38:39], v[20:21]
  v_pk_mul_f32 v[40:41], v[40:41], v[20:21]
  v_pk_mul_f32 v[42:43], v[42:43], v[20:21]
  v_cvt_pk_bf16_f32 v32, v36, v37
  v_cvt_pk_bf16_f32 v33, v38, v39
  v_cvt_pk_bf16_f32 v34, v40, v41
  v_cvt_pk_bf16_f32 v35, v42, v43
  buffer_store_dwordx4 v[32:35], v2, s[40:43], s66 offen offset:0 sc1
  v_accvgpr_read_b32 v48, a80
  v_accvgpr_read_b32 v49, a81
  v_accvgpr_read_b32 v50, a82
  v_accvgpr_read_b32 v51, a83
  v_accvgpr_read_b32 v52, a88
  v_accvgpr_read_b32 v53, a89
  v_accvgpr_read_b32 v54, a90
  v_accvgpr_read_b32 v55, a91
  v_pk_mul_f32 v[48:49], v[48:49], v[20:21]
  v_pk_mul_f32 v[50:51], v[50:51], v[20:21]
  v_pk_mul_f32 v[52:53], v[52:53], v[20:21]
  v_pk_mul_f32 v[54:55], v[54:55], v[20:21]
  v_cvt_pk_bf16_f32 v44, v48, v49
  v_cvt_pk_bf16_f32 v45, v50, v51
  v_cvt_pk_bf16_f32 v46, v52, v53
  v_cvt_pk_bf16_f32 v47, v54, v55
  buffer_store_dwordx4 v[44:47], v2, s[40:43], s66 offen offset:1024 sc1
  v_accvgpr_read_b32 v60, a96
  v_accvgpr_read_b32 v61, a97
  v_accvgpr_read_b32 v62, a98
  v_accvgpr_read_b32 v63, a99
  v_accvgpr_read_b32 v64, a104
  v_accvgpr_read_b32 v65, a105
  v_accvgpr_read_b32 v66, a106
  v_accvgpr_read_b32 v67, a107
  v_pk_mul_f32 v[60:61], v[60:61], v[20:21]
  v_pk_mul_f32 v[62:63], v[62:63], v[20:21]
  v_pk_mul_f32 v[64:65], v[64:65], v[20:21]
  v_pk_mul_f32 v[66:67], v[66:67], v[20:21]
  v_cvt_pk_bf16_f32 v56, v60, v61
  v_cvt_pk_bf16_f32 v57, v62, v63
  v_cvt_pk_bf16_f32 v58, v64, v65
  v_cvt_pk_bf16_f32 v59, v66, v67
  buffer_store_dwordx4 v[56:59], v2, s[40:43], s66 offen offset:2048 sc1
  v_accvgpr_read_b32 v72, a112
  v_accvgpr_read_b32 v73, a113
  v_accvgpr_read_b32 v74, a114
  v_accvgpr_read_b32 v75, a115
  v_accvgpr_read_b32 v76, a120
  v_accvgpr_read_b32 v77, a121
  v_accvgpr_read_b32 v78, a122
  v_accvgpr_read_b32 v79, a123
  v_pk_mul_f32 v[72:73], v[72:73], v[20:21]
  v_pk_mul_f32 v[74:75], v[74:75], v[20:21]
  v_pk_mul_f32 v[76:77], v[76:77], v[20:21]
  v_pk_mul_f32 v[78:79], v[78:79], v[20:21]
  v_cvt_pk_bf16_f32 v68, v72, v73
  v_cvt_pk_bf16_f32 v69, v74, v75
  v_cvt_pk_bf16_f32 v70, v76, v77
  v_cvt_pk_bf16_f32 v71, v78, v79
  buffer_store_dwordx4 v[68:71], v2, s[40:43], s66 offen offset:3072 sc1
  v_accvgpr_read_b32 v84, a68
  v_accvgpr_read_b32 v85, a69
  v_accvgpr_read_b32 v86, a70
  v_accvgpr_read_b32 v87, a71
  v_accvgpr_read_b32 v88, a76
  v_accvgpr_read_b32 v89, a77
  v_accvgpr_read_b32 v90, a78
  v_accvgpr_read_b32 v91, a79
  v_pk_mul_f32 v[84:85], v[84:85], v[22:23]
  v_pk_mul_f32 v[86:87], v[86:87], v[22:23]
  v_pk_mul_f32 v[88:89], v[88:89], v[22:23]
  v_pk_mul_f32 v[90:91], v[90:91], v[22:23]
  v_cvt_pk_bf16_f32 v80, v84, v85
  v_cvt_pk_bf16_f32 v81, v86, v87
  v_cvt_pk_bf16_f32 v82, v88, v89
  v_cvt_pk_bf16_f32 v83, v90, v91
  buffer_store_dwordx4 v[80:83], v2, s[40:43], s67 offen offset:0 sc1
  v_accvgpr_read_b32 v96, a84
  v_accvgpr_read_b32 v97, a85
  v_accvgpr_read_b32 v98, a86
  v_accvgpr_read_b32 v99, a87
  v_accvgpr_read_b32 v100, a92
  v_accvgpr_read_b32 v101, a93
  v_accvgpr_read_b32 v102, a94
  v_accvgpr_read_b32 v103, a95
  v_pk_mul_f32 v[96:97], v[96:97], v[22:23]
  v_pk_mul_f32 v[98:99], v[98:99], v[22:23]
  v_pk_mul_f32 v[100:101], v[100:101], v[22:23]
  v_pk_mul_f32 v[102:103], v[102:103], v[22:23]
  v_cvt_pk_bf16_f32 v92, v96, v97
  v_cvt_pk_bf16_f32 v93, v98, v99
  v_cvt_pk_bf16_f32 v94, v100, v101
  v_cvt_pk_bf16_f32 v95, v102, v103
  buffer_store_dwordx4 v[92:95], v2, s[40:43], s67 offen offset:1024 sc1
  v_accvgpr_read_b32 v108, a100
  v_accvgpr_read_b32 v109, a101
  v_accvgpr_read_b32 v110, a102
  v_accvgpr_read_b32 v111, a103
  v_accvgpr_read_b32 v112, a108
  v_accvgpr_read_b32 v113, a109
  v_accvgpr_read_b32 v114, a110
  v_accvgpr_read_b32 v115, a111
  v_pk_mul_f32 v[108:109], v[108:109], v[22:23]
  v_pk_mul_f32 v[110:111], v[110:111], v[22:23]
  v_pk_mul_f32 v[112:113], v[112:113], v[22:23]
  v_pk_mul_f32 v[114:115], v[114:115], v[22:23]
  v_cvt_pk_bf16_f32 v104, v108, v109
  v_cvt_pk_bf16_f32 v105, v110, v111
  v_cvt_pk_bf16_f32 v106, v112, v113
  v_cvt_pk_bf16_f32 v107, v114, v115
  buffer_store_dwordx4 v[104:107], v2, s[40:43], s67 offen offset:2048 sc1
  v_accvgpr_read_b32 v120, a116
  v_accvgpr_read_b32 v121, a117
  v_accvgpr_read_b32 v122, a118
  v_accvgpr_read_b32 v123, a119
  v_accvgpr_read_b32 v124, a124
  v_accvgpr_read_b32 v125, a125
  v_accvgpr_read_b32 v126, a126
  v_accvgpr_read_b32 v127, a127
  v_pk_mul_f32 v[120:121], v[120:121], v[22:23]
  v_pk_mul_f32 v[122:123], v[122:123], v[22:23]
  v_pk_mul_f32 v[124:125], v[124:125], v[22:23]
  v_pk_mul_f32 v[126:127], v[126:127], v[22:23]
  v_cvt_pk_bf16_f32 v116, v120, v121
  v_cvt_pk_bf16_f32 v117, v122, v123
  v_cvt_pk_bf16_f32 v118, v124, v125
  v_cvt_pk_bf16_f32 v119, v126, v127
  buffer_store_dwordx4 v[116:119], v2, s[40:43], s67 offen offset:3072 sc1
  v_mov_b32 v16, 1073741824
  v_mov_b32 v17, 1
  v_writelane_b32 v16, s80, 0
  v_writelane_b32 v16, s3, 1
  s_waitcnt vmcnt(0)
  buffer_store_dword v17, v16, s[40:43], 0 offen sc1
  s_cmp_lt_u32 s2, 192
  s_cbranch_scc1 fa_noffn
  s_cmp_ge_u32 s2, 246
  s_cbranch_scc1 fa_noffn
  s_load_dwordx4 s[4:7], s[0:1], 64
  s_load_dwordx2 s[8:9], s[0:1], 80
  s_waitcnt lgkmcnt(0)
  s_mov_b32 s32, s4
  s_mov_b32 s33, s5
  s_mov_b32 s34, 2211840
  s_mov_b32 s35, 0x20000
  s_mov_b32 s36, s6
  s_mov_b32 s37, s7
  s_mov_b32 s38, 2211840
  s_mov_b32 s39, 0x20000
  s_mov_b32 s60, s8
  s_mov_b32 s61, s9
  s_mov_b32 s62, 2211840
  s_mov_b32 s63, 0x20000
  s_sub_u32 s82, s2, 192
  v_lshrrev_b32 v16, 2, v1
  v_mul_u32_u24 v17, 3456, v16
  v_and_b32 v18, 3, v1
  v_lshl_add_u32 v17, v18, 4, v17
  s_mul_i32 s23, s20, 552960
  s_lshl_b32 s31, s82, 6
  s_add_u32 s23, s23, s31
  s_mul_i32 s24, s20, 10240
  s_mul_i32 s25, s82, 40960
  s_add_u32 s25, s25, s24
  s_mov_b32 s26, 10
  s_barrier
fa_fdma:
  s_mov_b32 m0, s24
  s_nop 0
  buffer_load_dwordx4 v17, s[32:35], s23 offen lds
  s_add_u32 m0, s24, 40960
  s_nop 0
  buffer_load_dwordx4 v17, s[36:39], s23 offen lds
  s_add_u32 m0, s24, 81920
  s_nop 0
  buffer_load_dwordx4 v2, s[60:63], s25 offen lds
  s_add_u32 s23, s23, 55296
  s_add_u32 s24, s24, 1024
  s_add_u32 s25, s25, 1024
  s_sub_u32 s26, s26, 1
  s_cmp_lg_u32 s26, 0
  s_cbranch_scc1 fa_fdma
  v_add_u32 v30, 131072, v2
  ds_read_b128 v[32:35], v30 offset:0
  ds_read_b128 v[36:39], v30 offset:1024
  ds_read_b128 v[40:43], v30 offset:2048
  ds_read_b128 v[44:47], v30 offset:3072
  ds_read_b128 v[48:51], v30 offset:4096
  ds_read_b128 v[52:55], v30 offset:5120
  ds_read_b128 v[56:59], v30 offset:6144
  ds_read_b128 v[60:63], v30 offset:7168
  ds_read_b128 v[64:67], v30 offset:8192
  ds_read_b128 v[68:71], v30 offset:9216
  ds_read_b128 v[72:75], v30 offset:10240
  ds_read_b128 v[76:79], v30 offset:11264
  ds_read_b128 v[80:83], v30 offset:12288
  ds_read_b128 v[84:87], v30 offset:13312
  ds_read_b128 v[88:91], v30 offset:14336
  ds_read_b128 v[92:95], v30 offset:15360
  ds_read_b128 v[96:99], v30 offset:16384
  ds_read_b128 v[100:103], v30 offset:17408
  ds_read_b128 v[104:107], v30 offset:18432
  ds_read_b128 v[108:111], v30 offset:19456
  v_lshrrev_b32 v24, 4, v1
  v_mov_b32 v21, 1073741824
  v_lshl_add_u32 v28, v24, 2, v16
  v_lshlrev_b32 v28, 6, v28
  v_lshl_add_u32 v28, v18, 3, v28
  s_lshr_b32 s23, s20, 1
  s_mul_i32 s23, s23, 40960
  s_and_b32 s31, s20, 1
  s_lshl_b32 s31, s31, 5
  s_add_u32 s23, s23, s31
  v_add_u32 v28, s23, v28
  v_mul_u32_u24 v29, 1280, v16
  v_lshl_add_u32 v29, v18, 3, v29
  s_mul_i32 s23, s20, 320
  s_add_u32 s23, s23, 81920
  v_add_u32 v29, s23, v29
  s_lshl_b32 s23, s20, 10
  s_add_u32 s23, s23, 122880
  v_add_u32 v30, s23, v2
  s_waitcnt vmcnt(0) lgkmcnt(0)
  s_barrier
  ds_read_b64_tr_b16 v[112:113], v28 offset:0
  ds_read_b64_tr_b16 v[114:115], v28 offset:256
  ds_read_b64_tr_b16 v[116:117], v28 offset:2048
  ds_read_b64_tr_b16 v[118:119], v28 offset:2304
  ds_read_b64_tr_b16 v[120:121], v28 offset:4096
  ds_read_b64_tr_b16 v[122:123], v28 offset:4352
  ds_read_b64_tr_b16 v[124:125], v28 offset:6144
  ds_read_b64_tr_b16 v[126:127], v28 offset:6400
  ds_read_b64_tr_b16 v[128:129], v28 offset:8192
  ds_read_b64_tr_b16 v[130:131], v28 offset:8448
  ds_read_b64_tr_b16 v[132:133], v28 offset:10240
  ds_read_b64_tr_b16 v[134:135], v28 offset:10496
  ds_read_b64_tr_b16 v[136:137], v28 offset:12288
  ds_read_b64_tr_b16 v[138:139], v28 offset:12544
  ds_read_b64_tr_b16 v[140:141], v28 offset:14336
  ds_read_b64_tr_b16 v[142:143], v28 offset:14592
  ds_read_b64_tr_b16 v[144:145], v28 offset:16384
  ds_read_b64_tr_b16 v[146:147], v28 offset:16640
  ds_read_b64_tr_b16 v[148:149], v28 offset:18432
  ds_read_b64_tr_b16 v[150:151], v28 offset:18688
  ds_read_b64_tr_b16 v[152:153], v28 offset:20480
  ds_read_b64_tr_b16 v[154:155], v28 offset:20736
  ds_read_b64_tr_b16 v[156:157], v28 offset:22528
  ds_read_b64_tr_b16 v[158:159], v28 offset:22784
  ds_read_b64_tr_b16 v[160:161], v28 offset:24576
  ds_read_b64_tr_b16 v[162:163], v28 offset:24832
  ds_read_b64_tr_b16 v[164:165], v28 offset:26624
  ds_read_b64_tr_b16 v[166:167], v28 offset:26880
  ds_read_b64_tr_b16 v[168:169], v28 offset:28672
  ds_read_b64_tr_b16 v[170:171], v28 offset:28928
  ds_read_b64_tr_b16 v[172:173], v28 offset:30720
  ds_read_b64_tr_b16 v[174:175], v28 offset:30976
  ds_read_b64_tr_b16 v[176:177], v28 offset:32768
  ds_read_b64_tr_b16 v[178:179], v28 offset:33024
  ds_read_b64_tr_b16 v[180:181], v28 offset:34816
  ds_read_b64_tr_b16 v[182:183], v28 offset:35072
  ds_read_b64_tr_b16 v[184:185], v28 offset:36864
  ds_read_b64_tr_b16 v[186:187], v28 offset:37120
  ds_read_b64_tr_b16 v[188:189], v28 offset:38912
  ds_read_b64_tr_b16 v[190:191], v28 offset:39168
  s_waitcnt lgkmcnt(0)
  ds_read_b64_tr_b16 v[192:193], v29 offset:0
  ds_read_b64_tr_b16 v[194:195], v29 offset:20480
  ds_read_b64_tr_b16 v[196:197], v29 offset:32
  ds_read_b64_tr_b16 v[198:199], v29 offset:20512
  ds_read_b64_tr_b16 v[200:201], v29 offset:64
  ds_read_b64_tr_b16 v[202:203], v29 offset:20544
  ds_read_b64_tr_b16 v[204:205], v29 offset:96
  ds_read_b64_tr_b16 v[206:207], v29 offset:20576
  ds_read_b64_tr_b16 v[208:209], v29 offset:128
  ds_read_b64_tr_b16 v[210:211], v29 offset:20608
  ds_read_b64_tr_b16 v[212:213], v29 offset:160
  ds_read_b64_tr_b16 v[214:215], v29 offset:20640
  ds_read_b64_tr_b16 v[216:217], v29 offset:192
  ds_read_b64_tr_b16 v[218:219], v29 offset:20672
  ds_read_b64_tr_b16 v[220:221], v29 offset:224
  ds_read_b64_tr_b16 v[222:223], v29 offset:20704
  ds_read_b64_tr_b16 v[224:225], v29 offset:256
  ds_read_b64_tr_b16 v[226:227], v29 offset:20736
  ds_read_b64_tr_b16 v[228:229], v29 offset:288
  ds_read_b64_tr_b16 v[230:231], v29 offset:20768
  v_mfma_f32_16x16x32_bf16 v[232:235], v[112:115], v[32:35], 0
  v_mfma_f32_16x16x32_bf16 v[232:235], v[116:119], v[36:39], v[232:235]
  v_mfma_f32_16x16x32_bf16 v[232:235], v[120:123], v[40:43], v[232:235]
  v_mfma_f32_16x16x32_bf16 v[232:235], v[124:127], v[44:47], v[232:235]
  v_mfma_f32_16x16x32_bf16 v[232:235], v[128:131], v[48:51], v[232:235]
  v_mfma_f32_16x16x32_bf16 v[232:235], v[132:135], v[52:55], v[232:235]
  v_mfma_f32_16x16x32_bf16 v[232:235], v[136:139], v[56:59], v[232:235]
  v_mfma_f32_16x16x32_bf16 v[232:235], v[140:143], v[60:63], v[232:235]
  v_mfma_f32_16x16x32_bf16 v[232:235], v[144:147], v[64:67], v[232:235]
  v_mfma_f32_16x16x32_bf16 v[232:235], v[148:151], v[68:71], v[232:235]
  v_mfma_f32_16x16x32_bf16 v[232:235], v[152:155], v[72:75], v[232:235]
  v_mfma_f32_16x16x32_bf16 v[232:235], v[156:159], v[76:79], v[232:235]
  v_mfma_f32_16x16x32_bf16 v[232:235], v[160:163], v[80:83], v[232:235]
  v_mfma_f32_16x16x32_bf16 v[232:235], v[164:167], v[84:87], v[232:235]
  v_mfma_f32_16x16x32_bf16 v[232:235], v[168:171], v[88:91], v[232:235]
  v_mfma_f32_16x16x32_bf16 v[232:235], v[172:175], v[92:95], v[232:235]
  v_mfma_f32_16x16x32_bf16 v[232:235], v[176:179], v[96:99], v[232:235]
  v_mfma_f32_16x16x32_bf16 v[232:235], v[180:183], v[100:103], v[232:235]
  v_mfma_f32_16x16x32_bf16 v[232:235], v[184:187], v[104:107], v[232:235]
  v_mfma_f32_16x16x32_bf16 v[232:235], v[188:191], v[108:111], v[232:235]
  s_nop 7
  ds_write_b128 v30, v[232:235]
  v_add_u32 v30, 122880, v2
  s_waitcnt lgkmcnt(0)
  s_barrier
  ds_read_b128 v[32:35], v30 offset:0
  ds_read_b128 v[36:39], v30 offset:1024
  ds_read_b128 v[40:43], v30 offset:2048
  ds_read_b128 v[44:47], v30 offset:3072
  v_and_b32 v20, 15, v1
  v_mul_u32_u24 v28, 2560, v20
  v_lshl_add_u32 v28, v24, 4, v28
  v_cmp_gt_u32 vcc, 8, v20
  s_mul_i32 s23, s82, 20480
  s_mul_i32 s31, s20, 640
  v_cndmask_b32 v28, v21, v28, vcc
  s_add_u32 s23, s23, s31
  s_add_u32 s23, s23, 2686976
  s_waitcnt lgkmcnt(0)
  v_cvt_pk_bf16_f32 v32, v32, v32
  v_and_b32 v32, 0xffff0000, v32
  v_cvt_pk_bf16_f32 v33, v33, v33
  v_and_b32 v33, 0xffff0000, v33
  v_cvt_pk_bf16_f32 v34, v34, v34
  v_and_b32 v34, 0xffff0000, v34
  v_cvt_pk_bf16_f32 v35, v35, v35
  v_and_b32 v35, 0xffff0000, v35
  v_cvt_pk_bf16_f32 v36, v36, v36
  v_and_b32 v36, 0xffff0000, v36
  v_cvt_pk_bf16_f32 v37, v37, v37
  v_and_b32 v37, 0xffff0000, v37
  v_cvt_pk_bf16_f32 v38, v38, v38
  v_and_b32 v38, 0xffff0000, v38
  v_cvt_pk_bf16_f32 v39, v39, v39
  v_and_b32 v39, 0xffff0000, v39
  v_cvt_pk_bf16_f32 v40, v40, v40
  v_and_b32 v40, 0xffff0000, v40
  v_cvt_pk_bf16_f32 v41, v41, v41
  v_and_b32 v41, 0xffff0000, v41
  v_cvt_pk_bf16_f32 v42, v42, v42
  v_and_b32 v42, 0xffff0000, v42
  v_cvt_pk_bf16_f32 v43, v43, v43
  v_and_b32 v43, 0xffff0000, v43
  v_cvt_pk_bf16_f32 v44, v44, v44
  v_and_b32 v44, 0xffff0000, v44
  v_cvt_pk_bf16_f32 v45, v45, v45
  v_and_b32 v45, 0xffff0000, v45
  v_cvt_pk_bf16_f32 v46, v46, v46
  v_and_b32 v46, 0xffff0000, v46
  v_cvt_pk_bf16_f32 v47, v47, v47
  v_and_b32 v47, 0xffff0000, v47
  v_mul_f32 v48, 0xbfb8aa3b, v32
  v_mul_f32 v49, 0xbfb8aa3b, v33
  v_mul_f32 v50, 0xbfb8aa3b, v34
  v_mul_f32 v51, 0xbfb8aa3b, v35
  v_mul_f32 v52, 0xbfb8aa3b, v36
  v_mul_f32 v53, 0xbfb8aa3b, v37
  v_mul_f32 v54, 0xbfb8aa3b, v38
  v_mul_f32 v55, 0xbfb8aa3b, v39
  v_exp_f32 v48, v48
  v_exp_f32 v49, v49
  v_exp_f32 v50, v50
  v_exp_f32 v51, v51
  v_exp_f32 v52, v52
  v_exp_f32 v53, v53
  v_exp_f32 v54, v54
  v_exp_f32 v55, v55
  v_add_f32 v48, 1.0, v48
  v_add_f32 v49, 1.0, v49
  v_add_f32 v50, 1.0, v50
  v_add_f32 v51, 1.0, v51
  v_add_f32 v52, 1.0, v52
  v_add_f32 v53, 1.0, v53
  v_add_f32 v54, 1.0, v54
  v_add_f32 v55, 1.0, v55
  v_rcp_f32 v48, v48
  v_rcp_f32 v49, v49
  v_rcp_f32 v50, v50
  v_rcp_f32 v51, v51
  v_rcp_f32 v52, v52
  v_rcp_f32 v53, v53
  v_rcp_f32 v54, v54
  v_rcp_f32 v55, v55
  v_mul_f32 v32, v32, v48
  v_mul_f32 v33, v33, v49
  v_mul_f32 v34, v34, v50
  v_mul_f32 v35, v35, v51
  v_mul_f32 v36, v36, v52
  v_mul_f32 v37, v37, v53
  v_mul_f32 v38, v38, v54
  v_mul_f32 v39, v39, v55
  v_cvt_pk_bf16_f32 v32, v32, v32
  v_and_b32 v32, 0xffff0000, v32
  v_cvt_pk_bf16_f32 v33, v33, v33
  v_and_b32 v33, 0xffff0000, v33
  v_cvt_pk_bf16_f32 v34, v34, v34
  v_and_b32 v34, 0xffff0000, v34
  v_cvt_pk_bf16_f32 v35, v35, v35
  v_and_b32 v35, 0xffff0000, v35
  v_cvt_pk_bf16_f32 v36, v36, v36
  v_and_b32 v36, 0xffff0000, v36
  v_cvt_pk_bf16_f32 v37, v37, v37
  v_and_b32 v37, 0xffff0000, v37
  v_cvt_pk_bf16_f32 v38, v38, v38
  v_and_b32 v38, 0xffff0000, v38
  v_cvt_pk_bf16_f32 v39, v39, v39
  v_and_b32 v39, 0xffff0000, v39
  v_mul_f32 v32, v32, v40
  v_mul_f32 v33, v33, v41
  v_mul_f32 v34, v34, v42
  v_mul_f32 v35, v35, v43
  v_mul_f32 v36, v36, v44
  v_mul_f32 v37, v37, v45
  v_mul_f32 v38, v38, v46
  v_mul_f32 v39, v39, v47
  v_cvt_pk_bf16_f32 v56, v32, v33
  v_cvt_pk_bf16_f32 v57, v34, v35
  v_cvt_pk_bf16_f32 v58, v36, v37
  v_cvt_pk_bf16_f32 v59, v38, v39
  s_nop 1
  v_mfma_f32_16x16x32_bf16 v[64:67], v[192:195], v[56:59], 0
  v_mfma_f32_16x16x32_bf16 v[68:71], v[196:199], v[56:59], 0
  v_mfma_f32_16x16x32_bf16 v[72:75], v[200:203], v[56:59], 0
  v_mfma_f32_16x16x32_bf16 v[76:79], v[204:207], v[56:59], 0
  v_mfma_f32_16x16x32_bf16 v[80:83], v[208:211], v[56:59], 0
  v_mfma_f32_16x16x32_bf16 v[84:87], v[212:215], v[56:59], 0
  v_mfma_f32_16x16x32_bf16 v[88:91], v[216:219], v[56:59], 0
  v_mfma_f32_16x16x32_bf16 v[92:95], v[220:223], v[56:59], 0
  v_mfma_f32_16x16x32_bf16 v[96:99], v[224:227], v[56:59], 0
  v_mfma_f32_16x16x32_bf16 v[100:103], v[228:231], v[56:59], 0
  s_nop 7
  buffer_store_dwordx4 v[64:67], v28, s[40:43], s23 offen offset:0 sc1
  buffer_store_dwordx4 v[68:71], v28, s[40:43], s23 offen offset:64 sc1
  buffer_store_dwordx4 v[72:75], v28, s[40:43], s23 offen offset:128 sc1
  buffer_store_dwordx4 v[76:79], v28, s[40:43], s23 offen offset:192 sc1
  buffer_store_dwordx4 v[80:83], v28, s[40:43], s23 offen offset:256 sc1
  buffer_store_dwordx4 v[84:87], v28, s[40:43], s23 offen offset:320 sc1
  buffer_store_dwordx4 v[88:91], v28, s[40:43], s23 offen offset:384 sc1
  buffer_store_dwordx4 v[92:95], v28, s[40:43], s23 offen offset:448 sc1
  buffer_store_dwordx4 v[96:99], v28, s[40:43], s23 offen offset:512 sc1
  buffer_store_dwordx4 v[100:103], v28, s[40:43], s23 offen offset:576 sc1
  s_lshl_b32 s23, s82, 2
  s_add_u32 s23, s23, 2650112
  s_cmp_eq_u32 s20, 0
  s_cselect_b32 s23, s23, 1073741824
  v_mov_b32 v20, 1
  v_writelane_b32 v21, s23, 0
  s_waitcnt vmcnt(0)
  s_barrier
  buffer_store_dword v20, v21, s[40:43], 0 offen sc1
fa_noffn:
fa_end:
  s_endpgm
fa_p1stubK:
  s_call_b64 s[76:77], fa_p1sub
  s_branch fa_p1backK
fa_p1stubV:
  s_call_b64 s[76:77], fa_p1sub
  s_branch fa_p1backV
fa_p1sub:
  s_cmp_eq_u32 s28, 0
  s_cbranch_scc0 fa_p1sub6
  s_cmp_eq_u32 s20, 0
  s_cselect_b32 s23, 0, 1073741824
  v_mov_b32 v16, 1073741824
  v_mov_b32 v17, 1
  v_writelane_b32 v16, s23, 0
  buffer_atomic_add v17, v16, s[56:59], 0 offen sc1
  s_and_b32 s29, s2, 1
  s_lshl_b32 s29, s29, 2
  s_add_u32 s29, s29, s20
  s_lshr_b32 s30, s2, 1
  s_mul_i32 s23, s30, 40960
  s_mul_i32 s31, s29, 160
  s_add_u32 s23, s23, s31
  s_mul_i32 s31, s20, 5120
  s_add_u32 s31, s31, 131072
  v_add_u32 v18, 0, v1
  v_mul_u32_u24 v19, 6554, v18
  v_lshrrev_b32 v19, 16, v19
  v_mul_u32_u24 v19, 1120, v19
  v_lshl_add_u32 v19, v18, 4, v19
  s_add_u32 m0, s31, 0
  s_nop 0
  buffer_load_dwordx4 v19, s[52:55], s23 offen lds
  v_add_u32 v18, 64, v1
  v_mul_u32_u24 v19, 6554, v18
  v_lshrrev_b32 v19, 16, v19
  v_mul_u32_u24 v19, 1120, v19
  v_lshl_add_u32 v19, v18, 4, v19
  s_add_u32 m0, s31, 1024
  s_nop 0
  buffer_load_dwordx4 v19, s[52:55], s23 offen lds
  v_add_u32 v18, 128, v1
  v_mul_u32_u24 v19, 6554, v18
  v_lshrrev_b32 v19, 16, v19
  v_mul_u32_u24 v19, 1120, v19
  v_lshl_add_u32 v19, v18, 4, v19
  s_add_u32 m0, s31, 2048
  s_nop 0
  buffer_load_dwordx4 v19, s[52:55], s23 offen lds
  v_add_u32 v18, 192, v1
  v_mul_u32_u24 v19, 6554, v18
  v_lshrrev_b32 v19, 16, v19
  v_mul_u32_u24 v19, 1120, v19
  v_lshl_add_u32 v19, v18, 4, v19
  s_add_u32 m0, s31, 3072
  s_nop 0
  buffer_load_dwordx4 v19, s[52:55], s23 offen lds
  v_add_u32 v18, 256, v1
  v_mul_u32_u24 v19, 6554, v18
  v_lshrrev_b32 v19, 16, v19
  v_mul_u32_u24 v19, 1120, v19
  v_lshl_add_u32 v19, v18, 4, v19
  s_add_u32 m0, s31, 4096
  s_nop 0
  buffer_load_dwordx4 v19, s[52:55], s23 offen lds
  s_setpc_b64 s[76:77]
fa_p1sub6:
  s_mov_b32 s34, 0
  s_mov_b32 s36, s60
  s_mov_b32 s37, s61
  s_lshl_b32 s23, s21, 8
  s_sub_u32 s38, 5242880, s23
  s_lshr_b32 s27, s20, 1
  s_lshl_b32 s27, s27, 18
  s_mov_b32 s25, 524288
  buffer_load_dword v228, v229, s[56:59], 0 offen sc1
  s_setpc_b64 s[76:77]
fa_qstub:
  s_cmp_eq_u32 s29, 1
  s_cbranch_scc0 fa_qstub3
  s_cmp_eq_u32 s20, 0
  s_cselect_b32 s23, s82, 1073741824
  s_cselect_b32 s31, 128, 1073741824
  v_mov_b32 v16, 1073741824
  v_mov_b32 v18, 1073741824
  v_mov_b32 v17, 1
  v_writelane_b32 v16, s23, 0
  v_writelane_b32 v18, s31, 0
  buffer_store_dword v17, v16, s[40:43], 0 offen sc1
  buffer_atomic_add v17, v18, s[56:59], 0 offen sc1
  s_branch fa_qback
fa_qstub3:
  s_cmp_eq_u32 s29, 3
  s_cbranch_scc0 fa_qstub4
  buffer_load_dword v228, v230, s[40:43], 0 offen sc1
  s_branch fa_qback
fa_qstub4:
  v_cmp_eq_u32 vcc, 0, v228
  s_cbranch_vccz fa_kv_ok
  s_mov_b32 s83, 200000
fa_kv_spin:
  s_sleep 4
  buffer_load_dword v228, v230, s[40:43], 0 offen sc1
  s_waitcnt vmcnt(0)
  v_cmp_eq_u32 vcc, 0, v228
  s_cbranch_vccz fa_kv_ok
  s_sub_u32 s83, s83, 1
  s_cmp_lg_u32 s83, 0
  s_cbranch_scc1 fa_kv_spin
fa_kv_ok:
  s_and_b32 s23, s20, 1
  s_lshl_b32 s23, s23, 12
  s_cmp_lt_u32 s20, 2
  s_cselect_b32 s60, 106496, 0
  s_add_u32 s60, s60, s23
  s_lshl_b32 s61, s20, 12
  s_mov_b32 m0, s60
  s_nop 0
  buffer_load_dwordx4 v2, s[44:47], s61 offen offset:0 sc1 lds
  buffer_load_dwordx4 v2, s[44:47], s61 offen offset:1024 sc1 lds
  buffer_load_dwordx4 v2, s[44:47], s61 offen offset:2048 sc1 lds
  buffer_load_dwordx4 v2, s[44:47], s61 offen offset:3072 sc1 lds
  s_add_u32 s61, s61, 16384
  s_add_u32 s60, s60, 32768
  s_and_b32 s60, s60, 0x1ffff
  s_mov_b32 m0, s60
  s_nop 0
  buffer_load_dwordx4 v2, s[44:47], s61 offen offset:0 sc1 lds
  buffer_load_dwordx4 v2, s[44:47], s61 offen offset:1024 sc1 lds
  buffer_load_dwordx4 v2, s[44:47], s61 offen offset:2048 sc1 lds
  buffer_load_dwordx4 v2, s[44:47], s61 offen offset:3072 sc1 lds
  s_add_u32 s61, s61, 16384
  s_add_u32 s60, s60, 32768
  s_and_b32 s60, s60, 0x1ffff
  s_mov_b32 m0, s60
  s_nop 0
  buffer_load_dwordx4 v2, s[44:47], s61 offen offset:0 sc1 lds
  buffer_load_dwordx4 v2, s[44:47], s61 offen offset:1024 sc1 lds
  buffer_load_dwordx4 v2, s[44:47], s61 offen offset:2048 sc1 lds
  buffer_load_dwordx4 v2, s[44:47], s61 offen offset:3072 sc1 lds
  s_add_u32 s61, s61, 16384
  s_add_u32 s60, s60, 32768
  s_and_b32 s60, s60, 0x1ffff
  v_and_b32 v16, 7, v1
  v_lshlrev_b32 v16, 2, v16
  s_mov_b32 s23, 2629632
  buffer_load_dword v228, v16, s[40:43], s23 offen sc1
  s_branch fa_qback
fa_stub0:
  s_call_b64 s[76:77], fa_rare00
  s_call_b64 s[76:77], fa_rare10
  s_branch fa_back0
fa_stub1:
  s_call_b64 s[76:77], fa_rare01
  s_call_b64 s[76:77], fa_rare11
  s_branch fa_back1
fa_stub2:
  s_call_b64 s[76:77], fa_rare00
  s_call_b64 s[76:77], fa_rare10
  s_branch fa_back2
fa_stub3:
  s_call_b64 s[76:77], fa_rare01
  s_call_b64 s[76:77], fa_rare11
  s_branch fa_back3
fa_stub4:
  s_call_b64 s[76:77], fa_rare00
  s_call_b64 s[76:77], fa_rare10
  s_branch fa_back4
fa_stub5:
  s_call_b64 s[76:77], fa_rare11
  s_branch fa_back5
fa_stub6:
  s_call_b64 s[76:77], fa_rare10
  s_branch fa_back6
fa_stub7:
  s_call_b64 s[76:77], fa_rare01
  s_call_b64 s[76:77], fa_rare11
  s_branch fa_back7
fa_stub8:
  s_call_b64 s[76:77], fa_rare10
  s_branch fa_back8
fa_stub9:
  s_call_b64 s[76:77], fa_rare11
  s_branch fa_back9
fa_stub10:
  s_call_b64 s[76:77], fa_rare10
  s_branch fa_back10
fa_stub11:
  s_call_b64 s[76:77], fa_rare11
  s_branch fa_back11
fa_stub12:
  s_call_b64 s[76:77], fa_rare10
  s_branch fa_back12
fa_stub13:
  s_call_b64 s[76:77], fa_rare11
  s_branch fa_back13
fa_rare00:
  s_nop 7
  v_max3_f32 v16, v96, v97, v98
  v_max3_f32 v16, v16, v99, v100
  v_max3_f32 v16, v16, v101, v102
  v_max3_f32 v16, v16, v103, 0
  v_mov_b32 v18, v16
  s_nop 1
  v_permlane16_swap_b32 v16, v18
  v_max_f32 v16, v16, v18
  v_mov_b32 v18, v16
  s_nop 1
  v_permlane32_swap_b32 v16, v18
  v_max_f32 v16, v16, v18
  v_sub_f32 v96, v96, v16
  v_sub_f32 v112, v112, v16
  v_sub_f32 v97, v97, v16
  v_sub_f32 v113, v113, v16
  v_sub_f32 v98, v98, v16
  v_sub_f32 v114, v114, v16
  v_sub_f32 v99, v99, v16
  v_sub_f32 v115, v115, v16
  v_sub_f32 v100, v100, v16
  v_sub_f32 v116, v116, v16
  v_sub_f32 v101, v101, v16
  v_sub_f32 v117, v117, v16
  v_sub_f32 v102, v102, v16
  v_sub_f32 v118, v118, v16
  v_sub_f32 v103, v103, v16
  v_sub_f32 v119, v119, v16
  v_max3_f32 v17, v104, v105, v106
  v_max3_f32 v17, v17, v107, v108
  v_max3_f32 v17, v17, v109, v110
  v_max3_f32 v17, v17, v111, 0
  v_mov_b32 v18, v17
  s_nop 1
  v_permlane16_swap_b32 v17, v18
  v_max_f32 v17, v17, v18
  v_mov_b32 v18, v17
  s_nop 1
  v_permlane32_swap_b32 v17, v18
  v_max_f32 v17, v17, v18
  v_sub_f32 v104, v104, v17
  v_sub_f32 v120, v120, v17
  v_sub_f32 v105, v105, v17
  v_sub_f32 v121, v121, v17
  v_sub_f32 v106, v106, v17
  v_sub_f32 v122, v122, v17
  v_sub_f32 v107, v107, v17
  v_sub_f32 v123, v123, v17
  v_sub_f32 v108, v108, v17
  v_sub_f32 v124, v124, v17
  v_sub_f32 v109, v109, v17
  v_sub_f32 v125, v125, v17
  v_sub_f32 v110, v110, v17
  v_sub_f32 v126, v126, v17
  v_sub_f32 v111, v111, v17
  v_sub_f32 v127, v127, v17
  s_call_b64 s[78:79], fa_resc0
  v_exp_f32 v208, v96
  v_exp_f32 v209, v97
  v_exp_f32 v210, v98
  v_add_f32 v224, v208, v209
  v_cvt_pk_bf16_f32 v160, v208, v209
  v_exp_f32 v211, v99
  v_add_f32 v224, v224, v210
  v_exp_f32 v212, v100
  v_add_f32 v224, v224, v211
  v_cvt_pk_bf16_f32 v161, v210, v211
  v_exp_f32 v213, v101
  v_add_f32 v224, v224, v212
  v_exp_f32 v214, v102
  v_add_f32 v224, v224, v213
  v_cvt_pk_bf16_f32 v162, v212, v213
  v_exp_f32 v215, v103
  v_add_f32 v224, v224, v214
  v_exp_f32 v208, v104
  v_add_f32 v224, v224, v215
  v_cvt_pk_bf16_f32 v163, v214, v215
  v_exp_f32 v209, v105
  v_exp_f32 v210, v106
  v_add_f32 v225, v208, v209
  v_cvt_pk_bf16_f32 v164, v208, v209
  v_exp_f32 v211, v107
  v_add_f32 v225, v225, v210
  v_exp_f32 v212, v108
  v_add_f32 v225, v225, v211
  v_cvt_pk_bf16_f32 v165, v210, v211
  v_exp_f32 v213, v109
  v_add_f32 v225, v225, v212
  v_exp_f32 v214, v110
  v_add_f32 v225, v225, v213
  v_cvt_pk_bf16_f32 v166, v212, v213
  v_exp_f32 v215, v111
  v_add_f32 v225, v225, v214
  s_nop 0
  v_add_f32 v225, v225, v215
  v_cvt_pk_bf16_f32 v167, v214, v215
  s_nop 1
  s_setpc_b64 s[76:77]
fa_rare01:
  s_nop 7
  v_max3_f32 v16, v112, v113, v114
  v_max3_f32 v16, v16, v115, v116
  v_max3_f32 v16, v16, v117, v118
  v_max3_f32 v16, v16, v119, 0
  v_mov_b32 v18, v16
  s_nop 1
  v_permlane16_swap_b32 v16, v18
  v_max_f32 v16, v16, v18
  v_mov_b32 v18, v16
  s_nop 1
  v_permlane32_swap_b32 v16, v18
  v_max_f32 v16, v16, v18
  v_sub_f32 v112, v112, v16
  v_sub_f32 v96, v96, v16
  v_sub_f32 v113, v113, v16
  v_sub_f32 v97, v97, v16
  v_sub_f32 v114, v114, v16
  v_sub_f32 v98, v98, v16
  v_sub_f32 v115, v115, v16
  v_sub_f32 v99, v99, v16
  v_sub_f32 v116, v116, v16
  v_sub_f32 v100, v100, v16
  v_sub_f32 v117, v117, v16
  v_sub_f32 v101, v101, v16
  v_sub_f32 v118, v118, v16
  v_sub_f32 v102, v102, v16
  v_sub_f32 v119, v119, v16
  v_sub_f32 v103, v103, v16
  v_max3_f32 v17, v120, v121, v122
  v_max3_f32 v17, v17, v123, v124
  v_max3_f32 v17, v17, v125, v126
  v_max3_f32 v17, v17, v127, 0
  v_mov_b32 v18, v17
  s_nop 1
  v_permlane16_swap_b32 v17, v18
  v_max_f32 v17, v17, v18
  v_mov_b32 v18, v17
  s_nop 1
  v_permlane32_swap_b32 v17, v18
  v_max_f32 v17, v17, v18
  v_sub_f32 v120, v120, v17
  v_sub_f32 v104, v104, v17
  v_sub_f32 v121, v121, v17
  v_sub_f32 v105, v105, v17
  v_sub_f32 v122, v122, v17
  v_sub_f32 v106, v106, v17
  v_sub_f32 v123, v123, v17
  v_sub_f32 v107, v107, v17
  v_sub_f32 v124, v124, v17
  v_sub_f32 v108, v108, v17
  v_sub_f32 v125, v125, v17
  v_sub_f32 v109, v109, v17
  v_sub_f32 v126, v126, v17
  v_sub_f32 v110, v110, v17
  v_sub_f32 v127, v127, v17
  v_sub_f32 v111, v111, v17
  s_call_b64 s[78:79], fa_resc0
  v_exp_f32 v208, v112
  v_exp_f32 v209, v113
  v_exp_f32 v210, v114
  v_add_f32 v224, v208, v209
  v_cvt_pk_bf16_f32 v168, v208, v209
  v_exp_f32 v211, v115
  v_add_f32 v224, v224, v210
  v_exp_f32 v212, v116
  v_add_f32 v224, v224, v211
  v_cvt_pk_bf16_f32 v169, v210, v211
  v_exp_f32 v213, v117
  v_add_f32 v224, v224, v212
  v_exp_f32 v214, v118
  v_add_f32 v224, v224, v213
  v_cvt_pk_bf16_f32 v170, v212, v213
  v_exp_f32 v215, v119
  v_add_f32 v224, v224, v214
  v_exp_f32 v208, v120
  v_add_f32 v224, v224, v215
  v_cvt_pk_bf16_f32 v171, v214, v215
  v_exp_f32 v209, v121
  v_exp_f32 v210, v122
  v_add_f32 v225, v208, v209
  v_cvt_pk_bf16_f32 v172, v208, v209
  v_exp_f32 v211, v123
  v_add_f32 v225, v225, v210
  v_exp_f32 v212, v124
  v_add_f32 v225, v225, v211
  v_cvt_pk_bf16_f32 v173, v210, v211
  v_exp_f32 v213, v125
  v_add_f32 v225, v225, v212
  v_exp_f32 v214, v126
  v_add_f32 v225, v225, v213
  v_cvt_pk_bf16_f32 v174, v212, v213
  v_exp_f32 v215, v127
  v_add_f32 v225, v225, v214
  s_nop 0
  v_add_f32 v225, v225, v215
  v_cvt_pk_bf16_f32 v175, v214, v215
  s_nop 1
  s_setpc_b64 s[76:77]
fa_resc0:
  v_sub_f32 v192, v192, v16
  v_sub_f32 v193, v193, v16
  v_sub_f32 v194, v194, v16
  v_sub_f32 v195, v195, v16
  v_exp_f32 v18, -v16
  v_sub_f32 v196, v196, v17
  v_sub_f32 v197, v197, v17
  v_sub_f32 v198, v198, v17
  v_sub_f32 v199, v199, v17
  v_exp_f32 v19, -v17
  s_nop 0
  v_mul_f32 v228, v228, v18
  v_mul_f32 v229, v229, v19
  v_accvgpr_read_b32 v20, a0
  v_accvgpr_read_b32 v21, a1
  v_accvgpr_read_b32 v22, a2
  v_accvgpr_read_b32 v23, a3
  v_mul_f32 v20, v20, v18
  v_mul_f32 v21, v21, v18
  v_mul_f32 v22, v22, v18
  v_mul_f32 v23, v23, v18
  v_accvgpr_write_b32 a0, v20
  v_accvgpr_write_b32 a1, v21
  v_accvgpr_write_b32 a2, v22
  v_accvgpr_write_b32 a3, v23
  v_accvgpr_read_b32 v20, a4
  v_accvgpr_read_b32 v21, a5
  v_accvgpr_read_b32 v22, a6
  v_accvgpr_read_b32 v23, a7
  v_mul_f32 v20, v20, v19
  v_mul_f32 v21, v21, v19
  v_mul_f32 v22, v22, v19
  v_mul_f32 v23, v23, v19
  v_accvgpr_write_b32 a4, v20
  v_accvgpr_write_b32 a5, v21
  v_accvgpr_write_b32 a6, v22
  v_accvgpr_write_b32 a7, v23
  v_accvgpr_read_b32 v20, a8
  v_accvgpr_read_b32 v21, a9
  v_accvgpr_read_b32 v22, a10
  v_accvgpr_read_b32 v23, a11
  v_mul_f32 v20, v20, v18
  v_mul_f32 v21, v21, v18
  v_mul_f32 v22, v22, v18
  v_mul_f32 v23, v23, v18
  v_accvgpr_write_b32 a8, v20
  v_accvgpr_write_b32 a9, v21
  v_accvgpr_write_b32 a10, v22
  v_accvgpr_write_b32 a11, v23
  v_accvgpr_read_b32 v20, a12
  v_accvgpr_read_b32 v21, a13
  v_accvgpr_read_b32 v22, a14
  v_accvgpr_read_b32 v23, a15
  v_mul_f32 v20, v20, v19
  v_mul_f32 v21, v21, v19
  v_mul_f32 v22, v22, v19
  v_mul_f32 v23, v23, v19
  v_accvgpr_write_b32 a12, v20
  v_accvgpr_write_b32 a13, v21
  v_accvgpr_write_b32 a14, v22
  v_accvgpr_write_b32 a15, v23
  v_accvgpr_read_b32 v20, a16
  v_accvgpr_read_b32 v21, a17
  v_accvgpr_read_b32 v22, a18
  v_accvgpr_read_b32 v23, a19
  v_mul_f32 v20, v20, v18
  v_mul_f32 v21, v21, v18
  v_mul_f32 v22, v22, v18
  v_mul_f32 v23, v23, v18
  v_accvgpr_write_b32 a16, v20
  v_accvgpr_write_b32 a17, v21
  v_accvgpr_write_b32 a18, v22
  v_accvgpr_write_b32 a19, v23
  v_accvgpr_read_b32 v20, a20
  v_accvgpr_read_b32 v21, a21
  v_accvgpr_read_b32 v22, a22
  v_accvgpr_read_b32 v23, a23
  v_mul_f32 v20, v20, v19
  v_mul_f32 v21, v21, v19
  v_mul_f32 v22, v22, v19
  v_mul_f32 v23, v23, v19
  v_accvgpr_write_b32 a20, v20
  v_accvgpr_write_b32 a21, v21
  v_accvgpr_write_b32 a22, v22
  v_accvgpr_write_b32 a23, v23
  v_accvgpr_read_b32 v20, a24
  v_accvgpr_read_b32 v21, a25
  v_accvgpr_read_b32 v22, a26
  v_accvgpr_read_b32 v23, a27
  v_mul_f32 v20, v20, v18
  v_mul_f32 v21, v21, v18
  v_mul_f32 v22, v22, v18
  v_mul_f32 v23, v23, v18
  v_accvgpr_write_b32 a24, v20
  v_accvgpr_write_b32 a25, v21
  v_accvgpr_write_b32 a26, v22
  v_accvgpr_write_b32 a27, v23
  v_accvgpr_read_b32 v20, a28
  v_accvgpr_read_b32 v21, a29
  v_accvgpr_read_b32 v22, a30
  v_accvgpr_read_b32 v23, a31
  v_mul_f32 v20, v20, v19
  v_mul_f32 v21, v21, v19
  v_mul_f32 v22, v22, v19
  v_mul_f32 v23, v23, v19
  v_accvgpr_write_b32 a28, v20
  v_accvgpr_write_b32 a29, v21
  v_accvgpr_write_b32 a30, v22
  v_accvgpr_write_b32 a31, v23
  v_accvgpr_read_b32 v20, a32
  v_accvgpr_read_b32 v21, a33
  v_accvgpr_read_b32 v22, a34
  v_accvgpr_read_b32 v23, a35
  v_mul_f32 v20, v20, v18
  v_mul_f32 v21, v21, v18
  v_mul_f32 v22, v22, v18
  v_mul_f32 v23, v23, v18
  v_accvgpr_write_b32 a32, v20
  v_accvgpr_write_b32 a33, v21
  v_accvgpr_write_b32 a34, v22
  v_accvgpr_write_b32 a35, v23
  v_accvgpr_read_b32 v20, a36
  v_accvgpr_read_b32 v21, a37
  v_accvgpr_read_b32 v22, a38
  v_accvgpr_read_b32 v23, a39
  v_mul_f32 v20, v20, v19
  v_mul_f32 v21, v21, v19
  v_mul_f32 v22, v22, v19
  v_mul_f32 v23, v23, v19
  v_accvgpr_write_b32 a36, v20
  v_accvgpr_write_b32 a37, v21
  v_accvgpr_write_b32 a38, v22
  v_accvgpr_write_b32 a39, v23
  v_accvgpr_read_b32 v20, a40
  v_accvgpr_read_b32 v21, a41
  v_accvgpr_read_b32 v22, a42
  v_accvgpr_read_b32 v23, a43
  v_mul_f32 v20, v20, v18
  v_mul_f32 v21, v21, v18
  v_mul_f32 v22, v22, v18
  v_mul_f32 v23, v23, v18
  v_accvgpr_write_b32 a40, v20
  v_accvgpr_write_b32 a41, v21
  v_accvgpr_write_b32 a42, v22
  v_accvgpr_write_b32 a43, v23
  v_accvgpr_read_b32 v20, a44
  v_accvgpr_read_b32 v21, a45
  v_accvgpr_read_b32 v22, a46
  v_accvgpr_read_b32 v23, a47
  v_mul_f32 v20, v20, v19
  v_mul_f32 v21, v21, v19
  v_mul_f32 v22, v22, v19
  v_mul_f32 v23, v23, v19
  v_accvgpr_write_b32 a44, v20
  v_accvgpr_write_b32 a45, v21
  v_accvgpr_write_b32 a46, v22
  v_accvgpr_write_b32 a47, v23
  v_accvgpr_read_b32 v20, a48
  v_accvgpr_read_b32 v21, a49
  v_accvgpr_read_b32 v22, a50
  v_accvgpr_read_b32 v23, a51
  v_mul_f32 v20, v20, v18
  v_mul_f32 v21, v21, v18
  v_mul_f32 v22, v22, v18
  v_mul_f32 v23, v23, v18
  v_accvgpr_write_b32 a48, v20
  v_accvgpr_write_b32 a49, v21
  v_accvgpr_write_b32 a50, v22
  v_accvgpr_write_b32 a51, v23
  v_accvgpr_read_b32 v20, a52
  v_accvgpr_read_b32 v21, a53
  v_accvgpr_read_b32 v22, a54
  v_accvgpr_read_b32 v23, a55
  v_mul_f32 v20, v20, v19
  v_mul_f32 v21, v21, v19
  v_mul_f32 v22, v22, v19
  v_mul_f32 v23, v23, v19
  v_accvgpr_write_b32 a52, v20
  v_accvgpr_write_b32 a53, v21
  v_accvgpr_write_b32 a54, v22
  v_accvgpr_write_b32 a55, v23
  v_accvgpr_read_b32 v20, a56
  v_accvgpr_read_b32 v21, a57
  v_accvgpr_read_b32 v22, a58
  v_accvgpr_read_b32 v23, a59
  v_mul_f32 v20, v20, v18
  v_mul_f32 v21, v21, v18
  v_mul_f32 v22, v22, v18
  v_mul_f32 v23, v23, v18
  v_accvgpr_write_b32 a56, v20
  v_accvgpr_write_b32 a57, v21
  v_accvgpr_write_b32 a58, v22
  v_accvgpr_write_b32 a59, v23
  v_accvgpr_read_b32 v20, a60
  v_accvgpr_read_b32 v21, a61
  v_accvgpr_read_b32 v22, a62
  v_accvgpr_read_b32 v23, a63
  v_mul_f32 v20, v20, v19
  v_mul_f32 v21, v21, v19
  v_mul_f32 v22, v22, v19
  v_mul_f32 v23, v23, v19
  v_accvgpr_write_b32 a60, v20
  v_accvgpr_write_b32 a61, v21
  v_accvgpr_write_b32 a62, v22
  v_accvgpr_write_b32 a63, v23
  s_setpc_b64 s[78:79]
fa_rare10:
  s_nop 7
  v_max3_f32 v16, v128, v129, v130
  v_max3_f32 v16, v16, v131, v132
  v_max3_f32 v16, v16, v133, v134
  v_max3_f32 v16, v16, v135, 0
  v_mov_b32 v18, v16
  s_nop 1
  v_permlane16_swap_b32 v16, v18
  v_max_f32 v16, v16, v18
  v_mov_b32 v18, v16
  s_nop 1
  v_permlane32_swap_b32 v16, v18
  v_max_f32 v16, v16, v18
  v_sub_f32 v128, v128, v16
  v_sub_f32 v144, v144, v16
  v_sub_f32 v129, v129, v16
  v_sub_f32 v145, v145, v16
  v_sub_f32 v130, v130, v16
  v_sub_f32 v146, v146, v16
  v_sub_f32 v131, v131, v16
  v_sub_f32 v147, v147, v16
  v_sub_f32 v132, v132, v16
  v_sub_f32 v148, v148, v16
  v_sub_f32 v133, v133, v16
  v_sub_f32 v149, v149, v16
  v_sub_f32 v134, v134, v16
  v_sub_f32 v150, v150, v16
  v_sub_f32 v135, v135, v16
  v_sub_f32 v151, v151, v16
  v_max3_f32 v17, v136, v137, v138
  v_max3_f32 v17, v17, v139, v140
  v_max3_f32 v17, v17, v141, v142
  v_max3_f32 v17, v17, v143, 0
  v_mov_b32 v18, v17
  s_nop 1
  v_permlane16_swap_b32 v17, v18
  v_max_f32 v17, v17, v18
  v_mov_b32 v18, v17
  s_nop 1
  v_permlane32_swap_b32 v17, v18
  v_max_f32 v17, v17, v18
  v_sub_f32 v136, v136, v17
  v_sub_f32 v152, v152, v17
  v_sub_f32 v137, v137, v17
  v_sub_f32 v153, v153, v17
  v_sub_f32 v138, v138, v17
  v_sub_f32 v154, v154, v17
  v_sub_f32 v139, v139, v17
  v_sub_f32 v155, v155, v17
  v_sub_f32 v140, v140, v17
  v_sub_f32 v156, v156, v17
  v_sub_f32 v141, v141, v17
  v_sub_f32 v157, v157, v17
  v_sub_f32 v142, v142, v17
  v_sub_f32 v158, v158, v17
  v_sub_f32 v143, v143, v17
  v_sub_f32 v159, v159, v17
  s_call_b64 s[78:79], fa_resc1
  v_exp_f32 v216, v128
  v_exp_f32 v217, v129
  v_exp_f32 v218, v130
  v_add_f32 v226, v216, v217
  v_cvt_pk_bf16_f32 v176, v216, v217
  v_exp_f32 v219, v131
  v_add_f32 v226, v226, v218
  v_exp_f32 v220, v132
  v_add_f32 v226, v226, v219
  v_cvt_pk_bf16_f32 v177, v218, v219
  v_exp_f32 v221, v133
  v_add_f32 v226, v226, v220
  v_exp_f32 v222, v134
  v_add_f32 v226, v226, v221
  v_cvt_pk_bf16_f32 v178, v220, v221
  v_exp_f32 v223, v135
  v_add_f32 v226, v226, v222
  v_exp_f32 v216, v136
  v_add_f32 v226, v226, v223
  v_cvt_pk_bf16_f32 v179, v222, v223
  v_exp_f32 v217, v137
  v_exp_f32 v218, v138
  v_add_f32 v227, v216, v217
  v_cvt_pk_bf16_f32 v180, v216, v217
  v_exp_f32 v219, v139
  v_add_f32 v227, v227, v218
  v_exp_f32 v220, v140
  v_add_f32 v227, v227, v219
  v_cvt_pk_bf16_f32 v181, v218, v219
  v_exp_f32 v221, v141
  v_add_f32 v227, v227, v220
  v_exp_f32 v222, v142
  v_add_f32 v227, v227, v221
  v_cvt_pk_bf16_f32 v182, v220, v221
  v_exp_f32 v223, v143
  v_add_f32 v227, v227, v222
  s_nop 0
  v_add_f32 v227, v227, v223
  v_cvt_pk_bf16_f32 v183, v222, v223
  s_nop 1
  s_setpc_b64 s[76:77]
fa_rare11:
  s_nop 7
  v_max3_f32 v16, v144, v145, v146
  v_max3_f32 v16, v16, v147, v148
  v_max3_f32 v16, v16, v149, v150
  v_max3_f32 v16, v16, v151, 0
  v_mov_b32 v18, v16
  s_nop 1
  v_permlane16_swap_b32 v16, v18
  v_max_f32 v16, v16, v18
  v_mov_b32 v18, v16
  s_nop 1
  v_permlane32_swap_b32 v16, v18
  v_max_f32 v16, v16, v18
  v_sub_f32 v144, v144, v16
  v_sub_f32 v128, v128, v16
  v_sub_f32 v145, v145, v16
  v_sub_f32 v129, v129, v16
  v_sub_f32 v146, v146, v16
  v_sub_f32 v130, v130, v16
  v_sub_f32 v147, v147, v16
  v_sub_f32 v131, v131, v16
  v_sub_f32 v148, v148, v16
  v_sub_f32 v132, v132, v16
  v_sub_f32 v149, v149, v16
  v_sub_f32 v133, v133, v16
  v_sub_f32 v150, v150, v16
  v_sub_f32 v134, v134, v16
  v_sub_f32 v151, v151, v16
  v_sub_f32 v135, v135, v16
  v_max3_f32 v17, v152, v153, v154
  v_max3_f32 v17, v17, v155, v156
  v_max3_f32 v17, v17, v157, v158
  v_max3_f32 v17, v17, v159, 0
  v_mov_b32 v18, v17
  s_nop 1
  v_permlane16_swap_b32 v17, v18
  v_max_f32 v17, v17, v18
  v_mov_b32 v18, v17
  s_nop 1
  v_permlane32_swap_b32 v17, v18
  v_max_f32 v17, v17, v18
  v_sub_f32 v152, v152, v17
  v_sub_f32 v136, v136, v17
  v_sub_f32 v153, v153, v17
  v_sub_f32 v137, v137, v17
  v_sub_f32 v154, v154, v17
  v_sub_f32 v138, v138, v17
  v_sub_f32 v155, v155, v17
  v_sub_f32 v139, v139, v17
  v_sub_f32 v156, v156, v17
  v_sub_f32 v140, v140, v17
  v_sub_f32 v157, v157, v17
  v_sub_f32 v141, v141, v17
  v_sub_f32 v158, v158, v17
  v_sub_f32 v142, v142, v17
  v_sub_f32 v159, v159, v17
  v_sub_f32 v143, v143, v17
  s_call_b64 s[78:79], fa_resc1
  v_exp_f32 v216, v144
  v_exp_f32 v217, v145
  v_exp_f32 v218, v146
  v_add_f32 v226, v216, v217
  v_cvt_pk_bf16_f32 v184, v216, v217
  v_exp_f32 v219, v147
  v_add_f32 v226, v226, v218
  v_exp_f32 v220, v148
  v_add_f32 v226, v226, v219
  v_cvt_pk_bf16_f32 v185, v218, v219
  v_exp_f32 v221, v149
  v_add_f32 v226, v226, v220
  v_exp_f32 v222, v150
  v_add_f32 v226, v226, v221
  v_cvt_pk_bf16_f32 v186, v220, v221
  v_exp_f32 v223, v151
  v_add_f32 v226, v226, v222
  v_exp_f32 v216, v152
  v_add_f32 v226, v226, v223
  v_cvt_pk_bf16_f32 v187, v222, v223
  v_exp_f32 v217, v153
  v_exp_f32 v218, v154
  v_add_f32 v227, v216, v217
  v_cvt_pk_bf16_f32 v188, v216, v217
  v_exp_f32 v219, v155
  v_add_f32 v227, v227, v218
  v_exp_f32 v220, v156
  v_add_f32 v227, v227, v219
  v_cvt_pk_bf16_f32 v189, v218, v219
  v_exp_f32 v221, v157
  v_add_f32 v227, v227, v220
  v_exp_f32 v222, v158
  v_add_f32 v227, v227, v221
  v_cvt_pk_bf16_f32 v190, v220, v221
  v_exp_f32 v223, v159
  v_add_f32 v227, v227, v222
  s_nop 0
  v_add_f32 v227, v227, v223
  v_cvt_pk_bf16_f32 v191, v222, v223
  s_nop 1
  s_setpc_b64 s[76:77]
fa_resc1:
  v_sub_f32 v200, v200, v16
  v_sub_f32 v201, v201, v16
  v_sub_f32 v202, v202, v16
  v_sub_f32 v203, v203, v16
  v_exp_f32 v18, -v16
  v_sub_f32 v204, v204, v17
  v_sub_f32 v205, v205, v17
  v_sub_f32 v206, v206, v17
  v_sub_f32 v207, v207, v17
  v_exp_f32 v19, -v17
  s_nop 0
  v_mul_f32 v230, v230, v18
  v_mul_f32 v231, v231, v19
  v_accvgpr_read_b32 v20, a64
  v_accvgpr_read_b32 v21, a65
  v_accvgpr_read_b32 v22, a66
  v_accvgpr_read_b32 v23, a67
  v_mul_f32 v20, v20, v18
  v_mul_f32 v21, v21, v18
  v_mul_f32 v22, v22, v18
  v_mul_f32 v23, v23, v18
  v_accvgpr_write_b32 a64, v20
  v_accvgpr_write_b32 a65, v21
  v_accvgpr_write_b32 a66, v22
  v_accvgpr_write_b32 a67, v23
  v_accvgpr_read_b32 v20, a68
  v_accvgpr_read_b32 v21, a69
  v_accvgpr_read_b32 v22, a70
  v_accvgpr_read_b32 v23, a71
  v_mul_f32 v20, v20, v19
  v_mul_f32 v21, v21, v19
  v_mul_f32 v22, v22, v19
  v_mul_f32 v23, v23, v19
  v_accvgpr_write_b32 a68, v20
  v_accvgpr_write_b32 a69, v21
  v_accvgpr_write_b32 a70, v22
  v_accvgpr_write_b32 a71, v23
  v_accvgpr_read_b32 v20, a72
  v_accvgpr_read_b32 v21, a73
  v_accvgpr_read_b32 v22, a74
  v_accvgpr_read_b32 v23, a75
  v_mul_f32 v20, v20, v18
  v_mul_f32 v21, v21, v18
  v_mul_f32 v22, v22, v18
  v_mul_f32 v23, v23, v18
  v_accvgpr_write_b32 a72, v20
  v_accvgpr_write_b32 a73, v21
  v_accvgpr_write_b32 a74, v22
  v_accvgpr_write_b32 a75, v23
  v_accvgpr_read_b32 v20, a76
  v_accvgpr_read_b32 v21, a77
  v_accvgpr_read_b32 v22, a78
  v_accvgpr_read_b32 v23, a79
  v_mul_f32 v20, v20, v19
  v_mul_f32 v21, v21, v19
  v_mul_f32 v22, v22, v19
  v_mul_f32 v23, v23, v19
  v_accvgpr_write_b32 a76, v20
  v_accvgpr_write_b32 a77, v21
  v_accvgpr_write_b32 a78, v22
  v_accvgpr_write_b32 a79, v23
  v_accvgpr_read_b32 v20, a80
  v_accvgpr_read_b32 v21, a81
  v_accvgpr_read_b32 v22, a82
  v_accvgpr_read_b32 v23, a83
  v_mul_f32 v20, v20, v18
  v_mul_f32 v21, v21, v18
  v_mul_f32 v22, v22, v18
  v_mul_f32 v23, v23, v18
  v_accvgpr_write_b32 a80, v20
  v_accvgpr_write_b32 a81, v21
  v_accvgpr_write_b32 a82, v22
  v_accvgpr_write_b32 a83, v23
  v_accvgpr_read_b32 v20, a84
  v_accvgpr_read_b32 v21, a85
  v_accvgpr_read_b32 v22, a86
  v_accvgpr_read_b32 v23, a87
  v_mul_f32 v20, v20, v19
  v_mul_f32 v21, v21, v19
  v_mul_f32 v22, v22, v19
  v_mul_f32 v23, v23, v19
  v_accvgpr_write_b32 a84, v20
  v_accvgpr_write_b32 a85, v21
  v_accvgpr_write_b32 a86, v22
  v_accvgpr_write_b32 a87, v23
  v_accvgpr_read_b32 v20, a88
  v_accvgpr_read_b32 v21, a89
  v_accvgpr_read_b32 v22, a90
  v_accvgpr_read_b32 v23, a91
  v_mul_f32 v20, v20, v18
  v_mul_f32 v21, v21, v18
  v_mul_f32 v22, v22, v18
  v_mul_f32 v23, v23, v18
  v_accvgpr_write_b32 a88, v20
  v_accvgpr_write_b32 a89, v21
  v_accvgpr_write_b32 a90, v22
  v_accvgpr_write_b32 a91, v23
  v_accvgpr_read_b32 v20, a92
  v_accvgpr_read_b32 v21, a93
  v_accvgpr_read_b32 v22, a94
  v_accvgpr_read_b32 v23, a95
  v_mul_f32 v20, v20, v19
  v_mul_f32 v21, v21, v19
  v_mul_f32 v22, v22, v19
  v_mul_f32 v23, v23, v19
  v_accvgpr_write_b32 a92, v20
  v_accvgpr_write_b32 a93, v21
  v_accvgpr_write_b32 a94, v22
  v_accvgpr_write_b32 a95, v23
  v_accvgpr_read_b32 v20, a96
  v_accvgpr_read_b32 v21, a97
  v_accvgpr_read_b32 v22, a98
  v_accvgpr_read_b32 v23, a99
  v_mul_f32 v20, v20, v18
  v_mul_f32 v21, v21, v18
  v_mul_f32 v22, v22, v18
  v_mul_f32 v23, v23, v18
  v_accvgpr_write_b32 a96, v20
  v_accvgpr_write_b32 a97, v21
  v_accvgpr_write_b32 a98, v22
  v_accvgpr_write_b32 a99, v23
  v_accvgpr_read_b32 v20, a100
  v_accvgpr_read_b32 v21, a101
  v_accvgpr_read_b32 v22, a102
  v_accvgpr_read_b32 v23, a103
  v_mul_f32 v20, v20, v19
  v_mul_f32 v21, v21, v19
  v_mul_f32 v22, v22, v19
  v_mul_f32 v23, v23, v19
  v_accvgpr_write_b32 a100, v20
  v_accvgpr_write_b32 a101, v21
  v_accvgpr_write_b32 a102, v22
  v_accvgpr_write_b32 a103, v23
  v_accvgpr_read_b32 v20, a104
  v_accvgpr_read_b32 v21, a105
  v_accvgpr_read_b32 v22, a106
  v_accvgpr_read_b32 v23, a107
  v_mul_f32 v20, v20, v18
  v_mul_f32 v21, v21, v18
  v_mul_f32 v22, v22, v18
  v_mul_f32 v23, v23, v18
  v_accvgpr_write_b32 a104, v20
  v_accvgpr_write_b32 a105, v21
  v_accvgpr_write_b32 a106, v22
  v_accvgpr_write_b32 a107, v23
  v_accvgpr_read_b32 v20, a108
  v_accvgpr_read_b32 v21, a109
  v_accvgpr_read_b32 v22, a110
  v_accvgpr_read_b32 v23, a111
  v_mul_f32 v20, v20, v19
  v_mul_f32 v21, v21, v19
  v_mul_f32 v22, v22, v19
  v_mul_f32 v23, v23, v19
  v_accvgpr_write_b32 a108, v20
  v_accvgpr_write_b32 a109, v21
  v_accvgpr_write_b32 a110, v22
  v_accvgpr_write_b32 a111, v23
  v_accvgpr_read_b32 v20, a112
  v_accvgpr_read_b32 v21, a113
  v_accvgpr_read_b32 v22, a114
  v_accvgpr_read_b32 v23, a115
  v_mul_f32 v20, v20, v18
  v_mul_f32 v21, v21, v18
  v_mul_f32 v22, v22, v18
  v_mul_f32 v23, v23, v18
  v_accvgpr_write_b32 a112, v20
  v_accvgpr_write_b32 a113, v21
  v_accvgpr_write_b32 a114, v22
  v_accvgpr_write_b32 a115, v23
  v_accvgpr_read_b32 v20, a116
  v_accvgpr_read_b32 v21, a117
  v_accvgpr_read_b32 v22, a118
  v_accvgpr_read_b32 v23, a119
  v_mul_f32 v20, v20, v19
  v_mul_f32 v21, v21, v19
  v_mul_f32 v22, v22, v19
  v_mul_f32 v23, v23, v19
  v_accvgpr_write_b32 a116, v20
  v_accvgpr_write_b32 a117, v21
  v_accvgpr_write_b32 a118, v22
  v_accvgpr_write_b32 a119, v23
  v_accvgpr_read_b32 v20, a120
  v_accvgpr_read_b32 v21, a121
  v_accvgpr_read_b32 v22, a122
  v_accvgpr_read_b32 v23, a123
  v_mul_f32 v20, v20, v18
  v_mul_f32 v21, v21, v18
  v_mul_f32 v22, v22, v18
  v_mul_f32 v23, v23, v18
  v_accvgpr_write_b32 a120, v20
  v_accvgpr_write_b32 a121, v21
  v_accvgpr_write_b32 a122, v22
  v_accvgpr_write_b32 a123, v23
  v_accvgpr_read_b32 v20, a124
  v_accvgpr_read_b32 v21, a125
  v_accvgpr_read_b32 v22, a126
  v_accvgpr_read_b32 v23, a127
  v_mul_f32 v20, v20, v19
  v_mul_f32 v21, v21, v19
  v_mul_f32 v22, v22, v19
  v_mul_f32 v23, v23, v19
  v_accvgpr_write_b32 a124, v20
  v_accvgpr_write_b32 a125, v21
  v_accvgpr_write_b32 a126, v22
  v_accvgpr_write_b32 a127, v23
  s_setpc_b64 s[78:79]
.section .rodata,"a"
.p2align 6
.amdhsa_kernel fa_kernel
  .amdhsa_next_free_vgpr 512
  .amdhsa_next_free_sgpr 102
  .amdhsa_accum_offset 256
  .amdhsa_group_segment_fixed_size 0
  .amdhsa_kernarg_size 112
  .amdhsa_user_sgpr_count 2
  .amdhsa_user_sgpr_kernarg_segment_ptr 1
  .amdhsa_system_sgpr_workgroup_id_x 1
  .amdhsa_float_denorm_mode_32 3
.end_amdhsa_kernel
.text
.globl k3_kernel
.p2align 8
.type k3_kernel,@function
k3_kernel:
  s_cmp_ge_u32 s2, 256
  s_cbranch_scc1 k3_end
  s_load_dwordx2 s[4:5], s[0:1], 0
  s_load_dwordx2 s[6:7], s[0:1], 88
  s_load_dwordx2 s[16:17], s[0:1], 104
  v_lshrrev_b32 v4, 6, v0
  v_and_b32 v1, 63, v0
  v_readfirstlane_b32 s20, v4
  s_and_b32 s21, s2, 7
  s_lshl_b32 s21, s21, 2
  s_lshr_b32 s23, s2, 3
  s_and_b32 s23, s23, 3
  s_add_u32 s21, s21, s23
  s_lshr_b32 s22, s2, 5
  v_lshlrev_b32 v2, 4, v1
  s_lshl_b32 s48, s21, 19
  s_lshl_b32 s23, s20, 15
  s_add_u32 s48, s48, s23
  s_add_u32 s48, s48, 50331648
  s_add_u32 s49, s48, 131072
  s_add_u32 s50, s48, 262144
  s_add_u32 s51, s48, 393216
  s_lshl_b32 s23, s22, 2
  s_add_u32 s23, s23, s20
  s_mul_i32 s52, s23, 163840
  s_add_u32 s52, s52, 4194304
  s_add_u32 s53, s52, 4096
  s_add_u32 s54, s52, 8192
  s_add_u32 s55, s52, 12288
  s_add_u32 s56, s52, 16384
  s_waitcnt lgkmcnt(0)
  s_mov_b32 s32, s16
  s_mov_b32 s33, s17
  s_mov_b32 s34, 67108864
  s_mov_b32 s35, 0x20000
  s_mov_b32 s36, s16
  s_mov_b32 s37, s17
  s_mov_b32 s38, 67108864
  s_mov_b32 s39, 0x20000
  s_mov_b32 s40, s4
  s_mov_b32 s41, s5
  s_mov_b32 s42, 2621440
  s_mov_b32 s43, 0x20000
  s_mov_b32 s44, s6
  s_mov_b32 s45, s7
  s_mov_b32 s46, 2621440
  s_mov_b32 s47, 0x20000
  s_add_u32 s18, s16, 2629632
  s_addc_u32 s19, s17, 0
  s_load_dwordx16 s[64:79], s[18:19], 0
  buffer_load_dwordx4 v[100:103], v2, s[32:35], s52 offen offset:0
  buffer_load_dwordx4 v[104:107], v2, s[32:35], s52 offen offset:1024
  buffer_load_dwordx4 v[108:111], v2, s[32:35], s52 offen offset:2048
  buffer_load_dwordx4 v[112:115], v2, s[32:35], s52 offen offset:3072
  buffer_load_dwordx4 v[116:119], v2, s[32:35], s53 offen offset:0
  buffer_load_dwordx4 v[120:123], v2, s[32:35], s48 offen offset:0
  buffer_load_dwordx4 v[124:127], v2, s[32:35], s49 offen offset:0
  buffer_load_dwordx4 v[128:131], v2, s[32:35], s50 offen offset:0
  buffer_load_dwordx4 v[132:135], v2, s[32:35], s51 offen offset:0
  buffer_load_dwordx4 v[136:139], v2, s[32:35], s53 offen offset:1024
  buffer_load_dwordx4 v[140:143], v2, s[32:35], s53 offen offset:2048
  buffer_load_dwordx4 v[144:147], v2, s[32:35], s53 offen offset:3072
  buffer_load_dwordx4 v[148:151], v2, s[32:35], s54 offen offset:0
  buffer_load_dwordx4 v[152:155], v2, s[32:35], s54 offen offset:1024
  buffer_load_dwordx4 v[156:159], v2, s[32:35], s48 offen offset:1024
  buffer_load_dwordx4 v[160:163], v2, s[32:35], s49 offen offset:1024
  buffer_load_dwordx4 v[164:167], v2, s[32:35], s50 offen offset:1024
  buffer_load_dwordx4 v[168:171], v2, s[32:35], s51 offen offset:1024
  buffer_load_dwordx4 v[172:175], v2, s[32:35], s54 offen offset:2048
  buffer_load_dwordx4 v[176:179], v2, s[32:35], s54 offen offset:3072
  buffer_load_dwordx4 v[180:183], v2, s[32:35], s55 offen offset:0
  buffer_load_dwordx4 v[184:187], v2, s[32:35], s55 offen offset:1024
  buffer_load_dwordx4 v[188:191], v2, s[32:35], s55 offen offset:2048
  buffer_load_dwordx4 v[192:195], v2, s[32:35], s48 offen offset:2048
  buffer_load_dwordx4 v[196:199], v2, s[32:35], s49 offen offset:2048
  buffer_load_dwordx4 v[200:203], v2, s[32:35], s50 offen offset:2048
  buffer_load_dwordx4 v[204:207], v2, s[32:35], s51 offen offset:2048
  buffer_load_dwordx4 v[208:211], v2, s[32:35], s55 offen offset:3072
  buffer_load_dwordx4 v[212:215], v2, s[32:35], s56 offen offset:0
  buffer_load_dwordx4 v[216:219], v2, s[32:35], s56 offen offset:1024
  buffer_load_dwordx4 v[220:223], v2, s[32:35], s56 offen offset:2048
  buffer_load_dwordx4 v[224:227], v2, s[32:35], s56 offen offset:3072
  buffer_load_dwordx4 v[228:231], v2, s[32:35], s48 offen offset:3072
  buffer_load_dwordx4 v[232:235], v2, s[32:35], s49 offen offset:3072
  buffer_load_dwordx4 v[236:239], v2, s[32:35], s50 offen offset:3072
  buffer_load_dwordx4 v[240:243], v2, s[32:35], s51 offen offset:3072
  s_add_u32 s48, s48, 4096
  s_add_u32 s49, s49, 4096
  s_add_u32 s50, s50, 4096
  s_add_u32 s51, s51, 4096
  s_add_u32 s52, s52, 20480
  s_add_u32 s53, s53, 20480
  s_add_u32 s54, s54, 20480
  s_add_u32 s55, s55, 20480
  s_add_u32 s56, s56, 20480
  v_mov_b32 v8, 0
  v_mov_b32 v9, 0
  v_mov_b32 v10, 0
  v_mov_b32 v11, 0
  v_lshlrev_b32 v4, 4, v0
  v_add_u32 v4, 86016, v4
  v_mfma_f32_32x32x16_bf16 v[20:35], v[8:11], v[8:11], 0
  v_mfma_f32_32x32x16_bf16 v[36:51], v[8:11], v[8:11], 0
  v_mfma_f32_32x32x16_bf16 v[52:67], v[8:11], v[8:11], 0
  v_mfma_f32_32x32x16_bf16 v[68:83], v[8:11], v[8:11], 0
  v_mfma_f32_32x32x16_bf16 v[84:99], v[8:11], v[8:11], 0
  ds_write_b128 v4, v[8:11] offset:0
  ds_write_b128 v4, v[8:11] offset:4096
  ds_write_b128 v4, v[8:11] offset:8192
  ds_write_b128 v4, v[8:11] offset:12288
  ds_write_b128 v4, v[8:11] offset:16384
  ds_write_b128 v4, v[8:11] offset:20480
  s_lshl_b32 s25, s21, 6
  s_mul_i32 s26, s22, 160
  s_mul_i32 s27, s22, 2560
  v_add_u32 v4, 0, v0
  v_mul_u32_u24 v5, 6554, v4
  v_lshrrev_b32 v5, 16, v5
  v_mul_u32_u24 v6, 10, v5
  v_sub_u32 v6, v4, v6
  v_mul_u32_u24 v15, 336, v5
  v_lshl_add_u32 v15, v6, 5, v15
  v_add_u32 v5, s25, v5
  v_mul_u32_u24 v12, 1280, v5
  v_lshl_add_u32 v12, v6, 4, v12
  v_add_u32 v12, s26, v12
  v_lshrrev_b32 v7, 4, v5
  v_mul_u32_u24 v7, 20480, v7
  v_and_b32 v5, 15, v5
  v_lshl_add_u32 v7, v5, 4, v7
  v_lshl_add_u32 v244, v6, 8, v7
  v_add_u32 v4, 256, v0
  v_mul_u32_u24 v5, 6554, v4
  v_lshrrev_b32 v5, 16, v5
  v_mul_u32_u24 v6, 10, v5
  v_sub_u32 v6, v4, v6
  v_mul_u32_u24 v16, 336, v5
  v_lshl_add_u32 v16, v6, 5, v16
  v_add_u32 v5, s25, v5
  v_mul_u32_u24 v13, 1280, v5
  v_lshl_add_u32 v13, v6, 4, v13
  v_add_u32 v13, s26, v13
  v_lshrrev_b32 v7, 4, v5
  v_mul_u32_u24 v7, 20480, v7
  v_and_b32 v5, 15, v5
  v_lshl_add_u32 v7, v5, 4, v7
  v_lshl_add_u32 v245, v6, 8, v7
  v_add_u32 v4, 512, v0
  v_mul_u32_u24 v5, 6554, v4
  v_lshrrev_b32 v5, 16, v5
  v_mul_u32_u24 v6, 10, v5
  v_sub_u32 v6, v4, v6
  v_mul_u32_u24 v17, 336, v5
  v_lshl_add_u32 v17, v6, 5, v17
  v_add_u32 v5, s25, v5
  v_mul_u32_u24 v14, 1280, v5
  v_lshl_add_u32 v14, v6, 4, v14
  v_add_u32 v14, s26, v14
  v_lshrrev_b32 v7, 4, v5
  v_mul_u32_u24 v7, 20480, v7
  v_and_b32 v5, 15, v5
  v_lshl_add_u32 v7, v5, 4, v7
  v_lshl_add_u32 v246, v6, 8, v7
  v_cmp_gt_u32 vcc, 128, v0
  v_mov_b32 v4, 0x40000000
  v_mov_b32 v5, 0
  v_cndmask_b32 v14, v4, v14, vcc
  v_cndmask_b32 v246, v4, v246, vcc
  v_cndmask_b32 v17, v5, v17, vcc
  s_waitcnt lgkmcnt(0)
  s_barrier
  s_mov_b32 s28, s64
  s_mov_b32 s30, s72
  s_cmp_eq_u32 s20, 1
  s_cselect_b32 s28, s66, s28
  s_cselect_b32 s30, s74, s30
  s_cmp_eq_u32 s20, 2
  s_cselect_b32 s28, s68, s28
  s_cselect_b32 s30, s76, s30
  s_cmp_eq_u32 s20, 3
  s_cselect_b32 s28, s70, s28
  s_cselect_b32 s30, s78, s30
  s_mov_b32 s29, s65
  s_mov_b32 s31, s73
  s_cmp_eq_u32 s20, 1
  s_cselect_b32 s29, s67, s29
  s_cselect_b32 s31, s75, s31
  s_cmp_eq_u32 s20, 2
  s_cselect_b32 s29, s69, s29
  s_cselect_b32 s31, s77, s31
  s_cmp_eq_u32 s20, 3
  s_cselect_b32 s29, s71, s29
  s_cselect_b32 s31, s79, s31
  s_sub_u32 s23, s28, s25
  s_cmp_ge_u32 s23, 64
  s_cbranch_scc1 k3_nosel0
  v_mul_u32_u24 v4, 3277, v1
  v_lshrrev_b32 v4, 16, v4
  v_mul_u32_u24 v5, 20, v4
  v_sub_u32 v5, v1, v5
  v_lshlrev_b32 v5, 4, v5
  v_mul_u32_u24 v6, 368640, v4
  v_add_u32 v6, v6, v5
  v_cmp_gt_u32 vcc, 3, v4
  v_mov_b32 v7, 0x40000000
  s_lshl_b32 s58, s20, 1
  v_cndmask_b32 v6, v7, v6, vcc
  s_add_u32 s58, s58, 0
  s_mul_i32 s58, s58, 2560
  s_mul_i32 s59, s22, 320
  s_add_u32 s58, s58, s59
  s_add_u32 s58, s58, 2686976
  s_mov_b32 s59, 9
  v_mov_b32 v8, 0
  v_mov_b32 v9, 0
  v_mov_b32 v10, 0
  v_mov_b32 v11, 0
k3_yl0:
  buffer_load_dwordx4 v[248:251], v6, s[36:39], s58 offen
  s_add_u32 s58, s58, 20480
  buffer_load_dwordx4 v[252:255], v6, s[36:39], s58 offen
  s_add_u32 s58, s58, 20480
  s_waitcnt vmcnt(0)
  v_add_f32 v8, v8, v248
  v_add_f32 v9, v9, v249
  v_add_f32 v10, v10, v250
  v_add_f32 v11, v11, v251
  v_add_f32 v8, v8, v252
  v_add_f32 v9, v9, v253
  v_add_f32 v10, v10, v254
  v_add_f32 v11, v11, v255
  s_sub_u32 s59, s59, 1
  s_cmp_lg_u32 s59, 0
  s_cbranch_scc1 k3_yl0
  s_lshl_b32 s58, s20, 10
  s_add_u32 s58, s58, 107520
  v_add_u32 v7, s58, v2
  ds_write_b128 v7, v[8:11]
  v_add_u32 v7, s58, v5
  s_waitcnt lgkmcnt(0)
  ds_read_b128 v[8:11], v7
  ds_read_b128 v[248:251], v7 offset:320
  ds_read_b128 v[252:255], v7 offset:640
  s_mul_i32 s23, s23, 336
  s_add_u32 s23, s23, 86016
  v_add_u32 v7, s23, v5
  s_waitcnt lgkmcnt(0)
  v_add_f32 v8, v8, v248
  v_add_f32 v8, v8, v252
  v_cvt_pk_bf16_f32 v8, v8, v8
  v_and_b32 v8, 0xffff0000, v8
  v_mul_f32 v8, s30, v8
  v_cvt_pk_bf16_f32 v8, v8, v8
  v_and_b32 v8, 0xffff0000, v8
  v_add_f32 v9, v9, v249
  v_add_f32 v9, v9, v253
  v_cvt_pk_bf16_f32 v9, v9, v9
  v_and_b32 v9, 0xffff0000, v9
  v_mul_f32 v9, s30, v9
  v_cvt_pk_bf16_f32 v9, v9, v9
  v_and_b32 v9, 0xffff0000, v9
  v_add_f32 v10, v10, v250
  v_add_f32 v10, v10, v254
  v_cvt_pk_bf16_f32 v10, v10, v10
  v_and_b32 v10, 0xffff0000, v10
  v_mul_f32 v10, s30, v10
  v_cvt_pk_bf16_f32 v10, v10, v10
  v_and_b32 v10, 0xffff0000, v10
  v_add_f32 v11, v11, v251
  v_add_f32 v11, v11, v255
  v_cvt_pk_bf16_f32 v11, v11, v11
  v_and_b32 v11, 0xffff0000, v11
  v_mul_f32 v11, s30, v11
  v_cvt_pk_bf16_f32 v11, v11, v11
  v_and_b32 v11, 0xffff0000, v11
  ds_write_b128 v7, v[8:11]
  s_waitcnt lgkmcnt(0)
k3_nosel0:
  s_sub_u32 s23, s29, s25
  s_cmp_ge_u32 s23, 64
  s_cbranch_scc1 k3_nosel1
  v_mul_u32_u24 v4, 3277, v1
  v_lshrrev_b32 v4, 16, v4
  v_mul_u32_u24 v5, 20, v4
  v_sub_u32 v5, v1, v5
  v_lshlrev_b32 v5, 4, v5
  v_mul_u32_u24 v6, 368640, v4
  v_add_u32 v6, v6, v5
  v_cmp_gt_u32 vcc, 3, v4
  v_mov_b32 v7, 0x40000000
  s_lshl_b32 s58, s20, 1
  v_cndmask_b32 v6, v7, v6, vcc
  s_add_u32 s58, s58, 1
  s_mul_i32 s58, s58, 2560
  s_mul_i32 s59, s22, 320
  s_add_u32 s58, s58, s59
  s_add_u32 s58, s58, 2686976
  s_mov_b32 s59, 9
  v_mov_b32 v8, 0
  v_mov_b32 v9, 0
  v_mov_b32 v10, 0
  v_mov_b32 v11, 0
k3_yl1:
  buffer_load_dwordx4 v[248:251], v6, s[36:39], s58 offen
  s_add_u32 s58, s58, 20480
  buffer_load_dwordx4 v[252:255], v6, s[36:39], s58 offen
  s_add_u32 s58, s58, 20480
  s_waitcnt vmcnt(0)
  v_add_f32 v8, v8, v248
  v_add_f32 v9, v9, v249
  v_add_f32 v10, v10, v250
  v_add_f32 v11, v11, v251
  v_add_f32 v8, v8, v252
  v_add_f32 v9, v9, v253
  v_add_f32 v10, v10, v254
  v_add_f32 v11, v11, v255
  s_sub_u32 s59, s59, 1
  s_cmp_lg_u32 s59, 0
  s_cbranch_scc1 k3_yl1
  s_lshl_b32 s58, s20, 10
  s_add_u32 s58, s58, 107520
  v_add_u32 v7, s58, v2
  ds_write_b128 v7, v[8:11]
  v_add_u32 v7, s58, v5
  s_waitcnt lgkmcnt(0)
  ds_read_b128 v[8:11], v7
  ds_read_b128 v[248:251], v7 offset:320
  ds_read_b128 v[252:255], v7 offset:640
  s_mul_i32 s23, s23, 336
  s_add_u32 s23, s23, 86016
  v_add_u32 v7, s23, v5
  s_waitcnt lgkmcnt(0)
  v_add_f32 v8, v8, v248
  v_add_f32 v8, v8, v252
  v_cvt_pk_bf16_f32 v8, v8, v8
  v_and_b32 v8, 0xffff0000, v8
  v_mul_f32 v8, s31, v8
  v_cvt_pk_bf16_f32 v8, v8, v8
  v_and_b32 v8, 0xffff0000, v8
  v_add_f32 v9, v9, v249
  v_add_f32 v9, v9, v253
  v_cvt_pk_bf16_f32 v9, v9, v9
  v_and_b32 v9, 0xffff0000, v9
  v_mul_f32 v9, s31, v9
  v_cvt_pk_bf16_f32 v9, v9, v9
  v_and_b32 v9, 0xffff0000, v9
  v_add_f32 v10, v10, v250
  v_add_f32 v10, v10, v254
  v_cvt_pk_bf16_f32 v10, v10, v10
  v_and_b32 v10, 0xffff0000, v10
  v_mul_f32 v10, s31, v10
  v_cvt_pk_bf16_f32 v10, v10, v10
  v_and_b32 v10, 0xffff0000, v10
  v_add_f32 v11, v11, v251
  v_add_f32 v11, v11, v255
  v_cvt_pk_bf16_f32 v11, v11, v11
  v_and_b32 v11, 0xffff0000, v11
  v_mul_f32 v11, s31, v11
  v_cvt_pk_bf16_f32 v11, v11, v11
  v_and_b32 v11, 0xffff0000, v11
  ds_write_b128 v7, v[8:11]
  s_waitcnt lgkmcnt(0)
k3_nosel1:
  s_mov_b32 s24, 0
  s_waitcnt vmcnt(27)
.p2align 6
k3_loop:
  v_mfma_f32_16x16x32_bf16 v[20:23], v[100:103], v[120:123], v[20:23]
  v_mfma_f32_16x16x32_bf16 v[24:27], v[100:103], v[124:127], v[24:27]
  v_mfma_f32_16x16x32_bf16 v[28:31], v[100:103], v[128:131], v[28:31]
  v_mfma_f32_16x16x32_bf16 v[32:35], v[100:103], v[132:135], v[32:35]
  buffer_load_dwordx4 v[100:103], v2, s[32:35], s52 offen offset:0
  v_mfma_f32_16x16x32_bf16 v[36:39], v[104:107], v[120:123], v[36:39]
  v_mfma_f32_16x16x32_bf16 v[40:43], v[104:107], v[124:127], v[40:43]
  v_mfma_f32_16x16x32_bf16 v[44:47], v[104:107], v[128:131], v[44:47]
  v_mfma_f32_16x16x32_bf16 v[48:51], v[104:107], v[132:135], v[48:51]
  buffer_load_dwordx4 v[104:107], v2, s[32:35], s52 offen offset:1024
  v_mfma_f32_16x16x32_bf16 v[52:55], v[108:111], v[120:123], v[52:55]
  v_mfma_f32_16x16x32_bf16 v[56:59], v[108:111], v[124:127], v[56:59]
  v_mfma_f32_16x16x32_bf16 v[60:63], v[108:111], v[128:131], v[60:63]
  v_mfma_f32_16x16x32_bf16 v[64:67], v[108:111], v[132:135], v[64:67]
  buffer_load_dwordx4 v[108:111], v2, s[32:35], s52 offen offset:2048
  v_mfma_f32_16x16x32_bf16 v[68:71], v[112:115], v[120:123], v[68:71]
  v_mfma_f32_16x16x32_bf16 v[72:75], v[112:115], v[124:127], v[72:75]
  v_mfma_f32_16x16x32_bf16 v[76:79], v[112:115], v[128:131], v[76:79]
  v_mfma_f32_16x16x32_bf16 v[80:83], v[112:115], v[132:135], v[80:83]
  buffer_load_dwordx4 v[112:115], v2, s[32:35], s52 offen offset:3072
  v_mfma_f32_16x16x32_bf16 v[84:87], v[116:119], v[120:123], v[84:87]
  buffer_load_dwordx4 v[120:123], v2, s[32:35], s48 offen offset:0
  v_mfma_f32_16x16x32_bf16 v[88:91], v[116:119], v[124:127], v[88:91]
  buffer_load_dwordx4 v[124:127], v2, s[32:35], s49 offen offset:0
  v_mfma_f32_16x16x32_bf16 v[92:95], v[116:119], v[128:131], v[92:95]
  buffer_load_dwordx4 v[128:131], v2, s[32:35], s50 offen offset:0
  v_mfma_f32_16x16x32_bf16 v[96:99], v[116:119], v[132:135], v[96:99]
  buffer_load_dwordx4 v[116:119], v2, s[32:35], s53 offen offset:0
  buffer_load_dwordx4 v[132:135], v2, s[32:35], s51 offen offset:0
  s_waitcnt vmcnt(27)
  v_mfma_f32_16x16x32_bf16 v[20:23], v[136:139], v[156:159], v[20:23]
  v_mfma_f32_16x16x32_bf16 v[24:27], v[136:139], v[160:163], v[24:27]
  v_mfma_f32_16x16x32_bf16 v[28:31], v[136:139], v[164:167], v[28:31]
  v_mfma_f32_16x16x32_bf16 v[32:35], v[136:139], v[168:171], v[32:35]
  buffer_load_dwordx4 v[136:139], v2, s[32:35], s53 offen offset:1024
  v_mfma_f32_16x16x32_bf16 v[36:39], v[140:143], v[156:159], v[36:39]
  v_mfma_f32_16x16x32_bf16 v[40:43], v[140:143], v[160:163], v[40:43]
  v_mfma_f32_16x16x32_bf16 v[44:47], v[140:143], v[164:167], v[44:47]
  v_mfma_f32_16x16x32_bf16 v[48:51], v[140:143], v[168:171], v[48:51]
  buffer_load_dwordx4 v[140:143], v2, s[32:35], s53 offen offset:2048
  v_mfma_f32_16x16x32_bf16 v[52:55], v[144:147], v[156:159], v[52:55]
  v_mfma_f32_16x16x32_bf16 v[56:59], v[144:147], v[160:163], v[56:59]
  v_mfma_f32_16x16x32_bf16 v[60:63], v[144:147], v[164:167], v[60:63]
  v_mfma_f32_16x16x32_bf16 v[64:67], v[144:147], v[168:171], v[64:67]
  buffer_load_dwordx4 v[144:147], v2, s[32:35], s53 offen offset:3072
  v_mfma_f32_16x16x32_bf16 v[68:71], v[148:151], v[156:159], v[68:71]
  v_mfma_f32_16x16x32_bf16 v[72:75], v[148:151], v[160:163], v[72:75]
  v_mfma_f32_16x16x32_bf16 v[76:79], v[148:151], v[164:167], v[76:79]
  v_mfma_f32_16x16x32_bf16 v[80:83], v[148:151], v[168:171], v[80:83]
  buffer_load_dwordx4 v[148:151], v2, s[32:35], s54 offen offset:0
  v_mfma_f32_16x16x32_bf16 v[84:87], v[152:155], v[156:159], v[84:87]
  buffer_load_dwordx4 v[156:159], v2, s[32:35], s48 offen offset:1024
  v_mfma_f32_16x16x32_bf16 v[88:91], v[152:155], v[160:163], v[88:91]
  buffer_load_dwordx4 v[160:163], v2, s[32:35], s49 offen offset:1024
  v_mfma_f32_16x16x32_bf16 v[92:95], v[152:155], v[164:167], v[92:95]
  buffer_load_dwordx4 v[164:167], v2, s[32:35], s50 offen offset:1024
  v_mfma_f32_16x16x32_bf16 v[96:99], v[152:155], v[168:171], v[96:99]
  buffer_load_dwordx4 v[152:155], v2, s[32:35], s54 offen offset:1024
  buffer_load_dwordx4 v[168:171], v2, s[32:35], s51 offen offset:1024
  s_waitcnt vmcnt(27)
  v_mfma_f32_16x16x32_bf16 v[20:23], v[172:175], v[192:195], v[20:23]
  v_mfma_f32_16x16x32_bf16 v[24:27], v[172:175], v[196:199], v[24:27]
  v_mfma_f32_16x16x32_bf16 v[28:31], v[172:175], v[200:203], v[28:31]
  v_mfma_f32_16x16x32_bf16 v[32:35], v[172:175], v[204:207], v[32:35]
  buffer_load_dwordx4 v[172:175], v2, s[32:35], s54 offen offset:2048
  v_mfma_f32_16x16x32_bf16 v[36:39], v[176:179], v[192:195], v[36:39]
  v_mfma_f32_16x16x32_bf16 v[40:43], v[176:179], v[196:199], v[40:43]
  v_mfma_f32_16x16x32_bf16 v[44:47], v[176:179], v[200:203], v[44:47]
  v_mfma_f32_16x16x32_bf16 v[48:51], v[176:179], v[204:207], v[48:51]
  buffer_load_dwordx4 v[176:179], v2, s[32:35], s54 offen offset:3072
  v_mfma_f32_16x16x32_bf16 v[52:55], v[180:183], v[192:195], v[52:55]
  v_mfma_f32_16x16x32_bf16 v[56:59], v[180:183], v[196:199], v[56:59]
  v_mfma_f32_16x16x32_bf16 v[60:63], v[180:183], v[200:203], v[60:63]
  v_mfma_f32_16x16x32_bf16 v[64:67], v[180:183], v[204:207], v[64:67]
  buffer_load_dwordx4 v[180:183], v2, s[32:35], s55 offen offset:0
  v_mfma_f32_16x16x32_bf16 v[68:71], v[184:187], v[192:195], v[68:71]
  v_mfma_f32_16x16x32_bf16 v[72:75], v[184:187], v[196:199], v[72:75]
  v_mfma_f32_16x16x32_bf16 v[76:79], v[184:187], v[200:203], v[76:79]
  v_mfma_f32_16x16x32_bf16 v[80:83], v[184:187], v[204:207], v[80:83]
  buffer_load_dwordx4 v[184:187], v2, s[32:35], s55 offen offset:1024
  v_mfma_f32_16x16x32_bf16 v[84:87], v[188:191], v[192:195], v[84:87]
  buffer_load_dwordx4 v[192:195], v2, s[32:35], s48 offen offset:2048
  v_mfma_f32_16x16x32_bf16 v[88:91], v[188:191], v[196:199], v[88:91]
  buffer_load_dwordx4 v[196:199], v2, s[32:35], s49 offen offset:2048
  v_mfma_f32_16x16x32_bf16 v[92:95], v[188:191], v[200:203], v[92:95]
  buffer_load_dwordx4 v[200:203], v2, s[32:35], s50 offen offset:2048
  v_mfma_f32_16x16x32_bf16 v[96:99], v[188:191], v[204:207], v[96:99]
  buffer_load_dwordx4 v[188:191], v2, s[32:35], s55 offen offset:2048
  buffer_load_dwordx4 v[204:207], v2, s[32:35], s51 offen offset:2048
  s_waitcnt vmcnt(27)
  v_mfma_f32_16x16x32_bf16 v[20:23], v[208:211], v[228:231], v[20:23]
  v_mfma_f32_16x16x32_bf16 v[24:27], v[208:211], v[232:235], v[24:27]
  v_mfma_f32_16x16x32_bf16 v[28:31], v[208:211], v[236:239], v[28:31]
  v_mfma_f32_16x16x32_bf16 v[32:35], v[208:211], v[240:243], v[32:35]
  buffer_load_dwordx4 v[208:211], v2, s[32:35], s55 offen offset:3072
  v_mfma_f32_16x16x32_bf16 v[36:39], v[212:215], v[228:231], v[36:39]
  s_add_u32 s52, s52, 20480
  v_mfma_f32_16x16x32_bf16 v[40:43], v[212:215], v[232:235], v[40:43]
  s_add_u32 s53, s53, 20480
  v_mfma_f32_16x16x32_bf16 v[44:47], v[212:215], v[236:239], v[44:47]
  s_add_u32 s54, s54, 20480
  v_mfma_f32_16x16x32_bf16 v[48:51], v[212:215], v[240:243], v[48:51]
  s_add_u32 s55, s55, 20480
  buffer_load_dwordx4 v[212:215], v2, s[32:35], s56 offen offset:0
  v_mfma_f32_16x16x32_bf16 v[52:55], v[216:219], v[228:231], v[52:55]
  s_add_u32 s24, s24, 1
  v_mfma_f32_16x16x32_bf16 v[56:59], v[216:219], v[232:235], v[56:59]
  v_mfma_f32_16x16x32_bf16 v[60:63], v[216:219], v[236:239], v[60:63]
  v_mfma_f32_16x16x32_bf16 v[64:67], v[216:219], v[240:243], v[64:67]
  buffer_load_dwordx4 v[216:219], v2, s[32:35], s56 offen offset:1024
  v_mfma_f32_16x16x32_bf16 v[68:71], v[220:223], v[228:231], v[68:71]
  v_mfma_f32_16x16x32_bf16 v[72:75], v[220:223], v[232:235], v[72:75]
  v_mfma_f32_16x16x32_bf16 v[76:79], v[220:223], v[236:239], v[76:79]
  v_mfma_f32_16x16x32_bf16 v[80:83], v[220:223], v[240:243], v[80:83]
  buffer_load_dwordx4 v[220:223], v2, s[32:35], s56 offen offset:2048
  v_mfma_f32_16x16x32_bf16 v[84:87], v[224:227], v[228:231], v[84:87]
  buffer_load_dwordx4 v[228:231], v2, s[32:35], s48 offen offset:3072
  v_mfma_f32_16x16x32_bf16 v[88:91], v[224:227], v[232:235], v[88:91]
  buffer_load_dwordx4 v[232:235], v2, s[32:35], s49 offen offset:3072
  v_mfma_f32_16x16x32_bf16 v[92:95], v[224:227], v[236:239], v[92:95]
  buffer_load_dwordx4 v[236:239], v2, s[32:35], s50 offen offset:3072
  v_mfma_f32_16x16x32_bf16 v[96:99], v[224:227], v[240:243], v[96:99]
  buffer_load_dwordx4 v[224:227], v2, s[32:35], s56 offen offset:3072
  buffer_load_dwordx4 v[240:243], v2, s[32:35], s51 offen offset:3072
  s_add_u32 s48, s48, 4096
  s_add_u32 s49, s49, 4096
  s_add_u32 s50, s50, 4096
  s_add_u32 s51, s51, 4096
  s_add_u32 s56, s56, 20480
  s_cmp_ge_u32 s24, 7
  s_cselect_b32 s34, 0, s34
  s_cmp_lt_u32 s24, 8
  s_waitcnt vmcnt(27)
  s_cbranch_scc1 k3_loop
  s_waitcnt vmcnt(0)
  buffer_load_dwordx4 v[100:103], v12, s[40:43], 0 offen
  buffer_load_dwordx4 v[112:115], v244, s[36:39], s27 offen
  buffer_load_dwordx4 v[104:107], v13, s[40:43], 0 offen
  buffer_load_dwordx4 v[116:119], v245, s[36:39], s27 offen
  buffer_load_dwordx4 v[108:111], v14, s[40:43], 0 offen
  buffer_load_dwordx4 v[120:123], v246, s[36:39], s27 offen
  v_and_b32 v4, 15, v1
  v_mul_u32_u24 v4, 336, v4
  v_lshrrev_b32 v5, 4, v1
  v_lshl_add_u32 v4, v5, 4, v4
  s_mul_i32 s23, s20, 21504
  v_add_u32 v4, s23, v4
  ds_write_b128 v4, v[20:23] offset:0
  ds_write_b128 v4, v[24:27] offset:5376
  ds_write_b128 v4, v[28:31] offset:10752
  ds_write_b128 v4, v[32:35] offset:16128
  ds_write_b128 v4, v[36:39] offset:64
  ds_write_b128 v4, v[40:43] offset:5440
  ds_write_b128 v4, v[44:47] offset:10816
  ds_write_b128 v4, v[48:51] offset:16192
  ds_write_b128 v4, v[52:55] offset:128
  ds_write_b128 v4, v[56:59] offset:5504
  ds_write_b128 v4, v[60:63] offset:10880
  ds_write_b128 v4, v[64:67] offset:16256
  ds_write_b128 v4, v[68:71] offset:192
  ds_write_b128 v4, v[72:75] offset:5568
  ds_write_b128 v4, v[76:79] offset:10944
  ds_write_b128 v4, v[80:83] offset:16320
  ds_write_b128 v4, v[84:87] offset:256
  ds_write_b128 v4, v[88:91] offset:5632
  ds_write_b128 v4, v[92:95] offset:11008
  ds_write_b128 v4, v[96:99] offset:16384
  s_waitcnt lgkmcnt(0)
  s_barrier
  v_add_u32 v4, 64512, v15
  v_add_u32 v5, 64512, v16
  v_add_u32 v6, 64512, v17
  ds_read_b128 v[128:131], v15 offset:0
  ds_read_b128 v[132:135], v15 offset:16
  ds_read_b128 v[136:139], v15 offset:21504
  ds_read_b128 v[140:143], v15 offset:21520
  ds_read_b128 v[144:147], v15 offset:43008
  ds_read_b128 v[148:151], v15 offset:43024
  ds_read_b128 v[152:155], v4 offset:0
  ds_read_b128 v[156:159], v4 offset:16
  ds_read_b128 v[160:163], v4 offset:21504
  ds_read_b128 v[164:167], v4 offset:21520
  ds_read_b128 v[168:171], v16 offset:0
  ds_read_b128 v[172:175], v16 offset:16
  ds_read_b128 v[176:179], v16 offset:21504
  ds_read_b128 v[180:183], v16 offset:21520
  ds_read_b128 v[184:187], v16 offset:43008
  ds_read_b128 v[188:191], v16 offset:43024
  ds_read_b128 v[192:195], v5 offset:0
  ds_read_b128 v[196:199], v5 offset:16
  ds_read_b128 v[200:203], v5 offset:21504
  ds_read_b128 v[204:207], v5 offset:21520
  ds_read_b128 v[208:211], v17 offset:0
  ds_read_b128 v[212:215], v17 offset:16
  ds_read_b128 v[216:219], v17 offset:21504
  ds_read_b128 v[220:223], v17 offset:21520
  ds_read_b128 v[224:227], v17 offset:43008
  ds_read_b128 v[228:231], v17 offset:43024
  ds_read_b128 v[232:235], v6 offset:0
  ds_read_b128 v[236:239], v6 offset:16
  ds_read_b128 v[240:243], v6 offset:21504
  ds_read_b128 v[244:247], v6 offset:21520
  s_waitcnt vmcnt(4) lgkmcnt(15)
  s_waitcnt lgkmcnt(10)
  v_add_f32 v128, v128, v136
  v_add_f32 v144, v144, v152
  v_add_f32 v129, v129, v137
  v_add_f32 v145, v145, v153
  v_add_f32 v130, v130, v138
  v_add_f32 v146, v146, v154
  v_add_f32 v131, v131, v139
  v_add_f32 v147, v147, v155
  v_add_f32 v132, v132, v140
  v_add_f32 v148, v148, v156
  v_add_f32 v133, v133, v141
  v_add_f32 v149, v149, v157
  v_add_f32 v134, v134, v142
  v_add_f32 v150, v150, v158
  v_add_f32 v135, v135, v143
  v_add_f32 v151, v151, v159
  v_add_f32 v128, v128, v144
  v_add_f32 v129, v129, v145
  v_add_f32 v130, v130, v146
  v_add_f32 v131, v131, v147
  v_add_f32 v132, v132, v148
  v_add_f32 v133, v133, v149
  v_add_f32 v134, v134, v150
  v_add_f32 v135, v135, v151
  v_cvt_pk_bf16_f32 v136, v128, v129
  v_lshlrev_b32 v138, 16, v100
  v_and_b32 v139, 0xffff0000, v100
  v_and_b32 v137, 0xffff0000, v136
  v_lshlrev_b32 v136, 16, v136
  v_add_f32 v136, v136, v138
  v_add_f32 v137, v137, v139
  v_cvt_pk_bf16_f32 v136, v136, v137
  v_lshlrev_b32 v138, 16, v112
  v_and_b32 v139, 0xffff0000, v112
  v_add_f32 v138, v138, v160
  v_add_f32 v139, v139, v161
  v_cvt_pk_bf16_f32 v138, v138, v139
  v_and_b32 v137, 0xffff0000, v136
  v_lshlrev_b32 v136, 16, v136
  v_and_b32 v139, 0xffff0000, v138
  v_lshlrev_b32 v138, 16, v138
  v_add_f32 v136, v136, v138
  v_add_f32 v137, v137, v139
  v_cvt_pk_bf16_f32 v140, v136, v137
  v_cvt_pk_bf16_f32 v136, v130, v131
  v_lshlrev_b32 v138, 16, v101
  v_and_b32 v139, 0xffff0000, v101
  v_and_b32 v137, 0xffff0000, v136
  v_lshlrev_b32 v136, 16, v136
  v_add_f32 v136, v136, v138
  v_add_f32 v137, v137, v139
  v_cvt_pk_bf16_f32 v136, v136, v137
  v_lshlrev_b32 v138, 16, v113
  v_and_b32 v139, 0xffff0000, v113
  v_add_f32 v138, v138, v162
  v_add_f32 v139, v139, v163
  v_cvt_pk_bf16_f32 v138, v138, v139
  v_and_b32 v137, 0xffff0000, v136
  v_lshlrev_b32 v136, 16, v136
  v_and_b32 v139, 0xffff0000, v138
  v_lshlrev_b32 v138, 16, v138
  v_add_f32 v136, v136, v138
  v_add_f32 v137, v137, v139
  v_cvt_pk_bf16_f32 v141, v136, v137
  v_cvt_pk_bf16_f32 v136, v132, v133
  v_lshlrev_b32 v138, 16, v102
  v_and_b32 v139, 0xffff0000, v102
  v_and_b32 v137, 0xffff0000, v136
  v_lshlrev_b32 v136, 16, v136
  v_add_f32 v136, v136, v138
  v_add_f32 v137, v137, v139
  v_cvt_pk_bf16_f32 v136, v136, v137
  v_lshlrev_b32 v138, 16, v114
  v_and_b32 v139, 0xffff0000, v114
  v_add_f32 v138, v138, v164
  v_add_f32 v139, v139, v165
  v_cvt_pk_bf16_f32 v138, v138, v139
  v_and_b32 v137, 0xffff0000, v136
  v_lshlrev_b32 v136, 16, v136
  v_and_b32 v139, 0xffff0000, v138
  v_lshlrev_b32 v138, 16, v138
  v_add_f32 v136, v136, v138
  v_add_f32 v137, v137, v139
  v_cvt_pk_bf16_f32 v142, v136, v137
  v_cvt_pk_bf16_f32 v136, v134, v135
  v_lshlrev_b32 v138, 16, v103
  v_and_b32 v139, 0xffff0000, v103
  v_and_b32 v137, 0xffff0000, v136
  v_lshlrev_b32 v136, 16, v136
  v_add_f32 v136, v136, v138
  v_add_f32 v137, v137, v139
  v_cvt_pk_bf16_f32 v136, v136, v137
  v_lshlrev_b32 v138, 16, v115
  v_and_b32 v139, 0xffff0000, v115
  v_add_f32 v138, v138, v166
  v_add_f32 v139, v139, v167
  v_cvt_pk_bf16_f32 v138, v138, v139
  v_and_b32 v137, 0xffff0000, v136
  v_lshlrev_b32 v136, 16, v136
  v_and_b32 v139, 0xffff0000, v138
  v_lshlrev_b32 v138, 16, v138
  v_add_f32 v136, v136, v138
  v_add_f32 v137, v137, v139
  v_cvt_pk_bf16_f32 v143, v136, v137
  buffer_store_dwordx4 v[140:143], v12, s[44:47], 0 offen
  s_waitcnt vmcnt(3) lgkmcnt(10)
  v_add_f32 v168, v168, v176
  v_add_f32 v184, v184, v192
  v_add_f32 v169, v169, v177
  v_add_f32 v185, v185, v193
  v_add_f32 v170, v170, v178
  v_add_f32 v186, v186, v194
  v_add_f32 v171, v171, v179
  v_add_f32 v187, v187, v195
  v_add_f32 v172, v172, v180
  v_add_f32 v188, v188, v196
  v_add_f32 v173, v173, v181
  v_add_f32 v189, v189, v197
  v_add_f32 v174, v174, v182
  v_add_f32 v190, v190, v198
  v_add_f32 v175, v175, v183
  v_add_f32 v191, v191, v199
  v_add_f32 v168, v168, v184
  v_add_f32 v169, v169, v185
  v_add_f32 v170, v170, v186
  v_add_f32 v171, v171, v187
  v_add_f32 v172, v172, v188
  v_add_f32 v173, v173, v189
  v_add_f32 v174, v174, v190
  v_add_f32 v175, v175, v191
  v_cvt_pk_bf16_f32 v176, v168, v169
  v_lshlrev_b32 v178, 16, v104
  v_and_b32 v179, 0xffff0000, v104
  v_and_b32 v177, 0xffff0000, v176
  v_lshlrev_b32 v176, 16, v176
  v_add_f32 v176, v176, v178
  v_add_f32 v177, v177, v179
  v_cvt_pk_bf16_f32 v176, v176, v177
  v_lshlrev_b32 v178, 16, v116
  v_and_b32 v179, 0xffff0000, v116
  v_add_f32 v178, v178, v200
  v_add_f32 v179, v179, v201
  v_cvt_pk_bf16_f32 v178, v178, v179
  v_and_b32 v177, 0xffff0000, v176
  v_lshlrev_b32 v176, 16, v176
  v_and_b32 v179, 0xffff0000, v178
  v_lshlrev_b32 v178, 16, v178
  v_add_f32 v176, v176, v178
  v_add_f32 v177, v177, v179
  v_cvt_pk_bf16_f32 v180, v176, v177
  v_cvt_pk_bf16_f32 v176, v170, v171
  v_lshlrev_b32 v178, 16, v105
  v_and_b32 v179, 0xffff0000, v105
  v_and_b32 v177, 0xffff0000, v176
  v_lshlrev_b32 v176, 16, v176
  v_add_f32 v176, v176, v178
  v_add_f32 v177, v177, v179
  v_cvt_pk_bf16_f32 v176, v176, v177
  v_lshlrev_b32 v178, 16, v117
  v_and_b32 v179, 0xffff0000, v117
  v_add_f32 v178, v178, v202
  v_add_f32 v179, v179, v203
  v_cvt_pk_bf16_f32 v178, v178, v179
  v_and_b32 v177, 0xffff0000, v176
  v_lshlrev_b32 v176, 16, v176
  v_and_b32 v179, 0xffff0000, v178
  v_lshlrev_b32 v178, 16, v178
  v_add_f32 v176, v176, v178
  v_add_f32 v177, v177, v179
  v_cvt_pk_bf16_f32 v181, v176, v177
  v_cvt_pk_bf16_f32 v176, v172, v173
  v_lshlrev_b32 v178, 16, v106
  v_and_b32 v179, 0xffff0000, v106
  v_and_b32 v177, 0xffff0000, v176
  v_lshlrev_b32 v176, 16, v176
  v_add_f32 v176, v176, v178
  v_add_f32 v177, v177, v179
  v_cvt_pk_bf16_f32 v176, v176, v177
  v_lshlrev_b32 v178, 16, v118
  v_and_b32 v179, 0xffff0000, v118
  v_add_f32 v178, v178, v204
  v_add_f32 v179, v179, v205
  v_cvt_pk_bf16_f32 v178, v178, v179
  v_and_b32 v177, 0xffff0000, v176
  v_lshlrev_b32 v176, 16, v176
  v_and_b32 v179, 0xffff0000, v178
  v_lshlrev_b32 v178, 16, v178
  v_add_f32 v176, v176, v178
  v_add_f32 v177, v177, v179
  v_cvt_pk_bf16_f32 v182, v176, v177
  v_cvt_pk_bf16_f32 v176, v174, v175
  v_lshlrev_b32 v178, 16, v107
  v_and_b32 v179, 0xffff0000, v107
  v_and_b32 v177, 0xffff0000, v176
  v_lshlrev_b32 v176, 16, v176
  v_add_f32 v176, v176, v178
  v_add_f32 v177, v177, v179
  v_cvt_pk_bf16_f32 v176, v176, v177
  v_lshlrev_b32 v178, 16, v119
  v_and_b32 v179, 0xffff0000, v119
  v_add_f32 v178, v178, v206
  v_add_f32 v179, v179, v207
  v_cvt_pk_bf16_f32 v178, v178, v179
  v_and_b32 v177, 0xffff0000, v176
  v_lshlrev_b32 v176, 16, v176
  v_and_b32 v179, 0xffff0000, v178
  v_lshlrev_b32 v178, 16, v178
  v_add_f32 v176, v176, v178
  v_add_f32 v177, v177, v179
  v_cvt_pk_bf16_f32 v183, v176, v177
  buffer_store_dwordx4 v[180:183], v13, s[44:47], 0 offen
  s_waitcnt vmcnt(2) lgkmcnt(0)
  v_add_f32 v208, v208, v216
  v_add_f32 v224, v224, v232
  v_add_f32 v209, v209, v217
  v_add_f32 v225, v225, v233
  v_add_f32 v210, v210, v218
  v_add_f32 v226, v226, v234
  v_add_f32 v211, v211, v219
  v_add_f32 v227, v227, v235
  v_add_f32 v212, v212, v220
  v_add_f32 v228, v228, v236
  v_add_f32 v213, v213, v221
  v_add_f32 v229, v229, v237
  v_add_f32 v214, v214, v222
  v_add_f32 v230, v230, v238
  v_add_f32 v215, v215, v223
  v_add_f32 v231, v231, v239
  v_add_f32 v208, v208, v224
  v_add_f32 v209, v209, v225
  v_add_f32 v210, v210, v226
  v_add_f32 v211, v211, v227
  v_add_f32 v212, v212, v228
  v_add_f32 v213, v213, v229
  v_add_f32 v214, v214, v230
  v_add_f32 v215, v215, v231
  v_cvt_pk_bf16_f32 v216, v208, v209
  v_lshlrev_b32 v218, 16, v108
  v_and_b32 v219, 0xffff0000, v108
  v_and_b32 v217, 0xffff0000, v216
  v_lshlrev_b32 v216, 16, v216
  v_add_f32 v216, v216, v218
  v_add_f32 v217, v217, v219
  v_cvt_pk_bf16_f32 v216, v216, v217
  v_lshlrev_b32 v218, 16, v120
  v_and_b32 v219, 0xffff0000, v120
  v_add_f32 v218, v218, v240
  v_add_f32 v219, v219, v241
  v_cvt_pk_bf16_f32 v218, v218, v219
  v_and_b32 v217, 0xffff0000, v216
  v_lshlrev_b32 v216, 16, v216
  v_and_b32 v219, 0xffff0000, v218
  v_lshlrev_b32 v218, 16, v218
  v_add_f32 v216, v216, v218
  v_add_f32 v217, v217, v219
  v_cvt_pk_bf16_f32 v220, v216, v217
  v_cvt_pk_bf16_f32 v216, v210, v211
  v_lshlrev_b32 v218, 16, v109
  v_and_b32 v219, 0xffff0000, v109
  v_and_b32 v217, 0xffff0000, v216
  v_lshlrev_b32 v216, 16, v216
  v_add_f32 v216, v216, v218
  v_add_f32 v217, v217, v219
  v_cvt_pk_bf16_f32 v216, v216, v217
  v_lshlrev_b32 v218, 16, v121
  v_and_b32 v219, 0xffff0000, v121
  v_add_f32 v218, v218, v242
  v_add_f32 v219, v219, v243
  v_cvt_pk_bf16_f32 v218, v218, v219
  v_and_b32 v217, 0xffff0000, v216
  v_lshlrev_b32 v216, 16, v216
  v_and_b32 v219, 0xffff0000, v218
  v_lshlrev_b32 v218, 16, v218
  v_add_f32 v216, v216, v218
  v_add_f32 v217, v217, v219
  v_cvt_pk_bf16_f32 v221, v216, v217
  v_cvt_pk_bf16_f32 v216, v212, v213
  v_lshlrev_b32 v218, 16, v110
  v_and_b32 v219, 0xffff0000, v110
  v_and_b32 v217, 0xffff0000, v216
  v_lshlrev_b32 v216, 16, v216
  v_add_f32 v216, v216, v218
  v_add_f32 v217, v217, v219
  v_cvt_pk_bf16_f32 v216, v216, v217
  v_lshlrev_b32 v218, 16, v122
  v_and_b32 v219, 0xffff0000, v122
  v_add_f32 v218, v218, v244
  v_add_f32 v219, v219, v245
  v_cvt_pk_bf16_f32 v218, v218, v219
  v_and_b32 v217, 0xffff0000, v216
  v_lshlrev_b32 v216, 16, v216
  v_and_b32 v219, 0xffff0000, v218
  v_lshlrev_b32 v218, 16, v218
  v_add_f32 v216, v216, v218
  v_add_f32 v217, v217, v219
  v_cvt_pk_bf16_f32 v222, v216, v217
  v_cvt_pk_bf16_f32 v216, v214, v215
  v_lshlrev_b32 v218, 16, v111
  v_and_b32 v219, 0xffff0000, v111
  v_and_b32 v217, 0xffff0000, v216
  v_lshlrev_b32 v216, 16, v216
  v_add_f32 v216, v216, v218
  v_add_f32 v217, v217, v219
  v_cvt_pk_bf16_f32 v216, v216, v217
  v_lshlrev_b32 v218, 16, v123
  v_and_b32 v219, 0xffff0000, v123
  v_add_f32 v218, v218, v246
  v_add_f32 v219, v219, v247
  v_cvt_pk_bf16_f32 v218, v218, v219
  v_and_b32 v217, 0xffff0000, v216
  v_lshlrev_b32 v216, 16, v216
  v_and_b32 v219, 0xffff0000, v218
  v_lshlrev_b32 v218, 16, v218
  v_add_f32 v216, v216, v218
  v_add_f32 v217, v217, v219
  v_cvt_pk_bf16_f32 v223, v216, v217
  buffer_store_dwordx4 v[220:223], v14, s[44:47], 0 offen
k3_end:
  s_endpgm
.section .rodata,"a"
.p2align 6
.amdhsa_kernel k3_kernel
  .amdhsa_next_free_vgpr 256
  .amdhsa_next_free_sgpr 102
  .amdhsa_accum_offset 256
  .amdhsa_group_segment_fixed_size 0
  .amdhsa_kernarg_size 112
  .amdhsa_user_sgpr_count 2
  .amdhsa_user_sgpr_kernarg_segment_ptr 1
  .amdhsa_system_sgpr_workgroup_id_x 1
  .amdhsa_float_denorm_mode_32 3
.end_amdhsa_kernel
.text
```

```asm
; @launch kernel=fa_kernel grid=(256,1,1) block=(256,1,1) lds=163840
; @launch kernel=k3_kernel grid=(256,1,1) block=(256,1,1) lds=111616
.amdgcn_target "amdgcn-amd-amdhsa--gfx950"
.text
.globl fa_kernel
.p2align 8
.type fa_kernel,@function
fa_kernel:
  s_cmp_ge_u32 s2, 256
  s_cbranch_scc1 fa_end
  s_load_dwordx4 s[4:7], s[0:1], 0
  s_load_dwordx2 s[14:15], s[0:1], 56
  s_load_dwordx4 s[8:11], s[0:1], 24
  s_load_dwordx2 s[12:13], s[0:1], 40
  s_load_dwordx4 s[16:19], s[0:1], 96
  s_load_dwordx2 s[60:61], s[0:1], 16
  v_lshrrev_b32 v16, 6, v0
  v_and_b32 v1, 63, v0
  v_readfirstlane_b32 s20, v16
  s_and_b32 s21, s2, 7
  s_lshl_b32 s21, s21, 2
  s_lshr_b32 s23, s2, 3
  s_and_b32 s23, s23, 3
  s_add_u32 s21, s21, s23
  s_lshr_b32 s22, s2, 5
  v_and_b32 v208, 31, v1
  v_lshrrev_b32 v209, 5, v1
  s_lshl_b32 s23, s2, 2
  s_add_u32 s23, s23, s20
  s_lshl_b32 s23, s23, 1
  v_add_u32 v209, s23, v209
  v_lshlrev_b32 v212, 4, v208
  v_mul_u32_u24 v210, 1280, v209
  v_add_u32 v210, v210, v212
  v_cmp_gt_u32 s[64:65], 16, v208
  v_mov_b32 v211, 1073741824
  v_lshlrev_b32 v2, 4, v1
  v_cndmask_b32 v211, v211, v210, s[64:65]
  v_lshrrev_b32 v17, 1, v1
  v_lshlrev_b32 v17, 13, v17
  v_and_b32 v18, 1, v1
  v_lshl_add_u32 v17, v18, 7, v17
  s_lshl_b32 s29, s22, 1
  s_and_b32 s31, s20, 1
  s_add_u32 s29, s29, s31
  s_lshl_b32 s29, s29, 18
  s_and_b32 s31, s2, 31
  s_lshl_b32 s31, s31, 2
  s_add_u32 s31, s31, s20
  s_lshl_b32 s31, s31, 11
  v_and_b32 v16, 15, v1
  v_lshlrev_b32 v234, 7, v16
  s_waitcnt lgkmcnt(0)
  s_mov_b32 s44, s4
  s_mov_b32 s45, s5
  s_mov_b32 s46, 2621440
  s_mov_b32 s47, 0x20000
  s_mov_b32 s48, s14
  s_mov_b32 s49, s15
  s_mov_b32 s50, 1280
  s_mov_b32 s51, 0x20000
  buffer_load_dwordx4 v[160:163], v210, s[44:47], 0 offen
  buffer_load_dwordx4 v[164:167], v210, s[44:47], 0 offen offset:512
  buffer_load_dwordx4 v[168:171], v211, s[44:47], 0 offen offset:1024
  buffer_load_dwordx4 v[172:175], v212, s[48:51], 0 offen offset:0
  buffer_load_dwordx4 v[176:179], v212, s[48:51], 0 offen offset:512
  buffer_load_dwordx4 v[180:183], v212, s[48:51], 0 offen offset:1024
  s_lshl_b32 s23, s22, 18
  s_add_u32 s62, s6, s23
  s_addc_u32 s63, s7, 0
  s_mov_b32 s32, s62
  s_mov_b32 s33, s63
  s_mov_b32 s34, 262144
  s_mov_b32 s35, 0x20000
  buffer_load_dword v231, v234, s[32:35], s31 offen
  s_cmp_ge_u32 s20, 2
  s_cselect_b32 s62, s10, s8
  s_cselect_b32 s63, s11, s9
  s_lshl_b32 s23, s21, 8
  s_add_u32 s62, s62, s23
  s_addc_u32 s63, s63, 0
  s_mov_b32 s36, s62
  s_mov_b32 s37, s63
  s_mov_b32 s38, 0
  s_mov_b32 s39, 0x20000
  s_sub_u32 s38, 4194304, s23
  buffer_load_dword v232, v17, s[36:39], s29 offen
  s_add_u32 s60, s60, s23
  s_addc_u32 s61, s61, 0
  s_sub_u32 s75, 5242880, s23
  s_mov_b32 s74, 0
  s_mov_b32 s48, s60
  s_mov_b32 s49, s61
  s_mov_b32 s50, 0
  s_mov_b32 s51, 0x20000
  s_mov_b32 s40, s18
  s_mov_b32 s41, s19
  s_mov_b32 s42, 67108864
  s_mov_b32 s43, 0x20000
  s_mov_b32 s52, s12
  s_mov_b32 s53, s13
  s_mov_b32 s54, 5242880
  s_mov_b32 s55, 0x20000
  s_mov_b32 s56, s16
  s_mov_b32 s57, s17
  s_mov_b32 s58, 256
  s_mov_b32 s59, 0x20000
  v_and_b32 v235, 0xffff, v17
  s_lshl_b32 s23, s22, 2
  s_add_u32 s23, s23, s20
  s_lshl_b32 s23, s23, 16
  v_add_u32 v235, s23, v235
  s_lshl_b32 s23, s20, 5
  s_add_u32 s23, s23, s21
  s_lshl_b32 s23, s23, 2
  s_add_u32 s23, s23, 2641920
  s_lshl_b32 s31, s22, 9
  s_add_u32 s80, s23, s31
  s_sub_u32 s31, 7680, s31
  s_add_u32 s3, s23, s31
  s_lshl_b32 s23, s21, 7
  s_lshl_b32 s31, s22, 2
  s_add_u32 s23, s23, s31
  s_add_u32 s82, s23, 2637824
  s_and_b32 s23, s2, 63
  s_lshl_b32 s23, s23, 2
  s_add_u32 s23, s23, 2650112
  s_cmp_ge_u32 s2, 192
  s_cselect_b32 s23, s23, 1073741824
  s_cmp_eq_u32 s2, 255
  s_cselect_b32 s31, 2650368, 1073741824
  s_cmp_eq_u32 s20, 1
  s_cselect_b32 s31, s23, s31
  s_cmp_eq_u32 s20, 0
  s_cselect_b32 s31, s82, s31
  v_mov_b32 v19, 1073741824
  v_mov_b32 v229, 0
  v_writelane_b32 v19, s80, 0
  v_writelane_b32 v19, s3, 1
  v_writelane_b32 v19, s31, 2
  buffer_store_dword v229, v19, s[40:43], 0 offen sc1
  v_lshrrev_b32 v16, 2, v1
  v_lshrrev_b32 v17, 5, v1
  v_mul_u32_u24 v17, 3, v17
  v_and_b32 v18, 3, v1
  v_xor_b32 v17, v17, v18
  v_lshlrev_b32 v17, 4, v17
  v_lshl_add_u32 v224, v16, 10, v17
  s_lshl_b32 s23, s20, 16
  v_add_u32 v224, s23, v224
  v_add_u32 v225, 15360, v224
  v_add_u32 v226, 30720, v224
  v_add_u32 v227, 46080, v224
  v_and_b32 v16, 3, v16
  v_lshrrev_b32 v17, 4, v1
  v_lshlrev_b32 v17, 6, v17
  v_lshl_add_u32 v16, v16, 13, v17
  s_and_b32 s23, s20, 1
  s_lshl_b32 s23, s23, 17
  v_add_u32 v16, s23, v16
  v_lshl_add_u32 v8, v18, 4, v16
  v_xor_b32 v18, 2, v18
  v_lshl_add_u32 v10, v18, 4, v16
  v_add_u32 v9, 31744, v8
  v_add_u32 v11, 95232, v10
  v_add_u32 v10, 63488, v10
  s_lshl_b32 s24, s20, 12
  s_mov_b32 s26, 0
  s_mov_b32 s27, 0
  s_mov_b32 s25, 262144
  v_mov_b32 v20, 0
  v_mov_b32 v21, 0
  v_mov_b32 v22, 0
  v_mov_b32 v23, 0
  v_and_b32 v16, 15, v1
  v_lshrrev_b32 v17, 4, v1
  v_lshrrev_b32 v18, 3, v16
  v_mul_u32_u24 v18, 3, v18
  v_xor_b32 v18, v18, v17
  v_lshlrev_b32 v18, 4, v18
  v_lshl_add_u32 v14, v16, 6, v18
  s_and_b32 s23, s20, 1
  s_lshl_b32 s23, s23, 13
  v_add_u32 v14, s23, v14
  v_mfma_f32_32x32x16_bf16 a[0:15], v[20:23], v[20:23], 0
  v_mfma_f32_32x32x16_bf16 a[16:31], v[20:23], v[20:23], 0
  v_mfma_f32_32x32x16_bf16 a[32:47], v[20:23], v[20:23], 0
  v_mfma_f32_32x32x16_bf16 a[48:63], v[20:23], v[20:23], 0
  v_mfma_f32_32x32x16_bf16 a[64:79], v[20:23], v[20:23], 0
  v_mfma_f32_32x32x16_bf16 a[80:95], v[20:23], v[20:23], 0
  v_mfma_f32_32x32x16_bf16 a[96:111], v[20:23], v[20:23], 0
  v_mfma_f32_32x32x16_bf16 a[112:127], v[20:23], v[20:23], 0
  v_mfma_f32_32x32x16_bf16 a[128:143], v[20:23], v[20:23], 0
  v_mfma_f32_32x32x16_bf16 a[144:159], v[20:23], v[20:23], 0
  v_mfma_f32_32x32x16_bf16 a[160:175], v[20:23], v[20:23], 0
  v_mfma_f32_32x32x16_bf16 a[176:191], v[20:23], v[20:23], 0
  v_mfma_f32_32x32x16_bf16 a[192:207], v[20:23], v[20:23], 0
  v_mfma_f32_32x32x16_bf16 a[208:223], v[20:23], v[20:23], 0
  v_mfma_f32_32x32x16_bf16 a[224:239], v[20:23], v[20:23], 0
  v_mfma_f32_32x32x16_bf16 a[240:255], v[20:23], v[20:23], 0
  v_lshrrev_b32 v18, 2, v16
  v_lshlrev_b32 v18, 6, v18
  v_lshl_add_u32 v18, v17, 11, v18
  v_and_b32 v19, 1, v1
  v_lshl_add_u32 v18, v19, 3, v18
  v_bfe_u32 v19, v1, 1, 1
  v_and_b32 v17, 1, v17
  v_lshl_or_b32 v19, v17, 1, v19
  s_lshr_b32 s23, s20, 1
  s_lshl_b32 s23, s23, 13
  s_add_u32 s23, s23, 16384
  v_add_u32 v18, s23, v18
  v_lshl_add_u32 v12, v19, 4, v18
  v_xor_b32 v13, 32, v12
  s_waitcnt vmcnt(3)
  s_mov_b32 m0, s24
  s_nop 0
  buffer_load_dwordx4 v224, s[32:35], s26 offen offset:0 lds
  buffer_load_dwordx4 v225, s[32:35], s26 offen offset:1024 lds
  buffer_load_dwordx4 v226, s[32:35], s26 offen offset:2048 lds
  buffer_load_dwordx4 v227, s[32:35], s26 offen offset:3072 lds
  s_add_u32 m0, s24, 16384
  s_nop 0
  buffer_load_dwordx4 v8, s[36:39], s27 offen offset:0 lds
  buffer_load_dwordx4 v9, s[36:39], s27 offen offset:1024 lds
  buffer_load_dwordx4 v10, s[36:39], s27 offen offset:2048 lds
  buffer_load_dwordx4 v11, s[36:39], s27 offen offset:3072 lds
  s_add_u32 s26, s26, 64
  s_add_u32 s27, s27, s25
  s_add_u32 s24, s24, 32768
  s_and_b32 s24, s24, 0x1ffff
  v_lshlrev_b32 v184, 16, v160
  v_and_b32 v185, 0xffff0000, v160
  v_lshlrev_b32 v186, 16, v161
  v_and_b32 v187, 0xffff0000, v161
  v_lshlrev_b32 v188, 16, v162
  v_and_b32 v189, 0xffff0000, v162
  v_lshlrev_b32 v190, 16, v163
  v_and_b32 v191, 0xffff0000, v163
  v_lshlrev_b32 v192, 16, v164
  v_and_b32 v193, 0xffff0000, v164
  v_lshlrev_b32 v194, 16, v165
  v_and_b32 v195, 0xffff0000, v165
  v_lshlrev_b32 v196, 16, v166
  v_and_b32 v197, 0xffff0000, v166
  v_lshlrev_b32 v198, 16, v167
  v_and_b32 v199, 0xffff0000, v167
  v_lshlrev_b32 v200, 16, v168
  v_and_b32 v201, 0xffff0000, v168
  v_lshlrev_b32 v202, 16, v169
  v_and_b32 v203, 0xffff0000, v169
  v_lshlrev_b32 v204, 16, v170
  v_and_b32 v205, 0xffff0000, v170
  v_lshlrev_b32 v206, 16, v171
  v_and_b32 v207, 0xffff0000, v171
  v_add_f32 v213, v184, v185
  v_add_f32 v214, v186, v187
  v_add_f32 v213, v213, v188
  v_add_f32 v214, v214, v189
  v_add_f32 v213, v213, v190
  v_add_f32 v214, v214, v191
  v_add_f32 v213, v213, v192
  v_add_f32 v214, v214, v193
  v_add_f32 v213, v213, v194
  v_add_f32 v214, v214, v195
  v_add_f32 v213, v213, v196
  v_add_f32 v214, v214, v197
  v_add_f32 v213, v213, v198
  v_add_f32 v214, v214, v199
  v_add_f32 v213, v213, v200
  v_add_f32 v214, v214, v201
  v_add_f32 v213, v213, v202
  v_add_f32 v214, v214, v203
  v_add_f32 v213, v213, v204
  v_add_f32 v214, v214, v205
  v_add_f32 v213, v213, v206
  v_add_f32 v214, v214, v207
  v_add_f32 v213, v213, v214
  s_nop 1
  v_add_f32_dpp v213, v213, v213 quad_perm:[1,0,3,2] row_mask:0xf bank_mask:0xf
  s_nop 1
  v_add_f32_dpp v213, v213, v213 quad_perm:[2,3,0,1] row_mask:0xf bank_mask:0xf
  s_nop 1
  v_add_f32_dpp v213, v213, v213 row_half_mirror row_mask:0xf bank_mask:0xf
  s_nop 1
  v_add_f32_dpp v213, v213, v213 row_mirror row_mask:0xf bank_mask:0xf
  v_mov_b32 v214, v213
  s_nop 1
  v_permlane16_swap_b32 v213, v214
  v_add_f32 v213, v213, v214
  v_mul_f32 v215, 0x3acccccd, v213
  v_mov_b32 v218, 0
  v_mov_b32 v213, 0
  v_sub_f32 v16, v184, v215
  v_fmac_f32 v218, v16, v16
  v_sub_f32 v17, v185, v215
  v_fmac_f32 v218, v17, v17
  v_sub_f32 v18, v186, v215
  v_fmac_f32 v218, v18, v18
  v_sub_f32 v19, v187, v215
  v_fmac_f32 v218, v19, v19
  v_sub_f32 v16, v188, v215
  v_fmac_f32 v218, v16, v16
  v_sub_f32 v17, v189, v215
  v_fmac_f32 v218, v17, v17
  v_sub_f32 v18, v190, v215
  v_fmac_f32 v218, v18, v18
  v_sub_f32 v19, v191, v215
  v_fmac_f32 v218, v19, v19
  v_sub_f32 v16, v192, v215
  v_fmac_f32 v218, v16, v16
  v_sub_f32 v17, v193, v215
  v_fmac_f32 v218, v17, v17
  v_sub_f32 v18, v194, v215
  v_fmac_f32 v218, v18, v18
  v_sub_f32 v19, v195, v215
  v_fmac_f32 v218, v19, v19
  v_sub_f32 v16, v196, v215
  v_fmac_f32 v218, v16, v16
  v_sub_f32 v17, v197, v215
  v_fmac_f32 v218, v17, v17
  v_sub_f32 v18, v198, v215
  v_fmac_f32 v218, v18, v18
  v_sub_f32 v19, v199, v215
  v_fmac_f32 v218, v19, v19
  v_sub_f32 v16, v200, v215
  v_fmac_f32 v213, v16, v16
  v_sub_f32 v17, v201, v215
  v_fmac_f32 v213, v17, v17
  v_sub_f32 v18, v202, v215
  v_fmac_f32 v213, v18, v18
  v_sub_f32 v19, v203, v215
  v_fmac_f32 v213, v19, v19
  v_sub_f32 v16, v204, v215
  v_fmac_f32 v213, v16, v16
  v_sub_f32 v17, v205, v215
  v_fmac_f32 v213, v17, v17
  v_sub_f32 v18, v206, v215
  v_fmac_f32 v213, v18, v18
  v_sub_f32 v19, v207, v215
  v_fmac_f32 v213, v19, v19
  v_cndmask_b32 v213, 0, v213, s[64:65]
  v_add_f32 v213, v213, v218
  s_nop 1
  v_add_f32_dpp v213, v213, v213 quad_perm:[1,0,3,2] row_mask:0xf bank_mask:0xf
  s_nop 1
  v_add_f32_dpp v213, v213, v213 quad_perm:[2,3,0,1] row_mask:0xf bank_mask:0xf
  s_nop 1
  v_add_f32_dpp v213, v213, v213 row_half_mirror row_mask:0xf bank_mask:0xf
  s_nop 1
  v_add_f32_dpp v213, v213, v213 row_mirror row_mask:0xf bank_mask:0xf
  v_mov_b32 v214, v213
  s_nop 1
  v_permlane16_swap_b32 v213, v214
  v_add_f32 v213, v213, v214
  v_mul_f32 v213, 0x3acccccd, v213
  v_cvt_pk_bf16_f32 v213, v213, v213
  v_and_b32 v213, 0xffff0000, v213
  v_add_f32 v213, 0x3727c5ac, v213
  v_cvt_pk_bf16_f32 v213, v213, v213
  v_and_b32 v213, 0xffff0000, v213
  v_sqrt_f32 v213, v213
  v_mov_b32 v216, v215
  v_cvt_pk_bf16_f32 v213, v213, v213
  v_and_b32 v213, 0xffff0000, v213
  v_rcp_f32 v217, v213
  v_cvt_pk_bf16_f32 v216, v216, v216
  v_and_b32 v216, 0xffff0000, v216
  v_mov_b32 v218, 0
  v_sub_f32 v184, v184, v216
  v_sub_f32 v185, v185, v216
  v_cvt_pk_bf16_f32 v16, v184, v185
  v_lshlrev_b32 v184, 16, v16
  v_and_b32 v185, 0xffff0000, v16
  v_mul_f32 v184, v184, v217
  v_mul_f32 v185, v185, v217
  v_cvt_pk_bf16_f32 v160, v184, v185
  v_lshlrev_b32 v184, 16, v160
  v_and_b32 v185, 0xffff0000, v160
  v_lshlrev_b32 v17, 16, v172
  v_and_b32 v18, 0xffff0000, v172
  v_fmac_f32 v218, v184, v17
  v_fmac_f32 v218, v185, v18
  v_sub_f32 v186, v186, v216
  v_sub_f32 v187, v187, v216
  v_cvt_pk_bf16_f32 v16, v186, v187
  v_lshlrev_b32 v186, 16, v16
  v_and_b32 v187, 0xffff0000, v16
  v_mul_f32 v186, v186, v217
  v_mul_f32 v187, v187, v217
  v_cvt_pk_bf16_f32 v161, v186, v187
  v_lshlrev_b32 v186, 16, v161
  v_and_b32 v187, 0xffff0000, v161
  v_lshlrev_b32 v17, 16, v173
  v_and_b32 v18, 0xffff0000, v173
  v_fmac_f32 v218, v186, v17
  v_fmac_f32 v218, v187, v18
  v_sub_f32 v188, v188, v216
  v_sub_f32 v189, v189, v216
  v_cvt_pk_bf16_f32 v16, v188, v189
  v_lshlrev_b32 v188, 16, v16
  v_and_b32 v189, 0xffff0000, v16
  v_mul_f32 v188, v188, v217
  v_mul_f32 v189, v189, v217
  v_cvt_pk_bf16_f32 v162, v188, v189
  v_lshlrev_b32 v188, 16, v162
  v_and_b32 v189, 0xffff0000, v162
  v_lshlrev_b32 v17, 16, v174
  v_and_b32 v18, 0xffff0000, v174
  v_fmac_f32 v218, v188, v17
  v_fmac_f32 v218, v189, v18
  v_sub_f32 v190, v190, v216
  v_sub_f32 v191, v191, v216
  v_cvt_pk_bf16_f32 v16, v190, v191
  v_lshlrev_b32 v190, 16, v16
  v_and_b32 v191, 0xffff0000, v16
  v_mul_f32 v190, v190, v217
  v_mul_f32 v191, v191, v217
  v_cvt_pk_bf16_f32 v163, v190, v191
  v_lshlrev_b32 v190, 16, v163
  v_and_b32 v191, 0xffff0000, v163
  v_lshlrev_b32 v17, 16, v175
  v_and_b32 v18, 0xffff0000, v175
  v_fmac_f32 v218, v190, v17
  v_fmac_f32 v218, v191, v18
  v_sub_f32 v192, v192, v216
  v_sub_f32 v193, v193, v216
  v_cvt_pk_bf16_f32 v16, v192, v193
  v_lshlrev_b32 v192, 16, v16
  v_and_b32 v193, 0xffff0000, v16
  v_mul_f32 v192, v192, v217
  v_mul_f32 v193, v193, v217
  v_cvt_pk_bf16_f32 v164, v192, v193
  v_lshlrev_b32 v192, 16, v164
  v_and_b32 v193, 0xffff0000, v164
  v_lshlrev_b32 v17, 16, v176
  v_and_b32 v18, 0xffff0000, v176
  v_fmac_f32 v218, v192, v17
  v_fmac_f32 v218, v193, v18
  v_sub_f32 v194, v194, v216
  v_sub_f32 v195, v195, v216
  v_cvt_pk_bf16_f32 v16, v194, v195
  v_lshlrev_b32 v194, 16, v16
  v_and_b32 v195, 0xffff0000, v16
  v_mul_f32 v194, v194, v217
  v_mul_f32 v195, v195, v217
  v_cvt_pk_bf16_f32 v165, v194, v195
  v_lshlrev_b32 v194, 16, v165
  v_and_b32 v195, 0xffff0000, v165
  v_lshlrev_b32 v17, 16, v177
  v_and_b32 v18, 0xffff0000, v177
  v_fmac_f32 v218, v194, v17
  v_fmac_f32 v218, v195, v18
  v_sub_f32 v196, v196, v216
  v_sub_f32 v197, v197, v216
  v_cvt_pk_bf16_f32 v16, v196, v197
  v_lshlrev_b32 v196, 16, v16
  v_and_b32 v197, 0xffff0000, v16
  v_mul_f32 v196, v196, v217
  v_mul_f32 v197, v197, v217
  v_cvt_pk_bf16_f32 v166, v196, v197
  v_lshlrev_b32 v196, 16, v166
  v_and_b32 v197, 0xffff0000, v166
  v_lshlrev_b32 v17, 16, v178
  v_and_b32 v18, 0xffff0000, v178
  v_fmac_f32 v218, v196, v17
  v_fmac_f32 v218, v197, v18
  v_sub_f32 v198, v198, v216
  v_sub_f32 v199, v199, v216
  v_cvt_pk_bf16_f32 v16, v198, v199
  v_lshlrev_b32 v198, 16, v16
  v_and_b32 v199, 0xffff0000, v16
  v_mul_f32 v198, v198, v217
  v_mul_f32 v199, v199, v217
  v_cvt_pk_bf16_f32 v167, v198, v199
  v_lshlrev_b32 v198, 16, v167
  v_and_b32 v199, 0xffff0000, v167
  v_lshlrev_b32 v17, 16, v179
  v_and_b32 v18, 0xffff0000, v179
  v_fmac_f32 v218, v198, v17
  v_fmac_f32 v218, v199, v18
  v_sub_f32 v200, v200, v216
  v_sub_f32 v201, v201, v216
  v_cvt_pk_bf16_f32 v16, v200, v201
  v_lshlrev_b32 v200, 16, v16
  v_and_b32 v201, 0xffff0000, v16
  v_mul_f32 v200, v200, v217
  v_mul_f32 v201, v201, v217
  v_cvt_pk_bf16_f32 v168, v200, v201
  v_lshlrev_b32 v200, 16, v168
  v_and_b32 v201, 0xffff0000, v168
  v_lshlrev_b32 v17, 16, v180
  v_and_b32 v18, 0xffff0000, v180
  v_fmac_f32 v218, v200, v17
  v_fmac_f32 v218, v201, v18
  v_sub_f32 v202, v202, v216
  v_sub_f32 v203, v203, v216
  v_cvt_pk_bf16_f32 v16, v202, v203
  v_lshlrev_b32 v202, 16, v16
  v_and_b32 v203, 0xffff0000, v16
  v_mul_f32 v202, v202, v217
  v_mul_f32 v203, v203, v217
  v_cvt_pk_bf16_f32 v169, v202, v203
  v_lshlrev_b32 v202, 16, v169
  v_and_b32 v203, 0xffff0000, v169
  v_lshlrev_b32 v17, 16, v181
  v_and_b32 v18, 0xffff0000, v181
  v_fmac_f32 v218, v202, v17
  v_fmac_f32 v218, v203, v18
  v_sub_f32 v204, v204, v216
  v_sub_f32 v205, v205, v216
  v_cvt_pk_bf16_f32 v16, v204, v205
  v_lshlrev_b32 v204, 16, v16
  v_and_b32 v205, 0xffff0000, v16
  v_mul_f32 v204, v204, v217
  v_mul_f32 v205, v205, v217
  v_cvt_pk_bf16_f32 v170, v204, v205
  v_lshlrev_b32 v204, 16, v170
  v_and_b32 v205, 0xffff0000, v170
  v_lshlrev_b32 v17, 16, v182
  v_and_b32 v18, 0xffff0000, v182
  v_fmac_f32 v218, v204, v17
  v_fmac_f32 v218, v205, v18
  v_sub_f32 v206, v206, v216
  v_sub_f32 v207, v207, v216
  v_cvt_pk_bf16_f32 v16, v206, v207
  v_lshlrev_b32 v206, 16, v16
  v_and_b32 v207, 0xffff0000, v16
  v_mul_f32 v206, v206, v217
  v_mul_f32 v207, v207, v217
  v_cvt_pk_bf16_f32 v171, v206, v207
  v_lshlrev_b32 v206, 16, v171
  v_and_b32 v207, 0xffff0000, v171
  v_lshlrev_b32 v17, 16, v183
  v_and_b32 v18, 0xffff0000, v183
  v_fmac_f32 v218, v206, v17
  v_fmac_f32 v218, v207, v18
  v_and_b32 v16, 7, v209
  v_lshlrev_b32 v16, 4, v16
  v_lshl_add_u32 v16, v208, 7, v16
  v_add_u32 v16, 131072, v16
  ds_write_b128 v16, v[160:163] offset:0
  ds_write_b128 v16, v[164:167] offset:4096
  ds_write_b128 v16, v[168:171] offset:8192
  s_nop 1
  v_add_f32_dpp v218, v218, v218 quad_perm:[1,0,3,2] row_mask:0xf bank_mask:0xf
  s_nop 1
  v_add_f32_dpp v218, v218, v218 quad_perm:[2,3,0,1] row_mask:0xf bank_mask:0xf
  s_nop 1
  v_add_f32_dpp v218, v218, v218 row_half_mirror row_mask:0xf bank_mask:0xf
  s_nop 1
  v_add_f32_dpp v218, v218, v218 row_mirror row_mask:0xf bank_mask:0xf
  v_mov_b32 v214, v218
  s_nop 1
  v_permlane16_swap_b32 v218, v214
  v_add_f32 v218, v218, v214
  v_cvt_pk_bf16_f32 v218, v218, v218
  v_and_b32 v218, 0xffff0000, v218
  v_ashrrev_i32 v214, 31, v218
  v_or_b32 v214, 0x80000000, v214
  v_xor_b32 v218, v218, v214
  v_and_b32 v218, 0xffff0000, v218
  v_sub_u32 v214, 0xffff, v209
  v_or_b32 v218, v218, v214
  v_lshlrev_b32 v214, 2, v209
  v_add_u32 v214, 2621440, v214
  v_mov_b32 v19, 1073741824
  v_cmp_eq_u32 vcc, 0, v208
  v_lshlrev_b32 v16, 4, v0
  v_add_u32 v16, 131072, v16
  v_cndmask_b32 v214, v19, v214, vcc
  v_lshrrev_b32 v17, 3, v0
  v_and_b32 v18, 7, v0
  v_lshlrev_b32 v18, 4, v18
  v_lshl_add_u32 v17, v17, 8, v18
  v_cmp_gt_u32 vcc, 128, v0
  s_lshr_b32 s23, s2, 1
  s_mul_i32 s23, s23, 20480
  s_and_b32 s31, s2, 1
  s_lshl_b32 s31, s31, 7
  s_add_u32 s23, s23, s31
  v_cndmask_b32 v18, v19, v17, vcc
  s_add_u32 s31, s23, 8192
  s_add_u32 s62, s23, 16384
  s_waitcnt lgkmcnt(0)
  s_barrier
  ds_read_b128 v[160:163], v16 offset:0
  ds_read_b128 v[164:167], v16 offset:4096
  ds_read_b128 v[168:171], v16 offset:8192
  buffer_store_dword v218, v214, s[40:43], 0 offen sc1
  s_mov_b32 s28, 0
  s_waitcnt lgkmcnt(0)
  buffer_store_dwordx4 v[160:163], v17, s[40:43], s23 offen sc1
  buffer_store_dwordx4 v[164:167], v17, s[40:43], s31 offen sc1
  buffer_store_dwordx4 v[168:171], v18, s[40:43], s62 offen sc1
  s_mov_b32 m0, s24
  s_nop 0
  buffer_load_dwordx4 v224, s[32:35], s26 offen offset:0 lds
  buffer_load_dwordx4 v225, s[32:35], s26 offen offset:1024 lds
  buffer_load_dwordx4 v226, s[32:35], s26 offen offset:2048 lds
  buffer_load_dwordx4 v227, s[32:35], s26 offen offset:3072 lds
  s_add_u32 m0, s24, 16384
  s_nop 0
  buffer_load_dwordx4 v8, s[36:39], s27 offen offset:0 lds
  buffer_load_dwordx4 v9, s[36:39], s27 offen offset:1024 lds
  buffer_load_dwordx4 v10, s[36:39], s27 offen offset:2048 lds
  buffer_load_dwordx4 v11, s[36:39], s27 offen offset:3072 lds
  s_add_u32 s26, s26, 64
  s_add_u32 s27, s27, s25
  s_add_u32 s24, s24, 32768
  s_and_b32 s24, s24, 0x1ffff
  s_mov_b32 m0, s24
  s_nop 0
  buffer_load_dwordx4 v224, s[32:35], s26 offen offset:0 lds
  buffer_load_dwordx4 v225, s[32:35], s26 offen offset:1024 lds
  buffer_load_dwordx4 v226, s[32:35], s26 offen offset:2048 lds
  buffer_load_dwordx4 v227, s[32:35], s26 offen offset:3072 lds
  s_add_u32 m0, s24, 16384
  s_nop 0
  buffer_load_dwordx4 v8, s[36:39], s27 offen offset:0 lds
  buffer_load_dwordx4 v9, s[36:39], s27 offen offset:1024 lds
  buffer_load_dwordx4 v10, s[36:39], s27 offen offset:2048 lds
  buffer_load_dwordx4 v11, s[36:39], s27 offen offset:3072 lds
  s_add_u32 s26, s26, 64
  s_add_u32 s27, s27, s25
  s_add_u32 s24, s24, 32768
  s_and_b32 s24, s24, 0x1ffff
  s_getpc_b64 s[62:63]
fa_pc:
  s_lshr_b32 s23, s2, 3
  s_and_b32 s23, s23, 7
  s_lshl_b32 s23, s23, 2
  s_add_u32 s23, s23, s20
  s_lshl_b32 s23, s23, 11
  s_min_u32 s23, s23, fa_codeend-fa_pc-2048
  v_add_u32 v234, s23, v234
  global_load_dword v231, v234, s[62:63]
  s_mov_b32 m0, s24
  s_nop 0
  buffer_load_dwordx4 v224, s[32:35], s26 offen offset:0 lds
  buffer_load_dwordx4 v225, s[32:35], s26 offen offset:1024 lds
  buffer_load_dwordx4 v226, s[32:35], s26 offen offset:2048 lds
  buffer_load_dwordx4 v227, s[32:35], s26 offen offset:3072 lds
  s_add_u32 m0, s24, 16384
  s_nop 0
  buffer_load_dwordx4 v8, s[36:39], s27 offen offset:0 lds
  buffer_load_dwordx4 v9, s[36:39], s27 offen offset:1024 lds
  buffer_load_dwordx4 v10, s[36:39], s27 offen offset:2048 lds
  buffer_load_dwordx4 v11, s[36:39], s27 offen offset:3072 lds
  s_add_u32 s26, s26, 64
  s_add_u32 s27, s27, s25
  s_add_u32 s24, s24, 32768
  s_and_b32 s24, s24, 0x1ffff
  s_waitcnt vmcnt(29)
  s_barrier
  s_cmp_ge_u32 s20, 2
  s_cbranch_scc1 fa_roleV
  ds_read_b128 v[96:99], v14 offset:0
  ds_read_b128 v[100:103], v14 offset:1024
  ds_read_b128 v[104:107], v14 offset:2048
  ds_read_b128 v[108:111], v14 offset:3072
  ds_read_b128 v[112:115], v14 offset:4096
  ds_read_b128 v[116:119], v14 offset:5120
  ds_read_b128 v[120:123], v14 offset:6144
  ds_read_b128 v[124:127], v14 offset:7168
  ds_read_b64_tr_b16 v[32:33], v12 offset:0
  ds_read_b64_tr_b16 v[34:35], v12 offset:1024
  ds_read_b64_tr_b16 v[36:37], v13 offset:0
  ds_read_b64_tr_b16 v[38:39], v13 offset:1024
  ds_read_b64_tr_b16 v[40:41], v12 offset:256
  ds_read_b64_tr_b16 v[42:43], v12 offset:1280
  ds_read_b64_tr_b16 v[44:45], v13 offset:256
  ds_read_b64_tr_b16 v[46:47], v13 offset:1280
  ds_read_b64_tr_b16 v[48:49], v12 offset:512
  ds_read_b64_tr_b16 v[50:51], v12 offset:1536
  ds_read_b64_tr_b16 v[52:53], v13 offset:512
  ds_read_b64_tr_b16 v[54:55], v13 offset:1536
  ds_read_b64_tr_b16 v[56:57], v12 offset:768
  ds_read_b64_tr_b16 v[58:59], v12 offset:1792
  ds_read_b64_tr_b16 v[60:61], v13 offset:768
  ds_read_b64_tr_b16 v[62:63], v13 offset:1792
  s_waitcnt lgkmcnt(0)
.p2align 6
fa_loopK:
  v_mfma_f32_16x16x32_bf16 a[0:3], v[32:35], v[96:99], a[0:3]
  s_waitcnt vmcnt(17)
  v_mfma_f32_16x16x32_bf16 a[4:7], v[32:35], v[100:103], a[4:7]
  s_barrier
  v_mfma_f32_16x16x32_bf16 a[8:11], v[32:35], v[104:107], a[8:11]
  s_bitcmp1_b32 0x41, s28
  ds_read_b64_tr_b16 v[64:65], v12 offset:32768
  v_mfma_f32_16x16x32_bf16 a[12:15], v[32:35], v[108:111], a[12:15]
  s_cbranch_scc1 fa_p1stubK
fa_p1backK:
  v_mfma_f32_16x16x32_bf16 a[16:19], v[32:35], v[112:115], a[16:19]
  s_mov_b32 m0, s24
  ds_read_b64_tr_b16 v[66:67], v12 offset:33792
  v_mfma_f32_16x16x32_bf16 a[20:23], v[32:35], v[116:119], a[20:23]
  buffer_load_dwordx4 v224, s[32:35], s26 offen offset:0 lds
  v_mfma_f32_16x16x32_bf16 a[24:27], v[32:35], v[120:123], a[24:27]
  ds_read_b128 v[128:131], v14 offset:32768
  v_mfma_f32_16x16x32_bf16 a[28:31], v[32:35], v[124:127], a[28:31]
  buffer_load_dwordx4 v225, s[32:35], s26 offen offset:1024 lds
  v_mfma_f32_16x16x32_bf16 a[32:35], v[36:39], v[96:99], a[32:35]
  ds_read_b64_tr_b16 v[68:69], v13 offset:32768
  v_mfma_f32_16x16x32_bf16 a[36:39], v[36:39], v[100:103], a[36:39]
  buffer_load_dwordx4 v226, s[32:35], s26 offen offset:2048 lds
  v_mfma_f32_16x16x32_bf16 a[40:43], v[36:39], v[104:107], a[40:43]
  ds_read_b64_tr_b16 v[70:71], v13 offset:33792
  v_mfma_f32_16x16x32_bf16 a[44:47], v[36:39], v[108:111], a[44:47]
  buffer_load_dwordx4 v227, s[32:35], s26 offen offset:3072 lds
  v_mfma_f32_16x16x32_bf16 a[48:51], v[36:39], v[112:115], a[48:51]
  s_add_u32 m0, s24, 16384
  ds_read_b128 v[132:135], v14 offset:33792
  v_mfma_f32_16x16x32_bf16 a[52:55], v[36:39], v[116:119], a[52:55]
  buffer_load_dwordx4 v8, s[36:39], s27 offen offset:0 lds
  v_mfma_f32_16x16x32_bf16 a[56:59], v[36:39], v[120:123], a[56:59]
  ds_read_b64_tr_b16 v[72:73], v12 offset:33024
  v_mfma_f32_16x16x32_bf16 a[60:63], v[36:39], v[124:127], a[60:63]
  buffer_load_dwordx4 v9, s[36:39], s27 offen offset:1024 lds
  v_mfma_f32_16x16x32_bf16 a[64:67], v[40:43], v[96:99], a[64:67]
  s_bitcmp1_b32 0x2a, s28
  ds_read_b64_tr_b16 v[74:75], v12 offset:34048
  v_mfma_f32_16x16x32_bf16 a[68:71], v[40:43], v[100:103], a[68:71]
  s_cselect_b32 s50, s75, 0
  buffer_load_dwordx4 v10, s[36:39], s27 offen offset:2048 lds
  v_mfma_f32_16x16x32_bf16 a[72:75], v[40:43], v[104:107], a[72:75]
  s_cselect_b32 s23, 2097152, 0
  ds_read_b128 v[136:139], v14 offset:34816
  v_mfma_f32_16x16x32_bf16 a[76:79], v[40:43], v[108:111], a[76:79]
  buffer_load_dwordx4 v11, s[36:39], s27 offen offset:3072 lds
  v_mfma_f32_16x16x32_bf16 a[80:83], v[40:43], v[112:115], a[80:83]
  ds_read_b64_tr_b16 v[76:77], v13 offset:33024
  v_mfma_f32_16x16x32_bf16 a[84:87], v[40:43], v[116:119], a[84:87]
  buffer_load_dword v231, v235, s[48:51], s74 offen
  v_mfma_f32_16x16x32_bf16 a[88:91], v[40:43], v[120:123], a[88:91]
  s_add_u32 s74, s74, s23
  ds_read_b64_tr_b16 v[78:79], v13 offset:34048
  v_mfma_f32_16x16x32_bf16 a[92:95], v[40:43], v[124:127], a[92:95]
  v_mfma_f32_16x16x32_bf16 a[96:99], v[44:47], v[96:99], a[96:99]
  ds_read_b128 v[140:143], v14 offset:35840
  v_mfma_f32_16x16x32_bf16 a[100:103], v[44:47], v[100:103], a[100:103]
  v_mfma_f32_16x16x32_bf16 a[104:107], v[44:47], v[104:107], a[104:107]
  ds_read_b64_tr_b16 v[80:81], v12 offset:33280
  v_mfma_f32_16x16x32_bf16 a[108:111], v[44:47], v[108:111], a[108:111]
  v_mfma_f32_16x16x32_bf16 a[112:115], v[44:47], v[112:115], a[112:115]
  ds_read_b64_tr_b16 v[82:83], v12 offset:34304
  v_mfma_f32_16x16x32_bf16 a[116:119], v[44:47], v[116:119], a[116:119]
  v_mfma_f32_16x16x32_bf16 a[120:123], v[44:47], v[120:123], a[120:123]
  ds_read_b128 v[144:147], v14 offset:36864
  v_mfma_f32_16x16x32_bf16 a[124:127], v[44:47], v[124:127], a[124:127]
  v_mfma_f32_16x16x32_bf16 a[128:131], v[48:51], v[96:99], a[128:131]
  ds_read_b64_tr_b16 v[84:85], v13 offset:33280
  v_mfma_f32_16x16x32_bf16 a[132:135], v[48:51], v[100:103], a[132:135]
  v_mfma_f32_16x16x32_bf16 a[136:139], v[48:51], v[104:107], a[136:139]
  ds_read_b64_tr_b16 v[86:87], v13 offset:34304
  v_mfma_f32_16x16x32_bf16 a[140:143], v[48:51], v[108:111], a[140:143]
  v_mfma_f32_16x16x32_bf16 a[144:147], v[48:51], v[112:115], a[144:147]
  ds_read_b128 v[148:151], v14 offset:37888
  v_mfma_f32_16x16x32_bf16 a[148:151], v[48:51], v[116:119], a[148:151]
  v_mfma_f32_16x16x32_bf16 a[152:155], v[48:51], v[120:123], a[152:155]
  ds_read_b64_tr_b16 v[88:89], v12 offset:33536
  v_mfma_f32_16x16x32_bf16 a[156:159], v[48:51], v[124:127], a[156:159]
  v_mfma_f32_16x16x32_bf16 a[160:163], v[52:55], v[96:99], a[160:163]
  ds_read_b64_tr_b16 v[90:91], v12 offset:34560
  v_mfma_f32_16x16x32_bf16 a[164:167], v[52:55], v[100:103], a[164:167]
  v_mfma_f32_16x16x32_bf16 a[168:171], v[52:55], v[104:107], a[168:171]
  ds_read_b128 v[152:155], v14 offset:38912
  v_mfma_f32_16x16x32_bf16 a[172:175], v[52:55], v[108:111], a[172:175]
  v_mfma_f32_16x16x32_bf16 a[176:179], v[52:55], v[112:115], a[176:179]
  ds_read_b64_tr_b16 v[92:93], v13 offset:33536
  v_mfma_f32_16x16x32_bf16 a[180:183], v[52:55], v[116:119], a[180:183]
  v_mfma_f32_16x16x32_bf16 a[184:187], v[52:55], v[120:123], a[184:187]
  ds_read_b64_tr_b16 v[94:95], v13 offset:34560
  v_mfma_f32_16x16x32_bf16 a[188:191], v[52:55], v[124:127], a[188:191]
  v_mfma_f32_16x16x32_bf16 a[192:195], v[56:59], v[96:99], a[192:195]
  s_add_u32 s26, s26, 64
  ds_read_b128 v[156:159], v14 offset:39936
  v_mfma_f32_16x16x32_bf16 a[196:199], v[56:59], v[100:103], a[196:199]
  s_add_u32 s27, s27, s25
  v_mfma_f32_16x16x32_bf16 a[200:203], v[56:59], v[104:107], a[200:203]
  s_add_u32 s24, s24, 32768
  v_mfma_f32_16x16x32_bf16 a[204:207], v[56:59], v[108:111], a[204:207]
  s_and_b32 s24, s24, 0x1ffff
  v_mfma_f32_16x16x32_bf16 a[208:211], v[56:59], v[112:115], a[208:211]
  v_xor_b32 v14, 0x10000, v14
  v_mfma_f32_16x16x32_bf16 a[212:215], v[56:59], v[116:119], a[212:215]
  v_xor_b32 v12, 0x10000, v12
  v_mfma_f32_16x16x32_bf16 a[216:219], v[56:59], v[120:123], a[216:219]
  v_xor_b32 v13, 0x10000, v13
  v_mfma_f32_16x16x32_bf16 a[220:223], v[56:59], v[124:127], a[220:223]
  v_mfma_f32_16x16x32_bf16 a[224:227], v[60:63], v[96:99], a[224:227]
  v_mfma_f32_16x16x32_bf16 a[228:231], v[60:63], v[100:103], a[228:231]
  v_mfma_f32_16x16x32_bf16 a[232:235], v[60:63], v[104:107], a[232:235]
  v_mfma_f32_16x16x32_bf16 a[236:239], v[60:63], v[108:111], a[236:239]
  v_mfma_f32_16x16x32_bf16 a[240:243], v[60:63], v[112:115], a[240:243]
  v_mfma_f32_16x16x32_bf16 a[244:247], v[60:63], v[116:119], a[244:247]
  v_mfma_f32_16x16x32_bf16 a[248:251], v[60:63], v[120:123], a[248:251]
  v_mfma_f32_16x16x32_bf16 a[252:255], v[60:63], v[124:127], a[252:255]
  s_waitcnt lgkmcnt(0)
  v_mfma_f32_16x16x32_bf16 a[0:3], v[64:67], v[128:131], a[0:3]
  s_waitcnt vmcnt(18)
  v_mfma_f32_16x16x32_bf16 a[4:7], v[64:67], v[132:135], a[4:7]
  s_barrier
  v_mfma_f32_16x16x32_bf16 a[8:11], v[64:67], v[136:139], a[8:11]
  ds_read_b64_tr_b16 v[32:33], v12 offset:0
  v_mfma_f32_16x16x32_bf16 a[12:15], v[64:67], v[140:143], a[12:15]
  v_mfma_f32_16x16x32_bf16 a[16:19], v[64:67], v[144:147], a[16:19]
  s_mov_b32 m0, s24
  ds_read_b64_tr_b16 v[34:35], v12 offset:1024
  v_mfma_f32_16x16x32_bf16 a[20:23], v[64:67], v[148:151], a[20:23]
  buffer_load_dwordx4 v224, s[32:35], s26 offen offset:0 lds
  v_mfma_f32_16x16x32_bf16 a[24:27], v[64:67], v[152:155], a[24:27]
  ds_read_b128 v[96:99], v14 offset:0
  v_mfma_f32_16x16x32_bf16 a[28:31], v[64:67], v[156:159], a[28:31]
  v_mfma_f32_16x16x32_bf16 a[32:35], v[68:71], v[128:131], a[32:35]
  ds_read_b64_tr_b16 v[36:37], v13 offset:0
  v_mfma_f32_16x16x32_bf16 a[36:39], v[68:71], v[132:135], a[36:39]
  v_mfma_f32_16x16x32_bf16 a[40:43], v[68:71], v[136:139], a[40:43]
  ds_read_b64_tr_b16 v[38:39], v13 offset:1024
  v_mfma_f32_16x16x32_bf16 a[44:47], v[68:71], v[140:143], a[44:47]
  buffer_load_dwordx4 v225, s[32:35], s26 offen offset:1024 lds
  v_mfma_f32_16x16x32_bf16 a[48:51], v[68:71], v[144:147], a[48:51]
  ds_read_b128 v[100:103], v14 offset:1024
  v_mfma_f32_16x16x32_bf16 a[52:55], v[68:71], v[148:151], a[52:55]
  v_mfma_f32_16x16x32_bf16 a[56:59], v[68:71], v[152:155], a[56:59]
  ds_read_b64_tr_b16 v[40:41], v12 offset:256
  v_mfma_f32_16x16x32_bf16 a[60:63], v[68:71], v[156:159], a[60:63]
  v_mfma_f32_16x16x32_bf16 a[64:67], v[72:75], v[128:131], a[64:67]
  ds_read_b64_tr_b16 v[42:43], v12 offset:1280
  v_mfma_f32_16x16x32_bf16 a[68:71], v[72:75], v[132:135], a[68:71]
  buffer_load_dwordx4 v226, s[32:35], s26 offen offset:2048 lds
  v_mfma_f32_16x16x32_bf16 a[72:75], v[72:75], v[136:139], a[72:75]
  ds_read_b128 v[104:107], v14 offset:2048
  v_mfma_f32_16x16x32_bf16 a[76:79], v[72:75], v[140:143], a[76:79]
  v_mfma_f32_16x16x32_bf16 a[80:83], v[72:75], v[144:147], a[80:83]
  ds_read_b64_tr_b16 v[44:45], v13 offset:256
  v_mfma_f32_16x16x32_bf16 a[84:87], v[72:75], v[148:151], a[84:87]
  v_mfma_f32_16x16x32_bf16 a[88:91], v[72:75], v[152:155], a[88:91]
  ds_read_b64_tr_b16 v[46:47], v13 offset:1280
  v_mfma_f32_16x16x32_bf16 a[92:95], v[72:75], v[156:159], a[92:95]
  buffer_load_dwordx4 v227, s[32:35], s26 offen offset:3072 lds
  v_mfma_f32_16x16x32_bf16 a[96:99], v[76:79], v[128:131], a[96:99]
  ds_read_b128 v[108:111], v14 offset:3072
  v_mfma_f32_16x16x32_bf16 a[100:103], v[76:79], v[132:135], a[100:103]
  v_mfma_f32_16x16x32_bf16 a[104:107], v[76:79], v[136:139], a[104:107]
  ds_read_b64_tr_b16 v[48:49], v12 offset:512
  v_mfma_f32_16x16x32_bf16 a[108:111], v[76:79], v[140:143], a[108:111]
  v_mfma_f32_16x16x32_bf16 a[112:115], v[76:79], v[144:147], a[112:115]
  s_add_u32 m0, s24, 16384
  ds_read_b64_tr_b16 v[50:51], v12 offset:1536
  v_mfma_f32_16x16x32_bf16 a[116:119], v[76:79], v[148:151], a[116:119]
  buffer_load_dwordx4 v8, s[36:39], s27 offen offset:0 lds
  v_mfma_f32_16x16x32_bf16 a[120:123], v[76:79], v[152:155], a[120:123]
  ds_read_b128 v[112:115], v14 offset:4096
  v_mfma_f32_16x16x32_bf16 a[124:127], v[76:79], v[156:159], a[124:127]
  v_mfma_f32_16x16x32_bf16 a[128:131], v[80:83], v[128:131], a[128:131]
  ds_read_b64_tr_b16 v[52:53], v13 offset:512
  v_mfma_f32_16x16x32_bf16 a[132:135], v[80:83], v[132:135], a[132:135]
  v_mfma_f32_16x16x32_bf16 a[136:139], v[80:83], v[136:139], a[136:139]
  ds_read_b64_tr_b16 v[54:55], v13 offset:1536
  v_mfma_f32_16x16x32_bf16 a[140:143], v[80:83], v[140:143], a[140:143]
  buffer_load_dwordx4 v9, s[36:39], s27 offen offset:1024 lds
  v_mfma_f32_16x16x32_bf16 a[144:147], v[80:83], v[144:147], a[144:147]
  ds_read_b128 v[116:119], v14 offset:5120
  v_mfma_f32_16x16x32_bf16 a[148:151], v[80:83], v[148:151], a[148:151]
  v_mfma_f32_16x16x32_bf16 a[152:155], v[80:83], v[152:155], a[152:155]
  ds_read_b64_tr_b16 v[56:57], v12 offset:768
  v_mfma_f32_16x16x32_bf16 a[156:159], v[80:83], v[156:159], a[156:159]
  v_mfma_f32_16x16x32_bf16 a[160:163], v[84:87], v[128:131], a[160:163]
  ds_read_b64_tr_b16 v[58:59], v12 offset:1792
  v_mfma_f32_16x16x32_bf16 a[164:167], v[84:87], v[132:135], a[164:167]
  buffer_load_dwordx4 v10, s[36:39], s27 offen offset:2048 lds
  v_mfma_f32_16x16x32_bf16 a[168:171], v[84:87], v[136:139], a[168:171]
  ds_read_b128 v[120:123], v14 offset:6144
  v_mfma_f32_16x16x32_bf16 a[172:175], v[84:87], v[140:143], a[172:175]
  v_mfma_f32_16x16x32_bf16 a[176:179], v[84:87], v[144:147], a[176:179]
  ds_read_b64_tr_b16 v[60:61], v13 offset:768
  v_mfma_f32_16x16x32_bf16 a[180:183], v[84:87], v[148:151], a[180:183]
  v_mfma_f32_16x16x32_bf16 a[184:187], v[84:87], v[152:155], a[184:187]
  ds_read_b64_tr_b16 v[62:63], v13 offset:1792
  v_mfma_f32_16x16x32_bf16 a[188:191], v[84:87], v[156:159], a[188:191]
  buffer_load_dwordx4 v11, s[36:39], s27 offen offset:3072 lds
  v_mfma_f32_16x16x32_bf16 a[192:195], v[88:91], v[128:131], a[192:195]
  s_add_u32 s26, s26, 64
  ds_read_b128 v[124:127], v14 offset:7168
  v_mfma_f32_16x16x32_bf16 a[196:199], v[88:91], v[132:135], a[196:199]
  s_add_u32 s27, s27, s25
  v_mfma_f32_16x16x32_bf16 a[200:203], v[88:91], v[136:139], a[200:203]
  s_add_u32 s24, s24, 32768
  v_mfma_f32_16x16x32_bf16 a[204:207], v[88:91], v[140:143], a[204:207]
  s_and_b32 s24, s24, 0x1ffff
  v_mfma_f32_16x16x32_bf16 a[208:211], v[88:91], v[144:147], a[208:211]
  v_mfma_f32_16x16x32_bf16 a[212:215], v[88:91], v[148:151], a[212:215]
  v_mfma_f32_16x16x32_bf16 a[216:219], v[88:91], v[152:155], a[216:219]
  s_add_u32 s28, s28, 1
  v_mfma_f32_16x16x32_bf16 a[220:223], v[88:91], v[156:159], a[220:223]
  v_mfma_f32_16x16x32_bf16 a[224:227], v[92:95], v[128:131], a[224:227]
  v_mfma_f32_16x16x32_bf16 a[228:231], v[92:95], v[132:135], a[228:231]
  v_mfma_f32_16x16x32_bf16 a[232:235], v[92:95], v[136:139], a[232:235]
  v_mfma_f32_16x16x32_bf16 a[236:239], v[92:95], v[140:143], a[236:239]
  v_mfma_f32_16x16x32_bf16 a[240:243], v[92:95], v[144:147], a[240:243]
  v_mfma_f32_16x16x32_bf16 a[244:247], v[92:95], v[148:151], a[244:247]
  s_cmp_lt_u32 s28, 8
  v_mfma_f32_16x16x32_bf16 a[248:251], v[92:95], v[152:155], a[248:251]
  s_waitcnt lgkmcnt(0)
  v_mfma_f32_16x16x32_bf16 a[252:255], v[92:95], v[156:159], a[252:255]
  s_cbranch_scc1 fa_loopK
  s_mov_b32 s60, 2048
  s_mov_b32 s61, 8192
  s_mov_b32 s62, 16777216
  s_branch fa_p1epi
fa_roleV:
  ds_read_b128 v[32:35], v14 offset:0
  ds_read_b128 v[36:39], v14 offset:1024
  ds_read_b128 v[40:43], v14 offset:2048
  ds_read_b128 v[44:47], v14 offset:3072
  ds_read_b128 v[48:51], v14 offset:4096
  ds_read_b128 v[52:55], v14 offset:5120
  ds_read_b128 v[56:59], v14 offset:6144
  ds_read_b128 v[60:63], v14 offset:7168
  ds_read_b64_tr_b16 v[96:97], v12 offset:0
  ds_read_b64_tr_b16 v[98:99], v12 offset:1024
  ds_read_b64_tr_b16 v[100:101], v13 offset:0
  ds_read_b64_tr_b16 v[102:103], v13 offset:1024
  ds_read_b64_tr_b16 v[104:105], v12 offset:256
  ds_read_b64_tr_b16 v[106:107], v12 offset:1280
  ds_read_b64_tr_b16 v[108:109], v13 offset:256
  ds_read_b64_tr_b16 v[110:111], v13 offset:1280
  ds_read_b64_tr_b16 v[112:113], v12 offset:512
  ds_read_b64_tr_b16 v[114:115], v12 offset:1536
  ds_read_b64_tr_b16 v[116:117], v13 offset:512
  ds_read_b64_tr_b16 v[118:119], v13 offset:1536
  ds_read_b64_tr_b16 v[120:121], v12 offset:768
  ds_read_b64_tr_b16 v[122:123], v12 offset:1792
  ds_read_b64_tr_b16 v[124:125], v13 offset:768
  ds_read_b64_tr_b16 v[126:127], v13 offset:1792
  s_waitcnt lgkmcnt(0)
.p2align 6
fa_loopV:
  v_mfma_f32_16x16x32_bf16 a[0:3], v[32:35], v[96:99], a[0:3]
  s_waitcnt vmcnt(17)
  v_mfma_f32_16x16x32_bf16 a[4:7], v[32:35], v[100:103], a[4:7]
  s_barrier
  v_mfma_f32_16x16x32_bf16 a[8:11], v[32:35], v[104:107], a[8:11]
  s_bitcmp1_b32 0x41, s28
  ds_read_b64_tr_b16 v[128:129], v12 offset:32768
  v_mfma_f32_16x16x32_bf16 a[12:15], v[32:35], v[108:111], a[12:15]
  s_cbranch_scc1 fa_p1stubV
fa_p1backV:
  v_mfma_f32_16x16x32_bf16 a[16:19], v[32:35], v[112:115], a[16:19]
  s_mov_b32 m0, s24
  ds_read_b64_tr_b16 v[130:131], v12 offset:33792
  v_mfma_f32_16x16x32_bf16 a[20:23], v[32:35], v[116:119], a[20:23]
  buffer_load_dwordx4 v224, s[32:35], s26 offen offset:0 lds
  v_mfma_f32_16x16x32_bf16 a[24:27], v[32:35], v[120:123], a[24:27]
  ds_read_b128 v[64:67], v14 offset:32768
  v_mfma_f32_16x16x32_bf16 a[28:31], v[32:35], v[124:127], a[28:31]
  buffer_load_dwordx4 v225, s[32:35], s26 offen offset:1024 lds
  v_mfma_f32_16x16x32_bf16 a[32:35], v[36:39], v[96:99], a[32:35]
  ds_read_b64_tr_b16 v[132:133], v13 offset:32768
  v_mfma_f32_16x16x32_bf16 a[36:39], v[36:39], v[100:103], a[36:39]
  buffer_load_dwordx4 v226, s[32:35], s26 offen offset:2048 lds
  v_mfma_f32_16x16x32_bf16 a[40:43], v[36:39], v[104:107], a[40:43]
  ds_read_b64_tr_b16 v[134:135], v13 offset:33792
  v_mfma_f32_16x16x32_bf16 a[44:47], v[36:39], v[108:111], a[44:47]
  buffer_load_dwordx4 v227, s[32:35], s26 offen offset:3072 lds
  v_mfma_f32_16x16x32_bf16 a[48:51], v[36:39], v[112:115], a[48:51]
  s_add_u32 m0, s24, 16384
  ds_read_b128 v[68:71], v14 offset:33792
  v_mfma_f32_16x16x32_bf16 a[52:55], v[36:39], v[116:119], a[52:55]
  buffer_load_dwordx4 v8, s[36:39], s27 offen offset:0 lds
  v_mfma_f32_16x16x32_bf16 a[56:59], v[36:39], v[120:123], a[56:59]
  ds_read_b64_tr_b16 v[136:137], v12 offset:33024
  v_mfma_f32_16x16x32_bf16 a[60:63], v[36:39], v[124:127], a[60:63]
  buffer_load_dwordx4 v9, s[36:39], s27 offen offset:1024 lds
  v_mfma_f32_16x16x32_bf16 a[64:67], v[40:43], v[96:99], a[64:67]
  s_bitcmp1_b32 0x2a, s28
  ds_read_b64_tr_b16 v[138:139], v12 offset:34048
  v_mfma_f32_16x16x32_bf16 a[68:71], v[40:43], v[100:103], a[68:71]
  s_cselect_b32 s50, s75, 0
  buffer_load_dwordx4 v10, s[36:39], s27 offen offset:2048 lds
  v_mfma_f32_16x16x32_bf16 a[72:75], v[40:43], v[104:107], a[72:75]
  s_cselect_b32 s23, 2097152, 0
  ds_read_b128 v[72:75], v14 offset:34816
  v_mfma_f32_16x16x32_bf16 a[76:79], v[40:43], v[108:111], a[76:79]
  buffer_load_dwordx4 v11, s[36:39], s27 offen offset:3072 lds
  v_mfma_f32_16x16x32_bf16 a[80:83], v[40:43], v[112:115], a[80:83]
  ds_read_b64_tr_b16 v[140:141], v13 offset:33024
  v_mfma_f32_16x16x32_bf16 a[84:87], v[40:43], v[116:119], a[84:87]
  buffer_load_dword v231, v235, s[48:51], s74 offen
  v_mfma_f32_16x16x32_bf16 a[88:91], v[40:43], v[120:123], a[88:91]
  s_add_u32 s74, s74, s23
  ds_read_b64_tr_b16 v[142:143], v13 offset:34048
  v_mfma_f32_16x16x32_bf16 a[92:95], v[40:43], v[124:127], a[92:95]
  v_mfma_f32_16x16x32_bf16 a[96:99], v[44:47], v[96:99], a[96:99]
  ds_read_b128 v[76:79], v14 offset:35840
  v_mfma_f32_16x16x32_bf16 a[100:103], v[44:47], v[100:103], a[100:103]
  v_mfma_f32_16x16x32_bf16 a[104:107], v[44:47], v[104:107], a[104:107]
  ds_read_b64_tr_b16 v[144:145], v12 offset:33280
  v_mfma_f32_16x16x32_bf16 a[108:111], v[44:47], v[108:111], a[108:111]
  v_mfma_f32_16x16x32_bf16 a[112:115], v[44:47], v[112:115], a[112:115]
  ds_read_b64_tr_b16 v[146:147], v12 offset:34304
  v_mfma_f32_16x16x32_bf16 a[116:119], v[44:47], v[116:119], a[116:119]
  v_mfma_f32_16x16x32_bf16 a[120:123], v[44:47], v[120:123], a[120:123]
  ds_read_b128 v[80:83], v14 offset:36864
  v_mfma_f32_16x16x32_bf16 a[124:127], v[44:47], v[124:127], a[124:127]
  v_mfma_f32_16x16x32_bf16 a[128:131], v[48:51], v[96:99], a[128:131]
  ds_read_b64_tr_b16 v[148:149], v13 offset:33280
  v_mfma_f32_16x16x32_bf16 a[132:135], v[48:51], v[100:103], a[132:135]
  v_mfma_f32_16x16x32_bf16 a[136:139], v[48:51], v[104:107], a[136:139]
  ds_read_b64_tr_b16 v[150:151], v13 offset:34304
  v_mfma_f32_16x16x32_bf16 a[140:143], v[48:51], v[108:111], a[140:143]
  v_mfma_f32_16x16x32_bf16 a[144:147], v[48:51], v[112:115], a[144:147]
  ds_read_b128 v[84:87], v14 offset:37888
  v_mfma_f32_16x16x32_bf16 a[148:151], v[48:51], v[116:119], a[148:151]
  v_mfma_f32_16x16x32_bf16 a[152:155], v[48:51], v[120:123], a[152:155]
  ds_read_b64_tr_b16 v[152:153], v12 offset:33536
  v_mfma_f32_16x16x32_bf16 a[156:159], v[48:51], v[124:127], a[156:159]
  v_mfma_f32_16x16x32_bf16 a[160:163], v[52:55], v[96:99], a[160:163]
  ds_read_b64_tr_b16 v[154:155], v12 offset:34560
  v_mfma_f32_16x16x32_bf16 a[164:167], v[52:55], v[100:103], a[164:167]
  v_mfma_f32_16x16x32_bf16 a[168:171], v[52:55], v[104:107], a[168:171]
  ds_read_b128 v[88:91], v14 offset:38912
  v_mfma_f32_16x16x32_bf16 a[172:175], v[52:55], v[108:111], a[172:175]
  v_mfma_f32_16x16x32_bf16 a[176:179], v[52:55], v[112:115], a[176:179]
  ds_read_b64_tr_b16 v[156:157], v13 offset:33536
  v_mfma_f32_16x16x32_bf16 a[180:183], v[52:55], v[116:119], a[180:183]
  v_mfma_f32_16x16x32_bf16 a[184:187], v[52:55], v[120:123], a[184:187]
  ds_read_b64_tr_b16 v[158:159], v13 offset:34560
  v_mfma_f32_16x16x32_bf16 a[188:191], v[52:55], v[124:127], a[188:191]
  v_mfma_f32_16x16x32_bf16 a[192:195], v[56:59], v[96:99], a[192:195]
  s_add_u32 s26, s26, 64
  ds_read_b128 v[92:95], v14 offset:39936
  v_mfma_f32_16x16x32_bf16 a[196:199], v[56:59], v[100:103], a[196:199]
  s_add_u32 s27, s27, s25
  v_mfma_f32_16x16x32_bf16 a[200:203], v[56:59], v[104:107], a[200:203]
  s_add_u32 s24, s24, 32768
  v_mfma_f32_16x16x32_bf16 a[204:207], v[56:59], v[108:111], a[204:207]
  s_and_b32 s24, s24, 0x1ffff
  v_mfma_f32_16x16x32_bf16 a[208:211], v[56:59], v[112:115], a[208:211]
  v_xor_b32 v14, 0x10000, v14
  v_mfma_f32_16x16x32_bf16 a[212:215], v[56:59], v[116:119], a[212:215]
  v_xor_b32 v12, 0x10000, v12
  v_mfma_f32_16x16x32_bf16 a[216:219], v[56:59], v[120:123], a[216:219]
  v_xor_b32 v13, 0x10000, v13
  v_mfma_f32_16x16x32_bf16 a[220:223], v[56:59], v[124:127], a[220:223]
  v_mfma_f32_16x16x32_bf16 a[224:227], v[60:63], v[96:99], a[224:227]
  v_mfma_f32_16x16x32_bf16 a[228:231], v[60:63], v[100:103], a[228:231]
  v_mfma_f32_16x16x32_bf16 a[232:235], v[60:63], v[104:107], a[232:235]
  v_mfma_f32_16x16x32_bf16 a[236:239], v[60:63], v[108:111], a[236:239]
  v_mfma_f32_16x16x32_bf16 a[240:243], v[60:63], v[112:115], a[240:243]
  v_mfma_f32_16x16x32_bf16 a[244:247], v[60:63], v[116:119], a[244:247]
  v_mfma_f32_16x16x32_bf16 a[248:251], v[60:63], v[120:123], a[248:251]
  v_mfma_f32_16x16x32_bf16 a[252:255], v[60:63], v[124:127], a[252:255]
  s_waitcnt lgkmcnt(0)
  v_mfma_f32_16x16x32_bf16 a[0:3], v[64:67], v[128:131], a[0:3]
  s_waitcnt vmcnt(18)
  v_mfma_f32_16x16x32_bf16 a[4:7], v[64:67], v[132:135], a[4:7]
  s_barrier
  v_mfma_f32_16x16x32_bf16 a[8:11], v[64:67], v[136:139], a[8:11]
  ds_read_b64_tr_b16 v[96:97], v12 offset:0
  v_mfma_f32_16x16x32_bf16 a[12:15], v[64:67], v[140:143], a[12:15]
  v_mfma_f32_16x16x32_bf16 a[16:19], v[64:67], v[144:147], a[16:19]
  s_mov_b32 m0, s24
  ds_read_b64_tr_b16 v[98:99], v12 offset:1024
  v_mfma_f32_16x16x32_bf16 a[20:23], v[64:67], v[148:151], a[20:23]
  buffer_load_dwordx4 v224, s[32:35], s26 offen offset:0 lds
  v_mfma_f32_16x16x32_bf16 a[24:27], v[64:67], v[152:155], a[24:27]
  ds_read_b128 v[32:35], v14 offset:0
  v_mfma_f32_16x16x32_bf16 a[28:31], v[64:67], v[156:159], a[28:31]
  v_mfma_f32_16x16x32_bf16 a[32:35], v[68:71], v[128:131], a[32:35]
  ds_read_b64_tr_b16 v[100:101], v13 offset:0
  v_mfma_f32_16x16x32_bf16 a[36:39], v[68:71], v[132:135], a[36:39]
  v_mfma_f32_16x16x32_bf16 a[40:43], v[68:71], v[136:139], a[40:43]
  ds_read_b64_tr_b16 v[102:103], v13 offset:1024
  v_mfma_f32_16x16x32_bf16 a[44:47], v[68:71], v[140:143], a[44:47]
  buffer_load_dwordx4 v225, s[32:35], s26 offen offset:1024 lds
  v_mfma_f32_16x16x32_bf16 a[48:51], v[68:71], v[144:147], a[48:51]
  ds_read_b128 v[36:39], v14 offset:1024
  v_mfma_f32_16x16x32_bf16 a[52:55], v[68:71], v[148:151], a[52:55]
  v_mfma_f32_16x16x32_bf16 a[56:59], v[68:71], v[152:155], a[56:59]
  ds_read_b64_tr_b16 v[104:105], v12 offset:256
  v_mfma_f32_16x16x32_bf16 a[60:63], v[68:71], v[156:159], a[60:63]
  v_mfma_f32_16x16x32_bf16 a[64:67], v[72:75], v[128:131], a[64:67]
  ds_read_b64_tr_b16 v[106:107], v12 offset:1280
  v_mfma_f32_16x16x32_bf16 a[68:71], v[72:75], v[132:135], a[68:71]
  buffer_load_dwordx4 v226, s[32:35], s26 offen offset:2048 lds
  v_mfma_f32_16x16x32_bf16 a[72:75], v[72:75], v[136:139], a[72:75]
  ds_read_b128 v[40:43], v14 offset:2048
  v_mfma_f32_16x16x32_bf16 a[76:79], v[72:75], v[140:143], a[76:79]
  v_mfma_f32_16x16x32_bf16 a[80:83], v[72:75], v[144:147], a[80:83]
  ds_read_b64_tr_b16 v[108:109], v13 offset:256
  v_mfma_f32_16x16x32_bf16 a[84:87], v[72:75], v[148:151], a[84:87]
  v_mfma_f32_16x16x32_bf16 a[88:91], v[72:75], v[152:155], a[88:91]
  ds_read_b64_tr_b16 v[110:111], v13 offset:1280
  v_mfma_f32_16x16x32_bf16 a[92:95], v[72:75], v[156:159], a[92:95]
  buffer_load_dwordx4 v227, s[32:35], s26 offen offset:3072 lds
  v_mfma_f32_16x16x32_bf16 a[96:99], v[76:79], v[128:131], a[96:99]
  ds_read_b128 v[44:47], v14 offset:3072
  v_mfma_f32_16x16x32_bf16 a[100:103], v[76:79], v[132:135], a[100:103]
  v_mfma_f32_16x16x32_bf16 a[104:107], v[76:79], v[136:139], a[104:107]
  ds_read_b64_tr_b16 v[112:113], v12 offset:512
  v_mfma_f32_16x16x32_bf16 a[108:111], v[76:79], v[140:143], a[108:111]
  v_mfma_f32_16x16x32_bf16 a[112:115], v[76:79], v[144:147], a[112:115]
  s_add_u32 m0, s24, 16384
  ds_read_b64_tr_b16 v[114:115], v12 offset:1536
  v_mfma_f32_16x16x32_bf16 a[116:119], v[76:79], v[148:151], a[116:119]
  buffer_load_dwordx4 v8, s[36:39], s27 offen offset:0 lds
  v_mfma_f32_16x16x32_bf16 a[120:123], v[76:79], v[152:155], a[120:123]
  ds_read_b128 v[48:51], v14 offset:4096
  v_mfma_f32_16x16x32_bf16 a[124:127], v[76:79], v[156:159], a[124:127]
  v_mfma_f32_16x16x32_bf16 a[128:131], v[80:83], v[128:131], a[128:131]
  ds_read_b64_tr_b16 v[116:117], v13 offset:512
  v_mfma_f32_16x16x32_bf16 a[132:135], v[80:83], v[132:135], a[132:135]
  v_mfma_f32_16x16x32_bf16 a[136:139], v[80:83], v[136:139], a[136:139]
  ds_read_b64_tr_b16 v[118:119], v13 offset:1536
  v_mfma_f32_16x16x32_bf16 a[140:143], v[80:83], v[140:143], a[140:143]
  buffer_load_dwordx4 v9, s[36:39], s27 offen offset:1024 lds
  v_mfma_f32_16x16x32_bf16 a[144:147], v[80:83], v[144:147], a[144:147]
  ds_read_b128 v[52:55], v14 offset:5120
  v_mfma_f32_16x16x32_bf16 a[148:151], v[80:83], v[148:151], a[148:151]
  v_mfma_f32_16x16x32_bf16 a[152:155], v[80:83], v[152:155], a[152:155]
  ds_read_b64_tr_b16 v[120:121], v12 offset:768
  v_mfma_f32_16x16x32_bf16 a[156:159], v[80:83], v[156:159], a[156:159]
  v_mfma_f32_16x16x32_bf16 a[160:163], v[84:87], v[128:131], a[160:163]
  ds_read_b64_tr_b16 v[122:123], v12 offset:1792
  v_mfma_f32_16x16x32_bf16 a[164:167], v[84:87], v[132:135], a[164:167]
  buffer_load_dwordx4 v10, s[36:39], s27 offen offset:2048 lds
  v_mfma_f32_16x16x32_bf16 a[168:171], v[84:87], v[136:139], a[168:171]
  ds_read_b128 v[56:59], v14 offset:6144
  v_mfma_f32_16x16x32_bf16 a[172:175], v[84:87], v[140:143], a[172:175]
  v_mfma_f32_16x16x32_bf16 a[176:179], v[84:87], v[144:147], a[176:179]
  ds_read_b64_tr_b16 v[124:125], v13 offset:768
  v_mfma_f32_16x16x32_bf16 a[180:183], v[84:87], v[148:151], a[180:183]
  v_mfma_f32_16x16x32_bf16 a[184:187], v[84:87], v[152:155], a[184:187]
  ds_read_b64_tr_b16 v[126:127], v13 offset:1792
  v_mfma_f32_16x16x32_bf16 a[188:191], v[84:87], v[156:159], a[188:191]
  buffer_load_dwordx4 v11, s[36:39], s27 offen offset:3072 lds
  v_mfma_f32_16x16x32_bf16 a[192:195], v[88:91], v[128:131], a[192:195]
  s_add_u32 s26, s26, 64
  ds_read_b128 v[60:63], v14 offset:7168
  v_mfma_f32_16x16x32_bf16 a[196:199], v[88:91], v[132:135], a[196:199]
  s_add_u32 s27, s27, s25
  v_mfma_f32_16x16x32_bf16 a[200:203], v[88:91], v[136:139], a[200:203]
  s_add_u32 s24, s24, 32768
  v_mfma_f32_16x16x32_bf16 a[204:207], v[88:91], v[140:143], a[204:207]
  s_and_b32 s24, s24, 0x1ffff
  v_mfma_f32_16x16x32_bf16 a[208:211], v[88:91], v[144:147], a[208:211]
  v_mfma_f32_16x16x32_bf16 a[212:215], v[88:91], v[148:151], a[212:215]
  v_mfma_f32_16x16x32_bf16 a[216:219], v[88:91], v[152:155], a[216:219]
  s_add_u32 s28, s28, 1
  v_mfma_f32_16x16x32_bf16 a[220:223], v[88:91], v[156:159], a[220:223]
  v_mfma_f32_16x16x32_bf16 a[224:227], v[92:95], v[128:131], a[224:227]
  v_mfma_f32_16x16x32_bf16 a[228:231], v[92:95], v[132:135], a[228:231]
  v_mfma_f32_16x16x32_bf16 a[232:235], v[92:95], v[136:139], a[232:235]
  v_mfma_f32_16x16x32_bf16 a[236:239], v[92:95], v[140:143], a[236:239]
  v_mfma_f32_16x16x32_bf16 a[240:243], v[92:95], v[144:147], a[240:243]
  v_mfma_f32_16x16x32_bf16 a[244:247], v[92:95], v[148:151], a[244:247]
  s_cmp_lt_u32 s28, 8
  v_mfma_f32_16x16x32_bf16 a[248:251], v[92:95], v[152:155], a[248:251]
  s_waitcnt lgkmcnt(0)
  v_mfma_f32_16x16x32_bf16 a[252:255], v[92:95], v[156:159], a[252:255]
  s_cbranch_scc1 fa_loopV
  s_mov_b32 s60, 8192
  s_mov_b32 s61, 2048
  s_mov_b32 s62, 33554432
fa_p1epi:
  s_lshl_b32 s23, s21, 19
  s_add_u32 s62, s62, s23
  s_lshl_b32 s23, s22, 16
  s_add_u32 s62, s62, s23
  s_and_b32 s23, s20, 1
  s_lshl_b32 s23, s23, 15
  s_add_u32 s62, s62, s23
  s_lshl_b32 s23, s22, 2
  s_add_u32 s23, s23, s20
  s_mul_i32 s64, s23, 40960
  s_add_u32 s65, s64, 20480
  s_sub_u32 s23, 15, s22
  s_lshl_b32 s23, s23, 2
  s_add_u32 s23, s23, s20
  s_mul_i32 s66, s23, 40960
  s_add_u32 s67, s66, 20480
  v_cmp_gt_u32 vcc, 0x100, v228
  s_cbranch_vccnz fa_ln_spin
fa_ln_ok:
  v_accvgpr_read_b32 v100, a192
  v_accvgpr_read_b32 v101, a193
  v_accvgpr_read_b32 v102, a194
  v_accvgpr_read_b32 v103, a195
  v_accvgpr_read_b32 v104, a224
  v_accvgpr_read_b32 v105, a225
  v_accvgpr_read_b32 v106, a226
  v_accvgpr_read_b32 v107, a227
  v_accvgpr_read_b32 v112, a196
  v_accvgpr_read_b32 v113, a197
  v_accvgpr_read_b32 v114, a198
  v_accvgpr_read_b32 v115, a199
  v_accvgpr_read_b32 v116, a228
  v_accvgpr_read_b32 v117, a229
  v_accvgpr_read_b32 v118, a230
  v_accvgpr_read_b32 v119, a231
  v_accvgpr_read_b32 v124, a200
  v_accvgpr_read_b32 v125, a201
  v_accvgpr_read_b32 v126, a202
  v_accvgpr_read_b32 v127, a203
  v_accvgpr_read_b32 v128, a232
  v_accvgpr_read_b32 v129, a233
  v_accvgpr_read_b32 v130, a234
  v_accvgpr_read_b32 v131, a235
  v_accvgpr_read_b32 v136, a204
  v_accvgpr_read_b32 v137, a205
  v_accvgpr_read_b32 v138, a206
  v_accvgpr_read_b32 v139, a207
  v_accvgpr_read_b32 v140, a236
  v_accvgpr_read_b32 v141, a237
  v_accvgpr_read_b32 v142, a238
  v_accvgpr_read_b32 v143, a239
  v_accvgpr_read_b32 v148, a208
  v_accvgpr_read_b32 v149, a209
  v_accvgpr_read_b32 v150, a210
  v_accvgpr_read_b32 v151, a211
  v_accvgpr_read_b32 v152, a240
  v_accvgpr_read_b32 v153, a241
  v_accvgpr_read_b32 v154, a242
  v_accvgpr_read_b32 v155, a243
  v_accvgpr_read_b32 v160, a212
  v_accvgpr_read_b32 v161, a213
  v_accvgpr_read_b32 v162, a214
  v_accvgpr_read_b32 v163, a215
  v_accvgpr_read_b32 v164, a244
  v_accvgpr_read_b32 v165, a245
  v_accvgpr_read_b32 v166, a246
  v_accvgpr_read_b32 v167, a247
  v_accvgpr_read_b32 v172, a216
  v_accvgpr_read_b32 v173, a217
  v_accvgpr_read_b32 v174, a218
  v_accvgpr_read_b32 v175, a219
  v_accvgpr_read_b32 v176, a248
  v_accvgpr_read_b32 v177, a249
  v_accvgpr_read_b32 v178, a250
  v_accvgpr_read_b32 v179, a251
  v_accvgpr_read_b32 v184, a220
  v_accvgpr_read_b32 v185, a221
  v_accvgpr_read_b32 v186, a222
  v_accvgpr_read_b32 v187, a223
  v_accvgpr_read_b32 v188, a252
  v_accvgpr_read_b32 v189, a253
  v_accvgpr_read_b32 v190, a254
  v_accvgpr_read_b32 v191, a255
  buffer_load_dwordx4 a[192:195], v2, s[40:43], s64 offen offset:0 sc1
  buffer_load_dwordx4 a[196:199], v2, s[40:43], s65 offen offset:0 sc1
  buffer_load_dwordx4 a[200:203], v2, s[40:43], s66 offen offset:0 sc1
  buffer_load_dwordx4 a[204:207], v2, s[40:43], s67 offen offset:0 sc1
  buffer_load_dwordx4 a[208:211], v2, s[40:43], s64 offen offset:1024 sc1
  buffer_load_dwordx4 a[212:215], v2, s[40:43], s65 offen offset:1024 sc1
  buffer_load_dwordx4 a[216:219], v2, s[40:43], s66 offen offset:1024 sc1
  buffer_load_dwordx4 a[220:223], v2, s[40:43], s67 offen offset:1024 sc1
  buffer_load_dwordx4 a[224:227], v2, s[40:43], s64 offen offset:2048 sc1
  buffer_load_dwordx4 a[228:231], v2, s[40:43], s65 offen offset:2048 sc1
  buffer_load_dwordx4 a[232:235], v2, s[40:43], s66 offen offset:2048 sc1
  buffer_load_dwordx4 a[236:239], v2, s[40:43], s67 offen offset:2048 sc1
  buffer_load_dwordx4 a[240:243], v2, s[40:43], s64 offen offset:3072 sc1
  buffer_load_dwordx4 a[244:247], v2, s[40:43], s65 offen offset:3072 sc1
  buffer_load_dwordx4 a[248:251], v2, s[40:43], s66 offen offset:3072 sc1
  buffer_load_dwordx4 a[252:255], v2, s[40:43], s67 offen offset:3072 sc1
  s_add_u32 s64, s64, 4096
  s_add_u32 s65, s65, 4096
  s_add_u32 s66, s66, 4096
  s_add_u32 s67, s67, 4096
  s_mul_i32 s63, s60, 3
  s_add_u32 s63, s63, s62
  v_cvt_pk_bf16_f32 v96, v100, v101
  v_cvt_pk_bf16_f32 v97, v102, v103
  v_cvt_pk_bf16_f32 v98, v104, v105
  v_cvt_pk_bf16_f32 v99, v106, v107
  buffer_store_dwordx4 v[96:99], v2, s[40:43], s63 offen offset:0 sc1
  v_cvt_pk_bf16_f32 v108, v112, v113
  v_cvt_pk_bf16_f32 v109, v114, v115
  v_cvt_pk_bf16_f32 v110, v116, v117
  v_cvt_pk_bf16_f32 v111, v118, v119
  buffer_store_dwordx4 v[108:111], v2, s[40:43], s63 offen offset:1024 sc1
  s_add_u32 s63, s63, s61
  v_cvt_pk_bf16_f32 v120, v124, v125
  v_cvt_pk_bf16_f32 v121, v126, v127
  v_cvt_pk_bf16_f32 v122, v128, v129
  v_cvt_pk_bf16_f32 v123, v130, v131
  buffer_store_dwordx4 v[120:123], v2, s[40:43], s63 offen offset:0 sc1
  v_cvt_pk_bf16_f32 v132, v136, v137
  v_cvt_pk_bf16_f32 v133, v138, v139
  v_cvt_pk_bf16_f32 v134, v140, v141
  v_cvt_pk_bf16_f32 v135, v142, v143
  buffer_store_dwordx4 v[132:135], v2, s[40:43], s63 offen offset:1024 sc1
  s_add_u32 s63, s63, s61
  v_cvt_pk_bf16_f32 v144, v148, v149
  v_cvt_pk_bf16_f32 v145, v150, v151
  v_cvt_pk_bf16_f32 v146, v152, v153
  v_cvt_pk_bf16_f32 v147, v154, v155
  buffer_store_dwordx4 v[144:147], v2, s[40:43], s63 offen offset:0 sc1
  v_cvt_pk_bf16_f32 v156, v160, v161
  v_cvt_pk_bf16_f32 v157, v162, v163
  v_cvt_pk_bf16_f32 v158, v164, v165
  v_cvt_pk_bf16_f32 v159, v166, v167
  buffer_store_dwordx4 v[156:159], v2, s[40:43], s63 offen offset:1024 sc1
  s_add_u32 s63, s63, s61
  v_cvt_pk_bf16_f32 v168, v172, v173
  v_cvt_pk_bf16_f32 v169, v174, v175
  v_cvt_pk_bf16_f32 v170, v176, v177
  v_cvt_pk_bf16_f32 v171, v178, v179
  buffer_store_dwordx4 v[168:171], v2, s[40:43], s63 offen offset:0 sc1
  v_cvt_pk_bf16_f32 v180, v184, v185
  v_cvt_pk_bf16_f32 v181, v186, v187
  v_cvt_pk_bf16_f32 v182, v188, v189
  v_cvt_pk_bf16_f32 v183, v190, v191
  buffer_store_dwordx4 v[180:183], v2, s[40:43], s63 offen offset:1024 sc1
  s_cmp_eq_u32 s2, 255
  s_cbranch_scc1 fa_top8
fa_notop:
  s_lshr_b32 s23, s20, 1
  s_lshl_b32 s23, s23, 13
  v_subrev_u32 v12, s23, v12
  v_subrev_u32 v13, s23, v13
  s_waitcnt vmcnt(20)
  s_barrier
  ds_read_b64_tr_b16 v[32:33], v12 offset:0
  ds_read_b64_tr_b16 v[34:35], v12 offset:1024
  ds_read_b64_tr_b16 v[36:37], v13 offset:0
  ds_read_b64_tr_b16 v[38:39], v13 offset:1024
  ds_read_b64_tr_b16 v[40:41], v12 offset:256
  ds_read_b64_tr_b16 v[42:43], v12 offset:1280
  ds_read_b64_tr_b16 v[44:45], v13 offset:256
  ds_read_b64_tr_b16 v[46:47], v13 offset:1280
  ds_read_b64_tr_b16 v[48:49], v12 offset:512
  ds_read_b64_tr_b16 v[50:51], v12 offset:1536
  ds_read_b64_tr_b16 v[52:53], v13 offset:512
  ds_read_b64_tr_b16 v[54:55], v13 offset:1536
  ds_read_b64_tr_b16 v[56:57], v12 offset:768
  ds_read_b64_tr_b16 v[58:59], v12 offset:1792
  ds_read_b64_tr_b16 v[60:61], v13 offset:768
  ds_read_b64_tr_b16 v[62:63], v13 offset:1792
  s_lshl_b32 s23, s21, 19
  s_add_u32 s23, s23, 16777216
  s_add_u32 s6, s18, s23
  s_addc_u32 s7, s19, 0
  s_add_u32 s8, s6, 16777216
  s_addc_u32 s9, s7, 0
  s_sub_u32 s23, 16, s22
  s_lshl_b32 s23, s23, 15
  s_mov_b32 s44, s6
  s_mov_b32 s45, s7
  s_mov_b32 s46, s23
  s_mov_b32 s47, 0x20000
  s_mov_b32 s48, s8
  s_mov_b32 s49, s9
  s_mov_b32 s50, s23
  s_mov_b32 s51, 0x20000
  s_waitcnt lgkmcnt(0)
  s_lshl_b32 s30, s21, 7
  s_add_u32 s30, s30, 2637824
  s_mov_b32 s31, 2650368
  s_mov_b32 s81, 0x47800000
  s_cmp_eq_u32 s20, 0
  s_cselect_b32 s29, s82, 1073741824
  v_mfma_f32_16x16x32_bf16 v[96:99], v[32:35], a[192:195], 0
  v_accvgpr_read_b32 v236, a0
  v_mfma_f32_16x16x32_bf16 v[112:115], v[36:39], a[192:195], 0
  ds_read_b64_tr_b16 v[64:65], v12 offset:8192
  v_accvgpr_read_b32 v237, a1
  v_mfma_f32_16x16x32_bf16 v[128:131], v[40:43], a[192:195], 0
  ds_read_b64_tr_b16 v[66:67], v12 offset:9216
  v_accvgpr_read_b32 v238, a2
  v_mfma_f32_16x16x32_bf16 v[144:147], v[44:47], a[192:195], 0
  ds_read_b64_tr_b16 v[68:69], v13 offset:8192
  v_accvgpr_read_b32 v239, a3
  v_mfma_f32_16x16x32_bf16 v[160:163], v[48:51], a[192:195], 0
  ds_read_b64_tr_b16 v[70:71], v13 offset:9216
  v_accvgpr_read_b32 v240, a32
  v_mfma_f32_16x16x32_bf16 v[176:179], v[52:55], a[192:195], 0
  ds_read_b64_tr_b16 v[72:73], v12 offset:8448
  v_accvgpr_read_b32 v241, a33
  v_mfma_f32_16x16x32_bf16 v[192:195], v[56:59], a[192:195], 0
  ds_read_b64_tr_b16 v[74:75], v12 offset:9472
  v_accvgpr_read_b32 v242, a34
  v_mfma_f32_16x16x32_bf16 v[208:211], v[60:63], a[192:195], 0
  buffer_load_dwordx4 a[192:195], v2, s[40:43], s64 offen offset:0 sc1
  v_accvgpr_read_b32 v243, a35
  v_mfma_f32_16x16x32_bf16 v[100:103], v[32:35], a[196:199], 0
  ds_read_b64_tr_b16 v[76:77], v13 offset:8448
  v_cvt_pk_bf16_f32 v232, v236, v237
  v_mfma_f32_16x16x32_bf16 v[116:119], v[36:39], a[196:199], 0
  ds_read_b64_tr_b16 v[78:79], v13 offset:9472
  v_cvt_pk_bf16_f32 v233, v238, v239
  v_mfma_f32_16x16x32_bf16 v[132:135], v[40:43], a[196:199], 0
  ds_read_b64_tr_b16 v[80:81], v12 offset:8704
  v_cvt_pk_bf16_f32 v234, v240, v241
  v_mfma_f32_16x16x32_bf16 v[148:151], v[44:47], a[196:199], 0
  v_cvt_pk_bf16_f32 v235, v242, v243
  v_mfma_f32_16x16x32_bf16 v[164:167], v[48:51], a[196:199], 0
  ds_read_b64_tr_b16 v[82:83], v12 offset:9728
  v_mfma_f32_16x16x32_bf16 v[180:183], v[52:55], a[196:199], 0
  s_mul_i32 s63, s60, 0
  ds_read_b64_tr_b16 v[84:85], v13 offset:8704
  v_mfma_f32_16x16x32_bf16 v[196:199], v[56:59], a[196:199], 0
  s_add_u32 s63, s63, s62
  ds_read_b64_tr_b16 v[86:87], v13 offset:9728
  v_mfma_f32_16x16x32_bf16 v[212:215], v[60:63], a[196:199], 0
  buffer_load_dwordx4 a[196:199], v2, s[40:43], s65 offen offset:0 sc1
  v_mfma_f32_16x16x32_bf16 v[104:107], v[32:35], a[200:203], 0
  ds_read_b64_tr_b16 v[88:89], v12 offset:8960
  v_accvgpr_read_b32 v248, a4
  v_mfma_f32_16x16x32_bf16 v[120:123], v[36:39], a[200:203], 0
  ds_read_b64_tr_b16 v[90:91], v12 offset:9984
  v_accvgpr_read_b32 v249, a5
  v_mfma_f32_16x16x32_bf16 v[136:139], v[40:43], a[200:203], 0
  ds_read_b64_tr_b16 v[92:93], v13 offset:8960
  v_accvgpr_read_b32 v250, a6
  v_mfma_f32_16x16x32_bf16 v[152:155], v[44:47], a[200:203], 0
  v_accvgpr_read_b32 v251, a7
  v_mfma_f32_16x16x32_bf16 v[168:171], v[48:51], a[200:203], 0
  ds_read_b64_tr_b16 v[94:95], v13 offset:9984
  v_accvgpr_read_b32 v252, a36
  v_mfma_f32_16x16x32_bf16 v[184:187], v[52:55], a[200:203], 0
  buffer_store_dwordx4 v[232:235], v2, s[40:43], s63 offen offset:0 sc1
  v_accvgpr_read_b32 v253, a37
  v_mfma_f32_16x16x32_bf16 v[200:203], v[56:59], a[200:203], 0
  v_accvgpr_read_b32 v254, a38
  v_mfma_f32_16x16x32_bf16 v[216:219], v[60:63], a[200:203], 0
  buffer_load_dwordx4 a[200:203], v2, s[40:43], s66 offen offset:0 sc1
  v_accvgpr_read_b32 v255, a39
  v_mfma_f32_16x16x32_bf16 v[108:111], v[32:35], a[204:207], 0
  v_cvt_pk_bf16_f32 v244, v248, v249
  v_mfma_f32_16x16x32_bf16 v[124:127], v[36:39], a[204:207], 0
  v_cvt_pk_bf16_f32 v245, v250, v251
  v_mfma_f32_16x16x32_bf16 v[140:143], v[40:43], a[204:207], 0
  v_cvt_pk_bf16_f32 v246, v252, v253
  v_mfma_f32_16x16x32_bf16 v[156:159], v[44:47], a[204:207], 0
  v_cvt_pk_bf16_f32 v247, v254, v255
  v_mfma_f32_16x16x32_bf16 v[172:175], v[48:51], a[204:207], 0
  v_mfma_f32_16x16x32_bf16 v[188:191], v[52:55], a[204:207], 0
  buffer_store_dwordx4 v[244:247], v2, s[40:43], s63 offen offset:1024 sc1
  v_mfma_f32_16x16x32_bf16 v[204:207], v[56:59], a[204:207], 0
  v_mfma_f32_16x16x32_bf16 v[220:223], v[60:63], a[204:207], 0
  s_waitcnt vmcnt(21) lgkmcnt(0)
  buffer_load_dwordx4 a[204:207], v2, s[40:43], s67 offen offset:0 sc1
  v_mfma_f32_16x16x32_bf16 v[96:99], v[64:67], a[208:211], v[96:99]
  s_barrier
  v_accvgpr_read_b32 v236, a8
  v_mfma_f32_16x16x32_bf16 v[112:115], v[68:71], a[208:211], v[112:115]
  ds_read_b64_tr_b16 v[32:33], v12 offset:32768
  v_accvgpr_read_b32 v237, a9
  v_mfma_f32_16x16x32_bf16 v[128:131], v[72:75], a[208:211], v[128:131]
  ds_read_b64_tr_b16 v[34:35], v12 offset:33792
  v_accvgpr_read_b32 v238, a10
  v_mfma_f32_16x16x32_bf16 v[144:147], v[76:79], a[208:211], v[144:147]
  ds_read_b64_tr_b16 v[36:37], v13 offset:32768
  v_accvgpr_read_b32 v239, a11
  v_mfma_f32_16x16x32_bf16 v[160:163], v[80:83], a[208:211], v[160:163]
  ds_read_b64_tr_b16 v[38:39], v13 offset:33792
  v_accvgpr_read_b32 v240, a40
  v_mfma_f32_16x16x32_bf16 v[176:179], v[84:87], a[208:211], v[176:179]
  ds_read_b64_tr_b16 v[40:41], v12 offset:33024
  v_accvgpr_read_b32 v241, a41
  v_mfma_f32_16x16x32_bf16 v[192:195], v[88:91], a[208:211], v[192:195]
  ds_read_b64_tr_b16 v[42:43], v12 offset:34048
  v_accvgpr_read_b32 v242, a42
  v_mfma_f32_16x16x32_bf16 v[208:211], v[92:95], a[208:211], v[208:211]
  buffer_load_dwordx4 a[208:211], v2, s[40:43], s64 offen offset:1024 sc1
  v_accvgpr_read_b32 v243, a43
  v_mfma_f32_16x16x32_bf16 v[100:103], v[64:67], a[212:215], v[100:103]
  ds_read_b64_tr_b16 v[44:45], v13 offset:33024
  v_cvt_pk_bf16_f32 v232, v236, v237
  v_mfma_f32_16x16x32_bf16 v[116:119], v[68:71], a[212:215], v[116:119]
  ds_read_b64_tr_b16 v[46:47], v13 offset:34048
  v_cvt_pk_bf16_f32 v233, v238, v239
  v_mfma_f32_16x16x32_bf16 v[132:135], v[72:75], a[212:215], v[132:135]
  s_add_u32 m0, s24, 16384
  ds_read_b64_tr_b16 v[48:49], v12 offset:33280
  v_cvt_pk_bf16_f32 v234, v240, v241
  v_mfma_f32_16x16x32_bf16 v[148:151], v[76:79], a[212:215], v[148:151]
  buffer_load_dwordx4 v8, s[36:39], s27 offen offset:0 lds
  v_cvt_pk_bf16_f32 v235, v242, v243
  v_mfma_f32_16x16x32_bf16 v[164:167], v[80:83], a[212:215], v[164:167]
  ds_read_b64_tr_b16 v[50:51], v12 offset:34304
  v_mfma_f32_16x16x32_bf16 v[180:183], v[84:87], a[212:215], v[180:183]
  s_add_u32 s63, s63, s61
  ds_read_b64_tr_b16 v[52:53], v13 offset:33280
  v_mfma_f32_16x16x32_bf16 v[196:199], v[88:91], a[212:215], v[196:199]
  ds_read_b64_tr_b16 v[54:55], v13 offset:34304
  v_mfma_f32_16x16x32_bf16 v[212:215], v[92:95], a[212:215], v[212:215]
  buffer_load_dwordx4 a[212:215], v2, s[40:43], s65 offen offset:1024 sc1
  v_mfma_f32_16x16x32_bf16 v[104:107], v[64:67], a[216:219], v[104:107]
  ds_read_b64_tr_b16 v[56:57], v12 offset:33536
  v_accvgpr_read_b32 v248, a12
  v_mfma_f32_16x16x32_bf16 v[120:123], v[68:71], a[216:219], v[120:123]
  ds_read_b64_tr_b16 v[58:59], v12 offset:34560
  v_accvgpr_read_b32 v249, a13
  v_mfma_f32_16x16x32_bf16 v[136:139], v[72:75], a[216:219], v[136:139]
  ds_read_b64_tr_b16 v[60:61], v13 offset:33536
  v_accvgpr_read_b32 v250, a14
  v_mfma_f32_16x16x32_bf16 v[152:155], v[76:79], a[216:219], v[152:155]
  buffer_load_dwordx4 v9, s[36:39], s27 offen offset:1024 lds
  v_accvgpr_read_b32 v251, a15
  v_mfma_f32_16x16x32_bf16 v[168:171], v[80:83], a[216:219], v[168:171]
  ds_read_b64_tr_b16 v[62:63], v13 offset:34560
  v_accvgpr_read_b32 v252, a44
  v_mfma_f32_16x16x32_bf16 v[184:187], v[84:87], a[216:219], v[184:187]
  buffer_store_dwordx4 v[232:235], v2, s[40:43], s63 offen offset:0 sc1
  v_accvgpr_read_b32 v253, a45
  v_mfma_f32_16x16x32_bf16 v[200:203], v[88:91], a[216:219], v[200:203]
  buffer_load_dwordx4 v10, s[36:39], s27 offen offset:2048 lds
  v_accvgpr_read_b32 v254, a46
  v_mfma_f32_16x16x32_bf16 v[216:219], v[92:95], a[216:219], v[216:219]
  buffer_load_dwordx4 a[216:219], v2, s[40:43], s66 offen offset:1024 sc1
  v_accvgpr_read_b32 v255, a47
  v_mfma_f32_16x16x32_bf16 v[108:111], v[64:67], a[220:223], v[108:111]
  v_cvt_pk_bf16_f32 v244, v248, v249
  v_mfma_f32_16x16x32_bf16 v[124:127], v[68:71], a[220:223], v[124:127]
  buffer_load_dwordx4 v11, s[36:39], s27 offen offset:3072 lds
  v_cvt_pk_bf16_f32 v245, v250, v251
  v_mfma_f32_16x16x32_bf16 v[140:143], v[72:75], a[220:223], v[140:143]
  s_add_u32 s27, s27, 524288
  v_cvt_pk_bf16_f32 v246, v252, v253
  v_mfma_f32_16x16x32_bf16 v[156:159], v[76:79], a[220:223], v[156:159]
  s_add_u32 s24, s24, 32768
  v_cvt_pk_bf16_f32 v247, v254, v255
  v_mfma_f32_16x16x32_bf16 v[172:175], v[80:83], a[220:223], v[172:175]
  s_and_b32 s24, s24, 0x1ffff
  v_mfma_f32_16x16x32_bf16 v[188:191], v[84:87], a[220:223], v[188:191]
  buffer_store_dwordx4 v[244:247], v2, s[40:43], s63 offen offset:1024 sc1
  v_mfma_f32_16x16x32_bf16 v[204:207], v[88:91], a[220:223], v[204:207]
  v_mfma_f32_16x16x32_bf16 v[220:223], v[92:95], a[220:223], v[220:223]
  s_waitcnt vmcnt(27) lgkmcnt(0)
  buffer_load_dwordx4 a[220:223], v2, s[40:43], s67 offen offset:1024 sc1
  v_mfma_f32_16x16x32_bf16 v[96:99], v[32:35], a[224:227], v[96:99]
  v_accvgpr_read_b32 v236, a16
  v_mfma_f32_16x16x32_bf16 v[112:115], v[36:39], a[224:227], v[112:115]
  ds_read_b64_tr_b16 v[64:65], v12 offset:40960
  v_accvgpr_read_b32 v237, a17
  v_mfma_f32_16x16x32_bf16 v[128:131], v[40:43], a[224:227], v[128:131]
  ds_read_b64_tr_b16 v[66:67], v12 offset:41984
  v_accvgpr_read_b32 v238, a18
  v_mfma_f32_16x16x32_bf16 v[144:147], v[44:47], a[224:227], v[144:147]
  ds_read_b64_tr_b16 v[68:69], v13 offset:40960
  v_accvgpr_read_b32 v239, a19
  v_mfma_f32_16x16x32_bf16 v[160:163], v[48:51], a[224:227], v[160:163]
  ds_read_b64_tr_b16 v[70:71], v13 offset:41984
  v_accvgpr_read_b32 v240, a48
  v_mfma_f32_16x16x32_bf16 v[176:179], v[52:55], a[224:227], v[176:179]
  ds_read_b64_tr_b16 v[72:73], v12 offset:41216
  v_accvgpr_read_b32 v241, a49
  v_mfma_f32_16x16x32_bf16 v[192:195], v[56:59], a[224:227], v[192:195]
  ds_read_b64_tr_b16 v[74:75], v12 offset:42240
  v_accvgpr_read_b32 v242, a50
  v_mfma_f32_16x16x32_bf16 v[208:211], v[60:63], a[224:227], v[208:211]
  buffer_load_dwordx4 a[224:227], v2, s[40:43], s64 offen offset:2048 sc1
  v_accvgpr_read_b32 v243, a51
  v_mfma_f32_16x16x32_bf16 v[100:103], v[32:35], a[228:231], v[100:103]
  ds_read_b64_tr_b16 v[76:77], v13 offset:41216
  v_cvt_pk_bf16_f32 v232, v236, v237
  v_mfma_f32_16x16x32_bf16 v[116:119], v[36:39], a[228:231], v[116:119]
  ds_read_b64_tr_b16 v[78:79], v13 offset:42240
  v_cvt_pk_bf16_f32 v233, v238, v239
  v_mfma_f32_16x16x32_bf16 v[132:135], v[40:43], a[228:231], v[132:135]
  ds_read_b64_tr_b16 v[80:81], v12 offset:41472
  v_cvt_pk_bf16_f32 v234, v240, v241
  v_mfma_f32_16x16x32_bf16 v[148:151], v[44:47], a[228:231], v[148:151]
  v_cvt_pk_bf16_f32 v235, v242, v243
  v_mfma_f32_16x16x32_bf16 v[164:167], v[48:51], a[228:231], v[164:167]
  ds_read_b64_tr_b16 v[82:83], v12 offset:42496
  v_mfma_f32_16x16x32_bf16 v[180:183], v[52:55], a[228:231], v[180:183]
  s_add_u32 s63, s63, s61
  ds_read_b64_tr_b16 v[84:85], v13 offset:41472
  v_mfma_f32_16x16x32_bf16 v[196:199], v[56:59], a[228:231], v[196:199]
  ds_read_b64_tr_b16 v[86:87], v13 offset:42496
  v_mfma_f32_16x16x32_bf16 v[212:215], v[60:63], a[228:231], v[212:215]
  buffer_load_dwordx4 a[228:231], v2, s[40:43], s65 offen offset:2048 sc1
  v_mfma_f32_16x16x32_bf16 v[104:107], v[32:35], a[232:235], v[104:107]
  ds_read_b64_tr_b16 v[88:89], v12 offset:41728
  v_accvgpr_read_b32 v248, a20
  v_mfma_f32_16x16x32_bf16 v[120:123], v[36:39], a[232:235], v[120:123]
  ds_read_b64_tr_b16 v[90:91], v12 offset:42752
  v_accvgpr_read_b32 v249, a21
  v_mfma_f32_16x16x32_bf16 v[136:139], v[40:43], a[232:235], v[136:139]
  ds_read_b64_tr_b16 v[92:93], v13 offset:41728
  v_accvgpr_read_b32 v250, a22
  v_mfma_f32_16x16x32_bf16 v[152:155], v[44:47], a[232:235], v[152:155]
  v_accvgpr_read_b32 v251, a23
  v_mfma_f32_16x16x32_bf16 v[168:171], v[48:51], a[232:235], v[168:171]
  ds_read_b64_tr_b16 v[94:95], v13 offset:42752
  v_accvgpr_read_b32 v252, a52
  v_mfma_f32_16x16x32_bf16 v[184:187], v[52:55], a[232:235], v[184:187]
  buffer_store_dwordx4 v[232:235], v2, s[40:43], s63 offen offset:0 sc1
  v_accvgpr_read_b32 v253, a53
  v_mfma_f32_16x16x32_bf16 v[200:203], v[56:59], a[232:235], v[200:203]
  v_accvgpr_read_b32 v254, a54
  v_mfma_f32_16x16x32_bf16 v[216:219], v[60:63], a[232:235], v[216:219]
  buffer_load_dwordx4 a[232:235], v2, s[40:43], s66 offen offset:2048 sc1
  v_accvgpr_read_b32 v255, a55
  v_mfma_f32_16x16x32_bf16 v[108:111], v[32:35], a[236:239], v[108:111]
  v_xor_b32 v12, 0x10000, v12
  v_cvt_pk_bf16_f32 v244, v248, v249
  v_mfma_f32_16x16x32_bf16 v[124:127], v[36:39], a[236:239], v[124:127]
  v_cvt_pk_bf16_f32 v245, v250, v251
  v_mfma_f32_16x16x32_bf16 v[140:143], v[40:43], a[236:239], v[140:143]
  v_xor_b32 v13, 0x10000, v13
  v_cvt_pk_bf16_f32 v246, v252, v253
  v_mfma_f32_16x16x32_bf16 v[156:159], v[44:47], a[236:239], v[156:159]
  v_cvt_pk_bf16_f32 v247, v254, v255
  v_mfma_f32_16x16x32_bf16 v[172:175], v[48:51], a[236:239], v[172:175]
  v_mfma_f32_16x16x32_bf16 v[188:191], v[52:55], a[236:239], v[188:191]
  buffer_store_dwordx4 v[244:247], v2, s[40:43], s63 offen offset:1024 sc1
  v_mfma_f32_16x16x32_bf16 v[204:207], v[56:59], a[236:239], v[204:207]
  v_mfma_f32_16x16x32_bf16 v[220:223], v[60:63], a[236:239], v[220:223]
  s_waitcnt vmcnt(29) lgkmcnt(0)
  buffer_load_dwordx4 a[236:239], v2, s[40:43], s67 offen offset:2048 sc1
  v_mfma_f32_16x16x32_bf16 v[96:99], v[64:67], a[240:243], v[96:99]
  s_barrier
  v_accvgpr_read_b32 v236, a24
  v_mfma_f32_16x16x32_bf16 v[112:115], v[68:71], a[240:243], v[112:115]
  ds_read_b64_tr_b16 v[32:33], v12 offset:0
  v_accvgpr_read_b32 v237, a25
  v_mfma_f32_16x16x32_bf16 v[128:131], v[72:75], a[240:243], v[128:131]
  ds_read_b64_tr_b16 v[34:35], v12 offset:1024
  v_accvgpr_read_b32 v238, a26
  v_mfma_f32_16x16x32_bf16 v[144:147], v[76:79], a[240:243], v[144:147]
  ds_read_b64_tr_b16 v[36:37], v13 offset:0
  v_accvgpr_read_b32 v239, a27
  v_mfma_f32_16x16x32_bf16 v[160:163], v[80:83], a[240:243], v[160:163]
  ds_read_b64_tr_b16 v[38:39], v13 offset:1024
  v_accvgpr_read_b32 v240, a56
  v_mfma_f32_16x16x32_bf16 v[176:179], v[84:87], a[240:243], v[176:179]
  ds_read_b64_tr_b16 v[40:41], v12 offset:256
  v_accvgpr_read_b32 v241, a57
  v_mfma_f32_16x16x32_bf16 v[192:195], v[88:91], a[240:243], v[192:195]
  ds_read_b64_tr_b16 v[42:43], v12 offset:1280
  v_accvgpr_read_b32 v242, a58
  v_mfma_f32_16x16x32_bf16 v[208:211], v[92:95], a[240:243], v[208:211]
  buffer_load_dwordx4 a[240:243], v2, s[40:43], s64 offen offset:3072 sc1
  v_accvgpr_read_b32 v243, a59
  v_mfma_f32_16x16x32_bf16 v[100:103], v[64:67], a[244:247], v[100:103]
  s_add_u32 s64, s64, 4096
  ds_read_b64_tr_b16 v[44:45], v13 offset:256
  v_cvt_pk_bf16_f32 v232, v236, v237
  v_mfma_f32_16x16x32_bf16 v[116:119], v[68:71], a[244:247], v[116:119]
  ds_read_b64_tr_b16 v[46:47], v13 offset:1280
  v_cvt_pk_bf16_f32 v233, v238, v239
  v_mfma_f32_16x16x32_bf16 v[132:135], v[72:75], a[244:247], v[132:135]
  s_add_u32 m0, s24, 16384
  ds_read_b64_tr_b16 v[48:49], v12 offset:512
  v_cvt_pk_bf16_f32 v234, v240, v241
  v_mfma_f32_16x16x32_bf16 v[148:151], v[76:79], a[244:247], v[148:151]
  buffer_load_dwordx4 v8, s[36:39], s27 offen offset:0 lds
  v_cvt_pk_bf16_f32 v235, v242, v243
  v_mfma_f32_16x16x32_bf16 v[164:167], v[80:83], a[244:247], v[164:167]
  ds_read_b64_tr_b16 v[50:51], v12 offset:1536
  v_mfma_f32_16x16x32_bf16 v[180:183], v[84:87], a[244:247], v[180:183]
  s_add_u32 s63, s63, s61
  ds_read_b64_tr_b16 v[52:53], v13 offset:512
  v_mfma_f32_16x16x32_bf16 v[196:199], v[88:91], a[244:247], v[196:199]
  ds_read_b64_tr_b16 v[54:55], v13 offset:1536
  v_mfma_f32_16x16x32_bf16 v[212:215], v[92:95], a[244:247], v[212:215]
  buffer_load_dwordx4 a[244:247], v2, s[40:43], s65 offen offset:3072 sc1
  v_mfma_f32_16x16x32_bf16 v[104:107], v[64:67], a[248:251], v[104:107]
  s_add_u32 s65, s65, 4096
  ds_read_b64_tr_b16 v[56:57], v12 offset:768
  v_accvgpr_read_b32 v248, a28
  v_mfma_f32_16x16x32_bf16 v[120:123], v[68:71], a[248:251], v[120:123]
  ds_read_b64_tr_b16 v[58:59], v12 offset:1792
  v_accvgpr_read_b32 v249, a29
  v_mfma_f32_16x16x32_bf16 v[136:139], v[72:75], a[248:251], v[136:139]
  ds_read_b64_tr_b16 v[60:61], v13 offset:768
  v_accvgpr_read_b32 v250, a30
  v_mfma_f32_16x16x32_bf16 v[152:155], v[76:79], a[248:251], v[152:155]
  buffer_load_dwordx4 v9, s[36:39], s27 offen offset:1024 lds
  v_accvgpr_read_b32 v251, a31
  v_mfma_f32_16x16x32_bf16 v[168:171], v[80:83], a[248:251], v[168:171]
  ds_read_b64_tr_b16 v[62:63], v13 offset:1792
  v_accvgpr_read_b32 v252, a60
  v_mfma_f32_16x16x32_bf16 v[184:187], v[84:87], a[248:251], v[184:187]
  buffer_store_dwordx4 v[232:235], v2, s[40:43], s63 offen offset:0 sc1
  v_accvgpr_read_b32 v253, a61
  v_mfma_f32_16x16x32_bf16 v[200:203], v[88:91], a[248:251], v[200:203]
  buffer_load_dwordx4 v10, s[36:39], s27 offen offset:2048 lds
  v_accvgpr_read_b32 v254, a62
  v_mfma_f32_16x16x32_bf16 v[216:219], v[92:95], a[248:251], v[216:219]
  buffer_load_dwordx4 a[248:251], v2, s[40:43], s66 offen offset:3072 sc1
  v_accvgpr_read_b32 v255, a63
  v_mfma_f32_16x16x32_bf16 v[108:111], v[64:67], a[252:255], v[108:111]
  s_add_u32 s66, s66, 4096
  v_cvt_pk_bf16_f32 v244, v248, v249
  v_mfma_f32_16x16x32_bf16 v[124:127], v[68:71], a[252:255], v[124:127]
  buffer_load_dwordx4 v11, s[36:39], s27 offen offset:3072 lds
  v_cvt_pk_bf16_f32 v245, v250, v251
  v_mfma_f32_16x16x32_bf16 v[140:143], v[72:75], a[252:255], v[140:143]
  s_add_u32 s27, s27, 524288
  v_cvt_pk_bf16_f32 v246, v252, v253
  v_mfma_f32_16x16x32_bf16 v[156:159], v[76:79], a[252:255], v[156:159]
  s_add_u32 s24, s24, 32768
  v_cvt_pk_bf16_f32 v247, v254, v255
  v_mfma_f32_16x16x32_bf16 v[172:175], v[80:83], a[252:255], v[172:175]
  s_and_b32 s24, s24, 0x1ffff
  v_mfma_f32_16x16x32_bf16 v[188:191], v[84:87], a[252:255], v[188:191]
  buffer_store_dwordx4 v[244:247], v2, s[40:43], s63 offen offset:1024 sc1
  v_mfma_f32_16x16x32_bf16 v[204:207], v[88:91], a[252:255], v[204:207]
  v_mfma_f32_16x16x32_bf16 v[220:223], v[92:95], a[252:255], v[220:223]
  s_waitcnt vmcnt(25) lgkmcnt(0)
  buffer_load_dwordx4 a[252:255], v2, s[40:43], s67 offen offset:3072 sc1
  v_mfma_f32_16x16x32_bf16 v[96:99], v[32:35], a[192:195], v[96:99]
  v_accvgpr_read_b32 v236, a64
  v_mfma_f32_16x16x32_bf16 v[112:115], v[36:39], a[192:195], v[112:115]
  s_add_u32 s67, s67, 4096
  ds_read_b64_tr_b16 v[64:65], v12 offset:8192
  v_accvgpr_read_b32 v237, a65
  v_mfma_f32_16x16x32_bf16 v[128:131], v[40:43], a[192:195], v[128:131]
  ds_read_b64_tr_b16 v[66:67], v12 offset:9216
  v_accvgpr_read_b32 v238, a66
  v_mfma_f32_16x16x32_bf16 v[144:147], v[44:47], a[192:195], v[144:147]
  ds_read_b64_tr_b16 v[68:69], v13 offset:8192
  v_accvgpr_read_b32 v239, a67
  v_mfma_f32_16x16x32_bf16 v[160:163], v[48:51], a[192:195], v[160:163]
  ds_read_b64_tr_b16 v[70:71], v13 offset:9216
  v_accvgpr_read_b32 v240, a96
  v_mfma_f32_16x16x32_bf16 v[176:179], v[52:55], a[192:195], v[176:179]
  ds_read_b64_tr_b16 v[72:73], v12 offset:8448
  v_accvgpr_read_b32 v241, a97
  v_mfma_f32_16x16x32_bf16 v[192:195], v[56:59], a[192:195], v[192:195]
  ds_read_b64_tr_b16 v[74:75], v12 offset:9472
  v_accvgpr_read_b32 v242, a98
  v_mfma_f32_16x16x32_bf16 v[208:211], v[60:63], a[192:195], v[208:211]
  buffer_load_dwordx4 a[192:195], v2, s[40:43], s64 offen offset:0 sc1
  v_accvgpr_read_b32 v243, a99
  v_mfma_f32_16x16x32_bf16 v[100:103], v[32:35], a[196:199], v[100:103]
  ds_read_b64_tr_b16 v[76:77], v13 offset:8448
  v_cvt_pk_bf16_f32 v232, v236, v237
  v_mfma_f32_16x16x32_bf16 v[116:119], v[36:39], a[196:199], v[116:119]
  ds_read_b64_tr_b16 v[78:79], v13 offset:9472
  v_cvt_pk_bf16_f32 v233, v238, v239
  v_mfma_f32_16x16x32_bf16 v[132:135], v[40:43], a[196:199], v[132:135]
  ds_read_b64_tr_b16 v[80:81], v12 offset:8704
  v_cvt_pk_bf16_f32 v234, v240, v241
  v_mfma_f32_16x16x32_bf16 v[148:151], v[44:47], a[196:199], v[148:151]
  v_cvt_pk_bf16_f32 v235, v242, v243
  v_mfma_f32_16x16x32_bf16 v[164:167], v[48:51], a[196:199], v[164:167]
  ds_read_b64_tr_b16 v[82:83], v12 offset:9728
  v_mfma_f32_16x16x32_bf16 v[180:183], v[52:55], a[196:199], v[180:183]
  s_mul_i32 s63, s60, 1
  ds_read_b64_tr_b16 v[84:85], v13 offset:8704
  v_mfma_f32_16x16x32_bf16 v[196:199], v[56:59], a[196:199], v[196:199]
  s_add_u32 s63, s63, s62
  ds_read_b64_tr_b16 v[86:87], v13 offset:9728
  v_mfma_f32_16x16x32_bf16 v[212:215], v[60:63], a[196:199], v[212:215]
  buffer_load_dwordx4 a[196:199], v2, s[40:43], s65 offen offset:0 sc1
  v_mfma_f32_16x16x32_bf16 v[104:107], v[32:35], a[200:203], v[104:107]
  ds_read_b64_tr_b16 v[88:89], v12 offset:8960
  v_accvgpr_read_b32 v248, a68
  v_mfma_f32_16x16x32_bf16 v[120:123], v[36:39], a[200:203], v[120:123]
  ds_read_b64_tr_b16 v[90:91], v12 offset:9984
  v_accvgpr_read_b32 v249, a69
  v_mfma_f32_16x16x32_bf16 v[136:139], v[40:43], a[200:203], v[136:139]
  ds_read_b64_tr_b16 v[92:93], v13 offset:8960
  v_accvgpr_read_b32 v250, a70
  v_mfma_f32_16x16x32_bf16 v[152:155], v[44:47], a[200:203], v[152:155]
  v_accvgpr_read_b32 v251, a71
  v_mfma_f32_16x16x32_bf16 v[168:171], v[48:51], a[200:203], v[168:171]
  ds_read_b64_tr_b16 v[94:95], v13 offset:9984
  v_accvgpr_read_b32 v252, a100
  v_mfma_f32_16x16x32_bf16 v[184:187], v[52:55], a[200:203], v[184:187]
  buffer_store_dwordx4 v[232:235], v2, s[40:43], s63 offen offset:0 sc1
  v_accvgpr_read_b32 v253, a101
  v_mfma_f32_16x16x32_bf16 v[200:203], v[56:59], a[200:203], v[200:203]
  v_accvgpr_read_b32 v254, a102
  v_mfma_f32_16x16x32_bf16 v[216:219], v[60:63], a[200:203], v[216:219]
  buffer_load_dwordx4 a[200:203], v2, s[40:43], s66 offen offset:0 sc1
  v_accvgpr_read_b32 v255, a103
  v_mfma_f32_16x16x32_bf16 v[108:111], v[32:35], a[204:207], v[108:111]
  v_cvt_pk_bf16_f32 v244, v248, v249
  v_mfma_f32_16x16x32_bf16 v[124:127], v[36:39], a[204:207], v[124:127]
  v_cvt_pk_bf16_f32 v245, v250, v251
  v_mfma_f32_16x16x32_bf16 v[140:143], v[40:43], a[204:207], v[140:143]
  v_cvt_pk_bf16_f32 v246, v252, v253
  v_mfma_f32_16x16x32_bf16 v[156:159], v[44:47], a[204:207], v[156:159]
  v_cvt_pk_bf16_f32 v247, v254, v255
  v_mfma_f32_16x16x32_bf16 v[172:175], v[48:51], a[204:207], v[172:175]
  v_mfma_f32_16x16x32_bf16 v[188:191], v[52:55], a[204:207], v[188:191]
  buffer_store_dwordx4 v[244:247], v2, s[40:43], s63 offen offset:1024 sc1
  v_mfma_f32_16x16x32_bf16 v[204:207], v[56:59], a[204:207], v[204:207]
  v_mfma_f32_16x16x32_bf16 v[220:223], v[60:63], a[204:207], v[220:223]
  s_waitcnt vmcnt(21) lgkmcnt(0)
  buffer_load_dwordx4 a[204:207], v2, s[40:43], s67 offen offset:0 sc1
  v_mfma_f32_16x16x32_bf16 v[96:99], v[64:67], a[208:211], v[96:99]
  s_barrier
  v_accvgpr_read_b32 v236, a72
  v_mfma_f32_16x16x32_bf16 v[112:115], v[68:71], a[208:211], v[112:115]
  ds_read_b64_tr_b16 v[32:33], v12 offset:32768
  v_accvgpr_read_b32 v237, a73
  v_mfma_f32_16x16x32_bf16 v[128:131], v[72:75], a[208:211], v[128:131]
  ds_read_b64_tr_b16 v[34:35], v12 offset:33792
  v_accvgpr_read_b32 v238, a74
  v_mfma_f32_16x16x32_bf16 v[144:147], v[76:79], a[208:211], v[144:147]
  ds_read_b64_tr_b16 v[36:37], v13 offset:32768
  v_accvgpr_read_b32 v239, a75
  v_mfma_f32_16x16x32_bf16 v[160:163], v[80:83], a[208:211], v[160:163]
  ds_read_b64_tr_b16 v[38:39], v13 offset:33792
  v_accvgpr_read_b32 v240, a104
  v_mfma_f32_16x16x32_bf16 v[176:179], v[84:87], a[208:211], v[176:179]
  ds_read_b64_tr_b16 v[40:41], v12 offset:33024
  v_accvgpr_read_b32 v241, a105
  v_mfma_f32_16x16x32_bf16 v[192:195], v[88:91], a[208:211], v[192:195]
  ds_read_b64_tr_b16 v[42:43], v12 offset:34048
  v_accvgpr_read_b32 v242, a106
  v_mfma_f32_16x16x32_bf16 v[208:211], v[92:95], a[208:211], v[208:211]
  buffer_load_dwordx4 a[208:211], v2, s[40:43], s64 offen offset:1024 sc1
  v_accvgpr_read_b32 v243, a107
  v_mfma_f32_16x16x32_bf16 v[100:103], v[64:67], a[212:215], v[100:103]
  ds_read_b64_tr_b16 v[44:45], v13 offset:33024
  v_cvt_pk_bf16_f32 v232, v236, v237
  v_mfma_f32_16x16x32_bf16 v[116:119], v[68:71], a[212:215], v[116:119]
  ds_read_b64_tr_b16 v[46:47], v13 offset:34048
  v_cvt_pk_bf16_f32 v233, v238, v239
  v_mfma_f32_16x16x32_bf16 v[132:135], v[72:75], a[212:215], v[132:135]
  s_add_u32 m0, s24, 16384
  ds_read_b64_tr_b16 v[48:49], v12 offset:33280
  v_cvt_pk_bf16_f32 v234, v240, v241
  v_mfma_f32_16x16x32_bf16 v[148:151], v[76:79], a[212:215], v[148:151]
  buffer_load_dwordx4 v8, s[36:39], s27 offen offset:0 lds
  v_cvt_pk_bf16_f32 v235, v242, v243
  v_mfma_f32_16x16x32_bf16 v[164:167], v[80:83], a[212:215], v[164:167]
  ds_read_b64_tr_b16 v[50:51], v12 offset:34304
  v_mfma_f32_16x16x32_bf16 v[180:183], v[84:87], a[212:215], v[180:183]
  s_add_u32 s63, s63, s61
  ds_read_b64_tr_b16 v[52:53], v13 offset:33280
  v_mfma_f32_16x16x32_bf16 v[196:199], v[88:91], a[212:215], v[196:199]
  ds_read_b64_tr_b16 v[54:55], v13 offset:34304
  v_mfma_f32_16x16x32_bf16 v[212:215], v[92:95], a[212:215], v[212:215]
  buffer_load_dwordx4 a[212:215], v2, s[40:43], s65 offen offset:1024 sc1
  v_mfma_f32_16x16x32_bf16 v[104:107], v[64:67], a[216:219], v[104:107]
  ds_read_b64_tr_b16 v[56:57], v12 offset:33536
  v_accvgpr_read_b32 v248, a76
  v_mfma_f32_16x16x32_bf16 v[120:123], v[68:71], a[216:219], v[120:123]
  ds_read_b64_tr_b16 v[58:59], v12 offset:34560
  v_accvgpr_read_b32 v249, a77
  v_mfma_f32_16x16x32_bf16 v[136:139], v[72:75], a[216:219], v[136:139]
  ds_read_b64_tr_b16 v[60:61], v13 offset:33536
  v_accvgpr_read_b32 v250, a78
  v_mfma_f32_16x16x32_bf16 v[152:155], v[76:79], a[216:219], v[152:155]
  buffer_load_dwordx4 v9, s[36:39], s27 offen offset:1024 lds
  v_accvgpr_read_b32 v251, a79
  v_mfma_f32_16x16x32_bf16 v[168:171], v[80:83], a[216:219], v[168:171]
  ds_read_b64_tr_b16 v[62:63], v13 offset:34560
  v_accvgpr_read_b32 v252, a108
  v_mfma_f32_16x16x32_bf16 v[184:187], v[84:87], a[216:219], v[184:187]
  buffer_store_dwordx4 v[232:235], v2, s[40:43], s63 offen offset:0 sc1
  v_accvgpr_read_b32 v253, a109
  v_mfma_f32_16x16x32_bf16 v[200:203], v[88:91], a[216:219], v[200:203]
  buffer_load_dwordx4 v10, s[36:39], s27 offen offset:2048 lds
  v_accvgpr_read_b32 v254, a110
  v_mfma_f32_16x16x32_bf16 v[216:219], v[92:95], a[216:219], v[216:219]
  buffer_load_dwordx4 a[216:219], v2, s[40:43], s66 offen offset:1024 sc1
  v_accvgpr_read_b32 v255, a111
  v_mfma_f32_16x16x32_bf16 v[108:111], v[64:67], a[220:223], v[108:111]
  v_cvt_pk_bf16_f32 v244, v248, v249
  v_mfma_f32_16x16x32_bf16 v[124:127], v[68:71], a[220:223], v[124:127]
  buffer_load_dwordx4 v11, s[36:39], s27 offen offset:3072 lds
  v_cvt_pk_bf16_f32 v245, v250, v251
  v_mfma_f32_16x16x32_bf16 v[140:143], v[72:75], a[220:223], v[140:143]
  s_add_u32 s27, s27, 524288
  v_cvt_pk_bf16_f32 v246, v252, v253
  v_mfma_f32_16x16x32_bf16 v[156:159], v[76:79], a[220:223], v[156:159]
  s_add_u32 s24, s24, 32768
  v_cvt_pk_bf16_f32 v247, v254, v255
  v_mfma_f32_16x16x32_bf16 v[172:175], v[80:83], a[220:223], v[172:175]
  s_and_b32 s24, s24, 0x1ffff
  v_mfma_f32_16x16x32_bf16 v[188:191], v[84:87], a[220:223], v[188:191]
  buffer_store_dwordx4 v[244:247], v2, s[40:43], s63 offen offset:1024 sc1
  v_mfma_f32_16x16x32_bf16 v[204:207], v[88:91], a[220:223], v[204:207]
  v_mfma_f32_16x16x32_bf16 v[220:223], v[92:95], a[220:223], v[220:223]
  s_waitcnt vmcnt(25) lgkmcnt(0)
  buffer_load_dwordx4 a[220:223], v2, s[40:43], s67 offen offset:1024 sc1
  v_mfma_f32_16x16x32_bf16 v[96:99], v[32:35], a[224:227], v[96:99]
  v_accvgpr_read_b32 v236, a80
  v_mfma_f32_16x16x32_bf16 v[112:115], v[36:39], a[224:227], v[112:115]
  ds_read_b64_tr_b16 v[64:65], v12 offset:40960
  v_accvgpr_read_b32 v237, a81
  v_mfma_f32_16x16x32_bf16 v[128:131], v[40:43], a[224:227], v[128:131]
  ds_read_b64_tr_b16 v[66:67], v12 offset:41984
  v_accvgpr_read_b32 v238, a82
  v_mfma_f32_16x16x32_bf16 v[144:147], v[44:47], a[224:227], v[144:147]
  ds_read_b64_tr_b16 v[68:69], v13 offset:40960
  v_accvgpr_read_b32 v239, a83
  v_mfma_f32_16x16x32_bf16 v[160:163], v[48:51], a[224:227], v[160:163]
  ds_read_b64_tr_b16 v[70:71], v13 offset:41984
  v_accvgpr_read_b32 v240, a112
  v_mfma_f32_16x16x32_bf16 v[176:179], v[52:55], a[224:227], v[176:179]
  ds_read_b64_tr_b16 v[72:73], v12 offset:41216
  v_accvgpr_read_b32 v241, a113
  v_mfma_f32_16x16x32_bf16 v[192:195], v[56:59], a[224:227], v[192:195]
  ds_read_b64_tr_b16 v[74:75], v12 offset:42240
  v_accvgpr_read_b32 v242, a114
  v_mfma_f32_16x16x32_bf16 v[208:211], v[60:63], a[224:227], v[208:211]
  buffer_load_dwordx4 a[224:227], v2, s[40:43], s64 offen offset:2048 sc1
  v_accvgpr_read_b32 v243, a115
  v_mfma_f32_16x16x32_bf16 v[100:103], v[32:35], a[228:231], v[100:103]
  ds_read_b64_tr_b16 v[76:77], v13 offset:41216
  v_cvt_pk_bf16_f32 v232, v236, v237
  v_mfma_f32_16x16x32_bf16 v[116:119], v[36:39], a[228:231], v[116:119]
  ds_read_b64_tr_b16 v[78:79], v13 offset:42240
  v_cvt_pk_bf16_f32 v233, v238, v239
  v_mfma_f32_16x16x32_bf16 v[132:135], v[40:43], a[228:231], v[132:135]
  ds_read_b64_tr_b16 v[80:81], v12 offset:41472
  v_cvt_pk_bf16_f32 v234, v240, v241
  v_mfma_f32_16x16x32_bf16 v[148:151], v[44:47], a[228:231], v[148:151]
  v_cvt_pk_bf16_f32 v235, v242, v243
  v_mfma_f32_16x16x32_bf16 v[164:167], v[48:51], a[228:231], v[164:167]
  ds_read_b64_tr_b16 v[82:83], v12 offset:42496
  v_mfma_f32_16x16x32_bf16 v[180:183], v[52:55], a[228:231], v[180:183]
  s_add_u32 s63, s63, s61
  ds_read_b64_tr_b16 v[84:85], v13 offset:41472
  v_mfma_f32_16x16x32_bf16 v[196:199], v[56:59], a[228:231], v[196:199]
  ds_read_b64_tr_b16 v[86:87], v13 offset:42496
  v_mfma_f32_16x16x32_bf16 v[212:215], v[60:63], a[228:231], v[212:215]
  buffer_load_dwordx4 a[228:231], v2, s[40:43], s65 offen offset:2048 sc1
  v_mfma_f32_16x16x32_bf16 v[104:107], v[32:35], a[232:235], v[104:107]
  ds_read_b64_tr_b16 v[88:89], v12 offset:41728
  v_accvgpr_read_b32 v248, a84
  v_mfma_f32_16x16x32_bf16 v[120:123], v[36:39], a[232:235], v[120:123]
  ds_read_b64_tr_b16 v[90:91], v12 offset:42752
  v_accvgpr_read_b32 v249, a85
  v_mfma_f32_16x16x32_bf16 v[136:139], v[40:43], a[232:235], v[136:139]
  ds_read_b64_tr_b16 v[92:93], v13 offset:41728
  v_accvgpr_read_b32 v250, a86
  v_mfma_f32_16x16x32_bf16 v[152:155], v[44:47], a[232:235], v[152:155]
  v_accvgpr_read_b32 v251, a87
  v_mfma_f32_16x16x32_bf16 v[168:171], v[48:51], a[232:235], v[168:171]
  ds_read_b64_tr_b16 v[94:95], v13 offset:42752
  v_accvgpr_read_b32 v252, a116
  v_mfma_f32_16x16x32_bf16 v[184:187], v[52:55], a[232:235], v[184:187]
  buffer_store_dwordx4 v[232:235], v2, s[40:43], s63 offen offset:0 sc1
  v_accvgpr_read_b32 v253, a117
  v_mfma_f32_16x16x32_bf16 v[200:203], v[56:59], a[232:235], v[200:203]
  v_accvgpr_read_b32 v254, a118
  v_mfma_f32_16x16x32_bf16 v[216:219], v[60:63], a[232:235], v[216:219]
  buffer_load_dwordx4 a[232:235], v2, s[40:43], s66 offen offset:2048 sc1
  v_accvgpr_read_b32 v255, a119
  v_mfma_f32_16x16x32_bf16 v[108:111], v[32:35], a[236:239], v[108:111]
  v_xor_b32 v12, 0x10000, v12
  v_cvt_pk_bf16_f32 v244, v248, v249
  v_mfma_f32_16x16x32_bf16 v[124:127], v[36:39], a[236:239], v[124:127]
  v_cvt_pk_bf16_f32 v245, v250, v251
  v_mfma_f32_16x16x32_bf16 v[140:143], v[40:43], a[236:239], v[140:143]
  v_xor_b32 v13, 0x10000, v13
  v_cvt_pk_bf16_f32 v246, v252, v253
  v_mfma_f32_16x16x32_bf16 v[156:159], v[44:47], a[236:239], v[156:159]
  v_cvt_pk_bf16_f32 v247, v254, v255
  v_mfma_f32_16x16x32_bf16 v[172:175], v[48:51], a[236:239], v[172:175]
  v_mfma_f32_16x16x32_bf16 v[188:191], v[52:55], a[236:239], v[188:191]
  buffer_store_dwordx4 v[244:247], v2, s[40:43], s63 offen offset:1024 sc1
  v_mfma_f32_16x16x32_bf16 v[204:207], v[56:59], a[236:239], v[204:207]
  v_mfma_f32_16x16x32_bf16 v[220:223], v[60:63], a[236:239], v[220:223]
  s_waitcnt vmcnt(21) lgkmcnt(0)
  buffer_load_dwordx4 a[236:239], v2, s[40:43], s67 offen offset:2048 sc1
  v_mfma_f32_16x16x32_bf16 v[96:99], v[64:67], a[240:243], v[96:99]
  s_barrier
  v_accvgpr_read_b32 v236, a88
  v_mfma_f32_16x16x32_bf16 v[112:115], v[68:71], a[240:243], v[112:115]
  ds_read_b64_tr_b16 v[32:33], v12 offset:0
  v_accvgpr_read_b32 v237, a89
  v_mfma_f32_16x16x32_bf16 v[128:131], v[72:75], a[240:243], v[128:131]
  ds_read_b64_tr_b16 v[34:35], v12 offset:1024
  v_accvgpr_read_b32 v238, a90
  v_mfma_f32_16x16x32_bf16 v[144:147], v[76:79], a[240:243], v[144:147]
  ds_read_b64_tr_b16 v[36:37], v13 offset:0
  v_accvgpr_read_b32 v239, a91
  v_mfma_f32_16x16x32_bf16 v[160:163], v[80:83], a[240:243], v[160:163]
  ds_read_b64_tr_b16 v[38:39], v13 offset:1024
  v_accvgpr_read_b32 v240, a120
  v_mfma_f32_16x16x32_bf16 v[176:179], v[84:87], a[240:243], v[176:179]
  ds_read_b64_tr_b16 v[40:41], v12 offset:256
  v_accvgpr_read_b32 v241, a121
  v_mfma_f32_16x16x32_bf16 v[192:195], v[88:91], a[240:243], v[192:195]
  ds_read_b64_tr_b16 v[42:43], v12 offset:1280
  v_accvgpr_read_b32 v242, a122
  v_mfma_f32_16x16x32_bf16 v[208:211], v[92:95], a[240:243], v[208:211]
  buffer_load_dwordx4 a[240:243], v2, s[40:43], s64 offen offset:3072 sc1
  v_accvgpr_read_b32 v243, a123
  v_mfma_f32_16x16x32_bf16 v[100:103], v[64:67], a[244:247], v[100:103]
  s_add_u32 s64, s64, 4096
  ds_read_b64_tr_b16 v[44:45], v13 offset:256
  v_cvt_pk_bf16_f32 v232, v236, v237
  v_mfma_f32_16x16x32_bf16 v[116:119], v[68:71], a[244:247], v[116:119]
  ds_read_b64_tr_b16 v[46:47], v13 offset:1280
  v_cvt_pk_bf16_f32 v233, v238, v239
  v_mfma_f32_16x16x32_bf16 v[132:135], v[72:75], a[244:247], v[132:135]
  s_add_u32 m0, s24, 16384
  ds_read_b64_tr_b16 v[48:49], v12 offset:512
  v_cvt_pk_bf16_f32 v234, v240, v241
  v_mfma_f32_16x16x32_bf16 v[148:151], v[76:79], a[244:247], v[148:151]
  buffer_load_dwordx4 v8, s[36:39], s27 offen offset:0 lds
  v_cvt_pk_bf16_f32 v235, v242, v243
  v_mfma_f32_16x16x32_bf16 v[164:167], v[80:83], a[244:247], v[164:167]
  ds_read_b64_tr_b16 v[50:51], v12 offset:1536
  v_mfma_f32_16x16x32_bf16 v[180:183], v[84:87], a[244:247], v[180:183]
  s_add_u32 s63, s63, s61
  ds_read_b64_tr_b16 v[52:53], v13 offset:512
  v_mfma_f32_16x16x32_bf16 v[196:199], v[88:91], a[244:247], v[196:199]
  ds_read_b64_tr_b16 v[54:55], v13 offset:1536
  v_mfma_f32_16x16x32_bf16 v[212:215], v[92:95], a[244:247], v[212:215]
  buffer_load_dwordx4 a[244:247], v2, s[40:43], s65 offen offset:3072 sc1
  v_mfma_f32_16x16x32_bf16 v[104:107], v[64:67], a[248:251], v[104:107]
  s_add_u32 s65, s65, 4096
  ds_read_b64_tr_b16 v[56:57], v12 offset:768
  v_accvgpr_read_b32 v248, a92
  v_mfma_f32_16x16x32_bf16 v[120:123], v[68:71], a[248:251], v[120:123]
  ds_read_b64_tr_b16 v[58:59], v12 offset:1792
  v_accvgpr_read_b32 v249, a93
  v_mfma_f32_16x16x32_bf16 v[136:139], v[72:75], a[248:251], v[136:139]
  ds_read_b64_tr_b16 v[60:61], v13 offset:768
  v_accvgpr_read_b32 v250, a94
  v_mfma_f32_16x16x32_bf16 v[152:155], v[76:79], a[248:251], v[152:155]
  buffer_load_dwordx4 v9, s[36:39], s27 offen offset:1024 lds
  v_accvgpr_read_b32 v251, a95
  v_mfma_f32_16x16x32_bf16 v[168:171], v[80:83], a[248:251], v[168:171]
  ds_read_b64_tr_b16 v[62:63], v13 offset:1792
  v_accvgpr_read_b32 v252, a124
  v_mfma_f32_16x16x32_bf16 v[184:187], v[84:87], a[248:251], v[184:187]
  buffer_store_dwordx4 v[232:235], v2, s[40:43], s63 offen offset:0 sc1
  v_accvgpr_read_b32 v253, a125
  v_mfma_f32_16x16x32_bf16 v[200:203], v[88:91], a[248:251], v[200:203]
  buffer_load_dwordx4 v10, s[36:39], s27 offen offset:2048 lds
  v_accvgpr_read_b32 v254, a126
  v_mfma_f32_16x16x32_bf16 v[216:219], v[92:95], a[248:251], v[216:219]
  buffer_load_dwordx4 a[248:251], v2, s[40:43], s66 offen offset:3072 sc1
  v_accvgpr_read_b32 v255, a127
  v_mfma_f32_16x16x32_bf16 v[108:111], v[64:67], a[252:255], v[108:111]
  s_add_u32 s66, s66, 4096
  v_cvt_pk_bf16_f32 v244, v248, v249
  v_mfma_f32_16x16x32_bf16 v[124:127], v[68:71], a[252:255], v[124:127]
  buffer_load_dwordx4 v11, s[36:39], s27 offen offset:3072 lds
  v_cvt_pk_bf16_f32 v245, v250, v251
  v_mfma_f32_16x16x32_bf16 v[140:143], v[72:75], a[252:255], v[140:143]
  s_add_u32 s27, s27, 524288
  v_cvt_pk_bf16_f32 v246, v252, v253
  v_mfma_f32_16x16x32_bf16 v[156:159], v[76:79], a[252:255], v[156:159]
  s_add_u32 s24, s24, 32768
  v_cvt_pk_bf16_f32 v247, v254, v255
  v_mfma_f32_16x16x32_bf16 v[172:175], v[80:83], a[252:255], v[172:175]
  s_and_b32 s24, s24, 0x1ffff
  v_mfma_f32_16x16x32_bf16 v[188:191], v[84:87], a[252:255], v[188:191]
  buffer_store_dwordx4 v[244:247], v2, s[40:43], s63 offen offset:1024 sc1
  v_mfma_f32_16x16x32_bf16 v[204:207], v[88:91], a[252:255], v[204:207]
  v_mfma_f32_16x16x32_bf16 v[220:223], v[92:95], a[252:255], v[220:223]
  s_waitcnt vmcnt(25) lgkmcnt(0)
  buffer_load_dwordx4 a[252:255], v2, s[40:43], s67 offen offset:3072 sc1
  v_mfma_f32_16x16x32_bf16 v[96:99], v[32:35], a[192:195], v[96:99]
  v_accvgpr_read_b32 v236, a128
  v_mfma_f32_16x16x32_bf16 v[112:115], v[36:39], a[192:195], v[112:115]
  s_add_u32 s67, s67, 4096
  ds_read_b64_tr_b16 v[64:65], v12 offset:8192
  v_accvgpr_read_b32 v237, a129
  v_mfma_f32_16x16x32_bf16 v[128:131], v[40:43], a[192:195], v[128:131]
  ds_read_b64_tr_b16 v[66:67], v12 offset:9216
  v_accvgpr_read_b32 v238, a130
  v_mfma_f32_16x16x32_bf16 v[144:147], v[44:47], a[192:195], v[144:147]
  ds_read_b64_tr_b16 v[68:69], v13 offset:8192
  v_accvgpr_read_b32 v239, a131
  v_mfma_f32_16x16x32_bf16 v[160:163], v[48:51], a[192:195], v[160:163]
  ds_read_b64_tr_b16 v[70:71], v13 offset:9216
  v_accvgpr_read_b32 v240, a160
  v_mfma_f32_16x16x32_bf16 v[176:179], v[52:55], a[192:195], v[176:179]
  ds_read_b64_tr_b16 v[72:73], v12 offset:8448
  v_accvgpr_read_b32 v241, a161
  v_mfma_f32_16x16x32_bf16 v[192:195], v[56:59], a[192:195], v[192:195]
  ds_read_b64_tr_b16 v[74:75], v12 offset:9472
  v_accvgpr_read_b32 v242, a162
  v_mfma_f32_16x16x32_bf16 v[208:211], v[60:63], a[192:195], v[208:211]
  buffer_load_dwordx4 a[192:195], v2, s[40:43], s64 offen offset:0 sc1
  v_accvgpr_read_b32 v243, a163
  v_mfma_f32_16x16x32_bf16 v[100:103], v[32:35], a[196:199], v[100:103]
  ds_read_b64_tr_b16 v[76:77], v13 offset:8448
  v_cvt_pk_bf16_f32 v232, v236, v237
  v_mfma_f32_16x16x32_bf16 v[116:119], v[36:39], a[196:199], v[116:119]
  ds_read_b64_tr_b16 v[78:79], v13 offset:9472
  v_cvt_pk_bf16_f32 v233, v238, v239
  v_mfma_f32_16x16x32_bf16 v[132:135], v[40:43], a[196:199], v[132:135]
  ds_read_b64_tr_b16 v[80:81], v12 offset:8704
  v_cvt_pk_bf16_f32 v234, v240, v241
  v_mfma_f32_16x16x32_bf16 v[148:151], v[44:47], a[196:199], v[148:151]
  v_cvt_pk_bf16_f32 v235, v242, v243
  v_mfma_f32_16x16x32_bf16 v[164:167], v[48:51], a[196:199], v[164:167]
  ds_read_b64_tr_b16 v[82:83], v12 offset:9728
  v_mfma_f32_16x16x32_bf16 v[180:183], v[52:55], a[196:199], v[180:183]
  s_mul_i32 s63, s60, 2
  ds_read_b64_tr_b16 v[84:85], v13 offset:8704
  v_mfma_f32_16x16x32_bf16 v[196:199], v[56:59], a[196:199], v[196:199]
  s_add_u32 s63, s63, s62
  ds_read_b64_tr_b16 v[86:87], v13 offset:9728
  v_mfma_f32_16x16x32_bf16 v[212:215], v[60:63], a[196:199], v[212:215]
  buffer_load_dwordx4 a[196:199], v2, s[40:43], s65 offen offset:0 sc1
  v_mfma_f32_16x16x32_bf16 v[104:107], v[32:35], a[200:203], v[104:107]
  ds_read_b64_tr_b16 v[88:89], v12 offset:8960
  v_accvgpr_read_b32 v248, a132
  v_mfma_f32_16x16x32_bf16 v[120:123], v[36:39], a[200:203], v[120:123]
  ds_read_b64_tr_b16 v[90:91], v12 offset:9984
  v_accvgpr_read_b32 v249, a133
  v_mfma_f32_16x16x32_bf16 v[136:139], v[40:43], a[200:203], v[136:139]
  ds_read_b64_tr_b16 v[92:93], v13 offset:8960
  v_accvgpr_read_b32 v250, a134
  v_mfma_f32_16x16x32_bf16 v[152:155], v[44:47], a[200:203], v[152:155]
  v_accvgpr_read_b32 v251, a135
  v_mfma_f32_16x16x32_bf16 v[168:171], v[48:51], a[200:203], v[168:171]
  ds_read_b64_tr_b16 v[94:95], v13 offset:9984
  v_accvgpr_read_b32 v252, a164
  v_mfma_f32_16x16x32_bf16 v[184:187], v[52:55], a[200:203], v[184:187]
  buffer_store_dwordx4 v[232:235], v2, s[40:43], s63 offen offset:0 sc1
  v_accvgpr_read_b32 v253, a165
  v_mfma_f32_16x16x32_bf16 v[200:203], v[56:59], a[200:203], v[200:203]
  v_accvgpr_read_b32 v254, a166
  v_mfma_f32_16x16x32_bf16 v[216:219], v[60:63], a[200:203], v[216:219]
  buffer_load_dwordx4 a[200:203], v2, s[40:43], s66 offen offset:0 sc1
  v_accvgpr_read_b32 v255, a167
  v_mfma_f32_16x16x32_bf16 v[108:111], v[32:35], a[204:207], v[108:111]
  v_cvt_pk_bf16_f32 v244, v248, v249
  v_mfma_f32_16x16x32_bf16 v[124:127], v[36:39], a[204:207], v[124:127]
  v_cvt_pk_bf16_f32 v245, v250, v251
  v_mfma_f32_16x16x32_bf16 v[140:143], v[40:43], a[204:207], v[140:143]
  v_cvt_pk_bf16_f32 v246, v252, v253
  v_mfma_f32_16x16x32_bf16 v[156:159], v[44:47], a[204:207], v[156:159]
  v_cvt_pk_bf16_f32 v247, v254, v255
  v_mfma_f32_16x16x32_bf16 v[172:175], v[48:51], a[204:207], v[172:175]
  v_mfma_f32_16x16x32_bf16 v[188:191], v[52:55], a[204:207], v[188:191]
  buffer_store_dwordx4 v[244:247], v2, s[40:43], s63 offen offset:1024 sc1
  v_mfma_f32_16x16x32_bf16 v[204:207], v[56:59], a[204:207], v[204:207]
  v_mfma_f32_16x16x32_bf16 v[220:223], v[60:63], a[204:207], v[220:223]
  s_waitcnt vmcnt(21) lgkmcnt(0)
  buffer_load_dwordx4 a[204:207], v2, s[40:43], s67 offen offset:0 sc1
  v_mfma_f32_16x16x32_bf16 v[96:99], v[64:67], a[208:211], v[96:99]
  s_barrier
  v_accvgpr_read_b32 v236, a136
  v_mfma_f32_16x16x32_bf16 v[112:115], v[68:71], a[208:211], v[112:115]
  ds_read_b64_tr_b16 v[32:33], v12 offset:32768
  v_accvgpr_read_b32 v237, a137
  v_mfma_f32_16x16x32_bf16 v[128:131], v[72:75], a[208:211], v[128:131]
  ds_read_b64_tr_b16 v[34:35], v12 offset:33792
  v_accvgpr_read_b32 v238, a138
  v_mfma_f32_16x16x32_bf16 v[144:147], v[76:79], a[208:211], v[144:147]
  ds_read_b64_tr_b16 v[36:37], v13 offset:32768
  v_accvgpr_read_b32 v239, a139
  v_mfma_f32_16x16x32_bf16 v[160:163], v[80:83], a[208:211], v[160:163]
  ds_read_b64_tr_b16 v[38:39], v13 offset:33792
  v_accvgpr_read_b32 v240, a168
  v_mfma_f32_16x16x32_bf16 v[176:179], v[84:87], a[208:211], v[176:179]
  ds_read_b64_tr_b16 v[40:41], v12 offset:33024
  v_accvgpr_read_b32 v241, a169
  v_mfma_f32_16x16x32_bf16 v[192:195], v[88:91], a[208:211], v[192:195]
  ds_read_b64_tr_b16 v[42:43], v12 offset:34048
  v_accvgpr_read_b32 v242, a170
  v_mfma_f32_16x16x32_bf16 v[208:211], v[92:95], a[208:211], v[208:211]
  buffer_load_dwordx4 a[208:211], v2, s[40:43], s64 offen offset:1024 sc1
  v_accvgpr_read_b32 v243, a171
  v_mfma_f32_16x16x32_bf16 v[100:103], v[64:67], a[212:215], v[100:103]
  ds_read_b64_tr_b16 v[44:45], v13 offset:33024
  v_cvt_pk_bf16_f32 v232, v236, v237
  v_mfma_f32_16x16x32_bf16 v[116:119], v[68:71], a[212:215], v[116:119]
  ds_read_b64_tr_b16 v[46:47], v13 offset:34048
  v_cvt_pk_bf16_f32 v233, v238, v239
  v_mfma_f32_16x16x32_bf16 v[132:135], v[72:75], a[212:215], v[132:135]
  s_add_u32 m0, s24, 16384
  ds_read_b64_tr_b16 v[48:49], v12 offset:33280
  v_cvt_pk_bf16_f32 v234, v240, v241
  v_mfma_f32_16x16x32_bf16 v[148:151], v[76:79], a[212:215], v[148:151]
  buffer_load_dwordx4 v8, s[36:39], s27 offen offset:0 lds
  v_cvt_pk_bf16_f32 v235, v242, v243
  v_mfma_f32_16x16x32_bf16 v[164:167], v[80:83], a[212:215], v[164:167]
  ds_read_b64_tr_b16 v[50:51], v12 offset:34304
  v_mfma_f32_16x16x32_bf16 v[180:183], v[84:87], a[212:215], v[180:183]
  s_add_u32 s63, s63, s61
  ds_read_b64_tr_b16 v[52:53], v13 offset:33280
  v_mfma_f32_16x16x32_bf16 v[196:199], v[88:91], a[212:215], v[196:199]
  ds_read_b64_tr_b16 v[54:55], v13 offset:34304
  v_mfma_f32_16x16x32_bf16 v[212:215], v[92:95], a[212:215], v[212:215]
  buffer_load_dwordx4 a[212:215], v2, s[40:43], s65 offen offset:1024 sc1
  v_mfma_f32_16x16x32_bf16 v[104:107], v[64:67], a[216:219], v[104:107]
  ds_read_b64_tr_b16 v[56:57], v12 offset:33536
  v_accvgpr_read_b32 v248, a140
  v_mfma_f32_16x16x32_bf16 v[120:123], v[68:71], a[216:219], v[120:123]
  ds_read_b64_tr_b16 v[58:59], v12 offset:34560
  v_accvgpr_read_b32 v249, a141
  v_mfma_f32_16x16x32_bf16 v[136:139], v[72:75], a[216:219], v[136:139]
  ds_read_b64_tr_b16 v[60:61], v13 offset:33536
  v_accvgpr_read_b32 v250, a142
  v_mfma_f32_16x16x32_bf16 v[152:155], v[76:79], a[216:219], v[152:155]
  buffer_load_dwordx4 v9, s[36:39], s27 offen offset:1024 lds
  v_accvgpr_read_b32 v251, a143
  v_mfma_f32_16x16x32_bf16 v[168:171], v[80:83], a[216:219], v[168:171]
  ds_read_b64_tr_b16 v[62:63], v13 offset:34560
  v_accvgpr_read_b32 v252, a172
  v_mfma_f32_16x16x32_bf16 v[184:187], v[84:87], a[216:219], v[184:187]
  buffer_store_dwordx4 v[232:235], v2, s[40:43], s63 offen offset:0 sc1
  v_accvgpr_read_b32 v253, a173
  v_mfma_f32_16x16x32_bf16 v[200:203], v[88:91], a[216:219], v[200:203]
  buffer_load_dwordx4 v10, s[36:39], s27 offen offset:2048 lds
  v_accvgpr_read_b32 v254, a174
  v_mfma_f32_16x16x32_bf16 v[216:219], v[92:95], a[216:219], v[216:219]
  buffer_load_dwordx4 a[216:219], v2, s[40:43], s66 offen offset:1024 sc1
  v_accvgpr_read_b32 v255, a175
  v_mfma_f32_16x16x32_bf16 v[108:111], v[64:67], a[220:223], v[108:111]
  v_cvt_pk_bf16_f32 v244, v248, v249
  v_mfma_f32_16x16x32_bf16 v[124:127], v[68:71], a[220:223], v[124:127]
  buffer_load_dwordx4 v11, s[36:39], s27 offen offset:3072 lds
  v_cvt_pk_bf16_f32 v245, v250, v251
  v_mfma_f32_16x16x32_bf16 v[140:143], v[72:75], a[220:223], v[140:143]
  s_add_u32 s27, s27, 524288
  v_cvt_pk_bf16_f32 v246, v252, v253
  v_mfma_f32_16x16x32_bf16 v[156:159], v[76:79], a[220:223], v[156:159]
  s_add_u32 s24, s24, 32768
  v_cvt_pk_bf16_f32 v247, v254, v255
  v_mfma_f32_16x16x32_bf16 v[172:175], v[80:83], a[220:223], v[172:175]
  s_and_b32 s24, s24, 0x1ffff
  v_mfma_f32_16x16x32_bf16 v[188:191], v[84:87], a[220:223], v[188:191]
  buffer_store_dwordx4 v[244:247], v2, s[40:43], s63 offen offset:1024 sc1
  v_mfma_f32_16x16x32_bf16 v[204:207], v[88:91], a[220:223], v[204:207]
  v_mfma_f32_16x16x32_bf16 v[220:223], v[92:95], a[220:223], v[220:223]
  s_waitcnt vmcnt(25) lgkmcnt(0)
  buffer_load_dwordx4 a[220:223], v2, s[40:43], s67 offen offset:1024 sc1
  v_mfma_f32_16x16x32_bf16 v[96:99], v[32:35], a[224:227], v[96:99]
  v_accvgpr_read_b32 v236, a144
  v_mfma_f32_16x16x32_bf16 v[112:115], v[36:39], a[224:227], v[112:115]
  ds_read_b64_tr_b16 v[64:65], v12 offset:40960
  v_accvgpr_read_b32 v237, a145
  v_mfma_f32_16x16x32_bf16 v[128:131], v[40:43], a[224:227], v[128:131]
  ds_read_b64_tr_b16 v[66:67], v12 offset:41984
  v_accvgpr_read_b32 v238, a146
  v_mfma_f32_16x16x32_bf16 v[144:147], v[44:47], a[224:227], v[144:147]
  ds_read_b64_tr_b16 v[68:69], v13 offset:40960
  v_accvgpr_read_b32 v239, a147
  v_mfma_f32_16x16x32_bf16 v[160:163], v[48:51], a[224:227], v[160:163]
  ds_read_b64_tr_b16 v[70:71], v13 offset:41984
  v_accvgpr_read_b32 v240, a176
  v_mfma_f32_16x16x32_bf16 v[176:179], v[52:55], a[224:227], v[176:179]
  ds_read_b64_tr_b16 v[72:73], v12 offset:41216
  v_accvgpr_read_b32 v241, a177
  v_mfma_f32_16x16x32_bf16 v[192:195], v[56:59], a[224:227], v[192:195]
  ds_read_b64_tr_b16 v[74:75], v12 offset:42240
  v_accvgpr_read_b32 v242, a178
  v_mfma_f32_16x16x32_bf16 v[208:211], v[60:63], a[224:227], v[208:211]
  buffer_load_dwordx4 a[224:227], v2, s[40:43], s64 offen offset:2048 sc1
  v_accvgpr_read_b32 v243, a179
  v_mfma_f32_16x16x32_bf16 v[100:103], v[32:35], a[228:231], v[100:103]
  ds_read_b64_tr_b16 v[76:77], v13 offset:41216
  v_cvt_pk_bf16_f32 v232, v236, v237
  v_mfma_f32_16x16x32_bf16 v[116:119], v[36:39], a[228:231], v[116:119]
  ds_read_b64_tr_b16 v[78:79], v13 offset:42240
  v_cvt_pk_bf16_f32 v233, v238, v239
  v_mfma_f32_16x16x32_bf16 v[132:135], v[40:43], a[228:231], v[132:135]
  ds_read_b64_tr_b16 v[80:81], v12 offset:41472
  v_cvt_pk_bf16_f32 v234, v240, v241
  v_mfma_f32_16x16x32_bf16 v[148:151], v[44:47], a[228:231], v[148:151]
  v_cvt_pk_bf16_f32 v235, v242, v243
  v_mfma_f32_16x16x32_bf16 v[164:167], v[48:51], a[228:231], v[164:167]
  ds_read_b64_tr_b16 v[82:83], v12 offset:42496
  v_mfma_f32_16x16x32_bf16 v[180:183], v[52:55], a[228:231], v[180:183]
  s_add_u32 s63, s63, s61
  ds_read_b64_tr_b16 v[84:85], v13 offset:41472
  v_mfma_f32_16x16x32_bf16 v[196:199], v[56:59], a[228:231], v[196:199]
  ds_read_b64_tr_b16 v[86:87], v13 offset:42496
  v_mfma_f32_16x16x32_bf16 v[212:215], v[60:63], a[228:231], v[212:215]
  buffer_load_dwordx4 a[228:231], v2, s[40:43], s65 offen offset:2048 sc1
  v_mfma_f32_16x16x32_bf16 v[104:107], v[32:35], a[232:235], v[104:107]
  ds_read_b64_tr_b16 v[88:89], v12 offset:41728
  v_accvgpr_read_b32 v248, a148
  v_mfma_f32_16x16x32_bf16 v[120:123], v[36:39], a[232:235], v[120:123]
  ds_read_b64_tr_b16 v[90:91], v12 offset:42752
  v_accvgpr_read_b32 v249, a149
  v_mfma_f32_16x16x32_bf16 v[136:139], v[40:43], a[232:235], v[136:139]
  ds_read_b64_tr_b16 v[92:93], v13 offset:41728
  v_accvgpr_read_b32 v250, a150
  v_mfma_f32_16x16x32_bf16 v[152:155], v[44:47], a[232:235], v[152:155]
  v_accvgpr_read_b32 v251, a151
  v_mfma_f32_16x16x32_bf16 v[168:171], v[48:51], a[232:235], v[168:171]
  ds_read_b64_tr_b16 v[94:95], v13 offset:42752
  v_accvgpr_read_b32 v252, a180
  v_mfma_f32_16x16x32_bf16 v[184:187], v[52:55], a[232:235], v[184:187]
  buffer_store_dwordx4 v[232:235], v2, s[40:43], s63 offen offset:0 sc1
  v_accvgpr_read_b32 v253, a181
  v_mfma_f32_16x16x32_bf16 v[200:203], v[56:59], a[232:235], v[200:203]
  v_accvgpr_read_b32 v254, a182
  v_mfma_f32_16x16x32_bf16 v[216:219], v[60:63], a[232:235], v[216:219]
  buffer_load_dwordx4 a[232:235], v2, s[40:43], s66 offen offset:2048 sc1
  v_accvgpr_read_b32 v255, a183
  v_mfma_f32_16x16x32_bf16 v[108:111], v[32:35], a[236:239], v[108:111]
  v_xor_b32 v12, 0x10000, v12
  v_cvt_pk_bf16_f32 v244, v248, v249
  v_mfma_f32_16x16x32_bf16 v[124:127], v[36:39], a[236:239], v[124:127]
  v_cvt_pk_bf16_f32 v245, v250, v251
  v_mfma_f32_16x16x32_bf16 v[140:143], v[40:43], a[236:239], v[140:143]
  v_xor_b32 v13, 0x10000, v13
  v_cvt_pk_bf16_f32 v246, v252, v253
  v_mfma_f32_16x16x32_bf16 v[156:159], v[44:47], a[236:239], v[156:159]
  v_cvt_pk_bf16_f32 v247, v254, v255
  v_mfma_f32_16x16x32_bf16 v[172:175], v[48:51], a[236:239], v[172:175]
  v_mfma_f32_16x16x32_bf16 v[188:191], v[52:55], a[236:239], v[188:191]
  buffer_store_dwordx4 v[244:247], v2, s[40:43], s63 offen offset:1024 sc1
  v_mfma_f32_16x16x32_bf16 v[204:207], v[56:59], a[236:239], v[204:207]
  v_mfma_f32_16x16x32_bf16 v[220:223], v[60:63], a[236:239], v[220:223]
  s_waitcnt vmcnt(21) lgkmcnt(0)
  buffer_load_dwordx4 a[236:239], v2, s[40:43], s67 offen offset:2048 sc1
  v_mfma_f32_16x16x32_bf16 v[96:99], v[64:67], a[240:243], v[96:99]
  s_barrier
  v_accvgpr_read_b32 v236, a152
  v_mfma_f32_16x16x32_bf16 v[112:115], v[68:71], a[240:243], v[112:115]
  ds_read_b64_tr_b16 v[32:33], v12 offset:0
  v_accvgpr_read_b32 v237, a153
  v_mfma_f32_16x16x32_bf16 v[128:131], v[72:75], a[240:243], v[128:131]
  ds_read_b64_tr_b16 v[34:35], v12 offset:1024
  v_accvgpr_read_b32 v238, a154
  v_mfma_f32_16x16x32_bf16 v[144:147], v[76:79], a[240:243], v[144:147]
  ds_read_b64_tr_b16 v[36:37], v13 offset:0
  v_accvgpr_read_b32 v239, a155
  v_mfma_f32_16x16x32_bf16 v[160:163], v[80:83], a[240:243], v[160:163]
  ds_read_b64_tr_b16 v[38:39], v13 offset:1024
  v_accvgpr_read_b32 v240, a184
  v_mfma_f32_16x16x32_bf16 v[176:179], v[84:87], a[240:243], v[176:179]
  ds_read_b64_tr_b16 v[40:41], v12 offset:256
  v_accvgpr_read_b32 v241, a185
  v_mfma_f32_16x16x32_bf16 v[192:195], v[88:91], a[240:243], v[192:195]
  ds_read_b64_tr_b16 v[42:43], v12 offset:1280
  v_accvgpr_read_b32 v242, a186
  v_mfma_f32_16x16x32_bf16 v[208:211], v[92:95], a[240:243], v[208:211]
  buffer_load_dwordx4 a[240:243], v2, s[40:43], s64 offen offset:3072 sc1
  v_accvgpr_read_b32 v243, a187
  v_mfma_f32_16x16x32_bf16 v[100:103], v[64:67], a[244:247], v[100:103]
  s_add_u32 s64, s64, 4096
  ds_read_b64_tr_b16 v[44:45], v13 offset:256
  v_cvt_pk_bf16_f32 v232, v236, v237
  v_mfma_f32_16x16x32_bf16 v[116:119], v[68:71], a[244:247], v[116:119]
  ds_read_b64_tr_b16 v[46:47], v13 offset:1280
  v_cvt_pk_bf16_f32 v233, v238, v239
  v_mfma_f32_16x16x32_bf16 v[132:135], v[72:75], a[244:247], v[132:135]
  s_add_u32 m0, s24, 16384
  ds_read_b64_tr_b16 v[48:49], v12 offset:512
  v_cvt_pk_bf16_f32 v234, v240, v241
  v_mfma_f32_16x16x32_bf16 v[148:151], v[76:79], a[244:247], v[148:151]
  buffer_load_dwordx4 v8, s[36:39], s27 offen offset:0 lds
  v_cvt_pk_bf16_f32 v235, v242, v243
  v_mfma_f32_16x16x32_bf16 v[164:167], v[80:83], a[244:247], v[164:167]
  ds_read_b64_tr_b16 v[50:51], v12 offset:1536
  v_mfma_f32_16x16x32_bf16 v[180:183], v[84:87], a[244:247], v[180:183]
  s_add_u32 s63, s63, s61
  ds_read_b64_tr_b16 v[52:53], v13 offset:512
  v_mfma_f32_16x16x32_bf16 v[196:199], v[88:91], a[244:247], v[196:199]
  ds_read_b64_tr_b16 v[54:55], v13 offset:1536
  v_mfma_f32_16x16x32_bf16 v[212:215], v[92:95], a[244:247], v[212:215]
  buffer_load_dwordx4 a[244:247], v2, s[40:43], s65 offen offset:3072 sc1
  v_mfma_f32_16x16x32_bf16 v[104:107], v[64:67], a[248:251], v[104:107]
  s_add_u32 s65, s65, 4096
  ds_read_b64_tr_b16 v[56:57], v12 offset:768
  v_accvgpr_read_b32 v248, a156
  v_mfma_f32_16x16x32_bf16 v[120:123], v[68:71], a[248:251], v[120:123]
  ds_read_b64_tr_b16 v[58:59], v12 offset:1792
  v_accvgpr_read_b32 v249, a157
  v_mfma_f32_16x16x32_bf16 v[136:139], v[72:75], a[248:251], v[136:139]
  ds_read_b64_tr_b16 v[60:61], v13 offset:768
  v_accvgpr_read_b32 v250, a158
  v_mfma_f32_16x16x32_bf16 v[152:155], v[76:79], a[248:251], v[152:155]
  buffer_load_dwordx4 v9, s[36:39], s27 offen offset:1024 lds
  v_accvgpr_read_b32 v251, a159
  v_mfma_f32_16x16x32_bf16 v[168:171], v[80:83], a[248:251], v[168:171]
  ds_read_b64_tr_b16 v[62:63], v13 offset:1792
  v_accvgpr_read_b32 v252, a188
  v_mfma_f32_16x16x32_bf16 v[184:187], v[84:87], a[248:251], v[184:187]
  buffer_store_dwordx4 v[232:235], v2, s[40:43], s63 offen offset:0 sc1
  v_accvgpr_read_b32 v253, a189
  v_mfma_f32_16x16x32_bf16 v[200:203], v[88:91], a[248:251], v[200:203]
  buffer_load_dwordx4 v10, s[36:39], s27 offen offset:2048 lds
  v_accvgpr_read_b32 v254, a190
  v_mfma_f32_16x16x32_bf16 v[216:219], v[92:95], a[248:251], v[216:219]
  buffer_load_dwordx4 a[248:251], v2, s[40:43], s66 offen offset:3072 sc1
  v_accvgpr_read_b32 v255, a191
  v_mfma_f32_16x16x32_bf16 v[108:111], v[64:67], a[252:255], v[108:111]
  s_add_u32 s66, s66, 4096
  v_cvt_pk_bf16_f32 v244, v248, v249
  v_mfma_f32_16x16x32_bf16 v[124:127], v[68:71], a[252:255], v[124:127]
  buffer_load_dwordx4 v11, s[36:39], s27 offen offset:3072 lds
  v_cvt_pk_bf16_f32 v245, v250, v251
  v_mfma_f32_16x16x32_bf16 v[140:143], v[72:75], a[252:255], v[140:143]
  s_add_u32 s27, s27, 524288
  v_cvt_pk_bf16_f32 v246, v252, v253
  v_mfma_f32_16x16x32_bf16 v[156:159], v[76:79], a[252:255], v[156:159]
  s_add_u32 s24, s24, 32768
  v_cvt_pk_bf16_f32 v247, v254, v255
  v_mfma_f32_16x16x32_bf16 v[172:175], v[80:83], a[252:255], v[172:175]
  s_and_b32 s24, s24, 0x1ffff
  v_mfma_f32_16x16x32_bf16 v[188:191], v[84:87], a[252:255], v[188:191]
  buffer_store_dwordx4 v[244:247], v2, s[40:43], s63 offen offset:1024 sc1
  v_mfma_f32_16x16x32_bf16 v[204:207], v[88:91], a[252:255], v[204:207]
  v_mfma_f32_16x16x32_bf16 v[220:223], v[92:95], a[252:255], v[220:223]
  s_waitcnt vmcnt(25) lgkmcnt(0)
  buffer_load_dwordx4 a[252:255], v2, s[40:43], s67 offen offset:3072 sc1
  v_mfma_f32_16x16x32_bf16 v[96:99], v[32:35], a[192:195], v[96:99]
  v_and_b32 v16, 15, v1
  v_mfma_f32_16x16x32_bf16 v[112:115], v[36:39], a[192:195], v[112:115]
  s_add_u32 s67, s67, 4096
  ds_read_b64_tr_b16 v[64:65], v12 offset:8192
  v_lshrrev_b32 v17, 4, v1
  v_mfma_f32_16x16x32_bf16 v[128:131], v[40:43], a[192:195], v[128:131]
  ds_read_b64_tr_b16 v[66:67], v12 offset:9216
  v_lshlrev_b32 v17, 2, v17
  v_mfma_f32_16x16x32_bf16 v[144:147], v[44:47], a[192:195], v[144:147]
  ds_read_b64_tr_b16 v[68:69], v13 offset:8192
  v_sub_u32 v16, v16, v17
  v_mfma_f32_16x16x32_bf16 v[160:163], v[48:51], a[192:195], v[160:163]
  ds_read_b64_tr_b16 v[70:71], v13 offset:9216
  v_cmp_le_i32 s[68:69], 0, v16
  v_mfma_f32_16x16x32_bf16 v[176:179], v[52:55], a[192:195], v[176:179]
  ds_read_b64_tr_b16 v[72:73], v12 offset:8448
  v_cmp_le_i32 s[70:71], 1, v16
  v_mfma_f32_16x16x32_bf16 v[192:195], v[56:59], a[192:195], v[192:195]
  ds_read_b64_tr_b16 v[74:75], v12 offset:9472
  v_cmp_le_i32 s[72:73], 2, v16
  v_mfma_f32_16x16x32_bf16 v[208:211], v[60:63], a[192:195], v[208:211]
  buffer_load_dwordx4 a[192:195], v2, s[40:43], s64 offen offset:0 sc1
  v_mfma_f32_16x16x32_bf16 v[100:103], v[32:35], a[196:199], v[100:103]
  ds_read_b64_tr_b16 v[76:77], v13 offset:8448
  v_mfma_f32_16x16x32_bf16 v[116:119], v[36:39], a[196:199], v[116:119]
  ds_read_b64_tr_b16 v[78:79], v13 offset:9472
  v_mfma_f32_16x16x32_bf16 v[132:135], v[40:43], a[196:199], v[132:135]
  ds_read_b64_tr_b16 v[80:81], v12 offset:8704
  v_mfma_f32_16x16x32_bf16 v[148:151], v[44:47], a[196:199], v[148:151]
  v_cmp_le_i32 s[74:75], 3, v16
  v_mfma_f32_16x16x32_bf16 v[164:167], v[48:51], a[196:199], v[164:167]
  ds_read_b64_tr_b16 v[82:83], v12 offset:9728
  v_mfma_f32_16x16x32_bf16 v[180:183], v[52:55], a[196:199], v[180:183]
  ds_read_b64_tr_b16 v[84:85], v13 offset:8704
  v_mfma_f32_16x16x32_bf16 v[196:199], v[56:59], a[196:199], v[196:199]
  ds_read_b64_tr_b16 v[86:87], v13 offset:9728
  v_mfma_f32_16x16x32_bf16 v[212:215], v[60:63], a[196:199], v[212:215]
  buffer_load_dwordx4 a[196:199], v2, s[40:43], s65 offen offset:0 sc1
  v_mfma_f32_16x16x32_bf16 v[104:107], v[32:35], a[200:203], v[104:107]
  ds_read_b64_tr_b16 v[88:89], v12 offset:8960
  v_mfma_f32_16x16x32_bf16 v[120:123], v[36:39], a[200:203], v[120:123]
  ds_read_b64_tr_b16 v[90:91], v12 offset:9984
  v_mfma_f32_16x16x32_bf16 v[136:139], v[40:43], a[200:203], v[136:139]
  ds_read_b64_tr_b16 v[92:93], v13 offset:8960
  v_mfma_f32_16x16x32_bf16 v[152:155], v[44:47], a[200:203], v[152:155]
  v_mov_b32 v4, 0xff800000
  v_mfma_f32_16x16x32_bf16 v[168:171], v[48:51], a[200:203], v[168:171]
  ds_read_b64_tr_b16 v[94:95], v13 offset:9984
  v_mfma_f32_16x16x32_bf16 v[184:187], v[52:55], a[200:203], v[184:187]
  v_and_b32 v230, 7, v1
  v_mfma_f32_16x16x32_bf16 v[200:203], v[56:59], a[200:203], v[200:203]
  v_lshlrev_b32 v230, 2, v230
  v_mfma_f32_16x16x32_bf16 v[216:219], v[60:63], a[200:203], v[216:219]
  buffer_load_dwordx4 a[200:203], v2, s[40:43], s66 offen offset:0 sc1
  v_mfma_f32_16x16x32_bf16 v[108:111], v[32:35], a[204:207], v[108:111]
  v_add_u32 v230, s30, v230
  v_mfma_f32_16x16x32_bf16 v[124:127], v[36:39], a[204:207], v[124:127]
  v_writelane_b32 v230, s31, 8
  v_mfma_f32_16x16x32_bf16 v[140:143], v[40:43], a[204:207], v[140:143]
  v_mov_b32 v18, 1073741824
  v_mfma_f32_16x16x32_bf16 v[156:159], v[44:47], a[204:207], v[156:159]
  v_mov_b32 v19, 1
  v_mfma_f32_16x16x32_bf16 v[172:175], v[48:51], a[204:207], v[172:175]
  v_writelane_b32 v18, s29, 0
  v_mfma_f32_16x16x32_bf16 v[188:191], v[52:55], a[204:207], v[188:191]
  v_accvgpr_write_b32 a0, 0
  v_mfma_f32_16x16x32_bf16 v[204:207], v[56:59], a[204:207], v[204:207]
  v_accvgpr_write_b32 a1, 0
  v_mfma_f32_16x16x32_bf16 v[220:223], v[60:63], a[204:207], v[220:223]
  s_waitcnt vmcnt(19) lgkmcnt(0)
  buffer_load_dwordx4 a[204:207], v2, s[40:43], s67 offen offset:0 sc1
  v_mfma_f32_16x16x32_bf16 v[96:99], v[64:67], a[208:211], v[96:99]
  s_barrier
  v_accvgpr_write_b32 a2, 0
  v_mfma_f32_16x16x32_bf16 v[112:115], v[68:71], a[208:211], v[112:115]
  ds_read_b64_tr_b16 v[32:33], v12 offset:32768
  v_accvgpr_write_b32 a3, 0
  v_mfma_f32_16x16x32_bf16 v[128:131], v[72:75], a[208:211], v[128:131]
  ds_read_b64_tr_b16 v[34:35], v12 offset:33792
  v_accvgpr_write_b32 a4, 0
  v_mfma_f32_16x16x32_bf16 v[144:147], v[76:79], a[208:211], v[144:147]
  ds_read_b64_tr_b16 v[36:37], v13 offset:32768
  v_accvgpr_write_b32 a5, 0
  v_mfma_f32_16x16x32_bf16 v[160:163], v[80:83], a[208:211], v[160:163]
  ds_read_b64_tr_b16 v[38:39], v13 offset:33792
  v_accvgpr_write_b32 a6, 0
  v_mfma_f32_16x16x32_bf16 v[176:179], v[84:87], a[208:211], v[176:179]
  ds_read_b64_tr_b16 v[40:41], v12 offset:33024
  v_accvgpr_write_b32 a7, 0
  v_mfma_f32_16x16x32_bf16 v[192:195], v[88:91], a[208:211], v[192:195]
  ds_read_b64_tr_b16 v[42:43], v12 offset:34048
  v_accvgpr_write_b32 a8, 0
  v_mfma_f32_16x16x32_bf16 v[208:211], v[92:95], a[208:211], v[208:211]
  buffer_load_dwordx4 a[208:211], v2, s[40:43], s64 offen offset:1024 sc1
  v_mfma_f32_16x16x32_bf16 v[100:103], v[64:67], a[212:215], v[100:103]
  ds_read_b64_tr_b16 v[44:45], v13 offset:33024
  v_mfma_f32_16x16x32_bf16 v[116:119], v[68:71], a[212:215], v[116:119]
  ds_read_b64_tr_b16 v[46:47], v13 offset:34048
  v_mfma_f32_16x16x32_bf16 v[132:135], v[72:75], a[212:215], v[132:135]
  ds_read_b64_tr_b16 v[48:49], v12 offset:33280
  v_mfma_f32_16x16x32_bf16 v[148:151], v[76:79], a[212:215], v[148:151]
  v_accvgpr_write_b32 a9, 0
  v_mfma_f32_16x16x32_bf16 v[164:167], v[80:83], a[212:215], v[164:167]
  ds_read_b64_tr_b16 v[50:51], v12 offset:34304
  v_mfma_f32_16x16x32_bf16 v[180:183], v[84:87], a[212:215], v[180:183]
  ds_read_b64_tr_b16 v[52:53], v13 offset:33280
  v_mfma_f32_16x16x32_bf16 v[196:199], v[88:91], a[212:215], v[196:199]
  ds_read_b64_tr_b16 v[54:55], v13 offset:34304
  v_mfma_f32_16x16x32_bf16 v[212:215], v[92:95], a[212:215], v[212:215]
  buffer_load_dwordx4 a[212:215], v2, s[40:43], s65 offen offset:1024 sc1
  v_mfma_f32_16x16x32_bf16 v[104:107], v[64:67], a[216:219], v[104:107]
  ds_read_b64_tr_b16 v[56:57], v12 offset:33536
  v_mfma_f32_16x16x32_bf16 v[120:123], v[68:71], a[216:219], v[120:123]
  ds_read_b64_tr_b16 v[58:59], v12 offset:34560
  v_mfma_f32_16x16x32_bf16 v[136:139], v[72:75], a[216:219], v[136:139]
  ds_read_b64_tr_b16 v[60:61], v13 offset:33536
  v_mfma_f32_16x16x32_bf16 v[152:155], v[76:79], a[216:219], v[152:155]
  v_accvgpr_write_b32 a10, 0
  v_mfma_f32_16x16x32_bf16 v[168:171], v[80:83], a[216:219], v[168:171]
  ds_read_b64_tr_b16 v[62:63], v13 offset:34560
  v_mfma_f32_16x16x32_bf16 v[184:187], v[84:87], a[216:219], v[184:187]
  v_accvgpr_write_b32 a11, 0
  v_mfma_f32_16x16x32_bf16 v[200:203], v[88:91], a[216:219], v[200:203]
  v_accvgpr_write_b32 a12, 0
  v_mfma_f32_16x16x32_bf16 v[216:219], v[92:95], a[216:219], v[216:219]
  buffer_load_dwordx4 a[216:219], v2, s[40:43], s66 offen offset:1024 sc1
  v_mfma_f32_16x16x32_bf16 v[108:111], v[64:67], a[220:223], v[108:111]
  v_accvgpr_write_b32 a13, 0
  v_mfma_f32_16x16x32_bf16 v[124:127], v[68:71], a[220:223], v[124:127]
  v_accvgpr_write_b32 a14, 0
  v_mfma_f32_16x16x32_bf16 v[140:143], v[72:75], a[220:223], v[140:143]
  v_accvgpr_write_b32 a15, 0
  v_mfma_f32_16x16x32_bf16 v[156:159], v[76:79], a[220:223], v[156:159]
  v_accvgpr_write_b32 a16, 0
  v_mfma_f32_16x16x32_bf16 v[172:175], v[80:83], a[220:223], v[172:175]
  v_accvgpr_write_b32 a17, 0
  v_mfma_f32_16x16x32_bf16 v[188:191], v[84:87], a[220:223], v[188:191]
  v_accvgpr_write_b32 a18, 0
  v_mfma_f32_16x16x32_bf16 v[204:207], v[88:91], a[220:223], v[204:207]
  v_accvgpr_write_b32 a19, 0
  v_mfma_f32_16x16x32_bf16 v[220:223], v[92:95], a[220:223], v[220:223]
  s_waitcnt vmcnt(17) lgkmcnt(0)
  buffer_load_dwordx4 a[220:223], v2, s[40:43], s67 offen offset:1024 sc1
  v_mfma_f32_16x16x32_bf16 v[96:99], v[32:35], a[224:227], v[96:99]
  v_accvgpr_write_b32 a20, 0
  v_mfma_f32_16x16x32_bf16 v[112:115], v[36:39], a[224:227], v[112:115]
  ds_read_b64_tr_b16 v[64:65], v12 offset:40960
  v_accvgpr_write_b32 a21, 0
  v_mfma_f32_16x16x32_bf16 v[128:131], v[40:43], a[224:227], v[128:131]
  ds_read_b64_tr_b16 v[66:67], v12 offset:41984
  v_accvgpr_write_b32 a22, 0
  v_mfma_f32_16x16x32_bf16 v[144:147], v[44:47], a[224:227], v[144:147]
  ds_read_b64_tr_b16 v[68:69], v13 offset:40960
  v_accvgpr_write_b32 a23, 0
  v_mfma_f32_16x16x32_bf16 v[160:163], v[48:51], a[224:227], v[160:163]
  ds_read_b64_tr_b16 v[70:71], v13 offset:41984
  v_accvgpr_write_b32 a24, 0
  v_mfma_f32_16x16x32_bf16 v[176:179], v[52:55], a[224:227], v[176:179]
  ds_read_b64_tr_b16 v[72:73], v12 offset:41216
  v_accvgpr_write_b32 a25, 0
  v_mfma_f32_16x16x32_bf16 v[192:195], v[56:59], a[224:227], v[192:195]
  ds_read_b64_tr_b16 v[74:75], v12 offset:42240
  v_accvgpr_write_b32 a26, 0
  v_mfma_f32_16x16x32_bf16 v[208:211], v[60:63], a[224:227], v[208:211]
  buffer_load_dwordx4 a[224:227], v2, s[40:43], s64 offen offset:2048 sc1
  v_accvgpr_write_b32 a27, 0
  v_mfma_f32_16x16x32_bf16 v[100:103], v[32:35], a[228:231], v[100:103]
  ds_read_b64_tr_b16 v[76:77], v13 offset:41216
  v_accvgpr_write_b32 a28, 0
  v_mfma_f32_16x16x32_bf16 v[116:119], v[36:39], a[228:231], v[116:119]
  ds_read_b64_tr_b16 v[78:79], v13 offset:42240
  v_mfma_f32_16x16x32_bf16 v[132:135], v[40:43], a[228:231], v[132:135]
  ds_read_b64_tr_b16 v[80:81], v12 offset:41472
  v_mfma_f32_16x16x32_bf16 v[148:151], v[44:47], a[228:231], v[148:151]
  v_accvgpr_write_b32 a29, 0
  v_mfma_f32_16x16x32_bf16 v[164:167], v[48:51], a[228:231], v[164:167]
  ds_read_b64_tr_b16 v[82:83], v12 offset:42496
  v_mfma_f32_16x16x32_bf16 v[180:183], v[52:55], a[228:231], v[180:183]
  ds_read_b64_tr_b16 v[84:85], v13 offset:41472
  v_mfma_f32_16x16x32_bf16 v[196:199], v[56:59], a[228:231], v[196:199]
  ds_read_b64_tr_b16 v[86:87], v13 offset:42496
  v_mfma_f32_16x16x32_bf16 v[212:215], v[60:63], a[228:231], v[212:215]
  buffer_load_dwordx4 a[228:231], v2, s[40:43], s65 offen offset:2048 sc1
  v_mfma_f32_16x16x32_bf16 v[104:107], v[32:35], a[232:235], v[104:107]
  ds_read_b64_tr_b16 v[88:89], v12 offset:41728
  v_mfma_f32_16x16x32_bf16 v[120:123], v[36:39], a[232:235], v[120:123]
  ds_read_b64_tr_b16 v[90:91], v12 offset:42752
  v_mfma_f32_16x16x32_bf16 v[136:139], v[40:43], a[232:235], v[136:139]
  ds_read_b64_tr_b16 v[92:93], v13 offset:41728
  v_mfma_f32_16x16x32_bf16 v[152:155], v[44:47], a[232:235], v[152:155]
  v_accvgpr_write_b32 a30, 0
  v_mfma_f32_16x16x32_bf16 v[168:171], v[48:51], a[232:235], v[168:171]
  ds_read_b64_tr_b16 v[94:95], v13 offset:42752
  v_mfma_f32_16x16x32_bf16 v[184:187], v[52:55], a[232:235], v[184:187]
  v_accvgpr_write_b32 a31, 0
  v_mfma_f32_16x16x32_bf16 v[200:203], v[56:59], a[232:235], v[200:203]
  v_accvgpr_write_b32 a32, 0
  v_mfma_f32_16x16x32_bf16 v[216:219], v[60:63], a[232:235], v[216:219]
  buffer_load_dwordx4 a[232:235], v2, s[40:43], s66 offen offset:2048 sc1
  v_mfma_f32_16x16x32_bf16 v[108:111], v[32:35], a[236:239], v[108:111]
  v_xor_b32 v12, 0x10000, v12
  v_mfma_f32_16x16x32_bf16 v[124:127], v[36:39], a[236:239], v[124:127]
  v_accvgpr_write_b32 a33, 0
  v_mfma_f32_16x16x32_bf16 v[140:143], v[40:43], a[236:239], v[140:143]
  v_xor_b32 v13, 0x10000, v13
  v_mfma_f32_16x16x32_bf16 v[156:159], v[44:47], a[236:239], v[156:159]
  v_accvgpr_write_b32 a34, 0
  v_mfma_f32_16x16x32_bf16 v[172:175], v[48:51], a[236:239], v[172:175]
  v_accvgpr_write_b32 a35, 0
  v_mfma_f32_16x16x32_bf16 v[188:191], v[52:55], a[236:239], v[188:191]
  v_accvgpr_write_b32 a36, 0
  v_mfma_f32_16x16x32_bf16 v[204:207], v[56:59], a[236:239], v[204:207]
  v_accvgpr_write_b32 a37, 0
  v_mfma_f32_16x16x32_bf16 v[220:223], v[60:63], a[236:239], v[220:223]
  s_waitcnt vmcnt(11) lgkmcnt(0)
  buffer_load_dwordx4 a[236:239], v2, s[40:43], s67 offen offset:2048 sc1
  v_mfma_f32_16x16x32_bf16 v[96:99], v[64:67], a[240:243], v[96:99]
  s_barrier
  v_accvgpr_write_b32 a38, 0
  v_mfma_f32_16x16x32_bf16 v[112:115], v[68:71], a[240:243], v[112:115]
  ds_read_b64_tr_b16 v[32:33], v12 offset:0
  v_accvgpr_write_b32 a39, 0
  v_mfma_f32_16x16x32_bf16 v[128:131], v[72:75], a[240:243], v[128:131]
  ds_read_b64_tr_b16 v[34:35], v12 offset:1024
  v_accvgpr_write_b32 a40, 0
  v_mfma_f32_16x16x32_bf16 v[144:147], v[76:79], a[240:243], v[144:147]
  ds_read_b64_tr_b16 v[36:37], v13 offset:0
  v_accvgpr_write_b32 a41, 0
  v_mfma_f32_16x16x32_bf16 v[160:163], v[80:83], a[240:243], v[160:163]
  ds_read_b64_tr_b16 v[38:39], v13 offset:1024
  v_accvgpr_write_b32 a42, 0
  v_mfma_f32_16x16x32_bf16 v[176:179], v[84:87], a[240:243], v[176:179]
  ds_read_b64_tr_b16 v[40:41], v12 offset:256
  v_accvgpr_write_b32 a43, 0
  v_mfma_f32_16x16x32_bf16 v[192:195], v[88:91], a[240:243], v[192:195]
  ds_read_b64_tr_b16 v[42:43], v12 offset:1280
  v_accvgpr_write_b32 a44, 0
  v_mfma_f32_16x16x32_bf16 v[208:211], v[92:95], a[240:243], v[208:211]
  buffer_load_dwordx4 a[240:243], v2, s[40:43], s64 offen offset:3072 sc1
  v_mfma_f32_16x16x32_bf16 v[100:103], v[64:67], a[244:247], v[100:103]
  s_add_u32 s64, s64, 4096
  ds_read_b64_tr_b16 v[44:45], v13 offset:256
  v_mfma_f32_16x16x32_bf16 v[116:119], v[68:71], a[244:247], v[116:119]
  ds_read_b64_tr_b16 v[46:47], v13 offset:1280
  v_mfma_f32_16x16x32_bf16 v[132:135], v[72:75], a[244:247], v[132:135]
  ds_read_b64_tr_b16 v[48:49], v12 offset:512
  v_mfma_f32_16x16x32_bf16 v[148:151], v[76:79], a[244:247], v[148:151]
  buffer_store_dword v19, v18, s[40:43], 0 offen sc1
  v_accvgpr_write_b32 a45, 0
  v_mfma_f32_16x16x32_bf16 v[164:167], v[80:83], a[244:247], v[164:167]
  ds_read_b64_tr_b16 v[50:51], v12 offset:1536
  v_mfma_f32_16x16x32_bf16 v[180:183], v[84:87], a[244:247], v[180:183]
  ds_read_b64_tr_b16 v[52:53], v13 offset:512
  v_mfma_f32_16x16x32_bf16 v[196:199], v[88:91], a[244:247], v[196:199]
  ds_read_b64_tr_b16 v[54:55], v13 offset:1536
  v_mfma_f32_16x16x32_bf16 v[212:215], v[92:95], a[244:247], v[212:215]
  buffer_load_dwordx4 a[244:247], v2, s[40:43], s65 offen offset:3072 sc1
  v_mfma_f32_16x16x32_bf16 v[104:107], v[64:67], a[248:251], v[104:107]
  s_add_u32 s65, s65, 4096
  ds_read_b64_tr_b16 v[56:57], v12 offset:768
  v_mfma_f32_16x16x32_bf16 v[120:123], v[68:71], a[248:251], v[120:123]
  ds_read_b64_tr_b16 v[58:59], v12 offset:1792
  v_mfma_f32_16x16x32_bf16 v[136:139], v[72:75], a[248:251], v[136:139]
  ds_read_b64_tr_b16 v[60:61], v13 offset:768
  v_mfma_f32_16x16x32_bf16 v[152:155], v[76:79], a[248:251], v[152:155]
  v_accvgpr_write_b32 a46, 0
  v_mfma_f32_16x16x32_bf16 v[168:171], v[80:83], a[248:251], v[168:171]
  ds_read_b64_tr_b16 v[62:63], v13 offset:1792
  v_mfma_f32_16x16x32_bf16 v[184:187], v[84:87], a[248:251], v[184:187]
  v_accvgpr_write_b32 a47, 0
  v_mfma_f32_16x16x32_bf16 v[200:203], v[88:91], a[248:251], v[200:203]
  v_accvgpr_write_b32 a48, 0
  v_mfma_f32_16x16x32_bf16 v[216:219], v[92:95], a[248:251], v[216:219]
  buffer_load_dwordx4 a[248:251], v2, s[40:43], s66 offen offset:3072 sc1
  v_mfma_f32_16x16x32_bf16 v[108:111], v[64:67], a[252:255], v[108:111]
  s_add_u32 s66, s66, 4096
  v_accvgpr_write_b32 a49, 0
  v_mfma_f32_16x16x32_bf16 v[124:127], v[68:71], a[252:255], v[124:127]
  v_accvgpr_write_b32 a50, 0
  v_mfma_f32_16x16x32_bf16 v[140:143], v[72:75], a[252:255], v[140:143]
  v_accvgpr_write_b32 a51, 0
  v_mfma_f32_16x16x32_bf16 v[156:159], v[76:79], a[252:255], v[156:159]
  v_accvgpr_write_b32 a52, 0
  v_mfma_f32_16x16x32_bf16 v[172:175], v[80:83], a[252:255], v[172:175]
  v_accvgpr_write_b32 a53, 0
  v_mfma_f32_16x16x32_bf16 v[188:191], v[84:87], a[252:255], v[188:191]
  v_accvgpr_write_b32 a54, 0
  v_mfma_f32_16x16x32_bf16 v[204:207], v[88:91], a[252:255], v[204:207]
  v_accvgpr_write_b32 a55, 0
  v_mfma_f32_16x16x32_bf16 v[220:223], v[92:95], a[252:255], v[220:223]
  s_waitcnt vmcnt(12) lgkmcnt(0)
  buffer_load_dwordx4 a[252:255], v2, s[40:43], s67 offen offset:3072 sc1
  v_mfma_f32_16x16x32_bf16 v[96:99], v[32:35], a[192:195], v[96:99]
  v_accvgpr_write_b32 a56, 0
  v_mfma_f32_16x16x32_bf16 v[112:115], v[36:39], a[192:195], v[112:115]
  s_add_u32 s67, s67, 4096
  ds_read_b64_tr_b16 v[64:65], v12 offset:8192
  v_accvgpr_write_b32 a57, 0
  v_mfma_f32_16x16x32_bf16 v[128:131], v[40:43], a[192:195], v[128:131]
  ds_read_b64_tr_b16 v[66:67], v12 offset:9216
  v_accvgpr_write_b32 a58, 0
  v_mfma_f32_16x16x32_bf16 v[144:147], v[44:47], a[192:195], v[144:147]
  ds_read_b64_tr_b16 v[68:69], v13 offset:8192
  v_accvgpr_write_b32 a59, 0
  v_mfma_f32_16x16x32_bf16 v[160:163], v[48:51], a[192:195], v[160:163]
  ds_read_b64_tr_b16 v[70:71], v13 offset:9216
  v_mfma_f32_16x16x32_bf16 v[176:179], v[52:55], a[192:195], v[176:179]
  ds_read_b64_tr_b16 v[72:73], v12 offset:8448
  v_mfma_f32_16x16x32_bf16 v[192:195], v[56:59], a[192:195], v[192:195]
  ds_read_b64_tr_b16 v[74:75], v12 offset:9472
  v_mfma_f32_16x16x32_bf16 v[208:211], v[60:63], a[192:195], v[208:211]
  v_accvgpr_write_b32 a60, 0
  v_mfma_f32_16x16x32_bf16 v[100:103], v[32:35], a[196:199], v[100:103]
  ds_read_b64_tr_b16 v[76:77], v13 offset:8448
  v_mfma_f32_16x16x32_bf16 v[116:119], v[36:39], a[196:199], v[116:119]
  ds_read_b64_tr_b16 v[78:79], v13 offset:9472
  v_mfma_f32_16x16x32_bf16 v[132:135], v[40:43], a[196:199], v[132:135]
  ds_read_b64_tr_b16 v[80:81], v12 offset:8704
  v_mfma_f32_16x16x32_bf16 v[148:151], v[44:47], a[196:199], v[148:151]
  v_accvgpr_write_b32 a61, 0
  v_mfma_f32_16x16x32_bf16 v[164:167], v[48:51], a[196:199], v[164:167]
  ds_read_b64_tr_b16 v[82:83], v12 offset:9728
  v_mfma_f32_16x16x32_bf16 v[180:183], v[52:55], a[196:199], v[180:183]
  ds_read_b64_tr_b16 v[84:85], v13 offset:8704
  v_mfma_f32_16x16x32_bf16 v[196:199], v[56:59], a[196:199], v[196:199]
  ds_read_b64_tr_b16 v[86:87], v13 offset:9728
  v_mfma_f32_16x16x32_bf16 v[212:215], v[60:63], a[196:199], v[212:215]
  v_accvgpr_write_b32 a62, 0
  v_mfma_f32_16x16x32_bf16 v[104:107], v[32:35], a[200:203], v[104:107]
  ds_read_b64_tr_b16 v[88:89], v12 offset:8960
  v_mfma_f32_16x16x32_bf16 v[120:123], v[36:39], a[200:203], v[120:123]
  ds_read_b64_tr_b16 v[90:91], v12 offset:9984
  v_mfma_f32_16x16x32_bf16 v[136:139], v[40:43], a[200:203], v[136:139]
  ds_read_b64_tr_b16 v[92:93], v13 offset:8960
  v_mfma_f32_16x16x32_bf16 v[152:155], v[44:47], a[200:203], v[152:155]
  v_accvgpr_write_b32 a63, 0
  v_mfma_f32_16x16x32_bf16 v[168:171], v[48:51], a[200:203], v[168:171]
  ds_read_b64_tr_b16 v[94:95], v13 offset:9984
  v_mfma_f32_16x16x32_bf16 v[184:187], v[52:55], a[200:203], v[184:187]
  v_accvgpr_write_b32 a64, 0
  v_mfma_f32_16x16x32_bf16 v[200:203], v[56:59], a[200:203], v[200:203]
  v_accvgpr_write_b32 a65, 0
  v_mfma_f32_16x16x32_bf16 v[216:219], v[60:63], a[200:203], v[216:219]
  v_accvgpr_write_b32 a66, 0
  v_mfma_f32_16x16x32_bf16 v[108:111], v[32:35], a[204:207], v[108:111]
  v_accvgpr_write_b32 a67, 0
  v_mfma_f32_16x16x32_bf16 v[124:127], v[36:39], a[204:207], v[124:127]
  v_accvgpr_write_b32 a68, 0
  v_mfma_f32_16x16x32_bf16 v[140:143], v[40:43], a[204:207], v[140:143]
  v_accvgpr_write_b32 a69, 0
  v_mfma_f32_16x16x32_bf16 v[156:159], v[44:47], a[204:207], v[156:159]
  v_accvgpr_write_b32 a70, 0
  v_mfma_f32_16x16x32_bf16 v[172:175], v[48:51], a[204:207], v[172:175]
  v_accvgpr_write_b32 a71, 0
  v_mfma_f32_16x16x32_bf16 v[188:191], v[52:55], a[204:207], v[188:191]
  v_accvgpr_write_b32 a72, 0
  v_mfma_f32_16x16x32_bf16 v[204:207], v[56:59], a[204:207], v[204:207]
  v_accvgpr_write_b32 a73, 0
  v_mfma_f32_16x16x32_bf16 v[220:223], v[60:63], a[204:207], v[220:223]
  s_waitcnt vmcnt(9) lgkmcnt(0)
  v_mfma_f32_16x16x32_bf16 v[96:99], v[64:67], a[208:211], v[96:99]
  s_barrier
  v_accvgpr_write_b32 a74, 0
  v_mfma_f32_16x16x32_bf16 v[112:115], v[68:71], a[208:211], v[112:115]
  ds_read_b64_tr_b16 v[32:33], v12 offset:32768
  v_accvgpr_write_b32 a75, 0
  v_mfma_f32_16x16x32_bf16 v[128:131], v[72:75], a[208:211], v[128:131]
  ds_read_b64_tr_b16 v[34:35], v12 offset:33792
  v_accvgpr_write_b32 a76, 0
  v_mfma_f32_16x16x32_bf16 v[144:147], v[76:79], a[208:211], v[144:147]
  ds_read_b64_tr_b16 v[36:37], v13 offset:32768
  v_accvgpr_write_b32 a77, 0
  v_mfma_f32_16x16x32_bf16 v[160:163], v[80:83], a[208:211], v[160:163]
  ds_read_b64_tr_b16 v[38:39], v13 offset:33792
  v_mfma_f32_16x16x32_bf16 v[176:179], v[84:87], a[208:211], v[176:179]
  ds_read_b64_tr_b16 v[40:41], v12 offset:33024
  v_mfma_f32_16x16x32_bf16 v[192:195], v[88:91], a[208:211], v[192:195]
  ds_read_b64_tr_b16 v[42:43], v12 offset:34048
  v_mfma_f32_16x16x32_bf16 v[208:211], v[92:95], a[208:211], v[208:211]
  v_accvgpr_write_b32 a78, 0
  v_mfma_f32_16x16x32_bf16 v[100:103], v[64:67], a[212:215], v[100:103]
  ds_read_b64_tr_b16 v[44:45], v13 offset:33024
  v_mfma_f32_16x16x32_bf16 v[116:119], v[68:71], a[212:215], v[116:119]
  ds_read_b64_tr_b16 v[46:47], v13 offset:34048
  v_mfma_f32_16x16x32_bf16 v[132:135], v[72:75], a[212:215], v[132:135]
  ds_read_b64_tr_b16 v[48:49], v12 offset:33280
  v_mfma_f32_16x16x32_bf16 v[148:151], v[76:79], a[212:215], v[148:151]
  v_accvgpr_write_b32 a79, 0
  v_mfma_f32_16x16x32_bf16 v[164:167], v[80:83], a[212:215], v[164:167]
  ds_read_b64_tr_b16 v[50:51], v12 offset:34304
  v_mfma_f32_16x16x32_bf16 v[180:183], v[84:87], a[212:215], v[180:183]
  ds_read_b64_tr_b16 v[52:53], v13 offset:33280
  v_mfma_f32_16x16x32_bf16 v[196:199], v[88:91], a[212:215], v[196:199]
  ds_read_b64_tr_b16 v[54:55], v13 offset:34304
  v_mfma_f32_16x16x32_bf16 v[212:215], v[92:95], a[212:215], v[212:215]
  v_accvgpr_write_b32 a80, 0
  v_mfma_f32_16x16x32_bf16 v[104:107], v[64:67], a[216:219], v[104:107]
  ds_read_b64_tr_b16 v[56:57], v12 offset:33536
  v_mfma_f32_16x16x32_bf16 v[120:123], v[68:71], a[216:219], v[120:123]
  ds_read_b64_tr_b16 v[58:59], v12 offset:34560
  v_mfma_f32_16x16x32_bf16 v[136:139], v[72:75], a[216:219], v[136:139]
  ds_read_b64_tr_b16 v[60:61], v13 offset:33536
  v_mfma_f32_16x16x32_bf16 v[152:155], v[76:79], a[216:219], v[152:155]
  v_accvgpr_write_b32 a81, 0
  v_mfma_f32_16x16x32_bf16 v[168:171], v[80:83], a[216:219], v[168:171]
  ds_read_b64_tr_b16 v[62:63], v13 offset:34560
  v_mfma_f32_16x16x32_bf16 v[184:187], v[84:87], a[216:219], v[184:187]
  buffer_load_dword v228, v230, s[40:43], 0 offen sc1
  v_accvgpr_write_b32 a82, 0
  v_mfma_f32_16x16x32_bf16 v[200:203], v[88:91], a[216:219], v[200:203]
  v_accvgpr_write_b32 a83, 0
  v_mfma_f32_16x16x32_bf16 v[216:219], v[92:95], a[216:219], v[216:219]
  v_accvgpr_write_b32 a84, 0
  v_mfma_f32_16x16x32_bf16 v[108:111], v[64:67], a[220:223], v[108:111]
  v_accvgpr_write_b32 a85, 0
  v_mfma_f32_16x16x32_bf16 v[124:127], v[68:71], a[220:223], v[124:127]
  v_accvgpr_write_b32 a86, 0
  v_mfma_f32_16x16x32_bf16 v[140:143], v[72:75], a[220:223], v[140:143]
  v_accvgpr_write_b32 a87, 0
  v_mfma_f32_16x16x32_bf16 v[156:159], v[76:79], a[220:223], v[156:159]
  v_accvgpr_write_b32 a88, 0
  v_mfma_f32_16x16x32_bf16 v[172:175], v[80:83], a[220:223], v[172:175]
  v_accvgpr_write_b32 a89, 0
  v_mfma_f32_16x16x32_bf16 v[188:191], v[84:87], a[220:223], v[188:191]
  v_accvgpr_write_b32 a90, 0
  v_mfma_f32_16x16x32_bf16 v[204:207], v[88:91], a[220:223], v[204:207]
  v_accvgpr_write_b32 a91, 0
  v_mfma_f32_16x16x32_bf16 v[220:223], v[92:95], a[220:223], v[220:223]
  s_waitcnt vmcnt(6) lgkmcnt(0)
  v_mfma_f32_16x16x32_bf16 v[96:99], v[32:35], a[224:227], v[96:99]
  v_accvgpr_write_b32 a92, 0
  v_mfma_f32_16x16x32_bf16 v[112:115], v[36:39], a[224:227], v[112:115]
  ds_read_b64_tr_b16 v[64:65], v12 offset:40960
  v_accvgpr_write_b32 a93, 0
  v_mfma_f32_16x16x32_bf16 v[128:131], v[40:43], a[224:227], v[128:131]
  ds_read_b64_tr_b16 v[66:67], v12 offset:41984
  v_accvgpr_write_b32 a94, 0
  v_mfma_f32_16x16x32_bf16 v[144:147], v[44:47], a[224:227], v[144:147]
  ds_read_b64_tr_b16 v[68:69], v13 offset:40960
  v_accvgpr_write_b32 a95, 0
  v_mfma_f32_16x16x32_bf16 v[160:163], v[48:51], a[224:227], v[160:163]
  ds_read_b64_tr_b16 v[70:71], v13 offset:41984
  v_accvgpr_write_b32 a96, 0
  v_mfma_f32_16x16x32_bf16 v[176:179], v[52:55], a[224:227], v[176:179]
  ds_read_b64_tr_b16 v[72:73], v12 offset:41216
  v_accvgpr_write_b32 a97, 0
  v_mfma_f32_16x16x32_bf16 v[192:195], v[56:59], a[224:227], v[192:195]
  ds_read_b64_tr_b16 v[74:75], v12 offset:42240
  v_mfma_f32_16x16x32_bf16 v[208:211], v[60:63], a[224:227], v[208:211]
  v_accvgpr_write_b32 a98, 0
  v_mfma_f32_16x16x32_bf16 v[100:103], v[32:35], a[228:231], v[100:103]
  ds_read_b64_tr_b16 v[76:77], v13 offset:41216
  v_mfma_f32_16x16x32_bf16 v[116:119], v[36:39], a[228:231], v[116:119]
  ds_read_b64_tr_b16 v[78:79], v13 offset:42240
  v_mfma_f32_16x16x32_bf16 v[132:135], v[40:43], a[228:231], v[132:135]
  ds_read_b64_tr_b16 v[80:81], v12 offset:41472
  v_mfma_f32_16x16x32_bf16 v[148:151], v[44:47], a[228:231], v[148:151]
  v_accvgpr_write_b32 a99, 0
  v_mfma_f32_16x16x32_bf16 v[164:167], v[48:51], a[228:231], v[164:167]
  ds_read_b64_tr_b16 v[82:83], v12 offset:42496
  v_mfma_f32_16x16x32_bf16 v[180:183], v[52:55], a[228:231], v[180:183]
  ds_read_b64_tr_b16 v[84:85], v13 offset:41472
  v_mfma_f32_16x16x32_bf16 v[196:199], v[56:59], a[228:231], v[196:199]
  ds_read_b64_tr_b16 v[86:87], v13 offset:42496
  v_mfma_f32_16x16x32_bf16 v[212:215], v[60:63], a[228:231], v[212:215]
  v_accvgpr_write_b32 a100, 0
  v_mfma_f32_16x16x32_bf16 v[104:107], v[32:35], a[232:235], v[104:107]
  ds_read_b64_tr_b16 v[88:89], v12 offset:41728
  v_mfma_f32_16x16x32_bf16 v[120:123], v[36:39], a[232:235], v[120:123]
  ds_read_b64_tr_b16 v[90:91], v12 offset:42752
  v_mfma_f32_16x16x32_bf16 v[136:139], v[40:43], a[232:235], v[136:139]
  ds_read_b64_tr_b16 v[92:93], v13 offset:41728
  v_mfma_f32_16x16x32_bf16 v[152:155], v[44:47], a[232:235], v[152:155]
  v_accvgpr_write_b32 a101, 0
  v_mfma_f32_16x16x32_bf16 v[168:171], v[48:51], a[232:235], v[168:171]
  ds_read_b64_tr_b16 v[94:95], v13 offset:42752
  v_mfma_f32_16x16x32_bf16 v[184:187], v[52:55], a[232:235], v[184:187]
  v_accvgpr_write_b32 a102, 0
  v_mfma_f32_16x16x32_bf16 v[200:203], v[56:59], a[232:235], v[200:203]
  v_accvgpr_write_b32 a103, 0
  v_mfma_f32_16x16x32_bf16 v[216:219], v[60:63], a[232:235], v[216:219]
  v_accvgpr_write_b32 a104, 0
  v_mfma_f32_16x16x32_bf16 v[108:111], v[32:35], a[236:239], v[108:111]
  v_xor_b32 v12, 0x10000, v12
  v_mfma_f32_16x16x32_bf16 v[124:127], v[36:39], a[236:239], v[124:127]
  v_accvgpr_write_b32 a105, 0
  v_mfma_f32_16x16x32_bf16 v[140:143], v[40:43], a[236:239], v[140:143]
  v_xor_b32 v13, 0x10000, v13
  v_mfma_f32_16x16x32_bf16 v[156:159], v[44:47], a[236:239], v[156:159]
  v_accvgpr_write_b32 a106, 0
  v_mfma_f32_16x16x32_bf16 v[172:175], v[48:51], a[236:239], v[172:175]
  v_accvgpr_write_b32 a107, 0
  v_mfma_f32_16x16x32_bf16 v[188:191], v[52:55], a[236:239], v[188:191]
  v_accvgpr_write_b32 a108, 0
  v_mfma_f32_16x16x32_bf16 v[204:207], v[56:59], a[236:239], v[204:207]
  v_accvgpr_write_b32 a109, 0
  v_mfma_f32_16x16x32_bf16 v[220:223], v[60:63], a[236:239], v[220:223]
  s_waitcnt vmcnt(1) lgkmcnt(0)
  v_mfma_f32_16x16x32_bf16 v[96:99], v[64:67], a[240:243], v[96:99]
  s_barrier
  v_accvgpr_write_b32 a110, 0
  v_mfma_f32_16x16x32_bf16 v[112:115], v[68:71], a[240:243], v[112:115]
  v_accvgpr_write_b32 a111, 0
  v_mfma_f32_16x16x32_bf16 v[128:131], v[72:75], a[240:243], v[128:131]
  v_accvgpr_write_b32 a112, 0
  v_mfma_f32_16x16x32_bf16 v[144:147], v[76:79], a[240:243], v[144:147]
  v_accvgpr_write_b32 a113, 0
  v_mfma_f32_16x16x32_bf16 v[160:163], v[80:83], a[240:243], v[160:163]
  v_accvgpr_write_b32 a114, 0
  v_mfma_f32_16x16x32_bf16 v[176:179], v[84:87], a[240:243], v[176:179]
  v_accvgpr_write_b32 a115, 0
  v_mfma_f32_16x16x32_bf16 v[192:195], v[88:91], a[240:243], v[192:195]
  v_accvgpr_write_b32 a116, 0
  v_mfma_f32_16x16x32_bf16 v[208:211], v[92:95], a[240:243], v[208:211]
  v_accvgpr_write_b32 a117, 0
  v_mfma_f32_16x16x32_bf16 v[100:103], v[64:67], a[244:247], v[100:103]
  v_accvgpr_write_b32 a118, 0
  v_mfma_f32_16x16x32_bf16 v[116:119], v[68:71], a[244:247], v[116:119]
  v_accvgpr_write_b32 a119, 0
  v_mfma_f32_16x16x32_bf16 v[132:135], v[72:75], a[244:247], v[132:135]
  v_accvgpr_write_b32 a120, 0
  v_mfma_f32_16x16x32_bf16 v[148:151], v[76:79], a[244:247], v[148:151]
  v_accvgpr_write_b32 a121, 0
  v_mfma_f32_16x16x32_bf16 v[164:167], v[80:83], a[244:247], v[164:167]
  v_accvgpr_write_b32 a122, 0
  v_mfma_f32_16x16x32_bf16 v[180:183], v[84:87], a[244:247], v[180:183]
  v_accvgpr_write_b32 a123, 0
  v_mfma_f32_16x16x32_bf16 v[196:199], v[88:91], a[244:247], v[196:199]
  v_accvgpr_write_b32 a124, 0
  v_mfma_f32_16x16x32_bf16 v[212:215], v[92:95], a[244:247], v[212:215]
  v_accvgpr_write_b32 a125, 0
  v_mfma_f32_16x16x32_bf16 v[104:107], v[64:67], a[248:251], v[104:107]
  v_accvgpr_write_b32 a126, 0
  v_mfma_f32_16x16x32_bf16 v[120:123], v[68:71], a[248:251], v[120:123]
  v_accvgpr_write_b32 a127, 0
  v_mfma_f32_16x16x32_bf16 v[136:139], v[72:75], a[248:251], v[136:139]
  v_mfma_f32_16x16x32_bf16 v[152:155], v[76:79], a[248:251], v[152:155]
  v_mfma_f32_16x16x32_bf16 v[168:171], v[80:83], a[248:251], v[168:171]
  v_mfma_f32_16x16x32_bf16 v[184:187], v[84:87], a[248:251], v[184:187]
  v_mfma_f32_16x16x32_bf16 v[200:203], v[88:91], a[248:251], v[200:203]
  v_mfma_f32_16x16x32_bf16 v[216:219], v[92:95], a[248:251], v[216:219]
  v_mfma_f32_16x16x32_bf16 v[108:111], v[64:67], a[252:255], v[108:111]
  v_mfma_f32_16x16x32_bf16 v[124:127], v[68:71], a[252:255], v[124:127]
  v_mfma_f32_16x16x32_bf16 v[140:143], v[72:75], a[252:255], v[140:143]
  v_mfma_f32_16x16x32_bf16 v[156:159], v[76:79], a[252:255], v[156:159]
  v_mfma_f32_16x16x32_bf16 v[172:175], v[80:83], a[252:255], v[172:175]
  v_mfma_f32_16x16x32_bf16 v[188:191], v[84:87], a[252:255], v[188:191]
  v_mfma_f32_16x16x32_bf16 v[204:207], v[88:91], a[252:255], v[204:207]
  v_mfma_f32_16x16x32_bf16 v[220:223], v[92:95], a[252:255], v[220:223]
  s_and_b32 s23, s20, 1
  s_lshl_b32 s23, s23, 12
  s_cmp_lt_u32 s20, 2
  s_cselect_b32 s24, 106496, 0
  s_add_u32 s24, s24, s23
  s_lshl_b32 s26, s20, 12
  s_mov_b32 s27, s26
  s_add_u32 s25, s27, 49152
  s_waitcnt vmcnt(0)
  v_cmp_eq_u32 vcc, 0, v228
  s_cbranch_vccnz fa_kv_spin
fa_kv_ok:
  v_and_b32 v16, 15, v1
  v_lshlrev_b32 v16, 2, v16
  s_mov_b32 s23, 2629632
  buffer_load_dword v15, v16, s[40:43], s23 offen sc1
  s_mov_b32 m0, s24
  s_nop 0
  buffer_load_dwordx4 v2, s[44:47], s26 offen offset:0 sc1 lds
  buffer_load_dwordx4 v2, s[44:47], s26 offen offset:1024 sc1 lds
  buffer_load_dwordx4 v2, s[44:47], s26 offen offset:2048 sc1 lds
  buffer_load_dwordx4 v2, s[44:47], s26 offen offset:3072 sc1 lds
  s_add_u32 s26, s26, 16384
  s_add_u32 s24, s24, 32768
  s_and_b32 s24, s24, 0x1ffff
  s_mov_b32 m0, s24
  s_nop 0
  buffer_load_dwordx4 v2, s[44:47], s26 offen offset:0 sc1 lds
  buffer_load_dwordx4 v2, s[44:47], s26 offen offset:1024 sc1 lds
  buffer_load_dwordx4 v2, s[44:47], s26 offen offset:2048 sc1 lds
  buffer_load_dwordx4 v2, s[44:47], s26 offen offset:3072 sc1 lds
  s_add_u32 s26, s26, 16384
  s_add_u32 s24, s24, 32768
  s_and_b32 s24, s24, 0x1ffff
  s_mov_b32 m0, s24
  s_nop 0
  buffer_load_dwordx4 v2, s[44:47], s26 offen offset:0 sc1 lds
  buffer_load_dwordx4 v2, s[44:47], s26 offen offset:1024 sc1 lds
  buffer_load_dwordx4 v2, s[44:47], s26 offen offset:2048 sc1 lds
  buffer_load_dwordx4 v2, s[44:47], s26 offen offset:3072 sc1 lds
  s_add_u32 s26, s26, 16384
  s_add_u32 s24, s24, 32768
  s_and_b32 s24, s24, 0x1ffff
  s_mov_b32 m0, s25
  s_nop 0
  buffer_load_dwordx4 v2, s[48:51], s27 offen offset:0 sc1 lds
  buffer_load_dwordx4 v2, s[48:51], s27 offen offset:1024 sc1 lds
  buffer_load_dwordx4 v2, s[48:51], s27 offen offset:2048 sc1 lds
  buffer_load_dwordx4 v2, s[48:51], s27 offen offset:3072 sc1 lds
  s_add_u32 s27, s27, 16384
  s_add_u32 s25, s25, 32768
  s_and_b32 s25, s25, 0x1ffff
  s_mov_b32 m0, s25
  s_nop 0
  buffer_load_dwordx4 v2, s[48:51], s27 offen offset:0 sc1 lds
  buffer_load_dwordx4 v2, s[48:51], s27 offen offset:1024 sc1 lds
  buffer_load_dwordx4 v2, s[48:51], s27 offen offset:2048 sc1 lds
  buffer_load_dwordx4 v2, s[48:51], s27 offen offset:3072 sc1 lds
  s_add_u32 s27, s27, 16384
  s_add_u32 s25, s25, 32768
  s_and_b32 s25, s25, 0x1ffff
  v_mov_b32 v16, 0x3e0293ee
  v_mov_b32 v17, 0x3e0293ee
  v_pk_mul_f32 v[96:97], v[96:97], v[16:17]
  v_pk_mul_f32 v[98:99], v[98:99], v[16:17]
  v_cvt_pk_bf16_f32 v32, v96, v97
  v_cvt_pk_bf16_f32 v33, v98, v99
  v_pk_mul_f32 v[112:113], v[112:113], v[16:17]
  v_pk_mul_f32 v[114:115], v[114:115], v[16:17]
  v_cvt_pk_bf16_f32 v34, v112, v113
  v_cvt_pk_bf16_f32 v35, v114, v115
  v_pk_mul_f32 v[100:101], v[100:101], v[16:17]
  v_pk_mul_f32 v[102:103], v[102:103], v[16:17]
  v_cvt_pk_bf16_f32 v36, v100, v101
  v_cvt_pk_bf16_f32 v37, v102, v103
  v_pk_mul_f32 v[116:117], v[116:117], v[16:17]
  v_pk_mul_f32 v[118:119], v[118:119], v[16:17]
  v_cvt_pk_bf16_f32 v38, v116, v117
  v_cvt_pk_bf16_f32 v39, v118, v119
  v_pk_mul_f32 v[128:129], v[128:129], v[16:17]
  v_pk_mul_f32 v[130:131], v[130:131], v[16:17]
  v_cvt_pk_bf16_f32 v40, v128, v129
  v_cvt_pk_bf16_f32 v41, v130, v131
  v_pk_mul_f32 v[144:145], v[144:145], v[16:17]
  v_pk_mul_f32 v[146:147], v[146:147], v[16:17]
  v_cvt_pk_bf16_f32 v42, v144, v145
  v_cvt_pk_bf16_f32 v43, v146, v147
  v_pk_mul_f32 v[132:133], v[132:133], v[16:17]
  v_pk_mul_f32 v[134:135], v[134:135], v[16:17]
  v_cvt_pk_bf16_f32 v44, v132, v133
  v_cvt_pk_bf16_f32 v45, v134, v135
  v_pk_mul_f32 v[148:149], v[148:149], v[16:17]
  v_pk_mul_f32 v[150:151], v[150:151], v[16:17]
  v_cvt_pk_bf16_f32 v46, v148, v149
  v_cvt_pk_bf16_f32 v47, v150, v151
  v_pk_mul_f32 v[160:161], v[160:161], v[16:17]
  v_pk_mul_f32 v[162:163], v[162:163], v[16:17]
  v_cvt_pk_bf16_f32 v48, v160, v161
  v_cvt_pk_bf16_f32 v49, v162, v163
  v_pk_mul_f32 v[176:177], v[176:177], v[16:17]
  v_pk_mul_f32 v[178:179], v[178:179], v[16:17]
  v_cvt_pk_bf16_f32 v50, v176, v177
  v_cvt_pk_bf16_f32 v51, v178, v179
  v_pk_mul_f32 v[164:165], v[164:165], v[16:17]
  v_pk_mul_f32 v[166:167], v[166:167], v[16:17]
  v_cvt_pk_bf16_f32 v52, v164, v165
  v_cvt_pk_bf16_f32 v53, v166, v167
  v_pk_mul_f32 v[180:181], v[180:181], v[16:17]
  v_pk_mul_f32 v[182:183], v[182:183], v[16:17]
  v_cvt_pk_bf16_f32 v54, v180, v181
  v_cvt_pk_bf16_f32 v55, v182, v183
  v_pk_mul_f32 v[192:193], v[192:193], v[16:17]
  v_pk_mul_f32 v[194:195], v[194:195], v[16:17]
  v_cvt_pk_bf16_f32 v56, v192, v193
  v_cvt_pk_bf16_f32 v57, v194, v195
  v_pk_mul_f32 v[208:209], v[208:209], v[16:17]
  v_pk_mul_f32 v[210:211], v[210:211], v[16:17]
  v_cvt_pk_bf16_f32 v58, v208, v209
  v_cvt_pk_bf16_f32 v59, v210, v211
  v_pk_mul_f32 v[196:197], v[196:197], v[16:17]
  v_pk_mul_f32 v[198:199], v[198:199], v[16:17]
  v_cvt_pk_bf16_f32 v60, v196, v197
  v_cvt_pk_bf16_f32 v61, v198, v199
  v_pk_mul_f32 v[212:213], v[212:213], v[16:17]
  v_pk_mul_f32 v[214:215], v[214:215], v[16:17]
  v_cvt_pk_bf16_f32 v62, v212, v213
  v_cvt_pk_bf16_f32 v63, v214, v215
  s_and_b32 s62, s2, 1
  s_lshl_b32 s62, s62, 2
  s_add_u32 s62, s62, s20
  s_lshr_b32 s63, s2, 1
  s_mul_i32 s23, s63, 40960
  s_mul_i32 s31, s62, 160
  s_add_u32 s23, s23, s31
  s_mul_i32 s34, s20, 5120
  s_add_u32 s34, s34, 131072
  v_add_u32 v20, 0, v1
  v_mul_u32_u24 v19, 6554, v20
  s_add_u32 m0, s34, 0
  v_lshrrev_b32 v19, 16, v19
  v_mul_u32_u24 v19, 1120, v19
  v_lshl_add_u32 v19, v20, 4, v19
  buffer_load_dwordx4 v19, s[52:55], s23 offen lds
  v_add_u32 v20, 64, v1
  v_mul_u32_u24 v19, 6554, v20
  s_add_u32 m0, s34, 1024
  v_lshrrev_b32 v19, 16, v19
  v_mul_u32_u24 v19, 1120, v19
  v_lshl_add_u32 v19, v20, 4, v19
  buffer_load_dwordx4 v19, s[52:55], s23 offen lds
  v_add_u32 v20, 128, v1
  v_mul_u32_u24 v19, 6554, v20
  s_add_u32 m0, s34, 2048
  v_lshrrev_b32 v19, 16, v19
  v_mul_u32_u24 v19, 1120, v19
  v_lshl_add_u32 v19, v20, 4, v19
  buffer_load_dwordx4 v19, s[52:55], s23 offen lds
  v_add_u32 v20, 192, v1
  v_mul_u32_u24 v19, 6554, v20
  s_add_u32 m0, s34, 3072
  v_lshrrev_b32 v19, 16, v19
  v_mul_u32_u24 v19, 1120, v19
  v_lshl_add_u32 v19, v20, 4, v19
  buffer_load_dwordx4 v19, s[52:55], s23 offen lds
  v_add_u32 v20, 256, v1
  v_mul_u32_u24 v19, 6554, v20
  s_add_u32 m0, s34, 4096
  v_lshrrev_b32 v19, 16, v19
  v_mul_u32_u24 v19, 1120, v19
  v_lshl_add_u32 v19, v20, 4, v19
  buffer_load_dwordx4 v19, s[52:55], s23 offen lds
  v_lshrrev_b32 v6, 2, v1
  v_mul_u32_u24 v6, 160, v6
  v_and_b32 v19, 3, v1
  v_lshl_add_u32 v6, v19, 3, v6
  v_add_u32 v6, s34, v6
  s_lshl_b32 s30, s62, 7
  s_add_u32 s30, s30, s63
  s_mul_i32 s30, s30, 5120
  s_add_u32 s30, s30, 4194304
  v_pk_mul_f32 v[104:105], v[104:105], v[16:17]
  v_pk_mul_f32 v[106:107], v[106:107], v[16:17]
  v_cvt_pk_bf16_f32 v64, v104, v105
  v_cvt_pk_bf16_f32 v65, v106, v107
  v_pk_mul_f32 v[120:121], v[120:121], v[16:17]
  v_pk_mul_f32 v[122:123], v[122:123], v[16:17]
  v_cvt_pk_bf16_f32 v66, v120, v121
  v_cvt_pk_bf16_f32 v67, v122, v123
  v_pk_mul_f32 v[108:109], v[108:109], v[16:17]
  v_pk_mul_f32 v[110:111], v[110:111], v[16:17]
  v_cvt_pk_bf16_f32 v68, v108, v109
  v_cvt_pk_bf16_f32 v69, v110, v111
  v_pk_mul_f32 v[124:125], v[124:125], v[16:17]
  v_pk_mul_f32 v[126:127], v[126:127], v[16:17]
  v_cvt_pk_bf16_f32 v70, v124, v125
  v_cvt_pk_bf16_f32 v71, v126, v127
  v_pk_mul_f32 v[136:137], v[136:137], v[16:17]
  v_pk_mul_f32 v[138:139], v[138:139], v[16:17]
  v_cvt_pk_bf16_f32 v72, v136, v137
  v_cvt_pk_bf16_f32 v73, v138, v139
  v_pk_mul_f32 v[152:153], v[152:153], v[16:17]
  v_pk_mul_f32 v[154:155], v[154:155], v[16:17]
  v_cvt_pk_bf16_f32 v74, v152, v153
  v_cvt_pk_bf16_f32 v75, v154, v155
  v_pk_mul_f32 v[140:141], v[140:141], v[16:17]
  v_pk_mul_f32 v[142:143], v[142:143], v[16:17]
  v_cvt_pk_bf16_f32 v76, v140, v141
  v_cvt_pk_bf16_f32 v77, v142, v143
  v_pk_mul_f32 v[156:157], v[156:157], v[16:17]
  v_pk_mul_f32 v[158:159], v[158:159], v[16:17]
  v_cvt_pk_bf16_f32 v78, v156, v157
  v_cvt_pk_bf16_f32 v79, v158, v159
  v_pk_mul_f32 v[168:169], v[168:169], v[16:17]
  v_pk_mul_f32 v[170:171], v[170:171], v[16:17]
  v_cvt_pk_bf16_f32 v80, v168, v169
  v_cvt_pk_bf16_f32 v81, v170, v171
  v_pk_mul_f32 v[184:185], v[184:185], v[16:17]
  v_pk_mul_f32 v[186:187], v[186:187], v[16:17]
  v_cvt_pk_bf16_f32 v82, v184, v185
  v_cvt_pk_bf16_f32 v83, v186, v187
  v_pk_mul_f32 v[172:173], v[172:173], v[16:17]
  v_pk_mul_f32 v[174:175], v[174:175], v[16:17]
  v_cvt_pk_bf16_f32 v84, v172, v173
  v_cvt_pk_bf16_f32 v85, v174, v175
  v_pk_mul_f32 v[188:189], v[188:189], v[16:17]
  v_pk_mul_f32 v[190:191], v[190:191], v[16:17]
  v_cvt_pk_bf16_f32 v86, v188, v189
  v_cvt_pk_bf16_f32 v87, v190, v191
  v_pk_mul_f32 v[200:201], v[200:201], v[16:17]
  v_pk_mul_f32 v[202:203], v[202:203], v[16:17]
  v_cvt_pk_bf16_f32 v88, v200, v201
  v_cvt_pk_bf16_f32 v89, v202, v203
  v_pk_mul_f32 v[216:217], v[216:217], v[16:17]
  v_pk_mul_f32 v[218:219], v[218:219], v[16:17]
  v_cvt_pk_bf16_f32 v90, v216, v217
  v_cvt_pk_bf16_f32 v91, v218, v219
  v_pk_mul_f32 v[204:205], v[204:205], v[16:17]
  v_pk_mul_f32 v[206:207], v[206:207], v[16:17]
  v_cvt_pk_bf16_f32 v92, v204, v205
  v_cvt_pk_bf16_f32 v93, v206, v207
  v_pk_mul_f32 v[220:221], v[220:221], v[16:17]
  v_pk_mul_f32 v[222:223], v[222:223], v[16:17]
  v_cvt_pk_bf16_f32 v94, v220, v221
  v_cvt_pk_bf16_f32 v95, v222, v223
  v_mov_b32 v228, 0
  v_mov_b32 v229, 0
  v_mov_b32 v230, 0
  v_mov_b32 v231, 0
  s_add_u32 s23, s20, 1
  s_lshr_b32 s23, s23, 1
  s_lshl_b32 s28, s22, 1
  s_add_u32 s28, s28, s23
  s_lshl_b32 s23, s22, 2
  s_sub_u32 s29, 28, s23
  s_and_b32 s23, s20, 1
  s_add_u32 s29, s29, s23
  v_mov_b32 v3, v2
  v_add_u32 v18, 106496, v2
  s_waitcnt vmcnt(17)
  s_barrier
  ds_read_b128 a[128:131], v18 offset:0
  ds_read_b128 a[132:135], v18 offset:1024
  ds_read_b128 a[136:139], v18 offset:2048
  ds_read_b128 a[140:143], v18 offset:3072
  ds_read_b128 a[144:147], v18 offset:4096
  ds_read_b128 a[148:151], v18 offset:5120
  ds_read_b128 a[152:155], v18 offset:6144
  ds_read_b128 a[156:159], v18 offset:7168
  s_mov_b32 s32, 0
  s_sub_u32 s23, s2, 192
  s_cmp_lt_u32 s23, 54
  s_cbranch_scc1 fa_fset
fa_fsetb:
  s_waitcnt lgkmcnt(0)
  v_mfma_f32_16x16x32_bf16 v[96:99], a[128:131], v[32:35], 0
  v_mfma_f32_16x16x32_bf16 v[104:107], a[128:131], v[36:39], 0
  v_mfma_f32_16x16x32_bf16 v[128:131], a[128:131], v[64:67], 0
  v_mfma_f32_16x16x32_bf16 v[136:139], a[128:131], v[68:71], 0
  s_mov_b32 m0, s24
  ds_read_b128 a[128:131], v3 offset:0
  v_mfma_f32_16x16x32_bf16 v[100:103], a[132:135], v[32:35], 0
  buffer_load_dwordx4 v2, s[44:47], s26 offen offset:0 sc1 lds
  v_mfma_f32_16x16x32_bf16 v[108:111], a[132:135], v[36:39], 0
  v_mfma_f32_16x16x32_bf16 v[132:135], a[132:135], v[64:67], 0
  v_mfma_f32_16x16x32_bf16 v[140:143], a[132:135], v[68:71], 0
  ds_read_b128 a[132:135], v3 offset:1024
  v_mfma_f32_16x16x32_bf16 v[96:99], a[136:139], v[40:43], v[96:99]
  v_mfma_f32_16x16x32_bf16 v[104:107], a[136:139], v[44:47], v[104:107]
  v_mfma_f32_16x16x32_bf16 v[128:131], a[136:139], v[72:75], v[128:131]
  buffer_load_dwordx4 v2, s[44:47], s26 offen offset:1024 sc1 lds
  v_mfma_f32_16x16x32_bf16 v[136:139], a[136:139], v[76:79], v[136:139]
  ds_read_b128 a[136:139], v3 offset:2048
  v_mfma_f32_16x16x32_bf16 v[100:103], a[140:143], v[40:43], v[100:103]
  v_mfma_f32_16x16x32_bf16 v[108:111], a[140:143], v[44:47], v[108:111]
  v_mfma_f32_16x16x32_bf16 v[132:135], a[140:143], v[72:75], v[132:135]
  v_mfma_f32_16x16x32_bf16 v[140:143], a[140:143], v[76:79], v[140:143]
  s_waitcnt lgkmcnt(3)
  ds_read_b128 a[140:143], v3 offset:3072
  v_mfma_f32_16x16x32_bf16 v[96:99], a[144:147], v[48:51], v[96:99]
  v_mfma_f32_16x16x32_bf16 v[104:107], a[144:147], v[52:55], v[104:107]
  v_mfma_f32_16x16x32_bf16 v[128:131], a[144:147], v[80:83], v[128:131]
  buffer_load_dwordx4 v2, s[44:47], s26 offen offset:2048 sc1 lds
  v_mfma_f32_16x16x32_bf16 v[136:139], a[144:147], v[84:87], v[136:139]
  ds_read_b128 a[144:147], v3 offset:4096
  v_mfma_f32_16x16x32_bf16 v[100:103], a[148:151], v[48:51], v[100:103]
  v_mfma_f32_16x16x32_bf16 v[108:111], a[148:151], v[52:55], v[108:111]
  v_mfma_f32_16x16x32_bf16 v[132:135], a[148:151], v[80:83], v[132:135]
  v_mfma_f32_16x16x32_bf16 v[140:143], a[148:151], v[84:87], v[140:143]
  ds_read_b128 a[148:151], v3 offset:5120
  v_mfma_f32_16x16x32_bf16 v[96:99], a[152:155], v[56:59], v[96:99]
  buffer_load_dwordx4 v2, s[44:47], s26 offen offset:3072 sc1 lds
  v_mfma_f32_16x16x32_bf16 v[104:107], a[152:155], v[60:63], v[104:107]
  s_add_u32 s26, s26, 16384
  v_mfma_f32_16x16x32_bf16 v[128:131], a[152:155], v[88:91], v[128:131]
  s_add_u32 s24, s24, 32768
  v_mfma_f32_16x16x32_bf16 v[136:139], a[152:155], v[92:95], v[136:139]
  s_and_b32 s24, s24, 0x1ffff
  ds_read_b128 a[152:155], v3 offset:6144
  v_mfma_f32_16x16x32_bf16 v[100:103], a[156:159], v[56:59], v[100:103]
  v_mfma_f32_16x16x32_bf16 v[108:111], a[156:159], v[60:63], v[108:111]
  v_mfma_f32_16x16x32_bf16 v[132:135], a[156:159], v[88:91], v[132:135]
  v_mfma_f32_16x16x32_bf16 v[140:143], a[156:159], v[92:95], v[140:143]
  s_waitcnt lgkmcnt(3)
  ds_read_b128 a[156:159], v3 offset:7168
  s_nop 7
  s_cmp_lg_u32 s28, 0
  s_cbranch_scc1 fa_nomask0
  v_cndmask_b32 v96, v4, v96, s[68:69]
  v_cndmask_b32 v97, v4, v97, s[70:71]
  v_cndmask_b32 v98, v4, v98, s[72:73]
  v_cndmask_b32 v99, v4, v99, s[74:75]
  v_mov_b32 v100, v4
  v_mov_b32 v101, v4
  v_mov_b32 v102, v4
  v_mov_b32 v103, v4
  v_cndmask_b32 v108, v4, v108, s[68:69]
  v_cndmask_b32 v109, v4, v109, s[70:71]
  v_cndmask_b32 v110, v4, v110, s[72:73]
  v_cndmask_b32 v111, v4, v111, s[74:75]
fa_nomask0:
  v_max3_f32 v16, v96, v97, v98
  v_max3_f32 v16, v16, v99, v100
  v_max3_f32 v16, v16, v101, v102
  v_max_f32 v16, v16, v103
  v_max3_f32 v17, v104, v105, v106
  v_max3_f32 v17, v17, v107, v108
  v_max3_f32 v17, v17, v109, v110
  v_max_f32 v17, v17, v111
  v_max3_f32 v18, v128, v129, v130
  v_max3_f32 v18, v18, v131, v132
  v_max3_f32 v18, v18, v133, v134
  v_max_f32 v18, v18, v135
  v_max3_f32 v19, v136, v137, v138
  v_max3_f32 v19, v19, v139, v140
  v_max3_f32 v19, v19, v141, v142
  v_max_f32 v19, v19, v143
  v_mov_b32 v20, v16
  v_mov_b32 v21, v17
  v_mov_b32 v22, v18
  v_mov_b32 v23, v19
  s_nop 0
  v_permlane16_swap_b32 v16, v20
  v_permlane16_swap_b32 v17, v21
  v_permlane16_swap_b32 v18, v22
  v_permlane16_swap_b32 v19, v23
  v_max_f32 v16, v16, v20
  v_max_f32 v17, v17, v21
  v_max_f32 v18, v18, v22
  v_max_f32 v19, v19, v23
  v_mov_b32 v20, v16
  v_mov_b32 v21, v17
  v_mov_b32 v22, v18
  v_mov_b32 v23, v19
  s_nop 0
  v_permlane32_swap_b32 v16, v20
  v_permlane32_swap_b32 v17, v21
  v_permlane32_swap_b32 v18, v22
  v_permlane32_swap_b32 v19, v23
  v_max_f32 v16, v16, v20
  v_max_f32 v17, v17, v21
  v_max_f32 v18, v18, v22
  v_max_f32 v19, v19, v23
  v_sub_f32 v192, 0, v16
  v_sub_f32 v193, 0, v16
  v_sub_f32 v194, 0, v16
  v_sub_f32 v195, 0, v16
  v_sub_f32 v196, 0, v17
  v_sub_f32 v197, 0, v17
  v_sub_f32 v198, 0, v17
  v_sub_f32 v199, 0, v17
  v_sub_f32 v200, 0, v18
  v_sub_f32 v201, 0, v18
  v_sub_f32 v202, 0, v18
  v_sub_f32 v203, 0, v18
  v_sub_f32 v204, 0, v19
  v_sub_f32 v205, 0, v19
  v_sub_f32 v206, 0, v19
  v_sub_f32 v207, 0, v19
  v_sub_f32 v96, v96, v16
  v_sub_f32 v97, v97, v16
  v_sub_f32 v98, v98, v16
  v_sub_f32 v99, v99, v16
  v_sub_f32 v100, v100, v16
  v_sub_f32 v101, v101, v16
  v_sub_f32 v102, v102, v16
  v_sub_f32 v103, v103, v16
  v_sub_f32 v104, v104, v17
  v_sub_f32 v105, v105, v17
  v_sub_f32 v106, v106, v17
  v_sub_f32 v107, v107, v17
  v_sub_f32 v108, v108, v17
  v_sub_f32 v109, v109, v17
  v_sub_f32 v110, v110, v17
  v_sub_f32 v111, v111, v17
  v_sub_f32 v128, v128, v18
  v_sub_f32 v129, v129, v18
  v_sub_f32 v130, v130, v18
  v_sub_f32 v131, v131, v18
  v_sub_f32 v132, v132, v18
  v_sub_f32 v133, v133, v18
  v_sub_f32 v134, v134, v18
  v_sub_f32 v135, v135, v18
  v_sub_f32 v136, v136, v19
  v_sub_f32 v137, v137, v19
  v_sub_f32 v138, v138, v19
  v_sub_f32 v139, v139, v19
  v_sub_f32 v140, v140, v19
  v_sub_f32 v141, v141, v19
  v_sub_f32 v142, v142, v19
  v_sub_f32 v143, v143, v19
  v_mfma_f32_16x16x32_bf16 v[112:115], a[128:131], v[32:35], v[192:195]
  v_exp_f32 v208, v96
  v_exp_f32 v209, v97
  v_mfma_f32_16x16x32_bf16 v[120:123], a[128:131], v[36:39], v[196:199]
  v_exp_f32 v210, v98
  v_exp_f32 v211, v99
  v_mfma_f32_16x16x32_bf16 v[144:147], a[128:131], v[64:67], v[200:203]
  v_exp_f32 v212, v100
  v_exp_f32 v213, v101
  v_mfma_f32_16x16x32_bf16 v[152:155], a[128:131], v[68:71], v[204:207]
  s_mov_b32 m0, s25
  ds_read_b128 a[128:131], v3 offset:8192
  v_exp_f32 v214, v102
  v_add_f32 v224, v208, v209
  v_mfma_f32_16x16x32_bf16 v[116:119], a[132:135], v[32:35], v[192:195]
  buffer_load_dwordx4 v2, s[48:51], s27 offen offset:0 sc1 lds
  v_exp_f32 v215, v103
  v_cvt_pk_bf16_f32 v160, v208, v209
  v_mfma_f32_16x16x32_bf16 v[124:127], a[132:135], v[36:39], v[196:199]
  v_exp_f32 v208, v104
  v_add_f32 v224, v224, v210
  v_add_f32 v224, v224, v211
  v_mfma_f32_16x16x32_bf16 v[148:151], a[132:135], v[64:67], v[200:203]
  v_exp_f32 v209, v105
  v_cvt_pk_bf16_f32 v161, v210, v211
  v_add_f32 v224, v224, v212
  v_mfma_f32_16x16x32_bf16 v[156:159], a[132:135], v[68:71], v[204:207]
  ds_read_b128 a[132:135], v3 offset:9216
  v_exp_f32 v210, v106
  v_mfma_f32_16x16x32_bf16 v[112:115], a[136:139], v[40:43], v[112:115]
  v_exp_f32 v211, v107
  v_add_f32 v224, v224, v213
  v_cvt_pk_bf16_f32 v162, v212, v213
  v_mfma_f32_16x16x32_bf16 v[120:123], a[136:139], v[44:47], v[120:123]
  v_exp_f32 v212, v108
  v_add_f32 v224, v224, v214
  v_add_f32 v224, v224, v215
  v_mfma_f32_16x16x32_bf16 v[144:147], a[136:139], v[72:75], v[144:147]
  buffer_load_dwordx4 v2, s[48:51], s27 offen offset:1024 sc1 lds
  v_exp_f32 v213, v109
  v_cvt_pk_bf16_f32 v163, v214, v215
  v_mfma_f32_16x16x32_bf16 v[152:155], a[136:139], v[76:79], v[152:155]
  ds_read_b128 a[136:139], v3 offset:10240
  v_exp_f32 v214, v110
  v_add_f32 v225, v208, v209
  v_mfma_f32_16x16x32_bf16 v[116:119], a[140:143], v[40:43], v[116:119]
  v_exp_f32 v215, v111
  v_exp_f32 v216, v128
  v_mfma_f32_16x16x32_bf16 v[124:127], a[140:143], v[44:47], v[124:127]
  v_exp_f32 v217, v129
  v_exp_f32 v218, v130
  v_mfma_f32_16x16x32_bf16 v[148:151], a[140:143], v[72:75], v[148:151]
  v_exp_f32 v219, v131
  v_exp_f32 v220, v132
  v_mfma_f32_16x16x32_bf16 v[156:159], a[140:143], v[76:79], v[156:159]
  s_waitcnt lgkmcnt(3)
  ds_read_b128 a[140:143], v3 offset:11264
  v_exp_f32 v221, v133
  v_cvt_pk_bf16_f32 v164, v208, v209
  v_mfma_f32_16x16x32_bf16 v[112:115], a[144:147], v[48:51], v[112:115]
  v_exp_f32 v222, v134
  v_exp_f32 v223, v135
  v_mfma_f32_16x16x32_bf16 v[120:123], a[144:147], v[52:55], v[120:123]
  v_add_f32 v225, v225, v210
  v_add_f32 v225, v225, v211
  v_cvt_pk_bf16_f32 v165, v210, v211
  v_add_f32 v225, v225, v212
  v_mfma_f32_16x16x32_bf16 v[144:147], a[144:147], v[80:83], v[144:147]
  buffer_load_dwordx4 v2, s[48:51], s27 offen offset:2048 sc1 lds
  v_add_f32 v225, v225, v213
  v_cvt_pk_bf16_f32 v166, v212, v213
  v_add_f32 v225, v225, v214
  v_mfma_f32_16x16x32_bf16 v[152:155], a[144:147], v[84:87], v[152:155]
  ds_read_b128 a[144:147], v3 offset:12288
  v_add_f32 v225, v225, v215
  v_cvt_pk_bf16_f32 v167, v214, v215
  v_add_f32 v226, v216, v217
  v_mfma_f32_16x16x32_bf16 v[116:119], a[148:151], v[48:51], v[116:119]
  v_cvt_pk_bf16_f32 v176, v216, v217
  v_exp_f32 v216, v136
  v_add_f32 v226, v226, v218
  v_mfma_f32_16x16x32_bf16 v[124:127], a[148:151], v[52:55], v[124:127]
  v_exp_f32 v217, v137
  v_add_f32 v226, v226, v219
  v_cvt_pk_bf16_f32 v177, v218, v219
  v_mfma_f32_16x16x32_bf16 v[148:151], a[148:151], v[80:83], v[148:151]
  v_exp_f32 v218, v138
  v_add_f32 v226, v226, v220
  v_add_f32 v226, v226, v221
  v_mfma_f32_16x16x32_bf16 v[156:159], a[148:151], v[84:87], v[156:159]
  ds_read_b128 a[148:151], v3 offset:13312
  v_exp_f32 v219, v139
  v_mfma_f32_16x16x32_bf16 v[112:115], a[152:155], v[56:59], v[112:115]
  buffer_load_dwordx4 v2, s[48:51], s27 offen offset:3072 sc1 lds
  v_cvt_pk_bf16_f32 v178, v220, v221
  v_exp_f32 v220, v140
  v_mfma_f32_16x16x32_bf16 v[120:123], a[152:155], v[60:63], v[120:123]
  s_add_u32 s27, s27, 16384
  v_add_f32 v226, v226, v222
  v_add_f32 v226, v226, v223
  v_cvt_pk_bf16_f32 v179, v222, v223
  v_add_f32 v227, v216, v217
  v_mfma_f32_16x16x32_bf16 v[144:147], a[152:155], v[88:91], v[144:147]
  s_add_u32 s25, s25, 32768
  v_exp_f32 v221, v141
  v_cvt_pk_bf16_f32 v180, v216, v217
  v_add_f32 v227, v227, v218
  v_mfma_f32_16x16x32_bf16 v[152:155], a[152:155], v[92:95], v[152:155]
  s_and_b32 s25, s25, 0x1ffff
  ds_read_b128 a[152:155], v3 offset:14336
  v_add_f32 v227, v227, v219
  v_cvt_pk_bf16_f32 v181, v218, v219
  v_max3_f32 v5, v224, v225, v226
  v_mfma_f32_16x16x32_bf16 v[116:119], a[156:159], v[56:59], v[116:119]
  v_exp_f32 v222, v142
  v_add_f32 v227, v227, v220
  v_add_f32 v227, v227, v221
  v_mfma_f32_16x16x32_bf16 v[124:127], a[156:159], v[60:63], v[124:127]
  v_exp_f32 v223, v143
  v_cvt_pk_bf16_f32 v182, v220, v221
  v_add_f32 v227, v227, v222
  v_mfma_f32_16x16x32_bf16 v[148:151], a[156:159], v[88:91], v[148:151]
  v_add_f32 v227, v227, v223
  v_cvt_pk_bf16_f32 v183, v222, v223
  v_max_f32 v5, v5, v227
  v_cmp_lt_f32 vcc, s81, v5
  v_mfma_f32_16x16x32_bf16 v[156:159], a[156:159], v[92:95], v[156:159]
  s_waitcnt lgkmcnt(3)
  s_cbranch_vccnz fa_stub0
fa_back0:
  ds_read_b128 a[156:159], v3 offset:15360
  v_add_f32 v228, v228, v224
  v_add_f32 v229, v229, v225
  v_add_f32 v230, v230, v226
  v_add_f32 v231, v231, v227
  v_add_u32 v3, 32768, v3
  v_and_b32 v3, 0x1ffff, v3
  s_waitcnt vmcnt(8)
  ds_read_b64_tr_b16 v[232:233], v6 offset:0
  ds_read_b64_tr_b16 v[234:235], v6 offset:2560
  ds_read_b64_tr_b16 v[236:237], v6 offset:32
  ds_read_b64_tr_b16 v[238:239], v6 offset:2592
  ds_read_b64_tr_b16 v[240:241], v6 offset:64
  ds_read_b64_tr_b16 v[242:243], v6 offset:2624
  ds_read_b64_tr_b16 v[244:245], v6 offset:96
  ds_read_b64_tr_b16 v[246:247], v6 offset:2656
  ds_read_b64_tr_b16 v[248:249], v6 offset:128
  ds_read_b64_tr_b16 v[250:251], v6 offset:2688
  s_add_u32 s31, s30, 4096
  s_waitcnt lgkmcnt(0)
  buffer_store_dwordx4 v[232:235], v2, s[40:43], s30 offen offset:0 sc1
  buffer_store_dwordx4 v[236:239], v2, s[40:43], s30 offen offset:1024 sc1
  buffer_store_dwordx4 v[240:243], v2, s[40:43], s30 offen offset:2048 sc1
  buffer_store_dwordx4 v[244:247], v2, s[40:43], s30 offen offset:3072 sc1
  buffer_store_dwordx4 v[248:251], v2, s[40:43], s31 offen offset:0 sc1
  s_cmp_eq_u32 s28, 0
  s_cbranch_scc1 fa_AV
  s_sub_u32 s28, s28, 1
  s_cmp_eq_u32 s28, 0
  s_cbranch_scc1 fa_Aexit
.p2align 6
fa_DD:
  v_mfma_f32_16x16x32_bf16 v[96:99], a[128:131], v[32:35], v[192:195]
  s_waitcnt vmcnt(12)
  v_exp_f32 v208, v112
  v_mfma_f32_16x16x32_bf16 v[104:107], a[128:131], v[36:39], v[196:199]
  s_barrier
  v_exp_f32 v209, v113
  v_mfma_f32_16x16x32_bf16 v[128:131], a[128:131], v[64:67], v[200:203]
  s_cmp_lg_u32 s32, 0
  ds_read_b128 a[160:163], v3 offset:16384
  v_add_f32 v224, v208, v209
  v_mfma_f32_16x16x32_bf16 v[136:139], a[128:131], v[68:71], v[204:207]
  s_cbranch_scc1 fa_fstub
fa_fback:
  v_exp_f32 v210, v114
  v_mfma_f32_16x16x32_bf16 v[100:103], a[132:135], v[32:35], v[192:195]
  ds_read_b128 a[164:167], v3 offset:17408
  v_cvt_pk_bf16_f32 v168, v208, v209
  v_mfma_f32_16x16x32_bf16 v[108:111], a[132:135], v[36:39], v[196:199]
  s_mov_b32 m0, s24
  v_exp_f32 v211, v115
  v_mfma_f32_16x16x32_bf16 v[132:135], a[132:135], v[64:67], v[200:203]
  buffer_load_dwordx4 v2, s[44:47], s26 offen offset:0 sc1 lds
  v_add_f32 v224, v224, v210
  v_add_f32 v224, v224, v211
  v_mfma_f32_16x16x32_bf16 v[140:143], a[132:135], v[68:71], v[204:207]
  v_exp_f32 v212, v116
  v_mfma_f32_16x16x32_bf16 v[96:99], a[136:139], v[40:43], v[96:99]
  ds_read_b128 a[168:171], v3 offset:18432
  v_cvt_pk_bf16_f32 v169, v210, v211
  v_mfma_f32_16x16x32_bf16 v[104:107], a[136:139], v[44:47], v[104:107]
  v_exp_f32 v213, v117
  v_mfma_f32_16x16x32_bf16 v[128:131], a[136:139], v[72:75], v[128:131]
  v_exp_f32 v214, v118
  v_mfma_f32_16x16x32_bf16 v[136:139], a[136:139], v[76:79], v[136:139]
  v_exp_f32 v215, v119
  v_mfma_f32_16x16x32_bf16 v[100:103], a[140:143], v[40:43], v[100:103]
  ds_read_b128 a[172:175], v3 offset:19456
  v_add_f32 v224, v224, v212
  v_mfma_f32_16x16x32_bf16 v[108:111], a[140:143], v[44:47], v[108:111]
  v_exp_f32 v208, v120
  v_mfma_f32_16x16x32_bf16 v[132:135], a[140:143], v[72:75], v[132:135]
  v_exp_f32 v209, v121
  v_mfma_f32_16x16x32_bf16 v[140:143], a[140:143], v[76:79], v[140:143]
  s_waitcnt lgkmcnt(4)
  v_exp_f32 v210, v122
  v_mfma_f32_16x16x32_bf16 v[96:99], a[144:147], v[48:51], v[96:99]
  ds_read_b128 a[176:179], v3 offset:20480
  v_add_f32 v224, v224, v213
  v_mfma_f32_16x16x32_bf16 v[104:107], a[144:147], v[52:55], v[104:107]
  v_exp_f32 v211, v123
  v_mfma_f32_16x16x32_bf16 v[128:131], a[144:147], v[80:83], v[128:131]
  v_cvt_pk_bf16_f32 v170, v212, v213
  v_add_f32 v224, v224, v214
  v_add_f32 v224, v224, v215
  v_mfma_f32_16x16x32_bf16 v[136:139], a[144:147], v[84:87], v[136:139]
  v_exp_f32 v212, v124
  v_mfma_f32_16x16x32_bf16 v[100:103], a[148:151], v[48:51], v[100:103]
  ds_read_b128 a[180:183], v3 offset:21504
  v_cvt_pk_bf16_f32 v171, v214, v215
  v_mfma_f32_16x16x32_bf16 v[108:111], a[148:151], v[52:55], v[108:111]
  v_exp_f32 v213, v125
  v_mfma_f32_16x16x32_bf16 v[132:135], a[148:151], v[80:83], v[132:135]
  buffer_load_dwordx4 v2, s[44:47], s26 offen offset:1024 sc1 lds
  v_add_f32 v225, v208, v209
  v_mfma_f32_16x16x32_bf16 v[140:143], a[148:151], v[84:87], v[140:143]
  v_exp_f32 v214, v126
  v_mfma_f32_16x16x32_bf16 v[96:99], a[152:155], v[56:59], v[96:99]
  ds_read_b128 a[184:187], v3 offset:22528
  v_cvt_pk_bf16_f32 v172, v208, v209
  v_mfma_f32_16x16x32_bf16 v[104:107], a[152:155], v[60:63], v[104:107]
  v_exp_f32 v215, v127
  v_mfma_f32_16x16x32_bf16 v[128:131], a[152:155], v[88:91], v[128:131]
  v_exp_f32 v216, v144
  v_mfma_f32_16x16x32_bf16 v[136:139], a[152:155], v[92:95], v[136:139]
  v_exp_f32 v217, v145
  v_mfma_f32_16x16x32_bf16 v[100:103], a[156:159], v[56:59], v[100:103]
  ds_read_b128 a[188:191], v3 offset:23552
  v_add_f32 v225, v225, v210
  v_mfma_f32_16x16x32_bf16 v[108:111], a[156:159], v[60:63], v[108:111]
  v_exp_f32 v218, v146
  v_mfma_f32_16x16x32_bf16 v[132:135], a[156:159], v[88:91], v[132:135]
  v_exp_f32 v219, v147
  v_mfma_f32_16x16x32_bf16 v[140:143], a[156:159], v[92:95], v[140:143]
  s_waitcnt lgkmcnt(4)
  v_exp_f32 v220, v148
  v_add_f32 v225, v225, v211
  v_mfma_f32_16x16x32_bf16 a[0:3], a[160:163], v[160:163], a[0:3]
  ds_read_b128 a[128:131], v3 offset:0
  v_cvt_pk_bf16_f32 v173, v210, v211
  v_mfma_f32_16x16x32_bf16 a[4:7], a[160:163], v[164:167], a[4:7]
  v_exp_f32 v221, v149
  v_mfma_f32_16x16x32_bf16 a[64:67], a[160:163], v[176:179], a[64:67]
  v_exp_f32 v222, v150
  v_mfma_f32_16x16x32_bf16 a[68:71], a[160:163], v[180:183], a[68:71]
  v_exp_f32 v223, v151
  v_mfma_f32_16x16x32_bf16 a[8:11], a[164:167], v[160:163], a[8:11]
  ds_read_b128 a[132:135], v3 offset:1024
  v_add_f32 v225, v225, v212
  v_mfma_f32_16x16x32_bf16 a[12:15], a[164:167], v[164:167], a[12:15]
  v_add_f32 v225, v225, v213
  v_cvt_pk_bf16_f32 v174, v212, v213
  v_mfma_f32_16x16x32_bf16 a[72:75], a[164:167], v[176:179], a[72:75]
  buffer_load_dwordx4 v2, s[44:47], s26 offen offset:2048 sc1 lds
  v_add_f32 v225, v225, v214
  v_mfma_f32_16x16x32_bf16 a[76:79], a[164:167], v[180:183], a[76:79]
  v_add_f32 v225, v225, v215
  v_cvt_pk_bf16_f32 v175, v214, v215
  v_mfma_f32_16x16x32_bf16 a[16:19], a[168:171], v[160:163], a[16:19]
  ds_read_b128 a[136:139], v3 offset:2048
  v_add_f32 v226, v216, v217
  v_mfma_f32_16x16x32_bf16 a[20:23], a[168:171], v[164:167], a[20:23]
  v_cvt_pk_bf16_f32 v184, v216, v217
  v_add_f32 v226, v226, v218
  v_mfma_f32_16x16x32_bf16 a[80:83], a[168:171], v[176:179], a[80:83]
  v_exp_f32 v216, v152
  v_mfma_f32_16x16x32_bf16 a[84:87], a[168:171], v[180:183], a[84:87]
  v_exp_f32 v217, v153
  v_mfma_f32_16x16x32_bf16 a[24:27], a[172:175], v[160:163], a[24:27]
  ds_read_b128 a[140:143], v3 offset:3072
  v_add_f32 v226, v226, v219
  v_cvt_pk_bf16_f32 v185, v218, v219
  v_mfma_f32_16x16x32_bf16 a[28:31], a[172:175], v[164:167], a[28:31]
  v_exp_f32 v218, v154
  v_mfma_f32_16x16x32_bf16 a[88:91], a[172:175], v[176:179], a[88:91]
  v_add_f32 v226, v226, v220
  v_add_f32 v226, v226, v221
  v_mfma_f32_16x16x32_bf16 a[92:95], a[172:175], v[180:183], a[92:95]
  s_waitcnt lgkmcnt(4)
  v_exp_f32 v219, v155
  v_mfma_f32_16x16x32_bf16 a[32:35], a[176:179], v[160:163], a[32:35]
  ds_read_b128 a[144:147], v3 offset:4096
  v_cvt_pk_bf16_f32 v186, v220, v221
  v_mfma_f32_16x16x32_bf16 a[36:39], a[176:179], v[164:167], a[36:39]
  v_exp_f32 v220, v156
  v_mfma_f32_16x16x32_bf16 a[96:99], a[176:179], v[176:179], a[96:99]
  v_add_f32 v226, v226, v222
  v_add_f32 v226, v226, v223
  v_mfma_f32_16x16x32_bf16 a[100:103], a[176:179], v[180:183], a[100:103]
  v_exp_f32 v221, v157
  v_mfma_f32_16x16x32_bf16 a[40:43], a[180:183], v[160:163], a[40:43]
  ds_read_b128 a[148:151], v3 offset:5120
  v_cvt_pk_bf16_f32 v187, v222, v223
  v_mfma_f32_16x16x32_bf16 a[44:47], a[180:183], v[164:167], a[44:47]
  v_exp_f32 v222, v158
  v_mfma_f32_16x16x32_bf16 a[104:107], a[180:183], v[176:179], a[104:107]
  buffer_load_dwordx4 v2, s[44:47], s26 offen offset:3072 sc1 lds
  v_add_f32 v227, v216, v217
  v_mfma_f32_16x16x32_bf16 a[108:111], a[180:183], v[180:183], a[108:111]
  s_add_u32 s26, s26, 16384
  v_exp_f32 v223, v159
  v_mfma_f32_16x16x32_bf16 a[48:51], a[184:187], v[160:163], a[48:51]
  s_add_u32 s24, s24, 32768
  ds_read_b128 a[152:155], v3 offset:6144
  v_cvt_pk_bf16_f32 v188, v216, v217
  v_add_f32 v227, v227, v218
  v_mfma_f32_16x16x32_bf16 a[52:55], a[184:187], v[164:167], a[52:55]
  s_and_b32 s24, s24, 0x1ffff
  v_add_f32 v227, v227, v219
  v_cvt_pk_bf16_f32 v189, v218, v219
  v_mfma_f32_16x16x32_bf16 a[112:115], a[184:187], v[176:179], a[112:115]
  v_max3_f32 v5, v224, v225, v226
  v_add_f32 v227, v227, v220
  v_mfma_f32_16x16x32_bf16 a[116:119], a[184:187], v[180:183], a[116:119]
  v_add_f32 v227, v227, v221
  v_cvt_pk_bf16_f32 v190, v220, v221
  v_mfma_f32_16x16x32_bf16 a[56:59], a[188:191], v[160:163], a[56:59]
  ds_read_b128 a[156:159], v3 offset:7168
  v_add_f32 v227, v227, v222
  v_mfma_f32_16x16x32_bf16 a[60:63], a[188:191], v[164:167], a[60:63]
  v_add_f32 v227, v227, v223
  v_cvt_pk_bf16_f32 v191, v222, v223
  v_mfma_f32_16x16x32_bf16 a[120:123], a[188:191], v[176:179], a[120:123]
  s_waitcnt lgkmcnt(4)
  v_max_f32 v5, v5, v227
  v_cmp_lt_f32 vcc, s81, v5
  v_mfma_f32_16x16x32_bf16 a[124:127], a[188:191], v[180:183], a[124:127]
  s_cbranch_vccnz fa_stub1
fa_back1:
  v_add_f32 v228, v228, v224
  v_add_f32 v229, v229, v225
  v_add_f32 v230, v230, v226
  v_add_f32 v231, v231, v227
  v_mfma_f32_16x16x32_bf16 v[112:115], a[128:131], v[32:35], v[192:195]
  ds_read_b128 a[160:163], v3 offset:24576
  v_exp_f32 v208, v96
  v_mfma_f32_16x16x32_bf16 v[120:123], a[128:131], v[36:39], v[196:199]
  v_exp_f32 v209, v97
  v_mfma_f32_16x16x32_bf16 v[144:147], a[128:131], v[64:67], v[200:203]
  v_exp_f32 v210, v98
  v_mfma_f32_16x16x32_bf16 v[152:155], a[128:131], v[68:71], v[204:207]
  v_exp_f32 v211, v99
  v_mfma_f32_16x16x32_bf16 v[116:119], a[132:135], v[32:35], v[192:195]
  ds_read_b128 a[164:167], v3 offset:25600
  v_mfma_f32_16x16x32_bf16 v[124:127], a[132:135], v[36:39], v[196:199]
  s_mov_b32 m0, s25
  v_exp_f32 v212, v100
  v_mfma_f32_16x16x32_bf16 v[148:151], a[132:135], v[64:67], v[200:203]
  buffer_load_dwordx4 v2, s[48:51], s27 offen offset:0 sc1 lds
  v_add_f32 v224, v208, v209
  v_cvt_pk_bf16_f32 v160, v208, v209
  v_mfma_f32_16x16x32_bf16 v[156:159], a[132:135], v[68:71], v[204:207]
  v_exp_f32 v213, v101
  v_mfma_f32_16x16x32_bf16 v[112:115], a[136:139], v[40:43], v[112:115]
  ds_read_b128 a[168:171], v3 offset:26624
  v_add_f32 v224, v224, v210
  v_mfma_f32_16x16x32_bf16 v[120:123], a[136:139], v[44:47], v[120:123]
  v_exp_f32 v214, v102
  v_mfma_f32_16x16x32_bf16 v[144:147], a[136:139], v[72:75], v[144:147]
  v_exp_f32 v215, v103
  v_mfma_f32_16x16x32_bf16 v[152:155], a[136:139], v[76:79], v[152:155]
  v_exp_f32 v208, v104
  v_mfma_f32_16x16x32_bf16 v[116:119], a[140:143], v[40:43], v[116:119]
  ds_read_b128 a[172:175], v3 offset:27648
  v_add_f32 v224, v224, v211
  v_mfma_f32_16x16x32_bf16 v[124:127], a[140:143], v[44:47], v[124:127]
  v_exp_f32 v209, v105
  v_mfma_f32_16x16x32_bf16 v[148:151], a[140:143], v[72:75], v[148:151]
  v_cvt_pk_bf16_f32 v161, v210, v211
  v_add_f32 v224, v224, v212
  v_mfma_f32_16x16x32_bf16 v[156:159], a[140:143], v[76:79], v[156:159]
  s_waitcnt lgkmcnt(4)
  v_exp_f32 v210, v106
  v_mfma_f32_16x16x32_bf16 v[112:115], a[144:147], v[48:51], v[112:115]
  ds_read_b128 a[176:179], v3 offset:28672
  v_add_f32 v224, v224, v213
  v_mfma_f32_16x16x32_bf16 v[120:123], a[144:147], v[52:55], v[120:123]
  v_exp_f32 v211, v107
  v_mfma_f32_16x16x32_bf16 v[144:147], a[144:147], v[80:83], v[144:147]
  v_cvt_pk_bf16_f32 v162, v212, v213
  v_add_f32 v224, v224, v214
  v_add_f32 v224, v224, v215
  v_mfma_f32_16x16x32_bf16 v[152:155], a[144:147], v[84:87], v[152:155]
  v_exp_f32 v212, v108
  v_mfma_f32_16x16x32_bf16 v[116:119], a[148:151], v[48:51], v[116:119]
  ds_read_b128 a[180:183], v3 offset:29696
  v_cvt_pk_bf16_f32 v163, v214, v215
  v_mfma_f32_16x16x32_bf16 v[124:127], a[148:151], v[52:55], v[124:127]
  v_exp_f32 v213, v109
  v_mfma_f32_16x16x32_bf16 v[148:151], a[148:151], v[80:83], v[148:151]
  buffer_load_dwordx4 v2, s[48:51], s27 offen offset:1024 sc1 lds
  v_add_f32 v225, v208, v209
  v_mfma_f32_16x16x32_bf16 v[156:159], a[148:151], v[84:87], v[156:159]
  v_exp_f32 v214, v110
  v_mfma_f32_16x16x32_bf16 v[112:115], a[152:155], v[56:59], v[112:115]
  ds_read_b128 a[184:187], v3 offset:30720
  v_cvt_pk_bf16_f32 v164, v208, v209
  v_mfma_f32_16x16x32_bf16 v[120:123], a[152:155], v[60:63], v[120:123]
  v_exp_f32 v215, v111
  v_mfma_f32_16x16x32_bf16 v[144:147], a[152:155], v[88:91], v[144:147]
  v_exp_f32 v216, v128
  v_mfma_f32_16x16x32_bf16 v[152:155], a[152:155], v[92:95], v[152:155]
  v_exp_f32 v217, v129
  v_mfma_f32_16x16x32_bf16 v[116:119], a[156:159], v[56:59], v[116:119]
  ds_read_b128 a[188:191], v3 offset:31744
  v_add_f32 v225, v225, v210
  v_mfma_f32_16x16x32_bf16 v[124:127], a[156:159], v[60:63], v[124:127]
  v_exp_f32 v218, v130
  v_mfma_f32_16x16x32_bf16 v[148:151], a[156:159], v[88:91], v[148:151]
  v_exp_f32 v219, v131
  v_mfma_f32_16x16x32_bf16 v[156:159], a[156:159], v[92:95], v[156:159]
  s_waitcnt lgkmcnt(4)
  v_exp_f32 v220, v132
  v_add_f32 v225, v225, v211
  v_mfma_f32_16x16x32_bf16 a[0:3], a[160:163], v[168:171], a[0:3]
  ds_read_b128 a[128:131], v3 offset:8192
  v_cvt_pk_bf16_f32 v165, v210, v211
  v_mfma_f32_16x16x32_bf16 a[4:7], a[160:163], v[172:175], a[4:7]
  v_exp_f32 v221, v133
  v_mfma_f32_16x16x32_bf16 a[64:67], a[160:163], v[184:187], a[64:67]
  v_exp_f32 v222, v134
  v_mfma_f32_16x16x32_bf16 a[68:71], a[160:163], v[188:191], a[68:71]
  v_exp_f32 v223, v135
  v_mfma_f32_16x16x32_bf16 a[8:11], a[164:167], v[168:171], a[8:11]
  ds_read_b128 a[132:135], v3 offset:9216
  v_add_f32 v225, v225, v212
  v_mfma_f32_16x16x32_bf16 a[12:15], a[164:167], v[172:175], a[12:15]
  v_add_f32 v225, v225, v213
  v_cvt_pk_bf16_f32 v166, v212, v213
  v_mfma_f32_16x16x32_bf16 a[72:75], a[164:167], v[184:187], a[72:75]
  buffer_load_dwordx4 v2, s[48:51], s27 offen offset:2048 sc1 lds
  v_add_f32 v225, v225, v214
  v_mfma_f32_16x16x32_bf16 a[76:79], a[164:167], v[188:191], a[76:79]
  v_add_f32 v225, v225, v215
  v_cvt_pk_bf16_f32 v167, v214, v215
  v_mfma_f32_16x16x32_bf16 a[16:19], a[168:171], v[168:171], a[16:19]
  ds_read_b128 a[136:139], v3 offset:10240
  v_add_f32 v226, v216, v217
  v_mfma_f32_16x16x32_bf16 a[20:23], a[168:171], v[172:175], a[20:23]
  v_cvt_pk_bf16_f32 v176, v216, v217
  v_add_f32 v226, v226, v218
  v_mfma_f32_16x16x32_bf16 a[80:83], a[168:171], v[184:187], a[80:83]
  v_exp_f32 v216, v136
  v_mfma_f32_16x16x32_bf16 a[84:87], a[168:171], v[188:191], a[84:87]
  v_exp_f32 v217, v137
  v_mfma_f32_16x16x32_bf16 a[24:27], a[172:175], v[168:171], a[24:27]
  ds_read_b128 a[140:143], v3 offset:11264
  v_add_f32 v226, v226, v219
  v_cvt_pk_bf16_f32 v177, v218, v219
  v_mfma_f32_16x16x32_bf16 a[28:31], a[172:175], v[172:175], a[28:31]
  v_exp_f32 v218, v138
  v_mfma_f32_16x16x32_bf16 a[88:91], a[172:175], v[184:187], a[88:91]
  v_add_f32 v226, v226, v220
  v_add_f32 v226, v226, v221
  v_mfma_f32_16x16x32_bf16 a[92:95], a[172:175], v[188:191], a[92:95]
  s_waitcnt lgkmcnt(4)
  v_exp_f32 v219, v139
  v_mfma_f32_16x16x32_bf16 a[32:35], a[176:179], v[168:171], a[32:35]
  ds_read_b128 a[144:147], v3 offset:12288
  v_cvt_pk_bf16_f32 v178, v220, v221
  v_mfma_f32_16x16x32_bf16 a[36:39], a[176:179], v[172:175], a[36:39]
  v_exp_f32 v220, v140
  v_mfma_f32_16x16x32_bf16 a[96:99], a[176:179], v[184:187], a[96:99]
  v_add_f32 v226, v226, v222
  v_add_f32 v226, v226, v223
  v_mfma_f32_16x16x32_bf16 a[100:103], a[176:179], v[188:191], a[100:103]
  v_exp_f32 v221, v141
  v_mfma_f32_16x16x32_bf16 a[40:43], a[180:183], v[168:171], a[40:43]
  ds_read_b128 a[148:151], v3 offset:13312
  v_cvt_pk_bf16_f32 v179, v222, v223
  v_mfma_f32_16x16x32_bf16 a[44:47], a[180:183], v[172:175], a[44:47]
  v_exp_f32 v222, v142
  v_mfma_f32_16x16x32_bf16 a[104:107], a[180:183], v[184:187], a[104:107]
  buffer_load_dwordx4 v2, s[48:51], s27 offen offset:3072 sc1 lds
  v_add_f32 v227, v216, v217
  v_mfma_f32_16x16x32_bf16 a[108:111], a[180:183], v[188:191], a[108:111]
  s_add_u32 s27, s27, 16384
  v_exp_f32 v223, v143
  v_mfma_f32_16x16x32_bf16 a[48:51], a[184:187], v[168:171], a[48:51]
  s_add_u32 s25, s25, 32768
  ds_read_b128 a[152:155], v3 offset:14336
  v_cvt_pk_bf16_f32 v180, v216, v217
  v_add_f32 v227, v227, v218
  v_mfma_f32_16x16x32_bf16 a[52:55], a[184:187], v[172:175], a[52:55]
  s_and_b32 s25, s25, 0x1ffff
  v_add_f32 v227, v227, v219
  v_cvt_pk_bf16_f32 v181, v218, v219
  v_mfma_f32_16x16x32_bf16 a[112:115], a[184:187], v[184:187], a[112:115]
  v_max3_f32 v5, v224, v225, v226
  v_add_f32 v227, v227, v220
  v_mfma_f32_16x16x32_bf16 a[116:119], a[184:187], v[188:191], a[116:119]
  v_add_f32 v227, v227, v221
  v_cvt_pk_bf16_f32 v182, v220, v221
  v_mfma_f32_16x16x32_bf16 a[56:59], a[188:191], v[168:171], a[56:59]
  ds_read_b128 a[156:159], v3 offset:15360
  v_add_f32 v227, v227, v222
  v_mfma_f32_16x16x32_bf16 a[60:63], a[188:191], v[172:175], a[60:63]
  s_sub_u32 s28, s28, 1
  v_add_f32 v227, v227, v223
  v_cvt_pk_bf16_f32 v183, v222, v223
  v_mfma_f32_16x16x32_bf16 a[120:123], a[188:191], v[184:187], a[120:123]
  s_waitcnt lgkmcnt(4)
  v_max_f32 v5, v5, v227
  v_cmp_lt_f32 vcc, s81, v5
  v_mfma_f32_16x16x32_bf16 a[124:127], a[188:191], v[188:191], a[124:127]
  s_cbranch_vccnz fa_stub2
fa_back2:
  v_add_f32 v228, v228, v224
  v_add_f32 v229, v229, v225
  v_add_f32 v230, v230, v226
  v_add_f32 v231, v231, v227
  v_add_u32 v3, 32768, v3
  v_and_b32 v3, 0x1ffff, v3
  s_cmp_lg_u32 s28, 0
  s_cbranch_scc1 fa_DD
fa_Aexit:
  s_bitcmp1_b32 s20, 0
  s_cbranch_scc1 fa_Aodd
  v_mfma_f32_16x16x32_bf16 v[96:99], a[128:131], v[32:35], v[192:195]
  s_waitcnt vmcnt(12)
  v_exp_f32 v208, v112
  v_mfma_f32_16x16x32_bf16 v[104:107], a[128:131], v[36:39], v[196:199]
  s_barrier
  v_exp_f32 v209, v113
  v_mfma_f32_16x16x32_bf16 v[128:131], a[128:131], v[64:67], v[200:203]
  ds_read_b128 a[160:163], v3 offset:16384
  v_add_f32 v224, v208, v209
  v_mfma_f32_16x16x32_bf16 v[136:139], a[128:131], v[68:71], v[204:207]
  v_exp_f32 v210, v114
  v_mfma_f32_16x16x32_bf16 v[100:103], a[132:135], v[32:35], v[192:195]
  ds_read_b128 a[164:167], v3 offset:17408
  v_cvt_pk_bf16_f32 v168, v208, v209
  v_mfma_f32_16x16x32_bf16 v[108:111], a[132:135], v[36:39], v[196:199]
  s_mov_b32 m0, s24
  v_exp_f32 v211, v115
  v_mfma_f32_16x16x32_bf16 v[132:135], a[132:135], v[64:67], v[200:203]
  buffer_load_dwordx4 v2, s[44:47], s26 offen offset:0 sc1 lds
  v_add_f32 v224, v224, v210
  v_add_f32 v224, v224, v211
  v_mfma_f32_16x16x32_bf16 v[140:143], a[132:135], v[68:71], v[204:207]
  v_exp_f32 v212, v116
  v_mfma_f32_16x16x32_bf16 v[96:99], a[136:139], v[40:43], v[96:99]
  ds_read_b128 a[168:171], v3 offset:18432
  v_cvt_pk_bf16_f32 v169, v210, v211
  v_mfma_f32_16x16x32_bf16 v[104:107], a[136:139], v[44:47], v[104:107]
  v_exp_f32 v213, v117
  v_mfma_f32_16x16x32_bf16 v[128:131], a[136:139], v[72:75], v[128:131]
  v_exp_f32 v214, v118
  v_mfma_f32_16x16x32_bf16 v[136:139], a[136:139], v[76:79], v[136:139]
  v_exp_f32 v215, v119
  v_mfma_f32_16x16x32_bf16 v[100:103], a[140:143], v[40:43], v[100:103]
  ds_read_b128 a[172:175], v3 offset:19456
  v_add_f32 v224, v224, v212
  v_mfma_f32_16x16x32_bf16 v[108:111], a[140:143], v[44:47], v[108:111]
  v_exp_f32 v208, v120
  v_mfma_f32_16x16x32_bf16 v[132:135], a[140:143], v[72:75], v[132:135]
  v_exp_f32 v209, v121
  v_mfma_f32_16x16x32_bf16 v[140:143], a[140:143], v[76:79], v[140:143]
  s_waitcnt lgkmcnt(4)
  v_exp_f32 v210, v122
  v_mfma_f32_16x16x32_bf16 v[96:99], a[144:147], v[48:51], v[96:99]
  ds_read_b128 a[176:179], v3 offset:20480
  v_add_f32 v224, v224, v213
  v_mfma_f32_16x16x32_bf16 v[104:107], a[144:147], v[52:55], v[104:107]
  v_exp_f32 v211, v123
  v_mfma_f32_16x16x32_bf16 v[128:131], a[144:147], v[80:83], v[128:131]
  v_cvt_pk_bf16_f32 v170, v212, v213
  v_add_f32 v224, v224, v214
  v_add_f32 v224, v224, v215
  v_mfma_f32_16x16x32_bf16 v[136:139], a[144:147], v[84:87], v[136:139]
  v_exp_f32 v212, v124
  v_mfma_f32_16x16x32_bf16 v[100:103], a[148:151], v[48:51], v[100:103]
  ds_read_b128 a[180:183], v3 offset:21504
  v_cvt_pk_bf16_f32 v171, v214, v215
  v_mfma_f32_16x16x32_bf16 v[108:111], a[148:151], v[52:55], v[108:111]
  v_exp_f32 v213, v125
  v_mfma_f32_16x16x32_bf16 v[132:135], a[148:151], v[80:83], v[132:135]
  buffer_load_dwordx4 v2, s[44:47], s26 offen offset:1024 sc1 lds
  v_add_f32 v225, v208, v209
  v_mfma_f32_16x16x32_bf16 v[140:143], a[148:151], v[84:87], v[140:143]
  v_exp_f32 v214, v126
  v_mfma_f32_16x16x32_bf16 v[96:99], a[152:155], v[56:59], v[96:99]
  ds_read_b128 a[184:187], v3 offset:22528
  v_cvt_pk_bf16_f32 v172, v208, v209
  v_mfma_f32_16x16x32_bf16 v[104:107], a[152:155], v[60:63], v[104:107]
  v_exp_f32 v215, v127
  v_mfma_f32_16x16x32_bf16 v[128:131], a[152:155], v[88:91], v[128:131]
  v_exp_f32 v216, v144
  v_mfma_f32_16x16x32_bf16 v[136:139], a[152:155], v[92:95], v[136:139]
  v_exp_f32 v217, v145
  v_mfma_f32_16x16x32_bf16 v[100:103], a[156:159], v[56:59], v[100:103]
  ds_read_b128 a[188:191], v3 offset:23552
  v_add_f32 v225, v225, v210
  v_mfma_f32_16x16x32_bf16 v[108:111], a[156:159], v[60:63], v[108:111]
  v_exp_f32 v218, v146
  v_mfma_f32_16x16x32_bf16 v[132:135], a[156:159], v[88:91], v[132:135]
  v_exp_f32 v219, v147
  v_mfma_f32_16x16x32_bf16 v[140:143], a[156:159], v[92:95], v[140:143]
  s_waitcnt lgkmcnt(4)
  v_exp_f32 v220, v148
  v_add_f32 v225, v225, v211
  v_mfma_f32_16x16x32_bf16 a[0:3], a[160:163], v[160:163], a[0:3]
  ds_read_b128 a[128:131], v3 offset:0
  v_cvt_pk_bf16_f32 v173, v210, v211
  v_mfma_f32_16x16x32_bf16 a[4:7], a[160:163], v[164:167], a[4:7]
  v_exp_f32 v221, v149
  v_mfma_f32_16x16x32_bf16 a[64:67], a[160:163], v[176:179], a[64:67]
  v_exp_f32 v222, v150
  v_mfma_f32_16x16x32_bf16 a[68:71], a[160:163], v[180:183], a[68:71]
  v_exp_f32 v223, v151
  v_mfma_f32_16x16x32_bf16 a[8:11], a[164:167], v[160:163], a[8:11]
  ds_read_b128 a[132:135], v3 offset:1024
  v_add_f32 v225, v225, v212
  v_mfma_f32_16x16x32_bf16 a[12:15], a[164:167], v[164:167], a[12:15]
  v_add_f32 v225, v225, v213
  v_cvt_pk_bf16_f32 v174, v212, v213
  v_mfma_f32_16x16x32_bf16 a[72:75], a[164:167], v[176:179], a[72:75]
  buffer_load_dwordx4 v2, s[44:47], s26 offen offset:2048 sc1 lds
  v_add_f32 v225, v225, v214
  v_mfma_f32_16x16x32_bf16 a[76:79], a[164:167], v[180:183], a[76:79]
  v_add_f32 v225, v225, v215
  v_cvt_pk_bf16_f32 v175, v214, v215
  v_mfma_f32_16x16x32_bf16 a[16:19], a[168:171], v[160:163], a[16:19]
  ds_read_b128 a[136:139], v3 offset:2048
  v_add_f32 v226, v216, v217
  v_mfma_f32_16x16x32_bf16 a[20:23], a[168:171], v[164:167], a[20:23]
  v_cvt_pk_bf16_f32 v184, v216, v217
  v_add_f32 v226, v226, v218
  v_mfma_f32_16x16x32_bf16 a[80:83], a[168:171], v[176:179], a[80:83]
  v_exp_f32 v216, v152
  v_mfma_f32_16x16x32_bf16 a[84:87], a[168:171], v[180:183], a[84:87]
  v_exp_f32 v217, v153
  v_mfma_f32_16x16x32_bf16 a[24:27], a[172:175], v[160:163], a[24:27]
  ds_read_b128 a[140:143], v3 offset:3072
  v_add_f32 v226, v226, v219
  v_cvt_pk_bf16_f32 v185, v218, v219
  v_mfma_f32_16x16x32_bf16 a[28:31], a[172:175], v[164:167], a[28:31]
  v_exp_f32 v218, v154
  v_mfma_f32_16x16x32_bf16 a[88:91], a[172:175], v[176:179], a[88:91]
  v_add_f32 v226, v226, v220
  v_add_f32 v226, v226, v221
  v_mfma_f32_16x16x32_bf16 a[92:95], a[172:175], v[180:183], a[92:95]
  s_waitcnt lgkmcnt(4)
  v_exp_f32 v219, v155
  v_mfma_f32_16x16x32_bf16 a[32:35], a[176:179], v[160:163], a[32:35]
  ds_read_b128 a[144:147], v3 offset:4096
  v_cvt_pk_bf16_f32 v186, v220, v221
  v_mfma_f32_16x16x32_bf16 a[36:39], a[176:179], v[164:167], a[36:39]
  v_exp_f32 v220, v156
  v_mfma_f32_16x16x32_bf16 a[96:99], a[176:179], v[176:179], a[96:99]
  v_add_f32 v226, v226, v222
  v_add_f32 v226, v226, v223
  v_mfma_f32_16x16x32_bf16 a[100:103], a[176:179], v[180:183], a[100:103]
  v_exp_f32 v221, v157
  v_mfma_f32_16x16x32_bf16 a[40:43], a[180:183], v[160:163], a[40:43]
  ds_read_b128 a[148:151], v3 offset:5120
  v_cvt_pk_bf16_f32 v187, v222, v223
  v_mfma_f32_16x16x32_bf16 a[44:47], a[180:183], v[164:167], a[44:47]
  v_exp_f32 v222, v158
  v_mfma_f32_16x16x32_bf16 a[104:107], a[180:183], v[176:179], a[104:107]
  buffer_load_dwordx4 v2, s[44:47], s26 offen offset:3072 sc1 lds
  v_add_f32 v227, v216, v217
  v_mfma_f32_16x16x32_bf16 a[108:111], a[180:183], v[180:183], a[108:111]
  s_add_u32 s26, s26, 16384
  v_exp_f32 v223, v159
  v_mfma_f32_16x16x32_bf16 a[48:51], a[184:187], v[160:163], a[48:51]
  s_add_u32 s24, s24, 32768
  ds_read_b128 a[152:155], v3 offset:6144
  v_cvt_pk_bf16_f32 v188, v216, v217
  v_add_f32 v227, v227, v218
  v_mfma_f32_16x16x32_bf16 a[52:55], a[184:187], v[164:167], a[52:55]
  s_and_b32 s24, s24, 0x1ffff
  v_add_f32 v227, v227, v219
  v_cvt_pk_bf16_f32 v189, v218, v219
  v_mfma_f32_16x16x32_bf16 a[112:115], a[184:187], v[176:179], a[112:115]
  v_max3_f32 v5, v224, v225, v226
  v_add_f32 v227, v227, v220
  v_mfma_f32_16x16x32_bf16 a[116:119], a[184:187], v[180:183], a[116:119]
  v_add_f32 v227, v227, v221
  v_cvt_pk_bf16_f32 v190, v220, v221
  v_mfma_f32_16x16x32_bf16 a[56:59], a[188:191], v[160:163], a[56:59]
  ds_read_b128 a[156:159], v3 offset:7168
  v_add_f32 v227, v227, v222
  v_mfma_f32_16x16x32_bf16 a[60:63], a[188:191], v[164:167], a[60:63]
  v_add_f32 v227, v227, v223
  v_cvt_pk_bf16_f32 v191, v222, v223
  v_mfma_f32_16x16x32_bf16 a[120:123], a[188:191], v[176:179], a[120:123]
  s_waitcnt lgkmcnt(4)
  v_max_f32 v5, v5, v227
  v_cmp_lt_f32 vcc, s81, v5
  v_mfma_f32_16x16x32_bf16 a[124:127], a[188:191], v[180:183], a[124:127]
  s_cbranch_vccnz fa_stub3
fa_back3:
  v_add_f32 v228, v228, v224
  v_add_f32 v229, v229, v225
  v_add_f32 v230, v230, v226
  v_add_f32 v231, v231, v227
  v_mfma_f32_16x16x32_bf16 v[144:147], a[128:131], v[64:67], v[200:203]
  ds_read_b128 a[160:163], v3 offset:24576
  v_cndmask_b32 v96, v4, v96, s[68:69]
  v_cndmask_b32 v97, v4, v97, s[70:71]
  v_mfma_f32_16x16x32_bf16 v[152:155], a[128:131], v[68:71], v[204:207]
  v_cndmask_b32 v98, v4, v98, s[72:73]
  v_cndmask_b32 v99, v4, v99, s[74:75]
  v_mov_b32 v100, v4
  v_mfma_f32_16x16x32_bf16 v[148:151], a[132:135], v[64:67], v[200:203]
  ds_read_b128 a[164:167], v3 offset:25600
  v_mov_b32 v101, v4
  v_mov_b32 v102, v4
  v_mfma_f32_16x16x32_bf16 v[156:159], a[132:135], v[68:71], v[204:207]
  v_mov_b32 v103, v4
  v_cndmask_b32 v108, v4, v108, s[68:69]
  v_cndmask_b32 v109, v4, v109, s[70:71]
  v_mfma_f32_16x16x32_bf16 v[144:147], a[136:139], v[72:75], v[144:147]
  ds_read_b128 a[168:171], v3 offset:26624
  v_cndmask_b32 v110, v4, v110, s[72:73]
  v_cndmask_b32 v111, v4, v111, s[74:75]
  v_mfma_f32_16x16x32_bf16 v[152:155], a[136:139], v[76:79], v[152:155]
  s_mov_b32 m0, s25
  v_exp_f32 v208, v96
  v_exp_f32 v209, v97
  v_mfma_f32_16x16x32_bf16 v[148:151], a[140:143], v[72:75], v[148:151]
  ds_read_b128 a[172:175], v3 offset:27648
  buffer_load_dwordx4 v2, s[48:51], s27 offen offset:0 sc1 lds
  v_mfma_f32_16x16x32_bf16 v[156:159], a[140:143], v[76:79], v[156:159]
  s_waitcnt lgkmcnt(4)
  v_exp_f32 v210, v98
  v_add_f32 v224, v208, v209
  v_mfma_f32_16x16x32_bf16 v[144:147], a[144:147], v[80:83], v[144:147]
  ds_read_b128 a[176:179], v3 offset:28672
  v_exp_f32 v211, v99
  v_mfma_f32_16x16x32_bf16 v[152:155], a[144:147], v[84:87], v[152:155]
  v_exp_f32 v212, v100
  v_cvt_pk_bf16_f32 v160, v208, v209
  v_mfma_f32_16x16x32_bf16 v[148:151], a[148:151], v[80:83], v[148:151]
  ds_read_b128 a[180:183], v3 offset:29696
  v_exp_f32 v213, v101
  v_mfma_f32_16x16x32_bf16 v[156:159], a[148:151], v[84:87], v[156:159]
  v_exp_f32 v214, v102
  v_add_f32 v224, v224, v210
  v_add_f32 v224, v224, v211
  v_mfma_f32_16x16x32_bf16 v[144:147], a[152:155], v[88:91], v[144:147]
  ds_read_b128 a[184:187], v3 offset:30720
  v_cvt_pk_bf16_f32 v161, v210, v211
  v_add_f32 v224, v224, v212
  v_mfma_f32_16x16x32_bf16 v[152:155], a[152:155], v[92:95], v[152:155]
  v_exp_f32 v215, v103
  v_add_f32 v224, v224, v213
  v_mfma_f32_16x16x32_bf16 v[148:151], a[156:159], v[88:91], v[148:151]
  ds_read_b128 a[188:191], v3 offset:31744
  v_cvt_pk_bf16_f32 v162, v212, v213
  v_add_f32 v224, v224, v214
  v_mfma_f32_16x16x32_bf16 v[156:159], a[156:159], v[92:95], v[156:159]
  s_waitcnt lgkmcnt(4)
  v_exp_f32 v208, v104
  v_add_f32 v224, v224, v215
  v_mfma_f32_16x16x32_bf16 a[0:3], a[160:163], v[168:171], a[0:3]
  ds_read_b128 a[128:131], v3 offset:8192
  v_cvt_pk_bf16_f32 v163, v214, v215
  v_exp_f32 v209, v105
  v_mfma_f32_16x16x32_bf16 a[4:7], a[160:163], v[172:175], a[4:7]
  v_exp_f32 v210, v106
  v_mfma_f32_16x16x32_bf16 a[64:67], a[160:163], v[184:187], a[64:67]
  buffer_load_dwordx4 v2, s[48:51], s27 offen offset:1024 sc1 lds
  v_exp_f32 v211, v107
  v_mfma_f32_16x16x32_bf16 a[68:71], a[160:163], v[188:191], a[68:71]
  v_exp_f32 v212, v108
  v_add_f32 v225, v208, v209
  v_mfma_f32_16x16x32_bf16 a[8:11], a[164:167], v[168:171], a[8:11]
  ds_read_b128 a[132:135], v3 offset:9216
  v_exp_f32 v213, v109
  v_mfma_f32_16x16x32_bf16 a[12:15], a[164:167], v[172:175], a[12:15]
  v_exp_f32 v214, v110
  v_cvt_pk_bf16_f32 v164, v208, v209
  v_mfma_f32_16x16x32_bf16 a[72:75], a[164:167], v[184:187], a[72:75]
  v_exp_f32 v215, v111
  v_add_f32 v225, v225, v210
  v_mfma_f32_16x16x32_bf16 a[76:79], a[164:167], v[188:191], a[76:79]
  v_exp_f32 v216, v128
  v_add_f32 v225, v225, v211
  v_mfma_f32_16x16x32_bf16 a[16:19], a[168:171], v[168:171], a[16:19]
  ds_read_b128 a[136:139], v3 offset:10240
  v_exp_f32 v217, v129
  v_mfma_f32_16x16x32_bf16 a[20:23], a[168:171], v[172:175], a[20:23]
  v_exp_f32 v218, v130
  v_cvt_pk_bf16_f32 v165, v210, v211
  v_mfma_f32_16x16x32_bf16 a[80:83], a[168:171], v[184:187], a[80:83]
  v_exp_f32 v219, v131
  v_add_f32 v225, v225, v212
  v_mfma_f32_16x16x32_bf16 a[84:87], a[168:171], v[188:191], a[84:87]
  v_exp_f32 v220, v132
  v_add_f32 v225, v225, v213
  v_mfma_f32_16x16x32_bf16 a[24:27], a[172:175], v[168:171], a[24:27]
  ds_read_b128 a[140:143], v3 offset:11264
  v_exp_f32 v221, v133
  v_mfma_f32_16x16x32_bf16 a[28:31], a[172:175], v[172:175], a[28:31]
  v_exp_f32 v222, v134
  v_cvt_pk_bf16_f32 v166, v212, v213
  v_mfma_f32_16x16x32_bf16 a[88:91], a[172:175], v[184:187], a[88:91]
  buffer_load_dwordx4 v2, s[48:51], s27 offen offset:2048 sc1 lds
  v_exp_f32 v223, v135
  v_mfma_f32_16x16x32_bf16 a[92:95], a[172:175], v[188:191], a[92:95]
  s_waitcnt lgkmcnt(4)
  v_add_f32 v225, v225, v214
  v_add_f32 v225, v225, v215
  v_cvt_pk_bf16_f32 v167, v214, v215
  v_mfma_f32_16x16x32_bf16 a[32:35], a[176:179], v[168:171], a[32:35]
  ds_read_b128 a[144:147], v3 offset:12288
  v_add_f32 v226, v216, v217
  v_cvt_pk_bf16_f32 v176, v216, v217
  v_mfma_f32_16x16x32_bf16 a[36:39], a[176:179], v[172:175], a[36:39]
  v_exp_f32 v216, v136
  v_add_f32 v226, v226, v218
  v_mfma_f32_16x16x32_bf16 a[96:99], a[176:179], v[184:187], a[96:99]
  v_exp_f32 v217, v137
  v_add_f32 v226, v226, v219
  v_mfma_f32_16x16x32_bf16 a[100:103], a[176:179], v[188:191], a[100:103]
  v_cvt_pk_bf16_f32 v177, v218, v219
  v_add_f32 v226, v226, v220
  v_add_f32 v226, v226, v221
  v_cvt_pk_bf16_f32 v178, v220, v221
  v_mfma_f32_16x16x32_bf16 a[40:43], a[180:183], v[168:171], a[40:43]
  ds_read_b128 a[148:151], v3 offset:13312
  v_add_f32 v226, v226, v222
  v_add_f32 v226, v226, v223
  v_mfma_f32_16x16x32_bf16 a[44:47], a[180:183], v[172:175], a[44:47]
  v_exp_f32 v218, v138
  v_cvt_pk_bf16_f32 v179, v222, v223
  v_mfma_f32_16x16x32_bf16 a[104:107], a[180:183], v[184:187], a[104:107]
  v_exp_f32 v219, v139
  v_add_f32 v227, v216, v217
  v_mfma_f32_16x16x32_bf16 a[108:111], a[180:183], v[188:191], a[108:111]
  v_exp_f32 v220, v140
  v_cvt_pk_bf16_f32 v180, v216, v217
  v_mfma_f32_16x16x32_bf16 a[48:51], a[184:187], v[168:171], a[48:51]
  ds_read_b128 a[152:155], v3 offset:14336
  v_add_f32 v227, v227, v218
  v_add_f32 v227, v227, v219
  v_mfma_f32_16x16x32_bf16 a[52:55], a[184:187], v[172:175], a[52:55]
  v_exp_f32 v221, v141
  v_cvt_pk_bf16_f32 v181, v218, v219
  v_mfma_f32_16x16x32_bf16 a[112:115], a[184:187], v[184:187], a[112:115]
  buffer_load_dwordx4 v2, s[48:51], s27 offen offset:3072 sc1 lds
  v_max3_f32 v5, v224, v225, v226
  v_add_f32 v227, v227, v220
  v_mfma_f32_16x16x32_bf16 a[116:119], a[184:187], v[188:191], a[116:119]
  s_add_u32 s27, s27, 16384
  v_exp_f32 v222, v142
  v_add_f32 v227, v227, v221
  v_mfma_f32_16x16x32_bf16 a[56:59], a[188:191], v[168:171], a[56:59]
  s_add_u32 s25, s25, 32768
  ds_read_b128 a[156:159], v3 offset:15360
  v_cvt_pk_bf16_f32 v182, v220, v221
  v_add_f32 v227, v227, v222
  v_mfma_f32_16x16x32_bf16 a[60:63], a[188:191], v[172:175], a[60:63]
  s_and_b32 s25, s25, 0x1ffff
  v_exp_f32 v223, v143
  v_mfma_f32_16x16x32_bf16 a[120:123], a[188:191], v[184:187], a[120:123]
  s_waitcnt lgkmcnt(4)
  v_add_f32 v227, v227, v223
  v_cvt_pk_bf16_f32 v183, v222, v223
  v_max_f32 v5, v5, v227
  v_cmp_lt_f32 vcc, s81, v5
  v_mfma_f32_16x16x32_bf16 a[124:127], a[188:191], v[188:191], a[124:127]
  s_cbranch_vccnz fa_stub4
fa_back4:
  v_add_f32 v228, v228, v224
  v_add_f32 v229, v229, v225
  v_add_f32 v230, v230, v226
  v_add_f32 v231, v231, v227
  v_add_u32 v3, 32768, v3
  v_and_b32 v3, 0x1ffff, v3
fa_AV:
  v_mfma_f32_16x16x32_bf16 v[128:131], a[128:131], v[64:67], v[200:203]
  s_waitcnt vmcnt(12)
  v_exp_f32 v216, v144
  v_mfma_f32_16x16x32_bf16 v[136:139], a[128:131], v[68:71], v[204:207]
  s_barrier
  v_exp_f32 v217, v145
  v_mfma_f32_16x16x32_bf16 v[132:135], a[132:135], v[64:67], v[200:203]
  ds_read_b128 a[160:163], v3 offset:16384
  ds_read_b128 a[164:167], v3 offset:17408
  v_mfma_f32_16x16x32_bf16 v[140:143], a[132:135], v[68:71], v[204:207]
  v_exp_f32 v218, v146
  v_mfma_f32_16x16x32_bf16 v[128:131], a[136:139], v[72:75], v[128:131]
  ds_read_b128 a[168:171], v3 offset:18432
  v_add_f32 v226, v216, v217
  v_mfma_f32_16x16x32_bf16 v[136:139], a[136:139], v[76:79], v[136:139]
  s_mov_b32 m0, s24
  v_exp_f32 v219, v147
  v_mfma_f32_16x16x32_bf16 v[132:135], a[140:143], v[72:75], v[132:135]
  ds_read_b128 a[172:175], v3 offset:19456
  buffer_load_dwordx4 v2, s[44:47], s26 offen offset:0 sc1 lds
  v_mfma_f32_16x16x32_bf16 v[140:143], a[140:143], v[76:79], v[140:143]
  s_waitcnt lgkmcnt(4)
  v_exp_f32 v220, v148
  v_mfma_f32_16x16x32_bf16 v[128:131], a[144:147], v[80:83], v[128:131]
  ds_read_b128 a[176:179], v3 offset:20480
  v_cvt_pk_bf16_f32 v184, v216, v217
  v_mfma_f32_16x16x32_bf16 v[136:139], a[144:147], v[84:87], v[136:139]
  v_exp_f32 v221, v149
  v_mfma_f32_16x16x32_bf16 v[132:135], a[148:151], v[80:83], v[132:135]
  ds_read_b128 a[180:183], v3 offset:21504
  v_add_f32 v226, v226, v218
  v_mfma_f32_16x16x32_bf16 v[140:143], a[148:151], v[84:87], v[140:143]
  v_exp_f32 v222, v150
  v_mfma_f32_16x16x32_bf16 v[128:131], a[152:155], v[88:91], v[128:131]
  ds_read_b128 a[184:187], v3 offset:22528
  v_add_f32 v226, v226, v219
  v_mfma_f32_16x16x32_bf16 v[136:139], a[152:155], v[92:95], v[136:139]
  v_exp_f32 v223, v151
  v_mfma_f32_16x16x32_bf16 v[132:135], a[156:159], v[88:91], v[132:135]
  ds_read_b128 a[188:191], v3 offset:23552
  v_cvt_pk_bf16_f32 v185, v218, v219
  v_mfma_f32_16x16x32_bf16 v[140:143], a[156:159], v[92:95], v[140:143]
  s_waitcnt lgkmcnt(4)
  v_exp_f32 v216, v152
  v_mfma_f32_16x16x32_bf16 a[0:3], a[160:163], v[160:163], a[0:3]
  ds_read_b128 a[128:131], v3 offset:0
  v_add_f32 v226, v226, v220
  v_mfma_f32_16x16x32_bf16 a[4:7], a[160:163], v[164:167], a[4:7]
  v_exp_f32 v217, v153
  v_mfma_f32_16x16x32_bf16 a[64:67], a[160:163], v[176:179], a[64:67]
  buffer_load_dwordx4 v2, s[44:47], s26 offen offset:1024 sc1 lds
  v_add_f32 v226, v226, v221
  v_mfma_f32_16x16x32_bf16 a[68:71], a[160:163], v[180:183], a[68:71]
  v_exp_f32 v218, v154
  v_mfma_f32_16x16x32_bf16 a[8:11], a[164:167], v[160:163], a[8:11]
  ds_read_b128 a[132:135], v3 offset:1024
  v_cvt_pk_bf16_f32 v186, v220, v221
  v_mfma_f32_16x16x32_bf16 a[12:15], a[164:167], v[164:167], a[12:15]
  v_exp_f32 v219, v155
  v_mfma_f32_16x16x32_bf16 a[72:75], a[164:167], v[176:179], a[72:75]
  v_exp_f32 v220, v156
  v_mfma_f32_16x16x32_bf16 a[76:79], a[164:167], v[180:183], a[76:79]
  v_add_f32 v226, v226, v222
  v_add_f32 v226, v226, v223
  v_mfma_f32_16x16x32_bf16 a[16:19], a[168:171], v[160:163], a[16:19]
  ds_read_b128 a[136:139], v3 offset:2048
  v_cvt_pk_bf16_f32 v187, v222, v223
  v_mfma_f32_16x16x32_bf16 a[20:23], a[168:171], v[164:167], a[20:23]
  v_exp_f32 v221, v157
  v_mfma_f32_16x16x32_bf16 a[80:83], a[168:171], v[176:179], a[80:83]
  v_exp_f32 v222, v158
  v_mfma_f32_16x16x32_bf16 a[84:87], a[168:171], v[180:183], a[84:87]
  v_exp_f32 v223, v159
  v_mfma_f32_16x16x32_bf16 a[24:27], a[172:175], v[160:163], a[24:27]
  ds_read_b128 a[140:143], v3 offset:3072
  v_add_f32 v227, v216, v217
  v_mfma_f32_16x16x32_bf16 a[28:31], a[172:175], v[164:167], a[28:31]
  v_cvt_pk_bf16_f32 v188, v216, v217
  v_add_f32 v227, v227, v218
  v_mfma_f32_16x16x32_bf16 a[88:91], a[172:175], v[176:179], a[88:91]
  buffer_load_dwordx4 v2, s[44:47], s26 offen offset:2048 sc1 lds
  v_add_f32 v227, v227, v219
  v_mfma_f32_16x16x32_bf16 a[92:95], a[172:175], v[180:183], a[92:95]
  s_waitcnt lgkmcnt(4)
  v_cvt_pk_bf16_f32 v189, v218, v219
  v_add_f32 v227, v227, v220
  v_mfma_f32_16x16x32_bf16 a[32:35], a[176:179], v[160:163], a[32:35]
  ds_read_b128 a[144:147], v3 offset:4096
  v_add_f32 v227, v227, v221
  v_mfma_f32_16x16x32_bf16 a[36:39], a[176:179], v[164:167], a[36:39]
  v_cvt_pk_bf16_f32 v190, v220, v221
  v_add_f32 v227, v227, v222
  v_mfma_f32_16x16x32_bf16 a[96:99], a[176:179], v[176:179], a[96:99]
  v_add_f32 v227, v227, v223
  v_cvt_pk_bf16_f32 v191, v222, v223
  v_mfma_f32_16x16x32_bf16 a[100:103], a[176:179], v[180:183], a[100:103]
  v_max_f32 v5, v226, v227
  v_cmp_lt_f32 vcc, s81, v5
  v_mfma_f32_16x16x32_bf16 a[40:43], a[180:183], v[160:163], a[40:43]
  ds_read_b128 a[148:151], v3 offset:5120
  v_mfma_f32_16x16x32_bf16 a[44:47], a[180:183], v[164:167], a[44:47]
  v_mfma_f32_16x16x32_bf16 a[104:107], a[180:183], v[176:179], a[104:107]
  v_mfma_f32_16x16x32_bf16 a[108:111], a[180:183], v[180:183], a[108:111]
  v_mfma_f32_16x16x32_bf16 a[48:51], a[184:187], v[160:163], a[48:51]
  ds_read_b128 a[152:155], v3 offset:6144
  v_mfma_f32_16x16x32_bf16 a[52:55], a[184:187], v[164:167], a[52:55]
  v_mfma_f32_16x16x32_bf16 a[112:115], a[184:187], v[176:179], a[112:115]
  buffer_load_dwordx4 v2, s[44:47], s26 offen offset:3072 sc1 lds
  v_mfma_f32_16x16x32_bf16 a[116:119], a[184:187], v[180:183], a[116:119]
  s_add_u32 s26, s26, 16384
  v_mfma_f32_16x16x32_bf16 a[56:59], a[188:191], v[160:163], a[56:59]
  s_add_u32 s24, s24, 32768
  ds_read_b128 a[156:159], v3 offset:7168
  v_mfma_f32_16x16x32_bf16 a[60:63], a[188:191], v[164:167], a[60:63]
  s_and_b32 s24, s24, 0x1ffff
  v_mfma_f32_16x16x32_bf16 a[120:123], a[188:191], v[176:179], a[120:123]
  s_waitcnt lgkmcnt(4)
  v_mfma_f32_16x16x32_bf16 a[124:127], a[188:191], v[180:183], a[124:127]
  s_cbranch_vccnz fa_stub5
fa_back5:
  v_add_f32 v230, v230, v226
  v_add_f32 v231, v231, v227
  v_mfma_f32_16x16x32_bf16 v[144:147], a[128:131], v[64:67], v[200:203]
  ds_read_b128 a[160:163], v3 offset:24576
  v_exp_f32 v216, v128
  v_mfma_f32_16x16x32_bf16 v[152:155], a[128:131], v[68:71], v[204:207]
  v_exp_f32 v217, v129
  v_mfma_f32_16x16x32_bf16 v[148:151], a[132:135], v[64:67], v[200:203]
  ds_read_b128 a[164:167], v3 offset:25600
  v_add_f32 v226, v216, v217
  v_mfma_f32_16x16x32_bf16 v[156:159], a[132:135], v[68:71], v[204:207]
  s_mov_b32 m0, s25
  v_exp_f32 v218, v130
  v_cvt_pk_bf16_f32 v176, v216, v217
  v_mfma_f32_16x16x32_bf16 v[144:147], a[136:139], v[72:75], v[144:147]
  ds_read_b128 a[168:171], v3 offset:26624
  buffer_load_dwordx4 v2, s[48:51], s27 offen offset:0 sc1 lds
  v_mfma_f32_16x16x32_bf16 v[152:155], a[136:139], v[76:79], v[152:155]
  v_exp_f32 v219, v131
  v_add_f32 v226, v226, v218
  v_mfma_f32_16x16x32_bf16 v[148:151], a[140:143], v[72:75], v[148:151]
  ds_read_b128 a[172:175], v3 offset:27648
  v_add_f32 v226, v226, v219
  v_mfma_f32_16x16x32_bf16 v[156:159], a[140:143], v[76:79], v[156:159]
  s_waitcnt lgkmcnt(4)
  v_exp_f32 v220, v132
  v_cvt_pk_bf16_f32 v177, v218, v219
  v_mfma_f32_16x16x32_bf16 v[144:147], a[144:147], v[80:83], v[144:147]
  ds_read_b128 a[176:179], v3 offset:28672
  v_add_f32 v226, v226, v220
  v_mfma_f32_16x16x32_bf16 v[152:155], a[144:147], v[84:87], v[152:155]
  v_exp_f32 v221, v133
  v_exp_f32 v222, v134
  v_mfma_f32_16x16x32_bf16 v[148:151], a[148:151], v[80:83], v[148:151]
  ds_read_b128 a[180:183], v3 offset:29696
  buffer_load_dwordx4 v2, s[48:51], s27 offen offset:1024 sc1 lds
  v_mfma_f32_16x16x32_bf16 v[156:159], a[148:151], v[84:87], v[156:159]
  v_exp_f32 v223, v135
  v_mfma_f32_16x16x32_bf16 v[144:147], a[152:155], v[88:91], v[144:147]
  ds_read_b128 a[184:187], v3 offset:30720
  v_add_f32 v226, v226, v221
  v_mfma_f32_16x16x32_bf16 v[152:155], a[152:155], v[92:95], v[152:155]
  v_exp_f32 v216, v136
  v_mfma_f32_16x16x32_bf16 v[148:151], a[156:159], v[88:91], v[148:151]
  ds_read_b128 a[188:191], v3 offset:31744
  v_cvt_pk_bf16_f32 v178, v220, v221
  v_add_f32 v226, v226, v222
  v_mfma_f32_16x16x32_bf16 v[156:159], a[156:159], v[92:95], v[156:159]
  s_waitcnt lgkmcnt(4)
  v_exp_f32 v217, v137
  v_mfma_f32_16x16x32_bf16 a[64:67], a[160:163], v[184:187], a[64:67]
  ds_read_b128 a[128:131], v3 offset:8192
  v_add_f32 v226, v226, v223
  v_cvt_pk_bf16_f32 v179, v222, v223
  v_mfma_f32_16x16x32_bf16 a[68:71], a[160:163], v[188:191], a[68:71]
  v_exp_f32 v218, v138
  v_mfma_f32_16x16x32_bf16 a[72:75], a[164:167], v[184:187], a[72:75]
  ds_read_b128 a[132:135], v3 offset:9216
  buffer_load_dwordx4 v2, s[48:51], s27 offen offset:2048 sc1 lds
  v_add_f32 v227, v216, v217
  v_mfma_f32_16x16x32_bf16 a[76:79], a[164:167], v[188:191], a[76:79]
  v_exp_f32 v219, v139
  v_mfma_f32_16x16x32_bf16 a[80:83], a[168:171], v[184:187], a[80:83]
  ds_read_b128 a[136:139], v3 offset:10240
  v_cvt_pk_bf16_f32 v180, v216, v217
  v_mfma_f32_16x16x32_bf16 a[84:87], a[168:171], v[188:191], a[84:87]
  v_exp_f32 v220, v140
  v_add_f32 v227, v227, v218
  v_mfma_f32_16x16x32_bf16 a[88:91], a[172:175], v[184:187], a[88:91]
  ds_read_b128 a[140:143], v3 offset:11264
  v_add_f32 v227, v227, v219
  v_mfma_f32_16x16x32_bf16 a[92:95], a[172:175], v[188:191], a[92:95]
  s_waitcnt lgkmcnt(4)
  v_exp_f32 v221, v141
  v_cvt_pk_bf16_f32 v181, v218, v219
  v_mfma_f32_16x16x32_bf16 a[96:99], a[176:179], v[184:187], a[96:99]
  ds_read_b128 a[144:147], v3 offset:12288
  buffer_load_dwordx4 v2, s[48:51], s27 offen offset:3072 sc1 lds
  v_mfma_f32_16x16x32_bf16 a[100:103], a[176:179], v[188:191], a[100:103]
  s_add_u32 s27, s27, 16384
  v_exp_f32 v222, v142
  v_add_f32 v227, v227, v220
  v_mfma_f32_16x16x32_bf16 a[104:107], a[180:183], v[184:187], a[104:107]
  s_add_u32 s25, s25, 32768
  ds_read_b128 a[148:151], v3 offset:13312
  v_add_f32 v227, v227, v221
  v_mfma_f32_16x16x32_bf16 a[108:111], a[180:183], v[188:191], a[108:111]
  s_and_b32 s25, s25, 0x1ffff
  v_exp_f32 v223, v143
  v_cvt_pk_bf16_f32 v182, v220, v221
  v_mfma_f32_16x16x32_bf16 a[112:115], a[184:187], v[184:187], a[112:115]
  ds_read_b128 a[152:155], v3 offset:14336
  v_add_f32 v227, v227, v222
  v_mfma_f32_16x16x32_bf16 a[116:119], a[184:187], v[188:191], a[116:119]
  v_add_f32 v227, v227, v223
  v_cvt_pk_bf16_f32 v183, v222, v223
  v_max_f32 v5, v226, v227
  v_mfma_f32_16x16x32_bf16 a[120:123], a[188:191], v[184:187], a[120:123]
  s_waitcnt lgkmcnt(3)
  ds_read_b128 a[156:159], v3 offset:15360
  v_cmp_lt_f32 vcc, s81, v5
  v_mfma_f32_16x16x32_bf16 a[124:127], a[188:191], v[188:191], a[124:127]
  s_cbranch_vccnz fa_stub6
fa_back6:
  v_add_f32 v230, v230, v226
  v_add_f32 v231, v231, v227
  v_add_u32 v3, 32768, v3
  v_and_b32 v3, 0x1ffff, v3
  s_branch fa_SSpre
fa_Aodd:
  v_mfma_f32_16x16x32_bf16 v[128:131], a[128:131], v[64:67], v[200:203]
  s_waitcnt vmcnt(12)
  v_cndmask_b32 v112, v4, v112, s[68:69]
  v_cndmask_b32 v113, v4, v113, s[70:71]
  v_cndmask_b32 v114, v4, v114, s[72:73]
  v_mfma_f32_16x16x32_bf16 v[136:139], a[128:131], v[68:71], v[204:207]
  s_barrier
  v_cndmask_b32 v115, v4, v115, s[74:75]
  v_mov_b32 v116, v4
  v_mov_b32 v117, v4
  v_mfma_f32_16x16x32_bf16 v[132:135], a[132:135], v[64:67], v[200:203]
  ds_read_b128 a[160:163], v3 offset:16384
  ds_read_b128 a[164:167], v3 offset:17408
  v_mov_b32 v118, v4
  v_mfma_f32_16x16x32_bf16 v[140:143], a[132:135], v[68:71], v[204:207]
  v_mov_b32 v119, v4
  v_cndmask_b32 v124, v4, v124, s[68:69]
  v_cndmask_b32 v125, v4, v125, s[70:71]
  v_mfma_f32_16x16x32_bf16 v[128:131], a[136:139], v[72:75], v[128:131]
  ds_read_b128 a[168:171], v3 offset:18432
  v_cndmask_b32 v126, v4, v126, s[72:73]
  v_cndmask_b32 v127, v4, v127, s[74:75]
  v_mfma_f32_16x16x32_bf16 v[136:139], a[136:139], v[76:79], v[136:139]
  s_mov_b32 m0, s24
  v_exp_f32 v208, v112
  v_exp_f32 v209, v113
  v_mfma_f32_16x16x32_bf16 v[132:135], a[140:143], v[72:75], v[132:135]
  ds_read_b128 a[172:175], v3 offset:19456
  buffer_load_dwordx4 v2, s[44:47], s26 offen offset:0 sc1 lds
  v_mfma_f32_16x16x32_bf16 v[140:143], a[140:143], v[76:79], v[140:143]
  s_waitcnt lgkmcnt(4)
  v_exp_f32 v210, v114
  v_add_f32 v224, v208, v209
  v_mfma_f32_16x16x32_bf16 v[128:131], a[144:147], v[80:83], v[128:131]
  ds_read_b128 a[176:179], v3 offset:20480
  v_exp_f32 v211, v115
  v_mfma_f32_16x16x32_bf16 v[136:139], a[144:147], v[84:87], v[136:139]
  v_exp_f32 v212, v116
  v_cvt_pk_bf16_f32 v168, v208, v209
  v_mfma_f32_16x16x32_bf16 v[132:135], a[148:151], v[80:83], v[132:135]
  ds_read_b128 a[180:183], v3 offset:21504
  v_exp_f32 v213, v117
  v_mfma_f32_16x16x32_bf16 v[140:143], a[148:151], v[84:87], v[140:143]
  v_exp_f32 v214, v118
  v_add_f32 v224, v224, v210
  v_add_f32 v224, v224, v211
  v_mfma_f32_16x16x32_bf16 v[128:131], a[152:155], v[88:91], v[128:131]
  ds_read_b128 a[184:187], v3 offset:22528
  v_cvt_pk_bf16_f32 v169, v210, v211
  v_add_f32 v224, v224, v212
  v_mfma_f32_16x16x32_bf16 v[136:139], a[152:155], v[92:95], v[136:139]
  v_exp_f32 v215, v119
  v_add_f32 v224, v224, v213
  v_mfma_f32_16x16x32_bf16 v[132:135], a[156:159], v[88:91], v[132:135]
  ds_read_b128 a[188:191], v3 offset:23552
  v_cvt_pk_bf16_f32 v170, v212, v213
  v_add_f32 v224, v224, v214
  v_mfma_f32_16x16x32_bf16 v[140:143], a[156:159], v[92:95], v[140:143]
  s_waitcnt lgkmcnt(4)
  v_exp_f32 v208, v120
  v_add_f32 v224, v224, v215
  v_mfma_f32_16x16x32_bf16 a[0:3], a[160:163], v[160:163], a[0:3]
  ds_read_b128 a[128:131], v3 offset:0
  v_cvt_pk_bf16_f32 v171, v214, v215
  v_exp_f32 v209, v121
  v_mfma_f32_16x16x32_bf16 a[4:7], a[160:163], v[164:167], a[4:7]
  v_exp_f32 v210, v122
  v_mfma_f32_16x16x32_bf16 a[64:67], a[160:163], v[176:179], a[64:67]
  buffer_load_dwordx4 v2, s[44:47], s26 offen offset:1024 sc1 lds
  v_exp_f32 v211, v123
  v_mfma_f32_16x16x32_bf16 a[68:71], a[160:163], v[180:183], a[68:71]
  v_exp_f32 v212, v124
  v_add_f32 v225, v208, v209
  v_mfma_f32_16x16x32_bf16 a[8:11], a[164:167], v[160:163], a[8:11]
  ds_read_b128 a[132:135], v3 offset:1024
  v_exp_f32 v213, v125
  v_mfma_f32_16x16x32_bf16 a[12:15], a[164:167], v[164:167], a[12:15]
  v_exp_f32 v214, v126
  v_cvt_pk_bf16_f32 v172, v208, v209
  v_mfma_f32_16x16x32_bf16 a[72:75], a[164:167], v[176:179], a[72:75]
  v_exp_f32 v215, v127
  v_add_f32 v225, v225, v210
  v_mfma_f32_16x16x32_bf16 a[76:79], a[164:167], v[180:183], a[76:79]
  v_exp_f32 v216, v144
  v_add_f32 v225, v225, v211
  v_mfma_f32_16x16x32_bf16 a[16:19], a[168:171], v[160:163], a[16:19]
  ds_read_b128 a[136:139], v3 offset:2048
  v_exp_f32 v217, v145
  v_mfma_f32_16x16x32_bf16 a[20:23], a[168:171], v[164:167], a[20:23]
  v_exp_f32 v218, v146
  v_cvt_pk_bf16_f32 v173, v210, v211
  v_mfma_f32_16x16x32_bf16 a[80:83], a[168:171], v[176:179], a[80:83]
  v_exp_f32 v219, v147
  v_add_f32 v225, v225, v212
  v_mfma_f32_16x16x32_bf16 a[84:87], a[168:171], v[180:183], a[84:87]
  v_exp_f32 v220, v148
  v_add_f32 v225, v225, v213
  v_mfma_f32_16x16x32_bf16 a[24:27], a[172:175], v[160:163], a[24:27]
  ds_read_b128 a[140:143], v3 offset:3072
  v_exp_f32 v221, v149
  v_mfma_f32_16x16x32_bf16 a[28:31], a[172:175], v[164:167], a[28:31]
  v_exp_f32 v222, v150
  v_cvt_pk_bf16_f32 v174, v212, v213
  v_mfma_f32_16x16x32_bf16 a[88:91], a[172:175], v[176:179], a[88:91]
  buffer_load_dwordx4 v2, s[44:47], s26 offen offset:2048 sc1 lds
  v_exp_f32 v223, v151
  v_mfma_f32_16x16x32_bf16 a[92:95], a[172:175], v[180:183], a[92:95]
  s_waitcnt lgkmcnt(4)
  v_add_f32 v225, v225, v214
  v_add_f32 v225, v225, v215
  v_cvt_pk_bf16_f32 v175, v214, v215
  v_mfma_f32_16x16x32_bf16 a[32:35], a[176:179], v[160:163], a[32:35]
  ds_read_b128 a[144:147], v3 offset:4096
  v_add_f32 v226, v216, v217
  v_cvt_pk_bf16_f32 v184, v216, v217
  v_mfma_f32_16x16x32_bf16 a[36:39], a[176:179], v[164:167], a[36:39]
  v_exp_f32 v216, v152
  v_add_f32 v226, v226, v218
  v_mfma_f32_16x16x32_bf16 a[96:99], a[176:179], v[176:179], a[96:99]
  v_exp_f32 v217, v153
  v_add_f32 v226, v226, v219
  v_mfma_f32_16x16x32_bf16 a[100:103], a[176:179], v[180:183], a[100:103]
  v_cvt_pk_bf16_f32 v185, v218, v219
  v_add_f32 v226, v226, v220
  v_add_f32 v226, v226, v221
  v_cvt_pk_bf16_f32 v186, v220, v221
  v_mfma_f32_16x16x32_bf16 a[40:43], a[180:183], v[160:163], a[40:43]
  ds_read_b128 a[148:151], v3 offset:5120
  v_add_f32 v226, v226, v222
  v_add_f32 v226, v226, v223
  v_mfma_f32_16x16x32_bf16 a[44:47], a[180:183], v[164:167], a[44:47]
  v_exp_f32 v218, v154
  v_cvt_pk_bf16_f32 v187, v222, v223
  v_mfma_f32_16x16x32_bf16 a[104:107], a[180:183], v[176:179], a[104:107]
  v_exp_f32 v219, v155
  v_add_f32 v227, v216, v217
  v_mfma_f32_16x16x32_bf16 a[108:111], a[180:183], v[180:183], a[108:111]
  v_exp_f32 v220, v156
  v_cvt_pk_bf16_f32 v188, v216, v217
  v_mfma_f32_16x16x32_bf16 a[48:51], a[184:187], v[160:163], a[48:51]
  ds_read_b128 a[152:155], v3 offset:6144
  v_add_f32 v227, v227, v218
  v_add_f32 v227, v227, v219
  v_mfma_f32_16x16x32_bf16 a[52:55], a[184:187], v[164:167], a[52:55]
  v_exp_f32 v221, v157
  v_cvt_pk_bf16_f32 v189, v218, v219
  v_mfma_f32_16x16x32_bf16 a[112:115], a[184:187], v[176:179], a[112:115]
  buffer_load_dwordx4 v2, s[44:47], s26 offen offset:3072 sc1 lds
  v_max3_f32 v5, v224, v225, v226
  v_add_f32 v227, v227, v220
  v_mfma_f32_16x16x32_bf16 a[116:119], a[184:187], v[180:183], a[116:119]
  s_add_u32 s26, s26, 16384
  v_exp_f32 v222, v158
  v_add_f32 v227, v227, v221
  v_mfma_f32_16x16x32_bf16 a[56:59], a[188:191], v[160:163], a[56:59]
  s_add_u32 s24, s24, 32768
  ds_read_b128 a[156:159], v3 offset:7168
  v_cvt_pk_bf16_f32 v190, v220, v221
  v_add_f32 v227, v227, v222
  v_mfma_f32_16x16x32_bf16 a[60:63], a[188:191], v[164:167], a[60:63]
  s_and_b32 s24, s24, 0x1ffff
  v_exp_f32 v223, v159
  v_mfma_f32_16x16x32_bf16 a[120:123], a[188:191], v[176:179], a[120:123]
  s_waitcnt lgkmcnt(4)
  v_add_f32 v227, v227, v223
  v_cvt_pk_bf16_f32 v191, v222, v223
  v_max_f32 v5, v5, v227
  v_cmp_lt_f32 vcc, s81, v5
  v_mfma_f32_16x16x32_bf16 a[124:127], a[188:191], v[180:183], a[124:127]
  s_cbranch_vccnz fa_stub7
fa_back7:
  v_add_f32 v228, v228, v224
  v_add_f32 v229, v229, v225
  v_add_f32 v230, v230, v226
  v_add_f32 v231, v231, v227
  v_mfma_f32_16x16x32_bf16 v[144:147], a[128:131], v[64:67], v[200:203]
  ds_read_b128 a[160:163], v3 offset:24576
  v_exp_f32 v216, v128
  v_mfma_f32_16x16x32_bf16 v[152:155], a[128:131], v[68:71], v[204:207]
  v_exp_f32 v217, v129
  v_mfma_f32_16x16x32_bf16 v[148:151], a[132:135], v[64:67], v[200:203]
  ds_read_b128 a[164:167], v3 offset:25600
  v_mfma_f32_16x16x32_bf16 v[156:159], a[132:135], v[68:71], v[204:207]
  v_exp_f32 v218, v130
  v_mfma_f32_16x16x32_bf16 v[144:147], a[136:139], v[72:75], v[144:147]
  ds_read_b128 a[168:171], v3 offset:26624
  v_add_f32 v226, v216, v217
  v_mfma_f32_16x16x32_bf16 v[152:155], a[136:139], v[76:79], v[152:155]
  s_mov_b32 m0, s25
  v_exp_f32 v219, v131
  v_mfma_f32_16x16x32_bf16 v[148:151], a[140:143], v[72:75], v[148:151]
  ds_read_b128 a[172:175], v3 offset:27648
  buffer_load_dwordx4 v2, s[48:51], s27 offen offset:0 sc1 lds
  v_mfma_f32_16x16x32_bf16 v[156:159], a[140:143], v[76:79], v[156:159]
  s_waitcnt lgkmcnt(4)
  v_exp_f32 v220, v132
  v_mfma_f32_16x16x32_bf16 v[144:147], a[144:147], v[80:83], v[144:147]
  ds_read_b128 a[176:179], v3 offset:28672
  v_cvt_pk_bf16_f32 v176, v216, v217
  v_mfma_f32_16x16x32_bf16 v[152:155], a[144:147], v[84:87], v[152:155]
  v_exp_f32 v221, v133
  v_mfma_f32_16x16x32_bf16 v[148:151], a[148:151], v[80:83], v[148:151]
  ds_read_b128 a[180:183], v3 offset:29696
  v_add_f32 v226, v226, v218
  v_mfma_f32_16x16x32_bf16 v[156:159], a[148:151], v[84:87], v[156:159]
  v_exp_f32 v222, v134
  v_mfma_f32_16x16x32_bf16 v[144:147], a[152:155], v[88:91], v[144:147]
  ds_read_b128 a[184:187], v3 offset:30720
  v_add_f32 v226, v226, v219
  v_mfma_f32_16x16x32_bf16 v[152:155], a[152:155], v[92:95], v[152:155]
  v_exp_f32 v223, v135
  v_mfma_f32_16x16x32_bf16 v[148:151], a[156:159], v[88:91], v[148:151]
  ds_read_b128 a[188:191], v3 offset:31744
  v_cvt_pk_bf16_f32 v177, v218, v219
  v_mfma_f32_16x16x32_bf16 v[156:159], a[156:159], v[92:95], v[156:159]
  s_waitcnt lgkmcnt(4)
  v_exp_f32 v216, v136
  v_mfma_f32_16x16x32_bf16 a[0:3], a[160:163], v[168:171], a[0:3]
  ds_read_b128 a[128:131], v3 offset:8192
  v_add_f32 v226, v226, v220
  v_mfma_f32_16x16x32_bf16 a[4:7], a[160:163], v[172:175], a[4:7]
  v_exp_f32 v217, v137
  v_mfma_f32_16x16x32_bf16 a[64:67], a[160:163], v[184:187], a[64:67]
  buffer_load_dwordx4 v2, s[48:51], s27 offen offset:1024 sc1 lds
  v_add_f32 v226, v226, v221
  v_mfma_f32_16x16x32_bf16 a[68:71], a[160:163], v[188:191], a[68:71]
  v_exp_f32 v218, v138
  v_mfma_f32_16x16x32_bf16 a[8:11], a[164:167], v[168:171], a[8:11]
  ds_read_b128 a[132:135], v3 offset:9216
  v_cvt_pk_bf16_f32 v178, v220, v221
  v_mfma_f32_16x16x32_bf16 a[12:15], a[164:167], v[172:175], a[12:15]
  v_exp_f32 v219, v139
  v_mfma_f32_16x16x32_bf16 a[72:75], a[164:167], v[184:187], a[72:75]
  v_exp_f32 v220, v140
  v_mfma_f32_16x16x32_bf16 a[76:79], a[164:167], v[188:191], a[76:79]
  v_add_f32 v226, v226, v222
  v_add_f32 v226, v226, v223
  v_mfma_f32_16x16x32_bf16 a[16:19], a[168:171], v[168:171], a[16:19]
  ds_read_b128 a[136:139], v3 offset:10240
  v_cvt_pk_bf16_f32 v179, v222, v223
  v_mfma_f32_16x16x32_bf16 a[20:23], a[168:171], v[172:175], a[20:23]
  v_exp_f32 v221, v141
  v_mfma_f32_16x16x32_bf16 a[80:83], a[168:171], v[184:187], a[80:83]
  v_exp_f32 v222, v142
  v_mfma_f32_16x16x32_bf16 a[84:87], a[168:171], v[188:191], a[84:87]
  v_exp_f32 v223, v143
  v_mfma_f32_16x16x32_bf16 a[24:27], a[172:175], v[168:171], a[24:27]
  ds_read_b128 a[140:143], v3 offset:11264
  v_add_f32 v227, v216, v217
  v_mfma_f32_16x16x32_bf16 a[28:31], a[172:175], v[172:175], a[28:31]
  v_cvt_pk_bf16_f32 v180, v216, v217
  v_add_f32 v227, v227, v218
  v_mfma_f32_16x16x32_bf16 a[88:91], a[172:175], v[184:187], a[88:91]
  buffer_load_dwordx4 v2, s[48:51], s27 offen offset:2048 sc1 lds
  v_add_f32 v227, v227, v219
  v_mfma_f32_16x16x32_bf16 a[92:95], a[172:175], v[188:191], a[92:95]
  s_waitcnt lgkmcnt(4)
  v_cvt_pk_bf16_f32 v181, v218, v219
  v_add_f32 v227, v227, v220
  v_mfma_f32_16x16x32_bf16 a[32:35], a[176:179], v[168:171], a[32:35]
  ds_read_b128 a[144:147], v3 offset:12288
  v_add_f32 v227, v227, v221
  v_mfma_f32_16x16x32_bf16 a[36:39], a[176:179], v[172:175], a[36:39]
  v_cvt_pk_bf16_f32 v182, v220, v221
  v_add_f32 v227, v227, v222
  v_mfma_f32_16x16x32_bf16 a[96:99], a[176:179], v[184:187], a[96:99]
  v_add_f32 v227, v227, v223
  v_cvt_pk_bf16_f32 v183, v222, v223
  v_mfma_f32_16x16x32_bf16 a[100:103], a[176:179], v[188:191], a[100:103]
  v_max_f32 v5, v226, v227
  v_cmp_lt_f32 vcc, s81, v5
  v_mfma_f32_16x16x32_bf16 a[40:43], a[180:183], v[168:171], a[40:43]
  ds_read_b128 a[148:151], v3 offset:13312
  v_mfma_f32_16x16x32_bf16 a[44:47], a[180:183], v[172:175], a[44:47]
  v_mfma_f32_16x16x32_bf16 a[104:107], a[180:183], v[184:187], a[104:107]
  v_mfma_f32_16x16x32_bf16 a[108:111], a[180:183], v[188:191], a[108:111]
  v_mfma_f32_16x16x32_bf16 a[48:51], a[184:187], v[168:171], a[48:51]
  ds_read_b128 a[152:155], v3 offset:14336
  v_mfma_f32_16x16x32_bf16 a[52:55], a[184:187], v[172:175], a[52:55]
  v_mfma_f32_16x16x32_bf16 a[112:115], a[184:187], v[184:187], a[112:115]
  buffer_load_dwordx4 v2, s[48:51], s27 offen offset:3072 sc1 lds
  v_mfma_f32_16x16x32_bf16 a[116:119], a[184:187], v[188:191], a[116:119]
  s_add_u32 s27, s27, 16384
  v_mfma_f32_16x16x32_bf16 a[56:59], a[188:191], v[168:171], a[56:59]
  s_add_u32 s25, s25, 32768
  ds_read_b128 a[156:159], v3 offset:15360
  v_mfma_f32_16x16x32_bf16 a[60:63], a[188:191], v[172:175], a[60:63]
  s_and_b32 s25, s25, 0x1ffff
  v_mfma_f32_16x16x32_bf16 a[120:123], a[188:191], v[184:187], a[120:123]
  s_waitcnt lgkmcnt(4)
  v_mfma_f32_16x16x32_bf16 a[124:127], a[188:191], v[188:191], a[124:127]
  s_cbranch_vccnz fa_stub8
fa_back8:
  v_add_f32 v230, v230, v226
  v_add_f32 v231, v231, v227
  v_add_u32 v3, 32768, v3
  v_and_b32 v3, 0x1ffff, v3
fa_SSpre:
  v_mov_b32 v16, 1073741824
  v_mov_b32 v17, 1
  s_movk_i32 s23, 128
  v_writelane_b32 v16, s23, 0
  s_waitcnt vmcnt(8)
  buffer_atomic_add v17, v16, s[56:59], 0 offen sc1
  s_cmp_eq_u32 s29, 0
  s_cbranch_scc1 fa_Bexit
.p2align 6
fa_SS:
  v_mfma_f32_16x16x32_bf16 v[128:131], a[128:131], v[64:67], v[200:203]
  s_waitcnt vmcnt(12)
  v_exp_f32 v216, v144
  v_mfma_f32_16x16x32_bf16 v[136:139], a[128:131], v[68:71], v[204:207]
  s_barrier
  v_exp_f32 v217, v145
  v_exp_f32 v218, v146
  v_mfma_f32_16x16x32_bf16 v[132:135], a[132:135], v[64:67], v[200:203]
  ds_read_b128 a[160:163], v3 offset:16384
  ds_read_b128 a[164:167], v3 offset:17408
  v_mfma_f32_16x16x32_bf16 v[140:143], a[132:135], v[68:71], v[204:207]
  s_mov_b32 m0, s24
  v_exp_f32 v219, v147
  v_mfma_f32_16x16x32_bf16 v[128:131], a[136:139], v[72:75], v[128:131]
  ds_read_b128 a[168:171], v3 offset:18432
  buffer_load_dwordx4 v2, s[44:47], s26 offen offset:0 sc1 lds
  v_mfma_f32_16x16x32_bf16 v[136:139], a[136:139], v[76:79], v[136:139]
  v_exp_f32 v220, v148
  v_add_f32 v226, v216, v217
  v_mfma_f32_16x16x32_bf16 v[132:135], a[140:143], v[72:75], v[132:135]
  ds_read_b128 a[172:175], v3 offset:19456
  v_cvt_pk_bf16_f32 v184, v216, v217
  v_mfma_f32_16x16x32_bf16 v[140:143], a[140:143], v[76:79], v[140:143]
  s_waitcnt lgkmcnt(4)
  v_exp_f32 v221, v149
  v_add_f32 v226, v226, v218
  v_mfma_f32_16x16x32_bf16 v[128:131], a[144:147], v[80:83], v[128:131]
  ds_read_b128 a[176:179], v3 offset:20480
  v_add_f32 v226, v226, v219
  v_mfma_f32_16x16x32_bf16 v[136:139], a[144:147], v[84:87], v[136:139]
  v_exp_f32 v222, v150
  v_cvt_pk_bf16_f32 v185, v218, v219
  v_mfma_f32_16x16x32_bf16 v[132:135], a[148:151], v[80:83], v[132:135]
  ds_read_b128 a[180:183], v3 offset:21504
  buffer_load_dwordx4 v2, s[44:47], s26 offen offset:1024 sc1 lds
  v_mfma_f32_16x16x32_bf16 v[140:143], a[148:151], v[84:87], v[140:143]
  v_exp_f32 v223, v151
  v_mfma_f32_16x16x32_bf16 v[128:131], a[152:155], v[88:91], v[128:131]
  ds_read_b128 a[184:187], v3 offset:22528
  v_add_f32 v226, v226, v220
  v_add_f32 v226, v226, v221
  v_mfma_f32_16x16x32_bf16 v[136:139], a[152:155], v[92:95], v[136:139]
  v_exp_f32 v216, v152
  v_mfma_f32_16x16x32_bf16 v[132:135], a[156:159], v[88:91], v[132:135]
  ds_read_b128 a[188:191], v3 offset:23552
  v_cvt_pk_bf16_f32 v186, v220, v221
  v_add_f32 v226, v226, v222
  v_mfma_f32_16x16x32_bf16 v[140:143], a[156:159], v[92:95], v[140:143]
  s_waitcnt lgkmcnt(4)
  v_exp_f32 v217, v153
  v_mfma_f32_16x16x32_bf16 a[64:67], a[160:163], v[176:179], a[64:67]
  ds_read_b128 a[128:131], v3 offset:0
  v_add_f32 v226, v226, v223
  v_cvt_pk_bf16_f32 v187, v222, v223
  v_mfma_f32_16x16x32_bf16 a[68:71], a[160:163], v[180:183], a[68:71]
  v_exp_f32 v218, v154
  v_mfma_f32_16x16x32_bf16 a[72:75], a[164:167], v[176:179], a[72:75]
  ds_read_b128 a[132:135], v3 offset:1024
  buffer_load_dwordx4 v2, s[44:47], s26 offen offset:2048 sc1 lds
  v_add_f32 v227, v216, v217
  v_mfma_f32_16x16x32_bf16 a[76:79], a[164:167], v[180:183], a[76:79]
  v_exp_f32 v219, v155
  v_mfma_f32_16x16x32_bf16 a[80:83], a[168:171], v[176:179], a[80:83]
  ds_read_b128 a[136:139], v3 offset:2048
  v_cvt_pk_bf16_f32 v188, v216, v217
  v_mfma_f32_16x16x32_bf16 a[84:87], a[168:171], v[180:183], a[84:87]
  v_exp_f32 v220, v156
  v_add_f32 v227, v227, v218
  v_mfma_f32_16x16x32_bf16 a[88:91], a[172:175], v[176:179], a[88:91]
  ds_read_b128 a[140:143], v3 offset:3072
  v_add_f32 v227, v227, v219
  v_mfma_f32_16x16x32_bf16 a[92:95], a[172:175], v[180:183], a[92:95]
  s_waitcnt lgkmcnt(4)
  v_exp_f32 v221, v157
  v_cvt_pk_bf16_f32 v189, v218, v219
  v_mfma_f32_16x16x32_bf16 a[96:99], a[176:179], v[176:179], a[96:99]
  ds_read_b128 a[144:147], v3 offset:4096
  buffer_load_dwordx4 v2, s[44:47], s26 offen offset:3072 sc1 lds
  v_mfma_f32_16x16x32_bf16 a[100:103], a[176:179], v[180:183], a[100:103]
  s_add_u32 s26, s26, 16384
  v_exp_f32 v222, v158
  v_add_f32 v227, v227, v220
  v_mfma_f32_16x16x32_bf16 a[104:107], a[180:183], v[176:179], a[104:107]
  s_add_u32 s24, s24, 32768
  ds_read_b128 a[148:151], v3 offset:5120
  v_add_f32 v227, v227, v221
  v_mfma_f32_16x16x32_bf16 a[108:111], a[180:183], v[180:183], a[108:111]
  s_and_b32 s24, s24, 0x1ffff
  v_exp_f32 v223, v159
  v_cvt_pk_bf16_f32 v190, v220, v221
  v_mfma_f32_16x16x32_bf16 a[112:115], a[184:187], v[176:179], a[112:115]
  ds_read_b128 a[152:155], v3 offset:6144
  v_add_f32 v227, v227, v222
  v_mfma_f32_16x16x32_bf16 a[116:119], a[184:187], v[180:183], a[116:119]
  v_add_f32 v227, v227, v223
  v_cvt_pk_bf16_f32 v191, v222, v223
  v_max_f32 v5, v226, v227
  v_mfma_f32_16x16x32_bf16 a[120:123], a[188:191], v[176:179], a[120:123]
  s_waitcnt lgkmcnt(3)
  ds_read_b128 a[156:159], v3 offset:7168
  v_cmp_lt_f32 vcc, s81, v5
  v_mfma_f32_16x16x32_bf16 a[124:127], a[188:191], v[180:183], a[124:127]
  s_cbranch_vccnz fa_stub9
fa_back9:
  v_add_f32 v230, v230, v226
  v_add_f32 v231, v231, v227
  v_mfma_f32_16x16x32_bf16 v[144:147], a[128:131], v[64:67], v[200:203]
  ds_read_b128 a[160:163], v3 offset:24576
  v_exp_f32 v216, v128
  v_mfma_f32_16x16x32_bf16 v[152:155], a[128:131], v[68:71], v[204:207]
  v_exp_f32 v217, v129
  v_mfma_f32_16x16x32_bf16 v[148:151], a[132:135], v[64:67], v[200:203]
  ds_read_b128 a[164:167], v3 offset:25600
  v_add_f32 v226, v216, v217
  v_mfma_f32_16x16x32_bf16 v[156:159], a[132:135], v[68:71], v[204:207]
  s_mov_b32 m0, s25
  v_exp_f32 v218, v130
  v_cvt_pk_bf16_f32 v176, v216, v217
  v_mfma_f32_16x16x32_bf16 v[144:147], a[136:139], v[72:75], v[144:147]
  ds_read_b128 a[168:171], v3 offset:26624
  buffer_load_dwordx4 v2, s[48:51], s27 offen offset:0 sc1 lds
  v_mfma_f32_16x16x32_bf16 v[152:155], a[136:139], v[76:79], v[152:155]
  v_exp_f32 v219, v131
  v_add_f32 v226, v226, v218
  v_mfma_f32_16x16x32_bf16 v[148:151], a[140:143], v[72:75], v[148:151]
  ds_read_b128 a[172:175], v3 offset:27648
  v_add_f32 v226, v226, v219
  v_mfma_f32_16x16x32_bf16 v[156:159], a[140:143], v[76:79], v[156:159]
  s_waitcnt lgkmcnt(4)
  v_exp_f32 v220, v132
  v_cvt_pk_bf16_f32 v177, v218, v219
  v_mfma_f32_16x16x32_bf16 v[144:147], a[144:147], v[80:83], v[144:147]
  ds_read_b128 a[176:179], v3 offset:28672
  v_add_f32 v226, v226, v220
  v_mfma_f32_16x16x32_bf16 v[152:155], a[144:147], v[84:87], v[152:155]
  v_exp_f32 v221, v133
  v_exp_f32 v222, v134
  v_mfma_f32_16x16x32_bf16 v[148:151], a[148:151], v[80:83], v[148:151]
  ds_read_b128 a[180:183], v3 offset:29696
  buffer_load_dwordx4 v2, s[48:51], s27 offen offset:1024 sc1 lds
  v_mfma_f32_16x16x32_bf16 v[156:159], a[148:151], v[84:87], v[156:159]
  v_exp_f32 v223, v135
  v_mfma_f32_16x16x32_bf16 v[144:147], a[152:155], v[88:91], v[144:147]
  ds_read_b128 a[184:187], v3 offset:30720
  v_add_f32 v226, v226, v221
  v_mfma_f32_16x16x32_bf16 v[152:155], a[152:155], v[92:95], v[152:155]
  v_exp_f32 v216, v136
  v_mfma_f32_16x16x32_bf16 v[148:151], a[156:159], v[88:91], v[148:151]
  ds_read_b128 a[188:191], v3 offset:31744
  v_cvt_pk_bf16_f32 v178, v220, v221
  v_add_f32 v226, v226, v222
  v_mfma_f32_16x16x32_bf16 v[156:159], a[156:159], v[92:95], v[156:159]
  s_waitcnt lgkmcnt(4)
  v_exp_f32 v217, v137
  v_mfma_f32_16x16x32_bf16 a[64:67], a[160:163], v[184:187], a[64:67]
  ds_read_b128 a[128:131], v3 offset:8192
  v_add_f32 v226, v226, v223
  v_cvt_pk_bf16_f32 v179, v222, v223
  v_mfma_f32_16x16x32_bf16 a[68:71], a[160:163], v[188:191], a[68:71]
  v_exp_f32 v218, v138
  v_mfma_f32_16x16x32_bf16 a[72:75], a[164:167], v[184:187], a[72:75]
  ds_read_b128 a[132:135], v3 offset:9216
  buffer_load_dwordx4 v2, s[48:51], s27 offen offset:2048 sc1 lds
  v_add_f32 v227, v216, v217
  v_mfma_f32_16x16x32_bf16 a[76:79], a[164:167], v[188:191], a[76:79]
  v_exp_f32 v219, v139
  v_mfma_f32_16x16x32_bf16 a[80:83], a[168:171], v[184:187], a[80:83]
  ds_read_b128 a[136:139], v3 offset:10240
  v_cvt_pk_bf16_f32 v180, v216, v217
  v_mfma_f32_16x16x32_bf16 a[84:87], a[168:171], v[188:191], a[84:87]
  v_exp_f32 v220, v140
  v_add_f32 v227, v227, v218
  v_mfma_f32_16x16x32_bf16 a[88:91], a[172:175], v[184:187], a[88:91]
  ds_read_b128 a[140:143], v3 offset:11264
  v_add_f32 v227, v227, v219
  v_mfma_f32_16x16x32_bf16 a[92:95], a[172:175], v[188:191], a[92:95]
  s_waitcnt lgkmcnt(4)
  v_exp_f32 v221, v141
  v_cvt_pk_bf16_f32 v181, v218, v219
  v_mfma_f32_16x16x32_bf16 a[96:99], a[176:179], v[184:187], a[96:99]
  ds_read_b128 a[144:147], v3 offset:12288
  buffer_load_dwordx4 v2, s[48:51], s27 offen offset:3072 sc1 lds
  v_mfma_f32_16x16x32_bf16 a[100:103], a[176:179], v[188:191], a[100:103]
  s_add_u32 s27, s27, 16384
  v_exp_f32 v222, v142
  v_add_f32 v227, v227, v220
  v_mfma_f32_16x16x32_bf16 a[104:107], a[180:183], v[184:187], a[104:107]
  s_add_u32 s25, s25, 32768
  ds_read_b128 a[148:151], v3 offset:13312
  v_add_f32 v227, v227, v221
  v_mfma_f32_16x16x32_bf16 a[108:111], a[180:183], v[188:191], a[108:111]
  s_and_b32 s25, s25, 0x1ffff
  v_exp_f32 v223, v143
  v_cvt_pk_bf16_f32 v182, v220, v221
  v_mfma_f32_16x16x32_bf16 a[112:115], a[184:187], v[184:187], a[112:115]
  ds_read_b128 a[152:155], v3 offset:14336
  v_add_f32 v227, v227, v222
  v_mfma_f32_16x16x32_bf16 a[116:119], a[184:187], v[188:191], a[116:119]
  s_sub_u32 s29, s29, 1
  v_add_f32 v227, v227, v223
  v_cvt_pk_bf16_f32 v183, v222, v223
  v_max_f32 v5, v226, v227
  v_mfma_f32_16x16x32_bf16 a[120:123], a[188:191], v[184:187], a[120:123]
  s_waitcnt lgkmcnt(3)
  ds_read_b128 a[156:159], v3 offset:15360
  v_cmp_lt_f32 vcc, s81, v5
  v_mfma_f32_16x16x32_bf16 a[124:127], a[188:191], v[188:191], a[124:127]
  s_cbranch_vccnz fa_stub10
fa_back10:
  v_add_f32 v230, v230, v226
  v_add_f32 v231, v231, v227
  v_add_u32 v3, 32768, v3
  v_and_b32 v3, 0x1ffff, v3
  s_cmp_lg_u32 s29, 0
  s_cbranch_scc1 fa_SS
fa_Bexit:
  s_bitcmp1_b32 s20, 0
  s_cbranch_scc1 fa_Bodd
  v_mfma_f32_16x16x32_bf16 v[128:131], a[128:131], v[64:67], v[200:203]
  s_waitcnt vmcnt(0)
  v_exp_f32 v216, v144
  v_mfma_f32_16x16x32_bf16 v[136:139], a[128:131], v[68:71], v[204:207]
  s_barrier
  v_exp_f32 v217, v145
  v_mfma_f32_16x16x32_bf16 v[132:135], a[132:135], v[64:67], v[200:203]
  ds_read_b128 a[160:163], v3 offset:16384
  ds_read_b128 a[164:167], v3 offset:17408
  v_mfma_f32_16x16x32_bf16 v[140:143], a[132:135], v[68:71], v[204:207]
  v_exp_f32 v218, v146
  v_mfma_f32_16x16x32_bf16 v[128:131], a[136:139], v[72:75], v[128:131]
  ds_read_b128 a[168:171], v3 offset:18432
  v_add_f32 v226, v216, v217
  v_mfma_f32_16x16x32_bf16 v[136:139], a[136:139], v[76:79], v[136:139]
  v_exp_f32 v219, v147
  v_mfma_f32_16x16x32_bf16 v[132:135], a[140:143], v[72:75], v[132:135]
  ds_read_b128 a[172:175], v3 offset:19456
  v_cvt_pk_bf16_f32 v184, v216, v217
  v_mfma_f32_16x16x32_bf16 v[140:143], a[140:143], v[76:79], v[140:143]
  s_waitcnt lgkmcnt(4)
  v_exp_f32 v220, v148
  v_add_f32 v226, v226, v218
  v_mfma_f32_16x16x32_bf16 v[128:131], a[144:147], v[80:83], v[128:131]
  ds_read_b128 a[176:179], v3 offset:20480
  v_add_f32 v226, v226, v219
  v_mfma_f32_16x16x32_bf16 v[136:139], a[144:147], v[84:87], v[136:139]
  v_exp_f32 v221, v149
  v_mfma_f32_16x16x32_bf16 v[132:135], a[148:151], v[80:83], v[132:135]
  ds_read_b128 a[180:183], v3 offset:21504
  v_cvt_pk_bf16_f32 v185, v218, v219
  v_mfma_f32_16x16x32_bf16 v[140:143], a[148:151], v[84:87], v[140:143]
  v_exp_f32 v222, v150
  v_mfma_f32_16x16x32_bf16 v[128:131], a[152:155], v[88:91], v[128:131]
  ds_read_b128 a[184:187], v3 offset:22528
  v_add_f32 v226, v226, v220
  v_mfma_f32_16x16x32_bf16 v[136:139], a[152:155], v[92:95], v[136:139]
  v_exp_f32 v223, v151
  v_mfma_f32_16x16x32_bf16 v[132:135], a[156:159], v[88:91], v[132:135]
  ds_read_b128 a[188:191], v3 offset:23552
  v_add_f32 v226, v226, v221
  v_mfma_f32_16x16x32_bf16 v[140:143], a[156:159], v[92:95], v[140:143]
  s_waitcnt lgkmcnt(4)
  v_exp_f32 v216, v152
  v_mfma_f32_16x16x32_bf16 a[64:67], a[160:163], v[176:179], a[64:67]
  v_exp_f32 v217, v153
  v_mfma_f32_16x16x32_bf16 a[68:71], a[160:163], v[180:183], a[68:71]
  v_exp_f32 v218, v154
  v_mfma_f32_16x16x32_bf16 a[72:75], a[164:167], v[176:179], a[72:75]
  v_exp_f32 v219, v155
  v_mfma_f32_16x16x32_bf16 a[76:79], a[164:167], v[180:183], a[76:79]
  v_cvt_pk_bf16_f32 v186, v220, v221
  v_add_f32 v226, v226, v222
  v_mfma_f32_16x16x32_bf16 a[80:83], a[168:171], v[176:179], a[80:83]
  v_exp_f32 v220, v156
  v_mfma_f32_16x16x32_bf16 a[84:87], a[168:171], v[180:183], a[84:87]
  v_exp_f32 v221, v157
  v_mfma_f32_16x16x32_bf16 a[88:91], a[172:175], v[176:179], a[88:91]
  v_add_f32 v226, v226, v223
  v_cvt_pk_bf16_f32 v187, v222, v223
  v_mfma_f32_16x16x32_bf16 a[92:95], a[172:175], v[180:183], a[92:95]
  s_waitcnt lgkmcnt(0)
  v_exp_f32 v222, v158
  v_add_f32 v227, v216, v217
  v_mfma_f32_16x16x32_bf16 a[96:99], a[176:179], v[176:179], a[96:99]
  v_exp_f32 v223, v159
  v_mfma_f32_16x16x32_bf16 a[100:103], a[176:179], v[180:183], a[100:103]
  v_cvt_pk_bf16_f32 v188, v216, v217
  v_add_f32 v227, v227, v218
  v_mfma_f32_16x16x32_bf16 a[104:107], a[180:183], v[176:179], a[104:107]
  v_add_f32 v227, v227, v219
  v_cvt_pk_bf16_f32 v189, v218, v219
  v_mfma_f32_16x16x32_bf16 a[108:111], a[180:183], v[180:183], a[108:111]
  v_add_f32 v227, v227, v220
  v_add_f32 v227, v227, v221
  v_mfma_f32_16x16x32_bf16 a[112:115], a[184:187], v[176:179], a[112:115]
  v_cvt_pk_bf16_f32 v190, v220, v221
  v_add_f32 v227, v227, v222
  v_mfma_f32_16x16x32_bf16 a[116:119], a[184:187], v[180:183], a[116:119]
  v_add_f32 v227, v227, v223
  v_cvt_pk_bf16_f32 v191, v222, v223
  v_mfma_f32_16x16x32_bf16 a[120:123], a[188:191], v[176:179], a[120:123]
  v_max_f32 v5, v226, v227
  v_cmp_lt_f32 vcc, s81, v5
  v_mfma_f32_16x16x32_bf16 a[124:127], a[188:191], v[180:183], a[124:127]
  s_cbranch_vccnz fa_stub11
fa_back11:
  v_add_f32 v230, v230, v226
  v_add_f32 v231, v231, v227
  ds_read_b128 a[160:163], v3 offset:24576
  ds_read_b128 a[164:167], v3 offset:25600
  ds_read_b128 a[168:171], v3 offset:26624
  ds_read_b128 a[172:175], v3 offset:27648
  ds_read_b128 a[176:179], v3 offset:28672
  ds_read_b128 a[180:183], v3 offset:29696
  ds_read_b128 a[184:187], v3 offset:30720
  ds_read_b128 a[188:191], v3 offset:31744
  v_cndmask_b32 v128, v4, v128, s[68:69]
  v_cndmask_b32 v129, v4, v129, s[70:71]
  v_cndmask_b32 v130, v4, v130, s[72:73]
  v_cndmask_b32 v131, v4, v131, s[74:75]
  v_mov_b32 v132, v4
  v_mov_b32 v133, v4
  v_mov_b32 v134, v4
  v_mov_b32 v135, v4
  v_cndmask_b32 v140, v4, v140, s[68:69]
  v_cndmask_b32 v141, v4, v141, s[70:71]
  v_cndmask_b32 v142, v4, v142, s[72:73]
  v_cndmask_b32 v143, v4, v143, s[74:75]
  v_exp_f32 v216, v128
  v_exp_f32 v217, v129
  v_exp_f32 v218, v130
  v_exp_f32 v219, v131
  v_exp_f32 v220, v132
  v_exp_f32 v221, v133
  v_exp_f32 v222, v134
  v_exp_f32 v223, v135
  v_add_f32 v226, v216, v217
  v_cvt_pk_bf16_f32 v176, v216, v217
  s_waitcnt lgkmcnt(4)
  v_mfma_f32_16x16x32_bf16 a[64:67], a[160:163], v[184:187], a[64:67]
  v_exp_f32 v216, v136
  v_add_f32 v226, v226, v218
  v_mfma_f32_16x16x32_bf16 a[68:71], a[160:163], v[188:191], a[68:71]
  v_exp_f32 v217, v137
  v_mfma_f32_16x16x32_bf16 a[72:75], a[164:167], v[184:187], a[72:75]
  v_add_f32 v226, v226, v219
  v_cvt_pk_bf16_f32 v177, v218, v219
  v_add_f32 v226, v226, v220
  v_mfma_f32_16x16x32_bf16 a[76:79], a[164:167], v[188:191], a[76:79]
  v_exp_f32 v218, v138
  v_mfma_f32_16x16x32_bf16 a[80:83], a[168:171], v[184:187], a[80:83]
  v_exp_f32 v219, v139
  v_add_f32 v226, v226, v221
  v_mfma_f32_16x16x32_bf16 a[84:87], a[168:171], v[188:191], a[84:87]
  v_cvt_pk_bf16_f32 v178, v220, v221
  v_add_f32 v226, v226, v222
  v_mfma_f32_16x16x32_bf16 a[88:91], a[172:175], v[184:187], a[88:91]
  v_exp_f32 v220, v140
  v_add_f32 v226, v226, v223
  v_mfma_f32_16x16x32_bf16 a[92:95], a[172:175], v[188:191], a[92:95]
  s_waitcnt lgkmcnt(0)
  v_exp_f32 v221, v141
  v_mfma_f32_16x16x32_bf16 a[96:99], a[176:179], v[184:187], a[96:99]
  v_cvt_pk_bf16_f32 v179, v222, v223
  v_add_f32 v227, v216, v217
  v_cvt_pk_bf16_f32 v180, v216, v217
  v_mfma_f32_16x16x32_bf16 a[100:103], a[176:179], v[188:191], a[100:103]
  v_exp_f32 v222, v142
  v_mfma_f32_16x16x32_bf16 a[104:107], a[180:183], v[184:187], a[104:107]
  v_exp_f32 v223, v143
  v_add_f32 v227, v227, v218
  v_mfma_f32_16x16x32_bf16 a[108:111], a[180:183], v[188:191], a[108:111]
  v_add_f32 v227, v227, v219
  v_cvt_pk_bf16_f32 v181, v218, v219
  v_mfma_f32_16x16x32_bf16 a[112:115], a[184:187], v[184:187], a[112:115]
  v_add_f32 v227, v227, v220
  v_add_f32 v227, v227, v221
  v_cvt_pk_bf16_f32 v182, v220, v221
  v_mfma_f32_16x16x32_bf16 a[116:119], a[184:187], v[188:191], a[116:119]
  v_add_f32 v227, v227, v222
  v_add_f32 v227, v227, v223
  v_mfma_f32_16x16x32_bf16 a[120:123], a[188:191], v[184:187], a[120:123]
  v_cvt_pk_bf16_f32 v183, v222, v223
  v_max_f32 v5, v226, v227
  v_cmp_lt_f32 vcc, s81, v5
  v_mfma_f32_16x16x32_bf16 a[124:127], a[188:191], v[188:191], a[124:127]
  s_cbranch_vccnz fa_stub12
fa_back12:
  v_add_f32 v230, v230, v226
  v_add_f32 v231, v231, v227
  v_add_u32 v3, 32768, v3
  v_and_b32 v3, 0x1ffff, v3
  s_waitcnt vmcnt(0)
  s_barrier
  ds_read_b128 a[160:163], v3 offset:16384
  ds_read_b128 a[164:167], v3 offset:17408
  ds_read_b128 a[168:171], v3 offset:18432
  ds_read_b128 a[172:175], v3 offset:19456
  ds_read_b128 a[176:179], v3 offset:20480
  ds_read_b128 a[180:183], v3 offset:21504
  ds_read_b128 a[184:187], v3 offset:22528
  ds_read_b128 a[188:191], v3 offset:23552
  s_waitcnt lgkmcnt(4)
  v_mfma_f32_16x16x32_bf16 a[64:67], a[160:163], v[176:179], a[64:67]
  v_mfma_f32_16x16x32_bf16 a[68:71], a[160:163], v[180:183], a[68:71]
  v_mfma_f32_16x16x32_bf16 a[72:75], a[164:167], v[176:179], a[72:75]
  v_mfma_f32_16x16x32_bf16 a[76:79], a[164:167], v[180:183], a[76:79]
  v_mfma_f32_16x16x32_bf16 a[80:83], a[168:171], v[176:179], a[80:83]
  v_mfma_f32_16x16x32_bf16 a[84:87], a[168:171], v[180:183], a[84:87]
  v_mfma_f32_16x16x32_bf16 a[88:91], a[172:175], v[176:179], a[88:91]
  v_mfma_f32_16x16x32_bf16 a[92:95], a[172:175], v[180:183], a[92:95]
  s_waitcnt lgkmcnt(0)
  v_mfma_f32_16x16x32_bf16 a[96:99], a[176:179], v[176:179], a[96:99]
  v_mfma_f32_16x16x32_bf16 a[100:103], a[176:179], v[180:183], a[100:103]
  v_mfma_f32_16x16x32_bf16 a[104:107], a[180:183], v[176:179], a[104:107]
  v_mfma_f32_16x16x32_bf16 a[108:111], a[180:183], v[180:183], a[108:111]
  v_mfma_f32_16x16x32_bf16 a[112:115], a[184:187], v[176:179], a[112:115]
  v_mfma_f32_16x16x32_bf16 a[116:119], a[184:187], v[180:183], a[116:119]
  v_mfma_f32_16x16x32_bf16 a[120:123], a[188:191], v[176:179], a[120:123]
  v_mfma_f32_16x16x32_bf16 a[124:127], a[188:191], v[180:183], a[124:127]
  s_branch fa_Bdone
fa_Bodd:
  s_waitcnt vmcnt(0)
  s_barrier
  ds_read_b128 a[160:163], v3 offset:16384
  ds_read_b128 a[164:167], v3 offset:17408
  ds_read_b128 a[168:171], v3 offset:18432
  ds_read_b128 a[172:175], v3 offset:19456
  ds_read_b128 a[176:179], v3 offset:20480
  ds_read_b128 a[180:183], v3 offset:21504
  ds_read_b128 a[184:187], v3 offset:22528
  ds_read_b128 a[188:191], v3 offset:23552
  v_cndmask_b32 v144, v4, v144, s[68:69]
  v_cndmask_b32 v145, v4, v145, s[70:71]
  v_cndmask_b32 v146, v4, v146, s[72:73]
  v_cndmask_b32 v147, v4, v147, s[74:75]
  v_mov_b32 v148, v4
  v_mov_b32 v149, v4
  v_mov_b32 v150, v4
  v_mov_b32 v151, v4
  v_cndmask_b32 v156, v4, v156, s[68:69]
  v_cndmask_b32 v157, v4, v157, s[70:71]
  v_cndmask_b32 v158, v4, v158, s[72:73]
  v_cndmask_b32 v159, v4, v159, s[74:75]
  v_exp_f32 v216, v144
  v_exp_f32 v217, v145
  v_exp_f32 v218, v146
  v_exp_f32 v219, v147
  v_exp_f32 v220, v148
  v_exp_f32 v221, v149
  v_exp_f32 v222, v150
  v_exp_f32 v223, v151
  v_add_f32 v226, v216, v217
  v_cvt_pk_bf16_f32 v184, v216, v217
  s_waitcnt lgkmcnt(4)
  v_mfma_f32_16x16x32_bf16 a[64:67], a[160:163], v[176:179], a[64:67]
  v_exp_f32 v216, v152
  v_add_f32 v226, v226, v218
  v_mfma_f32_16x16x32_bf16 a[68:71], a[160:163], v[180:183], a[68:71]
  v_exp_f32 v217, v153
  v_mfma_f32_16x16x32_bf16 a[72:75], a[164:167], v[176:179], a[72:75]
  v_add_f32 v226, v226, v219
  v_cvt_pk_bf16_f32 v185, v218, v219
  v_add_f32 v226, v226, v220
  v_mfma_f32_16x16x32_bf16 a[76:79], a[164:167], v[180:183], a[76:79]
  v_exp_f32 v218, v154
  v_mfma_f32_16x16x32_bf16 a[80:83], a[168:171], v[176:179], a[80:83]
  v_exp_f32 v219, v155
  v_add_f32 v226, v226, v221
  v_mfma_f32_16x16x32_bf16 a[84:87], a[168:171], v[180:183], a[84:87]
  v_cvt_pk_bf16_f32 v186, v220, v221
  v_add_f32 v226, v226, v222
  v_mfma_f32_16x16x32_bf16 a[88:91], a[172:175], v[176:179], a[88:91]
  v_exp_f32 v220, v156
  v_add_f32 v226, v226, v223
  v_mfma_f32_16x16x32_bf16 a[92:95], a[172:175], v[180:183], a[92:95]
  s_waitcnt lgkmcnt(0)
  v_exp_f32 v221, v157
  v_mfma_f32_16x16x32_bf16 a[96:99], a[176:179], v[176:179], a[96:99]
  v_cvt_pk_bf16_f32 v187, v222, v223
  v_add_f32 v227, v216, v217
  v_cvt_pk_bf16_f32 v188, v216, v217
  v_mfma_f32_16x16x32_bf16 a[100:103], a[176:179], v[180:183], a[100:103]
  v_exp_f32 v222, v158
  v_mfma_f32_16x16x32_bf16 a[104:107], a[180:183], v[176:179], a[104:107]
  v_exp_f32 v223, v159
  v_add_f32 v227, v227, v218
  v_mfma_f32_16x16x32_bf16 a[108:111], a[180:183], v[180:183], a[108:111]
  v_add_f32 v227, v227, v219
  v_cvt_pk_bf16_f32 v189, v218, v219
  v_mfma_f32_16x16x32_bf16 a[112:115], a[184:187], v[176:179], a[112:115]
  v_add_f32 v227, v227, v220
  v_add_f32 v227, v227, v221
  v_cvt_pk_bf16_f32 v190, v220, v221
  v_mfma_f32_16x16x32_bf16 a[116:119], a[184:187], v[180:183], a[116:119]
  v_add_f32 v227, v227, v222
  v_add_f32 v227, v227, v223
  v_mfma_f32_16x16x32_bf16 a[120:123], a[188:191], v[176:179], a[120:123]
  v_cvt_pk_bf16_f32 v191, v222, v223
  v_max_f32 v5, v226, v227
  v_cmp_lt_f32 vcc, s81, v5
  v_mfma_f32_16x16x32_bf16 a[124:127], a[188:191], v[180:183], a[124:127]
  s_cbranch_vccnz fa_stub13
fa_back13:
  v_add_f32 v230, v230, v226
  v_add_f32 v231, v231, v227
  ds_read_b128 a[160:163], v3 offset:24576
  ds_read_b128 a[164:167], v3 offset:25600
  ds_read_b128 a[168:171], v3 offset:26624
  ds_read_b128 a[172:175], v3 offset:27648
  ds_read_b128 a[176:179], v3 offset:28672
  ds_read_b128 a[180:183], v3 offset:29696
  ds_read_b128 a[184:187], v3 offset:30720
  ds_read_b128 a[188:191], v3 offset:31744
  s_waitcnt lgkmcnt(4)
  v_mfma_f32_16x16x32_bf16 a[64:67], a[160:163], v[184:187], a[64:67]
  v_mfma_f32_16x16x32_bf16 a[68:71], a[160:163], v[188:191], a[68:71]
  v_mfma_f32_16x16x32_bf16 a[72:75], a[164:167], v[184:187], a[72:75]
  v_mfma_f32_16x16x32_bf16 a[76:79], a[164:167], v[188:191], a[76:79]
  v_mfma_f32_16x16x32_bf16 a[80:83], a[168:171], v[184:187], a[80:83]
  v_mfma_f32_16x16x32_bf16 a[84:87], a[168:171], v[188:191], a[84:87]
  v_mfma_f32_16x16x32_bf16 a[88:91], a[172:175], v[184:187], a[88:91]
  v_mfma_f32_16x16x32_bf16 a[92:95], a[172:175], v[188:191], a[92:95]
  s_waitcnt lgkmcnt(0)
  v_mfma_f32_16x16x32_bf16 a[96:99], a[176:179], v[184:187], a[96:99]
  v_mfma_f32_16x16x32_bf16 a[100:103], a[176:179], v[188:191], a[100:103]
  v_mfma_f32_16x16x32_bf16 a[104:107], a[180:183], v[184:187], a[104:107]
  v_mfma_f32_16x16x32_bf16 a[108:111], a[180:183], v[188:191], a[108:111]
  v_mfma_f32_16x16x32_bf16 a[112:115], a[184:187], v[184:187], a[112:115]
  v_mfma_f32_16x16x32_bf16 a[116:119], a[184:187], v[188:191], a[116:119]
  v_mfma_f32_16x16x32_bf16 a[120:123], a[188:191], v[184:187], a[120:123]
  v_mfma_f32_16x16x32_bf16 a[124:127], a[188:191], v[188:191], a[124:127]
  v_add_u32 v3, 32768, v3
  v_and_b32 v3, 0x1ffff, v3
fa_Bdone:
  s_cmp_ge_u32 s20, 2
  s_cbranch_scc1 fa_epi
  s_barrier
fa_epi:
  v_mov_b32 v20, v228
  v_mov_b32 v21, v229
  v_mov_b32 v22, v230
  v_mov_b32 v23, v231
  s_nop 0
  v_permlane16_swap_b32 v228, v20
  v_permlane16_swap_b32 v229, v21
  v_permlane16_swap_b32 v230, v22
  v_permlane16_swap_b32 v231, v23
  v_add_f32 v228, v228, v20
  v_add_f32 v229, v229, v21
  v_add_f32 v230, v230, v22
  v_add_f32 v231, v231, v23
  v_mov_b32 v20, v228
  v_mov_b32 v21, v229
  v_mov_b32 v22, v230
  v_mov_b32 v23, v231
  s_nop 0
  v_permlane32_swap_b32 v228, v20
  v_permlane32_swap_b32 v229, v21
  v_permlane32_swap_b32 v230, v22
  v_permlane32_swap_b32 v231, v23
  v_add_f32 v228, v228, v20
  v_add_f32 v229, v229, v21
  v_add_f32 v230, v230, v22
  v_add_f32 v231, v231, v23
  v_rcp_f32 v16, v228
  v_rcp_f32 v18, v229
  v_rcp_f32 v20, v230
  v_rcp_f32 v22, v231
  s_nop 0
  v_mov_b32 v17, v16
  v_mov_b32 v19, v18
  v_mov_b32 v21, v20
  v_mov_b32 v23, v22
  s_lshl_b32 s23, s22, 2
  s_add_u32 s23, s23, s20
  s_lshl_b32 s23, s23, 18
  s_lshl_b32 s31, s21, 12
  s_add_u32 s31, s31, 50331648
  s_add_u32 s64, s23, s31
  s_add_u32 s65, s64, 131072
  s_sub_u32 s23, 15, s22
  s_lshl_b32 s23, s23, 2
  s_add_u32 s23, s23, s20
  s_lshl_b32 s23, s23, 18
  s_add_u32 s66, s23, s31
  s_add_u32 s67, s66, 131072
  v_accvgpr_read_b32 v36, a0
  v_accvgpr_read_b32 v37, a1
  v_accvgpr_read_b32 v38, a2
  v_accvgpr_read_b32 v39, a3
  v_accvgpr_read_b32 v40, a8
  v_accvgpr_read_b32 v41, a9
  v_accvgpr_read_b32 v42, a10
  v_accvgpr_read_b32 v43, a11
  v_pk_mul_f32 v[36:37], v[36:37], v[16:17]
  v_pk_mul_f32 v[38:39], v[38:39], v[16:17]
  v_pk_mul_f32 v[40:41], v[40:41], v[16:17]
  v_pk_mul_f32 v[42:43], v[42:43], v[16:17]
  v_cvt_pk_bf16_f32 v32, v36, v37
  v_cvt_pk_bf16_f32 v33, v38, v39
  v_cvt_pk_bf16_f32 v34, v40, v41
  v_cvt_pk_bf16_f32 v35, v42, v43
  buffer_store_dwordx4 v[32:35], v2, s[40:43], s64 offen offset:0 sc1
  v_accvgpr_read_b32 v48, a16
  v_accvgpr_read_b32 v49, a17
  v_accvgpr_read_b32 v50, a18
  v_accvgpr_read_b32 v51, a19
  v_accvgpr_read_b32 v52, a24
  v_accvgpr_read_b32 v53, a25
  v_accvgpr_read_b32 v54, a26
  v_accvgpr_read_b32 v55, a27
  v_pk_mul_f32 v[48:49], v[48:49], v[16:17]
  v_pk_mul_f32 v[50:51], v[50:51], v[16:17]
  v_pk_mul_f32 v[52:53], v[52:53], v[16:17]
  v_pk_mul_f32 v[54:55], v[54:55], v[16:17]
  v_cvt_pk_bf16_f32 v44, v48, v49
  v_cvt_pk_bf16_f32 v45, v50, v51
  v_cvt_pk_bf16_f32 v46, v52, v53
  v_cvt_pk_bf16_f32 v47, v54, v55
  buffer_store_dwordx4 v[44:47], v2, s[40:43], s64 offen offset:1024 sc1
  v_accvgpr_read_b32 v60, a32
  v_accvgpr_read_b32 v61, a33
  v_accvgpr_read_b32 v62, a34
  v_accvgpr_read_b32 v63, a35
  v_accvgpr_read_b32 v64, a40
  v_accvgpr_read_b32 v65, a41
  v_accvgpr_read_b32 v66, a42
  v_accvgpr_read_b32 v67, a43
  v_pk_mul_f32 v[60:61], v[60:61], v[16:17]
  v_pk_mul_f32 v[62:63], v[62:63], v[16:17]
  v_pk_mul_f32 v[64:65], v[64:65], v[16:17]
  v_pk_mul_f32 v[66:67], v[66:67], v[16:17]
  v_cvt_pk_bf16_f32 v56, v60, v61
  v_cvt_pk_bf16_f32 v57, v62, v63
  v_cvt_pk_bf16_f32 v58, v64, v65
  v_cvt_pk_bf16_f32 v59, v66, v67
  buffer_store_dwordx4 v[56:59], v2, s[40:43], s64 offen offset:2048 sc1
  v_accvgpr_read_b32 v72, a48
  v_accvgpr_read_b32 v73, a49
  v_accvgpr_read_b32 v74, a50
  v_accvgpr_read_b32 v75, a51
  v_accvgpr_read_b32 v76, a56
  v_accvgpr_read_b32 v77, a57
  v_accvgpr_read_b32 v78, a58
  v_accvgpr_read_b32 v79, a59
  v_pk_mul_f32 v[72:73], v[72:73], v[16:17]
  v_pk_mul_f32 v[74:75], v[74:75], v[16:17]
  v_pk_mul_f32 v[76:77], v[76:77], v[16:17]
  v_pk_mul_f32 v[78:79], v[78:79], v[16:17]
  v_cvt_pk_bf16_f32 v68, v72, v73
  v_cvt_pk_bf16_f32 v69, v74, v75
  v_cvt_pk_bf16_f32 v70, v76, v77
  v_cvt_pk_bf16_f32 v71, v78, v79
  buffer_store_dwordx4 v[68:71], v2, s[40:43], s64 offen offset:3072 sc1
  v_accvgpr_read_b32 v84, a4
  v_accvgpr_read_b32 v85, a5
  v_accvgpr_read_b32 v86, a6
  v_accvgpr_read_b32 v87, a7
  v_accvgpr_read_b32 v88, a12
  v_accvgpr_read_b32 v89, a13
  v_accvgpr_read_b32 v90, a14
  v_accvgpr_read_b32 v91, a15
  v_pk_mul_f32 v[84:85], v[84:85], v[18:19]
  v_pk_mul_f32 v[86:87], v[86:87], v[18:19]
  v_pk_mul_f32 v[88:89], v[88:89], v[18:19]
  v_pk_mul_f32 v[90:91], v[90:91], v[18:19]
  v_cvt_pk_bf16_f32 v80, v84, v85
  v_cvt_pk_bf16_f32 v81, v86, v87
  v_cvt_pk_bf16_f32 v82, v88, v89
  v_cvt_pk_bf16_f32 v83, v90, v91
  buffer_store_dwordx4 v[80:83], v2, s[40:43], s65 offen offset:0 sc1
  v_accvgpr_read_b32 v96, a20
  v_accvgpr_read_b32 v97, a21
  v_accvgpr_read_b32 v98, a22
  v_accvgpr_read_b32 v99, a23
  v_accvgpr_read_b32 v100, a28
  v_accvgpr_read_b32 v101, a29
  v_accvgpr_read_b32 v102, a30
  v_accvgpr_read_b32 v103, a31
  v_pk_mul_f32 v[96:97], v[96:97], v[18:19]
  v_pk_mul_f32 v[98:99], v[98:99], v[18:19]
  v_pk_mul_f32 v[100:101], v[100:101], v[18:19]
  v_pk_mul_f32 v[102:103], v[102:103], v[18:19]
  v_cvt_pk_bf16_f32 v92, v96, v97
  v_cvt_pk_bf16_f32 v93, v98, v99
  v_cvt_pk_bf16_f32 v94, v100, v101
  v_cvt_pk_bf16_f32 v95, v102, v103
  buffer_store_dwordx4 v[92:95], v2, s[40:43], s65 offen offset:1024 sc1
  v_accvgpr_read_b32 v108, a36
  v_accvgpr_read_b32 v109, a37
  v_accvgpr_read_b32 v110, a38
  v_accvgpr_read_b32 v111, a39
  v_accvgpr_read_b32 v112, a44
  v_accvgpr_read_b32 v113, a45
  v_accvgpr_read_b32 v114, a46
  v_accvgpr_read_b32 v115, a47
  v_pk_mul_f32 v[108:109], v[108:109], v[18:19]
  v_pk_mul_f32 v[110:111], v[110:111], v[18:19]
  v_pk_mul_f32 v[112:113], v[112:113], v[18:19]
  v_pk_mul_f32 v[114:115], v[114:115], v[18:19]
  v_cvt_pk_bf16_f32 v104, v108, v109
  v_cvt_pk_bf16_f32 v105, v110, v111
  v_cvt_pk_bf16_f32 v106, v112, v113
  v_cvt_pk_bf16_f32 v107, v114, v115
  buffer_store_dwordx4 v[104:107], v2, s[40:43], s65 offen offset:2048 sc1
  v_accvgpr_read_b32 v120, a52
  v_accvgpr_read_b32 v121, a53
  v_accvgpr_read_b32 v122, a54
  v_accvgpr_read_b32 v123, a55
  v_accvgpr_read_b32 v124, a60
  v_accvgpr_read_b32 v125, a61
  v_accvgpr_read_b32 v126, a62
  v_accvgpr_read_b32 v127, a63
  v_pk_mul_f32 v[120:121], v[120:121], v[18:19]
  v_pk_mul_f32 v[122:123], v[122:123], v[18:19]
  v_pk_mul_f32 v[124:125], v[124:125], v[18:19]
  v_pk_mul_f32 v[126:127], v[126:127], v[18:19]
  v_cvt_pk_bf16_f32 v116, v120, v121
  v_cvt_pk_bf16_f32 v117, v122, v123
  v_cvt_pk_bf16_f32 v118, v124, v125
  v_cvt_pk_bf16_f32 v119, v126, v127
  buffer_store_dwordx4 v[116:119], v2, s[40:43], s65 offen offset:3072 sc1
  v_accvgpr_read_b32 v36, a64
  v_accvgpr_read_b32 v37, a65
  v_accvgpr_read_b32 v38, a66
  v_accvgpr_read_b32 v39, a67
  v_accvgpr_read_b32 v40, a72
  v_accvgpr_read_b32 v41, a73
  v_accvgpr_read_b32 v42, a74
  v_accvgpr_read_b32 v43, a75
  v_pk_mul_f32 v[36:37], v[36:37], v[20:21]
  v_pk_mul_f32 v[38:39], v[38:39], v[20:21]
  v_pk_mul_f32 v[40:41], v[40:41], v[20:21]
  v_pk_mul_f32 v[42:43], v[42:43], v[20:21]
  v_cvt_pk_bf16_f32 v32, v36, v37
  v_cvt_pk_bf16_f32 v33, v38, v39
  v_cvt_pk_bf16_f32 v34, v40, v41
  v_cvt_pk_bf16_f32 v35, v42, v43
  buffer_store_dwordx4 v[32:35], v2, s[40:43], s66 offen offset:0 sc1
  v_accvgpr_read_b32 v48, a80
  v_accvgpr_read_b32 v49, a81
  v_accvgpr_read_b32 v50, a82
  v_accvgpr_read_b32 v51, a83
  v_accvgpr_read_b32 v52, a88
  v_accvgpr_read_b32 v53, a89
  v_accvgpr_read_b32 v54, a90
  v_accvgpr_read_b32 v55, a91
  v_pk_mul_f32 v[48:49], v[48:49], v[20:21]
  v_pk_mul_f32 v[50:51], v[50:51], v[20:21]
  v_pk_mul_f32 v[52:53], v[52:53], v[20:21]
  v_pk_mul_f32 v[54:55], v[54:55], v[20:21]
  v_cvt_pk_bf16_f32 v44, v48, v49
  v_cvt_pk_bf16_f32 v45, v50, v51
  v_cvt_pk_bf16_f32 v46, v52, v53
  v_cvt_pk_bf16_f32 v47, v54, v55
  buffer_store_dwordx4 v[44:47], v2, s[40:43], s66 offen offset:1024 sc1
  v_accvgpr_read_b32 v60, a96
  v_accvgpr_read_b32 v61, a97
  v_accvgpr_read_b32 v62, a98
  v_accvgpr_read_b32 v63, a99
  v_accvgpr_read_b32 v64, a104
  v_accvgpr_read_b32 v65, a105
  v_accvgpr_read_b32 v66, a106
  v_accvgpr_read_b32 v67, a107
  v_pk_mul_f32 v[60:61], v[60:61], v[20:21]
  v_pk_mul_f32 v[62:63], v[62:63], v[20:21]
  v_pk_mul_f32 v[64:65], v[64:65], v[20:21]
  v_pk_mul_f32 v[66:67], v[66:67], v[20:21]
  v_cvt_pk_bf16_f32 v56, v60, v61
  v_cvt_pk_bf16_f32 v57, v62, v63
  v_cvt_pk_bf16_f32 v58, v64, v65
  v_cvt_pk_bf16_f32 v59, v66, v67
  buffer_store_dwordx4 v[56:59], v2, s[40:43], s66 offen offset:2048 sc1
  v_accvgpr_read_b32 v72, a112
  v_accvgpr_read_b32 v73, a113
  v_accvgpr_read_b32 v74, a114
  v_accvgpr_read_b32 v75, a115
  v_accvgpr_read_b32 v76, a120
  v_accvgpr_read_b32 v77, a121
  v_accvgpr_read_b32 v78, a122
  v_accvgpr_read_b32 v79, a123
  v_pk_mul_f32 v[72:73], v[72:73], v[20:21]
  v_pk_mul_f32 v[74:75], v[74:75], v[20:21]
  v_pk_mul_f32 v[76:77], v[76:77], v[20:21]
  v_pk_mul_f32 v[78:79], v[78:79], v[20:21]
  v_cvt_pk_bf16_f32 v68, v72, v73
  v_cvt_pk_bf16_f32 v69, v74, v75
  v_cvt_pk_bf16_f32 v70, v76, v77
  v_cvt_pk_bf16_f32 v71, v78, v79
  buffer_store_dwordx4 v[68:71], v2, s[40:43], s66 offen offset:3072 sc1
  v_accvgpr_read_b32 v84, a68
  v_accvgpr_read_b32 v85, a69
  v_accvgpr_read_b32 v86, a70
  v_accvgpr_read_b32 v87, a71
  v_accvgpr_read_b32 v88, a76
  v_accvgpr_read_b32 v89, a77
  v_accvgpr_read_b32 v90, a78
  v_accvgpr_read_b32 v91, a79
  v_pk_mul_f32 v[84:85], v[84:85], v[22:23]
  v_pk_mul_f32 v[86:87], v[86:87], v[22:23]
  v_pk_mul_f32 v[88:89], v[88:89], v[22:23]
  v_pk_mul_f32 v[90:91], v[90:91], v[22:23]
  v_cvt_pk_bf16_f32 v80, v84, v85
  v_cvt_pk_bf16_f32 v81, v86, v87
  v_cvt_pk_bf16_f32 v82, v88, v89
  v_cvt_pk_bf16_f32 v83, v90, v91
  buffer_store_dwordx4 v[80:83], v2, s[40:43], s67 offen offset:0 sc1
  v_accvgpr_read_b32 v96, a84
  v_accvgpr_read_b32 v97, a85
  v_accvgpr_read_b32 v98, a86
  v_accvgpr_read_b32 v99, a87
  v_accvgpr_read_b32 v100, a92
  v_accvgpr_read_b32 v101, a93
  v_accvgpr_read_b32 v102, a94
  v_accvgpr_read_b32 v103, a95
  v_pk_mul_f32 v[96:97], v[96:97], v[22:23]
  v_pk_mul_f32 v[98:99], v[98:99], v[22:23]
  v_pk_mul_f32 v[100:101], v[100:101], v[22:23]
  v_pk_mul_f32 v[102:103], v[102:103], v[22:23]
  v_cvt_pk_bf16_f32 v92, v96, v97
  v_cvt_pk_bf16_f32 v93, v98, v99
  v_cvt_pk_bf16_f32 v94, v100, v101
  v_cvt_pk_bf16_f32 v95, v102, v103
  buffer_store_dwordx4 v[92:95], v2, s[40:43], s67 offen offset:1024 sc1
  v_accvgpr_read_b32 v108, a100
  v_accvgpr_read_b32 v109, a101
  v_accvgpr_read_b32 v110, a102
  v_accvgpr_read_b32 v111, a103
  v_accvgpr_read_b32 v112, a108
  v_accvgpr_read_b32 v113, a109
  v_accvgpr_read_b32 v114, a110
  v_accvgpr_read_b32 v115, a111
  v_pk_mul_f32 v[108:109], v[108:109], v[22:23]
  v_pk_mul_f32 v[110:111], v[110:111], v[22:23]
  v_pk_mul_f32 v[112:113], v[112:113], v[22:23]
  v_pk_mul_f32 v[114:115], v[114:115], v[22:23]
  v_cvt_pk_bf16_f32 v104, v108, v109
  v_cvt_pk_bf16_f32 v105, v110, v111
  v_cvt_pk_bf16_f32 v106, v112, v113
  v_cvt_pk_bf16_f32 v107, v114, v115
  buffer_store_dwordx4 v[104:107], v2, s[40:43], s67 offen offset:2048 sc1
  v_accvgpr_read_b32 v120, a116
  v_accvgpr_read_b32 v121, a117
  v_accvgpr_read_b32 v122, a118
  v_accvgpr_read_b32 v123, a119
  v_accvgpr_read_b32 v124, a124
  v_accvgpr_read_b32 v125, a125
  v_accvgpr_read_b32 v126, a126
  v_accvgpr_read_b32 v127, a127
  v_pk_mul_f32 v[120:121], v[120:121], v[22:23]
  v_pk_mul_f32 v[122:123], v[122:123], v[22:23]
  v_pk_mul_f32 v[124:125], v[124:125], v[22:23]
  v_pk_mul_f32 v[126:127], v[126:127], v[22:23]
  v_cvt_pk_bf16_f32 v116, v120, v121
  v_cvt_pk_bf16_f32 v117, v122, v123
  v_cvt_pk_bf16_f32 v118, v124, v125
  v_cvt_pk_bf16_f32 v119, v126, v127
  buffer_store_dwordx4 v[116:119], v2, s[40:43], s67 offen offset:3072 sc1
fa_end:
  s_endpgm
fa_p1stubK:
  s_call_b64 s[76:77], fa_p1sub
  s_branch fa_p1backK
fa_p1stubV:
  s_call_b64 s[76:77], fa_p1sub
  s_branch fa_p1backV
fa_p1sub:
  s_cmp_eq_u32 s28, 0
  s_cbranch_scc0 fa_p1sub6
  s_cmp_eq_u32 s20, 0
  s_cselect_b32 s23, 0, 1073741824
  v_mov_b32 v16, 1073741824
  v_mov_b32 v17, 1
  v_writelane_b32 v16, s23, 0
  buffer_atomic_add v17, v16, s[56:59], 0 offen sc1
  s_setpc_b64 s[76:77]
fa_p1sub6:
  s_mov_b32 s34, 0
  s_mov_b32 s36, s60
  s_mov_b32 s37, s61
  s_mov_b32 s38, s75
  s_lshr_b32 s27, s20, 1
  s_lshl_b32 s27, s27, 18
  s_mov_b32 s25, 524288
  buffer_load_dword v228, v229, s[56:59], 0 offen sc1
  s_setpc_b64 s[76:77]
fa_ln_spin:
  s_mov_b32 s83, 200000
fa_ln_spin2:
  buffer_load_dword v228, v229, s[56:59], 0 offen sc1
  s_waitcnt vmcnt(0)
  v_cmp_gt_u32 vcc, 0x100, v228
  s_cbranch_vccz fa_ln_ok
  s_sleep 2
  s_sub_u32 s83, s83, 1
  s_cmp_lg_u32 s83, 0
  s_cbranch_scc1 fa_ln_spin2
  s_branch fa_ln_ok
fa_top8:
  s_cmp_lg_u32 s20, 0
  s_cbranch_scc1 fa_notop
  s_mov_b32 s23, 2621440
  s_mov_b32 s31, 2625536
  buffer_load_dwordx4 v[32:35], v2, s[40:43], s23 offen offset:0 sc1
  buffer_load_dwordx4 v[36:39], v2, s[40:43], s23 offen offset:1024 sc1
  buffer_load_dwordx4 v[40:43], v2, s[40:43], s23 offen offset:2048 sc1
  buffer_load_dwordx4 v[44:47], v2, s[40:43], s23 offen offset:3072 sc1
  buffer_load_dwordx4 v[48:51], v2, s[40:43], s31 offen offset:0 sc1
  buffer_load_dwordx4 v[52:55], v2, s[40:43], s31 offen offset:1024 sc1
  buffer_load_dwordx4 v[56:59], v2, s[40:43], s31 offen offset:2048 sc1
  buffer_load_dwordx4 v[60:63], v2, s[40:43], s31 offen offset:3072 sc1
  v_mov_b32 v21, 0
  v_mov_b32 v22, 0
  v_and_b32 v23, 7, v1
  s_mov_b32 s23, 0
  s_waitcnt vmcnt(0)
fa_top:
  v_max3_u32 v20, v32, v33, v34
  v_max3_u32 v24, v35, v36, v37
  v_max3_u32 v20, v20, v38, v39
  v_max3_u32 v24, v24, v40, v41
  v_max3_u32 v20, v20, v42, v43
  v_max3_u32 v24, v24, v44, v45
  v_max3_u32 v20, v20, v46, v47
  v_max3_u32 v24, v24, v48, v49
  v_max3_u32 v20, v20, v50, v51
  v_max3_u32 v24, v24, v52, v53
  v_max3_u32 v20, v20, v54, v55
  v_max3_u32 v24, v24, v56, v57
  v_max3_u32 v20, v20, v58, v59
  v_max3_u32 v24, v24, v60, v61
  v_max3_u32 v20, v20, v62, v63
  v_max_u32 v20, v20, v24
  s_nop 1
  v_max_u32_dpp v20, v20, v20 quad_perm:[1,0,3,2] row_mask:0xf bank_mask:0xf
  s_nop 1
  v_max_u32_dpp v20, v20, v20 quad_perm:[2,3,0,1] row_mask:0xf bank_mask:0xf
  s_nop 1
  v_max_u32_dpp v20, v20, v20 row_half_mirror row_mask:0xf bank_mask:0xf
  s_nop 1
  v_max_u32_dpp v20, v20, v20 row_mirror row_mask:0xf bank_mask:0xf
  v_mov_b32 v24, v20
  s_nop 1
  v_permlane16_swap_b32 v20, v24
  v_max_u32 v20, v20, v24
  v_mov_b32 v24, v20
  s_nop 1
  v_permlane32_swap_b32 v20, v24
  v_max_u32 v20, v20, v24
  v_add_u32 v21, v21, v20
  v_cmp_eq_u32 vcc, s23, v23
  v_sub_u32 v32, v32, v20
  v_sub_u32 v33, v33, v20
  v_sub_u32 v34, v34, v20
  v_sub_u32 v35, v35, v20
  v_sub_u32 v36, v36, v20
  v_sub_u32 v37, v37, v20
  v_sub_u32 v38, v38, v20
  v_sub_u32 v39, v39, v20
  v_sub_u32 v40, v40, v20
  v_sub_u32 v41, v41, v20
  v_sub_u32 v42, v42, v20
  v_sub_u32 v43, v43, v20
  v_sub_u32 v44, v44, v20
  v_sub_u32 v45, v45, v20
  v_sub_u32 v46, v46, v20
  v_sub_u32 v47, v47, v20
  v_sub_u32 v48, v48, v20
  v_sub_u32 v49, v49, v20
  v_sub_u32 v50, v50, v20
  v_sub_u32 v51, v51, v20
  v_sub_u32 v52, v52, v20
  v_sub_u32 v53, v53, v20
  v_sub_u32 v54, v54, v20
  v_sub_u32 v55, v55, v20
  v_sub_u32 v56, v56, v20
  v_sub_u32 v57, v57, v20
  v_sub_u32 v58, v58, v20
  v_sub_u32 v59, v59, v20
  v_sub_u32 v60, v60, v20
  v_sub_u32 v61, v61, v20
  v_sub_u32 v62, v62, v20
  v_sub_u32 v63, v63, v20
  v_cndmask_b32 v22, v22, v21, vcc
  s_add_u32 s23, s23, 1
  s_cmp_lt_u32 s23, 8
  s_cbranch_scc1 fa_top
  v_and_b32 v25, 0xffff, v22
  v_sub_u32 v25, 0xffff, v25
  v_and_b32 v25, 2047, v25
  v_ashrrev_i32 v20, 31, v22
  v_not_b32 v20, v20
  v_or_b32 v20, 0x80000000, v20
  v_xor_b32 v26, v22, v20
  v_and_b32 v26, 0xffff0000, v26
  v_mul_f32 v26, 0xbfb8aa3b, v26
  v_exp_f32 v26, v26
  s_nop 0
  v_add_f32 v26, 1.0, v26
  v_rcp_f32 v26, v26
  s_nop 0
  v_cvt_pk_bf16_f32 v26, v26, v26
  v_and_b32 v26, 0xffff0000, v26
  v_lshlrev_b32 v20, 2, v1
  v_add_u32 v20, 2629632, v20
  v_mov_b32 v21, 1073741824
  v_cmp_gt_u32 vcc, 8, v1
  s_nop 1
  v_cndmask_b32 v20, v21, v20, vcc
  buffer_store_dword v25, v20, s[40:43], 0 offen sc1
  buffer_store_dword v26, v20, s[40:43], 0 offen offset:32 sc1
  s_mov_b32 s23, 2650368
  v_mov_b32 v24, 1
  v_writelane_b32 v21, s23, 0
  s_waitcnt vmcnt(0)
  buffer_store_dword v24, v21, s[40:43], 0 offen sc1
  s_branch fa_notop
fa_kv_spin:
  s_mov_b32 s83, 200000
fa_kv_spin2:
  buffer_load_dword v228, v230, s[40:43], 0 offen sc1
  s_waitcnt vmcnt(0)
  v_cmp_eq_u32 vcc, 0, v228
  s_cbranch_vccz fa_kv_ok
  s_sleep 2
  s_sub_u32 s83, s83, 1
  s_cmp_lg_u32 s83, 0
  s_cbranch_scc1 fa_kv_spin2
  s_branch fa_kv_ok
fa_fset:
  s_load_dwordx4 s[4:7], s[0:1], 64
  s_load_dwordx2 s[8:9], s[0:1], 80
  v_and_b32 v16, 7, v1
  v_lshlrev_b32 v17, 2, v16
  ds_bpermute_b32 v18, v17, v15
  s_mov_b32 s32, 1
  s_lshl_b32 s33, s23, 6
  s_and_b32 s31, s20, 1
  s_lshl_b32 s31, s31, 5
  s_add_u32 s33, s33, s31
  s_mul_i32 s35, s23, 40960
  s_mul_i32 s31, s20, 320
  s_add_u32 s35, s35, s31
  s_mul_i32 s36, s23, 20480
  s_mul_i32 s31, s20, 640
  s_add_u32 s36, s36, s31
  s_add_u32 s36, s36, 2686976
  s_waitcnt lgkmcnt(0)
  s_cmp_ge_u32 s20, 2
  s_cselect_b32 s4, s6, s4
  s_cselect_b32 s5, s7, s5
  s_mov_b32 s52, s4
  s_mov_b32 s53, s5
  s_mov_b32 s54, 2211840
  s_mov_b32 s55, 0x20000
  s_mov_b32 s60, s8
  s_mov_b32 s61, s9
  s_mov_b32 s62, 2211840
  s_mov_b32 s63, 0x20000
  v_and_b32 v18, 2047, v18
  v_lshrrev_b32 v19, 4, v18
  v_mul_u32_u24 v19, 20480, v19
  v_and_b32 v18, 15, v18
  v_lshl_add_u32 v19, v18, 4, v19
  v_lshrrev_b32 v18, 3, v1
  v_lshl_add_u32 v19, v18, 8, v19
  s_lshl_b32 s23, s20, 11
  s_lshl_b32 s31, s20, 10
  s_add_u32 s31, s31, 151552
  s_mov_b32 m0, s31
  s_nop 0
  buffer_load_dwordx4 v19, s[40:43], s23 offen sc1 lds
  s_add_u32 s23, s23, 8192
  s_add_u32 s31, s31, 4096
  s_mov_b32 m0, s31
  s_nop 0
  buffer_load_dwordx4 v19, s[40:43], s23 offen sc1 lds
  s_add_u32 s23, s23, 8192
  s_add_u32 s31, s31, 4096
  s_mov_b32 m0, s31
  s_nop 0
  buffer_load_dwordx4 v19, s[40:43], s23 offen sc1 lds
  s_add_u32 s23, s23, 8192
  s_add_u32 s31, s31, 4096
  v_lshrrev_b32 v17, 1, v1
  v_mul_u32_u24 v8, 3456, v17
  v_and_b32 v17, 1, v1
  v_lshl_add_u32 v8, v17, 4, v8
  v_lshrrev_b32 v17, 4, v1
  v_lshrrev_b32 v18, 2, v1
  v_lshl_add_u32 v18, v17, 2, v18
  v_lshlrev_b32 v18, 5, v18
  v_and_b32 v19, 3, v1
  v_lshl_add_u32 v9, v19, 3, v18
  v_add_u32 v9, s34, v9
  v_lshlrev_b32 v10, 4, v16
  v_lshl_add_u32 v10, v17, 7, v10
  v_add_u32 v10, 151552, v10
  v_and_b32 v18, 15, v1
  v_mul_u32_u24 v11, 2560, v18
  v_lshl_add_u32 v11, v17, 4, v11
  v_cmp_gt_u32 vcc, 8, v18
  v_mov_b32 v19, 1073741824
  s_nop 0
  v_cndmask_b32 v11, v19, v11, vcc
  s_branch fa_fsetb
fa_fstub:
  s_cmp_ge_u32 s32, 6
  s_cbranch_scc1 fa_f6
  s_cmp_eq_u32 s32, 1
  s_cbranch_scc0 fa_f2
  v_mov_b32 v232, 0
  v_mov_b32 v233, 0
  v_mov_b32 v234, 0
  v_mov_b32 v235, 0
  s_branch fa_fissueG
fa_f2:
  s_waitcnt vmcnt(8)
  ds_read_b64_tr_b16 a[192:193], v9 offset:0
  ds_read_b64_tr_b16 a[194:195], v9 offset:128
  ds_read_b128 a[212:215], v10 offset:0
  ds_read_b64_tr_b16 a[196:197], v9 offset:1024
  ds_read_b64_tr_b16 a[198:199], v9 offset:1152
  ds_read_b128 a[216:219], v10 offset:512
  ds_read_b64_tr_b16 a[200:201], v9 offset:2048
  ds_read_b64_tr_b16 a[202:203], v9 offset:2176
  ds_read_b128 a[220:223], v10 offset:1024
  ds_read_b64_tr_b16 a[204:205], v9 offset:3072
  ds_read_b64_tr_b16 a[206:207], v9 offset:3200
  ds_read_b128 a[224:227], v10 offset:1536
  ds_read_b64_tr_b16 a[208:209], v9 offset:4096
  ds_read_b64_tr_b16 a[210:211], v9 offset:4224
  ds_read_b128 a[228:231], v10 offset:2048
  v_add_u32 v10, 2560, v10
  s_waitcnt lgkmcnt(0)
  v_mfma_f32_16x16x32_bf16 v[232:235], a[192:195], a[212:215], v[232:235]
  v_mfma_f32_16x16x32_bf16 v[232:235], a[196:199], a[216:219], v[232:235]
  v_mfma_f32_16x16x32_bf16 v[232:235], a[200:203], a[220:223], v[232:235]
  v_mfma_f32_16x16x32_bf16 v[232:235], a[204:207], a[224:227], v[232:235]
  v_mfma_f32_16x16x32_bf16 v[232:235], a[208:211], a[228:231], v[232:235]
  s_cmp_eq_u32 s32, 5
  s_cbranch_scc1 fa_f5
fa_fissueG:
  s_add_u32 m0, s34, 0
  s_nop 0
  buffer_load_dwordx4 v8, s[52:55], s33 offen lds
  s_add_u32 s33, s33, 110592
  s_add_u32 m0, s34, 1024
  s_nop 0
  buffer_load_dwordx4 v8, s[52:55], s33 offen lds
  s_add_u32 s33, s33, 110592
  s_add_u32 m0, s34, 2048
  s_nop 0
  buffer_load_dwordx4 v8, s[52:55], s33 offen lds
  s_add_u32 s33, s33, 110592
  s_add_u32 m0, s34, 3072
  s_nop 0
  buffer_load_dwordx4 v8, s[52:55], s33 offen lds
  s_add_u32 s33, s33, 110592
  s_add_u32 m0, s34, 4096
  s_nop 0
  buffer_load_dwordx4 v8, s[52:55], s33 offen lds
  s_add_u32 s33, s33, 110592
  s_branch fa_fret
fa_f5:
  s_lshl_b32 s23, s20, 9
  v_add_u32 v16, s23, v10
  s_nop 6
  ds_write_b128 v16, v[232:235]
  s_waitcnt lgkmcnt(0)
  s_branch fa_fissueD
fa_f6:
  s_cmp_ge_u32 s32, 8
  s_cbranch_scc1 fa_f8
  s_cmp_eq_u32 s32, 6
  s_cbranch_scc0 fa_f7
  ds_read_b128 v[16:19], v10 offset:0
  ds_read_b128 v[20:23], v10 offset:512
  ds_read_b128 v[24:27], v10 offset:1024
  ds_read_b128 v[28:31], v10 offset:1536
  s_waitcnt lgkmcnt(0)
  v_cvt_pk_bf16_f32 v16, v16, v16
  v_and_b32 v16, 0xffff0000, v16
  v_cvt_pk_bf16_f32 v17, v17, v17
  v_and_b32 v17, 0xffff0000, v17
  v_cvt_pk_bf16_f32 v18, v18, v18
  v_and_b32 v18, 0xffff0000, v18
  v_cvt_pk_bf16_f32 v19, v19, v19
  v_and_b32 v19, 0xffff0000, v19
  v_cvt_pk_bf16_f32 v20, v20, v20
  v_and_b32 v20, 0xffff0000, v20
  v_cvt_pk_bf16_f32 v21, v21, v21
  v_and_b32 v21, 0xffff0000, v21
  v_cvt_pk_bf16_f32 v22, v22, v22
  v_and_b32 v22, 0xffff0000, v22
  v_cvt_pk_bf16_f32 v23, v23, v23
  v_and_b32 v23, 0xffff0000, v23
  v_cvt_pk_bf16_f32 v24, v24, v24
  v_and_b32 v24, 0xffff0000, v24
  v_cvt_pk_bf16_f32 v25, v25, v25
  v_and_b32 v25, 0xffff0000, v25
  v_cvt_pk_bf16_f32 v26, v26, v26
  v_and_b32 v26, 0xffff0000, v26
  v_cvt_pk_bf16_f32 v27, v27, v27
  v_and_b32 v27, 0xffff0000, v27
  v_cvt_pk_bf16_f32 v28, v28, v28
  v_and_b32 v28, 0xffff0000, v28
  v_cvt_pk_bf16_f32 v29, v29, v29
  v_and_b32 v29, 0xffff0000, v29
  v_cvt_pk_bf16_f32 v30, v30, v30
  v_and_b32 v30, 0xffff0000, v30
  v_cvt_pk_bf16_f32 v31, v31, v31
  v_and_b32 v31, 0xffff0000, v31
  v_mul_f32 v236, 0xbfb8aa3b, v16
  v_mul_f32 v237, 0xbfb8aa3b, v17
  v_mul_f32 v238, 0xbfb8aa3b, v18
  v_mul_f32 v239, 0xbfb8aa3b, v19
  v_mul_f32 v240, 0xbfb8aa3b, v20
  v_mul_f32 v241, 0xbfb8aa3b, v21
  v_mul_f32 v242, 0xbfb8aa3b, v22
  v_mul_f32 v243, 0xbfb8aa3b, v23
  v_exp_f32 v236, v236
  v_exp_f32 v237, v237
  v_exp_f32 v238, v238
  v_exp_f32 v239, v239
  v_exp_f32 v240, v240
  v_exp_f32 v241, v241
  v_exp_f32 v242, v242
  v_exp_f32 v243, v243
  v_add_f32 v236, 1.0, v236
  v_add_f32 v237, 1.0, v237
  v_add_f32 v238, 1.0, v238
  v_add_f32 v239, 1.0, v239
  v_add_f32 v240, 1.0, v240
  v_add_f32 v241, 1.0, v241
  v_add_f32 v242, 1.0, v242
  v_add_f32 v243, 1.0, v243
  v_rcp_f32 v236, v236
  v_rcp_f32 v237, v237
  v_rcp_f32 v238, v238
  v_rcp_f32 v239, v239
  v_rcp_f32 v240, v240
  v_rcp_f32 v241, v241
  v_rcp_f32 v242, v242
  v_rcp_f32 v243, v243
  v_mul_f32 v16, v16, v236
  v_mul_f32 v17, v17, v237
  v_mul_f32 v18, v18, v238
  v_mul_f32 v19, v19, v239
  v_mul_f32 v20, v20, v240
  v_mul_f32 v21, v21, v241
  v_mul_f32 v22, v22, v242
  v_mul_f32 v23, v23, v243
  v_cvt_pk_bf16_f32 v16, v16, v16
  v_and_b32 v16, 0xffff0000, v16
  v_cvt_pk_bf16_f32 v17, v17, v17
  v_and_b32 v17, 0xffff0000, v17
  v_cvt_pk_bf16_f32 v18, v18, v18
  v_and_b32 v18, 0xffff0000, v18
  v_cvt_pk_bf16_f32 v19, v19, v19
  v_and_b32 v19, 0xffff0000, v19
  v_cvt_pk_bf16_f32 v20, v20, v20
  v_and_b32 v20, 0xffff0000, v20
  v_cvt_pk_bf16_f32 v21, v21, v21
  v_and_b32 v21, 0xffff0000, v21
  v_cvt_pk_bf16_f32 v22, v22, v22
  v_and_b32 v22, 0xffff0000, v22
  v_cvt_pk_bf16_f32 v23, v23, v23
  v_and_b32 v23, 0xffff0000, v23
  v_mul_f32 v16, v16, v24
  v_mul_f32 v17, v17, v25
  v_mul_f32 v18, v18, v26
  v_mul_f32 v19, v19, v27
  v_mul_f32 v20, v20, v28
  v_mul_f32 v21, v21, v29
  v_mul_f32 v22, v22, v30
  v_mul_f32 v23, v23, v31
  v_cvt_pk_bf16_f32 v232, v16, v17
  v_cvt_pk_bf16_f32 v233, v18, v19
  v_cvt_pk_bf16_f32 v234, v20, v21
  v_cvt_pk_bf16_f32 v235, v22, v23
fa_f7:
  s_waitcnt vmcnt(8)
  ds_read_b64_tr_b16 a[192:193], v6 offset:0
  ds_read_b64_tr_b16 a[194:195], v6 offset:2560
  ds_read_b64_tr_b16 a[196:197], v6 offset:32
  ds_read_b64_tr_b16 a[198:199], v6 offset:2592
  ds_read_b64_tr_b16 a[200:201], v6 offset:64
  ds_read_b64_tr_b16 a[202:203], v6 offset:2624
  ds_read_b64_tr_b16 a[204:205], v6 offset:96
  ds_read_b64_tr_b16 a[206:207], v6 offset:2656
  ds_read_b64_tr_b16 a[208:209], v6 offset:128
  ds_read_b64_tr_b16 a[210:211], v6 offset:2688
  s_waitcnt lgkmcnt(0)
  v_mfma_f32_16x16x32_bf16 v[236:239], a[192:195], v[232:235], 0
  v_mfma_f32_16x16x32_bf16 v[240:243], a[196:199], v[232:235], 0
  v_mfma_f32_16x16x32_bf16 v[244:247], a[200:203], v[232:235], 0
  v_mfma_f32_16x16x32_bf16 v[248:251], a[204:207], v[232:235], 0
  v_mfma_f32_16x16x32_bf16 v[252:255], a[208:211], v[232:235], 0
  s_nop 7
  buffer_store_dwordx4 v[236:239], v11, s[40:43], s36 offen offset:0 sc1
  buffer_store_dwordx4 v[240:243], v11, s[40:43], s36 offen offset:64 sc1
  buffer_store_dwordx4 v[244:247], v11, s[40:43], s36 offen offset:128 sc1
  buffer_store_dwordx4 v[248:251], v11, s[40:43], s36 offen offset:192 sc1
  buffer_store_dwordx4 v[252:255], v11, s[40:43], s36 offen offset:256 sc1
  s_add_u32 s36, s36, 320
  s_cmp_eq_u32 s32, 7
  s_cbranch_scc1 fa_fret
fa_fissueD:
  v_add_u32 v20, 0, v1
  v_mul_u32_u24 v19, 6554, v20
  s_add_u32 m0, s34, 0
  v_lshrrev_b32 v19, 16, v19
  v_mul_u32_u24 v19, 1120, v19
  v_lshl_add_u32 v19, v20, 4, v19
  buffer_load_dwordx4 v19, s[60:63], s35 offen lds
  v_add_u32 v20, 64, v1
  v_mul_u32_u24 v19, 6554, v20
  s_add_u32 m0, s34, 1024
  v_lshrrev_b32 v19, 16, v19
  v_mul_u32_u24 v19, 1120, v19
  v_lshl_add_u32 v19, v20, 4, v19
  buffer_load_dwordx4 v19, s[60:63], s35 offen lds
  v_add_u32 v20, 128, v1
  v_mul_u32_u24 v19, 6554, v20
  s_add_u32 m0, s34, 2048
  v_lshrrev_b32 v19, 16, v19
  v_mul_u32_u24 v19, 1120, v19
  v_lshl_add_u32 v19, v20, 4, v19
  buffer_load_dwordx4 v19, s[60:63], s35 offen lds
  v_add_u32 v20, 192, v1
  v_mul_u32_u24 v19, 6554, v20
  s_add_u32 m0, s34, 3072
  v_lshrrev_b32 v19, 16, v19
  v_mul_u32_u24 v19, 1120, v19
  v_lshl_add_u32 v19, v20, 4, v19
  buffer_load_dwordx4 v19, s[60:63], s35 offen lds
  v_add_u32 v20, 256, v1
  v_mul_u32_u24 v19, 6554, v20
  s_add_u32 m0, s34, 4096
  v_lshrrev_b32 v19, 16, v19
  v_mul_u32_u24 v19, 1120, v19
  v_lshl_add_u32 v19, v20, 4, v19
  buffer_load_dwordx4 v19, s[60:63], s35 offen lds
  s_add_u32 s35, s35, 160
  s_branch fa_fret
fa_f8:
  s_cmp_eq_u32 s32, 8
  s_cbranch_scc1 fa_fret
  s_and_b32 s23, s2, 63
  s_lshl_b32 s23, s23, 2
  s_add_u32 s23, s23, 2650112
  s_cmp_eq_u32 s20, 0
  s_cselect_b32 s23, s23, 1073741824
  v_mov_b32 v16, 1073741824
  v_mov_b32 v17, 1
  v_writelane_b32 v16, s23, 0
  buffer_store_dword v17, v16, s[40:43], 0 offen sc1
  s_mov_b32 s32, -1
fa_fret:
  s_add_u32 s32, s32, 1
  s_branch fa_fback
fa_stub0:
  s_call_b64 s[76:77], fa_rare00
  s_call_b64 s[76:77], fa_rare10
  s_branch fa_back0
fa_stub1:
  s_call_b64 s[76:77], fa_rare01
  s_call_b64 s[76:77], fa_rare11
  s_branch fa_back1
fa_stub2:
  s_call_b64 s[76:77], fa_rare00
  s_call_b64 s[76:77], fa_rare10
  s_branch fa_back2
fa_stub3:
  s_call_b64 s[76:77], fa_rare01
  s_call_b64 s[76:77], fa_rare11
  s_branch fa_back3
fa_stub4:
  s_call_b64 s[76:77], fa_rare00
  s_call_b64 s[76:77], fa_rare10
  s_branch fa_back4
fa_stub5:
  s_call_b64 s[76:77], fa_rare11
  s_branch fa_back5
fa_stub6:
  s_call_b64 s[76:77], fa_rare10
  s_branch fa_back6
fa_stub7:
  s_call_b64 s[76:77], fa_rare01
  s_call_b64 s[76:77], fa_rare11
  s_branch fa_back7
fa_stub8:
  s_call_b64 s[76:77], fa_rare10
  s_branch fa_back8
fa_stub9:
  s_call_b64 s[76:77], fa_rare11
  s_branch fa_back9
fa_stub10:
  s_call_b64 s[76:77], fa_rare10
  s_branch fa_back10
fa_stub11:
  s_call_b64 s[76:77], fa_rare11
  s_branch fa_back11
fa_stub12:
  s_call_b64 s[76:77], fa_rare10
  s_branch fa_back12
fa_stub13:
  s_call_b64 s[76:77], fa_rare11
  s_branch fa_back13
fa_codeend:
fa_rare00:
  s_nop 7
  v_max3_f32 v16, v96, v97, v98
  v_max3_f32 v16, v16, v99, v100
  v_max3_f32 v16, v16, v101, v102
  v_max3_f32 v16, v16, v103, 0
  v_mov_b32 v18, v16
  s_nop 1
  v_permlane16_swap_b32 v16, v18
  v_max_f32 v16, v16, v18
  v_mov_b32 v18, v16
  s_nop 1
  v_permlane32_swap_b32 v16, v18
  v_max_f32 v16, v16, v18
  v_sub_f32 v96, v96, v16
  v_sub_f32 v112, v112, v16
  v_sub_f32 v97, v97, v16
  v_sub_f32 v113, v113, v16
  v_sub_f32 v98, v98, v16
  v_sub_f32 v114, v114, v16
  v_sub_f32 v99, v99, v16
  v_sub_f32 v115, v115, v16
  v_sub_f32 v100, v100, v16
  v_sub_f32 v116, v116, v16
  v_sub_f32 v101, v101, v16
  v_sub_f32 v117, v117, v16
  v_sub_f32 v102, v102, v16
  v_sub_f32 v118, v118, v16
  v_sub_f32 v103, v103, v16
  v_sub_f32 v119, v119, v16
  v_max3_f32 v17, v104, v105, v106
  v_max3_f32 v17, v17, v107, v108
  v_max3_f32 v17, v17, v109, v110
  v_max3_f32 v17, v17, v111, 0
  v_mov_b32 v18, v17
  s_nop 1
  v_permlane16_swap_b32 v17, v18
  v_max_f32 v17, v17, v18
  v_mov_b32 v18, v17
  s_nop 1
  v_permlane32_swap_b32 v17, v18
  v_max_f32 v17, v17, v18
  v_sub_f32 v104, v104, v17
  v_sub_f32 v120, v120, v17
  v_sub_f32 v105, v105, v17
  v_sub_f32 v121, v121, v17
  v_sub_f32 v106, v106, v17
  v_sub_f32 v122, v122, v17
  v_sub_f32 v107, v107, v17
  v_sub_f32 v123, v123, v17
  v_sub_f32 v108, v108, v17
  v_sub_f32 v124, v124, v17
  v_sub_f32 v109, v109, v17
  v_sub_f32 v125, v125, v17
  v_sub_f32 v110, v110, v17
  v_sub_f32 v126, v126, v17
  v_sub_f32 v111, v111, v17
  v_sub_f32 v127, v127, v17
  s_call_b64 s[78:79], fa_resc0
  v_exp_f32 v208, v96
  v_exp_f32 v209, v97
  v_exp_f32 v210, v98
  v_add_f32 v224, v208, v209
  v_cvt_pk_bf16_f32 v160, v208, v209
  v_exp_f32 v211, v99
  v_add_f32 v224, v224, v210
  v_exp_f32 v212, v100
  v_add_f32 v224, v224, v211
  v_cvt_pk_bf16_f32 v161, v210, v211
  v_exp_f32 v213, v101
  v_add_f32 v224, v224, v212
  v_exp_f32 v214, v102
  v_add_f32 v224, v224, v213
  v_cvt_pk_bf16_f32 v162, v212, v213
  v_exp_f32 v215, v103
  v_add_f32 v224, v224, v214
  v_exp_f32 v208, v104
  v_add_f32 v224, v224, v215
  v_cvt_pk_bf16_f32 v163, v214, v215
  v_exp_f32 v209, v105
  v_exp_f32 v210, v106
  v_add_f32 v225, v208, v209
  v_cvt_pk_bf16_f32 v164, v208, v209
  v_exp_f32 v211, v107
  v_add_f32 v225, v225, v210
  v_exp_f32 v212, v108
  v_add_f32 v225, v225, v211
  v_cvt_pk_bf16_f32 v165, v210, v211
  v_exp_f32 v213, v109
  v_add_f32 v225, v225, v212
  v_exp_f32 v214, v110
  v_add_f32 v225, v225, v213
  v_cvt_pk_bf16_f32 v166, v212, v213
  v_exp_f32 v215, v111
  v_add_f32 v225, v225, v214
  s_nop 0
  v_add_f32 v225, v225, v215
  v_cvt_pk_bf16_f32 v167, v214, v215
  s_nop 1
  s_setpc_b64 s[76:77]
fa_rare01:
  s_nop 7
  v_max3_f32 v16, v112, v113, v114
  v_max3_f32 v16, v16, v115, v116
  v_max3_f32 v16, v16, v117, v118
  v_max3_f32 v16, v16, v119, 0
  v_mov_b32 v18, v16
  s_nop 1
  v_permlane16_swap_b32 v16, v18
  v_max_f32 v16, v16, v18
  v_mov_b32 v18, v16
  s_nop 1
  v_permlane32_swap_b32 v16, v18
  v_max_f32 v16, v16, v18
  v_sub_f32 v112, v112, v16
  v_sub_f32 v96, v96, v16
  v_sub_f32 v113, v113, v16
  v_sub_f32 v97, v97, v16
  v_sub_f32 v114, v114, v16
  v_sub_f32 v98, v98, v16
  v_sub_f32 v115, v115, v16
  v_sub_f32 v99, v99, v16
  v_sub_f32 v116, v116, v16
  v_sub_f32 v100, v100, v16
  v_sub_f32 v117, v117, v16
  v_sub_f32 v101, v101, v16
  v_sub_f32 v118, v118, v16
  v_sub_f32 v102, v102, v16
  v_sub_f32 v119, v119, v16
  v_sub_f32 v103, v103, v16
  v_max3_f32 v17, v120, v121, v122
  v_max3_f32 v17, v17, v123, v124
  v_max3_f32 v17, v17, v125, v126
  v_max3_f32 v17, v17, v127, 0
  v_mov_b32 v18, v17
  s_nop 1
  v_permlane16_swap_b32 v17, v18
  v_max_f32 v17, v17, v18
  v_mov_b32 v18, v17
  s_nop 1
  v_permlane32_swap_b32 v17, v18
  v_max_f32 v17, v17, v18
  v_sub_f32 v120, v120, v17
  v_sub_f32 v104, v104, v17
  v_sub_f32 v121, v121, v17
  v_sub_f32 v105, v105, v17
  v_sub_f32 v122, v122, v17
  v_sub_f32 v106, v106, v17
  v_sub_f32 v123, v123, v17
  v_sub_f32 v107, v107, v17
  v_sub_f32 v124, v124, v17
  v_sub_f32 v108, v108, v17
  v_sub_f32 v125, v125, v17
  v_sub_f32 v109, v109, v17
  v_sub_f32 v126, v126, v17
  v_sub_f32 v110, v110, v17
  v_sub_f32 v127, v127, v17
  v_sub_f32 v111, v111, v17
  s_call_b64 s[78:79], fa_resc0
  v_exp_f32 v208, v112
  v_exp_f32 v209, v113
  v_exp_f32 v210, v114
  v_add_f32 v224, v208, v209
  v_cvt_pk_bf16_f32 v168, v208, v209
  v_exp_f32 v211, v115
  v_add_f32 v224, v224, v210
  v_exp_f32 v212, v116
  v_add_f32 v224, v224, v211
  v_cvt_pk_bf16_f32 v169, v210, v211
  v_exp_f32 v213, v117
  v_add_f32 v224, v224, v212
  v_exp_f32 v214, v118
  v_add_f32 v224, v224, v213
  v_cvt_pk_bf16_f32 v170, v212, v213
  v_exp_f32 v215, v119
  v_add_f32 v224, v224, v214
  v_exp_f32 v208, v120
  v_add_f32 v224, v224, v215
  v_cvt_pk_bf16_f32 v171, v214, v215
  v_exp_f32 v209, v121
  v_exp_f32 v210, v122
  v_add_f32 v225, v208, v209
  v_cvt_pk_bf16_f32 v172, v208, v209
  v_exp_f32 v211, v123
  v_add_f32 v225, v225, v210
  v_exp_f32 v212, v124
  v_add_f32 v225, v225, v211
  v_cvt_pk_bf16_f32 v173, v210, v211
  v_exp_f32 v213, v125
  v_add_f32 v225, v225, v212
  v_exp_f32 v214, v126
  v_add_f32 v225, v225, v213
  v_cvt_pk_bf16_f32 v174, v212, v213
  v_exp_f32 v215, v127
  v_add_f32 v225, v225, v214
  s_nop 0
  v_add_f32 v225, v225, v215
  v_cvt_pk_bf16_f32 v175, v214, v215
  s_nop 1
  s_setpc_b64 s[76:77]
fa_resc0:
  v_sub_f32 v192, v192, v16
  v_sub_f32 v193, v193, v16
  v_sub_f32 v194, v194, v16
  v_sub_f32 v195, v195, v16
  v_exp_f32 v18, -v16
  v_sub_f32 v196, v196, v17
  v_sub_f32 v197, v197, v17
  v_sub_f32 v198, v198, v17
  v_sub_f32 v199, v199, v17
  v_exp_f32 v19, -v17
  s_nop 0
  v_mul_f32 v228, v228, v18
  v_mul_f32 v229, v229, v19
  v_accvgpr_read_b32 v20, a0
  v_accvgpr_read_b32 v21, a1
  v_accvgpr_read_b32 v22, a2
  v_accvgpr_read_b32 v23, a3
  v_mul_f32 v20, v20, v18
  v_mul_f32 v21, v21, v18
  v_mul_f32 v22, v22, v18
  v_mul_f32 v23, v23, v18
  v_accvgpr_write_b32 a0, v20
  v_accvgpr_write_b32 a1, v21
  v_accvgpr_write_b32 a2, v22
  v_accvgpr_write_b32 a3, v23
  v_accvgpr_read_b32 v20, a4
  v_accvgpr_read_b32 v21, a5
  v_accvgpr_read_b32 v22, a6
  v_accvgpr_read_b32 v23, a7
  v_mul_f32 v20, v20, v19
  v_mul_f32 v21, v21, v19
  v_mul_f32 v22, v22, v19
  v_mul_f32 v23, v23, v19
  v_accvgpr_write_b32 a4, v20
  v_accvgpr_write_b32 a5, v21
  v_accvgpr_write_b32 a6, v22
  v_accvgpr_write_b32 a7, v23
  v_accvgpr_read_b32 v20, a8
  v_accvgpr_read_b32 v21, a9
  v_accvgpr_read_b32 v22, a10
  v_accvgpr_read_b32 v23, a11
  v_mul_f32 v20, v20, v18
  v_mul_f32 v21, v21, v18
  v_mul_f32 v22, v22, v18
  v_mul_f32 v23, v23, v18
  v_accvgpr_write_b32 a8, v20
  v_accvgpr_write_b32 a9, v21
  v_accvgpr_write_b32 a10, v22
  v_accvgpr_write_b32 a11, v23
  v_accvgpr_read_b32 v20, a12
  v_accvgpr_read_b32 v21, a13
  v_accvgpr_read_b32 v22, a14
  v_accvgpr_read_b32 v23, a15
  v_mul_f32 v20, v20, v19
  v_mul_f32 v21, v21, v19
  v_mul_f32 v22, v22, v19
  v_mul_f32 v23, v23, v19
  v_accvgpr_write_b32 a12, v20
  v_accvgpr_write_b32 a13, v21
  v_accvgpr_write_b32 a14, v22
  v_accvgpr_write_b32 a15, v23
  v_accvgpr_read_b32 v20, a16
  v_accvgpr_read_b32 v21, a17
  v_accvgpr_read_b32 v22, a18
  v_accvgpr_read_b32 v23, a19
  v_mul_f32 v20, v20, v18
  v_mul_f32 v21, v21, v18
  v_mul_f32 v22, v22, v18
  v_mul_f32 v23, v23, v18
  v_accvgpr_write_b32 a16, v20
  v_accvgpr_write_b32 a17, v21
  v_accvgpr_write_b32 a18, v22
  v_accvgpr_write_b32 a19, v23
  v_accvgpr_read_b32 v20, a20
  v_accvgpr_read_b32 v21, a21
  v_accvgpr_read_b32 v22, a22
  v_accvgpr_read_b32 v23, a23
  v_mul_f32 v20, v20, v19
  v_mul_f32 v21, v21, v19
  v_mul_f32 v22, v22, v19
  v_mul_f32 v23, v23, v19
  v_accvgpr_write_b32 a20, v20
  v_accvgpr_write_b32 a21, v21
  v_accvgpr_write_b32 a22, v22
  v_accvgpr_write_b32 a23, v23
  v_accvgpr_read_b32 v20, a24
  v_accvgpr_read_b32 v21, a25
  v_accvgpr_read_b32 v22, a26
  v_accvgpr_read_b32 v23, a27
  v_mul_f32 v20, v20, v18
  v_mul_f32 v21, v21, v18
  v_mul_f32 v22, v22, v18
  v_mul_f32 v23, v23, v18
  v_accvgpr_write_b32 a24, v20
  v_accvgpr_write_b32 a25, v21
  v_accvgpr_write_b32 a26, v22
  v_accvgpr_write_b32 a27, v23
  v_accvgpr_read_b32 v20, a28
  v_accvgpr_read_b32 v21, a29
  v_accvgpr_read_b32 v22, a30
  v_accvgpr_read_b32 v23, a31
  v_mul_f32 v20, v20, v19
  v_mul_f32 v21, v21, v19
  v_mul_f32 v22, v22, v19
  v_mul_f32 v23, v23, v19
  v_accvgpr_write_b32 a28, v20
  v_accvgpr_write_b32 a29, v21
  v_accvgpr_write_b32 a30, v22
  v_accvgpr_write_b32 a31, v23
  v_accvgpr_read_b32 v20, a32
  v_accvgpr_read_b32 v21, a33
  v_accvgpr_read_b32 v22, a34
  v_accvgpr_read_b32 v23, a35
  v_mul_f32 v20, v20, v18
  v_mul_f32 v21, v21, v18
  v_mul_f32 v22, v22, v18
  v_mul_f32 v23, v23, v18
  v_accvgpr_write_b32 a32, v20
  v_accvgpr_write_b32 a33, v21
  v_accvgpr_write_b32 a34, v22
  v_accvgpr_write_b32 a35, v23
  v_accvgpr_read_b32 v20, a36
  v_accvgpr_read_b32 v21, a37
  v_accvgpr_read_b32 v22, a38
  v_accvgpr_read_b32 v23, a39
  v_mul_f32 v20, v20, v19
  v_mul_f32 v21, v21, v19
  v_mul_f32 v22, v22, v19
  v_mul_f32 v23, v23, v19
  v_accvgpr_write_b32 a36, v20
  v_accvgpr_write_b32 a37, v21
  v_accvgpr_write_b32 a38, v22
  v_accvgpr_write_b32 a39, v23
  v_accvgpr_read_b32 v20, a40
  v_accvgpr_read_b32 v21, a41
  v_accvgpr_read_b32 v22, a42
  v_accvgpr_read_b32 v23, a43
  v_mul_f32 v20, v20, v18
  v_mul_f32 v21, v21, v18
  v_mul_f32 v22, v22, v18
  v_mul_f32 v23, v23, v18
  v_accvgpr_write_b32 a40, v20
  v_accvgpr_write_b32 a41, v21
  v_accvgpr_write_b32 a42, v22
  v_accvgpr_write_b32 a43, v23
  v_accvgpr_read_b32 v20, a44
  v_accvgpr_read_b32 v21, a45
  v_accvgpr_read_b32 v22, a46
  v_accvgpr_read_b32 v23, a47
  v_mul_f32 v20, v20, v19
  v_mul_f32 v21, v21, v19
  v_mul_f32 v22, v22, v19
  v_mul_f32 v23, v23, v19
  v_accvgpr_write_b32 a44, v20
  v_accvgpr_write_b32 a45, v21
  v_accvgpr_write_b32 a46, v22
  v_accvgpr_write_b32 a47, v23
  v_accvgpr_read_b32 v20, a48
  v_accvgpr_read_b32 v21, a49
  v_accvgpr_read_b32 v22, a50
  v_accvgpr_read_b32 v23, a51
  v_mul_f32 v20, v20, v18
  v_mul_f32 v21, v21, v18
  v_mul_f32 v22, v22, v18
  v_mul_f32 v23, v23, v18
  v_accvgpr_write_b32 a48, v20
  v_accvgpr_write_b32 a49, v21
  v_accvgpr_write_b32 a50, v22
  v_accvgpr_write_b32 a51, v23
  v_accvgpr_read_b32 v20, a52
  v_accvgpr_read_b32 v21, a53
  v_accvgpr_read_b32 v22, a54
  v_accvgpr_read_b32 v23, a55
  v_mul_f32 v20, v20, v19
  v_mul_f32 v21, v21, v19
  v_mul_f32 v22, v22, v19
  v_mul_f32 v23, v23, v19
  v_accvgpr_write_b32 a52, v20
  v_accvgpr_write_b32 a53, v21
  v_accvgpr_write_b32 a54, v22
  v_accvgpr_write_b32 a55, v23
  v_accvgpr_read_b32 v20, a56
  v_accvgpr_read_b32 v21, a57
  v_accvgpr_read_b32 v22, a58
  v_accvgpr_read_b32 v23, a59
  v_mul_f32 v20, v20, v18
  v_mul_f32 v21, v21, v18
  v_mul_f32 v22, v22, v18
  v_mul_f32 v23, v23, v18
  v_accvgpr_write_b32 a56, v20
  v_accvgpr_write_b32 a57, v21
  v_accvgpr_write_b32 a58, v22
  v_accvgpr_write_b32 a59, v23
  v_accvgpr_read_b32 v20, a60
  v_accvgpr_read_b32 v21, a61
  v_accvgpr_read_b32 v22, a62
  v_accvgpr_read_b32 v23, a63
  v_mul_f32 v20, v20, v19
  v_mul_f32 v21, v21, v19
  v_mul_f32 v22, v22, v19
  v_mul_f32 v23, v23, v19
  v_accvgpr_write_b32 a60, v20
  v_accvgpr_write_b32 a61, v21
  v_accvgpr_write_b32 a62, v22
  v_accvgpr_write_b32 a63, v23
  s_setpc_b64 s[78:79]
fa_rare10:
  s_nop 7
  v_max3_f32 v16, v128, v129, v130
  v_max3_f32 v16, v16, v131, v132
  v_max3_f32 v16, v16, v133, v134
  v_max3_f32 v16, v16, v135, 0
  v_mov_b32 v18, v16
  s_nop 1
  v_permlane16_swap_b32 v16, v18
  v_max_f32 v16, v16, v18
  v_mov_b32 v18, v16
  s_nop 1
  v_permlane32_swap_b32 v16, v18
  v_max_f32 v16, v16, v18
  v_sub_f32 v128, v128, v16
  v_sub_f32 v144, v144, v16
  v_sub_f32 v129, v129, v16
  v_sub_f32 v145, v145, v16
  v_sub_f32 v130, v130, v16
  v_sub_f32 v146, v146, v16
  v_sub_f32 v131, v131, v16
  v_sub_f32 v147, v147, v16
  v_sub_f32 v132, v132, v16
  v_sub_f32 v148, v148, v16
  v_sub_f32 v133, v133, v16
  v_sub_f32 v149, v149, v16
  v_sub_f32 v134, v134, v16
  v_sub_f32 v150, v150, v16
  v_sub_f32 v135, v135, v16
  v_sub_f32 v151, v151, v16
  v_max3_f32 v17, v136, v137, v138
  v_max3_f32 v17, v17, v139, v140
  v_max3_f32 v17, v17, v141, v142
  v_max3_f32 v17, v17, v143, 0
  v_mov_b32 v18, v17
  s_nop 1
  v_permlane16_swap_b32 v17, v18
  v_max_f32 v17, v17, v18
  v_mov_b32 v18, v17
  s_nop 1
  v_permlane32_swap_b32 v17, v18
  v_max_f32 v17, v17, v18
  v_sub_f32 v136, v136, v17
  v_sub_f32 v152, v152, v17
  v_sub_f32 v137, v137, v17
  v_sub_f32 v153, v153, v17
  v_sub_f32 v138, v138, v17
  v_sub_f32 v154, v154, v17
  v_sub_f32 v139, v139, v17
  v_sub_f32 v155, v155, v17
  v_sub_f32 v140, v140, v17
  v_sub_f32 v156, v156, v17
  v_sub_f32 v141, v141, v17
  v_sub_f32 v157, v157, v17
  v_sub_f32 v142, v142, v17
  v_sub_f32 v158, v158, v17
  v_sub_f32 v143, v143, v17
  v_sub_f32 v159, v159, v17
  s_call_b64 s[78:79], fa_resc1
  v_exp_f32 v216, v128
  v_exp_f32 v217, v129
  v_exp_f32 v218, v130
  v_add_f32 v226, v216, v217
  v_cvt_pk_bf16_f32 v176, v216, v217
  v_exp_f32 v219, v131
  v_add_f32 v226, v226, v218
  v_exp_f32 v220, v132
  v_add_f32 v226, v226, v219
  v_cvt_pk_bf16_f32 v177, v218, v219
  v_exp_f32 v221, v133
  v_add_f32 v226, v226, v220
  v_exp_f32 v222, v134
  v_add_f32 v226, v226, v221
  v_cvt_pk_bf16_f32 v178, v220, v221
  v_exp_f32 v223, v135
  v_add_f32 v226, v226, v222
  v_exp_f32 v216, v136
  v_add_f32 v226, v226, v223
  v_cvt_pk_bf16_f32 v179, v222, v223
  v_exp_f32 v217, v137
  v_exp_f32 v218, v138
  v_add_f32 v227, v216, v217
  v_cvt_pk_bf16_f32 v180, v216, v217
  v_exp_f32 v219, v139
  v_add_f32 v227, v227, v218
  v_exp_f32 v220, v140
  v_add_f32 v227, v227, v219
  v_cvt_pk_bf16_f32 v181, v218, v219
  v_exp_f32 v221, v141
  v_add_f32 v227, v227, v220
  v_exp_f32 v222, v142
  v_add_f32 v227, v227, v221
  v_cvt_pk_bf16_f32 v182, v220, v221
  v_exp_f32 v223, v143
  v_add_f32 v227, v227, v222
  s_nop 0
  v_add_f32 v227, v227, v223
  v_cvt_pk_bf16_f32 v183, v222, v223
  s_nop 1
  s_setpc_b64 s[76:77]
fa_rare11:
  s_nop 7
  v_max3_f32 v16, v144, v145, v146
  v_max3_f32 v16, v16, v147, v148
  v_max3_f32 v16, v16, v149, v150
  v_max3_f32 v16, v16, v151, 0
  v_mov_b32 v18, v16
  s_nop 1
  v_permlane16_swap_b32 v16, v18
  v_max_f32 v16, v16, v18
  v_mov_b32 v18, v16
  s_nop 1
  v_permlane32_swap_b32 v16, v18
  v_max_f32 v16, v16, v18
  v_sub_f32 v144, v144, v16
  v_sub_f32 v128, v128, v16
  v_sub_f32 v145, v145, v16
  v_sub_f32 v129, v129, v16
  v_sub_f32 v146, v146, v16
  v_sub_f32 v130, v130, v16
  v_sub_f32 v147, v147, v16
  v_sub_f32 v131, v131, v16
  v_sub_f32 v148, v148, v16
  v_sub_f32 v132, v132, v16
  v_sub_f32 v149, v149, v16
  v_sub_f32 v133, v133, v16
  v_sub_f32 v150, v150, v16
  v_sub_f32 v134, v134, v16
  v_sub_f32 v151, v151, v16
  v_sub_f32 v135, v135, v16
  v_max3_f32 v17, v152, v153, v154
  v_max3_f32 v17, v17, v155, v156
  v_max3_f32 v17, v17, v157, v158
  v_max3_f32 v17, v17, v159, 0
  v_mov_b32 v18, v17
  s_nop 1
  v_permlane16_swap_b32 v17, v18
  v_max_f32 v17, v17, v18
  v_mov_b32 v18, v17
  s_nop 1
  v_permlane32_swap_b32 v17, v18
  v_max_f32 v17, v17, v18
  v_sub_f32 v152, v152, v17
  v_sub_f32 v136, v136, v17
  v_sub_f32 v153, v153, v17
  v_sub_f32 v137, v137, v17
  v_sub_f32 v154, v154, v17
  v_sub_f32 v138, v138, v17
  v_sub_f32 v155, v155, v17
  v_sub_f32 v139, v139, v17
  v_sub_f32 v156, v156, v17
  v_sub_f32 v140, v140, v17
  v_sub_f32 v157, v157, v17
  v_sub_f32 v141, v141, v17
  v_sub_f32 v158, v158, v17
  v_sub_f32 v142, v142, v17
  v_sub_f32 v159, v159, v17
  v_sub_f32 v143, v143, v17
  s_call_b64 s[78:79], fa_resc1
  v_exp_f32 v216, v144
  v_exp_f32 v217, v145
  v_exp_f32 v218, v146
  v_add_f32 v226, v216, v217
  v_cvt_pk_bf16_f32 v184, v216, v217
  v_exp_f32 v219, v147
  v_add_f32 v226, v226, v218
  v_exp_f32 v220, v148
  v_add_f32 v226, v226, v219
  v_cvt_pk_bf16_f32 v185, v218, v219
  v_exp_f32 v221, v149
  v_add_f32 v226, v226, v220
  v_exp_f32 v222, v150
  v_add_f32 v226, v226, v221
  v_cvt_pk_bf16_f32 v186, v220, v221
  v_exp_f32 v223, v151
  v_add_f32 v226, v226, v222
  v_exp_f32 v216, v152
  v_add_f32 v226, v226, v223
  v_cvt_pk_bf16_f32 v187, v222, v223
  v_exp_f32 v217, v153
  v_exp_f32 v218, v154
  v_add_f32 v227, v216, v217
  v_cvt_pk_bf16_f32 v188, v216, v217
  v_exp_f32 v219, v155
  v_add_f32 v227, v227, v218
  v_exp_f32 v220, v156
  v_add_f32 v227, v227, v219
  v_cvt_pk_bf16_f32 v189, v218, v219
  v_exp_f32 v221, v157
  v_add_f32 v227, v227, v220
  v_exp_f32 v222, v158
  v_add_f32 v227, v227, v221
  v_cvt_pk_bf16_f32 v190, v220, v221
  v_exp_f32 v223, v159
  v_add_f32 v227, v227, v222
  s_nop 0
  v_add_f32 v227, v227, v223
  v_cvt_pk_bf16_f32 v191, v222, v223
  s_nop 1
  s_setpc_b64 s[76:77]
fa_resc1:
  v_sub_f32 v200, v200, v16
  v_sub_f32 v201, v201, v16
  v_sub_f32 v202, v202, v16
  v_sub_f32 v203, v203, v16
  v_exp_f32 v18, -v16
  v_sub_f32 v204, v204, v17
  v_sub_f32 v205, v205, v17
  v_sub_f32 v206, v206, v17
  v_sub_f32 v207, v207, v17
  v_exp_f32 v19, -v17
  s_nop 0
  v_mul_f32 v230, v230, v18
  v_mul_f32 v231, v231, v19
  v_accvgpr_read_b32 v20, a64
  v_accvgpr_read_b32 v21, a65
  v_accvgpr_read_b32 v22, a66
  v_accvgpr_read_b32 v23, a67
  v_mul_f32 v20, v20, v18
  v_mul_f32 v21, v21, v18
  v_mul_f32 v22, v22, v18
  v_mul_f32 v23, v23, v18
  v_accvgpr_write_b32 a64, v20
  v_accvgpr_write_b32 a65, v21
  v_accvgpr_write_b32 a66, v22
  v_accvgpr_write_b32 a67, v23
  v_accvgpr_read_b32 v20, a68
  v_accvgpr_read_b32 v21, a69
  v_accvgpr_read_b32 v22, a70
  v_accvgpr_read_b32 v23, a71
  v_mul_f32 v20, v20, v19
  v_mul_f32 v21, v21, v19
  v_mul_f32 v22, v22, v19
  v_mul_f32 v23, v23, v19
  v_accvgpr_write_b32 a68, v20
  v_accvgpr_write_b32 a69, v21
  v_accvgpr_write_b32 a70, v22
  v_accvgpr_write_b32 a71, v23
  v_accvgpr_read_b32 v20, a72
  v_accvgpr_read_b32 v21, a73
  v_accvgpr_read_b32 v22, a74
  v_accvgpr_read_b32 v23, a75
  v_mul_f32 v20, v20, v18
  v_mul_f32 v21, v21, v18
  v_mul_f32 v22, v22, v18
  v_mul_f32 v23, v23, v18
  v_accvgpr_write_b32 a72, v20
  v_accvgpr_write_b32 a73, v21
  v_accvgpr_write_b32 a74, v22
  v_accvgpr_write_b32 a75, v23
  v_accvgpr_read_b32 v20, a76
  v_accvgpr_read_b32 v21, a77
  v_accvgpr_read_b32 v22, a78
  v_accvgpr_read_b32 v23, a79
  v_mul_f32 v20, v20, v19
  v_mul_f32 v21, v21, v19
  v_mul_f32 v22, v22, v19
  v_mul_f32 v23, v23, v19
  v_accvgpr_write_b32 a76, v20
  v_accvgpr_write_b32 a77, v21
  v_accvgpr_write_b32 a78, v22
  v_accvgpr_write_b32 a79, v23
  v_accvgpr_read_b32 v20, a80
  v_accvgpr_read_b32 v21, a81
  v_accvgpr_read_b32 v22, a82
  v_accvgpr_read_b32 v23, a83
  v_mul_f32 v20, v20, v18
  v_mul_f32 v21, v21, v18
  v_mul_f32 v22, v22, v18
  v_mul_f32 v23, v23, v18
  v_accvgpr_write_b32 a80, v20
  v_accvgpr_write_b32 a81, v21
  v_accvgpr_write_b32 a82, v22
  v_accvgpr_write_b32 a83, v23
  v_accvgpr_read_b32 v20, a84
  v_accvgpr_read_b32 v21, a85
  v_accvgpr_read_b32 v22, a86
  v_accvgpr_read_b32 v23, a87
  v_mul_f32 v20, v20, v19
  v_mul_f32 v21, v21, v19
  v_mul_f32 v22, v22, v19
  v_mul_f32 v23, v23, v19
  v_accvgpr_write_b32 a84, v20
  v_accvgpr_write_b32 a85, v21
  v_accvgpr_write_b32 a86, v22
  v_accvgpr_write_b32 a87, v23
  v_accvgpr_read_b32 v20, a88
  v_accvgpr_read_b32 v21, a89
  v_accvgpr_read_b32 v22, a90
  v_accvgpr_read_b32 v23, a91
  v_mul_f32 v20, v20, v18
  v_mul_f32 v21, v21, v18
  v_mul_f32 v22, v22, v18
  v_mul_f32 v23, v23, v18
  v_accvgpr_write_b32 a88, v20
  v_accvgpr_write_b32 a89, v21
  v_accvgpr_write_b32 a90, v22
  v_accvgpr_write_b32 a91, v23
  v_accvgpr_read_b32 v20, a92
  v_accvgpr_read_b32 v21, a93
  v_accvgpr_read_b32 v22, a94
  v_accvgpr_read_b32 v23, a95
  v_mul_f32 v20, v20, v19
  v_mul_f32 v21, v21, v19
  v_mul_f32 v22, v22, v19
  v_mul_f32 v23, v23, v19
  v_accvgpr_write_b32 a92, v20
  v_accvgpr_write_b32 a93, v21
  v_accvgpr_write_b32 a94, v22
  v_accvgpr_write_b32 a95, v23
  v_accvgpr_read_b32 v20, a96
  v_accvgpr_read_b32 v21, a97
  v_accvgpr_read_b32 v22, a98
  v_accvgpr_read_b32 v23, a99
  v_mul_f32 v20, v20, v18
  v_mul_f32 v21, v21, v18
  v_mul_f32 v22, v22, v18
  v_mul_f32 v23, v23, v18
  v_accvgpr_write_b32 a96, v20
  v_accvgpr_write_b32 a97, v21
  v_accvgpr_write_b32 a98, v22
  v_accvgpr_write_b32 a99, v23
  v_accvgpr_read_b32 v20, a100
  v_accvgpr_read_b32 v21, a101
  v_accvgpr_read_b32 v22, a102
  v_accvgpr_read_b32 v23, a103
  v_mul_f32 v20, v20, v19
  v_mul_f32 v21, v21, v19
  v_mul_f32 v22, v22, v19
  v_mul_f32 v23, v23, v19
  v_accvgpr_write_b32 a100, v20
  v_accvgpr_write_b32 a101, v21
  v_accvgpr_write_b32 a102, v22
  v_accvgpr_write_b32 a103, v23
  v_accvgpr_read_b32 v20, a104
  v_accvgpr_read_b32 v21, a105
  v_accvgpr_read_b32 v22, a106
  v_accvgpr_read_b32 v23, a107
  v_mul_f32 v20, v20, v18
  v_mul_f32 v21, v21, v18
  v_mul_f32 v22, v22, v18
  v_mul_f32 v23, v23, v18
  v_accvgpr_write_b32 a104, v20
  v_accvgpr_write_b32 a105, v21
  v_accvgpr_write_b32 a106, v22
  v_accvgpr_write_b32 a107, v23
  v_accvgpr_read_b32 v20, a108
  v_accvgpr_read_b32 v21, a109
  v_accvgpr_read_b32 v22, a110
  v_accvgpr_read_b32 v23, a111
  v_mul_f32 v20, v20, v19
  v_mul_f32 v21, v21, v19
  v_mul_f32 v22, v22, v19
  v_mul_f32 v23, v23, v19
  v_accvgpr_write_b32 a108, v20
  v_accvgpr_write_b32 a109, v21
  v_accvgpr_write_b32 a110, v22
  v_accvgpr_write_b32 a111, v23
  v_accvgpr_read_b32 v20, a112
  v_accvgpr_read_b32 v21, a113
  v_accvgpr_read_b32 v22, a114
  v_accvgpr_read_b32 v23, a115
  v_mul_f32 v20, v20, v18
  v_mul_f32 v21, v21, v18
  v_mul_f32 v22, v22, v18
  v_mul_f32 v23, v23, v18
  v_accvgpr_write_b32 a112, v20
  v_accvgpr_write_b32 a113, v21
  v_accvgpr_write_b32 a114, v22
  v_accvgpr_write_b32 a115, v23
  v_accvgpr_read_b32 v20, a116
  v_accvgpr_read_b32 v21, a117
  v_accvgpr_read_b32 v22, a118
  v_accvgpr_read_b32 v23, a119
  v_mul_f32 v20, v20, v19
  v_mul_f32 v21, v21, v19
  v_mul_f32 v22, v22, v19
  v_mul_f32 v23, v23, v19
  v_accvgpr_write_b32 a116, v20
  v_accvgpr_write_b32 a117, v21
  v_accvgpr_write_b32 a118, v22
  v_accvgpr_write_b32 a119, v23
  v_accvgpr_read_b32 v20, a120
  v_accvgpr_read_b32 v21, a121
  v_accvgpr_read_b32 v22, a122
  v_accvgpr_read_b32 v23, a123
  v_mul_f32 v20, v20, v18
  v_mul_f32 v21, v21, v18
  v_mul_f32 v22, v22, v18
  v_mul_f32 v23, v23, v18
  v_accvgpr_write_b32 a120, v20
  v_accvgpr_write_b32 a121, v21
  v_accvgpr_write_b32 a122, v22
  v_accvgpr_write_b32 a123, v23
  v_accvgpr_read_b32 v20, a124
  v_accvgpr_read_b32 v21, a125
  v_accvgpr_read_b32 v22, a126
  v_accvgpr_read_b32 v23, a127
  v_mul_f32 v20, v20, v19
  v_mul_f32 v21, v21, v19
  v_mul_f32 v22, v22, v19
  v_mul_f32 v23, v23, v19
  v_accvgpr_write_b32 a124, v20
  v_accvgpr_write_b32 a125, v21
  v_accvgpr_write_b32 a126, v22
  v_accvgpr_write_b32 a127, v23
  s_setpc_b64 s[78:79]
.section .rodata,"a"
.p2align 6
.amdhsa_kernel fa_kernel
  .amdhsa_next_free_vgpr 512
  .amdhsa_next_free_sgpr 102
  .amdhsa_accum_offset 256
  .amdhsa_group_segment_fixed_size 0
  .amdhsa_kernarg_size 112
  .amdhsa_user_sgpr_count 2
  .amdhsa_user_sgpr_kernarg_segment_ptr 1
  .amdhsa_system_sgpr_workgroup_id_x 1
  .amdhsa_float_denorm_mode_32 3
.end_amdhsa_kernel
.text
.globl k3_kernel
.p2align 8
.type k3_kernel,@function
k3_kernel:
  s_cmp_ge_u32 s2, 256
  s_cbranch_scc1 k3_end
  s_load_dwordx2 s[4:5], s[0:1], 0
  s_load_dwordx2 s[6:7], s[0:1], 88
  s_load_dwordx2 s[16:17], s[0:1], 104
  v_lshrrev_b32 v4, 6, v0
  v_and_b32 v1, 63, v0
  v_readfirstlane_b32 s20, v4
  s_and_b32 s21, s2, 7
  s_lshl_b32 s21, s21, 2
  s_lshr_b32 s23, s2, 3
  s_and_b32 s23, s23, 3
  s_add_u32 s21, s21, s23
  s_lshr_b32 s22, s2, 5
  v_lshlrev_b32 v2, 4, v1
  s_lshl_b32 s48, s21, 19
  s_lshl_b32 s23, s20, 15
  s_add_u32 s48, s48, s23
  s_add_u32 s48, s48, 50331648
  s_add_u32 s49, s48, 131072
  s_add_u32 s50, s48, 262144
  s_add_u32 s51, s48, 393216
  s_lshl_b32 s23, s22, 2
  s_add_u32 s23, s23, s20
  s_mul_i32 s52, s23, 163840
  s_add_u32 s52, s52, 4194304
  s_add_u32 s53, s52, 4096
  s_add_u32 s54, s52, 8192
  s_add_u32 s55, s52, 12288
  s_add_u32 s56, s52, 16384
  s_waitcnt lgkmcnt(0)
  s_mov_b32 s32, s16
  s_mov_b32 s33, s17
  s_mov_b32 s34, 67108864
  s_mov_b32 s35, 0x20000
  s_mov_b32 s36, s16
  s_mov_b32 s37, s17
  s_mov_b32 s38, 67108864
  s_mov_b32 s39, 0x20000
  s_mov_b32 s40, s4
  s_mov_b32 s41, s5
  s_mov_b32 s42, 2621440
  s_mov_b32 s43, 0x20000
  s_mov_b32 s44, s6
  s_mov_b32 s45, s7
  s_mov_b32 s46, 2621440
  s_mov_b32 s47, 0x20000
  s_add_u32 s18, s16, 2629632
  s_addc_u32 s19, s17, 0
  s_load_dwordx16 s[64:79], s[18:19], 0
  buffer_load_dwordx4 v[100:103], v2, s[32:35], s52 offen offset:0
  buffer_load_dwordx4 v[104:107], v2, s[32:35], s52 offen offset:1024
  buffer_load_dwordx4 v[108:111], v2, s[32:35], s52 offen offset:2048
  buffer_load_dwordx4 v[112:115], v2, s[32:35], s52 offen offset:3072
  buffer_load_dwordx4 v[116:119], v2, s[32:35], s53 offen offset:0
  buffer_load_dwordx4 v[120:123], v2, s[32:35], s48 offen offset:0
  buffer_load_dwordx4 v[124:127], v2, s[32:35], s49 offen offset:0
  buffer_load_dwordx4 v[128:131], v2, s[32:35], s50 offen offset:0
  buffer_load_dwordx4 v[132:135], v2, s[32:35], s51 offen offset:0
  buffer_load_dwordx4 v[136:139], v2, s[32:35], s53 offen offset:1024
  buffer_load_dwordx4 v[140:143], v2, s[32:35], s53 offen offset:2048
  buffer_load_dwordx4 v[144:147], v2, s[32:35], s53 offen offset:3072
  buffer_load_dwordx4 v[148:151], v2, s[32:35], s54 offen offset:0
  buffer_load_dwordx4 v[152:155], v2, s[32:35], s54 offen offset:1024
  buffer_load_dwordx4 v[156:159], v2, s[32:35], s48 offen offset:1024
  buffer_load_dwordx4 v[160:163], v2, s[32:35], s49 offen offset:1024
  buffer_load_dwordx4 v[164:167], v2, s[32:35], s50 offen offset:1024
  buffer_load_dwordx4 v[168:171], v2, s[32:35], s51 offen offset:1024
  buffer_load_dwordx4 v[172:175], v2, s[32:35], s54 offen offset:2048
  buffer_load_dwordx4 v[176:179], v2, s[32:35], s54 offen offset:3072
  buffer_load_dwordx4 v[180:183], v2, s[32:35], s55 offen offset:0
  buffer_load_dwordx4 v[184:187], v2, s[32:35], s55 offen offset:1024
  buffer_load_dwordx4 v[188:191], v2, s[32:35], s55 offen offset:2048
  buffer_load_dwordx4 v[192:195], v2, s[32:35], s48 offen offset:2048
  buffer_load_dwordx4 v[196:199], v2, s[32:35], s49 offen offset:2048
  buffer_load_dwordx4 v[200:203], v2, s[32:35], s50 offen offset:2048
  buffer_load_dwordx4 v[204:207], v2, s[32:35], s51 offen offset:2048
  buffer_load_dwordx4 v[208:211], v2, s[32:35], s55 offen offset:3072
  buffer_load_dwordx4 v[212:215], v2, s[32:35], s56 offen offset:0
  buffer_load_dwordx4 v[216:219], v2, s[32:35], s56 offen offset:1024
  buffer_load_dwordx4 v[220:223], v2, s[32:35], s56 offen offset:2048
  buffer_load_dwordx4 v[224:227], v2, s[32:35], s56 offen offset:3072
  buffer_load_dwordx4 v[228:231], v2, s[32:35], s48 offen offset:3072
  buffer_load_dwordx4 v[232:235], v2, s[32:35], s49 offen offset:3072
  buffer_load_dwordx4 v[236:239], v2, s[32:35], s50 offen offset:3072
  buffer_load_dwordx4 v[240:243], v2, s[32:35], s51 offen offset:3072
  s_add_u32 s48, s48, 4096
  s_add_u32 s49, s49, 4096
  s_add_u32 s50, s50, 4096
  s_add_u32 s51, s51, 4096
  s_add_u32 s52, s52, 20480
  s_add_u32 s53, s53, 20480
  s_add_u32 s54, s54, 20480
  s_add_u32 s55, s55, 20480
  s_add_u32 s56, s56, 20480
  v_mov_b32 v8, 0
  v_mov_b32 v9, 0
  v_mov_b32 v10, 0
  v_mov_b32 v11, 0
  v_lshlrev_b32 v4, 4, v0
  v_add_u32 v4, 86016, v4
  v_mfma_f32_32x32x16_bf16 v[20:35], v[8:11], v[8:11], 0
  v_mfma_f32_32x32x16_bf16 v[36:51], v[8:11], v[8:11], 0
  v_mfma_f32_32x32x16_bf16 v[52:67], v[8:11], v[8:11], 0
  v_mfma_f32_32x32x16_bf16 v[68:83], v[8:11], v[8:11], 0
  v_mfma_f32_32x32x16_bf16 v[84:99], v[8:11], v[8:11], 0
  ds_write_b128 v4, v[8:11] offset:0
  ds_write_b128 v4, v[8:11] offset:4096
  ds_write_b128 v4, v[8:11] offset:8192
  ds_write_b128 v4, v[8:11] offset:12288
  ds_write_b128 v4, v[8:11] offset:16384
  ds_write_b128 v4, v[8:11] offset:20480
  s_lshl_b32 s25, s21, 6
  s_mul_i32 s26, s22, 160
  s_mul_i32 s27, s22, 2560
  v_add_u32 v4, 0, v0
  v_mul_u32_u24 v5, 6554, v4
  v_lshrrev_b32 v5, 16, v5
  v_mul_u32_u24 v6, 10, v5
  v_sub_u32 v6, v4, v6
  v_mul_u32_u24 v15, 336, v5
  v_lshl_add_u32 v15, v6, 5, v15
  v_add_u32 v5, s25, v5
  v_mul_u32_u24 v12, 1280, v5
  v_lshl_add_u32 v12, v6, 4, v12
  v_add_u32 v12, s26, v12
  v_lshrrev_b32 v7, 4, v5
  v_mul_u32_u24 v7, 20480, v7
  v_and_b32 v5, 15, v5
  v_lshl_add_u32 v7, v5, 4, v7
  v_lshl_add_u32 v244, v6, 8, v7
  v_add_u32 v4, 256, v0
  v_mul_u32_u24 v5, 6554, v4
  v_lshrrev_b32 v5, 16, v5
  v_mul_u32_u24 v6, 10, v5
  v_sub_u32 v6, v4, v6
  v_mul_u32_u24 v16, 336, v5
  v_lshl_add_u32 v16, v6, 5, v16
  v_add_u32 v5, s25, v5
  v_mul_u32_u24 v13, 1280, v5
  v_lshl_add_u32 v13, v6, 4, v13
  v_add_u32 v13, s26, v13
  v_lshrrev_b32 v7, 4, v5
  v_mul_u32_u24 v7, 20480, v7
  v_and_b32 v5, 15, v5
  v_lshl_add_u32 v7, v5, 4, v7
  v_lshl_add_u32 v245, v6, 8, v7
  v_add_u32 v4, 512, v0
  v_mul_u32_u24 v5, 6554, v4
  v_lshrrev_b32 v5, 16, v5
  v_mul_u32_u24 v6, 10, v5
  v_sub_u32 v6, v4, v6
  v_mul_u32_u24 v17, 336, v5
  v_lshl_add_u32 v17, v6, 5, v17
  v_add_u32 v5, s25, v5
  v_mul_u32_u24 v14, 1280, v5
  v_lshl_add_u32 v14, v6, 4, v14
  v_add_u32 v14, s26, v14
  v_lshrrev_b32 v7, 4, v5
  v_mul_u32_u24 v7, 20480, v7
  v_and_b32 v5, 15, v5
  v_lshl_add_u32 v7, v5, 4, v7
  v_lshl_add_u32 v246, v6, 8, v7
  v_cmp_gt_u32 vcc, 128, v0
  v_mov_b32 v4, 0x40000000
  v_mov_b32 v5, 0
  v_cndmask_b32 v14, v4, v14, vcc
  v_cndmask_b32 v246, v4, v246, vcc
  v_cndmask_b32 v17, v5, v17, vcc
  s_waitcnt lgkmcnt(0)
  s_barrier
  s_mov_b32 s28, s64
  s_mov_b32 s30, s72
  s_cmp_eq_u32 s20, 1
  s_cselect_b32 s28, s66, s28
  s_cselect_b32 s30, s74, s30
  s_cmp_eq_u32 s20, 2
  s_cselect_b32 s28, s68, s28
  s_cselect_b32 s30, s76, s30
  s_cmp_eq_u32 s20, 3
  s_cselect_b32 s28, s70, s28
  s_cselect_b32 s30, s78, s30
  s_mov_b32 s29, s65
  s_mov_b32 s31, s73
  s_cmp_eq_u32 s20, 1
  s_cselect_b32 s29, s67, s29
  s_cselect_b32 s31, s75, s31
  s_cmp_eq_u32 s20, 2
  s_cselect_b32 s29, s69, s29
  s_cselect_b32 s31, s77, s31
  s_cmp_eq_u32 s20, 3
  s_cselect_b32 s29, s71, s29
  s_cselect_b32 s31, s79, s31
  s_sub_u32 s23, s28, s25
  s_cmp_ge_u32 s23, 64
  s_cbranch_scc1 k3_nosel0
  v_mul_u32_u24 v4, 3277, v1
  v_lshrrev_b32 v4, 16, v4
  v_mul_u32_u24 v5, 20, v4
  v_sub_u32 v5, v1, v5
  v_lshlrev_b32 v5, 4, v5
  v_mul_u32_u24 v6, 368640, v4
  v_add_u32 v6, v6, v5
  v_cmp_gt_u32 vcc, 3, v4
  v_mov_b32 v7, 0x40000000
  s_lshl_b32 s58, s20, 1
  v_cndmask_b32 v6, v7, v6, vcc
  s_add_u32 s58, s58, 0
  s_mul_i32 s58, s58, 2560
  s_mul_i32 s59, s22, 320
  s_add_u32 s58, s58, s59
  s_add_u32 s58, s58, 2686976
  s_mov_b32 s59, 9
  v_mov_b32 v8, 0
  v_mov_b32 v9, 0
  v_mov_b32 v10, 0
  v_mov_b32 v11, 0
k3_yl0:
  buffer_load_dwordx4 v[248:251], v6, s[36:39], s58 offen
  s_add_u32 s58, s58, 20480
  buffer_load_dwordx4 v[252:255], v6, s[36:39], s58 offen
  s_add_u32 s58, s58, 20480
  s_waitcnt vmcnt(0)
  v_add_f32 v8, v8, v248
  v_add_f32 v9, v9, v249
  v_add_f32 v10, v10, v250
  v_add_f32 v11, v11, v251
  v_add_f32 v8, v8, v252
  v_add_f32 v9, v9, v253
  v_add_f32 v10, v10, v254
  v_add_f32 v11, v11, v255
  s_sub_u32 s59, s59, 1
  s_cmp_lg_u32 s59, 0
  s_cbranch_scc1 k3_yl0
  s_lshl_b32 s58, s20, 10
  s_add_u32 s58, s58, 107520
  v_add_u32 v7, s58, v2
  ds_write_b128 v7, v[8:11]
  v_add_u32 v7, s58, v5
  s_waitcnt lgkmcnt(0)
  ds_read_b128 v[8:11], v7
  ds_read_b128 v[248:251], v7 offset:320
  ds_read_b128 v[252:255], v7 offset:640
  s_mul_i32 s23, s23, 336
  s_add_u32 s23, s23, 86016
  v_add_u32 v7, s23, v5
  s_waitcnt lgkmcnt(0)
  v_add_f32 v8, v8, v248
  v_add_f32 v8, v8, v252
  v_cvt_pk_bf16_f32 v8, v8, v8
  v_and_b32 v8, 0xffff0000, v8
  v_mul_f32 v8, s30, v8
  v_cvt_pk_bf16_f32 v8, v8, v8
  v_and_b32 v8, 0xffff0000, v8
  v_add_f32 v9, v9, v249
  v_add_f32 v9, v9, v253
  v_cvt_pk_bf16_f32 v9, v9, v9
  v_and_b32 v9, 0xffff0000, v9
  v_mul_f32 v9, s30, v9
  v_cvt_pk_bf16_f32 v9, v9, v9
  v_and_b32 v9, 0xffff0000, v9
  v_add_f32 v10, v10, v250
  v_add_f32 v10, v10, v254
  v_cvt_pk_bf16_f32 v10, v10, v10
  v_and_b32 v10, 0xffff0000, v10
  v_mul_f32 v10, s30, v10
  v_cvt_pk_bf16_f32 v10, v10, v10
  v_and_b32 v10, 0xffff0000, v10
  v_add_f32 v11, v11, v251
  v_add_f32 v11, v11, v255
  v_cvt_pk_bf16_f32 v11, v11, v11
  v_and_b32 v11, 0xffff0000, v11
  v_mul_f32 v11, s30, v11
  v_cvt_pk_bf16_f32 v11, v11, v11
  v_and_b32 v11, 0xffff0000, v11
  ds_write_b128 v7, v[8:11]
  s_waitcnt lgkmcnt(0)
k3_nosel0:
  s_sub_u32 s23, s29, s25
  s_cmp_ge_u32 s23, 64
  s_cbranch_scc1 k3_nosel1
  v_mul_u32_u24 v4, 3277, v1
  v_lshrrev_b32 v4, 16, v4
  v_mul_u32_u24 v5, 20, v4
  v_sub_u32 v5, v1, v5
  v_lshlrev_b32 v5, 4, v5
  v_mul_u32_u24 v6, 368640, v4
  v_add_u32 v6, v6, v5
  v_cmp_gt_u32 vcc, 3, v4
  v_mov_b32 v7, 0x40000000
  s_lshl_b32 s58, s20, 1
  v_cndmask_b32 v6, v7, v6, vcc
  s_add_u32 s58, s58, 1
  s_mul_i32 s58, s58, 2560
  s_mul_i32 s59, s22, 320
  s_add_u32 s58, s58, s59
  s_add_u32 s58, s58, 2686976
  s_mov_b32 s59, 9
  v_mov_b32 v8, 0
  v_mov_b32 v9, 0
  v_mov_b32 v10, 0
  v_mov_b32 v11, 0
k3_yl1:
  buffer_load_dwordx4 v[248:251], v6, s[36:39], s58 offen
  s_add_u32 s58, s58, 20480
  buffer_load_dwordx4 v[252:255], v6, s[36:39], s58 offen
  s_add_u32 s58, s58, 20480
  s_waitcnt vmcnt(0)
  v_add_f32 v8, v8, v248
  v_add_f32 v9, v9, v249
  v_add_f32 v10, v10, v250
  v_add_f32 v11, v11, v251
  v_add_f32 v8, v8, v252
  v_add_f32 v9, v9, v253
  v_add_f32 v10, v10, v254
  v_add_f32 v11, v11, v255
  s_sub_u32 s59, s59, 1
  s_cmp_lg_u32 s59, 0
  s_cbranch_scc1 k3_yl1
  s_lshl_b32 s58, s20, 10
  s_add_u32 s58, s58, 107520
  v_add_u32 v7, s58, v2
  ds_write_b128 v7, v[8:11]
  v_add_u32 v7, s58, v5
  s_waitcnt lgkmcnt(0)
  ds_read_b128 v[8:11], v7
  ds_read_b128 v[248:251], v7 offset:320
  ds_read_b128 v[252:255], v7 offset:640
  s_mul_i32 s23, s23, 336
  s_add_u32 s23, s23, 86016
  v_add_u32 v7, s23, v5
  s_waitcnt lgkmcnt(0)
  v_add_f32 v8, v8, v248
  v_add_f32 v8, v8, v252
  v_cvt_pk_bf16_f32 v8, v8, v8
  v_and_b32 v8, 0xffff0000, v8
  v_mul_f32 v8, s31, v8
  v_cvt_pk_bf16_f32 v8, v8, v8
  v_and_b32 v8, 0xffff0000, v8
  v_add_f32 v9, v9, v249
  v_add_f32 v9, v9, v253
  v_cvt_pk_bf16_f32 v9, v9, v9
  v_and_b32 v9, 0xffff0000, v9
  v_mul_f32 v9, s31, v9
  v_cvt_pk_bf16_f32 v9, v9, v9
  v_and_b32 v9, 0xffff0000, v9
  v_add_f32 v10, v10, v250
  v_add_f32 v10, v10, v254
  v_cvt_pk_bf16_f32 v10, v10, v10
  v_and_b32 v10, 0xffff0000, v10
  v_mul_f32 v10, s31, v10
  v_cvt_pk_bf16_f32 v10, v10, v10
  v_and_b32 v10, 0xffff0000, v10
  v_add_f32 v11, v11, v251
  v_add_f32 v11, v11, v255
  v_cvt_pk_bf16_f32 v11, v11, v11
  v_and_b32 v11, 0xffff0000, v11
  v_mul_f32 v11, s31, v11
  v_cvt_pk_bf16_f32 v11, v11, v11
  v_and_b32 v11, 0xffff0000, v11
  ds_write_b128 v7, v[8:11]
  s_waitcnt lgkmcnt(0)
k3_nosel1:
  s_mov_b32 s24, 0
  s_waitcnt vmcnt(27)
.p2align 6
k3_loop:
  v_mfma_f32_16x16x32_bf16 v[20:23], v[100:103], v[120:123], v[20:23]
  v_mfma_f32_16x16x32_bf16 v[24:27], v[100:103], v[124:127], v[24:27]
  v_mfma_f32_16x16x32_bf16 v[28:31], v[100:103], v[128:131], v[28:31]
  v_mfma_f32_16x16x32_bf16 v[32:35], v[100:103], v[132:135], v[32:35]
  buffer_load_dwordx4 v[100:103], v2, s[32:35], s52 offen offset:0
  v_mfma_f32_16x16x32_bf16 v[36:39], v[104:107], v[120:123], v[36:39]
  v_mfma_f32_16x16x32_bf16 v[40:43], v[104:107], v[124:127], v[40:43]
  v_mfma_f32_16x16x32_bf16 v[44:47], v[104:107], v[128:131], v[44:47]
  v_mfma_f32_16x16x32_bf16 v[48:51], v[104:107], v[132:135], v[48:51]
  buffer_load_dwordx4 v[104:107], v2, s[32:35], s52 offen offset:1024
  v_mfma_f32_16x16x32_bf16 v[52:55], v[108:111], v[120:123], v[52:55]
  v_mfma_f32_16x16x32_bf16 v[56:59], v[108:111], v[124:127], v[56:59]
  v_mfma_f32_16x16x32_bf16 v[60:63], v[108:111], v[128:131], v[60:63]
  v_mfma_f32_16x16x32_bf16 v[64:67], v[108:111], v[132:135], v[64:67]
  buffer_load_dwordx4 v[108:111], v2, s[32:35], s52 offen offset:2048
  v_mfma_f32_16x16x32_bf16 v[68:71], v[112:115], v[120:123], v[68:71]
  v_mfma_f32_16x16x32_bf16 v[72:75], v[112:115], v[124:127], v[72:75]
  v_mfma_f32_16x16x32_bf16 v[76:79], v[112:115], v[128:131], v[76:79]
  v_mfma_f32_16x16x32_bf16 v[80:83], v[112:115], v[132:135], v[80:83]
  buffer_load_dwordx4 v[112:115], v2, s[32:35], s52 offen offset:3072
  v_mfma_f32_16x16x32_bf16 v[84:87], v[116:119], v[120:123], v[84:87]
  buffer_load_dwordx4 v[120:123], v2, s[32:35], s48 offen offset:0
  v_mfma_f32_16x16x32_bf16 v[88:91], v[116:119], v[124:127], v[88:91]
  buffer_load_dwordx4 v[124:127], v2, s[32:35], s49 offen offset:0
  v_mfma_f32_16x16x32_bf16 v[92:95], v[116:119], v[128:131], v[92:95]
  buffer_load_dwordx4 v[128:131], v2, s[32:35], s50 offen offset:0
  v_mfma_f32_16x16x32_bf16 v[96:99], v[116:119], v[132:135], v[96:99]
  buffer_load_dwordx4 v[116:119], v2, s[32:35], s53 offen offset:0
  buffer_load_dwordx4 v[132:135], v2, s[32:35], s51 offen offset:0
  s_waitcnt vmcnt(27)
  v_mfma_f32_16x16x32_bf16 v[20:23], v[136:139], v[156:159], v[20:23]
  v_mfma_f32_16x16x32_bf16 v[24:27], v[136:139], v[160:163], v[24:27]
  v_mfma_f32_16x16x32_bf16 v[28:31], v[136:139], v[164:167], v[28:31]
  v_mfma_f32_16x16x32_bf16 v[32:35], v[136:139], v[168:171], v[32:35]
  buffer_load_dwordx4 v[136:139], v2, s[32:35], s53 offen offset:1024
  v_mfma_f32_16x16x32_bf16 v[36:39], v[140:143], v[156:159], v[36:39]
  v_mfma_f32_16x16x32_bf16 v[40:43], v[140:143], v[160:163], v[40:43]
  v_mfma_f32_16x16x32_bf16 v[44:47], v[140:143], v[164:167], v[44:47]
  v_mfma_f32_16x16x32_bf16 v[48:51], v[140:143], v[168:171], v[48:51]
  buffer_load_dwordx4 v[140:143], v2, s[32:35], s53 offen offset:2048
  v_mfma_f32_16x16x32_bf16 v[52:55], v[144:147], v[156:159], v[52:55]
  v_mfma_f32_16x16x32_bf16 v[56:59], v[144:147], v[160:163], v[56:59]
  v_mfma_f32_16x16x32_bf16 v[60:63], v[144:147], v[164:167], v[60:63]
  v_mfma_f32_16x16x32_bf16 v[64:67], v[144:147], v[168:171], v[64:67]
  buffer_load_dwordx4 v[144:147], v2, s[32:35], s53 offen offset:3072
  v_mfma_f32_16x16x32_bf16 v[68:71], v[148:151], v[156:159], v[68:71]
  v_mfma_f32_16x16x32_bf16 v[72:75], v[148:151], v[160:163], v[72:75]
  v_mfma_f32_16x16x32_bf16 v[76:79], v[148:151], v[164:167], v[76:79]
  v_mfma_f32_16x16x32_bf16 v[80:83], v[148:151], v[168:171], v[80:83]
  buffer_load_dwordx4 v[148:151], v2, s[32:35], s54 offen offset:0
  v_mfma_f32_16x16x32_bf16 v[84:87], v[152:155], v[156:159], v[84:87]
  buffer_load_dwordx4 v[156:159], v2, s[32:35], s48 offen offset:1024
  v_mfma_f32_16x16x32_bf16 v[88:91], v[152:155], v[160:163], v[88:91]
  buffer_load_dwordx4 v[160:163], v2, s[32:35], s49 offen offset:1024
  v_mfma_f32_16x16x32_bf16 v[92:95], v[152:155], v[164:167], v[92:95]
  buffer_load_dwordx4 v[164:167], v2, s[32:35], s50 offen offset:1024
  v_mfma_f32_16x16x32_bf16 v[96:99], v[152:155], v[168:171], v[96:99]
  buffer_load_dwordx4 v[152:155], v2, s[32:35], s54 offen offset:1024
  buffer_load_dwordx4 v[168:171], v2, s[32:35], s51 offen offset:1024
  s_waitcnt vmcnt(27)
  v_mfma_f32_16x16x32_bf16 v[20:23], v[172:175], v[192:195], v[20:23]
  v_mfma_f32_16x16x32_bf16 v[24:27], v[172:175], v[196:199], v[24:27]
  v_mfma_f32_16x16x32_bf16 v[28:31], v[172:175], v[200:203], v[28:31]
  v_mfma_f32_16x16x32_bf16 v[32:35], v[172:175], v[204:207], v[32:35]
  buffer_load_dwordx4 v[172:175], v2, s[32:35], s54 offen offset:2048
  v_mfma_f32_16x16x32_bf16 v[36:39], v[176:179], v[192:195], v[36:39]
  v_mfma_f32_16x16x32_bf16 v[40:43], v[176:179], v[196:199], v[40:43]
  v_mfma_f32_16x16x32_bf16 v[44:47], v[176:179], v[200:203], v[44:47]
  v_mfma_f32_16x16x32_bf16 v[48:51], v[176:179], v[204:207], v[48:51]
  buffer_load_dwordx4 v[176:179], v2, s[32:35], s54 offen offset:3072
  v_mfma_f32_16x16x32_bf16 v[52:55], v[180:183], v[192:195], v[52:55]
  v_mfma_f32_16x16x32_bf16 v[56:59], v[180:183], v[196:199], v[56:59]
  v_mfma_f32_16x16x32_bf16 v[60:63], v[180:183], v[200:203], v[60:63]
  v_mfma_f32_16x16x32_bf16 v[64:67], v[180:183], v[204:207], v[64:67]
  buffer_load_dwordx4 v[180:183], v2, s[32:35], s55 offen offset:0
  v_mfma_f32_16x16x32_bf16 v[68:71], v[184:187], v[192:195], v[68:71]
  v_mfma_f32_16x16x32_bf16 v[72:75], v[184:187], v[196:199], v[72:75]
  v_mfma_f32_16x16x32_bf16 v[76:79], v[184:187], v[200:203], v[76:79]
  v_mfma_f32_16x16x32_bf16 v[80:83], v[184:187], v[204:207], v[80:83]
  buffer_load_dwordx4 v[184:187], v2, s[32:35], s55 offen offset:1024
  v_mfma_f32_16x16x32_bf16 v[84:87], v[188:191], v[192:195], v[84:87]
  buffer_load_dwordx4 v[192:195], v2, s[32:35], s48 offen offset:2048
  v_mfma_f32_16x16x32_bf16 v[88:91], v[188:191], v[196:199], v[88:91]
  buffer_load_dwordx4 v[196:199], v2, s[32:35], s49 offen offset:2048
  v_mfma_f32_16x16x32_bf16 v[92:95], v[188:191], v[200:203], v[92:95]
  buffer_load_dwordx4 v[200:203], v2, s[32:35], s50 offen offset:2048
  v_mfma_f32_16x16x32_bf16 v[96:99], v[188:191], v[204:207], v[96:99]
  buffer_load_dwordx4 v[188:191], v2, s[32:35], s55 offen offset:2048
  buffer_load_dwordx4 v[204:207], v2, s[32:35], s51 offen offset:2048
  s_waitcnt vmcnt(27)
  v_mfma_f32_16x16x32_bf16 v[20:23], v[208:211], v[228:231], v[20:23]
  v_mfma_f32_16x16x32_bf16 v[24:27], v[208:211], v[232:235], v[24:27]
  v_mfma_f32_16x16x32_bf16 v[28:31], v[208:211], v[236:239], v[28:31]
  v_mfma_f32_16x16x32_bf16 v[32:35], v[208:211], v[240:243], v[32:35]
  buffer_load_dwordx4 v[208:211], v2, s[32:35], s55 offen offset:3072
  v_mfma_f32_16x16x32_bf16 v[36:39], v[212:215], v[228:231], v[36:39]
  s_add_u32 s52, s52, 20480
  v_mfma_f32_16x16x32_bf16 v[40:43], v[212:215], v[232:235], v[40:43]
  s_add_u32 s53, s53, 20480
  v_mfma_f32_16x16x32_bf16 v[44:47], v[212:215], v[236:239], v[44:47]
  s_add_u32 s54, s54, 20480
  v_mfma_f32_16x16x32_bf16 v[48:51], v[212:215], v[240:243], v[48:51]
  s_add_u32 s55, s55, 20480
  buffer_load_dwordx4 v[212:215], v2, s[32:35], s56 offen offset:0
  v_mfma_f32_16x16x32_bf16 v[52:55], v[216:219], v[228:231], v[52:55]
  s_add_u32 s24, s24, 1
  v_mfma_f32_16x16x32_bf16 v[56:59], v[216:219], v[232:235], v[56:59]
  v_mfma_f32_16x16x32_bf16 v[60:63], v[216:219], v[236:239], v[60:63]
  v_mfma_f32_16x16x32_bf16 v[64:67], v[216:219], v[240:243], v[64:67]
  buffer_load_dwordx4 v[216:219], v2, s[32:35], s56 offen offset:1024
  v_mfma_f32_16x16x32_bf16 v[68:71], v[220:223], v[228:231], v[68:71]
  v_mfma_f32_16x16x32_bf16 v[72:75], v[220:223], v[232:235], v[72:75]
  v_mfma_f32_16x16x32_bf16 v[76:79], v[220:223], v[236:239], v[76:79]
  v_mfma_f32_16x16x32_bf16 v[80:83], v[220:223], v[240:243], v[80:83]
  buffer_load_dwordx4 v[220:223], v2, s[32:35], s56 offen offset:2048
  v_mfma_f32_16x16x32_bf16 v[84:87], v[224:227], v[228:231], v[84:87]
  buffer_load_dwordx4 v[228:231], v2, s[32:35], s48 offen offset:3072
  v_mfma_f32_16x16x32_bf16 v[88:91], v[224:227], v[232:235], v[88:91]
  buffer_load_dwordx4 v[232:235], v2, s[32:35], s49 offen offset:3072
  v_mfma_f32_16x16x32_bf16 v[92:95], v[224:227], v[236:239], v[92:95]
  buffer_load_dwordx4 v[236:239], v2, s[32:35], s50 offen offset:3072
  v_mfma_f32_16x16x32_bf16 v[96:99], v[224:227], v[240:243], v[96:99]
  buffer_load_dwordx4 v[224:227], v2, s[32:35], s56 offen offset:3072
  buffer_load_dwordx4 v[240:243], v2, s[32:35], s51 offen offset:3072
  s_add_u32 s48, s48, 4096
  s_add_u32 s49, s49, 4096
  s_add_u32 s50, s50, 4096
  s_add_u32 s51, s51, 4096
  s_add_u32 s56, s56, 20480
  s_cmp_ge_u32 s24, 7
  s_cselect_b32 s34, 0, s34
  s_cmp_lt_u32 s24, 8
  s_waitcnt vmcnt(27)
  s_cbranch_scc1 k3_loop
  s_waitcnt vmcnt(0)
  buffer_load_dwordx4 v[100:103], v12, s[40:43], 0 offen
  buffer_load_dwordx4 v[112:115], v244, s[36:39], s27 offen
  buffer_load_dwordx4 v[104:107], v13, s[40:43], 0 offen
  buffer_load_dwordx4 v[116:119], v245, s[36:39], s27 offen
  buffer_load_dwordx4 v[108:111], v14, s[40:43], 0 offen
  buffer_load_dwordx4 v[120:123], v246, s[36:39], s27 offen
  v_and_b32 v4, 15, v1
  v_mul_u32_u24 v4, 336, v4
  v_lshrrev_b32 v5, 4, v1
  v_lshl_add_u32 v4, v5, 4, v4
  s_mul_i32 s23, s20, 21504
  v_add_u32 v4, s23, v4
  ds_write_b128 v4, v[20:23] offset:0
  ds_write_b128 v4, v[24:27] offset:5376
  ds_write_b128 v4, v[28:31] offset:10752
  ds_write_b128 v4, v[32:35] offset:16128
  ds_write_b128 v4, v[36:39] offset:64
  ds_write_b128 v4, v[40:43] offset:5440
  ds_write_b128 v4, v[44:47] offset:10816
  ds_write_b128 v4, v[48:51] offset:16192
  ds_write_b128 v4, v[52:55] offset:128
  ds_write_b128 v4, v[56:59] offset:5504
  ds_write_b128 v4, v[60:63] offset:10880
  ds_write_b128 v4, v[64:67] offset:16256
  ds_write_b128 v4, v[68:71] offset:192
  ds_write_b128 v4, v[72:75] offset:5568
  ds_write_b128 v4, v[76:79] offset:10944
  ds_write_b128 v4, v[80:83] offset:16320
  ds_write_b128 v4, v[84:87] offset:256
  ds_write_b128 v4, v[88:91] offset:5632
  ds_write_b128 v4, v[92:95] offset:11008
  ds_write_b128 v4, v[96:99] offset:16384
  s_waitcnt lgkmcnt(0)
  s_barrier
  v_add_u32 v4, 64512, v15
  v_add_u32 v5, 64512, v16
  v_add_u32 v6, 64512, v17
  ds_read_b128 v[128:131], v15 offset:0
  ds_read_b128 v[132:135], v15 offset:16
  ds_read_b128 v[136:139], v15 offset:21504
  ds_read_b128 v[140:143], v15 offset:21520
  ds_read_b128 v[144:147], v15 offset:43008
  ds_read_b128 v[148:151], v15 offset:43024
  ds_read_b128 v[152:155], v4 offset:0
  ds_read_b128 v[156:159], v4 offset:16
  ds_read_b128 v[160:163], v4 offset:21504
  ds_read_b128 v[164:167], v4 offset:21520
  ds_read_b128 v[168:171], v16 offset:0
  ds_read_b128 v[172:175], v16 offset:16
  ds_read_b128 v[176:179], v16 offset:21504
  ds_read_b128 v[180:183], v16 offset:21520
  ds_read_b128 v[184:187], v16 offset:43008
  ds_read_b128 v[188:191], v16 offset:43024
  ds_read_b128 v[192:195], v5 offset:0
  ds_read_b128 v[196:199], v5 offset:16
  ds_read_b128 v[200:203], v5 offset:21504
  ds_read_b128 v[204:207], v5 offset:21520
  ds_read_b128 v[208:211], v17 offset:0
  ds_read_b128 v[212:215], v17 offset:16
  ds_read_b128 v[216:219], v17 offset:21504
  ds_read_b128 v[220:223], v17 offset:21520
  ds_read_b128 v[224:227], v17 offset:43008
  ds_read_b128 v[228:231], v17 offset:43024
  ds_read_b128 v[232:235], v6 offset:0
  ds_read_b128 v[236:239], v6 offset:16
  ds_read_b128 v[240:243], v6 offset:21504
  ds_read_b128 v[244:247], v6 offset:21520
  s_waitcnt vmcnt(4) lgkmcnt(15)
  s_waitcnt lgkmcnt(10)
  v_add_f32 v128, v128, v136
  v_add_f32 v144, v144, v152
  v_add_f32 v129, v129, v137
  v_add_f32 v145, v145, v153
  v_add_f32 v130, v130, v138
  v_add_f32 v146, v146, v154
  v_add_f32 v131, v131, v139
  v_add_f32 v147, v147, v155
  v_add_f32 v132, v132, v140
  v_add_f32 v148, v148, v156
  v_add_f32 v133, v133, v141
  v_add_f32 v149, v149, v157
  v_add_f32 v134, v134, v142
  v_add_f32 v150, v150, v158
  v_add_f32 v135, v135, v143
  v_add_f32 v151, v151, v159
  v_add_f32 v128, v128, v144
  v_add_f32 v129, v129, v145
  v_add_f32 v130, v130, v146
  v_add_f32 v131, v131, v147
  v_add_f32 v132, v132, v148
  v_add_f32 v133, v133, v149
  v_add_f32 v134, v134, v150
  v_add_f32 v135, v135, v151
  v_cvt_pk_bf16_f32 v136, v128, v129
  v_lshlrev_b32 v138, 16, v100
  v_and_b32 v139, 0xffff0000, v100
  v_and_b32 v137, 0xffff0000, v136
  v_lshlrev_b32 v136, 16, v136
  v_add_f32 v136, v136, v138
  v_add_f32 v137, v137, v139
  v_cvt_pk_bf16_f32 v136, v136, v137
  v_lshlrev_b32 v138, 16, v112
  v_and_b32 v139, 0xffff0000, v112
  v_add_f32 v138, v138, v160
  v_add_f32 v139, v139, v161
  v_cvt_pk_bf16_f32 v138, v138, v139
  v_and_b32 v137, 0xffff0000, v136
  v_lshlrev_b32 v136, 16, v136
  v_and_b32 v139, 0xffff0000, v138
  v_lshlrev_b32 v138, 16, v138
  v_add_f32 v136, v136, v138
  v_add_f32 v137, v137, v139
  v_cvt_pk_bf16_f32 v140, v136, v137
  v_cvt_pk_bf16_f32 v136, v130, v131
  v_lshlrev_b32 v138, 16, v101
  v_and_b32 v139, 0xffff0000, v101
  v_and_b32 v137, 0xffff0000, v136
  v_lshlrev_b32 v136, 16, v136
  v_add_f32 v136, v136, v138
  v_add_f32 v137, v137, v139
  v_cvt_pk_bf16_f32 v136, v136, v137
  v_lshlrev_b32 v138, 16, v113
  v_and_b32 v139, 0xffff0000, v113
  v_add_f32 v138, v138, v162
  v_add_f32 v139, v139, v163
  v_cvt_pk_bf16_f32 v138, v138, v139
  v_and_b32 v137, 0xffff0000, v136
  v_lshlrev_b32 v136, 16, v136
  v_and_b32 v139, 0xffff0000, v138
  v_lshlrev_b32 v138, 16, v138
  v_add_f32 v136, v136, v138
  v_add_f32 v137, v137, v139
  v_cvt_pk_bf16_f32 v141, v136, v137
  v_cvt_pk_bf16_f32 v136, v132, v133
  v_lshlrev_b32 v138, 16, v102
  v_and_b32 v139, 0xffff0000, v102
  v_and_b32 v137, 0xffff0000, v136
  v_lshlrev_b32 v136, 16, v136
  v_add_f32 v136, v136, v138
  v_add_f32 v137, v137, v139
  v_cvt_pk_bf16_f32 v136, v136, v137
  v_lshlrev_b32 v138, 16, v114
  v_and_b32 v139, 0xffff0000, v114
  v_add_f32 v138, v138, v164
  v_add_f32 v139, v139, v165
  v_cvt_pk_bf16_f32 v138, v138, v139
  v_and_b32 v137, 0xffff0000, v136
  v_lshlrev_b32 v136, 16, v136
  v_and_b32 v139, 0xffff0000, v138
  v_lshlrev_b32 v138, 16, v138
  v_add_f32 v136, v136, v138
  v_add_f32 v137, v137, v139
  v_cvt_pk_bf16_f32 v142, v136, v137
  v_cvt_pk_bf16_f32 v136, v134, v135
  v_lshlrev_b32 v138, 16, v103
  v_and_b32 v139, 0xffff0000, v103
  v_and_b32 v137, 0xffff0000, v136
  v_lshlrev_b32 v136, 16, v136
  v_add_f32 v136, v136, v138
  v_add_f32 v137, v137, v139
  v_cvt_pk_bf16_f32 v136, v136, v137
  v_lshlrev_b32 v138, 16, v115
  v_and_b32 v139, 0xffff0000, v115
  v_add_f32 v138, v138, v166
  v_add_f32 v139, v139, v167
  v_cvt_pk_bf16_f32 v138, v138, v139
  v_and_b32 v137, 0xffff0000, v136
  v_lshlrev_b32 v136, 16, v136
  v_and_b32 v139, 0xffff0000, v138
  v_lshlrev_b32 v138, 16, v138
  v_add_f32 v136, v136, v138
  v_add_f32 v137, v137, v139
  v_cvt_pk_bf16_f32 v143, v136, v137
  buffer_store_dwordx4 v[140:143], v12, s[44:47], 0 offen
  s_waitcnt vmcnt(3) lgkmcnt(10)
  v_add_f32 v168, v168, v176
  v_add_f32 v184, v184, v192
  v_add_f32 v169, v169, v177
  v_add_f32 v185, v185, v193
  v_add_f32 v170, v170, v178
  v_add_f32 v186, v186, v194
  v_add_f32 v171, v171, v179
  v_add_f32 v187, v187, v195
  v_add_f32 v172, v172, v180
  v_add_f32 v188, v188, v196
  v_add_f32 v173, v173, v181
  v_add_f32 v189, v189, v197
  v_add_f32 v174, v174, v182
  v_add_f32 v190, v190, v198
  v_add_f32 v175, v175, v183
  v_add_f32 v191, v191, v199
  v_add_f32 v168, v168, v184
  v_add_f32 v169, v169, v185
  v_add_f32 v170, v170, v186
  v_add_f32 v171, v171, v187
  v_add_f32 v172, v172, v188
  v_add_f32 v173, v173, v189
  v_add_f32 v174, v174, v190
  v_add_f32 v175, v175, v191
  v_cvt_pk_bf16_f32 v176, v168, v169
  v_lshlrev_b32 v178, 16, v104
  v_and_b32 v179, 0xffff0000, v104
  v_and_b32 v177, 0xffff0000, v176
  v_lshlrev_b32 v176, 16, v176
  v_add_f32 v176, v176, v178
  v_add_f32 v177, v177, v179
  v_cvt_pk_bf16_f32 v176, v176, v177
  v_lshlrev_b32 v178, 16, v116
  v_and_b32 v179, 0xffff0000, v116
  v_add_f32 v178, v178, v200
  v_add_f32 v179, v179, v201
  v_cvt_pk_bf16_f32 v178, v178, v179
  v_and_b32 v177, 0xffff0000, v176
  v_lshlrev_b32 v176, 16, v176
  v_and_b32 v179, 0xffff0000, v178
  v_lshlrev_b32 v178, 16, v178
  v_add_f32 v176, v176, v178
  v_add_f32 v177, v177, v179
  v_cvt_pk_bf16_f32 v180, v176, v177
  v_cvt_pk_bf16_f32 v176, v170, v171
  v_lshlrev_b32 v178, 16, v105
  v_and_b32 v179, 0xffff0000, v105
  v_and_b32 v177, 0xffff0000, v176
  v_lshlrev_b32 v176, 16, v176
  v_add_f32 v176, v176, v178
  v_add_f32 v177, v177, v179
  v_cvt_pk_bf16_f32 v176, v176, v177
  v_lshlrev_b32 v178, 16, v117
  v_and_b32 v179, 0xffff0000, v117
  v_add_f32 v178, v178, v202
  v_add_f32 v179, v179, v203
  v_cvt_pk_bf16_f32 v178, v178, v179
  v_and_b32 v177, 0xffff0000, v176
  v_lshlrev_b32 v176, 16, v176
  v_and_b32 v179, 0xffff0000, v178
  v_lshlrev_b32 v178, 16, v178
  v_add_f32 v176, v176, v178
  v_add_f32 v177, v177, v179
  v_cvt_pk_bf16_f32 v181, v176, v177
  v_cvt_pk_bf16_f32 v176, v172, v173
  v_lshlrev_b32 v178, 16, v106
  v_and_b32 v179, 0xffff0000, v106
  v_and_b32 v177, 0xffff0000, v176
  v_lshlrev_b32 v176, 16, v176
  v_add_f32 v176, v176, v178
  v_add_f32 v177, v177, v179
  v_cvt_pk_bf16_f32 v176, v176, v177
  v_lshlrev_b32 v178, 16, v118
  v_and_b32 v179, 0xffff0000, v118
  v_add_f32 v178, v178, v204
  v_add_f32 v179, v179, v205
  v_cvt_pk_bf16_f32 v178, v178, v179
  v_and_b32 v177, 0xffff0000, v176
  v_lshlrev_b32 v176, 16, v176
  v_and_b32 v179, 0xffff0000, v178
  v_lshlrev_b32 v178, 16, v178
  v_add_f32 v176, v176, v178
  v_add_f32 v177, v177, v179
  v_cvt_pk_bf16_f32 v182, v176, v177
  v_cvt_pk_bf16_f32 v176, v174, v175
  v_lshlrev_b32 v178, 16, v107
  v_and_b32 v179, 0xffff0000, v107
  v_and_b32 v177, 0xffff0000, v176
  v_lshlrev_b32 v176, 16, v176
  v_add_f32 v176, v176, v178
  v_add_f32 v177, v177, v179
  v_cvt_pk_bf16_f32 v176, v176, v177
  v_lshlrev_b32 v178, 16, v119
  v_and_b32 v179, 0xffff0000, v119
  v_add_f32 v178, v178, v206
  v_add_f32 v179, v179, v207
  v_cvt_pk_bf16_f32 v178, v178, v179
  v_and_b32 v177, 0xffff0000, v176
  v_lshlrev_b32 v176, 16, v176
  v_and_b32 v179, 0xffff0000, v178
  v_lshlrev_b32 v178, 16, v178
  v_add_f32 v176, v176, v178
  v_add_f32 v177, v177, v179
  v_cvt_pk_bf16_f32 v183, v176, v177
  buffer_store_dwordx4 v[180:183], v13, s[44:47], 0 offen
  s_waitcnt vmcnt(2) lgkmcnt(0)
  v_add_f32 v208, v208, v216
  v_add_f32 v224, v224, v232
  v_add_f32 v209, v209, v217
  v_add_f32 v225, v225, v233
  v_add_f32 v210, v210, v218
  v_add_f32 v226, v226, v234
  v_add_f32 v211, v211, v219
  v_add_f32 v227, v227, v235
  v_add_f32 v212, v212, v220
  v_add_f32 v228, v228, v236
  v_add_f32 v213, v213, v221
  v_add_f32 v229, v229, v237
  v_add_f32 v214, v214, v222
  v_add_f32 v230, v230, v238
  v_add_f32 v215, v215, v223
  v_add_f32 v231, v231, v239
  v_add_f32 v208, v208, v224
  v_add_f32 v209, v209, v225
  v_add_f32 v210, v210, v226
  v_add_f32 v211, v211, v227
  v_add_f32 v212, v212, v228
  v_add_f32 v213, v213, v229
  v_add_f32 v214, v214, v230
  v_add_f32 v215, v215, v231
  v_cvt_pk_bf16_f32 v216, v208, v209
  v_lshlrev_b32 v218, 16, v108
  v_and_b32 v219, 0xffff0000, v108
  v_and_b32 v217, 0xffff0000, v216
  v_lshlrev_b32 v216, 16, v216
  v_add_f32 v216, v216, v218
  v_add_f32 v217, v217, v219
  v_cvt_pk_bf16_f32 v216, v216, v217
  v_lshlrev_b32 v218, 16, v120
  v_and_b32 v219, 0xffff0000, v120
  v_add_f32 v218, v218, v240
  v_add_f32 v219, v219, v241
  v_cvt_pk_bf16_f32 v218, v218, v219
  v_and_b32 v217, 0xffff0000, v216
  v_lshlrev_b32 v216, 16, v216
  v_and_b32 v219, 0xffff0000, v218
  v_lshlrev_b32 v218, 16, v218
  v_add_f32 v216, v216, v218
  v_add_f32 v217, v217, v219
  v_cvt_pk_bf16_f32 v220, v216, v217
  v_cvt_pk_bf16_f32 v216, v210, v211
  v_lshlrev_b32 v218, 16, v109
  v_and_b32 v219, 0xffff0000, v109
  v_and_b32 v217, 0xffff0000, v216
  v_lshlrev_b32 v216, 16, v216
  v_add_f32 v216, v216, v218
  v_add_f32 v217, v217, v219
  v_cvt_pk_bf16_f32 v216, v216, v217
  v_lshlrev_b32 v218, 16, v121
  v_and_b32 v219, 0xffff0000, v121
  v_add_f32 v218, v218, v242
  v_add_f32 v219, v219, v243
  v_cvt_pk_bf16_f32 v218, v218, v219
  v_and_b32 v217, 0xffff0000, v216
  v_lshlrev_b32 v216, 16, v216
  v_and_b32 v219, 0xffff0000, v218
  v_lshlrev_b32 v218, 16, v218
  v_add_f32 v216, v216, v218
  v_add_f32 v217, v217, v219
  v_cvt_pk_bf16_f32 v221, v216, v217
  v_cvt_pk_bf16_f32 v216, v212, v213
  v_lshlrev_b32 v218, 16, v110
  v_and_b32 v219, 0xffff0000, v110
  v_and_b32 v217, 0xffff0000, v216
  v_lshlrev_b32 v216, 16, v216
  v_add_f32 v216, v216, v218
  v_add_f32 v217, v217, v219
  v_cvt_pk_bf16_f32 v216, v216, v217
  v_lshlrev_b32 v218, 16, v122
  v_and_b32 v219, 0xffff0000, v122
  v_add_f32 v218, v218, v244
  v_add_f32 v219, v219, v245
  v_cvt_pk_bf16_f32 v218, v218, v219
  v_and_b32 v217, 0xffff0000, v216
  v_lshlrev_b32 v216, 16, v216
  v_and_b32 v219, 0xffff0000, v218
  v_lshlrev_b32 v218, 16, v218
  v_add_f32 v216, v216, v218
  v_add_f32 v217, v217, v219
  v_cvt_pk_bf16_f32 v222, v216, v217
  v_cvt_pk_bf16_f32 v216, v214, v215
  v_lshlrev_b32 v218, 16, v111
  v_and_b32 v219, 0xffff0000, v111
  v_and_b32 v217, 0xffff0000, v216
  v_lshlrev_b32 v216, 16, v216
  v_add_f32 v216, v216, v218
  v_add_f32 v217, v217, v219
  v_cvt_pk_bf16_f32 v216, v216, v217
  v_lshlrev_b32 v218, 16, v123
  v_and_b32 v219, 0xffff0000, v123
  v_add_f32 v218, v218, v246
  v_add_f32 v219, v219, v247
  v_cvt_pk_bf16_f32 v218, v218, v219
  v_and_b32 v217, 0xffff0000, v216
  v_lshlrev_b32 v216, 16, v216
  v_and_b32 v219, 0xffff0000, v218
  v_lshlrev_b32 v218, 16, v218
  v_add_f32 v216, v216, v218
  v_add_f32 v217, v217, v219
  v_cvt_pk_bf16_f32 v223, v216, v217
  buffer_store_dwordx4 v[220:223], v14, s[44:47], 0 offen
k3_end:
  s_endpgm
.section .rodata,"a"
.p2align 6
.amdhsa_kernel k3_kernel
  .amdhsa_next_free_vgpr 256
  .amdhsa_next_free_sgpr 102
  .amdhsa_accum_offset 256
  .amdhsa_group_segment_fixed_size 0
  .amdhsa_kernarg_size 112
  .amdhsa_user_sgpr_count 2
  .amdhsa_user_sgpr_kernarg_segment_ptr 1
  .amdhsa_system_sgpr_workgroup_id_x 1
  .amdhsa_float_denorm_mode_32 3
.end_amdhsa_kernel
.text
```

```asm
; @launch kernel=fa_kernel grid=(256,1,1) block=(256,1,1) lds=163840
.amdgcn_target "amdgcn-amd-amdhsa--gfx950"
.text
.globl fa_kernel
.p2align 8
.type fa_kernel,@function
fa_kernel:
  s_cmp_ge_u32 s2, 256
  s_cbranch_scc1 fa_end
  s_load_dwordx4 s[4:7], s[0:1], 0
  s_load_dwordx2 s[14:15], s[0:1], 56
  s_load_dwordx4 s[8:11], s[0:1], 24
  s_load_dwordx2 s[12:13], s[0:1], 40
  s_load_dwordx4 s[16:19], s[0:1], 96
  s_load_dwordx2 s[60:61], s[0:1], 16
  v_lshrrev_b32 v16, 6, v0
  v_and_b32 v1, 63, v0
  v_readfirstlane_b32 s20, v16
  s_and_b32 s21, s2, 7
  s_lshl_b32 s21, s21, 2
  s_lshr_b32 s23, s2, 3
  s_and_b32 s23, s23, 3
  s_add_u32 s21, s21, s23
  s_lshr_b32 s22, s2, 5
  v_and_b32 v208, 31, v1
  v_lshrrev_b32 v209, 5, v1
  s_lshl_b32 s23, s2, 2
  s_add_u32 s23, s23, s20
  s_lshl_b32 s23, s23, 1
  v_add_u32 v209, s23, v209
  v_lshlrev_b32 v212, 4, v208
  v_mul_u32_u24 v210, 1280, v209
  v_add_u32 v210, v210, v212
  v_cmp_gt_u32 s[64:65], 16, v208
  v_mov_b32 v211, 1073741824
  v_lshlrev_b32 v2, 4, v1
  v_cndmask_b32 v211, v211, v210, s[64:65]
  v_lshrrev_b32 v17, 1, v1
  v_lshlrev_b32 v17, 13, v17
  v_and_b32 v18, 1, v1
  v_lshl_add_u32 v17, v18, 7, v17
  s_lshl_b32 s29, s22, 1
  s_and_b32 s31, s20, 1
  s_add_u32 s29, s29, s31
  s_lshl_b32 s29, s29, 18
  s_and_b32 s31, s2, 31
  s_lshl_b32 s31, s31, 2
  s_add_u32 s31, s31, s20
  s_lshl_b32 s31, s31, 11
  v_and_b32 v16, 15, v1
  v_lshlrev_b32 v234, 7, v16
  s_waitcnt lgkmcnt(0)
  s_mov_b32 s44, s4
  s_mov_b32 s45, s5
  s_mov_b32 s46, 2621440
  s_mov_b32 s47, 0x20000
  s_mov_b32 s48, s14
  s_mov_b32 s49, s15
  s_mov_b32 s50, 1280
  s_mov_b32 s51, 0x20000
  buffer_load_dwordx4 v[160:163], v210, s[44:47], 0 offen
  buffer_load_dwordx4 v[164:167], v210, s[44:47], 0 offen offset:512
  buffer_load_dwordx4 v[168:171], v211, s[44:47], 0 offen offset:1024
  buffer_load_dwordx4 v[172:175], v212, s[48:51], 0 offen offset:0
  buffer_load_dwordx4 v[176:179], v212, s[48:51], 0 offen offset:512
  buffer_load_dwordx4 v[180:183], v212, s[48:51], 0 offen offset:1024
  s_lshl_b32 s23, s22, 18
  s_add_u32 s62, s6, s23
  s_addc_u32 s63, s7, 0
  s_mov_b32 s32, s62
  s_mov_b32 s33, s63
  s_mov_b32 s34, 262144
  s_mov_b32 s35, 0x20000
  buffer_load_dword v231, v234, s[32:35], s31 offen
  s_cmp_ge_u32 s20, 2
  s_cselect_b32 s62, s10, s8
  s_cselect_b32 s63, s11, s9
  s_lshl_b32 s23, s21, 8
  s_add_u32 s62, s62, s23
  s_addc_u32 s63, s63, 0
  s_mov_b32 s36, s62
  s_mov_b32 s37, s63
  s_mov_b32 s38, 0
  s_mov_b32 s39, 0x20000
  s_sub_u32 s38, 4194304, s23
  buffer_load_dword v232, v17, s[36:39], s29 offen
  s_add_u32 s60, s60, s23
  s_addc_u32 s61, s61, 0
  s_sub_u32 s75, 5242880, s23
  s_mov_b32 s74, 0
  s_mov_b32 s48, s60
  s_mov_b32 s49, s61
  s_mov_b32 s50, 0
  s_mov_b32 s51, 0x20000
  s_mov_b32 s40, s18
  s_mov_b32 s41, s19
  s_mov_b32 s42, 67108864
  s_mov_b32 s43, 0x20000
  s_mov_b32 s52, s12
  s_mov_b32 s53, s13
  s_mov_b32 s54, 5242880
  s_mov_b32 s55, 0x20000
  s_mov_b32 s56, s16
  s_mov_b32 s57, s17
  s_mov_b32 s58, 256
  s_mov_b32 s59, 0x20000
  v_and_b32 v235, 0xffff, v17
  s_lshl_b32 s23, s22, 2
  s_add_u32 s23, s23, s20
  s_lshl_b32 s23, s23, 16
  v_add_u32 v235, s23, v235
  s_lshl_b32 s23, s20, 5
  s_add_u32 s23, s23, s21
  s_lshl_b32 s23, s23, 2
  s_add_u32 s23, s23, 2641920
  s_lshl_b32 s31, s22, 9
  s_add_u32 s80, s23, s31
  s_sub_u32 s31, 7680, s31
  s_add_u32 s3, s23, s31
  s_lshl_b32 s23, s21, 7
  s_lshl_b32 s31, s22, 2
  s_add_u32 s23, s23, s31
  s_add_u32 s82, s23, 2637824
  s_and_b32 s23, s2, 63
  s_lshl_b32 s23, s23, 2
  s_add_u32 s23, s23, 2650112
  s_cmp_ge_u32 s2, 192
  s_cselect_b32 s23, s23, 1073741824
  s_cmp_eq_u32 s20, 1
  s_cselect_b32 s31, s23, 1073741824
  s_cmp_eq_u32 s20, 0
  s_cselect_b32 s31, s82, s31
  s_cmp_eq_u32 s2, 255
  s_cselect_b32 s23, 2629632, 1073741824
  v_lshl_add_u32 v19, v16, 2, s23
  v_mov_b32 v229, 0
  v_writelane_b32 v19, s80, 0
  v_writelane_b32 v19, s3, 1
  v_writelane_b32 v19, s31, 2
  s_and_b32 s23, s2, 1
  s_lshl_b32 s23, s23, 2
  s_add_u32 s23, s23, s20
  s_lshl_b32 s23, s23, 7
  s_lshr_b32 s31, s2, 1
  s_add_u32 s23, s23, s31
  s_lshl_b32 s23, s23, 2
  s_add_u32 s23, s23, 2654208
  v_writelane_b32 v19, s23, 3
  buffer_store_dword v229, v19, s[40:43], 0 offen sc1
  v_lshrrev_b32 v16, 2, v1
  v_lshrrev_b32 v17, 5, v1
  v_mul_u32_u24 v17, 3, v17
  v_and_b32 v18, 3, v1
  v_xor_b32 v17, v17, v18
  v_lshlrev_b32 v17, 4, v17
  v_lshl_add_u32 v224, v16, 10, v17
  s_lshl_b32 s23, s20, 16
  v_add_u32 v224, s23, v224
  v_add_u32 v225, 15360, v224
  v_add_u32 v226, 30720, v224
  v_add_u32 v227, 46080, v224
  v_and_b32 v16, 3, v16
  v_lshrrev_b32 v17, 4, v1
  v_lshlrev_b32 v17, 6, v17
  v_lshl_add_u32 v16, v16, 13, v17
  s_and_b32 s23, s20, 1
  s_lshl_b32 s23, s23, 17
  v_add_u32 v16, s23, v16
  v_lshl_add_u32 v8, v18, 4, v16
  v_xor_b32 v18, 2, v18
  v_lshl_add_u32 v10, v18, 4, v16
  v_add_u32 v9, 31744, v8
  v_add_u32 v11, 95232, v10
  v_add_u32 v10, 63488, v10
  s_lshl_b32 s24, s20, 12
  s_mov_b32 s26, 0
  s_mov_b32 s27, 0
  s_mov_b32 s25, 262144
  v_mov_b32 v20, 0
  v_mov_b32 v21, 0
  v_mov_b32 v22, 0
  v_mov_b32 v23, 0
  v_and_b32 v16, 15, v1
  v_lshrrev_b32 v17, 4, v1
  v_lshrrev_b32 v18, 3, v16
  v_mul_u32_u24 v18, 3, v18
  v_xor_b32 v18, v18, v17
  v_lshlrev_b32 v18, 4, v18
  v_lshl_add_u32 v14, v16, 6, v18
  s_and_b32 s23, s20, 1
  s_lshl_b32 s23, s23, 13
  v_add_u32 v14, s23, v14
  v_mfma_f32_32x32x16_bf16 a[0:15], v[20:23], v[20:23], 0
  v_mfma_f32_32x32x16_bf16 a[16:31], v[20:23], v[20:23], 0
  v_mfma_f32_32x32x16_bf16 a[32:47], v[20:23], v[20:23], 0
  v_mfma_f32_32x32x16_bf16 a[48:63], v[20:23], v[20:23], 0
  v_mfma_f32_32x32x16_bf16 a[64:79], v[20:23], v[20:23], 0
  v_mfma_f32_32x32x16_bf16 a[80:95], v[20:23], v[20:23], 0
  v_mfma_f32_32x32x16_bf16 a[96:111], v[20:23], v[20:23], 0
  v_mfma_f32_32x32x16_bf16 a[112:127], v[20:23], v[20:23], 0
  v_mfma_f32_32x32x16_bf16 a[128:143], v[20:23], v[20:23], 0
  v_mfma_f32_32x32x16_bf16 a[144:159], v[20:23], v[20:23], 0
  v_mfma_f32_32x32x16_bf16 a[160:175], v[20:23], v[20:23], 0
  v_mfma_f32_32x32x16_bf16 a[176:191], v[20:23], v[20:23], 0
  v_mfma_f32_32x32x16_bf16 a[192:207], v[20:23], v[20:23], 0
  v_mfma_f32_32x32x16_bf16 a[208:223], v[20:23], v[20:23], 0
  v_mfma_f32_32x32x16_bf16 a[224:239], v[20:23], v[20:23], 0
  v_mfma_f32_32x32x16_bf16 a[240:255], v[20:23], v[20:23], 0
  v_lshrrev_b32 v18, 2, v16
  v_lshlrev_b32 v18, 6, v18
  v_lshl_add_u32 v18, v17, 11, v18
  v_and_b32 v19, 1, v1
  v_lshl_add_u32 v18, v19, 3, v18
  v_bfe_u32 v19, v1, 1, 1
  v_and_b32 v17, 1, v17
  v_lshl_or_b32 v19, v17, 1, v19
  s_lshr_b32 s23, s20, 1
  s_lshl_b32 s23, s23, 13
  s_add_u32 s23, s23, 16384
  v_add_u32 v18, s23, v18
  v_lshl_add_u32 v12, v19, 4, v18
  v_xor_b32 v13, 32, v12
  s_waitcnt vmcnt(3)
  s_mov_b32 m0, s24
  s_nop 0
  buffer_load_dwordx4 v224, s[32:35], s26 offen offset:0 lds
  buffer_load_dwordx4 v225, s[32:35], s26 offen offset:1024 lds
  buffer_load_dwordx4 v226, s[32:35], s26 offen offset:2048 lds
  buffer_load_dwordx4 v227, s[32:35], s26 offen offset:3072 lds
  s_add_u32 m0, s24, 16384
  s_nop 0
  buffer_load_dwordx4 v8, s[36:39], s27 offen offset:0 lds
  buffer_load_dwordx4 v9, s[36:39], s27 offen offset:1024 lds
  buffer_load_dwordx4 v10, s[36:39], s27 offen offset:2048 lds
  buffer_load_dwordx4 v11, s[36:39], s27 offen offset:3072 lds
  s_add_u32 s26, s26, 64
  s_add_u32 s27, s27, s25
  s_add_u32 s24, s24, 32768
  s_and_b32 s24, s24, 0x1ffff
  v_lshlrev_b32 v184, 16, v160
  v_and_b32 v185, 0xffff0000, v160
  v_lshlrev_b32 v186, 16, v161
  v_and_b32 v187, 0xffff0000, v161
  v_lshlrev_b32 v188, 16, v162
  v_and_b32 v189, 0xffff0000, v162
  v_lshlrev_b32 v190, 16, v163
  v_and_b32 v191, 0xffff0000, v163
  v_lshlrev_b32 v192, 16, v164
  v_and_b32 v193, 0xffff0000, v164
  v_lshlrev_b32 v194, 16, v165
  v_and_b32 v195, 0xffff0000, v165
  v_lshlrev_b32 v196, 16, v166
  v_and_b32 v197, 0xffff0000, v166
  v_lshlrev_b32 v198, 16, v167
  v_and_b32 v199, 0xffff0000, v167
  v_lshlrev_b32 v200, 16, v168
  v_and_b32 v201, 0xffff0000, v168
  v_lshlrev_b32 v202, 16, v169
  v_and_b32 v203, 0xffff0000, v169
  v_lshlrev_b32 v204, 16, v170
  v_and_b32 v205, 0xffff0000, v170
  v_lshlrev_b32 v206, 16, v171
  v_and_b32 v207, 0xffff0000, v171
  v_add_f32 v213, v184, v185
  v_add_f32 v214, v186, v187
  v_add_f32 v213, v213, v188
  v_add_f32 v214, v214, v189
  v_add_f32 v213, v213, v190
  v_add_f32 v214, v214, v191
  v_add_f32 v213, v213, v192
  v_add_f32 v214, v214, v193
  v_add_f32 v213, v213, v194
  v_add_f32 v214, v214, v195
  v_add_f32 v213, v213, v196
  v_add_f32 v214, v214, v197
  v_add_f32 v213, v213, v198
  v_add_f32 v214, v214, v199
  v_add_f32 v213, v213, v200
  v_add_f32 v214, v214, v201
  v_add_f32 v213, v213, v202
  v_add_f32 v214, v214, v203
  v_add_f32 v213, v213, v204
  v_add_f32 v214, v214, v205
  v_add_f32 v213, v213, v206
  v_add_f32 v214, v214, v207
  v_add_f32 v213, v213, v214
  s_nop 1
  v_add_f32_dpp v213, v213, v213 quad_perm:[1,0,3,2] row_mask:0xf bank_mask:0xf
  s_nop 1
  v_add_f32_dpp v213, v213, v213 quad_perm:[2,3,0,1] row_mask:0xf bank_mask:0xf
  s_nop 1
  v_add_f32_dpp v213, v213, v213 row_half_mirror row_mask:0xf bank_mask:0xf
  s_nop 1
  v_add_f32_dpp v213, v213, v213 row_mirror row_mask:0xf bank_mask:0xf
  v_mov_b32 v214, v213
  s_nop 1
  v_permlane16_swap_b32 v213, v214
  v_add_f32 v213, v213, v214
  v_mul_f32 v215, 0x3acccccd, v213
  v_mov_b32 v218, 0
  v_mov_b32 v213, 0
  v_sub_f32 v16, v184, v215
  v_fmac_f32 v218, v16, v16
  v_sub_f32 v17, v185, v215
  v_fmac_f32 v218, v17, v17
  v_sub_f32 v18, v186, v215
  v_fmac_f32 v218, v18, v18
  v_sub_f32 v19, v187, v215
  v_fmac_f32 v218, v19, v19
  v_sub_f32 v16, v188, v215
  v_fmac_f32 v218, v16, v16
  v_sub_f32 v17, v189, v215
  v_fmac_f32 v218, v17, v17
  v_sub_f32 v18, v190, v215
  v_fmac_f32 v218, v18, v18
  v_sub_f32 v19, v191, v215
  v_fmac_f32 v218, v19, v19
  v_sub_f32 v16, v192, v215
  v_fmac_f32 v218, v16, v16
  v_sub_f32 v17, v193, v215
  v_fmac_f32 v218, v17, v17
  v_sub_f32 v18, v194, v215
  v_fmac_f32 v218, v18, v18
  v_sub_f32 v19, v195, v215
  v_fmac_f32 v218, v19, v19
  v_sub_f32 v16, v196, v215
  v_fmac_f32 v218, v16, v16
  v_sub_f32 v17, v197, v215
  v_fmac_f32 v218, v17, v17
  v_sub_f32 v18, v198, v215
  v_fmac_f32 v218, v18, v18
  v_sub_f32 v19, v199, v215
  v_fmac_f32 v218, v19, v19
  v_sub_f32 v16, v200, v215
  v_fmac_f32 v213, v16, v16
  v_sub_f32 v17, v201, v215
  v_fmac_f32 v213, v17, v17
  v_sub_f32 v18, v202, v215
  v_fmac_f32 v213, v18, v18
  v_sub_f32 v19, v203, v215
  v_fmac_f32 v213, v19, v19
  v_sub_f32 v16, v204, v215
  v_fmac_f32 v213, v16, v16
  v_sub_f32 v17, v205, v215
  v_fmac_f32 v213, v17, v17
  v_sub_f32 v18, v206, v215
  v_fmac_f32 v213, v18, v18
  v_sub_f32 v19, v207, v215
  v_fmac_f32 v213, v19, v19
  v_cndmask_b32 v213, 0, v213, s[64:65]
  v_add_f32 v213, v213, v218
  s_nop 1
  v_add_f32_dpp v213, v213, v213 quad_perm:[1,0,3,2] row_mask:0xf bank_mask:0xf
  s_nop 1
  v_add_f32_dpp v213, v213, v213 quad_perm:[2,3,0,1] row_mask:0xf bank_mask:0xf
  s_nop 1
  v_add_f32_dpp v213, v213, v213 row_half_mirror row_mask:0xf bank_mask:0xf
  s_nop 1
  v_add_f32_dpp v213, v213, v213 row_mirror row_mask:0xf bank_mask:0xf
  v_mov_b32 v214, v213
  s_nop 1
  v_permlane16_swap_b32 v213, v214
  v_add_f32 v213, v213, v214
  v_mul_f32 v213, 0x3acccccd, v213
  v_cvt_pk_bf16_f32 v213, v213, v213
  v_and_b32 v213, 0xffff0000, v213
  v_add_f32 v213, 0x3727c5ac, v213
  v_cvt_pk_bf16_f32 v213, v213, v213
  v_and_b32 v213, 0xffff0000, v213
  v_sqrt_f32 v213, v213
  v_mov_b32 v216, v215
  v_cvt_pk_bf16_f32 v213, v213, v213
  v_and_b32 v213, 0xffff0000, v213
  v_rcp_f32 v217, v213
  v_cvt_pk_bf16_f32 v216, v216, v216
  v_and_b32 v216, 0xffff0000, v216
  v_mov_b32 v218, 0
  v_sub_f32 v184, v184, v216
  v_sub_f32 v185, v185, v216
  v_cvt_pk_bf16_f32 v16, v184, v185
  v_lshlrev_b32 v184, 16, v16
  v_and_b32 v185, 0xffff0000, v16
  v_mul_f32 v184, v184, v217
  v_mul_f32 v185, v185, v217
  v_cvt_pk_bf16_f32 v160, v184, v185
  v_lshlrev_b32 v184, 16, v160
  v_and_b32 v185, 0xffff0000, v160
  v_lshlrev_b32 v17, 16, v172
  v_and_b32 v18, 0xffff0000, v172
  v_fmac_f32 v218, v184, v17
  v_fmac_f32 v218, v185, v18
  v_sub_f32 v186, v186, v216
  v_sub_f32 v187, v187, v216
  v_cvt_pk_bf16_f32 v16, v186, v187
  v_lshlrev_b32 v186, 16, v16
  v_and_b32 v187, 0xffff0000, v16
  v_mul_f32 v186, v186, v217
  v_mul_f32 v187, v187, v217
  v_cvt_pk_bf16_f32 v161, v186, v187
  v_lshlrev_b32 v186, 16, v161
  v_and_b32 v187, 0xffff0000, v161
  v_lshlrev_b32 v17, 16, v173
  v_and_b32 v18, 0xffff0000, v173
  v_fmac_f32 v218, v186, v17
  v_fmac_f32 v218, v187, v18
  v_sub_f32 v188, v188, v216
  v_sub_f32 v189, v189, v216
  v_cvt_pk_bf16_f32 v16, v188, v189
  v_lshlrev_b32 v188, 16, v16
  v_and_b32 v189, 0xffff0000, v16
  v_mul_f32 v188, v188, v217
  v_mul_f32 v189, v189, v217
  v_cvt_pk_bf16_f32 v162, v188, v189
  v_lshlrev_b32 v188, 16, v162
  v_and_b32 v189, 0xffff0000, v162
  v_lshlrev_b32 v17, 16, v174
  v_and_b32 v18, 0xffff0000, v174
  v_fmac_f32 v218, v188, v17
  v_fmac_f32 v218, v189, v18
  v_sub_f32 v190, v190, v216
  v_sub_f32 v191, v191, v216
  v_cvt_pk_bf16_f32 v16, v190, v191
  v_lshlrev_b32 v190, 16, v16
  v_and_b32 v191, 0xffff0000, v16
  v_mul_f32 v190, v190, v217
  v_mul_f32 v191, v191, v217
  v_cvt_pk_bf16_f32 v163, v190, v191
  v_lshlrev_b32 v190, 16, v163
  v_and_b32 v191, 0xffff0000, v163
  v_lshlrev_b32 v17, 16, v175
  v_and_b32 v18, 0xffff0000, v175
  v_fmac_f32 v218, v190, v17
  v_fmac_f32 v218, v191, v18
  v_sub_f32 v192, v192, v216
  v_sub_f32 v193, v193, v216
  v_cvt_pk_bf16_f32 v16, v192, v193
  v_lshlrev_b32 v192, 16, v16
  v_and_b32 v193, 0xffff0000, v16
  v_mul_f32 v192, v192, v217
  v_mul_f32 v193, v193, v217
  v_cvt_pk_bf16_f32 v164, v192, v193
  v_lshlrev_b32 v192, 16, v164
  v_and_b32 v193, 0xffff0000, v164
  v_lshlrev_b32 v17, 16, v176
  v_and_b32 v18, 0xffff0000, v176
  v_fmac_f32 v218, v192, v17
  v_fmac_f32 v218, v193, v18
  v_sub_f32 v194, v194, v216
  v_sub_f32 v195, v195, v216
  v_cvt_pk_bf16_f32 v16, v194, v195
  v_lshlrev_b32 v194, 16, v16
  v_and_b32 v195, 0xffff0000, v16
  v_mul_f32 v194, v194, v217
  v_mul_f32 v195, v195, v217
  v_cvt_pk_bf16_f32 v165, v194, v195
  v_lshlrev_b32 v194, 16, v165
  v_and_b32 v195, 0xffff0000, v165
  v_lshlrev_b32 v17, 16, v177
  v_and_b32 v18, 0xffff0000, v177
  v_fmac_f32 v218, v194, v17
  v_fmac_f32 v218, v195, v18
  v_sub_f32 v196, v196, v216
  v_sub_f32 v197, v197, v216
  v_cvt_pk_bf16_f32 v16, v196, v197
  v_lshlrev_b32 v196, 16, v16
  v_and_b32 v197, 0xffff0000, v16
  v_mul_f32 v196, v196, v217
  v_mul_f32 v197, v197, v217
  v_cvt_pk_bf16_f32 v166, v196, v197
  v_lshlrev_b32 v196, 16, v166
  v_and_b32 v197, 0xffff0000, v166
  v_lshlrev_b32 v17, 16, v178
  v_and_b32 v18, 0xffff0000, v178
  v_fmac_f32 v218, v196, v17
  v_fmac_f32 v218, v197, v18
  v_sub_f32 v198, v198, v216
  v_sub_f32 v199, v199, v216
  v_cvt_pk_bf16_f32 v16, v198, v199
  v_lshlrev_b32 v198, 16, v16
  v_and_b32 v199, 0xffff0000, v16
  v_mul_f32 v198, v198, v217
  v_mul_f32 v199, v199, v217
  v_cvt_pk_bf16_f32 v167, v198, v199
  v_lshlrev_b32 v198, 16, v167
  v_and_b32 v199, 0xffff0000, v167
  v_lshlrev_b32 v17, 16, v179
  v_and_b32 v18, 0xffff0000, v179
  v_fmac_f32 v218, v198, v17
  v_fmac_f32 v218, v199, v18
  v_sub_f32 v200, v200, v216
  v_sub_f32 v201, v201, v216
  v_cvt_pk_bf16_f32 v16, v200, v201
  v_lshlrev_b32 v200, 16, v16
  v_and_b32 v201, 0xffff0000, v16
  v_mul_f32 v200, v200, v217
  v_mul_f32 v201, v201, v217
  v_cvt_pk_bf16_f32 v168, v200, v201
  v_lshlrev_b32 v200, 16, v168
  v_and_b32 v201, 0xffff0000, v168
  v_lshlrev_b32 v17, 16, v180
  v_and_b32 v18, 0xffff0000, v180
  v_fmac_f32 v218, v200, v17
  v_fmac_f32 v218, v201, v18
  v_sub_f32 v202, v202, v216
  v_sub_f32 v203, v203, v216
  v_cvt_pk_bf16_f32 v16, v202, v203
  v_lshlrev_b32 v202, 16, v16
  v_and_b32 v203, 0xffff0000, v16
  v_mul_f32 v202, v202, v217
  v_mul_f32 v203, v203, v217
  v_cvt_pk_bf16_f32 v169, v202, v203
  v_lshlrev_b32 v202, 16, v169
  v_and_b32 v203, 0xffff0000, v169
  v_lshlrev_b32 v17, 16, v181
  v_and_b32 v18, 0xffff0000, v181
  v_fmac_f32 v218, v202, v17
  v_fmac_f32 v218, v203, v18
  v_sub_f32 v204, v204, v216
  v_sub_f32 v205, v205, v216
  v_cvt_pk_bf16_f32 v16, v204, v205
  v_lshlrev_b32 v204, 16, v16
  v_and_b32 v205, 0xffff0000, v16
  v_mul_f32 v204, v204, v217
  v_mul_f32 v205, v205, v217
  v_cvt_pk_bf16_f32 v170, v204, v205
  v_lshlrev_b32 v204, 16, v170
  v_and_b32 v205, 0xffff0000, v170
  v_lshlrev_b32 v17, 16, v182
  v_and_b32 v18, 0xffff0000, v182
  v_fmac_f32 v218, v204, v17
  v_fmac_f32 v218, v205, v18
  v_sub_f32 v206, v206, v216
  v_sub_f32 v207, v207, v216
  v_cvt_pk_bf16_f32 v16, v206, v207
  v_lshlrev_b32 v206, 16, v16
  v_and_b32 v207, 0xffff0000, v16
  v_mul_f32 v206, v206, v217
  v_mul_f32 v207, v207, v217
  v_cvt_pk_bf16_f32 v171, v206, v207
  v_lshlrev_b32 v206, 16, v171
  v_and_b32 v207, 0xffff0000, v171
  v_lshlrev_b32 v17, 16, v183
  v_and_b32 v18, 0xffff0000, v183
  v_fmac_f32 v218, v206, v17
  v_fmac_f32 v218, v207, v18
  v_and_b32 v16, 7, v209
  v_lshlrev_b32 v16, 4, v16
  v_lshl_add_u32 v16, v208, 7, v16
  v_add_u32 v16, 131072, v16
  ds_write_b128 v16, v[160:163] offset:0
  ds_write_b128 v16, v[164:167] offset:4096
  ds_write_b128 v16, v[168:171] offset:8192
  s_nop 1
  v_add_f32_dpp v218, v218, v218 quad_perm:[1,0,3,2] row_mask:0xf bank_mask:0xf
  s_nop 1
  v_add_f32_dpp v218, v218, v218 quad_perm:[2,3,0,1] row_mask:0xf bank_mask:0xf
  s_nop 1
  v_add_f32_dpp v218, v218, v218 row_half_mirror row_mask:0xf bank_mask:0xf
  s_nop 1
  v_add_f32_dpp v218, v218, v218 row_mirror row_mask:0xf bank_mask:0xf
  v_mov_b32 v214, v218
  s_nop 1
  v_permlane16_swap_b32 v218, v214
  v_add_f32 v218, v218, v214
  v_cvt_pk_bf16_f32 v218, v218, v218
  v_and_b32 v218, 0xffff0000, v218
  v_ashrrev_i32 v214, 31, v218
  v_or_b32 v214, 0x80000000, v214
  v_xor_b32 v218, v218, v214
  v_and_b32 v218, 0xffff0000, v218
  v_sub_u32 v214, 0xffff, v209
  v_or_b32 v218, v218, v214
  v_lshlrev_b32 v214, 2, v209
  v_add_u32 v214, 2621440, v214
  v_mov_b32 v19, 1073741824
  v_cmp_eq_u32 vcc, 0, v208
  v_lshlrev_b32 v16, 4, v0
  v_add_u32 v16, 131072, v16
  v_cndmask_b32 v214, v19, v214, vcc
  v_lshrrev_b32 v17, 3, v0
  v_and_b32 v18, 7, v0
  v_lshlrev_b32 v18, 4, v18
  v_lshl_add_u32 v17, v17, 8, v18
  v_cmp_gt_u32 vcc, 128, v0
  s_lshr_b32 s23, s2, 1
  s_mul_i32 s23, s23, 20480
  s_and_b32 s31, s2, 1
  s_lshl_b32 s31, s31, 7
  s_add_u32 s23, s23, s31
  v_cndmask_b32 v18, v19, v17, vcc
  s_add_u32 s31, s23, 8192
  s_add_u32 s62, s23, 16384
  s_waitcnt lgkmcnt(0)
  s_barrier
  ds_read_b128 v[160:163], v16 offset:0
  ds_read_b128 v[164:167], v16 offset:4096
  ds_read_b128 v[168:171], v16 offset:8192
  buffer_store_dword v218, v214, s[40:43], 0 offen sc1
  s_mov_b32 s28, 0
  s_waitcnt lgkmcnt(0)
  buffer_store_dwordx4 v[160:163], v17, s[40:43], s23 offen sc1
  buffer_store_dwordx4 v[164:167], v17, s[40:43], s31 offen sc1
  buffer_store_dwordx4 v[168:171], v18, s[40:43], s62 offen sc1
  s_mov_b32 m0, s24
  s_nop 0
  buffer_load_dwordx4 v224, s[32:35], s26 offen offset:0 lds
  buffer_load_dwordx4 v225, s[32:35], s26 offen offset:1024 lds
  buffer_load_dwordx4 v226, s[32:35], s26 offen offset:2048 lds
  buffer_load_dwordx4 v227, s[32:35], s26 offen offset:3072 lds
  s_add_u32 m0, s24, 16384
  s_nop 0
  buffer_load_dwordx4 v8, s[36:39], s27 offen offset:0 lds
  buffer_load_dwordx4 v9, s[36:39], s27 offen offset:1024 lds
  buffer_load_dwordx4 v10, s[36:39], s27 offen offset:2048 lds
  buffer_load_dwordx4 v11, s[36:39], s27 offen offset:3072 lds
  s_add_u32 s26, s26, 64
  s_add_u32 s27, s27, s25
  s_add_u32 s24, s24, 32768
  s_and_b32 s24, s24, 0x1ffff
  s_mov_b32 m0, s24
  s_nop 0
  buffer_load_dwordx4 v224, s[32:35], s26 offen offset:0 lds
  buffer_load_dwordx4 v225, s[32:35], s26 offen offset:1024 lds
  buffer_load_dwordx4 v226, s[32:35], s26 offen offset:2048 lds
  buffer_load_dwordx4 v227, s[32:35], s26 offen offset:3072 lds
  s_add_u32 m0, s24, 16384
  s_nop 0
  buffer_load_dwordx4 v8, s[36:39], s27 offen offset:0 lds
  buffer_load_dwordx4 v9, s[36:39], s27 offen offset:1024 lds
  buffer_load_dwordx4 v10, s[36:39], s27 offen offset:2048 lds
  buffer_load_dwordx4 v11, s[36:39], s27 offen offset:3072 lds
  s_add_u32 s26, s26, 64
  s_add_u32 s27, s27, s25
  s_add_u32 s24, s24, 32768
  s_and_b32 s24, s24, 0x1ffff
  s_getpc_b64 s[62:63]
fa_pc:
  s_lshr_b32 s23, s2, 3
  s_and_b32 s23, s23, 7
  s_lshl_b32 s23, s23, 2
  s_add_u32 s23, s23, s20
  s_lshl_b32 s23, s23, 11
  s_min_u32 s23, s23, fa_codeend-fa_pc-2048
  v_add_u32 v234, s23, v234
  global_load_dword v231, v234, s[62:63]
  s_mov_b32 m0, s24
  s_nop 0
  buffer_load_dwordx4 v224, s[32:35], s26 offen offset:0 lds
  buffer_load_dwordx4 v225, s[32:35], s26 offen offset:1024 lds
  buffer_load_dwordx4 v226, s[32:35], s26 offen offset:2048 lds
  buffer_load_dwordx4 v227, s[32:35], s26 offen offset:3072 lds
  s_add_u32 m0, s24, 16384
  s_nop 0
  buffer_load_dwordx4 v8, s[36:39], s27 offen offset:0 lds
  buffer_load_dwordx4 v9, s[36:39], s27 offen offset:1024 lds
  buffer_load_dwordx4 v10, s[36:39], s27 offen offset:2048 lds
  buffer_load_dwordx4 v11, s[36:39], s27 offen offset:3072 lds
  s_add_u32 s26, s26, 64
  s_add_u32 s27, s27, s25
  s_add_u32 s24, s24, 32768
  s_and_b32 s24, s24, 0x1ffff
  s_waitcnt vmcnt(29)
  s_barrier
  s_cmp_ge_u32 s20, 2
  s_cbranch_scc1 fa_roleV
  ds_read_b128 v[96:99], v14 offset:0
  ds_read_b128 v[100:103], v14 offset:1024
  ds_read_b128 v[104:107], v14 offset:2048
  ds_read_b128 v[108:111], v14 offset:3072
  ds_read_b128 v[112:115], v14 offset:4096
  ds_read_b128 v[116:119], v14 offset:5120
  ds_read_b128 v[120:123], v14 offset:6144
  ds_read_b128 v[124:127], v14 offset:7168
  ds_read_b64_tr_b16 v[32:33], v12 offset:0
  ds_read_b64_tr_b16 v[34:35], v12 offset:1024
  ds_read_b64_tr_b16 v[36:37], v13 offset:0
  ds_read_b64_tr_b16 v[38:39], v13 offset:1024
  ds_read_b64_tr_b16 v[40:41], v12 offset:256
  ds_read_b64_tr_b16 v[42:43], v12 offset:1280
  ds_read_b64_tr_b16 v[44:45], v13 offset:256
  ds_read_b64_tr_b16 v[46:47], v13 offset:1280
  ds_read_b64_tr_b16 v[48:49], v12 offset:512
  ds_read_b64_tr_b16 v[50:51], v12 offset:1536
  ds_read_b64_tr_b16 v[52:53], v13 offset:512
  ds_read_b64_tr_b16 v[54:55], v13 offset:1536
  ds_read_b64_tr_b16 v[56:57], v12 offset:768
  ds_read_b64_tr_b16 v[58:59], v12 offset:1792
  ds_read_b64_tr_b16 v[60:61], v13 offset:768
  ds_read_b64_tr_b16 v[62:63], v13 offset:1792
  s_waitcnt lgkmcnt(0)
.p2align 6
fa_loopK:
  v_mfma_f32_16x16x32_bf16 a[0:3], v[32:35], v[96:99], a[0:3]
  s_waitcnt vmcnt(17)
  v_mfma_f32_16x16x32_bf16 a[4:7], v[32:35], v[100:103], a[4:7]
  s_barrier
  v_mfma_f32_16x16x32_bf16 a[8:11], v[32:35], v[104:107], a[8:11]
  s_bitcmp1_b32 0x41, s28
  ds_read_b64_tr_b16 v[64:65], v12 offset:32768
  v_mfma_f32_16x16x32_bf16 a[12:15], v[32:35], v[108:111], a[12:15]
  s_cbranch_scc1 fa_p1stubK
fa_p1backK:
  v_mfma_f32_16x16x32_bf16 a[16:19], v[32:35], v[112:115], a[16:19]
  s_mov_b32 m0, s24
  ds_read_b64_tr_b16 v[66:67], v12 offset:33792
  v_mfma_f32_16x16x32_bf16 a[20:23], v[32:35], v[116:119], a[20:23]
  buffer_load_dwordx4 v224, s[32:35], s26 offen offset:0 lds
  v_mfma_f32_16x16x32_bf16 a[24:27], v[32:35], v[120:123], a[24:27]
  ds_read_b128 v[128:131], v14 offset:32768
  v_mfma_f32_16x16x32_bf16 a[28:31], v[32:35], v[124:127], a[28:31]
  buffer_load_dwordx4 v225, s[32:35], s26 offen offset:1024 lds
  v_mfma_f32_16x16x32_bf16 a[32:35], v[36:39], v[96:99], a[32:35]
  ds_read_b64_tr_b16 v[68:69], v13 offset:32768
  v_mfma_f32_16x16x32_bf16 a[36:39], v[36:39], v[100:103], a[36:39]
  buffer_load_dwordx4 v226, s[32:35], s26 offen offset:2048 lds
  v_mfma_f32_16x16x32_bf16 a[40:43], v[36:39], v[104:107], a[40:43]
  ds_read_b64_tr_b16 v[70:71], v13 offset:33792
  v_mfma_f32_16x16x32_bf16 a[44:47], v[36:39], v[108:111], a[44:47]
  buffer_load_dwordx4 v227, s[32:35], s26 offen offset:3072 lds
  v_mfma_f32_16x16x32_bf16 a[48:51], v[36:39], v[112:115], a[48:51]
  s_add_u32 m0, s24, 16384
  ds_read_b128 v[132:135], v14 offset:33792
  v_mfma_f32_16x16x32_bf16 a[52:55], v[36:39], v[116:119], a[52:55]
  buffer_load_dwordx4 v8, s[36:39], s27 offen offset:0 lds
  v_mfma_f32_16x16x32_bf16 a[56:59], v[36:39], v[120:123], a[56:59]
  ds_read_b64_tr_b16 v[72:73], v12 offset:33024
  v_mfma_f32_16x16x32_bf16 a[60:63], v[36:39], v[124:127], a[60:63]
  buffer_load_dwordx4 v9, s[36:39], s27 offen offset:1024 lds
  v_mfma_f32_16x16x32_bf16 a[64:67], v[40:43], v[96:99], a[64:67]
  s_bitcmp1_b32 0x2a, s28
  ds_read_b64_tr_b16 v[74:75], v12 offset:34048
  v_mfma_f32_16x16x32_bf16 a[68:71], v[40:43], v[100:103], a[68:71]
  s_cselect_b32 s50, s75, 0
  buffer_load_dwordx4 v10, s[36:39], s27 offen offset:2048 lds
  v_mfma_f32_16x16x32_bf16 a[72:75], v[40:43], v[104:107], a[72:75]
  s_cselect_b32 s23, 2097152, 0
  ds_read_b128 v[136:139], v14 offset:34816
  v_mfma_f32_16x16x32_bf16 a[76:79], v[40:43], v[108:111], a[76:79]
  buffer_load_dwordx4 v11, s[36:39], s27 offen offset:3072 lds
  v_mfma_f32_16x16x32_bf16 a[80:83], v[40:43], v[112:115], a[80:83]
  ds_read_b64_tr_b16 v[76:77], v13 offset:33024
  v_mfma_f32_16x16x32_bf16 a[84:87], v[40:43], v[116:119], a[84:87]
  buffer_load_dword v231, v235, s[48:51], s74 offen
  v_mfma_f32_16x16x32_bf16 a[88:91], v[40:43], v[120:123], a[88:91]
  s_add_u32 s74, s74, s23
  ds_read_b64_tr_b16 v[78:79], v13 offset:34048
  v_mfma_f32_16x16x32_bf16 a[92:95], v[40:43], v[124:127], a[92:95]
  v_mfma_f32_16x16x32_bf16 a[96:99], v[44:47], v[96:99], a[96:99]
  ds_read_b128 v[140:143], v14 offset:35840
  v_mfma_f32_16x16x32_bf16 a[100:103], v[44:47], v[100:103], a[100:103]
  v_mfma_f32_16x16x32_bf16 a[104:107], v[44:47], v[104:107], a[104:107]
  ds_read_b64_tr_b16 v[80:81], v12 offset:33280
  v_mfma_f32_16x16x32_bf16 a[108:111], v[44:47], v[108:111], a[108:111]
  v_mfma_f32_16x16x32_bf16 a[112:115], v[44:47], v[112:115], a[112:115]
  ds_read_b64_tr_b16 v[82:83], v12 offset:34304
  v_mfma_f32_16x16x32_bf16 a[116:119], v[44:47], v[116:119], a[116:119]
  v_mfma_f32_16x16x32_bf16 a[120:123], v[44:47], v[120:123], a[120:123]
  ds_read_b128 v[144:147], v14 offset:36864
  v_mfma_f32_16x16x32_bf16 a[124:127], v[44:47], v[124:127], a[124:127]
  v_mfma_f32_16x16x32_bf16 a[128:131], v[48:51], v[96:99], a[128:131]
  ds_read_b64_tr_b16 v[84:85], v13 offset:33280
  v_mfma_f32_16x16x32_bf16 a[132:135], v[48:51], v[100:103], a[132:135]
  v_mfma_f32_16x16x32_bf16 a[136:139], v[48:51], v[104:107], a[136:139]
  ds_read_b64_tr_b16 v[86:87], v13 offset:34304
  v_mfma_f32_16x16x32_bf16 a[140:143], v[48:51], v[108:111], a[140:143]
  v_mfma_f32_16x16x32_bf16 a[144:147], v[48:51], v[112:115], a[144:147]
  ds_read_b128 v[148:151], v14 offset:37888
  v_mfma_f32_16x16x32_bf16 a[148:151], v[48:51], v[116:119], a[148:151]
  v_mfma_f32_16x16x32_bf16 a[152:155], v[48:51], v[120:123], a[152:155]
  ds_read_b64_tr_b16 v[88:89], v12 offset:33536
  v_mfma_f32_16x16x32_bf16 a[156:159], v[48:51], v[124:127], a[156:159]
  v_mfma_f32_16x16x32_bf16 a[160:163], v[52:55], v[96:99], a[160:163]
  ds_read_b64_tr_b16 v[90:91], v12 offset:34560
  v_mfma_f32_16x16x32_bf16 a[164:167], v[52:55], v[100:103], a[164:167]
  v_mfma_f32_16x16x32_bf16 a[168:171], v[52:55], v[104:107], a[168:171]
  ds_read_b128 v[152:155], v14 offset:38912
  v_mfma_f32_16x16x32_bf16 a[172:175], v[52:55], v[108:111], a[172:175]
  v_mfma_f32_16x16x32_bf16 a[176:179], v[52:55], v[112:115], a[176:179]
  ds_read_b64_tr_b16 v[92:93], v13 offset:33536
  v_mfma_f32_16x16x32_bf16 a[180:183], v[52:55], v[116:119], a[180:183]
  v_mfma_f32_16x16x32_bf16 a[184:187], v[52:55], v[120:123], a[184:187]
  ds_read_b64_tr_b16 v[94:95], v13 offset:34560
  v_mfma_f32_16x16x32_bf16 a[188:191], v[52:55], v[124:127], a[188:191]
  v_mfma_f32_16x16x32_bf16 a[192:195], v[56:59], v[96:99], a[192:195]
  s_add_u32 s26, s26, 64
  ds_read_b128 v[156:159], v14 offset:39936
  v_mfma_f32_16x16x32_bf16 a[196:199], v[56:59], v[100:103], a[196:199]
  s_add_u32 s27, s27, s25
  v_mfma_f32_16x16x32_bf16 a[200:203], v[56:59], v[104:107], a[200:203]
  s_add_u32 s24, s24, 32768
  v_mfma_f32_16x16x32_bf16 a[204:207], v[56:59], v[108:111], a[204:207]
  s_and_b32 s24, s24, 0x1ffff
  v_mfma_f32_16x16x32_bf16 a[208:211], v[56:59], v[112:115], a[208:211]
  v_xor_b32 v14, 0x10000, v14
  v_mfma_f32_16x16x32_bf16 a[212:215], v[56:59], v[116:119], a[212:215]
  v_xor_b32 v12, 0x10000, v12
  v_mfma_f32_16x16x32_bf16 a[216:219], v[56:59], v[120:123], a[216:219]
  v_xor_b32 v13, 0x10000, v13
  v_mfma_f32_16x16x32_bf16 a[220:223], v[56:59], v[124:127], a[220:223]
  v_mfma_f32_16x16x32_bf16 a[224:227], v[60:63], v[96:99], a[224:227]
  v_mfma_f32_16x16x32_bf16 a[228:231], v[60:63], v[100:103], a[228:231]
  v_mfma_f32_16x16x32_bf16 a[232:235], v[60:63], v[104:107], a[232:235]
  v_mfma_f32_16x16x32_bf16 a[236:239], v[60:63], v[108:111], a[236:239]
  v_mfma_f32_16x16x32_bf16 a[240:243], v[60:63], v[112:115], a[240:243]
  v_mfma_f32_16x16x32_bf16 a[244:247], v[60:63], v[116:119], a[244:247]
  v_mfma_f32_16x16x32_bf16 a[248:251], v[60:63], v[120:123], a[248:251]
  v_mfma_f32_16x16x32_bf16 a[252:255], v[60:63], v[124:127], a[252:255]
  s_waitcnt lgkmcnt(0)
  v_mfma_f32_16x16x32_bf16 a[0:3], v[64:67], v[128:131], a[0:3]
  s_waitcnt vmcnt(18)
  v_mfma_f32_16x16x32_bf16 a[4:7], v[64:67], v[132:135], a[4:7]
  s_barrier
  v_mfma_f32_16x16x32_bf16 a[8:11], v[64:67], v[136:139], a[8:11]
  ds_read_b64_tr_b16 v[32:33], v12 offset:0
  v_mfma_f32_16x16x32_bf16 a[12:15], v[64:67], v[140:143], a[12:15]
  v_mfma_f32_16x16x32_bf16 a[16:19], v[64:67], v[144:147], a[16:19]
  s_mov_b32 m0, s24
  ds_read_b64_tr_b16 v[34:35], v12 offset:1024
  v_mfma_f32_16x16x32_bf16 a[20:23], v[64:67], v[148:151], a[20:23]
  buffer_load_dwordx4 v224, s[32:35], s26 offen offset:0 lds
  v_mfma_f32_16x16x32_bf16 a[24:27], v[64:67], v[152:155], a[24:27]
  ds_read_b128 v[96:99], v14 offset:0
  v_mfma_f32_16x16x32_bf16 a[28:31], v[64:67], v[156:159], a[28:31]
  v_mfma_f32_16x16x32_bf16 a[32:35], v[68:71], v[128:131], a[32:35]
  ds_read_b64_tr_b16 v[36:37], v13 offset:0
  v_mfma_f32_16x16x32_bf16 a[36:39], v[68:71], v[132:135], a[36:39]
  v_mfma_f32_16x16x32_bf16 a[40:43], v[68:71], v[136:139], a[40:43]
  ds_read_b64_tr_b16 v[38:39], v13 offset:1024
  v_mfma_f32_16x16x32_bf16 a[44:47], v[68:71], v[140:143], a[44:47]
  buffer_load_dwordx4 v225, s[32:35], s26 offen offset:1024 lds
  v_mfma_f32_16x16x32_bf16 a[48:51], v[68:71], v[144:147], a[48:51]
  ds_read_b128 v[100:103], v14 offset:1024
  v_mfma_f32_16x16x32_bf16 a[52:55], v[68:71], v[148:151], a[52:55]
  v_mfma_f32_16x16x32_bf16 a[56:59], v[68:71], v[152:155], a[56:59]
  ds_read_b64_tr_b16 v[40:41], v12 offset:256
  v_mfma_f32_16x16x32_bf16 a[60:63], v[68:71], v[156:159], a[60:63]
  v_mfma_f32_16x16x32_bf16 a[64:67], v[72:75], v[128:131], a[64:67]
  ds_read_b64_tr_b16 v[42:43], v12 offset:1280
  v_mfma_f32_16x16x32_bf16 a[68:71], v[72:75], v[132:135], a[68:71]
  buffer_load_dwordx4 v226, s[32:35], s26 offen offset:2048 lds
  v_mfma_f32_16x16x32_bf16 a[72:75], v[72:75], v[136:139], a[72:75]
  ds_read_b128 v[104:107], v14 offset:2048
  v_mfma_f32_16x16x32_bf16 a[76:79], v[72:75], v[140:143], a[76:79]
  v_mfma_f32_16x16x32_bf16 a[80:83], v[72:75], v[144:147], a[80:83]
  ds_read_b64_tr_b16 v[44:45], v13 offset:256
  v_mfma_f32_16x16x32_bf16 a[84:87], v[72:75], v[148:151], a[84:87]
  v_mfma_f32_16x16x32_bf16 a[88:91], v[72:75], v[152:155], a[88:91]
  ds_read_b64_tr_b16 v[46:47], v13 offset:1280
  v_mfma_f32_16x16x32_bf16 a[92:95], v[72:75], v[156:159], a[92:95]
  buffer_load_dwordx4 v227, s[32:35], s26 offen offset:3072 lds
  v_mfma_f32_16x16x32_bf16 a[96:99], v[76:79], v[128:131], a[96:99]
  ds_read_b128 v[108:111], v14 offset:3072
  v_mfma_f32_16x16x32_bf16 a[100:103], v[76:79], v[132:135], a[100:103]
  v_mfma_f32_16x16x32_bf16 a[104:107], v[76:79], v[136:139], a[104:107]
  ds_read_b64_tr_b16 v[48:49], v12 offset:512
  v_mfma_f32_16x16x32_bf16 a[108:111], v[76:79], v[140:143], a[108:111]
  v_mfma_f32_16x16x32_bf16 a[112:115], v[76:79], v[144:147], a[112:115]
  s_add_u32 m0, s24, 16384
  ds_read_b64_tr_b16 v[50:51], v12 offset:1536
  v_mfma_f32_16x16x32_bf16 a[116:119], v[76:79], v[148:151], a[116:119]
  buffer_load_dwordx4 v8, s[36:39], s27 offen offset:0 lds
  v_mfma_f32_16x16x32_bf16 a[120:123], v[76:79], v[152:155], a[120:123]
  ds_read_b128 v[112:115], v14 offset:4096
  v_mfma_f32_16x16x32_bf16 a[124:127], v[76:79], v[156:159], a[124:127]
  v_mfma_f32_16x16x32_bf16 a[128:131], v[80:83], v[128:131], a[128:131]
  ds_read_b64_tr_b16 v[52:53], v13 offset:512
  v_mfma_f32_16x16x32_bf16 a[132:135], v[80:83], v[132:135], a[132:135]
  v_mfma_f32_16x16x32_bf16 a[136:139], v[80:83], v[136:139], a[136:139]
  ds_read_b64_tr_b16 v[54:55], v13 offset:1536
  v_mfma_f32_16x16x32_bf16 a[140:143], v[80:83], v[140:143], a[140:143]
  buffer_load_dwordx4 v9, s[36:39], s27 offen offset:1024 lds
  v_mfma_f32_16x16x32_bf16 a[144:147], v[80:83], v[144:147], a[144:147]
  ds_read_b128 v[116:119], v14 offset:5120
  v_mfma_f32_16x16x32_bf16 a[148:151], v[80:83], v[148:151], a[148:151]
  v_mfma_f32_16x16x32_bf16 a[152:155], v[80:83], v[152:155], a[152:155]
  ds_read_b64_tr_b16 v[56:57], v12 offset:768
  v_mfma_f32_16x16x32_bf16 a[156:159], v[80:83], v[156:159], a[156:159]
  v_mfma_f32_16x16x32_bf16 a[160:163], v[84:87], v[128:131], a[160:163]
  ds_read_b64_tr_b16 v[58:59], v12 offset:1792
  v_mfma_f32_16x16x32_bf16 a[164:167], v[84:87], v[132:135], a[164:167]
  buffer_load_dwordx4 v10, s[36:39], s27 offen offset:2048 lds
  v_mfma_f32_16x16x32_bf16 a[168:171], v[84:87], v[136:139], a[168:171]
  ds_read_b128 v[120:123], v14 offset:6144
  v_mfma_f32_16x16x32_bf16 a[172:175], v[84:87], v[140:143], a[172:175]
  v_mfma_f32_16x16x32_bf16 a[176:179], v[84:87], v[144:147], a[176:179]
  ds_read_b64_tr_b16 v[60:61], v13 offset:768
  v_mfma_f32_16x16x32_bf16 a[180:183], v[84:87], v[148:151], a[180:183]
  v_mfma_f32_16x16x32_bf16 a[184:187], v[84:87], v[152:155], a[184:187]
  ds_read_b64_tr_b16 v[62:63], v13 offset:1792
  v_mfma_f32_16x16x32_bf16 a[188:191], v[84:87], v[156:159], a[188:191]
  buffer_load_dwordx4 v11, s[36:39], s27 offen offset:3072 lds
  v_mfma_f32_16x16x32_bf16 a[192:195], v[88:91], v[128:131], a[192:195]
  s_add_u32 s26, s26, 64
  ds_read_b128 v[124:127], v14 offset:7168
  v_mfma_f32_16x16x32_bf16 a[196:199], v[88:91], v[132:135], a[196:199]
  s_add_u32 s27, s27, s25
  v_mfma_f32_16x16x32_bf16 a[200:203], v[88:91], v[136:139], a[200:203]
  s_add_u32 s24, s24, 32768
  v_mfma_f32_16x16x32_bf16 a[204:207], v[88:91], v[140:143], a[204:207]
  s_and_b32 s24, s24, 0x1ffff
  v_mfma_f32_16x16x32_bf16 a[208:211], v[88:91], v[144:147], a[208:211]
  v_mfma_f32_16x16x32_bf16 a[212:215], v[88:91], v[148:151], a[212:215]
  v_mfma_f32_16x16x32_bf16 a[216:219], v[88:91], v[152:155], a[216:219]
  s_add_u32 s28, s28, 1
  v_mfma_f32_16x16x32_bf16 a[220:223], v[88:91], v[156:159], a[220:223]
  v_mfma_f32_16x16x32_bf16 a[224:227], v[92:95], v[128:131], a[224:227]
  v_mfma_f32_16x16x32_bf16 a[228:231], v[92:95], v[132:135], a[228:231]
  v_mfma_f32_16x16x32_bf16 a[232:235], v[92:95], v[136:139], a[232:235]
  v_mfma_f32_16x16x32_bf16 a[236:239], v[92:95], v[140:143], a[236:239]
  v_mfma_f32_16x16x32_bf16 a[240:243], v[92:95], v[144:147], a[240:243]
  v_mfma_f32_16x16x32_bf16 a[244:247], v[92:95], v[148:151], a[244:247]
  s_cmp_lt_u32 s28, 8
  v_mfma_f32_16x16x32_bf16 a[248:251], v[92:95], v[152:155], a[248:251]
  s_waitcnt lgkmcnt(0)
  v_mfma_f32_16x16x32_bf16 a[252:255], v[92:95], v[156:159], a[252:255]
  s_cbranch_scc1 fa_loopK
  s_mov_b32 s60, 2048
  s_mov_b32 s61, 8192
  s_mov_b32 s62, 16777216
  s_branch fa_p1epi
fa_roleV:
  ds_read_b128 v[32:35], v14 offset:0
  ds_read_b128 v[36:39], v14 offset:1024
  ds_read_b128 v[40:43], v14 offset:2048
  ds_read_b128 v[44:47], v14 offset:3072
  ds_read_b128 v[48:51], v14 offset:4096
  ds_read_b128 v[52:55], v14 offset:5120
  ds_read_b128 v[56:59], v14 offset:6144
  ds_read_b128 v[60:63], v14 offset:7168
  ds_read_b64_tr_b16 v[96:97], v12 offset:0
  ds_read_b64_tr_b16 v[98:99], v12 offset:1024
  ds_read_b64_tr_b16 v[100:101], v13 offset:0
  ds_read_b64_tr_b16 v[102:103], v13 offset:1024
  ds_read_b64_tr_b16 v[104:105], v12 offset:256
  ds_read_b64_tr_b16 v[106:107], v12 offset:1280
  ds_read_b64_tr_b16 v[108:109], v13 offset:256
  ds_read_b64_tr_b16 v[110:111], v13 offset:1280
  ds_read_b64_tr_b16 v[112:113], v12 offset:512
  ds_read_b64_tr_b16 v[114:115], v12 offset:1536
  ds_read_b64_tr_b16 v[116:117], v13 offset:512
  ds_read_b64_tr_b16 v[118:119], v13 offset:1536
  ds_read_b64_tr_b16 v[120:121], v12 offset:768
  ds_read_b64_tr_b16 v[122:123], v12 offset:1792
  ds_read_b64_tr_b16 v[124:125], v13 offset:768
  ds_read_b64_tr_b16 v[126:127], v13 offset:1792
  s_waitcnt lgkmcnt(0)
.p2align 6
fa_loopV:
  v_mfma_f32_16x16x32_bf16 a[0:3], v[32:35], v[96:99], a[0:3]
  s_waitcnt vmcnt(17)
  v_mfma_f32_16x16x32_bf16 a[4:7], v[32:35], v[100:103], a[4:7]
  s_barrier
  v_mfma_f32_16x16x32_bf16 a[8:11], v[32:35], v[104:107], a[8:11]
  s_bitcmp1_b32 0x41, s28
  ds_read_b64_tr_b16 v[128:129], v12 offset:32768
  v_mfma_f32_16x16x32_bf16 a[12:15], v[32:35], v[108:111], a[12:15]
  s_cbranch_scc1 fa_p1stubV
fa_p1backV:
  v_mfma_f32_16x16x32_bf16 a[16:19], v[32:35], v[112:115], a[16:19]
  s_mov_b32 m0, s24
  ds_read_b64_tr_b16 v[130:131], v12 offset:33792
  v_mfma_f32_16x16x32_bf16 a[20:23], v[32:35], v[116:119], a[20:23]
  buffer_load_dwordx4 v224, s[32:35], s26 offen offset:0 lds
  v_mfma_f32_16x16x32_bf16 a[24:27], v[32:35], v[120:123], a[24:27]
  ds_read_b128 v[64:67], v14 offset:32768
  v_mfma_f32_16x16x32_bf16 a[28:31], v[32:35], v[124:127], a[28:31]
  buffer_load_dwordx4 v225, s[32:35], s26 offen offset:1024 lds
  v_mfma_f32_16x16x32_bf16 a[32:35], v[36:39], v[96:99], a[32:35]
  ds_read_b64_tr_b16 v[132:133], v13 offset:32768
  v_mfma_f32_16x16x32_bf16 a[36:39], v[36:39], v[100:103], a[36:39]
  buffer_load_dwordx4 v226, s[32:35], s26 offen offset:2048 lds
  v_mfma_f32_16x16x32_bf16 a[40:43], v[36:39], v[104:107], a[40:43]
  ds_read_b64_tr_b16 v[134:135], v13 offset:33792
  v_mfma_f32_16x16x32_bf16 a[44:47], v[36:39], v[108:111], a[44:47]
  buffer_load_dwordx4 v227, s[32:35], s26 offen offset:3072 lds
  v_mfma_f32_16x16x32_bf16 a[48:51], v[36:39], v[112:115], a[48:51]
  s_add_u32 m0, s24, 16384
  ds_read_b128 v[68:71], v14 offset:33792
  v_mfma_f32_16x16x32_bf16 a[52:55], v[36:39], v[116:119], a[52:55]
  buffer_load_dwordx4 v8, s[36:39], s27 offen offset:0 lds
  v_mfma_f32_16x16x32_bf16 a[56:59], v[36:39], v[120:123], a[56:59]
  ds_read_b64_tr_b16 v[136:137], v12 offset:33024
  v_mfma_f32_16x16x32_bf16 a[60:63], v[36:39], v[124:127], a[60:63]
  buffer_load_dwordx4 v9, s[36:39], s27 offen offset:1024 lds
  v_mfma_f32_16x16x32_bf16 a[64:67], v[40:43], v[96:99], a[64:67]
  s_bitcmp1_b32 0x2a, s28
  ds_read_b64_tr_b16 v[138:139], v12 offset:34048
  v_mfma_f32_16x16x32_bf16 a[68:71], v[40:43], v[100:103], a[68:71]
  s_cselect_b32 s50, s75, 0
  buffer_load_dwordx4 v10, s[36:39], s27 offen offset:2048 lds
  v_mfma_f32_16x16x32_bf16 a[72:75], v[40:43], v[104:107], a[72:75]
  s_cselect_b32 s23, 2097152, 0
  ds_read_b128 v[72:75], v14 offset:34816
  v_mfma_f32_16x16x32_bf16 a[76:79], v[40:43], v[108:111], a[76:79]
  buffer_load_dwordx4 v11, s[36:39], s27 offen offset:3072 lds
  v_mfma_f32_16x16x32_bf16 a[80:83], v[40:43], v[112:115], a[80:83]
  ds_read_b64_tr_b16 v[140:141], v13 offset:33024
  v_mfma_f32_16x16x32_bf16 a[84:87], v[40:43], v[116:119], a[84:87]
  buffer_load_dword v231, v235, s[48:51], s74 offen
  v_mfma_f32_16x16x32_bf16 a[88:91], v[40:43], v[120:123], a[88:91]
  s_add_u32 s74, s74, s23
  ds_read_b64_tr_b16 v[142:143], v13 offset:34048
  v_mfma_f32_16x16x32_bf16 a[92:95], v[40:43], v[124:127], a[92:95]
  v_mfma_f32_16x16x32_bf16 a[96:99], v[44:47], v[96:99], a[96:99]
  ds_read_b128 v[76:79], v14 offset:35840
  v_mfma_f32_16x16x32_bf16 a[100:103], v[44:47], v[100:103], a[100:103]
  v_mfma_f32_16x16x32_bf16 a[104:107], v[44:47], v[104:107], a[104:107]
  ds_read_b64_tr_b16 v[144:145], v12 offset:33280
  v_mfma_f32_16x16x32_bf16 a[108:111], v[44:47], v[108:111], a[108:111]
  v_mfma_f32_16x16x32_bf16 a[112:115], v[44:47], v[112:115], a[112:115]
  ds_read_b64_tr_b16 v[146:147], v12 offset:34304
  v_mfma_f32_16x16x32_bf16 a[116:119], v[44:47], v[116:119], a[116:119]
  v_mfma_f32_16x16x32_bf16 a[120:123], v[44:47], v[120:123], a[120:123]
  ds_read_b128 v[80:83], v14 offset:36864
  v_mfma_f32_16x16x32_bf16 a[124:127], v[44:47], v[124:127], a[124:127]
  v_mfma_f32_16x16x32_bf16 a[128:131], v[48:51], v[96:99], a[128:131]
  ds_read_b64_tr_b16 v[148:149], v13 offset:33280
  v_mfma_f32_16x16x32_bf16 a[132:135], v[48:51], v[100:103], a[132:135]
  v_mfma_f32_16x16x32_bf16 a[136:139], v[48:51], v[104:107], a[136:139]
  ds_read_b64_tr_b16 v[150:151], v13 offset:34304
  v_mfma_f32_16x16x32_bf16 a[140:143], v[48:51], v[108:111], a[140:143]
  v_mfma_f32_16x16x32_bf16 a[144:147], v[48:51], v[112:115], a[144:147]
  ds_read_b128 v[84:87], v14 offset:37888
  v_mfma_f32_16x16x32_bf16 a[148:151], v[48:51], v[116:119], a[148:151]
  v_mfma_f32_16x16x32_bf16 a[152:155], v[48:51], v[120:123], a[152:155]
  ds_read_b64_tr_b16 v[152:153], v12 offset:33536
  v_mfma_f32_16x16x32_bf16 a[156:159], v[48:51], v[124:127], a[156:159]
  v_mfma_f32_16x16x32_bf16 a[160:163], v[52:55], v[96:99], a[160:163]
  ds_read_b64_tr_b16 v[154:155], v12 offset:34560
  v_mfma_f32_16x16x32_bf16 a[164:167], v[52:55], v[100:103], a[164:167]
  v_mfma_f32_16x16x32_bf16 a[168:171], v[52:55], v[104:107], a[168:171]
  ds_read_b128 v[88:91], v14 offset:38912
  v_mfma_f32_16x16x32_bf16 a[172:175], v[52:55], v[108:111], a[172:175]
  v_mfma_f32_16x16x32_bf16 a[176:179], v[52:55], v[112:115], a[176:179]
  ds_read_b64_tr_b16 v[156:157], v13 offset:33536
  v_mfma_f32_16x16x32_bf16 a[180:183], v[52:55], v[116:119], a[180:183]
  v_mfma_f32_16x16x32_bf16 a[184:187], v[52:55], v[120:123], a[184:187]
  ds_read_b64_tr_b16 v[158:159], v13 offset:34560
  v_mfma_f32_16x16x32_bf16 a[188:191], v[52:55], v[124:127], a[188:191]
  v_mfma_f32_16x16x32_bf16 a[192:195], v[56:59], v[96:99], a[192:195]
  s_add_u32 s26, s26, 64
  ds_read_b128 v[92:95], v14 offset:39936
  v_mfma_f32_16x16x32_bf16 a[196:199], v[56:59], v[100:103], a[196:199]
  s_add_u32 s27, s27, s25
  v_mfma_f32_16x16x32_bf16 a[200:203], v[56:59], v[104:107], a[200:203]
  s_add_u32 s24, s24, 32768
  v_mfma_f32_16x16x32_bf16 a[204:207], v[56:59], v[108:111], a[204:207]
  s_and_b32 s24, s24, 0x1ffff
  v_mfma_f32_16x16x32_bf16 a[208:211], v[56:59], v[112:115], a[208:211]
  v_xor_b32 v14, 0x10000, v14
  v_mfma_f32_16x16x32_bf16 a[212:215], v[56:59], v[116:119], a[212:215]
  v_xor_b32 v12, 0x10000, v12
  v_mfma_f32_16x16x32_bf16 a[216:219], v[56:59], v[120:123], a[216:219]
  v_xor_b32 v13, 0x10000, v13
  v_mfma_f32_16x16x32_bf16 a[220:223], v[56:59], v[124:127], a[220:223]
  v_mfma_f32_16x16x32_bf16 a[224:227], v[60:63], v[96:99], a[224:227]
  v_mfma_f32_16x16x32_bf16 a[228:231], v[60:63], v[100:103], a[228:231]
  v_mfma_f32_16x16x32_bf16 a[232:235], v[60:63], v[104:107], a[232:235]
  v_mfma_f32_16x16x32_bf16 a[236:239], v[60:63], v[108:111], a[236:239]
  v_mfma_f32_16x16x32_bf16 a[240:243], v[60:63], v[112:115], a[240:243]
  v_mfma_f32_16x16x32_bf16 a[244:247], v[60:63], v[116:119], a[244:247]
  v_mfma_f32_16x16x32_bf16 a[248:251], v[60:63], v[120:123], a[248:251]
  v_mfma_f32_16x16x32_bf16 a[252:255], v[60:63], v[124:127], a[252:255]
  s_waitcnt lgkmcnt(0)
  v_mfma_f32_16x16x32_bf16 a[0:3], v[64:67], v[128:131], a[0:3]
  s_waitcnt vmcnt(18)
  v_mfma_f32_16x16x32_bf16 a[4:7], v[64:67], v[132:135], a[4:7]
  s_barrier
  v_mfma_f32_16x16x32_bf16 a[8:11], v[64:67], v[136:139], a[8:11]
  ds_read_b64_tr_b16 v[96:97], v12 offset:0
  v_mfma_f32_16x16x32_bf16 a[12:15], v[64:67], v[140:143], a[12:15]
  v_mfma_f32_16x16x32_bf16 a[16:19], v[64:67], v[144:147], a[16:19]
  s_mov_b32 m0, s24
  ds_read_b64_tr_b16 v[98:99], v12 offset:1024
  v_mfma_f32_16x16x32_bf16 a[20:23], v[64:67], v[148:151], a[20:23]
  buffer_load_dwordx4 v224, s[32:35], s26 offen offset:0 lds
  v_mfma_f32_16x16x32_bf16 a[24:27], v[64:67], v[152:155], a[24:27]
  ds_read_b128 v[32:35], v14 offset:0
  v_mfma_f32_16x16x32_bf16 a[28:31], v[64:67], v[156:159], a[28:31]
  v_mfma_f32_16x16x32_bf16 a[32:35], v[68:71], v[128:131], a[32:35]
  ds_read_b64_tr_b16 v[100:101], v13 offset:0
  v_mfma_f32_16x16x32_bf16 a[36:39], v[68:71], v[132:135], a[36:39]
  v_mfma_f32_16x16x32_bf16 a[40:43], v[68:71], v[136:139], a[40:43]
  ds_read_b64_tr_b16 v[102:103], v13 offset:1024
  v_mfma_f32_16x16x32_bf16 a[44:47], v[68:71], v[140:143], a[44:47]
  buffer_load_dwordx4 v225, s[32:35], s26 offen offset:1024 lds
  v_mfma_f32_16x16x32_bf16 a[48:51], v[68:71], v[144:147], a[48:51]
  ds_read_b128 v[36:39], v14 offset:1024
  v_mfma_f32_16x16x32_bf16 a[52:55], v[68:71], v[148:151], a[52:55]
  v_mfma_f32_16x16x32_bf16 a[56:59], v[68:71], v[152:155], a[56:59]
  ds_read_b64_tr_b16 v[104:105], v12 offset:256
  v_mfma_f32_16x16x32_bf16 a[60:63], v[68:71], v[156:159], a[60:63]
  v_mfma_f32_16x16x32_bf16 a[64:67], v[72:75], v[128:131], a[64:67]
  ds_read_b64_tr_b16 v[106:107], v12 offset:1280
  v_mfma_f32_16x16x32_bf16 a[68:71], v[72:75], v[132:135], a[68:71]
  buffer_load_dwordx4 v226, s[32:35], s26 offen offset:2048 lds
  v_mfma_f32_16x16x32_bf16 a[72:75], v[72:75], v[136:139], a[72:75]
  ds_read_b128 v[40:43], v14 offset:2048
  v_mfma_f32_16x16x32_bf16 a[76:79], v[72:75], v[140:143], a[76:79]
  v_mfma_f32_16x16x32_bf16 a[80:83], v[72:75], v[144:147], a[80:83]
  ds_read_b64_tr_b16 v[108:109], v13 offset:256
  v_mfma_f32_16x16x32_bf16 a[84:87], v[72:75], v[148:151], a[84:87]
  v_mfma_f32_16x16x32_bf16 a[88:91], v[72:75], v[152:155], a[88:91]
  ds_read_b64_tr_b16 v[110:111], v13 offset:1280
  v_mfma_f32_16x16x32_bf16 a[92:95], v[72:75], v[156:159], a[92:95]
  buffer_load_dwordx4 v227, s[32:35], s26 offen offset:3072 lds
  v_mfma_f32_16x16x32_bf16 a[96:99], v[76:79], v[128:131], a[96:99]
  ds_read_b128 v[44:47], v14 offset:3072
  v_mfma_f32_16x16x32_bf16 a[100:103], v[76:79], v[132:135], a[100:103]
  v_mfma_f32_16x16x32_bf16 a[104:107], v[76:79], v[136:139], a[104:107]
  ds_read_b64_tr_b16 v[112:113], v12 offset:512
  v_mfma_f32_16x16x32_bf16 a[108:111], v[76:79], v[140:143], a[108:111]
  v_mfma_f32_16x16x32_bf16 a[112:115], v[76:79], v[144:147], a[112:115]
  s_add_u32 m0, s24, 16384
  ds_read_b64_tr_b16 v[114:115], v12 offset:1536
  v_mfma_f32_16x16x32_bf16 a[116:119], v[76:79], v[148:151], a[116:119]
  buffer_load_dwordx4 v8, s[36:39], s27 offen offset:0 lds
  v_mfma_f32_16x16x32_bf16 a[120:123], v[76:79], v[152:155], a[120:123]
  ds_read_b128 v[48:51], v14 offset:4096
  v_mfma_f32_16x16x32_bf16 a[124:127], v[76:79], v[156:159], a[124:127]
  v_mfma_f32_16x16x32_bf16 a[128:131], v[80:83], v[128:131], a[128:131]
  ds_read_b64_tr_b16 v[116:117], v13 offset:512
  v_mfma_f32_16x16x32_bf16 a[132:135], v[80:83], v[132:135], a[132:135]
  v_mfma_f32_16x16x32_bf16 a[136:139], v[80:83], v[136:139], a[136:139]
  ds_read_b64_tr_b16 v[118:119], v13 offset:1536
  v_mfma_f32_16x16x32_bf16 a[140:143], v[80:83], v[140:143], a[140:143]
  buffer_load_dwordx4 v9, s[36:39], s27 offen offset:1024 lds
  v_mfma_f32_16x16x32_bf16 a[144:147], v[80:83], v[144:147], a[144:147]
  ds_read_b128 v[52:55], v14 offset:5120
  v_mfma_f32_16x16x32_bf16 a[148:151], v[80:83], v[148:151], a[148:151]
  v_mfma_f32_16x16x32_bf16 a[152:155], v[80:83], v[152:155], a[152:155]
  ds_read_b64_tr_b16 v[120:121], v12 offset:768
  v_mfma_f32_16x16x32_bf16 a[156:159], v[80:83], v[156:159], a[156:159]
  v_mfma_f32_16x16x32_bf16 a[160:163], v[84:87], v[128:131], a[160:163]
  ds_read_b64_tr_b16 v[122:123], v12 offset:1792
  v_mfma_f32_16x16x32_bf16 a[164:167], v[84:87], v[132:135], a[164:167]
  buffer_load_dwordx4 v10, s[36:39], s27 offen offset:2048 lds
  v_mfma_f32_16x16x32_bf16 a[168:171], v[84:87], v[136:139], a[168:171]
  ds_read_b128 v[56:59], v14 offset:6144
  v_mfma_f32_16x16x32_bf16 a[172:175], v[84:87], v[140:143], a[172:175]
  v_mfma_f32_16x16x32_bf16 a[176:179], v[84:87], v[144:147], a[176:179]
  ds_read_b64_tr_b16 v[124:125], v13 offset:768
  v_mfma_f32_16x16x32_bf16 a[180:183], v[84:87], v[148:151], a[180:183]
  v_mfma_f32_16x16x32_bf16 a[184:187], v[84:87], v[152:155], a[184:187]
  ds_read_b64_tr_b16 v[126:127], v13 offset:1792
  v_mfma_f32_16x16x32_bf16 a[188:191], v[84:87], v[156:159], a[188:191]
  buffer_load_dwordx4 v11, s[36:39], s27 offen offset:3072 lds
  v_mfma_f32_16x16x32_bf16 a[192:195], v[88:91], v[128:131], a[192:195]
  s_add_u32 s26, s26, 64
  ds_read_b128 v[60:63], v14 offset:7168
  v_mfma_f32_16x16x32_bf16 a[196:199], v[88:91], v[132:135], a[196:199]
  s_add_u32 s27, s27, s25
  v_mfma_f32_16x16x32_bf16 a[200:203], v[88:91], v[136:139], a[200:203]
  s_add_u32 s24, s24, 32768
  v_mfma_f32_16x16x32_bf16 a[204:207], v[88:91], v[140:143], a[204:207]
  s_and_b32 s24, s24, 0x1ffff
  v_mfma_f32_16x16x32_bf16 a[208:211], v[88:91], v[144:147], a[208:211]
  v_mfma_f32_16x16x32_bf16 a[212:215], v[88:91], v[148:151], a[212:215]
  v_mfma_f32_16x16x32_bf16 a[216:219], v[88:91], v[152:155], a[216:219]
  s_add_u32 s28, s28, 1
  v_mfma_f32_16x16x32_bf16 a[220:223], v[88:91], v[156:159], a[220:223]
  v_mfma_f32_16x16x32_bf16 a[224:227], v[92:95], v[128:131], a[224:227]
  v_mfma_f32_16x16x32_bf16 a[228:231], v[92:95], v[132:135], a[228:231]
  v_mfma_f32_16x16x32_bf16 a[232:235], v[92:95], v[136:139], a[232:235]
  v_mfma_f32_16x16x32_bf16 a[236:239], v[92:95], v[140:143], a[236:239]
  v_mfma_f32_16x16x32_bf16 a[240:243], v[92:95], v[144:147], a[240:243]
  v_mfma_f32_16x16x32_bf16 a[244:247], v[92:95], v[148:151], a[244:247]
  s_cmp_lt_u32 s28, 8
  v_mfma_f32_16x16x32_bf16 a[248:251], v[92:95], v[152:155], a[248:251]
  s_waitcnt lgkmcnt(0)
  v_mfma_f32_16x16x32_bf16 a[252:255], v[92:95], v[156:159], a[252:255]
  s_cbranch_scc1 fa_loopV
  s_mov_b32 s60, 8192
  s_mov_b32 s61, 2048
  s_mov_b32 s62, 33554432
fa_p1epi:
  s_lshl_b32 s23, s21, 19
  s_add_u32 s62, s62, s23
  s_lshl_b32 s23, s22, 16
  s_add_u32 s62, s62, s23
  s_and_b32 s23, s20, 1
  s_lshl_b32 s23, s23, 15
  s_add_u32 s62, s62, s23
  s_lshl_b32 s23, s22, 2
  s_add_u32 s23, s23, s20
  s_mul_i32 s64, s23, 40960
  s_add_u32 s65, s64, 20480
  s_sub_u32 s23, 15, s22
  s_lshl_b32 s23, s23, 2
  s_add_u32 s23, s23, s20
  s_mul_i32 s66, s23, 40960
  s_add_u32 s67, s66, 20480
  v_cmp_ne_u32 vcc, 0x01010101, v228
  s_cbranch_vccnz fa_ln_spin
fa_ln_ok:
  v_accvgpr_read_b32 v100, a192
  v_accvgpr_read_b32 v101, a193
  v_accvgpr_read_b32 v102, a194
  v_accvgpr_read_b32 v103, a195
  v_accvgpr_read_b32 v104, a224
  v_accvgpr_read_b32 v105, a225
  v_accvgpr_read_b32 v106, a226
  v_accvgpr_read_b32 v107, a227
  v_accvgpr_read_b32 v112, a196
  v_accvgpr_read_b32 v113, a197
  v_accvgpr_read_b32 v114, a198
  v_accvgpr_read_b32 v115, a199
  v_accvgpr_read_b32 v116, a228
  v_accvgpr_read_b32 v117, a229
  v_accvgpr_read_b32 v118, a230
  v_accvgpr_read_b32 v119, a231
  v_accvgpr_read_b32 v124, a200
  v_accvgpr_read_b32 v125, a201
  v_accvgpr_read_b32 v126, a202
  v_accvgpr_read_b32 v127, a203
  v_accvgpr_read_b32 v128, a232
  v_accvgpr_read_b32 v129, a233
  v_accvgpr_read_b32 v130, a234
  v_accvgpr_read_b32 v131, a235
  v_accvgpr_read_b32 v136, a204
  v_accvgpr_read_b32 v137, a205
  v_accvgpr_read_b32 v138, a206
  v_accvgpr_read_b32 v139, a207
  v_accvgpr_read_b32 v140, a236
  v_accvgpr_read_b32 v141, a237
  v_accvgpr_read_b32 v142, a238
  v_accvgpr_read_b32 v143, a239
  v_accvgpr_read_b32 v148, a208
  v_accvgpr_read_b32 v149, a209
  v_accvgpr_read_b32 v150, a210
  v_accvgpr_read_b32 v151, a211
  v_accvgpr_read_b32 v152, a240
  v_accvgpr_read_b32 v153, a241
  v_accvgpr_read_b32 v154, a242
  v_accvgpr_read_b32 v155, a243
  v_accvgpr_read_b32 v160, a212
  v_accvgpr_read_b32 v161, a213
  v_accvgpr_read_b32 v162, a214
  v_accvgpr_read_b32 v163, a215
  v_accvgpr_read_b32 v164, a244
  v_accvgpr_read_b32 v165, a245
  v_accvgpr_read_b32 v166, a246
  v_accvgpr_read_b32 v167, a247
  v_accvgpr_read_b32 v172, a216
  v_accvgpr_read_b32 v173, a217
  v_accvgpr_read_b32 v174, a218
  v_accvgpr_read_b32 v175, a219
  v_accvgpr_read_b32 v176, a248
  v_accvgpr_read_b32 v177, a249
  v_accvgpr_read_b32 v178, a250
  v_accvgpr_read_b32 v179, a251
  v_accvgpr_read_b32 v184, a220
  v_accvgpr_read_b32 v185, a221
  v_accvgpr_read_b32 v186, a222
  v_accvgpr_read_b32 v187, a223
  v_accvgpr_read_b32 v188, a252
  v_accvgpr_read_b32 v189, a253
  v_accvgpr_read_b32 v190, a254
  v_accvgpr_read_b32 v191, a255
  buffer_load_dwordx4 a[192:195], v2, s[40:43], s64 offen offset:0 sc1
  buffer_load_dwordx4 a[196:199], v2, s[40:43], s65 offen offset:0 sc1
  buffer_load_dwordx4 a[200:203], v2, s[40:43], s66 offen offset:0 sc1
  buffer_load_dwordx4 a[204:207], v2, s[40:43], s67 offen offset:0 sc1
  buffer_load_dwordx4 a[208:211], v2, s[40:43], s64 offen offset:1024 sc1
  buffer_load_dwordx4 a[212:215], v2, s[40:43], s65 offen offset:1024 sc1
  buffer_load_dwordx4 a[216:219], v2, s[40:43], s66 offen offset:1024 sc1
  buffer_load_dwordx4 a[220:223], v2, s[40:43], s67 offen offset:1024 sc1
  buffer_load_dwordx4 a[224:227], v2, s[40:43], s64 offen offset:2048 sc1
  buffer_load_dwordx4 a[228:231], v2, s[40:43], s65 offen offset:2048 sc1
  buffer_load_dwordx4 a[232:235], v2, s[40:43], s66 offen offset:2048 sc1
  buffer_load_dwordx4 a[236:239], v2, s[40:43], s67 offen offset:2048 sc1
  buffer_load_dwordx4 a[240:243], v2, s[40:43], s64 offen offset:3072 sc1
  buffer_load_dwordx4 a[244:247], v2, s[40:43], s65 offen offset:3072 sc1
  buffer_load_dwordx4 a[248:251], v2, s[40:43], s66 offen offset:3072 sc1
  buffer_load_dwordx4 a[252:255], v2, s[40:43], s67 offen offset:3072 sc1
  s_add_u32 s64, s64, 4096
  s_add_u32 s65, s65, 4096
  s_add_u32 s66, s66, 4096
  s_add_u32 s67, s67, 4096
  s_mul_i32 s63, s60, 3
  s_add_u32 s63, s63, s62
  v_cvt_pk_bf16_f32 v96, v100, v101
  v_cvt_pk_bf16_f32 v97, v102, v103
  v_cvt_pk_bf16_f32 v98, v104, v105
  v_cvt_pk_bf16_f32 v99, v106, v107
  buffer_store_dwordx4 v[96:99], v2, s[40:43], s63 offen offset:0 sc1
  v_cvt_pk_bf16_f32 v108, v112, v113
  v_cvt_pk_bf16_f32 v109, v114, v115
  v_cvt_pk_bf16_f32 v110, v116, v117
  v_cvt_pk_bf16_f32 v111, v118, v119
  buffer_store_dwordx4 v[108:111], v2, s[40:43], s63 offen offset:1024 sc1
  s_add_u32 s63, s63, s61
  v_cvt_pk_bf16_f32 v120, v124, v125
  v_cvt_pk_bf16_f32 v121, v126, v127
  v_cvt_pk_bf16_f32 v122, v128, v129
  v_cvt_pk_bf16_f32 v123, v130, v131
  buffer_store_dwordx4 v[120:123], v2, s[40:43], s63 offen offset:0 sc1
  v_cvt_pk_bf16_f32 v132, v136, v137
  v_cvt_pk_bf16_f32 v133, v138, v139
  v_cvt_pk_bf16_f32 v134, v140, v141
  v_cvt_pk_bf16_f32 v135, v142, v143
  buffer_store_dwordx4 v[132:135], v2, s[40:43], s63 offen offset:1024 sc1
  s_add_u32 s63, s63, s61
  v_cvt_pk_bf16_f32 v144, v148, v149
  v_cvt_pk_bf16_f32 v145, v150, v151
  v_cvt_pk_bf16_f32 v146, v152, v153
  v_cvt_pk_bf16_f32 v147, v154, v155
  buffer_store_dwordx4 v[144:147], v2, s[40:43], s63 offen offset:0 sc1
  v_cvt_pk_bf16_f32 v156, v160, v161
  v_cvt_pk_bf16_f32 v157, v162, v163
  v_cvt_pk_bf16_f32 v158, v164, v165
  v_cvt_pk_bf16_f32 v159, v166, v167
  buffer_store_dwordx4 v[156:159], v2, s[40:43], s63 offen offset:1024 sc1
  s_add_u32 s63, s63, s61
  v_cvt_pk_bf16_f32 v168, v172, v173
  v_cvt_pk_bf16_f32 v169, v174, v175
  v_cvt_pk_bf16_f32 v170, v176, v177
  v_cvt_pk_bf16_f32 v171, v178, v179
  buffer_store_dwordx4 v[168:171], v2, s[40:43], s63 offen offset:0 sc1
  v_cvt_pk_bf16_f32 v180, v184, v185
  v_cvt_pk_bf16_f32 v181, v186, v187
  v_cvt_pk_bf16_f32 v182, v188, v189
  v_cvt_pk_bf16_f32 v183, v190, v191
  buffer_store_dwordx4 v[180:183], v2, s[40:43], s63 offen offset:1024 sc1
  s_lshr_b32 s23, s20, 1
  s_lshl_b32 s23, s23, 13
  v_subrev_u32 v12, s23, v12
  v_subrev_u32 v13, s23, v13
  s_waitcnt vmcnt(20)
  s_barrier
  ds_read_b64_tr_b16 v[32:33], v12 offset:0
  ds_read_b64_tr_b16 v[34:35], v12 offset:1024
  ds_read_b64_tr_b16 v[36:37], v13 offset:0
  ds_read_b64_tr_b16 v[38:39], v13 offset:1024
  ds_read_b64_tr_b16 v[40:41], v12 offset:256
  ds_read_b64_tr_b16 v[42:43], v12 offset:1280
  ds_read_b64_tr_b16 v[44:45], v13 offset:256
  ds_read_b64_tr_b16 v[46:47], v13 offset:1280
  ds_read_b64_tr_b16 v[48:49], v12 offset:512
  ds_read_b64_tr_b16 v[50:51], v12 offset:1536
  ds_read_b64_tr_b16 v[52:53], v13 offset:512
  ds_read_b64_tr_b16 v[54:55], v13 offset:1536
  ds_read_b64_tr_b16 v[56:57], v12 offset:768
  ds_read_b64_tr_b16 v[58:59], v12 offset:1792
  ds_read_b64_tr_b16 v[60:61], v13 offset:768
  ds_read_b64_tr_b16 v[62:63], v13 offset:1792
  s_lshl_b32 s23, s21, 19
  s_add_u32 s23, s23, 16777216
  s_add_u32 s6, s18, s23
  s_addc_u32 s7, s19, 0
  s_add_u32 s8, s6, 16777216
  s_addc_u32 s9, s7, 0
  s_sub_u32 s23, 16, s22
  s_lshl_b32 s23, s23, 15
  s_mov_b32 s44, s6
  s_mov_b32 s45, s7
  s_mov_b32 s46, s23
  s_mov_b32 s47, 0x20000
  s_mov_b32 s48, s8
  s_mov_b32 s49, s9
  s_mov_b32 s50, s23
  s_mov_b32 s51, 0x20000
  s_waitcnt lgkmcnt(0)
  s_lshl_b32 s30, s21, 7
  s_add_u32 s30, s30, 2637824
  s_mov_b32 s81, 0x47800000
  s_cmp_eq_u32 s20, 0
  s_cselect_b32 s29, s82, 1073741824
  v_mfma_f32_16x16x32_bf16 v[96:99], v[32:35], a[192:195], 0
  v_accvgpr_read_b32 v236, a0
  v_mfma_f32_16x16x32_bf16 v[112:115], v[36:39], a[192:195], 0
  ds_read_b64_tr_b16 v[64:65], v12 offset:8192
  v_accvgpr_read_b32 v237, a1
  v_mfma_f32_16x16x32_bf16 v[128:131], v[40:43], a[192:195], 0
  ds_read_b64_tr_b16 v[66:67], v12 offset:9216
  v_accvgpr_read_b32 v238, a2
  v_mfma_f32_16x16x32_bf16 v[144:147], v[44:47], a[192:195], 0
  ds_read_b64_tr_b16 v[68:69], v13 offset:8192
  v_accvgpr_read_b32 v239, a3
  v_mfma_f32_16x16x32_bf16 v[160:163], v[48:51], a[192:195], 0
  ds_read_b64_tr_b16 v[70:71], v13 offset:9216
  v_accvgpr_read_b32 v240, a32
  v_mfma_f32_16x16x32_bf16 v[176:179], v[52:55], a[192:195], 0
  ds_read_b64_tr_b16 v[72:73], v12 offset:8448
  v_accvgpr_read_b32 v241, a33
  v_mfma_f32_16x16x32_bf16 v[192:195], v[56:59], a[192:195], 0
  ds_read_b64_tr_b16 v[74:75], v12 offset:9472
  v_accvgpr_read_b32 v242, a34
  v_mfma_f32_16x16x32_bf16 v[208:211], v[60:63], a[192:195], 0
  buffer_load_dwordx4 a[192:195], v2, s[40:43], s64 offen offset:0 sc1
  v_accvgpr_read_b32 v243, a35
  v_mfma_f32_16x16x32_bf16 v[100:103], v[32:35], a[196:199], 0
  ds_read_b64_tr_b16 v[76:77], v13 offset:8448
  v_cvt_pk_bf16_f32 v232, v236, v237
  v_mfma_f32_16x16x32_bf16 v[116:119], v[36:39], a[196:199], 0
  ds_read_b64_tr_b16 v[78:79], v13 offset:9472
  v_cvt_pk_bf16_f32 v233, v238, v239
  v_mfma_f32_16x16x32_bf16 v[132:135], v[40:43], a[196:199], 0
  ds_read_b64_tr_b16 v[80:81], v12 offset:8704
  v_cvt_pk_bf16_f32 v234, v240, v241
  v_mfma_f32_16x16x32_bf16 v[148:151], v[44:47], a[196:199], 0
  v_cvt_pk_bf16_f32 v235, v242, v243
  v_mfma_f32_16x16x32_bf16 v[164:167], v[48:51], a[196:199], 0
  ds_read_b64_tr_b16 v[82:83], v12 offset:9728
  v_mfma_f32_16x16x32_bf16 v[180:183], v[52:55], a[196:199], 0
  s_mul_i32 s63, s60, 0
  ds_read_b64_tr_b16 v[84:85], v13 offset:8704
  v_mfma_f32_16x16x32_bf16 v[196:199], v[56:59], a[196:199], 0
  s_add_u32 s63, s63, s62
  ds_read_b64_tr_b16 v[86:87], v13 offset:9728
  v_mfma_f32_16x16x32_bf16 v[212:215], v[60:63], a[196:199], 0
  buffer_load_dwordx4 a[196:199], v2, s[40:43], s65 offen offset:0 sc1
  v_mfma_f32_16x16x32_bf16 v[104:107], v[32:35], a[200:203], 0
  ds_read_b64_tr_b16 v[88:89], v12 offset:8960
  v_accvgpr_read_b32 v248, a4
  v_mfma_f32_16x16x32_bf16 v[120:123], v[36:39], a[200:203], 0
  ds_read_b64_tr_b16 v[90:91], v12 offset:9984
  v_accvgpr_read_b32 v249, a5
  v_mfma_f32_16x16x32_bf16 v[136:139], v[40:43], a[200:203], 0
  ds_read_b64_tr_b16 v[92:93], v13 offset:8960
  v_accvgpr_read_b32 v250, a6
  v_mfma_f32_16x16x32_bf16 v[152:155], v[44:47], a[200:203], 0
  v_accvgpr_read_b32 v251, a7
  v_mfma_f32_16x16x32_bf16 v[168:171], v[48:51], a[200:203], 0
  ds_read_b64_tr_b16 v[94:95], v13 offset:9984
  v_accvgpr_read_b32 v252, a36
  v_mfma_f32_16x16x32_bf16 v[184:187], v[52:55], a[200:203], 0
  buffer_store_dwordx4 v[232:235], v2, s[40:43], s63 offen offset:0 sc1
  v_accvgpr_read_b32 v253, a37
  v_mfma_f32_16x16x32_bf16 v[200:203], v[56:59], a[200:203], 0
  v_accvgpr_read_b32 v254, a38
  v_mfma_f32_16x16x32_bf16 v[216:219], v[60:63], a[200:203], 0
  buffer_load_dwordx4 a[200:203], v2, s[40:43], s66 offen offset:0 sc1
  v_accvgpr_read_b32 v255, a39
  v_mfma_f32_16x16x32_bf16 v[108:111], v[32:35], a[204:207], 0
  v_cvt_pk_bf16_f32 v244, v248, v249
  v_mfma_f32_16x16x32_bf16 v[124:127], v[36:39], a[204:207], 0
  v_cvt_pk_bf16_f32 v245, v250, v251
  v_mfma_f32_16x16x32_bf16 v[140:143], v[40:43], a[204:207], 0
  v_cvt_pk_bf16_f32 v246, v252, v253
  v_mfma_f32_16x16x32_bf16 v[156:159], v[44:47], a[204:207], 0
  v_cvt_pk_bf16_f32 v247, v254, v255
  v_mfma_f32_16x16x32_bf16 v[172:175], v[48:51], a[204:207], 0
  v_mfma_f32_16x16x32_bf16 v[188:191], v[52:55], a[204:207], 0
  buffer_store_dwordx4 v[244:247], v2, s[40:43], s63 offen offset:1024 sc1
  v_mfma_f32_16x16x32_bf16 v[204:207], v[56:59], a[204:207], 0
  v_mfma_f32_16x16x32_bf16 v[220:223], v[60:63], a[204:207], 0
  s_waitcnt vmcnt(21) lgkmcnt(0)
  buffer_load_dwordx4 a[204:207], v2, s[40:43], s67 offen offset:0 sc1
  v_mfma_f32_16x16x32_bf16 v[96:99], v[64:67], a[208:211], v[96:99]
  s_barrier
  v_accvgpr_read_b32 v236, a8
  v_mfma_f32_16x16x32_bf16 v[112:115], v[68:71], a[208:211], v[112:115]
  ds_read_b64_tr_b16 v[32:33], v12 offset:32768
  v_accvgpr_read_b32 v237, a9
  v_mfma_f32_16x16x32_bf16 v[128:131], v[72:75], a[208:211], v[128:131]
  ds_read_b64_tr_b16 v[34:35], v12 offset:33792
  v_accvgpr_read_b32 v238, a10
  v_mfma_f32_16x16x32_bf16 v[144:147], v[76:79], a[208:211], v[144:147]
  ds_read_b64_tr_b16 v[36:37], v13 offset:32768
  v_accvgpr_read_b32 v239, a11
  v_mfma_f32_16x16x32_bf16 v[160:163], v[80:83], a[208:211], v[160:163]
  ds_read_b64_tr_b16 v[38:39], v13 offset:33792
  v_accvgpr_read_b32 v240, a40
  v_mfma_f32_16x16x32_bf16 v[176:179], v[84:87], a[208:211], v[176:179]
  ds_read_b64_tr_b16 v[40:41], v12 offset:33024
  v_accvgpr_read_b32 v241, a41
  v_mfma_f32_16x16x32_bf16 v[192:195], v[88:91], a[208:211], v[192:195]
  ds_read_b64_tr_b16 v[42:43], v12 offset:34048
  v_accvgpr_read_b32 v242, a42
  v_mfma_f32_16x16x32_bf16 v[208:211], v[92:95], a[208:211], v[208:211]
  buffer_load_dwordx4 a[208:211], v2, s[40:43], s64 offen offset:1024 sc1
  v_accvgpr_read_b32 v243, a43
  v_mfma_f32_16x16x32_bf16 v[100:103], v[64:67], a[212:215], v[100:103]
  ds_read_b64_tr_b16 v[44:45], v13 offset:33024
  v_cvt_pk_bf16_f32 v232, v236, v237
  v_mfma_f32_16x16x32_bf16 v[116:119], v[68:71], a[212:215], v[116:119]
  ds_read_b64_tr_b16 v[46:47], v13 offset:34048
  v_cvt_pk_bf16_f32 v233, v238, v239
  v_mfma_f32_16x16x32_bf16 v[132:135], v[72:75], a[212:215], v[132:135]
  s_add_u32 m0, s24, 16384
  ds_read_b64_tr_b16 v[48:49], v12 offset:33280
  v_cvt_pk_bf16_f32 v234, v240, v241
  v_mfma_f32_16x16x32_bf16 v[148:151], v[76:79], a[212:215], v[148:151]
  buffer_load_dwordx4 v8, s[36:39], s27 offen offset:0 lds
  v_cvt_pk_bf16_f32 v235, v242, v243
  v_mfma_f32_16x16x32_bf16 v[164:167], v[80:83], a[212:215], v[164:167]
  ds_read_b64_tr_b16 v[50:51], v12 offset:34304
  v_mfma_f32_16x16x32_bf16 v[180:183], v[84:87], a[212:215], v[180:183]
  s_add_u32 s63, s63, s61
  ds_read_b64_tr_b16 v[52:53], v13 offset:33280
  v_mfma_f32_16x16x32_bf16 v[196:199], v[88:91], a[212:215], v[196:199]
  ds_read_b64_tr_b16 v[54:55], v13 offset:34304
  v_mfma_f32_16x16x32_bf16 v[212:215], v[92:95], a[212:215], v[212:215]
  buffer_load_dwordx4 a[212:215], v2, s[40:43], s65 offen offset:1024 sc1
  v_mfma_f32_16x16x32_bf16 v[104:107], v[64:67], a[216:219], v[104:107]
  ds_read_b64_tr_b16 v[56:57], v12 offset:33536
  v_accvgpr_read_b32 v248, a12
  v_mfma_f32_16x16x32_bf16 v[120:123], v[68:71], a[216:219], v[120:123]
  ds_read_b64_tr_b16 v[58:59], v12 offset:34560
  v_accvgpr_read_b32 v249, a13
  v_mfma_f32_16x16x32_bf16 v[136:139], v[72:75], a[216:219], v[136:139]
  ds_read_b64_tr_b16 v[60:61], v13 offset:33536
  v_accvgpr_read_b32 v250, a14
  v_mfma_f32_16x16x32_bf16 v[152:155], v[76:79], a[216:219], v[152:155]
  buffer_load_dwordx4 v9, s[36:39], s27 offen offset:1024 lds
  v_accvgpr_read_b32 v251, a15
  v_mfma_f32_16x16x32_bf16 v[168:171], v[80:83], a[216:219], v[168:171]
  ds_read_b64_tr_b16 v[62:63], v13 offset:34560
  v_accvgpr_read_b32 v252, a44
  v_mfma_f32_16x16x32_bf16 v[184:187], v[84:87], a[216:219], v[184:187]
  buffer_store_dwordx4 v[232:235], v2, s[40:43], s63 offen offset:0 sc1
  v_accvgpr_read_b32 v253, a45
  v_mfma_f32_16x16x32_bf16 v[200:203], v[88:91], a[216:219], v[200:203]
  buffer_load_dwordx4 v10, s[36:39], s27 offen offset:2048 lds
  v_accvgpr_read_b32 v254, a46
  v_mfma_f32_16x16x32_bf16 v[216:219], v[92:95], a[216:219], v[216:219]
  buffer_load_dwordx4 a[216:219], v2, s[40:43], s66 offen offset:1024 sc1
  v_accvgpr_read_b32 v255, a47
  v_mfma_f32_16x16x32_bf16 v[108:111], v[64:67], a[220:223], v[108:111]
  v_cvt_pk_bf16_f32 v244, v248, v249
  v_mfma_f32_16x16x32_bf16 v[124:127], v[68:71], a[220:223], v[124:127]
  buffer_load_dwordx4 v11, s[36:39], s27 offen offset:3072 lds
  v_cvt_pk_bf16_f32 v245, v250, v251
  v_mfma_f32_16x16x32_bf16 v[140:143], v[72:75], a[220:223], v[140:143]
  s_add_u32 s27, s27, 524288
  v_cvt_pk_bf16_f32 v246, v252, v253
  v_mfma_f32_16x16x32_bf16 v[156:159], v[76:79], a[220:223], v[156:159]
  s_add_u32 s24, s24, 32768
  v_cvt_pk_bf16_f32 v247, v254, v255
  v_mfma_f32_16x16x32_bf16 v[172:175], v[80:83], a[220:223], v[172:175]
  s_and_b32 s24, s24, 0x1ffff
  v_mfma_f32_16x16x32_bf16 v[188:191], v[84:87], a[220:223], v[188:191]
  buffer_store_dwordx4 v[244:247], v2, s[40:43], s63 offen offset:1024 sc1
  v_mfma_f32_16x16x32_bf16 v[204:207], v[88:91], a[220:223], v[204:207]
  v_mfma_f32_16x16x32_bf16 v[220:223], v[92:95], a[220:223], v[220:223]
  s_waitcnt vmcnt(27) lgkmcnt(0)
  buffer_load_dwordx4 a[220:223], v2, s[40:43], s67 offen offset:1024 sc1
  v_mfma_f32_16x16x32_bf16 v[96:99], v[32:35], a[224:227], v[96:99]
  v_accvgpr_read_b32 v236, a16
  v_mfma_f32_16x16x32_bf16 v[112:115], v[36:39], a[224:227], v[112:115]
  ds_read_b64_tr_b16 v[64:65], v12 offset:40960
  v_accvgpr_read_b32 v237, a17
  v_mfma_f32_16x16x32_bf16 v[128:131], v[40:43], a[224:227], v[128:131]
  ds_read_b64_tr_b16 v[66:67], v12 offset:41984
  v_accvgpr_read_b32 v238, a18
  v_mfma_f32_16x16x32_bf16 v[144:147], v[44:47], a[224:227], v[144:147]
  ds_read_b64_tr_b16 v[68:69], v13 offset:40960
  v_accvgpr_read_b32 v239, a19
  v_mfma_f32_16x16x32_bf16 v[160:163], v[48:51], a[224:227], v[160:163]
  ds_read_b64_tr_b16 v[70:71], v13 offset:41984
  v_accvgpr_read_b32 v240, a48
  v_mfma_f32_16x16x32_bf16 v[176:179], v[52:55], a[224:227], v[176:179]
  ds_read_b64_tr_b16 v[72:73], v12 offset:41216
  v_accvgpr_read_b32 v241, a49
  v_mfma_f32_16x16x32_bf16 v[192:195], v[56:59], a[224:227], v[192:195]
  ds_read_b64_tr_b16 v[74:75], v12 offset:42240
  v_accvgpr_read_b32 v242, a50
  v_mfma_f32_16x16x32_bf16 v[208:211], v[60:63], a[224:227], v[208:211]
  buffer_load_dwordx4 a[224:227], v2, s[40:43], s64 offen offset:2048 sc1
  v_accvgpr_read_b32 v243, a51
  v_mfma_f32_16x16x32_bf16 v[100:103], v[32:35], a[228:231], v[100:103]
  ds_read_b64_tr_b16 v[76:77], v13 offset:41216
  v_cvt_pk_bf16_f32 v232, v236, v237
  v_mfma_f32_16x16x32_bf16 v[116:119], v[36:39], a[228:231], v[116:119]
  ds_read_b64_tr_b16 v[78:79], v13 offset:42240
  v_cvt_pk_bf16_f32 v233, v238, v239
  v_mfma_f32_16x16x32_bf16 v[132:135], v[40:43], a[228:231], v[132:135]
  ds_read_b64_tr_b16 v[80:81], v12 offset:41472
  v_cvt_pk_bf16_f32 v234, v240, v241
  v_mfma_f32_16x16x32_bf16 v[148:151], v[44:47], a[228:231], v[148:151]
  v_cvt_pk_bf16_f32 v235, v242, v243
  v_mfma_f32_16x16x32_bf16 v[164:167], v[48:51], a[228:231], v[164:167]
  ds_read_b64_tr_b16 v[82:83], v12 offset:42496
  v_mfma_f32_16x16x32_bf16 v[180:183], v[52:55], a[228:231], v[180:183]
  s_add_u32 s63, s63, s61
  ds_read_b64_tr_b16 v[84:85], v13 offset:41472
  v_mfma_f32_16x16x32_bf16 v[196:199], v[56:59], a[228:231], v[196:199]
  ds_read_b64_tr_b16 v[86:87], v13 offset:42496
  v_mfma_f32_16x16x32_bf16 v[212:215], v[60:63], a[228:231], v[212:215]
  buffer_load_dwordx4 a[228:231], v2, s[40:43], s65 offen offset:2048 sc1
  v_mfma_f32_16x16x32_bf16 v[104:107], v[32:35], a[232:235], v[104:107]
  ds_read_b64_tr_b16 v[88:89], v12 offset:41728
  v_accvgpr_read_b32 v248, a20
  v_mfma_f32_16x16x32_bf16 v[120:123], v[36:39], a[232:235], v[120:123]
  ds_read_b64_tr_b16 v[90:91], v12 offset:42752
  v_accvgpr_read_b32 v249, a21
  v_mfma_f32_16x16x32_bf16 v[136:139], v[40:43], a[232:235], v[136:139]
  ds_read_b64_tr_b16 v[92:93], v13 offset:41728
  v_accvgpr_read_b32 v250, a22
  v_mfma_f32_16x16x32_bf16 v[152:155], v[44:47], a[232:235], v[152:155]
  v_accvgpr_read_b32 v251, a23
  v_mfma_f32_16x16x32_bf16 v[168:171], v[48:51], a[232:235], v[168:171]
  ds_read_b64_tr_b16 v[94:95], v13 offset:42752
  v_accvgpr_read_b32 v252, a52
  v_mfma_f32_16x16x32_bf16 v[184:187], v[52:55], a[232:235], v[184:187]
  buffer_store_dwordx4 v[232:235], v2, s[40:43], s63 offen offset:0 sc1
  v_accvgpr_read_b32 v253, a53
  v_mfma_f32_16x16x32_bf16 v[200:203], v[56:59], a[232:235], v[200:203]
  v_accvgpr_read_b32 v254, a54
  v_mfma_f32_16x16x32_bf16 v[216:219], v[60:63], a[232:235], v[216:219]
  buffer_load_dwordx4 a[232:235], v2, s[40:43], s66 offen offset:2048 sc1
  v_accvgpr_read_b32 v255, a55
  v_mfma_f32_16x16x32_bf16 v[108:111], v[32:35], a[236:239], v[108:111]
  v_xor_b32 v12, 0x10000, v12
  v_cvt_pk_bf16_f32 v244, v248, v249
  v_mfma_f32_16x16x32_bf16 v[124:127], v[36:39], a[236:239], v[124:127]
  v_cvt_pk_bf16_f32 v245, v250, v251
  v_mfma_f32_16x16x32_bf16 v[140:143], v[40:43], a[236:239], v[140:143]
  v_xor_b32 v13, 0x10000, v13
  v_cvt_pk_bf16_f32 v246, v252, v253
  v_mfma_f32_16x16x32_bf16 v[156:159], v[44:47], a[236:239], v[156:159]
  v_cvt_pk_bf16_f32 v247, v254, v255
  v_mfma_f32_16x16x32_bf16 v[172:175], v[48:51], a[236:239], v[172:175]
  v_mfma_f32_16x16x32_bf16 v[188:191], v[52:55], a[236:239], v[188:191]
  buffer_store_dwordx4 v[244:247], v2, s[40:43], s63 offen offset:1024 sc1
  v_mfma_f32_16x16x32_bf16 v[204:207], v[56:59], a[236:239], v[204:207]
  v_mfma_f32_16x16x32_bf16 v[220:223], v[60:63], a[236:239], v[220:223]
  s_waitcnt vmcnt(29) lgkmcnt(0)
  buffer_load_dwordx4 a[236:239], v2, s[40:43], s67 offen offset:2048 sc1
  v_mfma_f32_16x16x32_bf16 v[96:99], v[64:67], a[240:243], v[96:99]
  s_barrier
  v_accvgpr_read_b32 v236, a24
  v_mfma_f32_16x16x32_bf16 v[112:115], v[68:71], a[240:243], v[112:115]
  ds_read_b64_tr_b16 v[32:33], v12 offset:0
  v_accvgpr_read_b32 v237, a25
  v_mfma_f32_16x16x32_bf16 v[128:131], v[72:75], a[240:243], v[128:131]
  ds_read_b64_tr_b16 v[34:35], v12 offset:1024
  v_accvgpr_read_b32 v238, a26
  v_mfma_f32_16x16x32_bf16 v[144:147], v[76:79], a[240:243], v[144:147]
  ds_read_b64_tr_b16 v[36:37], v13 offset:0
  v_accvgpr_read_b32 v239, a27
  v_mfma_f32_16x16x32_bf16 v[160:163], v[80:83], a[240:243], v[160:163]
  ds_read_b64_tr_b16 v[38:39], v13 offset:1024
  v_accvgpr_read_b32 v240, a56
  v_mfma_f32_16x16x32_bf16 v[176:179], v[84:87], a[240:243], v[176:179]
  ds_read_b64_tr_b16 v[40:41], v12 offset:256
  v_accvgpr_read_b32 v241, a57
  v_mfma_f32_16x16x32_bf16 v[192:195], v[88:91], a[240:243], v[192:195]
  ds_read_b64_tr_b16 v[42:43], v12 offset:1280
  v_accvgpr_read_b32 v242, a58
  v_mfma_f32_16x16x32_bf16 v[208:211], v[92:95], a[240:243], v[208:211]
  buffer_load_dwordx4 a[240:243], v2, s[40:43], s64 offen offset:3072 sc1
  v_accvgpr_read_b32 v243, a59
  v_mfma_f32_16x16x32_bf16 v[100:103], v[64:67], a[244:247], v[100:103]
  s_add_u32 s64, s64, 4096
  ds_read_b64_tr_b16 v[44:45], v13 offset:256
  v_cvt_pk_bf16_f32 v232, v236, v237
  v_mfma_f32_16x16x32_bf16 v[116:119], v[68:71], a[244:247], v[116:119]
  ds_read_b64_tr_b16 v[46:47], v13 offset:1280
  v_cvt_pk_bf16_f32 v233, v238, v239
  v_mfma_f32_16x16x32_bf16 v[132:135], v[72:75], a[244:247], v[132:135]
  s_add_u32 m0, s24, 16384
  ds_read_b64_tr_b16 v[48:49], v12 offset:512
  v_cvt_pk_bf16_f32 v234, v240, v241
  v_mfma_f32_16x16x32_bf16 v[148:151], v[76:79], a[244:247], v[148:151]
  buffer_load_dwordx4 v8, s[36:39], s27 offen offset:0 lds
  v_cvt_pk_bf16_f32 v235, v242, v243
  v_mfma_f32_16x16x32_bf16 v[164:167], v[80:83], a[244:247], v[164:167]
  ds_read_b64_tr_b16 v[50:51], v12 offset:1536
  v_mfma_f32_16x16x32_bf16 v[180:183], v[84:87], a[244:247], v[180:183]
  s_add_u32 s63, s63, s61
  ds_read_b64_tr_b16 v[52:53], v13 offset:512
  v_mfma_f32_16x16x32_bf16 v[196:199], v[88:91], a[244:247], v[196:199]
  ds_read_b64_tr_b16 v[54:55], v13 offset:1536
  v_mfma_f32_16x16x32_bf16 v[212:215], v[92:95], a[244:247], v[212:215]
  buffer_load_dwordx4 a[244:247], v2, s[40:43], s65 offen offset:3072 sc1
  v_mfma_f32_16x16x32_bf16 v[104:107], v[64:67], a[248:251], v[104:107]
  s_add_u32 s65, s65, 4096
  ds_read_b64_tr_b16 v[56:57], v12 offset:768
  v_accvgpr_read_b32 v248, a28
  v_mfma_f32_16x16x32_bf16 v[120:123], v[68:71], a[248:251], v[120:123]
  ds_read_b64_tr_b16 v[58:59], v12 offset:1792
  v_accvgpr_read_b32 v249, a29
  v_mfma_f32_16x16x32_bf16 v[136:139], v[72:75], a[248:251], v[136:139]
  ds_read_b64_tr_b16 v[60:61], v13 offset:768
  v_accvgpr_read_b32 v250, a30
  v_mfma_f32_16x16x32_bf16 v[152:155], v[76:79], a[248:251], v[152:155]
  buffer_load_dwordx4 v9, s[36:39], s27 offen offset:1024 lds
  v_accvgpr_read_b32 v251, a31
  v_mfma_f32_16x16x32_bf16 v[168:171], v[80:83], a[248:251], v[168:171]
  ds_read_b64_tr_b16 v[62:63], v13 offset:1792
  v_accvgpr_read_b32 v252, a60
  v_mfma_f32_16x16x32_bf16 v[184:187], v[84:87], a[248:251], v[184:187]
  buffer_store_dwordx4 v[232:235], v2, s[40:43], s63 offen offset:0 sc1
  v_accvgpr_read_b32 v253, a61
  v_mfma_f32_16x16x32_bf16 v[200:203], v[88:91], a[248:251], v[200:203]
  buffer_load_dwordx4 v10, s[36:39], s27 offen offset:2048 lds
  v_accvgpr_read_b32 v254, a62
  v_mfma_f32_16x16x32_bf16 v[216:219], v[92:95], a[248:251], v[216:219]
  buffer_load_dwordx4 a[248:251], v2, s[40:43], s66 offen offset:3072 sc1
  v_accvgpr_read_b32 v255, a63
  v_mfma_f32_16x16x32_bf16 v[108:111], v[64:67], a[252:255], v[108:111]
  s_add_u32 s66, s66, 4096
  v_cvt_pk_bf16_f32 v244, v248, v249
  v_mfma_f32_16x16x32_bf16 v[124:127], v[68:71], a[252:255], v[124:127]
  buffer_load_dwordx4 v11, s[36:39], s27 offen offset:3072 lds
  v_cvt_pk_bf16_f32 v245, v250, v251
  v_mfma_f32_16x16x32_bf16 v[140:143], v[72:75], a[252:255], v[140:143]
  s_add_u32 s27, s27, 524288
  v_cvt_pk_bf16_f32 v246, v252, v253
  v_mfma_f32_16x16x32_bf16 v[156:159], v[76:79], a[252:255], v[156:159]
  s_add_u32 s24, s24, 32768
  v_cvt_pk_bf16_f32 v247, v254, v255
  v_mfma_f32_16x16x32_bf16 v[172:175], v[80:83], a[252:255], v[172:175]
  s_and_b32 s24, s24, 0x1ffff
  v_mfma_f32_16x16x32_bf16 v[188:191], v[84:87], a[252:255], v[188:191]
  buffer_store_dwordx4 v[244:247], v2, s[40:43], s63 offen offset:1024 sc1
  v_mfma_f32_16x16x32_bf16 v[204:207], v[88:91], a[252:255], v[204:207]
  v_mfma_f32_16x16x32_bf16 v[220:223], v[92:95], a[252:255], v[220:223]
  s_waitcnt vmcnt(25) lgkmcnt(0)
  buffer_load_dwordx4 a[252:255], v2, s[40:43], s67 offen offset:3072 sc1
  v_mfma_f32_16x16x32_bf16 v[96:99], v[32:35], a[192:195], v[96:99]
  v_accvgpr_read_b32 v236, a64
  v_mfma_f32_16x16x32_bf16 v[112:115], v[36:39], a[192:195], v[112:115]
  s_add_u32 s67, s67, 4096
  ds_read_b64_tr_b16 v[64:65], v12 offset:8192
  v_accvgpr_read_b32 v237, a65
  v_mfma_f32_16x16x32_bf16 v[128:131], v[40:43], a[192:195], v[128:131]
  ds_read_b64_tr_b16 v[66:67], v12 offset:9216
  v_accvgpr_read_b32 v238, a66
  v_mfma_f32_16x16x32_bf16 v[144:147], v[44:47], a[192:195], v[144:147]
  ds_read_b64_tr_b16 v[68:69], v13 offset:8192
  v_accvgpr_read_b32 v239, a67
  v_mfma_f32_16x16x32_bf16 v[160:163], v[48:51], a[192:195], v[160:163]
  ds_read_b64_tr_b16 v[70:71], v13 offset:9216
  v_accvgpr_read_b32 v240, a96
  v_mfma_f32_16x16x32_bf16 v[176:179], v[52:55], a[192:195], v[176:179]
  ds_read_b64_tr_b16 v[72:73], v12 offset:8448
  v_accvgpr_read_b32 v241, a97
  v_mfma_f32_16x16x32_bf16 v[192:195], v[56:59], a[192:195], v[192:195]
  ds_read_b64_tr_b16 v[74:75], v12 offset:9472
  v_accvgpr_read_b32 v242, a98
  v_mfma_f32_16x16x32_bf16 v[208:211], v[60:63], a[192:195], v[208:211]
  buffer_load_dwordx4 a[192:195], v2, s[40:43], s64 offen offset:0 sc1
  v_accvgpr_read_b32 v243, a99
  v_mfma_f32_16x16x32_bf16 v[100:103], v[32:35], a[196:199], v[100:103]
  ds_read_b64_tr_b16 v[76:77], v13 offset:8448
  v_cvt_pk_bf16_f32 v232, v236, v237
  v_mfma_f32_16x16x32_bf16 v[116:119], v[36:39], a[196:199], v[116:119]
  ds_read_b64_tr_b16 v[78:79], v13 offset:9472
  v_cvt_pk_bf16_f32 v233, v238, v239
  v_mfma_f32_16x16x32_bf16 v[132:135], v[40:43], a[196:199], v[132:135]
  ds_read_b64_tr_b16 v[80:81], v12 offset:8704
  v_cvt_pk_bf16_f32 v234, v240, v241
  v_mfma_f32_16x16x32_bf16 v[148:151], v[44:47], a[196:199], v[148:151]
  v_cvt_pk_bf16_f32 v235, v242, v243
  v_mfma_f32_16x16x32_bf16 v[164:167], v[48:51], a[196:199], v[164:167]
  ds_read_b64_tr_b16 v[82:83], v12 offset:9728
  v_mfma_f32_16x16x32_bf16 v[180:183], v[52:55], a[196:199], v[180:183]
  s_mul_i32 s63, s60, 1
  ds_read_b64_tr_b16 v[84:85], v13 offset:8704
  v_mfma_f32_16x16x32_bf16 v[196:199], v[56:59], a[196:199], v[196:199]
  s_add_u32 s63, s63, s62
  ds_read_b64_tr_b16 v[86:87], v13 offset:9728
  v_mfma_f32_16x16x32_bf16 v[212:215], v[60:63], a[196:199], v[212:215]
  buffer_load_dwordx4 a[196:199], v2, s[40:43], s65 offen offset:0 sc1
  v_mfma_f32_16x16x32_bf16 v[104:107], v[32:35], a[200:203], v[104:107]
  ds_read_b64_tr_b16 v[88:89], v12 offset:8960
  v_accvgpr_read_b32 v248, a68
  v_mfma_f32_16x16x32_bf16 v[120:123], v[36:39], a[200:203], v[120:123]
  ds_read_b64_tr_b16 v[90:91], v12 offset:9984
  v_accvgpr_read_b32 v249, a69
  v_mfma_f32_16x16x32_bf16 v[136:139], v[40:43], a[200:203], v[136:139]
  ds_read_b64_tr_b16 v[92:93], v13 offset:8960
  v_accvgpr_read_b32 v250, a70
  v_mfma_f32_16x16x32_bf16 v[152:155], v[44:47], a[200:203], v[152:155]
  v_accvgpr_read_b32 v251, a71
  v_mfma_f32_16x16x32_bf16 v[168:171], v[48:51], a[200:203], v[168:171]
  ds_read_b64_tr_b16 v[94:95], v13 offset:9984
  v_accvgpr_read_b32 v252, a100
  v_mfma_f32_16x16x32_bf16 v[184:187], v[52:55], a[200:203], v[184:187]
  buffer_store_dwordx4 v[232:235], v2, s[40:43], s63 offen offset:0 sc1
  v_accvgpr_read_b32 v253, a101
  v_mfma_f32_16x16x32_bf16 v[200:203], v[56:59], a[200:203], v[200:203]
  v_accvgpr_read_b32 v254, a102
  v_mfma_f32_16x16x32_bf16 v[216:219], v[60:63], a[200:203], v[216:219]
  buffer_load_dwordx4 a[200:203], v2, s[40:43], s66 offen offset:0 sc1
  v_accvgpr_read_b32 v255, a103
  v_mfma_f32_16x16x32_bf16 v[108:111], v[32:35], a[204:207], v[108:111]
  v_cvt_pk_bf16_f32 v244, v248, v249
  v_mfma_f32_16x16x32_bf16 v[124:127], v[36:39], a[204:207], v[124:127]
  v_cvt_pk_bf16_f32 v245, v250, v251
  v_mfma_f32_16x16x32_bf16 v[140:143], v[40:43], a[204:207], v[140:143]
  v_cvt_pk_bf16_f32 v246, v252, v253
  v_mfma_f32_16x16x32_bf16 v[156:159], v[44:47], a[204:207], v[156:159]
  v_cvt_pk_bf16_f32 v247, v254, v255
  v_mfma_f32_16x16x32_bf16 v[172:175], v[48:51], a[204:207], v[172:175]
  v_mfma_f32_16x16x32_bf16 v[188:191], v[52:55], a[204:207], v[188:191]
  buffer_store_dwordx4 v[244:247], v2, s[40:43], s63 offen offset:1024 sc1
  v_mfma_f32_16x16x32_bf16 v[204:207], v[56:59], a[204:207], v[204:207]
  v_mfma_f32_16x16x32_bf16 v[220:223], v[60:63], a[204:207], v[220:223]
  s_waitcnt vmcnt(21) lgkmcnt(0)
  buffer_load_dwordx4 a[204:207], v2, s[40:43], s67 offen offset:0 sc1
  v_mfma_f32_16x16x32_bf16 v[96:99], v[64:67], a[208:211], v[96:99]
  s_barrier
  v_accvgpr_read_b32 v236, a72
  v_mfma_f32_16x16x32_bf16 v[112:115], v[68:71], a[208:211], v[112:115]
  ds_read_b64_tr_b16 v[32:33], v12 offset:32768
  v_accvgpr_read_b32 v237, a73
  v_mfma_f32_16x16x32_bf16 v[128:131], v[72:75], a[208:211], v[128:131]
  ds_read_b64_tr_b16 v[34:35], v12 offset:33792
  v_accvgpr_read_b32 v238, a74
  v_mfma_f32_16x16x32_bf16 v[144:147], v[76:79], a[208:211], v[144:147]
  ds_read_b64_tr_b16 v[36:37], v13 offset:32768
  v_accvgpr_read_b32 v239, a75
  v_mfma_f32_16x16x32_bf16 v[160:163], v[80:83], a[208:211], v[160:163]
  ds_read_b64_tr_b16 v[38:39], v13 offset:33792
  v_accvgpr_read_b32 v240, a104
  v_mfma_f32_16x16x32_bf16 v[176:179], v[84:87], a[208:211], v[176:179]
  ds_read_b64_tr_b16 v[40:41], v12 offset:33024
  v_accvgpr_read_b32 v241, a105
  v_mfma_f32_16x16x32_bf16 v[192:195], v[88:91], a[208:211], v[192:195]
  ds_read_b64_tr_b16 v[42:43], v12 offset:34048
  v_accvgpr_read_b32 v242, a106
  v_mfma_f32_16x16x32_bf16 v[208:211], v[92:95], a[208:211], v[208:211]
  buffer_load_dwordx4 a[208:211], v2, s[40:43], s64 offen offset:1024 sc1
  v_accvgpr_read_b32 v243, a107
  v_mfma_f32_16x16x32_bf16 v[100:103], v[64:67], a[212:215], v[100:103]
  ds_read_b64_tr_b16 v[44:45], v13 offset:33024
  v_cvt_pk_bf16_f32 v232, v236, v237
  v_mfma_f32_16x16x32_bf16 v[116:119], v[68:71], a[212:215], v[116:119]
  ds_read_b64_tr_b16 v[46:47], v13 offset:34048
  v_cvt_pk_bf16_f32 v233, v238, v239
  v_mfma_f32_16x16x32_bf16 v[132:135], v[72:75], a[212:215], v[132:135]
  s_add_u32 m0, s24, 16384
  ds_read_b64_tr_b16 v[48:49], v12 offset:33280
  v_cvt_pk_bf16_f32 v234, v240, v241
  v_mfma_f32_16x16x32_bf16 v[148:151], v[76:79], a[212:215], v[148:151]
  buffer_load_dwordx4 v8, s[36:39], s27 offen offset:0 lds
  v_cvt_pk_bf16_f32 v235, v242, v243
  v_mfma_f32_16x16x32_bf16 v[164:167], v[80:83], a[212:215], v[164:167]
  ds_read_b64_tr_b16 v[50:51], v12 offset:34304
  v_mfma_f32_16x16x32_bf16 v[180:183], v[84:87], a[212:215], v[180:183]
  s_add_u32 s63, s63, s61
  ds_read_b64_tr_b16 v[52:53], v13 offset:33280
  v_mfma_f32_16x16x32_bf16 v[196:199], v[88:91], a[212:215], v[196:199]
  ds_read_b64_tr_b16 v[54:55], v13 offset:34304
  v_mfma_f32_16x16x32_bf16 v[212:215], v[92:95], a[212:215], v[212:215]
  buffer_load_dwordx4 a[212:215], v2, s[40:43], s65 offen offset:1024 sc1
  v_mfma_f32_16x16x32_bf16 v[104:107], v[64:67], a[216:219], v[104:107]
  ds_read_b64_tr_b16 v[56:57], v12 offset:33536
  v_accvgpr_read_b32 v248, a76
  v_mfma_f32_16x16x32_bf16 v[120:123], v[68:71], a[216:219], v[120:123]
  ds_read_b64_tr_b16 v[58:59], v12 offset:34560
  v_accvgpr_read_b32 v249, a77
  v_mfma_f32_16x16x32_bf16 v[136:139], v[72:75], a[216:219], v[136:139]
  ds_read_b64_tr_b16 v[60:61], v13 offset:33536
  v_accvgpr_read_b32 v250, a78
  v_mfma_f32_16x16x32_bf16 v[152:155], v[76:79], a[216:219], v[152:155]
  buffer_load_dwordx4 v9, s[36:39], s27 offen offset:1024 lds
  v_accvgpr_read_b32 v251, a79
  v_mfma_f32_16x16x32_bf16 v[168:171], v[80:83], a[216:219], v[168:171]
  ds_read_b64_tr_b16 v[62:63], v13 offset:34560
  v_accvgpr_read_b32 v252, a108
  v_mfma_f32_16x16x32_bf16 v[184:187], v[84:87], a[216:219], v[184:187]
  buffer_store_dwordx4 v[232:235], v2, s[40:43], s63 offen offset:0 sc1
  v_accvgpr_read_b32 v253, a109
  v_mfma_f32_16x16x32_bf16 v[200:203], v[88:91], a[216:219], v[200:203]
  buffer_load_dwordx4 v10, s[36:39], s27 offen offset:2048 lds
  v_accvgpr_read_b32 v254, a110
  v_mfma_f32_16x16x32_bf16 v[216:219], v[92:95], a[216:219], v[216:219]
  buffer_load_dwordx4 a[216:219], v2, s[40:43], s66 offen offset:1024 sc1
  v_accvgpr_read_b32 v255, a111
  v_mfma_f32_16x16x32_bf16 v[108:111], v[64:67], a[220:223], v[108:111]
  v_cvt_pk_bf16_f32 v244, v248, v249
  v_mfma_f32_16x16x32_bf16 v[124:127], v[68:71], a[220:223], v[124:127]
  buffer_load_dwordx4 v11, s[36:39], s27 offen offset:3072 lds
  v_cvt_pk_bf16_f32 v245, v250, v251
  v_mfma_f32_16x16x32_bf16 v[140:143], v[72:75], a[220:223], v[140:143]
  s_add_u32 s27, s27, 524288
  v_cvt_pk_bf16_f32 v246, v252, v253
  v_mfma_f32_16x16x32_bf16 v[156:159], v[76:79], a[220:223], v[156:159]
  s_add_u32 s24, s24, 32768
  v_cvt_pk_bf16_f32 v247, v254, v255
  v_mfma_f32_16x16x32_bf16 v[172:175], v[80:83], a[220:223], v[172:175]
  s_and_b32 s24, s24, 0x1ffff
  v_mfma_f32_16x16x32_bf16 v[188:191], v[84:87], a[220:223], v[188:191]
  buffer_store_dwordx4 v[244:247], v2, s[40:43], s63 offen offset:1024 sc1
  v_mfma_f32_16x16x32_bf16 v[204:207], v[88:91], a[220:223], v[204:207]
  v_mfma_f32_16x16x32_bf16 v[220:223], v[92:95], a[220:223], v[220:223]
  s_waitcnt vmcnt(25) lgkmcnt(0)
  buffer_load_dwordx4 a[220:223], v2, s[40:43], s67 offen offset:1024 sc1
  v_mfma_f32_16x16x32_bf16 v[96:99], v[32:35], a[224:227], v[96:99]
  v_accvgpr_read_b32 v236, a80
  v_mfma_f32_16x16x32_bf16 v[112:115], v[36:39], a[224:227], v[112:115]
  ds_read_b64_tr_b16 v[64:65], v12 offset:40960
  v_accvgpr_read_b32 v237, a81
  v_mfma_f32_16x16x32_bf16 v[128:131], v[40:43], a[224:227], v[128:131]
  ds_read_b64_tr_b16 v[66:67], v12 offset:41984
  v_accvgpr_read_b32 v238, a82
  v_mfma_f32_16x16x32_bf16 v[144:147], v[44:47], a[224:227], v[144:147]
  ds_read_b64_tr_b16 v[68:69], v13 offset:40960
  v_accvgpr_read_b32 v239, a83
  v_mfma_f32_16x16x32_bf16 v[160:163], v[48:51], a[224:227], v[160:163]
  ds_read_b64_tr_b16 v[70:71], v13 offset:41984
  v_accvgpr_read_b32 v240, a112
  v_mfma_f32_16x16x32_bf16 v[176:179], v[52:55], a[224:227], v[176:179]
  ds_read_b64_tr_b16 v[72:73], v12 offset:41216
  v_accvgpr_read_b32 v241, a113
  v_mfma_f32_16x16x32_bf16 v[192:195], v[56:59], a[224:227], v[192:195]
  ds_read_b64_tr_b16 v[74:75], v12 offset:42240
  v_accvgpr_read_b32 v242, a114
  v_mfma_f32_16x16x32_bf16 v[208:211], v[60:63], a[224:227], v[208:211]
  buffer_load_dwordx4 a[224:227], v2, s[40:43], s64 offen offset:2048 sc1
  v_accvgpr_read_b32 v243, a115
  v_mfma_f32_16x16x32_bf16 v[100:103], v[32:35], a[228:231], v[100:103]
  ds_read_b64_tr_b16 v[76:77], v13 offset:41216
  v_cvt_pk_bf16_f32 v232, v236, v237
  v_mfma_f32_16x16x32_bf16 v[116:119], v[36:39], a[228:231], v[116:119]
  ds_read_b64_tr_b16 v[78:79], v13 offset:42240
  v_cvt_pk_bf16_f32 v233, v238, v239
  v_mfma_f32_16x16x32_bf16 v[132:135], v[40:43], a[228:231], v[132:135]
  ds_read_b64_tr_b16 v[80:81], v12 offset:41472
  v_cvt_pk_bf16_f32 v234, v240, v241
  v_mfma_f32_16x16x32_bf16 v[148:151], v[44:47], a[228:231], v[148:151]
  v_cvt_pk_bf16_f32 v235, v242, v243
  v_mfma_f32_16x16x32_bf16 v[164:167], v[48:51], a[228:231], v[164:167]
  ds_read_b64_tr_b16 v[82:83], v12 offset:42496
  v_mfma_f32_16x16x32_bf16 v[180:183], v[52:55], a[228:231], v[180:183]
  s_add_u32 s63, s63, s61
  ds_read_b64_tr_b16 v[84:85], v13 offset:41472
  v_mfma_f32_16x16x32_bf16 v[196:199], v[56:59], a[228:231], v[196:199]
  ds_read_b64_tr_b16 v[86:87], v13 offset:42496
  v_mfma_f32_16x16x32_bf16 v[212:215], v[60:63], a[228:231], v[212:215]
  buffer_load_dwordx4 a[228:231], v2, s[40:43], s65 offen offset:2048 sc1
  v_mfma_f32_16x16x32_bf16 v[104:107], v[32:35], a[232:235], v[104:107]
  ds_read_b64_tr_b16 v[88:89], v12 offset:41728
  v_accvgpr_read_b32 v248, a84
  v_mfma_f32_16x16x32_bf16 v[120:123], v[36:39], a[232:235], v[120:123]
  ds_read_b64_tr_b16 v[90:91], v12 offset:42752
  v_accvgpr_read_b32 v249, a85
  v_mfma_f32_16x16x32_bf16 v[136:139], v[40:43], a[232:235], v[136:139]
  ds_read_b64_tr_b16 v[92:93], v13 offset:41728
  v_accvgpr_read_b32 v250, a86
  v_mfma_f32_16x16x32_bf16 v[152:155], v[44:47], a[232:235], v[152:155]
  v_accvgpr_read_b32 v251, a87
  v_mfma_f32_16x16x32_bf16 v[168:171], v[48:51], a[232:235], v[168:171]
  ds_read_b64_tr_b16 v[94:95], v13 offset:42752
  v_accvgpr_read_b32 v252, a116
  v_mfma_f32_16x16x32_bf16 v[184:187], v[52:55], a[232:235], v[184:187]
  buffer_store_dwordx4 v[232:235], v2, s[40:43], s63 offen offset:0 sc1
  v_accvgpr_read_b32 v253, a117
  v_mfma_f32_16x16x32_bf16 v[200:203], v[56:59], a[232:235], v[200:203]
  v_accvgpr_read_b32 v254, a118
  v_mfma_f32_16x16x32_bf16 v[216:219], v[60:63], a[232:235], v[216:219]
  buffer_load_dwordx4 a[232:235], v2, s[40:43], s66 offen offset:2048 sc1
  v_accvgpr_read_b32 v255, a119
  v_mfma_f32_16x16x32_bf16 v[108:111], v[32:35], a[236:239], v[108:111]
  v_xor_b32 v12, 0x10000, v12
  v_cvt_pk_bf16_f32 v244, v248, v249
  v_mfma_f32_16x16x32_bf16 v[124:127], v[36:39], a[236:239], v[124:127]
  v_cvt_pk_bf16_f32 v245, v250, v251
  v_mfma_f32_16x16x32_bf16 v[140:143], v[40:43], a[236:239], v[140:143]
  v_xor_b32 v13, 0x10000, v13
  v_cvt_pk_bf16_f32 v246, v252, v253
  v_mfma_f32_16x16x32_bf16 v[156:159], v[44:47], a[236:239], v[156:159]
  v_cvt_pk_bf16_f32 v247, v254, v255
  v_mfma_f32_16x16x32_bf16 v[172:175], v[48:51], a[236:239], v[172:175]
  v_mfma_f32_16x16x32_bf16 v[188:191], v[52:55], a[236:239], v[188:191]
  buffer_store_dwordx4 v[244:247], v2, s[40:43], s63 offen offset:1024 sc1
  v_mfma_f32_16x16x32_bf16 v[204:207], v[56:59], a[236:239], v[204:207]
  v_mfma_f32_16x16x32_bf16 v[220:223], v[60:63], a[236:239], v[220:223]
  s_waitcnt vmcnt(21) lgkmcnt(0)
  buffer_load_dwordx4 a[236:239], v2, s[40:43], s67 offen offset:2048 sc1
  v_mfma_f32_16x16x32_bf16 v[96:99], v[64:67], a[240:243], v[96:99]
  s_barrier
  v_accvgpr_read_b32 v236, a88
  v_mfma_f32_16x16x32_bf16 v[112:115], v[68:71], a[240:243], v[112:115]
  ds_read_b64_tr_b16 v[32:33], v12 offset:0
  v_accvgpr_read_b32 v237, a89
  v_mfma_f32_16x16x32_bf16 v[128:131], v[72:75], a[240:243], v[128:131]
  ds_read_b64_tr_b16 v[34:35], v12 offset:1024
  v_accvgpr_read_b32 v238, a90
  v_mfma_f32_16x16x32_bf16 v[144:147], v[76:79], a[240:243], v[144:147]
  ds_read_b64_tr_b16 v[36:37], v13 offset:0
  v_accvgpr_read_b32 v239, a91
  v_mfma_f32_16x16x32_bf16 v[160:163], v[80:83], a[240:243], v[160:163]
  ds_read_b64_tr_b16 v[38:39], v13 offset:1024
  v_accvgpr_read_b32 v240, a120
  v_mfma_f32_16x16x32_bf16 v[176:179], v[84:87], a[240:243], v[176:179]
  ds_read_b64_tr_b16 v[40:41], v12 offset:256
  v_accvgpr_read_b32 v241, a121
  v_mfma_f32_16x16x32_bf16 v[192:195], v[88:91], a[240:243], v[192:195]
  ds_read_b64_tr_b16 v[42:43], v12 offset:1280
  v_accvgpr_read_b32 v242, a122
  v_mfma_f32_16x16x32_bf16 v[208:211], v[92:95], a[240:243], v[208:211]
  buffer_load_dwordx4 a[240:243], v2, s[40:43], s64 offen offset:3072 sc1
  v_accvgpr_read_b32 v243, a123
  v_mfma_f32_16x16x32_bf16 v[100:103], v[64:67], a[244:247], v[100:103]
  s_add_u32 s64, s64, 4096
  ds_read_b64_tr_b16 v[44:45], v13 offset:256
  v_cvt_pk_bf16_f32 v232, v236, v237
  v_mfma_f32_16x16x32_bf16 v[116:119], v[68:71], a[244:247], v[116:119]
  ds_read_b64_tr_b16 v[46:47], v13 offset:1280
  v_cvt_pk_bf16_f32 v233, v238, v239
  v_mfma_f32_16x16x32_bf16 v[132:135], v[72:75], a[244:247], v[132:135]
  s_add_u32 m0, s24, 16384
  ds_read_b64_tr_b16 v[48:49], v12 offset:512
  v_cvt_pk_bf16_f32 v234, v240, v241
  v_mfma_f32_16x16x32_bf16 v[148:151], v[76:79], a[244:247], v[148:151]
  buffer_load_dwordx4 v8, s[36:39], s27 offen offset:0 lds
  v_cvt_pk_bf16_f32 v235, v242, v243
  v_mfma_f32_16x16x32_bf16 v[164:167], v[80:83], a[244:247], v[164:167]
  ds_read_b64_tr_b16 v[50:51], v12 offset:1536
  v_mfma_f32_16x16x32_bf16 v[180:183], v[84:87], a[244:247], v[180:183]
  s_add_u32 s63, s63, s61
  ds_read_b64_tr_b16 v[52:53], v13 offset:512
  v_mfma_f32_16x16x32_bf16 v[196:199], v[88:91], a[244:247], v[196:199]
  ds_read_b64_tr_b16 v[54:55], v13 offset:1536
  v_mfma_f32_16x16x32_bf16 v[212:215], v[92:95], a[244:247], v[212:215]
  buffer_load_dwordx4 a[244:247], v2, s[40:43], s65 offen offset:3072 sc1
  v_mfma_f32_16x16x32_bf16 v[104:107], v[64:67], a[248:251], v[104:107]
  s_add_u32 s65, s65, 4096
  ds_read_b64_tr_b16 v[56:57], v12 offset:768
  v_accvgpr_read_b32 v248, a92
  v_mfma_f32_16x16x32_bf16 v[120:123], v[68:71], a[248:251], v[120:123]
  ds_read_b64_tr_b16 v[58:59], v12 offset:1792
  v_accvgpr_read_b32 v249, a93
  v_mfma_f32_16x16x32_bf16 v[136:139], v[72:75], a[248:251], v[136:139]
  ds_read_b64_tr_b16 v[60:61], v13 offset:768
  v_accvgpr_read_b32 v250, a94
  v_mfma_f32_16x16x32_bf16 v[152:155], v[76:79], a[248:251], v[152:155]
  buffer_load_dwordx4 v9, s[36:39], s27 offen offset:1024 lds
  v_accvgpr_read_b32 v251, a95
  v_mfma_f32_16x16x32_bf16 v[168:171], v[80:83], a[248:251], v[168:171]
  ds_read_b64_tr_b16 v[62:63], v13 offset:1792
  v_accvgpr_read_b32 v252, a124
  v_mfma_f32_16x16x32_bf16 v[184:187], v[84:87], a[248:251], v[184:187]
  buffer_store_dwordx4 v[232:235], v2, s[40:43], s63 offen offset:0 sc1
  v_accvgpr_read_b32 v253, a125
  v_mfma_f32_16x16x32_bf16 v[200:203], v[88:91], a[248:251], v[200:203]
  buffer_load_dwordx4 v10, s[36:39], s27 offen offset:2048 lds
  v_accvgpr_read_b32 v254, a126
  v_mfma_f32_16x16x32_bf16 v[216:219], v[92:95], a[248:251], v[216:219]
  buffer_load_dwordx4 a[248:251], v2, s[40:43], s66 offen offset:3072 sc1
  v_accvgpr_read_b32 v255, a127
  v_mfma_f32_16x16x32_bf16 v[108:111], v[64:67], a[252:255], v[108:111]
  s_add_u32 s66, s66, 4096
  v_cvt_pk_bf16_f32 v244, v248, v249
  v_mfma_f32_16x16x32_bf16 v[124:127], v[68:71], a[252:255], v[124:127]
  buffer_load_dwordx4 v11, s[36:39], s27 offen offset:3072 lds
  v_cvt_pk_bf16_f32 v245, v250, v251
  v_mfma_f32_16x16x32_bf16 v[140:143], v[72:75], a[252:255], v[140:143]
  s_add_u32 s27, s27, 524288
  v_cvt_pk_bf16_f32 v246, v252, v253
  v_mfma_f32_16x16x32_bf16 v[156:159], v[76:79], a[252:255], v[156:159]
  s_add_u32 s24, s24, 32768
  v_cvt_pk_bf16_f32 v247, v254, v255
  v_mfma_f32_16x16x32_bf16 v[172:175], v[80:83], a[252:255], v[172:175]
  s_and_b32 s24, s24, 0x1ffff
  v_mfma_f32_16x16x32_bf16 v[188:191], v[84:87], a[252:255], v[188:191]
  buffer_store_dwordx4 v[244:247], v2, s[40:43], s63 offen offset:1024 sc1
  v_mfma_f32_16x16x32_bf16 v[204:207], v[88:91], a[252:255], v[204:207]
  v_mfma_f32_16x16x32_bf16 v[220:223], v[92:95], a[252:255], v[220:223]
  s_waitcnt vmcnt(25) lgkmcnt(0)
  buffer_load_dwordx4 a[252:255], v2, s[40:43], s67 offen offset:3072 sc1
  v_mfma_f32_16x16x32_bf16 v[96:99], v[32:35], a[192:195], v[96:99]
  v_accvgpr_read_b32 v236, a128
  v_mfma_f32_16x16x32_bf16 v[112:115], v[36:39], a[192:195], v[112:115]
  s_add_u32 s67, s67, 4096
  ds_read_b64_tr_b16 v[64:65], v12 offset:8192
  v_accvgpr_read_b32 v237, a129
  v_mfma_f32_16x16x32_bf16 v[128:131], v[40:43], a[192:195], v[128:131]
  ds_read_b64_tr_b16 v[66:67], v12 offset:9216
  v_accvgpr_read_b32 v238, a130
  v_mfma_f32_16x16x32_bf16 v[144:147], v[44:47], a[192:195], v[144:147]
  ds_read_b64_tr_b16 v[68:69], v13 offset:8192
  v_accvgpr_read_b32 v239, a131
  v_mfma_f32_16x16x32_bf16 v[160:163], v[48:51], a[192:195], v[160:163]
  ds_read_b64_tr_b16 v[70:71], v13 offset:9216
  v_accvgpr_read_b32 v240, a160
  v_mfma_f32_16x16x32_bf16 v[176:179], v[52:55], a[192:195], v[176:179]
  ds_read_b64_tr_b16 v[72:73], v12 offset:8448
  v_accvgpr_read_b32 v241, a161
  v_mfma_f32_16x16x32_bf16 v[192:195], v[56:59], a[192:195], v[192:195]
  ds_read_b64_tr_b16 v[74:75], v12 offset:9472
  v_accvgpr_read_b32 v242, a162
  v_mfma_f32_16x16x32_bf16 v[208:211], v[60:63], a[192:195], v[208:211]
  buffer_load_dwordx4 a[192:195], v2, s[40:43], s64 offen offset:0 sc1
  v_accvgpr_read_b32 v243, a163
  v_mfma_f32_16x16x32_bf16 v[100:103], v[32:35], a[196:199], v[100:103]
  ds_read_b64_tr_b16 v[76:77], v13 offset:8448
  v_cvt_pk_bf16_f32 v232, v236, v237
  v_mfma_f32_16x16x32_bf16 v[116:119], v[36:39], a[196:199], v[116:119]
  ds_read_b64_tr_b16 v[78:79], v13 offset:9472
  v_cvt_pk_bf16_f32 v233, v238, v239
  v_mfma_f32_16x16x32_bf16 v[132:135], v[40:43], a[196:199], v[132:135]
  ds_read_b64_tr_b16 v[80:81], v12 offset:8704
  v_cvt_pk_bf16_f32 v234, v240, v241
  v_mfma_f32_16x16x32_bf16 v[148:151], v[44:47], a[196:199], v[148:151]
  v_cvt_pk_bf16_f32 v235, v242, v243
  v_mfma_f32_16x16x32_bf16 v[164:167], v[48:51], a[196:199], v[164:167]
  ds_read_b64_tr_b16 v[82:83], v12 offset:9728
  v_mfma_f32_16x16x32_bf16 v[180:183], v[52:55], a[196:199], v[180:183]
  s_mul_i32 s63, s60, 2
  ds_read_b64_tr_b16 v[84:85], v13 offset:8704
  v_mfma_f32_16x16x32_bf16 v[196:199], v[56:59], a[196:199], v[196:199]
  s_add_u32 s63, s63, s62
  ds_read_b64_tr_b16 v[86:87], v13 offset:9728
  v_mfma_f32_16x16x32_bf16 v[212:215], v[60:63], a[196:199], v[212:215]
  buffer_load_dwordx4 a[196:199], v2, s[40:43], s65 offen offset:0 sc1
  v_mfma_f32_16x16x32_bf16 v[104:107], v[32:35], a[200:203], v[104:107]
  ds_read_b64_tr_b16 v[88:89], v12 offset:8960
  v_accvgpr_read_b32 v248, a132
  v_mfma_f32_16x16x32_bf16 v[120:123], v[36:39], a[200:203], v[120:123]
  ds_read_b64_tr_b16 v[90:91], v12 offset:9984
  v_accvgpr_read_b32 v249, a133
  v_mfma_f32_16x16x32_bf16 v[136:139], v[40:43], a[200:203], v[136:139]
  ds_read_b64_tr_b16 v[92:93], v13 offset:8960
  v_accvgpr_read_b32 v250, a134
  v_mfma_f32_16x16x32_bf16 v[152:155], v[44:47], a[200:203], v[152:155]
  v_accvgpr_read_b32 v251, a135
  v_mfma_f32_16x16x32_bf16 v[168:171], v[48:51], a[200:203], v[168:171]
  ds_read_b64_tr_b16 v[94:95], v13 offset:9984
  v_accvgpr_read_b32 v252, a164
  v_mfma_f32_16x16x32_bf16 v[184:187], v[52:55], a[200:203], v[184:187]
  buffer_store_dwordx4 v[232:235], v2, s[40:43], s63 offen offset:0 sc1
  v_accvgpr_read_b32 v253, a165
  v_mfma_f32_16x16x32_bf16 v[200:203], v[56:59], a[200:203], v[200:203]
  v_accvgpr_read_b32 v254, a166
  v_mfma_f32_16x16x32_bf16 v[216:219], v[60:63], a[200:203], v[216:219]
  buffer_load_dwordx4 a[200:203], v2, s[40:43], s66 offen offset:0 sc1
  v_accvgpr_read_b32 v255, a167
  v_mfma_f32_16x16x32_bf16 v[108:111], v[32:35], a[204:207], v[108:111]
  v_cvt_pk_bf16_f32 v244, v248, v249
  v_mfma_f32_16x16x32_bf16 v[124:127], v[36:39], a[204:207], v[124:127]
  v_cvt_pk_bf16_f32 v245, v250, v251
  v_mfma_f32_16x16x32_bf16 v[140:143], v[40:43], a[204:207], v[140:143]
  v_cvt_pk_bf16_f32 v246, v252, v253
  v_mfma_f32_16x16x32_bf16 v[156:159], v[44:47], a[204:207], v[156:159]
  v_cvt_pk_bf16_f32 v247, v254, v255
  v_mfma_f32_16x16x32_bf16 v[172:175], v[48:51], a[204:207], v[172:175]
  v_mfma_f32_16x16x32_bf16 v[188:191], v[52:55], a[204:207], v[188:191]
  buffer_store_dwordx4 v[244:247], v2, s[40:43], s63 offen offset:1024 sc1
  v_mfma_f32_16x16x32_bf16 v[204:207], v[56:59], a[204:207], v[204:207]
  v_mfma_f32_16x16x32_bf16 v[220:223], v[60:63], a[204:207], v[220:223]
  s_waitcnt vmcnt(21) lgkmcnt(0)
  buffer_load_dwordx4 a[204:207], v2, s[40:43], s67 offen offset:0 sc1
  v_mfma_f32_16x16x32_bf16 v[96:99], v[64:67], a[208:211], v[96:99]
  s_barrier
  v_accvgpr_read_b32 v236, a136
  v_mfma_f32_16x16x32_bf16 v[112:115], v[68:71], a[208:211], v[112:115]
  ds_read_b64_tr_b16 v[32:33], v12 offset:32768
  v_accvgpr_read_b32 v237, a137
  v_mfma_f32_16x16x32_bf16 v[128:131], v[72:75], a[208:211], v[128:131]
  ds_read_b64_tr_b16 v[34:35], v12 offset:33792
  v_accvgpr_read_b32 v238, a138
  v_mfma_f32_16x16x32_bf16 v[144:147], v[76:79], a[208:211], v[144:147]
  ds_read_b64_tr_b16 v[36:37], v13 offset:32768
  v_accvgpr_read_b32 v239, a139
  v_mfma_f32_16x16x32_bf16 v[160:163], v[80:83], a[208:211], v[160:163]
  ds_read_b64_tr_b16 v[38:39], v13 offset:33792
  v_accvgpr_read_b32 v240, a168
  v_mfma_f32_16x16x32_bf16 v[176:179], v[84:87], a[208:211], v[176:179]
  ds_read_b64_tr_b16 v[40:41], v12 offset:33024
  v_accvgpr_read_b32 v241, a169
  v_mfma_f32_16x16x32_bf16 v[192:195], v[88:91], a[208:211], v[192:195]
  ds_read_b64_tr_b16 v[42:43], v12 offset:34048
  v_accvgpr_read_b32 v242, a170
  v_mfma_f32_16x16x32_bf16 v[208:211], v[92:95], a[208:211], v[208:211]
  buffer_load_dwordx4 a[208:211], v2, s[40:43], s64 offen offset:1024 sc1
  v_accvgpr_read_b32 v243, a171
  v_mfma_f32_16x16x32_bf16 v[100:103], v[64:67], a[212:215], v[100:103]
  ds_read_b64_tr_b16 v[44:45], v13 offset:33024
  v_cvt_pk_bf16_f32 v232, v236, v237
  v_mfma_f32_16x16x32_bf16 v[116:119], v[68:71], a[212:215], v[116:119]
  ds_read_b64_tr_b16 v[46:47], v13 offset:34048
  v_cvt_pk_bf16_f32 v233, v238, v239
  v_mfma_f32_16x16x32_bf16 v[132:135], v[72:75], a[212:215], v[132:135]
  s_add_u32 m0, s24, 16384
  ds_read_b64_tr_b16 v[48:49], v12 offset:33280
  v_cvt_pk_bf16_f32 v234, v240, v241
  v_mfma_f32_16x16x32_bf16 v[148:151], v[76:79], a[212:215], v[148:151]
  buffer_load_dwordx4 v8, s[36:39], s27 offen offset:0 lds
  v_cvt_pk_bf16_f32 v235, v242, v243
  v_mfma_f32_16x16x32_bf16 v[164:167], v[80:83], a[212:215], v[164:167]
  ds_read_b64_tr_b16 v[50:51], v12 offset:34304
  v_mfma_f32_16x16x32_bf16 v[180:183], v[84:87], a[212:215], v[180:183]
  s_add_u32 s63, s63, s61
  ds_read_b64_tr_b16 v[52:53], v13 offset:33280
  v_mfma_f32_16x16x32_bf16 v[196:199], v[88:91], a[212:215], v[196:199]
  ds_read_b64_tr_b16 v[54:55], v13 offset:34304
  v_mfma_f32_16x16x32_bf16 v[212:215], v[92:95], a[212:215], v[212:215]
  buffer_load_dwordx4 a[212:215], v2, s[40:43], s65 offen offset:1024 sc1
  v_mfma_f32_16x16x32_bf16 v[104:107], v[64:67], a[216:219], v[104:107]
  ds_read_b64_tr_b16 v[56:57], v12 offset:33536
  v_accvgpr_read_b32 v248, a140
  v_mfma_f32_16x16x32_bf16 v[120:123], v[68:71], a[216:219], v[120:123]
  ds_read_b64_tr_b16 v[58:59], v12 offset:34560
  v_accvgpr_read_b32 v249, a141
  v_mfma_f32_16x16x32_bf16 v[136:139], v[72:75], a[216:219], v[136:139]
  ds_read_b64_tr_b16 v[60:61], v13 offset:33536
  v_accvgpr_read_b32 v250, a142
  v_mfma_f32_16x16x32_bf16 v[152:155], v[76:79], a[216:219], v[152:155]
  buffer_load_dwordx4 v9, s[36:39], s27 offen offset:1024 lds
  v_accvgpr_read_b32 v251, a143
  v_mfma_f32_16x16x32_bf16 v[168:171], v[80:83], a[216:219], v[168:171]
  ds_read_b64_tr_b16 v[62:63], v13 offset:34560
  v_accvgpr_read_b32 v252, a172
  v_mfma_f32_16x16x32_bf16 v[184:187], v[84:87], a[216:219], v[184:187]
  buffer_store_dwordx4 v[232:235], v2, s[40:43], s63 offen offset:0 sc1
  v_accvgpr_read_b32 v253, a173
  v_mfma_f32_16x16x32_bf16 v[200:203], v[88:91], a[216:219], v[200:203]
  buffer_load_dwordx4 v10, s[36:39], s27 offen offset:2048 lds
  v_accvgpr_read_b32 v254, a174
  v_mfma_f32_16x16x32_bf16 v[216:219], v[92:95], a[216:219], v[216:219]
  buffer_load_dwordx4 a[216:219], v2, s[40:43], s66 offen offset:1024 sc1
  v_accvgpr_read_b32 v255, a175
  v_mfma_f32_16x16x32_bf16 v[108:111], v[64:67], a[220:223], v[108:111]
  v_cvt_pk_bf16_f32 v244, v248, v249
  v_mfma_f32_16x16x32_bf16 v[124:127], v[68:71], a[220:223], v[124:127]
  buffer_load_dwordx4 v11, s[36:39], s27 offen offset:3072 lds
  v_cvt_pk_bf16_f32 v245, v250, v251
  v_mfma_f32_16x16x32_bf16 v[140:143], v[72:75], a[220:223], v[140:143]
  s_add_u32 s27, s27, 524288
  v_cvt_pk_bf16_f32 v246, v252, v253
  v_mfma_f32_16x16x32_bf16 v[156:159], v[76:79], a[220:223], v[156:159]
  s_add_u32 s24, s24, 32768
  v_cvt_pk_bf16_f32 v247, v254, v255
  v_mfma_f32_16x16x32_bf16 v[172:175], v[80:83], a[220:223], v[172:175]
  s_and_b32 s24, s24, 0x1ffff
  v_mfma_f32_16x16x32_bf16 v[188:191], v[84:87], a[220:223], v[188:191]
  buffer_store_dwordx4 v[244:247], v2, s[40:43], s63 offen offset:1024 sc1
  v_mfma_f32_16x16x32_bf16 v[204:207], v[88:91], a[220:223], v[204:207]
  v_mfma_f32_16x16x32_bf16 v[220:223], v[92:95], a[220:223], v[220:223]
  s_waitcnt vmcnt(25) lgkmcnt(0)
  buffer_load_dwordx4 a[220:223], v2, s[40:43], s67 offen offset:1024 sc1
  v_mfma_f32_16x16x32_bf16 v[96:99], v[32:35], a[224:227], v[96:99]
  v_accvgpr_read_b32 v236, a144
  v_mfma_f32_16x16x32_bf16 v[112:115], v[36:39], a[224:227], v[112:115]
  ds_read_b64_tr_b16 v[64:65], v12 offset:40960
  v_accvgpr_read_b32 v237, a145
  v_mfma_f32_16x16x32_bf16 v[128:131], v[40:43], a[224:227], v[128:131]
  ds_read_b64_tr_b16 v[66:67], v12 offset:41984
  v_accvgpr_read_b32 v238, a146
  v_mfma_f32_16x16x32_bf16 v[144:147], v[44:47], a[224:227], v[144:147]
  ds_read_b64_tr_b16 v[68:69], v13 offset:40960
  v_accvgpr_read_b32 v239, a147
  v_mfma_f32_16x16x32_bf16 v[160:163], v[48:51], a[224:227], v[160:163]
  ds_read_b64_tr_b16 v[70:71], v13 offset:41984
  v_accvgpr_read_b32 v240, a176
  v_mfma_f32_16x16x32_bf16 v[176:179], v[52:55], a[224:227], v[176:179]
  ds_read_b64_tr_b16 v[72:73], v12 offset:41216
  v_accvgpr_read_b32 v241, a177
  v_mfma_f32_16x16x32_bf16 v[192:195], v[56:59], a[224:227], v[192:195]
  ds_read_b64_tr_b16 v[74:75], v12 offset:42240
  v_accvgpr_read_b32 v242, a178
  v_mfma_f32_16x16x32_bf16 v[208:211], v[60:63], a[224:227], v[208:211]
  buffer_load_dwordx4 a[224:227], v2, s[40:43], s64 offen offset:2048 sc1
  v_accvgpr_read_b32 v243, a179
  v_mfma_f32_16x16x32_bf16 v[100:103], v[32:35], a[228:231], v[100:103]
  ds_read_b64_tr_b16 v[76:77], v13 offset:41216
  v_cvt_pk_bf16_f32 v232, v236, v237
  v_mfma_f32_16x16x32_bf16 v[116:119], v[36:39], a[228:231], v[116:119]
  ds_read_b64_tr_b16 v[78:79], v13 offset:42240
  v_cvt_pk_bf16_f32 v233, v238, v239
  v_mfma_f32_16x16x32_bf16 v[132:135], v[40:43], a[228:231], v[132:135]
  ds_read_b64_tr_b16 v[80:81], v12 offset:41472
  v_cvt_pk_bf16_f32 v234, v240, v241
  v_mfma_f32_16x16x32_bf16 v[148:151], v[44:47], a[228:231], v[148:151]
  v_cvt_pk_bf16_f32 v235, v242, v243
  v_mfma_f32_16x16x32_bf16 v[164:167], v[48:51], a[228:231], v[164:167]
  ds_read_b64_tr_b16 v[82:83], v12 offset:42496
  v_mfma_f32_16x16x32_bf16 v[180:183], v[52:55], a[228:231], v[180:183]
  s_add_u32 s63, s63, s61
  ds_read_b64_tr_b16 v[84:85], v13 offset:41472
  v_mfma_f32_16x16x32_bf16 v[196:199], v[56:59], a[228:231], v[196:199]
  ds_read_b64_tr_b16 v[86:87], v13 offset:42496
  v_mfma_f32_16x16x32_bf16 v[212:215], v[60:63], a[228:231], v[212:215]
  buffer_load_dwordx4 a[228:231], v2, s[40:43], s65 offen offset:2048 sc1
  v_mfma_f32_16x16x32_bf16 v[104:107], v[32:35], a[232:235], v[104:107]
  ds_read_b64_tr_b16 v[88:89], v12 offset:41728
  v_accvgpr_read_b32 v248, a148
  v_mfma_f32_16x16x32_bf16 v[120:123], v[36:39], a[232:235], v[120:123]
  ds_read_b64_tr_b16 v[90:91], v12 offset:42752
  v_accvgpr_read_b32 v249, a149
  v_mfma_f32_16x16x32_bf16 v[136:139], v[40:43], a[232:235], v[136:139]
  ds_read_b64_tr_b16 v[92:93], v13 offset:41728
  v_accvgpr_read_b32 v250, a150
  v_mfma_f32_16x16x32_bf16 v[152:155], v[44:47], a[232:235], v[152:155]
  v_accvgpr_read_b32 v251, a151
  v_mfma_f32_16x16x32_bf16 v[168:171], v[48:51], a[232:235], v[168:171]
  ds_read_b64_tr_b16 v[94:95], v13 offset:42752
  v_accvgpr_read_b32 v252, a180
  v_mfma_f32_16x16x32_bf16 v[184:187], v[52:55], a[232:235], v[184:187]
  buffer_store_dwordx4 v[232:235], v2, s[40:43], s63 offen offset:0 sc1
  v_accvgpr_read_b32 v253, a181
  v_mfma_f32_16x16x32_bf16 v[200:203], v[56:59], a[232:235], v[200:203]
  v_accvgpr_read_b32 v254, a182
  v_mfma_f32_16x16x32_bf16 v[216:219], v[60:63], a[232:235], v[216:219]
  buffer_load_dwordx4 a[232:235], v2, s[40:43], s66 offen offset:2048 sc1
  v_accvgpr_read_b32 v255, a183
  v_mfma_f32_16x16x32_bf16 v[108:111], v[32:35], a[236:239], v[108:111]
  v_xor_b32 v12, 0x10000, v12
  v_cvt_pk_bf16_f32 v244, v248, v249
  v_mfma_f32_16x16x32_bf16 v[124:127], v[36:39], a[236:239], v[124:127]
  v_cvt_pk_bf16_f32 v245, v250, v251
  v_mfma_f32_16x16x32_bf16 v[140:143], v[40:43], a[236:239], v[140:143]
  v_xor_b32 v13, 0x10000, v13
  v_cvt_pk_bf16_f32 v246, v252, v253
  v_mfma_f32_16x16x32_bf16 v[156:159], v[44:47], a[236:239], v[156:159]
  v_cvt_pk_bf16_f32 v247, v254, v255
  v_mfma_f32_16x16x32_bf16 v[172:175], v[48:51], a[236:239], v[172:175]
  v_mfma_f32_16x16x32_bf16 v[188:191], v[52:55], a[236:239], v[188:191]
  buffer_store_dwordx4 v[244:247], v2, s[40:43], s63 offen offset:1024 sc1
  v_mfma_f32_16x16x32_bf16 v[204:207], v[56:59], a[236:239], v[204:207]
  v_mfma_f32_16x16x32_bf16 v[220:223], v[60:63], a[236:239], v[220:223]
  s_waitcnt vmcnt(21) lgkmcnt(0)
  buffer_load_dwordx4 a[236:239], v2, s[40:43], s67 offen offset:2048 sc1
  v_mfma_f32_16x16x32_bf16 v[96:99], v[64:67], a[240:243], v[96:99]
  s_barrier
  v_accvgpr_read_b32 v236, a152
  v_mfma_f32_16x16x32_bf16 v[112:115], v[68:71], a[240:243], v[112:115]
  ds_read_b64_tr_b16 v[32:33], v12 offset:0
  v_accvgpr_read_b32 v237, a153
  v_mfma_f32_16x16x32_bf16 v[128:131], v[72:75], a[240:243], v[128:131]
  ds_read_b64_tr_b16 v[34:35], v12 offset:1024
  v_accvgpr_read_b32 v238, a154
  v_mfma_f32_16x16x32_bf16 v[144:147], v[76:79], a[240:243], v[144:147]
  ds_read_b64_tr_b16 v[36:37], v13 offset:0
  v_accvgpr_read_b32 v239, a155
  v_mfma_f32_16x16x32_bf16 v[160:163], v[80:83], a[240:243], v[160:163]
  ds_read_b64_tr_b16 v[38:39], v13 offset:1024
  v_accvgpr_read_b32 v240, a184
  v_mfma_f32_16x16x32_bf16 v[176:179], v[84:87], a[240:243], v[176:179]
  ds_read_b64_tr_b16 v[40:41], v12 offset:256
  v_accvgpr_read_b32 v241, a185
  v_mfma_f32_16x16x32_bf16 v[192:195], v[88:91], a[240:243], v[192:195]
  ds_read_b64_tr_b16 v[42:43], v12 offset:1280
  v_accvgpr_read_b32 v242, a186
  v_mfma_f32_16x16x32_bf16 v[208:211], v[92:95], a[240:243], v[208:211]
  buffer_load_dwordx4 a[240:243], v2, s[40:43], s64 offen offset:3072 sc1
  v_accvgpr_read_b32 v243, a187
  v_mfma_f32_16x16x32_bf16 v[100:103], v[64:67], a[244:247], v[100:103]
  s_add_u32 s64, s64, 4096
  ds_read_b64_tr_b16 v[44:45], v13 offset:256
  v_cvt_pk_bf16_f32 v232, v236, v237
  v_mfma_f32_16x16x32_bf16 v[116:119], v[68:71], a[244:247], v[116:119]
  ds_read_b64_tr_b16 v[46:47], v13 offset:1280
  v_cvt_pk_bf16_f32 v233, v238, v239
  v_mfma_f32_16x16x32_bf16 v[132:135], v[72:75], a[244:247], v[132:135]
  s_add_u32 m0, s24, 16384
  ds_read_b64_tr_b16 v[48:49], v12 offset:512
  v_cvt_pk_bf16_f32 v234, v240, v241
  v_mfma_f32_16x16x32_bf16 v[148:151], v[76:79], a[244:247], v[148:151]
  buffer_load_dwordx4 v8, s[36:39], s27 offen offset:0 lds
  v_cvt_pk_bf16_f32 v235, v242, v243
  v_mfma_f32_16x16x32_bf16 v[164:167], v[80:83], a[244:247], v[164:167]
  ds_read_b64_tr_b16 v[50:51], v12 offset:1536
  v_mfma_f32_16x16x32_bf16 v[180:183], v[84:87], a[244:247], v[180:183]
  s_add_u32 s63, s63, s61
  ds_read_b64_tr_b16 v[52:53], v13 offset:512
  v_mfma_f32_16x16x32_bf16 v[196:199], v[88:91], a[244:247], v[196:199]
  ds_read_b64_tr_b16 v[54:55], v13 offset:1536
  v_mfma_f32_16x16x32_bf16 v[212:215], v[92:95], a[244:247], v[212:215]
  buffer_load_dwordx4 a[244:247], v2, s[40:43], s65 offen offset:3072 sc1
  v_mfma_f32_16x16x32_bf16 v[104:107], v[64:67], a[248:251], v[104:107]
  s_add_u32 s65, s65, 4096
  ds_read_b64_tr_b16 v[56:57], v12 offset:768
  v_accvgpr_read_b32 v248, a156
  v_mfma_f32_16x16x32_bf16 v[120:123], v[68:71], a[248:251], v[120:123]
  ds_read_b64_tr_b16 v[58:59], v12 offset:1792
  v_accvgpr_read_b32 v249, a157
  v_mfma_f32_16x16x32_bf16 v[136:139], v[72:75], a[248:251], v[136:139]
  ds_read_b64_tr_b16 v[60:61], v13 offset:768
  v_accvgpr_read_b32 v250, a158
  v_mfma_f32_16x16x32_bf16 v[152:155], v[76:79], a[248:251], v[152:155]
  buffer_load_dwordx4 v9, s[36:39], s27 offen offset:1024 lds
  v_accvgpr_read_b32 v251, a159
  v_mfma_f32_16x16x32_bf16 v[168:171], v[80:83], a[248:251], v[168:171]
  ds_read_b64_tr_b16 v[62:63], v13 offset:1792
  v_accvgpr_read_b32 v252, a188
  v_mfma_f32_16x16x32_bf16 v[184:187], v[84:87], a[248:251], v[184:187]
  buffer_store_dwordx4 v[232:235], v2, s[40:43], s63 offen offset:0 sc1
  v_accvgpr_read_b32 v253, a189
  v_mfma_f32_16x16x32_bf16 v[200:203], v[88:91], a[248:251], v[200:203]
  buffer_load_dwordx4 v10, s[36:39], s27 offen offset:2048 lds
  v_accvgpr_read_b32 v254, a190
  v_mfma_f32_16x16x32_bf16 v[216:219], v[92:95], a[248:251], v[216:219]
  buffer_load_dwordx4 a[248:251], v2, s[40:43], s66 offen offset:3072 sc1
  v_accvgpr_read_b32 v255, a191
  v_mfma_f32_16x16x32_bf16 v[108:111], v[64:67], a[252:255], v[108:111]
  s_add_u32 s66, s66, 4096
  v_cvt_pk_bf16_f32 v244, v248, v249
  v_mfma_f32_16x16x32_bf16 v[124:127], v[68:71], a[252:255], v[124:127]
  buffer_load_dwordx4 v11, s[36:39], s27 offen offset:3072 lds
  v_cvt_pk_bf16_f32 v245, v250, v251
  v_mfma_f32_16x16x32_bf16 v[140:143], v[72:75], a[252:255], v[140:143]
  s_add_u32 s27, s27, 524288
  v_cvt_pk_bf16_f32 v246, v252, v253
  v_mfma_f32_16x16x32_bf16 v[156:159], v[76:79], a[252:255], v[156:159]
  s_add_u32 s24, s24, 32768
  v_cvt_pk_bf16_f32 v247, v254, v255
  v_mfma_f32_16x16x32_bf16 v[172:175], v[80:83], a[252:255], v[172:175]
  s_and_b32 s24, s24, 0x1ffff
  v_mfma_f32_16x16x32_bf16 v[188:191], v[84:87], a[252:255], v[188:191]
  buffer_store_dwordx4 v[244:247], v2, s[40:43], s63 offen offset:1024 sc1
  v_mfma_f32_16x16x32_bf16 v[204:207], v[88:91], a[252:255], v[204:207]
  v_mfma_f32_16x16x32_bf16 v[220:223], v[92:95], a[252:255], v[220:223]
  s_waitcnt vmcnt(25) lgkmcnt(0)
  buffer_load_dwordx4 a[252:255], v2, s[40:43], s67 offen offset:3072 sc1
  v_mfma_f32_16x16x32_bf16 v[96:99], v[32:35], a[192:195], v[96:99]
  v_and_b32 v16, 15, v1
  v_mfma_f32_16x16x32_bf16 v[112:115], v[36:39], a[192:195], v[112:115]
  s_add_u32 s67, s67, 4096
  ds_read_b64_tr_b16 v[64:65], v12 offset:8192
  v_lshrrev_b32 v17, 4, v1
  v_mfma_f32_16x16x32_bf16 v[128:131], v[40:43], a[192:195], v[128:131]
  ds_read_b64_tr_b16 v[66:67], v12 offset:9216
  v_lshlrev_b32 v17, 2, v17
  v_mfma_f32_16x16x32_bf16 v[144:147], v[44:47], a[192:195], v[144:147]
  ds_read_b64_tr_b16 v[68:69], v13 offset:8192
  v_sub_u32 v16, v16, v17
  v_mfma_f32_16x16x32_bf16 v[160:163], v[48:51], a[192:195], v[160:163]
  ds_read_b64_tr_b16 v[70:71], v13 offset:9216
  v_cmp_le_i32 s[68:69], 0, v16
  v_mfma_f32_16x16x32_bf16 v[176:179], v[52:55], a[192:195], v[176:179]
  ds_read_b64_tr_b16 v[72:73], v12 offset:8448
  v_cmp_le_i32 s[70:71], 1, v16
  v_mfma_f32_16x16x32_bf16 v[192:195], v[56:59], a[192:195], v[192:195]
  ds_read_b64_tr_b16 v[74:75], v12 offset:9472
  v_cmp_le_i32 s[72:73], 2, v16
  v_mfma_f32_16x16x32_bf16 v[208:211], v[60:63], a[192:195], v[208:211]
  buffer_load_dwordx4 a[192:195], v2, s[40:43], s64 offen offset:0 sc1
  v_mfma_f32_16x16x32_bf16 v[100:103], v[32:35], a[196:199], v[100:103]
  ds_read_b64_tr_b16 v[76:77], v13 offset:8448
  v_mfma_f32_16x16x32_bf16 v[116:119], v[36:39], a[196:199], v[116:119]
  ds_read_b64_tr_b16 v[78:79], v13 offset:9472
  v_mfma_f32_16x16x32_bf16 v[132:135], v[40:43], a[196:199], v[132:135]
  ds_read_b64_tr_b16 v[80:81], v12 offset:8704
  v_mfma_f32_16x16x32_bf16 v[148:151], v[44:47], a[196:199], v[148:151]
  v_cmp_le_i32 s[74:75], 3, v16
  v_mfma_f32_16x16x32_bf16 v[164:167], v[48:51], a[196:199], v[164:167]
  ds_read_b64_tr_b16 v[82:83], v12 offset:9728
  v_mfma_f32_16x16x32_bf16 v[180:183], v[52:55], a[196:199], v[180:183]
  ds_read_b64_tr_b16 v[84:85], v13 offset:8704
  v_mfma_f32_16x16x32_bf16 v[196:199], v[56:59], a[196:199], v[196:199]
  ds_read_b64_tr_b16 v[86:87], v13 offset:9728
  v_mfma_f32_16x16x32_bf16 v[212:215], v[60:63], a[196:199], v[212:215]
  buffer_load_dwordx4 a[196:199], v2, s[40:43], s65 offen offset:0 sc1
  v_mfma_f32_16x16x32_bf16 v[104:107], v[32:35], a[200:203], v[104:107]
  ds_read_b64_tr_b16 v[88:89], v12 offset:8960
  v_mfma_f32_16x16x32_bf16 v[120:123], v[36:39], a[200:203], v[120:123]
  ds_read_b64_tr_b16 v[90:91], v12 offset:9984
  v_mfma_f32_16x16x32_bf16 v[136:139], v[40:43], a[200:203], v[136:139]
  ds_read_b64_tr_b16 v[92:93], v13 offset:8960
  v_mfma_f32_16x16x32_bf16 v[152:155], v[44:47], a[200:203], v[152:155]
  v_mov_b32 v4, 0xff800000
  v_mfma_f32_16x16x32_bf16 v[168:171], v[48:51], a[200:203], v[168:171]
  ds_read_b64_tr_b16 v[94:95], v13 offset:9984
  v_mfma_f32_16x16x32_bf16 v[184:187], v[52:55], a[200:203], v[184:187]
  v_and_b32 v230, 7, v1
  v_mfma_f32_16x16x32_bf16 v[200:203], v[56:59], a[200:203], v[200:203]
  v_lshlrev_b32 v230, 2, v230
  v_mfma_f32_16x16x32_bf16 v[216:219], v[60:63], a[200:203], v[216:219]
  buffer_load_dwordx4 a[200:203], v2, s[40:43], s66 offen offset:0 sc1
  v_mfma_f32_16x16x32_bf16 v[108:111], v[32:35], a[204:207], v[108:111]
  v_add_u32 v230, s30, v230
  v_mfma_f32_16x16x32_bf16 v[124:127], v[36:39], a[204:207], v[124:127]
  v_mov_b32 v18, 1073741824
  v_mfma_f32_16x16x32_bf16 v[140:143], v[40:43], a[204:207], v[140:143]
  v_mov_b32 v19, 1
  v_mfma_f32_16x16x32_bf16 v[156:159], v[44:47], a[204:207], v[156:159]
  v_writelane_b32 v18, s29, 0
  v_mfma_f32_16x16x32_bf16 v[172:175], v[48:51], a[204:207], v[172:175]
  v_accvgpr_write_b32 a0, 0
  v_mfma_f32_16x16x32_bf16 v[188:191], v[52:55], a[204:207], v[188:191]
  v_accvgpr_write_b32 a1, 0
  v_mfma_f32_16x16x32_bf16 v[204:207], v[56:59], a[204:207], v[204:207]
  v_accvgpr_write_b32 a2, 0
  v_mfma_f32_16x16x32_bf16 v[220:223], v[60:63], a[204:207], v[220:223]
  s_waitcnt vmcnt(19) lgkmcnt(0)
  buffer_load_dwordx4 a[204:207], v2, s[40:43], s67 offen offset:0 sc1
  v_mfma_f32_16x16x32_bf16 v[96:99], v[64:67], a[208:211], v[96:99]
  s_barrier
  v_accvgpr_write_b32 a3, 0
  v_mfma_f32_16x16x32_bf16 v[112:115], v[68:71], a[208:211], v[112:115]
  ds_read_b64_tr_b16 v[32:33], v12 offset:32768
  v_accvgpr_write_b32 a4, 0
  v_mfma_f32_16x16x32_bf16 v[128:131], v[72:75], a[208:211], v[128:131]
  ds_read_b64_tr_b16 v[34:35], v12 offset:33792
  v_accvgpr_write_b32 a5, 0
  v_mfma_f32_16x16x32_bf16 v[144:147], v[76:79], a[208:211], v[144:147]
  ds_read_b64_tr_b16 v[36:37], v13 offset:32768
  v_accvgpr_write_b32 a6, 0
  v_mfma_f32_16x16x32_bf16 v[160:163], v[80:83], a[208:211], v[160:163]
  ds_read_b64_tr_b16 v[38:39], v13 offset:33792
  v_accvgpr_write_b32 a7, 0
  v_mfma_f32_16x16x32_bf16 v[176:179], v[84:87], a[208:211], v[176:179]
  ds_read_b64_tr_b16 v[40:41], v12 offset:33024
  v_accvgpr_write_b32 a8, 0
  v_mfma_f32_16x16x32_bf16 v[192:195], v[88:91], a[208:211], v[192:195]
  ds_read_b64_tr_b16 v[42:43], v12 offset:34048
  v_accvgpr_write_b32 a9, 0
  v_mfma_f32_16x16x32_bf16 v[208:211], v[92:95], a[208:211], v[208:211]
  buffer_load_dwordx4 a[208:211], v2, s[40:43], s64 offen offset:1024 sc1
  v_mfma_f32_16x16x32_bf16 v[100:103], v[64:67], a[212:215], v[100:103]
  ds_read_b64_tr_b16 v[44:45], v13 offset:33024
  v_mfma_f32_16x16x32_bf16 v[116:119], v[68:71], a[212:215], v[116:119]
  ds_read_b64_tr_b16 v[46:47], v13 offset:34048
  v_mfma_f32_16x16x32_bf16 v[132:135], v[72:75], a[212:215], v[132:135]
  ds_read_b64_tr_b16 v[48:49], v12 offset:33280
  v_mfma_f32_16x16x32_bf16 v[148:151], v[76:79], a[212:215], v[148:151]
  v_accvgpr_write_b32 a10, 0
  v_mfma_f32_16x16x32_bf16 v[164:167], v[80:83], a[212:215], v[164:167]
  ds_read_b64_tr_b16 v[50:51], v12 offset:34304
  v_mfma_f32_16x16x32_bf16 v[180:183], v[84:87], a[212:215], v[180:183]
  ds_read_b64_tr_b16 v[52:53], v13 offset:33280
  v_mfma_f32_16x16x32_bf16 v[196:199], v[88:91], a[212:215], v[196:199]
  ds_read_b64_tr_b16 v[54:55], v13 offset:34304
  v_mfma_f32_16x16x32_bf16 v[212:215], v[92:95], a[212:215], v[212:215]
  buffer_load_dwordx4 a[212:215], v2, s[40:43], s65 offen offset:1024 sc1
  v_mfma_f32_16x16x32_bf16 v[104:107], v[64:67], a[216:219], v[104:107]
  ds_read_b64_tr_b16 v[56:57], v12 offset:33536
  v_mfma_f32_16x16x32_bf16 v[120:123], v[68:71], a[216:219], v[120:123]
  ds_read_b64_tr_b16 v[58:59], v12 offset:34560
  v_mfma_f32_16x16x32_bf16 v[136:139], v[72:75], a[216:219], v[136:139]
  ds_read_b64_tr_b16 v[60:61], v13 offset:33536
  v_mfma_f32_16x16x32_bf16 v[152:155], v[76:79], a[216:219], v[152:155]
  v_accvgpr_write_b32 a11, 0
  v_mfma_f32_16x16x32_bf16 v[168:171], v[80:83], a[216:219], v[168:171]
  ds_read_b64_tr_b16 v[62:63], v13 offset:34560
  v_mfma_f32_16x16x32_bf16 v[184:187], v[84:87], a[216:219], v[184:187]
  v_accvgpr_write_b32 a12, 0
  v_mfma_f32_16x16x32_bf16 v[200:203], v[88:91], a[216:219], v[200:203]
  v_accvgpr_write_b32 a13, 0
  v_mfma_f32_16x16x32_bf16 v[216:219], v[92:95], a[216:219], v[216:219]
  buffer_load_dwordx4 a[216:219], v2, s[40:43], s66 offen offset:1024 sc1
  v_mfma_f32_16x16x32_bf16 v[108:111], v[64:67], a[220:223], v[108:111]
  v_accvgpr_write_b32 a14, 0
  v_mfma_f32_16x16x32_bf16 v[124:127], v[68:71], a[220:223], v[124:127]
  v_accvgpr_write_b32 a15, 0
  v_mfma_f32_16x16x32_bf16 v[140:143], v[72:75], a[220:223], v[140:143]
  v_accvgpr_write_b32 a16, 0
  v_mfma_f32_16x16x32_bf16 v[156:159], v[76:79], a[220:223], v[156:159]
  v_accvgpr_write_b32 a17, 0
  v_mfma_f32_16x16x32_bf16 v[172:175], v[80:83], a[220:223], v[172:175]
  v_accvgpr_write_b32 a18, 0
  v_mfma_f32_16x16x32_bf16 v[188:191], v[84:87], a[220:223], v[188:191]
  v_accvgpr_write_b32 a19, 0
  v_mfma_f32_16x16x32_bf16 v[204:207], v[88:91], a[220:223], v[204:207]
  v_accvgpr_write_b32 a20, 0
  v_mfma_f32_16x16x32_bf16 v[220:223], v[92:95], a[220:223], v[220:223]
  s_waitcnt vmcnt(17) lgkmcnt(0)
  buffer_load_dwordx4 a[220:223], v2, s[40:43], s67 offen offset:1024 sc1
  v_mfma_f32_16x16x32_bf16 v[96:99], v[32:35], a[224:227], v[96:99]
  v_accvgpr_write_b32 a21, 0
  v_mfma_f32_16x16x32_bf16 v[112:115], v[36:39], a[224:227], v[112:115]
  ds_read_b64_tr_b16 v[64:65], v12 offset:40960
  v_accvgpr_write_b32 a22, 0
  v_mfma_f32_16x16x32_bf16 v[128:131], v[40:43], a[224:227], v[128:131]
  ds_read_b64_tr_b16 v[66:67], v12 offset:41984
  v_accvgpr_write_b32 a23, 0
  v_mfma_f32_16x16x32_bf16 v[144:147], v[44:47], a[224:227], v[144:147]
  ds_read_b64_tr_b16 v[68:69], v13 offset:40960
  v_accvgpr_write_b32 a24, 0
  v_mfma_f32_16x16x32_bf16 v[160:163], v[48:51], a[224:227], v[160:163]
  ds_read_b64_tr_b16 v[70:71], v13 offset:41984
  v_accvgpr_write_b32 a25, 0
  v_mfma_f32_16x16x32_bf16 v[176:179], v[52:55], a[224:227], v[176:179]
  ds_read_b64_tr_b16 v[72:73], v12 offset:41216
  v_accvgpr_write_b32 a26, 0
  v_mfma_f32_16x16x32_bf16 v[192:195], v[56:59], a[224:227], v[192:195]
  ds_read_b64_tr_b16 v[74:75], v12 offset:42240
  v_accvgpr_write_b32 a27, 0
  v_mfma_f32_16x16x32_bf16 v[208:211], v[60:63], a[224:227], v[208:211]
  buffer_load_dwordx4 a[224:227], v2, s[40:43], s64 offen offset:2048 sc1
  v_accvgpr_write_b32 a28, 0
  v_mfma_f32_16x16x32_bf16 v[100:103], v[32:35], a[228:231], v[100:103]
  ds_read_b64_tr_b16 v[76:77], v13 offset:41216
  v_accvgpr_write_b32 a29, 0
  v_mfma_f32_16x16x32_bf16 v[116:119], v[36:39], a[228:231], v[116:119]
  ds_read_b64_tr_b16 v[78:79], v13 offset:42240
  v_mfma_f32_16x16x32_bf16 v[132:135], v[40:43], a[228:231], v[132:135]
  ds_read_b64_tr_b16 v[80:81], v12 offset:41472
  v_mfma_f32_16x16x32_bf16 v[148:151], v[44:47], a[228:231], v[148:151]
  v_accvgpr_write_b32 a30, 0
  v_mfma_f32_16x16x32_bf16 v[164:167], v[48:51], a[228:231], v[164:167]
  ds_read_b64_tr_b16 v[82:83], v12 offset:42496
  v_mfma_f32_16x16x32_bf16 v[180:183], v[52:55], a[228:231], v[180:183]
  ds_read_b64_tr_b16 v[84:85], v13 offset:41472
  v_mfma_f32_16x16x32_bf16 v[196:199], v[56:59], a[228:231], v[196:199]
  ds_read_b64_tr_b16 v[86:87], v13 offset:42496
  v_mfma_f32_16x16x32_bf16 v[212:215], v[60:63], a[228:231], v[212:215]
  buffer_load_dwordx4 a[228:231], v2, s[40:43], s65 offen offset:2048 sc1
  v_mfma_f32_16x16x32_bf16 v[104:107], v[32:35], a[232:235], v[104:107]
  ds_read_b64_tr_b16 v[88:89], v12 offset:41728
  v_mfma_f32_16x16x32_bf16 v[120:123], v[36:39], a[232:235], v[120:123]
  ds_read_b64_tr_b16 v[90:91], v12 offset:42752
  v_mfma_f32_16x16x32_bf16 v[136:139], v[40:43], a[232:235], v[136:139]
  ds_read_b64_tr_b16 v[92:93], v13 offset:41728
  v_mfma_f32_16x16x32_bf16 v[152:155], v[44:47], a[232:235], v[152:155]
  v_accvgpr_write_b32 a31, 0
  v_mfma_f32_16x16x32_bf16 v[168:171], v[48:51], a[232:235], v[168:171]
  ds_read_b64_tr_b16 v[94:95], v13 offset:42752
  v_mfma_f32_16x16x32_bf16 v[184:187], v[52:55], a[232:235], v[184:187]
  v_accvgpr_write_b32 a32, 0
  v_mfma_f32_16x16x32_bf16 v[200:203], v[56:59], a[232:235], v[200:203]
  v_accvgpr_write_b32 a33, 0
  v_mfma_f32_16x16x32_bf16 v[216:219], v[60:63], a[232:235], v[216:219]
  buffer_load_dwordx4 a[232:235], v2, s[40:43], s66 offen offset:2048 sc1
  v_mfma_f32_16x16x32_bf16 v[108:111], v[32:35], a[236:239], v[108:111]
  v_xor_b32 v12, 0x10000, v12
  v_mfma_f32_16x16x32_bf16 v[124:127], v[36:39], a[236:239], v[124:127]
  v_accvgpr_write_b32 a34, 0
  v_mfma_f32_16x16x32_bf16 v[140:143], v[40:43], a[236:239], v[140:143]
  v_xor_b32 v13, 0x10000, v13
  v_mfma_f32_16x16x32_bf16 v[156:159], v[44:47], a[236:239], v[156:159]
  v_accvgpr_write_b32 a35, 0
  v_mfma_f32_16x16x32_bf16 v[172:175], v[48:51], a[236:239], v[172:175]
  v_accvgpr_write_b32 a36, 0
  v_mfma_f32_16x16x32_bf16 v[188:191], v[52:55], a[236:239], v[188:191]
  v_accvgpr_write_b32 a37, 0
  v_mfma_f32_16x16x32_bf16 v[204:207], v[56:59], a[236:239], v[204:207]
  v_accvgpr_write_b32 a38, 0
  v_mfma_f32_16x16x32_bf16 v[220:223], v[60:63], a[236:239], v[220:223]
  s_waitcnt vmcnt(11) lgkmcnt(0)
  buffer_load_dwordx4 a[236:239], v2, s[40:43], s67 offen offset:2048 sc1
  v_mfma_f32_16x16x32_bf16 v[96:99], v[64:67], a[240:243], v[96:99]
  s_barrier
  v_accvgpr_write_b32 a39, 0
  v_mfma_f32_16x16x32_bf16 v[112:115], v[68:71], a[240:243], v[112:115]
  ds_read_b64_tr_b16 v[32:33], v12 offset:0
  v_accvgpr_write_b32 a40, 0
  v_mfma_f32_16x16x32_bf16 v[128:131], v[72:75], a[240:243], v[128:131]
  ds_read_b64_tr_b16 v[34:35], v12 offset:1024
  v_accvgpr_write_b32 a41, 0
  v_mfma_f32_16x16x32_bf16 v[144:147], v[76:79], a[240:243], v[144:147]
  ds_read_b64_tr_b16 v[36:37], v13 offset:0
  v_accvgpr_write_b32 a42, 0
  v_mfma_f32_16x16x32_bf16 v[160:163], v[80:83], a[240:243], v[160:163]
  ds_read_b64_tr_b16 v[38:39], v13 offset:1024
  v_accvgpr_write_b32 a43, 0
  v_mfma_f32_16x16x32_bf16 v[176:179], v[84:87], a[240:243], v[176:179]
  ds_read_b64_tr_b16 v[40:41], v12 offset:256
  v_accvgpr_write_b32 a44, 0
  v_mfma_f32_16x16x32_bf16 v[192:195], v[88:91], a[240:243], v[192:195]
  ds_read_b64_tr_b16 v[42:43], v12 offset:1280
  v_accvgpr_write_b32 a45, 0
  v_mfma_f32_16x16x32_bf16 v[208:211], v[92:95], a[240:243], v[208:211]
  buffer_load_dwordx4 a[240:243], v2, s[40:43], s64 offen offset:3072 sc1
  v_mfma_f32_16x16x32_bf16 v[100:103], v[64:67], a[244:247], v[100:103]
  s_add_u32 s64, s64, 4096
  ds_read_b64_tr_b16 v[44:45], v13 offset:256
  v_mfma_f32_16x16x32_bf16 v[116:119], v[68:71], a[244:247], v[116:119]
  ds_read_b64_tr_b16 v[46:47], v13 offset:1280
  v_mfma_f32_16x16x32_bf16 v[132:135], v[72:75], a[244:247], v[132:135]
  ds_read_b64_tr_b16 v[48:49], v12 offset:512
  v_mfma_f32_16x16x32_bf16 v[148:151], v[76:79], a[244:247], v[148:151]
  buffer_store_dword v19, v18, s[40:43], 0 offen sc1
  v_accvgpr_write_b32 a46, 0
  v_mfma_f32_16x16x32_bf16 v[164:167], v[80:83], a[244:247], v[164:167]
  ds_read_b64_tr_b16 v[50:51], v12 offset:1536
  v_mfma_f32_16x16x32_bf16 v[180:183], v[84:87], a[244:247], v[180:183]
  ds_read_b64_tr_b16 v[52:53], v13 offset:512
  v_mfma_f32_16x16x32_bf16 v[196:199], v[88:91], a[244:247], v[196:199]
  ds_read_b64_tr_b16 v[54:55], v13 offset:1536
  v_mfma_f32_16x16x32_bf16 v[212:215], v[92:95], a[244:247], v[212:215]
  buffer_load_dwordx4 a[244:247], v2, s[40:43], s65 offen offset:3072 sc1
  v_mfma_f32_16x16x32_bf16 v[104:107], v[64:67], a[248:251], v[104:107]
  s_add_u32 s65, s65, 4096
  ds_read_b64_tr_b16 v[56:57], v12 offset:768
  v_mfma_f32_16x16x32_bf16 v[120:123], v[68:71], a[248:251], v[120:123]
  ds_read_b64_tr_b16 v[58:59], v12 offset:1792
  v_mfma_f32_16x16x32_bf16 v[136:139], v[72:75], a[248:251], v[136:139]
  ds_read_b64_tr_b16 v[60:61], v13 offset:768
  v_mfma_f32_16x16x32_bf16 v[152:155], v[76:79], a[248:251], v[152:155]
  v_accvgpr_write_b32 a47, 0
  v_mfma_f32_16x16x32_bf16 v[168:171], v[80:83], a[248:251], v[168:171]
  ds_read_b64_tr_b16 v[62:63], v13 offset:1792
  v_mfma_f32_16x16x32_bf16 v[184:187], v[84:87], a[248:251], v[184:187]
  v_accvgpr_write_b32 a48, 0
  v_mfma_f32_16x16x32_bf16 v[200:203], v[88:91], a[248:251], v[200:203]
  v_accvgpr_write_b32 a49, 0
  v_mfma_f32_16x16x32_bf16 v[216:219], v[92:95], a[248:251], v[216:219]
  buffer_load_dwordx4 a[248:251], v2, s[40:43], s66 offen offset:3072 sc1
  v_mfma_f32_16x16x32_bf16 v[108:111], v[64:67], a[252:255], v[108:111]
  s_add_u32 s66, s66, 4096
  v_accvgpr_write_b32 a50, 0
  v_mfma_f32_16x16x32_bf16 v[124:127], v[68:71], a[252:255], v[124:127]
  v_accvgpr_write_b32 a51, 0
  v_mfma_f32_16x16x32_bf16 v[140:143], v[72:75], a[252:255], v[140:143]
  v_accvgpr_write_b32 a52, 0
  v_mfma_f32_16x16x32_bf16 v[156:159], v[76:79], a[252:255], v[156:159]
  v_accvgpr_write_b32 a53, 0
  v_mfma_f32_16x16x32_bf16 v[172:175], v[80:83], a[252:255], v[172:175]
  v_accvgpr_write_b32 a54, 0
  v_mfma_f32_16x16x32_bf16 v[188:191], v[84:87], a[252:255], v[188:191]
  v_accvgpr_write_b32 a55, 0
  v_mfma_f32_16x16x32_bf16 v[204:207], v[88:91], a[252:255], v[204:207]
  v_accvgpr_write_b32 a56, 0
  v_mfma_f32_16x16x32_bf16 v[220:223], v[92:95], a[252:255], v[220:223]
  s_waitcnt vmcnt(12) lgkmcnt(0)
  buffer_load_dwordx4 a[252:255], v2, s[40:43], s67 offen offset:3072 sc1
  v_mfma_f32_16x16x32_bf16 v[96:99], v[32:35], a[192:195], v[96:99]
  v_accvgpr_write_b32 a57, 0
  v_mfma_f32_16x16x32_bf16 v[112:115], v[36:39], a[192:195], v[112:115]
  s_add_u32 s67, s67, 4096
  ds_read_b64_tr_b16 v[64:65], v12 offset:8192
  v_accvgpr_write_b32 a58, 0
  v_mfma_f32_16x16x32_bf16 v[128:131], v[40:43], a[192:195], v[128:131]
  ds_read_b64_tr_b16 v[66:67], v12 offset:9216
  v_accvgpr_write_b32 a59, 0
  v_mfma_f32_16x16x32_bf16 v[144:147], v[44:47], a[192:195], v[144:147]
  ds_read_b64_tr_b16 v[68:69], v13 offset:8192
  v_accvgpr_write_b32 a60, 0
  v_mfma_f32_16x16x32_bf16 v[160:163], v[48:51], a[192:195], v[160:163]
  ds_read_b64_tr_b16 v[70:71], v13 offset:9216
  v_mfma_f32_16x16x32_bf16 v[176:179], v[52:55], a[192:195], v[176:179]
  ds_read_b64_tr_b16 v[72:73], v12 offset:8448
  v_mfma_f32_16x16x32_bf16 v[192:195], v[56:59], a[192:195], v[192:195]
  ds_read_b64_tr_b16 v[74:75], v12 offset:9472
  v_mfma_f32_16x16x32_bf16 v[208:211], v[60:63], a[192:195], v[208:211]
  v_accvgpr_write_b32 a61, 0
  v_mfma_f32_16x16x32_bf16 v[100:103], v[32:35], a[196:199], v[100:103]
  ds_read_b64_tr_b16 v[76:77], v13 offset:8448
  v_mfma_f32_16x16x32_bf16 v[116:119], v[36:39], a[196:199], v[116:119]
  ds_read_b64_tr_b16 v[78:79], v13 offset:9472
  v_mfma_f32_16x16x32_bf16 v[132:135], v[40:43], a[196:199], v[132:135]
  ds_read_b64_tr_b16 v[80:81], v12 offset:8704
  v_mfma_f32_16x16x32_bf16 v[148:151], v[44:47], a[196:199], v[148:151]
  v_accvgpr_write_b32 a62, 0
  v_mfma_f32_16x16x32_bf16 v[164:167], v[48:51], a[196:199], v[164:167]
  ds_read_b64_tr_b16 v[82:83], v12 offset:9728
  v_mfma_f32_16x16x32_bf16 v[180:183], v[52:55], a[196:199], v[180:183]
  ds_read_b64_tr_b16 v[84:85], v13 offset:8704
  v_mfma_f32_16x16x32_bf16 v[196:199], v[56:59], a[196:199], v[196:199]
  ds_read_b64_tr_b16 v[86:87], v13 offset:9728
  v_mfma_f32_16x16x32_bf16 v[212:215], v[60:63], a[196:199], v[212:215]
  v_accvgpr_write_b32 a63, 0
  v_mfma_f32_16x16x32_bf16 v[104:107], v[32:35], a[200:203], v[104:107]
  ds_read_b64_tr_b16 v[88:89], v12 offset:8960
  v_mfma_f32_16x16x32_bf16 v[120:123], v[36:39], a[200:203], v[120:123]
  ds_read_b64_tr_b16 v[90:91], v12 offset:9984
  v_mfma_f32_16x16x32_bf16 v[136:139], v[40:43], a[200:203], v[136:139]
  ds_read_b64_tr_b16 v[92:93], v13 offset:8960
  v_mfma_f32_16x16x32_bf16 v[152:155], v[44:47], a[200:203], v[152:155]
  v_accvgpr_write_b32 a64, 0
  v_mfma_f32_16x16x32_bf16 v[168:171], v[48:51], a[200:203], v[168:171]
  ds_read_b64_tr_b16 v[94:95], v13 offset:9984
  v_mfma_f32_16x16x32_bf16 v[184:187], v[52:55], a[200:203], v[184:187]
  v_accvgpr_write_b32 a65, 0
  v_mfma_f32_16x16x32_bf16 v[200:203], v[56:59], a[200:203], v[200:203]
  v_accvgpr_write_b32 a66, 0
  v_mfma_f32_16x16x32_bf16 v[216:219], v[60:63], a[200:203], v[216:219]
  v_accvgpr_write_b32 a67, 0
  v_mfma_f32_16x16x32_bf16 v[108:111], v[32:35], a[204:207], v[108:111]
  v_accvgpr_write_b32 a68, 0
  v_mfma_f32_16x16x32_bf16 v[124:127], v[36:39], a[204:207], v[124:127]
  v_accvgpr_write_b32 a69, 0
  v_mfma_f32_16x16x32_bf16 v[140:143], v[40:43], a[204:207], v[140:143]
  v_accvgpr_write_b32 a70, 0
  v_mfma_f32_16x16x32_bf16 v[156:159], v[44:47], a[204:207], v[156:159]
  v_accvgpr_write_b32 a71, 0
  v_mfma_f32_16x16x32_bf16 v[172:175], v[48:51], a[204:207], v[172:175]
  v_accvgpr_write_b32 a72, 0
  v_mfma_f32_16x16x32_bf16 v[188:191], v[52:55], a[204:207], v[188:191]
  v_accvgpr_write_b32 a73, 0
  v_mfma_f32_16x16x32_bf16 v[204:207], v[56:59], a[204:207], v[204:207]
  v_accvgpr_write_b32 a74, 0
  v_mfma_f32_16x16x32_bf16 v[220:223], v[60:63], a[204:207], v[220:223]
  s_waitcnt vmcnt(9) lgkmcnt(0)
  v_mfma_f32_16x16x32_bf16 v[96:99], v[64:67], a[208:211], v[96:99]
  s_barrier
  v_accvgpr_write_b32 a75, 0
  v_mfma_f32_16x16x32_bf16 v[112:115], v[68:71], a[208:211], v[112:115]
  ds_read_b64_tr_b16 v[32:33], v12 offset:32768
  v_accvgpr_write_b32 a76, 0
  v_mfma_f32_16x16x32_bf16 v[128:131], v[72:75], a[208:211], v[128:131]
  ds_read_b64_tr_b16 v[34:35], v12 offset:33792
  v_accvgpr_write_b32 a77, 0
  v_mfma_f32_16x16x32_bf16 v[144:147], v[76:79], a[208:211], v[144:147]
  ds_read_b64_tr_b16 v[36:37], v13 offset:32768
  v_accvgpr_write_b32 a78, 0
  v_mfma_f32_16x16x32_bf16 v[160:163], v[80:83], a[208:211], v[160:163]
  ds_read_b64_tr_b16 v[38:39], v13 offset:33792
  v_mfma_f32_16x16x32_bf16 v[176:179], v[84:87], a[208:211], v[176:179]
  ds_read_b64_tr_b16 v[40:41], v12 offset:33024
  v_mfma_f32_16x16x32_bf16 v[192:195], v[88:91], a[208:211], v[192:195]
  ds_read_b64_tr_b16 v[42:43], v12 offset:34048
  v_mfma_f32_16x16x32_bf16 v[208:211], v[92:95], a[208:211], v[208:211]
  v_accvgpr_write_b32 a79, 0
  v_mfma_f32_16x16x32_bf16 v[100:103], v[64:67], a[212:215], v[100:103]
  ds_read_b64_tr_b16 v[44:45], v13 offset:33024
  v_mfma_f32_16x16x32_bf16 v[116:119], v[68:71], a[212:215], v[116:119]
  ds_read_b64_tr_b16 v[46:47], v13 offset:34048
  v_mfma_f32_16x16x32_bf16 v[132:135], v[72:75], a[212:215], v[132:135]
  ds_read_b64_tr_b16 v[48:49], v12 offset:33280
  v_mfma_f32_16x16x32_bf16 v[148:151], v[76:79], a[212:215], v[148:151]
  v_accvgpr_write_b32 a80, 0
  v_mfma_f32_16x16x32_bf16 v[164:167], v[80:83], a[212:215], v[164:167]
  ds_read_b64_tr_b16 v[50:51], v12 offset:34304
  v_mfma_f32_16x16x32_bf16 v[180:183], v[84:87], a[212:215], v[180:183]
  ds_read_b64_tr_b16 v[52:53], v13 offset:33280
  v_mfma_f32_16x16x32_bf16 v[196:199], v[88:91], a[212:215], v[196:199]
  ds_read_b64_tr_b16 v[54:55], v13 offset:34304
  v_mfma_f32_16x16x32_bf16 v[212:215], v[92:95], a[212:215], v[212:215]
  v_accvgpr_write_b32 a81, 0
  v_mfma_f32_16x16x32_bf16 v[104:107], v[64:67], a[216:219], v[104:107]
  ds_read_b64_tr_b16 v[56:57], v12 offset:33536
  v_mfma_f32_16x16x32_bf16 v[120:123], v[68:71], a[216:219], v[120:123]
  ds_read_b64_tr_b16 v[58:59], v12 offset:34560
  v_mfma_f32_16x16x32_bf16 v[136:139], v[72:75], a[216:219], v[136:139]
  ds_read_b64_tr_b16 v[60:61], v13 offset:33536
  v_mfma_f32_16x16x32_bf16 v[152:155], v[76:79], a[216:219], v[152:155]
  v_accvgpr_write_b32 a82, 0
  v_mfma_f32_16x16x32_bf16 v[168:171], v[80:83], a[216:219], v[168:171]
  ds_read_b64_tr_b16 v[62:63], v13 offset:34560
  v_mfma_f32_16x16x32_bf16 v[184:187], v[84:87], a[216:219], v[184:187]
  buffer_load_dword v228, v230, s[40:43], 0 offen sc1
  v_accvgpr_write_b32 a83, 0
  v_mfma_f32_16x16x32_bf16 v[200:203], v[88:91], a[216:219], v[200:203]
  v_accvgpr_write_b32 a84, 0
  v_mfma_f32_16x16x32_bf16 v[216:219], v[92:95], a[216:219], v[216:219]
  v_accvgpr_write_b32 a85, 0
  v_mfma_f32_16x16x32_bf16 v[108:111], v[64:67], a[220:223], v[108:111]
  v_accvgpr_write_b32 a86, 0
  v_mfma_f32_16x16x32_bf16 v[124:127], v[68:71], a[220:223], v[124:127]
  v_accvgpr_write_b32 a87, 0
  v_mfma_f32_16x16x32_bf16 v[140:143], v[72:75], a[220:223], v[140:143]
  v_accvgpr_write_b32 a88, 0
  v_mfma_f32_16x16x32_bf16 v[156:159], v[76:79], a[220:223], v[156:159]
  v_accvgpr_write_b32 a89, 0
  v_mfma_f32_16x16x32_bf16 v[172:175], v[80:83], a[220:223], v[172:175]
  v_accvgpr_write_b32 a90, 0
  v_mfma_f32_16x16x32_bf16 v[188:191], v[84:87], a[220:223], v[188:191]
  v_accvgpr_write_b32 a91, 0
  v_mfma_f32_16x16x32_bf16 v[204:207], v[88:91], a[220:223], v[204:207]
  v_accvgpr_write_b32 a92, 0
  v_mfma_f32_16x16x32_bf16 v[220:223], v[92:95], a[220:223], v[220:223]
  s_waitcnt vmcnt(6) lgkmcnt(0)
  v_mfma_f32_16x16x32_bf16 v[96:99], v[32:35], a[224:227], v[96:99]
  v_accvgpr_write_b32 a93, 0
  v_mfma_f32_16x16x32_bf16 v[112:115], v[36:39], a[224:227], v[112:115]
  ds_read_b64_tr_b16 v[64:65], v12 offset:40960
  v_accvgpr_write_b32 a94, 0
  v_mfma_f32_16x16x32_bf16 v[128:131], v[40:43], a[224:227], v[128:131]
  ds_read_b64_tr_b16 v[66:67], v12 offset:41984
  v_accvgpr_write_b32 a95, 0
  v_mfma_f32_16x16x32_bf16 v[144:147], v[44:47], a[224:227], v[144:147]
  ds_read_b64_tr_b16 v[68:69], v13 offset:40960
  v_accvgpr_write_b32 a96, 0
  v_mfma_f32_16x16x32_bf16 v[160:163], v[48:51], a[224:227], v[160:163]
  ds_read_b64_tr_b16 v[70:71], v13 offset:41984
  v_accvgpr_write_b32 a97, 0
  v_mfma_f32_16x16x32_bf16 v[176:179], v[52:55], a[224:227], v[176:179]
  ds_read_b64_tr_b16 v[72:73], v12 offset:41216
  v_accvgpr_write_b32 a98, 0
  v_mfma_f32_16x16x32_bf16 v[192:195], v[56:59], a[224:227], v[192:195]
  ds_read_b64_tr_b16 v[74:75], v12 offset:42240
  v_mfma_f32_16x16x32_bf16 v[208:211], v[60:63], a[224:227], v[208:211]
  v_accvgpr_write_b32 a99, 0
  v_mfma_f32_16x16x32_bf16 v[100:103], v[32:35], a[228:231], v[100:103]
  ds_read_b64_tr_b16 v[76:77], v13 offset:41216
  v_mfma_f32_16x16x32_bf16 v[116:119], v[36:39], a[228:231], v[116:119]
  ds_read_b64_tr_b16 v[78:79], v13 offset:42240
  v_mfma_f32_16x16x32_bf16 v[132:135], v[40:43], a[228:231], v[132:135]
  ds_read_b64_tr_b16 v[80:81], v12 offset:41472
  v_mfma_f32_16x16x32_bf16 v[148:151], v[44:47], a[228:231], v[148:151]
  v_accvgpr_write_b32 a100, 0
  v_mfma_f32_16x16x32_bf16 v[164:167], v[48:51], a[228:231], v[164:167]
  ds_read_b64_tr_b16 v[82:83], v12 offset:42496
  v_mfma_f32_16x16x32_bf16 v[180:183], v[52:55], a[228:231], v[180:183]
  ds_read_b64_tr_b16 v[84:85], v13 offset:41472
  v_mfma_f32_16x16x32_bf16 v[196:199], v[56:59], a[228:231], v[196:199]
  ds_read_b64_tr_b16 v[86:87], v13 offset:42496
  v_mfma_f32_16x16x32_bf16 v[212:215], v[60:63], a[228:231], v[212:215]
  v_accvgpr_write_b32 a101, 0
  v_mfma_f32_16x16x32_bf16 v[104:107], v[32:35], a[232:235], v[104:107]
  ds_read_b64_tr_b16 v[88:89], v12 offset:41728
  v_mfma_f32_16x16x32_bf16 v[120:123], v[36:39], a[232:235], v[120:123]
  ds_read_b64_tr_b16 v[90:91], v12 offset:42752
  v_mfma_f32_16x16x32_bf16 v[136:139], v[40:43], a[232:235], v[136:139]
  ds_read_b64_tr_b16 v[92:93], v13 offset:41728
  v_mfma_f32_16x16x32_bf16 v[152:155], v[44:47], a[232:235], v[152:155]
  v_accvgpr_write_b32 a102, 0
  v_mfma_f32_16x16x32_bf16 v[168:171], v[48:51], a[232:235], v[168:171]
  ds_read_b64_tr_b16 v[94:95], v13 offset:42752
  v_mfma_f32_16x16x32_bf16 v[184:187], v[52:55], a[232:235], v[184:187]
  v_accvgpr_write_b32 a103, 0
  v_mfma_f32_16x16x32_bf16 v[200:203], v[56:59], a[232:235], v[200:203]
  v_accvgpr_write_b32 a104, 0
  v_mfma_f32_16x16x32_bf16 v[216:219], v[60:63], a[232:235], v[216:219]
  v_accvgpr_write_b32 a105, 0
  v_mfma_f32_16x16x32_bf16 v[108:111], v[32:35], a[236:239], v[108:111]
  v_xor_b32 v12, 0x10000, v12
  v_mfma_f32_16x16x32_bf16 v[124:127], v[36:39], a[236:239], v[124:127]
  v_accvgpr_write_b32 a106, 0
  v_mfma_f32_16x16x32_bf16 v[140:143], v[40:43], a[236:239], v[140:143]
  v_xor_b32 v13, 0x10000, v13
  v_mfma_f32_16x16x32_bf16 v[156:159], v[44:47], a[236:239], v[156:159]
  v_accvgpr_write_b32 a107, 0
  v_mfma_f32_16x16x32_bf16 v[172:175], v[48:51], a[236:239], v[172:175]
  v_accvgpr_write_b32 a108, 0
  v_mfma_f32_16x16x32_bf16 v[188:191], v[52:55], a[236:239], v[188:191]
  v_accvgpr_write_b32 a109, 0
  v_mfma_f32_16x16x32_bf16 v[204:207], v[56:59], a[236:239], v[204:207]
  v_accvgpr_write_b32 a110, 0
  v_mfma_f32_16x16x32_bf16 v[220:223], v[60:63], a[236:239], v[220:223]
  s_waitcnt vmcnt(1) lgkmcnt(0)
  v_mfma_f32_16x16x32_bf16 v[96:99], v[64:67], a[240:243], v[96:99]
  s_barrier
  v_accvgpr_write_b32 a111, 0
  v_mfma_f32_16x16x32_bf16 v[112:115], v[68:71], a[240:243], v[112:115]
  v_accvgpr_write_b32 a112, 0
  v_mfma_f32_16x16x32_bf16 v[128:131], v[72:75], a[240:243], v[128:131]
  v_accvgpr_write_b32 a113, 0
  v_mfma_f32_16x16x32_bf16 v[144:147], v[76:79], a[240:243], v[144:147]
  v_accvgpr_write_b32 a114, 0
  v_mfma_f32_16x16x32_bf16 v[160:163], v[80:83], a[240:243], v[160:163]
  v_accvgpr_write_b32 a115, 0
  v_mfma_f32_16x16x32_bf16 v[176:179], v[84:87], a[240:243], v[176:179]
  v_accvgpr_write_b32 a116, 0
  v_mfma_f32_16x16x32_bf16 v[192:195], v[88:91], a[240:243], v[192:195]
  v_accvgpr_write_b32 a117, 0
  v_mfma_f32_16x16x32_bf16 v[208:211], v[92:95], a[240:243], v[208:211]
  v_accvgpr_write_b32 a118, 0
  v_mfma_f32_16x16x32_bf16 v[100:103], v[64:67], a[244:247], v[100:103]
  v_accvgpr_write_b32 a119, 0
  v_mfma_f32_16x16x32_bf16 v[116:119], v[68:71], a[244:247], v[116:119]
  v_accvgpr_write_b32 a120, 0
  v_mfma_f32_16x16x32_bf16 v[132:135], v[72:75], a[244:247], v[132:135]
  v_accvgpr_write_b32 a121, 0
  v_mfma_f32_16x16x32_bf16 v[148:151], v[76:79], a[244:247], v[148:151]
  v_accvgpr_write_b32 a122, 0
  v_mfma_f32_16x16x32_bf16 v[164:167], v[80:83], a[244:247], v[164:167]
  v_accvgpr_write_b32 a123, 0
  v_mfma_f32_16x16x32_bf16 v[180:183], v[84:87], a[244:247], v[180:183]
  v_accvgpr_write_b32 a124, 0
  v_mfma_f32_16x16x32_bf16 v[196:199], v[88:91], a[244:247], v[196:199]
  v_accvgpr_write_b32 a125, 0
  v_mfma_f32_16x16x32_bf16 v[212:215], v[92:95], a[244:247], v[212:215]
  v_accvgpr_write_b32 a126, 0
  v_mfma_f32_16x16x32_bf16 v[104:107], v[64:67], a[248:251], v[104:107]
  v_accvgpr_write_b32 a127, 0
  v_mfma_f32_16x16x32_bf16 v[120:123], v[68:71], a[248:251], v[120:123]
  v_mfma_f32_16x16x32_bf16 v[136:139], v[72:75], a[248:251], v[136:139]
  v_mfma_f32_16x16x32_bf16 v[152:155], v[76:79], a[248:251], v[152:155]
  v_mfma_f32_16x16x32_bf16 v[168:171], v[80:83], a[248:251], v[168:171]
  v_mfma_f32_16x16x32_bf16 v[184:187], v[84:87], a[248:251], v[184:187]
  v_mfma_f32_16x16x32_bf16 v[200:203], v[88:91], a[248:251], v[200:203]
  v_mfma_f32_16x16x32_bf16 v[216:219], v[92:95], a[248:251], v[216:219]
  v_mfma_f32_16x16x32_bf16 v[108:111], v[64:67], a[252:255], v[108:111]
  v_mfma_f32_16x16x32_bf16 v[124:127], v[68:71], a[252:255], v[124:127]
  v_mfma_f32_16x16x32_bf16 v[140:143], v[72:75], a[252:255], v[140:143]
  v_mfma_f32_16x16x32_bf16 v[156:159], v[76:79], a[252:255], v[156:159]
  v_mfma_f32_16x16x32_bf16 v[172:175], v[80:83], a[252:255], v[172:175]
  v_mfma_f32_16x16x32_bf16 v[188:191], v[84:87], a[252:255], v[188:191]
  v_mfma_f32_16x16x32_bf16 v[204:207], v[88:91], a[252:255], v[204:207]
  v_mfma_f32_16x16x32_bf16 v[220:223], v[92:95], a[252:255], v[220:223]
  s_and_b32 s23, s20, 1
  s_lshl_b32 s23, s23, 12
  s_cmp_lt_u32 s20, 2
  s_cselect_b32 s24, 106496, 0
  s_add_u32 s24, s24, s23
  s_lshl_b32 s26, s20, 12
  s_mov_b32 s27, s26
  s_add_u32 s25, s27, 49152
  s_waitcnt vmcnt(0)
  v_cmp_eq_u32 vcc, 0, v228
  s_cbranch_vccnz fa_kv_spin
fa_kv_ok:
  s_load_dwordx4 s[4:7], s[0:1], 64
  s_load_dwordx2 s[8:9], s[0:1], 80
  s_mov_b32 m0, s24
  s_nop 0
  buffer_load_dwordx4 v2, s[44:47], s26 offen offset:0 sc1 lds
  buffer_load_dwordx4 v2, s[44:47], s26 offen offset:1024 sc1 lds
  buffer_load_dwordx4 v2, s[44:47], s26 offen offset:2048 sc1 lds
  buffer_load_dwordx4 v2, s[44:47], s26 offen offset:3072 sc1 lds
  s_add_u32 s26, s26, 16384
  s_add_u32 s24, s24, 32768
  s_and_b32 s24, s24, 0x1ffff
  s_mov_b32 m0, s24
  s_nop 0
  buffer_load_dwordx4 v2, s[44:47], s26 offen offset:0 sc1 lds
  buffer_load_dwordx4 v2, s[44:47], s26 offen offset:1024 sc1 lds
  buffer_load_dwordx4 v2, s[44:47], s26 offen offset:2048 sc1 lds
  buffer_load_dwordx4 v2, s[44:47], s26 offen offset:3072 sc1 lds
  s_add_u32 s26, s26, 16384
  s_add_u32 s24, s24, 32768
  s_and_b32 s24, s24, 0x1ffff
  s_mov_b32 m0, s24
  s_nop 0
  buffer_load_dwordx4 v2, s[44:47], s26 offen offset:0 sc1 lds
  buffer_load_dwordx4 v2, s[44:47], s26 offen offset:1024 sc1 lds
  buffer_load_dwordx4 v2, s[44:47], s26 offen offset:2048 sc1 lds
  buffer_load_dwordx4 v2, s[44:47], s26 offen offset:3072 sc1 lds
  s_add_u32 s26, s26, 16384
  s_add_u32 s24, s24, 32768
  s_and_b32 s24, s24, 0x1ffff
  s_mov_b32 m0, s25
  s_nop 0
  buffer_load_dwordx4 v2, s[48:51], s27 offen offset:0 sc1 lds
  buffer_load_dwordx4 v2, s[48:51], s27 offen offset:1024 sc1 lds
  buffer_load_dwordx4 v2, s[48:51], s27 offen offset:2048 sc1 lds
  buffer_load_dwordx4 v2, s[48:51], s27 offen offset:3072 sc1 lds
  s_add_u32 s27, s27, 16384
  s_add_u32 s25, s25, 32768
  s_and_b32 s25, s25, 0x1ffff
  s_mov_b32 m0, s25
  s_nop 0
  buffer_load_dwordx4 v2, s[48:51], s27 offen offset:0 sc1 lds
  buffer_load_dwordx4 v2, s[48:51], s27 offen offset:1024 sc1 lds
  buffer_load_dwordx4 v2, s[48:51], s27 offen offset:2048 sc1 lds
  buffer_load_dwordx4 v2, s[48:51], s27 offen offset:3072 sc1 lds
  s_add_u32 s27, s27, 16384
  s_add_u32 s25, s25, 32768
  s_and_b32 s25, s25, 0x1ffff
  s_cmp_eq_u32 s2, 255
  s_cbranch_scc1 fa_top8
fa_notop:
  v_mov_b32 v16, 0x3e0293ee
  v_mov_b32 v17, 0x3e0293ee
  v_pk_mul_f32 v[96:97], v[96:97], v[16:17]
  v_pk_mul_f32 v[98:99], v[98:99], v[16:17]
  v_cvt_pk_bf16_f32 v32, v96, v97
  v_cvt_pk_bf16_f32 v33, v98, v99
  v_pk_mul_f32 v[112:113], v[112:113], v[16:17]
  v_pk_mul_f32 v[114:115], v[114:115], v[16:17]
  v_cvt_pk_bf16_f32 v34, v112, v113
  v_cvt_pk_bf16_f32 v35, v114, v115
  v_pk_mul_f32 v[100:101], v[100:101], v[16:17]
  v_pk_mul_f32 v[102:103], v[102:103], v[16:17]
  v_cvt_pk_bf16_f32 v36, v100, v101
  v_cvt_pk_bf16_f32 v37, v102, v103
  v_pk_mul_f32 v[116:117], v[116:117], v[16:17]
  v_pk_mul_f32 v[118:119], v[118:119], v[16:17]
  v_cvt_pk_bf16_f32 v38, v116, v117
  v_cvt_pk_bf16_f32 v39, v118, v119
  v_pk_mul_f32 v[128:129], v[128:129], v[16:17]
  v_pk_mul_f32 v[130:131], v[130:131], v[16:17]
  v_cvt_pk_bf16_f32 v40, v128, v129
  v_cvt_pk_bf16_f32 v41, v130, v131
  v_pk_mul_f32 v[144:145], v[144:145], v[16:17]
  v_pk_mul_f32 v[146:147], v[146:147], v[16:17]
  v_cvt_pk_bf16_f32 v42, v144, v145
  v_cvt_pk_bf16_f32 v43, v146, v147
  v_pk_mul_f32 v[132:133], v[132:133], v[16:17]
  v_pk_mul_f32 v[134:135], v[134:135], v[16:17]
  v_cvt_pk_bf16_f32 v44, v132, v133
  v_cvt_pk_bf16_f32 v45, v134, v135
  v_pk_mul_f32 v[148:149], v[148:149], v[16:17]
  v_pk_mul_f32 v[150:151], v[150:151], v[16:17]
  v_cvt_pk_bf16_f32 v46, v148, v149
  v_cvt_pk_bf16_f32 v47, v150, v151
  v_pk_mul_f32 v[160:161], v[160:161], v[16:17]
  v_pk_mul_f32 v[162:163], v[162:163], v[16:17]
  v_cvt_pk_bf16_f32 v48, v160, v161
  v_cvt_pk_bf16_f32 v49, v162, v163
  v_pk_mul_f32 v[176:177], v[176:177], v[16:17]
  v_pk_mul_f32 v[178:179], v[178:179], v[16:17]
  v_cvt_pk_bf16_f32 v50, v176, v177
  v_cvt_pk_bf16_f32 v51, v178, v179
  v_pk_mul_f32 v[164:165], v[164:165], v[16:17]
  v_pk_mul_f32 v[166:167], v[166:167], v[16:17]
  v_cvt_pk_bf16_f32 v52, v164, v165
  v_cvt_pk_bf16_f32 v53, v166, v167
  v_pk_mul_f32 v[180:181], v[180:181], v[16:17]
  v_pk_mul_f32 v[182:183], v[182:183], v[16:17]
  v_cvt_pk_bf16_f32 v54, v180, v181
  v_cvt_pk_bf16_f32 v55, v182, v183
  v_pk_mul_f32 v[192:193], v[192:193], v[16:17]
  v_pk_mul_f32 v[194:195], v[194:195], v[16:17]
  v_cvt_pk_bf16_f32 v56, v192, v193
  v_cvt_pk_bf16_f32 v57, v194, v195
  v_pk_mul_f32 v[208:209], v[208:209], v[16:17]
  v_pk_mul_f32 v[210:211], v[210:211], v[16:17]
  v_cvt_pk_bf16_f32 v58, v208, v209
  v_cvt_pk_bf16_f32 v59, v210, v211
  v_pk_mul_f32 v[196:197], v[196:197], v[16:17]
  v_pk_mul_f32 v[198:199], v[198:199], v[16:17]
  v_cvt_pk_bf16_f32 v60, v196, v197
  v_cvt_pk_bf16_f32 v61, v198, v199
  v_pk_mul_f32 v[212:213], v[212:213], v[16:17]
  v_pk_mul_f32 v[214:215], v[214:215], v[16:17]
  v_cvt_pk_bf16_f32 v62, v212, v213
  v_cvt_pk_bf16_f32 v63, v214, v215
  s_and_b32 s62, s2, 1
  s_lshl_b32 s62, s62, 2
  s_add_u32 s62, s62, s20
  s_lshr_b32 s63, s2, 1
  s_mul_i32 s23, s63, 40960
  s_mul_i32 s31, s62, 160
  s_add_u32 s23, s23, s31
  s_mul_i32 s34, s20, 5120
  s_add_u32 s34, s34, 131072
  v_add_u32 v20, 0, v1
  v_mul_u32_u24 v19, 6554, v20
  s_add_u32 m0, s34, 0
  v_lshrrev_b32 v19, 16, v19
  v_mul_u32_u24 v19, 1120, v19
  v_lshl_add_u32 v19, v20, 4, v19
  buffer_load_dwordx4 v19, s[52:55], s23 offen lds
  v_add_u32 v20, 64, v1
  v_mul_u32_u24 v19, 6554, v20
  s_add_u32 m0, s34, 1024
  v_lshrrev_b32 v19, 16, v19
  v_mul_u32_u24 v19, 1120, v19
  v_lshl_add_u32 v19, v20, 4, v19
  buffer_load_dwordx4 v19, s[52:55], s23 offen lds
  v_add_u32 v20, 128, v1
  v_mul_u32_u24 v19, 6554, v20
  s_add_u32 m0, s34, 2048
  v_lshrrev_b32 v19, 16, v19
  v_mul_u32_u24 v19, 1120, v19
  v_lshl_add_u32 v19, v20, 4, v19
  buffer_load_dwordx4 v19, s[52:55], s23 offen lds
  v_add_u32 v20, 192, v1
  v_mul_u32_u24 v19, 6554, v20
  s_add_u32 m0, s34, 3072
  v_lshrrev_b32 v19, 16, v19
  v_mul_u32_u24 v19, 1120, v19
  v_lshl_add_u32 v19, v20, 4, v19
  buffer_load_dwordx4 v19, s[52:55], s23 offen lds
  v_add_u32 v20, 256, v1
  v_mul_u32_u24 v19, 6554, v20
  s_add_u32 m0, s34, 4096
  v_lshrrev_b32 v19, 16, v19
  v_mul_u32_u24 v19, 1120, v19
  v_lshl_add_u32 v19, v20, 4, v19
  buffer_load_dwordx4 v19, s[52:55], s23 offen lds
  v_lshrrev_b32 v6, 2, v1
  v_mul_u32_u24 v6, 160, v6
  v_and_b32 v19, 3, v1
  v_lshl_add_u32 v6, v19, 3, v6
  v_add_u32 v6, s34, v6
  s_lshl_b32 s30, s62, 7
  s_add_u32 s30, s30, s63
  s_mul_i32 s30, s30, 5120
  s_add_u32 s30, s30, 4194304
  s_waitcnt lgkmcnt(0)
  s_cmp_ge_u32 s20, 2
  s_cselect_b32 s4, s6, s4
  s_cselect_b32 s5, s7, s5
  s_mov_b32 s52, s4
  s_mov_b32 s53, s5
  s_mov_b32 s54, 2211840
  s_mov_b32 s55, 0x20000
  s_mov_b32 s60, s8
  s_mov_b32 s61, s9
  s_mov_b32 s62, 2211840
  s_mov_b32 s63, 0x20000
  v_pk_mul_f32 v[104:105], v[104:105], v[16:17]
  v_pk_mul_f32 v[106:107], v[106:107], v[16:17]
  v_cvt_pk_bf16_f32 v64, v104, v105
  v_cvt_pk_bf16_f32 v65, v106, v107
  v_pk_mul_f32 v[120:121], v[120:121], v[16:17]
  v_pk_mul_f32 v[122:123], v[122:123], v[16:17]
  v_cvt_pk_bf16_f32 v66, v120, v121
  v_cvt_pk_bf16_f32 v67, v122, v123
  v_pk_mul_f32 v[108:109], v[108:109], v[16:17]
  v_pk_mul_f32 v[110:111], v[110:111], v[16:17]
  v_cvt_pk_bf16_f32 v68, v108, v109
  v_cvt_pk_bf16_f32 v69, v110, v111
  v_pk_mul_f32 v[124:125], v[124:125], v[16:17]
  v_pk_mul_f32 v[126:127], v[126:127], v[16:17]
  v_cvt_pk_bf16_f32 v70, v124, v125
  v_cvt_pk_bf16_f32 v71, v126, v127
  v_pk_mul_f32 v[136:137], v[136:137], v[16:17]
  v_pk_mul_f32 v[138:139], v[138:139], v[16:17]
  v_cvt_pk_bf16_f32 v72, v136, v137
  v_cvt_pk_bf16_f32 v73, v138, v139
  v_pk_mul_f32 v[152:153], v[152:153], v[16:17]
  v_pk_mul_f32 v[154:155], v[154:155], v[16:17]
  v_cvt_pk_bf16_f32 v74, v152, v153
  v_cvt_pk_bf16_f32 v75, v154, v155
  v_pk_mul_f32 v[140:141], v[140:141], v[16:17]
  v_pk_mul_f32 v[142:143], v[142:143], v[16:17]
  v_cvt_pk_bf16_f32 v76, v140, v141
  v_cvt_pk_bf16_f32 v77, v142, v143
  v_pk_mul_f32 v[156:157], v[156:157], v[16:17]
  v_pk_mul_f32 v[158:159], v[158:159], v[16:17]
  v_cvt_pk_bf16_f32 v78, v156, v157
  v_cvt_pk_bf16_f32 v79, v158, v159
  v_pk_mul_f32 v[168:169], v[168:169], v[16:17]
  v_pk_mul_f32 v[170:171], v[170:171], v[16:17]
  v_cvt_pk_bf16_f32 v80, v168, v169
  v_cvt_pk_bf16_f32 v81, v170, v171
  v_pk_mul_f32 v[184:185], v[184:185], v[16:17]
  v_pk_mul_f32 v[186:187], v[186:187], v[16:17]
  v_cvt_pk_bf16_f32 v82, v184, v185
  v_cvt_pk_bf16_f32 v83, v186, v187
  v_pk_mul_f32 v[172:173], v[172:173], v[16:17]
  v_pk_mul_f32 v[174:175], v[174:175], v[16:17]
  v_cvt_pk_bf16_f32 v84, v172, v173
  v_cvt_pk_bf16_f32 v85, v174, v175
  v_pk_mul_f32 v[188:189], v[188:189], v[16:17]
  v_pk_mul_f32 v[190:191], v[190:191], v[16:17]
  v_cvt_pk_bf16_f32 v86, v188, v189
  v_cvt_pk_bf16_f32 v87, v190, v191
  v_pk_mul_f32 v[200:201], v[200:201], v[16:17]
  v_pk_mul_f32 v[202:203], v[202:203], v[16:17]
  v_cvt_pk_bf16_f32 v88, v200, v201
  v_cvt_pk_bf16_f32 v89, v202, v203
  v_pk_mul_f32 v[216:217], v[216:217], v[16:17]
  v_pk_mul_f32 v[218:219], v[218:219], v[16:17]
  v_cvt_pk_bf16_f32 v90, v216, v217
  v_cvt_pk_bf16_f32 v91, v218, v219
  v_pk_mul_f32 v[204:205], v[204:205], v[16:17]
  v_pk_mul_f32 v[206:207], v[206:207], v[16:17]
  v_cvt_pk_bf16_f32 v92, v204, v205
  v_cvt_pk_bf16_f32 v93, v206, v207
  v_pk_mul_f32 v[220:221], v[220:221], v[16:17]
  v_pk_mul_f32 v[222:223], v[222:223], v[16:17]
  v_cvt_pk_bf16_f32 v94, v220, v221
  v_cvt_pk_bf16_f32 v95, v222, v223
  v_mov_b32 v228, 0
  v_mov_b32 v229, 0
  v_mov_b32 v230, 0
  v_mov_b32 v231, 0
  s_add_u32 s23, s20, 1
  s_lshr_b32 s23, s23, 1
  s_lshl_b32 s28, s22, 1
  s_add_u32 s28, s28, s23
  s_lshl_b32 s23, s22, 2
  s_sub_u32 s29, 28, s23
  s_and_b32 s23, s20, 1
  s_add_u32 s29, s29, s23
  v_mov_b32 v3, v2
  v_add_u32 v18, 106496, v2
  s_waitcnt vmcnt(17)
  s_barrier
  ds_read_b128 a[128:131], v18 offset:0
  ds_read_b128 a[132:135], v18 offset:1024
  ds_read_b128 a[136:139], v18 offset:2048
  ds_read_b128 a[140:143], v18 offset:3072
  ds_read_b128 a[144:147], v18 offset:4096
  ds_read_b128 a[148:151], v18 offset:5120
  ds_read_b128 a[152:155], v18 offset:6144
  ds_read_b128 a[156:159], v18 offset:7168
  s_sub_u32 s23, s2, 192
  s_cmp_lt_u32 s23, 54
  s_cselect_b32 s32, 1, 41
  s_and_b32 s37, s2, 1
  s_lshl_b32 s37, s37, 2
  s_add_u32 s37, s37, s20
  s_lshl_b32 s37, s37, 7
  s_lshr_b32 s31, s2, 1
  s_add_u32 s37, s37, s31
  s_lshl_b32 s37, s37, 2
  s_add_u32 s37, s37, 2654208
  s_mov_b32 s38, 0
  s_sub_u32 s31, s2, 64
  s_cmp_lt_u32 s31, 128
  s_cselect_b32 s32, 21, s32
  v_and_b32 v11, 15, v1
  v_lshlrev_b32 v10, 2, v11
  v_add_u32 v10, 2629632, v10
  v_mov_b32 v8, 0
  v_mov_b32 v9, 0
  s_waitcnt lgkmcnt(0)
  v_mfma_f32_16x16x32_bf16 v[96:99], a[128:131], v[32:35], 0
  v_mfma_f32_16x16x32_bf16 v[104:107], a[128:131], v[36:39], 0
  v_mfma_f32_16x16x32_bf16 v[128:131], a[128:131], v[64:67], 0
  v_mfma_f32_16x16x32_bf16 v[136:139], a[128:131], v[68:71], 0
  s_mov_b32 m0, s24
  ds_read_b128 a[128:131], v3 offset:0
  v_mfma_f32_16x16x32_bf16 v[100:103], a[132:135], v[32:35], 0
  buffer_load_dwordx4 v2, s[44:47], s26 offen offset:0 sc1 lds
  v_mfma_f32_16x16x32_bf16 v[108:111], a[132:135], v[36:39], 0
  v_mfma_f32_16x16x32_bf16 v[132:135], a[132:135], v[64:67], 0
  v_mfma_f32_16x16x32_bf16 v[140:143], a[132:135], v[68:71], 0
  ds_read_b128 a[132:135], v3 offset:1024
  v_mfma_f32_16x16x32_bf16 v[96:99], a[136:139], v[40:43], v[96:99]
  v_mfma_f32_16x16x32_bf16 v[104:107], a[136:139], v[44:47], v[104:107]
  v_mfma_f32_16x16x32_bf16 v[128:131], a[136:139], v[72:75], v[128:131]
  buffer_load_dwordx4 v2, s[44:47], s26 offen offset:1024 sc1 lds
  v_mfma_f32_16x16x32_bf16 v[136:139], a[136:139], v[76:79], v[136:139]
  ds_read_b128 a[136:139], v3 offset:2048
  v_mfma_f32_16x16x32_bf16 v[100:103], a[140:143], v[40:43], v[100:103]
  v_mfma_f32_16x16x32_bf16 v[108:111], a[140:143], v[44:47], v[108:111]
  v_mfma_f32_16x16x32_bf16 v[132:135], a[140:143], v[72:75], v[132:135]
  v_mfma_f32_16x16x32_bf16 v[140:143], a[140:143], v[76:79], v[140:143]
  s_waitcnt lgkmcnt(3)
  ds_read_b128 a[140:143], v3 offset:3072
  v_mfma_f32_16x16x32_bf16 v[96:99], a[144:147], v[48:51], v[96:99]
  v_mfma_f32_16x16x32_bf16 v[104:107], a[144:147], v[52:55], v[104:107]
  v_mfma_f32_16x16x32_bf16 v[128:131], a[144:147], v[80:83], v[128:131]
  buffer_load_dwordx4 v2, s[44:47], s26 offen offset:2048 sc1 lds
  v_mfma_f32_16x16x32_bf16 v[136:139], a[144:147], v[84:87], v[136:139]
  ds_read_b128 a[144:147], v3 offset:4096
  v_mfma_f32_16x16x32_bf16 v[100:103], a[148:151], v[48:51], v[100:103]
  v_mfma_f32_16x16x32_bf16 v[108:111], a[148:151], v[52:55], v[108:111]
  v_mfma_f32_16x16x32_bf16 v[132:135], a[148:151], v[80:83], v[132:135]
  v_mfma_f32_16x16x32_bf16 v[140:143], a[148:151], v[84:87], v[140:143]
  ds_read_b128 a[148:151], v3 offset:5120
  v_mfma_f32_16x16x32_bf16 v[96:99], a[152:155], v[56:59], v[96:99]
  buffer_load_dwordx4 v2, s[44:47], s26 offen offset:3072 sc1 lds
  v_mfma_f32_16x16x32_bf16 v[104:107], a[152:155], v[60:63], v[104:107]
  s_add_u32 s26, s26, 16384
  v_mfma_f32_16x16x32_bf16 v[128:131], a[152:155], v[88:91], v[128:131]
  s_add_u32 s24, s24, 32768
  v_mfma_f32_16x16x32_bf16 v[136:139], a[152:155], v[92:95], v[136:139]
  s_and_b32 s24, s24, 0x1ffff
  ds_read_b128 a[152:155], v3 offset:6144
  v_mfma_f32_16x16x32_bf16 v[100:103], a[156:159], v[56:59], v[100:103]
  v_mfma_f32_16x16x32_bf16 v[108:111], a[156:159], v[60:63], v[108:111]
  v_mfma_f32_16x16x32_bf16 v[132:135], a[156:159], v[88:91], v[132:135]
  v_mfma_f32_16x16x32_bf16 v[140:143], a[156:159], v[92:95], v[140:143]
  s_waitcnt lgkmcnt(3)
  ds_read_b128 a[156:159], v3 offset:7168
  s_nop 7
  s_cmp_lg_u32 s28, 0
  s_cbranch_scc1 fa_nomask0
  v_cndmask_b32 v96, v4, v96, s[68:69]
  v_cndmask_b32 v97, v4, v97, s[70:71]
  v_cndmask_b32 v98, v4, v98, s[72:73]
  v_cndmask_b32 v99, v4, v99, s[74:75]
  v_mov_b32 v100, v4
  v_mov_b32 v101, v4
  v_mov_b32 v102, v4
  v_mov_b32 v103, v4
  v_cndmask_b32 v108, v4, v108, s[68:69]
  v_cndmask_b32 v109, v4, v109, s[70:71]
  v_cndmask_b32 v110, v4, v110, s[72:73]
  v_cndmask_b32 v111, v4, v111, s[74:75]
fa_nomask0:
  v_max3_f32 v16, v96, v97, v98
  v_max3_f32 v16, v16, v99, v100
  v_max3_f32 v16, v16, v101, v102
  v_max_f32 v16, v16, v103
  v_max3_f32 v17, v104, v105, v106
  v_max3_f32 v17, v17, v107, v108
  v_max3_f32 v17, v17, v109, v110
  v_max_f32 v17, v17, v111
  v_max3_f32 v18, v128, v129, v130
  v_max3_f32 v18, v18, v131, v132
  v_max3_f32 v18, v18, v133, v134
  v_max_f32 v18, v18, v135
  v_max3_f32 v19, v136, v137, v138
  v_max3_f32 v19, v19, v139, v140
  v_max3_f32 v19, v19, v141, v142
  v_max_f32 v19, v19, v143
  v_mov_b32 v20, v16
  v_mov_b32 v21, v17
  v_mov_b32 v22, v18
  v_mov_b32 v23, v19
  s_nop 0
  v_permlane16_swap_b32 v16, v20
  v_permlane16_swap_b32 v17, v21
  v_permlane16_swap_b32 v18, v22
  v_permlane16_swap_b32 v19, v23
  v_max_f32 v16, v16, v20
  v_max_f32 v17, v17, v21
  v_max_f32 v18, v18, v22
  v_max_f32 v19, v19, v23
  v_mov_b32 v20, v16
  v_mov_b32 v21, v17
  v_mov_b32 v22, v18
  v_mov_b32 v23, v19
  s_nop 0
  v_permlane32_swap_b32 v16, v20
  v_permlane32_swap_b32 v17, v21
  v_permlane32_swap_b32 v18, v22
  v_permlane32_swap_b32 v19, v23
  v_max_f32 v16, v16, v20
  v_max_f32 v17, v17, v21
  v_max_f32 v18, v18, v22
  v_max_f32 v19, v19, v23
  v_sub_f32 v192, 0, v16
  v_sub_f32 v193, 0, v16
  v_sub_f32 v194, 0, v16
  v_sub_f32 v195, 0, v16
  v_sub_f32 v196, 0, v17
  v_sub_f32 v197, 0, v17
  v_sub_f32 v198, 0, v17
  v_sub_f32 v199, 0, v17
  v_sub_f32 v200, 0, v18
  v_sub_f32 v201, 0, v18
  v_sub_f32 v202, 0, v18
  v_sub_f32 v203, 0, v18
  v_sub_f32 v204, 0, v19
  v_sub_f32 v205, 0, v19
  v_sub_f32 v206, 0, v19
  v_sub_f32 v207, 0, v19
  v_sub_f32 v96, v96, v16
  v_sub_f32 v97, v97, v16
  v_sub_f32 v98, v98, v16
  v_sub_f32 v99, v99, v16
  v_sub_f32 v100, v100, v16
  v_sub_f32 v101, v101, v16
  v_sub_f32 v102, v102, v16
  v_sub_f32 v103, v103, v16
  v_sub_f32 v104, v104, v17
  v_sub_f32 v105, v105, v17
  v_sub_f32 v106, v106, v17
  v_sub_f32 v107, v107, v17
  v_sub_f32 v108, v108, v17
  v_sub_f32 v109, v109, v17
  v_sub_f32 v110, v110, v17
  v_sub_f32 v111, v111, v17
  v_sub_f32 v128, v128, v18
  v_sub_f32 v129, v129, v18
  v_sub_f32 v130, v130, v18
  v_sub_f32 v131, v131, v18
  v_sub_f32 v132, v132, v18
  v_sub_f32 v133, v133, v18
  v_sub_f32 v134, v134, v18
  v_sub_f32 v135, v135, v18
  v_sub_f32 v136, v136, v19
  v_sub_f32 v137, v137, v19
  v_sub_f32 v138, v138, v19
  v_sub_f32 v139, v139, v19
  v_sub_f32 v140, v140, v19
  v_sub_f32 v141, v141, v19
  v_sub_f32 v142, v142, v19
  v_sub_f32 v143, v143, v19
  v_mfma_f32_16x16x32_bf16 v[112:115], a[128:131], v[32:35], v[192:195]
  v_exp_f32 v208, v96
  v_exp_f32 v209, v97
  v_mfma_f32_16x16x32_bf16 v[120:123], a[128:131], v[36:39], v[196:199]
  v_exp_f32 v210, v98
  v_exp_f32 v211, v99
  v_mfma_f32_16x16x32_bf16 v[144:147], a[128:131], v[64:67], v[200:203]
  v_exp_f32 v212, v100
  v_exp_f32 v213, v101
  v_mfma_f32_16x16x32_bf16 v[152:155], a[128:131], v[68:71], v[204:207]
  s_mov_b32 m0, s25
  ds_read_b128 a[128:131], v3 offset:8192
  v_exp_f32 v214, v102
  v_add_f32 v224, v208, v209
  v_mfma_f32_16x16x32_bf16 v[116:119], a[132:135], v[32:35], v[192:195]
  buffer_load_dwordx4 v2, s[48:51], s27 offen offset:0 sc1 lds
  v_exp_f32 v215, v103
  v_cvt_pk_bf16_f32 v160, v208, v209
  v_mfma_f32_16x16x32_bf16 v[124:127], a[132:135], v[36:39], v[196:199]
  v_exp_f32 v208, v104
  v_add_f32 v224, v224, v210
  v_add_f32 v224, v224, v211
  v_mfma_f32_16x16x32_bf16 v[148:151], a[132:135], v[64:67], v[200:203]
  v_exp_f32 v209, v105
  v_cvt_pk_bf16_f32 v161, v210, v211
  v_add_f32 v224, v224, v212
  v_mfma_f32_16x16x32_bf16 v[156:159], a[132:135], v[68:71], v[204:207]
  ds_read_b128 a[132:135], v3 offset:9216
  v_exp_f32 v210, v106
  v_mfma_f32_16x16x32_bf16 v[112:115], a[136:139], v[40:43], v[112:115]
  v_exp_f32 v211, v107
  v_add_f32 v224, v224, v213
  v_cvt_pk_bf16_f32 v162, v212, v213
  v_mfma_f32_16x16x32_bf16 v[120:123], a[136:139], v[44:47], v[120:123]
  v_exp_f32 v212, v108
  v_add_f32 v224, v224, v214
  v_add_f32 v224, v224, v215
  v_mfma_f32_16x16x32_bf16 v[144:147], a[136:139], v[72:75], v[144:147]
  buffer_load_dwordx4 v2, s[48:51], s27 offen offset:1024 sc1 lds
  v_exp_f32 v213, v109
  v_cvt_pk_bf16_f32 v163, v214, v215
  v_mfma_f32_16x16x32_bf16 v[152:155], a[136:139], v[76:79], v[152:155]
  ds_read_b128 a[136:139], v3 offset:10240
  v_exp_f32 v214, v110
  v_add_f32 v225, v208, v209
  v_mfma_f32_16x16x32_bf16 v[116:119], a[140:143], v[40:43], v[116:119]
  v_exp_f32 v215, v111
  v_exp_f32 v216, v128
  v_mfma_f32_16x16x32_bf16 v[124:127], a[140:143], v[44:47], v[124:127]
  v_exp_f32 v217, v129
  v_exp_f32 v218, v130
  v_mfma_f32_16x16x32_bf16 v[148:151], a[140:143], v[72:75], v[148:151]
  v_exp_f32 v219, v131
  v_exp_f32 v220, v132
  v_mfma_f32_16x16x32_bf16 v[156:159], a[140:143], v[76:79], v[156:159]
  s_waitcnt lgkmcnt(3)
  ds_read_b128 a[140:143], v3 offset:11264
  v_exp_f32 v221, v133
  v_cvt_pk_bf16_f32 v164, v208, v209
  v_mfma_f32_16x16x32_bf16 v[112:115], a[144:147], v[48:51], v[112:115]
  v_exp_f32 v222, v134
  v_exp_f32 v223, v135
  v_mfma_f32_16x16x32_bf16 v[120:123], a[144:147], v[52:55], v[120:123]
  v_add_f32 v225, v225, v210
  v_add_f32 v225, v225, v211
  v_cvt_pk_bf16_f32 v165, v210, v211
  v_add_f32 v225, v225, v212
  v_mfma_f32_16x16x32_bf16 v[144:147], a[144:147], v[80:83], v[144:147]
  buffer_load_dwordx4 v2, s[48:51], s27 offen offset:2048 sc1 lds
  v_add_f32 v225, v225, v213
  v_cvt_pk_bf16_f32 v166, v212, v213
  v_add_f32 v225, v225, v214
  v_mfma_f32_16x16x32_bf16 v[152:155], a[144:147], v[84:87], v[152:155]
  ds_read_b128 a[144:147], v3 offset:12288
  v_add_f32 v225, v225, v215
  v_cvt_pk_bf16_f32 v167, v214, v215
  v_add_f32 v226, v216, v217
  v_mfma_f32_16x16x32_bf16 v[116:119], a[148:151], v[48:51], v[116:119]
  v_cvt_pk_bf16_f32 v176, v216, v217
  v_exp_f32 v216, v136
  v_add_f32 v226, v226, v218
  v_mfma_f32_16x16x32_bf16 v[124:127], a[148:151], v[52:55], v[124:127]
  v_exp_f32 v217, v137
  v_add_f32 v226, v226, v219
  v_cvt_pk_bf16_f32 v177, v218, v219
  v_mfma_f32_16x16x32_bf16 v[148:151], a[148:151], v[80:83], v[148:151]
  v_exp_f32 v218, v138
  v_add_f32 v226, v226, v220
  v_add_f32 v226, v226, v221
  v_mfma_f32_16x16x32_bf16 v[156:159], a[148:151], v[84:87], v[156:159]
  ds_read_b128 a[148:151], v3 offset:13312
  v_exp_f32 v219, v139
  v_mfma_f32_16x16x32_bf16 v[112:115], a[152:155], v[56:59], v[112:115]
  buffer_load_dwordx4 v2, s[48:51], s27 offen offset:3072 sc1 lds
  v_cvt_pk_bf16_f32 v178, v220, v221
  v_exp_f32 v220, v140
  v_mfma_f32_16x16x32_bf16 v[120:123], a[152:155], v[60:63], v[120:123]
  s_add_u32 s27, s27, 16384
  v_add_f32 v226, v226, v222
  v_add_f32 v226, v226, v223
  v_cvt_pk_bf16_f32 v179, v222, v223
  v_add_f32 v227, v216, v217
  v_mfma_f32_16x16x32_bf16 v[144:147], a[152:155], v[88:91], v[144:147]
  s_add_u32 s25, s25, 32768
  v_exp_f32 v221, v141
  v_cvt_pk_bf16_f32 v180, v216, v217
  v_add_f32 v227, v227, v218
  v_mfma_f32_16x16x32_bf16 v[152:155], a[152:155], v[92:95], v[152:155]
  s_and_b32 s25, s25, 0x1ffff
  ds_read_b128 a[152:155], v3 offset:14336
  v_add_f32 v227, v227, v219
  v_cvt_pk_bf16_f32 v181, v218, v219
  v_max3_f32 v5, v224, v225, v226
  v_mfma_f32_16x16x32_bf16 v[116:119], a[156:159], v[56:59], v[116:119]
  v_exp_f32 v222, v142
  v_add_f32 v227, v227, v220
  v_add_f32 v227, v227, v221
  v_mfma_f32_16x16x32_bf16 v[124:127], a[156:159], v[60:63], v[124:127]
  v_exp_f32 v223, v143
  v_cvt_pk_bf16_f32 v182, v220, v221
  v_add_f32 v227, v227, v222
  v_mfma_f32_16x16x32_bf16 v[148:151], a[156:159], v[88:91], v[148:151]
  v_add_f32 v227, v227, v223
  v_cvt_pk_bf16_f32 v183, v222, v223
  v_max_f32 v5, v5, v227
  v_cmp_lt_f32 vcc, s81, v5
  v_mfma_f32_16x16x32_bf16 v[156:159], a[156:159], v[92:95], v[156:159]
  s_waitcnt lgkmcnt(3)
  s_cbranch_vccnz fa_stub0
fa_back0:
  ds_read_b128 a[156:159], v3 offset:15360
  v_add_f32 v228, v228, v224
  v_add_f32 v229, v229, v225
  v_add_f32 v230, v230, v226
  v_add_f32 v231, v231, v227
  v_add_u32 v3, 32768, v3
  v_and_b32 v3, 0x1ffff, v3
  s_waitcnt vmcnt(8)
  ds_read_b64_tr_b16 v[232:233], v6 offset:0
  ds_read_b64_tr_b16 v[234:235], v6 offset:2560
  ds_read_b64_tr_b16 v[236:237], v6 offset:32
  ds_read_b64_tr_b16 v[238:239], v6 offset:2592
  ds_read_b64_tr_b16 v[240:241], v6 offset:64
  ds_read_b64_tr_b16 v[242:243], v6 offset:2624
  ds_read_b64_tr_b16 v[244:245], v6 offset:96
  ds_read_b64_tr_b16 v[246:247], v6 offset:2656
  ds_read_b64_tr_b16 v[248:249], v6 offset:128
  ds_read_b64_tr_b16 v[250:251], v6 offset:2688
  s_add_u32 s31, s30, 4096
  s_waitcnt lgkmcnt(0)
  buffer_store_dwordx4 v[232:235], v2, s[40:43], s30 offen offset:0 sc1
  buffer_store_dwordx4 v[236:239], v2, s[40:43], s30 offen offset:1024 sc1
  buffer_store_dwordx4 v[240:243], v2, s[40:43], s30 offen offset:2048 sc1
  buffer_store_dwordx4 v[244:247], v2, s[40:43], s30 offen offset:3072 sc1
  buffer_store_dwordx4 v[248:251], v2, s[40:43], s31 offen offset:0 sc1
  s_cmp_eq_u32 s28, 0
  s_cbranch_scc1 fa_AV
  s_sub_u32 s28, s28, 1
  s_cmp_eq_u32 s28, 0
  s_cbranch_scc1 fa_Aexit
.p2align 6
fa_DD:
  v_mfma_f32_16x16x32_bf16 v[96:99], a[128:131], v[32:35], v[192:195]
  s_waitcnt vmcnt(12)
  v_exp_f32 v208, v112
  v_mfma_f32_16x16x32_bf16 v[104:107], a[128:131], v[36:39], v[196:199]
  s_barrier
  v_exp_f32 v209, v113
  v_mfma_f32_16x16x32_bf16 v[128:131], a[128:131], v[64:67], v[200:203]
  s_cmp_lg_u32 s32, 0
  ds_read_b128 a[160:163], v3 offset:16384
  v_add_f32 v224, v208, v209
  v_mfma_f32_16x16x32_bf16 v[136:139], a[128:131], v[68:71], v[204:207]
  s_cbranch_scc1 fa_fstub
fa_fback:
  v_exp_f32 v210, v114
  v_mfma_f32_16x16x32_bf16 v[100:103], a[132:135], v[32:35], v[192:195]
  ds_read_b128 a[164:167], v3 offset:17408
  v_cvt_pk_bf16_f32 v168, v208, v209
  v_mfma_f32_16x16x32_bf16 v[108:111], a[132:135], v[36:39], v[196:199]
  s_mov_b32 m0, s24
  v_exp_f32 v211, v115
  v_mfma_f32_16x16x32_bf16 v[132:135], a[132:135], v[64:67], v[200:203]
  buffer_load_dwordx4 v2, s[44:47], s26 offen offset:0 sc1 lds
  v_add_f32 v224, v224, v210
  v_add_f32 v224, v224, v211
  v_mfma_f32_16x16x32_bf16 v[140:143], a[132:135], v[68:71], v[204:207]
  v_exp_f32 v212, v116
  v_mfma_f32_16x16x32_bf16 v[96:99], a[136:139], v[40:43], v[96:99]
  ds_read_b128 a[168:171], v3 offset:18432
  v_cvt_pk_bf16_f32 v169, v210, v211
  v_mfma_f32_16x16x32_bf16 v[104:107], a[136:139], v[44:47], v[104:107]
  v_exp_f32 v213, v117
  v_mfma_f32_16x16x32_bf16 v[128:131], a[136:139], v[72:75], v[128:131]
  v_exp_f32 v214, v118
  v_mfma_f32_16x16x32_bf16 v[136:139], a[136:139], v[76:79], v[136:139]
  v_exp_f32 v215, v119
  v_mfma_f32_16x16x32_bf16 v[100:103], a[140:143], v[40:43], v[100:103]
  ds_read_b128 a[172:175], v3 offset:19456
  v_add_f32 v224, v224, v212
  v_mfma_f32_16x16x32_bf16 v[108:111], a[140:143], v[44:47], v[108:111]
  v_exp_f32 v208, v120
  v_mfma_f32_16x16x32_bf16 v[132:135], a[140:143], v[72:75], v[132:135]
  v_exp_f32 v209, v121
  v_mfma_f32_16x16x32_bf16 v[140:143], a[140:143], v[76:79], v[140:143]
  s_waitcnt lgkmcnt(4)
  v_exp_f32 v210, v122
  v_mfma_f32_16x16x32_bf16 v[96:99], a[144:147], v[48:51], v[96:99]
  ds_read_b128 a[176:179], v3 offset:20480
  v_add_f32 v224, v224, v213
  v_mfma_f32_16x16x32_bf16 v[104:107], a[144:147], v[52:55], v[104:107]
  v_exp_f32 v211, v123
  v_mfma_f32_16x16x32_bf16 v[128:131], a[144:147], v[80:83], v[128:131]
  v_cvt_pk_bf16_f32 v170, v212, v213
  v_add_f32 v224, v224, v214
  v_add_f32 v224, v224, v215
  v_mfma_f32_16x16x32_bf16 v[136:139], a[144:147], v[84:87], v[136:139]
  v_exp_f32 v212, v124
  v_mfma_f32_16x16x32_bf16 v[100:103], a[148:151], v[48:51], v[100:103]
  ds_read_b128 a[180:183], v3 offset:21504
  v_cvt_pk_bf16_f32 v171, v214, v215
  v_mfma_f32_16x16x32_bf16 v[108:111], a[148:151], v[52:55], v[108:111]
  v_exp_f32 v213, v125
  v_mfma_f32_16x16x32_bf16 v[132:135], a[148:151], v[80:83], v[132:135]
  buffer_load_dwordx4 v2, s[44:47], s26 offen offset:1024 sc1 lds
  v_add_f32 v225, v208, v209
  v_mfma_f32_16x16x32_bf16 v[140:143], a[148:151], v[84:87], v[140:143]
  v_exp_f32 v214, v126
  v_mfma_f32_16x16x32_bf16 v[96:99], a[152:155], v[56:59], v[96:99]
  ds_read_b128 a[184:187], v3 offset:22528
  v_cvt_pk_bf16_f32 v172, v208, v209
  v_mfma_f32_16x16x32_bf16 v[104:107], a[152:155], v[60:63], v[104:107]
  v_exp_f32 v215, v127
  v_mfma_f32_16x16x32_bf16 v[128:131], a[152:155], v[88:91], v[128:131]
  v_exp_f32 v216, v144
  v_mfma_f32_16x16x32_bf16 v[136:139], a[152:155], v[92:95], v[136:139]
  v_exp_f32 v217, v145
  v_mfma_f32_16x16x32_bf16 v[100:103], a[156:159], v[56:59], v[100:103]
  ds_read_b128 a[188:191], v3 offset:23552
  v_add_f32 v225, v225, v210
  v_mfma_f32_16x16x32_bf16 v[108:111], a[156:159], v[60:63], v[108:111]
  v_exp_f32 v218, v146
  v_mfma_f32_16x16x32_bf16 v[132:135], a[156:159], v[88:91], v[132:135]
  v_exp_f32 v219, v147
  v_mfma_f32_16x16x32_bf16 v[140:143], a[156:159], v[92:95], v[140:143]
  s_waitcnt lgkmcnt(4)
  v_exp_f32 v220, v148
  v_add_f32 v225, v225, v211
  v_mfma_f32_16x16x32_bf16 a[0:3], a[160:163], v[160:163], a[0:3]
  ds_read_b128 a[128:131], v3 offset:0
  v_cvt_pk_bf16_f32 v173, v210, v211
  v_mfma_f32_16x16x32_bf16 a[4:7], a[160:163], v[164:167], a[4:7]
  v_exp_f32 v221, v149
  v_mfma_f32_16x16x32_bf16 a[64:67], a[160:163], v[176:179], a[64:67]
  v_exp_f32 v222, v150
  v_mfma_f32_16x16x32_bf16 a[68:71], a[160:163], v[180:183], a[68:71]
  v_exp_f32 v223, v151
  v_mfma_f32_16x16x32_bf16 a[8:11], a[164:167], v[160:163], a[8:11]
  ds_read_b128 a[132:135], v3 offset:1024
  v_add_f32 v225, v225, v212
  v_mfma_f32_16x16x32_bf16 a[12:15], a[164:167], v[164:167], a[12:15]
  v_add_f32 v225, v225, v213
  v_cvt_pk_bf16_f32 v174, v212, v213
  v_mfma_f32_16x16x32_bf16 a[72:75], a[164:167], v[176:179], a[72:75]
  buffer_load_dwordx4 v2, s[44:47], s26 offen offset:2048 sc1 lds
  v_add_f32 v225, v225, v214
  v_mfma_f32_16x16x32_bf16 a[76:79], a[164:167], v[180:183], a[76:79]
  v_add_f32 v225, v225, v215
  v_cvt_pk_bf16_f32 v175, v214, v215
  v_mfma_f32_16x16x32_bf16 a[16:19], a[168:171], v[160:163], a[16:19]
  ds_read_b128 a[136:139], v3 offset:2048
  v_add_f32 v226, v216, v217
  v_mfma_f32_16x16x32_bf16 a[20:23], a[168:171], v[164:167], a[20:23]
  v_cvt_pk_bf16_f32 v184, v216, v217
  v_add_f32 v226, v226, v218
  v_mfma_f32_16x16x32_bf16 a[80:83], a[168:171], v[176:179], a[80:83]
  v_exp_f32 v216, v152
  v_mfma_f32_16x16x32_bf16 a[84:87], a[168:171], v[180:183], a[84:87]
  v_exp_f32 v217, v153
  v_mfma_f32_16x16x32_bf16 a[24:27], a[172:175], v[160:163], a[24:27]
  ds_read_b128 a[140:143], v3 offset:3072
  v_add_f32 v226, v226, v219
  v_cvt_pk_bf16_f32 v185, v218, v219
  v_mfma_f32_16x16x32_bf16 a[28:31], a[172:175], v[164:167], a[28:31]
  v_exp_f32 v218, v154
  v_mfma_f32_16x16x32_bf16 a[88:91], a[172:175], v[176:179], a[88:91]
  v_add_f32 v226, v226, v220
  v_add_f32 v226, v226, v221
  v_mfma_f32_16x16x32_bf16 a[92:95], a[172:175], v[180:183], a[92:95]
  s_waitcnt lgkmcnt(4)
  v_exp_f32 v219, v155
  v_mfma_f32_16x16x32_bf16 a[32:35], a[176:179], v[160:163], a[32:35]
  ds_read_b128 a[144:147], v3 offset:4096
  v_cvt_pk_bf16_f32 v186, v220, v221
  v_mfma_f32_16x16x32_bf16 a[36:39], a[176:179], v[164:167], a[36:39]
  v_exp_f32 v220, v156
  v_mfma_f32_16x16x32_bf16 a[96:99], a[176:179], v[176:179], a[96:99]
  v_add_f32 v226, v226, v222
  v_add_f32 v226, v226, v223
  v_mfma_f32_16x16x32_bf16 a[100:103], a[176:179], v[180:183], a[100:103]
  v_exp_f32 v221, v157
  v_mfma_f32_16x16x32_bf16 a[40:43], a[180:183], v[160:163], a[40:43]
  ds_read_b128 a[148:151], v3 offset:5120
  v_cvt_pk_bf16_f32 v187, v222, v223
  v_mfma_f32_16x16x32_bf16 a[44:47], a[180:183], v[164:167], a[44:47]
  v_exp_f32 v222, v158
  v_mfma_f32_16x16x32_bf16 a[104:107], a[180:183], v[176:179], a[104:107]
  buffer_load_dwordx4 v2, s[44:47], s26 offen offset:3072 sc1 lds
  v_add_f32 v227, v216, v217
  v_mfma_f32_16x16x32_bf16 a[108:111], a[180:183], v[180:183], a[108:111]
  s_add_u32 s26, s26, 16384
  v_exp_f32 v223, v159
  v_mfma_f32_16x16x32_bf16 a[48:51], a[184:187], v[160:163], a[48:51]
  s_add_u32 s24, s24, 32768
  ds_read_b128 a[152:155], v3 offset:6144
  v_cvt_pk_bf16_f32 v188, v216, v217
  v_add_f32 v227, v227, v218
  v_mfma_f32_16x16x32_bf16 a[52:55], a[184:187], v[164:167], a[52:55]
  s_and_b32 s24, s24, 0x1ffff
  v_add_f32 v227, v227, v219
  v_cvt_pk_bf16_f32 v189, v218, v219
  v_mfma_f32_16x16x32_bf16 a[112:115], a[184:187], v[176:179], a[112:115]
  v_max3_f32 v5, v224, v225, v226
  v_add_f32 v227, v227, v220
  v_mfma_f32_16x16x32_bf16 a[116:119], a[184:187], v[180:183], a[116:119]
  v_add_f32 v227, v227, v221
  v_cvt_pk_bf16_f32 v190, v220, v221
  v_mfma_f32_16x16x32_bf16 a[56:59], a[188:191], v[160:163], a[56:59]
  ds_read_b128 a[156:159], v3 offset:7168
  v_add_f32 v227, v227, v222
  v_mfma_f32_16x16x32_bf16 a[60:63], a[188:191], v[164:167], a[60:63]
  v_add_f32 v227, v227, v223
  v_cvt_pk_bf16_f32 v191, v222, v223
  v_mfma_f32_16x16x32_bf16 a[120:123], a[188:191], v[176:179], a[120:123]
  s_waitcnt lgkmcnt(4)
  v_max_f32 v5, v5, v227
  v_cmp_lt_f32 vcc, s81, v5
  v_mfma_f32_16x16x32_bf16 a[124:127], a[188:191], v[180:183], a[124:127]
  s_cbranch_vccnz fa_stub1
fa_back1:
  v_add_f32 v228, v228, v224
  v_add_f32 v229, v229, v225
  v_add_f32 v230, v230, v226
  v_add_f32 v231, v231, v227
  v_mfma_f32_16x16x32_bf16 v[112:115], a[128:131], v[32:35], v[192:195]
  ds_read_b128 a[160:163], v3 offset:24576
  v_exp_f32 v208, v96
  v_mfma_f32_16x16x32_bf16 v[120:123], a[128:131], v[36:39], v[196:199]
  v_exp_f32 v209, v97
  v_mfma_f32_16x16x32_bf16 v[144:147], a[128:131], v[64:67], v[200:203]
  v_exp_f32 v210, v98
  v_mfma_f32_16x16x32_bf16 v[152:155], a[128:131], v[68:71], v[204:207]
  v_exp_f32 v211, v99
  v_mfma_f32_16x16x32_bf16 v[116:119], a[132:135], v[32:35], v[192:195]
  ds_read_b128 a[164:167], v3 offset:25600
  v_mfma_f32_16x16x32_bf16 v[124:127], a[132:135], v[36:39], v[196:199]
  s_mov_b32 m0, s25
  v_exp_f32 v212, v100
  v_mfma_f32_16x16x32_bf16 v[148:151], a[132:135], v[64:67], v[200:203]
  buffer_load_dwordx4 v2, s[48:51], s27 offen offset:0 sc1 lds
  v_add_f32 v224, v208, v209
  v_cvt_pk_bf16_f32 v160, v208, v209
  v_mfma_f32_16x16x32_bf16 v[156:159], a[132:135], v[68:71], v[204:207]
  v_exp_f32 v213, v101
  v_mfma_f32_16x16x32_bf16 v[112:115], a[136:139], v[40:43], v[112:115]
  ds_read_b128 a[168:171], v3 offset:26624
  v_add_f32 v224, v224, v210
  v_mfma_f32_16x16x32_bf16 v[120:123], a[136:139], v[44:47], v[120:123]
  v_exp_f32 v214, v102
  v_mfma_f32_16x16x32_bf16 v[144:147], a[136:139], v[72:75], v[144:147]
  v_exp_f32 v215, v103
  v_mfma_f32_16x16x32_bf16 v[152:155], a[136:139], v[76:79], v[152:155]
  v_exp_f32 v208, v104
  v_mfma_f32_16x16x32_bf16 v[116:119], a[140:143], v[40:43], v[116:119]
  ds_read_b128 a[172:175], v3 offset:27648
  v_add_f32 v224, v224, v211
  v_mfma_f32_16x16x32_bf16 v[124:127], a[140:143], v[44:47], v[124:127]
  v_exp_f32 v209, v105
  v_mfma_f32_16x16x32_bf16 v[148:151], a[140:143], v[72:75], v[148:151]
  v_cvt_pk_bf16_f32 v161, v210, v211
  v_add_f32 v224, v224, v212
  v_mfma_f32_16x16x32_bf16 v[156:159], a[140:143], v[76:79], v[156:159]
  s_waitcnt lgkmcnt(4)
  v_exp_f32 v210, v106
  v_mfma_f32_16x16x32_bf16 v[112:115], a[144:147], v[48:51], v[112:115]
  ds_read_b128 a[176:179], v3 offset:28672
  v_add_f32 v224, v224, v213
  v_mfma_f32_16x16x32_bf16 v[120:123], a[144:147], v[52:55], v[120:123]
  v_exp_f32 v211, v107
  v_mfma_f32_16x16x32_bf16 v[144:147], a[144:147], v[80:83], v[144:147]
  v_cvt_pk_bf16_f32 v162, v212, v213
  v_add_f32 v224, v224, v214
  v_add_f32 v224, v224, v215
  v_mfma_f32_16x16x32_bf16 v[152:155], a[144:147], v[84:87], v[152:155]
  v_exp_f32 v212, v108
  v_mfma_f32_16x16x32_bf16 v[116:119], a[148:151], v[48:51], v[116:119]
  ds_read_b128 a[180:183], v3 offset:29696
  v_cvt_pk_bf16_f32 v163, v214, v215
  v_mfma_f32_16x16x32_bf16 v[124:127], a[148:151], v[52:55], v[124:127]
  v_exp_f32 v213, v109
  v_mfma_f32_16x16x32_bf16 v[148:151], a[148:151], v[80:83], v[148:151]
  buffer_load_dwordx4 v2, s[48:51], s27 offen offset:1024 sc1 lds
  v_add_f32 v225, v208, v209
  v_mfma_f32_16x16x32_bf16 v[156:159], a[148:151], v[84:87], v[156:159]
  v_exp_f32 v214, v110
  v_mfma_f32_16x16x32_bf16 v[112:115], a[152:155], v[56:59], v[112:115]
  ds_read_b128 a[184:187], v3 offset:30720
  v_cvt_pk_bf16_f32 v164, v208, v209
  v_mfma_f32_16x16x32_bf16 v[120:123], a[152:155], v[60:63], v[120:123]
  v_exp_f32 v215, v111
  v_mfma_f32_16x16x32_bf16 v[144:147], a[152:155], v[88:91], v[144:147]
  v_exp_f32 v216, v128
  v_mfma_f32_16x16x32_bf16 v[152:155], a[152:155], v[92:95], v[152:155]
  v_exp_f32 v217, v129
  v_mfma_f32_16x16x32_bf16 v[116:119], a[156:159], v[56:59], v[116:119]
  ds_read_b128 a[188:191], v3 offset:31744
  v_add_f32 v225, v225, v210
  v_mfma_f32_16x16x32_bf16 v[124:127], a[156:159], v[60:63], v[124:127]
  v_exp_f32 v218, v130
  v_mfma_f32_16x16x32_bf16 v[148:151], a[156:159], v[88:91], v[148:151]
  v_exp_f32 v219, v131
  v_mfma_f32_16x16x32_bf16 v[156:159], a[156:159], v[92:95], v[156:159]
  s_waitcnt lgkmcnt(4)
  v_exp_f32 v220, v132
  v_add_f32 v225, v225, v211
  v_mfma_f32_16x16x32_bf16 a[0:3], a[160:163], v[168:171], a[0:3]
  ds_read_b128 a[128:131], v3 offset:8192
  v_cvt_pk_bf16_f32 v165, v210, v211
  v_mfma_f32_16x16x32_bf16 a[4:7], a[160:163], v[172:175], a[4:7]
  v_exp_f32 v221, v133
  v_mfma_f32_16x16x32_bf16 a[64:67], a[160:163], v[184:187], a[64:67]
  v_exp_f32 v222, v134
  v_mfma_f32_16x16x32_bf16 a[68:71], a[160:163], v[188:191], a[68:71]
  v_exp_f32 v223, v135
  v_mfma_f32_16x16x32_bf16 a[8:11], a[164:167], v[168:171], a[8:11]
  ds_read_b128 a[132:135], v3 offset:9216
  v_add_f32 v225, v225, v212
  v_mfma_f32_16x16x32_bf16 a[12:15], a[164:167], v[172:175], a[12:15]
  v_add_f32 v225, v225, v213
  v_cvt_pk_bf16_f32 v166, v212, v213
  v_mfma_f32_16x16x32_bf16 a[72:75], a[164:167], v[184:187], a[72:75]
  buffer_load_dwordx4 v2, s[48:51], s27 offen offset:2048 sc1 lds
  v_add_f32 v225, v225, v214
  v_mfma_f32_16x16x32_bf16 a[76:79], a[164:167], v[188:191], a[76:79]
  v_add_f32 v225, v225, v215
  v_cvt_pk_bf16_f32 v167, v214, v215
  v_mfma_f32_16x16x32_bf16 a[16:19], a[168:171], v[168:171], a[16:19]
  ds_read_b128 a[136:139], v3 offset:10240
  v_add_f32 v226, v216, v217
  v_mfma_f32_16x16x32_bf16 a[20:23], a[168:171], v[172:175], a[20:23]
  v_cvt_pk_bf16_f32 v176, v216, v217
  v_add_f32 v226, v226, v218
  v_mfma_f32_16x16x32_bf16 a[80:83], a[168:171], v[184:187], a[80:83]
  v_exp_f32 v216, v136
  v_mfma_f32_16x16x32_bf16 a[84:87], a[168:171], v[188:191], a[84:87]
  v_exp_f32 v217, v137
  v_mfma_f32_16x16x32_bf16 a[24:27], a[172:175], v[168:171], a[24:27]
  ds_read_b128 a[140:143], v3 offset:11264
  v_add_f32 v226, v226, v219
  v_cvt_pk_bf16_f32 v177, v218, v219
  v_mfma_f32_16x16x32_bf16 a[28:31], a[172:175], v[172:175], a[28:31]
  v_exp_f32 v218, v138
  v_mfma_f32_16x16x32_bf16 a[88:91], a[172:175], v[184:187], a[88:91]
  v_add_f32 v226, v226, v220
  v_add_f32 v226, v226, v221
  v_mfma_f32_16x16x32_bf16 a[92:95], a[172:175], v[188:191], a[92:95]
  s_waitcnt lgkmcnt(4)
  v_exp_f32 v219, v139
  v_mfma_f32_16x16x32_bf16 a[32:35], a[176:179], v[168:171], a[32:35]
  ds_read_b128 a[144:147], v3 offset:12288
  v_cvt_pk_bf16_f32 v178, v220, v221
  v_mfma_f32_16x16x32_bf16 a[36:39], a[176:179], v[172:175], a[36:39]
  v_exp_f32 v220, v140
  v_mfma_f32_16x16x32_bf16 a[96:99], a[176:179], v[184:187], a[96:99]
  v_add_f32 v226, v226, v222
  v_add_f32 v226, v226, v223
  v_mfma_f32_16x16x32_bf16 a[100:103], a[176:179], v[188:191], a[100:103]
  v_exp_f32 v221, v141
  v_mfma_f32_16x16x32_bf16 a[40:43], a[180:183], v[168:171], a[40:43]
  ds_read_b128 a[148:151], v3 offset:13312
  v_cvt_pk_bf16_f32 v179, v222, v223
  v_mfma_f32_16x16x32_bf16 a[44:47], a[180:183], v[172:175], a[44:47]
  v_exp_f32 v222, v142
  v_mfma_f32_16x16x32_bf16 a[104:107], a[180:183], v[184:187], a[104:107]
  buffer_load_dwordx4 v2, s[48:51], s27 offen offset:3072 sc1 lds
  v_add_f32 v227, v216, v217
  v_mfma_f32_16x16x32_bf16 a[108:111], a[180:183], v[188:191], a[108:111]
  s_add_u32 s27, s27, 16384
  v_exp_f32 v223, v143
  v_mfma_f32_16x16x32_bf16 a[48:51], a[184:187], v[168:171], a[48:51]
  s_add_u32 s25, s25, 32768
  ds_read_b128 a[152:155], v3 offset:14336
  v_cvt_pk_bf16_f32 v180, v216, v217
  v_add_f32 v227, v227, v218
  v_mfma_f32_16x16x32_bf16 a[52:55], a[184:187], v[172:175], a[52:55]
  s_and_b32 s25, s25, 0x1ffff
  v_add_f32 v227, v227, v219
  v_cvt_pk_bf16_f32 v181, v218, v219
  v_mfma_f32_16x16x32_bf16 a[112:115], a[184:187], v[184:187], a[112:115]
  v_max3_f32 v5, v224, v225, v226
  v_add_f32 v227, v227, v220
  v_mfma_f32_16x16x32_bf16 a[116:119], a[184:187], v[188:191], a[116:119]
  v_add_f32 v227, v227, v221
  v_cvt_pk_bf16_f32 v182, v220, v221
  v_mfma_f32_16x16x32_bf16 a[56:59], a[188:191], v[168:171], a[56:59]
  ds_read_b128 a[156:159], v3 offset:15360
  v_add_f32 v227, v227, v222
  v_mfma_f32_16x16x32_bf16 a[60:63], a[188:191], v[172:175], a[60:63]
  s_sub_u32 s28, s28, 1
  v_add_f32 v227, v227, v223
  v_cvt_pk_bf16_f32 v183, v222, v223
  v_mfma_f32_16x16x32_bf16 a[120:123], a[188:191], v[184:187], a[120:123]
  s_waitcnt lgkmcnt(4)
  v_max_f32 v5, v5, v227
  v_cmp_lt_f32 vcc, s81, v5
  v_mfma_f32_16x16x32_bf16 a[124:127], a[188:191], v[188:191], a[124:127]
  s_cbranch_vccnz fa_stub2
fa_back2:
  v_add_f32 v228, v228, v224
  v_add_f32 v229, v229, v225
  v_add_f32 v230, v230, v226
  v_add_f32 v231, v231, v227
  v_add_u32 v3, 32768, v3
  v_and_b32 v3, 0x1ffff, v3
  s_cmp_lg_u32 s28, 0
  s_cbranch_scc1 fa_DD
fa_Aexit:
  s_bitcmp1_b32 s20, 0
  s_cbranch_scc1 fa_Aodd
  v_mfma_f32_16x16x32_bf16 v[96:99], a[128:131], v[32:35], v[192:195]
  s_waitcnt vmcnt(12)
  v_exp_f32 v208, v112
  v_mfma_f32_16x16x32_bf16 v[104:107], a[128:131], v[36:39], v[196:199]
  s_barrier
  v_exp_f32 v209, v113
  v_mfma_f32_16x16x32_bf16 v[128:131], a[128:131], v[64:67], v[200:203]
  ds_read_b128 a[160:163], v3 offset:16384
  v_add_f32 v224, v208, v209
  v_mfma_f32_16x16x32_bf16 v[136:139], a[128:131], v[68:71], v[204:207]
  v_exp_f32 v210, v114
  v_mfma_f32_16x16x32_bf16 v[100:103], a[132:135], v[32:35], v[192:195]
  ds_read_b128 a[164:167], v3 offset:17408
  v_cvt_pk_bf16_f32 v168, v208, v209
  v_mfma_f32_16x16x32_bf16 v[108:111], a[132:135], v[36:39], v[196:199]
  s_mov_b32 m0, s24
  v_exp_f32 v211, v115
  v_mfma_f32_16x16x32_bf16 v[132:135], a[132:135], v[64:67], v[200:203]
  buffer_load_dwordx4 v2, s[44:47], s26 offen offset:0 sc1 lds
  v_add_f32 v224, v224, v210
  v_add_f32 v224, v224, v211
  v_mfma_f32_16x16x32_bf16 v[140:143], a[132:135], v[68:71], v[204:207]
  v_exp_f32 v212, v116
  v_mfma_f32_16x16x32_bf16 v[96:99], a[136:139], v[40:43], v[96:99]
  ds_read_b128 a[168:171], v3 offset:18432
  v_cvt_pk_bf16_f32 v169, v210, v211
  v_mfma_f32_16x16x32_bf16 v[104:107], a[136:139], v[44:47], v[104:107]
  v_exp_f32 v213, v117
  v_mfma_f32_16x16x32_bf16 v[128:131], a[136:139], v[72:75], v[128:131]
  v_exp_f32 v214, v118
  v_mfma_f32_16x16x32_bf16 v[136:139], a[136:139], v[76:79], v[136:139]
  v_exp_f32 v215, v119
  v_mfma_f32_16x16x32_bf16 v[100:103], a[140:143], v[40:43], v[100:103]
  ds_read_b128 a[172:175], v3 offset:19456
  v_add_f32 v224, v224, v212
  v_mfma_f32_16x16x32_bf16 v[108:111], a[140:143], v[44:47], v[108:111]
  v_exp_f32 v208, v120
  v_mfma_f32_16x16x32_bf16 v[132:135], a[140:143], v[72:75], v[132:135]
  v_exp_f32 v209, v121
  v_mfma_f32_16x16x32_bf16 v[140:143], a[140:143], v[76:79], v[140:143]
  s_waitcnt lgkmcnt(4)
  v_exp_f32 v210, v122
  v_mfma_f32_16x16x32_bf16 v[96:99], a[144:147], v[48:51], v[96:99]
  ds_read_b128 a[176:179], v3 offset:20480
  v_add_f32 v224, v224, v213
  v_mfma_f32_16x16x32_bf16 v[104:107], a[144:147], v[52:55], v[104:107]
  v_exp_f32 v211, v123
  v_mfma_f32_16x16x32_bf16 v[128:131], a[144:147], v[80:83], v[128:131]
  v_cvt_pk_bf16_f32 v170, v212, v213
  v_add_f32 v224, v224, v214
  v_add_f32 v224, v224, v215
  v_mfma_f32_16x16x32_bf16 v[136:139], a[144:147], v[84:87], v[136:139]
  v_exp_f32 v212, v124
  v_mfma_f32_16x16x32_bf16 v[100:103], a[148:151], v[48:51], v[100:103]
  ds_read_b128 a[180:183], v3 offset:21504
  v_cvt_pk_bf16_f32 v171, v214, v215
  v_mfma_f32_16x16x32_bf16 v[108:111], a[148:151], v[52:55], v[108:111]
  v_exp_f32 v213, v125
  v_mfma_f32_16x16x32_bf16 v[132:135], a[148:151], v[80:83], v[132:135]
  buffer_load_dwordx4 v2, s[44:47], s26 offen offset:1024 sc1 lds
  v_add_f32 v225, v208, v209
  v_mfma_f32_16x16x32_bf16 v[140:143], a[148:151], v[84:87], v[140:143]
  v_exp_f32 v214, v126
  v_mfma_f32_16x16x32_bf16 v[96:99], a[152:155], v[56:59], v[96:99]
  ds_read_b128 a[184:187], v3 offset:22528
  v_cvt_pk_bf16_f32 v172, v208, v209
  v_mfma_f32_16x16x32_bf16 v[104:107], a[152:155], v[60:63], v[104:107]
  v_exp_f32 v215, v127
  v_mfma_f32_16x16x32_bf16 v[128:131], a[152:155], v[88:91], v[128:131]
  v_exp_f32 v216, v144
  v_mfma_f32_16x16x32_bf16 v[136:139], a[152:155], v[92:95], v[136:139]
  v_exp_f32 v217, v145
  v_mfma_f32_16x16x32_bf16 v[100:103], a[156:159], v[56:59], v[100:103]
  ds_read_b128 a[188:191], v3 offset:23552
  v_add_f32 v225, v225, v210
  v_mfma_f32_16x16x32_bf16 v[108:111], a[156:159], v[60:63], v[108:111]
  v_exp_f32 v218, v146
  v_mfma_f32_16x16x32_bf16 v[132:135], a[156:159], v[88:91], v[132:135]
  v_exp_f32 v219, v147
  v_mfma_f32_16x16x32_bf16 v[140:143], a[156:159], v[92:95], v[140:143]
  s_waitcnt lgkmcnt(4)
  v_exp_f32 v220, v148
  v_add_f32 v225, v225, v211
  v_mfma_f32_16x16x32_bf16 a[0:3], a[160:163], v[160:163], a[0:3]
  ds_read_b128 a[128:131], v3 offset:0
  v_cvt_pk_bf16_f32 v173, v210, v211
  v_mfma_f32_16x16x32_bf16 a[4:7], a[160:163], v[164:167], a[4:7]
  v_exp_f32 v221, v149
  v_mfma_f32_16x16x32_bf16 a[64:67], a[160:163], v[176:179], a[64:67]
  v_exp_f32 v222, v150
  v_mfma_f32_16x16x32_bf16 a[68:71], a[160:163], v[180:183], a[68:71]
  v_exp_f32 v223, v151
  v_mfma_f32_16x16x32_bf16 a[8:11], a[164:167], v[160:163], a[8:11]
  ds_read_b128 a[132:135], v3 offset:1024
  v_add_f32 v225, v225, v212
  v_mfma_f32_16x16x32_bf16 a[12:15], a[164:167], v[164:167], a[12:15]
  v_add_f32 v225, v225, v213
  v_cvt_pk_bf16_f32 v174, v212, v213
  v_mfma_f32_16x16x32_bf16 a[72:75], a[164:167], v[176:179], a[72:75]
  buffer_load_dwordx4 v2, s[44:47], s26 offen offset:2048 sc1 lds
  v_add_f32 v225, v225, v214
  v_mfma_f32_16x16x32_bf16 a[76:79], a[164:167], v[180:183], a[76:79]
  v_add_f32 v225, v225, v215
  v_cvt_pk_bf16_f32 v175, v214, v215
  v_mfma_f32_16x16x32_bf16 a[16:19], a[168:171], v[160:163], a[16:19]
  ds_read_b128 a[136:139], v3 offset:2048
  v_add_f32 v226, v216, v217
  v_mfma_f32_16x16x32_bf16 a[20:23], a[168:171], v[164:167], a[20:23]
  v_cvt_pk_bf16_f32 v184, v216, v217
  v_add_f32 v226, v226, v218
  v_mfma_f32_16x16x32_bf16 a[80:83], a[168:171], v[176:179], a[80:83]
  v_exp_f32 v216, v152
  v_mfma_f32_16x16x32_bf16 a[84:87], a[168:171], v[180:183], a[84:87]
  v_exp_f32 v217, v153
  v_mfma_f32_16x16x32_bf16 a[24:27], a[172:175], v[160:163], a[24:27]
  ds_read_b128 a[140:143], v3 offset:3072
  v_add_f32 v226, v226, v219
  v_cvt_pk_bf16_f32 v185, v218, v219
  v_mfma_f32_16x16x32_bf16 a[28:31], a[172:175], v[164:167], a[28:31]
  v_exp_f32 v218, v154
  v_mfma_f32_16x16x32_bf16 a[88:91], a[172:175], v[176:179], a[88:91]
  v_add_f32 v226, v226, v220
  v_add_f32 v226, v226, v221
  v_mfma_f32_16x16x32_bf16 a[92:95], a[172:175], v[180:183], a[92:95]
  s_waitcnt lgkmcnt(4)
  v_exp_f32 v219, v155
  v_mfma_f32_16x16x32_bf16 a[32:35], a[176:179], v[160:163], a[32:35]
  ds_read_b128 a[144:147], v3 offset:4096
  v_cvt_pk_bf16_f32 v186, v220, v221
  v_mfma_f32_16x16x32_bf16 a[36:39], a[176:179], v[164:167], a[36:39]
  v_exp_f32 v220, v156
  v_mfma_f32_16x16x32_bf16 a[96:99], a[176:179], v[176:179], a[96:99]
  v_add_f32 v226, v226, v222
  v_add_f32 v226, v226, v223
  v_mfma_f32_16x16x32_bf16 a[100:103], a[176:179], v[180:183], a[100:103]
  v_exp_f32 v221, v157
  v_mfma_f32_16x16x32_bf16 a[40:43], a[180:183], v[160:163], a[40:43]
  ds_read_b128 a[148:151], v3 offset:5120
  v_cvt_pk_bf16_f32 v187, v222, v223
  v_mfma_f32_16x16x32_bf16 a[44:47], a[180:183], v[164:167], a[44:47]
  v_exp_f32 v222, v158
  v_mfma_f32_16x16x32_bf16 a[104:107], a[180:183], v[176:179], a[104:107]
  buffer_load_dwordx4 v2, s[44:47], s26 offen offset:3072 sc1 lds
  v_add_f32 v227, v216, v217
  v_mfma_f32_16x16x32_bf16 a[108:111], a[180:183], v[180:183], a[108:111]
  s_add_u32 s26, s26, 16384
  v_exp_f32 v223, v159
  v_mfma_f32_16x16x32_bf16 a[48:51], a[184:187], v[160:163], a[48:51]
  s_add_u32 s24, s24, 32768
  ds_read_b128 a[152:155], v3 offset:6144
  v_cvt_pk_bf16_f32 v188, v216, v217
  v_add_f32 v227, v227, v218
  v_mfma_f32_16x16x32_bf16 a[52:55], a[184:187], v[164:167], a[52:55]
  s_and_b32 s24, s24, 0x1ffff
  v_add_f32 v227, v227, v219
  v_cvt_pk_bf16_f32 v189, v218, v219
  v_mfma_f32_16x16x32_bf16 a[112:115], a[184:187], v[176:179], a[112:115]
  v_max3_f32 v5, v224, v225, v226
  v_add_f32 v227, v227, v220
  v_mfma_f32_16x16x32_bf16 a[116:119], a[184:187], v[180:183], a[116:119]
  v_add_f32 v227, v227, v221
  v_cvt_pk_bf16_f32 v190, v220, v221
  v_mfma_f32_16x16x32_bf16 a[56:59], a[188:191], v[160:163], a[56:59]
  ds_read_b128 a[156:159], v3 offset:7168
  v_add_f32 v227, v227, v222
  v_mfma_f32_16x16x32_bf16 a[60:63], a[188:191], v[164:167], a[60:63]
  v_add_f32 v227, v227, v223
  v_cvt_pk_bf16_f32 v191, v222, v223
  v_mfma_f32_16x16x32_bf16 a[120:123], a[188:191], v[176:179], a[120:123]
  s_waitcnt lgkmcnt(4)
  v_max_f32 v5, v5, v227
  v_cmp_lt_f32 vcc, s81, v5
  v_mfma_f32_16x16x32_bf16 a[124:127], a[188:191], v[180:183], a[124:127]
  s_cbranch_vccnz fa_stub3
fa_back3:
  v_add_f32 v228, v228, v224
  v_add_f32 v229, v229, v225
  v_add_f32 v230, v230, v226
  v_add_f32 v231, v231, v227
  v_mfma_f32_16x16x32_bf16 v[144:147], a[128:131], v[64:67], v[200:203]
  ds_read_b128 a[160:163], v3 offset:24576
  v_cndmask_b32 v96, v4, v96, s[68:69]
  v_cndmask_b32 v97, v4, v97, s[70:71]
  v_mfma_f32_16x16x32_bf16 v[152:155], a[128:131], v[68:71], v[204:207]
  v_cndmask_b32 v98, v4, v98, s[72:73]
  v_cndmask_b32 v99, v4, v99, s[74:75]
  v_mov_b32 v100, v4
  v_mfma_f32_16x16x32_bf16 v[148:151], a[132:135], v[64:67], v[200:203]
  ds_read_b128 a[164:167], v3 offset:25600
  v_mov_b32 v101, v4
  v_mov_b32 v102, v4
  v_mfma_f32_16x16x32_bf16 v[156:159], a[132:135], v[68:71], v[204:207]
  v_mov_b32 v103, v4
  v_cndmask_b32 v108, v4, v108, s[68:69]
  v_cndmask_b32 v109, v4, v109, s[70:71]
  v_mfma_f32_16x16x32_bf16 v[144:147], a[136:139], v[72:75], v[144:147]
  ds_read_b128 a[168:171], v3 offset:26624
  v_cndmask_b32 v110, v4, v110, s[72:73]
  v_cndmask_b32 v111, v4, v111, s[74:75]
  v_mfma_f32_16x16x32_bf16 v[152:155], a[136:139], v[76:79], v[152:155]
  s_mov_b32 m0, s25
  v_exp_f32 v208, v96
  v_exp_f32 v209, v97
  v_mfma_f32_16x16x32_bf16 v[148:151], a[140:143], v[72:75], v[148:151]
  ds_read_b128 a[172:175], v3 offset:27648
  buffer_load_dwordx4 v2, s[48:51], s27 offen offset:0 sc1 lds
  v_mfma_f32_16x16x32_bf16 v[156:159], a[140:143], v[76:79], v[156:159]
  s_waitcnt lgkmcnt(4)
  v_exp_f32 v210, v98
  v_add_f32 v224, v208, v209
  v_mfma_f32_16x16x32_bf16 v[144:147], a[144:147], v[80:83], v[144:147]
  ds_read_b128 a[176:179], v3 offset:28672
  v_exp_f32 v211, v99
  v_mfma_f32_16x16x32_bf16 v[152:155], a[144:147], v[84:87], v[152:155]
  v_exp_f32 v212, v100
  v_cvt_pk_bf16_f32 v160, v208, v209
  v_mfma_f32_16x16x32_bf16 v[148:151], a[148:151], v[80:83], v[148:151]
  ds_read_b128 a[180:183], v3 offset:29696
  v_exp_f32 v213, v101
  v_mfma_f32_16x16x32_bf16 v[156:159], a[148:151], v[84:87], v[156:159]
  v_exp_f32 v214, v102
  v_add_f32 v224, v224, v210
  v_add_f32 v224, v224, v211
  v_mfma_f32_16x16x32_bf16 v[144:147], a[152:155], v[88:91], v[144:147]
  ds_read_b128 a[184:187], v3 offset:30720
  v_cvt_pk_bf16_f32 v161, v210, v211
  v_add_f32 v224, v224, v212
  v_mfma_f32_16x16x32_bf16 v[152:155], a[152:155], v[92:95], v[152:155]
  v_exp_f32 v215, v103
  v_add_f32 v224, v224, v213
  v_mfma_f32_16x16x32_bf16 v[148:151], a[156:159], v[88:91], v[148:151]
  ds_read_b128 a[188:191], v3 offset:31744
  v_cvt_pk_bf16_f32 v162, v212, v213
  v_add_f32 v224, v224, v214
  v_mfma_f32_16x16x32_bf16 v[156:159], a[156:159], v[92:95], v[156:159]
  s_waitcnt lgkmcnt(4)
  v_exp_f32 v208, v104
  v_add_f32 v224, v224, v215
  v_mfma_f32_16x16x32_bf16 a[0:3], a[160:163], v[168:171], a[0:3]
  ds_read_b128 a[128:131], v3 offset:8192
  v_cvt_pk_bf16_f32 v163, v214, v215
  v_exp_f32 v209, v105
  v_mfma_f32_16x16x32_bf16 a[4:7], a[160:163], v[172:175], a[4:7]
  v_exp_f32 v210, v106
  v_mfma_f32_16x16x32_bf16 a[64:67], a[160:163], v[184:187], a[64:67]
  buffer_load_dwordx4 v2, s[48:51], s27 offen offset:1024 sc1 lds
  v_exp_f32 v211, v107
  v_mfma_f32_16x16x32_bf16 a[68:71], a[160:163], v[188:191], a[68:71]
  v_exp_f32 v212, v108
  v_add_f32 v225, v208, v209
  v_mfma_f32_16x16x32_bf16 a[8:11], a[164:167], v[168:171], a[8:11]
  ds_read_b128 a[132:135], v3 offset:9216
  v_exp_f32 v213, v109
  v_mfma_f32_16x16x32_bf16 a[12:15], a[164:167], v[172:175], a[12:15]
  v_exp_f32 v214, v110
  v_cvt_pk_bf16_f32 v164, v208, v209
  v_mfma_f32_16x16x32_bf16 a[72:75], a[164:167], v[184:187], a[72:75]
  v_exp_f32 v215, v111
  v_add_f32 v225, v225, v210
  v_mfma_f32_16x16x32_bf16 a[76:79], a[164:167], v[188:191], a[76:79]
  v_exp_f32 v216, v128
  v_add_f32 v225, v225, v211
  v_mfma_f32_16x16x32_bf16 a[16:19], a[168:171], v[168:171], a[16:19]
  ds_read_b128 a[136:139], v3 offset:10240
  v_exp_f32 v217, v129
  v_mfma_f32_16x16x32_bf16 a[20:23], a[168:171], v[172:175], a[20:23]
  v_exp_f32 v218, v130
  v_cvt_pk_bf16_f32 v165, v210, v211
  v_mfma_f32_16x16x32_bf16 a[80:83], a[168:171], v[184:187], a[80:83]
  v_exp_f32 v219, v131
  v_add_f32 v225, v225, v212
  v_mfma_f32_16x16x32_bf16 a[84:87], a[168:171], v[188:191], a[84:87]
  v_exp_f32 v220, v132
  v_add_f32 v225, v225, v213
  v_mfma_f32_16x16x32_bf16 a[24:27], a[172:175], v[168:171], a[24:27]
  ds_read_b128 a[140:143], v3 offset:11264
  v_exp_f32 v221, v133
  v_mfma_f32_16x16x32_bf16 a[28:31], a[172:175], v[172:175], a[28:31]
  v_exp_f32 v222, v134
  v_cvt_pk_bf16_f32 v166, v212, v213
  v_mfma_f32_16x16x32_bf16 a[88:91], a[172:175], v[184:187], a[88:91]
  buffer_load_dwordx4 v2, s[48:51], s27 offen offset:2048 sc1 lds
  v_exp_f32 v223, v135
  v_mfma_f32_16x16x32_bf16 a[92:95], a[172:175], v[188:191], a[92:95]
  s_waitcnt lgkmcnt(4)
  v_add_f32 v225, v225, v214
  v_add_f32 v225, v225, v215
  v_cvt_pk_bf16_f32 v167, v214, v215
  v_mfma_f32_16x16x32_bf16 a[32:35], a[176:179], v[168:171], a[32:35]
  ds_read_b128 a[144:147], v3 offset:12288
  v_add_f32 v226, v216, v217
  v_cvt_pk_bf16_f32 v176, v216, v217
  v_mfma_f32_16x16x32_bf16 a[36:39], a[176:179], v[172:175], a[36:39]
  v_exp_f32 v216, v136
  v_add_f32 v226, v226, v218
  v_mfma_f32_16x16x32_bf16 a[96:99], a[176:179], v[184:187], a[96:99]
  v_exp_f32 v217, v137
  v_add_f32 v226, v226, v219
  v_mfma_f32_16x16x32_bf16 a[100:103], a[176:179], v[188:191], a[100:103]
  v_cvt_pk_bf16_f32 v177, v218, v219
  v_add_f32 v226, v226, v220
  v_add_f32 v226, v226, v221
  v_cvt_pk_bf16_f32 v178, v220, v221
  v_mfma_f32_16x16x32_bf16 a[40:43], a[180:183], v[168:171], a[40:43]
  ds_read_b128 a[148:151], v3 offset:13312
  v_add_f32 v226, v226, v222
  v_add_f32 v226, v226, v223
  v_mfma_f32_16x16x32_bf16 a[44:47], a[180:183], v[172:175], a[44:47]
  v_exp_f32 v218, v138
  v_cvt_pk_bf16_f32 v179, v222, v223
  v_mfma_f32_16x16x32_bf16 a[104:107], a[180:183], v[184:187], a[104:107]
  v_exp_f32 v219, v139
  v_add_f32 v227, v216, v217
  v_mfma_f32_16x16x32_bf16 a[108:111], a[180:183], v[188:191], a[108:111]
  v_exp_f32 v220, v140
  v_cvt_pk_bf16_f32 v180, v216, v217
  v_mfma_f32_16x16x32_bf16 a[48:51], a[184:187], v[168:171], a[48:51]
  ds_read_b128 a[152:155], v3 offset:14336
  v_add_f32 v227, v227, v218
  v_add_f32 v227, v227, v219
  v_mfma_f32_16x16x32_bf16 a[52:55], a[184:187], v[172:175], a[52:55]
  v_exp_f32 v221, v141
  v_cvt_pk_bf16_f32 v181, v218, v219
  v_mfma_f32_16x16x32_bf16 a[112:115], a[184:187], v[184:187], a[112:115]
  buffer_load_dwordx4 v2, s[48:51], s27 offen offset:3072 sc1 lds
  v_max3_f32 v5, v224, v225, v226
  v_add_f32 v227, v227, v220
  v_mfma_f32_16x16x32_bf16 a[116:119], a[184:187], v[188:191], a[116:119]
  s_add_u32 s27, s27, 16384
  v_exp_f32 v222, v142
  v_add_f32 v227, v227, v221
  v_mfma_f32_16x16x32_bf16 a[56:59], a[188:191], v[168:171], a[56:59]
  s_add_u32 s25, s25, 32768
  ds_read_b128 a[156:159], v3 offset:15360
  v_cvt_pk_bf16_f32 v182, v220, v221
  v_add_f32 v227, v227, v222
  v_mfma_f32_16x16x32_bf16 a[60:63], a[188:191], v[172:175], a[60:63]
  s_and_b32 s25, s25, 0x1ffff
  v_exp_f32 v223, v143
  v_mfma_f32_16x16x32_bf16 a[120:123], a[188:191], v[184:187], a[120:123]
  s_waitcnt lgkmcnt(4)
  v_add_f32 v227, v227, v223
  v_cvt_pk_bf16_f32 v183, v222, v223
  v_max_f32 v5, v5, v227
  v_cmp_lt_f32 vcc, s81, v5
  v_mfma_f32_16x16x32_bf16 a[124:127], a[188:191], v[188:191], a[124:127]
  s_cbranch_vccnz fa_stub4
fa_back4:
  v_add_f32 v228, v228, v224
  v_add_f32 v229, v229, v225
  v_add_f32 v230, v230, v226
  v_add_f32 v231, v231, v227
  v_add_u32 v3, 32768, v3
  v_and_b32 v3, 0x1ffff, v3
fa_AV:
  v_mfma_f32_16x16x32_bf16 v[128:131], a[128:131], v[64:67], v[200:203]
  s_waitcnt vmcnt(12)
  v_exp_f32 v216, v144
  v_mfma_f32_16x16x32_bf16 v[136:139], a[128:131], v[68:71], v[204:207]
  s_barrier
  v_exp_f32 v217, v145
  v_mfma_f32_16x16x32_bf16 v[132:135], a[132:135], v[64:67], v[200:203]
  ds_read_b128 a[160:163], v3 offset:16384
  ds_read_b128 a[164:167], v3 offset:17408
  v_mfma_f32_16x16x32_bf16 v[140:143], a[132:135], v[68:71], v[204:207]
  v_exp_f32 v218, v146
  v_mfma_f32_16x16x32_bf16 v[128:131], a[136:139], v[72:75], v[128:131]
  ds_read_b128 a[168:171], v3 offset:18432
  v_add_f32 v226, v216, v217
  v_mfma_f32_16x16x32_bf16 v[136:139], a[136:139], v[76:79], v[136:139]
  s_mov_b32 m0, s24
  v_exp_f32 v219, v147
  v_mfma_f32_16x16x32_bf16 v[132:135], a[140:143], v[72:75], v[132:135]
  ds_read_b128 a[172:175], v3 offset:19456
  buffer_load_dwordx4 v2, s[44:47], s26 offen offset:0 sc1 lds
  v_mfma_f32_16x16x32_bf16 v[140:143], a[140:143], v[76:79], v[140:143]
  s_waitcnt lgkmcnt(4)
  v_exp_f32 v220, v148
  v_mfma_f32_16x16x32_bf16 v[128:131], a[144:147], v[80:83], v[128:131]
  ds_read_b128 a[176:179], v3 offset:20480
  v_cvt_pk_bf16_f32 v184, v216, v217
  v_mfma_f32_16x16x32_bf16 v[136:139], a[144:147], v[84:87], v[136:139]
  v_exp_f32 v221, v149
  v_mfma_f32_16x16x32_bf16 v[132:135], a[148:151], v[80:83], v[132:135]
  ds_read_b128 a[180:183], v3 offset:21504
  v_add_f32 v226, v226, v218
  v_mfma_f32_16x16x32_bf16 v[140:143], a[148:151], v[84:87], v[140:143]
  v_exp_f32 v222, v150
  v_mfma_f32_16x16x32_bf16 v[128:131], a[152:155], v[88:91], v[128:131]
  ds_read_b128 a[184:187], v3 offset:22528
  v_add_f32 v226, v226, v219
  v_mfma_f32_16x16x32_bf16 v[136:139], a[152:155], v[92:95], v[136:139]
  v_exp_f32 v223, v151
  v_mfma_f32_16x16x32_bf16 v[132:135], a[156:159], v[88:91], v[132:135]
  ds_read_b128 a[188:191], v3 offset:23552
  v_cvt_pk_bf16_f32 v185, v218, v219
  v_mfma_f32_16x16x32_bf16 v[140:143], a[156:159], v[92:95], v[140:143]
  s_waitcnt lgkmcnt(4)
  v_exp_f32 v216, v152
  v_mfma_f32_16x16x32_bf16 a[0:3], a[160:163], v[160:163], a[0:3]
  ds_read_b128 a[128:131], v3 offset:0
  v_add_f32 v226, v226, v220
  v_mfma_f32_16x16x32_bf16 a[4:7], a[160:163], v[164:167], a[4:7]
  v_exp_f32 v217, v153
  v_mfma_f32_16x16x32_bf16 a[64:67], a[160:163], v[176:179], a[64:67]
  buffer_load_dwordx4 v2, s[44:47], s26 offen offset:1024 sc1 lds
  v_add_f32 v226, v226, v221
  v_mfma_f32_16x16x32_bf16 a[68:71], a[160:163], v[180:183], a[68:71]
  v_exp_f32 v218, v154
  v_mfma_f32_16x16x32_bf16 a[8:11], a[164:167], v[160:163], a[8:11]
  ds_read_b128 a[132:135], v3 offset:1024
  v_cvt_pk_bf16_f32 v186, v220, v221
  v_mfma_f32_16x16x32_bf16 a[12:15], a[164:167], v[164:167], a[12:15]
  v_exp_f32 v219, v155
  v_mfma_f32_16x16x32_bf16 a[72:75], a[164:167], v[176:179], a[72:75]
  v_exp_f32 v220, v156
  v_mfma_f32_16x16x32_bf16 a[76:79], a[164:167], v[180:183], a[76:79]
  v_add_f32 v226, v226, v222
  v_add_f32 v226, v226, v223
  v_mfma_f32_16x16x32_bf16 a[16:19], a[168:171], v[160:163], a[16:19]
  ds_read_b128 a[136:139], v3 offset:2048
  v_cvt_pk_bf16_f32 v187, v222, v223
  v_mfma_f32_16x16x32_bf16 a[20:23], a[168:171], v[164:167], a[20:23]
  v_exp_f32 v221, v157
  v_mfma_f32_16x16x32_bf16 a[80:83], a[168:171], v[176:179], a[80:83]
  v_exp_f32 v222, v158
  v_mfma_f32_16x16x32_bf16 a[84:87], a[168:171], v[180:183], a[84:87]
  v_exp_f32 v223, v159
  v_mfma_f32_16x16x32_bf16 a[24:27], a[172:175], v[160:163], a[24:27]
  ds_read_b128 a[140:143], v3 offset:3072
  v_add_f32 v227, v216, v217
  v_mfma_f32_16x16x32_bf16 a[28:31], a[172:175], v[164:167], a[28:31]
  v_cvt_pk_bf16_f32 v188, v216, v217
  v_add_f32 v227, v227, v218
  v_mfma_f32_16x16x32_bf16 a[88:91], a[172:175], v[176:179], a[88:91]
  buffer_load_dwordx4 v2, s[44:47], s26 offen offset:2048 sc1 lds
  v_add_f32 v227, v227, v219
  v_mfma_f32_16x16x32_bf16 a[92:95], a[172:175], v[180:183], a[92:95]
  s_waitcnt lgkmcnt(4)
  v_cvt_pk_bf16_f32 v189, v218, v219
  v_add_f32 v227, v227, v220
  v_mfma_f32_16x16x32_bf16 a[32:35], a[176:179], v[160:163], a[32:35]
  ds_read_b128 a[144:147], v3 offset:4096
  v_add_f32 v227, v227, v221
  v_mfma_f32_16x16x32_bf16 a[36:39], a[176:179], v[164:167], a[36:39]
  v_cvt_pk_bf16_f32 v190, v220, v221
  v_add_f32 v227, v227, v222
  v_mfma_f32_16x16x32_bf16 a[96:99], a[176:179], v[176:179], a[96:99]
  v_add_f32 v227, v227, v223
  v_cvt_pk_bf16_f32 v191, v222, v223
  v_mfma_f32_16x16x32_bf16 a[100:103], a[176:179], v[180:183], a[100:103]
  v_max_f32 v5, v226, v227
  v_cmp_lt_f32 vcc, s81, v5
  v_mfma_f32_16x16x32_bf16 a[40:43], a[180:183], v[160:163], a[40:43]
  ds_read_b128 a[148:151], v3 offset:5120
  v_mfma_f32_16x16x32_bf16 a[44:47], a[180:183], v[164:167], a[44:47]
  v_mfma_f32_16x16x32_bf16 a[104:107], a[180:183], v[176:179], a[104:107]
  v_mfma_f32_16x16x32_bf16 a[108:111], a[180:183], v[180:183], a[108:111]
  v_mfma_f32_16x16x32_bf16 a[48:51], a[184:187], v[160:163], a[48:51]
  ds_read_b128 a[152:155], v3 offset:6144
  v_mfma_f32_16x16x32_bf16 a[52:55], a[184:187], v[164:167], a[52:55]
  v_mfma_f32_16x16x32_bf16 a[112:115], a[184:187], v[176:179], a[112:115]
  buffer_load_dwordx4 v2, s[44:47], s26 offen offset:3072 sc1 lds
  v_mfma_f32_16x16x32_bf16 a[116:119], a[184:187], v[180:183], a[116:119]
  s_add_u32 s26, s26, 16384
  v_mfma_f32_16x16x32_bf16 a[56:59], a[188:191], v[160:163], a[56:59]
  s_add_u32 s24, s24, 32768
  ds_read_b128 a[156:159], v3 offset:7168
  v_mfma_f32_16x16x32_bf16 a[60:63], a[188:191], v[164:167], a[60:63]
  s_and_b32 s24, s24, 0x1ffff
  v_mfma_f32_16x16x32_bf16 a[120:123], a[188:191], v[176:179], a[120:123]
  s_waitcnt lgkmcnt(4)
  v_mfma_f32_16x16x32_bf16 a[124:127], a[188:191], v[180:183], a[124:127]
  s_cbranch_vccnz fa_stub5
fa_back5:
  v_add_f32 v230, v230, v226
  v_add_f32 v231, v231, v227
  v_mfma_f32_16x16x32_bf16 v[144:147], a[128:131], v[64:67], v[200:203]
  ds_read_b128 a[160:163], v3 offset:24576
  v_exp_f32 v216, v128
  v_mfma_f32_16x16x32_bf16 v[152:155], a[128:131], v[68:71], v[204:207]
  v_exp_f32 v217, v129
  v_mfma_f32_16x16x32_bf16 v[148:151], a[132:135], v[64:67], v[200:203]
  ds_read_b128 a[164:167], v3 offset:25600
  v_add_f32 v226, v216, v217
  v_mfma_f32_16x16x32_bf16 v[156:159], a[132:135], v[68:71], v[204:207]
  s_mov_b32 m0, s25
  v_exp_f32 v218, v130
  v_cvt_pk_bf16_f32 v176, v216, v217
  v_mfma_f32_16x16x32_bf16 v[144:147], a[136:139], v[72:75], v[144:147]
  ds_read_b128 a[168:171], v3 offset:26624
  buffer_load_dwordx4 v2, s[48:51], s27 offen offset:0 sc1 lds
  v_mfma_f32_16x16x32_bf16 v[152:155], a[136:139], v[76:79], v[152:155]
  v_exp_f32 v219, v131
  v_add_f32 v226, v226, v218
  v_mfma_f32_16x16x32_bf16 v[148:151], a[140:143], v[72:75], v[148:151]
  ds_read_b128 a[172:175], v3 offset:27648
  v_add_f32 v226, v226, v219
  v_mfma_f32_16x16x32_bf16 v[156:159], a[140:143], v[76:79], v[156:159]
  s_waitcnt lgkmcnt(4)
  v_exp_f32 v220, v132
  v_cvt_pk_bf16_f32 v177, v218, v219
  v_mfma_f32_16x16x32_bf16 v[144:147], a[144:147], v[80:83], v[144:147]
  ds_read_b128 a[176:179], v3 offset:28672
  v_add_f32 v226, v226, v220
  v_mfma_f32_16x16x32_bf16 v[152:155], a[144:147], v[84:87], v[152:155]
  v_exp_f32 v221, v133
  v_exp_f32 v222, v134
  v_mfma_f32_16x16x32_bf16 v[148:151], a[148:151], v[80:83], v[148:151]
  ds_read_b128 a[180:183], v3 offset:29696
  buffer_load_dwordx4 v2, s[48:51], s27 offen offset:1024 sc1 lds
  v_mfma_f32_16x16x32_bf16 v[156:159], a[148:151], v[84:87], v[156:159]
  v_exp_f32 v223, v135
  v_mfma_f32_16x16x32_bf16 v[144:147], a[152:155], v[88:91], v[144:147]
  ds_read_b128 a[184:187], v3 offset:30720
  v_add_f32 v226, v226, v221
  v_mfma_f32_16x16x32_bf16 v[152:155], a[152:155], v[92:95], v[152:155]
  v_exp_f32 v216, v136
  v_mfma_f32_16x16x32_bf16 v[148:151], a[156:159], v[88:91], v[148:151]
  ds_read_b128 a[188:191], v3 offset:31744
  v_cvt_pk_bf16_f32 v178, v220, v221
  v_add_f32 v226, v226, v222
  v_mfma_f32_16x16x32_bf16 v[156:159], a[156:159], v[92:95], v[156:159]
  s_waitcnt lgkmcnt(4)
  v_exp_f32 v217, v137
  v_mfma_f32_16x16x32_bf16 a[64:67], a[160:163], v[184:187], a[64:67]
  ds_read_b128 a[128:131], v3 offset:8192
  v_add_f32 v226, v226, v223
  v_cvt_pk_bf16_f32 v179, v222, v223
  v_mfma_f32_16x16x32_bf16 a[68:71], a[160:163], v[188:191], a[68:71]
  v_exp_f32 v218, v138
  v_mfma_f32_16x16x32_bf16 a[72:75], a[164:167], v[184:187], a[72:75]
  ds_read_b128 a[132:135], v3 offset:9216
  buffer_load_dwordx4 v2, s[48:51], s27 offen offset:2048 sc1 lds
  v_add_f32 v227, v216, v217
  v_mfma_f32_16x16x32_bf16 a[76:79], a[164:167], v[188:191], a[76:79]
  v_exp_f32 v219, v139
  v_mfma_f32_16x16x32_bf16 a[80:83], a[168:171], v[184:187], a[80:83]
  ds_read_b128 a[136:139], v3 offset:10240
  v_cvt_pk_bf16_f32 v180, v216, v217
  v_mfma_f32_16x16x32_bf16 a[84:87], a[168:171], v[188:191], a[84:87]
  v_exp_f32 v220, v140
  v_add_f32 v227, v227, v218
  v_mfma_f32_16x16x32_bf16 a[88:91], a[172:175], v[184:187], a[88:91]
  ds_read_b128 a[140:143], v3 offset:11264
  v_add_f32 v227, v227, v219
  v_mfma_f32_16x16x32_bf16 a[92:95], a[172:175], v[188:191], a[92:95]
  s_waitcnt lgkmcnt(4)
  v_exp_f32 v221, v141
  v_cvt_pk_bf16_f32 v181, v218, v219
  v_mfma_f32_16x16x32_bf16 a[96:99], a[176:179], v[184:187], a[96:99]
  ds_read_b128 a[144:147], v3 offset:12288
  buffer_load_dwordx4 v2, s[48:51], s27 offen offset:3072 sc1 lds
  v_mfma_f32_16x16x32_bf16 a[100:103], a[176:179], v[188:191], a[100:103]
  s_add_u32 s27, s27, 16384
  v_exp_f32 v222, v142
  v_add_f32 v227, v227, v220
  v_mfma_f32_16x16x32_bf16 a[104:107], a[180:183], v[184:187], a[104:107]
  s_add_u32 s25, s25, 32768
  ds_read_b128 a[148:151], v3 offset:13312
  v_add_f32 v227, v227, v221
  v_mfma_f32_16x16x32_bf16 a[108:111], a[180:183], v[188:191], a[108:111]
  s_and_b32 s25, s25, 0x1ffff
  v_exp_f32 v223, v143
  v_cvt_pk_bf16_f32 v182, v220, v221
  v_mfma_f32_16x16x32_bf16 a[112:115], a[184:187], v[184:187], a[112:115]
  ds_read_b128 a[152:155], v3 offset:14336
  v_add_f32 v227, v227, v222
  v_mfma_f32_16x16x32_bf16 a[116:119], a[184:187], v[188:191], a[116:119]
  v_add_f32 v227, v227, v223
  v_cvt_pk_bf16_f32 v183, v222, v223
  v_max_f32 v5, v226, v227
  v_mfma_f32_16x16x32_bf16 a[120:123], a[188:191], v[184:187], a[120:123]
  s_waitcnt lgkmcnt(3)
  ds_read_b128 a[156:159], v3 offset:15360
  v_cmp_lt_f32 vcc, s81, v5
  v_mfma_f32_16x16x32_bf16 a[124:127], a[188:191], v[188:191], a[124:127]
  s_cbranch_vccnz fa_stub6
fa_back6:
  v_add_f32 v230, v230, v226
  v_add_f32 v231, v231, v227
  v_add_u32 v3, 32768, v3
  v_and_b32 v3, 0x1ffff, v3
  s_branch fa_SSpre
fa_Aodd:
  v_mfma_f32_16x16x32_bf16 v[128:131], a[128:131], v[64:67], v[200:203]
  s_waitcnt vmcnt(12)
  v_cndmask_b32 v112, v4, v112, s[68:69]
  v_cndmask_b32 v113, v4, v113, s[70:71]
  v_cndmask_b32 v114, v4, v114, s[72:73]
  v_mfma_f32_16x16x32_bf16 v[136:139], a[128:131], v[68:71], v[204:207]
  s_barrier
  v_cndmask_b32 v115, v4, v115, s[74:75]
  v_mov_b32 v116, v4
  v_mov_b32 v117, v4
  v_mfma_f32_16x16x32_bf16 v[132:135], a[132:135], v[64:67], v[200:203]
  ds_read_b128 a[160:163], v3 offset:16384
  ds_read_b128 a[164:167], v3 offset:17408
  v_mov_b32 v118, v4
  v_mfma_f32_16x16x32_bf16 v[140:143], a[132:135], v[68:71], v[204:207]
  v_mov_b32 v119, v4
  v_cndmask_b32 v124, v4, v124, s[68:69]
  v_cndmask_b32 v125, v4, v125, s[70:71]
  v_mfma_f32_16x16x32_bf16 v[128:131], a[136:139], v[72:75], v[128:131]
  ds_read_b128 a[168:171], v3 offset:18432
  v_cndmask_b32 v126, v4, v126, s[72:73]
  v_cndmask_b32 v127, v4, v127, s[74:75]
  v_mfma_f32_16x16x32_bf16 v[136:139], a[136:139], v[76:79], v[136:139]
  s_mov_b32 m0, s24
  v_exp_f32 v208, v112
  v_exp_f32 v209, v113
  v_mfma_f32_16x16x32_bf16 v[132:135], a[140:143], v[72:75], v[132:135]
  ds_read_b128 a[172:175], v3 offset:19456
  buffer_load_dwordx4 v2, s[44:47], s26 offen offset:0 sc1 lds
  v_mfma_f32_16x16x32_bf16 v[140:143], a[140:143], v[76:79], v[140:143]
  s_waitcnt lgkmcnt(4)
  v_exp_f32 v210, v114
  v_add_f32 v224, v208, v209
  v_mfma_f32_16x16x32_bf16 v[128:131], a[144:147], v[80:83], v[128:131]
  ds_read_b128 a[176:179], v3 offset:20480
  v_exp_f32 v211, v115
  v_mfma_f32_16x16x32_bf16 v[136:139], a[144:147], v[84:87], v[136:139]
  v_exp_f32 v212, v116
  v_cvt_pk_bf16_f32 v168, v208, v209
  v_mfma_f32_16x16x32_bf16 v[132:135], a[148:151], v[80:83], v[132:135]
  ds_read_b128 a[180:183], v3 offset:21504
  v_exp_f32 v213, v117
  v_mfma_f32_16x16x32_bf16 v[140:143], a[148:151], v[84:87], v[140:143]
  v_exp_f32 v214, v118
  v_add_f32 v224, v224, v210
  v_add_f32 v224, v224, v211
  v_mfma_f32_16x16x32_bf16 v[128:131], a[152:155], v[88:91], v[128:131]
  ds_read_b128 a[184:187], v3 offset:22528
  v_cvt_pk_bf16_f32 v169, v210, v211
  v_add_f32 v224, v224, v212
  v_mfma_f32_16x16x32_bf16 v[136:139], a[152:155], v[92:95], v[136:139]
  v_exp_f32 v215, v119
  v_add_f32 v224, v224, v213
  v_mfma_f32_16x16x32_bf16 v[132:135], a[156:159], v[88:91], v[132:135]
  ds_read_b128 a[188:191], v3 offset:23552
  v_cvt_pk_bf16_f32 v170, v212, v213
  v_add_f32 v224, v224, v214
  v_mfma_f32_16x16x32_bf16 v[140:143], a[156:159], v[92:95], v[140:143]
  s_waitcnt lgkmcnt(4)
  v_exp_f32 v208, v120
  v_add_f32 v224, v224, v215
  v_mfma_f32_16x16x32_bf16 a[0:3], a[160:163], v[160:163], a[0:3]
  ds_read_b128 a[128:131], v3 offset:0
  v_cvt_pk_bf16_f32 v171, v214, v215
  v_exp_f32 v209, v121
  v_mfma_f32_16x16x32_bf16 a[4:7], a[160:163], v[164:167], a[4:7]
  v_exp_f32 v210, v122
  v_mfma_f32_16x16x32_bf16 a[64:67], a[160:163], v[176:179], a[64:67]
  buffer_load_dwordx4 v2, s[44:47], s26 offen offset:1024 sc1 lds
  v_exp_f32 v211, v123
  v_mfma_f32_16x16x32_bf16 a[68:71], a[160:163], v[180:183], a[68:71]
  v_exp_f32 v212, v124
  v_add_f32 v225, v208, v209
  v_mfma_f32_16x16x32_bf16 a[8:11], a[164:167], v[160:163], a[8:11]
  ds_read_b128 a[132:135], v3 offset:1024
  v_exp_f32 v213, v125
  v_mfma_f32_16x16x32_bf16 a[12:15], a[164:167], v[164:167], a[12:15]
  v_exp_f32 v214, v126
  v_cvt_pk_bf16_f32 v172, v208, v209
  v_mfma_f32_16x16x32_bf16 a[72:75], a[164:167], v[176:179], a[72:75]
  v_exp_f32 v215, v127
  v_add_f32 v225, v225, v210
  v_mfma_f32_16x16x32_bf16 a[76:79], a[164:167], v[180:183], a[76:79]
  v_exp_f32 v216, v144
  v_add_f32 v225, v225, v211
  v_mfma_f32_16x16x32_bf16 a[16:19], a[168:171], v[160:163], a[16:19]
  ds_read_b128 a[136:139], v3 offset:2048
  v_exp_f32 v217, v145
  v_mfma_f32_16x16x32_bf16 a[20:23], a[168:171], v[164:167], a[20:23]
  v_exp_f32 v218, v146
  v_cvt_pk_bf16_f32 v173, v210, v211
  v_mfma_f32_16x16x32_bf16 a[80:83], a[168:171], v[176:179], a[80:83]
  v_exp_f32 v219, v147
  v_add_f32 v225, v225, v212
  v_mfma_f32_16x16x32_bf16 a[84:87], a[168:171], v[180:183], a[84:87]
  v_exp_f32 v220, v148
  v_add_f32 v225, v225, v213
  v_mfma_f32_16x16x32_bf16 a[24:27], a[172:175], v[160:163], a[24:27]
  ds_read_b128 a[140:143], v3 offset:3072
  v_exp_f32 v221, v149
  v_mfma_f32_16x16x32_bf16 a[28:31], a[172:175], v[164:167], a[28:31]
  v_exp_f32 v222, v150
  v_cvt_pk_bf16_f32 v174, v212, v213
  v_mfma_f32_16x16x32_bf16 a[88:91], a[172:175], v[176:179], a[88:91]
  buffer_load_dwordx4 v2, s[44:47], s26 offen offset:2048 sc1 lds
  v_exp_f32 v223, v151
  v_mfma_f32_16x16x32_bf16 a[92:95], a[172:175], v[180:183], a[92:95]
  s_waitcnt lgkmcnt(4)
  v_add_f32 v225, v225, v214
  v_add_f32 v225, v225, v215
  v_cvt_pk_bf16_f32 v175, v214, v215
  v_mfma_f32_16x16x32_bf16 a[32:35], a[176:179], v[160:163], a[32:35]
  ds_read_b128 a[144:147], v3 offset:4096
  v_add_f32 v226, v216, v217
  v_cvt_pk_bf16_f32 v184, v216, v217
  v_mfma_f32_16x16x32_bf16 a[36:39], a[176:179], v[164:167], a[36:39]
  v_exp_f32 v216, v152
  v_add_f32 v226, v226, v218
  v_mfma_f32_16x16x32_bf16 a[96:99], a[176:179], v[176:179], a[96:99]
  v_exp_f32 v217, v153
  v_add_f32 v226, v226, v219
  v_mfma_f32_16x16x32_bf16 a[100:103], a[176:179], v[180:183], a[100:103]
  v_cvt_pk_bf16_f32 v185, v218, v219
  v_add_f32 v226, v226, v220
  v_add_f32 v226, v226, v221
  v_cvt_pk_bf16_f32 v186, v220, v221
  v_mfma_f32_16x16x32_bf16 a[40:43], a[180:183], v[160:163], a[40:43]
  ds_read_b128 a[148:151], v3 offset:5120
  v_add_f32 v226, v226, v222
  v_add_f32 v226, v226, v223
  v_mfma_f32_16x16x32_bf16 a[44:47], a[180:183], v[164:167], a[44:47]
  v_exp_f32 v218, v154
  v_cvt_pk_bf16_f32 v187, v222, v223
  v_mfma_f32_16x16x32_bf16 a[104:107], a[180:183], v[176:179], a[104:107]
  v_exp_f32 v219, v155
  v_add_f32 v227, v216, v217
  v_mfma_f32_16x16x32_bf16 a[108:111], a[180:183], v[180:183], a[108:111]
  v_exp_f32 v220, v156
  v_cvt_pk_bf16_f32 v188, v216, v217
  v_mfma_f32_16x16x32_bf16 a[48:51], a[184:187], v[160:163], a[48:51]
  ds_read_b128 a[152:155], v3 offset:6144
  v_add_f32 v227, v227, v218
  v_add_f32 v227, v227, v219
  v_mfma_f32_16x16x32_bf16 a[52:55], a[184:187], v[164:167], a[52:55]
  v_exp_f32 v221, v157
  v_cvt_pk_bf16_f32 v189, v218, v219
  v_mfma_f32_16x16x32_bf16 a[112:115], a[184:187], v[176:179], a[112:115]
  buffer_load_dwordx4 v2, s[44:47], s26 offen offset:3072 sc1 lds
  v_max3_f32 v5, v224, v225, v226
  v_add_f32 v227, v227, v220
  v_mfma_f32_16x16x32_bf16 a[116:119], a[184:187], v[180:183], a[116:119]
  s_add_u32 s26, s26, 16384
  v_exp_f32 v222, v158
  v_add_f32 v227, v227, v221
  v_mfma_f32_16x16x32_bf16 a[56:59], a[188:191], v[160:163], a[56:59]
  s_add_u32 s24, s24, 32768
  ds_read_b128 a[156:159], v3 offset:7168
  v_cvt_pk_bf16_f32 v190, v220, v221
  v_add_f32 v227, v227, v222
  v_mfma_f32_16x16x32_bf16 a[60:63], a[188:191], v[164:167], a[60:63]
  s_and_b32 s24, s24, 0x1ffff
  v_exp_f32 v223, v159
  v_mfma_f32_16x16x32_bf16 a[120:123], a[188:191], v[176:179], a[120:123]
  s_waitcnt lgkmcnt(4)
  v_add_f32 v227, v227, v223
  v_cvt_pk_bf16_f32 v191, v222, v223
  v_max_f32 v5, v5, v227
  v_cmp_lt_f32 vcc, s81, v5
  v_mfma_f32_16x16x32_bf16 a[124:127], a[188:191], v[180:183], a[124:127]
  s_cbranch_vccnz fa_stub7
fa_back7:
  v_add_f32 v228, v228, v224
  v_add_f32 v229, v229, v225
  v_add_f32 v230, v230, v226
  v_add_f32 v231, v231, v227
  v_mfma_f32_16x16x32_bf16 v[144:147], a[128:131], v[64:67], v[200:203]
  ds_read_b128 a[160:163], v3 offset:24576
  v_exp_f32 v216, v128
  v_mfma_f32_16x16x32_bf16 v[152:155], a[128:131], v[68:71], v[204:207]
  v_exp_f32 v217, v129
  v_mfma_f32_16x16x32_bf16 v[148:151], a[132:135], v[64:67], v[200:203]
  ds_read_b128 a[164:167], v3 offset:25600
  v_mfma_f32_16x16x32_bf16 v[156:159], a[132:135], v[68:71], v[204:207]
  v_exp_f32 v218, v130
  v_mfma_f32_16x16x32_bf16 v[144:147], a[136:139], v[72:75], v[144:147]
  ds_read_b128 a[168:171], v3 offset:26624
  v_add_f32 v226, v216, v217
  v_mfma_f32_16x16x32_bf16 v[152:155], a[136:139], v[76:79], v[152:155]
  s_mov_b32 m0, s25
  v_exp_f32 v219, v131
  v_mfma_f32_16x16x32_bf16 v[148:151], a[140:143], v[72:75], v[148:151]
  ds_read_b128 a[172:175], v3 offset:27648
  buffer_load_dwordx4 v2, s[48:51], s27 offen offset:0 sc1 lds
  v_mfma_f32_16x16x32_bf16 v[156:159], a[140:143], v[76:79], v[156:159]
  s_waitcnt lgkmcnt(4)
  v_exp_f32 v220, v132
  v_mfma_f32_16x16x32_bf16 v[144:147], a[144:147], v[80:83], v[144:147]
  ds_read_b128 a[176:179], v3 offset:28672
  v_cvt_pk_bf16_f32 v176, v216, v217
  v_mfma_f32_16x16x32_bf16 v[152:155], a[144:147], v[84:87], v[152:155]
  v_exp_f32 v221, v133
  v_mfma_f32_16x16x32_bf16 v[148:151], a[148:151], v[80:83], v[148:151]
  ds_read_b128 a[180:183], v3 offset:29696
  v_add_f32 v226, v226, v218
  v_mfma_f32_16x16x32_bf16 v[156:159], a[148:151], v[84:87], v[156:159]
  v_exp_f32 v222, v134
  v_mfma_f32_16x16x32_bf16 v[144:147], a[152:155], v[88:91], v[144:147]
  ds_read_b128 a[184:187], v3 offset:30720
  v_add_f32 v226, v226, v219
  v_mfma_f32_16x16x32_bf16 v[152:155], a[152:155], v[92:95], v[152:155]
  v_exp_f32 v223, v135
  v_mfma_f32_16x16x32_bf16 v[148:151], a[156:159], v[88:91], v[148:151]
  ds_read_b128 a[188:191], v3 offset:31744
  v_cvt_pk_bf16_f32 v177, v218, v219
  v_mfma_f32_16x16x32_bf16 v[156:159], a[156:159], v[92:95], v[156:159]
  s_waitcnt lgkmcnt(4)
  v_exp_f32 v216, v136
  v_mfma_f32_16x16x32_bf16 a[0:3], a[160:163], v[168:171], a[0:3]
  ds_read_b128 a[128:131], v3 offset:8192
  v_add_f32 v226, v226, v220
  v_mfma_f32_16x16x32_bf16 a[4:7], a[160:163], v[172:175], a[4:7]
  v_exp_f32 v217, v137
  v_mfma_f32_16x16x32_bf16 a[64:67], a[160:163], v[184:187], a[64:67]
  buffer_load_dwordx4 v2, s[48:51], s27 offen offset:1024 sc1 lds
  v_add_f32 v226, v226, v221
  v_mfma_f32_16x16x32_bf16 a[68:71], a[160:163], v[188:191], a[68:71]
  v_exp_f32 v218, v138
  v_mfma_f32_16x16x32_bf16 a[8:11], a[164:167], v[168:171], a[8:11]
  ds_read_b128 a[132:135], v3 offset:9216
  v_cvt_pk_bf16_f32 v178, v220, v221
  v_mfma_f32_16x16x32_bf16 a[12:15], a[164:167], v[172:175], a[12:15]
  v_exp_f32 v219, v139
  v_mfma_f32_16x16x32_bf16 a[72:75], a[164:167], v[184:187], a[72:75]
  v_exp_f32 v220, v140
  v_mfma_f32_16x16x32_bf16 a[76:79], a[164:167], v[188:191], a[76:79]
  v_add_f32 v226, v226, v222
  v_add_f32 v226, v226, v223
  v_mfma_f32_16x16x32_bf16 a[16:19], a[168:171], v[168:171], a[16:19]
  ds_read_b128 a[136:139], v3 offset:10240
  v_cvt_pk_bf16_f32 v179, v222, v223
  v_mfma_f32_16x16x32_bf16 a[20:23], a[168:171], v[172:175], a[20:23]
  v_exp_f32 v221, v141
  v_mfma_f32_16x16x32_bf16 a[80:83], a[168:171], v[184:187], a[80:83]
  v_exp_f32 v222, v142
  v_mfma_f32_16x16x32_bf16 a[84:87], a[168:171], v[188:191], a[84:87]
  v_exp_f32 v223, v143
  v_mfma_f32_16x16x32_bf16 a[24:27], a[172:175], v[168:171], a[24:27]
  ds_read_b128 a[140:143], v3 offset:11264
  v_add_f32 v227, v216, v217
  v_mfma_f32_16x16x32_bf16 a[28:31], a[172:175], v[172:175], a[28:31]
  v_cvt_pk_bf16_f32 v180, v216, v217
  v_add_f32 v227, v227, v218
  v_mfma_f32_16x16x32_bf16 a[88:91], a[172:175], v[184:187], a[88:91]
  buffer_load_dwordx4 v2, s[48:51], s27 offen offset:2048 sc1 lds
  v_add_f32 v227, v227, v219
  v_mfma_f32_16x16x32_bf16 a[92:95], a[172:175], v[188:191], a[92:95]
  s_waitcnt lgkmcnt(4)
  v_cvt_pk_bf16_f32 v181, v218, v219
  v_add_f32 v227, v227, v220
  v_mfma_f32_16x16x32_bf16 a[32:35], a[176:179], v[168:171], a[32:35]
  ds_read_b128 a[144:147], v3 offset:12288
  v_add_f32 v227, v227, v221
  v_mfma_f32_16x16x32_bf16 a[36:39], a[176:179], v[172:175], a[36:39]
  v_cvt_pk_bf16_f32 v182, v220, v221
  v_add_f32 v227, v227, v222
  v_mfma_f32_16x16x32_bf16 a[96:99], a[176:179], v[184:187], a[96:99]
  v_add_f32 v227, v227, v223
  v_cvt_pk_bf16_f32 v183, v222, v223
  v_mfma_f32_16x16x32_bf16 a[100:103], a[176:179], v[188:191], a[100:103]
  v_max_f32 v5, v226, v227
  v_cmp_lt_f32 vcc, s81, v5
  v_mfma_f32_16x16x32_bf16 a[40:43], a[180:183], v[168:171], a[40:43]
  ds_read_b128 a[148:151], v3 offset:13312
  v_mfma_f32_16x16x32_bf16 a[44:47], a[180:183], v[172:175], a[44:47]
  v_mfma_f32_16x16x32_bf16 a[104:107], a[180:183], v[184:187], a[104:107]
  v_mfma_f32_16x16x32_bf16 a[108:111], a[180:183], v[188:191], a[108:111]
  v_mfma_f32_16x16x32_bf16 a[48:51], a[184:187], v[168:171], a[48:51]
  ds_read_b128 a[152:155], v3 offset:14336
  v_mfma_f32_16x16x32_bf16 a[52:55], a[184:187], v[172:175], a[52:55]
  v_mfma_f32_16x16x32_bf16 a[112:115], a[184:187], v[184:187], a[112:115]
  buffer_load_dwordx4 v2, s[48:51], s27 offen offset:3072 sc1 lds
  v_mfma_f32_16x16x32_bf16 a[116:119], a[184:187], v[188:191], a[116:119]
  s_add_u32 s27, s27, 16384
  v_mfma_f32_16x16x32_bf16 a[56:59], a[188:191], v[168:171], a[56:59]
  s_add_u32 s25, s25, 32768
  ds_read_b128 a[156:159], v3 offset:15360
  v_mfma_f32_16x16x32_bf16 a[60:63], a[188:191], v[172:175], a[60:63]
  s_and_b32 s25, s25, 0x1ffff
  v_mfma_f32_16x16x32_bf16 a[120:123], a[188:191], v[184:187], a[120:123]
  s_waitcnt lgkmcnt(4)
  v_mfma_f32_16x16x32_bf16 a[124:127], a[188:191], v[188:191], a[124:127]
  s_cbranch_vccnz fa_stub8
fa_back8:
  v_add_f32 v230, v230, v226
  v_add_f32 v231, v231, v227
  v_add_u32 v3, 32768, v3
  v_and_b32 v3, 0x1ffff, v3
fa_SSpre:
  v_mov_b32 v16, 1073741824
  v_mov_b32 v17, 1
  v_writelane_b32 v16, s37, 0
  s_waitcnt vmcnt(8)
  buffer_store_dword v17, v16, s[40:43], 0 offen sc1
  s_mov_b32 s37, 1073741824
  s_cmp_eq_u32 s29, 0
  s_cbranch_scc1 fa_Bexit
.p2align 6
fa_SS:
  v_mfma_f32_16x16x32_bf16 v[128:131], a[128:131], v[64:67], v[200:203]
  s_waitcnt vmcnt(12)
  v_exp_f32 v216, v144
  v_mfma_f32_16x16x32_bf16 v[136:139], a[128:131], v[68:71], v[204:207]
  s_barrier
  v_exp_f32 v217, v145
  v_exp_f32 v218, v146
  v_mfma_f32_16x16x32_bf16 v[132:135], a[132:135], v[64:67], v[200:203]
  ds_read_b128 a[160:163], v3 offset:16384
  ds_read_b128 a[164:167], v3 offset:17408
  v_mfma_f32_16x16x32_bf16 v[140:143], a[132:135], v[68:71], v[204:207]
  s_mov_b32 m0, s24
  v_exp_f32 v219, v147
  v_mfma_f32_16x16x32_bf16 v[128:131], a[136:139], v[72:75], v[128:131]
  ds_read_b128 a[168:171], v3 offset:18432
  buffer_load_dwordx4 v2, s[44:47], s26 offen offset:0 sc1 lds
  v_mfma_f32_16x16x32_bf16 v[136:139], a[136:139], v[76:79], v[136:139]
  v_exp_f32 v220, v148
  v_add_f32 v226, v216, v217
  v_mfma_f32_16x16x32_bf16 v[132:135], a[140:143], v[72:75], v[132:135]
  ds_read_b128 a[172:175], v3 offset:19456
  v_cvt_pk_bf16_f32 v184, v216, v217
  v_mfma_f32_16x16x32_bf16 v[140:143], a[140:143], v[76:79], v[140:143]
  s_waitcnt lgkmcnt(4)
  v_exp_f32 v221, v149
  v_add_f32 v226, v226, v218
  v_mfma_f32_16x16x32_bf16 v[128:131], a[144:147], v[80:83], v[128:131]
  ds_read_b128 a[176:179], v3 offset:20480
  v_add_f32 v226, v226, v219
  v_mfma_f32_16x16x32_bf16 v[136:139], a[144:147], v[84:87], v[136:139]
  v_exp_f32 v222, v150
  v_cvt_pk_bf16_f32 v185, v218, v219
  v_mfma_f32_16x16x32_bf16 v[132:135], a[148:151], v[80:83], v[132:135]
  ds_read_b128 a[180:183], v3 offset:21504
  buffer_load_dwordx4 v2, s[44:47], s26 offen offset:1024 sc1 lds
  v_mfma_f32_16x16x32_bf16 v[140:143], a[148:151], v[84:87], v[140:143]
  v_exp_f32 v223, v151
  v_mfma_f32_16x16x32_bf16 v[128:131], a[152:155], v[88:91], v[128:131]
  ds_read_b128 a[184:187], v3 offset:22528
  v_add_f32 v226, v226, v220
  v_add_f32 v226, v226, v221
  v_mfma_f32_16x16x32_bf16 v[136:139], a[152:155], v[92:95], v[136:139]
  v_exp_f32 v216, v152
  v_mfma_f32_16x16x32_bf16 v[132:135], a[156:159], v[88:91], v[132:135]
  ds_read_b128 a[188:191], v3 offset:23552
  v_cvt_pk_bf16_f32 v186, v220, v221
  v_add_f32 v226, v226, v222
  v_mfma_f32_16x16x32_bf16 v[140:143], a[156:159], v[92:95], v[140:143]
  s_waitcnt lgkmcnt(4)
  v_exp_f32 v217, v153
  v_mfma_f32_16x16x32_bf16 a[64:67], a[160:163], v[176:179], a[64:67]
  ds_read_b128 a[128:131], v3 offset:0
  v_add_f32 v226, v226, v223
  v_cvt_pk_bf16_f32 v187, v222, v223
  v_mfma_f32_16x16x32_bf16 a[68:71], a[160:163], v[180:183], a[68:71]
  v_exp_f32 v218, v154
  v_mfma_f32_16x16x32_bf16 a[72:75], a[164:167], v[176:179], a[72:75]
  ds_read_b128 a[132:135], v3 offset:1024
  buffer_load_dwordx4 v2, s[44:47], s26 offen offset:2048 sc1 lds
  v_add_f32 v227, v216, v217
  v_mfma_f32_16x16x32_bf16 a[76:79], a[164:167], v[180:183], a[76:79]
  v_exp_f32 v219, v155
  v_mfma_f32_16x16x32_bf16 a[80:83], a[168:171], v[176:179], a[80:83]
  ds_read_b128 a[136:139], v3 offset:2048
  v_cvt_pk_bf16_f32 v188, v216, v217
  v_mfma_f32_16x16x32_bf16 a[84:87], a[168:171], v[180:183], a[84:87]
  v_exp_f32 v220, v156
  v_add_f32 v227, v227, v218
  v_mfma_f32_16x16x32_bf16 a[88:91], a[172:175], v[176:179], a[88:91]
  ds_read_b128 a[140:143], v3 offset:3072
  v_add_f32 v227, v227, v219
  v_mfma_f32_16x16x32_bf16 a[92:95], a[172:175], v[180:183], a[92:95]
  s_waitcnt lgkmcnt(4)
  v_exp_f32 v221, v157
  v_cvt_pk_bf16_f32 v189, v218, v219
  v_mfma_f32_16x16x32_bf16 a[96:99], a[176:179], v[176:179], a[96:99]
  ds_read_b128 a[144:147], v3 offset:4096
  buffer_load_dwordx4 v2, s[44:47], s26 offen offset:3072 sc1 lds
  v_mfma_f32_16x16x32_bf16 a[100:103], a[176:179], v[180:183], a[100:103]
  s_add_u32 s26, s26, 16384
  v_exp_f32 v222, v158
  v_add_f32 v227, v227, v220
  v_mfma_f32_16x16x32_bf16 a[104:107], a[180:183], v[176:179], a[104:107]
  s_add_u32 s24, s24, 32768
  ds_read_b128 a[148:151], v3 offset:5120
  v_add_f32 v227, v227, v221
  v_mfma_f32_16x16x32_bf16 a[108:111], a[180:183], v[180:183], a[108:111]
  s_and_b32 s24, s24, 0x1ffff
  v_exp_f32 v223, v159
  v_cvt_pk_bf16_f32 v190, v220, v221
  v_mfma_f32_16x16x32_bf16 a[112:115], a[184:187], v[176:179], a[112:115]
  ds_read_b128 a[152:155], v3 offset:6144
  v_add_f32 v227, v227, v222
  v_mfma_f32_16x16x32_bf16 a[116:119], a[184:187], v[180:183], a[116:119]
  v_add_f32 v227, v227, v223
  v_cvt_pk_bf16_f32 v191, v222, v223
  v_max_f32 v5, v226, v227
  v_mfma_f32_16x16x32_bf16 a[120:123], a[188:191], v[176:179], a[120:123]
  s_waitcnt lgkmcnt(3)
  ds_read_b128 a[156:159], v3 offset:7168
  v_cmp_lt_f32 vcc, s81, v5
  v_mfma_f32_16x16x32_bf16 a[124:127], a[188:191], v[180:183], a[124:127]
  s_cbranch_vccnz fa_stub9
fa_back9:
  v_add_f32 v230, v230, v226
  v_add_f32 v231, v231, v227
  v_mfma_f32_16x16x32_bf16 v[144:147], a[128:131], v[64:67], v[200:203]
  ds_read_b128 a[160:163], v3 offset:24576
  v_exp_f32 v216, v128
  v_mfma_f32_16x16x32_bf16 v[152:155], a[128:131], v[68:71], v[204:207]
  v_exp_f32 v217, v129
  v_mfma_f32_16x16x32_bf16 v[148:151], a[132:135], v[64:67], v[200:203]
  ds_read_b128 a[164:167], v3 offset:25600
  v_add_f32 v226, v216, v217
  v_mfma_f32_16x16x32_bf16 v[156:159], a[132:135], v[68:71], v[204:207]
  s_mov_b32 m0, s25
  v_exp_f32 v218, v130
  v_cvt_pk_bf16_f32 v176, v216, v217
  v_mfma_f32_16x16x32_bf16 v[144:147], a[136:139], v[72:75], v[144:147]
  ds_read_b128 a[168:171], v3 offset:26624
  buffer_load_dwordx4 v2, s[48:51], s27 offen offset:0 sc1 lds
  v_mfma_f32_16x16x32_bf16 v[152:155], a[136:139], v[76:79], v[152:155]
  v_exp_f32 v219, v131
  v_add_f32 v226, v226, v218
  v_mfma_f32_16x16x32_bf16 v[148:151], a[140:143], v[72:75], v[148:151]
  ds_read_b128 a[172:175], v3 offset:27648
  v_add_f32 v226, v226, v219
  v_mfma_f32_16x16x32_bf16 v[156:159], a[140:143], v[76:79], v[156:159]
  s_waitcnt lgkmcnt(4)
  v_exp_f32 v220, v132
  v_cvt_pk_bf16_f32 v177, v218, v219
  v_mfma_f32_16x16x32_bf16 v[144:147], a[144:147], v[80:83], v[144:147]
  ds_read_b128 a[176:179], v3 offset:28672
  v_add_f32 v226, v226, v220
  v_mfma_f32_16x16x32_bf16 v[152:155], a[144:147], v[84:87], v[152:155]
  v_exp_f32 v221, v133
  v_exp_f32 v222, v134
  v_mfma_f32_16x16x32_bf16 v[148:151], a[148:151], v[80:83], v[148:151]
  ds_read_b128 a[180:183], v3 offset:29696
  buffer_load_dwordx4 v2, s[48:51], s27 offen offset:1024 sc1 lds
  v_mfma_f32_16x16x32_bf16 v[156:159], a[148:151], v[84:87], v[156:159]
  v_exp_f32 v223, v135
  v_mfma_f32_16x16x32_bf16 v[144:147], a[152:155], v[88:91], v[144:147]
  ds_read_b128 a[184:187], v3 offset:30720
  v_add_f32 v226, v226, v221
  v_mfma_f32_16x16x32_bf16 v[152:155], a[152:155], v[92:95], v[152:155]
  v_exp_f32 v216, v136
  v_mfma_f32_16x16x32_bf16 v[148:151], a[156:159], v[88:91], v[148:151]
  ds_read_b128 a[188:191], v3 offset:31744
  v_cvt_pk_bf16_f32 v178, v220, v221
  v_add_f32 v226, v226, v222
  v_mfma_f32_16x16x32_bf16 v[156:159], a[156:159], v[92:95], v[156:159]
  s_waitcnt lgkmcnt(4)
  v_exp_f32 v217, v137
  v_mfma_f32_16x16x32_bf16 a[64:67], a[160:163], v[184:187], a[64:67]
  ds_read_b128 a[128:131], v3 offset:8192
  v_add_f32 v226, v226, v223
  v_cvt_pk_bf16_f32 v179, v222, v223
  v_mfma_f32_16x16x32_bf16 a[68:71], a[160:163], v[188:191], a[68:71]
  v_exp_f32 v218, v138
  v_mfma_f32_16x16x32_bf16 a[72:75], a[164:167], v[184:187], a[72:75]
  ds_read_b128 a[132:135], v3 offset:9216
  buffer_load_dwordx4 v2, s[48:51], s27 offen offset:2048 sc1 lds
  v_add_f32 v227, v216, v217
  v_mfma_f32_16x16x32_bf16 a[76:79], a[164:167], v[188:191], a[76:79]
  v_exp_f32 v219, v139
  v_mfma_f32_16x16x32_bf16 a[80:83], a[168:171], v[184:187], a[80:83]
  ds_read_b128 a[136:139], v3 offset:10240
  v_cvt_pk_bf16_f32 v180, v216, v217
  v_mfma_f32_16x16x32_bf16 a[84:87], a[168:171], v[188:191], a[84:87]
  v_exp_f32 v220, v140
  v_add_f32 v227, v227, v218
  v_mfma_f32_16x16x32_bf16 a[88:91], a[172:175], v[184:187], a[88:91]
  ds_read_b128 a[140:143], v3 offset:11264
  v_add_f32 v227, v227, v219
  v_mfma_f32_16x16x32_bf16 a[92:95], a[172:175], v[188:191], a[92:95]
  s_waitcnt lgkmcnt(4)
  v_exp_f32 v221, v141
  v_cvt_pk_bf16_f32 v181, v218, v219
  v_mfma_f32_16x16x32_bf16 a[96:99], a[176:179], v[184:187], a[96:99]
  ds_read_b128 a[144:147], v3 offset:12288
  buffer_load_dwordx4 v2, s[48:51], s27 offen offset:3072 sc1 lds
  v_mfma_f32_16x16x32_bf16 a[100:103], a[176:179], v[188:191], a[100:103]
  s_add_u32 s27, s27, 16384
  v_exp_f32 v222, v142
  v_add_f32 v227, v227, v220
  v_mfma_f32_16x16x32_bf16 a[104:107], a[180:183], v[184:187], a[104:107]
  s_add_u32 s25, s25, 32768
  ds_read_b128 a[148:151], v3 offset:13312
  v_add_f32 v227, v227, v221
  v_mfma_f32_16x16x32_bf16 a[108:111], a[180:183], v[188:191], a[108:111]
  s_and_b32 s25, s25, 0x1ffff
  v_exp_f32 v223, v143
  v_cvt_pk_bf16_f32 v182, v220, v221
  v_mfma_f32_16x16x32_bf16 a[112:115], a[184:187], v[184:187], a[112:115]
  ds_read_b128 a[152:155], v3 offset:14336
  v_add_f32 v227, v227, v222
  v_mfma_f32_16x16x32_bf16 a[116:119], a[184:187], v[188:191], a[116:119]
  s_sub_u32 s29, s29, 1
  v_add_f32 v227, v227, v223
  v_cvt_pk_bf16_f32 v183, v222, v223
  v_max_f32 v5, v226, v227
  v_mfma_f32_16x16x32_bf16 a[120:123], a[188:191], v[184:187], a[120:123]
  s_waitcnt lgkmcnt(3)
  ds_read_b128 a[156:159], v3 offset:15360
  v_cmp_lt_f32 vcc, s81, v5
  v_mfma_f32_16x16x32_bf16 a[124:127], a[188:191], v[188:191], a[124:127]
  s_cbranch_vccnz fa_stub10
fa_back10:
  v_add_f32 v230, v230, v226
  v_add_f32 v231, v231, v227
  v_add_u32 v3, 32768, v3
  v_and_b32 v3, 0x1ffff, v3
  s_cmp_lg_u32 s29, 0
  s_cbranch_scc1 fa_SS
fa_Bexit:
  s_bitcmp1_b32 s20, 0
  s_cbranch_scc1 fa_Bodd
  v_mfma_f32_16x16x32_bf16 v[128:131], a[128:131], v[64:67], v[200:203]
  s_waitcnt vmcnt(0)
  v_exp_f32 v216, v144
  v_mfma_f32_16x16x32_bf16 v[136:139], a[128:131], v[68:71], v[204:207]
  s_barrier
  v_exp_f32 v217, v145
  v_mfma_f32_16x16x32_bf16 v[132:135], a[132:135], v[64:67], v[200:203]
  ds_read_b128 a[160:163], v3 offset:16384
  ds_read_b128 a[164:167], v3 offset:17408
  v_mfma_f32_16x16x32_bf16 v[140:143], a[132:135], v[68:71], v[204:207]
  v_exp_f32 v218, v146
  v_mfma_f32_16x16x32_bf16 v[128:131], a[136:139], v[72:75], v[128:131]
  ds_read_b128 a[168:171], v3 offset:18432
  v_add_f32 v226, v216, v217
  v_mfma_f32_16x16x32_bf16 v[136:139], a[136:139], v[76:79], v[136:139]
  v_exp_f32 v219, v147
  v_mfma_f32_16x16x32_bf16 v[132:135], a[140:143], v[72:75], v[132:135]
  ds_read_b128 a[172:175], v3 offset:19456
  v_cvt_pk_bf16_f32 v184, v216, v217
  v_mfma_f32_16x16x32_bf16 v[140:143], a[140:143], v[76:79], v[140:143]
  s_waitcnt lgkmcnt(4)
  v_exp_f32 v220, v148
  v_add_f32 v226, v226, v218
  v_mfma_f32_16x16x32_bf16 v[128:131], a[144:147], v[80:83], v[128:131]
  ds_read_b128 a[176:179], v3 offset:20480
  v_add_f32 v226, v226, v219
  v_mfma_f32_16x16x32_bf16 v[136:139], a[144:147], v[84:87], v[136:139]
  v_exp_f32 v221, v149
  v_mfma_f32_16x16x32_bf16 v[132:135], a[148:151], v[80:83], v[132:135]
  ds_read_b128 a[180:183], v3 offset:21504
  v_cvt_pk_bf16_f32 v185, v218, v219
  v_mfma_f32_16x16x32_bf16 v[140:143], a[148:151], v[84:87], v[140:143]
  v_exp_f32 v222, v150
  v_mfma_f32_16x16x32_bf16 v[128:131], a[152:155], v[88:91], v[128:131]
  ds_read_b128 a[184:187], v3 offset:22528
  v_add_f32 v226, v226, v220
  v_mfma_f32_16x16x32_bf16 v[136:139], a[152:155], v[92:95], v[136:139]
  v_exp_f32 v223, v151
  v_mfma_f32_16x16x32_bf16 v[132:135], a[156:159], v[88:91], v[132:135]
  ds_read_b128 a[188:191], v3 offset:23552
  v_add_f32 v226, v226, v221
  v_mfma_f32_16x16x32_bf16 v[140:143], a[156:159], v[92:95], v[140:143]
  s_waitcnt lgkmcnt(4)
  v_exp_f32 v216, v152
  v_mfma_f32_16x16x32_bf16 a[64:67], a[160:163], v[176:179], a[64:67]
  v_exp_f32 v217, v153
  v_mfma_f32_16x16x32_bf16 a[68:71], a[160:163], v[180:183], a[68:71]
  v_exp_f32 v218, v154
  v_mfma_f32_16x16x32_bf16 a[72:75], a[164:167], v[176:179], a[72:75]
  v_exp_f32 v219, v155
  v_mfma_f32_16x16x32_bf16 a[76:79], a[164:167], v[180:183], a[76:79]
  v_cvt_pk_bf16_f32 v186, v220, v221
  v_add_f32 v226, v226, v222
  v_mfma_f32_16x16x32_bf16 a[80:83], a[168:171], v[176:179], a[80:83]
  v_exp_f32 v220, v156
  v_mfma_f32_16x16x32_bf16 a[84:87], a[168:171], v[180:183], a[84:87]
  v_exp_f32 v221, v157
  v_mfma_f32_16x16x32_bf16 a[88:91], a[172:175], v[176:179], a[88:91]
  v_add_f32 v226, v226, v223
  v_cvt_pk_bf16_f32 v187, v222, v223
  v_mfma_f32_16x16x32_bf16 a[92:95], a[172:175], v[180:183], a[92:95]
  s_waitcnt lgkmcnt(0)
  v_exp_f32 v222, v158
  v_add_f32 v227, v216, v217
  v_mfma_f32_16x16x32_bf16 a[96:99], a[176:179], v[176:179], a[96:99]
  v_exp_f32 v223, v159
  v_mfma_f32_16x16x32_bf16 a[100:103], a[176:179], v[180:183], a[100:103]
  v_cvt_pk_bf16_f32 v188, v216, v217
  v_add_f32 v227, v227, v218
  v_mfma_f32_16x16x32_bf16 a[104:107], a[180:183], v[176:179], a[104:107]
  v_add_f32 v227, v227, v219
  v_cvt_pk_bf16_f32 v189, v218, v219
  v_mfma_f32_16x16x32_bf16 a[108:111], a[180:183], v[180:183], a[108:111]
  v_add_f32 v227, v227, v220
  v_add_f32 v227, v227, v221
  v_mfma_f32_16x16x32_bf16 a[112:115], a[184:187], v[176:179], a[112:115]
  v_cvt_pk_bf16_f32 v190, v220, v221
  v_add_f32 v227, v227, v222
  v_mfma_f32_16x16x32_bf16 a[116:119], a[184:187], v[180:183], a[116:119]
  v_add_f32 v227, v227, v223
  v_cvt_pk_bf16_f32 v191, v222, v223
  v_mfma_f32_16x16x32_bf16 a[120:123], a[188:191], v[176:179], a[120:123]
  v_max_f32 v5, v226, v227
  v_cmp_lt_f32 vcc, s81, v5
  v_mfma_f32_16x16x32_bf16 a[124:127], a[188:191], v[180:183], a[124:127]
  s_cbranch_vccnz fa_stub11
fa_back11:
  v_add_f32 v230, v230, v226
  v_add_f32 v231, v231, v227
  ds_read_b128 a[160:163], v3 offset:24576
  ds_read_b128 a[164:167], v3 offset:25600
  ds_read_b128 a[168:171], v3 offset:26624
  ds_read_b128 a[172:175], v3 offset:27648
  ds_read_b128 a[176:179], v3 offset:28672
  ds_read_b128 a[180:183], v3 offset:29696
  ds_read_b128 a[184:187], v3 offset:30720
  ds_read_b128 a[188:191], v3 offset:31744
  v_cndmask_b32 v128, v4, v128, s[68:69]
  v_cndmask_b32 v129, v4, v129, s[70:71]
  v_cndmask_b32 v130, v4, v130, s[72:73]
  v_cndmask_b32 v131, v4, v131, s[74:75]
  v_mov_b32 v132, v4
  v_mov_b32 v133, v4
  v_mov_b32 v134, v4
  v_mov_b32 v135, v4
  v_cndmask_b32 v140, v4, v140, s[68:69]
  v_cndmask_b32 v141, v4, v141, s[70:71]
  v_cndmask_b32 v142, v4, v142, s[72:73]
  v_cndmask_b32 v143, v4, v143, s[74:75]
  v_exp_f32 v216, v128
  v_exp_f32 v217, v129
  v_exp_f32 v218, v130
  v_exp_f32 v219, v131
  v_exp_f32 v220, v132
  v_exp_f32 v221, v133
  v_exp_f32 v222, v134
  v_exp_f32 v223, v135
  v_add_f32 v226, v216, v217
  v_cvt_pk_bf16_f32 v176, v216, v217
  s_waitcnt lgkmcnt(4)
  v_mfma_f32_16x16x32_bf16 a[64:67], a[160:163], v[184:187], a[64:67]
  v_exp_f32 v216, v136
  v_add_f32 v226, v226, v218
  v_mfma_f32_16x16x32_bf16 a[68:71], a[160:163], v[188:191], a[68:71]
  v_exp_f32 v217, v137
  v_mfma_f32_16x16x32_bf16 a[72:75], a[164:167], v[184:187], a[72:75]
  v_add_f32 v226, v226, v219
  v_cvt_pk_bf16_f32 v177, v218, v219
  v_add_f32 v226, v226, v220
  v_mfma_f32_16x16x32_bf16 a[76:79], a[164:167], v[188:191], a[76:79]
  v_exp_f32 v218, v138
  v_mfma_f32_16x16x32_bf16 a[80:83], a[168:171], v[184:187], a[80:83]
  v_exp_f32 v219, v139
  v_add_f32 v226, v226, v221
  v_mfma_f32_16x16x32_bf16 a[84:87], a[168:171], v[188:191], a[84:87]
  v_cvt_pk_bf16_f32 v178, v220, v221
  v_add_f32 v226, v226, v222
  v_mfma_f32_16x16x32_bf16 a[88:91], a[172:175], v[184:187], a[88:91]
  v_exp_f32 v220, v140
  v_add_f32 v226, v226, v223
  v_mfma_f32_16x16x32_bf16 a[92:95], a[172:175], v[188:191], a[92:95]
  s_waitcnt lgkmcnt(0)
  v_exp_f32 v221, v141
  v_mfma_f32_16x16x32_bf16 a[96:99], a[176:179], v[184:187], a[96:99]
  v_cvt_pk_bf16_f32 v179, v222, v223
  v_add_f32 v227, v216, v217
  v_cvt_pk_bf16_f32 v180, v216, v217
  v_mfma_f32_16x16x32_bf16 a[100:103], a[176:179], v[188:191], a[100:103]
  v_exp_f32 v222, v142
  v_mfma_f32_16x16x32_bf16 a[104:107], a[180:183], v[184:187], a[104:107]
  v_exp_f32 v223, v143
  v_add_f32 v227, v227, v218
  v_mfma_f32_16x16x32_bf16 a[108:111], a[180:183], v[188:191], a[108:111]
  v_add_f32 v227, v227, v219
  v_cvt_pk_bf16_f32 v181, v218, v219
  v_mfma_f32_16x16x32_bf16 a[112:115], a[184:187], v[184:187], a[112:115]
  v_add_f32 v227, v227, v220
  v_add_f32 v227, v227, v221
  v_cvt_pk_bf16_f32 v182, v220, v221
  v_mfma_f32_16x16x32_bf16 a[116:119], a[184:187], v[188:191], a[116:119]
  v_add_f32 v227, v227, v222
  v_add_f32 v227, v227, v223
  v_mfma_f32_16x16x32_bf16 a[120:123], a[188:191], v[184:187], a[120:123]
  v_cvt_pk_bf16_f32 v183, v222, v223
  v_max_f32 v5, v226, v227
  v_cmp_lt_f32 vcc, s81, v5
  v_mfma_f32_16x16x32_bf16 a[124:127], a[188:191], v[188:191], a[124:127]
  s_cbranch_vccnz fa_stub12
fa_back12:
  v_add_f32 v230, v230, v226
  v_add_f32 v231, v231, v227
  v_add_u32 v3, 32768, v3
  v_and_b32 v3, 0x1ffff, v3
  s_waitcnt vmcnt(0)
  s_barrier
  ds_read_b128 a[160:163], v3 offset:16384
  ds_read_b128 a[164:167], v3 offset:17408
  ds_read_b128 a[168:171], v3 offset:18432
  ds_read_b128 a[172:175], v3 offset:19456
  ds_read_b128 a[176:179], v3 offset:20480
  ds_read_b128 a[180:183], v3 offset:21504
  ds_read_b128 a[184:187], v3 offset:22528
  ds_read_b128 a[188:191], v3 offset:23552
  s_waitcnt lgkmcnt(4)
  v_mfma_f32_16x16x32_bf16 a[64:67], a[160:163], v[176:179], a[64:67]
  v_mfma_f32_16x16x32_bf16 a[68:71], a[160:163], v[180:183], a[68:71]
  v_mfma_f32_16x16x32_bf16 a[72:75], a[164:167], v[176:179], a[72:75]
  v_mfma_f32_16x16x32_bf16 a[76:79], a[164:167], v[180:183], a[76:79]
  v_mfma_f32_16x16x32_bf16 a[80:83], a[168:171], v[176:179], a[80:83]
  v_mfma_f32_16x16x32_bf16 a[84:87], a[168:171], v[180:183], a[84:87]
  v_mfma_f32_16x16x32_bf16 a[88:91], a[172:175], v[176:179], a[88:91]
  v_mfma_f32_16x16x32_bf16 a[92:95], a[172:175], v[180:183], a[92:95]
  s_waitcnt lgkmcnt(0)
  v_mfma_f32_16x16x32_bf16 a[96:99], a[176:179], v[176:179], a[96:99]
  v_mfma_f32_16x16x32_bf16 a[100:103], a[176:179], v[180:183], a[100:103]
  v_mfma_f32_16x16x32_bf16 a[104:107], a[180:183], v[176:179], a[104:107]
  v_mfma_f32_16x16x32_bf16 a[108:111], a[180:183], v[180:183], a[108:111]
  v_mfma_f32_16x16x32_bf16 a[112:115], a[184:187], v[176:179], a[112:115]
  v_mfma_f32_16x16x32_bf16 a[116:119], a[184:187], v[180:183], a[116:119]
  v_mfma_f32_16x16x32_bf16 a[120:123], a[188:191], v[176:179], a[120:123]
  v_mfma_f32_16x16x32_bf16 a[124:127], a[188:191], v[180:183], a[124:127]
  s_branch fa_Bdone
fa_Bodd:
  s_waitcnt vmcnt(0)
  s_barrier
  ds_read_b128 a[160:163], v3 offset:16384
  ds_read_b128 a[164:167], v3 offset:17408
  ds_read_b128 a[168:171], v3 offset:18432
  ds_read_b128 a[172:175], v3 offset:19456
  ds_read_b128 a[176:179], v3 offset:20480
  ds_read_b128 a[180:183], v3 offset:21504
  ds_read_b128 a[184:187], v3 offset:22528
  ds_read_b128 a[188:191], v3 offset:23552
  v_cndmask_b32 v144, v4, v144, s[68:69]
  v_cndmask_b32 v145, v4, v145, s[70:71]
  v_cndmask_b32 v146, v4, v146, s[72:73]
  v_cndmask_b32 v147, v4, v147, s[74:75]
  v_mov_b32 v148, v4
  v_mov_b32 v149, v4
  v_mov_b32 v150, v4
  v_mov_b32 v151, v4
  v_cndmask_b32 v156, v4, v156, s[68:69]
  v_cndmask_b32 v157, v4, v157, s[70:71]
  v_cndmask_b32 v158, v4, v158, s[72:73]
  v_cndmask_b32 v159, v4, v159, s[74:75]
  v_exp_f32 v216, v144
  v_exp_f32 v217, v145
  v_exp_f32 v218, v146
  v_exp_f32 v219, v147
  v_exp_f32 v220, v148
  v_exp_f32 v221, v149
  v_exp_f32 v222, v150
  v_exp_f32 v223, v151
  v_add_f32 v226, v216, v217
  v_cvt_pk_bf16_f32 v184, v216, v217
  s_waitcnt lgkmcnt(4)
  v_mfma_f32_16x16x32_bf16 a[64:67], a[160:163], v[176:179], a[64:67]
  v_exp_f32 v216, v152
  v_add_f32 v226, v226, v218
  v_mfma_f32_16x16x32_bf16 a[68:71], a[160:163], v[180:183], a[68:71]
  v_exp_f32 v217, v153
  v_mfma_f32_16x16x32_bf16 a[72:75], a[164:167], v[176:179], a[72:75]
  v_add_f32 v226, v226, v219
  v_cvt_pk_bf16_f32 v185, v218, v219
  v_add_f32 v226, v226, v220
  v_mfma_f32_16x16x32_bf16 a[76:79], a[164:167], v[180:183], a[76:79]
  v_exp_f32 v218, v154
  v_mfma_f32_16x16x32_bf16 a[80:83], a[168:171], v[176:179], a[80:83]
  v_exp_f32 v219, v155
  v_add_f32 v226, v226, v221
  v_mfma_f32_16x16x32_bf16 a[84:87], a[168:171], v[180:183], a[84:87]
  v_cvt_pk_bf16_f32 v186, v220, v221
  v_add_f32 v226, v226, v222
  v_mfma_f32_16x16x32_bf16 a[88:91], a[172:175], v[176:179], a[88:91]
  v_exp_f32 v220, v156
  v_add_f32 v226, v226, v223
  v_mfma_f32_16x16x32_bf16 a[92:95], a[172:175], v[180:183], a[92:95]
  s_waitcnt lgkmcnt(0)
  v_exp_f32 v221, v157
  v_mfma_f32_16x16x32_bf16 a[96:99], a[176:179], v[176:179], a[96:99]
  v_cvt_pk_bf16_f32 v187, v222, v223
  v_add_f32 v227, v216, v217
  v_cvt_pk_bf16_f32 v188, v216, v217
  v_mfma_f32_16x16x32_bf16 a[100:103], a[176:179], v[180:183], a[100:103]
  v_exp_f32 v222, v158
  v_mfma_f32_16x16x32_bf16 a[104:107], a[180:183], v[176:179], a[104:107]
  v_exp_f32 v223, v159
  v_add_f32 v227, v227, v218
  v_mfma_f32_16x16x32_bf16 a[108:111], a[180:183], v[180:183], a[108:111]
  v_add_f32 v227, v227, v219
  v_cvt_pk_bf16_f32 v189, v218, v219
  v_mfma_f32_16x16x32_bf16 a[112:115], a[184:187], v[176:179], a[112:115]
  v_add_f32 v227, v227, v220
  v_add_f32 v227, v227, v221
  v_cvt_pk_bf16_f32 v190, v220, v221
  v_mfma_f32_16x16x32_bf16 a[116:119], a[184:187], v[180:183], a[116:119]
  v_add_f32 v227, v227, v222
  v_add_f32 v227, v227, v223
  v_mfma_f32_16x16x32_bf16 a[120:123], a[188:191], v[176:179], a[120:123]
  v_cvt_pk_bf16_f32 v191, v222, v223
  v_max_f32 v5, v226, v227
  v_cmp_lt_f32 vcc, s81, v5
  v_mfma_f32_16x16x32_bf16 a[124:127], a[188:191], v[180:183], a[124:127]
  s_cbranch_vccnz fa_stub13
fa_back13:
  v_add_f32 v230, v230, v226
  v_add_f32 v231, v231, v227
  ds_read_b128 a[160:163], v3 offset:24576
  ds_read_b128 a[164:167], v3 offset:25600
  ds_read_b128 a[168:171], v3 offset:26624
  ds_read_b128 a[172:175], v3 offset:27648
  ds_read_b128 a[176:179], v3 offset:28672
  ds_read_b128 a[180:183], v3 offset:29696
  ds_read_b128 a[184:187], v3 offset:30720
  ds_read_b128 a[188:191], v3 offset:31744
  s_waitcnt lgkmcnt(4)
  v_mfma_f32_16x16x32_bf16 a[64:67], a[160:163], v[184:187], a[64:67]
  v_mfma_f32_16x16x32_bf16 a[68:71], a[160:163], v[188:191], a[68:71]
  v_mfma_f32_16x16x32_bf16 a[72:75], a[164:167], v[184:187], a[72:75]
  v_mfma_f32_16x16x32_bf16 a[76:79], a[164:167], v[188:191], a[76:79]
  v_mfma_f32_16x16x32_bf16 a[80:83], a[168:171], v[184:187], a[80:83]
  v_mfma_f32_16x16x32_bf16 a[84:87], a[168:171], v[188:191], a[84:87]
  v_mfma_f32_16x16x32_bf16 a[88:91], a[172:175], v[184:187], a[88:91]
  v_mfma_f32_16x16x32_bf16 a[92:95], a[172:175], v[188:191], a[92:95]
  s_waitcnt lgkmcnt(0)
  v_mfma_f32_16x16x32_bf16 a[96:99], a[176:179], v[184:187], a[96:99]
  v_mfma_f32_16x16x32_bf16 a[100:103], a[176:179], v[188:191], a[100:103]
  v_mfma_f32_16x16x32_bf16 a[104:107], a[180:183], v[184:187], a[104:107]
  v_mfma_f32_16x16x32_bf16 a[108:111], a[180:183], v[188:191], a[108:111]
  v_mfma_f32_16x16x32_bf16 a[112:115], a[184:187], v[184:187], a[112:115]
  v_mfma_f32_16x16x32_bf16 a[116:119], a[184:187], v[188:191], a[116:119]
  v_mfma_f32_16x16x32_bf16 a[120:123], a[188:191], v[184:187], a[120:123]
  v_mfma_f32_16x16x32_bf16 a[124:127], a[188:191], v[188:191], a[124:127]
  v_add_u32 v3, 32768, v3
  v_and_b32 v3, 0x1ffff, v3
fa_Bdone:
  s_cmp_ge_u32 s20, 2
  s_cbranch_scc1 fa_epi
  s_barrier
fa_epi:
  s_and_b32 s23, s21, 0
  s_lshl_b32 s23, s23, 1
  s_add_u32 s23, s23, s22
  s_and_b32 s60, s23, 7
  s_lshl_b32 s23, s60, 2
  s_add_u32 s23, s23, s20
  s_lshl_b32 s23, s23, 7
  s_add_u32 s23, s23, 2654208
  v_and_b32 v9, 31, v1
  v_lshl_add_u32 v9, v9, 2, s23
  buffer_load_dword v8, v9, s[40:43], 0 offen sc1
  v_mov_b32 v20, v228
  v_mov_b32 v21, v229
  v_mov_b32 v22, v230
  v_mov_b32 v23, v231
  s_nop 0
  v_permlane16_swap_b32 v228, v20
  v_permlane16_swap_b32 v229, v21
  v_permlane16_swap_b32 v230, v22
  v_permlane16_swap_b32 v231, v23
  v_add_f32 v228, v228, v20
  v_add_f32 v229, v229, v21
  v_add_f32 v230, v230, v22
  v_add_f32 v231, v231, v23
  v_mov_b32 v20, v228
  v_mov_b32 v21, v229
  v_mov_b32 v22, v230
  v_mov_b32 v23, v231
  s_nop 0
  v_permlane32_swap_b32 v228, v20
  v_permlane32_swap_b32 v229, v21
  v_permlane32_swap_b32 v230, v22
  v_permlane32_swap_b32 v231, v23
  v_add_f32 v228, v228, v20
  v_add_f32 v229, v229, v21
  v_add_f32 v230, v230, v22
  v_add_f32 v231, v231, v23
  v_rcp_f32 v16, v228
  v_rcp_f32 v18, v229
  v_rcp_f32 v20, v230
  v_rcp_f32 v22, v231
  s_nop 0
  v_mov_b32 v17, v16
  v_mov_b32 v19, v18
  v_mov_b32 v21, v20
  v_mov_b32 v23, v22
  s_lshl_b32 s23, s22, 2
  s_add_u32 s23, s23, s20
  s_lshl_b32 s23, s23, 18
  s_lshl_b32 s31, s21, 12
  s_add_u32 s31, s31, 50331648
  s_add_u32 s64, s23, s31
  s_add_u32 s65, s64, 131072
  s_sub_u32 s23, 15, s22
  s_lshl_b32 s23, s23, 2
  s_add_u32 s23, s23, s20
  s_lshl_b32 s23, s23, 18
  s_add_u32 s66, s23, s31
  s_add_u32 s67, s66, 131072
  v_accvgpr_read_b32 v36, a0
  v_accvgpr_read_b32 v37, a1
  v_accvgpr_read_b32 v38, a2
  v_accvgpr_read_b32 v39, a3
  v_accvgpr_read_b32 v40, a8
  v_accvgpr_read_b32 v41, a9
  v_accvgpr_read_b32 v42, a10
  v_accvgpr_read_b32 v43, a11
  v_pk_mul_f32 v[36:37], v[36:37], v[16:17]
  v_pk_mul_f32 v[38:39], v[38:39], v[16:17]
  v_pk_mul_f32 v[40:41], v[40:41], v[16:17]
  v_pk_mul_f32 v[42:43], v[42:43], v[16:17]
  v_cvt_pk_bf16_f32 v32, v36, v37
  v_cvt_pk_bf16_f32 v33, v38, v39
  v_cvt_pk_bf16_f32 v34, v40, v41
  v_cvt_pk_bf16_f32 v35, v42, v43
  buffer_store_dwordx4 v[32:35], v2, s[40:43], s64 offen offset:0 sc1
  v_accvgpr_read_b32 v48, a16
  v_accvgpr_read_b32 v49, a17
  v_accvgpr_read_b32 v50, a18
  v_accvgpr_read_b32 v51, a19
  v_accvgpr_read_b32 v52, a24
  v_accvgpr_read_b32 v53, a25
  v_accvgpr_read_b32 v54, a26
  v_accvgpr_read_b32 v55, a27
  v_pk_mul_f32 v[48:49], v[48:49], v[16:17]
  v_pk_mul_f32 v[50:51], v[50:51], v[16:17]
  v_pk_mul_f32 v[52:53], v[52:53], v[16:17]
  v_pk_mul_f32 v[54:55], v[54:55], v[16:17]
  v_cvt_pk_bf16_f32 v44, v48, v49
  v_cvt_pk_bf16_f32 v45, v50, v51
  v_cvt_pk_bf16_f32 v46, v52, v53
  v_cvt_pk_bf16_f32 v47, v54, v55
  buffer_store_dwordx4 v[44:47], v2, s[40:43], s64 offen offset:1024 sc1
  v_accvgpr_read_b32 v60, a32
  v_accvgpr_read_b32 v61, a33
  v_accvgpr_read_b32 v62, a34
  v_accvgpr_read_b32 v63, a35
  v_accvgpr_read_b32 v64, a40
  v_accvgpr_read_b32 v65, a41
  v_accvgpr_read_b32 v66, a42
  v_accvgpr_read_b32 v67, a43
  v_pk_mul_f32 v[60:61], v[60:61], v[16:17]
  v_pk_mul_f32 v[62:63], v[62:63], v[16:17]
  v_pk_mul_f32 v[64:65], v[64:65], v[16:17]
  v_pk_mul_f32 v[66:67], v[66:67], v[16:17]
  v_cvt_pk_bf16_f32 v56, v60, v61
  v_cvt_pk_bf16_f32 v57, v62, v63
  v_cvt_pk_bf16_f32 v58, v64, v65
  v_cvt_pk_bf16_f32 v59, v66, v67
  buffer_store_dwordx4 v[56:59], v2, s[40:43], s64 offen offset:2048 sc1
  v_accvgpr_read_b32 v72, a48
  v_accvgpr_read_b32 v73, a49
  v_accvgpr_read_b32 v74, a50
  v_accvgpr_read_b32 v75, a51
  v_accvgpr_read_b32 v76, a56
  v_accvgpr_read_b32 v77, a57
  v_accvgpr_read_b32 v78, a58
  v_accvgpr_read_b32 v79, a59
  v_pk_mul_f32 v[72:73], v[72:73], v[16:17]
  v_pk_mul_f32 v[74:75], v[74:75], v[16:17]
  v_pk_mul_f32 v[76:77], v[76:77], v[16:17]
  v_pk_mul_f32 v[78:79], v[78:79], v[16:17]
  v_cvt_pk_bf16_f32 v68, v72, v73
  v_cvt_pk_bf16_f32 v69, v74, v75
  v_cvt_pk_bf16_f32 v70, v76, v77
  v_cvt_pk_bf16_f32 v71, v78, v79
  buffer_store_dwordx4 v[68:71], v2, s[40:43], s64 offen offset:3072 sc1
  v_accvgpr_read_b32 v84, a4
  v_accvgpr_read_b32 v85, a5
  v_accvgpr_read_b32 v86, a6
  v_accvgpr_read_b32 v87, a7
  v_accvgpr_read_b32 v88, a12
  v_accvgpr_read_b32 v89, a13
  v_accvgpr_read_b32 v90, a14
  v_accvgpr_read_b32 v91, a15
  v_pk_mul_f32 v[84:85], v[84:85], v[18:19]
  v_pk_mul_f32 v[86:87], v[86:87], v[18:19]
  v_pk_mul_f32 v[88:89], v[88:89], v[18:19]
  v_pk_mul_f32 v[90:91], v[90:91], v[18:19]
  v_cvt_pk_bf16_f32 v80, v84, v85
  v_cvt_pk_bf16_f32 v81, v86, v87
  v_cvt_pk_bf16_f32 v82, v88, v89
  v_cvt_pk_bf16_f32 v83, v90, v91
  buffer_store_dwordx4 v[80:83], v2, s[40:43], s65 offen offset:0 sc1
  v_accvgpr_read_b32 v96, a20
  v_accvgpr_read_b32 v97, a21
  v_accvgpr_read_b32 v98, a22
  v_accvgpr_read_b32 v99, a23
  v_accvgpr_read_b32 v100, a28
  v_accvgpr_read_b32 v101, a29
  v_accvgpr_read_b32 v102, a30
  v_accvgpr_read_b32 v103, a31
  v_pk_mul_f32 v[96:97], v[96:97], v[18:19]
  v_pk_mul_f32 v[98:99], v[98:99], v[18:19]
  v_pk_mul_f32 v[100:101], v[100:101], v[18:19]
  v_pk_mul_f32 v[102:103], v[102:103], v[18:19]
  v_cvt_pk_bf16_f32 v92, v96, v97
  v_cvt_pk_bf16_f32 v93, v98, v99
  v_cvt_pk_bf16_f32 v94, v100, v101
  v_cvt_pk_bf16_f32 v95, v102, v103
  buffer_store_dwordx4 v[92:95], v2, s[40:43], s65 offen offset:1024 sc1
  v_accvgpr_read_b32 v108, a36
  v_accvgpr_read_b32 v109, a37
  v_accvgpr_read_b32 v110, a38
  v_accvgpr_read_b32 v111, a39
  v_accvgpr_read_b32 v112, a44
  v_accvgpr_read_b32 v113, a45
  v_accvgpr_read_b32 v114, a46
  v_accvgpr_read_b32 v115, a47
  v_pk_mul_f32 v[108:109], v[108:109], v[18:19]
  v_pk_mul_f32 v[110:111], v[110:111], v[18:19]
  v_pk_mul_f32 v[112:113], v[112:113], v[18:19]
  v_pk_mul_f32 v[114:115], v[114:115], v[18:19]
  v_cvt_pk_bf16_f32 v104, v108, v109
  v_cvt_pk_bf16_f32 v105, v110, v111
  v_cvt_pk_bf16_f32 v106, v112, v113
  v_cvt_pk_bf16_f32 v107, v114, v115
  buffer_store_dwordx4 v[104:107], v2, s[40:43], s65 offen offset:2048 sc1
  v_accvgpr_read_b32 v120, a52
  v_accvgpr_read_b32 v121, a53
  v_accvgpr_read_b32 v122, a54
  v_accvgpr_read_b32 v123, a55
  v_accvgpr_read_b32 v124, a60
  v_accvgpr_read_b32 v125, a61
  v_accvgpr_read_b32 v126, a62
  v_accvgpr_read_b32 v127, a63
  v_pk_mul_f32 v[120:121], v[120:121], v[18:19]
  v_pk_mul_f32 v[122:123], v[122:123], v[18:19]
  v_pk_mul_f32 v[124:125], v[124:125], v[18:19]
  v_pk_mul_f32 v[126:127], v[126:127], v[18:19]
  v_cvt_pk_bf16_f32 v116, v120, v121
  v_cvt_pk_bf16_f32 v117, v122, v123
  v_cvt_pk_bf16_f32 v118, v124, v125
  v_cvt_pk_bf16_f32 v119, v126, v127
  buffer_store_dwordx4 v[116:119], v2, s[40:43], s65 offen offset:3072 sc1
  v_accvgpr_read_b32 v36, a64
  v_accvgpr_read_b32 v37, a65
  v_accvgpr_read_b32 v38, a66
  v_accvgpr_read_b32 v39, a67
  v_accvgpr_read_b32 v40, a72
  v_accvgpr_read_b32 v41, a73
  v_accvgpr_read_b32 v42, a74
  v_accvgpr_read_b32 v43, a75
  v_pk_mul_f32 v[36:37], v[36:37], v[20:21]
  v_pk_mul_f32 v[38:39], v[38:39], v[20:21]
  v_pk_mul_f32 v[40:41], v[40:41], v[20:21]
  v_pk_mul_f32 v[42:43], v[42:43], v[20:21]
  v_cvt_pk_bf16_f32 v32, v36, v37
  v_cvt_pk_bf16_f32 v33, v38, v39
  v_cvt_pk_bf16_f32 v34, v40, v41
  v_cvt_pk_bf16_f32 v35, v42, v43
  buffer_store_dwordx4 v[32:35], v2, s[40:43], s66 offen offset:0 sc1
  v_accvgpr_read_b32 v48, a80
  v_accvgpr_read_b32 v49, a81
  v_accvgpr_read_b32 v50, a82
  v_accvgpr_read_b32 v51, a83
  v_accvgpr_read_b32 v52, a88
  v_accvgpr_read_b32 v53, a89
  v_accvgpr_read_b32 v54, a90
  v_accvgpr_read_b32 v55, a91
  v_pk_mul_f32 v[48:49], v[48:49], v[20:21]
  v_pk_mul_f32 v[50:51], v[50:51], v[20:21]
  v_pk_mul_f32 v[52:53], v[52:53], v[20:21]
  v_pk_mul_f32 v[54:55], v[54:55], v[20:21]
  v_cvt_pk_bf16_f32 v44, v48, v49
  v_cvt_pk_bf16_f32 v45, v50, v51
  v_cvt_pk_bf16_f32 v46, v52, v53
  v_cvt_pk_bf16_f32 v47, v54, v55
  buffer_store_dwordx4 v[44:47], v2, s[40:43], s66 offen offset:1024 sc1
  v_accvgpr_read_b32 v60, a96
  v_accvgpr_read_b32 v61, a97
  v_accvgpr_read_b32 v62, a98
  v_accvgpr_read_b32 v63, a99
  v_accvgpr_read_b32 v64, a104
  v_accvgpr_read_b32 v65, a105
  v_accvgpr_read_b32 v66, a106
  v_accvgpr_read_b32 v67, a107
  v_pk_mul_f32 v[60:61], v[60:61], v[20:21]
  v_pk_mul_f32 v[62:63], v[62:63], v[20:21]
  v_pk_mul_f32 v[64:65], v[64:65], v[20:21]
  v_pk_mul_f32 v[66:67], v[66:67], v[20:21]
  v_cvt_pk_bf16_f32 v56, v60, v61
  v_cvt_pk_bf16_f32 v57, v62, v63
  v_cvt_pk_bf16_f32 v58, v64, v65
  v_cvt_pk_bf16_f32 v59, v66, v67
  buffer_store_dwordx4 v[56:59], v2, s[40:43], s66 offen offset:2048 sc1
  v_accvgpr_read_b32 v72, a112
  v_accvgpr_read_b32 v73, a113
  v_accvgpr_read_b32 v74, a114
  v_accvgpr_read_b32 v75, a115
  v_accvgpr_read_b32 v76, a120
  v_accvgpr_read_b32 v77, a121
  v_accvgpr_read_b32 v78, a122
  v_accvgpr_read_b32 v79, a123
  v_pk_mul_f32 v[72:73], v[72:73], v[20:21]
  v_pk_mul_f32 v[74:75], v[74:75], v[20:21]
  v_pk_mul_f32 v[76:77], v[76:77], v[20:21]
  v_pk_mul_f32 v[78:79], v[78:79], v[20:21]
  v_cvt_pk_bf16_f32 v68, v72, v73
  v_cvt_pk_bf16_f32 v69, v74, v75
  v_cvt_pk_bf16_f32 v70, v76, v77
  v_cvt_pk_bf16_f32 v71, v78, v79
  buffer_store_dwordx4 v[68:71], v2, s[40:43], s66 offen offset:3072 sc1
  v_accvgpr_read_b32 v84, a68
  v_accvgpr_read_b32 v85, a69
  v_accvgpr_read_b32 v86, a70
  v_accvgpr_read_b32 v87, a71
  v_accvgpr_read_b32 v88, a76
  v_accvgpr_read_b32 v89, a77
  v_accvgpr_read_b32 v90, a78
  v_accvgpr_read_b32 v91, a79
  v_pk_mul_f32 v[84:85], v[84:85], v[22:23]
  v_pk_mul_f32 v[86:87], v[86:87], v[22:23]
  v_pk_mul_f32 v[88:89], v[88:89], v[22:23]
  v_pk_mul_f32 v[90:91], v[90:91], v[22:23]
  v_cvt_pk_bf16_f32 v80, v84, v85
  v_cvt_pk_bf16_f32 v81, v86, v87
  v_cvt_pk_bf16_f32 v82, v88, v89
  v_cvt_pk_bf16_f32 v83, v90, v91
  buffer_store_dwordx4 v[80:83], v2, s[40:43], s67 offen offset:0 sc1
  v_accvgpr_read_b32 v96, a84
  v_accvgpr_read_b32 v97, a85
  v_accvgpr_read_b32 v98, a86
  v_accvgpr_read_b32 v99, a87
  v_accvgpr_read_b32 v100, a92
  v_accvgpr_read_b32 v101, a93
  v_accvgpr_read_b32 v102, a94
  v_accvgpr_read_b32 v103, a95
  v_pk_mul_f32 v[96:97], v[96:97], v[22:23]
  v_pk_mul_f32 v[98:99], v[98:99], v[22:23]
  v_pk_mul_f32 v[100:101], v[100:101], v[22:23]
  v_pk_mul_f32 v[102:103], v[102:103], v[22:23]
  v_cvt_pk_bf16_f32 v92, v96, v97
  v_cvt_pk_bf16_f32 v93, v98, v99
  v_cvt_pk_bf16_f32 v94, v100, v101
  v_cvt_pk_bf16_f32 v95, v102, v103
  buffer_store_dwordx4 v[92:95], v2, s[40:43], s67 offen offset:1024 sc1
  v_accvgpr_read_b32 v108, a100
  v_accvgpr_read_b32 v109, a101
  v_accvgpr_read_b32 v110, a102
  v_accvgpr_read_b32 v111, a103
  v_accvgpr_read_b32 v112, a108
  v_accvgpr_read_b32 v113, a109
  v_accvgpr_read_b32 v114, a110
  v_accvgpr_read_b32 v115, a111
  v_pk_mul_f32 v[108:109], v[108:109], v[22:23]
  v_pk_mul_f32 v[110:111], v[110:111], v[22:23]
  v_pk_mul_f32 v[112:113], v[112:113], v[22:23]
  v_pk_mul_f32 v[114:115], v[114:115], v[22:23]
  v_cvt_pk_bf16_f32 v104, v108, v109
  v_cvt_pk_bf16_f32 v105, v110, v111
  v_cvt_pk_bf16_f32 v106, v112, v113
  v_cvt_pk_bf16_f32 v107, v114, v115
  buffer_store_dwordx4 v[104:107], v2, s[40:43], s67 offen offset:2048 sc1
  v_accvgpr_read_b32 v120, a116
  v_accvgpr_read_b32 v121, a117
  v_accvgpr_read_b32 v122, a118
  v_accvgpr_read_b32 v123, a119
  v_accvgpr_read_b32 v124, a124
  v_accvgpr_read_b32 v125, a125
  v_accvgpr_read_b32 v126, a126
  v_accvgpr_read_b32 v127, a127
  v_pk_mul_f32 v[120:121], v[120:121], v[22:23]
  v_pk_mul_f32 v[122:123], v[122:123], v[22:23]
  v_pk_mul_f32 v[124:125], v[124:125], v[22:23]
  v_pk_mul_f32 v[126:127], v[126:127], v[22:23]
  v_cvt_pk_bf16_f32 v116, v120, v121
  v_cvt_pk_bf16_f32 v117, v122, v123
  v_cvt_pk_bf16_f32 v118, v124, v125
  v_cvt_pk_bf16_f32 v119, v126, v127
  buffer_store_dwordx4 v[116:119], v2, s[40:43], s67 offen offset:3072 sc1
  s_load_dwordx2 s[4:5], s[0:1], 0
  s_load_dwordx2 s[6:7], s[0:1], 88
  s_mov_b32 s32, s18
  s_mov_b32 s33, s19
  s_mov_b32 s34, 67108864
  s_mov_b32 s35, 0x20000
  s_mov_b32 s36, s18
  s_mov_b32 s37, s19
  s_mov_b32 s38, 67108864
  s_mov_b32 s39, 0x20000
  s_lshl_b32 s23, s60, 2
  s_add_u32 s23, s23, s20
  s_mul_i32 s24, s23, 163840
  s_add_u32 s24, s24, 4194304
  s_add_u32 s61, s24, 163840
  s_mul_i32 s23, s22, 0
  s_add_u32 s24, s24, s23
  s_waitcnt vmcnt(16)
  v_cmp_eq_u32 vcc, 0, v8
  s_cbranch_vccnz fa_wof_spin
fa_wof_ok:
  buffer_load_dwordx4 a[0:3], v2, s[32:35], s24 offen offset:0 sc1
  buffer_load_dwordx4 a[4:7], v2, s[32:35], s24 offen offset:1024 sc1
  buffer_load_dwordx4 a[8:11], v2, s[32:35], s24 offen offset:2048 sc1
  buffer_load_dwordx4 a[12:15], v2, s[32:35], s24 offen offset:3072 sc1
  s_add_u32 s24, s24, 4096
  buffer_load_dwordx4 a[16:19], v2, s[32:35], s24 offen offset:0 sc1
  buffer_load_dwordx4 a[20:23], v2, s[32:35], s24 offen offset:1024 sc1
  buffer_load_dwordx4 a[24:27], v2, s[32:35], s24 offen offset:2048 sc1
  buffer_load_dwordx4 a[28:31], v2, s[32:35], s24 offen offset:3072 sc1
  s_add_u32 s24, s24, 4096
  v_mov_b32 v16, 1073741824
  v_mov_b32 v17, 1
  v_writelane_b32 v16, s80, 0
  v_writelane_b32 v16, s3, 1
  v_and_b32 v10, 15, v1
  v_lshlrev_b32 v10, 2, v10
  v_add_u32 v10, 2629632, v10
  v_min_u32 v11, 53, v1
  v_lshlrev_b32 v11, 2, v11
  v_add_u32 v11, 2650112, v11
  s_waitcnt vmcnt(8)
  buffer_store_dword v17, v16, s[40:43], 0 offen sc1
  buffer_load_dword v15, v10, s[40:43], 0 offen sc1
  buffer_load_dword v14, v11, s[40:43], 0 offen sc1
  buffer_load_dwordx4 a[32:35], v2, s[32:35], s24 offen offset:0 sc1
  buffer_load_dwordx4 a[36:39], v2, s[32:35], s24 offen offset:1024 sc1
  buffer_load_dwordx4 a[40:43], v2, s[32:35], s24 offen offset:2048 sc1
  buffer_load_dwordx4 a[44:47], v2, s[32:35], s24 offen offset:3072 sc1
  s_add_u32 s24, s24, 4096
  buffer_load_dwordx4 a[48:51], v2, s[32:35], s24 offen offset:0 sc1
  buffer_load_dwordx4 a[52:55], v2, s[32:35], s24 offen offset:1024 sc1
  buffer_load_dwordx4 a[56:59], v2, s[32:35], s24 offen offset:2048 sc1
  buffer_load_dwordx4 a[60:63], v2, s[32:35], s24 offen offset:3072 sc1
  s_add_u32 s24, s24, 4096
  buffer_load_dwordx4 a[64:67], v2, s[32:35], s24 offen offset:0 sc1
  buffer_load_dwordx4 a[68:71], v2, s[32:35], s24 offen offset:1024 sc1
  buffer_load_dwordx4 a[72:75], v2, s[32:35], s24 offen offset:2048 sc1
  buffer_load_dwordx4 a[76:79], v2, s[32:35], s24 offen offset:3072 sc1
  s_add_u32 s24, s24, 4096
  s_cmp_ge_u32 s24, s61
  s_cselect_b32 s23, 163840, 0
  s_sub_u32 s24, s24, s23
  buffer_load_dwordx4 a[80:83], v2, s[32:35], s24 offen offset:0 sc1
  buffer_load_dwordx4 a[84:87], v2, s[32:35], s24 offen offset:1024 sc1
  buffer_load_dwordx4 a[88:91], v2, s[32:35], s24 offen offset:2048 sc1
  buffer_load_dwordx4 a[92:95], v2, s[32:35], s24 offen offset:3072 sc1
  s_add_u32 s24, s24, 4096
  buffer_load_dwordx4 a[96:99], v2, s[32:35], s24 offen offset:0 sc1
  buffer_load_dwordx4 a[100:103], v2, s[32:35], s24 offen offset:1024 sc1
  buffer_load_dwordx4 a[104:107], v2, s[32:35], s24 offen offset:2048 sc1
  buffer_load_dwordx4 a[108:111], v2, s[32:35], s24 offen offset:3072 sc1
  s_add_u32 s24, s24, 4096
  s_lshl_b32 s63, s21, 19
  s_lshl_b32 s23, s20, 15
  s_add_u32 s63, s63, s23
  s_add_u32 s63, s63, 50331648
  s_mul_i32 s62, s22, 0
  s_add_u32 s64, s63, s62
  s_add_u32 s65, s64, 131072
  s_add_u32 s66, s64, 262144
  s_add_u32 s67, s64, 393216
  v_bfe_u32 v12, v1, 3, 1
  v_lshlrev_b32 v12, 7, v12
  v_and_b32 v13, 7, v1
  v_lshl_add_u32 v12, v13, 2, v12
  s_lshl_b32 s23, s21, 8
  s_lshl_b32 s31, s20, 5
  s_add_u32 s23, s23, s31
  s_add_u32 s23, s23, 2641920
  v_add_u32 v12, s23, v12
  s_lshl_b32 s25, s21, 6
  s_mul_i32 s26, s60, 160
  s_mul_i32 s27, s60, 2560
  v_add_u32 v16, 0, v0
  v_mul_u32_u24 v17, 6554, v16
  v_lshrrev_b32 v17, 16, v17
  v_mul_u32_u24 v18, 10, v17
  v_sub_u32 v18, v16, v18
  v_mul_u32_u24 v243, 336, v17
  v_lshl_add_u32 v243, v18, 5, v243
  v_lshlrev_b32 v249, 5, v18
  v_add_u32 v17, s25, v17
  v_add_u32 v24, 1, v17
  v_mul_u32_u24 v240, 1280, v17
  v_lshl_add_u32 v240, v18, 4, v240
  v_add_u32 v240, s26, v240
  v_lshrrev_b32 v19, 4, v17
  v_mul_u32_u24 v19, 20480, v19
  v_and_b32 v17, 15, v17
  v_lshl_add_u32 v19, v17, 4, v19
  v_lshl_add_u32 v246, v18, 8, v19
  v_mov_b32 v28, 8
  v_add_u32 v16, 256, v0
  v_mul_u32_u24 v17, 6554, v16
  v_lshrrev_b32 v17, 16, v17
  v_mul_u32_u24 v18, 10, v17
  v_sub_u32 v18, v16, v18
  v_mul_u32_u24 v244, 336, v17
  v_lshl_add_u32 v244, v18, 5, v244
  v_lshlrev_b32 v250, 5, v18
  v_add_u32 v17, s25, v17
  v_add_u32 v25, 1, v17
  v_mul_u32_u24 v241, 1280, v17
  v_lshl_add_u32 v241, v18, 4, v241
  v_add_u32 v241, s26, v241
  v_lshrrev_b32 v19, 4, v17
  v_mul_u32_u24 v19, 20480, v19
  v_and_b32 v17, 15, v17
  v_lshl_add_u32 v19, v17, 4, v19
  v_lshl_add_u32 v247, v18, 8, v19
  v_mov_b32 v29, 8
  v_add_u32 v16, 512, v0
  v_mul_u32_u24 v17, 6554, v16
  v_lshrrev_b32 v17, 16, v17
  v_mul_u32_u24 v18, 10, v17
  v_sub_u32 v18, v16, v18
  v_mul_u32_u24 v245, 336, v17
  v_lshl_add_u32 v245, v18, 5, v245
  v_lshlrev_b32 v251, 5, v18
  v_add_u32 v17, s25, v17
  v_add_u32 v26, 1, v17
  v_mul_u32_u24 v242, 1280, v17
  v_lshl_add_u32 v242, v18, 4, v242
  v_add_u32 v242, s26, v242
  v_lshrrev_b32 v19, 4, v17
  v_mul_u32_u24 v19, 20480, v19
  v_and_b32 v17, 15, v17
  v_lshl_add_u32 v19, v17, 4, v19
  v_lshl_add_u32 v248, v18, 8, v19
  v_mov_b32 v30, 8
  v_cmp_gt_u32 vcc, 128, v0
  v_mov_b32 v16, 1073741824
  v_mov_b32 v17, 0
  v_cndmask_b32 v242, v16, v242, vcc
  v_cndmask_b32 v248, v16, v248, vcc
  v_cndmask_b32 v245, v17, v245, vcc
  v_mov_b32 v20, 0
  v_mov_b32 v21, 0
  v_mov_b32 v22, 0
  v_mov_b32 v23, 0
  v_add_u32 v16, 133632, v2
  ds_write_b128 v16, v[20:23]
  s_waitcnt vmcnt(20) lgkmcnt(0)
  s_mov_b32 s44, s4
  s_mov_b32 s45, s5
  s_mov_b32 s46, 2621440
  s_mov_b32 s47, 0x20000
  s_mov_b32 s48, s6
  s_mov_b32 s49, s7
  s_mov_b32 s50, 2621440
  s_mov_b32 s51, 0x20000
  v_cmp_eq_u32 vcc, 0, v15
  s_cbranch_vccnz fa_sel4_spin
fa_sel4_ok:
  v_readlane_b32 s68, v15, 0
  v_readlane_b32 s69, v15, 1
  v_readlane_b32 s70, v15, 2
  v_readlane_b32 s71, v15, 3
  v_readlane_b32 s72, v15, 4
  v_readlane_b32 s73, v15, 5
  v_readlane_b32 s74, v15, 6
  v_readlane_b32 s75, v15, 7
  s_lshl_b32 s23, s20, 1
  s_add_u32 s31, s23, 8
  v_readlane_b32 s29, v15, s23
  v_readlane_b32 s30, v15, s31
  v_cmp_eq_u32 s[8:9], s68, v24
  v_cmp_eq_u32 s[10:11], s68, v25
  v_cmp_eq_u32 s[12:13], s68, v26
  v_cndmask_b32 v28, v28, 0, s[8:9]
  v_cndmask_b32 v29, v29, 0, s[10:11]
  v_cndmask_b32 v30, v30, 0, s[12:13]
  v_cmp_eq_u32 s[8:9], s69, v24
  v_cmp_eq_u32 s[10:11], s69, v25
  v_cmp_eq_u32 s[12:13], s69, v26
  v_cndmask_b32 v28, v28, 1, s[8:9]
  v_cndmask_b32 v29, v29, 1, s[10:11]
  v_cndmask_b32 v30, v30, 1, s[12:13]
  v_cmp_eq_u32 s[8:9], s70, v24
  v_cmp_eq_u32 s[10:11], s70, v25
  v_cmp_eq_u32 s[12:13], s70, v26
  v_cndmask_b32 v28, v28, 2, s[8:9]
  v_cndmask_b32 v29, v29, 2, s[10:11]
  v_cndmask_b32 v30, v30, 2, s[12:13]
  v_cmp_eq_u32 s[8:9], s71, v24
  v_cmp_eq_u32 s[10:11], s71, v25
  v_cmp_eq_u32 s[12:13], s71, v26
  v_cndmask_b32 v28, v28, 3, s[8:9]
  v_cndmask_b32 v29, v29, 3, s[10:11]
  v_cndmask_b32 v30, v30, 3, s[12:13]
  v_cmp_eq_u32 s[8:9], s72, v24
  v_cmp_eq_u32 s[10:11], s72, v25
  v_cmp_eq_u32 s[12:13], s72, v26
  v_cndmask_b32 v28, v28, 4, s[8:9]
  v_cndmask_b32 v29, v29, 4, s[10:11]
  v_cndmask_b32 v30, v30, 4, s[12:13]
  v_cmp_eq_u32 s[8:9], s73, v24
  v_cmp_eq_u32 s[10:11], s73, v25
  v_cmp_eq_u32 s[12:13], s73, v26
  v_cndmask_b32 v28, v28, 5, s[8:9]
  v_cndmask_b32 v29, v29, 5, s[10:11]
  v_cndmask_b32 v30, v30, 5, s[12:13]
  v_cmp_eq_u32 s[8:9], s74, v24
  v_cmp_eq_u32 s[10:11], s74, v25
  v_cmp_eq_u32 s[12:13], s74, v26
  v_cndmask_b32 v28, v28, 6, s[8:9]
  v_cndmask_b32 v29, v29, 6, s[10:11]
  v_cndmask_b32 v30, v30, 6, s[12:13]
  v_cmp_eq_u32 s[8:9], s75, v24
  v_cmp_eq_u32 s[10:11], s75, v25
  v_cmp_eq_u32 s[12:13], s75, v26
  v_cndmask_b32 v28, v28, 7, s[8:9]
  v_cndmask_b32 v29, v29, 7, s[10:11]
  v_cndmask_b32 v30, v30, 7, s[12:13]
  v_mul_u32_u24 v28, 320, v28
  v_add3_u32 v249, v249, v28, v17
  v_mul_u32_u24 v29, 320, v29
  v_add3_u32 v250, v250, v29, v17
  v_mul_u32_u24 v30, 320, v30
  v_add3_u32 v251, v251, v30, v17
  v_add_u32 v249, 131072, v249
  v_add_u32 v250, 131072, v250
  v_add_u32 v251, 131072, v251
  s_sub_u32 s29, s29, s25
  s_sub_u32 s29, s29, 1
  s_cmp_lt_u32 s29, 64
  s_cbranch_scc1 fa_ystub0
fa_yback0:
  s_add_u32 s23, s23, 1
  s_add_u32 s31, s23, 8
  v_readlane_b32 s29, v15, s23
  v_readlane_b32 s30, v15, s31
  s_sub_u32 s29, s29, s25
  s_sub_u32 s29, s29, 1
  s_cmp_lt_u32 s29, 64
  s_cbranch_scc1 fa_ystub1
fa_yback1:
  buffer_load_dwordx4 a[112:115], v2, s[32:35], s24 offen offset:0 sc1
  buffer_load_dwordx4 a[116:119], v2, s[32:35], s24 offen offset:1024 sc1
  buffer_load_dwordx4 a[120:123], v2, s[32:35], s24 offen offset:2048 sc1
  buffer_load_dwordx4 a[124:127], v2, s[32:35], s24 offen offset:3072 sc1
  s_add_u32 s24, s24, 4096
  buffer_load_dwordx4 a[128:131], v2, s[32:35], s24 offen offset:0 sc1
  buffer_load_dwordx4 a[132:135], v2, s[32:35], s24 offen offset:1024 sc1
  buffer_load_dwordx4 a[136:139], v2, s[32:35], s24 offen offset:2048 sc1
  buffer_load_dwordx4 a[140:143], v2, s[32:35], s24 offen offset:3072 sc1
  s_add_u32 s24, s24, 4096
  buffer_load_dwordx4 a[144:147], v2, s[32:35], s24 offen offset:0 sc1
  buffer_load_dwordx4 a[148:151], v2, s[32:35], s24 offen offset:1024 sc1
  buffer_load_dwordx4 a[152:155], v2, s[32:35], s24 offen offset:2048 sc1
  buffer_load_dwordx4 a[156:159], v2, s[32:35], s24 offen offset:3072 sc1
  s_add_u32 s24, s24, 4096
  s_cmp_ge_u32 s24, s61
  s_cselect_b32 s23, 163840, 0
  s_sub_u32 s24, s24, s23
  buffer_load_dwordx4 a[160:163], v2, s[32:35], s24 offen offset:0 sc1
  buffer_load_dwordx4 a[164:167], v2, s[32:35], s24 offen offset:1024 sc1
  buffer_load_dwordx4 a[168:171], v2, s[32:35], s24 offen offset:2048 sc1
  buffer_load_dwordx4 a[172:175], v2, s[32:35], s24 offen offset:3072 sc1
  s_add_u32 s24, s24, 4096
  buffer_load_dwordx4 a[176:179], v2, s[32:35], s24 offen offset:0 sc1
  buffer_load_dwordx4 a[180:183], v2, s[32:35], s24 offen offset:1024 sc1
  buffer_load_dwordx4 a[184:187], v2, s[32:35], s24 offen offset:2048 sc1
  buffer_load_dwordx4 a[188:191], v2, s[32:35], s24 offen offset:3072 sc1
  s_add_u32 s24, s24, 4096
  buffer_load_dwordx4 a[192:195], v2, s[32:35], s24 offen offset:0 sc1
  buffer_load_dwordx4 a[196:199], v2, s[32:35], s24 offen offset:1024 sc1
  buffer_load_dwordx4 a[200:203], v2, s[32:35], s24 offen offset:2048 sc1
  buffer_load_dwordx4 a[204:207], v2, s[32:35], s24 offen offset:3072 sc1
  s_add_u32 s24, s24, 4096
  buffer_load_dwordx4 a[208:211], v2, s[32:35], s24 offen offset:0 sc1
  buffer_load_dwordx4 a[212:215], v2, s[32:35], s24 offen offset:1024 sc1
  buffer_load_dwordx4 a[216:219], v2, s[32:35], s24 offen offset:2048 sc1
  buffer_load_dwordx4 a[220:223], v2, s[32:35], s24 offen offset:3072 sc1
  s_add_u32 s24, s24, 4096
  buffer_load_dwordx4 a[224:227], v2, s[32:35], s24 offen offset:0 sc1
  buffer_load_dwordx4 a[228:231], v2, s[32:35], s24 offen offset:1024 sc1
  buffer_load_dwordx4 a[232:235], v2, s[32:35], s24 offen offset:2048 sc1
  buffer_load_dwordx4 a[236:239], v2, s[32:35], s24 offen offset:3072 sc1
  s_add_u32 s24, s24, 4096
  s_cmp_ge_u32 s24, s61
  s_cselect_b32 s23, 163840, 0
  s_sub_u32 s24, s24, s23
  buffer_load_dwordx4 a[240:243], v2, s[32:35], s24 offen offset:0 sc1
  buffer_load_dwordx4 a[244:247], v2, s[32:35], s24 offen offset:1024 sc1
  buffer_load_dwordx4 a[248:251], v2, s[32:35], s24 offen offset:2048 sc1
  buffer_load_dwordx4 a[252:255], v2, s[32:35], s24 offen offset:3072 sc1
  s_add_u32 s24, s24, 4096
  buffer_load_dwordx4 v[176:179], v2, s[32:35], s24 offen offset:0 sc1
  buffer_load_dwordx4 v[180:183], v2, s[32:35], s24 offen offset:1024 sc1
  buffer_load_dwordx4 v[184:187], v2, s[32:35], s24 offen offset:2048 sc1
  buffer_load_dwordx4 v[188:191], v2, s[32:35], s24 offen offset:3072 sc1
  s_add_u32 s24, s24, 4096
  buffer_load_dwordx4 v[192:195], v2, s[32:35], s24 offen offset:0 sc1
  buffer_load_dwordx4 v[196:199], v2, s[32:35], s24 offen offset:1024 sc1
  buffer_load_dwordx4 v[200:203], v2, s[32:35], s24 offen offset:2048 sc1
  buffer_load_dwordx4 v[204:207], v2, s[32:35], s24 offen offset:3072 sc1
  s_add_u32 s24, s24, 4096
  buffer_load_dwordx4 v[208:211], v2, s[32:35], s24 offen offset:0 sc1
  buffer_load_dwordx4 v[212:215], v2, s[32:35], s24 offen offset:1024 sc1
  buffer_load_dwordx4 v[216:219], v2, s[32:35], s24 offen offset:2048 sc1
  buffer_load_dwordx4 v[220:223], v2, s[32:35], s24 offen offset:3072 sc1
  s_add_u32 s24, s24, 4096
  buffer_load_dwordx4 v[224:227], v2, s[32:35], s24 offen offset:0 sc1
  buffer_load_dwordx4 v[228:231], v2, s[32:35], s24 offen offset:1024 sc1
  buffer_load_dwordx4 v[232:235], v2, s[32:35], s24 offen offset:2048 sc1
  buffer_load_dwordx4 v[236:239], v2, s[32:35], s24 offen offset:3072 sc1
  s_add_u32 s24, s24, 4096
  s_cmp_ge_u32 s24, s61
  s_cselect_b32 s23, 163840, 0
  s_sub_u32 s24, s24, s23
  buffer_load_dword v13, v12, s[40:43], 0 offen sc1
  v_mfma_f32_32x32x16_bf16 v[32:47], v[20:23], v[20:23], 0
  v_mfma_f32_32x32x16_bf16 v[48:63], v[20:23], v[20:23], 0
  v_mfma_f32_32x32x16_bf16 v[64:79], v[20:23], v[20:23], 0
  v_mfma_f32_32x32x16_bf16 v[80:95], v[20:23], v[20:23], 0
  v_mfma_f32_32x32x16_bf16 v[96:111], v[20:23], v[20:23], 0
  s_mov_b32 s28, 0
  s_waitcnt vmcnt(0)
  v_cmp_eq_u32 vcc, 0, v13
  s_cbranch_vccnz fa_ctx_spin
fa_ctx_ok:
  buffer_load_dwordx4 v[112:115], v2, s[36:39], s64 offen offset:0 sc1
  buffer_load_dwordx4 v[116:119], v2, s[36:39], s65 offen offset:0 sc1
  buffer_load_dwordx4 v[120:123], v2, s[36:39], s66 offen offset:0 sc1
  buffer_load_dwordx4 v[124:127], v2, s[36:39], s67 offen offset:0 sc1
  buffer_load_dwordx4 v[128:131], v2, s[36:39], s64 offen offset:1024 sc1
  buffer_load_dwordx4 v[132:135], v2, s[36:39], s65 offen offset:1024 sc1
  buffer_load_dwordx4 v[136:139], v2, s[36:39], s66 offen offset:1024 sc1
  buffer_load_dwordx4 v[140:143], v2, s[36:39], s67 offen offset:1024 sc1
  buffer_load_dwordx4 v[144:147], v2, s[36:39], s64 offen offset:2048 sc1
  buffer_load_dwordx4 v[148:151], v2, s[36:39], s65 offen offset:2048 sc1
  buffer_load_dwordx4 v[152:155], v2, s[36:39], s66 offen offset:2048 sc1
  buffer_load_dwordx4 v[156:159], v2, s[36:39], s67 offen offset:2048 sc1
  buffer_load_dwordx4 v[160:163], v2, s[36:39], s64 offen offset:3072 sc1
  buffer_load_dwordx4 v[164:167], v2, s[36:39], s65 offen offset:3072 sc1
  buffer_load_dwordx4 v[168:171], v2, s[36:39], s66 offen offset:3072 sc1
  buffer_load_dwordx4 v[172:175], v2, s[36:39], s67 offen offset:3072 sc1
  s_add_u32 s62, s62, 4096
  s_and_b32 s62, s62, 0x7fff
  s_add_u32 s64, s63, s62
  s_add_u32 s65, s64, 131072
  s_add_u32 s66, s64, 262144
  s_add_u32 s67, s64, 393216
  s_waitcnt vmcnt(12)
  v_mfma_f32_16x16x32_bf16 v[32:35], a[0:3], v[112:115], v[32:35]
  v_mfma_f32_16x16x32_bf16 v[36:39], a[0:3], v[116:119], v[36:39]
  v_mfma_f32_16x16x32_bf16 v[40:43], a[0:3], v[120:123], v[40:43]
  v_mfma_f32_16x16x32_bf16 v[44:47], a[0:3], v[124:127], v[44:47]
  buffer_load_dwordx4 a[0:3], v2, s[32:35], s24 offen offset:0 sc1
  v_mfma_f32_16x16x32_bf16 v[48:51], a[4:7], v[112:115], v[48:51]
  v_mfma_f32_16x16x32_bf16 v[52:55], a[4:7], v[116:119], v[52:55]
  v_mfma_f32_16x16x32_bf16 v[56:59], a[4:7], v[120:123], v[56:59]
  v_mfma_f32_16x16x32_bf16 v[60:63], a[4:7], v[124:127], v[60:63]
  buffer_load_dwordx4 a[4:7], v2, s[32:35], s24 offen offset:1024 sc1
  v_mfma_f32_16x16x32_bf16 v[64:67], a[8:11], v[112:115], v[64:67]
  v_mfma_f32_16x16x32_bf16 v[68:71], a[8:11], v[116:119], v[68:71]
  v_mfma_f32_16x16x32_bf16 v[72:75], a[8:11], v[120:123], v[72:75]
  v_mfma_f32_16x16x32_bf16 v[76:79], a[8:11], v[124:127], v[76:79]
  buffer_load_dwordx4 a[8:11], v2, s[32:35], s24 offen offset:2048 sc1
  v_mfma_f32_16x16x32_bf16 v[80:83], a[12:15], v[112:115], v[80:83]
  v_mfma_f32_16x16x32_bf16 v[84:87], a[12:15], v[116:119], v[84:87]
  v_mfma_f32_16x16x32_bf16 v[88:91], a[12:15], v[120:123], v[88:91]
  v_mfma_f32_16x16x32_bf16 v[92:95], a[12:15], v[124:127], v[92:95]
  v_mfma_f32_16x16x32_bf16 v[96:99], a[16:19], v[112:115], v[96:99]
  buffer_load_dwordx4 v[112:115], v2, s[36:39], s64 offen offset:0 sc1
  v_mfma_f32_16x16x32_bf16 v[100:103], a[16:19], v[116:119], v[100:103]
  buffer_load_dwordx4 v[116:119], v2, s[36:39], s65 offen offset:0 sc1
  v_mfma_f32_16x16x32_bf16 v[104:107], a[16:19], v[120:123], v[104:107]
  buffer_load_dwordx4 v[120:123], v2, s[36:39], s66 offen offset:0 sc1
  v_mfma_f32_16x16x32_bf16 v[108:111], a[16:19], v[124:127], v[108:111]
  buffer_load_dwordx4 v[124:127], v2, s[36:39], s67 offen offset:0 sc1
  s_waitcnt vmcnt(15)
  v_mfma_f32_16x16x32_bf16 v[32:35], a[20:23], v[128:131], v[32:35]
  v_mfma_f32_16x16x32_bf16 v[36:39], a[20:23], v[132:135], v[36:39]
  v_mfma_f32_16x16x32_bf16 v[40:43], a[20:23], v[136:139], v[40:43]
  v_mfma_f32_16x16x32_bf16 v[44:47], a[20:23], v[140:143], v[44:47]
  buffer_load_dwordx4 a[12:15], v2, s[32:35], s24 offen offset:3072 sc1
  v_mfma_f32_16x16x32_bf16 v[48:51], a[24:27], v[128:131], v[48:51]
  s_add_u32 s24, s24, 4096
  v_mfma_f32_16x16x32_bf16 v[52:55], a[24:27], v[132:135], v[52:55]
  v_mfma_f32_16x16x32_bf16 v[56:59], a[24:27], v[136:139], v[56:59]
  v_mfma_f32_16x16x32_bf16 v[60:63], a[24:27], v[140:143], v[60:63]
  buffer_load_dwordx4 a[16:19], v2, s[32:35], s24 offen offset:0 sc1
  v_mfma_f32_16x16x32_bf16 v[64:67], a[28:31], v[128:131], v[64:67]
  v_mfma_f32_16x16x32_bf16 v[68:71], a[28:31], v[132:135], v[68:71]
  v_mfma_f32_16x16x32_bf16 v[72:75], a[28:31], v[136:139], v[72:75]
  v_mfma_f32_16x16x32_bf16 v[76:79], a[28:31], v[140:143], v[76:79]
  buffer_load_dwordx4 a[20:23], v2, s[32:35], s24 offen offset:1024 sc1
  v_mfma_f32_16x16x32_bf16 v[80:83], a[32:35], v[128:131], v[80:83]
  v_mfma_f32_16x16x32_bf16 v[84:87], a[32:35], v[132:135], v[84:87]
  v_mfma_f32_16x16x32_bf16 v[88:91], a[32:35], v[136:139], v[88:91]
  v_mfma_f32_16x16x32_bf16 v[92:95], a[32:35], v[140:143], v[92:95]
  v_mfma_f32_16x16x32_bf16 v[96:99], a[36:39], v[128:131], v[96:99]
  buffer_load_dwordx4 v[128:131], v2, s[36:39], s64 offen offset:1024 sc1
  v_mfma_f32_16x16x32_bf16 v[100:103], a[36:39], v[132:135], v[100:103]
  buffer_load_dwordx4 v[132:135], v2, s[36:39], s65 offen offset:1024 sc1
  v_mfma_f32_16x16x32_bf16 v[104:107], a[36:39], v[136:139], v[104:107]
  buffer_load_dwordx4 v[136:139], v2, s[36:39], s66 offen offset:1024 sc1
  v_mfma_f32_16x16x32_bf16 v[108:111], a[36:39], v[140:143], v[108:111]
  buffer_load_dwordx4 v[140:143], v2, s[36:39], s67 offen offset:1024 sc1
  s_waitcnt vmcnt(18)
  v_mfma_f32_16x16x32_bf16 v[32:35], a[40:43], v[144:147], v[32:35]
  v_mfma_f32_16x16x32_bf16 v[36:39], a[40:43], v[148:151], v[36:39]
  v_mfma_f32_16x16x32_bf16 v[40:43], a[40:43], v[152:155], v[40:43]
  v_mfma_f32_16x16x32_bf16 v[44:47], a[40:43], v[156:159], v[44:47]
  buffer_load_dwordx4 a[24:27], v2, s[32:35], s24 offen offset:2048 sc1
  v_mfma_f32_16x16x32_bf16 v[48:51], a[44:47], v[144:147], v[48:51]
  v_mfma_f32_16x16x32_bf16 v[52:55], a[44:47], v[148:151], v[52:55]
  v_mfma_f32_16x16x32_bf16 v[56:59], a[44:47], v[152:155], v[56:59]
  v_mfma_f32_16x16x32_bf16 v[60:63], a[44:47], v[156:159], v[60:63]
  buffer_load_dwordx4 a[28:31], v2, s[32:35], s24 offen offset:3072 sc1
  v_mfma_f32_16x16x32_bf16 v[64:67], a[48:51], v[144:147], v[64:67]
  s_add_u32 s24, s24, 4096
  v_mfma_f32_16x16x32_bf16 v[68:71], a[48:51], v[148:151], v[68:71]
  v_mfma_f32_16x16x32_bf16 v[72:75], a[48:51], v[152:155], v[72:75]
  v_mfma_f32_16x16x32_bf16 v[76:79], a[48:51], v[156:159], v[76:79]
  buffer_load_dwordx4 a[32:35], v2, s[32:35], s24 offen offset:0 sc1
  v_mfma_f32_16x16x32_bf16 v[80:83], a[52:55], v[144:147], v[80:83]
  v_mfma_f32_16x16x32_bf16 v[84:87], a[52:55], v[148:151], v[84:87]
  v_mfma_f32_16x16x32_bf16 v[88:91], a[52:55], v[152:155], v[88:91]
  v_mfma_f32_16x16x32_bf16 v[92:95], a[52:55], v[156:159], v[92:95]
  v_mfma_f32_16x16x32_bf16 v[96:99], a[56:59], v[144:147], v[96:99]
  buffer_load_dwordx4 v[144:147], v2, s[36:39], s64 offen offset:2048 sc1
  v_mfma_f32_16x16x32_bf16 v[100:103], a[56:59], v[148:151], v[100:103]
  buffer_load_dwordx4 v[148:151], v2, s[36:39], s65 offen offset:2048 sc1
  v_mfma_f32_16x16x32_bf16 v[104:107], a[56:59], v[152:155], v[104:107]
  buffer_load_dwordx4 v[152:155], v2, s[36:39], s66 offen offset:2048 sc1
  v_mfma_f32_16x16x32_bf16 v[108:111], a[56:59], v[156:159], v[108:111]
  buffer_load_dwordx4 v[156:159], v2, s[36:39], s67 offen offset:2048 sc1
  s_waitcnt vmcnt(21)
  v_mfma_f32_16x16x32_bf16 v[32:35], a[60:63], v[160:163], v[32:35]
  v_mfma_f32_16x16x32_bf16 v[36:39], a[60:63], v[164:167], v[36:39]
  v_mfma_f32_16x16x32_bf16 v[40:43], a[60:63], v[168:171], v[40:43]
  v_mfma_f32_16x16x32_bf16 v[44:47], a[60:63], v[172:175], v[44:47]
  buffer_load_dwordx4 a[36:39], v2, s[32:35], s24 offen offset:1024 sc1
  v_mfma_f32_16x16x32_bf16 v[48:51], a[64:67], v[160:163], v[48:51]
  v_mfma_f32_16x16x32_bf16 v[52:55], a[64:67], v[164:167], v[52:55]
  v_mfma_f32_16x16x32_bf16 v[56:59], a[64:67], v[168:171], v[56:59]
  v_mfma_f32_16x16x32_bf16 v[60:63], a[64:67], v[172:175], v[60:63]
  buffer_load_dwordx4 a[40:43], v2, s[32:35], s24 offen offset:2048 sc1
  v_mfma_f32_16x16x32_bf16 v[64:67], a[68:71], v[160:163], v[64:67]
  v_mfma_f32_16x16x32_bf16 v[68:71], a[68:71], v[164:167], v[68:71]
  v_mfma_f32_16x16x32_bf16 v[72:75], a[68:71], v[168:171], v[72:75]
  v_mfma_f32_16x16x32_bf16 v[76:79], a[68:71], v[172:175], v[76:79]
  buffer_load_dwordx4 a[44:47], v2, s[32:35], s24 offen offset:3072 sc1
  v_mfma_f32_16x16x32_bf16 v[80:83], a[72:75], v[160:163], v[80:83]
  s_add_u32 s24, s24, 4096
  v_mfma_f32_16x16x32_bf16 v[84:87], a[72:75], v[164:167], v[84:87]
  v_mfma_f32_16x16x32_bf16 v[88:91], a[72:75], v[168:171], v[88:91]
  v_mfma_f32_16x16x32_bf16 v[92:95], a[72:75], v[172:175], v[92:95]
  v_mfma_f32_16x16x32_bf16 v[96:99], a[76:79], v[160:163], v[96:99]
  buffer_load_dwordx4 v[160:163], v2, s[36:39], s64 offen offset:3072 sc1
  v_mfma_f32_16x16x32_bf16 v[100:103], a[76:79], v[164:167], v[100:103]
  buffer_load_dwordx4 v[164:167], v2, s[36:39], s65 offen offset:3072 sc1
  v_mfma_f32_16x16x32_bf16 v[104:107], a[76:79], v[168:171], v[104:107]
  buffer_load_dwordx4 v[168:171], v2, s[36:39], s66 offen offset:3072 sc1
  v_mfma_f32_16x16x32_bf16 v[108:111], a[76:79], v[172:175], v[108:111]
  buffer_load_dwordx4 v[172:175], v2, s[36:39], s67 offen offset:3072 sc1
  s_waitcnt vmcnt(21)
  v_mfma_f32_16x16x32_bf16 v[32:35], a[80:83], v[112:115], v[32:35]
  s_add_u32 s62, s62, 4096
  v_mfma_f32_16x16x32_bf16 v[36:39], a[80:83], v[116:119], v[36:39]
  s_and_b32 s62, s62, 0x7fff
  v_mfma_f32_16x16x32_bf16 v[40:43], a[80:83], v[120:123], v[40:43]
  s_add_u32 s64, s63, s62
  v_mfma_f32_16x16x32_bf16 v[44:47], a[80:83], v[124:127], v[44:47]
  buffer_load_dwordx4 a[48:51], v2, s[32:35], s24 offen offset:0 sc1
  v_mfma_f32_16x16x32_bf16 v[48:51], a[84:87], v[112:115], v[48:51]
  v_mfma_f32_16x16x32_bf16 v[52:55], a[84:87], v[116:119], v[52:55]
  v_mfma_f32_16x16x32_bf16 v[56:59], a[84:87], v[120:123], v[56:59]
  s_add_u32 s65, s64, 131072
  v_mfma_f32_16x16x32_bf16 v[60:63], a[84:87], v[124:127], v[60:63]
  buffer_load_dwordx4 a[52:55], v2, s[32:35], s24 offen offset:1024 sc1
  v_mfma_f32_16x16x32_bf16 v[64:67], a[88:91], v[112:115], v[64:67]
  v_mfma_f32_16x16x32_bf16 v[68:71], a[88:91], v[116:119], v[68:71]
  v_mfma_f32_16x16x32_bf16 v[72:75], a[88:91], v[120:123], v[72:75]
  s_add_u32 s66, s64, 262144
  v_mfma_f32_16x16x32_bf16 v[76:79], a[88:91], v[124:127], v[76:79]
  buffer_load_dwordx4 a[56:59], v2, s[32:35], s24 offen offset:2048 sc1
  v_mfma_f32_16x16x32_bf16 v[80:83], a[92:95], v[112:115], v[80:83]
  v_mfma_f32_16x16x32_bf16 v[84:87], a[92:95], v[116:119], v[84:87]
  v_mfma_f32_16x16x32_bf16 v[88:91], a[92:95], v[120:123], v[88:91]
  s_add_u32 s67, s64, 393216
  v_mfma_f32_16x16x32_bf16 v[92:95], a[92:95], v[124:127], v[92:95]
  v_mfma_f32_16x16x32_bf16 v[96:99], a[96:99], v[112:115], v[96:99]
  buffer_load_dwordx4 v[112:115], v2, s[36:39], s64 offen offset:0 sc1
  v_mfma_f32_16x16x32_bf16 v[100:103], a[96:99], v[116:119], v[100:103]
  buffer_load_dwordx4 v[116:119], v2, s[36:39], s65 offen offset:0 sc1
  v_mfma_f32_16x16x32_bf16 v[104:107], a[96:99], v[120:123], v[104:107]
  buffer_load_dwordx4 v[120:123], v2, s[36:39], s66 offen offset:0 sc1
  v_mfma_f32_16x16x32_bf16 v[108:111], a[96:99], v[124:127], v[108:111]
  buffer_load_dwordx4 v[124:127], v2, s[36:39], s67 offen offset:0 sc1
  s_waitcnt vmcnt(21)
  v_mfma_f32_16x16x32_bf16 v[32:35], a[100:103], v[128:131], v[32:35]
  v_mfma_f32_16x16x32_bf16 v[36:39], a[100:103], v[132:135], v[36:39]
  v_mfma_f32_16x16x32_bf16 v[40:43], a[100:103], v[136:139], v[40:43]
  v_mfma_f32_16x16x32_bf16 v[44:47], a[100:103], v[140:143], v[44:47]
  buffer_load_dwordx4 a[60:63], v2, s[32:35], s24 offen offset:3072 sc1
  v_mfma_f32_16x16x32_bf16 v[48:51], a[104:107], v[128:131], v[48:51]
  s_add_u32 s24, s24, 4096
  v_mfma_f32_16x16x32_bf16 v[52:55], a[104:107], v[132:135], v[52:55]
  v_mfma_f32_16x16x32_bf16 v[56:59], a[104:107], v[136:139], v[56:59]
  v_mfma_f32_16x16x32_bf16 v[60:63], a[104:107], v[140:143], v[60:63]
  buffer_load_dwordx4 a[64:67], v2, s[32:35], s24 offen offset:0 sc1
  v_mfma_f32_16x16x32_bf16 v[64:67], a[108:111], v[128:131], v[64:67]
  v_mfma_f32_16x16x32_bf16 v[68:71], a[108:111], v[132:135], v[68:71]
  v_mfma_f32_16x16x32_bf16 v[72:75], a[108:111], v[136:139], v[72:75]
  v_mfma_f32_16x16x32_bf16 v[76:79], a[108:111], v[140:143], v[76:79]
  buffer_load_dwordx4 a[68:71], v2, s[32:35], s24 offen offset:1024 sc1
  v_mfma_f32_16x16x32_bf16 v[80:83], a[112:115], v[128:131], v[80:83]
  v_mfma_f32_16x16x32_bf16 v[84:87], a[112:115], v[132:135], v[84:87]
  v_mfma_f32_16x16x32_bf16 v[88:91], a[112:115], v[136:139], v[88:91]
  v_mfma_f32_16x16x32_bf16 v[92:95], a[112:115], v[140:143], v[92:95]
  v_mfma_f32_16x16x32_bf16 v[96:99], a[116:119], v[128:131], v[96:99]
  buffer_load_dwordx4 v[128:131], v2, s[36:39], s64 offen offset:1024 sc1
  v_mfma_f32_16x16x32_bf16 v[100:103], a[116:119], v[132:135], v[100:103]
  buffer_load_dwordx4 v[132:135], v2, s[36:39], s65 offen offset:1024 sc1
  v_mfma_f32_16x16x32_bf16 v[104:107], a[116:119], v[136:139], v[104:107]
  buffer_load_dwordx4 v[136:139], v2, s[36:39], s66 offen offset:1024 sc1
  v_mfma_f32_16x16x32_bf16 v[108:111], a[116:119], v[140:143], v[108:111]
  buffer_load_dwordx4 v[140:143], v2, s[36:39], s67 offen offset:1024 sc1
  s_waitcnt vmcnt(21)
  v_mfma_f32_16x16x32_bf16 v[32:35], a[120:123], v[144:147], v[32:35]
  v_mfma_f32_16x16x32_bf16 v[36:39], a[120:123], v[148:151], v[36:39]
  v_mfma_f32_16x16x32_bf16 v[40:43], a[120:123], v[152:155], v[40:43]
  v_mfma_f32_16x16x32_bf16 v[44:47], a[120:123], v[156:159], v[44:47]
  buffer_load_dwordx4 a[72:75], v2, s[32:35], s24 offen offset:2048 sc1
  v_mfma_f32_16x16x32_bf16 v[48:51], a[124:127], v[144:147], v[48:51]
  v_mfma_f32_16x16x32_bf16 v[52:55], a[124:127], v[148:151], v[52:55]
  v_mfma_f32_16x16x32_bf16 v[56:59], a[124:127], v[152:155], v[56:59]
  v_mfma_f32_16x16x32_bf16 v[60:63], a[124:127], v[156:159], v[60:63]
  buffer_load_dwordx4 a[76:79], v2, s[32:35], s24 offen offset:3072 sc1
  v_mfma_f32_16x16x32_bf16 v[64:67], a[128:131], v[144:147], v[64:67]
  s_add_u32 s24, s24, 4096
  v_mfma_f32_16x16x32_bf16 v[68:71], a[128:131], v[148:151], v[68:71]
  s_cmp_ge_u32 s24, s61
  s_cselect_b32 s23, 163840, 0
  s_sub_u32 s24, s24, s23
  v_mfma_f32_16x16x32_bf16 v[72:75], a[128:131], v[152:155], v[72:75]
  v_mfma_f32_16x16x32_bf16 v[76:79], a[128:131], v[156:159], v[76:79]
  buffer_load_dwordx4 a[80:83], v2, s[32:35], s24 offen offset:0 sc1
  v_mfma_f32_16x16x32_bf16 v[80:83], a[132:135], v[144:147], v[80:83]
  v_mfma_f32_16x16x32_bf16 v[84:87], a[132:135], v[148:151], v[84:87]
  v_mfma_f32_16x16x32_bf16 v[88:91], a[132:135], v[152:155], v[88:91]
  v_mfma_f32_16x16x32_bf16 v[92:95], a[132:135], v[156:159], v[92:95]
  v_mfma_f32_16x16x32_bf16 v[96:99], a[136:139], v[144:147], v[96:99]
  buffer_load_dwordx4 v[144:147], v2, s[36:39], s64 offen offset:2048 sc1
  v_mfma_f32_16x16x32_bf16 v[100:103], a[136:139], v[148:151], v[100:103]
  buffer_load_dwordx4 v[148:151], v2, s[36:39], s65 offen offset:2048 sc1
  v_mfma_f32_16x16x32_bf16 v[104:107], a[136:139], v[152:155], v[104:107]
  buffer_load_dwordx4 v[152:155], v2, s[36:39], s66 offen offset:2048 sc1
  v_mfma_f32_16x16x32_bf16 v[108:111], a[136:139], v[156:159], v[108:111]
  buffer_load_dwordx4 v[156:159], v2, s[36:39], s67 offen offset:2048 sc1
  s_waitcnt vmcnt(21)
  v_mfma_f32_16x16x32_bf16 v[32:35], a[140:143], v[160:163], v[32:35]
  v_mfma_f32_16x16x32_bf16 v[36:39], a[140:143], v[164:167], v[36:39]
  v_mfma_f32_16x16x32_bf16 v[40:43], a[140:143], v[168:171], v[40:43]
  v_mfma_f32_16x16x32_bf16 v[44:47], a[140:143], v[172:175], v[44:47]
  buffer_load_dwordx4 a[84:87], v2, s[32:35], s24 offen offset:1024 sc1
  v_mfma_f32_16x16x32_bf16 v[48:51], a[144:147], v[160:163], v[48:51]
  v_mfma_f32_16x16x32_bf16 v[52:55], a[144:147], v[164:167], v[52:55]
  v_mfma_f32_16x16x32_bf16 v[56:59], a[144:147], v[168:171], v[56:59]
  v_mfma_f32_16x16x32_bf16 v[60:63], a[144:147], v[172:175], v[60:63]
  buffer_load_dwordx4 a[88:91], v2, s[32:35], s24 offen offset:2048 sc1
  v_mfma_f32_16x16x32_bf16 v[64:67], a[148:151], v[160:163], v[64:67]
  v_mfma_f32_16x16x32_bf16 v[68:71], a[148:151], v[164:167], v[68:71]
  v_mfma_f32_16x16x32_bf16 v[72:75], a[148:151], v[168:171], v[72:75]
  v_mfma_f32_16x16x32_bf16 v[76:79], a[148:151], v[172:175], v[76:79]
  buffer_load_dwordx4 a[92:95], v2, s[32:35], s24 offen offset:3072 sc1
  v_mfma_f32_16x16x32_bf16 v[80:83], a[152:155], v[160:163], v[80:83]
  s_add_u32 s24, s24, 4096
  v_mfma_f32_16x16x32_bf16 v[84:87], a[152:155], v[164:167], v[84:87]
  v_mfma_f32_16x16x32_bf16 v[88:91], a[152:155], v[168:171], v[88:91]
  v_mfma_f32_16x16x32_bf16 v[92:95], a[152:155], v[172:175], v[92:95]
  v_mfma_f32_16x16x32_bf16 v[96:99], a[156:159], v[160:163], v[96:99]
  buffer_load_dwordx4 v[160:163], v2, s[36:39], s64 offen offset:3072 sc1
  v_mfma_f32_16x16x32_bf16 v[100:103], a[156:159], v[164:167], v[100:103]
  buffer_load_dwordx4 v[164:167], v2, s[36:39], s65 offen offset:3072 sc1
  v_mfma_f32_16x16x32_bf16 v[104:107], a[156:159], v[168:171], v[104:107]
  buffer_load_dwordx4 v[168:171], v2, s[36:39], s66 offen offset:3072 sc1
  v_mfma_f32_16x16x32_bf16 v[108:111], a[156:159], v[172:175], v[108:111]
  buffer_load_dwordx4 v[172:175], v2, s[36:39], s67 offen offset:3072 sc1
  s_waitcnt vmcnt(21)
  v_mfma_f32_16x16x32_bf16 v[32:35], a[160:163], v[112:115], v[32:35]
  s_add_u32 s62, s62, 4096
  v_mfma_f32_16x16x32_bf16 v[36:39], a[160:163], v[116:119], v[36:39]
  s_and_b32 s62, s62, 0x7fff
  v_mfma_f32_16x16x32_bf16 v[40:43], a[160:163], v[120:123], v[40:43]
  s_add_u32 s64, s63, s62
  v_mfma_f32_16x16x32_bf16 v[44:47], a[160:163], v[124:127], v[44:47]
  buffer_load_dwordx4 a[96:99], v2, s[32:35], s24 offen offset:0 sc1
  v_mfma_f32_16x16x32_bf16 v[48:51], a[164:167], v[112:115], v[48:51]
  v_mfma_f32_16x16x32_bf16 v[52:55], a[164:167], v[116:119], v[52:55]
  v_mfma_f32_16x16x32_bf16 v[56:59], a[164:167], v[120:123], v[56:59]
  s_add_u32 s65, s64, 131072
  v_mfma_f32_16x16x32_bf16 v[60:63], a[164:167], v[124:127], v[60:63]
  buffer_load_dwordx4 a[100:103], v2, s[32:35], s24 offen offset:1024 sc1
  v_mfma_f32_16x16x32_bf16 v[64:67], a[168:171], v[112:115], v[64:67]
  v_mfma_f32_16x16x32_bf16 v[68:71], a[168:171], v[116:119], v[68:71]
  v_mfma_f32_16x16x32_bf16 v[72:75], a[168:171], v[120:123], v[72:75]
  s_add_u32 s66, s64, 262144
  v_mfma_f32_16x16x32_bf16 v[76:79], a[168:171], v[124:127], v[76:79]
  buffer_load_dwordx4 a[104:107], v2, s[32:35], s24 offen offset:2048 sc1
  v_mfma_f32_16x16x32_bf16 v[80:83], a[172:175], v[112:115], v[80:83]
  v_mfma_f32_16x16x32_bf16 v[84:87], a[172:175], v[116:119], v[84:87]
  v_mfma_f32_16x16x32_bf16 v[88:91], a[172:175], v[120:123], v[88:91]
  s_add_u32 s67, s64, 393216
  v_mfma_f32_16x16x32_bf16 v[92:95], a[172:175], v[124:127], v[92:95]
  v_mfma_f32_16x16x32_bf16 v[96:99], a[176:179], v[112:115], v[96:99]
  buffer_load_dwordx4 v[112:115], v2, s[36:39], s64 offen offset:0 sc1
  v_mfma_f32_16x16x32_bf16 v[100:103], a[176:179], v[116:119], v[100:103]
  buffer_load_dwordx4 v[116:119], v2, s[36:39], s65 offen offset:0 sc1
  v_mfma_f32_16x16x32_bf16 v[104:107], a[176:179], v[120:123], v[104:107]
  buffer_load_dwordx4 v[120:123], v2, s[36:39], s66 offen offset:0 sc1
  v_mfma_f32_16x16x32_bf16 v[108:111], a[176:179], v[124:127], v[108:111]
  buffer_load_dwordx4 v[124:127], v2, s[36:39], s67 offen offset:0 sc1
  s_waitcnt vmcnt(21)
  v_mfma_f32_16x16x32_bf16 v[32:35], a[180:183], v[128:131], v[32:35]
  v_mfma_f32_16x16x32_bf16 v[36:39], a[180:183], v[132:135], v[36:39]
  v_mfma_f32_16x16x32_bf16 v[40:43], a[180:183], v[136:139], v[40:43]
  v_mfma_f32_16x16x32_bf16 v[44:47], a[180:183], v[140:143], v[44:47]
  buffer_load_dwordx4 a[108:111], v2, s[32:35], s24 offen offset:3072 sc1
  v_mfma_f32_16x16x32_bf16 v[48:51], a[184:187], v[128:131], v[48:51]
  s_add_u32 s24, s24, 4096
  v_mfma_f32_16x16x32_bf16 v[52:55], a[184:187], v[132:135], v[52:55]
  v_mfma_f32_16x16x32_bf16 v[56:59], a[184:187], v[136:139], v[56:59]
  v_mfma_f32_16x16x32_bf16 v[60:63], a[184:187], v[140:143], v[60:63]
  buffer_load_dwordx4 a[112:115], v2, s[32:35], s24 offen offset:0 sc1
  v_mfma_f32_16x16x32_bf16 v[64:67], a[188:191], v[128:131], v[64:67]
  v_mfma_f32_16x16x32_bf16 v[68:71], a[188:191], v[132:135], v[68:71]
  v_mfma_f32_16x16x32_bf16 v[72:75], a[188:191], v[136:139], v[72:75]
  v_mfma_f32_16x16x32_bf16 v[76:79], a[188:191], v[140:143], v[76:79]
  buffer_load_dwordx4 a[116:119], v2, s[32:35], s24 offen offset:1024 sc1
  v_mfma_f32_16x16x32_bf16 v[80:83], a[192:195], v[128:131], v[80:83]
  v_mfma_f32_16x16x32_bf16 v[84:87], a[192:195], v[132:135], v[84:87]
  v_mfma_f32_16x16x32_bf16 v[88:91], a[192:195], v[136:139], v[88:91]
  v_mfma_f32_16x16x32_bf16 v[92:95], a[192:195], v[140:143], v[92:95]
  v_mfma_f32_16x16x32_bf16 v[96:99], a[196:199], v[128:131], v[96:99]
  buffer_load_dwordx4 v[128:131], v2, s[36:39], s64 offen offset:1024 sc1
  v_mfma_f32_16x16x32_bf16 v[100:103], a[196:199], v[132:135], v[100:103]
  buffer_load_dwordx4 v[132:135], v2, s[36:39], s65 offen offset:1024 sc1
  v_mfma_f32_16x16x32_bf16 v[104:107], a[196:199], v[136:139], v[104:107]
  buffer_load_dwordx4 v[136:139], v2, s[36:39], s66 offen offset:1024 sc1
  v_mfma_f32_16x16x32_bf16 v[108:111], a[196:199], v[140:143], v[108:111]
  buffer_load_dwordx4 v[140:143], v2, s[36:39], s67 offen offset:1024 sc1
  s_waitcnt vmcnt(21)
  v_mfma_f32_16x16x32_bf16 v[32:35], a[200:203], v[144:147], v[32:35]
  v_mfma_f32_16x16x32_bf16 v[36:39], a[200:203], v[148:151], v[36:39]
  v_mfma_f32_16x16x32_bf16 v[40:43], a[200:203], v[152:155], v[40:43]
  v_mfma_f32_16x16x32_bf16 v[44:47], a[200:203], v[156:159], v[44:47]
  buffer_load_dwordx4 a[120:123], v2, s[32:35], s24 offen offset:2048 sc1
  v_mfma_f32_16x16x32_bf16 v[48:51], a[204:207], v[144:147], v[48:51]
  v_mfma_f32_16x16x32_bf16 v[52:55], a[204:207], v[148:151], v[52:55]
  v_mfma_f32_16x16x32_bf16 v[56:59], a[204:207], v[152:155], v[56:59]
  v_mfma_f32_16x16x32_bf16 v[60:63], a[204:207], v[156:159], v[60:63]
  buffer_load_dwordx4 a[124:127], v2, s[32:35], s24 offen offset:3072 sc1
  v_mfma_f32_16x16x32_bf16 v[64:67], a[208:211], v[144:147], v[64:67]
  s_add_u32 s24, s24, 4096
  v_mfma_f32_16x16x32_bf16 v[68:71], a[208:211], v[148:151], v[68:71]
  v_mfma_f32_16x16x32_bf16 v[72:75], a[208:211], v[152:155], v[72:75]
  v_mfma_f32_16x16x32_bf16 v[76:79], a[208:211], v[156:159], v[76:79]
  buffer_load_dwordx4 a[128:131], v2, s[32:35], s24 offen offset:0 sc1
  v_mfma_f32_16x16x32_bf16 v[80:83], a[212:215], v[144:147], v[80:83]
  v_mfma_f32_16x16x32_bf16 v[84:87], a[212:215], v[148:151], v[84:87]
  v_mfma_f32_16x16x32_bf16 v[88:91], a[212:215], v[152:155], v[88:91]
  v_mfma_f32_16x16x32_bf16 v[92:95], a[212:215], v[156:159], v[92:95]
  v_mfma_f32_16x16x32_bf16 v[96:99], a[216:219], v[144:147], v[96:99]
  buffer_load_dwordx4 v[144:147], v2, s[36:39], s64 offen offset:2048 sc1
  v_mfma_f32_16x16x32_bf16 v[100:103], a[216:219], v[148:151], v[100:103]
  buffer_load_dwordx4 v[148:151], v2, s[36:39], s65 offen offset:2048 sc1
  v_mfma_f32_16x16x32_bf16 v[104:107], a[216:219], v[152:155], v[104:107]
  buffer_load_dwordx4 v[152:155], v2, s[36:39], s66 offen offset:2048 sc1
  v_mfma_f32_16x16x32_bf16 v[108:111], a[216:219], v[156:159], v[108:111]
  buffer_load_dwordx4 v[156:159], v2, s[36:39], s67 offen offset:2048 sc1
  s_waitcnt vmcnt(21)
  v_mfma_f32_16x16x32_bf16 v[32:35], a[220:223], v[160:163], v[32:35]
  v_mfma_f32_16x16x32_bf16 v[36:39], a[220:223], v[164:167], v[36:39]
  v_mfma_f32_16x16x32_bf16 v[40:43], a[220:223], v[168:171], v[40:43]
  v_mfma_f32_16x16x32_bf16 v[44:47], a[220:223], v[172:175], v[44:47]
  buffer_load_dwordx4 a[132:135], v2, s[32:35], s24 offen offset:1024 sc1
  v_mfma_f32_16x16x32_bf16 v[48:51], a[224:227], v[160:163], v[48:51]
  v_mfma_f32_16x16x32_bf16 v[52:55], a[224:227], v[164:167], v[52:55]
  v_mfma_f32_16x16x32_bf16 v[56:59], a[224:227], v[168:171], v[56:59]
  v_mfma_f32_16x16x32_bf16 v[60:63], a[224:227], v[172:175], v[60:63]
  buffer_load_dwordx4 a[136:139], v2, s[32:35], s24 offen offset:2048 sc1
  v_mfma_f32_16x16x32_bf16 v[64:67], a[228:231], v[160:163], v[64:67]
  v_mfma_f32_16x16x32_bf16 v[68:71], a[228:231], v[164:167], v[68:71]
  v_mfma_f32_16x16x32_bf16 v[72:75], a[228:231], v[168:171], v[72:75]
  v_mfma_f32_16x16x32_bf16 v[76:79], a[228:231], v[172:175], v[76:79]
  buffer_load_dwordx4 a[140:143], v2, s[32:35], s24 offen offset:3072 sc1
  v_mfma_f32_16x16x32_bf16 v[80:83], a[232:235], v[160:163], v[80:83]
  s_add_u32 s24, s24, 4096
  v_mfma_f32_16x16x32_bf16 v[84:87], a[232:235], v[164:167], v[84:87]
  v_mfma_f32_16x16x32_bf16 v[88:91], a[232:235], v[168:171], v[88:91]
  v_mfma_f32_16x16x32_bf16 v[92:95], a[232:235], v[172:175], v[92:95]
  v_mfma_f32_16x16x32_bf16 v[96:99], a[236:239], v[160:163], v[96:99]
  buffer_load_dwordx4 v[160:163], v2, s[36:39], s64 offen offset:3072 sc1
  v_mfma_f32_16x16x32_bf16 v[100:103], a[236:239], v[164:167], v[100:103]
  buffer_load_dwordx4 v[164:167], v2, s[36:39], s65 offen offset:3072 sc1
  v_mfma_f32_16x16x32_bf16 v[104:107], a[236:239], v[168:171], v[104:107]
  buffer_load_dwordx4 v[168:171], v2, s[36:39], s66 offen offset:3072 sc1
  v_mfma_f32_16x16x32_bf16 v[108:111], a[236:239], v[172:175], v[108:111]
  buffer_load_dwordx4 v[172:175], v2, s[36:39], s67 offen offset:3072 sc1
  s_waitcnt vmcnt(21)
  v_mfma_f32_16x16x32_bf16 v[32:35], a[240:243], v[112:115], v[32:35]
  s_add_u32 s62, s62, 4096
  v_mfma_f32_16x16x32_bf16 v[36:39], a[240:243], v[116:119], v[36:39]
  s_and_b32 s62, s62, 0x7fff
  v_mfma_f32_16x16x32_bf16 v[40:43], a[240:243], v[120:123], v[40:43]
  s_add_u32 s64, s63, s62
  v_mfma_f32_16x16x32_bf16 v[44:47], a[240:243], v[124:127], v[44:47]
  buffer_load_dwordx4 a[144:147], v2, s[32:35], s24 offen offset:0 sc1
  v_mfma_f32_16x16x32_bf16 v[48:51], a[244:247], v[112:115], v[48:51]
  v_mfma_f32_16x16x32_bf16 v[52:55], a[244:247], v[116:119], v[52:55]
  v_mfma_f32_16x16x32_bf16 v[56:59], a[244:247], v[120:123], v[56:59]
  s_add_u32 s65, s64, 131072
  v_mfma_f32_16x16x32_bf16 v[60:63], a[244:247], v[124:127], v[60:63]
  buffer_load_dwordx4 a[148:151], v2, s[32:35], s24 offen offset:1024 sc1
  v_mfma_f32_16x16x32_bf16 v[64:67], a[248:251], v[112:115], v[64:67]
  v_mfma_f32_16x16x32_bf16 v[68:71], a[248:251], v[116:119], v[68:71]
  v_mfma_f32_16x16x32_bf16 v[72:75], a[248:251], v[120:123], v[72:75]
  s_add_u32 s66, s64, 262144
  v_mfma_f32_16x16x32_bf16 v[76:79], a[248:251], v[124:127], v[76:79]
  buffer_load_dwordx4 a[152:155], v2, s[32:35], s24 offen offset:2048 sc1
  v_mfma_f32_16x16x32_bf16 v[80:83], a[252:255], v[112:115], v[80:83]
  v_mfma_f32_16x16x32_bf16 v[84:87], a[252:255], v[116:119], v[84:87]
  v_mfma_f32_16x16x32_bf16 v[88:91], a[252:255], v[120:123], v[88:91]
  s_add_u32 s67, s64, 393216
  v_mfma_f32_16x16x32_bf16 v[92:95], a[252:255], v[124:127], v[92:95]
  v_mfma_f32_16x16x32_bf16 v[96:99], v[176:179], v[112:115], v[96:99]
  buffer_load_dwordx4 v[112:115], v2, s[36:39], s64 offen offset:0 sc1
  v_mfma_f32_16x16x32_bf16 v[100:103], v[176:179], v[116:119], v[100:103]
  buffer_load_dwordx4 v[116:119], v2, s[36:39], s65 offen offset:0 sc1
  v_mfma_f32_16x16x32_bf16 v[104:107], v[176:179], v[120:123], v[104:107]
  buffer_load_dwordx4 v[120:123], v2, s[36:39], s66 offen offset:0 sc1
  v_mfma_f32_16x16x32_bf16 v[108:111], v[176:179], v[124:127], v[108:111]
  buffer_load_dwordx4 v[124:127], v2, s[36:39], s67 offen offset:0 sc1
  s_waitcnt vmcnt(21)
  v_mfma_f32_16x16x32_bf16 v[32:35], v[180:183], v[128:131], v[32:35]
  v_mfma_f32_16x16x32_bf16 v[36:39], v[180:183], v[132:135], v[36:39]
  v_mfma_f32_16x16x32_bf16 v[40:43], v[180:183], v[136:139], v[40:43]
  v_mfma_f32_16x16x32_bf16 v[44:47], v[180:183], v[140:143], v[44:47]
  buffer_load_dwordx4 a[156:159], v2, s[32:35], s24 offen offset:3072 sc1
  v_mfma_f32_16x16x32_bf16 v[48:51], v[184:187], v[128:131], v[48:51]
  s_add_u32 s24, s24, 4096
  v_mfma_f32_16x16x32_bf16 v[52:55], v[184:187], v[132:135], v[52:55]
  s_cmp_ge_u32 s24, s61
  s_cselect_b32 s23, 163840, 0
  s_sub_u32 s24, s24, s23
  v_mfma_f32_16x16x32_bf16 v[56:59], v[184:187], v[136:139], v[56:59]
  v_mfma_f32_16x16x32_bf16 v[60:63], v[184:187], v[140:143], v[60:63]
  buffer_load_dwordx4 a[160:163], v2, s[32:35], s24 offen offset:0 sc1
  v_mfma_f32_16x16x32_bf16 v[64:67], v[188:191], v[128:131], v[64:67]
  v_mfma_f32_16x16x32_bf16 v[68:71], v[188:191], v[132:135], v[68:71]
  v_mfma_f32_16x16x32_bf16 v[72:75], v[188:191], v[136:139], v[72:75]
  v_mfma_f32_16x16x32_bf16 v[76:79], v[188:191], v[140:143], v[76:79]
  buffer_load_dwordx4 a[164:167], v2, s[32:35], s24 offen offset:1024 sc1
  v_mfma_f32_16x16x32_bf16 v[80:83], v[192:195], v[128:131], v[80:83]
  v_mfma_f32_16x16x32_bf16 v[84:87], v[192:195], v[132:135], v[84:87]
  v_mfma_f32_16x16x32_bf16 v[88:91], v[192:195], v[136:139], v[88:91]
  v_mfma_f32_16x16x32_bf16 v[92:95], v[192:195], v[140:143], v[92:95]
  v_mfma_f32_16x16x32_bf16 v[96:99], v[196:199], v[128:131], v[96:99]
  buffer_load_dwordx4 v[128:131], v2, s[36:39], s64 offen offset:1024 sc1
  v_mfma_f32_16x16x32_bf16 v[100:103], v[196:199], v[132:135], v[100:103]
  buffer_load_dwordx4 v[132:135], v2, s[36:39], s65 offen offset:1024 sc1
  v_mfma_f32_16x16x32_bf16 v[104:107], v[196:199], v[136:139], v[104:107]
  buffer_load_dwordx4 v[136:139], v2, s[36:39], s66 offen offset:1024 sc1
  v_mfma_f32_16x16x32_bf16 v[108:111], v[196:199], v[140:143], v[108:111]
  buffer_load_dwordx4 v[140:143], v2, s[36:39], s67 offen offset:1024 sc1
  s_waitcnt vmcnt(21)
  v_mfma_f32_16x16x32_bf16 v[32:35], v[200:203], v[144:147], v[32:35]
  v_mfma_f32_16x16x32_bf16 v[36:39], v[200:203], v[148:151], v[36:39]
  v_mfma_f32_16x16x32_bf16 v[40:43], v[200:203], v[152:155], v[40:43]
  v_mfma_f32_16x16x32_bf16 v[44:47], v[200:203], v[156:159], v[44:47]
  buffer_load_dwordx4 a[168:171], v2, s[32:35], s24 offen offset:2048 sc1
  v_mfma_f32_16x16x32_bf16 v[48:51], v[204:207], v[144:147], v[48:51]
  v_mfma_f32_16x16x32_bf16 v[52:55], v[204:207], v[148:151], v[52:55]
  v_mfma_f32_16x16x32_bf16 v[56:59], v[204:207], v[152:155], v[56:59]
  v_mfma_f32_16x16x32_bf16 v[60:63], v[204:207], v[156:159], v[60:63]
  buffer_load_dwordx4 a[172:175], v2, s[32:35], s24 offen offset:3072 sc1
  v_mfma_f32_16x16x32_bf16 v[64:67], v[208:211], v[144:147], v[64:67]
  s_add_u32 s24, s24, 4096
  v_mfma_f32_16x16x32_bf16 v[68:71], v[208:211], v[148:151], v[68:71]
  v_mfma_f32_16x16x32_bf16 v[72:75], v[208:211], v[152:155], v[72:75]
  v_mfma_f32_16x16x32_bf16 v[76:79], v[208:211], v[156:159], v[76:79]
  buffer_load_dwordx4 a[176:179], v2, s[32:35], s24 offen offset:0 sc1
  v_mfma_f32_16x16x32_bf16 v[80:83], v[212:215], v[144:147], v[80:83]
  v_mfma_f32_16x16x32_bf16 v[84:87], v[212:215], v[148:151], v[84:87]
  v_mfma_f32_16x16x32_bf16 v[88:91], v[212:215], v[152:155], v[88:91]
  v_mfma_f32_16x16x32_bf16 v[92:95], v[212:215], v[156:159], v[92:95]
  v_mfma_f32_16x16x32_bf16 v[96:99], v[216:219], v[144:147], v[96:99]
  buffer_load_dwordx4 v[144:147], v2, s[36:39], s64 offen offset:2048 sc1
  v_mfma_f32_16x16x32_bf16 v[100:103], v[216:219], v[148:151], v[100:103]
  buffer_load_dwordx4 v[148:151], v2, s[36:39], s65 offen offset:2048 sc1
  v_mfma_f32_16x16x32_bf16 v[104:107], v[216:219], v[152:155], v[104:107]
  buffer_load_dwordx4 v[152:155], v2, s[36:39], s66 offen offset:2048 sc1
  v_mfma_f32_16x16x32_bf16 v[108:111], v[216:219], v[156:159], v[108:111]
  buffer_load_dwordx4 v[156:159], v2, s[36:39], s67 offen offset:2048 sc1
  s_waitcnt vmcnt(21)
  v_mfma_f32_16x16x32_bf16 v[32:35], v[220:223], v[160:163], v[32:35]
  v_mfma_f32_16x16x32_bf16 v[36:39], v[220:223], v[164:167], v[36:39]
  v_mfma_f32_16x16x32_bf16 v[40:43], v[220:223], v[168:171], v[40:43]
  v_mfma_f32_16x16x32_bf16 v[44:47], v[220:223], v[172:175], v[44:47]
  buffer_load_dwordx4 a[180:183], v2, s[32:35], s24 offen offset:1024 sc1
  v_mfma_f32_16x16x32_bf16 v[48:51], v[224:227], v[160:163], v[48:51]
  v_mfma_f32_16x16x32_bf16 v[52:55], v[224:227], v[164:167], v[52:55]
  v_mfma_f32_16x16x32_bf16 v[56:59], v[224:227], v[168:171], v[56:59]
  v_mfma_f32_16x16x32_bf16 v[60:63], v[224:227], v[172:175], v[60:63]
  buffer_load_dwordx4 a[184:187], v2, s[32:35], s24 offen offset:2048 sc1
  v_mfma_f32_16x16x32_bf16 v[64:67], v[228:231], v[160:163], v[64:67]
  v_mfma_f32_16x16x32_bf16 v[68:71], v[228:231], v[164:167], v[68:71]
  v_mfma_f32_16x16x32_bf16 v[72:75], v[228:231], v[168:171], v[72:75]
  v_mfma_f32_16x16x32_bf16 v[76:79], v[228:231], v[172:175], v[76:79]
  buffer_load_dwordx4 a[188:191], v2, s[32:35], s24 offen offset:3072 sc1
  v_mfma_f32_16x16x32_bf16 v[80:83], v[232:235], v[160:163], v[80:83]
  s_add_u32 s24, s24, 4096
  v_mfma_f32_16x16x32_bf16 v[84:87], v[232:235], v[164:167], v[84:87]
  v_mfma_f32_16x16x32_bf16 v[88:91], v[232:235], v[168:171], v[88:91]
  v_mfma_f32_16x16x32_bf16 v[92:95], v[232:235], v[172:175], v[92:95]
  v_mfma_f32_16x16x32_bf16 v[96:99], v[236:239], v[160:163], v[96:99]
  buffer_load_dwordx4 v[160:163], v2, s[36:39], s64 offen offset:3072 sc1
  v_mfma_f32_16x16x32_bf16 v[100:103], v[236:239], v[164:167], v[100:103]
  buffer_load_dwordx4 v[164:167], v2, s[36:39], s65 offen offset:3072 sc1
  v_mfma_f32_16x16x32_bf16 v[104:107], v[236:239], v[168:171], v[104:107]
  buffer_load_dwordx4 v[168:171], v2, s[36:39], s66 offen offset:3072 sc1
  v_mfma_f32_16x16x32_bf16 v[108:111], v[236:239], v[172:175], v[108:111]
  buffer_load_dwordx4 v[172:175], v2, s[36:39], s67 offen offset:3072 sc1
  s_waitcnt vmcnt(21)
  v_mfma_f32_16x16x32_bf16 v[32:35], a[0:3], v[112:115], v[32:35]
  s_add_u32 s62, s62, 4096
  v_mfma_f32_16x16x32_bf16 v[36:39], a[0:3], v[116:119], v[36:39]
  s_and_b32 s62, s62, 0x7fff
  v_mfma_f32_16x16x32_bf16 v[40:43], a[0:3], v[120:123], v[40:43]
  s_add_u32 s64, s63, s62
  v_mfma_f32_16x16x32_bf16 v[44:47], a[0:3], v[124:127], v[44:47]
  buffer_load_dwordx4 a[192:195], v2, s[32:35], s24 offen offset:0 sc1
  v_mfma_f32_16x16x32_bf16 v[48:51], a[4:7], v[112:115], v[48:51]
  v_mfma_f32_16x16x32_bf16 v[52:55], a[4:7], v[116:119], v[52:55]
  v_mfma_f32_16x16x32_bf16 v[56:59], a[4:7], v[120:123], v[56:59]
  s_add_u32 s65, s64, 131072
  v_mfma_f32_16x16x32_bf16 v[60:63], a[4:7], v[124:127], v[60:63]
  buffer_load_dwordx4 a[196:199], v2, s[32:35], s24 offen offset:1024 sc1
  v_mfma_f32_16x16x32_bf16 v[64:67], a[8:11], v[112:115], v[64:67]
  v_mfma_f32_16x16x32_bf16 v[68:71], a[8:11], v[116:119], v[68:71]
  v_mfma_f32_16x16x32_bf16 v[72:75], a[8:11], v[120:123], v[72:75]
  s_add_u32 s66, s64, 262144
  v_mfma_f32_16x16x32_bf16 v[76:79], a[8:11], v[124:127], v[76:79]
  buffer_load_dwordx4 a[200:203], v2, s[32:35], s24 offen offset:2048 sc1
  v_mfma_f32_16x16x32_bf16 v[80:83], a[12:15], v[112:115], v[80:83]
  v_mfma_f32_16x16x32_bf16 v[84:87], a[12:15], v[116:119], v[84:87]
  v_mfma_f32_16x16x32_bf16 v[88:91], a[12:15], v[120:123], v[88:91]
  s_add_u32 s67, s64, 393216
  v_mfma_f32_16x16x32_bf16 v[92:95], a[12:15], v[124:127], v[92:95]
  v_mfma_f32_16x16x32_bf16 v[96:99], a[16:19], v[112:115], v[96:99]
  buffer_load_dwordx4 v[112:115], v2, s[36:39], s64 offen offset:0 sc1
  v_mfma_f32_16x16x32_bf16 v[100:103], a[16:19], v[116:119], v[100:103]
  buffer_load_dwordx4 v[116:119], v2, s[36:39], s65 offen offset:0 sc1
  v_mfma_f32_16x16x32_bf16 v[104:107], a[16:19], v[120:123], v[104:107]
  buffer_load_dwordx4 v[120:123], v2, s[36:39], s66 offen offset:0 sc1
  v_mfma_f32_16x16x32_bf16 v[108:111], a[16:19], v[124:127], v[108:111]
  buffer_load_dwordx4 v[124:127], v2, s[36:39], s67 offen offset:0 sc1
  s_waitcnt vmcnt(21)
  v_mfma_f32_16x16x32_bf16 v[32:35], a[20:23], v[128:131], v[32:35]
  v_mfma_f32_16x16x32_bf16 v[36:39], a[20:23], v[132:135], v[36:39]
  v_mfma_f32_16x16x32_bf16 v[40:43], a[20:23], v[136:139], v[40:43]
  v_mfma_f32_16x16x32_bf16 v[44:47], a[20:23], v[140:143], v[44:47]
  buffer_load_dwordx4 a[204:207], v2, s[32:35], s24 offen offset:3072 sc1
  v_mfma_f32_16x16x32_bf16 v[48:51], a[24:27], v[128:131], v[48:51]
  s_add_u32 s24, s24, 4096
  v_mfma_f32_16x16x32_bf16 v[52:55], a[24:27], v[132:135], v[52:55]
  v_mfma_f32_16x16x32_bf16 v[56:59], a[24:27], v[136:139], v[56:59]
  v_mfma_f32_16x16x32_bf16 v[60:63], a[24:27], v[140:143], v[60:63]
  buffer_load_dwordx4 a[208:211], v2, s[32:35], s24 offen offset:0 sc1
  v_mfma_f32_16x16x32_bf16 v[64:67], a[28:31], v[128:131], v[64:67]
  v_mfma_f32_16x16x32_bf16 v[68:71], a[28:31], v[132:135], v[68:71]
  v_mfma_f32_16x16x32_bf16 v[72:75], a[28:31], v[136:139], v[72:75]
  v_mfma_f32_16x16x32_bf16 v[76:79], a[28:31], v[140:143], v[76:79]
  buffer_load_dwordx4 a[212:215], v2, s[32:35], s24 offen offset:1024 sc1
  v_mfma_f32_16x16x32_bf16 v[80:83], a[32:35], v[128:131], v[80:83]
  v_mfma_f32_16x16x32_bf16 v[84:87], a[32:35], v[132:135], v[84:87]
  v_mfma_f32_16x16x32_bf16 v[88:91], a[32:35], v[136:139], v[88:91]
  v_mfma_f32_16x16x32_bf16 v[92:95], a[32:35], v[140:143], v[92:95]
  v_mfma_f32_16x16x32_bf16 v[96:99], a[36:39], v[128:131], v[96:99]
  buffer_load_dwordx4 v[128:131], v2, s[36:39], s64 offen offset:1024 sc1
  v_mfma_f32_16x16x32_bf16 v[100:103], a[36:39], v[132:135], v[100:103]
  buffer_load_dwordx4 v[132:135], v2, s[36:39], s65 offen offset:1024 sc1
  v_mfma_f32_16x16x32_bf16 v[104:107], a[36:39], v[136:139], v[104:107]
  buffer_load_dwordx4 v[136:139], v2, s[36:39], s66 offen offset:1024 sc1
  v_mfma_f32_16x16x32_bf16 v[108:111], a[36:39], v[140:143], v[108:111]
  buffer_load_dwordx4 v[140:143], v2, s[36:39], s67 offen offset:1024 sc1
  s_waitcnt vmcnt(21)
  v_mfma_f32_16x16x32_bf16 v[32:35], a[40:43], v[144:147], v[32:35]
  v_mfma_f32_16x16x32_bf16 v[36:39], a[40:43], v[148:151], v[36:39]
  v_mfma_f32_16x16x32_bf16 v[40:43], a[40:43], v[152:155], v[40:43]
  v_mfma_f32_16x16x32_bf16 v[44:47], a[40:43], v[156:159], v[44:47]
  buffer_load_dwordx4 a[216:219], v2, s[32:35], s24 offen offset:2048 sc1
  v_mfma_f32_16x16x32_bf16 v[48:51], a[44:47], v[144:147], v[48:51]
  v_mfma_f32_16x16x32_bf16 v[52:55], a[44:47], v[148:151], v[52:55]
  v_mfma_f32_16x16x32_bf16 v[56:59], a[44:47], v[152:155], v[56:59]
  v_mfma_f32_16x16x32_bf16 v[60:63], a[44:47], v[156:159], v[60:63]
  buffer_load_dwordx4 a[220:223], v2, s[32:35], s24 offen offset:3072 sc1
  v_mfma_f32_16x16x32_bf16 v[64:67], a[48:51], v[144:147], v[64:67]
  s_add_u32 s24, s24, 4096
  v_mfma_f32_16x16x32_bf16 v[68:71], a[48:51], v[148:151], v[68:71]
  v_mfma_f32_16x16x32_bf16 v[72:75], a[48:51], v[152:155], v[72:75]
  v_mfma_f32_16x16x32_bf16 v[76:79], a[48:51], v[156:159], v[76:79]
  buffer_load_dwordx4 a[224:227], v2, s[32:35], s24 offen offset:0 sc1
  v_mfma_f32_16x16x32_bf16 v[80:83], a[52:55], v[144:147], v[80:83]
  v_mfma_f32_16x16x32_bf16 v[84:87], a[52:55], v[148:151], v[84:87]
  v_mfma_f32_16x16x32_bf16 v[88:91], a[52:55], v[152:155], v[88:91]
  v_mfma_f32_16x16x32_bf16 v[92:95], a[52:55], v[156:159], v[92:95]
  v_mfma_f32_16x16x32_bf16 v[96:99], a[56:59], v[144:147], v[96:99]
  buffer_load_dwordx4 v[144:147], v2, s[36:39], s64 offen offset:2048 sc1
  v_mfma_f32_16x16x32_bf16 v[100:103], a[56:59], v[148:151], v[100:103]
  buffer_load_dwordx4 v[148:151], v2, s[36:39], s65 offen offset:2048 sc1
  v_mfma_f32_16x16x32_bf16 v[104:107], a[56:59], v[152:155], v[104:107]
  buffer_load_dwordx4 v[152:155], v2, s[36:39], s66 offen offset:2048 sc1
  v_mfma_f32_16x16x32_bf16 v[108:111], a[56:59], v[156:159], v[108:111]
  buffer_load_dwordx4 v[156:159], v2, s[36:39], s67 offen offset:2048 sc1
  s_waitcnt vmcnt(21)
  v_mfma_f32_16x16x32_bf16 v[32:35], a[60:63], v[160:163], v[32:35]
  v_mfma_f32_16x16x32_bf16 v[36:39], a[60:63], v[164:167], v[36:39]
  v_mfma_f32_16x16x32_bf16 v[40:43], a[60:63], v[168:171], v[40:43]
  v_mfma_f32_16x16x32_bf16 v[44:47], a[60:63], v[172:175], v[44:47]
  buffer_load_dwordx4 a[228:231], v2, s[32:35], s24 offen offset:1024 sc1
  v_mfma_f32_16x16x32_bf16 v[48:51], a[64:67], v[160:163], v[48:51]
  v_mfma_f32_16x16x32_bf16 v[52:55], a[64:67], v[164:167], v[52:55]
  v_mfma_f32_16x16x32_bf16 v[56:59], a[64:67], v[168:171], v[56:59]
  v_mfma_f32_16x16x32_bf16 v[60:63], a[64:67], v[172:175], v[60:63]
  buffer_load_dwordx4 a[232:235], v2, s[32:35], s24 offen offset:2048 sc1
  v_mfma_f32_16x16x32_bf16 v[64:67], a[68:71], v[160:163], v[64:67]
  v_mfma_f32_16x16x32_bf16 v[68:71], a[68:71], v[164:167], v[68:71]
  v_mfma_f32_16x16x32_bf16 v[72:75], a[68:71], v[168:171], v[72:75]
  v_mfma_f32_16x16x32_bf16 v[76:79], a[68:71], v[172:175], v[76:79]
  buffer_load_dwordx4 a[236:239], v2, s[32:35], s24 offen offset:3072 sc1
  v_mfma_f32_16x16x32_bf16 v[80:83], a[72:75], v[160:163], v[80:83]
  s_add_u32 s24, s24, 4096
  v_mfma_f32_16x16x32_bf16 v[84:87], a[72:75], v[164:167], v[84:87]
  s_cmp_ge_u32 s24, s61
  s_cselect_b32 s23, 163840, 0
  s_sub_u32 s24, s24, s23
  v_mfma_f32_16x16x32_bf16 v[88:91], a[72:75], v[168:171], v[88:91]
  v_mfma_f32_16x16x32_bf16 v[92:95], a[72:75], v[172:175], v[92:95]
  v_mfma_f32_16x16x32_bf16 v[96:99], a[76:79], v[160:163], v[96:99]
  buffer_load_dwordx4 v[160:163], v2, s[36:39], s64 offen offset:3072 sc1
  v_mfma_f32_16x16x32_bf16 v[100:103], a[76:79], v[164:167], v[100:103]
  buffer_load_dwordx4 v[164:167], v2, s[36:39], s65 offen offset:3072 sc1
  v_mfma_f32_16x16x32_bf16 v[104:107], a[76:79], v[168:171], v[104:107]
  buffer_load_dwordx4 v[168:171], v2, s[36:39], s66 offen offset:3072 sc1
  v_mfma_f32_16x16x32_bf16 v[108:111], a[76:79], v[172:175], v[108:111]
  buffer_load_dwordx4 v[172:175], v2, s[36:39], s67 offen offset:3072 sc1
  s_waitcnt vmcnt(21)
  v_mfma_f32_16x16x32_bf16 v[32:35], a[80:83], v[112:115], v[32:35]
  s_add_u32 s62, s62, 4096
  v_mfma_f32_16x16x32_bf16 v[36:39], a[80:83], v[116:119], v[36:39]
  s_and_b32 s62, s62, 0x7fff
  v_mfma_f32_16x16x32_bf16 v[40:43], a[80:83], v[120:123], v[40:43]
  s_add_u32 s64, s63, s62
  v_mfma_f32_16x16x32_bf16 v[44:47], a[80:83], v[124:127], v[44:47]
  buffer_load_dwordx4 a[240:243], v2, s[32:35], s24 offen offset:0 sc1
  v_mfma_f32_16x16x32_bf16 v[48:51], a[84:87], v[112:115], v[48:51]
  v_mfma_f32_16x16x32_bf16 v[52:55], a[84:87], v[116:119], v[52:55]
  v_mfma_f32_16x16x32_bf16 v[56:59], a[84:87], v[120:123], v[56:59]
  s_add_u32 s65, s64, 131072
  v_mfma_f32_16x16x32_bf16 v[60:63], a[84:87], v[124:127], v[60:63]
  buffer_load_dwordx4 a[244:247], v2, s[32:35], s24 offen offset:1024 sc1
  v_mfma_f32_16x16x32_bf16 v[64:67], a[88:91], v[112:115], v[64:67]
  v_mfma_f32_16x16x32_bf16 v[68:71], a[88:91], v[116:119], v[68:71]
  v_mfma_f32_16x16x32_bf16 v[72:75], a[88:91], v[120:123], v[72:75]
  s_add_u32 s66, s64, 262144
  v_mfma_f32_16x16x32_bf16 v[76:79], a[88:91], v[124:127], v[76:79]
  buffer_load_dwordx4 a[248:251], v2, s[32:35], s24 offen offset:2048 sc1
  v_mfma_f32_16x16x32_bf16 v[80:83], a[92:95], v[112:115], v[80:83]
  v_mfma_f32_16x16x32_bf16 v[84:87], a[92:95], v[116:119], v[84:87]
  v_mfma_f32_16x16x32_bf16 v[88:91], a[92:95], v[120:123], v[88:91]
  s_add_u32 s67, s64, 393216
  v_mfma_f32_16x16x32_bf16 v[92:95], a[92:95], v[124:127], v[92:95]
  v_mfma_f32_16x16x32_bf16 v[96:99], a[96:99], v[112:115], v[96:99]
  buffer_load_dwordx4 v[112:115], v2, s[36:39], s64 offen offset:0 sc1
  v_mfma_f32_16x16x32_bf16 v[100:103], a[96:99], v[116:119], v[100:103]
  buffer_load_dwordx4 v[116:119], v2, s[36:39], s65 offen offset:0 sc1
  v_mfma_f32_16x16x32_bf16 v[104:107], a[96:99], v[120:123], v[104:107]
  buffer_load_dwordx4 v[120:123], v2, s[36:39], s66 offen offset:0 sc1
  v_mfma_f32_16x16x32_bf16 v[108:111], a[96:99], v[124:127], v[108:111]
  buffer_load_dwordx4 v[124:127], v2, s[36:39], s67 offen offset:0 sc1
  s_waitcnt vmcnt(21)
  v_mfma_f32_16x16x32_bf16 v[32:35], a[100:103], v[128:131], v[32:35]
  v_mfma_f32_16x16x32_bf16 v[36:39], a[100:103], v[132:135], v[36:39]
  v_mfma_f32_16x16x32_bf16 v[40:43], a[100:103], v[136:139], v[40:43]
  v_mfma_f32_16x16x32_bf16 v[44:47], a[100:103], v[140:143], v[44:47]
  buffer_load_dwordx4 a[252:255], v2, s[32:35], s24 offen offset:3072 sc1
  v_mfma_f32_16x16x32_bf16 v[48:51], a[104:107], v[128:131], v[48:51]
  s_add_u32 s24, s24, 4096
  v_mfma_f32_16x16x32_bf16 v[52:55], a[104:107], v[132:135], v[52:55]
  v_mfma_f32_16x16x32_bf16 v[56:59], a[104:107], v[136:139], v[56:59]
  v_mfma_f32_16x16x32_bf16 v[60:63], a[104:107], v[140:143], v[60:63]
  buffer_load_dwordx4 v[176:179], v2, s[32:35], s24 offen offset:0 sc1
  v_mfma_f32_16x16x32_bf16 v[64:67], a[108:111], v[128:131], v[64:67]
  v_mfma_f32_16x16x32_bf16 v[68:71], a[108:111], v[132:135], v[68:71]
  v_mfma_f32_16x16x32_bf16 v[72:75], a[108:111], v[136:139], v[72:75]
  v_mfma_f32_16x16x32_bf16 v[76:79], a[108:111], v[140:143], v[76:79]
  buffer_load_dwordx4 v[180:183], v2, s[32:35], s24 offen offset:1024 sc1
  v_mfma_f32_16x16x32_bf16 v[80:83], a[112:115], v[128:131], v[80:83]
  v_mfma_f32_16x16x32_bf16 v[84:87], a[112:115], v[132:135], v[84:87]
  v_mfma_f32_16x16x32_bf16 v[88:91], a[112:115], v[136:139], v[88:91]
  v_mfma_f32_16x16x32_bf16 v[92:95], a[112:115], v[140:143], v[92:95]
  v_mfma_f32_16x16x32_bf16 v[96:99], a[116:119], v[128:131], v[96:99]
  buffer_load_dwordx4 v[128:131], v2, s[36:39], s64 offen offset:1024 sc1
  v_mfma_f32_16x16x32_bf16 v[100:103], a[116:119], v[132:135], v[100:103]
  buffer_load_dwordx4 v[132:135], v2, s[36:39], s65 offen offset:1024 sc1
  v_mfma_f32_16x16x32_bf16 v[104:107], a[116:119], v[136:139], v[104:107]
  buffer_load_dwordx4 v[136:139], v2, s[36:39], s66 offen offset:1024 sc1
  v_mfma_f32_16x16x32_bf16 v[108:111], a[116:119], v[140:143], v[108:111]
  buffer_load_dwordx4 v[140:143], v2, s[36:39], s67 offen offset:1024 sc1
  s_waitcnt vmcnt(21)
  v_mfma_f32_16x16x32_bf16 v[32:35], a[120:123], v[144:147], v[32:35]
  v_mfma_f32_16x16x32_bf16 v[36:39], a[120:123], v[148:151], v[36:39]
  v_mfma_f32_16x16x32_bf16 v[40:43], a[120:123], v[152:155], v[40:43]
  v_mfma_f32_16x16x32_bf16 v[44:47], a[120:123], v[156:159], v[44:47]
  buffer_load_dwordx4 v[184:187], v2, s[32:35], s24 offen offset:2048 sc1
  v_mfma_f32_16x16x32_bf16 v[48:51], a[124:127], v[144:147], v[48:51]
  v_mfma_f32_16x16x32_bf16 v[52:55], a[124:127], v[148:151], v[52:55]
  v_mfma_f32_16x16x32_bf16 v[56:59], a[124:127], v[152:155], v[56:59]
  v_mfma_f32_16x16x32_bf16 v[60:63], a[124:127], v[156:159], v[60:63]
  buffer_load_dwordx4 v[188:191], v2, s[32:35], s24 offen offset:3072 sc1
  v_mfma_f32_16x16x32_bf16 v[64:67], a[128:131], v[144:147], v[64:67]
  s_add_u32 s24, s24, 4096
  v_mfma_f32_16x16x32_bf16 v[68:71], a[128:131], v[148:151], v[68:71]
  v_mfma_f32_16x16x32_bf16 v[72:75], a[128:131], v[152:155], v[72:75]
  v_mfma_f32_16x16x32_bf16 v[76:79], a[128:131], v[156:159], v[76:79]
  buffer_load_dwordx4 v[192:195], v2, s[32:35], s24 offen offset:0 sc1
  v_mfma_f32_16x16x32_bf16 v[80:83], a[132:135], v[144:147], v[80:83]
  v_mfma_f32_16x16x32_bf16 v[84:87], a[132:135], v[148:151], v[84:87]
  v_mfma_f32_16x16x32_bf16 v[88:91], a[132:135], v[152:155], v[88:91]
  v_mfma_f32_16x16x32_bf16 v[92:95], a[132:135], v[156:159], v[92:95]
  v_mfma_f32_16x16x32_bf16 v[96:99], a[136:139], v[144:147], v[96:99]
  buffer_load_dwordx4 v[144:147], v2, s[36:39], s64 offen offset:2048 sc1
  v_mfma_f32_16x16x32_bf16 v[100:103], a[136:139], v[148:151], v[100:103]
  buffer_load_dwordx4 v[148:151], v2, s[36:39], s65 offen offset:2048 sc1
  v_mfma_f32_16x16x32_bf16 v[104:107], a[136:139], v[152:155], v[104:107]
  buffer_load_dwordx4 v[152:155], v2, s[36:39], s66 offen offset:2048 sc1
  v_mfma_f32_16x16x32_bf16 v[108:111], a[136:139], v[156:159], v[108:111]
  buffer_load_dwordx4 v[156:159], v2, s[36:39], s67 offen offset:2048 sc1
  s_waitcnt vmcnt(21)
  v_mfma_f32_16x16x32_bf16 v[32:35], a[140:143], v[160:163], v[32:35]
  v_mfma_f32_16x16x32_bf16 v[36:39], a[140:143], v[164:167], v[36:39]
  v_mfma_f32_16x16x32_bf16 v[40:43], a[140:143], v[168:171], v[40:43]
  v_mfma_f32_16x16x32_bf16 v[44:47], a[140:143], v[172:175], v[44:47]
  buffer_load_dwordx4 v[196:199], v2, s[32:35], s24 offen offset:1024 sc1
  v_mfma_f32_16x16x32_bf16 v[48:51], a[144:147], v[160:163], v[48:51]
  v_mfma_f32_16x16x32_bf16 v[52:55], a[144:147], v[164:167], v[52:55]
  v_mfma_f32_16x16x32_bf16 v[56:59], a[144:147], v[168:171], v[56:59]
  v_mfma_f32_16x16x32_bf16 v[60:63], a[144:147], v[172:175], v[60:63]
  buffer_load_dwordx4 v[200:203], v2, s[32:35], s24 offen offset:2048 sc1
  v_mfma_f32_16x16x32_bf16 v[64:67], a[148:151], v[160:163], v[64:67]
  v_mfma_f32_16x16x32_bf16 v[68:71], a[148:151], v[164:167], v[68:71]
  v_mfma_f32_16x16x32_bf16 v[72:75], a[148:151], v[168:171], v[72:75]
  v_mfma_f32_16x16x32_bf16 v[76:79], a[148:151], v[172:175], v[76:79]
  buffer_load_dwordx4 v[204:207], v2, s[32:35], s24 offen offset:3072 sc1
  v_mfma_f32_16x16x32_bf16 v[80:83], a[152:155], v[160:163], v[80:83]
  s_add_u32 s24, s24, 4096
  v_mfma_f32_16x16x32_bf16 v[84:87], a[152:155], v[164:167], v[84:87]
  v_mfma_f32_16x16x32_bf16 v[88:91], a[152:155], v[168:171], v[88:91]
  v_mfma_f32_16x16x32_bf16 v[92:95], a[152:155], v[172:175], v[92:95]
  v_mfma_f32_16x16x32_bf16 v[96:99], a[156:159], v[160:163], v[96:99]
  buffer_load_dwordx4 v[160:163], v2, s[36:39], s64 offen offset:3072 sc1
  v_mfma_f32_16x16x32_bf16 v[100:103], a[156:159], v[164:167], v[100:103]
  buffer_load_dwordx4 v[164:167], v2, s[36:39], s65 offen offset:3072 sc1
  v_mfma_f32_16x16x32_bf16 v[104:107], a[156:159], v[168:171], v[104:107]
  buffer_load_dwordx4 v[168:171], v2, s[36:39], s66 offen offset:3072 sc1
  v_mfma_f32_16x16x32_bf16 v[108:111], a[156:159], v[172:175], v[108:111]
  buffer_load_dwordx4 v[172:175], v2, s[36:39], s67 offen offset:3072 sc1
  s_waitcnt vmcnt(21)
  v_mfma_f32_16x16x32_bf16 v[32:35], a[160:163], v[112:115], v[32:35]
  s_add_u32 s62, s62, 4096
  v_mfma_f32_16x16x32_bf16 v[36:39], a[160:163], v[116:119], v[36:39]
  s_and_b32 s62, s62, 0x7fff
  v_mfma_f32_16x16x32_bf16 v[40:43], a[160:163], v[120:123], v[40:43]
  s_add_u32 s64, s63, s62
  v_mfma_f32_16x16x32_bf16 v[44:47], a[160:163], v[124:127], v[44:47]
  buffer_load_dwordx4 v[208:211], v2, s[32:35], s24 offen offset:0 sc1
  v_mfma_f32_16x16x32_bf16 v[48:51], a[164:167], v[112:115], v[48:51]
  v_mfma_f32_16x16x32_bf16 v[52:55], a[164:167], v[116:119], v[52:55]
  v_mfma_f32_16x16x32_bf16 v[56:59], a[164:167], v[120:123], v[56:59]
  s_add_u32 s65, s64, 131072
  v_mfma_f32_16x16x32_bf16 v[60:63], a[164:167], v[124:127], v[60:63]
  buffer_load_dwordx4 v[212:215], v2, s[32:35], s24 offen offset:1024 sc1
  v_mfma_f32_16x16x32_bf16 v[64:67], a[168:171], v[112:115], v[64:67]
  v_mfma_f32_16x16x32_bf16 v[68:71], a[168:171], v[116:119], v[68:71]
  v_mfma_f32_16x16x32_bf16 v[72:75], a[168:171], v[120:123], v[72:75]
  s_add_u32 s66, s64, 262144
  v_mfma_f32_16x16x32_bf16 v[76:79], a[168:171], v[124:127], v[76:79]
  buffer_load_dwordx4 v[216:219], v2, s[32:35], s24 offen offset:2048 sc1
  v_mfma_f32_16x16x32_bf16 v[80:83], a[172:175], v[112:115], v[80:83]
  v_mfma_f32_16x16x32_bf16 v[84:87], a[172:175], v[116:119], v[84:87]
  v_mfma_f32_16x16x32_bf16 v[88:91], a[172:175], v[120:123], v[88:91]
  s_add_u32 s67, s64, 393216
  v_mfma_f32_16x16x32_bf16 v[92:95], a[172:175], v[124:127], v[92:95]
  v_mfma_f32_16x16x32_bf16 v[96:99], a[176:179], v[112:115], v[96:99]
  buffer_load_dwordx4 v[112:115], v2, s[36:39], s64 offen offset:0 sc1
  v_mfma_f32_16x16x32_bf16 v[100:103], a[176:179], v[116:119], v[100:103]
  buffer_load_dwordx4 v[116:119], v2, s[36:39], s65 offen offset:0 sc1
  v_mfma_f32_16x16x32_bf16 v[104:107], a[176:179], v[120:123], v[104:107]
  buffer_load_dwordx4 v[120:123], v2, s[36:39], s66 offen offset:0 sc1
  v_mfma_f32_16x16x32_bf16 v[108:111], a[176:179], v[124:127], v[108:111]
  buffer_load_dwordx4 v[124:127], v2, s[36:39], s67 offen offset:0 sc1
  s_waitcnt vmcnt(21)
  v_mfma_f32_16x16x32_bf16 v[32:35], a[180:183], v[128:131], v[32:35]
  v_mfma_f32_16x16x32_bf16 v[36:39], a[180:183], v[132:135], v[36:39]
  v_mfma_f32_16x16x32_bf16 v[40:43], a[180:183], v[136:139], v[40:43]
  v_mfma_f32_16x16x32_bf16 v[44:47], a[180:183], v[140:143], v[44:47]
  buffer_load_dwordx4 v[220:223], v2, s[32:35], s24 offen offset:3072 sc1
  v_mfma_f32_16x16x32_bf16 v[48:51], a[184:187], v[128:131], v[48:51]
  s_add_u32 s24, s24, 4096
  v_mfma_f32_16x16x32_bf16 v[52:55], a[184:187], v[132:135], v[52:55]
  v_mfma_f32_16x16x32_bf16 v[56:59], a[184:187], v[136:139], v[56:59]
  v_mfma_f32_16x16x32_bf16 v[60:63], a[184:187], v[140:143], v[60:63]
  buffer_load_dwordx4 v[224:227], v2, s[32:35], s24 offen offset:0 sc1
  v_mfma_f32_16x16x32_bf16 v[64:67], a[188:191], v[128:131], v[64:67]
  v_mfma_f32_16x16x32_bf16 v[68:71], a[188:191], v[132:135], v[68:71]
  v_mfma_f32_16x16x32_bf16 v[72:75], a[188:191], v[136:139], v[72:75]
  v_mfma_f32_16x16x32_bf16 v[76:79], a[188:191], v[140:143], v[76:79]
  buffer_load_dwordx4 v[228:231], v2, s[32:35], s24 offen offset:1024 sc1
  v_mfma_f32_16x16x32_bf16 v[80:83], a[192:195], v[128:131], v[80:83]
  v_mfma_f32_16x16x32_bf16 v[84:87], a[192:195], v[132:135], v[84:87]
  v_mfma_f32_16x16x32_bf16 v[88:91], a[192:195], v[136:139], v[88:91]
  v_mfma_f32_16x16x32_bf16 v[92:95], a[192:195], v[140:143], v[92:95]
  v_mfma_f32_16x16x32_bf16 v[96:99], a[196:199], v[128:131], v[96:99]
  buffer_load_dwordx4 v[128:131], v2, s[36:39], s64 offen offset:1024 sc1
  v_mfma_f32_16x16x32_bf16 v[100:103], a[196:199], v[132:135], v[100:103]
  buffer_load_dwordx4 v[132:135], v2, s[36:39], s65 offen offset:1024 sc1
  v_mfma_f32_16x16x32_bf16 v[104:107], a[196:199], v[136:139], v[104:107]
  buffer_load_dwordx4 v[136:139], v2, s[36:39], s66 offen offset:1024 sc1
  v_mfma_f32_16x16x32_bf16 v[108:111], a[196:199], v[140:143], v[108:111]
  buffer_load_dwordx4 v[140:143], v2, s[36:39], s67 offen offset:1024 sc1
  s_waitcnt vmcnt(21)
  v_mfma_f32_16x16x32_bf16 v[32:35], a[200:203], v[144:147], v[32:35]
  v_mfma_f32_16x16x32_bf16 v[36:39], a[200:203], v[148:151], v[36:39]
  v_mfma_f32_16x16x32_bf16 v[40:43], a[200:203], v[152:155], v[40:43]
  v_mfma_f32_16x16x32_bf16 v[44:47], a[200:203], v[156:159], v[44:47]
  buffer_load_dwordx4 v[232:235], v2, s[32:35], s24 offen offset:2048 sc1
  v_mfma_f32_16x16x32_bf16 v[48:51], a[204:207], v[144:147], v[48:51]
  v_mfma_f32_16x16x32_bf16 v[52:55], a[204:207], v[148:151], v[52:55]
  v_mfma_f32_16x16x32_bf16 v[56:59], a[204:207], v[152:155], v[56:59]
  v_mfma_f32_16x16x32_bf16 v[60:63], a[204:207], v[156:159], v[60:63]
  buffer_load_dwordx4 v[236:239], v2, s[32:35], s24 offen offset:3072 sc1
  v_mfma_f32_16x16x32_bf16 v[64:67], a[208:211], v[144:147], v[64:67]
  s_add_u32 s24, s24, 4096
  v_mfma_f32_16x16x32_bf16 v[68:71], a[208:211], v[148:151], v[68:71]
  s_cmp_ge_u32 s24, s61
  s_cselect_b32 s23, 163840, 0
  s_sub_u32 s24, s24, s23
  v_mfma_f32_16x16x32_bf16 v[72:75], a[208:211], v[152:155], v[72:75]
  v_mfma_f32_16x16x32_bf16 v[76:79], a[208:211], v[156:159], v[76:79]
  v_mfma_f32_16x16x32_bf16 v[80:83], a[212:215], v[144:147], v[80:83]
  v_mfma_f32_16x16x32_bf16 v[84:87], a[212:215], v[148:151], v[84:87]
  v_mfma_f32_16x16x32_bf16 v[88:91], a[212:215], v[152:155], v[88:91]
  v_mfma_f32_16x16x32_bf16 v[92:95], a[212:215], v[156:159], v[92:95]
  v_mfma_f32_16x16x32_bf16 v[96:99], a[216:219], v[144:147], v[96:99]
  buffer_load_dwordx4 v[144:147], v2, s[36:39], s64 offen offset:2048 sc1
  v_mfma_f32_16x16x32_bf16 v[100:103], a[216:219], v[148:151], v[100:103]
  buffer_load_dwordx4 v[148:151], v2, s[36:39], s65 offen offset:2048 sc1
  v_mfma_f32_16x16x32_bf16 v[104:107], a[216:219], v[152:155], v[104:107]
  buffer_load_dwordx4 v[152:155], v2, s[36:39], s66 offen offset:2048 sc1
  v_mfma_f32_16x16x32_bf16 v[108:111], a[216:219], v[156:159], v[108:111]
  buffer_load_dwordx4 v[156:159], v2, s[36:39], s67 offen offset:2048 sc1
  s_waitcnt vmcnt(20)
  v_mfma_f32_16x16x32_bf16 v[32:35], a[220:223], v[160:163], v[32:35]
  v_mfma_f32_16x16x32_bf16 v[36:39], a[220:223], v[164:167], v[36:39]
  v_mfma_f32_16x16x32_bf16 v[40:43], a[220:223], v[168:171], v[40:43]
  v_mfma_f32_16x16x32_bf16 v[44:47], a[220:223], v[172:175], v[44:47]
  v_mfma_f32_16x16x32_bf16 v[48:51], a[224:227], v[160:163], v[48:51]
  v_mfma_f32_16x16x32_bf16 v[52:55], a[224:227], v[164:167], v[52:55]
  v_mfma_f32_16x16x32_bf16 v[56:59], a[224:227], v[168:171], v[56:59]
  v_mfma_f32_16x16x32_bf16 v[60:63], a[224:227], v[172:175], v[60:63]
  v_mfma_f32_16x16x32_bf16 v[64:67], a[228:231], v[160:163], v[64:67]
  v_mfma_f32_16x16x32_bf16 v[68:71], a[228:231], v[164:167], v[68:71]
  v_mfma_f32_16x16x32_bf16 v[72:75], a[228:231], v[168:171], v[72:75]
  v_mfma_f32_16x16x32_bf16 v[76:79], a[228:231], v[172:175], v[76:79]
  v_mfma_f32_16x16x32_bf16 v[80:83], a[232:235], v[160:163], v[80:83]
  v_mfma_f32_16x16x32_bf16 v[84:87], a[232:235], v[164:167], v[84:87]
  v_mfma_f32_16x16x32_bf16 v[88:91], a[232:235], v[168:171], v[88:91]
  v_mfma_f32_16x16x32_bf16 v[92:95], a[232:235], v[172:175], v[92:95]
  v_mfma_f32_16x16x32_bf16 v[96:99], a[236:239], v[160:163], v[96:99]
  buffer_load_dwordx4 v[160:163], v2, s[36:39], s64 offen offset:3072 sc1
  v_mfma_f32_16x16x32_bf16 v[100:103], a[236:239], v[164:167], v[100:103]
  buffer_load_dwordx4 v[164:167], v2, s[36:39], s65 offen offset:3072 sc1
  v_mfma_f32_16x16x32_bf16 v[104:107], a[236:239], v[168:171], v[104:107]
  buffer_load_dwordx4 v[168:171], v2, s[36:39], s66 offen offset:3072 sc1
  v_mfma_f32_16x16x32_bf16 v[108:111], a[236:239], v[172:175], v[108:111]
  buffer_load_dwordx4 v[172:175], v2, s[36:39], s67 offen offset:3072 sc1
  s_waitcnt vmcnt(17)
  v_mfma_f32_16x16x32_bf16 v[32:35], a[240:243], v[112:115], v[32:35]
  v_mfma_f32_16x16x32_bf16 v[36:39], a[240:243], v[116:119], v[36:39]
  v_mfma_f32_16x16x32_bf16 v[40:43], a[240:243], v[120:123], v[40:43]
  v_mfma_f32_16x16x32_bf16 v[44:47], a[240:243], v[124:127], v[44:47]
  buffer_load_dwordx4 a[0:3], v240, s[44:47], 0 offen
  v_mfma_f32_16x16x32_bf16 v[48:51], a[244:247], v[112:115], v[48:51]
  v_mfma_f32_16x16x32_bf16 v[52:55], a[244:247], v[116:119], v[52:55]
  buffer_load_dwordx4 a[12:15], v246, s[40:43], s27 offen sc1
  v_mfma_f32_16x16x32_bf16 v[56:59], a[244:247], v[120:123], v[56:59]
  v_mfma_f32_16x16x32_bf16 v[60:63], a[244:247], v[124:127], v[60:63]
  buffer_load_dwordx4 a[4:7], v241, s[44:47], 0 offen
  v_mfma_f32_16x16x32_bf16 v[64:67], a[248:251], v[112:115], v[64:67]
  v_mfma_f32_16x16x32_bf16 v[68:71], a[248:251], v[116:119], v[68:71]
  buffer_load_dwordx4 a[16:19], v247, s[40:43], s27 offen sc1
  v_mfma_f32_16x16x32_bf16 v[72:75], a[248:251], v[120:123], v[72:75]
  v_mfma_f32_16x16x32_bf16 v[76:79], a[248:251], v[124:127], v[76:79]
  buffer_load_dwordx4 a[8:11], v242, s[44:47], 0 offen
  v_mfma_f32_16x16x32_bf16 v[80:83], a[252:255], v[112:115], v[80:83]
  v_mfma_f32_16x16x32_bf16 v[84:87], a[252:255], v[116:119], v[84:87]
  buffer_load_dwordx4 a[20:23], v248, s[40:43], s27 offen sc1
  v_mfma_f32_16x16x32_bf16 v[88:91], a[252:255], v[120:123], v[88:91]
  v_mfma_f32_16x16x32_bf16 v[92:95], a[252:255], v[124:127], v[92:95]
  v_mfma_f32_16x16x32_bf16 v[96:99], v[176:179], v[112:115], v[96:99]
  v_mfma_f32_16x16x32_bf16 v[100:103], v[176:179], v[116:119], v[100:103]
  v_mfma_f32_16x16x32_bf16 v[104:107], v[176:179], v[120:123], v[104:107]
  v_mfma_f32_16x16x32_bf16 v[108:111], v[176:179], v[124:127], v[108:111]
  s_waitcnt vmcnt(16)
  v_mfma_f32_16x16x32_bf16 v[32:35], v[180:183], v[128:131], v[32:35]
  v_mfma_f32_16x16x32_bf16 v[36:39], v[180:183], v[132:135], v[36:39]
  v_mfma_f32_16x16x32_bf16 v[40:43], v[180:183], v[136:139], v[40:43]
  v_mfma_f32_16x16x32_bf16 v[44:47], v[180:183], v[140:143], v[44:47]
  v_mfma_f32_16x16x32_bf16 v[48:51], v[184:187], v[128:131], v[48:51]
  v_mfma_f32_16x16x32_bf16 v[52:55], v[184:187], v[132:135], v[52:55]
  v_mfma_f32_16x16x32_bf16 v[56:59], v[184:187], v[136:139], v[56:59]
  v_mfma_f32_16x16x32_bf16 v[60:63], v[184:187], v[140:143], v[60:63]
  v_mfma_f32_16x16x32_bf16 v[64:67], v[188:191], v[128:131], v[64:67]
  v_mfma_f32_16x16x32_bf16 v[68:71], v[188:191], v[132:135], v[68:71]
  v_mfma_f32_16x16x32_bf16 v[72:75], v[188:191], v[136:139], v[72:75]
  v_mfma_f32_16x16x32_bf16 v[76:79], v[188:191], v[140:143], v[76:79]
  v_mfma_f32_16x16x32_bf16 v[80:83], v[192:195], v[128:131], v[80:83]
  v_mfma_f32_16x16x32_bf16 v[84:87], v[192:195], v[132:135], v[84:87]
  v_mfma_f32_16x16x32_bf16 v[88:91], v[192:195], v[136:139], v[88:91]
  v_mfma_f32_16x16x32_bf16 v[92:95], v[192:195], v[140:143], v[92:95]
  v_mfma_f32_16x16x32_bf16 v[96:99], v[196:199], v[128:131], v[96:99]
  v_mfma_f32_16x16x32_bf16 v[100:103], v[196:199], v[132:135], v[100:103]
  v_mfma_f32_16x16x32_bf16 v[104:107], v[196:199], v[136:139], v[104:107]
  v_mfma_f32_16x16x32_bf16 v[108:111], v[196:199], v[140:143], v[108:111]
  s_waitcnt vmcnt(10)
  v_mfma_f32_16x16x32_bf16 v[32:35], v[200:203], v[144:147], v[32:35]
  v_mfma_f32_16x16x32_bf16 v[36:39], v[200:203], v[148:151], v[36:39]
  v_mfma_f32_16x16x32_bf16 v[40:43], v[200:203], v[152:155], v[40:43]
  v_mfma_f32_16x16x32_bf16 v[44:47], v[200:203], v[156:159], v[44:47]
  v_mfma_f32_16x16x32_bf16 v[48:51], v[204:207], v[144:147], v[48:51]
  v_mfma_f32_16x16x32_bf16 v[52:55], v[204:207], v[148:151], v[52:55]
  v_mfma_f32_16x16x32_bf16 v[56:59], v[204:207], v[152:155], v[56:59]
  v_mfma_f32_16x16x32_bf16 v[60:63], v[204:207], v[156:159], v[60:63]
  v_mfma_f32_16x16x32_bf16 v[64:67], v[208:211], v[144:147], v[64:67]
  v_mfma_f32_16x16x32_bf16 v[68:71], v[208:211], v[148:151], v[68:71]
  v_mfma_f32_16x16x32_bf16 v[72:75], v[208:211], v[152:155], v[72:75]
  v_mfma_f32_16x16x32_bf16 v[76:79], v[208:211], v[156:159], v[76:79]
  v_mfma_f32_16x16x32_bf16 v[80:83], v[212:215], v[144:147], v[80:83]
  v_mfma_f32_16x16x32_bf16 v[84:87], v[212:215], v[148:151], v[84:87]
  v_mfma_f32_16x16x32_bf16 v[88:91], v[212:215], v[152:155], v[88:91]
  v_mfma_f32_16x16x32_bf16 v[92:95], v[212:215], v[156:159], v[92:95]
  v_mfma_f32_16x16x32_bf16 v[96:99], v[216:219], v[144:147], v[96:99]
  v_mfma_f32_16x16x32_bf16 v[100:103], v[216:219], v[148:151], v[100:103]
  v_mfma_f32_16x16x32_bf16 v[104:107], v[216:219], v[152:155], v[104:107]
  v_mfma_f32_16x16x32_bf16 v[108:111], v[216:219], v[156:159], v[108:111]
  s_waitcnt vmcnt(6)
  v_mfma_f32_16x16x32_bf16 v[32:35], v[220:223], v[160:163], v[32:35]
  v_mfma_f32_16x16x32_bf16 v[36:39], v[220:223], v[164:167], v[36:39]
  v_mfma_f32_16x16x32_bf16 v[40:43], v[220:223], v[168:171], v[40:43]
  v_mfma_f32_16x16x32_bf16 v[44:47], v[220:223], v[172:175], v[44:47]
  v_mfma_f32_16x16x32_bf16 v[48:51], v[224:227], v[160:163], v[48:51]
  v_mfma_f32_16x16x32_bf16 v[52:55], v[224:227], v[164:167], v[52:55]
  v_mfma_f32_16x16x32_bf16 v[56:59], v[224:227], v[168:171], v[56:59]
  v_mfma_f32_16x16x32_bf16 v[60:63], v[224:227], v[172:175], v[60:63]
  v_mfma_f32_16x16x32_bf16 v[64:67], v[228:231], v[160:163], v[64:67]
  v_mfma_f32_16x16x32_bf16 v[68:71], v[228:231], v[164:167], v[68:71]
  v_mfma_f32_16x16x32_bf16 v[72:75], v[228:231], v[168:171], v[72:75]
  v_mfma_f32_16x16x32_bf16 v[76:79], v[228:231], v[172:175], v[76:79]
  v_mfma_f32_16x16x32_bf16 v[80:83], v[232:235], v[160:163], v[80:83]
  v_mfma_f32_16x16x32_bf16 v[84:87], v[232:235], v[164:167], v[84:87]
  v_mfma_f32_16x16x32_bf16 v[88:91], v[232:235], v[168:171], v[88:91]
  v_mfma_f32_16x16x32_bf16 v[92:95], v[232:235], v[172:175], v[92:95]
  v_mfma_f32_16x16x32_bf16 v[96:99], v[236:239], v[160:163], v[96:99]
  v_mfma_f32_16x16x32_bf16 v[100:103], v[236:239], v[164:167], v[100:103]
  v_mfma_f32_16x16x32_bf16 v[104:107], v[236:239], v[168:171], v[104:107]
  v_mfma_f32_16x16x32_bf16 v[108:111], v[236:239], v[172:175], v[108:111]
  v_and_b32 v16, 15, v1
  v_mul_u32_u24 v16, 336, v16
  v_lshrrev_b32 v17, 4, v1
  v_lshl_add_u32 v16, v17, 4, v16
  s_mul_i32 s23, s20, 21504
  v_add_u32 v16, s23, v16
  s_barrier
  ds_write_b128 v16, v[32:35] offset:0
  ds_write_b128 v16, v[36:39] offset:5376
  ds_write_b128 v16, v[40:43] offset:10752
  ds_write_b128 v16, v[44:47] offset:16128
  ds_write_b128 v16, v[48:51] offset:64
  ds_write_b128 v16, v[52:55] offset:5440
  ds_write_b128 v16, v[56:59] offset:10816
  ds_write_b128 v16, v[60:63] offset:16192
  ds_write_b128 v16, v[64:67] offset:128
  ds_write_b128 v16, v[68:71] offset:5504
  ds_write_b128 v16, v[72:75] offset:10880
  ds_write_b128 v16, v[76:79] offset:16256
  ds_write_b128 v16, v[80:83] offset:192
  ds_write_b128 v16, v[84:87] offset:5568
  ds_write_b128 v16, v[88:91] offset:10944
  ds_write_b128 v16, v[92:95] offset:16320
  ds_write_b128 v16, v[96:99] offset:256
  ds_write_b128 v16, v[100:103] offset:5632
  ds_write_b128 v16, v[104:107] offset:11008
  ds_write_b128 v16, v[108:111] offset:16384
  s_waitcnt vmcnt(0)
  v_accvgpr_read_b32 v112, a0
  v_accvgpr_read_b32 v113, a1
  v_accvgpr_read_b32 v114, a2
  v_accvgpr_read_b32 v115, a3
  v_accvgpr_read_b32 v116, a4
  v_accvgpr_read_b32 v117, a5
  v_accvgpr_read_b32 v118, a6
  v_accvgpr_read_b32 v119, a7
  v_accvgpr_read_b32 v120, a8
  v_accvgpr_read_b32 v121, a9
  v_accvgpr_read_b32 v122, a10
  v_accvgpr_read_b32 v123, a11
  v_accvgpr_read_b32 v124, a12
  v_accvgpr_read_b32 v125, a13
  v_accvgpr_read_b32 v126, a14
  v_accvgpr_read_b32 v127, a15
  v_accvgpr_read_b32 v128, a16
  v_accvgpr_read_b32 v129, a17
  v_accvgpr_read_b32 v130, a18
  v_accvgpr_read_b32 v131, a19
  v_accvgpr_read_b32 v132, a20
  v_accvgpr_read_b32 v133, a21
  v_accvgpr_read_b32 v134, a22
  v_accvgpr_read_b32 v135, a23
  s_waitcnt lgkmcnt(0)
  s_barrier
  ds_read_b128 v[32:35], v243 offset:0
  ds_read_b128 v[36:39], v243 offset:16
  ds_read_b128 v[40:43], v243 offset:21504
  ds_read_b128 v[44:47], v243 offset:21520
  ds_read_b128 v[48:51], v243 offset:43008
  ds_read_b128 v[52:55], v243 offset:43024
  ds_read_b128 v[56:59], v243 offset:64512
  ds_read_b128 v[60:63], v243 offset:64528
  ds_read_b128 v[64:67], v249 offset:0
  ds_read_b128 v[68:71], v249 offset:16
  ds_read_b128 v[72:75], v244 offset:0
  ds_read_b128 v[76:79], v244 offset:16
  ds_read_b128 v[80:83], v244 offset:21504
  ds_read_b128 v[84:87], v244 offset:21520
  ds_read_b128 v[88:91], v244 offset:43008
  ds_read_b128 v[92:95], v244 offset:43024
  ds_read_b128 v[96:99], v244 offset:64512
  ds_read_b128 v[100:103], v244 offset:64528
  ds_read_b128 v[104:107], v250 offset:0
  ds_read_b128 v[108:111], v250 offset:16
  ds_read_b128 v[136:139], v245 offset:0
  ds_read_b128 v[140:143], v245 offset:16
  ds_read_b128 v[144:147], v245 offset:21504
  ds_read_b128 v[148:151], v245 offset:21520
  ds_read_b128 v[152:155], v245 offset:43008
  ds_read_b128 v[156:159], v245 offset:43024
  ds_read_b128 v[160:163], v245 offset:64512
  ds_read_b128 v[164:167], v245 offset:64528
  ds_read_b128 v[168:171], v251 offset:0
  ds_read_b128 v[172:175], v251 offset:16
  s_waitcnt lgkmcnt(10)
  v_add_f32 v32, v32, v40
  v_add_f32 v48, v48, v56
  v_add_f32 v33, v33, v41
  v_add_f32 v49, v49, v57
  v_add_f32 v34, v34, v42
  v_add_f32 v50, v50, v58
  v_add_f32 v35, v35, v43
  v_add_f32 v51, v51, v59
  v_add_f32 v36, v36, v44
  v_add_f32 v52, v52, v60
  v_add_f32 v37, v37, v45
  v_add_f32 v53, v53, v61
  v_add_f32 v38, v38, v46
  v_add_f32 v54, v54, v62
  v_add_f32 v39, v39, v47
  v_add_f32 v55, v55, v63
  v_add_f32 v32, v32, v48
  v_add_f32 v33, v33, v49
  v_add_f32 v34, v34, v50
  v_add_f32 v35, v35, v51
  v_add_f32 v36, v36, v52
  v_add_f32 v37, v37, v53
  v_add_f32 v38, v38, v54
  v_add_f32 v39, v39, v55
  v_cvt_pk_bf16_f32 v40, v32, v33
  v_lshlrev_b32 v42, 16, v112
  v_and_b32 v43, 0xffff0000, v112
  v_and_b32 v41, 0xffff0000, v40
  v_lshlrev_b32 v40, 16, v40
  v_add_f32 v40, v40, v42
  v_add_f32 v41, v41, v43
  v_cvt_pk_bf16_f32 v40, v40, v41
  v_lshlrev_b32 v42, 16, v124
  v_and_b32 v43, 0xffff0000, v124
  v_add_f32 v42, v42, v64
  v_add_f32 v43, v43, v65
  v_cvt_pk_bf16_f32 v42, v42, v43
  v_and_b32 v41, 0xffff0000, v40
  v_lshlrev_b32 v40, 16, v40
  v_and_b32 v43, 0xffff0000, v42
  v_lshlrev_b32 v42, 16, v42
  v_add_f32 v40, v40, v42
  v_add_f32 v41, v41, v43
  v_cvt_pk_bf16_f32 v44, v40, v41
  v_cvt_pk_bf16_f32 v40, v34, v35
  v_lshlrev_b32 v42, 16, v113
  v_and_b32 v43, 0xffff0000, v113
  v_and_b32 v41, 0xffff0000, v40
  v_lshlrev_b32 v40, 16, v40
  v_add_f32 v40, v40, v42
  v_add_f32 v41, v41, v43
  v_cvt_pk_bf16_f32 v40, v40, v41
  v_lshlrev_b32 v42, 16, v125
  v_and_b32 v43, 0xffff0000, v125
  v_add_f32 v42, v42, v66
  v_add_f32 v43, v43, v67
  v_cvt_pk_bf16_f32 v42, v42, v43
  v_and_b32 v41, 0xffff0000, v40
  v_lshlrev_b32 v40, 16, v40
  v_and_b32 v43, 0xffff0000, v42
  v_lshlrev_b32 v42, 16, v42
  v_add_f32 v40, v40, v42
  v_add_f32 v41, v41, v43
  v_cvt_pk_bf16_f32 v45, v40, v41
  v_cvt_pk_bf16_f32 v40, v36, v37
  v_lshlrev_b32 v42, 16, v114
  v_and_b32 v43, 0xffff0000, v114
  v_and_b32 v41, 0xffff0000, v40
  v_lshlrev_b32 v40, 16, v40
  v_add_f32 v40, v40, v42
  v_add_f32 v41, v41, v43
  v_cvt_pk_bf16_f32 v40, v40, v41
  v_lshlrev_b32 v42, 16, v126
  v_and_b32 v43, 0xffff0000, v126
  v_add_f32 v42, v42, v68
  v_add_f32 v43, v43, v69
  v_cvt_pk_bf16_f32 v42, v42, v43
  v_and_b32 v41, 0xffff0000, v40
  v_lshlrev_b32 v40, 16, v40
  v_and_b32 v43, 0xffff0000, v42
  v_lshlrev_b32 v42, 16, v42
  v_add_f32 v40, v40, v42
  v_add_f32 v41, v41, v43
  v_cvt_pk_bf16_f32 v46, v40, v41
  v_cvt_pk_bf16_f32 v40, v38, v39
  v_lshlrev_b32 v42, 16, v115
  v_and_b32 v43, 0xffff0000, v115
  v_and_b32 v41, 0xffff0000, v40
  v_lshlrev_b32 v40, 16, v40
  v_add_f32 v40, v40, v42
  v_add_f32 v41, v41, v43
  v_cvt_pk_bf16_f32 v40, v40, v41
  v_lshlrev_b32 v42, 16, v127
  v_and_b32 v43, 0xffff0000, v127
  v_add_f32 v42, v42, v70
  v_add_f32 v43, v43, v71
  v_cvt_pk_bf16_f32 v42, v42, v43
  v_and_b32 v41, 0xffff0000, v40
  v_lshlrev_b32 v40, 16, v40
  v_and_b32 v43, 0xffff0000, v42
  v_lshlrev_b32 v42, 16, v42
  v_add_f32 v40, v40, v42
  v_add_f32 v41, v41, v43
  v_cvt_pk_bf16_f32 v47, v40, v41
  buffer_store_dwordx4 v[44:47], v240, s[48:51], 0 offen
  s_waitcnt lgkmcnt(10)
  v_add_f32 v72, v72, v80
  v_add_f32 v88, v88, v96
  v_add_f32 v73, v73, v81
  v_add_f32 v89, v89, v97
  v_add_f32 v74, v74, v82
  v_add_f32 v90, v90, v98
  v_add_f32 v75, v75, v83
  v_add_f32 v91, v91, v99
  v_add_f32 v76, v76, v84
  v_add_f32 v92, v92, v100
  v_add_f32 v77, v77, v85
  v_add_f32 v93, v93, v101
  v_add_f32 v78, v78, v86
  v_add_f32 v94, v94, v102
  v_add_f32 v79, v79, v87
  v_add_f32 v95, v95, v103
  v_add_f32 v72, v72, v88
  v_add_f32 v73, v73, v89
  v_add_f32 v74, v74, v90
  v_add_f32 v75, v75, v91
  v_add_f32 v76, v76, v92
  v_add_f32 v77, v77, v93
  v_add_f32 v78, v78, v94
  v_add_f32 v79, v79, v95
  v_cvt_pk_bf16_f32 v80, v72, v73
  v_lshlrev_b32 v82, 16, v116
  v_and_b32 v83, 0xffff0000, v116
  v_and_b32 v81, 0xffff0000, v80
  v_lshlrev_b32 v80, 16, v80
  v_add_f32 v80, v80, v82
  v_add_f32 v81, v81, v83
  v_cvt_pk_bf16_f32 v80, v80, v81
  v_lshlrev_b32 v82, 16, v128
  v_and_b32 v83, 0xffff0000, v128
  v_add_f32 v82, v82, v104
  v_add_f32 v83, v83, v105
  v_cvt_pk_bf16_f32 v82, v82, v83
  v_and_b32 v81, 0xffff0000, v80
  v_lshlrev_b32 v80, 16, v80
  v_and_b32 v83, 0xffff0000, v82
  v_lshlrev_b32 v82, 16, v82
  v_add_f32 v80, v80, v82
  v_add_f32 v81, v81, v83
  v_cvt_pk_bf16_f32 v84, v80, v81
  v_cvt_pk_bf16_f32 v80, v74, v75
  v_lshlrev_b32 v82, 16, v117
  v_and_b32 v83, 0xffff0000, v117
  v_and_b32 v81, 0xffff0000, v80
  v_lshlrev_b32 v80, 16, v80
  v_add_f32 v80, v80, v82
  v_add_f32 v81, v81, v83
  v_cvt_pk_bf16_f32 v80, v80, v81
  v_lshlrev_b32 v82, 16, v129
  v_and_b32 v83, 0xffff0000, v129
  v_add_f32 v82, v82, v106
  v_add_f32 v83, v83, v107
  v_cvt_pk_bf16_f32 v82, v82, v83
  v_and_b32 v81, 0xffff0000, v80
  v_lshlrev_b32 v80, 16, v80
  v_and_b32 v83, 0xffff0000, v82
  v_lshlrev_b32 v82, 16, v82
  v_add_f32 v80, v80, v82
  v_add_f32 v81, v81, v83
  v_cvt_pk_bf16_f32 v85, v80, v81
  v_cvt_pk_bf16_f32 v80, v76, v77
  v_lshlrev_b32 v82, 16, v118
  v_and_b32 v83, 0xffff0000, v118
  v_and_b32 v81, 0xffff0000, v80
  v_lshlrev_b32 v80, 16, v80
  v_add_f32 v80, v80, v82
  v_add_f32 v81, v81, v83
  v_cvt_pk_bf16_f32 v80, v80, v81
  v_lshlrev_b32 v82, 16, v130
  v_and_b32 v83, 0xffff0000, v130
  v_add_f32 v82, v82, v108
  v_add_f32 v83, v83, v109
  v_cvt_pk_bf16_f32 v82, v82, v83
  v_and_b32 v81, 0xffff0000, v80
  v_lshlrev_b32 v80, 16, v80
  v_and_b32 v83, 0xffff0000, v82
  v_lshlrev_b32 v82, 16, v82
  v_add_f32 v80, v80, v82
  v_add_f32 v81, v81, v83
  v_cvt_pk_bf16_f32 v86, v80, v81
  v_cvt_pk_bf16_f32 v80, v78, v79
  v_lshlrev_b32 v82, 16, v119
  v_and_b32 v83, 0xffff0000, v119
  v_and_b32 v81, 0xffff0000, v80
  v_lshlrev_b32 v80, 16, v80
  v_add_f32 v80, v80, v82
  v_add_f32 v81, v81, v83
  v_cvt_pk_bf16_f32 v80, v80, v81
  v_lshlrev_b32 v82, 16, v131
  v_and_b32 v83, 0xffff0000, v131
  v_add_f32 v82, v82, v110
  v_add_f32 v83, v83, v111
  v_cvt_pk_bf16_f32 v82, v82, v83
  v_and_b32 v81, 0xffff0000, v80
  v_lshlrev_b32 v80, 16, v80
  v_and_b32 v83, 0xffff0000, v82
  v_lshlrev_b32 v82, 16, v82
  v_add_f32 v80, v80, v82
  v_add_f32 v81, v81, v83
  v_cvt_pk_bf16_f32 v87, v80, v81
  buffer_store_dwordx4 v[84:87], v241, s[48:51], 0 offen
  s_waitcnt lgkmcnt(0)
  v_add_f32 v136, v136, v144
  v_add_f32 v152, v152, v160
  v_add_f32 v137, v137, v145
  v_add_f32 v153, v153, v161
  v_add_f32 v138, v138, v146
  v_add_f32 v154, v154, v162
  v_add_f32 v139, v139, v147
  v_add_f32 v155, v155, v163
  v_add_f32 v140, v140, v148
  v_add_f32 v156, v156, v164
  v_add_f32 v141, v141, v149
  v_add_f32 v157, v157, v165
  v_add_f32 v142, v142, v150
  v_add_f32 v158, v158, v166
  v_add_f32 v143, v143, v151
  v_add_f32 v159, v159, v167
  v_add_f32 v136, v136, v152
  v_add_f32 v137, v137, v153
  v_add_f32 v138, v138, v154
  v_add_f32 v139, v139, v155
  v_add_f32 v140, v140, v156
  v_add_f32 v141, v141, v157
  v_add_f32 v142, v142, v158
  v_add_f32 v143, v143, v159
  v_cvt_pk_bf16_f32 v144, v136, v137
  v_lshlrev_b32 v146, 16, v120
  v_and_b32 v147, 0xffff0000, v120
  v_and_b32 v145, 0xffff0000, v144
  v_lshlrev_b32 v144, 16, v144
  v_add_f32 v144, v144, v146
  v_add_f32 v145, v145, v147
  v_cvt_pk_bf16_f32 v144, v144, v145
  v_lshlrev_b32 v146, 16, v132
  v_and_b32 v147, 0xffff0000, v132
  v_add_f32 v146, v146, v168
  v_add_f32 v147, v147, v169
  v_cvt_pk_bf16_f32 v146, v146, v147
  v_and_b32 v145, 0xffff0000, v144
  v_lshlrev_b32 v144, 16, v144
  v_and_b32 v147, 0xffff0000, v146
  v_lshlrev_b32 v146, 16, v146
  v_add_f32 v144, v144, v146
  v_add_f32 v145, v145, v147
  v_cvt_pk_bf16_f32 v148, v144, v145
  v_cvt_pk_bf16_f32 v144, v138, v139
  v_lshlrev_b32 v146, 16, v121
  v_and_b32 v147, 0xffff0000, v121
  v_and_b32 v145, 0xffff0000, v144
  v_lshlrev_b32 v144, 16, v144
  v_add_f32 v144, v144, v146
  v_add_f32 v145, v145, v147
  v_cvt_pk_bf16_f32 v144, v144, v145
  v_lshlrev_b32 v146, 16, v133
  v_and_b32 v147, 0xffff0000, v133
  v_add_f32 v146, v146, v170
  v_add_f32 v147, v147, v171
  v_cvt_pk_bf16_f32 v146, v146, v147
  v_and_b32 v145, 0xffff0000, v144
  v_lshlrev_b32 v144, 16, v144
  v_and_b32 v147, 0xffff0000, v146
  v_lshlrev_b32 v146, 16, v146
  v_add_f32 v144, v144, v146
  v_add_f32 v145, v145, v147
  v_cvt_pk_bf16_f32 v149, v144, v145
  v_cvt_pk_bf16_f32 v144, v140, v141
  v_lshlrev_b32 v146, 16, v122
  v_and_b32 v147, 0xffff0000, v122
  v_and_b32 v145, 0xffff0000, v144
  v_lshlrev_b32 v144, 16, v144
  v_add_f32 v144, v144, v146
  v_add_f32 v145, v145, v147
  v_cvt_pk_bf16_f32 v144, v144, v145
  v_lshlrev_b32 v146, 16, v134
  v_and_b32 v147, 0xffff0000, v134
  v_add_f32 v146, v146, v172
  v_add_f32 v147, v147, v173
  v_cvt_pk_bf16_f32 v146, v146, v147
  v_and_b32 v145, 0xffff0000, v144
  v_lshlrev_b32 v144, 16, v144
  v_and_b32 v147, 0xffff0000, v146
  v_lshlrev_b32 v146, 16, v146
  v_add_f32 v144, v144, v146
  v_add_f32 v145, v145, v147
  v_cvt_pk_bf16_f32 v150, v144, v145
  v_cvt_pk_bf16_f32 v144, v142, v143
  v_lshlrev_b32 v146, 16, v123
  v_and_b32 v147, 0xffff0000, v123
  v_and_b32 v145, 0xffff0000, v144
  v_lshlrev_b32 v144, 16, v144
  v_add_f32 v144, v144, v146
  v_add_f32 v145, v145, v147
  v_cvt_pk_bf16_f32 v144, v144, v145
  v_lshlrev_b32 v146, 16, v135
  v_and_b32 v147, 0xffff0000, v135
  v_add_f32 v146, v146, v174
  v_add_f32 v147, v147, v175
  v_cvt_pk_bf16_f32 v146, v146, v147
  v_and_b32 v145, 0xffff0000, v144
  v_lshlrev_b32 v144, 16, v144
  v_and_b32 v147, 0xffff0000, v146
  v_lshlrev_b32 v146, 16, v146
  v_add_f32 v144, v144, v146
  v_add_f32 v145, v145, v147
  v_cvt_pk_bf16_f32 v151, v144, v145
  buffer_store_dwordx4 v[148:151], v242, s[48:51], 0 offen
fa_end:
  s_endpgm
fa_p1stubK:
  s_call_b64 s[76:77], fa_p1sub
  s_branch fa_p1backK
fa_p1stubV:
  s_call_b64 s[76:77], fa_p1sub
  s_branch fa_p1backV
fa_p1sub:
  s_cmp_eq_u32 s28, 0
  s_cbranch_scc0 fa_p1sub6
  s_cmp_eq_u32 s20, 0
  s_cselect_b32 s23, s2, 1073741824
  v_mov_b32 v16, 1073741824
  v_mov_b32 v17, 1
  v_writelane_b32 v16, s23, 0
  v_lshlrev_b32 v229, 2, v1
  buffer_store_byte v17, v16, s[56:59], 0 offen sc1
  s_setpc_b64 s[76:77]
fa_p1sub6:
  s_mov_b32 s34, 0
  s_mov_b32 s36, s60
  s_mov_b32 s37, s61
  s_mov_b32 s38, s75
  s_lshr_b32 s27, s20, 1
  s_lshl_b32 s27, s27, 18
  s_mov_b32 s25, 524288
  buffer_load_dword v228, v229, s[56:59], 0 offen sc1
  s_setpc_b64 s[76:77]
fa_ln_spin:
  s_mov_b32 s83, 200000
fa_ln_spin2:
  buffer_load_dword v228, v229, s[56:59], 0 offen sc1
  s_waitcnt vmcnt(0)
  v_cmp_ne_u32 vcc, 0x01010101, v228
  s_cbranch_vccz fa_ln_ok
  s_sleep 8
  s_sub_u32 s83, s83, 1
  s_cmp_lg_u32 s83, 0
  s_cbranch_scc1 fa_ln_spin2
  s_branch fa_ln_ok
fa_kv_spin:
  s_mov_b32 s83, 200000
fa_kv_spin2:
  buffer_load_dword v228, v230, s[40:43], 0 offen sc1
  s_waitcnt vmcnt(0)
  v_cmp_eq_u32 vcc, 0, v228
  s_cbranch_vccz fa_kv_ok
  s_sleep 8
  s_sub_u32 s83, s83, 1
  s_cmp_lg_u32 s83, 0
  s_cbranch_scc1 fa_kv_spin2
  s_branch fa_kv_ok
fa_top8:
  s_cmp_lg_u32 s20, 0
  s_cbranch_scc1 fa_notop
  s_mov_b32 s23, 2621440
  s_mov_b32 s31, 2625536
  buffer_load_dwordx4 v[32:35], v2, s[40:43], s23 offen offset:0 sc1
  buffer_load_dwordx4 v[36:39], v2, s[40:43], s23 offen offset:1024 sc1
  buffer_load_dwordx4 v[40:43], v2, s[40:43], s23 offen offset:2048 sc1
  buffer_load_dwordx4 v[44:47], v2, s[40:43], s23 offen offset:3072 sc1
  buffer_load_dwordx4 v[48:51], v2, s[40:43], s31 offen offset:0 sc1
  buffer_load_dwordx4 v[52:55], v2, s[40:43], s31 offen offset:1024 sc1
  buffer_load_dwordx4 v[56:59], v2, s[40:43], s31 offen offset:2048 sc1
  buffer_load_dwordx4 v[60:63], v2, s[40:43], s31 offen offset:3072 sc1
  v_mov_b32 v21, 0
  v_mov_b32 v22, 0
  v_and_b32 v23, 7, v1
  s_mov_b32 s23, 0
  s_waitcnt vmcnt(0)
fa_top:
  v_max3_u32 v20, v32, v33, v34
  v_max3_u32 v24, v35, v36, v37
  v_max3_u32 v20, v20, v38, v39
  v_max3_u32 v24, v24, v40, v41
  v_max3_u32 v20, v20, v42, v43
  v_max3_u32 v24, v24, v44, v45
  v_max3_u32 v20, v20, v46, v47
  v_max3_u32 v24, v24, v48, v49
  v_max3_u32 v20, v20, v50, v51
  v_max3_u32 v24, v24, v52, v53
  v_max3_u32 v20, v20, v54, v55
  v_max3_u32 v24, v24, v56, v57
  v_max3_u32 v20, v20, v58, v59
  v_max3_u32 v24, v24, v60, v61
  v_max3_u32 v20, v20, v62, v63
  v_max_u32 v20, v20, v24
  s_nop 1
  v_max_u32_dpp v20, v20, v20 quad_perm:[1,0,3,2] row_mask:0xf bank_mask:0xf
  s_nop 1
  v_max_u32_dpp v20, v20, v20 quad_perm:[2,3,0,1] row_mask:0xf bank_mask:0xf
  s_nop 1
  v_max_u32_dpp v20, v20, v20 row_half_mirror row_mask:0xf bank_mask:0xf
  s_nop 1
  v_max_u32_dpp v20, v20, v20 row_mirror row_mask:0xf bank_mask:0xf
  v_mov_b32 v24, v20
  s_nop 1
  v_permlane16_swap_b32 v20, v24
  v_max_u32 v20, v20, v24
  v_mov_b32 v24, v20
  s_nop 1
  v_permlane32_swap_b32 v20, v24
  v_max_u32 v20, v20, v24
  v_add_u32 v21, v21, v20
  v_cmp_eq_u32 vcc, s23, v23
  v_sub_u32 v32, v32, v20
  v_sub_u32 v33, v33, v20
  v_sub_u32 v34, v34, v20
  v_sub_u32 v35, v35, v20
  v_sub_u32 v36, v36, v20
  v_sub_u32 v37, v37, v20
  v_sub_u32 v38, v38, v20
  v_sub_u32 v39, v39, v20
  v_sub_u32 v40, v40, v20
  v_sub_u32 v41, v41, v20
  v_sub_u32 v42, v42, v20
  v_sub_u32 v43, v43, v20
  v_sub_u32 v44, v44, v20
  v_sub_u32 v45, v45, v20
  v_sub_u32 v46, v46, v20
  v_sub_u32 v47, v47, v20
  v_sub_u32 v48, v48, v20
  v_sub_u32 v49, v49, v20
  v_sub_u32 v50, v50, v20
  v_sub_u32 v51, v51, v20
  v_sub_u32 v52, v52, v20
  v_sub_u32 v53, v53, v20
  v_sub_u32 v54, v54, v20
  v_sub_u32 v55, v55, v20
  v_sub_u32 v56, v56, v20
  v_sub_u32 v57, v57, v20
  v_sub_u32 v58, v58, v20
  v_sub_u32 v59, v59, v20
  v_sub_u32 v60, v60, v20
  v_sub_u32 v61, v61, v20
  v_sub_u32 v62, v62, v20
  v_sub_u32 v63, v63, v20
  v_cndmask_b32 v22, v22, v21, vcc
  s_add_u32 s23, s23, 1
  s_cmp_lt_u32 s23, 8
  s_cbranch_scc1 fa_top
  v_and_b32 v25, 0xffff, v22
  v_sub_u32 v25, 0xffff, v25
  v_and_b32 v25, 2047, v25
  v_ashrrev_i32 v20, 31, v22
  v_not_b32 v20, v20
  v_or_b32 v20, 0x80000000, v20
  v_xor_b32 v26, v22, v20
  v_and_b32 v26, 0xffff0000, v26
  v_mul_f32 v26, 0xbfb8aa3b, v26
  v_exp_f32 v26, v26
  s_nop 0
  v_add_f32 v26, 1.0, v26
  v_rcp_f32 v26, v26
  s_nop 0
  v_cvt_pk_bf16_f32 v26, v26, v26
  v_and_b32 v26, 0xffff0000, v26
  v_lshlrev_b32 v20, 2, v1
  v_add_u32 v20, 2629632, v20
  v_mov_b32 v21, 1073741824
  v_cmp_gt_u32 vcc, 16, v1
  v_add_u32 v25, 1, v25
  v_or_b32 v26, 1, v26
  v_cndmask_b32 v20, v21, v20, vcc
  v_cmp_gt_u32 vcc, 8, v1
  s_nop 1
  v_cndmask_b32 v26, v26, v25, vcc
  buffer_store_dword v26, v20, s[40:43], 0 offen sc1
  s_branch fa_notop
fa_sel_spin:
  s_mov_b32 s83, 200000
fa_sel_spin2:
  buffer_load_dword v15, v10, s[40:43], 0 offen sc1
  s_waitcnt vmcnt(0)
  v_cmp_eq_u32 vcc, 0, v15
  s_cbranch_vccz fa_sel_ok
  s_sleep 8
  s_sub_u32 s83, s83, 1
  s_cmp_lg_u32 s83, 0
  s_cbranch_scc1 fa_sel_spin2
  s_branch fa_sel_ok
fa_fstub:
  s_add_u32 s38, s38, 1
  s_cmp_eq_u32 s38, 2
  s_cbranch_scc0 fa_fst2
  v_mov_b32 v16, 1073741824
  v_mov_b32 v17, 1
  v_writelane_b32 v16, s37, 0
  s_waitcnt vmcnt(8)
  buffer_store_dword v17, v16, s[40:43], 0 offen sc1
  s_mov_b32 s37, 1073741824
fa_fst2:
  s_cmp_ge_u32 s32, 8
  s_cbranch_scc1 fa_f6
  s_cmp_ge_u32 s32, 4
  s_cbranch_scc1 fa_f2
  s_cmp_eq_u32 s32, 1
  s_cbranch_scc1 fa_fret
  s_cmp_eq_u32 s32, 3
  s_cbranch_scc1 fa_f1
  buffer_load_dword v15, v10, s[40:43], 0 offen sc1
  s_branch fa_fret
fa_f1:
  s_waitcnt vmcnt(8)
  v_cmp_eq_u32 vcc, 0, v15
  s_cbranch_vccnz fa_sel_spin
fa_sel_ok:
  s_sub_u32 s23, s2, 192
  v_and_b32 v16, 7, v1
  v_lshlrev_b32 v17, 2, v16
  ds_bpermute_b32 v18, v17, v15
  s_lshl_b32 s33, s23, 6
  s_and_b32 s31, s20, 1
  s_lshl_b32 s31, s31, 5
  s_add_u32 s33, s33, s31
  s_mul_i32 s35, s23, 40960
  s_mul_i32 s31, s20, 320
  s_add_u32 s35, s35, s31
  s_mul_i32 s36, s23, 20480
  s_mul_i32 s31, s20, 640
  s_add_u32 s36, s36, s31
  s_add_u32 s36, s36, 2686976
  s_waitcnt lgkmcnt(0)
  v_add_u32 v18, -1, v18
  v_and_b32 v18, 2047, v18
  v_lshrrev_b32 v19, 4, v18
  v_mul_u32_u24 v19, 20480, v19
  v_and_b32 v18, 15, v18
  v_lshl_add_u32 v19, v18, 4, v19
  v_lshrrev_b32 v18, 3, v1
  v_lshl_add_u32 v19, v18, 8, v19
  s_lshl_b32 s23, s20, 11
  s_lshl_b32 s31, s20, 10
  s_add_u32 s31, s31, 151552
  s_mov_b32 m0, s31
  s_nop 0
  buffer_load_dwordx4 v19, s[40:43], s23 offen sc1 lds
  s_add_u32 s23, s23, 8192
  s_add_u32 s31, s31, 4096
  s_mov_b32 m0, s31
  s_nop 0
  buffer_load_dwordx4 v19, s[40:43], s23 offen sc1 lds
  s_add_u32 s23, s23, 8192
  s_add_u32 s31, s31, 4096
  s_mov_b32 m0, s31
  s_nop 0
  buffer_load_dwordx4 v19, s[40:43], s23 offen sc1 lds
  s_add_u32 s23, s23, 8192
  s_add_u32 s31, s31, 4096
  v_lshrrev_b32 v17, 1, v1
  v_mul_u32_u24 v8, 3456, v17
  v_and_b32 v17, 1, v1
  v_lshl_add_u32 v8, v17, 4, v8
  v_lshrrev_b32 v17, 4, v1
  v_lshrrev_b32 v18, 2, v1
  v_lshl_add_u32 v18, v17, 2, v18
  v_lshlrev_b32 v18, 5, v18
  v_and_b32 v19, 3, v1
  v_lshl_add_u32 v9, v19, 3, v18
  v_add_u32 v9, s34, v9
  v_lshlrev_b32 v10, 4, v16
  v_lshl_add_u32 v10, v17, 7, v10
  v_add_u32 v10, 151552, v10
  v_cmp_gt_u32 vcc, 8, v11
  v_mul_u32_u24 v11, 2560, v11
  v_lshl_add_u32 v11, v17, 4, v11
  v_mov_b32 v19, 1073741824
  v_cndmask_b32 v11, v19, v11, vcc
  v_mov_b32 v232, 0
  v_mov_b32 v233, 0
  v_mov_b32 v234, 0
  v_mov_b32 v235, 0
  s_branch fa_fissueG
fa_f2:
  s_waitcnt vmcnt(8)
  ds_read_b64_tr_b16 a[192:193], v9 offset:0
  ds_read_b64_tr_b16 a[194:195], v9 offset:128
  ds_read_b128 a[212:215], v10 offset:0
  ds_read_b64_tr_b16 a[196:197], v9 offset:1024
  ds_read_b64_tr_b16 a[198:199], v9 offset:1152
  ds_read_b128 a[216:219], v10 offset:512
  ds_read_b64_tr_b16 a[200:201], v9 offset:2048
  ds_read_b64_tr_b16 a[202:203], v9 offset:2176
  ds_read_b128 a[220:223], v10 offset:1024
  ds_read_b64_tr_b16 a[204:205], v9 offset:3072
  ds_read_b64_tr_b16 a[206:207], v9 offset:3200
  ds_read_b128 a[224:227], v10 offset:1536
  ds_read_b64_tr_b16 a[208:209], v9 offset:4096
  ds_read_b64_tr_b16 a[210:211], v9 offset:4224
  ds_read_b128 a[228:231], v10 offset:2048
  v_add_u32 v10, 2560, v10
  s_waitcnt lgkmcnt(0)
  v_mfma_f32_16x16x32_bf16 v[232:235], a[192:195], a[212:215], v[232:235]
  v_mfma_f32_16x16x32_bf16 v[232:235], a[196:199], a[216:219], v[232:235]
  v_mfma_f32_16x16x32_bf16 v[232:235], a[200:203], a[220:223], v[232:235]
  v_mfma_f32_16x16x32_bf16 v[232:235], a[204:207], a[224:227], v[232:235]
  v_mfma_f32_16x16x32_bf16 v[232:235], a[208:211], a[228:231], v[232:235]
  s_cmp_eq_u32 s32, 7
  s_cbranch_scc1 fa_f5
fa_fissueG:
  s_add_u32 m0, s34, 0
  s_nop 0
  buffer_load_dwordx4 v8, s[52:55], s33 offen lds
  s_add_u32 s33, s33, 110592
  s_add_u32 m0, s34, 1024
  s_nop 0
  buffer_load_dwordx4 v8, s[52:55], s33 offen lds
  s_add_u32 s33, s33, 110592
  s_add_u32 m0, s34, 2048
  s_nop 0
  buffer_load_dwordx4 v8, s[52:55], s33 offen lds
  s_add_u32 s33, s33, 110592
  s_add_u32 m0, s34, 3072
  s_nop 0
  buffer_load_dwordx4 v8, s[52:55], s33 offen lds
  s_add_u32 s33, s33, 110592
  s_add_u32 m0, s34, 4096
  s_nop 0
  buffer_load_dwordx4 v8, s[52:55], s33 offen lds
  s_add_u32 s33, s33, 110592
  s_branch fa_fret
fa_f5:
  s_lshl_b32 s23, s20, 9
  v_add_u32 v16, s23, v10
  s_nop 6
  ds_write_b128 v16, v[232:235]
  s_waitcnt lgkmcnt(0)
  s_branch fa_fissueD
fa_f6:
  s_cmp_ge_u32 s32, 10
  s_cbranch_scc1 fa_f8
  s_cmp_eq_u32 s32, 8
  s_cbranch_scc0 fa_f7
  ds_read_b128 v[16:19], v10 offset:0
  ds_read_b128 v[20:23], v10 offset:512
  ds_read_b128 v[24:27], v10 offset:1024
  ds_read_b128 v[28:31], v10 offset:1536
  s_waitcnt lgkmcnt(0)
  v_cvt_pk_bf16_f32 v16, v16, v16
  v_and_b32 v16, 0xffff0000, v16
  v_cvt_pk_bf16_f32 v17, v17, v17
  v_and_b32 v17, 0xffff0000, v17
  v_cvt_pk_bf16_f32 v18, v18, v18
  v_and_b32 v18, 0xffff0000, v18
  v_cvt_pk_bf16_f32 v19, v19, v19
  v_and_b32 v19, 0xffff0000, v19
  v_cvt_pk_bf16_f32 v20, v20, v20
  v_and_b32 v20, 0xffff0000, v20
  v_cvt_pk_bf16_f32 v21, v21, v21
  v_and_b32 v21, 0xffff0000, v21
  v_cvt_pk_bf16_f32 v22, v22, v22
  v_and_b32 v22, 0xffff0000, v22
  v_cvt_pk_bf16_f32 v23, v23, v23
  v_and_b32 v23, 0xffff0000, v23
  v_cvt_pk_bf16_f32 v24, v24, v24
  v_and_b32 v24, 0xffff0000, v24
  v_cvt_pk_bf16_f32 v25, v25, v25
  v_and_b32 v25, 0xffff0000, v25
  v_cvt_pk_bf16_f32 v26, v26, v26
  v_and_b32 v26, 0xffff0000, v26
  v_cvt_pk_bf16_f32 v27, v27, v27
  v_and_b32 v27, 0xffff0000, v27
  v_cvt_pk_bf16_f32 v28, v28, v28
  v_and_b32 v28, 0xffff0000, v28
  v_cvt_pk_bf16_f32 v29, v29, v29
  v_and_b32 v29, 0xffff0000, v29
  v_cvt_pk_bf16_f32 v30, v30, v30
  v_and_b32 v30, 0xffff0000, v30
  v_cvt_pk_bf16_f32 v31, v31, v31
  v_and_b32 v31, 0xffff0000, v31
  v_mul_f32 v236, 0xbfb8aa3b, v16
  v_mul_f32 v237, 0xbfb8aa3b, v17
  v_mul_f32 v238, 0xbfb8aa3b, v18
  v_mul_f32 v239, 0xbfb8aa3b, v19
  v_mul_f32 v240, 0xbfb8aa3b, v20
  v_mul_f32 v241, 0xbfb8aa3b, v21
  v_mul_f32 v242, 0xbfb8aa3b, v22
  v_mul_f32 v243, 0xbfb8aa3b, v23
  v_exp_f32 v236, v236
  v_exp_f32 v237, v237
  v_exp_f32 v238, v238
  v_exp_f32 v239, v239
  v_exp_f32 v240, v240
  v_exp_f32 v241, v241
  v_exp_f32 v242, v242
  v_exp_f32 v243, v243
  v_add_f32 v236, 1.0, v236
  v_add_f32 v237, 1.0, v237
  v_add_f32 v238, 1.0, v238
  v_add_f32 v239, 1.0, v239
  v_add_f32 v240, 1.0, v240
  v_add_f32 v241, 1.0, v241
  v_add_f32 v242, 1.0, v242
  v_add_f32 v243, 1.0, v243
  v_rcp_f32 v236, v236
  v_rcp_f32 v237, v237
  v_rcp_f32 v238, v238
  v_rcp_f32 v239, v239
  v_rcp_f32 v240, v240
  v_rcp_f32 v241, v241
  v_rcp_f32 v242, v242
  v_rcp_f32 v243, v243
  v_mul_f32 v16, v16, v236
  v_mul_f32 v17, v17, v237
  v_mul_f32 v18, v18, v238
  v_mul_f32 v19, v19, v239
  v_mul_f32 v20, v20, v240
  v_mul_f32 v21, v21, v241
  v_mul_f32 v22, v22, v242
  v_mul_f32 v23, v23, v243
  v_cvt_pk_bf16_f32 v16, v16, v16
  v_and_b32 v16, 0xffff0000, v16
  v_cvt_pk_bf16_f32 v17, v17, v17
  v_and_b32 v17, 0xffff0000, v17
  v_cvt_pk_bf16_f32 v18, v18, v18
  v_and_b32 v18, 0xffff0000, v18
  v_cvt_pk_bf16_f32 v19, v19, v19
  v_and_b32 v19, 0xffff0000, v19
  v_cvt_pk_bf16_f32 v20, v20, v20
  v_and_b32 v20, 0xffff0000, v20
  v_cvt_pk_bf16_f32 v21, v21, v21
  v_and_b32 v21, 0xffff0000, v21
  v_cvt_pk_bf16_f32 v22, v22, v22
  v_and_b32 v22, 0xffff0000, v22
  v_cvt_pk_bf16_f32 v23, v23, v23
  v_and_b32 v23, 0xffff0000, v23
  v_mul_f32 v16, v16, v24
  v_mul_f32 v17, v17, v25
  v_mul_f32 v18, v18, v26
  v_mul_f32 v19, v19, v27
  v_mul_f32 v20, v20, v28
  v_mul_f32 v21, v21, v29
  v_mul_f32 v22, v22, v30
  v_mul_f32 v23, v23, v31
  v_cvt_pk_bf16_f32 v232, v16, v17
  v_cvt_pk_bf16_f32 v233, v18, v19
  v_cvt_pk_bf16_f32 v234, v20, v21
  v_cvt_pk_bf16_f32 v235, v22, v23
fa_f7:
  s_waitcnt vmcnt(8)
  ds_read_b64_tr_b16 a[192:193], v6 offset:0
  ds_read_b64_tr_b16 a[194:195], v6 offset:2560
  ds_read_b64_tr_b16 a[196:197], v6 offset:32
  ds_read_b64_tr_b16 a[198:199], v6 offset:2592
  ds_read_b64_tr_b16 a[200:201], v6 offset:64
  ds_read_b64_tr_b16 a[202:203], v6 offset:2624
  ds_read_b64_tr_b16 a[204:205], v6 offset:96
  ds_read_b64_tr_b16 a[206:207], v6 offset:2656
  ds_read_b64_tr_b16 a[208:209], v6 offset:128
  ds_read_b64_tr_b16 a[210:211], v6 offset:2688
  s_waitcnt lgkmcnt(0)
  v_mfma_f32_16x16x32_bf16 v[236:239], a[192:195], v[232:235], 0
  v_mfma_f32_16x16x32_bf16 v[240:243], a[196:199], v[232:235], 0
  v_mfma_f32_16x16x32_bf16 v[244:247], a[200:203], v[232:235], 0
  v_mfma_f32_16x16x32_bf16 v[248:251], a[204:207], v[232:235], 0
  v_mfma_f32_16x16x32_bf16 v[252:255], a[208:211], v[232:235], 0
  s_nop 7
  buffer_store_dwordx4 v[236:239], v11, s[40:43], s36 offen offset:0 sc1
  buffer_store_dwordx4 v[240:243], v11, s[40:43], s36 offen offset:64 sc1
  buffer_store_dwordx4 v[244:247], v11, s[40:43], s36 offen offset:128 sc1
  buffer_store_dwordx4 v[248:251], v11, s[40:43], s36 offen offset:192 sc1
  buffer_store_dwordx4 v[252:255], v11, s[40:43], s36 offen offset:256 sc1
  s_add_u32 s36, s36, 320
  s_cmp_eq_u32 s32, 9
  s_cbranch_scc1 fa_fret
fa_fissueD:
  v_add_u32 v20, 0, v1
  v_mul_u32_u24 v19, 6554, v20
  s_add_u32 m0, s34, 0
  v_lshrrev_b32 v19, 16, v19
  v_mul_u32_u24 v19, 1120, v19
  v_lshl_add_u32 v19, v20, 4, v19
  buffer_load_dwordx4 v19, s[60:63], s35 offen lds
  v_add_u32 v20, 64, v1
  v_mul_u32_u24 v19, 6554, v20
  s_add_u32 m0, s34, 1024
  v_lshrrev_b32 v19, 16, v19
  v_mul_u32_u24 v19, 1120, v19
  v_lshl_add_u32 v19, v20, 4, v19
  buffer_load_dwordx4 v19, s[60:63], s35 offen lds
  v_add_u32 v20, 128, v1
  v_mul_u32_u24 v19, 6554, v20
  s_add_u32 m0, s34, 2048
  v_lshrrev_b32 v19, 16, v19
  v_mul_u32_u24 v19, 1120, v19
  v_lshl_add_u32 v19, v20, 4, v19
  buffer_load_dwordx4 v19, s[60:63], s35 offen lds
  v_add_u32 v20, 192, v1
  v_mul_u32_u24 v19, 6554, v20
  s_add_u32 m0, s34, 3072
  v_lshrrev_b32 v19, 16, v19
  v_mul_u32_u24 v19, 1120, v19
  v_lshl_add_u32 v19, v20, 4, v19
  buffer_load_dwordx4 v19, s[60:63], s35 offen lds
  v_add_u32 v20, 256, v1
  v_mul_u32_u24 v19, 6554, v20
  s_add_u32 m0, s34, 4096
  v_lshrrev_b32 v19, 16, v19
  v_mul_u32_u24 v19, 1120, v19
  v_lshl_add_u32 v19, v20, 4, v19
  buffer_load_dwordx4 v19, s[60:63], s35 offen lds
  s_add_u32 s35, s35, 160
  s_branch fa_fret
fa_f8:
  s_cmp_eq_u32 s32, 10
  s_cbranch_scc1 fa_fret
  s_cmp_ge_u32 s32, 41
  s_cbranch_scc1 fa_fdef
  s_cmp_ge_u32 s32, 21
  s_cbranch_scc1 fa_ftouch
  s_and_b32 s23, s2, 63
  s_lshl_b32 s23, s23, 2
  s_add_u32 s23, s23, 2650112
  s_cmp_eq_u32 s20, 0
  s_cselect_b32 s23, s23, 1073741824
  v_mov_b32 v16, 1073741824
  v_mov_b32 v17, 1
  v_writelane_b32 v16, s23, 0
  buffer_store_dword v17, v16, s[40:43], 0 offen sc1
  s_mov_b32 s32, -1
fa_fret:
  s_add_u32 s32, s32, 1
  s_branch fa_fback
fa_fdef:
  s_cmp_eq_u32 s32, 42
  s_cselect_b32 s32, -1, s32
  s_branch fa_fret
fa_ftouch:
  v_lshlrev_b32 v16, 7, v1
  v_cmp_gt_u32 vcc, 34, v1
  v_mov_b32 v17, 1073741824
  s_sub_u32 s23, s2, 64
  v_cndmask_b32 v16, v17, v16, vcc
  s_cmp_eq_u32 s32, 21
  s_cbranch_scc0 fa_ftouch2
  s_lshl_b32 s23, s23, 1
  s_and_b32 s31, s20, 1
  s_add_u32 s23, s23, s31
  s_mul_i32 s23, s23, 8704
  s_add_u32 s31, s23, 4352
  buffer_load_dword v8, v16, s[52:55], s23 offen
  buffer_load_dword v9, v16, s[52:55], s31 offen
  s_branch fa_fret
fa_ftouch2:
  s_lshl_b32 s23, s23, 2
  s_add_u32 s23, s23, s20
  s_mul_i32 s23, s23, 4352
  buffer_load_dword v8, v16, s[60:63], s23 offen
  s_mov_b32 s32, -1
  s_branch fa_fret
fa_wof_spin:
  s_mov_b32 s83, 200000
fa_wof_spin2:
  buffer_load_dword v8, v9, s[40:43], 0 offen sc1
  s_waitcnt vmcnt(0)
  v_cmp_eq_u32 vcc, 0, v8
  s_cbranch_vccz fa_wof_ok
  s_sleep 8
  s_sub_u32 s83, s83, 1
  s_cmp_lg_u32 s83, 0
  s_cbranch_scc1 fa_wof_spin2
  s_branch fa_wof_ok
fa_sel4_spin:
  s_mov_b32 s83, 200000
fa_sel4_spin2:
  buffer_load_dword v15, v10, s[40:43], 0 offen sc1
  s_waitcnt vmcnt(0)
  v_cmp_eq_u32 vcc, 0, v15
  s_cbranch_vccz fa_sel4_ok
  s_sleep 8
  s_sub_u32 s83, s83, 1
  s_cmp_lg_u32 s83, 0
  s_cbranch_scc1 fa_sel4_spin2
  s_branch fa_sel4_ok
fa_yf_spin:
  s_mov_b32 s83, 200000
fa_yf_spin2:
  buffer_load_dword v14, v11, s[40:43], 0 offen sc1
  s_waitcnt vmcnt(0)
  v_cmp_eq_u32 vcc, 0, v14
  s_cbranch_vccz fa_yf_ok
  s_sleep 8
  s_sub_u32 s83, s83, 1
  s_cmp_lg_u32 s83, 0
  s_cbranch_scc1 fa_yf_spin2
  s_branch fa_yf_ok
fa_ystub0:
  s_call_b64 s[76:77], fa_ysub
  s_branch fa_yback0
fa_ystub1:
  s_call_b64 s[76:77], fa_ysub
  s_branch fa_yback1
fa_ysub:
  v_cmp_eq_u32 vcc, 0, v14
  s_cbranch_vccnz fa_yf_spin
fa_yf_ok:
  v_mul_u32_u24 v16, 3277, v1
  v_lshrrev_b32 v16, 16, v16
  v_mul_u32_u24 v17, 20, v16
  v_sub_u32 v17, v1, v17
  v_lshlrev_b32 v17, 4, v17
  v_mul_u32_u24 v18, 368640, v16
  v_add_u32 v18, v18, v17
  v_cmp_gt_u32 vcc, 3, v16
  v_mov_b32 v19, 1073741824
  s_mul_i32 s14, s23, 2560
  v_cndmask_b32 v18, v19, v18, vcc
  s_mul_i32 s15, s60, 320
  s_add_u32 s14, s14, s15
  s_add_u32 s14, s14, 2686976
  buffer_load_dwordx4 v[32:35], v18, s[40:43], s14 offen sc1
  s_add_u32 s14, s14, 20480
  buffer_load_dwordx4 v[36:39], v18, s[40:43], s14 offen sc1
  s_add_u32 s14, s14, 20480
  buffer_load_dwordx4 v[40:43], v18, s[40:43], s14 offen sc1
  s_add_u32 s14, s14, 20480
  buffer_load_dwordx4 v[44:47], v18, s[40:43], s14 offen sc1
  s_add_u32 s14, s14, 20480
  buffer_load_dwordx4 v[48:51], v18, s[40:43], s14 offen sc1
  s_add_u32 s14, s14, 20480
  buffer_load_dwordx4 v[52:55], v18, s[40:43], s14 offen sc1
  s_add_u32 s14, s14, 20480
  buffer_load_dwordx4 v[56:59], v18, s[40:43], s14 offen sc1
  s_add_u32 s14, s14, 20480
  buffer_load_dwordx4 v[60:63], v18, s[40:43], s14 offen sc1
  s_add_u32 s14, s14, 20480
  buffer_load_dwordx4 v[64:67], v18, s[40:43], s14 offen sc1
  s_add_u32 s14, s14, 20480
  buffer_load_dwordx4 v[68:71], v18, s[40:43], s14 offen sc1
  s_add_u32 s14, s14, 20480
  buffer_load_dwordx4 v[72:75], v18, s[40:43], s14 offen sc1
  s_add_u32 s14, s14, 20480
  buffer_load_dwordx4 v[76:79], v18, s[40:43], s14 offen sc1
  s_add_u32 s14, s14, 20480
  buffer_load_dwordx4 v[80:83], v18, s[40:43], s14 offen sc1
  s_add_u32 s14, s14, 20480
  buffer_load_dwordx4 v[84:87], v18, s[40:43], s14 offen sc1
  s_add_u32 s14, s14, 20480
  buffer_load_dwordx4 v[88:91], v18, s[40:43], s14 offen sc1
  s_add_u32 s14, s14, 20480
  buffer_load_dwordx4 v[92:95], v18, s[40:43], s14 offen sc1
  s_add_u32 s14, s14, 20480
  buffer_load_dwordx4 v[96:99], v18, s[40:43], s14 offen sc1
  s_add_u32 s14, s14, 20480
  buffer_load_dwordx4 v[100:103], v18, s[40:43], s14 offen sc1
  s_add_u32 s14, s14, 20480
  s_lshl_b32 s14, s20, 10
  s_add_u32 s14, s14, 135168
  v_add_u32 v19, s14, v2
  s_and_b32 s30, s30, 0xffff0000
  s_waitcnt vmcnt(0)
  v_add_f32 v32, v32, v36
  v_add_f32 v33, v33, v37
  v_add_f32 v34, v34, v38
  v_add_f32 v35, v35, v39
  v_add_f32 v32, v32, v40
  v_add_f32 v33, v33, v41
  v_add_f32 v34, v34, v42
  v_add_f32 v35, v35, v43
  v_add_f32 v32, v32, v44
  v_add_f32 v33, v33, v45
  v_add_f32 v34, v34, v46
  v_add_f32 v35, v35, v47
  v_add_f32 v32, v32, v48
  v_add_f32 v33, v33, v49
  v_add_f32 v34, v34, v50
  v_add_f32 v35, v35, v51
  v_add_f32 v32, v32, v52
  v_add_f32 v33, v33, v53
  v_add_f32 v34, v34, v54
  v_add_f32 v35, v35, v55
  v_add_f32 v32, v32, v56
  v_add_f32 v33, v33, v57
  v_add_f32 v34, v34, v58
  v_add_f32 v35, v35, v59
  v_add_f32 v32, v32, v60
  v_add_f32 v33, v33, v61
  v_add_f32 v34, v34, v62
  v_add_f32 v35, v35, v63
  v_add_f32 v32, v32, v64
  v_add_f32 v33, v33, v65
  v_add_f32 v34, v34, v66
  v_add_f32 v35, v35, v67
  v_add_f32 v32, v32, v68
  v_add_f32 v33, v33, v69
  v_add_f32 v34, v34, v70
  v_add_f32 v35, v35, v71
  v_add_f32 v32, v32, v72
  v_add_f32 v33, v33, v73
  v_add_f32 v34, v34, v74
  v_add_f32 v35, v35, v75
  v_add_f32 v32, v32, v76
  v_add_f32 v33, v33, v77
  v_add_f32 v34, v34, v78
  v_add_f32 v35, v35, v79
  v_add_f32 v32, v32, v80
  v_add_f32 v33, v33, v81
  v_add_f32 v34, v34, v82
  v_add_f32 v35, v35, v83
  v_add_f32 v32, v32, v84
  v_add_f32 v33, v33, v85
  v_add_f32 v34, v34, v86
  v_add_f32 v35, v35, v87
  v_add_f32 v32, v32, v88
  v_add_f32 v33, v33, v89
  v_add_f32 v34, v34, v90
  v_add_f32 v35, v35, v91
  v_add_f32 v32, v32, v92
  v_add_f32 v33, v33, v93
  v_add_f32 v34, v34, v94
  v_add_f32 v35, v35, v95
  v_add_f32 v32, v32, v96
  v_add_f32 v33, v33, v97
  v_add_f32 v34, v34, v98
  v_add_f32 v35, v35, v99
  v_add_f32 v32, v32, v100
  v_add_f32 v33, v33, v101
  v_add_f32 v34, v34, v102
  v_add_f32 v35, v35, v103
  ds_write_b128 v19, v[32:35]
  v_add_u32 v19, s14, v17
  s_waitcnt lgkmcnt(0)
  ds_read_b128 v[32:35], v19
  ds_read_b128 v[36:39], v19 offset:320
  ds_read_b128 v[40:43], v19 offset:640
  s_mul_i32 s14, s23, 320
  s_add_u32 s14, s14, 131072
  v_add_u32 v19, s14, v17
  s_waitcnt lgkmcnt(0)
  v_add_f32 v32, v32, v36
  v_add_f32 v32, v32, v40
  v_cvt_pk_bf16_f32 v32, v32, v32
  v_and_b32 v32, 0xffff0000, v32
  v_mul_f32 v32, s30, v32
  v_cvt_pk_bf16_f32 v32, v32, v32
  v_and_b32 v32, 0xffff0000, v32
  v_add_f32 v33, v33, v37
  v_add_f32 v33, v33, v41
  v_cvt_pk_bf16_f32 v33, v33, v33
  v_and_b32 v33, 0xffff0000, v33
  v_mul_f32 v33, s30, v33
  v_cvt_pk_bf16_f32 v33, v33, v33
  v_and_b32 v33, 0xffff0000, v33
  v_add_f32 v34, v34, v38
  v_add_f32 v34, v34, v42
  v_cvt_pk_bf16_f32 v34, v34, v34
  v_and_b32 v34, 0xffff0000, v34
  v_mul_f32 v34, s30, v34
  v_cvt_pk_bf16_f32 v34, v34, v34
  v_and_b32 v34, 0xffff0000, v34
  v_add_f32 v35, v35, v39
  v_add_f32 v35, v35, v43
  v_cvt_pk_bf16_f32 v35, v35, v35
  v_and_b32 v35, 0xffff0000, v35
  v_mul_f32 v35, s30, v35
  v_cvt_pk_bf16_f32 v35, v35, v35
  v_and_b32 v35, 0xffff0000, v35
  ds_write_b128 v19, v[32:35]
  s_waitcnt lgkmcnt(0)
  s_setpc_b64 s[76:77]
fa_ctx_spin:
  s_mov_b32 s83, 200000
fa_ctx_spin2:
  buffer_load_dword v13, v12, s[40:43], 0 offen sc1
  s_waitcnt vmcnt(0)
  v_cmp_eq_u32 vcc, 0, v13
  s_cbranch_vccz fa_ctx_ok
  s_sleep 8
  s_sub_u32 s83, s83, 1
  s_cmp_lg_u32 s83, 0
  s_cbranch_scc1 fa_ctx_spin2
  s_branch fa_ctx_ok
fa_stub0:
  s_call_b64 s[76:77], fa_rare00
  s_call_b64 s[76:77], fa_rare10
  s_branch fa_back0
fa_stub1:
  s_call_b64 s[76:77], fa_rare01
  s_call_b64 s[76:77], fa_rare11
  s_branch fa_back1
fa_stub2:
  s_call_b64 s[76:77], fa_rare00
  s_call_b64 s[76:77], fa_rare10
  s_branch fa_back2
fa_stub3:
  s_call_b64 s[76:77], fa_rare01
  s_call_b64 s[76:77], fa_rare11
  s_branch fa_back3
fa_stub4:
  s_call_b64 s[76:77], fa_rare00
  s_call_b64 s[76:77], fa_rare10
  s_branch fa_back4
fa_stub5:
  s_call_b64 s[76:77], fa_rare11
  s_branch fa_back5
fa_stub6:
  s_call_b64 s[76:77], fa_rare10
  s_branch fa_back6
fa_stub7:
  s_call_b64 s[76:77], fa_rare01
  s_call_b64 s[76:77], fa_rare11
  s_branch fa_back7
fa_stub8:
  s_call_b64 s[76:77], fa_rare10
  s_branch fa_back8
fa_stub9:
  s_call_b64 s[76:77], fa_rare11
  s_branch fa_back9
fa_stub10:
  s_call_b64 s[76:77], fa_rare10
  s_branch fa_back10
fa_stub11:
  s_call_b64 s[76:77], fa_rare11
  s_branch fa_back11
fa_stub12:
  s_call_b64 s[76:77], fa_rare10
  s_branch fa_back12
fa_stub13:
  s_call_b64 s[76:77], fa_rare11
  s_branch fa_back13
fa_codeend:
fa_rare00:
  s_nop 7
  v_max3_f32 v16, v96, v97, v98
  v_max3_f32 v16, v16, v99, v100
  v_max3_f32 v16, v16, v101, v102
  v_max3_f32 v16, v16, v103, 0
  v_mov_b32 v18, v16
  s_nop 1
  v_permlane16_swap_b32 v16, v18
  v_max_f32 v16, v16, v18
  v_mov_b32 v18, v16
  s_nop 1
  v_permlane32_swap_b32 v16, v18
  v_max_f32 v16, v16, v18
  v_sub_f32 v96, v96, v16
  v_sub_f32 v112, v112, v16
  v_sub_f32 v97, v97, v16
  v_sub_f32 v113, v113, v16
  v_sub_f32 v98, v98, v16
  v_sub_f32 v114, v114, v16
  v_sub_f32 v99, v99, v16
  v_sub_f32 v115, v115, v16
  v_sub_f32 v100, v100, v16
  v_sub_f32 v116, v116, v16
  v_sub_f32 v101, v101, v16
  v_sub_f32 v117, v117, v16
  v_sub_f32 v102, v102, v16
  v_sub_f32 v118, v118, v16
  v_sub_f32 v103, v103, v16
  v_sub_f32 v119, v119, v16
  v_max3_f32 v17, v104, v105, v106
  v_max3_f32 v17, v17, v107, v108
  v_max3_f32 v17, v17, v109, v110
  v_max3_f32 v17, v17, v111, 0
  v_mov_b32 v18, v17
  s_nop 1
  v_permlane16_swap_b32 v17, v18
  v_max_f32 v17, v17, v18
  v_mov_b32 v18, v17
  s_nop 1
  v_permlane32_swap_b32 v17, v18
  v_max_f32 v17, v17, v18
  v_sub_f32 v104, v104, v17
  v_sub_f32 v120, v120, v17
  v_sub_f32 v105, v105, v17
  v_sub_f32 v121, v121, v17
  v_sub_f32 v106, v106, v17
  v_sub_f32 v122, v122, v17
  v_sub_f32 v107, v107, v17
  v_sub_f32 v123, v123, v17
  v_sub_f32 v108, v108, v17
  v_sub_f32 v124, v124, v17
  v_sub_f32 v109, v109, v17
  v_sub_f32 v125, v125, v17
  v_sub_f32 v110, v110, v17
  v_sub_f32 v126, v126, v17
  v_sub_f32 v111, v111, v17
  v_sub_f32 v127, v127, v17
  s_call_b64 s[78:79], fa_resc0
  v_exp_f32 v208, v96
  v_exp_f32 v209, v97
  v_exp_f32 v210, v98
  v_add_f32 v224, v208, v209
  v_cvt_pk_bf16_f32 v160, v208, v209
  v_exp_f32 v211, v99
  v_add_f32 v224, v224, v210
  v_exp_f32 v212, v100
  v_add_f32 v224, v224, v211
  v_cvt_pk_bf16_f32 v161, v210, v211
  v_exp_f32 v213, v101
  v_add_f32 v224, v224, v212
  v_exp_f32 v214, v102
  v_add_f32 v224, v224, v213
  v_cvt_pk_bf16_f32 v162, v212, v213
  v_exp_f32 v215, v103
  v_add_f32 v224, v224, v214
  v_exp_f32 v208, v104
  v_add_f32 v224, v224, v215
  v_cvt_pk_bf16_f32 v163, v214, v215
  v_exp_f32 v209, v105
  v_exp_f32 v210, v106
  v_add_f32 v225, v208, v209
  v_cvt_pk_bf16_f32 v164, v208, v209
  v_exp_f32 v211, v107
  v_add_f32 v225, v225, v210
  v_exp_f32 v212, v108
  v_add_f32 v225, v225, v211
  v_cvt_pk_bf16_f32 v165, v210, v211
  v_exp_f32 v213, v109
  v_add_f32 v225, v225, v212
  v_exp_f32 v214, v110
  v_add_f32 v225, v225, v213
  v_cvt_pk_bf16_f32 v166, v212, v213
  v_exp_f32 v215, v111
  v_add_f32 v225, v225, v214
  s_nop 0
  v_add_f32 v225, v225, v215
  v_cvt_pk_bf16_f32 v167, v214, v215
  s_nop 1
  s_setpc_b64 s[76:77]
fa_rare01:
  s_nop 7
  v_max3_f32 v16, v112, v113, v114
  v_max3_f32 v16, v16, v115, v116
  v_max3_f32 v16, v16, v117, v118
  v_max3_f32 v16, v16, v119, 0
  v_mov_b32 v18, v16
  s_nop 1
  v_permlane16_swap_b32 v16, v18
  v_max_f32 v16, v16, v18
  v_mov_b32 v18, v16
  s_nop 1
  v_permlane32_swap_b32 v16, v18
  v_max_f32 v16, v16, v18
  v_sub_f32 v112, v112, v16
  v_sub_f32 v96, v96, v16
  v_sub_f32 v113, v113, v16
  v_sub_f32 v97, v97, v16
  v_sub_f32 v114, v114, v16
  v_sub_f32 v98, v98, v16
  v_sub_f32 v115, v115, v16
  v_sub_f32 v99, v99, v16
  v_sub_f32 v116, v116, v16
  v_sub_f32 v100, v100, v16
  v_sub_f32 v117, v117, v16
  v_sub_f32 v101, v101, v16
  v_sub_f32 v118, v118, v16
  v_sub_f32 v102, v102, v16
  v_sub_f32 v119, v119, v16
  v_sub_f32 v103, v103, v16
  v_max3_f32 v17, v120, v121, v122
  v_max3_f32 v17, v17, v123, v124
  v_max3_f32 v17, v17, v125, v126
  v_max3_f32 v17, v17, v127, 0
  v_mov_b32 v18, v17
  s_nop 1
  v_permlane16_swap_b32 v17, v18
  v_max_f32 v17, v17, v18
  v_mov_b32 v18, v17
  s_nop 1
  v_permlane32_swap_b32 v17, v18
  v_max_f32 v17, v17, v18
  v_sub_f32 v120, v120, v17
  v_sub_f32 v104, v104, v17
  v_sub_f32 v121, v121, v17
  v_sub_f32 v105, v105, v17
  v_sub_f32 v122, v122, v17
  v_sub_f32 v106, v106, v17
  v_sub_f32 v123, v123, v17
  v_sub_f32 v107, v107, v17
  v_sub_f32 v124, v124, v17
  v_sub_f32 v108, v108, v17
  v_sub_f32 v125, v125, v17
  v_sub_f32 v109, v109, v17
  v_sub_f32 v126, v126, v17
  v_sub_f32 v110, v110, v17
  v_sub_f32 v127, v127, v17
  v_sub_f32 v111, v111, v17
  s_call_b64 s[78:79], fa_resc0
  v_exp_f32 v208, v112
  v_exp_f32 v209, v113
  v_exp_f32 v210, v114
  v_add_f32 v224, v208, v209
  v_cvt_pk_bf16_f32 v168, v208, v209
  v_exp_f32 v211, v115
  v_add_f32 v224, v224, v210
  v_exp_f32 v212, v116
  v_add_f32 v224, v224, v211
  v_cvt_pk_bf16_f32 v169, v210, v211
  v_exp_f32 v213, v117
  v_add_f32 v224, v224, v212
  v_exp_f32 v214, v118
  v_add_f32 v224, v224, v213
  v_cvt_pk_bf16_f32 v170, v212, v213
  v_exp_f32 v215, v119
  v_add_f32 v224, v224, v214
  v_exp_f32 v208, v120
  v_add_f32 v224, v224, v215
  v_cvt_pk_bf16_f32 v171, v214, v215
  v_exp_f32 v209, v121
  v_exp_f32 v210, v122
  v_add_f32 v225, v208, v209
  v_cvt_pk_bf16_f32 v172, v208, v209
  v_exp_f32 v211, v123
  v_add_f32 v225, v225, v210
  v_exp_f32 v212, v124
  v_add_f32 v225, v225, v211
  v_cvt_pk_bf16_f32 v173, v210, v211
  v_exp_f32 v213, v125
  v_add_f32 v225, v225, v212
  v_exp_f32 v214, v126
  v_add_f32 v225, v225, v213
  v_cvt_pk_bf16_f32 v174, v212, v213
  v_exp_f32 v215, v127
  v_add_f32 v225, v225, v214
  s_nop 0
  v_add_f32 v225, v225, v215
  v_cvt_pk_bf16_f32 v175, v214, v215
  s_nop 1
  s_setpc_b64 s[76:77]
fa_resc0:
  v_sub_f32 v192, v192, v16
  v_sub_f32 v193, v193, v16
  v_sub_f32 v194, v194, v16
  v_sub_f32 v195, v195, v16
  v_exp_f32 v18, -v16
  v_sub_f32 v196, v196, v17
  v_sub_f32 v197, v197, v17
  v_sub_f32 v198, v198, v17
  v_sub_f32 v199, v199, v17
  v_exp_f32 v19, -v17
  s_nop 0
  v_mul_f32 v228, v228, v18
  v_mul_f32 v229, v229, v19
  v_accvgpr_read_b32 v20, a0
  v_accvgpr_read_b32 v21, a1
  v_accvgpr_read_b32 v22, a2
  v_accvgpr_read_b32 v23, a3
  v_mul_f32 v20, v20, v18
  v_mul_f32 v21, v21, v18
  v_mul_f32 v22, v22, v18
  v_mul_f32 v23, v23, v18
  v_accvgpr_write_b32 a0, v20
  v_accvgpr_write_b32 a1, v21
  v_accvgpr_write_b32 a2, v22
  v_accvgpr_write_b32 a3, v23
  v_accvgpr_read_b32 v20, a4
  v_accvgpr_read_b32 v21, a5
  v_accvgpr_read_b32 v22, a6
  v_accvgpr_read_b32 v23, a7
  v_mul_f32 v20, v20, v19
  v_mul_f32 v21, v21, v19
  v_mul_f32 v22, v22, v19
  v_mul_f32 v23, v23, v19
  v_accvgpr_write_b32 a4, v20
  v_accvgpr_write_b32 a5, v21
  v_accvgpr_write_b32 a6, v22
  v_accvgpr_write_b32 a7, v23
  v_accvgpr_read_b32 v20, a8
  v_accvgpr_read_b32 v21, a9
  v_accvgpr_read_b32 v22, a10
  v_accvgpr_read_b32 v23, a11
  v_mul_f32 v20, v20, v18
  v_mul_f32 v21, v21, v18
  v_mul_f32 v22, v22, v18
  v_mul_f32 v23, v23, v18
  v_accvgpr_write_b32 a8, v20
  v_accvgpr_write_b32 a9, v21
  v_accvgpr_write_b32 a10, v22
  v_accvgpr_write_b32 a11, v23
  v_accvgpr_read_b32 v20, a12
  v_accvgpr_read_b32 v21, a13
  v_accvgpr_read_b32 v22, a14
  v_accvgpr_read_b32 v23, a15
  v_mul_f32 v20, v20, v19
  v_mul_f32 v21, v21, v19
  v_mul_f32 v22, v22, v19
  v_mul_f32 v23, v23, v19
  v_accvgpr_write_b32 a12, v20
  v_accvgpr_write_b32 a13, v21
  v_accvgpr_write_b32 a14, v22
  v_accvgpr_write_b32 a15, v23
  v_accvgpr_read_b32 v20, a16
  v_accvgpr_read_b32 v21, a17
  v_accvgpr_read_b32 v22, a18
  v_accvgpr_read_b32 v23, a19
  v_mul_f32 v20, v20, v18
  v_mul_f32 v21, v21, v18
  v_mul_f32 v22, v22, v18
  v_mul_f32 v23, v23, v18
  v_accvgpr_write_b32 a16, v20
  v_accvgpr_write_b32 a17, v21
  v_accvgpr_write_b32 a18, v22
  v_accvgpr_write_b32 a19, v23
  v_accvgpr_read_b32 v20, a20
  v_accvgpr_read_b32 v21, a21
  v_accvgpr_read_b32 v22, a22
  v_accvgpr_read_b32 v23, a23
  v_mul_f32 v20, v20, v19
  v_mul_f32 v21, v21, v19
  v_mul_f32 v22, v22, v19
  v_mul_f32 v23, v23, v19
  v_accvgpr_write_b32 a20, v20
  v_accvgpr_write_b32 a21, v21
  v_accvgpr_write_b32 a22, v22
  v_accvgpr_write_b32 a23, v23
  v_accvgpr_read_b32 v20, a24
  v_accvgpr_read_b32 v21, a25
  v_accvgpr_read_b32 v22, a26
  v_accvgpr_read_b32 v23, a27
  v_mul_f32 v20, v20, v18
  v_mul_f32 v21, v21, v18
  v_mul_f32 v22, v22, v18
  v_mul_f32 v23, v23, v18
  v_accvgpr_write_b32 a24, v20
  v_accvgpr_write_b32 a25, v21
  v_accvgpr_write_b32 a26, v22
  v_accvgpr_write_b32 a27, v23
  v_accvgpr_read_b32 v20, a28
  v_accvgpr_read_b32 v21, a29
  v_accvgpr_read_b32 v22, a30
  v_accvgpr_read_b32 v23, a31
  v_mul_f32 v20, v20, v19
  v_mul_f32 v21, v21, v19
  v_mul_f32 v22, v22, v19
  v_mul_f32 v23, v23, v19
  v_accvgpr_write_b32 a28, v20
  v_accvgpr_write_b32 a29, v21
  v_accvgpr_write_b32 a30, v22
  v_accvgpr_write_b32 a31, v23
  v_accvgpr_read_b32 v20, a32
  v_accvgpr_read_b32 v21, a33
  v_accvgpr_read_b32 v22, a34
  v_accvgpr_read_b32 v23, a35
  v_mul_f32 v20, v20, v18
  v_mul_f32 v21, v21, v18
  v_mul_f32 v22, v22, v18
  v_mul_f32 v23, v23, v18
  v_accvgpr_write_b32 a32, v20
  v_accvgpr_write_b32 a33, v21
  v_accvgpr_write_b32 a34, v22
  v_accvgpr_write_b32 a35, v23
  v_accvgpr_read_b32 v20, a36
  v_accvgpr_read_b32 v21, a37
  v_accvgpr_read_b32 v22, a38
  v_accvgpr_read_b32 v23, a39
  v_mul_f32 v20, v20, v19
  v_mul_f32 v21, v21, v19
  v_mul_f32 v22, v22, v19
  v_mul_f32 v23, v23, v19
  v_accvgpr_write_b32 a36, v20
  v_accvgpr_write_b32 a37, v21
  v_accvgpr_write_b32 a38, v22
  v_accvgpr_write_b32 a39, v23
  v_accvgpr_read_b32 v20, a40
  v_accvgpr_read_b32 v21, a41
  v_accvgpr_read_b32 v22, a42
  v_accvgpr_read_b32 v23, a43
  v_mul_f32 v20, v20, v18
  v_mul_f32 v21, v21, v18
  v_mul_f32 v22, v22, v18
  v_mul_f32 v23, v23, v18
  v_accvgpr_write_b32 a40, v20
  v_accvgpr_write_b32 a41, v21
  v_accvgpr_write_b32 a42, v22
  v_accvgpr_write_b32 a43, v23
  v_accvgpr_read_b32 v20, a44
  v_accvgpr_read_b32 v21, a45
  v_accvgpr_read_b32 v22, a46
  v_accvgpr_read_b32 v23, a47
  v_mul_f32 v20, v20, v19
  v_mul_f32 v21, v21, v19
  v_mul_f32 v22, v22, v19
  v_mul_f32 v23, v23, v19
  v_accvgpr_write_b32 a44, v20
  v_accvgpr_write_b32 a45, v21
  v_accvgpr_write_b32 a46, v22
  v_accvgpr_write_b32 a47, v23
  v_accvgpr_read_b32 v20, a48
  v_accvgpr_read_b32 v21, a49
  v_accvgpr_read_b32 v22, a50
  v_accvgpr_read_b32 v23, a51
  v_mul_f32 v20, v20, v18
  v_mul_f32 v21, v21, v18
  v_mul_f32 v22, v22, v18
  v_mul_f32 v23, v23, v18
  v_accvgpr_write_b32 a48, v20
  v_accvgpr_write_b32 a49, v21
  v_accvgpr_write_b32 a50, v22
  v_accvgpr_write_b32 a51, v23
  v_accvgpr_read_b32 v20, a52
  v_accvgpr_read_b32 v21, a53
  v_accvgpr_read_b32 v22, a54
  v_accvgpr_read_b32 v23, a55
  v_mul_f32 v20, v20, v19
  v_mul_f32 v21, v21, v19
  v_mul_f32 v22, v22, v19
  v_mul_f32 v23, v23, v19
  v_accvgpr_write_b32 a52, v20
  v_accvgpr_write_b32 a53, v21
  v_accvgpr_write_b32 a54, v22
  v_accvgpr_write_b32 a55, v23
  v_accvgpr_read_b32 v20, a56
  v_accvgpr_read_b32 v21, a57
  v_accvgpr_read_b32 v22, a58
  v_accvgpr_read_b32 v23, a59
  v_mul_f32 v20, v20, v18
  v_mul_f32 v21, v21, v18
  v_mul_f32 v22, v22, v18
  v_mul_f32 v23, v23, v18
  v_accvgpr_write_b32 a56, v20
  v_accvgpr_write_b32 a57, v21
  v_accvgpr_write_b32 a58, v22
  v_accvgpr_write_b32 a59, v23
  v_accvgpr_read_b32 v20, a60
  v_accvgpr_read_b32 v21, a61
  v_accvgpr_read_b32 v22, a62
  v_accvgpr_read_b32 v23, a63
  v_mul_f32 v20, v20, v19
  v_mul_f32 v21, v21, v19
  v_mul_f32 v22, v22, v19
  v_mul_f32 v23, v23, v19
  v_accvgpr_write_b32 a60, v20
  v_accvgpr_write_b32 a61, v21
  v_accvgpr_write_b32 a62, v22
  v_accvgpr_write_b32 a63, v23
  s_setpc_b64 s[78:79]
fa_rare10:
  s_nop 7
  v_max3_f32 v16, v128, v129, v130
  v_max3_f32 v16, v16, v131, v132
  v_max3_f32 v16, v16, v133, v134
  v_max3_f32 v16, v16, v135, 0
  v_mov_b32 v18, v16
  s_nop 1
  v_permlane16_swap_b32 v16, v18
  v_max_f32 v16, v16, v18
  v_mov_b32 v18, v16
  s_nop 1
  v_permlane32_swap_b32 v16, v18
  v_max_f32 v16, v16, v18
  v_sub_f32 v128, v128, v16
  v_sub_f32 v144, v144, v16
  v_sub_f32 v129, v129, v16
  v_sub_f32 v145, v145, v16
  v_sub_f32 v130, v130, v16
  v_sub_f32 v146, v146, v16
  v_sub_f32 v131, v131, v16
  v_sub_f32 v147, v147, v16
  v_sub_f32 v132, v132, v16
  v_sub_f32 v148, v148, v16
  v_sub_f32 v133, v133, v16
  v_sub_f32 v149, v149, v16
  v_sub_f32 v134, v134, v16
  v_sub_f32 v150, v150, v16
  v_sub_f32 v135, v135, v16
  v_sub_f32 v151, v151, v16
  v_max3_f32 v17, v136, v137, v138
  v_max3_f32 v17, v17, v139, v140
  v_max3_f32 v17, v17, v141, v142
  v_max3_f32 v17, v17, v143, 0
  v_mov_b32 v18, v17
  s_nop 1
  v_permlane16_swap_b32 v17, v18
  v_max_f32 v17, v17, v18
  v_mov_b32 v18, v17
  s_nop 1
  v_permlane32_swap_b32 v17, v18
  v_max_f32 v17, v17, v18
  v_sub_f32 v136, v136, v17
  v_sub_f32 v152, v152, v17
  v_sub_f32 v137, v137, v17
  v_sub_f32 v153, v153, v17
  v_sub_f32 v138, v138, v17
  v_sub_f32 v154, v154, v17
  v_sub_f32 v139, v139, v17
  v_sub_f32 v155, v155, v17
  v_sub_f32 v140, v140, v17
  v_sub_f32 v156, v156, v17
  v_sub_f32 v141, v141, v17
  v_sub_f32 v157, v157, v17
  v_sub_f32 v142, v142, v17
  v_sub_f32 v158, v158, v17
  v_sub_f32 v143, v143, v17
  v_sub_f32 v159, v159, v17
  s_call_b64 s[78:79], fa_resc1
  v_exp_f32 v216, v128
  v_exp_f32 v217, v129
  v_exp_f32 v218, v130
  v_add_f32 v226, v216, v217
  v_cvt_pk_bf16_f32 v176, v216, v217
  v_exp_f32 v219, v131
  v_add_f32 v226, v226, v218
  v_exp_f32 v220, v132
  v_add_f32 v226, v226, v219
  v_cvt_pk_bf16_f32 v177, v218, v219
  v_exp_f32 v221, v133
  v_add_f32 v226, v226, v220
  v_exp_f32 v222, v134
  v_add_f32 v226, v226, v221
  v_cvt_pk_bf16_f32 v178, v220, v221
  v_exp_f32 v223, v135
  v_add_f32 v226, v226, v222
  v_exp_f32 v216, v136
  v_add_f32 v226, v226, v223
  v_cvt_pk_bf16_f32 v179, v222, v223
  v_exp_f32 v217, v137
  v_exp_f32 v218, v138
  v_add_f32 v227, v216, v217
  v_cvt_pk_bf16_f32 v180, v216, v217
  v_exp_f32 v219, v139
  v_add_f32 v227, v227, v218
  v_exp_f32 v220, v140
  v_add_f32 v227, v227, v219
  v_cvt_pk_bf16_f32 v181, v218, v219
  v_exp_f32 v221, v141
  v_add_f32 v227, v227, v220
  v_exp_f32 v222, v142
  v_add_f32 v227, v227, v221
  v_cvt_pk_bf16_f32 v182, v220, v221
  v_exp_f32 v223, v143
  v_add_f32 v227, v227, v222
  s_nop 0
  v_add_f32 v227, v227, v223
  v_cvt_pk_bf16_f32 v183, v222, v223
  s_nop 1
  s_setpc_b64 s[76:77]
fa_rare11:
  s_nop 7
  v_max3_f32 v16, v144, v145, v146
  v_max3_f32 v16, v16, v147, v148
  v_max3_f32 v16, v16, v149, v150
  v_max3_f32 v16, v16, v151, 0
  v_mov_b32 v18, v16
  s_nop 1
  v_permlane16_swap_b32 v16, v18
  v_max_f32 v16, v16, v18
  v_mov_b32 v18, v16
  s_nop 1
  v_permlane32_swap_b32 v16, v18
  v_max_f32 v16, v16, v18
  v_sub_f32 v144, v144, v16
  v_sub_f32 v128, v128, v16
  v_sub_f32 v145, v145, v16
  v_sub_f32 v129, v129, v16
  v_sub_f32 v146, v146, v16
  v_sub_f32 v130, v130, v16
  v_sub_f32 v147, v147, v16
  v_sub_f32 v131, v131, v16
  v_sub_f32 v148, v148, v16
  v_sub_f32 v132, v132, v16
  v_sub_f32 v149, v149, v16
  v_sub_f32 v133, v133, v16
  v_sub_f32 v150, v150, v16
  v_sub_f32 v134, v134, v16
  v_sub_f32 v151, v151, v16
  v_sub_f32 v135, v135, v16
  v_max3_f32 v17, v152, v153, v154
  v_max3_f32 v17, v17, v155, v156
  v_max3_f32 v17, v17, v157, v158
  v_max3_f32 v17, v17, v159, 0
  v_mov_b32 v18, v17
  s_nop 1
  v_permlane16_swap_b32 v17, v18
  v_max_f32 v17, v17, v18
  v_mov_b32 v18, v17
  s_nop 1
  v_permlane32_swap_b32 v17, v18
  v_max_f32 v17, v17, v18
  v_sub_f32 v152, v152, v17
  v_sub_f32 v136, v136, v17
  v_sub_f32 v153, v153, v17
  v_sub_f32 v137, v137, v17
  v_sub_f32 v154, v154, v17
  v_sub_f32 v138, v138, v17
  v_sub_f32 v155, v155, v17
  v_sub_f32 v139, v139, v17
  v_sub_f32 v156, v156, v17
  v_sub_f32 v140, v140, v17
  v_sub_f32 v157, v157, v17
  v_sub_f32 v141, v141, v17
  v_sub_f32 v158, v158, v17
  v_sub_f32 v142, v142, v17
  v_sub_f32 v159, v159, v17
  v_sub_f32 v143, v143, v17
  s_call_b64 s[78:79], fa_resc1
  v_exp_f32 v216, v144
  v_exp_f32 v217, v145
  v_exp_f32 v218, v146
  v_add_f32 v226, v216, v217
  v_cvt_pk_bf16_f32 v184, v216, v217
  v_exp_f32 v219, v147
  v_add_f32 v226, v226, v218
  v_exp_f32 v220, v148
  v_add_f32 v226, v226, v219
  v_cvt_pk_bf16_f32 v185, v218, v219
  v_exp_f32 v221, v149
  v_add_f32 v226, v226, v220
  v_exp_f32 v222, v150
  v_add_f32 v226, v226, v221
  v_cvt_pk_bf16_f32 v186, v220, v221
  v_exp_f32 v223, v151
  v_add_f32 v226, v226, v222
  v_exp_f32 v216, v152
  v_add_f32 v226, v226, v223
  v_cvt_pk_bf16_f32 v187, v222, v223
  v_exp_f32 v217, v153
  v_exp_f32 v218, v154
  v_add_f32 v227, v216, v217
  v_cvt_pk_bf16_f32 v188, v216, v217
  v_exp_f32 v219, v155
  v_add_f32 v227, v227, v218
  v_exp_f32 v220, v156
  v_add_f32 v227, v227, v219
  v_cvt_pk_bf16_f32 v189, v218, v219
  v_exp_f32 v221, v157
  v_add_f32 v227, v227, v220
  v_exp_f32 v222, v158
  v_add_f32 v227, v227, v221
  v_cvt_pk_bf16_f32 v190, v220, v221
  v_exp_f32 v223, v159
  v_add_f32 v227, v227, v222
  s_nop 0
  v_add_f32 v227, v227, v223
  v_cvt_pk_bf16_f32 v191, v222, v223
  s_nop 1
  s_setpc_b64 s[76:77]
fa_resc1:
  v_sub_f32 v200, v200, v16
  v_sub_f32 v201, v201, v16
  v_sub_f32 v202, v202, v16
  v_sub_f32 v203, v203, v16
  v_exp_f32 v18, -v16
  v_sub_f32 v204, v204, v17
  v_sub_f32 v205, v205, v17
  v_sub_f32 v206, v206, v17
  v_sub_f32 v207, v207, v17
  v_exp_f32 v19, -v17
  s_nop 0
  v_mul_f32 v230, v230, v18
  v_mul_f32 v231, v231, v19
  v_accvgpr_read_b32 v20, a64
  v_accvgpr_read_b32 v21, a65
  v_accvgpr_read_b32 v22, a66
  v_accvgpr_read_b32 v23, a67
  v_mul_f32 v20, v20, v18
  v_mul_f32 v21, v21, v18
  v_mul_f32 v22, v22, v18
  v_mul_f32 v23, v23, v18
  v_accvgpr_write_b32 a64, v20
  v_accvgpr_write_b32 a65, v21
  v_accvgpr_write_b32 a66, v22
  v_accvgpr_write_b32 a67, v23
  v_accvgpr_read_b32 v20, a68
  v_accvgpr_read_b32 v21, a69
  v_accvgpr_read_b32 v22, a70
  v_accvgpr_read_b32 v23, a71
  v_mul_f32 v20, v20, v19
  v_mul_f32 v21, v21, v19
  v_mul_f32 v22, v22, v19
  v_mul_f32 v23, v23, v19
  v_accvgpr_write_b32 a68, v20
  v_accvgpr_write_b32 a69, v21
  v_accvgpr_write_b32 a70, v22
  v_accvgpr_write_b32 a71, v23
  v_accvgpr_read_b32 v20, a72
  v_accvgpr_read_b32 v21, a73
  v_accvgpr_read_b32 v22, a74
  v_accvgpr_read_b32 v23, a75
  v_mul_f32 v20, v20, v18
  v_mul_f32 v21, v21, v18
  v_mul_f32 v22, v22, v18
  v_mul_f32 v23, v23, v18
  v_accvgpr_write_b32 a72, v20
  v_accvgpr_write_b32 a73, v21
  v_accvgpr_write_b32 a74, v22
  v_accvgpr_write_b32 a75, v23
  v_accvgpr_read_b32 v20, a76
  v_accvgpr_read_b32 v21, a77
  v_accvgpr_read_b32 v22, a78
  v_accvgpr_read_b32 v23, a79
  v_mul_f32 v20, v20, v19
  v_mul_f32 v21, v21, v19
  v_mul_f32 v22, v22, v19
  v_mul_f32 v23, v23, v19
  v_accvgpr_write_b32 a76, v20
  v_accvgpr_write_b32 a77, v21
  v_accvgpr_write_b32 a78, v22
  v_accvgpr_write_b32 a79, v23
  v_accvgpr_read_b32 v20, a80
  v_accvgpr_read_b32 v21, a81
  v_accvgpr_read_b32 v22, a82
  v_accvgpr_read_b32 v23, a83
  v_mul_f32 v20, v20, v18
  v_mul_f32 v21, v21, v18
  v_mul_f32 v22, v22, v18
  v_mul_f32 v23, v23, v18
  v_accvgpr_write_b32 a80, v20
  v_accvgpr_write_b32 a81, v21
  v_accvgpr_write_b32 a82, v22
  v_accvgpr_write_b32 a83, v23
  v_accvgpr_read_b32 v20, a84
  v_accvgpr_read_b32 v21, a85
  v_accvgpr_read_b32 v22, a86
  v_accvgpr_read_b32 v23, a87
  v_mul_f32 v20, v20, v19
  v_mul_f32 v21, v21, v19
  v_mul_f32 v22, v22, v19
  v_mul_f32 v23, v23, v19
  v_accvgpr_write_b32 a84, v20
  v_accvgpr_write_b32 a85, v21
  v_accvgpr_write_b32 a86, v22
  v_accvgpr_write_b32 a87, v23
  v_accvgpr_read_b32 v20, a88
  v_accvgpr_read_b32 v21, a89
  v_accvgpr_read_b32 v22, a90
  v_accvgpr_read_b32 v23, a91
  v_mul_f32 v20, v20, v18
  v_mul_f32 v21, v21, v18
  v_mul_f32 v22, v22, v18
  v_mul_f32 v23, v23, v18
  v_accvgpr_write_b32 a88, v20
  v_accvgpr_write_b32 a89, v21
  v_accvgpr_write_b32 a90, v22
  v_accvgpr_write_b32 a91, v23
  v_accvgpr_read_b32 v20, a92
  v_accvgpr_read_b32 v21, a93
  v_accvgpr_read_b32 v22, a94
  v_accvgpr_read_b32 v23, a95
  v_mul_f32 v20, v20, v19
  v_mul_f32 v21, v21, v19
  v_mul_f32 v22, v22, v19
  v_mul_f32 v23, v23, v19
  v_accvgpr_write_b32 a92, v20
  v_accvgpr_write_b32 a93, v21
  v_accvgpr_write_b32 a94, v22
  v_accvgpr_write_b32 a95, v23
  v_accvgpr_read_b32 v20, a96
  v_accvgpr_read_b32 v21, a97
  v_accvgpr_read_b32 v22, a98
  v_accvgpr_read_b32 v23, a99
  v_mul_f32 v20, v20, v18
  v_mul_f32 v21, v21, v18
  v_mul_f32 v22, v22, v18
  v_mul_f32 v23, v23, v18
  v_accvgpr_write_b32 a96, v20
  v_accvgpr_write_b32 a97, v21
  v_accvgpr_write_b32 a98, v22
  v_accvgpr_write_b32 a99, v23
  v_accvgpr_read_b32 v20, a100
  v_accvgpr_read_b32 v21, a101
  v_accvgpr_read_b32 v22, a102
  v_accvgpr_read_b32 v23, a103
  v_mul_f32 v20, v20, v19
  v_mul_f32 v21, v21, v19
  v_mul_f32 v22, v22, v19
  v_mul_f32 v23, v23, v19
  v_accvgpr_write_b32 a100, v20
  v_accvgpr_write_b32 a101, v21
  v_accvgpr_write_b32 a102, v22
  v_accvgpr_write_b32 a103, v23
  v_accvgpr_read_b32 v20, a104
  v_accvgpr_read_b32 v21, a105
  v_accvgpr_read_b32 v22, a106
  v_accvgpr_read_b32 v23, a107
  v_mul_f32 v20, v20, v18
  v_mul_f32 v21, v21, v18
  v_mul_f32 v22, v22, v18
  v_mul_f32 v23, v23, v18
  v_accvgpr_write_b32 a104, v20
  v_accvgpr_write_b32 a105, v21
  v_accvgpr_write_b32 a106, v22
  v_accvgpr_write_b32 a107, v23
  v_accvgpr_read_b32 v20, a108
  v_accvgpr_read_b32 v21, a109
  v_accvgpr_read_b32 v22, a110
  v_accvgpr_read_b32 v23, a111
  v_mul_f32 v20, v20, v19
  v_mul_f32 v21, v21, v19
  v_mul_f32 v22, v22, v19
  v_mul_f32 v23, v23, v19
  v_accvgpr_write_b32 a108, v20
  v_accvgpr_write_b32 a109, v21
  v_accvgpr_write_b32 a110, v22
  v_accvgpr_write_b32 a111, v23
  v_accvgpr_read_b32 v20, a112
  v_accvgpr_read_b32 v21, a113
  v_accvgpr_read_b32 v22, a114
  v_accvgpr_read_b32 v23, a115
  v_mul_f32 v20, v20, v18
  v_mul_f32 v21, v21, v18
  v_mul_f32 v22, v22, v18
  v_mul_f32 v23, v23, v18
  v_accvgpr_write_b32 a112, v20
  v_accvgpr_write_b32 a113, v21
  v_accvgpr_write_b32 a114, v22
  v_accvgpr_write_b32 a115, v23
  v_accvgpr_read_b32 v20, a116
  v_accvgpr_read_b32 v21, a117
  v_accvgpr_read_b32 v22, a118
  v_accvgpr_read_b32 v23, a119
  v_mul_f32 v20, v20, v19
  v_mul_f32 v21, v21, v19
  v_mul_f32 v22, v22, v19
  v_mul_f32 v23, v23, v19
  v_accvgpr_write_b32 a116, v20
  v_accvgpr_write_b32 a117, v21
  v_accvgpr_write_b32 a118, v22
  v_accvgpr_write_b32 a119, v23
  v_accvgpr_read_b32 v20, a120
  v_accvgpr_read_b32 v21, a121
  v_accvgpr_read_b32 v22, a122
  v_accvgpr_read_b32 v23, a123
  v_mul_f32 v20, v20, v18
  v_mul_f32 v21, v21, v18
  v_mul_f32 v22, v22, v18
  v_mul_f32 v23, v23, v18
  v_accvgpr_write_b32 a120, v20
  v_accvgpr_write_b32 a121, v21
  v_accvgpr_write_b32 a122, v22
  v_accvgpr_write_b32 a123, v23
  v_accvgpr_read_b32 v20, a124
  v_accvgpr_read_b32 v21, a125
  v_accvgpr_read_b32 v22, a126
  v_accvgpr_read_b32 v23, a127
  v_mul_f32 v20, v20, v19
  v_mul_f32 v21, v21, v19
  v_mul_f32 v22, v22, v19
  v_mul_f32 v23, v23, v19
  v_accvgpr_write_b32 a124, v20
  v_accvgpr_write_b32 a125, v21
  v_accvgpr_write_b32 a126, v22
  v_accvgpr_write_b32 a127, v23
  s_setpc_b64 s[78:79]
.section .rodata,"a"
.p2align 6
.amdhsa_kernel fa_kernel
  .amdhsa_next_free_vgpr 512
  .amdhsa_next_free_sgpr 102
  .amdhsa_accum_offset 256
  .amdhsa_group_segment_fixed_size 0
  .amdhsa_kernarg_size 112
  .amdhsa_user_sgpr_count 2
  .amdhsa_user_sgpr_kernarg_segment_ptr 1
  .amdhsa_system_sgpr_workgroup_id_x 1
  .amdhsa_float_denorm_mode_32 3
.end_amdhsa_kernel
.text
```

```asm
; @launch kernel=fa_kernel grid=(256,1,1) block=(256,1,1) lds=163840
.amdgcn_target "amdgcn-amd-amdhsa--gfx950"
.text
.globl fa_kernel
.p2align 8
.type fa_kernel,@function
fa_kernel:
  s_cmp_ge_u32 s2, 256
  s_cbranch_scc1 fa_end
  s_load_dwordx4 s[4:7], s[0:1], 0
  s_load_dwordx2 s[14:15], s[0:1], 56
  s_load_dwordx4 s[8:11], s[0:1], 24
  s_load_dwordx2 s[12:13], s[0:1], 40
  s_load_dwordx4 s[16:19], s[0:1], 96
  s_load_dwordx2 s[60:61], s[0:1], 16
  v_lshrrev_b32 v16, 6, v0
  v_and_b32 v1, 63, v0
  v_readfirstlane_b32 s20, v16
  s_and_b32 s21, s2, 7
  s_lshl_b32 s21, s21, 2
  s_lshr_b32 s23, s2, 3
  s_and_b32 s23, s23, 3
  s_add_u32 s21, s21, s23
  s_lshr_b32 s22, s2, 5
  v_and_b32 v208, 31, v1
  v_lshrrev_b32 v209, 5, v1
  s_lshl_b32 s23, s2, 2
  s_add_u32 s23, s23, s20
  s_lshl_b32 s23, s23, 1
  v_add_u32 v209, s23, v209
  v_lshlrev_b32 v212, 4, v208
  v_mul_u32_u24 v210, 1280, v209
  v_add_u32 v210, v210, v212
  v_cmp_gt_u32 s[64:65], 16, v208
  v_mov_b32 v211, 1073741824
  v_lshlrev_b32 v2, 4, v1
  v_cndmask_b32 v211, v211, v210, s[64:65]
  v_lshrrev_b32 v16, 2, v1
  v_lshrrev_b32 v17, 5, v1
  v_mul_u32_u24 v17, 3, v17
  v_and_b32 v18, 3, v1
  v_xor_b32 v17, v17, v18
  v_lshlrev_b32 v17, 4, v17
  v_lshl_add_u32 v224, v16, 10, v17
  s_lshl_b32 s23, s20, 16
  v_add_u32 v224, s23, v224
  v_add_u32 v225, 15360, v224
  v_add_u32 v226, 30720, v224
  v_add_u32 v227, 46080, v224
  v_and_b32 v16, 3, v16
  v_lshrrev_b32 v17, 4, v1
  v_lshlrev_b32 v17, 6, v17
  v_lshl_add_u32 v16, v16, 13, v17
  s_and_b32 s23, s20, 1
  s_lshl_b32 s23, s23, 17
  v_add_u32 v16, s23, v16
  v_lshl_add_u32 v8, v18, 4, v16
  v_xor_b32 v18, 2, v18
  v_lshl_add_u32 v10, v18, 4, v16
  v_add_u32 v9, 31744, v8
  v_add_u32 v11, 95232, v10
  v_add_u32 v10, 63488, v10
  s_lshl_b32 s24, s20, 12
  s_mov_b32 s26, 0
  s_mov_b32 s27, 0
  s_mov_b32 s25, 262144
  v_bfe_u32 v17, v1, 1, 3
  v_lshlrev_b32 v17, 13, v17
  v_and_b32 v18, 1, v1
  v_lshl_add_u32 v235, v18, 7, v17
  s_lshl_b32 s74, s22, 1
  s_and_b32 s31, s20, 1
  s_add_u32 s74, s74, s31
  s_lshl_b32 s74, s74, 16
  s_mov_b32 s73, 1048576
  s_and_b32 s29, s2, 31
  s_lshl_b32 s29, s29, 2
  s_add_u32 s29, s29, s20
  s_lshl_b32 s29, s29, 11
  v_and_b32 v16, 15, v1
  v_lshlrev_b32 v234, 7, v16
  v_lshlrev_b32 v17, 10, v16
  v_and_b32 v18, 16, v1
  v_lshl_add_u32 v233, v18, 3, v17
  s_and_b32 s30, s21, 3
  s_lshl_b32 s30, s30, 2
  s_add_u32 s30, s30, s20
  s_lshl_b32 s30, s30, 14
  s_waitcnt lgkmcnt(0)
  s_mov_b32 s44, s4
  s_mov_b32 s45, s5
  s_mov_b32 s46, 2621440
  s_mov_b32 s47, 0x20000
  s_mov_b32 s48, s14
  s_mov_b32 s49, s15
  s_mov_b32 s50, 1280
  s_mov_b32 s51, 0x20000
  buffer_load_dwordx4 v[160:163], v210, s[44:47], 0 offen
  buffer_load_dwordx4 v[164:167], v210, s[44:47], 0 offen offset:512
  buffer_load_dwordx4 v[168:171], v211, s[44:47], 0 offen offset:1024
  buffer_load_dwordx4 v[172:175], v212, s[48:51], 0 offen offset:0
  buffer_load_dwordx4 v[176:179], v212, s[48:51], 0 offen offset:512
  buffer_load_dwordx4 v[180:183], v212, s[48:51], 0 offen offset:1024
  s_lshl_b32 s23, s22, 18
  s_add_u32 s62, s6, s23
  s_addc_u32 s63, s7, 0
  s_mov_b32 s32, s62
  s_mov_b32 s33, s63
  s_mov_b32 s34, 262144
  s_mov_b32 s35, 0x20000
  s_cmp_ge_u32 s20, 2
  s_cselect_b32 s62, s10, s8
  s_cselect_b32 s63, s11, s9
  s_lshl_b32 s23, s21, 8
  s_add_u32 s62, s62, s23
  s_addc_u32 s63, s63, 0
  s_mov_b32 s36, s62
  s_mov_b32 s37, s63
  s_mov_b32 s38, 0
  s_mov_b32 s39, 0x20000
  s_sub_u32 s38, 4194304, s23
  buffer_load_dword v231, v235, s[36:39], s74 offen
  buffer_load_dword v232, v233, s[32:35], s30 offen
  s_add_u32 s74, s74, s73
  s_add_u32 s60, s60, s23
  s_addc_u32 s61, s61, 0
  s_sub_u32 s75, 5242880, s23
  s_mov_b32 s48, s62
  s_mov_b32 s49, s63
  s_mov_b32 s50, s38
  s_mov_b32 s51, 0x20000
  s_mov_b32 s40, s18
  s_mov_b32 s41, s19
  s_mov_b32 s42, 67108864
  s_mov_b32 s43, 0x20000
  s_mov_b32 s52, s12
  s_mov_b32 s53, s13
  s_mov_b32 s54, 5242880
  s_mov_b32 s55, 0x20000
  s_mov_b32 s56, s16
  s_mov_b32 s57, s17
  s_mov_b32 s58, 256
  s_mov_b32 s59, 0x20000
  s_lshl_b32 s23, s20, 5
  s_add_u32 s23, s23, s21
  s_lshl_b32 s23, s23, 2
  s_add_u32 s23, s23, 2641920
  s_lshl_b32 s31, s22, 9
  s_add_u32 s80, s23, s31
  s_sub_u32 s31, 7680, s31
  s_add_u32 s3, s23, s31
  s_lshl_b32 s23, s21, 7
  s_lshl_b32 s31, s22, 2
  s_add_u32 s23, s23, s31
  s_add_u32 s82, s23, 2637824
  s_and_b32 s23, s2, 63
  s_lshl_b32 s23, s23, 2
  s_add_u32 s23, s23, 2650112
  s_cmp_ge_u32 s2, 192
  s_cselect_b32 s23, s23, 1073741824
  s_cmp_eq_u32 s20, 1
  s_cselect_b32 s31, s23, 1073741824
  s_cmp_eq_u32 s20, 0
  s_cselect_b32 s31, s82, s31
  s_cmp_eq_u32 s2, 255
  s_cselect_b32 s23, 2629632, 1073741824
  v_lshl_add_u32 v19, v16, 2, s23
  v_mov_b32 v229, 0
  v_writelane_b32 v19, s80, 0
  v_writelane_b32 v19, s3, 1
  v_writelane_b32 v19, s31, 2
  s_and_b32 s23, s2, 1
  s_lshl_b32 s23, s23, 2
  s_add_u32 s23, s23, s20
  s_lshl_b32 s23, s23, 7
  s_lshr_b32 s31, s2, 1
  s_add_u32 s23, s23, s31
  s_lshl_b32 s23, s23, 2
  s_add_u32 s23, s23, 2654208
  v_writelane_b32 v19, s23, 3
  buffer_store_dword v229, v19, s[40:43], 0 offen sc1
  s_and_b32 s71, s21, 3
  s_add_u32 s71, s71, 1
  s_lshl_b32 s72, 1, s71
  s_or_b32 s72, s72, 0x48
  s_cmp_eq_u32 s20, 0
  s_cselect_b32 s70, s2, 1073741824
  v_mov_b32 v20, 0
  v_mov_b32 v21, 0
  v_mov_b32 v22, 0
  v_mov_b32 v23, 0
  v_and_b32 v16, 15, v1
  v_lshrrev_b32 v17, 4, v1
  v_lshrrev_b32 v18, 3, v16
  v_mul_u32_u24 v18, 3, v18
  v_xor_b32 v18, v18, v17
  v_lshlrev_b32 v18, 4, v18
  v_lshl_add_u32 v14, v16, 6, v18
  s_and_b32 s23, s20, 1
  s_lshl_b32 s23, s23, 13
  v_add_u32 v14, s23, v14
  v_mfma_f32_32x32x16_bf16 a[0:15], v[20:23], v[20:23], 0
  v_mfma_f32_32x32x16_bf16 a[16:31], v[20:23], v[20:23], 0
  v_mfma_f32_32x32x16_bf16 a[32:47], v[20:23], v[20:23], 0
  v_mfma_f32_32x32x16_bf16 a[48:63], v[20:23], v[20:23], 0
  v_mfma_f32_32x32x16_bf16 a[64:79], v[20:23], v[20:23], 0
  v_mfma_f32_32x32x16_bf16 a[80:95], v[20:23], v[20:23], 0
  v_mfma_f32_32x32x16_bf16 a[96:111], v[20:23], v[20:23], 0
  v_mfma_f32_32x32x16_bf16 a[112:127], v[20:23], v[20:23], 0
  v_mfma_f32_32x32x16_bf16 a[128:143], v[20:23], v[20:23], 0
  v_mfma_f32_32x32x16_bf16 a[144:159], v[20:23], v[20:23], 0
  v_mfma_f32_32x32x16_bf16 a[160:175], v[20:23], v[20:23], 0
  v_mfma_f32_32x32x16_bf16 a[176:191], v[20:23], v[20:23], 0
  v_mfma_f32_32x32x16_bf16 a[192:207], v[20:23], v[20:23], 0
  v_mfma_f32_32x32x16_bf16 a[208:223], v[20:23], v[20:23], 0
  v_mfma_f32_32x32x16_bf16 a[224:239], v[20:23], v[20:23], 0
  v_mfma_f32_32x32x16_bf16 a[240:255], v[20:23], v[20:23], 0
  v_lshrrev_b32 v18, 2, v16
  v_lshlrev_b32 v18, 6, v18
  v_lshl_add_u32 v18, v17, 11, v18
  v_and_b32 v19, 1, v1
  v_lshl_add_u32 v18, v19, 3, v18
  v_bfe_u32 v19, v1, 1, 1
  v_and_b32 v17, 1, v17
  v_lshl_or_b32 v19, v17, 1, v19
  s_lshr_b32 s23, s20, 1
  s_lshl_b32 s23, s23, 13
  s_add_u32 s23, s23, 16384
  v_add_u32 v18, s23, v18
  v_lshl_add_u32 v12, v19, 4, v18
  v_xor_b32 v13, 32, v12
  s_waitcnt vmcnt(3)
  s_mov_b32 m0, s24
  s_nop 0
  buffer_load_dwordx4 v224, s[32:35], s26 offen offset:0 lds
  buffer_load_dwordx4 v225, s[32:35], s26 offen offset:1024 lds
  buffer_load_dwordx4 v226, s[32:35], s26 offen offset:2048 lds
  buffer_load_dwordx4 v227, s[32:35], s26 offen offset:3072 lds
  s_add_u32 m0, s24, 16384
  s_nop 0
  buffer_load_dwordx4 v8, s[36:39], s27 offen offset:0 lds
  buffer_load_dwordx4 v9, s[36:39], s27 offen offset:1024 lds
  buffer_load_dwordx4 v10, s[36:39], s27 offen offset:2048 lds
  buffer_load_dwordx4 v11, s[36:39], s27 offen offset:3072 lds
  s_add_u32 s26, s26, 64
  s_add_u32 s27, s27, s25
  s_add_u32 s24, s24, 32768
  s_and_b32 s24, s24, 0x1ffff
  v_lshlrev_b32 v184, 16, v160
  v_and_b32 v185, 0xffff0000, v160
  v_lshlrev_b32 v186, 16, v161
  v_and_b32 v187, 0xffff0000, v161
  v_lshlrev_b32 v188, 16, v162
  v_and_b32 v189, 0xffff0000, v162
  v_lshlrev_b32 v190, 16, v163
  v_and_b32 v191, 0xffff0000, v163
  v_lshlrev_b32 v192, 16, v164
  v_and_b32 v193, 0xffff0000, v164
  v_lshlrev_b32 v194, 16, v165
  v_and_b32 v195, 0xffff0000, v165
  v_lshlrev_b32 v196, 16, v166
  v_and_b32 v197, 0xffff0000, v166
  v_lshlrev_b32 v198, 16, v167
  v_and_b32 v199, 0xffff0000, v167
  v_lshlrev_b32 v200, 16, v168
  v_and_b32 v201, 0xffff0000, v168
  v_lshlrev_b32 v202, 16, v169
  v_and_b32 v203, 0xffff0000, v169
  v_lshlrev_b32 v204, 16, v170
  v_and_b32 v205, 0xffff0000, v170
  v_lshlrev_b32 v206, 16, v171
  v_and_b32 v207, 0xffff0000, v171
  v_add_f32 v213, v184, v185
  v_add_f32 v214, v186, v187
  v_add_f32 v213, v213, v188
  v_add_f32 v214, v214, v189
  v_add_f32 v213, v213, v190
  v_add_f32 v214, v214, v191
  v_add_f32 v213, v213, v192
  v_add_f32 v214, v214, v193
  v_add_f32 v213, v213, v194
  v_add_f32 v214, v214, v195
  v_add_f32 v213, v213, v196
  v_add_f32 v214, v214, v197
  v_add_f32 v213, v213, v198
  v_add_f32 v214, v214, v199
  v_add_f32 v213, v213, v200
  v_add_f32 v214, v214, v201
  v_add_f32 v213, v213, v202
  v_add_f32 v214, v214, v203
  v_add_f32 v213, v213, v204
  v_add_f32 v214, v214, v205
  v_add_f32 v213, v213, v206
  v_add_f32 v214, v214, v207
  v_add_f32 v213, v213, v214
  s_nop 1
  v_add_f32_dpp v213, v213, v213 quad_perm:[1,0,3,2] row_mask:0xf bank_mask:0xf
  s_nop 1
  v_add_f32_dpp v213, v213, v213 quad_perm:[2,3,0,1] row_mask:0xf bank_mask:0xf
  s_nop 1
  v_add_f32_dpp v213, v213, v213 row_half_mirror row_mask:0xf bank_mask:0xf
  s_nop 1
  v_add_f32_dpp v213, v213, v213 row_mirror row_mask:0xf bank_mask:0xf
  v_mov_b32 v214, v213
  s_nop 1
  v_permlane16_swap_b32 v213, v214
  v_add_f32 v213, v213, v214
  v_mul_f32 v215, 0x3acccccd, v213
  v_mov_b32 v218, 0
  v_mov_b32 v213, 0
  v_sub_f32 v16, v184, v215
  v_fmac_f32 v218, v16, v16
  v_sub_f32 v17, v185, v215
  v_fmac_f32 v218, v17, v17
  v_sub_f32 v18, v186, v215
  v_fmac_f32 v218, v18, v18
  v_sub_f32 v19, v187, v215
  v_fmac_f32 v218, v19, v19
  v_sub_f32 v16, v188, v215
  v_fmac_f32 v218, v16, v16
  v_sub_f32 v17, v189, v215
  v_fmac_f32 v218, v17, v17
  v_sub_f32 v18, v190, v215
  v_fmac_f32 v218, v18, v18
  v_sub_f32 v19, v191, v215
  v_fmac_f32 v218, v19, v19
  v_sub_f32 v16, v192, v215
  v_fmac_f32 v218, v16, v16
  v_sub_f32 v17, v193, v215
  v_fmac_f32 v218, v17, v17
  v_sub_f32 v18, v194, v215
  v_fmac_f32 v218, v18, v18
  v_sub_f32 v19, v195, v215
  v_fmac_f32 v218, v19, v19
  v_sub_f32 v16, v196, v215
  v_fmac_f32 v218, v16, v16
  v_sub_f32 v17, v197, v215
  v_fmac_f32 v218, v17, v17
  v_sub_f32 v18, v198, v215
  v_fmac_f32 v218, v18, v18
  v_sub_f32 v19, v199, v215
  v_fmac_f32 v218, v19, v19
  v_sub_f32 v16, v200, v215
  v_fmac_f32 v213, v16, v16
  v_sub_f32 v17, v201, v215
  v_fmac_f32 v213, v17, v17
  v_sub_f32 v18, v202, v215
  v_fmac_f32 v213, v18, v18
  v_sub_f32 v19, v203, v215
  v_fmac_f32 v213, v19, v19
  v_sub_f32 v16, v204, v215
  v_fmac_f32 v213, v16, v16
  v_sub_f32 v17, v205, v215
  v_fmac_f32 v213, v17, v17
  v_sub_f32 v18, v206, v215
  v_fmac_f32 v213, v18, v18
  v_sub_f32 v19, v207, v215
  v_fmac_f32 v213, v19, v19
  v_cndmask_b32 v213, 0, v213, s[64:65]
  v_add_f32 v213, v213, v218
  s_nop 1
  v_add_f32_dpp v213, v213, v213 quad_perm:[1,0,3,2] row_mask:0xf bank_mask:0xf
  s_nop 1
  v_add_f32_dpp v213, v213, v213 quad_perm:[2,3,0,1] row_mask:0xf bank_mask:0xf
  s_nop 1
  v_add_f32_dpp v213, v213, v213 row_half_mirror row_mask:0xf bank_mask:0xf
  s_nop 1
  v_add_f32_dpp v213, v213, v213 row_mirror row_mask:0xf bank_mask:0xf
  v_mov_b32 v214, v213
  s_nop 1
  v_permlane16_swap_b32 v213, v214
  v_add_f32 v213, v213, v214
  v_mul_f32 v213, 0x3acccccd, v213
  v_cvt_pk_bf16_f32 v213, v213, v213
  v_and_b32 v213, 0xffff0000, v213
  v_add_f32 v213, 0x3727c5ac, v213
  v_cvt_pk_bf16_f32 v213, v213, v213
  v_and_b32 v213, 0xffff0000, v213
  v_sqrt_f32 v213, v213
  v_mov_b32 v216, v215
  v_cvt_pk_bf16_f32 v213, v213, v213
  v_and_b32 v213, 0xffff0000, v213
  v_rcp_f32 v217, v213
  v_cvt_pk_bf16_f32 v216, v216, v216
  v_and_b32 v216, 0xffff0000, v216
  s_mov_b32 m0, s24
  s_nop 0
  buffer_load_dwordx4 v224, s[32:35], s26 offen offset:0 lds
  buffer_load_dwordx4 v225, s[32:35], s26 offen offset:1024 lds
  buffer_load_dwordx4 v226, s[32:35], s26 offen offset:2048 lds
  buffer_load_dwordx4 v227, s[32:35], s26 offen offset:3072 lds
  s_add_u32 m0, s24, 16384
  s_nop 0
  buffer_load_dwordx4 v8, s[36:39], s27 offen offset:0 lds
  buffer_load_dwordx4 v9, s[36:39], s27 offen offset:1024 lds
  buffer_load_dwordx4 v10, s[36:39], s27 offen offset:2048 lds
  buffer_load_dwordx4 v11, s[36:39], s27 offen offset:3072 lds
  s_add_u32 s26, s26, 64
  s_add_u32 s27, s27, s25
  s_add_u32 s24, s24, 32768
  s_and_b32 s24, s24, 0x1ffff
  v_mov_b32 v218, 0
  v_sub_f32 v184, v184, v216
  v_sub_f32 v185, v185, v216
  v_cvt_pk_bf16_f32 v16, v184, v185
  v_lshlrev_b32 v184, 16, v16
  v_and_b32 v185, 0xffff0000, v16
  v_mul_f32 v184, v184, v217
  v_mul_f32 v185, v185, v217
  v_cvt_pk_bf16_f32 v160, v184, v185
  v_lshlrev_b32 v184, 16, v160
  v_and_b32 v185, 0xffff0000, v160
  v_lshlrev_b32 v17, 16, v172
  v_and_b32 v18, 0xffff0000, v172
  v_fmac_f32 v218, v184, v17
  v_fmac_f32 v218, v185, v18
  v_sub_f32 v186, v186, v216
  v_sub_f32 v187, v187, v216
  v_cvt_pk_bf16_f32 v16, v186, v187
  v_lshlrev_b32 v186, 16, v16
  v_and_b32 v187, 0xffff0000, v16
  v_mul_f32 v186, v186, v217
  v_mul_f32 v187, v187, v217
  v_cvt_pk_bf16_f32 v161, v186, v187
  v_lshlrev_b32 v186, 16, v161
  v_and_b32 v187, 0xffff0000, v161
  v_lshlrev_b32 v17, 16, v173
  v_and_b32 v18, 0xffff0000, v173
  v_fmac_f32 v218, v186, v17
  v_fmac_f32 v218, v187, v18
  v_sub_f32 v188, v188, v216
  v_sub_f32 v189, v189, v216
  v_cvt_pk_bf16_f32 v16, v188, v189
  v_lshlrev_b32 v188, 16, v16
  v_and_b32 v189, 0xffff0000, v16
  v_mul_f32 v188, v188, v217
  v_mul_f32 v189, v189, v217
  v_cvt_pk_bf16_f32 v162, v188, v189
  v_lshlrev_b32 v188, 16, v162
  v_and_b32 v189, 0xffff0000, v162
  v_lshlrev_b32 v17, 16, v174
  v_and_b32 v18, 0xffff0000, v174
  v_fmac_f32 v218, v188, v17
  v_fmac_f32 v218, v189, v18
  v_sub_f32 v190, v190, v216
  v_sub_f32 v191, v191, v216
  v_cvt_pk_bf16_f32 v16, v190, v191
  v_lshlrev_b32 v190, 16, v16
  v_and_b32 v191, 0xffff0000, v16
  v_mul_f32 v190, v190, v217
  v_mul_f32 v191, v191, v217
  v_cvt_pk_bf16_f32 v163, v190, v191
  v_lshlrev_b32 v190, 16, v163
  v_and_b32 v191, 0xffff0000, v163
  v_lshlrev_b32 v17, 16, v175
  v_and_b32 v18, 0xffff0000, v175
  v_fmac_f32 v218, v190, v17
  v_fmac_f32 v218, v191, v18
  v_sub_f32 v192, v192, v216
  v_sub_f32 v193, v193, v216
  v_cvt_pk_bf16_f32 v16, v192, v193
  v_lshlrev_b32 v192, 16, v16
  v_and_b32 v193, 0xffff0000, v16
  v_mul_f32 v192, v192, v217
  v_mul_f32 v193, v193, v217
  v_cvt_pk_bf16_f32 v164, v192, v193
  v_lshlrev_b32 v192, 16, v164
  v_and_b32 v193, 0xffff0000, v164
  v_lshlrev_b32 v17, 16, v176
  v_and_b32 v18, 0xffff0000, v176
  v_fmac_f32 v218, v192, v17
  v_fmac_f32 v218, v193, v18
  v_sub_f32 v194, v194, v216
  v_sub_f32 v195, v195, v216
  v_cvt_pk_bf16_f32 v16, v194, v195
  v_lshlrev_b32 v194, 16, v16
  v_and_b32 v195, 0xffff0000, v16
  v_mul_f32 v194, v194, v217
  v_mul_f32 v195, v195, v217
  v_cvt_pk_bf16_f32 v165, v194, v195
  v_lshlrev_b32 v194, 16, v165
  v_and_b32 v195, 0xffff0000, v165
  v_lshlrev_b32 v17, 16, v177
  v_and_b32 v18, 0xffff0000, v177
  v_fmac_f32 v218, v194, v17
  v_fmac_f32 v218, v195, v18
  v_sub_f32 v196, v196, v216
  v_sub_f32 v197, v197, v216
  v_cvt_pk_bf16_f32 v16, v196, v197
  v_lshlrev_b32 v196, 16, v16
  v_and_b32 v197, 0xffff0000, v16
  v_mul_f32 v196, v196, v217
  v_mul_f32 v197, v197, v217
  v_cvt_pk_bf16_f32 v166, v196, v197
  v_lshlrev_b32 v196, 16, v166
  v_and_b32 v197, 0xffff0000, v166
  v_lshlrev_b32 v17, 16, v178
  v_and_b32 v18, 0xffff0000, v178
  v_fmac_f32 v218, v196, v17
  v_fmac_f32 v218, v197, v18
  v_sub_f32 v198, v198, v216
  v_sub_f32 v199, v199, v216
  v_cvt_pk_bf16_f32 v16, v198, v199
  v_lshlrev_b32 v198, 16, v16
  v_and_b32 v199, 0xffff0000, v16
  v_mul_f32 v198, v198, v217
  v_mul_f32 v199, v199, v217
  v_cvt_pk_bf16_f32 v167, v198, v199
  v_lshlrev_b32 v198, 16, v167
  v_and_b32 v199, 0xffff0000, v167
  v_lshlrev_b32 v17, 16, v179
  v_and_b32 v18, 0xffff0000, v179
  v_fmac_f32 v218, v198, v17
  v_fmac_f32 v218, v199, v18
  v_sub_f32 v200, v200, v216
  v_sub_f32 v201, v201, v216
  v_cvt_pk_bf16_f32 v16, v200, v201
  v_lshlrev_b32 v200, 16, v16
  v_and_b32 v201, 0xffff0000, v16
  v_mul_f32 v200, v200, v217
  v_mul_f32 v201, v201, v217
  v_cvt_pk_bf16_f32 v168, v200, v201
  v_lshlrev_b32 v200, 16, v168
  v_and_b32 v201, 0xffff0000, v168
  v_lshlrev_b32 v17, 16, v180
  v_and_b32 v18, 0xffff0000, v180
  v_fmac_f32 v218, v200, v17
  v_fmac_f32 v218, v201, v18
  v_sub_f32 v202, v202, v216
  v_sub_f32 v203, v203, v216
  v_cvt_pk_bf16_f32 v16, v202, v203
  v_lshlrev_b32 v202, 16, v16
  v_and_b32 v203, 0xffff0000, v16
  v_mul_f32 v202, v202, v217
  v_mul_f32 v203, v203, v217
  v_cvt_pk_bf16_f32 v169, v202, v203
  v_lshlrev_b32 v202, 16, v169
  v_and_b32 v203, 0xffff0000, v169
  v_lshlrev_b32 v17, 16, v181
  v_and_b32 v18, 0xffff0000, v181
  v_fmac_f32 v218, v202, v17
  v_fmac_f32 v218, v203, v18
  v_sub_f32 v204, v204, v216
  v_sub_f32 v205, v205, v216
  v_cvt_pk_bf16_f32 v16, v204, v205
  v_lshlrev_b32 v204, 16, v16
  v_and_b32 v205, 0xffff0000, v16
  v_mul_f32 v204, v204, v217
  v_mul_f32 v205, v205, v217
  v_cvt_pk_bf16_f32 v170, v204, v205
  v_lshlrev_b32 v204, 16, v170
  v_and_b32 v205, 0xffff0000, v170
  v_lshlrev_b32 v17, 16, v182
  v_and_b32 v18, 0xffff0000, v182
  v_fmac_f32 v218, v204, v17
  v_fmac_f32 v218, v205, v18
  v_sub_f32 v206, v206, v216
  v_sub_f32 v207, v207, v216
  v_cvt_pk_bf16_f32 v16, v206, v207
  v_lshlrev_b32 v206, 16, v16
  v_and_b32 v207, 0xffff0000, v16
  v_mul_f32 v206, v206, v217
  v_mul_f32 v207, v207, v217
  v_cvt_pk_bf16_f32 v171, v206, v207
  v_lshlrev_b32 v206, 16, v171
  v_and_b32 v207, 0xffff0000, v171
  v_lshlrev_b32 v17, 16, v183
  v_and_b32 v18, 0xffff0000, v183
  v_fmac_f32 v218, v206, v17
  v_fmac_f32 v218, v207, v18
  s_mov_b32 m0, s24
  s_nop 0
  buffer_load_dwordx4 v224, s[32:35], s26 offen offset:0 lds
  buffer_load_dwordx4 v225, s[32:35], s26 offen offset:1024 lds
  buffer_load_dwordx4 v226, s[32:35], s26 offen offset:2048 lds
  buffer_load_dwordx4 v227, s[32:35], s26 offen offset:3072 lds
  s_add_u32 m0, s24, 16384
  s_nop 0
  buffer_load_dwordx4 v8, s[36:39], s27 offen offset:0 lds
  buffer_load_dwordx4 v9, s[36:39], s27 offen offset:1024 lds
  buffer_load_dwordx4 v10, s[36:39], s27 offen offset:2048 lds
  buffer_load_dwordx4 v11, s[36:39], s27 offen offset:3072 lds
  s_add_u32 s26, s26, 64
  s_add_u32 s27, s27, s25
  s_add_u32 s24, s24, 32768
  s_and_b32 s24, s24, 0x1ffff
  v_and_b32 v16, 7, v209
  v_lshlrev_b32 v16, 4, v16
  v_lshl_add_u32 v16, v208, 7, v16
  v_add_u32 v16, 131072, v16
  ds_write_b128 v16, v[160:163] offset:0
  ds_write_b128 v16, v[164:167] offset:4096
  ds_write_b128 v16, v[168:171] offset:8192
  s_nop 1
  v_add_f32_dpp v218, v218, v218 quad_perm:[1,0,3,2] row_mask:0xf bank_mask:0xf
  s_nop 1
  v_add_f32_dpp v218, v218, v218 quad_perm:[2,3,0,1] row_mask:0xf bank_mask:0xf
  s_nop 1
  v_add_f32_dpp v218, v218, v218 row_half_mirror row_mask:0xf bank_mask:0xf
  s_nop 1
  v_add_f32_dpp v218, v218, v218 row_mirror row_mask:0xf bank_mask:0xf
  v_mov_b32 v214, v218
  s_nop 1
  v_permlane16_swap_b32 v218, v214
  v_add_f32 v218, v218, v214
  v_cvt_pk_bf16_f32 v218, v218, v218
  v_and_b32 v218, 0xffff0000, v218
  v_ashrrev_i32 v214, 31, v218
  v_or_b32 v214, 0x80000000, v214
  v_xor_b32 v218, v218, v214
  v_and_b32 v218, 0xffff0000, v218
  v_sub_u32 v214, 0xffff, v209
  v_or_b32 v218, v218, v214
  v_lshlrev_b32 v214, 2, v209
  v_add_u32 v214, 2621440, v214
  v_mov_b32 v19, 1073741824
  v_cmp_eq_u32 vcc, 0, v208
  v_lshlrev_b32 v16, 4, v0
  v_add_u32 v16, 131072, v16
  v_cndmask_b32 v214, v19, v214, vcc
  v_lshrrev_b32 v17, 3, v0
  v_and_b32 v18, 7, v0
  v_lshlrev_b32 v18, 4, v18
  v_lshl_add_u32 v17, v17, 8, v18
  v_cmp_gt_u32 vcc, 128, v0
  s_lshr_b32 s23, s2, 1
  s_mul_i32 s23, s23, 20480
  s_and_b32 s31, s2, 1
  s_lshl_b32 s31, s31, 7
  s_add_u32 s23, s23, s31
  v_cndmask_b32 v18, v19, v17, vcc
  s_mov_b32 s66, s23
  s_add_u32 s67, s23, 8192
  s_add_u32 s68, s23, 16384
  s_mov_b32 m0, s24
  s_nop 0
  buffer_load_dwordx4 v224, s[32:35], s26 offen offset:0 lds
  buffer_load_dwordx4 v225, s[32:35], s26 offen offset:1024 lds
  buffer_load_dwordx4 v226, s[32:35], s26 offen offset:2048 lds
  buffer_load_dwordx4 v227, s[32:35], s26 offen offset:3072 lds
  s_add_u32 m0, s24, 16384
  s_nop 0
  buffer_load_dwordx4 v8, s[36:39], s27 offen offset:0 lds
  buffer_load_dwordx4 v9, s[36:39], s27 offen offset:1024 lds
  buffer_load_dwordx4 v10, s[36:39], s27 offen offset:2048 lds
  buffer_load_dwordx4 v11, s[36:39], s27 offen offset:3072 lds
  s_add_u32 s26, s26, 64
  s_add_u32 s27, s27, s25
  s_add_u32 s24, s24, 32768
  s_and_b32 s24, s24, 0x1ffff
  s_waitcnt vmcnt(24) lgkmcnt(0)
  s_barrier
  ds_read_b128 v[160:163], v16 offset:0
  ds_read_b128 v[164:167], v16 offset:4096
  ds_read_b128 v[168:171], v16 offset:8192
  buffer_load_dword v231, v235, s[36:39], s74 offen
  buffer_load_dword v232, v234, s[32:35], s29 offen
  s_getpc_b64 s[62:63]
fa_pc:
  s_lshr_b32 s23, s2, 3
  s_and_b32 s23, s23, 7
  s_lshl_b32 s23, s23, 2
  s_add_u32 s23, s23, s20
  s_lshl_b32 s23, s23, 11
  s_min_u32 s23, s23, fa_codeend-fa_pc-2048
  v_add_u32 v234, s23, v234
  global_load_dword v231, v234, s[62:63]
  buffer_store_dword v218, v214, s[40:43], 0 offen sc1
  s_mov_b32 s28, 0
  s_waitcnt lgkmcnt(0)
  buffer_store_dwordx4 v[160:163], v17, s[40:43], s66 offen sc1
  buffer_store_dwordx4 v[164:167], v17, s[40:43], s67 offen sc1
  buffer_store_dwordx4 v[168:171], v18, s[40:43], s68 offen sc1
  s_cmp_ge_u32 s20, 2
  s_cbranch_scc1 fa_roleV
  ds_read_b128 v[96:99], v14 offset:0
  ds_read_b128 v[100:103], v14 offset:1024
  ds_read_b128 v[104:107], v14 offset:2048
  ds_read_b128 v[108:111], v14 offset:3072
  ds_read_b128 v[112:115], v14 offset:4096
  ds_read_b128 v[116:119], v14 offset:5120
  ds_read_b128 v[120:123], v14 offset:6144
  ds_read_b128 v[124:127], v14 offset:7168
  ds_read_b64_tr_b16 v[32:33], v12 offset:0
  ds_read_b64_tr_b16 v[34:35], v12 offset:1024
  ds_read_b64_tr_b16 v[36:37], v13 offset:0
  ds_read_b64_tr_b16 v[38:39], v13 offset:1024
  ds_read_b64_tr_b16 v[40:41], v12 offset:256
  ds_read_b64_tr_b16 v[42:43], v12 offset:1280
  ds_read_b64_tr_b16 v[44:45], v13 offset:256
  ds_read_b64_tr_b16 v[46:47], v13 offset:1280
  ds_read_b64_tr_b16 v[48:49], v12 offset:512
  ds_read_b64_tr_b16 v[50:51], v12 offset:1536
  ds_read_b64_tr_b16 v[52:53], v13 offset:512
  ds_read_b64_tr_b16 v[54:55], v13 offset:1536
  ds_read_b64_tr_b16 v[56:57], v12 offset:768
  ds_read_b64_tr_b16 v[58:59], v12 offset:1792
  ds_read_b64_tr_b16 v[60:61], v13 offset:768
  ds_read_b64_tr_b16 v[62:63], v13 offset:1792
  s_waitcnt lgkmcnt(0)
.p2align 6
fa_loopK:
  v_mfma_f32_16x16x32_bf16 a[0:3], v[32:35], v[96:99], a[0:3]
  s_waitcnt vmcnt(17)
  v_mfma_f32_16x16x32_bf16 a[4:7], v[32:35], v[100:103], a[4:7]
  s_barrier
  v_mfma_f32_16x16x32_bf16 a[8:11], v[32:35], v[104:107], a[8:11]
  s_bitcmp1_b32 s72, s28
  ds_read_b64_tr_b16 v[64:65], v12 offset:32768
  v_mfma_f32_16x16x32_bf16 a[12:15], v[32:35], v[108:111], a[12:15]
  s_cbranch_scc1 fa_p1stubK
fa_p1backK:
  v_mfma_f32_16x16x32_bf16 a[16:19], v[32:35], v[112:115], a[16:19]
  s_mov_b32 m0, s24
  ds_read_b64_tr_b16 v[66:67], v12 offset:33792
  v_mfma_f32_16x16x32_bf16 a[20:23], v[32:35], v[116:119], a[20:23]
  buffer_load_dwordx4 v224, s[32:35], s26 offen offset:0 lds
  v_mfma_f32_16x16x32_bf16 a[24:27], v[32:35], v[120:123], a[24:27]
  ds_read_b128 v[128:131], v14 offset:32768
  v_mfma_f32_16x16x32_bf16 a[28:31], v[32:35], v[124:127], a[28:31]
  buffer_load_dwordx4 v225, s[32:35], s26 offen offset:1024 lds
  v_mfma_f32_16x16x32_bf16 a[32:35], v[36:39], v[96:99], a[32:35]
  ds_read_b64_tr_b16 v[68:69], v13 offset:32768
  v_mfma_f32_16x16x32_bf16 a[36:39], v[36:39], v[100:103], a[36:39]
  buffer_load_dwordx4 v226, s[32:35], s26 offen offset:2048 lds
  v_mfma_f32_16x16x32_bf16 a[40:43], v[36:39], v[104:107], a[40:43]
  ds_read_b64_tr_b16 v[70:71], v13 offset:33792
  v_mfma_f32_16x16x32_bf16 a[44:47], v[36:39], v[108:111], a[44:47]
  buffer_load_dwordx4 v227, s[32:35], s26 offen offset:3072 lds
  v_mfma_f32_16x16x32_bf16 a[48:51], v[36:39], v[112:115], a[48:51]
  s_add_u32 m0, s24, 16384
  ds_read_b128 v[132:135], v14 offset:33792
  v_mfma_f32_16x16x32_bf16 a[52:55], v[36:39], v[116:119], a[52:55]
  buffer_load_dwordx4 v8, s[36:39], s27 offen offset:0 lds
  v_mfma_f32_16x16x32_bf16 a[56:59], v[36:39], v[120:123], a[56:59]
  ds_read_b64_tr_b16 v[72:73], v12 offset:33024
  v_mfma_f32_16x16x32_bf16 a[60:63], v[36:39], v[124:127], a[60:63]
  buffer_load_dwordx4 v9, s[36:39], s27 offen offset:1024 lds
  v_mfma_f32_16x16x32_bf16 a[64:67], v[40:43], v[96:99], a[64:67]
  ds_read_b64_tr_b16 v[74:75], v12 offset:34048
  v_mfma_f32_16x16x32_bf16 a[68:71], v[40:43], v[100:103], a[68:71]
  buffer_load_dwordx4 v10, s[36:39], s27 offen offset:2048 lds
  v_mfma_f32_16x16x32_bf16 a[72:75], v[40:43], v[104:107], a[72:75]
  ds_read_b128 v[136:139], v14 offset:34816
  v_mfma_f32_16x16x32_bf16 a[76:79], v[40:43], v[108:111], a[76:79]
  buffer_load_dwordx4 v11, s[36:39], s27 offen offset:3072 lds
  v_mfma_f32_16x16x32_bf16 a[80:83], v[40:43], v[112:115], a[80:83]
  ds_read_b64_tr_b16 v[76:77], v13 offset:33024
  v_mfma_f32_16x16x32_bf16 a[84:87], v[40:43], v[116:119], a[84:87]
  buffer_load_dword v231, v235, s[48:51], s74 offen
  v_mfma_f32_16x16x32_bf16 a[88:91], v[40:43], v[120:123], a[88:91]
  s_add_u32 s74, s74, s73
  ds_read_b64_tr_b16 v[78:79], v13 offset:34048
  v_mfma_f32_16x16x32_bf16 a[92:95], v[40:43], v[124:127], a[92:95]
  v_mfma_f32_16x16x32_bf16 a[96:99], v[44:47], v[96:99], a[96:99]
  ds_read_b128 v[140:143], v14 offset:35840
  v_mfma_f32_16x16x32_bf16 a[100:103], v[44:47], v[100:103], a[100:103]
  v_mfma_f32_16x16x32_bf16 a[104:107], v[44:47], v[104:107], a[104:107]
  ds_read_b64_tr_b16 v[80:81], v12 offset:33280
  v_mfma_f32_16x16x32_bf16 a[108:111], v[44:47], v[108:111], a[108:111]
  v_mfma_f32_16x16x32_bf16 a[112:115], v[44:47], v[112:115], a[112:115]
  ds_read_b64_tr_b16 v[82:83], v12 offset:34304
  v_mfma_f32_16x16x32_bf16 a[116:119], v[44:47], v[116:119], a[116:119]
  v_mfma_f32_16x16x32_bf16 a[120:123], v[44:47], v[120:123], a[120:123]
  ds_read_b128 v[144:147], v14 offset:36864
  v_mfma_f32_16x16x32_bf16 a[124:127], v[44:47], v[124:127], a[124:127]
  v_mfma_f32_16x16x32_bf16 a[128:131], v[48:51], v[96:99], a[128:131]
  ds_read_b64_tr_b16 v[84:85], v13 offset:33280
  v_mfma_f32_16x16x32_bf16 a[132:135], v[48:51], v[100:103], a[132:135]
  v_mfma_f32_16x16x32_bf16 a[136:139], v[48:51], v[104:107], a[136:139]
  ds_read_b64_tr_b16 v[86:87], v13 offset:34304
  v_mfma_f32_16x16x32_bf16 a[140:143], v[48:51], v[108:111], a[140:143]
  v_mfma_f32_16x16x32_bf16 a[144:147], v[48:51], v[112:115], a[144:147]
  ds_read_b128 v[148:151], v14 offset:37888
  v_mfma_f32_16x16x32_bf16 a[148:151], v[48:51], v[116:119], a[148:151]
  v_mfma_f32_16x16x32_bf16 a[152:155], v[48:51], v[120:123], a[152:155]
  ds_read_b64_tr_b16 v[88:89], v12 offset:33536
  v_mfma_f32_16x16x32_bf16 a[156:159], v[48:51], v[124:127], a[156:159]
  v_mfma_f32_16x16x32_bf16 a[160:163], v[52:55], v[96:99], a[160:163]
  ds_read_b64_tr_b16 v[90:91], v12 offset:34560
  v_mfma_f32_16x16x32_bf16 a[164:167], v[52:55], v[100:103], a[164:167]
  v_mfma_f32_16x16x32_bf16 a[168:171], v[52:55], v[104:107], a[168:171]
  ds_read_b128 v[152:155], v14 offset:38912
  v_mfma_f32_16x16x32_bf16 a[172:175], v[52:55], v[108:111], a[172:175]
  v_mfma_f32_16x16x32_bf16 a[176:179], v[52:55], v[112:115], a[176:179]
  ds_read_b64_tr_b16 v[92:93], v13 offset:33536
  v_mfma_f32_16x16x32_bf16 a[180:183], v[52:55], v[116:119], a[180:183]
  v_mfma_f32_16x16x32_bf16 a[184:187], v[52:55], v[120:123], a[184:187]
  ds_read_b64_tr_b16 v[94:95], v13 offset:34560
  v_mfma_f32_16x16x32_bf16 a[188:191], v[52:55], v[124:127], a[188:191]
  v_mfma_f32_16x16x32_bf16 a[192:195], v[56:59], v[96:99], a[192:195]
  s_add_u32 s26, s26, 64
  ds_read_b128 v[156:159], v14 offset:39936
  v_mfma_f32_16x16x32_bf16 a[196:199], v[56:59], v[100:103], a[196:199]
  s_add_u32 s27, s27, s25
  v_mfma_f32_16x16x32_bf16 a[200:203], v[56:59], v[104:107], a[200:203]
  s_add_u32 s24, s24, 32768
  v_mfma_f32_16x16x32_bf16 a[204:207], v[56:59], v[108:111], a[204:207]
  s_and_b32 s24, s24, 0x1ffff
  v_mfma_f32_16x16x32_bf16 a[208:211], v[56:59], v[112:115], a[208:211]
  v_xor_b32 v14, 0x10000, v14
  v_mfma_f32_16x16x32_bf16 a[212:215], v[56:59], v[116:119], a[212:215]
  v_xor_b32 v12, 0x10000, v12
  v_mfma_f32_16x16x32_bf16 a[216:219], v[56:59], v[120:123], a[216:219]
  v_xor_b32 v13, 0x10000, v13
  v_mfma_f32_16x16x32_bf16 a[220:223], v[56:59], v[124:127], a[220:223]
  v_mfma_f32_16x16x32_bf16 a[224:227], v[60:63], v[96:99], a[224:227]
  v_mfma_f32_16x16x32_bf16 a[228:231], v[60:63], v[100:103], a[228:231]
  v_mfma_f32_16x16x32_bf16 a[232:235], v[60:63], v[104:107], a[232:235]
  v_mfma_f32_16x16x32_bf16 a[236:239], v[60:63], v[108:111], a[236:239]
  v_mfma_f32_16x16x32_bf16 a[240:243], v[60:63], v[112:115], a[240:243]
  v_mfma_f32_16x16x32_bf16 a[244:247], v[60:63], v[116:119], a[244:247]
  v_mfma_f32_16x16x32_bf16 a[248:251], v[60:63], v[120:123], a[248:251]
  v_mfma_f32_16x16x32_bf16 a[252:255], v[60:63], v[124:127], a[252:255]
  s_waitcnt lgkmcnt(0)
  v_mfma_f32_16x16x32_bf16 a[0:3], v[64:67], v[128:131], a[0:3]
  s_waitcnt vmcnt(18)
  v_mfma_f32_16x16x32_bf16 a[4:7], v[64:67], v[132:135], a[4:7]
  s_barrier
  v_mfma_f32_16x16x32_bf16 a[8:11], v[64:67], v[136:139], a[8:11]
  ds_read_b64_tr_b16 v[32:33], v12 offset:0
  v_mfma_f32_16x16x32_bf16 a[12:15], v[64:67], v[140:143], a[12:15]
  v_mfma_f32_16x16x32_bf16 a[16:19], v[64:67], v[144:147], a[16:19]
  s_mov_b32 m0, s24
  ds_read_b64_tr_b16 v[34:35], v12 offset:1024
  v_mfma_f32_16x16x32_bf16 a[20:23], v[64:67], v[148:151], a[20:23]
  buffer_load_dwordx4 v224, s[32:35], s26 offen offset:0 lds
  v_mfma_f32_16x16x32_bf16 a[24:27], v[64:67], v[152:155], a[24:27]
  ds_read_b128 v[96:99], v14 offset:0
  v_mfma_f32_16x16x32_bf16 a[28:31], v[64:67], v[156:159], a[28:31]
  v_mfma_f32_16x16x32_bf16 a[32:35], v[68:71], v[128:131], a[32:35]
  ds_read_b64_tr_b16 v[36:37], v13 offset:0
  v_mfma_f32_16x16x32_bf16 a[36:39], v[68:71], v[132:135], a[36:39]
  v_mfma_f32_16x16x32_bf16 a[40:43], v[68:71], v[136:139], a[40:43]
  ds_read_b64_tr_b16 v[38:39], v13 offset:1024
  v_mfma_f32_16x16x32_bf16 a[44:47], v[68:71], v[140:143], a[44:47]
  buffer_load_dwordx4 v225, s[32:35], s26 offen offset:1024 lds
  v_mfma_f32_16x16x32_bf16 a[48:51], v[68:71], v[144:147], a[48:51]
  ds_read_b128 v[100:103], v14 offset:1024
  v_mfma_f32_16x16x32_bf16 a[52:55], v[68:71], v[148:151], a[52:55]
  v_mfma_f32_16x16x32_bf16 a[56:59], v[68:71], v[152:155], a[56:59]
  ds_read_b64_tr_b16 v[40:41], v12 offset:256
  v_mfma_f32_16x16x32_bf16 a[60:63], v[68:71], v[156:159], a[60:63]
  v_mfma_f32_16x16x32_bf16 a[64:67], v[72:75], v[128:131], a[64:67]
  ds_read_b64_tr_b16 v[42:43], v12 offset:1280
  v_mfma_f32_16x16x32_bf16 a[68:71], v[72:75], v[132:135], a[68:71]
  buffer_load_dwordx4 v226, s[32:35], s26 offen offset:2048 lds
  v_mfma_f32_16x16x32_bf16 a[72:75], v[72:75], v[136:139], a[72:75]
  ds_read_b128 v[104:107], v14 offset:2048
  v_mfma_f32_16x16x32_bf16 a[76:79], v[72:75], v[140:143], a[76:79]
  v_mfma_f32_16x16x32_bf16 a[80:83], v[72:75], v[144:147], a[80:83]
  ds_read_b64_tr_b16 v[44:45], v13 offset:256
  v_mfma_f32_16x16x32_bf16 a[84:87], v[72:75], v[148:151], a[84:87]
  v_mfma_f32_16x16x32_bf16 a[88:91], v[72:75], v[152:155], a[88:91]
  ds_read_b64_tr_b16 v[46:47], v13 offset:1280
  v_mfma_f32_16x16x32_bf16 a[92:95], v[72:75], v[156:159], a[92:95]
  buffer_load_dwordx4 v227, s[32:35], s26 offen offset:3072 lds
  v_mfma_f32_16x16x32_bf16 a[96:99], v[76:79], v[128:131], a[96:99]
  ds_read_b128 v[108:111], v14 offset:3072
  v_mfma_f32_16x16x32_bf16 a[100:103], v[76:79], v[132:135], a[100:103]
  v_mfma_f32_16x16x32_bf16 a[104:107], v[76:79], v[136:139], a[104:107]
  ds_read_b64_tr_b16 v[48:49], v12 offset:512
  v_mfma_f32_16x16x32_bf16 a[108:111], v[76:79], v[140:143], a[108:111]
  v_mfma_f32_16x16x32_bf16 a[112:115], v[76:79], v[144:147], a[112:115]
  s_add_u32 m0, s24, 16384
  ds_read_b64_tr_b16 v[50:51], v12 offset:1536
  v_mfma_f32_16x16x32_bf16 a[116:119], v[76:79], v[148:151], a[116:119]
  buffer_load_dwordx4 v8, s[36:39], s27 offen offset:0 lds
  v_mfma_f32_16x16x32_bf16 a[120:123], v[76:79], v[152:155], a[120:123]
  ds_read_b128 v[112:115], v14 offset:4096
  v_mfma_f32_16x16x32_bf16 a[124:127], v[76:79], v[156:159], a[124:127]
  v_mfma_f32_16x16x32_bf16 a[128:131], v[80:83], v[128:131], a[128:131]
  ds_read_b64_tr_b16 v[52:53], v13 offset:512
  v_mfma_f32_16x16x32_bf16 a[132:135], v[80:83], v[132:135], a[132:135]
  v_mfma_f32_16x16x32_bf16 a[136:139], v[80:83], v[136:139], a[136:139]
  ds_read_b64_tr_b16 v[54:55], v13 offset:1536
  v_mfma_f32_16x16x32_bf16 a[140:143], v[80:83], v[140:143], a[140:143]
  buffer_load_dwordx4 v9, s[36:39], s27 offen offset:1024 lds
  v_mfma_f32_16x16x32_bf16 a[144:147], v[80:83], v[144:147], a[144:147]
  ds_read_b128 v[116:119], v14 offset:5120
  v_mfma_f32_16x16x32_bf16 a[148:151], v[80:83], v[148:151], a[148:151]
  v_mfma_f32_16x16x32_bf16 a[152:155], v[80:83], v[152:155], a[152:155]
  ds_read_b64_tr_b16 v[56:57], v12 offset:768
  v_mfma_f32_16x16x32_bf16 a[156:159], v[80:83], v[156:159], a[156:159]
  v_mfma_f32_16x16x32_bf16 a[160:163], v[84:87], v[128:131], a[160:163]
  ds_read_b64_tr_b16 v[58:59], v12 offset:1792
  v_mfma_f32_16x16x32_bf16 a[164:167], v[84:87], v[132:135], a[164:167]
  buffer_load_dwordx4 v10, s[36:39], s27 offen offset:2048 lds
  v_mfma_f32_16x16x32_bf16 a[168:171], v[84:87], v[136:139], a[168:171]
  ds_read_b128 v[120:123], v14 offset:6144
  v_mfma_f32_16x16x32_bf16 a[172:175], v[84:87], v[140:143], a[172:175]
  v_mfma_f32_16x16x32_bf16 a[176:179], v[84:87], v[144:147], a[176:179]
  ds_read_b64_tr_b16 v[60:61], v13 offset:768
  v_mfma_f32_16x16x32_bf16 a[180:183], v[84:87], v[148:151], a[180:183]
  v_mfma_f32_16x16x32_bf16 a[184:187], v[84:87], v[152:155], a[184:187]
  ds_read_b64_tr_b16 v[62:63], v13 offset:1792
  v_mfma_f32_16x16x32_bf16 a[188:191], v[84:87], v[156:159], a[188:191]
  buffer_load_dwordx4 v11, s[36:39], s27 offen offset:3072 lds
  v_mfma_f32_16x16x32_bf16 a[192:195], v[88:91], v[128:131], a[192:195]
  s_add_u32 s26, s26, 64
  ds_read_b128 v[124:127], v14 offset:7168
  v_mfma_f32_16x16x32_bf16 a[196:199], v[88:91], v[132:135], a[196:199]
  s_add_u32 s27, s27, s25
  v_mfma_f32_16x16x32_bf16 a[200:203], v[88:91], v[136:139], a[200:203]
  s_add_u32 s24, s24, 32768
  v_mfma_f32_16x16x32_bf16 a[204:207], v[88:91], v[140:143], a[204:207]
  s_and_b32 s24, s24, 0x1ffff
  v_mfma_f32_16x16x32_bf16 a[208:211], v[88:91], v[144:147], a[208:211]
  v_mfma_f32_16x16x32_bf16 a[212:215], v[88:91], v[148:151], a[212:215]
  v_mfma_f32_16x16x32_bf16 a[216:219], v[88:91], v[152:155], a[216:219]
  s_add_u32 s28, s28, 1
  v_mfma_f32_16x16x32_bf16 a[220:223], v[88:91], v[156:159], a[220:223]
  v_mfma_f32_16x16x32_bf16 a[224:227], v[92:95], v[128:131], a[224:227]
  v_mfma_f32_16x16x32_bf16 a[228:231], v[92:95], v[132:135], a[228:231]
  v_mfma_f32_16x16x32_bf16 a[232:235], v[92:95], v[136:139], a[232:235]
  v_mfma_f32_16x16x32_bf16 a[236:239], v[92:95], v[140:143], a[236:239]
  v_mfma_f32_16x16x32_bf16 a[240:243], v[92:95], v[144:147], a[240:243]
  v_mfma_f32_16x16x32_bf16 a[244:247], v[92:95], v[148:151], a[244:247]
  s_cmp_lt_u32 s28, 8
  v_mfma_f32_16x16x32_bf16 a[248:251], v[92:95], v[152:155], a[248:251]
  s_waitcnt lgkmcnt(0)
  v_mfma_f32_16x16x32_bf16 a[252:255], v[92:95], v[156:159], a[252:255]
  s_cbranch_scc1 fa_loopK
  s_mov_b32 s60, 2048
  s_mov_b32 s61, 8192
  s_mov_b32 s62, 16777216
  s_branch fa_p1epi
fa_roleV:
  ds_read_b128 v[32:35], v14 offset:0
  ds_read_b128 v[36:39], v14 offset:1024
  ds_read_b128 v[40:43], v14 offset:2048
  ds_read_b128 v[44:47], v14 offset:3072
  ds_read_b128 v[48:51], v14 offset:4096
  ds_read_b128 v[52:55], v14 offset:5120
  ds_read_b128 v[56:59], v14 offset:6144
  ds_read_b128 v[60:63], v14 offset:7168
  ds_read_b64_tr_b16 v[96:97], v12 offset:0
  ds_read_b64_tr_b16 v[98:99], v12 offset:1024
  ds_read_b64_tr_b16 v[100:101], v13 offset:0
  ds_read_b64_tr_b16 v[102:103], v13 offset:1024
  ds_read_b64_tr_b16 v[104:105], v12 offset:256
  ds_read_b64_tr_b16 v[106:107], v12 offset:1280
  ds_read_b64_tr_b16 v[108:109], v13 offset:256
  ds_read_b64_tr_b16 v[110:111], v13 offset:1280
  ds_read_b64_tr_b16 v[112:113], v12 offset:512
  ds_read_b64_tr_b16 v[114:115], v12 offset:1536
  ds_read_b64_tr_b16 v[116:117], v13 offset:512
  ds_read_b64_tr_b16 v[118:119], v13 offset:1536
  ds_read_b64_tr_b16 v[120:121], v12 offset:768
  ds_read_b64_tr_b16 v[122:123], v12 offset:1792
  ds_read_b64_tr_b16 v[124:125], v13 offset:768
  ds_read_b64_tr_b16 v[126:127], v13 offset:1792
  s_waitcnt lgkmcnt(0)
.p2align 6
fa_loopV:
  v_mfma_f32_16x16x32_bf16 a[0:3], v[32:35], v[96:99], a[0:3]
  s_waitcnt vmcnt(17)
  v_mfma_f32_16x16x32_bf16 a[4:7], v[32:35], v[100:103], a[4:7]
  s_barrier
  v_mfma_f32_16x16x32_bf16 a[8:11], v[32:35], v[104:107], a[8:11]
  s_bitcmp1_b32 s72, s28
  ds_read_b64_tr_b16 v[128:129], v12 offset:32768
  v_mfma_f32_16x16x32_bf16 a[12:15], v[32:35], v[108:111], a[12:15]
  s_cbranch_scc1 fa_p1stubV
fa_p1backV:
  v_mfma_f32_16x16x32_bf16 a[16:19], v[32:35], v[112:115], a[16:19]
  s_mov_b32 m0, s24
  ds_read_b64_tr_b16 v[130:131], v12 offset:33792
  v_mfma_f32_16x16x32_bf16 a[20:23], v[32:35], v[116:119], a[20:23]
  buffer_load_dwordx4 v224, s[32:35], s26 offen offset:0 lds
  v_mfma_f32_16x16x32_bf16 a[24:27], v[32:35], v[120:123], a[24:27]
  ds_read_b128 v[64:67], v14 offset:32768
  v_mfma_f32_16x16x32_bf16 a[28:31], v[32:35], v[124:127], a[28:31]
  buffer_load_dwordx4 v225, s[32:35], s26 offen offset:1024 lds
  v_mfma_f32_16x16x32_bf16 a[32:35], v[36:39], v[96:99], a[32:35]
  ds_read_b64_tr_b16 v[132:133], v13 offset:32768
  v_mfma_f32_16x16x32_bf16 a[36:39], v[36:39], v[100:103], a[36:39]
  buffer_load_dwordx4 v226, s[32:35], s26 offen offset:2048 lds
  v_mfma_f32_16x16x32_bf16 a[40:43], v[36:39], v[104:107], a[40:43]
  ds_read_b64_tr_b16 v[134:135], v13 offset:33792
  v_mfma_f32_16x16x32_bf16 a[44:47], v[36:39], v[108:111], a[44:47]
  buffer_load_dwordx4 v227, s[32:35], s26 offen offset:3072 lds
  v_mfma_f32_16x16x32_bf16 a[48:51], v[36:39], v[112:115], a[48:51]
  s_add_u32 m0, s24, 16384
  ds_read_b128 v[68:71], v14 offset:33792
  v_mfma_f32_16x16x32_bf16 a[52:55], v[36:39], v[116:119], a[52:55]
  buffer_load_dwordx4 v8, s[36:39], s27 offen offset:0 lds
  v_mfma_f32_16x16x32_bf16 a[56:59], v[36:39], v[120:123], a[56:59]
  ds_read_b64_tr_b16 v[136:137], v12 offset:33024
  v_mfma_f32_16x16x32_bf16 a[60:63], v[36:39], v[124:127], a[60:63]
  buffer_load_dwordx4 v9, s[36:39], s27 offen offset:1024 lds
  v_mfma_f32_16x16x32_bf16 a[64:67], v[40:43], v[96:99], a[64:67]
  ds_read_b64_tr_b16 v[138:139], v12 offset:34048
  v_mfma_f32_16x16x32_bf16 a[68:71], v[40:43], v[100:103], a[68:71]
  buffer_load_dwordx4 v10, s[36:39], s27 offen offset:2048 lds
  v_mfma_f32_16x16x32_bf16 a[72:75], v[40:43], v[104:107], a[72:75]
  ds_read_b128 v[72:75], v14 offset:34816
  v_mfma_f32_16x16x32_bf16 a[76:79], v[40:43], v[108:111], a[76:79]
  buffer_load_dwordx4 v11, s[36:39], s27 offen offset:3072 lds
  v_mfma_f32_16x16x32_bf16 a[80:83], v[40:43], v[112:115], a[80:83]
  ds_read_b64_tr_b16 v[140:141], v13 offset:33024
  v_mfma_f32_16x16x32_bf16 a[84:87], v[40:43], v[116:119], a[84:87]
  buffer_load_dword v231, v235, s[48:51], s74 offen
  v_mfma_f32_16x16x32_bf16 a[88:91], v[40:43], v[120:123], a[88:91]
  s_add_u32 s74, s74, s73
  ds_read_b64_tr_b16 v[142:143], v13 offset:34048
  v_mfma_f32_16x16x32_bf16 a[92:95], v[40:43], v[124:127], a[92:95]
  v_mfma_f32_16x16x32_bf16 a[96:99], v[44:47], v[96:99], a[96:99]
  ds_read_b128 v[76:79], v14 offset:35840
  v_mfma_f32_16x16x32_bf16 a[100:103], v[44:47], v[100:103], a[100:103]
  v_mfma_f32_16x16x32_bf16 a[104:107], v[44:47], v[104:107], a[104:107]
  ds_read_b64_tr_b16 v[144:145], v12 offset:33280
  v_mfma_f32_16x16x32_bf16 a[108:111], v[44:47], v[108:111], a[108:111]
  v_mfma_f32_16x16x32_bf16 a[112:115], v[44:47], v[112:115], a[112:115]
  ds_read_b64_tr_b16 v[146:147], v12 offset:34304
  v_mfma_f32_16x16x32_bf16 a[116:119], v[44:47], v[116:119], a[116:119]
  v_mfma_f32_16x16x32_bf16 a[120:123], v[44:47], v[120:123], a[120:123]
  ds_read_b128 v[80:83], v14 offset:36864
  v_mfma_f32_16x16x32_bf16 a[124:127], v[44:47], v[124:127], a[124:127]
  v_mfma_f32_16x16x32_bf16 a[128:131], v[48:51], v[96:99], a[128:131]
  ds_read_b64_tr_b16 v[148:149], v13 offset:33280
  v_mfma_f32_16x16x32_bf16 a[132:135], v[48:51], v[100:103], a[132:135]
  v_mfma_f32_16x16x32_bf16 a[136:139], v[48:51], v[104:107], a[136:139]
  ds_read_b64_tr_b16 v[150:151], v13 offset:34304
  v_mfma_f32_16x16x32_bf16 a[140:143], v[48:51], v[108:111], a[140:143]
  v_mfma_f32_16x16x32_bf16 a[144:147], v[48:51], v[112:115], a[144:147]
  ds_read_b128 v[84:87], v14 offset:37888
  v_mfma_f32_16x16x32_bf16 a[148:151], v[48:51], v[116:119], a[148:151]
  v_mfma_f32_16x16x32_bf16 a[152:155], v[48:51], v[120:123], a[152:155]
  ds_read_b64_tr_b16 v[152:153], v12 offset:33536
  v_mfma_f32_16x16x32_bf16 a[156:159], v[48:51], v[124:127], a[156:159]
  v_mfma_f32_16x16x32_bf16 a[160:163], v[52:55], v[96:99], a[160:163]
  ds_read_b64_tr_b16 v[154:155], v12 offset:34560
  v_mfma_f32_16x16x32_bf16 a[164:167], v[52:55], v[100:103], a[164:167]
  v_mfma_f32_16x16x32_bf16 a[168:171], v[52:55], v[104:107], a[168:171]
  ds_read_b128 v[88:91], v14 offset:38912
  v_mfma_f32_16x16x32_bf16 a[172:175], v[52:55], v[108:111], a[172:175]
  v_mfma_f32_16x16x32_bf16 a[176:179], v[52:55], v[112:115], a[176:179]
  ds_read_b64_tr_b16 v[156:157], v13 offset:33536
  v_mfma_f32_16x16x32_bf16 a[180:183], v[52:55], v[116:119], a[180:183]
  v_mfma_f32_16x16x32_bf16 a[184:187], v[52:55], v[120:123], a[184:187]
  ds_read_b64_tr_b16 v[158:159], v13 offset:34560
  v_mfma_f32_16x16x32_bf16 a[188:191], v[52:55], v[124:127], a[188:191]
  v_mfma_f32_16x16x32_bf16 a[192:195], v[56:59], v[96:99], a[192:195]
  s_add_u32 s26, s26, 64
  ds_read_b128 v[92:95], v14 offset:39936
  v_mfma_f32_16x16x32_bf16 a[196:199], v[56:59], v[100:103], a[196:199]
  s_add_u32 s27, s27, s25
  v_mfma_f32_16x16x32_bf16 a[200:203], v[56:59], v[104:107], a[200:203]
  s_add_u32 s24, s24, 32768
  v_mfma_f32_16x16x32_bf16 a[204:207], v[56:59], v[108:111], a[204:207]
  s_and_b32 s24, s24, 0x1ffff
  v_mfma_f32_16x16x32_bf16 a[208:211], v[56:59], v[112:115], a[208:211]
  v_xor_b32 v14, 0x10000, v14
  v_mfma_f32_16x16x32_bf16 a[212:215], v[56:59], v[116:119], a[212:215]
  v_xor_b32 v12, 0x10000, v12
  v_mfma_f32_16x16x32_bf16 a[216:219], v[56:59], v[120:123], a[216:219]
  v_xor_b32 v13, 0x10000, v13
  v_mfma_f32_16x16x32_bf16 a[220:223], v[56:59], v[124:127], a[220:223]
  v_mfma_f32_16x16x32_bf16 a[224:227], v[60:63], v[96:99], a[224:227]
  v_mfma_f32_16x16x32_bf16 a[228:231], v[60:63], v[100:103], a[228:231]
  v_mfma_f32_16x16x32_bf16 a[232:235], v[60:63], v[104:107], a[232:235]
  v_mfma_f32_16x16x32_bf16 a[236:239], v[60:63], v[108:111], a[236:239]
  v_mfma_f32_16x16x32_bf16 a[240:243], v[60:63], v[112:115], a[240:243]
  v_mfma_f32_16x16x32_bf16 a[244:247], v[60:63], v[116:119], a[244:247]
  v_mfma_f32_16x16x32_bf16 a[248:251], v[60:63], v[120:123], a[248:251]
  v_mfma_f32_16x16x32_bf16 a[252:255], v[60:63], v[124:127], a[252:255]
  s_waitcnt lgkmcnt(0)
  v_mfma_f32_16x16x32_bf16 a[0:3], v[64:67], v[128:131], a[0:3]
  s_waitcnt vmcnt(18)
  v_mfma_f32_16x16x32_bf16 a[4:7], v[64:67], v[132:135], a[4:7]
  s_barrier
  v_mfma_f32_16x16x32_bf16 a[8:11], v[64:67], v[136:139], a[8:11]
  ds_read_b64_tr_b16 v[96:97], v12 offset:0
  v_mfma_f32_16x16x32_bf16 a[12:15], v[64:67], v[140:143], a[12:15]
  v_mfma_f32_16x16x32_bf16 a[16:19], v[64:67], v[144:147], a[16:19]
  s_mov_b32 m0, s24
  ds_read_b64_tr_b16 v[98:99], v12 offset:1024
  v_mfma_f32_16x16x32_bf16 a[20:23], v[64:67], v[148:151], a[20:23]
  buffer_load_dwordx4 v224, s[32:35], s26 offen offset:0 lds
  v_mfma_f32_16x16x32_bf16 a[24:27], v[64:67], v[152:155], a[24:27]
  ds_read_b128 v[32:35], v14 offset:0
  v_mfma_f32_16x16x32_bf16 a[28:31], v[64:67], v[156:159], a[28:31]
  v_mfma_f32_16x16x32_bf16 a[32:35], v[68:71], v[128:131], a[32:35]
  ds_read_b64_tr_b16 v[100:101], v13 offset:0
  v_mfma_f32_16x16x32_bf16 a[36:39], v[68:71], v[132:135], a[36:39]
  v_mfma_f32_16x16x32_bf16 a[40:43], v[68:71], v[136:139], a[40:43]
  ds_read_b64_tr_b16 v[102:103], v13 offset:1024
  v_mfma_f32_16x16x32_bf16 a[44:47], v[68:71], v[140:143], a[44:47]
  buffer_load_dwordx4 v225, s[32:35], s26 offen offset:1024 lds
  v_mfma_f32_16x16x32_bf16 a[48:51], v[68:71], v[144:147], a[48:51]
  ds_read_b128 v[36:39], v14 offset:1024
  v_mfma_f32_16x16x32_bf16 a[52:55], v[68:71], v[148:151], a[52:55]
  v_mfma_f32_16x16x32_bf16 a[56:59], v[68:71], v[152:155], a[56:59]
  ds_read_b64_tr_b16 v[104:105], v12 offset:256
  v_mfma_f32_16x16x32_bf16 a[60:63], v[68:71], v[156:159], a[60:63]
  v_mfma_f32_16x16x32_bf16 a[64:67], v[72:75], v[128:131], a[64:67]
  ds_read_b64_tr_b16 v[106:107], v12 offset:1280
  v_mfma_f32_16x16x32_bf16 a[68:71], v[72:75], v[132:135], a[68:71]
  buffer_load_dwordx4 v226, s[32:35], s26 offen offset:2048 lds
  v_mfma_f32_16x16x32_bf16 a[72:75], v[72:75], v[136:139], a[72:75]
  ds_read_b128 v[40:43], v14 offset:2048
  v_mfma_f32_16x16x32_bf16 a[76:79], v[72:75], v[140:143], a[76:79]
  v_mfma_f32_16x16x32_bf16 a[80:83], v[72:75], v[144:147], a[80:83]
  ds_read_b64_tr_b16 v[108:109], v13 offset:256
  v_mfma_f32_16x16x32_bf16 a[84:87], v[72:75], v[148:151], a[84:87]
  v_mfma_f32_16x16x32_bf16 a[88:91], v[72:75], v[152:155], a[88:91]
  ds_read_b64_tr_b16 v[110:111], v13 offset:1280
  v_mfma_f32_16x16x32_bf16 a[92:95], v[72:75], v[156:159], a[92:95]
  buffer_load_dwordx4 v227, s[32:35], s26 offen offset:3072 lds
  v_mfma_f32_16x16x32_bf16 a[96:99], v[76:79], v[128:131], a[96:99]
  ds_read_b128 v[44:47], v14 offset:3072
  v_mfma_f32_16x16x32_bf16 a[100:103], v[76:79], v[132:135], a[100:103]
  v_mfma_f32_16x16x32_bf16 a[104:107], v[76:79], v[136:139], a[104:107]
  ds_read_b64_tr_b16 v[112:113], v12 offset:512
  v_mfma_f32_16x16x32_bf16 a[108:111], v[76:79], v[140:143], a[108:111]
  v_mfma_f32_16x16x32_bf16 a[112:115], v[76:79], v[144:147], a[112:115]
  s_add_u32 m0, s24, 16384
  ds_read_b64_tr_b16 v[114:115], v12 offset:1536
  v_mfma_f32_16x16x32_bf16 a[116:119], v[76:79], v[148:151], a[116:119]
  buffer_load_dwordx4 v8, s[36:39], s27 offen offset:0 lds
  v_mfma_f32_16x16x32_bf16 a[120:123], v[76:79], v[152:155], a[120:123]
  ds_read_b128 v[48:51], v14 offset:4096
  v_mfma_f32_16x16x32_bf16 a[124:127], v[76:79], v[156:159], a[124:127]
  v_mfma_f32_16x16x32_bf16 a[128:131], v[80:83], v[128:131], a[128:131]
  ds_read_b64_tr_b16 v[116:117], v13 offset:512
  v_mfma_f32_16x16x32_bf16 a[132:135], v[80:83], v[132:135], a[132:135]
  v_mfma_f32_16x16x32_bf16 a[136:139], v[80:83], v[136:139], a[136:139]
  ds_read_b64_tr_b16 v[118:119], v13 offset:1536
  v_mfma_f32_16x16x32_bf16 a[140:143], v[80:83], v[140:143], a[140:143]
  buffer_load_dwordx4 v9, s[36:39], s27 offen offset:1024 lds
  v_mfma_f32_16x16x32_bf16 a[144:147], v[80:83], v[144:147], a[144:147]
  ds_read_b128 v[52:55], v14 offset:5120
  v_mfma_f32_16x16x32_bf16 a[148:151], v[80:83], v[148:151], a[148:151]
  v_mfma_f32_16x16x32_bf16 a[152:155], v[80:83], v[152:155], a[152:155]
  ds_read_b64_tr_b16 v[120:121], v12 offset:768
  v_mfma_f32_16x16x32_bf16 a[156:159], v[80:83], v[156:159], a[156:159]
  v_mfma_f32_16x16x32_bf16 a[160:163], v[84:87], v[128:131], a[160:163]
  ds_read_b64_tr_b16 v[122:123], v12 offset:1792
  v_mfma_f32_16x16x32_bf16 a[164:167], v[84:87], v[132:135], a[164:167]
  buffer_load_dwordx4 v10, s[36:39], s27 offen offset:2048 lds
  v_mfma_f32_16x16x32_bf16 a[168:171], v[84:87], v[136:139], a[168:171]
  ds_read_b128 v[56:59], v14 offset:6144
  v_mfma_f32_16x16x32_bf16 a[172:175], v[84:87], v[140:143], a[172:175]
  v_mfma_f32_16x16x32_bf16 a[176:179], v[84:87], v[144:147], a[176:179]
  ds_read_b64_tr_b16 v[124:125], v13 offset:768
  v_mfma_f32_16x16x32_bf16 a[180:183], v[84:87], v[148:151], a[180:183]
  v_mfma_f32_16x16x32_bf16 a[184:187], v[84:87], v[152:155], a[184:187]
  ds_read_b64_tr_b16 v[126:127], v13 offset:1792
  v_mfma_f32_16x16x32_bf16 a[188:191], v[84:87], v[156:159], a[188:191]
  buffer_load_dwordx4 v11, s[36:39], s27 offen offset:3072 lds
  v_mfma_f32_16x16x32_bf16 a[192:195], v[88:91], v[128:131], a[192:195]
  s_add_u32 s26, s26, 64
  ds_read_b128 v[60:63], v14 offset:7168
  v_mfma_f32_16x16x32_bf16 a[196:199], v[88:91], v[132:135], a[196:199]
  s_add_u32 s27, s27, s25
  v_mfma_f32_16x16x32_bf16 a[200:203], v[88:91], v[136:139], a[200:203]
  s_add_u32 s24, s24, 32768
  v_mfma_f32_16x16x32_bf16 a[204:207], v[88:91], v[140:143], a[204:207]
  s_and_b32 s24, s24, 0x1ffff
  v_mfma_f32_16x16x32_bf16 a[208:211], v[88:91], v[144:147], a[208:211]
  v_mfma_f32_16x16x32_bf16 a[212:215], v[88:91], v[148:151], a[212:215]
  v_mfma_f32_16x16x32_bf16 a[216:219], v[88:91], v[152:155], a[216:219]
  s_add_u32 s28, s28, 1
  v_mfma_f32_16x16x32_bf16 a[220:223], v[88:91], v[156:159], a[220:223]
  v_mfma_f32_16x16x32_bf16 a[224:227], v[92:95], v[128:131], a[224:227]
  v_mfma_f32_16x16x32_bf16 a[228:231], v[92:95], v[132:135], a[228:231]
  v_mfma_f32_16x16x32_bf16 a[232:235], v[92:95], v[136:139], a[232:235]
  v_mfma_f32_16x16x32_bf16 a[236:239], v[92:95], v[140:143], a[236:239]
  v_mfma_f32_16x16x32_bf16 a[240:243], v[92:95], v[144:147], a[240:243]
  v_mfma_f32_16x16x32_bf16 a[244:247], v[92:95], v[148:151], a[244:247]
  s_cmp_lt_u32 s28, 8
  v_mfma_f32_16x16x32_bf16 a[248:251], v[92:95], v[152:155], a[248:251]
  s_waitcnt lgkmcnt(0)
  v_mfma_f32_16x16x32_bf16 a[252:255], v[92:95], v[156:159], a[252:255]
  s_cbranch_scc1 fa_loopV
  s_mov_b32 s60, 8192
  s_mov_b32 s61, 2048
  s_mov_b32 s62, 33554432
fa_p1epi:
  s_lshl_b32 s23, s21, 19
  s_add_u32 s62, s62, s23
  s_lshl_b32 s23, s22, 16
  s_add_u32 s62, s62, s23
  s_and_b32 s23, s20, 1
  s_lshl_b32 s23, s23, 15
  s_add_u32 s62, s62, s23
  s_lshl_b32 s23, s22, 2
  s_add_u32 s23, s23, s20
  s_mul_i32 s64, s23, 40960
  s_add_u32 s65, s64, 20480
  s_sub_u32 s23, 15, s22
  s_lshl_b32 s23, s23, 2
  s_add_u32 s23, s23, s20
  s_mul_i32 s66, s23, 40960
  s_add_u32 s67, s66, 20480
  v_cmp_ne_u32 vcc, 0x01010101, v228
  s_cbranch_vccnz fa_ln_spin
fa_ln_ok:
  v_accvgpr_read_b32 v100, a192
  v_accvgpr_read_b32 v101, a193
  v_accvgpr_read_b32 v102, a194
  v_accvgpr_read_b32 v103, a195
  v_accvgpr_read_b32 v104, a224
  v_accvgpr_read_b32 v105, a225
  v_accvgpr_read_b32 v106, a226
  v_accvgpr_read_b32 v107, a227
  v_accvgpr_read_b32 v112, a196
  v_accvgpr_read_b32 v113, a197
  v_accvgpr_read_b32 v114, a198
  v_accvgpr_read_b32 v115, a199
  v_accvgpr_read_b32 v116, a228
  v_accvgpr_read_b32 v117, a229
  v_accvgpr_read_b32 v118, a230
  v_accvgpr_read_b32 v119, a231
  v_accvgpr_read_b32 v124, a200
  v_accvgpr_read_b32 v125, a201
  v_accvgpr_read_b32 v126, a202
  v_accvgpr_read_b32 v127, a203
  v_accvgpr_read_b32 v128, a232
  v_accvgpr_read_b32 v129, a233
  v_accvgpr_read_b32 v130, a234
  v_accvgpr_read_b32 v131, a235
  v_accvgpr_read_b32 v136, a204
  v_accvgpr_read_b32 v137, a205
  v_accvgpr_read_b32 v138, a206
  v_accvgpr_read_b32 v139, a207
  v_accvgpr_read_b32 v140, a236
  v_accvgpr_read_b32 v141, a237
  v_accvgpr_read_b32 v142, a238
  v_accvgpr_read_b32 v143, a239
  v_accvgpr_read_b32 v148, a208
  v_accvgpr_read_b32 v149, a209
  v_accvgpr_read_b32 v150, a210
  v_accvgpr_read_b32 v151, a211
  v_accvgpr_read_b32 v152, a240
  v_accvgpr_read_b32 v153, a241
  v_accvgpr_read_b32 v154, a242
  v_accvgpr_read_b32 v155, a243
  v_accvgpr_read_b32 v160, a212
  v_accvgpr_read_b32 v161, a213
  v_accvgpr_read_b32 v162, a214
  v_accvgpr_read_b32 v163, a215
  v_accvgpr_read_b32 v164, a244
  v_accvgpr_read_b32 v165, a245
  v_accvgpr_read_b32 v166, a246
  v_accvgpr_read_b32 v167, a247
  v_accvgpr_read_b32 v172, a216
  v_accvgpr_read_b32 v173, a217
  v_accvgpr_read_b32 v174, a218
  v_accvgpr_read_b32 v175, a219
  v_accvgpr_read_b32 v176, a248
  v_accvgpr_read_b32 v177, a249
  v_accvgpr_read_b32 v178, a250
  v_accvgpr_read_b32 v179, a251
  v_accvgpr_read_b32 v184, a220
  v_accvgpr_read_b32 v185, a221
  v_accvgpr_read_b32 v186, a222
  v_accvgpr_read_b32 v187, a223
  v_accvgpr_read_b32 v188, a252
  v_accvgpr_read_b32 v189, a253
  v_accvgpr_read_b32 v190, a254
  v_accvgpr_read_b32 v191, a255
  buffer_load_dwordx4 a[192:195], v2, s[40:43], s64 offen offset:0 sc1
  buffer_load_dwordx4 a[196:199], v2, s[40:43], s65 offen offset:0 sc1
  buffer_load_dwordx4 a[200:203], v2, s[40:43], s66 offen offset:0 sc1
  buffer_load_dwordx4 a[204:207], v2, s[40:43], s67 offen offset:0 sc1
  buffer_load_dwordx4 a[208:211], v2, s[40:43], s64 offen offset:1024 sc1
  buffer_load_dwordx4 a[212:215], v2, s[40:43], s65 offen offset:1024 sc1
  buffer_load_dwordx4 a[216:219], v2, s[40:43], s66 offen offset:1024 sc1
  buffer_load_dwordx4 a[220:223], v2, s[40:43], s67 offen offset:1024 sc1
  buffer_load_dwordx4 a[224:227], v2, s[40:43], s64 offen offset:2048 sc1
  buffer_load_dwordx4 a[228:231], v2, s[40:43], s65 offen offset:2048 sc1
  buffer_load_dwordx4 a[232:235], v2, s[40:43], s66 offen offset:2048 sc1
  buffer_load_dwordx4 a[236:239], v2, s[40:43], s67 offen offset:2048 sc1
  buffer_load_dwordx4 a[240:243], v2, s[40:43], s64 offen offset:3072 sc1
  buffer_load_dwordx4 a[244:247], v2, s[40:43], s65 offen offset:3072 sc1
  buffer_load_dwordx4 a[248:251], v2, s[40:43], s66 offen offset:3072 sc1
  buffer_load_dwordx4 a[252:255], v2, s[40:43], s67 offen offset:3072 sc1
  s_add_u32 s64, s64, 4096
  s_add_u32 s65, s65, 4096
  s_add_u32 s66, s66, 4096
  s_add_u32 s67, s67, 4096
  s_mul_i32 s63, s60, 3
  s_add_u32 s63, s63, s62
  v_cvt_pk_bf16_f32 v96, v100, v101
  v_cvt_pk_bf16_f32 v97, v102, v103
  v_cvt_pk_bf16_f32 v98, v104, v105
  v_cvt_pk_bf16_f32 v99, v106, v107
  buffer_store_dwordx4 v[96:99], v2, s[40:43], s63 offen offset:0 sc1
  v_cvt_pk_bf16_f32 v108, v112, v113
  v_cvt_pk_bf16_f32 v109, v114, v115
  v_cvt_pk_bf16_f32 v110, v116, v117
  v_cvt_pk_bf16_f32 v111, v118, v119
  buffer_store_dwordx4 v[108:111], v2, s[40:43], s63 offen offset:1024 sc1
  s_add_u32 s63, s63, s61
  v_cvt_pk_bf16_f32 v120, v124, v125
  v_cvt_pk_bf16_f32 v121, v126, v127
  v_cvt_pk_bf16_f32 v122, v128, v129
  v_cvt_pk_bf16_f32 v123, v130, v131
  buffer_store_dwordx4 v[120:123], v2, s[40:43], s63 offen offset:0 sc1
  v_cvt_pk_bf16_f32 v132, v136, v137
  v_cvt_pk_bf16_f32 v133, v138, v139
  v_cvt_pk_bf16_f32 v134, v140, v141
  v_cvt_pk_bf16_f32 v135, v142, v143
  buffer_store_dwordx4 v[132:135], v2, s[40:43], s63 offen offset:1024 sc1
  s_add_u32 s63, s63, s61
  v_cvt_pk_bf16_f32 v144, v148, v149
  v_cvt_pk_bf16_f32 v145, v150, v151
  v_cvt_pk_bf16_f32 v146, v152, v153
  v_cvt_pk_bf16_f32 v147, v154, v155
  buffer_store_dwordx4 v[144:147], v2, s[40:43], s63 offen offset:0 sc1
  v_cvt_pk_bf16_f32 v156, v160, v161
  v_cvt_pk_bf16_f32 v157, v162, v163
  v_cvt_pk_bf16_f32 v158, v164, v165
  v_cvt_pk_bf16_f32 v159, v166, v167
  buffer_store_dwordx4 v[156:159], v2, s[40:43], s63 offen offset:1024 sc1
  s_add_u32 s63, s63, s61
  v_cvt_pk_bf16_f32 v168, v172, v173
  v_cvt_pk_bf16_f32 v169, v174, v175
  v_cvt_pk_bf16_f32 v170, v176, v177
  v_cvt_pk_bf16_f32 v171, v178, v179
  buffer_store_dwordx4 v[168:171], v2, s[40:43], s63 offen offset:0 sc1
  v_cvt_pk_bf16_f32 v180, v184, v185
  v_cvt_pk_bf16_f32 v181, v186, v187
  v_cvt_pk_bf16_f32 v182, v188, v189
  v_cvt_pk_bf16_f32 v183, v190, v191
  buffer_store_dwordx4 v[180:183], v2, s[40:43], s63 offen offset:1024 sc1
  s_lshr_b32 s23, s20, 1
  s_lshl_b32 s23, s23, 13
  v_subrev_u32 v12, s23, v12
  v_subrev_u32 v13, s23, v13
  s_waitcnt vmcnt(20)
  s_barrier
  ds_read_b64_tr_b16 v[32:33], v12 offset:0
  ds_read_b64_tr_b16 v[34:35], v12 offset:1024
  ds_read_b64_tr_b16 v[36:37], v13 offset:0
  ds_read_b64_tr_b16 v[38:39], v13 offset:1024
  ds_read_b64_tr_b16 v[40:41], v12 offset:256
  ds_read_b64_tr_b16 v[42:43], v12 offset:1280
  ds_read_b64_tr_b16 v[44:45], v13 offset:256
  ds_read_b64_tr_b16 v[46:47], v13 offset:1280
  ds_read_b64_tr_b16 v[48:49], v12 offset:512
  ds_read_b64_tr_b16 v[50:51], v12 offset:1536
  ds_read_b64_tr_b16 v[52:53], v13 offset:512
  ds_read_b64_tr_b16 v[54:55], v13 offset:1536
  ds_read_b64_tr_b16 v[56:57], v12 offset:768
  ds_read_b64_tr_b16 v[58:59], v12 offset:1792
  ds_read_b64_tr_b16 v[60:61], v13 offset:768
  ds_read_b64_tr_b16 v[62:63], v13 offset:1792
  s_lshl_b32 s23, s21, 19
  s_add_u32 s23, s23, 16777216
  s_add_u32 s6, s18, s23
  s_addc_u32 s7, s19, 0
  s_add_u32 s8, s6, 16777216
  s_addc_u32 s9, s7, 0
  s_sub_u32 s23, 16, s22
  s_lshl_b32 s23, s23, 15
  s_mov_b32 s44, s6
  s_mov_b32 s45, s7
  s_mov_b32 s46, s23
  s_mov_b32 s47, 0x20000
  s_mov_b32 s48, s8
  s_mov_b32 s49, s9
  s_mov_b32 s50, s23
  s_mov_b32 s51, 0x20000
  s_waitcnt lgkmcnt(0)
  s_lshl_b32 s30, s21, 7
  s_add_u32 s30, s30, 2637824
  s_mov_b32 s81, 0x47800000
  s_cmp_eq_u32 s20, 0
  s_cselect_b32 s29, s82, 1073741824
  v_mfma_f32_16x16x32_bf16 v[96:99], v[32:35], a[192:195], 0
  v_accvgpr_read_b32 v236, a0
  v_mfma_f32_16x16x32_bf16 v[112:115], v[36:39], a[192:195], 0
  ds_read_b64_tr_b16 v[64:65], v12 offset:8192
  v_accvgpr_read_b32 v237, a1
  v_mfma_f32_16x16x32_bf16 v[128:131], v[40:43], a[192:195], 0
  ds_read_b64_tr_b16 v[66:67], v12 offset:9216
  v_accvgpr_read_b32 v238, a2
  v_mfma_f32_16x16x32_bf16 v[144:147], v[44:47], a[192:195], 0
  ds_read_b64_tr_b16 v[68:69], v13 offset:8192
  v_accvgpr_read_b32 v239, a3
  v_mfma_f32_16x16x32_bf16 v[160:163], v[48:51], a[192:195], 0
  ds_read_b64_tr_b16 v[70:71], v13 offset:9216
  v_accvgpr_read_b32 v240, a32
  v_mfma_f32_16x16x32_bf16 v[176:179], v[52:55], a[192:195], 0
  ds_read_b64_tr_b16 v[72:73], v12 offset:8448
  v_accvgpr_read_b32 v241, a33
  v_mfma_f32_16x16x32_bf16 v[192:195], v[56:59], a[192:195], 0
  ds_read_b64_tr_b16 v[74:75], v12 offset:9472
  v_accvgpr_read_b32 v242, a34
  v_mfma_f32_16x16x32_bf16 v[208:211], v[60:63], a[192:195], 0
  buffer_load_dwordx4 a[192:195], v2, s[40:43], s64 offen offset:0 sc1
  v_accvgpr_read_b32 v243, a35
  v_mfma_f32_16x16x32_bf16 v[100:103], v[32:35], a[196:199], 0
  ds_read_b64_tr_b16 v[76:77], v13 offset:8448
  v_cvt_pk_bf16_f32 v232, v236, v237
  v_mfma_f32_16x16x32_bf16 v[116:119], v[36:39], a[196:199], 0
  ds_read_b64_tr_b16 v[78:79], v13 offset:9472
  v_cvt_pk_bf16_f32 v233, v238, v239
  v_mfma_f32_16x16x32_bf16 v[132:135], v[40:43], a[196:199], 0
  ds_read_b64_tr_b16 v[80:81], v12 offset:8704
  v_cvt_pk_bf16_f32 v234, v240, v241
  v_mfma_f32_16x16x32_bf16 v[148:151], v[44:47], a[196:199], 0
  v_cvt_pk_bf16_f32 v235, v242, v243
  v_mfma_f32_16x16x32_bf16 v[164:167], v[48:51], a[196:199], 0
  ds_read_b64_tr_b16 v[82:83], v12 offset:9728
  v_mfma_f32_16x16x32_bf16 v[180:183], v[52:55], a[196:199], 0
  s_mul_i32 s63, s60, 0
  ds_read_b64_tr_b16 v[84:85], v13 offset:8704
  v_mfma_f32_16x16x32_bf16 v[196:199], v[56:59], a[196:199], 0
  s_add_u32 s63, s63, s62
  ds_read_b64_tr_b16 v[86:87], v13 offset:9728
  v_mfma_f32_16x16x32_bf16 v[212:215], v[60:63], a[196:199], 0
  buffer_load_dwordx4 a[196:199], v2, s[40:43], s65 offen offset:0 sc1
  v_mfma_f32_16x16x32_bf16 v[104:107], v[32:35], a[200:203], 0
  ds_read_b64_tr_b16 v[88:89], v12 offset:8960
  v_accvgpr_read_b32 v248, a4
  v_mfma_f32_16x16x32_bf16 v[120:123], v[36:39], a[200:203], 0
  ds_read_b64_tr_b16 v[90:91], v12 offset:9984
  v_accvgpr_read_b32 v249, a5
  v_mfma_f32_16x16x32_bf16 v[136:139], v[40:43], a[200:203], 0
  ds_read_b64_tr_b16 v[92:93], v13 offset:8960
  v_accvgpr_read_b32 v250, a6
  v_mfma_f32_16x16x32_bf16 v[152:155], v[44:47], a[200:203], 0
  v_accvgpr_read_b32 v251, a7
  v_mfma_f32_16x16x32_bf16 v[168:171], v[48:51], a[200:203], 0
  ds_read_b64_tr_b16 v[94:95], v13 offset:9984
  v_accvgpr_read_b32 v252, a36
  v_mfma_f32_16x16x32_bf16 v[184:187], v[52:55], a[200:203], 0
  buffer_store_dwordx4 v[232:235], v2, s[40:43], s63 offen offset:0 sc1
  v_accvgpr_read_b32 v253, a37
  v_mfma_f32_16x16x32_bf16 v[200:203], v[56:59], a[200:203], 0
  v_accvgpr_read_b32 v254, a38
  v_mfma_f32_16x16x32_bf16 v[216:219], v[60:63], a[200:203], 0
  buffer_load_dwordx4 a[200:203], v2, s[40:43], s66 offen offset:0 sc1
  v_accvgpr_read_b32 v255, a39
  v_mfma_f32_16x16x32_bf16 v[108:111], v[32:35], a[204:207], 0
  v_cvt_pk_bf16_f32 v244, v248, v249
  v_mfma_f32_16x16x32_bf16 v[124:127], v[36:39], a[204:207], 0
  v_cvt_pk_bf16_f32 v245, v250, v251
  v_mfma_f32_16x16x32_bf16 v[140:143], v[40:43], a[204:207], 0
  v_cvt_pk_bf16_f32 v246, v252, v253
  v_mfma_f32_16x16x32_bf16 v[156:159], v[44:47], a[204:207], 0
  v_cvt_pk_bf16_f32 v247, v254, v255
  v_mfma_f32_16x16x32_bf16 v[172:175], v[48:51], a[204:207], 0
  v_mfma_f32_16x16x32_bf16 v[188:191], v[52:55], a[204:207], 0
  buffer_store_dwordx4 v[244:247], v2, s[40:43], s63 offen offset:1024 sc1
  v_mfma_f32_16x16x32_bf16 v[204:207], v[56:59], a[204:207], 0
  v_mfma_f32_16x16x32_bf16 v[220:223], v[60:63], a[204:207], 0
  s_waitcnt vmcnt(21) lgkmcnt(0)
  buffer_load_dwordx4 a[204:207], v2, s[40:43], s67 offen offset:0 sc1
  v_mfma_f32_16x16x32_bf16 v[96:99], v[64:67], a[208:211], v[96:99]
  s_barrier
  v_accvgpr_read_b32 v236, a8
  v_mfma_f32_16x16x32_bf16 v[112:115], v[68:71], a[208:211], v[112:115]
  ds_read_b64_tr_b16 v[32:33], v12 offset:32768
  v_accvgpr_read_b32 v237, a9
  v_mfma_f32_16x16x32_bf16 v[128:131], v[72:75], a[208:211], v[128:131]
  ds_read_b64_tr_b16 v[34:35], v12 offset:33792
  v_accvgpr_read_b32 v238, a10
  v_mfma_f32_16x16x32_bf16 v[144:147], v[76:79], a[208:211], v[144:147]
  ds_read_b64_tr_b16 v[36:37], v13 offset:32768
  v_accvgpr_read_b32 v239, a11
  v_mfma_f32_16x16x32_bf16 v[160:163], v[80:83], a[208:211], v[160:163]
  ds_read_b64_tr_b16 v[38:39], v13 offset:33792
  v_accvgpr_read_b32 v240, a40
  v_mfma_f32_16x16x32_bf16 v[176:179], v[84:87], a[208:211], v[176:179]
  ds_read_b64_tr_b16 v[40:41], v12 offset:33024
  v_accvgpr_read_b32 v241, a41
  v_mfma_f32_16x16x32_bf16 v[192:195], v[88:91], a[208:211], v[192:195]
  ds_read_b64_tr_b16 v[42:43], v12 offset:34048
  v_accvgpr_read_b32 v242, a42
  v_mfma_f32_16x16x32_bf16 v[208:211], v[92:95], a[208:211], v[208:211]
  buffer_load_dwordx4 a[208:211], v2, s[40:43], s64 offen offset:1024 sc1
  v_accvgpr_read_b32 v243, a43
  v_mfma_f32_16x16x32_bf16 v[100:103], v[64:67], a[212:215], v[100:103]
  ds_read_b64_tr_b16 v[44:45], v13 offset:33024
  v_cvt_pk_bf16_f32 v232, v236, v237
  v_mfma_f32_16x16x32_bf16 v[116:119], v[68:71], a[212:215], v[116:119]
  ds_read_b64_tr_b16 v[46:47], v13 offset:34048
  v_cvt_pk_bf16_f32 v233, v238, v239
  v_mfma_f32_16x16x32_bf16 v[132:135], v[72:75], a[212:215], v[132:135]
  s_add_u32 m0, s24, 16384
  ds_read_b64_tr_b16 v[48:49], v12 offset:33280
  v_cvt_pk_bf16_f32 v234, v240, v241
  v_mfma_f32_16x16x32_bf16 v[148:151], v[76:79], a[212:215], v[148:151]
  buffer_load_dwordx4 v8, s[36:39], s27 offen offset:0 lds
  v_cvt_pk_bf16_f32 v235, v242, v243
  v_mfma_f32_16x16x32_bf16 v[164:167], v[80:83], a[212:215], v[164:167]
  ds_read_b64_tr_b16 v[50:51], v12 offset:34304
  v_mfma_f32_16x16x32_bf16 v[180:183], v[84:87], a[212:215], v[180:183]
  s_add_u32 s63, s63, s61
  ds_read_b64_tr_b16 v[52:53], v13 offset:33280
  v_mfma_f32_16x16x32_bf16 v[196:199], v[88:91], a[212:215], v[196:199]
  ds_read_b64_tr_b16 v[54:55], v13 offset:34304
  v_mfma_f32_16x16x32_bf16 v[212:215], v[92:95], a[212:215], v[212:215]
  buffer_load_dwordx4 a[212:215], v2, s[40:43], s65 offen offset:1024 sc1
  v_mfma_f32_16x16x32_bf16 v[104:107], v[64:67], a[216:219], v[104:107]
  ds_read_b64_tr_b16 v[56:57], v12 offset:33536
  v_accvgpr_read_b32 v248, a12
  v_mfma_f32_16x16x32_bf16 v[120:123], v[68:71], a[216:219], v[120:123]
  ds_read_b64_tr_b16 v[58:59], v12 offset:34560
  v_accvgpr_read_b32 v249, a13
  v_mfma_f32_16x16x32_bf16 v[136:139], v[72:75], a[216:219], v[136:139]
  ds_read_b64_tr_b16 v[60:61], v13 offset:33536
  v_accvgpr_read_b32 v250, a14
  v_mfma_f32_16x16x32_bf16 v[152:155], v[76:79], a[216:219], v[152:155]
  buffer_load_dwordx4 v9, s[36:39], s27 offen offset:1024 lds
  v_accvgpr_read_b32 v251, a15
  v_mfma_f32_16x16x32_bf16 v[168:171], v[80:83], a[216:219], v[168:171]
  ds_read_b64_tr_b16 v[62:63], v13 offset:34560
  v_accvgpr_read_b32 v252, a44
  v_mfma_f32_16x16x32_bf16 v[184:187], v[84:87], a[216:219], v[184:187]
  buffer_store_dwordx4 v[232:235], v2, s[40:43], s63 offen offset:0 sc1
  v_accvgpr_read_b32 v253, a45
  v_mfma_f32_16x16x32_bf16 v[200:203], v[88:91], a[216:219], v[200:203]
  buffer_load_dwordx4 v10, s[36:39], s27 offen offset:2048 lds
  v_accvgpr_read_b32 v254, a46
  v_mfma_f32_16x16x32_bf16 v[216:219], v[92:95], a[216:219], v[216:219]
  buffer_load_dwordx4 a[216:219], v2, s[40:43], s66 offen offset:1024 sc1
  v_accvgpr_read_b32 v255, a47
  v_mfma_f32_16x16x32_bf16 v[108:111], v[64:67], a[220:223], v[108:111]
  v_cvt_pk_bf16_f32 v244, v248, v249
  v_mfma_f32_16x16x32_bf16 v[124:127], v[68:71], a[220:223], v[124:127]
  buffer_load_dwordx4 v11, s[36:39], s27 offen offset:3072 lds
  v_cvt_pk_bf16_f32 v245, v250, v251
  v_mfma_f32_16x16x32_bf16 v[140:143], v[72:75], a[220:223], v[140:143]
  s_add_u32 s27, s27, 524288
  v_cvt_pk_bf16_f32 v246, v252, v253
  v_mfma_f32_16x16x32_bf16 v[156:159], v[76:79], a[220:223], v[156:159]
  s_add_u32 s24, s24, 32768
  v_cvt_pk_bf16_f32 v247, v254, v255
  v_mfma_f32_16x16x32_bf16 v[172:175], v[80:83], a[220:223], v[172:175]
  s_and_b32 s24, s24, 0x1ffff
  v_mfma_f32_16x16x32_bf16 v[188:191], v[84:87], a[220:223], v[188:191]
  buffer_store_dwordx4 v[244:247], v2, s[40:43], s63 offen offset:1024 sc1
  v_mfma_f32_16x16x32_bf16 v[204:207], v[88:91], a[220:223], v[204:207]
  v_mfma_f32_16x16x32_bf16 v[220:223], v[92:95], a[220:223], v[220:223]
  s_waitcnt vmcnt(27) lgkmcnt(0)
  buffer_load_dwordx4 a[220:223], v2, s[40:43], s67 offen offset:1024 sc1
  v_mfma_f32_16x16x32_bf16 v[96:99], v[32:35], a[224:227], v[96:99]
  v_accvgpr_read_b32 v236, a16
  v_mfma_f32_16x16x32_bf16 v[112:115], v[36:39], a[224:227], v[112:115]
  ds_read_b64_tr_b16 v[64:65], v12 offset:40960
  v_accvgpr_read_b32 v237, a17
  v_mfma_f32_16x16x32_bf16 v[128:131], v[40:43], a[224:227], v[128:131]
  ds_read_b64_tr_b16 v[66:67], v12 offset:41984
  v_accvgpr_read_b32 v238, a18
  v_mfma_f32_16x16x32_bf16 v[144:147], v[44:47], a[224:227], v[144:147]
  ds_read_b64_tr_b16 v[68:69], v13 offset:40960
  v_accvgpr_read_b32 v239, a19
  v_mfma_f32_16x16x32_bf16 v[160:163], v[48:51], a[224:227], v[160:163]
  ds_read_b64_tr_b16 v[70:71], v13 offset:41984
  v_accvgpr_read_b32 v240, a48
  v_mfma_f32_16x16x32_bf16 v[176:179], v[52:55], a[224:227], v[176:179]
  ds_read_b64_tr_b16 v[72:73], v12 offset:41216
  v_accvgpr_read_b32 v241, a49
  v_mfma_f32_16x16x32_bf16 v[192:195], v[56:59], a[224:227], v[192:195]
  ds_read_b64_tr_b16 v[74:75], v12 offset:42240
  v_accvgpr_read_b32 v242, a50
  v_mfma_f32_16x16x32_bf16 v[208:211], v[60:63], a[224:227], v[208:211]
  buffer_load_dwordx4 a[224:227], v2, s[40:43], s64 offen offset:2048 sc1
  v_accvgpr_read_b32 v243, a51
  v_mfma_f32_16x16x32_bf16 v[100:103], v[32:35], a[228:231], v[100:103]
  ds_read_b64_tr_b16 v[76:77], v13 offset:41216
  v_cvt_pk_bf16_f32 v232, v236, v237
  v_mfma_f32_16x16x32_bf16 v[116:119], v[36:39], a[228:231], v[116:119]
  ds_read_b64_tr_b16 v[78:79], v13 offset:42240
  v_cvt_pk_bf16_f32 v233, v238, v239
  v_mfma_f32_16x16x32_bf16 v[132:135], v[40:43], a[228:231], v[132:135]
  ds_read_b64_tr_b16 v[80:81], v12 offset:41472
  v_cvt_pk_bf16_f32 v234, v240, v241
  v_mfma_f32_16x16x32_bf16 v[148:151], v[44:47], a[228:231], v[148:151]
  v_cvt_pk_bf16_f32 v235, v242, v243
  v_mfma_f32_16x16x32_bf16 v[164:167], v[48:51], a[228:231], v[164:167]
  ds_read_b64_tr_b16 v[82:83], v12 offset:42496
  v_mfma_f32_16x16x32_bf16 v[180:183], v[52:55], a[228:231], v[180:183]
  s_add_u32 s63, s63, s61
  ds_read_b64_tr_b16 v[84:85], v13 offset:41472
  v_mfma_f32_16x16x32_bf16 v[196:199], v[56:59], a[228:231], v[196:199]
  ds_read_b64_tr_b16 v[86:87], v13 offset:42496
  v_mfma_f32_16x16x32_bf16 v[212:215], v[60:63], a[228:231], v[212:215]
  buffer_load_dwordx4 a[228:231], v2, s[40:43], s65 offen offset:2048 sc1
  v_mfma_f32_16x16x32_bf16 v[104:107], v[32:35], a[232:235], v[104:107]
  ds_read_b64_tr_b16 v[88:89], v12 offset:41728
  v_accvgpr_read_b32 v248, a20
  v_mfma_f32_16x16x32_bf16 v[120:123], v[36:39], a[232:235], v[120:123]
  ds_read_b64_tr_b16 v[90:91], v12 offset:42752
  v_accvgpr_read_b32 v249, a21
  v_mfma_f32_16x16x32_bf16 v[136:139], v[40:43], a[232:235], v[136:139]
  ds_read_b64_tr_b16 v[92:93], v13 offset:41728
  v_accvgpr_read_b32 v250, a22
  v_mfma_f32_16x16x32_bf16 v[152:155], v[44:47], a[232:235], v[152:155]
  v_accvgpr_read_b32 v251, a23
  v_mfma_f32_16x16x32_bf16 v[168:171], v[48:51], a[232:235], v[168:171]
  ds_read_b64_tr_b16 v[94:95], v13 offset:42752
  v_accvgpr_read_b32 v252, a52
  v_mfma_f32_16x16x32_bf16 v[184:187], v[52:55], a[232:235], v[184:187]
  buffer_store_dwordx4 v[232:235], v2, s[40:43], s63 offen offset:0 sc1
  v_accvgpr_read_b32 v253, a53
  v_mfma_f32_16x16x32_bf16 v[200:203], v[56:59], a[232:235], v[200:203]
  v_accvgpr_read_b32 v254, a54
  v_mfma_f32_16x16x32_bf16 v[216:219], v[60:63], a[232:235], v[216:219]
  buffer_load_dwordx4 a[232:235], v2, s[40:43], s66 offen offset:2048 sc1
  v_accvgpr_read_b32 v255, a55
  v_mfma_f32_16x16x32_bf16 v[108:111], v[32:35], a[236:239], v[108:111]
  v_xor_b32 v12, 0x10000, v12
  v_cvt_pk_bf16_f32 v244, v248, v249
  v_mfma_f32_16x16x32_bf16 v[124:127], v[36:39], a[236:239], v[124:127]
  v_cvt_pk_bf16_f32 v245, v250, v251
  v_mfma_f32_16x16x32_bf16 v[140:143], v[40:43], a[236:239], v[140:143]
  v_xor_b32 v13, 0x10000, v13
  v_cvt_pk_bf16_f32 v246, v252, v253
  v_mfma_f32_16x16x32_bf16 v[156:159], v[44:47], a[236:239], v[156:159]
  v_cvt_pk_bf16_f32 v247, v254, v255
  v_mfma_f32_16x16x32_bf16 v[172:175], v[48:51], a[236:239], v[172:175]
  v_mfma_f32_16x16x32_bf16 v[188:191], v[52:55], a[236:239], v[188:191]
  buffer_store_dwordx4 v[244:247], v2, s[40:43], s63 offen offset:1024 sc1
  v_mfma_f32_16x16x32_bf16 v[204:207], v[56:59], a[236:239], v[204:207]
  v_mfma_f32_16x16x32_bf16 v[220:223], v[60:63], a[236:239], v[220:223]
  s_waitcnt vmcnt(29) lgkmcnt(0)
  buffer_load_dwordx4 a[236:239], v2, s[40:43], s67 offen offset:2048 sc1
  v_mfma_f32_16x16x32_bf16 v[96:99], v[64:67], a[240:243], v[96:99]
  s_barrier
  v_accvgpr_read_b32 v236, a24
  v_mfma_f32_16x16x32_bf16 v[112:115], v[68:71], a[240:243], v[112:115]
  ds_read_b64_tr_b16 v[32:33], v12 offset:0
  v_accvgpr_read_b32 v237, a25
  v_mfma_f32_16x16x32_bf16 v[128:131], v[72:75], a[240:243], v[128:131]
  ds_read_b64_tr_b16 v[34:35], v12 offset:1024
  v_accvgpr_read_b32 v238, a26
  v_mfma_f32_16x16x32_bf16 v[144:147], v[76:79], a[240:243], v[144:147]
  ds_read_b64_tr_b16 v[36:37], v13 offset:0
  v_accvgpr_read_b32 v239, a27
  v_mfma_f32_16x16x32_bf16 v[160:163], v[80:83], a[240:243], v[160:163]
  ds_read_b64_tr_b16 v[38:39], v13 offset:1024
  v_accvgpr_read_b32 v240, a56
  v_mfma_f32_16x16x32_bf16 v[176:179], v[84:87], a[240:243], v[176:179]
  ds_read_b64_tr_b16 v[40:41], v12 offset:256
  v_accvgpr_read_b32 v241, a57
  v_mfma_f32_16x16x32_bf16 v[192:195], v[88:91], a[240:243], v[192:195]
  ds_read_b64_tr_b16 v[42:43], v12 offset:1280
  v_accvgpr_read_b32 v242, a58
  v_mfma_f32_16x16x32_bf16 v[208:211], v[92:95], a[240:243], v[208:211]
  buffer_load_dwordx4 a[240:243], v2, s[40:43], s64 offen offset:3072 sc1
  v_accvgpr_read_b32 v243, a59
  v_mfma_f32_16x16x32_bf16 v[100:103], v[64:67], a[244:247], v[100:103]
  s_add_u32 s64, s64, 4096
  ds_read_b64_tr_b16 v[44:45], v13 offset:256
  v_cvt_pk_bf16_f32 v232, v236, v237
  v_mfma_f32_16x16x32_bf16 v[116:119], v[68:71], a[244:247], v[116:119]
  ds_read_b64_tr_b16 v[46:47], v13 offset:1280
  v_cvt_pk_bf16_f32 v233, v238, v239
  v_mfma_f32_16x16x32_bf16 v[132:135], v[72:75], a[244:247], v[132:135]
  s_add_u32 m0, s24, 16384
  ds_read_b64_tr_b16 v[48:49], v12 offset:512
  v_cvt_pk_bf16_f32 v234, v240, v241
  v_mfma_f32_16x16x32_bf16 v[148:151], v[76:79], a[244:247], v[148:151]
  buffer_load_dwordx4 v8, s[36:39], s27 offen offset:0 lds
  v_cvt_pk_bf16_f32 v235, v242, v243
  v_mfma_f32_16x16x32_bf16 v[164:167], v[80:83], a[244:247], v[164:167]
  ds_read_b64_tr_b16 v[50:51], v12 offset:1536
  v_mfma_f32_16x16x32_bf16 v[180:183], v[84:87], a[244:247], v[180:183]
  s_add_u32 s63, s63, s61
  ds_read_b64_tr_b16 v[52:53], v13 offset:512
  v_mfma_f32_16x16x32_bf16 v[196:199], v[88:91], a[244:247], v[196:199]
  ds_read_b64_tr_b16 v[54:55], v13 offset:1536
  v_mfma_f32_16x16x32_bf16 v[212:215], v[92:95], a[244:247], v[212:215]
  buffer_load_dwordx4 a[244:247], v2, s[40:43], s65 offen offset:3072 sc1
  v_mfma_f32_16x16x32_bf16 v[104:107], v[64:67], a[248:251], v[104:107]
  s_add_u32 s65, s65, 4096
  ds_read_b64_tr_b16 v[56:57], v12 offset:768
  v_accvgpr_read_b32 v248, a28
  v_mfma_f32_16x16x32_bf16 v[120:123], v[68:71], a[248:251], v[120:123]
  ds_read_b64_tr_b16 v[58:59], v12 offset:1792
  v_accvgpr_read_b32 v249, a29
  v_mfma_f32_16x16x32_bf16 v[136:139], v[72:75], a[248:251], v[136:139]
  ds_read_b64_tr_b16 v[60:61], v13 offset:768
  v_accvgpr_read_b32 v250, a30
  v_mfma_f32_16x16x32_bf16 v[152:155], v[76:79], a[248:251], v[152:155]
  buffer_load_dwordx4 v9, s[36:39], s27 offen offset:1024 lds
  v_accvgpr_read_b32 v251, a31
  v_mfma_f32_16x16x32_bf16 v[168:171], v[80:83], a[248:251], v[168:171]
  ds_read_b64_tr_b16 v[62:63], v13 offset:1792
  v_accvgpr_read_b32 v252, a60
  v_mfma_f32_16x16x32_bf16 v[184:187], v[84:87], a[248:251], v[184:187]
  buffer_store_dwordx4 v[232:235], v2, s[40:43], s63 offen offset:0 sc1
  v_accvgpr_read_b32 v253, a61
  v_mfma_f32_16x16x32_bf16 v[200:203], v[88:91], a[248:251], v[200:203]
  buffer_load_dwordx4 v10, s[36:39], s27 offen offset:2048 lds
  v_accvgpr_read_b32 v254, a62
  v_mfma_f32_16x16x32_bf16 v[216:219], v[92:95], a[248:251], v[216:219]
  buffer_load_dwordx4 a[248:251], v2, s[40:43], s66 offen offset:3072 sc1
  v_accvgpr_read_b32 v255, a63
  v_mfma_f32_16x16x32_bf16 v[108:111], v[64:67], a[252:255], v[108:111]
  s_add_u32 s66, s66, 4096
  v_cvt_pk_bf16_f32 v244, v248, v249
  v_mfma_f32_16x16x32_bf16 v[124:127], v[68:71], a[252:255], v[124:127]
  buffer_load_dwordx4 v11, s[36:39], s27 offen offset:3072 lds
  v_cvt_pk_bf16_f32 v245, v250, v251
  v_mfma_f32_16x16x32_bf16 v[140:143], v[72:75], a[252:255], v[140:143]
  s_add_u32 s27, s27, 524288
  v_cvt_pk_bf16_f32 v246, v252, v253
  v_mfma_f32_16x16x32_bf16 v[156:159], v[76:79], a[252:255], v[156:159]
  s_add_u32 s24, s24, 32768
  v_cvt_pk_bf16_f32 v247, v254, v255
  v_mfma_f32_16x16x32_bf16 v[172:175], v[80:83], a[252:255], v[172:175]
  s_and_b32 s24, s24, 0x1ffff
  v_mfma_f32_16x16x32_bf16 v[188:191], v[84:87], a[252:255], v[188:191]
  buffer_store_dwordx4 v[244:247], v2, s[40:43], s63 offen offset:1024 sc1
  v_mfma_f32_16x16x32_bf16 v[204:207], v[88:91], a[252:255], v[204:207]
  v_mfma_f32_16x16x32_bf16 v[220:223], v[92:95], a[252:255], v[220:223]
  s_waitcnt vmcnt(25) lgkmcnt(0)
  buffer_load_dwordx4 a[252:255], v2, s[40:43], s67 offen offset:3072 sc1
  v_mfma_f32_16x16x32_bf16 v[96:99], v[32:35], a[192:195], v[96:99]
  v_accvgpr_read_b32 v236, a64
  v_mfma_f32_16x16x32_bf16 v[112:115], v[36:39], a[192:195], v[112:115]
  s_add_u32 s67, s67, 4096
  ds_read_b64_tr_b16 v[64:65], v12 offset:8192
  v_accvgpr_read_b32 v237, a65
  v_mfma_f32_16x16x32_bf16 v[128:131], v[40:43], a[192:195], v[128:131]
  ds_read_b64_tr_b16 v[66:67], v12 offset:9216
  v_accvgpr_read_b32 v238, a66
  v_mfma_f32_16x16x32_bf16 v[144:147], v[44:47], a[192:195], v[144:147]
  ds_read_b64_tr_b16 v[68:69], v13 offset:8192
  v_accvgpr_read_b32 v239, a67
  v_mfma_f32_16x16x32_bf16 v[160:163], v[48:51], a[192:195], v[160:163]
  ds_read_b64_tr_b16 v[70:71], v13 offset:9216
  v_accvgpr_read_b32 v240, a96
  v_mfma_f32_16x16x32_bf16 v[176:179], v[52:55], a[192:195], v[176:179]
  ds_read_b64_tr_b16 v[72:73], v12 offset:8448
  v_accvgpr_read_b32 v241, a97
  v_mfma_f32_16x16x32_bf16 v[192:195], v[56:59], a[192:195], v[192:195]
  ds_read_b64_tr_b16 v[74:75], v12 offset:9472
  v_accvgpr_read_b32 v242, a98
  v_mfma_f32_16x16x32_bf16 v[208:211], v[60:63], a[192:195], v[208:211]
  buffer_load_dwordx4 a[192:195], v2, s[40:43], s64 offen offset:0 sc1
  v_accvgpr_read_b32 v243, a99
  v_mfma_f32_16x16x32_bf16 v[100:103], v[32:35], a[196:199], v[100:103]
  ds_read_b64_tr_b16 v[76:77], v13 offset:8448
  v_cvt_pk_bf16_f32 v232, v236, v237
  v_mfma_f32_16x16x32_bf16 v[116:119], v[36:39], a[196:199], v[116:119]
  ds_read_b64_tr_b16 v[78:79], v13 offset:9472
  v_cvt_pk_bf16_f32 v233, v238, v239
  v_mfma_f32_16x16x32_bf16 v[132:135], v[40:43], a[196:199], v[132:135]
  ds_read_b64_tr_b16 v[80:81], v12 offset:8704
  v_cvt_pk_bf16_f32 v234, v240, v241
  v_mfma_f32_16x16x32_bf16 v[148:151], v[44:47], a[196:199], v[148:151]
  v_cvt_pk_bf16_f32 v235, v242, v243
  v_mfma_f32_16x16x32_bf16 v[164:167], v[48:51], a[196:199], v[164:167]
  ds_read_b64_tr_b16 v[82:83], v12 offset:9728
  v_mfma_f32_16x16x32_bf16 v[180:183], v[52:55], a[196:199], v[180:183]
  s_mul_i32 s63, s60, 1
  ds_read_b64_tr_b16 v[84:85], v13 offset:8704
  v_mfma_f32_16x16x32_bf16 v[196:199], v[56:59], a[196:199], v[196:199]
  s_add_u32 s63, s63, s62
  ds_read_b64_tr_b16 v[86:87], v13 offset:9728
  v_mfma_f32_16x16x32_bf16 v[212:215], v[60:63], a[196:199], v[212:215]
  buffer_load_dwordx4 a[196:199], v2, s[40:43], s65 offen offset:0 sc1
  v_mfma_f32_16x16x32_bf16 v[104:107], v[32:35], a[200:203], v[104:107]
  ds_read_b64_tr_b16 v[88:89], v12 offset:8960
  v_accvgpr_read_b32 v248, a68
  v_mfma_f32_16x16x32_bf16 v[120:123], v[36:39], a[200:203], v[120:123]
  ds_read_b64_tr_b16 v[90:91], v12 offset:9984
  v_accvgpr_read_b32 v249, a69
  v_mfma_f32_16x16x32_bf16 v[136:139], v[40:43], a[200:203], v[136:139]
  ds_read_b64_tr_b16 v[92:93], v13 offset:8960
  v_accvgpr_read_b32 v250, a70
  v_mfma_f32_16x16x32_bf16 v[152:155], v[44:47], a[200:203], v[152:155]
  v_accvgpr_read_b32 v251, a71
  v_mfma_f32_16x16x32_bf16 v[168:171], v[48:51], a[200:203], v[168:171]
  ds_read_b64_tr_b16 v[94:95], v13 offset:9984
  v_accvgpr_read_b32 v252, a100
  v_mfma_f32_16x16x32_bf16 v[184:187], v[52:55], a[200:203], v[184:187]
  buffer_store_dwordx4 v[232:235], v2, s[40:43], s63 offen offset:0 sc1
  v_accvgpr_read_b32 v253, a101
  v_mfma_f32_16x16x32_bf16 v[200:203], v[56:59], a[200:203], v[200:203]
  v_accvgpr_read_b32 v254, a102
  v_mfma_f32_16x16x32_bf16 v[216:219], v[60:63], a[200:203], v[216:219]
  buffer_load_dwordx4 a[200:203], v2, s[40:43], s66 offen offset:0 sc1
  v_accvgpr_read_b32 v255, a103
  v_mfma_f32_16x16x32_bf16 v[108:111], v[32:35], a[204:207], v[108:111]
  v_cvt_pk_bf16_f32 v244, v248, v249
  v_mfma_f32_16x16x32_bf16 v[124:127], v[36:39], a[204:207], v[124:127]
  v_cvt_pk_bf16_f32 v245, v250, v251
  v_mfma_f32_16x16x32_bf16 v[140:143], v[40:43], a[204:207], v[140:143]
  v_cvt_pk_bf16_f32 v246, v252, v253
  v_mfma_f32_16x16x32_bf16 v[156:159], v[44:47], a[204:207], v[156:159]
  v_cvt_pk_bf16_f32 v247, v254, v255
  v_mfma_f32_16x16x32_bf16 v[172:175], v[48:51], a[204:207], v[172:175]
  v_mfma_f32_16x16x32_bf16 v[188:191], v[52:55], a[204:207], v[188:191]
  buffer_store_dwordx4 v[244:247], v2, s[40:43], s63 offen offset:1024 sc1
  v_mfma_f32_16x16x32_bf16 v[204:207], v[56:59], a[204:207], v[204:207]
  v_mfma_f32_16x16x32_bf16 v[220:223], v[60:63], a[204:207], v[220:223]
  s_waitcnt vmcnt(21) lgkmcnt(0)
  buffer_load_dwordx4 a[204:207], v2, s[40:43], s67 offen offset:0 sc1
  v_mfma_f32_16x16x32_bf16 v[96:99], v[64:67], a[208:211], v[96:99]
  s_barrier
  v_accvgpr_read_b32 v236, a72
  v_mfma_f32_16x16x32_bf16 v[112:115], v[68:71], a[208:211], v[112:115]
  ds_read_b64_tr_b16 v[32:33], v12 offset:32768
  v_accvgpr_read_b32 v237, a73
  v_mfma_f32_16x16x32_bf16 v[128:131], v[72:75], a[208:211], v[128:131]
  ds_read_b64_tr_b16 v[34:35], v12 offset:33792
  v_accvgpr_read_b32 v238, a74
  v_mfma_f32_16x16x32_bf16 v[144:147], v[76:79], a[208:211], v[144:147]
  ds_read_b64_tr_b16 v[36:37], v13 offset:32768
  v_accvgpr_read_b32 v239, a75
  v_mfma_f32_16x16x32_bf16 v[160:163], v[80:83], a[208:211], v[160:163]
  ds_read_b64_tr_b16 v[38:39], v13 offset:33792
  v_accvgpr_read_b32 v240, a104
  v_mfma_f32_16x16x32_bf16 v[176:179], v[84:87], a[208:211], v[176:179]
  ds_read_b64_tr_b16 v[40:41], v12 offset:33024
  v_accvgpr_read_b32 v241, a105
  v_mfma_f32_16x16x32_bf16 v[192:195], v[88:91], a[208:211], v[192:195]
  ds_read_b64_tr_b16 v[42:43], v12 offset:34048
  v_accvgpr_read_b32 v242, a106
  v_mfma_f32_16x16x32_bf16 v[208:211], v[92:95], a[208:211], v[208:211]
  buffer_load_dwordx4 a[208:211], v2, s[40:43], s64 offen offset:1024 sc1
  v_accvgpr_read_b32 v243, a107
  v_mfma_f32_16x16x32_bf16 v[100:103], v[64:67], a[212:215], v[100:103]
  ds_read_b64_tr_b16 v[44:45], v13 offset:33024
  v_cvt_pk_bf16_f32 v232, v236, v237
  v_mfma_f32_16x16x32_bf16 v[116:119], v[68:71], a[212:215], v[116:119]
  ds_read_b64_tr_b16 v[46:47], v13 offset:34048
  v_cvt_pk_bf16_f32 v233, v238, v239
  v_mfma_f32_16x16x32_bf16 v[132:135], v[72:75], a[212:215], v[132:135]
  s_add_u32 m0, s24, 16384
  ds_read_b64_tr_b16 v[48:49], v12 offset:33280
  v_cvt_pk_bf16_f32 v234, v240, v241
  v_mfma_f32_16x16x32_bf16 v[148:151], v[76:79], a[212:215], v[148:151]
  buffer_load_dwordx4 v8, s[36:39], s27 offen offset:0 lds
  v_cvt_pk_bf16_f32 v235, v242, v243
  v_mfma_f32_16x16x32_bf16 v[164:167], v[80:83], a[212:215], v[164:167]
  ds_read_b64_tr_b16 v[50:51], v12 offset:34304
  v_mfma_f32_16x16x32_bf16 v[180:183], v[84:87], a[212:215], v[180:183]
  s_add_u32 s63, s63, s61
  ds_read_b64_tr_b16 v[52:53], v13 offset:33280
  v_mfma_f32_16x16x32_bf16 v[196:199], v[88:91], a[212:215], v[196:199]
  ds_read_b64_tr_b16 v[54:55], v13 offset:34304
  v_mfma_f32_16x16x32_bf16 v[212:215], v[92:95], a[212:215], v[212:215]
  buffer_load_dwordx4 a[212:215], v2, s[40:43], s65 offen offset:1024 sc1
  v_mfma_f32_16x16x32_bf16 v[104:107], v[64:67], a[216:219], v[104:107]
  ds_read_b64_tr_b16 v[56:57], v12 offset:33536
  v_accvgpr_read_b32 v248, a76
  v_mfma_f32_16x16x32_bf16 v[120:123], v[68:71], a[216:219], v[120:123]
  ds_read_b64_tr_b16 v[58:59], v12 offset:34560
  v_accvgpr_read_b32 v249, a77
  v_mfma_f32_16x16x32_bf16 v[136:139], v[72:75], a[216:219], v[136:139]
  ds_read_b64_tr_b16 v[60:61], v13 offset:33536
  v_accvgpr_read_b32 v250, a78
  v_mfma_f32_16x16x32_bf16 v[152:155], v[76:79], a[216:219], v[152:155]
  buffer_load_dwordx4 v9, s[36:39], s27 offen offset:1024 lds
  v_accvgpr_read_b32 v251, a79
  v_mfma_f32_16x16x32_bf16 v[168:171], v[80:83], a[216:219], v[168:171]
  ds_read_b64_tr_b16 v[62:63], v13 offset:34560
  v_accvgpr_read_b32 v252, a108
  v_mfma_f32_16x16x32_bf16 v[184:187], v[84:87], a[216:219], v[184:187]
  buffer_store_dwordx4 v[232:235], v2, s[40:43], s63 offen offset:0 sc1
  v_accvgpr_read_b32 v253, a109
  v_mfma_f32_16x16x32_bf16 v[200:203], v[88:91], a[216:219], v[200:203]
  buffer_load_dwordx4 v10, s[36:39], s27 offen offset:2048 lds
  v_accvgpr_read_b32 v254, a110
  v_mfma_f32_16x16x32_bf16 v[216:219], v[92:95], a[216:219], v[216:219]
  buffer_load_dwordx4 a[216:219], v2, s[40:43], s66 offen offset:1024 sc1
  v_accvgpr_read_b32 v255, a111
  v_mfma_f32_16x16x32_bf16 v[108:111], v[64:67], a[220:223], v[108:111]
  v_cvt_pk_bf16_f32 v244, v248, v249
  v_mfma_f32_16x16x32_bf16 v[124:127], v[68:71], a[220:223], v[124:127]
  buffer_load_dwordx4 v11, s[36:39], s27 offen offset:3072 lds
  v_cvt_pk_bf16_f32 v245, v250, v251
  v_mfma_f32_16x16x32_bf16 v[140:143], v[72:75], a[220:223], v[140:143]
  s_add_u32 s27, s27, 524288
  v_cvt_pk_bf16_f32 v246, v252, v253
  v_mfma_f32_16x16x32_bf16 v[156:159], v[76:79], a[220:223], v[156:159]
  s_add_u32 s24, s24, 32768
  v_cvt_pk_bf16_f32 v247, v254, v255
  v_mfma_f32_16x16x32_bf16 v[172:175], v[80:83], a[220:223], v[172:175]
  s_and_b32 s24, s24, 0x1ffff
  v_mfma_f32_16x16x32_bf16 v[188:191], v[84:87], a[220:223], v[188:191]
  buffer_store_dwordx4 v[244:247], v2, s[40:43], s63 offen offset:1024 sc1
  v_mfma_f32_16x16x32_bf16 v[204:207], v[88:91], a[220:223], v[204:207]
  v_mfma_f32_16x16x32_bf16 v[220:223], v[92:95], a[220:223], v[220:223]
  s_waitcnt vmcnt(25) lgkmcnt(0)
  buffer_load_dwordx4 a[220:223], v2, s[40:43], s67 offen offset:1024 sc1
  v_mfma_f32_16x16x32_bf16 v[96:99], v[32:35], a[224:227], v[96:99]
  v_accvgpr_read_b32 v236, a80
  v_mfma_f32_16x16x32_bf16 v[112:115], v[36:39], a[224:227], v[112:115]
  ds_read_b64_tr_b16 v[64:65], v12 offset:40960
  v_accvgpr_read_b32 v237, a81
  v_mfma_f32_16x16x32_bf16 v[128:131], v[40:43], a[224:227], v[128:131]
  ds_read_b64_tr_b16 v[66:67], v12 offset:41984
  v_accvgpr_read_b32 v238, a82
  v_mfma_f32_16x16x32_bf16 v[144:147], v[44:47], a[224:227], v[144:147]
  ds_read_b64_tr_b16 v[68:69], v13 offset:40960
  v_accvgpr_read_b32 v239, a83
  v_mfma_f32_16x16x32_bf16 v[160:163], v[48:51], a[224:227], v[160:163]
  ds_read_b64_tr_b16 v[70:71], v13 offset:41984
  v_accvgpr_read_b32 v240, a112
  v_mfma_f32_16x16x32_bf16 v[176:179], v[52:55], a[224:227], v[176:179]
  ds_read_b64_tr_b16 v[72:73], v12 offset:41216
  v_accvgpr_read_b32 v241, a113
  v_mfma_f32_16x16x32_bf16 v[192:195], v[56:59], a[224:227], v[192:195]
  ds_read_b64_tr_b16 v[74:75], v12 offset:42240
  v_accvgpr_read_b32 v242, a114
  v_mfma_f32_16x16x32_bf16 v[208:211], v[60:63], a[224:227], v[208:211]
  buffer_load_dwordx4 a[224:227], v2, s[40:43], s64 offen offset:2048 sc1
  v_accvgpr_read_b32 v243, a115
  v_mfma_f32_16x16x32_bf16 v[100:103], v[32:35], a[228:231], v[100:103]
  ds_read_b64_tr_b16 v[76:77], v13 offset:41216
  v_cvt_pk_bf16_f32 v232, v236, v237
  v_mfma_f32_16x16x32_bf16 v[116:119], v[36:39], a[228:231], v[116:119]
  ds_read_b64_tr_b16 v[78:79], v13 offset:42240
  v_cvt_pk_bf16_f32 v233, v238, v239
  v_mfma_f32_16x16x32_bf16 v[132:135], v[40:43], a[228:231], v[132:135]
  ds_read_b64_tr_b16 v[80:81], v12 offset:41472
  v_cvt_pk_bf16_f32 v234, v240, v241
  v_mfma_f32_16x16x32_bf16 v[148:151], v[44:47], a[228:231], v[148:151]
  v_cvt_pk_bf16_f32 v235, v242, v243
  v_mfma_f32_16x16x32_bf16 v[164:167], v[48:51], a[228:231], v[164:167]
  ds_read_b64_tr_b16 v[82:83], v12 offset:42496
  v_mfma_f32_16x16x32_bf16 v[180:183], v[52:55], a[228:231], v[180:183]
  s_add_u32 s63, s63, s61
  ds_read_b64_tr_b16 v[84:85], v13 offset:41472
  v_mfma_f32_16x16x32_bf16 v[196:199], v[56:59], a[228:231], v[196:199]
  ds_read_b64_tr_b16 v[86:87], v13 offset:42496
  v_mfma_f32_16x16x32_bf16 v[212:215], v[60:63], a[228:231], v[212:215]
  buffer_load_dwordx4 a[228:231], v2, s[40:43], s65 offen offset:2048 sc1
  v_mfma_f32_16x16x32_bf16 v[104:107], v[32:35], a[232:235], v[104:107]
  ds_read_b64_tr_b16 v[88:89], v12 offset:41728
  v_accvgpr_read_b32 v248, a84
  v_mfma_f32_16x16x32_bf16 v[120:123], v[36:39], a[232:235], v[120:123]
  ds_read_b64_tr_b16 v[90:91], v12 offset:42752
  v_accvgpr_read_b32 v249, a85
  v_mfma_f32_16x16x32_bf16 v[136:139], v[40:43], a[232:235], v[136:139]
  ds_read_b64_tr_b16 v[92:93], v13 offset:41728
  v_accvgpr_read_b32 v250, a86
  v_mfma_f32_16x16x32_bf16 v[152:155], v[44:47], a[232:235], v[152:155]
  v_accvgpr_read_b32 v251, a87
  v_mfma_f32_16x16x32_bf16 v[168:171], v[48:51], a[232:235], v[168:171]
  ds_read_b64_tr_b16 v[94:95], v13 offset:42752
  v_accvgpr_read_b32 v252, a116
  v_mfma_f32_16x16x32_bf16 v[184:187], v[52:55], a[232:235], v[184:187]
  buffer_store_dwordx4 v[232:235], v2, s[40:43], s63 offen offset:0 sc1
  v_accvgpr_read_b32 v253, a117
  v_mfma_f32_16x16x32_bf16 v[200:203], v[56:59], a[232:235], v[200:203]
  v_accvgpr_read_b32 v254, a118
  v_mfma_f32_16x16x32_bf16 v[216:219], v[60:63], a[232:235], v[216:219]
  buffer_load_dwordx4 a[232:235], v2, s[40:43], s66 offen offset:2048 sc1
  v_accvgpr_read_b32 v255, a119
  v_mfma_f32_16x16x32_bf16 v[108:111], v[32:35], a[236:239], v[108:111]
  v_xor_b32 v12, 0x10000, v12
  v_cvt_pk_bf16_f32 v244, v248, v249
  v_mfma_f32_16x16x32_bf16 v[124:127], v[36:39], a[236:239], v[124:127]
  v_cvt_pk_bf16_f32 v245, v250, v251
  v_mfma_f32_16x16x32_bf16 v[140:143], v[40:43], a[236:239], v[140:143]
  v_xor_b32 v13, 0x10000, v13
  v_cvt_pk_bf16_f32 v246, v252, v253
  v_mfma_f32_16x16x32_bf16 v[156:159], v[44:47], a[236:239], v[156:159]
  v_cvt_pk_bf16_f32 v247, v254, v255
  v_mfma_f32_16x16x32_bf16 v[172:175], v[48:51], a[236:239], v[172:175]
  v_mfma_f32_16x16x32_bf16 v[188:191], v[52:55], a[236:239], v[188:191]
  buffer_store_dwordx4 v[244:247], v2, s[40:43], s63 offen offset:1024 sc1
  v_mfma_f32_16x16x32_bf16 v[204:207], v[56:59], a[236:239], v[204:207]
  v_mfma_f32_16x16x32_bf16 v[220:223], v[60:63], a[236:239], v[220:223]
  s_waitcnt vmcnt(21) lgkmcnt(0)
  buffer_load_dwordx4 a[236:239], v2, s[40:43], s67 offen offset:2048 sc1
  v_mfma_f32_16x16x32_bf16 v[96:99], v[64:67], a[240:243], v[96:99]
  s_barrier
  v_accvgpr_read_b32 v236, a88
  v_mfma_f32_16x16x32_bf16 v[112:115], v[68:71], a[240:243], v[112:115]
  ds_read_b64_tr_b16 v[32:33], v12 offset:0
  v_accvgpr_read_b32 v237, a89
  v_mfma_f32_16x16x32_bf16 v[128:131], v[72:75], a[240:243], v[128:131]
  ds_read_b64_tr_b16 v[34:35], v12 offset:1024
  v_accvgpr_read_b32 v238, a90
  v_mfma_f32_16x16x32_bf16 v[144:147], v[76:79], a[240:243], v[144:147]
  ds_read_b64_tr_b16 v[36:37], v13 offset:0
  v_accvgpr_read_b32 v239, a91
  v_mfma_f32_16x16x32_bf16 v[160:163], v[80:83], a[240:243], v[160:163]
  ds_read_b64_tr_b16 v[38:39], v13 offset:1024
  v_accvgpr_read_b32 v240, a120
  v_mfma_f32_16x16x32_bf16 v[176:179], v[84:87], a[240:243], v[176:179]
  ds_read_b64_tr_b16 v[40:41], v12 offset:256
  v_accvgpr_read_b32 v241, a121
  v_mfma_f32_16x16x32_bf16 v[192:195], v[88:91], a[240:243], v[192:195]
  ds_read_b64_tr_b16 v[42:43], v12 offset:1280
  v_accvgpr_read_b32 v242, a122
  v_mfma_f32_16x16x32_bf16 v[208:211], v[92:95], a[240:243], v[208:211]
  buffer_load_dwordx4 a[240:243], v2, s[40:43], s64 offen offset:3072 sc1
  v_accvgpr_read_b32 v243, a123
  v_mfma_f32_16x16x32_bf16 v[100:103], v[64:67], a[244:247], v[100:103]
  s_add_u32 s64, s64, 4096
  ds_read_b64_tr_b16 v[44:45], v13 offset:256
  v_cvt_pk_bf16_f32 v232, v236, v237
  v_mfma_f32_16x16x32_bf16 v[116:119], v[68:71], a[244:247], v[116:119]
  ds_read_b64_tr_b16 v[46:47], v13 offset:1280
  v_cvt_pk_bf16_f32 v233, v238, v239
  v_mfma_f32_16x16x32_bf16 v[132:135], v[72:75], a[244:247], v[132:135]
  s_add_u32 m0, s24, 16384
  ds_read_b64_tr_b16 v[48:49], v12 offset:512
  v_cvt_pk_bf16_f32 v234, v240, v241
  v_mfma_f32_16x16x32_bf16 v[148:151], v[76:79], a[244:247], v[148:151]
  buffer_load_dwordx4 v8, s[36:39], s27 offen offset:0 lds
  v_cvt_pk_bf16_f32 v235, v242, v243
  v_mfma_f32_16x16x32_bf16 v[164:167], v[80:83], a[244:247], v[164:167]
  ds_read_b64_tr_b16 v[50:51], v12 offset:1536
  v_mfma_f32_16x16x32_bf16 v[180:183], v[84:87], a[244:247], v[180:183]
  s_add_u32 s63, s63, s61
  ds_read_b64_tr_b16 v[52:53], v13 offset:512
  v_mfma_f32_16x16x32_bf16 v[196:199], v[88:91], a[244:247], v[196:199]
  ds_read_b64_tr_b16 v[54:55], v13 offset:1536
  v_mfma_f32_16x16x32_bf16 v[212:215], v[92:95], a[244:247], v[212:215]
  buffer_load_dwordx4 a[244:247], v2, s[40:43], s65 offen offset:3072 sc1
  v_mfma_f32_16x16x32_bf16 v[104:107], v[64:67], a[248:251], v[104:107]
  s_add_u32 s65, s65, 4096
  ds_read_b64_tr_b16 v[56:57], v12 offset:768
  v_accvgpr_read_b32 v248, a92
  v_mfma_f32_16x16x32_bf16 v[120:123], v[68:71], a[248:251], v[120:123]
  ds_read_b64_tr_b16 v[58:59], v12 offset:1792
  v_accvgpr_read_b32 v249, a93
  v_mfma_f32_16x16x32_bf16 v[136:139], v[72:75], a[248:251], v[136:139]
  ds_read_b64_tr_b16 v[60:61], v13 offset:768
  v_accvgpr_read_b32 v250, a94
  v_mfma_f32_16x16x32_bf16 v[152:155], v[76:79], a[248:251], v[152:155]
  buffer_load_dwordx4 v9, s[36:39], s27 offen offset:1024 lds
  v_accvgpr_read_b32 v251, a95
  v_mfma_f32_16x16x32_bf16 v[168:171], v[80:83], a[248:251], v[168:171]
  ds_read_b64_tr_b16 v[62:63], v13 offset:1792
  v_accvgpr_read_b32 v252, a124
  v_mfma_f32_16x16x32_bf16 v[184:187], v[84:87], a[248:251], v[184:187]
  buffer_store_dwordx4 v[232:235], v2, s[40:43], s63 offen offset:0 sc1
  v_accvgpr_read_b32 v253, a125
  v_mfma_f32_16x16x32_bf16 v[200:203], v[88:91], a[248:251], v[200:203]
  buffer_load_dwordx4 v10, s[36:39], s27 offen offset:2048 lds
  v_accvgpr_read_b32 v254, a126
  v_mfma_f32_16x16x32_bf16 v[216:219], v[92:95], a[248:251], v[216:219]
  buffer_load_dwordx4 a[248:251], v2, s[40:43], s66 offen offset:3072 sc1
  v_accvgpr_read_b32 v255, a127
  v_mfma_f32_16x16x32_bf16 v[108:111], v[64:67], a[252:255], v[108:111]
  s_add_u32 s66, s66, 4096
  v_cvt_pk_bf16_f32 v244, v248, v249
  v_mfma_f32_16x16x32_bf16 v[124:127], v[68:71], a[252:255], v[124:127]
  buffer_load_dwordx4 v11, s[36:39], s27 offen offset:3072 lds
  v_cvt_pk_bf16_f32 v245, v250, v251
  v_mfma_f32_16x16x32_bf16 v[140:143], v[72:75], a[252:255], v[140:143]
  s_add_u32 s27, s27, 524288
  v_cvt_pk_bf16_f32 v246, v252, v253
  v_mfma_f32_16x16x32_bf16 v[156:159], v[76:79], a[252:255], v[156:159]
  s_add_u32 s24, s24, 32768
  v_cvt_pk_bf16_f32 v247, v254, v255
  v_mfma_f32_16x16x32_bf16 v[172:175], v[80:83], a[252:255], v[172:175]
  s_and_b32 s24, s24, 0x1ffff
  v_mfma_f32_16x16x32_bf16 v[188:191], v[84:87], a[252:255], v[188:191]
  buffer_store_dwordx4 v[244:247], v2, s[40:43], s63 offen offset:1024 sc1
  v_mfma_f32_16x16x32_bf16 v[204:207], v[88:91], a[252:255], v[204:207]
  v_mfma_f32_16x16x32_bf16 v[220:223], v[92:95], a[252:255], v[220:223]
  s_waitcnt vmcnt(25) lgkmcnt(0)
  buffer_load_dwordx4 a[252:255], v2, s[40:43], s67 offen offset:3072 sc1
  v_mfma_f32_16x16x32_bf16 v[96:99], v[32:35], a[192:195], v[96:99]
  v_accvgpr_read_b32 v236, a128
  v_mfma_f32_16x16x32_bf16 v[112:115], v[36:39], a[192:195], v[112:115]
  s_add_u32 s67, s67, 4096
  ds_read_b64_tr_b16 v[64:65], v12 offset:8192
  v_accvgpr_read_b32 v237, a129
  v_mfma_f32_16x16x32_bf16 v[128:131], v[40:43], a[192:195], v[128:131]
  ds_read_b64_tr_b16 v[66:67], v12 offset:9216
  v_accvgpr_read_b32 v238, a130
  v_mfma_f32_16x16x32_bf16 v[144:147], v[44:47], a[192:195], v[144:147]
  ds_read_b64_tr_b16 v[68:69], v13 offset:8192
  v_accvgpr_read_b32 v239, a131
  v_mfma_f32_16x16x32_bf16 v[160:163], v[48:51], a[192:195], v[160:163]
  ds_read_b64_tr_b16 v[70:71], v13 offset:9216
  v_accvgpr_read_b32 v240, a160
  v_mfma_f32_16x16x32_bf16 v[176:179], v[52:55], a[192:195], v[176:179]
  ds_read_b64_tr_b16 v[72:73], v12 offset:8448
  v_accvgpr_read_b32 v241, a161
  v_mfma_f32_16x16x32_bf16 v[192:195], v[56:59], a[192:195], v[192:195]
  ds_read_b64_tr_b16 v[74:75], v12 offset:9472
  v_accvgpr_read_b32 v242, a162
  v_mfma_f32_16x16x32_bf16 v[208:211], v[60:63], a[192:195], v[208:211]
  buffer_load_dwordx4 a[192:195], v2, s[40:43], s64 offen offset:0 sc1
  v_accvgpr_read_b32 v243, a163
  v_mfma_f32_16x16x32_bf16 v[100:103], v[32:35], a[196:199], v[100:103]
  ds_read_b64_tr_b16 v[76:77], v13 offset:8448
  v_cvt_pk_bf16_f32 v232, v236, v237
  v_mfma_f32_16x16x32_bf16 v[116:119], v[36:39], a[196:199], v[116:119]
  ds_read_b64_tr_b16 v[78:79], v13 offset:9472
  v_cvt_pk_bf16_f32 v233, v238, v239
  v_mfma_f32_16x16x32_bf16 v[132:135], v[40:43], a[196:199], v[132:135]
  ds_read_b64_tr_b16 v[80:81], v12 offset:8704
  v_cvt_pk_bf16_f32 v234, v240, v241
  v_mfma_f32_16x16x32_bf16 v[148:151], v[44:47], a[196:199], v[148:151]
  v_cvt_pk_bf16_f32 v235, v242, v243
  v_mfma_f32_16x16x32_bf16 v[164:167], v[48:51], a[196:199], v[164:167]
  ds_read_b64_tr_b16 v[82:83], v12 offset:9728
  v_mfma_f32_16x16x32_bf16 v[180:183], v[52:55], a[196:199], v[180:183]
  s_mul_i32 s63, s60, 2
  ds_read_b64_tr_b16 v[84:85], v13 offset:8704
  v_mfma_f32_16x16x32_bf16 v[196:199], v[56:59], a[196:199], v[196:199]
  s_add_u32 s63, s63, s62
  ds_read_b64_tr_b16 v[86:87], v13 offset:9728
  v_mfma_f32_16x16x32_bf16 v[212:215], v[60:63], a[196:199], v[212:215]
  buffer_load_dwordx4 a[196:199], v2, s[40:43], s65 offen offset:0 sc1
  v_mfma_f32_16x16x32_bf16 v[104:107], v[32:35], a[200:203], v[104:107]
  ds_read_b64_tr_b16 v[88:89], v12 offset:8960
  v_accvgpr_read_b32 v248, a132
  v_mfma_f32_16x16x32_bf16 v[120:123], v[36:39], a[200:203], v[120:123]
  ds_read_b64_tr_b16 v[90:91], v12 offset:9984
  v_accvgpr_read_b32 v249, a133
  v_mfma_f32_16x16x32_bf16 v[136:139], v[40:43], a[200:203], v[136:139]
  ds_read_b64_tr_b16 v[92:93], v13 offset:8960
  v_accvgpr_read_b32 v250, a134
  v_mfma_f32_16x16x32_bf16 v[152:155], v[44:47], a[200:203], v[152:155]
  v_accvgpr_read_b32 v251, a135
  v_mfma_f32_16x16x32_bf16 v[168:171], v[48:51], a[200:203], v[168:171]
  ds_read_b64_tr_b16 v[94:95], v13 offset:9984
  v_accvgpr_read_b32 v252, a164
  v_mfma_f32_16x16x32_bf16 v[184:187], v[52:55], a[200:203], v[184:187]
  buffer_store_dwordx4 v[232:235], v2, s[40:43], s63 offen offset:0 sc1
  v_accvgpr_read_b32 v253, a165
  v_mfma_f32_16x16x32_bf16 v[200:203], v[56:59], a[200:203], v[200:203]
  v_accvgpr_read_b32 v254, a166
  v_mfma_f32_16x16x32_bf16 v[216:219], v[60:63], a[200:203], v[216:219]
  buffer_load_dwordx4 a[200:203], v2, s[40:43], s66 offen offset:0 sc1
  v_accvgpr_read_b32 v255, a167
  v_mfma_f32_16x16x32_bf16 v[108:111], v[32:35], a[204:207], v[108:111]
  v_cvt_pk_bf16_f32 v244, v248, v249
  v_mfma_f32_16x16x32_bf16 v[124:127], v[36:39], a[204:207], v[124:127]
  v_cvt_pk_bf16_f32 v245, v250, v251
  v_mfma_f32_16x16x32_bf16 v[140:143], v[40:43], a[204:207], v[140:143]
  v_cvt_pk_bf16_f32 v246, v252, v253
  v_mfma_f32_16x16x32_bf16 v[156:159], v[44:47], a[204:207], v[156:159]
  v_cvt_pk_bf16_f32 v247, v254, v255
  v_mfma_f32_16x16x32_bf16 v[172:175], v[48:51], a[204:207], v[172:175]
  v_mfma_f32_16x16x32_bf16 v[188:191], v[52:55], a[204:207], v[188:191]
  buffer_store_dwordx4 v[244:247], v2, s[40:43], s63 offen offset:1024 sc1
  v_mfma_f32_16x16x32_bf16 v[204:207], v[56:59], a[204:207], v[204:207]
  v_mfma_f32_16x16x32_bf16 v[220:223], v[60:63], a[204:207], v[220:223]
  s_waitcnt vmcnt(21) lgkmcnt(0)
  buffer_load_dwordx4 a[204:207], v2, s[40:43], s67 offen offset:0 sc1
  v_mfma_f32_16x16x32_bf16 v[96:99], v[64:67], a[208:211], v[96:99]
  s_barrier
  v_accvgpr_read_b32 v236, a136
  v_mfma_f32_16x16x32_bf16 v[112:115], v[68:71], a[208:211], v[112:115]
  ds_read_b64_tr_b16 v[32:33], v12 offset:32768
  v_accvgpr_read_b32 v237, a137
  v_mfma_f32_16x16x32_bf16 v[128:131], v[72:75], a[208:211], v[128:131]
  ds_read_b64_tr_b16 v[34:35], v12 offset:33792
  v_accvgpr_read_b32 v238, a138
  v_mfma_f32_16x16x32_bf16 v[144:147], v[76:79], a[208:211], v[144:147]
  ds_read_b64_tr_b16 v[36:37], v13 offset:32768
  v_accvgpr_read_b32 v239, a139
  v_mfma_f32_16x16x32_bf16 v[160:163], v[80:83], a[208:211], v[160:163]
  ds_read_b64_tr_b16 v[38:39], v13 offset:33792
  v_accvgpr_read_b32 v240, a168
  v_mfma_f32_16x16x32_bf16 v[176:179], v[84:87], a[208:211], v[176:179]
  ds_read_b64_tr_b16 v[40:41], v12 offset:33024
  v_accvgpr_read_b32 v241, a169
  v_mfma_f32_16x16x32_bf16 v[192:195], v[88:91], a[208:211], v[192:195]
  ds_read_b64_tr_b16 v[42:43], v12 offset:34048
  v_accvgpr_read_b32 v242, a170
  v_mfma_f32_16x16x32_bf16 v[208:211], v[92:95], a[208:211], v[208:211]
  buffer_load_dwordx4 a[208:211], v2, s[40:43], s64 offen offset:1024 sc1
  v_accvgpr_read_b32 v243, a171
  v_mfma_f32_16x16x32_bf16 v[100:103], v[64:67], a[212:215], v[100:103]
  ds_read_b64_tr_b16 v[44:45], v13 offset:33024
  v_cvt_pk_bf16_f32 v232, v236, v237
  v_mfma_f32_16x16x32_bf16 v[116:119], v[68:71], a[212:215], v[116:119]
  ds_read_b64_tr_b16 v[46:47], v13 offset:34048
  v_cvt_pk_bf16_f32 v233, v238, v239
  v_mfma_f32_16x16x32_bf16 v[132:135], v[72:75], a[212:215], v[132:135]
  s_add_u32 m0, s24, 16384
  ds_read_b64_tr_b16 v[48:49], v12 offset:33280
  v_cvt_pk_bf16_f32 v234, v240, v241
  v_mfma_f32_16x16x32_bf16 v[148:151], v[76:79], a[212:215], v[148:151]
  buffer_load_dwordx4 v8, s[36:39], s27 offen offset:0 lds
  v_cvt_pk_bf16_f32 v235, v242, v243
  v_mfma_f32_16x16x32_bf16 v[164:167], v[80:83], a[212:215], v[164:167]
  ds_read_b64_tr_b16 v[50:51], v12 offset:34304
  v_mfma_f32_16x16x32_bf16 v[180:183], v[84:87], a[212:215], v[180:183]
  s_add_u32 s63, s63, s61
  ds_read_b64_tr_b16 v[52:53], v13 offset:33280
  v_mfma_f32_16x16x32_bf16 v[196:199], v[88:91], a[212:215], v[196:199]
  ds_read_b64_tr_b16 v[54:55], v13 offset:34304
  v_mfma_f32_16x16x32_bf16 v[212:215], v[92:95], a[212:215], v[212:215]
  buffer_load_dwordx4 a[212:215], v2, s[40:43], s65 offen offset:1024 sc1
  v_mfma_f32_16x16x32_bf16 v[104:107], v[64:67], a[216:219], v[104:107]
  ds_read_b64_tr_b16 v[56:57], v12 offset:33536
  v_accvgpr_read_b32 v248, a140
  v_mfma_f32_16x16x32_bf16 v[120:123], v[68:71], a[216:219], v[120:123]
  ds_read_b64_tr_b16 v[58:59], v12 offset:34560
  v_accvgpr_read_b32 v249, a141
  v_mfma_f32_16x16x32_bf16 v[136:139], v[72:75], a[216:219], v[136:139]
  ds_read_b64_tr_b16 v[60:61], v13 offset:33536
  v_accvgpr_read_b32 v250, a142
  v_mfma_f32_16x16x32_bf16 v[152:155], v[76:79], a[216:219], v[152:155]
  buffer_load_dwordx4 v9, s[36:39], s27 offen offset:1024 lds
  v_accvgpr_read_b32 v251, a143
  v_mfma_f32_16x16x32_bf16 v[168:171], v[80:83], a[216:219], v[168:171]
  ds_read_b64_tr_b16 v[62:63], v13 offset:34560
  v_accvgpr_read_b32 v252, a172
  v_mfma_f32_16x16x32_bf16 v[184:187], v[84:87], a[216:219], v[184:187]
  buffer_store_dwordx4 v[232:235], v2, s[40:43], s63 offen offset:0 sc1
  v_accvgpr_read_b32 v253, a173
  v_mfma_f32_16x16x32_bf16 v[200:203], v[88:91], a[216:219], v[200:203]
  buffer_load_dwordx4 v10, s[36:39], s27 offen offset:2048 lds
  v_accvgpr_read_b32 v254, a174
  v_mfma_f32_16x16x32_bf16 v[216:219], v[92:95], a[216:219], v[216:219]
  buffer_load_dwordx4 a[216:219], v2, s[40:43], s66 offen offset:1024 sc1
  v_accvgpr_read_b32 v255, a175
  v_mfma_f32_16x16x32_bf16 v[108:111], v[64:67], a[220:223], v[108:111]
  v_cvt_pk_bf16_f32 v244, v248, v249
  v_mfma_f32_16x16x32_bf16 v[124:127], v[68:71], a[220:223], v[124:127]
  buffer_load_dwordx4 v11, s[36:39], s27 offen offset:3072 lds
  v_cvt_pk_bf16_f32 v245, v250, v251
  v_mfma_f32_16x16x32_bf16 v[140:143], v[72:75], a[220:223], v[140:143]
  s_add_u32 s27, s27, 524288
  v_cvt_pk_bf16_f32 v246, v252, v253
  v_mfma_f32_16x16x32_bf16 v[156:159], v[76:79], a[220:223], v[156:159]
  s_add_u32 s24, s24, 32768
  v_cvt_pk_bf16_f32 v247, v254, v255
  v_mfma_f32_16x16x32_bf16 v[172:175], v[80:83], a[220:223], v[172:175]
  s_and_b32 s24, s24, 0x1ffff
  v_mfma_f32_16x16x32_bf16 v[188:191], v[84:87], a[220:223], v[188:191]
  buffer_store_dwordx4 v[244:247], v2, s[40:43], s63 offen offset:1024 sc1
  v_mfma_f32_16x16x32_bf16 v[204:207], v[88:91], a[220:223], v[204:207]
  v_mfma_f32_16x16x32_bf16 v[220:223], v[92:95], a[220:223], v[220:223]
  s_waitcnt vmcnt(25) lgkmcnt(0)
  buffer_load_dwordx4 a[220:223], v2, s[40:43], s67 offen offset:1024 sc1
  v_mfma_f32_16x16x32_bf16 v[96:99], v[32:35], a[224:227], v[96:99]
  v_accvgpr_read_b32 v236, a144
  v_mfma_f32_16x16x32_bf16 v[112:115], v[36:39], a[224:227], v[112:115]
  ds_read_b64_tr_b16 v[64:65], v12 offset:40960
  v_accvgpr_read_b32 v237, a145
  v_mfma_f32_16x16x32_bf16 v[128:131], v[40:43], a[224:227], v[128:131]
  ds_read_b64_tr_b16 v[66:67], v12 offset:41984
  v_accvgpr_read_b32 v238, a146
  v_mfma_f32_16x16x32_bf16 v[144:147], v[44:47], a[224:227], v[144:147]
  ds_read_b64_tr_b16 v[68:69], v13 offset:40960
  v_accvgpr_read_b32 v239, a147
  v_mfma_f32_16x16x32_bf16 v[160:163], v[48:51], a[224:227], v[160:163]
  ds_read_b64_tr_b16 v[70:71], v13 offset:41984
  v_accvgpr_read_b32 v240, a176
  v_mfma_f32_16x16x32_bf16 v[176:179], v[52:55], a[224:227], v[176:179]
  ds_read_b64_tr_b16 v[72:73], v12 offset:41216
  v_accvgpr_read_b32 v241, a177
  v_mfma_f32_16x16x32_bf16 v[192:195], v[56:59], a[224:227], v[192:195]
  ds_read_b64_tr_b16 v[74:75], v12 offset:42240
  v_accvgpr_read_b32 v242, a178
  v_mfma_f32_16x16x32_bf16 v[208:211], v[60:63], a[224:227], v[208:211]
  buffer_load_dwordx4 a[224:227], v2, s[40:43], s64 offen offset:2048 sc1
  v_accvgpr_read_b32 v243, a179
  v_mfma_f32_16x16x32_bf16 v[100:103], v[32:35], a[228:231], v[100:103]
  ds_read_b64_tr_b16 v[76:77], v13 offset:41216
  v_cvt_pk_bf16_f32 v232, v236, v237
  v_mfma_f32_16x16x32_bf16 v[116:119], v[36:39], a[228:231], v[116:119]
  ds_read_b64_tr_b16 v[78:79], v13 offset:42240
  v_cvt_pk_bf16_f32 v233, v238, v239
  v_mfma_f32_16x16x32_bf16 v[132:135], v[40:43], a[228:231], v[132:135]
  ds_read_b64_tr_b16 v[80:81], v12 offset:41472
  v_cvt_pk_bf16_f32 v234, v240, v241
  v_mfma_f32_16x16x32_bf16 v[148:151], v[44:47], a[228:231], v[148:151]
  v_cvt_pk_bf16_f32 v235, v242, v243
  v_mfma_f32_16x16x32_bf16 v[164:167], v[48:51], a[228:231], v[164:167]
  ds_read_b64_tr_b16 v[82:83], v12 offset:42496
  v_mfma_f32_16x16x32_bf16 v[180:183], v[52:55], a[228:231], v[180:183]
  s_add_u32 s63, s63, s61
  ds_read_b64_tr_b16 v[84:85], v13 offset:41472
  v_mfma_f32_16x16x32_bf16 v[196:199], v[56:59], a[228:231], v[196:199]
  ds_read_b64_tr_b16 v[86:87], v13 offset:42496
  v_mfma_f32_16x16x32_bf16 v[212:215], v[60:63], a[228:231], v[212:215]
  buffer_load_dwordx4 a[228:231], v2, s[40:43], s65 offen offset:2048 sc1
  v_mfma_f32_16x16x32_bf16 v[104:107], v[32:35], a[232:235], v[104:107]
  ds_read_b64_tr_b16 v[88:89], v12 offset:41728
  v_accvgpr_read_b32 v248, a148
  v_mfma_f32_16x16x32_bf16 v[120:123], v[36:39], a[232:235], v[120:123]
  ds_read_b64_tr_b16 v[90:91], v12 offset:42752
  v_accvgpr_read_b32 v249, a149
  v_mfma_f32_16x16x32_bf16 v[136:139], v[40:43], a[232:235], v[136:139]
  ds_read_b64_tr_b16 v[92:93], v13 offset:41728
  v_accvgpr_read_b32 v250, a150
  v_mfma_f32_16x16x32_bf16 v[152:155], v[44:47], a[232:235], v[152:155]
  v_accvgpr_read_b32 v251, a151
  v_mfma_f32_16x16x32_bf16 v[168:171], v[48:51], a[232:235], v[168:171]
  ds_read_b64_tr_b16 v[94:95], v13 offset:42752
  v_accvgpr_read_b32 v252, a180
  v_mfma_f32_16x16x32_bf16 v[184:187], v[52:55], a[232:235], v[184:187]
  buffer_store_dwordx4 v[232:235], v2, s[40:43], s63 offen offset:0 sc1
  v_accvgpr_read_b32 v253, a181
  v_mfma_f32_16x16x32_bf16 v[200:203], v[56:59], a[232:235], v[200:203]
  v_accvgpr_read_b32 v254, a182
  v_mfma_f32_16x16x32_bf16 v[216:219], v[60:63], a[232:235], v[216:219]
  buffer_load_dwordx4 a[232:235], v2, s[40:43], s66 offen offset:2048 sc1
  v_accvgpr_read_b32 v255, a183
  v_mfma_f32_16x16x32_bf16 v[108:111], v[32:35], a[236:239], v[108:111]
  v_xor_b32 v12, 0x10000, v12
  v_cvt_pk_bf16_f32 v244, v248, v249
  v_mfma_f32_16x16x32_bf16 v[124:127], v[36:39], a[236:239], v[124:127]
  v_cvt_pk_bf16_f32 v245, v250, v251
  v_mfma_f32_16x16x32_bf16 v[140:143], v[40:43], a[236:239], v[140:143]
  v_xor_b32 v13, 0x10000, v13
  v_cvt_pk_bf16_f32 v246, v252, v253
  v_mfma_f32_16x16x32_bf16 v[156:159], v[44:47], a[236:239], v[156:159]
  v_cvt_pk_bf16_f32 v247, v254, v255
  v_mfma_f32_16x16x32_bf16 v[172:175], v[48:51], a[236:239], v[172:175]
  v_mfma_f32_16x16x32_bf16 v[188:191], v[52:55], a[236:239], v[188:191]
  buffer_store_dwordx4 v[244:247], v2, s[40:43], s63 offen offset:1024 sc1
  v_mfma_f32_16x16x32_bf16 v[204:207], v[56:59], a[236:239], v[204:207]
  v_mfma_f32_16x16x32_bf16 v[220:223], v[60:63], a[236:239], v[220:223]
  s_waitcnt vmcnt(21) lgkmcnt(0)
  buffer_load_dwordx4 a[236:239], v2, s[40:43], s67 offen offset:2048 sc1
  v_mfma_f32_16x16x32_bf16 v[96:99], v[64:67], a[240:243], v[96:99]
  s_barrier
  v_accvgpr_read_b32 v236, a152
  v_mfma_f32_16x16x32_bf16 v[112:115], v[68:71], a[240:243], v[112:115]
  ds_read_b64_tr_b16 v[32:33], v12 offset:0
  v_accvgpr_read_b32 v237, a153
  v_mfma_f32_16x16x32_bf16 v[128:131], v[72:75], a[240:243], v[128:131]
  ds_read_b64_tr_b16 v[34:35], v12 offset:1024
  v_accvgpr_read_b32 v238, a154
  v_mfma_f32_16x16x32_bf16 v[144:147], v[76:79], a[240:243], v[144:147]
  ds_read_b64_tr_b16 v[36:37], v13 offset:0
  v_accvgpr_read_b32 v239, a155
  v_mfma_f32_16x16x32_bf16 v[160:163], v[80:83], a[240:243], v[160:163]
  ds_read_b64_tr_b16 v[38:39], v13 offset:1024
  v_accvgpr_read_b32 v240, a184
  v_mfma_f32_16x16x32_bf16 v[176:179], v[84:87], a[240:243], v[176:179]
  ds_read_b64_tr_b16 v[40:41], v12 offset:256
  v_accvgpr_read_b32 v241, a185
  v_mfma_f32_16x16x32_bf16 v[192:195], v[88:91], a[240:243], v[192:195]
  ds_read_b64_tr_b16 v[42:43], v12 offset:1280
  v_accvgpr_read_b32 v242, a186
  v_mfma_f32_16x16x32_bf16 v[208:211], v[92:95], a[240:243], v[208:211]
  buffer_load_dwordx4 a[240:243], v2, s[40:43], s64 offen offset:3072 sc1
  v_accvgpr_read_b32 v243, a187
  v_mfma_f32_16x16x32_bf16 v[100:103], v[64:67], a[244:247], v[100:103]
  s_add_u32 s64, s64, 4096
  ds_read_b64_tr_b16 v[44:45], v13 offset:256
  v_cvt_pk_bf16_f32 v232, v236, v237
  v_mfma_f32_16x16x32_bf16 v[116:119], v[68:71], a[244:247], v[116:119]
  ds_read_b64_tr_b16 v[46:47], v13 offset:1280
  v_cvt_pk_bf16_f32 v233, v238, v239
  v_mfma_f32_16x16x32_bf16 v[132:135], v[72:75], a[244:247], v[132:135]
  s_add_u32 m0, s24, 16384
  ds_read_b64_tr_b16 v[48:49], v12 offset:512
  v_cvt_pk_bf16_f32 v234, v240, v241
  v_mfma_f32_16x16x32_bf16 v[148:151], v[76:79], a[244:247], v[148:151]
  buffer_load_dwordx4 v8, s[36:39], s27 offen offset:0 lds
  v_cvt_pk_bf16_f32 v235, v242, v243
  v_mfma_f32_16x16x32_bf16 v[164:167], v[80:83], a[244:247], v[164:167]
  ds_read_b64_tr_b16 v[50:51], v12 offset:1536
  v_mfma_f32_16x16x32_bf16 v[180:183], v[84:87], a[244:247], v[180:183]
  s_add_u32 s63, s63, s61
  ds_read_b64_tr_b16 v[52:53], v13 offset:512
  v_mfma_f32_16x16x32_bf16 v[196:199], v[88:91], a[244:247], v[196:199]
  ds_read_b64_tr_b16 v[54:55], v13 offset:1536
  v_mfma_f32_16x16x32_bf16 v[212:215], v[92:95], a[244:247], v[212:215]
  buffer_load_dwordx4 a[244:247], v2, s[40:43], s65 offen offset:3072 sc1
  v_mfma_f32_16x16x32_bf16 v[104:107], v[64:67], a[248:251], v[104:107]
  s_add_u32 s65, s65, 4096
  ds_read_b64_tr_b16 v[56:57], v12 offset:768
  v_accvgpr_read_b32 v248, a156
  v_mfma_f32_16x16x32_bf16 v[120:123], v[68:71], a[248:251], v[120:123]
  ds_read_b64_tr_b16 v[58:59], v12 offset:1792
  v_accvgpr_read_b32 v249, a157
  v_mfma_f32_16x16x32_bf16 v[136:139], v[72:75], a[248:251], v[136:139]
  ds_read_b64_tr_b16 v[60:61], v13 offset:768
  v_accvgpr_read_b32 v250, a158
  v_mfma_f32_16x16x32_bf16 v[152:155], v[76:79], a[248:251], v[152:155]
  buffer_load_dwordx4 v9, s[36:39], s27 offen offset:1024 lds
  v_accvgpr_read_b32 v251, a159
  v_mfma_f32_16x16x32_bf16 v[168:171], v[80:83], a[248:251], v[168:171]
  ds_read_b64_tr_b16 v[62:63], v13 offset:1792
  v_accvgpr_read_b32 v252, a188
  v_mfma_f32_16x16x32_bf16 v[184:187], v[84:87], a[248:251], v[184:187]
  buffer_store_dwordx4 v[232:235], v2, s[40:43], s63 offen offset:0 sc1
  v_accvgpr_read_b32 v253, a189
  v_mfma_f32_16x16x32_bf16 v[200:203], v[88:91], a[248:251], v[200:203]
  buffer_load_dwordx4 v10, s[36:39], s27 offen offset:2048 lds
  v_accvgpr_read_b32 v254, a190
  v_mfma_f32_16x16x32_bf16 v[216:219], v[92:95], a[248:251], v[216:219]
  buffer_load_dwordx4 a[248:251], v2, s[40:43], s66 offen offset:3072 sc1
  v_accvgpr_read_b32 v255, a191
  v_mfma_f32_16x16x32_bf16 v[108:111], v[64:67], a[252:255], v[108:111]
  s_add_u32 s66, s66, 4096
  v_cvt_pk_bf16_f32 v244, v248, v249
  v_mfma_f32_16x16x32_bf16 v[124:127], v[68:71], a[252:255], v[124:127]
  buffer_load_dwordx4 v11, s[36:39], s27 offen offset:3072 lds
  v_cvt_pk_bf16_f32 v245, v250, v251
  v_mfma_f32_16x16x32_bf16 v[140:143], v[72:75], a[252:255], v[140:143]
  s_add_u32 s27, s27, 524288
  v_cvt_pk_bf16_f32 v246, v252, v253
  v_mfma_f32_16x16x32_bf16 v[156:159], v[76:79], a[252:255], v[156:159]
  s_add_u32 s24, s24, 32768
  v_cvt_pk_bf16_f32 v247, v254, v255
  v_mfma_f32_16x16x32_bf16 v[172:175], v[80:83], a[252:255], v[172:175]
  s_and_b32 s24, s24, 0x1ffff
  v_mfma_f32_16x16x32_bf16 v[188:191], v[84:87], a[252:255], v[188:191]
  buffer_store_dwordx4 v[244:247], v2, s[40:43], s63 offen offset:1024 sc1
  v_mfma_f32_16x16x32_bf16 v[204:207], v[88:91], a[252:255], v[204:207]
  v_mfma_f32_16x16x32_bf16 v[220:223], v[92:95], a[252:255], v[220:223]
  s_waitcnt vmcnt(25) lgkmcnt(0)
  buffer_load_dwordx4 a[252:255], v2, s[40:43], s67 offen offset:3072 sc1
  v_mfma_f32_16x16x32_bf16 v[96:99], v[32:35], a[192:195], v[96:99]
  v_and_b32 v16, 15, v1
  v_mfma_f32_16x16x32_bf16 v[112:115], v[36:39], a[192:195], v[112:115]
  s_add_u32 s67, s67, 4096
  ds_read_b64_tr_b16 v[64:65], v12 offset:8192
  v_lshrrev_b32 v17, 4, v1
  v_mfma_f32_16x16x32_bf16 v[128:131], v[40:43], a[192:195], v[128:131]
  ds_read_b64_tr_b16 v[66:67], v12 offset:9216
  v_lshlrev_b32 v17, 2, v17
  v_mfma_f32_16x16x32_bf16 v[144:147], v[44:47], a[192:195], v[144:147]
  ds_read_b64_tr_b16 v[68:69], v13 offset:8192
  v_sub_u32 v16, v16, v17
  v_mfma_f32_16x16x32_bf16 v[160:163], v[48:51], a[192:195], v[160:163]
  ds_read_b64_tr_b16 v[70:71], v13 offset:9216
  v_cmp_le_i32 s[68:69], 0, v16
  v_mfma_f32_16x16x32_bf16 v[176:179], v[52:55], a[192:195], v[176:179]
  ds_read_b64_tr_b16 v[72:73], v12 offset:8448
  v_cmp_le_i32 s[70:71], 1, v16
  v_mfma_f32_16x16x32_bf16 v[192:195], v[56:59], a[192:195], v[192:195]
  ds_read_b64_tr_b16 v[74:75], v12 offset:9472
  v_cmp_le_i32 s[72:73], 2, v16
  v_mfma_f32_16x16x32_bf16 v[208:211], v[60:63], a[192:195], v[208:211]
  buffer_load_dwordx4 a[192:195], v2, s[40:43], s64 offen offset:0 sc1
  v_mfma_f32_16x16x32_bf16 v[100:103], v[32:35], a[196:199], v[100:103]
  ds_read_b64_tr_b16 v[76:77], v13 offset:8448
  v_mfma_f32_16x16x32_bf16 v[116:119], v[36:39], a[196:199], v[116:119]
  ds_read_b64_tr_b16 v[78:79], v13 offset:9472
  v_mfma_f32_16x16x32_bf16 v[132:135], v[40:43], a[196:199], v[132:135]
  ds_read_b64_tr_b16 v[80:81], v12 offset:8704
  v_mfma_f32_16x16x32_bf16 v[148:151], v[44:47], a[196:199], v[148:151]
  v_cmp_le_i32 s[74:75], 3, v16
  v_mfma_f32_16x16x32_bf16 v[164:167], v[48:51], a[196:199], v[164:167]
  ds_read_b64_tr_b16 v[82:83], v12 offset:9728
  v_mfma_f32_16x16x32_bf16 v[180:183], v[52:55], a[196:199], v[180:183]
  ds_read_b64_tr_b16 v[84:85], v13 offset:8704
  v_mfma_f32_16x16x32_bf16 v[196:199], v[56:59], a[196:199], v[196:199]
  ds_read_b64_tr_b16 v[86:87], v13 offset:9728
  v_mfma_f32_16x16x32_bf16 v[212:215], v[60:63], a[196:199], v[212:215]
  buffer_load_dwordx4 a[196:199], v2, s[40:43], s65 offen offset:0 sc1
  v_mfma_f32_16x16x32_bf16 v[104:107], v[32:35], a[200:203], v[104:107]
  ds_read_b64_tr_b16 v[88:89], v12 offset:8960
  v_mfma_f32_16x16x32_bf16 v[120:123], v[36:39], a[200:203], v[120:123]
  ds_read_b64_tr_b16 v[90:91], v12 offset:9984
  v_mfma_f32_16x16x32_bf16 v[136:139], v[40:43], a[200:203], v[136:139]
  ds_read_b64_tr_b16 v[92:93], v13 offset:8960
  v_mfma_f32_16x16x32_bf16 v[152:155], v[44:47], a[200:203], v[152:155]
  v_mov_b32 v4, 0xff800000
  v_mfma_f32_16x16x32_bf16 v[168:171], v[48:51], a[200:203], v[168:171]
  ds_read_b64_tr_b16 v[94:95], v13 offset:9984
  v_mfma_f32_16x16x32_bf16 v[184:187], v[52:55], a[200:203], v[184:187]
  v_and_b32 v230, 7, v1
  v_mfma_f32_16x16x32_bf16 v[200:203], v[56:59], a[200:203], v[200:203]
  v_lshlrev_b32 v230, 2, v230
  v_mfma_f32_16x16x32_bf16 v[216:219], v[60:63], a[200:203], v[216:219]
  buffer_load_dwordx4 a[200:203], v2, s[40:43], s66 offen offset:0 sc1
  v_mfma_f32_16x16x32_bf16 v[108:111], v[32:35], a[204:207], v[108:111]
  v_add_u32 v230, s30, v230
  v_mfma_f32_16x16x32_bf16 v[124:127], v[36:39], a[204:207], v[124:127]
  v_mov_b32 v18, 1073741824
  v_mfma_f32_16x16x32_bf16 v[140:143], v[40:43], a[204:207], v[140:143]
  v_mov_b32 v19, 1
  v_mfma_f32_16x16x32_bf16 v[156:159], v[44:47], a[204:207], v[156:159]
  v_writelane_b32 v18, s29, 0
  v_mfma_f32_16x16x32_bf16 v[172:175], v[48:51], a[204:207], v[172:175]
  v_accvgpr_write_b32 a0, 0
  v_mfma_f32_16x16x32_bf16 v[188:191], v[52:55], a[204:207], v[188:191]
  v_accvgpr_write_b32 a1, 0
  v_mfma_f32_16x16x32_bf16 v[204:207], v[56:59], a[204:207], v[204:207]
  v_accvgpr_write_b32 a2, 0
  v_mfma_f32_16x16x32_bf16 v[220:223], v[60:63], a[204:207], v[220:223]
  s_waitcnt vmcnt(19) lgkmcnt(0)
  buffer_load_dwordx4 a[204:207], v2, s[40:43], s67 offen offset:0 sc1
  v_mfma_f32_16x16x32_bf16 v[96:99], v[64:67], a[208:211], v[96:99]
  s_barrier
  v_accvgpr_write_b32 a3, 0
  v_mfma_f32_16x16x32_bf16 v[112:115], v[68:71], a[208:211], v[112:115]
  ds_read_b64_tr_b16 v[32:33], v12 offset:32768
  v_accvgpr_write_b32 a4, 0
  v_mfma_f32_16x16x32_bf16 v[128:131], v[72:75], a[208:211], v[128:131]
  ds_read_b64_tr_b16 v[34:35], v12 offset:33792
  v_accvgpr_write_b32 a5, 0
  v_mfma_f32_16x16x32_bf16 v[144:147], v[76:79], a[208:211], v[144:147]
  ds_read_b64_tr_b16 v[36:37], v13 offset:32768
  v_accvgpr_write_b32 a6, 0
  v_mfma_f32_16x16x32_bf16 v[160:163], v[80:83], a[208:211], v[160:163]
  ds_read_b64_tr_b16 v[38:39], v13 offset:33792
  v_accvgpr_write_b32 a7, 0
  v_mfma_f32_16x16x32_bf16 v[176:179], v[84:87], a[208:211], v[176:179]
  ds_read_b64_tr_b16 v[40:41], v12 offset:33024
  v_accvgpr_write_b32 a8, 0
  v_mfma_f32_16x16x32_bf16 v[192:195], v[88:91], a[208:211], v[192:195]
  ds_read_b64_tr_b16 v[42:43], v12 offset:34048
  v_accvgpr_write_b32 a9, 0
  v_mfma_f32_16x16x32_bf16 v[208:211], v[92:95], a[208:211], v[208:211]
  buffer_load_dwordx4 a[208:211], v2, s[40:43], s64 offen offset:1024 sc1
  v_mfma_f32_16x16x32_bf16 v[100:103], v[64:67], a[212:215], v[100:103]
  ds_read_b64_tr_b16 v[44:45], v13 offset:33024
  v_mfma_f32_16x16x32_bf16 v[116:119], v[68:71], a[212:215], v[116:119]
  ds_read_b64_tr_b16 v[46:47], v13 offset:34048
  v_mfma_f32_16x16x32_bf16 v[132:135], v[72:75], a[212:215], v[132:135]
  ds_read_b64_tr_b16 v[48:49], v12 offset:33280
  v_mfma_f32_16x16x32_bf16 v[148:151], v[76:79], a[212:215], v[148:151]
  v_accvgpr_write_b32 a10, 0
  v_mfma_f32_16x16x32_bf16 v[164:167], v[80:83], a[212:215], v[164:167]
  ds_read_b64_tr_b16 v[50:51], v12 offset:34304
  v_mfma_f32_16x16x32_bf16 v[180:183], v[84:87], a[212:215], v[180:183]
  ds_read_b64_tr_b16 v[52:53], v13 offset:33280
  v_mfma_f32_16x16x32_bf16 v[196:199], v[88:91], a[212:215], v[196:199]
  ds_read_b64_tr_b16 v[54:55], v13 offset:34304
  v_mfma_f32_16x16x32_bf16 v[212:215], v[92:95], a[212:215], v[212:215]
  buffer_load_dwordx4 a[212:215], v2, s[40:43], s65 offen offset:1024 sc1
  v_mfma_f32_16x16x32_bf16 v[104:107], v[64:67], a[216:219], v[104:107]
  ds_read_b64_tr_b16 v[56:57], v12 offset:33536
  v_mfma_f32_16x16x32_bf16 v[120:123], v[68:71], a[216:219], v[120:123]
  ds_read_b64_tr_b16 v[58:59], v12 offset:34560
  v_mfma_f32_16x16x32_bf16 v[136:139], v[72:75], a[216:219], v[136:139]
  ds_read_b64_tr_b16 v[60:61], v13 offset:33536
  v_mfma_f32_16x16x32_bf16 v[152:155], v[76:79], a[216:219], v[152:155]
  v_accvgpr_write_b32 a11, 0
  v_mfma_f32_16x16x32_bf16 v[168:171], v[80:83], a[216:219], v[168:171]
  ds_read_b64_tr_b16 v[62:63], v13 offset:34560
  v_mfma_f32_16x16x32_bf16 v[184:187], v[84:87], a[216:219], v[184:187]
  v_accvgpr_write_b32 a12, 0
  v_mfma_f32_16x16x32_bf16 v[200:203], v[88:91], a[216:219], v[200:203]
  v_accvgpr_write_b32 a13, 0
  v_mfma_f32_16x16x32_bf16 v[216:219], v[92:95], a[216:219], v[216:219]
  buffer_load_dwordx4 a[216:219], v2, s[40:43], s66 offen offset:1024 sc1
  v_mfma_f32_16x16x32_bf16 v[108:111], v[64:67], a[220:223], v[108:111]
  v_accvgpr_write_b32 a14, 0
  v_mfma_f32_16x16x32_bf16 v[124:127], v[68:71], a[220:223], v[124:127]
  v_accvgpr_write_b32 a15, 0
  v_mfma_f32_16x16x32_bf16 v[140:143], v[72:75], a[220:223], v[140:143]
  v_accvgpr_write_b32 a16, 0
  v_mfma_f32_16x16x32_bf16 v[156:159], v[76:79], a[220:223], v[156:159]
  v_accvgpr_write_b32 a17, 0
  v_mfma_f32_16x16x32_bf16 v[172:175], v[80:83], a[220:223], v[172:175]
  v_accvgpr_write_b32 a18, 0
  v_mfma_f32_16x16x32_bf16 v[188:191], v[84:87], a[220:223], v[188:191]
  v_accvgpr_write_b32 a19, 0
  v_mfma_f32_16x16x32_bf16 v[204:207], v[88:91], a[220:223], v[204:207]
  v_accvgpr_write_b32 a20, 0
  v_mfma_f32_16x16x32_bf16 v[220:223], v[92:95], a[220:223], v[220:223]
  s_waitcnt vmcnt(17) lgkmcnt(0)
  buffer_load_dwordx4 a[220:223], v2, s[40:43], s67 offen offset:1024 sc1
  v_mfma_f32_16x16x32_bf16 v[96:99], v[32:35], a[224:227], v[96:99]
  v_accvgpr_write_b32 a21, 0
  v_mfma_f32_16x16x32_bf16 v[112:115], v[36:39], a[224:227], v[112:115]
  ds_read_b64_tr_b16 v[64:65], v12 offset:40960
  v_accvgpr_write_b32 a22, 0
  v_mfma_f32_16x16x32_bf16 v[128:131], v[40:43], a[224:227], v[128:131]
  ds_read_b64_tr_b16 v[66:67], v12 offset:41984
  v_accvgpr_write_b32 a23, 0
  v_mfma_f32_16x16x32_bf16 v[144:147], v[44:47], a[224:227], v[144:147]
  ds_read_b64_tr_b16 v[68:69], v13 offset:40960
  v_accvgpr_write_b32 a24, 0
  v_mfma_f32_16x16x32_bf16 v[160:163], v[48:51], a[224:227], v[160:163]
  ds_read_b64_tr_b16 v[70:71], v13 offset:41984
  v_accvgpr_write_b32 a25, 0
  v_mfma_f32_16x16x32_bf16 v[176:179], v[52:55], a[224:227], v[176:179]
  ds_read_b64_tr_b16 v[72:73], v12 offset:41216
  v_accvgpr_write_b32 a26, 0
  v_mfma_f32_16x16x32_bf16 v[192:195], v[56:59], a[224:227], v[192:195]
  ds_read_b64_tr_b16 v[74:75], v12 offset:42240
  v_accvgpr_write_b32 a27, 0
  v_mfma_f32_16x16x32_bf16 v[208:211], v[60:63], a[224:227], v[208:211]
  buffer_load_dwordx4 a[224:227], v2, s[40:43], s64 offen offset:2048 sc1
  v_accvgpr_write_b32 a28, 0
  v_mfma_f32_16x16x32_bf16 v[100:103], v[32:35], a[228:231], v[100:103]
  ds_read_b64_tr_b16 v[76:77], v13 offset:41216
  v_accvgpr_write_b32 a29, 0
  v_mfma_f32_16x16x32_bf16 v[116:119], v[36:39], a[228:231], v[116:119]
  ds_read_b64_tr_b16 v[78:79], v13 offset:42240
  v_mfma_f32_16x16x32_bf16 v[132:135], v[40:43], a[228:231], v[132:135]
  ds_read_b64_tr_b16 v[80:81], v12 offset:41472
  v_mfma_f32_16x16x32_bf16 v[148:151], v[44:47], a[228:231], v[148:151]
  v_accvgpr_write_b32 a30, 0
  v_mfma_f32_16x16x32_bf16 v[164:167], v[48:51], a[228:231], v[164:167]
  ds_read_b64_tr_b16 v[82:83], v12 offset:42496
  v_mfma_f32_16x16x32_bf16 v[180:183], v[52:55], a[228:231], v[180:183]
  ds_read_b64_tr_b16 v[84:85], v13 offset:41472
  v_mfma_f32_16x16x32_bf16 v[196:199], v[56:59], a[228:231], v[196:199]
  ds_read_b64_tr_b16 v[86:87], v13 offset:42496
  v_mfma_f32_16x16x32_bf16 v[212:215], v[60:63], a[228:231], v[212:215]
  buffer_load_dwordx4 a[228:231], v2, s[40:43], s65 offen offset:2048 sc1
  v_mfma_f32_16x16x32_bf16 v[104:107], v[32:35], a[232:235], v[104:107]
  ds_read_b64_tr_b16 v[88:89], v12 offset:41728
  v_mfma_f32_16x16x32_bf16 v[120:123], v[36:39], a[232:235], v[120:123]
  ds_read_b64_tr_b16 v[90:91], v12 offset:42752
  v_mfma_f32_16x16x32_bf16 v[136:139], v[40:43], a[232:235], v[136:139]
  ds_read_b64_tr_b16 v[92:93], v13 offset:41728
  v_mfma_f32_16x16x32_bf16 v[152:155], v[44:47], a[232:235], v[152:155]
  v_accvgpr_write_b32 a31, 0
  v_mfma_f32_16x16x32_bf16 v[168:171], v[48:51], a[232:235], v[168:171]
  ds_read_b64_tr_b16 v[94:95], v13 offset:42752
  v_mfma_f32_16x16x32_bf16 v[184:187], v[52:55], a[232:235], v[184:187]
  v_accvgpr_write_b32 a32, 0
  v_mfma_f32_16x16x32_bf16 v[200:203], v[56:59], a[232:235], v[200:203]
  v_accvgpr_write_b32 a33, 0
  v_mfma_f32_16x16x32_bf16 v[216:219], v[60:63], a[232:235], v[216:219]
  buffer_load_dwordx4 a[232:235], v2, s[40:43], s66 offen offset:2048 sc1
  v_mfma_f32_16x16x32_bf16 v[108:111], v[32:35], a[236:239], v[108:111]
  v_xor_b32 v12, 0x10000, v12
  v_mfma_f32_16x16x32_bf16 v[124:127], v[36:39], a[236:239], v[124:127]
  v_accvgpr_write_b32 a34, 0
  v_mfma_f32_16x16x32_bf16 v[140:143], v[40:43], a[236:239], v[140:143]
  v_xor_b32 v13, 0x10000, v13
  v_mfma_f32_16x16x32_bf16 v[156:159], v[44:47], a[236:239], v[156:159]
  v_accvgpr_write_b32 a35, 0
  v_mfma_f32_16x16x32_bf16 v[172:175], v[48:51], a[236:239], v[172:175]
  v_accvgpr_write_b32 a36, 0
  v_mfma_f32_16x16x32_bf16 v[188:191], v[52:55], a[236:239], v[188:191]
  v_accvgpr_write_b32 a37, 0
  v_mfma_f32_16x16x32_bf16 v[204:207], v[56:59], a[236:239], v[204:207]
  v_accvgpr_write_b32 a38, 0
  v_mfma_f32_16x16x32_bf16 v[220:223], v[60:63], a[236:239], v[220:223]
  s_waitcnt vmcnt(11) lgkmcnt(0)
  buffer_load_dwordx4 a[236:239], v2, s[40:43], s67 offen offset:2048 sc1
  v_mfma_f32_16x16x32_bf16 v[96:99], v[64:67], a[240:243], v[96:99]
  s_barrier
  v_accvgpr_write_b32 a39, 0
  v_mfma_f32_16x16x32_bf16 v[112:115], v[68:71], a[240:243], v[112:115]
  ds_read_b64_tr_b16 v[32:33], v12 offset:0
  v_accvgpr_write_b32 a40, 0
  v_mfma_f32_16x16x32_bf16 v[128:131], v[72:75], a[240:243], v[128:131]
  ds_read_b64_tr_b16 v[34:35], v12 offset:1024
  v_accvgpr_write_b32 a41, 0
  v_mfma_f32_16x16x32_bf16 v[144:147], v[76:79], a[240:243], v[144:147]
  ds_read_b64_tr_b16 v[36:37], v13 offset:0
  v_accvgpr_write_b32 a42, 0
  v_mfma_f32_16x16x32_bf16 v[160:163], v[80:83], a[240:243], v[160:163]
  ds_read_b64_tr_b16 v[38:39], v13 offset:1024
  v_accvgpr_write_b32 a43, 0
  v_mfma_f32_16x16x32_bf16 v[176:179], v[84:87], a[240:243], v[176:179]
  ds_read_b64_tr_b16 v[40:41], v12 offset:256
  v_accvgpr_write_b32 a44, 0
  v_mfma_f32_16x16x32_bf16 v[192:195], v[88:91], a[240:243], v[192:195]
  ds_read_b64_tr_b16 v[42:43], v12 offset:1280
  v_accvgpr_write_b32 a45, 0
  v_mfma_f32_16x16x32_bf16 v[208:211], v[92:95], a[240:243], v[208:211]
  buffer_load_dwordx4 a[240:243], v2, s[40:43], s64 offen offset:3072 sc1
  v_mfma_f32_16x16x32_bf16 v[100:103], v[64:67], a[244:247], v[100:103]
  s_add_u32 s64, s64, 4096
  ds_read_b64_tr_b16 v[44:45], v13 offset:256
  v_mfma_f32_16x16x32_bf16 v[116:119], v[68:71], a[244:247], v[116:119]
  ds_read_b64_tr_b16 v[46:47], v13 offset:1280
  v_mfma_f32_16x16x32_bf16 v[132:135], v[72:75], a[244:247], v[132:135]
  ds_read_b64_tr_b16 v[48:49], v12 offset:512
  v_mfma_f32_16x16x32_bf16 v[148:151], v[76:79], a[244:247], v[148:151]
  buffer_store_dword v19, v18, s[40:43], 0 offen sc1
  v_accvgpr_write_b32 a46, 0
  v_mfma_f32_16x16x32_bf16 v[164:167], v[80:83], a[244:247], v[164:167]
  ds_read_b64_tr_b16 v[50:51], v12 offset:1536
  v_mfma_f32_16x16x32_bf16 v[180:183], v[84:87], a[244:247], v[180:183]
  ds_read_b64_tr_b16 v[52:53], v13 offset:512
  v_mfma_f32_16x16x32_bf16 v[196:199], v[88:91], a[244:247], v[196:199]
  ds_read_b64_tr_b16 v[54:55], v13 offset:1536
  v_mfma_f32_16x16x32_bf16 v[212:215], v[92:95], a[244:247], v[212:215]
  buffer_load_dwordx4 a[244:247], v2, s[40:43], s65 offen offset:3072 sc1
  v_mfma_f32_16x16x32_bf16 v[104:107], v[64:67], a[248:251], v[104:107]
  s_add_u32 s65, s65, 4096
  ds_read_b64_tr_b16 v[56:57], v12 offset:768
  v_mfma_f32_16x16x32_bf16 v[120:123], v[68:71], a[248:251], v[120:123]
  ds_read_b64_tr_b16 v[58:59], v12 offset:1792
  v_mfma_f32_16x16x32_bf16 v[136:139], v[72:75], a[248:251], v[136:139]
  ds_read_b64_tr_b16 v[60:61], v13 offset:768
  v_mfma_f32_16x16x32_bf16 v[152:155], v[76:79], a[248:251], v[152:155]
  v_accvgpr_write_b32 a47, 0
  v_mfma_f32_16x16x32_bf16 v[168:171], v[80:83], a[248:251], v[168:171]
  ds_read_b64_tr_b16 v[62:63], v13 offset:1792
  v_mfma_f32_16x16x32_bf16 v[184:187], v[84:87], a[248:251], v[184:187]
  v_accvgpr_write_b32 a48, 0
  v_mfma_f32_16x16x32_bf16 v[200:203], v[88:91], a[248:251], v[200:203]
  v_accvgpr_write_b32 a49, 0
  v_mfma_f32_16x16x32_bf16 v[216:219], v[92:95], a[248:251], v[216:219]
  buffer_load_dwordx4 a[248:251], v2, s[40:43], s66 offen offset:3072 sc1
  v_mfma_f32_16x16x32_bf16 v[108:111], v[64:67], a[252:255], v[108:111]
  s_add_u32 s66, s66, 4096
  v_accvgpr_write_b32 a50, 0
  v_mfma_f32_16x16x32_bf16 v[124:127], v[68:71], a[252:255], v[124:127]
  v_accvgpr_write_b32 a51, 0
  v_mfma_f32_16x16x32_bf16 v[140:143], v[72:75], a[252:255], v[140:143]
  v_accvgpr_write_b32 a52, 0
  v_mfma_f32_16x16x32_bf16 v[156:159], v[76:79], a[252:255], v[156:159]
  v_accvgpr_write_b32 a53, 0
  v_mfma_f32_16x16x32_bf16 v[172:175], v[80:83], a[252:255], v[172:175]
  v_accvgpr_write_b32 a54, 0
  v_mfma_f32_16x16x32_bf16 v[188:191], v[84:87], a[252:255], v[188:191]
  v_accvgpr_write_b32 a55, 0
  v_mfma_f32_16x16x32_bf16 v[204:207], v[88:91], a[252:255], v[204:207]
  v_accvgpr_write_b32 a56, 0
  v_mfma_f32_16x16x32_bf16 v[220:223], v[92:95], a[252:255], v[220:223]
  s_waitcnt vmcnt(12) lgkmcnt(0)
  buffer_load_dwordx4 a[252:255], v2, s[40:43], s67 offen offset:3072 sc1
  v_mfma_f32_16x16x32_bf16 v[96:99], v[32:35], a[192:195], v[96:99]
  v_accvgpr_write_b32 a57, 0
  v_mfma_f32_16x16x32_bf16 v[112:115], v[36:39], a[192:195], v[112:115]
  s_add_u32 s67, s67, 4096
  ds_read_b64_tr_b16 v[64:65], v12 offset:8192
  v_accvgpr_write_b32 a58, 0
  v_mfma_f32_16x16x32_bf16 v[128:131], v[40:43], a[192:195], v[128:131]
  ds_read_b64_tr_b16 v[66:67], v12 offset:9216
  v_accvgpr_write_b32 a59, 0
  v_mfma_f32_16x16x32_bf16 v[144:147], v[44:47], a[192:195], v[144:147]
  ds_read_b64_tr_b16 v[68:69], v13 offset:8192
  v_accvgpr_write_b32 a60, 0
  v_mfma_f32_16x16x32_bf16 v[160:163], v[48:51], a[192:195], v[160:163]
  ds_read_b64_tr_b16 v[70:71], v13 offset:9216
  v_mfma_f32_16x16x32_bf16 v[176:179], v[52:55], a[192:195], v[176:179]
  ds_read_b64_tr_b16 v[72:73], v12 offset:8448
  v_mfma_f32_16x16x32_bf16 v[192:195], v[56:59], a[192:195], v[192:195]
  ds_read_b64_tr_b16 v[74:75], v12 offset:9472
  v_mfma_f32_16x16x32_bf16 v[208:211], v[60:63], a[192:195], v[208:211]
  v_accvgpr_write_b32 a61, 0
  v_mfma_f32_16x16x32_bf16 v[100:103], v[32:35], a[196:199], v[100:103]
  ds_read_b64_tr_b16 v[76:77], v13 offset:8448
  v_mfma_f32_16x16x32_bf16 v[116:119], v[36:39], a[196:199], v[116:119]
  ds_read_b64_tr_b16 v[78:79], v13 offset:9472
  v_mfma_f32_16x16x32_bf16 v[132:135], v[40:43], a[196:199], v[132:135]
  ds_read_b64_tr_b16 v[80:81], v12 offset:8704
  v_mfma_f32_16x16x32_bf16 v[148:151], v[44:47], a[196:199], v[148:151]
  v_accvgpr_write_b32 a62, 0
  v_mfma_f32_16x16x32_bf16 v[164:167], v[48:51], a[196:199], v[164:167]
  ds_read_b64_tr_b16 v[82:83], v12 offset:9728
  v_mfma_f32_16x16x32_bf16 v[180:183], v[52:55], a[196:199], v[180:183]
  ds_read_b64_tr_b16 v[84:85], v13 offset:8704
  v_mfma_f32_16x16x32_bf16 v[196:199], v[56:59], a[196:199], v[196:199]
  ds_read_b64_tr_b16 v[86:87], v13 offset:9728
  v_mfma_f32_16x16x32_bf16 v[212:215], v[60:63], a[196:199], v[212:215]
  v_accvgpr_write_b32 a63, 0
  v_mfma_f32_16x16x32_bf16 v[104:107], v[32:35], a[200:203], v[104:107]
  ds_read_b64_tr_b16 v[88:89], v12 offset:8960
  v_mfma_f32_16x16x32_bf16 v[120:123], v[36:39], a[200:203], v[120:123]
  ds_read_b64_tr_b16 v[90:91], v12 offset:9984
  v_mfma_f32_16x16x32_bf16 v[136:139], v[40:43], a[200:203], v[136:139]
  ds_read_b64_tr_b16 v[92:93], v13 offset:8960
  v_mfma_f32_16x16x32_bf16 v[152:155], v[44:47], a[200:203], v[152:155]
  v_accvgpr_write_b32 a64, 0
  v_mfma_f32_16x16x32_bf16 v[168:171], v[48:51], a[200:203], v[168:171]
  ds_read_b64_tr_b16 v[94:95], v13 offset:9984
  v_mfma_f32_16x16x32_bf16 v[184:187], v[52:55], a[200:203], v[184:187]
  v_accvgpr_write_b32 a65, 0
  v_mfma_f32_16x16x32_bf16 v[200:203], v[56:59], a[200:203], v[200:203]
  v_accvgpr_write_b32 a66, 0
  v_mfma_f32_16x16x32_bf16 v[216:219], v[60:63], a[200:203], v[216:219]
  v_accvgpr_write_b32 a67, 0
  v_mfma_f32_16x16x32_bf16 v[108:111], v[32:35], a[204:207], v[108:111]
  v_accvgpr_write_b32 a68, 0
  v_mfma_f32_16x16x32_bf16 v[124:127], v[36:39], a[204:207], v[124:127]
  v_accvgpr_write_b32 a69, 0
  v_mfma_f32_16x16x32_bf16 v[140:143], v[40:43], a[204:207], v[140:143]
  v_accvgpr_write_b32 a70, 0
  v_mfma_f32_16x16x32_bf16 v[156:159], v[44:47], a[204:207], v[156:159]
  v_accvgpr_write_b32 a71, 0
  v_mfma_f32_16x16x32_bf16 v[172:175], v[48:51], a[204:207], v[172:175]
  v_accvgpr_write_b32 a72, 0
  v_mfma_f32_16x16x32_bf16 v[188:191], v[52:55], a[204:207], v[188:191]
  v_accvgpr_write_b32 a73, 0
  v_mfma_f32_16x16x32_bf16 v[204:207], v[56:59], a[204:207], v[204:207]
  v_accvgpr_write_b32 a74, 0
  v_mfma_f32_16x16x32_bf16 v[220:223], v[60:63], a[204:207], v[220:223]
  s_waitcnt vmcnt(9) lgkmcnt(0)
  v_mfma_f32_16x16x32_bf16 v[96:99], v[64:67], a[208:211], v[96:99]
  s_barrier
  v_accvgpr_write_b32 a75, 0
  v_mfma_f32_16x16x32_bf16 v[112:115], v[68:71], a[208:211], v[112:115]
  ds_read_b64_tr_b16 v[32:33], v12 offset:32768
  v_accvgpr_write_b32 a76, 0
  v_mfma_f32_16x16x32_bf16 v[128:131], v[72:75], a[208:211], v[128:131]
  ds_read_b64_tr_b16 v[34:35], v12 offset:33792
  v_accvgpr_write_b32 a77, 0
  v_mfma_f32_16x16x32_bf16 v[144:147], v[76:79], a[208:211], v[144:147]
  ds_read_b64_tr_b16 v[36:37], v13 offset:32768
  v_accvgpr_write_b32 a78, 0
  v_mfma_f32_16x16x32_bf16 v[160:163], v[80:83], a[208:211], v[160:163]
  ds_read_b64_tr_b16 v[38:39], v13 offset:33792
  v_mfma_f32_16x16x32_bf16 v[176:179], v[84:87], a[208:211], v[176:179]
  ds_read_b64_tr_b16 v[40:41], v12 offset:33024
  v_mfma_f32_16x16x32_bf16 v[192:195], v[88:91], a[208:211], v[192:195]
  ds_read_b64_tr_b16 v[42:43], v12 offset:34048
  v_mfma_f32_16x16x32_bf16 v[208:211], v[92:95], a[208:211], v[208:211]
  v_accvgpr_write_b32 a79, 0
  v_mfma_f32_16x16x32_bf16 v[100:103], v[64:67], a[212:215], v[100:103]
  ds_read_b64_tr_b16 v[44:45], v13 offset:33024
  v_mfma_f32_16x16x32_bf16 v[116:119], v[68:71], a[212:215], v[116:119]
  ds_read_b64_tr_b16 v[46:47], v13 offset:34048
  v_mfma_f32_16x16x32_bf16 v[132:135], v[72:75], a[212:215], v[132:135]
  ds_read_b64_tr_b16 v[48:49], v12 offset:33280
  v_mfma_f32_16x16x32_bf16 v[148:151], v[76:79], a[212:215], v[148:151]
  v_accvgpr_write_b32 a80, 0
  v_mfma_f32_16x16x32_bf16 v[164:167], v[80:83], a[212:215], v[164:167]
  ds_read_b64_tr_b16 v[50:51], v12 offset:34304
  v_mfma_f32_16x16x32_bf16 v[180:183], v[84:87], a[212:215], v[180:183]
  ds_read_b64_tr_b16 v[52:53], v13 offset:33280
  v_mfma_f32_16x16x32_bf16 v[196:199], v[88:91], a[212:215], v[196:199]
  ds_read_b64_tr_b16 v[54:55], v13 offset:34304
  v_mfma_f32_16x16x32_bf16 v[212:215], v[92:95], a[212:215], v[212:215]
  v_accvgpr_write_b32 a81, 0
  v_mfma_f32_16x16x32_bf16 v[104:107], v[64:67], a[216:219], v[104:107]
  ds_read_b64_tr_b16 v[56:57], v12 offset:33536
  v_mfma_f32_16x16x32_bf16 v[120:123], v[68:71], a[216:219], v[120:123]
  ds_read_b64_tr_b16 v[58:59], v12 offset:34560
  v_mfma_f32_16x16x32_bf16 v[136:139], v[72:75], a[216:219], v[136:139]
  ds_read_b64_tr_b16 v[60:61], v13 offset:33536
  v_mfma_f32_16x16x32_bf16 v[152:155], v[76:79], a[216:219], v[152:155]
  v_accvgpr_write_b32 a82, 0
  v_mfma_f32_16x16x32_bf16 v[168:171], v[80:83], a[216:219], v[168:171]
  ds_read_b64_tr_b16 v[62:63], v13 offset:34560
  v_mfma_f32_16x16x32_bf16 v[184:187], v[84:87], a[216:219], v[184:187]
  buffer_load_dword v228, v230, s[40:43], 0 offen sc1
  v_accvgpr_write_b32 a83, 0
  v_mfma_f32_16x16x32_bf16 v[200:203], v[88:91], a[216:219], v[200:203]
  v_accvgpr_write_b32 a84, 0
  v_mfma_f32_16x16x32_bf16 v[216:219], v[92:95], a[216:219], v[216:219]
  v_accvgpr_write_b32 a85, 0
  v_mfma_f32_16x16x32_bf16 v[108:111], v[64:67], a[220:223], v[108:111]
  v_accvgpr_write_b32 a86, 0
  v_mfma_f32_16x16x32_bf16 v[124:127], v[68:71], a[220:223], v[124:127]
  v_accvgpr_write_b32 a87, 0
  v_mfma_f32_16x16x32_bf16 v[140:143], v[72:75], a[220:223], v[140:143]
  v_accvgpr_write_b32 a88, 0
  v_mfma_f32_16x16x32_bf16 v[156:159], v[76:79], a[220:223], v[156:159]
  v_accvgpr_write_b32 a89, 0
  v_mfma_f32_16x16x32_bf16 v[172:175], v[80:83], a[220:223], v[172:175]
  v_accvgpr_write_b32 a90, 0
  v_mfma_f32_16x16x32_bf16 v[188:191], v[84:87], a[220:223], v[188:191]
  v_accvgpr_write_b32 a91, 0
  v_mfma_f32_16x16x32_bf16 v[204:207], v[88:91], a[220:223], v[204:207]
  v_accvgpr_write_b32 a92, 0
  v_mfma_f32_16x16x32_bf16 v[220:223], v[92:95], a[220:223], v[220:223]
  s_waitcnt vmcnt(6) lgkmcnt(0)
  v_mfma_f32_16x16x32_bf16 v[96:99], v[32:35], a[224:227], v[96:99]
  v_accvgpr_write_b32 a93, 0
  v_mfma_f32_16x16x32_bf16 v[112:115], v[36:39], a[224:227], v[112:115]
  ds_read_b64_tr_b16 v[64:65], v12 offset:40960
  v_accvgpr_write_b32 a94, 0
  v_mfma_f32_16x16x32_bf16 v[128:131], v[40:43], a[224:227], v[128:131]
  ds_read_b64_tr_b16 v[66:67], v12 offset:41984
  v_accvgpr_write_b32 a95, 0
  v_mfma_f32_16x16x32_bf16 v[144:147], v[44:47], a[224:227], v[144:147]
  ds_read_b64_tr_b16 v[68:69], v13 offset:40960
  v_accvgpr_write_b32 a96, 0
  v_mfma_f32_16x16x32_bf16 v[160:163], v[48:51], a[224:227], v[160:163]
  ds_read_b64_tr_b16 v[70:71], v13 offset:41984
  v_accvgpr_write_b32 a97, 0
  v_mfma_f32_16x16x32_bf16 v[176:179], v[52:55], a[224:227], v[176:179]
  ds_read_b64_tr_b16 v[72:73], v12 offset:41216
  v_accvgpr_write_b32 a98, 0
  v_mfma_f32_16x16x32_bf16 v[192:195], v[56:59], a[224:227], v[192:195]
  ds_read_b64_tr_b16 v[74:75], v12 offset:42240
  v_mfma_f32_16x16x32_bf16 v[208:211], v[60:63], a[224:227], v[208:211]
  v_accvgpr_write_b32 a99, 0
  v_mfma_f32_16x16x32_bf16 v[100:103], v[32:35], a[228:231], v[100:103]
  ds_read_b64_tr_b16 v[76:77], v13 offset:41216
  v_mfma_f32_16x16x32_bf16 v[116:119], v[36:39], a[228:231], v[116:119]
  ds_read_b64_tr_b16 v[78:79], v13 offset:42240
  v_mfma_f32_16x16x32_bf16 v[132:135], v[40:43], a[228:231], v[132:135]
  ds_read_b64_tr_b16 v[80:81], v12 offset:41472
  v_mfma_f32_16x16x32_bf16 v[148:151], v[44:47], a[228:231], v[148:151]
  v_accvgpr_write_b32 a100, 0
  v_mfma_f32_16x16x32_bf16 v[164:167], v[48:51], a[228:231], v[164:167]
  ds_read_b64_tr_b16 v[82:83], v12 offset:42496
  v_mfma_f32_16x16x32_bf16 v[180:183], v[52:55], a[228:231], v[180:183]
  ds_read_b64_tr_b16 v[84:85], v13 offset:41472
  v_mfma_f32_16x16x32_bf16 v[196:199], v[56:59], a[228:231], v[196:199]
  ds_read_b64_tr_b16 v[86:87], v13 offset:42496
  v_mfma_f32_16x16x32_bf16 v[212:215], v[60:63], a[228:231], v[212:215]
  v_accvgpr_write_b32 a101, 0
  v_mfma_f32_16x16x32_bf16 v[104:107], v[32:35], a[232:235], v[104:107]
  ds_read_b64_tr_b16 v[88:89], v12 offset:41728
  v_mfma_f32_16x16x32_bf16 v[120:123], v[36:39], a[232:235], v[120:123]
  ds_read_b64_tr_b16 v[90:91], v12 offset:42752
  v_mfma_f32_16x16x32_bf16 v[136:139], v[40:43], a[232:235], v[136:139]
  ds_read_b64_tr_b16 v[92:93], v13 offset:41728
  v_mfma_f32_16x16x32_bf16 v[152:155], v[44:47], a[232:235], v[152:155]
  v_accvgpr_write_b32 a102, 0
  v_mfma_f32_16x16x32_bf16 v[168:171], v[48:51], a[232:235], v[168:171]
  ds_read_b64_tr_b16 v[94:95], v13 offset:42752
  v_mfma_f32_16x16x32_bf16 v[184:187], v[52:55], a[232:235], v[184:187]
  v_accvgpr_write_b32 a103, 0
  v_mfma_f32_16x16x32_bf16 v[200:203], v[56:59], a[232:235], v[200:203]
  v_accvgpr_write_b32 a104, 0
  v_mfma_f32_16x16x32_bf16 v[216:219], v[60:63], a[232:235], v[216:219]
  v_accvgpr_write_b32 a105, 0
  v_mfma_f32_16x16x32_bf16 v[108:111], v[32:35], a[236:239], v[108:111]
  v_xor_b32 v12, 0x10000, v12
  v_mfma_f32_16x16x32_bf16 v[124:127], v[36:39], a[236:239], v[124:127]
  v_accvgpr_write_b32 a106, 0
  v_mfma_f32_16x16x32_bf16 v[140:143], v[40:43], a[236:239], v[140:143]
  v_xor_b32 v13, 0x10000, v13
  v_mfma_f32_16x16x32_bf16 v[156:159], v[44:47], a[236:239], v[156:159]
  v_accvgpr_write_b32 a107, 0
  v_mfma_f32_16x16x32_bf16 v[172:175], v[48:51], a[236:239], v[172:175]
  v_accvgpr_write_b32 a108, 0
  v_mfma_f32_16x16x32_bf16 v[188:191], v[52:55], a[236:239], v[188:191]
  v_accvgpr_write_b32 a109, 0
  v_mfma_f32_16x16x32_bf16 v[204:207], v[56:59], a[236:239], v[204:207]
  v_accvgpr_write_b32 a110, 0
  v_mfma_f32_16x16x32_bf16 v[220:223], v[60:63], a[236:239], v[220:223]
  s_waitcnt vmcnt(1) lgkmcnt(0)
  v_mfma_f32_16x16x32_bf16 v[96:99], v[64:67], a[240:243], v[96:99]
  s_barrier
  v_accvgpr_write_b32 a111, 0
  v_mfma_f32_16x16x32_bf16 v[112:115], v[68:71], a[240:243], v[112:115]
  v_accvgpr_write_b32 a112, 0
  v_mfma_f32_16x16x32_bf16 v[128:131], v[72:75], a[240:243], v[128:131]
  v_accvgpr_write_b32 a113, 0
  v_mfma_f32_16x16x32_bf16 v[144:147], v[76:79], a[240:243], v[144:147]
  v_accvgpr_write_b32 a114, 0
  v_mfma_f32_16x16x32_bf16 v[160:163], v[80:83], a[240:243], v[160:163]
  v_accvgpr_write_b32 a115, 0
  v_mfma_f32_16x16x32_bf16 v[176:179], v[84:87], a[240:243], v[176:179]
  v_accvgpr_write_b32 a116, 0
  v_mfma_f32_16x16x32_bf16 v[192:195], v[88:91], a[240:243], v[192:195]
  v_accvgpr_write_b32 a117, 0
  v_mfma_f32_16x16x32_bf16 v[208:211], v[92:95], a[240:243], v[208:211]
  v_accvgpr_write_b32 a118, 0
  v_mfma_f32_16x16x32_bf16 v[100:103], v[64:67], a[244:247], v[100:103]
  v_accvgpr_write_b32 a119, 0
  v_mfma_f32_16x16x32_bf16 v[116:119], v[68:71], a[244:247], v[116:119]
  v_accvgpr_write_b32 a120, 0
  v_mfma_f32_16x16x32_bf16 v[132:135], v[72:75], a[244:247], v[132:135]
  v_accvgpr_write_b32 a121, 0
  v_mfma_f32_16x16x32_bf16 v[148:151], v[76:79], a[244:247], v[148:151]
  v_accvgpr_write_b32 a122, 0
  v_mfma_f32_16x16x32_bf16 v[164:167], v[80:83], a[244:247], v[164:167]
  v_accvgpr_write_b32 a123, 0
  v_mfma_f32_16x16x32_bf16 v[180:183], v[84:87], a[244:247], v[180:183]
  v_accvgpr_write_b32 a124, 0
  v_mfma_f32_16x16x32_bf16 v[196:199], v[88:91], a[244:247], v[196:199]
  v_accvgpr_write_b32 a125, 0
  v_mfma_f32_16x16x32_bf16 v[212:215], v[92:95], a[244:247], v[212:215]
  v_accvgpr_write_b32 a126, 0
  v_mfma_f32_16x16x32_bf16 v[104:107], v[64:67], a[248:251], v[104:107]
  v_accvgpr_write_b32 a127, 0
  v_mfma_f32_16x16x32_bf16 v[120:123], v[68:71], a[248:251], v[120:123]
  v_mfma_f32_16x16x32_bf16 v[136:139], v[72:75], a[248:251], v[136:139]
  v_mfma_f32_16x16x32_bf16 v[152:155], v[76:79], a[248:251], v[152:155]
  v_mfma_f32_16x16x32_bf16 v[168:171], v[80:83], a[248:251], v[168:171]
  v_mfma_f32_16x16x32_bf16 v[184:187], v[84:87], a[248:251], v[184:187]
  v_mfma_f32_16x16x32_bf16 v[200:203], v[88:91], a[248:251], v[200:203]
  v_mfma_f32_16x16x32_bf16 v[216:219], v[92:95], a[248:251], v[216:219]
  v_mfma_f32_16x16x32_bf16 v[108:111], v[64:67], a[252:255], v[108:111]
  v_mfma_f32_16x16x32_bf16 v[124:127], v[68:71], a[252:255], v[124:127]
  v_mfma_f32_16x16x32_bf16 v[140:143], v[72:75], a[252:255], v[140:143]
  v_mfma_f32_16x16x32_bf16 v[156:159], v[76:79], a[252:255], v[156:159]
  v_mfma_f32_16x16x32_bf16 v[172:175], v[80:83], a[252:255], v[172:175]
  v_mfma_f32_16x16x32_bf16 v[188:191], v[84:87], a[252:255], v[188:191]
  v_mfma_f32_16x16x32_bf16 v[204:207], v[88:91], a[252:255], v[204:207]
  v_mfma_f32_16x16x32_bf16 v[220:223], v[92:95], a[252:255], v[220:223]
  s_and_b32 s23, s20, 1
  s_lshl_b32 s23, s23, 12
  s_cmp_lt_u32 s20, 2
  s_cselect_b32 s24, 106496, 0
  s_add_u32 s24, s24, s23
  s_lshl_b32 s26, s20, 12
  s_mov_b32 s27, s26
  s_add_u32 s25, s27, 49152
  s_waitcnt vmcnt(0)
  v_cmp_eq_u32 vcc, 0, v228
  s_cbranch_vccnz fa_kv_spin
fa_kv_ok:
  s_load_dwordx4 s[4:7], s[0:1], 64
  s_load_dwordx2 s[8:9], s[0:1], 80
  s_mov_b32 m0, s24
  s_nop 0
  buffer_load_dwordx4 v2, s[44:47], s26 offen offset:0 sc1 lds
  buffer_load_dwordx4 v2, s[44:47], s26 offen offset:1024 sc1 lds
  buffer_load_dwordx4 v2, s[44:47], s26 offen offset:2048 sc1 lds
  buffer_load_dwordx4 v2, s[44:47], s26 offen offset:3072 sc1 lds
  s_add_u32 s26, s26, 16384
  s_add_u32 s24, s24, 32768
  s_and_b32 s24, s24, 0x1ffff
  s_mov_b32 m0, s24
  s_nop 0
  buffer_load_dwordx4 v2, s[44:47], s26 offen offset:0 sc1 lds
  buffer_load_dwordx4 v2, s[44:47], s26 offen offset:1024 sc1 lds
  buffer_load_dwordx4 v2, s[44:47], s26 offen offset:2048 sc1 lds
  buffer_load_dwordx4 v2, s[44:47], s26 offen offset:3072 sc1 lds
  s_add_u32 s26, s26, 16384
  s_add_u32 s24, s24, 32768
  s_and_b32 s24, s24, 0x1ffff
  s_mov_b32 m0, s24
  s_nop 0
  buffer_load_dwordx4 v2, s[44:47], s26 offen offset:0 sc1 lds
  buffer_load_dwordx4 v2, s[44:47], s26 offen offset:1024 sc1 lds
  buffer_load_dwordx4 v2, s[44:47], s26 offen offset:2048 sc1 lds
  buffer_load_dwordx4 v2, s[44:47], s26 offen offset:3072 sc1 lds
  s_add_u32 s26, s26, 16384
  s_add_u32 s24, s24, 32768
  s_and_b32 s24, s24, 0x1ffff
  s_mov_b32 m0, s25
  s_nop 0
  buffer_load_dwordx4 v2, s[48:51], s27 offen offset:0 sc1 lds
  buffer_load_dwordx4 v2, s[48:51], s27 offen offset:1024 sc1 lds
  buffer_load_dwordx4 v2, s[48:51], s27 offen offset:2048 sc1 lds
  buffer_load_dwordx4 v2, s[48:51], s27 offen offset:3072 sc1 lds
  s_add_u32 s27, s27, 16384
  s_add_u32 s25, s25, 32768
  s_and_b32 s25, s25, 0x1ffff
  s_mov_b32 m0, s25
  s_nop 0
  buffer_load_dwordx4 v2, s[48:51], s27 offen offset:0 sc1 lds
  buffer_load_dwordx4 v2, s[48:51], s27 offen offset:1024 sc1 lds
  buffer_load_dwordx4 v2, s[48:51], s27 offen offset:2048 sc1 lds
  buffer_load_dwordx4 v2, s[48:51], s27 offen offset:3072 sc1 lds
  s_add_u32 s27, s27, 16384
  s_add_u32 s25, s25, 32768
  s_and_b32 s25, s25, 0x1ffff
  s_cmp_eq_u32 s2, 255
  s_cbranch_scc1 fa_top8
fa_notop:
  v_mov_b32 v16, 0x3e0293ee
  v_mov_b32 v17, 0x3e0293ee
  v_pk_mul_f32 v[96:97], v[96:97], v[16:17]
  v_pk_mul_f32 v[98:99], v[98:99], v[16:17]
  v_cvt_pk_bf16_f32 v32, v96, v97
  v_cvt_pk_bf16_f32 v33, v98, v99
  v_pk_mul_f32 v[112:113], v[112:113], v[16:17]
  v_pk_mul_f32 v[114:115], v[114:115], v[16:17]
  v_cvt_pk_bf16_f32 v34, v112, v113
  v_cvt_pk_bf16_f32 v35, v114, v115
  v_pk_mul_f32 v[100:101], v[100:101], v[16:17]
  v_pk_mul_f32 v[102:103], v[102:103], v[16:17]
  v_cvt_pk_bf16_f32 v36, v100, v101
  v_cvt_pk_bf16_f32 v37, v102, v103
  v_pk_mul_f32 v[116:117], v[116:117], v[16:17]
  v_pk_mul_f32 v[118:119], v[118:119], v[16:17]
  v_cvt_pk_bf16_f32 v38, v116, v117
  v_cvt_pk_bf16_f32 v39, v118, v119
  v_pk_mul_f32 v[128:129], v[128:129], v[16:17]
  v_pk_mul_f32 v[130:131], v[130:131], v[16:17]
  v_cvt_pk_bf16_f32 v40, v128, v129
  v_cvt_pk_bf16_f32 v41, v130, v131
  v_pk_mul_f32 v[144:145], v[144:145], v[16:17]
  v_pk_mul_f32 v[146:147], v[146:147], v[16:17]
  v_cvt_pk_bf16_f32 v42, v144, v145
  v_cvt_pk_bf16_f32 v43, v146, v147
  v_pk_mul_f32 v[132:133], v[132:133], v[16:17]
  v_pk_mul_f32 v[134:135], v[134:135], v[16:17]
  v_cvt_pk_bf16_f32 v44, v132, v133
  v_cvt_pk_bf16_f32 v45, v134, v135
  v_pk_mul_f32 v[148:149], v[148:149], v[16:17]
  v_pk_mul_f32 v[150:151], v[150:151], v[16:17]
  v_cvt_pk_bf16_f32 v46, v148, v149
  v_cvt_pk_bf16_f32 v47, v150, v151
  v_pk_mul_f32 v[160:161], v[160:161], v[16:17]
  v_pk_mul_f32 v[162:163], v[162:163], v[16:17]
  v_cvt_pk_bf16_f32 v48, v160, v161
  v_cvt_pk_bf16_f32 v49, v162, v163
  v_pk_mul_f32 v[176:177], v[176:177], v[16:17]
  v_pk_mul_f32 v[178:179], v[178:179], v[16:17]
  v_cvt_pk_bf16_f32 v50, v176, v177
  v_cvt_pk_bf16_f32 v51, v178, v179
  v_pk_mul_f32 v[164:165], v[164:165], v[16:17]
  v_pk_mul_f32 v[166:167], v[166:167], v[16:17]
  v_cvt_pk_bf16_f32 v52, v164, v165
  v_cvt_pk_bf16_f32 v53, v166, v167
  v_pk_mul_f32 v[180:181], v[180:181], v[16:17]
  v_pk_mul_f32 v[182:183], v[182:183], v[16:17]
  v_cvt_pk_bf16_f32 v54, v180, v181
  v_cvt_pk_bf16_f32 v55, v182, v183
  v_pk_mul_f32 v[192:193], v[192:193], v[16:17]
  v_pk_mul_f32 v[194:195], v[194:195], v[16:17]
  v_cvt_pk_bf16_f32 v56, v192, v193
  v_cvt_pk_bf16_f32 v57, v194, v195
  v_pk_mul_f32 v[208:209], v[208:209], v[16:17]
  v_pk_mul_f32 v[210:211], v[210:211], v[16:17]
  v_cvt_pk_bf16_f32 v58, v208, v209
  v_cvt_pk_bf16_f32 v59, v210, v211
  v_pk_mul_f32 v[196:197], v[196:197], v[16:17]
  v_pk_mul_f32 v[198:199], v[198:199], v[16:17]
  v_cvt_pk_bf16_f32 v60, v196, v197
  v_cvt_pk_bf16_f32 v61, v198, v199
  v_pk_mul_f32 v[212:213], v[212:213], v[16:17]
  v_pk_mul_f32 v[214:215], v[214:215], v[16:17]
  v_cvt_pk_bf16_f32 v62, v212, v213
  v_cvt_pk_bf16_f32 v63, v214, v215
  s_and_b32 s62, s2, 1
  s_lshl_b32 s62, s62, 2
  s_add_u32 s62, s62, s20
  s_lshr_b32 s63, s2, 1
  s_mul_i32 s23, s63, 40960
  s_mul_i32 s31, s62, 160
  s_add_u32 s23, s23, s31
  s_mul_i32 s34, s20, 5120
  s_add_u32 s34, s34, 131072
  v_add_u32 v20, 0, v1
  v_mul_u32_u24 v19, 6554, v20
  s_add_u32 m0, s34, 0
  v_lshrrev_b32 v19, 16, v19
  v_mul_u32_u24 v19, 1120, v19
  v_lshl_add_u32 v19, v20, 4, v19
  buffer_load_dwordx4 v19, s[52:55], s23 offen lds
  v_add_u32 v20, 64, v1
  v_mul_u32_u24 v19, 6554, v20
  s_add_u32 m0, s34, 1024
  v_lshrrev_b32 v19, 16, v19
  v_mul_u32_u24 v19, 1120, v19
  v_lshl_add_u32 v19, v20, 4, v19
  buffer_load_dwordx4 v19, s[52:55], s23 offen lds
  v_add_u32 v20, 128, v1
  v_mul_u32_u24 v19, 6554, v20
  s_add_u32 m0, s34, 2048
  v_lshrrev_b32 v19, 16, v19
  v_mul_u32_u24 v19, 1120, v19
  v_lshl_add_u32 v19, v20, 4, v19
  buffer_load_dwordx4 v19, s[52:55], s23 offen lds
  v_add_u32 v20, 192, v1
  v_mul_u32_u24 v19, 6554, v20
  s_add_u32 m0, s34, 3072
  v_lshrrev_b32 v19, 16, v19
  v_mul_u32_u24 v19, 1120, v19
  v_lshl_add_u32 v19, v20, 4, v19
  buffer_load_dwordx4 v19, s[52:55], s23 offen lds
  v_add_u32 v20, 256, v1
  v_mul_u32_u24 v19, 6554, v20
  s_add_u32 m0, s34, 4096
  v_lshrrev_b32 v19, 16, v19
  v_mul_u32_u24 v19, 1120, v19
  v_lshl_add_u32 v19, v20, 4, v19
  buffer_load_dwordx4 v19, s[52:55], s23 offen lds
  v_lshrrev_b32 v6, 2, v1
  v_mul_u32_u24 v6, 160, v6
  v_and_b32 v19, 3, v1
  v_lshl_add_u32 v6, v19, 3, v6
  v_add_u32 v6, s34, v6
  s_lshl_b32 s30, s62, 7
  s_add_u32 s30, s30, s63
  s_mul_i32 s30, s30, 5120
  s_add_u32 s30, s30, 4194304
  s_waitcnt lgkmcnt(0)
  s_cmp_ge_u32 s20, 2
  s_cselect_b32 s4, s6, s4
  s_cselect_b32 s5, s7, s5
  s_mov_b32 s52, s4
  s_mov_b32 s53, s5
  s_mov_b32 s54, 2211840
  s_mov_b32 s55, 0x20000
  s_mov_b32 s60, s8
  s_mov_b32 s61, s9
  s_mov_b32 s62, 2211840
  s_mov_b32 s63, 0x20000
  v_pk_mul_f32 v[104:105], v[104:105], v[16:17]
  v_pk_mul_f32 v[106:107], v[106:107], v[16:17]
  v_cvt_pk_bf16_f32 v64, v104, v105
  v_cvt_pk_bf16_f32 v65, v106, v107
  v_pk_mul_f32 v[120:121], v[120:121], v[16:17]
  v_pk_mul_f32 v[122:123], v[122:123], v[16:17]
  v_cvt_pk_bf16_f32 v66, v120, v121
  v_cvt_pk_bf16_f32 v67, v122, v123
  v_pk_mul_f32 v[108:109], v[108:109], v[16:17]
  v_pk_mul_f32 v[110:111], v[110:111], v[16:17]
  v_cvt_pk_bf16_f32 v68, v108, v109
  v_cvt_pk_bf16_f32 v69, v110, v111
  v_pk_mul_f32 v[124:125], v[124:125], v[16:17]
  v_pk_mul_f32 v[126:127], v[126:127], v[16:17]
  v_cvt_pk_bf16_f32 v70, v124, v125
  v_cvt_pk_bf16_f32 v71, v126, v127
  v_pk_mul_f32 v[136:137], v[136:137], v[16:17]
  v_pk_mul_f32 v[138:139], v[138:139], v[16:17]
  v_cvt_pk_bf16_f32 v72, v136, v137
  v_cvt_pk_bf16_f32 v73, v138, v139
  v_pk_mul_f32 v[152:153], v[152:153], v[16:17]
  v_pk_mul_f32 v[154:155], v[154:155], v[16:17]
  v_cvt_pk_bf16_f32 v74, v152, v153
  v_cvt_pk_bf16_f32 v75, v154, v155
  v_pk_mul_f32 v[140:141], v[140:141], v[16:17]
  v_pk_mul_f32 v[142:143], v[142:143], v[16:17]
  v_cvt_pk_bf16_f32 v76, v140, v141
  v_cvt_pk_bf16_f32 v77, v142, v143
  v_pk_mul_f32 v[156:157], v[156:157], v[16:17]
  v_pk_mul_f32 v[158:159], v[158:159], v[16:17]
  v_cvt_pk_bf16_f32 v78, v156, v157
  v_cvt_pk_bf16_f32 v79, v158, v159
  v_pk_mul_f32 v[168:169], v[168:169], v[16:17]
  v_pk_mul_f32 v[170:171], v[170:171], v[16:17]
  v_cvt_pk_bf16_f32 v80, v168, v169
  v_cvt_pk_bf16_f32 v81, v170, v171
  v_pk_mul_f32 v[184:185], v[184:185], v[16:17]
  v_pk_mul_f32 v[186:187], v[186:187], v[16:17]
  v_cvt_pk_bf16_f32 v82, v184, v185
  v_cvt_pk_bf16_f32 v83, v186, v187
  v_pk_mul_f32 v[172:173], v[172:173], v[16:17]
  v_pk_mul_f32 v[174:175], v[174:175], v[16:17]
  v_cvt_pk_bf16_f32 v84, v172, v173
  v_cvt_pk_bf16_f32 v85, v174, v175
  v_pk_mul_f32 v[188:189], v[188:189], v[16:17]
  v_pk_mul_f32 v[190:191], v[190:191], v[16:17]
  v_cvt_pk_bf16_f32 v86, v188, v189
  v_cvt_pk_bf16_f32 v87, v190, v191
  v_pk_mul_f32 v[200:201], v[200:201], v[16:17]
  v_pk_mul_f32 v[202:203], v[202:203], v[16:17]
  v_cvt_pk_bf16_f32 v88, v200, v201
  v_cvt_pk_bf16_f32 v89, v202, v203
  v_pk_mul_f32 v[216:217], v[216:217], v[16:17]
  v_pk_mul_f32 v[218:219], v[218:219], v[16:17]
  v_cvt_pk_bf16_f32 v90, v216, v217
  v_cvt_pk_bf16_f32 v91, v218, v219
  v_pk_mul_f32 v[204:205], v[204:205], v[16:17]
  v_pk_mul_f32 v[206:207], v[206:207], v[16:17]
  v_cvt_pk_bf16_f32 v92, v204, v205
  v_cvt_pk_bf16_f32 v93, v206, v207
  v_pk_mul_f32 v[220:221], v[220:221], v[16:17]
  v_pk_mul_f32 v[222:223], v[222:223], v[16:17]
  v_cvt_pk_bf16_f32 v94, v220, v221
  v_cvt_pk_bf16_f32 v95, v222, v223
  v_mov_b32 v228, 0
  v_mov_b32 v229, 0
  v_mov_b32 v230, 0
  v_mov_b32 v231, 0
  s_add_u32 s23, s20, 1
  s_lshr_b32 s23, s23, 1
  s_lshl_b32 s28, s22, 1
  s_add_u32 s28, s28, s23
  s_lshl_b32 s23, s22, 2
  s_sub_u32 s29, 28, s23
  s_and_b32 s23, s20, 1
  s_add_u32 s29, s29, s23
  v_mov_b32 v3, v2
  v_add_u32 v18, 106496, v2
  s_waitcnt vmcnt(17)
  s_barrier
  ds_read_b128 a[128:131], v18 offset:0
  ds_read_b128 a[132:135], v18 offset:1024
  ds_read_b128 a[136:139], v18 offset:2048
  ds_read_b128 a[140:143], v18 offset:3072
  ds_read_b128 a[144:147], v18 offset:4096
  ds_read_b128 a[148:151], v18 offset:5120
  ds_read_b128 a[152:155], v18 offset:6144
  ds_read_b128 a[156:159], v18 offset:7168
  s_sub_u32 s23, s2, 192
  s_cmp_lt_u32 s23, 54
  s_cselect_b32 s32, 1, 41
  s_and_b32 s37, s2, 1
  s_lshl_b32 s37, s37, 2
  s_add_u32 s37, s37, s20
  s_lshl_b32 s37, s37, 7
  s_lshr_b32 s31, s2, 1
  s_add_u32 s37, s37, s31
  s_lshl_b32 s37, s37, 2
  s_add_u32 s37, s37, 2654208
  s_mov_b32 s38, 0
  s_sub_u32 s31, s2, 64
  s_cmp_lt_u32 s31, 128
  s_cselect_b32 s32, 21, s32
  v_and_b32 v11, 15, v1
  v_lshlrev_b32 v10, 2, v11
  v_add_u32 v10, 2629632, v10
  v_mov_b32 v8, 0
  v_mov_b32 v9, 0
  s_waitcnt lgkmcnt(0)
  v_mfma_f32_16x16x32_bf16 v[96:99], a[128:131], v[32:35], 0
  v_mfma_f32_16x16x32_bf16 v[104:107], a[128:131], v[36:39], 0
  v_mfma_f32_16x16x32_bf16 v[128:131], a[128:131], v[64:67], 0
  v_mfma_f32_16x16x32_bf16 v[136:139], a[128:131], v[68:71], 0
  s_mov_b32 m0, s24
  ds_read_b128 a[128:131], v3 offset:0
  v_mfma_f32_16x16x32_bf16 v[100:103], a[132:135], v[32:35], 0
  buffer_load_dwordx4 v2, s[44:47], s26 offen offset:0 sc1 lds
  v_mfma_f32_16x16x32_bf16 v[108:111], a[132:135], v[36:39], 0
  v_mfma_f32_16x16x32_bf16 v[132:135], a[132:135], v[64:67], 0
  v_mfma_f32_16x16x32_bf16 v[140:143], a[132:135], v[68:71], 0
  ds_read_b128 a[132:135], v3 offset:1024
  v_mfma_f32_16x16x32_bf16 v[96:99], a[136:139], v[40:43], v[96:99]
  v_mfma_f32_16x16x32_bf16 v[104:107], a[136:139], v[44:47], v[104:107]
  v_mfma_f32_16x16x32_bf16 v[128:131], a[136:139], v[72:75], v[128:131]
  buffer_load_dwordx4 v2, s[44:47], s26 offen offset:1024 sc1 lds
  v_mfma_f32_16x16x32_bf16 v[136:139], a[136:139], v[76:79], v[136:139]
  ds_read_b128 a[136:139], v3 offset:2048
  v_mfma_f32_16x16x32_bf16 v[100:103], a[140:143], v[40:43], v[100:103]
  v_mfma_f32_16x16x32_bf16 v[108:111], a[140:143], v[44:47], v[108:111]
  v_mfma_f32_16x16x32_bf16 v[132:135], a[140:143], v[72:75], v[132:135]
  v_mfma_f32_16x16x32_bf16 v[140:143], a[140:143], v[76:79], v[140:143]
  s_waitcnt lgkmcnt(3)
  ds_read_b128 a[140:143], v3 offset:3072
  v_mfma_f32_16x16x32_bf16 v[96:99], a[144:147], v[48:51], v[96:99]
  v_mfma_f32_16x16x32_bf16 v[104:107], a[144:147], v[52:55], v[104:107]
  v_mfma_f32_16x16x32_bf16 v[128:131], a[144:147], v[80:83], v[128:131]
  buffer_load_dwordx4 v2, s[44:47], s26 offen offset:2048 sc1 lds
  v_mfma_f32_16x16x32_bf16 v[136:139], a[144:147], v[84:87], v[136:139]
  ds_read_b128 a[144:147], v3 offset:4096
  v_mfma_f32_16x16x32_bf16 v[100:103], a[148:151], v[48:51], v[100:103]
  v_mfma_f32_16x16x32_bf16 v[108:111], a[148:151], v[52:55], v[108:111]
  v_mfma_f32_16x16x32_bf16 v[132:135], a[148:151], v[80:83], v[132:135]
  v_mfma_f32_16x16x32_bf16 v[140:143], a[148:151], v[84:87], v[140:143]
  ds_read_b128 a[148:151], v3 offset:5120
  v_mfma_f32_16x16x32_bf16 v[96:99], a[152:155], v[56:59], v[96:99]
  buffer_load_dwordx4 v2, s[44:47], s26 offen offset:3072 sc1 lds
  v_mfma_f32_16x16x32_bf16 v[104:107], a[152:155], v[60:63], v[104:107]
  s_add_u32 s26, s26, 16384
  v_mfma_f32_16x16x32_bf16 v[128:131], a[152:155], v[88:91], v[128:131]
  s_add_u32 s24, s24, 32768
  v_mfma_f32_16x16x32_bf16 v[136:139], a[152:155], v[92:95], v[136:139]
  s_and_b32 s24, s24, 0x1ffff
  ds_read_b128 a[152:155], v3 offset:6144
  v_mfma_f32_16x16x32_bf16 v[100:103], a[156:159], v[56:59], v[100:103]
  v_mfma_f32_16x16x32_bf16 v[108:111], a[156:159], v[60:63], v[108:111]
  v_mfma_f32_16x16x32_bf16 v[132:135], a[156:159], v[88:91], v[132:135]
  v_mfma_f32_16x16x32_bf16 v[140:143], a[156:159], v[92:95], v[140:143]
  s_waitcnt lgkmcnt(3)
  ds_read_b128 a[156:159], v3 offset:7168
  s_nop 7
  s_cmp_lg_u32 s28, 0
  s_cbranch_scc1 fa_nomask0
  v_cndmask_b32 v96, v4, v96, s[68:69]
  v_cndmask_b32 v97, v4, v97, s[70:71]
  v_cndmask_b32 v98, v4, v98, s[72:73]
  v_cndmask_b32 v99, v4, v99, s[74:75]
  v_mov_b32 v100, v4
  v_mov_b32 v101, v4
  v_mov_b32 v102, v4
  v_mov_b32 v103, v4
  v_cndmask_b32 v108, v4, v108, s[68:69]
  v_cndmask_b32 v109, v4, v109, s[70:71]
  v_cndmask_b32 v110, v4, v110, s[72:73]
  v_cndmask_b32 v111, v4, v111, s[74:75]
fa_nomask0:
  v_max3_f32 v16, v96, v97, v98
  v_max3_f32 v16, v16, v99, v100
  v_max3_f32 v16, v16, v101, v102
  v_max_f32 v16, v16, v103
  v_max3_f32 v17, v104, v105, v106
  v_max3_f32 v17, v17, v107, v108
  v_max3_f32 v17, v17, v109, v110
  v_max_f32 v17, v17, v111
  v_max3_f32 v18, v128, v129, v130
  v_max3_f32 v18, v18, v131, v132
  v_max3_f32 v18, v18, v133, v134
  v_max_f32 v18, v18, v135
  v_max3_f32 v19, v136, v137, v138
  v_max3_f32 v19, v19, v139, v140
  v_max3_f32 v19, v19, v141, v142
  v_max_f32 v19, v19, v143
  v_mov_b32 v20, v16
  v_mov_b32 v21, v17
  v_mov_b32 v22, v18
  v_mov_b32 v23, v19
  s_nop 0
  v_permlane16_swap_b32 v16, v20
  v_permlane16_swap_b32 v17, v21
  v_permlane16_swap_b32 v18, v22
  v_permlane16_swap_b32 v19, v23
  v_max_f32 v16, v16, v20
  v_max_f32 v17, v17, v21
  v_max_f32 v18, v18, v22
  v_max_f32 v19, v19, v23
  v_mov_b32 v20, v16
  v_mov_b32 v21, v17
  v_mov_b32 v22, v18
  v_mov_b32 v23, v19
  s_nop 0
  v_permlane32_swap_b32 v16, v20
  v_permlane32_swap_b32 v17, v21
  v_permlane32_swap_b32 v18, v22
  v_permlane32_swap_b32 v19, v23
  v_max_f32 v16, v16, v20
  v_max_f32 v17, v17, v21
  v_max_f32 v18, v18, v22
  v_max_f32 v19, v19, v23
  v_sub_f32 v192, 0, v16
  v_sub_f32 v193, 0, v16
  v_sub_f32 v194, 0, v16
  v_sub_f32 v195, 0, v16
  v_sub_f32 v196, 0, v17
  v_sub_f32 v197, 0, v17
  v_sub_f32 v198, 0, v17
  v_sub_f32 v199, 0, v17
  v_sub_f32 v200, 0, v18
  v_sub_f32 v201, 0, v18
  v_sub_f32 v202, 0, v18
  v_sub_f32 v203, 0, v18
  v_sub_f32 v204, 0, v19
  v_sub_f32 v205, 0, v19
  v_sub_f32 v206, 0, v19
  v_sub_f32 v207, 0, v19
  v_sub_f32 v96, v96, v16
  v_sub_f32 v97, v97, v16
  v_sub_f32 v98, v98, v16
  v_sub_f32 v99, v99, v16
  v_sub_f32 v100, v100, v16
  v_sub_f32 v101, v101, v16
  v_sub_f32 v102, v102, v16
  v_sub_f32 v103, v103, v16
  v_sub_f32 v104, v104, v17
  v_sub_f32 v105, v105, v17
  v_sub_f32 v106, v106, v17
  v_sub_f32 v107, v107, v17
  v_sub_f32 v108, v108, v17
  v_sub_f32 v109, v109, v17
  v_sub_f32 v110, v110, v17
  v_sub_f32 v111, v111, v17
  v_sub_f32 v128, v128, v18
  v_sub_f32 v129, v129, v18
  v_sub_f32 v130, v130, v18
  v_sub_f32 v131, v131, v18
  v_sub_f32 v132, v132, v18
  v_sub_f32 v133, v133, v18
  v_sub_f32 v134, v134, v18
  v_sub_f32 v135, v135, v18
  v_sub_f32 v136, v136, v19
  v_sub_f32 v137, v137, v19
  v_sub_f32 v138, v138, v19
  v_sub_f32 v139, v139, v19
  v_sub_f32 v140, v140, v19
  v_sub_f32 v141, v141, v19
  v_sub_f32 v142, v142, v19
  v_sub_f32 v143, v143, v19
  v_mfma_f32_16x16x32_bf16 v[112:115], a[128:131], v[32:35], v[192:195]
  v_exp_f32 v208, v96
  v_exp_f32 v209, v97
  v_mfma_f32_16x16x32_bf16 v[120:123], a[128:131], v[36:39], v[196:199]
  v_exp_f32 v210, v98
  v_exp_f32 v211, v99
  v_mfma_f32_16x16x32_bf16 v[144:147], a[128:131], v[64:67], v[200:203]
  v_exp_f32 v212, v100
  v_exp_f32 v213, v101
  v_mfma_f32_16x16x32_bf16 v[152:155], a[128:131], v[68:71], v[204:207]
  s_mov_b32 m0, s25
  ds_read_b128 a[128:131], v3 offset:8192
  v_exp_f32 v214, v102
  v_add_f32 v224, v208, v209
  v_mfma_f32_16x16x32_bf16 v[116:119], a[132:135], v[32:35], v[192:195]
  buffer_load_dwordx4 v2, s[48:51], s27 offen offset:0 sc1 lds
  v_exp_f32 v215, v103
  v_cvt_pk_bf16_f32 v160, v208, v209
  v_mfma_f32_16x16x32_bf16 v[124:127], a[132:135], v[36:39], v[196:199]
  v_exp_f32 v208, v104
  v_add_f32 v224, v224, v210
  v_add_f32 v224, v224, v211
  v_mfma_f32_16x16x32_bf16 v[148:151], a[132:135], v[64:67], v[200:203]
  v_exp_f32 v209, v105
  v_cvt_pk_bf16_f32 v161, v210, v211
  v_add_f32 v224, v224, v212
  v_mfma_f32_16x16x32_bf16 v[156:159], a[132:135], v[68:71], v[204:207]
  ds_read_b128 a[132:135], v3 offset:9216
  v_exp_f32 v210, v106
  v_mfma_f32_16x16x32_bf16 v[112:115], a[136:139], v[40:43], v[112:115]
  v_exp_f32 v211, v107
  v_add_f32 v224, v224, v213
  v_cvt_pk_bf16_f32 v162, v212, v213
  v_mfma_f32_16x16x32_bf16 v[120:123], a[136:139], v[44:47], v[120:123]
  v_exp_f32 v212, v108
  v_add_f32 v224, v224, v214
  v_add_f32 v224, v224, v215
  v_mfma_f32_16x16x32_bf16 v[144:147], a[136:139], v[72:75], v[144:147]
  buffer_load_dwordx4 v2, s[48:51], s27 offen offset:1024 sc1 lds
  v_exp_f32 v213, v109
  v_cvt_pk_bf16_f32 v163, v214, v215
  v_mfma_f32_16x16x32_bf16 v[152:155], a[136:139], v[76:79], v[152:155]
  ds_read_b128 a[136:139], v3 offset:10240
  v_exp_f32 v214, v110
  v_add_f32 v225, v208, v209
  v_mfma_f32_16x16x32_bf16 v[116:119], a[140:143], v[40:43], v[116:119]
  v_exp_f32 v215, v111
  v_exp_f32 v216, v128
  v_mfma_f32_16x16x32_bf16 v[124:127], a[140:143], v[44:47], v[124:127]
  v_exp_f32 v217, v129
  v_exp_f32 v218, v130
  v_mfma_f32_16x16x32_bf16 v[148:151], a[140:143], v[72:75], v[148:151]
  v_exp_f32 v219, v131
  v_exp_f32 v220, v132
  v_mfma_f32_16x16x32_bf16 v[156:159], a[140:143], v[76:79], v[156:159]
  s_waitcnt lgkmcnt(3)
  ds_read_b128 a[140:143], v3 offset:11264
  v_exp_f32 v221, v133
  v_cvt_pk_bf16_f32 v164, v208, v209
  v_mfma_f32_16x16x32_bf16 v[112:115], a[144:147], v[48:51], v[112:115]
  v_exp_f32 v222, v134
  v_exp_f32 v223, v135
  v_mfma_f32_16x16x32_bf16 v[120:123], a[144:147], v[52:55], v[120:123]
  v_add_f32 v225, v225, v210
  v_add_f32 v225, v225, v211
  v_cvt_pk_bf16_f32 v165, v210, v211
  v_add_f32 v225, v225, v212
  v_mfma_f32_16x16x32_bf16 v[144:147], a[144:147], v[80:83], v[144:147]
  buffer_load_dwordx4 v2, s[48:51], s27 offen offset:2048 sc1 lds
  v_add_f32 v225, v225, v213
  v_cvt_pk_bf16_f32 v166, v212, v213
  v_add_f32 v225, v225, v214
  v_mfma_f32_16x16x32_bf16 v[152:155], a[144:147], v[84:87], v[152:155]
  ds_read_b128 a[144:147], v3 offset:12288
  v_add_f32 v225, v225, v215
  v_cvt_pk_bf16_f32 v167, v214, v215
  v_add_f32 v226, v216, v217
  v_mfma_f32_16x16x32_bf16 v[116:119], a[148:151], v[48:51], v[116:119]
  v_cvt_pk_bf16_f32 v176, v216, v217
  v_exp_f32 v216, v136
  v_add_f32 v226, v226, v218
  v_mfma_f32_16x16x32_bf16 v[124:127], a[148:151], v[52:55], v[124:127]
  v_exp_f32 v217, v137
  v_add_f32 v226, v226, v219
  v_cvt_pk_bf16_f32 v177, v218, v219
  v_mfma_f32_16x16x32_bf16 v[148:151], a[148:151], v[80:83], v[148:151]
  v_exp_f32 v218, v138
  v_add_f32 v226, v226, v220
  v_add_f32 v226, v226, v221
  v_mfma_f32_16x16x32_bf16 v[156:159], a[148:151], v[84:87], v[156:159]
  ds_read_b128 a[148:151], v3 offset:13312
  v_exp_f32 v219, v139
  v_mfma_f32_16x16x32_bf16 v[112:115], a[152:155], v[56:59], v[112:115]
  buffer_load_dwordx4 v2, s[48:51], s27 offen offset:3072 sc1 lds
  v_cvt_pk_bf16_f32 v178, v220, v221
  v_exp_f32 v220, v140
  v_mfma_f32_16x16x32_bf16 v[120:123], a[152:155], v[60:63], v[120:123]
  s_add_u32 s27, s27, 16384
  v_add_f32 v226, v226, v222
  v_add_f32 v226, v226, v223
  v_cvt_pk_bf16_f32 v179, v222, v223
  v_add_f32 v227, v216, v217
  v_mfma_f32_16x16x32_bf16 v[144:147], a[152:155], v[88:91], v[144:147]
  s_add_u32 s25, s25, 32768
  v_exp_f32 v221, v141
  v_cvt_pk_bf16_f32 v180, v216, v217
  v_add_f32 v227, v227, v218
  v_mfma_f32_16x16x32_bf16 v[152:155], a[152:155], v[92:95], v[152:155]
  s_and_b32 s25, s25, 0x1ffff
  ds_read_b128 a[152:155], v3 offset:14336
  v_add_f32 v227, v227, v219
  v_cvt_pk_bf16_f32 v181, v218, v219
  v_max3_f32 v5, v224, v225, v226
  v_mfma_f32_16x16x32_bf16 v[116:119], a[156:159], v[56:59], v[116:119]
  v_exp_f32 v222, v142
  v_add_f32 v227, v227, v220
  v_add_f32 v227, v227, v221
  v_mfma_f32_16x16x32_bf16 v[124:127], a[156:159], v[60:63], v[124:127]
  v_exp_f32 v223, v143
  v_cvt_pk_bf16_f32 v182, v220, v221
  v_add_f32 v227, v227, v222
  v_mfma_f32_16x16x32_bf16 v[148:151], a[156:159], v[88:91], v[148:151]
  v_add_f32 v227, v227, v223
  v_cvt_pk_bf16_f32 v183, v222, v223
  v_max_f32 v5, v5, v227
  v_cmp_lt_f32 vcc, s81, v5
  v_mfma_f32_16x16x32_bf16 v[156:159], a[156:159], v[92:95], v[156:159]
  s_waitcnt lgkmcnt(3)
  s_cbranch_vccnz fa_stub0
fa_back0:
  ds_read_b128 a[156:159], v3 offset:15360
  v_add_f32 v228, v228, v224
  v_add_f32 v229, v229, v225
  v_add_f32 v230, v230, v226
  v_add_f32 v231, v231, v227
  v_add_u32 v3, 32768, v3
  v_and_b32 v3, 0x1ffff, v3
  s_waitcnt vmcnt(8)
  ds_read_b64_tr_b16 v[232:233], v6 offset:0
  ds_read_b64_tr_b16 v[234:235], v6 offset:2560
  ds_read_b64_tr_b16 v[236:237], v6 offset:32
  ds_read_b64_tr_b16 v[238:239], v6 offset:2592
  ds_read_b64_tr_b16 v[240:241], v6 offset:64
  ds_read_b64_tr_b16 v[242:243], v6 offset:2624
  ds_read_b64_tr_b16 v[244:245], v6 offset:96
  ds_read_b64_tr_b16 v[246:247], v6 offset:2656
  ds_read_b64_tr_b16 v[248:249], v6 offset:128
  ds_read_b64_tr_b16 v[250:251], v6 offset:2688
  s_add_u32 s31, s30, 4096
  s_waitcnt lgkmcnt(0)
  buffer_store_dwordx4 v[232:235], v2, s[40:43], s30 offen offset:0 sc1
  buffer_store_dwordx4 v[236:239], v2, s[40:43], s30 offen offset:1024 sc1
  buffer_store_dwordx4 v[240:243], v2, s[40:43], s30 offen offset:2048 sc1
  buffer_store_dwordx4 v[244:247], v2, s[40:43], s30 offen offset:3072 sc1
  buffer_store_dwordx4 v[248:251], v2, s[40:43], s31 offen offset:0 sc1
  s_cmp_eq_u32 s28, 0
  s_cbranch_scc1 fa_AV
  s_sub_u32 s28, s28, 1
  s_cmp_eq_u32 s28, 0
  s_cbranch_scc1 fa_Aexit
.p2align 6
fa_DD:
  v_mfma_f32_16x16x32_bf16 v[96:99], a[128:131], v[32:35], v[192:195]
  s_waitcnt vmcnt(12)
  v_exp_f32 v208, v112
  v_mfma_f32_16x16x32_bf16 v[104:107], a[128:131], v[36:39], v[196:199]
  s_barrier
  v_exp_f32 v209, v113
  v_mfma_f32_16x16x32_bf16 v[128:131], a[128:131], v[64:67], v[200:203]
  s_cmp_lg_u32 s32, 0
  ds_read_b128 a[160:163], v3 offset:16384
  v_add_f32 v224, v208, v209
  v_mfma_f32_16x16x32_bf16 v[136:139], a[128:131], v[68:71], v[204:207]
  s_cbranch_scc1 fa_fstub
fa_fback:
  v_exp_f32 v210, v114
  v_mfma_f32_16x16x32_bf16 v[100:103], a[132:135], v[32:35], v[192:195]
  ds_read_b128 a[164:167], v3 offset:17408
  v_cvt_pk_bf16_f32 v168, v208, v209
  v_mfma_f32_16x16x32_bf16 v[108:111], a[132:135], v[36:39], v[196:199]
  s_mov_b32 m0, s24
  v_exp_f32 v211, v115
  v_mfma_f32_16x16x32_bf16 v[132:135], a[132:135], v[64:67], v[200:203]
  buffer_load_dwordx4 v2, s[44:47], s26 offen offset:0 sc1 lds
  v_add_f32 v224, v224, v210
  v_add_f32 v224, v224, v211
  v_mfma_f32_16x16x32_bf16 v[140:143], a[132:135], v[68:71], v[204:207]
  v_exp_f32 v212, v116
  v_mfma_f32_16x16x32_bf16 v[96:99], a[136:139], v[40:43], v[96:99]
  ds_read_b128 a[168:171], v3 offset:18432
  v_cvt_pk_bf16_f32 v169, v210, v211
  v_mfma_f32_16x16x32_bf16 v[104:107], a[136:139], v[44:47], v[104:107]
  v_exp_f32 v213, v117
  v_mfma_f32_16x16x32_bf16 v[128:131], a[136:139], v[72:75], v[128:131]
  v_exp_f32 v214, v118
  v_mfma_f32_16x16x32_bf16 v[136:139], a[136:139], v[76:79], v[136:139]
  v_exp_f32 v215, v119
  v_mfma_f32_16x16x32_bf16 v[100:103], a[140:143], v[40:43], v[100:103]
  ds_read_b128 a[172:175], v3 offset:19456
  v_add_f32 v224, v224, v212
  v_mfma_f32_16x16x32_bf16 v[108:111], a[140:143], v[44:47], v[108:111]
  v_exp_f32 v208, v120
  v_mfma_f32_16x16x32_bf16 v[132:135], a[140:143], v[72:75], v[132:135]
  v_exp_f32 v209, v121
  v_mfma_f32_16x16x32_bf16 v[140:143], a[140:143], v[76:79], v[140:143]
  s_waitcnt lgkmcnt(4)
  v_exp_f32 v210, v122
  v_mfma_f32_16x16x32_bf16 v[96:99], a[144:147], v[48:51], v[96:99]
  ds_read_b128 a[176:179], v3 offset:20480
  v_add_f32 v224, v224, v213
  v_mfma_f32_16x16x32_bf16 v[104:107], a[144:147], v[52:55], v[104:107]
  v_exp_f32 v211, v123
  v_mfma_f32_16x16x32_bf16 v[128:131], a[144:147], v[80:83], v[128:131]
  v_cvt_pk_bf16_f32 v170, v212, v213
  v_add_f32 v224, v224, v214
  v_add_f32 v224, v224, v215
  v_mfma_f32_16x16x32_bf16 v[136:139], a[144:147], v[84:87], v[136:139]
  v_exp_f32 v212, v124
  v_mfma_f32_16x16x32_bf16 v[100:103], a[148:151], v[48:51], v[100:103]
  ds_read_b128 a[180:183], v3 offset:21504
  v_cvt_pk_bf16_f32 v171, v214, v215
  v_mfma_f32_16x16x32_bf16 v[108:111], a[148:151], v[52:55], v[108:111]
  v_exp_f32 v213, v125
  v_mfma_f32_16x16x32_bf16 v[132:135], a[148:151], v[80:83], v[132:135]
  buffer_load_dwordx4 v2, s[44:47], s26 offen offset:1024 sc1 lds
  v_add_f32 v225, v208, v209
  v_mfma_f32_16x16x32_bf16 v[140:143], a[148:151], v[84:87], v[140:143]
  v_exp_f32 v214, v126
  v_mfma_f32_16x16x32_bf16 v[96:99], a[152:155], v[56:59], v[96:99]
  ds_read_b128 a[184:187], v3 offset:22528
  v_cvt_pk_bf16_f32 v172, v208, v209
  v_mfma_f32_16x16x32_bf16 v[104:107], a[152:155], v[60:63], v[104:107]
  v_exp_f32 v215, v127
  v_mfma_f32_16x16x32_bf16 v[128:131], a[152:155], v[88:91], v[128:131]
  v_exp_f32 v216, v144
  v_mfma_f32_16x16x32_bf16 v[136:139], a[152:155], v[92:95], v[136:139]
  v_exp_f32 v217, v145
  v_mfma_f32_16x16x32_bf16 v[100:103], a[156:159], v[56:59], v[100:103]
  ds_read_b128 a[188:191], v3 offset:23552
  v_add_f32 v225, v225, v210
  v_mfma_f32_16x16x32_bf16 v[108:111], a[156:159], v[60:63], v[108:111]
  v_exp_f32 v218, v146
  v_mfma_f32_16x16x32_bf16 v[132:135], a[156:159], v[88:91], v[132:135]
  v_exp_f32 v219, v147
  v_mfma_f32_16x16x32_bf16 v[140:143], a[156:159], v[92:95], v[140:143]
  s_waitcnt lgkmcnt(4)
  v_exp_f32 v220, v148
  v_add_f32 v225, v225, v211
  v_mfma_f32_16x16x32_bf16 a[0:3], a[160:163], v[160:163], a[0:3]
  ds_read_b128 a[128:131], v3 offset:0
  v_cvt_pk_bf16_f32 v173, v210, v211
  v_mfma_f32_16x16x32_bf16 a[4:7], a[160:163], v[164:167], a[4:7]
  v_exp_f32 v221, v149
  v_mfma_f32_16x16x32_bf16 a[64:67], a[160:163], v[176:179], a[64:67]
  v_exp_f32 v222, v150
  v_mfma_f32_16x16x32_bf16 a[68:71], a[160:163], v[180:183], a[68:71]
  v_exp_f32 v223, v151
  v_mfma_f32_16x16x32_bf16 a[8:11], a[164:167], v[160:163], a[8:11]
  ds_read_b128 a[132:135], v3 offset:1024
  v_add_f32 v225, v225, v212
  v_mfma_f32_16x16x32_bf16 a[12:15], a[164:167], v[164:167], a[12:15]
  v_add_f32 v225, v225, v213
  v_cvt_pk_bf16_f32 v174, v212, v213
  v_mfma_f32_16x16x32_bf16 a[72:75], a[164:167], v[176:179], a[72:75]
  buffer_load_dwordx4 v2, s[44:47], s26 offen offset:2048 sc1 lds
  v_add_f32 v225, v225, v214
  v_mfma_f32_16x16x32_bf16 a[76:79], a[164:167], v[180:183], a[76:79]
  v_add_f32 v225, v225, v215
  v_cvt_pk_bf16_f32 v175, v214, v215
  v_mfma_f32_16x16x32_bf16 a[16:19], a[168:171], v[160:163], a[16:19]
  ds_read_b128 a[136:139], v3 offset:2048
  v_add_f32 v226, v216, v217
  v_mfma_f32_16x16x32_bf16 a[20:23], a[168:171], v[164:167], a[20:23]
  v_cvt_pk_bf16_f32 v184, v216, v217
  v_add_f32 v226, v226, v218
  v_mfma_f32_16x16x32_bf16 a[80:83], a[168:171], v[176:179], a[80:83]
  v_exp_f32 v216, v152
  v_mfma_f32_16x16x32_bf16 a[84:87], a[168:171], v[180:183], a[84:87]
  v_exp_f32 v217, v153
  v_mfma_f32_16x16x32_bf16 a[24:27], a[172:175], v[160:163], a[24:27]
  ds_read_b128 a[140:143], v3 offset:3072
  v_add_f32 v226, v226, v219
  v_cvt_pk_bf16_f32 v185, v218, v219
  v_mfma_f32_16x16x32_bf16 a[28:31], a[172:175], v[164:167], a[28:31]
  v_exp_f32 v218, v154
  v_mfma_f32_16x16x32_bf16 a[88:91], a[172:175], v[176:179], a[88:91]
  v_add_f32 v226, v226, v220
  v_add_f32 v226, v226, v221
  v_mfma_f32_16x16x32_bf16 a[92:95], a[172:175], v[180:183], a[92:95]
  s_waitcnt lgkmcnt(4)
  v_exp_f32 v219, v155
  v_mfma_f32_16x16x32_bf16 a[32:35], a[176:179], v[160:163], a[32:35]
  ds_read_b128 a[144:147], v3 offset:4096
  v_cvt_pk_bf16_f32 v186, v220, v221
  v_mfma_f32_16x16x32_bf16 a[36:39], a[176:179], v[164:167], a[36:39]
  v_exp_f32 v220, v156
  v_mfma_f32_16x16x32_bf16 a[96:99], a[176:179], v[176:179], a[96:99]
  v_add_f32 v226, v226, v222
  v_add_f32 v226, v226, v223
  v_mfma_f32_16x16x32_bf16 a[100:103], a[176:179], v[180:183], a[100:103]
  v_exp_f32 v221, v157
  v_mfma_f32_16x16x32_bf16 a[40:43], a[180:183], v[160:163], a[40:43]
  ds_read_b128 a[148:151], v3 offset:5120
  v_cvt_pk_bf16_f32 v187, v222, v223
  v_mfma_f32_16x16x32_bf16 a[44:47], a[180:183], v[164:167], a[44:47]
  v_exp_f32 v222, v158
  v_mfma_f32_16x16x32_bf16 a[104:107], a[180:183], v[176:179], a[104:107]
  buffer_load_dwordx4 v2, s[44:47], s26 offen offset:3072 sc1 lds
  v_add_f32 v227, v216, v217
  v_mfma_f32_16x16x32_bf16 a[108:111], a[180:183], v[180:183], a[108:111]
  s_add_u32 s26, s26, 16384
  v_exp_f32 v223, v159
  v_mfma_f32_16x16x32_bf16 a[48:51], a[184:187], v[160:163], a[48:51]
  s_add_u32 s24, s24, 32768
  ds_read_b128 a[152:155], v3 offset:6144
  v_cvt_pk_bf16_f32 v188, v216, v217
  v_add_f32 v227, v227, v218
  v_mfma_f32_16x16x32_bf16 a[52:55], a[184:187], v[164:167], a[52:55]
  s_and_b32 s24, s24, 0x1ffff
  v_add_f32 v227, v227, v219
  v_cvt_pk_bf16_f32 v189, v218, v219
  v_mfma_f32_16x16x32_bf16 a[112:115], a[184:187], v[176:179], a[112:115]
  v_max3_f32 v5, v224, v225, v226
  v_add_f32 v227, v227, v220
  v_mfma_f32_16x16x32_bf16 a[116:119], a[184:187], v[180:183], a[116:119]
  v_add_f32 v227, v227, v221
  v_cvt_pk_bf16_f32 v190, v220, v221
  v_mfma_f32_16x16x32_bf16 a[56:59], a[188:191], v[160:163], a[56:59]
  ds_read_b128 a[156:159], v3 offset:7168
  v_add_f32 v227, v227, v222
  v_mfma_f32_16x16x32_bf16 a[60:63], a[188:191], v[164:167], a[60:63]
  v_add_f32 v227, v227, v223
  v_cvt_pk_bf16_f32 v191, v222, v223
  v_mfma_f32_16x16x32_bf16 a[120:123], a[188:191], v[176:179], a[120:123]
  s_waitcnt lgkmcnt(4)
  v_max_f32 v5, v5, v227
  v_cmp_lt_f32 vcc, s81, v5
  v_mfma_f32_16x16x32_bf16 a[124:127], a[188:191], v[180:183], a[124:127]
  s_cbranch_vccnz fa_stub1
fa_back1:
  v_add_f32 v228, v228, v224
  v_add_f32 v229, v229, v225
  v_add_f32 v230, v230, v226
  v_add_f32 v231, v231, v227
  v_mfma_f32_16x16x32_bf16 v[112:115], a[128:131], v[32:35], v[192:195]
  ds_read_b128 a[160:163], v3 offset:24576
  v_exp_f32 v208, v96
  v_mfma_f32_16x16x32_bf16 v[120:123], a[128:131], v[36:39], v[196:199]
  v_exp_f32 v209, v97
  v_mfma_f32_16x16x32_bf16 v[144:147], a[128:131], v[64:67], v[200:203]
  v_exp_f32 v210, v98
  v_mfma_f32_16x16x32_bf16 v[152:155], a[128:131], v[68:71], v[204:207]
  v_exp_f32 v211, v99
  v_mfma_f32_16x16x32_bf16 v[116:119], a[132:135], v[32:35], v[192:195]
  ds_read_b128 a[164:167], v3 offset:25600
  v_mfma_f32_16x16x32_bf16 v[124:127], a[132:135], v[36:39], v[196:199]
  s_mov_b32 m0, s25
  v_exp_f32 v212, v100
  v_mfma_f32_16x16x32_bf16 v[148:151], a[132:135], v[64:67], v[200:203]
  buffer_load_dwordx4 v2, s[48:51], s27 offen offset:0 sc1 lds
  v_add_f32 v224, v208, v209
  v_cvt_pk_bf16_f32 v160, v208, v209
  v_mfma_f32_16x16x32_bf16 v[156:159], a[132:135], v[68:71], v[204:207]
  v_exp_f32 v213, v101
  v_mfma_f32_16x16x32_bf16 v[112:115], a[136:139], v[40:43], v[112:115]
  ds_read_b128 a[168:171], v3 offset:26624
  v_add_f32 v224, v224, v210
  v_mfma_f32_16x16x32_bf16 v[120:123], a[136:139], v[44:47], v[120:123]
  v_exp_f32 v214, v102
  v_mfma_f32_16x16x32_bf16 v[144:147], a[136:139], v[72:75], v[144:147]
  v_exp_f32 v215, v103
  v_mfma_f32_16x16x32_bf16 v[152:155], a[136:139], v[76:79], v[152:155]
  v_exp_f32 v208, v104
  v_mfma_f32_16x16x32_bf16 v[116:119], a[140:143], v[40:43], v[116:119]
  ds_read_b128 a[172:175], v3 offset:27648
  v_add_f32 v224, v224, v211
  v_mfma_f32_16x16x32_bf16 v[124:127], a[140:143], v[44:47], v[124:127]
  v_exp_f32 v209, v105
  v_mfma_f32_16x16x32_bf16 v[148:151], a[140:143], v[72:75], v[148:151]
  v_cvt_pk_bf16_f32 v161, v210, v211
  v_add_f32 v224, v224, v212
  v_mfma_f32_16x16x32_bf16 v[156:159], a[140:143], v[76:79], v[156:159]
  s_waitcnt lgkmcnt(4)
  v_exp_f32 v210, v106
  v_mfma_f32_16x16x32_bf16 v[112:115], a[144:147], v[48:51], v[112:115]
  ds_read_b128 a[176:179], v3 offset:28672
  v_add_f32 v224, v224, v213
  v_mfma_f32_16x16x32_bf16 v[120:123], a[144:147], v[52:55], v[120:123]
  v_exp_f32 v211, v107
  v_mfma_f32_16x16x32_bf16 v[144:147], a[144:147], v[80:83], v[144:147]
  v_cvt_pk_bf16_f32 v162, v212, v213
  v_add_f32 v224, v224, v214
  v_add_f32 v224, v224, v215
  v_mfma_f32_16x16x32_bf16 v[152:155], a[144:147], v[84:87], v[152:155]
  v_exp_f32 v212, v108
  v_mfma_f32_16x16x32_bf16 v[116:119], a[148:151], v[48:51], v[116:119]
  ds_read_b128 a[180:183], v3 offset:29696
  v_cvt_pk_bf16_f32 v163, v214, v215
  v_mfma_f32_16x16x32_bf16 v[124:127], a[148:151], v[52:55], v[124:127]
  v_exp_f32 v213, v109
  v_mfma_f32_16x16x32_bf16 v[148:151], a[148:151], v[80:83], v[148:151]
  buffer_load_dwordx4 v2, s[48:51], s27 offen offset:1024 sc1 lds
  v_add_f32 v225, v208, v209
  v_mfma_f32_16x16x32_bf16 v[156:159], a[148:151], v[84:87], v[156:159]
  v_exp_f32 v214, v110
  v_mfma_f32_16x16x32_bf16 v[112:115], a[152:155], v[56:59], v[112:115]
  ds_read_b128 a[184:187], v3 offset:30720
  v_cvt_pk_bf16_f32 v164, v208, v209
  v_mfma_f32_16x16x32_bf16 v[120:123], a[152:155], v[60:63], v[120:123]
  v_exp_f32 v215, v111
  v_mfma_f32_16x16x32_bf16 v[144:147], a[152:155], v[88:91], v[144:147]
  v_exp_f32 v216, v128
  v_mfma_f32_16x16x32_bf16 v[152:155], a[152:155], v[92:95], v[152:155]
  v_exp_f32 v217, v129
  v_mfma_f32_16x16x32_bf16 v[116:119], a[156:159], v[56:59], v[116:119]
  ds_read_b128 a[188:191], v3 offset:31744
  v_add_f32 v225, v225, v210
  v_mfma_f32_16x16x32_bf16 v[124:127], a[156:159], v[60:63], v[124:127]
  v_exp_f32 v218, v130
  v_mfma_f32_16x16x32_bf16 v[148:151], a[156:159], v[88:91], v[148:151]
  v_exp_f32 v219, v131
  v_mfma_f32_16x16x32_bf16 v[156:159], a[156:159], v[92:95], v[156:159]
  s_waitcnt lgkmcnt(4)
  v_exp_f32 v220, v132
  v_add_f32 v225, v225, v211
  v_mfma_f32_16x16x32_bf16 a[0:3], a[160:163], v[168:171], a[0:3]
  ds_read_b128 a[128:131], v3 offset:8192
  v_cvt_pk_bf16_f32 v165, v210, v211
  v_mfma_f32_16x16x32_bf16 a[4:7], a[160:163], v[172:175], a[4:7]
  v_exp_f32 v221, v133
  v_mfma_f32_16x16x32_bf16 a[64:67], a[160:163], v[184:187], a[64:67]
  v_exp_f32 v222, v134
  v_mfma_f32_16x16x32_bf16 a[68:71], a[160:163], v[188:191], a[68:71]
  v_exp_f32 v223, v135
  v_mfma_f32_16x16x32_bf16 a[8:11], a[164:167], v[168:171], a[8:11]
  ds_read_b128 a[132:135], v3 offset:9216
  v_add_f32 v225, v225, v212
  v_mfma_f32_16x16x32_bf16 a[12:15], a[164:167], v[172:175], a[12:15]
  v_add_f32 v225, v225, v213
  v_cvt_pk_bf16_f32 v166, v212, v213
  v_mfma_f32_16x16x32_bf16 a[72:75], a[164:167], v[184:187], a[72:75]
  buffer_load_dwordx4 v2, s[48:51], s27 offen offset:2048 sc1 lds
  v_add_f32 v225, v225, v214
  v_mfma_f32_16x16x32_bf16 a[76:79], a[164:167], v[188:191], a[76:79]
  v_add_f32 v225, v225, v215
  v_cvt_pk_bf16_f32 v167, v214, v215
  v_mfma_f32_16x16x32_bf16 a[16:19], a[168:171], v[168:171], a[16:19]
  ds_read_b128 a[136:139], v3 offset:10240
  v_add_f32 v226, v216, v217
  v_mfma_f32_16x16x32_bf16 a[20:23], a[168:171], v[172:175], a[20:23]
  v_cvt_pk_bf16_f32 v176, v216, v217
  v_add_f32 v226, v226, v218
  v_mfma_f32_16x16x32_bf16 a[80:83], a[168:171], v[184:187], a[80:83]
  v_exp_f32 v216, v136
  v_mfma_f32_16x16x32_bf16 a[84:87], a[168:171], v[188:191], a[84:87]
  v_exp_f32 v217, v137
  v_mfma_f32_16x16x32_bf16 a[24:27], a[172:175], v[168:171], a[24:27]
  ds_read_b128 a[140:143], v3 offset:11264
  v_add_f32 v226, v226, v219
  v_cvt_pk_bf16_f32 v177, v218, v219
  v_mfma_f32_16x16x32_bf16 a[28:31], a[172:175], v[172:175], a[28:31]
  v_exp_f32 v218, v138
  v_mfma_f32_16x16x32_bf16 a[88:91], a[172:175], v[184:187], a[88:91]
  v_add_f32 v226, v226, v220
  v_add_f32 v226, v226, v221
  v_mfma_f32_16x16x32_bf16 a[92:95], a[172:175], v[188:191], a[92:95]
  s_waitcnt lgkmcnt(4)
  v_exp_f32 v219, v139
  v_mfma_f32_16x16x32_bf16 a[32:35], a[176:179], v[168:171], a[32:35]
  ds_read_b128 a[144:147], v3 offset:12288
  v_cvt_pk_bf16_f32 v178, v220, v221
  v_mfma_f32_16x16x32_bf16 a[36:39], a[176:179], v[172:175], a[36:39]
  v_exp_f32 v220, v140
  v_mfma_f32_16x16x32_bf16 a[96:99], a[176:179], v[184:187], a[96:99]
  v_add_f32 v226, v226, v222
  v_add_f32 v226, v226, v223
  v_mfma_f32_16x16x32_bf16 a[100:103], a[176:179], v[188:191], a[100:103]
  v_exp_f32 v221, v141
  v_mfma_f32_16x16x32_bf16 a[40:43], a[180:183], v[168:171], a[40:43]
  ds_read_b128 a[148:151], v3 offset:13312
  v_cvt_pk_bf16_f32 v179, v222, v223
  v_mfma_f32_16x16x32_bf16 a[44:47], a[180:183], v[172:175], a[44:47]
  v_exp_f32 v222, v142
  v_mfma_f32_16x16x32_bf16 a[104:107], a[180:183], v[184:187], a[104:107]
  buffer_load_dwordx4 v2, s[48:51], s27 offen offset:3072 sc1 lds
  v_add_f32 v227, v216, v217
  v_mfma_f32_16x16x32_bf16 a[108:111], a[180:183], v[188:191], a[108:111]
  s_add_u32 s27, s27, 16384
  v_exp_f32 v223, v143
  v_mfma_f32_16x16x32_bf16 a[48:51], a[184:187], v[168:171], a[48:51]
  s_add_u32 s25, s25, 32768
  ds_read_b128 a[152:155], v3 offset:14336
  v_cvt_pk_bf16_f32 v180, v216, v217
  v_add_f32 v227, v227, v218
  v_mfma_f32_16x16x32_bf16 a[52:55], a[184:187], v[172:175], a[52:55]
  s_and_b32 s25, s25, 0x1ffff
  v_add_f32 v227, v227, v219
  v_cvt_pk_bf16_f32 v181, v218, v219
  v_mfma_f32_16x16x32_bf16 a[112:115], a[184:187], v[184:187], a[112:115]
  v_max3_f32 v5, v224, v225, v226
  v_add_f32 v227, v227, v220
  v_mfma_f32_16x16x32_bf16 a[116:119], a[184:187], v[188:191], a[116:119]
  v_add_f32 v227, v227, v221
  v_cvt_pk_bf16_f32 v182, v220, v221
  v_mfma_f32_16x16x32_bf16 a[56:59], a[188:191], v[168:171], a[56:59]
  ds_read_b128 a[156:159], v3 offset:15360
  v_add_f32 v227, v227, v222
  v_mfma_f32_16x16x32_bf16 a[60:63], a[188:191], v[172:175], a[60:63]
  s_sub_u32 s28, s28, 1
  v_add_f32 v227, v227, v223
  v_cvt_pk_bf16_f32 v183, v222, v223
  v_mfma_f32_16x16x32_bf16 a[120:123], a[188:191], v[184:187], a[120:123]
  s_waitcnt lgkmcnt(4)
  v_max_f32 v5, v5, v227
  v_cmp_lt_f32 vcc, s81, v5
  v_mfma_f32_16x16x32_bf16 a[124:127], a[188:191], v[188:191], a[124:127]
  s_cbranch_vccnz fa_stub2
fa_back2:
  v_add_f32 v228, v228, v224
  v_add_f32 v229, v229, v225
  v_add_f32 v230, v230, v226
  v_add_f32 v231, v231, v227
  v_add_u32 v3, 32768, v3
  v_and_b32 v3, 0x1ffff, v3
  s_cmp_lg_u32 s28, 0
  s_cbranch_scc1 fa_DD
fa_Aexit:
  s_bitcmp1_b32 s20, 0
  s_cbranch_scc1 fa_Aodd
  v_mfma_f32_16x16x32_bf16 v[96:99], a[128:131], v[32:35], v[192:195]
  s_waitcnt vmcnt(12)
  v_exp_f32 v208, v112
  v_mfma_f32_16x16x32_bf16 v[104:107], a[128:131], v[36:39], v[196:199]
  s_barrier
  v_exp_f32 v209, v113
  v_mfma_f32_16x16x32_bf16 v[128:131], a[128:131], v[64:67], v[200:203]
  ds_read_b128 a[160:163], v3 offset:16384
  v_add_f32 v224, v208, v209
  v_mfma_f32_16x16x32_bf16 v[136:139], a[128:131], v[68:71], v[204:207]
  v_exp_f32 v210, v114
  v_mfma_f32_16x16x32_bf16 v[100:103], a[132:135], v[32:35], v[192:195]
  ds_read_b128 a[164:167], v3 offset:17408
  v_cvt_pk_bf16_f32 v168, v208, v209
  v_mfma_f32_16x16x32_bf16 v[108:111], a[132:135], v[36:39], v[196:199]
  s_mov_b32 m0, s24
  v_exp_f32 v211, v115
  v_mfma_f32_16x16x32_bf16 v[132:135], a[132:135], v[64:67], v[200:203]
  buffer_load_dwordx4 v2, s[44:47], s26 offen offset:0 sc1 lds
  v_add_f32 v224, v224, v210
  v_add_f32 v224, v224, v211
  v_mfma_f32_16x16x32_bf16 v[140:143], a[132:135], v[68:71], v[204:207]
  v_exp_f32 v212, v116
  v_mfma_f32_16x16x32_bf16 v[96:99], a[136:139], v[40:43], v[96:99]
  ds_read_b128 a[168:171], v3 offset:18432
  v_cvt_pk_bf16_f32 v169, v210, v211
  v_mfma_f32_16x16x32_bf16 v[104:107], a[136:139], v[44:47], v[104:107]
  v_exp_f32 v213, v117
  v_mfma_f32_16x16x32_bf16 v[128:131], a[136:139], v[72:75], v[128:131]
  v_exp_f32 v214, v118
  v_mfma_f32_16x16x32_bf16 v[136:139], a[136:139], v[76:79], v[136:139]
  v_exp_f32 v215, v119
  v_mfma_f32_16x16x32_bf16 v[100:103], a[140:143], v[40:43], v[100:103]
  ds_read_b128 a[172:175], v3 offset:19456
  v_add_f32 v224, v224, v212
  v_mfma_f32_16x16x32_bf16 v[108:111], a[140:143], v[44:47], v[108:111]
  v_exp_f32 v208, v120
  v_mfma_f32_16x16x32_bf16 v[132:135], a[140:143], v[72:75], v[132:135]
  v_exp_f32 v209, v121
  v_mfma_f32_16x16x32_bf16 v[140:143], a[140:143], v[76:79], v[140:143]
  s_waitcnt lgkmcnt(4)
  v_exp_f32 v210, v122
  v_mfma_f32_16x16x32_bf16 v[96:99], a[144:147], v[48:51], v[96:99]
  ds_read_b128 a[176:179], v3 offset:20480
  v_add_f32 v224, v224, v213
  v_mfma_f32_16x16x32_bf16 v[104:107], a[144:147], v[52:55], v[104:107]
  v_exp_f32 v211, v123
  v_mfma_f32_16x16x32_bf16 v[128:131], a[144:147], v[80:83], v[128:131]
  v_cvt_pk_bf16_f32 v170, v212, v213
  v_add_f32 v224, v224, v214
  v_add_f32 v224, v224, v215
  v_mfma_f32_16x16x32_bf16 v[136:139], a[144:147], v[84:87], v[136:139]
  v_exp_f32 v212, v124
  v_mfma_f32_16x16x32_bf16 v[100:103], a[148:151], v[48:51], v[100:103]
  ds_read_b128 a[180:183], v3 offset:21504
  v_cvt_pk_bf16_f32 v171, v214, v215
  v_mfma_f32_16x16x32_bf16 v[108:111], a[148:151], v[52:55], v[108:111]
  v_exp_f32 v213, v125
  v_mfma_f32_16x16x32_bf16 v[132:135], a[148:151], v[80:83], v[132:135]
  buffer_load_dwordx4 v2, s[44:47], s26 offen offset:1024 sc1 lds
  v_add_f32 v225, v208, v209
  v_mfma_f32_16x16x32_bf16 v[140:143], a[148:151], v[84:87], v[140:143]
  v_exp_f32 v214, v126
  v_mfma_f32_16x16x32_bf16 v[96:99], a[152:155], v[56:59], v[96:99]
  ds_read_b128 a[184:187], v3 offset:22528
  v_cvt_pk_bf16_f32 v172, v208, v209
  v_mfma_f32_16x16x32_bf16 v[104:107], a[152:155], v[60:63], v[104:107]
  v_exp_f32 v215, v127
  v_mfma_f32_16x16x32_bf16 v[128:131], a[152:155], v[88:91], v[128:131]
  v_exp_f32 v216, v144
  v_mfma_f32_16x16x32_bf16 v[136:139], a[152:155], v[92:95], v[136:139]
  v_exp_f32 v217, v145
  v_mfma_f32_16x16x32_bf16 v[100:103], a[156:159], v[56:59], v[100:103]
  ds_read_b128 a[188:191], v3 offset:23552
  v_add_f32 v225, v225, v210
  v_mfma_f32_16x16x32_bf16 v[108:111], a[156:159], v[60:63], v[108:111]
  v_exp_f32 v218, v146
  v_mfma_f32_16x16x32_bf16 v[132:135], a[156:159], v[88:91], v[132:135]
  v_exp_f32 v219, v147
  v_mfma_f32_16x16x32_bf16 v[140:143], a[156:159], v[92:95], v[140:143]
  s_waitcnt lgkmcnt(4)
  v_exp_f32 v220, v148
  v_add_f32 v225, v225, v211
  v_mfma_f32_16x16x32_bf16 a[0:3], a[160:163], v[160:163], a[0:3]
  ds_read_b128 a[128:131], v3 offset:0
  v_cvt_pk_bf16_f32 v173, v210, v211
  v_mfma_f32_16x16x32_bf16 a[4:7], a[160:163], v[164:167], a[4:7]
  v_exp_f32 v221, v149
  v_mfma_f32_16x16x32_bf16 a[64:67], a[160:163], v[176:179], a[64:67]
  v_exp_f32 v222, v150
  v_mfma_f32_16x16x32_bf16 a[68:71], a[160:163], v[180:183], a[68:71]
  v_exp_f32 v223, v151
  v_mfma_f32_16x16x32_bf16 a[8:11], a[164:167], v[160:163], a[8:11]
  ds_read_b128 a[132:135], v3 offset:1024
  v_add_f32 v225, v225, v212
  v_mfma_f32_16x16x32_bf16 a[12:15], a[164:167], v[164:167], a[12:15]
  v_add_f32 v225, v225, v213
  v_cvt_pk_bf16_f32 v174, v212, v213
  v_mfma_f32_16x16x32_bf16 a[72:75], a[164:167], v[176:179], a[72:75]
  buffer_load_dwordx4 v2, s[44:47], s26 offen offset:2048 sc1 lds
  v_add_f32 v225, v225, v214
  v_mfma_f32_16x16x32_bf16 a[76:79], a[164:167], v[180:183], a[76:79]
  v_add_f32 v225, v225, v215
  v_cvt_pk_bf16_f32 v175, v214, v215
  v_mfma_f32_16x16x32_bf16 a[16:19], a[168:171], v[160:163], a[16:19]
  ds_read_b128 a[136:139], v3 offset:2048
  v_add_f32 v226, v216, v217
  v_mfma_f32_16x16x32_bf16 a[20:23], a[168:171], v[164:167], a[20:23]
  v_cvt_pk_bf16_f32 v184, v216, v217
  v_add_f32 v226, v226, v218
  v_mfma_f32_16x16x32_bf16 a[80:83], a[168:171], v[176:179], a[80:83]
  v_exp_f32 v216, v152
  v_mfma_f32_16x16x32_bf16 a[84:87], a[168:171], v[180:183], a[84:87]
  v_exp_f32 v217, v153
  v_mfma_f32_16x16x32_bf16 a[24:27], a[172:175], v[160:163], a[24:27]
  ds_read_b128 a[140:143], v3 offset:3072
  v_add_f32 v226, v226, v219
  v_cvt_pk_bf16_f32 v185, v218, v219
  v_mfma_f32_16x16x32_bf16 a[28:31], a[172:175], v[164:167], a[28:31]
  v_exp_f32 v218, v154
  v_mfma_f32_16x16x32_bf16 a[88:91], a[172:175], v[176:179], a[88:91]
  v_add_f32 v226, v226, v220
  v_add_f32 v226, v226, v221
  v_mfma_f32_16x16x32_bf16 a[92:95], a[172:175], v[180:183], a[92:95]
  s_waitcnt lgkmcnt(4)
  v_exp_f32 v219, v155
  v_mfma_f32_16x16x32_bf16 a[32:35], a[176:179], v[160:163], a[32:35]
  ds_read_b128 a[144:147], v3 offset:4096
  v_cvt_pk_bf16_f32 v186, v220, v221
  v_mfma_f32_16x16x32_bf16 a[36:39], a[176:179], v[164:167], a[36:39]
  v_exp_f32 v220, v156
  v_mfma_f32_16x16x32_bf16 a[96:99], a[176:179], v[176:179], a[96:99]
  v_add_f32 v226, v226, v222
  v_add_f32 v226, v226, v223
  v_mfma_f32_16x16x32_bf16 a[100:103], a[176:179], v[180:183], a[100:103]
  v_exp_f32 v221, v157
  v_mfma_f32_16x16x32_bf16 a[40:43], a[180:183], v[160:163], a[40:43]
  ds_read_b128 a[148:151], v3 offset:5120
  v_cvt_pk_bf16_f32 v187, v222, v223
  v_mfma_f32_16x16x32_bf16 a[44:47], a[180:183], v[164:167], a[44:47]
  v_exp_f32 v222, v158
  v_mfma_f32_16x16x32_bf16 a[104:107], a[180:183], v[176:179], a[104:107]
  buffer_load_dwordx4 v2, s[44:47], s26 offen offset:3072 sc1 lds
  v_add_f32 v227, v216, v217
  v_mfma_f32_16x16x32_bf16 a[108:111], a[180:183], v[180:183], a[108:111]
  s_add_u32 s26, s26, 16384
  v_exp_f32 v223, v159
  v_mfma_f32_16x16x32_bf16 a[48:51], a[184:187], v[160:163], a[48:51]
  s_add_u32 s24, s24, 32768
  ds_read_b128 a[152:155], v3 offset:6144
  v_cvt_pk_bf16_f32 v188, v216, v217
  v_add_f32 v227, v227, v218
  v_mfma_f32_16x16x32_bf16 a[52:55], a[184:187], v[164:167], a[52:55]
  s_and_b32 s24, s24, 0x1ffff
  v_add_f32 v227, v227, v219
  v_cvt_pk_bf16_f32 v189, v218, v219
  v_mfma_f32_16x16x32_bf16 a[112:115], a[184:187], v[176:179], a[112:115]
  v_max3_f32 v5, v224, v225, v226
  v_add_f32 v227, v227, v220
  v_mfma_f32_16x16x32_bf16 a[116:119], a[184:187], v[180:183], a[116:119]
  v_add_f32 v227, v227, v221
  v_cvt_pk_bf16_f32 v190, v220, v221
  v_mfma_f32_16x16x32_bf16 a[56:59], a[188:191], v[160:163], a[56:59]
  ds_read_b128 a[156:159], v3 offset:7168
  v_add_f32 v227, v227, v222
  v_mfma_f32_16x16x32_bf16 a[60:63], a[188:191], v[164:167], a[60:63]
  v_add_f32 v227, v227, v223
  v_cvt_pk_bf16_f32 v191, v222, v223
  v_mfma_f32_16x16x32_bf16 a[120:123], a[188:191], v[176:179], a[120:123]
  s_waitcnt lgkmcnt(4)
  v_max_f32 v5, v5, v227
  v_cmp_lt_f32 vcc, s81, v5
  v_mfma_f32_16x16x32_bf16 a[124:127], a[188:191], v[180:183], a[124:127]
  s_cbranch_vccnz fa_stub3
fa_back3:
  v_add_f32 v228, v228, v224
  v_add_f32 v229, v229, v225
  v_add_f32 v230, v230, v226
  v_add_f32 v231, v231, v227
  v_mfma_f32_16x16x32_bf16 v[144:147], a[128:131], v[64:67], v[200:203]
  ds_read_b128 a[160:163], v3 offset:24576
  v_cndmask_b32 v96, v4, v96, s[68:69]
  v_cndmask_b32 v97, v4, v97, s[70:71]
  v_mfma_f32_16x16x32_bf16 v[152:155], a[128:131], v[68:71], v[204:207]
  v_cndmask_b32 v98, v4, v98, s[72:73]
  v_cndmask_b32 v99, v4, v99, s[74:75]
  v_mov_b32 v100, v4
  v_mfma_f32_16x16x32_bf16 v[148:151], a[132:135], v[64:67], v[200:203]
  ds_read_b128 a[164:167], v3 offset:25600
  v_mov_b32 v101, v4
  v_mov_b32 v102, v4
  v_mfma_f32_16x16x32_bf16 v[156:159], a[132:135], v[68:71], v[204:207]
  v_mov_b32 v103, v4
  v_cndmask_b32 v108, v4, v108, s[68:69]
  v_cndmask_b32 v109, v4, v109, s[70:71]
  v_mfma_f32_16x16x32_bf16 v[144:147], a[136:139], v[72:75], v[144:147]
  ds_read_b128 a[168:171], v3 offset:26624
  v_cndmask_b32 v110, v4, v110, s[72:73]
  v_cndmask_b32 v111, v4, v111, s[74:75]
  v_mfma_f32_16x16x32_bf16 v[152:155], a[136:139], v[76:79], v[152:155]
  s_mov_b32 m0, s25
  v_exp_f32 v208, v96
  v_exp_f32 v209, v97
  v_mfma_f32_16x16x32_bf16 v[148:151], a[140:143], v[72:75], v[148:151]
  ds_read_b128 a[172:175], v3 offset:27648
  buffer_load_dwordx4 v2, s[48:51], s27 offen offset:0 sc1 lds
  v_mfma_f32_16x16x32_bf16 v[156:159], a[140:143], v[76:79], v[156:159]
  s_waitcnt lgkmcnt(4)
  v_exp_f32 v210, v98
  v_add_f32 v224, v208, v209
  v_mfma_f32_16x16x32_bf16 v[144:147], a[144:147], v[80:83], v[144:147]
  ds_read_b128 a[176:179], v3 offset:28672
  v_exp_f32 v211, v99
  v_mfma_f32_16x16x32_bf16 v[152:155], a[144:147], v[84:87], v[152:155]
  v_exp_f32 v212, v100
  v_cvt_pk_bf16_f32 v160, v208, v209
  v_mfma_f32_16x16x32_bf16 v[148:151], a[148:151], v[80:83], v[148:151]
  ds_read_b128 a[180:183], v3 offset:29696
  v_exp_f32 v213, v101
  v_mfma_f32_16x16x32_bf16 v[156:159], a[148:151], v[84:87], v[156:159]
  v_exp_f32 v214, v102
  v_add_f32 v224, v224, v210
  v_add_f32 v224, v224, v211
  v_mfma_f32_16x16x32_bf16 v[144:147], a[152:155], v[88:91], v[144:147]
  ds_read_b128 a[184:187], v3 offset:30720
  v_cvt_pk_bf16_f32 v161, v210, v211
  v_add_f32 v224, v224, v212
  v_mfma_f32_16x16x32_bf16 v[152:155], a[152:155], v[92:95], v[152:155]
  v_exp_f32 v215, v103
  v_add_f32 v224, v224, v213
  v_mfma_f32_16x16x32_bf16 v[148:151], a[156:159], v[88:91], v[148:151]
  ds_read_b128 a[188:191], v3 offset:31744
  v_cvt_pk_bf16_f32 v162, v212, v213
  v_add_f32 v224, v224, v214
  v_mfma_f32_16x16x32_bf16 v[156:159], a[156:159], v[92:95], v[156:159]
  s_waitcnt lgkmcnt(4)
  v_exp_f32 v208, v104
  v_add_f32 v224, v224, v215
  v_mfma_f32_16x16x32_bf16 a[0:3], a[160:163], v[168:171], a[0:3]
  ds_read_b128 a[128:131], v3 offset:8192
  v_cvt_pk_bf16_f32 v163, v214, v215
  v_exp_f32 v209, v105
  v_mfma_f32_16x16x32_bf16 a[4:7], a[160:163], v[172:175], a[4:7]
  v_exp_f32 v210, v106
  v_mfma_f32_16x16x32_bf16 a[64:67], a[160:163], v[184:187], a[64:67]
  buffer_load_dwordx4 v2, s[48:51], s27 offen offset:1024 sc1 lds
  v_exp_f32 v211, v107
  v_mfma_f32_16x16x32_bf16 a[68:71], a[160:163], v[188:191], a[68:71]
  v_exp_f32 v212, v108
  v_add_f32 v225, v208, v209
  v_mfma_f32_16x16x32_bf16 a[8:11], a[164:167], v[168:171], a[8:11]
  ds_read_b128 a[132:135], v3 offset:9216
  v_exp_f32 v213, v109
  v_mfma_f32_16x16x32_bf16 a[12:15], a[164:167], v[172:175], a[12:15]
  v_exp_f32 v214, v110
  v_cvt_pk_bf16_f32 v164, v208, v209
  v_mfma_f32_16x16x32_bf16 a[72:75], a[164:167], v[184:187], a[72:75]
  v_exp_f32 v215, v111
  v_add_f32 v225, v225, v210
  v_mfma_f32_16x16x32_bf16 a[76:79], a[164:167], v[188:191], a[76:79]
  v_exp_f32 v216, v128
  v_add_f32 v225, v225, v211
  v_mfma_f32_16x16x32_bf16 a[16:19], a[168:171], v[168:171], a[16:19]
  ds_read_b128 a[136:139], v3 offset:10240
  v_exp_f32 v217, v129
  v_mfma_f32_16x16x32_bf16 a[20:23], a[168:171], v[172:175], a[20:23]
  v_exp_f32 v218, v130
  v_cvt_pk_bf16_f32 v165, v210, v211
  v_mfma_f32_16x16x32_bf16 a[80:83], a[168:171], v[184:187], a[80:83]
  v_exp_f32 v219, v131
  v_add_f32 v225, v225, v212
  v_mfma_f32_16x16x32_bf16 a[84:87], a[168:171], v[188:191], a[84:87]
  v_exp_f32 v220, v132
  v_add_f32 v225, v225, v213
  v_mfma_f32_16x16x32_bf16 a[24:27], a[172:175], v[168:171], a[24:27]
  ds_read_b128 a[140:143], v3 offset:11264
  v_exp_f32 v221, v133
  v_mfma_f32_16x16x32_bf16 a[28:31], a[172:175], v[172:175], a[28:31]
  v_exp_f32 v222, v134
  v_cvt_pk_bf16_f32 v166, v212, v213
  v_mfma_f32_16x16x32_bf16 a[88:91], a[172:175], v[184:187], a[88:91]
  buffer_load_dwordx4 v2, s[48:51], s27 offen offset:2048 sc1 lds
  v_exp_f32 v223, v135
  v_mfma_f32_16x16x32_bf16 a[92:95], a[172:175], v[188:191], a[92:95]
  s_waitcnt lgkmcnt(4)
  v_add_f32 v225, v225, v214
  v_add_f32 v225, v225, v215
  v_cvt_pk_bf16_f32 v167, v214, v215
  v_mfma_f32_16x16x32_bf16 a[32:35], a[176:179], v[168:171], a[32:35]
  ds_read_b128 a[144:147], v3 offset:12288
  v_add_f32 v226, v216, v217
  v_cvt_pk_bf16_f32 v176, v216, v217
  v_mfma_f32_16x16x32_bf16 a[36:39], a[176:179], v[172:175], a[36:39]
  v_exp_f32 v216, v136
  v_add_f32 v226, v226, v218
  v_mfma_f32_16x16x32_bf16 a[96:99], a[176:179], v[184:187], a[96:99]
  v_exp_f32 v217, v137
  v_add_f32 v226, v226, v219
  v_mfma_f32_16x16x32_bf16 a[100:103], a[176:179], v[188:191], a[100:103]
  v_cvt_pk_bf16_f32 v177, v218, v219
  v_add_f32 v226, v226, v220
  v_add_f32 v226, v226, v221
  v_cvt_pk_bf16_f32 v178, v220, v221
  v_mfma_f32_16x16x32_bf16 a[40:43], a[180:183], v[168:171], a[40:43]
  ds_read_b128 a[148:151], v3 offset:13312
  v_add_f32 v226, v226, v222
  v_add_f32 v226, v226, v223
  v_mfma_f32_16x16x32_bf16 a[44:47], a[180:183], v[172:175], a[44:47]
  v_exp_f32 v218, v138
  v_cvt_pk_bf16_f32 v179, v222, v223
  v_mfma_f32_16x16x32_bf16 a[104:107], a[180:183], v[184:187], a[104:107]
  v_exp_f32 v219, v139
  v_add_f32 v227, v216, v217
  v_mfma_f32_16x16x32_bf16 a[108:111], a[180:183], v[188:191], a[108:111]
  v_exp_f32 v220, v140
  v_cvt_pk_bf16_f32 v180, v216, v217
  v_mfma_f32_16x16x32_bf16 a[48:51], a[184:187], v[168:171], a[48:51]
  ds_read_b128 a[152:155], v3 offset:14336
  v_add_f32 v227, v227, v218
  v_add_f32 v227, v227, v219
  v_mfma_f32_16x16x32_bf16 a[52:55], a[184:187], v[172:175], a[52:55]
  v_exp_f32 v221, v141
  v_cvt_pk_bf16_f32 v181, v218, v219
  v_mfma_f32_16x16x32_bf16 a[112:115], a[184:187], v[184:187], a[112:115]
  buffer_load_dwordx4 v2, s[48:51], s27 offen offset:3072 sc1 lds
  v_max3_f32 v5, v224, v225, v226
  v_add_f32 v227, v227, v220
  v_mfma_f32_16x16x32_bf16 a[116:119], a[184:187], v[188:191], a[116:119]
  s_add_u32 s27, s27, 16384
  v_exp_f32 v222, v142
  v_add_f32 v227, v227, v221
  v_mfma_f32_16x16x32_bf16 a[56:59], a[188:191], v[168:171], a[56:59]
  s_add_u32 s25, s25, 32768
  ds_read_b128 a[156:159], v3 offset:15360
  v_cvt_pk_bf16_f32 v182, v220, v221
  v_add_f32 v227, v227, v222
  v_mfma_f32_16x16x32_bf16 a[60:63], a[188:191], v[172:175], a[60:63]
  s_and_b32 s25, s25, 0x1ffff
  v_exp_f32 v223, v143
  v_mfma_f32_16x16x32_bf16 a[120:123], a[188:191], v[184:187], a[120:123]
  s_waitcnt lgkmcnt(4)
  v_add_f32 v227, v227, v223
  v_cvt_pk_bf16_f32 v183, v222, v223
  v_max_f32 v5, v5, v227
  v_cmp_lt_f32 vcc, s81, v5
  v_mfma_f32_16x16x32_bf16 a[124:127], a[188:191], v[188:191], a[124:127]
  s_cbranch_vccnz fa_stub4
fa_back4:
  v_add_f32 v228, v228, v224
  v_add_f32 v229, v229, v225
  v_add_f32 v230, v230, v226
  v_add_f32 v231, v231, v227
  v_add_u32 v3, 32768, v3
  v_and_b32 v3, 0x1ffff, v3
fa_AV:
  v_mfma_f32_16x16x32_bf16 v[128:131], a[128:131], v[64:67], v[200:203]
  s_waitcnt vmcnt(12)
  v_exp_f32 v216, v144
  v_mfma_f32_16x16x32_bf16 v[136:139], a[128:131], v[68:71], v[204:207]
  s_barrier
  v_exp_f32 v217, v145
  v_mfma_f32_16x16x32_bf16 v[132:135], a[132:135], v[64:67], v[200:203]
  ds_read_b128 a[160:163], v3 offset:16384
  ds_read_b128 a[164:167], v3 offset:17408
  v_mfma_f32_16x16x32_bf16 v[140:143], a[132:135], v[68:71], v[204:207]
  v_exp_f32 v218, v146
  v_mfma_f32_16x16x32_bf16 v[128:131], a[136:139], v[72:75], v[128:131]
  ds_read_b128 a[168:171], v3 offset:18432
  v_add_f32 v226, v216, v217
  v_mfma_f32_16x16x32_bf16 v[136:139], a[136:139], v[76:79], v[136:139]
  s_mov_b32 m0, s24
  v_exp_f32 v219, v147
  v_mfma_f32_16x16x32_bf16 v[132:135], a[140:143], v[72:75], v[132:135]
  ds_read_b128 a[172:175], v3 offset:19456
  buffer_load_dwordx4 v2, s[44:47], s26 offen offset:0 sc1 lds
  v_mfma_f32_16x16x32_bf16 v[140:143], a[140:143], v[76:79], v[140:143]
  s_waitcnt lgkmcnt(4)
  v_exp_f32 v220, v148
  v_mfma_f32_16x16x32_bf16 v[128:131], a[144:147], v[80:83], v[128:131]
  ds_read_b128 a[176:179], v3 offset:20480
  v_cvt_pk_bf16_f32 v184, v216, v217
  v_mfma_f32_16x16x32_bf16 v[136:139], a[144:147], v[84:87], v[136:139]
  v_exp_f32 v221, v149
  v_mfma_f32_16x16x32_bf16 v[132:135], a[148:151], v[80:83], v[132:135]
  ds_read_b128 a[180:183], v3 offset:21504
  v_add_f32 v226, v226, v218
  v_mfma_f32_16x16x32_bf16 v[140:143], a[148:151], v[84:87], v[140:143]
  v_exp_f32 v222, v150
  v_mfma_f32_16x16x32_bf16 v[128:131], a[152:155], v[88:91], v[128:131]
  ds_read_b128 a[184:187], v3 offset:22528
  v_add_f32 v226, v226, v219
  v_mfma_f32_16x16x32_bf16 v[136:139], a[152:155], v[92:95], v[136:139]
  v_exp_f32 v223, v151
  v_mfma_f32_16x16x32_bf16 v[132:135], a[156:159], v[88:91], v[132:135]
  ds_read_b128 a[188:191], v3 offset:23552
  v_cvt_pk_bf16_f32 v185, v218, v219
  v_mfma_f32_16x16x32_bf16 v[140:143], a[156:159], v[92:95], v[140:143]
  s_waitcnt lgkmcnt(4)
  v_exp_f32 v216, v152
  v_mfma_f32_16x16x32_bf16 a[0:3], a[160:163], v[160:163], a[0:3]
  ds_read_b128 a[128:131], v3 offset:0
  v_add_f32 v226, v226, v220
  v_mfma_f32_16x16x32_bf16 a[4:7], a[160:163], v[164:167], a[4:7]
  v_exp_f32 v217, v153
  v_mfma_f32_16x16x32_bf16 a[64:67], a[160:163], v[176:179], a[64:67]
  buffer_load_dwordx4 v2, s[44:47], s26 offen offset:1024 sc1 lds
  v_add_f32 v226, v226, v221
  v_mfma_f32_16x16x32_bf16 a[68:71], a[160:163], v[180:183], a[68:71]
  v_exp_f32 v218, v154
  v_mfma_f32_16x16x32_bf16 a[8:11], a[164:167], v[160:163], a[8:11]
  ds_read_b128 a[132:135], v3 offset:1024
  v_cvt_pk_bf16_f32 v186, v220, v221
  v_mfma_f32_16x16x32_bf16 a[12:15], a[164:167], v[164:167], a[12:15]
  v_exp_f32 v219, v155
  v_mfma_f32_16x16x32_bf16 a[72:75], a[164:167], v[176:179], a[72:75]
  v_exp_f32 v220, v156
  v_mfma_f32_16x16x32_bf16 a[76:79], a[164:167], v[180:183], a[76:79]
  v_add_f32 v226, v226, v222
  v_add_f32 v226, v226, v223
  v_mfma_f32_16x16x32_bf16 a[16:19], a[168:171], v[160:163], a[16:19]
  ds_read_b128 a[136:139], v3 offset:2048
  v_cvt_pk_bf16_f32 v187, v222, v223
  v_mfma_f32_16x16x32_bf16 a[20:23], a[168:171], v[164:167], a[20:23]
  v_exp_f32 v221, v157
  v_mfma_f32_16x16x32_bf16 a[80:83], a[168:171], v[176:179], a[80:83]
  v_exp_f32 v222, v158
  v_mfma_f32_16x16x32_bf16 a[84:87], a[168:171], v[180:183], a[84:87]
  v_exp_f32 v223, v159
  v_mfma_f32_16x16x32_bf16 a[24:27], a[172:175], v[160:163], a[24:27]
  ds_read_b128 a[140:143], v3 offset:3072
  v_add_f32 v227, v216, v217
  v_mfma_f32_16x16x32_bf16 a[28:31], a[172:175], v[164:167], a[28:31]
  v_cvt_pk_bf16_f32 v188, v216, v217
  v_add_f32 v227, v227, v218
  v_mfma_f32_16x16x32_bf16 a[88:91], a[172:175], v[176:179], a[88:91]
  buffer_load_dwordx4 v2, s[44:47], s26 offen offset:2048 sc1 lds
  v_add_f32 v227, v227, v219
  v_mfma_f32_16x16x32_bf16 a[92:95], a[172:175], v[180:183], a[92:95]
  s_waitcnt lgkmcnt(4)
  v_cvt_pk_bf16_f32 v189, v218, v219
  v_add_f32 v227, v227, v220
  v_mfma_f32_16x16x32_bf16 a[32:35], a[176:179], v[160:163], a[32:35]
  ds_read_b128 a[144:147], v3 offset:4096
  v_add_f32 v227, v227, v221
  v_mfma_f32_16x16x32_bf16 a[36:39], a[176:179], v[164:167], a[36:39]
  v_cvt_pk_bf16_f32 v190, v220, v221
  v_add_f32 v227, v227, v222
  v_mfma_f32_16x16x32_bf16 a[96:99], a[176:179], v[176:179], a[96:99]
  v_add_f32 v227, v227, v223
  v_cvt_pk_bf16_f32 v191, v222, v223
  v_mfma_f32_16x16x32_bf16 a[100:103], a[176:179], v[180:183], a[100:103]
  v_max_f32 v5, v226, v227
  v_cmp_lt_f32 vcc, s81, v5
  v_mfma_f32_16x16x32_bf16 a[40:43], a[180:183], v[160:163], a[40:43]
  ds_read_b128 a[148:151], v3 offset:5120
  v_mfma_f32_16x16x32_bf16 a[44:47], a[180:183], v[164:167], a[44:47]
  v_mfma_f32_16x16x32_bf16 a[104:107], a[180:183], v[176:179], a[104:107]
  v_mfma_f32_16x16x32_bf16 a[108:111], a[180:183], v[180:183], a[108:111]
  v_mfma_f32_16x16x32_bf16 a[48:51], a[184:187], v[160:163], a[48:51]
  ds_read_b128 a[152:155], v3 offset:6144
  v_mfma_f32_16x16x32_bf16 a[52:55], a[184:187], v[164:167], a[52:55]
  v_mfma_f32_16x16x32_bf16 a[112:115], a[184:187], v[176:179], a[112:115]
  buffer_load_dwordx4 v2, s[44:47], s26 offen offset:3072 sc1 lds
  v_mfma_f32_16x16x32_bf16 a[116:119], a[184:187], v[180:183], a[116:119]
  s_add_u32 s26, s26, 16384
  v_mfma_f32_16x16x32_bf16 a[56:59], a[188:191], v[160:163], a[56:59]
  s_add_u32 s24, s24, 32768
  ds_read_b128 a[156:159], v3 offset:7168
  v_mfma_f32_16x16x32_bf16 a[60:63], a[188:191], v[164:167], a[60:63]
  s_and_b32 s24, s24, 0x1ffff
  v_mfma_f32_16x16x32_bf16 a[120:123], a[188:191], v[176:179], a[120:123]
  s_waitcnt lgkmcnt(4)
  v_mfma_f32_16x16x32_bf16 a[124:127], a[188:191], v[180:183], a[124:127]
  s_cbranch_vccnz fa_stub5
fa_back5:
  v_add_f32 v230, v230, v226
  v_add_f32 v231, v231, v227
  v_mfma_f32_16x16x32_bf16 v[144:147], a[128:131], v[64:67], v[200:203]
  ds_read_b128 a[160:163], v3 offset:24576
  v_exp_f32 v216, v128
  v_mfma_f32_16x16x32_bf16 v[152:155], a[128:131], v[68:71], v[204:207]
  v_exp_f32 v217, v129
  v_mfma_f32_16x16x32_bf16 v[148:151], a[132:135], v[64:67], v[200:203]
  ds_read_b128 a[164:167], v3 offset:25600
  v_add_f32 v226, v216, v217
  v_mfma_f32_16x16x32_bf16 v[156:159], a[132:135], v[68:71], v[204:207]
  s_mov_b32 m0, s25
  v_exp_f32 v218, v130
  v_cvt_pk_bf16_f32 v176, v216, v217
  v_mfma_f32_16x16x32_bf16 v[144:147], a[136:139], v[72:75], v[144:147]
  ds_read_b128 a[168:171], v3 offset:26624
  buffer_load_dwordx4 v2, s[48:51], s27 offen offset:0 sc1 lds
  v_mfma_f32_16x16x32_bf16 v[152:155], a[136:139], v[76:79], v[152:155]
  v_exp_f32 v219, v131
  v_add_f32 v226, v226, v218
  v_mfma_f32_16x16x32_bf16 v[148:151], a[140:143], v[72:75], v[148:151]
  ds_read_b128 a[172:175], v3 offset:27648
  v_add_f32 v226, v226, v219
  v_mfma_f32_16x16x32_bf16 v[156:159], a[140:143], v[76:79], v[156:159]
  s_waitcnt lgkmcnt(4)
  v_exp_f32 v220, v132
  v_cvt_pk_bf16_f32 v177, v218, v219
  v_mfma_f32_16x16x32_bf16 v[144:147], a[144:147], v[80:83], v[144:147]
  ds_read_b128 a[176:179], v3 offset:28672
  v_add_f32 v226, v226, v220
  v_mfma_f32_16x16x32_bf16 v[152:155], a[144:147], v[84:87], v[152:155]
  v_exp_f32 v221, v133
  v_exp_f32 v222, v134
  v_mfma_f32_16x16x32_bf16 v[148:151], a[148:151], v[80:83], v[148:151]
  ds_read_b128 a[180:183], v3 offset:29696
  buffer_load_dwordx4 v2, s[48:51], s27 offen offset:1024 sc1 lds
  v_mfma_f32_16x16x32_bf16 v[156:159], a[148:151], v[84:87], v[156:159]
  v_exp_f32 v223, v135
  v_mfma_f32_16x16x32_bf16 v[144:147], a[152:155], v[88:91], v[144:147]
  ds_read_b128 a[184:187], v3 offset:30720
  v_add_f32 v226, v226, v221
  v_mfma_f32_16x16x32_bf16 v[152:155], a[152:155], v[92:95], v[152:155]
  v_exp_f32 v216, v136
  v_mfma_f32_16x16x32_bf16 v[148:151], a[156:159], v[88:91], v[148:151]
  ds_read_b128 a[188:191], v3 offset:31744
  v_cvt_pk_bf16_f32 v178, v220, v221
  v_add_f32 v226, v226, v222
  v_mfma_f32_16x16x32_bf16 v[156:159], a[156:159], v[92:95], v[156:159]
  s_waitcnt lgkmcnt(4)
  v_exp_f32 v217, v137
  v_mfma_f32_16x16x32_bf16 a[64:67], a[160:163], v[184:187], a[64:67]
  ds_read_b128 a[128:131], v3 offset:8192
  v_add_f32 v226, v226, v223
  v_cvt_pk_bf16_f32 v179, v222, v223
  v_mfma_f32_16x16x32_bf16 a[68:71], a[160:163], v[188:191], a[68:71]
  v_exp_f32 v218, v138
  v_mfma_f32_16x16x32_bf16 a[72:75], a[164:167], v[184:187], a[72:75]
  ds_read_b128 a[132:135], v3 offset:9216
  buffer_load_dwordx4 v2, s[48:51], s27 offen offset:2048 sc1 lds
  v_add_f32 v227, v216, v217
  v_mfma_f32_16x16x32_bf16 a[76:79], a[164:167], v[188:191], a[76:79]
  v_exp_f32 v219, v139
  v_mfma_f32_16x16x32_bf16 a[80:83], a[168:171], v[184:187], a[80:83]
  ds_read_b128 a[136:139], v3 offset:10240
  v_cvt_pk_bf16_f32 v180, v216, v217
  v_mfma_f32_16x16x32_bf16 a[84:87], a[168:171], v[188:191], a[84:87]
  v_exp_f32 v220, v140
  v_add_f32 v227, v227, v218
  v_mfma_f32_16x16x32_bf16 a[88:91], a[172:175], v[184:187], a[88:91]
  ds_read_b128 a[140:143], v3 offset:11264
  v_add_f32 v227, v227, v219
  v_mfma_f32_16x16x32_bf16 a[92:95], a[172:175], v[188:191], a[92:95]
  s_waitcnt lgkmcnt(4)
  v_exp_f32 v221, v141
  v_cvt_pk_bf16_f32 v181, v218, v219
  v_mfma_f32_16x16x32_bf16 a[96:99], a[176:179], v[184:187], a[96:99]
  ds_read_b128 a[144:147], v3 offset:12288
  buffer_load_dwordx4 v2, s[48:51], s27 offen offset:3072 sc1 lds
  v_mfma_f32_16x16x32_bf16 a[100:103], a[176:179], v[188:191], a[100:103]
  s_add_u32 s27, s27, 16384
  v_exp_f32 v222, v142
  v_add_f32 v227, v227, v220
  v_mfma_f32_16x16x32_bf16 a[104:107], a[180:183], v[184:187], a[104:107]
  s_add_u32 s25, s25, 32768
  ds_read_b128 a[148:151], v3 offset:13312
  v_add_f32 v227, v227, v221
  v_mfma_f32_16x16x32_bf16 a[108:111], a[180:183], v[188:191], a[108:111]
  s_and_b32 s25, s25, 0x1ffff
  v_exp_f32 v223, v143
  v_cvt_pk_bf16_f32 v182, v220, v221
  v_mfma_f32_16x16x32_bf16 a[112:115], a[184:187], v[184:187], a[112:115]
  ds_read_b128 a[152:155], v3 offset:14336
  v_add_f32 v227, v227, v222
  v_mfma_f32_16x16x32_bf16 a[116:119], a[184:187], v[188:191], a[116:119]
  v_add_f32 v227, v227, v223
  v_cvt_pk_bf16_f32 v183, v222, v223
  v_max_f32 v5, v226, v227
  v_mfma_f32_16x16x32_bf16 a[120:123], a[188:191], v[184:187], a[120:123]
  s_waitcnt lgkmcnt(3)
  ds_read_b128 a[156:159], v3 offset:15360
  v_cmp_lt_f32 vcc, s81, v5
  v_mfma_f32_16x16x32_bf16 a[124:127], a[188:191], v[188:191], a[124:127]
  s_cbranch_vccnz fa_stub6
fa_back6:
  v_add_f32 v230, v230, v226
  v_add_f32 v231, v231, v227
  v_add_u32 v3, 32768, v3
  v_and_b32 v3, 0x1ffff, v3
  s_branch fa_SSpre
fa_Aodd:
  v_mfma_f32_16x16x32_bf16 v[128:131], a[128:131], v[64:67], v[200:203]
  s_waitcnt vmcnt(12)
  v_cndmask_b32 v112, v4, v112, s[68:69]
  v_cndmask_b32 v113, v4, v113, s[70:71]
  v_cndmask_b32 v114, v4, v114, s[72:73]
  v_mfma_f32_16x16x32_bf16 v[136:139], a[128:131], v[68:71], v[204:207]
  s_barrier
  v_cndmask_b32 v115, v4, v115, s[74:75]
  v_mov_b32 v116, v4
  v_mov_b32 v117, v4
  v_mfma_f32_16x16x32_bf16 v[132:135], a[132:135], v[64:67], v[200:203]
  ds_read_b128 a[160:163], v3 offset:16384
  ds_read_b128 a[164:167], v3 offset:17408
  v_mov_b32 v118, v4
  v_mfma_f32_16x16x32_bf16 v[140:143], a[132:135], v[68:71], v[204:207]
  v_mov_b32 v119, v4
  v_cndmask_b32 v124, v4, v124, s[68:69]
  v_cndmask_b32 v125, v4, v125, s[70:71]
  v_mfma_f32_16x16x32_bf16 v[128:131], a[136:139], v[72:75], v[128:131]
  ds_read_b128 a[168:171], v3 offset:18432
  v_cndmask_b32 v126, v4, v126, s[72:73]
  v_cndmask_b32 v127, v4, v127, s[74:75]
  v_mfma_f32_16x16x32_bf16 v[136:139], a[136:139], v[76:79], v[136:139]
  s_mov_b32 m0, s24
  v_exp_f32 v208, v112
  v_exp_f32 v209, v113
  v_mfma_f32_16x16x32_bf16 v[132:135], a[140:143], v[72:75], v[132:135]
  ds_read_b128 a[172:175], v3 offset:19456
  buffer_load_dwordx4 v2, s[44:47], s26 offen offset:0 sc1 lds
  v_mfma_f32_16x16x32_bf16 v[140:143], a[140:143], v[76:79], v[140:143]
  s_waitcnt lgkmcnt(4)
  v_exp_f32 v210, v114
  v_add_f32 v224, v208, v209
  v_mfma_f32_16x16x32_bf16 v[128:131], a[144:147], v[80:83], v[128:131]
  ds_read_b128 a[176:179], v3 offset:20480
  v_exp_f32 v211, v115
  v_mfma_f32_16x16x32_bf16 v[136:139], a[144:147], v[84:87], v[136:139]
  v_exp_f32 v212, v116
  v_cvt_pk_bf16_f32 v168, v208, v209
  v_mfma_f32_16x16x32_bf16 v[132:135], a[148:151], v[80:83], v[132:135]
  ds_read_b128 a[180:183], v3 offset:21504
  v_exp_f32 v213, v117
  v_mfma_f32_16x16x32_bf16 v[140:143], a[148:151], v[84:87], v[140:143]
  v_exp_f32 v214, v118
  v_add_f32 v224, v224, v210
  v_add_f32 v224, v224, v211
  v_mfma_f32_16x16x32_bf16 v[128:131], a[152:155], v[88:91], v[128:131]
  ds_read_b128 a[184:187], v3 offset:22528
  v_cvt_pk_bf16_f32 v169, v210, v211
  v_add_f32 v224, v224, v212
  v_mfma_f32_16x16x32_bf16 v[136:139], a[152:155], v[92:95], v[136:139]
  v_exp_f32 v215, v119
  v_add_f32 v224, v224, v213
  v_mfma_f32_16x16x32_bf16 v[132:135], a[156:159], v[88:91], v[132:135]
  ds_read_b128 a[188:191], v3 offset:23552
  v_cvt_pk_bf16_f32 v170, v212, v213
  v_add_f32 v224, v224, v214
  v_mfma_f32_16x16x32_bf16 v[140:143], a[156:159], v[92:95], v[140:143]
  s_waitcnt lgkmcnt(4)
  v_exp_f32 v208, v120
  v_add_f32 v224, v224, v215
  v_mfma_f32_16x16x32_bf16 a[0:3], a[160:163], v[160:163], a[0:3]
  ds_read_b128 a[128:131], v3 offset:0
  v_cvt_pk_bf16_f32 v171, v214, v215
  v_exp_f32 v209, v121
  v_mfma_f32_16x16x32_bf16 a[4:7], a[160:163], v[164:167], a[4:7]
  v_exp_f32 v210, v122
  v_mfma_f32_16x16x32_bf16 a[64:67], a[160:163], v[176:179], a[64:67]
  buffer_load_dwordx4 v2, s[44:47], s26 offen offset:1024 sc1 lds
  v_exp_f32 v211, v123
  v_mfma_f32_16x16x32_bf16 a[68:71], a[160:163], v[180:183], a[68:71]
  v_exp_f32 v212, v124
  v_add_f32 v225, v208, v209
  v_mfma_f32_16x16x32_bf16 a[8:11], a[164:167], v[160:163], a[8:11]
  ds_read_b128 a[132:135], v3 offset:1024
  v_exp_f32 v213, v125
  v_mfma_f32_16x16x32_bf16 a[12:15], a[164:167], v[164:167], a[12:15]
  v_exp_f32 v214, v126
  v_cvt_pk_bf16_f32 v172, v208, v209
  v_mfma_f32_16x16x32_bf16 a[72:75], a[164:167], v[176:179], a[72:75]
  v_exp_f32 v215, v127
  v_add_f32 v225, v225, v210
  v_mfma_f32_16x16x32_bf16 a[76:79], a[164:167], v[180:183], a[76:79]
  v_exp_f32 v216, v144
  v_add_f32 v225, v225, v211
  v_mfma_f32_16x16x32_bf16 a[16:19], a[168:171], v[160:163], a[16:19]
  ds_read_b128 a[136:139], v3 offset:2048
  v_exp_f32 v217, v145
  v_mfma_f32_16x16x32_bf16 a[20:23], a[168:171], v[164:167], a[20:23]
  v_exp_f32 v218, v146
  v_cvt_pk_bf16_f32 v173, v210, v211
  v_mfma_f32_16x16x32_bf16 a[80:83], a[168:171], v[176:179], a[80:83]
  v_exp_f32 v219, v147
  v_add_f32 v225, v225, v212
  v_mfma_f32_16x16x32_bf16 a[84:87], a[168:171], v[180:183], a[84:87]
  v_exp_f32 v220, v148
  v_add_f32 v225, v225, v213
  v_mfma_f32_16x16x32_bf16 a[24:27], a[172:175], v[160:163], a[24:27]
  ds_read_b128 a[140:143], v3 offset:3072
  v_exp_f32 v221, v149
  v_mfma_f32_16x16x32_bf16 a[28:31], a[172:175], v[164:167], a[28:31]
  v_exp_f32 v222, v150
  v_cvt_pk_bf16_f32 v174, v212, v213
  v_mfma_f32_16x16x32_bf16 a[88:91], a[172:175], v[176:179], a[88:91]
  buffer_load_dwordx4 v2, s[44:47], s26 offen offset:2048 sc1 lds
  v_exp_f32 v223, v151
  v_mfma_f32_16x16x32_bf16 a[92:95], a[172:175], v[180:183], a[92:95]
  s_waitcnt lgkmcnt(4)
  v_add_f32 v225, v225, v214
  v_add_f32 v225, v225, v215
  v_cvt_pk_bf16_f32 v175, v214, v215
  v_mfma_f32_16x16x32_bf16 a[32:35], a[176:179], v[160:163], a[32:35]
  ds_read_b128 a[144:147], v3 offset:4096
  v_add_f32 v226, v216, v217
  v_cvt_pk_bf16_f32 v184, v216, v217
  v_mfma_f32_16x16x32_bf16 a[36:39], a[176:179], v[164:167], a[36:39]
  v_exp_f32 v216, v152
  v_add_f32 v226, v226, v218
  v_mfma_f32_16x16x32_bf16 a[96:99], a[176:179], v[176:179], a[96:99]
  v_exp_f32 v217, v153
  v_add_f32 v226, v226, v219
  v_mfma_f32_16x16x32_bf16 a[100:103], a[176:179], v[180:183], a[100:103]
  v_cvt_pk_bf16_f32 v185, v218, v219
  v_add_f32 v226, v226, v220
  v_add_f32 v226, v226, v221
  v_cvt_pk_bf16_f32 v186, v220, v221
  v_mfma_f32_16x16x32_bf16 a[40:43], a[180:183], v[160:163], a[40:43]
  ds_read_b128 a[148:151], v3 offset:5120
  v_add_f32 v226, v226, v222
  v_add_f32 v226, v226, v223
  v_mfma_f32_16x16x32_bf16 a[44:47], a[180:183], v[164:167], a[44:47]
  v_exp_f32 v218, v154
  v_cvt_pk_bf16_f32 v187, v222, v223
  v_mfma_f32_16x16x32_bf16 a[104:107], a[180:183], v[176:179], a[104:107]
  v_exp_f32 v219, v155
  v_add_f32 v227, v216, v217
  v_mfma_f32_16x16x32_bf16 a[108:111], a[180:183], v[180:183], a[108:111]
  v_exp_f32 v220, v156
  v_cvt_pk_bf16_f32 v188, v216, v217
  v_mfma_f32_16x16x32_bf16 a[48:51], a[184:187], v[160:163], a[48:51]
  ds_read_b128 a[152:155], v3 offset:6144
  v_add_f32 v227, v227, v218
  v_add_f32 v227, v227, v219
  v_mfma_f32_16x16x32_bf16 a[52:55], a[184:187], v[164:167], a[52:55]
  v_exp_f32 v221, v157
  v_cvt_pk_bf16_f32 v189, v218, v219
  v_mfma_f32_16x16x32_bf16 a[112:115], a[184:187], v[176:179], a[112:115]
  buffer_load_dwordx4 v2, s[44:47], s26 offen offset:3072 sc1 lds
  v_max3_f32 v5, v224, v225, v226
  v_add_f32 v227, v227, v220
  v_mfma_f32_16x16x32_bf16 a[116:119], a[184:187], v[180:183], a[116:119]
  s_add_u32 s26, s26, 16384
  v_exp_f32 v222, v158
  v_add_f32 v227, v227, v221
  v_mfma_f32_16x16x32_bf16 a[56:59], a[188:191], v[160:163], a[56:59]
  s_add_u32 s24, s24, 32768
  ds_read_b128 a[156:159], v3 offset:7168
  v_cvt_pk_bf16_f32 v190, v220, v221
  v_add_f32 v227, v227, v222
  v_mfma_f32_16x16x32_bf16 a[60:63], a[188:191], v[164:167], a[60:63]
  s_and_b32 s24, s24, 0x1ffff
  v_exp_f32 v223, v159
  v_mfma_f32_16x16x32_bf16 a[120:123], a[188:191], v[176:179], a[120:123]
  s_waitcnt lgkmcnt(4)
  v_add_f32 v227, v227, v223
  v_cvt_pk_bf16_f32 v191, v222, v223
  v_max_f32 v5, v5, v227
  v_cmp_lt_f32 vcc, s81, v5
  v_mfma_f32_16x16x32_bf16 a[124:127], a[188:191], v[180:183], a[124:127]
  s_cbranch_vccnz fa_stub7
fa_back7:
  v_add_f32 v228, v228, v224
  v_add_f32 v229, v229, v225
  v_add_f32 v230, v230, v226
  v_add_f32 v231, v231, v227
  v_mfma_f32_16x16x32_bf16 v[144:147], a[128:131], v[64:67], v[200:203]
  ds_read_b128 a[160:163], v3 offset:24576
  v_exp_f32 v216, v128
  v_mfma_f32_16x16x32_bf16 v[152:155], a[128:131], v[68:71], v[204:207]
  v_exp_f32 v217, v129
  v_mfma_f32_16x16x32_bf16 v[148:151], a[132:135], v[64:67], v[200:203]
  ds_read_b128 a[164:167], v3 offset:25600
  v_mfma_f32_16x16x32_bf16 v[156:159], a[132:135], v[68:71], v[204:207]
  v_exp_f32 v218, v130
  v_mfma_f32_16x16x32_bf16 v[144:147], a[136:139], v[72:75], v[144:147]
  ds_read_b128 a[168:171], v3 offset:26624
  v_add_f32 v226, v216, v217
  v_mfma_f32_16x16x32_bf16 v[152:155], a[136:139], v[76:79], v[152:155]
  s_mov_b32 m0, s25
  v_exp_f32 v219, v131
  v_mfma_f32_16x16x32_bf16 v[148:151], a[140:143], v[72:75], v[148:151]
  ds_read_b128 a[172:175], v3 offset:27648
  buffer_load_dwordx4 v2, s[48:51], s27 offen offset:0 sc1 lds
  v_mfma_f32_16x16x32_bf16 v[156:159], a[140:143], v[76:79], v[156:159]
  s_waitcnt lgkmcnt(4)
  v_exp_f32 v220, v132
  v_mfma_f32_16x16x32_bf16 v[144:147], a[144:147], v[80:83], v[144:147]
  ds_read_b128 a[176:179], v3 offset:28672
  v_cvt_pk_bf16_f32 v176, v216, v217
  v_mfma_f32_16x16x32_bf16 v[152:155], a[144:147], v[84:87], v[152:155]
  v_exp_f32 v221, v133
  v_mfma_f32_16x16x32_bf16 v[148:151], a[148:151], v[80:83], v[148:151]
  ds_read_b128 a[180:183], v3 offset:29696
  v_add_f32 v226, v226, v218
  v_mfma_f32_16x16x32_bf16 v[156:159], a[148:151], v[84:87], v[156:159]
  v_exp_f32 v222, v134
  v_mfma_f32_16x16x32_bf16 v[144:147], a[152:155], v[88:91], v[144:147]
  ds_read_b128 a[184:187], v3 offset:30720
  v_add_f32 v226, v226, v219
  v_mfma_f32_16x16x32_bf16 v[152:155], a[152:155], v[92:95], v[152:155]
  v_exp_f32 v223, v135
  v_mfma_f32_16x16x32_bf16 v[148:151], a[156:159], v[88:91], v[148:151]
  ds_read_b128 a[188:191], v3 offset:31744
  v_cvt_pk_bf16_f32 v177, v218, v219
  v_mfma_f32_16x16x32_bf16 v[156:159], a[156:159], v[92:95], v[156:159]
  s_waitcnt lgkmcnt(4)
  v_exp_f32 v216, v136
  v_mfma_f32_16x16x32_bf16 a[0:3], a[160:163], v[168:171], a[0:3]
  ds_read_b128 a[128:131], v3 offset:8192
  v_add_f32 v226, v226, v220
  v_mfma_f32_16x16x32_bf16 a[4:7], a[160:163], v[172:175], a[4:7]
  v_exp_f32 v217, v137
  v_mfma_f32_16x16x32_bf16 a[64:67], a[160:163], v[184:187], a[64:67]
  buffer_load_dwordx4 v2, s[48:51], s27 offen offset:1024 sc1 lds
  v_add_f32 v226, v226, v221
  v_mfma_f32_16x16x32_bf16 a[68:71], a[160:163], v[188:191], a[68:71]
  v_exp_f32 v218, v138
  v_mfma_f32_16x16x32_bf16 a[8:11], a[164:167], v[168:171], a[8:11]
  ds_read_b128 a[132:135], v3 offset:9216
  v_cvt_pk_bf16_f32 v178, v220, v221
  v_mfma_f32_16x16x32_bf16 a[12:15], a[164:167], v[172:175], a[12:15]
  v_exp_f32 v219, v139
  v_mfma_f32_16x16x32_bf16 a[72:75], a[164:167], v[184:187], a[72:75]
  v_exp_f32 v220, v140
  v_mfma_f32_16x16x32_bf16 a[76:79], a[164:167], v[188:191], a[76:79]
  v_add_f32 v226, v226, v222
  v_add_f32 v226, v226, v223
  v_mfma_f32_16x16x32_bf16 a[16:19], a[168:171], v[168:171], a[16:19]
  ds_read_b128 a[136:139], v3 offset:10240
  v_cvt_pk_bf16_f32 v179, v222, v223
  v_mfma_f32_16x16x32_bf16 a[20:23], a[168:171], v[172:175], a[20:23]
  v_exp_f32 v221, v141
  v_mfma_f32_16x16x32_bf16 a[80:83], a[168:171], v[184:187], a[80:83]
  v_exp_f32 v222, v142
  v_mfma_f32_16x16x32_bf16 a[84:87], a[168:171], v[188:191], a[84:87]
  v_exp_f32 v223, v143
  v_mfma_f32_16x16x32_bf16 a[24:27], a[172:175], v[168:171], a[24:27]
  ds_read_b128 a[140:143], v3 offset:11264
  v_add_f32 v227, v216, v217
  v_mfma_f32_16x16x32_bf16 a[28:31], a[172:175], v[172:175], a[28:31]
  v_cvt_pk_bf16_f32 v180, v216, v217
  v_add_f32 v227, v227, v218
  v_mfma_f32_16x16x32_bf16 a[88:91], a[172:175], v[184:187], a[88:91]
  buffer_load_dwordx4 v2, s[48:51], s27 offen offset:2048 sc1 lds
  v_add_f32 v227, v227, v219
  v_mfma_f32_16x16x32_bf16 a[92:95], a[172:175], v[188:191], a[92:95]
  s_waitcnt lgkmcnt(4)
  v_cvt_pk_bf16_f32 v181, v218, v219
  v_add_f32 v227, v227, v220
  v_mfma_f32_16x16x32_bf16 a[32:35], a[176:179], v[168:171], a[32:35]
  ds_read_b128 a[144:147], v3 offset:12288
  v_add_f32 v227, v227, v221
  v_mfma_f32_16x16x32_bf16 a[36:39], a[176:179], v[172:175], a[36:39]
  v_cvt_pk_bf16_f32 v182, v220, v221
  v_add_f32 v227, v227, v222
  v_mfma_f32_16x16x32_bf16 a[96:99], a[176:179], v[184:187], a[96:99]
  v_add_f32 v227, v227, v223
  v_cvt_pk_bf16_f32 v183, v222, v223
  v_mfma_f32_16x16x32_bf16 a[100:103], a[176:179], v[188:191], a[100:103]
  v_max_f32 v5, v226, v227
  v_cmp_lt_f32 vcc, s81, v5
  v_mfma_f32_16x16x32_bf16 a[40:43], a[180:183], v[168:171], a[40:43]
  ds_read_b128 a[148:151], v3 offset:13312
  v_mfma_f32_16x16x32_bf16 a[44:47], a[180:183], v[172:175], a[44:47]
  v_mfma_f32_16x16x32_bf16 a[104:107], a[180:183], v[184:187], a[104:107]
  v_mfma_f32_16x16x32_bf16 a[108:111], a[180:183], v[188:191], a[108:111]
  v_mfma_f32_16x16x32_bf16 a[48:51], a[184:187], v[168:171], a[48:51]
  ds_read_b128 a[152:155], v3 offset:14336
  v_mfma_f32_16x16x32_bf16 a[52:55], a[184:187], v[172:175], a[52:55]
  v_mfma_f32_16x16x32_bf16 a[112:115], a[184:187], v[184:187], a[112:115]
  buffer_load_dwordx4 v2, s[48:51], s27 offen offset:3072 sc1 lds
  v_mfma_f32_16x16x32_bf16 a[116:119], a[184:187], v[188:191], a[116:119]
  s_add_u32 s27, s27, 16384
  v_mfma_f32_16x16x32_bf16 a[56:59], a[188:191], v[168:171], a[56:59]
  s_add_u32 s25, s25, 32768
  ds_read_b128 a[156:159], v3 offset:15360
  v_mfma_f32_16x16x32_bf16 a[60:63], a[188:191], v[172:175], a[60:63]
  s_and_b32 s25, s25, 0x1ffff
  v_mfma_f32_16x16x32_bf16 a[120:123], a[188:191], v[184:187], a[120:123]
  s_waitcnt lgkmcnt(4)
  v_mfma_f32_16x16x32_bf16 a[124:127], a[188:191], v[188:191], a[124:127]
  s_cbranch_vccnz fa_stub8
fa_back8:
  v_add_f32 v230, v230, v226
  v_add_f32 v231, v231, v227
  v_add_u32 v3, 32768, v3
  v_and_b32 v3, 0x1ffff, v3
fa_SSpre:
  v_mov_b32 v16, 1073741824
  v_mov_b32 v17, 1
  v_writelane_b32 v16, s37, 0
  s_waitcnt vmcnt(8)
  buffer_store_dword v17, v16, s[40:43], 0 offen sc1
  s_mov_b32 s37, 1073741824
  s_cmp_eq_u32 s29, 0
  s_cbranch_scc1 fa_Bexit
.p2align 6
fa_SS:
  v_mfma_f32_16x16x32_bf16 v[128:131], a[128:131], v[64:67], v[200:203]
  s_waitcnt vmcnt(12)
  v_exp_f32 v216, v144
  v_mfma_f32_16x16x32_bf16 v[136:139], a[128:131], v[68:71], v[204:207]
  s_barrier
  v_exp_f32 v217, v145
  v_exp_f32 v218, v146
  v_mfma_f32_16x16x32_bf16 v[132:135], a[132:135], v[64:67], v[200:203]
  ds_read_b128 a[160:163], v3 offset:16384
  ds_read_b128 a[164:167], v3 offset:17408
  v_mfma_f32_16x16x32_bf16 v[140:143], a[132:135], v[68:71], v[204:207]
  s_mov_b32 m0, s24
  v_exp_f32 v219, v147
  v_mfma_f32_16x16x32_bf16 v[128:131], a[136:139], v[72:75], v[128:131]
  ds_read_b128 a[168:171], v3 offset:18432
  buffer_load_dwordx4 v2, s[44:47], s26 offen offset:0 sc1 lds
  v_mfma_f32_16x16x32_bf16 v[136:139], a[136:139], v[76:79], v[136:139]
  v_exp_f32 v220, v148
  v_add_f32 v226, v216, v217
  v_mfma_f32_16x16x32_bf16 v[132:135], a[140:143], v[72:75], v[132:135]
  ds_read_b128 a[172:175], v3 offset:19456
  v_cvt_pk_bf16_f32 v184, v216, v217
  v_mfma_f32_16x16x32_bf16 v[140:143], a[140:143], v[76:79], v[140:143]
  s_waitcnt lgkmcnt(4)
  v_exp_f32 v221, v149
  v_add_f32 v226, v226, v218
  v_mfma_f32_16x16x32_bf16 v[128:131], a[144:147], v[80:83], v[128:131]
  ds_read_b128 a[176:179], v3 offset:20480
  v_add_f32 v226, v226, v219
  v_mfma_f32_16x16x32_bf16 v[136:139], a[144:147], v[84:87], v[136:139]
  v_exp_f32 v222, v150
  v_cvt_pk_bf16_f32 v185, v218, v219
  v_mfma_f32_16x16x32_bf16 v[132:135], a[148:151], v[80:83], v[132:135]
  ds_read_b128 a[180:183], v3 offset:21504
  buffer_load_dwordx4 v2, s[44:47], s26 offen offset:1024 sc1 lds
  v_mfma_f32_16x16x32_bf16 v[140:143], a[148:151], v[84:87], v[140:143]
  v_exp_f32 v223, v151
  v_mfma_f32_16x16x32_bf16 v[128:131], a[152:155], v[88:91], v[128:131]
  ds_read_b128 a[184:187], v3 offset:22528
  v_add_f32 v226, v226, v220
  v_add_f32 v226, v226, v221
  v_mfma_f32_16x16x32_bf16 v[136:139], a[152:155], v[92:95], v[136:139]
  v_exp_f32 v216, v152
  v_mfma_f32_16x16x32_bf16 v[132:135], a[156:159], v[88:91], v[132:135]
  ds_read_b128 a[188:191], v3 offset:23552
  v_cvt_pk_bf16_f32 v186, v220, v221
  v_add_f32 v226, v226, v222
  v_mfma_f32_16x16x32_bf16 v[140:143], a[156:159], v[92:95], v[140:143]
  s_waitcnt lgkmcnt(4)
  v_exp_f32 v217, v153
  v_mfma_f32_16x16x32_bf16 a[64:67], a[160:163], v[176:179], a[64:67]
  ds_read_b128 a[128:131], v3 offset:0
  v_add_f32 v226, v226, v223
  v_cvt_pk_bf16_f32 v187, v222, v223
  v_mfma_f32_16x16x32_bf16 a[68:71], a[160:163], v[180:183], a[68:71]
  v_exp_f32 v218, v154
  v_mfma_f32_16x16x32_bf16 a[72:75], a[164:167], v[176:179], a[72:75]
  ds_read_b128 a[132:135], v3 offset:1024
  buffer_load_dwordx4 v2, s[44:47], s26 offen offset:2048 sc1 lds
  v_add_f32 v227, v216, v217
  v_mfma_f32_16x16x32_bf16 a[76:79], a[164:167], v[180:183], a[76:79]
  v_exp_f32 v219, v155
  v_mfma_f32_16x16x32_bf16 a[80:83], a[168:171], v[176:179], a[80:83]
  ds_read_b128 a[136:139], v3 offset:2048
  v_cvt_pk_bf16_f32 v188, v216, v217
  v_mfma_f32_16x16x32_bf16 a[84:87], a[168:171], v[180:183], a[84:87]
  v_exp_f32 v220, v156
  v_add_f32 v227, v227, v218
  v_mfma_f32_16x16x32_bf16 a[88:91], a[172:175], v[176:179], a[88:91]
  ds_read_b128 a[140:143], v3 offset:3072
  v_add_f32 v227, v227, v219
  v_mfma_f32_16x16x32_bf16 a[92:95], a[172:175], v[180:183], a[92:95]
  s_waitcnt lgkmcnt(4)
  v_exp_f32 v221, v157
  v_cvt_pk_bf16_f32 v189, v218, v219
  v_mfma_f32_16x16x32_bf16 a[96:99], a[176:179], v[176:179], a[96:99]
  ds_read_b128 a[144:147], v3 offset:4096
  buffer_load_dwordx4 v2, s[44:47], s26 offen offset:3072 sc1 lds
  v_mfma_f32_16x16x32_bf16 a[100:103], a[176:179], v[180:183], a[100:103]
  s_add_u32 s26, s26, 16384
  v_exp_f32 v222, v158
  v_add_f32 v227, v227, v220
  v_mfma_f32_16x16x32_bf16 a[104:107], a[180:183], v[176:179], a[104:107]
  s_add_u32 s24, s24, 32768
  ds_read_b128 a[148:151], v3 offset:5120
  v_add_f32 v227, v227, v221
  v_mfma_f32_16x16x32_bf16 a[108:111], a[180:183], v[180:183], a[108:111]
  s_and_b32 s24, s24, 0x1ffff
  v_exp_f32 v223, v159
  v_cvt_pk_bf16_f32 v190, v220, v221
  v_mfma_f32_16x16x32_bf16 a[112:115], a[184:187], v[176:179], a[112:115]
  ds_read_b128 a[152:155], v3 offset:6144
  v_add_f32 v227, v227, v222
  v_mfma_f32_16x16x32_bf16 a[116:119], a[184:187], v[180:183], a[116:119]
  v_add_f32 v227, v227, v223
  v_cvt_pk_bf16_f32 v191, v222, v223
  v_max_f32 v5, v226, v227
  v_mfma_f32_16x16x32_bf16 a[120:123], a[188:191], v[176:179], a[120:123]
  s_waitcnt lgkmcnt(3)
  ds_read_b128 a[156:159], v3 offset:7168
  v_cmp_lt_f32 vcc, s81, v5
  v_mfma_f32_16x16x32_bf16 a[124:127], a[188:191], v[180:183], a[124:127]
  s_cbranch_vccnz fa_stub9
fa_back9:
  v_add_f32 v230, v230, v226
  v_add_f32 v231, v231, v227
  v_mfma_f32_16x16x32_bf16 v[144:147], a[128:131], v[64:67], v[200:203]
  ds_read_b128 a[160:163], v3 offset:24576
  v_exp_f32 v216, v128
  v_mfma_f32_16x16x32_bf16 v[152:155], a[128:131], v[68:71], v[204:207]
  v_exp_f32 v217, v129
  v_mfma_f32_16x16x32_bf16 v[148:151], a[132:135], v[64:67], v[200:203]
  ds_read_b128 a[164:167], v3 offset:25600
  v_add_f32 v226, v216, v217
  v_mfma_f32_16x16x32_bf16 v[156:159], a[132:135], v[68:71], v[204:207]
  s_mov_b32 m0, s25
  v_exp_f32 v218, v130
  v_cvt_pk_bf16_f32 v176, v216, v217
  v_mfma_f32_16x16x32_bf16 v[144:147], a[136:139], v[72:75], v[144:147]
  ds_read_b128 a[168:171], v3 offset:26624
  buffer_load_dwordx4 v2, s[48:51], s27 offen offset:0 sc1 lds
  v_mfma_f32_16x16x32_bf16 v[152:155], a[136:139], v[76:79], v[152:155]
  v_exp_f32 v219, v131
  v_add_f32 v226, v226, v218
  v_mfma_f32_16x16x32_bf16 v[148:151], a[140:143], v[72:75], v[148:151]
  ds_read_b128 a[172:175], v3 offset:27648
  v_add_f32 v226, v226, v219
  v_mfma_f32_16x16x32_bf16 v[156:159], a[140:143], v[76:79], v[156:159]
  s_waitcnt lgkmcnt(4)
  v_exp_f32 v220, v132
  v_cvt_pk_bf16_f32 v177, v218, v219
  v_mfma_f32_16x16x32_bf16 v[144:147], a[144:147], v[80:83], v[144:147]
  ds_read_b128 a[176:179], v3 offset:28672
  v_add_f32 v226, v226, v220
  v_mfma_f32_16x16x32_bf16 v[152:155], a[144:147], v[84:87], v[152:155]
  v_exp_f32 v221, v133
  v_exp_f32 v222, v134
  v_mfma_f32_16x16x32_bf16 v[148:151], a[148:151], v[80:83], v[148:151]
  ds_read_b128 a[180:183], v3 offset:29696
  buffer_load_dwordx4 v2, s[48:51], s27 offen offset:1024 sc1 lds
  v_mfma_f32_16x16x32_bf16 v[156:159], a[148:151], v[84:87], v[156:159]
  v_exp_f32 v223, v135
  v_mfma_f32_16x16x32_bf16 v[144:147], a[152:155], v[88:91], v[144:147]
  ds_read_b128 a[184:187], v3 offset:30720
  v_add_f32 v226, v226, v221
  v_mfma_f32_16x16x32_bf16 v[152:155], a[152:155], v[92:95], v[152:155]
  v_exp_f32 v216, v136
  v_mfma_f32_16x16x32_bf16 v[148:151], a[156:159], v[88:91], v[148:151]
  ds_read_b128 a[188:191], v3 offset:31744
  v_cvt_pk_bf16_f32 v178, v220, v221
  v_add_f32 v226, v226, v222
  v_mfma_f32_16x16x32_bf16 v[156:159], a[156:159], v[92:95], v[156:159]
  s_waitcnt lgkmcnt(4)
  v_exp_f32 v217, v137
  v_mfma_f32_16x16x32_bf16 a[64:67], a[160:163], v[184:187], a[64:67]
  ds_read_b128 a[128:131], v3 offset:8192
  v_add_f32 v226, v226, v223
  v_cvt_pk_bf16_f32 v179, v222, v223
  v_mfma_f32_16x16x32_bf16 a[68:71], a[160:163], v[188:191], a[68:71]
  v_exp_f32 v218, v138
  v_mfma_f32_16x16x32_bf16 a[72:75], a[164:167], v[184:187], a[72:75]
  ds_read_b128 a[132:135], v3 offset:9216
  buffer_load_dwordx4 v2, s[48:51], s27 offen offset:2048 sc1 lds
  v_add_f32 v227, v216, v217
  v_mfma_f32_16x16x32_bf16 a[76:79], a[164:167], v[188:191], a[76:79]
  v_exp_f32 v219, v139
  v_mfma_f32_16x16x32_bf16 a[80:83], a[168:171], v[184:187], a[80:83]
  ds_read_b128 a[136:139], v3 offset:10240
  v_cvt_pk_bf16_f32 v180, v216, v217
  v_mfma_f32_16x16x32_bf16 a[84:87], a[168:171], v[188:191], a[84:87]
  v_exp_f32 v220, v140
  v_add_f32 v227, v227, v218
  v_mfma_f32_16x16x32_bf16 a[88:91], a[172:175], v[184:187], a[88:91]
  ds_read_b128 a[140:143], v3 offset:11264
  v_add_f32 v227, v227, v219
  v_mfma_f32_16x16x32_bf16 a[92:95], a[172:175], v[188:191], a[92:95]
  s_waitcnt lgkmcnt(4)
  v_exp_f32 v221, v141
  v_cvt_pk_bf16_f32 v181, v218, v219
  v_mfma_f32_16x16x32_bf16 a[96:99], a[176:179], v[184:187], a[96:99]
  ds_read_b128 a[144:147], v3 offset:12288
  buffer_load_dwordx4 v2, s[48:51], s27 offen offset:3072 sc1 lds
  v_mfma_f32_16x16x32_bf16 a[100:103], a[176:179], v[188:191], a[100:103]
  s_add_u32 s27, s27, 16384
  v_exp_f32 v222, v142
  v_add_f32 v227, v227, v220
  v_mfma_f32_16x16x32_bf16 a[104:107], a[180:183], v[184:187], a[104:107]
  s_add_u32 s25, s25, 32768
  ds_read_b128 a[148:151], v3 offset:13312
  v_add_f32 v227, v227, v221
  v_mfma_f32_16x16x32_bf16 a[108:111], a[180:183], v[188:191], a[108:111]
  s_and_b32 s25, s25, 0x1ffff
  v_exp_f32 v223, v143
  v_cvt_pk_bf16_f32 v182, v220, v221
  v_mfma_f32_16x16x32_bf16 a[112:115], a[184:187], v[184:187], a[112:115]
  ds_read_b128 a[152:155], v3 offset:14336
  v_add_f32 v227, v227, v222
  v_mfma_f32_16x16x32_bf16 a[116:119], a[184:187], v[188:191], a[116:119]
  s_sub_u32 s29, s29, 1
  v_add_f32 v227, v227, v223
  v_cvt_pk_bf16_f32 v183, v222, v223
  v_max_f32 v5, v226, v227
  v_mfma_f32_16x16x32_bf16 a[120:123], a[188:191], v[184:187], a[120:123]
  s_waitcnt lgkmcnt(3)
  ds_read_b128 a[156:159], v3 offset:15360
  v_cmp_lt_f32 vcc, s81, v5
  v_mfma_f32_16x16x32_bf16 a[124:127], a[188:191], v[188:191], a[124:127]
  s_cbranch_vccnz fa_stub10
fa_back10:
  v_add_f32 v230, v230, v226
  v_add_f32 v231, v231, v227
  v_add_u32 v3, 32768, v3
  v_and_b32 v3, 0x1ffff, v3
  s_cmp_lg_u32 s29, 0
  s_cbranch_scc1 fa_SS
fa_Bexit:
  s_bitcmp1_b32 s20, 0
  s_cbranch_scc1 fa_Bodd
  v_mfma_f32_16x16x32_bf16 v[128:131], a[128:131], v[64:67], v[200:203]
  s_waitcnt vmcnt(0)
  v_exp_f32 v216, v144
  v_mfma_f32_16x16x32_bf16 v[136:139], a[128:131], v[68:71], v[204:207]
  s_barrier
  v_exp_f32 v217, v145
  v_mfma_f32_16x16x32_bf16 v[132:135], a[132:135], v[64:67], v[200:203]
  ds_read_b128 a[160:163], v3 offset:16384
  ds_read_b128 a[164:167], v3 offset:17408
  v_mfma_f32_16x16x32_bf16 v[140:143], a[132:135], v[68:71], v[204:207]
  v_exp_f32 v218, v146
  v_mfma_f32_16x16x32_bf16 v[128:131], a[136:139], v[72:75], v[128:131]
  ds_read_b128 a[168:171], v3 offset:18432
  v_add_f32 v226, v216, v217
  v_mfma_f32_16x16x32_bf16 v[136:139], a[136:139], v[76:79], v[136:139]
  v_exp_f32 v219, v147
  v_mfma_f32_16x16x32_bf16 v[132:135], a[140:143], v[72:75], v[132:135]
  ds_read_b128 a[172:175], v3 offset:19456
  v_cvt_pk_bf16_f32 v184, v216, v217
  v_mfma_f32_16x16x32_bf16 v[140:143], a[140:143], v[76:79], v[140:143]
  s_waitcnt lgkmcnt(4)
  v_exp_f32 v220, v148
  v_add_f32 v226, v226, v218
  v_mfma_f32_16x16x32_bf16 v[128:131], a[144:147], v[80:83], v[128:131]
  ds_read_b128 a[176:179], v3 offset:20480
  v_add_f32 v226, v226, v219
  v_mfma_f32_16x16x32_bf16 v[136:139], a[144:147], v[84:87], v[136:139]
  v_exp_f32 v221, v149
  v_mfma_f32_16x16x32_bf16 v[132:135], a[148:151], v[80:83], v[132:135]
  ds_read_b128 a[180:183], v3 offset:21504
  v_cvt_pk_bf16_f32 v185, v218, v219
  v_mfma_f32_16x16x32_bf16 v[140:143], a[148:151], v[84:87], v[140:143]
  v_exp_f32 v222, v150
  v_mfma_f32_16x16x32_bf16 v[128:131], a[152:155], v[88:91], v[128:131]
  ds_read_b128 a[184:187], v3 offset:22528
  v_add_f32 v226, v226, v220
  v_mfma_f32_16x16x32_bf16 v[136:139], a[152:155], v[92:95], v[136:139]
  v_exp_f32 v223, v151
  v_mfma_f32_16x16x32_bf16 v[132:135], a[156:159], v[88:91], v[132:135]
  ds_read_b128 a[188:191], v3 offset:23552
  v_add_f32 v226, v226, v221
  v_mfma_f32_16x16x32_bf16 v[140:143], a[156:159], v[92:95], v[140:143]
  s_waitcnt lgkmcnt(4)
  v_exp_f32 v216, v152
  v_mfma_f32_16x16x32_bf16 a[64:67], a[160:163], v[176:179], a[64:67]
  v_exp_f32 v217, v153
  v_mfma_f32_16x16x32_bf16 a[68:71], a[160:163], v[180:183], a[68:71]
  v_exp_f32 v218, v154
  v_mfma_f32_16x16x32_bf16 a[72:75], a[164:167], v[176:179], a[72:75]
  v_exp_f32 v219, v155
  v_mfma_f32_16x16x32_bf16 a[76:79], a[164:167], v[180:183], a[76:79]
  v_cvt_pk_bf16_f32 v186, v220, v221
  v_add_f32 v226, v226, v222
  v_mfma_f32_16x16x32_bf16 a[80:83], a[168:171], v[176:179], a[80:83]
  v_exp_f32 v220, v156
  v_mfma_f32_16x16x32_bf16 a[84:87], a[168:171], v[180:183], a[84:87]
  v_exp_f32 v221, v157
  v_mfma_f32_16x16x32_bf16 a[88:91], a[172:175], v[176:179], a[88:91]
  v_add_f32 v226, v226, v223
  v_cvt_pk_bf16_f32 v187, v222, v223
  v_mfma_f32_16x16x32_bf16 a[92:95], a[172:175], v[180:183], a[92:95]
  s_waitcnt lgkmcnt(0)
  v_exp_f32 v222, v158
  v_add_f32 v227, v216, v217
  v_mfma_f32_16x16x32_bf16 a[96:99], a[176:179], v[176:179], a[96:99]
  v_exp_f32 v223, v159
  v_mfma_f32_16x16x32_bf16 a[100:103], a[176:179], v[180:183], a[100:103]
  v_cvt_pk_bf16_f32 v188, v216, v217
  v_add_f32 v227, v227, v218
  v_mfma_f32_16x16x32_bf16 a[104:107], a[180:183], v[176:179], a[104:107]
  v_add_f32 v227, v227, v219
  v_cvt_pk_bf16_f32 v189, v218, v219
  v_mfma_f32_16x16x32_bf16 a[108:111], a[180:183], v[180:183], a[108:111]
  v_add_f32 v227, v227, v220
  v_add_f32 v227, v227, v221
  v_mfma_f32_16x16x32_bf16 a[112:115], a[184:187], v[176:179], a[112:115]
  v_cvt_pk_bf16_f32 v190, v220, v221
  v_add_f32 v227, v227, v222
  v_mfma_f32_16x16x32_bf16 a[116:119], a[184:187], v[180:183], a[116:119]
  v_add_f32 v227, v227, v223
  v_cvt_pk_bf16_f32 v191, v222, v223
  v_mfma_f32_16x16x32_bf16 a[120:123], a[188:191], v[176:179], a[120:123]
  v_max_f32 v5, v226, v227
  v_cmp_lt_f32 vcc, s81, v5
  v_mfma_f32_16x16x32_bf16 a[124:127], a[188:191], v[180:183], a[124:127]
  s_cbranch_vccnz fa_stub11
fa_back11:
  v_add_f32 v230, v230, v226
  v_add_f32 v231, v231, v227
  ds_read_b128 a[160:163], v3 offset:24576
  ds_read_b128 a[164:167], v3 offset:25600
  ds_read_b128 a[168:171], v3 offset:26624
  ds_read_b128 a[172:175], v3 offset:27648
  ds_read_b128 a[176:179], v3 offset:28672
  ds_read_b128 a[180:183], v3 offset:29696
  ds_read_b128 a[184:187], v3 offset:30720
  ds_read_b128 a[188:191], v3 offset:31744
  v_cndmask_b32 v128, v4, v128, s[68:69]
  v_cndmask_b32 v129, v4, v129, s[70:71]
  v_cndmask_b32 v130, v4, v130, s[72:73]
  v_cndmask_b32 v131, v4, v131, s[74:75]
  v_mov_b32 v132, v4
  v_mov_b32 v133, v4
  v_mov_b32 v134, v4
  v_mov_b32 v135, v4
  v_cndmask_b32 v140, v4, v140, s[68:69]
  v_cndmask_b32 v141, v4, v141, s[70:71]
  v_cndmask_b32 v142, v4, v142, s[72:73]
  v_cndmask_b32 v143, v4, v143, s[74:75]
  v_exp_f32 v216, v128
  v_exp_f32 v217, v129
  v_exp_f32 v218, v130
  v_exp_f32 v219, v131
  v_exp_f32 v220, v132
  v_exp_f32 v221, v133
  v_exp_f32 v222, v134
  v_exp_f32 v223, v135
  v_add_f32 v226, v216, v217
  v_cvt_pk_bf16_f32 v176, v216, v217
  s_waitcnt lgkmcnt(4)
  v_mfma_f32_16x16x32_bf16 a[64:67], a[160:163], v[184:187], a[64:67]
  v_exp_f32 v216, v136
  v_add_f32 v226, v226, v218
  v_mfma_f32_16x16x32_bf16 a[68:71], a[160:163], v[188:191], a[68:71]
  v_exp_f32 v217, v137
  v_mfma_f32_16x16x32_bf16 a[72:75], a[164:167], v[184:187], a[72:75]
  v_add_f32 v226, v226, v219
  v_cvt_pk_bf16_f32 v177, v218, v219
  v_add_f32 v226, v226, v220
  v_mfma_f32_16x16x32_bf16 a[76:79], a[164:167], v[188:191], a[76:79]
  v_exp_f32 v218, v138
  v_mfma_f32_16x16x32_bf16 a[80:83], a[168:171], v[184:187], a[80:83]
  v_exp_f32 v219, v139
  v_add_f32 v226, v226, v221
  v_mfma_f32_16x16x32_bf16 a[84:87], a[168:171], v[188:191], a[84:87]
  v_cvt_pk_bf16_f32 v178, v220, v221
  v_add_f32 v226, v226, v222
  v_mfma_f32_16x16x32_bf16 a[88:91], a[172:175], v[184:187], a[88:91]
  v_exp_f32 v220, v140
  v_add_f32 v226, v226, v223
  v_mfma_f32_16x16x32_bf16 a[92:95], a[172:175], v[188:191], a[92:95]
  s_waitcnt lgkmcnt(0)
  v_exp_f32 v221, v141
  v_mfma_f32_16x16x32_bf16 a[96:99], a[176:179], v[184:187], a[96:99]
  v_cvt_pk_bf16_f32 v179, v222, v223
  v_add_f32 v227, v216, v217
  v_cvt_pk_bf16_f32 v180, v216, v217
  v_mfma_f32_16x16x32_bf16 a[100:103], a[176:179], v[188:191], a[100:103]
  v_exp_f32 v222, v142
  v_mfma_f32_16x16x32_bf16 a[104:107], a[180:183], v[184:187], a[104:107]
  v_exp_f32 v223, v143
  v_add_f32 v227, v227, v218
  v_mfma_f32_16x16x32_bf16 a[108:111], a[180:183], v[188:191], a[108:111]
  v_add_f32 v227, v227, v219
  v_cvt_pk_bf16_f32 v181, v218, v219
  v_mfma_f32_16x16x32_bf16 a[112:115], a[184:187], v[184:187], a[112:115]
  v_add_f32 v227, v227, v220
  v_add_f32 v227, v227, v221
  v_cvt_pk_bf16_f32 v182, v220, v221
  v_mfma_f32_16x16x32_bf16 a[116:119], a[184:187], v[188:191], a[116:119]
  v_add_f32 v227, v227, v222
  v_add_f32 v227, v227, v223
  v_mfma_f32_16x16x32_bf16 a[120:123], a[188:191], v[184:187], a[120:123]
  v_cvt_pk_bf16_f32 v183, v222, v223
  v_max_f32 v5, v226, v227
  v_cmp_lt_f32 vcc, s81, v5
  v_mfma_f32_16x16x32_bf16 a[124:127], a[188:191], v[188:191], a[124:127]
  s_cbranch_vccnz fa_stub12
fa_back12:
  v_add_f32 v230, v230, v226
  v_add_f32 v231, v231, v227
  v_add_u32 v3, 32768, v3
  v_and_b32 v3, 0x1ffff, v3
  s_waitcnt vmcnt(0)
  s_barrier
  ds_read_b128 a[160:163], v3 offset:16384
  ds_read_b128 a[164:167], v3 offset:17408
  ds_read_b128 a[168:171], v3 offset:18432
  ds_read_b128 a[172:175], v3 offset:19456
  ds_read_b128 a[176:179], v3 offset:20480
  ds_read_b128 a[180:183], v3 offset:21504
  ds_read_b128 a[184:187], v3 offset:22528
  ds_read_b128 a[188:191], v3 offset:23552
  s_waitcnt lgkmcnt(4)
  v_mfma_f32_16x16x32_bf16 a[64:67], a[160:163], v[176:179], a[64:67]
  v_mfma_f32_16x16x32_bf16 a[68:71], a[160:163], v[180:183], a[68:71]
  v_mfma_f32_16x16x32_bf16 a[72:75], a[164:167], v[176:179], a[72:75]
  v_mfma_f32_16x16x32_bf16 a[76:79], a[164:167], v[180:183], a[76:79]
  v_mfma_f32_16x16x32_bf16 a[80:83], a[168:171], v[176:179], a[80:83]
  v_mfma_f32_16x16x32_bf16 a[84:87], a[168:171], v[180:183], a[84:87]
  v_mfma_f32_16x16x32_bf16 a[88:91], a[172:175], v[176:179], a[88:91]
  v_mfma_f32_16x16x32_bf16 a[92:95], a[172:175], v[180:183], a[92:95]
  s_waitcnt lgkmcnt(0)
  v_mfma_f32_16x16x32_bf16 a[96:99], a[176:179], v[176:179], a[96:99]
  v_mfma_f32_16x16x32_bf16 a[100:103], a[176:179], v[180:183], a[100:103]
  v_mfma_f32_16x16x32_bf16 a[104:107], a[180:183], v[176:179], a[104:107]
  v_mfma_f32_16x16x32_bf16 a[108:111], a[180:183], v[180:183], a[108:111]
  v_mfma_f32_16x16x32_bf16 a[112:115], a[184:187], v[176:179], a[112:115]
  v_mfma_f32_16x16x32_bf16 a[116:119], a[184:187], v[180:183], a[116:119]
  v_mfma_f32_16x16x32_bf16 a[120:123], a[188:191], v[176:179], a[120:123]
  v_mfma_f32_16x16x32_bf16 a[124:127], a[188:191], v[180:183], a[124:127]
  s_branch fa_Bdone
fa_Bodd:
  s_waitcnt vmcnt(0)
  s_barrier
  ds_read_b128 a[160:163], v3 offset:16384
  ds_read_b128 a[164:167], v3 offset:17408
  ds_read_b128 a[168:171], v3 offset:18432
  ds_read_b128 a[172:175], v3 offset:19456
  ds_read_b128 a[176:179], v3 offset:20480
  ds_read_b128 a[180:183], v3 offset:21504
  ds_read_b128 a[184:187], v3 offset:22528
  ds_read_b128 a[188:191], v3 offset:23552
  v_cndmask_b32 v144, v4, v144, s[68:69]
  v_cndmask_b32 v145, v4, v145, s[70:71]
  v_cndmask_b32 v146, v4, v146, s[72:73]
  v_cndmask_b32 v147, v4, v147, s[74:75]
  v_mov_b32 v148, v4
  v_mov_b32 v149, v4
  v_mov_b32 v150, v4
  v_mov_b32 v151, v4
  v_cndmask_b32 v156, v4, v156, s[68:69]
  v_cndmask_b32 v157, v4, v157, s[70:71]
  v_cndmask_b32 v158, v4, v158, s[72:73]
  v_cndmask_b32 v159, v4, v159, s[74:75]
  v_exp_f32 v216, v144
  v_exp_f32 v217, v145
  v_exp_f32 v218, v146
  v_exp_f32 v219, v147
  v_exp_f32 v220, v148
  v_exp_f32 v221, v149
  v_exp_f32 v222, v150
  v_exp_f32 v223, v151
  v_add_f32 v226, v216, v217
  v_cvt_pk_bf16_f32 v184, v216, v217
  s_waitcnt lgkmcnt(4)
  v_mfma_f32_16x16x32_bf16 a[64:67], a[160:163], v[176:179], a[64:67]
  v_exp_f32 v216, v152
  v_add_f32 v226, v226, v218
  v_mfma_f32_16x16x32_bf16 a[68:71], a[160:163], v[180:183], a[68:71]
  v_exp_f32 v217, v153
  v_mfma_f32_16x16x32_bf16 a[72:75], a[164:167], v[176:179], a[72:75]
  v_add_f32 v226, v226, v219
  v_cvt_pk_bf16_f32 v185, v218, v219
  v_add_f32 v226, v226, v220
  v_mfma_f32_16x16x32_bf16 a[76:79], a[164:167], v[180:183], a[76:79]
  v_exp_f32 v218, v154
  v_mfma_f32_16x16x32_bf16 a[80:83], a[168:171], v[176:179], a[80:83]
  v_exp_f32 v219, v155
  v_add_f32 v226, v226, v221
  v_mfma_f32_16x16x32_bf16 a[84:87], a[168:171], v[180:183], a[84:87]
  v_cvt_pk_bf16_f32 v186, v220, v221
  v_add_f32 v226, v226, v222
  v_mfma_f32_16x16x32_bf16 a[88:91], a[172:175], v[176:179], a[88:91]
  v_exp_f32 v220, v156
  v_add_f32 v226, v226, v223
  v_mfma_f32_16x16x32_bf16 a[92:95], a[172:175], v[180:183], a[92:95]
  s_waitcnt lgkmcnt(0)
  v_exp_f32 v221, v157
  v_mfma_f32_16x16x32_bf16 a[96:99], a[176:179], v[176:179], a[96:99]
  v_cvt_pk_bf16_f32 v187, v222, v223
  v_add_f32 v227, v216, v217
  v_cvt_pk_bf16_f32 v188, v216, v217
  v_mfma_f32_16x16x32_bf16 a[100:103], a[176:179], v[180:183], a[100:103]
  v_exp_f32 v222, v158
  v_mfma_f32_16x16x32_bf16 a[104:107], a[180:183], v[176:179], a[104:107]
  v_exp_f32 v223, v159
  v_add_f32 v227, v227, v218
  v_mfma_f32_16x16x32_bf16 a[108:111], a[180:183], v[180:183], a[108:111]
  v_add_f32 v227, v227, v219
  v_cvt_pk_bf16_f32 v189, v218, v219
  v_mfma_f32_16x16x32_bf16 a[112:115], a[184:187], v[176:179], a[112:115]
  v_add_f32 v227, v227, v220
  v_add_f32 v227, v227, v221
  v_cvt_pk_bf16_f32 v190, v220, v221
  v_mfma_f32_16x16x32_bf16 a[116:119], a[184:187], v[180:183], a[116:119]
  v_add_f32 v227, v227, v222
  v_add_f32 v227, v227, v223
  v_mfma_f32_16x16x32_bf16 a[120:123], a[188:191], v[176:179], a[120:123]
  v_cvt_pk_bf16_f32 v191, v222, v223
  v_max_f32 v5, v226, v227
  v_cmp_lt_f32 vcc, s81, v5
  v_mfma_f32_16x16x32_bf16 a[124:127], a[188:191], v[180:183], a[124:127]
  s_cbranch_vccnz fa_stub13
fa_back13:
  v_add_f32 v230, v230, v226
  v_add_f32 v231, v231, v227
  ds_read_b128 a[160:163], v3 offset:24576
  ds_read_b128 a[164:167], v3 offset:25600
  ds_read_b128 a[168:171], v3 offset:26624
  ds_read_b128 a[172:175], v3 offset:27648
  ds_read_b128 a[176:179], v3 offset:28672
  ds_read_b128 a[180:183], v3 offset:29696
  ds_read_b128 a[184:187], v3 offset:30720
  ds_read_b128 a[188:191], v3 offset:31744
  s_waitcnt lgkmcnt(4)
  v_mfma_f32_16x16x32_bf16 a[64:67], a[160:163], v[184:187], a[64:67]
  v_mfma_f32_16x16x32_bf16 a[68:71], a[160:163], v[188:191], a[68:71]
  v_mfma_f32_16x16x32_bf16 a[72:75], a[164:167], v[184:187], a[72:75]
  v_mfma_f32_16x16x32_bf16 a[76:79], a[164:167], v[188:191], a[76:79]
  v_mfma_f32_16x16x32_bf16 a[80:83], a[168:171], v[184:187], a[80:83]
  v_mfma_f32_16x16x32_bf16 a[84:87], a[168:171], v[188:191], a[84:87]
  v_mfma_f32_16x16x32_bf16 a[88:91], a[172:175], v[184:187], a[88:91]
  v_mfma_f32_16x16x32_bf16 a[92:95], a[172:175], v[188:191], a[92:95]
  s_waitcnt lgkmcnt(0)
  v_mfma_f32_16x16x32_bf16 a[96:99], a[176:179], v[184:187], a[96:99]
  v_mfma_f32_16x16x32_bf16 a[100:103], a[176:179], v[188:191], a[100:103]
  v_mfma_f32_16x16x32_bf16 a[104:107], a[180:183], v[184:187], a[104:107]
  v_mfma_f32_16x16x32_bf16 a[108:111], a[180:183], v[188:191], a[108:111]
  v_mfma_f32_16x16x32_bf16 a[112:115], a[184:187], v[184:187], a[112:115]
  v_mfma_f32_16x16x32_bf16 a[116:119], a[184:187], v[188:191], a[116:119]
  v_mfma_f32_16x16x32_bf16 a[120:123], a[188:191], v[184:187], a[120:123]
  v_mfma_f32_16x16x32_bf16 a[124:127], a[188:191], v[188:191], a[124:127]
  v_add_u32 v3, 32768, v3
  v_and_b32 v3, 0x1ffff, v3
fa_Bdone:
  s_cmp_ge_u32 s20, 2
  s_cbranch_scc1 fa_epi
  s_barrier
fa_epi:
  s_and_b32 s23, s21, 0
  s_lshl_b32 s23, s23, 1
  s_add_u32 s23, s23, s22
  s_and_b32 s60, s23, 7
  s_lshl_b32 s23, s60, 2
  s_add_u32 s23, s23, s20
  s_lshl_b32 s23, s23, 7
  s_add_u32 s23, s23, 2654208
  v_and_b32 v9, 31, v1
  v_lshl_add_u32 v9, v9, 2, s23
  buffer_load_dword v8, v9, s[40:43], 0 offen sc1
  v_mov_b32 v20, v228
  v_mov_b32 v21, v229
  v_mov_b32 v22, v230
  v_mov_b32 v23, v231
  s_nop 0
  v_permlane16_swap_b32 v228, v20
  v_permlane16_swap_b32 v229, v21
  v_permlane16_swap_b32 v230, v22
  v_permlane16_swap_b32 v231, v23
  v_add_f32 v228, v228, v20
  v_add_f32 v229, v229, v21
  v_add_f32 v230, v230, v22
  v_add_f32 v231, v231, v23
  v_mov_b32 v20, v228
  v_mov_b32 v21, v229
  v_mov_b32 v22, v230
  v_mov_b32 v23, v231
  s_nop 0
  v_permlane32_swap_b32 v228, v20
  v_permlane32_swap_b32 v229, v21
  v_permlane32_swap_b32 v230, v22
  v_permlane32_swap_b32 v231, v23
  v_add_f32 v228, v228, v20
  v_add_f32 v229, v229, v21
  v_add_f32 v230, v230, v22
  v_add_f32 v231, v231, v23
  v_rcp_f32 v16, v228
  v_rcp_f32 v18, v229
  v_rcp_f32 v20, v230
  v_rcp_f32 v22, v231
  s_nop 0
  v_mov_b32 v17, v16
  v_mov_b32 v19, v18
  v_mov_b32 v21, v20
  v_mov_b32 v23, v22
  s_lshl_b32 s23, s22, 2
  s_add_u32 s23, s23, s20
  s_lshl_b32 s23, s23, 18
  s_lshl_b32 s31, s21, 12
  s_add_u32 s31, s31, 50331648
  s_add_u32 s64, s23, s31
  s_add_u32 s65, s64, 131072
  s_sub_u32 s23, 15, s22
  s_lshl_b32 s23, s23, 2
  s_add_u32 s23, s23, s20
  s_lshl_b32 s23, s23, 18
  s_add_u32 s66, s23, s31
  s_add_u32 s67, s66, 131072
  v_accvgpr_read_b32 v36, a0
  v_accvgpr_read_b32 v37, a1
  v_accvgpr_read_b32 v38, a2
  v_accvgpr_read_b32 v39, a3
  v_accvgpr_read_b32 v40, a8
  v_accvgpr_read_b32 v41, a9
  v_accvgpr_read_b32 v42, a10
  v_accvgpr_read_b32 v43, a11
  v_pk_mul_f32 v[36:37], v[36:37], v[16:17]
  v_pk_mul_f32 v[38:39], v[38:39], v[16:17]
  v_pk_mul_f32 v[40:41], v[40:41], v[16:17]
  v_pk_mul_f32 v[42:43], v[42:43], v[16:17]
  v_cvt_pk_bf16_f32 v32, v36, v37
  v_cvt_pk_bf16_f32 v33, v38, v39
  v_cvt_pk_bf16_f32 v34, v40, v41
  v_cvt_pk_bf16_f32 v35, v42, v43
  buffer_store_dwordx4 v[32:35], v2, s[40:43], s64 offen offset:0 sc1
  v_accvgpr_read_b32 v48, a16
  v_accvgpr_read_b32 v49, a17
  v_accvgpr_read_b32 v50, a18
  v_accvgpr_read_b32 v51, a19
  v_accvgpr_read_b32 v52, a24
  v_accvgpr_read_b32 v53, a25
  v_accvgpr_read_b32 v54, a26
  v_accvgpr_read_b32 v55, a27
  v_pk_mul_f32 v[48:49], v[48:49], v[16:17]
  v_pk_mul_f32 v[50:51], v[50:51], v[16:17]
  v_pk_mul_f32 v[52:53], v[52:53], v[16:17]
  v_pk_mul_f32 v[54:55], v[54:55], v[16:17]
  v_cvt_pk_bf16_f32 v44, v48, v49
  v_cvt_pk_bf16_f32 v45, v50, v51
  v_cvt_pk_bf16_f32 v46, v52, v53
  v_cvt_pk_bf16_f32 v47, v54, v55
  buffer_store_dwordx4 v[44:47], v2, s[40:43], s64 offen offset:1024 sc1
  v_accvgpr_read_b32 v60, a32
  v_accvgpr_read_b32 v61, a33
  v_accvgpr_read_b32 v62, a34
  v_accvgpr_read_b32 v63, a35
  v_accvgpr_read_b32 v64, a40
  v_accvgpr_read_b32 v65, a41
  v_accvgpr_read_b32 v66, a42
  v_accvgpr_read_b32 v67, a43
  v_pk_mul_f32 v[60:61], v[60:61], v[16:17]
  v_pk_mul_f32 v[62:63], v[62:63], v[16:17]
  v_pk_mul_f32 v[64:65], v[64:65], v[16:17]
  v_pk_mul_f32 v[66:67], v[66:67], v[16:17]
  v_cvt_pk_bf16_f32 v56, v60, v61
  v_cvt_pk_bf16_f32 v57, v62, v63
  v_cvt_pk_bf16_f32 v58, v64, v65
  v_cvt_pk_bf16_f32 v59, v66, v67
  buffer_store_dwordx4 v[56:59], v2, s[40:43], s64 offen offset:2048 sc1
  v_accvgpr_read_b32 v72, a48
  v_accvgpr_read_b32 v73, a49
  v_accvgpr_read_b32 v74, a50
  v_accvgpr_read_b32 v75, a51
  v_accvgpr_read_b32 v76, a56
  v_accvgpr_read_b32 v77, a57
  v_accvgpr_read_b32 v78, a58
  v_accvgpr_read_b32 v79, a59
  v_pk_mul_f32 v[72:73], v[72:73], v[16:17]
  v_pk_mul_f32 v[74:75], v[74:75], v[16:17]
  v_pk_mul_f32 v[76:77], v[76:77], v[16:17]
  v_pk_mul_f32 v[78:79], v[78:79], v[16:17]
  v_cvt_pk_bf16_f32 v68, v72, v73
  v_cvt_pk_bf16_f32 v69, v74, v75
  v_cvt_pk_bf16_f32 v70, v76, v77
  v_cvt_pk_bf16_f32 v71, v78, v79
  buffer_store_dwordx4 v[68:71], v2, s[40:43], s64 offen offset:3072 sc1
  v_accvgpr_read_b32 v84, a4
  v_accvgpr_read_b32 v85, a5
  v_accvgpr_read_b32 v86, a6
  v_accvgpr_read_b32 v87, a7
  v_accvgpr_read_b32 v88, a12
  v_accvgpr_read_b32 v89, a13
  v_accvgpr_read_b32 v90, a14
  v_accvgpr_read_b32 v91, a15
  v_pk_mul_f32 v[84:85], v[84:85], v[18:19]
  v_pk_mul_f32 v[86:87], v[86:87], v[18:19]
  v_pk_mul_f32 v[88:89], v[88:89], v[18:19]
  v_pk_mul_f32 v[90:91], v[90:91], v[18:19]
  v_cvt_pk_bf16_f32 v80, v84, v85
  v_cvt_pk_bf16_f32 v81, v86, v87
  v_cvt_pk_bf16_f32 v82, v88, v89
  v_cvt_pk_bf16_f32 v83, v90, v91
  buffer_store_dwordx4 v[80:83], v2, s[40:43], s65 offen offset:0 sc1
  v_accvgpr_read_b32 v96, a20
  v_accvgpr_read_b32 v97, a21
  v_accvgpr_read_b32 v98, a22
  v_accvgpr_read_b32 v99, a23
  v_accvgpr_read_b32 v100, a28
  v_accvgpr_read_b32 v101, a29
  v_accvgpr_read_b32 v102, a30
  v_accvgpr_read_b32 v103, a31
  v_pk_mul_f32 v[96:97], v[96:97], v[18:19]
  v_pk_mul_f32 v[98:99], v[98:99], v[18:19]
  v_pk_mul_f32 v[100:101], v[100:101], v[18:19]
  v_pk_mul_f32 v[102:103], v[102:103], v[18:19]
  v_cvt_pk_bf16_f32 v92, v96, v97
  v_cvt_pk_bf16_f32 v93, v98, v99
  v_cvt_pk_bf16_f32 v94, v100, v101
  v_cvt_pk_bf16_f32 v95, v102, v103
  buffer_store_dwordx4 v[92:95], v2, s[40:43], s65 offen offset:1024 sc1
  v_accvgpr_read_b32 v108, a36
  v_accvgpr_read_b32 v109, a37
  v_accvgpr_read_b32 v110, a38
  v_accvgpr_read_b32 v111, a39
  v_accvgpr_read_b32 v112, a44
  v_accvgpr_read_b32 v113, a45
  v_accvgpr_read_b32 v114, a46
  v_accvgpr_read_b32 v115, a47
  v_pk_mul_f32 v[108:109], v[108:109], v[18:19]
  v_pk_mul_f32 v[110:111], v[110:111], v[18:19]
  v_pk_mul_f32 v[112:113], v[112:113], v[18:19]
  v_pk_mul_f32 v[114:115], v[114:115], v[18:19]
  v_cvt_pk_bf16_f32 v104, v108, v109
  v_cvt_pk_bf16_f32 v105, v110, v111
  v_cvt_pk_bf16_f32 v106, v112, v113
  v_cvt_pk_bf16_f32 v107, v114, v115
  buffer_store_dwordx4 v[104:107], v2, s[40:43], s65 offen offset:2048 sc1
  v_accvgpr_read_b32 v120, a52
  v_accvgpr_read_b32 v121, a53
  v_accvgpr_read_b32 v122, a54
  v_accvgpr_read_b32 v123, a55
  v_accvgpr_read_b32 v124, a60
  v_accvgpr_read_b32 v125, a61
  v_accvgpr_read_b32 v126, a62
  v_accvgpr_read_b32 v127, a63
  v_pk_mul_f32 v[120:121], v[120:121], v[18:19]
  v_pk_mul_f32 v[122:123], v[122:123], v[18:19]
  v_pk_mul_f32 v[124:125], v[124:125], v[18:19]
  v_pk_mul_f32 v[126:127], v[126:127], v[18:19]
  v_cvt_pk_bf16_f32 v116, v120, v121
  v_cvt_pk_bf16_f32 v117, v122, v123
  v_cvt_pk_bf16_f32 v118, v124, v125
  v_cvt_pk_bf16_f32 v119, v126, v127
  buffer_store_dwordx4 v[116:119], v2, s[40:43], s65 offen offset:3072 sc1
  v_accvgpr_read_b32 v36, a64
  v_accvgpr_read_b32 v37, a65
  v_accvgpr_read_b32 v38, a66
  v_accvgpr_read_b32 v39, a67
  v_accvgpr_read_b32 v40, a72
  v_accvgpr_read_b32 v41, a73
  v_accvgpr_read_b32 v42, a74
  v_accvgpr_read_b32 v43, a75
  v_pk_mul_f32 v[36:37], v[36:37], v[20:21]
  v_pk_mul_f32 v[38:39], v[38:39], v[20:21]
  v_pk_mul_f32 v[40:41], v[40:41], v[20:21]
  v_pk_mul_f32 v[42:43], v[42:43], v[20:21]
  v_cvt_pk_bf16_f32 v32, v36, v37
  v_cvt_pk_bf16_f32 v33, v38, v39
  v_cvt_pk_bf16_f32 v34, v40, v41
  v_cvt_pk_bf16_f32 v35, v42, v43
  buffer_store_dwordx4 v[32:35], v2, s[40:43], s66 offen offset:0 sc1
  v_accvgpr_read_b32 v48, a80
  v_accvgpr_read_b32 v49, a81
  v_accvgpr_read_b32 v50, a82
  v_accvgpr_read_b32 v51, a83
  v_accvgpr_read_b32 v52, a88
  v_accvgpr_read_b32 v53, a89
  v_accvgpr_read_b32 v54, a90
  v_accvgpr_read_b32 v55, a91
  v_pk_mul_f32 v[48:49], v[48:49], v[20:21]
  v_pk_mul_f32 v[50:51], v[50:51], v[20:21]
  v_pk_mul_f32 v[52:53], v[52:53], v[20:21]
  v_pk_mul_f32 v[54:55], v[54:55], v[20:21]
  v_cvt_pk_bf16_f32 v44, v48, v49
  v_cvt_pk_bf16_f32 v45, v50, v51
  v_cvt_pk_bf16_f32 v46, v52, v53
  v_cvt_pk_bf16_f32 v47, v54, v55
  buffer_store_dwordx4 v[44:47], v2, s[40:43], s66 offen offset:1024 sc1
  v_accvgpr_read_b32 v60, a96
  v_accvgpr_read_b32 v61, a97
  v_accvgpr_read_b32 v62, a98
  v_accvgpr_read_b32 v63, a99
  v_accvgpr_read_b32 v64, a104
  v_accvgpr_read_b32 v65, a105
  v_accvgpr_read_b32 v66, a106
  v_accvgpr_read_b32 v67, a107
  v_pk_mul_f32 v[60:61], v[60:61], v[20:21]
  v_pk_mul_f32 v[62:63], v[62:63], v[20:21]
  v_pk_mul_f32 v[64:65], v[64:65], v[20:21]
  v_pk_mul_f32 v[66:67], v[66:67], v[20:21]
  v_cvt_pk_bf16_f32 v56, v60, v61
  v_cvt_pk_bf16_f32 v57, v62, v63
  v_cvt_pk_bf16_f32 v58, v64, v65
  v_cvt_pk_bf16_f32 v59, v66, v67
  buffer_store_dwordx4 v[56:59], v2, s[40:43], s66 offen offset:2048 sc1
  v_accvgpr_read_b32 v72, a112
  v_accvgpr_read_b32 v73, a113
  v_accvgpr_read_b32 v74, a114
  v_accvgpr_read_b32 v75, a115
  v_accvgpr_read_b32 v76, a120
  v_accvgpr_read_b32 v77, a121
  v_accvgpr_read_b32 v78, a122
  v_accvgpr_read_b32 v79, a123
  v_pk_mul_f32 v[72:73], v[72:73], v[20:21]
  v_pk_mul_f32 v[74:75], v[74:75], v[20:21]
  v_pk_mul_f32 v[76:77], v[76:77], v[20:21]
  v_pk_mul_f32 v[78:79], v[78:79], v[20:21]
  v_cvt_pk_bf16_f32 v68, v72, v73
  v_cvt_pk_bf16_f32 v69, v74, v75
  v_cvt_pk_bf16_f32 v70, v76, v77
  v_cvt_pk_bf16_f32 v71, v78, v79
  buffer_store_dwordx4 v[68:71], v2, s[40:43], s66 offen offset:3072 sc1
  v_accvgpr_read_b32 v84, a68
  v_accvgpr_read_b32 v85, a69
  v_accvgpr_read_b32 v86, a70
  v_accvgpr_read_b32 v87, a71
  v_accvgpr_read_b32 v88, a76
  v_accvgpr_read_b32 v89, a77
  v_accvgpr_read_b32 v90, a78
  v_accvgpr_read_b32 v91, a79
  v_pk_mul_f32 v[84:85], v[84:85], v[22:23]
  v_pk_mul_f32 v[86:87], v[86:87], v[22:23]
  v_pk_mul_f32 v[88:89], v[88:89], v[22:23]
  v_pk_mul_f32 v[90:91], v[90:91], v[22:23]
  v_cvt_pk_bf16_f32 v80, v84, v85
  v_cvt_pk_bf16_f32 v81, v86, v87
  v_cvt_pk_bf16_f32 v82, v88, v89
  v_cvt_pk_bf16_f32 v83, v90, v91
  buffer_store_dwordx4 v[80:83], v2, s[40:43], s67 offen offset:0 sc1
  v_accvgpr_read_b32 v96, a84
  v_accvgpr_read_b32 v97, a85
  v_accvgpr_read_b32 v98, a86
  v_accvgpr_read_b32 v99, a87
  v_accvgpr_read_b32 v100, a92
  v_accvgpr_read_b32 v101, a93
  v_accvgpr_read_b32 v102, a94
  v_accvgpr_read_b32 v103, a95
  v_pk_mul_f32 v[96:97], v[96:97], v[22:23]
  v_pk_mul_f32 v[98:99], v[98:99], v[22:23]
  v_pk_mul_f32 v[100:101], v[100:101], v[22:23]
  v_pk_mul_f32 v[102:103], v[102:103], v[22:23]
  v_cvt_pk_bf16_f32 v92, v96, v97
  v_cvt_pk_bf16_f32 v93, v98, v99
  v_cvt_pk_bf16_f32 v94, v100, v101
  v_cvt_pk_bf16_f32 v95, v102, v103
  buffer_store_dwordx4 v[92:95], v2, s[40:43], s67 offen offset:1024 sc1
  v_accvgpr_read_b32 v108, a100
  v_accvgpr_read_b32 v109, a101
  v_accvgpr_read_b32 v110, a102
  v_accvgpr_read_b32 v111, a103
  v_accvgpr_read_b32 v112, a108
  v_accvgpr_read_b32 v113, a109
  v_accvgpr_read_b32 v114, a110
  v_accvgpr_read_b32 v115, a111
  v_pk_mul_f32 v[108:109], v[108:109], v[22:23]
  v_pk_mul_f32 v[110:111], v[110:111], v[22:23]
  v_pk_mul_f32 v[112:113], v[112:113], v[22:23]
  v_pk_mul_f32 v[114:115], v[114:115], v[22:23]
  v_cvt_pk_bf16_f32 v104, v108, v109
  v_cvt_pk_bf16_f32 v105, v110, v111
  v_cvt_pk_bf16_f32 v106, v112, v113
  v_cvt_pk_bf16_f32 v107, v114, v115
  buffer_store_dwordx4 v[104:107], v2, s[40:43], s67 offen offset:2048 sc1
  v_accvgpr_read_b32 v120, a116
  v_accvgpr_read_b32 v121, a117
  v_accvgpr_read_b32 v122, a118
  v_accvgpr_read_b32 v123, a119
  v_accvgpr_read_b32 v124, a124
  v_accvgpr_read_b32 v125, a125
  v_accvgpr_read_b32 v126, a126
  v_accvgpr_read_b32 v127, a127
  v_pk_mul_f32 v[120:121], v[120:121], v[22:23]
  v_pk_mul_f32 v[122:123], v[122:123], v[22:23]
  v_pk_mul_f32 v[124:125], v[124:125], v[22:23]
  v_pk_mul_f32 v[126:127], v[126:127], v[22:23]
  v_cvt_pk_bf16_f32 v116, v120, v121
  v_cvt_pk_bf16_f32 v117, v122, v123
  v_cvt_pk_bf16_f32 v118, v124, v125
  v_cvt_pk_bf16_f32 v119, v126, v127
  buffer_store_dwordx4 v[116:119], v2, s[40:43], s67 offen offset:3072 sc1
  s_load_dwordx2 s[4:5], s[0:1], 0
  s_load_dwordx2 s[6:7], s[0:1], 88
  s_mov_b32 s32, s18
  s_mov_b32 s33, s19
  s_mov_b32 s34, 67108864
  s_mov_b32 s35, 0x20000
  s_mov_b32 s36, s18
  s_mov_b32 s37, s19
  s_mov_b32 s38, 67108864
  s_mov_b32 s39, 0x20000
  s_lshl_b32 s23, s60, 2
  s_add_u32 s23, s23, s20
  s_mul_i32 s24, s23, 163840
  s_add_u32 s24, s24, 4194304
  s_add_u32 s61, s24, 163840
  s_mul_i32 s23, s22, 0
  s_add_u32 s24, s24, s23
  s_waitcnt vmcnt(16)
  v_cmp_eq_u32 vcc, 0, v8
  s_cbranch_vccnz fa_wof_spin
fa_wof_ok:
  buffer_load_dwordx4 a[0:3], v2, s[32:35], s24 offen offset:0 sc1
  buffer_load_dwordx4 a[4:7], v2, s[32:35], s24 offen offset:1024 sc1
  buffer_load_dwordx4 a[8:11], v2, s[32:35], s24 offen offset:2048 sc1
  buffer_load_dwordx4 a[12:15], v2, s[32:35], s24 offen offset:3072 sc1
  s_add_u32 s24, s24, 4096
  buffer_load_dwordx4 a[16:19], v2, s[32:35], s24 offen offset:0 sc1
  buffer_load_dwordx4 a[20:23], v2, s[32:35], s24 offen offset:1024 sc1
  buffer_load_dwordx4 a[24:27], v2, s[32:35], s24 offen offset:2048 sc1
  buffer_load_dwordx4 a[28:31], v2, s[32:35], s24 offen offset:3072 sc1
  s_add_u32 s24, s24, 4096
  v_mov_b32 v16, 1073741824
  v_mov_b32 v17, 1
  v_writelane_b32 v16, s80, 0
  v_writelane_b32 v16, s3, 1
  v_and_b32 v10, 15, v1
  v_lshlrev_b32 v10, 2, v10
  v_add_u32 v10, 2629632, v10
  v_min_u32 v11, 53, v1
  v_lshlrev_b32 v11, 2, v11
  v_add_u32 v11, 2650112, v11
  s_waitcnt vmcnt(8)
  buffer_store_dword v17, v16, s[40:43], 0 offen sc1
  buffer_load_dword v15, v10, s[40:43], 0 offen sc1
  buffer_load_dword v14, v11, s[40:43], 0 offen sc1
  buffer_load_dwordx4 a[32:35], v2, s[32:35], s24 offen offset:0 sc1
  buffer_load_dwordx4 a[36:39], v2, s[32:35], s24 offen offset:1024 sc1
  buffer_load_dwordx4 a[40:43], v2, s[32:35], s24 offen offset:2048 sc1
  buffer_load_dwordx4 a[44:47], v2, s[32:35], s24 offen offset:3072 sc1
  s_add_u32 s24, s24, 4096
  buffer_load_dwordx4 a[48:51], v2, s[32:35], s24 offen offset:0 sc1
  buffer_load_dwordx4 a[52:55], v2, s[32:35], s24 offen offset:1024 sc1
  buffer_load_dwordx4 a[56:59], v2, s[32:35], s24 offen offset:2048 sc1
  buffer_load_dwordx4 a[60:63], v2, s[32:35], s24 offen offset:3072 sc1
  s_add_u32 s24, s24, 4096
  buffer_load_dwordx4 a[64:67], v2, s[32:35], s24 offen offset:0 sc1
  buffer_load_dwordx4 a[68:71], v2, s[32:35], s24 offen offset:1024 sc1
  buffer_load_dwordx4 a[72:75], v2, s[32:35], s24 offen offset:2048 sc1
  buffer_load_dwordx4 a[76:79], v2, s[32:35], s24 offen offset:3072 sc1
  s_add_u32 s24, s24, 4096
  s_cmp_ge_u32 s24, s61
  s_cselect_b32 s23, 163840, 0
  s_sub_u32 s24, s24, s23
  buffer_load_dwordx4 a[80:83], v2, s[32:35], s24 offen offset:0 sc1
  buffer_load_dwordx4 a[84:87], v2, s[32:35], s24 offen offset:1024 sc1
  buffer_load_dwordx4 a[88:91], v2, s[32:35], s24 offen offset:2048 sc1
  buffer_load_dwordx4 a[92:95], v2, s[32:35], s24 offen offset:3072 sc1
  s_add_u32 s24, s24, 4096
  buffer_load_dwordx4 a[96:99], v2, s[32:35], s24 offen offset:0 sc1
  buffer_load_dwordx4 a[100:103], v2, s[32:35], s24 offen offset:1024 sc1
  buffer_load_dwordx4 a[104:107], v2, s[32:35], s24 offen offset:2048 sc1
  buffer_load_dwordx4 a[108:111], v2, s[32:35], s24 offen offset:3072 sc1
  s_add_u32 s24, s24, 4096
  s_lshl_b32 s63, s21, 19
  s_lshl_b32 s23, s20, 15
  s_add_u32 s63, s63, s23
  s_add_u32 s63, s63, 50331648
  s_mul_i32 s62, s22, 0
  s_add_u32 s64, s63, s62
  s_add_u32 s65, s64, 131072
  s_add_u32 s66, s64, 262144
  s_add_u32 s67, s64, 393216
  v_bfe_u32 v12, v1, 3, 1
  v_lshlrev_b32 v12, 7, v12
  v_and_b32 v13, 7, v1
  v_lshl_add_u32 v12, v13, 2, v12
  s_lshl_b32 s23, s21, 8
  s_lshl_b32 s31, s20, 5
  s_add_u32 s23, s23, s31
  s_add_u32 s23, s23, 2641920
  v_add_u32 v12, s23, v12
  s_lshl_b32 s25, s21, 6
  s_mul_i32 s26, s60, 160
  s_mul_i32 s27, s60, 2560
  v_add_u32 v16, 0, v0
  v_mul_u32_u24 v17, 6554, v16
  v_lshrrev_b32 v17, 16, v17
  v_mul_u32_u24 v18, 10, v17
  v_sub_u32 v18, v16, v18
  v_mul_u32_u24 v243, 336, v17
  v_lshl_add_u32 v243, v18, 5, v243
  v_lshlrev_b32 v249, 5, v18
  v_add_u32 v17, s25, v17
  v_add_u32 v24, 1, v17
  v_mul_u32_u24 v240, 1280, v17
  v_lshl_add_u32 v240, v18, 4, v240
  v_add_u32 v240, s26, v240
  v_lshrrev_b32 v19, 4, v17
  v_mul_u32_u24 v19, 20480, v19
  v_and_b32 v17, 15, v17
  v_lshl_add_u32 v19, v17, 4, v19
  v_lshl_add_u32 v246, v18, 8, v19
  v_mov_b32 v28, 8
  v_add_u32 v16, 256, v0
  v_mul_u32_u24 v17, 6554, v16
  v_lshrrev_b32 v17, 16, v17
  v_mul_u32_u24 v18, 10, v17
  v_sub_u32 v18, v16, v18
  v_mul_u32_u24 v244, 336, v17
  v_lshl_add_u32 v244, v18, 5, v244
  v_lshlrev_b32 v250, 5, v18
  v_add_u32 v17, s25, v17
  v_add_u32 v25, 1, v17
  v_mul_u32_u24 v241, 1280, v17
  v_lshl_add_u32 v241, v18, 4, v241
  v_add_u32 v241, s26, v241
  v_lshrrev_b32 v19, 4, v17
  v_mul_u32_u24 v19, 20480, v19
  v_and_b32 v17, 15, v17
  v_lshl_add_u32 v19, v17, 4, v19
  v_lshl_add_u32 v247, v18, 8, v19
  v_mov_b32 v29, 8
  v_add_u32 v16, 512, v0
  v_mul_u32_u24 v17, 6554, v16
  v_lshrrev_b32 v17, 16, v17
  v_mul_u32_u24 v18, 10, v17
  v_sub_u32 v18, v16, v18
  v_mul_u32_u24 v245, 336, v17
  v_lshl_add_u32 v245, v18, 5, v245
  v_lshlrev_b32 v251, 5, v18
  v_add_u32 v17, s25, v17
  v_add_u32 v26, 1, v17
  v_mul_u32_u24 v242, 1280, v17
  v_lshl_add_u32 v242, v18, 4, v242
  v_add_u32 v242, s26, v242
  v_lshrrev_b32 v19, 4, v17
  v_mul_u32_u24 v19, 20480, v19
  v_and_b32 v17, 15, v17
  v_lshl_add_u32 v19, v17, 4, v19
  v_lshl_add_u32 v248, v18, 8, v19
  v_mov_b32 v30, 8
  v_cmp_gt_u32 vcc, 128, v0
  v_mov_b32 v16, 1073741824
  v_mov_b32 v17, 0
  v_cndmask_b32 v242, v16, v242, vcc
  v_cndmask_b32 v248, v16, v248, vcc
  v_cndmask_b32 v245, v17, v245, vcc
  v_mov_b32 v20, 0
  v_mov_b32 v21, 0
  v_mov_b32 v22, 0
  v_mov_b32 v23, 0
  v_add_u32 v16, 133632, v2
  ds_write_b128 v16, v[20:23]
  s_waitcnt vmcnt(20) lgkmcnt(0)
  s_mov_b32 s44, s4
  s_mov_b32 s45, s5
  s_mov_b32 s46, 2621440
  s_mov_b32 s47, 0x20000
  s_mov_b32 s48, s6
  s_mov_b32 s49, s7
  s_mov_b32 s50, 2621440
  s_mov_b32 s51, 0x20000
  v_cmp_eq_u32 vcc, 0, v15
  s_cbranch_vccnz fa_sel4_spin
fa_sel4_ok:
  v_readlane_b32 s68, v15, 0
  v_readlane_b32 s69, v15, 1
  v_readlane_b32 s70, v15, 2
  v_readlane_b32 s71, v15, 3
  v_readlane_b32 s72, v15, 4
  v_readlane_b32 s73, v15, 5
  v_readlane_b32 s74, v15, 6
  v_readlane_b32 s75, v15, 7
  s_lshl_b32 s23, s20, 1
  s_add_u32 s31, s23, 8
  v_readlane_b32 s29, v15, s23
  v_readlane_b32 s30, v15, s31
  v_cmp_eq_u32 s[8:9], s68, v24
  v_cmp_eq_u32 s[10:11], s68, v25
  v_cmp_eq_u32 s[12:13], s68, v26
  v_cndmask_b32 v28, v28, 0, s[8:9]
  v_cndmask_b32 v29, v29, 0, s[10:11]
  v_cndmask_b32 v30, v30, 0, s[12:13]
  v_cmp_eq_u32 s[8:9], s69, v24
  v_cmp_eq_u32 s[10:11], s69, v25
  v_cmp_eq_u32 s[12:13], s69, v26
  v_cndmask_b32 v28, v28, 1, s[8:9]
  v_cndmask_b32 v29, v29, 1, s[10:11]
  v_cndmask_b32 v30, v30, 1, s[12:13]
  v_cmp_eq_u32 s[8:9], s70, v24
  v_cmp_eq_u32 s[10:11], s70, v25
  v_cmp_eq_u32 s[12:13], s70, v26
  v_cndmask_b32 v28, v28, 2, s[8:9]
  v_cndmask_b32 v29, v29, 2, s[10:11]
  v_cndmask_b32 v30, v30, 2, s[12:13]
  v_cmp_eq_u32 s[8:9], s71, v24
  v_cmp_eq_u32 s[10:11], s71, v25
  v_cmp_eq_u32 s[12:13], s71, v26
  v_cndmask_b32 v28, v28, 3, s[8:9]
  v_cndmask_b32 v29, v29, 3, s[10:11]
  v_cndmask_b32 v30, v30, 3, s[12:13]
  v_cmp_eq_u32 s[8:9], s72, v24
  v_cmp_eq_u32 s[10:11], s72, v25
  v_cmp_eq_u32 s[12:13], s72, v26
  v_cndmask_b32 v28, v28, 4, s[8:9]
  v_cndmask_b32 v29, v29, 4, s[10:11]
  v_cndmask_b32 v30, v30, 4, s[12:13]
  v_cmp_eq_u32 s[8:9], s73, v24
  v_cmp_eq_u32 s[10:11], s73, v25
  v_cmp_eq_u32 s[12:13], s73, v26
  v_cndmask_b32 v28, v28, 5, s[8:9]
  v_cndmask_b32 v29, v29, 5, s[10:11]
  v_cndmask_b32 v30, v30, 5, s[12:13]
  v_cmp_eq_u32 s[8:9], s74, v24
  v_cmp_eq_u32 s[10:11], s74, v25
  v_cmp_eq_u32 s[12:13], s74, v26
  v_cndmask_b32 v28, v28, 6, s[8:9]
  v_cndmask_b32 v29, v29, 6, s[10:11]
  v_cndmask_b32 v30, v30, 6, s[12:13]
  v_cmp_eq_u32 s[8:9], s75, v24
  v_cmp_eq_u32 s[10:11], s75, v25
  v_cmp_eq_u32 s[12:13], s75, v26
  v_cndmask_b32 v28, v28, 7, s[8:9]
  v_cndmask_b32 v29, v29, 7, s[10:11]
  v_cndmask_b32 v30, v30, 7, s[12:13]
  v_mul_u32_u24 v28, 320, v28
  v_add3_u32 v249, v249, v28, v17
  v_mul_u32_u24 v29, 320, v29
  v_add3_u32 v250, v250, v29, v17
  v_mul_u32_u24 v30, 320, v30
  v_add3_u32 v251, v251, v30, v17
  v_add_u32 v249, 131072, v249
  v_add_u32 v250, 131072, v250
  v_add_u32 v251, 131072, v251
  s_sub_u32 s29, s29, s25
  s_sub_u32 s29, s29, 1
  s_cmp_lt_u32 s29, 64
  s_cbranch_scc1 fa_ystub0
fa_yback0:
  s_add_u32 s23, s23, 1
  s_add_u32 s31, s23, 8
  v_readlane_b32 s29, v15, s23
  v_readlane_b32 s30, v15, s31
  s_sub_u32 s29, s29, s25
  s_sub_u32 s29, s29, 1
  s_cmp_lt_u32 s29, 64
  s_cbranch_scc1 fa_ystub1
fa_yback1:
  buffer_load_dwordx4 a[112:115], v2, s[32:35], s24 offen offset:0 sc1
  buffer_load_dwordx4 a[116:119], v2, s[32:35], s24 offen offset:1024 sc1
  buffer_load_dwordx4 a[120:123], v2, s[32:35], s24 offen offset:2048 sc1
  buffer_load_dwordx4 a[124:127], v2, s[32:35], s24 offen offset:3072 sc1
  s_add_u32 s24, s24, 4096
  buffer_load_dwordx4 a[128:131], v2, s[32:35], s24 offen offset:0 sc1
  buffer_load_dwordx4 a[132:135], v2, s[32:35], s24 offen offset:1024 sc1
  buffer_load_dwordx4 a[136:139], v2, s[32:35], s24 offen offset:2048 sc1
  buffer_load_dwordx4 a[140:143], v2, s[32:35], s24 offen offset:3072 sc1
  s_add_u32 s24, s24, 4096
  buffer_load_dwordx4 a[144:147], v2, s[32:35], s24 offen offset:0 sc1
  buffer_load_dwordx4 a[148:151], v2, s[32:35], s24 offen offset:1024 sc1
  buffer_load_dwordx4 a[152:155], v2, s[32:35], s24 offen offset:2048 sc1
  buffer_load_dwordx4 a[156:159], v2, s[32:35], s24 offen offset:3072 sc1
  s_add_u32 s24, s24, 4096
  s_cmp_ge_u32 s24, s61
  s_cselect_b32 s23, 163840, 0
  s_sub_u32 s24, s24, s23
  buffer_load_dwordx4 a[160:163], v2, s[32:35], s24 offen offset:0 sc1
  buffer_load_dwordx4 a[164:167], v2, s[32:35], s24 offen offset:1024 sc1
  buffer_load_dwordx4 a[168:171], v2, s[32:35], s24 offen offset:2048 sc1
  buffer_load_dwordx4 a[172:175], v2, s[32:35], s24 offen offset:3072 sc1
  s_add_u32 s24, s24, 4096
  buffer_load_dwordx4 a[176:179], v2, s[32:35], s24 offen offset:0 sc1
  buffer_load_dwordx4 a[180:183], v2, s[32:35], s24 offen offset:1024 sc1
  buffer_load_dwordx4 a[184:187], v2, s[32:35], s24 offen offset:2048 sc1
  buffer_load_dwordx4 a[188:191], v2, s[32:35], s24 offen offset:3072 sc1
  s_add_u32 s24, s24, 4096
  buffer_load_dwordx4 a[192:195], v2, s[32:35], s24 offen offset:0 sc1
  buffer_load_dwordx4 a[196:199], v2, s[32:35], s24 offen offset:1024 sc1
  buffer_load_dwordx4 a[200:203], v2, s[32:35], s24 offen offset:2048 sc1
  buffer_load_dwordx4 a[204:207], v2, s[32:35], s24 offen offset:3072 sc1
  s_add_u32 s24, s24, 4096
  buffer_load_dwordx4 a[208:211], v2, s[32:35], s24 offen offset:0 sc1
  buffer_load_dwordx4 a[212:215], v2, s[32:35], s24 offen offset:1024 sc1
  buffer_load_dwordx4 a[216:219], v2, s[32:35], s24 offen offset:2048 sc1
  buffer_load_dwordx4 a[220:223], v2, s[32:35], s24 offen offset:3072 sc1
  s_add_u32 s24, s24, 4096
  buffer_load_dwordx4 a[224:227], v2, s[32:35], s24 offen offset:0 sc1
  buffer_load_dwordx4 a[228:231], v2, s[32:35], s24 offen offset:1024 sc1
  buffer_load_dwordx4 a[232:235], v2, s[32:35], s24 offen offset:2048 sc1
  buffer_load_dwordx4 a[236:239], v2, s[32:35], s24 offen offset:3072 sc1
  s_add_u32 s24, s24, 4096
  s_cmp_ge_u32 s24, s61
  s_cselect_b32 s23, 163840, 0
  s_sub_u32 s24, s24, s23
  buffer_load_dwordx4 a[240:243], v2, s[32:35], s24 offen offset:0 sc1
  buffer_load_dwordx4 a[244:247], v2, s[32:35], s24 offen offset:1024 sc1
  buffer_load_dwordx4 a[248:251], v2, s[32:35], s24 offen offset:2048 sc1
  buffer_load_dwordx4 a[252:255], v2, s[32:35], s24 offen offset:3072 sc1
  s_add_u32 s24, s24, 4096
  buffer_load_dwordx4 v[176:179], v2, s[32:35], s24 offen offset:0 sc1
  buffer_load_dwordx4 v[180:183], v2, s[32:35], s24 offen offset:1024 sc1
  buffer_load_dwordx4 v[184:187], v2, s[32:35], s24 offen offset:2048 sc1
  buffer_load_dwordx4 v[188:191], v2, s[32:35], s24 offen offset:3072 sc1
  s_add_u32 s24, s24, 4096
  buffer_load_dwordx4 v[192:195], v2, s[32:35], s24 offen offset:0 sc1
  buffer_load_dwordx4 v[196:199], v2, s[32:35], s24 offen offset:1024 sc1
  buffer_load_dwordx4 v[200:203], v2, s[32:35], s24 offen offset:2048 sc1
  buffer_load_dwordx4 v[204:207], v2, s[32:35], s24 offen offset:3072 sc1
  s_add_u32 s24, s24, 4096
  buffer_load_dwordx4 v[208:211], v2, s[32:35], s24 offen offset:0 sc1
  buffer_load_dwordx4 v[212:215], v2, s[32:35], s24 offen offset:1024 sc1
  buffer_load_dwordx4 v[216:219], v2, s[32:35], s24 offen offset:2048 sc1
  buffer_load_dwordx4 v[220:223], v2, s[32:35], s24 offen offset:3072 sc1
  s_add_u32 s24, s24, 4096
  buffer_load_dwordx4 v[224:227], v2, s[32:35], s24 offen offset:0 sc1
  buffer_load_dwordx4 v[228:231], v2, s[32:35], s24 offen offset:1024 sc1
  buffer_load_dwordx4 v[232:235], v2, s[32:35], s24 offen offset:2048 sc1
  buffer_load_dwordx4 v[236:239], v2, s[32:35], s24 offen offset:3072 sc1
  s_add_u32 s24, s24, 4096
  s_cmp_ge_u32 s24, s61
  s_cselect_b32 s23, 163840, 0
  s_sub_u32 s24, s24, s23
  buffer_load_dword v13, v12, s[40:43], 0 offen sc1
  v_mfma_f32_32x32x16_bf16 v[32:47], v[20:23], v[20:23], 0
  v_mfma_f32_32x32x16_bf16 v[48:63], v[20:23], v[20:23], 0
  v_mfma_f32_32x32x16_bf16 v[64:79], v[20:23], v[20:23], 0
  v_mfma_f32_32x32x16_bf16 v[80:95], v[20:23], v[20:23], 0
  v_mfma_f32_32x32x16_bf16 v[96:111], v[20:23], v[20:23], 0
  s_mov_b32 s28, 0
  s_waitcnt vmcnt(0)
  v_cmp_eq_u32 vcc, 0, v13
  s_cbranch_vccnz fa_ctx_spin
fa_ctx_ok:
  buffer_load_dwordx4 v[112:115], v2, s[36:39], s64 offen offset:0 sc1
  buffer_load_dwordx4 v[116:119], v2, s[36:39], s65 offen offset:0 sc1
  buffer_load_dwordx4 v[120:123], v2, s[36:39], s66 offen offset:0 sc1
  buffer_load_dwordx4 v[124:127], v2, s[36:39], s67 offen offset:0 sc1
  buffer_load_dwordx4 v[128:131], v2, s[36:39], s64 offen offset:1024 sc1
  buffer_load_dwordx4 v[132:135], v2, s[36:39], s65 offen offset:1024 sc1
  buffer_load_dwordx4 v[136:139], v2, s[36:39], s66 offen offset:1024 sc1
  buffer_load_dwordx4 v[140:143], v2, s[36:39], s67 offen offset:1024 sc1
  buffer_load_dwordx4 v[144:147], v2, s[36:39], s64 offen offset:2048 sc1
  buffer_load_dwordx4 v[148:151], v2, s[36:39], s65 offen offset:2048 sc1
  buffer_load_dwordx4 v[152:155], v2, s[36:39], s66 offen offset:2048 sc1
  buffer_load_dwordx4 v[156:159], v2, s[36:39], s67 offen offset:2048 sc1
  buffer_load_dwordx4 v[160:163], v2, s[36:39], s64 offen offset:3072 sc1
  buffer_load_dwordx4 v[164:167], v2, s[36:39], s65 offen offset:3072 sc1
  buffer_load_dwordx4 v[168:171], v2, s[36:39], s66 offen offset:3072 sc1
  buffer_load_dwordx4 v[172:175], v2, s[36:39], s67 offen offset:3072 sc1
  s_add_u32 s62, s62, 4096
  s_and_b32 s62, s62, 0x7fff
  s_add_u32 s64, s63, s62
  s_add_u32 s65, s64, 131072
  s_add_u32 s66, s64, 262144
  s_add_u32 s67, s64, 393216
  s_waitcnt vmcnt(12)
  v_mfma_f32_16x16x32_bf16 v[32:35], a[0:3], v[112:115], v[32:35]
  v_mfma_f32_16x16x32_bf16 v[36:39], a[0:3], v[116:119], v[36:39]
  v_mfma_f32_16x16x32_bf16 v[40:43], a[0:3], v[120:123], v[40:43]
  v_mfma_f32_16x16x32_bf16 v[44:47], a[0:3], v[124:127], v[44:47]
  buffer_load_dwordx4 a[0:3], v2, s[32:35], s24 offen offset:0 sc1
  v_mfma_f32_16x16x32_bf16 v[48:51], a[4:7], v[112:115], v[48:51]
  v_mfma_f32_16x16x32_bf16 v[52:55], a[4:7], v[116:119], v[52:55]
  v_mfma_f32_16x16x32_bf16 v[56:59], a[4:7], v[120:123], v[56:59]
  v_mfma_f32_16x16x32_bf16 v[60:63], a[4:7], v[124:127], v[60:63]
  buffer_load_dwordx4 a[4:7], v2, s[32:35], s24 offen offset:1024 sc1
  v_mfma_f32_16x16x32_bf16 v[64:67], a[8:11], v[112:115], v[64:67]
  v_mfma_f32_16x16x32_bf16 v[68:71], a[8:11], v[116:119], v[68:71]
  v_mfma_f32_16x16x32_bf16 v[72:75], a[8:11], v[120:123], v[72:75]
  v_mfma_f32_16x16x32_bf16 v[76:79], a[8:11], v[124:127], v[76:79]
  buffer_load_dwordx4 a[8:11], v2, s[32:35], s24 offen offset:2048 sc1
  v_mfma_f32_16x16x32_bf16 v[80:83], a[12:15], v[112:115], v[80:83]
  v_mfma_f32_16x16x32_bf16 v[84:87], a[12:15], v[116:119], v[84:87]
  v_mfma_f32_16x16x32_bf16 v[88:91], a[12:15], v[120:123], v[88:91]
  v_mfma_f32_16x16x32_bf16 v[92:95], a[12:15], v[124:127], v[92:95]
  v_mfma_f32_16x16x32_bf16 v[96:99], a[16:19], v[112:115], v[96:99]
  buffer_load_dwordx4 v[112:115], v2, s[36:39], s64 offen offset:0 sc1
  v_mfma_f32_16x16x32_bf16 v[100:103], a[16:19], v[116:119], v[100:103]
  buffer_load_dwordx4 v[116:119], v2, s[36:39], s65 offen offset:0 sc1
  v_mfma_f32_16x16x32_bf16 v[104:107], a[16:19], v[120:123], v[104:107]
  buffer_load_dwordx4 v[120:123], v2, s[36:39], s66 offen offset:0 sc1
  v_mfma_f32_16x16x32_bf16 v[108:111], a[16:19], v[124:127], v[108:111]
  buffer_load_dwordx4 v[124:127], v2, s[36:39], s67 offen offset:0 sc1
  s_waitcnt vmcnt(15)
  v_mfma_f32_16x16x32_bf16 v[32:35], a[20:23], v[128:131], v[32:35]
  v_mfma_f32_16x16x32_bf16 v[36:39], a[20:23], v[132:135], v[36:39]
  v_mfma_f32_16x16x32_bf16 v[40:43], a[20:23], v[136:139], v[40:43]
  v_mfma_f32_16x16x32_bf16 v[44:47], a[20:23], v[140:143], v[44:47]
  buffer_load_dwordx4 a[12:15], v2, s[32:35], s24 offen offset:3072 sc1
  v_mfma_f32_16x16x32_bf16 v[48:51], a[24:27], v[128:131], v[48:51]
  s_add_u32 s24, s24, 4096
  v_mfma_f32_16x16x32_bf16 v[52:55], a[24:27], v[132:135], v[52:55]
  v_mfma_f32_16x16x32_bf16 v[56:59], a[24:27], v[136:139], v[56:59]
  v_mfma_f32_16x16x32_bf16 v[60:63], a[24:27], v[140:143], v[60:63]
  buffer_load_dwordx4 a[16:19], v2, s[32:35], s24 offen offset:0 sc1
  v_mfma_f32_16x16x32_bf16 v[64:67], a[28:31], v[128:131], v[64:67]
  v_mfma_f32_16x16x32_bf16 v[68:71], a[28:31], v[132:135], v[68:71]
  v_mfma_f32_16x16x32_bf16 v[72:75], a[28:31], v[136:139], v[72:75]
  v_mfma_f32_16x16x32_bf16 v[76:79], a[28:31], v[140:143], v[76:79]
  buffer_load_dwordx4 a[20:23], v2, s[32:35], s24 offen offset:1024 sc1
  v_mfma_f32_16x16x32_bf16 v[80:83], a[32:35], v[128:131], v[80:83]
  v_mfma_f32_16x16x32_bf16 v[84:87], a[32:35], v[132:135], v[84:87]
  v_mfma_f32_16x16x32_bf16 v[88:91], a[32:35], v[136:139], v[88:91]
  v_mfma_f32_16x16x32_bf16 v[92:95], a[32:35], v[140:143], v[92:95]
  v_mfma_f32_16x16x32_bf16 v[96:99], a[36:39], v[128:131], v[96:99]
  buffer_load_dwordx4 v[128:131], v2, s[36:39], s64 offen offset:1024 sc1
  v_mfma_f32_16x16x32_bf16 v[100:103], a[36:39], v[132:135], v[100:103]
  buffer_load_dwordx4 v[132:135], v2, s[36:39], s65 offen offset:1024 sc1
  v_mfma_f32_16x16x32_bf16 v[104:107], a[36:39], v[136:139], v[104:107]
  buffer_load_dwordx4 v[136:139], v2, s[36:39], s66 offen offset:1024 sc1
  v_mfma_f32_16x16x32_bf16 v[108:111], a[36:39], v[140:143], v[108:111]
  buffer_load_dwordx4 v[140:143], v2, s[36:39], s67 offen offset:1024 sc1
  s_waitcnt vmcnt(18)
  v_mfma_f32_16x16x32_bf16 v[32:35], a[40:43], v[144:147], v[32:35]
  v_mfma_f32_16x16x32_bf16 v[36:39], a[40:43], v[148:151], v[36:39]
  v_mfma_f32_16x16x32_bf16 v[40:43], a[40:43], v[152:155], v[40:43]
  v_mfma_f32_16x16x32_bf16 v[44:47], a[40:43], v[156:159], v[44:47]
  buffer_load_dwordx4 a[24:27], v2, s[32:35], s24 offen offset:2048 sc1
  v_mfma_f32_16x16x32_bf16 v[48:51], a[44:47], v[144:147], v[48:51]
  v_mfma_f32_16x16x32_bf16 v[52:55], a[44:47], v[148:151], v[52:55]
  v_mfma_f32_16x16x32_bf16 v[56:59], a[44:47], v[152:155], v[56:59]
  v_mfma_f32_16x16x32_bf16 v[60:63], a[44:47], v[156:159], v[60:63]
  buffer_load_dwordx4 a[28:31], v2, s[32:35], s24 offen offset:3072 sc1
  v_mfma_f32_16x16x32_bf16 v[64:67], a[48:51], v[144:147], v[64:67]
  s_add_u32 s24, s24, 4096
  v_mfma_f32_16x16x32_bf16 v[68:71], a[48:51], v[148:151], v[68:71]
  v_mfma_f32_16x16x32_bf16 v[72:75], a[48:51], v[152:155], v[72:75]
  v_mfma_f32_16x16x32_bf16 v[76:79], a[48:51], v[156:159], v[76:79]
  buffer_load_dwordx4 a[32:35], v2, s[32:35], s24 offen offset:0 sc1
  v_mfma_f32_16x16x32_bf16 v[80:83], a[52:55], v[144:147], v[80:83]
  v_mfma_f32_16x16x32_bf16 v[84:87], a[52:55], v[148:151], v[84:87]
  v_mfma_f32_16x16x32_bf16 v[88:91], a[52:55], v[152:155], v[88:91]
  v_mfma_f32_16x16x32_bf16 v[92:95], a[52:55], v[156:159], v[92:95]
  v_mfma_f32_16x16x32_bf16 v[96:99], a[56:59], v[144:147], v[96:99]
  buffer_load_dwordx4 v[144:147], v2, s[36:39], s64 offen offset:2048 sc1
  v_mfma_f32_16x16x32_bf16 v[100:103], a[56:59], v[148:151], v[100:103]
  buffer_load_dwordx4 v[148:151], v2, s[36:39], s65 offen offset:2048 sc1
  v_mfma_f32_16x16x32_bf16 v[104:107], a[56:59], v[152:155], v[104:107]
  buffer_load_dwordx4 v[152:155], v2, s[36:39], s66 offen offset:2048 sc1
  v_mfma_f32_16x16x32_bf16 v[108:111], a[56:59], v[156:159], v[108:111]
  buffer_load_dwordx4 v[156:159], v2, s[36:39], s67 offen offset:2048 sc1
  s_waitcnt vmcnt(21)
  v_mfma_f32_16x16x32_bf16 v[32:35], a[60:63], v[160:163], v[32:35]
  v_mfma_f32_16x16x32_bf16 v[36:39], a[60:63], v[164:167], v[36:39]
  v_mfma_f32_16x16x32_bf16 v[40:43], a[60:63], v[168:171], v[40:43]
  v_mfma_f32_16x16x32_bf16 v[44:47], a[60:63], v[172:175], v[44:47]
  buffer_load_dwordx4 a[36:39], v2, s[32:35], s24 offen offset:1024 sc1
  v_mfma_f32_16x16x32_bf16 v[48:51], a[64:67], v[160:163], v[48:51]
  v_mfma_f32_16x16x32_bf16 v[52:55], a[64:67], v[164:167], v[52:55]
  v_mfma_f32_16x16x32_bf16 v[56:59], a[64:67], v[168:171], v[56:59]
  v_mfma_f32_16x16x32_bf16 v[60:63], a[64:67], v[172:175], v[60:63]
  buffer_load_dwordx4 a[40:43], v2, s[32:35], s24 offen offset:2048 sc1
  v_mfma_f32_16x16x32_bf16 v[64:67], a[68:71], v[160:163], v[64:67]
  v_mfma_f32_16x16x32_bf16 v[68:71], a[68:71], v[164:167], v[68:71]
  v_mfma_f32_16x16x32_bf16 v[72:75], a[68:71], v[168:171], v[72:75]
  v_mfma_f32_16x16x32_bf16 v[76:79], a[68:71], v[172:175], v[76:79]
  buffer_load_dwordx4 a[44:47], v2, s[32:35], s24 offen offset:3072 sc1
  v_mfma_f32_16x16x32_bf16 v[80:83], a[72:75], v[160:163], v[80:83]
  s_add_u32 s24, s24, 4096
  v_mfma_f32_16x16x32_bf16 v[84:87], a[72:75], v[164:167], v[84:87]
  v_mfma_f32_16x16x32_bf16 v[88:91], a[72:75], v[168:171], v[88:91]
  v_mfma_f32_16x16x32_bf16 v[92:95], a[72:75], v[172:175], v[92:95]
  v_mfma_f32_16x16x32_bf16 v[96:99], a[76:79], v[160:163], v[96:99]
  buffer_load_dwordx4 v[160:163], v2, s[36:39], s64 offen offset:3072 sc1
  v_mfma_f32_16x16x32_bf16 v[100:103], a[76:79], v[164:167], v[100:103]
  buffer_load_dwordx4 v[164:167], v2, s[36:39], s65 offen offset:3072 sc1
  v_mfma_f32_16x16x32_bf16 v[104:107], a[76:79], v[168:171], v[104:107]
  buffer_load_dwordx4 v[168:171], v2, s[36:39], s66 offen offset:3072 sc1
  v_mfma_f32_16x16x32_bf16 v[108:111], a[76:79], v[172:175], v[108:111]
  buffer_load_dwordx4 v[172:175], v2, s[36:39], s67 offen offset:3072 sc1
  s_waitcnt vmcnt(21)
  v_mfma_f32_16x16x32_bf16 v[32:35], a[80:83], v[112:115], v[32:35]
  s_add_u32 s62, s62, 4096
  v_mfma_f32_16x16x32_bf16 v[36:39], a[80:83], v[116:119], v[36:39]
  s_and_b32 s62, s62, 0x7fff
  v_mfma_f32_16x16x32_bf16 v[40:43], a[80:83], v[120:123], v[40:43]
  s_add_u32 s64, s63, s62
  v_mfma_f32_16x16x32_bf16 v[44:47], a[80:83], v[124:127], v[44:47]
  buffer_load_dwordx4 a[48:51], v2, s[32:35], s24 offen offset:0 sc1
  v_mfma_f32_16x16x32_bf16 v[48:51], a[84:87], v[112:115], v[48:51]
  v_mfma_f32_16x16x32_bf16 v[52:55], a[84:87], v[116:119], v[52:55]
  v_mfma_f32_16x16x32_bf16 v[56:59], a[84:87], v[120:123], v[56:59]
  s_add_u32 s65, s64, 131072
  v_mfma_f32_16x16x32_bf16 v[60:63], a[84:87], v[124:127], v[60:63]
  buffer_load_dwordx4 a[52:55], v2, s[32:35], s24 offen offset:1024 sc1
  v_mfma_f32_16x16x32_bf16 v[64:67], a[88:91], v[112:115], v[64:67]
  v_mfma_f32_16x16x32_bf16 v[68:71], a[88:91], v[116:119], v[68:71]
  v_mfma_f32_16x16x32_bf16 v[72:75], a[88:91], v[120:123], v[72:75]
  s_add_u32 s66, s64, 262144
  v_mfma_f32_16x16x32_bf16 v[76:79], a[88:91], v[124:127], v[76:79]
  buffer_load_dwordx4 a[56:59], v2, s[32:35], s24 offen offset:2048 sc1
  v_mfma_f32_16x16x32_bf16 v[80:83], a[92:95], v[112:115], v[80:83]
  v_mfma_f32_16x16x32_bf16 v[84:87], a[92:95], v[116:119], v[84:87]
  v_mfma_f32_16x16x32_bf16 v[88:91], a[92:95], v[120:123], v[88:91]
  s_add_u32 s67, s64, 393216
  v_mfma_f32_16x16x32_bf16 v[92:95], a[92:95], v[124:127], v[92:95]
  v_mfma_f32_16x16x32_bf16 v[96:99], a[96:99], v[112:115], v[96:99]
  buffer_load_dwordx4 v[112:115], v2, s[36:39], s64 offen offset:0 sc1
  v_mfma_f32_16x16x32_bf16 v[100:103], a[96:99], v[116:119], v[100:103]
  buffer_load_dwordx4 v[116:119], v2, s[36:39], s65 offen offset:0 sc1
  v_mfma_f32_16x16x32_bf16 v[104:107], a[96:99], v[120:123], v[104:107]
  buffer_load_dwordx4 v[120:123], v2, s[36:39], s66 offen offset:0 sc1
  v_mfma_f32_16x16x32_bf16 v[108:111], a[96:99], v[124:127], v[108:111]
  buffer_load_dwordx4 v[124:127], v2, s[36:39], s67 offen offset:0 sc1
  s_waitcnt vmcnt(21)
  v_mfma_f32_16x16x32_bf16 v[32:35], a[100:103], v[128:131], v[32:35]
  v_mfma_f32_16x16x32_bf16 v[36:39], a[100:103], v[132:135], v[36:39]
  v_mfma_f32_16x16x32_bf16 v[40:43], a[100:103], v[136:139], v[40:43]
  v_mfma_f32_16x16x32_bf16 v[44:47], a[100:103], v[140:143], v[44:47]
  buffer_load_dwordx4 a[60:63], v2, s[32:35], s24 offen offset:3072 sc1
  v_mfma_f32_16x16x32_bf16 v[48:51], a[104:107], v[128:131], v[48:51]
  s_add_u32 s24, s24, 4096
  v_mfma_f32_16x16x32_bf16 v[52:55], a[104:107], v[132:135], v[52:55]
  v_mfma_f32_16x16x32_bf16 v[56:59], a[104:107], v[136:139], v[56:59]
  v_mfma_f32_16x16x32_bf16 v[60:63], a[104:107], v[140:143], v[60:63]
  buffer_load_dwordx4 a[64:67], v2, s[32:35], s24 offen offset:0 sc1
  v_mfma_f32_16x16x32_bf16 v[64:67], a[108:111], v[128:131], v[64:67]
  v_mfma_f32_16x16x32_bf16 v[68:71], a[108:111], v[132:135], v[68:71]
  v_mfma_f32_16x16x32_bf16 v[72:75], a[108:111], v[136:139], v[72:75]
  v_mfma_f32_16x16x32_bf16 v[76:79], a[108:111], v[140:143], v[76:79]
  buffer_load_dwordx4 a[68:71], v2, s[32:35], s24 offen offset:1024 sc1
  v_mfma_f32_16x16x32_bf16 v[80:83], a[112:115], v[128:131], v[80:83]
  v_mfma_f32_16x16x32_bf16 v[84:87], a[112:115], v[132:135], v[84:87]
  v_mfma_f32_16x16x32_bf16 v[88:91], a[112:115], v[136:139], v[88:91]
  v_mfma_f32_16x16x32_bf16 v[92:95], a[112:115], v[140:143], v[92:95]
  v_mfma_f32_16x16x32_bf16 v[96:99], a[116:119], v[128:131], v[96:99]
  buffer_load_dwordx4 v[128:131], v2, s[36:39], s64 offen offset:1024 sc1
  v_mfma_f32_16x16x32_bf16 v[100:103], a[116:119], v[132:135], v[100:103]
  buffer_load_dwordx4 v[132:135], v2, s[36:39], s65 offen offset:1024 sc1
  v_mfma_f32_16x16x32_bf16 v[104:107], a[116:119], v[136:139], v[104:107]
  buffer_load_dwordx4 v[136:139], v2, s[36:39], s66 offen offset:1024 sc1
  v_mfma_f32_16x16x32_bf16 v[108:111], a[116:119], v[140:143], v[108:111]
  buffer_load_dwordx4 v[140:143], v2, s[36:39], s67 offen offset:1024 sc1
  s_waitcnt vmcnt(21)
  v_mfma_f32_16x16x32_bf16 v[32:35], a[120:123], v[144:147], v[32:35]
  v_mfma_f32_16x16x32_bf16 v[36:39], a[120:123], v[148:151], v[36:39]
  v_mfma_f32_16x16x32_bf16 v[40:43], a[120:123], v[152:155], v[40:43]
  v_mfma_f32_16x16x32_bf16 v[44:47], a[120:123], v[156:159], v[44:47]
  buffer_load_dwordx4 a[72:75], v2, s[32:35], s24 offen offset:2048 sc1
  v_mfma_f32_16x16x32_bf16 v[48:51], a[124:127], v[144:147], v[48:51]
  v_mfma_f32_16x16x32_bf16 v[52:55], a[124:127], v[148:151], v[52:55]
  v_mfma_f32_16x16x32_bf16 v[56:59], a[124:127], v[152:155], v[56:59]
  v_mfma_f32_16x16x32_bf16 v[60:63], a[124:127], v[156:159], v[60:63]
  buffer_load_dwordx4 a[76:79], v2, s[32:35], s24 offen offset:3072 sc1
  v_mfma_f32_16x16x32_bf16 v[64:67], a[128:131], v[144:147], v[64:67]
  s_add_u32 s24, s24, 4096
  v_mfma_f32_16x16x32_bf16 v[68:71], a[128:131], v[148:151], v[68:71]
  s_cmp_ge_u32 s24, s61
  s_cselect_b32 s23, 163840, 0
  s_sub_u32 s24, s24, s23
  v_mfma_f32_16x16x32_bf16 v[72:75], a[128:131], v[152:155], v[72:75]
  v_mfma_f32_16x16x32_bf16 v[76:79], a[128:131], v[156:159], v[76:79]
  buffer_load_dwordx4 a[80:83], v2, s[32:35], s24 offen offset:0 sc1
  v_mfma_f32_16x16x32_bf16 v[80:83], a[132:135], v[144:147], v[80:83]
  v_mfma_f32_16x16x32_bf16 v[84:87], a[132:135], v[148:151], v[84:87]
  v_mfma_f32_16x16x32_bf16 v[88:91], a[132:135], v[152:155], v[88:91]
  v_mfma_f32_16x16x32_bf16 v[92:95], a[132:135], v[156:159], v[92:95]
  v_mfma_f32_16x16x32_bf16 v[96:99], a[136:139], v[144:147], v[96:99]
  buffer_load_dwordx4 v[144:147], v2, s[36:39], s64 offen offset:2048 sc1
  v_mfma_f32_16x16x32_bf16 v[100:103], a[136:139], v[148:151], v[100:103]
  buffer_load_dwordx4 v[148:151], v2, s[36:39], s65 offen offset:2048 sc1
  v_mfma_f32_16x16x32_bf16 v[104:107], a[136:139], v[152:155], v[104:107]
  buffer_load_dwordx4 v[152:155], v2, s[36:39], s66 offen offset:2048 sc1
  v_mfma_f32_16x16x32_bf16 v[108:111], a[136:139], v[156:159], v[108:111]
  buffer_load_dwordx4 v[156:159], v2, s[36:39], s67 offen offset:2048 sc1
  s_waitcnt vmcnt(21)
  v_mfma_f32_16x16x32_bf16 v[32:35], a[140:143], v[160:163], v[32:35]
  v_mfma_f32_16x16x32_bf16 v[36:39], a[140:143], v[164:167], v[36:39]
  v_mfma_f32_16x16x32_bf16 v[40:43], a[140:143], v[168:171], v[40:43]
  v_mfma_f32_16x16x32_bf16 v[44:47], a[140:143], v[172:175], v[44:47]
  buffer_load_dwordx4 a[84:87], v2, s[32:35], s24 offen offset:1024 sc1
  v_mfma_f32_16x16x32_bf16 v[48:51], a[144:147], v[160:163], v[48:51]
  v_mfma_f32_16x16x32_bf16 v[52:55], a[144:147], v[164:167], v[52:55]
  v_mfma_f32_16x16x32_bf16 v[56:59], a[144:147], v[168:171], v[56:59]
  v_mfma_f32_16x16x32_bf16 v[60:63], a[144:147], v[172:175], v[60:63]
  buffer_load_dwordx4 a[88:91], v2, s[32:35], s24 offen offset:2048 sc1
  v_mfma_f32_16x16x32_bf16 v[64:67], a[148:151], v[160:163], v[64:67]
  v_mfma_f32_16x16x32_bf16 v[68:71], a[148:151], v[164:167], v[68:71]
  v_mfma_f32_16x16x32_bf16 v[72:75], a[148:151], v[168:171], v[72:75]
  v_mfma_f32_16x16x32_bf16 v[76:79], a[148:151], v[172:175], v[76:79]
  buffer_load_dwordx4 a[92:95], v2, s[32:35], s24 offen offset:3072 sc1
  v_mfma_f32_16x16x32_bf16 v[80:83], a[152:155], v[160:163], v[80:83]
  s_add_u32 s24, s24, 4096
  v_mfma_f32_16x16x32_bf16 v[84:87], a[152:155], v[164:167], v[84:87]
  v_mfma_f32_16x16x32_bf16 v[88:91], a[152:155], v[168:171], v[88:91]
  v_mfma_f32_16x16x32_bf16 v[92:95], a[152:155], v[172:175], v[92:95]
  v_mfma_f32_16x16x32_bf16 v[96:99], a[156:159], v[160:163], v[96:99]
  buffer_load_dwordx4 v[160:163], v2, s[36:39], s64 offen offset:3072 sc1
  v_mfma_f32_16x16x32_bf16 v[100:103], a[156:159], v[164:167], v[100:103]
  buffer_load_dwordx4 v[164:167], v2, s[36:39], s65 offen offset:3072 sc1
  v_mfma_f32_16x16x32_bf16 v[104:107], a[156:159], v[168:171], v[104:107]
  buffer_load_dwordx4 v[168:171], v2, s[36:39], s66 offen offset:3072 sc1
  v_mfma_f32_16x16x32_bf16 v[108:111], a[156:159], v[172:175], v[108:111]
  buffer_load_dwordx4 v[172:175], v2, s[36:39], s67 offen offset:3072 sc1
  s_waitcnt vmcnt(21)
  v_mfma_f32_16x16x32_bf16 v[32:35], a[160:163], v[112:115], v[32:35]
  s_add_u32 s62, s62, 4096
  v_mfma_f32_16x16x32_bf16 v[36:39], a[160:163], v[116:119], v[36:39]
  s_and_b32 s62, s62, 0x7fff
  v_mfma_f32_16x16x32_bf16 v[40:43], a[160:163], v[120:123], v[40:43]
  s_add_u32 s64, s63, s62
  v_mfma_f32_16x16x32_bf16 v[44:47], a[160:163], v[124:127], v[44:47]
  buffer_load_dwordx4 a[96:99], v2, s[32:35], s24 offen offset:0 sc1
  v_mfma_f32_16x16x32_bf16 v[48:51], a[164:167], v[112:115], v[48:51]
  v_mfma_f32_16x16x32_bf16 v[52:55], a[164:167], v[116:119], v[52:55]
  v_mfma_f32_16x16x32_bf16 v[56:59], a[164:167], v[120:123], v[56:59]
  s_add_u32 s65, s64, 131072
  v_mfma_f32_16x16x32_bf16 v[60:63], a[164:167], v[124:127], v[60:63]
  buffer_load_dwordx4 a[100:103], v2, s[32:35], s24 offen offset:1024 sc1
  v_mfma_f32_16x16x32_bf16 v[64:67], a[168:171], v[112:115], v[64:67]
  v_mfma_f32_16x16x32_bf16 v[68:71], a[168:171], v[116:119], v[68:71]
  v_mfma_f32_16x16x32_bf16 v[72:75], a[168:171], v[120:123], v[72:75]
  s_add_u32 s66, s64, 262144
  v_mfma_f32_16x16x32_bf16 v[76:79], a[168:171], v[124:127], v[76:79]
  buffer_load_dwordx4 a[104:107], v2, s[32:35], s24 offen offset:2048 sc1
  v_mfma_f32_16x16x32_bf16 v[80:83], a[172:175], v[112:115], v[80:83]
  v_mfma_f32_16x16x32_bf16 v[84:87], a[172:175], v[116:119], v[84:87]
  v_mfma_f32_16x16x32_bf16 v[88:91], a[172:175], v[120:123], v[88:91]
  s_add_u32 s67, s64, 393216
  v_mfma_f32_16x16x32_bf16 v[92:95], a[172:175], v[124:127], v[92:95]
  v_mfma_f32_16x16x32_bf16 v[96:99], a[176:179], v[112:115], v[96:99]
  buffer_load_dwordx4 v[112:115], v2, s[36:39], s64 offen offset:0 sc1
  v_mfma_f32_16x16x32_bf16 v[100:103], a[176:179], v[116:119], v[100:103]
  buffer_load_dwordx4 v[116:119], v2, s[36:39], s65 offen offset:0 sc1
  v_mfma_f32_16x16x32_bf16 v[104:107], a[176:179], v[120:123], v[104:107]
  buffer_load_dwordx4 v[120:123], v2, s[36:39], s66 offen offset:0 sc1
  v_mfma_f32_16x16x32_bf16 v[108:111], a[176:179], v[124:127], v[108:111]
  buffer_load_dwordx4 v[124:127], v2, s[36:39], s67 offen offset:0 sc1
  s_waitcnt vmcnt(21)
  v_mfma_f32_16x16x32_bf16 v[32:35], a[180:183], v[128:131], v[32:35]
  v_mfma_f32_16x16x32_bf16 v[36:39], a[180:183], v[132:135], v[36:39]
  v_mfma_f32_16x16x32_bf16 v[40:43], a[180:183], v[136:139], v[40:43]
  v_mfma_f32_16x16x32_bf16 v[44:47], a[180:183], v[140:143], v[44:47]
  buffer_load_dwordx4 a[108:111], v2, s[32:35], s24 offen offset:3072 sc1
  v_mfma_f32_16x16x32_bf16 v[48:51], a[184:187], v[128:131], v[48:51]
  s_add_u32 s24, s24, 4096
  v_mfma_f32_16x16x32_bf16 v[52:55], a[184:187], v[132:135], v[52:55]
  v_mfma_f32_16x16x32_bf16 v[56:59], a[184:187], v[136:139], v[56:59]
  v_mfma_f32_16x16x32_bf16 v[60:63], a[184:187], v[140:143], v[60:63]
  buffer_load_dwordx4 a[112:115], v2, s[32:35], s24 offen offset:0 sc1
  v_mfma_f32_16x16x32_bf16 v[64:67], a[188:191], v[128:131], v[64:67]
  v_mfma_f32_16x16x32_bf16 v[68:71], a[188:191], v[132:135], v[68:71]
  v_mfma_f32_16x16x32_bf16 v[72:75], a[188:191], v[136:139], v[72:75]
  v_mfma_f32_16x16x32_bf16 v[76:79], a[188:191], v[140:143], v[76:79]
  buffer_load_dwordx4 a[116:119], v2, s[32:35], s24 offen offset:1024 sc1
  v_mfma_f32_16x16x32_bf16 v[80:83], a[192:195], v[128:131], v[80:83]
  v_mfma_f32_16x16x32_bf16 v[84:87], a[192:195], v[132:135], v[84:87]
  v_mfma_f32_16x16x32_bf16 v[88:91], a[192:195], v[136:139], v[88:91]
  v_mfma_f32_16x16x32_bf16 v[92:95], a[192:195], v[140:143], v[92:95]
  v_mfma_f32_16x16x32_bf16 v[96:99], a[196:199], v[128:131], v[96:99]
  buffer_load_dwordx4 v[128:131], v2, s[36:39], s64 offen offset:1024 sc1
  v_mfma_f32_16x16x32_bf16 v[100:103], a[196:199], v[132:135], v[100:103]
  buffer_load_dwordx4 v[132:135], v2, s[36:39], s65 offen offset:1024 sc1
  v_mfma_f32_16x16x32_bf16 v[104:107], a[196:199], v[136:139], v[104:107]
  buffer_load_dwordx4 v[136:139], v2, s[36:39], s66 offen offset:1024 sc1
  v_mfma_f32_16x16x32_bf16 v[108:111], a[196:199], v[140:143], v[108:111]
  buffer_load_dwordx4 v[140:143], v2, s[36:39], s67 offen offset:1024 sc1
  s_waitcnt vmcnt(21)
  v_mfma_f32_16x16x32_bf16 v[32:35], a[200:203], v[144:147], v[32:35]
  v_mfma_f32_16x16x32_bf16 v[36:39], a[200:203], v[148:151], v[36:39]
  v_mfma_f32_16x16x32_bf16 v[40:43], a[200:203], v[152:155], v[40:43]
  v_mfma_f32_16x16x32_bf16 v[44:47], a[200:203], v[156:159], v[44:47]
  buffer_load_dwordx4 a[120:123], v2, s[32:35], s24 offen offset:2048 sc1
  v_mfma_f32_16x16x32_bf16 v[48:51], a[204:207], v[144:147], v[48:51]
  v_mfma_f32_16x16x32_bf16 v[52:55], a[204:207], v[148:151], v[52:55]
  v_mfma_f32_16x16x32_bf16 v[56:59], a[204:207], v[152:155], v[56:59]
  v_mfma_f32_16x16x32_bf16 v[60:63], a[204:207], v[156:159], v[60:63]
  buffer_load_dwordx4 a[124:127], v2, s[32:35], s24 offen offset:3072 sc1
  v_mfma_f32_16x16x32_bf16 v[64:67], a[208:211], v[144:147], v[64:67]
  s_add_u32 s24, s24, 4096
  v_mfma_f32_16x16x32_bf16 v[68:71], a[208:211], v[148:151], v[68:71]
  v_mfma_f32_16x16x32_bf16 v[72:75], a[208:211], v[152:155], v[72:75]
  v_mfma_f32_16x16x32_bf16 v[76:79], a[208:211], v[156:159], v[76:79]
  buffer_load_dwordx4 a[128:131], v2, s[32:35], s24 offen offset:0 sc1
  v_mfma_f32_16x16x32_bf16 v[80:83], a[212:215], v[144:147], v[80:83]
  v_mfma_f32_16x16x32_bf16 v[84:87], a[212:215], v[148:151], v[84:87]
  v_mfma_f32_16x16x32_bf16 v[88:91], a[212:215], v[152:155], v[88:91]
  v_mfma_f32_16x16x32_bf16 v[92:95], a[212:215], v[156:159], v[92:95]
  v_mfma_f32_16x16x32_bf16 v[96:99], a[216:219], v[144:147], v[96:99]
  buffer_load_dwordx4 v[144:147], v2, s[36:39], s64 offen offset:2048 sc1
  v_mfma_f32_16x16x32_bf16 v[100:103], a[216:219], v[148:151], v[100:103]
  buffer_load_dwordx4 v[148:151], v2, s[36:39], s65 offen offset:2048 sc1
  v_mfma_f32_16x16x32_bf16 v[104:107], a[216:219], v[152:155], v[104:107]
  buffer_load_dwordx4 v[152:155], v2, s[36:39], s66 offen offset:2048 sc1
  v_mfma_f32_16x16x32_bf16 v[108:111], a[216:219], v[156:159], v[108:111]
  buffer_load_dwordx4 v[156:159], v2, s[36:39], s67 offen offset:2048 sc1
  s_waitcnt vmcnt(21)
  v_mfma_f32_16x16x32_bf16 v[32:35], a[220:223], v[160:163], v[32:35]
  v_mfma_f32_16x16x32_bf16 v[36:39], a[220:223], v[164:167], v[36:39]
  v_mfma_f32_16x16x32_bf16 v[40:43], a[220:223], v[168:171], v[40:43]
  v_mfma_f32_16x16x32_bf16 v[44:47], a[220:223], v[172:175], v[44:47]
  buffer_load_dwordx4 a[132:135], v2, s[32:35], s24 offen offset:1024 sc1
  v_mfma_f32_16x16x32_bf16 v[48:51], a[224:227], v[160:163], v[48:51]
  v_mfma_f32_16x16x32_bf16 v[52:55], a[224:227], v[164:167], v[52:55]
  v_mfma_f32_16x16x32_bf16 v[56:59], a[224:227], v[168:171], v[56:59]
  v_mfma_f32_16x16x32_bf16 v[60:63], a[224:227], v[172:175], v[60:63]
  buffer_load_dwordx4 a[136:139], v2, s[32:35], s24 offen offset:2048 sc1
  v_mfma_f32_16x16x32_bf16 v[64:67], a[228:231], v[160:163], v[64:67]
  v_mfma_f32_16x16x32_bf16 v[68:71], a[228:231], v[164:167], v[68:71]
  v_mfma_f32_16x16x32_bf16 v[72:75], a[228:231], v[168:171], v[72:75]
  v_mfma_f32_16x16x32_bf16 v[76:79], a[228:231], v[172:175], v[76:79]
  buffer_load_dwordx4 a[140:143], v2, s[32:35], s24 offen offset:3072 sc1
  v_mfma_f32_16x16x32_bf16 v[80:83], a[232:235], v[160:163], v[80:83]
  s_add_u32 s24, s24, 4096
  v_mfma_f32_16x16x32_bf16 v[84:87], a[232:235], v[164:167], v[84:87]
  v_mfma_f32_16x16x32_bf16 v[88:91], a[232:235], v[168:171], v[88:91]
  v_mfma_f32_16x16x32_bf16 v[92:95], a[232:235], v[172:175], v[92:95]
  v_mfma_f32_16x16x32_bf16 v[96:99], a[236:239], v[160:163], v[96:99]
  buffer_load_dwordx4 v[160:163], v2, s[36:39], s64 offen offset:3072 sc1
  v_mfma_f32_16x16x32_bf16 v[100:103], a[236:239], v[164:167], v[100:103]
  buffer_load_dwordx4 v[164:167], v2, s[36:39], s65 offen offset:3072 sc1
  v_mfma_f32_16x16x32_bf16 v[104:107], a[236:239], v[168:171], v[104:107]
  buffer_load_dwordx4 v[168:171], v2, s[36:39], s66 offen offset:3072 sc1
  v_mfma_f32_16x16x32_bf16 v[108:111], a[236:239], v[172:175], v[108:111]
  buffer_load_dwordx4 v[172:175], v2, s[36:39], s67 offen offset:3072 sc1
  s_waitcnt vmcnt(21)
  v_mfma_f32_16x16x32_bf16 v[32:35], a[240:243], v[112:115], v[32:35]
  s_add_u32 s62, s62, 4096
  v_mfma_f32_16x16x32_bf16 v[36:39], a[240:243], v[116:119], v[36:39]
  s_and_b32 s62, s62, 0x7fff
  v_mfma_f32_16x16x32_bf16 v[40:43], a[240:243], v[120:123], v[40:43]
  s_add_u32 s64, s63, s62
  v_mfma_f32_16x16x32_bf16 v[44:47], a[240:243], v[124:127], v[44:47]
  buffer_load_dwordx4 a[144:147], v2, s[32:35], s24 offen offset:0 sc1
  v_mfma_f32_16x16x32_bf16 v[48:51], a[244:247], v[112:115], v[48:51]
  v_mfma_f32_16x16x32_bf16 v[52:55], a[244:247], v[116:119], v[52:55]
  v_mfma_f32_16x16x32_bf16 v[56:59], a[244:247], v[120:123], v[56:59]
  s_add_u32 s65, s64, 131072
  v_mfma_f32_16x16x32_bf16 v[60:63], a[244:247], v[124:127], v[60:63]
  buffer_load_dwordx4 a[148:151], v2, s[32:35], s24 offen offset:1024 sc1
  v_mfma_f32_16x16x32_bf16 v[64:67], a[248:251], v[112:115], v[64:67]
  v_mfma_f32_16x16x32_bf16 v[68:71], a[248:251], v[116:119], v[68:71]
  v_mfma_f32_16x16x32_bf16 v[72:75], a[248:251], v[120:123], v[72:75]
  s_add_u32 s66, s64, 262144
  v_mfma_f32_16x16x32_bf16 v[76:79], a[248:251], v[124:127], v[76:79]
  buffer_load_dwordx4 a[152:155], v2, s[32:35], s24 offen offset:2048 sc1
  v_mfma_f32_16x16x32_bf16 v[80:83], a[252:255], v[112:115], v[80:83]
  v_mfma_f32_16x16x32_bf16 v[84:87], a[252:255], v[116:119], v[84:87]
  v_mfma_f32_16x16x32_bf16 v[88:91], a[252:255], v[120:123], v[88:91]
  s_add_u32 s67, s64, 393216
  v_mfma_f32_16x16x32_bf16 v[92:95], a[252:255], v[124:127], v[92:95]
  v_mfma_f32_16x16x32_bf16 v[96:99], v[176:179], v[112:115], v[96:99]
  buffer_load_dwordx4 v[112:115], v2, s[36:39], s64 offen offset:0 sc1
  v_mfma_f32_16x16x32_bf16 v[100:103], v[176:179], v[116:119], v[100:103]
  buffer_load_dwordx4 v[116:119], v2, s[36:39], s65 offen offset:0 sc1
  v_mfma_f32_16x16x32_bf16 v[104:107], v[176:179], v[120:123], v[104:107]
  buffer_load_dwordx4 v[120:123], v2, s[36:39], s66 offen offset:0 sc1
  v_mfma_f32_16x16x32_bf16 v[108:111], v[176:179], v[124:127], v[108:111]
  buffer_load_dwordx4 v[124:127], v2, s[36:39], s67 offen offset:0 sc1
  s_waitcnt vmcnt(21)
  v_mfma_f32_16x16x32_bf16 v[32:35], v[180:183], v[128:131], v[32:35]
  v_mfma_f32_16x16x32_bf16 v[36:39], v[180:183], v[132:135], v[36:39]
  v_mfma_f32_16x16x32_bf16 v[40:43], v[180:183], v[136:139], v[40:43]
  v_mfma_f32_16x16x32_bf16 v[44:47], v[180:183], v[140:143], v[44:47]
  buffer_load_dwordx4 a[156:159], v2, s[32:35], s24 offen offset:3072 sc1
  v_mfma_f32_16x16x32_bf16 v[48:51], v[184:187], v[128:131], v[48:51]
  s_add_u32 s24, s24, 4096
  v_mfma_f32_16x16x32_bf16 v[52:55], v[184:187], v[132:135], v[52:55]
  s_cmp_ge_u32 s24, s61
  s_cselect_b32 s23, 163840, 0
  s_sub_u32 s24, s24, s23
  v_mfma_f32_16x16x32_bf16 v[56:59], v[184:187], v[136:139], v[56:59]
  v_mfma_f32_16x16x32_bf16 v[60:63], v[184:187], v[140:143], v[60:63]
  buffer_load_dwordx4 a[160:163], v2, s[32:35], s24 offen offset:0 sc1
  v_mfma_f32_16x16x32_bf16 v[64:67], v[188:191], v[128:131], v[64:67]
  v_mfma_f32_16x16x32_bf16 v[68:71], v[188:191], v[132:135], v[68:71]
  v_mfma_f32_16x16x32_bf16 v[72:75], v[188:191], v[136:139], v[72:75]
  v_mfma_f32_16x16x32_bf16 v[76:79], v[188:191], v[140:143], v[76:79]
  buffer_load_dwordx4 a[164:167], v2, s[32:35], s24 offen offset:1024 sc1
  v_mfma_f32_16x16x32_bf16 v[80:83], v[192:195], v[128:131], v[80:83]
  v_mfma_f32_16x16x32_bf16 v[84:87], v[192:195], v[132:135], v[84:87]
  v_mfma_f32_16x16x32_bf16 v[88:91], v[192:195], v[136:139], v[88:91]
  v_mfma_f32_16x16x32_bf16 v[92:95], v[192:195], v[140:143], v[92:95]
  v_mfma_f32_16x16x32_bf16 v[96:99], v[196:199], v[128:131], v[96:99]
  buffer_load_dwordx4 v[128:131], v2, s[36:39], s64 offen offset:1024 sc1
  v_mfma_f32_16x16x32_bf16 v[100:103], v[196:199], v[132:135], v[100:103]
  buffer_load_dwordx4 v[132:135], v2, s[36:39], s65 offen offset:1024 sc1
  v_mfma_f32_16x16x32_bf16 v[104:107], v[196:199], v[136:139], v[104:107]
  buffer_load_dwordx4 v[136:139], v2, s[36:39], s66 offen offset:1024 sc1
  v_mfma_f32_16x16x32_bf16 v[108:111], v[196:199], v[140:143], v[108:111]
  buffer_load_dwordx4 v[140:143], v2, s[36:39], s67 offen offset:1024 sc1
  s_waitcnt vmcnt(21)
  v_mfma_f32_16x16x32_bf16 v[32:35], v[200:203], v[144:147], v[32:35]
  v_mfma_f32_16x16x32_bf16 v[36:39], v[200:203], v[148:151], v[36:39]
  v_mfma_f32_16x16x32_bf16 v[40:43], v[200:203], v[152:155], v[40:43]
  v_mfma_f32_16x16x32_bf16 v[44:47], v[200:203], v[156:159], v[44:47]
  buffer_load_dwordx4 a[168:171], v2, s[32:35], s24 offen offset:2048 sc1
  v_mfma_f32_16x16x32_bf16 v[48:51], v[204:207], v[144:147], v[48:51]
  v_mfma_f32_16x16x32_bf16 v[52:55], v[204:207], v[148:151], v[52:55]
  v_mfma_f32_16x16x32_bf16 v[56:59], v[204:207], v[152:155], v[56:59]
  v_mfma_f32_16x16x32_bf16 v[60:63], v[204:207], v[156:159], v[60:63]
  buffer_load_dwordx4 a[172:175], v2, s[32:35], s24 offen offset:3072 sc1
  v_mfma_f32_16x16x32_bf16 v[64:67], v[208:211], v[144:147], v[64:67]
  s_add_u32 s24, s24, 4096
  v_mfma_f32_16x16x32_bf16 v[68:71], v[208:211], v[148:151], v[68:71]
  v_mfma_f32_16x16x32_bf16 v[72:75], v[208:211], v[152:155], v[72:75]
  v_mfma_f32_16x16x32_bf16 v[76:79], v[208:211], v[156:159], v[76:79]
  buffer_load_dwordx4 a[176:179], v2, s[32:35], s24 offen offset:0 sc1
  v_mfma_f32_16x16x32_bf16 v[80:83], v[212:215], v[144:147], v[80:83]
  v_mfma_f32_16x16x32_bf16 v[84:87], v[212:215], v[148:151], v[84:87]
  v_mfma_f32_16x16x32_bf16 v[88:91], v[212:215], v[152:155], v[88:91]
  v_mfma_f32_16x16x32_bf16 v[92:95], v[212:215], v[156:159], v[92:95]
  v_mfma_f32_16x16x32_bf16 v[96:99], v[216:219], v[144:147], v[96:99]
  buffer_load_dwordx4 v[144:147], v2, s[36:39], s64 offen offset:2048 sc1
  v_mfma_f32_16x16x32_bf16 v[100:103], v[216:219], v[148:151], v[100:103]
  buffer_load_dwordx4 v[148:151], v2, s[36:39], s65 offen offset:2048 sc1
  v_mfma_f32_16x16x32_bf16 v[104:107], v[216:219], v[152:155], v[104:107]
  buffer_load_dwordx4 v[152:155], v2, s[36:39], s66 offen offset:2048 sc1
  v_mfma_f32_16x16x32_bf16 v[108:111], v[216:219], v[156:159], v[108:111]
  buffer_load_dwordx4 v[156:159], v2, s[36:39], s67 offen offset:2048 sc1
  s_waitcnt vmcnt(21)
  v_mfma_f32_16x16x32_bf16 v[32:35], v[220:223], v[160:163], v[32:35]
  v_mfma_f32_16x16x32_bf16 v[36:39], v[220:223], v[164:167], v[36:39]
  v_mfma_f32_16x16x32_bf16 v[40:43], v[220:223], v[168:171], v[40:43]
  v_mfma_f32_16x16x32_bf16 v[44:47], v[220:223], v[172:175], v[44:47]
  buffer_load_dwordx4 a[180:183], v2, s[32:35], s24 offen offset:1024 sc1
  v_mfma_f32_16x16x32_bf16 v[48:51], v[224:227], v[160:163], v[48:51]
  v_mfma_f32_16x16x32_bf16 v[52:55], v[224:227], v[164:167], v[52:55]
  v_mfma_f32_16x16x32_bf16 v[56:59], v[224:227], v[168:171], v[56:59]
  v_mfma_f32_16x16x32_bf16 v[60:63], v[224:227], v[172:175], v[60:63]
  buffer_load_dwordx4 a[184:187], v2, s[32:35], s24 offen offset:2048 sc1
  v_mfma_f32_16x16x32_bf16 v[64:67], v[228:231], v[160:163], v[64:67]
  v_mfma_f32_16x16x32_bf16 v[68:71], v[228:231], v[164:167], v[68:71]
  v_mfma_f32_16x16x32_bf16 v[72:75], v[228:231], v[168:171], v[72:75]
  v_mfma_f32_16x16x32_bf16 v[76:79], v[228:231], v[172:175], v[76:79]
  buffer_load_dwordx4 a[188:191], v2, s[32:35], s24 offen offset:3072 sc1
  v_mfma_f32_16x16x32_bf16 v[80:83], v[232:235], v[160:163], v[80:83]
  s_add_u32 s24, s24, 4096
  v_mfma_f32_16x16x32_bf16 v[84:87], v[232:235], v[164:167], v[84:87]
  v_mfma_f32_16x16x32_bf16 v[88:91], v[232:235], v[168:171], v[88:91]
  v_mfma_f32_16x16x32_bf16 v[92:95], v[232:235], v[172:175], v[92:95]
  v_mfma_f32_16x16x32_bf16 v[96:99], v[236:239], v[160:163], v[96:99]
  buffer_load_dwordx4 v[160:163], v2, s[36:39], s64 offen offset:3072 sc1
  v_mfma_f32_16x16x32_bf16 v[100:103], v[236:239], v[164:167], v[100:103]
  buffer_load_dwordx4 v[164:167], v2, s[36:39], s65 offen offset:3072 sc1
  v_mfma_f32_16x16x32_bf16 v[104:107], v[236:239], v[168:171], v[104:107]
  buffer_load_dwordx4 v[168:171], v2, s[36:39], s66 offen offset:3072 sc1
  v_mfma_f32_16x16x32_bf16 v[108:111], v[236:239], v[172:175], v[108:111]
  buffer_load_dwordx4 v[172:175], v2, s[36:39], s67 offen offset:3072 sc1
  s_waitcnt vmcnt(21)
  v_mfma_f32_16x16x32_bf16 v[32:35], a[0:3], v[112:115], v[32:35]
  s_add_u32 s62, s62, 4096
  v_mfma_f32_16x16x32_bf16 v[36:39], a[0:3], v[116:119], v[36:39]
  s_and_b32 s62, s62, 0x7fff
  v_mfma_f32_16x16x32_bf16 v[40:43], a[0:3], v[120:123], v[40:43]
  s_add_u32 s64, s63, s62
  v_mfma_f32_16x16x32_bf16 v[44:47], a[0:3], v[124:127], v[44:47]
  buffer_load_dwordx4 a[192:195], v2, s[32:35], s24 offen offset:0 sc1
  v_mfma_f32_16x16x32_bf16 v[48:51], a[4:7], v[112:115], v[48:51]
  v_mfma_f32_16x16x32_bf16 v[52:55], a[4:7], v[116:119], v[52:55]
  v_mfma_f32_16x16x32_bf16 v[56:59], a[4:7], v[120:123], v[56:59]
  s_add_u32 s65, s64, 131072
  v_mfma_f32_16x16x32_bf16 v[60:63], a[4:7], v[124:127], v[60:63]
  buffer_load_dwordx4 a[196:199], v2, s[32:35], s24 offen offset:1024 sc1
  v_mfma_f32_16x16x32_bf16 v[64:67], a[8:11], v[112:115], v[64:67]
  v_mfma_f32_16x16x32_bf16 v[68:71], a[8:11], v[116:119], v[68:71]
  v_mfma_f32_16x16x32_bf16 v[72:75], a[8:11], v[120:123], v[72:75]
  s_add_u32 s66, s64, 262144
  v_mfma_f32_16x16x32_bf16 v[76:79], a[8:11], v[124:127], v[76:79]
  buffer_load_dwordx4 a[200:203], v2, s[32:35], s24 offen offset:2048 sc1
  v_mfma_f32_16x16x32_bf16 v[80:83], a[12:15], v[112:115], v[80:83]
  v_mfma_f32_16x16x32_bf16 v[84:87], a[12:15], v[116:119], v[84:87]
  v_mfma_f32_16x16x32_bf16 v[88:91], a[12:15], v[120:123], v[88:91]
  s_add_u32 s67, s64, 393216
  v_mfma_f32_16x16x32_bf16 v[92:95], a[12:15], v[124:127], v[92:95]
  v_mfma_f32_16x16x32_bf16 v[96:99], a[16:19], v[112:115], v[96:99]
  buffer_load_dwordx4 v[112:115], v2, s[36:39], s64 offen offset:0 sc1
  v_mfma_f32_16x16x32_bf16 v[100:103], a[16:19], v[116:119], v[100:103]
  buffer_load_dwordx4 v[116:119], v2, s[36:39], s65 offen offset:0 sc1
  v_mfma_f32_16x16x32_bf16 v[104:107], a[16:19], v[120:123], v[104:107]
  buffer_load_dwordx4 v[120:123], v2, s[36:39], s66 offen offset:0 sc1
  v_mfma_f32_16x16x32_bf16 v[108:111], a[16:19], v[124:127], v[108:111]
  buffer_load_dwordx4 v[124:127], v2, s[36:39], s67 offen offset:0 sc1
  s_waitcnt vmcnt(21)
  v_mfma_f32_16x16x32_bf16 v[32:35], a[20:23], v[128:131], v[32:35]
  v_mfma_f32_16x16x32_bf16 v[36:39], a[20:23], v[132:135], v[36:39]
  v_mfma_f32_16x16x32_bf16 v[40:43], a[20:23], v[136:139], v[40:43]
  v_mfma_f32_16x16x32_bf16 v[44:47], a[20:23], v[140:143], v[44:47]
  buffer_load_dwordx4 a[204:207], v2, s[32:35], s24 offen offset:3072 sc1
  v_mfma_f32_16x16x32_bf16 v[48:51], a[24:27], v[128:131], v[48:51]
  s_add_u32 s24, s24, 4096
  v_mfma_f32_16x16x32_bf16 v[52:55], a[24:27], v[132:135], v[52:55]
  v_mfma_f32_16x16x32_bf16 v[56:59], a[24:27], v[136:139], v[56:59]
  v_mfma_f32_16x16x32_bf16 v[60:63], a[24:27], v[140:143], v[60:63]
  buffer_load_dwordx4 a[208:211], v2, s[32:35], s24 offen offset:0 sc1
  v_mfma_f32_16x16x32_bf16 v[64:67], a[28:31], v[128:131], v[64:67]
  v_mfma_f32_16x16x32_bf16 v[68:71], a[28:31], v[132:135], v[68:71]
  v_mfma_f32_16x16x32_bf16 v[72:75], a[28:31], v[136:139], v[72:75]
  v_mfma_f32_16x16x32_bf16 v[76:79], a[28:31], v[140:143], v[76:79]
  buffer_load_dwordx4 a[212:215], v2, s[32:35], s24 offen offset:1024 sc1
  v_mfma_f32_16x16x32_bf16 v[80:83], a[32:35], v[128:131], v[80:83]
  v_mfma_f32_16x16x32_bf16 v[84:87], a[32:35], v[132:135], v[84:87]
  v_mfma_f32_16x16x32_bf16 v[88:91], a[32:35], v[136:139], v[88:91]
  v_mfma_f32_16x16x32_bf16 v[92:95], a[32:35], v[140:143], v[92:95]
  v_mfma_f32_16x16x32_bf16 v[96:99], a[36:39], v[128:131], v[96:99]
  buffer_load_dwordx4 v[128:131], v2, s[36:39], s64 offen offset:1024 sc1
  v_mfma_f32_16x16x32_bf16 v[100:103], a[36:39], v[132:135], v[100:103]
  buffer_load_dwordx4 v[132:135], v2, s[36:39], s65 offen offset:1024 sc1
  v_mfma_f32_16x16x32_bf16 v[104:107], a[36:39], v[136:139], v[104:107]
  buffer_load_dwordx4 v[136:139], v2, s[36:39], s66 offen offset:1024 sc1
  v_mfma_f32_16x16x32_bf16 v[108:111], a[36:39], v[140:143], v[108:111]
  buffer_load_dwordx4 v[140:143], v2, s[36:39], s67 offen offset:1024 sc1
  s_waitcnt vmcnt(21)
  v_mfma_f32_16x16x32_bf16 v[32:35], a[40:43], v[144:147], v[32:35]
  v_mfma_f32_16x16x32_bf16 v[36:39], a[40:43], v[148:151], v[36:39]
  v_mfma_f32_16x16x32_bf16 v[40:43], a[40:43], v[152:155], v[40:43]
  v_mfma_f32_16x16x32_bf16 v[44:47], a[40:43], v[156:159], v[44:47]
  buffer_load_dwordx4 a[216:219], v2, s[32:35], s24 offen offset:2048 sc1
  v_mfma_f32_16x16x32_bf16 v[48:51], a[44:47], v[144:147], v[48:51]
  v_mfma_f32_16x16x32_bf16 v[52:55], a[44:47], v[148:151], v[52:55]
  v_mfma_f32_16x16x32_bf16 v[56:59], a[44:47], v[152:155], v[56:59]
  v_mfma_f32_16x16x32_bf16 v[60:63], a[44:47], v[156:159], v[60:63]
  buffer_load_dwordx4 a[220:223], v2, s[32:35], s24 offen offset:3072 sc1
  v_mfma_f32_16x16x32_bf16 v[64:67], a[48:51], v[144:147], v[64:67]
  s_add_u32 s24, s24, 4096
  v_mfma_f32_16x16x32_bf16 v[68:71], a[48:51], v[148:151], v[68:71]
  v_mfma_f32_16x16x32_bf16 v[72:75], a[48:51], v[152:155], v[72:75]
  v_mfma_f32_16x16x32_bf16 v[76:79], a[48:51], v[156:159], v[76:79]
  buffer_load_dwordx4 a[224:227], v2, s[32:35], s24 offen offset:0 sc1
  v_mfma_f32_16x16x32_bf16 v[80:83], a[52:55], v[144:147], v[80:83]
  v_mfma_f32_16x16x32_bf16 v[84:87], a[52:55], v[148:151], v[84:87]
  v_mfma_f32_16x16x32_bf16 v[88:91], a[52:55], v[152:155], v[88:91]
  v_mfma_f32_16x16x32_bf16 v[92:95], a[52:55], v[156:159], v[92:95]
  v_mfma_f32_16x16x32_bf16 v[96:99], a[56:59], v[144:147], v[96:99]
  buffer_load_dwordx4 v[144:147], v2, s[36:39], s64 offen offset:2048 sc1
  v_mfma_f32_16x16x32_bf16 v[100:103], a[56:59], v[148:151], v[100:103]
  buffer_load_dwordx4 v[148:151], v2, s[36:39], s65 offen offset:2048 sc1
  v_mfma_f32_16x16x32_bf16 v[104:107], a[56:59], v[152:155], v[104:107]
  buffer_load_dwordx4 v[152:155], v2, s[36:39], s66 offen offset:2048 sc1
  v_mfma_f32_16x16x32_bf16 v[108:111], a[56:59], v[156:159], v[108:111]
  buffer_load_dwordx4 v[156:159], v2, s[36:39], s67 offen offset:2048 sc1
  s_waitcnt vmcnt(21)
  v_mfma_f32_16x16x32_bf16 v[32:35], a[60:63], v[160:163], v[32:35]
  v_mfma_f32_16x16x32_bf16 v[36:39], a[60:63], v[164:167], v[36:39]
  v_mfma_f32_16x16x32_bf16 v[40:43], a[60:63], v[168:171], v[40:43]
  v_mfma_f32_16x16x32_bf16 v[44:47], a[60:63], v[172:175], v[44:47]
  buffer_load_dwordx4 a[228:231], v2, s[32:35], s24 offen offset:1024 sc1
  v_mfma_f32_16x16x32_bf16 v[48:51], a[64:67], v[160:163], v[48:51]
  v_mfma_f32_16x16x32_bf16 v[52:55], a[64:67], v[164:167], v[52:55]
  v_mfma_f32_16x16x32_bf16 v[56:59], a[64:67], v[168:171], v[56:59]
  v_mfma_f32_16x16x32_bf16 v[60:63], a[64:67], v[172:175], v[60:63]
  buffer_load_dwordx4 a[232:235], v2, s[32:35], s24 offen offset:2048 sc1
  v_mfma_f32_16x16x32_bf16 v[64:67], a[68:71], v[160:163], v[64:67]
  v_mfma_f32_16x16x32_bf16 v[68:71], a[68:71], v[164:167], v[68:71]
  v_mfma_f32_16x16x32_bf16 v[72:75], a[68:71], v[168:171], v[72:75]
  v_mfma_f32_16x16x32_bf16 v[76:79], a[68:71], v[172:175], v[76:79]
  buffer_load_dwordx4 a[236:239], v2, s[32:35], s24 offen offset:3072 sc1
  v_mfma_f32_16x16x32_bf16 v[80:83], a[72:75], v[160:163], v[80:83]
  s_add_u32 s24, s24, 4096
  v_mfma_f32_16x16x32_bf16 v[84:87], a[72:75], v[164:167], v[84:87]
  s_cmp_ge_u32 s24, s61
  s_cselect_b32 s23, 163840, 0
  s_sub_u32 s24, s24, s23
  v_mfma_f32_16x16x32_bf16 v[88:91], a[72:75], v[168:171], v[88:91]
  v_mfma_f32_16x16x32_bf16 v[92:95], a[72:75], v[172:175], v[92:95]
  v_mfma_f32_16x16x32_bf16 v[96:99], a[76:79], v[160:163], v[96:99]
  buffer_load_dwordx4 v[160:163], v2, s[36:39], s64 offen offset:3072 sc1
  v_mfma_f32_16x16x32_bf16 v[100:103], a[76:79], v[164:167], v[100:103]
  buffer_load_dwordx4 v[164:167], v2, s[36:39], s65 offen offset:3072 sc1
  v_mfma_f32_16x16x32_bf16 v[104:107], a[76:79], v[168:171], v[104:107]
  buffer_load_dwordx4 v[168:171], v2, s[36:39], s66 offen offset:3072 sc1
  v_mfma_f32_16x16x32_bf16 v[108:111], a[76:79], v[172:175], v[108:111]
  buffer_load_dwordx4 v[172:175], v2, s[36:39], s67 offen offset:3072 sc1
  s_waitcnt vmcnt(21)
  v_mfma_f32_16x16x32_bf16 v[32:35], a[80:83], v[112:115], v[32:35]
  s_add_u32 s62, s62, 4096
  v_mfma_f32_16x16x32_bf16 v[36:39], a[80:83], v[116:119], v[36:39]
  s_and_b32 s62, s62, 0x7fff
  v_mfma_f32_16x16x32_bf16 v[40:43], a[80:83], v[120:123], v[40:43]
  s_add_u32 s64, s63, s62
  v_mfma_f32_16x16x32_bf16 v[44:47], a[80:83], v[124:127], v[44:47]
  buffer_load_dwordx4 a[240:243], v2, s[32:35], s24 offen offset:0 sc1
  v_mfma_f32_16x16x32_bf16 v[48:51], a[84:87], v[112:115], v[48:51]
  v_mfma_f32_16x16x32_bf16 v[52:55], a[84:87], v[116:119], v[52:55]
  v_mfma_f32_16x16x32_bf16 v[56:59], a[84:87], v[120:123], v[56:59]
  s_add_u32 s65, s64, 131072
  v_mfma_f32_16x16x32_bf16 v[60:63], a[84:87], v[124:127], v[60:63]
  buffer_load_dwordx4 a[244:247], v2, s[32:35], s24 offen offset:1024 sc1
  v_mfma_f32_16x16x32_bf16 v[64:67], a[88:91], v[112:115], v[64:67]
  v_mfma_f32_16x16x32_bf16 v[68:71], a[88:91], v[116:119], v[68:71]
  v_mfma_f32_16x16x32_bf16 v[72:75], a[88:91], v[120:123], v[72:75]
  s_add_u32 s66, s64, 262144
  v_mfma_f32_16x16x32_bf16 v[76:79], a[88:91], v[124:127], v[76:79]
  buffer_load_dwordx4 a[248:251], v2, s[32:35], s24 offen offset:2048 sc1
  v_mfma_f32_16x16x32_bf16 v[80:83], a[92:95], v[112:115], v[80:83]
  v_mfma_f32_16x16x32_bf16 v[84:87], a[92:95], v[116:119], v[84:87]
  v_mfma_f32_16x16x32_bf16 v[88:91], a[92:95], v[120:123], v[88:91]
  s_add_u32 s67, s64, 393216
  v_mfma_f32_16x16x32_bf16 v[92:95], a[92:95], v[124:127], v[92:95]
  v_mfma_f32_16x16x32_bf16 v[96:99], a[96:99], v[112:115], v[96:99]
  buffer_load_dwordx4 v[112:115], v2, s[36:39], s64 offen offset:0 sc1
  v_mfma_f32_16x16x32_bf16 v[100:103], a[96:99], v[116:119], v[100:103]
  buffer_load_dwordx4 v[116:119], v2, s[36:39], s65 offen offset:0 sc1
  v_mfma_f32_16x16x32_bf16 v[104:107], a[96:99], v[120:123], v[104:107]
  buffer_load_dwordx4 v[120:123], v2, s[36:39], s66 offen offset:0 sc1
  v_mfma_f32_16x16x32_bf16 v[108:111], a[96:99], v[124:127], v[108:111]
  buffer_load_dwordx4 v[124:127], v2, s[36:39], s67 offen offset:0 sc1
  s_waitcnt vmcnt(21)
  v_mfma_f32_16x16x32_bf16 v[32:35], a[100:103], v[128:131], v[32:35]
  v_mfma_f32_16x16x32_bf16 v[36:39], a[100:103], v[132:135], v[36:39]
  v_mfma_f32_16x16x32_bf16 v[40:43], a[100:103], v[136:139], v[40:43]
  v_mfma_f32_16x16x32_bf16 v[44:47], a[100:103], v[140:143], v[44:47]
  buffer_load_dwordx4 a[252:255], v2, s[32:35], s24 offen offset:3072 sc1
  v_mfma_f32_16x16x32_bf16 v[48:51], a[104:107], v[128:131], v[48:51]
  s_add_u32 s24, s24, 4096
  v_mfma_f32_16x16x32_bf16 v[52:55], a[104:107], v[132:135], v[52:55]
  v_mfma_f32_16x16x32_bf16 v[56:59], a[104:107], v[136:139], v[56:59]
  v_mfma_f32_16x16x32_bf16 v[60:63], a[104:107], v[140:143], v[60:63]
  buffer_load_dwordx4 v[176:179], v2, s[32:35], s24 offen offset:0 sc1
  v_mfma_f32_16x16x32_bf16 v[64:67], a[108:111], v[128:131], v[64:67]
  v_mfma_f32_16x16x32_bf16 v[68:71], a[108:111], v[132:135], v[68:71]
  v_mfma_f32_16x16x32_bf16 v[72:75], a[108:111], v[136:139], v[72:75]
  v_mfma_f32_16x16x32_bf16 v[76:79], a[108:111], v[140:143], v[76:79]
  buffer_load_dwordx4 v[180:183], v2, s[32:35], s24 offen offset:1024 sc1
  v_mfma_f32_16x16x32_bf16 v[80:83], a[112:115], v[128:131], v[80:83]
  v_mfma_f32_16x16x32_bf16 v[84:87], a[112:115], v[132:135], v[84:87]
  v_mfma_f32_16x16x32_bf16 v[88:91], a[112:115], v[136:139], v[88:91]
  v_mfma_f32_16x16x32_bf16 v[92:95], a[112:115], v[140:143], v[92:95]
  v_mfma_f32_16x16x32_bf16 v[96:99], a[116:119], v[128:131], v[96:99]
  buffer_load_dwordx4 v[128:131], v2, s[36:39], s64 offen offset:1024 sc1
  v_mfma_f32_16x16x32_bf16 v[100:103], a[116:119], v[132:135], v[100:103]
  buffer_load_dwordx4 v[132:135], v2, s[36:39], s65 offen offset:1024 sc1
  v_mfma_f32_16x16x32_bf16 v[104:107], a[116:119], v[136:139], v[104:107]
  buffer_load_dwordx4 v[136:139], v2, s[36:39], s66 offen offset:1024 sc1
  v_mfma_f32_16x16x32_bf16 v[108:111], a[116:119], v[140:143], v[108:111]
  buffer_load_dwordx4 v[140:143], v2, s[36:39], s67 offen offset:1024 sc1
  s_waitcnt vmcnt(21)
  v_mfma_f32_16x16x32_bf16 v[32:35], a[120:123], v[144:147], v[32:35]
  v_mfma_f32_16x16x32_bf16 v[36:39], a[120:123], v[148:151], v[36:39]
  v_mfma_f32_16x16x32_bf16 v[40:43], a[120:123], v[152:155], v[40:43]
  v_mfma_f32_16x16x32_bf16 v[44:47], a[120:123], v[156:159], v[44:47]
  buffer_load_dwordx4 v[184:187], v2, s[32:35], s24 offen offset:2048 sc1
  v_mfma_f32_16x16x32_bf16 v[48:51], a[124:127], v[144:147], v[48:51]
  v_mfma_f32_16x16x32_bf16 v[52:55], a[124:127], v[148:151], v[52:55]
  v_mfma_f32_16x16x32_bf16 v[56:59], a[124:127], v[152:155], v[56:59]
  v_mfma_f32_16x16x32_bf16 v[60:63], a[124:127], v[156:159], v[60:63]
  buffer_load_dwordx4 v[188:191], v2, s[32:35], s24 offen offset:3072 sc1
  v_mfma_f32_16x16x32_bf16 v[64:67], a[128:131], v[144:147], v[64:67]
  s_add_u32 s24, s24, 4096
  v_mfma_f32_16x16x32_bf16 v[68:71], a[128:131], v[148:151], v[68:71]
  v_mfma_f32_16x16x32_bf16 v[72:75], a[128:131], v[152:155], v[72:75]
  v_mfma_f32_16x16x32_bf16 v[76:79], a[128:131], v[156:159], v[76:79]
  buffer_load_dwordx4 v[192:195], v2, s[32:35], s24 offen offset:0 sc1
  v_mfma_f32_16x16x32_bf16 v[80:83], a[132:135], v[144:147], v[80:83]
  v_mfma_f32_16x16x32_bf16 v[84:87], a[132:135], v[148:151], v[84:87]
  v_mfma_f32_16x16x32_bf16 v[88:91], a[132:135], v[152:155], v[88:91]
  v_mfma_f32_16x16x32_bf16 v[92:95], a[132:135], v[156:159], v[92:95]
  v_mfma_f32_16x16x32_bf16 v[96:99], a[136:139], v[144:147], v[96:99]
  buffer_load_dwordx4 v[144:147], v2, s[36:39], s64 offen offset:2048 sc1
  v_mfma_f32_16x16x32_bf16 v[100:103], a[136:139], v[148:151], v[100:103]
  buffer_load_dwordx4 v[148:151], v2, s[36:39], s65 offen offset:2048 sc1
  v_mfma_f32_16x16x32_bf16 v[104:107], a[136:139], v[152:155], v[104:107]
  buffer_load_dwordx4 v[152:155], v2, s[36:39], s66 offen offset:2048 sc1
  v_mfma_f32_16x16x32_bf16 v[108:111], a[136:139], v[156:159], v[108:111]
  buffer_load_dwordx4 v[156:159], v2, s[36:39], s67 offen offset:2048 sc1
  s_waitcnt vmcnt(21)
  v_mfma_f32_16x16x32_bf16 v[32:35], a[140:143], v[160:163], v[32:35]
  v_mfma_f32_16x16x32_bf16 v[36:39], a[140:143], v[164:167], v[36:39]
  v_mfma_f32_16x16x32_bf16 v[40:43], a[140:143], v[168:171], v[40:43]
  v_mfma_f32_16x16x32_bf16 v[44:47], a[140:143], v[172:175], v[44:47]
  buffer_load_dwordx4 v[196:199], v2, s[32:35], s24 offen offset:1024 sc1
  v_mfma_f32_16x16x32_bf16 v[48:51], a[144:147], v[160:163], v[48:51]
  v_mfma_f32_16x16x32_bf16 v[52:55], a[144:147], v[164:167], v[52:55]
  v_mfma_f32_16x16x32_bf16 v[56:59], a[144:147], v[168:171], v[56:59]
  v_mfma_f32_16x16x32_bf16 v[60:63], a[144:147], v[172:175], v[60:63]
  buffer_load_dwordx4 v[200:203], v2, s[32:35], s24 offen offset:2048 sc1
  v_mfma_f32_16x16x32_bf16 v[64:67], a[148:151], v[160:163], v[64:67]
  v_mfma_f32_16x16x32_bf16 v[68:71], a[148:151], v[164:167], v[68:71]
  v_mfma_f32_16x16x32_bf16 v[72:75], a[148:151], v[168:171], v[72:75]
  v_mfma_f32_16x16x32_bf16 v[76:79], a[148:151], v[172:175], v[76:79]
  buffer_load_dwordx4 v[204:207], v2, s[32:35], s24 offen offset:3072 sc1
  v_mfma_f32_16x16x32_bf16 v[80:83], a[152:155], v[160:163], v[80:83]
  s_add_u32 s24, s24, 4096
  v_mfma_f32_16x16x32_bf16 v[84:87], a[152:155], v[164:167], v[84:87]
  v_mfma_f32_16x16x32_bf16 v[88:91], a[152:155], v[168:171], v[88:91]
  v_mfma_f32_16x16x32_bf16 v[92:95], a[152:155], v[172:175], v[92:95]
  v_mfma_f32_16x16x32_bf16 v[96:99], a[156:159], v[160:163], v[96:99]
  buffer_load_dwordx4 v[160:163], v2, s[36:39], s64 offen offset:3072 sc1
  v_mfma_f32_16x16x32_bf16 v[100:103], a[156:159], v[164:167], v[100:103]
  buffer_load_dwordx4 v[164:167], v2, s[36:39], s65 offen offset:3072 sc1
  v_mfma_f32_16x16x32_bf16 v[104:107], a[156:159], v[168:171], v[104:107]
  buffer_load_dwordx4 v[168:171], v2, s[36:39], s66 offen offset:3072 sc1
  v_mfma_f32_16x16x32_bf16 v[108:111], a[156:159], v[172:175], v[108:111]
  buffer_load_dwordx4 v[172:175], v2, s[36:39], s67 offen offset:3072 sc1
  s_waitcnt vmcnt(21)
  v_mfma_f32_16x16x32_bf16 v[32:35], a[160:163], v[112:115], v[32:35]
  s_add_u32 s62, s62, 4096
  v_mfma_f32_16x16x32_bf16 v[36:39], a[160:163], v[116:119], v[36:39]
  s_and_b32 s62, s62, 0x7fff
  v_mfma_f32_16x16x32_bf16 v[40:43], a[160:163], v[120:123], v[40:43]
  s_add_u32 s64, s63, s62
  v_mfma_f32_16x16x32_bf16 v[44:47], a[160:163], v[124:127], v[44:47]
  buffer_load_dwordx4 v[208:211], v2, s[32:35], s24 offen offset:0 sc1
  v_mfma_f32_16x16x32_bf16 v[48:51], a[164:167], v[112:115], v[48:51]
  v_mfma_f32_16x16x32_bf16 v[52:55], a[164:167], v[116:119], v[52:55]
  v_mfma_f32_16x16x32_bf16 v[56:59], a[164:167], v[120:123], v[56:59]
  s_add_u32 s65, s64, 131072
  v_mfma_f32_16x16x32_bf16 v[60:63], a[164:167], v[124:127], v[60:63]
  buffer_load_dwordx4 v[212:215], v2, s[32:35], s24 offen offset:1024 sc1
  v_mfma_f32_16x16x32_bf16 v[64:67], a[168:171], v[112:115], v[64:67]
  v_mfma_f32_16x16x32_bf16 v[68:71], a[168:171], v[116:119], v[68:71]
  v_mfma_f32_16x16x32_bf16 v[72:75], a[168:171], v[120:123], v[72:75]
  s_add_u32 s66, s64, 262144
  v_mfma_f32_16x16x32_bf16 v[76:79], a[168:171], v[124:127], v[76:79]
  buffer_load_dwordx4 v[216:219], v2, s[32:35], s24 offen offset:2048 sc1
  v_mfma_f32_16x16x32_bf16 v[80:83], a[172:175], v[112:115], v[80:83]
  v_mfma_f32_16x16x32_bf16 v[84:87], a[172:175], v[116:119], v[84:87]
  v_mfma_f32_16x16x32_bf16 v[88:91], a[172:175], v[120:123], v[88:91]
  s_add_u32 s67, s64, 393216
  v_mfma_f32_16x16x32_bf16 v[92:95], a[172:175], v[124:127], v[92:95]
  v_mfma_f32_16x16x32_bf16 v[96:99], a[176:179], v[112:115], v[96:99]
  buffer_load_dwordx4 v[112:115], v2, s[36:39], s64 offen offset:0 sc1
  v_mfma_f32_16x16x32_bf16 v[100:103], a[176:179], v[116:119], v[100:103]
  buffer_load_dwordx4 v[116:119], v2, s[36:39], s65 offen offset:0 sc1
  v_mfma_f32_16x16x32_bf16 v[104:107], a[176:179], v[120:123], v[104:107]
  buffer_load_dwordx4 v[120:123], v2, s[36:39], s66 offen offset:0 sc1
  v_mfma_f32_16x16x32_bf16 v[108:111], a[176:179], v[124:127], v[108:111]
  buffer_load_dwordx4 v[124:127], v2, s[36:39], s67 offen offset:0 sc1
  s_waitcnt vmcnt(21)
  v_mfma_f32_16x16x32_bf16 v[32:35], a[180:183], v[128:131], v[32:35]
  v_mfma_f32_16x16x32_bf16 v[36:39], a[180:183], v[132:135], v[36:39]
  v_mfma_f32_16x16x32_bf16 v[40:43], a[180:183], v[136:139], v[40:43]
  v_mfma_f32_16x16x32_bf16 v[44:47], a[180:183], v[140:143], v[44:47]
  buffer_load_dwordx4 v[220:223], v2, s[32:35], s24 offen offset:3072 sc1
  v_mfma_f32_16x16x32_bf16 v[48:51], a[184:187], v[128:131], v[48:51]
  s_add_u32 s24, s24, 4096
  v_mfma_f32_16x16x32_bf16 v[52:55], a[184:187], v[132:135], v[52:55]
  v_mfma_f32_16x16x32_bf16 v[56:59], a[184:187], v[136:139], v[56:59]
  v_mfma_f32_16x16x32_bf16 v[60:63], a[184:187], v[140:143], v[60:63]
  buffer_load_dwordx4 v[224:227], v2, s[32:35], s24 offen offset:0 sc1
  v_mfma_f32_16x16x32_bf16 v[64:67], a[188:191], v[128:131], v[64:67]
  v_mfma_f32_16x16x32_bf16 v[68:71], a[188:191], v[132:135], v[68:71]
  v_mfma_f32_16x16x32_bf16 v[72:75], a[188:191], v[136:139], v[72:75]
  v_mfma_f32_16x16x32_bf16 v[76:79], a[188:191], v[140:143], v[76:79]
  buffer_load_dwordx4 v[228:231], v2, s[32:35], s24 offen offset:1024 sc1
  v_mfma_f32_16x16x32_bf16 v[80:83], a[192:195], v[128:131], v[80:83]
  v_mfma_f32_16x16x32_bf16 v[84:87], a[192:195], v[132:135], v[84:87]
  v_mfma_f32_16x16x32_bf16 v[88:91], a[192:195], v[136:139], v[88:91]
  v_mfma_f32_16x16x32_bf16 v[92:95], a[192:195], v[140:143], v[92:95]
  v_mfma_f32_16x16x32_bf16 v[96:99], a[196:199], v[128:131], v[96:99]
  buffer_load_dwordx4 v[128:131], v2, s[36:39], s64 offen offset:1024 sc1
  v_mfma_f32_16x16x32_bf16 v[100:103], a[196:199], v[132:135], v[100:103]
  buffer_load_dwordx4 v[132:135], v2, s[36:39], s65 offen offset:1024 sc1
  v_mfma_f32_16x16x32_bf16 v[104:107], a[196:199], v[136:139], v[104:107]
  buffer_load_dwordx4 v[136:139], v2, s[36:39], s66 offen offset:1024 sc1
  v_mfma_f32_16x16x32_bf16 v[108:111], a[196:199], v[140:143], v[108:111]
  buffer_load_dwordx4 v[140:143], v2, s[36:39], s67 offen offset:1024 sc1
  s_waitcnt vmcnt(21)
  v_mfma_f32_16x16x32_bf16 v[32:35], a[200:203], v[144:147], v[32:35]
  v_mfma_f32_16x16x32_bf16 v[36:39], a[200:203], v[148:151], v[36:39]
  v_mfma_f32_16x16x32_bf16 v[40:43], a[200:203], v[152:155], v[40:43]
  v_mfma_f32_16x16x32_bf16 v[44:47], a[200:203], v[156:159], v[44:47]
  buffer_load_dwordx4 v[232:235], v2, s[32:35], s24 offen offset:2048 sc1
  v_mfma_f32_16x16x32_bf16 v[48:51], a[204:207], v[144:147], v[48:51]
  v_mfma_f32_16x16x32_bf16 v[52:55], a[204:207], v[148:151], v[52:55]
  v_mfma_f32_16x16x32_bf16 v[56:59], a[204:207], v[152:155], v[56:59]
  v_mfma_f32_16x16x32_bf16 v[60:63], a[204:207], v[156:159], v[60:63]
  buffer_load_dwordx4 v[236:239], v2, s[32:35], s24 offen offset:3072 sc1
  v_mfma_f32_16x16x32_bf16 v[64:67], a[208:211], v[144:147], v[64:67]
  s_add_u32 s24, s24, 4096
  v_mfma_f32_16x16x32_bf16 v[68:71], a[208:211], v[148:151], v[68:71]
  s_cmp_ge_u32 s24, s61
  s_cselect_b32 s23, 163840, 0
  s_sub_u32 s24, s24, s23
  v_mfma_f32_16x16x32_bf16 v[72:75], a[208:211], v[152:155], v[72:75]
  v_mfma_f32_16x16x32_bf16 v[76:79], a[208:211], v[156:159], v[76:79]
  v_mfma_f32_16x16x32_bf16 v[80:83], a[212:215], v[144:147], v[80:83]
  v_mfma_f32_16x16x32_bf16 v[84:87], a[212:215], v[148:151], v[84:87]
  v_mfma_f32_16x16x32_bf16 v[88:91], a[212:215], v[152:155], v[88:91]
  v_mfma_f32_16x16x32_bf16 v[92:95], a[212:215], v[156:159], v[92:95]
  v_mfma_f32_16x16x32_bf16 v[96:99], a[216:219], v[144:147], v[96:99]
  buffer_load_dwordx4 v[144:147], v2, s[36:39], s64 offen offset:2048 sc1
  v_mfma_f32_16x16x32_bf16 v[100:103], a[216:219], v[148:151], v[100:103]
  buffer_load_dwordx4 v[148:151], v2, s[36:39], s65 offen offset:2048 sc1
  v_mfma_f32_16x16x32_bf16 v[104:107], a[216:219], v[152:155], v[104:107]
  buffer_load_dwordx4 v[152:155], v2, s[36:39], s66 offen offset:2048 sc1
  v_mfma_f32_16x16x32_bf16 v[108:111], a[216:219], v[156:159], v[108:111]
  buffer_load_dwordx4 v[156:159], v2, s[36:39], s67 offen offset:2048 sc1
  s_waitcnt vmcnt(20)
  v_mfma_f32_16x16x32_bf16 v[32:35], a[220:223], v[160:163], v[32:35]
  v_mfma_f32_16x16x32_bf16 v[36:39], a[220:223], v[164:167], v[36:39]
  v_mfma_f32_16x16x32_bf16 v[40:43], a[220:223], v[168:171], v[40:43]
  v_mfma_f32_16x16x32_bf16 v[44:47], a[220:223], v[172:175], v[44:47]
  v_mfma_f32_16x16x32_bf16 v[48:51], a[224:227], v[160:163], v[48:51]
  v_mfma_f32_16x16x32_bf16 v[52:55], a[224:227], v[164:167], v[52:55]
  v_mfma_f32_16x16x32_bf16 v[56:59], a[224:227], v[168:171], v[56:59]
  v_mfma_f32_16x16x32_bf16 v[60:63], a[224:227], v[172:175], v[60:63]
  v_mfma_f32_16x16x32_bf16 v[64:67], a[228:231], v[160:163], v[64:67]
  v_mfma_f32_16x16x32_bf16 v[68:71], a[228:231], v[164:167], v[68:71]
  v_mfma_f32_16x16x32_bf16 v[72:75], a[228:231], v[168:171], v[72:75]
  v_mfma_f32_16x16x32_bf16 v[76:79], a[228:231], v[172:175], v[76:79]
  v_mfma_f32_16x16x32_bf16 v[80:83], a[232:235], v[160:163], v[80:83]
  v_mfma_f32_16x16x32_bf16 v[84:87], a[232:235], v[164:167], v[84:87]
  v_mfma_f32_16x16x32_bf16 v[88:91], a[232:235], v[168:171], v[88:91]
  v_mfma_f32_16x16x32_bf16 v[92:95], a[232:235], v[172:175], v[92:95]
  v_mfma_f32_16x16x32_bf16 v[96:99], a[236:239], v[160:163], v[96:99]
  buffer_load_dwordx4 v[160:163], v2, s[36:39], s64 offen offset:3072 sc1
  v_mfma_f32_16x16x32_bf16 v[100:103], a[236:239], v[164:167], v[100:103]
  buffer_load_dwordx4 v[164:167], v2, s[36:39], s65 offen offset:3072 sc1
  v_mfma_f32_16x16x32_bf16 v[104:107], a[236:239], v[168:171], v[104:107]
  buffer_load_dwordx4 v[168:171], v2, s[36:39], s66 offen offset:3072 sc1
  v_mfma_f32_16x16x32_bf16 v[108:111], a[236:239], v[172:175], v[108:111]
  buffer_load_dwordx4 v[172:175], v2, s[36:39], s67 offen offset:3072 sc1
  s_waitcnt vmcnt(17)
  v_mfma_f32_16x16x32_bf16 v[32:35], a[240:243], v[112:115], v[32:35]
  v_mfma_f32_16x16x32_bf16 v[36:39], a[240:243], v[116:119], v[36:39]
  v_mfma_f32_16x16x32_bf16 v[40:43], a[240:243], v[120:123], v[40:43]
  v_mfma_f32_16x16x32_bf16 v[44:47], a[240:243], v[124:127], v[44:47]
  buffer_load_dwordx4 a[0:3], v240, s[44:47], 0 offen
  v_mfma_f32_16x16x32_bf16 v[48:51], a[244:247], v[112:115], v[48:51]
  v_mfma_f32_16x16x32_bf16 v[52:55], a[244:247], v[116:119], v[52:55]
  buffer_load_dwordx4 a[12:15], v246, s[40:43], s27 offen sc1
  v_mfma_f32_16x16x32_bf16 v[56:59], a[244:247], v[120:123], v[56:59]
  v_mfma_f32_16x16x32_bf16 v[60:63], a[244:247], v[124:127], v[60:63]
  buffer_load_dwordx4 a[4:7], v241, s[44:47], 0 offen
  v_mfma_f32_16x16x32_bf16 v[64:67], a[248:251], v[112:115], v[64:67]
  v_mfma_f32_16x16x32_bf16 v[68:71], a[248:251], v[116:119], v[68:71]
  buffer_load_dwordx4 a[16:19], v247, s[40:43], s27 offen sc1
  v_mfma_f32_16x16x32_bf16 v[72:75], a[248:251], v[120:123], v[72:75]
  v_mfma_f32_16x16x32_bf16 v[76:79], a[248:251], v[124:127], v[76:79]
  buffer_load_dwordx4 a[8:11], v242, s[44:47], 0 offen
  v_mfma_f32_16x16x32_bf16 v[80:83], a[252:255], v[112:115], v[80:83]
  v_mfma_f32_16x16x32_bf16 v[84:87], a[252:255], v[116:119], v[84:87]
  buffer_load_dwordx4 a[20:23], v248, s[40:43], s27 offen sc1
  v_mfma_f32_16x16x32_bf16 v[88:91], a[252:255], v[120:123], v[88:91]
  v_mfma_f32_16x16x32_bf16 v[92:95], a[252:255], v[124:127], v[92:95]
  v_mfma_f32_16x16x32_bf16 v[96:99], v[176:179], v[112:115], v[96:99]
  v_mfma_f32_16x16x32_bf16 v[100:103], v[176:179], v[116:119], v[100:103]
  v_mfma_f32_16x16x32_bf16 v[104:107], v[176:179], v[120:123], v[104:107]
  v_mfma_f32_16x16x32_bf16 v[108:111], v[176:179], v[124:127], v[108:111]
  s_waitcnt vmcnt(16)
  v_mfma_f32_16x16x32_bf16 v[32:35], v[180:183], v[128:131], v[32:35]
  v_mfma_f32_16x16x32_bf16 v[36:39], v[180:183], v[132:135], v[36:39]
  v_mfma_f32_16x16x32_bf16 v[40:43], v[180:183], v[136:139], v[40:43]
  v_mfma_f32_16x16x32_bf16 v[44:47], v[180:183], v[140:143], v[44:47]
  v_mfma_f32_16x16x32_bf16 v[48:51], v[184:187], v[128:131], v[48:51]
  v_mfma_f32_16x16x32_bf16 v[52:55], v[184:187], v[132:135], v[52:55]
  v_mfma_f32_16x16x32_bf16 v[56:59], v[184:187], v[136:139], v[56:59]
  v_mfma_f32_16x16x32_bf16 v[60:63], v[184:187], v[140:143], v[60:63]
  v_mfma_f32_16x16x32_bf16 v[64:67], v[188:191], v[128:131], v[64:67]
  v_mfma_f32_16x16x32_bf16 v[68:71], v[188:191], v[132:135], v[68:71]
  v_mfma_f32_16x16x32_bf16 v[72:75], v[188:191], v[136:139], v[72:75]
  v_mfma_f32_16x16x32_bf16 v[76:79], v[188:191], v[140:143], v[76:79]
  v_mfma_f32_16x16x32_bf16 v[80:83], v[192:195], v[128:131], v[80:83]
  v_mfma_f32_16x16x32_bf16 v[84:87], v[192:195], v[132:135], v[84:87]
  v_mfma_f32_16x16x32_bf16 v[88:91], v[192:195], v[136:139], v[88:91]
  v_mfma_f32_16x16x32_bf16 v[92:95], v[192:195], v[140:143], v[92:95]
  v_mfma_f32_16x16x32_bf16 v[96:99], v[196:199], v[128:131], v[96:99]
  v_mfma_f32_16x16x32_bf16 v[100:103], v[196:199], v[132:135], v[100:103]
  v_mfma_f32_16x16x32_bf16 v[104:107], v[196:199], v[136:139], v[104:107]
  v_mfma_f32_16x16x32_bf16 v[108:111], v[196:199], v[140:143], v[108:111]
  s_waitcnt vmcnt(10)
  v_mfma_f32_16x16x32_bf16 v[32:35], v[200:203], v[144:147], v[32:35]
  v_mfma_f32_16x16x32_bf16 v[36:39], v[200:203], v[148:151], v[36:39]
  v_mfma_f32_16x16x32_bf16 v[40:43], v[200:203], v[152:155], v[40:43]
  v_mfma_f32_16x16x32_bf16 v[44:47], v[200:203], v[156:159], v[44:47]
  v_mfma_f32_16x16x32_bf16 v[48:51], v[204:207], v[144:147], v[48:51]
  v_mfma_f32_16x16x32_bf16 v[52:55], v[204:207], v[148:151], v[52:55]
  v_mfma_f32_16x16x32_bf16 v[56:59], v[204:207], v[152:155], v[56:59]
  v_mfma_f32_16x16x32_bf16 v[60:63], v[204:207], v[156:159], v[60:63]
  v_mfma_f32_16x16x32_bf16 v[64:67], v[208:211], v[144:147], v[64:67]
  v_mfma_f32_16x16x32_bf16 v[68:71], v[208:211], v[148:151], v[68:71]
  v_mfma_f32_16x16x32_bf16 v[72:75], v[208:211], v[152:155], v[72:75]
  v_mfma_f32_16x16x32_bf16 v[76:79], v[208:211], v[156:159], v[76:79]
  v_mfma_f32_16x16x32_bf16 v[80:83], v[212:215], v[144:147], v[80:83]
  v_mfma_f32_16x16x32_bf16 v[84:87], v[212:215], v[148:151], v[84:87]
  v_mfma_f32_16x16x32_bf16 v[88:91], v[212:215], v[152:155], v[88:91]
  v_mfma_f32_16x16x32_bf16 v[92:95], v[212:215], v[156:159], v[92:95]
  v_mfma_f32_16x16x32_bf16 v[96:99], v[216:219], v[144:147], v[96:99]
  v_mfma_f32_16x16x32_bf16 v[100:103], v[216:219], v[148:151], v[100:103]
  v_mfma_f32_16x16x32_bf16 v[104:107], v[216:219], v[152:155], v[104:107]
  v_mfma_f32_16x16x32_bf16 v[108:111], v[216:219], v[156:159], v[108:111]
  s_waitcnt vmcnt(6)
  v_mfma_f32_16x16x32_bf16 v[32:35], v[220:223], v[160:163], v[32:35]
  v_mfma_f32_16x16x32_bf16 v[36:39], v[220:223], v[164:167], v[36:39]
  v_mfma_f32_16x16x32_bf16 v[40:43], v[220:223], v[168:171], v[40:43]
  v_mfma_f32_16x16x32_bf16 v[44:47], v[220:223], v[172:175], v[44:47]
  v_mfma_f32_16x16x32_bf16 v[48:51], v[224:227], v[160:163], v[48:51]
  v_mfma_f32_16x16x32_bf16 v[52:55], v[224:227], v[164:167], v[52:55]
  v_mfma_f32_16x16x32_bf16 v[56:59], v[224:227], v[168:171], v[56:59]
  v_mfma_f32_16x16x32_bf16 v[60:63], v[224:227], v[172:175], v[60:63]
  v_mfma_f32_16x16x32_bf16 v[64:67], v[228:231], v[160:163], v[64:67]
  v_mfma_f32_16x16x32_bf16 v[68:71], v[228:231], v[164:167], v[68:71]
  v_mfma_f32_16x16x32_bf16 v[72:75], v[228:231], v[168:171], v[72:75]
  v_mfma_f32_16x16x32_bf16 v[76:79], v[228:231], v[172:175], v[76:79]
  v_mfma_f32_16x16x32_bf16 v[80:83], v[232:235], v[160:163], v[80:83]
  v_mfma_f32_16x16x32_bf16 v[84:87], v[232:235], v[164:167], v[84:87]
  v_mfma_f32_16x16x32_bf16 v[88:91], v[232:235], v[168:171], v[88:91]
  v_mfma_f32_16x16x32_bf16 v[92:95], v[232:235], v[172:175], v[92:95]
  v_mfma_f32_16x16x32_bf16 v[96:99], v[236:239], v[160:163], v[96:99]
  v_mfma_f32_16x16x32_bf16 v[100:103], v[236:239], v[164:167], v[100:103]
  v_mfma_f32_16x16x32_bf16 v[104:107], v[236:239], v[168:171], v[104:107]
  v_mfma_f32_16x16x32_bf16 v[108:111], v[236:239], v[172:175], v[108:111]
  v_and_b32 v16, 15, v1
  v_mul_u32_u24 v16, 336, v16
  v_lshrrev_b32 v17, 4, v1
  v_lshl_add_u32 v16, v17, 4, v16
  s_mul_i32 s23, s20, 21504
  v_add_u32 v16, s23, v16
  s_barrier
  ds_write_b128 v16, v[32:35] offset:0
  ds_write_b128 v16, v[36:39] offset:5376
  ds_write_b128 v16, v[40:43] offset:10752
  ds_write_b128 v16, v[44:47] offset:16128
  ds_write_b128 v16, v[48:51] offset:64
  ds_write_b128 v16, v[52:55] offset:5440
  ds_write_b128 v16, v[56:59] offset:10816
  ds_write_b128 v16, v[60:63] offset:16192
  ds_write_b128 v16, v[64:67] offset:128
  ds_write_b128 v16, v[68:71] offset:5504
  ds_write_b128 v16, v[72:75] offset:10880
  ds_write_b128 v16, v[76:79] offset:16256
  ds_write_b128 v16, v[80:83] offset:192
  ds_write_b128 v16, v[84:87] offset:5568
  ds_write_b128 v16, v[88:91] offset:10944
  ds_write_b128 v16, v[92:95] offset:16320
  ds_write_b128 v16, v[96:99] offset:256
  ds_write_b128 v16, v[100:103] offset:5632
  ds_write_b128 v16, v[104:107] offset:11008
  ds_write_b128 v16, v[108:111] offset:16384
  s_waitcnt vmcnt(0)
  v_accvgpr_read_b32 v112, a0
  v_accvgpr_read_b32 v113, a1
  v_accvgpr_read_b32 v114, a2
  v_accvgpr_read_b32 v115, a3
  v_accvgpr_read_b32 v116, a4
  v_accvgpr_read_b32 v117, a5
  v_accvgpr_read_b32 v118, a6
  v_accvgpr_read_b32 v119, a7
  v_accvgpr_read_b32 v120, a8
  v_accvgpr_read_b32 v121, a9
  v_accvgpr_read_b32 v122, a10
  v_accvgpr_read_b32 v123, a11
  v_accvgpr_read_b32 v124, a12
  v_accvgpr_read_b32 v125, a13
  v_accvgpr_read_b32 v126, a14
  v_accvgpr_read_b32 v127, a15
  v_accvgpr_read_b32 v128, a16
  v_accvgpr_read_b32 v129, a17
  v_accvgpr_read_b32 v130, a18
  v_accvgpr_read_b32 v131, a19
  v_accvgpr_read_b32 v132, a20
  v_accvgpr_read_b32 v133, a21
  v_accvgpr_read_b32 v134, a22
  v_accvgpr_read_b32 v135, a23
  s_waitcnt lgkmcnt(0)
  s_barrier
  ds_read_b128 v[32:35], v243 offset:0
  ds_read_b128 v[36:39], v243 offset:16
  ds_read_b128 v[40:43], v243 offset:21504
  ds_read_b128 v[44:47], v243 offset:21520
  ds_read_b128 v[48:51], v243 offset:43008
  ds_read_b128 v[52:55], v243 offset:43024
  ds_read_b128 v[56:59], v243 offset:64512
  ds_read_b128 v[60:63], v243 offset:64528
  ds_read_b128 v[64:67], v249 offset:0
  ds_read_b128 v[68:71], v249 offset:16
  ds_read_b128 v[72:75], v244 offset:0
  ds_read_b128 v[76:79], v244 offset:16
  ds_read_b128 v[80:83], v244 offset:21504
  ds_read_b128 v[84:87], v244 offset:21520
  ds_read_b128 v[88:91], v244 offset:43008
  ds_read_b128 v[92:95], v244 offset:43024
  ds_read_b128 v[96:99], v244 offset:64512
  ds_read_b128 v[100:103], v244 offset:64528
  ds_read_b128 v[104:107], v250 offset:0
  ds_read_b128 v[108:111], v250 offset:16
  ds_read_b128 v[136:139], v245 offset:0
  ds_read_b128 v[140:143], v245 offset:16
  ds_read_b128 v[144:147], v245 offset:21504
  ds_read_b128 v[148:151], v245 offset:21520
  ds_read_b128 v[152:155], v245 offset:43008
  ds_read_b128 v[156:159], v245 offset:43024
  ds_read_b128 v[160:163], v245 offset:64512
  ds_read_b128 v[164:167], v245 offset:64528
  ds_read_b128 v[168:171], v251 offset:0
  ds_read_b128 v[172:175], v251 offset:16
  s_waitcnt lgkmcnt(10)
  v_add_f32 v32, v32, v40
  v_add_f32 v48, v48, v56
  v_add_f32 v33, v33, v41
  v_add_f32 v49, v49, v57
  v_add_f32 v34, v34, v42
  v_add_f32 v50, v50, v58
  v_add_f32 v35, v35, v43
  v_add_f32 v51, v51, v59
  v_add_f32 v36, v36, v44
  v_add_f32 v52, v52, v60
  v_add_f32 v37, v37, v45
  v_add_f32 v53, v53, v61
  v_add_f32 v38, v38, v46
  v_add_f32 v54, v54, v62
  v_add_f32 v39, v39, v47
  v_add_f32 v55, v55, v63
  v_add_f32 v32, v32, v48
  v_add_f32 v33, v33, v49
  v_add_f32 v34, v34, v50
  v_add_f32 v35, v35, v51
  v_add_f32 v36, v36, v52
  v_add_f32 v37, v37, v53
  v_add_f32 v38, v38, v54
  v_add_f32 v39, v39, v55
  v_cvt_pk_bf16_f32 v40, v32, v33
  v_lshlrev_b32 v42, 16, v112
  v_and_b32 v43, 0xffff0000, v112
  v_and_b32 v41, 0xffff0000, v40
  v_lshlrev_b32 v40, 16, v40
  v_add_f32 v40, v40, v42
  v_add_f32 v41, v41, v43
  v_cvt_pk_bf16_f32 v40, v40, v41
  v_lshlrev_b32 v42, 16, v124
  v_and_b32 v43, 0xffff0000, v124
  v_add_f32 v42, v42, v64
  v_add_f32 v43, v43, v65
  v_cvt_pk_bf16_f32 v42, v42, v43
  v_and_b32 v41, 0xffff0000, v40
  v_lshlrev_b32 v40, 16, v40
  v_and_b32 v43, 0xffff0000, v42
  v_lshlrev_b32 v42, 16, v42
  v_add_f32 v40, v40, v42
  v_add_f32 v41, v41, v43
  v_cvt_pk_bf16_f32 v44, v40, v41
  v_cvt_pk_bf16_f32 v40, v34, v35
  v_lshlrev_b32 v42, 16, v113
  v_and_b32 v43, 0xffff0000, v113
  v_and_b32 v41, 0xffff0000, v40
  v_lshlrev_b32 v40, 16, v40
  v_add_f32 v40, v40, v42
  v_add_f32 v41, v41, v43
  v_cvt_pk_bf16_f32 v40, v40, v41
  v_lshlrev_b32 v42, 16, v125
  v_and_b32 v43, 0xffff0000, v125
  v_add_f32 v42, v42, v66
  v_add_f32 v43, v43, v67
  v_cvt_pk_bf16_f32 v42, v42, v43
  v_and_b32 v41, 0xffff0000, v40
  v_lshlrev_b32 v40, 16, v40
  v_and_b32 v43, 0xffff0000, v42
  v_lshlrev_b32 v42, 16, v42
  v_add_f32 v40, v40, v42
  v_add_f32 v41, v41, v43
  v_cvt_pk_bf16_f32 v45, v40, v41
  v_cvt_pk_bf16_f32 v40, v36, v37
  v_lshlrev_b32 v42, 16, v114
  v_and_b32 v43, 0xffff0000, v114
  v_and_b32 v41, 0xffff0000, v40
  v_lshlrev_b32 v40, 16, v40
  v_add_f32 v40, v40, v42
  v_add_f32 v41, v41, v43
  v_cvt_pk_bf16_f32 v40, v40, v41
  v_lshlrev_b32 v42, 16, v126
  v_and_b32 v43, 0xffff0000, v126
  v_add_f32 v42, v42, v68
  v_add_f32 v43, v43, v69
  v_cvt_pk_bf16_f32 v42, v42, v43
  v_and_b32 v41, 0xffff0000, v40
  v_lshlrev_b32 v40, 16, v40
  v_and_b32 v43, 0xffff0000, v42
  v_lshlrev_b32 v42, 16, v42
  v_add_f32 v40, v40, v42
  v_add_f32 v41, v41, v43
  v_cvt_pk_bf16_f32 v46, v40, v41
  v_cvt_pk_bf16_f32 v40, v38, v39
  v_lshlrev_b32 v42, 16, v115
  v_and_b32 v43, 0xffff0000, v115
  v_and_b32 v41, 0xffff0000, v40
  v_lshlrev_b32 v40, 16, v40
  v_add_f32 v40, v40, v42
  v_add_f32 v41, v41, v43
  v_cvt_pk_bf16_f32 v40, v40, v41
  v_lshlrev_b32 v42, 16, v127
  v_and_b32 v43, 0xffff0000, v127
  v_add_f32 v42, v42, v70
  v_add_f32 v43, v43, v71
  v_cvt_pk_bf16_f32 v42, v42, v43
  v_and_b32 v41, 0xffff0000, v40
  v_lshlrev_b32 v40, 16, v40
  v_and_b32 v43, 0xffff0000, v42
  v_lshlrev_b32 v42, 16, v42
  v_add_f32 v40, v40, v42
  v_add_f32 v41, v41, v43
  v_cvt_pk_bf16_f32 v47, v40, v41
  buffer_store_dwordx4 v[44:47], v240, s[48:51], 0 offen
  s_waitcnt lgkmcnt(10)
  v_add_f32 v72, v72, v80
  v_add_f32 v88, v88, v96
  v_add_f32 v73, v73, v81
  v_add_f32 v89, v89, v97
  v_add_f32 v74, v74, v82
  v_add_f32 v90, v90, v98
  v_add_f32 v75, v75, v83
  v_add_f32 v91, v91, v99
  v_add_f32 v76, v76, v84
  v_add_f32 v92, v92, v100
  v_add_f32 v77, v77, v85
  v_add_f32 v93, v93, v101
  v_add_f32 v78, v78, v86
  v_add_f32 v94, v94, v102
  v_add_f32 v79, v79, v87
  v_add_f32 v95, v95, v103
  v_add_f32 v72, v72, v88
  v_add_f32 v73, v73, v89
  v_add_f32 v74, v74, v90
  v_add_f32 v75, v75, v91
  v_add_f32 v76, v76, v92
  v_add_f32 v77, v77, v93
  v_add_f32 v78, v78, v94
  v_add_f32 v79, v79, v95
  v_cvt_pk_bf16_f32 v80, v72, v73
  v_lshlrev_b32 v82, 16, v116
  v_and_b32 v83, 0xffff0000, v116
  v_and_b32 v81, 0xffff0000, v80
  v_lshlrev_b32 v80, 16, v80
  v_add_f32 v80, v80, v82
  v_add_f32 v81, v81, v83
  v_cvt_pk_bf16_f32 v80, v80, v81
  v_lshlrev_b32 v82, 16, v128
  v_and_b32 v83, 0xffff0000, v128
  v_add_f32 v82, v82, v104
  v_add_f32 v83, v83, v105
  v_cvt_pk_bf16_f32 v82, v82, v83
  v_and_b32 v81, 0xffff0000, v80
  v_lshlrev_b32 v80, 16, v80
  v_and_b32 v83, 0xffff0000, v82
  v_lshlrev_b32 v82, 16, v82
  v_add_f32 v80, v80, v82
  v_add_f32 v81, v81, v83
  v_cvt_pk_bf16_f32 v84, v80, v81
  v_cvt_pk_bf16_f32 v80, v74, v75
  v_lshlrev_b32 v82, 16, v117
  v_and_b32 v83, 0xffff0000, v117
  v_and_b32 v81, 0xffff0000, v80
  v_lshlrev_b32 v80, 16, v80
  v_add_f32 v80, v80, v82
  v_add_f32 v81, v81, v83
  v_cvt_pk_bf16_f32 v80, v80, v81
  v_lshlrev_b32 v82, 16, v129
  v_and_b32 v83, 0xffff0000, v129
  v_add_f32 v82, v82, v106
  v_add_f32 v83, v83, v107
  v_cvt_pk_bf16_f32 v82, v82, v83
  v_and_b32 v81, 0xffff0000, v80
  v_lshlrev_b32 v80, 16, v80
  v_and_b32 v83, 0xffff0000, v82
  v_lshlrev_b32 v82, 16, v82
  v_add_f32 v80, v80, v82
  v_add_f32 v81, v81, v83
  v_cvt_pk_bf16_f32 v85, v80, v81
  v_cvt_pk_bf16_f32 v80, v76, v77
  v_lshlrev_b32 v82, 16, v118
  v_and_b32 v83, 0xffff0000, v118
  v_and_b32 v81, 0xffff0000, v80
  v_lshlrev_b32 v80, 16, v80
  v_add_f32 v80, v80, v82
  v_add_f32 v81, v81, v83
  v_cvt_pk_bf16_f32 v80, v80, v81
  v_lshlrev_b32 v82, 16, v130
  v_and_b32 v83, 0xffff0000, v130
  v_add_f32 v82, v82, v108
  v_add_f32 v83, v83, v109
  v_cvt_pk_bf16_f32 v82, v82, v83
  v_and_b32 v81, 0xffff0000, v80
  v_lshlrev_b32 v80, 16, v80
  v_and_b32 v83, 0xffff0000, v82
  v_lshlrev_b32 v82, 16, v82
  v_add_f32 v80, v80, v82
  v_add_f32 v81, v81, v83
  v_cvt_pk_bf16_f32 v86, v80, v81
  v_cvt_pk_bf16_f32 v80, v78, v79
  v_lshlrev_b32 v82, 16, v119
  v_and_b32 v83, 0xffff0000, v119
  v_and_b32 v81, 0xffff0000, v80
  v_lshlrev_b32 v80, 16, v80
  v_add_f32 v80, v80, v82
  v_add_f32 v81, v81, v83
  v_cvt_pk_bf16_f32 v80, v80, v81
  v_lshlrev_b32 v82, 16, v131
  v_and_b32 v83, 0xffff0000, v131
  v_add_f32 v82, v82, v110
  v_add_f32 v83, v83, v111
  v_cvt_pk_bf16_f32 v82, v82, v83
  v_and_b32 v81, 0xffff0000, v80
  v_lshlrev_b32 v80, 16, v80
  v_and_b32 v83, 0xffff0000, v82
  v_lshlrev_b32 v82, 16, v82
  v_add_f32 v80, v80, v82
  v_add_f32 v81, v81, v83
  v_cvt_pk_bf16_f32 v87, v80, v81
  buffer_store_dwordx4 v[84:87], v241, s[48:51], 0 offen
  s_waitcnt lgkmcnt(0)
  v_add_f32 v136, v136, v144
  v_add_f32 v152, v152, v160
  v_add_f32 v137, v137, v145
  v_add_f32 v153, v153, v161
  v_add_f32 v138, v138, v146
  v_add_f32 v154, v154, v162
  v_add_f32 v139, v139, v147
  v_add_f32 v155, v155, v163
  v_add_f32 v140, v140, v148
  v_add_f32 v156, v156, v164
  v_add_f32 v141, v141, v149
  v_add_f32 v157, v157, v165
  v_add_f32 v142, v142, v150
  v_add_f32 v158, v158, v166
  v_add_f32 v143, v143, v151
  v_add_f32 v159, v159, v167
  v_add_f32 v136, v136, v152
  v_add_f32 v137, v137, v153
  v_add_f32 v138, v138, v154
  v_add_f32 v139, v139, v155
  v_add_f32 v140, v140, v156
  v_add_f32 v141, v141, v157
  v_add_f32 v142, v142, v158
  v_add_f32 v143, v143, v159
  v_cvt_pk_bf16_f32 v144, v136, v137
  v_lshlrev_b32 v146, 16, v120
  v_and_b32 v147, 0xffff0000, v120
  v_and_b32 v145, 0xffff0000, v144
  v_lshlrev_b32 v144, 16, v144
  v_add_f32 v144, v144, v146
  v_add_f32 v145, v145, v147
  v_cvt_pk_bf16_f32 v144, v144, v145
  v_lshlrev_b32 v146, 16, v132
  v_and_b32 v147, 0xffff0000, v132
  v_add_f32 v146, v146, v168
  v_add_f32 v147, v147, v169
  v_cvt_pk_bf16_f32 v146, v146, v147
  v_and_b32 v145, 0xffff0000, v144
  v_lshlrev_b32 v144, 16, v144
  v_and_b32 v147, 0xffff0000, v146
  v_lshlrev_b32 v146, 16, v146
  v_add_f32 v144, v144, v146
  v_add_f32 v145, v145, v147
  v_cvt_pk_bf16_f32 v148, v144, v145
  v_cvt_pk_bf16_f32 v144, v138, v139
  v_lshlrev_b32 v146, 16, v121
  v_and_b32 v147, 0xffff0000, v121
  v_and_b32 v145, 0xffff0000, v144
  v_lshlrev_b32 v144, 16, v144
  v_add_f32 v144, v144, v146
  v_add_f32 v145, v145, v147
  v_cvt_pk_bf16_f32 v144, v144, v145
  v_lshlrev_b32 v146, 16, v133
  v_and_b32 v147, 0xffff0000, v133
  v_add_f32 v146, v146, v170
  v_add_f32 v147, v147, v171
  v_cvt_pk_bf16_f32 v146, v146, v147
  v_and_b32 v145, 0xffff0000, v144
  v_lshlrev_b32 v144, 16, v144
  v_and_b32 v147, 0xffff0000, v146
  v_lshlrev_b32 v146, 16, v146
  v_add_f32 v144, v144, v146
  v_add_f32 v145, v145, v147
  v_cvt_pk_bf16_f32 v149, v144, v145
  v_cvt_pk_bf16_f32 v144, v140, v141
  v_lshlrev_b32 v146, 16, v122
  v_and_b32 v147, 0xffff0000, v122
  v_and_b32 v145, 0xffff0000, v144
  v_lshlrev_b32 v144, 16, v144
  v_add_f32 v144, v144, v146
  v_add_f32 v145, v145, v147
  v_cvt_pk_bf16_f32 v144, v144, v145
  v_lshlrev_b32 v146, 16, v134
  v_and_b32 v147, 0xffff0000, v134
  v_add_f32 v146, v146, v172
  v_add_f32 v147, v147, v173
  v_cvt_pk_bf16_f32 v146, v146, v147
  v_and_b32 v145, 0xffff0000, v144
  v_lshlrev_b32 v144, 16, v144
  v_and_b32 v147, 0xffff0000, v146
  v_lshlrev_b32 v146, 16, v146
  v_add_f32 v144, v144, v146
  v_add_f32 v145, v145, v147
  v_cvt_pk_bf16_f32 v150, v144, v145
  v_cvt_pk_bf16_f32 v144, v142, v143
  v_lshlrev_b32 v146, 16, v123
  v_and_b32 v147, 0xffff0000, v123
  v_and_b32 v145, 0xffff0000, v144
  v_lshlrev_b32 v144, 16, v144
  v_add_f32 v144, v144, v146
  v_add_f32 v145, v145, v147
  v_cvt_pk_bf16_f32 v144, v144, v145
  v_lshlrev_b32 v146, 16, v135
  v_and_b32 v147, 0xffff0000, v135
  v_add_f32 v146, v146, v174
  v_add_f32 v147, v147, v175
  v_cvt_pk_bf16_f32 v146, v146, v147
  v_and_b32 v145, 0xffff0000, v144
  v_lshlrev_b32 v144, 16, v144
  v_and_b32 v147, 0xffff0000, v146
  v_lshlrev_b32 v146, 16, v146
  v_add_f32 v144, v144, v146
  v_add_f32 v145, v145, v147
  v_cvt_pk_bf16_f32 v151, v144, v145
  buffer_store_dwordx4 v[148:151], v242, s[48:51], 0 offen
fa_end:
  s_endpgm
fa_p1stubK:
  s_call_b64 s[76:77], fa_p1sub
  s_branch fa_p1backK
fa_p1stubV:
  s_call_b64 s[76:77], fa_p1sub
  s_branch fa_p1backV
fa_p1sub:
  s_cmp_eq_u32 s28, 6
  s_cbranch_scc1 fa_p1sub6
  s_cmp_eq_u32 s28, 3
  s_cbranch_scc0 fa_p1sub0
  s_mov_b32 s48, s60
  s_mov_b32 s49, s61
  s_mov_b32 s50, s75
  s_lshl_b32 s74, s22, 2
  s_add_u32 s74, s74, s20
  s_lshl_b32 s74, s74, 16
  s_mov_b32 s73, 2097152
fa_p1sub0:
  s_cmp_eq_u32 s28, s71
  s_cselect_b32 s23, s70, 1073741824
  v_mov_b32 v16, 1073741824
  v_mov_b32 v17, 1
  v_writelane_b32 v16, s23, 0
  buffer_store_byte v17, v16, s[56:59], 0 offen sc1
  s_setpc_b64 s[76:77]
fa_p1sub6:
  s_mov_b32 s34, 0
  s_mov_b32 s36, s60
  s_mov_b32 s37, s61
  s_mov_b32 s38, s75
  s_lshr_b32 s27, s20, 1
  s_lshl_b32 s27, s27, 18
  s_mov_b32 s25, 524288
  v_lshlrev_b32 v229, 2, v1
  buffer_load_dword v228, v229, s[56:59], 0 offen sc1
  s_setpc_b64 s[76:77]
fa_ln_spin:
  s_mov_b32 s83, 200000
fa_ln_spin2:
  buffer_load_dword v228, v229, s[56:59], 0 offen sc1
  s_waitcnt vmcnt(0)
  v_cmp_ne_u32 vcc, 0x01010101, v228
  s_cbranch_vccz fa_ln_ok
  s_sleep 8
  s_sub_u32 s83, s83, 1
  s_cmp_lg_u32 s83, 0
  s_cbranch_scc1 fa_ln_spin2
  s_branch fa_ln_ok
fa_kv_spin:
  s_mov_b32 s83, 200000
fa_kv_spin2:
  buffer_load_dword v228, v230, s[40:43], 0 offen sc1
  s_waitcnt vmcnt(0)
  v_cmp_eq_u32 vcc, 0, v228
  s_cbranch_vccz fa_kv_ok
  s_sleep 8
  s_sub_u32 s83, s83, 1
  s_cmp_lg_u32 s83, 0
  s_cbranch_scc1 fa_kv_spin2
  s_branch fa_kv_ok
fa_top8:
  s_cmp_lg_u32 s20, 0
  s_cbranch_scc1 fa_notop
  s_mov_b32 s23, 2621440
  s_mov_b32 s31, 2625536
  buffer_load_dwordx4 v[32:35], v2, s[40:43], s23 offen offset:0 sc1
  buffer_load_dwordx4 v[36:39], v2, s[40:43], s23 offen offset:1024 sc1
  buffer_load_dwordx4 v[40:43], v2, s[40:43], s23 offen offset:2048 sc1
  buffer_load_dwordx4 v[44:47], v2, s[40:43], s23 offen offset:3072 sc1
  buffer_load_dwordx4 v[48:51], v2, s[40:43], s31 offen offset:0 sc1
  buffer_load_dwordx4 v[52:55], v2, s[40:43], s31 offen offset:1024 sc1
  buffer_load_dwordx4 v[56:59], v2, s[40:43], s31 offen offset:2048 sc1
  buffer_load_dwordx4 v[60:63], v2, s[40:43], s31 offen offset:3072 sc1
  v_mov_b32 v21, 0
  v_mov_b32 v22, 0
  v_and_b32 v23, 7, v1
  s_mov_b32 s23, 0
  s_waitcnt vmcnt(0)
fa_top:
  v_max3_u32 v20, v32, v33, v34
  v_max3_u32 v24, v35, v36, v37
  v_max3_u32 v20, v20, v38, v39
  v_max3_u32 v24, v24, v40, v41
  v_max3_u32 v20, v20, v42, v43
  v_max3_u32 v24, v24, v44, v45
  v_max3_u32 v20, v20, v46, v47
  v_max3_u32 v24, v24, v48, v49
  v_max3_u32 v20, v20, v50, v51
  v_max3_u32 v24, v24, v52, v53
  v_max3_u32 v20, v20, v54, v55
  v_max3_u32 v24, v24, v56, v57
  v_max3_u32 v20, v20, v58, v59
  v_max3_u32 v24, v24, v60, v61
  v_max3_u32 v20, v20, v62, v63
  v_max_u32 v20, v20, v24
  s_nop 1
  v_max_u32_dpp v20, v20, v20 quad_perm:[1,0,3,2] row_mask:0xf bank_mask:0xf
  s_nop 1
  v_max_u32_dpp v20, v20, v20 quad_perm:[2,3,0,1] row_mask:0xf bank_mask:0xf
  s_nop 1
  v_max_u32_dpp v20, v20, v20 row_half_mirror row_mask:0xf bank_mask:0xf
  s_nop 1
  v_max_u32_dpp v20, v20, v20 row_mirror row_mask:0xf bank_mask:0xf
  v_mov_b32 v24, v20
  s_nop 1
  v_permlane16_swap_b32 v20, v24
  v_max_u32 v20, v20, v24
  v_mov_b32 v24, v20
  s_nop 1
  v_permlane32_swap_b32 v20, v24
  v_max_u32 v20, v20, v24
  v_add_u32 v21, v21, v20
  v_cmp_eq_u32 vcc, s23, v23
  v_sub_u32 v32, v32, v20
  v_sub_u32 v33, v33, v20
  v_sub_u32 v34, v34, v20
  v_sub_u32 v35, v35, v20
  v_sub_u32 v36, v36, v20
  v_sub_u32 v37, v37, v20
  v_sub_u32 v38, v38, v20
  v_sub_u32 v39, v39, v20
  v_sub_u32 v40, v40, v20
  v_sub_u32 v41, v41, v20
  v_sub_u32 v42, v42, v20
  v_sub_u32 v43, v43, v20
  v_sub_u32 v44, v44, v20
  v_sub_u32 v45, v45, v20
  v_sub_u32 v46, v46, v20
  v_sub_u32 v47, v47, v20
  v_sub_u32 v48, v48, v20
  v_sub_u32 v49, v49, v20
  v_sub_u32 v50, v50, v20
  v_sub_u32 v51, v51, v20
  v_sub_u32 v52, v52, v20
  v_sub_u32 v53, v53, v20
  v_sub_u32 v54, v54, v20
  v_sub_u32 v55, v55, v20
  v_sub_u32 v56, v56, v20
  v_sub_u32 v57, v57, v20
  v_sub_u32 v58, v58, v20
  v_sub_u32 v59, v59, v20
  v_sub_u32 v60, v60, v20
  v_sub_u32 v61, v61, v20
  v_sub_u32 v62, v62, v20
  v_sub_u32 v63, v63, v20
  v_cndmask_b32 v22, v22, v21, vcc
  s_add_u32 s23, s23, 1
  s_cmp_lt_u32 s23, 8
  s_cbranch_scc1 fa_top
  v_and_b32 v25, 0xffff, v22
  v_sub_u32 v25, 0xffff, v25
  v_and_b32 v25, 2047, v25
  v_ashrrev_i32 v20, 31, v22
  v_not_b32 v20, v20
  v_or_b32 v20, 0x80000000, v20
  v_xor_b32 v26, v22, v20
  v_and_b32 v26, 0xffff0000, v26
  v_mul_f32 v26, 0xbfb8aa3b, v26
  v_exp_f32 v26, v26
  s_nop 0
  v_add_f32 v26, 1.0, v26
  v_rcp_f32 v26, v26
  s_nop 0
  v_cvt_pk_bf16_f32 v26, v26, v26
  v_and_b32 v26, 0xffff0000, v26
  v_lshlrev_b32 v20, 2, v1
  v_add_u32 v20, 2629632, v20
  v_mov_b32 v21, 1073741824
  v_cmp_gt_u32 vcc, 16, v1
  v_add_u32 v25, 1, v25
  v_or_b32 v26, 1, v26
  v_cndmask_b32 v20, v21, v20, vcc
  v_cmp_gt_u32 vcc, 8, v1
  s_nop 1
  v_cndmask_b32 v26, v26, v25, vcc
  buffer_store_dword v26, v20, s[40:43], 0 offen sc1
  s_branch fa_notop
fa_sel_spin:
  s_mov_b32 s83, 200000
fa_sel_spin2:
  buffer_load_dword v15, v10, s[40:43], 0 offen sc1
  s_waitcnt vmcnt(0)
  v_cmp_eq_u32 vcc, 0, v15
  s_cbranch_vccz fa_sel_ok
  s_sleep 8
  s_sub_u32 s83, s83, 1
  s_cmp_lg_u32 s83, 0
  s_cbranch_scc1 fa_sel_spin2
  s_branch fa_sel_ok
fa_fstub:
  s_add_u32 s38, s38, 1
  s_cmp_eq_u32 s38, 2
  s_cbranch_scc0 fa_fst2
  v_mov_b32 v16, 1073741824
  v_mov_b32 v17, 1
  v_writelane_b32 v16, s37, 0
  s_waitcnt vmcnt(8)
  buffer_store_dword v17, v16, s[40:43], 0 offen sc1
  s_mov_b32 s37, 1073741824
fa_fst2:
  s_cmp_ge_u32 s32, 8
  s_cbranch_scc1 fa_f6
  s_cmp_ge_u32 s32, 4
  s_cbranch_scc1 fa_f2
  s_cmp_eq_u32 s32, 1
  s_cbranch_scc1 fa_fret
  s_cmp_eq_u32 s32, 3
  s_cbranch_scc1 fa_f1
  buffer_load_dword v15, v10, s[40:43], 0 offen sc1
  s_branch fa_fret
fa_f1:
  s_waitcnt vmcnt(8)
  v_cmp_eq_u32 vcc, 0, v15
  s_cbranch_vccnz fa_sel_spin
fa_sel_ok:
  s_sub_u32 s23, s2, 192
  v_and_b32 v16, 7, v1
  v_lshlrev_b32 v17, 2, v16
  ds_bpermute_b32 v18, v17, v15
  s_lshl_b32 s33, s23, 6
  s_and_b32 s31, s20, 1
  s_lshl_b32 s31, s31, 5
  s_add_u32 s33, s33, s31
  s_mul_i32 s35, s23, 40960
  s_mul_i32 s31, s20, 320
  s_add_u32 s35, s35, s31
  s_mul_i32 s36, s23, 20480
  s_mul_i32 s31, s20, 640
  s_add_u32 s36, s36, s31
  s_add_u32 s36, s36, 2686976
  s_waitcnt lgkmcnt(0)
  v_add_u32 v18, -1, v18
  v_and_b32 v18, 2047, v18
  v_lshrrev_b32 v19, 4, v18
  v_mul_u32_u24 v19, 20480, v19
  v_and_b32 v18, 15, v18
  v_lshl_add_u32 v19, v18, 4, v19
  v_lshrrev_b32 v18, 3, v1
  v_lshl_add_u32 v19, v18, 8, v19
  s_lshl_b32 s23, s20, 11
  s_lshl_b32 s31, s20, 10
  s_add_u32 s31, s31, 151552
  s_mov_b32 m0, s31
  s_nop 0
  buffer_load_dwordx4 v19, s[40:43], s23 offen sc1 lds
  s_add_u32 s23, s23, 8192
  s_add_u32 s31, s31, 4096
  s_mov_b32 m0, s31
  s_nop 0
  buffer_load_dwordx4 v19, s[40:43], s23 offen sc1 lds
  s_add_u32 s23, s23, 8192
  s_add_u32 s31, s31, 4096
  s_mov_b32 m0, s31
  s_nop 0
  buffer_load_dwordx4 v19, s[40:43], s23 offen sc1 lds
  s_add_u32 s23, s23, 8192
  s_add_u32 s31, s31, 4096
  v_lshrrev_b32 v17, 1, v1
  v_mul_u32_u24 v8, 3456, v17
  v_and_b32 v17, 1, v1
  v_lshl_add_u32 v8, v17, 4, v8
  v_lshrrev_b32 v17, 4, v1
  v_lshrrev_b32 v18, 2, v1
  v_lshl_add_u32 v18, v17, 2, v18
  v_lshlrev_b32 v18, 5, v18
  v_and_b32 v19, 3, v1
  v_lshl_add_u32 v9, v19, 3, v18
  v_add_u32 v9, s34, v9
  v_lshlrev_b32 v10, 4, v16
  v_lshl_add_u32 v10, v17, 7, v10
  v_add_u32 v10, 151552, v10
  v_cmp_gt_u32 vcc, 8, v11
  v_mul_u32_u24 v11, 2560, v11
  v_lshl_add_u32 v11, v17, 4, v11
  v_mov_b32 v19, 1073741824
  v_cndmask_b32 v11, v19, v11, vcc
  v_mov_b32 v232, 0
  v_mov_b32 v233, 0
  v_mov_b32 v234, 0
  v_mov_b32 v235, 0
  s_branch fa_fissueG
fa_f2:
  s_waitcnt vmcnt(8)
  ds_read_b64_tr_b16 a[192:193], v9 offset:0
  ds_read_b64_tr_b16 a[194:195], v9 offset:128
  ds_read_b128 a[212:215], v10 offset:0
  ds_read_b64_tr_b16 a[196:197], v9 offset:1024
  ds_read_b64_tr_b16 a[198:199], v9 offset:1152
  ds_read_b128 a[216:219], v10 offset:512
  ds_read_b64_tr_b16 a[200:201], v9 offset:2048
  ds_read_b64_tr_b16 a[202:203], v9 offset:2176
  ds_read_b128 a[220:223], v10 offset:1024
  ds_read_b64_tr_b16 a[204:205], v9 offset:3072
  ds_read_b64_tr_b16 a[206:207], v9 offset:3200
  ds_read_b128 a[224:227], v10 offset:1536
  ds_read_b64_tr_b16 a[208:209], v9 offset:4096
  ds_read_b64_tr_b16 a[210:211], v9 offset:4224
  ds_read_b128 a[228:231], v10 offset:2048
  v_add_u32 v10, 2560, v10
  s_waitcnt lgkmcnt(0)
  v_mfma_f32_16x16x32_bf16 v[232:235], a[192:195], a[212:215], v[232:235]
  v_mfma_f32_16x16x32_bf16 v[232:235], a[196:199], a[216:219], v[232:235]
  v_mfma_f32_16x16x32_bf16 v[232:235], a[200:203], a[220:223], v[232:235]
  v_mfma_f32_16x16x32_bf16 v[232:235], a[204:207], a[224:227], v[232:235]
  v_mfma_f32_16x16x32_bf16 v[232:235], a[208:211], a[228:231], v[232:235]
  s_cmp_eq_u32 s32, 7
  s_cbranch_scc1 fa_f5
fa_fissueG:
  s_add_u32 m0, s34, 0
  s_nop 0
  buffer_load_dwordx4 v8, s[52:55], s33 offen lds
  s_add_u32 s33, s33, 110592
  s_add_u32 m0, s34, 1024
  s_nop 0
  buffer_load_dwordx4 v8, s[52:55], s33 offen lds
  s_add_u32 s33, s33, 110592
  s_add_u32 m0, s34, 2048
  s_nop 0
  buffer_load_dwordx4 v8, s[52:55], s33 offen lds
  s_add_u32 s33, s33, 110592
  s_add_u32 m0, s34, 3072
  s_nop 0
  buffer_load_dwordx4 v8, s[52:55], s33 offen lds
  s_add_u32 s33, s33, 110592
  s_add_u32 m0, s34, 4096
  s_nop 0
  buffer_load_dwordx4 v8, s[52:55], s33 offen lds
  s_add_u32 s33, s33, 110592
  s_branch fa_fret
fa_f5:
  s_lshl_b32 s23, s20, 9
  v_add_u32 v16, s23, v10
  s_nop 6
  ds_write_b128 v16, v[232:235]
  s_waitcnt lgkmcnt(0)
  s_branch fa_fissueD
fa_f6:
  s_cmp_ge_u32 s32, 10
  s_cbranch_scc1 fa_f8
  s_cmp_eq_u32 s32, 8
  s_cbranch_scc0 fa_f7
  ds_read_b128 v[16:19], v10 offset:0
  ds_read_b128 v[20:23], v10 offset:512
  ds_read_b128 v[24:27], v10 offset:1024
  ds_read_b128 v[28:31], v10 offset:1536
  s_waitcnt lgkmcnt(0)
  v_cvt_pk_bf16_f32 v16, v16, v16
  v_and_b32 v16, 0xffff0000, v16
  v_cvt_pk_bf16_f32 v17, v17, v17
  v_and_b32 v17, 0xffff0000, v17
  v_cvt_pk_bf16_f32 v18, v18, v18
  v_and_b32 v18, 0xffff0000, v18
  v_cvt_pk_bf16_f32 v19, v19, v19
  v_and_b32 v19, 0xffff0000, v19
  v_cvt_pk_bf16_f32 v20, v20, v20
  v_and_b32 v20, 0xffff0000, v20
  v_cvt_pk_bf16_f32 v21, v21, v21
  v_and_b32 v21, 0xffff0000, v21
  v_cvt_pk_bf16_f32 v22, v22, v22
  v_and_b32 v22, 0xffff0000, v22
  v_cvt_pk_bf16_f32 v23, v23, v23
  v_and_b32 v23, 0xffff0000, v23
  v_cvt_pk_bf16_f32 v24, v24, v24
  v_and_b32 v24, 0xffff0000, v24
  v_cvt_pk_bf16_f32 v25, v25, v25
  v_and_b32 v25, 0xffff0000, v25
  v_cvt_pk_bf16_f32 v26, v26, v26
  v_and_b32 v26, 0xffff0000, v26
  v_cvt_pk_bf16_f32 v27, v27, v27
  v_and_b32 v27, 0xffff0000, v27
  v_cvt_pk_bf16_f32 v28, v28, v28
  v_and_b32 v28, 0xffff0000, v28
  v_cvt_pk_bf16_f32 v29, v29, v29
  v_and_b32 v29, 0xffff0000, v29
  v_cvt_pk_bf16_f32 v30, v30, v30
  v_and_b32 v30, 0xffff0000, v30
  v_cvt_pk_bf16_f32 v31, v31, v31
  v_and_b32 v31, 0xffff0000, v31
  v_mul_f32 v236, 0xbfb8aa3b, v16
  v_mul_f32 v237, 0xbfb8aa3b, v17
  v_mul_f32 v238, 0xbfb8aa3b, v18
  v_mul_f32 v239, 0xbfb8aa3b, v19
  v_mul_f32 v240, 0xbfb8aa3b, v20
  v_mul_f32 v241, 0xbfb8aa3b, v21
  v_mul_f32 v242, 0xbfb8aa3b, v22
  v_mul_f32 v243, 0xbfb8aa3b, v23
  v_exp_f32 v236, v236
  v_exp_f32 v237, v237
  v_exp_f32 v238, v238
  v_exp_f32 v239, v239
  v_exp_f32 v240, v240
  v_exp_f32 v241, v241
  v_exp_f32 v242, v242
  v_exp_f32 v243, v243
  v_add_f32 v236, 1.0, v236
  v_add_f32 v237, 1.0, v237
  v_add_f32 v238, 1.0, v238
  v_add_f32 v239, 1.0, v239
  v_add_f32 v240, 1.0, v240
  v_add_f32 v241, 1.0, v241
  v_add_f32 v242, 1.0, v242
  v_add_f32 v243, 1.0, v243
  v_rcp_f32 v236, v236
  v_rcp_f32 v237, v237
  v_rcp_f32 v238, v238
  v_rcp_f32 v239, v239
  v_rcp_f32 v240, v240
  v_rcp_f32 v241, v241
  v_rcp_f32 v242, v242
  v_rcp_f32 v243, v243
  v_mul_f32 v16, v16, v236
  v_mul_f32 v17, v17, v237
  v_mul_f32 v18, v18, v238
  v_mul_f32 v19, v19, v239
  v_mul_f32 v20, v20, v240
  v_mul_f32 v21, v21, v241
  v_mul_f32 v22, v22, v242
  v_mul_f32 v23, v23, v243
  v_cvt_pk_bf16_f32 v16, v16, v16
  v_and_b32 v16, 0xffff0000, v16
  v_cvt_pk_bf16_f32 v17, v17, v17
  v_and_b32 v17, 0xffff0000, v17
  v_cvt_pk_bf16_f32 v18, v18, v18
  v_and_b32 v18, 0xffff0000, v18
  v_cvt_pk_bf16_f32 v19, v19, v19
  v_and_b32 v19, 0xffff0000, v19
  v_cvt_pk_bf16_f32 v20, v20, v20
  v_and_b32 v20, 0xffff0000, v20
  v_cvt_pk_bf16_f32 v21, v21, v21
  v_and_b32 v21, 0xffff0000, v21
  v_cvt_pk_bf16_f32 v22, v22, v22
  v_and_b32 v22, 0xffff0000, v22
  v_cvt_pk_bf16_f32 v23, v23, v23
  v_and_b32 v23, 0xffff0000, v23
  v_mul_f32 v16, v16, v24
  v_mul_f32 v17, v17, v25
  v_mul_f32 v18, v18, v26
  v_mul_f32 v19, v19, v27
  v_mul_f32 v20, v20, v28
  v_mul_f32 v21, v21, v29
  v_mul_f32 v22, v22, v30
  v_mul_f32 v23, v23, v31
  v_cvt_pk_bf16_f32 v232, v16, v17
  v_cvt_pk_bf16_f32 v233, v18, v19
  v_cvt_pk_bf16_f32 v234, v20, v21
  v_cvt_pk_bf16_f32 v235, v22, v23
fa_f7:
  s_waitcnt vmcnt(8)
  ds_read_b64_tr_b16 a[192:193], v6 offset:0
  ds_read_b64_tr_b16 a[194:195], v6 offset:2560
  ds_read_b64_tr_b16 a[196:197], v6 offset:32
  ds_read_b64_tr_b16 a[198:199], v6 offset:2592
  ds_read_b64_tr_b16 a[200:201], v6 offset:64
  ds_read_b64_tr_b16 a[202:203], v6 offset:2624
  ds_read_b64_tr_b16 a[204:205], v6 offset:96
  ds_read_b64_tr_b16 a[206:207], v6 offset:2656
  ds_read_b64_tr_b16 a[208:209], v6 offset:128
  ds_read_b64_tr_b16 a[210:211], v6 offset:2688
  s_waitcnt lgkmcnt(0)
  v_mfma_f32_16x16x32_bf16 v[236:239], a[192:195], v[232:235], 0
  v_mfma_f32_16x16x32_bf16 v[240:243], a[196:199], v[232:235], 0
  v_mfma_f32_16x16x32_bf16 v[244:247], a[200:203], v[232:235], 0
  v_mfma_f32_16x16x32_bf16 v[248:251], a[204:207], v[232:235], 0
  v_mfma_f32_16x16x32_bf16 v[252:255], a[208:211], v[232:235], 0
  s_nop 7
  buffer_store_dwordx4 v[236:239], v11, s[40:43], s36 offen offset:0 sc1
  buffer_store_dwordx4 v[240:243], v11, s[40:43], s36 offen offset:64 sc1
  buffer_store_dwordx4 v[244:247], v11, s[40:43], s36 offen offset:128 sc1
  buffer_store_dwordx4 v[248:251], v11, s[40:43], s36 offen offset:192 sc1
  buffer_store_dwordx4 v[252:255], v11, s[40:43], s36 offen offset:256 sc1
  s_add_u32 s36, s36, 320
  s_cmp_eq_u32 s32, 9
  s_cbranch_scc1 fa_fret
fa_fissueD:
  v_add_u32 v20, 0, v1
  v_mul_u32_u24 v19, 6554, v20
  s_add_u32 m0, s34, 0
  v_lshrrev_b32 v19, 16, v19
  v_mul_u32_u24 v19, 1120, v19
  v_lshl_add_u32 v19, v20, 4, v19
  buffer_load_dwordx4 v19, s[60:63], s35 offen lds
  v_add_u32 v20, 64, v1
  v_mul_u32_u24 v19, 6554, v20
  s_add_u32 m0, s34, 1024
  v_lshrrev_b32 v19, 16, v19
  v_mul_u32_u24 v19, 1120, v19
  v_lshl_add_u32 v19, v20, 4, v19
  buffer_load_dwordx4 v19, s[60:63], s35 offen lds
  v_add_u32 v20, 128, v1
  v_mul_u32_u24 v19, 6554, v20
  s_add_u32 m0, s34, 2048
  v_lshrrev_b32 v19, 16, v19
  v_mul_u32_u24 v19, 1120, v19
  v_lshl_add_u32 v19, v20, 4, v19
  buffer_load_dwordx4 v19, s[60:63], s35 offen lds
  v_add_u32 v20, 192, v1
  v_mul_u32_u24 v19, 6554, v20
  s_add_u32 m0, s34, 3072
  v_lshrrev_b32 v19, 16, v19
  v_mul_u32_u24 v19, 1120, v19
  v_lshl_add_u32 v19, v20, 4, v19
  buffer_load_dwordx4 v19, s[60:63], s35 offen lds
  v_add_u32 v20, 256, v1
  v_mul_u32_u24 v19, 6554, v20
  s_add_u32 m0, s34, 4096
  v_lshrrev_b32 v19, 16, v19
  v_mul_u32_u24 v19, 1120, v19
  v_lshl_add_u32 v19, v20, 4, v19
  buffer_load_dwordx4 v19, s[60:63], s35 offen lds
  s_add_u32 s35, s35, 160
  s_branch fa_fret
fa_f8:
  s_cmp_eq_u32 s32, 10
  s_cbranch_scc1 fa_fret
  s_cmp_ge_u32 s32, 41
  s_cbranch_scc1 fa_fdef
  s_cmp_ge_u32 s32, 21
  s_cbranch_scc1 fa_ftouch
  s_and_b32 s23, s2, 63
  s_lshl_b32 s23, s23, 2
  s_add_u32 s23, s23, 2650112
  s_cmp_eq_u32 s20, 0
  s_cselect_b32 s23, s23, 1073741824
  v_mov_b32 v16, 1073741824
  v_mov_b32 v17, 1
  v_writelane_b32 v16, s23, 0
  buffer_store_dword v17, v16, s[40:43], 0 offen sc1
  s_mov_b32 s32, -1
fa_fret:
  s_add_u32 s32, s32, 1
  s_branch fa_fback
fa_fdef:
  s_cmp_eq_u32 s32, 42
  s_cselect_b32 s32, -1, s32
  s_branch fa_fret
fa_ftouch:
  v_lshlrev_b32 v16, 7, v1
  v_cmp_gt_u32 vcc, 34, v1
  v_mov_b32 v17, 1073741824
  s_sub_u32 s23, s2, 64
  v_cndmask_b32 v16, v17, v16, vcc
  s_cmp_eq_u32 s32, 21
  s_cbranch_scc0 fa_ftouch2
  s_lshl_b32 s23, s23, 1
  s_and_b32 s31, s20, 1
  s_add_u32 s23, s23, s31
  s_mul_i32 s23, s23, 8704
  s_add_u32 s31, s23, 4352
  buffer_load_dword v8, v16, s[52:55], s23 offen
  buffer_load_dword v9, v16, s[52:55], s31 offen
  s_branch fa_fret
fa_ftouch2:
  s_lshl_b32 s23, s23, 2
  s_add_u32 s23, s23, s20
  s_mul_i32 s23, s23, 4352
  buffer_load_dword v8, v16, s[60:63], s23 offen
  s_mov_b32 s32, -1
  s_branch fa_fret
fa_wof_spin:
  s_mov_b32 s83, 200000
fa_wof_spin2:
  buffer_load_dword v8, v9, s[40:43], 0 offen sc1
  s_waitcnt vmcnt(0)
  v_cmp_eq_u32 vcc, 0, v8
  s_cbranch_vccz fa_wof_ok
  s_sleep 8
  s_sub_u32 s83, s83, 1
  s_cmp_lg_u32 s83, 0
  s_cbranch_scc1 fa_wof_spin2
  s_branch fa_wof_ok
fa_sel4_spin:
  s_mov_b32 s83, 200000
fa_sel4_spin2:
  buffer_load_dword v15, v10, s[40:43], 0 offen sc1
  s_waitcnt vmcnt(0)
  v_cmp_eq_u32 vcc, 0, v15
  s_cbranch_vccz fa_sel4_ok
  s_sleep 8
  s_sub_u32 s83, s83, 1
  s_cmp_lg_u32 s83, 0
  s_cbranch_scc1 fa_sel4_spin2
  s_branch fa_sel4_ok
fa_yf_spin:
  s_mov_b32 s83, 200000
fa_yf_spin2:
  buffer_load_dword v14, v11, s[40:43], 0 offen sc1
  s_waitcnt vmcnt(0)
  v_cmp_eq_u32 vcc, 0, v14
  s_cbranch_vccz fa_yf_ok
  s_sleep 8
  s_sub_u32 s83, s83, 1
  s_cmp_lg_u32 s83, 0
  s_cbranch_scc1 fa_yf_spin2
  s_branch fa_yf_ok
fa_ystub0:
  s_call_b64 s[76:77], fa_ysub
  s_branch fa_yback0
fa_ystub1:
  s_call_b64 s[76:77], fa_ysub
  s_branch fa_yback1
fa_ysub:
  v_cmp_eq_u32 vcc, 0, v14
  s_cbranch_vccnz fa_yf_spin
fa_yf_ok:
  v_mul_u32_u24 v16, 3277, v1
  v_lshrrev_b32 v16, 16, v16
  v_mul_u32_u24 v17, 20, v16
  v_sub_u32 v17, v1, v17
  v_lshlrev_b32 v17, 4, v17
  v_mul_u32_u24 v18, 368640, v16
  v_add_u32 v18, v18, v17
  v_cmp_gt_u32 vcc, 3, v16
  v_mov_b32 v19, 1073741824
  s_mul_i32 s14, s23, 2560
  v_cndmask_b32 v18, v19, v18, vcc
  s_mul_i32 s15, s60, 320
  s_add_u32 s14, s14, s15
  s_add_u32 s14, s14, 2686976
  buffer_load_dwordx4 v[32:35], v18, s[40:43], s14 offen sc1
  s_add_u32 s14, s14, 20480
  buffer_load_dwordx4 v[36:39], v18, s[40:43], s14 offen sc1
  s_add_u32 s14, s14, 20480
  buffer_load_dwordx4 v[40:43], v18, s[40:43], s14 offen sc1
  s_add_u32 s14, s14, 20480
  buffer_load_dwordx4 v[44:47], v18, s[40:43], s14 offen sc1
  s_add_u32 s14, s14, 20480
  buffer_load_dwordx4 v[48:51], v18, s[40:43], s14 offen sc1
  s_add_u32 s14, s14, 20480
  buffer_load_dwordx4 v[52:55], v18, s[40:43], s14 offen sc1
  s_add_u32 s14, s14, 20480
  buffer_load_dwordx4 v[56:59], v18, s[40:43], s14 offen sc1
  s_add_u32 s14, s14, 20480
  buffer_load_dwordx4 v[60:63], v18, s[40:43], s14 offen sc1
  s_add_u32 s14, s14, 20480
  buffer_load_dwordx4 v[64:67], v18, s[40:43], s14 offen sc1
  s_add_u32 s14, s14, 20480
  buffer_load_dwordx4 v[68:71], v18, s[40:43], s14 offen sc1
  s_add_u32 s14, s14, 20480
  buffer_load_dwordx4 v[72:75], v18, s[40:43], s14 offen sc1
  s_add_u32 s14, s14, 20480
  buffer_load_dwordx4 v[76:79], v18, s[40:43], s14 offen sc1
  s_add_u32 s14, s14, 20480
  buffer_load_dwordx4 v[80:83], v18, s[40:43], s14 offen sc1
  s_add_u32 s14, s14, 20480
  buffer_load_dwordx4 v[84:87], v18, s[40:43], s14 offen sc1
  s_add_u32 s14, s14, 20480
  buffer_load_dwordx4 v[88:91], v18, s[40:43], s14 offen sc1
  s_add_u32 s14, s14, 20480
  buffer_load_dwordx4 v[92:95], v18, s[40:43], s14 offen sc1
  s_add_u32 s14, s14, 20480
  buffer_load_dwordx4 v[96:99], v18, s[40:43], s14 offen sc1
  s_add_u32 s14, s14, 20480
  buffer_load_dwordx4 v[100:103], v18, s[40:43], s14 offen sc1
  s_add_u32 s14, s14, 20480
  s_lshl_b32 s14, s20, 10
  s_add_u32 s14, s14, 135168
  v_add_u32 v19, s14, v2
  s_and_b32 s30, s30, 0xffff0000
  s_waitcnt vmcnt(0)
  v_add_f32 v32, v32, v36
  v_add_f32 v33, v33, v37
  v_add_f32 v34, v34, v38
  v_add_f32 v35, v35, v39
  v_add_f32 v32, v32, v40
  v_add_f32 v33, v33, v41
  v_add_f32 v34, v34, v42
  v_add_f32 v35, v35, v43
  v_add_f32 v32, v32, v44
  v_add_f32 v33, v33, v45
  v_add_f32 v34, v34, v46
  v_add_f32 v35, v35, v47
  v_add_f32 v32, v32, v48
  v_add_f32 v33, v33, v49
  v_add_f32 v34, v34, v50
  v_add_f32 v35, v35, v51
  v_add_f32 v32, v32, v52
  v_add_f32 v33, v33, v53
  v_add_f32 v34, v34, v54
  v_add_f32 v35, v35, v55
  v_add_f32 v32, v32, v56
  v_add_f32 v33, v33, v57
  v_add_f32 v34, v34, v58
  v_add_f32 v35, v35, v59
  v_add_f32 v32, v32, v60
  v_add_f32 v33, v33, v61
  v_add_f32 v34, v34, v62
  v_add_f32 v35, v35, v63
  v_add_f32 v32, v32, v64
  v_add_f32 v33, v33, v65
  v_add_f32 v34, v34, v66
  v_add_f32 v35, v35, v67
  v_add_f32 v32, v32, v68
  v_add_f32 v33, v33, v69
  v_add_f32 v34, v34, v70
  v_add_f32 v35, v35, v71
  v_add_f32 v32, v32, v72
  v_add_f32 v33, v33, v73
  v_add_f32 v34, v34, v74
  v_add_f32 v35, v35, v75
  v_add_f32 v32, v32, v76
  v_add_f32 v33, v33, v77
  v_add_f32 v34, v34, v78
  v_add_f32 v35, v35, v79
  v_add_f32 v32, v32, v80
  v_add_f32 v33, v33, v81
  v_add_f32 v34, v34, v82
  v_add_f32 v35, v35, v83
  v_add_f32 v32, v32, v84
  v_add_f32 v33, v33, v85
  v_add_f32 v34, v34, v86
  v_add_f32 v35, v35, v87
  v_add_f32 v32, v32, v88
  v_add_f32 v33, v33, v89
  v_add_f32 v34, v34, v90
  v_add_f32 v35, v35, v91
  v_add_f32 v32, v32, v92
  v_add_f32 v33, v33, v93
  v_add_f32 v34, v34, v94
  v_add_f32 v35, v35, v95
  v_add_f32 v32, v32, v96
  v_add_f32 v33, v33, v97
  v_add_f32 v34, v34, v98
  v_add_f32 v35, v35, v99
  v_add_f32 v32, v32, v100
  v_add_f32 v33, v33, v101
  v_add_f32 v34, v34, v102
  v_add_f32 v35, v35, v103
  ds_write_b128 v19, v[32:35]
  v_add_u32 v19, s14, v17
  s_waitcnt lgkmcnt(0)
  ds_read_b128 v[32:35], v19
  ds_read_b128 v[36:39], v19 offset:320
  ds_read_b128 v[40:43], v19 offset:640
  s_mul_i32 s14, s23, 320
  s_add_u32 s14, s14, 131072
  v_add_u32 v19, s14, v17
  s_waitcnt lgkmcnt(0)
  v_add_f32 v32, v32, v36
  v_add_f32 v32, v32, v40
  v_cvt_pk_bf16_f32 v32, v32, v32
  v_and_b32 v32, 0xffff0000, v32
  v_mul_f32 v32, s30, v32
  v_cvt_pk_bf16_f32 v32, v32, v32
  v_and_b32 v32, 0xffff0000, v32
  v_add_f32 v33, v33, v37
  v_add_f32 v33, v33, v41
  v_cvt_pk_bf16_f32 v33, v33, v33
  v_and_b32 v33, 0xffff0000, v33
  v_mul_f32 v33, s30, v33
  v_cvt_pk_bf16_f32 v33, v33, v33
  v_and_b32 v33, 0xffff0000, v33
  v_add_f32 v34, v34, v38
  v_add_f32 v34, v34, v42
  v_cvt_pk_bf16_f32 v34, v34, v34
  v_and_b32 v34, 0xffff0000, v34
  v_mul_f32 v34, s30, v34
  v_cvt_pk_bf16_f32 v34, v34, v34
  v_and_b32 v34, 0xffff0000, v34
  v_add_f32 v35, v35, v39
  v_add_f32 v35, v35, v43
  v_cvt_pk_bf16_f32 v35, v35, v35
  v_and_b32 v35, 0xffff0000, v35
  v_mul_f32 v35, s30, v35
  v_cvt_pk_bf16_f32 v35, v35, v35
  v_and_b32 v35, 0xffff0000, v35
  ds_write_b128 v19, v[32:35]
  s_waitcnt lgkmcnt(0)
  s_setpc_b64 s[76:77]
fa_ctx_spin:
  s_mov_b32 s83, 200000
fa_ctx_spin2:
  buffer_load_dword v13, v12, s[40:43], 0 offen sc1
  s_waitcnt vmcnt(0)
  v_cmp_eq_u32 vcc, 0, v13
  s_cbranch_vccz fa_ctx_ok
  s_sleep 8
  s_sub_u32 s83, s83, 1
  s_cmp_lg_u32 s83, 0
  s_cbranch_scc1 fa_ctx_spin2
  s_branch fa_ctx_ok
fa_stub0:
  s_call_b64 s[76:77], fa_rare00
  s_call_b64 s[76:77], fa_rare10
  s_branch fa_back0
fa_stub1:
  s_call_b64 s[76:77], fa_rare01
  s_call_b64 s[76:77], fa_rare11
  s_branch fa_back1
fa_stub2:
  s_call_b64 s[76:77], fa_rare00
  s_call_b64 s[76:77], fa_rare10
  s_branch fa_back2
fa_stub3:
  s_call_b64 s[76:77], fa_rare01
  s_call_b64 s[76:77], fa_rare11
  s_branch fa_back3
fa_stub4:
  s_call_b64 s[76:77], fa_rare00
  s_call_b64 s[76:77], fa_rare10
  s_branch fa_back4
fa_stub5:
  s_call_b64 s[76:77], fa_rare11
  s_branch fa_back5
fa_stub6:
  s_call_b64 s[76:77], fa_rare10
  s_branch fa_back6
fa_stub7:
  s_call_b64 s[76:77], fa_rare01
  s_call_b64 s[76:77], fa_rare11
  s_branch fa_back7
fa_stub8:
  s_call_b64 s[76:77], fa_rare10
  s_branch fa_back8
fa_stub9:
  s_call_b64 s[76:77], fa_rare11
  s_branch fa_back9
fa_stub10:
  s_call_b64 s[76:77], fa_rare10
  s_branch fa_back10
fa_stub11:
  s_call_b64 s[76:77], fa_rare11
  s_branch fa_back11
fa_stub12:
  s_call_b64 s[76:77], fa_rare10
  s_branch fa_back12
fa_stub13:
  s_call_b64 s[76:77], fa_rare11
  s_branch fa_back13
fa_codeend:
fa_rare00:
  s_nop 7
  v_max3_f32 v16, v96, v97, v98
  v_max3_f32 v16, v16, v99, v100
  v_max3_f32 v16, v16, v101, v102
  v_max3_f32 v16, v16, v103, 0
  v_mov_b32 v18, v16
  s_nop 1
  v_permlane16_swap_b32 v16, v18
  v_max_f32 v16, v16, v18
  v_mov_b32 v18, v16
  s_nop 1
  v_permlane32_swap_b32 v16, v18
  v_max_f32 v16, v16, v18
  v_sub_f32 v96, v96, v16
  v_sub_f32 v112, v112, v16
  v_sub_f32 v97, v97, v16
  v_sub_f32 v113, v113, v16
  v_sub_f32 v98, v98, v16
  v_sub_f32 v114, v114, v16
  v_sub_f32 v99, v99, v16
  v_sub_f32 v115, v115, v16
  v_sub_f32 v100, v100, v16
  v_sub_f32 v116, v116, v16
  v_sub_f32 v101, v101, v16
  v_sub_f32 v117, v117, v16
  v_sub_f32 v102, v102, v16
  v_sub_f32 v118, v118, v16
  v_sub_f32 v103, v103, v16
  v_sub_f32 v119, v119, v16
  v_max3_f32 v17, v104, v105, v106
  v_max3_f32 v17, v17, v107, v108
  v_max3_f32 v17, v17, v109, v110
  v_max3_f32 v17, v17, v111, 0
  v_mov_b32 v18, v17
  s_nop 1
  v_permlane16_swap_b32 v17, v18
  v_max_f32 v17, v17, v18
  v_mov_b32 v18, v17
  s_nop 1
  v_permlane32_swap_b32 v17, v18
  v_max_f32 v17, v17, v18
  v_sub_f32 v104, v104, v17
  v_sub_f32 v120, v120, v17
  v_sub_f32 v105, v105, v17
  v_sub_f32 v121, v121, v17
  v_sub_f32 v106, v106, v17
  v_sub_f32 v122, v122, v17
  v_sub_f32 v107, v107, v17
  v_sub_f32 v123, v123, v17
  v_sub_f32 v108, v108, v17
  v_sub_f32 v124, v124, v17
  v_sub_f32 v109, v109, v17
  v_sub_f32 v125, v125, v17
  v_sub_f32 v110, v110, v17
  v_sub_f32 v126, v126, v17
  v_sub_f32 v111, v111, v17
  v_sub_f32 v127, v127, v17
  s_call_b64 s[78:79], fa_resc0
  v_exp_f32 v208, v96
  v_exp_f32 v209, v97
  v_exp_f32 v210, v98
  v_add_f32 v224, v208, v209
  v_cvt_pk_bf16_f32 v160, v208, v209
  v_exp_f32 v211, v99
  v_add_f32 v224, v224, v210
  v_exp_f32 v212, v100
  v_add_f32 v224, v224, v211
  v_cvt_pk_bf16_f32 v161, v210, v211
  v_exp_f32 v213, v101
  v_add_f32 v224, v224, v212
  v_exp_f32 v214, v102
  v_add_f32 v224, v224, v213
  v_cvt_pk_bf16_f32 v162, v212, v213
  v_exp_f32 v215, v103
  v_add_f32 v224, v224, v214
  v_exp_f32 v208, v104
  v_add_f32 v224, v224, v215
  v_cvt_pk_bf16_f32 v163, v214, v215
  v_exp_f32 v209, v105
  v_exp_f32 v210, v106
  v_add_f32 v225, v208, v209
  v_cvt_pk_bf16_f32 v164, v208, v209
  v_exp_f32 v211, v107
  v_add_f32 v225, v225, v210
  v_exp_f32 v212, v108
  v_add_f32 v225, v225, v211
  v_cvt_pk_bf16_f32 v165, v210, v211
  v_exp_f32 v213, v109
  v_add_f32 v225, v225, v212
  v_exp_f32 v214, v110
  v_add_f32 v225, v225, v213
  v_cvt_pk_bf16_f32 v166, v212, v213
  v_exp_f32 v215, v111
  v_add_f32 v225, v225, v214
  s_nop 0
  v_add_f32 v225, v225, v215
  v_cvt_pk_bf16_f32 v167, v214, v215
  s_nop 1
  s_setpc_b64 s[76:77]
fa_rare01:
  s_nop 7
  v_max3_f32 v16, v112, v113, v114
  v_max3_f32 v16, v16, v115, v116
  v_max3_f32 v16, v16, v117, v118
  v_max3_f32 v16, v16, v119, 0
  v_mov_b32 v18, v16
  s_nop 1
  v_permlane16_swap_b32 v16, v18
  v_max_f32 v16, v16, v18
  v_mov_b32 v18, v16
  s_nop 1
  v_permlane32_swap_b32 v16, v18
  v_max_f32 v16, v16, v18
  v_sub_f32 v112, v112, v16
  v_sub_f32 v96, v96, v16
  v_sub_f32 v113, v113, v16
  v_sub_f32 v97, v97, v16
  v_sub_f32 v114, v114, v16
  v_sub_f32 v98, v98, v16
  v_sub_f32 v115, v115, v16
  v_sub_f32 v99, v99, v16
  v_sub_f32 v116, v116, v16
  v_sub_f32 v100, v100, v16
  v_sub_f32 v117, v117, v16
  v_sub_f32 v101, v101, v16
  v_sub_f32 v118, v118, v16
  v_sub_f32 v102, v102, v16
  v_sub_f32 v119, v119, v16
  v_sub_f32 v103, v103, v16
  v_max3_f32 v17, v120, v121, v122
  v_max3_f32 v17, v17, v123, v124
  v_max3_f32 v17, v17, v125, v126
  v_max3_f32 v17, v17, v127, 0
  v_mov_b32 v18, v17
  s_nop 1
  v_permlane16_swap_b32 v17, v18
  v_max_f32 v17, v17, v18
  v_mov_b32 v18, v17
  s_nop 1
  v_permlane32_swap_b32 v17, v18
  v_max_f32 v17, v17, v18
  v_sub_f32 v120, v120, v17
  v_sub_f32 v104, v104, v17
  v_sub_f32 v121, v121, v17
  v_sub_f32 v105, v105, v17
  v_sub_f32 v122, v122, v17
  v_sub_f32 v106, v106, v17
  v_sub_f32 v123, v123, v17
  v_sub_f32 v107, v107, v17
  v_sub_f32 v124, v124, v17
  v_sub_f32 v108, v108, v17
  v_sub_f32 v125, v125, v17
  v_sub_f32 v109, v109, v17
  v_sub_f32 v126, v126, v17
  v_sub_f32 v110, v110, v17
  v_sub_f32 v127, v127, v17
  v_sub_f32 v111, v111, v17
  s_call_b64 s[78:79], fa_resc0
  v_exp_f32 v208, v112
  v_exp_f32 v209, v113
  v_exp_f32 v210, v114
  v_add_f32 v224, v208, v209
  v_cvt_pk_bf16_f32 v168, v208, v209
  v_exp_f32 v211, v115
  v_add_f32 v224, v224, v210
  v_exp_f32 v212, v116
  v_add_f32 v224, v224, v211
  v_cvt_pk_bf16_f32 v169, v210, v211
  v_exp_f32 v213, v117
  v_add_f32 v224, v224, v212
  v_exp_f32 v214, v118
  v_add_f32 v224, v224, v213
  v_cvt_pk_bf16_f32 v170, v212, v213
  v_exp_f32 v215, v119
  v_add_f32 v224, v224, v214
  v_exp_f32 v208, v120
  v_add_f32 v224, v224, v215
  v_cvt_pk_bf16_f32 v171, v214, v215
  v_exp_f32 v209, v121
  v_exp_f32 v210, v122
  v_add_f32 v225, v208, v209
  v_cvt_pk_bf16_f32 v172, v208, v209
  v_exp_f32 v211, v123
  v_add_f32 v225, v225, v210
  v_exp_f32 v212, v124
  v_add_f32 v225, v225, v211
  v_cvt_pk_bf16_f32 v173, v210, v211
  v_exp_f32 v213, v125
  v_add_f32 v225, v225, v212
  v_exp_f32 v214, v126
  v_add_f32 v225, v225, v213
  v_cvt_pk_bf16_f32 v174, v212, v213
  v_exp_f32 v215, v127
  v_add_f32 v225, v225, v214
  s_nop 0
  v_add_f32 v225, v225, v215
  v_cvt_pk_bf16_f32 v175, v214, v215
  s_nop 1
  s_setpc_b64 s[76:77]
fa_resc0:
  v_sub_f32 v192, v192, v16
  v_sub_f32 v193, v193, v16
  v_sub_f32 v194, v194, v16
  v_sub_f32 v195, v195, v16
  v_exp_f32 v18, -v16
  v_sub_f32 v196, v196, v17
  v_sub_f32 v197, v197, v17
  v_sub_f32 v198, v198, v17
  v_sub_f32 v199, v199, v17
  v_exp_f32 v19, -v17
  s_nop 0
  v_mul_f32 v228, v228, v18
  v_mul_f32 v229, v229, v19
  v_accvgpr_read_b32 v20, a0
  v_accvgpr_read_b32 v21, a1
  v_accvgpr_read_b32 v22, a2
  v_accvgpr_read_b32 v23, a3
  v_mul_f32 v20, v20, v18
  v_mul_f32 v21, v21, v18
  v_mul_f32 v22, v22, v18
  v_mul_f32 v23, v23, v18
  v_accvgpr_write_b32 a0, v20
  v_accvgpr_write_b32 a1, v21
  v_accvgpr_write_b32 a2, v22
  v_accvgpr_write_b32 a3, v23
  v_accvgpr_read_b32 v20, a4
  v_accvgpr_read_b32 v21, a5
  v_accvgpr_read_b32 v22, a6
  v_accvgpr_read_b32 v23, a7
  v_mul_f32 v20, v20, v19
  v_mul_f32 v21, v21, v19
  v_mul_f32 v22, v22, v19
  v_mul_f32 v23, v23, v19
  v_accvgpr_write_b32 a4, v20
  v_accvgpr_write_b32 a5, v21
  v_accvgpr_write_b32 a6, v22
  v_accvgpr_write_b32 a7, v23
  v_accvgpr_read_b32 v20, a8
  v_accvgpr_read_b32 v21, a9
  v_accvgpr_read_b32 v22, a10
  v_accvgpr_read_b32 v23, a11
  v_mul_f32 v20, v20, v18
  v_mul_f32 v21, v21, v18
  v_mul_f32 v22, v22, v18
  v_mul_f32 v23, v23, v18
  v_accvgpr_write_b32 a8, v20
  v_accvgpr_write_b32 a9, v21
  v_accvgpr_write_b32 a10, v22
  v_accvgpr_write_b32 a11, v23
  v_accvgpr_read_b32 v20, a12
  v_accvgpr_read_b32 v21, a13
  v_accvgpr_read_b32 v22, a14
  v_accvgpr_read_b32 v23, a15
  v_mul_f32 v20, v20, v19
  v_mul_f32 v21, v21, v19
  v_mul_f32 v22, v22, v19
  v_mul_f32 v23, v23, v19
  v_accvgpr_write_b32 a12, v20
  v_accvgpr_write_b32 a13, v21
  v_accvgpr_write_b32 a14, v22
  v_accvgpr_write_b32 a15, v23
  v_accvgpr_read_b32 v20, a16
  v_accvgpr_read_b32 v21, a17
  v_accvgpr_read_b32 v22, a18
  v_accvgpr_read_b32 v23, a19
  v_mul_f32 v20, v20, v18
  v_mul_f32 v21, v21, v18
  v_mul_f32 v22, v22, v18
  v_mul_f32 v23, v23, v18
  v_accvgpr_write_b32 a16, v20
  v_accvgpr_write_b32 a17, v21
  v_accvgpr_write_b32 a18, v22
  v_accvgpr_write_b32 a19, v23
  v_accvgpr_read_b32 v20, a20
  v_accvgpr_read_b32 v21, a21
  v_accvgpr_read_b32 v22, a22
  v_accvgpr_read_b32 v23, a23
  v_mul_f32 v20, v20, v19
  v_mul_f32 v21, v21, v19
  v_mul_f32 v22, v22, v19
  v_mul_f32 v23, v23, v19
  v_accvgpr_write_b32 a20, v20
  v_accvgpr_write_b32 a21, v21
  v_accvgpr_write_b32 a22, v22
  v_accvgpr_write_b32 a23, v23
  v_accvgpr_read_b32 v20, a24
  v_accvgpr_read_b32 v21, a25
  v_accvgpr_read_b32 v22, a26
  v_accvgpr_read_b32 v23, a27
  v_mul_f32 v20, v20, v18
  v_mul_f32 v21, v21, v18
  v_mul_f32 v22, v22, v18
  v_mul_f32 v23, v23, v18
  v_accvgpr_write_b32 a24, v20
  v_accvgpr_write_b32 a25, v21
  v_accvgpr_write_b32 a26, v22
  v_accvgpr_write_b32 a27, v23
  v_accvgpr_read_b32 v20, a28
  v_accvgpr_read_b32 v21, a29
  v_accvgpr_read_b32 v22, a30
  v_accvgpr_read_b32 v23, a31
  v_mul_f32 v20, v20, v19
  v_mul_f32 v21, v21, v19
  v_mul_f32 v22, v22, v19
  v_mul_f32 v23, v23, v19
  v_accvgpr_write_b32 a28, v20
  v_accvgpr_write_b32 a29, v21
  v_accvgpr_write_b32 a30, v22
  v_accvgpr_write_b32 a31, v23
  v_accvgpr_read_b32 v20, a32
  v_accvgpr_read_b32 v21, a33
  v_accvgpr_read_b32 v22, a34
  v_accvgpr_read_b32 v23, a35
  v_mul_f32 v20, v20, v18
  v_mul_f32 v21, v21, v18
  v_mul_f32 v22, v22, v18
  v_mul_f32 v23, v23, v18
  v_accvgpr_write_b32 a32, v20
  v_accvgpr_write_b32 a33, v21
  v_accvgpr_write_b32 a34, v22
  v_accvgpr_write_b32 a35, v23
  v_accvgpr_read_b32 v20, a36
  v_accvgpr_read_b32 v21, a37
  v_accvgpr_read_b32 v22, a38
  v_accvgpr_read_b32 v23, a39
  v_mul_f32 v20, v20, v19
  v_mul_f32 v21, v21, v19
  v_mul_f32 v22, v22, v19
  v_mul_f32 v23, v23, v19
  v_accvgpr_write_b32 a36, v20
  v_accvgpr_write_b32 a37, v21
  v_accvgpr_write_b32 a38, v22
  v_accvgpr_write_b32 a39, v23
  v_accvgpr_read_b32 v20, a40
  v_accvgpr_read_b32 v21, a41
  v_accvgpr_read_b32 v22, a42
  v_accvgpr_read_b32 v23, a43
  v_mul_f32 v20, v20, v18
  v_mul_f32 v21, v21, v18
  v_mul_f32 v22, v22, v18
  v_mul_f32 v23, v23, v18
  v_accvgpr_write_b32 a40, v20
  v_accvgpr_write_b32 a41, v21
  v_accvgpr_write_b32 a42, v22
  v_accvgpr_write_b32 a43, v23
  v_accvgpr_read_b32 v20, a44
  v_accvgpr_read_b32 v21, a45
  v_accvgpr_read_b32 v22, a46
  v_accvgpr_read_b32 v23, a47
  v_mul_f32 v20, v20, v19
  v_mul_f32 v21, v21, v19
  v_mul_f32 v22, v22, v19
  v_mul_f32 v23, v23, v19
  v_accvgpr_write_b32 a44, v20
  v_accvgpr_write_b32 a45, v21
  v_accvgpr_write_b32 a46, v22
  v_accvgpr_write_b32 a47, v23
  v_accvgpr_read_b32 v20, a48
  v_accvgpr_read_b32 v21, a49
  v_accvgpr_read_b32 v22, a50
  v_accvgpr_read_b32 v23, a51
  v_mul_f32 v20, v20, v18
  v_mul_f32 v21, v21, v18
  v_mul_f32 v22, v22, v18
  v_mul_f32 v23, v23, v18
  v_accvgpr_write_b32 a48, v20
  v_accvgpr_write_b32 a49, v21
  v_accvgpr_write_b32 a50, v22
  v_accvgpr_write_b32 a51, v23
  v_accvgpr_read_b32 v20, a52
  v_accvgpr_read_b32 v21, a53
  v_accvgpr_read_b32 v22, a54
  v_accvgpr_read_b32 v23, a55
  v_mul_f32 v20, v20, v19
  v_mul_f32 v21, v21, v19
  v_mul_f32 v22, v22, v19
  v_mul_f32 v23, v23, v19
  v_accvgpr_write_b32 a52, v20
  v_accvgpr_write_b32 a53, v21
  v_accvgpr_write_b32 a54, v22
  v_accvgpr_write_b32 a55, v23
  v_accvgpr_read_b32 v20, a56
  v_accvgpr_read_b32 v21, a57
  v_accvgpr_read_b32 v22, a58
  v_accvgpr_read_b32 v23, a59
  v_mul_f32 v20, v20, v18
  v_mul_f32 v21, v21, v18
  v_mul_f32 v22, v22, v18
  v_mul_f32 v23, v23, v18
  v_accvgpr_write_b32 a56, v20
  v_accvgpr_write_b32 a57, v21
  v_accvgpr_write_b32 a58, v22
  v_accvgpr_write_b32 a59, v23
  v_accvgpr_read_b32 v20, a60
  v_accvgpr_read_b32 v21, a61
  v_accvgpr_read_b32 v22, a62
  v_accvgpr_read_b32 v23, a63
  v_mul_f32 v20, v20, v19
  v_mul_f32 v21, v21, v19
  v_mul_f32 v22, v22, v19
  v_mul_f32 v23, v23, v19
  v_accvgpr_write_b32 a60, v20
  v_accvgpr_write_b32 a61, v21
  v_accvgpr_write_b32 a62, v22
  v_accvgpr_write_b32 a63, v23
  s_setpc_b64 s[78:79]
fa_rare10:
  s_nop 7
  v_max3_f32 v16, v128, v129, v130
  v_max3_f32 v16, v16, v131, v132
  v_max3_f32 v16, v16, v133, v134
  v_max3_f32 v16, v16, v135, 0
  v_mov_b32 v18, v16
  s_nop 1
  v_permlane16_swap_b32 v16, v18
  v_max_f32 v16, v16, v18
  v_mov_b32 v18, v16
  s_nop 1
  v_permlane32_swap_b32 v16, v18
  v_max_f32 v16, v16, v18
  v_sub_f32 v128, v128, v16
  v_sub_f32 v144, v144, v16
  v_sub_f32 v129, v129, v16
  v_sub_f32 v145, v145, v16
  v_sub_f32 v130, v130, v16
  v_sub_f32 v146, v146, v16
  v_sub_f32 v131, v131, v16
  v_sub_f32 v147, v147, v16
  v_sub_f32 v132, v132, v16
  v_sub_f32 v148, v148, v16
  v_sub_f32 v133, v133, v16
  v_sub_f32 v149, v149, v16
  v_sub_f32 v134, v134, v16
  v_sub_f32 v150, v150, v16
  v_sub_f32 v135, v135, v16
  v_sub_f32 v151, v151, v16
  v_max3_f32 v17, v136, v137, v138
  v_max3_f32 v17, v17, v139, v140
  v_max3_f32 v17, v17, v141, v142
  v_max3_f32 v17, v17, v143, 0
  v_mov_b32 v18, v17
  s_nop 1
  v_permlane16_swap_b32 v17, v18
  v_max_f32 v17, v17, v18
  v_mov_b32 v18, v17
  s_nop 1
  v_permlane32_swap_b32 v17, v18
  v_max_f32 v17, v17, v18
  v_sub_f32 v136, v136, v17
  v_sub_f32 v152, v152, v17
  v_sub_f32 v137, v137, v17
  v_sub_f32 v153, v153, v17
  v_sub_f32 v138, v138, v17
  v_sub_f32 v154, v154, v17
  v_sub_f32 v139, v139, v17
  v_sub_f32 v155, v155, v17
  v_sub_f32 v140, v140, v17
  v_sub_f32 v156, v156, v17
  v_sub_f32 v141, v141, v17
  v_sub_f32 v157, v157, v17
  v_sub_f32 v142, v142, v17
  v_sub_f32 v158, v158, v17
  v_sub_f32 v143, v143, v17
  v_sub_f32 v159, v159, v17
  s_call_b64 s[78:79], fa_resc1
  v_exp_f32 v216, v128
  v_exp_f32 v217, v129
  v_exp_f32 v218, v130
  v_add_f32 v226, v216, v217
  v_cvt_pk_bf16_f32 v176, v216, v217
  v_exp_f32 v219, v131
  v_add_f32 v226, v226, v218
  v_exp_f32 v220, v132
  v_add_f32 v226, v226, v219
  v_cvt_pk_bf16_f32 v177, v218, v219
  v_exp_f32 v221, v133
  v_add_f32 v226, v226, v220
  v_exp_f32 v222, v134
  v_add_f32 v226, v226, v221
  v_cvt_pk_bf16_f32 v178, v220, v221
  v_exp_f32 v223, v135
  v_add_f32 v226, v226, v222
  v_exp_f32 v216, v136
  v_add_f32 v226, v226, v223
  v_cvt_pk_bf16_f32 v179, v222, v223
  v_exp_f32 v217, v137
  v_exp_f32 v218, v138
  v_add_f32 v227, v216, v217
  v_cvt_pk_bf16_f32 v180, v216, v217
  v_exp_f32 v219, v139
  v_add_f32 v227, v227, v218
  v_exp_f32 v220, v140
  v_add_f32 v227, v227, v219
  v_cvt_pk_bf16_f32 v181, v218, v219
  v_exp_f32 v221, v141
  v_add_f32 v227, v227, v220
  v_exp_f32 v222, v142
  v_add_f32 v227, v227, v221
  v_cvt_pk_bf16_f32 v182, v220, v221
  v_exp_f32 v223, v143
  v_add_f32 v227, v227, v222
  s_nop 0
  v_add_f32 v227, v227, v223
  v_cvt_pk_bf16_f32 v183, v222, v223
  s_nop 1
  s_setpc_b64 s[76:77]
fa_rare11:
  s_nop 7
  v_max3_f32 v16, v144, v145, v146
  v_max3_f32 v16, v16, v147, v148
  v_max3_f32 v16, v16, v149, v150
  v_max3_f32 v16, v16, v151, 0
  v_mov_b32 v18, v16
  s_nop 1
  v_permlane16_swap_b32 v16, v18
  v_max_f32 v16, v16, v18
  v_mov_b32 v18, v16
  s_nop 1
  v_permlane32_swap_b32 v16, v18
  v_max_f32 v16, v16, v18
  v_sub_f32 v144, v144, v16
  v_sub_f32 v128, v128, v16
  v_sub_f32 v145, v145, v16
  v_sub_f32 v129, v129, v16
  v_sub_f32 v146, v146, v16
  v_sub_f32 v130, v130, v16
  v_sub_f32 v147, v147, v16
  v_sub_f32 v131, v131, v16
  v_sub_f32 v148, v148, v16
  v_sub_f32 v132, v132, v16
  v_sub_f32 v149, v149, v16
  v_sub_f32 v133, v133, v16
  v_sub_f32 v150, v150, v16
  v_sub_f32 v134, v134, v16
  v_sub_f32 v151, v151, v16
  v_sub_f32 v135, v135, v16
  v_max3_f32 v17, v152, v153, v154
  v_max3_f32 v17, v17, v155, v156
  v_max3_f32 v17, v17, v157, v158
  v_max3_f32 v17, v17, v159, 0
  v_mov_b32 v18, v17
  s_nop 1
  v_permlane16_swap_b32 v17, v18
  v_max_f32 v17, v17, v18
  v_mov_b32 v18, v17
  s_nop 1
  v_permlane32_swap_b32 v17, v18
  v_max_f32 v17, v17, v18
  v_sub_f32 v152, v152, v17
  v_sub_f32 v136, v136, v17
  v_sub_f32 v153, v153, v17
  v_sub_f32 v137, v137, v17
  v_sub_f32 v154, v154, v17
  v_sub_f32 v138, v138, v17
  v_sub_f32 v155, v155, v17
  v_sub_f32 v139, v139, v17
  v_sub_f32 v156, v156, v17
  v_sub_f32 v140, v140, v17
  v_sub_f32 v157, v157, v17
  v_sub_f32 v141, v141, v17
  v_sub_f32 v158, v158, v17
  v_sub_f32 v142, v142, v17
  v_sub_f32 v159, v159, v17
  v_sub_f32 v143, v143, v17
  s_call_b64 s[78:79], fa_resc1
  v_exp_f32 v216, v144
  v_exp_f32 v217, v145
  v_exp_f32 v218, v146
  v_add_f32 v226, v216, v217
  v_cvt_pk_bf16_f32 v184, v216, v217
  v_exp_f32 v219, v147
  v_add_f32 v226, v226, v218
  v_exp_f32 v220, v148
  v_add_f32 v226, v226, v219
  v_cvt_pk_bf16_f32 v185, v218, v219
  v_exp_f32 v221, v149
  v_add_f32 v226, v226, v220
  v_exp_f32 v222, v150
  v_add_f32 v226, v226, v221
  v_cvt_pk_bf16_f32 v186, v220, v221
  v_exp_f32 v223, v151
  v_add_f32 v226, v226, v222
  v_exp_f32 v216, v152
  v_add_f32 v226, v226, v223
  v_cvt_pk_bf16_f32 v187, v222, v223
  v_exp_f32 v217, v153
  v_exp_f32 v218, v154
  v_add_f32 v227, v216, v217
  v_cvt_pk_bf16_f32 v188, v216, v217
  v_exp_f32 v219, v155
  v_add_f32 v227, v227, v218
  v_exp_f32 v220, v156
  v_add_f32 v227, v227, v219
  v_cvt_pk_bf16_f32 v189, v218, v219
  v_exp_f32 v221, v157
  v_add_f32 v227, v227, v220
  v_exp_f32 v222, v158
  v_add_f32 v227, v227, v221
  v_cvt_pk_bf16_f32 v190, v220, v221
  v_exp_f32 v223, v159
  v_add_f32 v227, v227, v222
  s_nop 0
  v_add_f32 v227, v227, v223
  v_cvt_pk_bf16_f32 v191, v222, v223
  s_nop 1
  s_setpc_b64 s[76:77]
fa_resc1:
  v_sub_f32 v200, v200, v16
  v_sub_f32 v201, v201, v16
  v_sub_f32 v202, v202, v16
  v_sub_f32 v203, v203, v16
  v_exp_f32 v18, -v16
  v_sub_f32 v204, v204, v17
  v_sub_f32 v205, v205, v17
  v_sub_f32 v206, v206, v17
  v_sub_f32 v207, v207, v17
  v_exp_f32 v19, -v17
  s_nop 0
  v_mul_f32 v230, v230, v18
  v_mul_f32 v231, v231, v19
  v_accvgpr_read_b32 v20, a64
  v_accvgpr_read_b32 v21, a65
  v_accvgpr_read_b32 v22, a66
  v_accvgpr_read_b32 v23, a67
  v_mul_f32 v20, v20, v18
  v_mul_f32 v21, v21, v18
  v_mul_f32 v22, v22, v18
  v_mul_f32 v23, v23, v18
  v_accvgpr_write_b32 a64, v20
  v_accvgpr_write_b32 a65, v21
  v_accvgpr_write_b32 a66, v22
  v_accvgpr_write_b32 a67, v23
  v_accvgpr_read_b32 v20, a68
  v_accvgpr_read_b32 v21, a69
  v_accvgpr_read_b32 v22, a70
  v_accvgpr_read_b32 v23, a71
  v_mul_f32 v20, v20, v19
  v_mul_f32 v21, v21, v19
  v_mul_f32 v22, v22, v19
  v_mul_f32 v23, v23, v19
  v_accvgpr_write_b32 a68, v20
  v_accvgpr_write_b32 a69, v21
  v_accvgpr_write_b32 a70, v22
  v_accvgpr_write_b32 a71, v23
  v_accvgpr_read_b32 v20, a72
  v_accvgpr_read_b32 v21, a73
  v_accvgpr_read_b32 v22, a74
  v_accvgpr_read_b32 v23, a75
  v_mul_f32 v20, v20, v18
  v_mul_f32 v21, v21, v18
  v_mul_f32 v22, v22, v18
  v_mul_f32 v23, v23, v18
  v_accvgpr_write_b32 a72, v20
  v_accvgpr_write_b32 a73, v21
  v_accvgpr_write_b32 a74, v22
  v_accvgpr_write_b32 a75, v23
  v_accvgpr_read_b32 v20, a76
  v_accvgpr_read_b32 v21, a77
  v_accvgpr_read_b32 v22, a78
  v_accvgpr_read_b32 v23, a79
  v_mul_f32 v20, v20, v19
  v_mul_f32 v21, v21, v19
  v_mul_f32 v22, v22, v19
  v_mul_f32 v23, v23, v19
  v_accvgpr_write_b32 a76, v20
  v_accvgpr_write_b32 a77, v21
  v_accvgpr_write_b32 a78, v22
  v_accvgpr_write_b32 a79, v23
  v_accvgpr_read_b32 v20, a80
  v_accvgpr_read_b32 v21, a81
  v_accvgpr_read_b32 v22, a82
  v_accvgpr_read_b32 v23, a83
  v_mul_f32 v20, v20, v18
  v_mul_f32 v21, v21, v18
  v_mul_f32 v22, v22, v18
  v_mul_f32 v23, v23, v18
  v_accvgpr_write_b32 a80, v20
  v_accvgpr_write_b32 a81, v21
  v_accvgpr_write_b32 a82, v22
  v_accvgpr_write_b32 a83, v23
  v_accvgpr_read_b32 v20, a84
  v_accvgpr_read_b32 v21, a85
  v_accvgpr_read_b32 v22, a86
  v_accvgpr_read_b32 v23, a87
  v_mul_f32 v20, v20, v19
  v_mul_f32 v21, v21, v19
  v_mul_f32 v22, v22, v19
  v_mul_f32 v23, v23, v19
  v_accvgpr_write_b32 a84, v20
  v_accvgpr_write_b32 a85, v21
  v_accvgpr_write_b32 a86, v22
  v_accvgpr_write_b32 a87, v23
  v_accvgpr_read_b32 v20, a88
  v_accvgpr_read_b32 v21, a89
  v_accvgpr_read_b32 v22, a90
  v_accvgpr_read_b32 v23, a91
  v_mul_f32 v20, v20, v18
  v_mul_f32 v21, v21, v18
  v_mul_f32 v22, v22, v18
  v_mul_f32 v23, v23, v18
  v_accvgpr_write_b32 a88, v20
  v_accvgpr_write_b32 a89, v21
  v_accvgpr_write_b32 a90, v22
  v_accvgpr_write_b32 a91, v23
  v_accvgpr_read_b32 v20, a92
  v_accvgpr_read_b32 v21, a93
  v_accvgpr_read_b32 v22, a94
  v_accvgpr_read_b32 v23, a95
  v_mul_f32 v20, v20, v19
  v_mul_f32 v21, v21, v19
  v_mul_f32 v22, v22, v19
  v_mul_f32 v23, v23, v19
  v_accvgpr_write_b32 a92, v20
  v_accvgpr_write_b32 a93, v21
  v_accvgpr_write_b32 a94, v22
  v_accvgpr_write_b32 a95, v23
  v_accvgpr_read_b32 v20, a96
  v_accvgpr_read_b32 v21, a97
  v_accvgpr_read_b32 v22, a98
  v_accvgpr_read_b32 v23, a99
  v_mul_f32 v20, v20, v18
  v_mul_f32 v21, v21, v18
  v_mul_f32 v22, v22, v18
  v_mul_f32 v23, v23, v18
  v_accvgpr_write_b32 a96, v20
  v_accvgpr_write_b32 a97, v21
  v_accvgpr_write_b32 a98, v22
  v_accvgpr_write_b32 a99, v23
  v_accvgpr_read_b32 v20, a100
  v_accvgpr_read_b32 v21, a101
  v_accvgpr_read_b32 v22, a102
  v_accvgpr_read_b32 v23, a103
  v_mul_f32 v20, v20, v19
  v_mul_f32 v21, v21, v19
  v_mul_f32 v22, v22, v19
  v_mul_f32 v23, v23, v19
  v_accvgpr_write_b32 a100, v20
  v_accvgpr_write_b32 a101, v21
  v_accvgpr_write_b32 a102, v22
  v_accvgpr_write_b32 a103, v23
  v_accvgpr_read_b32 v20, a104
  v_accvgpr_read_b32 v21, a105
  v_accvgpr_read_b32 v22, a106
  v_accvgpr_read_b32 v23, a107
  v_mul_f32 v20, v20, v18
  v_mul_f32 v21, v21, v18
  v_mul_f32 v22, v22, v18
  v_mul_f32 v23, v23, v18
  v_accvgpr_write_b32 a104, v20
  v_accvgpr_write_b32 a105, v21
  v_accvgpr_write_b32 a106, v22
  v_accvgpr_write_b32 a107, v23
  v_accvgpr_read_b32 v20, a108
  v_accvgpr_read_b32 v21, a109
  v_accvgpr_read_b32 v22, a110
  v_accvgpr_read_b32 v23, a111
  v_mul_f32 v20, v20, v19
  v_mul_f32 v21, v21, v19
  v_mul_f32 v22, v22, v19
  v_mul_f32 v23, v23, v19
  v_accvgpr_write_b32 a108, v20
  v_accvgpr_write_b32 a109, v21
  v_accvgpr_write_b32 a110, v22
  v_accvgpr_write_b32 a111, v23
  v_accvgpr_read_b32 v20, a112
  v_accvgpr_read_b32 v21, a113
  v_accvgpr_read_b32 v22, a114
  v_accvgpr_read_b32 v23, a115
  v_mul_f32 v20, v20, v18
  v_mul_f32 v21, v21, v18
  v_mul_f32 v22, v22, v18
  v_mul_f32 v23, v23, v18
  v_accvgpr_write_b32 a112, v20
  v_accvgpr_write_b32 a113, v21
  v_accvgpr_write_b32 a114, v22
  v_accvgpr_write_b32 a115, v23
  v_accvgpr_read_b32 v20, a116
  v_accvgpr_read_b32 v21, a117
  v_accvgpr_read_b32 v22, a118
  v_accvgpr_read_b32 v23, a119
  v_mul_f32 v20, v20, v19
  v_mul_f32 v21, v21, v19
  v_mul_f32 v22, v22, v19
  v_mul_f32 v23, v23, v19
  v_accvgpr_write_b32 a116, v20
  v_accvgpr_write_b32 a117, v21
  v_accvgpr_write_b32 a118, v22
  v_accvgpr_write_b32 a119, v23
  v_accvgpr_read_b32 v20, a120
  v_accvgpr_read_b32 v21, a121
  v_accvgpr_read_b32 v22, a122
  v_accvgpr_read_b32 v23, a123
  v_mul_f32 v20, v20, v18
  v_mul_f32 v21, v21, v18
  v_mul_f32 v22, v22, v18
  v_mul_f32 v23, v23, v18
  v_accvgpr_write_b32 a120, v20
  v_accvgpr_write_b32 a121, v21
  v_accvgpr_write_b32 a122, v22
  v_accvgpr_write_b32 a123, v23
  v_accvgpr_read_b32 v20, a124
  v_accvgpr_read_b32 v21, a125
  v_accvgpr_read_b32 v22, a126
  v_accvgpr_read_b32 v23, a127
  v_mul_f32 v20, v20, v19
  v_mul_f32 v21, v21, v19
  v_mul_f32 v22, v22, v19
  v_mul_f32 v23, v23, v19
  v_accvgpr_write_b32 a124, v20
  v_accvgpr_write_b32 a125, v21
  v_accvgpr_write_b32 a126, v22
  v_accvgpr_write_b32 a127, v23
  s_setpc_b64 s[78:79]
.section .rodata,"a"
.p2align 6
.amdhsa_kernel fa_kernel
  .amdhsa_next_free_vgpr 512
  .amdhsa_next_free_sgpr 102
  .amdhsa_accum_offset 256
  .amdhsa_group_segment_fixed_size 0
  .amdhsa_kernarg_size 112
  .amdhsa_user_sgpr_count 2
  .amdhsa_user_sgpr_kernarg_segment_ptr 1
  .amdhsa_system_sgpr_workgroup_id_x 1
  .amdhsa_float_denorm_mode_32 3
.end_amdhsa_kernel
.text
```

```asm
; @launch kernel=fa_kernel grid=(256,1,1) block=(256,1,1) lds=163840
.amdgcn_target "amdgcn-amd-amdhsa--gfx950"
.text
.globl fa_kernel
.p2align 8
.type fa_kernel,@function
fa_kernel:
  s_cmp_ge_u32 s2, 256
  s_cbranch_scc1 fa_end
  s_load_dwordx4 s[4:7], s[0:1], 0
  s_load_dwordx2 s[14:15], s[0:1], 56
  s_load_dwordx4 s[8:11], s[0:1], 24
  s_load_dwordx2 s[12:13], s[0:1], 40
  s_load_dwordx4 s[16:19], s[0:1], 96
  s_load_dwordx2 s[60:61], s[0:1], 16
  v_lshrrev_b32 v16, 6, v0
  v_and_b32 v1, 63, v0
  v_readfirstlane_b32 s20, v16
  s_and_b32 s21, s2, 7
  s_lshl_b32 s21, s21, 2
  s_lshr_b32 s23, s2, 3
  s_and_b32 s23, s23, 3
  s_add_u32 s21, s21, s23
  s_lshr_b32 s22, s2, 5
  v_and_b32 v208, 31, v1
  v_lshrrev_b32 v209, 5, v1
  s_lshl_b32 s23, s2, 2
  s_add_u32 s23, s23, s20
  s_lshl_b32 s23, s23, 1
  v_add_u32 v209, s23, v209
  v_lshlrev_b32 v212, 4, v208
  v_mul_u32_u24 v210, 1280, v209
  v_add_u32 v210, v210, v212
  v_cmp_gt_u32 s[64:65], 16, v208
  v_mov_b32 v211, 1073741824
  v_lshlrev_b32 v2, 4, v1
  v_cndmask_b32 v211, v211, v210, s[64:65]
  v_lshrrev_b32 v16, 2, v1
  v_lshrrev_b32 v17, 5, v1
  v_mul_u32_u24 v17, 3, v17
  v_and_b32 v18, 3, v1
  v_xor_b32 v17, v17, v18
  v_lshlrev_b32 v17, 4, v17
  v_lshl_add_u32 v224, v16, 10, v17
  s_lshl_b32 s23, s20, 16
  v_add_u32 v224, s23, v224
  v_add_u32 v225, 15360, v224
  v_add_u32 v226, 30720, v224
  v_add_u32 v227, 46080, v224
  v_and_b32 v16, 3, v16
  v_lshrrev_b32 v17, 4, v1
  v_lshlrev_b32 v17, 6, v17
  v_lshl_add_u32 v16, v16, 13, v17
  s_and_b32 s23, s20, 1
  s_lshl_b32 s23, s23, 17
  v_add_u32 v16, s23, v16
  v_lshl_add_u32 v8, v18, 4, v16
  v_xor_b32 v18, 2, v18
  v_lshl_add_u32 v10, v18, 4, v16
  v_add_u32 v9, 31744, v8
  v_add_u32 v11, 95232, v10
  v_add_u32 v10, 63488, v10
  s_lshl_b32 s24, s20, 12
  s_mov_b32 s26, 0
  s_mov_b32 s27, 0
  s_mov_b32 s25, 262144
  v_bfe_u32 v17, v1, 1, 3
  v_lshlrev_b32 v17, 13, v17
  v_and_b32 v18, 1, v1
  v_lshl_add_u32 v235, v18, 7, v17
  s_lshl_b32 s74, s22, 1
  s_and_b32 s31, s20, 1
  s_add_u32 s74, s74, s31
  s_lshl_b32 s74, s74, 16
  s_mov_b32 s73, 1048576
  s_and_b32 s29, s2, 31
  s_lshl_b32 s29, s29, 2
  s_add_u32 s29, s29, s20
  s_lshl_b32 s29, s29, 11
  v_and_b32 v16, 15, v1
  v_lshlrev_b32 v234, 7, v16
  v_lshlrev_b32 v17, 10, v16
  v_and_b32 v18, 16, v1
  v_lshl_add_u32 v233, v18, 3, v17
  s_and_b32 s30, s21, 3
  s_lshl_b32 s30, s30, 2
  s_add_u32 s30, s30, s20
  s_lshl_b32 s30, s30, 14
  s_waitcnt lgkmcnt(0)
  s_mov_b32 s44, s4
  s_mov_b32 s45, s5
  s_mov_b32 s46, 2621440
  s_mov_b32 s47, 0x20000
  s_mov_b32 s48, s14
  s_mov_b32 s49, s15
  s_mov_b32 s50, 1280
  s_mov_b32 s51, 0x20000
  buffer_load_dwordx4 v[160:163], v210, s[44:47], 0 offen
  buffer_load_dwordx4 v[164:167], v210, s[44:47], 0 offen offset:512
  buffer_load_dwordx4 v[168:171], v211, s[44:47], 0 offen offset:1024
  buffer_load_dwordx4 v[172:175], v212, s[48:51], 0 offen offset:0
  buffer_load_dwordx4 v[176:179], v212, s[48:51], 0 offen offset:512
  buffer_load_dwordx4 v[180:183], v212, s[48:51], 0 offen offset:1024
  s_lshl_b32 s23, s22, 18
  s_add_u32 s62, s6, s23
  s_addc_u32 s63, s7, 0
  s_mov_b32 s32, s62
  s_mov_b32 s33, s63
  s_mov_b32 s34, 262144
  s_mov_b32 s35, 0x20000
  s_cmp_ge_u32 s20, 2
  s_cselect_b32 s62, s10, s8
  s_cselect_b32 s63, s11, s9
  s_lshl_b32 s23, s21, 8
  s_add_u32 s62, s62, s23
  s_addc_u32 s63, s63, 0
  s_mov_b32 s36, s62
  s_mov_b32 s37, s63
  s_mov_b32 s38, 0
  s_mov_b32 s39, 0x20000
  s_sub_u32 s38, 4194304, s23
  buffer_load_dword v231, v235, s[36:39], s74 offen
  buffer_load_dword v232, v233, s[32:35], s30 offen
  s_add_u32 s74, s74, s73
  s_add_u32 s60, s60, s23
  s_addc_u32 s61, s61, 0
  s_sub_u32 s75, 5242880, s23
  s_mov_b32 s48, s62
  s_mov_b32 s49, s63
  s_mov_b32 s50, s38
  s_mov_b32 s51, 0x20000
  s_mov_b32 s40, s18
  s_mov_b32 s41, s19
  s_mov_b32 s42, 67108864
  s_mov_b32 s43, 0x20000
  s_mov_b32 s52, s12
  s_mov_b32 s53, s13
  s_mov_b32 s54, 5242880
  s_mov_b32 s55, 0x20000
  s_mov_b32 s56, s16
  s_mov_b32 s57, s17
  s_mov_b32 s58, 256
  s_mov_b32 s59, 0x20000
  s_lshl_b32 s23, s20, 5
  s_add_u32 s23, s23, s21
  s_lshl_b32 s23, s23, 2
  s_add_u32 s23, s23, 2641920
  s_lshl_b32 s31, s22, 9
  s_add_u32 s80, s23, s31
  s_sub_u32 s31, 7680, s31
  s_add_u32 s3, s23, s31
  s_lshl_b32 s23, s21, 7
  s_lshl_b32 s31, s22, 2
  s_add_u32 s23, s23, s31
  s_add_u32 s82, s23, 2637824
  s_and_b32 s69, s2, 63
  s_lshl_b32 s31, s20, 6
  s_add_u32 s69, s69, s31
  s_lshl_b32 s69, s69, 2
  s_add_u32 s69, s69, 2650112
  s_cmp_ge_u32 s2, 192
  s_cselect_b32 s69, s69, 1073741824
  s_cmp_eq_u32 s20, 0
  s_cselect_b32 s31, s82, 1073741824
  s_cmp_eq_u32 s2, 255
  s_cselect_b32 s23, 2629632, 1073741824
  v_lshl_add_u32 v19, v16, 2, s23
  v_mov_b32 v229, 0
  v_writelane_b32 v19, s80, 0
  v_writelane_b32 v19, s3, 1
  v_writelane_b32 v19, s31, 2
  s_and_b32 s23, s2, 1
  s_lshl_b32 s23, s23, 2
  s_add_u32 s23, s23, s20
  s_lshl_b32 s23, s23, 7
  s_lshr_b32 s31, s2, 1
  s_add_u32 s23, s23, s31
  s_lshl_b32 s23, s23, 2
  s_add_u32 s23, s23, 2654208
  v_writelane_b32 v19, s23, 3
  v_writelane_b32 v19, s69, 4
  buffer_store_dword v229, v19, s[40:43], 0 offen sc1
  s_and_b32 s71, s21, 3
  s_add_u32 s71, s71, 1
  s_lshl_b32 s72, 1, s71
  s_or_b32 s72, s72, 0x48
  s_cmp_eq_u32 s20, 0
  s_cselect_b32 s70, s2, 1073741824
  v_mov_b32 v20, 0
  v_mov_b32 v21, 0
  v_mov_b32 v22, 0
  v_mov_b32 v23, 0
  v_and_b32 v16, 15, v1
  v_lshrrev_b32 v17, 4, v1
  v_lshrrev_b32 v18, 3, v16
  v_mul_u32_u24 v18, 3, v18
  v_xor_b32 v18, v18, v17
  v_lshlrev_b32 v18, 4, v18
  v_lshl_add_u32 v14, v16, 6, v18
  s_and_b32 s23, s20, 1
  s_lshl_b32 s23, s23, 13
  v_add_u32 v14, s23, v14
  v_mfma_f32_32x32x16_bf16 a[0:15], v[20:23], v[20:23], 0
  v_mfma_f32_32x32x16_bf16 a[16:31], v[20:23], v[20:23], 0
  v_mfma_f32_32x32x16_bf16 a[32:47], v[20:23], v[20:23], 0
  v_mfma_f32_32x32x16_bf16 a[48:63], v[20:23], v[20:23], 0
  v_mfma_f32_32x32x16_bf16 a[64:79], v[20:23], v[20:23], 0
  v_mfma_f32_32x32x16_bf16 a[80:95], v[20:23], v[20:23], 0
  v_mfma_f32_32x32x16_bf16 a[96:111], v[20:23], v[20:23], 0
  v_mfma_f32_32x32x16_bf16 a[112:127], v[20:23], v[20:23], 0
  v_mfma_f32_32x32x16_bf16 a[128:143], v[20:23], v[20:23], 0
  v_mfma_f32_32x32x16_bf16 a[144:159], v[20:23], v[20:23], 0
  v_mfma_f32_32x32x16_bf16 a[160:175], v[20:23], v[20:23], 0
  v_mfma_f32_32x32x16_bf16 a[176:191], v[20:23], v[20:23], 0
  v_mfma_f32_32x32x16_bf16 a[192:207], v[20:23], v[20:23], 0
  v_mfma_f32_32x32x16_bf16 a[208:223], v[20:23], v[20:23], 0
  v_mfma_f32_32x32x16_bf16 a[224:239], v[20:23], v[20:23], 0
  v_mfma_f32_32x32x16_bf16 a[240:255], v[20:23], v[20:23], 0
  v_lshrrev_b32 v18, 2, v16
  v_lshlrev_b32 v18, 6, v18
  v_lshl_add_u32 v18, v17, 11, v18
  v_and_b32 v19, 1, v1
  v_lshl_add_u32 v18, v19, 3, v18
  v_bfe_u32 v19, v1, 1, 1
  v_and_b32 v17, 1, v17
  v_lshl_or_b32 v19, v17, 1, v19
  s_lshr_b32 s23, s20, 1
  s_lshl_b32 s23, s23, 13
  s_add_u32 s23, s23, 16384
  v_add_u32 v18, s23, v18
  v_lshl_add_u32 v12, v19, 4, v18
  v_xor_b32 v13, 32, v12
  s_waitcnt vmcnt(3)
  s_mov_b32 m0, s24
  s_nop 0
  buffer_load_dwordx4 v224, s[32:35], s26 offen offset:0 lds
  buffer_load_dwordx4 v225, s[32:35], s26 offen offset:1024 lds
  buffer_load_dwordx4 v226, s[32:35], s26 offen offset:2048 lds
  buffer_load_dwordx4 v227, s[32:35], s26 offen offset:3072 lds
  s_add_u32 m0, s24, 16384
  s_nop 0
  buffer_load_dwordx4 v8, s[36:39], s27 offen offset:0 lds
  buffer_load_dwordx4 v9, s[36:39], s27 offen offset:1024 lds
  buffer_load_dwordx4 v10, s[36:39], s27 offen offset:2048 lds
  buffer_load_dwordx4 v11, s[36:39], s27 offen offset:3072 lds
  s_add_u32 s26, s26, 64
  s_add_u32 s27, s27, s25
  s_add_u32 s24, s24, 32768
  s_and_b32 s24, s24, 0x1ffff
  v_lshlrev_b32 v184, 16, v160
  v_and_b32 v185, 0xffff0000, v160
  v_lshlrev_b32 v186, 16, v161
  v_and_b32 v187, 0xffff0000, v161
  v_lshlrev_b32 v188, 16, v162
  v_and_b32 v189, 0xffff0000, v162
  v_lshlrev_b32 v190, 16, v163
  v_and_b32 v191, 0xffff0000, v163
  v_lshlrev_b32 v192, 16, v164
  v_and_b32 v193, 0xffff0000, v164
  v_lshlrev_b32 v194, 16, v165
  v_and_b32 v195, 0xffff0000, v165
  v_lshlrev_b32 v196, 16, v166
  v_and_b32 v197, 0xffff0000, v166
  v_lshlrev_b32 v198, 16, v167
  v_and_b32 v199, 0xffff0000, v167
  v_lshlrev_b32 v200, 16, v168
  v_and_b32 v201, 0xffff0000, v168
  v_lshlrev_b32 v202, 16, v169
  v_and_b32 v203, 0xffff0000, v169
  v_lshlrev_b32 v204, 16, v170
  v_and_b32 v205, 0xffff0000, v170
  v_lshlrev_b32 v206, 16, v171
  v_and_b32 v207, 0xffff0000, v171
  v_add_f32 v213, v184, v185
  v_add_f32 v214, v186, v187
  v_add_f32 v213, v213, v188
  v_add_f32 v214, v214, v189
  v_add_f32 v213, v213, v190
  v_add_f32 v214, v214, v191
  v_add_f32 v213, v213, v192
  v_add_f32 v214, v214, v193
  v_add_f32 v213, v213, v194
  v_add_f32 v214, v214, v195
  v_add_f32 v213, v213, v196
  v_add_f32 v214, v214, v197
  v_add_f32 v213, v213, v198
  v_add_f32 v214, v214, v199
  v_add_f32 v213, v213, v200
  v_add_f32 v214, v214, v201
  v_add_f32 v213, v213, v202
  v_add_f32 v214, v214, v203
  v_add_f32 v213, v213, v204
  v_add_f32 v214, v214, v205
  v_add_f32 v213, v213, v206
  v_add_f32 v214, v214, v207
  v_add_f32 v213, v213, v214
  s_nop 1
  v_add_f32_dpp v213, v213, v213 quad_perm:[1,0,3,2] row_mask:0xf bank_mask:0xf
  s_nop 1
  v_add_f32_dpp v213, v213, v213 quad_perm:[2,3,0,1] row_mask:0xf bank_mask:0xf
  s_nop 1
  v_add_f32_dpp v213, v213, v213 row_half_mirror row_mask:0xf bank_mask:0xf
  s_nop 1
  v_add_f32_dpp v213, v213, v213 row_mirror row_mask:0xf bank_mask:0xf
  v_mov_b32 v214, v213
  s_nop 1
  v_permlane16_swap_b32 v213, v214
  v_add_f32 v213, v213, v214
  v_mul_f32 v215, 0x3acccccd, v213
  v_mov_b32 v218, 0
  v_mov_b32 v213, 0
  v_sub_f32 v16, v184, v215
  v_fmac_f32 v218, v16, v16
  v_sub_f32 v17, v185, v215
  v_fmac_f32 v218, v17, v17
  v_sub_f32 v18, v186, v215
  v_fmac_f32 v218, v18, v18
  v_sub_f32 v19, v187, v215
  v_fmac_f32 v218, v19, v19
  v_sub_f32 v16, v188, v215
  v_fmac_f32 v218, v16, v16
  v_sub_f32 v17, v189, v215
  v_fmac_f32 v218, v17, v17
  v_sub_f32 v18, v190, v215
  v_fmac_f32 v218, v18, v18
  v_sub_f32 v19, v191, v215
  v_fmac_f32 v218, v19, v19
  v_sub_f32 v16, v192, v215
  v_fmac_f32 v218, v16, v16
  v_sub_f32 v17, v193, v215
  v_fmac_f32 v218, v17, v17
  v_sub_f32 v18, v194, v215
  v_fmac_f32 v218, v18, v18
  v_sub_f32 v19, v195, v215
  v_fmac_f32 v218, v19, v19
  v_sub_f32 v16, v196, v215
  v_fmac_f32 v218, v16, v16
  v_sub_f32 v17, v197, v215
  v_fmac_f32 v218, v17, v17
  v_sub_f32 v18, v198, v215
  v_fmac_f32 v218, v18, v18
  v_sub_f32 v19, v199, v215
  v_fmac_f32 v218, v19, v19
  v_sub_f32 v16, v200, v215
  v_fmac_f32 v213, v16, v16
  v_sub_f32 v17, v201, v215
  v_fmac_f32 v213, v17, v17
  v_sub_f32 v18, v202, v215
  v_fmac_f32 v213, v18, v18
  v_sub_f32 v19, v203, v215
  v_fmac_f32 v213, v19, v19
  v_sub_f32 v16, v204, v215
  v_fmac_f32 v213, v16, v16
  v_sub_f32 v17, v205, v215
  v_fmac_f32 v213, v17, v17
  v_sub_f32 v18, v206, v215
  v_fmac_f32 v213, v18, v18
  v_sub_f32 v19, v207, v215
  v_fmac_f32 v213, v19, v19
  v_cndmask_b32 v213, 0, v213, s[64:65]
  v_add_f32 v213, v213, v218
  s_nop 1
  v_add_f32_dpp v213, v213, v213 quad_perm:[1,0,3,2] row_mask:0xf bank_mask:0xf
  s_nop 1
  v_add_f32_dpp v213, v213, v213 quad_perm:[2,3,0,1] row_mask:0xf bank_mask:0xf
  s_nop 1
  v_add_f32_dpp v213, v213, v213 row_half_mirror row_mask:0xf bank_mask:0xf
  s_nop 1
  v_add_f32_dpp v213, v213, v213 row_mirror row_mask:0xf bank_mask:0xf
  v_mov_b32 v214, v213
  s_nop 1
  v_permlane16_swap_b32 v213, v214
  v_add_f32 v213, v213, v214
  v_mul_f32 v213, 0x3acccccd, v213
  v_cvt_pk_bf16_f32 v213, v213, v213
  v_and_b32 v213, 0xffff0000, v213
  v_add_f32 v213, 0x3727c5ac, v213
  v_cvt_pk_bf16_f32 v213, v213, v213
  v_and_b32 v213, 0xffff0000, v213
  v_sqrt_f32 v213, v213
  v_mov_b32 v216, v215
  v_cvt_pk_bf16_f32 v213, v213, v213
  v_and_b32 v213, 0xffff0000, v213
  v_rcp_f32 v217, v213
  v_cvt_pk_bf16_f32 v216, v216, v216
  v_and_b32 v216, 0xffff0000, v216
  s_mov_b32 m0, s24
  s_nop 0
  buffer_load_dwordx4 v224, s[32:35], s26 offen offset:0 lds
  buffer_load_dwordx4 v225, s[32:35], s26 offen offset:1024 lds
  buffer_load_dwordx4 v226, s[32:35], s26 offen offset:2048 lds
  buffer_load_dwordx4 v227, s[32:35], s26 offen offset:3072 lds
  s_add_u32 m0, s24, 16384
  s_nop 0
  buffer_load_dwordx4 v8, s[36:39], s27 offen offset:0 lds
  buffer_load_dwordx4 v9, s[36:39], s27 offen offset:1024 lds
  buffer_load_dwordx4 v10, s[36:39], s27 offen offset:2048 lds
  buffer_load_dwordx4 v11, s[36:39], s27 offen offset:3072 lds
  s_add_u32 s26, s26, 64
  s_add_u32 s27, s27, s25
  s_add_u32 s24, s24, 32768
  s_and_b32 s24, s24, 0x1ffff
  v_mov_b32 v218, 0
  v_sub_f32 v184, v184, v216
  v_sub_f32 v185, v185, v216
  v_cvt_pk_bf16_f32 v16, v184, v185
  v_lshlrev_b32 v184, 16, v16
  v_and_b32 v185, 0xffff0000, v16
  v_mul_f32 v184, v184, v217
  v_mul_f32 v185, v185, v217
  v_cvt_pk_bf16_f32 v160, v184, v185
  v_lshlrev_b32 v184, 16, v160
  v_and_b32 v185, 0xffff0000, v160
  v_lshlrev_b32 v17, 16, v172
  v_and_b32 v18, 0xffff0000, v172
  v_fmac_f32 v218, v184, v17
  v_fmac_f32 v218, v185, v18
  v_sub_f32 v186, v186, v216
  v_sub_f32 v187, v187, v216
  v_cvt_pk_bf16_f32 v16, v186, v187
  v_lshlrev_b32 v186, 16, v16
  v_and_b32 v187, 0xffff0000, v16
  v_mul_f32 v186, v186, v217
  v_mul_f32 v187, v187, v217
  v_cvt_pk_bf16_f32 v161, v186, v187
  v_lshlrev_b32 v186, 16, v161
  v_and_b32 v187, 0xffff0000, v161
  v_lshlrev_b32 v17, 16, v173
  v_and_b32 v18, 0xffff0000, v173
  v_fmac_f32 v218, v186, v17
  v_fmac_f32 v218, v187, v18
  v_sub_f32 v188, v188, v216
  v_sub_f32 v189, v189, v216
  v_cvt_pk_bf16_f32 v16, v188, v189
  v_lshlrev_b32 v188, 16, v16
  v_and_b32 v189, 0xffff0000, v16
  v_mul_f32 v188, v188, v217
  v_mul_f32 v189, v189, v217
  v_cvt_pk_bf16_f32 v162, v188, v189
  v_lshlrev_b32 v188, 16, v162
  v_and_b32 v189, 0xffff0000, v162
  v_lshlrev_b32 v17, 16, v174
  v_and_b32 v18, 0xffff0000, v174
  v_fmac_f32 v218, v188, v17
  v_fmac_f32 v218, v189, v18
  v_sub_f32 v190, v190, v216
  v_sub_f32 v191, v191, v216
  v_cvt_pk_bf16_f32 v16, v190, v191
  v_lshlrev_b32 v190, 16, v16
  v_and_b32 v191, 0xffff0000, v16
  v_mul_f32 v190, v190, v217
  v_mul_f32 v191, v191, v217
  v_cvt_pk_bf16_f32 v163, v190, v191
  v_lshlrev_b32 v190, 16, v163
  v_and_b32 v191, 0xffff0000, v163
  v_lshlrev_b32 v17, 16, v175
  v_and_b32 v18, 0xffff0000, v175
  v_fmac_f32 v218, v190, v17
  v_fmac_f32 v218, v191, v18
  v_sub_f32 v192, v192, v216
  v_sub_f32 v193, v193, v216
  v_cvt_pk_bf16_f32 v16, v192, v193
  v_lshlrev_b32 v192, 16, v16
  v_and_b32 v193, 0xffff0000, v16
  v_mul_f32 v192, v192, v217
  v_mul_f32 v193, v193, v217
  v_cvt_pk_bf16_f32 v164, v192, v193
  v_lshlrev_b32 v192, 16, v164
  v_and_b32 v193, 0xffff0000, v164
  v_lshlrev_b32 v17, 16, v176
  v_and_b32 v18, 0xffff0000, v176
  v_fmac_f32 v218, v192, v17
  v_fmac_f32 v218, v193, v18
  v_sub_f32 v194, v194, v216
  v_sub_f32 v195, v195, v216
  v_cvt_pk_bf16_f32 v16, v194, v195
  v_lshlrev_b32 v194, 16, v16
  v_and_b32 v195, 0xffff0000, v16
  v_mul_f32 v194, v194, v217
  v_mul_f32 v195, v195, v217
  v_cvt_pk_bf16_f32 v165, v194, v195
  v_lshlrev_b32 v194, 16, v165
  v_and_b32 v195, 0xffff0000, v165
  v_lshlrev_b32 v17, 16, v177
  v_and_b32 v18, 0xffff0000, v177
  v_fmac_f32 v218, v194, v17
  v_fmac_f32 v218, v195, v18
  v_sub_f32 v196, v196, v216
  v_sub_f32 v197, v197, v216
  v_cvt_pk_bf16_f32 v16, v196, v197
  v_lshlrev_b32 v196, 16, v16
  v_and_b32 v197, 0xffff0000, v16
  v_mul_f32 v196, v196, v217
  v_mul_f32 v197, v197, v217
  v_cvt_pk_bf16_f32 v166, v196, v197
  v_lshlrev_b32 v196, 16, v166
  v_and_b32 v197, 0xffff0000, v166
  v_lshlrev_b32 v17, 16, v178
  v_and_b32 v18, 0xffff0000, v178
  v_fmac_f32 v218, v196, v17
  v_fmac_f32 v218, v197, v18
  v_sub_f32 v198, v198, v216
  v_sub_f32 v199, v199, v216
  v_cvt_pk_bf16_f32 v16, v198, v199
  v_lshlrev_b32 v198, 16, v16
  v_and_b32 v199, 0xffff0000, v16
  v_mul_f32 v198, v198, v217
  v_mul_f32 v199, v199, v217
  v_cvt_pk_bf16_f32 v167, v198, v199
  v_lshlrev_b32 v198, 16, v167
  v_and_b32 v199, 0xffff0000, v167
  v_lshlrev_b32 v17, 16, v179
  v_and_b32 v18, 0xffff0000, v179
  v_fmac_f32 v218, v198, v17
  v_fmac_f32 v218, v199, v18
  v_sub_f32 v200, v200, v216
  v_sub_f32 v201, v201, v216
  v_cvt_pk_bf16_f32 v16, v200, v201
  v_lshlrev_b32 v200, 16, v16
  v_and_b32 v201, 0xffff0000, v16
  v_mul_f32 v200, v200, v217
  v_mul_f32 v201, v201, v217
  v_cvt_pk_bf16_f32 v168, v200, v201
  v_lshlrev_b32 v200, 16, v168
  v_and_b32 v201, 0xffff0000, v168
  v_lshlrev_b32 v17, 16, v180
  v_and_b32 v18, 0xffff0000, v180
  v_fmac_f32 v218, v200, v17
  v_fmac_f32 v218, v201, v18
  v_sub_f32 v202, v202, v216
  v_sub_f32 v203, v203, v216
  v_cvt_pk_bf16_f32 v16, v202, v203
  v_lshlrev_b32 v202, 16, v16
  v_and_b32 v203, 0xffff0000, v16
  v_mul_f32 v202, v202, v217
  v_mul_f32 v203, v203, v217
  v_cvt_pk_bf16_f32 v169, v202, v203
  v_lshlrev_b32 v202, 16, v169
  v_and_b32 v203, 0xffff0000, v169
  v_lshlrev_b32 v17, 16, v181
  v_and_b32 v18, 0xffff0000, v181
  v_fmac_f32 v218, v202, v17
  v_fmac_f32 v218, v203, v18
  v_sub_f32 v204, v204, v216
  v_sub_f32 v205, v205, v216
  v_cvt_pk_bf16_f32 v16, v204, v205
  v_lshlrev_b32 v204, 16, v16
  v_and_b32 v205, 0xffff0000, v16
  v_mul_f32 v204, v204, v217
  v_mul_f32 v205, v205, v217
  v_cvt_pk_bf16_f32 v170, v204, v205
  v_lshlrev_b32 v204, 16, v170
  v_and_b32 v205, 0xffff0000, v170
  v_lshlrev_b32 v17, 16, v182
  v_and_b32 v18, 0xffff0000, v182
  v_fmac_f32 v218, v204, v17
  v_fmac_f32 v218, v205, v18
  v_sub_f32 v206, v206, v216
  v_sub_f32 v207, v207, v216
  v_cvt_pk_bf16_f32 v16, v206, v207
  v_lshlrev_b32 v206, 16, v16
  v_and_b32 v207, 0xffff0000, v16
  v_mul_f32 v206, v206, v217
  v_mul_f32 v207, v207, v217
  v_cvt_pk_bf16_f32 v171, v206, v207
  v_lshlrev_b32 v206, 16, v171
  v_and_b32 v207, 0xffff0000, v171
  v_lshlrev_b32 v17, 16, v183
  v_and_b32 v18, 0xffff0000, v183
  v_fmac_f32 v218, v206, v17
  v_fmac_f32 v218, v207, v18
  s_mov_b32 m0, s24
  s_nop 0
  buffer_load_dwordx4 v224, s[32:35], s26 offen offset:0 lds
  buffer_load_dwordx4 v225, s[32:35], s26 offen offset:1024 lds
  buffer_load_dwordx4 v226, s[32:35], s26 offen offset:2048 lds
  buffer_load_dwordx4 v227, s[32:35], s26 offen offset:3072 lds
  s_add_u32 m0, s24, 16384
  s_nop 0
  buffer_load_dwordx4 v8, s[36:39], s27 offen offset:0 lds
  buffer_load_dwordx4 v9, s[36:39], s27 offen offset:1024 lds
  buffer_load_dwordx4 v10, s[36:39], s27 offen offset:2048 lds
  buffer_load_dwordx4 v11, s[36:39], s27 offen offset:3072 lds
  s_add_u32 s26, s26, 64
  s_add_u32 s27, s27, s25
  s_add_u32 s24, s24, 32768
  s_and_b32 s24, s24, 0x1ffff
  v_and_b32 v16, 7, v209
  v_lshlrev_b32 v16, 4, v16
  v_lshl_add_u32 v16, v208, 7, v16
  v_add_u32 v16, 131072, v16
  ds_write_b128 v16, v[160:163] offset:0
  ds_write_b128 v16, v[164:167] offset:4096
  ds_write_b128 v16, v[168:171] offset:8192
  s_nop 1
  v_add_f32_dpp v218, v218, v218 quad_perm:[1,0,3,2] row_mask:0xf bank_mask:0xf
  s_nop 1
  v_add_f32_dpp v218, v218, v218 quad_perm:[2,3,0,1] row_mask:0xf bank_mask:0xf
  s_nop 1
  v_add_f32_dpp v218, v218, v218 row_half_mirror row_mask:0xf bank_mask:0xf
  s_nop 1
  v_add_f32_dpp v218, v218, v218 row_mirror row_mask:0xf bank_mask:0xf
  v_mov_b32 v214, v218
  s_nop 1
  v_permlane16_swap_b32 v218, v214
  v_add_f32 v218, v218, v214
  v_cvt_pk_bf16_f32 v218, v218, v218
  v_and_b32 v218, 0xffff0000, v218
  v_ashrrev_i32 v214, 31, v218
  v_or_b32 v214, 0x80000000, v214
  v_xor_b32 v218, v218, v214
  v_and_b32 v218, 0xffff0000, v218
  v_sub_u32 v214, 0xffff, v209
  v_or_b32 v218, v218, v214
  v_lshlrev_b32 v214, 2, v209
  v_add_u32 v214, 2621440, v214
  v_mov_b32 v19, 1073741824
  v_cmp_eq_u32 vcc, 0, v208
  v_lshlrev_b32 v16, 4, v0
  v_add_u32 v16, 131072, v16
  v_cndmask_b32 v214, v19, v214, vcc
  v_lshrrev_b32 v17, 3, v0
  v_and_b32 v18, 7, v0
  v_lshlrev_b32 v18, 4, v18
  v_lshl_add_u32 v17, v17, 8, v18
  v_cmp_gt_u32 vcc, 128, v0
  s_lshr_b32 s23, s2, 1
  s_mul_i32 s23, s23, 20480
  s_and_b32 s31, s2, 1
  s_lshl_b32 s31, s31, 7
  s_add_u32 s23, s23, s31
  v_cndmask_b32 v18, v19, v17, vcc
  s_mov_b32 s66, s23
  s_add_u32 s67, s23, 8192
  s_add_u32 s68, s23, 16384
  s_mov_b32 m0, s24
  s_nop 0
  buffer_load_dwordx4 v224, s[32:35], s26 offen offset:0 lds
  buffer_load_dwordx4 v225, s[32:35], s26 offen offset:1024 lds
  buffer_load_dwordx4 v226, s[32:35], s26 offen offset:2048 lds
  buffer_load_dwordx4 v227, s[32:35], s26 offen offset:3072 lds
  s_add_u32 m0, s24, 16384
  s_nop 0
  buffer_load_dwordx4 v8, s[36:39], s27 offen offset:0 lds
  buffer_load_dwordx4 v9, s[36:39], s27 offen offset:1024 lds
  buffer_load_dwordx4 v10, s[36:39], s27 offen offset:2048 lds
  buffer_load_dwordx4 v11, s[36:39], s27 offen offset:3072 lds
  s_add_u32 s26, s26, 64
  s_add_u32 s27, s27, s25
  s_add_u32 s24, s24, 32768
  s_and_b32 s24, s24, 0x1ffff
  s_waitcnt vmcnt(24) lgkmcnt(0)
  s_barrier
  ds_read_b128 v[160:163], v16 offset:0
  ds_read_b128 v[164:167], v16 offset:4096
  ds_read_b128 v[168:171], v16 offset:8192
  buffer_load_dword v231, v235, s[36:39], s74 offen
  buffer_load_dword v232, v234, s[32:35], s29 offen
  s_getpc_b64 s[62:63]
fa_pc:
  s_lshr_b32 s23, s2, 3
  s_and_b32 s23, s23, 7
  s_lshl_b32 s23, s23, 2
  s_add_u32 s23, s23, s20
  s_lshl_b32 s23, s23, 11
  s_min_u32 s23, s23, fa_codeend-fa_pc-2048
  v_add_u32 v234, s23, v234
  global_load_dword v231, v234, s[62:63]
  buffer_store_dword v218, v214, s[40:43], 0 offen sc1
  s_mov_b32 s28, 0
  s_waitcnt lgkmcnt(0)
  buffer_store_dwordx4 v[160:163], v17, s[40:43], s66 offen sc1
  buffer_store_dwordx4 v[164:167], v17, s[40:43], s67 offen sc1
  buffer_store_dwordx4 v[168:171], v18, s[40:43], s68 offen sc1
  s_cmp_ge_u32 s20, 2
  s_cbranch_scc1 fa_roleV
  ds_read_b128 v[96:99], v14 offset:0
  ds_read_b128 v[100:103], v14 offset:1024
  ds_read_b128 v[104:107], v14 offset:2048
  ds_read_b128 v[108:111], v14 offset:3072
  ds_read_b128 v[112:115], v14 offset:4096
  ds_read_b128 v[116:119], v14 offset:5120
  ds_read_b128 v[120:123], v14 offset:6144
  ds_read_b128 v[124:127], v14 offset:7168
  ds_read_b64_tr_b16 v[32:33], v12 offset:0
  ds_read_b64_tr_b16 v[34:35], v12 offset:1024
  ds_read_b64_tr_b16 v[36:37], v13 offset:0
  ds_read_b64_tr_b16 v[38:39], v13 offset:1024
  ds_read_b64_tr_b16 v[40:41], v12 offset:256
  ds_read_b64_tr_b16 v[42:43], v12 offset:1280
  ds_read_b64_tr_b16 v[44:45], v13 offset:256
  ds_read_b64_tr_b16 v[46:47], v13 offset:1280
  ds_read_b64_tr_b16 v[48:49], v12 offset:512
  ds_read_b64_tr_b16 v[50:51], v12 offset:1536
  ds_read_b64_tr_b16 v[52:53], v13 offset:512
  ds_read_b64_tr_b16 v[54:55], v13 offset:1536
  ds_read_b64_tr_b16 v[56:57], v12 offset:768
  ds_read_b64_tr_b16 v[58:59], v12 offset:1792
  ds_read_b64_tr_b16 v[60:61], v13 offset:768
  ds_read_b64_tr_b16 v[62:63], v13 offset:1792
  s_waitcnt lgkmcnt(0)
.p2align 6
fa_loopK:
  v_mfma_f32_16x16x32_bf16 a[0:3], v[32:35], v[96:99], a[0:3]
  s_waitcnt vmcnt(17)
  v_mfma_f32_16x16x32_bf16 a[4:7], v[32:35], v[100:103], a[4:7]
  s_barrier
  v_mfma_f32_16x16x32_bf16 a[8:11], v[32:35], v[104:107], a[8:11]
  s_bitcmp1_b32 s72, s28
  ds_read_b64_tr_b16 v[64:65], v12 offset:32768
  v_mfma_f32_16x16x32_bf16 a[12:15], v[32:35], v[108:111], a[12:15]
  s_cbranch_scc1 fa_p1stubK
fa_p1backK:
  v_mfma_f32_16x16x32_bf16 a[16:19], v[32:35], v[112:115], a[16:19]
  s_mov_b32 m0, s24
  ds_read_b64_tr_b16 v[66:67], v12 offset:33792
  v_mfma_f32_16x16x32_bf16 a[20:23], v[32:35], v[116:119], a[20:23]
  buffer_load_dwordx4 v224, s[32:35], s26 offen offset:0 lds
  v_mfma_f32_16x16x32_bf16 a[24:27], v[32:35], v[120:123], a[24:27]
  ds_read_b128 v[128:131], v14 offset:32768
  v_mfma_f32_16x16x32_bf16 a[28:31], v[32:35], v[124:127], a[28:31]
  buffer_load_dwordx4 v225, s[32:35], s26 offen offset:1024 lds
  v_mfma_f32_16x16x32_bf16 a[32:35], v[36:39], v[96:99], a[32:35]
  ds_read_b64_tr_b16 v[68:69], v13 offset:32768
  v_mfma_f32_16x16x32_bf16 a[36:39], v[36:39], v[100:103], a[36:39]
  buffer_load_dwordx4 v226, s[32:35], s26 offen offset:2048 lds
  v_mfma_f32_16x16x32_bf16 a[40:43], v[36:39], v[104:107], a[40:43]
  ds_read_b64_tr_b16 v[70:71], v13 offset:33792
  v_mfma_f32_16x16x32_bf16 a[44:47], v[36:39], v[108:111], a[44:47]
  buffer_load_dwordx4 v227, s[32:35], s26 offen offset:3072 lds
  v_mfma_f32_16x16x32_bf16 a[48:51], v[36:39], v[112:115], a[48:51]
  s_add_u32 m0, s24, 16384
  ds_read_b128 v[132:135], v14 offset:33792
  v_mfma_f32_16x16x32_bf16 a[52:55], v[36:39], v[116:119], a[52:55]
  buffer_load_dwordx4 v8, s[36:39], s27 offen offset:0 lds
  v_mfma_f32_16x16x32_bf16 a[56:59], v[36:39], v[120:123], a[56:59]
  ds_read_b64_tr_b16 v[72:73], v12 offset:33024
  v_mfma_f32_16x16x32_bf16 a[60:63], v[36:39], v[124:127], a[60:63]
  buffer_load_dwordx4 v9, s[36:39], s27 offen offset:1024 lds
  v_mfma_f32_16x16x32_bf16 a[64:67], v[40:43], v[96:99], a[64:67]
  ds_read_b64_tr_b16 v[74:75], v12 offset:34048
  v_mfma_f32_16x16x32_bf16 a[68:71], v[40:43], v[100:103], a[68:71]
  buffer_load_dwordx4 v10, s[36:39], s27 offen offset:2048 lds
  v_mfma_f32_16x16x32_bf16 a[72:75], v[40:43], v[104:107], a[72:75]
  ds_read_b128 v[136:139], v14 offset:34816
  v_mfma_f32_16x16x32_bf16 a[76:79], v[40:43], v[108:111], a[76:79]
  buffer_load_dwordx4 v11, s[36:39], s27 offen offset:3072 lds
  v_mfma_f32_16x16x32_bf16 a[80:83], v[40:43], v[112:115], a[80:83]
  ds_read_b64_tr_b16 v[76:77], v13 offset:33024
  v_mfma_f32_16x16x32_bf16 a[84:87], v[40:43], v[116:119], a[84:87]
  buffer_load_dword v231, v235, s[48:51], s74 offen
  v_mfma_f32_16x16x32_bf16 a[88:91], v[40:43], v[120:123], a[88:91]
  s_add_u32 s74, s74, s73
  ds_read_b64_tr_b16 v[78:79], v13 offset:34048
  v_mfma_f32_16x16x32_bf16 a[92:95], v[40:43], v[124:127], a[92:95]
  v_mfma_f32_16x16x32_bf16 a[96:99], v[44:47], v[96:99], a[96:99]
  ds_read_b128 v[140:143], v14 offset:35840
  v_mfma_f32_16x16x32_bf16 a[100:103], v[44:47], v[100:103], a[100:103]
  v_mfma_f32_16x16x32_bf16 a[104:107], v[44:47], v[104:107], a[104:107]
  ds_read_b64_tr_b16 v[80:81], v12 offset:33280
  v_mfma_f32_16x16x32_bf16 a[108:111], v[44:47], v[108:111], a[108:111]
  v_mfma_f32_16x16x32_bf16 a[112:115], v[44:47], v[112:115], a[112:115]
  ds_read_b64_tr_b16 v[82:83], v12 offset:34304
  v_mfma_f32_16x16x32_bf16 a[116:119], v[44:47], v[116:119], a[116:119]
  v_mfma_f32_16x16x32_bf16 a[120:123], v[44:47], v[120:123], a[120:123]
  ds_read_b128 v[144:147], v14 offset:36864
  v_mfma_f32_16x16x32_bf16 a[124:127], v[44:47], v[124:127], a[124:127]
  v_mfma_f32_16x16x32_bf16 a[128:131], v[48:51], v[96:99], a[128:131]
  ds_read_b64_tr_b16 v[84:85], v13 offset:33280
  v_mfma_f32_16x16x32_bf16 a[132:135], v[48:51], v[100:103], a[132:135]
  v_mfma_f32_16x16x32_bf16 a[136:139], v[48:51], v[104:107], a[136:139]
  ds_read_b64_tr_b16 v[86:87], v13 offset:34304
  v_mfma_f32_16x16x32_bf16 a[140:143], v[48:51], v[108:111], a[140:143]
  v_mfma_f32_16x16x32_bf16 a[144:147], v[48:51], v[112:115], a[144:147]
  ds_read_b128 v[148:151], v14 offset:37888
  v_mfma_f32_16x16x32_bf16 a[148:151], v[48:51], v[116:119], a[148:151]
  v_mfma_f32_16x16x32_bf16 a[152:155], v[48:51], v[120:123], a[152:155]
  ds_read_b64_tr_b16 v[88:89], v12 offset:33536
  v_mfma_f32_16x16x32_bf16 a[156:159], v[48:51], v[124:127], a[156:159]
  v_mfma_f32_16x16x32_bf16 a[160:163], v[52:55], v[96:99], a[160:163]
  ds_read_b64_tr_b16 v[90:91], v12 offset:34560
  v_mfma_f32_16x16x32_bf16 a[164:167], v[52:55], v[100:103], a[164:167]
  v_mfma_f32_16x16x32_bf16 a[168:171], v[52:55], v[104:107], a[168:171]
  ds_read_b128 v[152:155], v14 offset:38912
  v_mfma_f32_16x16x32_bf16 a[172:175], v[52:55], v[108:111], a[172:175]
  v_mfma_f32_16x16x32_bf16 a[176:179], v[52:55], v[112:115], a[176:179]
  ds_read_b64_tr_b16 v[92:93], v13 offset:33536
  v_mfma_f32_16x16x32_bf16 a[180:183], v[52:55], v[116:119], a[180:183]
  v_mfma_f32_16x16x32_bf16 a[184:187], v[52:55], v[120:123], a[184:187]
  ds_read_b64_tr_b16 v[94:95], v13 offset:34560
  v_mfma_f32_16x16x32_bf16 a[188:191], v[52:55], v[124:127], a[188:191]
  v_mfma_f32_16x16x32_bf16 a[192:195], v[56:59], v[96:99], a[192:195]
  s_add_u32 s26, s26, 64
  ds_read_b128 v[156:159], v14 offset:39936
  v_mfma_f32_16x16x32_bf16 a[196:199], v[56:59], v[100:103], a[196:199]
  s_add_u32 s27, s27, s25
  v_mfma_f32_16x16x32_bf16 a[200:203], v[56:59], v[104:107], a[200:203]
  s_add_u32 s24, s24, 32768
  v_mfma_f32_16x16x32_bf16 a[204:207], v[56:59], v[108:111], a[204:207]
  s_and_b32 s24, s24, 0x1ffff
  v_mfma_f32_16x16x32_bf16 a[208:211], v[56:59], v[112:115], a[208:211]
  v_xor_b32 v14, 0x10000, v14
  v_mfma_f32_16x16x32_bf16 a[212:215], v[56:59], v[116:119], a[212:215]
  v_xor_b32 v12, 0x10000, v12
  v_mfma_f32_16x16x32_bf16 a[216:219], v[56:59], v[120:123], a[216:219]
  v_xor_b32 v13, 0x10000, v13
  v_mfma_f32_16x16x32_bf16 a[220:223], v[56:59], v[124:127], a[220:223]
  v_mfma_f32_16x16x32_bf16 a[224:227], v[60:63], v[96:99], a[224:227]
  v_mfma_f32_16x16x32_bf16 a[228:231], v[60:63], v[100:103], a[228:231]
  v_mfma_f32_16x16x32_bf16 a[232:235], v[60:63], v[104:107], a[232:235]
  v_mfma_f32_16x16x32_bf16 a[236:239], v[60:63], v[108:111], a[236:239]
  v_mfma_f32_16x16x32_bf16 a[240:243], v[60:63], v[112:115], a[240:243]
  v_mfma_f32_16x16x32_bf16 a[244:247], v[60:63], v[116:119], a[244:247]
  v_mfma_f32_16x16x32_bf16 a[248:251], v[60:63], v[120:123], a[248:251]
  v_mfma_f32_16x16x32_bf16 a[252:255], v[60:63], v[124:127], a[252:255]
  s_waitcnt lgkmcnt(0)
  v_mfma_f32_16x16x32_bf16 a[0:3], v[64:67], v[128:131], a[0:3]
  s_waitcnt vmcnt(18)
  v_mfma_f32_16x16x32_bf16 a[4:7], v[64:67], v[132:135], a[4:7]
  s_barrier
  v_mfma_f32_16x16x32_bf16 a[8:11], v[64:67], v[136:139], a[8:11]
  ds_read_b64_tr_b16 v[32:33], v12 offset:0
  v_mfma_f32_16x16x32_bf16 a[12:15], v[64:67], v[140:143], a[12:15]
  v_mfma_f32_16x16x32_bf16 a[16:19], v[64:67], v[144:147], a[16:19]
  s_mov_b32 m0, s24
  ds_read_b64_tr_b16 v[34:35], v12 offset:1024
  v_mfma_f32_16x16x32_bf16 a[20:23], v[64:67], v[148:151], a[20:23]
  buffer_load_dwordx4 v224, s[32:35], s26 offen offset:0 lds
  v_mfma_f32_16x16x32_bf16 a[24:27], v[64:67], v[152:155], a[24:27]
  ds_read_b128 v[96:99], v14 offset:0
  v_mfma_f32_16x16x32_bf16 a[28:31], v[64:67], v[156:159], a[28:31]
  v_mfma_f32_16x16x32_bf16 a[32:35], v[68:71], v[128:131], a[32:35]
  ds_read_b64_tr_b16 v[36:37], v13 offset:0
  v_mfma_f32_16x16x32_bf16 a[36:39], v[68:71], v[132:135], a[36:39]
  v_mfma_f32_16x16x32_bf16 a[40:43], v[68:71], v[136:139], a[40:43]
  ds_read_b64_tr_b16 v[38:39], v13 offset:1024
  v_mfma_f32_16x16x32_bf16 a[44:47], v[68:71], v[140:143], a[44:47]
  buffer_load_dwordx4 v225, s[32:35], s26 offen offset:1024 lds
  v_mfma_f32_16x16x32_bf16 a[48:51], v[68:71], v[144:147], a[48:51]
  ds_read_b128 v[100:103], v14 offset:1024
  v_mfma_f32_16x16x32_bf16 a[52:55], v[68:71], v[148:151], a[52:55]
  v_mfma_f32_16x16x32_bf16 a[56:59], v[68:71], v[152:155], a[56:59]
  ds_read_b64_tr_b16 v[40:41], v12 offset:256
  v_mfma_f32_16x16x32_bf16 a[60:63], v[68:71], v[156:159], a[60:63]
  v_mfma_f32_16x16x32_bf16 a[64:67], v[72:75], v[128:131], a[64:67]
  ds_read_b64_tr_b16 v[42:43], v12 offset:1280
  v_mfma_f32_16x16x32_bf16 a[68:71], v[72:75], v[132:135], a[68:71]
  buffer_load_dwordx4 v226, s[32:35], s26 offen offset:2048 lds
  v_mfma_f32_16x16x32_bf16 a[72:75], v[72:75], v[136:139], a[72:75]
  ds_read_b128 v[104:107], v14 offset:2048
  v_mfma_f32_16x16x32_bf16 a[76:79], v[72:75], v[140:143], a[76:79]
  v_mfma_f32_16x16x32_bf16 a[80:83], v[72:75], v[144:147], a[80:83]
  ds_read_b64_tr_b16 v[44:45], v13 offset:256
  v_mfma_f32_16x16x32_bf16 a[84:87], v[72:75], v[148:151], a[84:87]
  v_mfma_f32_16x16x32_bf16 a[88:91], v[72:75], v[152:155], a[88:91]
  ds_read_b64_tr_b16 v[46:47], v13 offset:1280
  v_mfma_f32_16x16x32_bf16 a[92:95], v[72:75], v[156:159], a[92:95]
  buffer_load_dwordx4 v227, s[32:35], s26 offen offset:3072 lds
  v_mfma_f32_16x16x32_bf16 a[96:99], v[76:79], v[128:131], a[96:99]
  ds_read_b128 v[108:111], v14 offset:3072
  v_mfma_f32_16x16x32_bf16 a[100:103], v[76:79], v[132:135], a[100:103]
  v_mfma_f32_16x16x32_bf16 a[104:107], v[76:79], v[136:139], a[104:107]
  ds_read_b64_tr_b16 v[48:49], v12 offset:512
  v_mfma_f32_16x16x32_bf16 a[108:111], v[76:79], v[140:143], a[108:111]
  v_mfma_f32_16x16x32_bf16 a[112:115], v[76:79], v[144:147], a[112:115]
  s_add_u32 m0, s24, 16384
  ds_read_b64_tr_b16 v[50:51], v12 offset:1536
  v_mfma_f32_16x16x32_bf16 a[116:119], v[76:79], v[148:151], a[116:119]
  buffer_load_dwordx4 v8, s[36:39], s27 offen offset:0 lds
  v_mfma_f32_16x16x32_bf16 a[120:123], v[76:79], v[152:155], a[120:123]
  ds_read_b128 v[112:115], v14 offset:4096
  v_mfma_f32_16x16x32_bf16 a[124:127], v[76:79], v[156:159], a[124:127]
  v_mfma_f32_16x16x32_bf16 a[128:131], v[80:83], v[128:131], a[128:131]
  ds_read_b64_tr_b16 v[52:53], v13 offset:512
  v_mfma_f32_16x16x32_bf16 a[132:135], v[80:83], v[132:135], a[132:135]
  v_mfma_f32_16x16x32_bf16 a[136:139], v[80:83], v[136:139], a[136:139]
  ds_read_b64_tr_b16 v[54:55], v13 offset:1536
  v_mfma_f32_16x16x32_bf16 a[140:143], v[80:83], v[140:143], a[140:143]
  buffer_load_dwordx4 v9, s[36:39], s27 offen offset:1024 lds
  v_mfma_f32_16x16x32_bf16 a[144:147], v[80:83], v[144:147], a[144:147]
  ds_read_b128 v[116:119], v14 offset:5120
  v_mfma_f32_16x16x32_bf16 a[148:151], v[80:83], v[148:151], a[148:151]
  v_mfma_f32_16x16x32_bf16 a[152:155], v[80:83], v[152:155], a[152:155]
  ds_read_b64_tr_b16 v[56:57], v12 offset:768
  v_mfma_f32_16x16x32_bf16 a[156:159], v[80:83], v[156:159], a[156:159]
  v_mfma_f32_16x16x32_bf16 a[160:163], v[84:87], v[128:131], a[160:163]
  ds_read_b64_tr_b16 v[58:59], v12 offset:1792
  v_mfma_f32_16x16x32_bf16 a[164:167], v[84:87], v[132:135], a[164:167]
  buffer_load_dwordx4 v10, s[36:39], s27 offen offset:2048 lds
  v_mfma_f32_16x16x32_bf16 a[168:171], v[84:87], v[136:139], a[168:171]
  ds_read_b128 v[120:123], v14 offset:6144
  v_mfma_f32_16x16x32_bf16 a[172:175], v[84:87], v[140:143], a[172:175]
  v_mfma_f32_16x16x32_bf16 a[176:179], v[84:87], v[144:147], a[176:179]
  ds_read_b64_tr_b16 v[60:61], v13 offset:768
  v_mfma_f32_16x16x32_bf16 a[180:183], v[84:87], v[148:151], a[180:183]
  v_mfma_f32_16x16x32_bf16 a[184:187], v[84:87], v[152:155], a[184:187]
  ds_read_b64_tr_b16 v[62:63], v13 offset:1792
  v_mfma_f32_16x16x32_bf16 a[188:191], v[84:87], v[156:159], a[188:191]
  buffer_load_dwordx4 v11, s[36:39], s27 offen offset:3072 lds
  v_mfma_f32_16x16x32_bf16 a[192:195], v[88:91], v[128:131], a[192:195]
  s_add_u32 s26, s26, 64
  ds_read_b128 v[124:127], v14 offset:7168
  v_mfma_f32_16x16x32_bf16 a[196:199], v[88:91], v[132:135], a[196:199]
  s_add_u32 s27, s27, s25
  v_mfma_f32_16x16x32_bf16 a[200:203], v[88:91], v[136:139], a[200:203]
  s_add_u32 s24, s24, 32768
  v_mfma_f32_16x16x32_bf16 a[204:207], v[88:91], v[140:143], a[204:207]
  s_and_b32 s24, s24, 0x1ffff
  v_mfma_f32_16x16x32_bf16 a[208:211], v[88:91], v[144:147], a[208:211]
  v_mfma_f32_16x16x32_bf16 a[212:215], v[88:91], v[148:151], a[212:215]
  v_mfma_f32_16x16x32_bf16 a[216:219], v[88:91], v[152:155], a[216:219]
  s_add_u32 s28, s28, 1
  v_mfma_f32_16x16x32_bf16 a[220:223], v[88:91], v[156:159], a[220:223]
  v_mfma_f32_16x16x32_bf16 a[224:227], v[92:95], v[128:131], a[224:227]
  v_mfma_f32_16x16x32_bf16 a[228:231], v[92:95], v[132:135], a[228:231]
  v_mfma_f32_16x16x32_bf16 a[232:235], v[92:95], v[136:139], a[232:235]
  v_mfma_f32_16x16x32_bf16 a[236:239], v[92:95], v[140:143], a[236:239]
  v_mfma_f32_16x16x32_bf16 a[240:243], v[92:95], v[144:147], a[240:243]
  v_mfma_f32_16x16x32_bf16 a[244:247], v[92:95], v[148:151], a[244:247]
  s_cmp_lt_u32 s28, 8
  v_mfma_f32_16x16x32_bf16 a[248:251], v[92:95], v[152:155], a[248:251]
  s_waitcnt lgkmcnt(0)
  v_mfma_f32_16x16x32_bf16 a[252:255], v[92:95], v[156:159], a[252:255]
  s_cbranch_scc1 fa_loopK
  s_mov_b32 s60, 2048
  s_mov_b32 s61, 8192
  s_mov_b32 s62, 16777216
  s_branch fa_p1epi
fa_roleV:
  ds_read_b128 v[32:35], v14 offset:0
  ds_read_b128 v[36:39], v14 offset:1024
  ds_read_b128 v[40:43], v14 offset:2048
  ds_read_b128 v[44:47], v14 offset:3072
  ds_read_b128 v[48:51], v14 offset:4096
  ds_read_b128 v[52:55], v14 offset:5120
  ds_read_b128 v[56:59], v14 offset:6144
  ds_read_b128 v[60:63], v14 offset:7168
  ds_read_b64_tr_b16 v[96:97], v12 offset:0
  ds_read_b64_tr_b16 v[98:99], v12 offset:1024
  ds_read_b64_tr_b16 v[100:101], v13 offset:0
  ds_read_b64_tr_b16 v[102:103], v13 offset:1024
  ds_read_b64_tr_b16 v[104:105], v12 offset:256
  ds_read_b64_tr_b16 v[106:107], v12 offset:1280
  ds_read_b64_tr_b16 v[108:109], v13 offset:256
  ds_read_b64_tr_b16 v[110:111], v13 offset:1280
  ds_read_b64_tr_b16 v[112:113], v12 offset:512
  ds_read_b64_tr_b16 v[114:115], v12 offset:1536
  ds_read_b64_tr_b16 v[116:117], v13 offset:512
  ds_read_b64_tr_b16 v[118:119], v13 offset:1536
  ds_read_b64_tr_b16 v[120:121], v12 offset:768
  ds_read_b64_tr_b16 v[122:123], v12 offset:1792
  ds_read_b64_tr_b16 v[124:125], v13 offset:768
  ds_read_b64_tr_b16 v[126:127], v13 offset:1792
  s_waitcnt lgkmcnt(0)
.p2align 6
fa_loopV:
  v_mfma_f32_16x16x32_bf16 a[0:3], v[32:35], v[96:99], a[0:3]
  s_waitcnt vmcnt(17)
  v_mfma_f32_16x16x32_bf16 a[4:7], v[32:35], v[100:103], a[4:7]
  s_barrier
  v_mfma_f32_16x16x32_bf16 a[8:11], v[32:35], v[104:107], a[8:11]
  s_bitcmp1_b32 s72, s28
  ds_read_b64_tr_b16 v[128:129], v12 offset:32768
  v_mfma_f32_16x16x32_bf16 a[12:15], v[32:35], v[108:111], a[12:15]
  s_cbranch_scc1 fa_p1stubV
fa_p1backV:
  v_mfma_f32_16x16x32_bf16 a[16:19], v[32:35], v[112:115], a[16:19]
  s_mov_b32 m0, s24
  ds_read_b64_tr_b16 v[130:131], v12 offset:33792
  v_mfma_f32_16x16x32_bf16 a[20:23], v[32:35], v[116:119], a[20:23]
  buffer_load_dwordx4 v224, s[32:35], s26 offen offset:0 lds
  v_mfma_f32_16x16x32_bf16 a[24:27], v[32:35], v[120:123], a[24:27]
  ds_read_b128 v[64:67], v14 offset:32768
  v_mfma_f32_16x16x32_bf16 a[28:31], v[32:35], v[124:127], a[28:31]
  buffer_load_dwordx4 v225, s[32:35], s26 offen offset:1024 lds
  v_mfma_f32_16x16x32_bf16 a[32:35], v[36:39], v[96:99], a[32:35]
  ds_read_b64_tr_b16 v[132:133], v13 offset:32768
  v_mfma_f32_16x16x32_bf16 a[36:39], v[36:39], v[100:103], a[36:39]
  buffer_load_dwordx4 v226, s[32:35], s26 offen offset:2048 lds
  v_mfma_f32_16x16x32_bf16 a[40:43], v[36:39], v[104:107], a[40:43]
  ds_read_b64_tr_b16 v[134:135], v13 offset:33792
  v_mfma_f32_16x16x32_bf16 a[44:47], v[36:39], v[108:111], a[44:47]
  buffer_load_dwordx4 v227, s[32:35], s26 offen offset:3072 lds
  v_mfma_f32_16x16x32_bf16 a[48:51], v[36:39], v[112:115], a[48:51]
  s_add_u32 m0, s24, 16384
  ds_read_b128 v[68:71], v14 offset:33792
  v_mfma_f32_16x16x32_bf16 a[52:55], v[36:39], v[116:119], a[52:55]
  buffer_load_dwordx4 v8, s[36:39], s27 offen offset:0 lds
  v_mfma_f32_16x16x32_bf16 a[56:59], v[36:39], v[120:123], a[56:59]
  ds_read_b64_tr_b16 v[136:137], v12 offset:33024
  v_mfma_f32_16x16x32_bf16 a[60:63], v[36:39], v[124:127], a[60:63]
  buffer_load_dwordx4 v9, s[36:39], s27 offen offset:1024 lds
  v_mfma_f32_16x16x32_bf16 a[64:67], v[40:43], v[96:99], a[64:67]
  ds_read_b64_tr_b16 v[138:139], v12 offset:34048
  v_mfma_f32_16x16x32_bf16 a[68:71], v[40:43], v[100:103], a[68:71]
  buffer_load_dwordx4 v10, s[36:39], s27 offen offset:2048 lds
  v_mfma_f32_16x16x32_bf16 a[72:75], v[40:43], v[104:107], a[72:75]
  ds_read_b128 v[72:75], v14 offset:34816
  v_mfma_f32_16x16x32_bf16 a[76:79], v[40:43], v[108:111], a[76:79]
  buffer_load_dwordx4 v11, s[36:39], s27 offen offset:3072 lds
  v_mfma_f32_16x16x32_bf16 a[80:83], v[40:43], v[112:115], a[80:83]
  ds_read_b64_tr_b16 v[140:141], v13 offset:33024
  v_mfma_f32_16x16x32_bf16 a[84:87], v[40:43], v[116:119], a[84:87]
  buffer_load_dword v231, v235, s[48:51], s74 offen
  v_mfma_f32_16x16x32_bf16 a[88:91], v[40:43], v[120:123], a[88:91]
  s_add_u32 s74, s74, s73
  ds_read_b64_tr_b16 v[142:143], v13 offset:34048
  v_mfma_f32_16x16x32_bf16 a[92:95], v[40:43], v[124:127], a[92:95]
  v_mfma_f32_16x16x32_bf16 a[96:99], v[44:47], v[96:99], a[96:99]
  ds_read_b128 v[76:79], v14 offset:35840
  v_mfma_f32_16x16x32_bf16 a[100:103], v[44:47], v[100:103], a[100:103]
  v_mfma_f32_16x16x32_bf16 a[104:107], v[44:47], v[104:107], a[104:107]
  ds_read_b64_tr_b16 v[144:145], v12 offset:33280
  v_mfma_f32_16x16x32_bf16 a[108:111], v[44:47], v[108:111], a[108:111]
  v_mfma_f32_16x16x32_bf16 a[112:115], v[44:47], v[112:115], a[112:115]
  ds_read_b64_tr_b16 v[146:147], v12 offset:34304
  v_mfma_f32_16x16x32_bf16 a[116:119], v[44:47], v[116:119], a[116:119]
  v_mfma_f32_16x16x32_bf16 a[120:123], v[44:47], v[120:123], a[120:123]
  ds_read_b128 v[80:83], v14 offset:36864
  v_mfma_f32_16x16x32_bf16 a[124:127], v[44:47], v[124:127], a[124:127]
  v_mfma_f32_16x16x32_bf16 a[128:131], v[48:51], v[96:99], a[128:131]
  ds_read_b64_tr_b16 v[148:149], v13 offset:33280
  v_mfma_f32_16x16x32_bf16 a[132:135], v[48:51], v[100:103], a[132:135]
  v_mfma_f32_16x16x32_bf16 a[136:139], v[48:51], v[104:107], a[136:139]
  ds_read_b64_tr_b16 v[150:151], v13 offset:34304
  v_mfma_f32_16x16x32_bf16 a[140:143], v[48:51], v[108:111], a[140:143]
  v_mfma_f32_16x16x32_bf16 a[144:147], v[48:51], v[112:115], a[144:147]
  ds_read_b128 v[84:87], v14 offset:37888
  v_mfma_f32_16x16x32_bf16 a[148:151], v[48:51], v[116:119], a[148:151]
  v_mfma_f32_16x16x32_bf16 a[152:155], v[48:51], v[120:123], a[152:155]
  ds_read_b64_tr_b16 v[152:153], v12 offset:33536
  v_mfma_f32_16x16x32_bf16 a[156:159], v[48:51], v[124:127], a[156:159]
  v_mfma_f32_16x16x32_bf16 a[160:163], v[52:55], v[96:99], a[160:163]
  ds_read_b64_tr_b16 v[154:155], v12 offset:34560
  v_mfma_f32_16x16x32_bf16 a[164:167], v[52:55], v[100:103], a[164:167]
  v_mfma_f32_16x16x32_bf16 a[168:171], v[52:55], v[104:107], a[168:171]
  ds_read_b128 v[88:91], v14 offset:38912
  v_mfma_f32_16x16x32_bf16 a[172:175], v[52:55], v[108:111], a[172:175]
  v_mfma_f32_16x16x32_bf16 a[176:179], v[52:55], v[112:115], a[176:179]
  ds_read_b64_tr_b16 v[156:157], v13 offset:33536
  v_mfma_f32_16x16x32_bf16 a[180:183], v[52:55], v[116:119], a[180:183]
  v_mfma_f32_16x16x32_bf16 a[184:187], v[52:55], v[120:123], a[184:187]
  ds_read_b64_tr_b16 v[158:159], v13 offset:34560
  v_mfma_f32_16x16x32_bf16 a[188:191], v[52:55], v[124:127], a[188:191]
  v_mfma_f32_16x16x32_bf16 a[192:195], v[56:59], v[96:99], a[192:195]
  s_add_u32 s26, s26, 64
  ds_read_b128 v[92:95], v14 offset:39936
  v_mfma_f32_16x16x32_bf16 a[196:199], v[56:59], v[100:103], a[196:199]
  s_add_u32 s27, s27, s25
  v_mfma_f32_16x16x32_bf16 a[200:203], v[56:59], v[104:107], a[200:203]
  s_add_u32 s24, s24, 32768
  v_mfma_f32_16x16x32_bf16 a[204:207], v[56:59], v[108:111], a[204:207]
  s_and_b32 s24, s24, 0x1ffff
  v_mfma_f32_16x16x32_bf16 a[208:211], v[56:59], v[112:115], a[208:211]
  v_xor_b32 v14, 0x10000, v14
  v_mfma_f32_16x16x32_bf16 a[212:215], v[56:59], v[116:119], a[212:215]
  v_xor_b32 v12, 0x10000, v12
  v_mfma_f32_16x16x32_bf16 a[216:219], v[56:59], v[120:123], a[216:219]
  v_xor_b32 v13, 0x10000, v13
  v_mfma_f32_16x16x32_bf16 a[220:223], v[56:59], v[124:127], a[220:223]
  v_mfma_f32_16x16x32_bf16 a[224:227], v[60:63], v[96:99], a[224:227]
  v_mfma_f32_16x16x32_bf16 a[228:231], v[60:63], v[100:103], a[228:231]
  v_mfma_f32_16x16x32_bf16 a[232:235], v[60:63], v[104:107], a[232:235]
  v_mfma_f32_16x16x32_bf16 a[236:239], v[60:63], v[108:111], a[236:239]
  v_mfma_f32_16x16x32_bf16 a[240:243], v[60:63], v[112:115], a[240:243]
  v_mfma_f32_16x16x32_bf16 a[244:247], v[60:63], v[116:119], a[244:247]
  v_mfma_f32_16x16x32_bf16 a[248:251], v[60:63], v[120:123], a[248:251]
  v_mfma_f32_16x16x32_bf16 a[252:255], v[60:63], v[124:127], a[252:255]
  s_waitcnt lgkmcnt(0)
  v_mfma_f32_16x16x32_bf16 a[0:3], v[64:67], v[128:131], a[0:3]
  s_waitcnt vmcnt(18)
  v_mfma_f32_16x16x32_bf16 a[4:7], v[64:67], v[132:135], a[4:7]
  s_barrier
  v_mfma_f32_16x16x32_bf16 a[8:11], v[64:67], v[136:139], a[8:11]
  ds_read_b64_tr_b16 v[96:97], v12 offset:0
  v_mfma_f32_16x16x32_bf16 a[12:15], v[64:67], v[140:143], a[12:15]
  v_mfma_f32_16x16x32_bf16 a[16:19], v[64:67], v[144:147], a[16:19]
  s_mov_b32 m0, s24
  ds_read_b64_tr_b16 v[98:99], v12 offset:1024
  v_mfma_f32_16x16x32_bf16 a[20:23], v[64:67], v[148:151], a[20:23]
  buffer_load_dwordx4 v224, s[32:35], s26 offen offset:0 lds
  v_mfma_f32_16x16x32_bf16 a[24:27], v[64:67], v[152:155], a[24:27]
  ds_read_b128 v[32:35], v14 offset:0
  v_mfma_f32_16x16x32_bf16 a[28:31], v[64:67], v[156:159], a[28:31]
  v_mfma_f32_16x16x32_bf16 a[32:35], v[68:71], v[128:131], a[32:35]
  ds_read_b64_tr_b16 v[100:101], v13 offset:0
  v_mfma_f32_16x16x32_bf16 a[36:39], v[68:71], v[132:135], a[36:39]
  v_mfma_f32_16x16x32_bf16 a[40:43], v[68:71], v[136:139], a[40:43]
  ds_read_b64_tr_b16 v[102:103], v13 offset:1024
  v_mfma_f32_16x16x32_bf16 a[44:47], v[68:71], v[140:143], a[44:47]
  buffer_load_dwordx4 v225, s[32:35], s26 offen offset:1024 lds
  v_mfma_f32_16x16x32_bf16 a[48:51], v[68:71], v[144:147], a[48:51]
  ds_read_b128 v[36:39], v14 offset:1024
  v_mfma_f32_16x16x32_bf16 a[52:55], v[68:71], v[148:151], a[52:55]
  v_mfma_f32_16x16x32_bf16 a[56:59], v[68:71], v[152:155], a[56:59]
  ds_read_b64_tr_b16 v[104:105], v12 offset:256
  v_mfma_f32_16x16x32_bf16 a[60:63], v[68:71], v[156:159], a[60:63]
  v_mfma_f32_16x16x32_bf16 a[64:67], v[72:75], v[128:131], a[64:67]
  ds_read_b64_tr_b16 v[106:107], v12 offset:1280
  v_mfma_f32_16x16x32_bf16 a[68:71], v[72:75], v[132:135], a[68:71]
  buffer_load_dwordx4 v226, s[32:35], s26 offen offset:2048 lds
  v_mfma_f32_16x16x32_bf16 a[72:75], v[72:75], v[136:139], a[72:75]
  ds_read_b128 v[40:43], v14 offset:2048
  v_mfma_f32_16x16x32_bf16 a[76:79], v[72:75], v[140:143], a[76:79]
  v_mfma_f32_16x16x32_bf16 a[80:83], v[72:75], v[144:147], a[80:83]
  ds_read_b64_tr_b16 v[108:109], v13 offset:256
  v_mfma_f32_16x16x32_bf16 a[84:87], v[72:75], v[148:151], a[84:87]
  v_mfma_f32_16x16x32_bf16 a[88:91], v[72:75], v[152:155], a[88:91]
  ds_read_b64_tr_b16 v[110:111], v13 offset:1280
  v_mfma_f32_16x16x32_bf16 a[92:95], v[72:75], v[156:159], a[92:95]
  buffer_load_dwordx4 v227, s[32:35], s26 offen offset:3072 lds
  v_mfma_f32_16x16x32_bf16 a[96:99], v[76:79], v[128:131], a[96:99]
  ds_read_b128 v[44:47], v14 offset:3072
  v_mfma_f32_16x16x32_bf16 a[100:103], v[76:79], v[132:135], a[100:103]
  v_mfma_f32_16x16x32_bf16 a[104:107], v[76:79], v[136:139], a[104:107]
  ds_read_b64_tr_b16 v[112:113], v12 offset:512
  v_mfma_f32_16x16x32_bf16 a[108:111], v[76:79], v[140:143], a[108:111]
  v_mfma_f32_16x16x32_bf16 a[112:115], v[76:79], v[144:147], a[112:115]
  s_add_u32 m0, s24, 16384
  ds_read_b64_tr_b16 v[114:115], v12 offset:1536
  v_mfma_f32_16x16x32_bf16 a[116:119], v[76:79], v[148:151], a[116:119]
  buffer_load_dwordx4 v8, s[36:39], s27 offen offset:0 lds
  v_mfma_f32_16x16x32_bf16 a[120:123], v[76:79], v[152:155], a[120:123]
  ds_read_b128 v[48:51], v14 offset:4096
  v_mfma_f32_16x16x32_bf16 a[124:127], v[76:79], v[156:159], a[124:127]
  v_mfma_f32_16x16x32_bf16 a[128:131], v[80:83], v[128:131], a[128:131]
  ds_read_b64_tr_b16 v[116:117], v13 offset:512
  v_mfma_f32_16x16x32_bf16 a[132:135], v[80:83], v[132:135], a[132:135]
  v_mfma_f32_16x16x32_bf16 a[136:139], v[80:83], v[136:139], a[136:139]
  ds_read_b64_tr_b16 v[118:119], v13 offset:1536
  v_mfma_f32_16x16x32_bf16 a[140:143], v[80:83], v[140:143], a[140:143]
  buffer_load_dwordx4 v9, s[36:39], s27 offen offset:1024 lds
  v_mfma_f32_16x16x32_bf16 a[144:147], v[80:83], v[144:147], a[144:147]
  ds_read_b128 v[52:55], v14 offset:5120
  v_mfma_f32_16x16x32_bf16 a[148:151], v[80:83], v[148:151], a[148:151]
  v_mfma_f32_16x16x32_bf16 a[152:155], v[80:83], v[152:155], a[152:155]
  ds_read_b64_tr_b16 v[120:121], v12 offset:768
  v_mfma_f32_16x16x32_bf16 a[156:159], v[80:83], v[156:159], a[156:159]
  v_mfma_f32_16x16x32_bf16 a[160:163], v[84:87], v[128:131], a[160:163]
  ds_read_b64_tr_b16 v[122:123], v12 offset:1792
  v_mfma_f32_16x16x32_bf16 a[164:167], v[84:87], v[132:135], a[164:167]
  buffer_load_dwordx4 v10, s[36:39], s27 offen offset:2048 lds
  v_mfma_f32_16x16x32_bf16 a[168:171], v[84:87], v[136:139], a[168:171]
  ds_read_b128 v[56:59], v14 offset:6144
  v_mfma_f32_16x16x32_bf16 a[172:175], v[84:87], v[140:143], a[172:175]
  v_mfma_f32_16x16x32_bf16 a[176:179], v[84:87], v[144:147], a[176:179]
  ds_read_b64_tr_b16 v[124:125], v13 offset:768
  v_mfma_f32_16x16x32_bf16 a[180:183], v[84:87], v[148:151], a[180:183]
  v_mfma_f32_16x16x32_bf16 a[184:187], v[84:87], v[152:155], a[184:187]
  ds_read_b64_tr_b16 v[126:127], v13 offset:1792
  v_mfma_f32_16x16x32_bf16 a[188:191], v[84:87], v[156:159], a[188:191]
  buffer_load_dwordx4 v11, s[36:39], s27 offen offset:3072 lds
  v_mfma_f32_16x16x32_bf16 a[192:195], v[88:91], v[128:131], a[192:195]
  s_add_u32 s26, s26, 64
  ds_read_b128 v[60:63], v14 offset:7168
  v_mfma_f32_16x16x32_bf16 a[196:199], v[88:91], v[132:135], a[196:199]
  s_add_u32 s27, s27, s25
  v_mfma_f32_16x16x32_bf16 a[200:203], v[88:91], v[136:139], a[200:203]
  s_add_u32 s24, s24, 32768
  v_mfma_f32_16x16x32_bf16 a[204:207], v[88:91], v[140:143], a[204:207]
  s_and_b32 s24, s24, 0x1ffff
  v_mfma_f32_16x16x32_bf16 a[208:211], v[88:91], v[144:147], a[208:211]
  v_mfma_f32_16x16x32_bf16 a[212:215], v[88:91], v[148:151], a[212:215]
  v_mfma_f32_16x16x32_bf16 a[216:219], v[88:91], v[152:155], a[216:219]
  s_add_u32 s28, s28, 1
  v_mfma_f32_16x16x32_bf16 a[220:223], v[88:91], v[156:159], a[220:223]
  v_mfma_f32_16x16x32_bf16 a[224:227], v[92:95], v[128:131], a[224:227]
  v_mfma_f32_16x16x32_bf16 a[228:231], v[92:95], v[132:135], a[228:231]
  v_mfma_f32_16x16x32_bf16 a[232:235], v[92:95], v[136:139], a[232:235]
  v_mfma_f32_16x16x32_bf16 a[236:239], v[92:95], v[140:143], a[236:239]
  v_mfma_f32_16x16x32_bf16 a[240:243], v[92:95], v[144:147], a[240:243]
  v_mfma_f32_16x16x32_bf16 a[244:247], v[92:95], v[148:151], a[244:247]
  s_cmp_lt_u32 s28, 8
  v_mfma_f32_16x16x32_bf16 a[248:251], v[92:95], v[152:155], a[248:251]
  s_waitcnt lgkmcnt(0)
  v_mfma_f32_16x16x32_bf16 a[252:255], v[92:95], v[156:159], a[252:255]
  s_cbranch_scc1 fa_loopV
  s_mov_b32 s60, 8192
  s_mov_b32 s61, 2048
  s_mov_b32 s62, 33554432
fa_p1epi:
  s_lshl_b32 s23, s21, 19
  s_add_u32 s62, s62, s23
  s_lshl_b32 s23, s22, 16
  s_add_u32 s62, s62, s23
  s_and_b32 s23, s20, 1
  s_lshl_b32 s23, s23, 15
  s_add_u32 s62, s62, s23
  s_lshl_b32 s23, s22, 2
  s_add_u32 s23, s23, s20
  s_mul_i32 s64, s23, 40960
  s_add_u32 s65, s64, 20480
  s_sub_u32 s23, 15, s22
  s_lshl_b32 s23, s23, 2
  s_add_u32 s23, s23, s20
  s_mul_i32 s66, s23, 40960
  s_add_u32 s67, s66, 20480
  v_cmp_ne_u32 vcc, 0x01010101, v228
  s_cbranch_vccnz fa_ln_spin
fa_ln_ok:
  v_accvgpr_read_b32 v100, a192
  v_accvgpr_read_b32 v101, a193
  v_accvgpr_read_b32 v102, a194
  v_accvgpr_read_b32 v103, a195
  v_accvgpr_read_b32 v104, a224
  v_accvgpr_read_b32 v105, a225
  v_accvgpr_read_b32 v106, a226
  v_accvgpr_read_b32 v107, a227
  v_accvgpr_read_b32 v112, a196
  v_accvgpr_read_b32 v113, a197
  v_accvgpr_read_b32 v114, a198
  v_accvgpr_read_b32 v115, a199
  v_accvgpr_read_b32 v116, a228
  v_accvgpr_read_b32 v117, a229
  v_accvgpr_read_b32 v118, a230
  v_accvgpr_read_b32 v119, a231
  v_accvgpr_read_b32 v124, a200
  v_accvgpr_read_b32 v125, a201
  v_accvgpr_read_b32 v126, a202
  v_accvgpr_read_b32 v127, a203
  v_accvgpr_read_b32 v128, a232
  v_accvgpr_read_b32 v129, a233
  v_accvgpr_read_b32 v130, a234
  v_accvgpr_read_b32 v131, a235
  v_accvgpr_read_b32 v136, a204
  v_accvgpr_read_b32 v137, a205
  v_accvgpr_read_b32 v138, a206
  v_accvgpr_read_b32 v139, a207
  v_accvgpr_read_b32 v140, a236
  v_accvgpr_read_b32 v141, a237
  v_accvgpr_read_b32 v142, a238
  v_accvgpr_read_b32 v143, a239
  v_accvgpr_read_b32 v148, a208
  v_accvgpr_read_b32 v149, a209
  v_accvgpr_read_b32 v150, a210
  v_accvgpr_read_b32 v151, a211
  v_accvgpr_read_b32 v152, a240
  v_accvgpr_read_b32 v153, a241
  v_accvgpr_read_b32 v154, a242
  v_accvgpr_read_b32 v155, a243
  v_accvgpr_read_b32 v160, a212
  v_accvgpr_read_b32 v161, a213
  v_accvgpr_read_b32 v162, a214
  v_accvgpr_read_b32 v163, a215
  v_accvgpr_read_b32 v164, a244
  v_accvgpr_read_b32 v165, a245
  v_accvgpr_read_b32 v166, a246
  v_accvgpr_read_b32 v167, a247
  v_accvgpr_read_b32 v172, a216
  v_accvgpr_read_b32 v173, a217
  v_accvgpr_read_b32 v174, a218
  v_accvgpr_read_b32 v175, a219
  v_accvgpr_read_b32 v176, a248
  v_accvgpr_read_b32 v177, a249
  v_accvgpr_read_b32 v178, a250
  v_accvgpr_read_b32 v179, a251
  v_accvgpr_read_b32 v184, a220
  v_accvgpr_read_b32 v185, a221
  v_accvgpr_read_b32 v186, a222
  v_accvgpr_read_b32 v187, a223
  v_accvgpr_read_b32 v188, a252
  v_accvgpr_read_b32 v189, a253
  v_accvgpr_read_b32 v190, a254
  v_accvgpr_read_b32 v191, a255
  buffer_load_dwordx4 a[192:195], v2, s[40:43], s64 offen offset:0 sc1
  buffer_load_dwordx4 a[196:199], v2, s[40:43], s65 offen offset:0 sc1
  buffer_load_dwordx4 a[200:203], v2, s[40:43], s66 offen offset:0 sc1
  buffer_load_dwordx4 a[204:207], v2, s[40:43], s67 offen offset:0 sc1
  buffer_load_dwordx4 a[208:211], v2, s[40:43], s64 offen offset:1024 sc1
  buffer_load_dwordx4 a[212:215], v2, s[40:43], s65 offen offset:1024 sc1
  buffer_load_dwordx4 a[216:219], v2, s[40:43], s66 offen offset:1024 sc1
  buffer_load_dwordx4 a[220:223], v2, s[40:43], s67 offen offset:1024 sc1
  buffer_load_dwordx4 a[224:227], v2, s[40:43], s64 offen offset:2048 sc1
  buffer_load_dwordx4 a[228:231], v2, s[40:43], s65 offen offset:2048 sc1
  buffer_load_dwordx4 a[232:235], v2, s[40:43], s66 offen offset:2048 sc1
  buffer_load_dwordx4 a[236:239], v2, s[40:43], s67 offen offset:2048 sc1
  buffer_load_dwordx4 a[240:243], v2, s[40:43], s64 offen offset:3072 sc1
  buffer_load_dwordx4 a[244:247], v2, s[40:43], s65 offen offset:3072 sc1
  buffer_load_dwordx4 a[248:251], v2, s[40:43], s66 offen offset:3072 sc1
  buffer_load_dwordx4 a[252:255], v2, s[40:43], s67 offen offset:3072 sc1
  s_add_u32 s64, s64, 4096
  s_add_u32 s65, s65, 4096
  s_add_u32 s66, s66, 4096
  s_add_u32 s67, s67, 4096
  s_mul_i32 s63, s60, 3
  s_add_u32 s63, s63, s62
  v_cvt_pk_bf16_f32 v96, v100, v101
  v_cvt_pk_bf16_f32 v97, v102, v103
  v_cvt_pk_bf16_f32 v98, v104, v105
  v_cvt_pk_bf16_f32 v99, v106, v107
  buffer_store_dwordx4 v[96:99], v2, s[40:43], s63 offen offset:0 sc1
  v_cvt_pk_bf16_f32 v108, v112, v113
  v_cvt_pk_bf16_f32 v109, v114, v115
  v_cvt_pk_bf16_f32 v110, v116, v117
  v_cvt_pk_bf16_f32 v111, v118, v119
  buffer_store_dwordx4 v[108:111], v2, s[40:43], s63 offen offset:1024 sc1
  s_add_u32 s63, s63, s61
  v_cvt_pk_bf16_f32 v120, v124, v125
  v_cvt_pk_bf16_f32 v121, v126, v127
  v_cvt_pk_bf16_f32 v122, v128, v129
  v_cvt_pk_bf16_f32 v123, v130, v131
  buffer_store_dwordx4 v[120:123], v2, s[40:43], s63 offen offset:0 sc1
  v_cvt_pk_bf16_f32 v132, v136, v137
  v_cvt_pk_bf16_f32 v133, v138, v139
  v_cvt_pk_bf16_f32 v134, v140, v141
  v_cvt_pk_bf16_f32 v135, v142, v143
  buffer_store_dwordx4 v[132:135], v2, s[40:43], s63 offen offset:1024 sc1
  s_add_u32 s63, s63, s61
  v_cvt_pk_bf16_f32 v144, v148, v149
  v_cvt_pk_bf16_f32 v145, v150, v151
  v_cvt_pk_bf16_f32 v146, v152, v153
  v_cvt_pk_bf16_f32 v147, v154, v155
  buffer_store_dwordx4 v[144:147], v2, s[40:43], s63 offen offset:0 sc1
  v_cvt_pk_bf16_f32 v156, v160, v161
  v_cvt_pk_bf16_f32 v157, v162, v163
  v_cvt_pk_bf16_f32 v158, v164, v165
  v_cvt_pk_bf16_f32 v159, v166, v167
  buffer_store_dwordx4 v[156:159], v2, s[40:43], s63 offen offset:1024 sc1
  s_add_u32 s63, s63, s61
  v_cvt_pk_bf16_f32 v168, v172, v173
  v_cvt_pk_bf16_f32 v169, v174, v175
  v_cvt_pk_bf16_f32 v170, v176, v177
  v_cvt_pk_bf16_f32 v171, v178, v179
  buffer_store_dwordx4 v[168:171], v2, s[40:43], s63 offen offset:0 sc1
  v_cvt_pk_bf16_f32 v180, v184, v185
  v_cvt_pk_bf16_f32 v181, v186, v187
  v_cvt_pk_bf16_f32 v182, v188, v189
  v_cvt_pk_bf16_f32 v183, v190, v191
  buffer_store_dwordx4 v[180:183], v2, s[40:43], s63 offen offset:1024 sc1
  s_lshr_b32 s23, s20, 1
  s_lshl_b32 s23, s23, 13
  v_subrev_u32 v12, s23, v12
  v_subrev_u32 v13, s23, v13
  s_waitcnt vmcnt(20)
  s_barrier
  ds_read_b64_tr_b16 v[32:33], v12 offset:0
  ds_read_b64_tr_b16 v[34:35], v12 offset:1024
  ds_read_b64_tr_b16 v[36:37], v13 offset:0
  ds_read_b64_tr_b16 v[38:39], v13 offset:1024
  ds_read_b64_tr_b16 v[40:41], v12 offset:256
  ds_read_b64_tr_b16 v[42:43], v12 offset:1280
  ds_read_b64_tr_b16 v[44:45], v13 offset:256
  ds_read_b64_tr_b16 v[46:47], v13 offset:1280
  ds_read_b64_tr_b16 v[48:49], v12 offset:512
  ds_read_b64_tr_b16 v[50:51], v12 offset:1536
  ds_read_b64_tr_b16 v[52:53], v13 offset:512
  ds_read_b64_tr_b16 v[54:55], v13 offset:1536
  ds_read_b64_tr_b16 v[56:57], v12 offset:768
  ds_read_b64_tr_b16 v[58:59], v12 offset:1792
  ds_read_b64_tr_b16 v[60:61], v13 offset:768
  ds_read_b64_tr_b16 v[62:63], v13 offset:1792
  s_lshl_b32 s23, s21, 19
  s_add_u32 s23, s23, 16777216
  s_add_u32 s6, s18, s23
  s_addc_u32 s7, s19, 0
  s_add_u32 s8, s6, 16777216
  s_addc_u32 s9, s7, 0
  s_sub_u32 s23, 16, s22
  s_lshl_b32 s23, s23, 15
  s_mov_b32 s44, s6
  s_mov_b32 s45, s7
  s_mov_b32 s46, s23
  s_mov_b32 s47, 0x20000
  s_mov_b32 s48, s8
  s_mov_b32 s49, s9
  s_mov_b32 s50, s23
  s_mov_b32 s51, 0x20000
  s_waitcnt lgkmcnt(0)
  s_lshl_b32 s30, s21, 7
  s_add_u32 s30, s30, 2637824
  s_mov_b32 s81, 0x47800000
  s_cmp_eq_u32 s20, 0
  s_cselect_b32 s29, s82, 1073741824
  v_mfma_f32_16x16x32_bf16 v[96:99], v[32:35], a[192:195], 0
  v_accvgpr_read_b32 v236, a0
  v_mfma_f32_16x16x32_bf16 v[112:115], v[36:39], a[192:195], 0
  ds_read_b64_tr_b16 v[64:65], v12 offset:8192
  v_accvgpr_read_b32 v237, a1
  v_mfma_f32_16x16x32_bf16 v[128:131], v[40:43], a[192:195], 0
  ds_read_b64_tr_b16 v[66:67], v12 offset:9216
  v_accvgpr_read_b32 v238, a2
  v_mfma_f32_16x16x32_bf16 v[144:147], v[44:47], a[192:195], 0
  ds_read_b64_tr_b16 v[68:69], v13 offset:8192
  v_accvgpr_read_b32 v239, a3
  v_mfma_f32_16x16x32_bf16 v[160:163], v[48:51], a[192:195], 0
  ds_read_b64_tr_b16 v[70:71], v13 offset:9216
  v_accvgpr_read_b32 v240, a32
  v_mfma_f32_16x16x32_bf16 v[176:179], v[52:55], a[192:195], 0
  ds_read_b64_tr_b16 v[72:73], v12 offset:8448
  v_accvgpr_read_b32 v241, a33
  v_mfma_f32_16x16x32_bf16 v[192:195], v[56:59], a[192:195], 0
  ds_read_b64_tr_b16 v[74:75], v12 offset:9472
  v_accvgpr_read_b32 v242, a34
  v_mfma_f32_16x16x32_bf16 v[208:211], v[60:63], a[192:195], 0
  buffer_load_dwordx4 a[192:195], v2, s[40:43], s64 offen offset:0 sc1
  v_accvgpr_read_b32 v243, a35
  v_mfma_f32_16x16x32_bf16 v[100:103], v[32:35], a[196:199], 0
  ds_read_b64_tr_b16 v[76:77], v13 offset:8448
  v_cvt_pk_bf16_f32 v232, v236, v237
  v_mfma_f32_16x16x32_bf16 v[116:119], v[36:39], a[196:199], 0
  ds_read_b64_tr_b16 v[78:79], v13 offset:9472
  v_cvt_pk_bf16_f32 v233, v238, v239
  v_mfma_f32_16x16x32_bf16 v[132:135], v[40:43], a[196:199], 0
  ds_read_b64_tr_b16 v[80:81], v12 offset:8704
  v_cvt_pk_bf16_f32 v234, v240, v241
  v_mfma_f32_16x16x32_bf16 v[148:151], v[44:47], a[196:199], 0
  v_cvt_pk_bf16_f32 v235, v242, v243
  v_mfma_f32_16x16x32_bf16 v[164:167], v[48:51], a[196:199], 0
  ds_read_b64_tr_b16 v[82:83], v12 offset:9728
  v_mfma_f32_16x16x32_bf16 v[180:183], v[52:55], a[196:199], 0
  s_mul_i32 s63, s60, 0
  ds_read_b64_tr_b16 v[84:85], v13 offset:8704
  v_mfma_f32_16x16x32_bf16 v[196:199], v[56:59], a[196:199], 0
  s_add_u32 s63, s63, s62
  ds_read_b64_tr_b16 v[86:87], v13 offset:9728
  v_mfma_f32_16x16x32_bf16 v[212:215], v[60:63], a[196:199], 0
  buffer_load_dwordx4 a[196:199], v2, s[40:43], s65 offen offset:0 sc1
  v_mfma_f32_16x16x32_bf16 v[104:107], v[32:35], a[200:203], 0
  ds_read_b64_tr_b16 v[88:89], v12 offset:8960
  v_accvgpr_read_b32 v248, a4
  v_mfma_f32_16x16x32_bf16 v[120:123], v[36:39], a[200:203], 0
  ds_read_b64_tr_b16 v[90:91], v12 offset:9984
  v_accvgpr_read_b32 v249, a5
  v_mfma_f32_16x16x32_bf16 v[136:139], v[40:43], a[200:203], 0
  ds_read_b64_tr_b16 v[92:93], v13 offset:8960
  v_accvgpr_read_b32 v250, a6
  v_mfma_f32_16x16x32_bf16 v[152:155], v[44:47], a[200:203], 0
  v_accvgpr_read_b32 v251, a7
  v_mfma_f32_16x16x32_bf16 v[168:171], v[48:51], a[200:203], 0
  ds_read_b64_tr_b16 v[94:95], v13 offset:9984
  v_accvgpr_read_b32 v252, a36
  v_mfma_f32_16x16x32_bf16 v[184:187], v[52:55], a[200:203], 0
  buffer_store_dwordx4 v[232:235], v2, s[40:43], s63 offen offset:0 sc1
  v_accvgpr_read_b32 v253, a37
  v_mfma_f32_16x16x32_bf16 v[200:203], v[56:59], a[200:203], 0
  v_accvgpr_read_b32 v254, a38
  v_mfma_f32_16x16x32_bf16 v[216:219], v[60:63], a[200:203], 0
  buffer_load_dwordx4 a[200:203], v2, s[40:43], s66 offen offset:0 sc1
  v_accvgpr_read_b32 v255, a39
  v_mfma_f32_16x16x32_bf16 v[108:111], v[32:35], a[204:207], 0
  v_cvt_pk_bf16_f32 v244, v248, v249
  v_mfma_f32_16x16x32_bf16 v[124:127], v[36:39], a[204:207], 0
  v_cvt_pk_bf16_f32 v245, v250, v251
  v_mfma_f32_16x16x32_bf16 v[140:143], v[40:43], a[204:207], 0
  v_cvt_pk_bf16_f32 v246, v252, v253
  v_mfma_f32_16x16x32_bf16 v[156:159], v[44:47], a[204:207], 0
  v_cvt_pk_bf16_f32 v247, v254, v255
  v_mfma_f32_16x16x32_bf16 v[172:175], v[48:51], a[204:207], 0
  v_mfma_f32_16x16x32_bf16 v[188:191], v[52:55], a[204:207], 0
  buffer_store_dwordx4 v[244:247], v2, s[40:43], s63 offen offset:1024 sc1
  v_mfma_f32_16x16x32_bf16 v[204:207], v[56:59], a[204:207], 0
  v_mfma_f32_16x16x32_bf16 v[220:223], v[60:63], a[204:207], 0
  s_waitcnt vmcnt(21) lgkmcnt(0)
  buffer_load_dwordx4 a[204:207], v2, s[40:43], s67 offen offset:0 sc1
  v_mfma_f32_16x16x32_bf16 v[96:99], v[64:67], a[208:211], v[96:99]
  s_barrier
  v_accvgpr_read_b32 v236, a8
  v_mfma_f32_16x16x32_bf16 v[112:115], v[68:71], a[208:211], v[112:115]
  ds_read_b64_tr_b16 v[32:33], v12 offset:32768
  v_accvgpr_read_b32 v237, a9
  v_mfma_f32_16x16x32_bf16 v[128:131], v[72:75], a[208:211], v[128:131]
  ds_read_b64_tr_b16 v[34:35], v12 offset:33792
  v_accvgpr_read_b32 v238, a10
  v_mfma_f32_16x16x32_bf16 v[144:147], v[76:79], a[208:211], v[144:147]
  ds_read_b64_tr_b16 v[36:37], v13 offset:32768
  v_accvgpr_read_b32 v239, a11
  v_mfma_f32_16x16x32_bf16 v[160:163], v[80:83], a[208:211], v[160:163]
  ds_read_b64_tr_b16 v[38:39], v13 offset:33792
  v_accvgpr_read_b32 v240, a40
  v_mfma_f32_16x16x32_bf16 v[176:179], v[84:87], a[208:211], v[176:179]
  ds_read_b64_tr_b16 v[40:41], v12 offset:33024
  v_accvgpr_read_b32 v241, a41
  v_mfma_f32_16x16x32_bf16 v[192:195], v[88:91], a[208:211], v[192:195]
  ds_read_b64_tr_b16 v[42:43], v12 offset:34048
  v_accvgpr_read_b32 v242, a42
  v_mfma_f32_16x16x32_bf16 v[208:211], v[92:95], a[208:211], v[208:211]
  buffer_load_dwordx4 a[208:211], v2, s[40:43], s64 offen offset:1024 sc1
  v_accvgpr_read_b32 v243, a43
  v_mfma_f32_16x16x32_bf16 v[100:103], v[64:67], a[212:215], v[100:103]
  ds_read_b64_tr_b16 v[44:45], v13 offset:33024
  v_cvt_pk_bf16_f32 v232, v236, v237
  v_mfma_f32_16x16x32_bf16 v[116:119], v[68:71], a[212:215], v[116:119]
  ds_read_b64_tr_b16 v[46:47], v13 offset:34048
  v_cvt_pk_bf16_f32 v233, v238, v239
  v_mfma_f32_16x16x32_bf16 v[132:135], v[72:75], a[212:215], v[132:135]
  s_add_u32 m0, s24, 16384
  ds_read_b64_tr_b16 v[48:49], v12 offset:33280
  v_cvt_pk_bf16_f32 v234, v240, v241
  v_mfma_f32_16x16x32_bf16 v[148:151], v[76:79], a[212:215], v[148:151]
  buffer_load_dwordx4 v8, s[36:39], s27 offen offset:0 lds
  v_cvt_pk_bf16_f32 v235, v242, v243
  v_mfma_f32_16x16x32_bf16 v[164:167], v[80:83], a[212:215], v[164:167]
  ds_read_b64_tr_b16 v[50:51], v12 offset:34304
  v_mfma_f32_16x16x32_bf16 v[180:183], v[84:87], a[212:215], v[180:183]
  s_add_u32 s63, s63, s61
  ds_read_b64_tr_b16 v[52:53], v13 offset:33280
  v_mfma_f32_16x16x32_bf16 v[196:199], v[88:91], a[212:215], v[196:199]
  ds_read_b64_tr_b16 v[54:55], v13 offset:34304
  v_mfma_f32_16x16x32_bf16 v[212:215], v[92:95], a[212:215], v[212:215]
  buffer_load_dwordx4 a[212:215], v2, s[40:43], s65 offen offset:1024 sc1
  v_mfma_f32_16x16x32_bf16 v[104:107], v[64:67], a[216:219], v[104:107]
  ds_read_b64_tr_b16 v[56:57], v12 offset:33536
  v_accvgpr_read_b32 v248, a12
  v_mfma_f32_16x16x32_bf16 v[120:123], v[68:71], a[216:219], v[120:123]
  ds_read_b64_tr_b16 v[58:59], v12 offset:34560
  v_accvgpr_read_b32 v249, a13
  v_mfma_f32_16x16x32_bf16 v[136:139], v[72:75], a[216:219], v[136:139]
  ds_read_b64_tr_b16 v[60:61], v13 offset:33536
  v_accvgpr_read_b32 v250, a14
  v_mfma_f32_16x16x32_bf16 v[152:155], v[76:79], a[216:219], v[152:155]
  buffer_load_dwordx4 v9, s[36:39], s27 offen offset:1024 lds
  v_accvgpr_read_b32 v251, a15
  v_mfma_f32_16x16x32_bf16 v[168:171], v[80:83], a[216:219], v[168:171]
  ds_read_b64_tr_b16 v[62:63], v13 offset:34560
  v_accvgpr_read_b32 v252, a44
  v_mfma_f32_16x16x32_bf16 v[184:187], v[84:87], a[216:219], v[184:187]
  buffer_store_dwordx4 v[232:235], v2, s[40:43], s63 offen offset:0 sc1
  v_accvgpr_read_b32 v253, a45
  v_mfma_f32_16x16x32_bf16 v[200:203], v[88:91], a[216:219], v[200:203]
  buffer_load_dwordx4 v10, s[36:39], s27 offen offset:2048 lds
  v_accvgpr_read_b32 v254, a46
  v_mfma_f32_16x16x32_bf16 v[216:219], v[92:95], a[216:219], v[216:219]
  buffer_load_dwordx4 a[216:219], v2, s[40:43], s66 offen offset:1024 sc1
  v_accvgpr_read_b32 v255, a47
  v_mfma_f32_16x16x32_bf16 v[108:111], v[64:67], a[220:223], v[108:111]
  v_cvt_pk_bf16_f32 v244, v248, v249
  v_mfma_f32_16x16x32_bf16 v[124:127], v[68:71], a[220:223], v[124:127]
  buffer_load_dwordx4 v11, s[36:39], s27 offen offset:3072 lds
  v_cvt_pk_bf16_f32 v245, v250, v251
  v_mfma_f32_16x16x32_bf16 v[140:143], v[72:75], a[220:223], v[140:143]
  s_add_u32 s27, s27, 524288
  v_cvt_pk_bf16_f32 v246, v252, v253
  v_mfma_f32_16x16x32_bf16 v[156:159], v[76:79], a[220:223], v[156:159]
  s_add_u32 s24, s24, 32768
  v_cvt_pk_bf16_f32 v247, v254, v255
  v_mfma_f32_16x16x32_bf16 v[172:175], v[80:83], a[220:223], v[172:175]
  s_and_b32 s24, s24, 0x1ffff
  v_mfma_f32_16x16x32_bf16 v[188:191], v[84:87], a[220:223], v[188:191]
  buffer_store_dwordx4 v[244:247], v2, s[40:43], s63 offen offset:1024 sc1
  v_mfma_f32_16x16x32_bf16 v[204:207], v[88:91], a[220:223], v[204:207]
  v_mfma_f32_16x16x32_bf16 v[220:223], v[92:95], a[220:223], v[220:223]
  s_waitcnt vmcnt(27) lgkmcnt(0)
  buffer_load_dwordx4 a[220:223], v2, s[40:43], s67 offen offset:1024 sc1
  v_mfma_f32_16x16x32_bf16 v[96:99], v[32:35], a[224:227], v[96:99]
  v_accvgpr_read_b32 v236, a16
  v_mfma_f32_16x16x32_bf16 v[112:115], v[36:39], a[224:227], v[112:115]
  ds_read_b64_tr_b16 v[64:65], v12 offset:40960
  v_accvgpr_read_b32 v237, a17
  v_mfma_f32_16x16x32_bf16 v[128:131], v[40:43], a[224:227], v[128:131]
  ds_read_b64_tr_b16 v[66:67], v12 offset:41984
  v_accvgpr_read_b32 v238, a18
  v_mfma_f32_16x16x32_bf16 v[144:147], v[44:47], a[224:227], v[144:147]
  ds_read_b64_tr_b16 v[68:69], v13 offset:40960
  v_accvgpr_read_b32 v239, a19
  v_mfma_f32_16x16x32_bf16 v[160:163], v[48:51], a[224:227], v[160:163]
  ds_read_b64_tr_b16 v[70:71], v13 offset:41984
  v_accvgpr_read_b32 v240, a48
  v_mfma_f32_16x16x32_bf16 v[176:179], v[52:55], a[224:227], v[176:179]
  ds_read_b64_tr_b16 v[72:73], v12 offset:41216
  v_accvgpr_read_b32 v241, a49
  v_mfma_f32_16x16x32_bf16 v[192:195], v[56:59], a[224:227], v[192:195]
  ds_read_b64_tr_b16 v[74:75], v12 offset:42240
  v_accvgpr_read_b32 v242, a50
  v_mfma_f32_16x16x32_bf16 v[208:211], v[60:63], a[224:227], v[208:211]
  buffer_load_dwordx4 a[224:227], v2, s[40:43], s64 offen offset:2048 sc1
  v_accvgpr_read_b32 v243, a51
  v_mfma_f32_16x16x32_bf16 v[100:103], v[32:35], a[228:231], v[100:103]
  ds_read_b64_tr_b16 v[76:77], v13 offset:41216
  v_cvt_pk_bf16_f32 v232, v236, v237
  v_mfma_f32_16x16x32_bf16 v[116:119], v[36:39], a[228:231], v[116:119]
  ds_read_b64_tr_b16 v[78:79], v13 offset:42240
  v_cvt_pk_bf16_f32 v233, v238, v239
  v_mfma_f32_16x16x32_bf16 v[132:135], v[40:43], a[228:231], v[132:135]
  ds_read_b64_tr_b16 v[80:81], v12 offset:41472
  v_cvt_pk_bf16_f32 v234, v240, v241
  v_mfma_f32_16x16x32_bf16 v[148:151], v[44:47], a[228:231], v[148:151]
  v_cvt_pk_bf16_f32 v235, v242, v243
  v_mfma_f32_16x16x32_bf16 v[164:167], v[48:51], a[228:231], v[164:167]
  ds_read_b64_tr_b16 v[82:83], v12 offset:42496
  v_mfma_f32_16x16x32_bf16 v[180:183], v[52:55], a[228:231], v[180:183]
  s_add_u32 s63, s63, s61
  ds_read_b64_tr_b16 v[84:85], v13 offset:41472
  v_mfma_f32_16x16x32_bf16 v[196:199], v[56:59], a[228:231], v[196:199]
  ds_read_b64_tr_b16 v[86:87], v13 offset:42496
  v_mfma_f32_16x16x32_bf16 v[212:215], v[60:63], a[228:231], v[212:215]
  buffer_load_dwordx4 a[228:231], v2, s[40:43], s65 offen offset:2048 sc1
  v_mfma_f32_16x16x32_bf16 v[104:107], v[32:35], a[232:235], v[104:107]
  ds_read_b64_tr_b16 v[88:89], v12 offset:41728
  v_accvgpr_read_b32 v248, a20
  v_mfma_f32_16x16x32_bf16 v[120:123], v[36:39], a[232:235], v[120:123]
  ds_read_b64_tr_b16 v[90:91], v12 offset:42752
  v_accvgpr_read_b32 v249, a21
  v_mfma_f32_16x16x32_bf16 v[136:139], v[40:43], a[232:235], v[136:139]
  ds_read_b64_tr_b16 v[92:93], v13 offset:41728
  v_accvgpr_read_b32 v250, a22
  v_mfma_f32_16x16x32_bf16 v[152:155], v[44:47], a[232:235], v[152:155]
  v_accvgpr_read_b32 v251, a23
  v_mfma_f32_16x16x32_bf16 v[168:171], v[48:51], a[232:235], v[168:171]
  ds_read_b64_tr_b16 v[94:95], v13 offset:42752
  v_accvgpr_read_b32 v252, a52
  v_mfma_f32_16x16x32_bf16 v[184:187], v[52:55], a[232:235], v[184:187]
  buffer_store_dwordx4 v[232:235], v2, s[40:43], s63 offen offset:0 sc1
  v_accvgpr_read_b32 v253, a53
  v_mfma_f32_16x16x32_bf16 v[200:203], v[56:59], a[232:235], v[200:203]
  v_accvgpr_read_b32 v254, a54
  v_mfma_f32_16x16x32_bf16 v[216:219], v[60:63], a[232:235], v[216:219]
  buffer_load_dwordx4 a[232:235], v2, s[40:43], s66 offen offset:2048 sc1
  v_accvgpr_read_b32 v255, a55
  v_mfma_f32_16x16x32_bf16 v[108:111], v[32:35], a[236:239], v[108:111]
  v_xor_b32 v12, 0x10000, v12
  v_cvt_pk_bf16_f32 v244, v248, v249
  v_mfma_f32_16x16x32_bf16 v[124:127], v[36:39], a[236:239], v[124:127]
  v_cvt_pk_bf16_f32 v245, v250, v251
  v_mfma_f32_16x16x32_bf16 v[140:143], v[40:43], a[236:239], v[140:143]
  v_xor_b32 v13, 0x10000, v13
  v_cvt_pk_bf16_f32 v246, v252, v253
  v_mfma_f32_16x16x32_bf16 v[156:159], v[44:47], a[236:239], v[156:159]
  v_cvt_pk_bf16_f32 v247, v254, v255
  v_mfma_f32_16x16x32_bf16 v[172:175], v[48:51], a[236:239], v[172:175]
  v_mfma_f32_16x16x32_bf16 v[188:191], v[52:55], a[236:239], v[188:191]
  buffer_store_dwordx4 v[244:247], v2, s[40:43], s63 offen offset:1024 sc1
  v_mfma_f32_16x16x32_bf16 v[204:207], v[56:59], a[236:239], v[204:207]
  v_mfma_f32_16x16x32_bf16 v[220:223], v[60:63], a[236:239], v[220:223]
  s_waitcnt vmcnt(29) lgkmcnt(0)
  buffer_load_dwordx4 a[236:239], v2, s[40:43], s67 offen offset:2048 sc1
  v_mfma_f32_16x16x32_bf16 v[96:99], v[64:67], a[240:243], v[96:99]
  s_barrier
  v_accvgpr_read_b32 v236, a24
  v_mfma_f32_16x16x32_bf16 v[112:115], v[68:71], a[240:243], v[112:115]
  ds_read_b64_tr_b16 v[32:33], v12 offset:0
  v_accvgpr_read_b32 v237, a25
  v_mfma_f32_16x16x32_bf16 v[128:131], v[72:75], a[240:243], v[128:131]
  ds_read_b64_tr_b16 v[34:35], v12 offset:1024
  v_accvgpr_read_b32 v238, a26
  v_mfma_f32_16x16x32_bf16 v[144:147], v[76:79], a[240:243], v[144:147]
  ds_read_b64_tr_b16 v[36:37], v13 offset:0
  v_accvgpr_read_b32 v239, a27
  v_mfma_f32_16x16x32_bf16 v[160:163], v[80:83], a[240:243], v[160:163]
  ds_read_b64_tr_b16 v[38:39], v13 offset:1024
  v_accvgpr_read_b32 v240, a56
  v_mfma_f32_16x16x32_bf16 v[176:179], v[84:87], a[240:243], v[176:179]
  ds_read_b64_tr_b16 v[40:41], v12 offset:256
  v_accvgpr_read_b32 v241, a57
  v_mfma_f32_16x16x32_bf16 v[192:195], v[88:91], a[240:243], v[192:195]
  ds_read_b64_tr_b16 v[42:43], v12 offset:1280
  v_accvgpr_read_b32 v242, a58
  v_mfma_f32_16x16x32_bf16 v[208:211], v[92:95], a[240:243], v[208:211]
  buffer_load_dwordx4 a[240:243], v2, s[40:43], s64 offen offset:3072 sc1
  v_accvgpr_read_b32 v243, a59
  v_mfma_f32_16x16x32_bf16 v[100:103], v[64:67], a[244:247], v[100:103]
  s_add_u32 s64, s64, 4096
  ds_read_b64_tr_b16 v[44:45], v13 offset:256
  v_cvt_pk_bf16_f32 v232, v236, v237
  v_mfma_f32_16x16x32_bf16 v[116:119], v[68:71], a[244:247], v[116:119]
  ds_read_b64_tr_b16 v[46:47], v13 offset:1280
  v_cvt_pk_bf16_f32 v233, v238, v239
  v_mfma_f32_16x16x32_bf16 v[132:135], v[72:75], a[244:247], v[132:135]
  s_add_u32 m0, s24, 16384
  ds_read_b64_tr_b16 v[48:49], v12 offset:512
  v_cvt_pk_bf16_f32 v234, v240, v241
  v_mfma_f32_16x16x32_bf16 v[148:151], v[76:79], a[244:247], v[148:151]
  buffer_load_dwordx4 v8, s[36:39], s27 offen offset:0 lds
  v_cvt_pk_bf16_f32 v235, v242, v243
  v_mfma_f32_16x16x32_bf16 v[164:167], v[80:83], a[244:247], v[164:167]
  ds_read_b64_tr_b16 v[50:51], v12 offset:1536
  v_mfma_f32_16x16x32_bf16 v[180:183], v[84:87], a[244:247], v[180:183]
  s_add_u32 s63, s63, s61
  ds_read_b64_tr_b16 v[52:53], v13 offset:512
  v_mfma_f32_16x16x32_bf16 v[196:199], v[88:91], a[244:247], v[196:199]
  ds_read_b64_tr_b16 v[54:55], v13 offset:1536
  v_mfma_f32_16x16x32_bf16 v[212:215], v[92:95], a[244:247], v[212:215]
  buffer_load_dwordx4 a[244:247], v2, s[40:43], s65 offen offset:3072 sc1
  v_mfma_f32_16x16x32_bf16 v[104:107], v[64:67], a[248:251], v[104:107]
  s_add_u32 s65, s65, 4096
  ds_read_b64_tr_b16 v[56:57], v12 offset:768
  v_accvgpr_read_b32 v248, a28
  v_mfma_f32_16x16x32_bf16 v[120:123], v[68:71], a[248:251], v[120:123]
  ds_read_b64_tr_b16 v[58:59], v12 offset:1792
  v_accvgpr_read_b32 v249, a29
  v_mfma_f32_16x16x32_bf16 v[136:139], v[72:75], a[248:251], v[136:139]
  ds_read_b64_tr_b16 v[60:61], v13 offset:768
  v_accvgpr_read_b32 v250, a30
  v_mfma_f32_16x16x32_bf16 v[152:155], v[76:79], a[248:251], v[152:155]
  buffer_load_dwordx4 v9, s[36:39], s27 offen offset:1024 lds
  v_accvgpr_read_b32 v251, a31
  v_mfma_f32_16x16x32_bf16 v[168:171], v[80:83], a[248:251], v[168:171]
  ds_read_b64_tr_b16 v[62:63], v13 offset:1792
  v_accvgpr_read_b32 v252, a60
  v_mfma_f32_16x16x32_bf16 v[184:187], v[84:87], a[248:251], v[184:187]
  buffer_store_dwordx4 v[232:235], v2, s[40:43], s63 offen offset:0 sc1
  v_accvgpr_read_b32 v253, a61
  v_mfma_f32_16x16x32_bf16 v[200:203], v[88:91], a[248:251], v[200:203]
  buffer_load_dwordx4 v10, s[36:39], s27 offen offset:2048 lds
  v_accvgpr_read_b32 v254, a62
  v_mfma_f32_16x16x32_bf16 v[216:219], v[92:95], a[248:251], v[216:219]
  buffer_load_dwordx4 a[248:251], v2, s[40:43], s66 offen offset:3072 sc1
  v_accvgpr_read_b32 v255, a63
  v_mfma_f32_16x16x32_bf16 v[108:111], v[64:67], a[252:255], v[108:111]
  s_add_u32 s66, s66, 4096
  v_cvt_pk_bf16_f32 v244, v248, v249
  v_mfma_f32_16x16x32_bf16 v[124:127], v[68:71], a[252:255], v[124:127]
  buffer_load_dwordx4 v11, s[36:39], s27 offen offset:3072 lds
  v_cvt_pk_bf16_f32 v245, v250, v251
  v_mfma_f32_16x16x32_bf16 v[140:143], v[72:75], a[252:255], v[140:143]
  s_add_u32 s27, s27, 524288
  v_cvt_pk_bf16_f32 v246, v252, v253
  v_mfma_f32_16x16x32_bf16 v[156:159], v[76:79], a[252:255], v[156:159]
  s_add_u32 s24, s24, 32768
  v_cvt_pk_bf16_f32 v247, v254, v255
  v_mfma_f32_16x16x32_bf16 v[172:175], v[80:83], a[252:255], v[172:175]
  s_and_b32 s24, s24, 0x1ffff
  v_mfma_f32_16x16x32_bf16 v[188:191], v[84:87], a[252:255], v[188:191]
  buffer_store_dwordx4 v[244:247], v2, s[40:43], s63 offen offset:1024 sc1
  v_mfma_f32_16x16x32_bf16 v[204:207], v[88:91], a[252:255], v[204:207]
  v_mfma_f32_16x16x32_bf16 v[220:223], v[92:95], a[252:255], v[220:223]
  s_waitcnt vmcnt(25) lgkmcnt(0)
  buffer_load_dwordx4 a[252:255], v2, s[40:43], s67 offen offset:3072 sc1
  v_mfma_f32_16x16x32_bf16 v[96:99], v[32:35], a[192:195], v[96:99]
  v_accvgpr_read_b32 v236, a64
  v_mfma_f32_16x16x32_bf16 v[112:115], v[36:39], a[192:195], v[112:115]
  s_add_u32 s67, s67, 4096
  ds_read_b64_tr_b16 v[64:65], v12 offset:8192
  v_accvgpr_read_b32 v237, a65
  v_mfma_f32_16x16x32_bf16 v[128:131], v[40:43], a[192:195], v[128:131]
  ds_read_b64_tr_b16 v[66:67], v12 offset:9216
  v_accvgpr_read_b32 v238, a66
  v_mfma_f32_16x16x32_bf16 v[144:147], v[44:47], a[192:195], v[144:147]
  ds_read_b64_tr_b16 v[68:69], v13 offset:8192
  v_accvgpr_read_b32 v239, a67
  v_mfma_f32_16x16x32_bf16 v[160:163], v[48:51], a[192:195], v[160:163]
  ds_read_b64_tr_b16 v[70:71], v13 offset:9216
  v_accvgpr_read_b32 v240, a96
  v_mfma_f32_16x16x32_bf16 v[176:179], v[52:55], a[192:195], v[176:179]
  ds_read_b64_tr_b16 v[72:73], v12 offset:8448
  v_accvgpr_read_b32 v241, a97
  v_mfma_f32_16x16x32_bf16 v[192:195], v[56:59], a[192:195], v[192:195]
  ds_read_b64_tr_b16 v[74:75], v12 offset:9472
  v_accvgpr_read_b32 v242, a98
  v_mfma_f32_16x16x32_bf16 v[208:211], v[60:63], a[192:195], v[208:211]
  buffer_load_dwordx4 a[192:195], v2, s[40:43], s64 offen offset:0 sc1
  v_accvgpr_read_b32 v243, a99
  v_mfma_f32_16x16x32_bf16 v[100:103], v[32:35], a[196:199], v[100:103]
  ds_read_b64_tr_b16 v[76:77], v13 offset:8448
  v_cvt_pk_bf16_f32 v232, v236, v237
  v_mfma_f32_16x16x32_bf16 v[116:119], v[36:39], a[196:199], v[116:119]
  ds_read_b64_tr_b16 v[78:79], v13 offset:9472
  v_cvt_pk_bf16_f32 v233, v238, v239
  v_mfma_f32_16x16x32_bf16 v[132:135], v[40:43], a[196:199], v[132:135]
  ds_read_b64_tr_b16 v[80:81], v12 offset:8704
  v_cvt_pk_bf16_f32 v234, v240, v241
  v_mfma_f32_16x16x32_bf16 v[148:151], v[44:47], a[196:199], v[148:151]
  v_cvt_pk_bf16_f32 v235, v242, v243
  v_mfma_f32_16x16x32_bf16 v[164:167], v[48:51], a[196:199], v[164:167]
  ds_read_b64_tr_b16 v[82:83], v12 offset:9728
  v_mfma_f32_16x16x32_bf16 v[180:183], v[52:55], a[196:199], v[180:183]
  s_mul_i32 s63, s60, 1
  ds_read_b64_tr_b16 v[84:85], v13 offset:8704
  v_mfma_f32_16x16x32_bf16 v[196:199], v[56:59], a[196:199], v[196:199]
  s_add_u32 s63, s63, s62
  ds_read_b64_tr_b16 v[86:87], v13 offset:9728
  v_mfma_f32_16x16x32_bf16 v[212:215], v[60:63], a[196:199], v[212:215]
  buffer_load_dwordx4 a[196:199], v2, s[40:43], s65 offen offset:0 sc1
  v_mfma_f32_16x16x32_bf16 v[104:107], v[32:35], a[200:203], v[104:107]
  ds_read_b64_tr_b16 v[88:89], v12 offset:8960
  v_accvgpr_read_b32 v248, a68
  v_mfma_f32_16x16x32_bf16 v[120:123], v[36:39], a[200:203], v[120:123]
  ds_read_b64_tr_b16 v[90:91], v12 offset:9984
  v_accvgpr_read_b32 v249, a69
  v_mfma_f32_16x16x32_bf16 v[136:139], v[40:43], a[200:203], v[136:139]
  ds_read_b64_tr_b16 v[92:93], v13 offset:8960
  v_accvgpr_read_b32 v250, a70
  v_mfma_f32_16x16x32_bf16 v[152:155], v[44:47], a[200:203], v[152:155]
  v_accvgpr_read_b32 v251, a71
  v_mfma_f32_16x16x32_bf16 v[168:171], v[48:51], a[200:203], v[168:171]
  ds_read_b64_tr_b16 v[94:95], v13 offset:9984
  v_accvgpr_read_b32 v252, a100
  v_mfma_f32_16x16x32_bf16 v[184:187], v[52:55], a[200:203], v[184:187]
  buffer_store_dwordx4 v[232:235], v2, s[40:43], s63 offen offset:0 sc1
  v_accvgpr_read_b32 v253, a101
  v_mfma_f32_16x16x32_bf16 v[200:203], v[56:59], a[200:203], v[200:203]
  v_accvgpr_read_b32 v254, a102
  v_mfma_f32_16x16x32_bf16 v[216:219], v[60:63], a[200:203], v[216:219]
  buffer_load_dwordx4 a[200:203], v2, s[40:43], s66 offen offset:0 sc1
  v_accvgpr_read_b32 v255, a103
  v_mfma_f32_16x16x32_bf16 v[108:111], v[32:35], a[204:207], v[108:111]
  v_cvt_pk_bf16_f32 v244, v248, v249
  v_mfma_f32_16x16x32_bf16 v[124:127], v[36:39], a[204:207], v[124:127]
  v_cvt_pk_bf16_f32 v245, v250, v251
  v_mfma_f32_16x16x32_bf16 v[140:143], v[40:43], a[204:207], v[140:143]
  v_cvt_pk_bf16_f32 v246, v252, v253
  v_mfma_f32_16x16x32_bf16 v[156:159], v[44:47], a[204:207], v[156:159]
  v_cvt_pk_bf16_f32 v247, v254, v255
  v_mfma_f32_16x16x32_bf16 v[172:175], v[48:51], a[204:207], v[172:175]
  v_mfma_f32_16x16x32_bf16 v[188:191], v[52:55], a[204:207], v[188:191]
  buffer_store_dwordx4 v[244:247], v2, s[40:43], s63 offen offset:1024 sc1
  v_mfma_f32_16x16x32_bf16 v[204:207], v[56:59], a[204:207], v[204:207]
  v_mfma_f32_16x16x32_bf16 v[220:223], v[60:63], a[204:207], v[220:223]
  s_waitcnt vmcnt(21) lgkmcnt(0)
  buffer_load_dwordx4 a[204:207], v2, s[40:43], s67 offen offset:0 sc1
  v_mfma_f32_16x16x32_bf16 v[96:99], v[64:67], a[208:211], v[96:99]
  s_barrier
  v_accvgpr_read_b32 v236, a72
  v_mfma_f32_16x16x32_bf16 v[112:115], v[68:71], a[208:211], v[112:115]
  ds_read_b64_tr_b16 v[32:33], v12 offset:32768
  v_accvgpr_read_b32 v237, a73
  v_mfma_f32_16x16x32_bf16 v[128:131], v[72:75], a[208:211], v[128:131]
  ds_read_b64_tr_b16 v[34:35], v12 offset:33792
  v_accvgpr_read_b32 v238, a74
  v_mfma_f32_16x16x32_bf16 v[144:147], v[76:79], a[208:211], v[144:147]
  ds_read_b64_tr_b16 v[36:37], v13 offset:32768
  v_accvgpr_read_b32 v239, a75
  v_mfma_f32_16x16x32_bf16 v[160:163], v[80:83], a[208:211], v[160:163]
  ds_read_b64_tr_b16 v[38:39], v13 offset:33792
  v_accvgpr_read_b32 v240, a104
  v_mfma_f32_16x16x32_bf16 v[176:179], v[84:87], a[208:211], v[176:179]
  ds_read_b64_tr_b16 v[40:41], v12 offset:33024
  v_accvgpr_read_b32 v241, a105
  v_mfma_f32_16x16x32_bf16 v[192:195], v[88:91], a[208:211], v[192:195]
  ds_read_b64_tr_b16 v[42:43], v12 offset:34048
  v_accvgpr_read_b32 v242, a106
  v_mfma_f32_16x16x32_bf16 v[208:211], v[92:95], a[208:211], v[208:211]
  buffer_load_dwordx4 a[208:211], v2, s[40:43], s64 offen offset:1024 sc1
  v_accvgpr_read_b32 v243, a107
  v_mfma_f32_16x16x32_bf16 v[100:103], v[64:67], a[212:215], v[100:103]
  ds_read_b64_tr_b16 v[44:45], v13 offset:33024
  v_cvt_pk_bf16_f32 v232, v236, v237
  v_mfma_f32_16x16x32_bf16 v[116:119], v[68:71], a[212:215], v[116:119]
  ds_read_b64_tr_b16 v[46:47], v13 offset:34048
  v_cvt_pk_bf16_f32 v233, v238, v239
  v_mfma_f32_16x16x32_bf16 v[132:135], v[72:75], a[212:215], v[132:135]
  s_add_u32 m0, s24, 16384
  ds_read_b64_tr_b16 v[48:49], v12 offset:33280
  v_cvt_pk_bf16_f32 v234, v240, v241
  v_mfma_f32_16x16x32_bf16 v[148:151], v[76:79], a[212:215], v[148:151]
  buffer_load_dwordx4 v8, s[36:39], s27 offen offset:0 lds
  v_cvt_pk_bf16_f32 v235, v242, v243
  v_mfma_f32_16x16x32_bf16 v[164:167], v[80:83], a[212:215], v[164:167]
  ds_read_b64_tr_b16 v[50:51], v12 offset:34304
  v_mfma_f32_16x16x32_bf16 v[180:183], v[84:87], a[212:215], v[180:183]
  s_add_u32 s63, s63, s61
  ds_read_b64_tr_b16 v[52:53], v13 offset:33280
  v_mfma_f32_16x16x32_bf16 v[196:199], v[88:91], a[212:215], v[196:199]
  ds_read_b64_tr_b16 v[54:55], v13 offset:34304
  v_mfma_f32_16x16x32_bf16 v[212:215], v[92:95], a[212:215], v[212:215]
  buffer_load_dwordx4 a[212:215], v2, s[40:43], s65 offen offset:1024 sc1
  v_mfma_f32_16x16x32_bf16 v[104:107], v[64:67], a[216:219], v[104:107]
  ds_read_b64_tr_b16 v[56:57], v12 offset:33536
  v_accvgpr_read_b32 v248, a76
  v_mfma_f32_16x16x32_bf16 v[120:123], v[68:71], a[216:219], v[120:123]
  ds_read_b64_tr_b16 v[58:59], v12 offset:34560
  v_accvgpr_read_b32 v249, a77
  v_mfma_f32_16x16x32_bf16 v[136:139], v[72:75], a[216:219], v[136:139]
  ds_read_b64_tr_b16 v[60:61], v13 offset:33536
  v_accvgpr_read_b32 v250, a78
  v_mfma_f32_16x16x32_bf16 v[152:155], v[76:79], a[216:219], v[152:155]
  buffer_load_dwordx4 v9, s[36:39], s27 offen offset:1024 lds
  v_accvgpr_read_b32 v251, a79
  v_mfma_f32_16x16x32_bf16 v[168:171], v[80:83], a[216:219], v[168:171]
  ds_read_b64_tr_b16 v[62:63], v13 offset:34560
  v_accvgpr_read_b32 v252, a108
  v_mfma_f32_16x16x32_bf16 v[184:187], v[84:87], a[216:219], v[184:187]
  buffer_store_dwordx4 v[232:235], v2, s[40:43], s63 offen offset:0 sc1
  v_accvgpr_read_b32 v253, a109
  v_mfma_f32_16x16x32_bf16 v[200:203], v[88:91], a[216:219], v[200:203]
  buffer_load_dwordx4 v10, s[36:39], s27 offen offset:2048 lds
  v_accvgpr_read_b32 v254, a110
  v_mfma_f32_16x16x32_bf16 v[216:219], v[92:95], a[216:219], v[216:219]
  buffer_load_dwordx4 a[216:219], v2, s[40:43], s66 offen offset:1024 sc1
  v_accvgpr_read_b32 v255, a111
  v_mfma_f32_16x16x32_bf16 v[108:111], v[64:67], a[220:223], v[108:111]
  v_cvt_pk_bf16_f32 v244, v248, v249
  v_mfma_f32_16x16x32_bf16 v[124:127], v[68:71], a[220:223], v[124:127]
  buffer_load_dwordx4 v11, s[36:39], s27 offen offset:3072 lds
  v_cvt_pk_bf16_f32 v245, v250, v251
  v_mfma_f32_16x16x32_bf16 v[140:143], v[72:75], a[220:223], v[140:143]
  s_add_u32 s27, s27, 524288
  v_cvt_pk_bf16_f32 v246, v252, v253
  v_mfma_f32_16x16x32_bf16 v[156:159], v[76:79], a[220:223], v[156:159]
  s_add_u32 s24, s24, 32768
  v_cvt_pk_bf16_f32 v247, v254, v255
  v_mfma_f32_16x16x32_bf16 v[172:175], v[80:83], a[220:223], v[172:175]
  s_and_b32 s24, s24, 0x1ffff
  v_mfma_f32_16x16x32_bf16 v[188:191], v[84:87], a[220:223], v[188:191]
  buffer_store_dwordx4 v[244:247], v2, s[40:43], s63 offen offset:1024 sc1
  v_mfma_f32_16x16x32_bf16 v[204:207], v[88:91], a[220:223], v[204:207]
  v_mfma_f32_16x16x32_bf16 v[220:223], v[92:95], a[220:223], v[220:223]
  s_waitcnt vmcnt(25) lgkmcnt(0)
  buffer_load_dwordx4 a[220:223], v2, s[40:43], s67 offen offset:1024 sc1
  v_mfma_f32_16x16x32_bf16 v[96:99], v[32:35], a[224:227], v[96:99]
  v_accvgpr_read_b32 v236, a80
  v_mfma_f32_16x16x32_bf16 v[112:115], v[36:39], a[224:227], v[112:115]
  ds_read_b64_tr_b16 v[64:65], v12 offset:40960
  v_accvgpr_read_b32 v237, a81
  v_mfma_f32_16x16x32_bf16 v[128:131], v[40:43], a[224:227], v[128:131]
  ds_read_b64_tr_b16 v[66:67], v12 offset:41984
  v_accvgpr_read_b32 v238, a82
  v_mfma_f32_16x16x32_bf16 v[144:147], v[44:47], a[224:227], v[144:147]
  ds_read_b64_tr_b16 v[68:69], v13 offset:40960
  v_accvgpr_read_b32 v239, a83
  v_mfma_f32_16x16x32_bf16 v[160:163], v[48:51], a[224:227], v[160:163]
  ds_read_b64_tr_b16 v[70:71], v13 offset:41984
  v_accvgpr_read_b32 v240, a112
  v_mfma_f32_16x16x32_bf16 v[176:179], v[52:55], a[224:227], v[176:179]
  ds_read_b64_tr_b16 v[72:73], v12 offset:41216
  v_accvgpr_read_b32 v241, a113
  v_mfma_f32_16x16x32_bf16 v[192:195], v[56:59], a[224:227], v[192:195]
  ds_read_b64_tr_b16 v[74:75], v12 offset:42240
  v_accvgpr_read_b32 v242, a114
  v_mfma_f32_16x16x32_bf16 v[208:211], v[60:63], a[224:227], v[208:211]
  buffer_load_dwordx4 a[224:227], v2, s[40:43], s64 offen offset:2048 sc1
  v_accvgpr_read_b32 v243, a115
  v_mfma_f32_16x16x32_bf16 v[100:103], v[32:35], a[228:231], v[100:103]
  ds_read_b64_tr_b16 v[76:77], v13 offset:41216
  v_cvt_pk_bf16_f32 v232, v236, v237
  v_mfma_f32_16x16x32_bf16 v[116:119], v[36:39], a[228:231], v[116:119]
  ds_read_b64_tr_b16 v[78:79], v13 offset:42240
  v_cvt_pk_bf16_f32 v233, v238, v239
  v_mfma_f32_16x16x32_bf16 v[132:135], v[40:43], a[228:231], v[132:135]
  ds_read_b64_tr_b16 v[80:81], v12 offset:41472
  v_cvt_pk_bf16_f32 v234, v240, v241
  v_mfma_f32_16x16x32_bf16 v[148:151], v[44:47], a[228:231], v[148:151]
  v_cvt_pk_bf16_f32 v235, v242, v243
  v_mfma_f32_16x16x32_bf16 v[164:167], v[48:51], a[228:231], v[164:167]
  ds_read_b64_tr_b16 v[82:83], v12 offset:42496
  v_mfma_f32_16x16x32_bf16 v[180:183], v[52:55], a[228:231], v[180:183]
  s_add_u32 s63, s63, s61
  ds_read_b64_tr_b16 v[84:85], v13 offset:41472
  v_mfma_f32_16x16x32_bf16 v[196:199], v[56:59], a[228:231], v[196:199]
  ds_read_b64_tr_b16 v[86:87], v13 offset:42496
  v_mfma_f32_16x16x32_bf16 v[212:215], v[60:63], a[228:231], v[212:215]
  buffer_load_dwordx4 a[228:231], v2, s[40:43], s65 offen offset:2048 sc1
  v_mfma_f32_16x16x32_bf16 v[104:107], v[32:35], a[232:235], v[104:107]
  ds_read_b64_tr_b16 v[88:89], v12 offset:41728
  v_accvgpr_read_b32 v248, a84
  v_mfma_f32_16x16x32_bf16 v[120:123], v[36:39], a[232:235], v[120:123]
  ds_read_b64_tr_b16 v[90:91], v12 offset:42752
  v_accvgpr_read_b32 v249, a85
  v_mfma_f32_16x16x32_bf16 v[136:139], v[40:43], a[232:235], v[136:139]
  ds_read_b64_tr_b16 v[92:93], v13 offset:41728
  v_accvgpr_read_b32 v250, a86
  v_mfma_f32_16x16x32_bf16 v[152:155], v[44:47], a[232:235], v[152:155]
  v_accvgpr_read_b32 v251, a87
  v_mfma_f32_16x16x32_bf16 v[168:171], v[48:51], a[232:235], v[168:171]
  ds_read_b64_tr_b16 v[94:95], v13 offset:42752
  v_accvgpr_read_b32 v252, a116
  v_mfma_f32_16x16x32_bf16 v[184:187], v[52:55], a[232:235], v[184:187]
  buffer_store_dwordx4 v[232:235], v2, s[40:43], s63 offen offset:0 sc1
  v_accvgpr_read_b32 v253, a117
  v_mfma_f32_16x16x32_bf16 v[200:203], v[56:59], a[232:235], v[200:203]
  v_accvgpr_read_b32 v254, a118
  v_mfma_f32_16x16x32_bf16 v[216:219], v[60:63], a[232:235], v[216:219]
  buffer_load_dwordx4 a[232:235], v2, s[40:43], s66 offen offset:2048 sc1
  v_accvgpr_read_b32 v255, a119
  v_mfma_f32_16x16x32_bf16 v[108:111], v[32:35], a[236:239], v[108:111]
  v_xor_b32 v12, 0x10000, v12
  v_cvt_pk_bf16_f32 v244, v248, v249
  v_mfma_f32_16x16x32_bf16 v[124:127], v[36:39], a[236:239], v[124:127]
  v_cvt_pk_bf16_f32 v245, v250, v251
  v_mfma_f32_16x16x32_bf16 v[140:143], v[40:43], a[236:239], v[140:143]
  v_xor_b32 v13, 0x10000, v13
  v_cvt_pk_bf16_f32 v246, v252, v253
  v_mfma_f32_16x16x32_bf16 v[156:159], v[44:47], a[236:239], v[156:159]
  v_cvt_pk_bf16_f32 v247, v254, v255
  v_mfma_f32_16x16x32_bf16 v[172:175], v[48:51], a[236:239], v[172:175]
  v_mfma_f32_16x16x32_bf16 v[188:191], v[52:55], a[236:239], v[188:191]
  buffer_store_dwordx4 v[244:247], v2, s[40:43], s63 offen offset:1024 sc1
  v_mfma_f32_16x16x32_bf16 v[204:207], v[56:59], a[236:239], v[204:207]
  v_mfma_f32_16x16x32_bf16 v[220:223], v[60:63], a[236:239], v[220:223]
  s_waitcnt vmcnt(21) lgkmcnt(0)
  buffer_load_dwordx4 a[236:239], v2, s[40:43], s67 offen offset:2048 sc1
  v_mfma_f32_16x16x32_bf16 v[96:99], v[64:67], a[240:243], v[96:99]
  s_barrier
  v_accvgpr_read_b32 v236, a88
  v_mfma_f32_16x16x32_bf16 v[112:115], v[68:71], a[240:243], v[112:115]
  ds_read_b64_tr_b16 v[32:33], v12 offset:0
  v_accvgpr_read_b32 v237, a89
  v_mfma_f32_16x16x32_bf16 v[128:131], v[72:75], a[240:243], v[128:131]
  ds_read_b64_tr_b16 v[34:35], v12 offset:1024
  v_accvgpr_read_b32 v238, a90
  v_mfma_f32_16x16x32_bf16 v[144:147], v[76:79], a[240:243], v[144:147]
  ds_read_b64_tr_b16 v[36:37], v13 offset:0
  v_accvgpr_read_b32 v239, a91
  v_mfma_f32_16x16x32_bf16 v[160:163], v[80:83], a[240:243], v[160:163]
  ds_read_b64_tr_b16 v[38:39], v13 offset:1024
  v_accvgpr_read_b32 v240, a120
  v_mfma_f32_16x16x32_bf16 v[176:179], v[84:87], a[240:243], v[176:179]
  ds_read_b64_tr_b16 v[40:41], v12 offset:256
  v_accvgpr_read_b32 v241, a121
  v_mfma_f32_16x16x32_bf16 v[192:195], v[88:91], a[240:243], v[192:195]
  ds_read_b64_tr_b16 v[42:43], v12 offset:1280
  v_accvgpr_read_b32 v242, a122
  v_mfma_f32_16x16x32_bf16 v[208:211], v[92:95], a[240:243], v[208:211]
  buffer_load_dwordx4 a[240:243], v2, s[40:43], s64 offen offset:3072 sc1
  v_accvgpr_read_b32 v243, a123
  v_mfma_f32_16x16x32_bf16 v[100:103], v[64:67], a[244:247], v[100:103]
  s_add_u32 s64, s64, 4096
  ds_read_b64_tr_b16 v[44:45], v13 offset:256
  v_cvt_pk_bf16_f32 v232, v236, v237
  v_mfma_f32_16x16x32_bf16 v[116:119], v[68:71], a[244:247], v[116:119]
  ds_read_b64_tr_b16 v[46:47], v13 offset:1280
  v_cvt_pk_bf16_f32 v233, v238, v239
  v_mfma_f32_16x16x32_bf16 v[132:135], v[72:75], a[244:247], v[132:135]
  s_add_u32 m0, s24, 16384
  ds_read_b64_tr_b16 v[48:49], v12 offset:512
  v_cvt_pk_bf16_f32 v234, v240, v241
  v_mfma_f32_16x16x32_bf16 v[148:151], v[76:79], a[244:247], v[148:151]
  buffer_load_dwordx4 v8, s[36:39], s27 offen offset:0 lds
  v_cvt_pk_bf16_f32 v235, v242, v243
  v_mfma_f32_16x16x32_bf16 v[164:167], v[80:83], a[244:247], v[164:167]
  ds_read_b64_tr_b16 v[50:51], v12 offset:1536
  v_mfma_f32_16x16x32_bf16 v[180:183], v[84:87], a[244:247], v[180:183]
  s_add_u32 s63, s63, s61
  ds_read_b64_tr_b16 v[52:53], v13 offset:512
  v_mfma_f32_16x16x32_bf16 v[196:199], v[88:91], a[244:247], v[196:199]
  ds_read_b64_tr_b16 v[54:55], v13 offset:1536
  v_mfma_f32_16x16x32_bf16 v[212:215], v[92:95], a[244:247], v[212:215]
  buffer_load_dwordx4 a[244:247], v2, s[40:43], s65 offen offset:3072 sc1
  v_mfma_f32_16x16x32_bf16 v[104:107], v[64:67], a[248:251], v[104:107]
  s_add_u32 s65, s65, 4096
  ds_read_b64_tr_b16 v[56:57], v12 offset:768
  v_accvgpr_read_b32 v248, a92
  v_mfma_f32_16x16x32_bf16 v[120:123], v[68:71], a[248:251], v[120:123]
  ds_read_b64_tr_b16 v[58:59], v12 offset:1792
  v_accvgpr_read_b32 v249, a93
  v_mfma_f32_16x16x32_bf16 v[136:139], v[72:75], a[248:251], v[136:139]
  ds_read_b64_tr_b16 v[60:61], v13 offset:768
  v_accvgpr_read_b32 v250, a94
  v_mfma_f32_16x16x32_bf16 v[152:155], v[76:79], a[248:251], v[152:155]
  buffer_load_dwordx4 v9, s[36:39], s27 offen offset:1024 lds
  v_accvgpr_read_b32 v251, a95
  v_mfma_f32_16x16x32_bf16 v[168:171], v[80:83], a[248:251], v[168:171]
  ds_read_b64_tr_b16 v[62:63], v13 offset:1792
  v_accvgpr_read_b32 v252, a124
  v_mfma_f32_16x16x32_bf16 v[184:187], v[84:87], a[248:251], v[184:187]
  buffer_store_dwordx4 v[232:235], v2, s[40:43], s63 offen offset:0 sc1
  v_accvgpr_read_b32 v253, a125
  v_mfma_f32_16x16x32_bf16 v[200:203], v[88:91], a[248:251], v[200:203]
  buffer_load_dwordx4 v10, s[36:39], s27 offen offset:2048 lds
  v_accvgpr_read_b32 v254, a126
  v_mfma_f32_16x16x32_bf16 v[216:219], v[92:95], a[248:251], v[216:219]
  buffer_load_dwordx4 a[248:251], v2, s[40:43], s66 offen offset:3072 sc1
  v_accvgpr_read_b32 v255, a127
  v_mfma_f32_16x16x32_bf16 v[108:111], v[64:67], a[252:255], v[108:111]
  s_add_u32 s66, s66, 4096
  v_cvt_pk_bf16_f32 v244, v248, v249
  v_mfma_f32_16x16x32_bf16 v[124:127], v[68:71], a[252:255], v[124:127]
  buffer_load_dwordx4 v11, s[36:39], s27 offen offset:3072 lds
  v_cvt_pk_bf16_f32 v245, v250, v251
  v_mfma_f32_16x16x32_bf16 v[140:143], v[72:75], a[252:255], v[140:143]
  s_add_u32 s27, s27, 524288
  v_cvt_pk_bf16_f32 v246, v252, v253
  v_mfma_f32_16x16x32_bf16 v[156:159], v[76:79], a[252:255], v[156:159]
  s_add_u32 s24, s24, 32768
  v_cvt_pk_bf16_f32 v247, v254, v255
  v_mfma_f32_16x16x32_bf16 v[172:175], v[80:83], a[252:255], v[172:175]
  s_and_b32 s24, s24, 0x1ffff
  v_mfma_f32_16x16x32_bf16 v[188:191], v[84:87], a[252:255], v[188:191]
  buffer_store_dwordx4 v[244:247], v2, s[40:43], s63 offen offset:1024 sc1
  v_mfma_f32_16x16x32_bf16 v[204:207], v[88:91], a[252:255], v[204:207]
  v_mfma_f32_16x16x32_bf16 v[220:223], v[92:95], a[252:255], v[220:223]
  s_waitcnt vmcnt(25) lgkmcnt(0)
  buffer_load_dwordx4 a[252:255], v2, s[40:43], s67 offen offset:3072 sc1
  v_mfma_f32_16x16x32_bf16 v[96:99], v[32:35], a[192:195], v[96:99]
  v_accvgpr_read_b32 v236, a128
  v_mfma_f32_16x16x32_bf16 v[112:115], v[36:39], a[192:195], v[112:115]
  s_add_u32 s67, s67, 4096
  ds_read_b64_tr_b16 v[64:65], v12 offset:8192
  v_accvgpr_read_b32 v237, a129
  v_mfma_f32_16x16x32_bf16 v[128:131], v[40:43], a[192:195], v[128:131]
  ds_read_b64_tr_b16 v[66:67], v12 offset:9216
  v_accvgpr_read_b32 v238, a130
  v_mfma_f32_16x16x32_bf16 v[144:147], v[44:47], a[192:195], v[144:147]
  ds_read_b64_tr_b16 v[68:69], v13 offset:8192
  v_accvgpr_read_b32 v239, a131
  v_mfma_f32_16x16x32_bf16 v[160:163], v[48:51], a[192:195], v[160:163]
  ds_read_b64_tr_b16 v[70:71], v13 offset:9216
  v_accvgpr_read_b32 v240, a160
  v_mfma_f32_16x16x32_bf16 v[176:179], v[52:55], a[192:195], v[176:179]
  ds_read_b64_tr_b16 v[72:73], v12 offset:8448
  v_accvgpr_read_b32 v241, a161
  v_mfma_f32_16x16x32_bf16 v[192:195], v[56:59], a[192:195], v[192:195]
  ds_read_b64_tr_b16 v[74:75], v12 offset:9472
  v_accvgpr_read_b32 v242, a162
  v_mfma_f32_16x16x32_bf16 v[208:211], v[60:63], a[192:195], v[208:211]
  buffer_load_dwordx4 a[192:195], v2, s[40:43], s64 offen offset:0 sc1
  v_accvgpr_read_b32 v243, a163
  v_mfma_f32_16x16x32_bf16 v[100:103], v[32:35], a[196:199], v[100:103]
  ds_read_b64_tr_b16 v[76:77], v13 offset:8448
  v_cvt_pk_bf16_f32 v232, v236, v237
  v_mfma_f32_16x16x32_bf16 v[116:119], v[36:39], a[196:199], v[116:119]
  ds_read_b64_tr_b16 v[78:79], v13 offset:9472
  v_cvt_pk_bf16_f32 v233, v238, v239
  v_mfma_f32_16x16x32_bf16 v[132:135], v[40:43], a[196:199], v[132:135]
  ds_read_b64_tr_b16 v[80:81], v12 offset:8704
  v_cvt_pk_bf16_f32 v234, v240, v241
  v_mfma_f32_16x16x32_bf16 v[148:151], v[44:47], a[196:199], v[148:151]
  v_cvt_pk_bf16_f32 v235, v242, v243
  v_mfma_f32_16x16x32_bf16 v[164:167], v[48:51], a[196:199], v[164:167]
  ds_read_b64_tr_b16 v[82:83], v12 offset:9728
  v_mfma_f32_16x16x32_bf16 v[180:183], v[52:55], a[196:199], v[180:183]
  s_mul_i32 s63, s60, 2
  ds_read_b64_tr_b16 v[84:85], v13 offset:8704
  v_mfma_f32_16x16x32_bf16 v[196:199], v[56:59], a[196:199], v[196:199]
  s_add_u32 s63, s63, s62
  ds_read_b64_tr_b16 v[86:87], v13 offset:9728
  v_mfma_f32_16x16x32_bf16 v[212:215], v[60:63], a[196:199], v[212:215]
  buffer_load_dwordx4 a[196:199], v2, s[40:43], s65 offen offset:0 sc1
  v_mfma_f32_16x16x32_bf16 v[104:107], v[32:35], a[200:203], v[104:107]
  ds_read_b64_tr_b16 v[88:89], v12 offset:8960
  v_accvgpr_read_b32 v248, a132
  v_mfma_f32_16x16x32_bf16 v[120:123], v[36:39], a[200:203], v[120:123]
  ds_read_b64_tr_b16 v[90:91], v12 offset:9984
  v_accvgpr_read_b32 v249, a133
  v_mfma_f32_16x16x32_bf16 v[136:139], v[40:43], a[200:203], v[136:139]
  ds_read_b64_tr_b16 v[92:93], v13 offset:8960
  v_accvgpr_read_b32 v250, a134
  v_mfma_f32_16x16x32_bf16 v[152:155], v[44:47], a[200:203], v[152:155]
  v_accvgpr_read_b32 v251, a135
  v_mfma_f32_16x16x32_bf16 v[168:171], v[48:51], a[200:203], v[168:171]
  ds_read_b64_tr_b16 v[94:95], v13 offset:9984
  v_accvgpr_read_b32 v252, a164
  v_mfma_f32_16x16x32_bf16 v[184:187], v[52:55], a[200:203], v[184:187]
  buffer_store_dwordx4 v[232:235], v2, s[40:43], s63 offen offset:0 sc1
  v_accvgpr_read_b32 v253, a165
  v_mfma_f32_16x16x32_bf16 v[200:203], v[56:59], a[200:203], v[200:203]
  v_accvgpr_read_b32 v254, a166
  v_mfma_f32_16x16x32_bf16 v[216:219], v[60:63], a[200:203], v[216:219]
  buffer_load_dwordx4 a[200:203], v2, s[40:43], s66 offen offset:0 sc1
  v_accvgpr_read_b32 v255, a167
  v_mfma_f32_16x16x32_bf16 v[108:111], v[32:35], a[204:207], v[108:111]
  v_cvt_pk_bf16_f32 v244, v248, v249
  v_mfma_f32_16x16x32_bf16 v[124:127], v[36:39], a[204:207], v[124:127]
  v_cvt_pk_bf16_f32 v245, v250, v251
  v_mfma_f32_16x16x32_bf16 v[140:143], v[40:43], a[204:207], v[140:143]
  v_cvt_pk_bf16_f32 v246, v252, v253
  v_mfma_f32_16x16x32_bf16 v[156:159], v[44:47], a[204:207], v[156:159]
  v_cvt_pk_bf16_f32 v247, v254, v255
  v_mfma_f32_16x16x32_bf16 v[172:175], v[48:51], a[204:207], v[172:175]
  v_mfma_f32_16x16x32_bf16 v[188:191], v[52:55], a[204:207], v[188:191]
  buffer_store_dwordx4 v[244:247], v2, s[40:43], s63 offen offset:1024 sc1
  v_mfma_f32_16x16x32_bf16 v[204:207], v[56:59], a[204:207], v[204:207]
  v_mfma_f32_16x16x32_bf16 v[220:223], v[60:63], a[204:207], v[220:223]
  s_waitcnt vmcnt(21) lgkmcnt(0)
  buffer_load_dwordx4 a[204:207], v2, s[40:43], s67 offen offset:0 sc1
  v_mfma_f32_16x16x32_bf16 v[96:99], v[64:67], a[208:211], v[96:99]
  s_barrier
  v_accvgpr_read_b32 v236, a136
  v_mfma_f32_16x16x32_bf16 v[112:115], v[68:71], a[208:211], v[112:115]
  ds_read_b64_tr_b16 v[32:33], v12 offset:32768
  v_accvgpr_read_b32 v237, a137
  v_mfma_f32_16x16x32_bf16 v[128:131], v[72:75], a[208:211], v[128:131]
  ds_read_b64_tr_b16 v[34:35], v12 offset:33792
  v_accvgpr_read_b32 v238, a138
  v_mfma_f32_16x16x32_bf16 v[144:147], v[76:79], a[208:211], v[144:147]
  ds_read_b64_tr_b16 v[36:37], v13 offset:32768
  v_accvgpr_read_b32 v239, a139
  v_mfma_f32_16x16x32_bf16 v[160:163], v[80:83], a[208:211], v[160:163]
  ds_read_b64_tr_b16 v[38:39], v13 offset:33792
  v_accvgpr_read_b32 v240, a168
  v_mfma_f32_16x16x32_bf16 v[176:179], v[84:87], a[208:211], v[176:179]
  ds_read_b64_tr_b16 v[40:41], v12 offset:33024
  v_accvgpr_read_b32 v241, a169
  v_mfma_f32_16x16x32_bf16 v[192:195], v[88:91], a[208:211], v[192:195]
  ds_read_b64_tr_b16 v[42:43], v12 offset:34048
  v_accvgpr_read_b32 v242, a170
  v_mfma_f32_16x16x32_bf16 v[208:211], v[92:95], a[208:211], v[208:211]
  buffer_load_dwordx4 a[208:211], v2, s[40:43], s64 offen offset:1024 sc1
  v_accvgpr_read_b32 v243, a171
  v_mfma_f32_16x16x32_bf16 v[100:103], v[64:67], a[212:215], v[100:103]
  ds_read_b64_tr_b16 v[44:45], v13 offset:33024
  v_cvt_pk_bf16_f32 v232, v236, v237
  v_mfma_f32_16x16x32_bf16 v[116:119], v[68:71], a[212:215], v[116:119]
  ds_read_b64_tr_b16 v[46:47], v13 offset:34048
  v_cvt_pk_bf16_f32 v233, v238, v239
  v_mfma_f32_16x16x32_bf16 v[132:135], v[72:75], a[212:215], v[132:135]
  s_add_u32 m0, s24, 16384
  ds_read_b64_tr_b16 v[48:49], v12 offset:33280
  v_cvt_pk_bf16_f32 v234, v240, v241
  v_mfma_f32_16x16x32_bf16 v[148:151], v[76:79], a[212:215], v[148:151]
  buffer_load_dwordx4 v8, s[36:39], s27 offen offset:0 lds
  v_cvt_pk_bf16_f32 v235, v242, v243
  v_mfma_f32_16x16x32_bf16 v[164:167], v[80:83], a[212:215], v[164:167]
  ds_read_b64_tr_b16 v[50:51], v12 offset:34304
  v_mfma_f32_16x16x32_bf16 v[180:183], v[84:87], a[212:215], v[180:183]
  s_add_u32 s63, s63, s61
  ds_read_b64_tr_b16 v[52:53], v13 offset:33280
  v_mfma_f32_16x16x32_bf16 v[196:199], v[88:91], a[212:215], v[196:199]
  ds_read_b64_tr_b16 v[54:55], v13 offset:34304
  v_mfma_f32_16x16x32_bf16 v[212:215], v[92:95], a[212:215], v[212:215]
  buffer_load_dwordx4 a[212:215], v2, s[40:43], s65 offen offset:1024 sc1
  v_mfma_f32_16x16x32_bf16 v[104:107], v[64:67], a[216:219], v[104:107]
  ds_read_b64_tr_b16 v[56:57], v12 offset:33536
  v_accvgpr_read_b32 v248, a140
  v_mfma_f32_16x16x32_bf16 v[120:123], v[68:71], a[216:219], v[120:123]
  ds_read_b64_tr_b16 v[58:59], v12 offset:34560
  v_accvgpr_read_b32 v249, a141
  v_mfma_f32_16x16x32_bf16 v[136:139], v[72:75], a[216:219], v[136:139]
  ds_read_b64_tr_b16 v[60:61], v13 offset:33536
  v_accvgpr_read_b32 v250, a142
  v_mfma_f32_16x16x32_bf16 v[152:155], v[76:79], a[216:219], v[152:155]
  buffer_load_dwordx4 v9, s[36:39], s27 offen offset:1024 lds
  v_accvgpr_read_b32 v251, a143
  v_mfma_f32_16x16x32_bf16 v[168:171], v[80:83], a[216:219], v[168:171]
  ds_read_b64_tr_b16 v[62:63], v13 offset:34560
  v_accvgpr_read_b32 v252, a172
  v_mfma_f32_16x16x32_bf16 v[184:187], v[84:87], a[216:219], v[184:187]
  buffer_store_dwordx4 v[232:235], v2, s[40:43], s63 offen offset:0 sc1
  v_accvgpr_read_b32 v253, a173
  v_mfma_f32_16x16x32_bf16 v[200:203], v[88:91], a[216:219], v[200:203]
  buffer_load_dwordx4 v10, s[36:39], s27 offen offset:2048 lds
  v_accvgpr_read_b32 v254, a174
  v_mfma_f32_16x16x32_bf16 v[216:219], v[92:95], a[216:219], v[216:219]
  buffer_load_dwordx4 a[216:219], v2, s[40:43], s66 offen offset:1024 sc1
  v_accvgpr_read_b32 v255, a175
  v_mfma_f32_16x16x32_bf16 v[108:111], v[64:67], a[220:223], v[108:111]
  v_cvt_pk_bf16_f32 v244, v248, v249
  v_mfma_f32_16x16x32_bf16 v[124:127], v[68:71], a[220:223], v[124:127]
  buffer_load_dwordx4 v11, s[36:39], s27 offen offset:3072 lds
  v_cvt_pk_bf16_f32 v245, v250, v251
  v_mfma_f32_16x16x32_bf16 v[140:143], v[72:75], a[220:223], v[140:143]
  s_add_u32 s27, s27, 524288
  v_cvt_pk_bf16_f32 v246, v252, v253
  v_mfma_f32_16x16x32_bf16 v[156:159], v[76:79], a[220:223], v[156:159]
  s_add_u32 s24, s24, 32768
  v_cvt_pk_bf16_f32 v247, v254, v255
  v_mfma_f32_16x16x32_bf16 v[172:175], v[80:83], a[220:223], v[172:175]
  s_and_b32 s24, s24, 0x1ffff
  v_mfma_f32_16x16x32_bf16 v[188:191], v[84:87], a[220:223], v[188:191]
  buffer_store_dwordx4 v[244:247], v2, s[40:43], s63 offen offset:1024 sc1
  v_mfma_f32_16x16x32_bf16 v[204:207], v[88:91], a[220:223], v[204:207]
  v_mfma_f32_16x16x32_bf16 v[220:223], v[92:95], a[220:223], v[220:223]
  s_waitcnt vmcnt(25) lgkmcnt(0)
  buffer_load_dwordx4 a[220:223], v2, s[40:43], s67 offen offset:1024 sc1
  v_mfma_f32_16x16x32_bf16 v[96:99], v[32:35], a[224:227], v[96:99]
  v_accvgpr_read_b32 v236, a144
  v_mfma_f32_16x16x32_bf16 v[112:115], v[36:39], a[224:227], v[112:115]
  ds_read_b64_tr_b16 v[64:65], v12 offset:40960
  v_accvgpr_read_b32 v237, a145
  v_mfma_f32_16x16x32_bf16 v[128:131], v[40:43], a[224:227], v[128:131]
  ds_read_b64_tr_b16 v[66:67], v12 offset:41984
  v_accvgpr_read_b32 v238, a146
  v_mfma_f32_16x16x32_bf16 v[144:147], v[44:47], a[224:227], v[144:147]
  ds_read_b64_tr_b16 v[68:69], v13 offset:40960
  v_accvgpr_read_b32 v239, a147
  v_mfma_f32_16x16x32_bf16 v[160:163], v[48:51], a[224:227], v[160:163]
  ds_read_b64_tr_b16 v[70:71], v13 offset:41984
  v_accvgpr_read_b32 v240, a176
  v_mfma_f32_16x16x32_bf16 v[176:179], v[52:55], a[224:227], v[176:179]
  ds_read_b64_tr_b16 v[72:73], v12 offset:41216
  v_accvgpr_read_b32 v241, a177
  v_mfma_f32_16x16x32_bf16 v[192:195], v[56:59], a[224:227], v[192:195]
  ds_read_b64_tr_b16 v[74:75], v12 offset:42240
  v_accvgpr_read_b32 v242, a178
  v_mfma_f32_16x16x32_bf16 v[208:211], v[60:63], a[224:227], v[208:211]
  buffer_load_dwordx4 a[224:227], v2, s[40:43], s64 offen offset:2048 sc1
  v_accvgpr_read_b32 v243, a179
  v_mfma_f32_16x16x32_bf16 v[100:103], v[32:35], a[228:231], v[100:103]
  ds_read_b64_tr_b16 v[76:77], v13 offset:41216
  v_cvt_pk_bf16_f32 v232, v236, v237
  v_mfma_f32_16x16x32_bf16 v[116:119], v[36:39], a[228:231], v[116:119]
  ds_read_b64_tr_b16 v[78:79], v13 offset:42240
  v_cvt_pk_bf16_f32 v233, v238, v239
  v_mfma_f32_16x16x32_bf16 v[132:135], v[40:43], a[228:231], v[132:135]
  ds_read_b64_tr_b16 v[80:81], v12 offset:41472
  v_cvt_pk_bf16_f32 v234, v240, v241
  v_mfma_f32_16x16x32_bf16 v[148:151], v[44:47], a[228:231], v[148:151]
  v_cvt_pk_bf16_f32 v235, v242, v243
  v_mfma_f32_16x16x32_bf16 v[164:167], v[48:51], a[228:231], v[164:167]
  ds_read_b64_tr_b16 v[82:83], v12 offset:42496
  v_mfma_f32_16x16x32_bf16 v[180:183], v[52:55], a[228:231], v[180:183]
  s_add_u32 s63, s63, s61
  ds_read_b64_tr_b16 v[84:85], v13 offset:41472
  v_mfma_f32_16x16x32_bf16 v[196:199], v[56:59], a[228:231], v[196:199]
  ds_read_b64_tr_b16 v[86:87], v13 offset:42496
  v_mfma_f32_16x16x32_bf16 v[212:215], v[60:63], a[228:231], v[212:215]
  buffer_load_dwordx4 a[228:231], v2, s[40:43], s65 offen offset:2048 sc1
  v_mfma_f32_16x16x32_bf16 v[104:107], v[32:35], a[232:235], v[104:107]
  ds_read_b64_tr_b16 v[88:89], v12 offset:41728
  v_accvgpr_read_b32 v248, a148
  v_mfma_f32_16x16x32_bf16 v[120:123], v[36:39], a[232:235], v[120:123]
  ds_read_b64_tr_b16 v[90:91], v12 offset:42752
  v_accvgpr_read_b32 v249, a149
  v_mfma_f32_16x16x32_bf16 v[136:139], v[40:43], a[232:235], v[136:139]
  ds_read_b64_tr_b16 v[92:93], v13 offset:41728
  v_accvgpr_read_b32 v250, a150
  v_mfma_f32_16x16x32_bf16 v[152:155], v[44:47], a[232:235], v[152:155]
  v_accvgpr_read_b32 v251, a151
  v_mfma_f32_16x16x32_bf16 v[168:171], v[48:51], a[232:235], v[168:171]
  ds_read_b64_tr_b16 v[94:95], v13 offset:42752
  v_accvgpr_read_b32 v252, a180
  v_mfma_f32_16x16x32_bf16 v[184:187], v[52:55], a[232:235], v[184:187]
  buffer_store_dwordx4 v[232:235], v2, s[40:43], s63 offen offset:0 sc1
  v_accvgpr_read_b32 v253, a181
  v_mfma_f32_16x16x32_bf16 v[200:203], v[56:59], a[232:235], v[200:203]
  v_accvgpr_read_b32 v254, a182
  v_mfma_f32_16x16x32_bf16 v[216:219], v[60:63], a[232:235], v[216:219]
  buffer_load_dwordx4 a[232:235], v2, s[40:43], s66 offen offset:2048 sc1
  v_accvgpr_read_b32 v255, a183
  v_mfma_f32_16x16x32_bf16 v[108:111], v[32:35], a[236:239], v[108:111]
  v_xor_b32 v12, 0x10000, v12
  v_cvt_pk_bf16_f32 v244, v248, v249
  v_mfma_f32_16x16x32_bf16 v[124:127], v[36:39], a[236:239], v[124:127]
  v_cvt_pk_bf16_f32 v245, v250, v251
  v_mfma_f32_16x16x32_bf16 v[140:143], v[40:43], a[236:239], v[140:143]
  v_xor_b32 v13, 0x10000, v13
  v_cvt_pk_bf16_f32 v246, v252, v253
  v_mfma_f32_16x16x32_bf16 v[156:159], v[44:47], a[236:239], v[156:159]
  v_cvt_pk_bf16_f32 v247, v254, v255
  v_mfma_f32_16x16x32_bf16 v[172:175], v[48:51], a[236:239], v[172:175]
  v_mfma_f32_16x16x32_bf16 v[188:191], v[52:55], a[236:239], v[188:191]
  buffer_store_dwordx4 v[244:247], v2, s[40:43], s63 offen offset:1024 sc1
  v_mfma_f32_16x16x32_bf16 v[204:207], v[56:59], a[236:239], v[204:207]
  v_mfma_f32_16x16x32_bf16 v[220:223], v[60:63], a[236:239], v[220:223]
  s_waitcnt vmcnt(21) lgkmcnt(0)
  buffer_load_dwordx4 a[236:239], v2, s[40:43], s67 offen offset:2048 sc1
  v_mfma_f32_16x16x32_bf16 v[96:99], v[64:67], a[240:243], v[96:99]
  s_barrier
  v_accvgpr_read_b32 v236, a152
  v_mfma_f32_16x16x32_bf16 v[112:115], v[68:71], a[240:243], v[112:115]
  ds_read_b64_tr_b16 v[32:33], v12 offset:0
  v_accvgpr_read_b32 v237, a153
  v_mfma_f32_16x16x32_bf16 v[128:131], v[72:75], a[240:243], v[128:131]
  ds_read_b64_tr_b16 v[34:35], v12 offset:1024
  v_accvgpr_read_b32 v238, a154
  v_mfma_f32_16x16x32_bf16 v[144:147], v[76:79], a[240:243], v[144:147]
  ds_read_b64_tr_b16 v[36:37], v13 offset:0
  v_accvgpr_read_b32 v239, a155
  v_mfma_f32_16x16x32_bf16 v[160:163], v[80:83], a[240:243], v[160:163]
  ds_read_b64_tr_b16 v[38:39], v13 offset:1024
  v_accvgpr_read_b32 v240, a184
  v_mfma_f32_16x16x32_bf16 v[176:179], v[84:87], a[240:243], v[176:179]
  ds_read_b64_tr_b16 v[40:41], v12 offset:256
  v_accvgpr_read_b32 v241, a185
  v_mfma_f32_16x16x32_bf16 v[192:195], v[88:91], a[240:243], v[192:195]
  ds_read_b64_tr_b16 v[42:43], v12 offset:1280
  v_accvgpr_read_b32 v242, a186
  v_mfma_f32_16x16x32_bf16 v[208:211], v[92:95], a[240:243], v[208:211]
  buffer_load_dwordx4 a[240:243], v2, s[40:43], s64 offen offset:3072 sc1
  v_accvgpr_read_b32 v243, a187
  v_mfma_f32_16x16x32_bf16 v[100:103], v[64:67], a[244:247], v[100:103]
  s_add_u32 s64, s64, 4096
  ds_read_b64_tr_b16 v[44:45], v13 offset:256
  v_cvt_pk_bf16_f32 v232, v236, v237
  v_mfma_f32_16x16x32_bf16 v[116:119], v[68:71], a[244:247], v[116:119]
  ds_read_b64_tr_b16 v[46:47], v13 offset:1280
  v_cvt_pk_bf16_f32 v233, v238, v239
  v_mfma_f32_16x16x32_bf16 v[132:135], v[72:75], a[244:247], v[132:135]
  s_add_u32 m0, s24, 16384
  ds_read_b64_tr_b16 v[48:49], v12 offset:512
  v_cvt_pk_bf16_f32 v234, v240, v241
  v_mfma_f32_16x16x32_bf16 v[148:151], v[76:79], a[244:247], v[148:151]
  buffer_load_dwordx4 v8, s[36:39], s27 offen offset:0 lds
  v_cvt_pk_bf16_f32 v235, v242, v243
  v_mfma_f32_16x16x32_bf16 v[164:167], v[80:83], a[244:247], v[164:167]
  ds_read_b64_tr_b16 v[50:51], v12 offset:1536
  v_mfma_f32_16x16x32_bf16 v[180:183], v[84:87], a[244:247], v[180:183]
  s_add_u32 s63, s63, s61
  ds_read_b64_tr_b16 v[52:53], v13 offset:512
  v_mfma_f32_16x16x32_bf16 v[196:199], v[88:91], a[244:247], v[196:199]
  ds_read_b64_tr_b16 v[54:55], v13 offset:1536
  v_mfma_f32_16x16x32_bf16 v[212:215], v[92:95], a[244:247], v[212:215]
  buffer_load_dwordx4 a[244:247], v2, s[40:43], s65 offen offset:3072 sc1
  v_mfma_f32_16x16x32_bf16 v[104:107], v[64:67], a[248:251], v[104:107]
  s_add_u32 s65, s65, 4096
  ds_read_b64_tr_b16 v[56:57], v12 offset:768
  v_accvgpr_read_b32 v248, a156
  v_mfma_f32_16x16x32_bf16 v[120:123], v[68:71], a[248:251], v[120:123]
  ds_read_b64_tr_b16 v[58:59], v12 offset:1792
  v_accvgpr_read_b32 v249, a157
  v_mfma_f32_16x16x32_bf16 v[136:139], v[72:75], a[248:251], v[136:139]
  ds_read_b64_tr_b16 v[60:61], v13 offset:768
  v_accvgpr_read_b32 v250, a158
  v_mfma_f32_16x16x32_bf16 v[152:155], v[76:79], a[248:251], v[152:155]
  buffer_load_dwordx4 v9, s[36:39], s27 offen offset:1024 lds
  v_accvgpr_read_b32 v251, a159
  v_mfma_f32_16x16x32_bf16 v[168:171], v[80:83], a[248:251], v[168:171]
  ds_read_b64_tr_b16 v[62:63], v13 offset:1792
  v_accvgpr_read_b32 v252, a188
  v_mfma_f32_16x16x32_bf16 v[184:187], v[84:87], a[248:251], v[184:187]
  buffer_store_dwordx4 v[232:235], v2, s[40:43], s63 offen offset:0 sc1
  v_accvgpr_read_b32 v253, a189
  v_mfma_f32_16x16x32_bf16 v[200:203], v[88:91], a[248:251], v[200:203]
  buffer_load_dwordx4 v10, s[36:39], s27 offen offset:2048 lds
  v_accvgpr_read_b32 v254, a190
  v_mfma_f32_16x16x32_bf16 v[216:219], v[92:95], a[248:251], v[216:219]
  buffer_load_dwordx4 a[248:251], v2, s[40:43], s66 offen offset:3072 sc1
  v_accvgpr_read_b32 v255, a191
  v_mfma_f32_16x16x32_bf16 v[108:111], v[64:67], a[252:255], v[108:111]
  s_add_u32 s66, s66, 4096
  v_cvt_pk_bf16_f32 v244, v248, v249
  v_mfma_f32_16x16x32_bf16 v[124:127], v[68:71], a[252:255], v[124:127]
  buffer_load_dwordx4 v11, s[36:39], s27 offen offset:3072 lds
  v_cvt_pk_bf16_f32 v245, v250, v251
  v_mfma_f32_16x16x32_bf16 v[140:143], v[72:75], a[252:255], v[140:143]
  s_add_u32 s27, s27, 524288
  v_cvt_pk_bf16_f32 v246, v252, v253
  v_mfma_f32_16x16x32_bf16 v[156:159], v[76:79], a[252:255], v[156:159]
  s_add_u32 s24, s24, 32768
  v_cvt_pk_bf16_f32 v247, v254, v255
  v_mfma_f32_16x16x32_bf16 v[172:175], v[80:83], a[252:255], v[172:175]
  s_and_b32 s24, s24, 0x1ffff
  v_mfma_f32_16x16x32_bf16 v[188:191], v[84:87], a[252:255], v[188:191]
  buffer_store_dwordx4 v[244:247], v2, s[40:43], s63 offen offset:1024 sc1
  v_mfma_f32_16x16x32_bf16 v[204:207], v[88:91], a[252:255], v[204:207]
  v_mfma_f32_16x16x32_bf16 v[220:223], v[92:95], a[252:255], v[220:223]
  s_waitcnt vmcnt(25) lgkmcnt(0)
  buffer_load_dwordx4 a[252:255], v2, s[40:43], s67 offen offset:3072 sc1
  v_mfma_f32_16x16x32_bf16 v[96:99], v[32:35], a[192:195], v[96:99]
  v_and_b32 v16, 15, v1
  v_mfma_f32_16x16x32_bf16 v[112:115], v[36:39], a[192:195], v[112:115]
  s_add_u32 s67, s67, 4096
  ds_read_b64_tr_b16 v[64:65], v12 offset:8192
  v_lshrrev_b32 v17, 4, v1
  v_mfma_f32_16x16x32_bf16 v[128:131], v[40:43], a[192:195], v[128:131]
  ds_read_b64_tr_b16 v[66:67], v12 offset:9216
  v_lshlrev_b32 v17, 2, v17
  v_mfma_f32_16x16x32_bf16 v[144:147], v[44:47], a[192:195], v[144:147]
  ds_read_b64_tr_b16 v[68:69], v13 offset:8192
  v_sub_u32 v16, v16, v17
  v_mfma_f32_16x16x32_bf16 v[160:163], v[48:51], a[192:195], v[160:163]
  ds_read_b64_tr_b16 v[70:71], v13 offset:9216
  v_cmp_le_i32 s[68:69], 0, v16
  v_mfma_f32_16x16x32_bf16 v[176:179], v[52:55], a[192:195], v[176:179]
  ds_read_b64_tr_b16 v[72:73], v12 offset:8448
  v_cmp_le_i32 s[70:71], 1, v16
  v_mfma_f32_16x16x32_bf16 v[192:195], v[56:59], a[192:195], v[192:195]
  ds_read_b64_tr_b16 v[74:75], v12 offset:9472
  v_cmp_le_i32 s[72:73], 2, v16
  v_mfma_f32_16x16x32_bf16 v[208:211], v[60:63], a[192:195], v[208:211]
  buffer_load_dwordx4 a[192:195], v2, s[40:43], s64 offen offset:0 sc1
  v_mfma_f32_16x16x32_bf16 v[100:103], v[32:35], a[196:199], v[100:103]
  ds_read_b64_tr_b16 v[76:77], v13 offset:8448
  v_mfma_f32_16x16x32_bf16 v[116:119], v[36:39], a[196:199], v[116:119]
  ds_read_b64_tr_b16 v[78:79], v13 offset:9472
  v_mfma_f32_16x16x32_bf16 v[132:135], v[40:43], a[196:199], v[132:135]
  ds_read_b64_tr_b16 v[80:81], v12 offset:8704
  v_mfma_f32_16x16x32_bf16 v[148:151], v[44:47], a[196:199], v[148:151]
  v_cmp_le_i32 s[74:75], 3, v16
  v_mfma_f32_16x16x32_bf16 v[164:167], v[48:51], a[196:199], v[164:167]
  ds_read_b64_tr_b16 v[82:83], v12 offset:9728
  v_mfma_f32_16x16x32_bf16 v[180:183], v[52:55], a[196:199], v[180:183]
  ds_read_b64_tr_b16 v[84:85], v13 offset:8704
  v_mfma_f32_16x16x32_bf16 v[196:199], v[56:59], a[196:199], v[196:199]
  ds_read_b64_tr_b16 v[86:87], v13 offset:9728
  v_mfma_f32_16x16x32_bf16 v[212:215], v[60:63], a[196:199], v[212:215]
  buffer_load_dwordx4 a[196:199], v2, s[40:43], s65 offen offset:0 sc1
  v_mfma_f32_16x16x32_bf16 v[104:107], v[32:35], a[200:203], v[104:107]
  ds_read_b64_tr_b16 v[88:89], v12 offset:8960
  v_mfma_f32_16x16x32_bf16 v[120:123], v[36:39], a[200:203], v[120:123]
  ds_read_b64_tr_b16 v[90:91], v12 offset:9984
  v_mfma_f32_16x16x32_bf16 v[136:139], v[40:43], a[200:203], v[136:139]
  ds_read_b64_tr_b16 v[92:93], v13 offset:8960
  v_mfma_f32_16x16x32_bf16 v[152:155], v[44:47], a[200:203], v[152:155]
  v_mov_b32 v4, 0xff800000
  v_mfma_f32_16x16x32_bf16 v[168:171], v[48:51], a[200:203], v[168:171]
  ds_read_b64_tr_b16 v[94:95], v13 offset:9984
  v_mfma_f32_16x16x32_bf16 v[184:187], v[52:55], a[200:203], v[184:187]
  v_and_b32 v230, 7, v1
  v_mfma_f32_16x16x32_bf16 v[200:203], v[56:59], a[200:203], v[200:203]
  v_lshlrev_b32 v230, 2, v230
  v_mfma_f32_16x16x32_bf16 v[216:219], v[60:63], a[200:203], v[216:219]
  buffer_load_dwordx4 a[200:203], v2, s[40:43], s66 offen offset:0 sc1
  v_mfma_f32_16x16x32_bf16 v[108:111], v[32:35], a[204:207], v[108:111]
  v_add_u32 v230, s30, v230
  v_mfma_f32_16x16x32_bf16 v[124:127], v[36:39], a[204:207], v[124:127]
  v_mov_b32 v18, 1073741824
  v_mfma_f32_16x16x32_bf16 v[140:143], v[40:43], a[204:207], v[140:143]
  v_mov_b32 v19, 1
  v_mfma_f32_16x16x32_bf16 v[156:159], v[44:47], a[204:207], v[156:159]
  v_writelane_b32 v18, s29, 0
  v_mfma_f32_16x16x32_bf16 v[172:175], v[48:51], a[204:207], v[172:175]
  v_accvgpr_write_b32 a0, 0
  v_mfma_f32_16x16x32_bf16 v[188:191], v[52:55], a[204:207], v[188:191]
  v_accvgpr_write_b32 a1, 0
  v_mfma_f32_16x16x32_bf16 v[204:207], v[56:59], a[204:207], v[204:207]
  v_accvgpr_write_b32 a2, 0
  v_mfma_f32_16x16x32_bf16 v[220:223], v[60:63], a[204:207], v[220:223]
  s_waitcnt vmcnt(19) lgkmcnt(0)
  buffer_load_dwordx4 a[204:207], v2, s[40:43], s67 offen offset:0 sc1
  v_mfma_f32_16x16x32_bf16 v[96:99], v[64:67], a[208:211], v[96:99]
  s_barrier
  v_accvgpr_write_b32 a3, 0
  v_mfma_f32_16x16x32_bf16 v[112:115], v[68:71], a[208:211], v[112:115]
  ds_read_b64_tr_b16 v[32:33], v12 offset:32768
  v_accvgpr_write_b32 a4, 0
  v_mfma_f32_16x16x32_bf16 v[128:131], v[72:75], a[208:211], v[128:131]
  ds_read_b64_tr_b16 v[34:35], v12 offset:33792
  v_accvgpr_write_b32 a5, 0
  v_mfma_f32_16x16x32_bf16 v[144:147], v[76:79], a[208:211], v[144:147]
  ds_read_b64_tr_b16 v[36:37], v13 offset:32768
  v_accvgpr_write_b32 a6, 0
  v_mfma_f32_16x16x32_bf16 v[160:163], v[80:83], a[208:211], v[160:163]
  ds_read_b64_tr_b16 v[38:39], v13 offset:33792
  v_accvgpr_write_b32 a7, 0
  v_mfma_f32_16x16x32_bf16 v[176:179], v[84:87], a[208:211], v[176:179]
  ds_read_b64_tr_b16 v[40:41], v12 offset:33024
  v_accvgpr_write_b32 a8, 0
  v_mfma_f32_16x16x32_bf16 v[192:195], v[88:91], a[208:211], v[192:195]
  ds_read_b64_tr_b16 v[42:43], v12 offset:34048
  v_accvgpr_write_b32 a9, 0
  v_mfma_f32_16x16x32_bf16 v[208:211], v[92:95], a[208:211], v[208:211]
  buffer_load_dwordx4 a[208:211], v2, s[40:43], s64 offen offset:1024 sc1
  v_mfma_f32_16x16x32_bf16 v[100:103], v[64:67], a[212:215], v[100:103]
  ds_read_b64_tr_b16 v[44:45], v13 offset:33024
  v_mfma_f32_16x16x32_bf16 v[116:119], v[68:71], a[212:215], v[116:119]
  ds_read_b64_tr_b16 v[46:47], v13 offset:34048
  v_mfma_f32_16x16x32_bf16 v[132:135], v[72:75], a[212:215], v[132:135]
  ds_read_b64_tr_b16 v[48:49], v12 offset:33280
  v_mfma_f32_16x16x32_bf16 v[148:151], v[76:79], a[212:215], v[148:151]
  v_accvgpr_write_b32 a10, 0
  v_mfma_f32_16x16x32_bf16 v[164:167], v[80:83], a[212:215], v[164:167]
  ds_read_b64_tr_b16 v[50:51], v12 offset:34304
  v_mfma_f32_16x16x32_bf16 v[180:183], v[84:87], a[212:215], v[180:183]
  ds_read_b64_tr_b16 v[52:53], v13 offset:33280
  v_mfma_f32_16x16x32_bf16 v[196:199], v[88:91], a[212:215], v[196:199]
  ds_read_b64_tr_b16 v[54:55], v13 offset:34304
  v_mfma_f32_16x16x32_bf16 v[212:215], v[92:95], a[212:215], v[212:215]
  buffer_load_dwordx4 a[212:215], v2, s[40:43], s65 offen offset:1024 sc1
  v_mfma_f32_16x16x32_bf16 v[104:107], v[64:67], a[216:219], v[104:107]
  ds_read_b64_tr_b16 v[56:57], v12 offset:33536
  v_mfma_f32_16x16x32_bf16 v[120:123], v[68:71], a[216:219], v[120:123]
  ds_read_b64_tr_b16 v[58:59], v12 offset:34560
  v_mfma_f32_16x16x32_bf16 v[136:139], v[72:75], a[216:219], v[136:139]
  ds_read_b64_tr_b16 v[60:61], v13 offset:33536
  v_mfma_f32_16x16x32_bf16 v[152:155], v[76:79], a[216:219], v[152:155]
  v_accvgpr_write_b32 a11, 0
  v_mfma_f32_16x16x32_bf16 v[168:171], v[80:83], a[216:219], v[168:171]
  ds_read_b64_tr_b16 v[62:63], v13 offset:34560
  v_mfma_f32_16x16x32_bf16 v[184:187], v[84:87], a[216:219], v[184:187]
  v_accvgpr_write_b32 a12, 0
  v_mfma_f32_16x16x32_bf16 v[200:203], v[88:91], a[216:219], v[200:203]
  v_accvgpr_write_b32 a13, 0
  v_mfma_f32_16x16x32_bf16 v[216:219], v[92:95], a[216:219], v[216:219]
  buffer_load_dwordx4 a[216:219], v2, s[40:43], s66 offen offset:1024 sc1
  v_mfma_f32_16x16x32_bf16 v[108:111], v[64:67], a[220:223], v[108:111]
  v_accvgpr_write_b32 a14, 0
  v_mfma_f32_16x16x32_bf16 v[124:127], v[68:71], a[220:223], v[124:127]
  v_accvgpr_write_b32 a15, 0
  v_mfma_f32_16x16x32_bf16 v[140:143], v[72:75], a[220:223], v[140:143]
  v_accvgpr_write_b32 a16, 0
  v_mfma_f32_16x16x32_bf16 v[156:159], v[76:79], a[220:223], v[156:159]
  v_accvgpr_write_b32 a17, 0
  v_mfma_f32_16x16x32_bf16 v[172:175], v[80:83], a[220:223], v[172:175]
  v_accvgpr_write_b32 a18, 0
  v_mfma_f32_16x16x32_bf16 v[188:191], v[84:87], a[220:223], v[188:191]
  v_accvgpr_write_b32 a19, 0
  v_mfma_f32_16x16x32_bf16 v[204:207], v[88:91], a[220:223], v[204:207]
  v_accvgpr_write_b32 a20, 0
  v_mfma_f32_16x16x32_bf16 v[220:223], v[92:95], a[220:223], v[220:223]
  s_waitcnt vmcnt(17) lgkmcnt(0)
  buffer_load_dwordx4 a[220:223], v2, s[40:43], s67 offen offset:1024 sc1
  v_mfma_f32_16x16x32_bf16 v[96:99], v[32:35], a[224:227], v[96:99]
  v_accvgpr_write_b32 a21, 0
  v_mfma_f32_16x16x32_bf16 v[112:115], v[36:39], a[224:227], v[112:115]
  ds_read_b64_tr_b16 v[64:65], v12 offset:40960
  v_accvgpr_write_b32 a22, 0
  v_mfma_f32_16x16x32_bf16 v[128:131], v[40:43], a[224:227], v[128:131]
  ds_read_b64_tr_b16 v[66:67], v12 offset:41984
  v_accvgpr_write_b32 a23, 0
  v_mfma_f32_16x16x32_bf16 v[144:147], v[44:47], a[224:227], v[144:147]
  ds_read_b64_tr_b16 v[68:69], v13 offset:40960
  v_accvgpr_write_b32 a24, 0
  v_mfma_f32_16x16x32_bf16 v[160:163], v[48:51], a[224:227], v[160:163]
  ds_read_b64_tr_b16 v[70:71], v13 offset:41984
  v_accvgpr_write_b32 a25, 0
  v_mfma_f32_16x16x32_bf16 v[176:179], v[52:55], a[224:227], v[176:179]
  ds_read_b64_tr_b16 v[72:73], v12 offset:41216
  v_accvgpr_write_b32 a26, 0
  v_mfma_f32_16x16x32_bf16 v[192:195], v[56:59], a[224:227], v[192:195]
  ds_read_b64_tr_b16 v[74:75], v12 offset:42240
  v_accvgpr_write_b32 a27, 0
  v_mfma_f32_16x16x32_bf16 v[208:211], v[60:63], a[224:227], v[208:211]
  buffer_load_dwordx4 a[224:227], v2, s[40:43], s64 offen offset:2048 sc1
  v_accvgpr_write_b32 a28, 0
  v_mfma_f32_16x16x32_bf16 v[100:103], v[32:35], a[228:231], v[100:103]
  ds_read_b64_tr_b16 v[76:77], v13 offset:41216
  v_accvgpr_write_b32 a29, 0
  v_mfma_f32_16x16x32_bf16 v[116:119], v[36:39], a[228:231], v[116:119]
  ds_read_b64_tr_b16 v[78:79], v13 offset:42240
  v_mfma_f32_16x16x32_bf16 v[132:135], v[40:43], a[228:231], v[132:135]
  ds_read_b64_tr_b16 v[80:81], v12 offset:41472
  v_mfma_f32_16x16x32_bf16 v[148:151], v[44:47], a[228:231], v[148:151]
  v_accvgpr_write_b32 a30, 0
  v_mfma_f32_16x16x32_bf16 v[164:167], v[48:51], a[228:231], v[164:167]
  ds_read_b64_tr_b16 v[82:83], v12 offset:42496
  v_mfma_f32_16x16x32_bf16 v[180:183], v[52:55], a[228:231], v[180:183]
  ds_read_b64_tr_b16 v[84:85], v13 offset:41472
  v_mfma_f32_16x16x32_bf16 v[196:199], v[56:59], a[228:231], v[196:199]
  ds_read_b64_tr_b16 v[86:87], v13 offset:42496
  v_mfma_f32_16x16x32_bf16 v[212:215], v[60:63], a[228:231], v[212:215]
  buffer_load_dwordx4 a[228:231], v2, s[40:43], s65 offen offset:2048 sc1
  v_mfma_f32_16x16x32_bf16 v[104:107], v[32:35], a[232:235], v[104:107]
  ds_read_b64_tr_b16 v[88:89], v12 offset:41728
  v_mfma_f32_16x16x32_bf16 v[120:123], v[36:39], a[232:235], v[120:123]
  ds_read_b64_tr_b16 v[90:91], v12 offset:42752
  v_mfma_f32_16x16x32_bf16 v[136:139], v[40:43], a[232:235], v[136:139]
  ds_read_b64_tr_b16 v[92:93], v13 offset:41728
  v_mfma_f32_16x16x32_bf16 v[152:155], v[44:47], a[232:235], v[152:155]
  v_accvgpr_write_b32 a31, 0
  v_mfma_f32_16x16x32_bf16 v[168:171], v[48:51], a[232:235], v[168:171]
  ds_read_b64_tr_b16 v[94:95], v13 offset:42752
  v_mfma_f32_16x16x32_bf16 v[184:187], v[52:55], a[232:235], v[184:187]
  v_accvgpr_write_b32 a32, 0
  v_mfma_f32_16x16x32_bf16 v[200:203], v[56:59], a[232:235], v[200:203]
  v_accvgpr_write_b32 a33, 0
  v_mfma_f32_16x16x32_bf16 v[216:219], v[60:63], a[232:235], v[216:219]
  buffer_load_dwordx4 a[232:235], v2, s[40:43], s66 offen offset:2048 sc1
  v_mfma_f32_16x16x32_bf16 v[108:111], v[32:35], a[236:239], v[108:111]
  v_xor_b32 v12, 0x10000, v12
  v_mfma_f32_16x16x32_bf16 v[124:127], v[36:39], a[236:239], v[124:127]
  v_accvgpr_write_b32 a34, 0
  v_mfma_f32_16x16x32_bf16 v[140:143], v[40:43], a[236:239], v[140:143]
  v_xor_b32 v13, 0x10000, v13
  v_mfma_f32_16x16x32_bf16 v[156:159], v[44:47], a[236:239], v[156:159]
  v_accvgpr_write_b32 a35, 0
  v_mfma_f32_16x16x32_bf16 v[172:175], v[48:51], a[236:239], v[172:175]
  v_accvgpr_write_b32 a36, 0
  v_mfma_f32_16x16x32_bf16 v[188:191], v[52:55], a[236:239], v[188:191]
  v_accvgpr_write_b32 a37, 0
  v_mfma_f32_16x16x32_bf16 v[204:207], v[56:59], a[236:239], v[204:207]
  v_accvgpr_write_b32 a38, 0
  v_mfma_f32_16x16x32_bf16 v[220:223], v[60:63], a[236:239], v[220:223]
  s_waitcnt vmcnt(11) lgkmcnt(0)
  buffer_load_dwordx4 a[236:239], v2, s[40:43], s67 offen offset:2048 sc1
  v_mfma_f32_16x16x32_bf16 v[96:99], v[64:67], a[240:243], v[96:99]
  s_barrier
  v_accvgpr_write_b32 a39, 0
  v_mfma_f32_16x16x32_bf16 v[112:115], v[68:71], a[240:243], v[112:115]
  ds_read_b64_tr_b16 v[32:33], v12 offset:0
  v_accvgpr_write_b32 a40, 0
  v_mfma_f32_16x16x32_bf16 v[128:131], v[72:75], a[240:243], v[128:131]
  ds_read_b64_tr_b16 v[34:35], v12 offset:1024
  v_accvgpr_write_b32 a41, 0
  v_mfma_f32_16x16x32_bf16 v[144:147], v[76:79], a[240:243], v[144:147]
  ds_read_b64_tr_b16 v[36:37], v13 offset:0
  v_accvgpr_write_b32 a42, 0
  v_mfma_f32_16x16x32_bf16 v[160:163], v[80:83], a[240:243], v[160:163]
  ds_read_b64_tr_b16 v[38:39], v13 offset:1024
  v_accvgpr_write_b32 a43, 0
  v_mfma_f32_16x16x32_bf16 v[176:179], v[84:87], a[240:243], v[176:179]
  ds_read_b64_tr_b16 v[40:41], v12 offset:256
  v_accvgpr_write_b32 a44, 0
  v_mfma_f32_16x16x32_bf16 v[192:195], v[88:91], a[240:243], v[192:195]
  ds_read_b64_tr_b16 v[42:43], v12 offset:1280
  v_accvgpr_write_b32 a45, 0
  v_mfma_f32_16x16x32_bf16 v[208:211], v[92:95], a[240:243], v[208:211]
  buffer_load_dwordx4 a[240:243], v2, s[40:43], s64 offen offset:3072 sc1
  v_mfma_f32_16x16x32_bf16 v[100:103], v[64:67], a[244:247], v[100:103]
  s_add_u32 s64, s64, 4096
  ds_read_b64_tr_b16 v[44:45], v13 offset:256
  v_mfma_f32_16x16x32_bf16 v[116:119], v[68:71], a[244:247], v[116:119]
  ds_read_b64_tr_b16 v[46:47], v13 offset:1280
  v_mfma_f32_16x16x32_bf16 v[132:135], v[72:75], a[244:247], v[132:135]
  ds_read_b64_tr_b16 v[48:49], v12 offset:512
  v_mfma_f32_16x16x32_bf16 v[148:151], v[76:79], a[244:247], v[148:151]
  buffer_store_dword v19, v18, s[40:43], 0 offen sc1
  v_accvgpr_write_b32 a46, 0
  v_mfma_f32_16x16x32_bf16 v[164:167], v[80:83], a[244:247], v[164:167]
  ds_read_b64_tr_b16 v[50:51], v12 offset:1536
  v_mfma_f32_16x16x32_bf16 v[180:183], v[84:87], a[244:247], v[180:183]
  ds_read_b64_tr_b16 v[52:53], v13 offset:512
  v_mfma_f32_16x16x32_bf16 v[196:199], v[88:91], a[244:247], v[196:199]
  ds_read_b64_tr_b16 v[54:55], v13 offset:1536
  v_mfma_f32_16x16x32_bf16 v[212:215], v[92:95], a[244:247], v[212:215]
  buffer_load_dwordx4 a[244:247], v2, s[40:43], s65 offen offset:3072 sc1
  v_mfma_f32_16x16x32_bf16 v[104:107], v[64:67], a[248:251], v[104:107]
  s_add_u32 s65, s65, 4096
  ds_read_b64_tr_b16 v[56:57], v12 offset:768
  v_mfma_f32_16x16x32_bf16 v[120:123], v[68:71], a[248:251], v[120:123]
  ds_read_b64_tr_b16 v[58:59], v12 offset:1792
  v_mfma_f32_16x16x32_bf16 v[136:139], v[72:75], a[248:251], v[136:139]
  ds_read_b64_tr_b16 v[60:61], v13 offset:768
  v_mfma_f32_16x16x32_bf16 v[152:155], v[76:79], a[248:251], v[152:155]
  v_accvgpr_write_b32 a47, 0
  v_mfma_f32_16x16x32_bf16 v[168:171], v[80:83], a[248:251], v[168:171]
  ds_read_b64_tr_b16 v[62:63], v13 offset:1792
  v_mfma_f32_16x16x32_bf16 v[184:187], v[84:87], a[248:251], v[184:187]
  v_accvgpr_write_b32 a48, 0
  v_mfma_f32_16x16x32_bf16 v[200:203], v[88:91], a[248:251], v[200:203]
  v_accvgpr_write_b32 a49, 0
  v_mfma_f32_16x16x32_bf16 v[216:219], v[92:95], a[248:251], v[216:219]
  buffer_load_dwordx4 a[248:251], v2, s[40:43], s66 offen offset:3072 sc1
  v_mfma_f32_16x16x32_bf16 v[108:111], v[64:67], a[252:255], v[108:111]
  s_add_u32 s66, s66, 4096
  v_accvgpr_write_b32 a50, 0
  v_mfma_f32_16x16x32_bf16 v[124:127], v[68:71], a[252:255], v[124:127]
  v_accvgpr_write_b32 a51, 0
  v_mfma_f32_16x16x32_bf16 v[140:143], v[72:75], a[252:255], v[140:143]
  v_accvgpr_write_b32 a52, 0
  v_mfma_f32_16x16x32_bf16 v[156:159], v[76:79], a[252:255], v[156:159]
  v_accvgpr_write_b32 a53, 0
  v_mfma_f32_16x16x32_bf16 v[172:175], v[80:83], a[252:255], v[172:175]
  v_accvgpr_write_b32 a54, 0
  v_mfma_f32_16x16x32_bf16 v[188:191], v[84:87], a[252:255], v[188:191]
  v_accvgpr_write_b32 a55, 0
  v_mfma_f32_16x16x32_bf16 v[204:207], v[88:91], a[252:255], v[204:207]
  v_accvgpr_write_b32 a56, 0
  v_mfma_f32_16x16x32_bf16 v[220:223], v[92:95], a[252:255], v[220:223]
  s_waitcnt vmcnt(12) lgkmcnt(0)
  buffer_load_dwordx4 a[252:255], v2, s[40:43], s67 offen offset:3072 sc1
  v_mfma_f32_16x16x32_bf16 v[96:99], v[32:35], a[192:195], v[96:99]
  v_accvgpr_write_b32 a57, 0
  v_mfma_f32_16x16x32_bf16 v[112:115], v[36:39], a[192:195], v[112:115]
  s_add_u32 s67, s67, 4096
  ds_read_b64_tr_b16 v[64:65], v12 offset:8192
  v_accvgpr_write_b32 a58, 0
  v_mfma_f32_16x16x32_bf16 v[128:131], v[40:43], a[192:195], v[128:131]
  ds_read_b64_tr_b16 v[66:67], v12 offset:9216
  v_accvgpr_write_b32 a59, 0
  v_mfma_f32_16x16x32_bf16 v[144:147], v[44:47], a[192:195], v[144:147]
  ds_read_b64_tr_b16 v[68:69], v13 offset:8192
  v_accvgpr_write_b32 a60, 0
  v_mfma_f32_16x16x32_bf16 v[160:163], v[48:51], a[192:195], v[160:163]
  ds_read_b64_tr_b16 v[70:71], v13 offset:9216
  v_mfma_f32_16x16x32_bf16 v[176:179], v[52:55], a[192:195], v[176:179]
  ds_read_b64_tr_b16 v[72:73], v12 offset:8448
  v_mfma_f32_16x16x32_bf16 v[192:195], v[56:59], a[192:195], v[192:195]
  ds_read_b64_tr_b16 v[74:75], v12 offset:9472
  v_mfma_f32_16x16x32_bf16 v[208:211], v[60:63], a[192:195], v[208:211]
  v_accvgpr_write_b32 a61, 0
  v_mfma_f32_16x16x32_bf16 v[100:103], v[32:35], a[196:199], v[100:103]
  ds_read_b64_tr_b16 v[76:77], v13 offset:8448
  v_mfma_f32_16x16x32_bf16 v[116:119], v[36:39], a[196:199], v[116:119]
  ds_read_b64_tr_b16 v[78:79], v13 offset:9472
  v_mfma_f32_16x16x32_bf16 v[132:135], v[40:43], a[196:199], v[132:135]
  ds_read_b64_tr_b16 v[80:81], v12 offset:8704
  v_mfma_f32_16x16x32_bf16 v[148:151], v[44:47], a[196:199], v[148:151]
  v_accvgpr_write_b32 a62, 0
  v_mfma_f32_16x16x32_bf16 v[164:167], v[48:51], a[196:199], v[164:167]
  ds_read_b64_tr_b16 v[82:83], v12 offset:9728
  v_mfma_f32_16x16x32_bf16 v[180:183], v[52:55], a[196:199], v[180:183]
  ds_read_b64_tr_b16 v[84:85], v13 offset:8704
  v_mfma_f32_16x16x32_bf16 v[196:199], v[56:59], a[196:199], v[196:199]
  ds_read_b64_tr_b16 v[86:87], v13 offset:9728
  v_mfma_f32_16x16x32_bf16 v[212:215], v[60:63], a[196:199], v[212:215]
  v_accvgpr_write_b32 a63, 0
  v_mfma_f32_16x16x32_bf16 v[104:107], v[32:35], a[200:203], v[104:107]
  ds_read_b64_tr_b16 v[88:89], v12 offset:8960
  v_mfma_f32_16x16x32_bf16 v[120:123], v[36:39], a[200:203], v[120:123]
  ds_read_b64_tr_b16 v[90:91], v12 offset:9984
  v_mfma_f32_16x16x32_bf16 v[136:139], v[40:43], a[200:203], v[136:139]
  ds_read_b64_tr_b16 v[92:93], v13 offset:8960
  v_mfma_f32_16x16x32_bf16 v[152:155], v[44:47], a[200:203], v[152:155]
  v_accvgpr_write_b32 a64, 0
  v_mfma_f32_16x16x32_bf16 v[168:171], v[48:51], a[200:203], v[168:171]
  ds_read_b64_tr_b16 v[94:95], v13 offset:9984
  v_mfma_f32_16x16x32_bf16 v[184:187], v[52:55], a[200:203], v[184:187]
  v_accvgpr_write_b32 a65, 0
  v_mfma_f32_16x16x32_bf16 v[200:203], v[56:59], a[200:203], v[200:203]
  v_accvgpr_write_b32 a66, 0
  v_mfma_f32_16x16x32_bf16 v[216:219], v[60:63], a[200:203], v[216:219]
  v_accvgpr_write_b32 a67, 0
  v_mfma_f32_16x16x32_bf16 v[108:111], v[32:35], a[204:207], v[108:111]
  v_accvgpr_write_b32 a68, 0
  v_mfma_f32_16x16x32_bf16 v[124:127], v[36:39], a[204:207], v[124:127]
  v_accvgpr_write_b32 a69, 0
  v_mfma_f32_16x16x32_bf16 v[140:143], v[40:43], a[204:207], v[140:143]
  v_accvgpr_write_b32 a70, 0
  v_mfma_f32_16x16x32_bf16 v[156:159], v[44:47], a[204:207], v[156:159]
  v_accvgpr_write_b32 a71, 0
  v_mfma_f32_16x16x32_bf16 v[172:175], v[48:51], a[204:207], v[172:175]
  v_accvgpr_write_b32 a72, 0
  v_mfma_f32_16x16x32_bf16 v[188:191], v[52:55], a[204:207], v[188:191]
  v_accvgpr_write_b32 a73, 0
  v_mfma_f32_16x16x32_bf16 v[204:207], v[56:59], a[204:207], v[204:207]
  v_accvgpr_write_b32 a74, 0
  v_mfma_f32_16x16x32_bf16 v[220:223], v[60:63], a[204:207], v[220:223]
  s_waitcnt vmcnt(9) lgkmcnt(0)
  v_mfma_f32_16x16x32_bf16 v[96:99], v[64:67], a[208:211], v[96:99]
  s_barrier
  v_accvgpr_write_b32 a75, 0
  v_mfma_f32_16x16x32_bf16 v[112:115], v[68:71], a[208:211], v[112:115]
  ds_read_b64_tr_b16 v[32:33], v12 offset:32768
  v_accvgpr_write_b32 a76, 0
  v_mfma_f32_16x16x32_bf16 v[128:131], v[72:75], a[208:211], v[128:131]
  ds_read_b64_tr_b16 v[34:35], v12 offset:33792
  v_accvgpr_write_b32 a77, 0
  v_mfma_f32_16x16x32_bf16 v[144:147], v[76:79], a[208:211], v[144:147]
  ds_read_b64_tr_b16 v[36:37], v13 offset:32768
  v_accvgpr_write_b32 a78, 0
  v_mfma_f32_16x16x32_bf16 v[160:163], v[80:83], a[208:211], v[160:163]
  ds_read_b64_tr_b16 v[38:39], v13 offset:33792
  v_mfma_f32_16x16x32_bf16 v[176:179], v[84:87], a[208:211], v[176:179]
  ds_read_b64_tr_b16 v[40:41], v12 offset:33024
  v_mfma_f32_16x16x32_bf16 v[192:195], v[88:91], a[208:211], v[192:195]
  ds_read_b64_tr_b16 v[42:43], v12 offset:34048
  v_mfma_f32_16x16x32_bf16 v[208:211], v[92:95], a[208:211], v[208:211]
  v_accvgpr_write_b32 a79, 0
  v_mfma_f32_16x16x32_bf16 v[100:103], v[64:67], a[212:215], v[100:103]
  ds_read_b64_tr_b16 v[44:45], v13 offset:33024
  v_mfma_f32_16x16x32_bf16 v[116:119], v[68:71], a[212:215], v[116:119]
  ds_read_b64_tr_b16 v[46:47], v13 offset:34048
  v_mfma_f32_16x16x32_bf16 v[132:135], v[72:75], a[212:215], v[132:135]
  ds_read_b64_tr_b16 v[48:49], v12 offset:33280
  v_mfma_f32_16x16x32_bf16 v[148:151], v[76:79], a[212:215], v[148:151]
  v_accvgpr_write_b32 a80, 0
  v_mfma_f32_16x16x32_bf16 v[164:167], v[80:83], a[212:215], v[164:167]
  ds_read_b64_tr_b16 v[50:51], v12 offset:34304
  v_mfma_f32_16x16x32_bf16 v[180:183], v[84:87], a[212:215], v[180:183]
  ds_read_b64_tr_b16 v[52:53], v13 offset:33280
  v_mfma_f32_16x16x32_bf16 v[196:199], v[88:91], a[212:215], v[196:199]
  ds_read_b64_tr_b16 v[54:55], v13 offset:34304
  v_mfma_f32_16x16x32_bf16 v[212:215], v[92:95], a[212:215], v[212:215]
  v_accvgpr_write_b32 a81, 0
  v_mfma_f32_16x16x32_bf16 v[104:107], v[64:67], a[216:219], v[104:107]
  ds_read_b64_tr_b16 v[56:57], v12 offset:33536
  v_mfma_f32_16x16x32_bf16 v[120:123], v[68:71], a[216:219], v[120:123]
  ds_read_b64_tr_b16 v[58:59], v12 offset:34560
  v_mfma_f32_16x16x32_bf16 v[136:139], v[72:75], a[216:219], v[136:139]
  ds_read_b64_tr_b16 v[60:61], v13 offset:33536
  v_mfma_f32_16x16x32_bf16 v[152:155], v[76:79], a[216:219], v[152:155]
  v_accvgpr_write_b32 a82, 0
  v_mfma_f32_16x16x32_bf16 v[168:171], v[80:83], a[216:219], v[168:171]
  ds_read_b64_tr_b16 v[62:63], v13 offset:34560
  v_mfma_f32_16x16x32_bf16 v[184:187], v[84:87], a[216:219], v[184:187]
  buffer_load_dword v228, v230, s[40:43], 0 offen sc1
  v_accvgpr_write_b32 a83, 0
  v_mfma_f32_16x16x32_bf16 v[200:203], v[88:91], a[216:219], v[200:203]
  v_accvgpr_write_b32 a84, 0
  v_mfma_f32_16x16x32_bf16 v[216:219], v[92:95], a[216:219], v[216:219]
  v_accvgpr_write_b32 a85, 0
  v_mfma_f32_16x16x32_bf16 v[108:111], v[64:67], a[220:223], v[108:111]
  v_accvgpr_write_b32 a86, 0
  v_mfma_f32_16x16x32_bf16 v[124:127], v[68:71], a[220:223], v[124:127]
  v_accvgpr_write_b32 a87, 0
  v_mfma_f32_16x16x32_bf16 v[140:143], v[72:75], a[220:223], v[140:143]
  v_accvgpr_write_b32 a88, 0
  v_mfma_f32_16x16x32_bf16 v[156:159], v[76:79], a[220:223], v[156:159]
  v_accvgpr_write_b32 a89, 0
  v_mfma_f32_16x16x32_bf16 v[172:175], v[80:83], a[220:223], v[172:175]
  v_accvgpr_write_b32 a90, 0
  v_mfma_f32_16x16x32_bf16 v[188:191], v[84:87], a[220:223], v[188:191]
  v_accvgpr_write_b32 a91, 0
  v_mfma_f32_16x16x32_bf16 v[204:207], v[88:91], a[220:223], v[204:207]
  v_accvgpr_write_b32 a92, 0
  v_mfma_f32_16x16x32_bf16 v[220:223], v[92:95], a[220:223], v[220:223]
  s_waitcnt vmcnt(6) lgkmcnt(0)
  v_mfma_f32_16x16x32_bf16 v[96:99], v[32:35], a[224:227], v[96:99]
  v_accvgpr_write_b32 a93, 0
  v_mfma_f32_16x16x32_bf16 v[112:115], v[36:39], a[224:227], v[112:115]
  ds_read_b64_tr_b16 v[64:65], v12 offset:40960
  v_accvgpr_write_b32 a94, 0
  v_mfma_f32_16x16x32_bf16 v[128:131], v[40:43], a[224:227], v[128:131]
  ds_read_b64_tr_b16 v[66:67], v12 offset:41984
  v_accvgpr_write_b32 a95, 0
  v_mfma_f32_16x16x32_bf16 v[144:147], v[44:47], a[224:227], v[144:147]
  ds_read_b64_tr_b16 v[68:69], v13 offset:40960
  v_accvgpr_write_b32 a96, 0
  v_mfma_f32_16x16x32_bf16 v[160:163], v[48:51], a[224:227], v[160:163]
  ds_read_b64_tr_b16 v[70:71], v13 offset:41984
  v_accvgpr_write_b32 a97, 0
  v_mfma_f32_16x16x32_bf16 v[176:179], v[52:55], a[224:227], v[176:179]
  ds_read_b64_tr_b16 v[72:73], v12 offset:41216
  v_accvgpr_write_b32 a98, 0
  v_mfma_f32_16x16x32_bf16 v[192:195], v[56:59], a[224:227], v[192:195]
  ds_read_b64_tr_b16 v[74:75], v12 offset:42240
  v_mfma_f32_16x16x32_bf16 v[208:211], v[60:63], a[224:227], v[208:211]
  v_accvgpr_write_b32 a99, 0
  v_mfma_f32_16x16x32_bf16 v[100:103], v[32:35], a[228:231], v[100:103]
  ds_read_b64_tr_b16 v[76:77], v13 offset:41216
  v_mfma_f32_16x16x32_bf16 v[116:119], v[36:39], a[228:231], v[116:119]
  ds_read_b64_tr_b16 v[78:79], v13 offset:42240
  v_mfma_f32_16x16x32_bf16 v[132:135], v[40:43], a[228:231], v[132:135]
  ds_read_b64_tr_b16 v[80:81], v12 offset:41472
  v_mfma_f32_16x16x32_bf16 v[148:151], v[44:47], a[228:231], v[148:151]
  v_accvgpr_write_b32 a100, 0
  v_mfma_f32_16x16x32_bf16 v[164:167], v[48:51], a[228:231], v[164:167]
  ds_read_b64_tr_b16 v[82:83], v12 offset:42496
  v_mfma_f32_16x16x32_bf16 v[180:183], v[52:55], a[228:231], v[180:183]
  ds_read_b64_tr_b16 v[84:85], v13 offset:41472
  v_mfma_f32_16x16x32_bf16 v[196:199], v[56:59], a[228:231], v[196:199]
  ds_read_b64_tr_b16 v[86:87], v13 offset:42496
  v_mfma_f32_16x16x32_bf16 v[212:215], v[60:63], a[228:231], v[212:215]
  v_accvgpr_write_b32 a101, 0
  v_mfma_f32_16x16x32_bf16 v[104:107], v[32:35], a[232:235], v[104:107]
  ds_read_b64_tr_b16 v[88:89], v12 offset:41728
  v_mfma_f32_16x16x32_bf16 v[120:123], v[36:39], a[232:235], v[120:123]
  ds_read_b64_tr_b16 v[90:91], v12 offset:42752
  v_mfma_f32_16x16x32_bf16 v[136:139], v[40:43], a[232:235], v[136:139]
  ds_read_b64_tr_b16 v[92:93], v13 offset:41728
  v_mfma_f32_16x16x32_bf16 v[152:155], v[44:47], a[232:235], v[152:155]
  v_accvgpr_write_b32 a102, 0
  v_mfma_f32_16x16x32_bf16 v[168:171], v[48:51], a[232:235], v[168:171]
  ds_read_b64_tr_b16 v[94:95], v13 offset:42752
  v_mfma_f32_16x16x32_bf16 v[184:187], v[52:55], a[232:235], v[184:187]
  v_accvgpr_write_b32 a103, 0
  v_mfma_f32_16x16x32_bf16 v[200:203], v[56:59], a[232:235], v[200:203]
  v_accvgpr_write_b32 a104, 0
  v_mfma_f32_16x16x32_bf16 v[216:219], v[60:63], a[232:235], v[216:219]
  v_accvgpr_write_b32 a105, 0
  v_mfma_f32_16x16x32_bf16 v[108:111], v[32:35], a[236:239], v[108:111]
  v_xor_b32 v12, 0x10000, v12
  v_mfma_f32_16x16x32_bf16 v[124:127], v[36:39], a[236:239], v[124:127]
  v_accvgpr_write_b32 a106, 0
  v_mfma_f32_16x16x32_bf16 v[140:143], v[40:43], a[236:239], v[140:143]
  v_xor_b32 v13, 0x10000, v13
  v_mfma_f32_16x16x32_bf16 v[156:159], v[44:47], a[236:239], v[156:159]
  v_accvgpr_write_b32 a107, 0
  v_mfma_f32_16x16x32_bf16 v[172:175], v[48:51], a[236:239], v[172:175]
  v_accvgpr_write_b32 a108, 0
  v_mfma_f32_16x16x32_bf16 v[188:191], v[52:55], a[236:239], v[188:191]
  v_accvgpr_write_b32 a109, 0
  v_mfma_f32_16x16x32_bf16 v[204:207], v[56:59], a[236:239], v[204:207]
  v_accvgpr_write_b32 a110, 0
  v_mfma_f32_16x16x32_bf16 v[220:223], v[60:63], a[236:239], v[220:223]
  s_waitcnt vmcnt(1) lgkmcnt(0)
  v_mfma_f32_16x16x32_bf16 v[96:99], v[64:67], a[240:243], v[96:99]
  s_barrier
  v_accvgpr_write_b32 a111, 0
  v_mfma_f32_16x16x32_bf16 v[112:115], v[68:71], a[240:243], v[112:115]
  v_accvgpr_write_b32 a112, 0
  v_mfma_f32_16x16x32_bf16 v[128:131], v[72:75], a[240:243], v[128:131]
  v_accvgpr_write_b32 a113, 0
  v_mfma_f32_16x16x32_bf16 v[144:147], v[76:79], a[240:243], v[144:147]
  v_accvgpr_write_b32 a114, 0
  v_mfma_f32_16x16x32_bf16 v[160:163], v[80:83], a[240:243], v[160:163]
  v_accvgpr_write_b32 a115, 0
  v_mfma_f32_16x16x32_bf16 v[176:179], v[84:87], a[240:243], v[176:179]
  v_accvgpr_write_b32 a116, 0
  v_mfma_f32_16x16x32_bf16 v[192:195], v[88:91], a[240:243], v[192:195]
  v_accvgpr_write_b32 a117, 0
  v_mfma_f32_16x16x32_bf16 v[208:211], v[92:95], a[240:243], v[208:211]
  v_accvgpr_write_b32 a118, 0
  v_mfma_f32_16x16x32_bf16 v[100:103], v[64:67], a[244:247], v[100:103]
  v_accvgpr_write_b32 a119, 0
  v_mfma_f32_16x16x32_bf16 v[116:119], v[68:71], a[244:247], v[116:119]
  v_accvgpr_write_b32 a120, 0
  v_mfma_f32_16x16x32_bf16 v[132:135], v[72:75], a[244:247], v[132:135]
  v_accvgpr_write_b32 a121, 0
  v_mfma_f32_16x16x32_bf16 v[148:151], v[76:79], a[244:247], v[148:151]
  v_accvgpr_write_b32 a122, 0
  v_mfma_f32_16x16x32_bf16 v[164:167], v[80:83], a[244:247], v[164:167]
  v_accvgpr_write_b32 a123, 0
  v_mfma_f32_16x16x32_bf16 v[180:183], v[84:87], a[244:247], v[180:183]
  v_accvgpr_write_b32 a124, 0
  v_mfma_f32_16x16x32_bf16 v[196:199], v[88:91], a[244:247], v[196:199]
  v_accvgpr_write_b32 a125, 0
  v_mfma_f32_16x16x32_bf16 v[212:215], v[92:95], a[244:247], v[212:215]
  v_accvgpr_write_b32 a126, 0
  v_mfma_f32_16x16x32_bf16 v[104:107], v[64:67], a[248:251], v[104:107]
  v_accvgpr_write_b32 a127, 0
  v_mfma_f32_16x16x32_bf16 v[120:123], v[68:71], a[248:251], v[120:123]
  v_mfma_f32_16x16x32_bf16 v[136:139], v[72:75], a[248:251], v[136:139]
  v_mfma_f32_16x16x32_bf16 v[152:155], v[76:79], a[248:251], v[152:155]
  v_mfma_f32_16x16x32_bf16 v[168:171], v[80:83], a[248:251], v[168:171]
  v_mfma_f32_16x16x32_bf16 v[184:187], v[84:87], a[248:251], v[184:187]
  v_mfma_f32_16x16x32_bf16 v[200:203], v[88:91], a[248:251], v[200:203]
  v_mfma_f32_16x16x32_bf16 v[216:219], v[92:95], a[248:251], v[216:219]
  v_mfma_f32_16x16x32_bf16 v[108:111], v[64:67], a[252:255], v[108:111]
  v_mfma_f32_16x16x32_bf16 v[124:127], v[68:71], a[252:255], v[124:127]
  v_mfma_f32_16x16x32_bf16 v[140:143], v[72:75], a[252:255], v[140:143]
  v_mfma_f32_16x16x32_bf16 v[156:159], v[76:79], a[252:255], v[156:159]
  v_mfma_f32_16x16x32_bf16 v[172:175], v[80:83], a[252:255], v[172:175]
  v_mfma_f32_16x16x32_bf16 v[188:191], v[84:87], a[252:255], v[188:191]
  v_mfma_f32_16x16x32_bf16 v[204:207], v[88:91], a[252:255], v[204:207]
  v_mfma_f32_16x16x32_bf16 v[220:223], v[92:95], a[252:255], v[220:223]
  s_and_b32 s23, s20, 1
  s_lshl_b32 s23, s23, 12
  s_cmp_lt_u32 s20, 2
  s_cselect_b32 s24, 106496, 0
  s_add_u32 s24, s24, s23
  s_lshl_b32 s26, s20, 12
  s_mov_b32 s27, s26
  s_add_u32 s25, s27, 49152
  s_waitcnt vmcnt(0)
  v_cmp_eq_u32 vcc, 0, v228
  s_cbranch_vccnz fa_kv_spin
fa_kv_ok:
  s_load_dwordx4 s[4:7], s[0:1], 64
  s_load_dwordx2 s[8:9], s[0:1], 80
  s_mov_b32 m0, s24
  s_nop 0
  buffer_load_dwordx4 v2, s[44:47], s26 offen offset:0 sc1 lds
  buffer_load_dwordx4 v2, s[44:47], s26 offen offset:1024 sc1 lds
  buffer_load_dwordx4 v2, s[44:47], s26 offen offset:2048 sc1 lds
  buffer_load_dwordx4 v2, s[44:47], s26 offen offset:3072 sc1 lds
  s_add_u32 s26, s26, 16384
  s_add_u32 s24, s24, 32768
  s_and_b32 s24, s24, 0x1ffff
  s_mov_b32 m0, s24
  s_nop 0
  buffer_load_dwordx4 v2, s[44:47], s26 offen offset:0 sc1 lds
  buffer_load_dwordx4 v2, s[44:47], s26 offen offset:1024 sc1 lds
  buffer_load_dwordx4 v2, s[44:47], s26 offen offset:2048 sc1 lds
  buffer_load_dwordx4 v2, s[44:47], s26 offen offset:3072 sc1 lds
  s_add_u32 s26, s26, 16384
  s_add_u32 s24, s24, 32768
  s_and_b32 s24, s24, 0x1ffff
  s_mov_b32 m0, s24
  s_nop 0
  buffer_load_dwordx4 v2, s[44:47], s26 offen offset:0 sc1 lds
  buffer_load_dwordx4 v2, s[44:47], s26 offen offset:1024 sc1 lds
  buffer_load_dwordx4 v2, s[44:47], s26 offen offset:2048 sc1 lds
  buffer_load_dwordx4 v2, s[44:47], s26 offen offset:3072 sc1 lds
  s_add_u32 s26, s26, 16384
  s_add_u32 s24, s24, 32768
  s_and_b32 s24, s24, 0x1ffff
  s_mov_b32 m0, s25
  s_nop 0
  buffer_load_dwordx4 v2, s[48:51], s27 offen offset:0 sc1 lds
  buffer_load_dwordx4 v2, s[48:51], s27 offen offset:1024 sc1 lds
  buffer_load_dwordx4 v2, s[48:51], s27 offen offset:2048 sc1 lds
  buffer_load_dwordx4 v2, s[48:51], s27 offen offset:3072 sc1 lds
  s_add_u32 s27, s27, 16384
  s_add_u32 s25, s25, 32768
  s_and_b32 s25, s25, 0x1ffff
  s_mov_b32 m0, s25
  s_nop 0
  buffer_load_dwordx4 v2, s[48:51], s27 offen offset:0 sc1 lds
  buffer_load_dwordx4 v2, s[48:51], s27 offen offset:1024 sc1 lds
  buffer_load_dwordx4 v2, s[48:51], s27 offen offset:2048 sc1 lds
  buffer_load_dwordx4 v2, s[48:51], s27 offen offset:3072 sc1 lds
  s_add_u32 s27, s27, 16384
  s_add_u32 s25, s25, 32768
  s_and_b32 s25, s25, 0x1ffff
  s_cmp_eq_u32 s2, 255
  s_cbranch_scc1 fa_top8
fa_notop:
  v_mov_b32 v16, 0x3e0293ee
  v_mov_b32 v17, 0x3e0293ee
  v_pk_mul_f32 v[96:97], v[96:97], v[16:17]
  v_pk_mul_f32 v[98:99], v[98:99], v[16:17]
  v_cvt_pk_bf16_f32 v32, v96, v97
  v_cvt_pk_bf16_f32 v33, v98, v99
  v_pk_mul_f32 v[112:113], v[112:113], v[16:17]
  v_pk_mul_f32 v[114:115], v[114:115], v[16:17]
  v_cvt_pk_bf16_f32 v34, v112, v113
  v_cvt_pk_bf16_f32 v35, v114, v115
  v_pk_mul_f32 v[100:101], v[100:101], v[16:17]
  v_pk_mul_f32 v[102:103], v[102:103], v[16:17]
  v_cvt_pk_bf16_f32 v36, v100, v101
  v_cvt_pk_bf16_f32 v37, v102, v103
  v_pk_mul_f32 v[116:117], v[116:117], v[16:17]
  v_pk_mul_f32 v[118:119], v[118:119], v[16:17]
  v_cvt_pk_bf16_f32 v38, v116, v117
  v_cvt_pk_bf16_f32 v39, v118, v119
  v_pk_mul_f32 v[128:129], v[128:129], v[16:17]
  v_pk_mul_f32 v[130:131], v[130:131], v[16:17]
  v_cvt_pk_bf16_f32 v40, v128, v129
  v_cvt_pk_bf16_f32 v41, v130, v131
  v_pk_mul_f32 v[144:145], v[144:145], v[16:17]
  v_pk_mul_f32 v[146:147], v[146:147], v[16:17]
  v_cvt_pk_bf16_f32 v42, v144, v145
  v_cvt_pk_bf16_f32 v43, v146, v147
  v_pk_mul_f32 v[132:133], v[132:133], v[16:17]
  v_pk_mul_f32 v[134:135], v[134:135], v[16:17]
  v_cvt_pk_bf16_f32 v44, v132, v133
  v_cvt_pk_bf16_f32 v45, v134, v135
  v_pk_mul_f32 v[148:149], v[148:149], v[16:17]
  v_pk_mul_f32 v[150:151], v[150:151], v[16:17]
  v_cvt_pk_bf16_f32 v46, v148, v149
  v_cvt_pk_bf16_f32 v47, v150, v151
  v_pk_mul_f32 v[160:161], v[160:161], v[16:17]
  v_pk_mul_f32 v[162:163], v[162:163], v[16:17]
  v_cvt_pk_bf16_f32 v48, v160, v161
  v_cvt_pk_bf16_f32 v49, v162, v163
  v_pk_mul_f32 v[176:177], v[176:177], v[16:17]
  v_pk_mul_f32 v[178:179], v[178:179], v[16:17]
  v_cvt_pk_bf16_f32 v50, v176, v177
  v_cvt_pk_bf16_f32 v51, v178, v179
  v_pk_mul_f32 v[164:165], v[164:165], v[16:17]
  v_pk_mul_f32 v[166:167], v[166:167], v[16:17]
  v_cvt_pk_bf16_f32 v52, v164, v165
  v_cvt_pk_bf16_f32 v53, v166, v167
  v_pk_mul_f32 v[180:181], v[180:181], v[16:17]
  v_pk_mul_f32 v[182:183], v[182:183], v[16:17]
  v_cvt_pk_bf16_f32 v54, v180, v181
  v_cvt_pk_bf16_f32 v55, v182, v183
  v_pk_mul_f32 v[192:193], v[192:193], v[16:17]
  v_pk_mul_f32 v[194:195], v[194:195], v[16:17]
  v_cvt_pk_bf16_f32 v56, v192, v193
  v_cvt_pk_bf16_f32 v57, v194, v195
  v_pk_mul_f32 v[208:209], v[208:209], v[16:17]
  v_pk_mul_f32 v[210:211], v[210:211], v[16:17]
  v_cvt_pk_bf16_f32 v58, v208, v209
  v_cvt_pk_bf16_f32 v59, v210, v211
  v_pk_mul_f32 v[196:197], v[196:197], v[16:17]
  v_pk_mul_f32 v[198:199], v[198:199], v[16:17]
  v_cvt_pk_bf16_f32 v60, v196, v197
  v_cvt_pk_bf16_f32 v61, v198, v199
  v_pk_mul_f32 v[212:213], v[212:213], v[16:17]
  v_pk_mul_f32 v[214:215], v[214:215], v[16:17]
  v_cvt_pk_bf16_f32 v62, v212, v213
  v_cvt_pk_bf16_f32 v63, v214, v215
  s_and_b32 s62, s2, 1
  s_lshl_b32 s62, s62, 2
  s_add_u32 s62, s62, s20
  s_lshr_b32 s63, s2, 1
  s_mul_i32 s23, s63, 40960
  s_mul_i32 s31, s62, 160
  s_add_u32 s23, s23, s31
  s_mul_i32 s34, s20, 5120
  s_add_u32 s34, s34, 131072
  v_add_u32 v20, 0, v1
  v_mul_u32_u24 v19, 6554, v20
  s_add_u32 m0, s34, 0
  v_lshrrev_b32 v19, 16, v19
  v_mul_u32_u24 v19, 1120, v19
  v_lshl_add_u32 v19, v20, 4, v19
  buffer_load_dwordx4 v19, s[52:55], s23 offen lds
  v_accvgpr_write_b32 a248, v19
  v_add_u32 v20, 64, v1
  v_mul_u32_u24 v19, 6554, v20
  s_add_u32 m0, s34, 1024
  v_lshrrev_b32 v19, 16, v19
  v_mul_u32_u24 v19, 1120, v19
  v_lshl_add_u32 v19, v20, 4, v19
  buffer_load_dwordx4 v19, s[52:55], s23 offen lds
  v_accvgpr_write_b32 a249, v19
  v_add_u32 v20, 128, v1
  v_mul_u32_u24 v19, 6554, v20
  s_add_u32 m0, s34, 2048
  v_lshrrev_b32 v19, 16, v19
  v_mul_u32_u24 v19, 1120, v19
  v_lshl_add_u32 v19, v20, 4, v19
  buffer_load_dwordx4 v19, s[52:55], s23 offen lds
  v_accvgpr_write_b32 a250, v19
  v_add_u32 v20, 192, v1
  v_mul_u32_u24 v19, 6554, v20
  s_add_u32 m0, s34, 3072
  v_lshrrev_b32 v19, 16, v19
  v_mul_u32_u24 v19, 1120, v19
  v_lshl_add_u32 v19, v20, 4, v19
  buffer_load_dwordx4 v19, s[52:55], s23 offen lds
  v_accvgpr_write_b32 a251, v19
  v_add_u32 v20, 256, v1
  v_mul_u32_u24 v19, 6554, v20
  s_add_u32 m0, s34, 4096
  v_lshrrev_b32 v19, 16, v19
  v_mul_u32_u24 v19, 1120, v19
  v_lshl_add_u32 v19, v20, 4, v19
  buffer_load_dwordx4 v19, s[52:55], s23 offen lds
  v_accvgpr_write_b32 a252, v19
  v_lshrrev_b32 v6, 2, v1
  v_mul_u32_u24 v6, 160, v6
  v_and_b32 v19, 3, v1
  v_lshl_add_u32 v6, v19, 3, v6
  v_add_u32 v6, s34, v6
  s_lshl_b32 s30, s62, 7
  s_add_u32 s30, s30, s63
  s_mul_i32 s30, s30, 5120
  s_add_u32 s30, s30, 4194304
  s_waitcnt lgkmcnt(0)
  s_cmp_ge_u32 s20, 2
  s_cselect_b32 s4, s6, s4
  s_cselect_b32 s5, s7, s5
  s_mov_b32 s52, s4
  s_mov_b32 s53, s5
  s_mov_b32 s54, 2211840
  s_mov_b32 s55, 0x20000
  s_mov_b32 s60, s8
  s_mov_b32 s61, s9
  s_mov_b32 s62, 2211840
  s_mov_b32 s63, 0x20000
  v_pk_mul_f32 v[104:105], v[104:105], v[16:17]
  v_pk_mul_f32 v[106:107], v[106:107], v[16:17]
  v_cvt_pk_bf16_f32 v64, v104, v105
  v_cvt_pk_bf16_f32 v65, v106, v107
  v_pk_mul_f32 v[120:121], v[120:121], v[16:17]
  v_pk_mul_f32 v[122:123], v[122:123], v[16:17]
  v_cvt_pk_bf16_f32 v66, v120, v121
  v_cvt_pk_bf16_f32 v67, v122, v123
  v_pk_mul_f32 v[108:109], v[108:109], v[16:17]
  v_pk_mul_f32 v[110:111], v[110:111], v[16:17]
  v_cvt_pk_bf16_f32 v68, v108, v109
  v_cvt_pk_bf16_f32 v69, v110, v111
  v_pk_mul_f32 v[124:125], v[124:125], v[16:17]
  v_pk_mul_f32 v[126:127], v[126:127], v[16:17]
  v_cvt_pk_bf16_f32 v70, v124, v125
  v_cvt_pk_bf16_f32 v71, v126, v127
  v_pk_mul_f32 v[136:137], v[136:137], v[16:17]
  v_pk_mul_f32 v[138:139], v[138:139], v[16:17]
  v_cvt_pk_bf16_f32 v72, v136, v137
  v_cvt_pk_bf16_f32 v73, v138, v139
  v_pk_mul_f32 v[152:153], v[152:153], v[16:17]
  v_pk_mul_f32 v[154:155], v[154:155], v[16:17]
  v_cvt_pk_bf16_f32 v74, v152, v153
  v_cvt_pk_bf16_f32 v75, v154, v155
  v_pk_mul_f32 v[140:141], v[140:141], v[16:17]
  v_pk_mul_f32 v[142:143], v[142:143], v[16:17]
  v_cvt_pk_bf16_f32 v76, v140, v141
  v_cvt_pk_bf16_f32 v77, v142, v143
  v_pk_mul_f32 v[156:157], v[156:157], v[16:17]
  v_pk_mul_f32 v[158:159], v[158:159], v[16:17]
  v_cvt_pk_bf16_f32 v78, v156, v157
  v_cvt_pk_bf16_f32 v79, v158, v159
  v_pk_mul_f32 v[168:169], v[168:169], v[16:17]
  v_pk_mul_f32 v[170:171], v[170:171], v[16:17]
  v_cvt_pk_bf16_f32 v80, v168, v169
  v_cvt_pk_bf16_f32 v81, v170, v171
  v_pk_mul_f32 v[184:185], v[184:185], v[16:17]
  v_pk_mul_f32 v[186:187], v[186:187], v[16:17]
  v_cvt_pk_bf16_f32 v82, v184, v185
  v_cvt_pk_bf16_f32 v83, v186, v187
  v_pk_mul_f32 v[172:173], v[172:173], v[16:17]
  v_pk_mul_f32 v[174:175], v[174:175], v[16:17]
  v_cvt_pk_bf16_f32 v84, v172, v173
  v_cvt_pk_bf16_f32 v85, v174, v175
  v_pk_mul_f32 v[188:189], v[188:189], v[16:17]
  v_pk_mul_f32 v[190:191], v[190:191], v[16:17]
  v_cvt_pk_bf16_f32 v86, v188, v189
  v_cvt_pk_bf16_f32 v87, v190, v191
  v_pk_mul_f32 v[200:201], v[200:201], v[16:17]
  v_pk_mul_f32 v[202:203], v[202:203], v[16:17]
  v_cvt_pk_bf16_f32 v88, v200, v201
  v_cvt_pk_bf16_f32 v89, v202, v203
  v_pk_mul_f32 v[216:217], v[216:217], v[16:17]
  v_pk_mul_f32 v[218:219], v[218:219], v[16:17]
  v_cvt_pk_bf16_f32 v90, v216, v217
  v_cvt_pk_bf16_f32 v91, v218, v219
  v_pk_mul_f32 v[204:205], v[204:205], v[16:17]
  v_pk_mul_f32 v[206:207], v[206:207], v[16:17]
  v_cvt_pk_bf16_f32 v92, v204, v205
  v_cvt_pk_bf16_f32 v93, v206, v207
  v_pk_mul_f32 v[220:221], v[220:221], v[16:17]
  v_pk_mul_f32 v[222:223], v[222:223], v[16:17]
  v_cvt_pk_bf16_f32 v94, v220, v221
  v_cvt_pk_bf16_f32 v95, v222, v223
  v_mov_b32 v228, 0
  v_mov_b32 v229, 0
  v_mov_b32 v230, 0
  v_mov_b32 v231, 0
  s_add_u32 s23, s20, 1
  s_lshr_b32 s23, s23, 1
  s_lshl_b32 s28, s22, 1
  s_add_u32 s28, s28, s23
  s_lshl_b32 s23, s22, 2
  s_sub_u32 s29, 28, s23
  s_and_b32 s23, s20, 1
  s_add_u32 s29, s29, s23
  v_mov_b32 v3, v2
  v_add_u32 v18, 106496, v2
  s_waitcnt vmcnt(17)
  s_barrier
  ds_read_b128 a[128:131], v18 offset:0
  ds_read_b128 a[132:135], v18 offset:1024
  ds_read_b128 a[136:139], v18 offset:2048
  ds_read_b128 a[140:143], v18 offset:3072
  ds_read_b128 a[144:147], v18 offset:4096
  ds_read_b128 a[148:151], v18 offset:5120
  ds_read_b128 a[152:155], v18 offset:6144
  ds_read_b128 a[156:159], v18 offset:7168
  s_mov_b32 s32, 0
  s_mov_b32 s11, 0
  s_mov_b32 s12, 0
  s_lshl_b32 s15, s22, 1
  s_sub_u32 s15, 25, s15
  s_lshl_b32 s15, s15, 14
  s_getpc_b64 s[36:37]
fa_copc:
  s_add_u32 s36, s36, fa_co-fa_copc-4
  s_addc_u32 s37, s37, 0
  s_waitcnt lgkmcnt(0)
  v_mfma_f32_16x16x32_bf16 v[96:99], a[128:131], v[32:35], 0
  v_mfma_f32_16x16x32_bf16 v[104:107], a[128:131], v[36:39], 0
  v_mfma_f32_16x16x32_bf16 v[128:131], a[128:131], v[64:67], 0
  v_mfma_f32_16x16x32_bf16 v[136:139], a[128:131], v[68:71], 0
  s_mov_b32 m0, s24
  ds_read_b128 a[128:131], v3 offset:0
  v_mfma_f32_16x16x32_bf16 v[100:103], a[132:135], v[32:35], 0
  buffer_load_dwordx4 v2, s[44:47], s26 offen offset:0 sc1 lds
  v_mfma_f32_16x16x32_bf16 v[108:111], a[132:135], v[36:39], 0
  v_mfma_f32_16x16x32_bf16 v[132:135], a[132:135], v[64:67], 0
  v_mfma_f32_16x16x32_bf16 v[140:143], a[132:135], v[68:71], 0
  ds_read_b128 a[132:135], v3 offset:1024
  v_mfma_f32_16x16x32_bf16 v[96:99], a[136:139], v[40:43], v[96:99]
  v_mfma_f32_16x16x32_bf16 v[104:107], a[136:139], v[44:47], v[104:107]
  v_mfma_f32_16x16x32_bf16 v[128:131], a[136:139], v[72:75], v[128:131]
  buffer_load_dwordx4 v2, s[44:47], s26 offen offset:1024 sc1 lds
  v_mfma_f32_16x16x32_bf16 v[136:139], a[136:139], v[76:79], v[136:139]
  ds_read_b128 a[136:139], v3 offset:2048
  v_mfma_f32_16x16x32_bf16 v[100:103], a[140:143], v[40:43], v[100:103]
  v_mfma_f32_16x16x32_bf16 v[108:111], a[140:143], v[44:47], v[108:111]
  v_mfma_f32_16x16x32_bf16 v[132:135], a[140:143], v[72:75], v[132:135]
  v_mfma_f32_16x16x32_bf16 v[140:143], a[140:143], v[76:79], v[140:143]
  s_waitcnt lgkmcnt(3)
  ds_read_b128 a[140:143], v3 offset:3072
  v_mfma_f32_16x16x32_bf16 v[96:99], a[144:147], v[48:51], v[96:99]
  v_mfma_f32_16x16x32_bf16 v[104:107], a[144:147], v[52:55], v[104:107]
  v_mfma_f32_16x16x32_bf16 v[128:131], a[144:147], v[80:83], v[128:131]
  buffer_load_dwordx4 v2, s[44:47], s26 offen offset:2048 sc1 lds
  v_mfma_f32_16x16x32_bf16 v[136:139], a[144:147], v[84:87], v[136:139]
  ds_read_b128 a[144:147], v3 offset:4096
  v_mfma_f32_16x16x32_bf16 v[100:103], a[148:151], v[48:51], v[100:103]
  v_mfma_f32_16x16x32_bf16 v[108:111], a[148:151], v[52:55], v[108:111]
  v_mfma_f32_16x16x32_bf16 v[132:135], a[148:151], v[80:83], v[132:135]
  v_mfma_f32_16x16x32_bf16 v[140:143], a[148:151], v[84:87], v[140:143]
  ds_read_b128 a[148:151], v3 offset:5120
  v_mfma_f32_16x16x32_bf16 v[96:99], a[152:155], v[56:59], v[96:99]
  buffer_load_dwordx4 v2, s[44:47], s26 offen offset:3072 sc1 lds
  v_mfma_f32_16x16x32_bf16 v[104:107], a[152:155], v[60:63], v[104:107]
  s_add_u32 s26, s26, 16384
  v_mfma_f32_16x16x32_bf16 v[128:131], a[152:155], v[88:91], v[128:131]
  s_add_u32 s24, s24, 32768
  v_mfma_f32_16x16x32_bf16 v[136:139], a[152:155], v[92:95], v[136:139]
  s_and_b32 s24, s24, 0x1ffff
  ds_read_b128 a[152:155], v3 offset:6144
  v_mfma_f32_16x16x32_bf16 v[100:103], a[156:159], v[56:59], v[100:103]
  v_mfma_f32_16x16x32_bf16 v[108:111], a[156:159], v[60:63], v[108:111]
  v_mfma_f32_16x16x32_bf16 v[132:135], a[156:159], v[88:91], v[132:135]
  v_mfma_f32_16x16x32_bf16 v[140:143], a[156:159], v[92:95], v[140:143]
  s_waitcnt lgkmcnt(3)
  ds_read_b128 a[156:159], v3 offset:7168
  s_nop 7
  s_cmp_lg_u32 s28, 0
  s_cbranch_scc1 fa_nomask0
  v_cndmask_b32 v96, v4, v96, s[68:69]
  v_cndmask_b32 v97, v4, v97, s[70:71]
  v_cndmask_b32 v98, v4, v98, s[72:73]
  v_cndmask_b32 v99, v4, v99, s[74:75]
  v_mov_b32 v100, v4
  v_mov_b32 v101, v4
  v_mov_b32 v102, v4
  v_mov_b32 v103, v4
  v_cndmask_b32 v108, v4, v108, s[68:69]
  v_cndmask_b32 v109, v4, v109, s[70:71]
  v_cndmask_b32 v110, v4, v110, s[72:73]
  v_cndmask_b32 v111, v4, v111, s[74:75]
fa_nomask0:
  v_max3_f32 v16, v96, v97, v98
  v_max3_f32 v16, v16, v99, v100
  v_max3_f32 v16, v16, v101, v102
  v_max_f32 v16, v16, v103
  v_max3_f32 v17, v104, v105, v106
  v_max3_f32 v17, v17, v107, v108
  v_max3_f32 v17, v17, v109, v110
  v_max_f32 v17, v17, v111
  v_max3_f32 v18, v128, v129, v130
  v_max3_f32 v18, v18, v131, v132
  v_max3_f32 v18, v18, v133, v134
  v_max_f32 v18, v18, v135
  v_max3_f32 v19, v136, v137, v138
  v_max3_f32 v19, v19, v139, v140
  v_max3_f32 v19, v19, v141, v142
  v_max_f32 v19, v19, v143
  v_mov_b32 v20, v16
  v_mov_b32 v21, v17
  v_mov_b32 v22, v18
  v_mov_b32 v23, v19
  s_nop 0
  v_permlane16_swap_b32 v16, v20
  v_permlane16_swap_b32 v17, v21
  v_permlane16_swap_b32 v18, v22
  v_permlane16_swap_b32 v19, v23
  v_max_f32 v16, v16, v20
  v_max_f32 v17, v17, v21
  v_max_f32 v18, v18, v22
  v_max_f32 v19, v19, v23
  v_mov_b32 v20, v16
  v_mov_b32 v21, v17
  v_mov_b32 v22, v18
  v_mov_b32 v23, v19
  s_nop 0
  v_permlane32_swap_b32 v16, v20
  v_permlane32_swap_b32 v17, v21
  v_permlane32_swap_b32 v18, v22
  v_permlane32_swap_b32 v19, v23
  v_max_f32 v16, v16, v20
  v_max_f32 v17, v17, v21
  v_max_f32 v18, v18, v22
  v_max_f32 v19, v19, v23
  v_sub_f32 v192, 0, v16
  v_sub_f32 v193, 0, v16
  v_sub_f32 v194, 0, v16
  v_sub_f32 v195, 0, v16
  v_sub_f32 v196, 0, v17
  v_sub_f32 v197, 0, v17
  v_sub_f32 v198, 0, v17
  v_sub_f32 v199, 0, v17
  v_sub_f32 v200, 0, v18
  v_sub_f32 v201, 0, v18
  v_sub_f32 v202, 0, v18
  v_sub_f32 v203, 0, v18
  v_sub_f32 v204, 0, v19
  v_sub_f32 v205, 0, v19
  v_sub_f32 v206, 0, v19
  v_sub_f32 v207, 0, v19
  v_sub_f32 v96, v96, v16
  v_sub_f32 v97, v97, v16
  v_sub_f32 v98, v98, v16
  v_sub_f32 v99, v99, v16
  v_sub_f32 v100, v100, v16
  v_sub_f32 v101, v101, v16
  v_sub_f32 v102, v102, v16
  v_sub_f32 v103, v103, v16
  v_sub_f32 v104, v104, v17
  v_sub_f32 v105, v105, v17
  v_sub_f32 v106, v106, v17
  v_sub_f32 v107, v107, v17
  v_sub_f32 v108, v108, v17
  v_sub_f32 v109, v109, v17
  v_sub_f32 v110, v110, v17
  v_sub_f32 v111, v111, v17
  v_sub_f32 v128, v128, v18
  v_sub_f32 v129, v129, v18
  v_sub_f32 v130, v130, v18
  v_sub_f32 v131, v131, v18
  v_sub_f32 v132, v132, v18
  v_sub_f32 v133, v133, v18
  v_sub_f32 v134, v134, v18
  v_sub_f32 v135, v135, v18
  v_sub_f32 v136, v136, v19
  v_sub_f32 v137, v137, v19
  v_sub_f32 v138, v138, v19
  v_sub_f32 v139, v139, v19
  v_sub_f32 v140, v140, v19
  v_sub_f32 v141, v141, v19
  v_sub_f32 v142, v142, v19
  v_sub_f32 v143, v143, v19
  v_mfma_f32_16x16x32_bf16 v[112:115], a[128:131], v[32:35], v[192:195]
  v_exp_f32 v208, v96
  v_exp_f32 v209, v97
  v_mfma_f32_16x16x32_bf16 v[120:123], a[128:131], v[36:39], v[196:199]
  v_exp_f32 v210, v98
  v_exp_f32 v211, v99
  v_mfma_f32_16x16x32_bf16 v[144:147], a[128:131], v[64:67], v[200:203]
  v_exp_f32 v212, v100
  v_exp_f32 v213, v101
  v_mfma_f32_16x16x32_bf16 v[152:155], a[128:131], v[68:71], v[204:207]
  s_mov_b32 m0, s25
  ds_read_b128 a[128:131], v3 offset:8192
  v_exp_f32 v214, v102
  v_add_f32 v224, v208, v209
  v_mfma_f32_16x16x32_bf16 v[116:119], a[132:135], v[32:35], v[192:195]
  buffer_load_dwordx4 v2, s[48:51], s27 offen offset:0 sc1 lds
  v_exp_f32 v215, v103
  v_cvt_pk_bf16_f32 v160, v208, v209
  v_mfma_f32_16x16x32_bf16 v[124:127], a[132:135], v[36:39], v[196:199]
  v_exp_f32 v208, v104
  v_add_f32 v224, v224, v210
  v_add_f32 v224, v224, v211
  v_mfma_f32_16x16x32_bf16 v[148:151], a[132:135], v[64:67], v[200:203]
  v_exp_f32 v209, v105
  v_cvt_pk_bf16_f32 v161, v210, v211
  v_add_f32 v224, v224, v212
  v_mfma_f32_16x16x32_bf16 v[156:159], a[132:135], v[68:71], v[204:207]
  ds_read_b128 a[132:135], v3 offset:9216
  v_exp_f32 v210, v106
  v_mfma_f32_16x16x32_bf16 v[112:115], a[136:139], v[40:43], v[112:115]
  v_exp_f32 v211, v107
  v_add_f32 v224, v224, v213
  v_cvt_pk_bf16_f32 v162, v212, v213
  v_mfma_f32_16x16x32_bf16 v[120:123], a[136:139], v[44:47], v[120:123]
  v_exp_f32 v212, v108
  v_add_f32 v224, v224, v214
  v_add_f32 v224, v224, v215
  v_mfma_f32_16x16x32_bf16 v[144:147], a[136:139], v[72:75], v[144:147]
  buffer_load_dwordx4 v2, s[48:51], s27 offen offset:1024 sc1 lds
  v_exp_f32 v213, v109
  v_cvt_pk_bf16_f32 v163, v214, v215
  v_mfma_f32_16x16x32_bf16 v[152:155], a[136:139], v[76:79], v[152:155]
  ds_read_b128 a[136:139], v3 offset:10240
  v_exp_f32 v214, v110
  v_add_f32 v225, v208, v209
  v_mfma_f32_16x16x32_bf16 v[116:119], a[140:143], v[40:43], v[116:119]
  v_exp_f32 v215, v111
  v_exp_f32 v216, v128
  v_mfma_f32_16x16x32_bf16 v[124:127], a[140:143], v[44:47], v[124:127]
  v_exp_f32 v217, v129
  v_exp_f32 v218, v130
  v_mfma_f32_16x16x32_bf16 v[148:151], a[140:143], v[72:75], v[148:151]
  v_exp_f32 v219, v131
  v_exp_f32 v220, v132
  v_mfma_f32_16x16x32_bf16 v[156:159], a[140:143], v[76:79], v[156:159]
  s_waitcnt lgkmcnt(3)
  ds_read_b128 a[140:143], v3 offset:11264
  v_exp_f32 v221, v133
  v_cvt_pk_bf16_f32 v164, v208, v209
  v_mfma_f32_16x16x32_bf16 v[112:115], a[144:147], v[48:51], v[112:115]
  v_exp_f32 v222, v134
  v_exp_f32 v223, v135
  v_mfma_f32_16x16x32_bf16 v[120:123], a[144:147], v[52:55], v[120:123]
  v_add_f32 v225, v225, v210
  v_add_f32 v225, v225, v211
  v_cvt_pk_bf16_f32 v165, v210, v211
  v_add_f32 v225, v225, v212
  v_mfma_f32_16x16x32_bf16 v[144:147], a[144:147], v[80:83], v[144:147]
  buffer_load_dwordx4 v2, s[48:51], s27 offen offset:2048 sc1 lds
  v_add_f32 v225, v225, v213
  v_cvt_pk_bf16_f32 v166, v212, v213
  v_add_f32 v225, v225, v214
  v_mfma_f32_16x16x32_bf16 v[152:155], a[144:147], v[84:87], v[152:155]
  ds_read_b128 a[144:147], v3 offset:12288
  v_add_f32 v225, v225, v215
  v_cvt_pk_bf16_f32 v167, v214, v215
  v_add_f32 v226, v216, v217
  v_mfma_f32_16x16x32_bf16 v[116:119], a[148:151], v[48:51], v[116:119]
  v_cvt_pk_bf16_f32 v176, v216, v217
  v_exp_f32 v216, v136
  v_add_f32 v226, v226, v218
  v_mfma_f32_16x16x32_bf16 v[124:127], a[148:151], v[52:55], v[124:127]
  v_exp_f32 v217, v137
  v_add_f32 v226, v226, v219
  v_cvt_pk_bf16_f32 v177, v218, v219
  v_mfma_f32_16x16x32_bf16 v[148:151], a[148:151], v[80:83], v[148:151]
  v_exp_f32 v218, v138
  v_add_f32 v226, v226, v220
  v_add_f32 v226, v226, v221
  v_mfma_f32_16x16x32_bf16 v[156:159], a[148:151], v[84:87], v[156:159]
  ds_read_b128 a[148:151], v3 offset:13312
  v_exp_f32 v219, v139
  v_mfma_f32_16x16x32_bf16 v[112:115], a[152:155], v[56:59], v[112:115]
  buffer_load_dwordx4 v2, s[48:51], s27 offen offset:3072 sc1 lds
  v_cvt_pk_bf16_f32 v178, v220, v221
  v_exp_f32 v220, v140
  v_mfma_f32_16x16x32_bf16 v[120:123], a[152:155], v[60:63], v[120:123]
  s_add_u32 s27, s27, 16384
  v_add_f32 v226, v226, v222
  v_add_f32 v226, v226, v223
  v_cvt_pk_bf16_f32 v179, v222, v223
  v_add_f32 v227, v216, v217
  v_mfma_f32_16x16x32_bf16 v[144:147], a[152:155], v[88:91], v[144:147]
  s_add_u32 s25, s25, 32768
  v_exp_f32 v221, v141
  v_cvt_pk_bf16_f32 v180, v216, v217
  v_add_f32 v227, v227, v218
  v_mfma_f32_16x16x32_bf16 v[152:155], a[152:155], v[92:95], v[152:155]
  s_and_b32 s25, s25, 0x1ffff
  ds_read_b128 a[152:155], v3 offset:14336
  v_add_f32 v227, v227, v219
  v_cvt_pk_bf16_f32 v181, v218, v219
  v_max3_f32 v5, v224, v225, v226
  v_mfma_f32_16x16x32_bf16 v[116:119], a[156:159], v[56:59], v[116:119]
  v_exp_f32 v222, v142
  v_add_f32 v227, v227, v220
  v_add_f32 v227, v227, v221
  v_mfma_f32_16x16x32_bf16 v[124:127], a[156:159], v[60:63], v[124:127]
  v_exp_f32 v223, v143
  v_cvt_pk_bf16_f32 v182, v220, v221
  v_add_f32 v227, v227, v222
  v_mfma_f32_16x16x32_bf16 v[148:151], a[156:159], v[88:91], v[148:151]
  v_add_f32 v227, v227, v223
  v_cvt_pk_bf16_f32 v183, v222, v223
  v_max_f32 v5, v5, v227
  v_cmp_lt_f32 vcc, s81, v5
  v_mfma_f32_16x16x32_bf16 v[156:159], a[156:159], v[92:95], v[156:159]
  s_waitcnt lgkmcnt(3)
  s_cbranch_vccnz fa_stub0
fa_back0:
  ds_read_b128 a[156:159], v3 offset:15360
  v_add_f32 v228, v228, v224
  v_add_f32 v229, v229, v225
  v_add_f32 v230, v230, v226
  v_add_f32 v231, v231, v227
  v_add_u32 v3, 32768, v3
  v_and_b32 v3, 0x1ffff, v3
  s_cmp_eq_u32 s28, 0
  s_cbranch_scc1 fa_AV
  s_sub_u32 s28, s28, 1
  s_cmp_eq_u32 s28, 0
  s_cbranch_scc1 fa_Aexit
.p2align 6
fa_DD:
  v_mfma_f32_16x16x32_bf16 v[96:99], a[128:131], v[32:35], v[192:195]
  s_waitcnt vmcnt(12)
  v_exp_f32 v208, v112
  v_mfma_f32_16x16x32_bf16 v[104:107], a[128:131], v[36:39], v[196:199]
  s_barrier
  v_exp_f32 v209, v113
  v_mfma_f32_16x16x32_bf16 v[128:131], a[128:131], v[64:67], v[200:203]
  s_cmp_ge_u32 s26, s32
  ds_read_b128 a[160:163], v3 offset:16384
  v_add_f32 v224, v208, v209
  v_mfma_f32_16x16x32_bf16 v[136:139], a[128:131], v[68:71], v[204:207]
  s_cbranch_scc1 fa_hk0
fa_hb0:
  v_exp_f32 v210, v114
  v_mfma_f32_16x16x32_bf16 v[100:103], a[132:135], v[32:35], v[192:195]
  ds_read_b128 a[164:167], v3 offset:17408
  v_cvt_pk_bf16_f32 v168, v208, v209
  v_mfma_f32_16x16x32_bf16 v[108:111], a[132:135], v[36:39], v[196:199]
  s_mov_b32 m0, s24
  v_exp_f32 v211, v115
  v_mfma_f32_16x16x32_bf16 v[132:135], a[132:135], v[64:67], v[200:203]
  buffer_load_dwordx4 v2, s[44:47], s26 offen offset:0 sc1 lds
  v_add_f32 v224, v224, v210
  v_add_f32 v224, v224, v211
  v_mfma_f32_16x16x32_bf16 v[140:143], a[132:135], v[68:71], v[204:207]
  v_exp_f32 v212, v116
  v_mfma_f32_16x16x32_bf16 v[96:99], a[136:139], v[40:43], v[96:99]
  ds_read_b128 a[168:171], v3 offset:18432
  v_cvt_pk_bf16_f32 v169, v210, v211
  v_mfma_f32_16x16x32_bf16 v[104:107], a[136:139], v[44:47], v[104:107]
  v_exp_f32 v213, v117
  v_mfma_f32_16x16x32_bf16 v[128:131], a[136:139], v[72:75], v[128:131]
  v_exp_f32 v214, v118
  v_mfma_f32_16x16x32_bf16 v[136:139], a[136:139], v[76:79], v[136:139]
  v_exp_f32 v215, v119
  v_mfma_f32_16x16x32_bf16 v[100:103], a[140:143], v[40:43], v[100:103]
  ds_read_b128 a[172:175], v3 offset:19456
  v_add_f32 v224, v224, v212
  v_mfma_f32_16x16x32_bf16 v[108:111], a[140:143], v[44:47], v[108:111]
  v_exp_f32 v208, v120
  v_mfma_f32_16x16x32_bf16 v[132:135], a[140:143], v[72:75], v[132:135]
  v_exp_f32 v209, v121
  v_mfma_f32_16x16x32_bf16 v[140:143], a[140:143], v[76:79], v[140:143]
  s_waitcnt lgkmcnt(4)
  v_exp_f32 v210, v122
  v_mfma_f32_16x16x32_bf16 v[96:99], a[144:147], v[48:51], v[96:99]
  ds_read_b128 a[176:179], v3 offset:20480
  v_add_f32 v224, v224, v213
  v_mfma_f32_16x16x32_bf16 v[104:107], a[144:147], v[52:55], v[104:107]
  v_exp_f32 v211, v123
  v_mfma_f32_16x16x32_bf16 v[128:131], a[144:147], v[80:83], v[128:131]
  v_cvt_pk_bf16_f32 v170, v212, v213
  v_add_f32 v224, v224, v214
  v_add_f32 v224, v224, v215
  v_mfma_f32_16x16x32_bf16 v[136:139], a[144:147], v[84:87], v[136:139]
  v_exp_f32 v212, v124
  v_mfma_f32_16x16x32_bf16 v[100:103], a[148:151], v[48:51], v[100:103]
  ds_read_b128 a[180:183], v3 offset:21504
  v_cvt_pk_bf16_f32 v171, v214, v215
  v_mfma_f32_16x16x32_bf16 v[108:111], a[148:151], v[52:55], v[108:111]
  v_exp_f32 v213, v125
  v_mfma_f32_16x16x32_bf16 v[132:135], a[148:151], v[80:83], v[132:135]
  buffer_load_dwordx4 v2, s[44:47], s26 offen offset:1024 sc1 lds
  v_add_f32 v225, v208, v209
  v_mfma_f32_16x16x32_bf16 v[140:143], a[148:151], v[84:87], v[140:143]
  v_exp_f32 v214, v126
  v_mfma_f32_16x16x32_bf16 v[96:99], a[152:155], v[56:59], v[96:99]
  ds_read_b128 a[184:187], v3 offset:22528
  v_cvt_pk_bf16_f32 v172, v208, v209
  v_mfma_f32_16x16x32_bf16 v[104:107], a[152:155], v[60:63], v[104:107]
  v_exp_f32 v215, v127
  v_mfma_f32_16x16x32_bf16 v[128:131], a[152:155], v[88:91], v[128:131]
  v_exp_f32 v216, v144
  v_mfma_f32_16x16x32_bf16 v[136:139], a[152:155], v[92:95], v[136:139]
  v_exp_f32 v217, v145
  v_mfma_f32_16x16x32_bf16 v[100:103], a[156:159], v[56:59], v[100:103]
  ds_read_b128 a[188:191], v3 offset:23552
  v_add_f32 v225, v225, v210
  v_mfma_f32_16x16x32_bf16 v[108:111], a[156:159], v[60:63], v[108:111]
  v_exp_f32 v218, v146
  v_mfma_f32_16x16x32_bf16 v[132:135], a[156:159], v[88:91], v[132:135]
  v_exp_f32 v219, v147
  v_mfma_f32_16x16x32_bf16 v[140:143], a[156:159], v[92:95], v[140:143]
  s_waitcnt lgkmcnt(4)
  v_exp_f32 v220, v148
  v_add_f32 v225, v225, v211
  v_mfma_f32_16x16x32_bf16 a[0:3], a[160:163], v[160:163], a[0:3]
  ds_read_b128 a[128:131], v3 offset:0
  v_cvt_pk_bf16_f32 v173, v210, v211
  v_mfma_f32_16x16x32_bf16 a[4:7], a[160:163], v[164:167], a[4:7]
  v_exp_f32 v221, v149
  v_mfma_f32_16x16x32_bf16 a[64:67], a[160:163], v[176:179], a[64:67]
  v_exp_f32 v222, v150
  v_mfma_f32_16x16x32_bf16 a[68:71], a[160:163], v[180:183], a[68:71]
  v_exp_f32 v223, v151
  v_mfma_f32_16x16x32_bf16 a[8:11], a[164:167], v[160:163], a[8:11]
  ds_read_b128 a[132:135], v3 offset:1024
  v_add_f32 v225, v225, v212
  v_mfma_f32_16x16x32_bf16 a[12:15], a[164:167], v[164:167], a[12:15]
  v_add_f32 v225, v225, v213
  v_cvt_pk_bf16_f32 v174, v212, v213
  v_mfma_f32_16x16x32_bf16 a[72:75], a[164:167], v[176:179], a[72:75]
  buffer_load_dwordx4 v2, s[44:47], s26 offen offset:2048 sc1 lds
  v_add_f32 v225, v225, v214
  v_mfma_f32_16x16x32_bf16 a[76:79], a[164:167], v[180:183], a[76:79]
  v_add_f32 v225, v225, v215
  v_cvt_pk_bf16_f32 v175, v214, v215
  v_mfma_f32_16x16x32_bf16 a[16:19], a[168:171], v[160:163], a[16:19]
  ds_read_b128 a[136:139], v3 offset:2048
  v_add_f32 v226, v216, v217
  v_mfma_f32_16x16x32_bf16 a[20:23], a[168:171], v[164:167], a[20:23]
  v_cvt_pk_bf16_f32 v184, v216, v217
  v_add_f32 v226, v226, v218
  v_mfma_f32_16x16x32_bf16 a[80:83], a[168:171], v[176:179], a[80:83]
  v_exp_f32 v216, v152
  v_mfma_f32_16x16x32_bf16 a[84:87], a[168:171], v[180:183], a[84:87]
  v_exp_f32 v217, v153
  v_mfma_f32_16x16x32_bf16 a[24:27], a[172:175], v[160:163], a[24:27]
  ds_read_b128 a[140:143], v3 offset:3072
  v_add_f32 v226, v226, v219
  v_cvt_pk_bf16_f32 v185, v218, v219
  v_mfma_f32_16x16x32_bf16 a[28:31], a[172:175], v[164:167], a[28:31]
  v_exp_f32 v218, v154
  v_mfma_f32_16x16x32_bf16 a[88:91], a[172:175], v[176:179], a[88:91]
  v_add_f32 v226, v226, v220
  v_add_f32 v226, v226, v221
  v_mfma_f32_16x16x32_bf16 a[92:95], a[172:175], v[180:183], a[92:95]
  s_waitcnt lgkmcnt(4)
  v_exp_f32 v219, v155
  v_mfma_f32_16x16x32_bf16 a[32:35], a[176:179], v[160:163], a[32:35]
  ds_read_b128 a[144:147], v3 offset:4096
  v_cvt_pk_bf16_f32 v186, v220, v221
  v_mfma_f32_16x16x32_bf16 a[36:39], a[176:179], v[164:167], a[36:39]
  v_exp_f32 v220, v156
  v_mfma_f32_16x16x32_bf16 a[96:99], a[176:179], v[176:179], a[96:99]
  v_add_f32 v226, v226, v222
  v_add_f32 v226, v226, v223
  v_mfma_f32_16x16x32_bf16 a[100:103], a[176:179], v[180:183], a[100:103]
  v_exp_f32 v221, v157
  v_mfma_f32_16x16x32_bf16 a[40:43], a[180:183], v[160:163], a[40:43]
  ds_read_b128 a[148:151], v3 offset:5120
  v_cvt_pk_bf16_f32 v187, v222, v223
  v_mfma_f32_16x16x32_bf16 a[44:47], a[180:183], v[164:167], a[44:47]
  v_exp_f32 v222, v158
  v_mfma_f32_16x16x32_bf16 a[104:107], a[180:183], v[176:179], a[104:107]
  buffer_load_dwordx4 v2, s[44:47], s26 offen offset:3072 sc1 lds
  v_add_f32 v227, v216, v217
  v_mfma_f32_16x16x32_bf16 a[108:111], a[180:183], v[180:183], a[108:111]
  s_add_u32 s26, s26, 16384
  v_exp_f32 v223, v159
  v_mfma_f32_16x16x32_bf16 a[48:51], a[184:187], v[160:163], a[48:51]
  s_add_u32 s24, s24, 32768
  ds_read_b128 a[152:155], v3 offset:6144
  v_cvt_pk_bf16_f32 v188, v216, v217
  v_add_f32 v227, v227, v218
  v_mfma_f32_16x16x32_bf16 a[52:55], a[184:187], v[164:167], a[52:55]
  s_and_b32 s24, s24, 0x1ffff
  v_add_f32 v227, v227, v219
  v_cvt_pk_bf16_f32 v189, v218, v219
  v_mfma_f32_16x16x32_bf16 a[112:115], a[184:187], v[176:179], a[112:115]
  v_max3_f32 v5, v224, v225, v226
  v_add_f32 v227, v227, v220
  v_mfma_f32_16x16x32_bf16 a[116:119], a[184:187], v[180:183], a[116:119]
  v_add_f32 v227, v227, v221
  v_cvt_pk_bf16_f32 v190, v220, v221
  v_mfma_f32_16x16x32_bf16 a[56:59], a[188:191], v[160:163], a[56:59]
  ds_read_b128 a[156:159], v3 offset:7168
  v_add_f32 v227, v227, v222
  v_mfma_f32_16x16x32_bf16 a[60:63], a[188:191], v[164:167], a[60:63]
  v_add_f32 v227, v227, v223
  v_cvt_pk_bf16_f32 v191, v222, v223
  v_mfma_f32_16x16x32_bf16 a[120:123], a[188:191], v[176:179], a[120:123]
  s_waitcnt lgkmcnt(4)
  v_max_f32 v5, v5, v227
  v_cmp_lt_f32 vcc, s81, v5
  v_mfma_f32_16x16x32_bf16 a[124:127], a[188:191], v[180:183], a[124:127]
  s_cbranch_vccnz fa_stub1
fa_back1:
  v_add_f32 v228, v228, v224
  v_add_f32 v229, v229, v225
  v_add_f32 v230, v230, v226
  v_add_f32 v231, v231, v227
  v_mfma_f32_16x16x32_bf16 v[112:115], a[128:131], v[32:35], v[192:195]
  ds_read_b128 a[160:163], v3 offset:24576
  v_exp_f32 v208, v96
  v_mfma_f32_16x16x32_bf16 v[120:123], a[128:131], v[36:39], v[196:199]
  v_exp_f32 v209, v97
  v_mfma_f32_16x16x32_bf16 v[144:147], a[128:131], v[64:67], v[200:203]
  s_cmp_ge_u32 s26, s32
  v_exp_f32 v210, v98
  v_mfma_f32_16x16x32_bf16 v[152:155], a[128:131], v[68:71], v[204:207]
  s_cbranch_scc1 fa_hk1
fa_hb1:
  v_exp_f32 v211, v99
  v_mfma_f32_16x16x32_bf16 v[116:119], a[132:135], v[32:35], v[192:195]
  ds_read_b128 a[164:167], v3 offset:25600
  v_mfma_f32_16x16x32_bf16 v[124:127], a[132:135], v[36:39], v[196:199]
  s_mov_b32 m0, s25
  v_exp_f32 v212, v100
  v_mfma_f32_16x16x32_bf16 v[148:151], a[132:135], v[64:67], v[200:203]
  buffer_load_dwordx4 v2, s[48:51], s27 offen offset:0 sc1 lds
  v_add_f32 v224, v208, v209
  v_cvt_pk_bf16_f32 v160, v208, v209
  v_mfma_f32_16x16x32_bf16 v[156:159], a[132:135], v[68:71], v[204:207]
  v_exp_f32 v213, v101
  v_mfma_f32_16x16x32_bf16 v[112:115], a[136:139], v[40:43], v[112:115]
  ds_read_b128 a[168:171], v3 offset:26624
  v_add_f32 v224, v224, v210
  v_mfma_f32_16x16x32_bf16 v[120:123], a[136:139], v[44:47], v[120:123]
  v_exp_f32 v214, v102
  v_mfma_f32_16x16x32_bf16 v[144:147], a[136:139], v[72:75], v[144:147]
  v_exp_f32 v215, v103
  v_mfma_f32_16x16x32_bf16 v[152:155], a[136:139], v[76:79], v[152:155]
  v_exp_f32 v208, v104
  v_mfma_f32_16x16x32_bf16 v[116:119], a[140:143], v[40:43], v[116:119]
  ds_read_b128 a[172:175], v3 offset:27648
  v_add_f32 v224, v224, v211
  v_mfma_f32_16x16x32_bf16 v[124:127], a[140:143], v[44:47], v[124:127]
  v_exp_f32 v209, v105
  v_mfma_f32_16x16x32_bf16 v[148:151], a[140:143], v[72:75], v[148:151]
  v_cvt_pk_bf16_f32 v161, v210, v211
  v_add_f32 v224, v224, v212
  v_mfma_f32_16x16x32_bf16 v[156:159], a[140:143], v[76:79], v[156:159]
  s_waitcnt lgkmcnt(4)
  v_exp_f32 v210, v106
  v_mfma_f32_16x16x32_bf16 v[112:115], a[144:147], v[48:51], v[112:115]
  ds_read_b128 a[176:179], v3 offset:28672
  v_add_f32 v224, v224, v213
  v_mfma_f32_16x16x32_bf16 v[120:123], a[144:147], v[52:55], v[120:123]
  v_exp_f32 v211, v107
  v_mfma_f32_16x16x32_bf16 v[144:147], a[144:147], v[80:83], v[144:147]
  v_cvt_pk_bf16_f32 v162, v212, v213
  v_add_f32 v224, v224, v214
  v_add_f32 v224, v224, v215
  v_mfma_f32_16x16x32_bf16 v[152:155], a[144:147], v[84:87], v[152:155]
  v_exp_f32 v212, v108
  v_mfma_f32_16x16x32_bf16 v[116:119], a[148:151], v[48:51], v[116:119]
  ds_read_b128 a[180:183], v3 offset:29696
  v_cvt_pk_bf16_f32 v163, v214, v215
  v_mfma_f32_16x16x32_bf16 v[124:127], a[148:151], v[52:55], v[124:127]
  v_exp_f32 v213, v109
  v_mfma_f32_16x16x32_bf16 v[148:151], a[148:151], v[80:83], v[148:151]
  buffer_load_dwordx4 v2, s[48:51], s27 offen offset:1024 sc1 lds
  v_add_f32 v225, v208, v209
  v_mfma_f32_16x16x32_bf16 v[156:159], a[148:151], v[84:87], v[156:159]
  v_exp_f32 v214, v110
  v_mfma_f32_16x16x32_bf16 v[112:115], a[152:155], v[56:59], v[112:115]
  ds_read_b128 a[184:187], v3 offset:30720
  v_cvt_pk_bf16_f32 v164, v208, v209
  v_mfma_f32_16x16x32_bf16 v[120:123], a[152:155], v[60:63], v[120:123]
  v_exp_f32 v215, v111
  v_mfma_f32_16x16x32_bf16 v[144:147], a[152:155], v[88:91], v[144:147]
  v_exp_f32 v216, v128
  v_mfma_f32_16x16x32_bf16 v[152:155], a[152:155], v[92:95], v[152:155]
  v_exp_f32 v217, v129
  v_mfma_f32_16x16x32_bf16 v[116:119], a[156:159], v[56:59], v[116:119]
  ds_read_b128 a[188:191], v3 offset:31744
  v_add_f32 v225, v225, v210
  v_mfma_f32_16x16x32_bf16 v[124:127], a[156:159], v[60:63], v[124:127]
  v_exp_f32 v218, v130
  v_mfma_f32_16x16x32_bf16 v[148:151], a[156:159], v[88:91], v[148:151]
  v_exp_f32 v219, v131
  v_mfma_f32_16x16x32_bf16 v[156:159], a[156:159], v[92:95], v[156:159]
  s_waitcnt lgkmcnt(4)
  v_exp_f32 v220, v132
  v_add_f32 v225, v225, v211
  v_mfma_f32_16x16x32_bf16 a[0:3], a[160:163], v[168:171], a[0:3]
  ds_read_b128 a[128:131], v3 offset:8192
  v_cvt_pk_bf16_f32 v165, v210, v211
  v_mfma_f32_16x16x32_bf16 a[4:7], a[160:163], v[172:175], a[4:7]
  v_exp_f32 v221, v133
  v_mfma_f32_16x16x32_bf16 a[64:67], a[160:163], v[184:187], a[64:67]
  v_exp_f32 v222, v134
  v_mfma_f32_16x16x32_bf16 a[68:71], a[160:163], v[188:191], a[68:71]
  v_exp_f32 v223, v135
  v_mfma_f32_16x16x32_bf16 a[8:11], a[164:167], v[168:171], a[8:11]
  ds_read_b128 a[132:135], v3 offset:9216
  v_add_f32 v225, v225, v212
  v_mfma_f32_16x16x32_bf16 a[12:15], a[164:167], v[172:175], a[12:15]
  v_add_f32 v225, v225, v213
  v_cvt_pk_bf16_f32 v166, v212, v213
  v_mfma_f32_16x16x32_bf16 a[72:75], a[164:167], v[184:187], a[72:75]
  buffer_load_dwordx4 v2, s[48:51], s27 offen offset:2048 sc1 lds
  v_add_f32 v225, v225, v214
  v_mfma_f32_16x16x32_bf16 a[76:79], a[164:167], v[188:191], a[76:79]
  v_add_f32 v225, v225, v215
  v_cvt_pk_bf16_f32 v167, v214, v215
  v_mfma_f32_16x16x32_bf16 a[16:19], a[168:171], v[168:171], a[16:19]
  ds_read_b128 a[136:139], v3 offset:10240
  v_add_f32 v226, v216, v217
  v_mfma_f32_16x16x32_bf16 a[20:23], a[168:171], v[172:175], a[20:23]
  v_cvt_pk_bf16_f32 v176, v216, v217
  v_add_f32 v226, v226, v218
  v_mfma_f32_16x16x32_bf16 a[80:83], a[168:171], v[184:187], a[80:83]
  v_exp_f32 v216, v136
  v_mfma_f32_16x16x32_bf16 a[84:87], a[168:171], v[188:191], a[84:87]
  v_exp_f32 v217, v137
  v_mfma_f32_16x16x32_bf16 a[24:27], a[172:175], v[168:171], a[24:27]
  ds_read_b128 a[140:143], v3 offset:11264
  v_add_f32 v226, v226, v219
  v_cvt_pk_bf16_f32 v177, v218, v219
  v_mfma_f32_16x16x32_bf16 a[28:31], a[172:175], v[172:175], a[28:31]
  v_exp_f32 v218, v138
  v_mfma_f32_16x16x32_bf16 a[88:91], a[172:175], v[184:187], a[88:91]
  v_add_f32 v226, v226, v220
  v_add_f32 v226, v226, v221
  v_mfma_f32_16x16x32_bf16 a[92:95], a[172:175], v[188:191], a[92:95]
  s_waitcnt lgkmcnt(4)
  v_exp_f32 v219, v139
  v_mfma_f32_16x16x32_bf16 a[32:35], a[176:179], v[168:171], a[32:35]
  ds_read_b128 a[144:147], v3 offset:12288
  v_cvt_pk_bf16_f32 v178, v220, v221
  v_mfma_f32_16x16x32_bf16 a[36:39], a[176:179], v[172:175], a[36:39]
  v_exp_f32 v220, v140
  v_mfma_f32_16x16x32_bf16 a[96:99], a[176:179], v[184:187], a[96:99]
  v_add_f32 v226, v226, v222
  v_add_f32 v226, v226, v223
  v_mfma_f32_16x16x32_bf16 a[100:103], a[176:179], v[188:191], a[100:103]
  v_exp_f32 v221, v141
  v_mfma_f32_16x16x32_bf16 a[40:43], a[180:183], v[168:171], a[40:43]
  ds_read_b128 a[148:151], v3 offset:13312
  v_cvt_pk_bf16_f32 v179, v222, v223
  v_mfma_f32_16x16x32_bf16 a[44:47], a[180:183], v[172:175], a[44:47]
  v_exp_f32 v222, v142
  v_mfma_f32_16x16x32_bf16 a[104:107], a[180:183], v[184:187], a[104:107]
  buffer_load_dwordx4 v2, s[48:51], s27 offen offset:3072 sc1 lds
  v_add_f32 v227, v216, v217
  v_mfma_f32_16x16x32_bf16 a[108:111], a[180:183], v[188:191], a[108:111]
  s_add_u32 s27, s27, 16384
  v_exp_f32 v223, v143
  v_mfma_f32_16x16x32_bf16 a[48:51], a[184:187], v[168:171], a[48:51]
  s_add_u32 s25, s25, 32768
  ds_read_b128 a[152:155], v3 offset:14336
  v_cvt_pk_bf16_f32 v180, v216, v217
  v_add_f32 v227, v227, v218
  v_mfma_f32_16x16x32_bf16 a[52:55], a[184:187], v[172:175], a[52:55]
  s_and_b32 s25, s25, 0x1ffff
  v_add_f32 v227, v227, v219
  v_cvt_pk_bf16_f32 v181, v218, v219
  v_mfma_f32_16x16x32_bf16 a[112:115], a[184:187], v[184:187], a[112:115]
  v_max3_f32 v5, v224, v225, v226
  v_add_f32 v227, v227, v220
  v_mfma_f32_16x16x32_bf16 a[116:119], a[184:187], v[188:191], a[116:119]
  v_add_f32 v227, v227, v221
  v_cvt_pk_bf16_f32 v182, v220, v221
  v_mfma_f32_16x16x32_bf16 a[56:59], a[188:191], v[168:171], a[56:59]
  ds_read_b128 a[156:159], v3 offset:15360
  v_add_f32 v227, v227, v222
  v_mfma_f32_16x16x32_bf16 a[60:63], a[188:191], v[172:175], a[60:63]
  s_sub_u32 s28, s28, 1
  v_add_f32 v227, v227, v223
  v_cvt_pk_bf16_f32 v183, v222, v223
  v_mfma_f32_16x16x32_bf16 a[120:123], a[188:191], v[184:187], a[120:123]
  s_waitcnt lgkmcnt(4)
  v_max_f32 v5, v5, v227
  v_cmp_lt_f32 vcc, s81, v5
  v_mfma_f32_16x16x32_bf16 a[124:127], a[188:191], v[188:191], a[124:127]
  s_cbranch_vccnz fa_stub2
fa_back2:
  v_add_f32 v228, v228, v224
  v_add_f32 v229, v229, v225
  v_add_f32 v230, v230, v226
  v_add_f32 v231, v231, v227
  v_add_u32 v3, 32768, v3
  v_and_b32 v3, 0x1ffff, v3
  s_cmp_lg_u32 s28, 0
  s_cbranch_scc1 fa_DD
fa_Aexit:
  s_bitcmp1_b32 s20, 0
  s_cbranch_scc1 fa_Aodd
  v_mfma_f32_16x16x32_bf16 v[96:99], a[128:131], v[32:35], v[192:195]
  s_waitcnt vmcnt(12)
  v_exp_f32 v208, v112
  v_mfma_f32_16x16x32_bf16 v[104:107], a[128:131], v[36:39], v[196:199]
  s_barrier
  v_exp_f32 v209, v113
  v_mfma_f32_16x16x32_bf16 v[128:131], a[128:131], v[64:67], v[200:203]
  ds_read_b128 a[160:163], v3 offset:16384
  v_add_f32 v224, v208, v209
  v_mfma_f32_16x16x32_bf16 v[136:139], a[128:131], v[68:71], v[204:207]
  v_exp_f32 v210, v114
  v_mfma_f32_16x16x32_bf16 v[100:103], a[132:135], v[32:35], v[192:195]
  ds_read_b128 a[164:167], v3 offset:17408
  v_cvt_pk_bf16_f32 v168, v208, v209
  v_mfma_f32_16x16x32_bf16 v[108:111], a[132:135], v[36:39], v[196:199]
  s_mov_b32 m0, s24
  v_exp_f32 v211, v115
  v_mfma_f32_16x16x32_bf16 v[132:135], a[132:135], v[64:67], v[200:203]
  buffer_load_dwordx4 v2, s[44:47], s26 offen offset:0 sc1 lds
  v_add_f32 v224, v224, v210
  v_add_f32 v224, v224, v211
  v_mfma_f32_16x16x32_bf16 v[140:143], a[132:135], v[68:71], v[204:207]
  v_exp_f32 v212, v116
  v_mfma_f32_16x16x32_bf16 v[96:99], a[136:139], v[40:43], v[96:99]
  ds_read_b128 a[168:171], v3 offset:18432
  v_cvt_pk_bf16_f32 v169, v210, v211
  v_mfma_f32_16x16x32_bf16 v[104:107], a[136:139], v[44:47], v[104:107]
  v_exp_f32 v213, v117
  v_mfma_f32_16x16x32_bf16 v[128:131], a[136:139], v[72:75], v[128:131]
  v_exp_f32 v214, v118
  v_mfma_f32_16x16x32_bf16 v[136:139], a[136:139], v[76:79], v[136:139]
  v_exp_f32 v215, v119
  v_mfma_f32_16x16x32_bf16 v[100:103], a[140:143], v[40:43], v[100:103]
  ds_read_b128 a[172:175], v3 offset:19456
  v_add_f32 v224, v224, v212
  v_mfma_f32_16x16x32_bf16 v[108:111], a[140:143], v[44:47], v[108:111]
  v_exp_f32 v208, v120
  v_mfma_f32_16x16x32_bf16 v[132:135], a[140:143], v[72:75], v[132:135]
  v_exp_f32 v209, v121
  v_mfma_f32_16x16x32_bf16 v[140:143], a[140:143], v[76:79], v[140:143]
  s_waitcnt lgkmcnt(4)
  v_exp_f32 v210, v122
  v_mfma_f32_16x16x32_bf16 v[96:99], a[144:147], v[48:51], v[96:99]
  ds_read_b128 a[176:179], v3 offset:20480
  v_add_f32 v224, v224, v213
  v_mfma_f32_16x16x32_bf16 v[104:107], a[144:147], v[52:55], v[104:107]
  v_exp_f32 v211, v123
  v_mfma_f32_16x16x32_bf16 v[128:131], a[144:147], v[80:83], v[128:131]
  v_cvt_pk_bf16_f32 v170, v212, v213
  v_add_f32 v224, v224, v214
  v_add_f32 v224, v224, v215
  v_mfma_f32_16x16x32_bf16 v[136:139], a[144:147], v[84:87], v[136:139]
  v_exp_f32 v212, v124
  v_mfma_f32_16x16x32_bf16 v[100:103], a[148:151], v[48:51], v[100:103]
  ds_read_b128 a[180:183], v3 offset:21504
  v_cvt_pk_bf16_f32 v171, v214, v215
  v_mfma_f32_16x16x32_bf16 v[108:111], a[148:151], v[52:55], v[108:111]
  v_exp_f32 v213, v125
  v_mfma_f32_16x16x32_bf16 v[132:135], a[148:151], v[80:83], v[132:135]
  buffer_load_dwordx4 v2, s[44:47], s26 offen offset:1024 sc1 lds
  v_add_f32 v225, v208, v209
  v_mfma_f32_16x16x32_bf16 v[140:143], a[148:151], v[84:87], v[140:143]
  v_exp_f32 v214, v126
  v_mfma_f32_16x16x32_bf16 v[96:99], a[152:155], v[56:59], v[96:99]
  ds_read_b128 a[184:187], v3 offset:22528
  v_cvt_pk_bf16_f32 v172, v208, v209
  v_mfma_f32_16x16x32_bf16 v[104:107], a[152:155], v[60:63], v[104:107]
  v_exp_f32 v215, v127
  v_mfma_f32_16x16x32_bf16 v[128:131], a[152:155], v[88:91], v[128:131]
  v_exp_f32 v216, v144
  v_mfma_f32_16x16x32_bf16 v[136:139], a[152:155], v[92:95], v[136:139]
  v_exp_f32 v217, v145
  v_mfma_f32_16x16x32_bf16 v[100:103], a[156:159], v[56:59], v[100:103]
  ds_read_b128 a[188:191], v3 offset:23552
  v_add_f32 v225, v225, v210
  v_mfma_f32_16x16x32_bf16 v[108:111], a[156:159], v[60:63], v[108:111]
  v_exp_f32 v218, v146
  v_mfma_f32_16x16x32_bf16 v[132:135], a[156:159], v[88:91], v[132:135]
  v_exp_f32 v219, v147
  v_mfma_f32_16x16x32_bf16 v[140:143], a[156:159], v[92:95], v[140:143]
  s_waitcnt lgkmcnt(4)
  v_exp_f32 v220, v148
  v_add_f32 v225, v225, v211
  v_mfma_f32_16x16x32_bf16 a[0:3], a[160:163], v[160:163], a[0:3]
  ds_read_b128 a[128:131], v3 offset:0
  v_cvt_pk_bf16_f32 v173, v210, v211
  v_mfma_f32_16x16x32_bf16 a[4:7], a[160:163], v[164:167], a[4:7]
  v_exp_f32 v221, v149
  v_mfma_f32_16x16x32_bf16 a[64:67], a[160:163], v[176:179], a[64:67]
  v_exp_f32 v222, v150
  v_mfma_f32_16x16x32_bf16 a[68:71], a[160:163], v[180:183], a[68:71]
  v_exp_f32 v223, v151
  v_mfma_f32_16x16x32_bf16 a[8:11], a[164:167], v[160:163], a[8:11]
  ds_read_b128 a[132:135], v3 offset:1024
  v_add_f32 v225, v225, v212
  v_mfma_f32_16x16x32_bf16 a[12:15], a[164:167], v[164:167], a[12:15]
  v_add_f32 v225, v225, v213
  v_cvt_pk_bf16_f32 v174, v212, v213
  v_mfma_f32_16x16x32_bf16 a[72:75], a[164:167], v[176:179], a[72:75]
  buffer_load_dwordx4 v2, s[44:47], s26 offen offset:2048 sc1 lds
  v_add_f32 v225, v225, v214
  v_mfma_f32_16x16x32_bf16 a[76:79], a[164:167], v[180:183], a[76:79]
  v_add_f32 v225, v225, v215
  v_cvt_pk_bf16_f32 v175, v214, v215
  v_mfma_f32_16x16x32_bf16 a[16:19], a[168:171], v[160:163], a[16:19]
  ds_read_b128 a[136:139], v3 offset:2048
  v_add_f32 v226, v216, v217
  v_mfma_f32_16x16x32_bf16 a[20:23], a[168:171], v[164:167], a[20:23]
  v_cvt_pk_bf16_f32 v184, v216, v217
  v_add_f32 v226, v226, v218
  v_mfma_f32_16x16x32_bf16 a[80:83], a[168:171], v[176:179], a[80:83]
  v_exp_f32 v216, v152
  v_mfma_f32_16x16x32_bf16 a[84:87], a[168:171], v[180:183], a[84:87]
  v_exp_f32 v217, v153
  v_mfma_f32_16x16x32_bf16 a[24:27], a[172:175], v[160:163], a[24:27]
  ds_read_b128 a[140:143], v3 offset:3072
  v_add_f32 v226, v226, v219
  v_cvt_pk_bf16_f32 v185, v218, v219
  v_mfma_f32_16x16x32_bf16 a[28:31], a[172:175], v[164:167], a[28:31]
  v_exp_f32 v218, v154
  v_mfma_f32_16x16x32_bf16 a[88:91], a[172:175], v[176:179], a[88:91]
  v_add_f32 v226, v226, v220
  v_add_f32 v226, v226, v221
  v_mfma_f32_16x16x32_bf16 a[92:95], a[172:175], v[180:183], a[92:95]
  s_waitcnt lgkmcnt(4)
  v_exp_f32 v219, v155
  v_mfma_f32_16x16x32_bf16 a[32:35], a[176:179], v[160:163], a[32:35]
  ds_read_b128 a[144:147], v3 offset:4096
  v_cvt_pk_bf16_f32 v186, v220, v221
  v_mfma_f32_16x16x32_bf16 a[36:39], a[176:179], v[164:167], a[36:39]
  v_exp_f32 v220, v156
  v_mfma_f32_16x16x32_bf16 a[96:99], a[176:179], v[176:179], a[96:99]
  v_add_f32 v226, v226, v222
  v_add_f32 v226, v226, v223
  v_mfma_f32_16x16x32_bf16 a[100:103], a[176:179], v[180:183], a[100:103]
  v_exp_f32 v221, v157
  v_mfma_f32_16x16x32_bf16 a[40:43], a[180:183], v[160:163], a[40:43]
  ds_read_b128 a[148:151], v3 offset:5120
  v_cvt_pk_bf16_f32 v187, v222, v223
  v_mfma_f32_16x16x32_bf16 a[44:47], a[180:183], v[164:167], a[44:47]
  v_exp_f32 v222, v158
  v_mfma_f32_16x16x32_bf16 a[104:107], a[180:183], v[176:179], a[104:107]
  buffer_load_dwordx4 v2, s[44:47], s26 offen offset:3072 sc1 lds
  v_add_f32 v227, v216, v217
  v_mfma_f32_16x16x32_bf16 a[108:111], a[180:183], v[180:183], a[108:111]
  s_add_u32 s26, s26, 16384
  v_exp_f32 v223, v159
  v_mfma_f32_16x16x32_bf16 a[48:51], a[184:187], v[160:163], a[48:51]
  s_add_u32 s24, s24, 32768
  ds_read_b128 a[152:155], v3 offset:6144
  v_cvt_pk_bf16_f32 v188, v216, v217
  v_add_f32 v227, v227, v218
  v_mfma_f32_16x16x32_bf16 a[52:55], a[184:187], v[164:167], a[52:55]
  s_and_b32 s24, s24, 0x1ffff
  v_add_f32 v227, v227, v219
  v_cvt_pk_bf16_f32 v189, v218, v219
  v_mfma_f32_16x16x32_bf16 a[112:115], a[184:187], v[176:179], a[112:115]
  v_max3_f32 v5, v224, v225, v226
  v_add_f32 v227, v227, v220
  v_mfma_f32_16x16x32_bf16 a[116:119], a[184:187], v[180:183], a[116:119]
  v_add_f32 v227, v227, v221
  v_cvt_pk_bf16_f32 v190, v220, v221
  v_mfma_f32_16x16x32_bf16 a[56:59], a[188:191], v[160:163], a[56:59]
  ds_read_b128 a[156:159], v3 offset:7168
  v_add_f32 v227, v227, v222
  v_mfma_f32_16x16x32_bf16 a[60:63], a[188:191], v[164:167], a[60:63]
  v_add_f32 v227, v227, v223
  v_cvt_pk_bf16_f32 v191, v222, v223
  v_mfma_f32_16x16x32_bf16 a[120:123], a[188:191], v[176:179], a[120:123]
  s_waitcnt lgkmcnt(4)
  v_max_f32 v5, v5, v227
  v_cmp_lt_f32 vcc, s81, v5
  v_mfma_f32_16x16x32_bf16 a[124:127], a[188:191], v[180:183], a[124:127]
  s_cbranch_vccnz fa_stub3
fa_back3:
  v_add_f32 v228, v228, v224
  v_add_f32 v229, v229, v225
  v_add_f32 v230, v230, v226
  v_add_f32 v231, v231, v227
  v_mfma_f32_16x16x32_bf16 v[144:147], a[128:131], v[64:67], v[200:203]
  ds_read_b128 a[160:163], v3 offset:24576
  v_cndmask_b32 v96, v4, v96, s[68:69]
  v_cndmask_b32 v97, v4, v97, s[70:71]
  v_mfma_f32_16x16x32_bf16 v[152:155], a[128:131], v[68:71], v[204:207]
  v_cndmask_b32 v98, v4, v98, s[72:73]
  v_cndmask_b32 v99, v4, v99, s[74:75]
  v_mov_b32 v100, v4
  v_mfma_f32_16x16x32_bf16 v[148:151], a[132:135], v[64:67], v[200:203]
  ds_read_b128 a[164:167], v3 offset:25600
  v_mov_b32 v101, v4
  v_mov_b32 v102, v4
  v_mfma_f32_16x16x32_bf16 v[156:159], a[132:135], v[68:71], v[204:207]
  v_mov_b32 v103, v4
  v_cndmask_b32 v108, v4, v108, s[68:69]
  v_cndmask_b32 v109, v4, v109, s[70:71]
  v_mfma_f32_16x16x32_bf16 v[144:147], a[136:139], v[72:75], v[144:147]
  ds_read_b128 a[168:171], v3 offset:26624
  v_cndmask_b32 v110, v4, v110, s[72:73]
  v_cndmask_b32 v111, v4, v111, s[74:75]
  v_mfma_f32_16x16x32_bf16 v[152:155], a[136:139], v[76:79], v[152:155]
  s_mov_b32 m0, s25
  v_exp_f32 v208, v96
  v_exp_f32 v209, v97
  v_mfma_f32_16x16x32_bf16 v[148:151], a[140:143], v[72:75], v[148:151]
  ds_read_b128 a[172:175], v3 offset:27648
  buffer_load_dwordx4 v2, s[48:51], s27 offen offset:0 sc1 lds
  v_mfma_f32_16x16x32_bf16 v[156:159], a[140:143], v[76:79], v[156:159]
  s_waitcnt lgkmcnt(4)
  v_exp_f32 v210, v98
  v_add_f32 v224, v208, v209
  v_mfma_f32_16x16x32_bf16 v[144:147], a[144:147], v[80:83], v[144:147]
  ds_read_b128 a[176:179], v3 offset:28672
  v_exp_f32 v211, v99
  v_mfma_f32_16x16x32_bf16 v[152:155], a[144:147], v[84:87], v[152:155]
  v_exp_f32 v212, v100
  v_cvt_pk_bf16_f32 v160, v208, v209
  v_mfma_f32_16x16x32_bf16 v[148:151], a[148:151], v[80:83], v[148:151]
  ds_read_b128 a[180:183], v3 offset:29696
  v_exp_f32 v213, v101
  v_mfma_f32_16x16x32_bf16 v[156:159], a[148:151], v[84:87], v[156:159]
  v_exp_f32 v214, v102
  v_add_f32 v224, v224, v210
  v_add_f32 v224, v224, v211
  v_mfma_f32_16x16x32_bf16 v[144:147], a[152:155], v[88:91], v[144:147]
  ds_read_b128 a[184:187], v3 offset:30720
  v_cvt_pk_bf16_f32 v161, v210, v211
  v_add_f32 v224, v224, v212
  v_mfma_f32_16x16x32_bf16 v[152:155], a[152:155], v[92:95], v[152:155]
  v_exp_f32 v215, v103
  v_add_f32 v224, v224, v213
  v_mfma_f32_16x16x32_bf16 v[148:151], a[156:159], v[88:91], v[148:151]
  ds_read_b128 a[188:191], v3 offset:31744
  v_cvt_pk_bf16_f32 v162, v212, v213
  v_add_f32 v224, v224, v214
  v_mfma_f32_16x16x32_bf16 v[156:159], a[156:159], v[92:95], v[156:159]
  s_waitcnt lgkmcnt(4)
  v_exp_f32 v208, v104
  v_add_f32 v224, v224, v215
  v_mfma_f32_16x16x32_bf16 a[0:3], a[160:163], v[168:171], a[0:3]
  ds_read_b128 a[128:131], v3 offset:8192
  v_cvt_pk_bf16_f32 v163, v214, v215
  v_exp_f32 v209, v105
  v_mfma_f32_16x16x32_bf16 a[4:7], a[160:163], v[172:175], a[4:7]
  v_exp_f32 v210, v106
  v_mfma_f32_16x16x32_bf16 a[64:67], a[160:163], v[184:187], a[64:67]
  buffer_load_dwordx4 v2, s[48:51], s27 offen offset:1024 sc1 lds
  v_exp_f32 v211, v107
  v_mfma_f32_16x16x32_bf16 a[68:71], a[160:163], v[188:191], a[68:71]
  v_exp_f32 v212, v108
  v_add_f32 v225, v208, v209
  v_mfma_f32_16x16x32_bf16 a[8:11], a[164:167], v[168:171], a[8:11]
  ds_read_b128 a[132:135], v3 offset:9216
  v_exp_f32 v213, v109
  v_mfma_f32_16x16x32_bf16 a[12:15], a[164:167], v[172:175], a[12:15]
  v_exp_f32 v214, v110
  v_cvt_pk_bf16_f32 v164, v208, v209
  v_mfma_f32_16x16x32_bf16 a[72:75], a[164:167], v[184:187], a[72:75]
  v_exp_f32 v215, v111
  v_add_f32 v225, v225, v210
  v_mfma_f32_16x16x32_bf16 a[76:79], a[164:167], v[188:191], a[76:79]
  v_exp_f32 v216, v128
  v_add_f32 v225, v225, v211
  v_mfma_f32_16x16x32_bf16 a[16:19], a[168:171], v[168:171], a[16:19]
  ds_read_b128 a[136:139], v3 offset:10240
  v_exp_f32 v217, v129
  v_mfma_f32_16x16x32_bf16 a[20:23], a[168:171], v[172:175], a[20:23]
  v_exp_f32 v218, v130
  v_cvt_pk_bf16_f32 v165, v210, v211
  v_mfma_f32_16x16x32_bf16 a[80:83], a[168:171], v[184:187], a[80:83]
  v_exp_f32 v219, v131
  v_add_f32 v225, v225, v212
  v_mfma_f32_16x16x32_bf16 a[84:87], a[168:171], v[188:191], a[84:87]
  v_exp_f32 v220, v132
  v_add_f32 v225, v225, v213
  v_mfma_f32_16x16x32_bf16 a[24:27], a[172:175], v[168:171], a[24:27]
  ds_read_b128 a[140:143], v3 offset:11264
  v_exp_f32 v221, v133
  v_mfma_f32_16x16x32_bf16 a[28:31], a[172:175], v[172:175], a[28:31]
  v_exp_f32 v222, v134
  v_cvt_pk_bf16_f32 v166, v212, v213
  v_mfma_f32_16x16x32_bf16 a[88:91], a[172:175], v[184:187], a[88:91]
  buffer_load_dwordx4 v2, s[48:51], s27 offen offset:2048 sc1 lds
  v_exp_f32 v223, v135
  v_mfma_f32_16x16x32_bf16 a[92:95], a[172:175], v[188:191], a[92:95]
  s_waitcnt lgkmcnt(4)
  v_add_f32 v225, v225, v214
  v_add_f32 v225, v225, v215
  v_cvt_pk_bf16_f32 v167, v214, v215
  v_mfma_f32_16x16x32_bf16 a[32:35], a[176:179], v[168:171], a[32:35]
  ds_read_b128 a[144:147], v3 offset:12288
  v_add_f32 v226, v216, v217
  v_cvt_pk_bf16_f32 v176, v216, v217
  v_mfma_f32_16x16x32_bf16 a[36:39], a[176:179], v[172:175], a[36:39]
  v_exp_f32 v216, v136
  v_add_f32 v226, v226, v218
  v_mfma_f32_16x16x32_bf16 a[96:99], a[176:179], v[184:187], a[96:99]
  v_exp_f32 v217, v137
  v_add_f32 v226, v226, v219
  v_mfma_f32_16x16x32_bf16 a[100:103], a[176:179], v[188:191], a[100:103]
  v_cvt_pk_bf16_f32 v177, v218, v219
  v_add_f32 v226, v226, v220
  v_add_f32 v226, v226, v221
  v_cvt_pk_bf16_f32 v178, v220, v221
  v_mfma_f32_16x16x32_bf16 a[40:43], a[180:183], v[168:171], a[40:43]
  ds_read_b128 a[148:151], v3 offset:13312
  v_add_f32 v226, v226, v222
  v_add_f32 v226, v226, v223
  v_mfma_f32_16x16x32_bf16 a[44:47], a[180:183], v[172:175], a[44:47]
  v_exp_f32 v218, v138
  v_cvt_pk_bf16_f32 v179, v222, v223
  v_mfma_f32_16x16x32_bf16 a[104:107], a[180:183], v[184:187], a[104:107]
  v_exp_f32 v219, v139
  v_add_f32 v227, v216, v217
  v_mfma_f32_16x16x32_bf16 a[108:111], a[180:183], v[188:191], a[108:111]
  v_exp_f32 v220, v140
  v_cvt_pk_bf16_f32 v180, v216, v217
  v_mfma_f32_16x16x32_bf16 a[48:51], a[184:187], v[168:171], a[48:51]
  ds_read_b128 a[152:155], v3 offset:14336
  v_add_f32 v227, v227, v218
  v_add_f32 v227, v227, v219
  v_mfma_f32_16x16x32_bf16 a[52:55], a[184:187], v[172:175], a[52:55]
  v_exp_f32 v221, v141
  v_cvt_pk_bf16_f32 v181, v218, v219
  v_mfma_f32_16x16x32_bf16 a[112:115], a[184:187], v[184:187], a[112:115]
  buffer_load_dwordx4 v2, s[48:51], s27 offen offset:3072 sc1 lds
  v_max3_f32 v5, v224, v225, v226
  v_add_f32 v227, v227, v220
  v_mfma_f32_16x16x32_bf16 a[116:119], a[184:187], v[188:191], a[116:119]
  s_add_u32 s27, s27, 16384
  v_exp_f32 v222, v142
  v_add_f32 v227, v227, v221
  v_mfma_f32_16x16x32_bf16 a[56:59], a[188:191], v[168:171], a[56:59]
  s_add_u32 s25, s25, 32768
  ds_read_b128 a[156:159], v3 offset:15360
  v_cvt_pk_bf16_f32 v182, v220, v221
  v_add_f32 v227, v227, v222
  v_mfma_f32_16x16x32_bf16 a[60:63], a[188:191], v[172:175], a[60:63]
  s_and_b32 s25, s25, 0x1ffff
  v_exp_f32 v223, v143
  v_mfma_f32_16x16x32_bf16 a[120:123], a[188:191], v[184:187], a[120:123]
  s_waitcnt lgkmcnt(4)
  v_add_f32 v227, v227, v223
  v_cvt_pk_bf16_f32 v183, v222, v223
  v_max_f32 v5, v5, v227
  v_cmp_lt_f32 vcc, s81, v5
  v_mfma_f32_16x16x32_bf16 a[124:127], a[188:191], v[188:191], a[124:127]
  s_cbranch_vccnz fa_stub4
fa_back4:
  v_add_f32 v228, v228, v224
  v_add_f32 v229, v229, v225
  v_add_f32 v230, v230, v226
  v_add_f32 v231, v231, v227
  v_add_u32 v3, 32768, v3
  v_and_b32 v3, 0x1ffff, v3
fa_AV:
  v_mfma_f32_16x16x32_bf16 v[128:131], a[128:131], v[64:67], v[200:203]
  s_waitcnt vmcnt(12)
  v_exp_f32 v216, v144
  v_mfma_f32_16x16x32_bf16 v[136:139], a[128:131], v[68:71], v[204:207]
  s_barrier
  v_exp_f32 v217, v145
  v_mfma_f32_16x16x32_bf16 v[132:135], a[132:135], v[64:67], v[200:203]
  ds_read_b128 a[160:163], v3 offset:16384
  ds_read_b128 a[164:167], v3 offset:17408
  v_mfma_f32_16x16x32_bf16 v[140:143], a[132:135], v[68:71], v[204:207]
  v_exp_f32 v218, v146
  v_mfma_f32_16x16x32_bf16 v[128:131], a[136:139], v[72:75], v[128:131]
  ds_read_b128 a[168:171], v3 offset:18432
  v_add_f32 v226, v216, v217
  v_mfma_f32_16x16x32_bf16 v[136:139], a[136:139], v[76:79], v[136:139]
  s_mov_b32 m0, s24
  v_exp_f32 v219, v147
  v_mfma_f32_16x16x32_bf16 v[132:135], a[140:143], v[72:75], v[132:135]
  ds_read_b128 a[172:175], v3 offset:19456
  buffer_load_dwordx4 v2, s[44:47], s26 offen offset:0 sc1 lds
  v_mfma_f32_16x16x32_bf16 v[140:143], a[140:143], v[76:79], v[140:143]
  s_waitcnt lgkmcnt(4)
  v_exp_f32 v220, v148
  v_mfma_f32_16x16x32_bf16 v[128:131], a[144:147], v[80:83], v[128:131]
  ds_read_b128 a[176:179], v3 offset:20480
  v_cvt_pk_bf16_f32 v184, v216, v217
  v_mfma_f32_16x16x32_bf16 v[136:139], a[144:147], v[84:87], v[136:139]
  v_exp_f32 v221, v149
  v_mfma_f32_16x16x32_bf16 v[132:135], a[148:151], v[80:83], v[132:135]
  ds_read_b128 a[180:183], v3 offset:21504
  v_add_f32 v226, v226, v218
  v_mfma_f32_16x16x32_bf16 v[140:143], a[148:151], v[84:87], v[140:143]
  v_exp_f32 v222, v150
  v_mfma_f32_16x16x32_bf16 v[128:131], a[152:155], v[88:91], v[128:131]
  ds_read_b128 a[184:187], v3 offset:22528
  v_add_f32 v226, v226, v219
  v_mfma_f32_16x16x32_bf16 v[136:139], a[152:155], v[92:95], v[136:139]
  v_exp_f32 v223, v151
  v_mfma_f32_16x16x32_bf16 v[132:135], a[156:159], v[88:91], v[132:135]
  ds_read_b128 a[188:191], v3 offset:23552
  v_cvt_pk_bf16_f32 v185, v218, v219
  v_mfma_f32_16x16x32_bf16 v[140:143], a[156:159], v[92:95], v[140:143]
  s_waitcnt lgkmcnt(4)
  v_exp_f32 v216, v152
  v_mfma_f32_16x16x32_bf16 a[0:3], a[160:163], v[160:163], a[0:3]
  ds_read_b128 a[128:131], v3 offset:0
  v_add_f32 v226, v226, v220
  v_mfma_f32_16x16x32_bf16 a[4:7], a[160:163], v[164:167], a[4:7]
  v_exp_f32 v217, v153
  v_mfma_f32_16x16x32_bf16 a[64:67], a[160:163], v[176:179], a[64:67]
  buffer_load_dwordx4 v2, s[44:47], s26 offen offset:1024 sc1 lds
  v_add_f32 v226, v226, v221
  v_mfma_f32_16x16x32_bf16 a[68:71], a[160:163], v[180:183], a[68:71]
  v_exp_f32 v218, v154
  v_mfma_f32_16x16x32_bf16 a[8:11], a[164:167], v[160:163], a[8:11]
  ds_read_b128 a[132:135], v3 offset:1024
  v_cvt_pk_bf16_f32 v186, v220, v221
  v_mfma_f32_16x16x32_bf16 a[12:15], a[164:167], v[164:167], a[12:15]
  v_exp_f32 v219, v155
  v_mfma_f32_16x16x32_bf16 a[72:75], a[164:167], v[176:179], a[72:75]
  v_exp_f32 v220, v156
  v_mfma_f32_16x16x32_bf16 a[76:79], a[164:167], v[180:183], a[76:79]
  v_add_f32 v226, v226, v222
  v_add_f32 v226, v226, v223
  v_mfma_f32_16x16x32_bf16 a[16:19], a[168:171], v[160:163], a[16:19]
  ds_read_b128 a[136:139], v3 offset:2048
  v_cvt_pk_bf16_f32 v187, v222, v223
  v_mfma_f32_16x16x32_bf16 a[20:23], a[168:171], v[164:167], a[20:23]
  v_exp_f32 v221, v157
  v_mfma_f32_16x16x32_bf16 a[80:83], a[168:171], v[176:179], a[80:83]
  v_exp_f32 v222, v158
  v_mfma_f32_16x16x32_bf16 a[84:87], a[168:171], v[180:183], a[84:87]
  v_exp_f32 v223, v159
  v_mfma_f32_16x16x32_bf16 a[24:27], a[172:175], v[160:163], a[24:27]
  ds_read_b128 a[140:143], v3 offset:3072
  v_add_f32 v227, v216, v217
  v_mfma_f32_16x16x32_bf16 a[28:31], a[172:175], v[164:167], a[28:31]
  v_cvt_pk_bf16_f32 v188, v216, v217
  v_add_f32 v227, v227, v218
  v_mfma_f32_16x16x32_bf16 a[88:91], a[172:175], v[176:179], a[88:91]
  buffer_load_dwordx4 v2, s[44:47], s26 offen offset:2048 sc1 lds
  v_add_f32 v227, v227, v219
  v_mfma_f32_16x16x32_bf16 a[92:95], a[172:175], v[180:183], a[92:95]
  s_waitcnt lgkmcnt(4)
  v_cvt_pk_bf16_f32 v189, v218, v219
  v_add_f32 v227, v227, v220
  v_mfma_f32_16x16x32_bf16 a[32:35], a[176:179], v[160:163], a[32:35]
  ds_read_b128 a[144:147], v3 offset:4096
  v_add_f32 v227, v227, v221
  v_mfma_f32_16x16x32_bf16 a[36:39], a[176:179], v[164:167], a[36:39]
  v_cvt_pk_bf16_f32 v190, v220, v221
  v_add_f32 v227, v227, v222
  v_mfma_f32_16x16x32_bf16 a[96:99], a[176:179], v[176:179], a[96:99]
  v_add_f32 v227, v227, v223
  v_cvt_pk_bf16_f32 v191, v222, v223
  v_mfma_f32_16x16x32_bf16 a[100:103], a[176:179], v[180:183], a[100:103]
  v_max_f32 v5, v226, v227
  v_cmp_lt_f32 vcc, s81, v5
  v_mfma_f32_16x16x32_bf16 a[40:43], a[180:183], v[160:163], a[40:43]
  ds_read_b128 a[148:151], v3 offset:5120
  v_mfma_f32_16x16x32_bf16 a[44:47], a[180:183], v[164:167], a[44:47]
  v_mfma_f32_16x16x32_bf16 a[104:107], a[180:183], v[176:179], a[104:107]
  v_mfma_f32_16x16x32_bf16 a[108:111], a[180:183], v[180:183], a[108:111]
  v_mfma_f32_16x16x32_bf16 a[48:51], a[184:187], v[160:163], a[48:51]
  ds_read_b128 a[152:155], v3 offset:6144
  v_mfma_f32_16x16x32_bf16 a[52:55], a[184:187], v[164:167], a[52:55]
  v_mfma_f32_16x16x32_bf16 a[112:115], a[184:187], v[176:179], a[112:115]
  buffer_load_dwordx4 v2, s[44:47], s26 offen offset:3072 sc1 lds
  v_mfma_f32_16x16x32_bf16 a[116:119], a[184:187], v[180:183], a[116:119]
  s_add_u32 s26, s26, 16384
  v_mfma_f32_16x16x32_bf16 a[56:59], a[188:191], v[160:163], a[56:59]
  s_add_u32 s24, s24, 32768
  ds_read_b128 a[156:159], v3 offset:7168
  v_mfma_f32_16x16x32_bf16 a[60:63], a[188:191], v[164:167], a[60:63]
  s_and_b32 s24, s24, 0x1ffff
  v_mfma_f32_16x16x32_bf16 a[120:123], a[188:191], v[176:179], a[120:123]
  s_waitcnt lgkmcnt(4)
  v_mfma_f32_16x16x32_bf16 a[124:127], a[188:191], v[180:183], a[124:127]
  s_cbranch_vccnz fa_stub5
fa_back5:
  v_add_f32 v230, v230, v226
  v_add_f32 v231, v231, v227
  v_mfma_f32_16x16x32_bf16 v[144:147], a[128:131], v[64:67], v[200:203]
  ds_read_b128 a[160:163], v3 offset:24576
  v_exp_f32 v216, v128
  v_mfma_f32_16x16x32_bf16 v[152:155], a[128:131], v[68:71], v[204:207]
  v_exp_f32 v217, v129
  v_mfma_f32_16x16x32_bf16 v[148:151], a[132:135], v[64:67], v[200:203]
  ds_read_b128 a[164:167], v3 offset:25600
  v_add_f32 v226, v216, v217
  v_mfma_f32_16x16x32_bf16 v[156:159], a[132:135], v[68:71], v[204:207]
  s_mov_b32 m0, s25
  v_exp_f32 v218, v130
  v_cvt_pk_bf16_f32 v176, v216, v217
  v_mfma_f32_16x16x32_bf16 v[144:147], a[136:139], v[72:75], v[144:147]
  ds_read_b128 a[168:171], v3 offset:26624
  buffer_load_dwordx4 v2, s[48:51], s27 offen offset:0 sc1 lds
  v_mfma_f32_16x16x32_bf16 v[152:155], a[136:139], v[76:79], v[152:155]
  v_exp_f32 v219, v131
  v_add_f32 v226, v226, v218
  v_mfma_f32_16x16x32_bf16 v[148:151], a[140:143], v[72:75], v[148:151]
  ds_read_b128 a[172:175], v3 offset:27648
  v_add_f32 v226, v226, v219
  v_mfma_f32_16x16x32_bf16 v[156:159], a[140:143], v[76:79], v[156:159]
  s_waitcnt lgkmcnt(4)
  v_exp_f32 v220, v132
  v_cvt_pk_bf16_f32 v177, v218, v219
  v_mfma_f32_16x16x32_bf16 v[144:147], a[144:147], v[80:83], v[144:147]
  ds_read_b128 a[176:179], v3 offset:28672
  v_add_f32 v226, v226, v220
  v_mfma_f32_16x16x32_bf16 v[152:155], a[144:147], v[84:87], v[152:155]
  v_exp_f32 v221, v133
  v_exp_f32 v222, v134
  v_mfma_f32_16x16x32_bf16 v[148:151], a[148:151], v[80:83], v[148:151]
  ds_read_b128 a[180:183], v3 offset:29696
  buffer_load_dwordx4 v2, s[48:51], s27 offen offset:1024 sc1 lds
  v_mfma_f32_16x16x32_bf16 v[156:159], a[148:151], v[84:87], v[156:159]
  v_exp_f32 v223, v135
  v_mfma_f32_16x16x32_bf16 v[144:147], a[152:155], v[88:91], v[144:147]
  ds_read_b128 a[184:187], v3 offset:30720
  v_add_f32 v226, v226, v221
  v_mfma_f32_16x16x32_bf16 v[152:155], a[152:155], v[92:95], v[152:155]
  v_exp_f32 v216, v136
  v_mfma_f32_16x16x32_bf16 v[148:151], a[156:159], v[88:91], v[148:151]
  ds_read_b128 a[188:191], v3 offset:31744
  v_cvt_pk_bf16_f32 v178, v220, v221
  v_add_f32 v226, v226, v222
  v_mfma_f32_16x16x32_bf16 v[156:159], a[156:159], v[92:95], v[156:159]
  s_waitcnt lgkmcnt(4)
  v_exp_f32 v217, v137
  v_mfma_f32_16x16x32_bf16 a[64:67], a[160:163], v[184:187], a[64:67]
  ds_read_b128 a[128:131], v3 offset:8192
  v_add_f32 v226, v226, v223
  v_cvt_pk_bf16_f32 v179, v222, v223
  v_mfma_f32_16x16x32_bf16 a[68:71], a[160:163], v[188:191], a[68:71]
  v_exp_f32 v218, v138
  v_mfma_f32_16x16x32_bf16 a[72:75], a[164:167], v[184:187], a[72:75]
  ds_read_b128 a[132:135], v3 offset:9216
  buffer_load_dwordx4 v2, s[48:51], s27 offen offset:2048 sc1 lds
  v_add_f32 v227, v216, v217
  v_mfma_f32_16x16x32_bf16 a[76:79], a[164:167], v[188:191], a[76:79]
  v_exp_f32 v219, v139
  v_mfma_f32_16x16x32_bf16 a[80:83], a[168:171], v[184:187], a[80:83]
  ds_read_b128 a[136:139], v3 offset:10240
  v_cvt_pk_bf16_f32 v180, v216, v217
  v_mfma_f32_16x16x32_bf16 a[84:87], a[168:171], v[188:191], a[84:87]
  v_exp_f32 v220, v140
  v_add_f32 v227, v227, v218
  v_mfma_f32_16x16x32_bf16 a[88:91], a[172:175], v[184:187], a[88:91]
  ds_read_b128 a[140:143], v3 offset:11264
  v_add_f32 v227, v227, v219
  v_mfma_f32_16x16x32_bf16 a[92:95], a[172:175], v[188:191], a[92:95]
  s_waitcnt lgkmcnt(4)
  v_exp_f32 v221, v141
  v_cvt_pk_bf16_f32 v181, v218, v219
  v_mfma_f32_16x16x32_bf16 a[96:99], a[176:179], v[184:187], a[96:99]
  ds_read_b128 a[144:147], v3 offset:12288
  buffer_load_dwordx4 v2, s[48:51], s27 offen offset:3072 sc1 lds
  v_mfma_f32_16x16x32_bf16 a[100:103], a[176:179], v[188:191], a[100:103]
  s_add_u32 s27, s27, 16384
  v_exp_f32 v222, v142
  v_add_f32 v227, v227, v220
  v_mfma_f32_16x16x32_bf16 a[104:107], a[180:183], v[184:187], a[104:107]
  s_add_u32 s25, s25, 32768
  ds_read_b128 a[148:151], v3 offset:13312
  v_add_f32 v227, v227, v221
  v_mfma_f32_16x16x32_bf16 a[108:111], a[180:183], v[188:191], a[108:111]
  s_and_b32 s25, s25, 0x1ffff
  v_exp_f32 v223, v143
  v_cvt_pk_bf16_f32 v182, v220, v221
  v_mfma_f32_16x16x32_bf16 a[112:115], a[184:187], v[184:187], a[112:115]
  ds_read_b128 a[152:155], v3 offset:14336
  v_add_f32 v227, v227, v222
  v_mfma_f32_16x16x32_bf16 a[116:119], a[184:187], v[188:191], a[116:119]
  v_add_f32 v227, v227, v223
  v_cvt_pk_bf16_f32 v183, v222, v223
  v_max_f32 v5, v226, v227
  v_mfma_f32_16x16x32_bf16 a[120:123], a[188:191], v[184:187], a[120:123]
  s_waitcnt lgkmcnt(3)
  ds_read_b128 a[156:159], v3 offset:15360
  v_cmp_lt_f32 vcc, s81, v5
  v_mfma_f32_16x16x32_bf16 a[124:127], a[188:191], v[188:191], a[124:127]
  s_cbranch_vccnz fa_stub6
fa_back6:
  v_add_f32 v230, v230, v226
  v_add_f32 v231, v231, v227
  v_add_u32 v3, 32768, v3
  v_and_b32 v3, 0x1ffff, v3
  s_branch fa_SSpre
fa_Aodd:
  v_mfma_f32_16x16x32_bf16 v[128:131], a[128:131], v[64:67], v[200:203]
  s_waitcnt vmcnt(12)
  v_cndmask_b32 v112, v4, v112, s[68:69]
  v_cndmask_b32 v113, v4, v113, s[70:71]
  v_cndmask_b32 v114, v4, v114, s[72:73]
  v_mfma_f32_16x16x32_bf16 v[136:139], a[128:131], v[68:71], v[204:207]
  s_barrier
  v_cndmask_b32 v115, v4, v115, s[74:75]
  v_mov_b32 v116, v4
  v_mov_b32 v117, v4
  v_mfma_f32_16x16x32_bf16 v[132:135], a[132:135], v[64:67], v[200:203]
  ds_read_b128 a[160:163], v3 offset:16384
  ds_read_b128 a[164:167], v3 offset:17408
  v_mov_b32 v118, v4
  v_mfma_f32_16x16x32_bf16 v[140:143], a[132:135], v[68:71], v[204:207]
  v_mov_b32 v119, v4
  v_cndmask_b32 v124, v4, v124, s[68:69]
  v_cndmask_b32 v125, v4, v125, s[70:71]
  v_mfma_f32_16x16x32_bf16 v[128:131], a[136:139], v[72:75], v[128:131]
  ds_read_b128 a[168:171], v3 offset:18432
  v_cndmask_b32 v126, v4, v126, s[72:73]
  v_cndmask_b32 v127, v4, v127, s[74:75]
  v_mfma_f32_16x16x32_bf16 v[136:139], a[136:139], v[76:79], v[136:139]
  s_mov_b32 m0, s24
  v_exp_f32 v208, v112
  v_exp_f32 v209, v113
  v_mfma_f32_16x16x32_bf16 v[132:135], a[140:143], v[72:75], v[132:135]
  ds_read_b128 a[172:175], v3 offset:19456
  buffer_load_dwordx4 v2, s[44:47], s26 offen offset:0 sc1 lds
  v_mfma_f32_16x16x32_bf16 v[140:143], a[140:143], v[76:79], v[140:143]
  s_waitcnt lgkmcnt(4)
  v_exp_f32 v210, v114
  v_add_f32 v224, v208, v209
  v_mfma_f32_16x16x32_bf16 v[128:131], a[144:147], v[80:83], v[128:131]
  ds_read_b128 a[176:179], v3 offset:20480
  v_exp_f32 v211, v115
  v_mfma_f32_16x16x32_bf16 v[136:139], a[144:147], v[84:87], v[136:139]
  v_exp_f32 v212, v116
  v_cvt_pk_bf16_f32 v168, v208, v209
  v_mfma_f32_16x16x32_bf16 v[132:135], a[148:151], v[80:83], v[132:135]
  ds_read_b128 a[180:183], v3 offset:21504
  v_exp_f32 v213, v117
  v_mfma_f32_16x16x32_bf16 v[140:143], a[148:151], v[84:87], v[140:143]
  v_exp_f32 v214, v118
  v_add_f32 v224, v224, v210
  v_add_f32 v224, v224, v211
  v_mfma_f32_16x16x32_bf16 v[128:131], a[152:155], v[88:91], v[128:131]
  ds_read_b128 a[184:187], v3 offset:22528
  v_cvt_pk_bf16_f32 v169, v210, v211
  v_add_f32 v224, v224, v212
  v_mfma_f32_16x16x32_bf16 v[136:139], a[152:155], v[92:95], v[136:139]
  v_exp_f32 v215, v119
  v_add_f32 v224, v224, v213
  v_mfma_f32_16x16x32_bf16 v[132:135], a[156:159], v[88:91], v[132:135]
  ds_read_b128 a[188:191], v3 offset:23552
  v_cvt_pk_bf16_f32 v170, v212, v213
  v_add_f32 v224, v224, v214
  v_mfma_f32_16x16x32_bf16 v[140:143], a[156:159], v[92:95], v[140:143]
  s_waitcnt lgkmcnt(4)
  v_exp_f32 v208, v120
  v_add_f32 v224, v224, v215
  v_mfma_f32_16x16x32_bf16 a[0:3], a[160:163], v[160:163], a[0:3]
  ds_read_b128 a[128:131], v3 offset:0
  v_cvt_pk_bf16_f32 v171, v214, v215
  v_exp_f32 v209, v121
  v_mfma_f32_16x16x32_bf16 a[4:7], a[160:163], v[164:167], a[4:7]
  v_exp_f32 v210, v122
  v_mfma_f32_16x16x32_bf16 a[64:67], a[160:163], v[176:179], a[64:67]
  buffer_load_dwordx4 v2, s[44:47], s26 offen offset:1024 sc1 lds
  v_exp_f32 v211, v123
  v_mfma_f32_16x16x32_bf16 a[68:71], a[160:163], v[180:183], a[68:71]
  v_exp_f32 v212, v124
  v_add_f32 v225, v208, v209
  v_mfma_f32_16x16x32_bf16 a[8:11], a[164:167], v[160:163], a[8:11]
  ds_read_b128 a[132:135], v3 offset:1024
  v_exp_f32 v213, v125
  v_mfma_f32_16x16x32_bf16 a[12:15], a[164:167], v[164:167], a[12:15]
  v_exp_f32 v214, v126
  v_cvt_pk_bf16_f32 v172, v208, v209
  v_mfma_f32_16x16x32_bf16 a[72:75], a[164:167], v[176:179], a[72:75]
  v_exp_f32 v215, v127
  v_add_f32 v225, v225, v210
  v_mfma_f32_16x16x32_bf16 a[76:79], a[164:167], v[180:183], a[76:79]
  v_exp_f32 v216, v144
  v_add_f32 v225, v225, v211
  v_mfma_f32_16x16x32_bf16 a[16:19], a[168:171], v[160:163], a[16:19]
  ds_read_b128 a[136:139], v3 offset:2048
  v_exp_f32 v217, v145
  v_mfma_f32_16x16x32_bf16 a[20:23], a[168:171], v[164:167], a[20:23]
  v_exp_f32 v218, v146
  v_cvt_pk_bf16_f32 v173, v210, v211
  v_mfma_f32_16x16x32_bf16 a[80:83], a[168:171], v[176:179], a[80:83]
  v_exp_f32 v219, v147
  v_add_f32 v225, v225, v212
  v_mfma_f32_16x16x32_bf16 a[84:87], a[168:171], v[180:183], a[84:87]
  v_exp_f32 v220, v148
  v_add_f32 v225, v225, v213
  v_mfma_f32_16x16x32_bf16 a[24:27], a[172:175], v[160:163], a[24:27]
  ds_read_b128 a[140:143], v3 offset:3072
  v_exp_f32 v221, v149
  v_mfma_f32_16x16x32_bf16 a[28:31], a[172:175], v[164:167], a[28:31]
  v_exp_f32 v222, v150
  v_cvt_pk_bf16_f32 v174, v212, v213
  v_mfma_f32_16x16x32_bf16 a[88:91], a[172:175], v[176:179], a[88:91]
  buffer_load_dwordx4 v2, s[44:47], s26 offen offset:2048 sc1 lds
  v_exp_f32 v223, v151
  v_mfma_f32_16x16x32_bf16 a[92:95], a[172:175], v[180:183], a[92:95]
  s_waitcnt lgkmcnt(4)
  v_add_f32 v225, v225, v214
  v_add_f32 v225, v225, v215
  v_cvt_pk_bf16_f32 v175, v214, v215
  v_mfma_f32_16x16x32_bf16 a[32:35], a[176:179], v[160:163], a[32:35]
  ds_read_b128 a[144:147], v3 offset:4096
  v_add_f32 v226, v216, v217
  v_cvt_pk_bf16_f32 v184, v216, v217
  v_mfma_f32_16x16x32_bf16 a[36:39], a[176:179], v[164:167], a[36:39]
  v_exp_f32 v216, v152
  v_add_f32 v226, v226, v218
  v_mfma_f32_16x16x32_bf16 a[96:99], a[176:179], v[176:179], a[96:99]
  v_exp_f32 v217, v153
  v_add_f32 v226, v226, v219
  v_mfma_f32_16x16x32_bf16 a[100:103], a[176:179], v[180:183], a[100:103]
  v_cvt_pk_bf16_f32 v185, v218, v219
  v_add_f32 v226, v226, v220
  v_add_f32 v226, v226, v221
  v_cvt_pk_bf16_f32 v186, v220, v221
  v_mfma_f32_16x16x32_bf16 a[40:43], a[180:183], v[160:163], a[40:43]
  ds_read_b128 a[148:151], v3 offset:5120
  v_add_f32 v226, v226, v222
  v_add_f32 v226, v226, v223
  v_mfma_f32_16x16x32_bf16 a[44:47], a[180:183], v[164:167], a[44:47]
  v_exp_f32 v218, v154
  v_cvt_pk_bf16_f32 v187, v222, v223
  v_mfma_f32_16x16x32_bf16 a[104:107], a[180:183], v[176:179], a[104:107]
  v_exp_f32 v219, v155
  v_add_f32 v227, v216, v217
  v_mfma_f32_16x16x32_bf16 a[108:111], a[180:183], v[180:183], a[108:111]
  v_exp_f32 v220, v156
  v_cvt_pk_bf16_f32 v188, v216, v217
  v_mfma_f32_16x16x32_bf16 a[48:51], a[184:187], v[160:163], a[48:51]
  ds_read_b128 a[152:155], v3 offset:6144
  v_add_f32 v227, v227, v218
  v_add_f32 v227, v227, v219
  v_mfma_f32_16x16x32_bf16 a[52:55], a[184:187], v[164:167], a[52:55]
  v_exp_f32 v221, v157
  v_cvt_pk_bf16_f32 v189, v218, v219
  v_mfma_f32_16x16x32_bf16 a[112:115], a[184:187], v[176:179], a[112:115]
  buffer_load_dwordx4 v2, s[44:47], s26 offen offset:3072 sc1 lds
  v_max3_f32 v5, v224, v225, v226
  v_add_f32 v227, v227, v220
  v_mfma_f32_16x16x32_bf16 a[116:119], a[184:187], v[180:183], a[116:119]
  s_add_u32 s26, s26, 16384
  v_exp_f32 v222, v158
  v_add_f32 v227, v227, v221
  v_mfma_f32_16x16x32_bf16 a[56:59], a[188:191], v[160:163], a[56:59]
  s_add_u32 s24, s24, 32768
  ds_read_b128 a[156:159], v3 offset:7168
  v_cvt_pk_bf16_f32 v190, v220, v221
  v_add_f32 v227, v227, v222
  v_mfma_f32_16x16x32_bf16 a[60:63], a[188:191], v[164:167], a[60:63]
  s_and_b32 s24, s24, 0x1ffff
  v_exp_f32 v223, v159
  v_mfma_f32_16x16x32_bf16 a[120:123], a[188:191], v[176:179], a[120:123]
  s_waitcnt lgkmcnt(4)
  v_add_f32 v227, v227, v223
  v_cvt_pk_bf16_f32 v191, v222, v223
  v_max_f32 v5, v5, v227
  v_cmp_lt_f32 vcc, s81, v5
  v_mfma_f32_16x16x32_bf16 a[124:127], a[188:191], v[180:183], a[124:127]
  s_cbranch_vccnz fa_stub7
fa_back7:
  v_add_f32 v228, v228, v224
  v_add_f32 v229, v229, v225
  v_add_f32 v230, v230, v226
  v_add_f32 v231, v231, v227
  v_mfma_f32_16x16x32_bf16 v[144:147], a[128:131], v[64:67], v[200:203]
  ds_read_b128 a[160:163], v3 offset:24576
  v_exp_f32 v216, v128
  v_mfma_f32_16x16x32_bf16 v[152:155], a[128:131], v[68:71], v[204:207]
  v_exp_f32 v217, v129
  v_mfma_f32_16x16x32_bf16 v[148:151], a[132:135], v[64:67], v[200:203]
  ds_read_b128 a[164:167], v3 offset:25600
  v_mfma_f32_16x16x32_bf16 v[156:159], a[132:135], v[68:71], v[204:207]
  v_exp_f32 v218, v130
  v_mfma_f32_16x16x32_bf16 v[144:147], a[136:139], v[72:75], v[144:147]
  ds_read_b128 a[168:171], v3 offset:26624
  v_add_f32 v226, v216, v217
  v_mfma_f32_16x16x32_bf16 v[152:155], a[136:139], v[76:79], v[152:155]
  s_mov_b32 m0, s25
  v_exp_f32 v219, v131
  v_mfma_f32_16x16x32_bf16 v[148:151], a[140:143], v[72:75], v[148:151]
  ds_read_b128 a[172:175], v3 offset:27648
  buffer_load_dwordx4 v2, s[48:51], s27 offen offset:0 sc1 lds
  v_mfma_f32_16x16x32_bf16 v[156:159], a[140:143], v[76:79], v[156:159]
  s_waitcnt lgkmcnt(4)
  v_exp_f32 v220, v132
  v_mfma_f32_16x16x32_bf16 v[144:147], a[144:147], v[80:83], v[144:147]
  ds_read_b128 a[176:179], v3 offset:28672
  v_cvt_pk_bf16_f32 v176, v216, v217
  v_mfma_f32_16x16x32_bf16 v[152:155], a[144:147], v[84:87], v[152:155]
  v_exp_f32 v221, v133
  v_mfma_f32_16x16x32_bf16 v[148:151], a[148:151], v[80:83], v[148:151]
  ds_read_b128 a[180:183], v3 offset:29696
  v_add_f32 v226, v226, v218
  v_mfma_f32_16x16x32_bf16 v[156:159], a[148:151], v[84:87], v[156:159]
  v_exp_f32 v222, v134
  v_mfma_f32_16x16x32_bf16 v[144:147], a[152:155], v[88:91], v[144:147]
  ds_read_b128 a[184:187], v3 offset:30720
  v_add_f32 v226, v226, v219
  v_mfma_f32_16x16x32_bf16 v[152:155], a[152:155], v[92:95], v[152:155]
  v_exp_f32 v223, v135
  v_mfma_f32_16x16x32_bf16 v[148:151], a[156:159], v[88:91], v[148:151]
  ds_read_b128 a[188:191], v3 offset:31744
  v_cvt_pk_bf16_f32 v177, v218, v219
  v_mfma_f32_16x16x32_bf16 v[156:159], a[156:159], v[92:95], v[156:159]
  s_waitcnt lgkmcnt(4)
  v_exp_f32 v216, v136
  v_mfma_f32_16x16x32_bf16 a[0:3], a[160:163], v[168:171], a[0:3]
  ds_read_b128 a[128:131], v3 offset:8192
  v_add_f32 v226, v226, v220
  v_mfma_f32_16x16x32_bf16 a[4:7], a[160:163], v[172:175], a[4:7]
  v_exp_f32 v217, v137
  v_mfma_f32_16x16x32_bf16 a[64:67], a[160:163], v[184:187], a[64:67]
  buffer_load_dwordx4 v2, s[48:51], s27 offen offset:1024 sc1 lds
  v_add_f32 v226, v226, v221
  v_mfma_f32_16x16x32_bf16 a[68:71], a[160:163], v[188:191], a[68:71]
  v_exp_f32 v218, v138
  v_mfma_f32_16x16x32_bf16 a[8:11], a[164:167], v[168:171], a[8:11]
  ds_read_b128 a[132:135], v3 offset:9216
  v_cvt_pk_bf16_f32 v178, v220, v221
  v_mfma_f32_16x16x32_bf16 a[12:15], a[164:167], v[172:175], a[12:15]
  v_exp_f32 v219, v139
  v_mfma_f32_16x16x32_bf16 a[72:75], a[164:167], v[184:187], a[72:75]
  v_exp_f32 v220, v140
  v_mfma_f32_16x16x32_bf16 a[76:79], a[164:167], v[188:191], a[76:79]
  v_add_f32 v226, v226, v222
  v_add_f32 v226, v226, v223
  v_mfma_f32_16x16x32_bf16 a[16:19], a[168:171], v[168:171], a[16:19]
  ds_read_b128 a[136:139], v3 offset:10240
  v_cvt_pk_bf16_f32 v179, v222, v223
  v_mfma_f32_16x16x32_bf16 a[20:23], a[168:171], v[172:175], a[20:23]
  v_exp_f32 v221, v141
  v_mfma_f32_16x16x32_bf16 a[80:83], a[168:171], v[184:187], a[80:83]
  v_exp_f32 v222, v142
  v_mfma_f32_16x16x32_bf16 a[84:87], a[168:171], v[188:191], a[84:87]
  v_exp_f32 v223, v143
  v_mfma_f32_16x16x32_bf16 a[24:27], a[172:175], v[168:171], a[24:27]
  ds_read_b128 a[140:143], v3 offset:11264
  v_add_f32 v227, v216, v217
  v_mfma_f32_16x16x32_bf16 a[28:31], a[172:175], v[172:175], a[28:31]
  v_cvt_pk_bf16_f32 v180, v216, v217
  v_add_f32 v227, v227, v218
  v_mfma_f32_16x16x32_bf16 a[88:91], a[172:175], v[184:187], a[88:91]
  buffer_load_dwordx4 v2, s[48:51], s27 offen offset:2048 sc1 lds
  v_add_f32 v227, v227, v219
  v_mfma_f32_16x16x32_bf16 a[92:95], a[172:175], v[188:191], a[92:95]
  s_waitcnt lgkmcnt(4)
  v_cvt_pk_bf16_f32 v181, v218, v219
  v_add_f32 v227, v227, v220
  v_mfma_f32_16x16x32_bf16 a[32:35], a[176:179], v[168:171], a[32:35]
  ds_read_b128 a[144:147], v3 offset:12288
  v_add_f32 v227, v227, v221
  v_mfma_f32_16x16x32_bf16 a[36:39], a[176:179], v[172:175], a[36:39]
  v_cvt_pk_bf16_f32 v182, v220, v221
  v_add_f32 v227, v227, v222
  v_mfma_f32_16x16x32_bf16 a[96:99], a[176:179], v[184:187], a[96:99]
  v_add_f32 v227, v227, v223
  v_cvt_pk_bf16_f32 v183, v222, v223
  v_mfma_f32_16x16x32_bf16 a[100:103], a[176:179], v[188:191], a[100:103]
  v_max_f32 v5, v226, v227
  v_cmp_lt_f32 vcc, s81, v5
  v_mfma_f32_16x16x32_bf16 a[40:43], a[180:183], v[168:171], a[40:43]
  ds_read_b128 a[148:151], v3 offset:13312
  v_mfma_f32_16x16x32_bf16 a[44:47], a[180:183], v[172:175], a[44:47]
  v_mfma_f32_16x16x32_bf16 a[104:107], a[180:183], v[184:187], a[104:107]
  v_mfma_f32_16x16x32_bf16 a[108:111], a[180:183], v[188:191], a[108:111]
  v_mfma_f32_16x16x32_bf16 a[48:51], a[184:187], v[168:171], a[48:51]
  ds_read_b128 a[152:155], v3 offset:14336
  v_mfma_f32_16x16x32_bf16 a[52:55], a[184:187], v[172:175], a[52:55]
  v_mfma_f32_16x16x32_bf16 a[112:115], a[184:187], v[184:187], a[112:115]
  buffer_load_dwordx4 v2, s[48:51], s27 offen offset:3072 sc1 lds
  v_mfma_f32_16x16x32_bf16 a[116:119], a[184:187], v[188:191], a[116:119]
  s_add_u32 s27, s27, 16384
  v_mfma_f32_16x16x32_bf16 a[56:59], a[188:191], v[168:171], a[56:59]
  s_add_u32 s25, s25, 32768
  ds_read_b128 a[156:159], v3 offset:15360
  v_mfma_f32_16x16x32_bf16 a[60:63], a[188:191], v[172:175], a[60:63]
  s_and_b32 s25, s25, 0x1ffff
  v_mfma_f32_16x16x32_bf16 a[120:123], a[188:191], v[184:187], a[120:123]
  s_waitcnt lgkmcnt(4)
  v_mfma_f32_16x16x32_bf16 a[124:127], a[188:191], v[188:191], a[124:127]
  s_cbranch_vccnz fa_stub8
fa_back8:
  v_add_f32 v230, v230, v226
  v_add_f32 v231, v231, v227
  v_add_u32 v3, 32768, v3
  v_and_b32 v3, 0x1ffff, v3
fa_SSpre:
  s_mov_b32 s11, 1
  s_cmp_lg_u32 s12, 0
  s_cselect_b32 s32, s15, s32
  s_cmp_eq_u32 s29, 0
  s_cbranch_scc1 fa_Bexit
.p2align 6
fa_SS:
  v_mfma_f32_16x16x32_bf16 v[128:131], a[128:131], v[64:67], v[200:203]
  s_waitcnt vmcnt(12)
  v_exp_f32 v216, v144
  v_mfma_f32_16x16x32_bf16 v[136:139], a[128:131], v[68:71], v[204:207]
  s_barrier
  v_exp_f32 v217, v145
  v_exp_f32 v218, v146
  v_mfma_f32_16x16x32_bf16 v[132:135], a[132:135], v[64:67], v[200:203]
  s_cmp_ge_u32 s26, s32
  ds_read_b128 a[160:163], v3 offset:16384
  ds_read_b128 a[164:167], v3 offset:17408
  v_mfma_f32_16x16x32_bf16 v[140:143], a[132:135], v[68:71], v[204:207]
  s_cbranch_scc1 fa_hk2
fa_hb2:
  s_mov_b32 m0, s24
  v_exp_f32 v219, v147
  v_mfma_f32_16x16x32_bf16 v[128:131], a[136:139], v[72:75], v[128:131]
  ds_read_b128 a[168:171], v3 offset:18432
  buffer_load_dwordx4 v2, s[44:47], s26 offen offset:0 sc1 lds
  v_mfma_f32_16x16x32_bf16 v[136:139], a[136:139], v[76:79], v[136:139]
  v_exp_f32 v220, v148
  v_add_f32 v226, v216, v217
  v_mfma_f32_16x16x32_bf16 v[132:135], a[140:143], v[72:75], v[132:135]
  ds_read_b128 a[172:175], v3 offset:19456
  v_cvt_pk_bf16_f32 v184, v216, v217
  v_mfma_f32_16x16x32_bf16 v[140:143], a[140:143], v[76:79], v[140:143]
  s_waitcnt lgkmcnt(4)
  v_exp_f32 v221, v149
  v_add_f32 v226, v226, v218
  v_mfma_f32_16x16x32_bf16 v[128:131], a[144:147], v[80:83], v[128:131]
  ds_read_b128 a[176:179], v3 offset:20480
  v_add_f32 v226, v226, v219
  v_mfma_f32_16x16x32_bf16 v[136:139], a[144:147], v[84:87], v[136:139]
  v_exp_f32 v222, v150
  v_cvt_pk_bf16_f32 v185, v218, v219
  v_mfma_f32_16x16x32_bf16 v[132:135], a[148:151], v[80:83], v[132:135]
  ds_read_b128 a[180:183], v3 offset:21504
  buffer_load_dwordx4 v2, s[44:47], s26 offen offset:1024 sc1 lds
  v_mfma_f32_16x16x32_bf16 v[140:143], a[148:151], v[84:87], v[140:143]
  v_exp_f32 v223, v151
  v_mfma_f32_16x16x32_bf16 v[128:131], a[152:155], v[88:91], v[128:131]
  ds_read_b128 a[184:187], v3 offset:22528
  v_add_f32 v226, v226, v220
  v_add_f32 v226, v226, v221
  v_mfma_f32_16x16x32_bf16 v[136:139], a[152:155], v[92:95], v[136:139]
  v_exp_f32 v216, v152
  v_mfma_f32_16x16x32_bf16 v[132:135], a[156:159], v[88:91], v[132:135]
  ds_read_b128 a[188:191], v3 offset:23552
  v_cvt_pk_bf16_f32 v186, v220, v221
  v_add_f32 v226, v226, v222
  v_mfma_f32_16x16x32_bf16 v[140:143], a[156:159], v[92:95], v[140:143]
  s_waitcnt lgkmcnt(4)
  v_exp_f32 v217, v153
  v_mfma_f32_16x16x32_bf16 a[64:67], a[160:163], v[176:179], a[64:67]
  ds_read_b128 a[128:131], v3 offset:0
  v_add_f32 v226, v226, v223
  v_cvt_pk_bf16_f32 v187, v222, v223
  v_mfma_f32_16x16x32_bf16 a[68:71], a[160:163], v[180:183], a[68:71]
  v_exp_f32 v218, v154
  v_mfma_f32_16x16x32_bf16 a[72:75], a[164:167], v[176:179], a[72:75]
  ds_read_b128 a[132:135], v3 offset:1024
  buffer_load_dwordx4 v2, s[44:47], s26 offen offset:2048 sc1 lds
  v_add_f32 v227, v216, v217
  v_mfma_f32_16x16x32_bf16 a[76:79], a[164:167], v[180:183], a[76:79]
  v_exp_f32 v219, v155
  v_mfma_f32_16x16x32_bf16 a[80:83], a[168:171], v[176:179], a[80:83]
  ds_read_b128 a[136:139], v3 offset:2048
  v_cvt_pk_bf16_f32 v188, v216, v217
  v_mfma_f32_16x16x32_bf16 a[84:87], a[168:171], v[180:183], a[84:87]
  v_exp_f32 v220, v156
  v_add_f32 v227, v227, v218
  v_mfma_f32_16x16x32_bf16 a[88:91], a[172:175], v[176:179], a[88:91]
  ds_read_b128 a[140:143], v3 offset:3072
  v_add_f32 v227, v227, v219
  v_mfma_f32_16x16x32_bf16 a[92:95], a[172:175], v[180:183], a[92:95]
  s_waitcnt lgkmcnt(4)
  v_exp_f32 v221, v157
  v_cvt_pk_bf16_f32 v189, v218, v219
  v_mfma_f32_16x16x32_bf16 a[96:99], a[176:179], v[176:179], a[96:99]
  ds_read_b128 a[144:147], v3 offset:4096
  buffer_load_dwordx4 v2, s[44:47], s26 offen offset:3072 sc1 lds
  v_mfma_f32_16x16x32_bf16 a[100:103], a[176:179], v[180:183], a[100:103]
  s_add_u32 s26, s26, 16384
  v_exp_f32 v222, v158
  v_add_f32 v227, v227, v220
  v_mfma_f32_16x16x32_bf16 a[104:107], a[180:183], v[176:179], a[104:107]
  s_add_u32 s24, s24, 32768
  ds_read_b128 a[148:151], v3 offset:5120
  v_add_f32 v227, v227, v221
  v_mfma_f32_16x16x32_bf16 a[108:111], a[180:183], v[180:183], a[108:111]
  s_and_b32 s24, s24, 0x1ffff
  v_exp_f32 v223, v159
  v_cvt_pk_bf16_f32 v190, v220, v221
  v_mfma_f32_16x16x32_bf16 a[112:115], a[184:187], v[176:179], a[112:115]
  ds_read_b128 a[152:155], v3 offset:6144
  v_add_f32 v227, v227, v222
  v_mfma_f32_16x16x32_bf16 a[116:119], a[184:187], v[180:183], a[116:119]
  v_add_f32 v227, v227, v223
  v_cvt_pk_bf16_f32 v191, v222, v223
  v_max_f32 v5, v226, v227
  v_mfma_f32_16x16x32_bf16 a[120:123], a[188:191], v[176:179], a[120:123]
  s_waitcnt lgkmcnt(3)
  ds_read_b128 a[156:159], v3 offset:7168
  v_cmp_lt_f32 vcc, s81, v5
  v_mfma_f32_16x16x32_bf16 a[124:127], a[188:191], v[180:183], a[124:127]
  s_cbranch_vccnz fa_stub9
fa_back9:
  v_add_f32 v230, v230, v226
  v_add_f32 v231, v231, v227
  v_mfma_f32_16x16x32_bf16 v[144:147], a[128:131], v[64:67], v[200:203]
  ds_read_b128 a[160:163], v3 offset:24576
  v_exp_f32 v216, v128
  v_mfma_f32_16x16x32_bf16 v[152:155], a[128:131], v[68:71], v[204:207]
  v_exp_f32 v217, v129
  v_mfma_f32_16x16x32_bf16 v[148:151], a[132:135], v[64:67], v[200:203]
  ds_read_b128 a[164:167], v3 offset:25600
  v_add_f32 v226, v216, v217
  v_mfma_f32_16x16x32_bf16 v[156:159], a[132:135], v[68:71], v[204:207]
  s_mov_b32 m0, s25
  v_exp_f32 v218, v130
  v_cvt_pk_bf16_f32 v176, v216, v217
  v_mfma_f32_16x16x32_bf16 v[144:147], a[136:139], v[72:75], v[144:147]
  ds_read_b128 a[168:171], v3 offset:26624
  buffer_load_dwordx4 v2, s[48:51], s27 offen offset:0 sc1 lds
  v_mfma_f32_16x16x32_bf16 v[152:155], a[136:139], v[76:79], v[152:155]
  v_exp_f32 v219, v131
  v_add_f32 v226, v226, v218
  v_mfma_f32_16x16x32_bf16 v[148:151], a[140:143], v[72:75], v[148:151]
  ds_read_b128 a[172:175], v3 offset:27648
  v_add_f32 v226, v226, v219
  v_mfma_f32_16x16x32_bf16 v[156:159], a[140:143], v[76:79], v[156:159]
  s_waitcnt lgkmcnt(4)
  v_exp_f32 v220, v132
  v_cvt_pk_bf16_f32 v177, v218, v219
  v_mfma_f32_16x16x32_bf16 v[144:147], a[144:147], v[80:83], v[144:147]
  ds_read_b128 a[176:179], v3 offset:28672
  v_add_f32 v226, v226, v220
  v_mfma_f32_16x16x32_bf16 v[152:155], a[144:147], v[84:87], v[152:155]
  v_exp_f32 v221, v133
  v_exp_f32 v222, v134
  v_mfma_f32_16x16x32_bf16 v[148:151], a[148:151], v[80:83], v[148:151]
  ds_read_b128 a[180:183], v3 offset:29696
  buffer_load_dwordx4 v2, s[48:51], s27 offen offset:1024 sc1 lds
  v_mfma_f32_16x16x32_bf16 v[156:159], a[148:151], v[84:87], v[156:159]
  v_exp_f32 v223, v135
  v_mfma_f32_16x16x32_bf16 v[144:147], a[152:155], v[88:91], v[144:147]
  ds_read_b128 a[184:187], v3 offset:30720
  v_add_f32 v226, v226, v221
  v_mfma_f32_16x16x32_bf16 v[152:155], a[152:155], v[92:95], v[152:155]
  v_exp_f32 v216, v136
  v_mfma_f32_16x16x32_bf16 v[148:151], a[156:159], v[88:91], v[148:151]
  ds_read_b128 a[188:191], v3 offset:31744
  v_cvt_pk_bf16_f32 v178, v220, v221
  v_add_f32 v226, v226, v222
  v_mfma_f32_16x16x32_bf16 v[156:159], a[156:159], v[92:95], v[156:159]
  s_waitcnt lgkmcnt(4)
  v_exp_f32 v217, v137
  v_mfma_f32_16x16x32_bf16 a[64:67], a[160:163], v[184:187], a[64:67]
  ds_read_b128 a[128:131], v3 offset:8192
  v_add_f32 v226, v226, v223
  v_cvt_pk_bf16_f32 v179, v222, v223
  v_mfma_f32_16x16x32_bf16 a[68:71], a[160:163], v[188:191], a[68:71]
  v_exp_f32 v218, v138
  v_mfma_f32_16x16x32_bf16 a[72:75], a[164:167], v[184:187], a[72:75]
  ds_read_b128 a[132:135], v3 offset:9216
  buffer_load_dwordx4 v2, s[48:51], s27 offen offset:2048 sc1 lds
  v_add_f32 v227, v216, v217
  v_mfma_f32_16x16x32_bf16 a[76:79], a[164:167], v[188:191], a[76:79]
  v_exp_f32 v219, v139
  v_mfma_f32_16x16x32_bf16 a[80:83], a[168:171], v[184:187], a[80:83]
  ds_read_b128 a[136:139], v3 offset:10240
  v_cvt_pk_bf16_f32 v180, v216, v217
  v_mfma_f32_16x16x32_bf16 a[84:87], a[168:171], v[188:191], a[84:87]
  v_exp_f32 v220, v140
  v_add_f32 v227, v227, v218
  v_mfma_f32_16x16x32_bf16 a[88:91], a[172:175], v[184:187], a[88:91]
  ds_read_b128 a[140:143], v3 offset:11264
  v_add_f32 v227, v227, v219
  v_mfma_f32_16x16x32_bf16 a[92:95], a[172:175], v[188:191], a[92:95]
  s_waitcnt lgkmcnt(4)
  v_exp_f32 v221, v141
  v_cvt_pk_bf16_f32 v181, v218, v219
  v_mfma_f32_16x16x32_bf16 a[96:99], a[176:179], v[184:187], a[96:99]
  ds_read_b128 a[144:147], v3 offset:12288
  buffer_load_dwordx4 v2, s[48:51], s27 offen offset:3072 sc1 lds
  v_mfma_f32_16x16x32_bf16 a[100:103], a[176:179], v[188:191], a[100:103]
  s_add_u32 s27, s27, 16384
  v_exp_f32 v222, v142
  v_add_f32 v227, v227, v220
  v_mfma_f32_16x16x32_bf16 a[104:107], a[180:183], v[184:187], a[104:107]
  s_add_u32 s25, s25, 32768
  ds_read_b128 a[148:151], v3 offset:13312
  v_add_f32 v227, v227, v221
  v_mfma_f32_16x16x32_bf16 a[108:111], a[180:183], v[188:191], a[108:111]
  s_and_b32 s25, s25, 0x1ffff
  v_exp_f32 v223, v143
  v_cvt_pk_bf16_f32 v182, v220, v221
  v_mfma_f32_16x16x32_bf16 a[112:115], a[184:187], v[184:187], a[112:115]
  ds_read_b128 a[152:155], v3 offset:14336
  v_add_f32 v227, v227, v222
  v_mfma_f32_16x16x32_bf16 a[116:119], a[184:187], v[188:191], a[116:119]
  s_sub_u32 s29, s29, 1
  v_add_f32 v227, v227, v223
  v_cvt_pk_bf16_f32 v183, v222, v223
  v_max_f32 v5, v226, v227
  v_mfma_f32_16x16x32_bf16 a[120:123], a[188:191], v[184:187], a[120:123]
  s_waitcnt lgkmcnt(3)
  ds_read_b128 a[156:159], v3 offset:15360
  v_cmp_lt_f32 vcc, s81, v5
  v_mfma_f32_16x16x32_bf16 a[124:127], a[188:191], v[188:191], a[124:127]
  s_cbranch_vccnz fa_stub10
fa_back10:
  v_add_f32 v230, v230, v226
  v_add_f32 v231, v231, v227
  v_add_u32 v3, 32768, v3
  v_and_b32 v3, 0x1ffff, v3
  s_cmp_lg_u32 s29, 0
  s_cbranch_scc1 fa_SS
fa_Bexit:
  s_bitcmp1_b32 s20, 0
  s_cbranch_scc1 fa_Bodd
  v_mfma_f32_16x16x32_bf16 v[128:131], a[128:131], v[64:67], v[200:203]
  s_waitcnt vmcnt(0)
  v_exp_f32 v216, v144
  v_mfma_f32_16x16x32_bf16 v[136:139], a[128:131], v[68:71], v[204:207]
  s_barrier
  v_exp_f32 v217, v145
  v_mfma_f32_16x16x32_bf16 v[132:135], a[132:135], v[64:67], v[200:203]
  ds_read_b128 a[160:163], v3 offset:16384
  ds_read_b128 a[164:167], v3 offset:17408
  v_mfma_f32_16x16x32_bf16 v[140:143], a[132:135], v[68:71], v[204:207]
  v_exp_f32 v218, v146
  v_mfma_f32_16x16x32_bf16 v[128:131], a[136:139], v[72:75], v[128:131]
  ds_read_b128 a[168:171], v3 offset:18432
  v_add_f32 v226, v216, v217
  v_mfma_f32_16x16x32_bf16 v[136:139], a[136:139], v[76:79], v[136:139]
  v_exp_f32 v219, v147
  v_mfma_f32_16x16x32_bf16 v[132:135], a[140:143], v[72:75], v[132:135]
  ds_read_b128 a[172:175], v3 offset:19456
  v_cvt_pk_bf16_f32 v184, v216, v217
  v_mfma_f32_16x16x32_bf16 v[140:143], a[140:143], v[76:79], v[140:143]
  s_waitcnt lgkmcnt(4)
  v_exp_f32 v220, v148
  v_add_f32 v226, v226, v218
  v_mfma_f32_16x16x32_bf16 v[128:131], a[144:147], v[80:83], v[128:131]
  ds_read_b128 a[176:179], v3 offset:20480
  v_add_f32 v226, v226, v219
  v_mfma_f32_16x16x32_bf16 v[136:139], a[144:147], v[84:87], v[136:139]
  v_exp_f32 v221, v149
  v_mfma_f32_16x16x32_bf16 v[132:135], a[148:151], v[80:83], v[132:135]
  ds_read_b128 a[180:183], v3 offset:21504
  v_cvt_pk_bf16_f32 v185, v218, v219
  v_mfma_f32_16x16x32_bf16 v[140:143], a[148:151], v[84:87], v[140:143]
  v_exp_f32 v222, v150
  v_mfma_f32_16x16x32_bf16 v[128:131], a[152:155], v[88:91], v[128:131]
  ds_read_b128 a[184:187], v3 offset:22528
  v_add_f32 v226, v226, v220
  v_mfma_f32_16x16x32_bf16 v[136:139], a[152:155], v[92:95], v[136:139]
  v_exp_f32 v223, v151
  v_mfma_f32_16x16x32_bf16 v[132:135], a[156:159], v[88:91], v[132:135]
  ds_read_b128 a[188:191], v3 offset:23552
  v_add_f32 v226, v226, v221
  v_mfma_f32_16x16x32_bf16 v[140:143], a[156:159], v[92:95], v[140:143]
  s_waitcnt lgkmcnt(4)
  v_exp_f32 v216, v152
  v_mfma_f32_16x16x32_bf16 a[64:67], a[160:163], v[176:179], a[64:67]
  v_exp_f32 v217, v153
  v_mfma_f32_16x16x32_bf16 a[68:71], a[160:163], v[180:183], a[68:71]
  v_exp_f32 v218, v154
  v_mfma_f32_16x16x32_bf16 a[72:75], a[164:167], v[176:179], a[72:75]
  v_exp_f32 v219, v155
  v_mfma_f32_16x16x32_bf16 a[76:79], a[164:167], v[180:183], a[76:79]
  v_cvt_pk_bf16_f32 v186, v220, v221
  v_add_f32 v226, v226, v222
  v_mfma_f32_16x16x32_bf16 a[80:83], a[168:171], v[176:179], a[80:83]
  v_exp_f32 v220, v156
  v_mfma_f32_16x16x32_bf16 a[84:87], a[168:171], v[180:183], a[84:87]
  v_exp_f32 v221, v157
  v_mfma_f32_16x16x32_bf16 a[88:91], a[172:175], v[176:179], a[88:91]
  v_add_f32 v226, v226, v223
  v_cvt_pk_bf16_f32 v187, v222, v223
  v_mfma_f32_16x16x32_bf16 a[92:95], a[172:175], v[180:183], a[92:95]
  s_waitcnt lgkmcnt(0)
  v_exp_f32 v222, v158
  v_add_f32 v227, v216, v217
  v_mfma_f32_16x16x32_bf16 a[96:99], a[176:179], v[176:179], a[96:99]
  v_exp_f32 v223, v159
  v_mfma_f32_16x16x32_bf16 a[100:103], a[176:179], v[180:183], a[100:103]
  v_cvt_pk_bf16_f32 v188, v216, v217
  v_add_f32 v227, v227, v218
  v_mfma_f32_16x16x32_bf16 a[104:107], a[180:183], v[176:179], a[104:107]
  v_add_f32 v227, v227, v219
  v_cvt_pk_bf16_f32 v189, v218, v219
  v_mfma_f32_16x16x32_bf16 a[108:111], a[180:183], v[180:183], a[108:111]
  v_add_f32 v227, v227, v220
  v_add_f32 v227, v227, v221
  v_mfma_f32_16x16x32_bf16 a[112:115], a[184:187], v[176:179], a[112:115]
  v_cvt_pk_bf16_f32 v190, v220, v221
  v_add_f32 v227, v227, v222
  v_mfma_f32_16x16x32_bf16 a[116:119], a[184:187], v[180:183], a[116:119]
  v_add_f32 v227, v227, v223
  v_cvt_pk_bf16_f32 v191, v222, v223
  v_mfma_f32_16x16x32_bf16 a[120:123], a[188:191], v[176:179], a[120:123]
  v_max_f32 v5, v226, v227
  v_cmp_lt_f32 vcc, s81, v5
  v_mfma_f32_16x16x32_bf16 a[124:127], a[188:191], v[180:183], a[124:127]
  s_cbranch_vccnz fa_stub11
fa_back11:
  v_add_f32 v230, v230, v226
  v_add_f32 v231, v231, v227
  ds_read_b128 a[160:163], v3 offset:24576
  ds_read_b128 a[164:167], v3 offset:25600
  ds_read_b128 a[168:171], v3 offset:26624
  ds_read_b128 a[172:175], v3 offset:27648
  ds_read_b128 a[176:179], v3 offset:28672
  ds_read_b128 a[180:183], v3 offset:29696
  ds_read_b128 a[184:187], v3 offset:30720
  ds_read_b128 a[188:191], v3 offset:31744
  v_cndmask_b32 v128, v4, v128, s[68:69]
  v_cndmask_b32 v129, v4, v129, s[70:71]
  v_cndmask_b32 v130, v4, v130, s[72:73]
  v_cndmask_b32 v131, v4, v131, s[74:75]
  v_mov_b32 v132, v4
  v_mov_b32 v133, v4
  v_mov_b32 v134, v4
  v_mov_b32 v135, v4
  v_cndmask_b32 v140, v4, v140, s[68:69]
  v_cndmask_b32 v141, v4, v141, s[70:71]
  v_cndmask_b32 v142, v4, v142, s[72:73]
  v_cndmask_b32 v143, v4, v143, s[74:75]
  v_exp_f32 v216, v128
  v_exp_f32 v217, v129
  v_exp_f32 v218, v130
  v_exp_f32 v219, v131
  v_exp_f32 v220, v132
  v_exp_f32 v221, v133
  v_exp_f32 v222, v134
  v_exp_f32 v223, v135
  v_add_f32 v226, v216, v217
  v_cvt_pk_bf16_f32 v176, v216, v217
  s_waitcnt lgkmcnt(4)
  v_mfma_f32_16x16x32_bf16 a[64:67], a[160:163], v[184:187], a[64:67]
  v_exp_f32 v216, v136
  v_add_f32 v226, v226, v218
  v_mfma_f32_16x16x32_bf16 a[68:71], a[160:163], v[188:191], a[68:71]
  v_exp_f32 v217, v137
  v_mfma_f32_16x16x32_bf16 a[72:75], a[164:167], v[184:187], a[72:75]
  v_add_f32 v226, v226, v219
  v_cvt_pk_bf16_f32 v177, v218, v219
  v_add_f32 v226, v226, v220
  v_mfma_f32_16x16x32_bf16 a[76:79], a[164:167], v[188:191], a[76:79]
  v_exp_f32 v218, v138
  v_mfma_f32_16x16x32_bf16 a[80:83], a[168:171], v[184:187], a[80:83]
  v_exp_f32 v219, v139
  v_add_f32 v226, v226, v221
  v_mfma_f32_16x16x32_bf16 a[84:87], a[168:171], v[188:191], a[84:87]
  v_cvt_pk_bf16_f32 v178, v220, v221
  v_add_f32 v226, v226, v222
  v_mfma_f32_16x16x32_bf16 a[88:91], a[172:175], v[184:187], a[88:91]
  v_exp_f32 v220, v140
  v_add_f32 v226, v226, v223
  v_mfma_f32_16x16x32_bf16 a[92:95], a[172:175], v[188:191], a[92:95]
  s_waitcnt lgkmcnt(0)
  v_exp_f32 v221, v141
  v_mfma_f32_16x16x32_bf16 a[96:99], a[176:179], v[184:187], a[96:99]
  v_cvt_pk_bf16_f32 v179, v222, v223
  v_add_f32 v227, v216, v217
  v_cvt_pk_bf16_f32 v180, v216, v217
  v_mfma_f32_16x16x32_bf16 a[100:103], a[176:179], v[188:191], a[100:103]
  v_exp_f32 v222, v142
  v_mfma_f32_16x16x32_bf16 a[104:107], a[180:183], v[184:187], a[104:107]
  v_exp_f32 v223, v143
  v_add_f32 v227, v227, v218
  v_mfma_f32_16x16x32_bf16 a[108:111], a[180:183], v[188:191], a[108:111]
  v_add_f32 v227, v227, v219
  v_cvt_pk_bf16_f32 v181, v218, v219
  v_mfma_f32_16x16x32_bf16 a[112:115], a[184:187], v[184:187], a[112:115]
  v_add_f32 v227, v227, v220
  v_add_f32 v227, v227, v221
  v_cvt_pk_bf16_f32 v182, v220, v221
  v_mfma_f32_16x16x32_bf16 a[116:119], a[184:187], v[188:191], a[116:119]
  v_add_f32 v227, v227, v222
  v_add_f32 v227, v227, v223
  v_mfma_f32_16x16x32_bf16 a[120:123], a[188:191], v[184:187], a[120:123]
  v_cvt_pk_bf16_f32 v183, v222, v223
  v_max_f32 v5, v226, v227
  v_cmp_lt_f32 vcc, s81, v5
  v_mfma_f32_16x16x32_bf16 a[124:127], a[188:191], v[188:191], a[124:127]
  s_cbranch_vccnz fa_stub12
fa_back12:
  v_add_f32 v230, v230, v226
  v_add_f32 v231, v231, v227
  v_add_u32 v3, 32768, v3
  v_and_b32 v3, 0x1ffff, v3
  s_waitcnt vmcnt(0)
  s_barrier
  ds_read_b128 a[160:163], v3 offset:16384
  ds_read_b128 a[164:167], v3 offset:17408
  ds_read_b128 a[168:171], v3 offset:18432
  ds_read_b128 a[172:175], v3 offset:19456
  ds_read_b128 a[176:179], v3 offset:20480
  ds_read_b128 a[180:183], v3 offset:21504
  ds_read_b128 a[184:187], v3 offset:22528
  ds_read_b128 a[188:191], v3 offset:23552
  s_waitcnt lgkmcnt(4)
  v_mfma_f32_16x16x32_bf16 a[64:67], a[160:163], v[176:179], a[64:67]
  v_mfma_f32_16x16x32_bf16 a[68:71], a[160:163], v[180:183], a[68:71]
  v_mfma_f32_16x16x32_bf16 a[72:75], a[164:167], v[176:179], a[72:75]
  v_mfma_f32_16x16x32_bf16 a[76:79], a[164:167], v[180:183], a[76:79]
  v_mfma_f32_16x16x32_bf16 a[80:83], a[168:171], v[176:179], a[80:83]
  v_mfma_f32_16x16x32_bf16 a[84:87], a[168:171], v[180:183], a[84:87]
  v_mfma_f32_16x16x32_bf16 a[88:91], a[172:175], v[176:179], a[88:91]
  v_mfma_f32_16x16x32_bf16 a[92:95], a[172:175], v[180:183], a[92:95]
  s_waitcnt lgkmcnt(0)
  v_mfma_f32_16x16x32_bf16 a[96:99], a[176:179], v[176:179], a[96:99]
  v_mfma_f32_16x16x32_bf16 a[100:103], a[176:179], v[180:183], a[100:103]
  v_mfma_f32_16x16x32_bf16 a[104:107], a[180:183], v[176:179], a[104:107]
  v_mfma_f32_16x16x32_bf16 a[108:111], a[180:183], v[180:183], a[108:111]
  v_mfma_f32_16x16x32_bf16 a[112:115], a[184:187], v[176:179], a[112:115]
  v_mfma_f32_16x16x32_bf16 a[116:119], a[184:187], v[180:183], a[116:119]
  v_mfma_f32_16x16x32_bf16 a[120:123], a[188:191], v[176:179], a[120:123]
  v_mfma_f32_16x16x32_bf16 a[124:127], a[188:191], v[180:183], a[124:127]
  s_branch fa_Bdone
fa_Bodd:
  s_waitcnt vmcnt(0)
  s_barrier
  ds_read_b128 a[160:163], v3 offset:16384
  ds_read_b128 a[164:167], v3 offset:17408
  ds_read_b128 a[168:171], v3 offset:18432
  ds_read_b128 a[172:175], v3 offset:19456
  ds_read_b128 a[176:179], v3 offset:20480
  ds_read_b128 a[180:183], v3 offset:21504
  ds_read_b128 a[184:187], v3 offset:22528
  ds_read_b128 a[188:191], v3 offset:23552
  v_cndmask_b32 v144, v4, v144, s[68:69]
  v_cndmask_b32 v145, v4, v145, s[70:71]
  v_cndmask_b32 v146, v4, v146, s[72:73]
  v_cndmask_b32 v147, v4, v147, s[74:75]
  v_mov_b32 v148, v4
  v_mov_b32 v149, v4
  v_mov_b32 v150, v4
  v_mov_b32 v151, v4
  v_cndmask_b32 v156, v4, v156, s[68:69]
  v_cndmask_b32 v157, v4, v157, s[70:71]
  v_cndmask_b32 v158, v4, v158, s[72:73]
  v_cndmask_b32 v159, v4, v159, s[74:75]
  v_exp_f32 v216, v144
  v_exp_f32 v217, v145
  v_exp_f32 v218, v146
  v_exp_f32 v219, v147
  v_exp_f32 v220, v148
  v_exp_f32 v221, v149
  v_exp_f32 v222, v150
  v_exp_f32 v223, v151
  v_add_f32 v226, v216, v217
  v_cvt_pk_bf16_f32 v184, v216, v217
  s_waitcnt lgkmcnt(4)
  v_mfma_f32_16x16x32_bf16 a[64:67], a[160:163], v[176:179], a[64:67]
  v_exp_f32 v216, v152
  v_add_f32 v226, v226, v218
  v_mfma_f32_16x16x32_bf16 a[68:71], a[160:163], v[180:183], a[68:71]
  v_exp_f32 v217, v153
  v_mfma_f32_16x16x32_bf16 a[72:75], a[164:167], v[176:179], a[72:75]
  v_add_f32 v226, v226, v219
  v_cvt_pk_bf16_f32 v185, v218, v219
  v_add_f32 v226, v226, v220
  v_mfma_f32_16x16x32_bf16 a[76:79], a[164:167], v[180:183], a[76:79]
  v_exp_f32 v218, v154
  v_mfma_f32_16x16x32_bf16 a[80:83], a[168:171], v[176:179], a[80:83]
  v_exp_f32 v219, v155
  v_add_f32 v226, v226, v221
  v_mfma_f32_16x16x32_bf16 a[84:87], a[168:171], v[180:183], a[84:87]
  v_cvt_pk_bf16_f32 v186, v220, v221
  v_add_f32 v226, v226, v222
  v_mfma_f32_16x16x32_bf16 a[88:91], a[172:175], v[176:179], a[88:91]
  v_exp_f32 v220, v156
  v_add_f32 v226, v226, v223
  v_mfma_f32_16x16x32_bf16 a[92:95], a[172:175], v[180:183], a[92:95]
  s_waitcnt lgkmcnt(0)
  v_exp_f32 v221, v157
  v_mfma_f32_16x16x32_bf16 a[96:99], a[176:179], v[176:179], a[96:99]
  v_cvt_pk_bf16_f32 v187, v222, v223
  v_add_f32 v227, v216, v217
  v_cvt_pk_bf16_f32 v188, v216, v217
  v_mfma_f32_16x16x32_bf16 a[100:103], a[176:179], v[180:183], a[100:103]
  v_exp_f32 v222, v158
  v_mfma_f32_16x16x32_bf16 a[104:107], a[180:183], v[176:179], a[104:107]
  v_exp_f32 v223, v159
  v_add_f32 v227, v227, v218
  v_mfma_f32_16x16x32_bf16 a[108:111], a[180:183], v[180:183], a[108:111]
  v_add_f32 v227, v227, v219
  v_cvt_pk_bf16_f32 v189, v218, v219
  v_mfma_f32_16x16x32_bf16 a[112:115], a[184:187], v[176:179], a[112:115]
  v_add_f32 v227, v227, v220
  v_add_f32 v227, v227, v221
  v_cvt_pk_bf16_f32 v190, v220, v221
  v_mfma_f32_16x16x32_bf16 a[116:119], a[184:187], v[180:183], a[116:119]
  v_add_f32 v227, v227, v222
  v_add_f32 v227, v227, v223
  v_mfma_f32_16x16x32_bf16 a[120:123], a[188:191], v[176:179], a[120:123]
  v_cvt_pk_bf16_f32 v191, v222, v223
  v_max_f32 v5, v226, v227
  v_cmp_lt_f32 vcc, s81, v5
  v_mfma_f32_16x16x32_bf16 a[124:127], a[188:191], v[180:183], a[124:127]
  s_cbranch_vccnz fa_stub13
fa_back13:
  v_add_f32 v230, v230, v226
  v_add_f32 v231, v231, v227
  ds_read_b128 a[160:163], v3 offset:24576
  ds_read_b128 a[164:167], v3 offset:25600
  ds_read_b128 a[168:171], v3 offset:26624
  ds_read_b128 a[172:175], v3 offset:27648
  ds_read_b128 a[176:179], v3 offset:28672
  ds_read_b128 a[180:183], v3 offset:29696
  ds_read_b128 a[184:187], v3 offset:30720
  ds_read_b128 a[188:191], v3 offset:31744
  s_waitcnt lgkmcnt(4)
  v_mfma_f32_16x16x32_bf16 a[64:67], a[160:163], v[184:187], a[64:67]
  v_mfma_f32_16x16x32_bf16 a[68:71], a[160:163], v[188:191], a[68:71]
  v_mfma_f32_16x16x32_bf16 a[72:75], a[164:167], v[184:187], a[72:75]
  v_mfma_f32_16x16x32_bf16 a[76:79], a[164:167], v[188:191], a[76:79]
  v_mfma_f32_16x16x32_bf16 a[80:83], a[168:171], v[184:187], a[80:83]
  v_mfma_f32_16x16x32_bf16 a[84:87], a[168:171], v[188:191], a[84:87]
  v_mfma_f32_16x16x32_bf16 a[88:91], a[172:175], v[184:187], a[88:91]
  v_mfma_f32_16x16x32_bf16 a[92:95], a[172:175], v[188:191], a[92:95]
  s_waitcnt lgkmcnt(0)
  v_mfma_f32_16x16x32_bf16 a[96:99], a[176:179], v[184:187], a[96:99]
  v_mfma_f32_16x16x32_bf16 a[100:103], a[176:179], v[188:191], a[100:103]
  v_mfma_f32_16x16x32_bf16 a[104:107], a[180:183], v[184:187], a[104:107]
  v_mfma_f32_16x16x32_bf16 a[108:111], a[180:183], v[188:191], a[108:111]
  v_mfma_f32_16x16x32_bf16 a[112:115], a[184:187], v[184:187], a[112:115]
  v_mfma_f32_16x16x32_bf16 a[116:119], a[184:187], v[188:191], a[116:119]
  v_mfma_f32_16x16x32_bf16 a[120:123], a[188:191], v[184:187], a[120:123]
  v_mfma_f32_16x16x32_bf16 a[124:127], a[188:191], v[188:191], a[124:127]
  v_add_u32 v3, 32768, v3
  v_and_b32 v3, 0x1ffff, v3
fa_Bdone:
  s_cmp_ge_u32 s20, 2
  s_cbranch_scc1 fa_epi
  s_barrier
fa_epi:
  s_cmp_lt_u32 s12, 2
  s_cbranch_scc1 fa_hk3
fa_hb3:
  v_mov_b32 v20, v230
  v_mov_b32 v21, v231
  s_nop 1
  v_permlane16_swap_b32 v230, v20
  v_permlane16_swap_b32 v231, v21
  v_add_f32 v230, v230, v20
  v_add_f32 v231, v231, v21
  v_mov_b32 v20, v230
  v_mov_b32 v21, v231
  s_nop 1
  v_permlane32_swap_b32 v230, v20
  v_permlane32_swap_b32 v231, v21
  v_add_f32 v230, v230, v20
  v_add_f32 v231, v231, v21
  v_rcp_f32 v16, v230
  v_rcp_f32 v18, v231
  s_sub_u32 s23, 15, s22
  s_lshl_b32 s23, s23, 2
  v_mov_b32 v17, v16
  v_mov_b32 v19, v18
  s_add_u32 s23, s23, s20
  s_lshl_b32 s23, s23, 18
  s_lshl_b32 s31, s21, 12
  s_add_u32 s31, s31, 50331648
  s_add_u32 s64, s23, s31
  s_add_u32 s65, s64, 131072
  v_accvgpr_read_b32 v68, a64
  v_accvgpr_read_b32 v69, a65
  v_accvgpr_read_b32 v70, a66
  v_accvgpr_read_b32 v71, a67
  v_accvgpr_read_b32 v72, a72
  v_accvgpr_read_b32 v73, a73
  v_accvgpr_read_b32 v74, a74
  v_accvgpr_read_b32 v75, a75
  v_pk_mul_f32 v[68:69], v[68:69], v[16:17]
  v_pk_mul_f32 v[70:71], v[70:71], v[16:17]
  v_pk_mul_f32 v[72:73], v[72:73], v[16:17]
  v_pk_mul_f32 v[74:75], v[74:75], v[16:17]
  v_cvt_pk_bf16_f32 v64, v68, v69
  v_cvt_pk_bf16_f32 v65, v70, v71
  v_cvt_pk_bf16_f32 v66, v72, v73
  v_cvt_pk_bf16_f32 v67, v74, v75
  buffer_store_dwordx4 v[64:67], v2, s[40:43], s64 offen offset:0 sc1
  v_accvgpr_read_b32 v80, a80
  v_accvgpr_read_b32 v81, a81
  v_accvgpr_read_b32 v82, a82
  v_accvgpr_read_b32 v83, a83
  v_accvgpr_read_b32 v84, a88
  v_accvgpr_read_b32 v85, a89
  v_accvgpr_read_b32 v86, a90
  v_accvgpr_read_b32 v87, a91
  v_pk_mul_f32 v[80:81], v[80:81], v[16:17]
  v_pk_mul_f32 v[82:83], v[82:83], v[16:17]
  v_pk_mul_f32 v[84:85], v[84:85], v[16:17]
  v_pk_mul_f32 v[86:87], v[86:87], v[16:17]
  v_cvt_pk_bf16_f32 v76, v80, v81
  v_cvt_pk_bf16_f32 v77, v82, v83
  v_cvt_pk_bf16_f32 v78, v84, v85
  v_cvt_pk_bf16_f32 v79, v86, v87
  buffer_store_dwordx4 v[76:79], v2, s[40:43], s64 offen offset:1024 sc1
  v_accvgpr_read_b32 v132, a96
  v_accvgpr_read_b32 v133, a97
  v_accvgpr_read_b32 v134, a98
  v_accvgpr_read_b32 v135, a99
  v_accvgpr_read_b32 v136, a104
  v_accvgpr_read_b32 v137, a105
  v_accvgpr_read_b32 v138, a106
  v_accvgpr_read_b32 v139, a107
  v_pk_mul_f32 v[132:133], v[132:133], v[16:17]
  v_pk_mul_f32 v[134:135], v[134:135], v[16:17]
  v_pk_mul_f32 v[136:137], v[136:137], v[16:17]
  v_pk_mul_f32 v[138:139], v[138:139], v[16:17]
  v_cvt_pk_bf16_f32 v128, v132, v133
  v_cvt_pk_bf16_f32 v129, v134, v135
  v_cvt_pk_bf16_f32 v130, v136, v137
  v_cvt_pk_bf16_f32 v131, v138, v139
  buffer_store_dwordx4 v[128:131], v2, s[40:43], s64 offen offset:2048 sc1
  v_accvgpr_read_b32 v144, a112
  v_accvgpr_read_b32 v145, a113
  v_accvgpr_read_b32 v146, a114
  v_accvgpr_read_b32 v147, a115
  v_accvgpr_read_b32 v148, a120
  v_accvgpr_read_b32 v149, a121
  v_accvgpr_read_b32 v150, a122
  v_accvgpr_read_b32 v151, a123
  v_pk_mul_f32 v[144:145], v[144:145], v[16:17]
  v_pk_mul_f32 v[146:147], v[146:147], v[16:17]
  v_pk_mul_f32 v[148:149], v[148:149], v[16:17]
  v_pk_mul_f32 v[150:151], v[150:151], v[16:17]
  v_cvt_pk_bf16_f32 v140, v144, v145
  v_cvt_pk_bf16_f32 v141, v146, v147
  v_cvt_pk_bf16_f32 v142, v148, v149
  v_cvt_pk_bf16_f32 v143, v150, v151
  buffer_store_dwordx4 v[140:143], v2, s[40:43], s64 offen offset:3072 sc1
  v_accvgpr_read_b32 v68, a68
  v_accvgpr_read_b32 v69, a69
  v_accvgpr_read_b32 v70, a70
  v_accvgpr_read_b32 v71, a71
  v_accvgpr_read_b32 v72, a76
  v_accvgpr_read_b32 v73, a77
  v_accvgpr_read_b32 v74, a78
  v_accvgpr_read_b32 v75, a79
  v_pk_mul_f32 v[68:69], v[68:69], v[18:19]
  v_pk_mul_f32 v[70:71], v[70:71], v[18:19]
  v_pk_mul_f32 v[72:73], v[72:73], v[18:19]
  v_pk_mul_f32 v[74:75], v[74:75], v[18:19]
  v_cvt_pk_bf16_f32 v64, v68, v69
  v_cvt_pk_bf16_f32 v65, v70, v71
  v_cvt_pk_bf16_f32 v66, v72, v73
  v_cvt_pk_bf16_f32 v67, v74, v75
  buffer_store_dwordx4 v[64:67], v2, s[40:43], s65 offen offset:0 sc1
  v_accvgpr_read_b32 v80, a84
  v_accvgpr_read_b32 v81, a85
  v_accvgpr_read_b32 v82, a86
  v_accvgpr_read_b32 v83, a87
  v_accvgpr_read_b32 v84, a92
  v_accvgpr_read_b32 v85, a93
  v_accvgpr_read_b32 v86, a94
  v_accvgpr_read_b32 v87, a95
  v_pk_mul_f32 v[80:81], v[80:81], v[18:19]
  v_pk_mul_f32 v[82:83], v[82:83], v[18:19]
  v_pk_mul_f32 v[84:85], v[84:85], v[18:19]
  v_pk_mul_f32 v[86:87], v[86:87], v[18:19]
  v_cvt_pk_bf16_f32 v76, v80, v81
  v_cvt_pk_bf16_f32 v77, v82, v83
  v_cvt_pk_bf16_f32 v78, v84, v85
  v_cvt_pk_bf16_f32 v79, v86, v87
  buffer_store_dwordx4 v[76:79], v2, s[40:43], s65 offen offset:1024 sc1
  v_accvgpr_read_b32 v132, a100
  v_accvgpr_read_b32 v133, a101
  v_accvgpr_read_b32 v134, a102
  v_accvgpr_read_b32 v135, a103
  v_accvgpr_read_b32 v136, a108
  v_accvgpr_read_b32 v137, a109
  v_accvgpr_read_b32 v138, a110
  v_accvgpr_read_b32 v139, a111
  v_pk_mul_f32 v[132:133], v[132:133], v[18:19]
  v_pk_mul_f32 v[134:135], v[134:135], v[18:19]
  v_pk_mul_f32 v[136:137], v[136:137], v[18:19]
  v_pk_mul_f32 v[138:139], v[138:139], v[18:19]
  v_cvt_pk_bf16_f32 v128, v132, v133
  v_cvt_pk_bf16_f32 v129, v134, v135
  v_cvt_pk_bf16_f32 v130, v136, v137
  v_cvt_pk_bf16_f32 v131, v138, v139
  buffer_store_dwordx4 v[128:131], v2, s[40:43], s65 offen offset:2048 sc1
  v_accvgpr_read_b32 v144, a116
  v_accvgpr_read_b32 v145, a117
  v_accvgpr_read_b32 v146, a118
  v_accvgpr_read_b32 v147, a119
  v_accvgpr_read_b32 v148, a124
  v_accvgpr_read_b32 v149, a125
  v_accvgpr_read_b32 v150, a126
  v_accvgpr_read_b32 v151, a127
  v_pk_mul_f32 v[144:145], v[144:145], v[18:19]
  v_pk_mul_f32 v[146:147], v[146:147], v[18:19]
  v_pk_mul_f32 v[148:149], v[148:149], v[18:19]
  v_pk_mul_f32 v[150:151], v[150:151], v[18:19]
  v_cvt_pk_bf16_f32 v140, v144, v145
  v_cvt_pk_bf16_f32 v141, v146, v147
  v_cvt_pk_bf16_f32 v142, v148, v149
  v_cvt_pk_bf16_f32 v143, v150, v151
  buffer_store_dwordx4 v[140:143], v2, s[40:43], s65 offen offset:3072 sc1
  s_load_dwordx2 s[4:5], s[0:1], 0
  s_load_dwordx2 s[6:7], s[0:1], 88
  v_mov_b32 v30, 1073741824
  v_mov_b32 v31, 1
  v_writelane_b32 v30, s80, 0
  v_writelane_b32 v30, s3, 1
  v_and_b32 v10, 15, v1
  v_lshlrev_b32 v10, 2, v10
  v_add_u32 v10, 2629632, v10
  v_min_u32 v11, 53, v1
  s_lshr_b32 s23, s22, 1
  s_lshl_b32 s23, s23, 8
  s_add_u32 s23, s23, 2650112
  v_lshl_add_u32 v11, v11, 2, s23
  buffer_load_dword v15, v10, s[40:43], 0 offen sc1
  buffer_load_dword v14, v11, s[40:43], 0 offen sc1
  s_lshl_b32 s64, s21, 19
  s_lshl_b32 s23, s20, 15
  s_add_u32 s64, s64, s23
  s_add_u32 s64, s64, 50331648
  s_add_u32 s65, s64, 131072
  s_add_u32 s66, s64, 262144
  s_add_u32 s67, s64, 393216
  v_bfe_u32 v12, v1, 3, 1
  v_lshlrev_b32 v12, 7, v12
  v_and_b32 v13, 7, v1
  v_lshl_add_u32 v12, v13, 2, v12
  s_lshl_b32 s23, s21, 8
  s_lshl_b32 s31, s20, 5
  s_add_u32 s23, s23, s31
  s_add_u32 s23, s23, 2641920
  v_add_u32 v12, s23, v12
  s_lshl_b32 s25, s21, 6
  s_mul_i32 s26, s22, 160
  s_mul_i32 s27, s22, 2560
  v_add_u32 v16, 0, v0
  v_mul_u32_u24 v17, 6554, v16
  v_lshrrev_b32 v17, 16, v17
  v_mul_u32_u24 v18, 10, v17
  v_sub_u32 v18, v16, v18
  v_mul_u32_u24 v251, 336, v17
  v_lshl_add_u32 v251, v18, 5, v251
  v_lshlrev_b32 v203, 5, v18
  v_add_u32 v17, s25, v17
  v_add_u32 v24, 1, v17
  v_mul_u32_u24 v248, 1280, v17
  v_lshl_add_u32 v248, v18, 4, v248
  v_add_u32 v248, s26, v248
  v_lshrrev_b32 v19, 4, v17
  v_mul_u32_u24 v19, 20480, v19
  v_and_b32 v17, 15, v17
  v_lshl_add_u32 v19, v17, 4, v19
  v_lshl_add_u32 v200, v18, 8, v19
  v_mov_b32 v27, 8
  v_add_u32 v16, 256, v0
  v_mul_u32_u24 v17, 6554, v16
  v_lshrrev_b32 v17, 16, v17
  v_mul_u32_u24 v18, 10, v17
  v_sub_u32 v18, v16, v18
  v_mul_u32_u24 v252, 336, v17
  v_lshl_add_u32 v252, v18, 5, v252
  v_lshlrev_b32 v204, 5, v18
  v_add_u32 v17, s25, v17
  v_add_u32 v25, 1, v17
  v_mul_u32_u24 v249, 1280, v17
  v_lshl_add_u32 v249, v18, 4, v249
  v_add_u32 v249, s26, v249
  v_lshrrev_b32 v19, 4, v17
  v_mul_u32_u24 v19, 20480, v19
  v_and_b32 v17, 15, v17
  v_lshl_add_u32 v19, v17, 4, v19
  v_lshl_add_u32 v201, v18, 8, v19
  v_mov_b32 v28, 8
  v_add_u32 v16, 512, v0
  v_mul_u32_u24 v17, 6554, v16
  v_lshrrev_b32 v17, 16, v17
  v_mul_u32_u24 v18, 10, v17
  v_sub_u32 v18, v16, v18
  v_mul_u32_u24 v253, 336, v17
  v_lshl_add_u32 v253, v18, 5, v253
  v_lshlrev_b32 v205, 5, v18
  v_add_u32 v17, s25, v17
  v_add_u32 v26, 1, v17
  v_mul_u32_u24 v250, 1280, v17
  v_lshl_add_u32 v250, v18, 4, v250
  v_add_u32 v250, s26, v250
  v_lshrrev_b32 v19, 4, v17
  v_mul_u32_u24 v19, 20480, v19
  v_and_b32 v17, 15, v17
  v_lshl_add_u32 v19, v17, 4, v19
  v_lshl_add_u32 v202, v18, 8, v19
  v_mov_b32 v29, 8
  v_cmp_gt_u32 vcc, 128, v0
  v_mov_b32 v16, 1073741824
  v_mov_b32 v17, 0
  v_cndmask_b32 v250, v16, v250, vcc
  v_cndmask_b32 v202, v16, v202, vcc
  v_cndmask_b32 v253, v17, v253, vcc
  v_mov_b32 v20, 0
  v_mov_b32 v21, 0
  v_mov_b32 v22, 0
  v_mov_b32 v23, 0
  v_add_u32 v16, 133632, v2
  ds_write_b128 v16, v[20:23]
  s_waitcnt vmcnt(0) lgkmcnt(0)
  buffer_store_dword v31, v30, s[40:43], 0 offen sc1
fa_hb4:
  s_cmp_lt_u32 s12, 2
  s_cbranch_scc1 fa_hk4
  s_mov_b32 s44, s4
  s_mov_b32 s45, s5
  s_mov_b32 s46, 2621440
  s_mov_b32 s47, 0x20000
  s_mov_b32 s48, s6
  s_mov_b32 s49, s7
  s_mov_b32 s50, 2621440
  s_mov_b32 s51, 0x20000
  v_cmp_eq_u32 vcc, 0, v15
  s_cbranch_vccnz fa_sel4_spin
fa_sel4_ok:
  v_readlane_b32 s68, v15, 0
  v_readlane_b32 s69, v15, 1
  v_readlane_b32 s70, v15, 2
  v_readlane_b32 s71, v15, 3
  v_readlane_b32 s72, v15, 4
  v_readlane_b32 s73, v15, 5
  v_readlane_b32 s74, v15, 6
  v_readlane_b32 s75, v15, 7
  s_lshl_b32 s23, s20, 1
  s_add_u32 s31, s23, 8
  v_readlane_b32 s29, v15, s23
  v_readlane_b32 s30, v15, s31
  v_cmp_eq_u32 s[52:53], s68, v24
  v_cmp_eq_u32 s[54:55], s68, v25
  v_cmp_eq_u32 s[56:57], s68, v26
  v_cndmask_b32 v27, v27, 0, s[52:53]
  v_cndmask_b32 v28, v28, 0, s[54:55]
  v_cndmask_b32 v29, v29, 0, s[56:57]
  v_cmp_eq_u32 s[52:53], s69, v24
  v_cmp_eq_u32 s[54:55], s69, v25
  v_cmp_eq_u32 s[56:57], s69, v26
  v_cndmask_b32 v27, v27, 1, s[52:53]
  v_cndmask_b32 v28, v28, 1, s[54:55]
  v_cndmask_b32 v29, v29, 1, s[56:57]
  v_cmp_eq_u32 s[52:53], s70, v24
  v_cmp_eq_u32 s[54:55], s70, v25
  v_cmp_eq_u32 s[56:57], s70, v26
  v_cndmask_b32 v27, v27, 2, s[52:53]
  v_cndmask_b32 v28, v28, 2, s[54:55]
  v_cndmask_b32 v29, v29, 2, s[56:57]
  v_cmp_eq_u32 s[52:53], s71, v24
  v_cmp_eq_u32 s[54:55], s71, v25
  v_cmp_eq_u32 s[56:57], s71, v26
  v_cndmask_b32 v27, v27, 3, s[52:53]
  v_cndmask_b32 v28, v28, 3, s[54:55]
  v_cndmask_b32 v29, v29, 3, s[56:57]
  v_cmp_eq_u32 s[52:53], s72, v24
  v_cmp_eq_u32 s[54:55], s72, v25
  v_cmp_eq_u32 s[56:57], s72, v26
  v_cndmask_b32 v27, v27, 4, s[52:53]
  v_cndmask_b32 v28, v28, 4, s[54:55]
  v_cndmask_b32 v29, v29, 4, s[56:57]
  v_cmp_eq_u32 s[52:53], s73, v24
  v_cmp_eq_u32 s[54:55], s73, v25
  v_cmp_eq_u32 s[56:57], s73, v26
  v_cndmask_b32 v27, v27, 5, s[52:53]
  v_cndmask_b32 v28, v28, 5, s[54:55]
  v_cndmask_b32 v29, v29, 5, s[56:57]
  v_cmp_eq_u32 s[52:53], s74, v24
  v_cmp_eq_u32 s[54:55], s74, v25
  v_cmp_eq_u32 s[56:57], s74, v26
  v_cndmask_b32 v27, v27, 6, s[52:53]
  v_cndmask_b32 v28, v28, 6, s[54:55]
  v_cndmask_b32 v29, v29, 6, s[56:57]
  v_cmp_eq_u32 s[52:53], s75, v24
  v_cmp_eq_u32 s[54:55], s75, v25
  v_cmp_eq_u32 s[56:57], s75, v26
  v_cndmask_b32 v27, v27, 7, s[52:53]
  v_cndmask_b32 v28, v28, 7, s[54:55]
  v_cndmask_b32 v29, v29, 7, s[56:57]
  v_mul_u32_u24 v27, 320, v27
  v_add_u32 v203, v203, v27
  v_mul_u32_u24 v28, 320, v28
  v_add_u32 v204, v204, v28
  v_mul_u32_u24 v29, 320, v29
  v_add_u32 v205, v205, v29
  v_add_u32 v203, 131072, v203
  v_add_u32 v204, 131072, v204
  v_add_u32 v205, 131072, v205
  s_sub_u32 s29, s29, s25
  s_sub_u32 s29, s29, 1
  s_cmp_lt_u32 s29, 64
  s_cbranch_scc1 fa_ystub0
fa_yback0:
  s_add_u32 s23, s23, 1
  s_add_u32 s31, s23, 8
  v_readlane_b32 s29, v15, s23
  v_readlane_b32 s30, v15, s31
  s_sub_u32 s29, s29, s25
  s_sub_u32 s29, s29, 1
  s_cmp_lt_u32 s29, 64
  s_cbranch_scc1 fa_ystub1
fa_yback1:
  buffer_load_dwordx4 v[64:67], v2, s[40:43], s13 offen offset:0 sc1
  buffer_load_dwordx4 v[68:71], v2, s[40:43], s13 offen offset:1024 sc1
  buffer_load_dwordx4 v[72:75], v2, s[40:43], s13 offen offset:2048 sc1
  buffer_load_dwordx4 v[76:79], v2, s[40:43], s13 offen offset:3072 sc1
  s_add_u32 s13, s13, 4096
  buffer_load_dwordx4 v[80:83], v2, s[40:43], s13 offen offset:0 sc1
  buffer_load_dwordx4 v[84:87], v2, s[40:43], s13 offen offset:1024 sc1
  buffer_load_dwordx4 v[88:91], v2, s[40:43], s13 offen offset:2048 sc1
  buffer_load_dwordx4 v[92:95], v2, s[40:43], s13 offen offset:3072 sc1
  s_add_u32 s13, s13, 4096
  buffer_load_dword v13, v12, s[40:43], 0 offen sc1
  buffer_load_dwordx4 v[128:131], v2, s[40:43], s13 offen offset:0 sc1
  buffer_load_dwordx4 v[132:135], v2, s[40:43], s13 offen offset:1024 sc1
  buffer_load_dwordx4 v[136:139], v2, s[40:43], s13 offen offset:2048 sc1
  buffer_load_dwordx4 v[140:143], v2, s[40:43], s13 offen offset:3072 sc1
  s_add_u32 s13, s13, 4096
  buffer_load_dwordx4 v[144:147], v2, s[40:43], s13 offen offset:0 sc1
  buffer_load_dwordx4 v[148:151], v2, s[40:43], s13 offen offset:1024 sc1
  buffer_load_dwordx4 v[152:155], v2, s[40:43], s13 offen offset:2048 sc1
  buffer_load_dwordx4 v[156:159], v2, s[40:43], s13 offen offset:3072 sc1
  s_add_u32 s13, s13, 4096
  buffer_load_dwordx4 v[176:179], v2, s[40:43], s13 offen offset:0 sc1
  buffer_load_dwordx4 v[180:183], v2, s[40:43], s13 offen offset:1024 sc1
  buffer_load_dwordx4 v[184:187], v2, s[40:43], s13 offen offset:2048 sc1
  buffer_load_dwordx4 v[188:191], v2, s[40:43], s13 offen offset:3072 sc1
  s_add_u32 s13, s13, 4096
  s_waitcnt vmcnt(12)
  v_cmp_eq_u32 vcc, 0, v13
  s_cbranch_vccnz fa_ctx_spin
fa_ctx_ok:
  buffer_load_dwordx4 a[144:147], v2, s[40:43], s64 offen offset:0 sc1
  buffer_load_dwordx4 a[148:151], v2, s[40:43], s65 offen offset:0 sc1
  buffer_load_dwordx4 a[152:155], v2, s[40:43], s66 offen offset:0 sc1
  buffer_load_dwordx4 a[156:159], v2, s[40:43], s67 offen offset:0 sc1
  buffer_load_dwordx4 a[160:163], v2, s[40:43], s64 offen offset:1024 sc1
  buffer_load_dwordx4 a[164:167], v2, s[40:43], s65 offen offset:1024 sc1
  buffer_load_dwordx4 a[168:171], v2, s[40:43], s66 offen offset:1024 sc1
  buffer_load_dwordx4 a[172:175], v2, s[40:43], s67 offen offset:1024 sc1
  buffer_load_dwordx4 a[176:179], v2, s[40:43], s64 offen offset:2048 sc1
  buffer_load_dwordx4 a[180:183], v2, s[40:43], s65 offen offset:2048 sc1
  buffer_load_dwordx4 a[184:187], v2, s[40:43], s66 offen offset:2048 sc1
  buffer_load_dwordx4 a[188:191], v2, s[40:43], s67 offen offset:2048 sc1
  buffer_load_dwordx4 v[216:219], v2, s[40:43], s64 offen offset:3072 sc1
  buffer_load_dwordx4 v[220:223], v2, s[40:43], s65 offen offset:3072 sc1
  buffer_load_dwordx4 v[224:227], v2, s[40:43], s66 offen offset:3072 sc1
  buffer_load_dwordx4 v[228:231], v2, s[40:43], s67 offen offset:3072 sc1
  s_add_u32 s64, s64, 4096
  s_add_u32 s65, s65, 4096
  s_add_u32 s66, s66, 4096
  s_add_u32 s67, s67, 4096
  s_waitcnt vmcnt(12)
  v_mfma_f32_16x16x32_bf16 a[64:67], a[0:3], a[144:147], 0
  v_mfma_f32_16x16x32_bf16 a[68:71], a[0:3], a[148:151], 0
  v_mfma_f32_16x16x32_bf16 a[72:75], a[0:3], a[152:155], 0
  v_mfma_f32_16x16x32_bf16 a[76:79], a[0:3], a[156:159], 0
  buffer_load_dwordx4 a[0:3], v2, s[40:43], s13 offen offset:0 sc1
  v_mfma_f32_16x16x32_bf16 a[80:83], a[4:7], a[144:147], 0
  v_mfma_f32_16x16x32_bf16 a[84:87], a[4:7], a[148:151], 0
  v_mfma_f32_16x16x32_bf16 a[88:91], a[4:7], a[152:155], 0
  v_mfma_f32_16x16x32_bf16 a[92:95], a[4:7], a[156:159], 0
  buffer_load_dwordx4 a[4:7], v2, s[40:43], s13 offen offset:1024 sc1
  v_mfma_f32_16x16x32_bf16 a[96:99], a[8:11], a[144:147], 0
  v_mfma_f32_16x16x32_bf16 a[100:103], a[8:11], a[148:151], 0
  v_mfma_f32_16x16x32_bf16 a[104:107], a[8:11], a[152:155], 0
  v_mfma_f32_16x16x32_bf16 a[108:111], a[8:11], a[156:159], 0
  buffer_load_dwordx4 a[8:11], v2, s[40:43], s13 offen offset:2048 sc1
  v_mfma_f32_16x16x32_bf16 a[112:115], a[12:15], a[144:147], 0
  v_mfma_f32_16x16x32_bf16 a[116:119], a[12:15], a[148:151], 0
  v_mfma_f32_16x16x32_bf16 a[120:123], a[12:15], a[152:155], 0
  v_mfma_f32_16x16x32_bf16 a[124:127], a[12:15], a[156:159], 0
  v_mfma_f32_16x16x32_bf16 a[128:131], a[16:19], a[144:147], 0
  buffer_load_dwordx4 a[144:147], v2, s[40:43], s64 offen offset:0 sc1
  v_mfma_f32_16x16x32_bf16 a[132:135], a[16:19], a[148:151], 0
  buffer_load_dwordx4 a[148:151], v2, s[40:43], s65 offen offset:0 sc1
  v_mfma_f32_16x16x32_bf16 a[136:139], a[16:19], a[152:155], 0
  buffer_load_dwordx4 a[152:155], v2, s[40:43], s66 offen offset:0 sc1
  v_mfma_f32_16x16x32_bf16 a[140:143], a[16:19], a[156:159], 0
  buffer_load_dwordx4 a[156:159], v2, s[40:43], s67 offen offset:0 sc1
  s_waitcnt vmcnt(15)
  v_mfma_f32_16x16x32_bf16 a[64:67], a[20:23], a[160:163], a[64:67]
  v_mfma_f32_16x16x32_bf16 a[68:71], a[20:23], a[164:167], a[68:71]
  v_mfma_f32_16x16x32_bf16 a[72:75], a[20:23], a[168:171], a[72:75]
  v_mfma_f32_16x16x32_bf16 a[76:79], a[20:23], a[172:175], a[76:79]
  buffer_load_dwordx4 a[12:15], v2, s[40:43], s13 offen offset:3072 sc1
  v_mfma_f32_16x16x32_bf16 a[80:83], a[24:27], a[160:163], a[80:83]
  s_add_u32 s13, s13, 4096
  v_mfma_f32_16x16x32_bf16 a[84:87], a[24:27], a[164:167], a[84:87]
  v_mfma_f32_16x16x32_bf16 a[88:91], a[24:27], a[168:171], a[88:91]
  v_mfma_f32_16x16x32_bf16 a[92:95], a[24:27], a[172:175], a[92:95]
  buffer_load_dwordx4 a[16:19], v2, s[40:43], s13 offen offset:0 sc1
  v_mfma_f32_16x16x32_bf16 a[96:99], a[28:31], a[160:163], a[96:99]
  v_mfma_f32_16x16x32_bf16 a[100:103], a[28:31], a[164:167], a[100:103]
  v_mfma_f32_16x16x32_bf16 a[104:107], a[28:31], a[168:171], a[104:107]
  v_mfma_f32_16x16x32_bf16 a[108:111], a[28:31], a[172:175], a[108:111]
  buffer_load_dwordx4 a[20:23], v2, s[40:43], s13 offen offset:1024 sc1
  v_mfma_f32_16x16x32_bf16 a[112:115], a[32:35], a[160:163], a[112:115]
  v_mfma_f32_16x16x32_bf16 a[116:119], a[32:35], a[164:167], a[116:119]
  v_mfma_f32_16x16x32_bf16 a[120:123], a[32:35], a[168:171], a[120:123]
  v_mfma_f32_16x16x32_bf16 a[124:127], a[32:35], a[172:175], a[124:127]
  v_mfma_f32_16x16x32_bf16 a[128:131], a[36:39], a[160:163], a[128:131]
  buffer_load_dwordx4 a[160:163], v2, s[40:43], s64 offen offset:1024 sc1
  v_mfma_f32_16x16x32_bf16 a[132:135], a[36:39], a[164:167], a[132:135]
  buffer_load_dwordx4 a[164:167], v2, s[40:43], s65 offen offset:1024 sc1
  v_mfma_f32_16x16x32_bf16 a[136:139], a[36:39], a[168:171], a[136:139]
  buffer_load_dwordx4 a[168:171], v2, s[40:43], s66 offen offset:1024 sc1
  v_mfma_f32_16x16x32_bf16 a[140:143], a[36:39], a[172:175], a[140:143]
  buffer_load_dwordx4 a[172:175], v2, s[40:43], s67 offen offset:1024 sc1
  s_waitcnt vmcnt(18)
  v_mfma_f32_16x16x32_bf16 a[64:67], a[40:43], a[176:179], a[64:67]
  v_mfma_f32_16x16x32_bf16 a[68:71], a[40:43], a[180:183], a[68:71]
  v_mfma_f32_16x16x32_bf16 a[72:75], a[40:43], a[184:187], a[72:75]
  v_mfma_f32_16x16x32_bf16 a[76:79], a[40:43], a[188:191], a[76:79]
  buffer_load_dwordx4 a[24:27], v2, s[40:43], s13 offen offset:2048 sc1
  v_mfma_f32_16x16x32_bf16 a[80:83], a[44:47], a[176:179], a[80:83]
  v_mfma_f32_16x16x32_bf16 a[84:87], a[44:47], a[180:183], a[84:87]
  v_mfma_f32_16x16x32_bf16 a[88:91], a[44:47], a[184:187], a[88:91]
  v_mfma_f32_16x16x32_bf16 a[92:95], a[44:47], a[188:191], a[92:95]
  buffer_load_dwordx4 a[28:31], v2, s[40:43], s13 offen offset:3072 sc1
  v_mfma_f32_16x16x32_bf16 a[96:99], a[48:51], a[176:179], a[96:99]
  s_add_u32 s13, s13, 4096
  v_mfma_f32_16x16x32_bf16 a[100:103], a[48:51], a[180:183], a[100:103]
  v_mfma_f32_16x16x32_bf16 a[104:107], a[48:51], a[184:187], a[104:107]
  v_mfma_f32_16x16x32_bf16 a[108:111], a[48:51], a[188:191], a[108:111]
  buffer_load_dwordx4 a[32:35], v2, s[40:43], s13 offen offset:0 sc1
  v_mfma_f32_16x16x32_bf16 a[112:115], a[52:55], a[176:179], a[112:115]
  v_mfma_f32_16x16x32_bf16 a[116:119], a[52:55], a[180:183], a[116:119]
  v_mfma_f32_16x16x32_bf16 a[120:123], a[52:55], a[184:187], a[120:123]
  v_mfma_f32_16x16x32_bf16 a[124:127], a[52:55], a[188:191], a[124:127]
  v_mfma_f32_16x16x32_bf16 a[128:131], a[56:59], a[176:179], a[128:131]
  buffer_load_dwordx4 a[176:179], v2, s[40:43], s64 offen offset:2048 sc1
  v_mfma_f32_16x16x32_bf16 a[132:135], a[56:59], a[180:183], a[132:135]
  buffer_load_dwordx4 a[180:183], v2, s[40:43], s65 offen offset:2048 sc1
  v_mfma_f32_16x16x32_bf16 a[136:139], a[56:59], a[184:187], a[136:139]
  buffer_load_dwordx4 a[184:187], v2, s[40:43], s66 offen offset:2048 sc1
  v_mfma_f32_16x16x32_bf16 a[140:143], a[56:59], a[188:191], a[140:143]
  buffer_load_dwordx4 a[188:191], v2, s[40:43], s67 offen offset:2048 sc1
  s_waitcnt vmcnt(21)
  v_mfma_f32_16x16x32_bf16 a[64:67], a[60:63], v[216:219], a[64:67]
  v_mfma_f32_16x16x32_bf16 a[68:71], a[60:63], v[220:223], a[68:71]
  v_mfma_f32_16x16x32_bf16 a[72:75], a[60:63], v[224:227], a[72:75]
  v_mfma_f32_16x16x32_bf16 a[76:79], a[60:63], v[228:231], a[76:79]
  buffer_load_dwordx4 a[36:39], v2, s[40:43], s13 offen offset:1024 sc1
  v_mfma_f32_16x16x32_bf16 a[80:83], a[192:195], v[216:219], a[80:83]
  v_mfma_f32_16x16x32_bf16 a[84:87], a[192:195], v[220:223], a[84:87]
  v_mfma_f32_16x16x32_bf16 a[88:91], a[192:195], v[224:227], a[88:91]
  v_mfma_f32_16x16x32_bf16 a[92:95], a[192:195], v[228:231], a[92:95]
  buffer_load_dwordx4 a[40:43], v2, s[40:43], s13 offen offset:2048 sc1
  v_mfma_f32_16x16x32_bf16 a[96:99], a[196:199], v[216:219], a[96:99]
  v_mfma_f32_16x16x32_bf16 a[100:103], a[196:199], v[220:223], a[100:103]
  v_mfma_f32_16x16x32_bf16 a[104:107], a[196:199], v[224:227], a[104:107]
  v_mfma_f32_16x16x32_bf16 a[108:111], a[196:199], v[228:231], a[108:111]
  buffer_load_dwordx4 a[44:47], v2, s[40:43], s13 offen offset:3072 sc1
  v_mfma_f32_16x16x32_bf16 a[112:115], a[200:203], v[216:219], a[112:115]
  s_add_u32 s13, s13, 4096
  v_mfma_f32_16x16x32_bf16 a[116:119], a[200:203], v[220:223], a[116:119]
  v_mfma_f32_16x16x32_bf16 a[120:123], a[200:203], v[224:227], a[120:123]
  v_mfma_f32_16x16x32_bf16 a[124:127], a[200:203], v[228:231], a[124:127]
  v_mfma_f32_16x16x32_bf16 a[128:131], a[204:207], v[216:219], a[128:131]
  buffer_load_dwordx4 v[216:219], v2, s[40:43], s64 offen offset:3072 sc1
  v_mfma_f32_16x16x32_bf16 a[132:135], a[204:207], v[220:223], a[132:135]
  buffer_load_dwordx4 v[220:223], v2, s[40:43], s65 offen offset:3072 sc1
  v_mfma_f32_16x16x32_bf16 a[136:139], a[204:207], v[224:227], a[136:139]
  buffer_load_dwordx4 v[224:227], v2, s[40:43], s66 offen offset:3072 sc1
  v_mfma_f32_16x16x32_bf16 a[140:143], a[204:207], v[228:231], a[140:143]
  buffer_load_dwordx4 v[228:231], v2, s[40:43], s67 offen offset:3072 sc1
  s_waitcnt vmcnt(21)
  v_mfma_f32_16x16x32_bf16 a[64:67], a[208:211], a[144:147], a[64:67]
  s_add_u32 s64, s64, 4096
  v_mfma_f32_16x16x32_bf16 a[68:71], a[208:211], a[148:151], a[68:71]
  s_add_u32 s65, s65, 4096
  v_mfma_f32_16x16x32_bf16 a[72:75], a[208:211], a[152:155], a[72:75]
  s_add_u32 s66, s66, 4096
  v_mfma_f32_16x16x32_bf16 a[76:79], a[208:211], a[156:159], a[76:79]
  buffer_load_dwordx4 a[48:51], v2, s[40:43], s13 offen offset:0 sc1
  v_mfma_f32_16x16x32_bf16 a[80:83], a[212:215], a[144:147], a[80:83]
  v_mfma_f32_16x16x32_bf16 a[84:87], a[212:215], a[148:151], a[84:87]
  v_mfma_f32_16x16x32_bf16 a[88:91], a[212:215], a[152:155], a[88:91]
  s_add_u32 s67, s67, 4096
  v_mfma_f32_16x16x32_bf16 a[92:95], a[212:215], a[156:159], a[92:95]
  buffer_load_dwordx4 a[52:55], v2, s[40:43], s13 offen offset:1024 sc1
  v_mfma_f32_16x16x32_bf16 a[96:99], a[216:219], a[144:147], a[96:99]
  v_mfma_f32_16x16x32_bf16 a[100:103], a[216:219], a[148:151], a[100:103]
  v_mfma_f32_16x16x32_bf16 a[104:107], a[216:219], a[152:155], a[104:107]
  v_mfma_f32_16x16x32_bf16 a[108:111], a[216:219], a[156:159], a[108:111]
  buffer_load_dwordx4 a[56:59], v2, s[40:43], s13 offen offset:2048 sc1
  v_mfma_f32_16x16x32_bf16 a[112:115], a[220:223], a[144:147], a[112:115]
  v_mfma_f32_16x16x32_bf16 a[116:119], a[220:223], a[148:151], a[116:119]
  v_mfma_f32_16x16x32_bf16 a[120:123], a[220:223], a[152:155], a[120:123]
  v_mfma_f32_16x16x32_bf16 a[124:127], a[220:223], a[156:159], a[124:127]
  v_mfma_f32_16x16x32_bf16 a[128:131], a[224:227], a[144:147], a[128:131]
  buffer_load_dwordx4 a[144:147], v2, s[40:43], s64 offen offset:0 sc1
  v_mfma_f32_16x16x32_bf16 a[132:135], a[224:227], a[148:151], a[132:135]
  buffer_load_dwordx4 a[148:151], v2, s[40:43], s65 offen offset:0 sc1
  v_mfma_f32_16x16x32_bf16 a[136:139], a[224:227], a[152:155], a[136:139]
  buffer_load_dwordx4 a[152:155], v2, s[40:43], s66 offen offset:0 sc1
  v_mfma_f32_16x16x32_bf16 a[140:143], a[224:227], a[156:159], a[140:143]
  buffer_load_dwordx4 a[156:159], v2, s[40:43], s67 offen offset:0 sc1
  s_waitcnt vmcnt(21)
  v_mfma_f32_16x16x32_bf16 a[64:67], a[228:231], a[160:163], a[64:67]
  v_mfma_f32_16x16x32_bf16 a[68:71], a[228:231], a[164:167], a[68:71]
  v_mfma_f32_16x16x32_bf16 a[72:75], a[228:231], a[168:171], a[72:75]
  v_mfma_f32_16x16x32_bf16 a[76:79], a[228:231], a[172:175], a[76:79]
  buffer_load_dwordx4 a[60:63], v2, s[40:43], s13 offen offset:3072 sc1
  v_mfma_f32_16x16x32_bf16 a[80:83], a[232:235], a[160:163], a[80:83]
  s_add_u32 s13, s13, 4096
  v_mfma_f32_16x16x32_bf16 a[84:87], a[232:235], a[164:167], a[84:87]
  v_mfma_f32_16x16x32_bf16 a[88:91], a[232:235], a[168:171], a[88:91]
  v_mfma_f32_16x16x32_bf16 a[92:95], a[232:235], a[172:175], a[92:95]
  buffer_load_dwordx4 a[192:195], v2, s[40:43], s13 offen offset:0 sc1
  v_mfma_f32_16x16x32_bf16 a[96:99], a[236:239], a[160:163], a[96:99]
  v_mfma_f32_16x16x32_bf16 a[100:103], a[236:239], a[164:167], a[100:103]
  v_mfma_f32_16x16x32_bf16 a[104:107], a[236:239], a[168:171], a[104:107]
  v_mfma_f32_16x16x32_bf16 a[108:111], a[236:239], a[172:175], a[108:111]
  buffer_load_dwordx4 a[196:199], v2, s[40:43], s13 offen offset:1024 sc1
  v_mfma_f32_16x16x32_bf16 a[112:115], a[240:243], a[160:163], a[112:115]
  v_mfma_f32_16x16x32_bf16 a[116:119], a[240:243], a[164:167], a[116:119]
  v_mfma_f32_16x16x32_bf16 a[120:123], a[240:243], a[168:171], a[120:123]
  v_mfma_f32_16x16x32_bf16 a[124:127], a[240:243], a[172:175], a[124:127]
  v_mfma_f32_16x16x32_bf16 a[128:131], a[244:247], a[160:163], a[128:131]
  buffer_load_dwordx4 a[160:163], v2, s[40:43], s64 offen offset:1024 sc1
  v_mfma_f32_16x16x32_bf16 a[132:135], a[244:247], a[164:167], a[132:135]
  buffer_load_dwordx4 a[164:167], v2, s[40:43], s65 offen offset:1024 sc1
  v_mfma_f32_16x16x32_bf16 a[136:139], a[244:247], a[168:171], a[136:139]
  buffer_load_dwordx4 a[168:171], v2, s[40:43], s66 offen offset:1024 sc1
  v_mfma_f32_16x16x32_bf16 a[140:143], a[244:247], a[172:175], a[140:143]
  buffer_load_dwordx4 a[172:175], v2, s[40:43], s67 offen offset:1024 sc1
  s_waitcnt vmcnt(21)
  v_mfma_f32_16x16x32_bf16 a[64:67], a[248:251], a[176:179], a[64:67]
  v_mfma_f32_16x16x32_bf16 a[68:71], a[248:251], a[180:183], a[68:71]
  v_mfma_f32_16x16x32_bf16 a[72:75], a[248:251], a[184:187], a[72:75]
  v_mfma_f32_16x16x32_bf16 a[76:79], a[248:251], a[188:191], a[76:79]
  buffer_load_dwordx4 a[200:203], v2, s[40:43], s13 offen offset:2048 sc1
  v_mfma_f32_16x16x32_bf16 a[80:83], a[252:255], a[176:179], a[80:83]
  v_mfma_f32_16x16x32_bf16 a[84:87], a[252:255], a[180:183], a[84:87]
  v_mfma_f32_16x16x32_bf16 a[88:91], a[252:255], a[184:187], a[88:91]
  v_mfma_f32_16x16x32_bf16 a[92:95], a[252:255], a[188:191], a[92:95]
  buffer_load_dwordx4 a[204:207], v2, s[40:43], s13 offen offset:3072 sc1
  v_mfma_f32_16x16x32_bf16 a[96:99], v[32:35], a[176:179], a[96:99]
  s_add_u32 s13, s13, 4096
  v_mfma_f32_16x16x32_bf16 a[100:103], v[32:35], a[180:183], a[100:103]
  v_mfma_f32_16x16x32_bf16 a[104:107], v[32:35], a[184:187], a[104:107]
  v_mfma_f32_16x16x32_bf16 a[108:111], v[32:35], a[188:191], a[108:111]
  buffer_load_dwordx4 a[208:211], v2, s[40:43], s13 offen offset:0 sc1
  v_mfma_f32_16x16x32_bf16 a[112:115], v[36:39], a[176:179], a[112:115]
  v_mfma_f32_16x16x32_bf16 a[116:119], v[36:39], a[180:183], a[116:119]
  v_mfma_f32_16x16x32_bf16 a[120:123], v[36:39], a[184:187], a[120:123]
  v_mfma_f32_16x16x32_bf16 a[124:127], v[36:39], a[188:191], a[124:127]
  v_mfma_f32_16x16x32_bf16 a[128:131], v[40:43], a[176:179], a[128:131]
  buffer_load_dwordx4 a[176:179], v2, s[40:43], s64 offen offset:2048 sc1
  v_mfma_f32_16x16x32_bf16 a[132:135], v[40:43], a[180:183], a[132:135]
  buffer_load_dwordx4 a[180:183], v2, s[40:43], s65 offen offset:2048 sc1
  v_mfma_f32_16x16x32_bf16 a[136:139], v[40:43], a[184:187], a[136:139]
  buffer_load_dwordx4 a[184:187], v2, s[40:43], s66 offen offset:2048 sc1
  v_mfma_f32_16x16x32_bf16 a[140:143], v[40:43], a[188:191], a[140:143]
  buffer_load_dwordx4 a[188:191], v2, s[40:43], s67 offen offset:2048 sc1
  s_waitcnt vmcnt(21)
  v_mfma_f32_16x16x32_bf16 a[64:67], v[44:47], v[216:219], a[64:67]
  v_mfma_f32_16x16x32_bf16 a[68:71], v[44:47], v[220:223], a[68:71]
  v_mfma_f32_16x16x32_bf16 a[72:75], v[44:47], v[224:227], a[72:75]
  v_mfma_f32_16x16x32_bf16 a[76:79], v[44:47], v[228:231], a[76:79]
  buffer_load_dwordx4 a[212:215], v2, s[40:43], s13 offen offset:1024 sc1
  v_mfma_f32_16x16x32_bf16 a[80:83], v[48:51], v[216:219], a[80:83]
  v_mfma_f32_16x16x32_bf16 a[84:87], v[48:51], v[220:223], a[84:87]
  v_mfma_f32_16x16x32_bf16 a[88:91], v[48:51], v[224:227], a[88:91]
  v_mfma_f32_16x16x32_bf16 a[92:95], v[48:51], v[228:231], a[92:95]
  buffer_load_dwordx4 a[216:219], v2, s[40:43], s13 offen offset:2048 sc1
  v_mfma_f32_16x16x32_bf16 a[96:99], v[52:55], v[216:219], a[96:99]
  v_mfma_f32_16x16x32_bf16 a[100:103], v[52:55], v[220:223], a[100:103]
  v_mfma_f32_16x16x32_bf16 a[104:107], v[52:55], v[224:227], a[104:107]
  v_mfma_f32_16x16x32_bf16 a[108:111], v[52:55], v[228:231], a[108:111]
  buffer_load_dwordx4 a[220:223], v2, s[40:43], s13 offen offset:3072 sc1
  v_mfma_f32_16x16x32_bf16 a[112:115], v[56:59], v[216:219], a[112:115]
  s_add_u32 s13, s13, 4096
  v_mfma_f32_16x16x32_bf16 a[116:119], v[56:59], v[220:223], a[116:119]
  v_mfma_f32_16x16x32_bf16 a[120:123], v[56:59], v[224:227], a[120:123]
  v_mfma_f32_16x16x32_bf16 a[124:127], v[56:59], v[228:231], a[124:127]
  v_mfma_f32_16x16x32_bf16 a[128:131], v[60:63], v[216:219], a[128:131]
  buffer_load_dwordx4 v[216:219], v2, s[40:43], s64 offen offset:3072 sc1
  v_mfma_f32_16x16x32_bf16 a[132:135], v[60:63], v[220:223], a[132:135]
  buffer_load_dwordx4 v[220:223], v2, s[40:43], s65 offen offset:3072 sc1
  v_mfma_f32_16x16x32_bf16 a[136:139], v[60:63], v[224:227], a[136:139]
  buffer_load_dwordx4 v[224:227], v2, s[40:43], s66 offen offset:3072 sc1
  v_mfma_f32_16x16x32_bf16 a[140:143], v[60:63], v[228:231], a[140:143]
  buffer_load_dwordx4 v[228:231], v2, s[40:43], s67 offen offset:3072 sc1
  s_waitcnt vmcnt(21)
  v_mfma_f32_16x16x32_bf16 a[64:67], v[96:99], a[144:147], a[64:67]
  s_add_u32 s64, s64, 4096
  v_mfma_f32_16x16x32_bf16 a[68:71], v[96:99], a[148:151], a[68:71]
  s_add_u32 s65, s65, 4096
  v_mfma_f32_16x16x32_bf16 a[72:75], v[96:99], a[152:155], a[72:75]
  s_add_u32 s66, s66, 4096
  v_mfma_f32_16x16x32_bf16 a[76:79], v[96:99], a[156:159], a[76:79]
  buffer_load_dwordx4 a[224:227], v2, s[40:43], s13 offen offset:0 sc1
  v_mfma_f32_16x16x32_bf16 a[80:83], v[100:103], a[144:147], a[80:83]
  v_mfma_f32_16x16x32_bf16 a[84:87], v[100:103], a[148:151], a[84:87]
  v_mfma_f32_16x16x32_bf16 a[88:91], v[100:103], a[152:155], a[88:91]
  s_add_u32 s67, s67, 4096
  v_mfma_f32_16x16x32_bf16 a[92:95], v[100:103], a[156:159], a[92:95]
  buffer_load_dwordx4 a[228:231], v2, s[40:43], s13 offen offset:1024 sc1
  v_mfma_f32_16x16x32_bf16 a[96:99], v[104:107], a[144:147], a[96:99]
  v_mfma_f32_16x16x32_bf16 a[100:103], v[104:107], a[148:151], a[100:103]
  v_mfma_f32_16x16x32_bf16 a[104:107], v[104:107], a[152:155], a[104:107]
  v_mfma_f32_16x16x32_bf16 a[108:111], v[104:107], a[156:159], a[108:111]
  buffer_load_dwordx4 a[232:235], v2, s[40:43], s13 offen offset:2048 sc1
  v_mfma_f32_16x16x32_bf16 a[112:115], v[108:111], a[144:147], a[112:115]
  v_mfma_f32_16x16x32_bf16 a[116:119], v[108:111], a[148:151], a[116:119]
  v_mfma_f32_16x16x32_bf16 a[120:123], v[108:111], a[152:155], a[120:123]
  v_mfma_f32_16x16x32_bf16 a[124:127], v[108:111], a[156:159], a[124:127]
  v_mfma_f32_16x16x32_bf16 a[128:131], v[112:115], a[144:147], a[128:131]
  buffer_load_dwordx4 a[144:147], v2, s[40:43], s64 offen offset:0 sc1
  v_mfma_f32_16x16x32_bf16 a[132:135], v[112:115], a[148:151], a[132:135]
  buffer_load_dwordx4 a[148:151], v2, s[40:43], s65 offen offset:0 sc1
  v_mfma_f32_16x16x32_bf16 a[136:139], v[112:115], a[152:155], a[136:139]
  buffer_load_dwordx4 a[152:155], v2, s[40:43], s66 offen offset:0 sc1
  v_mfma_f32_16x16x32_bf16 a[140:143], v[112:115], a[156:159], a[140:143]
  buffer_load_dwordx4 a[156:159], v2, s[40:43], s67 offen offset:0 sc1
  s_waitcnt vmcnt(21)
  v_mfma_f32_16x16x32_bf16 a[64:67], v[116:119], a[160:163], a[64:67]
  v_mfma_f32_16x16x32_bf16 a[68:71], v[116:119], a[164:167], a[68:71]
  v_mfma_f32_16x16x32_bf16 a[72:75], v[116:119], a[168:171], a[72:75]
  v_mfma_f32_16x16x32_bf16 a[76:79], v[116:119], a[172:175], a[76:79]
  buffer_load_dwordx4 a[236:239], v2, s[40:43], s13 offen offset:3072 sc1
  v_mfma_f32_16x16x32_bf16 a[80:83], v[120:123], a[160:163], a[80:83]
  s_add_u32 s13, s13, 4096
  v_mfma_f32_16x16x32_bf16 a[84:87], v[120:123], a[164:167], a[84:87]
  v_mfma_f32_16x16x32_bf16 a[88:91], v[120:123], a[168:171], a[88:91]
  v_mfma_f32_16x16x32_bf16 a[92:95], v[120:123], a[172:175], a[92:95]
  buffer_load_dwordx4 a[240:243], v2, s[40:43], s13 offen offset:0 sc1
  v_mfma_f32_16x16x32_bf16 a[96:99], v[124:127], a[160:163], a[96:99]
  v_mfma_f32_16x16x32_bf16 a[100:103], v[124:127], a[164:167], a[100:103]
  v_mfma_f32_16x16x32_bf16 a[104:107], v[124:127], a[168:171], a[104:107]
  v_mfma_f32_16x16x32_bf16 a[108:111], v[124:127], a[172:175], a[108:111]
  buffer_load_dwordx4 a[244:247], v2, s[40:43], s13 offen offset:1024 sc1
  v_mfma_f32_16x16x32_bf16 a[112:115], v[160:163], a[160:163], a[112:115]
  v_mfma_f32_16x16x32_bf16 a[116:119], v[160:163], a[164:167], a[116:119]
  v_mfma_f32_16x16x32_bf16 a[120:123], v[160:163], a[168:171], a[120:123]
  v_mfma_f32_16x16x32_bf16 a[124:127], v[160:163], a[172:175], a[124:127]
  v_mfma_f32_16x16x32_bf16 a[128:131], v[164:167], a[160:163], a[128:131]
  buffer_load_dwordx4 a[160:163], v2, s[40:43], s64 offen offset:1024 sc1
  v_mfma_f32_16x16x32_bf16 a[132:135], v[164:167], a[164:167], a[132:135]
  buffer_load_dwordx4 a[164:167], v2, s[40:43], s65 offen offset:1024 sc1
  v_mfma_f32_16x16x32_bf16 a[136:139], v[164:167], a[168:171], a[136:139]
  buffer_load_dwordx4 a[168:171], v2, s[40:43], s66 offen offset:1024 sc1
  v_mfma_f32_16x16x32_bf16 a[140:143], v[164:167], a[172:175], a[140:143]
  buffer_load_dwordx4 a[172:175], v2, s[40:43], s67 offen offset:1024 sc1
  s_waitcnt vmcnt(21)
  v_mfma_f32_16x16x32_bf16 a[64:67], v[168:171], a[176:179], a[64:67]
  v_mfma_f32_16x16x32_bf16 a[68:71], v[168:171], a[180:183], a[68:71]
  v_mfma_f32_16x16x32_bf16 a[72:75], v[168:171], a[184:187], a[72:75]
  v_mfma_f32_16x16x32_bf16 a[76:79], v[168:171], a[188:191], a[76:79]
  buffer_load_dwordx4 a[248:251], v2, s[40:43], s13 offen offset:2048 sc1
  v_mfma_f32_16x16x32_bf16 a[80:83], v[172:175], a[176:179], a[80:83]
  v_mfma_f32_16x16x32_bf16 a[84:87], v[172:175], a[180:183], a[84:87]
  v_mfma_f32_16x16x32_bf16 a[88:91], v[172:175], a[184:187], a[88:91]
  v_mfma_f32_16x16x32_bf16 a[92:95], v[172:175], a[188:191], a[92:95]
  buffer_load_dwordx4 a[252:255], v2, s[40:43], s13 offen offset:3072 sc1
  v_mfma_f32_16x16x32_bf16 a[96:99], v[192:195], a[176:179], a[96:99]
  s_add_u32 s13, s13, 4096
  v_mfma_f32_16x16x32_bf16 a[100:103], v[192:195], a[180:183], a[100:103]
  v_mfma_f32_16x16x32_bf16 a[104:107], v[192:195], a[184:187], a[104:107]
  v_mfma_f32_16x16x32_bf16 a[108:111], v[192:195], a[188:191], a[108:111]
  buffer_load_dwordx4 v[32:35], v2, s[40:43], s13 offen offset:0 sc1
  v_mfma_f32_16x16x32_bf16 a[112:115], v[196:199], a[176:179], a[112:115]
  v_mfma_f32_16x16x32_bf16 a[116:119], v[196:199], a[180:183], a[116:119]
  v_mfma_f32_16x16x32_bf16 a[120:123], v[196:199], a[184:187], a[120:123]
  v_mfma_f32_16x16x32_bf16 a[124:127], v[196:199], a[188:191], a[124:127]
  v_mfma_f32_16x16x32_bf16 a[128:131], v[208:211], a[176:179], a[128:131]
  buffer_load_dwordx4 a[176:179], v2, s[40:43], s64 offen offset:2048 sc1
  v_mfma_f32_16x16x32_bf16 a[132:135], v[208:211], a[180:183], a[132:135]
  buffer_load_dwordx4 a[180:183], v2, s[40:43], s65 offen offset:2048 sc1
  v_mfma_f32_16x16x32_bf16 a[136:139], v[208:211], a[184:187], a[136:139]
  buffer_load_dwordx4 a[184:187], v2, s[40:43], s66 offen offset:2048 sc1
  v_mfma_f32_16x16x32_bf16 a[140:143], v[208:211], a[188:191], a[140:143]
  buffer_load_dwordx4 a[188:191], v2, s[40:43], s67 offen offset:2048 sc1
  s_waitcnt vmcnt(21)
  v_mfma_f32_16x16x32_bf16 a[64:67], v[212:215], v[216:219], a[64:67]
  v_mfma_f32_16x16x32_bf16 a[68:71], v[212:215], v[220:223], a[68:71]
  v_mfma_f32_16x16x32_bf16 a[72:75], v[212:215], v[224:227], a[72:75]
  v_mfma_f32_16x16x32_bf16 a[76:79], v[212:215], v[228:231], a[76:79]
  buffer_load_dwordx4 v[36:39], v2, s[40:43], s13 offen offset:1024 sc1
  v_mfma_f32_16x16x32_bf16 a[80:83], v[232:235], v[216:219], a[80:83]
  v_mfma_f32_16x16x32_bf16 a[84:87], v[232:235], v[220:223], a[84:87]
  v_mfma_f32_16x16x32_bf16 a[88:91], v[232:235], v[224:227], a[88:91]
  v_mfma_f32_16x16x32_bf16 a[92:95], v[232:235], v[228:231], a[92:95]
  buffer_load_dwordx4 v[40:43], v2, s[40:43], s13 offen offset:2048 sc1
  v_mfma_f32_16x16x32_bf16 a[96:99], v[236:239], v[216:219], a[96:99]
  v_mfma_f32_16x16x32_bf16 a[100:103], v[236:239], v[220:223], a[100:103]
  v_mfma_f32_16x16x32_bf16 a[104:107], v[236:239], v[224:227], a[104:107]
  v_mfma_f32_16x16x32_bf16 a[108:111], v[236:239], v[228:231], a[108:111]
  buffer_load_dwordx4 v[44:47], v2, s[40:43], s13 offen offset:3072 sc1
  v_mfma_f32_16x16x32_bf16 a[112:115], v[240:243], v[216:219], a[112:115]
  s_add_u32 s13, s13, 4096
  v_mfma_f32_16x16x32_bf16 a[116:119], v[240:243], v[220:223], a[116:119]
  v_mfma_f32_16x16x32_bf16 a[120:123], v[240:243], v[224:227], a[120:123]
  v_mfma_f32_16x16x32_bf16 a[124:127], v[240:243], v[228:231], a[124:127]
  v_mfma_f32_16x16x32_bf16 a[128:131], v[244:247], v[216:219], a[128:131]
  buffer_load_dwordx4 v[216:219], v2, s[40:43], s64 offen offset:3072 sc1
  v_mfma_f32_16x16x32_bf16 a[132:135], v[244:247], v[220:223], a[132:135]
  buffer_load_dwordx4 v[220:223], v2, s[40:43], s65 offen offset:3072 sc1
  v_mfma_f32_16x16x32_bf16 a[136:139], v[244:247], v[224:227], a[136:139]
  buffer_load_dwordx4 v[224:227], v2, s[40:43], s66 offen offset:3072 sc1
  v_mfma_f32_16x16x32_bf16 a[140:143], v[244:247], v[228:231], a[140:143]
  buffer_load_dwordx4 v[228:231], v2, s[40:43], s67 offen offset:3072 sc1
  s_waitcnt vmcnt(21)
  v_mfma_f32_16x16x32_bf16 a[64:67], v[64:67], a[144:147], a[64:67]
  s_add_u32 s64, s64, 4096
  v_mfma_f32_16x16x32_bf16 a[68:71], v[64:67], a[148:151], a[68:71]
  s_add_u32 s65, s65, 4096
  v_mfma_f32_16x16x32_bf16 a[72:75], v[64:67], a[152:155], a[72:75]
  s_add_u32 s66, s66, 4096
  v_mfma_f32_16x16x32_bf16 a[76:79], v[64:67], a[156:159], a[76:79]
  buffer_load_dwordx4 v[48:51], v2, s[40:43], s13 offen offset:0 sc1
  v_mfma_f32_16x16x32_bf16 a[80:83], v[68:71], a[144:147], a[80:83]
  v_mfma_f32_16x16x32_bf16 a[84:87], v[68:71], a[148:151], a[84:87]
  v_mfma_f32_16x16x32_bf16 a[88:91], v[68:71], a[152:155], a[88:91]
  s_add_u32 s67, s67, 4096
  v_mfma_f32_16x16x32_bf16 a[92:95], v[68:71], a[156:159], a[92:95]
  buffer_load_dwordx4 v[52:55], v2, s[40:43], s13 offen offset:1024 sc1
  v_mfma_f32_16x16x32_bf16 a[96:99], v[72:75], a[144:147], a[96:99]
  v_mfma_f32_16x16x32_bf16 a[100:103], v[72:75], a[148:151], a[100:103]
  v_mfma_f32_16x16x32_bf16 a[104:107], v[72:75], a[152:155], a[104:107]
  v_mfma_f32_16x16x32_bf16 a[108:111], v[72:75], a[156:159], a[108:111]
  buffer_load_dwordx4 v[56:59], v2, s[40:43], s13 offen offset:2048 sc1
  v_mfma_f32_16x16x32_bf16 a[112:115], v[76:79], a[144:147], a[112:115]
  v_mfma_f32_16x16x32_bf16 a[116:119], v[76:79], a[148:151], a[116:119]
  v_mfma_f32_16x16x32_bf16 a[120:123], v[76:79], a[152:155], a[120:123]
  v_mfma_f32_16x16x32_bf16 a[124:127], v[76:79], a[156:159], a[124:127]
  v_mfma_f32_16x16x32_bf16 a[128:131], v[80:83], a[144:147], a[128:131]
  buffer_load_dwordx4 a[144:147], v2, s[40:43], s64 offen offset:0 sc1
  v_mfma_f32_16x16x32_bf16 a[132:135], v[80:83], a[148:151], a[132:135]
  buffer_load_dwordx4 a[148:151], v2, s[40:43], s65 offen offset:0 sc1
  v_mfma_f32_16x16x32_bf16 a[136:139], v[80:83], a[152:155], a[136:139]
  buffer_load_dwordx4 a[152:155], v2, s[40:43], s66 offen offset:0 sc1
  v_mfma_f32_16x16x32_bf16 a[140:143], v[80:83], a[156:159], a[140:143]
  buffer_load_dwordx4 a[156:159], v2, s[40:43], s67 offen offset:0 sc1
  s_waitcnt vmcnt(21)
  v_mfma_f32_16x16x32_bf16 a[64:67], v[84:87], a[160:163], a[64:67]
  v_mfma_f32_16x16x32_bf16 a[68:71], v[84:87], a[164:167], a[68:71]
  v_mfma_f32_16x16x32_bf16 a[72:75], v[84:87], a[168:171], a[72:75]
  v_mfma_f32_16x16x32_bf16 a[76:79], v[84:87], a[172:175], a[76:79]
  buffer_load_dwordx4 v[60:63], v2, s[40:43], s13 offen offset:3072 sc1
  v_mfma_f32_16x16x32_bf16 a[80:83], v[88:91], a[160:163], a[80:83]
  s_add_u32 s13, s13, 4096
  v_mfma_f32_16x16x32_bf16 a[84:87], v[88:91], a[164:167], a[84:87]
  v_mfma_f32_16x16x32_bf16 a[88:91], v[88:91], a[168:171], a[88:91]
  v_mfma_f32_16x16x32_bf16 a[92:95], v[88:91], a[172:175], a[92:95]
  buffer_load_dwordx4 v[96:99], v2, s[40:43], s13 offen offset:0 sc1
  v_mfma_f32_16x16x32_bf16 a[96:99], v[92:95], a[160:163], a[96:99]
  v_mfma_f32_16x16x32_bf16 a[100:103], v[92:95], a[164:167], a[100:103]
  v_mfma_f32_16x16x32_bf16 a[104:107], v[92:95], a[168:171], a[104:107]
  v_mfma_f32_16x16x32_bf16 a[108:111], v[92:95], a[172:175], a[108:111]
  buffer_load_dwordx4 v[100:103], v2, s[40:43], s13 offen offset:1024 sc1
  v_mfma_f32_16x16x32_bf16 a[112:115], v[128:131], a[160:163], a[112:115]
  v_mfma_f32_16x16x32_bf16 a[116:119], v[128:131], a[164:167], a[116:119]
  v_mfma_f32_16x16x32_bf16 a[120:123], v[128:131], a[168:171], a[120:123]
  v_mfma_f32_16x16x32_bf16 a[124:127], v[128:131], a[172:175], a[124:127]
  v_mfma_f32_16x16x32_bf16 a[128:131], v[132:135], a[160:163], a[128:131]
  buffer_load_dwordx4 a[160:163], v2, s[40:43], s64 offen offset:1024 sc1
  v_mfma_f32_16x16x32_bf16 a[132:135], v[132:135], a[164:167], a[132:135]
  buffer_load_dwordx4 a[164:167], v2, s[40:43], s65 offen offset:1024 sc1
  v_mfma_f32_16x16x32_bf16 a[136:139], v[132:135], a[168:171], a[136:139]
  buffer_load_dwordx4 a[168:171], v2, s[40:43], s66 offen offset:1024 sc1
  v_mfma_f32_16x16x32_bf16 a[140:143], v[132:135], a[172:175], a[140:143]
  buffer_load_dwordx4 a[172:175], v2, s[40:43], s67 offen offset:1024 sc1
  s_waitcnt vmcnt(21)
  v_mfma_f32_16x16x32_bf16 a[64:67], v[136:139], a[176:179], a[64:67]
  v_mfma_f32_16x16x32_bf16 a[68:71], v[136:139], a[180:183], a[68:71]
  v_mfma_f32_16x16x32_bf16 a[72:75], v[136:139], a[184:187], a[72:75]
  v_mfma_f32_16x16x32_bf16 a[76:79], v[136:139], a[188:191], a[76:79]
  buffer_load_dwordx4 v[104:107], v2, s[40:43], s13 offen offset:2048 sc1
  v_mfma_f32_16x16x32_bf16 a[80:83], v[140:143], a[176:179], a[80:83]
  v_mfma_f32_16x16x32_bf16 a[84:87], v[140:143], a[180:183], a[84:87]
  v_mfma_f32_16x16x32_bf16 a[88:91], v[140:143], a[184:187], a[88:91]
  v_mfma_f32_16x16x32_bf16 a[92:95], v[140:143], a[188:191], a[92:95]
  buffer_load_dwordx4 v[108:111], v2, s[40:43], s13 offen offset:3072 sc1
  v_mfma_f32_16x16x32_bf16 a[96:99], v[144:147], a[176:179], a[96:99]
  s_add_u32 s13, s13, 4096
  v_mfma_f32_16x16x32_bf16 a[100:103], v[144:147], a[180:183], a[100:103]
  v_mfma_f32_16x16x32_bf16 a[104:107], v[144:147], a[184:187], a[104:107]
  v_mfma_f32_16x16x32_bf16 a[108:111], v[144:147], a[188:191], a[108:111]
  buffer_load_dwordx4 v[112:115], v2, s[40:43], s13 offen offset:0 sc1
  v_mfma_f32_16x16x32_bf16 a[112:115], v[148:151], a[176:179], a[112:115]
  v_mfma_f32_16x16x32_bf16 a[116:119], v[148:151], a[180:183], a[116:119]
  v_mfma_f32_16x16x32_bf16 a[120:123], v[148:151], a[184:187], a[120:123]
  v_mfma_f32_16x16x32_bf16 a[124:127], v[148:151], a[188:191], a[124:127]
  v_mfma_f32_16x16x32_bf16 a[128:131], v[152:155], a[176:179], a[128:131]
  buffer_load_dwordx4 a[176:179], v2, s[40:43], s64 offen offset:2048 sc1
  v_mfma_f32_16x16x32_bf16 a[132:135], v[152:155], a[180:183], a[132:135]
  buffer_load_dwordx4 a[180:183], v2, s[40:43], s65 offen offset:2048 sc1
  v_mfma_f32_16x16x32_bf16 a[136:139], v[152:155], a[184:187], a[136:139]
  buffer_load_dwordx4 a[184:187], v2, s[40:43], s66 offen offset:2048 sc1
  v_mfma_f32_16x16x32_bf16 a[140:143], v[152:155], a[188:191], a[140:143]
  buffer_load_dwordx4 a[188:191], v2, s[40:43], s67 offen offset:2048 sc1
  s_waitcnt vmcnt(21)
  v_mfma_f32_16x16x32_bf16 a[64:67], v[156:159], v[216:219], a[64:67]
  v_mfma_f32_16x16x32_bf16 a[68:71], v[156:159], v[220:223], a[68:71]
  v_mfma_f32_16x16x32_bf16 a[72:75], v[156:159], v[224:227], a[72:75]
  v_mfma_f32_16x16x32_bf16 a[76:79], v[156:159], v[228:231], a[76:79]
  buffer_load_dwordx4 v[116:119], v2, s[40:43], s13 offen offset:1024 sc1
  v_mfma_f32_16x16x32_bf16 a[80:83], v[176:179], v[216:219], a[80:83]
  v_mfma_f32_16x16x32_bf16 a[84:87], v[176:179], v[220:223], a[84:87]
  v_mfma_f32_16x16x32_bf16 a[88:91], v[176:179], v[224:227], a[88:91]
  v_mfma_f32_16x16x32_bf16 a[92:95], v[176:179], v[228:231], a[92:95]
  buffer_load_dwordx4 v[120:123], v2, s[40:43], s13 offen offset:2048 sc1
  v_mfma_f32_16x16x32_bf16 a[96:99], v[180:183], v[216:219], a[96:99]
  v_mfma_f32_16x16x32_bf16 a[100:103], v[180:183], v[220:223], a[100:103]
  v_mfma_f32_16x16x32_bf16 a[104:107], v[180:183], v[224:227], a[104:107]
  v_mfma_f32_16x16x32_bf16 a[108:111], v[180:183], v[228:231], a[108:111]
  buffer_load_dwordx4 v[124:127], v2, s[40:43], s13 offen offset:3072 sc1
  v_mfma_f32_16x16x32_bf16 a[112:115], v[184:187], v[216:219], a[112:115]
  s_add_u32 s13, s13, 4096
  v_mfma_f32_16x16x32_bf16 a[116:119], v[184:187], v[220:223], a[116:119]
  v_mfma_f32_16x16x32_bf16 a[120:123], v[184:187], v[224:227], a[120:123]
  v_mfma_f32_16x16x32_bf16 a[124:127], v[184:187], v[228:231], a[124:127]
  v_mfma_f32_16x16x32_bf16 a[128:131], v[188:191], v[216:219], a[128:131]
  buffer_load_dwordx4 v[216:219], v2, s[40:43], s64 offen offset:3072 sc1
  v_mfma_f32_16x16x32_bf16 a[132:135], v[188:191], v[220:223], a[132:135]
  buffer_load_dwordx4 v[220:223], v2, s[40:43], s65 offen offset:3072 sc1
  v_mfma_f32_16x16x32_bf16 a[136:139], v[188:191], v[224:227], a[136:139]
  buffer_load_dwordx4 v[224:227], v2, s[40:43], s66 offen offset:3072 sc1
  v_mfma_f32_16x16x32_bf16 a[140:143], v[188:191], v[228:231], a[140:143]
  buffer_load_dwordx4 v[228:231], v2, s[40:43], s67 offen offset:3072 sc1
  s_waitcnt vmcnt(21)
  v_mfma_f32_16x16x32_bf16 a[64:67], a[0:3], a[144:147], a[64:67]
  s_add_u32 s64, s64, 4096
  v_mfma_f32_16x16x32_bf16 a[68:71], a[0:3], a[148:151], a[68:71]
  s_add_u32 s65, s65, 4096
  v_mfma_f32_16x16x32_bf16 a[72:75], a[0:3], a[152:155], a[72:75]
  s_add_u32 s66, s66, 4096
  v_mfma_f32_16x16x32_bf16 a[76:79], a[0:3], a[156:159], a[76:79]
  buffer_load_dwordx4 v[160:163], v2, s[40:43], s13 offen offset:0 sc1
  v_mfma_f32_16x16x32_bf16 a[80:83], a[4:7], a[144:147], a[80:83]
  v_mfma_f32_16x16x32_bf16 a[84:87], a[4:7], a[148:151], a[84:87]
  v_mfma_f32_16x16x32_bf16 a[88:91], a[4:7], a[152:155], a[88:91]
  s_add_u32 s67, s67, 4096
  v_mfma_f32_16x16x32_bf16 a[92:95], a[4:7], a[156:159], a[92:95]
  buffer_load_dwordx4 v[164:167], v2, s[40:43], s13 offen offset:1024 sc1
  v_mfma_f32_16x16x32_bf16 a[96:99], a[8:11], a[144:147], a[96:99]
  v_mfma_f32_16x16x32_bf16 a[100:103], a[8:11], a[148:151], a[100:103]
  v_mfma_f32_16x16x32_bf16 a[104:107], a[8:11], a[152:155], a[104:107]
  v_mfma_f32_16x16x32_bf16 a[108:111], a[8:11], a[156:159], a[108:111]
  buffer_load_dwordx4 v[168:171], v2, s[40:43], s13 offen offset:2048 sc1
  v_mfma_f32_16x16x32_bf16 a[112:115], a[12:15], a[144:147], a[112:115]
  v_mfma_f32_16x16x32_bf16 a[116:119], a[12:15], a[148:151], a[116:119]
  v_mfma_f32_16x16x32_bf16 a[120:123], a[12:15], a[152:155], a[120:123]
  v_mfma_f32_16x16x32_bf16 a[124:127], a[12:15], a[156:159], a[124:127]
  v_mfma_f32_16x16x32_bf16 a[128:131], a[16:19], a[144:147], a[128:131]
  buffer_load_dwordx4 a[144:147], v2, s[40:43], s64 offen offset:0 sc1
  v_mfma_f32_16x16x32_bf16 a[132:135], a[16:19], a[148:151], a[132:135]
  buffer_load_dwordx4 a[148:151], v2, s[40:43], s65 offen offset:0 sc1
  v_mfma_f32_16x16x32_bf16 a[136:139], a[16:19], a[152:155], a[136:139]
  buffer_load_dwordx4 a[152:155], v2, s[40:43], s66 offen offset:0 sc1
  v_mfma_f32_16x16x32_bf16 a[140:143], a[16:19], a[156:159], a[140:143]
  buffer_load_dwordx4 a[156:159], v2, s[40:43], s67 offen offset:0 sc1
  s_waitcnt vmcnt(21)
  v_mfma_f32_16x16x32_bf16 a[64:67], a[20:23], a[160:163], a[64:67]
  v_mfma_f32_16x16x32_bf16 a[68:71], a[20:23], a[164:167], a[68:71]
  v_mfma_f32_16x16x32_bf16 a[72:75], a[20:23], a[168:171], a[72:75]
  v_mfma_f32_16x16x32_bf16 a[76:79], a[20:23], a[172:175], a[76:79]
  buffer_load_dwordx4 v[172:175], v2, s[40:43], s13 offen offset:3072 sc1
  v_mfma_f32_16x16x32_bf16 a[80:83], a[24:27], a[160:163], a[80:83]
  s_add_u32 s13, s13, 4096
  v_mfma_f32_16x16x32_bf16 a[84:87], a[24:27], a[164:167], a[84:87]
  v_mfma_f32_16x16x32_bf16 a[88:91], a[24:27], a[168:171], a[88:91]
  v_mfma_f32_16x16x32_bf16 a[92:95], a[24:27], a[172:175], a[92:95]
  buffer_load_dwordx4 v[192:195], v2, s[40:43], s13 offen offset:0 sc1
  v_mfma_f32_16x16x32_bf16 a[96:99], a[28:31], a[160:163], a[96:99]
  v_mfma_f32_16x16x32_bf16 a[100:103], a[28:31], a[164:167], a[100:103]
  v_mfma_f32_16x16x32_bf16 a[104:107], a[28:31], a[168:171], a[104:107]
  v_mfma_f32_16x16x32_bf16 a[108:111], a[28:31], a[172:175], a[108:111]
  buffer_load_dwordx4 v[196:199], v2, s[40:43], s13 offen offset:1024 sc1
  v_mfma_f32_16x16x32_bf16 a[112:115], a[32:35], a[160:163], a[112:115]
  v_mfma_f32_16x16x32_bf16 a[116:119], a[32:35], a[164:167], a[116:119]
  v_mfma_f32_16x16x32_bf16 a[120:123], a[32:35], a[168:171], a[120:123]
  v_mfma_f32_16x16x32_bf16 a[124:127], a[32:35], a[172:175], a[124:127]
  v_mfma_f32_16x16x32_bf16 a[128:131], a[36:39], a[160:163], a[128:131]
  buffer_load_dwordx4 a[160:163], v2, s[40:43], s64 offen offset:1024 sc1
  v_mfma_f32_16x16x32_bf16 a[132:135], a[36:39], a[164:167], a[132:135]
  buffer_load_dwordx4 a[164:167], v2, s[40:43], s65 offen offset:1024 sc1
  v_mfma_f32_16x16x32_bf16 a[136:139], a[36:39], a[168:171], a[136:139]
  buffer_load_dwordx4 a[168:171], v2, s[40:43], s66 offen offset:1024 sc1
  v_mfma_f32_16x16x32_bf16 a[140:143], a[36:39], a[172:175], a[140:143]
  buffer_load_dwordx4 a[172:175], v2, s[40:43], s67 offen offset:1024 sc1
  s_waitcnt vmcnt(21)
  v_mfma_f32_16x16x32_bf16 a[64:67], a[40:43], a[176:179], a[64:67]
  v_mfma_f32_16x16x32_bf16 a[68:71], a[40:43], a[180:183], a[68:71]
  v_mfma_f32_16x16x32_bf16 a[72:75], a[40:43], a[184:187], a[72:75]
  v_mfma_f32_16x16x32_bf16 a[76:79], a[40:43], a[188:191], a[76:79]
  buffer_load_dwordx4 v[208:211], v2, s[40:43], s13 offen offset:2048 sc1
  v_mfma_f32_16x16x32_bf16 a[80:83], a[44:47], a[176:179], a[80:83]
  v_mfma_f32_16x16x32_bf16 a[84:87], a[44:47], a[180:183], a[84:87]
  v_mfma_f32_16x16x32_bf16 a[88:91], a[44:47], a[184:187], a[88:91]
  v_mfma_f32_16x16x32_bf16 a[92:95], a[44:47], a[188:191], a[92:95]
  buffer_load_dwordx4 v[212:215], v2, s[40:43], s13 offen offset:3072 sc1
  v_mfma_f32_16x16x32_bf16 a[96:99], a[48:51], a[176:179], a[96:99]
  s_add_u32 s13, s13, 4096
  v_mfma_f32_16x16x32_bf16 a[100:103], a[48:51], a[180:183], a[100:103]
  v_mfma_f32_16x16x32_bf16 a[104:107], a[48:51], a[184:187], a[104:107]
  v_mfma_f32_16x16x32_bf16 a[108:111], a[48:51], a[188:191], a[108:111]
  buffer_load_dwordx4 v[232:235], v2, s[40:43], s13 offen offset:0 sc1
  v_mfma_f32_16x16x32_bf16 a[112:115], a[52:55], a[176:179], a[112:115]
  v_mfma_f32_16x16x32_bf16 a[116:119], a[52:55], a[180:183], a[116:119]
  v_mfma_f32_16x16x32_bf16 a[120:123], a[52:55], a[184:187], a[120:123]
  v_mfma_f32_16x16x32_bf16 a[124:127], a[52:55], a[188:191], a[124:127]
  v_mfma_f32_16x16x32_bf16 a[128:131], a[56:59], a[176:179], a[128:131]
  buffer_load_dwordx4 a[176:179], v2, s[40:43], s64 offen offset:2048 sc1
  v_mfma_f32_16x16x32_bf16 a[132:135], a[56:59], a[180:183], a[132:135]
  buffer_load_dwordx4 a[180:183], v2, s[40:43], s65 offen offset:2048 sc1
  v_mfma_f32_16x16x32_bf16 a[136:139], a[56:59], a[184:187], a[136:139]
  buffer_load_dwordx4 a[184:187], v2, s[40:43], s66 offen offset:2048 sc1
  v_mfma_f32_16x16x32_bf16 a[140:143], a[56:59], a[188:191], a[140:143]
  buffer_load_dwordx4 a[188:191], v2, s[40:43], s67 offen offset:2048 sc1
  s_waitcnt vmcnt(21)
  v_mfma_f32_16x16x32_bf16 a[64:67], a[60:63], v[216:219], a[64:67]
  v_mfma_f32_16x16x32_bf16 a[68:71], a[60:63], v[220:223], a[68:71]
  v_mfma_f32_16x16x32_bf16 a[72:75], a[60:63], v[224:227], a[72:75]
  v_mfma_f32_16x16x32_bf16 a[76:79], a[60:63], v[228:231], a[76:79]
  buffer_load_dwordx4 v[236:239], v2, s[40:43], s13 offen offset:1024 sc1
  v_mfma_f32_16x16x32_bf16 a[80:83], a[192:195], v[216:219], a[80:83]
  v_mfma_f32_16x16x32_bf16 a[84:87], a[192:195], v[220:223], a[84:87]
  v_mfma_f32_16x16x32_bf16 a[88:91], a[192:195], v[224:227], a[88:91]
  v_mfma_f32_16x16x32_bf16 a[92:95], a[192:195], v[228:231], a[92:95]
  buffer_load_dwordx4 v[240:243], v2, s[40:43], s13 offen offset:2048 sc1
  v_mfma_f32_16x16x32_bf16 a[96:99], a[196:199], v[216:219], a[96:99]
  v_mfma_f32_16x16x32_bf16 a[100:103], a[196:199], v[220:223], a[100:103]
  v_mfma_f32_16x16x32_bf16 a[104:107], a[196:199], v[224:227], a[104:107]
  v_mfma_f32_16x16x32_bf16 a[108:111], a[196:199], v[228:231], a[108:111]
  buffer_load_dwordx4 v[244:247], v2, s[40:43], s13 offen offset:3072 sc1
  v_mfma_f32_16x16x32_bf16 a[112:115], a[200:203], v[216:219], a[112:115]
  s_add_u32 s13, s13, 4096
  v_mfma_f32_16x16x32_bf16 a[116:119], a[200:203], v[220:223], a[116:119]
  v_mfma_f32_16x16x32_bf16 a[120:123], a[200:203], v[224:227], a[120:123]
  v_mfma_f32_16x16x32_bf16 a[124:127], a[200:203], v[228:231], a[124:127]
  v_mfma_f32_16x16x32_bf16 a[128:131], a[204:207], v[216:219], a[128:131]
  buffer_load_dwordx4 v[216:219], v2, s[40:43], s64 offen offset:3072 sc1
  v_mfma_f32_16x16x32_bf16 a[132:135], a[204:207], v[220:223], a[132:135]
  buffer_load_dwordx4 v[220:223], v2, s[40:43], s65 offen offset:3072 sc1
  v_mfma_f32_16x16x32_bf16 a[136:139], a[204:207], v[224:227], a[136:139]
  buffer_load_dwordx4 v[224:227], v2, s[40:43], s66 offen offset:3072 sc1
  v_mfma_f32_16x16x32_bf16 a[140:143], a[204:207], v[228:231], a[140:143]
  buffer_load_dwordx4 v[228:231], v2, s[40:43], s67 offen offset:3072 sc1
  s_waitcnt vmcnt(21)
  v_mfma_f32_16x16x32_bf16 a[64:67], a[208:211], a[144:147], a[64:67]
  s_add_u32 s64, s64, 4096
  v_mfma_f32_16x16x32_bf16 a[68:71], a[208:211], a[148:151], a[68:71]
  s_add_u32 s65, s65, 4096
  v_mfma_f32_16x16x32_bf16 a[72:75], a[208:211], a[152:155], a[72:75]
  s_add_u32 s66, s66, 4096
  v_mfma_f32_16x16x32_bf16 a[76:79], a[208:211], a[156:159], a[76:79]
  buffer_load_dwordx4 v[64:67], v2, s[40:43], s13 offen offset:0 sc1
  v_mfma_f32_16x16x32_bf16 a[80:83], a[212:215], a[144:147], a[80:83]
  v_mfma_f32_16x16x32_bf16 a[84:87], a[212:215], a[148:151], a[84:87]
  v_mfma_f32_16x16x32_bf16 a[88:91], a[212:215], a[152:155], a[88:91]
  s_add_u32 s67, s67, 4096
  v_mfma_f32_16x16x32_bf16 a[92:95], a[212:215], a[156:159], a[92:95]
  buffer_load_dwordx4 v[68:71], v2, s[40:43], s13 offen offset:1024 sc1
  v_mfma_f32_16x16x32_bf16 a[96:99], a[216:219], a[144:147], a[96:99]
  v_mfma_f32_16x16x32_bf16 a[100:103], a[216:219], a[148:151], a[100:103]
  v_mfma_f32_16x16x32_bf16 a[104:107], a[216:219], a[152:155], a[104:107]
  v_mfma_f32_16x16x32_bf16 a[108:111], a[216:219], a[156:159], a[108:111]
  buffer_load_dwordx4 v[72:75], v2, s[40:43], s13 offen offset:2048 sc1
  v_mfma_f32_16x16x32_bf16 a[112:115], a[220:223], a[144:147], a[112:115]
  v_mfma_f32_16x16x32_bf16 a[116:119], a[220:223], a[148:151], a[116:119]
  v_mfma_f32_16x16x32_bf16 a[120:123], a[220:223], a[152:155], a[120:123]
  v_mfma_f32_16x16x32_bf16 a[124:127], a[220:223], a[156:159], a[124:127]
  v_mfma_f32_16x16x32_bf16 a[128:131], a[224:227], a[144:147], a[128:131]
  buffer_load_dwordx4 a[144:147], v2, s[40:43], s64 offen offset:0 sc1
  v_mfma_f32_16x16x32_bf16 a[132:135], a[224:227], a[148:151], a[132:135]
  buffer_load_dwordx4 a[148:151], v2, s[40:43], s65 offen offset:0 sc1
  v_mfma_f32_16x16x32_bf16 a[136:139], a[224:227], a[152:155], a[136:139]
  buffer_load_dwordx4 a[152:155], v2, s[40:43], s66 offen offset:0 sc1
  v_mfma_f32_16x16x32_bf16 a[140:143], a[224:227], a[156:159], a[140:143]
  buffer_load_dwordx4 a[156:159], v2, s[40:43], s67 offen offset:0 sc1
  s_waitcnt vmcnt(21)
  v_mfma_f32_16x16x32_bf16 a[64:67], a[228:231], a[160:163], a[64:67]
  v_mfma_f32_16x16x32_bf16 a[68:71], a[228:231], a[164:167], a[68:71]
  v_mfma_f32_16x16x32_bf16 a[72:75], a[228:231], a[168:171], a[72:75]
  v_mfma_f32_16x16x32_bf16 a[76:79], a[228:231], a[172:175], a[76:79]
  buffer_load_dwordx4 v[76:79], v2, s[40:43], s13 offen offset:3072 sc1
  v_mfma_f32_16x16x32_bf16 a[80:83], a[232:235], a[160:163], a[80:83]
  s_add_u32 s13, s13, 4096
  v_mfma_f32_16x16x32_bf16 a[84:87], a[232:235], a[164:167], a[84:87]
  v_mfma_f32_16x16x32_bf16 a[88:91], a[232:235], a[168:171], a[88:91]
  v_mfma_f32_16x16x32_bf16 a[92:95], a[232:235], a[172:175], a[92:95]
  buffer_load_dwordx4 v[80:83], v2, s[40:43], s13 offen offset:0 sc1
  v_mfma_f32_16x16x32_bf16 a[96:99], a[236:239], a[160:163], a[96:99]
  v_mfma_f32_16x16x32_bf16 a[100:103], a[236:239], a[164:167], a[100:103]
  v_mfma_f32_16x16x32_bf16 a[104:107], a[236:239], a[168:171], a[104:107]
  v_mfma_f32_16x16x32_bf16 a[108:111], a[236:239], a[172:175], a[108:111]
  buffer_load_dwordx4 v[84:87], v2, s[40:43], s13 offen offset:1024 sc1
  v_mfma_f32_16x16x32_bf16 a[112:115], a[240:243], a[160:163], a[112:115]
  v_mfma_f32_16x16x32_bf16 a[116:119], a[240:243], a[164:167], a[116:119]
  v_mfma_f32_16x16x32_bf16 a[120:123], a[240:243], a[168:171], a[120:123]
  v_mfma_f32_16x16x32_bf16 a[124:127], a[240:243], a[172:175], a[124:127]
  v_mfma_f32_16x16x32_bf16 a[128:131], a[244:247], a[160:163], a[128:131]
  buffer_load_dwordx4 a[160:163], v2, s[40:43], s64 offen offset:1024 sc1
  v_mfma_f32_16x16x32_bf16 a[132:135], a[244:247], a[164:167], a[132:135]
  buffer_load_dwordx4 a[164:167], v2, s[40:43], s65 offen offset:1024 sc1
  v_mfma_f32_16x16x32_bf16 a[136:139], a[244:247], a[168:171], a[136:139]
  buffer_load_dwordx4 a[168:171], v2, s[40:43], s66 offen offset:1024 sc1
  v_mfma_f32_16x16x32_bf16 a[140:143], a[244:247], a[172:175], a[140:143]
  buffer_load_dwordx4 a[172:175], v2, s[40:43], s67 offen offset:1024 sc1
  s_waitcnt vmcnt(21)
  v_mfma_f32_16x16x32_bf16 a[64:67], a[248:251], a[176:179], a[64:67]
  v_mfma_f32_16x16x32_bf16 a[68:71], a[248:251], a[180:183], a[68:71]
  v_mfma_f32_16x16x32_bf16 a[72:75], a[248:251], a[184:187], a[72:75]
  v_mfma_f32_16x16x32_bf16 a[76:79], a[248:251], a[188:191], a[76:79]
  buffer_load_dwordx4 v[88:91], v2, s[40:43], s13 offen offset:2048 sc1
  v_mfma_f32_16x16x32_bf16 a[80:83], a[252:255], a[176:179], a[80:83]
  v_mfma_f32_16x16x32_bf16 a[84:87], a[252:255], a[180:183], a[84:87]
  v_mfma_f32_16x16x32_bf16 a[88:91], a[252:255], a[184:187], a[88:91]
  v_mfma_f32_16x16x32_bf16 a[92:95], a[252:255], a[188:191], a[92:95]
  buffer_load_dwordx4 v[92:95], v2, s[40:43], s13 offen offset:3072 sc1
  v_mfma_f32_16x16x32_bf16 a[96:99], v[32:35], a[176:179], a[96:99]
  s_add_u32 s13, s13, 4096
  v_mfma_f32_16x16x32_bf16 a[100:103], v[32:35], a[180:183], a[100:103]
  v_mfma_f32_16x16x32_bf16 a[104:107], v[32:35], a[184:187], a[104:107]
  v_mfma_f32_16x16x32_bf16 a[108:111], v[32:35], a[188:191], a[108:111]
  buffer_load_dwordx4 v[128:131], v2, s[40:43], s13 offen offset:0 sc1
  v_mfma_f32_16x16x32_bf16 a[112:115], v[36:39], a[176:179], a[112:115]
  v_mfma_f32_16x16x32_bf16 a[116:119], v[36:39], a[180:183], a[116:119]
  v_mfma_f32_16x16x32_bf16 a[120:123], v[36:39], a[184:187], a[120:123]
  v_mfma_f32_16x16x32_bf16 a[124:127], v[36:39], a[188:191], a[124:127]
  v_mfma_f32_16x16x32_bf16 a[128:131], v[40:43], a[176:179], a[128:131]
  buffer_load_dwordx4 a[176:179], v2, s[40:43], s64 offen offset:2048 sc1
  v_mfma_f32_16x16x32_bf16 a[132:135], v[40:43], a[180:183], a[132:135]
  buffer_load_dwordx4 a[180:183], v2, s[40:43], s65 offen offset:2048 sc1
  v_mfma_f32_16x16x32_bf16 a[136:139], v[40:43], a[184:187], a[136:139]
  buffer_load_dwordx4 a[184:187], v2, s[40:43], s66 offen offset:2048 sc1
  v_mfma_f32_16x16x32_bf16 a[140:143], v[40:43], a[188:191], a[140:143]
  buffer_load_dwordx4 a[188:191], v2, s[40:43], s67 offen offset:2048 sc1
  s_waitcnt vmcnt(21)
  v_mfma_f32_16x16x32_bf16 a[64:67], v[44:47], v[216:219], a[64:67]
  v_mfma_f32_16x16x32_bf16 a[68:71], v[44:47], v[220:223], a[68:71]
  v_mfma_f32_16x16x32_bf16 a[72:75], v[44:47], v[224:227], a[72:75]
  v_mfma_f32_16x16x32_bf16 a[76:79], v[44:47], v[228:231], a[76:79]
  buffer_load_dwordx4 v[132:135], v2, s[40:43], s13 offen offset:1024 sc1
  v_mfma_f32_16x16x32_bf16 a[80:83], v[48:51], v[216:219], a[80:83]
  v_mfma_f32_16x16x32_bf16 a[84:87], v[48:51], v[220:223], a[84:87]
  v_mfma_f32_16x16x32_bf16 a[88:91], v[48:51], v[224:227], a[88:91]
  v_mfma_f32_16x16x32_bf16 a[92:95], v[48:51], v[228:231], a[92:95]
  buffer_load_dwordx4 v[136:139], v2, s[40:43], s13 offen offset:2048 sc1
  v_mfma_f32_16x16x32_bf16 a[96:99], v[52:55], v[216:219], a[96:99]
  v_mfma_f32_16x16x32_bf16 a[100:103], v[52:55], v[220:223], a[100:103]
  v_mfma_f32_16x16x32_bf16 a[104:107], v[52:55], v[224:227], a[104:107]
  v_mfma_f32_16x16x32_bf16 a[108:111], v[52:55], v[228:231], a[108:111]
  buffer_load_dwordx4 v[140:143], v2, s[40:43], s13 offen offset:3072 sc1
  v_mfma_f32_16x16x32_bf16 a[112:115], v[56:59], v[216:219], a[112:115]
  s_add_u32 s13, s13, 4096
  v_mfma_f32_16x16x32_bf16 a[116:119], v[56:59], v[220:223], a[116:119]
  v_mfma_f32_16x16x32_bf16 a[120:123], v[56:59], v[224:227], a[120:123]
  v_mfma_f32_16x16x32_bf16 a[124:127], v[56:59], v[228:231], a[124:127]
  v_mfma_f32_16x16x32_bf16 a[128:131], v[60:63], v[216:219], a[128:131]
  buffer_load_dwordx4 v[216:219], v2, s[40:43], s64 offen offset:3072 sc1
  v_mfma_f32_16x16x32_bf16 a[132:135], v[60:63], v[220:223], a[132:135]
  buffer_load_dwordx4 v[220:223], v2, s[40:43], s65 offen offset:3072 sc1
  v_mfma_f32_16x16x32_bf16 a[136:139], v[60:63], v[224:227], a[136:139]
  buffer_load_dwordx4 v[224:227], v2, s[40:43], s66 offen offset:3072 sc1
  v_mfma_f32_16x16x32_bf16 a[140:143], v[60:63], v[228:231], a[140:143]
  buffer_load_dwordx4 v[228:231], v2, s[40:43], s67 offen offset:3072 sc1
  s_waitcnt vmcnt(21)
  v_mfma_f32_16x16x32_bf16 a[64:67], v[96:99], a[144:147], a[64:67]
  s_add_u32 s64, s64, 4096
  v_mfma_f32_16x16x32_bf16 a[68:71], v[96:99], a[148:151], a[68:71]
  s_add_u32 s65, s65, 4096
  v_mfma_f32_16x16x32_bf16 a[72:75], v[96:99], a[152:155], a[72:75]
  s_add_u32 s66, s66, 4096
  v_mfma_f32_16x16x32_bf16 a[76:79], v[96:99], a[156:159], a[76:79]
  buffer_load_dwordx4 v[144:147], v2, s[40:43], s13 offen offset:0 sc1
  v_mfma_f32_16x16x32_bf16 a[80:83], v[100:103], a[144:147], a[80:83]
  v_mfma_f32_16x16x32_bf16 a[84:87], v[100:103], a[148:151], a[84:87]
  v_mfma_f32_16x16x32_bf16 a[88:91], v[100:103], a[152:155], a[88:91]
  s_add_u32 s67, s67, 4096
  v_mfma_f32_16x16x32_bf16 a[92:95], v[100:103], a[156:159], a[92:95]
  buffer_load_dwordx4 v[148:151], v2, s[40:43], s13 offen offset:1024 sc1
  v_mfma_f32_16x16x32_bf16 a[96:99], v[104:107], a[144:147], a[96:99]
  v_mfma_f32_16x16x32_bf16 a[100:103], v[104:107], a[148:151], a[100:103]
  v_mfma_f32_16x16x32_bf16 a[104:107], v[104:107], a[152:155], a[104:107]
  v_mfma_f32_16x16x32_bf16 a[108:111], v[104:107], a[156:159], a[108:111]
  buffer_load_dwordx4 v[152:155], v2, s[40:43], s13 offen offset:2048 sc1
  v_mfma_f32_16x16x32_bf16 a[112:115], v[108:111], a[144:147], a[112:115]
  v_mfma_f32_16x16x32_bf16 a[116:119], v[108:111], a[148:151], a[116:119]
  v_mfma_f32_16x16x32_bf16 a[120:123], v[108:111], a[152:155], a[120:123]
  v_mfma_f32_16x16x32_bf16 a[124:127], v[108:111], a[156:159], a[124:127]
  v_mfma_f32_16x16x32_bf16 a[128:131], v[112:115], a[144:147], a[128:131]
  buffer_load_dwordx4 a[144:147], v2, s[40:43], s64 offen offset:0 sc1
  v_mfma_f32_16x16x32_bf16 a[132:135], v[112:115], a[148:151], a[132:135]
  buffer_load_dwordx4 a[148:151], v2, s[40:43], s65 offen offset:0 sc1
  v_mfma_f32_16x16x32_bf16 a[136:139], v[112:115], a[152:155], a[136:139]
  buffer_load_dwordx4 a[152:155], v2, s[40:43], s66 offen offset:0 sc1
  v_mfma_f32_16x16x32_bf16 a[140:143], v[112:115], a[156:159], a[140:143]
  buffer_load_dwordx4 a[156:159], v2, s[40:43], s67 offen offset:0 sc1
  s_waitcnt vmcnt(21)
  v_mfma_f32_16x16x32_bf16 a[64:67], v[116:119], a[160:163], a[64:67]
  v_mfma_f32_16x16x32_bf16 a[68:71], v[116:119], a[164:167], a[68:71]
  v_mfma_f32_16x16x32_bf16 a[72:75], v[116:119], a[168:171], a[72:75]
  v_mfma_f32_16x16x32_bf16 a[76:79], v[116:119], a[172:175], a[76:79]
  buffer_load_dwordx4 v[156:159], v2, s[40:43], s13 offen offset:3072 sc1
  v_mfma_f32_16x16x32_bf16 a[80:83], v[120:123], a[160:163], a[80:83]
  s_add_u32 s13, s13, 4096
  v_mfma_f32_16x16x32_bf16 a[84:87], v[120:123], a[164:167], a[84:87]
  v_mfma_f32_16x16x32_bf16 a[88:91], v[120:123], a[168:171], a[88:91]
  v_mfma_f32_16x16x32_bf16 a[92:95], v[120:123], a[172:175], a[92:95]
  buffer_load_dwordx4 v[176:179], v2, s[40:43], s13 offen offset:0 sc1
  v_mfma_f32_16x16x32_bf16 a[96:99], v[124:127], a[160:163], a[96:99]
  v_mfma_f32_16x16x32_bf16 a[100:103], v[124:127], a[164:167], a[100:103]
  v_mfma_f32_16x16x32_bf16 a[104:107], v[124:127], a[168:171], a[104:107]
  v_mfma_f32_16x16x32_bf16 a[108:111], v[124:127], a[172:175], a[108:111]
  buffer_load_dwordx4 v[180:183], v2, s[40:43], s13 offen offset:1024 sc1
  v_mfma_f32_16x16x32_bf16 a[112:115], v[160:163], a[160:163], a[112:115]
  v_mfma_f32_16x16x32_bf16 a[116:119], v[160:163], a[164:167], a[116:119]
  v_mfma_f32_16x16x32_bf16 a[120:123], v[160:163], a[168:171], a[120:123]
  v_mfma_f32_16x16x32_bf16 a[124:127], v[160:163], a[172:175], a[124:127]
  v_mfma_f32_16x16x32_bf16 a[128:131], v[164:167], a[160:163], a[128:131]
  buffer_load_dwordx4 a[160:163], v2, s[40:43], s64 offen offset:1024 sc1
  v_mfma_f32_16x16x32_bf16 a[132:135], v[164:167], a[164:167], a[132:135]
  buffer_load_dwordx4 a[164:167], v2, s[40:43], s65 offen offset:1024 sc1
  v_mfma_f32_16x16x32_bf16 a[136:139], v[164:167], a[168:171], a[136:139]
  buffer_load_dwordx4 a[168:171], v2, s[40:43], s66 offen offset:1024 sc1
  v_mfma_f32_16x16x32_bf16 a[140:143], v[164:167], a[172:175], a[140:143]
  buffer_load_dwordx4 a[172:175], v2, s[40:43], s67 offen offset:1024 sc1
  s_waitcnt vmcnt(21)
  v_mfma_f32_16x16x32_bf16 a[64:67], v[168:171], a[176:179], a[64:67]
  v_mfma_f32_16x16x32_bf16 a[68:71], v[168:171], a[180:183], a[68:71]
  v_mfma_f32_16x16x32_bf16 a[72:75], v[168:171], a[184:187], a[72:75]
  v_mfma_f32_16x16x32_bf16 a[76:79], v[168:171], a[188:191], a[76:79]
  buffer_load_dwordx4 v[184:187], v2, s[40:43], s13 offen offset:2048 sc1
  v_mfma_f32_16x16x32_bf16 a[80:83], v[172:175], a[176:179], a[80:83]
  v_mfma_f32_16x16x32_bf16 a[84:87], v[172:175], a[180:183], a[84:87]
  v_mfma_f32_16x16x32_bf16 a[88:91], v[172:175], a[184:187], a[88:91]
  v_mfma_f32_16x16x32_bf16 a[92:95], v[172:175], a[188:191], a[92:95]
  buffer_load_dwordx4 v[188:191], v2, s[40:43], s13 offen offset:3072 sc1
  v_mfma_f32_16x16x32_bf16 a[96:99], v[192:195], a[176:179], a[96:99]
  s_add_u32 s13, s13, 4096
  v_mfma_f32_16x16x32_bf16 a[100:103], v[192:195], a[180:183], a[100:103]
  v_mfma_f32_16x16x32_bf16 a[104:107], v[192:195], a[184:187], a[104:107]
  v_mfma_f32_16x16x32_bf16 a[108:111], v[192:195], a[188:191], a[108:111]
  v_mfma_f32_16x16x32_bf16 a[112:115], v[196:199], a[176:179], a[112:115]
  v_mfma_f32_16x16x32_bf16 a[116:119], v[196:199], a[180:183], a[116:119]
  v_mfma_f32_16x16x32_bf16 a[120:123], v[196:199], a[184:187], a[120:123]
  v_mfma_f32_16x16x32_bf16 a[124:127], v[196:199], a[188:191], a[124:127]
  v_mfma_f32_16x16x32_bf16 a[128:131], v[208:211], a[176:179], a[128:131]
  buffer_load_dwordx4 a[176:179], v2, s[40:43], s64 offen offset:2048 sc1
  v_mfma_f32_16x16x32_bf16 a[132:135], v[208:211], a[180:183], a[132:135]
  buffer_load_dwordx4 a[180:183], v2, s[40:43], s65 offen offset:2048 sc1
  v_mfma_f32_16x16x32_bf16 a[136:139], v[208:211], a[184:187], a[136:139]
  buffer_load_dwordx4 a[184:187], v2, s[40:43], s66 offen offset:2048 sc1
  v_mfma_f32_16x16x32_bf16 a[140:143], v[208:211], a[188:191], a[140:143]
  buffer_load_dwordx4 a[188:191], v2, s[40:43], s67 offen offset:2048 sc1
  s_waitcnt vmcnt(20)
  v_mfma_f32_16x16x32_bf16 a[64:67], v[212:215], v[216:219], a[64:67]
  v_mfma_f32_16x16x32_bf16 a[68:71], v[212:215], v[220:223], a[68:71]
  v_mfma_f32_16x16x32_bf16 a[72:75], v[212:215], v[224:227], a[72:75]
  v_mfma_f32_16x16x32_bf16 a[76:79], v[212:215], v[228:231], a[76:79]
  v_mfma_f32_16x16x32_bf16 a[80:83], v[232:235], v[216:219], a[80:83]
  v_mfma_f32_16x16x32_bf16 a[84:87], v[232:235], v[220:223], a[84:87]
  v_mfma_f32_16x16x32_bf16 a[88:91], v[232:235], v[224:227], a[88:91]
  v_mfma_f32_16x16x32_bf16 a[92:95], v[232:235], v[228:231], a[92:95]
  v_mfma_f32_16x16x32_bf16 a[96:99], v[236:239], v[216:219], a[96:99]
  v_mfma_f32_16x16x32_bf16 a[100:103], v[236:239], v[220:223], a[100:103]
  v_mfma_f32_16x16x32_bf16 a[104:107], v[236:239], v[224:227], a[104:107]
  v_mfma_f32_16x16x32_bf16 a[108:111], v[236:239], v[228:231], a[108:111]
  v_mfma_f32_16x16x32_bf16 a[112:115], v[240:243], v[216:219], a[112:115]
  v_mfma_f32_16x16x32_bf16 a[116:119], v[240:243], v[220:223], a[116:119]
  v_mfma_f32_16x16x32_bf16 a[120:123], v[240:243], v[224:227], a[120:123]
  v_mfma_f32_16x16x32_bf16 a[124:127], v[240:243], v[228:231], a[124:127]
  v_mfma_f32_16x16x32_bf16 a[128:131], v[244:247], v[216:219], a[128:131]
  buffer_load_dwordx4 v[216:219], v2, s[40:43], s64 offen offset:3072 sc1
  v_mfma_f32_16x16x32_bf16 a[132:135], v[244:247], v[220:223], a[132:135]
  buffer_load_dwordx4 v[220:223], v2, s[40:43], s65 offen offset:3072 sc1
  v_mfma_f32_16x16x32_bf16 a[136:139], v[244:247], v[224:227], a[136:139]
  buffer_load_dwordx4 v[224:227], v2, s[40:43], s66 offen offset:3072 sc1
  v_mfma_f32_16x16x32_bf16 a[140:143], v[244:247], v[228:231], a[140:143]
  buffer_load_dwordx4 v[228:231], v2, s[40:43], s67 offen offset:3072 sc1
  s_waitcnt vmcnt(17)
  v_mfma_f32_16x16x32_bf16 a[64:67], v[64:67], a[144:147], a[64:67]
  v_mfma_f32_16x16x32_bf16 a[68:71], v[64:67], a[148:151], a[68:71]
  v_mfma_f32_16x16x32_bf16 a[72:75], v[64:67], a[152:155], a[72:75]
  v_mfma_f32_16x16x32_bf16 a[76:79], v[64:67], a[156:159], a[76:79]
  buffer_load_dwordx4 v[160:163], v248, s[44:47], 0 offen
  v_mfma_f32_16x16x32_bf16 a[80:83], v[68:71], a[144:147], a[80:83]
  v_mfma_f32_16x16x32_bf16 a[84:87], v[68:71], a[148:151], a[84:87]
  buffer_load_dwordx4 v[172:175], v200, s[40:43], s27 offen sc1
  v_mfma_f32_16x16x32_bf16 a[88:91], v[68:71], a[152:155], a[88:91]
  v_mfma_f32_16x16x32_bf16 a[92:95], v[68:71], a[156:159], a[92:95]
  buffer_load_dwordx4 v[164:167], v249, s[44:47], 0 offen
  v_mfma_f32_16x16x32_bf16 a[96:99], v[72:75], a[144:147], a[96:99]
  v_mfma_f32_16x16x32_bf16 a[100:103], v[72:75], a[148:151], a[100:103]
  buffer_load_dwordx4 v[192:195], v201, s[40:43], s27 offen sc1
  v_mfma_f32_16x16x32_bf16 a[104:107], v[72:75], a[152:155], a[104:107]
  v_mfma_f32_16x16x32_bf16 a[108:111], v[72:75], a[156:159], a[108:111]
  buffer_load_dwordx4 v[168:171], v250, s[44:47], 0 offen
  v_mfma_f32_16x16x32_bf16 a[112:115], v[76:79], a[144:147], a[112:115]
  v_mfma_f32_16x16x32_bf16 a[116:119], v[76:79], a[148:151], a[116:119]
  buffer_load_dwordx4 v[196:199], v202, s[40:43], s27 offen sc1
  v_mfma_f32_16x16x32_bf16 a[120:123], v[76:79], a[152:155], a[120:123]
  v_mfma_f32_16x16x32_bf16 a[124:127], v[76:79], a[156:159], a[124:127]
  v_mfma_f32_16x16x32_bf16 a[128:131], v[80:83], a[144:147], a[128:131]
  v_mfma_f32_16x16x32_bf16 a[132:135], v[80:83], a[148:151], a[132:135]
  v_mfma_f32_16x16x32_bf16 a[136:139], v[80:83], a[152:155], a[136:139]
  v_mfma_f32_16x16x32_bf16 a[140:143], v[80:83], a[156:159], a[140:143]
  s_waitcnt vmcnt(16)
  v_mfma_f32_16x16x32_bf16 a[64:67], v[84:87], a[160:163], a[64:67]
  v_mfma_f32_16x16x32_bf16 a[68:71], v[84:87], a[164:167], a[68:71]
  v_mfma_f32_16x16x32_bf16 a[72:75], v[84:87], a[168:171], a[72:75]
  v_mfma_f32_16x16x32_bf16 a[76:79], v[84:87], a[172:175], a[76:79]
  v_mfma_f32_16x16x32_bf16 a[80:83], v[88:91], a[160:163], a[80:83]
  v_mfma_f32_16x16x32_bf16 a[84:87], v[88:91], a[164:167], a[84:87]
  v_mfma_f32_16x16x32_bf16 a[88:91], v[88:91], a[168:171], a[88:91]
  v_mfma_f32_16x16x32_bf16 a[92:95], v[88:91], a[172:175], a[92:95]
  v_mfma_f32_16x16x32_bf16 a[96:99], v[92:95], a[160:163], a[96:99]
  v_mfma_f32_16x16x32_bf16 a[100:103], v[92:95], a[164:167], a[100:103]
  v_mfma_f32_16x16x32_bf16 a[104:107], v[92:95], a[168:171], a[104:107]
  v_mfma_f32_16x16x32_bf16 a[108:111], v[92:95], a[172:175], a[108:111]
  v_mfma_f32_16x16x32_bf16 a[112:115], v[128:131], a[160:163], a[112:115]
  v_mfma_f32_16x16x32_bf16 a[116:119], v[128:131], a[164:167], a[116:119]
  v_mfma_f32_16x16x32_bf16 a[120:123], v[128:131], a[168:171], a[120:123]
  v_mfma_f32_16x16x32_bf16 a[124:127], v[128:131], a[172:175], a[124:127]
  v_mfma_f32_16x16x32_bf16 a[128:131], v[132:135], a[160:163], a[128:131]
  v_mfma_f32_16x16x32_bf16 a[132:135], v[132:135], a[164:167], a[132:135]
  v_mfma_f32_16x16x32_bf16 a[136:139], v[132:135], a[168:171], a[136:139]
  v_mfma_f32_16x16x32_bf16 a[140:143], v[132:135], a[172:175], a[140:143]
  s_waitcnt vmcnt(10)
  v_mfma_f32_16x16x32_bf16 a[64:67], v[136:139], a[176:179], a[64:67]
  v_mfma_f32_16x16x32_bf16 a[68:71], v[136:139], a[180:183], a[68:71]
  v_mfma_f32_16x16x32_bf16 a[72:75], v[136:139], a[184:187], a[72:75]
  v_mfma_f32_16x16x32_bf16 a[76:79], v[136:139], a[188:191], a[76:79]
  v_mfma_f32_16x16x32_bf16 a[80:83], v[140:143], a[176:179], a[80:83]
  v_mfma_f32_16x16x32_bf16 a[84:87], v[140:143], a[180:183], a[84:87]
  v_mfma_f32_16x16x32_bf16 a[88:91], v[140:143], a[184:187], a[88:91]
  v_mfma_f32_16x16x32_bf16 a[92:95], v[140:143], a[188:191], a[92:95]
  v_mfma_f32_16x16x32_bf16 a[96:99], v[144:147], a[176:179], a[96:99]
  v_mfma_f32_16x16x32_bf16 a[100:103], v[144:147], a[180:183], a[100:103]
  v_mfma_f32_16x16x32_bf16 a[104:107], v[144:147], a[184:187], a[104:107]
  v_mfma_f32_16x16x32_bf16 a[108:111], v[144:147], a[188:191], a[108:111]
  v_mfma_f32_16x16x32_bf16 a[112:115], v[148:151], a[176:179], a[112:115]
  v_mfma_f32_16x16x32_bf16 a[116:119], v[148:151], a[180:183], a[116:119]
  v_mfma_f32_16x16x32_bf16 a[120:123], v[148:151], a[184:187], a[120:123]
  v_mfma_f32_16x16x32_bf16 a[124:127], v[148:151], a[188:191], a[124:127]
  v_mfma_f32_16x16x32_bf16 a[128:131], v[152:155], a[176:179], a[128:131]
  v_mfma_f32_16x16x32_bf16 a[132:135], v[152:155], a[180:183], a[132:135]
  v_mfma_f32_16x16x32_bf16 a[136:139], v[152:155], a[184:187], a[136:139]
  v_mfma_f32_16x16x32_bf16 a[140:143], v[152:155], a[188:191], a[140:143]
  s_waitcnt vmcnt(6)
  v_mfma_f32_16x16x32_bf16 a[64:67], v[156:159], v[216:219], a[64:67]
  v_mfma_f32_16x16x32_bf16 a[68:71], v[156:159], v[220:223], a[68:71]
  v_mfma_f32_16x16x32_bf16 a[72:75], v[156:159], v[224:227], a[72:75]
  v_mfma_f32_16x16x32_bf16 a[76:79], v[156:159], v[228:231], a[76:79]
  v_mfma_f32_16x16x32_bf16 a[80:83], v[176:179], v[216:219], a[80:83]
  v_mfma_f32_16x16x32_bf16 a[84:87], v[176:179], v[220:223], a[84:87]
  v_mfma_f32_16x16x32_bf16 a[88:91], v[176:179], v[224:227], a[88:91]
  v_mfma_f32_16x16x32_bf16 a[92:95], v[176:179], v[228:231], a[92:95]
  v_mfma_f32_16x16x32_bf16 a[96:99], v[180:183], v[216:219], a[96:99]
  v_mfma_f32_16x16x32_bf16 a[100:103], v[180:183], v[220:223], a[100:103]
  v_mfma_f32_16x16x32_bf16 a[104:107], v[180:183], v[224:227], a[104:107]
  v_mfma_f32_16x16x32_bf16 a[108:111], v[180:183], v[228:231], a[108:111]
  v_mfma_f32_16x16x32_bf16 a[112:115], v[184:187], v[216:219], a[112:115]
  v_mfma_f32_16x16x32_bf16 a[116:119], v[184:187], v[220:223], a[116:119]
  v_mfma_f32_16x16x32_bf16 a[120:123], v[184:187], v[224:227], a[120:123]
  v_mfma_f32_16x16x32_bf16 a[124:127], v[184:187], v[228:231], a[124:127]
  v_mfma_f32_16x16x32_bf16 a[128:131], v[188:191], v[216:219], a[128:131]
  v_mfma_f32_16x16x32_bf16 a[132:135], v[188:191], v[220:223], a[132:135]
  v_mfma_f32_16x16x32_bf16 a[136:139], v[188:191], v[224:227], a[136:139]
  v_mfma_f32_16x16x32_bf16 a[140:143], v[188:191], v[228:231], a[140:143]
  v_and_b32 v16, 15, v1
  v_mul_u32_u24 v16, 336, v16
  v_lshrrev_b32 v17, 4, v1
  v_lshl_add_u32 v16, v17, 4, v16
  s_mul_i32 s23, s20, 21504
  v_add_u32 v16, s23, v16
  s_barrier
  ds_write_b128 v16, a[64:67] offset:0
  ds_write_b128 v16, a[68:71] offset:5376
  ds_write_b128 v16, a[72:75] offset:10752
  ds_write_b128 v16, a[76:79] offset:16128
  ds_write_b128 v16, a[80:83] offset:64
  ds_write_b128 v16, a[84:87] offset:5440
  ds_write_b128 v16, a[88:91] offset:10816
  ds_write_b128 v16, a[92:95] offset:16192
  ds_write_b128 v16, a[96:99] offset:128
  ds_write_b128 v16, a[100:103] offset:5504
  ds_write_b128 v16, a[104:107] offset:10880
  ds_write_b128 v16, a[108:111] offset:16256
  ds_write_b128 v16, a[112:115] offset:192
  ds_write_b128 v16, a[116:119] offset:5568
  ds_write_b128 v16, a[120:123] offset:10944
  ds_write_b128 v16, a[124:127] offset:16320
  ds_write_b128 v16, a[128:131] offset:256
  ds_write_b128 v16, a[132:135] offset:5632
  ds_write_b128 v16, a[136:139] offset:11008
  ds_write_b128 v16, a[140:143] offset:16384
  s_waitcnt vmcnt(0) lgkmcnt(0)
  s_barrier
  ds_read_b128 v[32:35], v251 offset:0
  ds_read_b128 v[36:39], v251 offset:16
  ds_read_b128 v[40:43], v251 offset:21504
  ds_read_b128 v[44:47], v251 offset:21520
  ds_read_b128 v[48:51], v251 offset:43008
  ds_read_b128 v[52:55], v251 offset:43024
  ds_read_b128 v[56:59], v251 offset:64512
  ds_read_b128 v[60:63], v251 offset:64528
  ds_read_b128 v[64:67], v203 offset:0
  ds_read_b128 v[68:71], v203 offset:16
  ds_read_b128 v[72:75], v252 offset:0
  ds_read_b128 v[76:79], v252 offset:16
  ds_read_b128 v[80:83], v252 offset:21504
  ds_read_b128 v[84:87], v252 offset:21520
  ds_read_b128 v[88:91], v252 offset:43008
  ds_read_b128 v[92:95], v252 offset:43024
  ds_read_b128 v[96:99], v252 offset:64512
  ds_read_b128 v[100:103], v252 offset:64528
  ds_read_b128 v[104:107], v204 offset:0
  ds_read_b128 v[108:111], v204 offset:16
  ds_read_b128 v[112:115], v253 offset:0
  ds_read_b128 v[116:119], v253 offset:16
  ds_read_b128 v[120:123], v253 offset:21504
  ds_read_b128 v[124:127], v253 offset:21520
  ds_read_b128 v[128:131], v253 offset:43008
  ds_read_b128 v[132:135], v253 offset:43024
  ds_read_b128 v[136:139], v253 offset:64512
  ds_read_b128 v[140:143], v253 offset:64528
  ds_read_b128 v[144:147], v205 offset:0
  ds_read_b128 v[148:151], v205 offset:16
  s_waitcnt lgkmcnt(10)
  v_add_f32 v32, v32, v40
  v_add_f32 v48, v48, v56
  v_add_f32 v33, v33, v41
  v_add_f32 v49, v49, v57
  v_add_f32 v34, v34, v42
  v_add_f32 v50, v50, v58
  v_add_f32 v35, v35, v43
  v_add_f32 v51, v51, v59
  v_add_f32 v36, v36, v44
  v_add_f32 v52, v52, v60
  v_add_f32 v37, v37, v45
  v_add_f32 v53, v53, v61
  v_add_f32 v38, v38, v46
  v_add_f32 v54, v54, v62
  v_add_f32 v39, v39, v47
  v_add_f32 v55, v55, v63
  v_add_f32 v32, v32, v48
  v_add_f32 v33, v33, v49
  v_add_f32 v34, v34, v50
  v_add_f32 v35, v35, v51
  v_add_f32 v36, v36, v52
  v_add_f32 v37, v37, v53
  v_add_f32 v38, v38, v54
  v_add_f32 v39, v39, v55
  v_cvt_pk_bf16_f32 v40, v32, v33
  v_lshlrev_b32 v42, 16, v160
  v_and_b32 v43, 0xffff0000, v160
  v_and_b32 v41, 0xffff0000, v40
  v_lshlrev_b32 v40, 16, v40
  v_add_f32 v40, v40, v42
  v_add_f32 v41, v41, v43
  v_cvt_pk_bf16_f32 v40, v40, v41
  v_lshlrev_b32 v42, 16, v172
  v_and_b32 v43, 0xffff0000, v172
  v_add_f32 v42, v42, v64
  v_add_f32 v43, v43, v65
  v_cvt_pk_bf16_f32 v42, v42, v43
  v_and_b32 v41, 0xffff0000, v40
  v_lshlrev_b32 v40, 16, v40
  v_and_b32 v43, 0xffff0000, v42
  v_lshlrev_b32 v42, 16, v42
  v_add_f32 v40, v40, v42
  v_add_f32 v41, v41, v43
  v_cvt_pk_bf16_f32 v44, v40, v41
  v_cvt_pk_bf16_f32 v40, v34, v35
  v_lshlrev_b32 v42, 16, v161
  v_and_b32 v43, 0xffff0000, v161
  v_and_b32 v41, 0xffff0000, v40
  v_lshlrev_b32 v40, 16, v40
  v_add_f32 v40, v40, v42
  v_add_f32 v41, v41, v43
  v_cvt_pk_bf16_f32 v40, v40, v41
  v_lshlrev_b32 v42, 16, v173
  v_and_b32 v43, 0xffff0000, v173
  v_add_f32 v42, v42, v66
  v_add_f32 v43, v43, v67
  v_cvt_pk_bf16_f32 v42, v42, v43
  v_and_b32 v41, 0xffff0000, v40
  v_lshlrev_b32 v40, 16, v40
  v_and_b32 v43, 0xffff0000, v42
  v_lshlrev_b32 v42, 16, v42
  v_add_f32 v40, v40, v42
  v_add_f32 v41, v41, v43
  v_cvt_pk_bf16_f32 v45, v40, v41
  v_cvt_pk_bf16_f32 v40, v36, v37
  v_lshlrev_b32 v42, 16, v162
  v_and_b32 v43, 0xffff0000, v162
  v_and_b32 v41, 0xffff0000, v40
  v_lshlrev_b32 v40, 16, v40
  v_add_f32 v40, v40, v42
  v_add_f32 v41, v41, v43
  v_cvt_pk_bf16_f32 v40, v40, v41
  v_lshlrev_b32 v42, 16, v174
  v_and_b32 v43, 0xffff0000, v174
  v_add_f32 v42, v42, v68
  v_add_f32 v43, v43, v69
  v_cvt_pk_bf16_f32 v42, v42, v43
  v_and_b32 v41, 0xffff0000, v40
  v_lshlrev_b32 v40, 16, v40
  v_and_b32 v43, 0xffff0000, v42
  v_lshlrev_b32 v42, 16, v42
  v_add_f32 v40, v40, v42
  v_add_f32 v41, v41, v43
  v_cvt_pk_bf16_f32 v46, v40, v41
  v_cvt_pk_bf16_f32 v40, v38, v39
  v_lshlrev_b32 v42, 16, v163
  v_and_b32 v43, 0xffff0000, v163
  v_and_b32 v41, 0xffff0000, v40
  v_lshlrev_b32 v40, 16, v40
  v_add_f32 v40, v40, v42
  v_add_f32 v41, v41, v43
  v_cvt_pk_bf16_f32 v40, v40, v41
  v_lshlrev_b32 v42, 16, v175
  v_and_b32 v43, 0xffff0000, v175
  v_add_f32 v42, v42, v70
  v_add_f32 v43, v43, v71
  v_cvt_pk_bf16_f32 v42, v42, v43
  v_and_b32 v41, 0xffff0000, v40
  v_lshlrev_b32 v40, 16, v40
  v_and_b32 v43, 0xffff0000, v42
  v_lshlrev_b32 v42, 16, v42
  v_add_f32 v40, v40, v42
  v_add_f32 v41, v41, v43
  v_cvt_pk_bf16_f32 v47, v40, v41
  buffer_store_dwordx4 v[44:47], v248, s[48:51], 0 offen
  s_waitcnt lgkmcnt(10)
  v_add_f32 v72, v72, v80
  v_add_f32 v88, v88, v96
  v_add_f32 v73, v73, v81
  v_add_f32 v89, v89, v97
  v_add_f32 v74, v74, v82
  v_add_f32 v90, v90, v98
  v_add_f32 v75, v75, v83
  v_add_f32 v91, v91, v99
  v_add_f32 v76, v76, v84
  v_add_f32 v92, v92, v100
  v_add_f32 v77, v77, v85
  v_add_f32 v93, v93, v101
  v_add_f32 v78, v78, v86
  v_add_f32 v94, v94, v102
  v_add_f32 v79, v79, v87
  v_add_f32 v95, v95, v103
  v_add_f32 v72, v72, v88
  v_add_f32 v73, v73, v89
  v_add_f32 v74, v74, v90
  v_add_f32 v75, v75, v91
  v_add_f32 v76, v76, v92
  v_add_f32 v77, v77, v93
  v_add_f32 v78, v78, v94
  v_add_f32 v79, v79, v95
  v_cvt_pk_bf16_f32 v80, v72, v73
  v_lshlrev_b32 v82, 16, v164
  v_and_b32 v83, 0xffff0000, v164
  v_and_b32 v81, 0xffff0000, v80
  v_lshlrev_b32 v80, 16, v80
  v_add_f32 v80, v80, v82
  v_add_f32 v81, v81, v83
  v_cvt_pk_bf16_f32 v80, v80, v81
  v_lshlrev_b32 v82, 16, v192
  v_and_b32 v83, 0xffff0000, v192
  v_add_f32 v82, v82, v104
  v_add_f32 v83, v83, v105
  v_cvt_pk_bf16_f32 v82, v82, v83
  v_and_b32 v81, 0xffff0000, v80
  v_lshlrev_b32 v80, 16, v80
  v_and_b32 v83, 0xffff0000, v82
  v_lshlrev_b32 v82, 16, v82
  v_add_f32 v80, v80, v82
  v_add_f32 v81, v81, v83
  v_cvt_pk_bf16_f32 v84, v80, v81
  v_cvt_pk_bf16_f32 v80, v74, v75
  v_lshlrev_b32 v82, 16, v165
  v_and_b32 v83, 0xffff0000, v165
  v_and_b32 v81, 0xffff0000, v80
  v_lshlrev_b32 v80, 16, v80
  v_add_f32 v80, v80, v82
  v_add_f32 v81, v81, v83
  v_cvt_pk_bf16_f32 v80, v80, v81
  v_lshlrev_b32 v82, 16, v193
  v_and_b32 v83, 0xffff0000, v193
  v_add_f32 v82, v82, v106
  v_add_f32 v83, v83, v107
  v_cvt_pk_bf16_f32 v82, v82, v83
  v_and_b32 v81, 0xffff0000, v80
  v_lshlrev_b32 v80, 16, v80
  v_and_b32 v83, 0xffff0000, v82
  v_lshlrev_b32 v82, 16, v82
  v_add_f32 v80, v80, v82
  v_add_f32 v81, v81, v83
  v_cvt_pk_bf16_f32 v85, v80, v81
  v_cvt_pk_bf16_f32 v80, v76, v77
  v_lshlrev_b32 v82, 16, v166
  v_and_b32 v83, 0xffff0000, v166
  v_and_b32 v81, 0xffff0000, v80
  v_lshlrev_b32 v80, 16, v80
  v_add_f32 v80, v80, v82
  v_add_f32 v81, v81, v83
  v_cvt_pk_bf16_f32 v80, v80, v81
  v_lshlrev_b32 v82, 16, v194
  v_and_b32 v83, 0xffff0000, v194
  v_add_f32 v82, v82, v108
  v_add_f32 v83, v83, v109
  v_cvt_pk_bf16_f32 v82, v82, v83
  v_and_b32 v81, 0xffff0000, v80
  v_lshlrev_b32 v80, 16, v80
  v_and_b32 v83, 0xffff0000, v82
  v_lshlrev_b32 v82, 16, v82
  v_add_f32 v80, v80, v82
  v_add_f32 v81, v81, v83
  v_cvt_pk_bf16_f32 v86, v80, v81
  v_cvt_pk_bf16_f32 v80, v78, v79
  v_lshlrev_b32 v82, 16, v167
  v_and_b32 v83, 0xffff0000, v167
  v_and_b32 v81, 0xffff0000, v80
  v_lshlrev_b32 v80, 16, v80
  v_add_f32 v80, v80, v82
  v_add_f32 v81, v81, v83
  v_cvt_pk_bf16_f32 v80, v80, v81
  v_lshlrev_b32 v82, 16, v195
  v_and_b32 v83, 0xffff0000, v195
  v_add_f32 v82, v82, v110
  v_add_f32 v83, v83, v111
  v_cvt_pk_bf16_f32 v82, v82, v83
  v_and_b32 v81, 0xffff0000, v80
  v_lshlrev_b32 v80, 16, v80
  v_and_b32 v83, 0xffff0000, v82
  v_lshlrev_b32 v82, 16, v82
  v_add_f32 v80, v80, v82
  v_add_f32 v81, v81, v83
  v_cvt_pk_bf16_f32 v87, v80, v81
  buffer_store_dwordx4 v[84:87], v249, s[48:51], 0 offen
  s_waitcnt lgkmcnt(0)
  v_add_f32 v112, v112, v120
  v_add_f32 v128, v128, v136
  v_add_f32 v113, v113, v121
  v_add_f32 v129, v129, v137
  v_add_f32 v114, v114, v122
  v_add_f32 v130, v130, v138
  v_add_f32 v115, v115, v123
  v_add_f32 v131, v131, v139
  v_add_f32 v116, v116, v124
  v_add_f32 v132, v132, v140
  v_add_f32 v117, v117, v125
  v_add_f32 v133, v133, v141
  v_add_f32 v118, v118, v126
  v_add_f32 v134, v134, v142
  v_add_f32 v119, v119, v127
  v_add_f32 v135, v135, v143
  v_add_f32 v112, v112, v128
  v_add_f32 v113, v113, v129
  v_add_f32 v114, v114, v130
  v_add_f32 v115, v115, v131
  v_add_f32 v116, v116, v132
  v_add_f32 v117, v117, v133
  v_add_f32 v118, v118, v134
  v_add_f32 v119, v119, v135
  v_cvt_pk_bf16_f32 v120, v112, v113
  v_lshlrev_b32 v122, 16, v168
  v_and_b32 v123, 0xffff0000, v168
  v_and_b32 v121, 0xffff0000, v120
  v_lshlrev_b32 v120, 16, v120
  v_add_f32 v120, v120, v122
  v_add_f32 v121, v121, v123
  v_cvt_pk_bf16_f32 v120, v120, v121
  v_lshlrev_b32 v122, 16, v196
  v_and_b32 v123, 0xffff0000, v196
  v_add_f32 v122, v122, v144
  v_add_f32 v123, v123, v145
  v_cvt_pk_bf16_f32 v122, v122, v123
  v_and_b32 v121, 0xffff0000, v120
  v_lshlrev_b32 v120, 16, v120
  v_and_b32 v123, 0xffff0000, v122
  v_lshlrev_b32 v122, 16, v122
  v_add_f32 v120, v120, v122
  v_add_f32 v121, v121, v123
  v_cvt_pk_bf16_f32 v124, v120, v121
  v_cvt_pk_bf16_f32 v120, v114, v115
  v_lshlrev_b32 v122, 16, v169
  v_and_b32 v123, 0xffff0000, v169
  v_and_b32 v121, 0xffff0000, v120
  v_lshlrev_b32 v120, 16, v120
  v_add_f32 v120, v120, v122
  v_add_f32 v121, v121, v123
  v_cvt_pk_bf16_f32 v120, v120, v121
  v_lshlrev_b32 v122, 16, v197
  v_and_b32 v123, 0xffff0000, v197
  v_add_f32 v122, v122, v146
  v_add_f32 v123, v123, v147
  v_cvt_pk_bf16_f32 v122, v122, v123
  v_and_b32 v121, 0xffff0000, v120
  v_lshlrev_b32 v120, 16, v120
  v_and_b32 v123, 0xffff0000, v122
  v_lshlrev_b32 v122, 16, v122
  v_add_f32 v120, v120, v122
  v_add_f32 v121, v121, v123
  v_cvt_pk_bf16_f32 v125, v120, v121
  v_cvt_pk_bf16_f32 v120, v116, v117
  v_lshlrev_b32 v122, 16, v170
  v_and_b32 v123, 0xffff0000, v170
  v_and_b32 v121, 0xffff0000, v120
  v_lshlrev_b32 v120, 16, v120
  v_add_f32 v120, v120, v122
  v_add_f32 v121, v121, v123
  v_cvt_pk_bf16_f32 v120, v120, v121
  v_lshlrev_b32 v122, 16, v198
  v_and_b32 v123, 0xffff0000, v198
  v_add_f32 v122, v122, v148
  v_add_f32 v123, v123, v149
  v_cvt_pk_bf16_f32 v122, v122, v123
  v_and_b32 v121, 0xffff0000, v120
  v_lshlrev_b32 v120, 16, v120
  v_and_b32 v123, 0xffff0000, v122
  v_lshlrev_b32 v122, 16, v122
  v_add_f32 v120, v120, v122
  v_add_f32 v121, v121, v123
  v_cvt_pk_bf16_f32 v126, v120, v121
  v_cvt_pk_bf16_f32 v120, v118, v119
  v_lshlrev_b32 v122, 16, v171
  v_and_b32 v123, 0xffff0000, v171
  v_and_b32 v121, 0xffff0000, v120
  v_lshlrev_b32 v120, 16, v120
  v_add_f32 v120, v120, v122
  v_add_f32 v121, v121, v123
  v_cvt_pk_bf16_f32 v120, v120, v121
  v_lshlrev_b32 v122, 16, v199
  v_and_b32 v123, 0xffff0000, v199
  v_add_f32 v122, v122, v150
  v_add_f32 v123, v123, v151
  v_cvt_pk_bf16_f32 v122, v122, v123
  v_and_b32 v121, 0xffff0000, v120
  v_lshlrev_b32 v120, 16, v120
  v_and_b32 v123, 0xffff0000, v122
  v_lshlrev_b32 v122, 16, v122
  v_add_f32 v120, v120, v122
  v_add_f32 v121, v121, v123
  v_cvt_pk_bf16_f32 v127, v120, v121
  buffer_store_dwordx4 v[124:127], v250, s[48:51], 0 offen
fa_end:
  s_endpgm
fa_p1stubK:
  s_call_b64 s[76:77], fa_p1sub
  s_branch fa_p1backK
fa_p1stubV:
  s_call_b64 s[76:77], fa_p1sub
  s_branch fa_p1backV
fa_p1sub:
  s_cmp_eq_u32 s28, 6
  s_cbranch_scc1 fa_p1sub6
  s_cmp_eq_u32 s28, 3
  s_cbranch_scc0 fa_p1sub0
  s_mov_b32 s48, s60
  s_mov_b32 s49, s61
  s_mov_b32 s50, s75
  s_lshl_b32 s74, s22, 2
  s_add_u32 s74, s74, s20
  s_lshl_b32 s74, s74, 16
  s_mov_b32 s73, 2097152
fa_p1sub0:
  s_cmp_eq_u32 s28, s71
  s_cselect_b32 s23, s70, 1073741824
  v_mov_b32 v16, 1073741824
  v_mov_b32 v17, 1
  v_writelane_b32 v16, s23, 0
  buffer_store_byte v17, v16, s[56:59], 0 offen sc1
  s_setpc_b64 s[76:77]
fa_p1sub6:
  s_mov_b32 s34, 0
  s_mov_b32 s36, s60
  s_mov_b32 s37, s61
  s_mov_b32 s38, s75
  s_lshr_b32 s27, s20, 1
  s_lshl_b32 s27, s27, 18
  s_mov_b32 s25, 524288
  v_lshlrev_b32 v229, 2, v1
  buffer_load_dword v228, v229, s[56:59], 0 offen sc1
  s_setpc_b64 s[76:77]
fa_ln_spin:
  s_mov_b32 s83, 200000
fa_ln_spin2:
  buffer_load_dword v228, v229, s[56:59], 0 offen sc1
  s_waitcnt vmcnt(0)
  v_cmp_ne_u32 vcc, 0x01010101, v228
  s_cbranch_vccz fa_ln_ok
  s_sleep 8
  s_sub_u32 s83, s83, 1
  s_cmp_lg_u32 s83, 0
  s_cbranch_scc1 fa_ln_spin2
  s_branch fa_ln_ok
fa_kv_spin:
  s_mov_b32 s83, 200000
fa_kv_spin2:
  buffer_load_dword v228, v230, s[40:43], 0 offen sc1
  s_waitcnt vmcnt(0)
  v_cmp_eq_u32 vcc, 0, v228
  s_cbranch_vccz fa_kv_ok
  s_sleep 8
  s_sub_u32 s83, s83, 1
  s_cmp_lg_u32 s83, 0
  s_cbranch_scc1 fa_kv_spin2
  s_branch fa_kv_ok
fa_top8:
  s_cmp_lg_u32 s20, 0
  s_cbranch_scc1 fa_notop
  s_mov_b32 s23, 2621440
  s_mov_b32 s31, 2625536
  buffer_load_dwordx4 v[32:35], v2, s[40:43], s23 offen offset:0 sc1
  buffer_load_dwordx4 v[36:39], v2, s[40:43], s23 offen offset:1024 sc1
  buffer_load_dwordx4 v[40:43], v2, s[40:43], s23 offen offset:2048 sc1
  buffer_load_dwordx4 v[44:47], v2, s[40:43], s23 offen offset:3072 sc1
  buffer_load_dwordx4 v[48:51], v2, s[40:43], s31 offen offset:0 sc1
  buffer_load_dwordx4 v[52:55], v2, s[40:43], s31 offen offset:1024 sc1
  buffer_load_dwordx4 v[56:59], v2, s[40:43], s31 offen offset:2048 sc1
  buffer_load_dwordx4 v[60:63], v2, s[40:43], s31 offen offset:3072 sc1
  v_mov_b32 v21, 0
  v_mov_b32 v22, 0
  v_and_b32 v23, 7, v1
  s_mov_b32 s23, 0
  s_waitcnt vmcnt(0)
fa_top:
  v_max3_u32 v20, v32, v33, v34
  v_max3_u32 v24, v35, v36, v37
  v_max3_u32 v20, v20, v38, v39
  v_max3_u32 v24, v24, v40, v41
  v_max3_u32 v20, v20, v42, v43
  v_max3_u32 v24, v24, v44, v45
  v_max3_u32 v20, v20, v46, v47
  v_max3_u32 v24, v24, v48, v49
  v_max3_u32 v20, v20, v50, v51
  v_max3_u32 v24, v24, v52, v53
  v_max3_u32 v20, v20, v54, v55
  v_max3_u32 v24, v24, v56, v57
  v_max3_u32 v20, v20, v58, v59
  v_max3_u32 v24, v24, v60, v61
  v_max3_u32 v20, v20, v62, v63
  v_max_u32 v20, v20, v24
  s_nop 1
  v_max_u32_dpp v20, v20, v20 quad_perm:[1,0,3,2] row_mask:0xf bank_mask:0xf
  s_nop 1
  v_max_u32_dpp v20, v20, v20 quad_perm:[2,3,0,1] row_mask:0xf bank_mask:0xf
  s_nop 1
  v_max_u32_dpp v20, v20, v20 row_half_mirror row_mask:0xf bank_mask:0xf
  s_nop 1
  v_max_u32_dpp v20, v20, v20 row_mirror row_mask:0xf bank_mask:0xf
  v_mov_b32 v24, v20
  s_nop 1
  v_permlane16_swap_b32 v20, v24
  v_max_u32 v20, v20, v24
  v_mov_b32 v24, v20
  s_nop 1
  v_permlane32_swap_b32 v20, v24
  v_max_u32 v20, v20, v24
  v_add_u32 v21, v21, v20
  v_cmp_eq_u32 vcc, s23, v23
  v_sub_u32 v32, v32, v20
  v_sub_u32 v33, v33, v20
  v_sub_u32 v34, v34, v20
  v_sub_u32 v35, v35, v20
  v_sub_u32 v36, v36, v20
  v_sub_u32 v37, v37, v20
  v_sub_u32 v38, v38, v20
  v_sub_u32 v39, v39, v20
  v_sub_u32 v40, v40, v20
  v_sub_u32 v41, v41, v20
  v_sub_u32 v42, v42, v20
  v_sub_u32 v43, v43, v20
  v_sub_u32 v44, v44, v20
  v_sub_u32 v45, v45, v20
  v_sub_u32 v46, v46, v20
  v_sub_u32 v47, v47, v20
  v_sub_u32 v48, v48, v20
  v_sub_u32 v49, v49, v20
  v_sub_u32 v50, v50, v20
  v_sub_u32 v51, v51, v20
  v_sub_u32 v52, v52, v20
  v_sub_u32 v53, v53, v20
  v_sub_u32 v54, v54, v20
  v_sub_u32 v55, v55, v20
  v_sub_u32 v56, v56, v20
  v_sub_u32 v57, v57, v20
  v_sub_u32 v58, v58, v20
  v_sub_u32 v59, v59, v20
  v_sub_u32 v60, v60, v20
  v_sub_u32 v61, v61, v20
  v_sub_u32 v62, v62, v20
  v_sub_u32 v63, v63, v20
  v_cndmask_b32 v22, v22, v21, vcc
  s_add_u32 s23, s23, 1
  s_cmp_lt_u32 s23, 8
  s_cbranch_scc1 fa_top
  v_and_b32 v25, 0xffff, v22
  v_sub_u32 v25, 0xffff, v25
  v_and_b32 v25, 2047, v25
  v_ashrrev_i32 v20, 31, v22
  v_not_b32 v20, v20
  v_or_b32 v20, 0x80000000, v20
  v_xor_b32 v26, v22, v20
  v_and_b32 v26, 0xffff0000, v26
  v_mul_f32 v26, 0xbfb8aa3b, v26
  v_exp_f32 v26, v26
  s_nop 0
  v_add_f32 v26, 1.0, v26
  v_rcp_f32 v26, v26
  s_nop 0
  v_cvt_pk_bf16_f32 v26, v26, v26
  v_and_b32 v26, 0xffff0000, v26
  v_lshlrev_b32 v20, 2, v1
  v_add_u32 v20, 2629632, v20
  v_mov_b32 v21, 1073741824
  v_cmp_gt_u32 vcc, 16, v1
  v_add_u32 v25, 1, v25
  v_or_b32 v26, 1, v26
  v_cndmask_b32 v20, v21, v20, vcc
  v_cmp_gt_u32 vcc, 8, v1
  s_nop 1
  v_cndmask_b32 v26, v26, v25, vcc
  buffer_store_dword v26, v20, s[40:43], 0 offen sc1
  s_branch fa_notop
fa_hk0:
  s_getpc_b64 s[38:39]
fa_hp0:
  s_add_u32 s36, s36, 4
  s_addc_u32 s37, s37, 0
  s_sub_u32 s38, s38, fa_hp0-fa_hb0
  s_subb_u32 s39, s39, 0
  s_setpc_b64 s[36:37]
fa_hk1:
  s_getpc_b64 s[38:39]
fa_hp1:
  s_add_u32 s36, s36, 4
  s_addc_u32 s37, s37, 0
  s_sub_u32 s38, s38, fa_hp1-fa_hb1
  s_subb_u32 s39, s39, 0
  s_setpc_b64 s[36:37]
fa_sel_spin:
  s_mov_b32 s83, 200000
fa_sel_spin2:
  buffer_load_dword v15, v12, s[40:43], 0 offen sc1
  s_waitcnt vmcnt(0)
  v_cmp_eq_u32 vcc, 0, v15
  s_cbranch_vccz fa_sel_ok
  s_sleep 8
  s_sub_u32 s83, s83, 1
  s_cmp_lg_u32 s83, 0
  s_cbranch_scc1 fa_sel_spin2
  s_branch fa_sel_ok
fa_wof_spin:
  s_mov_b32 s83, 200000
fa_wof_spin2:
  buffer_load_dword v8, v9, s[40:43], 0 offen sc1
  s_waitcnt vmcnt(0)
  v_cmp_eq_u32 vcc, 0, v8
  s_cbranch_vccz fa_wof_ok
  s_sleep 8
  s_sub_u32 s83, s83, 1
  s_cmp_lg_u32 s83, 0
  s_cbranch_scc1 fa_wof_spin2
  s_branch fa_wof_ok
fa_co:
  s_waitcnt vmcnt(8)
  ds_read_b64_tr_b16 v[232:233], v6 offset:0
  ds_read_b64_tr_b16 v[234:235], v6 offset:2560
  ds_read_b64_tr_b16 v[236:237], v6 offset:32
  ds_read_b64_tr_b16 v[238:239], v6 offset:2592
  ds_read_b64_tr_b16 v[240:241], v6 offset:64
  ds_read_b64_tr_b16 v[242:243], v6 offset:2624
  ds_read_b64_tr_b16 v[244:245], v6 offset:96
  ds_read_b64_tr_b16 v[246:247], v6 offset:2656
  ds_read_b64_tr_b16 v[248:249], v6 offset:128
  ds_read_b64_tr_b16 v[250:251], v6 offset:2688
  s_sub_u32 s14, s2, 192
  s_cmp_lt_u32 s14, 54
  s_cbranch_scc1 fa_coF
  s_sub_u32 s14, s2, 64
  s_cmp_lt_u32 s14, 128
  s_cbranch_scc1 fa_coT
  s_getpc_b64 s[36:37]
  s_setpc_b64 s[38:39]
  s_add_u32 s31, s30, 4096
  buffer_store_dwordx4 v[232:235], v2, s[40:43], s30 offen offset:0 sc1
  buffer_store_dwordx4 v[236:239], v2, s[40:43], s30 offen offset:1024 sc1
  buffer_store_dwordx4 v[240:243], v2, s[40:43], s30 offen offset:2048 sc1
  buffer_store_dwordx4 v[244:247], v2, s[40:43], s30 offen offset:3072 sc1
  buffer_store_dwordx4 v[248:251], v2, s[40:43], s31 offen offset:0 sc1
  s_getpc_b64 s[36:37]
  s_setpc_b64 s[38:39]
  s_getpc_b64 s[36:37]
  s_setpc_b64 s[38:39]
  s_and_b32 s23, s2, 1
  s_lshl_b32 s23, s23, 2
  s_add_u32 s23, s23, s20
  s_lshl_b32 s23, s23, 7
  s_lshr_b32 s31, s2, 1
  s_add_u32 s23, s23, s31
  s_lshl_b32 s23, s23, 2
  s_add_u32 s23, s23, 2654208
  v_mov_b32 v16, 1073741824
  v_mov_b32 v17, 1
  v_writelane_b32 v16, s23, 0
  s_waitcnt vmcnt(8)
  buffer_store_dword v17, v16, s[40:43], 0 offen sc1
  s_branch fa_coW
fa_coT:
  v_min_u32 v8, 16, v1
  v_lshlrev_b32 v8, 7, v8
  s_lshl_b32 s33, s14, 1
  s_and_b32 s31, s20, 1
  s_add_u32 s33, s33, s31
  s_mul_i32 s33, s33, 2176
  s_lshl_b32 s35, s14, 2
  s_add_u32 s35, s35, s20
  s_mul_i32 s35, s35, 4352
  buffer_load_dword v14, v8, s[52:55], s33 offen
  s_add_u32 s33, s33, 552960
  s_getpc_b64 s[36:37]
  s_setpc_b64 s[38:39]
  s_add_u32 s31, s30, 4096
  buffer_store_dwordx4 v[232:235], v2, s[40:43], s30 offen offset:0 sc1
  buffer_store_dwordx4 v[236:239], v2, s[40:43], s30 offen offset:1024 sc1
  buffer_store_dwordx4 v[240:243], v2, s[40:43], s30 offen offset:2048 sc1
  buffer_store_dwordx4 v[244:247], v2, s[40:43], s30 offen offset:3072 sc1
  buffer_store_dwordx4 v[248:251], v2, s[40:43], s31 offen offset:0 sc1
  buffer_load_dword v14, v8, s[52:55], s33 offen
  s_add_u32 s33, s33, 552960
  s_getpc_b64 s[36:37]
  s_setpc_b64 s[38:39]
  buffer_load_dword v14, v8, s[52:55], s33 offen
  s_add_u32 s33, s33, 552960
  s_getpc_b64 s[36:37]
  s_setpc_b64 s[38:39]
  s_and_b32 s23, s2, 1
  s_lshl_b32 s23, s23, 2
  s_add_u32 s23, s23, s20
  s_lshl_b32 s23, s23, 7
  s_lshr_b32 s31, s2, 1
  s_add_u32 s23, s23, s31
  s_lshl_b32 s23, s23, 2
  s_add_u32 s23, s23, 2654208
  v_mov_b32 v16, 1073741824
  v_mov_b32 v17, 1
  v_writelane_b32 v16, s23, 0
  s_waitcnt vmcnt(10)
  buffer_store_dword v17, v16, s[40:43], 0 offen sc1
  buffer_load_dword v14, v8, s[52:55], s33 offen
  s_add_u32 s33, s33, 552960
  s_getpc_b64 s[36:37]
  s_setpc_b64 s[38:39]
  buffer_load_dword v14, v8, s[60:63], s35 offen
  s_getpc_b64 s[36:37]
  s_setpc_b64 s[38:39]
  buffer_load_dword v14, v8, s[60:63], s35 offen offset:2176
  s_branch fa_coW
fa_coF:
  s_getpc_b64 s[36:37]
  s_setpc_b64 s[38:39]
  s_add_u32 s31, s30, 4096
  buffer_store_dwordx4 v[232:235], v2, s[40:43], s30 offen offset:0 sc1
  buffer_store_dwordx4 v[236:239], v2, s[40:43], s30 offen offset:1024 sc1
  buffer_store_dwordx4 v[240:243], v2, s[40:43], s30 offen offset:2048 sc1
  buffer_store_dwordx4 v[244:247], v2, s[40:43], s30 offen offset:3072 sc1
  buffer_store_dwordx4 v[248:251], v2, s[40:43], s31 offen offset:0 sc1
  s_lshl_b32 s33, s14, 6
  s_and_b32 s31, s20, 1
  s_lshl_b32 s31, s31, 5
  s_add_u32 s33, s33, s31
  s_mul_i32 s35, s14, 40960
  s_mul_i32 s31, s20, 320
  s_add_u32 s35, s35, s31
  s_mul_i32 s10, s14, 20480
  s_mul_i32 s31, s20, 640
  s_add_u32 s10, s10, s31
  s_add_u32 s10, s10, 2686976
  s_getpc_b64 s[36:37]
  s_setpc_b64 s[38:39]
  v_and_b32 v11, 7, v1
  v_lshlrev_b32 v12, 2, v11
  v_add_u32 v12, 2629632, v12
  buffer_load_dword v15, v12, s[40:43], 0 offen sc1
  v_lshrrev_b32 v17, 1, v1
  v_mul_u32_u24 v8, 3456, v17
  v_and_b32 v17, 1, v1
  v_lshl_add_u32 v8, v17, 4, v8
  v_lshrrev_b32 v17, 4, v1
  v_lshrrev_b32 v18, 2, v1
  v_lshl_add_u32 v18, v17, 2, v18
  v_lshlrev_b32 v18, 5, v18
  v_and_b32 v19, 3, v1
  v_lshl_add_u32 v9, v19, 3, v18
  v_add_u32 v9, s34, v9
  v_lshlrev_b32 v10, 4, v11
  v_lshl_add_u32 v10, v17, 7, v10
  v_add_u32 v10, 151552, v10
  v_and_b32 v18, 8, v1
  v_mul_u32_u24 v11, 2560, v11
  v_lshl_add_u32 v11, v17, 4, v11
  v_lshl_add_u32 v11, v18, 27, v11
  s_getpc_b64 s[36:37]
  s_setpc_b64 s[38:39]
  s_and_b32 s23, s2, 1
  s_lshl_b32 s23, s23, 2
  s_add_u32 s23, s23, s20
  s_lshl_b32 s23, s23, 7
  s_lshr_b32 s31, s2, 1
  s_add_u32 s23, s23, s31
  s_lshl_b32 s23, s23, 2
  s_add_u32 s23, s23, 2654208
  v_mov_b32 v16, 1073741824
  v_mov_b32 v17, 1
  v_writelane_b32 v16, s23, 0
  s_waitcnt vmcnt(9)
  buffer_store_dword v17, v16, s[40:43], 0 offen sc1
  s_add_u32 m0, s34, 0
  s_nop 0
  buffer_load_dwordx4 v8, s[52:55], s33 offen lds
  s_add_u32 s33, s33, 110592
  s_add_u32 m0, s34, 1024
  s_nop 0
  buffer_load_dwordx4 v8, s[52:55], s33 offen lds
  s_add_u32 s33, s33, 110592
  s_add_u32 m0, s34, 2048
  s_nop 0
  buffer_load_dwordx4 v8, s[52:55], s33 offen lds
  s_add_u32 s33, s33, 110592
  s_add_u32 m0, s34, 3072
  s_nop 0
  buffer_load_dwordx4 v8, s[52:55], s33 offen lds
  s_add_u32 s33, s33, 110592
  s_add_u32 m0, s34, 4096
  s_nop 0
  buffer_load_dwordx4 v8, s[52:55], s33 offen lds
  s_add_u32 s33, s33, 110592
  s_getpc_b64 s[36:37]
  s_setpc_b64 s[38:39]
  s_waitcnt vmcnt(14)
  v_cmp_eq_u32 vcc, 0, v15
  s_cbranch_vccnz fa_sel_spin
fa_sel_ok:
  v_add_u32 v18, -1, v15
  v_and_b32 v18, 2047, v18
  v_lshrrev_b32 v19, 4, v18
  v_mul_u32_u24 v19, 20480, v19
  v_and_b32 v18, 15, v18
  v_lshl_add_u32 v19, v18, 4, v19
  v_lshrrev_b32 v18, 3, v1
  v_lshl_add_u32 v19, v18, 8, v19
  s_lshl_b32 s23, s20, 11
  s_lshl_b32 s31, s20, 10
  s_add_u32 s31, s31, 151552
  s_mov_b32 m0, s31
  s_add_u32 s31, s31, 4096
  buffer_load_dwordx4 v19, s[40:43], s23 offen sc1 lds
  s_add_u32 s23, s23, 8192
  s_mov_b32 m0, s31
  s_add_u32 s31, s31, 4096
  buffer_load_dwordx4 v19, s[40:43], s23 offen sc1 lds
  s_add_u32 s23, s23, 8192
  s_mov_b32 m0, s31
  s_add_u32 s31, s31, 4096
  buffer_load_dwordx4 v19, s[40:43], s23 offen sc1 lds
  s_add_u32 s23, s23, 8192
  s_getpc_b64 s[36:37]
  s_setpc_b64 s[38:39]
  s_waitcnt vmcnt(4)
  s_getpc_b64 s[36:37]
  s_setpc_b64 s[38:39]
  ds_read_b64_tr_b16 a[192:193], v9 offset:0
  ds_read_b64_tr_b16 a[194:195], v9 offset:128
  ds_read_b128 a[212:215], v10 offset:0
  ds_read_b64_tr_b16 a[196:197], v9 offset:1024
  ds_read_b64_tr_b16 a[198:199], v9 offset:1152
  ds_read_b128 a[216:219], v10 offset:512
  ds_read_b64_tr_b16 a[200:201], v9 offset:2048
  ds_read_b64_tr_b16 a[202:203], v9 offset:2176
  ds_read_b128 a[220:223], v10 offset:1024
  ds_read_b64_tr_b16 a[204:205], v9 offset:3072
  ds_read_b64_tr_b16 a[206:207], v9 offset:3200
  ds_read_b128 a[224:227], v10 offset:1536
  ds_read_b64_tr_b16 a[208:209], v9 offset:4096
  ds_read_b64_tr_b16 a[210:211], v9 offset:4224
  ds_read_b128 a[228:231], v10 offset:2048
  s_getpc_b64 s[36:37]
  s_setpc_b64 s[38:39]
  v_mfma_f32_16x16x32_bf16 v[232:235], a[192:195], a[212:215], 0
  v_mfma_f32_16x16x32_bf16 v[232:235], a[196:199], a[216:219], v[232:235]
  v_mfma_f32_16x16x32_bf16 v[232:235], a[200:203], a[220:223], v[232:235]
  v_mfma_f32_16x16x32_bf16 v[232:235], a[204:207], a[224:227], v[232:235]
  v_mfma_f32_16x16x32_bf16 v[232:235], a[208:211], a[228:231], v[232:235]
  s_add_u32 m0, s34, 0
  s_nop 0
  buffer_load_dwordx4 v8, s[52:55], s33 offen lds
  s_add_u32 s33, s33, 110592
  s_add_u32 m0, s34, 1024
  s_nop 0
  buffer_load_dwordx4 v8, s[52:55], s33 offen lds
  s_add_u32 s33, s33, 110592
  s_add_u32 m0, s34, 2048
  s_nop 0
  buffer_load_dwordx4 v8, s[52:55], s33 offen lds
  s_add_u32 s33, s33, 110592
  s_add_u32 m0, s34, 3072
  s_nop 0
  buffer_load_dwordx4 v8, s[52:55], s33 offen lds
  s_add_u32 s33, s33, 110592
  s_add_u32 m0, s34, 4096
  s_nop 0
  buffer_load_dwordx4 v8, s[52:55], s33 offen lds
  s_add_u32 s33, s33, 110592
  s_getpc_b64 s[36:37]
  s_setpc_b64 s[38:39]
  s_getpc_b64 s[36:37]
  s_setpc_b64 s[38:39]
  s_waitcnt vmcnt(8)
  ds_read_b64_tr_b16 a[192:193], v9 offset:0
  ds_read_b64_tr_b16 a[194:195], v9 offset:128
  ds_read_b128 a[212:215], v10 offset:2560
  ds_read_b64_tr_b16 a[196:197], v9 offset:1024
  ds_read_b64_tr_b16 a[198:199], v9 offset:1152
  ds_read_b128 a[216:219], v10 offset:3072
  ds_read_b64_tr_b16 a[200:201], v9 offset:2048
  ds_read_b64_tr_b16 a[202:203], v9 offset:2176
  ds_read_b128 a[220:223], v10 offset:3584
  ds_read_b64_tr_b16 a[204:205], v9 offset:3072
  ds_read_b64_tr_b16 a[206:207], v9 offset:3200
  ds_read_b128 a[224:227], v10 offset:4096
  ds_read_b64_tr_b16 a[208:209], v9 offset:4096
  ds_read_b64_tr_b16 a[210:211], v9 offset:4224
  ds_read_b128 a[228:231], v10 offset:4608
  s_getpc_b64 s[36:37]
  s_setpc_b64 s[38:39]
  v_mfma_f32_16x16x32_bf16 v[232:235], a[192:195], a[212:215], v[232:235]
  v_mfma_f32_16x16x32_bf16 v[232:235], a[196:199], a[216:219], v[232:235]
  v_mfma_f32_16x16x32_bf16 v[232:235], a[200:203], a[220:223], v[232:235]
  v_mfma_f32_16x16x32_bf16 v[232:235], a[204:207], a[224:227], v[232:235]
  v_mfma_f32_16x16x32_bf16 v[232:235], a[208:211], a[228:231], v[232:235]
  s_add_u32 m0, s34, 0
  s_nop 0
  buffer_load_dwordx4 v8, s[52:55], s33 offen lds
  s_add_u32 s33, s33, 110592
  s_add_u32 m0, s34, 1024
  s_nop 0
  buffer_load_dwordx4 v8, s[52:55], s33 offen lds
  s_add_u32 s33, s33, 110592
  s_add_u32 m0, s34, 2048
  s_nop 0
  buffer_load_dwordx4 v8, s[52:55], s33 offen lds
  s_add_u32 s33, s33, 110592
  s_add_u32 m0, s34, 3072
  s_nop 0
  buffer_load_dwordx4 v8, s[52:55], s33 offen lds
  s_add_u32 s33, s33, 110592
  s_add_u32 m0, s34, 4096
  s_nop 0
  buffer_load_dwordx4 v8, s[52:55], s33 offen lds
  s_add_u32 s33, s33, 110592
  s_getpc_b64 s[36:37]
  s_setpc_b64 s[38:39]
  s_getpc_b64 s[36:37]
  s_setpc_b64 s[38:39]
  s_waitcnt vmcnt(8)
  ds_read_b64_tr_b16 a[192:193], v9 offset:0
  ds_read_b64_tr_b16 a[194:195], v9 offset:128
  ds_read_b128 a[212:215], v10 offset:5120
  ds_read_b64_tr_b16 a[196:197], v9 offset:1024
  ds_read_b64_tr_b16 a[198:199], v9 offset:1152
  ds_read_b128 a[216:219], v10 offset:5632
  ds_read_b64_tr_b16 a[200:201], v9 offset:2048
  ds_read_b64_tr_b16 a[202:203], v9 offset:2176
  ds_read_b128 a[220:223], v10 offset:6144
  ds_read_b64_tr_b16 a[204:205], v9 offset:3072
  ds_read_b64_tr_b16 a[206:207], v9 offset:3200
  ds_read_b128 a[224:227], v10 offset:6656
  ds_read_b64_tr_b16 a[208:209], v9 offset:4096
  ds_read_b64_tr_b16 a[210:211], v9 offset:4224
  ds_read_b128 a[228:231], v10 offset:7168
  s_getpc_b64 s[36:37]
  s_setpc_b64 s[38:39]
  v_mfma_f32_16x16x32_bf16 v[232:235], a[192:195], a[212:215], v[232:235]
  v_mfma_f32_16x16x32_bf16 v[232:235], a[196:199], a[216:219], v[232:235]
  v_mfma_f32_16x16x32_bf16 v[232:235], a[200:203], a[220:223], v[232:235]
  v_mfma_f32_16x16x32_bf16 v[232:235], a[204:207], a[224:227], v[232:235]
  v_mfma_f32_16x16x32_bf16 v[232:235], a[208:211], a[228:231], v[232:235]
  s_add_u32 m0, s34, 0
  s_nop 0
  buffer_load_dwordx4 v8, s[52:55], s33 offen lds
  s_add_u32 s33, s33, 110592
  s_add_u32 m0, s34, 1024
  s_nop 0
  buffer_load_dwordx4 v8, s[52:55], s33 offen lds
  s_add_u32 s33, s33, 110592
  s_add_u32 m0, s34, 2048
  s_nop 0
  buffer_load_dwordx4 v8, s[52:55], s33 offen lds
  s_add_u32 s33, s33, 110592
  s_add_u32 m0, s34, 3072
  s_nop 0
  buffer_load_dwordx4 v8, s[52:55], s33 offen lds
  s_add_u32 s33, s33, 110592
  s_add_u32 m0, s34, 4096
  s_nop 0
  buffer_load_dwordx4 v8, s[52:55], s33 offen lds
  s_add_u32 s33, s33, 110592
  s_getpc_b64 s[36:37]
  s_setpc_b64 s[38:39]
  s_getpc_b64 s[36:37]
  s_setpc_b64 s[38:39]
  s_waitcnt vmcnt(8)
  ds_read_b64_tr_b16 a[192:193], v9 offset:0
  ds_read_b64_tr_b16 a[194:195], v9 offset:128
  ds_read_b128 a[212:215], v10 offset:7680
  ds_read_b64_tr_b16 a[196:197], v9 offset:1024
  ds_read_b64_tr_b16 a[198:199], v9 offset:1152
  ds_read_b128 a[216:219], v10 offset:8192
  ds_read_b64_tr_b16 a[200:201], v9 offset:2048
  ds_read_b64_tr_b16 a[202:203], v9 offset:2176
  ds_read_b128 a[220:223], v10 offset:8704
  ds_read_b64_tr_b16 a[204:205], v9 offset:3072
  ds_read_b64_tr_b16 a[206:207], v9 offset:3200
  ds_read_b128 a[224:227], v10 offset:9216
  ds_read_b64_tr_b16 a[208:209], v9 offset:4096
  ds_read_b64_tr_b16 a[210:211], v9 offset:4224
  ds_read_b128 a[228:231], v10 offset:9728
  s_getpc_b64 s[36:37]
  s_setpc_b64 s[38:39]
  v_mfma_f32_16x16x32_bf16 v[232:235], a[192:195], a[212:215], v[232:235]
  v_mfma_f32_16x16x32_bf16 v[232:235], a[196:199], a[216:219], v[232:235]
  v_mfma_f32_16x16x32_bf16 v[232:235], a[200:203], a[220:223], v[232:235]
  v_mfma_f32_16x16x32_bf16 v[232:235], a[204:207], a[224:227], v[232:235]
  v_mfma_f32_16x16x32_bf16 v[232:235], a[208:211], a[228:231], v[232:235]
  s_add_u32 m0, s34, 0
  v_accvgpr_read_b32 v19, a248
  buffer_load_dwordx4 v19, s[60:63], s35 offen lds
  s_add_u32 m0, s34, 1024
  v_accvgpr_read_b32 v19, a249
  buffer_load_dwordx4 v19, s[60:63], s35 offen lds
  s_add_u32 m0, s34, 2048
  v_accvgpr_read_b32 v19, a250
  buffer_load_dwordx4 v19, s[60:63], s35 offen lds
  s_add_u32 m0, s34, 3072
  v_accvgpr_read_b32 v19, a251
  buffer_load_dwordx4 v19, s[60:63], s35 offen lds
  s_add_u32 m0, s34, 4096
  v_accvgpr_read_b32 v19, a252
  buffer_load_dwordx4 v19, s[60:63], s35 offen lds
  s_add_u32 s35, s35, 160
  s_lshl_b32 s23, s20, 9
  v_add_u32 v16, s23, v10
  ds_write_b128 v16, v[232:235] offset:10240
  s_getpc_b64 s[36:37]
  s_setpc_b64 s[38:39]
  s_getpc_b64 s[36:37]
  s_setpc_b64 s[38:39]
  ds_read_b128 v[236:239], v10 offset:10240
  ds_read_b128 v[240:243], v10 offset:10752
  ds_read_b128 v[244:247], v10 offset:11264
  ds_read_b128 v[248:251], v10 offset:11776
  s_waitcnt vmcnt(8)
  ds_read_b64_tr_b16 a[192:193], v6 offset:0
  ds_read_b64_tr_b16 a[194:195], v6 offset:2560
  ds_read_b64_tr_b16 a[196:197], v6 offset:32
  ds_read_b64_tr_b16 a[198:199], v6 offset:2592
  ds_read_b64_tr_b16 a[200:201], v6 offset:64
  ds_read_b64_tr_b16 a[202:203], v6 offset:2624
  ds_read_b64_tr_b16 a[204:205], v6 offset:96
  ds_read_b64_tr_b16 a[206:207], v6 offset:2656
  ds_read_b64_tr_b16 a[208:209], v6 offset:128
  ds_read_b64_tr_b16 a[210:211], v6 offset:2688
  s_getpc_b64 s[36:37]
  s_setpc_b64 s[38:39]
  v_cvt_pk_bf16_f32 v236, v236, v244
  v_cvt_pk_bf16_f32 v237, v237, v245
  v_cvt_pk_bf16_f32 v238, v238, v246
  v_cvt_pk_bf16_f32 v239, v239, v247
  v_cvt_pk_bf16_f32 v240, v240, v248
  v_cvt_pk_bf16_f32 v241, v241, v249
  v_cvt_pk_bf16_f32 v242, v242, v250
  v_cvt_pk_bf16_f32 v243, v243, v251
  v_lshlrev_b32 v244, 16, v236
  v_lshlrev_b32 v245, 16, v237
  v_lshlrev_b32 v246, 16, v238
  v_lshlrev_b32 v247, 16, v239
  v_lshlrev_b32 v248, 16, v240
  v_lshlrev_b32 v249, 16, v241
  v_lshlrev_b32 v250, 16, v242
  v_lshlrev_b32 v251, 16, v243
  v_mul_f32 v16, 0xbfb8aa3b, v244
  v_mul_f32 v17, 0xbfb8aa3b, v245
  v_mul_f32 v18, 0xbfb8aa3b, v246
  v_mul_f32 v19, 0xbfb8aa3b, v247
  v_mul_f32 v20, 0xbfb8aa3b, v248
  v_mul_f32 v21, 0xbfb8aa3b, v249
  v_mul_f32 v22, 0xbfb8aa3b, v250
  v_mul_f32 v23, 0xbfb8aa3b, v251
  v_exp_f32 v16, v16
  v_exp_f32 v17, v17
  v_exp_f32 v18, v18
  v_exp_f32 v19, v19
  v_exp_f32 v20, v20
  v_exp_f32 v21, v21
  v_exp_f32 v22, v22
  v_exp_f32 v23, v23
  v_add_f32 v16, 1.0, v16
  v_add_f32 v17, 1.0, v17
  v_add_f32 v18, 1.0, v18
  v_add_f32 v19, 1.0, v19
  v_add_f32 v20, 1.0, v20
  v_add_f32 v21, 1.0, v21
  v_add_f32 v22, 1.0, v22
  v_add_f32 v23, 1.0, v23
  v_rcp_f32 v16, v16
  v_rcp_f32 v17, v17
  v_rcp_f32 v18, v18
  v_rcp_f32 v19, v19
  v_rcp_f32 v20, v20
  v_rcp_f32 v21, v21
  v_rcp_f32 v22, v22
  v_rcp_f32 v23, v23
  v_mul_f32 v244, v244, v16
  v_mul_f32 v245, v245, v17
  v_mul_f32 v246, v246, v18
  v_mul_f32 v247, v247, v19
  v_mul_f32 v248, v248, v20
  v_mul_f32 v249, v249, v21
  v_mul_f32 v250, v250, v22
  v_mul_f32 v251, v251, v23
  v_cvt_pk_bf16_f32 v16, v244, v245
  v_cvt_pk_bf16_f32 v17, v246, v247
  v_cvt_pk_bf16_f32 v18, v248, v249
  v_cvt_pk_bf16_f32 v19, v250, v251
  v_and_b32 v236, 0xffff0000, v236
  v_and_b32 v237, 0xffff0000, v237
  v_and_b32 v238, 0xffff0000, v238
  v_and_b32 v239, 0xffff0000, v239
  v_and_b32 v240, 0xffff0000, v240
  v_and_b32 v241, 0xffff0000, v241
  v_and_b32 v242, 0xffff0000, v242
  v_and_b32 v243, 0xffff0000, v243
  v_lshlrev_b32 v244, 16, v16
  v_and_b32 v245, 0xffff0000, v16
  v_lshlrev_b32 v246, 16, v17
  v_and_b32 v247, 0xffff0000, v17
  v_lshlrev_b32 v248, 16, v18
  v_and_b32 v249, 0xffff0000, v18
  v_lshlrev_b32 v250, 16, v19
  v_and_b32 v251, 0xffff0000, v19
  v_mul_f32 v236, v236, v244
  v_mul_f32 v237, v237, v245
  v_mul_f32 v238, v238, v246
  v_mul_f32 v239, v239, v247
  v_mul_f32 v240, v240, v248
  v_mul_f32 v241, v241, v249
  v_mul_f32 v242, v242, v250
  v_mul_f32 v243, v243, v251
  v_cvt_pk_bf16_f32 v232, v236, v237
  v_cvt_pk_bf16_f32 v233, v238, v239
  v_cvt_pk_bf16_f32 v234, v240, v241
  v_cvt_pk_bf16_f32 v235, v242, v243
  s_nop 1
  v_mfma_f32_16x16x32_bf16 v[236:239], a[192:195], v[232:235], 0
  v_mfma_f32_16x16x32_bf16 v[240:243], a[196:199], v[232:235], 0
  v_mfma_f32_16x16x32_bf16 v[244:247], a[200:203], v[232:235], 0
  v_mfma_f32_16x16x32_bf16 v[248:251], a[204:207], v[232:235], 0
  v_mfma_f32_16x16x32_bf16 v[252:255], a[208:211], v[232:235], 0
  s_add_u32 m0, s34, 0
  v_accvgpr_read_b32 v19, a248
  buffer_load_dwordx4 v19, s[60:63], s35 offen lds
  s_add_u32 m0, s34, 1024
  v_accvgpr_read_b32 v19, a249
  buffer_load_dwordx4 v19, s[60:63], s35 offen lds
  s_add_u32 m0, s34, 2048
  v_accvgpr_read_b32 v19, a250
  buffer_load_dwordx4 v19, s[60:63], s35 offen lds
  s_add_u32 m0, s34, 3072
  v_accvgpr_read_b32 v19, a251
  buffer_load_dwordx4 v19, s[60:63], s35 offen lds
  s_add_u32 m0, s34, 4096
  v_accvgpr_read_b32 v19, a252
  buffer_load_dwordx4 v19, s[60:63], s35 offen lds
  s_add_u32 s35, s35, 160
  buffer_store_dwordx4 v[236:239], v11, s[40:43], s10 offen offset:0 sc1
  buffer_store_dwordx4 v[240:243], v11, s[40:43], s10 offen offset:64 sc1
  buffer_store_dwordx4 v[244:247], v11, s[40:43], s10 offen offset:128 sc1
  buffer_store_dwordx4 v[248:251], v11, s[40:43], s10 offen offset:192 sc1
  buffer_store_dwordx4 v[252:255], v11, s[40:43], s10 offen offset:256 sc1
  s_add_u32 s10, s10, 320
  s_getpc_b64 s[36:37]
  s_setpc_b64 s[38:39]
  s_getpc_b64 s[36:37]
  s_setpc_b64 s[38:39]
  s_waitcnt vmcnt(13)
  ds_read_b64_tr_b16 a[192:193], v6 offset:0
  ds_read_b64_tr_b16 a[194:195], v6 offset:2560
  ds_read_b64_tr_b16 a[196:197], v6 offset:32
  ds_read_b64_tr_b16 a[198:199], v6 offset:2592
  ds_read_b64_tr_b16 a[200:201], v6 offset:64
  ds_read_b64_tr_b16 a[202:203], v6 offset:2624
  ds_read_b64_tr_b16 a[204:205], v6 offset:96
  ds_read_b64_tr_b16 a[206:207], v6 offset:2656
  ds_read_b64_tr_b16 a[208:209], v6 offset:128
  ds_read_b64_tr_b16 a[210:211], v6 offset:2688
  s_waitcnt lgkmcnt(0)
  v_mfma_f32_16x16x32_bf16 v[236:239], a[192:195], v[232:235], 0
  v_mfma_f32_16x16x32_bf16 v[240:243], a[196:199], v[232:235], 0
  v_mfma_f32_16x16x32_bf16 v[244:247], a[200:203], v[232:235], 0
  v_mfma_f32_16x16x32_bf16 v[248:251], a[204:207], v[232:235], 0
  v_mfma_f32_16x16x32_bf16 v[252:255], a[208:211], v[232:235], 0
  s_nop 7
  buffer_store_dwordx4 v[236:239], v11, s[40:43], s10 offen offset:0 sc1
  buffer_store_dwordx4 v[240:243], v11, s[40:43], s10 offen offset:64 sc1
  buffer_store_dwordx4 v[244:247], v11, s[40:43], s10 offen offset:128 sc1
  buffer_store_dwordx4 v[248:251], v11, s[40:43], s10 offen offset:192 sc1
  buffer_store_dwordx4 v[252:255], v11, s[40:43], s10 offen offset:256 sc1
  s_add_u32 s10, s10, 320
  s_getpc_b64 s[36:37]
  s_setpc_b64 s[38:39]
  s_and_b32 s23, s2, 63
  s_lshl_b32 s31, s20, 6
  s_add_u32 s23, s23, s31
  s_lshl_b32 s23, s23, 2
  s_add_u32 s23, s23, 2650112
  v_mov_b32 v16, 1073741824
  v_mov_b32 v17, 1
  v_writelane_b32 v16, s23, 0
  s_waitcnt vmcnt(4)
  buffer_store_dword v17, v16, s[40:43], 0 offen sc1
fa_coW:
  s_mov_b32 s12, 1
  s_cmp_lg_u32 s11, 0
  s_cselect_b32 s32, s15, -1
  s_getpc_b64 s[36:37]
  s_setpc_b64 s[38:39]
  s_lshl_b32 s23, s22, 2
  s_add_u32 s23, s23, s20
  s_mul_i32 s13, s23, 163840
  s_add_u32 s13, s13, 4194304
  s_lshl_b32 s23, s23, 7
  s_add_u32 s23, s23, 2654208
  v_and_b32 v9, 31, v1
  v_lshl_add_u32 v9, v9, 2, s23
  buffer_load_dword v8, v9, s[40:43], 0 offen sc1
  v_mov_b32 v20, v228
  v_mov_b32 v21, v229
  s_nop 1
  v_permlane16_swap_b32 v228, v20
  v_permlane16_swap_b32 v229, v21
  v_add_f32 v228, v228, v20
  v_add_f32 v229, v229, v21
  v_mov_b32 v20, v228
  v_mov_b32 v21, v229
  s_nop 1
  v_permlane32_swap_b32 v228, v20
  v_permlane32_swap_b32 v229, v21
  v_add_f32 v228, v228, v20
  v_add_f32 v229, v229, v21
  v_rcp_f32 v16, v228
  v_rcp_f32 v18, v229
  s_lshl_b32 s23, s22, 2
  v_mov_b32 v17, v16
  v_mov_b32 v19, v18
  s_add_u32 s23, s23, s20
  s_lshl_b32 s23, s23, 18
  s_lshl_b32 s31, s21, 12
  s_add_u32 s31, s31, 50331648
  s_add_u32 s64, s23, s31
  s_add_u32 s65, s64, 131072
  v_accvgpr_read_b32 v36, a0
  v_accvgpr_read_b32 v37, a1
  v_accvgpr_read_b32 v38, a2
  v_accvgpr_read_b32 v39, a3
  v_accvgpr_read_b32 v40, a8
  v_accvgpr_read_b32 v41, a9
  v_accvgpr_read_b32 v42, a10
  v_accvgpr_read_b32 v43, a11
  v_pk_mul_f32 v[36:37], v[36:37], v[16:17]
  v_pk_mul_f32 v[38:39], v[38:39], v[16:17]
  v_pk_mul_f32 v[40:41], v[40:41], v[16:17]
  v_pk_mul_f32 v[42:43], v[42:43], v[16:17]
  v_cvt_pk_bf16_f32 v32, v36, v37
  v_cvt_pk_bf16_f32 v33, v38, v39
  v_cvt_pk_bf16_f32 v34, v40, v41
  v_cvt_pk_bf16_f32 v35, v42, v43
  buffer_store_dwordx4 v[32:35], v2, s[40:43], s64 offen offset:0 sc1
  v_accvgpr_read_b32 v48, a16
  v_accvgpr_read_b32 v49, a17
  v_accvgpr_read_b32 v50, a18
  v_accvgpr_read_b32 v51, a19
  v_accvgpr_read_b32 v52, a24
  v_accvgpr_read_b32 v53, a25
  v_accvgpr_read_b32 v54, a26
  v_accvgpr_read_b32 v55, a27
  v_pk_mul_f32 v[48:49], v[48:49], v[16:17]
  v_pk_mul_f32 v[50:51], v[50:51], v[16:17]
  v_pk_mul_f32 v[52:53], v[52:53], v[16:17]
  v_pk_mul_f32 v[54:55], v[54:55], v[16:17]
  v_cvt_pk_bf16_f32 v44, v48, v49
  v_cvt_pk_bf16_f32 v45, v50, v51
  v_cvt_pk_bf16_f32 v46, v52, v53
  v_cvt_pk_bf16_f32 v47, v54, v55
  buffer_store_dwordx4 v[44:47], v2, s[40:43], s64 offen offset:1024 sc1
  v_accvgpr_read_b32 v100, a32
  v_accvgpr_read_b32 v101, a33
  v_accvgpr_read_b32 v102, a34
  v_accvgpr_read_b32 v103, a35
  v_accvgpr_read_b32 v104, a40
  v_accvgpr_read_b32 v105, a41
  v_accvgpr_read_b32 v106, a42
  v_accvgpr_read_b32 v107, a43
  v_pk_mul_f32 v[100:101], v[100:101], v[16:17]
  v_pk_mul_f32 v[102:103], v[102:103], v[16:17]
  v_pk_mul_f32 v[104:105], v[104:105], v[16:17]
  v_pk_mul_f32 v[106:107], v[106:107], v[16:17]
  v_cvt_pk_bf16_f32 v96, v100, v101
  v_cvt_pk_bf16_f32 v97, v102, v103
  v_cvt_pk_bf16_f32 v98, v104, v105
  v_cvt_pk_bf16_f32 v99, v106, v107
  buffer_store_dwordx4 v[96:99], v2, s[40:43], s64 offen offset:2048 sc1
  v_accvgpr_read_b32 v112, a48
  v_accvgpr_read_b32 v113, a49
  v_accvgpr_read_b32 v114, a50
  v_accvgpr_read_b32 v115, a51
  v_accvgpr_read_b32 v116, a56
  v_accvgpr_read_b32 v117, a57
  v_accvgpr_read_b32 v118, a58
  v_accvgpr_read_b32 v119, a59
  v_pk_mul_f32 v[112:113], v[112:113], v[16:17]
  v_pk_mul_f32 v[114:115], v[114:115], v[16:17]
  v_pk_mul_f32 v[116:117], v[116:117], v[16:17]
  v_pk_mul_f32 v[118:119], v[118:119], v[16:17]
  v_cvt_pk_bf16_f32 v108, v112, v113
  v_cvt_pk_bf16_f32 v109, v114, v115
  v_cvt_pk_bf16_f32 v110, v116, v117
  v_cvt_pk_bf16_f32 v111, v118, v119
  buffer_store_dwordx4 v[108:111], v2, s[40:43], s64 offen offset:3072 sc1
  v_accvgpr_read_b32 v36, a4
  v_accvgpr_read_b32 v37, a5
  v_accvgpr_read_b32 v38, a6
  v_accvgpr_read_b32 v39, a7
  v_accvgpr_read_b32 v40, a12
  v_accvgpr_read_b32 v41, a13
  v_accvgpr_read_b32 v42, a14
  v_accvgpr_read_b32 v43, a15
  v_pk_mul_f32 v[36:37], v[36:37], v[18:19]
  v_pk_mul_f32 v[38:39], v[38:39], v[18:19]
  v_pk_mul_f32 v[40:41], v[40:41], v[18:19]
  v_pk_mul_f32 v[42:43], v[42:43], v[18:19]
  v_cvt_pk_bf16_f32 v32, v36, v37
  v_cvt_pk_bf16_f32 v33, v38, v39
  v_cvt_pk_bf16_f32 v34, v40, v41
  v_cvt_pk_bf16_f32 v35, v42, v43
  buffer_store_dwordx4 v[32:35], v2, s[40:43], s65 offen offset:0 sc1
  v_accvgpr_read_b32 v48, a20
  v_accvgpr_read_b32 v49, a21
  v_accvgpr_read_b32 v50, a22
  v_accvgpr_read_b32 v51, a23
  v_accvgpr_read_b32 v52, a28
  v_accvgpr_read_b32 v53, a29
  v_accvgpr_read_b32 v54, a30
  v_accvgpr_read_b32 v55, a31
  v_pk_mul_f32 v[48:49], v[48:49], v[18:19]
  v_pk_mul_f32 v[50:51], v[50:51], v[18:19]
  v_pk_mul_f32 v[52:53], v[52:53], v[18:19]
  v_pk_mul_f32 v[54:55], v[54:55], v[18:19]
  v_cvt_pk_bf16_f32 v44, v48, v49
  v_cvt_pk_bf16_f32 v45, v50, v51
  v_cvt_pk_bf16_f32 v46, v52, v53
  v_cvt_pk_bf16_f32 v47, v54, v55
  buffer_store_dwordx4 v[44:47], v2, s[40:43], s65 offen offset:1024 sc1
  v_accvgpr_read_b32 v100, a36
  v_accvgpr_read_b32 v101, a37
  v_accvgpr_read_b32 v102, a38
  v_accvgpr_read_b32 v103, a39
  v_accvgpr_read_b32 v104, a44
  v_accvgpr_read_b32 v105, a45
  v_accvgpr_read_b32 v106, a46
  v_accvgpr_read_b32 v107, a47
  v_pk_mul_f32 v[100:101], v[100:101], v[18:19]
  v_pk_mul_f32 v[102:103], v[102:103], v[18:19]
  v_pk_mul_f32 v[104:105], v[104:105], v[18:19]
  v_pk_mul_f32 v[106:107], v[106:107], v[18:19]
  v_cvt_pk_bf16_f32 v96, v100, v101
  v_cvt_pk_bf16_f32 v97, v102, v103
  v_cvt_pk_bf16_f32 v98, v104, v105
  v_cvt_pk_bf16_f32 v99, v106, v107
  buffer_store_dwordx4 v[96:99], v2, s[40:43], s65 offen offset:2048 sc1
  v_accvgpr_read_b32 v112, a52
  v_accvgpr_read_b32 v113, a53
  v_accvgpr_read_b32 v114, a54
  v_accvgpr_read_b32 v115, a55
  v_accvgpr_read_b32 v116, a60
  v_accvgpr_read_b32 v117, a61
  v_accvgpr_read_b32 v118, a62
  v_accvgpr_read_b32 v119, a63
  v_pk_mul_f32 v[112:113], v[112:113], v[18:19]
  v_pk_mul_f32 v[114:115], v[114:115], v[18:19]
  v_pk_mul_f32 v[116:117], v[116:117], v[18:19]
  v_pk_mul_f32 v[118:119], v[118:119], v[18:19]
  v_cvt_pk_bf16_f32 v108, v112, v113
  v_cvt_pk_bf16_f32 v109, v114, v115
  v_cvt_pk_bf16_f32 v110, v116, v117
  v_cvt_pk_bf16_f32 v111, v118, v119
  buffer_store_dwordx4 v[108:111], v2, s[40:43], s65 offen offset:3072 sc1
  s_getpc_b64 s[36:37]
  s_setpc_b64 s[38:39]
  s_waitcnt vmcnt(8)
  v_cmp_eq_u32 vcc, 0, v8
  s_cbranch_vccnz fa_wof_spin
fa_wof_ok:
  buffer_load_dwordx4 a[0:3], v2, s[40:43], s13 offen offset:0 sc1
  buffer_load_dwordx4 a[4:7], v2, s[40:43], s13 offen offset:1024 sc1
  buffer_load_dwordx4 a[8:11], v2, s[40:43], s13 offen offset:2048 sc1
  buffer_load_dwordx4 a[12:15], v2, s[40:43], s13 offen offset:3072 sc1
  s_add_u32 s13, s13, 4096
  buffer_load_dwordx4 a[16:19], v2, s[40:43], s13 offen offset:0 sc1
  buffer_load_dwordx4 a[20:23], v2, s[40:43], s13 offen offset:1024 sc1
  buffer_load_dwordx4 a[24:27], v2, s[40:43], s13 offen offset:2048 sc1
  buffer_load_dwordx4 a[28:31], v2, s[40:43], s13 offen offset:3072 sc1
  s_add_u32 s13, s13, 4096
  buffer_load_dwordx4 a[32:35], v2, s[40:43], s13 offen offset:0 sc1
  buffer_load_dwordx4 a[36:39], v2, s[40:43], s13 offen offset:1024 sc1
  s_getpc_b64 s[36:37]
  s_setpc_b64 s[38:39]
  buffer_load_dwordx4 a[40:43], v2, s[40:43], s13 offen offset:2048 sc1
  buffer_load_dwordx4 a[44:47], v2, s[40:43], s13 offen offset:3072 sc1
  s_add_u32 s13, s13, 4096
  buffer_load_dwordx4 a[48:51], v2, s[40:43], s13 offen offset:0 sc1
  buffer_load_dwordx4 a[52:55], v2, s[40:43], s13 offen offset:1024 sc1
  buffer_load_dwordx4 a[56:59], v2, s[40:43], s13 offen offset:2048 sc1
  buffer_load_dwordx4 a[60:63], v2, s[40:43], s13 offen offset:3072 sc1
  s_add_u32 s13, s13, 4096
  buffer_load_dwordx4 a[192:195], v2, s[40:43], s13 offen offset:0 sc1
  buffer_load_dwordx4 a[196:199], v2, s[40:43], s13 offen offset:1024 sc1
  buffer_load_dwordx4 a[200:203], v2, s[40:43], s13 offen offset:2048 sc1
  buffer_load_dwordx4 a[204:207], v2, s[40:43], s13 offen offset:3072 sc1
  s_add_u32 s13, s13, 4096
  s_getpc_b64 s[36:37]
  s_setpc_b64 s[38:39]
  buffer_load_dwordx4 a[208:211], v2, s[40:43], s13 offen offset:0 sc1
  buffer_load_dwordx4 a[212:215], v2, s[40:43], s13 offen offset:1024 sc1
  buffer_load_dwordx4 a[216:219], v2, s[40:43], s13 offen offset:2048 sc1
  buffer_load_dwordx4 a[220:223], v2, s[40:43], s13 offen offset:3072 sc1
  s_add_u32 s13, s13, 4096
  buffer_load_dwordx4 a[224:227], v2, s[40:43], s13 offen offset:0 sc1
  buffer_load_dwordx4 a[228:231], v2, s[40:43], s13 offen offset:1024 sc1
  buffer_load_dwordx4 a[232:235], v2, s[40:43], s13 offen offset:2048 sc1
  buffer_load_dwordx4 a[236:239], v2, s[40:43], s13 offen offset:3072 sc1
  s_add_u32 s13, s13, 4096
  buffer_load_dwordx4 a[240:243], v2, s[40:43], s13 offen offset:0 sc1
  buffer_load_dwordx4 a[244:247], v2, s[40:43], s13 offen offset:1024 sc1
  s_getpc_b64 s[36:37]
  s_setpc_b64 s[38:39]
  buffer_load_dwordx4 a[248:251], v2, s[40:43], s13 offen offset:2048 sc1
  buffer_load_dwordx4 a[252:255], v2, s[40:43], s13 offen offset:3072 sc1
  s_add_u32 s13, s13, 4096
  buffer_load_dwordx4 v[32:35], v2, s[40:43], s13 offen offset:0 sc1
  buffer_load_dwordx4 v[36:39], v2, s[40:43], s13 offen offset:1024 sc1
  buffer_load_dwordx4 v[40:43], v2, s[40:43], s13 offen offset:2048 sc1
  buffer_load_dwordx4 v[44:47], v2, s[40:43], s13 offen offset:3072 sc1
  s_add_u32 s13, s13, 4096
  buffer_load_dwordx4 v[48:51], v2, s[40:43], s13 offen offset:0 sc1
  buffer_load_dwordx4 v[52:55], v2, s[40:43], s13 offen offset:1024 sc1
  buffer_load_dwordx4 v[56:59], v2, s[40:43], s13 offen offset:2048 sc1
  buffer_load_dwordx4 v[60:63], v2, s[40:43], s13 offen offset:3072 sc1
  s_add_u32 s13, s13, 4096
  s_getpc_b64 s[36:37]
  s_setpc_b64 s[38:39]
  buffer_load_dwordx4 v[96:99], v2, s[40:43], s13 offen offset:0 sc1
  buffer_load_dwordx4 v[100:103], v2, s[40:43], s13 offen offset:1024 sc1
  buffer_load_dwordx4 v[104:107], v2, s[40:43], s13 offen offset:2048 sc1
  buffer_load_dwordx4 v[108:111], v2, s[40:43], s13 offen offset:3072 sc1
  s_add_u32 s13, s13, 4096
  buffer_load_dwordx4 v[112:115], v2, s[40:43], s13 offen offset:0 sc1
  buffer_load_dwordx4 v[116:119], v2, s[40:43], s13 offen offset:1024 sc1
  buffer_load_dwordx4 v[120:123], v2, s[40:43], s13 offen offset:2048 sc1
  buffer_load_dwordx4 v[124:127], v2, s[40:43], s13 offen offset:3072 sc1
  s_add_u32 s13, s13, 4096
  buffer_load_dwordx4 v[160:163], v2, s[40:43], s13 offen offset:0 sc1
  buffer_load_dwordx4 v[164:167], v2, s[40:43], s13 offen offset:1024 sc1
  s_getpc_b64 s[36:37]
  s_setpc_b64 s[38:39]
  buffer_load_dwordx4 v[168:171], v2, s[40:43], s13 offen offset:2048 sc1
  buffer_load_dwordx4 v[172:175], v2, s[40:43], s13 offen offset:3072 sc1
  s_add_u32 s13, s13, 4096
  buffer_load_dwordx4 v[192:195], v2, s[40:43], s13 offen offset:0 sc1
  buffer_load_dwordx4 v[196:199], v2, s[40:43], s13 offen offset:1024 sc1
  buffer_load_dwordx4 v[208:211], v2, s[40:43], s13 offen offset:2048 sc1
  buffer_load_dwordx4 v[212:215], v2, s[40:43], s13 offen offset:3072 sc1
  s_add_u32 s13, s13, 4096
  buffer_load_dwordx4 v[232:235], v2, s[40:43], s13 offen offset:0 sc1
  buffer_load_dwordx4 v[236:239], v2, s[40:43], s13 offen offset:1024 sc1
  buffer_load_dwordx4 v[240:243], v2, s[40:43], s13 offen offset:2048 sc1
  buffer_load_dwordx4 v[244:247], v2, s[40:43], s13 offen offset:3072 sc1
  s_add_u32 s13, s13, 4096
  s_mov_b32 s12, 2
  s_mov_b32 s32, -1
  s_setpc_b64 s[38:39]
fa_hk2:
  s_getpc_b64 s[38:39]
fa_hp2:
  s_add_u32 s36, s36, 4
  s_addc_u32 s37, s37, 0
  s_sub_u32 s38, s38, fa_hp2-fa_hb2
  s_subb_u32 s39, s39, 0
  s_setpc_b64 s[36:37]
fa_hk3:
  s_getpc_b64 s[38:39]
fa_hp3:
  s_add_u32 s36, s36, 4
  s_addc_u32 s37, s37, 0
  s_sub_u32 s38, s38, fa_hp3-fa_hb3
  s_subb_u32 s39, s39, 0
  s_setpc_b64 s[36:37]
fa_hk4:
  s_getpc_b64 s[38:39]
fa_hp4:
  s_add_u32 s36, s36, 4
  s_addc_u32 s37, s37, 0
  s_sub_u32 s38, s38, fa_hp4-fa_hb4
  s_subb_u32 s39, s39, 0
  s_setpc_b64 s[36:37]
fa_sel4_spin:
  s_mov_b32 s83, 200000
fa_sel4_spin2:
  buffer_load_dword v15, v10, s[40:43], 0 offen sc1
  s_waitcnt vmcnt(0)
  v_cmp_eq_u32 vcc, 0, v15
  s_cbranch_vccz fa_sel4_ok
  s_sleep 8
  s_sub_u32 s83, s83, 1
  s_cmp_lg_u32 s83, 0
  s_cbranch_scc1 fa_sel4_spin2
  s_branch fa_sel4_ok
fa_yf_spin:
  s_mov_b32 s83, 200000
fa_yf_spin2:
  buffer_load_dword v14, v11, s[40:43], 0 offen sc1
  s_waitcnt vmcnt(0)
  v_cmp_eq_u32 vcc, 0, v14
  s_cbranch_vccz fa_yf_ok
  s_sleep 8
  s_sub_u32 s83, s83, 1
  s_cmp_lg_u32 s83, 0
  s_cbranch_scc1 fa_yf_spin2
  s_branch fa_yf_ok
fa_ystub0:
  s_call_b64 s[76:77], fa_ysub
  s_branch fa_yback0
fa_ystub1:
  s_call_b64 s[76:77], fa_ysub
  s_branch fa_yback1
fa_ysub:
  v_cmp_eq_u32 vcc, 0, v14
  s_cbranch_vccnz fa_yf_spin
fa_yf_ok:
  v_mul_u32_u24 v16, 3277, v1
  v_lshrrev_b32 v16, 16, v16
  v_mul_u32_u24 v17, 20, v16
  v_sub_u32 v17, v1, v17
  v_lshlrev_b32 v17, 4, v17
  v_mul_u32_u24 v18, 368640, v16
  v_add_u32 v18, v18, v17
  v_cmp_gt_u32 vcc, 3, v16
  v_mov_b32 v19, 1073741824
  s_mul_i32 s14, s23, 2560
  v_cndmask_b32 v18, v19, v18, vcc
  s_mul_i32 s15, s22, 320
  s_add_u32 s14, s14, s15
  s_add_u32 s14, s14, 2686976
  buffer_load_dwordx4 v[64:67], v18, s[40:43], s14 offen sc1
  s_add_u32 s14, s14, 20480
  buffer_load_dwordx4 v[68:71], v18, s[40:43], s14 offen sc1
  s_add_u32 s14, s14, 20480
  buffer_load_dwordx4 v[72:75], v18, s[40:43], s14 offen sc1
  s_add_u32 s14, s14, 20480
  buffer_load_dwordx4 v[76:79], v18, s[40:43], s14 offen sc1
  s_add_u32 s14, s14, 20480
  buffer_load_dwordx4 v[80:83], v18, s[40:43], s14 offen sc1
  s_add_u32 s14, s14, 20480
  buffer_load_dwordx4 v[84:87], v18, s[40:43], s14 offen sc1
  s_add_u32 s14, s14, 20480
  buffer_load_dwordx4 v[88:91], v18, s[40:43], s14 offen sc1
  s_add_u32 s14, s14, 20480
  buffer_load_dwordx4 v[92:95], v18, s[40:43], s14 offen sc1
  s_add_u32 s14, s14, 20480
  buffer_load_dwordx4 v[128:131], v18, s[40:43], s14 offen sc1
  s_add_u32 s14, s14, 20480
  buffer_load_dwordx4 v[132:135], v18, s[40:43], s14 offen sc1
  s_add_u32 s14, s14, 20480
  buffer_load_dwordx4 v[136:139], v18, s[40:43], s14 offen sc1
  s_add_u32 s14, s14, 20480
  buffer_load_dwordx4 v[140:143], v18, s[40:43], s14 offen sc1
  s_add_u32 s14, s14, 20480
  buffer_load_dwordx4 v[144:147], v18, s[40:43], s14 offen sc1
  s_add_u32 s14, s14, 20480
  buffer_load_dwordx4 v[148:151], v18, s[40:43], s14 offen sc1
  s_add_u32 s14, s14, 20480
  buffer_load_dwordx4 v[152:155], v18, s[40:43], s14 offen sc1
  s_add_u32 s14, s14, 20480
  buffer_load_dwordx4 v[156:159], v18, s[40:43], s14 offen sc1
  s_add_u32 s14, s14, 20480
  buffer_load_dwordx4 v[176:179], v18, s[40:43], s14 offen sc1
  s_add_u32 s14, s14, 20480
  buffer_load_dwordx4 v[180:183], v18, s[40:43], s14 offen sc1
  s_add_u32 s14, s14, 20480
  s_lshl_b32 s14, s20, 10
  s_add_u32 s14, s14, 135168
  v_add_u32 v19, s14, v2
  s_and_b32 s30, s30, 0xffff0000
  s_waitcnt vmcnt(0)
  v_add_f32 v64, v64, v68
  v_add_f32 v65, v65, v69
  v_add_f32 v66, v66, v70
  v_add_f32 v67, v67, v71
  v_add_f32 v64, v64, v72
  v_add_f32 v65, v65, v73
  v_add_f32 v66, v66, v74
  v_add_f32 v67, v67, v75
  v_add_f32 v64, v64, v76
  v_add_f32 v65, v65, v77
  v_add_f32 v66, v66, v78
  v_add_f32 v67, v67, v79
  v_add_f32 v64, v64, v80
  v_add_f32 v65, v65, v81
  v_add_f32 v66, v66, v82
  v_add_f32 v67, v67, v83
  v_add_f32 v64, v64, v84
  v_add_f32 v65, v65, v85
  v_add_f32 v66, v66, v86
  v_add_f32 v67, v67, v87
  v_add_f32 v64, v64, v88
  v_add_f32 v65, v65, v89
  v_add_f32 v66, v66, v90
  v_add_f32 v67, v67, v91
  v_add_f32 v64, v64, v92
  v_add_f32 v65, v65, v93
  v_add_f32 v66, v66, v94
  v_add_f32 v67, v67, v95
  v_add_f32 v64, v64, v128
  v_add_f32 v65, v65, v129
  v_add_f32 v66, v66, v130
  v_add_f32 v67, v67, v131
  v_add_f32 v64, v64, v132
  v_add_f32 v65, v65, v133
  v_add_f32 v66, v66, v134
  v_add_f32 v67, v67, v135
  v_add_f32 v64, v64, v136
  v_add_f32 v65, v65, v137
  v_add_f32 v66, v66, v138
  v_add_f32 v67, v67, v139
  v_add_f32 v64, v64, v140
  v_add_f32 v65, v65, v141
  v_add_f32 v66, v66, v142
  v_add_f32 v67, v67, v143
  v_add_f32 v64, v64, v144
  v_add_f32 v65, v65, v145
  v_add_f32 v66, v66, v146
  v_add_f32 v67, v67, v147
  v_add_f32 v64, v64, v148
  v_add_f32 v65, v65, v149
  v_add_f32 v66, v66, v150
  v_add_f32 v67, v67, v151
  v_add_f32 v64, v64, v152
  v_add_f32 v65, v65, v153
  v_add_f32 v66, v66, v154
  v_add_f32 v67, v67, v155
  v_add_f32 v64, v64, v156
  v_add_f32 v65, v65, v157
  v_add_f32 v66, v66, v158
  v_add_f32 v67, v67, v159
  v_add_f32 v64, v64, v176
  v_add_f32 v65, v65, v177
  v_add_f32 v66, v66, v178
  v_add_f32 v67, v67, v179
  v_add_f32 v64, v64, v180
  v_add_f32 v65, v65, v181
  v_add_f32 v66, v66, v182
  v_add_f32 v67, v67, v183
  ds_write_b128 v19, v[64:67]
  v_add_u32 v19, s14, v17
  s_waitcnt lgkmcnt(0)
  ds_read_b128 v[64:67], v19
  ds_read_b128 v[68:71], v19 offset:320
  ds_read_b128 v[72:75], v19 offset:640
  s_mul_i32 s14, s23, 320
  s_add_u32 s14, s14, 131072
  v_add_u32 v19, s14, v17
  s_waitcnt lgkmcnt(0)
  v_add_f32 v64, v64, v68
  v_add_f32 v64, v64, v72
  v_cvt_pk_bf16_f32 v64, v64, v64
  v_and_b32 v64, 0xffff0000, v64
  v_mul_f32 v64, s30, v64
  v_cvt_pk_bf16_f32 v64, v64, v64
  v_and_b32 v64, 0xffff0000, v64
  v_add_f32 v65, v65, v69
  v_add_f32 v65, v65, v73
  v_cvt_pk_bf16_f32 v65, v65, v65
  v_and_b32 v65, 0xffff0000, v65
  v_mul_f32 v65, s30, v65
  v_cvt_pk_bf16_f32 v65, v65, v65
  v_and_b32 v65, 0xffff0000, v65
  v_add_f32 v66, v66, v70
  v_add_f32 v66, v66, v74
  v_cvt_pk_bf16_f32 v66, v66, v66
  v_and_b32 v66, 0xffff0000, v66
  v_mul_f32 v66, s30, v66
  v_cvt_pk_bf16_f32 v66, v66, v66
  v_and_b32 v66, 0xffff0000, v66
  v_add_f32 v67, v67, v71
  v_add_f32 v67, v67, v75
  v_cvt_pk_bf16_f32 v67, v67, v67
  v_and_b32 v67, 0xffff0000, v67
  v_mul_f32 v67, s30, v67
  v_cvt_pk_bf16_f32 v67, v67, v67
  v_and_b32 v67, 0xffff0000, v67
  ds_write_b128 v19, v[64:67]
  s_waitcnt lgkmcnt(0)
  s_setpc_b64 s[76:77]
fa_ctx_spin:
  s_mov_b32 s83, 200000
fa_ctx_spin2:
  buffer_load_dword v13, v12, s[40:43], 0 offen sc1
  s_waitcnt vmcnt(0)
  v_cmp_eq_u32 vcc, 0, v13
  s_cbranch_vccz fa_ctx_ok
  s_sleep 8
  s_sub_u32 s83, s83, 1
  s_cmp_lg_u32 s83, 0
  s_cbranch_scc1 fa_ctx_spin2
  s_branch fa_ctx_ok
fa_stub0:
  s_call_b64 s[76:77], fa_rare00
  s_call_b64 s[76:77], fa_rare10
  s_branch fa_back0
fa_stub1:
  s_call_b64 s[76:77], fa_rare01
  s_call_b64 s[76:77], fa_rare11
  s_branch fa_back1
fa_stub2:
  s_call_b64 s[76:77], fa_rare00
  s_call_b64 s[76:77], fa_rare10
  s_branch fa_back2
fa_stub3:
  s_call_b64 s[76:77], fa_rare01
  s_call_b64 s[76:77], fa_rare11
  s_branch fa_back3
fa_stub4:
  s_call_b64 s[76:77], fa_rare00
  s_call_b64 s[76:77], fa_rare10
  s_branch fa_back4
fa_stub5:
  s_call_b64 s[76:77], fa_rare11
  s_branch fa_back5
fa_stub6:
  s_call_b64 s[76:77], fa_rare10
  s_branch fa_back6
fa_stub7:
  s_call_b64 s[76:77], fa_rare01
  s_call_b64 s[76:77], fa_rare11
  s_branch fa_back7
fa_stub8:
  s_call_b64 s[76:77], fa_rare10
  s_branch fa_back8
fa_stub9:
  s_call_b64 s[76:77], fa_rare11
  s_branch fa_back9
fa_stub10:
  s_call_b64 s[76:77], fa_rare10
  s_branch fa_back10
fa_stub11:
  s_call_b64 s[76:77], fa_rare11
  s_branch fa_back11
fa_stub12:
  s_call_b64 s[76:77], fa_rare10
  s_branch fa_back12
fa_stub13:
  s_call_b64 s[76:77], fa_rare11
  s_branch fa_back13
fa_codeend:
fa_rare00:
  s_nop 7
  v_max3_f32 v16, v96, v97, v98
  v_max3_f32 v16, v16, v99, v100
  v_max3_f32 v16, v16, v101, v102
  v_max3_f32 v16, v16, v103, 0
  v_mov_b32 v18, v16
  s_nop 1
  v_permlane16_swap_b32 v16, v18
  v_max_f32 v16, v16, v18
  v_mov_b32 v18, v16
  s_nop 1
  v_permlane32_swap_b32 v16, v18
  v_max_f32 v16, v16, v18
  v_sub_f32 v96, v96, v16
  v_sub_f32 v112, v112, v16
  v_sub_f32 v97, v97, v16
  v_sub_f32 v113, v113, v16
  v_sub_f32 v98, v98, v16
  v_sub_f32 v114, v114, v16
  v_sub_f32 v99, v99, v16
  v_sub_f32 v115, v115, v16
  v_sub_f32 v100, v100, v16
  v_sub_f32 v116, v116, v16
  v_sub_f32 v101, v101, v16
  v_sub_f32 v117, v117, v16
  v_sub_f32 v102, v102, v16
  v_sub_f32 v118, v118, v16
  v_sub_f32 v103, v103, v16
  v_sub_f32 v119, v119, v16
  v_max3_f32 v17, v104, v105, v106
  v_max3_f32 v17, v17, v107, v108
  v_max3_f32 v17, v17, v109, v110
  v_max3_f32 v17, v17, v111, 0
  v_mov_b32 v18, v17
  s_nop 1
  v_permlane16_swap_b32 v17, v18
  v_max_f32 v17, v17, v18
  v_mov_b32 v18, v17
  s_nop 1
  v_permlane32_swap_b32 v17, v18
  v_max_f32 v17, v17, v18
  v_sub_f32 v104, v104, v17
  v_sub_f32 v120, v120, v17
  v_sub_f32 v105, v105, v17
  v_sub_f32 v121, v121, v17
  v_sub_f32 v106, v106, v17
  v_sub_f32 v122, v122, v17
  v_sub_f32 v107, v107, v17
  v_sub_f32 v123, v123, v17
  v_sub_f32 v108, v108, v17
  v_sub_f32 v124, v124, v17
  v_sub_f32 v109, v109, v17
  v_sub_f32 v125, v125, v17
  v_sub_f32 v110, v110, v17
  v_sub_f32 v126, v126, v17
  v_sub_f32 v111, v111, v17
  v_sub_f32 v127, v127, v17
  s_call_b64 s[78:79], fa_resc0
  v_exp_f32 v208, v96
  v_exp_f32 v209, v97
  v_exp_f32 v210, v98
  v_add_f32 v224, v208, v209
  v_cvt_pk_bf16_f32 v160, v208, v209
  v_exp_f32 v211, v99
  v_add_f32 v224, v224, v210
  v_exp_f32 v212, v100
  v_add_f32 v224, v224, v211
  v_cvt_pk_bf16_f32 v161, v210, v211
  v_exp_f32 v213, v101
  v_add_f32 v224, v224, v212
  v_exp_f32 v214, v102
  v_add_f32 v224, v224, v213
  v_cvt_pk_bf16_f32 v162, v212, v213
  v_exp_f32 v215, v103
  v_add_f32 v224, v224, v214
  v_exp_f32 v208, v104
  v_add_f32 v224, v224, v215
  v_cvt_pk_bf16_f32 v163, v214, v215
  v_exp_f32 v209, v105
  v_exp_f32 v210, v106
  v_add_f32 v225, v208, v209
  v_cvt_pk_bf16_f32 v164, v208, v209
  v_exp_f32 v211, v107
  v_add_f32 v225, v225, v210
  v_exp_f32 v212, v108
  v_add_f32 v225, v225, v211
  v_cvt_pk_bf16_f32 v165, v210, v211
  v_exp_f32 v213, v109
  v_add_f32 v225, v225, v212
  v_exp_f32 v214, v110
  v_add_f32 v225, v225, v213
  v_cvt_pk_bf16_f32 v166, v212, v213
  v_exp_f32 v215, v111
  v_add_f32 v225, v225, v214
  s_nop 0
  v_add_f32 v225, v225, v215
  v_cvt_pk_bf16_f32 v167, v214, v215
  s_nop 1
  s_setpc_b64 s[76:77]
fa_rare01:
  s_nop 7
  v_max3_f32 v16, v112, v113, v114
  v_max3_f32 v16, v16, v115, v116
  v_max3_f32 v16, v16, v117, v118
  v_max3_f32 v16, v16, v119, 0
  v_mov_b32 v18, v16
  s_nop 1
  v_permlane16_swap_b32 v16, v18
  v_max_f32 v16, v16, v18
  v_mov_b32 v18, v16
  s_nop 1
  v_permlane32_swap_b32 v16, v18
  v_max_f32 v16, v16, v18
  v_sub_f32 v112, v112, v16
  v_sub_f32 v96, v96, v16
  v_sub_f32 v113, v113, v16
  v_sub_f32 v97, v97, v16
  v_sub_f32 v114, v114, v16
  v_sub_f32 v98, v98, v16
  v_sub_f32 v115, v115, v16
  v_sub_f32 v99, v99, v16
  v_sub_f32 v116, v116, v16
  v_sub_f32 v100, v100, v16
  v_sub_f32 v117, v117, v16
  v_sub_f32 v101, v101, v16
  v_sub_f32 v118, v118, v16
  v_sub_f32 v102, v102, v16
  v_sub_f32 v119, v119, v16
  v_sub_f32 v103, v103, v16
  v_max3_f32 v17, v120, v121, v122
  v_max3_f32 v17, v17, v123, v124
  v_max3_f32 v17, v17, v125, v126
  v_max3_f32 v17, v17, v127, 0
  v_mov_b32 v18, v17
  s_nop 1
  v_permlane16_swap_b32 v17, v18
  v_max_f32 v17, v17, v18
  v_mov_b32 v18, v17
  s_nop 1
  v_permlane32_swap_b32 v17, v18
  v_max_f32 v17, v17, v18
  v_sub_f32 v120, v120, v17
  v_sub_f32 v104, v104, v17
  v_sub_f32 v121, v121, v17
  v_sub_f32 v105, v105, v17
  v_sub_f32 v122, v122, v17
  v_sub_f32 v106, v106, v17
  v_sub_f32 v123, v123, v17
  v_sub_f32 v107, v107, v17
  v_sub_f32 v124, v124, v17
  v_sub_f32 v108, v108, v17
  v_sub_f32 v125, v125, v17
  v_sub_f32 v109, v109, v17
  v_sub_f32 v126, v126, v17
  v_sub_f32 v110, v110, v17
  v_sub_f32 v127, v127, v17
  v_sub_f32 v111, v111, v17
  s_call_b64 s[78:79], fa_resc0
  v_exp_f32 v208, v112
  v_exp_f32 v209, v113
  v_exp_f32 v210, v114
  v_add_f32 v224, v208, v209
  v_cvt_pk_bf16_f32 v168, v208, v209
  v_exp_f32 v211, v115
  v_add_f32 v224, v224, v210
  v_exp_f32 v212, v116
  v_add_f32 v224, v224, v211
  v_cvt_pk_bf16_f32 v169, v210, v211
  v_exp_f32 v213, v117
  v_add_f32 v224, v224, v212
  v_exp_f32 v214, v118
  v_add_f32 v224, v224, v213
  v_cvt_pk_bf16_f32 v170, v212, v213
  v_exp_f32 v215, v119
  v_add_f32 v224, v224, v214
  v_exp_f32 v208, v120
  v_add_f32 v224, v224, v215
  v_cvt_pk_bf16_f32 v171, v214, v215
  v_exp_f32 v209, v121
  v_exp_f32 v210, v122
  v_add_f32 v225, v208, v209
  v_cvt_pk_bf16_f32 v172, v208, v209
  v_exp_f32 v211, v123
  v_add_f32 v225, v225, v210
  v_exp_f32 v212, v124
  v_add_f32 v225, v225, v211
  v_cvt_pk_bf16_f32 v173, v210, v211
  v_exp_f32 v213, v125
  v_add_f32 v225, v225, v212
  v_exp_f32 v214, v126
  v_add_f32 v225, v225, v213
  v_cvt_pk_bf16_f32 v174, v212, v213
  v_exp_f32 v215, v127
  v_add_f32 v225, v225, v214
  s_nop 0
  v_add_f32 v225, v225, v215
  v_cvt_pk_bf16_f32 v175, v214, v215
  s_nop 1
  s_setpc_b64 s[76:77]
fa_resc0:
  v_sub_f32 v192, v192, v16
  v_sub_f32 v193, v193, v16
  v_sub_f32 v194, v194, v16
  v_sub_f32 v195, v195, v16
  v_exp_f32 v18, -v16
  v_sub_f32 v196, v196, v17
  v_sub_f32 v197, v197, v17
  v_sub_f32 v198, v198, v17
  v_sub_f32 v199, v199, v17
  v_exp_f32 v19, -v17
  s_nop 0
  v_mul_f32 v228, v228, v18
  v_mul_f32 v229, v229, v19
  v_accvgpr_read_b32 v20, a0
  v_accvgpr_read_b32 v21, a1
  v_accvgpr_read_b32 v22, a2
  v_accvgpr_read_b32 v23, a3
  v_mul_f32 v20, v20, v18
  v_mul_f32 v21, v21, v18
  v_mul_f32 v22, v22, v18
  v_mul_f32 v23, v23, v18
  v_accvgpr_write_b32 a0, v20
  v_accvgpr_write_b32 a1, v21
  v_accvgpr_write_b32 a2, v22
  v_accvgpr_write_b32 a3, v23
  v_accvgpr_read_b32 v20, a4
  v_accvgpr_read_b32 v21, a5
  v_accvgpr_read_b32 v22, a6
  v_accvgpr_read_b32 v23, a7
  v_mul_f32 v20, v20, v19
  v_mul_f32 v21, v21, v19
  v_mul_f32 v22, v22, v19
  v_mul_f32 v23, v23, v19
  v_accvgpr_write_b32 a4, v20
  v_accvgpr_write_b32 a5, v21
  v_accvgpr_write_b32 a6, v22
  v_accvgpr_write_b32 a7, v23
  v_accvgpr_read_b32 v20, a8
  v_accvgpr_read_b32 v21, a9
  v_accvgpr_read_b32 v22, a10
  v_accvgpr_read_b32 v23, a11
  v_mul_f32 v20, v20, v18
  v_mul_f32 v21, v21, v18
  v_mul_f32 v22, v22, v18
  v_mul_f32 v23, v23, v18
  v_accvgpr_write_b32 a8, v20
  v_accvgpr_write_b32 a9, v21
  v_accvgpr_write_b32 a10, v22
  v_accvgpr_write_b32 a11, v23
  v_accvgpr_read_b32 v20, a12
  v_accvgpr_read_b32 v21, a13
  v_accvgpr_read_b32 v22, a14
  v_accvgpr_read_b32 v23, a15
  v_mul_f32 v20, v20, v19
  v_mul_f32 v21, v21, v19
  v_mul_f32 v22, v22, v19
  v_mul_f32 v23, v23, v19
  v_accvgpr_write_b32 a12, v20
  v_accvgpr_write_b32 a13, v21
  v_accvgpr_write_b32 a14, v22
  v_accvgpr_write_b32 a15, v23
  v_accvgpr_read_b32 v20, a16
  v_accvgpr_read_b32 v21, a17
  v_accvgpr_read_b32 v22, a18
  v_accvgpr_read_b32 v23, a19
  v_mul_f32 v20, v20, v18
  v_mul_f32 v21, v21, v18
  v_mul_f32 v22, v22, v18
  v_mul_f32 v23, v23, v18
  v_accvgpr_write_b32 a16, v20
  v_accvgpr_write_b32 a17, v21
  v_accvgpr_write_b32 a18, v22
  v_accvgpr_write_b32 a19, v23
  v_accvgpr_read_b32 v20, a20
  v_accvgpr_read_b32 v21, a21
  v_accvgpr_read_b32 v22, a22
  v_accvgpr_read_b32 v23, a23
  v_mul_f32 v20, v20, v19
  v_mul_f32 v21, v21, v19
  v_mul_f32 v22, v22, v19
  v_mul_f32 v23, v23, v19
  v_accvgpr_write_b32 a20, v20
  v_accvgpr_write_b32 a21, v21
  v_accvgpr_write_b32 a22, v22
  v_accvgpr_write_b32 a23, v23
  v_accvgpr_read_b32 v20, a24
  v_accvgpr_read_b32 v21, a25
  v_accvgpr_read_b32 v22, a26
  v_accvgpr_read_b32 v23, a27
  v_mul_f32 v20, v20, v18
  v_mul_f32 v21, v21, v18
  v_mul_f32 v22, v22, v18
  v_mul_f32 v23, v23, v18
  v_accvgpr_write_b32 a24, v20
  v_accvgpr_write_b32 a25, v21
  v_accvgpr_write_b32 a26, v22
  v_accvgpr_write_b32 a27, v23
  v_accvgpr_read_b32 v20, a28
  v_accvgpr_read_b32 v21, a29
  v_accvgpr_read_b32 v22, a30
  v_accvgpr_read_b32 v23, a31
  v_mul_f32 v20, v20, v19
  v_mul_f32 v21, v21, v19
  v_mul_f32 v22, v22, v19
  v_mul_f32 v23, v23, v19
  v_accvgpr_write_b32 a28, v20
  v_accvgpr_write_b32 a29, v21
  v_accvgpr_write_b32 a30, v22
  v_accvgpr_write_b32 a31, v23
  v_accvgpr_read_b32 v20, a32
  v_accvgpr_read_b32 v21, a33
  v_accvgpr_read_b32 v22, a34
  v_accvgpr_read_b32 v23, a35
  v_mul_f32 v20, v20, v18
  v_mul_f32 v21, v21, v18
  v_mul_f32 v22, v22, v18
  v_mul_f32 v23, v23, v18
  v_accvgpr_write_b32 a32, v20
  v_accvgpr_write_b32 a33, v21
  v_accvgpr_write_b32 a34, v22
  v_accvgpr_write_b32 a35, v23
  v_accvgpr_read_b32 v20, a36
  v_accvgpr_read_b32 v21, a37
  v_accvgpr_read_b32 v22, a38
  v_accvgpr_read_b32 v23, a39
  v_mul_f32 v20, v20, v19
  v_mul_f32 v21, v21, v19
  v_mul_f32 v22, v22, v19
  v_mul_f32 v23, v23, v19
  v_accvgpr_write_b32 a36, v20
  v_accvgpr_write_b32 a37, v21
  v_accvgpr_write_b32 a38, v22
  v_accvgpr_write_b32 a39, v23
  v_accvgpr_read_b32 v20, a40
  v_accvgpr_read_b32 v21, a41
  v_accvgpr_read_b32 v22, a42
  v_accvgpr_read_b32 v23, a43
  v_mul_f32 v20, v20, v18
  v_mul_f32 v21, v21, v18
  v_mul_f32 v22, v22, v18
  v_mul_f32 v23, v23, v18
  v_accvgpr_write_b32 a40, v20
  v_accvgpr_write_b32 a41, v21
  v_accvgpr_write_b32 a42, v22
  v_accvgpr_write_b32 a43, v23
  v_accvgpr_read_b32 v20, a44
  v_accvgpr_read_b32 v21, a45
  v_accvgpr_read_b32 v22, a46
  v_accvgpr_read_b32 v23, a47
  v_mul_f32 v20, v20, v19
  v_mul_f32 v21, v21, v19
  v_mul_f32 v22, v22, v19
  v_mul_f32 v23, v23, v19
  v_accvgpr_write_b32 a44, v20
  v_accvgpr_write_b32 a45, v21
  v_accvgpr_write_b32 a46, v22
  v_accvgpr_write_b32 a47, v23
  v_accvgpr_read_b32 v20, a48
  v_accvgpr_read_b32 v21, a49
  v_accvgpr_read_b32 v22, a50
  v_accvgpr_read_b32 v23, a51
  v_mul_f32 v20, v20, v18
  v_mul_f32 v21, v21, v18
  v_mul_f32 v22, v22, v18
  v_mul_f32 v23, v23, v18
  v_accvgpr_write_b32 a48, v20
  v_accvgpr_write_b32 a49, v21
  v_accvgpr_write_b32 a50, v22
  v_accvgpr_write_b32 a51, v23
  v_accvgpr_read_b32 v20, a52
  v_accvgpr_read_b32 v21, a53
  v_accvgpr_read_b32 v22, a54
  v_accvgpr_read_b32 v23, a55
  v_mul_f32 v20, v20, v19
  v_mul_f32 v21, v21, v19
  v_mul_f32 v22, v22, v19
  v_mul_f32 v23, v23, v19
  v_accvgpr_write_b32 a52, v20
  v_accvgpr_write_b32 a53, v21
  v_accvgpr_write_b32 a54, v22
  v_accvgpr_write_b32 a55, v23
  v_accvgpr_read_b32 v20, a56
  v_accvgpr_read_b32 v21, a57
  v_accvgpr_read_b32 v22, a58
  v_accvgpr_read_b32 v23, a59
  v_mul_f32 v20, v20, v18
  v_mul_f32 v21, v21, v18
  v_mul_f32 v22, v22, v18
  v_mul_f32 v23, v23, v18
  v_accvgpr_write_b32 a56, v20
  v_accvgpr_write_b32 a57, v21
  v_accvgpr_write_b32 a58, v22
  v_accvgpr_write_b32 a59, v23
  v_accvgpr_read_b32 v20, a60
  v_accvgpr_read_b32 v21, a61
  v_accvgpr_read_b32 v22, a62
  v_accvgpr_read_b32 v23, a63
  v_mul_f32 v20, v20, v19
  v_mul_f32 v21, v21, v19
  v_mul_f32 v22, v22, v19
  v_mul_f32 v23, v23, v19
  v_accvgpr_write_b32 a60, v20
  v_accvgpr_write_b32 a61, v21
  v_accvgpr_write_b32 a62, v22
  v_accvgpr_write_b32 a63, v23
  s_setpc_b64 s[78:79]
fa_rare10:
  s_nop 7
  v_max3_f32 v16, v128, v129, v130
  v_max3_f32 v16, v16, v131, v132
  v_max3_f32 v16, v16, v133, v134
  v_max3_f32 v16, v16, v135, 0
  v_mov_b32 v18, v16
  s_nop 1
  v_permlane16_swap_b32 v16, v18
  v_max_f32 v16, v16, v18
  v_mov_b32 v18, v16
  s_nop 1
  v_permlane32_swap_b32 v16, v18
  v_max_f32 v16, v16, v18
  v_sub_f32 v128, v128, v16
  v_sub_f32 v144, v144, v16
  v_sub_f32 v129, v129, v16
  v_sub_f32 v145, v145, v16
  v_sub_f32 v130, v130, v16
  v_sub_f32 v146, v146, v16
  v_sub_f32 v131, v131, v16
  v_sub_f32 v147, v147, v16
  v_sub_f32 v132, v132, v16
  v_sub_f32 v148, v148, v16
  v_sub_f32 v133, v133, v16
  v_sub_f32 v149, v149, v16
  v_sub_f32 v134, v134, v16
  v_sub_f32 v150, v150, v16
  v_sub_f32 v135, v135, v16
  v_sub_f32 v151, v151, v16
  v_max3_f32 v17, v136, v137, v138
  v_max3_f32 v17, v17, v139, v140
  v_max3_f32 v17, v17, v141, v142
  v_max3_f32 v17, v17, v143, 0
  v_mov_b32 v18, v17
  s_nop 1
  v_permlane16_swap_b32 v17, v18
  v_max_f32 v17, v17, v18
  v_mov_b32 v18, v17
  s_nop 1
  v_permlane32_swap_b32 v17, v18
  v_max_f32 v17, v17, v18
  v_sub_f32 v136, v136, v17
  v_sub_f32 v152, v152, v17
  v_sub_f32 v137, v137, v17
  v_sub_f32 v153, v153, v17
  v_sub_f32 v138, v138, v17
  v_sub_f32 v154, v154, v17
  v_sub_f32 v139, v139, v17
  v_sub_f32 v155, v155, v17
  v_sub_f32 v140, v140, v17
  v_sub_f32 v156, v156, v17
  v_sub_f32 v141, v141, v17
  v_sub_f32 v157, v157, v17
  v_sub_f32 v142, v142, v17
  v_sub_f32 v158, v158, v17
  v_sub_f32 v143, v143, v17
  v_sub_f32 v159, v159, v17
  s_call_b64 s[78:79], fa_resc1
  v_exp_f32 v216, v128
  v_exp_f32 v217, v129
  v_exp_f32 v218, v130
  v_add_f32 v226, v216, v217
  v_cvt_pk_bf16_f32 v176, v216, v217
  v_exp_f32 v219, v131
  v_add_f32 v226, v226, v218
  v_exp_f32 v220, v132
  v_add_f32 v226, v226, v219
  v_cvt_pk_bf16_f32 v177, v218, v219
  v_exp_f32 v221, v133
  v_add_f32 v226, v226, v220
  v_exp_f32 v222, v134
  v_add_f32 v226, v226, v221
  v_cvt_pk_bf16_f32 v178, v220, v221
  v_exp_f32 v223, v135
  v_add_f32 v226, v226, v222
  v_exp_f32 v216, v136
  v_add_f32 v226, v226, v223
  v_cvt_pk_bf16_f32 v179, v222, v223
  v_exp_f32 v217, v137
  v_exp_f32 v218, v138
  v_add_f32 v227, v216, v217
  v_cvt_pk_bf16_f32 v180, v216, v217
  v_exp_f32 v219, v139
  v_add_f32 v227, v227, v218
  v_exp_f32 v220, v140
  v_add_f32 v227, v227, v219
  v_cvt_pk_bf16_f32 v181, v218, v219
  v_exp_f32 v221, v141
  v_add_f32 v227, v227, v220
  v_exp_f32 v222, v142
  v_add_f32 v227, v227, v221
  v_cvt_pk_bf16_f32 v182, v220, v221
  v_exp_f32 v223, v143
  v_add_f32 v227, v227, v222
  s_nop 0
  v_add_f32 v227, v227, v223
  v_cvt_pk_bf16_f32 v183, v222, v223
  s_nop 1
  s_setpc_b64 s[76:77]
fa_rare11:
  s_nop 7
  v_max3_f32 v16, v144, v145, v146
  v_max3_f32 v16, v16, v147, v148
  v_max3_f32 v16, v16, v149, v150
  v_max3_f32 v16, v16, v151, 0
  v_mov_b32 v18, v16
  s_nop 1
  v_permlane16_swap_b32 v16, v18
  v_max_f32 v16, v16, v18
  v_mov_b32 v18, v16
  s_nop 1
  v_permlane32_swap_b32 v16, v18
  v_max_f32 v16, v16, v18
  v_sub_f32 v144, v144, v16
  v_sub_f32 v128, v128, v16
  v_sub_f32 v145, v145, v16
  v_sub_f32 v129, v129, v16
  v_sub_f32 v146, v146, v16
  v_sub_f32 v130, v130, v16
  v_sub_f32 v147, v147, v16
  v_sub_f32 v131, v131, v16
  v_sub_f32 v148, v148, v16
  v_sub_f32 v132, v132, v16
  v_sub_f32 v149, v149, v16
  v_sub_f32 v133, v133, v16
  v_sub_f32 v150, v150, v16
  v_sub_f32 v134, v134, v16
  v_sub_f32 v151, v151, v16
  v_sub_f32 v135, v135, v16
  v_max3_f32 v17, v152, v153, v154
  v_max3_f32 v17, v17, v155, v156
  v_max3_f32 v17, v17, v157, v158
  v_max3_f32 v17, v17, v159, 0
  v_mov_b32 v18, v17
  s_nop 1
  v_permlane16_swap_b32 v17, v18
  v_max_f32 v17, v17, v18
  v_mov_b32 v18, v17
  s_nop 1
  v_permlane32_swap_b32 v17, v18
  v_max_f32 v17, v17, v18
  v_sub_f32 v152, v152, v17
  v_sub_f32 v136, v136, v17
  v_sub_f32 v153, v153, v17
  v_sub_f32 v137, v137, v17
  v_sub_f32 v154, v154, v17
  v_sub_f32 v138, v138, v17
  v_sub_f32 v155, v155, v17
  v_sub_f32 v139, v139, v17
  v_sub_f32 v156, v156, v17
  v_sub_f32 v140, v140, v17
  v_sub_f32 v157, v157, v17
  v_sub_f32 v141, v141, v17
  v_sub_f32 v158, v158, v17
  v_sub_f32 v142, v142, v17
  v_sub_f32 v159, v159, v17
  v_sub_f32 v143, v143, v17
  s_call_b64 s[78:79], fa_resc1
  v_exp_f32 v216, v144
  v_exp_f32 v217, v145
  v_exp_f32 v218, v146
  v_add_f32 v226, v216, v217
  v_cvt_pk_bf16_f32 v184, v216, v217
  v_exp_f32 v219, v147
  v_add_f32 v226, v226, v218
  v_exp_f32 v220, v148
  v_add_f32 v226, v226, v219
  v_cvt_pk_bf16_f32 v185, v218, v219
  v_exp_f32 v221, v149
  v_add_f32 v226, v226, v220
  v_exp_f32 v222, v150
  v_add_f32 v226, v226, v221
  v_cvt_pk_bf16_f32 v186, v220, v221
  v_exp_f32 v223, v151
  v_add_f32 v226, v226, v222
  v_exp_f32 v216, v152
  v_add_f32 v226, v226, v223
  v_cvt_pk_bf16_f32 v187, v222, v223
  v_exp_f32 v217, v153
  v_exp_f32 v218, v154
  v_add_f32 v227, v216, v217
  v_cvt_pk_bf16_f32 v188, v216, v217
  v_exp_f32 v219, v155
  v_add_f32 v227, v227, v218
  v_exp_f32 v220, v156
  v_add_f32 v227, v227, v219
  v_cvt_pk_bf16_f32 v189, v218, v219
  v_exp_f32 v221, v157
  v_add_f32 v227, v227, v220
  v_exp_f32 v222, v158
  v_add_f32 v227, v227, v221
  v_cvt_pk_bf16_f32 v190, v220, v221
  v_exp_f32 v223, v159
  v_add_f32 v227, v227, v222
  s_nop 0
  v_add_f32 v227, v227, v223
  v_cvt_pk_bf16_f32 v191, v222, v223
  s_nop 1
  s_setpc_b64 s[76:77]
fa_resc1:
  v_sub_f32 v200, v200, v16
  v_sub_f32 v201, v201, v16
  v_sub_f32 v202, v202, v16
  v_sub_f32 v203, v203, v16
  v_exp_f32 v18, -v16
  v_sub_f32 v204, v204, v17
  v_sub_f32 v205, v205, v17
  v_sub_f32 v206, v206, v17
  v_sub_f32 v207, v207, v17
  v_exp_f32 v19, -v17
  s_nop 0
  v_mul_f32 v230, v230, v18
  v_mul_f32 v231, v231, v19
  v_accvgpr_read_b32 v20, a64
  v_accvgpr_read_b32 v21, a65
  v_accvgpr_read_b32 v22, a66
  v_accvgpr_read_b32 v23, a67
  v_mul_f32 v20, v20, v18
  v_mul_f32 v21, v21, v18
  v_mul_f32 v22, v22, v18
  v_mul_f32 v23, v23, v18
  v_accvgpr_write_b32 a64, v20
  v_accvgpr_write_b32 a65, v21
  v_accvgpr_write_b32 a66, v22
  v_accvgpr_write_b32 a67, v23
  v_accvgpr_read_b32 v20, a68
  v_accvgpr_read_b32 v21, a69
  v_accvgpr_read_b32 v22, a70
  v_accvgpr_read_b32 v23, a71
  v_mul_f32 v20, v20, v19
  v_mul_f32 v21, v21, v19
  v_mul_f32 v22, v22, v19
  v_mul_f32 v23, v23, v19
  v_accvgpr_write_b32 a68, v20
  v_accvgpr_write_b32 a69, v21
  v_accvgpr_write_b32 a70, v22
  v_accvgpr_write_b32 a71, v23
  v_accvgpr_read_b32 v20, a72
  v_accvgpr_read_b32 v21, a73
  v_accvgpr_read_b32 v22, a74
  v_accvgpr_read_b32 v23, a75
  v_mul_f32 v20, v20, v18
  v_mul_f32 v21, v21, v18
  v_mul_f32 v22, v22, v18
  v_mul_f32 v23, v23, v18
  v_accvgpr_write_b32 a72, v20
  v_accvgpr_write_b32 a73, v21
  v_accvgpr_write_b32 a74, v22
  v_accvgpr_write_b32 a75, v23
  v_accvgpr_read_b32 v20, a76
  v_accvgpr_read_b32 v21, a77
  v_accvgpr_read_b32 v22, a78
  v_accvgpr_read_b32 v23, a79
  v_mul_f32 v20, v20, v19
  v_mul_f32 v21, v21, v19
  v_mul_f32 v22, v22, v19
  v_mul_f32 v23, v23, v19
  v_accvgpr_write_b32 a76, v20
  v_accvgpr_write_b32 a77, v21
  v_accvgpr_write_b32 a78, v22
  v_accvgpr_write_b32 a79, v23
  v_accvgpr_read_b32 v20, a80
  v_accvgpr_read_b32 v21, a81
  v_accvgpr_read_b32 v22, a82
  v_accvgpr_read_b32 v23, a83
  v_mul_f32 v20, v20, v18
  v_mul_f32 v21, v21, v18
  v_mul_f32 v22, v22, v18
  v_mul_f32 v23, v23, v18
  v_accvgpr_write_b32 a80, v20
  v_accvgpr_write_b32 a81, v21
  v_accvgpr_write_b32 a82, v22
  v_accvgpr_write_b32 a83, v23
  v_accvgpr_read_b32 v20, a84
  v_accvgpr_read_b32 v21, a85
  v_accvgpr_read_b32 v22, a86
  v_accvgpr_read_b32 v23, a87
  v_mul_f32 v20, v20, v19
  v_mul_f32 v21, v21, v19
  v_mul_f32 v22, v22, v19
  v_mul_f32 v23, v23, v19
  v_accvgpr_write_b32 a84, v20
  v_accvgpr_write_b32 a85, v21
  v_accvgpr_write_b32 a86, v22
  v_accvgpr_write_b32 a87, v23
  v_accvgpr_read_b32 v20, a88
  v_accvgpr_read_b32 v21, a89
  v_accvgpr_read_b32 v22, a90
  v_accvgpr_read_b32 v23, a91
  v_mul_f32 v20, v20, v18
  v_mul_f32 v21, v21, v18
  v_mul_f32 v22, v22, v18
  v_mul_f32 v23, v23, v18
  v_accvgpr_write_b32 a88, v20
  v_accvgpr_write_b32 a89, v21
  v_accvgpr_write_b32 a90, v22
  v_accvgpr_write_b32 a91, v23
  v_accvgpr_read_b32 v20, a92
  v_accvgpr_read_b32 v21, a93
  v_accvgpr_read_b32 v22, a94
  v_accvgpr_read_b32 v23, a95
  v_mul_f32 v20, v20, v19
  v_mul_f32 v21, v21, v19
  v_mul_f32 v22, v22, v19
  v_mul_f32 v23, v23, v19
  v_accvgpr_write_b32 a92, v20
  v_accvgpr_write_b32 a93, v21
  v_accvgpr_write_b32 a94, v22
  v_accvgpr_write_b32 a95, v23
  v_accvgpr_read_b32 v20, a96
  v_accvgpr_read_b32 v21, a97
  v_accvgpr_read_b32 v22, a98
  v_accvgpr_read_b32 v23, a99
  v_mul_f32 v20, v20, v18
  v_mul_f32 v21, v21, v18
  v_mul_f32 v22, v22, v18
  v_mul_f32 v23, v23, v18
  v_accvgpr_write_b32 a96, v20
  v_accvgpr_write_b32 a97, v21
  v_accvgpr_write_b32 a98, v22
  v_accvgpr_write_b32 a99, v23
  v_accvgpr_read_b32 v20, a100
  v_accvgpr_read_b32 v21, a101
  v_accvgpr_read_b32 v22, a102
  v_accvgpr_read_b32 v23, a103
  v_mul_f32 v20, v20, v19
  v_mul_f32 v21, v21, v19
  v_mul_f32 v22, v22, v19
  v_mul_f32 v23, v23, v19
  v_accvgpr_write_b32 a100, v20
  v_accvgpr_write_b32 a101, v21
  v_accvgpr_write_b32 a102, v22
  v_accvgpr_write_b32 a103, v23
  v_accvgpr_read_b32 v20, a104
  v_accvgpr_read_b32 v21, a105
  v_accvgpr_read_b32 v22, a106
  v_accvgpr_read_b32 v23, a107
  v_mul_f32 v20, v20, v18
  v_mul_f32 v21, v21, v18
  v_mul_f32 v22, v22, v18
  v_mul_f32 v23, v23, v18
  v_accvgpr_write_b32 a104, v20
  v_accvgpr_write_b32 a105, v21
  v_accvgpr_write_b32 a106, v22
  v_accvgpr_write_b32 a107, v23
  v_accvgpr_read_b32 v20, a108
  v_accvgpr_read_b32 v21, a109
  v_accvgpr_read_b32 v22, a110
  v_accvgpr_read_b32 v23, a111
  v_mul_f32 v20, v20, v19
  v_mul_f32 v21, v21, v19
  v_mul_f32 v22, v22, v19
  v_mul_f32 v23, v23, v19
  v_accvgpr_write_b32 a108, v20
  v_accvgpr_write_b32 a109, v21
  v_accvgpr_write_b32 a110, v22
  v_accvgpr_write_b32 a111, v23
  v_accvgpr_read_b32 v20, a112
  v_accvgpr_read_b32 v21, a113
  v_accvgpr_read_b32 v22, a114
  v_accvgpr_read_b32 v23, a115
  v_mul_f32 v20, v20, v18
  v_mul_f32 v21, v21, v18
  v_mul_f32 v22, v22, v18
  v_mul_f32 v23, v23, v18
  v_accvgpr_write_b32 a112, v20
  v_accvgpr_write_b32 a113, v21
  v_accvgpr_write_b32 a114, v22
  v_accvgpr_write_b32 a115, v23
  v_accvgpr_read_b32 v20, a116
  v_accvgpr_read_b32 v21, a117
  v_accvgpr_read_b32 v22, a118
  v_accvgpr_read_b32 v23, a119
  v_mul_f32 v20, v20, v19
  v_mul_f32 v21, v21, v19
  v_mul_f32 v22, v22, v19
  v_mul_f32 v23, v23, v19
  v_accvgpr_write_b32 a116, v20
  v_accvgpr_write_b32 a117, v21
  v_accvgpr_write_b32 a118, v22
  v_accvgpr_write_b32 a119, v23
  v_accvgpr_read_b32 v20, a120
  v_accvgpr_read_b32 v21, a121
  v_accvgpr_read_b32 v22, a122
  v_accvgpr_read_b32 v23, a123
  v_mul_f32 v20, v20, v18
  v_mul_f32 v21, v21, v18
  v_mul_f32 v22, v22, v18
  v_mul_f32 v23, v23, v18
  v_accvgpr_write_b32 a120, v20
  v_accvgpr_write_b32 a121, v21
  v_accvgpr_write_b32 a122, v22
  v_accvgpr_write_b32 a123, v23
  v_accvgpr_read_b32 v20, a124
  v_accvgpr_read_b32 v21, a125
  v_accvgpr_read_b32 v22, a126
  v_accvgpr_read_b32 v23, a127
  v_mul_f32 v20, v20, v19
  v_mul_f32 v21, v21, v19
  v_mul_f32 v22, v22, v19
  v_mul_f32 v23, v23, v19
  v_accvgpr_write_b32 a124, v20
  v_accvgpr_write_b32 a125, v21
  v_accvgpr_write_b32 a126, v22
  v_accvgpr_write_b32 a127, v23
  s_setpc_b64 s[78:79]
.section .rodata,"a"
.p2align 6
.amdhsa_kernel fa_kernel
  .amdhsa_next_free_vgpr 512
  .amdhsa_next_free_sgpr 102
  .amdhsa_accum_offset 256
  .amdhsa_group_segment_fixed_size 0
  .amdhsa_kernarg_size 112
  .amdhsa_user_sgpr_count 2
  .amdhsa_user_sgpr_kernarg_segment_ptr 1
  .amdhsa_system_sgpr_workgroup_id_x 1
  .amdhsa_float_denorm_mode_32 3
.end_amdhsa_kernel
.text
```

```asm
; @launch kernel=fa_kernel grid=(256,1,1) block=(256,1,1) lds=163840
.amdgcn_target "amdgcn-amd-amdhsa--gfx950"
.text
.globl fa_kernel
.p2align 8
.type fa_kernel,@function
fa_kernel:
  s_cmp_ge_u32 s2, 256
  s_cbranch_scc1 fa_end
  s_load_dwordx4 s[4:7], s[0:1], 0
  s_load_dwordx2 s[14:15], s[0:1], 56
  s_load_dwordx4 s[8:11], s[0:1], 24
  s_load_dwordx2 s[12:13], s[0:1], 40
  s_load_dwordx4 s[16:19], s[0:1], 96
  s_load_dwordx2 s[60:61], s[0:1], 16
  v_lshrrev_b32 v16, 6, v0
  v_and_b32 v1, 63, v0
  v_readfirstlane_b32 s20, v16
  s_and_b32 s21, s2, 7
  s_lshl_b32 s21, s21, 2
  s_lshr_b32 s23, s2, 3
  s_and_b32 s23, s23, 3
  s_add_u32 s21, s21, s23
  s_lshr_b32 s22, s2, 5
  v_and_b32 v208, 31, v1
  v_lshrrev_b32 v209, 5, v1
  s_lshl_b32 s23, s2, 2
  s_add_u32 s23, s23, s20
  s_lshl_b32 s23, s23, 1
  v_add_u32 v209, s23, v209
  v_lshlrev_b32 v212, 4, v208
  v_mul_u32_u24 v210, 1280, v209
  v_add_u32 v210, v210, v212
  v_cmp_gt_u32 s[64:65], 16, v208
  v_mov_b32 v211, 1073741824
  v_lshlrev_b32 v2, 4, v1
  v_cndmask_b32 v211, v211, v210, s[64:65]
  v_lshrrev_b32 v16, 2, v1
  v_lshrrev_b32 v17, 5, v1
  v_mul_u32_u24 v17, 3, v17
  v_and_b32 v18, 3, v1
  v_xor_b32 v17, v17, v18
  v_lshlrev_b32 v17, 4, v17
  v_lshl_add_u32 v3, v16, 10, v17
  s_lshl_b32 s23, s20, 16
  v_add_u32 v3, s23, v3
  v_add_u32 v4, 15360, v3
  v_add_u32 v5, 30720, v3
  v_add_u32 v6, 46080, v3
  v_and_b32 v16, 3, v16
  v_lshrrev_b32 v17, 4, v1
  v_lshlrev_b32 v17, 6, v17
  v_lshl_add_u32 v16, v16, 13, v17
  s_and_b32 s23, s20, 1
  s_lshl_b32 s23, s23, 17
  v_add_u32 v16, s23, v16
  v_lshl_add_u32 v8, v18, 4, v16
  v_xor_b32 v18, 2, v18
  v_lshl_add_u32 v10, v18, 4, v16
  v_add_u32 v9, 31744, v8
  v_add_u32 v11, 95232, v10
  v_add_u32 v10, 63488, v10
  s_lshl_b32 s24, s20, 12
  s_mov_b32 s26, 0
  s_mov_b32 s27, 0
  s_mov_b32 s25, 262144
  s_mov_b32 s79, 64
  v_bfe_u32 v17, v1, 1, 3
  v_lshlrev_b32 v17, 13, v17
  v_and_b32 v18, 1, v1
  v_lshl_add_u32 v235, v18, 7, v17
  s_lshl_b32 s74, s22, 1
  s_and_b32 s31, s20, 1
  s_add_u32 s74, s74, s31
  s_lshl_b32 s74, s74, 16
  s_mov_b32 s73, 1048576
  s_and_b32 s29, s2, 31
  s_lshl_b32 s29, s29, 2
  s_add_u32 s29, s29, s20
  s_lshl_b32 s29, s29, 11
  v_and_b32 v16, 15, v1
  v_lshlrev_b32 v234, 7, v16
  v_lshlrev_b32 v17, 10, v16
  v_and_b32 v18, 16, v1
  v_lshl_add_u32 v233, v18, 3, v17
  s_and_b32 s30, s21, 3
  s_lshl_b32 s30, s30, 2
  s_add_u32 s30, s30, s20
  s_lshl_b32 s30, s30, 14
  s_waitcnt lgkmcnt(0)
  s_mov_b32 s44, s4
  s_mov_b32 s45, s5
  s_mov_b32 s46, 2621440
  s_mov_b32 s47, 0x20000
  s_mov_b32 s48, s14
  s_mov_b32 s49, s15
  s_mov_b32 s50, 1280
  s_mov_b32 s51, 0x20000
  buffer_load_dwordx4 v[160:163], v210, s[44:47], 0 offen
  buffer_load_dwordx4 v[164:167], v210, s[44:47], 0 offen offset:512
  buffer_load_dwordx4 v[168:171], v211, s[44:47], 0 offen offset:1024
  buffer_load_dwordx4 v[172:175], v212, s[48:51], 0 offen offset:0
  buffer_load_dwordx4 v[176:179], v212, s[48:51], 0 offen offset:512
  buffer_load_dwordx4 v[180:183], v212, s[48:51], 0 offen offset:1024
  s_lshl_b32 s23, s22, 18
  s_add_u32 s62, s6, s23
  s_addc_u32 s63, s7, 0
  s_mov_b32 s32, s62
  s_mov_b32 s33, s63
  s_mov_b32 s34, 262144
  s_mov_b32 s35, 0x20000
  s_cmp_ge_u32 s20, 2
  s_cselect_b32 s62, s10, s8
  s_cselect_b32 s63, s11, s9
  s_lshl_b32 s23, s21, 8
  s_add_u32 s62, s62, s23
  s_addc_u32 s63, s63, 0
  s_mov_b32 s36, s62
  s_mov_b32 s37, s63
  s_mov_b32 s38, 0
  s_mov_b32 s39, 0x20000
  s_sub_u32 s38, 4194304, s23
  buffer_load_dword v231, v235, s[36:39], s74 offen
  buffer_load_dword v232, v233, s[32:35], s30 offen
  s_add_u32 s74, s74, s73
  s_add_u32 s60, s60, s23
  s_addc_u32 s61, s61, 0
  s_sub_u32 s75, 5242880, s23
  s_mov_b32 s48, s62
  s_mov_b32 s49, s63
  s_mov_b32 s50, s38
  s_mov_b32 s51, 0x20000
  s_mov_b32 s40, s18
  s_mov_b32 s41, s19
  s_mov_b32 s42, 67108864
  s_mov_b32 s43, 0x20000
  s_mov_b32 s52, s12
  s_mov_b32 s53, s13
  s_mov_b32 s54, 5242880
  s_mov_b32 s55, 0x20000
  s_mov_b32 s56, s16
  s_mov_b32 s57, s17
  s_mov_b32 s58, 256
  s_mov_b32 s59, 0x20000
  s_lshl_b32 s23, s20, 5
  s_add_u32 s23, s23, s21
  s_lshl_b32 s23, s23, 2
  s_add_u32 s23, s23, 2641920
  s_lshl_b32 s31, s22, 9
  s_add_u32 s80, s23, s31
  s_sub_u32 s31, 7680, s31
  s_add_u32 s3, s23, s31
  s_lshl_b32 s23, s21, 7
  s_lshl_b32 s31, s22, 2
  s_add_u32 s23, s23, s31
  s_add_u32 s82, s23, 2637824
  s_and_b32 s69, s2, 63
  s_lshl_b32 s31, s20, 6
  s_add_u32 s69, s69, s31
  s_lshl_b32 s69, s69, 2
  s_add_u32 s69, s69, 2650112
  s_cmp_ge_u32 s2, 192
  s_cselect_b32 s69, s69, 1073741824
  s_cmp_eq_u32 s20, 0
  s_cselect_b32 s31, s82, 1073741824
  s_cmp_eq_u32 s2, 255
  s_cselect_b32 s23, 2629632, 1073741824
  v_lshl_add_u32 v19, v16, 2, s23
  v_mov_b32 v229, 0
  v_writelane_b32 v19, s80, 0
  v_writelane_b32 v19, s3, 1
  v_writelane_b32 v19, s31, 2
  s_and_b32 s23, s2, 1
  s_lshl_b32 s23, s23, 2
  s_add_u32 s23, s23, s20
  s_lshl_b32 s23, s23, 7
  s_lshr_b32 s31, s2, 1
  s_add_u32 s23, s23, s31
  s_lshl_b32 s23, s23, 2
  s_add_u32 s23, s23, 2654208
  v_writelane_b32 v19, s23, 3
  v_writelane_b32 v19, s69, 4
  buffer_store_dword v229, v19, s[40:43], 0 offen sc1
  s_and_b32 s71, s21, 3
  s_max_u32 s71, s71, 1
  s_lshl_b32 s72, 1, s71
  s_or_b32 s72, s72, 0x68
  s_cmp_eq_u32 s20, 0
  s_cselect_b32 s70, s2, 1073741824
  v_mov_b32 v20, 0
  v_mov_b32 v21, 0
  v_mov_b32 v22, 0
  v_mov_b32 v23, 0
  v_and_b32 v16, 15, v1
  v_lshrrev_b32 v17, 4, v1
  v_lshrrev_b32 v18, 3, v16
  v_mul_u32_u24 v18, 3, v18
  v_xor_b32 v18, v18, v17
  v_lshlrev_b32 v18, 4, v18
  v_lshl_add_u32 v14, v16, 6, v18
  s_and_b32 s23, s20, 1
  s_lshl_b32 s23, s23, 13
  v_add_u32 v14, s23, v14
  v_mfma_f32_32x32x16_bf16 a[0:15], v[20:23], v[20:23], 0
  v_mfma_f32_32x32x16_bf16 a[16:31], v[20:23], v[20:23], 0
  v_mfma_f32_32x32x16_bf16 a[32:47], v[20:23], v[20:23], 0
  v_mfma_f32_32x32x16_bf16 a[48:63], v[20:23], v[20:23], 0
  v_mfma_f32_32x32x16_bf16 a[64:79], v[20:23], v[20:23], 0
  v_mfma_f32_32x32x16_bf16 a[80:95], v[20:23], v[20:23], 0
  v_mfma_f32_32x32x16_bf16 a[96:111], v[20:23], v[20:23], 0
  v_mfma_f32_32x32x16_bf16 a[112:127], v[20:23], v[20:23], 0
  v_mfma_f32_32x32x16_bf16 a[128:143], v[20:23], v[20:23], 0
  v_mfma_f32_32x32x16_bf16 a[144:159], v[20:23], v[20:23], 0
  v_mfma_f32_32x32x16_bf16 a[160:175], v[20:23], v[20:23], 0
  v_mfma_f32_32x32x16_bf16 a[176:191], v[20:23], v[20:23], 0
  v_mfma_f32_32x32x16_bf16 a[192:207], v[20:23], v[20:23], 0
  v_mfma_f32_32x32x16_bf16 a[208:223], v[20:23], v[20:23], 0
  v_mfma_f32_32x32x16_bf16 a[224:239], v[20:23], v[20:23], 0
  v_mfma_f32_32x32x16_bf16 a[240:255], v[20:23], v[20:23], 0
  v_lshrrev_b32 v18, 2, v16
  v_lshlrev_b32 v18, 6, v18
  v_lshl_add_u32 v18, v17, 11, v18
  v_and_b32 v19, 1, v1
  v_lshl_add_u32 v18, v19, 3, v18
  v_bfe_u32 v19, v1, 1, 1
  v_and_b32 v17, 1, v17
  v_lshl_or_b32 v19, v17, 1, v19
  s_lshr_b32 s23, s20, 1
  s_lshl_b32 s23, s23, 13
  s_add_u32 s23, s23, 16384
  v_add_u32 v18, s23, v18
  v_lshl_add_u32 v12, v19, 4, v18
  v_xor_b32 v13, 32, v12
  s_waitcnt vmcnt(3)
  s_mov_b32 m0, s24
  s_nop 0
  buffer_load_dwordx4 v3, s[32:35], s26 offen offset:0 sc1 lds
  buffer_load_dwordx4 v4, s[32:35], s26 offen offset:1024 sc1 lds
  buffer_load_dwordx4 v5, s[32:35], s26 offen offset:2048 sc1 lds
  buffer_load_dwordx4 v6, s[32:35], s26 offen offset:3072 sc1 lds
  s_add_u32 m0, s24, 16384
  s_nop 0
  buffer_load_dwordx4 v8, s[36:39], s27 offen offset:0 lds
  buffer_load_dwordx4 v9, s[36:39], s27 offen offset:1024 lds
  buffer_load_dwordx4 v10, s[36:39], s27 offen offset:2048 lds
  buffer_load_dwordx4 v11, s[36:39], s27 offen offset:3072 lds
  s_add_u32 s26, s26, s79
  s_add_u32 s27, s27, s25
  s_add_u32 s24, s24, 32768
  s_and_b32 s24, s24, 0x1ffff
  v_lshlrev_b32 v184, 16, v160
  v_and_b32 v185, 0xffff0000, v160
  v_lshlrev_b32 v186, 16, v161
  v_and_b32 v187, 0xffff0000, v161
  v_lshlrev_b32 v188, 16, v162
  v_and_b32 v189, 0xffff0000, v162
  v_lshlrev_b32 v190, 16, v163
  v_and_b32 v191, 0xffff0000, v163
  v_lshlrev_b32 v192, 16, v164
  v_and_b32 v193, 0xffff0000, v164
  v_lshlrev_b32 v194, 16, v165
  v_and_b32 v195, 0xffff0000, v165
  v_lshlrev_b32 v196, 16, v166
  v_and_b32 v197, 0xffff0000, v166
  v_lshlrev_b32 v198, 16, v167
  v_and_b32 v199, 0xffff0000, v167
  v_lshlrev_b32 v200, 16, v168
  v_and_b32 v201, 0xffff0000, v168
  v_lshlrev_b32 v202, 16, v169
  v_and_b32 v203, 0xffff0000, v169
  v_lshlrev_b32 v204, 16, v170
  v_and_b32 v205, 0xffff0000, v170
  v_lshlrev_b32 v206, 16, v171
  v_and_b32 v207, 0xffff0000, v171
  v_add_f32 v213, v184, v185
  v_add_f32 v214, v186, v187
  v_add_f32 v213, v213, v188
  v_add_f32 v214, v214, v189
  v_add_f32 v213, v213, v190
  v_add_f32 v214, v214, v191
  v_add_f32 v213, v213, v192
  v_add_f32 v214, v214, v193
  v_add_f32 v213, v213, v194
  v_add_f32 v214, v214, v195
  v_add_f32 v213, v213, v196
  v_add_f32 v214, v214, v197
  v_add_f32 v213, v213, v198
  v_add_f32 v214, v214, v199
  v_add_f32 v213, v213, v200
  v_add_f32 v214, v214, v201
  v_add_f32 v213, v213, v202
  v_add_f32 v214, v214, v203
  v_add_f32 v213, v213, v204
  v_add_f32 v214, v214, v205
  v_add_f32 v213, v213, v206
  v_add_f32 v214, v214, v207
  v_add_f32 v213, v213, v214
  s_nop 1
  v_add_f32_dpp v213, v213, v213 quad_perm:[1,0,3,2] row_mask:0xf bank_mask:0xf
  s_nop 1
  v_add_f32_dpp v213, v213, v213 quad_perm:[2,3,0,1] row_mask:0xf bank_mask:0xf
  s_nop 1
  v_add_f32_dpp v213, v213, v213 row_half_mirror row_mask:0xf bank_mask:0xf
  s_nop 1
  v_add_f32_dpp v213, v213, v213 row_mirror row_mask:0xf bank_mask:0xf
  v_mov_b32 v214, v213
  s_nop 1
  v_permlane16_swap_b32 v213, v214
  v_add_f32 v213, v213, v214
  v_mul_f32 v215, 0x3acccccd, v213
  v_mov_b32 v218, 0
  v_mov_b32 v213, 0
  v_sub_f32 v16, v184, v215
  v_fmac_f32 v218, v16, v16
  v_sub_f32 v17, v185, v215
  v_fmac_f32 v218, v17, v17
  v_sub_f32 v18, v186, v215
  v_fmac_f32 v218, v18, v18
  v_sub_f32 v19, v187, v215
  v_fmac_f32 v218, v19, v19
  v_sub_f32 v16, v188, v215
  v_fmac_f32 v218, v16, v16
  v_sub_f32 v17, v189, v215
  v_fmac_f32 v218, v17, v17
  v_sub_f32 v18, v190, v215
  v_fmac_f32 v218, v18, v18
  v_sub_f32 v19, v191, v215
  v_fmac_f32 v218, v19, v19
  v_sub_f32 v16, v192, v215
  v_fmac_f32 v218, v16, v16
  v_sub_f32 v17, v193, v215
  v_fmac_f32 v218, v17, v17
  v_sub_f32 v18, v194, v215
  v_fmac_f32 v218, v18, v18
  v_sub_f32 v19, v195, v215
  v_fmac_f32 v218, v19, v19
  v_sub_f32 v16, v196, v215
  v_fmac_f32 v218, v16, v16
  v_sub_f32 v17, v197, v215
  v_fmac_f32 v218, v17, v17
  v_sub_f32 v18, v198, v215
  v_fmac_f32 v218, v18, v18
  v_sub_f32 v19, v199, v215
  v_fmac_f32 v218, v19, v19
  v_sub_f32 v16, v200, v215
  v_fmac_f32 v213, v16, v16
  v_sub_f32 v17, v201, v215
  v_fmac_f32 v213, v17, v17
  v_sub_f32 v18, v202, v215
  v_fmac_f32 v213, v18, v18
  v_sub_f32 v19, v203, v215
  v_fmac_f32 v213, v19, v19
  v_sub_f32 v16, v204, v215
  v_fmac_f32 v213, v16, v16
  v_sub_f32 v17, v205, v215
  v_fmac_f32 v213, v17, v17
  v_sub_f32 v18, v206, v215
  v_fmac_f32 v213, v18, v18
  v_sub_f32 v19, v207, v215
  v_fmac_f32 v213, v19, v19
  v_cndmask_b32 v213, 0, v213, s[64:65]
  v_add_f32 v213, v213, v218
  s_nop 1
  v_add_f32_dpp v213, v213, v213 quad_perm:[1,0,3,2] row_mask:0xf bank_mask:0xf
  s_nop 1
  v_add_f32_dpp v213, v213, v213 quad_perm:[2,3,0,1] row_mask:0xf bank_mask:0xf
  s_nop 1
  v_add_f32_dpp v213, v213, v213 row_half_mirror row_mask:0xf bank_mask:0xf
  s_nop 1
  v_add_f32_dpp v213, v213, v213 row_mirror row_mask:0xf bank_mask:0xf
  v_mov_b32 v214, v213
  s_nop 1
  v_permlane16_swap_b32 v213, v214
  v_add_f32 v213, v213, v214
  v_mul_f32 v213, 0x3acccccd, v213
  v_cvt_pk_bf16_f32 v213, v213, v213
  v_and_b32 v213, 0xffff0000, v213
  v_add_f32 v213, 0x3727c5ac, v213
  v_cvt_pk_bf16_f32 v213, v213, v213
  v_and_b32 v213, 0xffff0000, v213
  v_sqrt_f32 v213, v213
  v_mov_b32 v216, v215
  v_cvt_pk_bf16_f32 v213, v213, v213
  v_and_b32 v213, 0xffff0000, v213
  v_rcp_f32 v217, v213
  v_cvt_pk_bf16_f32 v216, v216, v216
  v_and_b32 v216, 0xffff0000, v216
  s_mov_b32 m0, s24
  s_nop 0
  buffer_load_dwordx4 v3, s[32:35], s26 offen offset:0 sc1 lds
  buffer_load_dwordx4 v4, s[32:35], s26 offen offset:1024 sc1 lds
  buffer_load_dwordx4 v5, s[32:35], s26 offen offset:2048 sc1 lds
  buffer_load_dwordx4 v6, s[32:35], s26 offen offset:3072 sc1 lds
  s_add_u32 m0, s24, 16384
  s_nop 0
  buffer_load_dwordx4 v8, s[36:39], s27 offen offset:0 lds
  buffer_load_dwordx4 v9, s[36:39], s27 offen offset:1024 lds
  buffer_load_dwordx4 v10, s[36:39], s27 offen offset:2048 lds
  buffer_load_dwordx4 v11, s[36:39], s27 offen offset:3072 lds
  s_add_u32 s26, s26, s79
  s_add_u32 s27, s27, s25
  s_add_u32 s24, s24, 32768
  s_and_b32 s24, s24, 0x1ffff
  v_mov_b32 v218, 0
  v_sub_f32 v184, v184, v216
  v_sub_f32 v185, v185, v216
  v_cvt_pk_bf16_f32 v16, v184, v185
  v_lshlrev_b32 v184, 16, v16
  v_and_b32 v185, 0xffff0000, v16
  v_mul_f32 v184, v184, v217
  v_mul_f32 v185, v185, v217
  v_cvt_pk_bf16_f32 v160, v184, v185
  v_lshlrev_b32 v184, 16, v160
  v_and_b32 v185, 0xffff0000, v160
  v_lshlrev_b32 v17, 16, v172
  v_and_b32 v18, 0xffff0000, v172
  v_fmac_f32 v218, v184, v17
  v_fmac_f32 v218, v185, v18
  v_sub_f32 v186, v186, v216
  v_sub_f32 v187, v187, v216
  v_cvt_pk_bf16_f32 v16, v186, v187
  v_lshlrev_b32 v186, 16, v16
  v_and_b32 v187, 0xffff0000, v16
  v_mul_f32 v186, v186, v217
  v_mul_f32 v187, v187, v217
  v_cvt_pk_bf16_f32 v161, v186, v187
  v_lshlrev_b32 v186, 16, v161
  v_and_b32 v187, 0xffff0000, v161
  v_lshlrev_b32 v17, 16, v173
  v_and_b32 v18, 0xffff0000, v173
  v_fmac_f32 v218, v186, v17
  v_fmac_f32 v218, v187, v18
  v_sub_f32 v188, v188, v216
  v_sub_f32 v189, v189, v216
  v_cvt_pk_bf16_f32 v16, v188, v189
  v_lshlrev_b32 v188, 16, v16
  v_and_b32 v189, 0xffff0000, v16
  v_mul_f32 v188, v188, v217
  v_mul_f32 v189, v189, v217
  v_cvt_pk_bf16_f32 v162, v188, v189
  v_lshlrev_b32 v188, 16, v162
  v_and_b32 v189, 0xffff0000, v162
  v_lshlrev_b32 v17, 16, v174
  v_and_b32 v18, 0xffff0000, v174
  v_fmac_f32 v218, v188, v17
  v_fmac_f32 v218, v189, v18
  v_sub_f32 v190, v190, v216
  v_sub_f32 v191, v191, v216
  v_cvt_pk_bf16_f32 v16, v190, v191
  v_lshlrev_b32 v190, 16, v16
  v_and_b32 v191, 0xffff0000, v16
  v_mul_f32 v190, v190, v217
  v_mul_f32 v191, v191, v217
  v_cvt_pk_bf16_f32 v163, v190, v191
  v_lshlrev_b32 v190, 16, v163
  v_and_b32 v191, 0xffff0000, v163
  v_lshlrev_b32 v17, 16, v175
  v_and_b32 v18, 0xffff0000, v175
  v_fmac_f32 v218, v190, v17
  v_fmac_f32 v218, v191, v18
  v_sub_f32 v192, v192, v216
  v_sub_f32 v193, v193, v216
  v_cvt_pk_bf16_f32 v16, v192, v193
  v_lshlrev_b32 v192, 16, v16
  v_and_b32 v193, 0xffff0000, v16
  v_mul_f32 v192, v192, v217
  v_mul_f32 v193, v193, v217
  v_cvt_pk_bf16_f32 v164, v192, v193
  v_lshlrev_b32 v192, 16, v164
  v_and_b32 v193, 0xffff0000, v164
  v_lshlrev_b32 v17, 16, v176
  v_and_b32 v18, 0xffff0000, v176
  v_fmac_f32 v218, v192, v17
  v_fmac_f32 v218, v193, v18
  v_sub_f32 v194, v194, v216
  v_sub_f32 v195, v195, v216
  v_cvt_pk_bf16_f32 v16, v194, v195
  v_lshlrev_b32 v194, 16, v16
  v_and_b32 v195, 0xffff0000, v16
  v_mul_f32 v194, v194, v217
  v_mul_f32 v195, v195, v217
  v_cvt_pk_bf16_f32 v165, v194, v195
  v_lshlrev_b32 v194, 16, v165
  v_and_b32 v195, 0xffff0000, v165
  v_lshlrev_b32 v17, 16, v177
  v_and_b32 v18, 0xffff0000, v177
  v_fmac_f32 v218, v194, v17
  v_fmac_f32 v218, v195, v18
  v_sub_f32 v196, v196, v216
  v_sub_f32 v197, v197, v216
  v_cvt_pk_bf16_f32 v16, v196, v197
  v_lshlrev_b32 v196, 16, v16
  v_and_b32 v197, 0xffff0000, v16
  v_mul_f32 v196, v196, v217
  v_mul_f32 v197, v197, v217
  v_cvt_pk_bf16_f32 v166, v196, v197
  v_lshlrev_b32 v196, 16, v166
  v_and_b32 v197, 0xffff0000, v166
  v_lshlrev_b32 v17, 16, v178
  v_and_b32 v18, 0xffff0000, v178
  v_fmac_f32 v218, v196, v17
  v_fmac_f32 v218, v197, v18
  v_sub_f32 v198, v198, v216
  v_sub_f32 v199, v199, v216
  v_cvt_pk_bf16_f32 v16, v198, v199
  v_lshlrev_b32 v198, 16, v16
  v_and_b32 v199, 0xffff0000, v16
  v_mul_f32 v198, v198, v217
  v_mul_f32 v199, v199, v217
  v_cvt_pk_bf16_f32 v167, v198, v199
  v_lshlrev_b32 v198, 16, v167
  v_and_b32 v199, 0xffff0000, v167
  v_lshlrev_b32 v17, 16, v179
  v_and_b32 v18, 0xffff0000, v179
  v_fmac_f32 v218, v198, v17
  v_fmac_f32 v218, v199, v18
  v_sub_f32 v200, v200, v216
  v_sub_f32 v201, v201, v216
  v_cvt_pk_bf16_f32 v16, v200, v201
  v_lshlrev_b32 v200, 16, v16
  v_and_b32 v201, 0xffff0000, v16
  v_mul_f32 v200, v200, v217
  v_mul_f32 v201, v201, v217
  v_cvt_pk_bf16_f32 v168, v200, v201
  v_lshlrev_b32 v200, 16, v168
  v_and_b32 v201, 0xffff0000, v168
  v_lshlrev_b32 v17, 16, v180
  v_and_b32 v18, 0xffff0000, v180
  v_fmac_f32 v218, v200, v17
  v_fmac_f32 v218, v201, v18
  v_sub_f32 v202, v202, v216
  v_sub_f32 v203, v203, v216
  v_cvt_pk_bf16_f32 v16, v202, v203
  v_lshlrev_b32 v202, 16, v16
  v_and_b32 v203, 0xffff0000, v16
  v_mul_f32 v202, v202, v217
  v_mul_f32 v203, v203, v217
  v_cvt_pk_bf16_f32 v169, v202, v203
  v_lshlrev_b32 v202, 16, v169
  v_and_b32 v203, 0xffff0000, v169
  v_lshlrev_b32 v17, 16, v181
  v_and_b32 v18, 0xffff0000, v181
  v_fmac_f32 v218, v202, v17
  v_fmac_f32 v218, v203, v18
  v_sub_f32 v204, v204, v216
  v_sub_f32 v205, v205, v216
  v_cvt_pk_bf16_f32 v16, v204, v205
  v_lshlrev_b32 v204, 16, v16
  v_and_b32 v205, 0xffff0000, v16
  v_mul_f32 v204, v204, v217
  v_mul_f32 v205, v205, v217
  v_cvt_pk_bf16_f32 v170, v204, v205
  v_lshlrev_b32 v204, 16, v170
  v_and_b32 v205, 0xffff0000, v170
  v_lshlrev_b32 v17, 16, v182
  v_and_b32 v18, 0xffff0000, v182
  v_fmac_f32 v218, v204, v17
  v_fmac_f32 v218, v205, v18
  v_sub_f32 v206, v206, v216
  v_sub_f32 v207, v207, v216
  v_cvt_pk_bf16_f32 v16, v206, v207
  v_lshlrev_b32 v206, 16, v16
  v_and_b32 v207, 0xffff0000, v16
  v_mul_f32 v206, v206, v217
  v_mul_f32 v207, v207, v217
  v_cvt_pk_bf16_f32 v171, v206, v207
  v_lshlrev_b32 v206, 16, v171
  v_and_b32 v207, 0xffff0000, v171
  v_lshlrev_b32 v17, 16, v183
  v_and_b32 v18, 0xffff0000, v183
  v_fmac_f32 v218, v206, v17
  v_fmac_f32 v218, v207, v18
  s_mov_b32 m0, s24
  s_nop 0
  buffer_load_dwordx4 v3, s[32:35], s26 offen offset:0 sc1 lds
  buffer_load_dwordx4 v4, s[32:35], s26 offen offset:1024 sc1 lds
  buffer_load_dwordx4 v5, s[32:35], s26 offen offset:2048 sc1 lds
  buffer_load_dwordx4 v6, s[32:35], s26 offen offset:3072 sc1 lds
  s_add_u32 m0, s24, 16384
  s_nop 0
  buffer_load_dwordx4 v8, s[36:39], s27 offen offset:0 lds
  buffer_load_dwordx4 v9, s[36:39], s27 offen offset:1024 lds
  buffer_load_dwordx4 v10, s[36:39], s27 offen offset:2048 lds
  buffer_load_dwordx4 v11, s[36:39], s27 offen offset:3072 lds
  s_add_u32 s26, s26, s79
  s_add_u32 s27, s27, s25
  s_add_u32 s24, s24, 32768
  s_and_b32 s24, s24, 0x1ffff
  v_and_b32 v16, 7, v209
  v_lshlrev_b32 v16, 4, v16
  v_lshl_add_u32 v16, v208, 7, v16
  v_add_u32 v16, 131072, v16
  ds_write_b128 v16, v[160:163] offset:0
  ds_write_b128 v16, v[164:167] offset:4096
  ds_write_b128 v16, v[168:171] offset:8192
  s_nop 1
  v_add_f32_dpp v218, v218, v218 quad_perm:[1,0,3,2] row_mask:0xf bank_mask:0xf
  s_nop 1
  v_add_f32_dpp v218, v218, v218 quad_perm:[2,3,0,1] row_mask:0xf bank_mask:0xf
  s_nop 1
  v_add_f32_dpp v218, v218, v218 row_half_mirror row_mask:0xf bank_mask:0xf
  s_nop 1
  v_add_f32_dpp v218, v218, v218 row_mirror row_mask:0xf bank_mask:0xf
  v_mov_b32 v214, v218
  s_nop 1
  v_permlane16_swap_b32 v218, v214
  v_add_f32 v218, v218, v214
  v_cvt_pk_bf16_f32 v218, v218, v218
  v_and_b32 v218, 0xffff0000, v218
  v_ashrrev_i32 v214, 31, v218
  v_or_b32 v214, 0x80000000, v214
  v_xor_b32 v218, v218, v214
  v_and_b32 v218, 0xffff0000, v218
  v_sub_u32 v214, 0xffff, v209
  v_or_b32 v218, v218, v214
  v_lshlrev_b32 v214, 2, v209
  v_add_u32 v214, 2621440, v214
  v_mov_b32 v19, 1073741824
  v_cmp_eq_u32 vcc, 0, v208
  v_lshlrev_b32 v16, 4, v0
  v_add_u32 v16, 131072, v16
  v_cndmask_b32 v214, v19, v214, vcc
  v_lshrrev_b32 v17, 3, v0
  v_and_b32 v18, 7, v0
  v_lshlrev_b32 v18, 4, v18
  v_lshl_add_u32 v17, v17, 8, v18
  v_cmp_gt_u32 vcc, 128, v0
  s_lshr_b32 s23, s2, 1
  s_mul_i32 s23, s23, 20480
  s_and_b32 s31, s2, 1
  s_lshl_b32 s31, s31, 7
  s_add_u32 s23, s23, s31
  v_cndmask_b32 v18, v19, v17, vcc
  s_mov_b32 s66, s23
  s_add_u32 s67, s23, 8192
  s_add_u32 s68, s23, 16384
  s_mov_b32 m0, s24
  s_nop 0
  buffer_load_dwordx4 v3, s[32:35], s26 offen offset:0 sc1 lds
  buffer_load_dwordx4 v4, s[32:35], s26 offen offset:1024 sc1 lds
  buffer_load_dwordx4 v5, s[32:35], s26 offen offset:2048 sc1 lds
  buffer_load_dwordx4 v6, s[32:35], s26 offen offset:3072 sc1 lds
  s_add_u32 m0, s24, 16384
  s_nop 0
  buffer_load_dwordx4 v8, s[36:39], s27 offen offset:0 lds
  buffer_load_dwordx4 v9, s[36:39], s27 offen offset:1024 lds
  buffer_load_dwordx4 v10, s[36:39], s27 offen offset:2048 lds
  buffer_load_dwordx4 v11, s[36:39], s27 offen offset:3072 lds
  s_add_u32 s26, s26, s79
  s_add_u32 s27, s27, s25
  s_add_u32 s24, s24, 32768
  s_and_b32 s24, s24, 0x1ffff
  s_waitcnt vmcnt(24) lgkmcnt(0)
  s_barrier
  ds_read_b128 v[160:163], v16 offset:0
  ds_read_b128 v[164:167], v16 offset:4096
  ds_read_b128 v[168:171], v16 offset:8192
  buffer_load_dword v231, v235, s[36:39], s74 offen
  buffer_load_dword v232, v234, s[32:35], s29 offen
  s_getpc_b64 s[62:63]
fa_pc:
  s_lshr_b32 s23, s2, 3
  s_and_b32 s23, s23, 7
  s_lshl_b32 s23, s23, 2
  s_add_u32 s23, s23, s20
  s_lshl_b32 s23, s23, 11
  s_min_u32 s23, s23, fa_codeend-fa_pc-2048
  v_add_u32 v234, s23, v234
  global_load_dword v231, v234, s[62:63]
  buffer_store_dword v218, v214, s[40:43], 0 offen sc1
  s_mov_b32 s28, 0
  s_waitcnt lgkmcnt(0)
  buffer_store_dwordx4 v[160:163], v17, s[40:43], s66 offen sc1
  buffer_store_dwordx4 v[164:167], v17, s[40:43], s67 offen sc1
  buffer_store_dwordx4 v[168:171], v18, s[40:43], s68 offen sc1
  s_cmp_ge_u32 s20, 2
  s_cbranch_scc1 fa_roleV
  ds_read_b128 v[96:99], v14 offset:0
  ds_read_b128 v[100:103], v14 offset:1024
  ds_read_b128 v[104:107], v14 offset:2048
  ds_read_b128 v[108:111], v14 offset:3072
  ds_read_b128 v[112:115], v14 offset:4096
  ds_read_b128 v[116:119], v14 offset:5120
  ds_read_b128 v[120:123], v14 offset:6144
  ds_read_b128 v[124:127], v14 offset:7168
  ds_read_b64_tr_b16 v[32:33], v12 offset:0
  ds_read_b64_tr_b16 v[34:35], v12 offset:1024
  ds_read_b64_tr_b16 v[36:37], v13 offset:0
  ds_read_b64_tr_b16 v[38:39], v13 offset:1024
  ds_read_b64_tr_b16 v[40:41], v12 offset:256
  ds_read_b64_tr_b16 v[42:43], v12 offset:1280
  ds_read_b64_tr_b16 v[44:45], v13 offset:256
  ds_read_b64_tr_b16 v[46:47], v13 offset:1280
  ds_read_b64_tr_b16 v[48:49], v12 offset:512
  ds_read_b64_tr_b16 v[50:51], v12 offset:1536
  ds_read_b64_tr_b16 v[52:53], v13 offset:512
  ds_read_b64_tr_b16 v[54:55], v13 offset:1536
  ds_read_b64_tr_b16 v[56:57], v12 offset:768
  ds_read_b64_tr_b16 v[58:59], v12 offset:1792
  ds_read_b64_tr_b16 v[60:61], v13 offset:768
  ds_read_b64_tr_b16 v[62:63], v13 offset:1792
  s_waitcnt lgkmcnt(0)
.p2align 6
fa_loopK:
  v_mfma_f32_16x16x32_bf16 a[0:3], v[32:35], v[96:99], a[0:3]
  s_waitcnt vmcnt(17)
  v_mfma_f32_16x16x32_bf16 a[4:7], v[32:35], v[100:103], a[4:7]
  s_barrier
  v_mfma_f32_16x16x32_bf16 a[8:11], v[32:35], v[104:107], a[8:11]
  s_bitcmp1_b32 s72, s28
  ds_read_b64_tr_b16 v[64:65], v12 offset:32768
  v_mfma_f32_16x16x32_bf16 a[12:15], v[32:35], v[108:111], a[12:15]
  s_cbranch_scc1 fa_p1stubK
fa_p1backK:
  v_mfma_f32_16x16x32_bf16 a[16:19], v[32:35], v[112:115], a[16:19]
  s_mov_b32 m0, s24
  ds_read_b64_tr_b16 v[66:67], v12 offset:33792
  v_mfma_f32_16x16x32_bf16 a[20:23], v[32:35], v[116:119], a[20:23]
  buffer_load_dwordx4 v3, s[32:35], s26 offen offset:0 sc1 lds
  v_mfma_f32_16x16x32_bf16 a[24:27], v[32:35], v[120:123], a[24:27]
  ds_read_b128 v[128:131], v14 offset:32768
  v_mfma_f32_16x16x32_bf16 a[28:31], v[32:35], v[124:127], a[28:31]
  buffer_load_dwordx4 v4, s[32:35], s26 offen offset:1024 sc1 lds
  v_mfma_f32_16x16x32_bf16 a[32:35], v[36:39], v[96:99], a[32:35]
  ds_read_b64_tr_b16 v[68:69], v13 offset:32768
  v_mfma_f32_16x16x32_bf16 a[36:39], v[36:39], v[100:103], a[36:39]
  buffer_load_dwordx4 v5, s[32:35], s26 offen offset:2048 sc1 lds
  v_mfma_f32_16x16x32_bf16 a[40:43], v[36:39], v[104:107], a[40:43]
  ds_read_b64_tr_b16 v[70:71], v13 offset:33792
  v_mfma_f32_16x16x32_bf16 a[44:47], v[36:39], v[108:111], a[44:47]
  buffer_load_dwordx4 v6, s[32:35], s26 offen offset:3072 sc1 lds
  v_mfma_f32_16x16x32_bf16 a[48:51], v[36:39], v[112:115], a[48:51]
  s_add_u32 m0, s24, 16384
  ds_read_b128 v[132:135], v14 offset:33792
  v_mfma_f32_16x16x32_bf16 a[52:55], v[36:39], v[116:119], a[52:55]
  buffer_load_dwordx4 v8, s[36:39], s27 offen offset:0 lds
  v_mfma_f32_16x16x32_bf16 a[56:59], v[36:39], v[120:123], a[56:59]
  ds_read_b64_tr_b16 v[72:73], v12 offset:33024
  v_mfma_f32_16x16x32_bf16 a[60:63], v[36:39], v[124:127], a[60:63]
  buffer_load_dwordx4 v9, s[36:39], s27 offen offset:1024 lds
  v_mfma_f32_16x16x32_bf16 a[64:67], v[40:43], v[96:99], a[64:67]
  ds_read_b64_tr_b16 v[74:75], v12 offset:34048
  v_mfma_f32_16x16x32_bf16 a[68:71], v[40:43], v[100:103], a[68:71]
  buffer_load_dwordx4 v10, s[36:39], s27 offen offset:2048 lds
  v_mfma_f32_16x16x32_bf16 a[72:75], v[40:43], v[104:107], a[72:75]
  ds_read_b128 v[136:139], v14 offset:34816
  v_mfma_f32_16x16x32_bf16 a[76:79], v[40:43], v[108:111], a[76:79]
  buffer_load_dwordx4 v11, s[36:39], s27 offen offset:3072 lds
  v_mfma_f32_16x16x32_bf16 a[80:83], v[40:43], v[112:115], a[80:83]
  ds_read_b64_tr_b16 v[76:77], v13 offset:33024
  v_mfma_f32_16x16x32_bf16 a[84:87], v[40:43], v[116:119], a[84:87]
  buffer_load_dword v231, v235, s[48:51], s74 offen
  v_mfma_f32_16x16x32_bf16 a[88:91], v[40:43], v[120:123], a[88:91]
  s_add_u32 s74, s74, s73
  ds_read_b64_tr_b16 v[78:79], v13 offset:34048
  v_mfma_f32_16x16x32_bf16 a[92:95], v[40:43], v[124:127], a[92:95]
  v_mfma_f32_16x16x32_bf16 a[96:99], v[44:47], v[96:99], a[96:99]
  ds_read_b128 v[140:143], v14 offset:35840
  v_mfma_f32_16x16x32_bf16 a[100:103], v[44:47], v[100:103], a[100:103]
  v_mfma_f32_16x16x32_bf16 a[104:107], v[44:47], v[104:107], a[104:107]
  ds_read_b64_tr_b16 v[80:81], v12 offset:33280
  v_mfma_f32_16x16x32_bf16 a[108:111], v[44:47], v[108:111], a[108:111]
  v_mfma_f32_16x16x32_bf16 a[112:115], v[44:47], v[112:115], a[112:115]
  ds_read_b64_tr_b16 v[82:83], v12 offset:34304
  v_mfma_f32_16x16x32_bf16 a[116:119], v[44:47], v[116:119], a[116:119]
  v_mfma_f32_16x16x32_bf16 a[120:123], v[44:47], v[120:123], a[120:123]
  ds_read_b128 v[144:147], v14 offset:36864
  v_mfma_f32_16x16x32_bf16 a[124:127], v[44:47], v[124:127], a[124:127]
  v_mfma_f32_16x16x32_bf16 a[128:131], v[48:51], v[96:99], a[128:131]
  ds_read_b64_tr_b16 v[84:85], v13 offset:33280
  v_mfma_f32_16x16x32_bf16 a[132:135], v[48:51], v[100:103], a[132:135]
  v_mfma_f32_16x16x32_bf16 a[136:139], v[48:51], v[104:107], a[136:139]
  ds_read_b64_tr_b16 v[86:87], v13 offset:34304
  v_mfma_f32_16x16x32_bf16 a[140:143], v[48:51], v[108:111], a[140:143]
  v_mfma_f32_16x16x32_bf16 a[144:147], v[48:51], v[112:115], a[144:147]
  ds_read_b128 v[148:151], v14 offset:37888
  v_mfma_f32_16x16x32_bf16 a[148:151], v[48:51], v[116:119], a[148:151]
  v_mfma_f32_16x16x32_bf16 a[152:155], v[48:51], v[120:123], a[152:155]
  ds_read_b64_tr_b16 v[88:89], v12 offset:33536
  v_mfma_f32_16x16x32_bf16 a[156:159], v[48:51], v[124:127], a[156:159]
  v_mfma_f32_16x16x32_bf16 a[160:163], v[52:55], v[96:99], a[160:163]
  ds_read_b64_tr_b16 v[90:91], v12 offset:34560
  v_mfma_f32_16x16x32_bf16 a[164:167], v[52:55], v[100:103], a[164:167]
  v_mfma_f32_16x16x32_bf16 a[168:171], v[52:55], v[104:107], a[168:171]
  ds_read_b128 v[152:155], v14 offset:38912
  v_mfma_f32_16x16x32_bf16 a[172:175], v[52:55], v[108:111], a[172:175]
  v_mfma_f32_16x16x32_bf16 a[176:179], v[52:55], v[112:115], a[176:179]
  ds_read_b64_tr_b16 v[92:93], v13 offset:33536
  v_mfma_f32_16x16x32_bf16 a[180:183], v[52:55], v[116:119], a[180:183]
  v_mfma_f32_16x16x32_bf16 a[184:187], v[52:55], v[120:123], a[184:187]
  ds_read_b64_tr_b16 v[94:95], v13 offset:34560
  v_mfma_f32_16x16x32_bf16 a[188:191], v[52:55], v[124:127], a[188:191]
  v_mfma_f32_16x16x32_bf16 a[192:195], v[56:59], v[96:99], a[192:195]
  s_add_u32 s26, s26, s79
  ds_read_b128 v[156:159], v14 offset:39936
  v_mfma_f32_16x16x32_bf16 a[196:199], v[56:59], v[100:103], a[196:199]
  s_add_u32 s27, s27, s25
  v_mfma_f32_16x16x32_bf16 a[200:203], v[56:59], v[104:107], a[200:203]
  s_add_u32 s24, s24, 32768
  v_mfma_f32_16x16x32_bf16 a[204:207], v[56:59], v[108:111], a[204:207]
  s_and_b32 s24, s24, 0x1ffff
  v_mfma_f32_16x16x32_bf16 a[208:211], v[56:59], v[112:115], a[208:211]
  v_xor_b32 v14, 0x10000, v14
  v_mfma_f32_16x16x32_bf16 a[212:215], v[56:59], v[116:119], a[212:215]
  v_xor_b32 v12, 0x10000, v12
  v_mfma_f32_16x16x32_bf16 a[216:219], v[56:59], v[120:123], a[216:219]
  v_xor_b32 v13, 0x10000, v13
  v_mfma_f32_16x16x32_bf16 a[220:223], v[56:59], v[124:127], a[220:223]
  v_mfma_f32_16x16x32_bf16 a[224:227], v[60:63], v[96:99], a[224:227]
  v_mfma_f32_16x16x32_bf16 a[228:231], v[60:63], v[100:103], a[228:231]
  v_mfma_f32_16x16x32_bf16 a[232:235], v[60:63], v[104:107], a[232:235]
  v_mfma_f32_16x16x32_bf16 a[236:239], v[60:63], v[108:111], a[236:239]
  v_mfma_f32_16x16x32_bf16 a[240:243], v[60:63], v[112:115], a[240:243]
  v_mfma_f32_16x16x32_bf16 a[244:247], v[60:63], v[116:119], a[244:247]
  v_mfma_f32_16x16x32_bf16 a[248:251], v[60:63], v[120:123], a[248:251]
  v_mfma_f32_16x16x32_bf16 a[252:255], v[60:63], v[124:127], a[252:255]
  s_waitcnt lgkmcnt(0)
  v_mfma_f32_16x16x32_bf16 a[0:3], v[64:67], v[128:131], a[0:3]
  s_waitcnt vmcnt(18)
  v_mfma_f32_16x16x32_bf16 a[4:7], v[64:67], v[132:135], a[4:7]
  s_barrier
  v_mfma_f32_16x16x32_bf16 a[8:11], v[64:67], v[136:139], a[8:11]
  ds_read_b64_tr_b16 v[32:33], v12 offset:0
  v_mfma_f32_16x16x32_bf16 a[12:15], v[64:67], v[140:143], a[12:15]
  v_mfma_f32_16x16x32_bf16 a[16:19], v[64:67], v[144:147], a[16:19]
  s_mov_b32 m0, s24
  ds_read_b64_tr_b16 v[34:35], v12 offset:1024
  v_mfma_f32_16x16x32_bf16 a[20:23], v[64:67], v[148:151], a[20:23]
  buffer_load_dwordx4 v3, s[32:35], s26 offen offset:0 sc1 lds
  v_mfma_f32_16x16x32_bf16 a[24:27], v[64:67], v[152:155], a[24:27]
  ds_read_b128 v[96:99], v14 offset:0
  v_mfma_f32_16x16x32_bf16 a[28:31], v[64:67], v[156:159], a[28:31]
  v_mfma_f32_16x16x32_bf16 a[32:35], v[68:71], v[128:131], a[32:35]
  ds_read_b64_tr_b16 v[36:37], v13 offset:0
  v_mfma_f32_16x16x32_bf16 a[36:39], v[68:71], v[132:135], a[36:39]
  v_mfma_f32_16x16x32_bf16 a[40:43], v[68:71], v[136:139], a[40:43]
  ds_read_b64_tr_b16 v[38:39], v13 offset:1024
  v_mfma_f32_16x16x32_bf16 a[44:47], v[68:71], v[140:143], a[44:47]
  buffer_load_dwordx4 v4, s[32:35], s26 offen offset:1024 sc1 lds
  v_mfma_f32_16x16x32_bf16 a[48:51], v[68:71], v[144:147], a[48:51]
  ds_read_b128 v[100:103], v14 offset:1024
  v_mfma_f32_16x16x32_bf16 a[52:55], v[68:71], v[148:151], a[52:55]
  v_mfma_f32_16x16x32_bf16 a[56:59], v[68:71], v[152:155], a[56:59]
  ds_read_b64_tr_b16 v[40:41], v12 offset:256
  v_mfma_f32_16x16x32_bf16 a[60:63], v[68:71], v[156:159], a[60:63]
  v_mfma_f32_16x16x32_bf16 a[64:67], v[72:75], v[128:131], a[64:67]
  ds_read_b64_tr_b16 v[42:43], v12 offset:1280
  v_mfma_f32_16x16x32_bf16 a[68:71], v[72:75], v[132:135], a[68:71]
  buffer_load_dwordx4 v5, s[32:35], s26 offen offset:2048 sc1 lds
  v_mfma_f32_16x16x32_bf16 a[72:75], v[72:75], v[136:139], a[72:75]
  ds_read_b128 v[104:107], v14 offset:2048
  v_mfma_f32_16x16x32_bf16 a[76:79], v[72:75], v[140:143], a[76:79]
  v_mfma_f32_16x16x32_bf16 a[80:83], v[72:75], v[144:147], a[80:83]
  ds_read_b64_tr_b16 v[44:45], v13 offset:256
  v_mfma_f32_16x16x32_bf16 a[84:87], v[72:75], v[148:151], a[84:87]
  v_mfma_f32_16x16x32_bf16 a[88:91], v[72:75], v[152:155], a[88:91]
  ds_read_b64_tr_b16 v[46:47], v13 offset:1280
  v_mfma_f32_16x16x32_bf16 a[92:95], v[72:75], v[156:159], a[92:95]
  buffer_load_dwordx4 v6, s[32:35], s26 offen offset:3072 sc1 lds
  v_mfma_f32_16x16x32_bf16 a[96:99], v[76:79], v[128:131], a[96:99]
  ds_read_b128 v[108:111], v14 offset:3072
  v_mfma_f32_16x16x32_bf16 a[100:103], v[76:79], v[132:135], a[100:103]
  v_mfma_f32_16x16x32_bf16 a[104:107], v[76:79], v[136:139], a[104:107]
  ds_read_b64_tr_b16 v[48:49], v12 offset:512
  v_mfma_f32_16x16x32_bf16 a[108:111], v[76:79], v[140:143], a[108:111]
  v_mfma_f32_16x16x32_bf16 a[112:115], v[76:79], v[144:147], a[112:115]
  s_add_u32 m0, s24, 16384
  ds_read_b64_tr_b16 v[50:51], v12 offset:1536
  v_mfma_f32_16x16x32_bf16 a[116:119], v[76:79], v[148:151], a[116:119]
  buffer_load_dwordx4 v8, s[36:39], s27 offen offset:0 lds
  v_mfma_f32_16x16x32_bf16 a[120:123], v[76:79], v[152:155], a[120:123]
  ds_read_b128 v[112:115], v14 offset:4096
  v_mfma_f32_16x16x32_bf16 a[124:127], v[76:79], v[156:159], a[124:127]
  v_mfma_f32_16x16x32_bf16 a[128:131], v[80:83], v[128:131], a[128:131]
  ds_read_b64_tr_b16 v[52:53], v13 offset:512
  v_mfma_f32_16x16x32_bf16 a[132:135], v[80:83], v[132:135], a[132:135]
  v_mfma_f32_16x16x32_bf16 a[136:139], v[80:83], v[136:139], a[136:139]
  ds_read_b64_tr_b16 v[54:55], v13 offset:1536
  v_mfma_f32_16x16x32_bf16 a[140:143], v[80:83], v[140:143], a[140:143]
  buffer_load_dwordx4 v9, s[36:39], s27 offen offset:1024 lds
  v_mfma_f32_16x16x32_bf16 a[144:147], v[80:83], v[144:147], a[144:147]
  ds_read_b128 v[116:119], v14 offset:5120
  v_mfma_f32_16x16x32_bf16 a[148:151], v[80:83], v[148:151], a[148:151]
  v_mfma_f32_16x16x32_bf16 a[152:155], v[80:83], v[152:155], a[152:155]
  ds_read_b64_tr_b16 v[56:57], v12 offset:768
  v_mfma_f32_16x16x32_bf16 a[156:159], v[80:83], v[156:159], a[156:159]
  v_mfma_f32_16x16x32_bf16 a[160:163], v[84:87], v[128:131], a[160:163]
  ds_read_b64_tr_b16 v[58:59], v12 offset:1792
  v_mfma_f32_16x16x32_bf16 a[164:167], v[84:87], v[132:135], a[164:167]
  buffer_load_dwordx4 v10, s[36:39], s27 offen offset:2048 lds
  v_mfma_f32_16x16x32_bf16 a[168:171], v[84:87], v[136:139], a[168:171]
  ds_read_b128 v[120:123], v14 offset:6144
  v_mfma_f32_16x16x32_bf16 a[172:175], v[84:87], v[140:143], a[172:175]
  v_mfma_f32_16x16x32_bf16 a[176:179], v[84:87], v[144:147], a[176:179]
  ds_read_b64_tr_b16 v[60:61], v13 offset:768
  v_mfma_f32_16x16x32_bf16 a[180:183], v[84:87], v[148:151], a[180:183]
  v_mfma_f32_16x16x32_bf16 a[184:187], v[84:87], v[152:155], a[184:187]
  ds_read_b64_tr_b16 v[62:63], v13 offset:1792
  v_mfma_f32_16x16x32_bf16 a[188:191], v[84:87], v[156:159], a[188:191]
  buffer_load_dwordx4 v11, s[36:39], s27 offen offset:3072 lds
  v_mfma_f32_16x16x32_bf16 a[192:195], v[88:91], v[128:131], a[192:195]
  s_add_u32 s26, s26, s79
  ds_read_b128 v[124:127], v14 offset:7168
  v_mfma_f32_16x16x32_bf16 a[196:199], v[88:91], v[132:135], a[196:199]
  s_add_u32 s27, s27, s25
  v_mfma_f32_16x16x32_bf16 a[200:203], v[88:91], v[136:139], a[200:203]
  s_add_u32 s24, s24, 32768
  v_mfma_f32_16x16x32_bf16 a[204:207], v[88:91], v[140:143], a[204:207]
  s_and_b32 s24, s24, 0x1ffff
  v_mfma_f32_16x16x32_bf16 a[208:211], v[88:91], v[144:147], a[208:211]
  v_mfma_f32_16x16x32_bf16 a[212:215], v[88:91], v[148:151], a[212:215]
  v_mfma_f32_16x16x32_bf16 a[216:219], v[88:91], v[152:155], a[216:219]
  s_add_u32 s28, s28, 1
  v_mfma_f32_16x16x32_bf16 a[220:223], v[88:91], v[156:159], a[220:223]
  v_mfma_f32_16x16x32_bf16 a[224:227], v[92:95], v[128:131], a[224:227]
  v_mfma_f32_16x16x32_bf16 a[228:231], v[92:95], v[132:135], a[228:231]
  v_mfma_f32_16x16x32_bf16 a[232:235], v[92:95], v[136:139], a[232:235]
  v_mfma_f32_16x16x32_bf16 a[236:239], v[92:95], v[140:143], a[236:239]
  v_mfma_f32_16x16x32_bf16 a[240:243], v[92:95], v[144:147], a[240:243]
  v_mfma_f32_16x16x32_bf16 a[244:247], v[92:95], v[148:151], a[244:247]
  s_cmp_lt_u32 s28, 8
  v_mfma_f32_16x16x32_bf16 a[248:251], v[92:95], v[152:155], a[248:251]
  s_waitcnt lgkmcnt(0)
  v_mfma_f32_16x16x32_bf16 a[252:255], v[92:95], v[156:159], a[252:255]
  s_cbranch_scc1 fa_loopK
  s_mov_b32 s60, 2048
  s_mov_b32 s61, 8192
  s_mov_b32 s62, 16777216
  s_branch fa_p1epi
fa_roleV:
  ds_read_b128 v[32:35], v14 offset:0
  ds_read_b128 v[36:39], v14 offset:1024
  ds_read_b128 v[40:43], v14 offset:2048
  ds_read_b128 v[44:47], v14 offset:3072
  ds_read_b128 v[48:51], v14 offset:4096
  ds_read_b128 v[52:55], v14 offset:5120
  ds_read_b128 v[56:59], v14 offset:6144
  ds_read_b128 v[60:63], v14 offset:7168
  ds_read_b64_tr_b16 v[96:97], v12 offset:0
  ds_read_b64_tr_b16 v[98:99], v12 offset:1024
  ds_read_b64_tr_b16 v[100:101], v13 offset:0
  ds_read_b64_tr_b16 v[102:103], v13 offset:1024
  ds_read_b64_tr_b16 v[104:105], v12 offset:256
  ds_read_b64_tr_b16 v[106:107], v12 offset:1280
  ds_read_b64_tr_b16 v[108:109], v13 offset:256
  ds_read_b64_tr_b16 v[110:111], v13 offset:1280
  ds_read_b64_tr_b16 v[112:113], v12 offset:512
  ds_read_b64_tr_b16 v[114:115], v12 offset:1536
  ds_read_b64_tr_b16 v[116:117], v13 offset:512
  ds_read_b64_tr_b16 v[118:119], v13 offset:1536
  ds_read_b64_tr_b16 v[120:121], v12 offset:768
  ds_read_b64_tr_b16 v[122:123], v12 offset:1792
  ds_read_b64_tr_b16 v[124:125], v13 offset:768
  ds_read_b64_tr_b16 v[126:127], v13 offset:1792
  s_waitcnt lgkmcnt(0)
.p2align 6
fa_loopV:
  v_mfma_f32_16x16x32_bf16 a[0:3], v[32:35], v[96:99], a[0:3]
  s_waitcnt vmcnt(17)
  v_mfma_f32_16x16x32_bf16 a[4:7], v[32:35], v[100:103], a[4:7]
  s_barrier
  v_mfma_f32_16x16x32_bf16 a[8:11], v[32:35], v[104:107], a[8:11]
  s_bitcmp1_b32 s72, s28
  ds_read_b64_tr_b16 v[128:129], v12 offset:32768
  v_mfma_f32_16x16x32_bf16 a[12:15], v[32:35], v[108:111], a[12:15]
  s_cbranch_scc1 fa_p1stubV
fa_p1backV:
  v_mfma_f32_16x16x32_bf16 a[16:19], v[32:35], v[112:115], a[16:19]
  s_mov_b32 m0, s24
  ds_read_b64_tr_b16 v[130:131], v12 offset:33792
  v_mfma_f32_16x16x32_bf16 a[20:23], v[32:35], v[116:119], a[20:23]
  buffer_load_dwordx4 v3, s[32:35], s26 offen offset:0 sc1 lds
  v_mfma_f32_16x16x32_bf16 a[24:27], v[32:35], v[120:123], a[24:27]
  ds_read_b128 v[64:67], v14 offset:32768
  v_mfma_f32_16x16x32_bf16 a[28:31], v[32:35], v[124:127], a[28:31]
  buffer_load_dwordx4 v4, s[32:35], s26 offen offset:1024 sc1 lds
  v_mfma_f32_16x16x32_bf16 a[32:35], v[36:39], v[96:99], a[32:35]
  ds_read_b64_tr_b16 v[132:133], v13 offset:32768
  v_mfma_f32_16x16x32_bf16 a[36:39], v[36:39], v[100:103], a[36:39]
  buffer_load_dwordx4 v5, s[32:35], s26 offen offset:2048 sc1 lds
  v_mfma_f32_16x16x32_bf16 a[40:43], v[36:39], v[104:107], a[40:43]
  ds_read_b64_tr_b16 v[134:135], v13 offset:33792
  v_mfma_f32_16x16x32_bf16 a[44:47], v[36:39], v[108:111], a[44:47]
  buffer_load_dwordx4 v6, s[32:35], s26 offen offset:3072 sc1 lds
  v_mfma_f32_16x16x32_bf16 a[48:51], v[36:39], v[112:115], a[48:51]
  s_add_u32 m0, s24, 16384
  ds_read_b128 v[68:71], v14 offset:33792
  v_mfma_f32_16x16x32_bf16 a[52:55], v[36:39], v[116:119], a[52:55]
  buffer_load_dwordx4 v8, s[36:39], s27 offen offset:0 lds
  v_mfma_f32_16x16x32_bf16 a[56:59], v[36:39], v[120:123], a[56:59]
  ds_read_b64_tr_b16 v[136:137], v12 offset:33024
  v_mfma_f32_16x16x32_bf16 a[60:63], v[36:39], v[124:127], a[60:63]
  buffer_load_dwordx4 v9, s[36:39], s27 offen offset:1024 lds
  v_mfma_f32_16x16x32_bf16 a[64:67], v[40:43], v[96:99], a[64:67]
  ds_read_b64_tr_b16 v[138:139], v12 offset:34048
  v_mfma_f32_16x16x32_bf16 a[68:71], v[40:43], v[100:103], a[68:71]
  buffer_load_dwordx4 v10, s[36:39], s27 offen offset:2048 lds
  v_mfma_f32_16x16x32_bf16 a[72:75], v[40:43], v[104:107], a[72:75]
  ds_read_b128 v[72:75], v14 offset:34816
  v_mfma_f32_16x16x32_bf16 a[76:79], v[40:43], v[108:111], a[76:79]
  buffer_load_dwordx4 v11, s[36:39], s27 offen offset:3072 lds
  v_mfma_f32_16x16x32_bf16 a[80:83], v[40:43], v[112:115], a[80:83]
  ds_read_b64_tr_b16 v[140:141], v13 offset:33024
  v_mfma_f32_16x16x32_bf16 a[84:87], v[40:43], v[116:119], a[84:87]
  buffer_load_dword v231, v235, s[48:51], s74 offen
  v_mfma_f32_16x16x32_bf16 a[88:91], v[40:43], v[120:123], a[88:91]
  s_add_u32 s74, s74, s73
  ds_read_b64_tr_b16 v[142:143], v13 offset:34048
  v_mfma_f32_16x16x32_bf16 a[92:95], v[40:43], v[124:127], a[92:95]
  v_mfma_f32_16x16x32_bf16 a[96:99], v[44:47], v[96:99], a[96:99]
  ds_read_b128 v[76:79], v14 offset:35840
  v_mfma_f32_16x16x32_bf16 a[100:103], v[44:47], v[100:103], a[100:103]
  v_mfma_f32_16x16x32_bf16 a[104:107], v[44:47], v[104:107], a[104:107]
  ds_read_b64_tr_b16 v[144:145], v12 offset:33280
  v_mfma_f32_16x16x32_bf16 a[108:111], v[44:47], v[108:111], a[108:111]
  v_mfma_f32_16x16x32_bf16 a[112:115], v[44:47], v[112:115], a[112:115]
  ds_read_b64_tr_b16 v[146:147], v12 offset:34304
  v_mfma_f32_16x16x32_bf16 a[116:119], v[44:47], v[116:119], a[116:119]
  v_mfma_f32_16x16x32_bf16 a[120:123], v[44:47], v[120:123], a[120:123]
  ds_read_b128 v[80:83], v14 offset:36864
  v_mfma_f32_16x16x32_bf16 a[124:127], v[44:47], v[124:127], a[124:127]
  v_mfma_f32_16x16x32_bf16 a[128:131], v[48:51], v[96:99], a[128:131]
  ds_read_b64_tr_b16 v[148:149], v13 offset:33280
  v_mfma_f32_16x16x32_bf16 a[132:135], v[48:51], v[100:103], a[132:135]
  v_mfma_f32_16x16x32_bf16 a[136:139], v[48:51], v[104:107], a[136:139]
  ds_read_b64_tr_b16 v[150:151], v13 offset:34304
  v_mfma_f32_16x16x32_bf16 a[140:143], v[48:51], v[108:111], a[140:143]
  v_mfma_f32_16x16x32_bf16 a[144:147], v[48:51], v[112:115], a[144:147]
  ds_read_b128 v[84:87], v14 offset:37888
  v_mfma_f32_16x16x32_bf16 a[148:151], v[48:51], v[116:119], a[148:151]
  v_mfma_f32_16x16x32_bf16 a[152:155], v[48:51], v[120:123], a[152:155]
  ds_read_b64_tr_b16 v[152:153], v12 offset:33536
  v_mfma_f32_16x16x32_bf16 a[156:159], v[48:51], v[124:127], a[156:159]
  v_mfma_f32_16x16x32_bf16 a[160:163], v[52:55], v[96:99], a[160:163]
  ds_read_b64_tr_b16 v[154:155], v12 offset:34560
  v_mfma_f32_16x16x32_bf16 a[164:167], v[52:55], v[100:103], a[164:167]
  v_mfma_f32_16x16x32_bf16 a[168:171], v[52:55], v[104:107], a[168:171]
  ds_read_b128 v[88:91], v14 offset:38912
  v_mfma_f32_16x16x32_bf16 a[172:175], v[52:55], v[108:111], a[172:175]
  v_mfma_f32_16x16x32_bf16 a[176:179], v[52:55], v[112:115], a[176:179]
  ds_read_b64_tr_b16 v[156:157], v13 offset:33536
  v_mfma_f32_16x16x32_bf16 a[180:183], v[52:55], v[116:119], a[180:183]
  v_mfma_f32_16x16x32_bf16 a[184:187], v[52:55], v[120:123], a[184:187]
  ds_read_b64_tr_b16 v[158:159], v13 offset:34560
  v_mfma_f32_16x16x32_bf16 a[188:191], v[52:55], v[124:127], a[188:191]
  v_mfma_f32_16x16x32_bf16 a[192:195], v[56:59], v[96:99], a[192:195]
  s_add_u32 s26, s26, s79
  ds_read_b128 v[92:95], v14 offset:39936
  v_mfma_f32_16x16x32_bf16 a[196:199], v[56:59], v[100:103], a[196:199]
  s_add_u32 s27, s27, s25
  v_mfma_f32_16x16x32_bf16 a[200:203], v[56:59], v[104:107], a[200:203]
  s_add_u32 s24, s24, 32768
  v_mfma_f32_16x16x32_bf16 a[204:207], v[56:59], v[108:111], a[204:207]
  s_and_b32 s24, s24, 0x1ffff
  v_mfma_f32_16x16x32_bf16 a[208:211], v[56:59], v[112:115], a[208:211]
  v_xor_b32 v14, 0x10000, v14
  v_mfma_f32_16x16x32_bf16 a[212:215], v[56:59], v[116:119], a[212:215]
  v_xor_b32 v12, 0x10000, v12
  v_mfma_f32_16x16x32_bf16 a[216:219], v[56:59], v[120:123], a[216:219]
  v_xor_b32 v13, 0x10000, v13
  v_mfma_f32_16x16x32_bf16 a[220:223], v[56:59], v[124:127], a[220:223]
  v_mfma_f32_16x16x32_bf16 a[224:227], v[60:63], v[96:99], a[224:227]
  v_mfma_f32_16x16x32_bf16 a[228:231], v[60:63], v[100:103], a[228:231]
  v_mfma_f32_16x16x32_bf16 a[232:235], v[60:63], v[104:107], a[232:235]
  v_mfma_f32_16x16x32_bf16 a[236:239], v[60:63], v[108:111], a[236:239]
  v_mfma_f32_16x16x32_bf16 a[240:243], v[60:63], v[112:115], a[240:243]
  v_mfma_f32_16x16x32_bf16 a[244:247], v[60:63], v[116:119], a[244:247]
  v_mfma_f32_16x16x32_bf16 a[248:251], v[60:63], v[120:123], a[248:251]
  v_mfma_f32_16x16x32_bf16 a[252:255], v[60:63], v[124:127], a[252:255]
  s_waitcnt lgkmcnt(0)
  v_mfma_f32_16x16x32_bf16 a[0:3], v[64:67], v[128:131], a[0:3]
  s_waitcnt vmcnt(18)
  v_mfma_f32_16x16x32_bf16 a[4:7], v[64:67], v[132:135], a[4:7]
  s_barrier
  v_mfma_f32_16x16x32_bf16 a[8:11], v[64:67], v[136:139], a[8:11]
  ds_read_b64_tr_b16 v[96:97], v12 offset:0
  v_mfma_f32_16x16x32_bf16 a[12:15], v[64:67], v[140:143], a[12:15]
  v_mfma_f32_16x16x32_bf16 a[16:19], v[64:67], v[144:147], a[16:19]
  s_mov_b32 m0, s24
  ds_read_b64_tr_b16 v[98:99], v12 offset:1024
  v_mfma_f32_16x16x32_bf16 a[20:23], v[64:67], v[148:151], a[20:23]
  buffer_load_dwordx4 v3, s[32:35], s26 offen offset:0 sc1 lds
  v_mfma_f32_16x16x32_bf16 a[24:27], v[64:67], v[152:155], a[24:27]
  ds_read_b128 v[32:35], v14 offset:0
  v_mfma_f32_16x16x32_bf16 a[28:31], v[64:67], v[156:159], a[28:31]
  v_mfma_f32_16x16x32_bf16 a[32:35], v[68:71], v[128:131], a[32:35]
  ds_read_b64_tr_b16 v[100:101], v13 offset:0
  v_mfma_f32_16x16x32_bf16 a[36:39], v[68:71], v[132:135], a[36:39]
  v_mfma_f32_16x16x32_bf16 a[40:43], v[68:71], v[136:139], a[40:43]
  ds_read_b64_tr_b16 v[102:103], v13 offset:1024
  v_mfma_f32_16x16x32_bf16 a[44:47], v[68:71], v[140:143], a[44:47]
  buffer_load_dwordx4 v4, s[32:35], s26 offen offset:1024 sc1 lds
  v_mfma_f32_16x16x32_bf16 a[48:51], v[68:71], v[144:147], a[48:51]
  ds_read_b128 v[36:39], v14 offset:1024
  v_mfma_f32_16x16x32_bf16 a[52:55], v[68:71], v[148:151], a[52:55]
  v_mfma_f32_16x16x32_bf16 a[56:59], v[68:71], v[152:155], a[56:59]
  ds_read_b64_tr_b16 v[104:105], v12 offset:256
  v_mfma_f32_16x16x32_bf16 a[60:63], v[68:71], v[156:159], a[60:63]
  v_mfma_f32_16x16x32_bf16 a[64:67], v[72:75], v[128:131], a[64:67]
  ds_read_b64_tr_b16 v[106:107], v12 offset:1280
  v_mfma_f32_16x16x32_bf16 a[68:71], v[72:75], v[132:135], a[68:71]
  buffer_load_dwordx4 v5, s[32:35], s26 offen offset:2048 sc1 lds
  v_mfma_f32_16x16x32_bf16 a[72:75], v[72:75], v[136:139], a[72:75]
  ds_read_b128 v[40:43], v14 offset:2048
  v_mfma_f32_16x16x32_bf16 a[76:79], v[72:75], v[140:143], a[76:79]
  v_mfma_f32_16x16x32_bf16 a[80:83], v[72:75], v[144:147], a[80:83]
  ds_read_b64_tr_b16 v[108:109], v13 offset:256
  v_mfma_f32_16x16x32_bf16 a[84:87], v[72:75], v[148:151], a[84:87]
  v_mfma_f32_16x16x32_bf16 a[88:91], v[72:75], v[152:155], a[88:91]
  ds_read_b64_tr_b16 v[110:111], v13 offset:1280
  v_mfma_f32_16x16x32_bf16 a[92:95], v[72:75], v[156:159], a[92:95]
  buffer_load_dwordx4 v6, s[32:35], s26 offen offset:3072 sc1 lds
  v_mfma_f32_16x16x32_bf16 a[96:99], v[76:79], v[128:131], a[96:99]
  ds_read_b128 v[44:47], v14 offset:3072
  v_mfma_f32_16x16x32_bf16 a[100:103], v[76:79], v[132:135], a[100:103]
  v_mfma_f32_16x16x32_bf16 a[104:107], v[76:79], v[136:139], a[104:107]
  ds_read_b64_tr_b16 v[112:113], v12 offset:512
  v_mfma_f32_16x16x32_bf16 a[108:111], v[76:79], v[140:143], a[108:111]
  v_mfma_f32_16x16x32_bf16 a[112:115], v[76:79], v[144:147], a[112:115]
  s_add_u32 m0, s24, 16384
  ds_read_b64_tr_b16 v[114:115], v12 offset:1536
  v_mfma_f32_16x16x32_bf16 a[116:119], v[76:79], v[148:151], a[116:119]
  buffer_load_dwordx4 v8, s[36:39], s27 offen offset:0 lds
  v_mfma_f32_16x16x32_bf16 a[120:123], v[76:79], v[152:155], a[120:123]
  ds_read_b128 v[48:51], v14 offset:4096
  v_mfma_f32_16x16x32_bf16 a[124:127], v[76:79], v[156:159], a[124:127]
  v_mfma_f32_16x16x32_bf16 a[128:131], v[80:83], v[128:131], a[128:131]
  ds_read_b64_tr_b16 v[116:117], v13 offset:512
  v_mfma_f32_16x16x32_bf16 a[132:135], v[80:83], v[132:135], a[132:135]
  v_mfma_f32_16x16x32_bf16 a[136:139], v[80:83], v[136:139], a[136:139]
  ds_read_b64_tr_b16 v[118:119], v13 offset:1536
  v_mfma_f32_16x16x32_bf16 a[140:143], v[80:83], v[140:143], a[140:143]
  buffer_load_dwordx4 v9, s[36:39], s27 offen offset:1024 lds
  v_mfma_f32_16x16x32_bf16 a[144:147], v[80:83], v[144:147], a[144:147]
  ds_read_b128 v[52:55], v14 offset:5120
  v_mfma_f32_16x16x32_bf16 a[148:151], v[80:83], v[148:151], a[148:151]
  v_mfma_f32_16x16x32_bf16 a[152:155], v[80:83], v[152:155], a[152:155]
  ds_read_b64_tr_b16 v[120:121], v12 offset:768
  v_mfma_f32_16x16x32_bf16 a[156:159], v[80:83], v[156:159], a[156:159]
  v_mfma_f32_16x16x32_bf16 a[160:163], v[84:87], v[128:131], a[160:163]
  ds_read_b64_tr_b16 v[122:123], v12 offset:1792
  v_mfma_f32_16x16x32_bf16 a[164:167], v[84:87], v[132:135], a[164:167]
  buffer_load_dwordx4 v10, s[36:39], s27 offen offset:2048 lds
  v_mfma_f32_16x16x32_bf16 a[168:171], v[84:87], v[136:139], a[168:171]
  ds_read_b128 v[56:59], v14 offset:6144
  v_mfma_f32_16x16x32_bf16 a[172:175], v[84:87], v[140:143], a[172:175]
  v_mfma_f32_16x16x32_bf16 a[176:179], v[84:87], v[144:147], a[176:179]
  ds_read_b64_tr_b16 v[124:125], v13 offset:768
  v_mfma_f32_16x16x32_bf16 a[180:183], v[84:87], v[148:151], a[180:183]
  v_mfma_f32_16x16x32_bf16 a[184:187], v[84:87], v[152:155], a[184:187]
  ds_read_b64_tr_b16 v[126:127], v13 offset:1792
  v_mfma_f32_16x16x32_bf16 a[188:191], v[84:87], v[156:159], a[188:191]
  buffer_load_dwordx4 v11, s[36:39], s27 offen offset:3072 lds
  v_mfma_f32_16x16x32_bf16 a[192:195], v[88:91], v[128:131], a[192:195]
  s_add_u32 s26, s26, s79
  ds_read_b128 v[60:63], v14 offset:7168
  v_mfma_f32_16x16x32_bf16 a[196:199], v[88:91], v[132:135], a[196:199]
  s_add_u32 s27, s27, s25
  v_mfma_f32_16x16x32_bf16 a[200:203], v[88:91], v[136:139], a[200:203]
  s_add_u32 s24, s24, 32768
  v_mfma_f32_16x16x32_bf16 a[204:207], v[88:91], v[140:143], a[204:207]
  s_and_b32 s24, s24, 0x1ffff
  v_mfma_f32_16x16x32_bf16 a[208:211], v[88:91], v[144:147], a[208:211]
  v_mfma_f32_16x16x32_bf16 a[212:215], v[88:91], v[148:151], a[212:215]
  v_mfma_f32_16x16x32_bf16 a[216:219], v[88:91], v[152:155], a[216:219]
  s_add_u32 s28, s28, 1
  v_mfma_f32_16x16x32_bf16 a[220:223], v[88:91], v[156:159], a[220:223]
  v_mfma_f32_16x16x32_bf16 a[224:227], v[92:95], v[128:131], a[224:227]
  v_mfma_f32_16x16x32_bf16 a[228:231], v[92:95], v[132:135], a[228:231]
  v_mfma_f32_16x16x32_bf16 a[232:235], v[92:95], v[136:139], a[232:235]
  v_mfma_f32_16x16x32_bf16 a[236:239], v[92:95], v[140:143], a[236:239]
  v_mfma_f32_16x16x32_bf16 a[240:243], v[92:95], v[144:147], a[240:243]
  v_mfma_f32_16x16x32_bf16 a[244:247], v[92:95], v[148:151], a[244:247]
  s_cmp_lt_u32 s28, 8
  v_mfma_f32_16x16x32_bf16 a[248:251], v[92:95], v[152:155], a[248:251]
  s_waitcnt lgkmcnt(0)
  v_mfma_f32_16x16x32_bf16 a[252:255], v[92:95], v[156:159], a[252:255]
  s_cbranch_scc1 fa_loopV
  s_mov_b32 s60, 8192
  s_mov_b32 s61, 2048
  s_mov_b32 s62, 33554432
fa_p1epi:
  s_lshr_b32 s23, s20, 1
  s_lshl_b32 s23, s23, 13
  v_subrev_u32 v12, s23, v12
  v_subrev_u32 v13, s23, v13
  s_lshl_b32 s24, s20, 12
  v_add_u32 v14, s24, v2
  ds_read_b128 v[224:227], v14 offset:0
  ds_read_b64_tr_b16 v[32:33], v12 offset:0
  ds_read_b64_tr_b16 v[34:35], v12 offset:1024
  ds_read_b64_tr_b16 v[36:37], v13 offset:0
  ds_read_b64_tr_b16 v[38:39], v13 offset:1024
  ds_read_b64_tr_b16 v[40:41], v12 offset:256
  ds_read_b64_tr_b16 v[42:43], v12 offset:1280
  ds_read_b64_tr_b16 v[44:45], v13 offset:256
  ds_read_b64_tr_b16 v[46:47], v13 offset:1280
  ds_read_b64_tr_b16 v[48:49], v12 offset:512
  ds_read_b64_tr_b16 v[50:51], v12 offset:1536
  ds_read_b64_tr_b16 v[52:53], v13 offset:512
  ds_read_b64_tr_b16 v[54:55], v13 offset:1536
  ds_read_b64_tr_b16 v[56:57], v12 offset:768
  ds_read_b64_tr_b16 v[58:59], v12 offset:1792
  ds_read_b64_tr_b16 v[60:61], v13 offset:768
  ds_read_b64_tr_b16 v[62:63], v13 offset:1792
  ds_read_b128 v[228:231], v14 offset:1024
  ds_read_b128 v[232:235], v14 offset:2048
  ds_read_b128 v[236:239], v14 offset:3072
  s_lshl_b32 s23, s21, 19
  s_add_u32 s62, s62, s23
  s_lshl_b32 s23, s22, 16
  s_add_u32 s62, s62, s23
  s_and_b32 s23, s20, 1
  s_lshl_b32 s23, s23, 15
  s_add_u32 s62, s62, s23
  s_lshl_b32 s23, s21, 19
  s_add_u32 s23, s23, 16777216
  s_add_u32 s6, s18, s23
  s_addc_u32 s7, s19, 0
  s_add_u32 s8, s6, 16777216
  s_addc_u32 s9, s7, 0
  s_sub_u32 s23, 16, s22
  s_lshl_b32 s23, s23, 15
  s_mov_b32 s44, s6
  s_mov_b32 s45, s7
  s_mov_b32 s46, s23
  s_mov_b32 s47, 0x20000
  s_mov_b32 s48, s8
  s_mov_b32 s49, s9
  s_mov_b32 s50, s23
  s_mov_b32 s51, 0x20000
  s_lshl_b32 s30, s21, 7
  s_add_u32 s30, s30, 2637824
  s_mov_b32 s81, 0x47800000
  s_cmp_eq_u32 s20, 0
  s_cselect_b32 s29, s82, 1073741824
  s_waitcnt vmcnt(21) lgkmcnt(0)
  v_mfma_f32_16x16x32_bf16 v[96:99], v[32:35], v[224:227], 0
  s_mul_i32 s63, s60, 0
  v_accvgpr_read_b32 v16, a0
  v_accvgpr_read_b32 v17, a1
  v_mfma_f32_16x16x32_bf16 v[112:115], v[36:39], v[224:227], 0
  s_add_u32 s63, s63, s62
  ds_read_b64_tr_b16 v[64:65], v12 offset:8192
  v_accvgpr_read_b32 v18, a2
  v_mfma_f32_16x16x32_bf16 v[128:131], v[40:43], v[224:227], 0
  s_add_u32 m0, s24, 0
  ds_read_b64_tr_b16 v[66:67], v12 offset:9216
  v_accvgpr_read_b32 v19, a3
  v_mfma_f32_16x16x32_bf16 v[144:147], v[44:47], v[224:227], 0
  buffer_load_dwordx4 v3, s[32:35], s26 offen offset:0 sc1 lds
  v_accvgpr_read_b32 v20, a32
  v_mfma_f32_16x16x32_bf16 v[160:163], v[48:51], v[224:227], 0
  ds_read_b64_tr_b16 v[68:69], v13 offset:8192
  v_accvgpr_read_b32 v21, a33
  v_mfma_f32_16x16x32_bf16 v[176:179], v[52:55], v[224:227], 0
  ds_read_b64_tr_b16 v[70:71], v13 offset:9216
  v_accvgpr_read_b32 v22, a34
  v_mfma_f32_16x16x32_bf16 v[192:195], v[56:59], v[224:227], 0
  ds_read_b64_tr_b16 v[72:73], v12 offset:8448
  v_accvgpr_read_b32 v23, a35
  v_mfma_f32_16x16x32_bf16 v[208:211], v[60:63], v[224:227], 0
  ds_read_b64_tr_b16 v[74:75], v12 offset:9472
  v_cvt_pk_bf16_f32 v24, v16, v17
  v_mfma_f32_16x16x32_bf16 v[100:103], v[32:35], v[228:231], 0
  buffer_load_dwordx4 v4, s[32:35], s26 offen offset:1024 sc1 lds
  v_cvt_pk_bf16_f32 v25, v18, v19
  v_mfma_f32_16x16x32_bf16 v[116:119], v[36:39], v[228:231], 0
  ds_read_b64_tr_b16 v[76:77], v13 offset:8448
  v_cvt_pk_bf16_f32 v26, v20, v21
  v_mfma_f32_16x16x32_bf16 v[132:135], v[40:43], v[228:231], 0
  ds_read_b64_tr_b16 v[78:79], v13 offset:9472
  v_cvt_pk_bf16_f32 v27, v22, v23
  v_mfma_f32_16x16x32_bf16 v[148:151], v[44:47], v[228:231], 0
  ds_read_b128 v[240:243], v14 offset:32768
  buffer_store_dwordx4 v[24:27], v2, s[40:43], s63 offen offset:0 sc1
  v_mfma_f32_16x16x32_bf16 v[164:167], v[48:51], v[228:231], 0
  ds_read_b128 v[244:247], v14 offset:33792
  v_accvgpr_read_b32 v16, a4
  v_mfma_f32_16x16x32_bf16 v[180:183], v[52:55], v[228:231], 0
  buffer_load_dwordx4 v5, s[32:35], s26 offen offset:2048 sc1 lds
  v_accvgpr_read_b32 v17, a5
  v_mfma_f32_16x16x32_bf16 v[196:199], v[56:59], v[228:231], 0
  ds_read_b64_tr_b16 v[80:81], v12 offset:8704
  v_accvgpr_read_b32 v18, a6
  v_mfma_f32_16x16x32_bf16 v[212:215], v[60:63], v[228:231], 0
  ds_read_b64_tr_b16 v[82:83], v12 offset:9728
  v_accvgpr_read_b32 v19, a7
  v_mfma_f32_16x16x32_bf16 v[104:107], v[32:35], v[232:235], 0
  ds_read_b64_tr_b16 v[84:85], v13 offset:8704
  v_accvgpr_read_b32 v20, a36
  v_mfma_f32_16x16x32_bf16 v[120:123], v[36:39], v[232:235], 0
  ds_read_b64_tr_b16 v[86:87], v13 offset:9728
  v_accvgpr_read_b32 v21, a37
  v_mfma_f32_16x16x32_bf16 v[136:139], v[40:43], v[232:235], 0
  buffer_load_dwordx4 v6, s[32:35], s26 offen offset:3072 sc1 lds
  v_accvgpr_read_b32 v22, a38
  v_mfma_f32_16x16x32_bf16 v[152:155], v[44:47], v[232:235], 0
  s_add_u32 s26, s26, 1024
  ds_read_b64_tr_b16 v[88:89], v12 offset:8960
  v_accvgpr_read_b32 v23, a39
  v_mfma_f32_16x16x32_bf16 v[168:171], v[48:51], v[232:235], 0
  ds_read_b64_tr_b16 v[90:91], v12 offset:9984
  v_cvt_pk_bf16_f32 v28, v16, v17
  v_mfma_f32_16x16x32_bf16 v[184:187], v[52:55], v[232:235], 0
  ds_read_b64_tr_b16 v[92:93], v13 offset:8960
  v_cvt_pk_bf16_f32 v29, v18, v19
  v_mfma_f32_16x16x32_bf16 v[200:203], v[56:59], v[232:235], 0
  ds_read_b64_tr_b16 v[94:95], v13 offset:9984
  v_cvt_pk_bf16_f32 v30, v20, v21
  v_mfma_f32_16x16x32_bf16 v[216:219], v[60:63], v[232:235], 0
  v_cvt_pk_bf16_f32 v31, v22, v23
  v_mfma_f32_16x16x32_bf16 v[108:111], v[32:35], v[236:239], 0
  ds_read_b128 v[248:251], v14 offset:34816
  buffer_store_dwordx4 v[28:31], v2, s[40:43], s63 offen offset:1024 sc1
  v_mfma_f32_16x16x32_bf16 v[124:127], v[36:39], v[236:239], 0
  ds_read_b128 v[252:255], v14 offset:35840
  v_accvgpr_write_b32 a0, 0
  v_mfma_f32_16x16x32_bf16 v[140:143], v[40:43], v[236:239], 0
  v_accvgpr_write_b32 a1, 0
  v_accvgpr_write_b32 a2, 0
  v_mfma_f32_16x16x32_bf16 v[156:159], v[44:47], v[236:239], 0
  v_xor_b32 v14, 0x10000, v14
  v_accvgpr_write_b32 a3, 0
  v_mfma_f32_16x16x32_bf16 v[172:175], v[48:51], v[236:239], 0
  v_accvgpr_write_b32 a32, 0
  v_accvgpr_write_b32 a33, 0
  v_mfma_f32_16x16x32_bf16 v[188:191], v[52:55], v[236:239], 0
  v_accvgpr_write_b32 a34, 0
  v_accvgpr_write_b32 a35, 0
  v_mfma_f32_16x16x32_bf16 v[204:207], v[56:59], v[236:239], 0
  v_mfma_f32_16x16x32_bf16 v[220:223], v[60:63], v[236:239], 0
  s_waitcnt vmcnt(19) lgkmcnt(0)
  v_mfma_f32_16x16x32_bf16 v[96:99], v[64:67], v[240:243], v[96:99]
  s_barrier
  v_accvgpr_read_b32 v16, a8
  v_accvgpr_read_b32 v17, a9
  v_mfma_f32_16x16x32_bf16 v[112:115], v[68:71], v[240:243], v[112:115]
  s_add_u32 s63, s63, s61
  ds_read_b64_tr_b16 v[32:33], v12 offset:32768
  v_accvgpr_read_b32 v18, a10
  v_mfma_f32_16x16x32_bf16 v[128:131], v[72:75], v[240:243], v[128:131]
  s_add_u32 m0, s24, 32768
  ds_read_b64_tr_b16 v[34:35], v12 offset:33792
  v_accvgpr_read_b32 v19, a11
  v_mfma_f32_16x16x32_bf16 v[144:147], v[76:79], v[240:243], v[144:147]
  buffer_load_dwordx4 v3, s[32:35], s26 offen offset:0 sc1 lds
  v_accvgpr_read_b32 v20, a40
  v_mfma_f32_16x16x32_bf16 v[160:163], v[80:83], v[240:243], v[160:163]
  ds_read_b64_tr_b16 v[36:37], v13 offset:32768
  v_accvgpr_read_b32 v21, a41
  v_mfma_f32_16x16x32_bf16 v[176:179], v[84:87], v[240:243], v[176:179]
  ds_read_b64_tr_b16 v[38:39], v13 offset:33792
  v_accvgpr_read_b32 v22, a42
  v_mfma_f32_16x16x32_bf16 v[192:195], v[88:91], v[240:243], v[192:195]
  ds_read_b64_tr_b16 v[40:41], v12 offset:33024
  v_accvgpr_read_b32 v23, a43
  v_mfma_f32_16x16x32_bf16 v[208:211], v[92:95], v[240:243], v[208:211]
  ds_read_b64_tr_b16 v[42:43], v12 offset:34048
  v_cvt_pk_bf16_f32 v24, v16, v17
  v_mfma_f32_16x16x32_bf16 v[100:103], v[64:67], v[244:247], v[100:103]
  buffer_load_dwordx4 v4, s[32:35], s26 offen offset:1024 sc1 lds
  v_cvt_pk_bf16_f32 v25, v18, v19
  v_mfma_f32_16x16x32_bf16 v[116:119], v[68:71], v[244:247], v[116:119]
  ds_read_b64_tr_b16 v[44:45], v13 offset:33024
  v_cvt_pk_bf16_f32 v26, v20, v21
  v_mfma_f32_16x16x32_bf16 v[132:135], v[72:75], v[244:247], v[132:135]
  ds_read_b64_tr_b16 v[46:47], v13 offset:34048
  v_cvt_pk_bf16_f32 v27, v22, v23
  v_mfma_f32_16x16x32_bf16 v[148:151], v[76:79], v[244:247], v[148:151]
  ds_read_b128 v[224:227], v14 offset:0
  buffer_store_dwordx4 v[24:27], v2, s[40:43], s63 offen offset:0 sc1
  v_mfma_f32_16x16x32_bf16 v[164:167], v[80:83], v[244:247], v[164:167]
  ds_read_b128 v[228:231], v14 offset:1024
  v_accvgpr_read_b32 v16, a12
  v_mfma_f32_16x16x32_bf16 v[180:183], v[84:87], v[244:247], v[180:183]
  buffer_load_dwordx4 v5, s[32:35], s26 offen offset:2048 sc1 lds
  v_accvgpr_read_b32 v17, a13
  v_mfma_f32_16x16x32_bf16 v[196:199], v[88:91], v[244:247], v[196:199]
  ds_read_b64_tr_b16 v[48:49], v12 offset:33280
  v_accvgpr_read_b32 v18, a14
  v_mfma_f32_16x16x32_bf16 v[212:215], v[92:95], v[244:247], v[212:215]
  ds_read_b64_tr_b16 v[50:51], v12 offset:34304
  v_accvgpr_read_b32 v19, a15
  v_mfma_f32_16x16x32_bf16 v[104:107], v[64:67], v[248:251], v[104:107]
  ds_read_b64_tr_b16 v[52:53], v13 offset:33280
  v_accvgpr_read_b32 v20, a44
  v_mfma_f32_16x16x32_bf16 v[120:123], v[68:71], v[248:251], v[120:123]
  ds_read_b64_tr_b16 v[54:55], v13 offset:34304
  v_accvgpr_read_b32 v21, a45
  v_mfma_f32_16x16x32_bf16 v[136:139], v[72:75], v[248:251], v[136:139]
  buffer_load_dwordx4 v6, s[32:35], s26 offen offset:3072 sc1 lds
  v_accvgpr_read_b32 v22, a46
  v_mfma_f32_16x16x32_bf16 v[152:155], v[76:79], v[248:251], v[152:155]
  s_add_u32 s26, s26, 1024
  ds_read_b64_tr_b16 v[56:57], v12 offset:33536
  v_accvgpr_read_b32 v23, a47
  v_mfma_f32_16x16x32_bf16 v[168:171], v[80:83], v[248:251], v[168:171]
  ds_read_b64_tr_b16 v[58:59], v12 offset:34560
  v_cvt_pk_bf16_f32 v28, v16, v17
  v_mfma_f32_16x16x32_bf16 v[184:187], v[84:87], v[248:251], v[184:187]
  ds_read_b64_tr_b16 v[60:61], v13 offset:33536
  v_cvt_pk_bf16_f32 v29, v18, v19
  v_mfma_f32_16x16x32_bf16 v[200:203], v[88:91], v[248:251], v[200:203]
  s_add_u32 m0, s24, 16384
  ds_read_b64_tr_b16 v[62:63], v13 offset:34560
  v_cvt_pk_bf16_f32 v30, v20, v21
  v_mfma_f32_16x16x32_bf16 v[216:219], v[92:95], v[248:251], v[216:219]
  buffer_load_dwordx4 v8, s[36:39], s27 offen offset:0 lds
  v_cvt_pk_bf16_f32 v31, v22, v23
  v_mfma_f32_16x16x32_bf16 v[108:111], v[64:67], v[252:255], v[108:111]
  ds_read_b128 v[232:235], v14 offset:2048
  buffer_store_dwordx4 v[28:31], v2, s[40:43], s63 offen offset:1024 sc1
  v_mfma_f32_16x16x32_bf16 v[124:127], v[68:71], v[252:255], v[124:127]
  ds_read_b128 v[236:239], v14 offset:3072
  v_accvgpr_write_b32 a4, 0
  v_mfma_f32_16x16x32_bf16 v[140:143], v[72:75], v[252:255], v[140:143]
  v_accvgpr_write_b32 a5, 0
  v_accvgpr_write_b32 a6, 0
  v_mfma_f32_16x16x32_bf16 v[156:159], v[76:79], v[252:255], v[156:159]
  v_accvgpr_write_b32 a7, 0
  v_accvgpr_write_b32 a36, 0
  v_mfma_f32_16x16x32_bf16 v[172:175], v[80:83], v[252:255], v[172:175]
  buffer_load_dwordx4 v9, s[36:39], s27 offen offset:1024 lds
  v_accvgpr_write_b32 a37, 0
  v_mfma_f32_16x16x32_bf16 v[188:191], v[84:87], v[252:255], v[188:191]
  v_accvgpr_write_b32 a38, 0
  v_mfma_f32_16x16x32_bf16 v[204:207], v[88:91], v[252:255], v[204:207]
  v_mfma_f32_16x16x32_bf16 v[220:223], v[92:95], v[252:255], v[220:223]
  s_waitcnt vmcnt(18) lgkmcnt(0)
  v_mfma_f32_16x16x32_bf16 v[96:99], v[32:35], v[224:227], v[96:99]
  s_add_u32 s63, s63, s61
  v_accvgpr_read_b32 v16, a16
  v_accvgpr_read_b32 v17, a17
  v_mfma_f32_16x16x32_bf16 v[112:115], v[36:39], v[224:227], v[112:115]
  ds_read_b64_tr_b16 v[64:65], v12 offset:40960
  v_accvgpr_read_b32 v18, a18
  v_mfma_f32_16x16x32_bf16 v[128:131], v[40:43], v[224:227], v[128:131]
  s_add_u32 m0, s24, 65536
  ds_read_b64_tr_b16 v[66:67], v12 offset:41984
  v_accvgpr_read_b32 v19, a19
  v_mfma_f32_16x16x32_bf16 v[144:147], v[44:47], v[224:227], v[144:147]
  buffer_load_dwordx4 v3, s[32:35], s26 offen offset:0 sc1 lds
  v_accvgpr_read_b32 v20, a48
  v_mfma_f32_16x16x32_bf16 v[160:163], v[48:51], v[224:227], v[160:163]
  ds_read_b64_tr_b16 v[68:69], v13 offset:40960
  v_accvgpr_read_b32 v21, a49
  v_mfma_f32_16x16x32_bf16 v[176:179], v[52:55], v[224:227], v[176:179]
  ds_read_b64_tr_b16 v[70:71], v13 offset:41984
  v_accvgpr_read_b32 v22, a50
  v_mfma_f32_16x16x32_bf16 v[192:195], v[56:59], v[224:227], v[192:195]
  ds_read_b64_tr_b16 v[72:73], v12 offset:41216
  v_accvgpr_read_b32 v23, a51
  v_mfma_f32_16x16x32_bf16 v[208:211], v[60:63], v[224:227], v[208:211]
  ds_read_b64_tr_b16 v[74:75], v12 offset:42240
  v_cvt_pk_bf16_f32 v24, v16, v17
  v_mfma_f32_16x16x32_bf16 v[100:103], v[32:35], v[228:231], v[100:103]
  buffer_load_dwordx4 v4, s[32:35], s26 offen offset:1024 sc1 lds
  v_cvt_pk_bf16_f32 v25, v18, v19
  v_mfma_f32_16x16x32_bf16 v[116:119], v[36:39], v[228:231], v[116:119]
  ds_read_b64_tr_b16 v[76:77], v13 offset:41216
  v_cvt_pk_bf16_f32 v26, v20, v21
  v_mfma_f32_16x16x32_bf16 v[132:135], v[40:43], v[228:231], v[132:135]
  ds_read_b64_tr_b16 v[78:79], v13 offset:42240
  v_cvt_pk_bf16_f32 v27, v22, v23
  v_mfma_f32_16x16x32_bf16 v[148:151], v[44:47], v[228:231], v[148:151]
  ds_read_b128 v[240:243], v14 offset:32768
  buffer_store_dwordx4 v[24:27], v2, s[40:43], s63 offen offset:0 sc1
  v_mfma_f32_16x16x32_bf16 v[164:167], v[48:51], v[228:231], v[164:167]
  ds_read_b128 v[244:247], v14 offset:33792
  v_accvgpr_read_b32 v16, a20
  v_mfma_f32_16x16x32_bf16 v[180:183], v[52:55], v[228:231], v[180:183]
  buffer_load_dwordx4 v5, s[32:35], s26 offen offset:2048 sc1 lds
  v_accvgpr_read_b32 v17, a21
  v_mfma_f32_16x16x32_bf16 v[196:199], v[56:59], v[228:231], v[196:199]
  ds_read_b64_tr_b16 v[80:81], v12 offset:41472
  v_accvgpr_read_b32 v18, a22
  v_mfma_f32_16x16x32_bf16 v[212:215], v[60:63], v[228:231], v[212:215]
  ds_read_b64_tr_b16 v[82:83], v12 offset:42496
  v_accvgpr_read_b32 v19, a23
  v_mfma_f32_16x16x32_bf16 v[104:107], v[32:35], v[232:235], v[104:107]
  ds_read_b64_tr_b16 v[84:85], v13 offset:41472
  v_accvgpr_read_b32 v20, a52
  v_mfma_f32_16x16x32_bf16 v[120:123], v[36:39], v[232:235], v[120:123]
  ds_read_b64_tr_b16 v[86:87], v13 offset:42496
  v_accvgpr_read_b32 v21, a53
  v_mfma_f32_16x16x32_bf16 v[136:139], v[40:43], v[232:235], v[136:139]
  buffer_load_dwordx4 v6, s[32:35], s26 offen offset:3072 sc1 lds
  v_accvgpr_read_b32 v22, a54
  v_mfma_f32_16x16x32_bf16 v[152:155], v[44:47], v[232:235], v[152:155]
  s_add_u32 s26, s26, 1024
  ds_read_b64_tr_b16 v[88:89], v12 offset:41728
  v_accvgpr_read_b32 v23, a55
  v_mfma_f32_16x16x32_bf16 v[168:171], v[48:51], v[232:235], v[168:171]
  ds_read_b64_tr_b16 v[90:91], v12 offset:42752
  v_cvt_pk_bf16_f32 v28, v16, v17
  v_mfma_f32_16x16x32_bf16 v[184:187], v[52:55], v[232:235], v[184:187]
  ds_read_b64_tr_b16 v[92:93], v13 offset:41728
  v_cvt_pk_bf16_f32 v29, v18, v19
  v_mfma_f32_16x16x32_bf16 v[200:203], v[56:59], v[232:235], v[200:203]
  s_add_u32 m0, s24, 16384
  ds_read_b64_tr_b16 v[94:95], v13 offset:42752
  v_cvt_pk_bf16_f32 v30, v20, v21
  v_mfma_f32_16x16x32_bf16 v[216:219], v[60:63], v[232:235], v[216:219]
  buffer_load_dwordx4 v10, s[36:39], s27 offen offset:2048 lds
  v_cvt_pk_bf16_f32 v31, v22, v23
  v_mfma_f32_16x16x32_bf16 v[108:111], v[32:35], v[236:239], v[108:111]
  ds_read_b128 v[248:251], v14 offset:34816
  buffer_store_dwordx4 v[28:31], v2, s[40:43], s63 offen offset:1024 sc1
  v_mfma_f32_16x16x32_bf16 v[124:127], v[36:39], v[236:239], v[124:127]
  ds_read_b128 v[252:255], v14 offset:35840
  v_accvgpr_write_b32 a39, 0
  v_mfma_f32_16x16x32_bf16 v[140:143], v[40:43], v[236:239], v[140:143]
  v_accvgpr_write_b32 a8, 0
  v_accvgpr_write_b32 a9, 0
  v_mfma_f32_16x16x32_bf16 v[156:159], v[44:47], v[236:239], v[156:159]
  v_xor_b32 v14, 0x10000, v14
  v_accvgpr_write_b32 a10, 0
  v_mfma_f32_16x16x32_bf16 v[172:175], v[48:51], v[236:239], v[172:175]
  buffer_load_dwordx4 v11, s[36:39], s27 offen offset:3072 lds
  v_mfma_f32_16x16x32_bf16 v[188:191], v[52:55], v[236:239], v[188:191]
  s_add_u32 s27, s27, 524288
  v_xor_b32 v12, 0x10000, v12
  v_mfma_f32_16x16x32_bf16 v[204:207], v[56:59], v[236:239], v[204:207]
  v_xor_b32 v13, 0x10000, v13
  v_mfma_f32_16x16x32_bf16 v[220:223], v[60:63], v[236:239], v[220:223]
  s_waitcnt vmcnt(17) lgkmcnt(0)
  v_mfma_f32_16x16x32_bf16 v[96:99], v[64:67], v[240:243], v[96:99]
  s_barrier
  v_accvgpr_read_b32 v16, a24
  v_accvgpr_read_b32 v17, a25
  v_mfma_f32_16x16x32_bf16 v[112:115], v[68:71], v[240:243], v[112:115]
  s_add_u32 s63, s63, s61
  ds_read_b64_tr_b16 v[32:33], v12 offset:0
  v_accvgpr_read_b32 v18, a26
  v_mfma_f32_16x16x32_bf16 v[128:131], v[72:75], v[240:243], v[128:131]
  s_add_u32 m0, s24, 98304
  ds_read_b64_tr_b16 v[34:35], v12 offset:1024
  v_accvgpr_read_b32 v19, a27
  v_mfma_f32_16x16x32_bf16 v[144:147], v[76:79], v[240:243], v[144:147]
  buffer_load_dwordx4 v3, s[32:35], s26 offen offset:0 sc1 lds
  v_accvgpr_read_b32 v20, a56
  v_mfma_f32_16x16x32_bf16 v[160:163], v[80:83], v[240:243], v[160:163]
  ds_read_b64_tr_b16 v[36:37], v13 offset:0
  v_accvgpr_read_b32 v21, a57
  v_mfma_f32_16x16x32_bf16 v[176:179], v[84:87], v[240:243], v[176:179]
  ds_read_b64_tr_b16 v[38:39], v13 offset:1024
  v_accvgpr_read_b32 v22, a58
  v_mfma_f32_16x16x32_bf16 v[192:195], v[88:91], v[240:243], v[192:195]
  ds_read_b64_tr_b16 v[40:41], v12 offset:256
  v_accvgpr_read_b32 v23, a59
  v_mfma_f32_16x16x32_bf16 v[208:211], v[92:95], v[240:243], v[208:211]
  ds_read_b64_tr_b16 v[42:43], v12 offset:1280
  v_cvt_pk_bf16_f32 v24, v16, v17
  v_mfma_f32_16x16x32_bf16 v[100:103], v[64:67], v[244:247], v[100:103]
  buffer_load_dwordx4 v4, s[32:35], s26 offen offset:1024 sc1 lds
  v_cvt_pk_bf16_f32 v25, v18, v19
  v_mfma_f32_16x16x32_bf16 v[116:119], v[68:71], v[244:247], v[116:119]
  ds_read_b64_tr_b16 v[44:45], v13 offset:256
  v_cvt_pk_bf16_f32 v26, v20, v21
  v_mfma_f32_16x16x32_bf16 v[132:135], v[72:75], v[244:247], v[132:135]
  ds_read_b64_tr_b16 v[46:47], v13 offset:1280
  v_cvt_pk_bf16_f32 v27, v22, v23
  v_mfma_f32_16x16x32_bf16 v[148:151], v[76:79], v[244:247], v[148:151]
  ds_read_b128 v[224:227], v14 offset:0
  buffer_store_dwordx4 v[24:27], v2, s[40:43], s63 offen offset:0 sc1
  v_mfma_f32_16x16x32_bf16 v[164:167], v[80:83], v[244:247], v[164:167]
  ds_read_b128 v[228:231], v14 offset:1024
  v_accvgpr_read_b32 v16, a28
  v_mfma_f32_16x16x32_bf16 v[180:183], v[84:87], v[244:247], v[180:183]
  buffer_load_dwordx4 v5, s[32:35], s26 offen offset:2048 sc1 lds
  v_accvgpr_read_b32 v17, a29
  v_mfma_f32_16x16x32_bf16 v[196:199], v[88:91], v[244:247], v[196:199]
  ds_read_b64_tr_b16 v[48:49], v12 offset:512
  v_accvgpr_read_b32 v18, a30
  v_mfma_f32_16x16x32_bf16 v[212:215], v[92:95], v[244:247], v[212:215]
  ds_read_b64_tr_b16 v[50:51], v12 offset:1536
  v_accvgpr_read_b32 v19, a31
  v_mfma_f32_16x16x32_bf16 v[104:107], v[64:67], v[248:251], v[104:107]
  ds_read_b64_tr_b16 v[52:53], v13 offset:512
  v_accvgpr_read_b32 v20, a60
  v_mfma_f32_16x16x32_bf16 v[120:123], v[68:71], v[248:251], v[120:123]
  ds_read_b64_tr_b16 v[54:55], v13 offset:1536
  v_accvgpr_read_b32 v21, a61
  v_mfma_f32_16x16x32_bf16 v[136:139], v[72:75], v[248:251], v[136:139]
  buffer_load_dwordx4 v6, s[32:35], s26 offen offset:3072 sc1 lds
  v_accvgpr_read_b32 v22, a62
  v_mfma_f32_16x16x32_bf16 v[152:155], v[76:79], v[248:251], v[152:155]
  s_add_u32 s26, s26, 1024
  ds_read_b64_tr_b16 v[56:57], v12 offset:768
  v_accvgpr_read_b32 v23, a63
  v_mfma_f32_16x16x32_bf16 v[168:171], v[80:83], v[248:251], v[168:171]
  ds_read_b64_tr_b16 v[58:59], v12 offset:1792
  v_cvt_pk_bf16_f32 v28, v16, v17
  v_mfma_f32_16x16x32_bf16 v[184:187], v[84:87], v[248:251], v[184:187]
  ds_read_b64_tr_b16 v[60:61], v13 offset:768
  v_cvt_pk_bf16_f32 v29, v18, v19
  v_mfma_f32_16x16x32_bf16 v[200:203], v[88:91], v[248:251], v[200:203]
  s_add_u32 m0, s24, 49152
  ds_read_b64_tr_b16 v[62:63], v13 offset:1792
  v_cvt_pk_bf16_f32 v30, v20, v21
  v_mfma_f32_16x16x32_bf16 v[216:219], v[92:95], v[248:251], v[216:219]
  buffer_load_dwordx4 v8, s[36:39], s27 offen offset:0 lds
  v_cvt_pk_bf16_f32 v31, v22, v23
  v_mfma_f32_16x16x32_bf16 v[108:111], v[64:67], v[252:255], v[108:111]
  ds_read_b128 v[232:235], v14 offset:2048
  buffer_store_dwordx4 v[28:31], v2, s[40:43], s63 offen offset:1024 sc1
  v_mfma_f32_16x16x32_bf16 v[124:127], v[68:71], v[252:255], v[124:127]
  ds_read_b128 v[236:239], v14 offset:3072
  v_accvgpr_write_b32 a11, 0
  v_mfma_f32_16x16x32_bf16 v[140:143], v[72:75], v[252:255], v[140:143]
  v_accvgpr_write_b32 a40, 0
  v_accvgpr_write_b32 a41, 0
  v_mfma_f32_16x16x32_bf16 v[156:159], v[76:79], v[252:255], v[156:159]
  v_accvgpr_write_b32 a42, 0
  v_accvgpr_write_b32 a43, 0
  v_mfma_f32_16x16x32_bf16 v[172:175], v[80:83], v[252:255], v[172:175]
  buffer_load_dwordx4 v9, s[36:39], s27 offen offset:1024 lds
  v_accvgpr_write_b32 a12, 0
  v_mfma_f32_16x16x32_bf16 v[188:191], v[84:87], v[252:255], v[188:191]
  v_accvgpr_write_b32 a13, 0
  v_mfma_f32_16x16x32_bf16 v[204:207], v[88:91], v[252:255], v[204:207]
  v_mfma_f32_16x16x32_bf16 v[220:223], v[92:95], v[252:255], v[220:223]
  s_waitcnt vmcnt(19) lgkmcnt(0)
  v_mfma_f32_16x16x32_bf16 v[96:99], v[32:35], v[224:227], v[96:99]
  s_mul_i32 s63, s60, 1
  v_accvgpr_read_b32 v16, a64
  v_accvgpr_read_b32 v17, a65
  v_mfma_f32_16x16x32_bf16 v[112:115], v[36:39], v[224:227], v[112:115]
  s_add_u32 s63, s63, s62
  ds_read_b64_tr_b16 v[64:65], v12 offset:8192
  v_accvgpr_read_b32 v18, a66
  v_mfma_f32_16x16x32_bf16 v[128:131], v[40:43], v[224:227], v[128:131]
  s_add_u32 m0, s24, 0
  ds_read_b64_tr_b16 v[66:67], v12 offset:9216
  v_accvgpr_read_b32 v19, a67
  v_mfma_f32_16x16x32_bf16 v[144:147], v[44:47], v[224:227], v[144:147]
  buffer_load_dwordx4 v3, s[32:35], s26 offen offset:0 sc1 lds
  v_accvgpr_read_b32 v20, a96
  v_mfma_f32_16x16x32_bf16 v[160:163], v[48:51], v[224:227], v[160:163]
  ds_read_b64_tr_b16 v[68:69], v13 offset:8192
  v_accvgpr_read_b32 v21, a97
  v_mfma_f32_16x16x32_bf16 v[176:179], v[52:55], v[224:227], v[176:179]
  ds_read_b64_tr_b16 v[70:71], v13 offset:9216
  v_accvgpr_read_b32 v22, a98
  v_mfma_f32_16x16x32_bf16 v[192:195], v[56:59], v[224:227], v[192:195]
  ds_read_b64_tr_b16 v[72:73], v12 offset:8448
  v_accvgpr_read_b32 v23, a99
  v_mfma_f32_16x16x32_bf16 v[208:211], v[60:63], v[224:227], v[208:211]
  ds_read_b64_tr_b16 v[74:75], v12 offset:9472
  v_cvt_pk_bf16_f32 v24, v16, v17
  v_mfma_f32_16x16x32_bf16 v[100:103], v[32:35], v[228:231], v[100:103]
  buffer_load_dwordx4 v4, s[32:35], s26 offen offset:1024 sc1 lds
  v_cvt_pk_bf16_f32 v25, v18, v19
  v_mfma_f32_16x16x32_bf16 v[116:119], v[36:39], v[228:231], v[116:119]
  ds_read_b64_tr_b16 v[76:77], v13 offset:8448
  v_cvt_pk_bf16_f32 v26, v20, v21
  v_mfma_f32_16x16x32_bf16 v[132:135], v[40:43], v[228:231], v[132:135]
  ds_read_b64_tr_b16 v[78:79], v13 offset:9472
  v_cvt_pk_bf16_f32 v27, v22, v23
  v_mfma_f32_16x16x32_bf16 v[148:151], v[44:47], v[228:231], v[148:151]
  ds_read_b128 v[240:243], v14 offset:32768
  buffer_store_dwordx4 v[24:27], v2, s[40:43], s63 offen offset:0 sc1
  v_mfma_f32_16x16x32_bf16 v[164:167], v[48:51], v[228:231], v[164:167]
  ds_read_b128 v[244:247], v14 offset:33792
  v_accvgpr_read_b32 v16, a68
  v_mfma_f32_16x16x32_bf16 v[180:183], v[52:55], v[228:231], v[180:183]
  buffer_load_dwordx4 v5, s[32:35], s26 offen offset:2048 sc1 lds
  v_accvgpr_read_b32 v17, a69
  v_mfma_f32_16x16x32_bf16 v[196:199], v[56:59], v[228:231], v[196:199]
  ds_read_b64_tr_b16 v[80:81], v12 offset:8704
  v_accvgpr_read_b32 v18, a70
  v_mfma_f32_16x16x32_bf16 v[212:215], v[60:63], v[228:231], v[212:215]
  ds_read_b64_tr_b16 v[82:83], v12 offset:9728
  v_accvgpr_read_b32 v19, a71
  v_mfma_f32_16x16x32_bf16 v[104:107], v[32:35], v[232:235], v[104:107]
  ds_read_b64_tr_b16 v[84:85], v13 offset:8704
  v_accvgpr_read_b32 v20, a100
  v_mfma_f32_16x16x32_bf16 v[120:123], v[36:39], v[232:235], v[120:123]
  ds_read_b64_tr_b16 v[86:87], v13 offset:9728
  v_accvgpr_read_b32 v21, a101
  v_mfma_f32_16x16x32_bf16 v[136:139], v[40:43], v[232:235], v[136:139]
  buffer_load_dwordx4 v6, s[32:35], s26 offen offset:3072 sc1 lds
  v_accvgpr_read_b32 v22, a102
  v_mfma_f32_16x16x32_bf16 v[152:155], v[44:47], v[232:235], v[152:155]
  s_add_u32 s26, s26, 1024
  ds_read_b64_tr_b16 v[88:89], v12 offset:8960
  v_accvgpr_read_b32 v23, a103
  v_mfma_f32_16x16x32_bf16 v[168:171], v[48:51], v[232:235], v[168:171]
  ds_read_b64_tr_b16 v[90:91], v12 offset:9984
  v_cvt_pk_bf16_f32 v28, v16, v17
  v_mfma_f32_16x16x32_bf16 v[184:187], v[52:55], v[232:235], v[184:187]
  ds_read_b64_tr_b16 v[92:93], v13 offset:8960
  v_cvt_pk_bf16_f32 v29, v18, v19
  v_mfma_f32_16x16x32_bf16 v[200:203], v[56:59], v[232:235], v[200:203]
  s_add_u32 m0, s24, 49152
  ds_read_b64_tr_b16 v[94:95], v13 offset:9984
  v_cvt_pk_bf16_f32 v30, v20, v21
  v_mfma_f32_16x16x32_bf16 v[216:219], v[60:63], v[232:235], v[216:219]
  buffer_load_dwordx4 v10, s[36:39], s27 offen offset:2048 lds
  v_cvt_pk_bf16_f32 v31, v22, v23
  v_mfma_f32_16x16x32_bf16 v[108:111], v[32:35], v[236:239], v[108:111]
  ds_read_b128 v[248:251], v14 offset:34816
  buffer_store_dwordx4 v[28:31], v2, s[40:43], s63 offen offset:1024 sc1
  v_mfma_f32_16x16x32_bf16 v[124:127], v[36:39], v[236:239], v[124:127]
  ds_read_b128 v[252:255], v14 offset:35840
  v_accvgpr_write_b32 a14, 0
  v_mfma_f32_16x16x32_bf16 v[140:143], v[40:43], v[236:239], v[140:143]
  v_accvgpr_write_b32 a15, 0
  v_accvgpr_write_b32 a44, 0
  v_mfma_f32_16x16x32_bf16 v[156:159], v[44:47], v[236:239], v[156:159]
  v_xor_b32 v14, 0x10000, v14
  v_accvgpr_write_b32 a45, 0
  v_mfma_f32_16x16x32_bf16 v[172:175], v[48:51], v[236:239], v[172:175]
  buffer_load_dwordx4 v11, s[36:39], s27 offen offset:3072 lds
  v_accvgpr_write_b32 a46, 0
  v_mfma_f32_16x16x32_bf16 v[188:191], v[52:55], v[236:239], v[188:191]
  s_add_u32 s27, s27, 524288
  v_accvgpr_write_b32 a47, 0
  v_mfma_f32_16x16x32_bf16 v[204:207], v[56:59], v[236:239], v[204:207]
  v_mfma_f32_16x16x32_bf16 v[220:223], v[60:63], v[236:239], v[220:223]
  s_waitcnt vmcnt(19) lgkmcnt(0)
  v_mfma_f32_16x16x32_bf16 v[96:99], v[64:67], v[240:243], v[96:99]
  s_barrier
  v_accvgpr_read_b32 v16, a72
  v_accvgpr_read_b32 v17, a73
  v_mfma_f32_16x16x32_bf16 v[112:115], v[68:71], v[240:243], v[112:115]
  s_add_u32 s63, s63, s61
  ds_read_b64_tr_b16 v[32:33], v12 offset:32768
  v_accvgpr_read_b32 v18, a74
  v_mfma_f32_16x16x32_bf16 v[128:131], v[72:75], v[240:243], v[128:131]
  s_add_u32 m0, s24, 32768
  ds_read_b64_tr_b16 v[34:35], v12 offset:33792
  v_accvgpr_read_b32 v19, a75
  v_mfma_f32_16x16x32_bf16 v[144:147], v[76:79], v[240:243], v[144:147]
  buffer_load_dwordx4 v3, s[32:35], s26 offen offset:0 sc1 lds
  v_accvgpr_read_b32 v20, a104
  v_mfma_f32_16x16x32_bf16 v[160:163], v[80:83], v[240:243], v[160:163]
  ds_read_b64_tr_b16 v[36:37], v13 offset:32768
  v_accvgpr_read_b32 v21, a105
  v_mfma_f32_16x16x32_bf16 v[176:179], v[84:87], v[240:243], v[176:179]
  ds_read_b64_tr_b16 v[38:39], v13 offset:33792
  v_accvgpr_read_b32 v22, a106
  v_mfma_f32_16x16x32_bf16 v[192:195], v[88:91], v[240:243], v[192:195]
  ds_read_b64_tr_b16 v[40:41], v12 offset:33024
  v_accvgpr_read_b32 v23, a107
  v_mfma_f32_16x16x32_bf16 v[208:211], v[92:95], v[240:243], v[208:211]
  ds_read_b64_tr_b16 v[42:43], v12 offset:34048
  v_cvt_pk_bf16_f32 v24, v16, v17
  v_mfma_f32_16x16x32_bf16 v[100:103], v[64:67], v[244:247], v[100:103]
  buffer_load_dwordx4 v4, s[32:35], s26 offen offset:1024 sc1 lds
  v_cvt_pk_bf16_f32 v25, v18, v19
  v_mfma_f32_16x16x32_bf16 v[116:119], v[68:71], v[244:247], v[116:119]
  ds_read_b64_tr_b16 v[44:45], v13 offset:33024
  v_cvt_pk_bf16_f32 v26, v20, v21
  v_mfma_f32_16x16x32_bf16 v[132:135], v[72:75], v[244:247], v[132:135]
  ds_read_b64_tr_b16 v[46:47], v13 offset:34048
  v_cvt_pk_bf16_f32 v27, v22, v23
  v_mfma_f32_16x16x32_bf16 v[148:151], v[76:79], v[244:247], v[148:151]
  ds_read_b128 v[224:227], v14 offset:0
  buffer_store_dwordx4 v[24:27], v2, s[40:43], s63 offen offset:0 sc1
  v_mfma_f32_16x16x32_bf16 v[164:167], v[80:83], v[244:247], v[164:167]
  ds_read_b128 v[228:231], v14 offset:1024
  v_accvgpr_read_b32 v16, a76
  v_mfma_f32_16x16x32_bf16 v[180:183], v[84:87], v[244:247], v[180:183]
  buffer_load_dwordx4 v5, s[32:35], s26 offen offset:2048 sc1 lds
  v_accvgpr_read_b32 v17, a77
  v_mfma_f32_16x16x32_bf16 v[196:199], v[88:91], v[244:247], v[196:199]
  ds_read_b64_tr_b16 v[48:49], v12 offset:33280
  v_accvgpr_read_b32 v18, a78
  v_mfma_f32_16x16x32_bf16 v[212:215], v[92:95], v[244:247], v[212:215]
  ds_read_b64_tr_b16 v[50:51], v12 offset:34304
  v_accvgpr_read_b32 v19, a79
  v_mfma_f32_16x16x32_bf16 v[104:107], v[64:67], v[248:251], v[104:107]
  ds_read_b64_tr_b16 v[52:53], v13 offset:33280
  v_accvgpr_read_b32 v20, a108
  v_mfma_f32_16x16x32_bf16 v[120:123], v[68:71], v[248:251], v[120:123]
  ds_read_b64_tr_b16 v[54:55], v13 offset:34304
  v_accvgpr_read_b32 v21, a109
  v_mfma_f32_16x16x32_bf16 v[136:139], v[72:75], v[248:251], v[136:139]
  buffer_load_dwordx4 v6, s[32:35], s26 offen offset:3072 sc1 lds
  v_accvgpr_read_b32 v22, a110
  v_mfma_f32_16x16x32_bf16 v[152:155], v[76:79], v[248:251], v[152:155]
  s_add_u32 s26, s26, 1024
  ds_read_b64_tr_b16 v[56:57], v12 offset:33536
  v_accvgpr_read_b32 v23, a111
  v_mfma_f32_16x16x32_bf16 v[168:171], v[80:83], v[248:251], v[168:171]
  ds_read_b64_tr_b16 v[58:59], v12 offset:34560
  v_cvt_pk_bf16_f32 v28, v16, v17
  v_mfma_f32_16x16x32_bf16 v[184:187], v[84:87], v[248:251], v[184:187]
  ds_read_b64_tr_b16 v[60:61], v13 offset:33536
  v_cvt_pk_bf16_f32 v29, v18, v19
  v_mfma_f32_16x16x32_bf16 v[200:203], v[88:91], v[248:251], v[200:203]
  s_add_u32 m0, s24, 81920
  ds_read_b64_tr_b16 v[62:63], v13 offset:34560
  v_cvt_pk_bf16_f32 v30, v20, v21
  v_mfma_f32_16x16x32_bf16 v[216:219], v[92:95], v[248:251], v[216:219]
  buffer_load_dwordx4 v8, s[36:39], s27 offen offset:0 lds
  v_cvt_pk_bf16_f32 v31, v22, v23
  v_mfma_f32_16x16x32_bf16 v[108:111], v[64:67], v[252:255], v[108:111]
  ds_read_b128 v[232:235], v14 offset:2048
  buffer_store_dwordx4 v[28:31], v2, s[40:43], s63 offen offset:1024 sc1
  v_mfma_f32_16x16x32_bf16 v[124:127], v[68:71], v[252:255], v[124:127]
  ds_read_b128 v[236:239], v14 offset:3072
  v_accvgpr_write_b32 a16, 0
  v_mfma_f32_16x16x32_bf16 v[140:143], v[72:75], v[252:255], v[140:143]
  v_accvgpr_write_b32 a17, 0
  v_accvgpr_write_b32 a18, 0
  v_mfma_f32_16x16x32_bf16 v[156:159], v[76:79], v[252:255], v[156:159]
  v_accvgpr_write_b32 a19, 0
  v_accvgpr_write_b32 a48, 0
  v_mfma_f32_16x16x32_bf16 v[172:175], v[80:83], v[252:255], v[172:175]
  buffer_load_dwordx4 v9, s[36:39], s27 offen offset:1024 lds
  v_accvgpr_write_b32 a49, 0
  v_mfma_f32_16x16x32_bf16 v[188:191], v[84:87], v[252:255], v[188:191]
  v_accvgpr_write_b32 a50, 0
  v_mfma_f32_16x16x32_bf16 v[204:207], v[88:91], v[252:255], v[204:207]
  v_mfma_f32_16x16x32_bf16 v[220:223], v[92:95], v[252:255], v[220:223]
  s_waitcnt vmcnt(19) lgkmcnt(0)
  v_mfma_f32_16x16x32_bf16 v[96:99], v[32:35], v[224:227], v[96:99]
  s_add_u32 s63, s63, s61
  v_accvgpr_read_b32 v16, a80
  v_accvgpr_read_b32 v17, a81
  v_mfma_f32_16x16x32_bf16 v[112:115], v[36:39], v[224:227], v[112:115]
  ds_read_b64_tr_b16 v[64:65], v12 offset:40960
  v_accvgpr_read_b32 v18, a82
  v_mfma_f32_16x16x32_bf16 v[128:131], v[40:43], v[224:227], v[128:131]
  s_add_u32 m0, s24, 65536
  ds_read_b64_tr_b16 v[66:67], v12 offset:41984
  v_accvgpr_read_b32 v19, a83
  v_mfma_f32_16x16x32_bf16 v[144:147], v[44:47], v[224:227], v[144:147]
  buffer_load_dwordx4 v3, s[32:35], s26 offen offset:0 sc1 lds
  v_accvgpr_read_b32 v20, a112
  v_mfma_f32_16x16x32_bf16 v[160:163], v[48:51], v[224:227], v[160:163]
  ds_read_b64_tr_b16 v[68:69], v13 offset:40960
  v_accvgpr_read_b32 v21, a113
  v_mfma_f32_16x16x32_bf16 v[176:179], v[52:55], v[224:227], v[176:179]
  ds_read_b64_tr_b16 v[70:71], v13 offset:41984
  v_accvgpr_read_b32 v22, a114
  v_mfma_f32_16x16x32_bf16 v[192:195], v[56:59], v[224:227], v[192:195]
  ds_read_b64_tr_b16 v[72:73], v12 offset:41216
  v_accvgpr_read_b32 v23, a115
  v_mfma_f32_16x16x32_bf16 v[208:211], v[60:63], v[224:227], v[208:211]
  ds_read_b64_tr_b16 v[74:75], v12 offset:42240
  v_cvt_pk_bf16_f32 v24, v16, v17
  v_mfma_f32_16x16x32_bf16 v[100:103], v[32:35], v[228:231], v[100:103]
  buffer_load_dwordx4 v4, s[32:35], s26 offen offset:1024 sc1 lds
  v_cvt_pk_bf16_f32 v25, v18, v19
  v_mfma_f32_16x16x32_bf16 v[116:119], v[36:39], v[228:231], v[116:119]
  ds_read_b64_tr_b16 v[76:77], v13 offset:41216
  v_cvt_pk_bf16_f32 v26, v20, v21
  v_mfma_f32_16x16x32_bf16 v[132:135], v[40:43], v[228:231], v[132:135]
  ds_read_b64_tr_b16 v[78:79], v13 offset:42240
  v_cvt_pk_bf16_f32 v27, v22, v23
  v_mfma_f32_16x16x32_bf16 v[148:151], v[44:47], v[228:231], v[148:151]
  ds_read_b128 v[240:243], v14 offset:32768
  buffer_store_dwordx4 v[24:27], v2, s[40:43], s63 offen offset:0 sc1
  v_mfma_f32_16x16x32_bf16 v[164:167], v[48:51], v[228:231], v[164:167]
  ds_read_b128 v[244:247], v14 offset:33792
  v_accvgpr_read_b32 v16, a84
  v_mfma_f32_16x16x32_bf16 v[180:183], v[52:55], v[228:231], v[180:183]
  buffer_load_dwordx4 v5, s[32:35], s26 offen offset:2048 sc1 lds
  v_accvgpr_read_b32 v17, a85
  v_mfma_f32_16x16x32_bf16 v[196:199], v[56:59], v[228:231], v[196:199]
  ds_read_b64_tr_b16 v[80:81], v12 offset:41472
  v_accvgpr_read_b32 v18, a86
  v_mfma_f32_16x16x32_bf16 v[212:215], v[60:63], v[228:231], v[212:215]
  ds_read_b64_tr_b16 v[82:83], v12 offset:42496
  v_accvgpr_read_b32 v19, a87
  v_mfma_f32_16x16x32_bf16 v[104:107], v[32:35], v[232:235], v[104:107]
  ds_read_b64_tr_b16 v[84:85], v13 offset:41472
  v_accvgpr_read_b32 v20, a116
  v_mfma_f32_16x16x32_bf16 v[120:123], v[36:39], v[232:235], v[120:123]
  ds_read_b64_tr_b16 v[86:87], v13 offset:42496
  v_accvgpr_read_b32 v21, a117
  v_mfma_f32_16x16x32_bf16 v[136:139], v[40:43], v[232:235], v[136:139]
  buffer_load_dwordx4 v6, s[32:35], s26 offen offset:3072 sc1 lds
  v_accvgpr_read_b32 v22, a118
  v_mfma_f32_16x16x32_bf16 v[152:155], v[44:47], v[232:235], v[152:155]
  s_add_u32 s26, s26, 1024
  ds_read_b64_tr_b16 v[88:89], v12 offset:41728
  v_accvgpr_read_b32 v23, a119
  v_mfma_f32_16x16x32_bf16 v[168:171], v[48:51], v[232:235], v[168:171]
  ds_read_b64_tr_b16 v[90:91], v12 offset:42752
  v_cvt_pk_bf16_f32 v28, v16, v17
  v_mfma_f32_16x16x32_bf16 v[184:187], v[52:55], v[232:235], v[184:187]
  ds_read_b64_tr_b16 v[92:93], v13 offset:41728
  v_cvt_pk_bf16_f32 v29, v18, v19
  v_mfma_f32_16x16x32_bf16 v[200:203], v[56:59], v[232:235], v[200:203]
  s_add_u32 m0, s24, 81920
  ds_read_b64_tr_b16 v[94:95], v13 offset:42752
  v_cvt_pk_bf16_f32 v30, v20, v21
  v_mfma_f32_16x16x32_bf16 v[216:219], v[60:63], v[232:235], v[216:219]
  buffer_load_dwordx4 v10, s[36:39], s27 offen offset:2048 lds
  v_cvt_pk_bf16_f32 v31, v22, v23
  v_mfma_f32_16x16x32_bf16 v[108:111], v[32:35], v[236:239], v[108:111]
  ds_read_b128 v[248:251], v14 offset:34816
  buffer_store_dwordx4 v[28:31], v2, s[40:43], s63 offen offset:1024 sc1
  v_mfma_f32_16x16x32_bf16 v[124:127], v[36:39], v[236:239], v[124:127]
  ds_read_b128 v[252:255], v14 offset:35840
  v_accvgpr_write_b32 a51, 0
  v_mfma_f32_16x16x32_bf16 v[140:143], v[40:43], v[236:239], v[140:143]
  v_accvgpr_write_b32 a20, 0
  v_accvgpr_write_b32 a21, 0
  v_mfma_f32_16x16x32_bf16 v[156:159], v[44:47], v[236:239], v[156:159]
  v_xor_b32 v14, 0x10000, v14
  v_accvgpr_write_b32 a22, 0
  v_mfma_f32_16x16x32_bf16 v[172:175], v[48:51], v[236:239], v[172:175]
  buffer_load_dwordx4 v11, s[36:39], s27 offen offset:3072 lds
  v_mfma_f32_16x16x32_bf16 v[188:191], v[52:55], v[236:239], v[188:191]
  s_add_u32 s27, s27, 524288
  v_xor_b32 v12, 0x10000, v12
  v_mfma_f32_16x16x32_bf16 v[204:207], v[56:59], v[236:239], v[204:207]
  v_xor_b32 v13, 0x10000, v13
  v_mfma_f32_16x16x32_bf16 v[220:223], v[60:63], v[236:239], v[220:223]
  s_waitcnt vmcnt(19) lgkmcnt(0)
  v_mfma_f32_16x16x32_bf16 v[96:99], v[64:67], v[240:243], v[96:99]
  s_barrier
  v_accvgpr_read_b32 v16, a88
  v_accvgpr_read_b32 v17, a89
  v_mfma_f32_16x16x32_bf16 v[112:115], v[68:71], v[240:243], v[112:115]
  s_add_u32 s63, s63, s61
  ds_read_b64_tr_b16 v[32:33], v12 offset:0
  v_accvgpr_read_b32 v18, a90
  v_mfma_f32_16x16x32_bf16 v[128:131], v[72:75], v[240:243], v[128:131]
  s_add_u32 m0, s24, 98304
  ds_read_b64_tr_b16 v[34:35], v12 offset:1024
  v_accvgpr_read_b32 v19, a91
  v_mfma_f32_16x16x32_bf16 v[144:147], v[76:79], v[240:243], v[144:147]
  buffer_load_dwordx4 v3, s[32:35], s26 offen offset:0 sc1 lds
  v_accvgpr_read_b32 v20, a120
  v_mfma_f32_16x16x32_bf16 v[160:163], v[80:83], v[240:243], v[160:163]
  ds_read_b64_tr_b16 v[36:37], v13 offset:0
  v_accvgpr_read_b32 v21, a121
  v_mfma_f32_16x16x32_bf16 v[176:179], v[84:87], v[240:243], v[176:179]
  ds_read_b64_tr_b16 v[38:39], v13 offset:1024
  v_accvgpr_read_b32 v22, a122
  v_mfma_f32_16x16x32_bf16 v[192:195], v[88:91], v[240:243], v[192:195]
  ds_read_b64_tr_b16 v[40:41], v12 offset:256
  v_accvgpr_read_b32 v23, a123
  v_mfma_f32_16x16x32_bf16 v[208:211], v[92:95], v[240:243], v[208:211]
  ds_read_b64_tr_b16 v[42:43], v12 offset:1280
  v_cvt_pk_bf16_f32 v24, v16, v17
  v_mfma_f32_16x16x32_bf16 v[100:103], v[64:67], v[244:247], v[100:103]
  buffer_load_dwordx4 v4, s[32:35], s26 offen offset:1024 sc1 lds
  v_cvt_pk_bf16_f32 v25, v18, v19
  v_mfma_f32_16x16x32_bf16 v[116:119], v[68:71], v[244:247], v[116:119]
  ds_read_b64_tr_b16 v[44:45], v13 offset:256
  v_cvt_pk_bf16_f32 v26, v20, v21
  v_mfma_f32_16x16x32_bf16 v[132:135], v[72:75], v[244:247], v[132:135]
  ds_read_b64_tr_b16 v[46:47], v13 offset:1280
  v_cvt_pk_bf16_f32 v27, v22, v23
  v_mfma_f32_16x16x32_bf16 v[148:151], v[76:79], v[244:247], v[148:151]
  ds_read_b128 v[224:227], v14 offset:0
  buffer_store_dwordx4 v[24:27], v2, s[40:43], s63 offen offset:0 sc1
  v_mfma_f32_16x16x32_bf16 v[164:167], v[80:83], v[244:247], v[164:167]
  ds_read_b128 v[228:231], v14 offset:1024
  v_accvgpr_read_b32 v16, a92
  v_mfma_f32_16x16x32_bf16 v[180:183], v[84:87], v[244:247], v[180:183]
  buffer_load_dwordx4 v5, s[32:35], s26 offen offset:2048 sc1 lds
  v_accvgpr_read_b32 v17, a93
  v_mfma_f32_16x16x32_bf16 v[196:199], v[88:91], v[244:247], v[196:199]
  ds_read_b64_tr_b16 v[48:49], v12 offset:512
  v_accvgpr_read_b32 v18, a94
  v_mfma_f32_16x16x32_bf16 v[212:215], v[92:95], v[244:247], v[212:215]
  ds_read_b64_tr_b16 v[50:51], v12 offset:1536
  v_accvgpr_read_b32 v19, a95
  v_mfma_f32_16x16x32_bf16 v[104:107], v[64:67], v[248:251], v[104:107]
  ds_read_b64_tr_b16 v[52:53], v13 offset:512
  v_accvgpr_read_b32 v20, a124
  v_mfma_f32_16x16x32_bf16 v[120:123], v[68:71], v[248:251], v[120:123]
  ds_read_b64_tr_b16 v[54:55], v13 offset:1536
  v_accvgpr_read_b32 v21, a125
  v_mfma_f32_16x16x32_bf16 v[136:139], v[72:75], v[248:251], v[136:139]
  buffer_load_dwordx4 v6, s[32:35], s26 offen offset:3072 sc1 lds
  v_accvgpr_read_b32 v22, a126
  v_mfma_f32_16x16x32_bf16 v[152:155], v[76:79], v[248:251], v[152:155]
  s_add_u32 s26, s26, 1024
  ds_read_b64_tr_b16 v[56:57], v12 offset:768
  v_accvgpr_read_b32 v23, a127
  v_mfma_f32_16x16x32_bf16 v[168:171], v[80:83], v[248:251], v[168:171]
  ds_read_b64_tr_b16 v[58:59], v12 offset:1792
  v_cvt_pk_bf16_f32 v28, v16, v17
  v_mfma_f32_16x16x32_bf16 v[184:187], v[84:87], v[248:251], v[184:187]
  ds_read_b64_tr_b16 v[60:61], v13 offset:768
  v_cvt_pk_bf16_f32 v29, v18, v19
  v_mfma_f32_16x16x32_bf16 v[200:203], v[88:91], v[248:251], v[200:203]
  s_add_u32 m0, s24, 114688
  ds_read_b64_tr_b16 v[62:63], v13 offset:1792
  v_cvt_pk_bf16_f32 v30, v20, v21
  v_mfma_f32_16x16x32_bf16 v[216:219], v[92:95], v[248:251], v[216:219]
  buffer_load_dwordx4 v8, s[36:39], s27 offen offset:0 lds
  v_cvt_pk_bf16_f32 v31, v22, v23
  v_mfma_f32_16x16x32_bf16 v[108:111], v[64:67], v[252:255], v[108:111]
  ds_read_b128 v[232:235], v14 offset:2048
  buffer_store_dwordx4 v[28:31], v2, s[40:43], s63 offen offset:1024 sc1
  v_mfma_f32_16x16x32_bf16 v[124:127], v[68:71], v[252:255], v[124:127]
  ds_read_b128 v[236:239], v14 offset:3072
  v_accvgpr_write_b32 a23, 0
  v_mfma_f32_16x16x32_bf16 v[140:143], v[72:75], v[252:255], v[140:143]
  v_accvgpr_write_b32 a52, 0
  v_accvgpr_write_b32 a53, 0
  v_mfma_f32_16x16x32_bf16 v[156:159], v[76:79], v[252:255], v[156:159]
  v_accvgpr_write_b32 a54, 0
  v_accvgpr_write_b32 a55, 0
  v_mfma_f32_16x16x32_bf16 v[172:175], v[80:83], v[252:255], v[172:175]
  buffer_load_dwordx4 v9, s[36:39], s27 offen offset:1024 lds
  v_accvgpr_write_b32 a24, 0
  v_mfma_f32_16x16x32_bf16 v[188:191], v[84:87], v[252:255], v[188:191]
  v_accvgpr_write_b32 a25, 0
  v_mfma_f32_16x16x32_bf16 v[204:207], v[88:91], v[252:255], v[204:207]
  v_mfma_f32_16x16x32_bf16 v[220:223], v[92:95], v[252:255], v[220:223]
  s_waitcnt vmcnt(19) lgkmcnt(0)
  v_mfma_f32_16x16x32_bf16 v[96:99], v[32:35], v[224:227], v[96:99]
  s_mul_i32 s63, s60, 2
  v_accvgpr_read_b32 v16, a128
  v_accvgpr_read_b32 v17, a129
  v_mfma_f32_16x16x32_bf16 v[112:115], v[36:39], v[224:227], v[112:115]
  s_add_u32 s63, s63, s62
  ds_read_b64_tr_b16 v[64:65], v12 offset:8192
  v_accvgpr_read_b32 v18, a130
  v_mfma_f32_16x16x32_bf16 v[128:131], v[40:43], v[224:227], v[128:131]
  s_add_u32 m0, s24, 0
  ds_read_b64_tr_b16 v[66:67], v12 offset:9216
  v_accvgpr_read_b32 v19, a131
  v_mfma_f32_16x16x32_bf16 v[144:147], v[44:47], v[224:227], v[144:147]
  buffer_load_dwordx4 v3, s[32:35], s26 offen offset:0 sc1 lds
  v_accvgpr_read_b32 v20, a160
  v_mfma_f32_16x16x32_bf16 v[160:163], v[48:51], v[224:227], v[160:163]
  ds_read_b64_tr_b16 v[68:69], v13 offset:8192
  v_accvgpr_read_b32 v21, a161
  v_mfma_f32_16x16x32_bf16 v[176:179], v[52:55], v[224:227], v[176:179]
  ds_read_b64_tr_b16 v[70:71], v13 offset:9216
  v_accvgpr_read_b32 v22, a162
  v_mfma_f32_16x16x32_bf16 v[192:195], v[56:59], v[224:227], v[192:195]
  ds_read_b64_tr_b16 v[72:73], v12 offset:8448
  v_accvgpr_read_b32 v23, a163
  v_mfma_f32_16x16x32_bf16 v[208:211], v[60:63], v[224:227], v[208:211]
  ds_read_b64_tr_b16 v[74:75], v12 offset:9472
  v_cvt_pk_bf16_f32 v24, v16, v17
  v_mfma_f32_16x16x32_bf16 v[100:103], v[32:35], v[228:231], v[100:103]
  buffer_load_dwordx4 v4, s[32:35], s26 offen offset:1024 sc1 lds
  v_cvt_pk_bf16_f32 v25, v18, v19
  v_mfma_f32_16x16x32_bf16 v[116:119], v[36:39], v[228:231], v[116:119]
  ds_read_b64_tr_b16 v[76:77], v13 offset:8448
  v_cvt_pk_bf16_f32 v26, v20, v21
  v_mfma_f32_16x16x32_bf16 v[132:135], v[40:43], v[228:231], v[132:135]
  ds_read_b64_tr_b16 v[78:79], v13 offset:9472
  v_cvt_pk_bf16_f32 v27, v22, v23
  v_mfma_f32_16x16x32_bf16 v[148:151], v[44:47], v[228:231], v[148:151]
  ds_read_b128 v[240:243], v14 offset:32768
  buffer_store_dwordx4 v[24:27], v2, s[40:43], s63 offen offset:0 sc1
  v_mfma_f32_16x16x32_bf16 v[164:167], v[48:51], v[228:231], v[164:167]
  ds_read_b128 v[244:247], v14 offset:33792
  v_accvgpr_read_b32 v16, a132
  v_mfma_f32_16x16x32_bf16 v[180:183], v[52:55], v[228:231], v[180:183]
  buffer_load_dwordx4 v5, s[32:35], s26 offen offset:2048 sc1 lds
  v_accvgpr_read_b32 v17, a133
  v_mfma_f32_16x16x32_bf16 v[196:199], v[56:59], v[228:231], v[196:199]
  ds_read_b64_tr_b16 v[80:81], v12 offset:8704
  v_accvgpr_read_b32 v18, a134
  v_mfma_f32_16x16x32_bf16 v[212:215], v[60:63], v[228:231], v[212:215]
  ds_read_b64_tr_b16 v[82:83], v12 offset:9728
  v_accvgpr_read_b32 v19, a135
  v_mfma_f32_16x16x32_bf16 v[104:107], v[32:35], v[232:235], v[104:107]
  ds_read_b64_tr_b16 v[84:85], v13 offset:8704
  v_accvgpr_read_b32 v20, a164
  v_mfma_f32_16x16x32_bf16 v[120:123], v[36:39], v[232:235], v[120:123]
  ds_read_b64_tr_b16 v[86:87], v13 offset:9728
  v_accvgpr_read_b32 v21, a165
  v_mfma_f32_16x16x32_bf16 v[136:139], v[40:43], v[232:235], v[136:139]
  buffer_load_dwordx4 v6, s[32:35], s26 offen offset:3072 sc1 lds
  v_accvgpr_read_b32 v22, a166
  v_mfma_f32_16x16x32_bf16 v[152:155], v[44:47], v[232:235], v[152:155]
  s_add_u32 s26, s26, 1024
  ds_read_b64_tr_b16 v[88:89], v12 offset:8960
  v_accvgpr_read_b32 v23, a167
  v_mfma_f32_16x16x32_bf16 v[168:171], v[48:51], v[232:235], v[168:171]
  ds_read_b64_tr_b16 v[90:91], v12 offset:9984
  v_cvt_pk_bf16_f32 v28, v16, v17
  v_mfma_f32_16x16x32_bf16 v[184:187], v[52:55], v[232:235], v[184:187]
  ds_read_b64_tr_b16 v[92:93], v13 offset:8960
  v_cvt_pk_bf16_f32 v29, v18, v19
  v_mfma_f32_16x16x32_bf16 v[200:203], v[56:59], v[232:235], v[200:203]
  s_add_u32 m0, s24, 114688
  ds_read_b64_tr_b16 v[94:95], v13 offset:9984
  v_cvt_pk_bf16_f32 v30, v20, v21
  v_mfma_f32_16x16x32_bf16 v[216:219], v[60:63], v[232:235], v[216:219]
  buffer_load_dwordx4 v10, s[36:39], s27 offen offset:2048 lds
  v_cvt_pk_bf16_f32 v31, v22, v23
  v_mfma_f32_16x16x32_bf16 v[108:111], v[32:35], v[236:239], v[108:111]
  ds_read_b128 v[248:251], v14 offset:34816
  buffer_store_dwordx4 v[28:31], v2, s[40:43], s63 offen offset:1024 sc1
  v_mfma_f32_16x16x32_bf16 v[124:127], v[36:39], v[236:239], v[124:127]
  ds_read_b128 v[252:255], v14 offset:35840
  v_accvgpr_write_b32 a26, 0
  v_mfma_f32_16x16x32_bf16 v[140:143], v[40:43], v[236:239], v[140:143]
  v_accvgpr_write_b32 a27, 0
  v_accvgpr_write_b32 a56, 0
  v_mfma_f32_16x16x32_bf16 v[156:159], v[44:47], v[236:239], v[156:159]
  v_xor_b32 v14, 0x10000, v14
  v_accvgpr_write_b32 a57, 0
  v_mfma_f32_16x16x32_bf16 v[172:175], v[48:51], v[236:239], v[172:175]
  buffer_load_dwordx4 v11, s[36:39], s27 offen offset:3072 lds
  v_accvgpr_write_b32 a58, 0
  v_mfma_f32_16x16x32_bf16 v[188:191], v[52:55], v[236:239], v[188:191]
  s_add_u32 s27, s27, 524288
  v_accvgpr_write_b32 a59, 0
  v_mfma_f32_16x16x32_bf16 v[204:207], v[56:59], v[236:239], v[204:207]
  v_mfma_f32_16x16x32_bf16 v[220:223], v[60:63], v[236:239], v[220:223]
  s_waitcnt vmcnt(19) lgkmcnt(0)
  v_mfma_f32_16x16x32_bf16 v[96:99], v[64:67], v[240:243], v[96:99]
  s_barrier
  v_accvgpr_read_b32 v16, a136
  v_accvgpr_read_b32 v17, a137
  v_mfma_f32_16x16x32_bf16 v[112:115], v[68:71], v[240:243], v[112:115]
  s_add_u32 s63, s63, s61
  ds_read_b64_tr_b16 v[32:33], v12 offset:32768
  v_accvgpr_read_b32 v18, a138
  v_mfma_f32_16x16x32_bf16 v[128:131], v[72:75], v[240:243], v[128:131]
  s_add_u32 m0, s24, 32768
  ds_read_b64_tr_b16 v[34:35], v12 offset:33792
  v_accvgpr_read_b32 v19, a139
  v_mfma_f32_16x16x32_bf16 v[144:147], v[76:79], v[240:243], v[144:147]
  buffer_load_dwordx4 v3, s[32:35], s26 offen offset:0 sc1 lds
  v_accvgpr_read_b32 v20, a168
  v_mfma_f32_16x16x32_bf16 v[160:163], v[80:83], v[240:243], v[160:163]
  ds_read_b64_tr_b16 v[36:37], v13 offset:32768
  v_accvgpr_read_b32 v21, a169
  v_mfma_f32_16x16x32_bf16 v[176:179], v[84:87], v[240:243], v[176:179]
  ds_read_b64_tr_b16 v[38:39], v13 offset:33792
  v_accvgpr_read_b32 v22, a170
  v_mfma_f32_16x16x32_bf16 v[192:195], v[88:91], v[240:243], v[192:195]
  ds_read_b64_tr_b16 v[40:41], v12 offset:33024
  v_accvgpr_read_b32 v23, a171
  v_mfma_f32_16x16x32_bf16 v[208:211], v[92:95], v[240:243], v[208:211]
  ds_read_b64_tr_b16 v[42:43], v12 offset:34048
  v_cvt_pk_bf16_f32 v24, v16, v17
  v_mfma_f32_16x16x32_bf16 v[100:103], v[64:67], v[244:247], v[100:103]
  buffer_load_dwordx4 v4, s[32:35], s26 offen offset:1024 sc1 lds
  v_cvt_pk_bf16_f32 v25, v18, v19
  v_mfma_f32_16x16x32_bf16 v[116:119], v[68:71], v[244:247], v[116:119]
  ds_read_b64_tr_b16 v[44:45], v13 offset:33024
  v_cvt_pk_bf16_f32 v26, v20, v21
  v_mfma_f32_16x16x32_bf16 v[132:135], v[72:75], v[244:247], v[132:135]
  ds_read_b64_tr_b16 v[46:47], v13 offset:34048
  v_cvt_pk_bf16_f32 v27, v22, v23
  v_mfma_f32_16x16x32_bf16 v[148:151], v[76:79], v[244:247], v[148:151]
  ds_read_b128 v[224:227], v14 offset:0
  buffer_store_dwordx4 v[24:27], v2, s[40:43], s63 offen offset:0 sc1
  v_mfma_f32_16x16x32_bf16 v[164:167], v[80:83], v[244:247], v[164:167]
  ds_read_b128 v[228:231], v14 offset:1024
  v_accvgpr_read_b32 v16, a140
  v_mfma_f32_16x16x32_bf16 v[180:183], v[84:87], v[244:247], v[180:183]
  buffer_load_dwordx4 v5, s[32:35], s26 offen offset:2048 sc1 lds
  v_accvgpr_read_b32 v17, a141
  v_mfma_f32_16x16x32_bf16 v[196:199], v[88:91], v[244:247], v[196:199]
  ds_read_b64_tr_b16 v[48:49], v12 offset:33280
  v_accvgpr_read_b32 v18, a142
  v_mfma_f32_16x16x32_bf16 v[212:215], v[92:95], v[244:247], v[212:215]
  ds_read_b64_tr_b16 v[50:51], v12 offset:34304
  v_accvgpr_read_b32 v19, a143
  v_mfma_f32_16x16x32_bf16 v[104:107], v[64:67], v[248:251], v[104:107]
  ds_read_b64_tr_b16 v[52:53], v13 offset:33280
  v_accvgpr_read_b32 v20, a172
  v_mfma_f32_16x16x32_bf16 v[120:123], v[68:71], v[248:251], v[120:123]
  ds_read_b64_tr_b16 v[54:55], v13 offset:34304
  v_accvgpr_read_b32 v21, a173
  v_mfma_f32_16x16x32_bf16 v[136:139], v[72:75], v[248:251], v[136:139]
  buffer_load_dwordx4 v6, s[32:35], s26 offen offset:3072 sc1 lds
  v_accvgpr_read_b32 v22, a174
  v_mfma_f32_16x16x32_bf16 v[152:155], v[76:79], v[248:251], v[152:155]
  s_add_u32 s26, s26, 1024
  ds_read_b64_tr_b16 v[56:57], v12 offset:33536
  v_accvgpr_read_b32 v23, a175
  v_mfma_f32_16x16x32_bf16 v[168:171], v[80:83], v[248:251], v[168:171]
  ds_read_b64_tr_b16 v[58:59], v12 offset:34560
  v_cvt_pk_bf16_f32 v28, v16, v17
  v_mfma_f32_16x16x32_bf16 v[184:187], v[84:87], v[248:251], v[184:187]
  ds_read_b64_tr_b16 v[60:61], v13 offset:33536
  v_cvt_pk_bf16_f32 v29, v18, v19
  v_mfma_f32_16x16x32_bf16 v[200:203], v[88:91], v[248:251], v[200:203]
  s_add_u32 m0, s24, 16384
  ds_read_b64_tr_b16 v[62:63], v13 offset:34560
  v_cvt_pk_bf16_f32 v30, v20, v21
  v_mfma_f32_16x16x32_bf16 v[216:219], v[92:95], v[248:251], v[216:219]
  buffer_load_dwordx4 v8, s[36:39], s27 offen offset:0 lds
  v_cvt_pk_bf16_f32 v31, v22, v23
  v_mfma_f32_16x16x32_bf16 v[108:111], v[64:67], v[252:255], v[108:111]
  ds_read_b128 v[232:235], v14 offset:2048
  buffer_store_dwordx4 v[28:31], v2, s[40:43], s63 offen offset:1024 sc1
  v_mfma_f32_16x16x32_bf16 v[124:127], v[68:71], v[252:255], v[124:127]
  ds_read_b128 v[236:239], v14 offset:3072
  v_accvgpr_write_b32 a28, 0
  v_mfma_f32_16x16x32_bf16 v[140:143], v[72:75], v[252:255], v[140:143]
  v_accvgpr_write_b32 a29, 0
  v_accvgpr_write_b32 a30, 0
  v_mfma_f32_16x16x32_bf16 v[156:159], v[76:79], v[252:255], v[156:159]
  v_accvgpr_write_b32 a31, 0
  v_accvgpr_write_b32 a60, 0
  v_mfma_f32_16x16x32_bf16 v[172:175], v[80:83], v[252:255], v[172:175]
  buffer_load_dwordx4 v9, s[36:39], s27 offen offset:1024 lds
  v_accvgpr_write_b32 a61, 0
  v_mfma_f32_16x16x32_bf16 v[188:191], v[84:87], v[252:255], v[188:191]
  v_accvgpr_write_b32 a62, 0
  v_mfma_f32_16x16x32_bf16 v[204:207], v[88:91], v[252:255], v[204:207]
  v_mfma_f32_16x16x32_bf16 v[220:223], v[92:95], v[252:255], v[220:223]
  s_waitcnt vmcnt(19) lgkmcnt(0)
  v_mfma_f32_16x16x32_bf16 v[96:99], v[32:35], v[224:227], v[96:99]
  s_add_u32 s63, s63, s61
  v_accvgpr_read_b32 v16, a144
  v_accvgpr_read_b32 v17, a145
  v_mfma_f32_16x16x32_bf16 v[112:115], v[36:39], v[224:227], v[112:115]
  ds_read_b64_tr_b16 v[64:65], v12 offset:40960
  v_accvgpr_read_b32 v18, a146
  v_mfma_f32_16x16x32_bf16 v[128:131], v[40:43], v[224:227], v[128:131]
  s_add_u32 m0, s24, 65536
  ds_read_b64_tr_b16 v[66:67], v12 offset:41984
  v_accvgpr_read_b32 v19, a147
  v_mfma_f32_16x16x32_bf16 v[144:147], v[44:47], v[224:227], v[144:147]
  buffer_load_dwordx4 v3, s[32:35], s26 offen offset:0 sc1 lds
  v_accvgpr_read_b32 v20, a176
  v_mfma_f32_16x16x32_bf16 v[160:163], v[48:51], v[224:227], v[160:163]
  ds_read_b64_tr_b16 v[68:69], v13 offset:40960
  v_accvgpr_read_b32 v21, a177
  v_mfma_f32_16x16x32_bf16 v[176:179], v[52:55], v[224:227], v[176:179]
  ds_read_b64_tr_b16 v[70:71], v13 offset:41984
  v_accvgpr_read_b32 v22, a178
  v_mfma_f32_16x16x32_bf16 v[192:195], v[56:59], v[224:227], v[192:195]
  ds_read_b64_tr_b16 v[72:73], v12 offset:41216
  v_accvgpr_read_b32 v23, a179
  v_mfma_f32_16x16x32_bf16 v[208:211], v[60:63], v[224:227], v[208:211]
  ds_read_b64_tr_b16 v[74:75], v12 offset:42240
  v_cvt_pk_bf16_f32 v24, v16, v17
  v_mfma_f32_16x16x32_bf16 v[100:103], v[32:35], v[228:231], v[100:103]
  buffer_load_dwordx4 v4, s[32:35], s26 offen offset:1024 sc1 lds
  v_cvt_pk_bf16_f32 v25, v18, v19
  v_mfma_f32_16x16x32_bf16 v[116:119], v[36:39], v[228:231], v[116:119]
  ds_read_b64_tr_b16 v[76:77], v13 offset:41216
  v_cvt_pk_bf16_f32 v26, v20, v21
  v_mfma_f32_16x16x32_bf16 v[132:135], v[40:43], v[228:231], v[132:135]
  ds_read_b64_tr_b16 v[78:79], v13 offset:42240
  v_cvt_pk_bf16_f32 v27, v22, v23
  v_mfma_f32_16x16x32_bf16 v[148:151], v[44:47], v[228:231], v[148:151]
  ds_read_b128 v[240:243], v14 offset:32768
  buffer_store_dwordx4 v[24:27], v2, s[40:43], s63 offen offset:0 sc1
  v_mfma_f32_16x16x32_bf16 v[164:167], v[48:51], v[228:231], v[164:167]
  ds_read_b128 v[244:247], v14 offset:33792
  v_accvgpr_read_b32 v16, a148
  v_mfma_f32_16x16x32_bf16 v[180:183], v[52:55], v[228:231], v[180:183]
  buffer_load_dwordx4 v5, s[32:35], s26 offen offset:2048 sc1 lds
  v_accvgpr_read_b32 v17, a149
  v_mfma_f32_16x16x32_bf16 v[196:199], v[56:59], v[228:231], v[196:199]
  ds_read_b64_tr_b16 v[80:81], v12 offset:41472
  v_accvgpr_read_b32 v18, a150
  v_mfma_f32_16x16x32_bf16 v[212:215], v[60:63], v[228:231], v[212:215]
  ds_read_b64_tr_b16 v[82:83], v12 offset:42496
  v_accvgpr_read_b32 v19, a151
  v_mfma_f32_16x16x32_bf16 v[104:107], v[32:35], v[232:235], v[104:107]
  ds_read_b64_tr_b16 v[84:85], v13 offset:41472
  v_accvgpr_read_b32 v20, a180
  v_mfma_f32_16x16x32_bf16 v[120:123], v[36:39], v[232:235], v[120:123]
  ds_read_b64_tr_b16 v[86:87], v13 offset:42496
  v_accvgpr_read_b32 v21, a181
  v_mfma_f32_16x16x32_bf16 v[136:139], v[40:43], v[232:235], v[136:139]
  buffer_load_dwordx4 v6, s[32:35], s26 offen offset:3072 sc1 lds
  v_accvgpr_read_b32 v22, a182
  v_mfma_f32_16x16x32_bf16 v[152:155], v[44:47], v[232:235], v[152:155]
  s_add_u32 s26, s26, 1024
  ds_read_b64_tr_b16 v[88:89], v12 offset:41728
  v_accvgpr_read_b32 v23, a183
  v_mfma_f32_16x16x32_bf16 v[168:171], v[48:51], v[232:235], v[168:171]
  ds_read_b64_tr_b16 v[90:91], v12 offset:42752
  v_cvt_pk_bf16_f32 v28, v16, v17
  v_mfma_f32_16x16x32_bf16 v[184:187], v[52:55], v[232:235], v[184:187]
  ds_read_b64_tr_b16 v[92:93], v13 offset:41728
  v_cvt_pk_bf16_f32 v29, v18, v19
  v_mfma_f32_16x16x32_bf16 v[200:203], v[56:59], v[232:235], v[200:203]
  s_add_u32 m0, s24, 16384
  ds_read_b64_tr_b16 v[94:95], v13 offset:42752
  v_cvt_pk_bf16_f32 v30, v20, v21
  v_mfma_f32_16x16x32_bf16 v[216:219], v[60:63], v[232:235], v[216:219]
  buffer_load_dwordx4 v10, s[36:39], s27 offen offset:2048 lds
  v_cvt_pk_bf16_f32 v31, v22, v23
  v_mfma_f32_16x16x32_bf16 v[108:111], v[32:35], v[236:239], v[108:111]
  ds_read_b128 v[248:251], v14 offset:34816
  buffer_store_dwordx4 v[28:31], v2, s[40:43], s63 offen offset:1024 sc1
  v_mfma_f32_16x16x32_bf16 v[124:127], v[36:39], v[236:239], v[124:127]
  ds_read_b128 v[252:255], v14 offset:35840
  v_accvgpr_write_b32 a63, 0
  v_mfma_f32_16x16x32_bf16 v[140:143], v[40:43], v[236:239], v[140:143]
  v_accvgpr_write_b32 a64, 0
  v_accvgpr_write_b32 a65, 0
  v_mfma_f32_16x16x32_bf16 v[156:159], v[44:47], v[236:239], v[156:159]
  v_xor_b32 v14, 0x10000, v14
  v_accvgpr_write_b32 a66, 0
  v_mfma_f32_16x16x32_bf16 v[172:175], v[48:51], v[236:239], v[172:175]
  buffer_load_dwordx4 v11, s[36:39], s27 offen offset:3072 lds
  v_mfma_f32_16x16x32_bf16 v[188:191], v[52:55], v[236:239], v[188:191]
  s_add_u32 s27, s27, 524288
  v_xor_b32 v12, 0x10000, v12
  v_mfma_f32_16x16x32_bf16 v[204:207], v[56:59], v[236:239], v[204:207]
  v_xor_b32 v13, 0x10000, v13
  v_mfma_f32_16x16x32_bf16 v[220:223], v[60:63], v[236:239], v[220:223]
  s_waitcnt vmcnt(19) lgkmcnt(0)
  v_mfma_f32_16x16x32_bf16 v[96:99], v[64:67], v[240:243], v[96:99]
  s_barrier
  v_accvgpr_read_b32 v16, a152
  v_accvgpr_read_b32 v17, a153
  v_mfma_f32_16x16x32_bf16 v[112:115], v[68:71], v[240:243], v[112:115]
  s_add_u32 s63, s63, s61
  ds_read_b64_tr_b16 v[32:33], v12 offset:0
  v_accvgpr_read_b32 v18, a154
  v_mfma_f32_16x16x32_bf16 v[128:131], v[72:75], v[240:243], v[128:131]
  s_add_u32 m0, s24, 98304
  ds_read_b64_tr_b16 v[34:35], v12 offset:1024
  v_accvgpr_read_b32 v19, a155
  v_mfma_f32_16x16x32_bf16 v[144:147], v[76:79], v[240:243], v[144:147]
  buffer_load_dwordx4 v3, s[32:35], s26 offen offset:0 sc1 lds
  v_accvgpr_read_b32 v20, a184
  v_mfma_f32_16x16x32_bf16 v[160:163], v[80:83], v[240:243], v[160:163]
  ds_read_b64_tr_b16 v[36:37], v13 offset:0
  v_accvgpr_read_b32 v21, a185
  v_mfma_f32_16x16x32_bf16 v[176:179], v[84:87], v[240:243], v[176:179]
  ds_read_b64_tr_b16 v[38:39], v13 offset:1024
  v_accvgpr_read_b32 v22, a186
  v_mfma_f32_16x16x32_bf16 v[192:195], v[88:91], v[240:243], v[192:195]
  ds_read_b64_tr_b16 v[40:41], v12 offset:256
  v_accvgpr_read_b32 v23, a187
  v_mfma_f32_16x16x32_bf16 v[208:211], v[92:95], v[240:243], v[208:211]
  ds_read_b64_tr_b16 v[42:43], v12 offset:1280
  v_cvt_pk_bf16_f32 v24, v16, v17
  v_mfma_f32_16x16x32_bf16 v[100:103], v[64:67], v[244:247], v[100:103]
  buffer_load_dwordx4 v4, s[32:35], s26 offen offset:1024 sc1 lds
  v_cvt_pk_bf16_f32 v25, v18, v19
  v_mfma_f32_16x16x32_bf16 v[116:119], v[68:71], v[244:247], v[116:119]
  ds_read_b64_tr_b16 v[44:45], v13 offset:256
  v_cvt_pk_bf16_f32 v26, v20, v21
  v_mfma_f32_16x16x32_bf16 v[132:135], v[72:75], v[244:247], v[132:135]
  ds_read_b64_tr_b16 v[46:47], v13 offset:1280
  v_cvt_pk_bf16_f32 v27, v22, v23
  v_mfma_f32_16x16x32_bf16 v[148:151], v[76:79], v[244:247], v[148:151]
  ds_read_b128 v[224:227], v14 offset:0
  buffer_store_dwordx4 v[24:27], v2, s[40:43], s63 offen offset:0 sc1
  v_mfma_f32_16x16x32_bf16 v[164:167], v[80:83], v[244:247], v[164:167]
  ds_read_b128 v[228:231], v14 offset:1024
  v_accvgpr_read_b32 v16, a156
  v_mfma_f32_16x16x32_bf16 v[180:183], v[84:87], v[244:247], v[180:183]
  buffer_load_dwordx4 v5, s[32:35], s26 offen offset:2048 sc1 lds
  v_accvgpr_read_b32 v17, a157
  v_mfma_f32_16x16x32_bf16 v[196:199], v[88:91], v[244:247], v[196:199]
  ds_read_b64_tr_b16 v[48:49], v12 offset:512
  v_accvgpr_read_b32 v18, a158
  v_mfma_f32_16x16x32_bf16 v[212:215], v[92:95], v[244:247], v[212:215]
  ds_read_b64_tr_b16 v[50:51], v12 offset:1536
  v_accvgpr_read_b32 v19, a159
  v_mfma_f32_16x16x32_bf16 v[104:107], v[64:67], v[248:251], v[104:107]
  ds_read_b64_tr_b16 v[52:53], v13 offset:512
  v_accvgpr_read_b32 v20, a188
  v_mfma_f32_16x16x32_bf16 v[120:123], v[68:71], v[248:251], v[120:123]
  ds_read_b64_tr_b16 v[54:55], v13 offset:1536
  v_accvgpr_read_b32 v21, a189
  v_mfma_f32_16x16x32_bf16 v[136:139], v[72:75], v[248:251], v[136:139]
  buffer_load_dwordx4 v6, s[32:35], s26 offen offset:3072 sc1 lds
  v_accvgpr_read_b32 v22, a190
  v_mfma_f32_16x16x32_bf16 v[152:155], v[76:79], v[248:251], v[152:155]
  s_add_u32 s26, s26, 1024
  ds_read_b64_tr_b16 v[56:57], v12 offset:768
  v_accvgpr_read_b32 v23, a191
  v_mfma_f32_16x16x32_bf16 v[168:171], v[80:83], v[248:251], v[168:171]
  ds_read_b64_tr_b16 v[58:59], v12 offset:1792
  v_cvt_pk_bf16_f32 v28, v16, v17
  v_mfma_f32_16x16x32_bf16 v[184:187], v[84:87], v[248:251], v[184:187]
  ds_read_b64_tr_b16 v[60:61], v13 offset:768
  v_cvt_pk_bf16_f32 v29, v18, v19
  v_mfma_f32_16x16x32_bf16 v[200:203], v[88:91], v[248:251], v[200:203]
  s_add_u32 m0, s24, 49152
  ds_read_b64_tr_b16 v[62:63], v13 offset:1792
  v_cvt_pk_bf16_f32 v30, v20, v21
  v_mfma_f32_16x16x32_bf16 v[216:219], v[92:95], v[248:251], v[216:219]
  buffer_load_dwordx4 v8, s[36:39], s27 offen offset:0 lds
  v_cvt_pk_bf16_f32 v31, v22, v23
  v_mfma_f32_16x16x32_bf16 v[108:111], v[64:67], v[252:255], v[108:111]
  ds_read_b128 v[232:235], v14 offset:2048
  buffer_store_dwordx4 v[28:31], v2, s[40:43], s63 offen offset:1024 sc1
  v_mfma_f32_16x16x32_bf16 v[124:127], v[68:71], v[252:255], v[124:127]
  ds_read_b128 v[236:239], v14 offset:3072
  v_accvgpr_write_b32 a67, 0
  v_mfma_f32_16x16x32_bf16 v[140:143], v[72:75], v[252:255], v[140:143]
  v_accvgpr_write_b32 a96, 0
  v_accvgpr_write_b32 a97, 0
  v_mfma_f32_16x16x32_bf16 v[156:159], v[76:79], v[252:255], v[156:159]
  v_accvgpr_write_b32 a98, 0
  v_accvgpr_write_b32 a99, 0
  v_mfma_f32_16x16x32_bf16 v[172:175], v[80:83], v[252:255], v[172:175]
  buffer_load_dwordx4 v9, s[36:39], s27 offen offset:1024 lds
  v_accvgpr_write_b32 a68, 0
  v_mfma_f32_16x16x32_bf16 v[188:191], v[84:87], v[252:255], v[188:191]
  v_accvgpr_write_b32 a69, 0
  v_mfma_f32_16x16x32_bf16 v[204:207], v[88:91], v[252:255], v[204:207]
  v_mfma_f32_16x16x32_bf16 v[220:223], v[92:95], v[252:255], v[220:223]
  s_waitcnt vmcnt(19) lgkmcnt(0)
  v_mfma_f32_16x16x32_bf16 v[96:99], v[32:35], v[224:227], v[96:99]
  s_mul_i32 s63, s60, 3
  v_accvgpr_read_b32 v16, a192
  v_accvgpr_read_b32 v17, a193
  v_accvgpr_read_b32 v18, a194
  v_mfma_f32_16x16x32_bf16 v[112:115], v[36:39], v[224:227], v[112:115]
  s_add_u32 s63, s63, s62
  ds_read_b64_tr_b16 v[64:65], v12 offset:8192
  v_accvgpr_read_b32 v19, a195
  v_mfma_f32_16x16x32_bf16 v[128:131], v[40:43], v[224:227], v[128:131]
  s_add_u32 m0, s24, 0
  ds_read_b64_tr_b16 v[66:67], v12 offset:9216
  v_accvgpr_read_b32 v20, a224
  v_mfma_f32_16x16x32_bf16 v[144:147], v[44:47], v[224:227], v[144:147]
  buffer_load_dwordx4 v3, s[32:35], s26 offen offset:0 sc1 lds
  v_accvgpr_read_b32 v21, a225
  v_accvgpr_read_b32 v22, a226
  v_mfma_f32_16x16x32_bf16 v[160:163], v[48:51], v[224:227], v[160:163]
  ds_read_b64_tr_b16 v[68:69], v13 offset:8192
  v_accvgpr_read_b32 v23, a227
  v_mfma_f32_16x16x32_bf16 v[176:179], v[52:55], v[224:227], v[176:179]
  ds_read_b64_tr_b16 v[70:71], v13 offset:9216
  v_cvt_pk_bf16_f32 v24, v16, v17
  v_mfma_f32_16x16x32_bf16 v[192:195], v[56:59], v[224:227], v[192:195]
  ds_read_b64_tr_b16 v[72:73], v12 offset:8448
  v_cvt_pk_bf16_f32 v25, v18, v19
  v_mfma_f32_16x16x32_bf16 v[208:211], v[60:63], v[224:227], v[208:211]
  ds_read_b64_tr_b16 v[74:75], v12 offset:9472
  v_cvt_pk_bf16_f32 v26, v20, v21
  v_cvt_pk_bf16_f32 v27, v22, v23
  v_mfma_f32_16x16x32_bf16 v[100:103], v[32:35], v[228:231], v[100:103]
  buffer_load_dwordx4 v4, s[32:35], s26 offen offset:1024 sc1 lds
  buffer_store_dwordx4 v[24:27], v2, s[40:43], s63 offen offset:0 sc1
  v_mfma_f32_16x16x32_bf16 v[116:119], v[36:39], v[228:231], v[116:119]
  ds_read_b64_tr_b16 v[76:77], v13 offset:8448
  v_accvgpr_read_b32 v16, a196
  v_mfma_f32_16x16x32_bf16 v[132:135], v[40:43], v[228:231], v[132:135]
  ds_read_b64_tr_b16 v[78:79], v13 offset:9472
  v_accvgpr_read_b32 v17, a197
  v_mfma_f32_16x16x32_bf16 v[148:151], v[44:47], v[228:231], v[148:151]
  ds_read_b128 v[240:243], v14 offset:32768
  v_accvgpr_read_b32 v18, a198
  v_accvgpr_read_b32 v19, a199
  v_mfma_f32_16x16x32_bf16 v[164:167], v[48:51], v[228:231], v[164:167]
  ds_read_b128 v[244:247], v14 offset:33792
  v_accvgpr_read_b32 v20, a228
  v_mfma_f32_16x16x32_bf16 v[180:183], v[52:55], v[228:231], v[180:183]
  buffer_load_dwordx4 v5, s[32:35], s26 offen offset:2048 sc1 lds
  v_accvgpr_read_b32 v21, a229
  v_mfma_f32_16x16x32_bf16 v[196:199], v[56:59], v[228:231], v[196:199]
  ds_read_b64_tr_b16 v[80:81], v12 offset:8704
  v_accvgpr_read_b32 v22, a230
  v_mfma_f32_16x16x32_bf16 v[212:215], v[60:63], v[228:231], v[212:215]
  ds_read_b64_tr_b16 v[82:83], v12 offset:9728
  v_accvgpr_read_b32 v23, a231
  v_cvt_pk_bf16_f32 v28, v16, v17
  v_mfma_f32_16x16x32_bf16 v[104:107], v[32:35], v[232:235], v[104:107]
  ds_read_b64_tr_b16 v[84:85], v13 offset:8704
  v_cvt_pk_bf16_f32 v29, v18, v19
  v_mfma_f32_16x16x32_bf16 v[120:123], v[36:39], v[232:235], v[120:123]
  ds_read_b64_tr_b16 v[86:87], v13 offset:9728
  v_cvt_pk_bf16_f32 v30, v20, v21
  v_mfma_f32_16x16x32_bf16 v[136:139], v[40:43], v[232:235], v[136:139]
  buffer_load_dwordx4 v6, s[32:35], s26 offen offset:3072 sc1 lds
  v_cvt_pk_bf16_f32 v31, v22, v23
  v_mfma_f32_16x16x32_bf16 v[152:155], v[44:47], v[232:235], v[152:155]
  s_add_u32 s26, s26, 1024
  ds_read_b64_tr_b16 v[88:89], v12 offset:8960
  buffer_store_dwordx4 v[28:31], v2, s[40:43], s63 offen offset:1024 sc1
  v_mfma_f32_16x16x32_bf16 v[168:171], v[48:51], v[232:235], v[168:171]
  s_add_u32 s63, s63, s61
  ds_read_b64_tr_b16 v[90:91], v12 offset:9984
  v_accvgpr_read_b32 v16, a200
  v_mfma_f32_16x16x32_bf16 v[184:187], v[52:55], v[232:235], v[184:187]
  ds_read_b64_tr_b16 v[92:93], v13 offset:8960
  v_accvgpr_read_b32 v17, a201
  v_mfma_f32_16x16x32_bf16 v[200:203], v[56:59], v[232:235], v[200:203]
  s_add_u32 m0, s24, 49152
  ds_read_b64_tr_b16 v[94:95], v13 offset:9984
  v_accvgpr_read_b32 v18, a202
  v_accvgpr_read_b32 v19, a203
  v_mfma_f32_16x16x32_bf16 v[216:219], v[60:63], v[232:235], v[216:219]
  buffer_load_dwordx4 v10, s[36:39], s27 offen offset:2048 lds
  v_accvgpr_read_b32 v20, a232
  v_mfma_f32_16x16x32_bf16 v[108:111], v[32:35], v[236:239], v[108:111]
  ds_read_b128 v[248:251], v14 offset:34816
  v_accvgpr_read_b32 v21, a233
  v_mfma_f32_16x16x32_bf16 v[124:127], v[36:39], v[236:239], v[124:127]
  ds_read_b128 v[252:255], v14 offset:35840
  v_accvgpr_read_b32 v22, a234
  v_mfma_f32_16x16x32_bf16 v[140:143], v[40:43], v[236:239], v[140:143]
  v_accvgpr_read_b32 v23, a235
  v_cvt_pk_bf16_f32 v24, v16, v17
  v_cvt_pk_bf16_f32 v25, v18, v19
  v_mfma_f32_16x16x32_bf16 v[156:159], v[44:47], v[236:239], v[156:159]
  v_xor_b32 v14, 0x10000, v14
  v_cvt_pk_bf16_f32 v26, v20, v21
  v_mfma_f32_16x16x32_bf16 v[172:175], v[48:51], v[236:239], v[172:175]
  buffer_load_dwordx4 v11, s[36:39], s27 offen offset:3072 lds
  v_cvt_pk_bf16_f32 v27, v22, v23
  v_mfma_f32_16x16x32_bf16 v[188:191], v[52:55], v[236:239], v[188:191]
  s_add_u32 s27, s27, 524288
  buffer_store_dwordx4 v[24:27], v2, s[40:43], s63 offen offset:0 sc1
  v_mfma_f32_16x16x32_bf16 v[204:207], v[56:59], v[236:239], v[204:207]
  v_mfma_f32_16x16x32_bf16 v[220:223], v[60:63], v[236:239], v[220:223]
  s_waitcnt vmcnt(20) lgkmcnt(0)
  v_mfma_f32_16x16x32_bf16 v[96:99], v[64:67], v[240:243], v[96:99]
  s_barrier
  v_accvgpr_read_b32 v16, a204
  v_accvgpr_read_b32 v17, a205
  v_accvgpr_read_b32 v18, a206
  v_mfma_f32_16x16x32_bf16 v[112:115], v[68:71], v[240:243], v[112:115]
  ds_read_b64_tr_b16 v[32:33], v12 offset:32768
  v_accvgpr_read_b32 v19, a207
  v_accvgpr_read_b32 v20, a236
  v_mfma_f32_16x16x32_bf16 v[128:131], v[72:75], v[240:243], v[128:131]
  s_add_u32 m0, s24, 32768
  ds_read_b64_tr_b16 v[34:35], v12 offset:33792
  v_accvgpr_read_b32 v21, a237
  v_mfma_f32_16x16x32_bf16 v[144:147], v[76:79], v[240:243], v[144:147]
  buffer_load_dwordx4 v3, s[32:35], s26 offen offset:0 sc1 lds
  v_accvgpr_read_b32 v22, a238
  v_accvgpr_read_b32 v23, a239
  v_mfma_f32_16x16x32_bf16 v[160:163], v[80:83], v[240:243], v[160:163]
  ds_read_b64_tr_b16 v[36:37], v13 offset:32768
  v_cvt_pk_bf16_f32 v28, v16, v17
  v_cvt_pk_bf16_f32 v29, v18, v19
  v_mfma_f32_16x16x32_bf16 v[176:179], v[84:87], v[240:243], v[176:179]
  ds_read_b64_tr_b16 v[38:39], v13 offset:33792
  v_cvt_pk_bf16_f32 v30, v20, v21
  v_mfma_f32_16x16x32_bf16 v[192:195], v[88:91], v[240:243], v[192:195]
  ds_read_b64_tr_b16 v[40:41], v12 offset:33024
  v_cvt_pk_bf16_f32 v31, v22, v23
  v_mfma_f32_16x16x32_bf16 v[208:211], v[92:95], v[240:243], v[208:211]
  ds_read_b64_tr_b16 v[42:43], v12 offset:34048
  buffer_store_dwordx4 v[28:31], v2, s[40:43], s63 offen offset:1024 sc1
  v_accvgpr_read_b32 v16, a208
  v_mfma_f32_16x16x32_bf16 v[100:103], v[64:67], v[244:247], v[100:103]
  s_add_u32 s63, s63, s61
  buffer_load_dwordx4 v4, s[32:35], s26 offen offset:1024 sc1 lds
  v_accvgpr_read_b32 v17, a209
  v_mfma_f32_16x16x32_bf16 v[116:119], v[68:71], v[244:247], v[116:119]
  ds_read_b64_tr_b16 v[44:45], v13 offset:33024
  v_accvgpr_read_b32 v18, a210
  v_accvgpr_read_b32 v19, a211
  v_mfma_f32_16x16x32_bf16 v[132:135], v[72:75], v[244:247], v[132:135]
  ds_read_b64_tr_b16 v[46:47], v13 offset:34048
  v_accvgpr_read_b32 v20, a240
  v_mfma_f32_16x16x32_bf16 v[148:151], v[76:79], v[244:247], v[148:151]
  ds_read_b128 v[224:227], v14 offset:0
  v_accvgpr_read_b32 v21, a241
  v_accvgpr_read_b32 v22, a242
  v_mfma_f32_16x16x32_bf16 v[164:167], v[80:83], v[244:247], v[164:167]
  ds_read_b128 v[228:231], v14 offset:1024
  v_accvgpr_read_b32 v23, a243
  v_cvt_pk_bf16_f32 v24, v16, v17
  v_mfma_f32_16x16x32_bf16 v[180:183], v[84:87], v[244:247], v[180:183]
  buffer_load_dwordx4 v5, s[32:35], s26 offen offset:2048 sc1 lds
  v_cvt_pk_bf16_f32 v25, v18, v19
  v_mfma_f32_16x16x32_bf16 v[196:199], v[88:91], v[244:247], v[196:199]
  ds_read_b64_tr_b16 v[48:49], v12 offset:33280
  v_cvt_pk_bf16_f32 v26, v20, v21
  v_cvt_pk_bf16_f32 v27, v22, v23
  v_mfma_f32_16x16x32_bf16 v[212:215], v[92:95], v[244:247], v[212:215]
  ds_read_b64_tr_b16 v[50:51], v12 offset:34304
  buffer_store_dwordx4 v[24:27], v2, s[40:43], s63 offen offset:0 sc1
  v_accvgpr_read_b32 v16, a212
  v_mfma_f32_16x16x32_bf16 v[104:107], v[64:67], v[248:251], v[104:107]
  ds_read_b64_tr_b16 v[52:53], v13 offset:33280
  v_accvgpr_read_b32 v17, a213
  v_mfma_f32_16x16x32_bf16 v[120:123], v[68:71], v[248:251], v[120:123]
  ds_read_b64_tr_b16 v[54:55], v13 offset:34304
  v_accvgpr_read_b32 v18, a214
  v_accvgpr_read_b32 v19, a215
  v_mfma_f32_16x16x32_bf16 v[136:139], v[72:75], v[248:251], v[136:139]
  buffer_load_dwordx4 v6, s[32:35], s26 offen offset:3072 sc1 lds
  v_accvgpr_read_b32 v20, a244
  v_accvgpr_read_b32 v21, a245
  v_mfma_f32_16x16x32_bf16 v[152:155], v[76:79], v[248:251], v[152:155]
  s_add_u32 s26, s26, 1024
  ds_read_b64_tr_b16 v[56:57], v12 offset:33536
  v_accvgpr_read_b32 v22, a246
  v_mfma_f32_16x16x32_bf16 v[168:171], v[80:83], v[248:251], v[168:171]
  ds_read_b64_tr_b16 v[58:59], v12 offset:34560
  v_accvgpr_read_b32 v23, a247
  v_cvt_pk_bf16_f32 v28, v16, v17
  v_mfma_f32_16x16x32_bf16 v[184:187], v[84:87], v[248:251], v[184:187]
  ds_read_b64_tr_b16 v[60:61], v13 offset:33536
  v_cvt_pk_bf16_f32 v29, v18, v19
  v_mfma_f32_16x16x32_bf16 v[200:203], v[88:91], v[248:251], v[200:203]
  ds_read_b64_tr_b16 v[62:63], v13 offset:34560
  v_cvt_pk_bf16_f32 v30, v20, v21
  v_cvt_pk_bf16_f32 v31, v22, v23
  v_mfma_f32_16x16x32_bf16 v[216:219], v[92:95], v[248:251], v[216:219]
  buffer_store_dwordx4 v[28:31], v2, s[40:43], s63 offen offset:1024 sc1
  v_and_b32 v11, 15, v1
  v_lshrrev_b32 v10, 4, v1
  v_mfma_f32_16x16x32_bf16 v[108:111], v[64:67], v[252:255], v[108:111]
  ds_read_b128 v[232:235], v14 offset:2048
  v_lshlrev_b32 v10, 2, v10
  v_mfma_f32_16x16x32_bf16 v[124:127], v[68:71], v[252:255], v[124:127]
  ds_read_b128 v[236:239], v14 offset:3072
  v_sub_u32 v11, v11, v10
  v_cmp_le_i32 s[68:69], 0, v11
  v_mfma_f32_16x16x32_bf16 v[140:143], v[72:75], v[252:255], v[140:143]
  v_cmp_le_i32 s[70:71], 1, v11
  v_cmp_le_i32 s[72:73], 2, v11
  v_cmp_le_i32 s[74:75], 3, v11
  v_mfma_f32_16x16x32_bf16 v[156:159], v[76:79], v[252:255], v[156:159]
  v_and_b32 v8, 7, v1
  v_lshlrev_b32 v8, 2, v8
  v_mfma_f32_16x16x32_bf16 v[172:175], v[80:83], v[252:255], v[172:175]
  v_add_u32 v8, s30, v8
  v_mov_b32 v9, 1073741824
  v_mov_b32 v10, 1
  v_mfma_f32_16x16x32_bf16 v[188:191], v[84:87], v[252:255], v[188:191]
  v_writelane_b32 v9, s29, 0
  v_mfma_f32_16x16x32_bf16 v[204:207], v[88:91], v[252:255], v[204:207]
  v_mfma_f32_16x16x32_bf16 v[220:223], v[92:95], v[252:255], v[220:223]
  s_waitcnt vmcnt(19) lgkmcnt(0)
  v_mfma_f32_16x16x32_bf16 v[96:99], v[32:35], v[224:227], v[96:99]
  s_add_u32 s63, s63, s61
  v_accvgpr_read_b32 v16, a216
  v_accvgpr_read_b32 v17, a217
  v_mfma_f32_16x16x32_bf16 v[112:115], v[36:39], v[224:227], v[112:115]
  ds_read_b64_tr_b16 v[64:65], v12 offset:40960
  v_accvgpr_read_b32 v18, a218
  v_mfma_f32_16x16x32_bf16 v[128:131], v[40:43], v[224:227], v[128:131]
  s_add_u32 m0, s24, 65536
  ds_read_b64_tr_b16 v[66:67], v12 offset:41984
  v_accvgpr_read_b32 v19, a219
  v_mfma_f32_16x16x32_bf16 v[144:147], v[44:47], v[224:227], v[144:147]
  buffer_load_dwordx4 v3, s[32:35], s26 offen offset:0 sc1 lds
  v_accvgpr_read_b32 v20, a248
  v_mfma_f32_16x16x32_bf16 v[160:163], v[48:51], v[224:227], v[160:163]
  ds_read_b64_tr_b16 v[68:69], v13 offset:40960
  v_accvgpr_read_b32 v21, a249
  v_mfma_f32_16x16x32_bf16 v[176:179], v[52:55], v[224:227], v[176:179]
  ds_read_b64_tr_b16 v[70:71], v13 offset:41984
  v_accvgpr_read_b32 v22, a250
  v_mfma_f32_16x16x32_bf16 v[192:195], v[56:59], v[224:227], v[192:195]
  ds_read_b64_tr_b16 v[72:73], v12 offset:41216
  v_accvgpr_read_b32 v23, a251
  v_mfma_f32_16x16x32_bf16 v[208:211], v[60:63], v[224:227], v[208:211]
  ds_read_b64_tr_b16 v[74:75], v12 offset:42240
  v_cvt_pk_bf16_f32 v24, v16, v17
  v_mfma_f32_16x16x32_bf16 v[100:103], v[32:35], v[228:231], v[100:103]
  buffer_load_dwordx4 v4, s[32:35], s26 offen offset:1024 sc1 lds
  v_cvt_pk_bf16_f32 v25, v18, v19
  v_mfma_f32_16x16x32_bf16 v[116:119], v[36:39], v[228:231], v[116:119]
  ds_read_b64_tr_b16 v[76:77], v13 offset:41216
  v_cvt_pk_bf16_f32 v26, v20, v21
  v_mfma_f32_16x16x32_bf16 v[132:135], v[40:43], v[228:231], v[132:135]
  ds_read_b64_tr_b16 v[78:79], v13 offset:42240
  v_cvt_pk_bf16_f32 v27, v22, v23
  v_mfma_f32_16x16x32_bf16 v[148:151], v[44:47], v[228:231], v[148:151]
  ds_read_b128 v[240:243], v14 offset:32768
  buffer_store_dwordx4 v[24:27], v2, s[40:43], s63 offen offset:0 sc1
  v_mfma_f32_16x16x32_bf16 v[164:167], v[48:51], v[228:231], v[164:167]
  ds_read_b128 v[244:247], v14 offset:33792
  v_accvgpr_read_b32 v16, a220
  v_mfma_f32_16x16x32_bf16 v[180:183], v[52:55], v[228:231], v[180:183]
  buffer_load_dwordx4 v5, s[32:35], s26 offen offset:2048 sc1 lds
  v_accvgpr_read_b32 v17, a221
  v_mfma_f32_16x16x32_bf16 v[196:199], v[56:59], v[228:231], v[196:199]
  ds_read_b64_tr_b16 v[80:81], v12 offset:41472
  v_accvgpr_read_b32 v18, a222
  v_mfma_f32_16x16x32_bf16 v[212:215], v[60:63], v[228:231], v[212:215]
  ds_read_b64_tr_b16 v[82:83], v12 offset:42496
  v_accvgpr_read_b32 v19, a223
  v_mfma_f32_16x16x32_bf16 v[104:107], v[32:35], v[232:235], v[104:107]
  ds_read_b64_tr_b16 v[84:85], v13 offset:41472
  v_accvgpr_read_b32 v20, a252
  v_mfma_f32_16x16x32_bf16 v[120:123], v[36:39], v[232:235], v[120:123]
  ds_read_b64_tr_b16 v[86:87], v13 offset:42496
  v_accvgpr_read_b32 v21, a253
  v_mfma_f32_16x16x32_bf16 v[136:139], v[40:43], v[232:235], v[136:139]
  buffer_load_dwordx4 v6, s[32:35], s26 offen offset:3072 sc1 lds
  v_accvgpr_read_b32 v22, a254
  v_mfma_f32_16x16x32_bf16 v[152:155], v[44:47], v[232:235], v[152:155]
  s_add_u32 s26, s26, 1024
  ds_read_b64_tr_b16 v[88:89], v12 offset:41728
  v_accvgpr_read_b32 v23, a255
  v_mfma_f32_16x16x32_bf16 v[168:171], v[48:51], v[232:235], v[168:171]
  ds_read_b64_tr_b16 v[90:91], v12 offset:42752
  v_cvt_pk_bf16_f32 v28, v16, v17
  v_mfma_f32_16x16x32_bf16 v[184:187], v[52:55], v[232:235], v[184:187]
  ds_read_b64_tr_b16 v[92:93], v13 offset:41728
  v_cvt_pk_bf16_f32 v29, v18, v19
  v_mfma_f32_16x16x32_bf16 v[200:203], v[56:59], v[232:235], v[200:203]
  ds_read_b64_tr_b16 v[94:95], v13 offset:42752
  v_cvt_pk_bf16_f32 v30, v20, v21
  v_mfma_f32_16x16x32_bf16 v[216:219], v[60:63], v[232:235], v[216:219]
  v_cvt_pk_bf16_f32 v31, v22, v23
  v_mfma_f32_16x16x32_bf16 v[108:111], v[32:35], v[236:239], v[108:111]
  ds_read_b128 v[248:251], v14 offset:34816
  buffer_store_dwordx4 v[28:31], v2, s[40:43], s63 offen offset:1024 sc1
  v_mfma_f32_16x16x32_bf16 v[124:127], v[36:39], v[236:239], v[124:127]
  ds_read_b128 v[252:255], v14 offset:35840
  v_accvgpr_write_b32 a70, 0
  v_mfma_f32_16x16x32_bf16 v[140:143], v[40:43], v[236:239], v[140:143]
  v_accvgpr_write_b32 a71, 0
  v_accvgpr_write_b32 a100, 0
  v_mfma_f32_16x16x32_bf16 v[156:159], v[44:47], v[236:239], v[156:159]
  v_xor_b32 v14, 0x10000, v14
  v_accvgpr_write_b32 a101, 0
  v_mfma_f32_16x16x32_bf16 v[172:175], v[48:51], v[236:239], v[172:175]
  v_accvgpr_write_b32 a102, 0
  v_accvgpr_write_b32 a103, 0
  v_mfma_f32_16x16x32_bf16 v[188:191], v[52:55], v[236:239], v[188:191]
  v_xor_b32 v12, 0x10000, v12
  v_mfma_f32_16x16x32_bf16 v[204:207], v[56:59], v[236:239], v[204:207]
  v_xor_b32 v13, 0x10000, v13
  v_mfma_f32_16x16x32_bf16 v[220:223], v[60:63], v[236:239], v[220:223]
  s_waitcnt vmcnt(17) lgkmcnt(0)
  v_mfma_f32_16x16x32_bf16 v[96:99], v[64:67], v[240:243], v[96:99]
  s_barrier
  v_accvgpr_write_b32 a72, 0
  v_accvgpr_write_b32 a73, 0
  v_mfma_f32_16x16x32_bf16 v[112:115], v[68:71], v[240:243], v[112:115]
  ds_read_b64_tr_b16 v[32:33], v12 offset:0
  v_accvgpr_write_b32 a74, 0
  v_mfma_f32_16x16x32_bf16 v[128:131], v[72:75], v[240:243], v[128:131]
  s_add_u32 m0, s24, 98304
  ds_read_b64_tr_b16 v[34:35], v12 offset:1024
  v_accvgpr_write_b32 a75, 0
  v_mfma_f32_16x16x32_bf16 v[144:147], v[76:79], v[240:243], v[144:147]
  buffer_load_dwordx4 v3, s[32:35], s26 offen offset:0 sc1 lds
  v_accvgpr_write_b32 a104, 0
  v_mfma_f32_16x16x32_bf16 v[160:163], v[80:83], v[240:243], v[160:163]
  ds_read_b64_tr_b16 v[36:37], v13 offset:0
  v_accvgpr_write_b32 a105, 0
  v_mfma_f32_16x16x32_bf16 v[176:179], v[84:87], v[240:243], v[176:179]
  ds_read_b64_tr_b16 v[38:39], v13 offset:1024
  v_accvgpr_write_b32 a106, 0
  v_mfma_f32_16x16x32_bf16 v[192:195], v[88:91], v[240:243], v[192:195]
  ds_read_b64_tr_b16 v[40:41], v12 offset:256
  v_accvgpr_write_b32 a107, 0
  v_mfma_f32_16x16x32_bf16 v[208:211], v[92:95], v[240:243], v[208:211]
  ds_read_b64_tr_b16 v[42:43], v12 offset:1280
  v_accvgpr_write_b32 a76, 0
  v_mfma_f32_16x16x32_bf16 v[100:103], v[64:67], v[244:247], v[100:103]
  buffer_load_dwordx4 v4, s[32:35], s26 offen offset:1024 sc1 lds
  v_accvgpr_write_b32 a77, 0
  v_mfma_f32_16x16x32_bf16 v[116:119], v[68:71], v[244:247], v[116:119]
  ds_read_b64_tr_b16 v[44:45], v13 offset:256
  v_accvgpr_write_b32 a78, 0
  v_mfma_f32_16x16x32_bf16 v[132:135], v[72:75], v[244:247], v[132:135]
  ds_read_b64_tr_b16 v[46:47], v13 offset:1280
  v_accvgpr_write_b32 a79, 0
  v_mfma_f32_16x16x32_bf16 v[148:151], v[76:79], v[244:247], v[148:151]
  ds_read_b128 v[224:227], v14 offset:0
  v_accvgpr_write_b32 a108, 0
  v_mfma_f32_16x16x32_bf16 v[164:167], v[80:83], v[244:247], v[164:167]
  ds_read_b128 v[228:231], v14 offset:1024
  v_accvgpr_write_b32 a109, 0
  v_mfma_f32_16x16x32_bf16 v[180:183], v[84:87], v[244:247], v[180:183]
  buffer_load_dwordx4 v5, s[32:35], s26 offen offset:2048 sc1 lds
  v_accvgpr_write_b32 a110, 0
  v_mfma_f32_16x16x32_bf16 v[196:199], v[88:91], v[244:247], v[196:199]
  ds_read_b64_tr_b16 v[48:49], v12 offset:512
  v_accvgpr_write_b32 a111, 0
  v_mfma_f32_16x16x32_bf16 v[212:215], v[92:95], v[244:247], v[212:215]
  ds_read_b64_tr_b16 v[50:51], v12 offset:1536
  v_accvgpr_write_b32 a80, 0
  v_mfma_f32_16x16x32_bf16 v[104:107], v[64:67], v[248:251], v[104:107]
  ds_read_b64_tr_b16 v[52:53], v13 offset:512
  v_accvgpr_write_b32 a81, 0
  v_mfma_f32_16x16x32_bf16 v[120:123], v[68:71], v[248:251], v[120:123]
  ds_read_b64_tr_b16 v[54:55], v13 offset:1536
  v_accvgpr_write_b32 a82, 0
  v_mfma_f32_16x16x32_bf16 v[136:139], v[72:75], v[248:251], v[136:139]
  buffer_load_dwordx4 v6, s[32:35], s26 offen offset:3072 sc1 lds
  v_accvgpr_write_b32 a83, 0
  v_mfma_f32_16x16x32_bf16 v[152:155], v[76:79], v[248:251], v[152:155]
  s_add_u32 s26, s26, 1024
  ds_read_b64_tr_b16 v[56:57], v12 offset:768
  v_accvgpr_write_b32 a112, 0
  v_mfma_f32_16x16x32_bf16 v[168:171], v[80:83], v[248:251], v[168:171]
  ds_read_b64_tr_b16 v[58:59], v12 offset:1792
  v_accvgpr_write_b32 a113, 0
  v_mfma_f32_16x16x32_bf16 v[184:187], v[84:87], v[248:251], v[184:187]
  ds_read_b64_tr_b16 v[60:61], v13 offset:768
  v_accvgpr_write_b32 a114, 0
  v_mfma_f32_16x16x32_bf16 v[200:203], v[88:91], v[248:251], v[200:203]
  ds_read_b64_tr_b16 v[62:63], v13 offset:1792
  v_accvgpr_write_b32 a115, 0
  v_mfma_f32_16x16x32_bf16 v[216:219], v[92:95], v[248:251], v[216:219]
  v_accvgpr_write_b32 a84, 0
  v_accvgpr_write_b32 a85, 0
  v_mfma_f32_16x16x32_bf16 v[108:111], v[64:67], v[252:255], v[108:111]
  ds_read_b128 v[232:235], v14 offset:2048
  v_accvgpr_write_b32 a86, 0
  v_mfma_f32_16x16x32_bf16 v[124:127], v[68:71], v[252:255], v[124:127]
  ds_read_b128 v[236:239], v14 offset:3072
  v_accvgpr_write_b32 a87, 0
  v_mfma_f32_16x16x32_bf16 v[140:143], v[72:75], v[252:255], v[140:143]
  v_accvgpr_write_b32 a116, 0
  v_accvgpr_write_b32 a117, 0
  v_mfma_f32_16x16x32_bf16 v[156:159], v[76:79], v[252:255], v[156:159]
  v_accvgpr_write_b32 a118, 0
  v_accvgpr_write_b32 a119, 0
  v_mfma_f32_16x16x32_bf16 v[172:175], v[80:83], v[252:255], v[172:175]
  v_accvgpr_write_b32 a88, 0
  v_accvgpr_write_b32 a89, 0
  v_mfma_f32_16x16x32_bf16 v[188:191], v[84:87], v[252:255], v[188:191]
  v_accvgpr_write_b32 a90, 0
  v_accvgpr_write_b32 a91, 0
  v_mfma_f32_16x16x32_bf16 v[204:207], v[88:91], v[252:255], v[204:207]
  v_accvgpr_write_b32 a120, 0
  v_mfma_f32_16x16x32_bf16 v[220:223], v[92:95], v[252:255], v[220:223]
  s_waitcnt vmcnt(11) lgkmcnt(0)
  v_mfma_f32_16x16x32_bf16 v[96:99], v[32:35], v[224:227], v[96:99]
  v_accvgpr_write_b32 a121, 0
  v_accvgpr_write_b32 a122, 0
  v_mfma_f32_16x16x32_bf16 v[112:115], v[36:39], v[224:227], v[112:115]
  ds_read_b64_tr_b16 v[64:65], v12 offset:8192
  v_accvgpr_write_b32 a123, 0
  v_mfma_f32_16x16x32_bf16 v[128:131], v[40:43], v[224:227], v[128:131]
  ds_read_b64_tr_b16 v[66:67], v12 offset:9216
  v_accvgpr_write_b32 a92, 0
  v_mfma_f32_16x16x32_bf16 v[144:147], v[44:47], v[224:227], v[144:147]
  v_accvgpr_write_b32 a93, 0
  v_accvgpr_write_b32 a94, 0
  v_mfma_f32_16x16x32_bf16 v[160:163], v[48:51], v[224:227], v[160:163]
  ds_read_b64_tr_b16 v[68:69], v13 offset:8192
  v_accvgpr_write_b32 a95, 0
  v_mfma_f32_16x16x32_bf16 v[176:179], v[52:55], v[224:227], v[176:179]
  ds_read_b64_tr_b16 v[70:71], v13 offset:9216
  v_accvgpr_write_b32 a124, 0
  v_mfma_f32_16x16x32_bf16 v[192:195], v[56:59], v[224:227], v[192:195]
  ds_read_b64_tr_b16 v[72:73], v12 offset:8448
  v_accvgpr_write_b32 a125, 0
  v_mfma_f32_16x16x32_bf16 v[208:211], v[60:63], v[224:227], v[208:211]
  ds_read_b64_tr_b16 v[74:75], v12 offset:9472
  v_accvgpr_write_b32 a126, 0
  v_mfma_f32_16x16x32_bf16 v[100:103], v[32:35], v[228:231], v[100:103]
  v_accvgpr_write_b32 a127, 0
  v_mfma_f32_16x16x32_bf16 v[116:119], v[36:39], v[228:231], v[116:119]
  ds_read_b64_tr_b16 v[76:77], v13 offset:8448
  v_mfma_f32_16x16x32_bf16 v[132:135], v[40:43], v[228:231], v[132:135]
  ds_read_b64_tr_b16 v[78:79], v13 offset:9472
  v_mfma_f32_16x16x32_bf16 v[148:151], v[44:47], v[228:231], v[148:151]
  ds_read_b128 v[240:243], v14 offset:32768
  v_mfma_f32_16x16x32_bf16 v[164:167], v[48:51], v[228:231], v[164:167]
  ds_read_b128 v[244:247], v14 offset:33792
  v_mfma_f32_16x16x32_bf16 v[180:183], v[52:55], v[228:231], v[180:183]
  v_mfma_f32_16x16x32_bf16 v[196:199], v[56:59], v[228:231], v[196:199]
  ds_read_b64_tr_b16 v[80:81], v12 offset:8704
  v_mfma_f32_16x16x32_bf16 v[212:215], v[60:63], v[228:231], v[212:215]
  ds_read_b64_tr_b16 v[82:83], v12 offset:9728
  v_mfma_f32_16x16x32_bf16 v[104:107], v[32:35], v[232:235], v[104:107]
  ds_read_b64_tr_b16 v[84:85], v13 offset:8704
  v_mfma_f32_16x16x32_bf16 v[120:123], v[36:39], v[232:235], v[120:123]
  ds_read_b64_tr_b16 v[86:87], v13 offset:9728
  v_mfma_f32_16x16x32_bf16 v[136:139], v[40:43], v[232:235], v[136:139]
  v_mfma_f32_16x16x32_bf16 v[152:155], v[44:47], v[232:235], v[152:155]
  ds_read_b64_tr_b16 v[88:89], v12 offset:8960
  v_mfma_f32_16x16x32_bf16 v[168:171], v[48:51], v[232:235], v[168:171]
  ds_read_b64_tr_b16 v[90:91], v12 offset:9984
  v_mfma_f32_16x16x32_bf16 v[184:187], v[52:55], v[232:235], v[184:187]
  ds_read_b64_tr_b16 v[92:93], v13 offset:8960
  v_mfma_f32_16x16x32_bf16 v[200:203], v[56:59], v[232:235], v[200:203]
  ds_read_b64_tr_b16 v[94:95], v13 offset:9984
  v_mfma_f32_16x16x32_bf16 v[216:219], v[60:63], v[232:235], v[216:219]
  v_mfma_f32_16x16x32_bf16 v[108:111], v[32:35], v[236:239], v[108:111]
  ds_read_b128 v[248:251], v14 offset:34816
  v_mfma_f32_16x16x32_bf16 v[124:127], v[36:39], v[236:239], v[124:127]
  ds_read_b128 v[252:255], v14 offset:35840
  v_mfma_f32_16x16x32_bf16 v[140:143], v[40:43], v[236:239], v[140:143]
  v_mfma_f32_16x16x32_bf16 v[156:159], v[44:47], v[236:239], v[156:159]
  v_xor_b32 v14, 0x10000, v14
  v_mfma_f32_16x16x32_bf16 v[172:175], v[48:51], v[236:239], v[172:175]
  v_mfma_f32_16x16x32_bf16 v[188:191], v[52:55], v[236:239], v[188:191]
  v_mfma_f32_16x16x32_bf16 v[204:207], v[56:59], v[236:239], v[204:207]
  v_mfma_f32_16x16x32_bf16 v[220:223], v[60:63], v[236:239], v[220:223]
  s_waitcnt vmcnt(4) lgkmcnt(0)
  v_mfma_f32_16x16x32_bf16 v[96:99], v[64:67], v[240:243], v[96:99]
  s_barrier
  buffer_store_dword v10, v9, s[40:43], 0 offen sc1
  v_mfma_f32_16x16x32_bf16 v[112:115], v[68:71], v[240:243], v[112:115]
  ds_read_b64_tr_b16 v[32:33], v12 offset:32768
  v_mfma_f32_16x16x32_bf16 v[128:131], v[72:75], v[240:243], v[128:131]
  ds_read_b64_tr_b16 v[34:35], v12 offset:33792
  v_mfma_f32_16x16x32_bf16 v[144:147], v[76:79], v[240:243], v[144:147]
  v_mfma_f32_16x16x32_bf16 v[160:163], v[80:83], v[240:243], v[160:163]
  ds_read_b64_tr_b16 v[36:37], v13 offset:32768
  v_mfma_f32_16x16x32_bf16 v[176:179], v[84:87], v[240:243], v[176:179]
  ds_read_b64_tr_b16 v[38:39], v13 offset:33792
  v_mfma_f32_16x16x32_bf16 v[192:195], v[88:91], v[240:243], v[192:195]
  ds_read_b64_tr_b16 v[40:41], v12 offset:33024
  v_mfma_f32_16x16x32_bf16 v[208:211], v[92:95], v[240:243], v[208:211]
  ds_read_b64_tr_b16 v[42:43], v12 offset:34048
  v_mfma_f32_16x16x32_bf16 v[100:103], v[64:67], v[244:247], v[100:103]
  v_mfma_f32_16x16x32_bf16 v[116:119], v[68:71], v[244:247], v[116:119]
  ds_read_b64_tr_b16 v[44:45], v13 offset:33024
  v_mfma_f32_16x16x32_bf16 v[132:135], v[72:75], v[244:247], v[132:135]
  ds_read_b64_tr_b16 v[46:47], v13 offset:34048
  v_mfma_f32_16x16x32_bf16 v[148:151], v[76:79], v[244:247], v[148:151]
  ds_read_b128 v[224:227], v14 offset:0
  v_mfma_f32_16x16x32_bf16 v[164:167], v[80:83], v[244:247], v[164:167]
  ds_read_b128 v[228:231], v14 offset:1024
  v_mfma_f32_16x16x32_bf16 v[180:183], v[84:87], v[244:247], v[180:183]
  v_mfma_f32_16x16x32_bf16 v[196:199], v[88:91], v[244:247], v[196:199]
  ds_read_b64_tr_b16 v[48:49], v12 offset:33280
  v_mfma_f32_16x16x32_bf16 v[212:215], v[92:95], v[244:247], v[212:215]
  ds_read_b64_tr_b16 v[50:51], v12 offset:34304
  v_mfma_f32_16x16x32_bf16 v[104:107], v[64:67], v[248:251], v[104:107]
  ds_read_b64_tr_b16 v[52:53], v13 offset:33280
  v_mfma_f32_16x16x32_bf16 v[120:123], v[68:71], v[248:251], v[120:123]
  ds_read_b64_tr_b16 v[54:55], v13 offset:34304
  v_mfma_f32_16x16x32_bf16 v[136:139], v[72:75], v[248:251], v[136:139]
  v_mfma_f32_16x16x32_bf16 v[152:155], v[76:79], v[248:251], v[152:155]
  ds_read_b64_tr_b16 v[56:57], v12 offset:33536
  v_mfma_f32_16x16x32_bf16 v[168:171], v[80:83], v[248:251], v[168:171]
  ds_read_b64_tr_b16 v[58:59], v12 offset:34560
  v_mfma_f32_16x16x32_bf16 v[184:187], v[84:87], v[248:251], v[184:187]
  ds_read_b64_tr_b16 v[60:61], v13 offset:33536
  v_mfma_f32_16x16x32_bf16 v[200:203], v[88:91], v[248:251], v[200:203]
  ds_read_b64_tr_b16 v[62:63], v13 offset:34560
  v_mfma_f32_16x16x32_bf16 v[216:219], v[92:95], v[248:251], v[216:219]
  v_mfma_f32_16x16x32_bf16 v[108:111], v[64:67], v[252:255], v[108:111]
  ds_read_b128 v[232:235], v14 offset:2048
  v_mfma_f32_16x16x32_bf16 v[124:127], v[68:71], v[252:255], v[124:127]
  ds_read_b128 v[236:239], v14 offset:3072
  v_mfma_f32_16x16x32_bf16 v[140:143], v[72:75], v[252:255], v[140:143]
  v_mfma_f32_16x16x32_bf16 v[156:159], v[76:79], v[252:255], v[156:159]
  v_mfma_f32_16x16x32_bf16 v[172:175], v[80:83], v[252:255], v[172:175]
  v_mfma_f32_16x16x32_bf16 v[188:191], v[84:87], v[252:255], v[188:191]
  v_mfma_f32_16x16x32_bf16 v[204:207], v[88:91], v[252:255], v[204:207]
  v_mfma_f32_16x16x32_bf16 v[220:223], v[92:95], v[252:255], v[220:223]
  s_waitcnt vmcnt(1) lgkmcnt(0)
  v_mfma_f32_16x16x32_bf16 v[96:99], v[32:35], v[224:227], v[96:99]
  v_mfma_f32_16x16x32_bf16 v[112:115], v[36:39], v[224:227], v[112:115]
  ds_read_b64_tr_b16 v[64:65], v12 offset:40960
  v_mfma_f32_16x16x32_bf16 v[128:131], v[40:43], v[224:227], v[128:131]
  ds_read_b64_tr_b16 v[66:67], v12 offset:41984
  v_mfma_f32_16x16x32_bf16 v[144:147], v[44:47], v[224:227], v[144:147]
  buffer_load_dword v15, v8, s[40:43], 0 offen sc1
  v_mfma_f32_16x16x32_bf16 v[160:163], v[48:51], v[224:227], v[160:163]
  ds_read_b64_tr_b16 v[68:69], v13 offset:40960
  v_mfma_f32_16x16x32_bf16 v[176:179], v[52:55], v[224:227], v[176:179]
  ds_read_b64_tr_b16 v[70:71], v13 offset:41984
  v_mfma_f32_16x16x32_bf16 v[192:195], v[56:59], v[224:227], v[192:195]
  ds_read_b64_tr_b16 v[72:73], v12 offset:41216
  v_mfma_f32_16x16x32_bf16 v[208:211], v[60:63], v[224:227], v[208:211]
  ds_read_b64_tr_b16 v[74:75], v12 offset:42240
  v_mfma_f32_16x16x32_bf16 v[100:103], v[32:35], v[228:231], v[100:103]
  v_mfma_f32_16x16x32_bf16 v[116:119], v[36:39], v[228:231], v[116:119]
  ds_read_b64_tr_b16 v[76:77], v13 offset:41216
  v_mfma_f32_16x16x32_bf16 v[132:135], v[40:43], v[228:231], v[132:135]
  ds_read_b64_tr_b16 v[78:79], v13 offset:42240
  v_mfma_f32_16x16x32_bf16 v[148:151], v[44:47], v[228:231], v[148:151]
  ds_read_b128 v[240:243], v14 offset:32768
  v_mfma_f32_16x16x32_bf16 v[164:167], v[48:51], v[228:231], v[164:167]
  ds_read_b128 v[244:247], v14 offset:33792
  v_mfma_f32_16x16x32_bf16 v[180:183], v[52:55], v[228:231], v[180:183]
  v_mfma_f32_16x16x32_bf16 v[196:199], v[56:59], v[228:231], v[196:199]
  ds_read_b64_tr_b16 v[80:81], v12 offset:41472
  v_mfma_f32_16x16x32_bf16 v[212:215], v[60:63], v[228:231], v[212:215]
  ds_read_b64_tr_b16 v[82:83], v12 offset:42496
  v_mfma_f32_16x16x32_bf16 v[104:107], v[32:35], v[232:235], v[104:107]
  ds_read_b64_tr_b16 v[84:85], v13 offset:41472
  v_mfma_f32_16x16x32_bf16 v[120:123], v[36:39], v[232:235], v[120:123]
  ds_read_b64_tr_b16 v[86:87], v13 offset:42496
  v_mfma_f32_16x16x32_bf16 v[136:139], v[40:43], v[232:235], v[136:139]
  v_mfma_f32_16x16x32_bf16 v[152:155], v[44:47], v[232:235], v[152:155]
  ds_read_b64_tr_b16 v[88:89], v12 offset:41728
  v_mfma_f32_16x16x32_bf16 v[168:171], v[48:51], v[232:235], v[168:171]
  ds_read_b64_tr_b16 v[90:91], v12 offset:42752
  v_mfma_f32_16x16x32_bf16 v[184:187], v[52:55], v[232:235], v[184:187]
  ds_read_b64_tr_b16 v[92:93], v13 offset:41728
  v_mfma_f32_16x16x32_bf16 v[200:203], v[56:59], v[232:235], v[200:203]
  ds_read_b64_tr_b16 v[94:95], v13 offset:42752
  v_mfma_f32_16x16x32_bf16 v[216:219], v[60:63], v[232:235], v[216:219]
  v_mfma_f32_16x16x32_bf16 v[108:111], v[32:35], v[236:239], v[108:111]
  ds_read_b128 v[248:251], v14 offset:34816
  v_mfma_f32_16x16x32_bf16 v[124:127], v[36:39], v[236:239], v[124:127]
  ds_read_b128 v[252:255], v14 offset:35840
  v_mfma_f32_16x16x32_bf16 v[140:143], v[40:43], v[236:239], v[140:143]
  v_mfma_f32_16x16x32_bf16 v[156:159], v[44:47], v[236:239], v[156:159]
  v_xor_b32 v14, 0x10000, v14
  v_mfma_f32_16x16x32_bf16 v[172:175], v[48:51], v[236:239], v[172:175]
  v_mfma_f32_16x16x32_bf16 v[188:191], v[52:55], v[236:239], v[188:191]
  v_xor_b32 v12, 0x10000, v12
  v_mfma_f32_16x16x32_bf16 v[204:207], v[56:59], v[236:239], v[204:207]
  v_xor_b32 v13, 0x10000, v13
  v_mfma_f32_16x16x32_bf16 v[220:223], v[60:63], v[236:239], v[220:223]
  s_waitcnt lgkmcnt(0)
  v_mfma_f32_16x16x32_bf16 v[96:99], v[64:67], v[240:243], v[96:99]
  s_barrier
  v_mfma_f32_16x16x32_bf16 v[112:115], v[68:71], v[240:243], v[112:115]
  v_mfma_f32_16x16x32_bf16 v[128:131], v[72:75], v[240:243], v[128:131]
  v_mfma_f32_16x16x32_bf16 v[144:147], v[76:79], v[240:243], v[144:147]
  v_mfma_f32_16x16x32_bf16 v[160:163], v[80:83], v[240:243], v[160:163]
  v_mfma_f32_16x16x32_bf16 v[176:179], v[84:87], v[240:243], v[176:179]
  v_mfma_f32_16x16x32_bf16 v[192:195], v[88:91], v[240:243], v[192:195]
  v_mfma_f32_16x16x32_bf16 v[208:211], v[92:95], v[240:243], v[208:211]
  v_mfma_f32_16x16x32_bf16 v[100:103], v[64:67], v[244:247], v[100:103]
  v_mfma_f32_16x16x32_bf16 v[116:119], v[68:71], v[244:247], v[116:119]
  v_mfma_f32_16x16x32_bf16 v[132:135], v[72:75], v[244:247], v[132:135]
  v_mfma_f32_16x16x32_bf16 v[148:151], v[76:79], v[244:247], v[148:151]
  v_mfma_f32_16x16x32_bf16 v[164:167], v[80:83], v[244:247], v[164:167]
  v_mfma_f32_16x16x32_bf16 v[180:183], v[84:87], v[244:247], v[180:183]
  v_mfma_f32_16x16x32_bf16 v[196:199], v[88:91], v[244:247], v[196:199]
  v_mfma_f32_16x16x32_bf16 v[212:215], v[92:95], v[244:247], v[212:215]
  v_mfma_f32_16x16x32_bf16 v[104:107], v[64:67], v[248:251], v[104:107]
  v_mfma_f32_16x16x32_bf16 v[120:123], v[68:71], v[248:251], v[120:123]
  v_mfma_f32_16x16x32_bf16 v[136:139], v[72:75], v[248:251], v[136:139]
  v_mfma_f32_16x16x32_bf16 v[152:155], v[76:79], v[248:251], v[152:155]
  v_mfma_f32_16x16x32_bf16 v[168:171], v[80:83], v[248:251], v[168:171]
  v_mfma_f32_16x16x32_bf16 v[184:187], v[84:87], v[248:251], v[184:187]
  v_mfma_f32_16x16x32_bf16 v[200:203], v[88:91], v[248:251], v[200:203]
  v_mfma_f32_16x16x32_bf16 v[216:219], v[92:95], v[248:251], v[216:219]
  v_mfma_f32_16x16x32_bf16 v[108:111], v[64:67], v[252:255], v[108:111]
  v_mfma_f32_16x16x32_bf16 v[124:127], v[68:71], v[252:255], v[124:127]
  v_mfma_f32_16x16x32_bf16 v[140:143], v[72:75], v[252:255], v[140:143]
  v_mfma_f32_16x16x32_bf16 v[156:159], v[76:79], v[252:255], v[156:159]
  v_mfma_f32_16x16x32_bf16 v[172:175], v[80:83], v[252:255], v[172:175]
  v_mfma_f32_16x16x32_bf16 v[188:191], v[84:87], v[252:255], v[188:191]
  v_mfma_f32_16x16x32_bf16 v[204:207], v[88:91], v[252:255], v[204:207]
  v_mfma_f32_16x16x32_bf16 v[220:223], v[92:95], v[252:255], v[220:223]
  s_and_b32 s23, s20, 1
  s_lshl_b32 s23, s23, 12
  s_cmp_lt_u32 s20, 2
  s_cselect_b32 s24, 106496, 0
  s_add_u32 s24, s24, s23
  s_lshl_b32 s26, s20, 12
  s_mov_b32 s27, s26
  s_add_u32 s25, s27, 49152
  s_load_dwordx4 s[4:7], s[0:1], 64
  s_load_dwordx2 s[8:9], s[0:1], 80
  v_mov_b32 v12, 0x3e0293ee
  v_mov_b32 v13, 0x3e0293ee
  s_waitcnt vmcnt(0)
  v_cmp_eq_u32 vcc, 0, v15
  s_cbranch_vccnz fa_kv_spin
fa_kv_ok:
  s_mov_b32 m0, s24
  s_nop 0
  buffer_load_dwordx4 v2, s[44:47], s26 offen offset:0 sc1 lds
  v_pk_mul_f32 v[96:97], v[96:97], v[12:13]
  v_pk_mul_f32 v[98:99], v[98:99], v[12:13]
  v_cvt_pk_bf16_f32 v32, v96, v97
  v_cvt_pk_bf16_f32 v33, v98, v99
  v_pk_mul_f32 v[112:113], v[112:113], v[12:13]
  v_pk_mul_f32 v[114:115], v[114:115], v[12:13]
  v_cvt_pk_bf16_f32 v34, v112, v113
  buffer_load_dwordx4 v2, s[44:47], s26 offen offset:1024 sc1 lds
  v_cvt_pk_bf16_f32 v35, v114, v115
  v_pk_mul_f32 v[100:101], v[100:101], v[12:13]
  v_pk_mul_f32 v[102:103], v[102:103], v[12:13]
  v_cvt_pk_bf16_f32 v36, v100, v101
  v_cvt_pk_bf16_f32 v37, v102, v103
  v_pk_mul_f32 v[116:117], v[116:117], v[12:13]
  v_pk_mul_f32 v[118:119], v[118:119], v[12:13]
  buffer_load_dwordx4 v2, s[44:47], s26 offen offset:2048 sc1 lds
  v_cvt_pk_bf16_f32 v38, v116, v117
  v_cvt_pk_bf16_f32 v39, v118, v119
  v_pk_mul_f32 v[128:129], v[128:129], v[12:13]
  v_pk_mul_f32 v[130:131], v[130:131], v[12:13]
  v_cvt_pk_bf16_f32 v40, v128, v129
  v_cvt_pk_bf16_f32 v41, v130, v131
  v_pk_mul_f32 v[144:145], v[144:145], v[12:13]
  buffer_load_dwordx4 v2, s[44:47], s26 offen offset:3072 sc1 lds
  v_pk_mul_f32 v[146:147], v[146:147], v[12:13]
  v_cvt_pk_bf16_f32 v42, v144, v145
  v_cvt_pk_bf16_f32 v43, v146, v147
  v_pk_mul_f32 v[132:133], v[132:133], v[12:13]
  v_pk_mul_f32 v[134:135], v[134:135], v[12:13]
  v_cvt_pk_bf16_f32 v44, v132, v133
  v_cvt_pk_bf16_f32 v45, v134, v135
  s_add_u32 s26, s26, 16384
  s_add_u32 s24, s24, 32768
  s_and_b32 s24, s24, 0x1ffff
  s_mov_b32 m0, s24
  s_nop 0
  buffer_load_dwordx4 v2, s[44:47], s26 offen offset:0 sc1 lds
  v_pk_mul_f32 v[148:149], v[148:149], v[12:13]
  v_pk_mul_f32 v[150:151], v[150:151], v[12:13]
  v_cvt_pk_bf16_f32 v46, v148, v149
  v_cvt_pk_bf16_f32 v47, v150, v151
  v_pk_mul_f32 v[160:161], v[160:161], v[12:13]
  v_pk_mul_f32 v[162:163], v[162:163], v[12:13]
  v_cvt_pk_bf16_f32 v48, v160, v161
  buffer_load_dwordx4 v2, s[44:47], s26 offen offset:1024 sc1 lds
  v_cvt_pk_bf16_f32 v49, v162, v163
  v_pk_mul_f32 v[176:177], v[176:177], v[12:13]
  v_pk_mul_f32 v[178:179], v[178:179], v[12:13]
  v_cvt_pk_bf16_f32 v50, v176, v177
  v_cvt_pk_bf16_f32 v51, v178, v179
  v_pk_mul_f32 v[164:165], v[164:165], v[12:13]
  v_pk_mul_f32 v[166:167], v[166:167], v[12:13]
  buffer_load_dwordx4 v2, s[44:47], s26 offen offset:2048 sc1 lds
  v_cvt_pk_bf16_f32 v52, v164, v165
  v_cvt_pk_bf16_f32 v53, v166, v167
  v_pk_mul_f32 v[180:181], v[180:181], v[12:13]
  v_pk_mul_f32 v[182:183], v[182:183], v[12:13]
  v_cvt_pk_bf16_f32 v54, v180, v181
  v_cvt_pk_bf16_f32 v55, v182, v183
  v_pk_mul_f32 v[192:193], v[192:193], v[12:13]
  buffer_load_dwordx4 v2, s[44:47], s26 offen offset:3072 sc1 lds
  v_pk_mul_f32 v[194:195], v[194:195], v[12:13]
  v_cvt_pk_bf16_f32 v56, v192, v193
  v_cvt_pk_bf16_f32 v57, v194, v195
  v_pk_mul_f32 v[208:209], v[208:209], v[12:13]
  v_pk_mul_f32 v[210:211], v[210:211], v[12:13]
  v_cvt_pk_bf16_f32 v58, v208, v209
  v_cvt_pk_bf16_f32 v59, v210, v211
  s_add_u32 s26, s26, 16384
  s_add_u32 s24, s24, 32768
  s_and_b32 s24, s24, 0x1ffff
  s_mov_b32 m0, s24
  s_nop 0
  buffer_load_dwordx4 v2, s[44:47], s26 offen offset:0 sc1 lds
  v_pk_mul_f32 v[196:197], v[196:197], v[12:13]
  v_pk_mul_f32 v[198:199], v[198:199], v[12:13]
  v_cvt_pk_bf16_f32 v60, v196, v197
  v_cvt_pk_bf16_f32 v61, v198, v199
  v_pk_mul_f32 v[212:213], v[212:213], v[12:13]
  v_pk_mul_f32 v[214:215], v[214:215], v[12:13]
  v_cvt_pk_bf16_f32 v62, v212, v213
  buffer_load_dwordx4 v2, s[44:47], s26 offen offset:1024 sc1 lds
  v_cvt_pk_bf16_f32 v63, v214, v215
  v_pk_mul_f32 v[104:105], v[104:105], v[12:13]
  v_pk_mul_f32 v[106:107], v[106:107], v[12:13]
  v_cvt_pk_bf16_f32 v64, v104, v105
  v_cvt_pk_bf16_f32 v65, v106, v107
  v_pk_mul_f32 v[120:121], v[120:121], v[12:13]
  v_pk_mul_f32 v[122:123], v[122:123], v[12:13]
  buffer_load_dwordx4 v2, s[44:47], s26 offen offset:2048 sc1 lds
  v_cvt_pk_bf16_f32 v66, v120, v121
  v_cvt_pk_bf16_f32 v67, v122, v123
  v_pk_mul_f32 v[108:109], v[108:109], v[12:13]
  v_pk_mul_f32 v[110:111], v[110:111], v[12:13]
  v_cvt_pk_bf16_f32 v68, v108, v109
  v_cvt_pk_bf16_f32 v69, v110, v111
  v_pk_mul_f32 v[124:125], v[124:125], v[12:13]
  buffer_load_dwordx4 v2, s[44:47], s26 offen offset:3072 sc1 lds
  v_pk_mul_f32 v[126:127], v[126:127], v[12:13]
  v_cvt_pk_bf16_f32 v70, v124, v125
  v_cvt_pk_bf16_f32 v71, v126, v127
  v_pk_mul_f32 v[136:137], v[136:137], v[12:13]
  v_pk_mul_f32 v[138:139], v[138:139], v[12:13]
  v_cvt_pk_bf16_f32 v72, v136, v137
  v_cvt_pk_bf16_f32 v73, v138, v139
  s_add_u32 s26, s26, 16384
  s_add_u32 s24, s24, 32768
  s_and_b32 s24, s24, 0x1ffff
  s_mov_b32 m0, s25
  s_nop 0
  buffer_load_dwordx4 v2, s[48:51], s27 offen offset:0 sc1 lds
  v_pk_mul_f32 v[152:153], v[152:153], v[12:13]
  v_pk_mul_f32 v[154:155], v[154:155], v[12:13]
  v_cvt_pk_bf16_f32 v74, v152, v153
  v_cvt_pk_bf16_f32 v75, v154, v155
  v_pk_mul_f32 v[140:141], v[140:141], v[12:13]
  v_pk_mul_f32 v[142:143], v[142:143], v[12:13]
  v_cvt_pk_bf16_f32 v76, v140, v141
  buffer_load_dwordx4 v2, s[48:51], s27 offen offset:1024 sc1 lds
  v_cvt_pk_bf16_f32 v77, v142, v143
  v_pk_mul_f32 v[156:157], v[156:157], v[12:13]
  v_pk_mul_f32 v[158:159], v[158:159], v[12:13]
  v_cvt_pk_bf16_f32 v78, v156, v157
  v_cvt_pk_bf16_f32 v79, v158, v159
  v_pk_mul_f32 v[168:169], v[168:169], v[12:13]
  v_pk_mul_f32 v[170:171], v[170:171], v[12:13]
  buffer_load_dwordx4 v2, s[48:51], s27 offen offset:2048 sc1 lds
  v_cvt_pk_bf16_f32 v80, v168, v169
  v_cvt_pk_bf16_f32 v81, v170, v171
  v_pk_mul_f32 v[184:185], v[184:185], v[12:13]
  v_pk_mul_f32 v[186:187], v[186:187], v[12:13]
  v_cvt_pk_bf16_f32 v82, v184, v185
  v_cvt_pk_bf16_f32 v83, v186, v187
  v_pk_mul_f32 v[172:173], v[172:173], v[12:13]
  buffer_load_dwordx4 v2, s[48:51], s27 offen offset:3072 sc1 lds
  v_pk_mul_f32 v[174:175], v[174:175], v[12:13]
  v_cvt_pk_bf16_f32 v84, v172, v173
  v_cvt_pk_bf16_f32 v85, v174, v175
  v_pk_mul_f32 v[188:189], v[188:189], v[12:13]
  v_pk_mul_f32 v[190:191], v[190:191], v[12:13]
  v_cvt_pk_bf16_f32 v86, v188, v189
  v_cvt_pk_bf16_f32 v87, v190, v191
  s_add_u32 s27, s27, 16384
  s_add_u32 s25, s25, 32768
  s_and_b32 s25, s25, 0x1ffff
  s_mov_b32 m0, s25
  s_nop 0
  buffer_load_dwordx4 v2, s[48:51], s27 offen offset:0 sc1 lds
  v_pk_mul_f32 v[200:201], v[200:201], v[12:13]
  v_pk_mul_f32 v[202:203], v[202:203], v[12:13]
  v_cvt_pk_bf16_f32 v88, v200, v201
  v_cvt_pk_bf16_f32 v89, v202, v203
  v_pk_mul_f32 v[216:217], v[216:217], v[12:13]
  v_pk_mul_f32 v[218:219], v[218:219], v[12:13]
  v_cvt_pk_bf16_f32 v90, v216, v217
  buffer_load_dwordx4 v2, s[48:51], s27 offen offset:1024 sc1 lds
  v_cvt_pk_bf16_f32 v91, v218, v219
  v_pk_mul_f32 v[204:205], v[204:205], v[12:13]
  v_pk_mul_f32 v[206:207], v[206:207], v[12:13]
  v_cvt_pk_bf16_f32 v92, v204, v205
  v_cvt_pk_bf16_f32 v93, v206, v207
  v_pk_mul_f32 v[220:221], v[220:221], v[12:13]
  v_pk_mul_f32 v[222:223], v[222:223], v[12:13]
  buffer_load_dwordx4 v2, s[48:51], s27 offen offset:2048 sc1 lds
  v_cvt_pk_bf16_f32 v94, v220, v221
  v_cvt_pk_bf16_f32 v95, v222, v223
  buffer_load_dwordx4 v2, s[48:51], s27 offen offset:3072 sc1 lds
  s_add_u32 s27, s27, 16384
  s_add_u32 s25, s25, 32768
  s_and_b32 s25, s25, 0x1ffff
  v_add_u32 v18, 106496, v2
  s_waitcnt vmcnt(12)
  s_barrier
  ds_read_b128 a[128:131], v18 offset:0
  ds_read_b128 a[132:135], v18 offset:1024
  ds_read_b128 a[136:139], v18 offset:2048
  ds_read_b128 a[140:143], v18 offset:3072
  ds_read_b128 a[144:147], v18 offset:4096
  ds_read_b128 a[148:151], v18 offset:5120
  ds_read_b128 a[152:155], v18 offset:6144
  ds_read_b128 a[156:159], v18 offset:7168
  s_and_b32 s62, s2, 1
  s_lshl_b32 s62, s62, 2
  s_add_u32 s62, s62, s20
  s_lshr_b32 s63, s2, 1
  s_mul_i32 s23, s63, 40960
  s_mul_i32 s31, s62, 160
  s_add_u32 s23, s23, s31
  s_mul_i32 s34, s20, 5120
  s_add_u32 s34, s34, 131072
  v_add_u32 v20, 0, v1
  v_mul_u32_u24 v19, 6554, v20
  s_add_u32 m0, s34, 0
  v_lshrrev_b32 v19, 16, v19
  v_mul_u32_u24 v19, 1120, v19
  v_lshl_add_u32 v19, v20, 4, v19
  buffer_load_dwordx4 v19, s[52:55], s23 offen lds
  v_accvgpr_write_b32 a248, v19
  v_add_u32 v20, 64, v1
  v_mul_u32_u24 v19, 6554, v20
  s_add_u32 m0, s34, 1024
  v_lshrrev_b32 v19, 16, v19
  v_mul_u32_u24 v19, 1120, v19
  v_lshl_add_u32 v19, v20, 4, v19
  buffer_load_dwordx4 v19, s[52:55], s23 offen lds
  v_accvgpr_write_b32 a249, v19
  v_add_u32 v20, 128, v1
  v_mul_u32_u24 v19, 6554, v20
  s_add_u32 m0, s34, 2048
  v_lshrrev_b32 v19, 16, v19
  v_mul_u32_u24 v19, 1120, v19
  v_lshl_add_u32 v19, v20, 4, v19
  buffer_load_dwordx4 v19, s[52:55], s23 offen lds
  v_accvgpr_write_b32 a250, v19
  v_add_u32 v20, 192, v1
  v_mul_u32_u24 v19, 6554, v20
  s_add_u32 m0, s34, 3072
  v_lshrrev_b32 v19, 16, v19
  v_mul_u32_u24 v19, 1120, v19
  v_lshl_add_u32 v19, v20, 4, v19
  buffer_load_dwordx4 v19, s[52:55], s23 offen lds
  v_accvgpr_write_b32 a251, v19
  v_add_u32 v20, 256, v1
  v_mul_u32_u24 v19, 6554, v20
  s_add_u32 m0, s34, 4096
  v_lshrrev_b32 v19, 16, v19
  v_mul_u32_u24 v19, 1120, v19
  v_lshl_add_u32 v19, v20, 4, v19
  buffer_load_dwordx4 v19, s[52:55], s23 offen lds
  v_accvgpr_write_b32 a252, v19
  v_lshrrev_b32 v6, 2, v1
  v_mul_u32_u24 v6, 160, v6
  v_and_b32 v19, 3, v1
  v_lshl_add_u32 v6, v19, 3, v6
  v_add_u32 v6, s34, v6
  s_lshl_b32 s30, s62, 7
  s_add_u32 s30, s30, s63
  s_mul_i32 s30, s30, 5120
  s_add_u32 s30, s30, 4194304
  s_waitcnt lgkmcnt(0)
  s_cmp_ge_u32 s20, 2
  s_cselect_b32 s4, s6, s4
  s_cselect_b32 s5, s7, s5
  s_mov_b32 s52, s4
  s_mov_b32 s53, s5
  s_mov_b32 s54, 2211840
  s_mov_b32 s55, 0x20000
  s_mov_b32 s60, s8
  s_mov_b32 s61, s9
  s_mov_b32 s62, 2211840
  s_mov_b32 s63, 0x20000
  v_mov_b32 v228, 0
  v_mov_b32 v229, 0
  v_mov_b32 v230, 0
  v_mov_b32 v231, 0
  s_add_u32 s23, s20, 1
  s_lshr_b32 s23, s23, 1
  s_lshl_b32 s28, s22, 1
  s_add_u32 s28, s28, s23
  s_lshl_b32 s23, s22, 2
  s_sub_u32 s29, 28, s23
  s_and_b32 s23, s20, 1
  s_add_u32 s29, s29, s23
  v_mov_b32 v3, v2
  v_mov_b32 v4, 0xff800000
  s_cmp_eq_u32 s2, 255
  s_cbranch_scc1 fa_top8
fa_notop:
  s_mov_b32 s32, 0
  s_mov_b32 s11, 0
  s_mov_b32 s12, 0
  s_lshl_b32 s15, s22, 1
  s_sub_u32 s15, 25, s15
  s_lshl_b32 s15, s15, 14
  s_getpc_b64 s[36:37]
fa_copc:
  s_add_u32 s36, s36, fa_co-fa_copc-4
  s_addc_u32 s37, s37, 0
  s_waitcnt lgkmcnt(0)
  v_mfma_f32_16x16x32_bf16 v[96:99], a[128:131], v[32:35], 0
  v_mfma_f32_16x16x32_bf16 v[104:107], a[128:131], v[36:39], 0
  v_mfma_f32_16x16x32_bf16 v[128:131], a[128:131], v[64:67], 0
  v_mfma_f32_16x16x32_bf16 v[136:139], a[128:131], v[68:71], 0
  s_mov_b32 m0, s24
  ds_read_b128 a[128:131], v3 offset:0
  v_mfma_f32_16x16x32_bf16 v[100:103], a[132:135], v[32:35], 0
  buffer_load_dwordx4 v2, s[44:47], s26 offen offset:0 sc1 lds
  v_mfma_f32_16x16x32_bf16 v[108:111], a[132:135], v[36:39], 0
  v_mfma_f32_16x16x32_bf16 v[132:135], a[132:135], v[64:67], 0
  v_mfma_f32_16x16x32_bf16 v[140:143], a[132:135], v[68:71], 0
  ds_read_b128 a[132:135], v3 offset:1024
  v_mfma_f32_16x16x32_bf16 v[96:99], a[136:139], v[40:43], v[96:99]
  v_mfma_f32_16x16x32_bf16 v[104:107], a[136:139], v[44:47], v[104:107]
  v_mfma_f32_16x16x32_bf16 v[128:131], a[136:139], v[72:75], v[128:131]
  buffer_load_dwordx4 v2, s[44:47], s26 offen offset:1024 sc1 lds
  v_mfma_f32_16x16x32_bf16 v[136:139], a[136:139], v[76:79], v[136:139]
  ds_read_b128 a[136:139], v3 offset:2048
  v_mfma_f32_16x16x32_bf16 v[100:103], a[140:143], v[40:43], v[100:103]
  v_mfma_f32_16x16x32_bf16 v[108:111], a[140:143], v[44:47], v[108:111]
  v_mfma_f32_16x16x32_bf16 v[132:135], a[140:143], v[72:75], v[132:135]
  v_mfma_f32_16x16x32_bf16 v[140:143], a[140:143], v[76:79], v[140:143]
  s_waitcnt lgkmcnt(3)
  ds_read_b128 a[140:143], v3 offset:3072
  v_mfma_f32_16x16x32_bf16 v[96:99], a[144:147], v[48:51], v[96:99]
  v_mfma_f32_16x16x32_bf16 v[104:107], a[144:147], v[52:55], v[104:107]
  v_mfma_f32_16x16x32_bf16 v[128:131], a[144:147], v[80:83], v[128:131]
  buffer_load_dwordx4 v2, s[44:47], s26 offen offset:2048 sc1 lds
  v_mfma_f32_16x16x32_bf16 v[136:139], a[144:147], v[84:87], v[136:139]
  ds_read_b128 a[144:147], v3 offset:4096
  v_mfma_f32_16x16x32_bf16 v[100:103], a[148:151], v[48:51], v[100:103]
  v_mfma_f32_16x16x32_bf16 v[108:111], a[148:151], v[52:55], v[108:111]
  v_mfma_f32_16x16x32_bf16 v[132:135], a[148:151], v[80:83], v[132:135]
  v_mfma_f32_16x16x32_bf16 v[140:143], a[148:151], v[84:87], v[140:143]
  ds_read_b128 a[148:151], v3 offset:5120
  v_mfma_f32_16x16x32_bf16 v[96:99], a[152:155], v[56:59], v[96:99]
  buffer_load_dwordx4 v2, s[44:47], s26 offen offset:3072 sc1 lds
  v_mfma_f32_16x16x32_bf16 v[104:107], a[152:155], v[60:63], v[104:107]
  s_add_u32 s26, s26, 16384
  v_mfma_f32_16x16x32_bf16 v[128:131], a[152:155], v[88:91], v[128:131]
  s_add_u32 s24, s24, 32768
  v_mfma_f32_16x16x32_bf16 v[136:139], a[152:155], v[92:95], v[136:139]
  s_and_b32 s24, s24, 0x1ffff
  ds_read_b128 a[152:155], v3 offset:6144
  v_mfma_f32_16x16x32_bf16 v[100:103], a[156:159], v[56:59], v[100:103]
  v_mfma_f32_16x16x32_bf16 v[108:111], a[156:159], v[60:63], v[108:111]
  v_mfma_f32_16x16x32_bf16 v[132:135], a[156:159], v[88:91], v[132:135]
  v_mfma_f32_16x16x32_bf16 v[140:143], a[156:159], v[92:95], v[140:143]
  s_waitcnt lgkmcnt(3)
  ds_read_b128 a[156:159], v3 offset:7168
  s_nop 7
  s_cmp_lg_u32 s28, 0
  s_cbranch_scc1 fa_nomask0
  v_cndmask_b32 v96, v4, v96, s[68:69]
  v_cndmask_b32 v97, v4, v97, s[70:71]
  v_cndmask_b32 v98, v4, v98, s[72:73]
  v_cndmask_b32 v99, v4, v99, s[74:75]
  v_mov_b32 v100, v4
  v_mov_b32 v101, v4
  v_mov_b32 v102, v4
  v_mov_b32 v103, v4
  v_cndmask_b32 v108, v4, v108, s[68:69]
  v_cndmask_b32 v109, v4, v109, s[70:71]
  v_cndmask_b32 v110, v4, v110, s[72:73]
  v_cndmask_b32 v111, v4, v111, s[74:75]
fa_nomask0:
  v_max3_f32 v16, v96, v97, v98
  v_max3_f32 v16, v16, v99, v100
  v_max3_f32 v16, v16, v101, v102
  v_max_f32 v16, v16, v103
  v_max3_f32 v17, v104, v105, v106
  v_max3_f32 v17, v17, v107, v108
  v_max3_f32 v17, v17, v109, v110
  v_max_f32 v17, v17, v111
  v_max3_f32 v18, v128, v129, v130
  v_max3_f32 v18, v18, v131, v132
  v_max3_f32 v18, v18, v133, v134
  v_max_f32 v18, v18, v135
  v_max3_f32 v19, v136, v137, v138
  v_max3_f32 v19, v19, v139, v140
  v_max3_f32 v19, v19, v141, v142
  v_max_f32 v19, v19, v143
  v_mov_b32 v20, v16
  v_mov_b32 v21, v17
  v_mov_b32 v22, v18
  v_mov_b32 v23, v19
  s_nop 0
  v_permlane16_swap_b32 v16, v20
  v_permlane16_swap_b32 v17, v21
  v_permlane16_swap_b32 v18, v22
  v_permlane16_swap_b32 v19, v23
  v_max_f32 v16, v16, v20
  v_max_f32 v17, v17, v21
  v_max_f32 v18, v18, v22
  v_max_f32 v19, v19, v23
  v_mov_b32 v20, v16
  v_mov_b32 v21, v17
  v_mov_b32 v22, v18
  v_mov_b32 v23, v19
  s_nop 0
  v_permlane32_swap_b32 v16, v20
  v_permlane32_swap_b32 v17, v21
  v_permlane32_swap_b32 v18, v22
  v_permlane32_swap_b32 v19, v23
  v_max_f32 v16, v16, v20
  v_max_f32 v17, v17, v21
  v_max_f32 v18, v18, v22
  v_max_f32 v19, v19, v23
  v_sub_f32 v192, 0, v16
  v_sub_f32 v193, 0, v16
  v_sub_f32 v194, 0, v16
  v_sub_f32 v195, 0, v16
  v_sub_f32 v196, 0, v17
  v_sub_f32 v197, 0, v17
  v_sub_f32 v198, 0, v17
  v_sub_f32 v199, 0, v17
  v_sub_f32 v200, 0, v18
  v_sub_f32 v201, 0, v18
  v_sub_f32 v202, 0, v18
  v_sub_f32 v203, 0, v18
  v_sub_f32 v204, 0, v19
  v_sub_f32 v205, 0, v19
  v_sub_f32 v206, 0, v19
  v_sub_f32 v207, 0, v19
  v_sub_f32 v96, v96, v16
  v_sub_f32 v97, v97, v16
  v_sub_f32 v98, v98, v16
  v_sub_f32 v99, v99, v16
  v_sub_f32 v100, v100, v16
  v_sub_f32 v101, v101, v16
  v_sub_f32 v102, v102, v16
  v_sub_f32 v103, v103, v16
  v_sub_f32 v104, v104, v17
  v_sub_f32 v105, v105, v17
  v_sub_f32 v106, v106, v17
  v_sub_f32 v107, v107, v17
  v_sub_f32 v108, v108, v17
  v_sub_f32 v109, v109, v17
  v_sub_f32 v110, v110, v17
  v_sub_f32 v111, v111, v17
  v_sub_f32 v128, v128, v18
  v_sub_f32 v129, v129, v18
  v_sub_f32 v130, v130, v18
  v_sub_f32 v131, v131, v18
  v_sub_f32 v132, v132, v18
  v_sub_f32 v133, v133, v18
  v_sub_f32 v134, v134, v18
  v_sub_f32 v135, v135, v18
  v_sub_f32 v136, v136, v19
  v_sub_f32 v137, v137, v19
  v_sub_f32 v138, v138, v19
  v_sub_f32 v139, v139, v19
  v_sub_f32 v140, v140, v19
  v_sub_f32 v141, v141, v19
  v_sub_f32 v142, v142, v19
  v_sub_f32 v143, v143, v19
  v_mfma_f32_16x16x32_bf16 v[112:115], a[128:131], v[32:35], v[192:195]
  v_exp_f32 v208, v96
  v_exp_f32 v209, v97
  v_mfma_f32_16x16x32_bf16 v[120:123], a[128:131], v[36:39], v[196:199]
  v_exp_f32 v210, v98
  v_exp_f32 v211, v99
  v_mfma_f32_16x16x32_bf16 v[144:147], a[128:131], v[64:67], v[200:203]
  v_exp_f32 v212, v100
  v_exp_f32 v213, v101
  v_mfma_f32_16x16x32_bf16 v[152:155], a[128:131], v[68:71], v[204:207]
  s_mov_b32 m0, s25
  ds_read_b128 a[128:131], v3 offset:8192
  v_exp_f32 v214, v102
  v_add_f32 v224, v208, v209
  v_mfma_f32_16x16x32_bf16 v[116:119], a[132:135], v[32:35], v[192:195]
  buffer_load_dwordx4 v2, s[48:51], s27 offen offset:0 sc1 lds
  v_exp_f32 v215, v103
  v_cvt_pk_bf16_f32 v160, v208, v209
  v_mfma_f32_16x16x32_bf16 v[124:127], a[132:135], v[36:39], v[196:199]
  v_exp_f32 v208, v104
  v_add_f32 v224, v224, v210
  v_add_f32 v224, v224, v211
  v_mfma_f32_16x16x32_bf16 v[148:151], a[132:135], v[64:67], v[200:203]
  v_exp_f32 v209, v105
  v_cvt_pk_bf16_f32 v161, v210, v211
  v_add_f32 v224, v224, v212
  v_mfma_f32_16x16x32_bf16 v[156:159], a[132:135], v[68:71], v[204:207]
  ds_read_b128 a[132:135], v3 offset:9216
  v_exp_f32 v210, v106
  v_mfma_f32_16x16x32_bf16 v[112:115], a[136:139], v[40:43], v[112:115]
  v_exp_f32 v211, v107
  v_add_f32 v224, v224, v213
  v_cvt_pk_bf16_f32 v162, v212, v213
  v_mfma_f32_16x16x32_bf16 v[120:123], a[136:139], v[44:47], v[120:123]
  v_exp_f32 v212, v108
  v_add_f32 v224, v224, v214
  v_add_f32 v224, v224, v215
  v_mfma_f32_16x16x32_bf16 v[144:147], a[136:139], v[72:75], v[144:147]
  buffer_load_dwordx4 v2, s[48:51], s27 offen offset:1024 sc1 lds
  v_exp_f32 v213, v109
  v_cvt_pk_bf16_f32 v163, v214, v215
  v_mfma_f32_16x16x32_bf16 v[152:155], a[136:139], v[76:79], v[152:155]
  ds_read_b128 a[136:139], v3 offset:10240
  v_exp_f32 v214, v110
  v_add_f32 v225, v208, v209
  v_mfma_f32_16x16x32_bf16 v[116:119], a[140:143], v[40:43], v[116:119]
  v_exp_f32 v215, v111
  v_exp_f32 v216, v128
  v_mfma_f32_16x16x32_bf16 v[124:127], a[140:143], v[44:47], v[124:127]
  v_exp_f32 v217, v129
  v_exp_f32 v218, v130
  v_mfma_f32_16x16x32_bf16 v[148:151], a[140:143], v[72:75], v[148:151]
  v_exp_f32 v219, v131
  v_exp_f32 v220, v132
  v_mfma_f32_16x16x32_bf16 v[156:159], a[140:143], v[76:79], v[156:159]
  s_waitcnt lgkmcnt(3)
  ds_read_b128 a[140:143], v3 offset:11264
  v_exp_f32 v221, v133
  v_cvt_pk_bf16_f32 v164, v208, v209
  v_mfma_f32_16x16x32_bf16 v[112:115], a[144:147], v[48:51], v[112:115]
  v_exp_f32 v222, v134
  v_exp_f32 v223, v135
  v_mfma_f32_16x16x32_bf16 v[120:123], a[144:147], v[52:55], v[120:123]
  v_add_f32 v225, v225, v210
  v_add_f32 v225, v225, v211
  v_cvt_pk_bf16_f32 v165, v210, v211
  v_add_f32 v225, v225, v212
  v_mfma_f32_16x16x32_bf16 v[144:147], a[144:147], v[80:83], v[144:147]
  buffer_load_dwordx4 v2, s[48:51], s27 offen offset:2048 sc1 lds
  v_add_f32 v225, v225, v213
  v_cvt_pk_bf16_f32 v166, v212, v213
  v_add_f32 v225, v225, v214
  v_mfma_f32_16x16x32_bf16 v[152:155], a[144:147], v[84:87], v[152:155]
  ds_read_b128 a[144:147], v3 offset:12288
  v_add_f32 v225, v225, v215
  v_cvt_pk_bf16_f32 v167, v214, v215
  v_add_f32 v226, v216, v217
  v_mfma_f32_16x16x32_bf16 v[116:119], a[148:151], v[48:51], v[116:119]
  v_cvt_pk_bf16_f32 v176, v216, v217
  v_exp_f32 v216, v136
  v_add_f32 v226, v226, v218
  v_mfma_f32_16x16x32_bf16 v[124:127], a[148:151], v[52:55], v[124:127]
  v_exp_f32 v217, v137
  v_add_f32 v226, v226, v219
  v_cvt_pk_bf16_f32 v177, v218, v219
  v_mfma_f32_16x16x32_bf16 v[148:151], a[148:151], v[80:83], v[148:151]
  v_exp_f32 v218, v138
  v_add_f32 v226, v226, v220
  v_add_f32 v226, v226, v221
  v_mfma_f32_16x16x32_bf16 v[156:159], a[148:151], v[84:87], v[156:159]
  ds_read_b128 a[148:151], v3 offset:13312
  v_exp_f32 v219, v139
  v_mfma_f32_16x16x32_bf16 v[112:115], a[152:155], v[56:59], v[112:115]
  buffer_load_dwordx4 v2, s[48:51], s27 offen offset:3072 sc1 lds
  v_cvt_pk_bf16_f32 v178, v220, v221
  v_exp_f32 v220, v140
  v_mfma_f32_16x16x32_bf16 v[120:123], a[152:155], v[60:63], v[120:123]
  s_add_u32 s27, s27, 16384
  v_add_f32 v226, v226, v222
  v_add_f32 v226, v226, v223
  v_cvt_pk_bf16_f32 v179, v222, v223
  v_add_f32 v227, v216, v217
  v_mfma_f32_16x16x32_bf16 v[144:147], a[152:155], v[88:91], v[144:147]
  s_add_u32 s25, s25, 32768
  v_exp_f32 v221, v141
  v_cvt_pk_bf16_f32 v180, v216, v217
  v_add_f32 v227, v227, v218
  v_mfma_f32_16x16x32_bf16 v[152:155], a[152:155], v[92:95], v[152:155]
  s_and_b32 s25, s25, 0x1ffff
  ds_read_b128 a[152:155], v3 offset:14336
  v_add_f32 v227, v227, v219
  v_cvt_pk_bf16_f32 v181, v218, v219
  v_max3_f32 v5, v224, v225, v226
  v_mfma_f32_16x16x32_bf16 v[116:119], a[156:159], v[56:59], v[116:119]
  v_exp_f32 v222, v142
  v_add_f32 v227, v227, v220
  v_add_f32 v227, v227, v221
  v_mfma_f32_16x16x32_bf16 v[124:127], a[156:159], v[60:63], v[124:127]
  v_exp_f32 v223, v143
  v_cvt_pk_bf16_f32 v182, v220, v221
  v_add_f32 v227, v227, v222
  v_mfma_f32_16x16x32_bf16 v[148:151], a[156:159], v[88:91], v[148:151]
  v_add_f32 v227, v227, v223
  v_cvt_pk_bf16_f32 v183, v222, v223
  v_max_f32 v5, v5, v227
  v_cmp_lt_f32 vcc, s81, v5
  v_mfma_f32_16x16x32_bf16 v[156:159], a[156:159], v[92:95], v[156:159]
  s_waitcnt lgkmcnt(3)
  s_cbranch_vccnz fa_stub0
fa_back0:
  ds_read_b128 a[156:159], v3 offset:15360
  v_add_f32 v228, v228, v224
  v_add_f32 v229, v229, v225
  v_add_f32 v230, v230, v226
  v_add_f32 v231, v231, v227
  v_add_u32 v3, 32768, v3
  v_and_b32 v3, 0x1ffff, v3
  s_cmp_eq_u32 s28, 0
  s_cbranch_scc1 fa_AV
  s_sub_u32 s28, s28, 1
  s_cmp_eq_u32 s28, 0
  s_cbranch_scc1 fa_Aexit
.p2align 6
fa_DD:
  v_mfma_f32_16x16x32_bf16 v[96:99], a[128:131], v[32:35], v[192:195]
  s_waitcnt vmcnt(12)
  v_exp_f32 v208, v112
  v_mfma_f32_16x16x32_bf16 v[104:107], a[128:131], v[36:39], v[196:199]
  s_barrier
  v_exp_f32 v209, v113
  v_mfma_f32_16x16x32_bf16 v[128:131], a[128:131], v[64:67], v[200:203]
  s_cmp_ge_u32 s26, s32
  ds_read_b128 a[160:163], v3 offset:16384
  v_add_f32 v224, v208, v209
  v_mfma_f32_16x16x32_bf16 v[136:139], a[128:131], v[68:71], v[204:207]
  s_cbranch_scc1 fa_hk0
fa_hb0:
  v_exp_f32 v210, v114
  v_mfma_f32_16x16x32_bf16 v[100:103], a[132:135], v[32:35], v[192:195]
  ds_read_b128 a[164:167], v3 offset:17408
  v_cvt_pk_bf16_f32 v168, v208, v209
  v_mfma_f32_16x16x32_bf16 v[108:111], a[132:135], v[36:39], v[196:199]
  s_mov_b32 m0, s24
  v_exp_f32 v211, v115
  v_mfma_f32_16x16x32_bf16 v[132:135], a[132:135], v[64:67], v[200:203]
  buffer_load_dwordx4 v2, s[44:47], s26 offen offset:0 sc1 lds
  v_add_f32 v224, v224, v210
  v_add_f32 v224, v224, v211
  v_mfma_f32_16x16x32_bf16 v[140:143], a[132:135], v[68:71], v[204:207]
  v_exp_f32 v212, v116
  v_mfma_f32_16x16x32_bf16 v[96:99], a[136:139], v[40:43], v[96:99]
  ds_read_b128 a[168:171], v3 offset:18432
  v_cvt_pk_bf16_f32 v169, v210, v211
  v_mfma_f32_16x16x32_bf16 v[104:107], a[136:139], v[44:47], v[104:107]
  v_exp_f32 v213, v117
  v_mfma_f32_16x16x32_bf16 v[128:131], a[136:139], v[72:75], v[128:131]
  v_exp_f32 v214, v118
  v_mfma_f32_16x16x32_bf16 v[136:139], a[136:139], v[76:79], v[136:139]
  v_exp_f32 v215, v119
  v_mfma_f32_16x16x32_bf16 v[100:103], a[140:143], v[40:43], v[100:103]
  ds_read_b128 a[172:175], v3 offset:19456
  v_add_f32 v224, v224, v212
  v_mfma_f32_16x16x32_bf16 v[108:111], a[140:143], v[44:47], v[108:111]
  v_exp_f32 v208, v120
  v_mfma_f32_16x16x32_bf16 v[132:135], a[140:143], v[72:75], v[132:135]
  v_exp_f32 v209, v121
  v_mfma_f32_16x16x32_bf16 v[140:143], a[140:143], v[76:79], v[140:143]
  s_waitcnt lgkmcnt(4)
  v_exp_f32 v210, v122
  v_mfma_f32_16x16x32_bf16 v[96:99], a[144:147], v[48:51], v[96:99]
  ds_read_b128 a[176:179], v3 offset:20480
  v_add_f32 v224, v224, v213
  v_mfma_f32_16x16x32_bf16 v[104:107], a[144:147], v[52:55], v[104:107]
  v_exp_f32 v211, v123
  v_mfma_f32_16x16x32_bf16 v[128:131], a[144:147], v[80:83], v[128:131]
  v_cvt_pk_bf16_f32 v170, v212, v213
  v_add_f32 v224, v224, v214
  v_add_f32 v224, v224, v215
  v_mfma_f32_16x16x32_bf16 v[136:139], a[144:147], v[84:87], v[136:139]
  v_exp_f32 v212, v124
  v_mfma_f32_16x16x32_bf16 v[100:103], a[148:151], v[48:51], v[100:103]
  ds_read_b128 a[180:183], v3 offset:21504
  v_cvt_pk_bf16_f32 v171, v214, v215
  v_mfma_f32_16x16x32_bf16 v[108:111], a[148:151], v[52:55], v[108:111]
  v_exp_f32 v213, v125
  v_mfma_f32_16x16x32_bf16 v[132:135], a[148:151], v[80:83], v[132:135]
  buffer_load_dwordx4 v2, s[44:47], s26 offen offset:1024 sc1 lds
  v_add_f32 v225, v208, v209
  v_mfma_f32_16x16x32_bf16 v[140:143], a[148:151], v[84:87], v[140:143]
  v_exp_f32 v214, v126
  v_mfma_f32_16x16x32_bf16 v[96:99], a[152:155], v[56:59], v[96:99]
  ds_read_b128 a[184:187], v3 offset:22528
  v_cvt_pk_bf16_f32 v172, v208, v209
  v_mfma_f32_16x16x32_bf16 v[104:107], a[152:155], v[60:63], v[104:107]
  v_exp_f32 v215, v127
  v_mfma_f32_16x16x32_bf16 v[128:131], a[152:155], v[88:91], v[128:131]
  v_exp_f32 v216, v144
  v_mfma_f32_16x16x32_bf16 v[136:139], a[152:155], v[92:95], v[136:139]
  v_exp_f32 v217, v145
  v_mfma_f32_16x16x32_bf16 v[100:103], a[156:159], v[56:59], v[100:103]
  ds_read_b128 a[188:191], v3 offset:23552
  v_add_f32 v225, v225, v210
  v_mfma_f32_16x16x32_bf16 v[108:111], a[156:159], v[60:63], v[108:111]
  v_exp_f32 v218, v146
  v_mfma_f32_16x16x32_bf16 v[132:135], a[156:159], v[88:91], v[132:135]
  v_exp_f32 v219, v147
  v_mfma_f32_16x16x32_bf16 v[140:143], a[156:159], v[92:95], v[140:143]
  s_waitcnt lgkmcnt(4)
  v_exp_f32 v220, v148
  v_add_f32 v225, v225, v211
  v_mfma_f32_16x16x32_bf16 a[0:3], a[160:163], v[160:163], a[0:3]
  ds_read_b128 a[128:131], v3 offset:0
  v_cvt_pk_bf16_f32 v173, v210, v211
  v_mfma_f32_16x16x32_bf16 a[4:7], a[160:163], v[164:167], a[4:7]
  v_exp_f32 v221, v149
  v_mfma_f32_16x16x32_bf16 a[64:67], a[160:163], v[176:179], a[64:67]
  v_exp_f32 v222, v150
  v_mfma_f32_16x16x32_bf16 a[68:71], a[160:163], v[180:183], a[68:71]
  v_exp_f32 v223, v151
  v_mfma_f32_16x16x32_bf16 a[8:11], a[164:167], v[160:163], a[8:11]
  ds_read_b128 a[132:135], v3 offset:1024
  v_add_f32 v225, v225, v212
  v_mfma_f32_16x16x32_bf16 a[12:15], a[164:167], v[164:167], a[12:15]
  v_add_f32 v225, v225, v213
  v_cvt_pk_bf16_f32 v174, v212, v213
  v_mfma_f32_16x16x32_bf16 a[72:75], a[164:167], v[176:179], a[72:75]
  buffer_load_dwordx4 v2, s[44:47], s26 offen offset:2048 sc1 lds
  v_add_f32 v225, v225, v214
  v_mfma_f32_16x16x32_bf16 a[76:79], a[164:167], v[180:183], a[76:79]
  v_add_f32 v225, v225, v215
  v_cvt_pk_bf16_f32 v175, v214, v215
  v_mfma_f32_16x16x32_bf16 a[16:19], a[168:171], v[160:163], a[16:19]
  ds_read_b128 a[136:139], v3 offset:2048
  v_add_f32 v226, v216, v217
  v_mfma_f32_16x16x32_bf16 a[20:23], a[168:171], v[164:167], a[20:23]
  v_cvt_pk_bf16_f32 v184, v216, v217
  v_add_f32 v226, v226, v218
  v_mfma_f32_16x16x32_bf16 a[80:83], a[168:171], v[176:179], a[80:83]
  v_exp_f32 v216, v152
  v_mfma_f32_16x16x32_bf16 a[84:87], a[168:171], v[180:183], a[84:87]
  v_exp_f32 v217, v153
  v_mfma_f32_16x16x32_bf16 a[24:27], a[172:175], v[160:163], a[24:27]
  ds_read_b128 a[140:143], v3 offset:3072
  v_add_f32 v226, v226, v219
  v_cvt_pk_bf16_f32 v185, v218, v219
  v_mfma_f32_16x16x32_bf16 a[28:31], a[172:175], v[164:167], a[28:31]
  v_exp_f32 v218, v154
  v_mfma_f32_16x16x32_bf16 a[88:91], a[172:175], v[176:179], a[88:91]
  v_add_f32 v226, v226, v220
  v_add_f32 v226, v226, v221
  v_mfma_f32_16x16x32_bf16 a[92:95], a[172:175], v[180:183], a[92:95]
  s_waitcnt lgkmcnt(4)
  v_exp_f32 v219, v155
  v_mfma_f32_16x16x32_bf16 a[32:35], a[176:179], v[160:163], a[32:35]
  ds_read_b128 a[144:147], v3 offset:4096
  v_cvt_pk_bf16_f32 v186, v220, v221
  v_mfma_f32_16x16x32_bf16 a[36:39], a[176:179], v[164:167], a[36:39]
  v_exp_f32 v220, v156
  v_mfma_f32_16x16x32_bf16 a[96:99], a[176:179], v[176:179], a[96:99]
  v_add_f32 v226, v226, v222
  v_add_f32 v226, v226, v223
  v_mfma_f32_16x16x32_bf16 a[100:103], a[176:179], v[180:183], a[100:103]
  v_exp_f32 v221, v157
  v_mfma_f32_16x16x32_bf16 a[40:43], a[180:183], v[160:163], a[40:43]
  ds_read_b128 a[148:151], v3 offset:5120
  v_cvt_pk_bf16_f32 v187, v222, v223
  v_mfma_f32_16x16x32_bf16 a[44:47], a[180:183], v[164:167], a[44:47]
  v_exp_f32 v222, v158
  v_mfma_f32_16x16x32_bf16 a[104:107], a[180:183], v[176:179], a[104:107]
  buffer_load_dwordx4 v2, s[44:47], s26 offen offset:3072 sc1 lds
  v_add_f32 v227, v216, v217
  v_mfma_f32_16x16x32_bf16 a[108:111], a[180:183], v[180:183], a[108:111]
  s_add_u32 s26, s26, 16384
  v_exp_f32 v223, v159
  v_mfma_f32_16x16x32_bf16 a[48:51], a[184:187], v[160:163], a[48:51]
  s_add_u32 s24, s24, 32768
  ds_read_b128 a[152:155], v3 offset:6144
  v_cvt_pk_bf16_f32 v188, v216, v217
  v_add_f32 v227, v227, v218
  v_mfma_f32_16x16x32_bf16 a[52:55], a[184:187], v[164:167], a[52:55]
  s_and_b32 s24, s24, 0x1ffff
  v_add_f32 v227, v227, v219
  v_cvt_pk_bf16_f32 v189, v218, v219
  v_mfma_f32_16x16x32_bf16 a[112:115], a[184:187], v[176:179], a[112:115]
  v_max3_f32 v5, v224, v225, v226
  v_add_f32 v227, v227, v220
  v_mfma_f32_16x16x32_bf16 a[116:119], a[184:187], v[180:183], a[116:119]
  v_add_f32 v227, v227, v221
  v_cvt_pk_bf16_f32 v190, v220, v221
  v_mfma_f32_16x16x32_bf16 a[56:59], a[188:191], v[160:163], a[56:59]
  ds_read_b128 a[156:159], v3 offset:7168
  v_add_f32 v227, v227, v222
  v_mfma_f32_16x16x32_bf16 a[60:63], a[188:191], v[164:167], a[60:63]
  v_add_f32 v227, v227, v223
  v_cvt_pk_bf16_f32 v191, v222, v223
  v_mfma_f32_16x16x32_bf16 a[120:123], a[188:191], v[176:179], a[120:123]
  s_waitcnt lgkmcnt(4)
  v_max_f32 v5, v5, v227
  v_cmp_lt_f32 vcc, s81, v5
  v_mfma_f32_16x16x32_bf16 a[124:127], a[188:191], v[180:183], a[124:127]
  s_cbranch_vccnz fa_stub1
fa_back1:
  v_add_f32 v228, v228, v224
  v_add_f32 v229, v229, v225
  v_add_f32 v230, v230, v226
  v_add_f32 v231, v231, v227
  v_mfma_f32_16x16x32_bf16 v[112:115], a[128:131], v[32:35], v[192:195]
  ds_read_b128 a[160:163], v3 offset:24576
  v_exp_f32 v208, v96
  v_mfma_f32_16x16x32_bf16 v[120:123], a[128:131], v[36:39], v[196:199]
  v_exp_f32 v209, v97
  v_mfma_f32_16x16x32_bf16 v[144:147], a[128:131], v[64:67], v[200:203]
  s_cmp_ge_u32 s26, s32
  v_exp_f32 v210, v98
  v_mfma_f32_16x16x32_bf16 v[152:155], a[128:131], v[68:71], v[204:207]
  s_cbranch_scc1 fa_hk1
fa_hb1:
  v_exp_f32 v211, v99
  v_mfma_f32_16x16x32_bf16 v[116:119], a[132:135], v[32:35], v[192:195]
  ds_read_b128 a[164:167], v3 offset:25600
  v_mfma_f32_16x16x32_bf16 v[124:127], a[132:135], v[36:39], v[196:199]
  s_mov_b32 m0, s25
  v_exp_f32 v212, v100
  v_mfma_f32_16x16x32_bf16 v[148:151], a[132:135], v[64:67], v[200:203]
  buffer_load_dwordx4 v2, s[48:51], s27 offen offset:0 sc1 lds
  v_add_f32 v224, v208, v209
  v_cvt_pk_bf16_f32 v160, v208, v209
  v_mfma_f32_16x16x32_bf16 v[156:159], a[132:135], v[68:71], v[204:207]
  v_exp_f32 v213, v101
  v_mfma_f32_16x16x32_bf16 v[112:115], a[136:139], v[40:43], v[112:115]
  ds_read_b128 a[168:171], v3 offset:26624
  v_add_f32 v224, v224, v210
  v_mfma_f32_16x16x32_bf16 v[120:123], a[136:139], v[44:47], v[120:123]
  v_exp_f32 v214, v102
  v_mfma_f32_16x16x32_bf16 v[144:147], a[136:139], v[72:75], v[144:147]
  v_exp_f32 v215, v103
  v_mfma_f32_16x16x32_bf16 v[152:155], a[136:139], v[76:79], v[152:155]
  v_exp_f32 v208, v104
  v_mfma_f32_16x16x32_bf16 v[116:119], a[140:143], v[40:43], v[116:119]
  ds_read_b128 a[172:175], v3 offset:27648
  v_add_f32 v224, v224, v211
  v_mfma_f32_16x16x32_bf16 v[124:127], a[140:143], v[44:47], v[124:127]
  v_exp_f32 v209, v105
  v_mfma_f32_16x16x32_bf16 v[148:151], a[140:143], v[72:75], v[148:151]
  v_cvt_pk_bf16_f32 v161, v210, v211
  v_add_f32 v224, v224, v212
  v_mfma_f32_16x16x32_bf16 v[156:159], a[140:143], v[76:79], v[156:159]
  s_waitcnt lgkmcnt(4)
  v_exp_f32 v210, v106
  v_mfma_f32_16x16x32_bf16 v[112:115], a[144:147], v[48:51], v[112:115]
  ds_read_b128 a[176:179], v3 offset:28672
  v_add_f32 v224, v224, v213
  v_mfma_f32_16x16x32_bf16 v[120:123], a[144:147], v[52:55], v[120:123]
  v_exp_f32 v211, v107
  v_mfma_f32_16x16x32_bf16 v[144:147], a[144:147], v[80:83], v[144:147]
  v_cvt_pk_bf16_f32 v162, v212, v213
  v_add_f32 v224, v224, v214
  v_add_f32 v224, v224, v215
  v_mfma_f32_16x16x32_bf16 v[152:155], a[144:147], v[84:87], v[152:155]
  v_exp_f32 v212, v108
  v_mfma_f32_16x16x32_bf16 v[116:119], a[148:151], v[48:51], v[116:119]
  ds_read_b128 a[180:183], v3 offset:29696
  v_cvt_pk_bf16_f32 v163, v214, v215
  v_mfma_f32_16x16x32_bf16 v[124:127], a[148:151], v[52:55], v[124:127]
  v_exp_f32 v213, v109
  v_mfma_f32_16x16x32_bf16 v[148:151], a[148:151], v[80:83], v[148:151]
  buffer_load_dwordx4 v2, s[48:51], s27 offen offset:1024 sc1 lds
  v_add_f32 v225, v208, v209
  v_mfma_f32_16x16x32_bf16 v[156:159], a[148:151], v[84:87], v[156:159]
  v_exp_f32 v214, v110
  v_mfma_f32_16x16x32_bf16 v[112:115], a[152:155], v[56:59], v[112:115]
  ds_read_b128 a[184:187], v3 offset:30720
  v_cvt_pk_bf16_f32 v164, v208, v209
  v_mfma_f32_16x16x32_bf16 v[120:123], a[152:155], v[60:63], v[120:123]
  v_exp_f32 v215, v111
  v_mfma_f32_16x16x32_bf16 v[144:147], a[152:155], v[88:91], v[144:147]
  v_exp_f32 v216, v128
  v_mfma_f32_16x16x32_bf16 v[152:155], a[152:155], v[92:95], v[152:155]
  v_exp_f32 v217, v129
  v_mfma_f32_16x16x32_bf16 v[116:119], a[156:159], v[56:59], v[116:119]
  ds_read_b128 a[188:191], v3 offset:31744
  v_add_f32 v225, v225, v210
  v_mfma_f32_16x16x32_bf16 v[124:127], a[156:159], v[60:63], v[124:127]
  v_exp_f32 v218, v130
  v_mfma_f32_16x16x32_bf16 v[148:151], a[156:159], v[88:91], v[148:151]
  v_exp_f32 v219, v131
  v_mfma_f32_16x16x32_bf16 v[156:159], a[156:159], v[92:95], v[156:159]
  s_waitcnt lgkmcnt(4)
  v_exp_f32 v220, v132
  v_add_f32 v225, v225, v211
  v_mfma_f32_16x16x32_bf16 a[0:3], a[160:163], v[168:171], a[0:3]
  ds_read_b128 a[128:131], v3 offset:8192
  v_cvt_pk_bf16_f32 v165, v210, v211
  v_mfma_f32_16x16x32_bf16 a[4:7], a[160:163], v[172:175], a[4:7]
  v_exp_f32 v221, v133
  v_mfma_f32_16x16x32_bf16 a[64:67], a[160:163], v[184:187], a[64:67]
  v_exp_f32 v222, v134
  v_mfma_f32_16x16x32_bf16 a[68:71], a[160:163], v[188:191], a[68:71]
  v_exp_f32 v223, v135
  v_mfma_f32_16x16x32_bf16 a[8:11], a[164:167], v[168:171], a[8:11]
  ds_read_b128 a[132:135], v3 offset:9216
  v_add_f32 v225, v225, v212
  v_mfma_f32_16x16x32_bf16 a[12:15], a[164:167], v[172:175], a[12:15]
  v_add_f32 v225, v225, v213
  v_cvt_pk_bf16_f32 v166, v212, v213
  v_mfma_f32_16x16x32_bf16 a[72:75], a[164:167], v[184:187], a[72:75]
  buffer_load_dwordx4 v2, s[48:51], s27 offen offset:2048 sc1 lds
  v_add_f32 v225, v225, v214
  v_mfma_f32_16x16x32_bf16 a[76:79], a[164:167], v[188:191], a[76:79]
  v_add_f32 v225, v225, v215
  v_cvt_pk_bf16_f32 v167, v214, v215
  v_mfma_f32_16x16x32_bf16 a[16:19], a[168:171], v[168:171], a[16:19]
  ds_read_b128 a[136:139], v3 offset:10240
  v_add_f32 v226, v216, v217
  v_mfma_f32_16x16x32_bf16 a[20:23], a[168:171], v[172:175], a[20:23]
  v_cvt_pk_bf16_f32 v176, v216, v217
  v_add_f32 v226, v226, v218
  v_mfma_f32_16x16x32_bf16 a[80:83], a[168:171], v[184:187], a[80:83]
  v_exp_f32 v216, v136
  v_mfma_f32_16x16x32_bf16 a[84:87], a[168:171], v[188:191], a[84:87]
  v_exp_f32 v217, v137
  v_mfma_f32_16x16x32_bf16 a[24:27], a[172:175], v[168:171], a[24:27]
  ds_read_b128 a[140:143], v3 offset:11264
  v_add_f32 v226, v226, v219
  v_cvt_pk_bf16_f32 v177, v218, v219
  v_mfma_f32_16x16x32_bf16 a[28:31], a[172:175], v[172:175], a[28:31]
  v_exp_f32 v218, v138
  v_mfma_f32_16x16x32_bf16 a[88:91], a[172:175], v[184:187], a[88:91]
  v_add_f32 v226, v226, v220
  v_add_f32 v226, v226, v221
  v_mfma_f32_16x16x32_bf16 a[92:95], a[172:175], v[188:191], a[92:95]
  s_waitcnt lgkmcnt(4)
  v_exp_f32 v219, v139
  v_mfma_f32_16x16x32_bf16 a[32:35], a[176:179], v[168:171], a[32:35]
  ds_read_b128 a[144:147], v3 offset:12288
  v_cvt_pk_bf16_f32 v178, v220, v221
  v_mfma_f32_16x16x32_bf16 a[36:39], a[176:179], v[172:175], a[36:39]
  v_exp_f32 v220, v140
  v_mfma_f32_16x16x32_bf16 a[96:99], a[176:179], v[184:187], a[96:99]
  v_add_f32 v226, v226, v222
  v_add_f32 v226, v226, v223
  v_mfma_f32_16x16x32_bf16 a[100:103], a[176:179], v[188:191], a[100:103]
  v_exp_f32 v221, v141
  v_mfma_f32_16x16x32_bf16 a[40:43], a[180:183], v[168:171], a[40:43]
  ds_read_b128 a[148:151], v3 offset:13312
  v_cvt_pk_bf16_f32 v179, v222, v223
  v_mfma_f32_16x16x32_bf16 a[44:47], a[180:183], v[172:175], a[44:47]
  v_exp_f32 v222, v142
  v_mfma_f32_16x16x32_bf16 a[104:107], a[180:183], v[184:187], a[104:107]
  buffer_load_dwordx4 v2, s[48:51], s27 offen offset:3072 sc1 lds
  v_add_f32 v227, v216, v217
  v_mfma_f32_16x16x32_bf16 a[108:111], a[180:183], v[188:191], a[108:111]
  s_add_u32 s27, s27, 16384
  v_exp_f32 v223, v143
  v_mfma_f32_16x16x32_bf16 a[48:51], a[184:187], v[168:171], a[48:51]
  s_add_u32 s25, s25, 32768
  ds_read_b128 a[152:155], v3 offset:14336
  v_cvt_pk_bf16_f32 v180, v216, v217
  v_add_f32 v227, v227, v218
  v_mfma_f32_16x16x32_bf16 a[52:55], a[184:187], v[172:175], a[52:55]
  s_and_b32 s25, s25, 0x1ffff
  v_add_f32 v227, v227, v219
  v_cvt_pk_bf16_f32 v181, v218, v219
  v_mfma_f32_16x16x32_bf16 a[112:115], a[184:187], v[184:187], a[112:115]
  v_max3_f32 v5, v224, v225, v226
  v_add_f32 v227, v227, v220
  v_mfma_f32_16x16x32_bf16 a[116:119], a[184:187], v[188:191], a[116:119]
  v_add_f32 v227, v227, v221
  v_cvt_pk_bf16_f32 v182, v220, v221
  v_mfma_f32_16x16x32_bf16 a[56:59], a[188:191], v[168:171], a[56:59]
  ds_read_b128 a[156:159], v3 offset:15360
  v_add_f32 v227, v227, v222
  v_mfma_f32_16x16x32_bf16 a[60:63], a[188:191], v[172:175], a[60:63]
  s_sub_u32 s28, s28, 1
  v_add_f32 v227, v227, v223
  v_cvt_pk_bf16_f32 v183, v222, v223
  v_mfma_f32_16x16x32_bf16 a[120:123], a[188:191], v[184:187], a[120:123]
  s_waitcnt lgkmcnt(4)
  v_max_f32 v5, v5, v227
  v_cmp_lt_f32 vcc, s81, v5
  v_mfma_f32_16x16x32_bf16 a[124:127], a[188:191], v[188:191], a[124:127]
  s_cbranch_vccnz fa_stub2
fa_back2:
  v_add_f32 v228, v228, v224
  v_add_f32 v229, v229, v225
  v_add_f32 v230, v230, v226
  v_add_f32 v231, v231, v227
  v_add_u32 v3, 32768, v3
  v_and_b32 v3, 0x1ffff, v3
  s_cmp_lg_u32 s28, 0
  s_cbranch_scc1 fa_DD
fa_Aexit:
  s_bitcmp1_b32 s20, 0
  s_cbranch_scc1 fa_Aodd
  v_mfma_f32_16x16x32_bf16 v[96:99], a[128:131], v[32:35], v[192:195]
  s_waitcnt vmcnt(12)
  v_exp_f32 v208, v112
  v_mfma_f32_16x16x32_bf16 v[104:107], a[128:131], v[36:39], v[196:199]
  s_barrier
  v_exp_f32 v209, v113
  v_mfma_f32_16x16x32_bf16 v[128:131], a[128:131], v[64:67], v[200:203]
  ds_read_b128 a[160:163], v3 offset:16384
  v_add_f32 v224, v208, v209
  v_mfma_f32_16x16x32_bf16 v[136:139], a[128:131], v[68:71], v[204:207]
  v_exp_f32 v210, v114
  v_mfma_f32_16x16x32_bf16 v[100:103], a[132:135], v[32:35], v[192:195]
  ds_read_b128 a[164:167], v3 offset:17408
  v_cvt_pk_bf16_f32 v168, v208, v209
  v_mfma_f32_16x16x32_bf16 v[108:111], a[132:135], v[36:39], v[196:199]
  s_mov_b32 m0, s24
  v_exp_f32 v211, v115
  v_mfma_f32_16x16x32_bf16 v[132:135], a[132:135], v[64:67], v[200:203]
  buffer_load_dwordx4 v2, s[44:47], s26 offen offset:0 sc1 lds
  v_add_f32 v224, v224, v210
  v_add_f32 v224, v224, v211
  v_mfma_f32_16x16x32_bf16 v[140:143], a[132:135], v[68:71], v[204:207]
  v_exp_f32 v212, v116
  v_mfma_f32_16x16x32_bf16 v[96:99], a[136:139], v[40:43], v[96:99]
  ds_read_b128 a[168:171], v3 offset:18432
  v_cvt_pk_bf16_f32 v169, v210, v211
  v_mfma_f32_16x16x32_bf16 v[104:107], a[136:139], v[44:47], v[104:107]
  v_exp_f32 v213, v117
  v_mfma_f32_16x16x32_bf16 v[128:131], a[136:139], v[72:75], v[128:131]
  v_exp_f32 v214, v118
  v_mfma_f32_16x16x32_bf16 v[136:139], a[136:139], v[76:79], v[136:139]
  v_exp_f32 v215, v119
  v_mfma_f32_16x16x32_bf16 v[100:103], a[140:143], v[40:43], v[100:103]
  ds_read_b128 a[172:175], v3 offset:19456
  v_add_f32 v224, v224, v212
  v_mfma_f32_16x16x32_bf16 v[108:111], a[140:143], v[44:47], v[108:111]
  v_exp_f32 v208, v120
  v_mfma_f32_16x16x32_bf16 v[132:135], a[140:143], v[72:75], v[132:135]
  v_exp_f32 v209, v121
  v_mfma_f32_16x16x32_bf16 v[140:143], a[140:143], v[76:79], v[140:143]
  s_waitcnt lgkmcnt(4)
  v_exp_f32 v210, v122
  v_mfma_f32_16x16x32_bf16 v[96:99], a[144:147], v[48:51], v[96:99]
  ds_read_b128 a[176:179], v3 offset:20480
  v_add_f32 v224, v224, v213
  v_mfma_f32_16x16x32_bf16 v[104:107], a[144:147], v[52:55], v[104:107]
  v_exp_f32 v211, v123
  v_mfma_f32_16x16x32_bf16 v[128:131], a[144:147], v[80:83], v[128:131]
  v_cvt_pk_bf16_f32 v170, v212, v213
  v_add_f32 v224, v224, v214
  v_add_f32 v224, v224, v215
  v_mfma_f32_16x16x32_bf16 v[136:139], a[144:147], v[84:87], v[136:139]
  v_exp_f32 v212, v124
  v_mfma_f32_16x16x32_bf16 v[100:103], a[148:151], v[48:51], v[100:103]
  ds_read_b128 a[180:183], v3 offset:21504
  v_cvt_pk_bf16_f32 v171, v214, v215
  v_mfma_f32_16x16x32_bf16 v[108:111], a[148:151], v[52:55], v[108:111]
  v_exp_f32 v213, v125
  v_mfma_f32_16x16x32_bf16 v[132:135], a[148:151], v[80:83], v[132:135]
  buffer_load_dwordx4 v2, s[44:47], s26 offen offset:1024 sc1 lds
  v_add_f32 v225, v208, v209
  v_mfma_f32_16x16x32_bf16 v[140:143], a[148:151], v[84:87], v[140:143]
  v_exp_f32 v214, v126
  v_mfma_f32_16x16x32_bf16 v[96:99], a[152:155], v[56:59], v[96:99]
  ds_read_b128 a[184:187], v3 offset:22528
  v_cvt_pk_bf16_f32 v172, v208, v209
  v_mfma_f32_16x16x32_bf16 v[104:107], a[152:155], v[60:63], v[104:107]
  v_exp_f32 v215, v127
  v_mfma_f32_16x16x32_bf16 v[128:131], a[152:155], v[88:91], v[128:131]
  v_exp_f32 v216, v144
  v_mfma_f32_16x16x32_bf16 v[136:139], a[152:155], v[92:95], v[136:139]
  v_exp_f32 v217, v145
  v_mfma_f32_16x16x32_bf16 v[100:103], a[156:159], v[56:59], v[100:103]
  ds_read_b128 a[188:191], v3 offset:23552
  v_add_f32 v225, v225, v210
  v_mfma_f32_16x16x32_bf16 v[108:111], a[156:159], v[60:63], v[108:111]
  v_exp_f32 v218, v146
  v_mfma_f32_16x16x32_bf16 v[132:135], a[156:159], v[88:91], v[132:135]
  v_exp_f32 v219, v147
  v_mfma_f32_16x16x32_bf16 v[140:143], a[156:159], v[92:95], v[140:143]
  s_waitcnt lgkmcnt(4)
  v_exp_f32 v220, v148
  v_add_f32 v225, v225, v211
  v_mfma_f32_16x16x32_bf16 a[0:3], a[160:163], v[160:163], a[0:3]
  ds_read_b128 a[128:131], v3 offset:0
  v_cvt_pk_bf16_f32 v173, v210, v211
  v_mfma_f32_16x16x32_bf16 a[4:7], a[160:163], v[164:167], a[4:7]
  v_exp_f32 v221, v149
  v_mfma_f32_16x16x32_bf16 a[64:67], a[160:163], v[176:179], a[64:67]
  v_exp_f32 v222, v150
  v_mfma_f32_16x16x32_bf16 a[68:71], a[160:163], v[180:183], a[68:71]
  v_exp_f32 v223, v151
  v_mfma_f32_16x16x32_bf16 a[8:11], a[164:167], v[160:163], a[8:11]
  ds_read_b128 a[132:135], v3 offset:1024
  v_add_f32 v225, v225, v212
  v_mfma_f32_16x16x32_bf16 a[12:15], a[164:167], v[164:167], a[12:15]
  v_add_f32 v225, v225, v213
  v_cvt_pk_bf16_f32 v174, v212, v213
  v_mfma_f32_16x16x32_bf16 a[72:75], a[164:167], v[176:179], a[72:75]
  buffer_load_dwordx4 v2, s[44:47], s26 offen offset:2048 sc1 lds
  v_add_f32 v225, v225, v214
  v_mfma_f32_16x16x32_bf16 a[76:79], a[164:167], v[180:183], a[76:79]
  v_add_f32 v225, v225, v215
  v_cvt_pk_bf16_f32 v175, v214, v215
  v_mfma_f32_16x16x32_bf16 a[16:19], a[168:171], v[160:163], a[16:19]
  ds_read_b128 a[136:139], v3 offset:2048
  v_add_f32 v226, v216, v217
  v_mfma_f32_16x16x32_bf16 a[20:23], a[168:171], v[164:167], a[20:23]
  v_cvt_pk_bf16_f32 v184, v216, v217
  v_add_f32 v226, v226, v218
  v_mfma_f32_16x16x32_bf16 a[80:83], a[168:171], v[176:179], a[80:83]
  v_exp_f32 v216, v152
  v_mfma_f32_16x16x32_bf16 a[84:87], a[168:171], v[180:183], a[84:87]
  v_exp_f32 v217, v153
  v_mfma_f32_16x16x32_bf16 a[24:27], a[172:175], v[160:163], a[24:27]
  ds_read_b128 a[140:143], v3 offset:3072
  v_add_f32 v226, v226, v219
  v_cvt_pk_bf16_f32 v185, v218, v219
  v_mfma_f32_16x16x32_bf16 a[28:31], a[172:175], v[164:167], a[28:31]
  v_exp_f32 v218, v154
  v_mfma_f32_16x16x32_bf16 a[88:91], a[172:175], v[176:179], a[88:91]
  v_add_f32 v226, v226, v220
  v_add_f32 v226, v226, v221
  v_mfma_f32_16x16x32_bf16 a[92:95], a[172:175], v[180:183], a[92:95]
  s_waitcnt lgkmcnt(4)
  v_exp_f32 v219, v155
  v_mfma_f32_16x16x32_bf16 a[32:35], a[176:179], v[160:163], a[32:35]
  ds_read_b128 a[144:147], v3 offset:4096
  v_cvt_pk_bf16_f32 v186, v220, v221
  v_mfma_f32_16x16x32_bf16 a[36:39], a[176:179], v[164:167], a[36:39]
  v_exp_f32 v220, v156
  v_mfma_f32_16x16x32_bf16 a[96:99], a[176:179], v[176:179], a[96:99]
  v_add_f32 v226, v226, v222
  v_add_f32 v226, v226, v223
  v_mfma_f32_16x16x32_bf16 a[100:103], a[176:179], v[180:183], a[100:103]
  v_exp_f32 v221, v157
  v_mfma_f32_16x16x32_bf16 a[40:43], a[180:183], v[160:163], a[40:43]
  ds_read_b128 a[148:151], v3 offset:5120
  v_cvt_pk_bf16_f32 v187, v222, v223
  v_mfma_f32_16x16x32_bf16 a[44:47], a[180:183], v[164:167], a[44:47]
  v_exp_f32 v222, v158
  v_mfma_f32_16x16x32_bf16 a[104:107], a[180:183], v[176:179], a[104:107]
  buffer_load_dwordx4 v2, s[44:47], s26 offen offset:3072 sc1 lds
  v_add_f32 v227, v216, v217
  v_mfma_f32_16x16x32_bf16 a[108:111], a[180:183], v[180:183], a[108:111]
  s_add_u32 s26, s26, 16384
  v_exp_f32 v223, v159
  v_mfma_f32_16x16x32_bf16 a[48:51], a[184:187], v[160:163], a[48:51]
  s_add_u32 s24, s24, 32768
  ds_read_b128 a[152:155], v3 offset:6144
  v_cvt_pk_bf16_f32 v188, v216, v217
  v_add_f32 v227, v227, v218
  v_mfma_f32_16x16x32_bf16 a[52:55], a[184:187], v[164:167], a[52:55]
  s_and_b32 s24, s24, 0x1ffff
  v_add_f32 v227, v227, v219
  v_cvt_pk_bf16_f32 v189, v218, v219
  v_mfma_f32_16x16x32_bf16 a[112:115], a[184:187], v[176:179], a[112:115]
  v_max3_f32 v5, v224, v225, v226
  v_add_f32 v227, v227, v220
  v_mfma_f32_16x16x32_bf16 a[116:119], a[184:187], v[180:183], a[116:119]
  v_add_f32 v227, v227, v221
  v_cvt_pk_bf16_f32 v190, v220, v221
  v_mfma_f32_16x16x32_bf16 a[56:59], a[188:191], v[160:163], a[56:59]
  ds_read_b128 a[156:159], v3 offset:7168
  v_add_f32 v227, v227, v222
  v_mfma_f32_16x16x32_bf16 a[60:63], a[188:191], v[164:167], a[60:63]
  v_add_f32 v227, v227, v223
  v_cvt_pk_bf16_f32 v191, v222, v223
  v_mfma_f32_16x16x32_bf16 a[120:123], a[188:191], v[176:179], a[120:123]
  s_waitcnt lgkmcnt(4)
  v_max_f32 v5, v5, v227
  v_cmp_lt_f32 vcc, s81, v5
  v_mfma_f32_16x16x32_bf16 a[124:127], a[188:191], v[180:183], a[124:127]
  s_cbranch_vccnz fa_stub3
fa_back3:
  v_add_f32 v228, v228, v224
  v_add_f32 v229, v229, v225
  v_add_f32 v230, v230, v226
  v_add_f32 v231, v231, v227
  v_mfma_f32_16x16x32_bf16 v[144:147], a[128:131], v[64:67], v[200:203]
  ds_read_b128 a[160:163], v3 offset:24576
  v_cndmask_b32 v96, v4, v96, s[68:69]
  v_cndmask_b32 v97, v4, v97, s[70:71]
  v_mfma_f32_16x16x32_bf16 v[152:155], a[128:131], v[68:71], v[204:207]
  v_cndmask_b32 v98, v4, v98, s[72:73]
  v_cndmask_b32 v99, v4, v99, s[74:75]
  v_mov_b32 v100, v4
  v_mfma_f32_16x16x32_bf16 v[148:151], a[132:135], v[64:67], v[200:203]
  ds_read_b128 a[164:167], v3 offset:25600
  v_mov_b32 v101, v4
  v_mov_b32 v102, v4
  v_mfma_f32_16x16x32_bf16 v[156:159], a[132:135], v[68:71], v[204:207]
  v_mov_b32 v103, v4
  v_cndmask_b32 v108, v4, v108, s[68:69]
  v_cndmask_b32 v109, v4, v109, s[70:71]
  v_mfma_f32_16x16x32_bf16 v[144:147], a[136:139], v[72:75], v[144:147]
  ds_read_b128 a[168:171], v3 offset:26624
  v_cndmask_b32 v110, v4, v110, s[72:73]
  v_cndmask_b32 v111, v4, v111, s[74:75]
  v_mfma_f32_16x16x32_bf16 v[152:155], a[136:139], v[76:79], v[152:155]
  s_mov_b32 m0, s25
  v_exp_f32 v208, v96
  v_exp_f32 v209, v97
  v_mfma_f32_16x16x32_bf16 v[148:151], a[140:143], v[72:75], v[148:151]
  ds_read_b128 a[172:175], v3 offset:27648
  buffer_load_dwordx4 v2, s[48:51], s27 offen offset:0 sc1 lds
  v_mfma_f32_16x16x32_bf16 v[156:159], a[140:143], v[76:79], v[156:159]
  s_waitcnt lgkmcnt(4)
  v_exp_f32 v210, v98
  v_add_f32 v224, v208, v209
  v_mfma_f32_16x16x32_bf16 v[144:147], a[144:147], v[80:83], v[144:147]
  ds_read_b128 a[176:179], v3 offset:28672
  v_exp_f32 v211, v99
  v_mfma_f32_16x16x32_bf16 v[152:155], a[144:147], v[84:87], v[152:155]
  v_exp_f32 v212, v100
  v_cvt_pk_bf16_f32 v160, v208, v209
  v_mfma_f32_16x16x32_bf16 v[148:151], a[148:151], v[80:83], v[148:151]
  ds_read_b128 a[180:183], v3 offset:29696
  v_exp_f32 v213, v101
  v_mfma_f32_16x16x32_bf16 v[156:159], a[148:151], v[84:87], v[156:159]
  v_exp_f32 v214, v102
  v_add_f32 v224, v224, v210
  v_add_f32 v224, v224, v211
  v_mfma_f32_16x16x32_bf16 v[144:147], a[152:155], v[88:91], v[144:147]
  ds_read_b128 a[184:187], v3 offset:30720
  v_cvt_pk_bf16_f32 v161, v210, v211
  v_add_f32 v224, v224, v212
  v_mfma_f32_16x16x32_bf16 v[152:155], a[152:155], v[92:95], v[152:155]
  v_exp_f32 v215, v103
  v_add_f32 v224, v224, v213
  v_mfma_f32_16x16x32_bf16 v[148:151], a[156:159], v[88:91], v[148:151]
  ds_read_b128 a[188:191], v3 offset:31744
  v_cvt_pk_bf16_f32 v162, v212, v213
  v_add_f32 v224, v224, v214
  v_mfma_f32_16x16x32_bf16 v[156:159], a[156:159], v[92:95], v[156:159]
  s_waitcnt lgkmcnt(4)
  v_exp_f32 v208, v104
  v_add_f32 v224, v224, v215
  v_mfma_f32_16x16x32_bf16 a[0:3], a[160:163], v[168:171], a[0:3]
  ds_read_b128 a[128:131], v3 offset:8192
  v_cvt_pk_bf16_f32 v163, v214, v215
  v_exp_f32 v209, v105
  v_mfma_f32_16x16x32_bf16 a[4:7], a[160:163], v[172:175], a[4:7]
  v_exp_f32 v210, v106
  v_mfma_f32_16x16x32_bf16 a[64:67], a[160:163], v[184:187], a[64:67]
  buffer_load_dwordx4 v2, s[48:51], s27 offen offset:1024 sc1 lds
  v_exp_f32 v211, v107
  v_mfma_f32_16x16x32_bf16 a[68:71], a[160:163], v[188:191], a[68:71]
  v_exp_f32 v212, v108
  v_add_f32 v225, v208, v209
  v_mfma_f32_16x16x32_bf16 a[8:11], a[164:167], v[168:171], a[8:11]
  ds_read_b128 a[132:135], v3 offset:9216
  v_exp_f32 v213, v109
  v_mfma_f32_16x16x32_bf16 a[12:15], a[164:167], v[172:175], a[12:15]
  v_exp_f32 v214, v110
  v_cvt_pk_bf16_f32 v164, v208, v209
  v_mfma_f32_16x16x32_bf16 a[72:75], a[164:167], v[184:187], a[72:75]
  v_exp_f32 v215, v111
  v_add_f32 v225, v225, v210
  v_mfma_f32_16x16x32_bf16 a[76:79], a[164:167], v[188:191], a[76:79]
  v_exp_f32 v216, v128
  v_add_f32 v225, v225, v211
  v_mfma_f32_16x16x32_bf16 a[16:19], a[168:171], v[168:171], a[16:19]
  ds_read_b128 a[136:139], v3 offset:10240
  v_exp_f32 v217, v129
  v_mfma_f32_16x16x32_bf16 a[20:23], a[168:171], v[172:175], a[20:23]
  v_exp_f32 v218, v130
  v_cvt_pk_bf16_f32 v165, v210, v211
  v_mfma_f32_16x16x32_bf16 a[80:83], a[168:171], v[184:187], a[80:83]
  v_exp_f32 v219, v131
  v_add_f32 v225, v225, v212
  v_mfma_f32_16x16x32_bf16 a[84:87], a[168:171], v[188:191], a[84:87]
  v_exp_f32 v220, v132
  v_add_f32 v225, v225, v213
  v_mfma_f32_16x16x32_bf16 a[24:27], a[172:175], v[168:171], a[24:27]
  ds_read_b128 a[140:143], v3 offset:11264
  v_exp_f32 v221, v133
  v_mfma_f32_16x16x32_bf16 a[28:31], a[172:175], v[172:175], a[28:31]
  v_exp_f32 v222, v134
  v_cvt_pk_bf16_f32 v166, v212, v213
  v_mfma_f32_16x16x32_bf16 a[88:91], a[172:175], v[184:187], a[88:91]
  buffer_load_dwordx4 v2, s[48:51], s27 offen offset:2048 sc1 lds
  v_exp_f32 v223, v135
  v_mfma_f32_16x16x32_bf16 a[92:95], a[172:175], v[188:191], a[92:95]
  s_waitcnt lgkmcnt(4)
  v_add_f32 v225, v225, v214
  v_add_f32 v225, v225, v215
  v_cvt_pk_bf16_f32 v167, v214, v215
  v_mfma_f32_16x16x32_bf16 a[32:35], a[176:179], v[168:171], a[32:35]
  ds_read_b128 a[144:147], v3 offset:12288
  v_add_f32 v226, v216, v217
  v_cvt_pk_bf16_f32 v176, v216, v217
  v_mfma_f32_16x16x32_bf16 a[36:39], a[176:179], v[172:175], a[36:39]
  v_exp_f32 v216, v136
  v_add_f32 v226, v226, v218
  v_mfma_f32_16x16x32_bf16 a[96:99], a[176:179], v[184:187], a[96:99]
  v_exp_f32 v217, v137
  v_add_f32 v226, v226, v219
  v_mfma_f32_16x16x32_bf16 a[100:103], a[176:179], v[188:191], a[100:103]
  v_cvt_pk_bf16_f32 v177, v218, v219
  v_add_f32 v226, v226, v220
  v_add_f32 v226, v226, v221
  v_cvt_pk_bf16_f32 v178, v220, v221
  v_mfma_f32_16x16x32_bf16 a[40:43], a[180:183], v[168:171], a[40:43]
  ds_read_b128 a[148:151], v3 offset:13312
  v_add_f32 v226, v226, v222
  v_add_f32 v226, v226, v223
  v_mfma_f32_16x16x32_bf16 a[44:47], a[180:183], v[172:175], a[44:47]
  v_exp_f32 v218, v138
  v_cvt_pk_bf16_f32 v179, v222, v223
  v_mfma_f32_16x16x32_bf16 a[104:107], a[180:183], v[184:187], a[104:107]
  v_exp_f32 v219, v139
  v_add_f32 v227, v216, v217
  v_mfma_f32_16x16x32_bf16 a[108:111], a[180:183], v[188:191], a[108:111]
  v_exp_f32 v220, v140
  v_cvt_pk_bf16_f32 v180, v216, v217
  v_mfma_f32_16x16x32_bf16 a[48:51], a[184:187], v[168:171], a[48:51]
  ds_read_b128 a[152:155], v3 offset:14336
  v_add_f32 v227, v227, v218
  v_add_f32 v227, v227, v219
  v_mfma_f32_16x16x32_bf16 a[52:55], a[184:187], v[172:175], a[52:55]
  v_exp_f32 v221, v141
  v_cvt_pk_bf16_f32 v181, v218, v219
  v_mfma_f32_16x16x32_bf16 a[112:115], a[184:187], v[184:187], a[112:115]
  buffer_load_dwordx4 v2, s[48:51], s27 offen offset:3072 sc1 lds
  v_max3_f32 v5, v224, v225, v226
  v_add_f32 v227, v227, v220
  v_mfma_f32_16x16x32_bf16 a[116:119], a[184:187], v[188:191], a[116:119]
  s_add_u32 s27, s27, 16384
  v_exp_f32 v222, v142
  v_add_f32 v227, v227, v221
  v_mfma_f32_16x16x32_bf16 a[56:59], a[188:191], v[168:171], a[56:59]
  s_add_u32 s25, s25, 32768
  ds_read_b128 a[156:159], v3 offset:15360
  v_cvt_pk_bf16_f32 v182, v220, v221
  v_add_f32 v227, v227, v222
  v_mfma_f32_16x16x32_bf16 a[60:63], a[188:191], v[172:175], a[60:63]
  s_and_b32 s25, s25, 0x1ffff
  v_exp_f32 v223, v143
  v_mfma_f32_16x16x32_bf16 a[120:123], a[188:191], v[184:187], a[120:123]
  s_waitcnt lgkmcnt(4)
  v_add_f32 v227, v227, v223
  v_cvt_pk_bf16_f32 v183, v222, v223
  v_max_f32 v5, v5, v227
  v_cmp_lt_f32 vcc, s81, v5
  v_mfma_f32_16x16x32_bf16 a[124:127], a[188:191], v[188:191], a[124:127]
  s_cbranch_vccnz fa_stub4
fa_back4:
  v_add_f32 v228, v228, v224
  v_add_f32 v229, v229, v225
  v_add_f32 v230, v230, v226
  v_add_f32 v231, v231, v227
  v_add_u32 v3, 32768, v3
  v_and_b32 v3, 0x1ffff, v3
fa_AV:
  v_mfma_f32_16x16x32_bf16 v[128:131], a[128:131], v[64:67], v[200:203]
  s_waitcnt vmcnt(12)
  v_exp_f32 v216, v144
  v_mfma_f32_16x16x32_bf16 v[136:139], a[128:131], v[68:71], v[204:207]
  s_barrier
  v_exp_f32 v217, v145
  v_mfma_f32_16x16x32_bf16 v[132:135], a[132:135], v[64:67], v[200:203]
  ds_read_b128 a[160:163], v3 offset:16384
  ds_read_b128 a[164:167], v3 offset:17408
  v_mfma_f32_16x16x32_bf16 v[140:143], a[132:135], v[68:71], v[204:207]
  v_exp_f32 v218, v146
  v_mfma_f32_16x16x32_bf16 v[128:131], a[136:139], v[72:75], v[128:131]
  ds_read_b128 a[168:171], v3 offset:18432
  v_add_f32 v226, v216, v217
  v_mfma_f32_16x16x32_bf16 v[136:139], a[136:139], v[76:79], v[136:139]
  s_mov_b32 m0, s24
  v_exp_f32 v219, v147
  v_mfma_f32_16x16x32_bf16 v[132:135], a[140:143], v[72:75], v[132:135]
  ds_read_b128 a[172:175], v3 offset:19456
  buffer_load_dwordx4 v2, s[44:47], s26 offen offset:0 sc1 lds
  v_mfma_f32_16x16x32_bf16 v[140:143], a[140:143], v[76:79], v[140:143]
  s_waitcnt lgkmcnt(4)
  v_exp_f32 v220, v148
  v_mfma_f32_16x16x32_bf16 v[128:131], a[144:147], v[80:83], v[128:131]
  ds_read_b128 a[176:179], v3 offset:20480
  v_cvt_pk_bf16_f32 v184, v216, v217
  v_mfma_f32_16x16x32_bf16 v[136:139], a[144:147], v[84:87], v[136:139]
  v_exp_f32 v221, v149
  v_mfma_f32_16x16x32_bf16 v[132:135], a[148:151], v[80:83], v[132:135]
  ds_read_b128 a[180:183], v3 offset:21504
  v_add_f32 v226, v226, v218
  v_mfma_f32_16x16x32_bf16 v[140:143], a[148:151], v[84:87], v[140:143]
  v_exp_f32 v222, v150
  v_mfma_f32_16x16x32_bf16 v[128:131], a[152:155], v[88:91], v[128:131]
  ds_read_b128 a[184:187], v3 offset:22528
  v_add_f32 v226, v226, v219
  v_mfma_f32_16x16x32_bf16 v[136:139], a[152:155], v[92:95], v[136:139]
  v_exp_f32 v223, v151
  v_mfma_f32_16x16x32_bf16 v[132:135], a[156:159], v[88:91], v[132:135]
  ds_read_b128 a[188:191], v3 offset:23552
  v_cvt_pk_bf16_f32 v185, v218, v219
  v_mfma_f32_16x16x32_bf16 v[140:143], a[156:159], v[92:95], v[140:143]
  s_waitcnt lgkmcnt(4)
  v_exp_f32 v216, v152
  v_mfma_f32_16x16x32_bf16 a[0:3], a[160:163], v[160:163], a[0:3]
  ds_read_b128 a[128:131], v3 offset:0
  v_add_f32 v226, v226, v220
  v_mfma_f32_16x16x32_bf16 a[4:7], a[160:163], v[164:167], a[4:7]
  v_exp_f32 v217, v153
  v_mfma_f32_16x16x32_bf16 a[64:67], a[160:163], v[176:179], a[64:67]
  buffer_load_dwordx4 v2, s[44:47], s26 offen offset:1024 sc1 lds
  v_add_f32 v226, v226, v221
  v_mfma_f32_16x16x32_bf16 a[68:71], a[160:163], v[180:183], a[68:71]
  v_exp_f32 v218, v154
  v_mfma_f32_16x16x32_bf16 a[8:11], a[164:167], v[160:163], a[8:11]
  ds_read_b128 a[132:135], v3 offset:1024
  v_cvt_pk_bf16_f32 v186, v220, v221
  v_mfma_f32_16x16x32_bf16 a[12:15], a[164:167], v[164:167], a[12:15]
  v_exp_f32 v219, v155
  v_mfma_f32_16x16x32_bf16 a[72:75], a[164:167], v[176:179], a[72:75]
  v_exp_f32 v220, v156
  v_mfma_f32_16x16x32_bf16 a[76:79], a[164:167], v[180:183], a[76:79]
  v_add_f32 v226, v226, v222
  v_add_f32 v226, v226, v223
  v_mfma_f32_16x16x32_bf16 a[16:19], a[168:171], v[160:163], a[16:19]
  ds_read_b128 a[136:139], v3 offset:2048
  v_cvt_pk_bf16_f32 v187, v222, v223
  v_mfma_f32_16x16x32_bf16 a[20:23], a[168:171], v[164:167], a[20:23]
  v_exp_f32 v221, v157
  v_mfma_f32_16x16x32_bf16 a[80:83], a[168:171], v[176:179], a[80:83]
  v_exp_f32 v222, v158
  v_mfma_f32_16x16x32_bf16 a[84:87], a[168:171], v[180:183], a[84:87]
  v_exp_f32 v223, v159
  v_mfma_f32_16x16x32_bf16 a[24:27], a[172:175], v[160:163], a[24:27]
  ds_read_b128 a[140:143], v3 offset:3072
  v_add_f32 v227, v216, v217
  v_mfma_f32_16x16x32_bf16 a[28:31], a[172:175], v[164:167], a[28:31]
  v_cvt_pk_bf16_f32 v188, v216, v217
  v_add_f32 v227, v227, v218
  v_mfma_f32_16x16x32_bf16 a[88:91], a[172:175], v[176:179], a[88:91]
  buffer_load_dwordx4 v2, s[44:47], s26 offen offset:2048 sc1 lds
  v_add_f32 v227, v227, v219
  v_mfma_f32_16x16x32_bf16 a[92:95], a[172:175], v[180:183], a[92:95]
  s_waitcnt lgkmcnt(4)
  v_cvt_pk_bf16_f32 v189, v218, v219
  v_add_f32 v227, v227, v220
  v_mfma_f32_16x16x32_bf16 a[32:35], a[176:179], v[160:163], a[32:35]
  ds_read_b128 a[144:147], v3 offset:4096
  v_add_f32 v227, v227, v221
  v_mfma_f32_16x16x32_bf16 a[36:39], a[176:179], v[164:167], a[36:39]
  v_cvt_pk_bf16_f32 v190, v220, v221
  v_add_f32 v227, v227, v222
  v_mfma_f32_16x16x32_bf16 a[96:99], a[176:179], v[176:179], a[96:99]
  v_add_f32 v227, v227, v223
  v_cvt_pk_bf16_f32 v191, v222, v223
  v_mfma_f32_16x16x32_bf16 a[100:103], a[176:179], v[180:183], a[100:103]
  v_max_f32 v5, v226, v227
  v_cmp_lt_f32 vcc, s81, v5
  v_mfma_f32_16x16x32_bf16 a[40:43], a[180:183], v[160:163], a[40:43]
  ds_read_b128 a[148:151], v3 offset:5120
  v_mfma_f32_16x16x32_bf16 a[44:47], a[180:183], v[164:167], a[44:47]
  v_mfma_f32_16x16x32_bf16 a[104:107], a[180:183], v[176:179], a[104:107]
  v_mfma_f32_16x16x32_bf16 a[108:111], a[180:183], v[180:183], a[108:111]
  v_mfma_f32_16x16x32_bf16 a[48:51], a[184:187], v[160:163], a[48:51]
  ds_read_b128 a[152:155], v3 offset:6144
  v_mfma_f32_16x16x32_bf16 a[52:55], a[184:187], v[164:167], a[52:55]
  v_mfma_f32_16x16x32_bf16 a[112:115], a[184:187], v[176:179], a[112:115]
  buffer_load_dwordx4 v2, s[44:47], s26 offen offset:3072 sc1 lds
  v_mfma_f32_16x16x32_bf16 a[116:119], a[184:187], v[180:183], a[116:119]
  s_add_u32 s26, s26, 16384
  v_mfma_f32_16x16x32_bf16 a[56:59], a[188:191], v[160:163], a[56:59]
  s_add_u32 s24, s24, 32768
  ds_read_b128 a[156:159], v3 offset:7168
  v_mfma_f32_16x16x32_bf16 a[60:63], a[188:191], v[164:167], a[60:63]
  s_and_b32 s24, s24, 0x1ffff
  v_mfma_f32_16x16x32_bf16 a[120:123], a[188:191], v[176:179], a[120:123]
  s_waitcnt lgkmcnt(4)
  v_mfma_f32_16x16x32_bf16 a[124:127], a[188:191], v[180:183], a[124:127]
  s_cbranch_vccnz fa_stub5
fa_back5:
  v_add_f32 v230, v230, v226
  v_add_f32 v231, v231, v227
  v_mfma_f32_16x16x32_bf16 v[144:147], a[128:131], v[64:67], v[200:203]
  ds_read_b128 a[160:163], v3 offset:24576
  v_exp_f32 v216, v128
  v_mfma_f32_16x16x32_bf16 v[152:155], a[128:131], v[68:71], v[204:207]
  v_exp_f32 v217, v129
  v_mfma_f32_16x16x32_bf16 v[148:151], a[132:135], v[64:67], v[200:203]
  ds_read_b128 a[164:167], v3 offset:25600
  v_add_f32 v226, v216, v217
  v_mfma_f32_16x16x32_bf16 v[156:159], a[132:135], v[68:71], v[204:207]
  s_mov_b32 m0, s25
  v_exp_f32 v218, v130
  v_cvt_pk_bf16_f32 v176, v216, v217
  v_mfma_f32_16x16x32_bf16 v[144:147], a[136:139], v[72:75], v[144:147]
  ds_read_b128 a[168:171], v3 offset:26624
  buffer_load_dwordx4 v2, s[48:51], s27 offen offset:0 sc1 lds
  v_mfma_f32_16x16x32_bf16 v[152:155], a[136:139], v[76:79], v[152:155]
  v_exp_f32 v219, v131
  v_add_f32 v226, v226, v218
  v_mfma_f32_16x16x32_bf16 v[148:151], a[140:143], v[72:75], v[148:151]
  ds_read_b128 a[172:175], v3 offset:27648
  v_add_f32 v226, v226, v219
  v_mfma_f32_16x16x32_bf16 v[156:159], a[140:143], v[76:79], v[156:159]
  s_waitcnt lgkmcnt(4)
  v_exp_f32 v220, v132
  v_cvt_pk_bf16_f32 v177, v218, v219
  v_mfma_f32_16x16x32_bf16 v[144:147], a[144:147], v[80:83], v[144:147]
  ds_read_b128 a[176:179], v3 offset:28672
  v_add_f32 v226, v226, v220
  v_mfma_f32_16x16x32_bf16 v[152:155], a[144:147], v[84:87], v[152:155]
  v_exp_f32 v221, v133
  v_exp_f32 v222, v134
  v_mfma_f32_16x16x32_bf16 v[148:151], a[148:151], v[80:83], v[148:151]
  ds_read_b128 a[180:183], v3 offset:29696
  buffer_load_dwordx4 v2, s[48:51], s27 offen offset:1024 sc1 lds
  v_mfma_f32_16x16x32_bf16 v[156:159], a[148:151], v[84:87], v[156:159]
  v_exp_f32 v223, v135
  v_mfma_f32_16x16x32_bf16 v[144:147], a[152:155], v[88:91], v[144:147]
  ds_read_b128 a[184:187], v3 offset:30720
  v_add_f32 v226, v226, v221
  v_mfma_f32_16x16x32_bf16 v[152:155], a[152:155], v[92:95], v[152:155]
  v_exp_f32 v216, v136
  v_mfma_f32_16x16x32_bf16 v[148:151], a[156:159], v[88:91], v[148:151]
  ds_read_b128 a[188:191], v3 offset:31744
  v_cvt_pk_bf16_f32 v178, v220, v221
  v_add_f32 v226, v226, v222
  v_mfma_f32_16x16x32_bf16 v[156:159], a[156:159], v[92:95], v[156:159]
  s_waitcnt lgkmcnt(4)
  v_exp_f32 v217, v137
  v_mfma_f32_16x16x32_bf16 a[64:67], a[160:163], v[184:187], a[64:67]
  ds_read_b128 a[128:131], v3 offset:8192
  v_add_f32 v226, v226, v223
  v_cvt_pk_bf16_f32 v179, v222, v223
  v_mfma_f32_16x16x32_bf16 a[68:71], a[160:163], v[188:191], a[68:71]
  v_exp_f32 v218, v138
  v_mfma_f32_16x16x32_bf16 a[72:75], a[164:167], v[184:187], a[72:75]
  ds_read_b128 a[132:135], v3 offset:9216
  buffer_load_dwordx4 v2, s[48:51], s27 offen offset:2048 sc1 lds
  v_add_f32 v227, v216, v217
  v_mfma_f32_16x16x32_bf16 a[76:79], a[164:167], v[188:191], a[76:79]
  v_exp_f32 v219, v139
  v_mfma_f32_16x16x32_bf16 a[80:83], a[168:171], v[184:187], a[80:83]
  ds_read_b128 a[136:139], v3 offset:10240
  v_cvt_pk_bf16_f32 v180, v216, v217
  v_mfma_f32_16x16x32_bf16 a[84:87], a[168:171], v[188:191], a[84:87]
  v_exp_f32 v220, v140
  v_add_f32 v227, v227, v218
  v_mfma_f32_16x16x32_bf16 a[88:91], a[172:175], v[184:187], a[88:91]
  ds_read_b128 a[140:143], v3 offset:11264
  v_add_f32 v227, v227, v219
  v_mfma_f32_16x16x32_bf16 a[92:95], a[172:175], v[188:191], a[92:95]
  s_waitcnt lgkmcnt(4)
  v_exp_f32 v221, v141
  v_cvt_pk_bf16_f32 v181, v218, v219
  v_mfma_f32_16x16x32_bf16 a[96:99], a[176:179], v[184:187], a[96:99]
  ds_read_b128 a[144:147], v3 offset:12288
  buffer_load_dwordx4 v2, s[48:51], s27 offen offset:3072 sc1 lds
  v_mfma_f32_16x16x32_bf16 a[100:103], a[176:179], v[188:191], a[100:103]
  s_add_u32 s27, s27, 16384
  v_exp_f32 v222, v142
  v_add_f32 v227, v227, v220
  v_mfma_f32_16x16x32_bf16 a[104:107], a[180:183], v[184:187], a[104:107]
  s_add_u32 s25, s25, 32768
  ds_read_b128 a[148:151], v3 offset:13312
  v_add_f32 v227, v227, v221
  v_mfma_f32_16x16x32_bf16 a[108:111], a[180:183], v[188:191], a[108:111]
  s_and_b32 s25, s25, 0x1ffff
  v_exp_f32 v223, v143
  v_cvt_pk_bf16_f32 v182, v220, v221
  v_mfma_f32_16x16x32_bf16 a[112:115], a[184:187], v[184:187], a[112:115]
  ds_read_b128 a[152:155], v3 offset:14336
  v_add_f32 v227, v227, v222
  v_mfma_f32_16x16x32_bf16 a[116:119], a[184:187], v[188:191], a[116:119]
  v_add_f32 v227, v227, v223
  v_cvt_pk_bf16_f32 v183, v222, v223
  v_max_f32 v5, v226, v227
  v_mfma_f32_16x16x32_bf16 a[120:123], a[188:191], v[184:187], a[120:123]
  s_waitcnt lgkmcnt(3)
  ds_read_b128 a[156:159], v3 offset:15360
  v_cmp_lt_f32 vcc, s81, v5
  v_mfma_f32_16x16x32_bf16 a[124:127], a[188:191], v[188:191], a[124:127]
  s_cbranch_vccnz fa_stub6
fa_back6:
  v_add_f32 v230, v230, v226
  v_add_f32 v231, v231, v227
  v_add_u32 v3, 32768, v3
  v_and_b32 v3, 0x1ffff, v3
  s_branch fa_SSpre
fa_Aodd:
  v_mfma_f32_16x16x32_bf16 v[128:131], a[128:131], v[64:67], v[200:203]
  s_waitcnt vmcnt(12)
  v_cndmask_b32 v112, v4, v112, s[68:69]
  v_cndmask_b32 v113, v4, v113, s[70:71]
  v_cndmask_b32 v114, v4, v114, s[72:73]
  v_mfma_f32_16x16x32_bf16 v[136:139], a[128:131], v[68:71], v[204:207]
  s_barrier
  v_cndmask_b32 v115, v4, v115, s[74:75]
  v_mov_b32 v116, v4
  v_mov_b32 v117, v4
  v_mfma_f32_16x16x32_bf16 v[132:135], a[132:135], v[64:67], v[200:203]
  ds_read_b128 a[160:163], v3 offset:16384
  ds_read_b128 a[164:167], v3 offset:17408
  v_mov_b32 v118, v4
  v_mfma_f32_16x16x32_bf16 v[140:143], a[132:135], v[68:71], v[204:207]
  v_mov_b32 v119, v4
  v_cndmask_b32 v124, v4, v124, s[68:69]
  v_cndmask_b32 v125, v4, v125, s[70:71]
  v_mfma_f32_16x16x32_bf16 v[128:131], a[136:139], v[72:75], v[128:131]
  ds_read_b128 a[168:171], v3 offset:18432
  v_cndmask_b32 v126, v4, v126, s[72:73]
  v_cndmask_b32 v127, v4, v127, s[74:75]
  v_mfma_f32_16x16x32_bf16 v[136:139], a[136:139], v[76:79], v[136:139]
  s_mov_b32 m0, s24
  v_exp_f32 v208, v112
  v_exp_f32 v209, v113
  v_mfma_f32_16x16x32_bf16 v[132:135], a[140:143], v[72:75], v[132:135]
  ds_read_b128 a[172:175], v3 offset:19456
  buffer_load_dwordx4 v2, s[44:47], s26 offen offset:0 sc1 lds
  v_mfma_f32_16x16x32_bf16 v[140:143], a[140:143], v[76:79], v[140:143]
  s_waitcnt lgkmcnt(4)
  v_exp_f32 v210, v114
  v_add_f32 v224, v208, v209
  v_mfma_f32_16x16x32_bf16 v[128:131], a[144:147], v[80:83], v[128:131]
  ds_read_b128 a[176:179], v3 offset:20480
  v_exp_f32 v211, v115
  v_mfma_f32_16x16x32_bf16 v[136:139], a[144:147], v[84:87], v[136:139]
  v_exp_f32 v212, v116
  v_cvt_pk_bf16_f32 v168, v208, v209
  v_mfma_f32_16x16x32_bf16 v[132:135], a[148:151], v[80:83], v[132:135]
  ds_read_b128 a[180:183], v3 offset:21504
  v_exp_f32 v213, v117
  v_mfma_f32_16x16x32_bf16 v[140:143], a[148:151], v[84:87], v[140:143]
  v_exp_f32 v214, v118
  v_add_f32 v224, v224, v210
  v_add_f32 v224, v224, v211
  v_mfma_f32_16x16x32_bf16 v[128:131], a[152:155], v[88:91], v[128:131]
  ds_read_b128 a[184:187], v3 offset:22528
  v_cvt_pk_bf16_f32 v169, v210, v211
  v_add_f32 v224, v224, v212
  v_mfma_f32_16x16x32_bf16 v[136:139], a[152:155], v[92:95], v[136:139]
  v_exp_f32 v215, v119
  v_add_f32 v224, v224, v213
  v_mfma_f32_16x16x32_bf16 v[132:135], a[156:159], v[88:91], v[132:135]
  ds_read_b128 a[188:191], v3 offset:23552
  v_cvt_pk_bf16_f32 v170, v212, v213
  v_add_f32 v224, v224, v214
  v_mfma_f32_16x16x32_bf16 v[140:143], a[156:159], v[92:95], v[140:143]
  s_waitcnt lgkmcnt(4)
  v_exp_f32 v208, v120
  v_add_f32 v224, v224, v215
  v_mfma_f32_16x16x32_bf16 a[0:3], a[160:163], v[160:163], a[0:3]
  ds_read_b128 a[128:131], v3 offset:0
  v_cvt_pk_bf16_f32 v171, v214, v215
  v_exp_f32 v209, v121
  v_mfma_f32_16x16x32_bf16 a[4:7], a[160:163], v[164:167], a[4:7]
  v_exp_f32 v210, v122
  v_mfma_f32_16x16x32_bf16 a[64:67], a[160:163], v[176:179], a[64:67]
  buffer_load_dwordx4 v2, s[44:47], s26 offen offset:1024 sc1 lds
  v_exp_f32 v211, v123
  v_mfma_f32_16x16x32_bf16 a[68:71], a[160:163], v[180:183], a[68:71]
  v_exp_f32 v212, v124
  v_add_f32 v225, v208, v209
  v_mfma_f32_16x16x32_bf16 a[8:11], a[164:167], v[160:163], a[8:11]
  ds_read_b128 a[132:135], v3 offset:1024
  v_exp_f32 v213, v125
  v_mfma_f32_16x16x32_bf16 a[12:15], a[164:167], v[164:167], a[12:15]
  v_exp_f32 v214, v126
  v_cvt_pk_bf16_f32 v172, v208, v209
  v_mfma_f32_16x16x32_bf16 a[72:75], a[164:167], v[176:179], a[72:75]
  v_exp_f32 v215, v127
  v_add_f32 v225, v225, v210
  v_mfma_f32_16x16x32_bf16 a[76:79], a[164:167], v[180:183], a[76:79]
  v_exp_f32 v216, v144
  v_add_f32 v225, v225, v211
  v_mfma_f32_16x16x32_bf16 a[16:19], a[168:171], v[160:163], a[16:19]
  ds_read_b128 a[136:139], v3 offset:2048
  v_exp_f32 v217, v145
  v_mfma_f32_16x16x32_bf16 a[20:23], a[168:171], v[164:167], a[20:23]
  v_exp_f32 v218, v146
  v_cvt_pk_bf16_f32 v173, v210, v211
  v_mfma_f32_16x16x32_bf16 a[80:83], a[168:171], v[176:179], a[80:83]
  v_exp_f32 v219, v147
  v_add_f32 v225, v225, v212
  v_mfma_f32_16x16x32_bf16 a[84:87], a[168:171], v[180:183], a[84:87]
  v_exp_f32 v220, v148
  v_add_f32 v225, v225, v213
  v_mfma_f32_16x16x32_bf16 a[24:27], a[172:175], v[160:163], a[24:27]
  ds_read_b128 a[140:143], v3 offset:3072
  v_exp_f32 v221, v149
  v_mfma_f32_16x16x32_bf16 a[28:31], a[172:175], v[164:167], a[28:31]
  v_exp_f32 v222, v150
  v_cvt_pk_bf16_f32 v174, v212, v213
  v_mfma_f32_16x16x32_bf16 a[88:91], a[172:175], v[176:179], a[88:91]
  buffer_load_dwordx4 v2, s[44:47], s26 offen offset:2048 sc1 lds
  v_exp_f32 v223, v151
  v_mfma_f32_16x16x32_bf16 a[92:95], a[172:175], v[180:183], a[92:95]
  s_waitcnt lgkmcnt(4)
  v_add_f32 v225, v225, v214
  v_add_f32 v225, v225, v215
  v_cvt_pk_bf16_f32 v175, v214, v215
  v_mfma_f32_16x16x32_bf16 a[32:35], a[176:179], v[160:163], a[32:35]
  ds_read_b128 a[144:147], v3 offset:4096
  v_add_f32 v226, v216, v217
  v_cvt_pk_bf16_f32 v184, v216, v217
  v_mfma_f32_16x16x32_bf16 a[36:39], a[176:179], v[164:167], a[36:39]
  v_exp_f32 v216, v152
  v_add_f32 v226, v226, v218
  v_mfma_f32_16x16x32_bf16 a[96:99], a[176:179], v[176:179], a[96:99]
  v_exp_f32 v217, v153
  v_add_f32 v226, v226, v219
  v_mfma_f32_16x16x32_bf16 a[100:103], a[176:179], v[180:183], a[100:103]
  v_cvt_pk_bf16_f32 v185, v218, v219
  v_add_f32 v226, v226, v220
  v_add_f32 v226, v226, v221
  v_cvt_pk_bf16_f32 v186, v220, v221
  v_mfma_f32_16x16x32_bf16 a[40:43], a[180:183], v[160:163], a[40:43]
  ds_read_b128 a[148:151], v3 offset:5120
  v_add_f32 v226, v226, v222
  v_add_f32 v226, v226, v223
  v_mfma_f32_16x16x32_bf16 a[44:47], a[180:183], v[164:167], a[44:47]
  v_exp_f32 v218, v154
  v_cvt_pk_bf16_f32 v187, v222, v223
  v_mfma_f32_16x16x32_bf16 a[104:107], a[180:183], v[176:179], a[104:107]
  v_exp_f32 v219, v155
  v_add_f32 v227, v216, v217
  v_mfma_f32_16x16x32_bf16 a[108:111], a[180:183], v[180:183], a[108:111]
  v_exp_f32 v220, v156
  v_cvt_pk_bf16_f32 v188, v216, v217
  v_mfma_f32_16x16x32_bf16 a[48:51], a[184:187], v[160:163], a[48:51]
  ds_read_b128 a[152:155], v3 offset:6144
  v_add_f32 v227, v227, v218
  v_add_f32 v227, v227, v219
  v_mfma_f32_16x16x32_bf16 a[52:55], a[184:187], v[164:167], a[52:55]
  v_exp_f32 v221, v157
  v_cvt_pk_bf16_f32 v189, v218, v219
  v_mfma_f32_16x16x32_bf16 a[112:115], a[184:187], v[176:179], a[112:115]
  buffer_load_dwordx4 v2, s[44:47], s26 offen offset:3072 sc1 lds
  v_max3_f32 v5, v224, v225, v226
  v_add_f32 v227, v227, v220
  v_mfma_f32_16x16x32_bf16 a[116:119], a[184:187], v[180:183], a[116:119]
  s_add_u32 s26, s26, 16384
  v_exp_f32 v222, v158
  v_add_f32 v227, v227, v221
  v_mfma_f32_16x16x32_bf16 a[56:59], a[188:191], v[160:163], a[56:59]
  s_add_u32 s24, s24, 32768
  ds_read_b128 a[156:159], v3 offset:7168
  v_cvt_pk_bf16_f32 v190, v220, v221
  v_add_f32 v227, v227, v222
  v_mfma_f32_16x16x32_bf16 a[60:63], a[188:191], v[164:167], a[60:63]
  s_and_b32 s24, s24, 0x1ffff
  v_exp_f32 v223, v159
  v_mfma_f32_16x16x32_bf16 a[120:123], a[188:191], v[176:179], a[120:123]
  s_waitcnt lgkmcnt(4)
  v_add_f32 v227, v227, v223
  v_cvt_pk_bf16_f32 v191, v222, v223
  v_max_f32 v5, v5, v227
  v_cmp_lt_f32 vcc, s81, v5
  v_mfma_f32_16x16x32_bf16 a[124:127], a[188:191], v[180:183], a[124:127]
  s_cbranch_vccnz fa_stub7
fa_back7:
  v_add_f32 v228, v228, v224
  v_add_f32 v229, v229, v225
  v_add_f32 v230, v230, v226
  v_add_f32 v231, v231, v227
  v_mfma_f32_16x16x32_bf16 v[144:147], a[128:131], v[64:67], v[200:203]
  ds_read_b128 a[160:163], v3 offset:24576
  v_exp_f32 v216, v128
  v_mfma_f32_16x16x32_bf16 v[152:155], a[128:131], v[68:71], v[204:207]
  v_exp_f32 v217, v129
  v_mfma_f32_16x16x32_bf16 v[148:151], a[132:135], v[64:67], v[200:203]
  ds_read_b128 a[164:167], v3 offset:25600
  v_mfma_f32_16x16x32_bf16 v[156:159], a[132:135], v[68:71], v[204:207]
  v_exp_f32 v218, v130
  v_mfma_f32_16x16x32_bf16 v[144:147], a[136:139], v[72:75], v[144:147]
  ds_read_b128 a[168:171], v3 offset:26624
  v_add_f32 v226, v216, v217
  v_mfma_f32_16x16x32_bf16 v[152:155], a[136:139], v[76:79], v[152:155]
  s_mov_b32 m0, s25
  v_exp_f32 v219, v131
  v_mfma_f32_16x16x32_bf16 v[148:151], a[140:143], v[72:75], v[148:151]
  ds_read_b128 a[172:175], v3 offset:27648
  buffer_load_dwordx4 v2, s[48:51], s27 offen offset:0 sc1 lds
  v_mfma_f32_16x16x32_bf16 v[156:159], a[140:143], v[76:79], v[156:159]
  s_waitcnt lgkmcnt(4)
  v_exp_f32 v220, v132
  v_mfma_f32_16x16x32_bf16 v[144:147], a[144:147], v[80:83], v[144:147]
  ds_read_b128 a[176:179], v3 offset:28672
  v_cvt_pk_bf16_f32 v176, v216, v217
  v_mfma_f32_16x16x32_bf16 v[152:155], a[144:147], v[84:87], v[152:155]
  v_exp_f32 v221, v133
  v_mfma_f32_16x16x32_bf16 v[148:151], a[148:151], v[80:83], v[148:151]
  ds_read_b128 a[180:183], v3 offset:29696
  v_add_f32 v226, v226, v218
  v_mfma_f32_16x16x32_bf16 v[156:159], a[148:151], v[84:87], v[156:159]
  v_exp_f32 v222, v134
  v_mfma_f32_16x16x32_bf16 v[144:147], a[152:155], v[88:91], v[144:147]
  ds_read_b128 a[184:187], v3 offset:30720
  v_add_f32 v226, v226, v219
  v_mfma_f32_16x16x32_bf16 v[152:155], a[152:155], v[92:95], v[152:155]
  v_exp_f32 v223, v135
  v_mfma_f32_16x16x32_bf16 v[148:151], a[156:159], v[88:91], v[148:151]
  ds_read_b128 a[188:191], v3 offset:31744
  v_cvt_pk_bf16_f32 v177, v218, v219
  v_mfma_f32_16x16x32_bf16 v[156:159], a[156:159], v[92:95], v[156:159]
  s_waitcnt lgkmcnt(4)
  v_exp_f32 v216, v136
  v_mfma_f32_16x16x32_bf16 a[0:3], a[160:163], v[168:171], a[0:3]
  ds_read_b128 a[128:131], v3 offset:8192
  v_add_f32 v226, v226, v220
  v_mfma_f32_16x16x32_bf16 a[4:7], a[160:163], v[172:175], a[4:7]
  v_exp_f32 v217, v137
  v_mfma_f32_16x16x32_bf16 a[64:67], a[160:163], v[184:187], a[64:67]
  buffer_load_dwordx4 v2, s[48:51], s27 offen offset:1024 sc1 lds
  v_add_f32 v226, v226, v221
  v_mfma_f32_16x16x32_bf16 a[68:71], a[160:163], v[188:191], a[68:71]
  v_exp_f32 v218, v138
  v_mfma_f32_16x16x32_bf16 a[8:11], a[164:167], v[168:171], a[8:11]
  ds_read_b128 a[132:135], v3 offset:9216
  v_cvt_pk_bf16_f32 v178, v220, v221
  v_mfma_f32_16x16x32_bf16 a[12:15], a[164:167], v[172:175], a[12:15]
  v_exp_f32 v219, v139
  v_mfma_f32_16x16x32_bf16 a[72:75], a[164:167], v[184:187], a[72:75]
  v_exp_f32 v220, v140
  v_mfma_f32_16x16x32_bf16 a[76:79], a[164:167], v[188:191], a[76:79]
  v_add_f32 v226, v226, v222
  v_add_f32 v226, v226, v223
  v_mfma_f32_16x16x32_bf16 a[16:19], a[168:171], v[168:171], a[16:19]
  ds_read_b128 a[136:139], v3 offset:10240
  v_cvt_pk_bf16_f32 v179, v222, v223
  v_mfma_f32_16x16x32_bf16 a[20:23], a[168:171], v[172:175], a[20:23]
  v_exp_f32 v221, v141
  v_mfma_f32_16x16x32_bf16 a[80:83], a[168:171], v[184:187], a[80:83]
  v_exp_f32 v222, v142
  v_mfma_f32_16x16x32_bf16 a[84:87], a[168:171], v[188:191], a[84:87]
  v_exp_f32 v223, v143
  v_mfma_f32_16x16x32_bf16 a[24:27], a[172:175], v[168:171], a[24:27]
  ds_read_b128 a[140:143], v3 offset:11264
  v_add_f32 v227, v216, v217
  v_mfma_f32_16x16x32_bf16 a[28:31], a[172:175], v[172:175], a[28:31]
  v_cvt_pk_bf16_f32 v180, v216, v217
  v_add_f32 v227, v227, v218
  v_mfma_f32_16x16x32_bf16 a[88:91], a[172:175], v[184:187], a[88:91]
  buffer_load_dwordx4 v2, s[48:51], s27 offen offset:2048 sc1 lds
  v_add_f32 v227, v227, v219
  v_mfma_f32_16x16x32_bf16 a[92:95], a[172:175], v[188:191], a[92:95]
  s_waitcnt lgkmcnt(4)
  v_cvt_pk_bf16_f32 v181, v218, v219
  v_add_f32 v227, v227, v220
  v_mfma_f32_16x16x32_bf16 a[32:35], a[176:179], v[168:171], a[32:35]
  ds_read_b128 a[144:147], v3 offset:12288
  v_add_f32 v227, v227, v221
  v_mfma_f32_16x16x32_bf16 a[36:39], a[176:179], v[172:175], a[36:39]
  v_cvt_pk_bf16_f32 v182, v220, v221
  v_add_f32 v227, v227, v222
  v_mfma_f32_16x16x32_bf16 a[96:99], a[176:179], v[184:187], a[96:99]
  v_add_f32 v227, v227, v223
  v_cvt_pk_bf16_f32 v183, v222, v223
  v_mfma_f32_16x16x32_bf16 a[100:103], a[176:179], v[188:191], a[100:103]
  v_max_f32 v5, v226, v227
  v_cmp_lt_f32 vcc, s81, v5
  v_mfma_f32_16x16x32_bf16 a[40:43], a[180:183], v[168:171], a[40:43]
  ds_read_b128 a[148:151], v3 offset:13312
  v_mfma_f32_16x16x32_bf16 a[44:47], a[180:183], v[172:175], a[44:47]
  v_mfma_f32_16x16x32_bf16 a[104:107], a[180:183], v[184:187], a[104:107]
  v_mfma_f32_16x16x32_bf16 a[108:111], a[180:183], v[188:191], a[108:111]
  v_mfma_f32_16x16x32_bf16 a[48:51], a[184:187], v[168:171], a[48:51]
  ds_read_b128 a[152:155], v3 offset:14336
  v_mfma_f32_16x16x32_bf16 a[52:55], a[184:187], v[172:175], a[52:55]
  v_mfma_f32_16x16x32_bf16 a[112:115], a[184:187], v[184:187], a[112:115]
  buffer_load_dwordx4 v2, s[48:51], s27 offen offset:3072 sc1 lds
  v_mfma_f32_16x16x32_bf16 a[116:119], a[184:187], v[188:191], a[116:119]
  s_add_u32 s27, s27, 16384
  v_mfma_f32_16x16x32_bf16 a[56:59], a[188:191], v[168:171], a[56:59]
  s_add_u32 s25, s25, 32768
  ds_read_b128 a[156:159], v3 offset:15360
  v_mfma_f32_16x16x32_bf16 a[60:63], a[188:191], v[172:175], a[60:63]
  s_and_b32 s25, s25, 0x1ffff
  v_mfma_f32_16x16x32_bf16 a[120:123], a[188:191], v[184:187], a[120:123]
  s_waitcnt lgkmcnt(4)
  v_mfma_f32_16x16x32_bf16 a[124:127], a[188:191], v[188:191], a[124:127]
  s_cbranch_vccnz fa_stub8
fa_back8:
  v_add_f32 v230, v230, v226
  v_add_f32 v231, v231, v227
  v_add_u32 v3, 32768, v3
  v_and_b32 v3, 0x1ffff, v3
fa_SSpre:
  s_mov_b32 s11, 1
  s_cmp_lg_u32 s12, 0
  s_cselect_b32 s32, s15, s32
  s_cmp_eq_u32 s29, 0
  s_cbranch_scc1 fa_Bexit
.p2align 6
fa_SS:
  v_mfma_f32_16x16x32_bf16 v[128:131], a[128:131], v[64:67], v[200:203]
  s_waitcnt vmcnt(12)
  v_exp_f32 v216, v144
  v_mfma_f32_16x16x32_bf16 v[136:139], a[128:131], v[68:71], v[204:207]
  s_barrier
  v_exp_f32 v217, v145
  v_exp_f32 v218, v146
  v_mfma_f32_16x16x32_bf16 v[132:135], a[132:135], v[64:67], v[200:203]
  s_cmp_ge_u32 s26, s32
  ds_read_b128 a[160:163], v3 offset:16384
  ds_read_b128 a[164:167], v3 offset:17408
  v_mfma_f32_16x16x32_bf16 v[140:143], a[132:135], v[68:71], v[204:207]
  s_cbranch_scc1 fa_hk2
fa_hb2:
  s_mov_b32 m0, s24
  v_exp_f32 v219, v147
  v_mfma_f32_16x16x32_bf16 v[128:131], a[136:139], v[72:75], v[128:131]
  ds_read_b128 a[168:171], v3 offset:18432
  buffer_load_dwordx4 v2, s[44:47], s26 offen offset:0 sc1 lds
  v_mfma_f32_16x16x32_bf16 v[136:139], a[136:139], v[76:79], v[136:139]
  v_exp_f32 v220, v148
  v_add_f32 v226, v216, v217
  v_mfma_f32_16x16x32_bf16 v[132:135], a[140:143], v[72:75], v[132:135]
  ds_read_b128 a[172:175], v3 offset:19456
  v_cvt_pk_bf16_f32 v184, v216, v217
  v_mfma_f32_16x16x32_bf16 v[140:143], a[140:143], v[76:79], v[140:143]
  s_waitcnt lgkmcnt(4)
  v_exp_f32 v221, v149
  v_add_f32 v226, v226, v218
  v_mfma_f32_16x16x32_bf16 v[128:131], a[144:147], v[80:83], v[128:131]
  ds_read_b128 a[176:179], v3 offset:20480
  v_add_f32 v226, v226, v219
  v_mfma_f32_16x16x32_bf16 v[136:139], a[144:147], v[84:87], v[136:139]
  v_exp_f32 v222, v150
  v_cvt_pk_bf16_f32 v185, v218, v219
  v_mfma_f32_16x16x32_bf16 v[132:135], a[148:151], v[80:83], v[132:135]
  ds_read_b128 a[180:183], v3 offset:21504
  buffer_load_dwordx4 v2, s[44:47], s26 offen offset:1024 sc1 lds
  v_mfma_f32_16x16x32_bf16 v[140:143], a[148:151], v[84:87], v[140:143]
  v_exp_f32 v223, v151
  v_mfma_f32_16x16x32_bf16 v[128:131], a[152:155], v[88:91], v[128:131]
  ds_read_b128 a[184:187], v3 offset:22528
  v_add_f32 v226, v226, v220
  v_add_f32 v226, v226, v221
  v_mfma_f32_16x16x32_bf16 v[136:139], a[152:155], v[92:95], v[136:139]
  v_exp_f32 v216, v152
  v_mfma_f32_16x16x32_bf16 v[132:135], a[156:159], v[88:91], v[132:135]
  ds_read_b128 a[188:191], v3 offset:23552
  v_cvt_pk_bf16_f32 v186, v220, v221
  v_add_f32 v226, v226, v222
  v_mfma_f32_16x16x32_bf16 v[140:143], a[156:159], v[92:95], v[140:143]
  s_waitcnt lgkmcnt(4)
  v_exp_f32 v217, v153
  v_mfma_f32_16x16x32_bf16 a[64:67], a[160:163], v[176:179], a[64:67]
  ds_read_b128 a[128:131], v3 offset:0
  v_add_f32 v226, v226, v223
  v_cvt_pk_bf16_f32 v187, v222, v223
  v_mfma_f32_16x16x32_bf16 a[68:71], a[160:163], v[180:183], a[68:71]
  v_exp_f32 v218, v154
  v_mfma_f32_16x16x32_bf16 a[72:75], a[164:167], v[176:179], a[72:75]
  ds_read_b128 a[132:135], v3 offset:1024
  buffer_load_dwordx4 v2, s[44:47], s26 offen offset:2048 sc1 lds
  v_add_f32 v227, v216, v217
  v_mfma_f32_16x16x32_bf16 a[76:79], a[164:167], v[180:183], a[76:79]
  v_exp_f32 v219, v155
  v_mfma_f32_16x16x32_bf16 a[80:83], a[168:171], v[176:179], a[80:83]
  ds_read_b128 a[136:139], v3 offset:2048
  v_cvt_pk_bf16_f32 v188, v216, v217
  v_mfma_f32_16x16x32_bf16 a[84:87], a[168:171], v[180:183], a[84:87]
  v_exp_f32 v220, v156
  v_add_f32 v227, v227, v218
  v_mfma_f32_16x16x32_bf16 a[88:91], a[172:175], v[176:179], a[88:91]
  ds_read_b128 a[140:143], v3 offset:3072
  v_add_f32 v227, v227, v219
  v_mfma_f32_16x16x32_bf16 a[92:95], a[172:175], v[180:183], a[92:95]
  s_waitcnt lgkmcnt(4)
  v_exp_f32 v221, v157
  v_cvt_pk_bf16_f32 v189, v218, v219
  v_mfma_f32_16x16x32_bf16 a[96:99], a[176:179], v[176:179], a[96:99]
  ds_read_b128 a[144:147], v3 offset:4096
  buffer_load_dwordx4 v2, s[44:47], s26 offen offset:3072 sc1 lds
  v_mfma_f32_16x16x32_bf16 a[100:103], a[176:179], v[180:183], a[100:103]
  s_add_u32 s26, s26, 16384
  v_exp_f32 v222, v158
  v_add_f32 v227, v227, v220
  v_mfma_f32_16x16x32_bf16 a[104:107], a[180:183], v[176:179], a[104:107]
  s_add_u32 s24, s24, 32768
  ds_read_b128 a[148:151], v3 offset:5120
  v_add_f32 v227, v227, v221
  v_mfma_f32_16x16x32_bf16 a[108:111], a[180:183], v[180:183], a[108:111]
  s_and_b32 s24, s24, 0x1ffff
  v_exp_f32 v223, v159
  v_cvt_pk_bf16_f32 v190, v220, v221
  v_mfma_f32_16x16x32_bf16 a[112:115], a[184:187], v[176:179], a[112:115]
  ds_read_b128 a[152:155], v3 offset:6144
  v_add_f32 v227, v227, v222
  v_mfma_f32_16x16x32_bf16 a[116:119], a[184:187], v[180:183], a[116:119]
  v_add_f32 v227, v227, v223
  v_cvt_pk_bf16_f32 v191, v222, v223
  v_max_f32 v5, v226, v227
  v_mfma_f32_16x16x32_bf16 a[120:123], a[188:191], v[176:179], a[120:123]
  s_waitcnt lgkmcnt(3)
  ds_read_b128 a[156:159], v3 offset:7168
  v_cmp_lt_f32 vcc, s81, v5
  v_mfma_f32_16x16x32_bf16 a[124:127], a[188:191], v[180:183], a[124:127]
  s_cbranch_vccnz fa_stub9
fa_back9:
  v_add_f32 v230, v230, v226
  v_add_f32 v231, v231, v227
  v_mfma_f32_16x16x32_bf16 v[144:147], a[128:131], v[64:67], v[200:203]
  ds_read_b128 a[160:163], v3 offset:24576
  v_exp_f32 v216, v128
  v_mfma_f32_16x16x32_bf16 v[152:155], a[128:131], v[68:71], v[204:207]
  v_exp_f32 v217, v129
  v_mfma_f32_16x16x32_bf16 v[148:151], a[132:135], v[64:67], v[200:203]
  ds_read_b128 a[164:167], v3 offset:25600
  v_add_f32 v226, v216, v217
  v_mfma_f32_16x16x32_bf16 v[156:159], a[132:135], v[68:71], v[204:207]
  s_mov_b32 m0, s25
  v_exp_f32 v218, v130
  v_cvt_pk_bf16_f32 v176, v216, v217
  v_mfma_f32_16x16x32_bf16 v[144:147], a[136:139], v[72:75], v[144:147]
  ds_read_b128 a[168:171], v3 offset:26624
  buffer_load_dwordx4 v2, s[48:51], s27 offen offset:0 sc1 lds
  v_mfma_f32_16x16x32_bf16 v[152:155], a[136:139], v[76:79], v[152:155]
  v_exp_f32 v219, v131
  v_add_f32 v226, v226, v218
  v_mfma_f32_16x16x32_bf16 v[148:151], a[140:143], v[72:75], v[148:151]
  ds_read_b128 a[172:175], v3 offset:27648
  v_add_f32 v226, v226, v219
  v_mfma_f32_16x16x32_bf16 v[156:159], a[140:143], v[76:79], v[156:159]
  s_waitcnt lgkmcnt(4)
  v_exp_f32 v220, v132
  v_cvt_pk_bf16_f32 v177, v218, v219
  v_mfma_f32_16x16x32_bf16 v[144:147], a[144:147], v[80:83], v[144:147]
  ds_read_b128 a[176:179], v3 offset:28672
  v_add_f32 v226, v226, v220
  v_mfma_f32_16x16x32_bf16 v[152:155], a[144:147], v[84:87], v[152:155]
  v_exp_f32 v221, v133
  v_exp_f32 v222, v134
  v_mfma_f32_16x16x32_bf16 v[148:151], a[148:151], v[80:83], v[148:151]
  ds_read_b128 a[180:183], v3 offset:29696
  buffer_load_dwordx4 v2, s[48:51], s27 offen offset:1024 sc1 lds
  v_mfma_f32_16x16x32_bf16 v[156:159], a[148:151], v[84:87], v[156:159]
  v_exp_f32 v223, v135
  v_mfma_f32_16x16x32_bf16 v[144:147], a[152:155], v[88:91], v[144:147]
  ds_read_b128 a[184:187], v3 offset:30720
  v_add_f32 v226, v226, v221
  v_mfma_f32_16x16x32_bf16 v[152:155], a[152:155], v[92:95], v[152:155]
  v_exp_f32 v216, v136
  v_mfma_f32_16x16x32_bf16 v[148:151], a[156:159], v[88:91], v[148:151]
  ds_read_b128 a[188:191], v3 offset:31744
  v_cvt_pk_bf16_f32 v178, v220, v221
  v_add_f32 v226, v226, v222
  v_mfma_f32_16x16x32_bf16 v[156:159], a[156:159], v[92:95], v[156:159]
  s_waitcnt lgkmcnt(4)
  v_exp_f32 v217, v137
  v_mfma_f32_16x16x32_bf16 a[64:67], a[160:163], v[184:187], a[64:67]
  ds_read_b128 a[128:131], v3 offset:8192
  v_add_f32 v226, v226, v223
  v_cvt_pk_bf16_f32 v179, v222, v223
  v_mfma_f32_16x16x32_bf16 a[68:71], a[160:163], v[188:191], a[68:71]
  v_exp_f32 v218, v138
  v_mfma_f32_16x16x32_bf16 a[72:75], a[164:167], v[184:187], a[72:75]
  ds_read_b128 a[132:135], v3 offset:9216
  buffer_load_dwordx4 v2, s[48:51], s27 offen offset:2048 sc1 lds
  v_add_f32 v227, v216, v217
  v_mfma_f32_16x16x32_bf16 a[76:79], a[164:167], v[188:191], a[76:79]
  v_exp_f32 v219, v139
  v_mfma_f32_16x16x32_bf16 a[80:83], a[168:171], v[184:187], a[80:83]
  ds_read_b128 a[136:139], v3 offset:10240
  v_cvt_pk_bf16_f32 v180, v216, v217
  v_mfma_f32_16x16x32_bf16 a[84:87], a[168:171], v[188:191], a[84:87]
  v_exp_f32 v220, v140
  v_add_f32 v227, v227, v218
  v_mfma_f32_16x16x32_bf16 a[88:91], a[172:175], v[184:187], a[88:91]
  ds_read_b128 a[140:143], v3 offset:11264
  v_add_f32 v227, v227, v219
  v_mfma_f32_16x16x32_bf16 a[92:95], a[172:175], v[188:191], a[92:95]
  s_waitcnt lgkmcnt(4)
  v_exp_f32 v221, v141
  v_cvt_pk_bf16_f32 v181, v218, v219
  v_mfma_f32_16x16x32_bf16 a[96:99], a[176:179], v[184:187], a[96:99]
  ds_read_b128 a[144:147], v3 offset:12288
  buffer_load_dwordx4 v2, s[48:51], s27 offen offset:3072 sc1 lds
  v_mfma_f32_16x16x32_bf16 a[100:103], a[176:179], v[188:191], a[100:103]
  s_add_u32 s27, s27, 16384
  v_exp_f32 v222, v142
  v_add_f32 v227, v227, v220
  v_mfma_f32_16x16x32_bf16 a[104:107], a[180:183], v[184:187], a[104:107]
  s_add_u32 s25, s25, 32768
  ds_read_b128 a[148:151], v3 offset:13312
  v_add_f32 v227, v227, v221
  v_mfma_f32_16x16x32_bf16 a[108:111], a[180:183], v[188:191], a[108:111]
  s_and_b32 s25, s25, 0x1ffff
  v_exp_f32 v223, v143
  v_cvt_pk_bf16_f32 v182, v220, v221
  v_mfma_f32_16x16x32_bf16 a[112:115], a[184:187], v[184:187], a[112:115]
  ds_read_b128 a[152:155], v3 offset:14336
  v_add_f32 v227, v227, v222
  v_mfma_f32_16x16x32_bf16 a[116:119], a[184:187], v[188:191], a[116:119]
  s_sub_u32 s29, s29, 1
  v_add_f32 v227, v227, v223
  v_cvt_pk_bf16_f32 v183, v222, v223
  v_max_f32 v5, v226, v227
  v_mfma_f32_16x16x32_bf16 a[120:123], a[188:191], v[184:187], a[120:123]
  s_waitcnt lgkmcnt(3)
  ds_read_b128 a[156:159], v3 offset:15360
  v_cmp_lt_f32 vcc, s81, v5
  v_mfma_f32_16x16x32_bf16 a[124:127], a[188:191], v[188:191], a[124:127]
  s_cbranch_vccnz fa_stub10
fa_back10:
  v_add_f32 v230, v230, v226
  v_add_f32 v231, v231, v227
  v_add_u32 v3, 32768, v3
  v_and_b32 v3, 0x1ffff, v3
  s_cmp_lg_u32 s29, 0
  s_cbranch_scc1 fa_SS
fa_Bexit:
  s_bitcmp1_b32 s20, 0
  s_cbranch_scc1 fa_Bodd
  v_mfma_f32_16x16x32_bf16 v[128:131], a[128:131], v[64:67], v[200:203]
  s_waitcnt vmcnt(0)
  v_exp_f32 v216, v144
  v_mfma_f32_16x16x32_bf16 v[136:139], a[128:131], v[68:71], v[204:207]
  s_barrier
  v_exp_f32 v217, v145
  v_mfma_f32_16x16x32_bf16 v[132:135], a[132:135], v[64:67], v[200:203]
  ds_read_b128 a[160:163], v3 offset:16384
  ds_read_b128 a[164:167], v3 offset:17408
  v_mfma_f32_16x16x32_bf16 v[140:143], a[132:135], v[68:71], v[204:207]
  v_exp_f32 v218, v146
  v_mfma_f32_16x16x32_bf16 v[128:131], a[136:139], v[72:75], v[128:131]
  ds_read_b128 a[168:171], v3 offset:18432
  v_add_f32 v226, v216, v217
  v_mfma_f32_16x16x32_bf16 v[136:139], a[136:139], v[76:79], v[136:139]
  v_exp_f32 v219, v147
  v_mfma_f32_16x16x32_bf16 v[132:135], a[140:143], v[72:75], v[132:135]
  ds_read_b128 a[172:175], v3 offset:19456
  v_cvt_pk_bf16_f32 v184, v216, v217
  v_mfma_f32_16x16x32_bf16 v[140:143], a[140:143], v[76:79], v[140:143]
  s_waitcnt lgkmcnt(4)
  v_exp_f32 v220, v148
  v_add_f32 v226, v226, v218
  v_mfma_f32_16x16x32_bf16 v[128:131], a[144:147], v[80:83], v[128:131]
  ds_read_b128 a[176:179], v3 offset:20480
  v_add_f32 v226, v226, v219
  v_mfma_f32_16x16x32_bf16 v[136:139], a[144:147], v[84:87], v[136:139]
  v_exp_f32 v221, v149
  v_mfma_f32_16x16x32_bf16 v[132:135], a[148:151], v[80:83], v[132:135]
  ds_read_b128 a[180:183], v3 offset:21504
  v_cvt_pk_bf16_f32 v185, v218, v219
  v_mfma_f32_16x16x32_bf16 v[140:143], a[148:151], v[84:87], v[140:143]
  v_exp_f32 v222, v150
  v_mfma_f32_16x16x32_bf16 v[128:131], a[152:155], v[88:91], v[128:131]
  ds_read_b128 a[184:187], v3 offset:22528
  v_add_f32 v226, v226, v220
  v_mfma_f32_16x16x32_bf16 v[136:139], a[152:155], v[92:95], v[136:139]
  v_exp_f32 v223, v151
  v_mfma_f32_16x16x32_bf16 v[132:135], a[156:159], v[88:91], v[132:135]
  ds_read_b128 a[188:191], v3 offset:23552
  v_add_f32 v226, v226, v221
  v_mfma_f32_16x16x32_bf16 v[140:143], a[156:159], v[92:95], v[140:143]
  s_waitcnt lgkmcnt(4)
  v_exp_f32 v216, v152
  v_mfma_f32_16x16x32_bf16 a[64:67], a[160:163], v[176:179], a[64:67]
  v_exp_f32 v217, v153
  v_mfma_f32_16x16x32_bf16 a[68:71], a[160:163], v[180:183], a[68:71]
  v_exp_f32 v218, v154
  v_mfma_f32_16x16x32_bf16 a[72:75], a[164:167], v[176:179], a[72:75]
  v_exp_f32 v219, v155
  v_mfma_f32_16x16x32_bf16 a[76:79], a[164:167], v[180:183], a[76:79]
  v_cvt_pk_bf16_f32 v186, v220, v221
  v_add_f32 v226, v226, v222
  v_mfma_f32_16x16x32_bf16 a[80:83], a[168:171], v[176:179], a[80:83]
  v_exp_f32 v220, v156
  v_mfma_f32_16x16x32_bf16 a[84:87], a[168:171], v[180:183], a[84:87]
  v_exp_f32 v221, v157
  v_mfma_f32_16x16x32_bf16 a[88:91], a[172:175], v[176:179], a[88:91]
  v_add_f32 v226, v226, v223
  v_cvt_pk_bf16_f32 v187, v222, v223
  v_mfma_f32_16x16x32_bf16 a[92:95], a[172:175], v[180:183], a[92:95]
  s_waitcnt lgkmcnt(0)
  v_exp_f32 v222, v158
  v_add_f32 v227, v216, v217
  v_mfma_f32_16x16x32_bf16 a[96:99], a[176:179], v[176:179], a[96:99]
  v_exp_f32 v223, v159
  v_mfma_f32_16x16x32_bf16 a[100:103], a[176:179], v[180:183], a[100:103]
  v_cvt_pk_bf16_f32 v188, v216, v217
  v_add_f32 v227, v227, v218
  v_mfma_f32_16x16x32_bf16 a[104:107], a[180:183], v[176:179], a[104:107]
  v_add_f32 v227, v227, v219
  v_cvt_pk_bf16_f32 v189, v218, v219
  v_mfma_f32_16x16x32_bf16 a[108:111], a[180:183], v[180:183], a[108:111]
  v_add_f32 v227, v227, v220
  v_add_f32 v227, v227, v221
  v_mfma_f32_16x16x32_bf16 a[112:115], a[184:187], v[176:179], a[112:115]
  v_cvt_pk_bf16_f32 v190, v220, v221
  v_add_f32 v227, v227, v222
  v_mfma_f32_16x16x32_bf16 a[116:119], a[184:187], v[180:183], a[116:119]
  v_add_f32 v227, v227, v223
  v_cvt_pk_bf16_f32 v191, v222, v223
  v_mfma_f32_16x16x32_bf16 a[120:123], a[188:191], v[176:179], a[120:123]
  v_max_f32 v5, v226, v227
  v_cmp_lt_f32 vcc, s81, v5
  v_mfma_f32_16x16x32_bf16 a[124:127], a[188:191], v[180:183], a[124:127]
  s_cbranch_vccnz fa_stub11
fa_back11:
  v_add_f32 v230, v230, v226
  v_add_f32 v231, v231, v227
  ds_read_b128 a[160:163], v3 offset:24576
  ds_read_b128 a[164:167], v3 offset:25600
  ds_read_b128 a[168:171], v3 offset:26624
  ds_read_b128 a[172:175], v3 offset:27648
  ds_read_b128 a[176:179], v3 offset:28672
  ds_read_b128 a[180:183], v3 offset:29696
  ds_read_b128 a[184:187], v3 offset:30720
  ds_read_b128 a[188:191], v3 offset:31744
  v_cndmask_b32 v128, v4, v128, s[68:69]
  v_cndmask_b32 v129, v4, v129, s[70:71]
  v_cndmask_b32 v130, v4, v130, s[72:73]
  v_cndmask_b32 v131, v4, v131, s[74:75]
  v_mov_b32 v132, v4
  v_mov_b32 v133, v4
  v_mov_b32 v134, v4
  v_mov_b32 v135, v4
  v_cndmask_b32 v140, v4, v140, s[68:69]
  v_cndmask_b32 v141, v4, v141, s[70:71]
  v_cndmask_b32 v142, v4, v142, s[72:73]
  v_cndmask_b32 v143, v4, v143, s[74:75]
  v_exp_f32 v216, v128
  v_exp_f32 v217, v129
  v_exp_f32 v218, v130
  v_exp_f32 v219, v131
  v_exp_f32 v220, v132
  v_exp_f32 v221, v133
  v_exp_f32 v222, v134
  v_exp_f32 v223, v135
  v_add_f32 v226, v216, v217
  v_cvt_pk_bf16_f32 v176, v216, v217
  s_waitcnt lgkmcnt(4)
  v_mfma_f32_16x16x32_bf16 a[64:67], a[160:163], v[184:187], a[64:67]
  v_exp_f32 v216, v136
  v_add_f32 v226, v226, v218
  v_mfma_f32_16x16x32_bf16 a[68:71], a[160:163], v[188:191], a[68:71]
  v_exp_f32 v217, v137
  v_mfma_f32_16x16x32_bf16 a[72:75], a[164:167], v[184:187], a[72:75]
  v_add_f32 v226, v226, v219
  v_cvt_pk_bf16_f32 v177, v218, v219
  v_add_f32 v226, v226, v220
  v_mfma_f32_16x16x32_bf16 a[76:79], a[164:167], v[188:191], a[76:79]
  v_exp_f32 v218, v138
  v_mfma_f32_16x16x32_bf16 a[80:83], a[168:171], v[184:187], a[80:83]
  v_exp_f32 v219, v139
  v_add_f32 v226, v226, v221
  v_mfma_f32_16x16x32_bf16 a[84:87], a[168:171], v[188:191], a[84:87]
  v_cvt_pk_bf16_f32 v178, v220, v221
  v_add_f32 v226, v226, v222
  v_mfma_f32_16x16x32_bf16 a[88:91], a[172:175], v[184:187], a[88:91]
  v_exp_f32 v220, v140
  v_add_f32 v226, v226, v223
  v_mfma_f32_16x16x32_bf16 a[92:95], a[172:175], v[188:191], a[92:95]
  s_waitcnt lgkmcnt(0)
  v_exp_f32 v221, v141
  v_mfma_f32_16x16x32_bf16 a[96:99], a[176:179], v[184:187], a[96:99]
  v_cvt_pk_bf16_f32 v179, v222, v223
  v_add_f32 v227, v216, v217
  v_cvt_pk_bf16_f32 v180, v216, v217
  v_mfma_f32_16x16x32_bf16 a[100:103], a[176:179], v[188:191], a[100:103]
  v_exp_f32 v222, v142
  v_mfma_f32_16x16x32_bf16 a[104:107], a[180:183], v[184:187], a[104:107]
  v_exp_f32 v223, v143
  v_add_f32 v227, v227, v218
  v_mfma_f32_16x16x32_bf16 a[108:111], a[180:183], v[188:191], a[108:111]
  v_add_f32 v227, v227, v219
  v_cvt_pk_bf16_f32 v181, v218, v219
  v_mfma_f32_16x16x32_bf16 a[112:115], a[184:187], v[184:187], a[112:115]
  v_add_f32 v227, v227, v220
  v_add_f32 v227, v227, v221
  v_cvt_pk_bf16_f32 v182, v220, v221
  v_mfma_f32_16x16x32_bf16 a[116:119], a[184:187], v[188:191], a[116:119]
  v_add_f32 v227, v227, v222
  v_add_f32 v227, v227, v223
  v_mfma_f32_16x16x32_bf16 a[120:123], a[188:191], v[184:187], a[120:123]
  v_cvt_pk_bf16_f32 v183, v222, v223
  v_max_f32 v5, v226, v227
  v_cmp_lt_f32 vcc, s81, v5
  v_mfma_f32_16x16x32_bf16 a[124:127], a[188:191], v[188:191], a[124:127]
  s_cbranch_vccnz fa_stub12
fa_back12:
  v_add_f32 v230, v230, v226
  v_add_f32 v231, v231, v227
  v_add_u32 v3, 32768, v3
  v_and_b32 v3, 0x1ffff, v3
  s_waitcnt vmcnt(0)
  s_barrier
  ds_read_b128 a[160:163], v3 offset:16384
  ds_read_b128 a[164:167], v3 offset:17408
  ds_read_b128 a[168:171], v3 offset:18432
  ds_read_b128 a[172:175], v3 offset:19456
  ds_read_b128 a[176:179], v3 offset:20480
  ds_read_b128 a[180:183], v3 offset:21504
  ds_read_b128 a[184:187], v3 offset:22528
  ds_read_b128 a[188:191], v3 offset:23552
  s_waitcnt lgkmcnt(4)
  v_mfma_f32_16x16x32_bf16 a[64:67], a[160:163], v[176:179], a[64:67]
  v_mfma_f32_16x16x32_bf16 a[68:71], a[160:163], v[180:183], a[68:71]
  v_mfma_f32_16x16x32_bf16 a[72:75], a[164:167], v[176:179], a[72:75]
  v_mfma_f32_16x16x32_bf16 a[76:79], a[164:167], v[180:183], a[76:79]
  v_mfma_f32_16x16x32_bf16 a[80:83], a[168:171], v[176:179], a[80:83]
  v_mfma_f32_16x16x32_bf16 a[84:87], a[168:171], v[180:183], a[84:87]
  v_mfma_f32_16x16x32_bf16 a[88:91], a[172:175], v[176:179], a[88:91]
  v_mfma_f32_16x16x32_bf16 a[92:95], a[172:175], v[180:183], a[92:95]
  s_waitcnt lgkmcnt(0)
  v_mfma_f32_16x16x32_bf16 a[96:99], a[176:179], v[176:179], a[96:99]
  v_mfma_f32_16x16x32_bf16 a[100:103], a[176:179], v[180:183], a[100:103]
  v_mfma_f32_16x16x32_bf16 a[104:107], a[180:183], v[176:179], a[104:107]
  v_mfma_f32_16x16x32_bf16 a[108:111], a[180:183], v[180:183], a[108:111]
  v_mfma_f32_16x16x32_bf16 a[112:115], a[184:187], v[176:179], a[112:115]
  v_mfma_f32_16x16x32_bf16 a[116:119], a[184:187], v[180:183], a[116:119]
  v_mfma_f32_16x16x32_bf16 a[120:123], a[188:191], v[176:179], a[120:123]
  v_mfma_f32_16x16x32_bf16 a[124:127], a[188:191], v[180:183], a[124:127]
  s_branch fa_Bdone
fa_Bodd:
  s_waitcnt vmcnt(0)
  s_barrier
  ds_read_b128 a[160:163], v3 offset:16384
  ds_read_b128 a[164:167], v3 offset:17408
  ds_read_b128 a[168:171], v3 offset:18432
  ds_read_b128 a[172:175], v3 offset:19456
  ds_read_b128 a[176:179], v3 offset:20480
  ds_read_b128 a[180:183], v3 offset:21504
  ds_read_b128 a[184:187], v3 offset:22528
  ds_read_b128 a[188:191], v3 offset:23552
  v_cndmask_b32 v144, v4, v144, s[68:69]
  v_cndmask_b32 v145, v4, v145, s[70:71]
  v_cndmask_b32 v146, v4, v146, s[72:73]
  v_cndmask_b32 v147, v4, v147, s[74:75]
  v_mov_b32 v148, v4
  v_mov_b32 v149, v4
  v_mov_b32 v150, v4
  v_mov_b32 v151, v4
  v_cndmask_b32 v156, v4, v156, s[68:69]
  v_cndmask_b32 v157, v4, v157, s[70:71]
  v_cndmask_b32 v158, v4, v158, s[72:73]
  v_cndmask_b32 v159, v4, v159, s[74:75]
  v_exp_f32 v216, v144
  v_exp_f32 v217, v145
  v_exp_f32 v218, v146
  v_exp_f32 v219, v147
  v_exp_f32 v220, v148
  v_exp_f32 v221, v149
  v_exp_f32 v222, v150
  v_exp_f32 v223, v151
  v_add_f32 v226, v216, v217
  v_cvt_pk_bf16_f32 v184, v216, v217
  s_waitcnt lgkmcnt(4)
  v_mfma_f32_16x16x32_bf16 a[64:67], a[160:163], v[176:179], a[64:67]
  v_exp_f32 v216, v152
  v_add_f32 v226, v226, v218
  v_mfma_f32_16x16x32_bf16 a[68:71], a[160:163], v[180:183], a[68:71]
  v_exp_f32 v217, v153
  v_mfma_f32_16x16x32_bf16 a[72:75], a[164:167], v[176:179], a[72:75]
  v_add_f32 v226, v226, v219
  v_cvt_pk_bf16_f32 v185, v218, v219
  v_add_f32 v226, v226, v220
  v_mfma_f32_16x16x32_bf16 a[76:79], a[164:167], v[180:183], a[76:79]
  v_exp_f32 v218, v154
  v_mfma_f32_16x16x32_bf16 a[80:83], a[168:171], v[176:179], a[80:83]
  v_exp_f32 v219, v155
  v_add_f32 v226, v226, v221
  v_mfma_f32_16x16x32_bf16 a[84:87], a[168:171], v[180:183], a[84:87]
  v_cvt_pk_bf16_f32 v186, v220, v221
  v_add_f32 v226, v226, v222
  v_mfma_f32_16x16x32_bf16 a[88:91], a[172:175], v[176:179], a[88:91]
  v_exp_f32 v220, v156
  v_add_f32 v226, v226, v223
  v_mfma_f32_16x16x32_bf16 a[92:95], a[172:175], v[180:183], a[92:95]
  s_waitcnt lgkmcnt(0)
  v_exp_f32 v221, v157
  v_mfma_f32_16x16x32_bf16 a[96:99], a[176:179], v[176:179], a[96:99]
  v_cvt_pk_bf16_f32 v187, v222, v223
  v_add_f32 v227, v216, v217
  v_cvt_pk_bf16_f32 v188, v216, v217
  v_mfma_f32_16x16x32_bf16 a[100:103], a[176:179], v[180:183], a[100:103]
  v_exp_f32 v222, v158
  v_mfma_f32_16x16x32_bf16 a[104:107], a[180:183], v[176:179], a[104:107]
  v_exp_f32 v223, v159
  v_add_f32 v227, v227, v218
  v_mfma_f32_16x16x32_bf16 a[108:111], a[180:183], v[180:183], a[108:111]
  v_add_f32 v227, v227, v219
  v_cvt_pk_bf16_f32 v189, v218, v219
  v_mfma_f32_16x16x32_bf16 a[112:115], a[184:187], v[176:179], a[112:115]
  v_add_f32 v227, v227, v220
  v_add_f32 v227, v227, v221
  v_cvt_pk_bf16_f32 v190, v220, v221
  v_mfma_f32_16x16x32_bf16 a[116:119], a[184:187], v[180:183], a[116:119]
  v_add_f32 v227, v227, v222
  v_add_f32 v227, v227, v223
  v_mfma_f32_16x16x32_bf16 a[120:123], a[188:191], v[176:179], a[120:123]
  v_cvt_pk_bf16_f32 v191, v222, v223
  v_max_f32 v5, v226, v227
  v_cmp_lt_f32 vcc, s81, v5
  v_mfma_f32_16x16x32_bf16 a[124:127], a[188:191], v[180:183], a[124:127]
  s_cbranch_vccnz fa_stub13
fa_back13:
  v_add_f32 v230, v230, v226
  v_add_f32 v231, v231, v227
  ds_read_b128 a[160:163], v3 offset:24576
  ds_read_b128 a[164:167], v3 offset:25600
  ds_read_b128 a[168:171], v3 offset:26624
  ds_read_b128 a[172:175], v3 offset:27648
  ds_read_b128 a[176:179], v3 offset:28672
  ds_read_b128 a[180:183], v3 offset:29696
  ds_read_b128 a[184:187], v3 offset:30720
  ds_read_b128 a[188:191], v3 offset:31744
  s_waitcnt lgkmcnt(4)
  v_mfma_f32_16x16x32_bf16 a[64:67], a[160:163], v[184:187], a[64:67]
  v_mfma_f32_16x16x32_bf16 a[68:71], a[160:163], v[188:191], a[68:71]
  v_mfma_f32_16x16x32_bf16 a[72:75], a[164:167], v[184:187], a[72:75]
  v_mfma_f32_16x16x32_bf16 a[76:79], a[164:167], v[188:191], a[76:79]
  v_mfma_f32_16x16x32_bf16 a[80:83], a[168:171], v[184:187], a[80:83]
  v_mfma_f32_16x16x32_bf16 a[84:87], a[168:171], v[188:191], a[84:87]
  v_mfma_f32_16x16x32_bf16 a[88:91], a[172:175], v[184:187], a[88:91]
  v_mfma_f32_16x16x32_bf16 a[92:95], a[172:175], v[188:191], a[92:95]
  s_waitcnt lgkmcnt(0)
  v_mfma_f32_16x16x32_bf16 a[96:99], a[176:179], v[184:187], a[96:99]
  v_mfma_f32_16x16x32_bf16 a[100:103], a[176:179], v[188:191], a[100:103]
  v_mfma_f32_16x16x32_bf16 a[104:107], a[180:183], v[184:187], a[104:107]
  v_mfma_f32_16x16x32_bf16 a[108:111], a[180:183], v[188:191], a[108:111]
  v_mfma_f32_16x16x32_bf16 a[112:115], a[184:187], v[184:187], a[112:115]
  v_mfma_f32_16x16x32_bf16 a[116:119], a[184:187], v[188:191], a[116:119]
  v_mfma_f32_16x16x32_bf16 a[120:123], a[188:191], v[184:187], a[120:123]
  v_mfma_f32_16x16x32_bf16 a[124:127], a[188:191], v[188:191], a[124:127]
  v_add_u32 v3, 32768, v3
  v_and_b32 v3, 0x1ffff, v3
fa_Bdone:
  s_cmp_ge_u32 s20, 2
  s_cbranch_scc1 fa_epi
  s_barrier
fa_epi:
  s_cmp_lt_u32 s12, 2
  s_cbranch_scc1 fa_hk3
fa_hb3:
  v_mov_b32 v20, v230
  v_mov_b32 v21, v231
  s_nop 1
  v_permlane16_swap_b32 v230, v20
  v_permlane16_swap_b32 v231, v21
  v_add_f32 v230, v230, v20
  v_add_f32 v231, v231, v21
  v_mov_b32 v20, v230
  v_mov_b32 v21, v231
  s_nop 1
  v_permlane32_swap_b32 v230, v20
  v_permlane32_swap_b32 v231, v21
  v_add_f32 v230, v230, v20
  v_add_f32 v231, v231, v21
  v_rcp_f32 v16, v230
  v_rcp_f32 v18, v231
  s_sub_u32 s23, 15, s22
  s_lshl_b32 s23, s23, 2
  v_mov_b32 v17, v16
  v_mov_b32 v19, v18
  s_add_u32 s23, s23, s20
  s_lshl_b32 s23, s23, 18
  s_lshl_b32 s31, s21, 12
  s_add_u32 s31, s31, 50331648
  s_add_u32 s64, s23, s31
  s_add_u32 s65, s64, 131072
  v_accvgpr_read_b32 v68, a64
  v_accvgpr_read_b32 v69, a65
  v_accvgpr_read_b32 v70, a66
  v_accvgpr_read_b32 v71, a67
  v_accvgpr_read_b32 v72, a72
  v_accvgpr_read_b32 v73, a73
  v_accvgpr_read_b32 v74, a74
  v_accvgpr_read_b32 v75, a75
  v_pk_mul_f32 v[68:69], v[68:69], v[16:17]
  v_pk_mul_f32 v[70:71], v[70:71], v[16:17]
  v_pk_mul_f32 v[72:73], v[72:73], v[16:17]
  v_pk_mul_f32 v[74:75], v[74:75], v[16:17]
  v_cvt_pk_bf16_f32 v64, v68, v69
  v_cvt_pk_bf16_f32 v65, v70, v71
  v_cvt_pk_bf16_f32 v66, v72, v73
  v_cvt_pk_bf16_f32 v67, v74, v75
  buffer_store_dwordx4 v[64:67], v2, s[40:43], s64 offen offset:0 sc1
  v_accvgpr_read_b32 v80, a80
  v_accvgpr_read_b32 v81, a81
  v_accvgpr_read_b32 v82, a82
  v_accvgpr_read_b32 v83, a83
  v_accvgpr_read_b32 v84, a88
  v_accvgpr_read_b32 v85, a89
  v_accvgpr_read_b32 v86, a90
  v_accvgpr_read_b32 v87, a91
  v_pk_mul_f32 v[80:81], v[80:81], v[16:17]
  v_pk_mul_f32 v[82:83], v[82:83], v[16:17]
  v_pk_mul_f32 v[84:85], v[84:85], v[16:17]
  v_pk_mul_f32 v[86:87], v[86:87], v[16:17]
  v_cvt_pk_bf16_f32 v76, v80, v81
  v_cvt_pk_bf16_f32 v77, v82, v83
  v_cvt_pk_bf16_f32 v78, v84, v85
  v_cvt_pk_bf16_f32 v79, v86, v87
  buffer_store_dwordx4 v[76:79], v2, s[40:43], s64 offen offset:1024 sc1
  v_accvgpr_read_b32 v132, a96
  v_accvgpr_read_b32 v133, a97
  v_accvgpr_read_b32 v134, a98
  v_accvgpr_read_b32 v135, a99
  v_accvgpr_read_b32 v136, a104
  v_accvgpr_read_b32 v137, a105
  v_accvgpr_read_b32 v138, a106
  v_accvgpr_read_b32 v139, a107
  v_pk_mul_f32 v[132:133], v[132:133], v[16:17]
  v_pk_mul_f32 v[134:135], v[134:135], v[16:17]
  v_pk_mul_f32 v[136:137], v[136:137], v[16:17]
  v_pk_mul_f32 v[138:139], v[138:139], v[16:17]
  v_cvt_pk_bf16_f32 v128, v132, v133
  v_cvt_pk_bf16_f32 v129, v134, v135
  v_cvt_pk_bf16_f32 v130, v136, v137
  v_cvt_pk_bf16_f32 v131, v138, v139
  buffer_store_dwordx4 v[128:131], v2, s[40:43], s64 offen offset:2048 sc1
  v_accvgpr_read_b32 v144, a112
  v_accvgpr_read_b32 v145, a113
  v_accvgpr_read_b32 v146, a114
  v_accvgpr_read_b32 v147, a115
  v_accvgpr_read_b32 v148, a120
  v_accvgpr_read_b32 v149, a121
  v_accvgpr_read_b32 v150, a122
  v_accvgpr_read_b32 v151, a123
  v_pk_mul_f32 v[144:145], v[144:145], v[16:17]
  v_pk_mul_f32 v[146:147], v[146:147], v[16:17]
  v_pk_mul_f32 v[148:149], v[148:149], v[16:17]
  v_pk_mul_f32 v[150:151], v[150:151], v[16:17]
  v_cvt_pk_bf16_f32 v140, v144, v145
  v_cvt_pk_bf16_f32 v141, v146, v147
  v_cvt_pk_bf16_f32 v142, v148, v149
  v_cvt_pk_bf16_f32 v143, v150, v151
  buffer_store_dwordx4 v[140:143], v2, s[40:43], s64 offen offset:3072 sc1
  v_accvgpr_read_b32 v68, a68
  v_accvgpr_read_b32 v69, a69
  v_accvgpr_read_b32 v70, a70
  v_accvgpr_read_b32 v71, a71
  v_accvgpr_read_b32 v72, a76
  v_accvgpr_read_b32 v73, a77
  v_accvgpr_read_b32 v74, a78
  v_accvgpr_read_b32 v75, a79
  v_pk_mul_f32 v[68:69], v[68:69], v[18:19]
  v_pk_mul_f32 v[70:71], v[70:71], v[18:19]
  v_pk_mul_f32 v[72:73], v[72:73], v[18:19]
  v_pk_mul_f32 v[74:75], v[74:75], v[18:19]
  v_cvt_pk_bf16_f32 v64, v68, v69
  v_cvt_pk_bf16_f32 v65, v70, v71
  v_cvt_pk_bf16_f32 v66, v72, v73
  v_cvt_pk_bf16_f32 v67, v74, v75
  buffer_store_dwordx4 v[64:67], v2, s[40:43], s65 offen offset:0 sc1
  v_accvgpr_read_b32 v80, a84
  v_accvgpr_read_b32 v81, a85
  v_accvgpr_read_b32 v82, a86
  v_accvgpr_read_b32 v83, a87
  v_accvgpr_read_b32 v84, a92
  v_accvgpr_read_b32 v85, a93
  v_accvgpr_read_b32 v86, a94
  v_accvgpr_read_b32 v87, a95
  v_pk_mul_f32 v[80:81], v[80:81], v[18:19]
  v_pk_mul_f32 v[82:83], v[82:83], v[18:19]
  v_pk_mul_f32 v[84:85], v[84:85], v[18:19]
  v_pk_mul_f32 v[86:87], v[86:87], v[18:19]
  v_cvt_pk_bf16_f32 v76, v80, v81
  v_cvt_pk_bf16_f32 v77, v82, v83
  v_cvt_pk_bf16_f32 v78, v84, v85
  v_cvt_pk_bf16_f32 v79, v86, v87
  buffer_store_dwordx4 v[76:79], v2, s[40:43], s65 offen offset:1024 sc1
  v_accvgpr_read_b32 v132, a100
  v_accvgpr_read_b32 v133, a101
  v_accvgpr_read_b32 v134, a102
  v_accvgpr_read_b32 v135, a103
  v_accvgpr_read_b32 v136, a108
  v_accvgpr_read_b32 v137, a109
  v_accvgpr_read_b32 v138, a110
  v_accvgpr_read_b32 v139, a111
  v_pk_mul_f32 v[132:133], v[132:133], v[18:19]
  v_pk_mul_f32 v[134:135], v[134:135], v[18:19]
  v_pk_mul_f32 v[136:137], v[136:137], v[18:19]
  v_pk_mul_f32 v[138:139], v[138:139], v[18:19]
  v_cvt_pk_bf16_f32 v128, v132, v133
  v_cvt_pk_bf16_f32 v129, v134, v135
  v_cvt_pk_bf16_f32 v130, v136, v137
  v_cvt_pk_bf16_f32 v131, v138, v139
  buffer_store_dwordx4 v[128:131], v2, s[40:43], s65 offen offset:2048 sc1
  v_accvgpr_read_b32 v144, a116
  v_accvgpr_read_b32 v145, a117
  v_accvgpr_read_b32 v146, a118
  v_accvgpr_read_b32 v147, a119
  v_accvgpr_read_b32 v148, a124
  v_accvgpr_read_b32 v149, a125
  v_accvgpr_read_b32 v150, a126
  v_accvgpr_read_b32 v151, a127
  v_pk_mul_f32 v[144:145], v[144:145], v[18:19]
  v_pk_mul_f32 v[146:147], v[146:147], v[18:19]
  v_pk_mul_f32 v[148:149], v[148:149], v[18:19]
  v_pk_mul_f32 v[150:151], v[150:151], v[18:19]
  v_cvt_pk_bf16_f32 v140, v144, v145
  v_cvt_pk_bf16_f32 v141, v146, v147
  v_cvt_pk_bf16_f32 v142, v148, v149
  v_cvt_pk_bf16_f32 v143, v150, v151
  buffer_store_dwordx4 v[140:143], v2, s[40:43], s65 offen offset:3072 sc1
  s_load_dwordx2 s[4:5], s[0:1], 0
  s_load_dwordx2 s[6:7], s[0:1], 88
  v_mov_b32 v30, 1073741824
  v_mov_b32 v31, 1
  v_writelane_b32 v30, s80, 0
  v_writelane_b32 v30, s3, 1
  v_and_b32 v10, 15, v1
  v_lshlrev_b32 v10, 2, v10
  v_add_u32 v10, 2629632, v10
  v_min_u32 v11, 53, v1
  s_lshr_b32 s23, s22, 1
  s_lshl_b32 s23, s23, 8
  s_add_u32 s23, s23, 2650112
  v_lshl_add_u32 v11, v11, 2, s23
  buffer_load_dword v15, v10, s[40:43], 0 offen sc1
  buffer_load_dword v14, v11, s[40:43], 0 offen sc1
  s_lshl_b32 s64, s21, 19
  s_lshl_b32 s23, s20, 15
  s_add_u32 s64, s64, s23
  s_add_u32 s64, s64, 50331648
  s_add_u32 s65, s64, 131072
  s_add_u32 s66, s64, 262144
  s_add_u32 s67, s64, 393216
  v_bfe_u32 v12, v1, 3, 1
  v_lshlrev_b32 v12, 7, v12
  v_and_b32 v13, 7, v1
  v_lshl_add_u32 v12, v13, 2, v12
  s_lshl_b32 s23, s21, 8
  s_lshl_b32 s31, s20, 5
  s_add_u32 s23, s23, s31
  s_add_u32 s23, s23, 2641920
  v_add_u32 v12, s23, v12
  s_lshl_b32 s25, s21, 6
  s_mul_i32 s26, s22, 160
  s_mul_i32 s27, s22, 2560
  v_add_u32 v16, 0, v0
  v_mul_u32_u24 v17, 6554, v16
  v_lshrrev_b32 v17, 16, v17
  v_mul_u32_u24 v18, 10, v17
  v_sub_u32 v18, v16, v18
  v_mul_u32_u24 v251, 336, v17
  v_lshl_add_u32 v251, v18, 5, v251
  v_lshlrev_b32 v203, 5, v18
  v_add_u32 v17, s25, v17
  v_add_u32 v24, 1, v17
  v_mul_u32_u24 v248, 1280, v17
  v_lshl_add_u32 v248, v18, 4, v248
  v_add_u32 v248, s26, v248
  v_lshrrev_b32 v19, 4, v17
  v_mul_u32_u24 v19, 20480, v19
  v_and_b32 v17, 15, v17
  v_lshl_add_u32 v19, v17, 4, v19
  v_lshl_add_u32 v200, v18, 8, v19
  v_mov_b32 v27, 8
  v_add_u32 v16, 256, v0
  v_mul_u32_u24 v17, 6554, v16
  v_lshrrev_b32 v17, 16, v17
  v_mul_u32_u24 v18, 10, v17
  v_sub_u32 v18, v16, v18
  v_mul_u32_u24 v252, 336, v17
  v_lshl_add_u32 v252, v18, 5, v252
  v_lshlrev_b32 v204, 5, v18
  v_add_u32 v17, s25, v17
  v_add_u32 v25, 1, v17
  v_mul_u32_u24 v249, 1280, v17
  v_lshl_add_u32 v249, v18, 4, v249
  v_add_u32 v249, s26, v249
  v_lshrrev_b32 v19, 4, v17
  v_mul_u32_u24 v19, 20480, v19
  v_and_b32 v17, 15, v17
  v_lshl_add_u32 v19, v17, 4, v19
  v_lshl_add_u32 v201, v18, 8, v19
  v_mov_b32 v28, 8
  v_add_u32 v16, 512, v0
  v_mul_u32_u24 v17, 6554, v16
  v_lshrrev_b32 v17, 16, v17
  v_mul_u32_u24 v18, 10, v17
  v_sub_u32 v18, v16, v18
  v_mul_u32_u24 v253, 336, v17
  v_lshl_add_u32 v253, v18, 5, v253
  v_lshlrev_b32 v205, 5, v18
  v_add_u32 v17, s25, v17
  v_add_u32 v26, 1, v17
  v_mul_u32_u24 v250, 1280, v17
  v_lshl_add_u32 v250, v18, 4, v250
  v_add_u32 v250, s26, v250
  v_lshrrev_b32 v19, 4, v17
  v_mul_u32_u24 v19, 20480, v19
  v_and_b32 v17, 15, v17
  v_lshl_add_u32 v19, v17, 4, v19
  v_lshl_add_u32 v202, v18, 8, v19
  v_mov_b32 v29, 8
  v_cmp_gt_u32 vcc, 128, v0
  v_mov_b32 v16, 1073741824
  v_mov_b32 v17, 0
  v_cndmask_b32 v250, v16, v250, vcc
  v_cndmask_b32 v202, v16, v202, vcc
  v_cndmask_b32 v253, v17, v253, vcc
  v_mov_b32 v20, 0
  v_mov_b32 v21, 0
  v_mov_b32 v22, 0
  v_mov_b32 v23, 0
  v_add_u32 v16, 133632, v2
  ds_write_b128 v16, v[20:23]
  s_waitcnt vmcnt(0) lgkmcnt(0)
  buffer_store_dword v31, v30, s[40:43], 0 offen sc1
fa_hb4:
  s_cmp_lt_u32 s12, 2
  s_cbranch_scc1 fa_hk4
  buffer_load_dwordx4 a[0:3], v2, s[40:43], s13 offen offset:0 sc1
  buffer_load_dwordx4 a[4:7], v2, s[40:43], s13 offen offset:1024 sc1
  buffer_load_dwordx4 a[8:11], v2, s[40:43], s13 offen offset:2048 sc1
  buffer_load_dwordx4 a[12:15], v2, s[40:43], s13 offen offset:3072 sc1
  s_add_u32 s13, s13, 4096
  buffer_load_dwordx4 a[16:19], v2, s[40:43], s13 offen offset:0 sc1
  buffer_load_dwordx4 a[20:23], v2, s[40:43], s13 offen offset:1024 sc1
  buffer_load_dwordx4 a[24:27], v2, s[40:43], s13 offen offset:2048 sc1
  buffer_load_dwordx4 a[28:31], v2, s[40:43], s13 offen offset:3072 sc1
  s_add_u32 s13, s13, 4096
  buffer_load_dwordx4 a[32:35], v2, s[40:43], s13 offen offset:0 sc1
  buffer_load_dwordx4 a[36:39], v2, s[40:43], s13 offen offset:1024 sc1
  buffer_load_dwordx4 a[40:43], v2, s[40:43], s13 offen offset:2048 sc1
  buffer_load_dwordx4 a[44:47], v2, s[40:43], s13 offen offset:3072 sc1
  s_add_u32 s13, s13, 4096
  buffer_load_dwordx4 a[48:51], v2, s[40:43], s13 offen offset:0 sc1
  buffer_load_dwordx4 a[52:55], v2, s[40:43], s13 offen offset:1024 sc1
  buffer_load_dwordx4 a[56:59], v2, s[40:43], s13 offen offset:2048 sc1
  buffer_load_dwordx4 a[60:63], v2, s[40:43], s13 offen offset:3072 sc1
  s_add_u32 s13, s13, 4096
  buffer_load_dwordx4 a[192:195], v2, s[40:43], s13 offen offset:0 sc1
  buffer_load_dwordx4 a[196:199], v2, s[40:43], s13 offen offset:1024 sc1
  buffer_load_dwordx4 a[200:203], v2, s[40:43], s13 offen offset:2048 sc1
  buffer_load_dwordx4 a[204:207], v2, s[40:43], s13 offen offset:3072 sc1
  s_add_u32 s13, s13, 4096
  buffer_load_dwordx4 a[208:211], v2, s[40:43], s13 offen offset:0 sc1
  buffer_load_dwordx4 a[212:215], v2, s[40:43], s13 offen offset:1024 sc1
  buffer_load_dwordx4 a[216:219], v2, s[40:43], s13 offen offset:2048 sc1
  buffer_load_dwordx4 a[220:223], v2, s[40:43], s13 offen offset:3072 sc1
  s_add_u32 s13, s13, 4096
  buffer_load_dwordx4 a[224:227], v2, s[40:43], s13 offen offset:0 sc1
  buffer_load_dwordx4 a[228:231], v2, s[40:43], s13 offen offset:1024 sc1
  buffer_load_dwordx4 a[232:235], v2, s[40:43], s13 offen offset:2048 sc1
  buffer_load_dwordx4 a[236:239], v2, s[40:43], s13 offen offset:3072 sc1
  s_add_u32 s13, s13, 4096
  buffer_load_dwordx4 a[240:243], v2, s[40:43], s13 offen offset:0 sc1
  buffer_load_dwordx4 a[244:247], v2, s[40:43], s13 offen offset:1024 sc1
  buffer_load_dwordx4 a[248:251], v2, s[40:43], s13 offen offset:2048 sc1
  buffer_load_dwordx4 a[252:255], v2, s[40:43], s13 offen offset:3072 sc1
  s_add_u32 s13, s13, 4096
  buffer_load_dwordx4 v[32:35], v2, s[40:43], s13 offen offset:0 sc1
  buffer_load_dwordx4 v[36:39], v2, s[40:43], s13 offen offset:1024 sc1
  buffer_load_dwordx4 v[40:43], v2, s[40:43], s13 offen offset:2048 sc1
  buffer_load_dwordx4 v[44:47], v2, s[40:43], s13 offen offset:3072 sc1
  s_add_u32 s13, s13, 4096
  buffer_load_dwordx4 v[48:51], v2, s[40:43], s13 offen offset:0 sc1
  buffer_load_dwordx4 v[52:55], v2, s[40:43], s13 offen offset:1024 sc1
  buffer_load_dwordx4 v[56:59], v2, s[40:43], s13 offen offset:2048 sc1
  buffer_load_dwordx4 v[60:63], v2, s[40:43], s13 offen offset:3072 sc1
  s_add_u32 s13, s13, 4096
  buffer_load_dwordx4 v[96:99], v2, s[40:43], s13 offen offset:0 sc1
  buffer_load_dwordx4 v[100:103], v2, s[40:43], s13 offen offset:1024 sc1
  buffer_load_dwordx4 v[104:107], v2, s[40:43], s13 offen offset:2048 sc1
  buffer_load_dwordx4 v[108:111], v2, s[40:43], s13 offen offset:3072 sc1
  s_add_u32 s13, s13, 4096
  buffer_load_dwordx4 v[112:115], v2, s[40:43], s13 offen offset:0 sc1
  buffer_load_dwordx4 v[116:119], v2, s[40:43], s13 offen offset:1024 sc1
  buffer_load_dwordx4 v[120:123], v2, s[40:43], s13 offen offset:2048 sc1
  buffer_load_dwordx4 v[124:127], v2, s[40:43], s13 offen offset:3072 sc1
  s_add_u32 s13, s13, 4096
  buffer_load_dwordx4 v[160:163], v2, s[40:43], s13 offen offset:0 sc1
  buffer_load_dwordx4 v[164:167], v2, s[40:43], s13 offen offset:1024 sc1
  buffer_load_dwordx4 v[168:171], v2, s[40:43], s13 offen offset:2048 sc1
  buffer_load_dwordx4 v[172:175], v2, s[40:43], s13 offen offset:3072 sc1
  s_add_u32 s13, s13, 4096
  buffer_load_dwordx4 v[192:195], v2, s[40:43], s13 offen offset:0 sc1
  buffer_load_dwordx4 v[196:199], v2, s[40:43], s13 offen offset:1024 sc1
  buffer_load_dwordx4 v[208:211], v2, s[40:43], s13 offen offset:2048 sc1
  buffer_load_dwordx4 v[212:215], v2, s[40:43], s13 offen offset:3072 sc1
  s_add_u32 s13, s13, 4096
  buffer_load_dwordx4 v[232:235], v2, s[40:43], s13 offen offset:0 sc1
  buffer_load_dwordx4 v[236:239], v2, s[40:43], s13 offen offset:1024 sc1
  buffer_load_dwordx4 v[240:243], v2, s[40:43], s13 offen offset:2048 sc1
  buffer_load_dwordx4 v[244:247], v2, s[40:43], s13 offen offset:3072 sc1
  s_add_u32 s13, s13, 4096
  s_mov_b32 s44, s4
  s_mov_b32 s45, s5
  s_mov_b32 s46, 2621440
  s_mov_b32 s47, 0x20000
  s_mov_b32 s48, s6
  s_mov_b32 s49, s7
  s_mov_b32 s50, 2621440
  s_mov_b32 s51, 0x20000
  v_cmp_eq_u32 vcc, 0, v15
  s_cbranch_vccnz fa_sel4_spin
fa_sel4_ok:
  v_readlane_b32 s68, v15, 0
  v_readlane_b32 s69, v15, 1
  v_readlane_b32 s70, v15, 2
  v_readlane_b32 s71, v15, 3
  v_readlane_b32 s72, v15, 4
  v_readlane_b32 s73, v15, 5
  v_readlane_b32 s74, v15, 6
  v_readlane_b32 s75, v15, 7
  s_lshl_b32 s23, s20, 1
  s_add_u32 s31, s23, 8
  v_readlane_b32 s29, v15, s23
  v_readlane_b32 s30, v15, s31
  v_cmp_eq_u32 s[52:53], s68, v24
  v_cmp_eq_u32 s[54:55], s68, v25
  v_cmp_eq_u32 s[56:57], s68, v26
  v_cndmask_b32 v27, v27, 0, s[52:53]
  v_cndmask_b32 v28, v28, 0, s[54:55]
  v_cndmask_b32 v29, v29, 0, s[56:57]
  v_cmp_eq_u32 s[52:53], s69, v24
  v_cmp_eq_u32 s[54:55], s69, v25
  v_cmp_eq_u32 s[56:57], s69, v26
  v_cndmask_b32 v27, v27, 1, s[52:53]
  v_cndmask_b32 v28, v28, 1, s[54:55]
  v_cndmask_b32 v29, v29, 1, s[56:57]
  v_cmp_eq_u32 s[52:53], s70, v24
  v_cmp_eq_u32 s[54:55], s70, v25
  v_cmp_eq_u32 s[56:57], s70, v26
  v_cndmask_b32 v27, v27, 2, s[52:53]
  v_cndmask_b32 v28, v28, 2, s[54:55]
  v_cndmask_b32 v29, v29, 2, s[56:57]
  v_cmp_eq_u32 s[52:53], s71, v24
  v_cmp_eq_u32 s[54:55], s71, v25
  v_cmp_eq_u32 s[56:57], s71, v26
  v_cndmask_b32 v27, v27, 3, s[52:53]
  v_cndmask_b32 v28, v28, 3, s[54:55]
  v_cndmask_b32 v29, v29, 3, s[56:57]
  v_cmp_eq_u32 s[52:53], s72, v24
  v_cmp_eq_u32 s[54:55], s72, v25
  v_cmp_eq_u32 s[56:57], s72, v26
  v_cndmask_b32 v27, v27, 4, s[52:53]
  v_cndmask_b32 v28, v28, 4, s[54:55]
  v_cndmask_b32 v29, v29, 4, s[56:57]
  v_cmp_eq_u32 s[52:53], s73, v24
  v_cmp_eq_u32 s[54:55], s73, v25
  v_cmp_eq_u32 s[56:57], s73, v26
  v_cndmask_b32 v27, v27, 5, s[52:53]
  v_cndmask_b32 v28, v28, 5, s[54:55]
  v_cndmask_b32 v29, v29, 5, s[56:57]
  v_cmp_eq_u32 s[52:53], s74, v24
  v_cmp_eq_u32 s[54:55], s74, v25
  v_cmp_eq_u32 s[56:57], s74, v26
  v_cndmask_b32 v27, v27, 6, s[52:53]
  v_cndmask_b32 v28, v28, 6, s[54:55]
  v_cndmask_b32 v29, v29, 6, s[56:57]
  v_cmp_eq_u32 s[52:53], s75, v24
  v_cmp_eq_u32 s[54:55], s75, v25
  v_cmp_eq_u32 s[56:57], s75, v26
  v_cndmask_b32 v27, v27, 7, s[52:53]
  v_cndmask_b32 v28, v28, 7, s[54:55]
  v_cndmask_b32 v29, v29, 7, s[56:57]
  v_mul_u32_u24 v27, 320, v27
  v_add_u32 v203, v203, v27
  v_mul_u32_u24 v28, 320, v28
  v_add_u32 v204, v204, v28
  v_mul_u32_u24 v29, 320, v29
  v_add_u32 v205, v205, v29
  v_add_u32 v203, 131072, v203
  v_add_u32 v204, 131072, v204
  v_add_u32 v205, 131072, v205
  s_sub_u32 s29, s29, s25
  s_sub_u32 s29, s29, 1
  s_cmp_lt_u32 s29, 64
  s_cbranch_scc1 fa_ystub0
fa_yback0:
  s_add_u32 s23, s23, 1
  s_add_u32 s31, s23, 8
  v_readlane_b32 s29, v15, s23
  v_readlane_b32 s30, v15, s31
  s_sub_u32 s29, s29, s25
  s_sub_u32 s29, s29, 1
  s_cmp_lt_u32 s29, 64
  s_cbranch_scc1 fa_ystub1
fa_yback1:
  buffer_load_dwordx4 v[64:67], v2, s[40:43], s13 offen offset:0 sc1
  buffer_load_dwordx4 v[68:71], v2, s[40:43], s13 offen offset:1024 sc1
  buffer_load_dwordx4 v[72:75], v2, s[40:43], s13 offen offset:2048 sc1
  buffer_load_dwordx4 v[76:79], v2, s[40:43], s13 offen offset:3072 sc1
  s_add_u32 s13, s13, 4096
  buffer_load_dwordx4 v[80:83], v2, s[40:43], s13 offen offset:0 sc1
  buffer_load_dwordx4 v[84:87], v2, s[40:43], s13 offen offset:1024 sc1
  buffer_load_dwordx4 v[88:91], v2, s[40:43], s13 offen offset:2048 sc1
  buffer_load_dwordx4 v[92:95], v2, s[40:43], s13 offen offset:3072 sc1
  s_add_u32 s13, s13, 4096
  buffer_load_dword v13, v12, s[40:43], 0 offen sc1
  buffer_load_dwordx4 v[128:131], v2, s[40:43], s13 offen offset:0 sc1
  buffer_load_dwordx4 v[132:135], v2, s[40:43], s13 offen offset:1024 sc1
  buffer_load_dwordx4 v[136:139], v2, s[40:43], s13 offen offset:2048 sc1
  buffer_load_dwordx4 v[140:143], v2, s[40:43], s13 offen offset:3072 sc1
  s_add_u32 s13, s13, 4096
  buffer_load_dwordx4 v[144:147], v2, s[40:43], s13 offen offset:0 sc1
  buffer_load_dwordx4 v[148:151], v2, s[40:43], s13 offen offset:1024 sc1
  buffer_load_dwordx4 v[152:155], v2, s[40:43], s13 offen offset:2048 sc1
  buffer_load_dwordx4 v[156:159], v2, s[40:43], s13 offen offset:3072 sc1
  s_add_u32 s13, s13, 4096
  buffer_load_dwordx4 v[176:179], v2, s[40:43], s13 offen offset:0 sc1
  buffer_load_dwordx4 v[180:183], v2, s[40:43], s13 offen offset:1024 sc1
  buffer_load_dwordx4 v[184:187], v2, s[40:43], s13 offen offset:2048 sc1
  buffer_load_dwordx4 v[188:191], v2, s[40:43], s13 offen offset:3072 sc1
  s_add_u32 s13, s13, 4096
  s_waitcnt vmcnt(12)
  v_cmp_eq_u32 vcc, 0, v13
  s_cbranch_vccnz fa_ctx_spin
fa_ctx_ok:
  buffer_load_dwordx4 a[144:147], v2, s[40:43], s64 offen offset:0 sc1
  buffer_load_dwordx4 a[148:151], v2, s[40:43], s65 offen offset:0 sc1
  buffer_load_dwordx4 a[152:155], v2, s[40:43], s66 offen offset:0 sc1
  buffer_load_dwordx4 a[156:159], v2, s[40:43], s67 offen offset:0 sc1
  buffer_load_dwordx4 a[160:163], v2, s[40:43], s64 offen offset:1024 sc1
  buffer_load_dwordx4 a[164:167], v2, s[40:43], s65 offen offset:1024 sc1
  buffer_load_dwordx4 a[168:171], v2, s[40:43], s66 offen offset:1024 sc1
  buffer_load_dwordx4 a[172:175], v2, s[40:43], s67 offen offset:1024 sc1
  buffer_load_dwordx4 a[176:179], v2, s[40:43], s64 offen offset:2048 sc1
  buffer_load_dwordx4 a[180:183], v2, s[40:43], s65 offen offset:2048 sc1
  buffer_load_dwordx4 a[184:187], v2, s[40:43], s66 offen offset:2048 sc1
  buffer_load_dwordx4 a[188:191], v2, s[40:43], s67 offen offset:2048 sc1
  buffer_load_dwordx4 v[216:219], v2, s[40:43], s64 offen offset:3072 sc1
  buffer_load_dwordx4 v[220:223], v2, s[40:43], s65 offen offset:3072 sc1
  buffer_load_dwordx4 v[224:227], v2, s[40:43], s66 offen offset:3072 sc1
  buffer_load_dwordx4 v[228:231], v2, s[40:43], s67 offen offset:3072 sc1
  s_add_u32 s64, s64, 4096
  s_add_u32 s65, s65, 4096
  s_add_u32 s66, s66, 4096
  s_add_u32 s67, s67, 4096
  s_waitcnt vmcnt(12)
  v_mfma_f32_16x16x32_bf16 a[64:67], a[0:3], a[144:147], 0
  v_mfma_f32_16x16x32_bf16 a[68:71], a[0:3], a[148:151], 0
  v_mfma_f32_16x16x32_bf16 a[72:75], a[0:3], a[152:155], 0
  v_mfma_f32_16x16x32_bf16 a[76:79], a[0:3], a[156:159], 0
  buffer_load_dwordx4 a[0:3], v2, s[40:43], s13 offen offset:0 sc1
  v_mfma_f32_16x16x32_bf16 a[80:83], a[4:7], a[144:147], 0
  v_mfma_f32_16x16x32_bf16 a[84:87], a[4:7], a[148:151], 0
  v_mfma_f32_16x16x32_bf16 a[88:91], a[4:7], a[152:155], 0
  v_mfma_f32_16x16x32_bf16 a[92:95], a[4:7], a[156:159], 0
  buffer_load_dwordx4 a[4:7], v2, s[40:43], s13 offen offset:1024 sc1
  v_mfma_f32_16x16x32_bf16 a[96:99], a[8:11], a[144:147], 0
  v_mfma_f32_16x16x32_bf16 a[100:103], a[8:11], a[148:151], 0
  v_mfma_f32_16x16x32_bf16 a[104:107], a[8:11], a[152:155], 0
  v_mfma_f32_16x16x32_bf16 a[108:111], a[8:11], a[156:159], 0
  buffer_load_dwordx4 a[8:11], v2, s[40:43], s13 offen offset:2048 sc1
  v_mfma_f32_16x16x32_bf16 a[112:115], a[12:15], a[144:147], 0
  v_mfma_f32_16x16x32_bf16 a[116:119], a[12:15], a[148:151], 0
  v_mfma_f32_16x16x32_bf16 a[120:123], a[12:15], a[152:155], 0
  v_mfma_f32_16x16x32_bf16 a[124:127], a[12:15], a[156:159], 0
  v_mfma_f32_16x16x32_bf16 a[128:131], a[16:19], a[144:147], 0
  buffer_load_dwordx4 a[144:147], v2, s[40:43], s64 offen offset:0 sc1
  v_mfma_f32_16x16x32_bf16 a[132:135], a[16:19], a[148:151], 0
  buffer_load_dwordx4 a[148:151], v2, s[40:43], s65 offen offset:0 sc1
  v_mfma_f32_16x16x32_bf16 a[136:139], a[16:19], a[152:155], 0
  buffer_load_dwordx4 a[152:155], v2, s[40:43], s66 offen offset:0 sc1
  v_mfma_f32_16x16x32_bf16 a[140:143], a[16:19], a[156:159], 0
  buffer_load_dwordx4 a[156:159], v2, s[40:43], s67 offen offset:0 sc1
  s_waitcnt vmcnt(15)
  v_mfma_f32_16x16x32_bf16 a[64:67], a[20:23], a[160:163], a[64:67]
  v_mfma_f32_16x16x32_bf16 a[68:71], a[20:23], a[164:167], a[68:71]
  v_mfma_f32_16x16x32_bf16 a[72:75], a[20:23], a[168:171], a[72:75]
  v_mfma_f32_16x16x32_bf16 a[76:79], a[20:23], a[172:175], a[76:79]
  buffer_load_dwordx4 a[12:15], v2, s[40:43], s13 offen offset:3072 sc1
  v_mfma_f32_16x16x32_bf16 a[80:83], a[24:27], a[160:163], a[80:83]
  s_add_u32 s13, s13, 4096
  v_mfma_f32_16x16x32_bf16 a[84:87], a[24:27], a[164:167], a[84:87]
  v_mfma_f32_16x16x32_bf16 a[88:91], a[24:27], a[168:171], a[88:91]
  v_mfma_f32_16x16x32_bf16 a[92:95], a[24:27], a[172:175], a[92:95]
  buffer_load_dwordx4 a[16:19], v2, s[40:43], s13 offen offset:0 sc1
  v_mfma_f32_16x16x32_bf16 a[96:99], a[28:31], a[160:163], a[96:99]
  v_mfma_f32_16x16x32_bf16 a[100:103], a[28:31], a[164:167], a[100:103]
  v_mfma_f32_16x16x32_bf16 a[104:107], a[28:31], a[168:171], a[104:107]
  v_mfma_f32_16x16x32_bf16 a[108:111], a[28:31], a[172:175], a[108:111]
  buffer_load_dwordx4 a[20:23], v2, s[40:43], s13 offen offset:1024 sc1
  v_mfma_f32_16x16x32_bf16 a[112:115], a[32:35], a[160:163], a[112:115]
  v_mfma_f32_16x16x32_bf16 a[116:119], a[32:35], a[164:167], a[116:119]
  v_mfma_f32_16x16x32_bf16 a[120:123], a[32:35], a[168:171], a[120:123]
  v_mfma_f32_16x16x32_bf16 a[124:127], a[32:35], a[172:175], a[124:127]
  v_mfma_f32_16x16x32_bf16 a[128:131], a[36:39], a[160:163], a[128:131]
  buffer_load_dwordx4 a[160:163], v2, s[40:43], s64 offen offset:1024 sc1
  v_mfma_f32_16x16x32_bf16 a[132:135], a[36:39], a[164:167], a[132:135]
  buffer_load_dwordx4 a[164:167], v2, s[40:43], s65 offen offset:1024 sc1
  v_mfma_f32_16x16x32_bf16 a[136:139], a[36:39], a[168:171], a[136:139]
  buffer_load_dwordx4 a[168:171], v2, s[40:43], s66 offen offset:1024 sc1
  v_mfma_f32_16x16x32_bf16 a[140:143], a[36:39], a[172:175], a[140:143]
  buffer_load_dwordx4 a[172:175], v2, s[40:43], s67 offen offset:1024 sc1
  s_waitcnt vmcnt(18)
  v_mfma_f32_16x16x32_bf16 a[64:67], a[40:43], a[176:179], a[64:67]
  v_mfma_f32_16x16x32_bf16 a[68:71], a[40:43], a[180:183], a[68:71]
  v_mfma_f32_16x16x32_bf16 a[72:75], a[40:43], a[184:187], a[72:75]
  v_mfma_f32_16x16x32_bf16 a[76:79], a[40:43], a[188:191], a[76:79]
  buffer_load_dwordx4 a[24:27], v2, s[40:43], s13 offen offset:2048 sc1
  v_mfma_f32_16x16x32_bf16 a[80:83], a[44:47], a[176:179], a[80:83]
  v_mfma_f32_16x16x32_bf16 a[84:87], a[44:47], a[180:183], a[84:87]
  v_mfma_f32_16x16x32_bf16 a[88:91], a[44:47], a[184:187], a[88:91]
  v_mfma_f32_16x16x32_bf16 a[92:95], a[44:47], a[188:191], a[92:95]
  buffer_load_dwordx4 a[28:31], v2, s[40:43], s13 offen offset:3072 sc1
  v_mfma_f32_16x16x32_bf16 a[96:99], a[48:51], a[176:179], a[96:99]
  s_add_u32 s13, s13, 4096
  v_mfma_f32_16x16x32_bf16 a[100:103], a[48:51], a[180:183], a[100:103]
  v_mfma_f32_16x16x32_bf16 a[104:107], a[48:51], a[184:187], a[104:107]
  v_mfma_f32_16x16x32_bf16 a[108:111], a[48:51], a[188:191], a[108:111]
  buffer_load_dwordx4 a[32:35], v2, s[40:43], s13 offen offset:0 sc1
  v_mfma_f32_16x16x32_bf16 a[112:115], a[52:55], a[176:179], a[112:115]
  v_mfma_f32_16x16x32_bf16 a[116:119], a[52:55], a[180:183], a[116:119]
  v_mfma_f32_16x16x32_bf16 a[120:123], a[52:55], a[184:187], a[120:123]
  v_mfma_f32_16x16x32_bf16 a[124:127], a[52:55], a[188:191], a[124:127]
  v_mfma_f32_16x16x32_bf16 a[128:131], a[56:59], a[176:179], a[128:131]
  buffer_load_dwordx4 a[176:179], v2, s[40:43], s64 offen offset:2048 sc1
  v_mfma_f32_16x16x32_bf16 a[132:135], a[56:59], a[180:183], a[132:135]
  buffer_load_dwordx4 a[180:183], v2, s[40:43], s65 offen offset:2048 sc1
  v_mfma_f32_16x16x32_bf16 a[136:139], a[56:59], a[184:187], a[136:139]
  buffer_load_dwordx4 a[184:187], v2, s[40:43], s66 offen offset:2048 sc1
  v_mfma_f32_16x16x32_bf16 a[140:143], a[56:59], a[188:191], a[140:143]
  buffer_load_dwordx4 a[188:191], v2, s[40:43], s67 offen offset:2048 sc1
  s_waitcnt vmcnt(21)
  v_mfma_f32_16x16x32_bf16 a[64:67], a[60:63], v[216:219], a[64:67]
  v_mfma_f32_16x16x32_bf16 a[68:71], a[60:63], v[220:223], a[68:71]
  v_mfma_f32_16x16x32_bf16 a[72:75], a[60:63], v[224:227], a[72:75]
  v_mfma_f32_16x16x32_bf16 a[76:79], a[60:63], v[228:231], a[76:79]
  buffer_load_dwordx4 a[36:39], v2, s[40:43], s13 offen offset:1024 sc1
  v_mfma_f32_16x16x32_bf16 a[80:83], a[192:195], v[216:219], a[80:83]
  v_mfma_f32_16x16x32_bf16 a[84:87], a[192:195], v[220:223], a[84:87]
  v_mfma_f32_16x16x32_bf16 a[88:91], a[192:195], v[224:227], a[88:91]
  v_mfma_f32_16x16x32_bf16 a[92:95], a[192:195], v[228:231], a[92:95]
  buffer_load_dwordx4 a[40:43], v2, s[40:43], s13 offen offset:2048 sc1
  v_mfma_f32_16x16x32_bf16 a[96:99], a[196:199], v[216:219], a[96:99]
  v_mfma_f32_16x16x32_bf16 a[100:103], a[196:199], v[220:223], a[100:103]
  v_mfma_f32_16x16x32_bf16 a[104:107], a[196:199], v[224:227], a[104:107]
  v_mfma_f32_16x16x32_bf16 a[108:111], a[196:199], v[228:231], a[108:111]
  buffer_load_dwordx4 a[44:47], v2, s[40:43], s13 offen offset:3072 sc1
  v_mfma_f32_16x16x32_bf16 a[112:115], a[200:203], v[216:219], a[112:115]
  s_add_u32 s13, s13, 4096
  v_mfma_f32_16x16x32_bf16 a[116:119], a[200:203], v[220:223], a[116:119]
  v_mfma_f32_16x16x32_bf16 a[120:123], a[200:203], v[224:227], a[120:123]
  v_mfma_f32_16x16x32_bf16 a[124:127], a[200:203], v[228:231], a[124:127]
  v_mfma_f32_16x16x32_bf16 a[128:131], a[204:207], v[216:219], a[128:131]
  buffer_load_dwordx4 v[216:219], v2, s[40:43], s64 offen offset:3072 sc1
  v_mfma_f32_16x16x32_bf16 a[132:135], a[204:207], v[220:223], a[132:135]
  buffer_load_dwordx4 v[220:223], v2, s[40:43], s65 offen offset:3072 sc1
  v_mfma_f32_16x16x32_bf16 a[136:139], a[204:207], v[224:227], a[136:139]
  buffer_load_dwordx4 v[224:227], v2, s[40:43], s66 offen offset:3072 sc1
  v_mfma_f32_16x16x32_bf16 a[140:143], a[204:207], v[228:231], a[140:143]
  buffer_load_dwordx4 v[228:231], v2, s[40:43], s67 offen offset:3072 sc1
  s_waitcnt vmcnt(21)
  v_mfma_f32_16x16x32_bf16 a[64:67], a[208:211], a[144:147], a[64:67]
  s_add_u32 s64, s64, 4096
  v_mfma_f32_16x16x32_bf16 a[68:71], a[208:211], a[148:151], a[68:71]
  s_add_u32 s65, s65, 4096
  v_mfma_f32_16x16x32_bf16 a[72:75], a[208:211], a[152:155], a[72:75]
  s_add_u32 s66, s66, 4096
  v_mfma_f32_16x16x32_bf16 a[76:79], a[208:211], a[156:159], a[76:79]
  buffer_load_dwordx4 a[48:51], v2, s[40:43], s13 offen offset:0 sc1
  v_mfma_f32_16x16x32_bf16 a[80:83], a[212:215], a[144:147], a[80:83]
  v_mfma_f32_16x16x32_bf16 a[84:87], a[212:215], a[148:151], a[84:87]
  v_mfma_f32_16x16x32_bf16 a[88:91], a[212:215], a[152:155], a[88:91]
  s_add_u32 s67, s67, 4096
  v_mfma_f32_16x16x32_bf16 a[92:95], a[212:215], a[156:159], a[92:95]
  buffer_load_dwordx4 a[52:55], v2, s[40:43], s13 offen offset:1024 sc1
  v_mfma_f32_16x16x32_bf16 a[96:99], a[216:219], a[144:147], a[96:99]
  v_mfma_f32_16x16x32_bf16 a[100:103], a[216:219], a[148:151], a[100:103]
  v_mfma_f32_16x16x32_bf16 a[104:107], a[216:219], a[152:155], a[104:107]
  v_mfma_f32_16x16x32_bf16 a[108:111], a[216:219], a[156:159], a[108:111]
  buffer_load_dwordx4 a[56:59], v2, s[40:43], s13 offen offset:2048 sc1
  v_mfma_f32_16x16x32_bf16 a[112:115], a[220:223], a[144:147], a[112:115]
  v_mfma_f32_16x16x32_bf16 a[116:119], a[220:223], a[148:151], a[116:119]
  v_mfma_f32_16x16x32_bf16 a[120:123], a[220:223], a[152:155], a[120:123]
  v_mfma_f32_16x16x32_bf16 a[124:127], a[220:223], a[156:159], a[124:127]
  v_mfma_f32_16x16x32_bf16 a[128:131], a[224:227], a[144:147], a[128:131]
  buffer_load_dwordx4 a[144:147], v2, s[40:43], s64 offen offset:0 sc1
  v_mfma_f32_16x16x32_bf16 a[132:135], a[224:227], a[148:151], a[132:135]
  buffer_load_dwordx4 a[148:151], v2, s[40:43], s65 offen offset:0 sc1
  v_mfma_f32_16x16x32_bf16 a[136:139], a[224:227], a[152:155], a[136:139]
  buffer_load_dwordx4 a[152:155], v2, s[40:43], s66 offen offset:0 sc1
  v_mfma_f32_16x16x32_bf16 a[140:143], a[224:227], a[156:159], a[140:143]
  buffer_load_dwordx4 a[156:159], v2, s[40:43], s67 offen offset:0 sc1
  s_waitcnt vmcnt(21)
  v_mfma_f32_16x16x32_bf16 a[64:67], a[228:231], a[160:163], a[64:67]
  v_mfma_f32_16x16x32_bf16 a[68:71], a[228:231], a[164:167], a[68:71]
  v_mfma_f32_16x16x32_bf16 a[72:75], a[228:231], a[168:171], a[72:75]
  v_mfma_f32_16x16x32_bf16 a[76:79], a[228:231], a[172:175], a[76:79]
  buffer_load_dwordx4 a[60:63], v2, s[40:43], s13 offen offset:3072 sc1
  v_mfma_f32_16x16x32_bf16 a[80:83], a[232:235], a[160:163], a[80:83]
  s_add_u32 s13, s13, 4096
  v_mfma_f32_16x16x32_bf16 a[84:87], a[232:235], a[164:167], a[84:87]
  v_mfma_f32_16x16x32_bf16 a[88:91], a[232:235], a[168:171], a[88:91]
  v_mfma_f32_16x16x32_bf16 a[92:95], a[232:235], a[172:175], a[92:95]
  buffer_load_dwordx4 a[192:195], v2, s[40:43], s13 offen offset:0 sc1
  v_mfma_f32_16x16x32_bf16 a[96:99], a[236:239], a[160:163], a[96:99]
  v_mfma_f32_16x16x32_bf16 a[100:103], a[236:239], a[164:167], a[100:103]
  v_mfma_f32_16x16x32_bf16 a[104:107], a[236:239], a[168:171], a[104:107]
  v_mfma_f32_16x16x32_bf16 a[108:111], a[236:239], a[172:175], a[108:111]
  buffer_load_dwordx4 a[196:199], v2, s[40:43], s13 offen offset:1024 sc1
  v_mfma_f32_16x16x32_bf16 a[112:115], a[240:243], a[160:163], a[112:115]
  v_mfma_f32_16x16x32_bf16 a[116:119], a[240:243], a[164:167], a[116:119]
  v_mfma_f32_16x16x32_bf16 a[120:123], a[240:243], a[168:171], a[120:123]
  v_mfma_f32_16x16x32_bf16 a[124:127], a[240:243], a[172:175], a[124:127]
  v_mfma_f32_16x16x32_bf16 a[128:131], a[244:247], a[160:163], a[128:131]
  buffer_load_dwordx4 a[160:163], v2, s[40:43], s64 offen offset:1024 sc1
  v_mfma_f32_16x16x32_bf16 a[132:135], a[244:247], a[164:167], a[132:135]
  buffer_load_dwordx4 a[164:167], v2, s[40:43], s65 offen offset:1024 sc1
  v_mfma_f32_16x16x32_bf16 a[136:139], a[244:247], a[168:171], a[136:139]
  buffer_load_dwordx4 a[168:171], v2, s[40:43], s66 offen offset:1024 sc1
  v_mfma_f32_16x16x32_bf16 a[140:143], a[244:247], a[172:175], a[140:143]
  buffer_load_dwordx4 a[172:175], v2, s[40:43], s67 offen offset:1024 sc1
  s_waitcnt vmcnt(21)
  v_mfma_f32_16x16x32_bf16 a[64:67], a[248:251], a[176:179], a[64:67]
  v_mfma_f32_16x16x32_bf16 a[68:71], a[248:251], a[180:183], a[68:71]
  v_mfma_f32_16x16x32_bf16 a[72:75], a[248:251], a[184:187], a[72:75]
  v_mfma_f32_16x16x32_bf16 a[76:79], a[248:251], a[188:191], a[76:79]
  buffer_load_dwordx4 a[200:203], v2, s[40:43], s13 offen offset:2048 sc1
  v_mfma_f32_16x16x32_bf16 a[80:83], a[252:255], a[176:179], a[80:83]
  v_mfma_f32_16x16x32_bf16 a[84:87], a[252:255], a[180:183], a[84:87]
  v_mfma_f32_16x16x32_bf16 a[88:91], a[252:255], a[184:187], a[88:91]
  v_mfma_f32_16x16x32_bf16 a[92:95], a[252:255], a[188:191], a[92:95]
  buffer_load_dwordx4 a[204:207], v2, s[40:43], s13 offen offset:3072 sc1
  v_mfma_f32_16x16x32_bf16 a[96:99], v[32:35], a[176:179], a[96:99]
  s_add_u32 s13, s13, 4096
  v_mfma_f32_16x16x32_bf16 a[100:103], v[32:35], a[180:183], a[100:103]
  v_mfma_f32_16x16x32_bf16 a[104:107], v[32:35], a[184:187], a[104:107]
  v_mfma_f32_16x16x32_bf16 a[108:111], v[32:35], a[188:191], a[108:111]
  buffer_load_dwordx4 a[208:211], v2, s[40:43], s13 offen offset:0 sc1
  v_mfma_f32_16x16x32_bf16 a[112:115], v[36:39], a[176:179], a[112:115]
  v_mfma_f32_16x16x32_bf16 a[116:119], v[36:39], a[180:183], a[116:119]
  v_mfma_f32_16x16x32_bf16 a[120:123], v[36:39], a[184:187], a[120:123]
  v_mfma_f32_16x16x32_bf16 a[124:127], v[36:39], a[188:191], a[124:127]
  v_mfma_f32_16x16x32_bf16 a[128:131], v[40:43], a[176:179], a[128:131]
  buffer_load_dwordx4 a[176:179], v2, s[40:43], s64 offen offset:2048 sc1
  v_mfma_f32_16x16x32_bf16 a[132:135], v[40:43], a[180:183], a[132:135]
  buffer_load_dwordx4 a[180:183], v2, s[40:43], s65 offen offset:2048 sc1
  v_mfma_f32_16x16x32_bf16 a[136:139], v[40:43], a[184:187], a[136:139]
  buffer_load_dwordx4 a[184:187], v2, s[40:43], s66 offen offset:2048 sc1
  v_mfma_f32_16x16x32_bf16 a[140:143], v[40:43], a[188:191], a[140:143]
  buffer_load_dwordx4 a[188:191], v2, s[40:43], s67 offen offset:2048 sc1
  s_waitcnt vmcnt(21)
  v_mfma_f32_16x16x32_bf16 a[64:67], v[44:47], v[216:219], a[64:67]
  v_mfma_f32_16x16x32_bf16 a[68:71], v[44:47], v[220:223], a[68:71]
  v_mfma_f32_16x16x32_bf16 a[72:75], v[44:47], v[224:227], a[72:75]
  v_mfma_f32_16x16x32_bf16 a[76:79], v[44:47], v[228:231], a[76:79]
  buffer_load_dwordx4 a[212:215], v2, s[40:43], s13 offen offset:1024 sc1
  v_mfma_f32_16x16x32_bf16 a[80:83], v[48:51], v[216:219], a[80:83]
  v_mfma_f32_16x16x32_bf16 a[84:87], v[48:51], v[220:223], a[84:87]
  v_mfma_f32_16x16x32_bf16 a[88:91], v[48:51], v[224:227], a[88:91]
  v_mfma_f32_16x16x32_bf16 a[92:95], v[48:51], v[228:231], a[92:95]
  buffer_load_dwordx4 a[216:219], v2, s[40:43], s13 offen offset:2048 sc1
  v_mfma_f32_16x16x32_bf16 a[96:99], v[52:55], v[216:219], a[96:99]
  v_mfma_f32_16x16x32_bf16 a[100:103], v[52:55], v[220:223], a[100:103]
  v_mfma_f32_16x16x32_bf16 a[104:107], v[52:55], v[224:227], a[104:107]
  v_mfma_f32_16x16x32_bf16 a[108:111], v[52:55], v[228:231], a[108:111]
  buffer_load_dwordx4 a[220:223], v2, s[40:43], s13 offen offset:3072 sc1
  v_mfma_f32_16x16x32_bf16 a[112:115], v[56:59], v[216:219], a[112:115]
  s_add_u32 s13, s13, 4096
  v_mfma_f32_16x16x32_bf16 a[116:119], v[56:59], v[220:223], a[116:119]
  v_mfma_f32_16x16x32_bf16 a[120:123], v[56:59], v[224:227], a[120:123]
  v_mfma_f32_16x16x32_bf16 a[124:127], v[56:59], v[228:231], a[124:127]
  v_mfma_f32_16x16x32_bf16 a[128:131], v[60:63], v[216:219], a[128:131]
  buffer_load_dwordx4 v[216:219], v2, s[40:43], s64 offen offset:3072 sc1
  v_mfma_f32_16x16x32_bf16 a[132:135], v[60:63], v[220:223], a[132:135]
  buffer_load_dwordx4 v[220:223], v2, s[40:43], s65 offen offset:3072 sc1
  v_mfma_f32_16x16x32_bf16 a[136:139], v[60:63], v[224:227], a[136:139]
  buffer_load_dwordx4 v[224:227], v2, s[40:43], s66 offen offset:3072 sc1
  v_mfma_f32_16x16x32_bf16 a[140:143], v[60:63], v[228:231], a[140:143]
  buffer_load_dwordx4 v[228:231], v2, s[40:43], s67 offen offset:3072 sc1
  s_waitcnt vmcnt(21)
  v_mfma_f32_16x16x32_bf16 a[64:67], v[96:99], a[144:147], a[64:67]
  s_add_u32 s64, s64, 4096
  v_mfma_f32_16x16x32_bf16 a[68:71], v[96:99], a[148:151], a[68:71]
  s_add_u32 s65, s65, 4096
  v_mfma_f32_16x16x32_bf16 a[72:75], v[96:99], a[152:155], a[72:75]
  s_add_u32 s66, s66, 4096
  v_mfma_f32_16x16x32_bf16 a[76:79], v[96:99], a[156:159], a[76:79]
  buffer_load_dwordx4 a[224:227], v2, s[40:43], s13 offen offset:0 sc1
  v_mfma_f32_16x16x32_bf16 a[80:83], v[100:103], a[144:147], a[80:83]
  v_mfma_f32_16x16x32_bf16 a[84:87], v[100:103], a[148:151], a[84:87]
  v_mfma_f32_16x16x32_bf16 a[88:91], v[100:103], a[152:155], a[88:91]
  s_add_u32 s67, s67, 4096
  v_mfma_f32_16x16x32_bf16 a[92:95], v[100:103], a[156:159], a[92:95]
  buffer_load_dwordx4 a[228:231], v2, s[40:43], s13 offen offset:1024 sc1
  v_mfma_f32_16x16x32_bf16 a[96:99], v[104:107], a[144:147], a[96:99]
  v_mfma_f32_16x16x32_bf16 a[100:103], v[104:107], a[148:151], a[100:103]
  v_mfma_f32_16x16x32_bf16 a[104:107], v[104:107], a[152:155], a[104:107]
  v_mfma_f32_16x16x32_bf16 a[108:111], v[104:107], a[156:159], a[108:111]
  buffer_load_dwordx4 a[232:235], v2, s[40:43], s13 offen offset:2048 sc1
  v_mfma_f32_16x16x32_bf16 a[112:115], v[108:111], a[144:147], a[112:115]
  v_mfma_f32_16x16x32_bf16 a[116:119], v[108:111], a[148:151], a[116:119]
  v_mfma_f32_16x16x32_bf16 a[120:123], v[108:111], a[152:155], a[120:123]
  v_mfma_f32_16x16x32_bf16 a[124:127], v[108:111], a[156:159], a[124:127]
  v_mfma_f32_16x16x32_bf16 a[128:131], v[112:115], a[144:147], a[128:131]
  buffer_load_dwordx4 a[144:147], v2, s[40:43], s64 offen offset:0 sc1
  v_mfma_f32_16x16x32_bf16 a[132:135], v[112:115], a[148:151], a[132:135]
  buffer_load_dwordx4 a[148:151], v2, s[40:43], s65 offen offset:0 sc1
  v_mfma_f32_16x16x32_bf16 a[136:139], v[112:115], a[152:155], a[136:139]
  buffer_load_dwordx4 a[152:155], v2, s[40:43], s66 offen offset:0 sc1
  v_mfma_f32_16x16x32_bf16 a[140:143], v[112:115], a[156:159], a[140:143]
  buffer_load_dwordx4 a[156:159], v2, s[40:43], s67 offen offset:0 sc1
  s_waitcnt vmcnt(21)
  v_mfma_f32_16x16x32_bf16 a[64:67], v[116:119], a[160:163], a[64:67]
  v_mfma_f32_16x16x32_bf16 a[68:71], v[116:119], a[164:167], a[68:71]
  v_mfma_f32_16x16x32_bf16 a[72:75], v[116:119], a[168:171], a[72:75]
  v_mfma_f32_16x16x32_bf16 a[76:79], v[116:119], a[172:175], a[76:79]
  buffer_load_dwordx4 a[236:239], v2, s[40:43], s13 offen offset:3072 sc1
  v_mfma_f32_16x16x32_bf16 a[80:83], v[120:123], a[160:163], a[80:83]
  s_add_u32 s13, s13, 4096
  v_mfma_f32_16x16x32_bf16 a[84:87], v[120:123], a[164:167], a[84:87]
  v_mfma_f32_16x16x32_bf16 a[88:91], v[120:123], a[168:171], a[88:91]
  v_mfma_f32_16x16x32_bf16 a[92:95], v[120:123], a[172:175], a[92:95]
  buffer_load_dwordx4 a[240:243], v2, s[40:43], s13 offen offset:0 sc1
  v_mfma_f32_16x16x32_bf16 a[96:99], v[124:127], a[160:163], a[96:99]
  v_mfma_f32_16x16x32_bf16 a[100:103], v[124:127], a[164:167], a[100:103]
  v_mfma_f32_16x16x32_bf16 a[104:107], v[124:127], a[168:171], a[104:107]
  v_mfma_f32_16x16x32_bf16 a[108:111], v[124:127], a[172:175], a[108:111]
  buffer_load_dwordx4 a[244:247], v2, s[40:43], s13 offen offset:1024 sc1
  v_mfma_f32_16x16x32_bf16 a[112:115], v[160:163], a[160:163], a[112:115]
  v_mfma_f32_16x16x32_bf16 a[116:119], v[160:163], a[164:167], a[116:119]
  v_mfma_f32_16x16x32_bf16 a[120:123], v[160:163], a[168:171], a[120:123]
  v_mfma_f32_16x16x32_bf16 a[124:127], v[160:163], a[172:175], a[124:127]
  v_mfma_f32_16x16x32_bf16 a[128:131], v[164:167], a[160:163], a[128:131]
  buffer_load_dwordx4 a[160:163], v2, s[40:43], s64 offen offset:1024 sc1
  v_mfma_f32_16x16x32_bf16 a[132:135], v[164:167], a[164:167], a[132:135]
  buffer_load_dwordx4 a[164:167], v2, s[40:43], s65 offen offset:1024 sc1
  v_mfma_f32_16x16x32_bf16 a[136:139], v[164:167], a[168:171], a[136:139]
  buffer_load_dwordx4 a[168:171], v2, s[40:43], s66 offen offset:1024 sc1
  v_mfma_f32_16x16x32_bf16 a[140:143], v[164:167], a[172:175], a[140:143]
  buffer_load_dwordx4 a[172:175], v2, s[40:43], s67 offen offset:1024 sc1
  s_waitcnt vmcnt(21)
  v_mfma_f32_16x16x32_bf16 a[64:67], v[168:171], a[176:179], a[64:67]
  v_mfma_f32_16x16x32_bf16 a[68:71], v[168:171], a[180:183], a[68:71]
  v_mfma_f32_16x16x32_bf16 a[72:75], v[168:171], a[184:187], a[72:75]
  v_mfma_f32_16x16x32_bf16 a[76:79], v[168:171], a[188:191], a[76:79]
  buffer_load_dwordx4 a[248:251], v2, s[40:43], s13 offen offset:2048 sc1
  v_mfma_f32_16x16x32_bf16 a[80:83], v[172:175], a[176:179], a[80:83]
  v_mfma_f32_16x16x32_bf16 a[84:87], v[172:175], a[180:183], a[84:87]
  v_mfma_f32_16x16x32_bf16 a[88:91], v[172:175], a[184:187], a[88:91]
  v_mfma_f32_16x16x32_bf16 a[92:95], v[172:175], a[188:191], a[92:95]
  buffer_load_dwordx4 a[252:255], v2, s[40:43], s13 offen offset:3072 sc1
  v_mfma_f32_16x16x32_bf16 a[96:99], v[192:195], a[176:179], a[96:99]
  s_add_u32 s13, s13, 4096
  v_mfma_f32_16x16x32_bf16 a[100:103], v[192:195], a[180:183], a[100:103]
  v_mfma_f32_16x16x32_bf16 a[104:107], v[192:195], a[184:187], a[104:107]
  v_mfma_f32_16x16x32_bf16 a[108:111], v[192:195], a[188:191], a[108:111]
  buffer_load_dwordx4 v[32:35], v2, s[40:43], s13 offen offset:0 sc1
  v_mfma_f32_16x16x32_bf16 a[112:115], v[196:199], a[176:179], a[112:115]
  v_mfma_f32_16x16x32_bf16 a[116:119], v[196:199], a[180:183], a[116:119]
  v_mfma_f32_16x16x32_bf16 a[120:123], v[196:199], a[184:187], a[120:123]
  v_mfma_f32_16x16x32_bf16 a[124:127], v[196:199], a[188:191], a[124:127]
  v_mfma_f32_16x16x32_bf16 a[128:131], v[208:211], a[176:179], a[128:131]
  buffer_load_dwordx4 a[176:179], v2, s[40:43], s64 offen offset:2048 sc1
  v_mfma_f32_16x16x32_bf16 a[132:135], v[208:211], a[180:183], a[132:135]
  buffer_load_dwordx4 a[180:183], v2, s[40:43], s65 offen offset:2048 sc1
  v_mfma_f32_16x16x32_bf16 a[136:139], v[208:211], a[184:187], a[136:139]
  buffer_load_dwordx4 a[184:187], v2, s[40:43], s66 offen offset:2048 sc1
  v_mfma_f32_16x16x32_bf16 a[140:143], v[208:211], a[188:191], a[140:143]
  buffer_load_dwordx4 a[188:191], v2, s[40:43], s67 offen offset:2048 sc1
  s_waitcnt vmcnt(21)
  v_mfma_f32_16x16x32_bf16 a[64:67], v[212:215], v[216:219], a[64:67]
  v_mfma_f32_16x16x32_bf16 a[68:71], v[212:215], v[220:223], a[68:71]
  v_mfma_f32_16x16x32_bf16 a[72:75], v[212:215], v[224:227], a[72:75]
  v_mfma_f32_16x16x32_bf16 a[76:79], v[212:215], v[228:231], a[76:79]
  buffer_load_dwordx4 v[36:39], v2, s[40:43], s13 offen offset:1024 sc1
  v_mfma_f32_16x16x32_bf16 a[80:83], v[232:235], v[216:219], a[80:83]
  v_mfma_f32_16x16x32_bf16 a[84:87], v[232:235], v[220:223], a[84:87]
  v_mfma_f32_16x16x32_bf16 a[88:91], v[232:235], v[224:227], a[88:91]
  v_mfma_f32_16x16x32_bf16 a[92:95], v[232:235], v[228:231], a[92:95]
  buffer_load_dwordx4 v[40:43], v2, s[40:43], s13 offen offset:2048 sc1
  v_mfma_f32_16x16x32_bf16 a[96:99], v[236:239], v[216:219], a[96:99]
  v_mfma_f32_16x16x32_bf16 a[100:103], v[236:239], v[220:223], a[100:103]
  v_mfma_f32_16x16x32_bf16 a[104:107], v[236:239], v[224:227], a[104:107]
  v_mfma_f32_16x16x32_bf16 a[108:111], v[236:239], v[228:231], a[108:111]
  buffer_load_dwordx4 v[44:47], v2, s[40:43], s13 offen offset:3072 sc1
  v_mfma_f32_16x16x32_bf16 a[112:115], v[240:243], v[216:219], a[112:115]
  s_add_u32 s13, s13, 4096
  v_mfma_f32_16x16x32_bf16 a[116:119], v[240:243], v[220:223], a[116:119]
  v_mfma_f32_16x16x32_bf16 a[120:123], v[240:243], v[224:227], a[120:123]
  v_mfma_f32_16x16x32_bf16 a[124:127], v[240:243], v[228:231], a[124:127]
  v_mfma_f32_16x16x32_bf16 a[128:131], v[244:247], v[216:219], a[128:131]
  buffer_load_dwordx4 v[216:219], v2, s[40:43], s64 offen offset:3072 sc1
  v_mfma_f32_16x16x32_bf16 a[132:135], v[244:247], v[220:223], a[132:135]
  buffer_load_dwordx4 v[220:223], v2, s[40:43], s65 offen offset:3072 sc1
  v_mfma_f32_16x16x32_bf16 a[136:139], v[244:247], v[224:227], a[136:139]
  buffer_load_dwordx4 v[224:227], v2, s[40:43], s66 offen offset:3072 sc1
  v_mfma_f32_16x16x32_bf16 a[140:143], v[244:247], v[228:231], a[140:143]
  buffer_load_dwordx4 v[228:231], v2, s[40:43], s67 offen offset:3072 sc1
  s_waitcnt vmcnt(21)
  v_mfma_f32_16x16x32_bf16 a[64:67], v[64:67], a[144:147], a[64:67]
  s_add_u32 s64, s64, 4096
  v_mfma_f32_16x16x32_bf16 a[68:71], v[64:67], a[148:151], a[68:71]
  s_add_u32 s65, s65, 4096
  v_mfma_f32_16x16x32_bf16 a[72:75], v[64:67], a[152:155], a[72:75]
  s_add_u32 s66, s66, 4096
  v_mfma_f32_16x16x32_bf16 a[76:79], v[64:67], a[156:159], a[76:79]
  buffer_load_dwordx4 v[48:51], v2, s[40:43], s13 offen offset:0 sc1
  v_mfma_f32_16x16x32_bf16 a[80:83], v[68:71], a[144:147], a[80:83]
  v_mfma_f32_16x16x32_bf16 a[84:87], v[68:71], a[148:151], a[84:87]
  v_mfma_f32_16x16x32_bf16 a[88:91], v[68:71], a[152:155], a[88:91]
  s_add_u32 s67, s67, 4096
  v_mfma_f32_16x16x32_bf16 a[92:95], v[68:71], a[156:159], a[92:95]
  buffer_load_dwordx4 v[52:55], v2, s[40:43], s13 offen offset:1024 sc1
  v_mfma_f32_16x16x32_bf16 a[96:99], v[72:75], a[144:147], a[96:99]
  v_mfma_f32_16x16x32_bf16 a[100:103], v[72:75], a[148:151], a[100:103]
  v_mfma_f32_16x16x32_bf16 a[104:107], v[72:75], a[152:155], a[104:107]
  v_mfma_f32_16x16x32_bf16 a[108:111], v[72:75], a[156:159], a[108:111]
  buffer_load_dwordx4 v[56:59], v2, s[40:43], s13 offen offset:2048 sc1
  v_mfma_f32_16x16x32_bf16 a[112:115], v[76:79], a[144:147], a[112:115]
  v_mfma_f32_16x16x32_bf16 a[116:119], v[76:79], a[148:151], a[116:119]
  v_mfma_f32_16x16x32_bf16 a[120:123], v[76:79], a[152:155], a[120:123]
  v_mfma_f32_16x16x32_bf16 a[124:127], v[76:79], a[156:159], a[124:127]
  v_mfma_f32_16x16x32_bf16 a[128:131], v[80:83], a[144:147], a[128:131]
  buffer_load_dwordx4 a[144:147], v2, s[40:43], s64 offen offset:0 sc1
  v_mfma_f32_16x16x32_bf16 a[132:135], v[80:83], a[148:151], a[132:135]
  buffer_load_dwordx4 a[148:151], v2, s[40:43], s65 offen offset:0 sc1
  v_mfma_f32_16x16x32_bf16 a[136:139], v[80:83], a[152:155], a[136:139]
  buffer_load_dwordx4 a[152:155], v2, s[40:43], s66 offen offset:0 sc1
  v_mfma_f32_16x16x32_bf16 a[140:143], v[80:83], a[156:159], a[140:143]
  buffer_load_dwordx4 a[156:159], v2, s[40:43], s67 offen offset:0 sc1
  s_waitcnt vmcnt(21)
  v_mfma_f32_16x16x32_bf16 a[64:67], v[84:87], a[160:163], a[64:67]
  v_mfma_f32_16x16x32_bf16 a[68:71], v[84:87], a[164:167], a[68:71]
  v_mfma_f32_16x16x32_bf16 a[72:75], v[84:87], a[168:171], a[72:75]
  v_mfma_f32_16x16x32_bf16 a[76:79], v[84:87], a[172:175], a[76:79]
  buffer_load_dwordx4 v[60:63], v2, s[40:43], s13 offen offset:3072 sc1
  v_mfma_f32_16x16x32_bf16 a[80:83], v[88:91], a[160:163], a[80:83]
  s_add_u32 s13, s13, 4096
  v_mfma_f32_16x16x32_bf16 a[84:87], v[88:91], a[164:167], a[84:87]
  v_mfma_f32_16x16x32_bf16 a[88:91], v[88:91], a[168:171], a[88:91]
  v_mfma_f32_16x16x32_bf16 a[92:95], v[88:91], a[172:175], a[92:95]
  buffer_load_dwordx4 v[96:99], v2, s[40:43], s13 offen offset:0 sc1
  v_mfma_f32_16x16x32_bf16 a[96:99], v[92:95], a[160:163], a[96:99]
  v_mfma_f32_16x16x32_bf16 a[100:103], v[92:95], a[164:167], a[100:103]
  v_mfma_f32_16x16x32_bf16 a[104:107], v[92:95], a[168:171], a[104:107]
  v_mfma_f32_16x16x32_bf16 a[108:111], v[92:95], a[172:175], a[108:111]
  buffer_load_dwordx4 v[100:103], v2, s[40:43], s13 offen offset:1024 sc1
  v_mfma_f32_16x16x32_bf16 a[112:115], v[128:131], a[160:163], a[112:115]
  v_mfma_f32_16x16x32_bf16 a[116:119], v[128:131], a[164:167], a[116:119]
  v_mfma_f32_16x16x32_bf16 a[120:123], v[128:131], a[168:171], a[120:123]
  v_mfma_f32_16x16x32_bf16 a[124:127], v[128:131], a[172:175], a[124:127]
  v_mfma_f32_16x16x32_bf16 a[128:131], v[132:135], a[160:163], a[128:131]
  buffer_load_dwordx4 a[160:163], v2, s[40:43], s64 offen offset:1024 sc1
  v_mfma_f32_16x16x32_bf16 a[132:135], v[132:135], a[164:167], a[132:135]
  buffer_load_dwordx4 a[164:167], v2, s[40:43], s65 offen offset:1024 sc1
  v_mfma_f32_16x16x32_bf16 a[136:139], v[132:135], a[168:171], a[136:139]
  buffer_load_dwordx4 a[168:171], v2, s[40:43], s66 offen offset:1024 sc1
  v_mfma_f32_16x16x32_bf16 a[140:143], v[132:135], a[172:175], a[140:143]
  buffer_load_dwordx4 a[172:175], v2, s[40:43], s67 offen offset:1024 sc1
  s_waitcnt vmcnt(21)
  v_mfma_f32_16x16x32_bf16 a[64:67], v[136:139], a[176:179], a[64:67]
  v_mfma_f32_16x16x32_bf16 a[68:71], v[136:139], a[180:183], a[68:71]
  v_mfma_f32_16x16x32_bf16 a[72:75], v[136:139], a[184:187], a[72:75]
  v_mfma_f32_16x16x32_bf16 a[76:79], v[136:139], a[188:191], a[76:79]
  buffer_load_dwordx4 v[104:107], v2, s[40:43], s13 offen offset:2048 sc1
  v_mfma_f32_16x16x32_bf16 a[80:83], v[140:143], a[176:179], a[80:83]
  v_mfma_f32_16x16x32_bf16 a[84:87], v[140:143], a[180:183], a[84:87]
  v_mfma_f32_16x16x32_bf16 a[88:91], v[140:143], a[184:187], a[88:91]
  v_mfma_f32_16x16x32_bf16 a[92:95], v[140:143], a[188:191], a[92:95]
  buffer_load_dwordx4 v[108:111], v2, s[40:43], s13 offen offset:3072 sc1
  v_mfma_f32_16x16x32_bf16 a[96:99], v[144:147], a[176:179], a[96:99]
  s_add_u32 s13, s13, 4096
  v_mfma_f32_16x16x32_bf16 a[100:103], v[144:147], a[180:183], a[100:103]
  v_mfma_f32_16x16x32_bf16 a[104:107], v[144:147], a[184:187], a[104:107]
  v_mfma_f32_16x16x32_bf16 a[108:111], v[144:147], a[188:191], a[108:111]
  buffer_load_dwordx4 v[112:115], v2, s[40:43], s13 offen offset:0 sc1
  v_mfma_f32_16x16x32_bf16 a[112:115], v[148:151], a[176:179], a[112:115]
  v_mfma_f32_16x16x32_bf16 a[116:119], v[148:151], a[180:183], a[116:119]
  v_mfma_f32_16x16x32_bf16 a[120:123], v[148:151], a[184:187], a[120:123]
  v_mfma_f32_16x16x32_bf16 a[124:127], v[148:151], a[188:191], a[124:127]
  v_mfma_f32_16x16x32_bf16 a[128:131], v[152:155], a[176:179], a[128:131]
  buffer_load_dwordx4 a[176:179], v2, s[40:43], s64 offen offset:2048 sc1
  v_mfma_f32_16x16x32_bf16 a[132:135], v[152:155], a[180:183], a[132:135]
  buffer_load_dwordx4 a[180:183], v2, s[40:43], s65 offen offset:2048 sc1
  v_mfma_f32_16x16x32_bf16 a[136:139], v[152:155], a[184:187], a[136:139]
  buffer_load_dwordx4 a[184:187], v2, s[40:43], s66 offen offset:2048 sc1
  v_mfma_f32_16x16x32_bf16 a[140:143], v[152:155], a[188:191], a[140:143]
  buffer_load_dwordx4 a[188:191], v2, s[40:43], s67 offen offset:2048 sc1
  s_waitcnt vmcnt(21)
  v_mfma_f32_16x16x32_bf16 a[64:67], v[156:159], v[216:219], a[64:67]
  v_mfma_f32_16x16x32_bf16 a[68:71], v[156:159], v[220:223], a[68:71]
  v_mfma_f32_16x16x32_bf16 a[72:75], v[156:159], v[224:227], a[72:75]
  v_mfma_f32_16x16x32_bf16 a[76:79], v[156:159], v[228:231], a[76:79]
  buffer_load_dwordx4 v[116:119], v2, s[40:43], s13 offen offset:1024 sc1
  v_mfma_f32_16x16x32_bf16 a[80:83], v[176:179], v[216:219], a[80:83]
  v_mfma_f32_16x16x32_bf16 a[84:87], v[176:179], v[220:223], a[84:87]
  v_mfma_f32_16x16x32_bf16 a[88:91], v[176:179], v[224:227], a[88:91]
  v_mfma_f32_16x16x32_bf16 a[92:95], v[176:179], v[228:231], a[92:95]
  buffer_load_dwordx4 v[120:123], v2, s[40:43], s13 offen offset:2048 sc1
  v_mfma_f32_16x16x32_bf16 a[96:99], v[180:183], v[216:219], a[96:99]
  v_mfma_f32_16x16x32_bf16 a[100:103], v[180:183], v[220:223], a[100:103]
  v_mfma_f32_16x16x32_bf16 a[104:107], v[180:183], v[224:227], a[104:107]
  v_mfma_f32_16x16x32_bf16 a[108:111], v[180:183], v[228:231], a[108:111]
  buffer_load_dwordx4 v[124:127], v2, s[40:43], s13 offen offset:3072 sc1
  v_mfma_f32_16x16x32_bf16 a[112:115], v[184:187], v[216:219], a[112:115]
  s_add_u32 s13, s13, 4096
  v_mfma_f32_16x16x32_bf16 a[116:119], v[184:187], v[220:223], a[116:119]
  v_mfma_f32_16x16x32_bf16 a[120:123], v[184:187], v[224:227], a[120:123]
  v_mfma_f32_16x16x32_bf16 a[124:127], v[184:187], v[228:231], a[124:127]
  v_mfma_f32_16x16x32_bf16 a[128:131], v[188:191], v[216:219], a[128:131]
  buffer_load_dwordx4 v[216:219], v2, s[40:43], s64 offen offset:3072 sc1
  v_mfma_f32_16x16x32_bf16 a[132:135], v[188:191], v[220:223], a[132:135]
  buffer_load_dwordx4 v[220:223], v2, s[40:43], s65 offen offset:3072 sc1
  v_mfma_f32_16x16x32_bf16 a[136:139], v[188:191], v[224:227], a[136:139]
  buffer_load_dwordx4 v[224:227], v2, s[40:43], s66 offen offset:3072 sc1
  v_mfma_f32_16x16x32_bf16 a[140:143], v[188:191], v[228:231], a[140:143]
  buffer_load_dwordx4 v[228:231], v2, s[40:43], s67 offen offset:3072 sc1
  s_waitcnt vmcnt(21)
  v_mfma_f32_16x16x32_bf16 a[64:67], a[0:3], a[144:147], a[64:67]
  s_add_u32 s64, s64, 4096
  v_mfma_f32_16x16x32_bf16 a[68:71], a[0:3], a[148:151], a[68:71]
  s_add_u32 s65, s65, 4096
  v_mfma_f32_16x16x32_bf16 a[72:75], a[0:3], a[152:155], a[72:75]
  s_add_u32 s66, s66, 4096
  v_mfma_f32_16x16x32_bf16 a[76:79], a[0:3], a[156:159], a[76:79]
  buffer_load_dwordx4 v[160:163], v2, s[40:43], s13 offen offset:0 sc1
  v_mfma_f32_16x16x32_bf16 a[80:83], a[4:7], a[144:147], a[80:83]
  v_mfma_f32_16x16x32_bf16 a[84:87], a[4:7], a[148:151], a[84:87]
  v_mfma_f32_16x16x32_bf16 a[88:91], a[4:7], a[152:155], a[88:91]
  s_add_u32 s67, s67, 4096
  v_mfma_f32_16x16x32_bf16 a[92:95], a[4:7], a[156:159], a[92:95]
  buffer_load_dwordx4 v[164:167], v2, s[40:43], s13 offen offset:1024 sc1
  v_mfma_f32_16x16x32_bf16 a[96:99], a[8:11], a[144:147], a[96:99]
  v_mfma_f32_16x16x32_bf16 a[100:103], a[8:11], a[148:151], a[100:103]
  v_mfma_f32_16x16x32_bf16 a[104:107], a[8:11], a[152:155], a[104:107]
  v_mfma_f32_16x16x32_bf16 a[108:111], a[8:11], a[156:159], a[108:111]
  buffer_load_dwordx4 v[168:171], v2, s[40:43], s13 offen offset:2048 sc1
  v_mfma_f32_16x16x32_bf16 a[112:115], a[12:15], a[144:147], a[112:115]
  v_mfma_f32_16x16x32_bf16 a[116:119], a[12:15], a[148:151], a[116:119]
  v_mfma_f32_16x16x32_bf16 a[120:123], a[12:15], a[152:155], a[120:123]
  v_mfma_f32_16x16x32_bf16 a[124:127], a[12:15], a[156:159], a[124:127]
  v_mfma_f32_16x16x32_bf16 a[128:131], a[16:19], a[144:147], a[128:131]
  buffer_load_dwordx4 a[144:147], v2, s[40:43], s64 offen offset:0 sc1
  v_mfma_f32_16x16x32_bf16 a[132:135], a[16:19], a[148:151], a[132:135]
  buffer_load_dwordx4 a[148:151], v2, s[40:43], s65 offen offset:0 sc1
  v_mfma_f32_16x16x32_bf16 a[136:139], a[16:19], a[152:155], a[136:139]
  buffer_load_dwordx4 a[152:155], v2, s[40:43], s66 offen offset:0 sc1
  v_mfma_f32_16x16x32_bf16 a[140:143], a[16:19], a[156:159], a[140:143]
  buffer_load_dwordx4 a[156:159], v2, s[40:43], s67 offen offset:0 sc1
  s_waitcnt vmcnt(21)
  v_mfma_f32_16x16x32_bf16 a[64:67], a[20:23], a[160:163], a[64:67]
  v_mfma_f32_16x16x32_bf16 a[68:71], a[20:23], a[164:167], a[68:71]
  v_mfma_f32_16x16x32_bf16 a[72:75], a[20:23], a[168:171], a[72:75]
  v_mfma_f32_16x16x32_bf16 a[76:79], a[20:23], a[172:175], a[76:79]
  buffer_load_dwordx4 v[172:175], v2, s[40:43], s13 offen offset:3072 sc1
  v_mfma_f32_16x16x32_bf16 a[80:83], a[24:27], a[160:163], a[80:83]
  s_add_u32 s13, s13, 4096
  v_mfma_f32_16x16x32_bf16 a[84:87], a[24:27], a[164:167], a[84:87]
  v_mfma_f32_16x16x32_bf16 a[88:91], a[24:27], a[168:171], a[88:91]
  v_mfma_f32_16x16x32_bf16 a[92:95], a[24:27], a[172:175], a[92:95]
  buffer_load_dwordx4 v[192:195], v2, s[40:43], s13 offen offset:0 sc1
  v_mfma_f32_16x16x32_bf16 a[96:99], a[28:31], a[160:163], a[96:99]
  v_mfma_f32_16x16x32_bf16 a[100:103], a[28:31], a[164:167], a[100:103]
  v_mfma_f32_16x16x32_bf16 a[104:107], a[28:31], a[168:171], a[104:107]
  v_mfma_f32_16x16x32_bf16 a[108:111], a[28:31], a[172:175], a[108:111]
  buffer_load_dwordx4 v[196:199], v2, s[40:43], s13 offen offset:1024 sc1
  v_mfma_f32_16x16x32_bf16 a[112:115], a[32:35], a[160:163], a[112:115]
  v_mfma_f32_16x16x32_bf16 a[116:119], a[32:35], a[164:167], a[116:119]
  v_mfma_f32_16x16x32_bf16 a[120:123], a[32:35], a[168:171], a[120:123]
  v_mfma_f32_16x16x32_bf16 a[124:127], a[32:35], a[172:175], a[124:127]
  v_mfma_f32_16x16x32_bf16 a[128:131], a[36:39], a[160:163], a[128:131]
  buffer_load_dwordx4 a[160:163], v2, s[40:43], s64 offen offset:1024 sc1
  v_mfma_f32_16x16x32_bf16 a[132:135], a[36:39], a[164:167], a[132:135]
  buffer_load_dwordx4 a[164:167], v2, s[40:43], s65 offen offset:1024 sc1
  v_mfma_f32_16x16x32_bf16 a[136:139], a[36:39], a[168:171], a[136:139]
  buffer_load_dwordx4 a[168:171], v2, s[40:43], s66 offen offset:1024 sc1
  v_mfma_f32_16x16x32_bf16 a[140:143], a[36:39], a[172:175], a[140:143]
  buffer_load_dwordx4 a[172:175], v2, s[40:43], s67 offen offset:1024 sc1
  s_waitcnt vmcnt(21)
  v_mfma_f32_16x16x32_bf16 a[64:67], a[40:43], a[176:179], a[64:67]
  v_mfma_f32_16x16x32_bf16 a[68:71], a[40:43], a[180:183], a[68:71]
  v_mfma_f32_16x16x32_bf16 a[72:75], a[40:43], a[184:187], a[72:75]
  v_mfma_f32_16x16x32_bf16 a[76:79], a[40:43], a[188:191], a[76:79]
  buffer_load_dwordx4 v[208:211], v2, s[40:43], s13 offen offset:2048 sc1
  v_mfma_f32_16x16x32_bf16 a[80:83], a[44:47], a[176:179], a[80:83]
  v_mfma_f32_16x16x32_bf16 a[84:87], a[44:47], a[180:183], a[84:87]
  v_mfma_f32_16x16x32_bf16 a[88:91], a[44:47], a[184:187], a[88:91]
  v_mfma_f32_16x16x32_bf16 a[92:95], a[44:47], a[188:191], a[92:95]
  buffer_load_dwordx4 v[212:215], v2, s[40:43], s13 offen offset:3072 sc1
  v_mfma_f32_16x16x32_bf16 a[96:99], a[48:51], a[176:179], a[96:99]
  s_add_u32 s13, s13, 4096
  v_mfma_f32_16x16x32_bf16 a[100:103], a[48:51], a[180:183], a[100:103]
  v_mfma_f32_16x16x32_bf16 a[104:107], a[48:51], a[184:187], a[104:107]
  v_mfma_f32_16x16x32_bf16 a[108:111], a[48:51], a[188:191], a[108:111]
  buffer_load_dwordx4 v[232:235], v2, s[40:43], s13 offen offset:0 sc1
  v_mfma_f32_16x16x32_bf16 a[112:115], a[52:55], a[176:179], a[112:115]
  v_mfma_f32_16x16x32_bf16 a[116:119], a[52:55], a[180:183], a[116:119]
  v_mfma_f32_16x16x32_bf16 a[120:123], a[52:55], a[184:187], a[120:123]
  v_mfma_f32_16x16x32_bf16 a[124:127], a[52:55], a[188:191], a[124:127]
  v_mfma_f32_16x16x32_bf16 a[128:131], a[56:59], a[176:179], a[128:131]
  buffer_load_dwordx4 a[176:179], v2, s[40:43], s64 offen offset:2048 sc1
  v_mfma_f32_16x16x32_bf16 a[132:135], a[56:59], a[180:183], a[132:135]
  buffer_load_dwordx4 a[180:183], v2, s[40:43], s65 offen offset:2048 sc1
  v_mfma_f32_16x16x32_bf16 a[136:139], a[56:59], a[184:187], a[136:139]
  buffer_load_dwordx4 a[184:187], v2, s[40:43], s66 offen offset:2048 sc1
  v_mfma_f32_16x16x32_bf16 a[140:143], a[56:59], a[188:191], a[140:143]
  buffer_load_dwordx4 a[188:191], v2, s[40:43], s67 offen offset:2048 sc1
  s_waitcnt vmcnt(21)
  v_mfma_f32_16x16x32_bf16 a[64:67], a[60:63], v[216:219], a[64:67]
  v_mfma_f32_16x16x32_bf16 a[68:71], a[60:63], v[220:223], a[68:71]
  v_mfma_f32_16x16x32_bf16 a[72:75], a[60:63], v[224:227], a[72:75]
  v_mfma_f32_16x16x32_bf16 a[76:79], a[60:63], v[228:231], a[76:79]
  buffer_load_dwordx4 v[236:239], v2, s[40:43], s13 offen offset:1024 sc1
  v_mfma_f32_16x16x32_bf16 a[80:83], a[192:195], v[216:219], a[80:83]
  v_mfma_f32_16x16x32_bf16 a[84:87], a[192:195], v[220:223], a[84:87]
  v_mfma_f32_16x16x32_bf16 a[88:91], a[192:195], v[224:227], a[88:91]
  v_mfma_f32_16x16x32_bf16 a[92:95], a[192:195], v[228:231], a[92:95]
  buffer_load_dwordx4 v[240:243], v2, s[40:43], s13 offen offset:2048 sc1
  v_mfma_f32_16x16x32_bf16 a[96:99], a[196:199], v[216:219], a[96:99]
  v_mfma_f32_16x16x32_bf16 a[100:103], a[196:199], v[220:223], a[100:103]
  v_mfma_f32_16x16x32_bf16 a[104:107], a[196:199], v[224:227], a[104:107]
  v_mfma_f32_16x16x32_bf16 a[108:111], a[196:199], v[228:231], a[108:111]
  buffer_load_dwordx4 v[244:247], v2, s[40:43], s13 offen offset:3072 sc1
  v_mfma_f32_16x16x32_bf16 a[112:115], a[200:203], v[216:219], a[112:115]
  s_add_u32 s13, s13, 4096
  v_mfma_f32_16x16x32_bf16 a[116:119], a[200:203], v[220:223], a[116:119]
  v_mfma_f32_16x16x32_bf16 a[120:123], a[200:203], v[224:227], a[120:123]
  v_mfma_f32_16x16x32_bf16 a[124:127], a[200:203], v[228:231], a[124:127]
  v_mfma_f32_16x16x32_bf16 a[128:131], a[204:207], v[216:219], a[128:131]
  buffer_load_dwordx4 v[216:219], v2, s[40:43], s64 offen offset:3072 sc1
  v_mfma_f32_16x16x32_bf16 a[132:135], a[204:207], v[220:223], a[132:135]
  buffer_load_dwordx4 v[220:223], v2, s[40:43], s65 offen offset:3072 sc1
  v_mfma_f32_16x16x32_bf16 a[136:139], a[204:207], v[224:227], a[136:139]
  buffer_load_dwordx4 v[224:227], v2, s[40:43], s66 offen offset:3072 sc1
  v_mfma_f32_16x16x32_bf16 a[140:143], a[204:207], v[228:231], a[140:143]
  buffer_load_dwordx4 v[228:231], v2, s[40:43], s67 offen offset:3072 sc1
  s_waitcnt vmcnt(21)
  v_mfma_f32_16x16x32_bf16 a[64:67], a[208:211], a[144:147], a[64:67]
  s_add_u32 s64, s64, 4096
  v_mfma_f32_16x16x32_bf16 a[68:71], a[208:211], a[148:151], a[68:71]
  s_add_u32 s65, s65, 4096
  v_mfma_f32_16x16x32_bf16 a[72:75], a[208:211], a[152:155], a[72:75]
  s_add_u32 s66, s66, 4096
  v_mfma_f32_16x16x32_bf16 a[76:79], a[208:211], a[156:159], a[76:79]
  buffer_load_dwordx4 v[64:67], v2, s[40:43], s13 offen offset:0 sc1
  v_mfma_f32_16x16x32_bf16 a[80:83], a[212:215], a[144:147], a[80:83]
  v_mfma_f32_16x16x32_bf16 a[84:87], a[212:215], a[148:151], a[84:87]
  v_mfma_f32_16x16x32_bf16 a[88:91], a[212:215], a[152:155], a[88:91]
  s_add_u32 s67, s67, 4096
  v_mfma_f32_16x16x32_bf16 a[92:95], a[212:215], a[156:159], a[92:95]
  buffer_load_dwordx4 v[68:71], v2, s[40:43], s13 offen offset:1024 sc1
  v_mfma_f32_16x16x32_bf16 a[96:99], a[216:219], a[144:147], a[96:99]
  v_mfma_f32_16x16x32_bf16 a[100:103], a[216:219], a[148:151], a[100:103]
  v_mfma_f32_16x16x32_bf16 a[104:107], a[216:219], a[152:155], a[104:107]
  v_mfma_f32_16x16x32_bf16 a[108:111], a[216:219], a[156:159], a[108:111]
  buffer_load_dwordx4 v[72:75], v2, s[40:43], s13 offen offset:2048 sc1
  v_mfma_f32_16x16x32_bf16 a[112:115], a[220:223], a[144:147], a[112:115]
  v_mfma_f32_16x16x32_bf16 a[116:119], a[220:223], a[148:151], a[116:119]
  v_mfma_f32_16x16x32_bf16 a[120:123], a[220:223], a[152:155], a[120:123]
  v_mfma_f32_16x16x32_bf16 a[124:127], a[220:223], a[156:159], a[124:127]
  v_mfma_f32_16x16x32_bf16 a[128:131], a[224:227], a[144:147], a[128:131]
  buffer_load_dwordx4 a[144:147], v2, s[40:43], s64 offen offset:0 sc1
  v_mfma_f32_16x16x32_bf16 a[132:135], a[224:227], a[148:151], a[132:135]
  buffer_load_dwordx4 a[148:151], v2, s[40:43], s65 offen offset:0 sc1
  v_mfma_f32_16x16x32_bf16 a[136:139], a[224:227], a[152:155], a[136:139]
  buffer_load_dwordx4 a[152:155], v2, s[40:43], s66 offen offset:0 sc1
  v_mfma_f32_16x16x32_bf16 a[140:143], a[224:227], a[156:159], a[140:143]
  buffer_load_dwordx4 a[156:159], v2, s[40:43], s67 offen offset:0 sc1
  s_waitcnt vmcnt(21)
  v_mfma_f32_16x16x32_bf16 a[64:67], a[228:231], a[160:163], a[64:67]
  v_mfma_f32_16x16x32_bf16 a[68:71], a[228:231], a[164:167], a[68:71]
  v_mfma_f32_16x16x32_bf16 a[72:75], a[228:231], a[168:171], a[72:75]
  v_mfma_f32_16x16x32_bf16 a[76:79], a[228:231], a[172:175], a[76:79]
  buffer_load_dwordx4 v[76:79], v2, s[40:43], s13 offen offset:3072 sc1
  v_mfma_f32_16x16x32_bf16 a[80:83], a[232:235], a[160:163], a[80:83]
  s_add_u32 s13, s13, 4096
  v_mfma_f32_16x16x32_bf16 a[84:87], a[232:235], a[164:167], a[84:87]
  v_mfma_f32_16x16x32_bf16 a[88:91], a[232:235], a[168:171], a[88:91]
  v_mfma_f32_16x16x32_bf16 a[92:95], a[232:235], a[172:175], a[92:95]
  buffer_load_dwordx4 v[80:83], v2, s[40:43], s13 offen offset:0 sc1
  v_mfma_f32_16x16x32_bf16 a[96:99], a[236:239], a[160:163], a[96:99]
  v_mfma_f32_16x16x32_bf16 a[100:103], a[236:239], a[164:167], a[100:103]
  v_mfma_f32_16x16x32_bf16 a[104:107], a[236:239], a[168:171], a[104:107]
  v_mfma_f32_16x16x32_bf16 a[108:111], a[236:239], a[172:175], a[108:111]
  buffer_load_dwordx4 v[84:87], v2, s[40:43], s13 offen offset:1024 sc1
  v_mfma_f32_16x16x32_bf16 a[112:115], a[240:243], a[160:163], a[112:115]
  v_mfma_f32_16x16x32_bf16 a[116:119], a[240:243], a[164:167], a[116:119]
  v_mfma_f32_16x16x32_bf16 a[120:123], a[240:243], a[168:171], a[120:123]
  v_mfma_f32_16x16x32_bf16 a[124:127], a[240:243], a[172:175], a[124:127]
  v_mfma_f32_16x16x32_bf16 a[128:131], a[244:247], a[160:163], a[128:131]
  buffer_load_dwordx4 a[160:163], v2, s[40:43], s64 offen offset:1024 sc1
  v_mfma_f32_16x16x32_bf16 a[132:135], a[244:247], a[164:167], a[132:135]
  buffer_load_dwordx4 a[164:167], v2, s[40:43], s65 offen offset:1024 sc1
  v_mfma_f32_16x16x32_bf16 a[136:139], a[244:247], a[168:171], a[136:139]
  buffer_load_dwordx4 a[168:171], v2, s[40:43], s66 offen offset:1024 sc1
  v_mfma_f32_16x16x32_bf16 a[140:143], a[244:247], a[172:175], a[140:143]
  buffer_load_dwordx4 a[172:175], v2, s[40:43], s67 offen offset:1024 sc1
  s_waitcnt vmcnt(21)
  v_mfma_f32_16x16x32_bf16 a[64:67], a[248:251], a[176:179], a[64:67]
  v_mfma_f32_16x16x32_bf16 a[68:71], a[248:251], a[180:183], a[68:71]
  v_mfma_f32_16x16x32_bf16 a[72:75], a[248:251], a[184:187], a[72:75]
  v_mfma_f32_16x16x32_bf16 a[76:79], a[248:251], a[188:191], a[76:79]
  buffer_load_dwordx4 v[88:91], v2, s[40:43], s13 offen offset:2048 sc1
  v_mfma_f32_16x16x32_bf16 a[80:83], a[252:255], a[176:179], a[80:83]
  v_mfma_f32_16x16x32_bf16 a[84:87], a[252:255], a[180:183], a[84:87]
  v_mfma_f32_16x16x32_bf16 a[88:91], a[252:255], a[184:187], a[88:91]
  v_mfma_f32_16x16x32_bf16 a[92:95], a[252:255], a[188:191], a[92:95]
  buffer_load_dwordx4 v[92:95], v2, s[40:43], s13 offen offset:3072 sc1
  v_mfma_f32_16x16x32_bf16 a[96:99], v[32:35], a[176:179], a[96:99]
  s_add_u32 s13, s13, 4096
  v_mfma_f32_16x16x32_bf16 a[100:103], v[32:35], a[180:183], a[100:103]
  v_mfma_f32_16x16x32_bf16 a[104:107], v[32:35], a[184:187], a[104:107]
  v_mfma_f32_16x16x32_bf16 a[108:111], v[32:35], a[188:191], a[108:111]
  buffer_load_dwordx4 v[128:131], v2, s[40:43], s13 offen offset:0 sc1
  v_mfma_f32_16x16x32_bf16 a[112:115], v[36:39], a[176:179], a[112:115]
  v_mfma_f32_16x16x32_bf16 a[116:119], v[36:39], a[180:183], a[116:119]
  v_mfma_f32_16x16x32_bf16 a[120:123], v[36:39], a[184:187], a[120:123]
  v_mfma_f32_16x16x32_bf16 a[124:127], v[36:39], a[188:191], a[124:127]
  v_mfma_f32_16x16x32_bf16 a[128:131], v[40:43], a[176:179], a[128:131]
  buffer_load_dwordx4 a[176:179], v2, s[40:43], s64 offen offset:2048 sc1
  v_mfma_f32_16x16x32_bf16 a[132:135], v[40:43], a[180:183], a[132:135]
  buffer_load_dwordx4 a[180:183], v2, s[40:43], s65 offen offset:2048 sc1
  v_mfma_f32_16x16x32_bf16 a[136:139], v[40:43], a[184:187], a[136:139]
  buffer_load_dwordx4 a[184:187], v2, s[40:43], s66 offen offset:2048 sc1
  v_mfma_f32_16x16x32_bf16 a[140:143], v[40:43], a[188:191], a[140:143]
  buffer_load_dwordx4 a[188:191], v2, s[40:43], s67 offen offset:2048 sc1
  s_waitcnt vmcnt(21)
  v_mfma_f32_16x16x32_bf16 a[64:67], v[44:47], v[216:219], a[64:67]
  v_mfma_f32_16x16x32_bf16 a[68:71], v[44:47], v[220:223], a[68:71]
  v_mfma_f32_16x16x32_bf16 a[72:75], v[44:47], v[224:227], a[72:75]
  v_mfma_f32_16x16x32_bf16 a[76:79], v[44:47], v[228:231], a[76:79]
  buffer_load_dwordx4 v[132:135], v2, s[40:43], s13 offen offset:1024 sc1
  v_mfma_f32_16x16x32_bf16 a[80:83], v[48:51], v[216:219], a[80:83]
  v_mfma_f32_16x16x32_bf16 a[84:87], v[48:51], v[220:223], a[84:87]
  v_mfma_f32_16x16x32_bf16 a[88:91], v[48:51], v[224:227], a[88:91]
  v_mfma_f32_16x16x32_bf16 a[92:95], v[48:51], v[228:231], a[92:95]
  buffer_load_dwordx4 v[136:139], v2, s[40:43], s13 offen offset:2048 sc1
  v_mfma_f32_16x16x32_bf16 a[96:99], v[52:55], v[216:219], a[96:99]
  v_mfma_f32_16x16x32_bf16 a[100:103], v[52:55], v[220:223], a[100:103]
  v_mfma_f32_16x16x32_bf16 a[104:107], v[52:55], v[224:227], a[104:107]
  v_mfma_f32_16x16x32_bf16 a[108:111], v[52:55], v[228:231], a[108:111]
  buffer_load_dwordx4 v[140:143], v2, s[40:43], s13 offen offset:3072 sc1
  v_mfma_f32_16x16x32_bf16 a[112:115], v[56:59], v[216:219], a[112:115]
  s_add_u32 s13, s13, 4096
  v_mfma_f32_16x16x32_bf16 a[116:119], v[56:59], v[220:223], a[116:119]
  v_mfma_f32_16x16x32_bf16 a[120:123], v[56:59], v[224:227], a[120:123]
  v_mfma_f32_16x16x32_bf16 a[124:127], v[56:59], v[228:231], a[124:127]
  v_mfma_f32_16x16x32_bf16 a[128:131], v[60:63], v[216:219], a[128:131]
  buffer_load_dwordx4 v[216:219], v2, s[40:43], s64 offen offset:3072 sc1
  v_mfma_f32_16x16x32_bf16 a[132:135], v[60:63], v[220:223], a[132:135]
  buffer_load_dwordx4 v[220:223], v2, s[40:43], s65 offen offset:3072 sc1
  v_mfma_f32_16x16x32_bf16 a[136:139], v[60:63], v[224:227], a[136:139]
  buffer_load_dwordx4 v[224:227], v2, s[40:43], s66 offen offset:3072 sc1
  v_mfma_f32_16x16x32_bf16 a[140:143], v[60:63], v[228:231], a[140:143]
  buffer_load_dwordx4 v[228:231], v2, s[40:43], s67 offen offset:3072 sc1
  s_waitcnt vmcnt(21)
  v_mfma_f32_16x16x32_bf16 a[64:67], v[96:99], a[144:147], a[64:67]
  s_add_u32 s64, s64, 4096
  v_mfma_f32_16x16x32_bf16 a[68:71], v[96:99], a[148:151], a[68:71]
  s_add_u32 s65, s65, 4096
  v_mfma_f32_16x16x32_bf16 a[72:75], v[96:99], a[152:155], a[72:75]
  s_add_u32 s66, s66, 4096
  v_mfma_f32_16x16x32_bf16 a[76:79], v[96:99], a[156:159], a[76:79]
  buffer_load_dwordx4 v[144:147], v2, s[40:43], s13 offen offset:0 sc1
  v_mfma_f32_16x16x32_bf16 a[80:83], v[100:103], a[144:147], a[80:83]
  v_mfma_f32_16x16x32_bf16 a[84:87], v[100:103], a[148:151], a[84:87]
  v_mfma_f32_16x16x32_bf16 a[88:91], v[100:103], a[152:155], a[88:91]
  s_add_u32 s67, s67, 4096
  v_mfma_f32_16x16x32_bf16 a[92:95], v[100:103], a[156:159], a[92:95]
  buffer_load_dwordx4 v[148:151], v2, s[40:43], s13 offen offset:1024 sc1
  v_mfma_f32_16x16x32_bf16 a[96:99], v[104:107], a[144:147], a[96:99]
  v_mfma_f32_16x16x32_bf16 a[100:103], v[104:107], a[148:151], a[100:103]
  v_mfma_f32_16x16x32_bf16 a[104:107], v[104:107], a[152:155], a[104:107]
  v_mfma_f32_16x16x32_bf16 a[108:111], v[104:107], a[156:159], a[108:111]
  buffer_load_dwordx4 v[152:155], v2, s[40:43], s13 offen offset:2048 sc1
  v_mfma_f32_16x16x32_bf16 a[112:115], v[108:111], a[144:147], a[112:115]
  v_mfma_f32_16x16x32_bf16 a[116:119], v[108:111], a[148:151], a[116:119]
  v_mfma_f32_16x16x32_bf16 a[120:123], v[108:111], a[152:155], a[120:123]
  v_mfma_f32_16x16x32_bf16 a[124:127], v[108:111], a[156:159], a[124:127]
  v_mfma_f32_16x16x32_bf16 a[128:131], v[112:115], a[144:147], a[128:131]
  buffer_load_dwordx4 a[144:147], v2, s[40:43], s64 offen offset:0 sc1
  v_mfma_f32_16x16x32_bf16 a[132:135], v[112:115], a[148:151], a[132:135]
  buffer_load_dwordx4 a[148:151], v2, s[40:43], s65 offen offset:0 sc1
  v_mfma_f32_16x16x32_bf16 a[136:139], v[112:115], a[152:155], a[136:139]
  buffer_load_dwordx4 a[152:155], v2, s[40:43], s66 offen offset:0 sc1
  v_mfma_f32_16x16x32_bf16 a[140:143], v[112:115], a[156:159], a[140:143]
  buffer_load_dwordx4 a[156:159], v2, s[40:43], s67 offen offset:0 sc1
  s_waitcnt vmcnt(21)
  v_mfma_f32_16x16x32_bf16 a[64:67], v[116:119], a[160:163], a[64:67]
  v_mfma_f32_16x16x32_bf16 a[68:71], v[116:119], a[164:167], a[68:71]
  v_mfma_f32_16x16x32_bf16 a[72:75], v[116:119], a[168:171], a[72:75]
  v_mfma_f32_16x16x32_bf16 a[76:79], v[116:119], a[172:175], a[76:79]
  buffer_load_dwordx4 v[156:159], v2, s[40:43], s13 offen offset:3072 sc1
  v_mfma_f32_16x16x32_bf16 a[80:83], v[120:123], a[160:163], a[80:83]
  s_add_u32 s13, s13, 4096
  v_mfma_f32_16x16x32_bf16 a[84:87], v[120:123], a[164:167], a[84:87]
  v_mfma_f32_16x16x32_bf16 a[88:91], v[120:123], a[168:171], a[88:91]
  v_mfma_f32_16x16x32_bf16 a[92:95], v[120:123], a[172:175], a[92:95]
  buffer_load_dwordx4 v[176:179], v2, s[40:43], s13 offen offset:0 sc1
  v_mfma_f32_16x16x32_bf16 a[96:99], v[124:127], a[160:163], a[96:99]
  v_mfma_f32_16x16x32_bf16 a[100:103], v[124:127], a[164:167], a[100:103]
  v_mfma_f32_16x16x32_bf16 a[104:107], v[124:127], a[168:171], a[104:107]
  v_mfma_f32_16x16x32_bf16 a[108:111], v[124:127], a[172:175], a[108:111]
  buffer_load_dwordx4 v[180:183], v2, s[40:43], s13 offen offset:1024 sc1
  v_mfma_f32_16x16x32_bf16 a[112:115], v[160:163], a[160:163], a[112:115]
  v_mfma_f32_16x16x32_bf16 a[116:119], v[160:163], a[164:167], a[116:119]
  v_mfma_f32_16x16x32_bf16 a[120:123], v[160:163], a[168:171], a[120:123]
  v_mfma_f32_16x16x32_bf16 a[124:127], v[160:163], a[172:175], a[124:127]
  v_mfma_f32_16x16x32_bf16 a[128:131], v[164:167], a[160:163], a[128:131]
  buffer_load_dwordx4 a[160:163], v2, s[40:43], s64 offen offset:1024 sc1
  v_mfma_f32_16x16x32_bf16 a[132:135], v[164:167], a[164:167], a[132:135]
  buffer_load_dwordx4 a[164:167], v2, s[40:43], s65 offen offset:1024 sc1
  v_mfma_f32_16x16x32_bf16 a[136:139], v[164:167], a[168:171], a[136:139]
  buffer_load_dwordx4 a[168:171], v2, s[40:43], s66 offen offset:1024 sc1
  v_mfma_f32_16x16x32_bf16 a[140:143], v[164:167], a[172:175], a[140:143]
  buffer_load_dwordx4 a[172:175], v2, s[40:43], s67 offen offset:1024 sc1
  s_waitcnt vmcnt(21)
  v_mfma_f32_16x16x32_bf16 a[64:67], v[168:171], a[176:179], a[64:67]
  v_mfma_f32_16x16x32_bf16 a[68:71], v[168:171], a[180:183], a[68:71]
  v_mfma_f32_16x16x32_bf16 a[72:75], v[168:171], a[184:187], a[72:75]
  v_mfma_f32_16x16x32_bf16 a[76:79], v[168:171], a[188:191], a[76:79]
  buffer_load_dwordx4 v[184:187], v2, s[40:43], s13 offen offset:2048 sc1
  v_mfma_f32_16x16x32_bf16 a[80:83], v[172:175], a[176:179], a[80:83]
  v_mfma_f32_16x16x32_bf16 a[84:87], v[172:175], a[180:183], a[84:87]
  v_mfma_f32_16x16x32_bf16 a[88:91], v[172:175], a[184:187], a[88:91]
  v_mfma_f32_16x16x32_bf16 a[92:95], v[172:175], a[188:191], a[92:95]
  buffer_load_dwordx4 v[188:191], v2, s[40:43], s13 offen offset:3072 sc1
  v_mfma_f32_16x16x32_bf16 a[96:99], v[192:195], a[176:179], a[96:99]
  s_add_u32 s13, s13, 4096
  v_mfma_f32_16x16x32_bf16 a[100:103], v[192:195], a[180:183], a[100:103]
  v_mfma_f32_16x16x32_bf16 a[104:107], v[192:195], a[184:187], a[104:107]
  v_mfma_f32_16x16x32_bf16 a[108:111], v[192:195], a[188:191], a[108:111]
  v_mfma_f32_16x16x32_bf16 a[112:115], v[196:199], a[176:179], a[112:115]
  v_mfma_f32_16x16x32_bf16 a[116:119], v[196:199], a[180:183], a[116:119]
  v_mfma_f32_16x16x32_bf16 a[120:123], v[196:199], a[184:187], a[120:123]
  v_mfma_f32_16x16x32_bf16 a[124:127], v[196:199], a[188:191], a[124:127]
  v_mfma_f32_16x16x32_bf16 a[128:131], v[208:211], a[176:179], a[128:131]
  buffer_load_dwordx4 a[176:179], v2, s[40:43], s64 offen offset:2048 sc1
  v_mfma_f32_16x16x32_bf16 a[132:135], v[208:211], a[180:183], a[132:135]
  buffer_load_dwordx4 a[180:183], v2, s[40:43], s65 offen offset:2048 sc1
  v_mfma_f32_16x16x32_bf16 a[136:139], v[208:211], a[184:187], a[136:139]
  buffer_load_dwordx4 a[184:187], v2, s[40:43], s66 offen offset:2048 sc1
  v_mfma_f32_16x16x32_bf16 a[140:143], v[208:211], a[188:191], a[140:143]
  buffer_load_dwordx4 a[188:191], v2, s[40:43], s67 offen offset:2048 sc1
  s_waitcnt vmcnt(20)
  v_mfma_f32_16x16x32_bf16 a[64:67], v[212:215], v[216:219], a[64:67]
  v_mfma_f32_16x16x32_bf16 a[68:71], v[212:215], v[220:223], a[68:71]
  v_mfma_f32_16x16x32_bf16 a[72:75], v[212:215], v[224:227], a[72:75]
  v_mfma_f32_16x16x32_bf16 a[76:79], v[212:215], v[228:231], a[76:79]
  v_mfma_f32_16x16x32_bf16 a[80:83], v[232:235], v[216:219], a[80:83]
  v_mfma_f32_16x16x32_bf16 a[84:87], v[232:235], v[220:223], a[84:87]
  v_mfma_f32_16x16x32_bf16 a[88:91], v[232:235], v[224:227], a[88:91]
  v_mfma_f32_16x16x32_bf16 a[92:95], v[232:235], v[228:231], a[92:95]
  v_mfma_f32_16x16x32_bf16 a[96:99], v[236:239], v[216:219], a[96:99]
  v_mfma_f32_16x16x32_bf16 a[100:103], v[236:239], v[220:223], a[100:103]
  v_mfma_f32_16x16x32_bf16 a[104:107], v[236:239], v[224:227], a[104:107]
  v_mfma_f32_16x16x32_bf16 a[108:111], v[236:239], v[228:231], a[108:111]
  v_mfma_f32_16x16x32_bf16 a[112:115], v[240:243], v[216:219], a[112:115]
  v_mfma_f32_16x16x32_bf16 a[116:119], v[240:243], v[220:223], a[116:119]
  v_mfma_f32_16x16x32_bf16 a[120:123], v[240:243], v[224:227], a[120:123]
  v_mfma_f32_16x16x32_bf16 a[124:127], v[240:243], v[228:231], a[124:127]
  v_mfma_f32_16x16x32_bf16 a[128:131], v[244:247], v[216:219], a[128:131]
  buffer_load_dwordx4 v[216:219], v2, s[40:43], s64 offen offset:3072 sc1
  v_mfma_f32_16x16x32_bf16 a[132:135], v[244:247], v[220:223], a[132:135]
  buffer_load_dwordx4 v[220:223], v2, s[40:43], s65 offen offset:3072 sc1
  v_mfma_f32_16x16x32_bf16 a[136:139], v[244:247], v[224:227], a[136:139]
  buffer_load_dwordx4 v[224:227], v2, s[40:43], s66 offen offset:3072 sc1
  v_mfma_f32_16x16x32_bf16 a[140:143], v[244:247], v[228:231], a[140:143]
  buffer_load_dwordx4 v[228:231], v2, s[40:43], s67 offen offset:3072 sc1
  s_waitcnt vmcnt(17)
  v_mfma_f32_16x16x32_bf16 a[64:67], v[64:67], a[144:147], a[64:67]
  v_mfma_f32_16x16x32_bf16 a[68:71], v[64:67], a[148:151], a[68:71]
  v_mfma_f32_16x16x32_bf16 a[72:75], v[64:67], a[152:155], a[72:75]
  v_mfma_f32_16x16x32_bf16 a[76:79], v[64:67], a[156:159], a[76:79]
  buffer_load_dwordx4 v[160:163], v248, s[44:47], 0 offen
  v_mfma_f32_16x16x32_bf16 a[80:83], v[68:71], a[144:147], a[80:83]
  v_mfma_f32_16x16x32_bf16 a[84:87], v[68:71], a[148:151], a[84:87]
  buffer_load_dwordx4 v[172:175], v200, s[40:43], s27 offen sc1
  v_mfma_f32_16x16x32_bf16 a[88:91], v[68:71], a[152:155], a[88:91]
  v_mfma_f32_16x16x32_bf16 a[92:95], v[68:71], a[156:159], a[92:95]
  buffer_load_dwordx4 v[164:167], v249, s[44:47], 0 offen
  v_mfma_f32_16x16x32_bf16 a[96:99], v[72:75], a[144:147], a[96:99]
  v_mfma_f32_16x16x32_bf16 a[100:103], v[72:75], a[148:151], a[100:103]
  buffer_load_dwordx4 v[192:195], v201, s[40:43], s27 offen sc1
  v_mfma_f32_16x16x32_bf16 a[104:107], v[72:75], a[152:155], a[104:107]
  v_mfma_f32_16x16x32_bf16 a[108:111], v[72:75], a[156:159], a[108:111]
  buffer_load_dwordx4 v[168:171], v250, s[44:47], 0 offen
  v_mfma_f32_16x16x32_bf16 a[112:115], v[76:79], a[144:147], a[112:115]
  v_mfma_f32_16x16x32_bf16 a[116:119], v[76:79], a[148:151], a[116:119]
  buffer_load_dwordx4 v[196:199], v202, s[40:43], s27 offen sc1
  v_mfma_f32_16x16x32_bf16 a[120:123], v[76:79], a[152:155], a[120:123]
  v_mfma_f32_16x16x32_bf16 a[124:127], v[76:79], a[156:159], a[124:127]
  v_mfma_f32_16x16x32_bf16 a[128:131], v[80:83], a[144:147], a[128:131]
  v_mfma_f32_16x16x32_bf16 a[132:135], v[80:83], a[148:151], a[132:135]
  v_mfma_f32_16x16x32_bf16 a[136:139], v[80:83], a[152:155], a[136:139]
  v_mfma_f32_16x16x32_bf16 a[140:143], v[80:83], a[156:159], a[140:143]
  s_waitcnt vmcnt(16)
  v_mfma_f32_16x16x32_bf16 a[64:67], v[84:87], a[160:163], a[64:67]
  v_mfma_f32_16x16x32_bf16 a[68:71], v[84:87], a[164:167], a[68:71]
  v_mfma_f32_16x16x32_bf16 a[72:75], v[84:87], a[168:171], a[72:75]
  v_mfma_f32_16x16x32_bf16 a[76:79], v[84:87], a[172:175], a[76:79]
  v_mfma_f32_16x16x32_bf16 a[80:83], v[88:91], a[160:163], a[80:83]
  v_mfma_f32_16x16x32_bf16 a[84:87], v[88:91], a[164:167], a[84:87]
  v_mfma_f32_16x16x32_bf16 a[88:91], v[88:91], a[168:171], a[88:91]
  v_mfma_f32_16x16x32_bf16 a[92:95], v[88:91], a[172:175], a[92:95]
  v_mfma_f32_16x16x32_bf16 a[96:99], v[92:95], a[160:163], a[96:99]
  v_mfma_f32_16x16x32_bf16 a[100:103], v[92:95], a[164:167], a[100:103]
  v_mfma_f32_16x16x32_bf16 a[104:107], v[92:95], a[168:171], a[104:107]
  v_mfma_f32_16x16x32_bf16 a[108:111], v[92:95], a[172:175], a[108:111]
  v_mfma_f32_16x16x32_bf16 a[112:115], v[128:131], a[160:163], a[112:115]
  v_mfma_f32_16x16x32_bf16 a[116:119], v[128:131], a[164:167], a[116:119]
  v_mfma_f32_16x16x32_bf16 a[120:123], v[128:131], a[168:171], a[120:123]
  v_mfma_f32_16x16x32_bf16 a[124:127], v[128:131], a[172:175], a[124:127]
  v_mfma_f32_16x16x32_bf16 a[128:131], v[132:135], a[160:163], a[128:131]
  v_mfma_f32_16x16x32_bf16 a[132:135], v[132:135], a[164:167], a[132:135]
  v_mfma_f32_16x16x32_bf16 a[136:139], v[132:135], a[168:171], a[136:139]
  v_mfma_f32_16x16x32_bf16 a[140:143], v[132:135], a[172:175], a[140:143]
  s_waitcnt vmcnt(10)
  v_mfma_f32_16x16x32_bf16 a[64:67], v[136:139], a[176:179], a[64:67]
  v_mfma_f32_16x16x32_bf16 a[68:71], v[136:139], a[180:183], a[68:71]
  v_mfma_f32_16x16x32_bf16 a[72:75], v[136:139], a[184:187], a[72:75]
  v_mfma_f32_16x16x32_bf16 a[76:79], v[136:139], a[188:191], a[76:79]
  v_mfma_f32_16x16x32_bf16 a[80:83], v[140:143], a[176:179], a[80:83]
  v_mfma_f32_16x16x32_bf16 a[84:87], v[140:143], a[180:183], a[84:87]
  v_mfma_f32_16x16x32_bf16 a[88:91], v[140:143], a[184:187], a[88:91]
  v_mfma_f32_16x16x32_bf16 a[92:95], v[140:143], a[188:191], a[92:95]
  v_mfma_f32_16x16x32_bf16 a[96:99], v[144:147], a[176:179], a[96:99]
  v_mfma_f32_16x16x32_bf16 a[100:103], v[144:147], a[180:183], a[100:103]
  v_mfma_f32_16x16x32_bf16 a[104:107], v[144:147], a[184:187], a[104:107]
  v_mfma_f32_16x16x32_bf16 a[108:111], v[144:147], a[188:191], a[108:111]
  v_mfma_f32_16x16x32_bf16 a[112:115], v[148:151], a[176:179], a[112:115]
  v_mfma_f32_16x16x32_bf16 a[116:119], v[148:151], a[180:183], a[116:119]
  v_mfma_f32_16x16x32_bf16 a[120:123], v[148:151], a[184:187], a[120:123]
  v_mfma_f32_16x16x32_bf16 a[124:127], v[148:151], a[188:191], a[124:127]
  v_mfma_f32_16x16x32_bf16 a[128:131], v[152:155], a[176:179], a[128:131]
  v_mfma_f32_16x16x32_bf16 a[132:135], v[152:155], a[180:183], a[132:135]
  v_mfma_f32_16x16x32_bf16 a[136:139], v[152:155], a[184:187], a[136:139]
  v_mfma_f32_16x16x32_bf16 a[140:143], v[152:155], a[188:191], a[140:143]
  s_waitcnt vmcnt(6)
  v_mfma_f32_16x16x32_bf16 a[64:67], v[156:159], v[216:219], a[64:67]
  v_mfma_f32_16x16x32_bf16 a[68:71], v[156:159], v[220:223], a[68:71]
  v_mfma_f32_16x16x32_bf16 a[72:75], v[156:159], v[224:227], a[72:75]
  v_mfma_f32_16x16x32_bf16 a[76:79], v[156:159], v[228:231], a[76:79]
  v_mfma_f32_16x16x32_bf16 a[80:83], v[176:179], v[216:219], a[80:83]
  v_mfma_f32_16x16x32_bf16 a[84:87], v[176:179], v[220:223], a[84:87]
  v_mfma_f32_16x16x32_bf16 a[88:91], v[176:179], v[224:227], a[88:91]
  v_mfma_f32_16x16x32_bf16 a[92:95], v[176:179], v[228:231], a[92:95]
  v_mfma_f32_16x16x32_bf16 a[96:99], v[180:183], v[216:219], a[96:99]
  v_mfma_f32_16x16x32_bf16 a[100:103], v[180:183], v[220:223], a[100:103]
  v_mfma_f32_16x16x32_bf16 a[104:107], v[180:183], v[224:227], a[104:107]
  v_mfma_f32_16x16x32_bf16 a[108:111], v[180:183], v[228:231], a[108:111]
  v_mfma_f32_16x16x32_bf16 a[112:115], v[184:187], v[216:219], a[112:115]
  v_mfma_f32_16x16x32_bf16 a[116:119], v[184:187], v[220:223], a[116:119]
  v_mfma_f32_16x16x32_bf16 a[120:123], v[184:187], v[224:227], a[120:123]
  v_mfma_f32_16x16x32_bf16 a[124:127], v[184:187], v[228:231], a[124:127]
  v_mfma_f32_16x16x32_bf16 a[128:131], v[188:191], v[216:219], a[128:131]
  v_mfma_f32_16x16x32_bf16 a[132:135], v[188:191], v[220:223], a[132:135]
  v_mfma_f32_16x16x32_bf16 a[136:139], v[188:191], v[224:227], a[136:139]
  v_mfma_f32_16x16x32_bf16 a[140:143], v[188:191], v[228:231], a[140:143]
  v_and_b32 v16, 15, v1
  v_mul_u32_u24 v16, 336, v16
  v_lshrrev_b32 v17, 4, v1
  v_lshl_add_u32 v16, v17, 4, v16
  s_mul_i32 s23, s20, 21504
  v_add_u32 v16, s23, v16
  s_barrier
  ds_write_b128 v16, a[64:67] offset:0
  ds_write_b128 v16, a[68:71] offset:5376
  ds_write_b128 v16, a[72:75] offset:10752
  ds_write_b128 v16, a[76:79] offset:16128
  ds_write_b128 v16, a[80:83] offset:64
  ds_write_b128 v16, a[84:87] offset:5440
  ds_write_b128 v16, a[88:91] offset:10816
  ds_write_b128 v16, a[92:95] offset:16192
  ds_write_b128 v16, a[96:99] offset:128
  ds_write_b128 v16, a[100:103] offset:5504
  ds_write_b128 v16, a[104:107] offset:10880
  ds_write_b128 v16, a[108:111] offset:16256
  ds_write_b128 v16, a[112:115] offset:192
  ds_write_b128 v16, a[116:119] offset:5568
  ds_write_b128 v16, a[120:123] offset:10944
  ds_write_b128 v16, a[124:127] offset:16320
  ds_write_b128 v16, a[128:131] offset:256
  ds_write_b128 v16, a[132:135] offset:5632
  ds_write_b128 v16, a[136:139] offset:11008
  ds_write_b128 v16, a[140:143] offset:16384
  s_waitcnt vmcnt(0) lgkmcnt(0)
  s_barrier
  ds_read_b128 v[32:35], v251 offset:0
  ds_read_b128 v[36:39], v251 offset:16
  ds_read_b128 v[40:43], v251 offset:21504
  ds_read_b128 v[44:47], v251 offset:21520
  ds_read_b128 v[48:51], v251 offset:43008
  ds_read_b128 v[52:55], v251 offset:43024
  ds_read_b128 v[56:59], v251 offset:64512
  ds_read_b128 v[60:63], v251 offset:64528
  ds_read_b128 v[64:67], v203 offset:0
  ds_read_b128 v[68:71], v203 offset:16
  ds_read_b128 v[72:75], v252 offset:0
  ds_read_b128 v[76:79], v252 offset:16
  ds_read_b128 v[80:83], v252 offset:21504
  ds_read_b128 v[84:87], v252 offset:21520
  ds_read_b128 v[88:91], v252 offset:43008
  ds_read_b128 v[92:95], v252 offset:43024
  ds_read_b128 v[96:99], v252 offset:64512
  ds_read_b128 v[100:103], v252 offset:64528
  ds_read_b128 v[104:107], v204 offset:0
  ds_read_b128 v[108:111], v204 offset:16
  ds_read_b128 v[112:115], v253 offset:0
  ds_read_b128 v[116:119], v253 offset:16
  ds_read_b128 v[120:123], v253 offset:21504
  ds_read_b128 v[124:127], v253 offset:21520
  ds_read_b128 v[128:131], v253 offset:43008
  ds_read_b128 v[132:135], v253 offset:43024
  ds_read_b128 v[136:139], v253 offset:64512
  ds_read_b128 v[140:143], v253 offset:64528
  ds_read_b128 v[144:147], v205 offset:0
  ds_read_b128 v[148:151], v205 offset:16
  s_waitcnt lgkmcnt(10)
  v_add_f32 v32, v32, v40
  v_add_f32 v48, v48, v56
  v_add_f32 v33, v33, v41
  v_add_f32 v49, v49, v57
  v_add_f32 v34, v34, v42
  v_add_f32 v50, v50, v58
  v_add_f32 v35, v35, v43
  v_add_f32 v51, v51, v59
  v_add_f32 v36, v36, v44
  v_add_f32 v52, v52, v60
  v_add_f32 v37, v37, v45
  v_add_f32 v53, v53, v61
  v_add_f32 v38, v38, v46
  v_add_f32 v54, v54, v62
  v_add_f32 v39, v39, v47
  v_add_f32 v55, v55, v63
  v_add_f32 v32, v32, v48
  v_add_f32 v33, v33, v49
  v_add_f32 v34, v34, v50
  v_add_f32 v35, v35, v51
  v_add_f32 v36, v36, v52
  v_add_f32 v37, v37, v53
  v_add_f32 v38, v38, v54
  v_add_f32 v39, v39, v55
  v_cvt_pk_bf16_f32 v40, v32, v33
  v_lshlrev_b32 v42, 16, v160
  v_and_b32 v43, 0xffff0000, v160
  v_and_b32 v41, 0xffff0000, v40
  v_lshlrev_b32 v40, 16, v40
  v_add_f32 v40, v40, v42
  v_add_f32 v41, v41, v43
  v_cvt_pk_bf16_f32 v40, v40, v41
  v_lshlrev_b32 v42, 16, v172
  v_and_b32 v43, 0xffff0000, v172
  v_add_f32 v42, v42, v64
  v_add_f32 v43, v43, v65
  v_cvt_pk_bf16_f32 v42, v42, v43
  v_and_b32 v41, 0xffff0000, v40
  v_lshlrev_b32 v40, 16, v40
  v_and_b32 v43, 0xffff0000, v42
  v_lshlrev_b32 v42, 16, v42
  v_add_f32 v40, v40, v42
  v_add_f32 v41, v41, v43
  v_cvt_pk_bf16_f32 v44, v40, v41
  v_cvt_pk_bf16_f32 v40, v34, v35
  v_lshlrev_b32 v42, 16, v161
  v_and_b32 v43, 0xffff0000, v161
  v_and_b32 v41, 0xffff0000, v40
  v_lshlrev_b32 v40, 16, v40
  v_add_f32 v40, v40, v42
  v_add_f32 v41, v41, v43
  v_cvt_pk_bf16_f32 v40, v40, v41
  v_lshlrev_b32 v42, 16, v173
  v_and_b32 v43, 0xffff0000, v173
  v_add_f32 v42, v42, v66
  v_add_f32 v43, v43, v67
  v_cvt_pk_bf16_f32 v42, v42, v43
  v_and_b32 v41, 0xffff0000, v40
  v_lshlrev_b32 v40, 16, v40
  v_and_b32 v43, 0xffff0000, v42
  v_lshlrev_b32 v42, 16, v42
  v_add_f32 v40, v40, v42
  v_add_f32 v41, v41, v43
  v_cvt_pk_bf16_f32 v45, v40, v41
  v_cvt_pk_bf16_f32 v40, v36, v37
  v_lshlrev_b32 v42, 16, v162
  v_and_b32 v43, 0xffff0000, v162
  v_and_b32 v41, 0xffff0000, v40
  v_lshlrev_b32 v40, 16, v40
  v_add_f32 v40, v40, v42
  v_add_f32 v41, v41, v43
  v_cvt_pk_bf16_f32 v40, v40, v41
  v_lshlrev_b32 v42, 16, v174
  v_and_b32 v43, 0xffff0000, v174
  v_add_f32 v42, v42, v68
  v_add_f32 v43, v43, v69
  v_cvt_pk_bf16_f32 v42, v42, v43
  v_and_b32 v41, 0xffff0000, v40
  v_lshlrev_b32 v40, 16, v40
  v_and_b32 v43, 0xffff0000, v42
  v_lshlrev_b32 v42, 16, v42
  v_add_f32 v40, v40, v42
  v_add_f32 v41, v41, v43
  v_cvt_pk_bf16_f32 v46, v40, v41
  v_cvt_pk_bf16_f32 v40, v38, v39
  v_lshlrev_b32 v42, 16, v163
  v_and_b32 v43, 0xffff0000, v163
  v_and_b32 v41, 0xffff0000, v40
  v_lshlrev_b32 v40, 16, v40
  v_add_f32 v40, v40, v42
  v_add_f32 v41, v41, v43
  v_cvt_pk_bf16_f32 v40, v40, v41
  v_lshlrev_b32 v42, 16, v175
  v_and_b32 v43, 0xffff0000, v175
  v_add_f32 v42, v42, v70
  v_add_f32 v43, v43, v71
  v_cvt_pk_bf16_f32 v42, v42, v43
  v_and_b32 v41, 0xffff0000, v40
  v_lshlrev_b32 v40, 16, v40
  v_and_b32 v43, 0xffff0000, v42
  v_lshlrev_b32 v42, 16, v42
  v_add_f32 v40, v40, v42
  v_add_f32 v41, v41, v43
  v_cvt_pk_bf16_f32 v47, v40, v41
  buffer_store_dwordx4 v[44:47], v248, s[48:51], 0 offen
  s_waitcnt lgkmcnt(10)
  v_add_f32 v72, v72, v80
  v_add_f32 v88, v88, v96
  v_add_f32 v73, v73, v81
  v_add_f32 v89, v89, v97
  v_add_f32 v74, v74, v82
  v_add_f32 v90, v90, v98
  v_add_f32 v75, v75, v83
  v_add_f32 v91, v91, v99
  v_add_f32 v76, v76, v84
  v_add_f32 v92, v92, v100
  v_add_f32 v77, v77, v85
  v_add_f32 v93, v93, v101
  v_add_f32 v78, v78, v86
  v_add_f32 v94, v94, v102
  v_add_f32 v79, v79, v87
  v_add_f32 v95, v95, v103
  v_add_f32 v72, v72, v88
  v_add_f32 v73, v73, v89
  v_add_f32 v74, v74, v90
  v_add_f32 v75, v75, v91
  v_add_f32 v76, v76, v92
  v_add_f32 v77, v77, v93
  v_add_f32 v78, v78, v94
  v_add_f32 v79, v79, v95
  v_cvt_pk_bf16_f32 v80, v72, v73
  v_lshlrev_b32 v82, 16, v164
  v_and_b32 v83, 0xffff0000, v164
  v_and_b32 v81, 0xffff0000, v80
  v_lshlrev_b32 v80, 16, v80
  v_add_f32 v80, v80, v82
  v_add_f32 v81, v81, v83
  v_cvt_pk_bf16_f32 v80, v80, v81
  v_lshlrev_b32 v82, 16, v192
  v_and_b32 v83, 0xffff0000, v192
  v_add_f32 v82, v82, v104
  v_add_f32 v83, v83, v105
  v_cvt_pk_bf16_f32 v82, v82, v83
  v_and_b32 v81, 0xffff0000, v80
  v_lshlrev_b32 v80, 16, v80
  v_and_b32 v83, 0xffff0000, v82
  v_lshlrev_b32 v82, 16, v82
  v_add_f32 v80, v80, v82
  v_add_f32 v81, v81, v83
  v_cvt_pk_bf16_f32 v84, v80, v81
  v_cvt_pk_bf16_f32 v80, v74, v75
  v_lshlrev_b32 v82, 16, v165
  v_and_b32 v83, 0xffff0000, v165
  v_and_b32 v81, 0xffff0000, v80
  v_lshlrev_b32 v80, 16, v80
  v_add_f32 v80, v80, v82
  v_add_f32 v81, v81, v83
  v_cvt_pk_bf16_f32 v80, v80, v81
  v_lshlrev_b32 v82, 16, v193
  v_and_b32 v83, 0xffff0000, v193
  v_add_f32 v82, v82, v106
  v_add_f32 v83, v83, v107
  v_cvt_pk_bf16_f32 v82, v82, v83
  v_and_b32 v81, 0xffff0000, v80
  v_lshlrev_b32 v80, 16, v80
  v_and_b32 v83, 0xffff0000, v82
  v_lshlrev_b32 v82, 16, v82
  v_add_f32 v80, v80, v82
  v_add_f32 v81, v81, v83
  v_cvt_pk_bf16_f32 v85, v80, v81
  v_cvt_pk_bf16_f32 v80, v76, v77
  v_lshlrev_b32 v82, 16, v166
  v_and_b32 v83, 0xffff0000, v166
  v_and_b32 v81, 0xffff0000, v80
  v_lshlrev_b32 v80, 16, v80
  v_add_f32 v80, v80, v82
  v_add_f32 v81, v81, v83
  v_cvt_pk_bf16_f32 v80, v80, v81
  v_lshlrev_b32 v82, 16, v194
  v_and_b32 v83, 0xffff0000, v194
  v_add_f32 v82, v82, v108
  v_add_f32 v83, v83, v109
  v_cvt_pk_bf16_f32 v82, v82, v83
  v_and_b32 v81, 0xffff0000, v80
  v_lshlrev_b32 v80, 16, v80
  v_and_b32 v83, 0xffff0000, v82
  v_lshlrev_b32 v82, 16, v82
  v_add_f32 v80, v80, v82
  v_add_f32 v81, v81, v83
  v_cvt_pk_bf16_f32 v86, v80, v81
  v_cvt_pk_bf16_f32 v80, v78, v79
  v_lshlrev_b32 v82, 16, v167
  v_and_b32 v83, 0xffff0000, v167
  v_and_b32 v81, 0xffff0000, v80
  v_lshlrev_b32 v80, 16, v80
  v_add_f32 v80, v80, v82
  v_add_f32 v81, v81, v83
  v_cvt_pk_bf16_f32 v80, v80, v81
  v_lshlrev_b32 v82, 16, v195
  v_and_b32 v83, 0xffff0000, v195
  v_add_f32 v82, v82, v110
  v_add_f32 v83, v83, v111
  v_cvt_pk_bf16_f32 v82, v82, v83
  v_and_b32 v81, 0xffff0000, v80
  v_lshlrev_b32 v80, 16, v80
  v_and_b32 v83, 0xffff0000, v82
  v_lshlrev_b32 v82, 16, v82
  v_add_f32 v80, v80, v82
  v_add_f32 v81, v81, v83
  v_cvt_pk_bf16_f32 v87, v80, v81
  buffer_store_dwordx4 v[84:87], v249, s[48:51], 0 offen
  s_waitcnt lgkmcnt(0)
  v_add_f32 v112, v112, v120
  v_add_f32 v128, v128, v136
  v_add_f32 v113, v113, v121
  v_add_f32 v129, v129, v137
  v_add_f32 v114, v114, v122
  v_add_f32 v130, v130, v138
  v_add_f32 v115, v115, v123
  v_add_f32 v131, v131, v139
  v_add_f32 v116, v116, v124
  v_add_f32 v132, v132, v140
  v_add_f32 v117, v117, v125
  v_add_f32 v133, v133, v141
  v_add_f32 v118, v118, v126
  v_add_f32 v134, v134, v142
  v_add_f32 v119, v119, v127
  v_add_f32 v135, v135, v143
  v_add_f32 v112, v112, v128
  v_add_f32 v113, v113, v129
  v_add_f32 v114, v114, v130
  v_add_f32 v115, v115, v131
  v_add_f32 v116, v116, v132
  v_add_f32 v117, v117, v133
  v_add_f32 v118, v118, v134
  v_add_f32 v119, v119, v135
  v_cvt_pk_bf16_f32 v120, v112, v113
  v_lshlrev_b32 v122, 16, v168
  v_and_b32 v123, 0xffff0000, v168
  v_and_b32 v121, 0xffff0000, v120
  v_lshlrev_b32 v120, 16, v120
  v_add_f32 v120, v120, v122
  v_add_f32 v121, v121, v123
  v_cvt_pk_bf16_f32 v120, v120, v121
  v_lshlrev_b32 v122, 16, v196
  v_and_b32 v123, 0xffff0000, v196
  v_add_f32 v122, v122, v144
  v_add_f32 v123, v123, v145
  v_cvt_pk_bf16_f32 v122, v122, v123
  v_and_b32 v121, 0xffff0000, v120
  v_lshlrev_b32 v120, 16, v120
  v_and_b32 v123, 0xffff0000, v122
  v_lshlrev_b32 v122, 16, v122
  v_add_f32 v120, v120, v122
  v_add_f32 v121, v121, v123
  v_cvt_pk_bf16_f32 v124, v120, v121
  v_cvt_pk_bf16_f32 v120, v114, v115
  v_lshlrev_b32 v122, 16, v169
  v_and_b32 v123, 0xffff0000, v169
  v_and_b32 v121, 0xffff0000, v120
  v_lshlrev_b32 v120, 16, v120
  v_add_f32 v120, v120, v122
  v_add_f32 v121, v121, v123
  v_cvt_pk_bf16_f32 v120, v120, v121
  v_lshlrev_b32 v122, 16, v197
  v_and_b32 v123, 0xffff0000, v197
  v_add_f32 v122, v122, v146
  v_add_f32 v123, v123, v147
  v_cvt_pk_bf16_f32 v122, v122, v123
  v_and_b32 v121, 0xffff0000, v120
  v_lshlrev_b32 v120, 16, v120
  v_and_b32 v123, 0xffff0000, v122
  v_lshlrev_b32 v122, 16, v122
  v_add_f32 v120, v120, v122
  v_add_f32 v121, v121, v123
  v_cvt_pk_bf16_f32 v125, v120, v121
  v_cvt_pk_bf16_f32 v120, v116, v117
  v_lshlrev_b32 v122, 16, v170
  v_and_b32 v123, 0xffff0000, v170
  v_and_b32 v121, 0xffff0000, v120
  v_lshlrev_b32 v120, 16, v120
  v_add_f32 v120, v120, v122
  v_add_f32 v121, v121, v123
  v_cvt_pk_bf16_f32 v120, v120, v121
  v_lshlrev_b32 v122, 16, v198
  v_and_b32 v123, 0xffff0000, v198
  v_add_f32 v122, v122, v148
  v_add_f32 v123, v123, v149
  v_cvt_pk_bf16_f32 v122, v122, v123
  v_and_b32 v121, 0xffff0000, v120
  v_lshlrev_b32 v120, 16, v120
  v_and_b32 v123, 0xffff0000, v122
  v_lshlrev_b32 v122, 16, v122
  v_add_f32 v120, v120, v122
  v_add_f32 v121, v121, v123
  v_cvt_pk_bf16_f32 v126, v120, v121
  v_cvt_pk_bf16_f32 v120, v118, v119
  v_lshlrev_b32 v122, 16, v171
  v_and_b32 v123, 0xffff0000, v171
  v_and_b32 v121, 0xffff0000, v120
  v_lshlrev_b32 v120, 16, v120
  v_add_f32 v120, v120, v122
  v_add_f32 v121, v121, v123
  v_cvt_pk_bf16_f32 v120, v120, v121
  v_lshlrev_b32 v122, 16, v199
  v_and_b32 v123, 0xffff0000, v199
  v_add_f32 v122, v122, v150
  v_add_f32 v123, v123, v151
  v_cvt_pk_bf16_f32 v122, v122, v123
  v_and_b32 v121, 0xffff0000, v120
  v_lshlrev_b32 v120, 16, v120
  v_and_b32 v123, 0xffff0000, v122
  v_lshlrev_b32 v122, 16, v122
  v_add_f32 v120, v120, v122
  v_add_f32 v121, v121, v123
  v_cvt_pk_bf16_f32 v127, v120, v121
  buffer_store_dwordx4 v[124:127], v250, s[48:51], 0 offen
fa_end:
  s_endpgm
fa_ln_spin:
  s_mov_b32 s83, 200000
fa_ln_spin2:
  buffer_load_dword v15, v229, s[56:59], 0 offen sc1
  s_waitcnt vmcnt(0)
  v_cmp_ne_u32 vcc, 0x01010101, v15
  s_cbranch_vccz fa_ln_ok
  s_sleep 8
  s_sub_u32 s83, s83, 1
  s_cmp_lg_u32 s83, 0
  s_cbranch_scc1 fa_ln_spin2
  s_branch fa_ln_ok
fa_p1stubK:
  s_call_b64 s[76:77], fa_p1sub
  s_branch fa_p1backK
fa_p1stubV:
  s_call_b64 s[76:77], fa_p1sub
  s_branch fa_p1backV
fa_p1sub:
  s_cmp_ge_u32 s28, 5
  s_cbranch_scc1 fa_p1sub5
  s_cmp_eq_u32 s28, 3
  s_cbranch_scc0 fa_p1sub0
  s_mov_b32 s48, s60
  s_mov_b32 s49, s61
  s_mov_b32 s50, s75
  s_lshl_b32 s74, s22, 2
  s_add_u32 s74, s74, s20
  s_lshl_b32 s74, s74, 16
  s_mov_b32 s73, 2097152
fa_p1sub0:
  s_cmp_eq_u32 s28, s71
  s_cselect_b32 s23, s70, 1073741824
  v_mov_b32 v16, 1073741824
  v_mov_b32 v17, 1
  v_writelane_b32 v16, s23, 0
  buffer_store_byte v17, v16, s[56:59], 0 offen sc1
  s_setpc_b64 s[76:77]
fa_p1sub5:
  s_cmp_eq_u32 s28, 6
  s_cbranch_scc1 fa_p1sub6
  v_lshlrev_b32 v229, 2, v1
  buffer_load_dword v15, v229, s[56:59], 0 offen sc1
  s_setpc_b64 s[76:77]
fa_p1sub6:
  v_cmp_ne_u32 vcc, 0x01010101, v15
  s_cbranch_vccnz fa_ln_spin
fa_ln_ok:
  s_mov_b32 s36, s60
  s_mov_b32 s37, s61
  s_mov_b32 s38, s75
  s_lshr_b32 s27, s20, 1
  s_lshl_b32 s27, s27, 18
  s_mov_b32 s25, 524288
  s_mov_b32 s32, s18
  s_mov_b32 s33, s19
  s_mov_b32 s34, 2621440
  s_mov_b32 s26, 0
  s_movk_i32 s79, 1024
  s_lshl_b32 s23, s22, 2
  s_add_u32 s23, s23, s20
  s_mul_i32 s23, s23, 40960
  v_add_u32 v3, s23, v2
  s_sub_u32 s23, 15, s22
  s_lshl_b32 s23, s23, 2
  s_add_u32 s23, s23, s20
  s_mul_i32 s23, s23, 40960
  s_sub_u32 s23, s23, 2048
  v_add_u32 v5, s23, v2
  v_add_u32 v4, 19456, v3
  v_add_u32 v6, 19456, v5
  s_setpc_b64 s[76:77]
fa_kv_spin:
  s_mov_b32 s83, 200000
fa_kv_spin2:
  buffer_load_dword v15, v8, s[40:43], 0 offen sc1
  s_waitcnt vmcnt(0)
  v_cmp_eq_u32 vcc, 0, v15
  s_cbranch_vccz fa_kv_ok
  s_sleep 8
  s_sub_u32 s83, s83, 1
  s_cmp_lg_u32 s83, 0
  s_cbranch_scc1 fa_kv_spin2
  s_branch fa_kv_ok
fa_top8:
  s_cmp_lg_u32 s20, 0
  s_cbranch_scc1 fa_notop
  s_mov_b32 s23, 2621440
  s_mov_b32 s31, 2625536
  buffer_load_dwordx4 v[96:99], v2, s[40:43], s23 offen offset:0 sc1
  buffer_load_dwordx4 v[100:103], v2, s[40:43], s23 offen offset:1024 sc1
  buffer_load_dwordx4 v[104:107], v2, s[40:43], s23 offen offset:2048 sc1
  buffer_load_dwordx4 v[108:111], v2, s[40:43], s23 offen offset:3072 sc1
  buffer_load_dwordx4 v[112:115], v2, s[40:43], s31 offen offset:0 sc1
  buffer_load_dwordx4 v[116:119], v2, s[40:43], s31 offen offset:1024 sc1
  buffer_load_dwordx4 v[120:123], v2, s[40:43], s31 offen offset:2048 sc1
  buffer_load_dwordx4 v[124:127], v2, s[40:43], s31 offen offset:3072 sc1
  v_mov_b32 v21, 0
  v_mov_b32 v22, 0
  v_and_b32 v23, 7, v1
  s_mov_b32 s23, 0
  s_waitcnt vmcnt(0)
fa_top:
  v_max3_u32 v20, v96, v97, v98
  v_max3_u32 v24, v99, v100, v101
  v_max3_u32 v20, v20, v102, v103
  v_max3_u32 v24, v24, v104, v105
  v_max3_u32 v20, v20, v106, v107
  v_max3_u32 v24, v24, v108, v109
  v_max3_u32 v20, v20, v110, v111
  v_max3_u32 v24, v24, v112, v113
  v_max3_u32 v20, v20, v114, v115
  v_max3_u32 v24, v24, v116, v117
  v_max3_u32 v20, v20, v118, v119
  v_max3_u32 v24, v24, v120, v121
  v_max3_u32 v20, v20, v122, v123
  v_max3_u32 v24, v24, v124, v125
  v_max3_u32 v20, v20, v126, v127
  v_max_u32 v20, v20, v24
  s_nop 1
  v_max_u32_dpp v20, v20, v20 quad_perm:[1,0,3,2] row_mask:0xf bank_mask:0xf
  s_nop 1
  v_max_u32_dpp v20, v20, v20 quad_perm:[2,3,0,1] row_mask:0xf bank_mask:0xf
  s_nop 1
  v_max_u32_dpp v20, v20, v20 row_half_mirror row_mask:0xf bank_mask:0xf
  s_nop 1
  v_max_u32_dpp v20, v20, v20 row_mirror row_mask:0xf bank_mask:0xf
  v_mov_b32 v24, v20
  s_nop 1
  v_permlane16_swap_b32 v20, v24
  v_max_u32 v20, v20, v24
  v_mov_b32 v24, v20
  s_nop 1
  v_permlane32_swap_b32 v20, v24
  v_max_u32 v20, v20, v24
  v_add_u32 v21, v21, v20
  v_cmp_eq_u32 vcc, s23, v23
  v_sub_u32 v96, v96, v20
  v_sub_u32 v97, v97, v20
  v_sub_u32 v98, v98, v20
  v_sub_u32 v99, v99, v20
  v_sub_u32 v100, v100, v20
  v_sub_u32 v101, v101, v20
  v_sub_u32 v102, v102, v20
  v_sub_u32 v103, v103, v20
  v_sub_u32 v104, v104, v20
  v_sub_u32 v105, v105, v20
  v_sub_u32 v106, v106, v20
  v_sub_u32 v107, v107, v20
  v_sub_u32 v108, v108, v20
  v_sub_u32 v109, v109, v20
  v_sub_u32 v110, v110, v20
  v_sub_u32 v111, v111, v20
  v_sub_u32 v112, v112, v20
  v_sub_u32 v113, v113, v20
  v_sub_u32 v114, v114, v20
  v_sub_u32 v115, v115, v20
  v_sub_u32 v116, v116, v20
  v_sub_u32 v117, v117, v20
  v_sub_u32 v118, v118, v20
  v_sub_u32 v119, v119, v20
  v_sub_u32 v120, v120, v20
  v_sub_u32 v121, v121, v20
  v_sub_u32 v122, v122, v20
  v_sub_u32 v123, v123, v20
  v_sub_u32 v124, v124, v20
  v_sub_u32 v125, v125, v20
  v_sub_u32 v126, v126, v20
  v_sub_u32 v127, v127, v20
  v_cndmask_b32 v22, v22, v21, vcc
  s_add_u32 s23, s23, 1
  s_cmp_lt_u32 s23, 8
  s_cbranch_scc1 fa_top
  v_and_b32 v25, 0xffff, v22
  v_sub_u32 v25, 0xffff, v25
  v_and_b32 v25, 2047, v25
  v_ashrrev_i32 v20, 31, v22
  v_not_b32 v20, v20
  v_or_b32 v20, 0x80000000, v20
  v_xor_b32 v26, v22, v20
  v_and_b32 v26, 0xffff0000, v26
  v_mul_f32 v26, 0xbfb8aa3b, v26
  v_exp_f32 v26, v26
  s_nop 0
  v_add_f32 v26, 1.0, v26
  v_rcp_f32 v26, v26
  s_nop 0
  v_cvt_pk_bf16_f32 v26, v26, v26
  v_and_b32 v26, 0xffff0000, v26
  v_lshlrev_b32 v20, 2, v1
  v_add_u32 v20, 2629632, v20
  v_mov_b32 v21, 1073741824
  v_cmp_gt_u32 vcc, 16, v1
  v_add_u32 v25, 1, v25
  v_or_b32 v26, 1, v26
  v_cndmask_b32 v20, v21, v20, vcc
  v_cmp_gt_u32 vcc, 8, v1
  s_nop 1
  v_cndmask_b32 v26, v26, v25, vcc
  buffer_store_dword v26, v20, s[40:43], 0 offen sc1
  s_branch fa_notop
fa_hk0:
  s_getpc_b64 s[38:39]
fa_hp0:
  s_add_u32 s36, s36, 4
  s_addc_u32 s37, s37, 0
  s_sub_u32 s38, s38, fa_hp0-fa_hb0
  s_subb_u32 s39, s39, 0
  s_setpc_b64 s[36:37]
fa_hk1:
  s_getpc_b64 s[38:39]
fa_hp1:
  s_add_u32 s36, s36, 4
  s_addc_u32 s37, s37, 0
  s_sub_u32 s38, s38, fa_hp1-fa_hb1
  s_subb_u32 s39, s39, 0
  s_setpc_b64 s[36:37]
fa_sel_spin:
  s_mov_b32 s83, 200000
fa_sel_spin2:
  buffer_load_dword v15, v12, s[40:43], 0 offen sc1
  s_waitcnt vmcnt(0)
  v_cmp_eq_u32 vcc, 0, v15
  s_cbranch_vccz fa_sel_ok
  s_sleep 8
  s_sub_u32 s83, s83, 1
  s_cmp_lg_u32 s83, 0
  s_cbranch_scc1 fa_sel_spin2
  s_branch fa_sel_ok
fa_wof_spin:
  s_mov_b32 s83, 200000
fa_wof_spin2:
  buffer_load_dword v8, v9, s[40:43], 0 offen sc1
  s_waitcnt vmcnt(0)
  v_cmp_eq_u32 vcc, 0, v8
  s_cbranch_vccz fa_wof_ok
  s_sleep 8
  s_sub_u32 s83, s83, 1
  s_cmp_lg_u32 s83, 0
  s_cbranch_scc1 fa_wof_spin2
  s_branch fa_wof_ok
fa_co:
  s_waitcnt vmcnt(8)
  ds_read_b64_tr_b16 v[232:233], v6 offset:0
  ds_read_b64_tr_b16 v[234:235], v6 offset:2560
  ds_read_b64_tr_b16 v[236:237], v6 offset:32
  ds_read_b64_tr_b16 v[238:239], v6 offset:2592
  ds_read_b64_tr_b16 v[240:241], v6 offset:64
  ds_read_b64_tr_b16 v[242:243], v6 offset:2624
  ds_read_b64_tr_b16 v[244:245], v6 offset:96
  ds_read_b64_tr_b16 v[246:247], v6 offset:2656
  ds_read_b64_tr_b16 v[248:249], v6 offset:128
  ds_read_b64_tr_b16 v[250:251], v6 offset:2688
  s_sub_u32 s14, s2, 192
  s_cmp_lt_u32 s14, 54
  s_cbranch_scc1 fa_coF
  s_sub_u32 s14, s2, 64
  s_cmp_lt_u32 s14, 128
  s_cbranch_scc1 fa_coT
  s_getpc_b64 s[36:37]
  s_setpc_b64 s[38:39]
  s_add_u32 s31, s30, 4096
  buffer_store_dwordx4 v[232:235], v2, s[40:43], s30 offen offset:0 sc1
  buffer_store_dwordx4 v[236:239], v2, s[40:43], s30 offen offset:1024 sc1
  buffer_store_dwordx4 v[240:243], v2, s[40:43], s30 offen offset:2048 sc1
  buffer_store_dwordx4 v[244:247], v2, s[40:43], s30 offen offset:3072 sc1
  buffer_store_dwordx4 v[248:251], v2, s[40:43], s31 offen offset:0 sc1
  s_getpc_b64 s[36:37]
  s_setpc_b64 s[38:39]
  s_getpc_b64 s[36:37]
  s_setpc_b64 s[38:39]
  s_and_b32 s23, s2, 1
  s_lshl_b32 s23, s23, 2
  s_add_u32 s23, s23, s20
  s_lshl_b32 s23, s23, 7
  s_lshr_b32 s31, s2, 1
  s_add_u32 s23, s23, s31
  s_lshl_b32 s23, s23, 2
  s_add_u32 s23, s23, 2654208
  v_mov_b32 v16, 1073741824
  v_mov_b32 v17, 1
  v_writelane_b32 v16, s23, 0
  s_waitcnt vmcnt(8)
  buffer_store_dword v17, v16, s[40:43], 0 offen sc1
  s_branch fa_coW
fa_coT:
  v_min_u32 v8, 16, v1
  v_lshlrev_b32 v8, 7, v8
  s_lshl_b32 s33, s14, 1
  s_and_b32 s31, s20, 1
  s_add_u32 s33, s33, s31
  s_mul_i32 s33, s33, 2176
  s_lshl_b32 s35, s14, 2
  s_add_u32 s35, s35, s20
  s_mul_i32 s35, s35, 4352
  buffer_load_dword v255, v8, s[52:55], s33 offen
  s_add_u32 s33, s33, 552960
  s_getpc_b64 s[36:37]
  s_setpc_b64 s[38:39]
  s_add_u32 s31, s30, 4096
  buffer_store_dwordx4 v[232:235], v2, s[40:43], s30 offen offset:0 sc1
  buffer_store_dwordx4 v[236:239], v2, s[40:43], s30 offen offset:1024 sc1
  buffer_store_dwordx4 v[240:243], v2, s[40:43], s30 offen offset:2048 sc1
  buffer_store_dwordx4 v[244:247], v2, s[40:43], s30 offen offset:3072 sc1
  buffer_store_dwordx4 v[248:251], v2, s[40:43], s31 offen offset:0 sc1
  buffer_load_dword v255, v8, s[52:55], s33 offen
  s_add_u32 s33, s33, 552960
  s_getpc_b64 s[36:37]
  s_setpc_b64 s[38:39]
  buffer_load_dword v255, v8, s[52:55], s33 offen
  s_add_u32 s33, s33, 552960
  s_getpc_b64 s[36:37]
  s_setpc_b64 s[38:39]
  s_and_b32 s23, s2, 1
  s_lshl_b32 s23, s23, 2
  s_add_u32 s23, s23, s20
  s_lshl_b32 s23, s23, 7
  s_lshr_b32 s31, s2, 1
  s_add_u32 s23, s23, s31
  s_lshl_b32 s23, s23, 2
  s_add_u32 s23, s23, 2654208
  v_mov_b32 v16, 1073741824
  v_mov_b32 v17, 1
  v_writelane_b32 v16, s23, 0
  s_waitcnt vmcnt(10)
  buffer_store_dword v17, v16, s[40:43], 0 offen sc1
  buffer_load_dword v255, v8, s[52:55], s33 offen
  s_add_u32 s33, s33, 552960
  s_getpc_b64 s[36:37]
  s_setpc_b64 s[38:39]
  buffer_load_dword v255, v8, s[60:63], s35 offen
  s_getpc_b64 s[36:37]
  s_setpc_b64 s[38:39]
  buffer_load_dword v255, v8, s[60:63], s35 offen offset:2176
  s_branch fa_coW
fa_coF:
  s_getpc_b64 s[36:37]
  s_setpc_b64 s[38:39]
  s_add_u32 s31, s30, 4096
  buffer_store_dwordx4 v[232:235], v2, s[40:43], s30 offen offset:0 sc1
  buffer_store_dwordx4 v[236:239], v2, s[40:43], s30 offen offset:1024 sc1
  buffer_store_dwordx4 v[240:243], v2, s[40:43], s30 offen offset:2048 sc1
  buffer_store_dwordx4 v[244:247], v2, s[40:43], s30 offen offset:3072 sc1
  buffer_store_dwordx4 v[248:251], v2, s[40:43], s31 offen offset:0 sc1
  s_lshl_b32 s33, s14, 6
  s_and_b32 s31, s20, 1
  s_lshl_b32 s31, s31, 5
  s_add_u32 s33, s33, s31
  s_mul_i32 s35, s14, 40960
  s_mul_i32 s31, s20, 320
  s_add_u32 s35, s35, s31
  s_mul_i32 s10, s14, 20480
  s_mul_i32 s31, s20, 640
  s_add_u32 s10, s10, s31
  s_add_u32 s10, s10, 2686976
  s_getpc_b64 s[36:37]
  s_setpc_b64 s[38:39]
  v_and_b32 v11, 7, v1
  v_lshlrev_b32 v12, 2, v11
  v_add_u32 v12, 2629632, v12
  buffer_load_dword v15, v12, s[40:43], 0 offen sc1
  v_lshrrev_b32 v17, 1, v1
  v_mul_u32_u24 v8, 3456, v17
  v_and_b32 v17, 1, v1
  v_lshl_add_u32 v8, v17, 4, v8
  v_lshrrev_b32 v17, 4, v1
  v_lshrrev_b32 v18, 2, v1
  v_lshl_add_u32 v18, v17, 2, v18
  v_lshlrev_b32 v18, 5, v18
  v_and_b32 v19, 3, v1
  v_lshl_add_u32 v9, v19, 3, v18
  v_add_u32 v9, s34, v9
  v_lshlrev_b32 v10, 4, v11
  v_lshl_add_u32 v10, v17, 7, v10
  v_add_u32 v10, 151552, v10
  v_and_b32 v18, 8, v1
  v_mul_u32_u24 v11, 2560, v11
  v_lshl_add_u32 v11, v17, 4, v11
  v_lshl_add_u32 v11, v18, 27, v11
  s_getpc_b64 s[36:37]
  s_setpc_b64 s[38:39]
  s_and_b32 s23, s2, 1
  s_lshl_b32 s23, s23, 2
  s_add_u32 s23, s23, s20
  s_lshl_b32 s23, s23, 7
  s_lshr_b32 s31, s2, 1
  s_add_u32 s23, s23, s31
  s_lshl_b32 s23, s23, 2
  s_add_u32 s23, s23, 2654208
  v_mov_b32 v16, 1073741824
  v_mov_b32 v17, 1
  v_writelane_b32 v16, s23, 0
  s_waitcnt vmcnt(9)
  buffer_store_dword v17, v16, s[40:43], 0 offen sc1
  s_add_u32 m0, s34, 0
  s_nop 0
  buffer_load_dwordx4 v8, s[52:55], s33 offen lds
  s_add_u32 s33, s33, 110592
  s_add_u32 m0, s34, 1024
  s_nop 0
  buffer_load_dwordx4 v8, s[52:55], s33 offen lds
  s_add_u32 s33, s33, 110592
  s_add_u32 m0, s34, 2048
  s_nop 0
  buffer_load_dwordx4 v8, s[52:55], s33 offen lds
  s_add_u32 s33, s33, 110592
  s_add_u32 m0, s34, 3072
  s_nop 0
  buffer_load_dwordx4 v8, s[52:55], s33 offen lds
  s_add_u32 s33, s33, 110592
  s_add_u32 m0, s34, 4096
  s_nop 0
  buffer_load_dwordx4 v8, s[52:55], s33 offen lds
  s_add_u32 s33, s33, 110592
  s_getpc_b64 s[36:37]
  s_setpc_b64 s[38:39]
  s_waitcnt vmcnt(14)
  v_cmp_eq_u32 vcc, 0, v15
  s_cbranch_vccnz fa_sel_spin
fa_sel_ok:
  v_add_u32 v18, -1, v15
  v_and_b32 v18, 2047, v18
  v_lshrrev_b32 v19, 4, v18
  v_mul_u32_u24 v19, 20480, v19
  v_and_b32 v18, 15, v18
  v_lshl_add_u32 v19, v18, 4, v19
  v_lshrrev_b32 v18, 3, v1
  v_lshl_add_u32 v19, v18, 8, v19
  s_lshl_b32 s23, s20, 11
  s_lshl_b32 s31, s20, 10
  s_add_u32 s31, s31, 151552
  s_mov_b32 m0, s31
  s_add_u32 s31, s31, 4096
  buffer_load_dwordx4 v19, s[40:43], s23 offen sc1 lds
  s_add_u32 s23, s23, 8192
  s_mov_b32 m0, s31
  s_add_u32 s31, s31, 4096
  buffer_load_dwordx4 v19, s[40:43], s23 offen sc1 lds
  s_add_u32 s23, s23, 8192
  s_mov_b32 m0, s31
  s_add_u32 s31, s31, 4096
  buffer_load_dwordx4 v19, s[40:43], s23 offen sc1 lds
  s_add_u32 s23, s23, 8192
  s_getpc_b64 s[36:37]
  s_setpc_b64 s[38:39]
  s_waitcnt vmcnt(4)
  s_getpc_b64 s[36:37]
  s_setpc_b64 s[38:39]
  ds_read_b64_tr_b16 a[192:193], v9 offset:0
  ds_read_b64_tr_b16 a[194:195], v9 offset:128
  ds_read_b128 a[212:215], v10 offset:0
  ds_read_b64_tr_b16 a[196:197], v9 offset:1024
  ds_read_b64_tr_b16 a[198:199], v9 offset:1152
  ds_read_b128 a[216:219], v10 offset:512
  ds_read_b64_tr_b16 a[200:201], v9 offset:2048
  ds_read_b64_tr_b16 a[202:203], v9 offset:2176
  ds_read_b128 a[220:223], v10 offset:1024
  ds_read_b64_tr_b16 a[204:205], v9 offset:3072
  ds_read_b64_tr_b16 a[206:207], v9 offset:3200
  ds_read_b128 a[224:227], v10 offset:1536
  ds_read_b64_tr_b16 a[208:209], v9 offset:4096
  ds_read_b64_tr_b16 a[210:211], v9 offset:4224
  ds_read_b128 a[228:231], v10 offset:2048
  s_getpc_b64 s[36:37]
  s_setpc_b64 s[38:39]
  v_mfma_f32_16x16x32_bf16 v[232:235], a[192:195], a[212:215], 0
  v_mfma_f32_16x16x32_bf16 v[232:235], a[196:199], a[216:219], v[232:235]
  v_mfma_f32_16x16x32_bf16 v[232:235], a[200:203], a[220:223], v[232:235]
  v_mfma_f32_16x16x32_bf16 v[232:235], a[204:207], a[224:227], v[232:235]
  v_mfma_f32_16x16x32_bf16 v[232:235], a[208:211], a[228:231], v[232:235]
  s_add_u32 m0, s34, 0
  s_nop 0
  buffer_load_dwordx4 v8, s[52:55], s33 offen lds
  s_add_u32 s33, s33, 110592
  s_add_u32 m0, s34, 1024
  s_nop 0
  buffer_load_dwordx4 v8, s[52:55], s33 offen lds
  s_add_u32 s33, s33, 110592
  s_add_u32 m0, s34, 2048
  s_nop 0
  buffer_load_dwordx4 v8, s[52:55], s33 offen lds
  s_add_u32 s33, s33, 110592
  s_add_u32 m0, s34, 3072
  s_nop 0
  buffer_load_dwordx4 v8, s[52:55], s33 offen lds
  s_add_u32 s33, s33, 110592
  s_add_u32 m0, s34, 4096
  s_nop 0
  buffer_load_dwordx4 v8, s[52:55], s33 offen lds
  s_add_u32 s33, s33, 110592
  s_getpc_b64 s[36:37]
  s_setpc_b64 s[38:39]
  s_getpc_b64 s[36:37]
  s_setpc_b64 s[38:39]
  s_waitcnt vmcnt(8)
  ds_read_b64_tr_b16 a[192:193], v9 offset:0
  ds_read_b64_tr_b16 a[194:195], v9 offset:128
  ds_read_b128 a[212:215], v10 offset:2560
  ds_read_b64_tr_b16 a[196:197], v9 offset:1024
  ds_read_b64_tr_b16 a[198:199], v9 offset:1152
  ds_read_b128 a[216:219], v10 offset:3072
  ds_read_b64_tr_b16 a[200:201], v9 offset:2048
  ds_read_b64_tr_b16 a[202:203], v9 offset:2176
  ds_read_b128 a[220:223], v10 offset:3584
  ds_read_b64_tr_b16 a[204:205], v9 offset:3072
  ds_read_b64_tr_b16 a[206:207], v9 offset:3200
  ds_read_b128 a[224:227], v10 offset:4096
  ds_read_b64_tr_b16 a[208:209], v9 offset:4096
  ds_read_b64_tr_b16 a[210:211], v9 offset:4224
  ds_read_b128 a[228:231], v10 offset:4608
  s_getpc_b64 s[36:37]
  s_setpc_b64 s[38:39]
  v_mfma_f32_16x16x32_bf16 v[232:235], a[192:195], a[212:215], v[232:235]
  v_mfma_f32_16x16x32_bf16 v[232:235], a[196:199], a[216:219], v[232:235]
  v_mfma_f32_16x16x32_bf16 v[232:235], a[200:203], a[220:223], v[232:235]
  v_mfma_f32_16x16x32_bf16 v[232:235], a[204:207], a[224:227], v[232:235]
  v_mfma_f32_16x16x32_bf16 v[232:235], a[208:211], a[228:231], v[232:235]
  s_add_u32 m0, s34, 0
  s_nop 0
  buffer_load_dwordx4 v8, s[52:55], s33 offen lds
  s_add_u32 s33, s33, 110592
  s_add_u32 m0, s34, 1024
  s_nop 0
  buffer_load_dwordx4 v8, s[52:55], s33 offen lds
  s_add_u32 s33, s33, 110592
  s_add_u32 m0, s34, 2048
  s_nop 0
  buffer_load_dwordx4 v8, s[52:55], s33 offen lds
  s_add_u32 s33, s33, 110592
  s_add_u32 m0, s34, 3072
  s_nop 0
  buffer_load_dwordx4 v8, s[52:55], s33 offen lds
  s_add_u32 s33, s33, 110592
  s_add_u32 m0, s34, 4096
  s_nop 0
  buffer_load_dwordx4 v8, s[52:55], s33 offen lds
  s_add_u32 s33, s33, 110592
  s_getpc_b64 s[36:37]
  s_setpc_b64 s[38:39]
  s_getpc_b64 s[36:37]
  s_setpc_b64 s[38:39]
  s_waitcnt vmcnt(8)
  ds_read_b64_tr_b16 a[192:193], v9 offset:0
  ds_read_b64_tr_b16 a[194:195], v9 offset:128
  ds_read_b128 a[212:215], v10 offset:5120
  ds_read_b64_tr_b16 a[196:197], v9 offset:1024
  ds_read_b64_tr_b16 a[198:199], v9 offset:1152
  ds_read_b128 a[216:219], v10 offset:5632
  ds_read_b64_tr_b16 a[200:201], v9 offset:2048
  ds_read_b64_tr_b16 a[202:203], v9 offset:2176
  ds_read_b128 a[220:223], v10 offset:6144
  ds_read_b64_tr_b16 a[204:205], v9 offset:3072
  ds_read_b64_tr_b16 a[206:207], v9 offset:3200
  ds_read_b128 a[224:227], v10 offset:6656
  ds_read_b64_tr_b16 a[208:209], v9 offset:4096
  ds_read_b64_tr_b16 a[210:211], v9 offset:4224
  ds_read_b128 a[228:231], v10 offset:7168
  s_getpc_b64 s[36:37]
  s_setpc_b64 s[38:39]
  v_mfma_f32_16x16x32_bf16 v[232:235], a[192:195], a[212:215], v[232:235]
  v_mfma_f32_16x16x32_bf16 v[232:235], a[196:199], a[216:219], v[232:235]
  v_mfma_f32_16x16x32_bf16 v[232:235], a[200:203], a[220:223], v[232:235]
  v_mfma_f32_16x16x32_bf16 v[232:235], a[204:207], a[224:227], v[232:235]
  v_mfma_f32_16x16x32_bf16 v[232:235], a[208:211], a[228:231], v[232:235]
  s_add_u32 m0, s34, 0
  s_nop 0
  buffer_load_dwordx4 v8, s[52:55], s33 offen lds
  s_add_u32 s33, s33, 110592
  s_add_u32 m0, s34, 1024
  s_nop 0
  buffer_load_dwordx4 v8, s[52:55], s33 offen lds
  s_add_u32 s33, s33, 110592
  s_add_u32 m0, s34, 2048
  s_nop 0
  buffer_load_dwordx4 v8, s[52:55], s33 offen lds
  s_add_u32 s33, s33, 110592
  s_add_u32 m0, s34, 3072
  s_nop 0
  buffer_load_dwordx4 v8, s[52:55], s33 offen lds
  s_add_u32 s33, s33, 110592
  s_add_u32 m0, s34, 4096
  s_nop 0
  buffer_load_dwordx4 v8, s[52:55], s33 offen lds
  s_add_u32 s33, s33, 110592
  s_getpc_b64 s[36:37]
  s_setpc_b64 s[38:39]
  s_getpc_b64 s[36:37]
  s_setpc_b64 s[38:39]
  s_waitcnt vmcnt(8)
  ds_read_b64_tr_b16 a[192:193], v9 offset:0
  ds_read_b64_tr_b16 a[194:195], v9 offset:128
  ds_read_b128 a[212:215], v10 offset:7680
  ds_read_b64_tr_b16 a[196:197], v9 offset:1024
  ds_read_b64_tr_b16 a[198:199], v9 offset:1152
  ds_read_b128 a[216:219], v10 offset:8192
  ds_read_b64_tr_b16 a[200:201], v9 offset:2048
  ds_read_b64_tr_b16 a[202:203], v9 offset:2176
  ds_read_b128 a[220:223], v10 offset:8704
  ds_read_b64_tr_b16 a[204:205], v9 offset:3072
  ds_read_b64_tr_b16 a[206:207], v9 offset:3200
  ds_read_b128 a[224:227], v10 offset:9216
  ds_read_b64_tr_b16 a[208:209], v9 offset:4096
  ds_read_b64_tr_b16 a[210:211], v9 offset:4224
  ds_read_b128 a[228:231], v10 offset:9728
  s_getpc_b64 s[36:37]
  s_setpc_b64 s[38:39]
  v_mfma_f32_16x16x32_bf16 v[232:235], a[192:195], a[212:215], v[232:235]
  v_mfma_f32_16x16x32_bf16 v[232:235], a[196:199], a[216:219], v[232:235]
  v_mfma_f32_16x16x32_bf16 v[232:235], a[200:203], a[220:223], v[232:235]
  v_mfma_f32_16x16x32_bf16 v[232:235], a[204:207], a[224:227], v[232:235]
  v_mfma_f32_16x16x32_bf16 v[232:235], a[208:211], a[228:231], v[232:235]
  s_add_u32 m0, s34, 0
  v_accvgpr_read_b32 v19, a248
  buffer_load_dwordx4 v19, s[60:63], s35 offen lds
  s_add_u32 m0, s34, 1024
  v_accvgpr_read_b32 v19, a249
  buffer_load_dwordx4 v19, s[60:63], s35 offen lds
  s_add_u32 m0, s34, 2048
  v_accvgpr_read_b32 v19, a250
  buffer_load_dwordx4 v19, s[60:63], s35 offen lds
  s_add_u32 m0, s34, 3072
  v_accvgpr_read_b32 v19, a251
  buffer_load_dwordx4 v19, s[60:63], s35 offen lds
  s_add_u32 m0, s34, 4096
  v_accvgpr_read_b32 v19, a252
  buffer_load_dwordx4 v19, s[60:63], s35 offen lds
  s_add_u32 s35, s35, 160
  s_lshl_b32 s23, s20, 9
  v_add_u32 v16, s23, v10
  ds_write_b128 v16, v[232:235] offset:10240
  s_getpc_b64 s[36:37]
  s_setpc_b64 s[38:39]
  s_getpc_b64 s[36:37]
  s_setpc_b64 s[38:39]
  ds_read_b128 v[236:239], v10 offset:10240
  ds_read_b128 v[240:243], v10 offset:10752
  ds_read_b128 v[244:247], v10 offset:11264
  ds_read_b128 v[248:251], v10 offset:11776
  s_waitcnt vmcnt(8)
  ds_read_b64_tr_b16 a[192:193], v6 offset:0
  ds_read_b64_tr_b16 a[194:195], v6 offset:2560
  ds_read_b64_tr_b16 a[196:197], v6 offset:32
  ds_read_b64_tr_b16 a[198:199], v6 offset:2592
  ds_read_b64_tr_b16 a[200:201], v6 offset:64
  ds_read_b64_tr_b16 a[202:203], v6 offset:2624
  ds_read_b64_tr_b16 a[204:205], v6 offset:96
  ds_read_b64_tr_b16 a[206:207], v6 offset:2656
  ds_read_b64_tr_b16 a[208:209], v6 offset:128
  ds_read_b64_tr_b16 a[210:211], v6 offset:2688
  s_getpc_b64 s[36:37]
  s_setpc_b64 s[38:39]
  v_cvt_pk_bf16_f32 v236, v236, v244
  v_cvt_pk_bf16_f32 v237, v237, v245
  v_cvt_pk_bf16_f32 v238, v238, v246
  v_cvt_pk_bf16_f32 v239, v239, v247
  v_cvt_pk_bf16_f32 v240, v240, v248
  v_cvt_pk_bf16_f32 v241, v241, v249
  v_cvt_pk_bf16_f32 v242, v242, v250
  v_cvt_pk_bf16_f32 v243, v243, v251
  v_lshlrev_b32 v244, 16, v236
  v_lshlrev_b32 v245, 16, v237
  v_lshlrev_b32 v246, 16, v238
  v_lshlrev_b32 v247, 16, v239
  v_lshlrev_b32 v248, 16, v240
  v_lshlrev_b32 v249, 16, v241
  v_lshlrev_b32 v250, 16, v242
  v_lshlrev_b32 v251, 16, v243
  v_mul_f32 v16, 0xbfb8aa3b, v244
  v_mul_f32 v17, 0xbfb8aa3b, v245
  v_mul_f32 v18, 0xbfb8aa3b, v246
  v_mul_f32 v19, 0xbfb8aa3b, v247
  v_mul_f32 v20, 0xbfb8aa3b, v248
  v_mul_f32 v21, 0xbfb8aa3b, v249
  v_mul_f32 v22, 0xbfb8aa3b, v250
  v_mul_f32 v23, 0xbfb8aa3b, v251
  v_exp_f32 v16, v16
  v_exp_f32 v17, v17
  v_exp_f32 v18, v18
  v_exp_f32 v19, v19
  v_exp_f32 v20, v20
  v_exp_f32 v21, v21
  v_exp_f32 v22, v22
  v_exp_f32 v23, v23
  v_add_f32 v16, 1.0, v16
  v_add_f32 v17, 1.0, v17
  v_add_f32 v18, 1.0, v18
  v_add_f32 v19, 1.0, v19
  v_add_f32 v20, 1.0, v20
  v_add_f32 v21, 1.0, v21
  v_add_f32 v22, 1.0, v22
  v_add_f32 v23, 1.0, v23
  v_rcp_f32 v16, v16
  v_rcp_f32 v17, v17
  v_rcp_f32 v18, v18
  v_rcp_f32 v19, v19
  v_rcp_f32 v20, v20
  v_rcp_f32 v21, v21
  v_rcp_f32 v22, v22
  v_rcp_f32 v23, v23
  v_mul_f32 v244, v244, v16
  v_mul_f32 v245, v245, v17
  v_mul_f32 v246, v246, v18
  v_mul_f32 v247, v247, v19
  v_mul_f32 v248, v248, v20
  v_mul_f32 v249, v249, v21
  v_mul_f32 v250, v250, v22
  v_mul_f32 v251, v251, v23
  v_cvt_pk_bf16_f32 v16, v244, v245
  v_cvt_pk_bf16_f32 v17, v246, v247
  v_cvt_pk_bf16_f32 v18, v248, v249
  v_cvt_pk_bf16_f32 v19, v250, v251
  v_and_b32 v236, 0xffff0000, v236
  v_and_b32 v237, 0xffff0000, v237
  v_and_b32 v238, 0xffff0000, v238
  v_and_b32 v239, 0xffff0000, v239
  v_and_b32 v240, 0xffff0000, v240
  v_and_b32 v241, 0xffff0000, v241
  v_and_b32 v242, 0xffff0000, v242
  v_and_b32 v243, 0xffff0000, v243
  v_lshlrev_b32 v244, 16, v16
  v_and_b32 v245, 0xffff0000, v16
  v_lshlrev_b32 v246, 16, v17
  v_and_b32 v247, 0xffff0000, v17
  v_lshlrev_b32 v248, 16, v18
  v_and_b32 v249, 0xffff0000, v18
  v_lshlrev_b32 v250, 16, v19
  v_and_b32 v251, 0xffff0000, v19
  v_mul_f32 v236, v236, v244
  v_mul_f32 v237, v237, v245
  v_mul_f32 v238, v238, v246
  v_mul_f32 v239, v239, v247
  v_mul_f32 v240, v240, v248
  v_mul_f32 v241, v241, v249
  v_mul_f32 v242, v242, v250
  v_mul_f32 v243, v243, v251
  v_cvt_pk_bf16_f32 v232, v236, v237
  v_cvt_pk_bf16_f32 v233, v238, v239
  v_cvt_pk_bf16_f32 v234, v240, v241
  v_cvt_pk_bf16_f32 v235, v242, v243
  s_nop 1
  v_mfma_f32_16x16x32_bf16 v[236:239], a[192:195], v[232:235], 0
  v_mfma_f32_16x16x32_bf16 v[240:243], a[196:199], v[232:235], 0
  v_mfma_f32_16x16x32_bf16 v[244:247], a[200:203], v[232:235], 0
  v_mfma_f32_16x16x32_bf16 v[248:251], a[204:207], v[232:235], 0
  v_mfma_f32_16x16x32_bf16 v[252:255], a[208:211], v[232:235], 0
  s_add_u32 m0, s34, 0
  v_accvgpr_read_b32 v19, a248
  buffer_load_dwordx4 v19, s[60:63], s35 offen lds
  s_add_u32 m0, s34, 1024
  v_accvgpr_read_b32 v19, a249
  buffer_load_dwordx4 v19, s[60:63], s35 offen lds
  s_add_u32 m0, s34, 2048
  v_accvgpr_read_b32 v19, a250
  buffer_load_dwordx4 v19, s[60:63], s35 offen lds
  s_add_u32 m0, s34, 3072
  v_accvgpr_read_b32 v19, a251
  buffer_load_dwordx4 v19, s[60:63], s35 offen lds
  s_add_u32 m0, s34, 4096
  v_accvgpr_read_b32 v19, a252
  buffer_load_dwordx4 v19, s[60:63], s35 offen lds
  s_add_u32 s35, s35, 160
  buffer_store_dwordx4 v[236:239], v11, s[40:43], s10 offen offset:0 sc1
  buffer_store_dwordx4 v[240:243], v11, s[40:43], s10 offen offset:64 sc1
  buffer_store_dwordx4 v[244:247], v11, s[40:43], s10 offen offset:128 sc1
  buffer_store_dwordx4 v[248:251], v11, s[40:43], s10 offen offset:192 sc1
  buffer_store_dwordx4 v[252:255], v11, s[40:43], s10 offen offset:256 sc1
  s_add_u32 s10, s10, 320
  s_getpc_b64 s[36:37]
  s_setpc_b64 s[38:39]
  s_getpc_b64 s[36:37]
  s_setpc_b64 s[38:39]
  s_waitcnt vmcnt(13)
  ds_read_b64_tr_b16 a[192:193], v6 offset:0
  ds_read_b64_tr_b16 a[194:195], v6 offset:2560
  ds_read_b64_tr_b16 a[196:197], v6 offset:32
  ds_read_b64_tr_b16 a[198:199], v6 offset:2592
  ds_read_b64_tr_b16 a[200:201], v6 offset:64
  ds_read_b64_tr_b16 a[202:203], v6 offset:2624
  ds_read_b64_tr_b16 a[204:205], v6 offset:96
  ds_read_b64_tr_b16 a[206:207], v6 offset:2656
  ds_read_b64_tr_b16 a[208:209], v6 offset:128
  ds_read_b64_tr_b16 a[210:211], v6 offset:2688
  s_waitcnt lgkmcnt(0)
  v_mfma_f32_16x16x32_bf16 v[236:239], a[192:195], v[232:235], 0
  v_mfma_f32_16x16x32_bf16 v[240:243], a[196:199], v[232:235], 0
  v_mfma_f32_16x16x32_bf16 v[244:247], a[200:203], v[232:235], 0
  v_mfma_f32_16x16x32_bf16 v[248:251], a[204:207], v[232:235], 0
  v_mfma_f32_16x16x32_bf16 v[252:255], a[208:211], v[232:235], 0
  s_nop 7
  buffer_store_dwordx4 v[236:239], v11, s[40:43], s10 offen offset:0 sc1
  buffer_store_dwordx4 v[240:243], v11, s[40:43], s10 offen offset:64 sc1
  buffer_store_dwordx4 v[244:247], v11, s[40:43], s10 offen offset:128 sc1
  buffer_store_dwordx4 v[248:251], v11, s[40:43], s10 offen offset:192 sc1
  buffer_store_dwordx4 v[252:255], v11, s[40:43], s10 offen offset:256 sc1
  s_add_u32 s10, s10, 320
  s_getpc_b64 s[36:37]
  s_setpc_b64 s[38:39]
  s_and_b32 s23, s2, 63
  s_lshl_b32 s31, s20, 6
  s_add_u32 s23, s23, s31
  s_lshl_b32 s23, s23, 2
  s_add_u32 s23, s23, 2650112
  v_mov_b32 v16, 1073741824
  v_mov_b32 v17, 1
  v_writelane_b32 v16, s23, 0
  s_waitcnt vmcnt(4)
  buffer_store_dword v17, v16, s[40:43], 0 offen sc1
fa_coW:
  s_mov_b32 s12, 1
  s_cmp_lg_u32 s11, 0
  s_cselect_b32 s32, s15, -1
  s_getpc_b64 s[36:37]
  s_setpc_b64 s[38:39]
  s_lshl_b32 s23, s22, 2
  s_add_u32 s23, s23, s20
  s_mul_i32 s13, s23, 163840
  s_add_u32 s13, s13, 4194304
  s_lshl_b32 s23, s23, 7
  s_add_u32 s23, s23, 2654208
  v_and_b32 v9, 31, v1
  v_lshl_add_u32 v9, v9, 2, s23
  buffer_load_dword v8, v9, s[40:43], 0 offen sc1
  v_mov_b32 v20, v228
  v_mov_b32 v21, v229
  s_nop 1
  v_permlane16_swap_b32 v228, v20
  v_permlane16_swap_b32 v229, v21
  v_add_f32 v228, v228, v20
  v_add_f32 v229, v229, v21
  v_mov_b32 v20, v228
  v_mov_b32 v21, v229
  s_nop 1
  v_permlane32_swap_b32 v228, v20
  v_permlane32_swap_b32 v229, v21
  v_add_f32 v228, v228, v20
  v_add_f32 v229, v229, v21
  v_rcp_f32 v16, v228
  v_rcp_f32 v18, v229
  s_lshl_b32 s23, s22, 2
  v_mov_b32 v17, v16
  v_mov_b32 v19, v18
  s_add_u32 s23, s23, s20
  s_lshl_b32 s23, s23, 18
  s_lshl_b32 s31, s21, 12
  s_add_u32 s31, s31, 50331648
  s_add_u32 s64, s23, s31
  s_add_u32 s65, s64, 131072
  v_accvgpr_read_b32 v36, a0
  v_accvgpr_read_b32 v37, a1
  v_accvgpr_read_b32 v38, a2
  v_accvgpr_read_b32 v39, a3
  v_accvgpr_read_b32 v40, a8
  v_accvgpr_read_b32 v41, a9
  v_accvgpr_read_b32 v42, a10
  v_accvgpr_read_b32 v43, a11
  v_pk_mul_f32 v[36:37], v[36:37], v[16:17]
  v_pk_mul_f32 v[38:39], v[38:39], v[16:17]
  v_pk_mul_f32 v[40:41], v[40:41], v[16:17]
  v_pk_mul_f32 v[42:43], v[42:43], v[16:17]
  v_cvt_pk_bf16_f32 v32, v36, v37
  v_cvt_pk_bf16_f32 v33, v38, v39
  v_cvt_pk_bf16_f32 v34, v40, v41
  v_cvt_pk_bf16_f32 v35, v42, v43
  buffer_store_dwordx4 v[32:35], v2, s[40:43], s64 offen offset:0 sc1
  v_accvgpr_read_b32 v48, a16
  v_accvgpr_read_b32 v49, a17
  v_accvgpr_read_b32 v50, a18
  v_accvgpr_read_b32 v51, a19
  v_accvgpr_read_b32 v52, a24
  v_accvgpr_read_b32 v53, a25
  v_accvgpr_read_b32 v54, a26
  v_accvgpr_read_b32 v55, a27
  v_pk_mul_f32 v[48:49], v[48:49], v[16:17]
  v_pk_mul_f32 v[50:51], v[50:51], v[16:17]
  v_pk_mul_f32 v[52:53], v[52:53], v[16:17]
  v_pk_mul_f32 v[54:55], v[54:55], v[16:17]
  v_cvt_pk_bf16_f32 v44, v48, v49
  v_cvt_pk_bf16_f32 v45, v50, v51
  v_cvt_pk_bf16_f32 v46, v52, v53
  v_cvt_pk_bf16_f32 v47, v54, v55
  buffer_store_dwordx4 v[44:47], v2, s[40:43], s64 offen offset:1024 sc1
  v_accvgpr_read_b32 v100, a32
  v_accvgpr_read_b32 v101, a33
  v_accvgpr_read_b32 v102, a34
  v_accvgpr_read_b32 v103, a35
  v_accvgpr_read_b32 v104, a40
  v_accvgpr_read_b32 v105, a41
  v_accvgpr_read_b32 v106, a42
  v_accvgpr_read_b32 v107, a43
  v_pk_mul_f32 v[100:101], v[100:101], v[16:17]
  v_pk_mul_f32 v[102:103], v[102:103], v[16:17]
  v_pk_mul_f32 v[104:105], v[104:105], v[16:17]
  v_pk_mul_f32 v[106:107], v[106:107], v[16:17]
  v_cvt_pk_bf16_f32 v96, v100, v101
  v_cvt_pk_bf16_f32 v97, v102, v103
  v_cvt_pk_bf16_f32 v98, v104, v105
  v_cvt_pk_bf16_f32 v99, v106, v107
  buffer_store_dwordx4 v[96:99], v2, s[40:43], s64 offen offset:2048 sc1
  v_accvgpr_read_b32 v112, a48
  v_accvgpr_read_b32 v113, a49
  v_accvgpr_read_b32 v114, a50
  v_accvgpr_read_b32 v115, a51
  v_accvgpr_read_b32 v116, a56
  v_accvgpr_read_b32 v117, a57
  v_accvgpr_read_b32 v118, a58
  v_accvgpr_read_b32 v119, a59
  v_pk_mul_f32 v[112:113], v[112:113], v[16:17]
  v_pk_mul_f32 v[114:115], v[114:115], v[16:17]
  v_pk_mul_f32 v[116:117], v[116:117], v[16:17]
  v_pk_mul_f32 v[118:119], v[118:119], v[16:17]
  v_cvt_pk_bf16_f32 v108, v112, v113
  v_cvt_pk_bf16_f32 v109, v114, v115
  v_cvt_pk_bf16_f32 v110, v116, v117
  v_cvt_pk_bf16_f32 v111, v118, v119
  buffer_store_dwordx4 v[108:111], v2, s[40:43], s64 offen offset:3072 sc1
  v_accvgpr_read_b32 v36, a4
  v_accvgpr_read_b32 v37, a5
  v_accvgpr_read_b32 v38, a6
  v_accvgpr_read_b32 v39, a7
  v_accvgpr_read_b32 v40, a12
  v_accvgpr_read_b32 v41, a13
  v_accvgpr_read_b32 v42, a14
  v_accvgpr_read_b32 v43, a15
  v_pk_mul_f32 v[36:37], v[36:37], v[18:19]
  v_pk_mul_f32 v[38:39], v[38:39], v[18:19]
  v_pk_mul_f32 v[40:41], v[40:41], v[18:19]
  v_pk_mul_f32 v[42:43], v[42:43], v[18:19]
  v_cvt_pk_bf16_f32 v32, v36, v37
  v_cvt_pk_bf16_f32 v33, v38, v39
  v_cvt_pk_bf16_f32 v34, v40, v41
  v_cvt_pk_bf16_f32 v35, v42, v43
  buffer_store_dwordx4 v[32:35], v2, s[40:43], s65 offen offset:0 sc1
  v_accvgpr_read_b32 v48, a20
  v_accvgpr_read_b32 v49, a21
  v_accvgpr_read_b32 v50, a22
  v_accvgpr_read_b32 v51, a23
  v_accvgpr_read_b32 v52, a28
  v_accvgpr_read_b32 v53, a29
  v_accvgpr_read_b32 v54, a30
  v_accvgpr_read_b32 v55, a31
  v_pk_mul_f32 v[48:49], v[48:49], v[18:19]
  v_pk_mul_f32 v[50:51], v[50:51], v[18:19]
  v_pk_mul_f32 v[52:53], v[52:53], v[18:19]
  v_pk_mul_f32 v[54:55], v[54:55], v[18:19]
  v_cvt_pk_bf16_f32 v44, v48, v49
  v_cvt_pk_bf16_f32 v45, v50, v51
  v_cvt_pk_bf16_f32 v46, v52, v53
  v_cvt_pk_bf16_f32 v47, v54, v55
  buffer_store_dwordx4 v[44:47], v2, s[40:43], s65 offen offset:1024 sc1
  v_accvgpr_read_b32 v100, a36
  v_accvgpr_read_b32 v101, a37
  v_accvgpr_read_b32 v102, a38
  v_accvgpr_read_b32 v103, a39
  v_accvgpr_read_b32 v104, a44
  v_accvgpr_read_b32 v105, a45
  v_accvgpr_read_b32 v106, a46
  v_accvgpr_read_b32 v107, a47
  v_pk_mul_f32 v[100:101], v[100:101], v[18:19]
  v_pk_mul_f32 v[102:103], v[102:103], v[18:19]
  v_pk_mul_f32 v[104:105], v[104:105], v[18:19]
  v_pk_mul_f32 v[106:107], v[106:107], v[18:19]
  v_cvt_pk_bf16_f32 v96, v100, v101
  v_cvt_pk_bf16_f32 v97, v102, v103
  v_cvt_pk_bf16_f32 v98, v104, v105
  v_cvt_pk_bf16_f32 v99, v106, v107
  buffer_store_dwordx4 v[96:99], v2, s[40:43], s65 offen offset:2048 sc1
  v_accvgpr_read_b32 v112, a52
  v_accvgpr_read_b32 v113, a53
  v_accvgpr_read_b32 v114, a54
  v_accvgpr_read_b32 v115, a55
  v_accvgpr_read_b32 v116, a60
  v_accvgpr_read_b32 v117, a61
  v_accvgpr_read_b32 v118, a62
  v_accvgpr_read_b32 v119, a63
  v_pk_mul_f32 v[112:113], v[112:113], v[18:19]
  v_pk_mul_f32 v[114:115], v[114:115], v[18:19]
  v_pk_mul_f32 v[116:117], v[116:117], v[18:19]
  v_pk_mul_f32 v[118:119], v[118:119], v[18:19]
  v_cvt_pk_bf16_f32 v108, v112, v113
  v_cvt_pk_bf16_f32 v109, v114, v115
  v_cvt_pk_bf16_f32 v110, v116, v117
  v_cvt_pk_bf16_f32 v111, v118, v119
  buffer_store_dwordx4 v[108:111], v2, s[40:43], s65 offen offset:3072 sc1
  s_getpc_b64 s[36:37]
  s_setpc_b64 s[38:39]
  s_waitcnt vmcnt(8)
  v_cmp_eq_u32 vcc, 0, v8
  s_cbranch_vccnz fa_wof_spin
fa_wof_ok:
  s_and_b32 s23, s21, 3
  s_lshl_b32 s23, s23, 13
  s_add_u32 s33, s13, s23
  v_lshlrev_b32 v9, 7, v1
  buffer_load_dword v255, v9, s[40:43], s33 offen sc1
  s_add_u32 s33, s33, 32768
  s_getpc_b64 s[36:37]
  s_setpc_b64 s[38:39]
  buffer_load_dword v255, v9, s[40:43], s33 offen sc1
  s_add_u32 s33, s33, 32768
  s_getpc_b64 s[36:37]
  s_setpc_b64 s[38:39]
  buffer_load_dword v255, v9, s[40:43], s33 offen sc1
  s_add_u32 s33, s33, 32768
  s_mov_b32 s12, 2
  s_mov_b32 s32, -1
  s_setpc_b64 s[38:39]
fa_hk2:
  s_getpc_b64 s[38:39]
fa_hp2:
  s_add_u32 s36, s36, 4
  s_addc_u32 s37, s37, 0
  s_sub_u32 s38, s38, fa_hp2-fa_hb2
  s_subb_u32 s39, s39, 0
  s_setpc_b64 s[36:37]
fa_hk3:
  s_getpc_b64 s[38:39]
fa_hp3:
  s_add_u32 s36, s36, 4
  s_addc_u32 s37, s37, 0
  s_sub_u32 s38, s38, fa_hp3-fa_hb3
  s_subb_u32 s39, s39, 0
  s_setpc_b64 s[36:37]
fa_hk4:
  s_getpc_b64 s[38:39]
fa_hp4:
  s_add_u32 s36, s36, 4
  s_addc_u32 s37, s37, 0
  s_sub_u32 s38, s38, fa_hp4-fa_hb4
  s_subb_u32 s39, s39, 0
  s_setpc_b64 s[36:37]
fa_sel4_spin:
  s_mov_b32 s83, 200000
fa_sel4_spin2:
  buffer_load_dword v15, v10, s[40:43], 0 offen sc1
  s_waitcnt vmcnt(0)
  v_cmp_eq_u32 vcc, 0, v15
  s_cbranch_vccz fa_sel4_ok
  s_sleep 8
  s_sub_u32 s83, s83, 1
  s_cmp_lg_u32 s83, 0
  s_cbranch_scc1 fa_sel4_spin2
  s_branch fa_sel4_ok
fa_yf_spin:
  s_mov_b32 s83, 200000
fa_yf_spin2:
  buffer_load_dword v14, v11, s[40:43], 0 offen sc1
  s_waitcnt vmcnt(0)
  v_cmp_eq_u32 vcc, 0, v14
  s_cbranch_vccz fa_yf_ok
  s_sleep 8
  s_sub_u32 s83, s83, 1
  s_cmp_lg_u32 s83, 0
  s_cbranch_scc1 fa_yf_spin2
  s_branch fa_yf_ok
fa_ystub0:
  s_call_b64 s[76:77], fa_ysub
  s_branch fa_yback0
fa_ystub1:
  s_call_b64 s[76:77], fa_ysub
  s_branch fa_yback1
fa_ysub:
  v_cmp_eq_u32 vcc, 0, v14
  s_cbranch_vccnz fa_yf_spin
fa_yf_ok:
  v_mul_u32_u24 v16, 3277, v1
  v_lshrrev_b32 v16, 16, v16
  v_mul_u32_u24 v17, 20, v16
  v_sub_u32 v17, v1, v17
  v_lshlrev_b32 v17, 4, v17
  v_mul_u32_u24 v18, 368640, v16
  v_add_u32 v18, v18, v17
  v_cmp_gt_u32 vcc, 3, v16
  v_mov_b32 v19, 1073741824
  s_mul_i32 s14, s23, 2560
  v_cndmask_b32 v18, v19, v18, vcc
  s_mul_i32 s15, s22, 320
  s_add_u32 s14, s14, s15
  s_add_u32 s14, s14, 2686976
  buffer_load_dwordx4 v[64:67], v18, s[40:43], s14 offen sc1
  s_add_u32 s14, s14, 20480
  buffer_load_dwordx4 v[68:71], v18, s[40:43], s14 offen sc1
  s_add_u32 s14, s14, 20480
  buffer_load_dwordx4 v[72:75], v18, s[40:43], s14 offen sc1
  s_add_u32 s14, s14, 20480
  buffer_load_dwordx4 v[76:79], v18, s[40:43], s14 offen sc1
  s_add_u32 s14, s14, 20480
  buffer_load_dwordx4 v[80:83], v18, s[40:43], s14 offen sc1
  s_add_u32 s14, s14, 20480
  buffer_load_dwordx4 v[84:87], v18, s[40:43], s14 offen sc1
  s_add_u32 s14, s14, 20480
  buffer_load_dwordx4 v[88:91], v18, s[40:43], s14 offen sc1
  s_add_u32 s14, s14, 20480
  buffer_load_dwordx4 v[92:95], v18, s[40:43], s14 offen sc1
  s_add_u32 s14, s14, 20480
  buffer_load_dwordx4 v[128:131], v18, s[40:43], s14 offen sc1
  s_add_u32 s14, s14, 20480
  buffer_load_dwordx4 v[132:135], v18, s[40:43], s14 offen sc1
  s_add_u32 s14, s14, 20480
  buffer_load_dwordx4 v[136:139], v18, s[40:43], s14 offen sc1
  s_add_u32 s14, s14, 20480
  buffer_load_dwordx4 v[140:143], v18, s[40:43], s14 offen sc1
  s_add_u32 s14, s14, 20480
  buffer_load_dwordx4 v[144:147], v18, s[40:43], s14 offen sc1
  s_add_u32 s14, s14, 20480
  buffer_load_dwordx4 v[148:151], v18, s[40:43], s14 offen sc1
  s_add_u32 s14, s14, 20480
  buffer_load_dwordx4 v[152:155], v18, s[40:43], s14 offen sc1
  s_add_u32 s14, s14, 20480
  buffer_load_dwordx4 v[156:159], v18, s[40:43], s14 offen sc1
  s_add_u32 s14, s14, 20480
  buffer_load_dwordx4 v[176:179], v18, s[40:43], s14 offen sc1
  s_add_u32 s14, s14, 20480
  buffer_load_dwordx4 v[180:183], v18, s[40:43], s14 offen sc1
  s_add_u32 s14, s14, 20480
  s_lshl_b32 s14, s20, 10
  s_add_u32 s14, s14, 135168
  v_add_u32 v19, s14, v2
  s_and_b32 s30, s30, 0xffff0000
  s_waitcnt vmcnt(0)
  v_add_f32 v64, v64, v68
  v_add_f32 v65, v65, v69
  v_add_f32 v66, v66, v70
  v_add_f32 v67, v67, v71
  v_add_f32 v64, v64, v72
  v_add_f32 v65, v65, v73
  v_add_f32 v66, v66, v74
  v_add_f32 v67, v67, v75
  v_add_f32 v64, v64, v76
  v_add_f32 v65, v65, v77
  v_add_f32 v66, v66, v78
  v_add_f32 v67, v67, v79
  v_add_f32 v64, v64, v80
  v_add_f32 v65, v65, v81
  v_add_f32 v66, v66, v82
  v_add_f32 v67, v67, v83
  v_add_f32 v64, v64, v84
  v_add_f32 v65, v65, v85
  v_add_f32 v66, v66, v86
  v_add_f32 v67, v67, v87
  v_add_f32 v64, v64, v88
  v_add_f32 v65, v65, v89
  v_add_f32 v66, v66, v90
  v_add_f32 v67, v67, v91
  v_add_f32 v64, v64, v92
  v_add_f32 v65, v65, v93
  v_add_f32 v66, v66, v94
  v_add_f32 v67, v67, v95
  v_add_f32 v64, v64, v128
  v_add_f32 v65, v65, v129
  v_add_f32 v66, v66, v130
  v_add_f32 v67, v67, v131
  v_add_f32 v64, v64, v132
  v_add_f32 v65, v65, v133
  v_add_f32 v66, v66, v134
  v_add_f32 v67, v67, v135
  v_add_f32 v64, v64, v136
  v_add_f32 v65, v65, v137
  v_add_f32 v66, v66, v138
  v_add_f32 v67, v67, v139
  v_add_f32 v64, v64, v140
  v_add_f32 v65, v65, v141
  v_add_f32 v66, v66, v142
  v_add_f32 v67, v67, v143
  v_add_f32 v64, v64, v144
  v_add_f32 v65, v65, v145
  v_add_f32 v66, v66, v146
  v_add_f32 v67, v67, v147
  v_add_f32 v64, v64, v148
  v_add_f32 v65, v65, v149
  v_add_f32 v66, v66, v150
  v_add_f32 v67, v67, v151
  v_add_f32 v64, v64, v152
  v_add_f32 v65, v65, v153
  v_add_f32 v66, v66, v154
  v_add_f32 v67, v67, v155
  v_add_f32 v64, v64, v156
  v_add_f32 v65, v65, v157
  v_add_f32 v66, v66, v158
  v_add_f32 v67, v67, v159
  v_add_f32 v64, v64, v176
  v_add_f32 v65, v65, v177
  v_add_f32 v66, v66, v178
  v_add_f32 v67, v67, v179
  v_add_f32 v64, v64, v180
  v_add_f32 v65, v65, v181
  v_add_f32 v66, v66, v182
  v_add_f32 v67, v67, v183
  ds_write_b128 v19, v[64:67]
  v_add_u32 v19, s14, v17
  s_waitcnt lgkmcnt(0)
  ds_read_b128 v[64:67], v19
  ds_read_b128 v[68:71], v19 offset:320
  ds_read_b128 v[72:75], v19 offset:640
  s_mul_i32 s14, s23, 320
  s_add_u32 s14, s14, 131072
  v_add_u32 v19, s14, v17
  s_waitcnt lgkmcnt(0)
  v_add_f32 v64, v64, v68
  v_add_f32 v64, v64, v72
  v_cvt_pk_bf16_f32 v64, v64, v64
  v_and_b32 v64, 0xffff0000, v64
  v_mul_f32 v64, s30, v64
  v_cvt_pk_bf16_f32 v64, v64, v64
  v_and_b32 v64, 0xffff0000, v64
  v_add_f32 v65, v65, v69
  v_add_f32 v65, v65, v73
  v_cvt_pk_bf16_f32 v65, v65, v65
  v_and_b32 v65, 0xffff0000, v65
  v_mul_f32 v65, s30, v65
  v_cvt_pk_bf16_f32 v65, v65, v65
  v_and_b32 v65, 0xffff0000, v65
  v_add_f32 v66, v66, v70
  v_add_f32 v66, v66, v74
  v_cvt_pk_bf16_f32 v66, v66, v66
  v_and_b32 v66, 0xffff0000, v66
  v_mul_f32 v66, s30, v66
  v_cvt_pk_bf16_f32 v66, v66, v66
  v_and_b32 v66, 0xffff0000, v66
  v_add_f32 v67, v67, v71
  v_add_f32 v67, v67, v75
  v_cvt_pk_bf16_f32 v67, v67, v67
  v_and_b32 v67, 0xffff0000, v67
  v_mul_f32 v67, s30, v67
  v_cvt_pk_bf16_f32 v67, v67, v67
  v_and_b32 v67, 0xffff0000, v67
  ds_write_b128 v19, v[64:67]
  s_waitcnt lgkmcnt(0)
  s_setpc_b64 s[76:77]
fa_ctx_spin:
  s_mov_b32 s83, 200000
fa_ctx_spin2:
  buffer_load_dword v13, v12, s[40:43], 0 offen sc1
  s_waitcnt vmcnt(0)
  v_cmp_eq_u32 vcc, 0, v13
  s_cbranch_vccz fa_ctx_ok
  s_sleep 8
  s_sub_u32 s83, s83, 1
  s_cmp_lg_u32 s83, 0
  s_cbranch_scc1 fa_ctx_spin2
  s_branch fa_ctx_ok
fa_stub0:
  s_call_b64 s[76:77], fa_rare00
  s_call_b64 s[76:77], fa_rare10
  s_branch fa_back0
fa_stub1:
  s_call_b64 s[76:77], fa_rare01
  s_call_b64 s[76:77], fa_rare11
  s_branch fa_back1
fa_stub2:
  s_call_b64 s[76:77], fa_rare00
  s_call_b64 s[76:77], fa_rare10
  s_branch fa_back2
fa_stub3:
  s_call_b64 s[76:77], fa_rare01
  s_call_b64 s[76:77], fa_rare11
  s_branch fa_back3
fa_stub4:
  s_call_b64 s[76:77], fa_rare00
  s_call_b64 s[76:77], fa_rare10
  s_branch fa_back4
fa_stub5:
  s_call_b64 s[76:77], fa_rare11
  s_branch fa_back5
fa_stub6:
  s_call_b64 s[76:77], fa_rare10
  s_branch fa_back6
fa_stub7:
  s_call_b64 s[76:77], fa_rare01
  s_call_b64 s[76:77], fa_rare11
  s_branch fa_back7
fa_stub8:
  s_call_b64 s[76:77], fa_rare10
  s_branch fa_back8
fa_stub9:
  s_call_b64 s[76:77], fa_rare11
  s_branch fa_back9
fa_stub10:
  s_call_b64 s[76:77], fa_rare10
  s_branch fa_back10
fa_stub11:
  s_call_b64 s[76:77], fa_rare11
  s_branch fa_back11
fa_stub12:
  s_call_b64 s[76:77], fa_rare10
  s_branch fa_back12
fa_stub13:
  s_call_b64 s[76:77], fa_rare11
  s_branch fa_back13
fa_codeend:
fa_rare00:
  s_nop 7
  v_max3_f32 v16, v96, v97, v98
  v_max3_f32 v16, v16, v99, v100
  v_max3_f32 v16, v16, v101, v102
  v_max3_f32 v16, v16, v103, 0
  v_mov_b32 v18, v16
  s_nop 1
  v_permlane16_swap_b32 v16, v18
  v_max_f32 v16, v16, v18
  v_mov_b32 v18, v16
  s_nop 1
  v_permlane32_swap_b32 v16, v18
  v_max_f32 v16, v16, v18
  v_sub_f32 v96, v96, v16
  v_sub_f32 v112, v112, v16
  v_sub_f32 v97, v97, v16
  v_sub_f32 v113, v113, v16
  v_sub_f32 v98, v98, v16
  v_sub_f32 v114, v114, v16
  v_sub_f32 v99, v99, v16
  v_sub_f32 v115, v115, v16
  v_sub_f32 v100, v100, v16
  v_sub_f32 v116, v116, v16
  v_sub_f32 v101, v101, v16
  v_sub_f32 v117, v117, v16
  v_sub_f32 v102, v102, v16
  v_sub_f32 v118, v118, v16
  v_sub_f32 v103, v103, v16
  v_sub_f32 v119, v119, v16
  v_max3_f32 v17, v104, v105, v106
  v_max3_f32 v17, v17, v107, v108
  v_max3_f32 v17, v17, v109, v110
  v_max3_f32 v17, v17, v111, 0
  v_mov_b32 v18, v17
  s_nop 1
  v_permlane16_swap_b32 v17, v18
  v_max_f32 v17, v17, v18
  v_mov_b32 v18, v17
  s_nop 1
  v_permlane32_swap_b32 v17, v18
  v_max_f32 v17, v17, v18
  v_sub_f32 v104, v104, v17
  v_sub_f32 v120, v120, v17
  v_sub_f32 v105, v105, v17
  v_sub_f32 v121, v121, v17
  v_sub_f32 v106, v106, v17
  v_sub_f32 v122, v122, v17
  v_sub_f32 v107, v107, v17
  v_sub_f32 v123, v123, v17
  v_sub_f32 v108, v108, v17
  v_sub_f32 v124, v124, v17
  v_sub_f32 v109, v109, v17
  v_sub_f32 v125, v125, v17
  v_sub_f32 v110, v110, v17
  v_sub_f32 v126, v126, v17
  v_sub_f32 v111, v111, v17
  v_sub_f32 v127, v127, v17
  s_call_b64 s[78:79], fa_resc0
  v_exp_f32 v208, v96
  v_exp_f32 v209, v97
  v_exp_f32 v210, v98
  v_add_f32 v224, v208, v209
  v_cvt_pk_bf16_f32 v160, v208, v209
  v_exp_f32 v211, v99
  v_add_f32 v224, v224, v210
  v_exp_f32 v212, v100
  v_add_f32 v224, v224, v211
  v_cvt_pk_bf16_f32 v161, v210, v211
  v_exp_f32 v213, v101
  v_add_f32 v224, v224, v212
  v_exp_f32 v214, v102
  v_add_f32 v224, v224, v213
  v_cvt_pk_bf16_f32 v162, v212, v213
  v_exp_f32 v215, v103
  v_add_f32 v224, v224, v214
  v_exp_f32 v208, v104
  v_add_f32 v224, v224, v215
  v_cvt_pk_bf16_f32 v163, v214, v215
  v_exp_f32 v209, v105
  v_exp_f32 v210, v106
  v_add_f32 v225, v208, v209
  v_cvt_pk_bf16_f32 v164, v208, v209
  v_exp_f32 v211, v107
  v_add_f32 v225, v225, v210
  v_exp_f32 v212, v108
  v_add_f32 v225, v225, v211
  v_cvt_pk_bf16_f32 v165, v210, v211
  v_exp_f32 v213, v109
  v_add_f32 v225, v225, v212
  v_exp_f32 v214, v110
  v_add_f32 v225, v225, v213
  v_cvt_pk_bf16_f32 v166, v212, v213
  v_exp_f32 v215, v111
  v_add_f32 v225, v225, v214
  s_nop 0
  v_add_f32 v225, v225, v215
  v_cvt_pk_bf16_f32 v167, v214, v215
  s_nop 1
  s_setpc_b64 s[76:77]
fa_rare01:
  s_nop 7
  v_max3_f32 v16, v112, v113, v114
  v_max3_f32 v16, v16, v115, v116
  v_max3_f32 v16, v16, v117, v118
  v_max3_f32 v16, v16, v119, 0
  v_mov_b32 v18, v16
  s_nop 1
  v_permlane16_swap_b32 v16, v18
  v_max_f32 v16, v16, v18
  v_mov_b32 v18, v16
  s_nop 1
  v_permlane32_swap_b32 v16, v18
  v_max_f32 v16, v16, v18
  v_sub_f32 v112, v112, v16
  v_sub_f32 v96, v96, v16
  v_sub_f32 v113, v113, v16
  v_sub_f32 v97, v97, v16
  v_sub_f32 v114, v114, v16
  v_sub_f32 v98, v98, v16
  v_sub_f32 v115, v115, v16
  v_sub_f32 v99, v99, v16
  v_sub_f32 v116, v116, v16
  v_sub_f32 v100, v100, v16
  v_sub_f32 v117, v117, v16
  v_sub_f32 v101, v101, v16
  v_sub_f32 v118, v118, v16
  v_sub_f32 v102, v102, v16
  v_sub_f32 v119, v119, v16
  v_sub_f32 v103, v103, v16
  v_max3_f32 v17, v120, v121, v122
  v_max3_f32 v17, v17, v123, v124
  v_max3_f32 v17, v17, v125, v126
  v_max3_f32 v17, v17, v127, 0
  v_mov_b32 v18, v17
  s_nop 1
  v_permlane16_swap_b32 v17, v18
  v_max_f32 v17, v17, v18
  v_mov_b32 v18, v17
  s_nop 1
  v_permlane32_swap_b32 v17, v18
  v_max_f32 v17, v17, v18
  v_sub_f32 v120, v120, v17
  v_sub_f32 v104, v104, v17
  v_sub_f32 v121, v121, v17
  v_sub_f32 v105, v105, v17
  v_sub_f32 v122, v122, v17
  v_sub_f32 v106, v106, v17
  v_sub_f32 v123, v123, v17
  v_sub_f32 v107, v107, v17
  v_sub_f32 v124, v124, v17
  v_sub_f32 v108, v108, v17
  v_sub_f32 v125, v125, v17
  v_sub_f32 v109, v109, v17
  v_sub_f32 v126, v126, v17
  v_sub_f32 v110, v110, v17
  v_sub_f32 v127, v127, v17
  v_sub_f32 v111, v111, v17
  s_call_b64 s[78:79], fa_resc0
  v_exp_f32 v208, v112
  v_exp_f32 v209, v113
  v_exp_f32 v210, v114
  v_add_f32 v224, v208, v209
  v_cvt_pk_bf16_f32 v168, v208, v209
  v_exp_f32 v211, v115
  v_add_f32 v224, v224, v210
  v_exp_f32 v212, v116
  v_add_f32 v224, v224, v211
  v_cvt_pk_bf16_f32 v169, v210, v211
  v_exp_f32 v213, v117
  v_add_f32 v224, v224, v212
  v_exp_f32 v214, v118
  v_add_f32 v224, v224, v213
  v_cvt_pk_bf16_f32 v170, v212, v213
  v_exp_f32 v215, v119
  v_add_f32 v224, v224, v214
  v_exp_f32 v208, v120
  v_add_f32 v224, v224, v215
  v_cvt_pk_bf16_f32 v171, v214, v215
  v_exp_f32 v209, v121
  v_exp_f32 v210, v122
  v_add_f32 v225, v208, v209
  v_cvt_pk_bf16_f32 v172, v208, v209
  v_exp_f32 v211, v123
  v_add_f32 v225, v225, v210
  v_exp_f32 v212, v124
  v_add_f32 v225, v225, v211
  v_cvt_pk_bf16_f32 v173, v210, v211
  v_exp_f32 v213, v125
  v_add_f32 v225, v225, v212
  v_exp_f32 v214, v126
  v_add_f32 v225, v225, v213
  v_cvt_pk_bf16_f32 v174, v212, v213
  v_exp_f32 v215, v127
  v_add_f32 v225, v225, v214
  s_nop 0
  v_add_f32 v225, v225, v215
  v_cvt_pk_bf16_f32 v175, v214, v215
  s_nop 1
  s_setpc_b64 s[76:77]
fa_resc0:
  v_sub_f32 v192, v192, v16
  v_sub_f32 v193, v193, v16
  v_sub_f32 v194, v194, v16
  v_sub_f32 v195, v195, v16
  v_exp_f32 v18, -v16
  v_sub_f32 v196, v196, v17
  v_sub_f32 v197, v197, v17
  v_sub_f32 v198, v198, v17
  v_sub_f32 v199, v199, v17
  v_exp_f32 v19, -v17
  s_nop 0
  v_mul_f32 v228, v228, v18
  v_mul_f32 v229, v229, v19
  v_accvgpr_read_b32 v20, a0
  v_accvgpr_read_b32 v21, a1
  v_accvgpr_read_b32 v22, a2
  v_accvgpr_read_b32 v23, a3
  v_mul_f32 v20, v20, v18
  v_mul_f32 v21, v21, v18
  v_mul_f32 v22, v22, v18
  v_mul_f32 v23, v23, v18
  v_accvgpr_write_b32 a0, v20
  v_accvgpr_write_b32 a1, v21
  v_accvgpr_write_b32 a2, v22
  v_accvgpr_write_b32 a3, v23
  v_accvgpr_read_b32 v20, a4
  v_accvgpr_read_b32 v21, a5
  v_accvgpr_read_b32 v22, a6
  v_accvgpr_read_b32 v23, a7
  v_mul_f32 v20, v20, v19
  v_mul_f32 v21, v21, v19
  v_mul_f32 v22, v22, v19
  v_mul_f32 v23, v23, v19
  v_accvgpr_write_b32 a4, v20
  v_accvgpr_write_b32 a5, v21
  v_accvgpr_write_b32 a6, v22
  v_accvgpr_write_b32 a7, v23
  v_accvgpr_read_b32 v20, a8
  v_accvgpr_read_b32 v21, a9
  v_accvgpr_read_b32 v22, a10
  v_accvgpr_read_b32 v23, a11
  v_mul_f32 v20, v20, v18
  v_mul_f32 v21, v21, v18
  v_mul_f32 v22, v22, v18
  v_mul_f32 v23, v23, v18
  v_accvgpr_write_b32 a8, v20
  v_accvgpr_write_b32 a9, v21
  v_accvgpr_write_b32 a10, v22
  v_accvgpr_write_b32 a11, v23
  v_accvgpr_read_b32 v20, a12
  v_accvgpr_read_b32 v21, a13
  v_accvgpr_read_b32 v22, a14
  v_accvgpr_read_b32 v23, a15
  v_mul_f32 v20, v20, v19
  v_mul_f32 v21, v21, v19
  v_mul_f32 v22, v22, v19
  v_mul_f32 v23, v23, v19
  v_accvgpr_write_b32 a12, v20
  v_accvgpr_write_b32 a13, v21
  v_accvgpr_write_b32 a14, v22
  v_accvgpr_write_b32 a15, v23
  v_accvgpr_read_b32 v20, a16
  v_accvgpr_read_b32 v21, a17
  v_accvgpr_read_b32 v22, a18
  v_accvgpr_read_b32 v23, a19
  v_mul_f32 v20, v20, v18
  v_mul_f32 v21, v21, v18
  v_mul_f32 v22, v22, v18
  v_mul_f32 v23, v23, v18
  v_accvgpr_write_b32 a16, v20
  v_accvgpr_write_b32 a17, v21
  v_accvgpr_write_b32 a18, v22
  v_accvgpr_write_b32 a19, v23
  v_accvgpr_read_b32 v20, a20
  v_accvgpr_read_b32 v21, a21
  v_accvgpr_read_b32 v22, a22
  v_accvgpr_read_b32 v23, a23
  v_mul_f32 v20, v20, v19
  v_mul_f32 v21, v21, v19
  v_mul_f32 v22, v22, v19
  v_mul_f32 v23, v23, v19
  v_accvgpr_write_b32 a20, v20
  v_accvgpr_write_b32 a21, v21
  v_accvgpr_write_b32 a22, v22
  v_accvgpr_write_b32 a23, v23
  v_accvgpr_read_b32 v20, a24
  v_accvgpr_read_b32 v21, a25
  v_accvgpr_read_b32 v22, a26
  v_accvgpr_read_b32 v23, a27
  v_mul_f32 v20, v20, v18
  v_mul_f32 v21, v21, v18
  v_mul_f32 v22, v22, v18
  v_mul_f32 v23, v23, v18
  v_accvgpr_write_b32 a24, v20
  v_accvgpr_write_b32 a25, v21
  v_accvgpr_write_b32 a26, v22
  v_accvgpr_write_b32 a27, v23
  v_accvgpr_read_b32 v20, a28
  v_accvgpr_read_b32 v21, a29
  v_accvgpr_read_b32 v22, a30
  v_accvgpr_read_b32 v23, a31
  v_mul_f32 v20, v20, v19
  v_mul_f32 v21, v21, v19
  v_mul_f32 v22, v22, v19
  v_mul_f32 v23, v23, v19
  v_accvgpr_write_b32 a28, v20
  v_accvgpr_write_b32 a29, v21
  v_accvgpr_write_b32 a30, v22
  v_accvgpr_write_b32 a31, v23
  v_accvgpr_read_b32 v20, a32
  v_accvgpr_read_b32 v21, a33
  v_accvgpr_read_b32 v22, a34
  v_accvgpr_read_b32 v23, a35
  v_mul_f32 v20, v20, v18
  v_mul_f32 v21, v21, v18
  v_mul_f32 v22, v22, v18
  v_mul_f32 v23, v23, v18
  v_accvgpr_write_b32 a32, v20
  v_accvgpr_write_b32 a33, v21
  v_accvgpr_write_b32 a34, v22
  v_accvgpr_write_b32 a35, v23
  v_accvgpr_read_b32 v20, a36
  v_accvgpr_read_b32 v21, a37
  v_accvgpr_read_b32 v22, a38
  v_accvgpr_read_b32 v23, a39
  v_mul_f32 v20, v20, v19
  v_mul_f32 v21, v21, v19
  v_mul_f32 v22, v22, v19
  v_mul_f32 v23, v23, v19
  v_accvgpr_write_b32 a36, v20
  v_accvgpr_write_b32 a37, v21
  v_accvgpr_write_b32 a38, v22
  v_accvgpr_write_b32 a39, v23
  v_accvgpr_read_b32 v20, a40
  v_accvgpr_read_b32 v21, a41
  v_accvgpr_read_b32 v22, a42
  v_accvgpr_read_b32 v23, a43
  v_mul_f32 v20, v20, v18
  v_mul_f32 v21, v21, v18
  v_mul_f32 v22, v22, v18
  v_mul_f32 v23, v23, v18
  v_accvgpr_write_b32 a40, v20
  v_accvgpr_write_b32 a41, v21
  v_accvgpr_write_b32 a42, v22
  v_accvgpr_write_b32 a43, v23
  v_accvgpr_read_b32 v20, a44
  v_accvgpr_read_b32 v21, a45
  v_accvgpr_read_b32 v22, a46
  v_accvgpr_read_b32 v23, a47
  v_mul_f32 v20, v20, v19
  v_mul_f32 v21, v21, v19
  v_mul_f32 v22, v22, v19
  v_mul_f32 v23, v23, v19
  v_accvgpr_write_b32 a44, v20
  v_accvgpr_write_b32 a45, v21
  v_accvgpr_write_b32 a46, v22
  v_accvgpr_write_b32 a47, v23
  v_accvgpr_read_b32 v20, a48
  v_accvgpr_read_b32 v21, a49
  v_accvgpr_read_b32 v22, a50
  v_accvgpr_read_b32 v23, a51
  v_mul_f32 v20, v20, v18
  v_mul_f32 v21, v21, v18
  v_mul_f32 v22, v22, v18
  v_mul_f32 v23, v23, v18
  v_accvgpr_write_b32 a48, v20
  v_accvgpr_write_b32 a49, v21
  v_accvgpr_write_b32 a50, v22
  v_accvgpr_write_b32 a51, v23
  v_accvgpr_read_b32 v20, a52
  v_accvgpr_read_b32 v21, a53
  v_accvgpr_read_b32 v22, a54
  v_accvgpr_read_b32 v23, a55
  v_mul_f32 v20, v20, v19
  v_mul_f32 v21, v21, v19
  v_mul_f32 v22, v22, v19
  v_mul_f32 v23, v23, v19
  v_accvgpr_write_b32 a52, v20
  v_accvgpr_write_b32 a53, v21
  v_accvgpr_write_b32 a54, v22
  v_accvgpr_write_b32 a55, v23
  v_accvgpr_read_b32 v20, a56
  v_accvgpr_read_b32 v21, a57
  v_accvgpr_read_b32 v22, a58
  v_accvgpr_read_b32 v23, a59
  v_mul_f32 v20, v20, v18
  v_mul_f32 v21, v21, v18
  v_mul_f32 v22, v22, v18
  v_mul_f32 v23, v23, v18
  v_accvgpr_write_b32 a56, v20
  v_accvgpr_write_b32 a57, v21
  v_accvgpr_write_b32 a58, v22
  v_accvgpr_write_b32 a59, v23
  v_accvgpr_read_b32 v20, a60
  v_accvgpr_read_b32 v21, a61
  v_accvgpr_read_b32 v22, a62
  v_accvgpr_read_b32 v23, a63
  v_mul_f32 v20, v20, v19
  v_mul_f32 v21, v21, v19
  v_mul_f32 v22, v22, v19
  v_mul_f32 v23, v23, v19
  v_accvgpr_write_b32 a60, v20
  v_accvgpr_write_b32 a61, v21
  v_accvgpr_write_b32 a62, v22
  v_accvgpr_write_b32 a63, v23
  s_setpc_b64 s[78:79]
fa_rare10:
  s_nop 7
  v_max3_f32 v16, v128, v129, v130
  v_max3_f32 v16, v16, v131, v132
  v_max3_f32 v16, v16, v133, v134
  v_max3_f32 v16, v16, v135, 0
  v_mov_b32 v18, v16
  s_nop 1
  v_permlane16_swap_b32 v16, v18
  v_max_f32 v16, v16, v18
  v_mov_b32 v18, v16
  s_nop 1
  v_permlane32_swap_b32 v16, v18
  v_max_f32 v16, v16, v18
  v_sub_f32 v128, v128, v16
  v_sub_f32 v144, v144, v16
  v_sub_f32 v129, v129, v16
  v_sub_f32 v145, v145, v16
  v_sub_f32 v130, v130, v16
  v_sub_f32 v146, v146, v16
  v_sub_f32 v131, v131, v16
  v_sub_f32 v147, v147, v16
  v_sub_f32 v132, v132, v16
  v_sub_f32 v148, v148, v16
  v_sub_f32 v133, v133, v16
  v_sub_f32 v149, v149, v16
  v_sub_f32 v134, v134, v16
  v_sub_f32 v150, v150, v16
  v_sub_f32 v135, v135, v16
  v_sub_f32 v151, v151, v16
  v_max3_f32 v17, v136, v137, v138
  v_max3_f32 v17, v17, v139, v140
  v_max3_f32 v17, v17, v141, v142
  v_max3_f32 v17, v17, v143, 0
  v_mov_b32 v18, v17
  s_nop 1
  v_permlane16_swap_b32 v17, v18
  v_max_f32 v17, v17, v18
  v_mov_b32 v18, v17
  s_nop 1
  v_permlane32_swap_b32 v17, v18
  v_max_f32 v17, v17, v18
  v_sub_f32 v136, v136, v17
  v_sub_f32 v152, v152, v17
  v_sub_f32 v137, v137, v17
  v_sub_f32 v153, v153, v17
  v_sub_f32 v138, v138, v17
  v_sub_f32 v154, v154, v17
  v_sub_f32 v139, v139, v17
  v_sub_f32 v155, v155, v17
  v_sub_f32 v140, v140, v17
  v_sub_f32 v156, v156, v17
  v_sub_f32 v141, v141, v17
  v_sub_f32 v157, v157, v17
  v_sub_f32 v142, v142, v17
  v_sub_f32 v158, v158, v17
  v_sub_f32 v143, v143, v17
  v_sub_f32 v159, v159, v17
  s_call_b64 s[78:79], fa_resc1
  v_exp_f32 v216, v128
  v_exp_f32 v217, v129
  v_exp_f32 v218, v130
  v_add_f32 v226, v216, v217
  v_cvt_pk_bf16_f32 v176, v216, v217
  v_exp_f32 v219, v131
  v_add_f32 v226, v226, v218
  v_exp_f32 v220, v132
  v_add_f32 v226, v226, v219
  v_cvt_pk_bf16_f32 v177, v218, v219
  v_exp_f32 v221, v133
  v_add_f32 v226, v226, v220
  v_exp_f32 v222, v134
  v_add_f32 v226, v226, v221
  v_cvt_pk_bf16_f32 v178, v220, v221
  v_exp_f32 v223, v135
  v_add_f32 v226, v226, v222
  v_exp_f32 v216, v136
  v_add_f32 v226, v226, v223
  v_cvt_pk_bf16_f32 v179, v222, v223
  v_exp_f32 v217, v137
  v_exp_f32 v218, v138
  v_add_f32 v227, v216, v217
  v_cvt_pk_bf16_f32 v180, v216, v217
  v_exp_f32 v219, v139
  v_add_f32 v227, v227, v218
  v_exp_f32 v220, v140
  v_add_f32 v227, v227, v219
  v_cvt_pk_bf16_f32 v181, v218, v219
  v_exp_f32 v221, v141
  v_add_f32 v227, v227, v220
  v_exp_f32 v222, v142
  v_add_f32 v227, v227, v221
  v_cvt_pk_bf16_f32 v182, v220, v221
  v_exp_f32 v223, v143
  v_add_f32 v227, v227, v222
  s_nop 0
  v_add_f32 v227, v227, v223
  v_cvt_pk_bf16_f32 v183, v222, v223
  s_nop 1
  s_setpc_b64 s[76:77]
fa_rare11:
  s_nop 7
  v_max3_f32 v16, v144, v145, v146
  v_max3_f32 v16, v16, v147, v148
  v_max3_f32 v16, v16, v149, v150
  v_max3_f32 v16, v16, v151, 0
  v_mov_b32 v18, v16
  s_nop 1
  v_permlane16_swap_b32 v16, v18
  v_max_f32 v16, v16, v18
  v_mov_b32 v18, v16
  s_nop 1
  v_permlane32_swap_b32 v16, v18
  v_max_f32 v16, v16, v18
  v_sub_f32 v144, v144, v16
  v_sub_f32 v128, v128, v16
  v_sub_f32 v145, v145, v16
  v_sub_f32 v129, v129, v16
  v_sub_f32 v146, v146, v16
  v_sub_f32 v130, v130, v16
  v_sub_f32 v147, v147, v16
  v_sub_f32 v131, v131, v16
  v_sub_f32 v148, v148, v16
  v_sub_f32 v132, v132, v16
  v_sub_f32 v149, v149, v16
  v_sub_f32 v133, v133, v16
  v_sub_f32 v150, v150, v16
  v_sub_f32 v134, v134, v16
  v_sub_f32 v151, v151, v16
  v_sub_f32 v135, v135, v16
  v_max3_f32 v17, v152, v153, v154
  v_max3_f32 v17, v17, v155, v156
  v_max3_f32 v17, v17, v157, v158
  v_max3_f32 v17, v17, v159, 0
  v_mov_b32 v18, v17
  s_nop 1
  v_permlane16_swap_b32 v17, v18
  v_max_f32 v17, v17, v18
  v_mov_b32 v18, v17
  s_nop 1
  v_permlane32_swap_b32 v17, v18
  v_max_f32 v17, v17, v18
  v_sub_f32 v152, v152, v17
  v_sub_f32 v136, v136, v17
  v_sub_f32 v153, v153, v17
  v_sub_f32 v137, v137, v17
  v_sub_f32 v154, v154, v17
  v_sub_f32 v138, v138, v17
  v_sub_f32 v155, v155, v17
  v_sub_f32 v139, v139, v17
  v_sub_f32 v156, v156, v17
  v_sub_f32 v140, v140, v17
  v_sub_f32 v157, v157, v17
  v_sub_f32 v141, v141, v17
  v_sub_f32 v158, v158, v17
  v_sub_f32 v142, v142, v17
  v_sub_f32 v159, v159, v17
  v_sub_f32 v143, v143, v17
  s_call_b64 s[78:79], fa_resc1
  v_exp_f32 v216, v144
  v_exp_f32 v217, v145
  v_exp_f32 v218, v146
  v_add_f32 v226, v216, v217
  v_cvt_pk_bf16_f32 v184, v216, v217
  v_exp_f32 v219, v147
  v_add_f32 v226, v226, v218
  v_exp_f32 v220, v148
  v_add_f32 v226, v226, v219
  v_cvt_pk_bf16_f32 v185, v218, v219
  v_exp_f32 v221, v149
  v_add_f32 v226, v226, v220
  v_exp_f32 v222, v150
  v_add_f32 v226, v226, v221
  v_cvt_pk_bf16_f32 v186, v220, v221
  v_exp_f32 v223, v151
  v_add_f32 v226, v226, v222
  v_exp_f32 v216, v152
  v_add_f32 v226, v226, v223
  v_cvt_pk_bf16_f32 v187, v222, v223
  v_exp_f32 v217, v153
  v_exp_f32 v218, v154
  v_add_f32 v227, v216, v217
  v_cvt_pk_bf16_f32 v188, v216, v217
  v_exp_f32 v219, v155
  v_add_f32 v227, v227, v218
  v_exp_f32 v220, v156
  v_add_f32 v227, v227, v219
  v_cvt_pk_bf16_f32 v189, v218, v219
  v_exp_f32 v221, v157
  v_add_f32 v227, v227, v220
  v_exp_f32 v222, v158
  v_add_f32 v227, v227, v221
  v_cvt_pk_bf16_f32 v190, v220, v221
  v_exp_f32 v223, v159
  v_add_f32 v227, v227, v222
  s_nop 0
  v_add_f32 v227, v227, v223
  v_cvt_pk_bf16_f32 v191, v222, v223
  s_nop 1
  s_setpc_b64 s[76:77]
fa_resc1:
  v_sub_f32 v200, v200, v16
  v_sub_f32 v201, v201, v16
  v_sub_f32 v202, v202, v16
  v_sub_f32 v203, v203, v16
  v_exp_f32 v18, -v16
  v_sub_f32 v204, v204, v17
  v_sub_f32 v205, v205, v17
  v_sub_f32 v206, v206, v17
  v_sub_f32 v207, v207, v17
  v_exp_f32 v19, -v17
  s_nop 0
  v_mul_f32 v230, v230, v18
  v_mul_f32 v231, v231, v19
  v_accvgpr_read_b32 v20, a64
  v_accvgpr_read_b32 v21, a65
  v_accvgpr_read_b32 v22, a66
  v_accvgpr_read_b32 v23, a67
  v_mul_f32 v20, v20, v18
  v_mul_f32 v21, v21, v18
  v_mul_f32 v22, v22, v18
  v_mul_f32 v23, v23, v18
  v_accvgpr_write_b32 a64, v20
  v_accvgpr_write_b32 a65, v21
  v_accvgpr_write_b32 a66, v22
  v_accvgpr_write_b32 a67, v23
  v_accvgpr_read_b32 v20, a68
  v_accvgpr_read_b32 v21, a69
  v_accvgpr_read_b32 v22, a70
  v_accvgpr_read_b32 v23, a71
  v_mul_f32 v20, v20, v19
  v_mul_f32 v21, v21, v19
  v_mul_f32 v22, v22, v19
  v_mul_f32 v23, v23, v19
  v_accvgpr_write_b32 a68, v20
  v_accvgpr_write_b32 a69, v21
  v_accvgpr_write_b32 a70, v22
  v_accvgpr_write_b32 a71, v23
  v_accvgpr_read_b32 v20, a72
  v_accvgpr_read_b32 v21, a73
  v_accvgpr_read_b32 v22, a74
  v_accvgpr_read_b32 v23, a75
  v_mul_f32 v20, v20, v18
  v_mul_f32 v21, v21, v18
  v_mul_f32 v22, v22, v18
  v_mul_f32 v23, v23, v18
  v_accvgpr_write_b32 a72, v20
  v_accvgpr_write_b32 a73, v21
  v_accvgpr_write_b32 a74, v22
  v_accvgpr_write_b32 a75, v23
  v_accvgpr_read_b32 v20, a76
  v_accvgpr_read_b32 v21, a77
  v_accvgpr_read_b32 v22, a78
  v_accvgpr_read_b32 v23, a79
  v_mul_f32 v20, v20, v19
  v_mul_f32 v21, v21, v19
  v_mul_f32 v22, v22, v19
  v_mul_f32 v23, v23, v19
  v_accvgpr_write_b32 a76, v20
  v_accvgpr_write_b32 a77, v21
  v_accvgpr_write_b32 a78, v22
  v_accvgpr_write_b32 a79, v23
  v_accvgpr_read_b32 v20, a80
  v_accvgpr_read_b32 v21, a81
  v_accvgpr_read_b32 v22, a82
  v_accvgpr_read_b32 v23, a83
  v_mul_f32 v20, v20, v18
  v_mul_f32 v21, v21, v18
  v_mul_f32 v22, v22, v18
  v_mul_f32 v23, v23, v18
  v_accvgpr_write_b32 a80, v20
  v_accvgpr_write_b32 a81, v21
  v_accvgpr_write_b32 a82, v22
  v_accvgpr_write_b32 a83, v23
  v_accvgpr_read_b32 v20, a84
  v_accvgpr_read_b32 v21, a85
  v_accvgpr_read_b32 v22, a86
  v_accvgpr_read_b32 v23, a87
  v_mul_f32 v20, v20, v19
  v_mul_f32 v21, v21, v19
  v_mul_f32 v22, v22, v19
  v_mul_f32 v23, v23, v19
  v_accvgpr_write_b32 a84, v20
  v_accvgpr_write_b32 a85, v21
  v_accvgpr_write_b32 a86, v22
  v_accvgpr_write_b32 a87, v23
  v_accvgpr_read_b32 v20, a88
  v_accvgpr_read_b32 v21, a89
  v_accvgpr_read_b32 v22, a90
  v_accvgpr_read_b32 v23, a91
  v_mul_f32 v20, v20, v18
  v_mul_f32 v21, v21, v18
  v_mul_f32 v22, v22, v18
  v_mul_f32 v23, v23, v18
  v_accvgpr_write_b32 a88, v20
  v_accvgpr_write_b32 a89, v21
  v_accvgpr_write_b32 a90, v22
  v_accvgpr_write_b32 a91, v23
  v_accvgpr_read_b32 v20, a92
  v_accvgpr_read_b32 v21, a93
  v_accvgpr_read_b32 v22, a94
  v_accvgpr_read_b32 v23, a95
  v_mul_f32 v20, v20, v19
  v_mul_f32 v21, v21, v19
  v_mul_f32 v22, v22, v19
  v_mul_f32 v23, v23, v19
  v_accvgpr_write_b32 a92, v20
  v_accvgpr_write_b32 a93, v21
  v_accvgpr_write_b32 a94, v22
  v_accvgpr_write_b32 a95, v23
  v_accvgpr_read_b32 v20, a96
  v_accvgpr_read_b32 v21, a97
  v_accvgpr_read_b32 v22, a98
  v_accvgpr_read_b32 v23, a99
  v_mul_f32 v20, v20, v18
  v_mul_f32 v21, v21, v18
  v_mul_f32 v22, v22, v18
  v_mul_f32 v23, v23, v18
  v_accvgpr_write_b32 a96, v20
  v_accvgpr_write_b32 a97, v21
  v_accvgpr_write_b32 a98, v22
  v_accvgpr_write_b32 a99, v23
  v_accvgpr_read_b32 v20, a100
  v_accvgpr_read_b32 v21, a101
  v_accvgpr_read_b32 v22, a102
  v_accvgpr_read_b32 v23, a103
  v_mul_f32 v20, v20, v19
  v_mul_f32 v21, v21, v19
  v_mul_f32 v22, v22, v19
  v_mul_f32 v23, v23, v19
  v_accvgpr_write_b32 a100, v20
  v_accvgpr_write_b32 a101, v21
  v_accvgpr_write_b32 a102, v22
  v_accvgpr_write_b32 a103, v23
  v_accvgpr_read_b32 v20, a104
  v_accvgpr_read_b32 v21, a105
  v_accvgpr_read_b32 v22, a106
  v_accvgpr_read_b32 v23, a107
  v_mul_f32 v20, v20, v18
  v_mul_f32 v21, v21, v18
  v_mul_f32 v22, v22, v18
  v_mul_f32 v23, v23, v18
  v_accvgpr_write_b32 a104, v20
  v_accvgpr_write_b32 a105, v21
  v_accvgpr_write_b32 a106, v22
  v_accvgpr_write_b32 a107, v23
  v_accvgpr_read_b32 v20, a108
  v_accvgpr_read_b32 v21, a109
  v_accvgpr_read_b32 v22, a110
  v_accvgpr_read_b32 v23, a111
  v_mul_f32 v20, v20, v19
  v_mul_f32 v21, v21, v19
  v_mul_f32 v22, v22, v19
  v_mul_f32 v23, v23, v19
  v_accvgpr_write_b32 a108, v20
  v_accvgpr_write_b32 a109, v21
  v_accvgpr_write_b32 a110, v22
  v_accvgpr_write_b32 a111, v23
  v_accvgpr_read_b32 v20, a112
  v_accvgpr_read_b32 v21, a113
  v_accvgpr_read_b32 v22, a114
  v_accvgpr_read_b32 v23, a115
  v_mul_f32 v20, v20, v18
  v_mul_f32 v21, v21, v18
  v_mul_f32 v22, v22, v18
  v_mul_f32 v23, v23, v18
  v_accvgpr_write_b32 a112, v20
  v_accvgpr_write_b32 a113, v21
  v_accvgpr_write_b32 a114, v22
  v_accvgpr_write_b32 a115, v23
  v_accvgpr_read_b32 v20, a116
  v_accvgpr_read_b32 v21, a117
  v_accvgpr_read_b32 v22, a118
  v_accvgpr_read_b32 v23, a119
  v_mul_f32 v20, v20, v19
  v_mul_f32 v21, v21, v19
  v_mul_f32 v22, v22, v19
  v_mul_f32 v23, v23, v19
  v_accvgpr_write_b32 a116, v20
  v_accvgpr_write_b32 a117, v21
  v_accvgpr_write_b32 a118, v22
  v_accvgpr_write_b32 a119, v23
  v_accvgpr_read_b32 v20, a120
  v_accvgpr_read_b32 v21, a121
  v_accvgpr_read_b32 v22, a122
  v_accvgpr_read_b32 v23, a123
  v_mul_f32 v20, v20, v18
  v_mul_f32 v21, v21, v18
  v_mul_f32 v22, v22, v18
  v_mul_f32 v23, v23, v18
  v_accvgpr_write_b32 a120, v20
  v_accvgpr_write_b32 a121, v21
  v_accvgpr_write_b32 a122, v22
  v_accvgpr_write_b32 a123, v23
  v_accvgpr_read_b32 v20, a124
  v_accvgpr_read_b32 v21, a125
  v_accvgpr_read_b32 v22, a126
  v_accvgpr_read_b32 v23, a127
  v_mul_f32 v20, v20, v19
  v_mul_f32 v21, v21, v19
  v_mul_f32 v22, v22, v19
  v_mul_f32 v23, v23, v19
  v_accvgpr_write_b32 a124, v20
  v_accvgpr_write_b32 a125, v21
  v_accvgpr_write_b32 a126, v22
  v_accvgpr_write_b32 a127, v23
  s_setpc_b64 s[78:79]
.section .rodata,"a"
.p2align 6
.amdhsa_kernel fa_kernel
  .amdhsa_next_free_vgpr 512
  .amdhsa_next_free_sgpr 102
  .amdhsa_accum_offset 256
  .amdhsa_group_segment_fixed_size 0
  .amdhsa_kernarg_size 112
  .amdhsa_user_sgpr_count 2
  .amdhsa_user_sgpr_kernarg_segment_ptr 1
  .amdhsa_system_sgpr_workgroup_id_x 1
  .amdhsa_float_denorm_mode_32 3
.end_amdhsa_kernel
.text
```

```asm
; @launch kernel=fa_kernel grid=(256,1,1) block=(256,1,1) lds=163840
.amdgcn_target "amdgcn-amd-amdhsa--gfx950"
.text
.globl fa_kernel
.p2align 8
.type fa_kernel,@function
fa_kernel:
  s_cmp_ge_u32 s2, 256
  s_cbranch_scc1 fa_end
  s_load_dwordx4 s[4:7], s[0:1], 0
  s_load_dwordx2 s[14:15], s[0:1], 56
  s_load_dwordx4 s[8:11], s[0:1], 24
  s_load_dwordx2 s[12:13], s[0:1], 40
  s_load_dwordx4 s[16:19], s[0:1], 96
  s_load_dwordx2 s[60:61], s[0:1], 16
  v_lshrrev_b32 v16, 6, v0
  v_and_b32 v1, 63, v0
  v_readfirstlane_b32 s20, v16
  s_and_b32 s21, s2, 7
  s_lshl_b32 s21, s21, 2
  s_lshr_b32 s23, s2, 3
  s_and_b32 s23, s23, 3
  s_add_u32 s21, s21, s23
  s_lshr_b32 s22, s2, 5
  v_and_b32 v208, 31, v1
  v_lshrrev_b32 v209, 5, v1
  s_lshl_b32 s23, s2, 2
  s_add_u32 s23, s23, s20
  s_lshl_b32 s23, s23, 1
  v_add_u32 v209, s23, v209
  v_lshlrev_b32 v212, 4, v208
  v_mul_u32_u24 v210, 1280, v209
  v_add_u32 v210, v210, v212
  v_cmp_gt_u32 s[64:65], 16, v208
  v_mov_b32 v211, 1073741824
  v_lshlrev_b32 v2, 4, v1
  v_cndmask_b32 v211, v211, v210, s[64:65]
  v_lshrrev_b32 v16, 2, v1
  v_lshrrev_b32 v17, 5, v1
  v_mul_u32_u24 v17, 3, v17
  v_and_b32 v18, 3, v1
  v_xor_b32 v17, v17, v18
  v_lshlrev_b32 v17, 4, v17
  v_lshl_add_u32 v3, v16, 10, v17
  s_lshl_b32 s23, s20, 16
  v_add_u32 v3, s23, v3
  v_add_u32 v4, 15360, v3
  v_add_u32 v5, 30720, v3
  v_add_u32 v6, 46080, v3
  v_and_b32 v16, 3, v16
  v_lshrrev_b32 v17, 4, v1
  v_lshlrev_b32 v17, 6, v17
  v_lshl_add_u32 v16, v16, 13, v17
  s_and_b32 s23, s20, 1
  s_lshl_b32 s23, s23, 17
  v_add_u32 v16, s23, v16
  v_lshl_add_u32 v8, v18, 4, v16
  v_xor_b32 v18, 2, v18
  v_lshl_add_u32 v10, v18, 4, v16
  v_add_u32 v9, 31744, v8
  v_add_u32 v11, 95232, v10
  v_add_u32 v10, 63488, v10
  s_lshl_b32 s24, s20, 12
  s_mov_b32 s26, 0
  s_mov_b32 s27, 0
  s_mov_b32 s25, 262144
  s_mov_b32 s79, 64
  v_bfe_u32 v17, v1, 1, 3
  v_lshlrev_b32 v17, 13, v17
  v_and_b32 v18, 1, v1
  v_lshl_add_u32 v235, v18, 7, v17
  s_lshl_b32 s74, s22, 1
  s_and_b32 s31, s20, 1
  s_add_u32 s74, s74, s31
  s_lshl_b32 s74, s74, 16
  s_mov_b32 s73, 1048576
  s_and_b32 s29, s2, 31
  s_lshl_b32 s29, s29, 2
  s_add_u32 s29, s29, s20
  s_lshl_b32 s29, s29, 11
  v_and_b32 v16, 15, v1
  v_lshlrev_b32 v234, 7, v16
  v_lshlrev_b32 v17, 10, v16
  v_and_b32 v18, 16, v1
  v_lshl_add_u32 v233, v18, 3, v17
  s_and_b32 s30, s21, 3
  s_lshl_b32 s30, s30, 2
  s_add_u32 s30, s30, s20
  s_lshl_b32 s30, s30, 14
  s_waitcnt lgkmcnt(0)
  s_mov_b32 s44, s4
  s_mov_b32 s45, s5
  s_mov_b32 s46, 2621440
  s_mov_b32 s47, 0x20000
  s_mov_b32 s48, s14
  s_mov_b32 s49, s15
  s_mov_b32 s50, 1280
  s_mov_b32 s51, 0x20000
  buffer_load_dwordx4 v[160:163], v210, s[44:47], 0 offen
  buffer_load_dwordx4 v[164:167], v210, s[44:47], 0 offen offset:512
  buffer_load_dwordx4 v[168:171], v211, s[44:47], 0 offen offset:1024
  buffer_load_dwordx4 v[172:175], v212, s[48:51], 0 offen offset:0
  buffer_load_dwordx4 v[176:179], v212, s[48:51], 0 offen offset:512
  buffer_load_dwordx4 v[180:183], v212, s[48:51], 0 offen offset:1024
  s_lshl_b32 s23, s22, 18
  s_add_u32 s62, s6, s23
  s_addc_u32 s63, s7, 0
  s_mov_b32 s32, s62
  s_mov_b32 s33, s63
  s_mov_b32 s34, 262144
  s_mov_b32 s35, 0x20000
  s_cmp_ge_u32 s20, 2
  s_cselect_b32 s62, s10, s8
  s_cselect_b32 s63, s11, s9
  s_lshl_b32 s23, s21, 8
  s_add_u32 s62, s62, s23
  s_addc_u32 s63, s63, 0
  s_mov_b32 s36, s62
  s_mov_b32 s37, s63
  s_mov_b32 s38, 0
  s_mov_b32 s39, 0x20000
  s_sub_u32 s38, 4194304, s23
  buffer_load_dword v231, v235, s[36:39], s74 offen
  buffer_load_dword v232, v233, s[32:35], s30 offen
  s_add_u32 s74, s74, s73
  s_add_u32 s60, s60, s23
  s_addc_u32 s61, s61, 0
  s_sub_u32 s75, 5242880, s23
  s_mov_b32 s48, s62
  s_mov_b32 s49, s63
  s_mov_b32 s50, s38
  s_mov_b32 s51, 0x20000
  s_mov_b32 s40, s18
  s_mov_b32 s41, s19
  s_mov_b32 s42, 67108864
  s_mov_b32 s43, 0x20000
  s_mov_b32 s52, s12
  s_mov_b32 s53, s13
  s_mov_b32 s54, 5242880
  s_mov_b32 s55, 0x20000
  s_mov_b32 s56, s16
  s_mov_b32 s57, s17
  s_mov_b32 s58, 256
  s_mov_b32 s59, 0x20000
  s_lshl_b32 s23, s20, 5
  s_add_u32 s23, s23, s21
  s_lshl_b32 s23, s23, 2
  s_add_u32 s23, s23, 2641920
  s_lshl_b32 s31, s22, 9
  s_add_u32 s80, s23, s31
  s_sub_u32 s31, 7680, s31
  s_add_u32 s3, s23, s31
  s_lshl_b32 s23, s21, 7
  s_lshl_b32 s31, s22, 2
  s_add_u32 s23, s23, s31
  s_add_u32 s82, s23, 2637824
  s_and_b32 s69, s2, 63
  s_lshl_b32 s31, s20, 6
  s_add_u32 s69, s69, s31
  s_lshl_b32 s69, s69, 2
  s_add_u32 s69, s69, 2650112
  s_cmp_ge_u32 s2, 192
  s_cselect_b32 s69, s69, 1073741824
  s_cmp_eq_u32 s20, 0
  s_cselect_b32 s31, s82, 1073741824
  s_cmp_eq_u32 s2, 255
  s_cselect_b32 s23, 2629632, 1073741824
  v_lshl_add_u32 v19, v16, 2, s23
  v_mov_b32 v229, 0
  v_writelane_b32 v19, s80, 0
  v_writelane_b32 v19, s3, 1
  v_writelane_b32 v19, s31, 2
  s_and_b32 s23, s2, 1
  s_lshl_b32 s23, s23, 2
  s_add_u32 s23, s23, s20
  s_lshl_b32 s23, s23, 7
  s_lshr_b32 s31, s2, 1
  s_add_u32 s23, s23, s31
  s_lshl_b32 s23, s23, 2
  s_add_u32 s23, s23, 2654208
  v_writelane_b32 v19, s23, 3
  v_writelane_b32 v19, s69, 4
  buffer_store_dword v229, v19, s[40:43], 0 offen sc1
  s_and_b32 s71, s21, 3
  s_max_u32 s71, s71, 1
  s_lshl_b32 s72, 1, s71
  s_or_b32 s72, s72, 0x68
  s_cmp_eq_u32 s20, 0
  s_cselect_b32 s70, s2, 1073741824
  v_mov_b32 v20, 0
  v_mov_b32 v21, 0
  v_mov_b32 v22, 0
  v_mov_b32 v23, 0
  v_and_b32 v16, 15, v1
  v_lshrrev_b32 v17, 4, v1
  v_lshrrev_b32 v18, 3, v16
  v_mul_u32_u24 v18, 3, v18
  v_xor_b32 v18, v18, v17
  v_lshlrev_b32 v18, 4, v18
  v_lshl_add_u32 v14, v16, 6, v18
  s_and_b32 s23, s20, 1
  s_lshl_b32 s23, s23, 13
  v_add_u32 v14, s23, v14
  v_mfma_f32_32x32x16_bf16 a[0:15], v[20:23], v[20:23], 0
  v_mfma_f32_32x32x16_bf16 a[16:31], v[20:23], v[20:23], 0
  v_mfma_f32_32x32x16_bf16 a[32:47], v[20:23], v[20:23], 0
  v_mfma_f32_32x32x16_bf16 a[48:63], v[20:23], v[20:23], 0
  v_mfma_f32_32x32x16_bf16 a[64:79], v[20:23], v[20:23], 0
  v_mfma_f32_32x32x16_bf16 a[80:95], v[20:23], v[20:23], 0
  v_mfma_f32_32x32x16_bf16 a[96:111], v[20:23], v[20:23], 0
  v_mfma_f32_32x32x16_bf16 a[112:127], v[20:23], v[20:23], 0
  v_mfma_f32_32x32x16_bf16 a[128:143], v[20:23], v[20:23], 0
  v_mfma_f32_32x32x16_bf16 a[144:159], v[20:23], v[20:23], 0
  v_mfma_f32_32x32x16_bf16 a[160:175], v[20:23], v[20:23], 0
  v_mfma_f32_32x32x16_bf16 a[176:191], v[20:23], v[20:23], 0
  v_mfma_f32_32x32x16_bf16 a[192:207], v[20:23], v[20:23], 0
  v_mfma_f32_32x32x16_bf16 a[208:223], v[20:23], v[20:23], 0
  v_mfma_f32_32x32x16_bf16 a[224:239], v[20:23], v[20:23], 0
  v_mfma_f32_32x32x16_bf16 a[240:255], v[20:23], v[20:23], 0
  v_lshrrev_b32 v18, 2, v16
  v_lshlrev_b32 v18, 6, v18
  v_lshl_add_u32 v18, v17, 11, v18
  v_and_b32 v19, 1, v1
  v_lshl_add_u32 v18, v19, 3, v18
  v_bfe_u32 v19, v1, 1, 1
  v_and_b32 v17, 1, v17
  v_lshl_or_b32 v19, v17, 1, v19
  s_lshr_b32 s23, s20, 1
  s_lshl_b32 s23, s23, 13
  s_add_u32 s23, s23, 16384
  v_add_u32 v18, s23, v18
  v_lshl_add_u32 v12, v19, 4, v18
  v_xor_b32 v13, 32, v12
  s_waitcnt vmcnt(3)
  s_mov_b32 m0, s24
  s_nop 0
  buffer_load_dwordx4 v3, s[32:35], s26 offen offset:0 sc1 lds
  buffer_load_dwordx4 v4, s[32:35], s26 offen offset:1024 sc1 lds
  buffer_load_dwordx4 v5, s[32:35], s26 offen offset:2048 sc1 lds
  buffer_load_dwordx4 v6, s[32:35], s26 offen offset:3072 sc1 lds
  s_add_u32 m0, s24, 16384
  s_nop 0
  buffer_load_dwordx4 v8, s[36:39], s27 offen offset:0 lds
  buffer_load_dwordx4 v9, s[36:39], s27 offen offset:1024 lds
  buffer_load_dwordx4 v10, s[36:39], s27 offen offset:2048 lds
  buffer_load_dwordx4 v11, s[36:39], s27 offen offset:3072 lds
  s_add_u32 s26, s26, s79
  s_add_u32 s27, s27, s25
  s_add_u32 s24, s24, 32768
  s_and_b32 s24, s24, 0x1ffff
  v_lshlrev_b32 v184, 16, v160
  v_and_b32 v185, 0xffff0000, v160
  v_lshlrev_b32 v186, 16, v161
  v_and_b32 v187, 0xffff0000, v161
  v_lshlrev_b32 v188, 16, v162
  v_and_b32 v189, 0xffff0000, v162
  v_lshlrev_b32 v190, 16, v163
  v_and_b32 v191, 0xffff0000, v163
  v_lshlrev_b32 v192, 16, v164
  v_and_b32 v193, 0xffff0000, v164
  v_lshlrev_b32 v194, 16, v165
  v_and_b32 v195, 0xffff0000, v165
  v_lshlrev_b32 v196, 16, v166
  v_and_b32 v197, 0xffff0000, v166
  v_lshlrev_b32 v198, 16, v167
  v_and_b32 v199, 0xffff0000, v167
  v_lshlrev_b32 v200, 16, v168
  v_and_b32 v201, 0xffff0000, v168
  v_lshlrev_b32 v202, 16, v169
  v_and_b32 v203, 0xffff0000, v169
  v_lshlrev_b32 v204, 16, v170
  v_and_b32 v205, 0xffff0000, v170
  v_lshlrev_b32 v206, 16, v171
  v_and_b32 v207, 0xffff0000, v171
  v_add_f32 v213, v184, v185
  v_add_f32 v214, v186, v187
  v_add_f32 v213, v213, v188
  v_add_f32 v214, v214, v189
  v_add_f32 v213, v213, v190
  v_add_f32 v214, v214, v191
  v_add_f32 v213, v213, v192
  v_add_f32 v214, v214, v193
  v_add_f32 v213, v213, v194
  v_add_f32 v214, v214, v195
  v_add_f32 v213, v213, v196
  v_add_f32 v214, v214, v197
  v_add_f32 v213, v213, v198
  v_add_f32 v214, v214, v199
  v_add_f32 v213, v213, v200
  v_add_f32 v214, v214, v201
  v_add_f32 v213, v213, v202
  v_add_f32 v214, v214, v203
  v_add_f32 v213, v213, v204
  v_add_f32 v214, v214, v205
  v_add_f32 v213, v213, v206
  v_add_f32 v214, v214, v207
  v_add_f32 v213, v213, v214
  s_nop 1
  v_add_f32_dpp v213, v213, v213 quad_perm:[1,0,3,2] row_mask:0xf bank_mask:0xf
  s_nop 1
  v_add_f32_dpp v213, v213, v213 quad_perm:[2,3,0,1] row_mask:0xf bank_mask:0xf
  s_nop 1
  v_add_f32_dpp v213, v213, v213 row_half_mirror row_mask:0xf bank_mask:0xf
  s_nop 1
  v_add_f32_dpp v213, v213, v213 row_mirror row_mask:0xf bank_mask:0xf
  v_mov_b32 v214, v213
  s_nop 1
  v_permlane16_swap_b32 v213, v214
  v_add_f32 v213, v213, v214
  v_mul_f32 v215, 0x3acccccd, v213
  v_mov_b32 v218, 0
  v_mov_b32 v213, 0
  v_sub_f32 v16, v184, v215
  v_fmac_f32 v218, v16, v16
  v_sub_f32 v17, v185, v215
  v_fmac_f32 v218, v17, v17
  v_sub_f32 v18, v186, v215
  v_fmac_f32 v218, v18, v18
  v_sub_f32 v19, v187, v215
  v_fmac_f32 v218, v19, v19
  v_sub_f32 v16, v188, v215
  v_fmac_f32 v218, v16, v16
  v_sub_f32 v17, v189, v215
  v_fmac_f32 v218, v17, v17
  v_sub_f32 v18, v190, v215
  v_fmac_f32 v218, v18, v18
  v_sub_f32 v19, v191, v215
  v_fmac_f32 v218, v19, v19
  v_sub_f32 v16, v192, v215
  v_fmac_f32 v218, v16, v16
  v_sub_f32 v17, v193, v215
  v_fmac_f32 v218, v17, v17
  v_sub_f32 v18, v194, v215
  v_fmac_f32 v218, v18, v18
  v_sub_f32 v19, v195, v215
  v_fmac_f32 v218, v19, v19
  v_sub_f32 v16, v196, v215
  v_fmac_f32 v218, v16, v16
  v_sub_f32 v17, v197, v215
  v_fmac_f32 v218, v17, v17
  v_sub_f32 v18, v198, v215
  v_fmac_f32 v218, v18, v18
  v_sub_f32 v19, v199, v215
  v_fmac_f32 v218, v19, v19
  v_sub_f32 v16, v200, v215
  v_fmac_f32 v213, v16, v16
  v_sub_f32 v17, v201, v215
  v_fmac_f32 v213, v17, v17
  v_sub_f32 v18, v202, v215
  v_fmac_f32 v213, v18, v18
  v_sub_f32 v19, v203, v215
  v_fmac_f32 v213, v19, v19
  v_sub_f32 v16, v204, v215
  v_fmac_f32 v213, v16, v16
  v_sub_f32 v17, v205, v215
  v_fmac_f32 v213, v17, v17
  v_sub_f32 v18, v206, v215
  v_fmac_f32 v213, v18, v18
  v_sub_f32 v19, v207, v215
  v_fmac_f32 v213, v19, v19
  v_cndmask_b32 v213, 0, v213, s[64:65]
  v_add_f32 v213, v213, v218
  s_nop 1
  v_add_f32_dpp v213, v213, v213 quad_perm:[1,0,3,2] row_mask:0xf bank_mask:0xf
  s_nop 1
  v_add_f32_dpp v213, v213, v213 quad_perm:[2,3,0,1] row_mask:0xf bank_mask:0xf
  s_nop 1
  v_add_f32_dpp v213, v213, v213 row_half_mirror row_mask:0xf bank_mask:0xf
  s_nop 1
  v_add_f32_dpp v213, v213, v213 row_mirror row_mask:0xf bank_mask:0xf
  v_mov_b32 v214, v213
  s_nop 1
  v_permlane16_swap_b32 v213, v214
  v_add_f32 v213, v213, v214
  v_mul_f32 v213, 0x3acccccd, v213
  v_cvt_pk_bf16_f32 v213, v213, v213
  v_and_b32 v213, 0xffff0000, v213
  v_add_f32 v213, 0x3727c5ac, v213
  v_cvt_pk_bf16_f32 v213, v213, v213
  v_and_b32 v213, 0xffff0000, v213
  v_sqrt_f32 v213, v213
  v_mov_b32 v216, v215
  v_cvt_pk_bf16_f32 v213, v213, v213
  v_and_b32 v213, 0xffff0000, v213
  v_rcp_f32 v217, v213
  v_cvt_pk_bf16_f32 v216, v216, v216
  v_and_b32 v216, 0xffff0000, v216
  s_mov_b32 m0, s24
  s_nop 0
  buffer_load_dwordx4 v3, s[32:35], s26 offen offset:0 sc1 lds
  buffer_load_dwordx4 v4, s[32:35], s26 offen offset:1024 sc1 lds
  buffer_load_dwordx4 v5, s[32:35], s26 offen offset:2048 sc1 lds
  buffer_load_dwordx4 v6, s[32:35], s26 offen offset:3072 sc1 lds
  s_add_u32 m0, s24, 16384
  s_nop 0
  buffer_load_dwordx4 v8, s[36:39], s27 offen offset:0 lds
  buffer_load_dwordx4 v9, s[36:39], s27 offen offset:1024 lds
  buffer_load_dwordx4 v10, s[36:39], s27 offen offset:2048 lds
  buffer_load_dwordx4 v11, s[36:39], s27 offen offset:3072 lds
  s_add_u32 s26, s26, s79
  s_add_u32 s27, s27, s25
  s_add_u32 s24, s24, 32768
  s_and_b32 s24, s24, 0x1ffff
  v_mov_b32 v218, 0
  v_sub_f32 v184, v184, v216
  v_sub_f32 v185, v185, v216
  v_cvt_pk_bf16_f32 v16, v184, v185
  v_lshlrev_b32 v184, 16, v16
  v_and_b32 v185, 0xffff0000, v16
  v_mul_f32 v184, v184, v217
  v_mul_f32 v185, v185, v217
  v_cvt_pk_bf16_f32 v160, v184, v185
  v_lshlrev_b32 v184, 16, v160
  v_and_b32 v185, 0xffff0000, v160
  v_lshlrev_b32 v17, 16, v172
  v_and_b32 v18, 0xffff0000, v172
  v_fmac_f32 v218, v184, v17
  v_fmac_f32 v218, v185, v18
  v_sub_f32 v186, v186, v216
  v_sub_f32 v187, v187, v216
  v_cvt_pk_bf16_f32 v16, v186, v187
  v_lshlrev_b32 v186, 16, v16
  v_and_b32 v187, 0xffff0000, v16
  v_mul_f32 v186, v186, v217
  v_mul_f32 v187, v187, v217
  v_cvt_pk_bf16_f32 v161, v186, v187
  v_lshlrev_b32 v186, 16, v161
  v_and_b32 v187, 0xffff0000, v161
  v_lshlrev_b32 v17, 16, v173
  v_and_b32 v18, 0xffff0000, v173
  v_fmac_f32 v218, v186, v17
  v_fmac_f32 v218, v187, v18
  v_sub_f32 v188, v188, v216
  v_sub_f32 v189, v189, v216
  v_cvt_pk_bf16_f32 v16, v188, v189
  v_lshlrev_b32 v188, 16, v16
  v_and_b32 v189, 0xffff0000, v16
  v_mul_f32 v188, v188, v217
  v_mul_f32 v189, v189, v217
  v_cvt_pk_bf16_f32 v162, v188, v189
  v_lshlrev_b32 v188, 16, v162
  v_and_b32 v189, 0xffff0000, v162
  v_lshlrev_b32 v17, 16, v174
  v_and_b32 v18, 0xffff0000, v174
  v_fmac_f32 v218, v188, v17
  v_fmac_f32 v218, v189, v18
  v_sub_f32 v190, v190, v216
  v_sub_f32 v191, v191, v216
  v_cvt_pk_bf16_f32 v16, v190, v191
  v_lshlrev_b32 v190, 16, v16
  v_and_b32 v191, 0xffff0000, v16
  v_mul_f32 v190, v190, v217
  v_mul_f32 v191, v191, v217
  v_cvt_pk_bf16_f32 v163, v190, v191
  v_lshlrev_b32 v190, 16, v163
  v_and_b32 v191, 0xffff0000, v163
  v_lshlrev_b32 v17, 16, v175
  v_and_b32 v18, 0xffff0000, v175
  v_fmac_f32 v218, v190, v17
  v_fmac_f32 v218, v191, v18
  v_sub_f32 v192, v192, v216
  v_sub_f32 v193, v193, v216
  v_cvt_pk_bf16_f32 v16, v192, v193
  v_lshlrev_b32 v192, 16, v16
  v_and_b32 v193, 0xffff0000, v16
  v_mul_f32 v192, v192, v217
  v_mul_f32 v193, v193, v217
  v_cvt_pk_bf16_f32 v164, v192, v193
  v_lshlrev_b32 v192, 16, v164
  v_and_b32 v193, 0xffff0000, v164
  v_lshlrev_b32 v17, 16, v176
  v_and_b32 v18, 0xffff0000, v176
  v_fmac_f32 v218, v192, v17
  v_fmac_f32 v218, v193, v18
  v_sub_f32 v194, v194, v216
  v_sub_f32 v195, v195, v216
  v_cvt_pk_bf16_f32 v16, v194, v195
  v_lshlrev_b32 v194, 16, v16
  v_and_b32 v195, 0xffff0000, v16
  v_mul_f32 v194, v194, v217
  v_mul_f32 v195, v195, v217
  v_cvt_pk_bf16_f32 v165, v194, v195
  v_lshlrev_b32 v194, 16, v165
  v_and_b32 v195, 0xffff0000, v165
  v_lshlrev_b32 v17, 16, v177
  v_and_b32 v18, 0xffff0000, v177
  v_fmac_f32 v218, v194, v17
  v_fmac_f32 v218, v195, v18
  v_sub_f32 v196, v196, v216
  v_sub_f32 v197, v197, v216
  v_cvt_pk_bf16_f32 v16, v196, v197
  v_lshlrev_b32 v196, 16, v16
  v_and_b32 v197, 0xffff0000, v16
  v_mul_f32 v196, v196, v217
  v_mul_f32 v197, v197, v217
  v_cvt_pk_bf16_f32 v166, v196, v197
  v_lshlrev_b32 v196, 16, v166
  v_and_b32 v197, 0xffff0000, v166
  v_lshlrev_b32 v17, 16, v178
  v_and_b32 v18, 0xffff0000, v178
  v_fmac_f32 v218, v196, v17
  v_fmac_f32 v218, v197, v18
  v_sub_f32 v198, v198, v216
  v_sub_f32 v199, v199, v216
  v_cvt_pk_bf16_f32 v16, v198, v199
  v_lshlrev_b32 v198, 16, v16
  v_and_b32 v199, 0xffff0000, v16
  v_mul_f32 v198, v198, v217
  v_mul_f32 v199, v199, v217
  v_cvt_pk_bf16_f32 v167, v198, v199
  v_lshlrev_b32 v198, 16, v167
  v_and_b32 v199, 0xffff0000, v167
  v_lshlrev_b32 v17, 16, v179
  v_and_b32 v18, 0xffff0000, v179
  v_fmac_f32 v218, v198, v17
  v_fmac_f32 v218, v199, v18
  v_sub_f32 v200, v200, v216
  v_sub_f32 v201, v201, v216
  v_cvt_pk_bf16_f32 v16, v200, v201
  v_lshlrev_b32 v200, 16, v16
  v_and_b32 v201, 0xffff0000, v16
  v_mul_f32 v200, v200, v217
  v_mul_f32 v201, v201, v217
  v_cvt_pk_bf16_f32 v168, v200, v201
  v_lshlrev_b32 v200, 16, v168
  v_and_b32 v201, 0xffff0000, v168
  v_lshlrev_b32 v17, 16, v180
  v_and_b32 v18, 0xffff0000, v180
  v_fmac_f32 v218, v200, v17
  v_fmac_f32 v218, v201, v18
  v_sub_f32 v202, v202, v216
  v_sub_f32 v203, v203, v216
  v_cvt_pk_bf16_f32 v16, v202, v203
  v_lshlrev_b32 v202, 16, v16
  v_and_b32 v203, 0xffff0000, v16
  v_mul_f32 v202, v202, v217
  v_mul_f32 v203, v203, v217
  v_cvt_pk_bf16_f32 v169, v202, v203
  v_lshlrev_b32 v202, 16, v169
  v_and_b32 v203, 0xffff0000, v169
  v_lshlrev_b32 v17, 16, v181
  v_and_b32 v18, 0xffff0000, v181
  v_fmac_f32 v218, v202, v17
  v_fmac_f32 v218, v203, v18
  v_sub_f32 v204, v204, v216
  v_sub_f32 v205, v205, v216
  v_cvt_pk_bf16_f32 v16, v204, v205
  v_lshlrev_b32 v204, 16, v16
  v_and_b32 v205, 0xffff0000, v16
  v_mul_f32 v204, v204, v217
  v_mul_f32 v205, v205, v217
  v_cvt_pk_bf16_f32 v170, v204, v205
  v_lshlrev_b32 v204, 16, v170
  v_and_b32 v205, 0xffff0000, v170
  v_lshlrev_b32 v17, 16, v182
  v_and_b32 v18, 0xffff0000, v182
  v_fmac_f32 v218, v204, v17
  v_fmac_f32 v218, v205, v18
  v_sub_f32 v206, v206, v216
  v_sub_f32 v207, v207, v216
  v_cvt_pk_bf16_f32 v16, v206, v207
  v_lshlrev_b32 v206, 16, v16
  v_and_b32 v207, 0xffff0000, v16
  v_mul_f32 v206, v206, v217
  v_mul_f32 v207, v207, v217
  v_cvt_pk_bf16_f32 v171, v206, v207
  v_lshlrev_b32 v206, 16, v171
  v_and_b32 v207, 0xffff0000, v171
  v_lshlrev_b32 v17, 16, v183
  v_and_b32 v18, 0xffff0000, v183
  v_fmac_f32 v218, v206, v17
  v_fmac_f32 v218, v207, v18
  s_mov_b32 m0, s24
  s_nop 0
  buffer_load_dwordx4 v3, s[32:35], s26 offen offset:0 sc1 lds
  buffer_load_dwordx4 v4, s[32:35], s26 offen offset:1024 sc1 lds
  buffer_load_dwordx4 v5, s[32:35], s26 offen offset:2048 sc1 lds
  buffer_load_dwordx4 v6, s[32:35], s26 offen offset:3072 sc1 lds
  s_add_u32 m0, s24, 16384
  s_nop 0
  buffer_load_dwordx4 v8, s[36:39], s27 offen offset:0 lds
  buffer_load_dwordx4 v9, s[36:39], s27 offen offset:1024 lds
  buffer_load_dwordx4 v10, s[36:39], s27 offen offset:2048 lds
  buffer_load_dwordx4 v11, s[36:39], s27 offen offset:3072 lds
  s_add_u32 s26, s26, s79
  s_add_u32 s27, s27, s25
  s_add_u32 s24, s24, 32768
  s_and_b32 s24, s24, 0x1ffff
  v_and_b32 v16, 7, v209
  v_lshlrev_b32 v16, 4, v16
  v_lshl_add_u32 v16, v208, 7, v16
  v_add_u32 v16, 131072, v16
  ds_write_b128 v16, v[160:163] offset:0
  ds_write_b128 v16, v[164:167] offset:4096
  ds_write_b128 v16, v[168:171] offset:8192
  s_nop 1
  v_add_f32_dpp v218, v218, v218 quad_perm:[1,0,3,2] row_mask:0xf bank_mask:0xf
  s_nop 1
  v_add_f32_dpp v218, v218, v218 quad_perm:[2,3,0,1] row_mask:0xf bank_mask:0xf
  s_nop 1
  v_add_f32_dpp v218, v218, v218 row_half_mirror row_mask:0xf bank_mask:0xf
  s_nop 1
  v_add_f32_dpp v218, v218, v218 row_mirror row_mask:0xf bank_mask:0xf
  v_mov_b32 v214, v218
  s_nop 1
  v_permlane16_swap_b32 v218, v214
  v_add_f32 v218, v218, v214
  v_cvt_pk_bf16_f32 v218, v218, v218
  v_and_b32 v218, 0xffff0000, v218
  v_ashrrev_i32 v214, 31, v218
  v_or_b32 v214, 0x80000000, v214
  v_xor_b32 v218, v218, v214
  v_and_b32 v218, 0xffff0000, v218
  v_sub_u32 v214, 0xffff, v209
  v_or_b32 v218, v218, v214
  v_lshlrev_b32 v214, 2, v209
  v_add_u32 v214, 2621440, v214
  v_mov_b32 v19, 1073741824
  v_cmp_eq_u32 vcc, 0, v208
  v_lshlrev_b32 v16, 4, v0
  v_add_u32 v16, 131072, v16
  v_cndmask_b32 v214, v19, v214, vcc
  v_lshrrev_b32 v17, 3, v0
  v_and_b32 v18, 7, v0
  v_lshlrev_b32 v18, 4, v18
  v_lshl_add_u32 v17, v17, 8, v18
  v_cmp_gt_u32 vcc, 128, v0
  s_lshr_b32 s23, s2, 1
  s_mul_i32 s23, s23, 20480
  s_and_b32 s31, s2, 1
  s_lshl_b32 s31, s31, 7
  s_add_u32 s23, s23, s31
  v_cndmask_b32 v18, v19, v17, vcc
  s_mov_b32 s66, s23
  s_add_u32 s67, s23, 8192
  s_add_u32 s68, s23, 16384
  s_mov_b32 m0, s24
  s_nop 0
  buffer_load_dwordx4 v3, s[32:35], s26 offen offset:0 sc1 lds
  buffer_load_dwordx4 v4, s[32:35], s26 offen offset:1024 sc1 lds
  buffer_load_dwordx4 v5, s[32:35], s26 offen offset:2048 sc1 lds
  buffer_load_dwordx4 v6, s[32:35], s26 offen offset:3072 sc1 lds
  s_add_u32 m0, s24, 16384
  s_nop 0
  buffer_load_dwordx4 v8, s[36:39], s27 offen offset:0 lds
  buffer_load_dwordx4 v9, s[36:39], s27 offen offset:1024 lds
  buffer_load_dwordx4 v10, s[36:39], s27 offen offset:2048 lds
  buffer_load_dwordx4 v11, s[36:39], s27 offen offset:3072 lds
  s_add_u32 s26, s26, s79
  s_add_u32 s27, s27, s25
  s_add_u32 s24, s24, 32768
  s_and_b32 s24, s24, 0x1ffff
  s_waitcnt vmcnt(24) lgkmcnt(0)
  s_barrier
  ds_read_b128 v[160:163], v16 offset:0
  ds_read_b128 v[164:167], v16 offset:4096
  ds_read_b128 v[168:171], v16 offset:8192
  buffer_load_dword v231, v235, s[36:39], s74 offen
  buffer_load_dword v232, v234, s[32:35], s29 offen
  s_getpc_b64 s[62:63]
fa_pc:
  s_lshr_b32 s23, s2, 3
  s_and_b32 s23, s23, 15
  s_lshl_b32 s23, s23, 2
  s_add_u32 s23, s23, s20
  s_lshl_b32 s23, s23, 11
  s_min_u32 s23, s23, fa_codeend-fa_pc-2048
  v_add_u32 v234, s23, v234
  global_load_dword v231, v234, s[62:63]
  buffer_store_dword v218, v214, s[40:43], 0 offen sc1
  s_mov_b32 s28, 0
  s_waitcnt lgkmcnt(0)
  buffer_store_dwordx4 v[160:163], v17, s[40:43], s66 offen sc1
  buffer_store_dwordx4 v[164:167], v17, s[40:43], s67 offen sc1
  buffer_store_dwordx4 v[168:171], v18, s[40:43], s68 offen sc1
  s_cmp_ge_u32 s20, 2
  s_cbranch_scc1 fa_roleV
  ds_read_b128 v[96:99], v14 offset:0
  ds_read_b128 v[100:103], v14 offset:1024
  ds_read_b128 v[104:107], v14 offset:2048
  ds_read_b128 v[108:111], v14 offset:3072
  ds_read_b128 v[112:115], v14 offset:4096
  ds_read_b128 v[116:119], v14 offset:5120
  ds_read_b128 v[120:123], v14 offset:6144
  ds_read_b128 v[124:127], v14 offset:7168
  ds_read_b64_tr_b16 v[32:33], v12 offset:0
  ds_read_b64_tr_b16 v[34:35], v12 offset:1024
  ds_read_b64_tr_b16 v[36:37], v13 offset:0
  ds_read_b64_tr_b16 v[38:39], v13 offset:1024
  ds_read_b64_tr_b16 v[40:41], v12 offset:256
  ds_read_b64_tr_b16 v[42:43], v12 offset:1280
  ds_read_b64_tr_b16 v[44:45], v13 offset:256
  ds_read_b64_tr_b16 v[46:47], v13 offset:1280
  ds_read_b64_tr_b16 v[48:49], v12 offset:512
  ds_read_b64_tr_b16 v[50:51], v12 offset:1536
  ds_read_b64_tr_b16 v[52:53], v13 offset:512
  ds_read_b64_tr_b16 v[54:55], v13 offset:1536
  ds_read_b64_tr_b16 v[56:57], v12 offset:768
  ds_read_b64_tr_b16 v[58:59], v12 offset:1792
  ds_read_b64_tr_b16 v[60:61], v13 offset:768
  ds_read_b64_tr_b16 v[62:63], v13 offset:1792
  s_waitcnt lgkmcnt(0)
.p2align 6
fa_loopK:
  v_mfma_f32_16x16x32_bf16 a[0:3], v[32:35], v[96:99], a[0:3]
  s_waitcnt vmcnt(17)
  v_mfma_f32_16x16x32_bf16 a[4:7], v[32:35], v[100:103], a[4:7]
  s_barrier
  v_mfma_f32_16x16x32_bf16 a[8:11], v[32:35], v[104:107], a[8:11]
  s_bitcmp1_b32 s72, s28
  ds_read_b64_tr_b16 v[64:65], v12 offset:32768
  v_mfma_f32_16x16x32_bf16 a[12:15], v[32:35], v[108:111], a[12:15]
  s_cbranch_scc1 fa_p1stubK
fa_p1backK:
  v_mfma_f32_16x16x32_bf16 a[16:19], v[32:35], v[112:115], a[16:19]
  s_mov_b32 m0, s24
  ds_read_b64_tr_b16 v[66:67], v12 offset:33792
  v_mfma_f32_16x16x32_bf16 a[20:23], v[32:35], v[116:119], a[20:23]
  buffer_load_dwordx4 v3, s[32:35], s26 offen offset:0 sc1 lds
  v_mfma_f32_16x16x32_bf16 a[24:27], v[32:35], v[120:123], a[24:27]
  ds_read_b128 v[128:131], v14 offset:32768
  v_mfma_f32_16x16x32_bf16 a[28:31], v[32:35], v[124:127], a[28:31]
  buffer_load_dwordx4 v4, s[32:35], s26 offen offset:1024 sc1 lds
  v_mfma_f32_16x16x32_bf16 a[32:35], v[36:39], v[96:99], a[32:35]
  ds_read_b64_tr_b16 v[68:69], v13 offset:32768
  v_mfma_f32_16x16x32_bf16 a[36:39], v[36:39], v[100:103], a[36:39]
  buffer_load_dwordx4 v5, s[32:35], s26 offen offset:2048 sc1 lds
  v_mfma_f32_16x16x32_bf16 a[40:43], v[36:39], v[104:107], a[40:43]
  ds_read_b64_tr_b16 v[70:71], v13 offset:33792
  v_mfma_f32_16x16x32_bf16 a[44:47], v[36:39], v[108:111], a[44:47]
  buffer_load_dwordx4 v6, s[32:35], s26 offen offset:3072 sc1 lds
  v_mfma_f32_16x16x32_bf16 a[48:51], v[36:39], v[112:115], a[48:51]
  s_add_u32 m0, s24, 16384
  ds_read_b128 v[132:135], v14 offset:33792
  v_mfma_f32_16x16x32_bf16 a[52:55], v[36:39], v[116:119], a[52:55]
  buffer_load_dwordx4 v8, s[36:39], s27 offen offset:0 lds
  v_mfma_f32_16x16x32_bf16 a[56:59], v[36:39], v[120:123], a[56:59]
  ds_read_b64_tr_b16 v[72:73], v12 offset:33024
  v_mfma_f32_16x16x32_bf16 a[60:63], v[36:39], v[124:127], a[60:63]
  buffer_load_dwordx4 v9, s[36:39], s27 offen offset:1024 lds
  v_mfma_f32_16x16x32_bf16 a[64:67], v[40:43], v[96:99], a[64:67]
  ds_read_b64_tr_b16 v[74:75], v12 offset:34048
  v_mfma_f32_16x16x32_bf16 a[68:71], v[40:43], v[100:103], a[68:71]
  buffer_load_dwordx4 v10, s[36:39], s27 offen offset:2048 lds
  v_mfma_f32_16x16x32_bf16 a[72:75], v[40:43], v[104:107], a[72:75]
  ds_read_b128 v[136:139], v14 offset:34816
  v_mfma_f32_16x16x32_bf16 a[76:79], v[40:43], v[108:111], a[76:79]
  buffer_load_dwordx4 v11, s[36:39], s27 offen offset:3072 lds
  v_mfma_f32_16x16x32_bf16 a[80:83], v[40:43], v[112:115], a[80:83]
  ds_read_b64_tr_b16 v[76:77], v13 offset:33024
  v_mfma_f32_16x16x32_bf16 a[84:87], v[40:43], v[116:119], a[84:87]
  buffer_load_dword v231, v235, s[48:51], s74 offen
  v_mfma_f32_16x16x32_bf16 a[88:91], v[40:43], v[120:123], a[88:91]
  s_add_u32 s74, s74, s73
  ds_read_b64_tr_b16 v[78:79], v13 offset:34048
  v_mfma_f32_16x16x32_bf16 a[92:95], v[40:43], v[124:127], a[92:95]
  v_mfma_f32_16x16x32_bf16 a[96:99], v[44:47], v[96:99], a[96:99]
  ds_read_b128 v[140:143], v14 offset:35840
  v_mfma_f32_16x16x32_bf16 a[100:103], v[44:47], v[100:103], a[100:103]
  v_mfma_f32_16x16x32_bf16 a[104:107], v[44:47], v[104:107], a[104:107]
  ds_read_b64_tr_b16 v[80:81], v12 offset:33280
  v_mfma_f32_16x16x32_bf16 a[108:111], v[44:47], v[108:111], a[108:111]
  v_mfma_f32_16x16x32_bf16 a[112:115], v[44:47], v[112:115], a[112:115]
  ds_read_b64_tr_b16 v[82:83], v12 offset:34304
  v_mfma_f32_16x16x32_bf16 a[116:119], v[44:47], v[116:119], a[116:119]
  v_mfma_f32_16x16x32_bf16 a[120:123], v[44:47], v[120:123], a[120:123]
  ds_read_b128 v[144:147], v14 offset:36864
  v_mfma_f32_16x16x32_bf16 a[124:127], v[44:47], v[124:127], a[124:127]
  v_mfma_f32_16x16x32_bf16 a[128:131], v[48:51], v[96:99], a[128:131]
  ds_read_b64_tr_b16 v[84:85], v13 offset:33280
  v_mfma_f32_16x16x32_bf16 a[132:135], v[48:51], v[100:103], a[132:135]
  v_mfma_f32_16x16x32_bf16 a[136:139], v[48:51], v[104:107], a[136:139]
  ds_read_b64_tr_b16 v[86:87], v13 offset:34304
  v_mfma_f32_16x16x32_bf16 a[140:143], v[48:51], v[108:111], a[140:143]
  v_mfma_f32_16x16x32_bf16 a[144:147], v[48:51], v[112:115], a[144:147]
  ds_read_b128 v[148:151], v14 offset:37888
  v_mfma_f32_16x16x32_bf16 a[148:151], v[48:51], v[116:119], a[148:151]
  v_mfma_f32_16x16x32_bf16 a[152:155], v[48:51], v[120:123], a[152:155]
  ds_read_b64_tr_b16 v[88:89], v12 offset:33536
  v_mfma_f32_16x16x32_bf16 a[156:159], v[48:51], v[124:127], a[156:159]
  v_mfma_f32_16x16x32_bf16 a[160:163], v[52:55], v[96:99], a[160:163]
  ds_read_b64_tr_b16 v[90:91], v12 offset:34560
  v_mfma_f32_16x16x32_bf16 a[164:167], v[52:55], v[100:103], a[164:167]
  v_mfma_f32_16x16x32_bf16 a[168:171], v[52:55], v[104:107], a[168:171]
  ds_read_b128 v[152:155], v14 offset:38912
  v_mfma_f32_16x16x32_bf16 a[172:175], v[52:55], v[108:111], a[172:175]
  v_mfma_f32_16x16x32_bf16 a[176:179], v[52:55], v[112:115], a[176:179]
  ds_read_b64_tr_b16 v[92:93], v13 offset:33536
  v_mfma_f32_16x16x32_bf16 a[180:183], v[52:55], v[116:119], a[180:183]
  v_mfma_f32_16x16x32_bf16 a[184:187], v[52:55], v[120:123], a[184:187]
  ds_read_b64_tr_b16 v[94:95], v13 offset:34560
  v_mfma_f32_16x16x32_bf16 a[188:191], v[52:55], v[124:127], a[188:191]
  v_mfma_f32_16x16x32_bf16 a[192:195], v[56:59], v[96:99], a[192:195]
  s_add_u32 s26, s26, s79
  ds_read_b128 v[156:159], v14 offset:39936
  v_mfma_f32_16x16x32_bf16 a[196:199], v[56:59], v[100:103], a[196:199]
  s_add_u32 s27, s27, s25
  v_mfma_f32_16x16x32_bf16 a[200:203], v[56:59], v[104:107], a[200:203]
  s_add_u32 s24, s24, 32768
  v_mfma_f32_16x16x32_bf16 a[204:207], v[56:59], v[108:111], a[204:207]
  s_and_b32 s24, s24, 0x1ffff
  v_mfma_f32_16x16x32_bf16 a[208:211], v[56:59], v[112:115], a[208:211]
  v_xor_b32 v14, 0x10000, v14
  v_mfma_f32_16x16x32_bf16 a[212:215], v[56:59], v[116:119], a[212:215]
  v_xor_b32 v12, 0x10000, v12
  v_mfma_f32_16x16x32_bf16 a[216:219], v[56:59], v[120:123], a[216:219]
  v_xor_b32 v13, 0x10000, v13
  v_mfma_f32_16x16x32_bf16 a[220:223], v[56:59], v[124:127], a[220:223]
  v_mfma_f32_16x16x32_bf16 a[224:227], v[60:63], v[96:99], a[224:227]
  v_mfma_f32_16x16x32_bf16 a[228:231], v[60:63], v[100:103], a[228:231]
  v_mfma_f32_16x16x32_bf16 a[232:235], v[60:63], v[104:107], a[232:235]
  v_mfma_f32_16x16x32_bf16 a[236:239], v[60:63], v[108:111], a[236:239]
  v_mfma_f32_16x16x32_bf16 a[240:243], v[60:63], v[112:115], a[240:243]
  v_mfma_f32_16x16x32_bf16 a[244:247], v[60:63], v[116:119], a[244:247]
  v_mfma_f32_16x16x32_bf16 a[248:251], v[60:63], v[120:123], a[248:251]
  v_mfma_f32_16x16x32_bf16 a[252:255], v[60:63], v[124:127], a[252:255]
  s_waitcnt lgkmcnt(0)
  v_mfma_f32_16x16x32_bf16 a[0:3], v[64:67], v[128:131], a[0:3]
  s_waitcnt vmcnt(18)
  v_mfma_f32_16x16x32_bf16 a[4:7], v[64:67], v[132:135], a[4:7]
  s_barrier
  v_mfma_f32_16x16x32_bf16 a[8:11], v[64:67], v[136:139], a[8:11]
  ds_read_b64_tr_b16 v[32:33], v12 offset:0
  v_mfma_f32_16x16x32_bf16 a[12:15], v[64:67], v[140:143], a[12:15]
  v_mfma_f32_16x16x32_bf16 a[16:19], v[64:67], v[144:147], a[16:19]
  s_mov_b32 m0, s24
  ds_read_b64_tr_b16 v[34:35], v12 offset:1024
  v_mfma_f32_16x16x32_bf16 a[20:23], v[64:67], v[148:151], a[20:23]
  buffer_load_dwordx4 v3, s[32:35], s26 offen offset:0 sc1 lds
  v_mfma_f32_16x16x32_bf16 a[24:27], v[64:67], v[152:155], a[24:27]
  ds_read_b128 v[96:99], v14 offset:0
  v_mfma_f32_16x16x32_bf16 a[28:31], v[64:67], v[156:159], a[28:31]
  v_mfma_f32_16x16x32_bf16 a[32:35], v[68:71], v[128:131], a[32:35]
  ds_read_b64_tr_b16 v[36:37], v13 offset:0
  v_mfma_f32_16x16x32_bf16 a[36:39], v[68:71], v[132:135], a[36:39]
  v_mfma_f32_16x16x32_bf16 a[40:43], v[68:71], v[136:139], a[40:43]
  ds_read_b64_tr_b16 v[38:39], v13 offset:1024
  v_mfma_f32_16x16x32_bf16 a[44:47], v[68:71], v[140:143], a[44:47]
  buffer_load_dwordx4 v4, s[32:35], s26 offen offset:1024 sc1 lds
  v_mfma_f32_16x16x32_bf16 a[48:51], v[68:71], v[144:147], a[48:51]
  ds_read_b128 v[100:103], v14 offset:1024
  v_mfma_f32_16x16x32_bf16 a[52:55], v[68:71], v[148:151], a[52:55]
  v_mfma_f32_16x16x32_bf16 a[56:59], v[68:71], v[152:155], a[56:59]
  ds_read_b64_tr_b16 v[40:41], v12 offset:256
  v_mfma_f32_16x16x32_bf16 a[60:63], v[68:71], v[156:159], a[60:63]
  v_mfma_f32_16x16x32_bf16 a[64:67], v[72:75], v[128:131], a[64:67]
  ds_read_b64_tr_b16 v[42:43], v12 offset:1280
  v_mfma_f32_16x16x32_bf16 a[68:71], v[72:75], v[132:135], a[68:71]
  buffer_load_dwordx4 v5, s[32:35], s26 offen offset:2048 sc1 lds
  v_mfma_f32_16x16x32_bf16 a[72:75], v[72:75], v[136:139], a[72:75]
  ds_read_b128 v[104:107], v14 offset:2048
  v_mfma_f32_16x16x32_bf16 a[76:79], v[72:75], v[140:143], a[76:79]
  v_mfma_f32_16x16x32_bf16 a[80:83], v[72:75], v[144:147], a[80:83]
  ds_read_b64_tr_b16 v[44:45], v13 offset:256
  v_mfma_f32_16x16x32_bf16 a[84:87], v[72:75], v[148:151], a[84:87]
  v_mfma_f32_16x16x32_bf16 a[88:91], v[72:75], v[152:155], a[88:91]
  ds_read_b64_tr_b16 v[46:47], v13 offset:1280
  v_mfma_f32_16x16x32_bf16 a[92:95], v[72:75], v[156:159], a[92:95]
  buffer_load_dwordx4 v6, s[32:35], s26 offen offset:3072 sc1 lds
  v_mfma_f32_16x16x32_bf16 a[96:99], v[76:79], v[128:131], a[96:99]
  ds_read_b128 v[108:111], v14 offset:3072
  v_mfma_f32_16x16x32_bf16 a[100:103], v[76:79], v[132:135], a[100:103]
  v_mfma_f32_16x16x32_bf16 a[104:107], v[76:79], v[136:139], a[104:107]
  ds_read_b64_tr_b16 v[48:49], v12 offset:512
  v_mfma_f32_16x16x32_bf16 a[108:111], v[76:79], v[140:143], a[108:111]
  v_mfma_f32_16x16x32_bf16 a[112:115], v[76:79], v[144:147], a[112:115]
  s_add_u32 m0, s24, 16384
  ds_read_b64_tr_b16 v[50:51], v12 offset:1536
  v_mfma_f32_16x16x32_bf16 a[116:119], v[76:79], v[148:151], a[116:119]
  buffer_load_dwordx4 v8, s[36:39], s27 offen offset:0 lds
  v_mfma_f32_16x16x32_bf16 a[120:123], v[76:79], v[152:155], a[120:123]
  ds_read_b128 v[112:115], v14 offset:4096
  v_mfma_f32_16x16x32_bf16 a[124:127], v[76:79], v[156:159], a[124:127]
  v_mfma_f32_16x16x32_bf16 a[128:131], v[80:83], v[128:131], a[128:131]
  ds_read_b64_tr_b16 v[52:53], v13 offset:512
  v_mfma_f32_16x16x32_bf16 a[132:135], v[80:83], v[132:135], a[132:135]
  v_mfma_f32_16x16x32_bf16 a[136:139], v[80:83], v[136:139], a[136:139]
  ds_read_b64_tr_b16 v[54:55], v13 offset:1536
  v_mfma_f32_16x16x32_bf16 a[140:143], v[80:83], v[140:143], a[140:143]
  buffer_load_dwordx4 v9, s[36:39], s27 offen offset:1024 lds
  v_mfma_f32_16x16x32_bf16 a[144:147], v[80:83], v[144:147], a[144:147]
  ds_read_b128 v[116:119], v14 offset:5120
  v_mfma_f32_16x16x32_bf16 a[148:151], v[80:83], v[148:151], a[148:151]
  v_mfma_f32_16x16x32_bf16 a[152:155], v[80:83], v[152:155], a[152:155]
  ds_read_b64_tr_b16 v[56:57], v12 offset:768
  v_mfma_f32_16x16x32_bf16 a[156:159], v[80:83], v[156:159], a[156:159]
  v_mfma_f32_16x16x32_bf16 a[160:163], v[84:87], v[128:131], a[160:163]
  ds_read_b64_tr_b16 v[58:59], v12 offset:1792
  v_mfma_f32_16x16x32_bf16 a[164:167], v[84:87], v[132:135], a[164:167]
  buffer_load_dwordx4 v10, s[36:39], s27 offen offset:2048 lds
  v_mfma_f32_16x16x32_bf16 a[168:171], v[84:87], v[136:139], a[168:171]
  ds_read_b128 v[120:123], v14 offset:6144
  v_mfma_f32_16x16x32_bf16 a[172:175], v[84:87], v[140:143], a[172:175]
  v_mfma_f32_16x16x32_bf16 a[176:179], v[84:87], v[144:147], a[176:179]
  ds_read_b64_tr_b16 v[60:61], v13 offset:768
  v_mfma_f32_16x16x32_bf16 a[180:183], v[84:87], v[148:151], a[180:183]
  v_mfma_f32_16x16x32_bf16 a[184:187], v[84:87], v[152:155], a[184:187]
  ds_read_b64_tr_b16 v[62:63], v13 offset:1792
  v_mfma_f32_16x16x32_bf16 a[188:191], v[84:87], v[156:159], a[188:191]
  buffer_load_dwordx4 v11, s[36:39], s27 offen offset:3072 lds
  v_mfma_f32_16x16x32_bf16 a[192:195], v[88:91], v[128:131], a[192:195]
  s_add_u32 s26, s26, s79
  ds_read_b128 v[124:127], v14 offset:7168
  v_mfma_f32_16x16x32_bf16 a[196:199], v[88:91], v[132:135], a[196:199]
  s_add_u32 s27, s27, s25
  v_mfma_f32_16x16x32_bf16 a[200:203], v[88:91], v[136:139], a[200:203]
  s_add_u32 s24, s24, 32768
  v_mfma_f32_16x16x32_bf16 a[204:207], v[88:91], v[140:143], a[204:207]
  s_and_b32 s24, s24, 0x1ffff
  v_mfma_f32_16x16x32_bf16 a[208:211], v[88:91], v[144:147], a[208:211]
  v_mfma_f32_16x16x32_bf16 a[212:215], v[88:91], v[148:151], a[212:215]
  v_mfma_f32_16x16x32_bf16 a[216:219], v[88:91], v[152:155], a[216:219]
  s_add_u32 s28, s28, 1
  v_mfma_f32_16x16x32_bf16 a[220:223], v[88:91], v[156:159], a[220:223]
  v_mfma_f32_16x16x32_bf16 a[224:227], v[92:95], v[128:131], a[224:227]
  v_mfma_f32_16x16x32_bf16 a[228:231], v[92:95], v[132:135], a[228:231]
  v_mfma_f32_16x16x32_bf16 a[232:235], v[92:95], v[136:139], a[232:235]
  v_mfma_f32_16x16x32_bf16 a[236:239], v[92:95], v[140:143], a[236:239]
  v_mfma_f32_16x16x32_bf16 a[240:243], v[92:95], v[144:147], a[240:243]
  v_mfma_f32_16x16x32_bf16 a[244:247], v[92:95], v[148:151], a[244:247]
  s_cmp_lt_u32 s28, 8
  v_mfma_f32_16x16x32_bf16 a[248:251], v[92:95], v[152:155], a[248:251]
  s_waitcnt lgkmcnt(0)
  v_mfma_f32_16x16x32_bf16 a[252:255], v[92:95], v[156:159], a[252:255]
  s_cbranch_scc1 fa_loopK
  s_mov_b32 s60, 2048
  s_mov_b32 s61, 8192
  s_mov_b32 s62, 16777216
  s_branch fa_p1epi
fa_roleV:
  ds_read_b128 v[32:35], v14 offset:0
  ds_read_b128 v[36:39], v14 offset:1024
  ds_read_b128 v[40:43], v14 offset:2048
  ds_read_b128 v[44:47], v14 offset:3072
  ds_read_b128 v[48:51], v14 offset:4096
  ds_read_b128 v[52:55], v14 offset:5120
  ds_read_b128 v[56:59], v14 offset:6144
  ds_read_b128 v[60:63], v14 offset:7168
  ds_read_b64_tr_b16 v[96:97], v12 offset:0
  ds_read_b64_tr_b16 v[98:99], v12 offset:1024
  ds_read_b64_tr_b16 v[100:101], v13 offset:0
  ds_read_b64_tr_b16 v[102:103], v13 offset:1024
  ds_read_b64_tr_b16 v[104:105], v12 offset:256
  ds_read_b64_tr_b16 v[106:107], v12 offset:1280
  ds_read_b64_tr_b16 v[108:109], v13 offset:256
  ds_read_b64_tr_b16 v[110:111], v13 offset:1280
  ds_read_b64_tr_b16 v[112:113], v12 offset:512
  ds_read_b64_tr_b16 v[114:115], v12 offset:1536
  ds_read_b64_tr_b16 v[116:117], v13 offset:512
  ds_read_b64_tr_b16 v[118:119], v13 offset:1536
  ds_read_b64_tr_b16 v[120:121], v12 offset:768
  ds_read_b64_tr_b16 v[122:123], v12 offset:1792
  ds_read_b64_tr_b16 v[124:125], v13 offset:768
  ds_read_b64_tr_b16 v[126:127], v13 offset:1792
  s_waitcnt lgkmcnt(0)
.p2align 6
fa_loopV:
  v_mfma_f32_16x16x32_bf16 a[0:3], v[32:35], v[96:99], a[0:3]
  s_waitcnt vmcnt(17)
  v_mfma_f32_16x16x32_bf16 a[4:7], v[32:35], v[100:103], a[4:7]
  s_barrier
  v_mfma_f32_16x16x32_bf16 a[8:11], v[32:35], v[104:107], a[8:11]
  s_bitcmp1_b32 s72, s28
  ds_read_b64_tr_b16 v[128:129], v12 offset:32768
  v_mfma_f32_16x16x32_bf16 a[12:15], v[32:35], v[108:111], a[12:15]
  s_cbranch_scc1 fa_p1stubV
fa_p1backV:
  v_mfma_f32_16x16x32_bf16 a[16:19], v[32:35], v[112:115], a[16:19]
  s_mov_b32 m0, s24
  ds_read_b64_tr_b16 v[130:131], v12 offset:33792
  v_mfma_f32_16x16x32_bf16 a[20:23], v[32:35], v[116:119], a[20:23]
  buffer_load_dwordx4 v3, s[32:35], s26 offen offset:0 sc1 lds
  v_mfma_f32_16x16x32_bf16 a[24:27], v[32:35], v[120:123], a[24:27]
  ds_read_b128 v[64:67], v14 offset:32768
  v_mfma_f32_16x16x32_bf16 a[28:31], v[32:35], v[124:127], a[28:31]
  buffer_load_dwordx4 v4, s[32:35], s26 offen offset:1024 sc1 lds
  v_mfma_f32_16x16x32_bf16 a[32:35], v[36:39], v[96:99], a[32:35]
  ds_read_b64_tr_b16 v[132:133], v13 offset:32768
  v_mfma_f32_16x16x32_bf16 a[36:39], v[36:39], v[100:103], a[36:39]
  buffer_load_dwordx4 v5, s[32:35], s26 offen offset:2048 sc1 lds
  v_mfma_f32_16x16x32_bf16 a[40:43], v[36:39], v[104:107], a[40:43]
  ds_read_b64_tr_b16 v[134:135], v13 offset:33792
  v_mfma_f32_16x16x32_bf16 a[44:47], v[36:39], v[108:111], a[44:47]
  buffer_load_dwordx4 v6, s[32:35], s26 offen offset:3072 sc1 lds
  v_mfma_f32_16x16x32_bf16 a[48:51], v[36:39], v[112:115], a[48:51]
  s_add_u32 m0, s24, 16384
  ds_read_b128 v[68:71], v14 offset:33792
  v_mfma_f32_16x16x32_bf16 a[52:55], v[36:39], v[116:119], a[52:55]
  buffer_load_dwordx4 v8, s[36:39], s27 offen offset:0 lds
  v_mfma_f32_16x16x32_bf16 a[56:59], v[36:39], v[120:123], a[56:59]
  ds_read_b64_tr_b16 v[136:137], v12 offset:33024
  v_mfma_f32_16x16x32_bf16 a[60:63], v[36:39], v[124:127], a[60:63]
  buffer_load_dwordx4 v9, s[36:39], s27 offen offset:1024 lds
  v_mfma_f32_16x16x32_bf16 a[64:67], v[40:43], v[96:99], a[64:67]
  ds_read_b64_tr_b16 v[138:139], v12 offset:34048
  v_mfma_f32_16x16x32_bf16 a[68:71], v[40:43], v[100:103], a[68:71]
  buffer_load_dwordx4 v10, s[36:39], s27 offen offset:2048 lds
  v_mfma_f32_16x16x32_bf16 a[72:75], v[40:43], v[104:107], a[72:75]
  ds_read_b128 v[72:75], v14 offset:34816
  v_mfma_f32_16x16x32_bf16 a[76:79], v[40:43], v[108:111], a[76:79]
  buffer_load_dwordx4 v11, s[36:39], s27 offen offset:3072 lds
  v_mfma_f32_16x16x32_bf16 a[80:83], v[40:43], v[112:115], a[80:83]
  ds_read_b64_tr_b16 v[140:141], v13 offset:33024
  v_mfma_f32_16x16x32_bf16 a[84:87], v[40:43], v[116:119], a[84:87]
  buffer_load_dword v231, v235, s[48:51], s74 offen
  v_mfma_f32_16x16x32_bf16 a[88:91], v[40:43], v[120:123], a[88:91]
  s_add_u32 s74, s74, s73
  ds_read_b64_tr_b16 v[142:143], v13 offset:34048
  v_mfma_f32_16x16x32_bf16 a[92:95], v[40:43], v[124:127], a[92:95]
  v_mfma_f32_16x16x32_bf16 a[96:99], v[44:47], v[96:99], a[96:99]
  ds_read_b128 v[76:79], v14 offset:35840
  v_mfma_f32_16x16x32_bf16 a[100:103], v[44:47], v[100:103], a[100:103]
  v_mfma_f32_16x16x32_bf16 a[104:107], v[44:47], v[104:107], a[104:107]
  ds_read_b64_tr_b16 v[144:145], v12 offset:33280
  v_mfma_f32_16x16x32_bf16 a[108:111], v[44:47], v[108:111], a[108:111]
  v_mfma_f32_16x16x32_bf16 a[112:115], v[44:47], v[112:115], a[112:115]
  ds_read_b64_tr_b16 v[146:147], v12 offset:34304
  v_mfma_f32_16x16x32_bf16 a[116:119], v[44:47], v[116:119], a[116:119]
  v_mfma_f32_16x16x32_bf16 a[120:123], v[44:47], v[120:123], a[120:123]
  ds_read_b128 v[80:83], v14 offset:36864
  v_mfma_f32_16x16x32_bf16 a[124:127], v[44:47], v[124:127], a[124:127]
  v_mfma_f32_16x16x32_bf16 a[128:131], v[48:51], v[96:99], a[128:131]
  ds_read_b64_tr_b16 v[148:149], v13 offset:33280
  v_mfma_f32_16x16x32_bf16 a[132:135], v[48:51], v[100:103], a[132:135]
  v_mfma_f32_16x16x32_bf16 a[136:139], v[48:51], v[104:107], a[136:139]
  ds_read_b64_tr_b16 v[150:151], v13 offset:34304
  v_mfma_f32_16x16x32_bf16 a[140:143], v[48:51], v[108:111], a[140:143]
  v_mfma_f32_16x16x32_bf16 a[144:147], v[48:51], v[112:115], a[144:147]
  ds_read_b128 v[84:87], v14 offset:37888
  v_mfma_f32_16x16x32_bf16 a[148:151], v[48:51], v[116:119], a[148:151]
  v_mfma_f32_16x16x32_bf16 a[152:155], v[48:51], v[120:123], a[152:155]
  ds_read_b64_tr_b16 v[152:153], v12 offset:33536
  v_mfma_f32_16x16x32_bf16 a[156:159], v[48:51], v[124:127], a[156:159]
  v_mfma_f32_16x16x32_bf16 a[160:163], v[52:55], v[96:99], a[160:163]
  ds_read_b64_tr_b16 v[154:155], v12 offset:34560
  v_mfma_f32_16x16x32_bf16 a[164:167], v[52:55], v[100:103], a[164:167]
  v_mfma_f32_16x16x32_bf16 a[168:171], v[52:55], v[104:107], a[168:171]
  ds_read_b128 v[88:91], v14 offset:38912
  v_mfma_f32_16x16x32_bf16 a[172:175], v[52:55], v[108:111], a[172:175]
  v_mfma_f32_16x16x32_bf16 a[176:179], v[52:55], v[112:115], a[176:179]
  ds_read_b64_tr_b16 v[156:157], v13 offset:33536
  v_mfma_f32_16x16x32_bf16 a[180:183], v[52:55], v[116:119], a[180:183]
  v_mfma_f32_16x16x32_bf16 a[184:187], v[52:55], v[120:123], a[184:187]
  ds_read_b64_tr_b16 v[158:159], v13 offset:34560
  v_mfma_f32_16x16x32_bf16 a[188:191], v[52:55], v[124:127], a[188:191]
  v_mfma_f32_16x16x32_bf16 a[192:195], v[56:59], v[96:99], a[192:195]
  s_add_u32 s26, s26, s79
  ds_read_b128 v[92:95], v14 offset:39936
  v_mfma_f32_16x16x32_bf16 a[196:199], v[56:59], v[100:103], a[196:199]
  s_add_u32 s27, s27, s25
  v_mfma_f32_16x16x32_bf16 a[200:203], v[56:59], v[104:107], a[200:203]
  s_add_u32 s24, s24, 32768
  v_mfma_f32_16x16x32_bf16 a[204:207], v[56:59], v[108:111], a[204:207]
  s_and_b32 s24, s24, 0x1ffff
  v_mfma_f32_16x16x32_bf16 a[208:211], v[56:59], v[112:115], a[208:211]
  v_xor_b32 v14, 0x10000, v14
  v_mfma_f32_16x16x32_bf16 a[212:215], v[56:59], v[116:119], a[212:215]
  v_xor_b32 v12, 0x10000, v12
  v_mfma_f32_16x16x32_bf16 a[216:219], v[56:59], v[120:123], a[216:219]
  v_xor_b32 v13, 0x10000, v13
  v_mfma_f32_16x16x32_bf16 a[220:223], v[56:59], v[124:127], a[220:223]
  v_mfma_f32_16x16x32_bf16 a[224:227], v[60:63], v[96:99], a[224:227]
  v_mfma_f32_16x16x32_bf16 a[228:231], v[60:63], v[100:103], a[228:231]
  v_mfma_f32_16x16x32_bf16 a[232:235], v[60:63], v[104:107], a[232:235]
  v_mfma_f32_16x16x32_bf16 a[236:239], v[60:63], v[108:111], a[236:239]
  v_mfma_f32_16x16x32_bf16 a[240:243], v[60:63], v[112:115], a[240:243]
  v_mfma_f32_16x16x32_bf16 a[244:247], v[60:63], v[116:119], a[244:247]
  v_mfma_f32_16x16x32_bf16 a[248:251], v[60:63], v[120:123], a[248:251]
  v_mfma_f32_16x16x32_bf16 a[252:255], v[60:63], v[124:127], a[252:255]
  s_waitcnt lgkmcnt(0)
  v_mfma_f32_16x16x32_bf16 a[0:3], v[64:67], v[128:131], a[0:3]
  s_waitcnt vmcnt(18)
  v_mfma_f32_16x16x32_bf16 a[4:7], v[64:67], v[132:135], a[4:7]
  s_barrier
  v_mfma_f32_16x16x32_bf16 a[8:11], v[64:67], v[136:139], a[8:11]
  ds_read_b64_tr_b16 v[96:97], v12 offset:0
  v_mfma_f32_16x16x32_bf16 a[12:15], v[64:67], v[140:143], a[12:15]
  v_mfma_f32_16x16x32_bf16 a[16:19], v[64:67], v[144:147], a[16:19]
  s_mov_b32 m0, s24
  ds_read_b64_tr_b16 v[98:99], v12 offset:1024
  v_mfma_f32_16x16x32_bf16 a[20:23], v[64:67], v[148:151], a[20:23]
  buffer_load_dwordx4 v3, s[32:35], s26 offen offset:0 sc1 lds
  v_mfma_f32_16x16x32_bf16 a[24:27], v[64:67], v[152:155], a[24:27]
  ds_read_b128 v[32:35], v14 offset:0
  v_mfma_f32_16x16x32_bf16 a[28:31], v[64:67], v[156:159], a[28:31]
  v_mfma_f32_16x16x32_bf16 a[32:35], v[68:71], v[128:131], a[32:35]
  ds_read_b64_tr_b16 v[100:101], v13 offset:0
  v_mfma_f32_16x16x32_bf16 a[36:39], v[68:71], v[132:135], a[36:39]
  v_mfma_f32_16x16x32_bf16 a[40:43], v[68:71], v[136:139], a[40:43]
  ds_read_b64_tr_b16 v[102:103], v13 offset:1024
  v_mfma_f32_16x16x32_bf16 a[44:47], v[68:71], v[140:143], a[44:47]
  buffer_load_dwordx4 v4, s[32:35], s26 offen offset:1024 sc1 lds
  v_mfma_f32_16x16x32_bf16 a[48:51], v[68:71], v[144:147], a[48:51]
  ds_read_b128 v[36:39], v14 offset:1024
  v_mfma_f32_16x16x32_bf16 a[52:55], v[68:71], v[148:151], a[52:55]
  v_mfma_f32_16x16x32_bf16 a[56:59], v[68:71], v[152:155], a[56:59]
  ds_read_b64_tr_b16 v[104:105], v12 offset:256
  v_mfma_f32_16x16x32_bf16 a[60:63], v[68:71], v[156:159], a[60:63]
  v_mfma_f32_16x16x32_bf16 a[64:67], v[72:75], v[128:131], a[64:67]
  ds_read_b64_tr_b16 v[106:107], v12 offset:1280
  v_mfma_f32_16x16x32_bf16 a[68:71], v[72:75], v[132:135], a[68:71]
  buffer_load_dwordx4 v5, s[32:35], s26 offen offset:2048 sc1 lds
  v_mfma_f32_16x16x32_bf16 a[72:75], v[72:75], v[136:139], a[72:75]
  ds_read_b128 v[40:43], v14 offset:2048
  v_mfma_f32_16x16x32_bf16 a[76:79], v[72:75], v[140:143], a[76:79]
  v_mfma_f32_16x16x32_bf16 a[80:83], v[72:75], v[144:147], a[80:83]
  ds_read_b64_tr_b16 v[108:109], v13 offset:256
  v_mfma_f32_16x16x32_bf16 a[84:87], v[72:75], v[148:151], a[84:87]
  v_mfma_f32_16x16x32_bf16 a[88:91], v[72:75], v[152:155], a[88:91]
  ds_read_b64_tr_b16 v[110:111], v13 offset:1280
  v_mfma_f32_16x16x32_bf16 a[92:95], v[72:75], v[156:159], a[92:95]
  buffer_load_dwordx4 v6, s[32:35], s26 offen offset:3072 sc1 lds
  v_mfma_f32_16x16x32_bf16 a[96:99], v[76:79], v[128:131], a[96:99]
  ds_read_b128 v[44:47], v14 offset:3072
  v_mfma_f32_16x16x32_bf16 a[100:103], v[76:79], v[132:135], a[100:103]
  v_mfma_f32_16x16x32_bf16 a[104:107], v[76:79], v[136:139], a[104:107]
  ds_read_b64_tr_b16 v[112:113], v12 offset:512
  v_mfma_f32_16x16x32_bf16 a[108:111], v[76:79], v[140:143], a[108:111]
  v_mfma_f32_16x16x32_bf16 a[112:115], v[76:79], v[144:147], a[112:115]
  s_add_u32 m0, s24, 16384
  ds_read_b64_tr_b16 v[114:115], v12 offset:1536
  v_mfma_f32_16x16x32_bf16 a[116:119], v[76:79], v[148:151], a[116:119]
  buffer_load_dwordx4 v8, s[36:39], s27 offen offset:0 lds
  v_mfma_f32_16x16x32_bf16 a[120:123], v[76:79], v[152:155], a[120:123]
  ds_read_b128 v[48:51], v14 offset:4096
  v_mfma_f32_16x16x32_bf16 a[124:127], v[76:79], v[156:159], a[124:127]
  v_mfma_f32_16x16x32_bf16 a[128:131], v[80:83], v[128:131], a[128:131]
  ds_read_b64_tr_b16 v[116:117], v13 offset:512
  v_mfma_f32_16x16x32_bf16 a[132:135], v[80:83], v[132:135], a[132:135]
  v_mfma_f32_16x16x32_bf16 a[136:139], v[80:83], v[136:139], a[136:139]
  ds_read_b64_tr_b16 v[118:119], v13 offset:1536
  v_mfma_f32_16x16x32_bf16 a[140:143], v[80:83], v[140:143], a[140:143]
  buffer_load_dwordx4 v9, s[36:39], s27 offen offset:1024 lds
  v_mfma_f32_16x16x32_bf16 a[144:147], v[80:83], v[144:147], a[144:147]
  ds_read_b128 v[52:55], v14 offset:5120
  v_mfma_f32_16x16x32_bf16 a[148:151], v[80:83], v[148:151], a[148:151]
  v_mfma_f32_16x16x32_bf16 a[152:155], v[80:83], v[152:155], a[152:155]
  ds_read_b64_tr_b16 v[120:121], v12 offset:768
  v_mfma_f32_16x16x32_bf16 a[156:159], v[80:83], v[156:159], a[156:159]
  v_mfma_f32_16x16x32_bf16 a[160:163], v[84:87], v[128:131], a[160:163]
  ds_read_b64_tr_b16 v[122:123], v12 offset:1792
  v_mfma_f32_16x16x32_bf16 a[164:167], v[84:87], v[132:135], a[164:167]
  buffer_load_dwordx4 v10, s[36:39], s27 offen offset:2048 lds
  v_mfma_f32_16x16x32_bf16 a[168:171], v[84:87], v[136:139], a[168:171]
  ds_read_b128 v[56:59], v14 offset:6144
  v_mfma_f32_16x16x32_bf16 a[172:175], v[84:87], v[140:143], a[172:175]
  v_mfma_f32_16x16x32_bf16 a[176:179], v[84:87], v[144:147], a[176:179]
  ds_read_b64_tr_b16 v[124:125], v13 offset:768
  v_mfma_f32_16x16x32_bf16 a[180:183], v[84:87], v[148:151], a[180:183]
  v_mfma_f32_16x16x32_bf16 a[184:187], v[84:87], v[152:155], a[184:187]
  ds_read_b64_tr_b16 v[126:127], v13 offset:1792
  v_mfma_f32_16x16x32_bf16 a[188:191], v[84:87], v[156:159], a[188:191]
  buffer_load_dwordx4 v11, s[36:39], s27 offen offset:3072 lds
  v_mfma_f32_16x16x32_bf16 a[192:195], v[88:91], v[128:131], a[192:195]
  s_add_u32 s26, s26, s79
  ds_read_b128 v[60:63], v14 offset:7168
  v_mfma_f32_16x16x32_bf16 a[196:199], v[88:91], v[132:135], a[196:199]
  s_add_u32 s27, s27, s25
  v_mfma_f32_16x16x32_bf16 a[200:203], v[88:91], v[136:139], a[200:203]
  s_add_u32 s24, s24, 32768
  v_mfma_f32_16x16x32_bf16 a[204:207], v[88:91], v[140:143], a[204:207]
  s_and_b32 s24, s24, 0x1ffff
  v_mfma_f32_16x16x32_bf16 a[208:211], v[88:91], v[144:147], a[208:211]
  v_mfma_f32_16x16x32_bf16 a[212:215], v[88:91], v[148:151], a[212:215]
  v_mfma_f32_16x16x32_bf16 a[216:219], v[88:91], v[152:155], a[216:219]
  s_add_u32 s28, s28, 1
  v_mfma_f32_16x16x32_bf16 a[220:223], v[88:91], v[156:159], a[220:223]
  v_mfma_f32_16x16x32_bf16 a[224:227], v[92:95], v[128:131], a[224:227]
  v_mfma_f32_16x16x32_bf16 a[228:231], v[92:95], v[132:135], a[228:231]
  v_mfma_f32_16x16x32_bf16 a[232:235], v[92:95], v[136:139], a[232:235]
  v_mfma_f32_16x16x32_bf16 a[236:239], v[92:95], v[140:143], a[236:239]
  v_mfma_f32_16x16x32_bf16 a[240:243], v[92:95], v[144:147], a[240:243]
  v_mfma_f32_16x16x32_bf16 a[244:247], v[92:95], v[148:151], a[244:247]
  s_cmp_lt_u32 s28, 8
  v_mfma_f32_16x16x32_bf16 a[248:251], v[92:95], v[152:155], a[248:251]
  s_waitcnt lgkmcnt(0)
  v_mfma_f32_16x16x32_bf16 a[252:255], v[92:95], v[156:159], a[252:255]
  s_cbranch_scc1 fa_loopV
  s_mov_b32 s60, 8192
  s_mov_b32 s61, 2048
  s_mov_b32 s62, 33554432
fa_p1epi:
  s_lshr_b32 s23, s20, 1
  s_lshl_b32 s23, s23, 13
  v_subrev_u32 v12, s23, v12
  v_subrev_u32 v13, s23, v13
  s_lshl_b32 s24, s20, 12
  v_add_u32 v14, s24, v2
  ds_read_b64_tr_b16 v[32:33], v12 offset:0
  ds_read_b64_tr_b16 v[34:35], v12 offset:1024
  ds_read_b64_tr_b16 v[36:37], v13 offset:0
  ds_read_b64_tr_b16 v[38:39], v13 offset:1024
  ds_read_b64_tr_b16 v[40:41], v12 offset:256
  ds_read_b64_tr_b16 v[42:43], v12 offset:1280
  ds_read_b64_tr_b16 v[44:45], v13 offset:256
  ds_read_b64_tr_b16 v[46:47], v13 offset:1280
  ds_read_b64_tr_b16 v[48:49], v12 offset:512
  ds_read_b64_tr_b16 v[50:51], v12 offset:1536
  ds_read_b64_tr_b16 v[52:53], v13 offset:512
  ds_read_b64_tr_b16 v[54:55], v13 offset:1536
  ds_read_b64_tr_b16 v[56:57], v12 offset:768
  ds_read_b64_tr_b16 v[58:59], v12 offset:1792
  ds_read_b64_tr_b16 v[60:61], v13 offset:768
  ds_read_b64_tr_b16 v[62:63], v13 offset:1792
  s_waitcnt vmcnt(8)
  ds_read_b128 v[224:227], v14 offset:0
  ds_read_b128 v[228:231], v14 offset:1024
  ds_read_b128 v[232:235], v14 offset:2048
  ds_read_b128 v[236:239], v14 offset:3072
  s_lshl_b32 s23, s21, 19
  s_add_u32 s62, s62, s23
  s_lshl_b32 s23, s22, 16
  s_add_u32 s62, s62, s23
  s_and_b32 s23, s20, 1
  s_lshl_b32 s23, s23, 15
  s_add_u32 s62, s62, s23
  s_lshl_b32 s23, s21, 19
  s_add_u32 s23, s23, 16777216
  s_add_u32 s6, s18, s23
  s_addc_u32 s7, s19, 0
  s_add_u32 s8, s6, 16777216
  s_addc_u32 s9, s7, 0
  s_sub_u32 s23, 16, s22
  s_lshl_b32 s23, s23, 15
  s_mov_b32 s44, s6
  s_mov_b32 s45, s7
  s_mov_b32 s46, s23
  s_mov_b32 s47, 0x20000
  s_mov_b32 s48, s8
  s_mov_b32 s49, s9
  s_mov_b32 s50, s23
  s_mov_b32 s51, 0x20000
  s_lshl_b32 s30, s21, 7
  s_add_u32 s30, s30, 2637824
  s_mov_b32 s81, 0x47800000
  s_cmp_eq_u32 s20, 0
  s_cselect_b32 s29, s82, 1073741824
  s_waitcnt vmcnt(21) lgkmcnt(0)
  v_mfma_f32_16x16x32_bf16 v[96:99], v[32:35], v[224:227], 0
  s_mul_i32 s63, s60, 0
  v_accvgpr_read_b32 v16, a0
  v_accvgpr_read_b32 v17, a1
  v_mfma_f32_16x16x32_bf16 v[112:115], v[36:39], v[224:227], 0
  s_add_u32 s63, s63, s62
  ds_read_b64_tr_b16 v[64:65], v12 offset:8192
  v_accvgpr_read_b32 v18, a2
  v_mfma_f32_16x16x32_bf16 v[128:131], v[40:43], v[224:227], 0
  s_add_u32 m0, s24, 0
  ds_read_b64_tr_b16 v[66:67], v12 offset:9216
  v_accvgpr_read_b32 v19, a3
  v_mfma_f32_16x16x32_bf16 v[144:147], v[44:47], v[224:227], 0
  buffer_load_dwordx4 v3, s[32:35], s26 offen offset:0 sc1 lds
  v_accvgpr_read_b32 v20, a32
  v_mfma_f32_16x16x32_bf16 v[160:163], v[48:51], v[224:227], 0
  ds_read_b64_tr_b16 v[68:69], v13 offset:8192
  v_accvgpr_read_b32 v21, a33
  v_mfma_f32_16x16x32_bf16 v[176:179], v[52:55], v[224:227], 0
  ds_read_b64_tr_b16 v[70:71], v13 offset:9216
  v_accvgpr_read_b32 v22, a34
  v_mfma_f32_16x16x32_bf16 v[192:195], v[56:59], v[224:227], 0
  ds_read_b64_tr_b16 v[72:73], v12 offset:8448
  v_accvgpr_read_b32 v23, a35
  v_mfma_f32_16x16x32_bf16 v[208:211], v[60:63], v[224:227], 0
  ds_read_b64_tr_b16 v[74:75], v12 offset:9472
  v_cvt_pk_bf16_f32 v24, v16, v17
  v_mfma_f32_16x16x32_bf16 v[100:103], v[32:35], v[228:231], 0
  buffer_load_dwordx4 v4, s[32:35], s26 offen offset:1024 sc1 lds
  v_cvt_pk_bf16_f32 v25, v18, v19
  v_mfma_f32_16x16x32_bf16 v[116:119], v[36:39], v[228:231], 0
  ds_read_b64_tr_b16 v[76:77], v13 offset:8448
  v_cvt_pk_bf16_f32 v26, v20, v21
  v_mfma_f32_16x16x32_bf16 v[132:135], v[40:43], v[228:231], 0
  ds_read_b64_tr_b16 v[78:79], v13 offset:9472
  v_cvt_pk_bf16_f32 v27, v22, v23
  v_mfma_f32_16x16x32_bf16 v[148:151], v[44:47], v[228:231], 0
  ds_read_b128 v[240:243], v14 offset:32768
  buffer_store_dwordx4 v[24:27], v2, s[40:43], s63 offen offset:0 sc1
  v_mfma_f32_16x16x32_bf16 v[164:167], v[48:51], v[228:231], 0
  ds_read_b128 v[244:247], v14 offset:33792
  v_accvgpr_read_b32 v16, a4
  v_mfma_f32_16x16x32_bf16 v[180:183], v[52:55], v[228:231], 0
  buffer_load_dwordx4 v5, s[32:35], s26 offen offset:2048 sc1 lds
  v_accvgpr_read_b32 v17, a5
  v_mfma_f32_16x16x32_bf16 v[196:199], v[56:59], v[228:231], 0
  ds_read_b64_tr_b16 v[80:81], v12 offset:8704
  v_accvgpr_read_b32 v18, a6
  v_mfma_f32_16x16x32_bf16 v[212:215], v[60:63], v[228:231], 0
  ds_read_b64_tr_b16 v[82:83], v12 offset:9728
  v_accvgpr_read_b32 v19, a7
  v_mfma_f32_16x16x32_bf16 v[104:107], v[32:35], v[232:235], 0
  ds_read_b64_tr_b16 v[84:85], v13 offset:8704
  v_accvgpr_read_b32 v20, a36
  v_mfma_f32_16x16x32_bf16 v[120:123], v[36:39], v[232:235], 0
  ds_read_b64_tr_b16 v[86:87], v13 offset:9728
  v_accvgpr_read_b32 v21, a37
  v_mfma_f32_16x16x32_bf16 v[136:139], v[40:43], v[232:235], 0
  buffer_load_dwordx4 v6, s[32:35], s26 offen offset:3072 sc1 lds
  v_accvgpr_read_b32 v22, a38
  v_mfma_f32_16x16x32_bf16 v[152:155], v[44:47], v[232:235], 0
  s_add_u32 s26, s26, 1024
  ds_read_b64_tr_b16 v[88:89], v12 offset:8960
  v_accvgpr_read_b32 v23, a39
  v_mfma_f32_16x16x32_bf16 v[168:171], v[48:51], v[232:235], 0
  ds_read_b64_tr_b16 v[90:91], v12 offset:9984
  v_cvt_pk_bf16_f32 v28, v16, v17
  v_mfma_f32_16x16x32_bf16 v[184:187], v[52:55], v[232:235], 0
  ds_read_b64_tr_b16 v[92:93], v13 offset:8960
  v_cvt_pk_bf16_f32 v29, v18, v19
  v_mfma_f32_16x16x32_bf16 v[200:203], v[56:59], v[232:235], 0
  ds_read_b64_tr_b16 v[94:95], v13 offset:9984
  v_cvt_pk_bf16_f32 v30, v20, v21
  v_mfma_f32_16x16x32_bf16 v[216:219], v[60:63], v[232:235], 0
  v_cvt_pk_bf16_f32 v31, v22, v23
  v_mfma_f32_16x16x32_bf16 v[108:111], v[32:35], v[236:239], 0
  ds_read_b128 v[248:251], v14 offset:34816
  buffer_store_dwordx4 v[28:31], v2, s[40:43], s63 offen offset:1024 sc1
  v_mfma_f32_16x16x32_bf16 v[124:127], v[36:39], v[236:239], 0
  ds_read_b128 v[252:255], v14 offset:35840
  v_accvgpr_write_b32 a0, 0
  v_mfma_f32_16x16x32_bf16 v[140:143], v[40:43], v[236:239], 0
  v_accvgpr_write_b32 a1, 0
  v_accvgpr_write_b32 a2, 0
  v_mfma_f32_16x16x32_bf16 v[156:159], v[44:47], v[236:239], 0
  v_xor_b32 v14, 0x10000, v14
  v_accvgpr_write_b32 a3, 0
  v_mfma_f32_16x16x32_bf16 v[172:175], v[48:51], v[236:239], 0
  v_accvgpr_write_b32 a32, 0
  v_accvgpr_write_b32 a33, 0
  v_mfma_f32_16x16x32_bf16 v[188:191], v[52:55], v[236:239], 0
  v_accvgpr_write_b32 a34, 0
  v_accvgpr_write_b32 a35, 0
  v_mfma_f32_16x16x32_bf16 v[204:207], v[56:59], v[236:239], 0
  v_mfma_f32_16x16x32_bf16 v[220:223], v[60:63], v[236:239], 0
  s_waitcnt vmcnt(19) lgkmcnt(0)
  v_mfma_f32_16x16x32_bf16 v[96:99], v[64:67], v[240:243], v[96:99]
  s_barrier
  v_accvgpr_read_b32 v16, a8
  v_accvgpr_read_b32 v17, a9
  v_mfma_f32_16x16x32_bf16 v[112:115], v[68:71], v[240:243], v[112:115]
  s_add_u32 s63, s63, s61
  ds_read_b64_tr_b16 v[32:33], v12 offset:32768
  v_accvgpr_read_b32 v18, a10
  v_mfma_f32_16x16x32_bf16 v[128:131], v[72:75], v[240:243], v[128:131]
  s_add_u32 m0, s24, 32768
  ds_read_b64_tr_b16 v[34:35], v12 offset:33792
  v_accvgpr_read_b32 v19, a11
  v_mfma_f32_16x16x32_bf16 v[144:147], v[76:79], v[240:243], v[144:147]
  buffer_load_dwordx4 v3, s[32:35], s26 offen offset:0 sc1 lds
  v_accvgpr_read_b32 v20, a40
  v_mfma_f32_16x16x32_bf16 v[160:163], v[80:83], v[240:243], v[160:163]
  ds_read_b64_tr_b16 v[36:37], v13 offset:32768
  v_accvgpr_read_b32 v21, a41
  v_mfma_f32_16x16x32_bf16 v[176:179], v[84:87], v[240:243], v[176:179]
  ds_read_b64_tr_b16 v[38:39], v13 offset:33792
  v_accvgpr_read_b32 v22, a42
  v_mfma_f32_16x16x32_bf16 v[192:195], v[88:91], v[240:243], v[192:195]
  ds_read_b64_tr_b16 v[40:41], v12 offset:33024
  v_accvgpr_read_b32 v23, a43
  v_mfma_f32_16x16x32_bf16 v[208:211], v[92:95], v[240:243], v[208:211]
  ds_read_b64_tr_b16 v[42:43], v12 offset:34048
  v_cvt_pk_bf16_f32 v24, v16, v17
  v_mfma_f32_16x16x32_bf16 v[100:103], v[64:67], v[244:247], v[100:103]
  buffer_load_dwordx4 v4, s[32:35], s26 offen offset:1024 sc1 lds
  v_cvt_pk_bf16_f32 v25, v18, v19
  v_mfma_f32_16x16x32_bf16 v[116:119], v[68:71], v[244:247], v[116:119]
  ds_read_b64_tr_b16 v[44:45], v13 offset:33024
  v_cvt_pk_bf16_f32 v26, v20, v21
  v_mfma_f32_16x16x32_bf16 v[132:135], v[72:75], v[244:247], v[132:135]
  ds_read_b64_tr_b16 v[46:47], v13 offset:34048
  v_cvt_pk_bf16_f32 v27, v22, v23
  v_mfma_f32_16x16x32_bf16 v[148:151], v[76:79], v[244:247], v[148:151]
  ds_read_b128 v[224:227], v14 offset:0
  buffer_store_dwordx4 v[24:27], v2, s[40:43], s63 offen offset:0 sc1
  v_mfma_f32_16x16x32_bf16 v[164:167], v[80:83], v[244:247], v[164:167]
  ds_read_b128 v[228:231], v14 offset:1024
  v_accvgpr_read_b32 v16, a12
  v_mfma_f32_16x16x32_bf16 v[180:183], v[84:87], v[244:247], v[180:183]
  buffer_load_dwordx4 v5, s[32:35], s26 offen offset:2048 sc1 lds
  v_accvgpr_read_b32 v17, a13
  v_mfma_f32_16x16x32_bf16 v[196:199], v[88:91], v[244:247], v[196:199]
  ds_read_b64_tr_b16 v[48:49], v12 offset:33280
  v_accvgpr_read_b32 v18, a14
  v_mfma_f32_16x16x32_bf16 v[212:215], v[92:95], v[244:247], v[212:215]
  ds_read_b64_tr_b16 v[50:51], v12 offset:34304
  v_accvgpr_read_b32 v19, a15
  v_mfma_f32_16x16x32_bf16 v[104:107], v[64:67], v[248:251], v[104:107]
  ds_read_b64_tr_b16 v[52:53], v13 offset:33280
  v_accvgpr_read_b32 v20, a44
  v_mfma_f32_16x16x32_bf16 v[120:123], v[68:71], v[248:251], v[120:123]
  ds_read_b64_tr_b16 v[54:55], v13 offset:34304
  v_accvgpr_read_b32 v21, a45
  v_mfma_f32_16x16x32_bf16 v[136:139], v[72:75], v[248:251], v[136:139]
  buffer_load_dwordx4 v6, s[32:35], s26 offen offset:3072 sc1 lds
  v_accvgpr_read_b32 v22, a46
  v_mfma_f32_16x16x32_bf16 v[152:155], v[76:79], v[248:251], v[152:155]
  s_add_u32 s26, s26, 1024
  ds_read_b64_tr_b16 v[56:57], v12 offset:33536
  v_accvgpr_read_b32 v23, a47
  v_mfma_f32_16x16x32_bf16 v[168:171], v[80:83], v[248:251], v[168:171]
  ds_read_b64_tr_b16 v[58:59], v12 offset:34560
  v_cvt_pk_bf16_f32 v28, v16, v17
  v_mfma_f32_16x16x32_bf16 v[184:187], v[84:87], v[248:251], v[184:187]
  ds_read_b64_tr_b16 v[60:61], v13 offset:33536
  v_cvt_pk_bf16_f32 v29, v18, v19
  v_mfma_f32_16x16x32_bf16 v[200:203], v[88:91], v[248:251], v[200:203]
  s_add_u32 m0, s24, 16384
  ds_read_b64_tr_b16 v[62:63], v13 offset:34560
  v_cvt_pk_bf16_f32 v30, v20, v21
  v_mfma_f32_16x16x32_bf16 v[216:219], v[92:95], v[248:251], v[216:219]
  buffer_load_dwordx4 v8, s[36:39], s27 offen offset:0 lds
  v_cvt_pk_bf16_f32 v31, v22, v23
  v_mfma_f32_16x16x32_bf16 v[108:111], v[64:67], v[252:255], v[108:111]
  ds_read_b128 v[232:235], v14 offset:2048
  buffer_store_dwordx4 v[28:31], v2, s[40:43], s63 offen offset:1024 sc1
  v_mfma_f32_16x16x32_bf16 v[124:127], v[68:71], v[252:255], v[124:127]
  ds_read_b128 v[236:239], v14 offset:3072
  v_accvgpr_write_b32 a4, 0
  v_mfma_f32_16x16x32_bf16 v[140:143], v[72:75], v[252:255], v[140:143]
  v_accvgpr_write_b32 a5, 0
  v_accvgpr_write_b32 a6, 0
  v_mfma_f32_16x16x32_bf16 v[156:159], v[76:79], v[252:255], v[156:159]
  v_accvgpr_write_b32 a7, 0
  v_accvgpr_write_b32 a36, 0
  v_mfma_f32_16x16x32_bf16 v[172:175], v[80:83], v[252:255], v[172:175]
  buffer_load_dwordx4 v9, s[36:39], s27 offen offset:1024 lds
  v_accvgpr_write_b32 a37, 0
  v_mfma_f32_16x16x32_bf16 v[188:191], v[84:87], v[252:255], v[188:191]
  v_accvgpr_write_b32 a38, 0
  v_mfma_f32_16x16x32_bf16 v[204:207], v[88:91], v[252:255], v[204:207]
  v_mfma_f32_16x16x32_bf16 v[220:223], v[92:95], v[252:255], v[220:223]
  s_waitcnt vmcnt(18) lgkmcnt(0)
  v_mfma_f32_16x16x32_bf16 v[96:99], v[32:35], v[224:227], v[96:99]
  s_add_u32 s63, s63, s61
  v_accvgpr_read_b32 v16, a16
  v_accvgpr_read_b32 v17, a17
  v_mfma_f32_16x16x32_bf16 v[112:115], v[36:39], v[224:227], v[112:115]
  ds_read_b64_tr_b16 v[64:65], v12 offset:40960
  v_accvgpr_read_b32 v18, a18
  v_mfma_f32_16x16x32_bf16 v[128:131], v[40:43], v[224:227], v[128:131]
  s_add_u32 m0, s24, 65536
  ds_read_b64_tr_b16 v[66:67], v12 offset:41984
  v_accvgpr_read_b32 v19, a19
  v_mfma_f32_16x16x32_bf16 v[144:147], v[44:47], v[224:227], v[144:147]
  buffer_load_dwordx4 v3, s[32:35], s26 offen offset:0 sc1 lds
  v_accvgpr_read_b32 v20, a48
  v_mfma_f32_16x16x32_bf16 v[160:163], v[48:51], v[224:227], v[160:163]
  ds_read_b64_tr_b16 v[68:69], v13 offset:40960
  v_accvgpr_read_b32 v21, a49
  v_mfma_f32_16x16x32_bf16 v[176:179], v[52:55], v[224:227], v[176:179]
  ds_read_b64_tr_b16 v[70:71], v13 offset:41984
  v_accvgpr_read_b32 v22, a50
  v_mfma_f32_16x16x32_bf16 v[192:195], v[56:59], v[224:227], v[192:195]
  ds_read_b64_tr_b16 v[72:73], v12 offset:41216
  v_accvgpr_read_b32 v23, a51
  v_mfma_f32_16x16x32_bf16 v[208:211], v[60:63], v[224:227], v[208:211]
  ds_read_b64_tr_b16 v[74:75], v12 offset:42240
  v_cvt_pk_bf16_f32 v24, v16, v17
  v_mfma_f32_16x16x32_bf16 v[100:103], v[32:35], v[228:231], v[100:103]
  buffer_load_dwordx4 v4, s[32:35], s26 offen offset:1024 sc1 lds
  v_cvt_pk_bf16_f32 v25, v18, v19
  v_mfma_f32_16x16x32_bf16 v[116:119], v[36:39], v[228:231], v[116:119]
  ds_read_b64_tr_b16 v[76:77], v13 offset:41216
  v_cvt_pk_bf16_f32 v26, v20, v21
  v_mfma_f32_16x16x32_bf16 v[132:135], v[40:43], v[228:231], v[132:135]
  ds_read_b64_tr_b16 v[78:79], v13 offset:42240
  v_cvt_pk_bf16_f32 v27, v22, v23
  v_mfma_f32_16x16x32_bf16 v[148:151], v[44:47], v[228:231], v[148:151]
  ds_read_b128 v[240:243], v14 offset:32768
  buffer_store_dwordx4 v[24:27], v2, s[40:43], s63 offen offset:0 sc1
  v_mfma_f32_16x16x32_bf16 v[164:167], v[48:51], v[228:231], v[164:167]
  ds_read_b128 v[244:247], v14 offset:33792
  v_accvgpr_read_b32 v16, a20
  v_mfma_f32_16x16x32_bf16 v[180:183], v[52:55], v[228:231], v[180:183]
  buffer_load_dwordx4 v5, s[32:35], s26 offen offset:2048 sc1 lds
  v_accvgpr_read_b32 v17, a21
  v_mfma_f32_16x16x32_bf16 v[196:199], v[56:59], v[228:231], v[196:199]
  ds_read_b64_tr_b16 v[80:81], v12 offset:41472
  v_accvgpr_read_b32 v18, a22
  v_mfma_f32_16x16x32_bf16 v[212:215], v[60:63], v[228:231], v[212:215]
  ds_read_b64_tr_b16 v[82:83], v12 offset:42496
  v_accvgpr_read_b32 v19, a23
  v_mfma_f32_16x16x32_bf16 v[104:107], v[32:35], v[232:235], v[104:107]
  ds_read_b64_tr_b16 v[84:85], v13 offset:41472
  v_accvgpr_read_b32 v20, a52
  v_mfma_f32_16x16x32_bf16 v[120:123], v[36:39], v[232:235], v[120:123]
  ds_read_b64_tr_b16 v[86:87], v13 offset:42496
  v_accvgpr_read_b32 v21, a53
  v_mfma_f32_16x16x32_bf16 v[136:139], v[40:43], v[232:235], v[136:139]
  buffer_load_dwordx4 v6, s[32:35], s26 offen offset:3072 sc1 lds
  v_accvgpr_read_b32 v22, a54
  v_mfma_f32_16x16x32_bf16 v[152:155], v[44:47], v[232:235], v[152:155]
  s_add_u32 s26, s26, 1024
  ds_read_b64_tr_b16 v[88:89], v12 offset:41728
  v_accvgpr_read_b32 v23, a55
  v_mfma_f32_16x16x32_bf16 v[168:171], v[48:51], v[232:235], v[168:171]
  ds_read_b64_tr_b16 v[90:91], v12 offset:42752
  v_cvt_pk_bf16_f32 v28, v16, v17
  v_mfma_f32_16x16x32_bf16 v[184:187], v[52:55], v[232:235], v[184:187]
  ds_read_b64_tr_b16 v[92:93], v13 offset:41728
  v_cvt_pk_bf16_f32 v29, v18, v19
  v_mfma_f32_16x16x32_bf16 v[200:203], v[56:59], v[232:235], v[200:203]
  s_add_u32 m0, s24, 16384
  ds_read_b64_tr_b16 v[94:95], v13 offset:42752
  v_cvt_pk_bf16_f32 v30, v20, v21
  v_mfma_f32_16x16x32_bf16 v[216:219], v[60:63], v[232:235], v[216:219]
  buffer_load_dwordx4 v10, s[36:39], s27 offen offset:2048 lds
  v_cvt_pk_bf16_f32 v31, v22, v23
  v_mfma_f32_16x16x32_bf16 v[108:111], v[32:35], v[236:239], v[108:111]
  ds_read_b128 v[248:251], v14 offset:34816
  buffer_store_dwordx4 v[28:31], v2, s[40:43], s63 offen offset:1024 sc1
  v_mfma_f32_16x16x32_bf16 v[124:127], v[36:39], v[236:239], v[124:127]
  ds_read_b128 v[252:255], v14 offset:35840
  v_accvgpr_write_b32 a39, 0
  v_mfma_f32_16x16x32_bf16 v[140:143], v[40:43], v[236:239], v[140:143]
  v_accvgpr_write_b32 a8, 0
  v_accvgpr_write_b32 a9, 0
  v_mfma_f32_16x16x32_bf16 v[156:159], v[44:47], v[236:239], v[156:159]
  v_xor_b32 v14, 0x10000, v14
  v_accvgpr_write_b32 a10, 0
  v_mfma_f32_16x16x32_bf16 v[172:175], v[48:51], v[236:239], v[172:175]
  buffer_load_dwordx4 v11, s[36:39], s27 offen offset:3072 lds
  v_mfma_f32_16x16x32_bf16 v[188:191], v[52:55], v[236:239], v[188:191]
  s_add_u32 s27, s27, 524288
  v_xor_b32 v12, 0x10000, v12
  v_mfma_f32_16x16x32_bf16 v[204:207], v[56:59], v[236:239], v[204:207]
  v_xor_b32 v13, 0x10000, v13
  v_mfma_f32_16x16x32_bf16 v[220:223], v[60:63], v[236:239], v[220:223]
  s_waitcnt vmcnt(17) lgkmcnt(0)
  v_mfma_f32_16x16x32_bf16 v[96:99], v[64:67], v[240:243], v[96:99]
  s_barrier
  v_accvgpr_read_b32 v16, a24
  v_accvgpr_read_b32 v17, a25
  v_mfma_f32_16x16x32_bf16 v[112:115], v[68:71], v[240:243], v[112:115]
  s_add_u32 s63, s63, s61
  ds_read_b64_tr_b16 v[32:33], v12 offset:0
  v_accvgpr_read_b32 v18, a26
  v_mfma_f32_16x16x32_bf16 v[128:131], v[72:75], v[240:243], v[128:131]
  s_add_u32 m0, s24, 98304
  ds_read_b64_tr_b16 v[34:35], v12 offset:1024
  v_accvgpr_read_b32 v19, a27
  v_mfma_f32_16x16x32_bf16 v[144:147], v[76:79], v[240:243], v[144:147]
  buffer_load_dwordx4 v3, s[32:35], s26 offen offset:0 sc1 lds
  v_accvgpr_read_b32 v20, a56
  v_mfma_f32_16x16x32_bf16 v[160:163], v[80:83], v[240:243], v[160:163]
  ds_read_b64_tr_b16 v[36:37], v13 offset:0
  v_accvgpr_read_b32 v21, a57
  v_mfma_f32_16x16x32_bf16 v[176:179], v[84:87], v[240:243], v[176:179]
  ds_read_b64_tr_b16 v[38:39], v13 offset:1024
  v_accvgpr_read_b32 v22, a58
  v_mfma_f32_16x16x32_bf16 v[192:195], v[88:91], v[240:243], v[192:195]
  ds_read_b64_tr_b16 v[40:41], v12 offset:256
  v_accvgpr_read_b32 v23, a59
  v_mfma_f32_16x16x32_bf16 v[208:211], v[92:95], v[240:243], v[208:211]
  ds_read_b64_tr_b16 v[42:43], v12 offset:1280
  v_cvt_pk_bf16_f32 v24, v16, v17
  v_mfma_f32_16x16x32_bf16 v[100:103], v[64:67], v[244:247], v[100:103]
  buffer_load_dwordx4 v4, s[32:35], s26 offen offset:1024 sc1 lds
  v_cvt_pk_bf16_f32 v25, v18, v19
  v_mfma_f32_16x16x32_bf16 v[116:119], v[68:71], v[244:247], v[116:119]
  ds_read_b64_tr_b16 v[44:45], v13 offset:256
  v_cvt_pk_bf16_f32 v26, v20, v21
  v_mfma_f32_16x16x32_bf16 v[132:135], v[72:75], v[244:247], v[132:135]
  ds_read_b64_tr_b16 v[46:47], v13 offset:1280
  v_cvt_pk_bf16_f32 v27, v22, v23
  v_mfma_f32_16x16x32_bf16 v[148:151], v[76:79], v[244:247], v[148:151]
  ds_read_b128 v[224:227], v14 offset:0
  buffer_store_dwordx4 v[24:27], v2, s[40:43], s63 offen offset:0 sc1
  v_mfma_f32_16x16x32_bf16 v[164:167], v[80:83], v[244:247], v[164:167]
  ds_read_b128 v[228:231], v14 offset:1024
  v_accvgpr_read_b32 v16, a28
  v_mfma_f32_16x16x32_bf16 v[180:183], v[84:87], v[244:247], v[180:183]
  buffer_load_dwordx4 v5, s[32:35], s26 offen offset:2048 sc1 lds
  v_accvgpr_read_b32 v17, a29
  v_mfma_f32_16x16x32_bf16 v[196:199], v[88:91], v[244:247], v[196:199]
  ds_read_b64_tr_b16 v[48:49], v12 offset:512
  v_accvgpr_read_b32 v18, a30
  v_mfma_f32_16x16x32_bf16 v[212:215], v[92:95], v[244:247], v[212:215]
  ds_read_b64_tr_b16 v[50:51], v12 offset:1536
  v_accvgpr_read_b32 v19, a31
  v_mfma_f32_16x16x32_bf16 v[104:107], v[64:67], v[248:251], v[104:107]
  ds_read_b64_tr_b16 v[52:53], v13 offset:512
  v_accvgpr_read_b32 v20, a60
  v_mfma_f32_16x16x32_bf16 v[120:123], v[68:71], v[248:251], v[120:123]
  ds_read_b64_tr_b16 v[54:55], v13 offset:1536
  v_accvgpr_read_b32 v21, a61
  v_mfma_f32_16x16x32_bf16 v[136:139], v[72:75], v[248:251], v[136:139]
  buffer_load_dwordx4 v6, s[32:35], s26 offen offset:3072 sc1 lds
  v_accvgpr_read_b32 v22, a62
  v_mfma_f32_16x16x32_bf16 v[152:155], v[76:79], v[248:251], v[152:155]
  s_add_u32 s26, s26, 1024
  ds_read_b64_tr_b16 v[56:57], v12 offset:768
  v_accvgpr_read_b32 v23, a63
  v_mfma_f32_16x16x32_bf16 v[168:171], v[80:83], v[248:251], v[168:171]
  ds_read_b64_tr_b16 v[58:59], v12 offset:1792
  v_cvt_pk_bf16_f32 v28, v16, v17
  v_mfma_f32_16x16x32_bf16 v[184:187], v[84:87], v[248:251], v[184:187]
  ds_read_b64_tr_b16 v[60:61], v13 offset:768
  v_cvt_pk_bf16_f32 v29, v18, v19
  v_mfma_f32_16x16x32_bf16 v[200:203], v[88:91], v[248:251], v[200:203]
  s_add_u32 m0, s24, 49152
  ds_read_b64_tr_b16 v[62:63], v13 offset:1792
  v_cvt_pk_bf16_f32 v30, v20, v21
  v_mfma_f32_16x16x32_bf16 v[216:219], v[92:95], v[248:251], v[216:219]
  buffer_load_dwordx4 v8, s[36:39], s27 offen offset:0 lds
  v_cvt_pk_bf16_f32 v31, v22, v23
  v_mfma_f32_16x16x32_bf16 v[108:111], v[64:67], v[252:255], v[108:111]
  ds_read_b128 v[232:235], v14 offset:2048
  buffer_store_dwordx4 v[28:31], v2, s[40:43], s63 offen offset:1024 sc1
  v_mfma_f32_16x16x32_bf16 v[124:127], v[68:71], v[252:255], v[124:127]
  ds_read_b128 v[236:239], v14 offset:3072
  v_accvgpr_write_b32 a11, 0
  v_mfma_f32_16x16x32_bf16 v[140:143], v[72:75], v[252:255], v[140:143]
  v_accvgpr_write_b32 a40, 0
  v_accvgpr_write_b32 a41, 0
  v_mfma_f32_16x16x32_bf16 v[156:159], v[76:79], v[252:255], v[156:159]
  v_accvgpr_write_b32 a42, 0
  v_accvgpr_write_b32 a43, 0
  v_mfma_f32_16x16x32_bf16 v[172:175], v[80:83], v[252:255], v[172:175]
  buffer_load_dwordx4 v9, s[36:39], s27 offen offset:1024 lds
  v_accvgpr_write_b32 a12, 0
  v_mfma_f32_16x16x32_bf16 v[188:191], v[84:87], v[252:255], v[188:191]
  v_accvgpr_write_b32 a13, 0
  v_mfma_f32_16x16x32_bf16 v[204:207], v[88:91], v[252:255], v[204:207]
  v_mfma_f32_16x16x32_bf16 v[220:223], v[92:95], v[252:255], v[220:223]
  s_waitcnt vmcnt(19) lgkmcnt(0)
  v_mfma_f32_16x16x32_bf16 v[96:99], v[32:35], v[224:227], v[96:99]
  s_mul_i32 s63, s60, 1
  v_accvgpr_read_b32 v16, a64
  v_accvgpr_read_b32 v17, a65
  v_mfma_f32_16x16x32_bf16 v[112:115], v[36:39], v[224:227], v[112:115]
  s_add_u32 s63, s63, s62
  ds_read_b64_tr_b16 v[64:65], v12 offset:8192
  v_accvgpr_read_b32 v18, a66
  v_mfma_f32_16x16x32_bf16 v[128:131], v[40:43], v[224:227], v[128:131]
  s_add_u32 m0, s24, 0
  ds_read_b64_tr_b16 v[66:67], v12 offset:9216
  v_accvgpr_read_b32 v19, a67
  v_mfma_f32_16x16x32_bf16 v[144:147], v[44:47], v[224:227], v[144:147]
  buffer_load_dwordx4 v3, s[32:35], s26 offen offset:0 sc1 lds
  v_accvgpr_read_b32 v20, a96
  v_mfma_f32_16x16x32_bf16 v[160:163], v[48:51], v[224:227], v[160:163]
  ds_read_b64_tr_b16 v[68:69], v13 offset:8192
  v_accvgpr_read_b32 v21, a97
  v_mfma_f32_16x16x32_bf16 v[176:179], v[52:55], v[224:227], v[176:179]
  ds_read_b64_tr_b16 v[70:71], v13 offset:9216
  v_accvgpr_read_b32 v22, a98
  v_mfma_f32_16x16x32_bf16 v[192:195], v[56:59], v[224:227], v[192:195]
  ds_read_b64_tr_b16 v[72:73], v12 offset:8448
  v_accvgpr_read_b32 v23, a99
  v_mfma_f32_16x16x32_bf16 v[208:211], v[60:63], v[224:227], v[208:211]
  ds_read_b64_tr_b16 v[74:75], v12 offset:9472
  v_cvt_pk_bf16_f32 v24, v16, v17
  v_mfma_f32_16x16x32_bf16 v[100:103], v[32:35], v[228:231], v[100:103]
  buffer_load_dwordx4 v4, s[32:35], s26 offen offset:1024 sc1 lds
  v_cvt_pk_bf16_f32 v25, v18, v19
  v_mfma_f32_16x16x32_bf16 v[116:119], v[36:39], v[228:231], v[116:119]
  ds_read_b64_tr_b16 v[76:77], v13 offset:8448
  v_cvt_pk_bf16_f32 v26, v20, v21
  v_mfma_f32_16x16x32_bf16 v[132:135], v[40:43], v[228:231], v[132:135]
  ds_read_b64_tr_b16 v[78:79], v13 offset:9472
  v_cvt_pk_bf16_f32 v27, v22, v23
  v_mfma_f32_16x16x32_bf16 v[148:151], v[44:47], v[228:231], v[148:151]
  ds_read_b128 v[240:243], v14 offset:32768
  buffer_store_dwordx4 v[24:27], v2, s[40:43], s63 offen offset:0 sc1
  v_mfma_f32_16x16x32_bf16 v[164:167], v[48:51], v[228:231], v[164:167]
  ds_read_b128 v[244:247], v14 offset:33792
  v_accvgpr_read_b32 v16, a68
  v_mfma_f32_16x16x32_bf16 v[180:183], v[52:55], v[228:231], v[180:183]
  buffer_load_dwordx4 v5, s[32:35], s26 offen offset:2048 sc1 lds
  v_accvgpr_read_b32 v17, a69
  v_mfma_f32_16x16x32_bf16 v[196:199], v[56:59], v[228:231], v[196:199]
  ds_read_b64_tr_b16 v[80:81], v12 offset:8704
  v_accvgpr_read_b32 v18, a70
  v_mfma_f32_16x16x32_bf16 v[212:215], v[60:63], v[228:231], v[212:215]
  ds_read_b64_tr_b16 v[82:83], v12 offset:9728
  v_accvgpr_read_b32 v19, a71
  v_mfma_f32_16x16x32_bf16 v[104:107], v[32:35], v[232:235], v[104:107]
  ds_read_b64_tr_b16 v[84:85], v13 offset:8704
  v_accvgpr_read_b32 v20, a100
  v_mfma_f32_16x16x32_bf16 v[120:123], v[36:39], v[232:235], v[120:123]
  ds_read_b64_tr_b16 v[86:87], v13 offset:9728
  v_accvgpr_read_b32 v21, a101
  v_mfma_f32_16x16x32_bf16 v[136:139], v[40:43], v[232:235], v[136:139]
  buffer_load_dwordx4 v6, s[32:35], s26 offen offset:3072 sc1 lds
  v_accvgpr_read_b32 v22, a102
  v_mfma_f32_16x16x32_bf16 v[152:155], v[44:47], v[232:235], v[152:155]
  s_add_u32 s26, s26, 1024
  ds_read_b64_tr_b16 v[88:89], v12 offset:8960
  v_accvgpr_read_b32 v23, a103
  v_mfma_f32_16x16x32_bf16 v[168:171], v[48:51], v[232:235], v[168:171]
  ds_read_b64_tr_b16 v[90:91], v12 offset:9984
  v_cvt_pk_bf16_f32 v28, v16, v17
  v_mfma_f32_16x16x32_bf16 v[184:187], v[52:55], v[232:235], v[184:187]
  ds_read_b64_tr_b16 v[92:93], v13 offset:8960
  v_cvt_pk_bf16_f32 v29, v18, v19
  v_mfma_f32_16x16x32_bf16 v[200:203], v[56:59], v[232:235], v[200:203]
  s_add_u32 m0, s24, 49152
  ds_read_b64_tr_b16 v[94:95], v13 offset:9984
  v_cvt_pk_bf16_f32 v30, v20, v21
  v_mfma_f32_16x16x32_bf16 v[216:219], v[60:63], v[232:235], v[216:219]
  buffer_load_dwordx4 v10, s[36:39], s27 offen offset:2048 lds
  v_cvt_pk_bf16_f32 v31, v22, v23
  v_mfma_f32_16x16x32_bf16 v[108:111], v[32:35], v[236:239], v[108:111]
  ds_read_b128 v[248:251], v14 offset:34816
  buffer_store_dwordx4 v[28:31], v2, s[40:43], s63 offen offset:1024 sc1
  v_mfma_f32_16x16x32_bf16 v[124:127], v[36:39], v[236:239], v[124:127]
  ds_read_b128 v[252:255], v14 offset:35840
  v_accvgpr_write_b32 a14, 0
  v_mfma_f32_16x16x32_bf16 v[140:143], v[40:43], v[236:239], v[140:143]
  v_accvgpr_write_b32 a15, 0
  v_accvgpr_write_b32 a44, 0
  v_mfma_f32_16x16x32_bf16 v[156:159], v[44:47], v[236:239], v[156:159]
  v_xor_b32 v14, 0x10000, v14
  v_accvgpr_write_b32 a45, 0
  v_mfma_f32_16x16x32_bf16 v[172:175], v[48:51], v[236:239], v[172:175]
  buffer_load_dwordx4 v11, s[36:39], s27 offen offset:3072 lds
  v_accvgpr_write_b32 a46, 0
  v_mfma_f32_16x16x32_bf16 v[188:191], v[52:55], v[236:239], v[188:191]
  s_add_u32 s27, s27, 524288
  v_accvgpr_write_b32 a47, 0
  v_mfma_f32_16x16x32_bf16 v[204:207], v[56:59], v[236:239], v[204:207]
  v_mfma_f32_16x16x32_bf16 v[220:223], v[60:63], v[236:239], v[220:223]
  s_waitcnt vmcnt(19) lgkmcnt(0)
  v_mfma_f32_16x16x32_bf16 v[96:99], v[64:67], v[240:243], v[96:99]
  s_barrier
  v_accvgpr_read_b32 v16, a72
  v_accvgpr_read_b32 v17, a73
  v_mfma_f32_16x16x32_bf16 v[112:115], v[68:71], v[240:243], v[112:115]
  s_add_u32 s63, s63, s61
  ds_read_b64_tr_b16 v[32:33], v12 offset:32768
  v_accvgpr_read_b32 v18, a74
  v_mfma_f32_16x16x32_bf16 v[128:131], v[72:75], v[240:243], v[128:131]
  s_add_u32 m0, s24, 32768
  ds_read_b64_tr_b16 v[34:35], v12 offset:33792
  v_accvgpr_read_b32 v19, a75
  v_mfma_f32_16x16x32_bf16 v[144:147], v[76:79], v[240:243], v[144:147]
  buffer_load_dwordx4 v3, s[32:35], s26 offen offset:0 sc1 lds
  v_accvgpr_read_b32 v20, a104
  v_mfma_f32_16x16x32_bf16 v[160:163], v[80:83], v[240:243], v[160:163]
  ds_read_b64_tr_b16 v[36:37], v13 offset:32768
  v_accvgpr_read_b32 v21, a105
  v_mfma_f32_16x16x32_bf16 v[176:179], v[84:87], v[240:243], v[176:179]
  ds_read_b64_tr_b16 v[38:39], v13 offset:33792
  v_accvgpr_read_b32 v22, a106
  v_mfma_f32_16x16x32_bf16 v[192:195], v[88:91], v[240:243], v[192:195]
  ds_read_b64_tr_b16 v[40:41], v12 offset:33024
  v_accvgpr_read_b32 v23, a107
  v_mfma_f32_16x16x32_bf16 v[208:211], v[92:95], v[240:243], v[208:211]
  ds_read_b64_tr_b16 v[42:43], v12 offset:34048
  v_cvt_pk_bf16_f32 v24, v16, v17
  v_mfma_f32_16x16x32_bf16 v[100:103], v[64:67], v[244:247], v[100:103]
  buffer_load_dwordx4 v4, s[32:35], s26 offen offset:1024 sc1 lds
  v_cvt_pk_bf16_f32 v25, v18, v19
  v_mfma_f32_16x16x32_bf16 v[116:119], v[68:71], v[244:247], v[116:119]
  ds_read_b64_tr_b16 v[44:45], v13 offset:33024
  v_cvt_pk_bf16_f32 v26, v20, v21
  v_mfma_f32_16x16x32_bf16 v[132:135], v[72:75], v[244:247], v[132:135]
  ds_read_b64_tr_b16 v[46:47], v13 offset:34048
  v_cvt_pk_bf16_f32 v27, v22, v23
  v_mfma_f32_16x16x32_bf16 v[148:151], v[76:79], v[244:247], v[148:151]
  ds_read_b128 v[224:227], v14 offset:0
  buffer_store_dwordx4 v[24:27], v2, s[40:43], s63 offen offset:0 sc1
  v_mfma_f32_16x16x32_bf16 v[164:167], v[80:83], v[244:247], v[164:167]
  ds_read_b128 v[228:231], v14 offset:1024
  v_accvgpr_read_b32 v16, a76
  v_mfma_f32_16x16x32_bf16 v[180:183], v[84:87], v[244:247], v[180:183]
  buffer_load_dwordx4 v5, s[32:35], s26 offen offset:2048 sc1 lds
  v_accvgpr_read_b32 v17, a77
  v_mfma_f32_16x16x32_bf16 v[196:199], v[88:91], v[244:247], v[196:199]
  ds_read_b64_tr_b16 v[48:49], v12 offset:33280
  v_accvgpr_read_b32 v18, a78
  v_mfma_f32_16x16x32_bf16 v[212:215], v[92:95], v[244:247], v[212:215]
  ds_read_b64_tr_b16 v[50:51], v12 offset:34304
  v_accvgpr_read_b32 v19, a79
  v_mfma_f32_16x16x32_bf16 v[104:107], v[64:67], v[248:251], v[104:107]
  ds_read_b64_tr_b16 v[52:53], v13 offset:33280
  v_accvgpr_read_b32 v20, a108
  v_mfma_f32_16x16x32_bf16 v[120:123], v[68:71], v[248:251], v[120:123]
  ds_read_b64_tr_b16 v[54:55], v13 offset:34304
  v_accvgpr_read_b32 v21, a109
  v_mfma_f32_16x16x32_bf16 v[136:139], v[72:75], v[248:251], v[136:139]
  buffer_load_dwordx4 v6, s[32:35], s26 offen offset:3072 sc1 lds
  v_accvgpr_read_b32 v22, a110
  v_mfma_f32_16x16x32_bf16 v[152:155], v[76:79], v[248:251], v[152:155]
  s_add_u32 s26, s26, 1024
  ds_read_b64_tr_b16 v[56:57], v12 offset:33536
  v_accvgpr_read_b32 v23, a111
  v_mfma_f32_16x16x32_bf16 v[168:171], v[80:83], v[248:251], v[168:171]
  ds_read_b64_tr_b16 v[58:59], v12 offset:34560
  v_cvt_pk_bf16_f32 v28, v16, v17
  v_mfma_f32_16x16x32_bf16 v[184:187], v[84:87], v[248:251], v[184:187]
  ds_read_b64_tr_b16 v[60:61], v13 offset:33536
  v_cvt_pk_bf16_f32 v29, v18, v19
  v_mfma_f32_16x16x32_bf16 v[200:203], v[88:91], v[248:251], v[200:203]
  s_add_u32 m0, s24, 81920
  ds_read_b64_tr_b16 v[62:63], v13 offset:34560
  v_cvt_pk_bf16_f32 v30, v20, v21
  v_mfma_f32_16x16x32_bf16 v[216:219], v[92:95], v[248:251], v[216:219]
  buffer_load_dwordx4 v8, s[36:39], s27 offen offset:0 lds
  v_cvt_pk_bf16_f32 v31, v22, v23
  v_mfma_f32_16x16x32_bf16 v[108:111], v[64:67], v[252:255], v[108:111]
  ds_read_b128 v[232:235], v14 offset:2048
  buffer_store_dwordx4 v[28:31], v2, s[40:43], s63 offen offset:1024 sc1
  v_mfma_f32_16x16x32_bf16 v[124:127], v[68:71], v[252:255], v[124:127]
  ds_read_b128 v[236:239], v14 offset:3072
  v_accvgpr_write_b32 a16, 0
  v_mfma_f32_16x16x32_bf16 v[140:143], v[72:75], v[252:255], v[140:143]
  v_accvgpr_write_b32 a17, 0
  v_accvgpr_write_b32 a18, 0
  v_mfma_f32_16x16x32_bf16 v[156:159], v[76:79], v[252:255], v[156:159]
  v_accvgpr_write_b32 a19, 0
  v_accvgpr_write_b32 a48, 0
  v_mfma_f32_16x16x32_bf16 v[172:175], v[80:83], v[252:255], v[172:175]
  buffer_load_dwordx4 v9, s[36:39], s27 offen offset:1024 lds
  v_accvgpr_write_b32 a49, 0
  v_mfma_f32_16x16x32_bf16 v[188:191], v[84:87], v[252:255], v[188:191]
  v_accvgpr_write_b32 a50, 0
  v_mfma_f32_16x16x32_bf16 v[204:207], v[88:91], v[252:255], v[204:207]
  v_mfma_f32_16x16x32_bf16 v[220:223], v[92:95], v[252:255], v[220:223]
  s_waitcnt vmcnt(19) lgkmcnt(0)
  v_mfma_f32_16x16x32_bf16 v[96:99], v[32:35], v[224:227], v[96:99]
  s_add_u32 s63, s63, s61
  v_accvgpr_read_b32 v16, a80
  v_accvgpr_read_b32 v17, a81
  v_mfma_f32_16x16x32_bf16 v[112:115], v[36:39], v[224:227], v[112:115]
  ds_read_b64_tr_b16 v[64:65], v12 offset:40960
  v_accvgpr_read_b32 v18, a82
  v_mfma_f32_16x16x32_bf16 v[128:131], v[40:43], v[224:227], v[128:131]
  s_add_u32 m0, s24, 65536
  ds_read_b64_tr_b16 v[66:67], v12 offset:41984
  v_accvgpr_read_b32 v19, a83
  v_mfma_f32_16x16x32_bf16 v[144:147], v[44:47], v[224:227], v[144:147]
  buffer_load_dwordx4 v3, s[32:35], s26 offen offset:0 sc1 lds
  v_accvgpr_read_b32 v20, a112
  v_mfma_f32_16x16x32_bf16 v[160:163], v[48:51], v[224:227], v[160:163]
  ds_read_b64_tr_b16 v[68:69], v13 offset:40960
  v_accvgpr_read_b32 v21, a113
  v_mfma_f32_16x16x32_bf16 v[176:179], v[52:55], v[224:227], v[176:179]
  ds_read_b64_tr_b16 v[70:71], v13 offset:41984
  v_accvgpr_read_b32 v22, a114
  v_mfma_f32_16x16x32_bf16 v[192:195], v[56:59], v[224:227], v[192:195]
  ds_read_b64_tr_b16 v[72:73], v12 offset:41216
  v_accvgpr_read_b32 v23, a115
  v_mfma_f32_16x16x32_bf16 v[208:211], v[60:63], v[224:227], v[208:211]
  ds_read_b64_tr_b16 v[74:75], v12 offset:42240
  v_cvt_pk_bf16_f32 v24, v16, v17
  v_mfma_f32_16x16x32_bf16 v[100:103], v[32:35], v[228:231], v[100:103]
  buffer_load_dwordx4 v4, s[32:35], s26 offen offset:1024 sc1 lds
  v_cvt_pk_bf16_f32 v25, v18, v19
  v_mfma_f32_16x16x32_bf16 v[116:119], v[36:39], v[228:231], v[116:119]
  ds_read_b64_tr_b16 v[76:77], v13 offset:41216
  v_cvt_pk_bf16_f32 v26, v20, v21
  v_mfma_f32_16x16x32_bf16 v[132:135], v[40:43], v[228:231], v[132:135]
  ds_read_b64_tr_b16 v[78:79], v13 offset:42240
  v_cvt_pk_bf16_f32 v27, v22, v23
  v_mfma_f32_16x16x32_bf16 v[148:151], v[44:47], v[228:231], v[148:151]
  ds_read_b128 v[240:243], v14 offset:32768
  buffer_store_dwordx4 v[24:27], v2, s[40:43], s63 offen offset:0 sc1
  v_mfma_f32_16x16x32_bf16 v[164:167], v[48:51], v[228:231], v[164:167]
  ds_read_b128 v[244:247], v14 offset:33792
  v_accvgpr_read_b32 v16, a84
  v_mfma_f32_16x16x32_bf16 v[180:183], v[52:55], v[228:231], v[180:183]
  buffer_load_dwordx4 v5, s[32:35], s26 offen offset:2048 sc1 lds
  v_accvgpr_read_b32 v17, a85
  v_mfma_f32_16x16x32_bf16 v[196:199], v[56:59], v[228:231], v[196:199]
  ds_read_b64_tr_b16 v[80:81], v12 offset:41472
  v_accvgpr_read_b32 v18, a86
  v_mfma_f32_16x16x32_bf16 v[212:215], v[60:63], v[228:231], v[212:215]
  ds_read_b64_tr_b16 v[82:83], v12 offset:42496
  v_accvgpr_read_b32 v19, a87
  v_mfma_f32_16x16x32_bf16 v[104:107], v[32:35], v[232:235], v[104:107]
  ds_read_b64_tr_b16 v[84:85], v13 offset:41472
  v_accvgpr_read_b32 v20, a116
  v_mfma_f32_16x16x32_bf16 v[120:123], v[36:39], v[232:235], v[120:123]
  ds_read_b64_tr_b16 v[86:87], v13 offset:42496
  v_accvgpr_read_b32 v21, a117
  v_mfma_f32_16x16x32_bf16 v[136:139], v[40:43], v[232:235], v[136:139]
  buffer_load_dwordx4 v6, s[32:35], s26 offen offset:3072 sc1 lds
  v_accvgpr_read_b32 v22, a118
  v_mfma_f32_16x16x32_bf16 v[152:155], v[44:47], v[232:235], v[152:155]
  s_add_u32 s26, s26, 1024
  ds_read_b64_tr_b16 v[88:89], v12 offset:41728
  v_accvgpr_read_b32 v23, a119
  v_mfma_f32_16x16x32_bf16 v[168:171], v[48:51], v[232:235], v[168:171]
  ds_read_b64_tr_b16 v[90:91], v12 offset:42752
  v_cvt_pk_bf16_f32 v28, v16, v17
  v_mfma_f32_16x16x32_bf16 v[184:187], v[52:55], v[232:235], v[184:187]
  ds_read_b64_tr_b16 v[92:93], v13 offset:41728
  v_cvt_pk_bf16_f32 v29, v18, v19
  v_mfma_f32_16x16x32_bf16 v[200:203], v[56:59], v[232:235], v[200:203]
  s_add_u32 m0, s24, 81920
  ds_read_b64_tr_b16 v[94:95], v13 offset:42752
  v_cvt_pk_bf16_f32 v30, v20, v21
  v_mfma_f32_16x16x32_bf16 v[216:219], v[60:63], v[232:235], v[216:219]
  buffer_load_dwordx4 v10, s[36:39], s27 offen offset:2048 lds
  v_cvt_pk_bf16_f32 v31, v22, v23
  v_mfma_f32_16x16x32_bf16 v[108:111], v[32:35], v[236:239], v[108:111]
  ds_read_b128 v[248:251], v14 offset:34816
  buffer_store_dwordx4 v[28:31], v2, s[40:43], s63 offen offset:1024 sc1
  v_mfma_f32_16x16x32_bf16 v[124:127], v[36:39], v[236:239], v[124:127]
  ds_read_b128 v[252:255], v14 offset:35840
  v_accvgpr_write_b32 a51, 0
  v_mfma_f32_16x16x32_bf16 v[140:143], v[40:43], v[236:239], v[140:143]
  v_accvgpr_write_b32 a20, 0
  v_accvgpr_write_b32 a21, 0
  v_mfma_f32_16x16x32_bf16 v[156:159], v[44:47], v[236:239], v[156:159]
  v_xor_b32 v14, 0x10000, v14
  v_accvgpr_write_b32 a22, 0
  v_mfma_f32_16x16x32_bf16 v[172:175], v[48:51], v[236:239], v[172:175]
  buffer_load_dwordx4 v11, s[36:39], s27 offen offset:3072 lds
  v_mfma_f32_16x16x32_bf16 v[188:191], v[52:55], v[236:239], v[188:191]
  s_add_u32 s27, s27, 524288
  v_xor_b32 v12, 0x10000, v12
  v_mfma_f32_16x16x32_bf16 v[204:207], v[56:59], v[236:239], v[204:207]
  v_xor_b32 v13, 0x10000, v13
  v_mfma_f32_16x16x32_bf16 v[220:223], v[60:63], v[236:239], v[220:223]
  s_waitcnt vmcnt(19) lgkmcnt(0)
  v_mfma_f32_16x16x32_bf16 v[96:99], v[64:67], v[240:243], v[96:99]
  s_barrier
  v_accvgpr_read_b32 v16, a88
  v_accvgpr_read_b32 v17, a89
  v_mfma_f32_16x16x32_bf16 v[112:115], v[68:71], v[240:243], v[112:115]
  s_add_u32 s63, s63, s61
  ds_read_b64_tr_b16 v[32:33], v12 offset:0
  v_accvgpr_read_b32 v18, a90
  v_mfma_f32_16x16x32_bf16 v[128:131], v[72:75], v[240:243], v[128:131]
  s_add_u32 m0, s24, 98304
  ds_read_b64_tr_b16 v[34:35], v12 offset:1024
  v_accvgpr_read_b32 v19, a91
  v_mfma_f32_16x16x32_bf16 v[144:147], v[76:79], v[240:243], v[144:147]
  buffer_load_dwordx4 v3, s[32:35], s26 offen offset:0 sc1 lds
  v_accvgpr_read_b32 v20, a120
  v_mfma_f32_16x16x32_bf16 v[160:163], v[80:83], v[240:243], v[160:163]
  ds_read_b64_tr_b16 v[36:37], v13 offset:0
  v_accvgpr_read_b32 v21, a121
  v_mfma_f32_16x16x32_bf16 v[176:179], v[84:87], v[240:243], v[176:179]
  ds_read_b64_tr_b16 v[38:39], v13 offset:1024
  v_accvgpr_read_b32 v22, a122
  v_mfma_f32_16x16x32_bf16 v[192:195], v[88:91], v[240:243], v[192:195]
  ds_read_b64_tr_b16 v[40:41], v12 offset:256
  v_accvgpr_read_b32 v23, a123
  v_mfma_f32_16x16x32_bf16 v[208:211], v[92:95], v[240:243], v[208:211]
  ds_read_b64_tr_b16 v[42:43], v12 offset:1280
  v_cvt_pk_bf16_f32 v24, v16, v17
  v_mfma_f32_16x16x32_bf16 v[100:103], v[64:67], v[244:247], v[100:103]
  buffer_load_dwordx4 v4, s[32:35], s26 offen offset:1024 sc1 lds
  v_cvt_pk_bf16_f32 v25, v18, v19
  v_mfma_f32_16x16x32_bf16 v[116:119], v[68:71], v[244:247], v[116:119]
  ds_read_b64_tr_b16 v[44:45], v13 offset:256
  v_cvt_pk_bf16_f32 v26, v20, v21
  v_mfma_f32_16x16x32_bf16 v[132:135], v[72:75], v[244:247], v[132:135]
  ds_read_b64_tr_b16 v[46:47], v13 offset:1280
  v_cvt_pk_bf16_f32 v27, v22, v23
  v_mfma_f32_16x16x32_bf16 v[148:151], v[76:79], v[244:247], v[148:151]
  ds_read_b128 v[224:227], v14 offset:0
  buffer_store_dwordx4 v[24:27], v2, s[40:43], s63 offen offset:0 sc1
  v_mfma_f32_16x16x32_bf16 v[164:167], v[80:83], v[244:247], v[164:167]
  ds_read_b128 v[228:231], v14 offset:1024
  v_accvgpr_read_b32 v16, a92
  v_mfma_f32_16x16x32_bf16 v[180:183], v[84:87], v[244:247], v[180:183]
  buffer_load_dwordx4 v5, s[32:35], s26 offen offset:2048 sc1 lds
  v_accvgpr_read_b32 v17, a93
  v_mfma_f32_16x16x32_bf16 v[196:199], v[88:91], v[244:247], v[196:199]
  ds_read_b64_tr_b16 v[48:49], v12 offset:512
  v_accvgpr_read_b32 v18, a94
  v_mfma_f32_16x16x32_bf16 v[212:215], v[92:95], v[244:247], v[212:215]
  ds_read_b64_tr_b16 v[50:51], v12 offset:1536
  v_accvgpr_read_b32 v19, a95
  v_mfma_f32_16x16x32_bf16 v[104:107], v[64:67], v[248:251], v[104:107]
  ds_read_b64_tr_b16 v[52:53], v13 offset:512
  v_accvgpr_read_b32 v20, a124
  v_mfma_f32_16x16x32_bf16 v[120:123], v[68:71], v[248:251], v[120:123]
  ds_read_b64_tr_b16 v[54:55], v13 offset:1536
  v_accvgpr_read_b32 v21, a125
  v_mfma_f32_16x16x32_bf16 v[136:139], v[72:75], v[248:251], v[136:139]
  buffer_load_dwordx4 v6, s[32:35], s26 offen offset:3072 sc1 lds
  v_accvgpr_read_b32 v22, a126
  v_mfma_f32_16x16x32_bf16 v[152:155], v[76:79], v[248:251], v[152:155]
  s_add_u32 s26, s26, 1024
  ds_read_b64_tr_b16 v[56:57], v12 offset:768
  v_accvgpr_read_b32 v23, a127
  v_mfma_f32_16x16x32_bf16 v[168:171], v[80:83], v[248:251], v[168:171]
  ds_read_b64_tr_b16 v[58:59], v12 offset:1792
  v_cvt_pk_bf16_f32 v28, v16, v17
  v_mfma_f32_16x16x32_bf16 v[184:187], v[84:87], v[248:251], v[184:187]
  ds_read_b64_tr_b16 v[60:61], v13 offset:768
  v_cvt_pk_bf16_f32 v29, v18, v19
  v_mfma_f32_16x16x32_bf16 v[200:203], v[88:91], v[248:251], v[200:203]
  s_add_u32 m0, s24, 114688
  ds_read_b64_tr_b16 v[62:63], v13 offset:1792
  v_cvt_pk_bf16_f32 v30, v20, v21
  v_mfma_f32_16x16x32_bf16 v[216:219], v[92:95], v[248:251], v[216:219]
  buffer_load_dwordx4 v8, s[36:39], s27 offen offset:0 lds
  v_cvt_pk_bf16_f32 v31, v22, v23
  v_mfma_f32_16x16x32_bf16 v[108:111], v[64:67], v[252:255], v[108:111]
  ds_read_b128 v[232:235], v14 offset:2048
  buffer_store_dwordx4 v[28:31], v2, s[40:43], s63 offen offset:1024 sc1
  v_mfma_f32_16x16x32_bf16 v[124:127], v[68:71], v[252:255], v[124:127]
  ds_read_b128 v[236:239], v14 offset:3072
  v_accvgpr_write_b32 a23, 0
  v_mfma_f32_16x16x32_bf16 v[140:143], v[72:75], v[252:255], v[140:143]
  v_accvgpr_write_b32 a52, 0
  v_accvgpr_write_b32 a53, 0
  v_mfma_f32_16x16x32_bf16 v[156:159], v[76:79], v[252:255], v[156:159]
  v_accvgpr_write_b32 a54, 0
  v_accvgpr_write_b32 a55, 0
  v_mfma_f32_16x16x32_bf16 v[172:175], v[80:83], v[252:255], v[172:175]
  buffer_load_dwordx4 v9, s[36:39], s27 offen offset:1024 lds
  v_accvgpr_write_b32 a24, 0
  v_mfma_f32_16x16x32_bf16 v[188:191], v[84:87], v[252:255], v[188:191]
  v_accvgpr_write_b32 a25, 0
  v_mfma_f32_16x16x32_bf16 v[204:207], v[88:91], v[252:255], v[204:207]
  v_mfma_f32_16x16x32_bf16 v[220:223], v[92:95], v[252:255], v[220:223]
  s_waitcnt vmcnt(19) lgkmcnt(0)
  v_mfma_f32_16x16x32_bf16 v[96:99], v[32:35], v[224:227], v[96:99]
  s_mul_i32 s63, s60, 2
  v_accvgpr_read_b32 v16, a128
  v_accvgpr_read_b32 v17, a129
  v_mfma_f32_16x16x32_bf16 v[112:115], v[36:39], v[224:227], v[112:115]
  s_add_u32 s63, s63, s62
  ds_read_b64_tr_b16 v[64:65], v12 offset:8192
  v_accvgpr_read_b32 v18, a130
  v_mfma_f32_16x16x32_bf16 v[128:131], v[40:43], v[224:227], v[128:131]
  s_add_u32 m0, s24, 0
  ds_read_b64_tr_b16 v[66:67], v12 offset:9216
  v_accvgpr_read_b32 v19, a131
  v_mfma_f32_16x16x32_bf16 v[144:147], v[44:47], v[224:227], v[144:147]
  buffer_load_dwordx4 v3, s[32:35], s26 offen offset:0 sc1 lds
  v_accvgpr_read_b32 v20, a160
  v_mfma_f32_16x16x32_bf16 v[160:163], v[48:51], v[224:227], v[160:163]
  ds_read_b64_tr_b16 v[68:69], v13 offset:8192
  v_accvgpr_read_b32 v21, a161
  v_mfma_f32_16x16x32_bf16 v[176:179], v[52:55], v[224:227], v[176:179]
  ds_read_b64_tr_b16 v[70:71], v13 offset:9216
  v_accvgpr_read_b32 v22, a162
  v_mfma_f32_16x16x32_bf16 v[192:195], v[56:59], v[224:227], v[192:195]
  ds_read_b64_tr_b16 v[72:73], v12 offset:8448
  v_accvgpr_read_b32 v23, a163
  v_mfma_f32_16x16x32_bf16 v[208:211], v[60:63], v[224:227], v[208:211]
  ds_read_b64_tr_b16 v[74:75], v12 offset:9472
  v_cvt_pk_bf16_f32 v24, v16, v17
  v_mfma_f32_16x16x32_bf16 v[100:103], v[32:35], v[228:231], v[100:103]
  buffer_load_dwordx4 v4, s[32:35], s26 offen offset:1024 sc1 lds
  v_cvt_pk_bf16_f32 v25, v18, v19
  v_mfma_f32_16x16x32_bf16 v[116:119], v[36:39], v[228:231], v[116:119]
  ds_read_b64_tr_b16 v[76:77], v13 offset:8448
  v_cvt_pk_bf16_f32 v26, v20, v21
  v_mfma_f32_16x16x32_bf16 v[132:135], v[40:43], v[228:231], v[132:135]
  ds_read_b64_tr_b16 v[78:79], v13 offset:9472
  v_cvt_pk_bf16_f32 v27, v22, v23
  v_mfma_f32_16x16x32_bf16 v[148:151], v[44:47], v[228:231], v[148:151]
  ds_read_b128 v[240:243], v14 offset:32768
  buffer_store_dwordx4 v[24:27], v2, s[40:43], s63 offen offset:0 sc1
  v_mfma_f32_16x16x32_bf16 v[164:167], v[48:51], v[228:231], v[164:167]
  ds_read_b128 v[244:247], v14 offset:33792
  v_accvgpr_read_b32 v16, a132
  v_mfma_f32_16x16x32_bf16 v[180:183], v[52:55], v[228:231], v[180:183]
  buffer_load_dwordx4 v5, s[32:35], s26 offen offset:2048 sc1 lds
  v_accvgpr_read_b32 v17, a133
  v_mfma_f32_16x16x32_bf16 v[196:199], v[56:59], v[228:231], v[196:199]
  ds_read_b64_tr_b16 v[80:81], v12 offset:8704
  v_accvgpr_read_b32 v18, a134
  v_mfma_f32_16x16x32_bf16 v[212:215], v[60:63], v[228:231], v[212:215]
  ds_read_b64_tr_b16 v[82:83], v12 offset:9728
  v_accvgpr_read_b32 v19, a135
  v_mfma_f32_16x16x32_bf16 v[104:107], v[32:35], v[232:235], v[104:107]
  ds_read_b64_tr_b16 v[84:85], v13 offset:8704
  v_accvgpr_read_b32 v20, a164
  v_mfma_f32_16x16x32_bf16 v[120:123], v[36:39], v[232:235], v[120:123]
  ds_read_b64_tr_b16 v[86:87], v13 offset:9728
  v_accvgpr_read_b32 v21, a165
  v_mfma_f32_16x16x32_bf16 v[136:139], v[40:43], v[232:235], v[136:139]
  buffer_load_dwordx4 v6, s[32:35], s26 offen offset:3072 sc1 lds
  v_accvgpr_read_b32 v22, a166
  v_mfma_f32_16x16x32_bf16 v[152:155], v[44:47], v[232:235], v[152:155]
  s_add_u32 s26, s26, 1024
  ds_read_b64_tr_b16 v[88:89], v12 offset:8960
  v_accvgpr_read_b32 v23, a167
  v_mfma_f32_16x16x32_bf16 v[168:171], v[48:51], v[232:235], v[168:171]
  ds_read_b64_tr_b16 v[90:91], v12 offset:9984
  v_cvt_pk_bf16_f32 v28, v16, v17
  v_mfma_f32_16x16x32_bf16 v[184:187], v[52:55], v[232:235], v[184:187]
  ds_read_b64_tr_b16 v[92:93], v13 offset:8960
  v_cvt_pk_bf16_f32 v29, v18, v19
  v_mfma_f32_16x16x32_bf16 v[200:203], v[56:59], v[232:235], v[200:203]
  s_add_u32 m0, s24, 114688
  ds_read_b64_tr_b16 v[94:95], v13 offset:9984
  v_cvt_pk_bf16_f32 v30, v20, v21
  v_mfma_f32_16x16x32_bf16 v[216:219], v[60:63], v[232:235], v[216:219]
  buffer_load_dwordx4 v10, s[36:39], s27 offen offset:2048 lds
  v_cvt_pk_bf16_f32 v31, v22, v23
  v_mfma_f32_16x16x32_bf16 v[108:111], v[32:35], v[236:239], v[108:111]
  ds_read_b128 v[248:251], v14 offset:34816
  buffer_store_dwordx4 v[28:31], v2, s[40:43], s63 offen offset:1024 sc1
  v_mfma_f32_16x16x32_bf16 v[124:127], v[36:39], v[236:239], v[124:127]
  ds_read_b128 v[252:255], v14 offset:35840
  v_accvgpr_write_b32 a26, 0
  v_mfma_f32_16x16x32_bf16 v[140:143], v[40:43], v[236:239], v[140:143]
  v_accvgpr_write_b32 a27, 0
  v_accvgpr_write_b32 a56, 0
  v_mfma_f32_16x16x32_bf16 v[156:159], v[44:47], v[236:239], v[156:159]
  v_xor_b32 v14, 0x10000, v14
  v_accvgpr_write_b32 a57, 0
  v_mfma_f32_16x16x32_bf16 v[172:175], v[48:51], v[236:239], v[172:175]
  buffer_load_dwordx4 v11, s[36:39], s27 offen offset:3072 lds
  v_accvgpr_write_b32 a58, 0
  v_mfma_f32_16x16x32_bf16 v[188:191], v[52:55], v[236:239], v[188:191]
  s_add_u32 s27, s27, 524288
  v_accvgpr_write_b32 a59, 0
  v_mfma_f32_16x16x32_bf16 v[204:207], v[56:59], v[236:239], v[204:207]
  v_mfma_f32_16x16x32_bf16 v[220:223], v[60:63], v[236:239], v[220:223]
  s_waitcnt vmcnt(19) lgkmcnt(0)
  v_mfma_f32_16x16x32_bf16 v[96:99], v[64:67], v[240:243], v[96:99]
  s_barrier
  v_accvgpr_read_b32 v16, a136
  v_accvgpr_read_b32 v17, a137
  v_mfma_f32_16x16x32_bf16 v[112:115], v[68:71], v[240:243], v[112:115]
  s_add_u32 s63, s63, s61
  ds_read_b64_tr_b16 v[32:33], v12 offset:32768
  v_accvgpr_read_b32 v18, a138
  v_mfma_f32_16x16x32_bf16 v[128:131], v[72:75], v[240:243], v[128:131]
  s_add_u32 m0, s24, 32768
  ds_read_b64_tr_b16 v[34:35], v12 offset:33792
  v_accvgpr_read_b32 v19, a139
  v_mfma_f32_16x16x32_bf16 v[144:147], v[76:79], v[240:243], v[144:147]
  buffer_load_dwordx4 v3, s[32:35], s26 offen offset:0 sc1 lds
  v_accvgpr_read_b32 v20, a168
  v_mfma_f32_16x16x32_bf16 v[160:163], v[80:83], v[240:243], v[160:163]
  ds_read_b64_tr_b16 v[36:37], v13 offset:32768
  v_accvgpr_read_b32 v21, a169
  v_mfma_f32_16x16x32_bf16 v[176:179], v[84:87], v[240:243], v[176:179]
  ds_read_b64_tr_b16 v[38:39], v13 offset:33792
  v_accvgpr_read_b32 v22, a170
  v_mfma_f32_16x16x32_bf16 v[192:195], v[88:91], v[240:243], v[192:195]
  ds_read_b64_tr_b16 v[40:41], v12 offset:33024
  v_accvgpr_read_b32 v23, a171
  v_mfma_f32_16x16x32_bf16 v[208:211], v[92:95], v[240:243], v[208:211]
  ds_read_b64_tr_b16 v[42:43], v12 offset:34048
  v_cvt_pk_bf16_f32 v24, v16, v17
  v_mfma_f32_16x16x32_bf16 v[100:103], v[64:67], v[244:247], v[100:103]
  buffer_load_dwordx4 v4, s[32:35], s26 offen offset:1024 sc1 lds
  v_cvt_pk_bf16_f32 v25, v18, v19
  v_mfma_f32_16x16x32_bf16 v[116:119], v[68:71], v[244:247], v[116:119]
  ds_read_b64_tr_b16 v[44:45], v13 offset:33024
  v_cvt_pk_bf16_f32 v26, v20, v21
  v_mfma_f32_16x16x32_bf16 v[132:135], v[72:75], v[244:247], v[132:135]
  ds_read_b64_tr_b16 v[46:47], v13 offset:34048
  v_cvt_pk_bf16_f32 v27, v22, v23
  v_mfma_f32_16x16x32_bf16 v[148:151], v[76:79], v[244:247], v[148:151]
  ds_read_b128 v[224:227], v14 offset:0
  buffer_store_dwordx4 v[24:27], v2, s[40:43], s63 offen offset:0 sc1
  v_mfma_f32_16x16x32_bf16 v[164:167], v[80:83], v[244:247], v[164:167]
  ds_read_b128 v[228:231], v14 offset:1024
  v_accvgpr_read_b32 v16, a140
  v_mfma_f32_16x16x32_bf16 v[180:183], v[84:87], v[244:247], v[180:183]
  buffer_load_dwordx4 v5, s[32:35], s26 offen offset:2048 sc1 lds
  v_accvgpr_read_b32 v17, a141
  v_mfma_f32_16x16x32_bf16 v[196:199], v[88:91], v[244:247], v[196:199]
  ds_read_b64_tr_b16 v[48:49], v12 offset:33280
  v_accvgpr_read_b32 v18, a142
  v_mfma_f32_16x16x32_bf16 v[212:215], v[92:95], v[244:247], v[212:215]
  ds_read_b64_tr_b16 v[50:51], v12 offset:34304
  v_accvgpr_read_b32 v19, a143
  v_mfma_f32_16x16x32_bf16 v[104:107], v[64:67], v[248:251], v[104:107]
  ds_read_b64_tr_b16 v[52:53], v13 offset:33280
  v_accvgpr_read_b32 v20, a172
  v_mfma_f32_16x16x32_bf16 v[120:123], v[68:71], v[248:251], v[120:123]
  ds_read_b64_tr_b16 v[54:55], v13 offset:34304
  v_accvgpr_read_b32 v21, a173
  v_mfma_f32_16x16x32_bf16 v[136:139], v[72:75], v[248:251], v[136:139]
  buffer_load_dwordx4 v6, s[32:35], s26 offen offset:3072 sc1 lds
  v_accvgpr_read_b32 v22, a174
  v_mfma_f32_16x16x32_bf16 v[152:155], v[76:79], v[248:251], v[152:155]
  s_add_u32 s26, s26, 1024
  ds_read_b64_tr_b16 v[56:57], v12 offset:33536
  v_accvgpr_read_b32 v23, a175
  v_mfma_f32_16x16x32_bf16 v[168:171], v[80:83], v[248:251], v[168:171]
  ds_read_b64_tr_b16 v[58:59], v12 offset:34560
  v_cvt_pk_bf16_f32 v28, v16, v17
  v_mfma_f32_16x16x32_bf16 v[184:187], v[84:87], v[248:251], v[184:187]
  ds_read_b64_tr_b16 v[60:61], v13 offset:33536
  v_cvt_pk_bf16_f32 v29, v18, v19
  v_mfma_f32_16x16x32_bf16 v[200:203], v[88:91], v[248:251], v[200:203]
  s_add_u32 m0, s24, 16384
  ds_read_b64_tr_b16 v[62:63], v13 offset:34560
  v_cvt_pk_bf16_f32 v30, v20, v21
  v_mfma_f32_16x16x32_bf16 v[216:219], v[92:95], v[248:251], v[216:219]
  buffer_load_dwordx4 v8, s[36:39], s27 offen offset:0 lds
  v_cvt_pk_bf16_f32 v31, v22, v23
  v_mfma_f32_16x16x32_bf16 v[108:111], v[64:67], v[252:255], v[108:111]
  ds_read_b128 v[232:235], v14 offset:2048
  buffer_store_dwordx4 v[28:31], v2, s[40:43], s63 offen offset:1024 sc1
  v_mfma_f32_16x16x32_bf16 v[124:127], v[68:71], v[252:255], v[124:127]
  ds_read_b128 v[236:239], v14 offset:3072
  v_accvgpr_write_b32 a28, 0
  v_mfma_f32_16x16x32_bf16 v[140:143], v[72:75], v[252:255], v[140:143]
  v_accvgpr_write_b32 a29, 0
  v_accvgpr_write_b32 a30, 0
  v_mfma_f32_16x16x32_bf16 v[156:159], v[76:79], v[252:255], v[156:159]
  v_accvgpr_write_b32 a31, 0
  v_accvgpr_write_b32 a60, 0
  v_mfma_f32_16x16x32_bf16 v[172:175], v[80:83], v[252:255], v[172:175]
  buffer_load_dwordx4 v9, s[36:39], s27 offen offset:1024 lds
  v_accvgpr_write_b32 a61, 0
  v_mfma_f32_16x16x32_bf16 v[188:191], v[84:87], v[252:255], v[188:191]
  v_accvgpr_write_b32 a62, 0
  v_mfma_f32_16x16x32_bf16 v[204:207], v[88:91], v[252:255], v[204:207]
  v_mfma_f32_16x16x32_bf16 v[220:223], v[92:95], v[252:255], v[220:223]
  s_waitcnt vmcnt(19) lgkmcnt(0)
  v_mfma_f32_16x16x32_bf16 v[96:99], v[32:35], v[224:227], v[96:99]
  s_add_u32 s63, s63, s61
  v_accvgpr_read_b32 v16, a144
  v_accvgpr_read_b32 v17, a145
  v_mfma_f32_16x16x32_bf16 v[112:115], v[36:39], v[224:227], v[112:115]
  ds_read_b64_tr_b16 v[64:65], v12 offset:40960
  v_accvgpr_read_b32 v18, a146
  v_mfma_f32_16x16x32_bf16 v[128:131], v[40:43], v[224:227], v[128:131]
  s_add_u32 m0, s24, 65536
  ds_read_b64_tr_b16 v[66:67], v12 offset:41984
  v_accvgpr_read_b32 v19, a147
  v_mfma_f32_16x16x32_bf16 v[144:147], v[44:47], v[224:227], v[144:147]
  buffer_load_dwordx4 v3, s[32:35], s26 offen offset:0 sc1 lds
  v_accvgpr_read_b32 v20, a176
  v_mfma_f32_16x16x32_bf16 v[160:163], v[48:51], v[224:227], v[160:163]
  ds_read_b64_tr_b16 v[68:69], v13 offset:40960
  v_accvgpr_read_b32 v21, a177
  v_mfma_f32_16x16x32_bf16 v[176:179], v[52:55], v[224:227], v[176:179]
  ds_read_b64_tr_b16 v[70:71], v13 offset:41984
  v_accvgpr_read_b32 v22, a178
  v_mfma_f32_16x16x32_bf16 v[192:195], v[56:59], v[224:227], v[192:195]
  ds_read_b64_tr_b16 v[72:73], v12 offset:41216
  v_accvgpr_read_b32 v23, a179
  v_mfma_f32_16x16x32_bf16 v[208:211], v[60:63], v[224:227], v[208:211]
  ds_read_b64_tr_b16 v[74:75], v12 offset:42240
  v_cvt_pk_bf16_f32 v24, v16, v17
  v_mfma_f32_16x16x32_bf16 v[100:103], v[32:35], v[228:231], v[100:103]
  buffer_load_dwordx4 v4, s[32:35], s26 offen offset:1024 sc1 lds
  v_cvt_pk_bf16_f32 v25, v18, v19
  v_mfma_f32_16x16x32_bf16 v[116:119], v[36:39], v[228:231], v[116:119]
  ds_read_b64_tr_b16 v[76:77], v13 offset:41216
  v_cvt_pk_bf16_f32 v26, v20, v21
  v_mfma_f32_16x16x32_bf16 v[132:135], v[40:43], v[228:231], v[132:135]
  ds_read_b64_tr_b16 v[78:79], v13 offset:42240
  v_cvt_pk_bf16_f32 v27, v22, v23
  v_mfma_f32_16x16x32_bf16 v[148:151], v[44:47], v[228:231], v[148:151]
  ds_read_b128 v[240:243], v14 offset:32768
  buffer_store_dwordx4 v[24:27], v2, s[40:43], s63 offen offset:0 sc1
  v_mfma_f32_16x16x32_bf16 v[164:167], v[48:51], v[228:231], v[164:167]
  ds_read_b128 v[244:247], v14 offset:33792
  v_accvgpr_read_b32 v16, a148
  v_mfma_f32_16x16x32_bf16 v[180:183], v[52:55], v[228:231], v[180:183]
  buffer_load_dwordx4 v5, s[32:35], s26 offen offset:2048 sc1 lds
  v_accvgpr_read_b32 v17, a149
  v_mfma_f32_16x16x32_bf16 v[196:199], v[56:59], v[228:231], v[196:199]
  ds_read_b64_tr_b16 v[80:81], v12 offset:41472
  v_accvgpr_read_b32 v18, a150
  v_mfma_f32_16x16x32_bf16 v[212:215], v[60:63], v[228:231], v[212:215]
  ds_read_b64_tr_b16 v[82:83], v12 offset:42496
  v_accvgpr_read_b32 v19, a151
  v_mfma_f32_16x16x32_bf16 v[104:107], v[32:35], v[232:235], v[104:107]
  ds_read_b64_tr_b16 v[84:85], v13 offset:41472
  v_accvgpr_read_b32 v20, a180
  v_mfma_f32_16x16x32_bf16 v[120:123], v[36:39], v[232:235], v[120:123]
  ds_read_b64_tr_b16 v[86:87], v13 offset:42496
  v_accvgpr_read_b32 v21, a181
  v_mfma_f32_16x16x32_bf16 v[136:139], v[40:43], v[232:235], v[136:139]
  buffer_load_dwordx4 v6, s[32:35], s26 offen offset:3072 sc1 lds
  v_accvgpr_read_b32 v22, a182
  v_mfma_f32_16x16x32_bf16 v[152:155], v[44:47], v[232:235], v[152:155]
  s_add_u32 s26, s26, 1024
  ds_read_b64_tr_b16 v[88:89], v12 offset:41728
  v_accvgpr_read_b32 v23, a183
  v_mfma_f32_16x16x32_bf16 v[168:171], v[48:51], v[232:235], v[168:171]
  ds_read_b64_tr_b16 v[90:91], v12 offset:42752
  v_cvt_pk_bf16_f32 v28, v16, v17
  v_mfma_f32_16x16x32_bf16 v[184:187], v[52:55], v[232:235], v[184:187]
  ds_read_b64_tr_b16 v[92:93], v13 offset:41728
  v_cvt_pk_bf16_f32 v29, v18, v19
  v_mfma_f32_16x16x32_bf16 v[200:203], v[56:59], v[232:235], v[200:203]
  s_add_u32 m0, s24, 16384
  ds_read_b64_tr_b16 v[94:95], v13 offset:42752
  v_cvt_pk_bf16_f32 v30, v20, v21
  v_mfma_f32_16x16x32_bf16 v[216:219], v[60:63], v[232:235], v[216:219]
  buffer_load_dwordx4 v10, s[36:39], s27 offen offset:2048 lds
  v_cvt_pk_bf16_f32 v31, v22, v23
  v_mfma_f32_16x16x32_bf16 v[108:111], v[32:35], v[236:239], v[108:111]
  ds_read_b128 v[248:251], v14 offset:34816
  buffer_store_dwordx4 v[28:31], v2, s[40:43], s63 offen offset:1024 sc1
  v_mfma_f32_16x16x32_bf16 v[124:127], v[36:39], v[236:239], v[124:127]
  ds_read_b128 v[252:255], v14 offset:35840
  v_accvgpr_write_b32 a63, 0
  v_mfma_f32_16x16x32_bf16 v[140:143], v[40:43], v[236:239], v[140:143]
  v_accvgpr_write_b32 a64, 0
  v_accvgpr_write_b32 a65, 0
  v_mfma_f32_16x16x32_bf16 v[156:159], v[44:47], v[236:239], v[156:159]
  v_xor_b32 v14, 0x10000, v14
  v_accvgpr_write_b32 a66, 0
  v_mfma_f32_16x16x32_bf16 v[172:175], v[48:51], v[236:239], v[172:175]
  buffer_load_dwordx4 v11, s[36:39], s27 offen offset:3072 lds
  v_mfma_f32_16x16x32_bf16 v[188:191], v[52:55], v[236:239], v[188:191]
  s_add_u32 s27, s27, 524288
  v_xor_b32 v12, 0x10000, v12
  v_mfma_f32_16x16x32_bf16 v[204:207], v[56:59], v[236:239], v[204:207]
  v_xor_b32 v13, 0x10000, v13
  v_mfma_f32_16x16x32_bf16 v[220:223], v[60:63], v[236:239], v[220:223]
  s_waitcnt vmcnt(19) lgkmcnt(0)
  v_mfma_f32_16x16x32_bf16 v[96:99], v[64:67], v[240:243], v[96:99]
  s_barrier
  v_accvgpr_read_b32 v16, a152
  v_accvgpr_read_b32 v17, a153
  v_mfma_f32_16x16x32_bf16 v[112:115], v[68:71], v[240:243], v[112:115]
  s_add_u32 s63, s63, s61
  ds_read_b64_tr_b16 v[32:33], v12 offset:0
  v_accvgpr_read_b32 v18, a154
  v_mfma_f32_16x16x32_bf16 v[128:131], v[72:75], v[240:243], v[128:131]
  s_add_u32 m0, s24, 98304
  ds_read_b64_tr_b16 v[34:35], v12 offset:1024
  v_accvgpr_read_b32 v19, a155
  v_mfma_f32_16x16x32_bf16 v[144:147], v[76:79], v[240:243], v[144:147]
  buffer_load_dwordx4 v3, s[32:35], s26 offen offset:0 sc1 lds
  v_accvgpr_read_b32 v20, a184
  v_mfma_f32_16x16x32_bf16 v[160:163], v[80:83], v[240:243], v[160:163]
  ds_read_b64_tr_b16 v[36:37], v13 offset:0
  v_accvgpr_read_b32 v21, a185
  v_mfma_f32_16x16x32_bf16 v[176:179], v[84:87], v[240:243], v[176:179]
  ds_read_b64_tr_b16 v[38:39], v13 offset:1024
  v_accvgpr_read_b32 v22, a186
  v_mfma_f32_16x16x32_bf16 v[192:195], v[88:91], v[240:243], v[192:195]
  ds_read_b64_tr_b16 v[40:41], v12 offset:256
  v_accvgpr_read_b32 v23, a187
  v_mfma_f32_16x16x32_bf16 v[208:211], v[92:95], v[240:243], v[208:211]
  ds_read_b64_tr_b16 v[42:43], v12 offset:1280
  v_cvt_pk_bf16_f32 v24, v16, v17
  v_mfma_f32_16x16x32_bf16 v[100:103], v[64:67], v[244:247], v[100:103]
  buffer_load_dwordx4 v4, s[32:35], s26 offen offset:1024 sc1 lds
  v_cvt_pk_bf16_f32 v25, v18, v19
  v_mfma_f32_16x16x32_bf16 v[116:119], v[68:71], v[244:247], v[116:119]
  ds_read_b64_tr_b16 v[44:45], v13 offset:256
  v_cvt_pk_bf16_f32 v26, v20, v21
  v_mfma_f32_16x16x32_bf16 v[132:135], v[72:75], v[244:247], v[132:135]
  ds_read_b64_tr_b16 v[46:47], v13 offset:1280
  v_cvt_pk_bf16_f32 v27, v22, v23
  v_mfma_f32_16x16x32_bf16 v[148:151], v[76:79], v[244:247], v[148:151]
  ds_read_b128 v[224:227], v14 offset:0
  buffer_store_dwordx4 v[24:27], v2, s[40:43], s63 offen offset:0 sc1
  v_mfma_f32_16x16x32_bf16 v[164:167], v[80:83], v[244:247], v[164:167]
  ds_read_b128 v[228:231], v14 offset:1024
  v_accvgpr_read_b32 v16, a156
  v_mfma_f32_16x16x32_bf16 v[180:183], v[84:87], v[244:247], v[180:183]
  buffer_load_dwordx4 v5, s[32:35], s26 offen offset:2048 sc1 lds
  v_accvgpr_read_b32 v17, a157
  v_mfma_f32_16x16x32_bf16 v[196:199], v[88:91], v[244:247], v[196:199]
  ds_read_b64_tr_b16 v[48:49], v12 offset:512
  v_accvgpr_read_b32 v18, a158
  v_mfma_f32_16x16x32_bf16 v[212:215], v[92:95], v[244:247], v[212:215]
  ds_read_b64_tr_b16 v[50:51], v12 offset:1536
  v_accvgpr_read_b32 v19, a159
  v_mfma_f32_16x16x32_bf16 v[104:107], v[64:67], v[248:251], v[104:107]
  ds_read_b64_tr_b16 v[52:53], v13 offset:512
  v_accvgpr_read_b32 v20, a188
  v_mfma_f32_16x16x32_bf16 v[120:123], v[68:71], v[248:251], v[120:123]
  ds_read_b64_tr_b16 v[54:55], v13 offset:1536
  v_accvgpr_read_b32 v21, a189
  v_mfma_f32_16x16x32_bf16 v[136:139], v[72:75], v[248:251], v[136:139]
  buffer_load_dwordx4 v6, s[32:35], s26 offen offset:3072 sc1 lds
  v_accvgpr_read_b32 v22, a190
  v_mfma_f32_16x16x32_bf16 v[152:155], v[76:79], v[248:251], v[152:155]
  s_add_u32 s26, s26, 1024
  ds_read_b64_tr_b16 v[56:57], v12 offset:768
  v_accvgpr_read_b32 v23, a191
  v_mfma_f32_16x16x32_bf16 v[168:171], v[80:83], v[248:251], v[168:171]
  ds_read_b64_tr_b16 v[58:59], v12 offset:1792
  v_cvt_pk_bf16_f32 v28, v16, v17
  v_mfma_f32_16x16x32_bf16 v[184:187], v[84:87], v[248:251], v[184:187]
  ds_read_b64_tr_b16 v[60:61], v13 offset:768
  v_cvt_pk_bf16_f32 v29, v18, v19
  v_mfma_f32_16x16x32_bf16 v[200:203], v[88:91], v[248:251], v[200:203]
  s_add_u32 m0, s24, 49152
  ds_read_b64_tr_b16 v[62:63], v13 offset:1792
  v_cvt_pk_bf16_f32 v30, v20, v21
  v_mfma_f32_16x16x32_bf16 v[216:219], v[92:95], v[248:251], v[216:219]
  buffer_load_dwordx4 v8, s[36:39], s27 offen offset:0 lds
  v_cvt_pk_bf16_f32 v31, v22, v23
  v_mfma_f32_16x16x32_bf16 v[108:111], v[64:67], v[252:255], v[108:111]
  ds_read_b128 v[232:235], v14 offset:2048
  buffer_store_dwordx4 v[28:31], v2, s[40:43], s63 offen offset:1024 sc1
  v_mfma_f32_16x16x32_bf16 v[124:127], v[68:71], v[252:255], v[124:127]
  ds_read_b128 v[236:239], v14 offset:3072
  v_accvgpr_write_b32 a67, 0
  v_mfma_f32_16x16x32_bf16 v[140:143], v[72:75], v[252:255], v[140:143]
  v_accvgpr_write_b32 a96, 0
  v_accvgpr_write_b32 a97, 0
  v_mfma_f32_16x16x32_bf16 v[156:159], v[76:79], v[252:255], v[156:159]
  v_accvgpr_write_b32 a98, 0
  v_accvgpr_write_b32 a99, 0
  v_mfma_f32_16x16x32_bf16 v[172:175], v[80:83], v[252:255], v[172:175]
  buffer_load_dwordx4 v9, s[36:39], s27 offen offset:1024 lds
  v_accvgpr_write_b32 a68, 0
  v_mfma_f32_16x16x32_bf16 v[188:191], v[84:87], v[252:255], v[188:191]
  v_accvgpr_write_b32 a69, 0
  v_mfma_f32_16x16x32_bf16 v[204:207], v[88:91], v[252:255], v[204:207]
  v_mfma_f32_16x16x32_bf16 v[220:223], v[92:95], v[252:255], v[220:223]
  s_waitcnt vmcnt(19) lgkmcnt(0)
  v_mfma_f32_16x16x32_bf16 v[96:99], v[32:35], v[224:227], v[96:99]
  s_mul_i32 s63, s60, 3
  v_accvgpr_read_b32 v16, a192
  v_accvgpr_read_b32 v17, a193
  v_accvgpr_read_b32 v18, a194
  v_mfma_f32_16x16x32_bf16 v[112:115], v[36:39], v[224:227], v[112:115]
  s_add_u32 s63, s63, s62
  ds_read_b64_tr_b16 v[64:65], v12 offset:8192
  v_accvgpr_read_b32 v19, a195
  v_mfma_f32_16x16x32_bf16 v[128:131], v[40:43], v[224:227], v[128:131]
  s_add_u32 m0, s24, 0
  ds_read_b64_tr_b16 v[66:67], v12 offset:9216
  v_accvgpr_read_b32 v20, a224
  v_mfma_f32_16x16x32_bf16 v[144:147], v[44:47], v[224:227], v[144:147]
  buffer_load_dwordx4 v3, s[32:35], s26 offen offset:0 sc1 lds
  v_accvgpr_read_b32 v21, a225
  v_accvgpr_read_b32 v22, a226
  v_mfma_f32_16x16x32_bf16 v[160:163], v[48:51], v[224:227], v[160:163]
  ds_read_b64_tr_b16 v[68:69], v13 offset:8192
  v_accvgpr_read_b32 v23, a227
  v_mfma_f32_16x16x32_bf16 v[176:179], v[52:55], v[224:227], v[176:179]
  ds_read_b64_tr_b16 v[70:71], v13 offset:9216
  v_cvt_pk_bf16_f32 v24, v16, v17
  v_mfma_f32_16x16x32_bf16 v[192:195], v[56:59], v[224:227], v[192:195]
  ds_read_b64_tr_b16 v[72:73], v12 offset:8448
  v_cvt_pk_bf16_f32 v25, v18, v19
  v_mfma_f32_16x16x32_bf16 v[208:211], v[60:63], v[224:227], v[208:211]
  ds_read_b64_tr_b16 v[74:75], v12 offset:9472
  v_cvt_pk_bf16_f32 v26, v20, v21
  v_cvt_pk_bf16_f32 v27, v22, v23
  v_mfma_f32_16x16x32_bf16 v[100:103], v[32:35], v[228:231], v[100:103]
  buffer_load_dwordx4 v4, s[32:35], s26 offen offset:1024 sc1 lds
  buffer_store_dwordx4 v[24:27], v2, s[40:43], s63 offen offset:0 sc1
  v_mfma_f32_16x16x32_bf16 v[116:119], v[36:39], v[228:231], v[116:119]
  ds_read_b64_tr_b16 v[76:77], v13 offset:8448
  v_accvgpr_read_b32 v16, a196
  v_mfma_f32_16x16x32_bf16 v[132:135], v[40:43], v[228:231], v[132:135]
  ds_read_b64_tr_b16 v[78:79], v13 offset:9472
  v_accvgpr_read_b32 v17, a197
  v_mfma_f32_16x16x32_bf16 v[148:151], v[44:47], v[228:231], v[148:151]
  ds_read_b128 v[240:243], v14 offset:32768
  v_accvgpr_read_b32 v18, a198
  v_accvgpr_read_b32 v19, a199
  v_mfma_f32_16x16x32_bf16 v[164:167], v[48:51], v[228:231], v[164:167]
  ds_read_b128 v[244:247], v14 offset:33792
  v_accvgpr_read_b32 v20, a228
  v_mfma_f32_16x16x32_bf16 v[180:183], v[52:55], v[228:231], v[180:183]
  buffer_load_dwordx4 v5, s[32:35], s26 offen offset:2048 sc1 lds
  v_accvgpr_read_b32 v21, a229
  v_mfma_f32_16x16x32_bf16 v[196:199], v[56:59], v[228:231], v[196:199]
  ds_read_b64_tr_b16 v[80:81], v12 offset:8704
  v_accvgpr_read_b32 v22, a230
  v_mfma_f32_16x16x32_bf16 v[212:215], v[60:63], v[228:231], v[212:215]
  ds_read_b64_tr_b16 v[82:83], v12 offset:9728
  v_accvgpr_read_b32 v23, a231
  v_cvt_pk_bf16_f32 v28, v16, v17
  v_mfma_f32_16x16x32_bf16 v[104:107], v[32:35], v[232:235], v[104:107]
  ds_read_b64_tr_b16 v[84:85], v13 offset:8704
  v_cvt_pk_bf16_f32 v29, v18, v19
  v_mfma_f32_16x16x32_bf16 v[120:123], v[36:39], v[232:235], v[120:123]
  ds_read_b64_tr_b16 v[86:87], v13 offset:9728
  v_cvt_pk_bf16_f32 v30, v20, v21
  v_mfma_f32_16x16x32_bf16 v[136:139], v[40:43], v[232:235], v[136:139]
  buffer_load_dwordx4 v6, s[32:35], s26 offen offset:3072 sc1 lds
  v_cvt_pk_bf16_f32 v31, v22, v23
  v_mfma_f32_16x16x32_bf16 v[152:155], v[44:47], v[232:235], v[152:155]
  s_add_u32 s26, s26, 1024
  ds_read_b64_tr_b16 v[88:89], v12 offset:8960
  buffer_store_dwordx4 v[28:31], v2, s[40:43], s63 offen offset:1024 sc1
  v_mfma_f32_16x16x32_bf16 v[168:171], v[48:51], v[232:235], v[168:171]
  s_add_u32 s63, s63, s61
  ds_read_b64_tr_b16 v[90:91], v12 offset:9984
  v_accvgpr_read_b32 v16, a200
  v_mfma_f32_16x16x32_bf16 v[184:187], v[52:55], v[232:235], v[184:187]
  ds_read_b64_tr_b16 v[92:93], v13 offset:8960
  v_accvgpr_read_b32 v17, a201
  v_mfma_f32_16x16x32_bf16 v[200:203], v[56:59], v[232:235], v[200:203]
  s_add_u32 m0, s24, 49152
  ds_read_b64_tr_b16 v[94:95], v13 offset:9984
  v_accvgpr_read_b32 v18, a202
  v_accvgpr_read_b32 v19, a203
  v_mfma_f32_16x16x32_bf16 v[216:219], v[60:63], v[232:235], v[216:219]
  buffer_load_dwordx4 v10, s[36:39], s27 offen offset:2048 lds
  v_accvgpr_read_b32 v20, a232
  v_mfma_f32_16x16x32_bf16 v[108:111], v[32:35], v[236:239], v[108:111]
  ds_read_b128 v[248:251], v14 offset:34816
  v_accvgpr_read_b32 v21, a233
  v_mfma_f32_16x16x32_bf16 v[124:127], v[36:39], v[236:239], v[124:127]
  ds_read_b128 v[252:255], v14 offset:35840
  v_accvgpr_read_b32 v22, a234
  v_mfma_f32_16x16x32_bf16 v[140:143], v[40:43], v[236:239], v[140:143]
  v_accvgpr_read_b32 v23, a235
  v_cvt_pk_bf16_f32 v24, v16, v17
  v_cvt_pk_bf16_f32 v25, v18, v19
  v_mfma_f32_16x16x32_bf16 v[156:159], v[44:47], v[236:239], v[156:159]
  v_xor_b32 v14, 0x10000, v14
  v_cvt_pk_bf16_f32 v26, v20, v21
  v_mfma_f32_16x16x32_bf16 v[172:175], v[48:51], v[236:239], v[172:175]
  buffer_load_dwordx4 v11, s[36:39], s27 offen offset:3072 lds
  v_cvt_pk_bf16_f32 v27, v22, v23
  v_mfma_f32_16x16x32_bf16 v[188:191], v[52:55], v[236:239], v[188:191]
  s_add_u32 s27, s27, 524288
  buffer_store_dwordx4 v[24:27], v2, s[40:43], s63 offen offset:0 sc1
  v_mfma_f32_16x16x32_bf16 v[204:207], v[56:59], v[236:239], v[204:207]
  v_mfma_f32_16x16x32_bf16 v[220:223], v[60:63], v[236:239], v[220:223]
  s_waitcnt vmcnt(20) lgkmcnt(0)
  v_mfma_f32_16x16x32_bf16 v[96:99], v[64:67], v[240:243], v[96:99]
  s_barrier
  v_accvgpr_read_b32 v16, a204
  v_accvgpr_read_b32 v17, a205
  v_accvgpr_read_b32 v18, a206
  v_mfma_f32_16x16x32_bf16 v[112:115], v[68:71], v[240:243], v[112:115]
  ds_read_b64_tr_b16 v[32:33], v12 offset:32768
  v_accvgpr_read_b32 v19, a207
  v_accvgpr_read_b32 v20, a236
  v_mfma_f32_16x16x32_bf16 v[128:131], v[72:75], v[240:243], v[128:131]
  s_add_u32 m0, s24, 32768
  ds_read_b64_tr_b16 v[34:35], v12 offset:33792
  v_accvgpr_read_b32 v21, a237
  v_mfma_f32_16x16x32_bf16 v[144:147], v[76:79], v[240:243], v[144:147]
  buffer_load_dwordx4 v3, s[32:35], s26 offen offset:0 sc1 lds
  v_accvgpr_read_b32 v22, a238
  v_accvgpr_read_b32 v23, a239
  v_mfma_f32_16x16x32_bf16 v[160:163], v[80:83], v[240:243], v[160:163]
  ds_read_b64_tr_b16 v[36:37], v13 offset:32768
  v_cvt_pk_bf16_f32 v28, v16, v17
  v_cvt_pk_bf16_f32 v29, v18, v19
  v_mfma_f32_16x16x32_bf16 v[176:179], v[84:87], v[240:243], v[176:179]
  ds_read_b64_tr_b16 v[38:39], v13 offset:33792
  v_cvt_pk_bf16_f32 v30, v20, v21
  v_mfma_f32_16x16x32_bf16 v[192:195], v[88:91], v[240:243], v[192:195]
  ds_read_b64_tr_b16 v[40:41], v12 offset:33024
  v_cvt_pk_bf16_f32 v31, v22, v23
  v_mfma_f32_16x16x32_bf16 v[208:211], v[92:95], v[240:243], v[208:211]
  ds_read_b64_tr_b16 v[42:43], v12 offset:34048
  buffer_store_dwordx4 v[28:31], v2, s[40:43], s63 offen offset:1024 sc1
  v_accvgpr_read_b32 v16, a208
  v_mfma_f32_16x16x32_bf16 v[100:103], v[64:67], v[244:247], v[100:103]
  s_add_u32 s63, s63, s61
  buffer_load_dwordx4 v4, s[32:35], s26 offen offset:1024 sc1 lds
  v_accvgpr_read_b32 v17, a209
  v_mfma_f32_16x16x32_bf16 v[116:119], v[68:71], v[244:247], v[116:119]
  ds_read_b64_tr_b16 v[44:45], v13 offset:33024
  v_accvgpr_read_b32 v18, a210
  v_accvgpr_read_b32 v19, a211
  v_mfma_f32_16x16x32_bf16 v[132:135], v[72:75], v[244:247], v[132:135]
  ds_read_b64_tr_b16 v[46:47], v13 offset:34048
  v_accvgpr_read_b32 v20, a240
  v_mfma_f32_16x16x32_bf16 v[148:151], v[76:79], v[244:247], v[148:151]
  ds_read_b128 v[224:227], v14 offset:0
  v_accvgpr_read_b32 v21, a241
  v_accvgpr_read_b32 v22, a242
  v_mfma_f32_16x16x32_bf16 v[164:167], v[80:83], v[244:247], v[164:167]
  ds_read_b128 v[228:231], v14 offset:1024
  v_accvgpr_read_b32 v23, a243
  v_cvt_pk_bf16_f32 v24, v16, v17
  v_mfma_f32_16x16x32_bf16 v[180:183], v[84:87], v[244:247], v[180:183]
  buffer_load_dwordx4 v5, s[32:35], s26 offen offset:2048 sc1 lds
  v_cvt_pk_bf16_f32 v25, v18, v19
  v_mfma_f32_16x16x32_bf16 v[196:199], v[88:91], v[244:247], v[196:199]
  ds_read_b64_tr_b16 v[48:49], v12 offset:33280
  v_cvt_pk_bf16_f32 v26, v20, v21
  v_cvt_pk_bf16_f32 v27, v22, v23
  v_mfma_f32_16x16x32_bf16 v[212:215], v[92:95], v[244:247], v[212:215]
  ds_read_b64_tr_b16 v[50:51], v12 offset:34304
  buffer_store_dwordx4 v[24:27], v2, s[40:43], s63 offen offset:0 sc1
  v_accvgpr_read_b32 v16, a212
  v_mfma_f32_16x16x32_bf16 v[104:107], v[64:67], v[248:251], v[104:107]
  ds_read_b64_tr_b16 v[52:53], v13 offset:33280
  v_accvgpr_read_b32 v17, a213
  v_mfma_f32_16x16x32_bf16 v[120:123], v[68:71], v[248:251], v[120:123]
  ds_read_b64_tr_b16 v[54:55], v13 offset:34304
  v_accvgpr_read_b32 v18, a214
  v_accvgpr_read_b32 v19, a215
  v_mfma_f32_16x16x32_bf16 v[136:139], v[72:75], v[248:251], v[136:139]
  buffer_load_dwordx4 v6, s[32:35], s26 offen offset:3072 sc1 lds
  v_accvgpr_read_b32 v20, a244
  v_accvgpr_read_b32 v21, a245
  v_mfma_f32_16x16x32_bf16 v[152:155], v[76:79], v[248:251], v[152:155]
  s_add_u32 s26, s26, 1024
  ds_read_b64_tr_b16 v[56:57], v12 offset:33536
  v_accvgpr_read_b32 v22, a246
  v_mfma_f32_16x16x32_bf16 v[168:171], v[80:83], v[248:251], v[168:171]
  ds_read_b64_tr_b16 v[58:59], v12 offset:34560
  v_accvgpr_read_b32 v23, a247
  v_cvt_pk_bf16_f32 v28, v16, v17
  v_mfma_f32_16x16x32_bf16 v[184:187], v[84:87], v[248:251], v[184:187]
  ds_read_b64_tr_b16 v[60:61], v13 offset:33536
  v_cvt_pk_bf16_f32 v29, v18, v19
  v_mfma_f32_16x16x32_bf16 v[200:203], v[88:91], v[248:251], v[200:203]
  ds_read_b64_tr_b16 v[62:63], v13 offset:34560
  v_cvt_pk_bf16_f32 v30, v20, v21
  v_cvt_pk_bf16_f32 v31, v22, v23
  v_mfma_f32_16x16x32_bf16 v[216:219], v[92:95], v[248:251], v[216:219]
  buffer_store_dwordx4 v[28:31], v2, s[40:43], s63 offen offset:1024 sc1
  v_and_b32 v11, 15, v1
  v_lshrrev_b32 v10, 4, v1
  v_mfma_f32_16x16x32_bf16 v[108:111], v[64:67], v[252:255], v[108:111]
  ds_read_b128 v[232:235], v14 offset:2048
  v_lshlrev_b32 v10, 2, v10
  v_mfma_f32_16x16x32_bf16 v[124:127], v[68:71], v[252:255], v[124:127]
  ds_read_b128 v[236:239], v14 offset:3072
  v_sub_u32 v11, v11, v10
  v_cmp_le_i32 s[68:69], 0, v11
  v_mfma_f32_16x16x32_bf16 v[140:143], v[72:75], v[252:255], v[140:143]
  v_cmp_le_i32 s[70:71], 1, v11
  v_cmp_le_i32 s[72:73], 2, v11
  v_cmp_le_i32 s[74:75], 3, v11
  v_mfma_f32_16x16x32_bf16 v[156:159], v[76:79], v[252:255], v[156:159]
  v_and_b32 v8, 7, v1
  v_lshlrev_b32 v8, 2, v8
  v_mfma_f32_16x16x32_bf16 v[172:175], v[80:83], v[252:255], v[172:175]
  v_add_u32 v8, s30, v8
  v_mov_b32 v9, 1073741824
  v_mov_b32 v10, 1
  v_mfma_f32_16x16x32_bf16 v[188:191], v[84:87], v[252:255], v[188:191]
  v_writelane_b32 v9, s29, 0
  v_mfma_f32_16x16x32_bf16 v[204:207], v[88:91], v[252:255], v[204:207]
  v_mfma_f32_16x16x32_bf16 v[220:223], v[92:95], v[252:255], v[220:223]
  s_waitcnt vmcnt(19) lgkmcnt(0)
  v_mfma_f32_16x16x32_bf16 v[96:99], v[32:35], v[224:227], v[96:99]
  s_add_u32 s63, s63, s61
  v_accvgpr_read_b32 v16, a216
  v_accvgpr_read_b32 v17, a217
  v_mfma_f32_16x16x32_bf16 v[112:115], v[36:39], v[224:227], v[112:115]
  ds_read_b64_tr_b16 v[64:65], v12 offset:40960
  v_accvgpr_read_b32 v18, a218
  v_mfma_f32_16x16x32_bf16 v[128:131], v[40:43], v[224:227], v[128:131]
  s_add_u32 m0, s24, 65536
  ds_read_b64_tr_b16 v[66:67], v12 offset:41984
  v_accvgpr_read_b32 v19, a219
  v_mfma_f32_16x16x32_bf16 v[144:147], v[44:47], v[224:227], v[144:147]
  buffer_load_dwordx4 v3, s[32:35], s26 offen offset:0 sc1 lds
  v_accvgpr_read_b32 v20, a248
  v_mfma_f32_16x16x32_bf16 v[160:163], v[48:51], v[224:227], v[160:163]
  ds_read_b64_tr_b16 v[68:69], v13 offset:40960
  v_accvgpr_read_b32 v21, a249
  v_mfma_f32_16x16x32_bf16 v[176:179], v[52:55], v[224:227], v[176:179]
  ds_read_b64_tr_b16 v[70:71], v13 offset:41984
  v_accvgpr_read_b32 v22, a250
  v_mfma_f32_16x16x32_bf16 v[192:195], v[56:59], v[224:227], v[192:195]
  ds_read_b64_tr_b16 v[72:73], v12 offset:41216
  v_accvgpr_read_b32 v23, a251
  v_mfma_f32_16x16x32_bf16 v[208:211], v[60:63], v[224:227], v[208:211]
  ds_read_b64_tr_b16 v[74:75], v12 offset:42240
  v_cvt_pk_bf16_f32 v24, v16, v17
  v_mfma_f32_16x16x32_bf16 v[100:103], v[32:35], v[228:231], v[100:103]
  buffer_load_dwordx4 v4, s[32:35], s26 offen offset:1024 sc1 lds
  v_cvt_pk_bf16_f32 v25, v18, v19
  v_mfma_f32_16x16x32_bf16 v[116:119], v[36:39], v[228:231], v[116:119]
  ds_read_b64_tr_b16 v[76:77], v13 offset:41216
  v_cvt_pk_bf16_f32 v26, v20, v21
  v_mfma_f32_16x16x32_bf16 v[132:135], v[40:43], v[228:231], v[132:135]
  ds_read_b64_tr_b16 v[78:79], v13 offset:42240
  v_cvt_pk_bf16_f32 v27, v22, v23
  v_mfma_f32_16x16x32_bf16 v[148:151], v[44:47], v[228:231], v[148:151]
  ds_read_b128 v[240:243], v14 offset:32768
  buffer_store_dwordx4 v[24:27], v2, s[40:43], s63 offen offset:0 sc1
  v_mfma_f32_16x16x32_bf16 v[164:167], v[48:51], v[228:231], v[164:167]
  ds_read_b128 v[244:247], v14 offset:33792
  v_accvgpr_read_b32 v16, a220
  v_mfma_f32_16x16x32_bf16 v[180:183], v[52:55], v[228:231], v[180:183]
  buffer_load_dwordx4 v5, s[32:35], s26 offen offset:2048 sc1 lds
  v_accvgpr_read_b32 v17, a221
  v_mfma_f32_16x16x32_bf16 v[196:199], v[56:59], v[228:231], v[196:199]
  ds_read_b64_tr_b16 v[80:81], v12 offset:41472
  v_accvgpr_read_b32 v18, a222
  v_mfma_f32_16x16x32_bf16 v[212:215], v[60:63], v[228:231], v[212:215]
  ds_read_b64_tr_b16 v[82:83], v12 offset:42496
  v_accvgpr_read_b32 v19, a223
  v_mfma_f32_16x16x32_bf16 v[104:107], v[32:35], v[232:235], v[104:107]
  ds_read_b64_tr_b16 v[84:85], v13 offset:41472
  v_accvgpr_read_b32 v20, a252
  v_mfma_f32_16x16x32_bf16 v[120:123], v[36:39], v[232:235], v[120:123]
  ds_read_b64_tr_b16 v[86:87], v13 offset:42496
  v_accvgpr_read_b32 v21, a253
  v_mfma_f32_16x16x32_bf16 v[136:139], v[40:43], v[232:235], v[136:139]
  buffer_load_dwordx4 v6, s[32:35], s26 offen offset:3072 sc1 lds
  v_accvgpr_read_b32 v22, a254
  v_mfma_f32_16x16x32_bf16 v[152:155], v[44:47], v[232:235], v[152:155]
  s_add_u32 s26, s26, 1024
  ds_read_b64_tr_b16 v[88:89], v12 offset:41728
  v_accvgpr_read_b32 v23, a255
  v_mfma_f32_16x16x32_bf16 v[168:171], v[48:51], v[232:235], v[168:171]
  ds_read_b64_tr_b16 v[90:91], v12 offset:42752
  v_cvt_pk_bf16_f32 v28, v16, v17
  v_mfma_f32_16x16x32_bf16 v[184:187], v[52:55], v[232:235], v[184:187]
  ds_read_b64_tr_b16 v[92:93], v13 offset:41728
  v_cvt_pk_bf16_f32 v29, v18, v19
  v_mfma_f32_16x16x32_bf16 v[200:203], v[56:59], v[232:235], v[200:203]
  ds_read_b64_tr_b16 v[94:95], v13 offset:42752
  v_cvt_pk_bf16_f32 v30, v20, v21
  v_mfma_f32_16x16x32_bf16 v[216:219], v[60:63], v[232:235], v[216:219]
  v_cvt_pk_bf16_f32 v31, v22, v23
  v_mfma_f32_16x16x32_bf16 v[108:111], v[32:35], v[236:239], v[108:111]
  ds_read_b128 v[248:251], v14 offset:34816
  buffer_store_dwordx4 v[28:31], v2, s[40:43], s63 offen offset:1024 sc1
  v_mfma_f32_16x16x32_bf16 v[124:127], v[36:39], v[236:239], v[124:127]
  ds_read_b128 v[252:255], v14 offset:35840
  v_accvgpr_write_b32 a70, 0
  v_mfma_f32_16x16x32_bf16 v[140:143], v[40:43], v[236:239], v[140:143]
  v_accvgpr_write_b32 a71, 0
  v_accvgpr_write_b32 a100, 0
  v_mfma_f32_16x16x32_bf16 v[156:159], v[44:47], v[236:239], v[156:159]
  v_xor_b32 v14, 0x10000, v14
  v_accvgpr_write_b32 a101, 0
  v_mfma_f32_16x16x32_bf16 v[172:175], v[48:51], v[236:239], v[172:175]
  v_accvgpr_write_b32 a102, 0
  v_accvgpr_write_b32 a103, 0
  v_mfma_f32_16x16x32_bf16 v[188:191], v[52:55], v[236:239], v[188:191]
  v_xor_b32 v12, 0x10000, v12
  v_mfma_f32_16x16x32_bf16 v[204:207], v[56:59], v[236:239], v[204:207]
  v_xor_b32 v13, 0x10000, v13
  v_mfma_f32_16x16x32_bf16 v[220:223], v[60:63], v[236:239], v[220:223]
  s_waitcnt vmcnt(17) lgkmcnt(0)
  v_mfma_f32_16x16x32_bf16 v[96:99], v[64:67], v[240:243], v[96:99]
  s_barrier
  v_accvgpr_write_b32 a72, 0
  v_accvgpr_write_b32 a73, 0
  v_mfma_f32_16x16x32_bf16 v[112:115], v[68:71], v[240:243], v[112:115]
  ds_read_b64_tr_b16 v[32:33], v12 offset:0
  v_accvgpr_write_b32 a74, 0
  v_mfma_f32_16x16x32_bf16 v[128:131], v[72:75], v[240:243], v[128:131]
  s_add_u32 m0, s24, 98304
  ds_read_b64_tr_b16 v[34:35], v12 offset:1024
  v_accvgpr_write_b32 a75, 0
  v_mfma_f32_16x16x32_bf16 v[144:147], v[76:79], v[240:243], v[144:147]
  buffer_load_dwordx4 v3, s[32:35], s26 offen offset:0 sc1 lds
  v_accvgpr_write_b32 a104, 0
  v_mfma_f32_16x16x32_bf16 v[160:163], v[80:83], v[240:243], v[160:163]
  ds_read_b64_tr_b16 v[36:37], v13 offset:0
  v_accvgpr_write_b32 a105, 0
  v_mfma_f32_16x16x32_bf16 v[176:179], v[84:87], v[240:243], v[176:179]
  ds_read_b64_tr_b16 v[38:39], v13 offset:1024
  v_accvgpr_write_b32 a106, 0
  v_mfma_f32_16x16x32_bf16 v[192:195], v[88:91], v[240:243], v[192:195]
  ds_read_b64_tr_b16 v[40:41], v12 offset:256
  v_accvgpr_write_b32 a107, 0
  v_mfma_f32_16x16x32_bf16 v[208:211], v[92:95], v[240:243], v[208:211]
  ds_read_b64_tr_b16 v[42:43], v12 offset:1280
  v_accvgpr_write_b32 a76, 0
  v_mfma_f32_16x16x32_bf16 v[100:103], v[64:67], v[244:247], v[100:103]
  buffer_load_dwordx4 v4, s[32:35], s26 offen offset:1024 sc1 lds
  v_accvgpr_write_b32 a77, 0
  v_mfma_f32_16x16x32_bf16 v[116:119], v[68:71], v[244:247], v[116:119]
  ds_read_b64_tr_b16 v[44:45], v13 offset:256
  v_accvgpr_write_b32 a78, 0
  v_mfma_f32_16x16x32_bf16 v[132:135], v[72:75], v[244:247], v[132:135]
  ds_read_b64_tr_b16 v[46:47], v13 offset:1280
  v_accvgpr_write_b32 a79, 0
  v_mfma_f32_16x16x32_bf16 v[148:151], v[76:79], v[244:247], v[148:151]
  ds_read_b128 v[224:227], v14 offset:0
  v_accvgpr_write_b32 a108, 0
  v_mfma_f32_16x16x32_bf16 v[164:167], v[80:83], v[244:247], v[164:167]
  ds_read_b128 v[228:231], v14 offset:1024
  v_accvgpr_write_b32 a109, 0
  v_mfma_f32_16x16x32_bf16 v[180:183], v[84:87], v[244:247], v[180:183]
  buffer_load_dwordx4 v5, s[32:35], s26 offen offset:2048 sc1 lds
  v_accvgpr_write_b32 a110, 0
  v_mfma_f32_16x16x32_bf16 v[196:199], v[88:91], v[244:247], v[196:199]
  ds_read_b64_tr_b16 v[48:49], v12 offset:512
  v_accvgpr_write_b32 a111, 0
  v_mfma_f32_16x16x32_bf16 v[212:215], v[92:95], v[244:247], v[212:215]
  ds_read_b64_tr_b16 v[50:51], v12 offset:1536
  v_accvgpr_write_b32 a80, 0
  v_mfma_f32_16x16x32_bf16 v[104:107], v[64:67], v[248:251], v[104:107]
  ds_read_b64_tr_b16 v[52:53], v13 offset:512
  v_accvgpr_write_b32 a81, 0
  v_mfma_f32_16x16x32_bf16 v[120:123], v[68:71], v[248:251], v[120:123]
  ds_read_b64_tr_b16 v[54:55], v13 offset:1536
  v_accvgpr_write_b32 a82, 0
  v_mfma_f32_16x16x32_bf16 v[136:139], v[72:75], v[248:251], v[136:139]
  buffer_load_dwordx4 v6, s[32:35], s26 offen offset:3072 sc1 lds
  v_accvgpr_write_b32 a83, 0
  v_mfma_f32_16x16x32_bf16 v[152:155], v[76:79], v[248:251], v[152:155]
  s_add_u32 s26, s26, 1024
  ds_read_b64_tr_b16 v[56:57], v12 offset:768
  v_accvgpr_write_b32 a112, 0
  v_mfma_f32_16x16x32_bf16 v[168:171], v[80:83], v[248:251], v[168:171]
  ds_read_b64_tr_b16 v[58:59], v12 offset:1792
  v_accvgpr_write_b32 a113, 0
  v_mfma_f32_16x16x32_bf16 v[184:187], v[84:87], v[248:251], v[184:187]
  ds_read_b64_tr_b16 v[60:61], v13 offset:768
  v_accvgpr_write_b32 a114, 0
  v_mfma_f32_16x16x32_bf16 v[200:203], v[88:91], v[248:251], v[200:203]
  ds_read_b64_tr_b16 v[62:63], v13 offset:1792
  v_accvgpr_write_b32 a115, 0
  v_mfma_f32_16x16x32_bf16 v[216:219], v[92:95], v[248:251], v[216:219]
  v_accvgpr_write_b32 a84, 0
  v_accvgpr_write_b32 a85, 0
  v_mfma_f32_16x16x32_bf16 v[108:111], v[64:67], v[252:255], v[108:111]
  ds_read_b128 v[232:235], v14 offset:2048
  v_accvgpr_write_b32 a86, 0
  v_mfma_f32_16x16x32_bf16 v[124:127], v[68:71], v[252:255], v[124:127]
  ds_read_b128 v[236:239], v14 offset:3072
  v_accvgpr_write_b32 a87, 0
  v_mfma_f32_16x16x32_bf16 v[140:143], v[72:75], v[252:255], v[140:143]
  v_accvgpr_write_b32 a116, 0
  v_accvgpr_write_b32 a117, 0
  v_mfma_f32_16x16x32_bf16 v[156:159], v[76:79], v[252:255], v[156:159]
  v_accvgpr_write_b32 a118, 0
  v_accvgpr_write_b32 a119, 0
  v_mfma_f32_16x16x32_bf16 v[172:175], v[80:83], v[252:255], v[172:175]
  v_accvgpr_write_b32 a88, 0
  v_accvgpr_write_b32 a89, 0
  v_mfma_f32_16x16x32_bf16 v[188:191], v[84:87], v[252:255], v[188:191]
  v_accvgpr_write_b32 a90, 0
  v_accvgpr_write_b32 a91, 0
  v_mfma_f32_16x16x32_bf16 v[204:207], v[88:91], v[252:255], v[204:207]
  v_accvgpr_write_b32 a120, 0
  v_mfma_f32_16x16x32_bf16 v[220:223], v[92:95], v[252:255], v[220:223]
  s_waitcnt vmcnt(11) lgkmcnt(0)
  v_mfma_f32_16x16x32_bf16 v[96:99], v[32:35], v[224:227], v[96:99]
  v_accvgpr_write_b32 a121, 0
  v_accvgpr_write_b32 a122, 0
  v_mfma_f32_16x16x32_bf16 v[112:115], v[36:39], v[224:227], v[112:115]
  ds_read_b64_tr_b16 v[64:65], v12 offset:8192
  v_accvgpr_write_b32 a123, 0
  v_mfma_f32_16x16x32_bf16 v[128:131], v[40:43], v[224:227], v[128:131]
  ds_read_b64_tr_b16 v[66:67], v12 offset:9216
  v_accvgpr_write_b32 a92, 0
  v_mfma_f32_16x16x32_bf16 v[144:147], v[44:47], v[224:227], v[144:147]
  v_accvgpr_write_b32 a93, 0
  v_accvgpr_write_b32 a94, 0
  v_mfma_f32_16x16x32_bf16 v[160:163], v[48:51], v[224:227], v[160:163]
  ds_read_b64_tr_b16 v[68:69], v13 offset:8192
  v_accvgpr_write_b32 a95, 0
  v_mfma_f32_16x16x32_bf16 v[176:179], v[52:55], v[224:227], v[176:179]
  ds_read_b64_tr_b16 v[70:71], v13 offset:9216
  v_accvgpr_write_b32 a124, 0
  v_mfma_f32_16x16x32_bf16 v[192:195], v[56:59], v[224:227], v[192:195]
  ds_read_b64_tr_b16 v[72:73], v12 offset:8448
  v_accvgpr_write_b32 a125, 0
  v_mfma_f32_16x16x32_bf16 v[208:211], v[60:63], v[224:227], v[208:211]
  ds_read_b64_tr_b16 v[74:75], v12 offset:9472
  v_accvgpr_write_b32 a126, 0
  v_mfma_f32_16x16x32_bf16 v[100:103], v[32:35], v[228:231], v[100:103]
  v_accvgpr_write_b32 a127, 0
  v_mfma_f32_16x16x32_bf16 v[116:119], v[36:39], v[228:231], v[116:119]
  ds_read_b64_tr_b16 v[76:77], v13 offset:8448
  v_mfma_f32_16x16x32_bf16 v[132:135], v[40:43], v[228:231], v[132:135]
  ds_read_b64_tr_b16 v[78:79], v13 offset:9472
  v_mfma_f32_16x16x32_bf16 v[148:151], v[44:47], v[228:231], v[148:151]
  ds_read_b128 v[240:243], v14 offset:32768
  v_mfma_f32_16x16x32_bf16 v[164:167], v[48:51], v[228:231], v[164:167]
  ds_read_b128 v[244:247], v14 offset:33792
  v_mfma_f32_16x16x32_bf16 v[180:183], v[52:55], v[228:231], v[180:183]
  v_mfma_f32_16x16x32_bf16 v[196:199], v[56:59], v[228:231], v[196:199]
  ds_read_b64_tr_b16 v[80:81], v12 offset:8704
  v_mfma_f32_16x16x32_bf16 v[212:215], v[60:63], v[228:231], v[212:215]
  ds_read_b64_tr_b16 v[82:83], v12 offset:9728
  v_mfma_f32_16x16x32_bf16 v[104:107], v[32:35], v[232:235], v[104:107]
  ds_read_b64_tr_b16 v[84:85], v13 offset:8704
  v_mfma_f32_16x16x32_bf16 v[120:123], v[36:39], v[232:235], v[120:123]
  ds_read_b64_tr_b16 v[86:87], v13 offset:9728
  v_mfma_f32_16x16x32_bf16 v[136:139], v[40:43], v[232:235], v[136:139]
  v_mfma_f32_16x16x32_bf16 v[152:155], v[44:47], v[232:235], v[152:155]
  ds_read_b64_tr_b16 v[88:89], v12 offset:8960
  v_mfma_f32_16x16x32_bf16 v[168:171], v[48:51], v[232:235], v[168:171]
  ds_read_b64_tr_b16 v[90:91], v12 offset:9984
  v_mfma_f32_16x16x32_bf16 v[184:187], v[52:55], v[232:235], v[184:187]
  ds_read_b64_tr_b16 v[92:93], v13 offset:8960
  v_mfma_f32_16x16x32_bf16 v[200:203], v[56:59], v[232:235], v[200:203]
  ds_read_b64_tr_b16 v[94:95], v13 offset:9984
  v_mfma_f32_16x16x32_bf16 v[216:219], v[60:63], v[232:235], v[216:219]
  v_mfma_f32_16x16x32_bf16 v[108:111], v[32:35], v[236:239], v[108:111]
  ds_read_b128 v[248:251], v14 offset:34816
  v_mfma_f32_16x16x32_bf16 v[124:127], v[36:39], v[236:239], v[124:127]
  ds_read_b128 v[252:255], v14 offset:35840
  v_mfma_f32_16x16x32_bf16 v[140:143], v[40:43], v[236:239], v[140:143]
  v_mfma_f32_16x16x32_bf16 v[156:159], v[44:47], v[236:239], v[156:159]
  v_xor_b32 v14, 0x10000, v14
  v_mfma_f32_16x16x32_bf16 v[172:175], v[48:51], v[236:239], v[172:175]
  v_mfma_f32_16x16x32_bf16 v[188:191], v[52:55], v[236:239], v[188:191]
  v_mfma_f32_16x16x32_bf16 v[204:207], v[56:59], v[236:239], v[204:207]
  v_mfma_f32_16x16x32_bf16 v[220:223], v[60:63], v[236:239], v[220:223]
  s_waitcnt vmcnt(4) lgkmcnt(0)
  v_mfma_f32_16x16x32_bf16 v[96:99], v[64:67], v[240:243], v[96:99]
  s_barrier
  buffer_store_dword v10, v9, s[40:43], 0 offen sc1
  v_mfma_f32_16x16x32_bf16 v[112:115], v[68:71], v[240:243], v[112:115]
  ds_read_b64_tr_b16 v[32:33], v12 offset:32768
  v_mfma_f32_16x16x32_bf16 v[128:131], v[72:75], v[240:243], v[128:131]
  ds_read_b64_tr_b16 v[34:35], v12 offset:33792
  v_mfma_f32_16x16x32_bf16 v[144:147], v[76:79], v[240:243], v[144:147]
  v_mfma_f32_16x16x32_bf16 v[160:163], v[80:83], v[240:243], v[160:163]
  ds_read_b64_tr_b16 v[36:37], v13 offset:32768
  v_mfma_f32_16x16x32_bf16 v[176:179], v[84:87], v[240:243], v[176:179]
  ds_read_b64_tr_b16 v[38:39], v13 offset:33792
  v_mfma_f32_16x16x32_bf16 v[192:195], v[88:91], v[240:243], v[192:195]
  ds_read_b64_tr_b16 v[40:41], v12 offset:33024
  v_mfma_f32_16x16x32_bf16 v[208:211], v[92:95], v[240:243], v[208:211]
  ds_read_b64_tr_b16 v[42:43], v12 offset:34048
  v_mfma_f32_16x16x32_bf16 v[100:103], v[64:67], v[244:247], v[100:103]
  v_mfma_f32_16x16x32_bf16 v[116:119], v[68:71], v[244:247], v[116:119]
  ds_read_b64_tr_b16 v[44:45], v13 offset:33024
  v_mfma_f32_16x16x32_bf16 v[132:135], v[72:75], v[244:247], v[132:135]
  ds_read_b64_tr_b16 v[46:47], v13 offset:34048
  v_mfma_f32_16x16x32_bf16 v[148:151], v[76:79], v[244:247], v[148:151]
  ds_read_b128 v[224:227], v14 offset:0
  v_mfma_f32_16x16x32_bf16 v[164:167], v[80:83], v[244:247], v[164:167]
  ds_read_b128 v[228:231], v14 offset:1024
  v_mfma_f32_16x16x32_bf16 v[180:183], v[84:87], v[244:247], v[180:183]
  v_mfma_f32_16x16x32_bf16 v[196:199], v[88:91], v[244:247], v[196:199]
  ds_read_b64_tr_b16 v[48:49], v12 offset:33280
  v_mfma_f32_16x16x32_bf16 v[212:215], v[92:95], v[244:247], v[212:215]
  ds_read_b64_tr_b16 v[50:51], v12 offset:34304
  v_mfma_f32_16x16x32_bf16 v[104:107], v[64:67], v[248:251], v[104:107]
  ds_read_b64_tr_b16 v[52:53], v13 offset:33280
  v_mfma_f32_16x16x32_bf16 v[120:123], v[68:71], v[248:251], v[120:123]
  ds_read_b64_tr_b16 v[54:55], v13 offset:34304
  v_mfma_f32_16x16x32_bf16 v[136:139], v[72:75], v[248:251], v[136:139]
  v_mfma_f32_16x16x32_bf16 v[152:155], v[76:79], v[248:251], v[152:155]
  ds_read_b64_tr_b16 v[56:57], v12 offset:33536
  v_mfma_f32_16x16x32_bf16 v[168:171], v[80:83], v[248:251], v[168:171]
  ds_read_b64_tr_b16 v[58:59], v12 offset:34560
  v_mfma_f32_16x16x32_bf16 v[184:187], v[84:87], v[248:251], v[184:187]
  ds_read_b64_tr_b16 v[60:61], v13 offset:33536
  v_mfma_f32_16x16x32_bf16 v[200:203], v[88:91], v[248:251], v[200:203]
  ds_read_b64_tr_b16 v[62:63], v13 offset:34560
  v_mfma_f32_16x16x32_bf16 v[216:219], v[92:95], v[248:251], v[216:219]
  v_mfma_f32_16x16x32_bf16 v[108:111], v[64:67], v[252:255], v[108:111]
  ds_read_b128 v[232:235], v14 offset:2048
  v_mfma_f32_16x16x32_bf16 v[124:127], v[68:71], v[252:255], v[124:127]
  ds_read_b128 v[236:239], v14 offset:3072
  v_mfma_f32_16x16x32_bf16 v[140:143], v[72:75], v[252:255], v[140:143]
  v_mfma_f32_16x16x32_bf16 v[156:159], v[76:79], v[252:255], v[156:159]
  v_mfma_f32_16x16x32_bf16 v[172:175], v[80:83], v[252:255], v[172:175]
  v_mfma_f32_16x16x32_bf16 v[188:191], v[84:87], v[252:255], v[188:191]
  v_mfma_f32_16x16x32_bf16 v[204:207], v[88:91], v[252:255], v[204:207]
  v_mfma_f32_16x16x32_bf16 v[220:223], v[92:95], v[252:255], v[220:223]
  s_waitcnt vmcnt(1) lgkmcnt(0)
  v_mfma_f32_16x16x32_bf16 v[96:99], v[32:35], v[224:227], v[96:99]
  v_mfma_f32_16x16x32_bf16 v[112:115], v[36:39], v[224:227], v[112:115]
  ds_read_b64_tr_b16 v[64:65], v12 offset:40960
  v_mfma_f32_16x16x32_bf16 v[128:131], v[40:43], v[224:227], v[128:131]
  ds_read_b64_tr_b16 v[66:67], v12 offset:41984
  v_mfma_f32_16x16x32_bf16 v[144:147], v[44:47], v[224:227], v[144:147]
  buffer_load_dword v15, v8, s[40:43], 0 offen sc1
  v_mfma_f32_16x16x32_bf16 v[160:163], v[48:51], v[224:227], v[160:163]
  ds_read_b64_tr_b16 v[68:69], v13 offset:40960
  v_mfma_f32_16x16x32_bf16 v[176:179], v[52:55], v[224:227], v[176:179]
  ds_read_b64_tr_b16 v[70:71], v13 offset:41984
  v_mfma_f32_16x16x32_bf16 v[192:195], v[56:59], v[224:227], v[192:195]
  ds_read_b64_tr_b16 v[72:73], v12 offset:41216
  v_mfma_f32_16x16x32_bf16 v[208:211], v[60:63], v[224:227], v[208:211]
  ds_read_b64_tr_b16 v[74:75], v12 offset:42240
  v_mfma_f32_16x16x32_bf16 v[100:103], v[32:35], v[228:231], v[100:103]
  v_mfma_f32_16x16x32_bf16 v[116:119], v[36:39], v[228:231], v[116:119]
  ds_read_b64_tr_b16 v[76:77], v13 offset:41216
  v_mfma_f32_16x16x32_bf16 v[132:135], v[40:43], v[228:231], v[132:135]
  ds_read_b64_tr_b16 v[78:79], v13 offset:42240
  v_mfma_f32_16x16x32_bf16 v[148:151], v[44:47], v[228:231], v[148:151]
  ds_read_b128 v[240:243], v14 offset:32768
  v_mfma_f32_16x16x32_bf16 v[164:167], v[48:51], v[228:231], v[164:167]
  ds_read_b128 v[244:247], v14 offset:33792
  v_mfma_f32_16x16x32_bf16 v[180:183], v[52:55], v[228:231], v[180:183]
  v_mfma_f32_16x16x32_bf16 v[196:199], v[56:59], v[228:231], v[196:199]
  ds_read_b64_tr_b16 v[80:81], v12 offset:41472
  v_mfma_f32_16x16x32_bf16 v[212:215], v[60:63], v[228:231], v[212:215]
  ds_read_b64_tr_b16 v[82:83], v12 offset:42496
  v_mfma_f32_16x16x32_bf16 v[104:107], v[32:35], v[232:235], v[104:107]
  ds_read_b64_tr_b16 v[84:85], v13 offset:41472
  v_mfma_f32_16x16x32_bf16 v[120:123], v[36:39], v[232:235], v[120:123]
  ds_read_b64_tr_b16 v[86:87], v13 offset:42496
  v_mfma_f32_16x16x32_bf16 v[136:139], v[40:43], v[232:235], v[136:139]
  v_mfma_f32_16x16x32_bf16 v[152:155], v[44:47], v[232:235], v[152:155]
  ds_read_b64_tr_b16 v[88:89], v12 offset:41728
  v_mfma_f32_16x16x32_bf16 v[168:171], v[48:51], v[232:235], v[168:171]
  ds_read_b64_tr_b16 v[90:91], v12 offset:42752
  v_mfma_f32_16x16x32_bf16 v[184:187], v[52:55], v[232:235], v[184:187]
  ds_read_b64_tr_b16 v[92:93], v13 offset:41728
  v_mfma_f32_16x16x32_bf16 v[200:203], v[56:59], v[232:235], v[200:203]
  ds_read_b64_tr_b16 v[94:95], v13 offset:42752
  v_mfma_f32_16x16x32_bf16 v[216:219], v[60:63], v[232:235], v[216:219]
  v_mfma_f32_16x16x32_bf16 v[108:111], v[32:35], v[236:239], v[108:111]
  ds_read_b128 v[248:251], v14 offset:34816
  v_mfma_f32_16x16x32_bf16 v[124:127], v[36:39], v[236:239], v[124:127]
  ds_read_b128 v[252:255], v14 offset:35840
  v_mfma_f32_16x16x32_bf16 v[140:143], v[40:43], v[236:239], v[140:143]
  v_mfma_f32_16x16x32_bf16 v[156:159], v[44:47], v[236:239], v[156:159]
  v_xor_b32 v14, 0x10000, v14
  v_mfma_f32_16x16x32_bf16 v[172:175], v[48:51], v[236:239], v[172:175]
  v_mfma_f32_16x16x32_bf16 v[188:191], v[52:55], v[236:239], v[188:191]
  v_xor_b32 v12, 0x10000, v12
  v_mfma_f32_16x16x32_bf16 v[204:207], v[56:59], v[236:239], v[204:207]
  v_xor_b32 v13, 0x10000, v13
  v_mfma_f32_16x16x32_bf16 v[220:223], v[60:63], v[236:239], v[220:223]
  s_waitcnt lgkmcnt(0)
  v_mfma_f32_16x16x32_bf16 v[96:99], v[64:67], v[240:243], v[96:99]
  s_barrier
  v_mfma_f32_16x16x32_bf16 v[112:115], v[68:71], v[240:243], v[112:115]
  v_mfma_f32_16x16x32_bf16 v[128:131], v[72:75], v[240:243], v[128:131]
  v_mfma_f32_16x16x32_bf16 v[144:147], v[76:79], v[240:243], v[144:147]
  v_mfma_f32_16x16x32_bf16 v[160:163], v[80:83], v[240:243], v[160:163]
  v_mfma_f32_16x16x32_bf16 v[176:179], v[84:87], v[240:243], v[176:179]
  v_mfma_f32_16x16x32_bf16 v[192:195], v[88:91], v[240:243], v[192:195]
  v_mfma_f32_16x16x32_bf16 v[208:211], v[92:95], v[240:243], v[208:211]
  v_mfma_f32_16x16x32_bf16 v[100:103], v[64:67], v[244:247], v[100:103]
  v_mfma_f32_16x16x32_bf16 v[116:119], v[68:71], v[244:247], v[116:119]
  v_mfma_f32_16x16x32_bf16 v[132:135], v[72:75], v[244:247], v[132:135]
  v_mfma_f32_16x16x32_bf16 v[148:151], v[76:79], v[244:247], v[148:151]
  v_mfma_f32_16x16x32_bf16 v[164:167], v[80:83], v[244:247], v[164:167]
  v_mfma_f32_16x16x32_bf16 v[180:183], v[84:87], v[244:247], v[180:183]
  v_mfma_f32_16x16x32_bf16 v[196:199], v[88:91], v[244:247], v[196:199]
  v_mfma_f32_16x16x32_bf16 v[212:215], v[92:95], v[244:247], v[212:215]
  v_mfma_f32_16x16x32_bf16 v[104:107], v[64:67], v[248:251], v[104:107]
  v_mfma_f32_16x16x32_bf16 v[120:123], v[68:71], v[248:251], v[120:123]
  v_mfma_f32_16x16x32_bf16 v[136:139], v[72:75], v[248:251], v[136:139]
  v_mfma_f32_16x16x32_bf16 v[152:155], v[76:79], v[248:251], v[152:155]
  v_mfma_f32_16x16x32_bf16 v[168:171], v[80:83], v[248:251], v[168:171]
  v_mfma_f32_16x16x32_bf16 v[184:187], v[84:87], v[248:251], v[184:187]
  v_mfma_f32_16x16x32_bf16 v[200:203], v[88:91], v[248:251], v[200:203]
  v_mfma_f32_16x16x32_bf16 v[216:219], v[92:95], v[248:251], v[216:219]
  v_mfma_f32_16x16x32_bf16 v[108:111], v[64:67], v[252:255], v[108:111]
  v_mfma_f32_16x16x32_bf16 v[124:127], v[68:71], v[252:255], v[124:127]
  v_mfma_f32_16x16x32_bf16 v[140:143], v[72:75], v[252:255], v[140:143]
  v_mfma_f32_16x16x32_bf16 v[156:159], v[76:79], v[252:255], v[156:159]
  v_mfma_f32_16x16x32_bf16 v[172:175], v[80:83], v[252:255], v[172:175]
  v_mfma_f32_16x16x32_bf16 v[188:191], v[84:87], v[252:255], v[188:191]
  v_mfma_f32_16x16x32_bf16 v[204:207], v[88:91], v[252:255], v[204:207]
  v_mfma_f32_16x16x32_bf16 v[220:223], v[92:95], v[252:255], v[220:223]
  s_and_b32 s23, s20, 1
  s_lshl_b32 s23, s23, 12
  s_cmp_lt_u32 s20, 2
  s_cselect_b32 s24, 106496, 0
  s_add_u32 s24, s24, s23
  s_lshl_b32 s26, s20, 12
  s_mov_b32 s27, s26
  s_add_u32 s25, s27, 49152
  s_load_dwordx4 s[4:7], s[0:1], 64
  s_load_dwordx2 s[8:9], s[0:1], 80
  v_mov_b32 v12, 0x3e0293ee
  v_mov_b32 v13, 0x3e0293ee
  s_waitcnt vmcnt(0)
  v_cmp_eq_u32 vcc, 0, v15
  s_cbranch_vccnz fa_kv_spin
fa_kv_ok:
  s_mov_b32 m0, s24
  s_nop 0
  buffer_load_dwordx4 v2, s[44:47], s26 offen offset:0 sc1 lds
  v_pk_mul_f32 v[96:97], v[96:97], v[12:13]
  v_pk_mul_f32 v[98:99], v[98:99], v[12:13]
  v_cvt_pk_bf16_f32 v32, v96, v97
  v_cvt_pk_bf16_f32 v33, v98, v99
  v_pk_mul_f32 v[112:113], v[112:113], v[12:13]
  v_pk_mul_f32 v[114:115], v[114:115], v[12:13]
  v_cvt_pk_bf16_f32 v34, v112, v113
  buffer_load_dwordx4 v2, s[44:47], s26 offen offset:1024 sc1 lds
  v_cvt_pk_bf16_f32 v35, v114, v115
  v_pk_mul_f32 v[100:101], v[100:101], v[12:13]
  v_pk_mul_f32 v[102:103], v[102:103], v[12:13]
  v_cvt_pk_bf16_f32 v36, v100, v101
  v_cvt_pk_bf16_f32 v37, v102, v103
  v_pk_mul_f32 v[116:117], v[116:117], v[12:13]
  v_pk_mul_f32 v[118:119], v[118:119], v[12:13]
  buffer_load_dwordx4 v2, s[44:47], s26 offen offset:2048 sc1 lds
  v_cvt_pk_bf16_f32 v38, v116, v117
  v_cvt_pk_bf16_f32 v39, v118, v119
  v_pk_mul_f32 v[128:129], v[128:129], v[12:13]
  v_pk_mul_f32 v[130:131], v[130:131], v[12:13]
  v_cvt_pk_bf16_f32 v40, v128, v129
  v_cvt_pk_bf16_f32 v41, v130, v131
  v_pk_mul_f32 v[144:145], v[144:145], v[12:13]
  buffer_load_dwordx4 v2, s[44:47], s26 offen offset:3072 sc1 lds
  v_pk_mul_f32 v[146:147], v[146:147], v[12:13]
  v_cvt_pk_bf16_f32 v42, v144, v145
  v_cvt_pk_bf16_f32 v43, v146, v147
  v_pk_mul_f32 v[132:133], v[132:133], v[12:13]
  v_pk_mul_f32 v[134:135], v[134:135], v[12:13]
  v_cvt_pk_bf16_f32 v44, v132, v133
  v_cvt_pk_bf16_f32 v45, v134, v135
  s_add_u32 s26, s26, 16384
  s_add_u32 s24, s24, 32768
  s_and_b32 s24, s24, 0x1ffff
  s_mov_b32 m0, s24
  s_nop 0
  buffer_load_dwordx4 v2, s[44:47], s26 offen offset:0 sc1 lds
  v_pk_mul_f32 v[148:149], v[148:149], v[12:13]
  v_pk_mul_f32 v[150:151], v[150:151], v[12:13]
  v_cvt_pk_bf16_f32 v46, v148, v149
  v_cvt_pk_bf16_f32 v47, v150, v151
  v_pk_mul_f32 v[160:161], v[160:161], v[12:13]
  v_pk_mul_f32 v[162:163], v[162:163], v[12:13]
  v_cvt_pk_bf16_f32 v48, v160, v161
  buffer_load_dwordx4 v2, s[44:47], s26 offen offset:1024 sc1 lds
  v_cvt_pk_bf16_f32 v49, v162, v163
  v_pk_mul_f32 v[176:177], v[176:177], v[12:13]
  v_pk_mul_f32 v[178:179], v[178:179], v[12:13]
  v_cvt_pk_bf16_f32 v50, v176, v177
  v_cvt_pk_bf16_f32 v51, v178, v179
  v_pk_mul_f32 v[164:165], v[164:165], v[12:13]
  v_pk_mul_f32 v[166:167], v[166:167], v[12:13]
  buffer_load_dwordx4 v2, s[44:47], s26 offen offset:2048 sc1 lds
  v_cvt_pk_bf16_f32 v52, v164, v165
  v_cvt_pk_bf16_f32 v53, v166, v167
  v_pk_mul_f32 v[180:181], v[180:181], v[12:13]
  v_pk_mul_f32 v[182:183], v[182:183], v[12:13]
  v_cvt_pk_bf16_f32 v54, v180, v181
  v_cvt_pk_bf16_f32 v55, v182, v183
  v_pk_mul_f32 v[192:193], v[192:193], v[12:13]
  buffer_load_dwordx4 v2, s[44:47], s26 offen offset:3072 sc1 lds
  v_pk_mul_f32 v[194:195], v[194:195], v[12:13]
  v_cvt_pk_bf16_f32 v56, v192, v193
  v_cvt_pk_bf16_f32 v57, v194, v195
  v_pk_mul_f32 v[208:209], v[208:209], v[12:13]
  v_pk_mul_f32 v[210:211], v[210:211], v[12:13]
  v_cvt_pk_bf16_f32 v58, v208, v209
  v_cvt_pk_bf16_f32 v59, v210, v211
  s_add_u32 s26, s26, 16384
  s_add_u32 s24, s24, 32768
  s_and_b32 s24, s24, 0x1ffff
  s_mov_b32 m0, s24
  s_nop 0
  buffer_load_dwordx4 v2, s[44:47], s26 offen offset:0 sc1 lds
  v_pk_mul_f32 v[196:197], v[196:197], v[12:13]
  v_pk_mul_f32 v[198:199], v[198:199], v[12:13]
  v_cvt_pk_bf16_f32 v60, v196, v197
  v_cvt_pk_bf16_f32 v61, v198, v199
  v_pk_mul_f32 v[212:213], v[212:213], v[12:13]
  v_pk_mul_f32 v[214:215], v[214:215], v[12:13]
  v_cvt_pk_bf16_f32 v62, v212, v213
  buffer_load_dwordx4 v2, s[44:47], s26 offen offset:1024 sc1 lds
  v_cvt_pk_bf16_f32 v63, v214, v215
  v_pk_mul_f32 v[104:105], v[104:105], v[12:13]
  v_pk_mul_f32 v[106:107], v[106:107], v[12:13]
  v_cvt_pk_bf16_f32 v64, v104, v105
  v_cvt_pk_bf16_f32 v65, v106, v107
  v_pk_mul_f32 v[120:121], v[120:121], v[12:13]
  v_pk_mul_f32 v[122:123], v[122:123], v[12:13]
  buffer_load_dwordx4 v2, s[44:47], s26 offen offset:2048 sc1 lds
  v_cvt_pk_bf16_f32 v66, v120, v121
  v_cvt_pk_bf16_f32 v67, v122, v123
  v_pk_mul_f32 v[108:109], v[108:109], v[12:13]
  v_pk_mul_f32 v[110:111], v[110:111], v[12:13]
  v_cvt_pk_bf16_f32 v68, v108, v109
  v_cvt_pk_bf16_f32 v69, v110, v111
  v_pk_mul_f32 v[124:125], v[124:125], v[12:13]
  buffer_load_dwordx4 v2, s[44:47], s26 offen offset:3072 sc1 lds
  v_pk_mul_f32 v[126:127], v[126:127], v[12:13]
  v_cvt_pk_bf16_f32 v70, v124, v125
  v_cvt_pk_bf16_f32 v71, v126, v127
  v_pk_mul_f32 v[136:137], v[136:137], v[12:13]
  v_pk_mul_f32 v[138:139], v[138:139], v[12:13]
  v_cvt_pk_bf16_f32 v72, v136, v137
  v_cvt_pk_bf16_f32 v73, v138, v139
  s_add_u32 s26, s26, 16384
  s_add_u32 s24, s24, 32768
  s_and_b32 s24, s24, 0x1ffff
  s_mov_b32 m0, s25
  s_nop 0
  buffer_load_dwordx4 v2, s[48:51], s27 offen offset:0 sc1 lds
  v_pk_mul_f32 v[152:153], v[152:153], v[12:13]
  v_pk_mul_f32 v[154:155], v[154:155], v[12:13]
  v_cvt_pk_bf16_f32 v74, v152, v153
  v_cvt_pk_bf16_f32 v75, v154, v155
  v_pk_mul_f32 v[140:141], v[140:141], v[12:13]
  v_pk_mul_f32 v[142:143], v[142:143], v[12:13]
  v_cvt_pk_bf16_f32 v76, v140, v141
  buffer_load_dwordx4 v2, s[48:51], s27 offen offset:1024 sc1 lds
  v_cvt_pk_bf16_f32 v77, v142, v143
  v_pk_mul_f32 v[156:157], v[156:157], v[12:13]
  v_pk_mul_f32 v[158:159], v[158:159], v[12:13]
  v_cvt_pk_bf16_f32 v78, v156, v157
  v_cvt_pk_bf16_f32 v79, v158, v159
  v_pk_mul_f32 v[168:169], v[168:169], v[12:13]
  v_pk_mul_f32 v[170:171], v[170:171], v[12:13]
  buffer_load_dwordx4 v2, s[48:51], s27 offen offset:2048 sc1 lds
  v_cvt_pk_bf16_f32 v80, v168, v169
  v_cvt_pk_bf16_f32 v81, v170, v171
  v_pk_mul_f32 v[184:185], v[184:185], v[12:13]
  v_pk_mul_f32 v[186:187], v[186:187], v[12:13]
  v_cvt_pk_bf16_f32 v82, v184, v185
  v_cvt_pk_bf16_f32 v83, v186, v187
  v_pk_mul_f32 v[172:173], v[172:173], v[12:13]
  buffer_load_dwordx4 v2, s[48:51], s27 offen offset:3072 sc1 lds
  v_pk_mul_f32 v[174:175], v[174:175], v[12:13]
  v_cvt_pk_bf16_f32 v84, v172, v173
  v_cvt_pk_bf16_f32 v85, v174, v175
  v_pk_mul_f32 v[188:189], v[188:189], v[12:13]
  v_pk_mul_f32 v[190:191], v[190:191], v[12:13]
  v_cvt_pk_bf16_f32 v86, v188, v189
  v_cvt_pk_bf16_f32 v87, v190, v191
  s_add_u32 s27, s27, 16384
  s_add_u32 s25, s25, 32768
  s_and_b32 s25, s25, 0x1ffff
  s_mov_b32 m0, s25
  s_nop 0
  buffer_load_dwordx4 v2, s[48:51], s27 offen offset:0 sc1 lds
  v_pk_mul_f32 v[200:201], v[200:201], v[12:13]
  v_pk_mul_f32 v[202:203], v[202:203], v[12:13]
  v_cvt_pk_bf16_f32 v88, v200, v201
  v_cvt_pk_bf16_f32 v89, v202, v203
  v_pk_mul_f32 v[216:217], v[216:217], v[12:13]
  v_pk_mul_f32 v[218:219], v[218:219], v[12:13]
  v_cvt_pk_bf16_f32 v90, v216, v217
  buffer_load_dwordx4 v2, s[48:51], s27 offen offset:1024 sc1 lds
  v_cvt_pk_bf16_f32 v91, v218, v219
  v_pk_mul_f32 v[204:205], v[204:205], v[12:13]
  v_pk_mul_f32 v[206:207], v[206:207], v[12:13]
  v_cvt_pk_bf16_f32 v92, v204, v205
  v_cvt_pk_bf16_f32 v93, v206, v207
  v_pk_mul_f32 v[220:221], v[220:221], v[12:13]
  v_pk_mul_f32 v[222:223], v[222:223], v[12:13]
  buffer_load_dwordx4 v2, s[48:51], s27 offen offset:2048 sc1 lds
  v_cvt_pk_bf16_f32 v94, v220, v221
  v_cvt_pk_bf16_f32 v95, v222, v223
  buffer_load_dwordx4 v2, s[48:51], s27 offen offset:3072 sc1 lds
  s_add_u32 s27, s27, 16384
  s_add_u32 s25, s25, 32768
  s_and_b32 s25, s25, 0x1ffff
  v_add_u32 v18, 106496, v2
  s_waitcnt vmcnt(12)
  s_barrier
  ds_read_b128 a[128:131], v18 offset:0
  ds_read_b128 a[132:135], v18 offset:1024
  ds_read_b128 a[136:139], v18 offset:2048
  ds_read_b128 a[140:143], v18 offset:3072
  ds_read_b128 a[144:147], v18 offset:4096
  ds_read_b128 a[148:151], v18 offset:5120
  ds_read_b128 a[152:155], v18 offset:6144
  ds_read_b128 a[156:159], v18 offset:7168
  s_and_b32 s62, s2, 1
  s_lshl_b32 s62, s62, 2
  s_add_u32 s62, s62, s20
  s_lshr_b32 s63, s2, 1
  s_mul_i32 s23, s63, 40960
  s_mul_i32 s31, s62, 160
  s_add_u32 s23, s23, s31
  s_mul_i32 s34, s20, 5120
  s_add_u32 s34, s34, 131072
  v_add_u32 v20, 0, v1
  v_mul_u32_u24 v19, 6554, v20
  s_add_u32 m0, s34, 0
  v_lshrrev_b32 v19, 16, v19
  v_mul_u32_u24 v19, 1120, v19
  v_lshl_add_u32 v19, v20, 4, v19
  buffer_load_dwordx4 v19, s[52:55], s23 offen lds
  v_accvgpr_write_b32 a248, v19
  v_add_u32 v20, 64, v1
  v_mul_u32_u24 v19, 6554, v20
  s_add_u32 m0, s34, 1024
  v_lshrrev_b32 v19, 16, v19
  v_mul_u32_u24 v19, 1120, v19
  v_lshl_add_u32 v19, v20, 4, v19
  buffer_load_dwordx4 v19, s[52:55], s23 offen lds
  v_accvgpr_write_b32 a249, v19
  v_add_u32 v20, 128, v1
  v_mul_u32_u24 v19, 6554, v20
  s_add_u32 m0, s34, 2048
  v_lshrrev_b32 v19, 16, v19
  v_mul_u32_u24 v19, 1120, v19
  v_lshl_add_u32 v19, v20, 4, v19
  buffer_load_dwordx4 v19, s[52:55], s23 offen lds
  v_accvgpr_write_b32 a250, v19
  v_add_u32 v20, 192, v1
  v_mul_u32_u24 v19, 6554, v20
  s_add_u32 m0, s34, 3072
  v_lshrrev_b32 v19, 16, v19
  v_mul_u32_u24 v19, 1120, v19
  v_lshl_add_u32 v19, v20, 4, v19
  buffer_load_dwordx4 v19, s[52:55], s23 offen lds
  v_accvgpr_write_b32 a251, v19
  v_add_u32 v20, 256, v1
  v_mul_u32_u24 v19, 6554, v20
  s_add_u32 m0, s34, 4096
  v_lshrrev_b32 v19, 16, v19
  v_mul_u32_u24 v19, 1120, v19
  v_lshl_add_u32 v19, v20, 4, v19
  buffer_load_dwordx4 v19, s[52:55], s23 offen lds
  v_accvgpr_write_b32 a252, v19
  v_lshrrev_b32 v6, 2, v1
  v_mul_u32_u24 v6, 160, v6
  v_and_b32 v19, 3, v1
  v_lshl_add_u32 v6, v19, 3, v6
  v_add_u32 v6, s34, v6
  s_lshl_b32 s30, s62, 7
  s_add_u32 s30, s30, s63
  s_mul_i32 s30, s30, 5120
  s_add_u32 s30, s30, 4194304
  s_waitcnt lgkmcnt(0)
  s_cmp_ge_u32 s20, 2
  s_cselect_b32 s4, s6, s4
  s_cselect_b32 s5, s7, s5
  s_mov_b32 s52, s4
  s_mov_b32 s53, s5
  s_mov_b32 s54, 2211840
  s_mov_b32 s55, 0x20000
  s_mov_b32 s60, s8
  s_mov_b32 s61, s9
  s_mov_b32 s62, 2211840
  s_mov_b32 s63, 0x20000
  v_mov_b32 v228, 0
  v_mov_b32 v229, 0
  v_mov_b32 v230, 0
  v_mov_b32 v231, 0
  s_add_u32 s23, s20, 1
  s_lshr_b32 s23, s23, 1
  s_lshl_b32 s28, s22, 1
  s_add_u32 s28, s28, s23
  s_lshl_b32 s23, s22, 2
  s_sub_u32 s29, 28, s23
  s_and_b32 s23, s20, 1
  s_add_u32 s29, s29, s23
  v_mov_b32 v3, v2
  v_mov_b32 v4, 0xff800000
  s_cmp_eq_u32 s2, 255
  s_cbranch_scc1 fa_top8
fa_notop:
  s_mov_b32 s32, 0
  s_mov_b32 s11, 0
  s_mov_b32 s12, 0
  s_lshl_b32 s15, s22, 1
  s_sub_u32 s15, 24, s15
  s_lshl_b32 s15, s15, 14
  s_getpc_b64 s[36:37]
fa_copc:
  s_add_u32 s36, s36, fa_co-fa_copc-4
  s_addc_u32 s37, s37, 0
  s_waitcnt lgkmcnt(0)
  v_mfma_f32_16x16x32_bf16 v[96:99], a[128:131], v[32:35], 0
  v_mfma_f32_16x16x32_bf16 v[104:107], a[128:131], v[36:39], 0
  v_mfma_f32_16x16x32_bf16 v[128:131], a[128:131], v[64:67], 0
  v_mfma_f32_16x16x32_bf16 v[136:139], a[128:131], v[68:71], 0
  s_mov_b32 m0, s24
  ds_read_b128 a[128:131], v3 offset:0
  v_mfma_f32_16x16x32_bf16 v[100:103], a[132:135], v[32:35], 0
  buffer_load_dwordx4 v2, s[44:47], s26 offen offset:0 sc1 lds
  v_mfma_f32_16x16x32_bf16 v[108:111], a[132:135], v[36:39], 0
  v_mfma_f32_16x16x32_bf16 v[132:135], a[132:135], v[64:67], 0
  v_mfma_f32_16x16x32_bf16 v[140:143], a[132:135], v[68:71], 0
  ds_read_b128 a[132:135], v3 offset:1024
  v_mfma_f32_16x16x32_bf16 v[96:99], a[136:139], v[40:43], v[96:99]
  v_mfma_f32_16x16x32_bf16 v[104:107], a[136:139], v[44:47], v[104:107]
  v_mfma_f32_16x16x32_bf16 v[128:131], a[136:139], v[72:75], v[128:131]
  buffer_load_dwordx4 v2, s[44:47], s26 offen offset:1024 sc1 lds
  v_mfma_f32_16x16x32_bf16 v[136:139], a[136:139], v[76:79], v[136:139]
  ds_read_b128 a[136:139], v3 offset:2048
  v_mfma_f32_16x16x32_bf16 v[100:103], a[140:143], v[40:43], v[100:103]
  v_mfma_f32_16x16x32_bf16 v[108:111], a[140:143], v[44:47], v[108:111]
  v_mfma_f32_16x16x32_bf16 v[132:135], a[140:143], v[72:75], v[132:135]
  v_mfma_f32_16x16x32_bf16 v[140:143], a[140:143], v[76:79], v[140:143]
  s_waitcnt lgkmcnt(3)
  ds_read_b128 a[140:143], v3 offset:3072
  v_mfma_f32_16x16x32_bf16 v[96:99], a[144:147], v[48:51], v[96:99]
  v_mfma_f32_16x16x32_bf16 v[104:107], a[144:147], v[52:55], v[104:107]
  v_mfma_f32_16x16x32_bf16 v[128:131], a[144:147], v[80:83], v[128:131]
  buffer_load_dwordx4 v2, s[44:47], s26 offen offset:2048 sc1 lds
  v_mfma_f32_16x16x32_bf16 v[136:139], a[144:147], v[84:87], v[136:139]
  ds_read_b128 a[144:147], v3 offset:4096
  v_mfma_f32_16x16x32_bf16 v[100:103], a[148:151], v[48:51], v[100:103]
  v_mfma_f32_16x16x32_bf16 v[108:111], a[148:151], v[52:55], v[108:111]
  v_mfma_f32_16x16x32_bf16 v[132:135], a[148:151], v[80:83], v[132:135]
  v_mfma_f32_16x16x32_bf16 v[140:143], a[148:151], v[84:87], v[140:143]
  ds_read_b128 a[148:151], v3 offset:5120
  v_mfma_f32_16x16x32_bf16 v[96:99], a[152:155], v[56:59], v[96:99]
  buffer_load_dwordx4 v2, s[44:47], s26 offen offset:3072 sc1 lds
  v_mfma_f32_16x16x32_bf16 v[104:107], a[152:155], v[60:63], v[104:107]
  s_add_u32 s26, s26, 16384
  v_mfma_f32_16x16x32_bf16 v[128:131], a[152:155], v[88:91], v[128:131]
  s_add_u32 s24, s24, 32768
  v_mfma_f32_16x16x32_bf16 v[136:139], a[152:155], v[92:95], v[136:139]
  s_and_b32 s24, s24, 0x1ffff
  ds_read_b128 a[152:155], v3 offset:6144
  v_mfma_f32_16x16x32_bf16 v[100:103], a[156:159], v[56:59], v[100:103]
  v_mfma_f32_16x16x32_bf16 v[108:111], a[156:159], v[60:63], v[108:111]
  v_mfma_f32_16x16x32_bf16 v[132:135], a[156:159], v[88:91], v[132:135]
  v_mfma_f32_16x16x32_bf16 v[140:143], a[156:159], v[92:95], v[140:143]
  s_waitcnt lgkmcnt(3)
  ds_read_b128 a[156:159], v3 offset:7168
  s_nop 7
  s_cmp_lg_u32 s28, 0
  s_cbranch_scc1 fa_nomask0
  v_cndmask_b32 v96, v4, v96, s[68:69]
  v_cndmask_b32 v97, v4, v97, s[70:71]
  v_cndmask_b32 v98, v4, v98, s[72:73]
  v_cndmask_b32 v99, v4, v99, s[74:75]
  v_mov_b32 v100, v4
  v_mov_b32 v101, v4
  v_mov_b32 v102, v4
  v_mov_b32 v103, v4
  v_cndmask_b32 v108, v4, v108, s[68:69]
  v_cndmask_b32 v109, v4, v109, s[70:71]
  v_cndmask_b32 v110, v4, v110, s[72:73]
  v_cndmask_b32 v111, v4, v111, s[74:75]
fa_nomask0:
  v_max3_f32 v16, v96, v97, v98
  v_max3_f32 v16, v16, v99, v100
  v_max3_f32 v16, v16, v101, v102
  v_max_f32 v16, v16, v103
  v_max3_f32 v17, v104, v105, v106
  v_max3_f32 v17, v17, v107, v108
  v_max3_f32 v17, v17, v109, v110
  v_max_f32 v17, v17, v111
  v_max3_f32 v18, v128, v129, v130
  v_max3_f32 v18, v18, v131, v132
  v_max3_f32 v18, v18, v133, v134
  v_max_f32 v18, v18, v135
  v_max3_f32 v19, v136, v137, v138
  v_max3_f32 v19, v19, v139, v140
  v_max3_f32 v19, v19, v141, v142
  v_max_f32 v19, v19, v143
  v_mov_b32 v20, v16
  v_mov_b32 v21, v17
  v_mov_b32 v22, v18
  v_mov_b32 v23, v19
  s_nop 0
  v_permlane16_swap_b32 v16, v20
  v_permlane16_swap_b32 v17, v21
  v_permlane16_swap_b32 v18, v22
  v_permlane16_swap_b32 v19, v23
  v_max_f32 v16, v16, v20
  v_max_f32 v17, v17, v21
  v_max_f32 v18, v18, v22
  v_max_f32 v19, v19, v23
  v_mov_b32 v20, v16
  v_mov_b32 v21, v17
  v_mov_b32 v22, v18
  v_mov_b32 v23, v19
  s_nop 0
  v_permlane32_swap_b32 v16, v20
  v_permlane32_swap_b32 v17, v21
  v_permlane32_swap_b32 v18, v22
  v_permlane32_swap_b32 v19, v23
  v_max_f32 v16, v16, v20
  v_max_f32 v17, v17, v21
  v_max_f32 v18, v18, v22
  v_max_f32 v19, v19, v23
  v_sub_f32 v192, 0, v16
  v_sub_f32 v193, 0, v16
  v_sub_f32 v194, 0, v16
  v_sub_f32 v195, 0, v16
  v_sub_f32 v196, 0, v17
  v_sub_f32 v197, 0, v17
  v_sub_f32 v198, 0, v17
  v_sub_f32 v199, 0, v17
  v_sub_f32 v200, 0, v18
  v_sub_f32 v201, 0, v18
  v_sub_f32 v202, 0, v18
  v_sub_f32 v203, 0, v18
  v_sub_f32 v204, 0, v19
  v_sub_f32 v205, 0, v19
  v_sub_f32 v206, 0, v19
  v_sub_f32 v207, 0, v19
  v_sub_f32 v96, v96, v16
  v_sub_f32 v97, v97, v16
  v_sub_f32 v98, v98, v16
  v_sub_f32 v99, v99, v16
  v_sub_f32 v100, v100, v16
  v_sub_f32 v101, v101, v16
  v_sub_f32 v102, v102, v16
  v_sub_f32 v103, v103, v16
  v_sub_f32 v104, v104, v17
  v_sub_f32 v105, v105, v17
  v_sub_f32 v106, v106, v17
  v_sub_f32 v107, v107, v17
  v_sub_f32 v108, v108, v17
  v_sub_f32 v109, v109, v17
  v_sub_f32 v110, v110, v17
  v_sub_f32 v111, v111, v17
  v_sub_f32 v128, v128, v18
  v_sub_f32 v129, v129, v18
  v_sub_f32 v130, v130, v18
  v_sub_f32 v131, v131, v18
  v_sub_f32 v132, v132, v18
  v_sub_f32 v133, v133, v18
  v_sub_f32 v134, v134, v18
  v_sub_f32 v135, v135, v18
  v_sub_f32 v136, v136, v19
  v_sub_f32 v137, v137, v19
  v_sub_f32 v138, v138, v19
  v_sub_f32 v139, v139, v19
  v_sub_f32 v140, v140, v19
  v_sub_f32 v141, v141, v19
  v_sub_f32 v142, v142, v19
  v_sub_f32 v143, v143, v19
  v_mfma_f32_16x16x32_bf16 v[112:115], a[128:131], v[32:35], v[192:195]
  v_exp_f32 v208, v96
  v_exp_f32 v209, v97
  v_mfma_f32_16x16x32_bf16 v[120:123], a[128:131], v[36:39], v[196:199]
  v_exp_f32 v210, v98
  v_exp_f32 v211, v99
  v_mfma_f32_16x16x32_bf16 v[144:147], a[128:131], v[64:67], v[200:203]
  v_exp_f32 v212, v100
  v_exp_f32 v213, v101
  v_mfma_f32_16x16x32_bf16 v[152:155], a[128:131], v[68:71], v[204:207]
  s_mov_b32 m0, s25
  ds_read_b128 a[128:131], v3 offset:8192
  v_exp_f32 v214, v102
  v_add_f32 v224, v208, v209
  v_mfma_f32_16x16x32_bf16 v[116:119], a[132:135], v[32:35], v[192:195]
  buffer_load_dwordx4 v2, s[48:51], s27 offen offset:0 sc1 lds
  v_exp_f32 v215, v103
  v_cvt_pk_bf16_f32 v160, v208, v209
  v_mfma_f32_16x16x32_bf16 v[124:127], a[132:135], v[36:39], v[196:199]
  v_exp_f32 v208, v104
  v_add_f32 v224, v224, v210
  v_add_f32 v224, v224, v211
  v_mfma_f32_16x16x32_bf16 v[148:151], a[132:135], v[64:67], v[200:203]
  v_exp_f32 v209, v105
  v_cvt_pk_bf16_f32 v161, v210, v211
  v_add_f32 v224, v224, v212
  v_mfma_f32_16x16x32_bf16 v[156:159], a[132:135], v[68:71], v[204:207]
  ds_read_b128 a[132:135], v3 offset:9216
  v_exp_f32 v210, v106
  v_mfma_f32_16x16x32_bf16 v[112:115], a[136:139], v[40:43], v[112:115]
  v_exp_f32 v211, v107
  v_add_f32 v224, v224, v213
  v_cvt_pk_bf16_f32 v162, v212, v213
  v_mfma_f32_16x16x32_bf16 v[120:123], a[136:139], v[44:47], v[120:123]
  v_exp_f32 v212, v108
  v_add_f32 v224, v224, v214
  v_add_f32 v224, v224, v215
  v_mfma_f32_16x16x32_bf16 v[144:147], a[136:139], v[72:75], v[144:147]
  buffer_load_dwordx4 v2, s[48:51], s27 offen offset:1024 sc1 lds
  v_exp_f32 v213, v109
  v_cvt_pk_bf16_f32 v163, v214, v215
  v_mfma_f32_16x16x32_bf16 v[152:155], a[136:139], v[76:79], v[152:155]
  ds_read_b128 a[136:139], v3 offset:10240
  v_exp_f32 v214, v110
  v_add_f32 v225, v208, v209
  v_mfma_f32_16x16x32_bf16 v[116:119], a[140:143], v[40:43], v[116:119]
  v_exp_f32 v215, v111
  v_exp_f32 v216, v128
  v_mfma_f32_16x16x32_bf16 v[124:127], a[140:143], v[44:47], v[124:127]
  v_exp_f32 v217, v129
  v_exp_f32 v218, v130
  v_mfma_f32_16x16x32_bf16 v[148:151], a[140:143], v[72:75], v[148:151]
  v_exp_f32 v219, v131
  v_exp_f32 v220, v132
  v_mfma_f32_16x16x32_bf16 v[156:159], a[140:143], v[76:79], v[156:159]
  s_waitcnt lgkmcnt(3)
  ds_read_b128 a[140:143], v3 offset:11264
  v_exp_f32 v221, v133
  v_cvt_pk_bf16_f32 v164, v208, v209
  v_mfma_f32_16x16x32_bf16 v[112:115], a[144:147], v[48:51], v[112:115]
  v_exp_f32 v222, v134
  v_exp_f32 v223, v135
  v_mfma_f32_16x16x32_bf16 v[120:123], a[144:147], v[52:55], v[120:123]
  v_add_f32 v225, v225, v210
  v_add_f32 v225, v225, v211
  v_cvt_pk_bf16_f32 v165, v210, v211
  v_add_f32 v225, v225, v212
  v_mfma_f32_16x16x32_bf16 v[144:147], a[144:147], v[80:83], v[144:147]
  buffer_load_dwordx4 v2, s[48:51], s27 offen offset:2048 sc1 lds
  v_add_f32 v225, v225, v213
  v_cvt_pk_bf16_f32 v166, v212, v213
  v_add_f32 v225, v225, v214
  v_mfma_f32_16x16x32_bf16 v[152:155], a[144:147], v[84:87], v[152:155]
  ds_read_b128 a[144:147], v3 offset:12288
  v_add_f32 v225, v225, v215
  v_cvt_pk_bf16_f32 v167, v214, v215
  v_add_f32 v226, v216, v217
  v_mfma_f32_16x16x32_bf16 v[116:119], a[148:151], v[48:51], v[116:119]
  v_cvt_pk_bf16_f32 v176, v216, v217
  v_exp_f32 v216, v136
  v_add_f32 v226, v226, v218
  v_mfma_f32_16x16x32_bf16 v[124:127], a[148:151], v[52:55], v[124:127]
  v_exp_f32 v217, v137
  v_add_f32 v226, v226, v219
  v_cvt_pk_bf16_f32 v177, v218, v219
  v_mfma_f32_16x16x32_bf16 v[148:151], a[148:151], v[80:83], v[148:151]
  v_exp_f32 v218, v138
  v_add_f32 v226, v226, v220
  v_add_f32 v226, v226, v221
  v_mfma_f32_16x16x32_bf16 v[156:159], a[148:151], v[84:87], v[156:159]
  ds_read_b128 a[148:151], v3 offset:13312
  v_exp_f32 v219, v139
  v_mfma_f32_16x16x32_bf16 v[112:115], a[152:155], v[56:59], v[112:115]
  buffer_load_dwordx4 v2, s[48:51], s27 offen offset:3072 sc1 lds
  v_cvt_pk_bf16_f32 v178, v220, v221
  v_exp_f32 v220, v140
  v_mfma_f32_16x16x32_bf16 v[120:123], a[152:155], v[60:63], v[120:123]
  s_add_u32 s27, s27, 16384
  v_add_f32 v226, v226, v222
  v_add_f32 v226, v226, v223
  v_cvt_pk_bf16_f32 v179, v222, v223
  v_add_f32 v227, v216, v217
  v_mfma_f32_16x16x32_bf16 v[144:147], a[152:155], v[88:91], v[144:147]
  s_add_u32 s25, s25, 32768
  v_exp_f32 v221, v141
  v_cvt_pk_bf16_f32 v180, v216, v217
  v_add_f32 v227, v227, v218
  v_mfma_f32_16x16x32_bf16 v[152:155], a[152:155], v[92:95], v[152:155]
  s_and_b32 s25, s25, 0x1ffff
  ds_read_b128 a[152:155], v3 offset:14336
  v_add_f32 v227, v227, v219
  v_cvt_pk_bf16_f32 v181, v218, v219
  v_max3_f32 v5, v224, v225, v226
  v_mfma_f32_16x16x32_bf16 v[116:119], a[156:159], v[56:59], v[116:119]
  v_exp_f32 v222, v142
  v_add_f32 v227, v227, v220
  v_add_f32 v227, v227, v221
  v_mfma_f32_16x16x32_bf16 v[124:127], a[156:159], v[60:63], v[124:127]
  v_exp_f32 v223, v143
  v_cvt_pk_bf16_f32 v182, v220, v221
  v_add_f32 v227, v227, v222
  v_mfma_f32_16x16x32_bf16 v[148:151], a[156:159], v[88:91], v[148:151]
  v_add_f32 v227, v227, v223
  v_cvt_pk_bf16_f32 v183, v222, v223
  v_max_f32 v5, v5, v227
  v_cmp_lt_f32 vcc, s81, v5
  v_mfma_f32_16x16x32_bf16 v[156:159], a[156:159], v[92:95], v[156:159]
  s_waitcnt lgkmcnt(3)
  s_cbranch_vccnz fa_stub0
fa_back0:
  ds_read_b128 a[156:159], v3 offset:15360
  v_add_f32 v228, v228, v224
  v_add_f32 v229, v229, v225
  v_add_f32 v230, v230, v226
  v_add_f32 v231, v231, v227
  v_add_u32 v3, 32768, v3
  v_and_b32 v3, 0x1ffff, v3
  s_cmp_eq_u32 s28, 0
  s_cbranch_scc1 fa_AV
  s_sub_u32 s28, s28, 1
  s_cmp_eq_u32 s28, 0
  s_cbranch_scc1 fa_Aexit
.p2align 6
fa_DD:
  v_mfma_f32_16x16x32_bf16 v[96:99], a[128:131], v[32:35], v[192:195]
  s_waitcnt vmcnt(12)
  v_exp_f32 v208, v112
  v_mfma_f32_16x16x32_bf16 v[104:107], a[128:131], v[36:39], v[196:199]
  s_barrier
  v_exp_f32 v209, v113
  v_mfma_f32_16x16x32_bf16 v[128:131], a[128:131], v[64:67], v[200:203]
  s_cmp_ge_u32 s26, s32
  ds_read_b128 a[160:163], v3 offset:16384
  v_add_f32 v224, v208, v209
  v_mfma_f32_16x16x32_bf16 v[136:139], a[128:131], v[68:71], v[204:207]
  s_cbranch_scc1 fa_hk0
fa_hb0:
  v_exp_f32 v210, v114
  v_mfma_f32_16x16x32_bf16 v[100:103], a[132:135], v[32:35], v[192:195]
  ds_read_b128 a[164:167], v3 offset:17408
  v_cvt_pk_bf16_f32 v168, v208, v209
  v_mfma_f32_16x16x32_bf16 v[108:111], a[132:135], v[36:39], v[196:199]
  s_mov_b32 m0, s24
  v_exp_f32 v211, v115
  v_mfma_f32_16x16x32_bf16 v[132:135], a[132:135], v[64:67], v[200:203]
  buffer_load_dwordx4 v2, s[44:47], s26 offen offset:0 sc1 lds
  v_add_f32 v224, v224, v210
  v_add_f32 v224, v224, v211
  v_mfma_f32_16x16x32_bf16 v[140:143], a[132:135], v[68:71], v[204:207]
  v_exp_f32 v212, v116
  v_mfma_f32_16x16x32_bf16 v[96:99], a[136:139], v[40:43], v[96:99]
  ds_read_b128 a[168:171], v3 offset:18432
  v_cvt_pk_bf16_f32 v169, v210, v211
  v_mfma_f32_16x16x32_bf16 v[104:107], a[136:139], v[44:47], v[104:107]
  v_exp_f32 v213, v117
  v_mfma_f32_16x16x32_bf16 v[128:131], a[136:139], v[72:75], v[128:131]
  v_exp_f32 v214, v118
  v_mfma_f32_16x16x32_bf16 v[136:139], a[136:139], v[76:79], v[136:139]
  v_exp_f32 v215, v119
  v_mfma_f32_16x16x32_bf16 v[100:103], a[140:143], v[40:43], v[100:103]
  ds_read_b128 a[172:175], v3 offset:19456
  v_add_f32 v224, v224, v212
  v_mfma_f32_16x16x32_bf16 v[108:111], a[140:143], v[44:47], v[108:111]
  v_exp_f32 v208, v120
  v_mfma_f32_16x16x32_bf16 v[132:135], a[140:143], v[72:75], v[132:135]
  v_exp_f32 v209, v121
  v_mfma_f32_16x16x32_bf16 v[140:143], a[140:143], v[76:79], v[140:143]
  s_waitcnt lgkmcnt(4)
  v_exp_f32 v210, v122
  v_mfma_f32_16x16x32_bf16 v[96:99], a[144:147], v[48:51], v[96:99]
  ds_read_b128 a[176:179], v3 offset:20480
  v_add_f32 v224, v224, v213
  v_mfma_f32_16x16x32_bf16 v[104:107], a[144:147], v[52:55], v[104:107]
  v_exp_f32 v211, v123
  v_mfma_f32_16x16x32_bf16 v[128:131], a[144:147], v[80:83], v[128:131]
  v_cvt_pk_bf16_f32 v170, v212, v213
  v_add_f32 v224, v224, v214
  v_add_f32 v224, v224, v215
  v_mfma_f32_16x16x32_bf16 v[136:139], a[144:147], v[84:87], v[136:139]
  v_exp_f32 v212, v124
  v_mfma_f32_16x16x32_bf16 v[100:103], a[148:151], v[48:51], v[100:103]
  ds_read_b128 a[180:183], v3 offset:21504
  v_cvt_pk_bf16_f32 v171, v214, v215
  v_mfma_f32_16x16x32_bf16 v[108:111], a[148:151], v[52:55], v[108:111]
  v_exp_f32 v213, v125
  v_mfma_f32_16x16x32_bf16 v[132:135], a[148:151], v[80:83], v[132:135]
  buffer_load_dwordx4 v2, s[44:47], s26 offen offset:1024 sc1 lds
  v_add_f32 v225, v208, v209
  v_mfma_f32_16x16x32_bf16 v[140:143], a[148:151], v[84:87], v[140:143]
  v_exp_f32 v214, v126
  v_mfma_f32_16x16x32_bf16 v[96:99], a[152:155], v[56:59], v[96:99]
  ds_read_b128 a[184:187], v3 offset:22528
  v_cvt_pk_bf16_f32 v172, v208, v209
  v_mfma_f32_16x16x32_bf16 v[104:107], a[152:155], v[60:63], v[104:107]
  v_exp_f32 v215, v127
  v_mfma_f32_16x16x32_bf16 v[128:131], a[152:155], v[88:91], v[128:131]
  v_exp_f32 v216, v144
  v_mfma_f32_16x16x32_bf16 v[136:139], a[152:155], v[92:95], v[136:139]
  v_exp_f32 v217, v145
  v_mfma_f32_16x16x32_bf16 v[100:103], a[156:159], v[56:59], v[100:103]
  ds_read_b128 a[188:191], v3 offset:23552
  v_add_f32 v225, v225, v210
  v_mfma_f32_16x16x32_bf16 v[108:111], a[156:159], v[60:63], v[108:111]
  v_exp_f32 v218, v146
  v_mfma_f32_16x16x32_bf16 v[132:135], a[156:159], v[88:91], v[132:135]
  v_exp_f32 v219, v147
  v_mfma_f32_16x16x32_bf16 v[140:143], a[156:159], v[92:95], v[140:143]
  s_waitcnt lgkmcnt(4)
  v_exp_f32 v220, v148
  v_add_f32 v225, v225, v211
  v_mfma_f32_16x16x32_bf16 a[0:3], a[160:163], v[160:163], a[0:3]
  ds_read_b128 a[128:131], v3 offset:0
  v_cvt_pk_bf16_f32 v173, v210, v211
  v_mfma_f32_16x16x32_bf16 a[4:7], a[160:163], v[164:167], a[4:7]
  v_exp_f32 v221, v149
  v_mfma_f32_16x16x32_bf16 a[64:67], a[160:163], v[176:179], a[64:67]
  v_exp_f32 v222, v150
  v_mfma_f32_16x16x32_bf16 a[68:71], a[160:163], v[180:183], a[68:71]
  v_exp_f32 v223, v151
  v_mfma_f32_16x16x32_bf16 a[8:11], a[164:167], v[160:163], a[8:11]
  ds_read_b128 a[132:135], v3 offset:1024
  v_add_f32 v225, v225, v212
  v_mfma_f32_16x16x32_bf16 a[12:15], a[164:167], v[164:167], a[12:15]
  v_add_f32 v225, v225, v213
  v_cvt_pk_bf16_f32 v174, v212, v213
  v_mfma_f32_16x16x32_bf16 a[72:75], a[164:167], v[176:179], a[72:75]
  buffer_load_dwordx4 v2, s[44:47], s26 offen offset:2048 sc1 lds
  v_add_f32 v225, v225, v214
  v_mfma_f32_16x16x32_bf16 a[76:79], a[164:167], v[180:183], a[76:79]
  v_add_f32 v225, v225, v215
  v_cvt_pk_bf16_f32 v175, v214, v215
  v_mfma_f32_16x16x32_bf16 a[16:19], a[168:171], v[160:163], a[16:19]
  ds_read_b128 a[136:139], v3 offset:2048
  v_add_f32 v226, v216, v217
  v_mfma_f32_16x16x32_bf16 a[20:23], a[168:171], v[164:167], a[20:23]
  v_cvt_pk_bf16_f32 v184, v216, v217
  v_add_f32 v226, v226, v218
  v_mfma_f32_16x16x32_bf16 a[80:83], a[168:171], v[176:179], a[80:83]
  v_exp_f32 v216, v152
  v_mfma_f32_16x16x32_bf16 a[84:87], a[168:171], v[180:183], a[84:87]
  v_exp_f32 v217, v153
  v_mfma_f32_16x16x32_bf16 a[24:27], a[172:175], v[160:163], a[24:27]
  ds_read_b128 a[140:143], v3 offset:3072
  v_add_f32 v226, v226, v219
  v_cvt_pk_bf16_f32 v185, v218, v219
  v_mfma_f32_16x16x32_bf16 a[28:31], a[172:175], v[164:167], a[28:31]
  v_exp_f32 v218, v154
  v_mfma_f32_16x16x32_bf16 a[88:91], a[172:175], v[176:179], a[88:91]
  v_add_f32 v226, v226, v220
  v_add_f32 v226, v226, v221
  v_mfma_f32_16x16x32_bf16 a[92:95], a[172:175], v[180:183], a[92:95]
  s_waitcnt lgkmcnt(4)
  v_exp_f32 v219, v155
  v_mfma_f32_16x16x32_bf16 a[32:35], a[176:179], v[160:163], a[32:35]
  ds_read_b128 a[144:147], v3 offset:4096
  v_cvt_pk_bf16_f32 v186, v220, v221
  v_mfma_f32_16x16x32_bf16 a[36:39], a[176:179], v[164:167], a[36:39]
  v_exp_f32 v220, v156
  v_mfma_f32_16x16x32_bf16 a[96:99], a[176:179], v[176:179], a[96:99]
  v_add_f32 v226, v226, v222
  v_add_f32 v226, v226, v223
  v_mfma_f32_16x16x32_bf16 a[100:103], a[176:179], v[180:183], a[100:103]
  v_exp_f32 v221, v157
  v_mfma_f32_16x16x32_bf16 a[40:43], a[180:183], v[160:163], a[40:43]
  ds_read_b128 a[148:151], v3 offset:5120
  v_cvt_pk_bf16_f32 v187, v222, v223
  v_mfma_f32_16x16x32_bf16 a[44:47], a[180:183], v[164:167], a[44:47]
  v_exp_f32 v222, v158
  v_mfma_f32_16x16x32_bf16 a[104:107], a[180:183], v[176:179], a[104:107]
  buffer_load_dwordx4 v2, s[44:47], s26 offen offset:3072 sc1 lds
  v_add_f32 v227, v216, v217
  v_mfma_f32_16x16x32_bf16 a[108:111], a[180:183], v[180:183], a[108:111]
  s_add_u32 s26, s26, 16384
  v_exp_f32 v223, v159
  v_mfma_f32_16x16x32_bf16 a[48:51], a[184:187], v[160:163], a[48:51]
  s_add_u32 s24, s24, 32768
  ds_read_b128 a[152:155], v3 offset:6144
  v_cvt_pk_bf16_f32 v188, v216, v217
  v_add_f32 v227, v227, v218
  v_mfma_f32_16x16x32_bf16 a[52:55], a[184:187], v[164:167], a[52:55]
  s_and_b32 s24, s24, 0x1ffff
  v_add_f32 v227, v227, v219
  v_cvt_pk_bf16_f32 v189, v218, v219
  v_mfma_f32_16x16x32_bf16 a[112:115], a[184:187], v[176:179], a[112:115]
  v_max3_f32 v5, v224, v225, v226
  v_add_f32 v227, v227, v220
  v_mfma_f32_16x16x32_bf16 a[116:119], a[184:187], v[180:183], a[116:119]
  v_add_f32 v227, v227, v221
  v_cvt_pk_bf16_f32 v190, v220, v221
  v_mfma_f32_16x16x32_bf16 a[56:59], a[188:191], v[160:163], a[56:59]
  ds_read_b128 a[156:159], v3 offset:7168
  v_add_f32 v227, v227, v222
  v_mfma_f32_16x16x32_bf16 a[60:63], a[188:191], v[164:167], a[60:63]
  v_add_f32 v227, v227, v223
  v_cvt_pk_bf16_f32 v191, v222, v223
  v_mfma_f32_16x16x32_bf16 a[120:123], a[188:191], v[176:179], a[120:123]
  s_waitcnt lgkmcnt(4)
  v_max_f32 v5, v5, v227
  v_cmp_lt_f32 vcc, s81, v5
  v_mfma_f32_16x16x32_bf16 a[124:127], a[188:191], v[180:183], a[124:127]
  s_cbranch_vccnz fa_stub1
fa_back1:
  v_add_f32 v228, v228, v224
  v_add_f32 v229, v229, v225
  v_add_f32 v230, v230, v226
  v_add_f32 v231, v231, v227
  v_mfma_f32_16x16x32_bf16 v[112:115], a[128:131], v[32:35], v[192:195]
  ds_read_b128 a[160:163], v3 offset:24576
  v_exp_f32 v208, v96
  v_mfma_f32_16x16x32_bf16 v[120:123], a[128:131], v[36:39], v[196:199]
  v_exp_f32 v209, v97
  v_mfma_f32_16x16x32_bf16 v[144:147], a[128:131], v[64:67], v[200:203]
  s_cmp_ge_u32 s26, s32
  v_exp_f32 v210, v98
  v_mfma_f32_16x16x32_bf16 v[152:155], a[128:131], v[68:71], v[204:207]
  s_cbranch_scc1 fa_hk1
fa_hb1:
  v_exp_f32 v211, v99
  v_mfma_f32_16x16x32_bf16 v[116:119], a[132:135], v[32:35], v[192:195]
  ds_read_b128 a[164:167], v3 offset:25600
  v_mfma_f32_16x16x32_bf16 v[124:127], a[132:135], v[36:39], v[196:199]
  s_mov_b32 m0, s25
  v_exp_f32 v212, v100
  v_mfma_f32_16x16x32_bf16 v[148:151], a[132:135], v[64:67], v[200:203]
  buffer_load_dwordx4 v2, s[48:51], s27 offen offset:0 sc1 lds
  v_add_f32 v224, v208, v209
  v_cvt_pk_bf16_f32 v160, v208, v209
  v_mfma_f32_16x16x32_bf16 v[156:159], a[132:135], v[68:71], v[204:207]
  v_exp_f32 v213, v101
  v_mfma_f32_16x16x32_bf16 v[112:115], a[136:139], v[40:43], v[112:115]
  ds_read_b128 a[168:171], v3 offset:26624
  v_add_f32 v224, v224, v210
  v_mfma_f32_16x16x32_bf16 v[120:123], a[136:139], v[44:47], v[120:123]
  v_exp_f32 v214, v102
  v_mfma_f32_16x16x32_bf16 v[144:147], a[136:139], v[72:75], v[144:147]
  v_exp_f32 v215, v103
  v_mfma_f32_16x16x32_bf16 v[152:155], a[136:139], v[76:79], v[152:155]
  v_exp_f32 v208, v104
  v_mfma_f32_16x16x32_bf16 v[116:119], a[140:143], v[40:43], v[116:119]
  ds_read_b128 a[172:175], v3 offset:27648
  v_add_f32 v224, v224, v211
  v_mfma_f32_16x16x32_bf16 v[124:127], a[140:143], v[44:47], v[124:127]
  v_exp_f32 v209, v105
  v_mfma_f32_16x16x32_bf16 v[148:151], a[140:143], v[72:75], v[148:151]
  v_cvt_pk_bf16_f32 v161, v210, v211
  v_add_f32 v224, v224, v212
  v_mfma_f32_16x16x32_bf16 v[156:159], a[140:143], v[76:79], v[156:159]
  s_waitcnt lgkmcnt(4)
  v_exp_f32 v210, v106
  v_mfma_f32_16x16x32_bf16 v[112:115], a[144:147], v[48:51], v[112:115]
  ds_read_b128 a[176:179], v3 offset:28672
  v_add_f32 v224, v224, v213
  v_mfma_f32_16x16x32_bf16 v[120:123], a[144:147], v[52:55], v[120:123]
  v_exp_f32 v211, v107
  v_mfma_f32_16x16x32_bf16 v[144:147], a[144:147], v[80:83], v[144:147]
  v_cvt_pk_bf16_f32 v162, v212, v213
  v_add_f32 v224, v224, v214
  v_add_f32 v224, v224, v215
  v_mfma_f32_16x16x32_bf16 v[152:155], a[144:147], v[84:87], v[152:155]
  v_exp_f32 v212, v108
  v_mfma_f32_16x16x32_bf16 v[116:119], a[148:151], v[48:51], v[116:119]
  ds_read_b128 a[180:183], v3 offset:29696
  v_cvt_pk_bf16_f32 v163, v214, v215
  v_mfma_f32_16x16x32_bf16 v[124:127], a[148:151], v[52:55], v[124:127]
  v_exp_f32 v213, v109
  v_mfma_f32_16x16x32_bf16 v[148:151], a[148:151], v[80:83], v[148:151]
  buffer_load_dwordx4 v2, s[48:51], s27 offen offset:1024 sc1 lds
  v_add_f32 v225, v208, v209
  v_mfma_f32_16x16x32_bf16 v[156:159], a[148:151], v[84:87], v[156:159]
  v_exp_f32 v214, v110
  v_mfma_f32_16x16x32_bf16 v[112:115], a[152:155], v[56:59], v[112:115]
  ds_read_b128 a[184:187], v3 offset:30720
  v_cvt_pk_bf16_f32 v164, v208, v209
  v_mfma_f32_16x16x32_bf16 v[120:123], a[152:155], v[60:63], v[120:123]
  v_exp_f32 v215, v111
  v_mfma_f32_16x16x32_bf16 v[144:147], a[152:155], v[88:91], v[144:147]
  v_exp_f32 v216, v128
  v_mfma_f32_16x16x32_bf16 v[152:155], a[152:155], v[92:95], v[152:155]
  v_exp_f32 v217, v129
  v_mfma_f32_16x16x32_bf16 v[116:119], a[156:159], v[56:59], v[116:119]
  ds_read_b128 a[188:191], v3 offset:31744
  v_add_f32 v225, v225, v210
  v_mfma_f32_16x16x32_bf16 v[124:127], a[156:159], v[60:63], v[124:127]
  v_exp_f32 v218, v130
  v_mfma_f32_16x16x32_bf16 v[148:151], a[156:159], v[88:91], v[148:151]
  v_exp_f32 v219, v131
  v_mfma_f32_16x16x32_bf16 v[156:159], a[156:159], v[92:95], v[156:159]
  s_waitcnt lgkmcnt(4)
  v_exp_f32 v220, v132
  v_add_f32 v225, v225, v211
  v_mfma_f32_16x16x32_bf16 a[0:3], a[160:163], v[168:171], a[0:3]
  ds_read_b128 a[128:131], v3 offset:8192
  v_cvt_pk_bf16_f32 v165, v210, v211
  v_mfma_f32_16x16x32_bf16 a[4:7], a[160:163], v[172:175], a[4:7]
  v_exp_f32 v221, v133
  v_mfma_f32_16x16x32_bf16 a[64:67], a[160:163], v[184:187], a[64:67]
  v_exp_f32 v222, v134
  v_mfma_f32_16x16x32_bf16 a[68:71], a[160:163], v[188:191], a[68:71]
  v_exp_f32 v223, v135
  v_mfma_f32_16x16x32_bf16 a[8:11], a[164:167], v[168:171], a[8:11]
  ds_read_b128 a[132:135], v3 offset:9216
  v_add_f32 v225, v225, v212
  v_mfma_f32_16x16x32_bf16 a[12:15], a[164:167], v[172:175], a[12:15]
  v_add_f32 v225, v225, v213
  v_cvt_pk_bf16_f32 v166, v212, v213
  v_mfma_f32_16x16x32_bf16 a[72:75], a[164:167], v[184:187], a[72:75]
  buffer_load_dwordx4 v2, s[48:51], s27 offen offset:2048 sc1 lds
  v_add_f32 v225, v225, v214
  v_mfma_f32_16x16x32_bf16 a[76:79], a[164:167], v[188:191], a[76:79]
  v_add_f32 v225, v225, v215
  v_cvt_pk_bf16_f32 v167, v214, v215
  v_mfma_f32_16x16x32_bf16 a[16:19], a[168:171], v[168:171], a[16:19]
  ds_read_b128 a[136:139], v3 offset:10240
  v_add_f32 v226, v216, v217
  v_mfma_f32_16x16x32_bf16 a[20:23], a[168:171], v[172:175], a[20:23]
  v_cvt_pk_bf16_f32 v176, v216, v217
  v_add_f32 v226, v226, v218
  v_mfma_f32_16x16x32_bf16 a[80:83], a[168:171], v[184:187], a[80:83]
  v_exp_f32 v216, v136
  v_mfma_f32_16x16x32_bf16 a[84:87], a[168:171], v[188:191], a[84:87]
  v_exp_f32 v217, v137
  v_mfma_f32_16x16x32_bf16 a[24:27], a[172:175], v[168:171], a[24:27]
  ds_read_b128 a[140:143], v3 offset:11264
  v_add_f32 v226, v226, v219
  v_cvt_pk_bf16_f32 v177, v218, v219
  v_mfma_f32_16x16x32_bf16 a[28:31], a[172:175], v[172:175], a[28:31]
  v_exp_f32 v218, v138
  v_mfma_f32_16x16x32_bf16 a[88:91], a[172:175], v[184:187], a[88:91]
  v_add_f32 v226, v226, v220
  v_add_f32 v226, v226, v221
  v_mfma_f32_16x16x32_bf16 a[92:95], a[172:175], v[188:191], a[92:95]
  s_waitcnt lgkmcnt(4)
  v_exp_f32 v219, v139
  v_mfma_f32_16x16x32_bf16 a[32:35], a[176:179], v[168:171], a[32:35]
  ds_read_b128 a[144:147], v3 offset:12288
  v_cvt_pk_bf16_f32 v178, v220, v221
  v_mfma_f32_16x16x32_bf16 a[36:39], a[176:179], v[172:175], a[36:39]
  v_exp_f32 v220, v140
  v_mfma_f32_16x16x32_bf16 a[96:99], a[176:179], v[184:187], a[96:99]
  v_add_f32 v226, v226, v222
  v_add_f32 v226, v226, v223
  v_mfma_f32_16x16x32_bf16 a[100:103], a[176:179], v[188:191], a[100:103]
  v_exp_f32 v221, v141
  v_mfma_f32_16x16x32_bf16 a[40:43], a[180:183], v[168:171], a[40:43]
  ds_read_b128 a[148:151], v3 offset:13312
  v_cvt_pk_bf16_f32 v179, v222, v223
  v_mfma_f32_16x16x32_bf16 a[44:47], a[180:183], v[172:175], a[44:47]
  v_exp_f32 v222, v142
  v_mfma_f32_16x16x32_bf16 a[104:107], a[180:183], v[184:187], a[104:107]
  buffer_load_dwordx4 v2, s[48:51], s27 offen offset:3072 sc1 lds
  v_add_f32 v227, v216, v217
  v_mfma_f32_16x16x32_bf16 a[108:111], a[180:183], v[188:191], a[108:111]
  s_add_u32 s27, s27, 16384
  v_exp_f32 v223, v143
  v_mfma_f32_16x16x32_bf16 a[48:51], a[184:187], v[168:171], a[48:51]
  s_add_u32 s25, s25, 32768
  ds_read_b128 a[152:155], v3 offset:14336
  v_cvt_pk_bf16_f32 v180, v216, v217
  v_add_f32 v227, v227, v218
  v_mfma_f32_16x16x32_bf16 a[52:55], a[184:187], v[172:175], a[52:55]
  s_and_b32 s25, s25, 0x1ffff
  v_add_f32 v227, v227, v219
  v_cvt_pk_bf16_f32 v181, v218, v219
  v_mfma_f32_16x16x32_bf16 a[112:115], a[184:187], v[184:187], a[112:115]
  v_max3_f32 v5, v224, v225, v226
  v_add_f32 v227, v227, v220
  v_mfma_f32_16x16x32_bf16 a[116:119], a[184:187], v[188:191], a[116:119]
  v_add_f32 v227, v227, v221
  v_cvt_pk_bf16_f32 v182, v220, v221
  v_mfma_f32_16x16x32_bf16 a[56:59], a[188:191], v[168:171], a[56:59]
  ds_read_b128 a[156:159], v3 offset:15360
  v_add_f32 v227, v227, v222
  v_mfma_f32_16x16x32_bf16 a[60:63], a[188:191], v[172:175], a[60:63]
  s_sub_u32 s28, s28, 1
  v_add_f32 v227, v227, v223
  v_cvt_pk_bf16_f32 v183, v222, v223
  v_mfma_f32_16x16x32_bf16 a[120:123], a[188:191], v[184:187], a[120:123]
  s_waitcnt lgkmcnt(4)
  v_max_f32 v5, v5, v227
  v_cmp_lt_f32 vcc, s81, v5
  v_mfma_f32_16x16x32_bf16 a[124:127], a[188:191], v[188:191], a[124:127]
  s_cbranch_vccnz fa_stub2
fa_back2:
  v_add_f32 v228, v228, v224
  v_add_f32 v229, v229, v225
  v_add_f32 v230, v230, v226
  v_add_f32 v231, v231, v227
  v_add_u32 v3, 32768, v3
  v_and_b32 v3, 0x1ffff, v3
  s_cmp_lg_u32 s28, 0
  s_cbranch_scc1 fa_DD
fa_Aexit:
  s_bitcmp1_b32 s20, 0
  s_cbranch_scc1 fa_Aodd
  v_mfma_f32_16x16x32_bf16 v[96:99], a[128:131], v[32:35], v[192:195]
  s_waitcnt vmcnt(12)
  v_exp_f32 v208, v112
  v_mfma_f32_16x16x32_bf16 v[104:107], a[128:131], v[36:39], v[196:199]
  s_barrier
  v_exp_f32 v209, v113
  v_mfma_f32_16x16x32_bf16 v[128:131], a[128:131], v[64:67], v[200:203]
  ds_read_b128 a[160:163], v3 offset:16384
  v_add_f32 v224, v208, v209
  v_mfma_f32_16x16x32_bf16 v[136:139], a[128:131], v[68:71], v[204:207]
  v_exp_f32 v210, v114
  v_mfma_f32_16x16x32_bf16 v[100:103], a[132:135], v[32:35], v[192:195]
  ds_read_b128 a[164:167], v3 offset:17408
  v_cvt_pk_bf16_f32 v168, v208, v209
  v_mfma_f32_16x16x32_bf16 v[108:111], a[132:135], v[36:39], v[196:199]
  s_mov_b32 m0, s24
  v_exp_f32 v211, v115
  v_mfma_f32_16x16x32_bf16 v[132:135], a[132:135], v[64:67], v[200:203]
  buffer_load_dwordx4 v2, s[44:47], s26 offen offset:0 sc1 lds
  v_add_f32 v224, v224, v210
  v_add_f32 v224, v224, v211
  v_mfma_f32_16x16x32_bf16 v[140:143], a[132:135], v[68:71], v[204:207]
  v_exp_f32 v212, v116
  v_mfma_f32_16x16x32_bf16 v[96:99], a[136:139], v[40:43], v[96:99]
  ds_read_b128 a[168:171], v3 offset:18432
  v_cvt_pk_bf16_f32 v169, v210, v211
  v_mfma_f32_16x16x32_bf16 v[104:107], a[136:139], v[44:47], v[104:107]
  v_exp_f32 v213, v117
  v_mfma_f32_16x16x32_bf16 v[128:131], a[136:139], v[72:75], v[128:131]
  v_exp_f32 v214, v118
  v_mfma_f32_16x16x32_bf16 v[136:139], a[136:139], v[76:79], v[136:139]
  v_exp_f32 v215, v119
  v_mfma_f32_16x16x32_bf16 v[100:103], a[140:143], v[40:43], v[100:103]
  ds_read_b128 a[172:175], v3 offset:19456
  v_add_f32 v224, v224, v212
  v_mfma_f32_16x16x32_bf16 v[108:111], a[140:143], v[44:47], v[108:111]
  v_exp_f32 v208, v120
  v_mfma_f32_16x16x32_bf16 v[132:135], a[140:143], v[72:75], v[132:135]
  v_exp_f32 v209, v121
  v_mfma_f32_16x16x32_bf16 v[140:143], a[140:143], v[76:79], v[140:143]
  s_waitcnt lgkmcnt(4)
  v_exp_f32 v210, v122
  v_mfma_f32_16x16x32_bf16 v[96:99], a[144:147], v[48:51], v[96:99]
  ds_read_b128 a[176:179], v3 offset:20480
  v_add_f32 v224, v224, v213
  v_mfma_f32_16x16x32_bf16 v[104:107], a[144:147], v[52:55], v[104:107]
  v_exp_f32 v211, v123
  v_mfma_f32_16x16x32_bf16 v[128:131], a[144:147], v[80:83], v[128:131]
  v_cvt_pk_bf16_f32 v170, v212, v213
  v_add_f32 v224, v224, v214
  v_add_f32 v224, v224, v215
  v_mfma_f32_16x16x32_bf16 v[136:139], a[144:147], v[84:87], v[136:139]
  v_exp_f32 v212, v124
  v_mfma_f32_16x16x32_bf16 v[100:103], a[148:151], v[48:51], v[100:103]
  ds_read_b128 a[180:183], v3 offset:21504
  v_cvt_pk_bf16_f32 v171, v214, v215
  v_mfma_f32_16x16x32_bf16 v[108:111], a[148:151], v[52:55], v[108:111]
  v_exp_f32 v213, v125
  v_mfma_f32_16x16x32_bf16 v[132:135], a[148:151], v[80:83], v[132:135]
  buffer_load_dwordx4 v2, s[44:47], s26 offen offset:1024 sc1 lds
  v_add_f32 v225, v208, v209
  v_mfma_f32_16x16x32_bf16 v[140:143], a[148:151], v[84:87], v[140:143]
  v_exp_f32 v214, v126
  v_mfma_f32_16x16x32_bf16 v[96:99], a[152:155], v[56:59], v[96:99]
  ds_read_b128 a[184:187], v3 offset:22528
  v_cvt_pk_bf16_f32 v172, v208, v209
  v_mfma_f32_16x16x32_bf16 v[104:107], a[152:155], v[60:63], v[104:107]
  v_exp_f32 v215, v127
  v_mfma_f32_16x16x32_bf16 v[128:131], a[152:155], v[88:91], v[128:131]
  v_exp_f32 v216, v144
  v_mfma_f32_16x16x32_bf16 v[136:139], a[152:155], v[92:95], v[136:139]
  v_exp_f32 v217, v145
  v_mfma_f32_16x16x32_bf16 v[100:103], a[156:159], v[56:59], v[100:103]
  ds_read_b128 a[188:191], v3 offset:23552
  v_add_f32 v225, v225, v210
  v_mfma_f32_16x16x32_bf16 v[108:111], a[156:159], v[60:63], v[108:111]
  v_exp_f32 v218, v146
  v_mfma_f32_16x16x32_bf16 v[132:135], a[156:159], v[88:91], v[132:135]
  v_exp_f32 v219, v147
  v_mfma_f32_16x16x32_bf16 v[140:143], a[156:159], v[92:95], v[140:143]
  s_waitcnt lgkmcnt(4)
  v_exp_f32 v220, v148
  v_add_f32 v225, v225, v211
  v_mfma_f32_16x16x32_bf16 a[0:3], a[160:163], v[160:163], a[0:3]
  ds_read_b128 a[128:131], v3 offset:0
  v_cvt_pk_bf16_f32 v173, v210, v211
  v_mfma_f32_16x16x32_bf16 a[4:7], a[160:163], v[164:167], a[4:7]
  v_exp_f32 v221, v149
  v_mfma_f32_16x16x32_bf16 a[64:67], a[160:163], v[176:179], a[64:67]
  v_exp_f32 v222, v150
  v_mfma_f32_16x16x32_bf16 a[68:71], a[160:163], v[180:183], a[68:71]
  v_exp_f32 v223, v151
  v_mfma_f32_16x16x32_bf16 a[8:11], a[164:167], v[160:163], a[8:11]
  ds_read_b128 a[132:135], v3 offset:1024
  v_add_f32 v225, v225, v212
  v_mfma_f32_16x16x32_bf16 a[12:15], a[164:167], v[164:167], a[12:15]
  v_add_f32 v225, v225, v213
  v_cvt_pk_bf16_f32 v174, v212, v213
  v_mfma_f32_16x16x32_bf16 a[72:75], a[164:167], v[176:179], a[72:75]
  buffer_load_dwordx4 v2, s[44:47], s26 offen offset:2048 sc1 lds
  v_add_f32 v225, v225, v214
  v_mfma_f32_16x16x32_bf16 a[76:79], a[164:167], v[180:183], a[76:79]
  v_add_f32 v225, v225, v215
  v_cvt_pk_bf16_f32 v175, v214, v215
  v_mfma_f32_16x16x32_bf16 a[16:19], a[168:171], v[160:163], a[16:19]
  ds_read_b128 a[136:139], v3 offset:2048
  v_add_f32 v226, v216, v217
  v_mfma_f32_16x16x32_bf16 a[20:23], a[168:171], v[164:167], a[20:23]
  v_cvt_pk_bf16_f32 v184, v216, v217
  v_add_f32 v226, v226, v218
  v_mfma_f32_16x16x32_bf16 a[80:83], a[168:171], v[176:179], a[80:83]
  v_exp_f32 v216, v152
  v_mfma_f32_16x16x32_bf16 a[84:87], a[168:171], v[180:183], a[84:87]
  v_exp_f32 v217, v153
  v_mfma_f32_16x16x32_bf16 a[24:27], a[172:175], v[160:163], a[24:27]
  ds_read_b128 a[140:143], v3 offset:3072
  v_add_f32 v226, v226, v219
  v_cvt_pk_bf16_f32 v185, v218, v219
  v_mfma_f32_16x16x32_bf16 a[28:31], a[172:175], v[164:167], a[28:31]
  v_exp_f32 v218, v154
  v_mfma_f32_16x16x32_bf16 a[88:91], a[172:175], v[176:179], a[88:91]
  v_add_f32 v226, v226, v220
  v_add_f32 v226, v226, v221
  v_mfma_f32_16x16x32_bf16 a[92:95], a[172:175], v[180:183], a[92:95]
  s_waitcnt lgkmcnt(4)
  v_exp_f32 v219, v155
  v_mfma_f32_16x16x32_bf16 a[32:35], a[176:179], v[160:163], a[32:35]
  ds_read_b128 a[144:147], v3 offset:4096
  v_cvt_pk_bf16_f32 v186, v220, v221
  v_mfma_f32_16x16x32_bf16 a[36:39], a[176:179], v[164:167], a[36:39]
  v_exp_f32 v220, v156
  v_mfma_f32_16x16x32_bf16 a[96:99], a[176:179], v[176:179], a[96:99]
  v_add_f32 v226, v226, v222
  v_add_f32 v226, v226, v223
  v_mfma_f32_16x16x32_bf16 a[100:103], a[176:179], v[180:183], a[100:103]
  v_exp_f32 v221, v157
  v_mfma_f32_16x16x32_bf16 a[40:43], a[180:183], v[160:163], a[40:43]
  ds_read_b128 a[148:151], v3 offset:5120
  v_cvt_pk_bf16_f32 v187, v222, v223
  v_mfma_f32_16x16x32_bf16 a[44:47], a[180:183], v[164:167], a[44:47]
  v_exp_f32 v222, v158
  v_mfma_f32_16x16x32_bf16 a[104:107], a[180:183], v[176:179], a[104:107]
  buffer_load_dwordx4 v2, s[44:47], s26 offen offset:3072 sc1 lds
  v_add_f32 v227, v216, v217
  v_mfma_f32_16x16x32_bf16 a[108:111], a[180:183], v[180:183], a[108:111]
  s_add_u32 s26, s26, 16384
  v_exp_f32 v223, v159
  v_mfma_f32_16x16x32_bf16 a[48:51], a[184:187], v[160:163], a[48:51]
  s_add_u32 s24, s24, 32768
  ds_read_b128 a[152:155], v3 offset:6144
  v_cvt_pk_bf16_f32 v188, v216, v217
  v_add_f32 v227, v227, v218
  v_mfma_f32_16x16x32_bf16 a[52:55], a[184:187], v[164:167], a[52:55]
  s_and_b32 s24, s24, 0x1ffff
  v_add_f32 v227, v227, v219
  v_cvt_pk_bf16_f32 v189, v218, v219
  v_mfma_f32_16x16x32_bf16 a[112:115], a[184:187], v[176:179], a[112:115]
  v_max3_f32 v5, v224, v225, v226
  v_add_f32 v227, v227, v220
  v_mfma_f32_16x16x32_bf16 a[116:119], a[184:187], v[180:183], a[116:119]
  v_add_f32 v227, v227, v221
  v_cvt_pk_bf16_f32 v190, v220, v221
  v_mfma_f32_16x16x32_bf16 a[56:59], a[188:191], v[160:163], a[56:59]
  ds_read_b128 a[156:159], v3 offset:7168
  v_add_f32 v227, v227, v222
  v_mfma_f32_16x16x32_bf16 a[60:63], a[188:191], v[164:167], a[60:63]
  v_add_f32 v227, v227, v223
  v_cvt_pk_bf16_f32 v191, v222, v223
  v_mfma_f32_16x16x32_bf16 a[120:123], a[188:191], v[176:179], a[120:123]
  s_waitcnt lgkmcnt(4)
  v_max_f32 v5, v5, v227
  v_cmp_lt_f32 vcc, s81, v5
  v_mfma_f32_16x16x32_bf16 a[124:127], a[188:191], v[180:183], a[124:127]
  s_cbranch_vccnz fa_stub3
fa_back3:
  v_add_f32 v228, v228, v224
  v_add_f32 v229, v229, v225
  v_add_f32 v230, v230, v226
  v_add_f32 v231, v231, v227
  v_mfma_f32_16x16x32_bf16 v[144:147], a[128:131], v[64:67], v[200:203]
  ds_read_b128 a[160:163], v3 offset:24576
  v_cndmask_b32 v96, v4, v96, s[68:69]
  v_cndmask_b32 v97, v4, v97, s[70:71]
  v_mfma_f32_16x16x32_bf16 v[152:155], a[128:131], v[68:71], v[204:207]
  v_cndmask_b32 v98, v4, v98, s[72:73]
  v_cndmask_b32 v99, v4, v99, s[74:75]
  v_mov_b32 v100, v4
  v_mfma_f32_16x16x32_bf16 v[148:151], a[132:135], v[64:67], v[200:203]
  ds_read_b128 a[164:167], v3 offset:25600
  v_mov_b32 v101, v4
  v_mov_b32 v102, v4
  v_mfma_f32_16x16x32_bf16 v[156:159], a[132:135], v[68:71], v[204:207]
  v_mov_b32 v103, v4
  v_cndmask_b32 v108, v4, v108, s[68:69]
  v_cndmask_b32 v109, v4, v109, s[70:71]
  v_mfma_f32_16x16x32_bf16 v[144:147], a[136:139], v[72:75], v[144:147]
  ds_read_b128 a[168:171], v3 offset:26624
  v_cndmask_b32 v110, v4, v110, s[72:73]
  v_cndmask_b32 v111, v4, v111, s[74:75]
  v_mfma_f32_16x16x32_bf16 v[152:155], a[136:139], v[76:79], v[152:155]
  s_mov_b32 m0, s25
  v_exp_f32 v208, v96
  v_exp_f32 v209, v97
  v_mfma_f32_16x16x32_bf16 v[148:151], a[140:143], v[72:75], v[148:151]
  ds_read_b128 a[172:175], v3 offset:27648
  buffer_load_dwordx4 v2, s[48:51], s27 offen offset:0 sc1 lds
  v_mfma_f32_16x16x32_bf16 v[156:159], a[140:143], v[76:79], v[156:159]
  s_waitcnt lgkmcnt(4)
  v_exp_f32 v210, v98
  v_add_f32 v224, v208, v209
  v_mfma_f32_16x16x32_bf16 v[144:147], a[144:147], v[80:83], v[144:147]
  ds_read_b128 a[176:179], v3 offset:28672
  v_exp_f32 v211, v99
  v_mfma_f32_16x16x32_bf16 v[152:155], a[144:147], v[84:87], v[152:155]
  v_exp_f32 v212, v100
  v_cvt_pk_bf16_f32 v160, v208, v209
  v_mfma_f32_16x16x32_bf16 v[148:151], a[148:151], v[80:83], v[148:151]
  ds_read_b128 a[180:183], v3 offset:29696
  v_exp_f32 v213, v101
  v_mfma_f32_16x16x32_bf16 v[156:159], a[148:151], v[84:87], v[156:159]
  v_exp_f32 v214, v102
  v_add_f32 v224, v224, v210
  v_add_f32 v224, v224, v211
  v_mfma_f32_16x16x32_bf16 v[144:147], a[152:155], v[88:91], v[144:147]
  ds_read_b128 a[184:187], v3 offset:30720
  v_cvt_pk_bf16_f32 v161, v210, v211
  v_add_f32 v224, v224, v212
  v_mfma_f32_16x16x32_bf16 v[152:155], a[152:155], v[92:95], v[152:155]
  v_exp_f32 v215, v103
  v_add_f32 v224, v224, v213
  v_mfma_f32_16x16x32_bf16 v[148:151], a[156:159], v[88:91], v[148:151]
  ds_read_b128 a[188:191], v3 offset:31744
  v_cvt_pk_bf16_f32 v162, v212, v213
  v_add_f32 v224, v224, v214
  v_mfma_f32_16x16x32_bf16 v[156:159], a[156:159], v[92:95], v[156:159]
  s_waitcnt lgkmcnt(4)
  v_exp_f32 v208, v104
  v_add_f32 v224, v224, v215
  v_mfma_f32_16x16x32_bf16 a[0:3], a[160:163], v[168:171], a[0:3]
  ds_read_b128 a[128:131], v3 offset:8192
  v_cvt_pk_bf16_f32 v163, v214, v215
  v_exp_f32 v209, v105
  v_mfma_f32_16x16x32_bf16 a[4:7], a[160:163], v[172:175], a[4:7]
  v_exp_f32 v210, v106
  v_mfma_f32_16x16x32_bf16 a[64:67], a[160:163], v[184:187], a[64:67]
  buffer_load_dwordx4 v2, s[48:51], s27 offen offset:1024 sc1 lds
  v_exp_f32 v211, v107
  v_mfma_f32_16x16x32_bf16 a[68:71], a[160:163], v[188:191], a[68:71]
  v_exp_f32 v212, v108
  v_add_f32 v225, v208, v209
  v_mfma_f32_16x16x32_bf16 a[8:11], a[164:167], v[168:171], a[8:11]
  ds_read_b128 a[132:135], v3 offset:9216
  v_exp_f32 v213, v109
  v_mfma_f32_16x16x32_bf16 a[12:15], a[164:167], v[172:175], a[12:15]
  v_exp_f32 v214, v110
  v_cvt_pk_bf16_f32 v164, v208, v209
  v_mfma_f32_16x16x32_bf16 a[72:75], a[164:167], v[184:187], a[72:75]
  v_exp_f32 v215, v111
  v_add_f32 v225, v225, v210
  v_mfma_f32_16x16x32_bf16 a[76:79], a[164:167], v[188:191], a[76:79]
  v_exp_f32 v216, v128
  v_add_f32 v225, v225, v211
  v_mfma_f32_16x16x32_bf16 a[16:19], a[168:171], v[168:171], a[16:19]
  ds_read_b128 a[136:139], v3 offset:10240
  v_exp_f32 v217, v129
  v_mfma_f32_16x16x32_bf16 a[20:23], a[168:171], v[172:175], a[20:23]
  v_exp_f32 v218, v130
  v_cvt_pk_bf16_f32 v165, v210, v211
  v_mfma_f32_16x16x32_bf16 a[80:83], a[168:171], v[184:187], a[80:83]
  v_exp_f32 v219, v131
  v_add_f32 v225, v225, v212
  v_mfma_f32_16x16x32_bf16 a[84:87], a[168:171], v[188:191], a[84:87]
  v_exp_f32 v220, v132
  v_add_f32 v225, v225, v213
  v_mfma_f32_16x16x32_bf16 a[24:27], a[172:175], v[168:171], a[24:27]
  ds_read_b128 a[140:143], v3 offset:11264
  v_exp_f32 v221, v133
  v_mfma_f32_16x16x32_bf16 a[28:31], a[172:175], v[172:175], a[28:31]
  v_exp_f32 v222, v134
  v_cvt_pk_bf16_f32 v166, v212, v213
  v_mfma_f32_16x16x32_bf16 a[88:91], a[172:175], v[184:187], a[88:91]
  buffer_load_dwordx4 v2, s[48:51], s27 offen offset:2048 sc1 lds
  v_exp_f32 v223, v135
  v_mfma_f32_16x16x32_bf16 a[92:95], a[172:175], v[188:191], a[92:95]
  s_waitcnt lgkmcnt(4)
  v_add_f32 v225, v225, v214
  v_add_f32 v225, v225, v215
  v_cvt_pk_bf16_f32 v167, v214, v215
  v_mfma_f32_16x16x32_bf16 a[32:35], a[176:179], v[168:171], a[32:35]
  ds_read_b128 a[144:147], v3 offset:12288
  v_add_f32 v226, v216, v217
  v_cvt_pk_bf16_f32 v176, v216, v217
  v_mfma_f32_16x16x32_bf16 a[36:39], a[176:179], v[172:175], a[36:39]
  v_exp_f32 v216, v136
  v_add_f32 v226, v226, v218
  v_mfma_f32_16x16x32_bf16 a[96:99], a[176:179], v[184:187], a[96:99]
  v_exp_f32 v217, v137
  v_add_f32 v226, v226, v219
  v_mfma_f32_16x16x32_bf16 a[100:103], a[176:179], v[188:191], a[100:103]
  v_cvt_pk_bf16_f32 v177, v218, v219
  v_add_f32 v226, v226, v220
  v_add_f32 v226, v226, v221
  v_cvt_pk_bf16_f32 v178, v220, v221
  v_mfma_f32_16x16x32_bf16 a[40:43], a[180:183], v[168:171], a[40:43]
  ds_read_b128 a[148:151], v3 offset:13312
  v_add_f32 v226, v226, v222
  v_add_f32 v226, v226, v223
  v_mfma_f32_16x16x32_bf16 a[44:47], a[180:183], v[172:175], a[44:47]
  v_exp_f32 v218, v138
  v_cvt_pk_bf16_f32 v179, v222, v223
  v_mfma_f32_16x16x32_bf16 a[104:107], a[180:183], v[184:187], a[104:107]
  v_exp_f32 v219, v139
  v_add_f32 v227, v216, v217
  v_mfma_f32_16x16x32_bf16 a[108:111], a[180:183], v[188:191], a[108:111]
  v_exp_f32 v220, v140
  v_cvt_pk_bf16_f32 v180, v216, v217
  v_mfma_f32_16x16x32_bf16 a[48:51], a[184:187], v[168:171], a[48:51]
  ds_read_b128 a[152:155], v3 offset:14336
  v_add_f32 v227, v227, v218
  v_add_f32 v227, v227, v219
  v_mfma_f32_16x16x32_bf16 a[52:55], a[184:187], v[172:175], a[52:55]
  v_exp_f32 v221, v141
  v_cvt_pk_bf16_f32 v181, v218, v219
  v_mfma_f32_16x16x32_bf16 a[112:115], a[184:187], v[184:187], a[112:115]
  buffer_load_dwordx4 v2, s[48:51], s27 offen offset:3072 sc1 lds
  v_max3_f32 v5, v224, v225, v226
  v_add_f32 v227, v227, v220
  v_mfma_f32_16x16x32_bf16 a[116:119], a[184:187], v[188:191], a[116:119]
  s_add_u32 s27, s27, 16384
  v_exp_f32 v222, v142
  v_add_f32 v227, v227, v221
  v_mfma_f32_16x16x32_bf16 a[56:59], a[188:191], v[168:171], a[56:59]
  s_add_u32 s25, s25, 32768
  ds_read_b128 a[156:159], v3 offset:15360
  v_cvt_pk_bf16_f32 v182, v220, v221
  v_add_f32 v227, v227, v222
  v_mfma_f32_16x16x32_bf16 a[60:63], a[188:191], v[172:175], a[60:63]
  s_and_b32 s25, s25, 0x1ffff
  v_exp_f32 v223, v143
  v_mfma_f32_16x16x32_bf16 a[120:123], a[188:191], v[184:187], a[120:123]
  s_waitcnt lgkmcnt(4)
  v_add_f32 v227, v227, v223
  v_cvt_pk_bf16_f32 v183, v222, v223
  v_max_f32 v5, v5, v227
  v_cmp_lt_f32 vcc, s81, v5
  v_mfma_f32_16x16x32_bf16 a[124:127], a[188:191], v[188:191], a[124:127]
  s_cbranch_vccnz fa_stub4
fa_back4:
  v_add_f32 v228, v228, v224
  v_add_f32 v229, v229, v225
  v_add_f32 v230, v230, v226
  v_add_f32 v231, v231, v227
  v_add_u32 v3, 32768, v3
  v_and_b32 v3, 0x1ffff, v3
fa_AV:
  v_mfma_f32_16x16x32_bf16 v[128:131], a[128:131], v[64:67], v[200:203]
  s_waitcnt vmcnt(12)
  v_exp_f32 v216, v144
  v_mfma_f32_16x16x32_bf16 v[136:139], a[128:131], v[68:71], v[204:207]
  s_barrier
  v_exp_f32 v217, v145
  v_mfma_f32_16x16x32_bf16 v[132:135], a[132:135], v[64:67], v[200:203]
  ds_read_b128 a[160:163], v3 offset:16384
  ds_read_b128 a[164:167], v3 offset:17408
  v_mfma_f32_16x16x32_bf16 v[140:143], a[132:135], v[68:71], v[204:207]
  v_exp_f32 v218, v146
  v_mfma_f32_16x16x32_bf16 v[128:131], a[136:139], v[72:75], v[128:131]
  ds_read_b128 a[168:171], v3 offset:18432
  v_add_f32 v226, v216, v217
  v_mfma_f32_16x16x32_bf16 v[136:139], a[136:139], v[76:79], v[136:139]
  s_mov_b32 m0, s24
  v_exp_f32 v219, v147
  v_mfma_f32_16x16x32_bf16 v[132:135], a[140:143], v[72:75], v[132:135]
  ds_read_b128 a[172:175], v3 offset:19456
  buffer_load_dwordx4 v2, s[44:47], s26 offen offset:0 sc1 lds
  v_mfma_f32_16x16x32_bf16 v[140:143], a[140:143], v[76:79], v[140:143]
  s_waitcnt lgkmcnt(4)
  v_exp_f32 v220, v148
  v_mfma_f32_16x16x32_bf16 v[128:131], a[144:147], v[80:83], v[128:131]
  ds_read_b128 a[176:179], v3 offset:20480
  v_cvt_pk_bf16_f32 v184, v216, v217
  v_mfma_f32_16x16x32_bf16 v[136:139], a[144:147], v[84:87], v[136:139]
  v_exp_f32 v221, v149
  v_mfma_f32_16x16x32_bf16 v[132:135], a[148:151], v[80:83], v[132:135]
  ds_read_b128 a[180:183], v3 offset:21504
  v_add_f32 v226, v226, v218
  v_mfma_f32_16x16x32_bf16 v[140:143], a[148:151], v[84:87], v[140:143]
  v_exp_f32 v222, v150
  v_mfma_f32_16x16x32_bf16 v[128:131], a[152:155], v[88:91], v[128:131]
  ds_read_b128 a[184:187], v3 offset:22528
  v_add_f32 v226, v226, v219
  v_mfma_f32_16x16x32_bf16 v[136:139], a[152:155], v[92:95], v[136:139]
  v_exp_f32 v223, v151
  v_mfma_f32_16x16x32_bf16 v[132:135], a[156:159], v[88:91], v[132:135]
  ds_read_b128 a[188:191], v3 offset:23552
  v_cvt_pk_bf16_f32 v185, v218, v219
  v_mfma_f32_16x16x32_bf16 v[140:143], a[156:159], v[92:95], v[140:143]
  s_waitcnt lgkmcnt(4)
  v_exp_f32 v216, v152
  v_mfma_f32_16x16x32_bf16 a[0:3], a[160:163], v[160:163], a[0:3]
  ds_read_b128 a[128:131], v3 offset:0
  v_add_f32 v226, v226, v220
  v_mfma_f32_16x16x32_bf16 a[4:7], a[160:163], v[164:167], a[4:7]
  v_exp_f32 v217, v153
  v_mfma_f32_16x16x32_bf16 a[64:67], a[160:163], v[176:179], a[64:67]
  buffer_load_dwordx4 v2, s[44:47], s26 offen offset:1024 sc1 lds
  v_add_f32 v226, v226, v221
  v_mfma_f32_16x16x32_bf16 a[68:71], a[160:163], v[180:183], a[68:71]
  v_exp_f32 v218, v154
  v_mfma_f32_16x16x32_bf16 a[8:11], a[164:167], v[160:163], a[8:11]
  ds_read_b128 a[132:135], v3 offset:1024
  v_cvt_pk_bf16_f32 v186, v220, v221
  v_mfma_f32_16x16x32_bf16 a[12:15], a[164:167], v[164:167], a[12:15]
  v_exp_f32 v219, v155
  v_mfma_f32_16x16x32_bf16 a[72:75], a[164:167], v[176:179], a[72:75]
  v_exp_f32 v220, v156
  v_mfma_f32_16x16x32_bf16 a[76:79], a[164:167], v[180:183], a[76:79]
  v_add_f32 v226, v226, v222
  v_add_f32 v226, v226, v223
  v_mfma_f32_16x16x32_bf16 a[16:19], a[168:171], v[160:163], a[16:19]
  ds_read_b128 a[136:139], v3 offset:2048
  v_cvt_pk_bf16_f32 v187, v222, v223
  v_mfma_f32_16x16x32_bf16 a[20:23], a[168:171], v[164:167], a[20:23]
  v_exp_f32 v221, v157
  v_mfma_f32_16x16x32_bf16 a[80:83], a[168:171], v[176:179], a[80:83]
  v_exp_f32 v222, v158
  v_mfma_f32_16x16x32_bf16 a[84:87], a[168:171], v[180:183], a[84:87]
  v_exp_f32 v223, v159
  v_mfma_f32_16x16x32_bf16 a[24:27], a[172:175], v[160:163], a[24:27]
  ds_read_b128 a[140:143], v3 offset:3072
  v_add_f32 v227, v216, v217
  v_mfma_f32_16x16x32_bf16 a[28:31], a[172:175], v[164:167], a[28:31]
  v_cvt_pk_bf16_f32 v188, v216, v217
  v_add_f32 v227, v227, v218
  v_mfma_f32_16x16x32_bf16 a[88:91], a[172:175], v[176:179], a[88:91]
  buffer_load_dwordx4 v2, s[44:47], s26 offen offset:2048 sc1 lds
  v_add_f32 v227, v227, v219
  v_mfma_f32_16x16x32_bf16 a[92:95], a[172:175], v[180:183], a[92:95]
  s_waitcnt lgkmcnt(4)
  v_cvt_pk_bf16_f32 v189, v218, v219
  v_add_f32 v227, v227, v220
  v_mfma_f32_16x16x32_bf16 a[32:35], a[176:179], v[160:163], a[32:35]
  ds_read_b128 a[144:147], v3 offset:4096
  v_add_f32 v227, v227, v221
  v_mfma_f32_16x16x32_bf16 a[36:39], a[176:179], v[164:167], a[36:39]
  v_cvt_pk_bf16_f32 v190, v220, v221
  v_add_f32 v227, v227, v222
  v_mfma_f32_16x16x32_bf16 a[96:99], a[176:179], v[176:179], a[96:99]
  v_add_f32 v227, v227, v223
  v_cvt_pk_bf16_f32 v191, v222, v223
  v_mfma_f32_16x16x32_bf16 a[100:103], a[176:179], v[180:183], a[100:103]
  v_max_f32 v5, v226, v227
  v_cmp_lt_f32 vcc, s81, v5
  v_mfma_f32_16x16x32_bf16 a[40:43], a[180:183], v[160:163], a[40:43]
  ds_read_b128 a[148:151], v3 offset:5120
  v_mfma_f32_16x16x32_bf16 a[44:47], a[180:183], v[164:167], a[44:47]
  v_mfma_f32_16x16x32_bf16 a[104:107], a[180:183], v[176:179], a[104:107]
  v_mfma_f32_16x16x32_bf16 a[108:111], a[180:183], v[180:183], a[108:111]
  v_mfma_f32_16x16x32_bf16 a[48:51], a[184:187], v[160:163], a[48:51]
  ds_read_b128 a[152:155], v3 offset:6144
  v_mfma_f32_16x16x32_bf16 a[52:55], a[184:187], v[164:167], a[52:55]
  v_mfma_f32_16x16x32_bf16 a[112:115], a[184:187], v[176:179], a[112:115]
  buffer_load_dwordx4 v2, s[44:47], s26 offen offset:3072 sc1 lds
  v_mfma_f32_16x16x32_bf16 a[116:119], a[184:187], v[180:183], a[116:119]
  s_add_u32 s26, s26, 16384
  v_mfma_f32_16x16x32_bf16 a[56:59], a[188:191], v[160:163], a[56:59]
  s_add_u32 s24, s24, 32768
  ds_read_b128 a[156:159], v3 offset:7168
  v_mfma_f32_16x16x32_bf16 a[60:63], a[188:191], v[164:167], a[60:63]
  s_and_b32 s24, s24, 0x1ffff
  v_mfma_f32_16x16x32_bf16 a[120:123], a[188:191], v[176:179], a[120:123]
  s_waitcnt lgkmcnt(4)
  v_mfma_f32_16x16x32_bf16 a[124:127], a[188:191], v[180:183], a[124:127]
  s_cbranch_vccnz fa_stub5
fa_back5:
  v_add_f32 v230, v230, v226
  v_add_f32 v231, v231, v227
  v_mfma_f32_16x16x32_bf16 v[144:147], a[128:131], v[64:67], v[200:203]
  ds_read_b128 a[160:163], v3 offset:24576
  v_exp_f32 v216, v128
  v_mfma_f32_16x16x32_bf16 v[152:155], a[128:131], v[68:71], v[204:207]
  v_exp_f32 v217, v129
  v_mfma_f32_16x16x32_bf16 v[148:151], a[132:135], v[64:67], v[200:203]
  ds_read_b128 a[164:167], v3 offset:25600
  v_add_f32 v226, v216, v217
  v_mfma_f32_16x16x32_bf16 v[156:159], a[132:135], v[68:71], v[204:207]
  s_mov_b32 m0, s25
  v_exp_f32 v218, v130
  v_cvt_pk_bf16_f32 v176, v216, v217
  v_mfma_f32_16x16x32_bf16 v[144:147], a[136:139], v[72:75], v[144:147]
  ds_read_b128 a[168:171], v3 offset:26624
  buffer_load_dwordx4 v2, s[48:51], s27 offen offset:0 sc1 lds
  v_mfma_f32_16x16x32_bf16 v[152:155], a[136:139], v[76:79], v[152:155]
  v_exp_f32 v219, v131
  v_add_f32 v226, v226, v218
  v_mfma_f32_16x16x32_bf16 v[148:151], a[140:143], v[72:75], v[148:151]
  ds_read_b128 a[172:175], v3 offset:27648
  v_add_f32 v226, v226, v219
  v_mfma_f32_16x16x32_bf16 v[156:159], a[140:143], v[76:79], v[156:159]
  s_waitcnt lgkmcnt(4)
  v_exp_f32 v220, v132
  v_cvt_pk_bf16_f32 v177, v218, v219
  v_mfma_f32_16x16x32_bf16 v[144:147], a[144:147], v[80:83], v[144:147]
  ds_read_b128 a[176:179], v3 offset:28672
  v_add_f32 v226, v226, v220
  v_mfma_f32_16x16x32_bf16 v[152:155], a[144:147], v[84:87], v[152:155]
  v_exp_f32 v221, v133
  v_exp_f32 v222, v134
  v_mfma_f32_16x16x32_bf16 v[148:151], a[148:151], v[80:83], v[148:151]
  ds_read_b128 a[180:183], v3 offset:29696
  buffer_load_dwordx4 v2, s[48:51], s27 offen offset:1024 sc1 lds
  v_mfma_f32_16x16x32_bf16 v[156:159], a[148:151], v[84:87], v[156:159]
  v_exp_f32 v223, v135
  v_mfma_f32_16x16x32_bf16 v[144:147], a[152:155], v[88:91], v[144:147]
  ds_read_b128 a[184:187], v3 offset:30720
  v_add_f32 v226, v226, v221
  v_mfma_f32_16x16x32_bf16 v[152:155], a[152:155], v[92:95], v[152:155]
  v_exp_f32 v216, v136
  v_mfma_f32_16x16x32_bf16 v[148:151], a[156:159], v[88:91], v[148:151]
  ds_read_b128 a[188:191], v3 offset:31744
  v_cvt_pk_bf16_f32 v178, v220, v221
  v_add_f32 v226, v226, v222
  v_mfma_f32_16x16x32_bf16 v[156:159], a[156:159], v[92:95], v[156:159]
  s_waitcnt lgkmcnt(4)
  v_exp_f32 v217, v137
  v_mfma_f32_16x16x32_bf16 a[64:67], a[160:163], v[184:187], a[64:67]
  ds_read_b128 a[128:131], v3 offset:8192
  v_add_f32 v226, v226, v223
  v_cvt_pk_bf16_f32 v179, v222, v223
  v_mfma_f32_16x16x32_bf16 a[68:71], a[160:163], v[188:191], a[68:71]
  v_exp_f32 v218, v138
  v_mfma_f32_16x16x32_bf16 a[72:75], a[164:167], v[184:187], a[72:75]
  ds_read_b128 a[132:135], v3 offset:9216
  buffer_load_dwordx4 v2, s[48:51], s27 offen offset:2048 sc1 lds
  v_add_f32 v227, v216, v217
  v_mfma_f32_16x16x32_bf16 a[76:79], a[164:167], v[188:191], a[76:79]
  v_exp_f32 v219, v139
  v_mfma_f32_16x16x32_bf16 a[80:83], a[168:171], v[184:187], a[80:83]
  ds_read_b128 a[136:139], v3 offset:10240
  v_cvt_pk_bf16_f32 v180, v216, v217
  v_mfma_f32_16x16x32_bf16 a[84:87], a[168:171], v[188:191], a[84:87]
  v_exp_f32 v220, v140
  v_add_f32 v227, v227, v218
  v_mfma_f32_16x16x32_bf16 a[88:91], a[172:175], v[184:187], a[88:91]
  ds_read_b128 a[140:143], v3 offset:11264
  v_add_f32 v227, v227, v219
  v_mfma_f32_16x16x32_bf16 a[92:95], a[172:175], v[188:191], a[92:95]
  s_waitcnt lgkmcnt(4)
  v_exp_f32 v221, v141
  v_cvt_pk_bf16_f32 v181, v218, v219
  v_mfma_f32_16x16x32_bf16 a[96:99], a[176:179], v[184:187], a[96:99]
  ds_read_b128 a[144:147], v3 offset:12288
  buffer_load_dwordx4 v2, s[48:51], s27 offen offset:3072 sc1 lds
  v_mfma_f32_16x16x32_bf16 a[100:103], a[176:179], v[188:191], a[100:103]
  s_add_u32 s27, s27, 16384
  v_exp_f32 v222, v142
  v_add_f32 v227, v227, v220
  v_mfma_f32_16x16x32_bf16 a[104:107], a[180:183], v[184:187], a[104:107]
  s_add_u32 s25, s25, 32768
  ds_read_b128 a[148:151], v3 offset:13312
  v_add_f32 v227, v227, v221
  v_mfma_f32_16x16x32_bf16 a[108:111], a[180:183], v[188:191], a[108:111]
  s_and_b32 s25, s25, 0x1ffff
  v_exp_f32 v223, v143
  v_cvt_pk_bf16_f32 v182, v220, v221
  v_mfma_f32_16x16x32_bf16 a[112:115], a[184:187], v[184:187], a[112:115]
  ds_read_b128 a[152:155], v3 offset:14336
  v_add_f32 v227, v227, v222
  v_mfma_f32_16x16x32_bf16 a[116:119], a[184:187], v[188:191], a[116:119]
  v_add_f32 v227, v227, v223
  v_cvt_pk_bf16_f32 v183, v222, v223
  v_max_f32 v5, v226, v227
  v_mfma_f32_16x16x32_bf16 a[120:123], a[188:191], v[184:187], a[120:123]
  s_waitcnt lgkmcnt(3)
  ds_read_b128 a[156:159], v3 offset:15360
  v_cmp_lt_f32 vcc, s81, v5
  v_mfma_f32_16x16x32_bf16 a[124:127], a[188:191], v[188:191], a[124:127]
  s_cbranch_vccnz fa_stub6
fa_back6:
  v_add_f32 v230, v230, v226
  v_add_f32 v231, v231, v227
  v_add_u32 v3, 32768, v3
  v_and_b32 v3, 0x1ffff, v3
  s_branch fa_SSpre
fa_Aodd:
  v_mfma_f32_16x16x32_bf16 v[128:131], a[128:131], v[64:67], v[200:203]
  s_waitcnt vmcnt(12)
  v_cndmask_b32 v112, v4, v112, s[68:69]
  v_cndmask_b32 v113, v4, v113, s[70:71]
  v_cndmask_b32 v114, v4, v114, s[72:73]
  v_mfma_f32_16x16x32_bf16 v[136:139], a[128:131], v[68:71], v[204:207]
  s_barrier
  v_cndmask_b32 v115, v4, v115, s[74:75]
  v_mov_b32 v116, v4
  v_mov_b32 v117, v4
  v_mfma_f32_16x16x32_bf16 v[132:135], a[132:135], v[64:67], v[200:203]
  ds_read_b128 a[160:163], v3 offset:16384
  ds_read_b128 a[164:167], v3 offset:17408
  v_mov_b32 v118, v4
  v_mfma_f32_16x16x32_bf16 v[140:143], a[132:135], v[68:71], v[204:207]
  v_mov_b32 v119, v4
  v_cndmask_b32 v124, v4, v124, s[68:69]
  v_cndmask_b32 v125, v4, v125, s[70:71]
  v_mfma_f32_16x16x32_bf16 v[128:131], a[136:139], v[72:75], v[128:131]
  ds_read_b128 a[168:171], v3 offset:18432
  v_cndmask_b32 v126, v4, v126, s[72:73]
  v_cndmask_b32 v127, v4, v127, s[74:75]
  v_mfma_f32_16x16x32_bf16 v[136:139], a[136:139], v[76:79], v[136:139]
  s_mov_b32 m0, s24
  v_exp_f32 v208, v112
  v_exp_f32 v209, v113
  v_mfma_f32_16x16x32_bf16 v[132:135], a[140:143], v[72:75], v[132:135]
  ds_read_b128 a[172:175], v3 offset:19456
  buffer_load_dwordx4 v2, s[44:47], s26 offen offset:0 sc1 lds
  v_mfma_f32_16x16x32_bf16 v[140:143], a[140:143], v[76:79], v[140:143]
  s_waitcnt lgkmcnt(4)
  v_exp_f32 v210, v114
  v_add_f32 v224, v208, v209
  v_mfma_f32_16x16x32_bf16 v[128:131], a[144:147], v[80:83], v[128:131]
  ds_read_b128 a[176:179], v3 offset:20480
  v_exp_f32 v211, v115
  v_mfma_f32_16x16x32_bf16 v[136:139], a[144:147], v[84:87], v[136:139]
  v_exp_f32 v212, v116
  v_cvt_pk_bf16_f32 v168, v208, v209
  v_mfma_f32_16x16x32_bf16 v[132:135], a[148:151], v[80:83], v[132:135]
  ds_read_b128 a[180:183], v3 offset:21504
  v_exp_f32 v213, v117
  v_mfma_f32_16x16x32_bf16 v[140:143], a[148:151], v[84:87], v[140:143]
  v_exp_f32 v214, v118
  v_add_f32 v224, v224, v210
  v_add_f32 v224, v224, v211
  v_mfma_f32_16x16x32_bf16 v[128:131], a[152:155], v[88:91], v[128:131]
  ds_read_b128 a[184:187], v3 offset:22528
  v_cvt_pk_bf16_f32 v169, v210, v211
  v_add_f32 v224, v224, v212
  v_mfma_f32_16x16x32_bf16 v[136:139], a[152:155], v[92:95], v[136:139]
  v_exp_f32 v215, v119
  v_add_f32 v224, v224, v213
  v_mfma_f32_16x16x32_bf16 v[132:135], a[156:159], v[88:91], v[132:135]
  ds_read_b128 a[188:191], v3 offset:23552
  v_cvt_pk_bf16_f32 v170, v212, v213
  v_add_f32 v224, v224, v214
  v_mfma_f32_16x16x32_bf16 v[140:143], a[156:159], v[92:95], v[140:143]
  s_waitcnt lgkmcnt(4)
  v_exp_f32 v208, v120
  v_add_f32 v224, v224, v215
  v_mfma_f32_16x16x32_bf16 a[0:3], a[160:163], v[160:163], a[0:3]
  ds_read_b128 a[128:131], v3 offset:0
  v_cvt_pk_bf16_f32 v171, v214, v215
  v_exp_f32 v209, v121
  v_mfma_f32_16x16x32_bf16 a[4:7], a[160:163], v[164:167], a[4:7]
  v_exp_f32 v210, v122
  v_mfma_f32_16x16x32_bf16 a[64:67], a[160:163], v[176:179], a[64:67]
  buffer_load_dwordx4 v2, s[44:47], s26 offen offset:1024 sc1 lds
  v_exp_f32 v211, v123
  v_mfma_f32_16x16x32_bf16 a[68:71], a[160:163], v[180:183], a[68:71]
  v_exp_f32 v212, v124
  v_add_f32 v225, v208, v209
  v_mfma_f32_16x16x32_bf16 a[8:11], a[164:167], v[160:163], a[8:11]
  ds_read_b128 a[132:135], v3 offset:1024
  v_exp_f32 v213, v125
  v_mfma_f32_16x16x32_bf16 a[12:15], a[164:167], v[164:167], a[12:15]
  v_exp_f32 v214, v126
  v_cvt_pk_bf16_f32 v172, v208, v209
  v_mfma_f32_16x16x32_bf16 a[72:75], a[164:167], v[176:179], a[72:75]
  v_exp_f32 v215, v127
  v_add_f32 v225, v225, v210
  v_mfma_f32_16x16x32_bf16 a[76:79], a[164:167], v[180:183], a[76:79]
  v_exp_f32 v216, v144
  v_add_f32 v225, v225, v211
  v_mfma_f32_16x16x32_bf16 a[16:19], a[168:171], v[160:163], a[16:19]
  ds_read_b128 a[136:139], v3 offset:2048
  v_exp_f32 v217, v145
  v_mfma_f32_16x16x32_bf16 a[20:23], a[168:171], v[164:167], a[20:23]
  v_exp_f32 v218, v146
  v_cvt_pk_bf16_f32 v173, v210, v211
  v_mfma_f32_16x16x32_bf16 a[80:83], a[168:171], v[176:179], a[80:83]
  v_exp_f32 v219, v147
  v_add_f32 v225, v225, v212
  v_mfma_f32_16x16x32_bf16 a[84:87], a[168:171], v[180:183], a[84:87]
  v_exp_f32 v220, v148
  v_add_f32 v225, v225, v213
  v_mfma_f32_16x16x32_bf16 a[24:27], a[172:175], v[160:163], a[24:27]
  ds_read_b128 a[140:143], v3 offset:3072
  v_exp_f32 v221, v149
  v_mfma_f32_16x16x32_bf16 a[28:31], a[172:175], v[164:167], a[28:31]
  v_exp_f32 v222, v150
  v_cvt_pk_bf16_f32 v174, v212, v213
  v_mfma_f32_16x16x32_bf16 a[88:91], a[172:175], v[176:179], a[88:91]
  buffer_load_dwordx4 v2, s[44:47], s26 offen offset:2048 sc1 lds
  v_exp_f32 v223, v151
  v_mfma_f32_16x16x32_bf16 a[92:95], a[172:175], v[180:183], a[92:95]
  s_waitcnt lgkmcnt(4)
  v_add_f32 v225, v225, v214
  v_add_f32 v225, v225, v215
  v_cvt_pk_bf16_f32 v175, v214, v215
  v_mfma_f32_16x16x32_bf16 a[32:35], a[176:179], v[160:163], a[32:35]
  ds_read_b128 a[144:147], v3 offset:4096
  v_add_f32 v226, v216, v217
  v_cvt_pk_bf16_f32 v184, v216, v217
  v_mfma_f32_16x16x32_bf16 a[36:39], a[176:179], v[164:167], a[36:39]
  v_exp_f32 v216, v152
  v_add_f32 v226, v226, v218
  v_mfma_f32_16x16x32_bf16 a[96:99], a[176:179], v[176:179], a[96:99]
  v_exp_f32 v217, v153
  v_add_f32 v226, v226, v219
  v_mfma_f32_16x16x32_bf16 a[100:103], a[176:179], v[180:183], a[100:103]
  v_cvt_pk_bf16_f32 v185, v218, v219
  v_add_f32 v226, v226, v220
  v_add_f32 v226, v226, v221
  v_cvt_pk_bf16_f32 v186, v220, v221
  v_mfma_f32_16x16x32_bf16 a[40:43], a[180:183], v[160:163], a[40:43]
  ds_read_b128 a[148:151], v3 offset:5120
  v_add_f32 v226, v226, v222
  v_add_f32 v226, v226, v223
  v_mfma_f32_16x16x32_bf16 a[44:47], a[180:183], v[164:167], a[44:47]
  v_exp_f32 v218, v154
  v_cvt_pk_bf16_f32 v187, v222, v223
  v_mfma_f32_16x16x32_bf16 a[104:107], a[180:183], v[176:179], a[104:107]
  v_exp_f32 v219, v155
  v_add_f32 v227, v216, v217
  v_mfma_f32_16x16x32_bf16 a[108:111], a[180:183], v[180:183], a[108:111]
  v_exp_f32 v220, v156
  v_cvt_pk_bf16_f32 v188, v216, v217
  v_mfma_f32_16x16x32_bf16 a[48:51], a[184:187], v[160:163], a[48:51]
  ds_read_b128 a[152:155], v3 offset:6144
  v_add_f32 v227, v227, v218
  v_add_f32 v227, v227, v219
  v_mfma_f32_16x16x32_bf16 a[52:55], a[184:187], v[164:167], a[52:55]
  v_exp_f32 v221, v157
  v_cvt_pk_bf16_f32 v189, v218, v219
  v_mfma_f32_16x16x32_bf16 a[112:115], a[184:187], v[176:179], a[112:115]
  buffer_load_dwordx4 v2, s[44:47], s26 offen offset:3072 sc1 lds
  v_max3_f32 v5, v224, v225, v226
  v_add_f32 v227, v227, v220
  v_mfma_f32_16x16x32_bf16 a[116:119], a[184:187], v[180:183], a[116:119]
  s_add_u32 s26, s26, 16384
  v_exp_f32 v222, v158
  v_add_f32 v227, v227, v221
  v_mfma_f32_16x16x32_bf16 a[56:59], a[188:191], v[160:163], a[56:59]
  s_add_u32 s24, s24, 32768
  ds_read_b128 a[156:159], v3 offset:7168
  v_cvt_pk_bf16_f32 v190, v220, v221
  v_add_f32 v227, v227, v222
  v_mfma_f32_16x16x32_bf16 a[60:63], a[188:191], v[164:167], a[60:63]
  s_and_b32 s24, s24, 0x1ffff
  v_exp_f32 v223, v159
  v_mfma_f32_16x16x32_bf16 a[120:123], a[188:191], v[176:179], a[120:123]
  s_waitcnt lgkmcnt(4)
  v_add_f32 v227, v227, v223
  v_cvt_pk_bf16_f32 v191, v222, v223
  v_max_f32 v5, v5, v227
  v_cmp_lt_f32 vcc, s81, v5
  v_mfma_f32_16x16x32_bf16 a[124:127], a[188:191], v[180:183], a[124:127]
  s_cbranch_vccnz fa_stub7
fa_back7:
  v_add_f32 v228, v228, v224
  v_add_f32 v229, v229, v225
  v_add_f32 v230, v230, v226
  v_add_f32 v231, v231, v227
  v_mfma_f32_16x16x32_bf16 v[144:147], a[128:131], v[64:67], v[200:203]
  ds_read_b128 a[160:163], v3 offset:24576
  v_exp_f32 v216, v128
  v_mfma_f32_16x16x32_bf16 v[152:155], a[128:131], v[68:71], v[204:207]
  v_exp_f32 v217, v129
  v_mfma_f32_16x16x32_bf16 v[148:151], a[132:135], v[64:67], v[200:203]
  ds_read_b128 a[164:167], v3 offset:25600
  v_mfma_f32_16x16x32_bf16 v[156:159], a[132:135], v[68:71], v[204:207]
  v_exp_f32 v218, v130
  v_mfma_f32_16x16x32_bf16 v[144:147], a[136:139], v[72:75], v[144:147]
  ds_read_b128 a[168:171], v3 offset:26624
  v_add_f32 v226, v216, v217
  v_mfma_f32_16x16x32_bf16 v[152:155], a[136:139], v[76:79], v[152:155]
  s_mov_b32 m0, s25
  v_exp_f32 v219, v131
  v_mfma_f32_16x16x32_bf16 v[148:151], a[140:143], v[72:75], v[148:151]
  ds_read_b128 a[172:175], v3 offset:27648
  buffer_load_dwordx4 v2, s[48:51], s27 offen offset:0 sc1 lds
  v_mfma_f32_16x16x32_bf16 v[156:159], a[140:143], v[76:79], v[156:159]
  s_waitcnt lgkmcnt(4)
  v_exp_f32 v220, v132
  v_mfma_f32_16x16x32_bf16 v[144:147], a[144:147], v[80:83], v[144:147]
  ds_read_b128 a[176:179], v3 offset:28672
  v_cvt_pk_bf16_f32 v176, v216, v217
  v_mfma_f32_16x16x32_bf16 v[152:155], a[144:147], v[84:87], v[152:155]
  v_exp_f32 v221, v133
  v_mfma_f32_16x16x32_bf16 v[148:151], a[148:151], v[80:83], v[148:151]
  ds_read_b128 a[180:183], v3 offset:29696
  v_add_f32 v226, v226, v218
  v_mfma_f32_16x16x32_bf16 v[156:159], a[148:151], v[84:87], v[156:159]
  v_exp_f32 v222, v134
  v_mfma_f32_16x16x32_bf16 v[144:147], a[152:155], v[88:91], v[144:147]
  ds_read_b128 a[184:187], v3 offset:30720
  v_add_f32 v226, v226, v219
  v_mfma_f32_16x16x32_bf16 v[152:155], a[152:155], v[92:95], v[152:155]
  v_exp_f32 v223, v135
  v_mfma_f32_16x16x32_bf16 v[148:151], a[156:159], v[88:91], v[148:151]
  ds_read_b128 a[188:191], v3 offset:31744
  v_cvt_pk_bf16_f32 v177, v218, v219
  v_mfma_f32_16x16x32_bf16 v[156:159], a[156:159], v[92:95], v[156:159]
  s_waitcnt lgkmcnt(4)
  v_exp_f32 v216, v136
  v_mfma_f32_16x16x32_bf16 a[0:3], a[160:163], v[168:171], a[0:3]
  ds_read_b128 a[128:131], v3 offset:8192
  v_add_f32 v226, v226, v220
  v_mfma_f32_16x16x32_bf16 a[4:7], a[160:163], v[172:175], a[4:7]
  v_exp_f32 v217, v137
  v_mfma_f32_16x16x32_bf16 a[64:67], a[160:163], v[184:187], a[64:67]
  buffer_load_dwordx4 v2, s[48:51], s27 offen offset:1024 sc1 lds
  v_add_f32 v226, v226, v221
  v_mfma_f32_16x16x32_bf16 a[68:71], a[160:163], v[188:191], a[68:71]
  v_exp_f32 v218, v138
  v_mfma_f32_16x16x32_bf16 a[8:11], a[164:167], v[168:171], a[8:11]
  ds_read_b128 a[132:135], v3 offset:9216
  v_cvt_pk_bf16_f32 v178, v220, v221
  v_mfma_f32_16x16x32_bf16 a[12:15], a[164:167], v[172:175], a[12:15]
  v_exp_f32 v219, v139
  v_mfma_f32_16x16x32_bf16 a[72:75], a[164:167], v[184:187], a[72:75]
  v_exp_f32 v220, v140
  v_mfma_f32_16x16x32_bf16 a[76:79], a[164:167], v[188:191], a[76:79]
  v_add_f32 v226, v226, v222
  v_add_f32 v226, v226, v223
  v_mfma_f32_16x16x32_bf16 a[16:19], a[168:171], v[168:171], a[16:19]
  ds_read_b128 a[136:139], v3 offset:10240
  v_cvt_pk_bf16_f32 v179, v222, v223
  v_mfma_f32_16x16x32_bf16 a[20:23], a[168:171], v[172:175], a[20:23]
  v_exp_f32 v221, v141
  v_mfma_f32_16x16x32_bf16 a[80:83], a[168:171], v[184:187], a[80:83]
  v_exp_f32 v222, v142
  v_mfma_f32_16x16x32_bf16 a[84:87], a[168:171], v[188:191], a[84:87]
  v_exp_f32 v223, v143
  v_mfma_f32_16x16x32_bf16 a[24:27], a[172:175], v[168:171], a[24:27]
  ds_read_b128 a[140:143], v3 offset:11264
  v_add_f32 v227, v216, v217
  v_mfma_f32_16x16x32_bf16 a[28:31], a[172:175], v[172:175], a[28:31]
  v_cvt_pk_bf16_f32 v180, v216, v217
  v_add_f32 v227, v227, v218
  v_mfma_f32_16x16x32_bf16 a[88:91], a[172:175], v[184:187], a[88:91]
  buffer_load_dwordx4 v2, s[48:51], s27 offen offset:2048 sc1 lds
  v_add_f32 v227, v227, v219
  v_mfma_f32_16x16x32_bf16 a[92:95], a[172:175], v[188:191], a[92:95]
  s_waitcnt lgkmcnt(4)
  v_cvt_pk_bf16_f32 v181, v218, v219
  v_add_f32 v227, v227, v220
  v_mfma_f32_16x16x32_bf16 a[32:35], a[176:179], v[168:171], a[32:35]
  ds_read_b128 a[144:147], v3 offset:12288
  v_add_f32 v227, v227, v221
  v_mfma_f32_16x16x32_bf16 a[36:39], a[176:179], v[172:175], a[36:39]
  v_cvt_pk_bf16_f32 v182, v220, v221
  v_add_f32 v227, v227, v222
  v_mfma_f32_16x16x32_bf16 a[96:99], a[176:179], v[184:187], a[96:99]
  v_add_f32 v227, v227, v223
  v_cvt_pk_bf16_f32 v183, v222, v223
  v_mfma_f32_16x16x32_bf16 a[100:103], a[176:179], v[188:191], a[100:103]
  v_max_f32 v5, v226, v227
  v_cmp_lt_f32 vcc, s81, v5
  v_mfma_f32_16x16x32_bf16 a[40:43], a[180:183], v[168:171], a[40:43]
  ds_read_b128 a[148:151], v3 offset:13312
  v_mfma_f32_16x16x32_bf16 a[44:47], a[180:183], v[172:175], a[44:47]
  v_mfma_f32_16x16x32_bf16 a[104:107], a[180:183], v[184:187], a[104:107]
  v_mfma_f32_16x16x32_bf16 a[108:111], a[180:183], v[188:191], a[108:111]
  v_mfma_f32_16x16x32_bf16 a[48:51], a[184:187], v[168:171], a[48:51]
  ds_read_b128 a[152:155], v3 offset:14336
  v_mfma_f32_16x16x32_bf16 a[52:55], a[184:187], v[172:175], a[52:55]
  v_mfma_f32_16x16x32_bf16 a[112:115], a[184:187], v[184:187], a[112:115]
  buffer_load_dwordx4 v2, s[48:51], s27 offen offset:3072 sc1 lds
  v_mfma_f32_16x16x32_bf16 a[116:119], a[184:187], v[188:191], a[116:119]
  s_add_u32 s27, s27, 16384
  v_mfma_f32_16x16x32_bf16 a[56:59], a[188:191], v[168:171], a[56:59]
  s_add_u32 s25, s25, 32768
  ds_read_b128 a[156:159], v3 offset:15360
  v_mfma_f32_16x16x32_bf16 a[60:63], a[188:191], v[172:175], a[60:63]
  s_and_b32 s25, s25, 0x1ffff
  v_mfma_f32_16x16x32_bf16 a[120:123], a[188:191], v[184:187], a[120:123]
  s_waitcnt lgkmcnt(4)
  v_mfma_f32_16x16x32_bf16 a[124:127], a[188:191], v[188:191], a[124:127]
  s_cbranch_vccnz fa_stub8
fa_back8:
  v_add_f32 v230, v230, v226
  v_add_f32 v231, v231, v227
  v_add_u32 v3, 32768, v3
  v_and_b32 v3, 0x1ffff, v3
fa_SSpre:
  s_mov_b32 s11, 1
  s_cmp_lg_u32 s12, 0
  s_cselect_b32 s32, s15, s32
  s_cmp_le_u32 s29, 8
  s_cbranch_scc1 fa_chain
.p2align 6
fa_SS:
  v_mfma_f32_16x16x32_bf16 v[128:131], a[128:131], v[64:67], v[200:203]
  s_waitcnt vmcnt(12)
  v_exp_f32 v216, v144
  v_mfma_f32_16x16x32_bf16 v[136:139], a[128:131], v[68:71], v[204:207]
  s_barrier
  v_exp_f32 v217, v145
  v_exp_f32 v218, v146
  v_mfma_f32_16x16x32_bf16 v[132:135], a[132:135], v[64:67], v[200:203]
  s_cmp_ge_u32 s26, s32
  ds_read_b128 a[160:163], v3 offset:16384
  ds_read_b128 a[164:167], v3 offset:17408
  v_mfma_f32_16x16x32_bf16 v[140:143], a[132:135], v[68:71], v[204:207]
  s_cbranch_scc1 fa_hk2
fa_hb2:
  s_mov_b32 m0, s24
  v_exp_f32 v219, v147
  v_mfma_f32_16x16x32_bf16 v[128:131], a[136:139], v[72:75], v[128:131]
  ds_read_b128 a[168:171], v3 offset:18432
  buffer_load_dwordx4 v2, s[44:47], s26 offen offset:0 sc1 lds
  v_mfma_f32_16x16x32_bf16 v[136:139], a[136:139], v[76:79], v[136:139]
  v_exp_f32 v220, v148
  v_add_f32 v226, v216, v217
  v_mfma_f32_16x16x32_bf16 v[132:135], a[140:143], v[72:75], v[132:135]
  ds_read_b128 a[172:175], v3 offset:19456
  v_cvt_pk_bf16_f32 v184, v216, v217
  v_mfma_f32_16x16x32_bf16 v[140:143], a[140:143], v[76:79], v[140:143]
  s_waitcnt lgkmcnt(4)
  v_exp_f32 v221, v149
  v_add_f32 v226, v226, v218
  v_mfma_f32_16x16x32_bf16 v[128:131], a[144:147], v[80:83], v[128:131]
  ds_read_b128 a[176:179], v3 offset:20480
  v_add_f32 v226, v226, v219
  v_mfma_f32_16x16x32_bf16 v[136:139], a[144:147], v[84:87], v[136:139]
  v_exp_f32 v222, v150
  v_cvt_pk_bf16_f32 v185, v218, v219
  v_mfma_f32_16x16x32_bf16 v[132:135], a[148:151], v[80:83], v[132:135]
  ds_read_b128 a[180:183], v3 offset:21504
  buffer_load_dwordx4 v2, s[44:47], s26 offen offset:1024 sc1 lds
  v_mfma_f32_16x16x32_bf16 v[140:143], a[148:151], v[84:87], v[140:143]
  v_exp_f32 v223, v151
  v_mfma_f32_16x16x32_bf16 v[128:131], a[152:155], v[88:91], v[128:131]
  ds_read_b128 a[184:187], v3 offset:22528
  v_add_f32 v226, v226, v220
  v_add_f32 v226, v226, v221
  v_mfma_f32_16x16x32_bf16 v[136:139], a[152:155], v[92:95], v[136:139]
  v_exp_f32 v216, v152
  v_mfma_f32_16x16x32_bf16 v[132:135], a[156:159], v[88:91], v[132:135]
  ds_read_b128 a[188:191], v3 offset:23552
  v_cvt_pk_bf16_f32 v186, v220, v221
  v_add_f32 v226, v226, v222
  v_mfma_f32_16x16x32_bf16 v[140:143], a[156:159], v[92:95], v[140:143]
  s_waitcnt lgkmcnt(4)
  v_exp_f32 v217, v153
  v_mfma_f32_16x16x32_bf16 a[64:67], a[160:163], v[176:179], a[64:67]
  ds_read_b128 a[128:131], v3 offset:0
  v_add_f32 v226, v226, v223
  v_cvt_pk_bf16_f32 v187, v222, v223
  v_mfma_f32_16x16x32_bf16 a[68:71], a[160:163], v[180:183], a[68:71]
  v_exp_f32 v218, v154
  v_mfma_f32_16x16x32_bf16 a[72:75], a[164:167], v[176:179], a[72:75]
  ds_read_b128 a[132:135], v3 offset:1024
  buffer_load_dwordx4 v2, s[44:47], s26 offen offset:2048 sc1 lds
  v_add_f32 v227, v216, v217
  v_mfma_f32_16x16x32_bf16 a[76:79], a[164:167], v[180:183], a[76:79]
  v_exp_f32 v219, v155
  v_mfma_f32_16x16x32_bf16 a[80:83], a[168:171], v[176:179], a[80:83]
  ds_read_b128 a[136:139], v3 offset:2048
  v_cvt_pk_bf16_f32 v188, v216, v217
  v_mfma_f32_16x16x32_bf16 a[84:87], a[168:171], v[180:183], a[84:87]
  v_exp_f32 v220, v156
  v_add_f32 v227, v227, v218
  v_mfma_f32_16x16x32_bf16 a[88:91], a[172:175], v[176:179], a[88:91]
  ds_read_b128 a[140:143], v3 offset:3072
  v_add_f32 v227, v227, v219
  v_mfma_f32_16x16x32_bf16 a[92:95], a[172:175], v[180:183], a[92:95]
  s_waitcnt lgkmcnt(4)
  v_exp_f32 v221, v157
  v_cvt_pk_bf16_f32 v189, v218, v219
  v_mfma_f32_16x16x32_bf16 a[96:99], a[176:179], v[176:179], a[96:99]
  ds_read_b128 a[144:147], v3 offset:4096
  buffer_load_dwordx4 v2, s[44:47], s26 offen offset:3072 sc1 lds
  v_mfma_f32_16x16x32_bf16 a[100:103], a[176:179], v[180:183], a[100:103]
  s_add_u32 s26, s26, 16384
  v_exp_f32 v222, v158
  v_add_f32 v227, v227, v220
  v_mfma_f32_16x16x32_bf16 a[104:107], a[180:183], v[176:179], a[104:107]
  s_add_u32 s24, s24, 32768
  ds_read_b128 a[148:151], v3 offset:5120
  v_add_f32 v227, v227, v221
  v_mfma_f32_16x16x32_bf16 a[108:111], a[180:183], v[180:183], a[108:111]
  s_and_b32 s24, s24, 0x1ffff
  v_exp_f32 v223, v159
  v_cvt_pk_bf16_f32 v190, v220, v221
  v_mfma_f32_16x16x32_bf16 a[112:115], a[184:187], v[176:179], a[112:115]
  ds_read_b128 a[152:155], v3 offset:6144
  v_add_f32 v227, v227, v222
  v_mfma_f32_16x16x32_bf16 a[116:119], a[184:187], v[180:183], a[116:119]
  v_add_f32 v227, v227, v223
  v_cvt_pk_bf16_f32 v191, v222, v223
  v_max_f32 v5, v226, v227
  v_mfma_f32_16x16x32_bf16 a[120:123], a[188:191], v[176:179], a[120:123]
  s_waitcnt lgkmcnt(3)
  ds_read_b128 a[156:159], v3 offset:7168
  v_cmp_lt_f32 vcc, s81, v5
  v_mfma_f32_16x16x32_bf16 a[124:127], a[188:191], v[180:183], a[124:127]
  s_cbranch_vccnz fa_stub9
fa_back9:
  v_add_f32 v230, v230, v226
  v_add_f32 v231, v231, v227
  v_mfma_f32_16x16x32_bf16 v[144:147], a[128:131], v[64:67], v[200:203]
  ds_read_b128 a[160:163], v3 offset:24576
  v_exp_f32 v216, v128
  v_mfma_f32_16x16x32_bf16 v[152:155], a[128:131], v[68:71], v[204:207]
  v_exp_f32 v217, v129
  v_mfma_f32_16x16x32_bf16 v[148:151], a[132:135], v[64:67], v[200:203]
  ds_read_b128 a[164:167], v3 offset:25600
  v_add_f32 v226, v216, v217
  v_mfma_f32_16x16x32_bf16 v[156:159], a[132:135], v[68:71], v[204:207]
  s_mov_b32 m0, s25
  v_exp_f32 v218, v130
  v_cvt_pk_bf16_f32 v176, v216, v217
  v_mfma_f32_16x16x32_bf16 v[144:147], a[136:139], v[72:75], v[144:147]
  ds_read_b128 a[168:171], v3 offset:26624
  buffer_load_dwordx4 v2, s[48:51], s27 offen offset:0 sc1 lds
  v_mfma_f32_16x16x32_bf16 v[152:155], a[136:139], v[76:79], v[152:155]
  v_exp_f32 v219, v131
  v_add_f32 v226, v226, v218
  v_mfma_f32_16x16x32_bf16 v[148:151], a[140:143], v[72:75], v[148:151]
  ds_read_b128 a[172:175], v3 offset:27648
  v_add_f32 v226, v226, v219
  v_mfma_f32_16x16x32_bf16 v[156:159], a[140:143], v[76:79], v[156:159]
  s_waitcnt lgkmcnt(4)
  v_exp_f32 v220, v132
  v_cvt_pk_bf16_f32 v177, v218, v219
  v_mfma_f32_16x16x32_bf16 v[144:147], a[144:147], v[80:83], v[144:147]
  ds_read_b128 a[176:179], v3 offset:28672
  v_add_f32 v226, v226, v220
  v_mfma_f32_16x16x32_bf16 v[152:155], a[144:147], v[84:87], v[152:155]
  v_exp_f32 v221, v133
  v_exp_f32 v222, v134
  v_mfma_f32_16x16x32_bf16 v[148:151], a[148:151], v[80:83], v[148:151]
  ds_read_b128 a[180:183], v3 offset:29696
  buffer_load_dwordx4 v2, s[48:51], s27 offen offset:1024 sc1 lds
  v_mfma_f32_16x16x32_bf16 v[156:159], a[148:151], v[84:87], v[156:159]
  v_exp_f32 v223, v135
  v_mfma_f32_16x16x32_bf16 v[144:147], a[152:155], v[88:91], v[144:147]
  ds_read_b128 a[184:187], v3 offset:30720
  v_add_f32 v226, v226, v221
  v_mfma_f32_16x16x32_bf16 v[152:155], a[152:155], v[92:95], v[152:155]
  v_exp_f32 v216, v136
  v_mfma_f32_16x16x32_bf16 v[148:151], a[156:159], v[88:91], v[148:151]
  ds_read_b128 a[188:191], v3 offset:31744
  v_cvt_pk_bf16_f32 v178, v220, v221
  v_add_f32 v226, v226, v222
  v_mfma_f32_16x16x32_bf16 v[156:159], a[156:159], v[92:95], v[156:159]
  s_waitcnt lgkmcnt(4)
  v_exp_f32 v217, v137
  v_mfma_f32_16x16x32_bf16 a[64:67], a[160:163], v[184:187], a[64:67]
  ds_read_b128 a[128:131], v3 offset:8192
  v_add_f32 v226, v226, v223
  v_cvt_pk_bf16_f32 v179, v222, v223
  v_mfma_f32_16x16x32_bf16 a[68:71], a[160:163], v[188:191], a[68:71]
  v_exp_f32 v218, v138
  v_mfma_f32_16x16x32_bf16 a[72:75], a[164:167], v[184:187], a[72:75]
  ds_read_b128 a[132:135], v3 offset:9216
  buffer_load_dwordx4 v2, s[48:51], s27 offen offset:2048 sc1 lds
  v_add_f32 v227, v216, v217
  v_mfma_f32_16x16x32_bf16 a[76:79], a[164:167], v[188:191], a[76:79]
  v_exp_f32 v219, v139
  v_mfma_f32_16x16x32_bf16 a[80:83], a[168:171], v[184:187], a[80:83]
  ds_read_b128 a[136:139], v3 offset:10240
  v_cvt_pk_bf16_f32 v180, v216, v217
  v_mfma_f32_16x16x32_bf16 a[84:87], a[168:171], v[188:191], a[84:87]
  v_exp_f32 v220, v140
  v_add_f32 v227, v227, v218
  v_mfma_f32_16x16x32_bf16 a[88:91], a[172:175], v[184:187], a[88:91]
  ds_read_b128 a[140:143], v3 offset:11264
  v_add_f32 v227, v227, v219
  v_mfma_f32_16x16x32_bf16 a[92:95], a[172:175], v[188:191], a[92:95]
  s_waitcnt lgkmcnt(4)
  v_exp_f32 v221, v141
  v_cvt_pk_bf16_f32 v181, v218, v219
  v_mfma_f32_16x16x32_bf16 a[96:99], a[176:179], v[184:187], a[96:99]
  ds_read_b128 a[144:147], v3 offset:12288
  buffer_load_dwordx4 v2, s[48:51], s27 offen offset:3072 sc1 lds
  v_mfma_f32_16x16x32_bf16 a[100:103], a[176:179], v[188:191], a[100:103]
  s_add_u32 s27, s27, 16384
  v_exp_f32 v222, v142
  v_add_f32 v227, v227, v220
  v_mfma_f32_16x16x32_bf16 a[104:107], a[180:183], v[184:187], a[104:107]
  s_add_u32 s25, s25, 32768
  ds_read_b128 a[148:151], v3 offset:13312
  v_add_f32 v227, v227, v221
  v_mfma_f32_16x16x32_bf16 a[108:111], a[180:183], v[188:191], a[108:111]
  s_and_b32 s25, s25, 0x1ffff
  v_exp_f32 v223, v143
  v_cvt_pk_bf16_f32 v182, v220, v221
  v_mfma_f32_16x16x32_bf16 a[112:115], a[184:187], v[184:187], a[112:115]
  ds_read_b128 a[152:155], v3 offset:14336
  v_add_f32 v227, v227, v222
  v_mfma_f32_16x16x32_bf16 a[116:119], a[184:187], v[188:191], a[116:119]
  s_sub_u32 s29, s29, 1
  v_add_f32 v227, v227, v223
  v_cvt_pk_bf16_f32 v183, v222, v223
  v_max_f32 v5, v226, v227
  v_mfma_f32_16x16x32_bf16 a[120:123], a[188:191], v[184:187], a[120:123]
  s_waitcnt lgkmcnt(3)
  ds_read_b128 a[156:159], v3 offset:15360
  v_cmp_lt_f32 vcc, s81, v5
  v_mfma_f32_16x16x32_bf16 a[124:127], a[188:191], v[188:191], a[124:127]
  s_cbranch_vccnz fa_stub10
fa_back10:
  v_add_f32 v230, v230, v226
  v_add_f32 v231, v231, v227
  v_add_u32 v3, 32768, v3
  v_and_b32 v3, 0x1ffff, v3
  s_cmp_gt_u32 s29, 8
  s_cbranch_scc1 fa_SS
fa_chain:
fa_hb3:
  s_cmp_lt_u32 s12, 2
  s_cbranch_scc1 fa_hk3
  s_cmp_eq_u32 s29, 8
  s_cbranch_scc0 fa_disp
fa_SSW8:
  v_mfma_f32_16x16x32_bf16 v[128:131], a[128:131], v[64:67], v[200:203]
  s_waitcnt vmcnt(12)
  v_exp_f32 v216, v144
  v_exp_f32 v217, v145
  v_mfma_f32_16x16x32_bf16 v[136:139], a[128:131], v[68:71], v[204:207]
  s_barrier
  v_exp_f32 v218, v146
  v_mfma_f32_16x16x32_bf16 v[132:135], a[132:135], v[64:67], v[200:203]
  s_cmp_ge_u32 s26, s32
  ds_read_b128 a[160:163], v3 offset:16384
  ds_read_b128 a[164:167], v3 offset:17408
  v_mfma_f32_16x16x32_bf16 v[140:143], a[132:135], v[68:71], v[204:207]
  s_cbranch_scc1 fa_hk5
fa_hb5:
  s_mov_b32 m0, s24
  v_exp_f32 v219, v147
  v_mfma_f32_16x16x32_bf16 v[128:131], a[136:139], v[72:75], v[128:131]
  ds_read_b128 a[168:171], v3 offset:18432
  buffer_load_dwordx4 v2, s[44:47], s26 offen offset:0 sc1 lds
  v_add_f32 v226, v216, v217
  v_mfma_f32_16x16x32_bf16 v[136:139], a[136:139], v[76:79], v[136:139]
  v_exp_f32 v220, v148
  v_mfma_f32_16x16x32_bf16 v[132:135], a[140:143], v[72:75], v[132:135]
  ds_read_b128 a[172:175], v3 offset:19456
  v_cvt_pk_bf16_f32 v184, v216, v217
  v_add_f32 v226, v226, v218
  v_mfma_f32_16x16x32_bf16 v[140:143], a[140:143], v[76:79], v[140:143]
  s_add_u32 s14, s13, 0
  s_waitcnt lgkmcnt(4)
  buffer_load_dwordx4 a[0:3], v2, s[40:43], s14 offen offset:0 sc1
  v_add_f32 v226, v226, v219
  v_mfma_f32_16x16x32_bf16 v[128:131], a[144:147], v[80:83], v[128:131]
  ds_read_b128 a[176:179], v3 offset:20480
  v_cvt_pk_bf16_f32 v185, v218, v219
  v_add_f32 v226, v226, v220
  v_mfma_f32_16x16x32_bf16 v[136:139], a[144:147], v[84:87], v[136:139]
  v_exp_f32 v221, v149
  v_mfma_f32_16x16x32_bf16 v[132:135], a[148:151], v[80:83], v[132:135]
  ds_read_b128 a[180:183], v3 offset:21504
  buffer_load_dwordx4 v2, s[44:47], s26 offen offset:1024 sc1 lds
  v_add_f32 v226, v226, v221
  v_mfma_f32_16x16x32_bf16 v[140:143], a[148:151], v[84:87], v[140:143]
  v_exp_f32 v222, v150
  v_cvt_pk_bf16_f32 v186, v220, v221
  v_mfma_f32_16x16x32_bf16 v[128:131], a[152:155], v[88:91], v[128:131]
  ds_read_b128 a[184:187], v3 offset:22528
  v_add_f32 v226, v226, v222
  v_mfma_f32_16x16x32_bf16 v[136:139], a[152:155], v[92:95], v[136:139]
  v_exp_f32 v223, v151
  v_exp_f32 v216, v152
  v_mfma_f32_16x16x32_bf16 v[132:135], a[156:159], v[88:91], v[132:135]
  ds_read_b128 a[188:191], v3 offset:23552
  buffer_load_dwordx4 a[4:7], v2, s[40:43], s14 offen offset:1024 sc1
  v_mfma_f32_16x16x32_bf16 v[140:143], a[156:159], v[92:95], v[140:143]
  s_waitcnt lgkmcnt(4)
  v_exp_f32 v217, v153
  v_mfma_f32_16x16x32_bf16 a[64:67], a[160:163], v[176:179], a[64:67]
  ds_read_b128 a[128:131], v3 offset:0
  v_add_f32 v226, v226, v223
  v_mfma_f32_16x16x32_bf16 a[68:71], a[160:163], v[180:183], a[68:71]
  v_exp_f32 v218, v154
  v_cvt_pk_bf16_f32 v187, v222, v223
  v_mfma_f32_16x16x32_bf16 a[72:75], a[164:167], v[176:179], a[72:75]
  ds_read_b128 a[132:135], v3 offset:1024
  buffer_load_dwordx4 v2, s[44:47], s26 offen offset:2048 sc1 lds
  v_mfma_f32_16x16x32_bf16 a[76:79], a[164:167], v[180:183], a[76:79]
  v_exp_f32 v219, v155
  v_add_f32 v227, v216, v217
  v_mfma_f32_16x16x32_bf16 a[80:83], a[168:171], v[176:179], a[80:83]
  ds_read_b128 a[136:139], v3 offset:2048
  v_cvt_pk_bf16_f32 v188, v216, v217
  v_add_f32 v227, v227, v218
  v_mfma_f32_16x16x32_bf16 a[84:87], a[168:171], v[180:183], a[84:87]
  buffer_load_dwordx4 a[8:11], v2, s[40:43], s14 offen offset:2048 sc1
  v_add_f32 v227, v227, v219
  v_mfma_f32_16x16x32_bf16 a[88:91], a[172:175], v[176:179], a[88:91]
  ds_read_b128 a[140:143], v3 offset:3072
  v_cvt_pk_bf16_f32 v189, v218, v219
  v_exp_f32 v220, v156
  v_mfma_f32_16x16x32_bf16 a[92:95], a[172:175], v[180:183], a[92:95]
  s_waitcnt lgkmcnt(4)
  v_exp_f32 v221, v157
  v_mfma_f32_16x16x32_bf16 a[96:99], a[176:179], v[176:179], a[96:99]
  ds_read_b128 a[144:147], v3 offset:4096
  buffer_load_dwordx4 v2, s[44:47], s26 offen offset:3072 sc1 lds
  v_mfma_f32_16x16x32_bf16 a[100:103], a[176:179], v[180:183], a[100:103]
  s_add_u32 s26, s26, 16384
  v_exp_f32 v222, v158
  v_mfma_f32_16x16x32_bf16 a[104:107], a[180:183], v[176:179], a[104:107]
  s_add_u32 s24, s24, 32768
  ds_read_b128 a[148:151], v3 offset:5120
  v_add_f32 v227, v227, v220
  v_add_f32 v227, v227, v221
  v_mfma_f32_16x16x32_bf16 a[108:111], a[180:183], v[180:183], a[108:111]
  s_and_b32 s24, s24, 0x1ffff
  v_exp_f32 v223, v159
  v_mfma_f32_16x16x32_bf16 a[112:115], a[184:187], v[176:179], a[112:115]
  ds_read_b128 a[152:155], v3 offset:6144
  v_cvt_pk_bf16_f32 v190, v220, v221
  v_add_f32 v227, v227, v222
  v_mfma_f32_16x16x32_bf16 a[116:119], a[184:187], v[180:183], a[116:119]
  v_add_f32 v227, v227, v223
  v_cvt_pk_bf16_f32 v191, v222, v223
  v_mfma_f32_16x16x32_bf16 a[120:123], a[188:191], v[176:179], a[120:123]
  s_waitcnt lgkmcnt(3)
  ds_read_b128 a[156:159], v3 offset:7168
  v_max_f32 v5, v226, v227
  v_cmp_lt_f32 vcc, s81, v5
  v_mfma_f32_16x16x32_bf16 a[124:127], a[188:191], v[180:183], a[124:127]
  s_cbranch_vccnz fa_stub11
fa_back11:
  v_add_f32 v230, v230, v226
  v_add_f32 v231, v231, v227
  v_mfma_f32_16x16x32_bf16 v[144:147], a[128:131], v[64:67], v[200:203]
  ds_read_b128 a[160:163], v3 offset:24576
  v_exp_f32 v216, v128
  v_mfma_f32_16x16x32_bf16 v[152:155], a[128:131], v[68:71], v[204:207]
  v_exp_f32 v217, v129
  v_mfma_f32_16x16x32_bf16 v[148:151], a[132:135], v[64:67], v[200:203]
  ds_read_b128 a[164:167], v3 offset:25600
  v_add_f32 v226, v216, v217
  v_cvt_pk_bf16_f32 v176, v216, v217
  v_mfma_f32_16x16x32_bf16 v[156:159], a[132:135], v[68:71], v[204:207]
  s_mov_b32 m0, s25
  v_exp_f32 v218, v130
  v_mfma_f32_16x16x32_bf16 v[144:147], a[136:139], v[72:75], v[144:147]
  ds_read_b128 a[168:171], v3 offset:26624
  buffer_load_dwordx4 v2, s[48:51], s27 offen offset:0 sc1 lds
  v_add_f32 v226, v226, v218
  v_mfma_f32_16x16x32_bf16 v[152:155], a[136:139], v[76:79], v[152:155]
  v_exp_f32 v219, v131
  v_mfma_f32_16x16x32_bf16 v[148:151], a[140:143], v[72:75], v[148:151]
  ds_read_b128 a[172:175], v3 offset:27648
  v_add_f32 v226, v226, v219
  v_cvt_pk_bf16_f32 v177, v218, v219
  v_mfma_f32_16x16x32_bf16 v[156:159], a[140:143], v[76:79], v[156:159]
  s_add_u32 s14, s13, 0
  s_waitcnt lgkmcnt(4)
  buffer_load_dwordx4 a[12:15], v2, s[40:43], s14 offen offset:3072 sc1
  v_exp_f32 v220, v132
  v_mfma_f32_16x16x32_bf16 v[144:147], a[144:147], v[80:83], v[144:147]
  ds_read_b128 a[176:179], v3 offset:28672
  v_add_f32 v226, v226, v220
  v_mfma_f32_16x16x32_bf16 v[152:155], a[144:147], v[84:87], v[152:155]
  v_exp_f32 v221, v133
  v_mfma_f32_16x16x32_bf16 v[148:151], a[148:151], v[80:83], v[148:151]
  ds_read_b128 a[180:183], v3 offset:29696
  buffer_load_dwordx4 v2, s[48:51], s27 offen offset:1024 sc1 lds
  v_add_f32 v226, v226, v221
  v_mfma_f32_16x16x32_bf16 v[156:159], a[148:151], v[84:87], v[156:159]
  v_exp_f32 v222, v134
  v_cvt_pk_bf16_f32 v178, v220, v221
  v_mfma_f32_16x16x32_bf16 v[144:147], a[152:155], v[88:91], v[144:147]
  ds_read_b128 a[184:187], v3 offset:30720
  v_add_f32 v226, v226, v222
  v_mfma_f32_16x16x32_bf16 v[152:155], a[152:155], v[92:95], v[152:155]
  v_exp_f32 v223, v135
  v_exp_f32 v216, v136
  v_mfma_f32_16x16x32_bf16 v[148:151], a[156:159], v[88:91], v[148:151]
  s_add_u32 s14, s13, 4096
  ds_read_b128 a[188:191], v3 offset:31744
  buffer_load_dwordx4 a[16:19], v2, s[40:43], s14 offen offset:0 sc1
  v_mfma_f32_16x16x32_bf16 v[156:159], a[156:159], v[92:95], v[156:159]
  s_waitcnt lgkmcnt(4)
  v_exp_f32 v217, v137
  v_mfma_f32_16x16x32_bf16 a[64:67], a[160:163], v[184:187], a[64:67]
  ds_read_b128 a[128:131], v3 offset:8192
  v_add_f32 v226, v226, v223
  v_mfma_f32_16x16x32_bf16 a[68:71], a[160:163], v[188:191], a[68:71]
  v_exp_f32 v218, v138
  v_cvt_pk_bf16_f32 v179, v222, v223
  v_mfma_f32_16x16x32_bf16 a[72:75], a[164:167], v[184:187], a[72:75]
  ds_read_b128 a[132:135], v3 offset:9216
  buffer_load_dwordx4 v2, s[48:51], s27 offen offset:2048 sc1 lds
  v_mfma_f32_16x16x32_bf16 a[76:79], a[164:167], v[188:191], a[76:79]
  v_exp_f32 v219, v139
  v_add_f32 v227, v216, v217
  v_mfma_f32_16x16x32_bf16 a[80:83], a[168:171], v[184:187], a[80:83]
  ds_read_b128 a[136:139], v3 offset:10240
  v_cvt_pk_bf16_f32 v180, v216, v217
  v_add_f32 v227, v227, v218
  v_mfma_f32_16x16x32_bf16 a[84:87], a[168:171], v[188:191], a[84:87]
  buffer_load_dwordx4 a[20:23], v2, s[40:43], s14 offen offset:1024 sc1
  v_add_f32 v227, v227, v219
  v_mfma_f32_16x16x32_bf16 a[88:91], a[172:175], v[184:187], a[88:91]
  ds_read_b128 a[140:143], v3 offset:11264
  v_cvt_pk_bf16_f32 v181, v218, v219
  v_exp_f32 v220, v140
  v_mfma_f32_16x16x32_bf16 a[92:95], a[172:175], v[188:191], a[92:95]
  s_waitcnt lgkmcnt(4)
  v_exp_f32 v221, v141
  v_mfma_f32_16x16x32_bf16 a[96:99], a[176:179], v[184:187], a[96:99]
  ds_read_b128 a[144:147], v3 offset:12288
  buffer_load_dwordx4 v2, s[48:51], s27 offen offset:3072 sc1 lds
  v_mfma_f32_16x16x32_bf16 a[100:103], a[176:179], v[188:191], a[100:103]
  s_add_u32 s27, s27, 16384
  v_exp_f32 v222, v142
  v_mfma_f32_16x16x32_bf16 a[104:107], a[180:183], v[184:187], a[104:107]
  s_add_u32 s25, s25, 32768
  ds_read_b128 a[148:151], v3 offset:13312
  v_add_f32 v227, v227, v220
  v_add_f32 v227, v227, v221
  v_mfma_f32_16x16x32_bf16 a[108:111], a[180:183], v[188:191], a[108:111]
  s_and_b32 s25, s25, 0x1ffff
  v_exp_f32 v223, v143
  v_mfma_f32_16x16x32_bf16 a[112:115], a[184:187], v[184:187], a[112:115]
  ds_read_b128 a[152:155], v3 offset:14336
  v_cvt_pk_bf16_f32 v182, v220, v221
  v_add_f32 v227, v227, v222
  v_mfma_f32_16x16x32_bf16 a[116:119], a[184:187], v[188:191], a[116:119]
  v_add_f32 v227, v227, v223
  v_cvt_pk_bf16_f32 v183, v222, v223
  v_mfma_f32_16x16x32_bf16 a[120:123], a[188:191], v[184:187], a[120:123]
  s_waitcnt lgkmcnt(3)
  ds_read_b128 a[156:159], v3 offset:15360
  v_max_f32 v5, v226, v227
  v_cmp_lt_f32 vcc, s81, v5
  v_mfma_f32_16x16x32_bf16 a[124:127], a[188:191], v[188:191], a[124:127]
  s_cbranch_vccnz fa_stub12
fa_back12:
  v_add_f32 v230, v230, v226
  v_add_f32 v231, v231, v227
  v_add_u32 v3, 32768, v3
  v_and_b32 v3, 0x1ffff, v3
fa_SSW7:
  v_mfma_f32_16x16x32_bf16 v[128:131], a[128:131], v[64:67], v[200:203]
  s_waitcnt vmcnt(12)
  v_exp_f32 v216, v144
  v_exp_f32 v217, v145
  v_mfma_f32_16x16x32_bf16 v[136:139], a[128:131], v[68:71], v[204:207]
  s_barrier
  v_exp_f32 v218, v146
  v_mfma_f32_16x16x32_bf16 v[132:135], a[132:135], v[64:67], v[200:203]
  s_cmp_ge_u32 s26, s32
  ds_read_b128 a[160:163], v3 offset:16384
  ds_read_b128 a[164:167], v3 offset:17408
  v_mfma_f32_16x16x32_bf16 v[140:143], a[132:135], v[68:71], v[204:207]
  s_cbranch_scc1 fa_hk6
fa_hb6:
  s_mov_b32 m0, s24
  v_exp_f32 v219, v147
  v_mfma_f32_16x16x32_bf16 v[128:131], a[136:139], v[72:75], v[128:131]
  ds_read_b128 a[168:171], v3 offset:18432
  buffer_load_dwordx4 v2, s[44:47], s26 offen offset:0 sc1 lds
  v_add_f32 v226, v216, v217
  v_mfma_f32_16x16x32_bf16 v[136:139], a[136:139], v[76:79], v[136:139]
  v_exp_f32 v220, v148
  v_mfma_f32_16x16x32_bf16 v[132:135], a[140:143], v[72:75], v[132:135]
  ds_read_b128 a[172:175], v3 offset:19456
  v_cvt_pk_bf16_f32 v184, v216, v217
  v_add_f32 v226, v226, v218
  v_mfma_f32_16x16x32_bf16 v[140:143], a[140:143], v[76:79], v[140:143]
  s_add_u32 s14, s13, 4096
  s_waitcnt lgkmcnt(4)
  buffer_load_dwordx4 a[24:27], v2, s[40:43], s14 offen offset:2048 sc1
  v_add_f32 v226, v226, v219
  v_mfma_f32_16x16x32_bf16 v[128:131], a[144:147], v[80:83], v[128:131]
  ds_read_b128 a[176:179], v3 offset:20480
  v_cvt_pk_bf16_f32 v185, v218, v219
  v_add_f32 v226, v226, v220
  v_mfma_f32_16x16x32_bf16 v[136:139], a[144:147], v[84:87], v[136:139]
  v_exp_f32 v221, v149
  v_mfma_f32_16x16x32_bf16 v[132:135], a[148:151], v[80:83], v[132:135]
  ds_read_b128 a[180:183], v3 offset:21504
  buffer_load_dwordx4 v2, s[44:47], s26 offen offset:1024 sc1 lds
  v_add_f32 v226, v226, v221
  v_mfma_f32_16x16x32_bf16 v[140:143], a[148:151], v[84:87], v[140:143]
  v_exp_f32 v222, v150
  v_cvt_pk_bf16_f32 v186, v220, v221
  v_mfma_f32_16x16x32_bf16 v[128:131], a[152:155], v[88:91], v[128:131]
  ds_read_b128 a[184:187], v3 offset:22528
  v_add_f32 v226, v226, v222
  v_mfma_f32_16x16x32_bf16 v[136:139], a[152:155], v[92:95], v[136:139]
  v_exp_f32 v223, v151
  v_exp_f32 v216, v152
  v_mfma_f32_16x16x32_bf16 v[132:135], a[156:159], v[88:91], v[132:135]
  ds_read_b128 a[188:191], v3 offset:23552
  buffer_load_dwordx4 a[28:31], v2, s[40:43], s14 offen offset:3072 sc1
  v_mfma_f32_16x16x32_bf16 v[140:143], a[156:159], v[92:95], v[140:143]
  s_waitcnt lgkmcnt(4)
  v_exp_f32 v217, v153
  v_mfma_f32_16x16x32_bf16 a[64:67], a[160:163], v[176:179], a[64:67]
  ds_read_b128 a[128:131], v3 offset:0
  v_add_f32 v226, v226, v223
  v_mfma_f32_16x16x32_bf16 a[68:71], a[160:163], v[180:183], a[68:71]
  v_exp_f32 v218, v154
  v_cvt_pk_bf16_f32 v187, v222, v223
  v_mfma_f32_16x16x32_bf16 a[72:75], a[164:167], v[176:179], a[72:75]
  ds_read_b128 a[132:135], v3 offset:1024
  buffer_load_dwordx4 v2, s[44:47], s26 offen offset:2048 sc1 lds
  v_mfma_f32_16x16x32_bf16 a[76:79], a[164:167], v[180:183], a[76:79]
  v_exp_f32 v219, v155
  v_add_f32 v227, v216, v217
  v_mfma_f32_16x16x32_bf16 a[80:83], a[168:171], v[176:179], a[80:83]
  ds_read_b128 a[136:139], v3 offset:2048
  v_cvt_pk_bf16_f32 v188, v216, v217
  v_add_f32 v227, v227, v218
  v_mfma_f32_16x16x32_bf16 a[84:87], a[168:171], v[180:183], a[84:87]
  s_add_u32 s14, s13, 8192
  buffer_load_dwordx4 a[32:35], v2, s[40:43], s14 offen offset:0 sc1
  v_add_f32 v227, v227, v219
  v_mfma_f32_16x16x32_bf16 a[88:91], a[172:175], v[176:179], a[88:91]
  ds_read_b128 a[140:143], v3 offset:3072
  v_cvt_pk_bf16_f32 v189, v218, v219
  v_exp_f32 v220, v156
  v_mfma_f32_16x16x32_bf16 a[92:95], a[172:175], v[180:183], a[92:95]
  s_waitcnt lgkmcnt(4)
  v_exp_f32 v221, v157
  v_mfma_f32_16x16x32_bf16 a[96:99], a[176:179], v[176:179], a[96:99]
  ds_read_b128 a[144:147], v3 offset:4096
  buffer_load_dwordx4 v2, s[44:47], s26 offen offset:3072 sc1 lds
  v_mfma_f32_16x16x32_bf16 a[100:103], a[176:179], v[180:183], a[100:103]
  s_add_u32 s26, s26, 16384
  v_exp_f32 v222, v158
  v_mfma_f32_16x16x32_bf16 a[104:107], a[180:183], v[176:179], a[104:107]
  s_add_u32 s24, s24, 32768
  ds_read_b128 a[148:151], v3 offset:5120
  v_add_f32 v227, v227, v220
  v_add_f32 v227, v227, v221
  v_mfma_f32_16x16x32_bf16 a[108:111], a[180:183], v[180:183], a[108:111]
  s_and_b32 s24, s24, 0x1ffff
  v_exp_f32 v223, v159
  v_mfma_f32_16x16x32_bf16 a[112:115], a[184:187], v[176:179], a[112:115]
  ds_read_b128 a[152:155], v3 offset:6144
  v_cvt_pk_bf16_f32 v190, v220, v221
  v_add_f32 v227, v227, v222
  v_mfma_f32_16x16x32_bf16 a[116:119], a[184:187], v[180:183], a[116:119]
  v_add_f32 v227, v227, v223
  v_cvt_pk_bf16_f32 v191, v222, v223
  v_mfma_f32_16x16x32_bf16 a[120:123], a[188:191], v[176:179], a[120:123]
  s_waitcnt lgkmcnt(3)
  ds_read_b128 a[156:159], v3 offset:7168
  v_max_f32 v5, v226, v227
  v_cmp_lt_f32 vcc, s81, v5
  v_mfma_f32_16x16x32_bf16 a[124:127], a[188:191], v[180:183], a[124:127]
  s_cbranch_vccnz fa_stub13
fa_back13:
  v_add_f32 v230, v230, v226
  v_add_f32 v231, v231, v227
  v_mfma_f32_16x16x32_bf16 v[144:147], a[128:131], v[64:67], v[200:203]
  ds_read_b128 a[160:163], v3 offset:24576
  v_exp_f32 v216, v128
  v_mfma_f32_16x16x32_bf16 v[152:155], a[128:131], v[68:71], v[204:207]
  v_exp_f32 v217, v129
  v_mfma_f32_16x16x32_bf16 v[148:151], a[132:135], v[64:67], v[200:203]
  ds_read_b128 a[164:167], v3 offset:25600
  v_add_f32 v226, v216, v217
  v_cvt_pk_bf16_f32 v176, v216, v217
  v_mfma_f32_16x16x32_bf16 v[156:159], a[132:135], v[68:71], v[204:207]
  s_mov_b32 m0, s25
  v_exp_f32 v218, v130
  v_mfma_f32_16x16x32_bf16 v[144:147], a[136:139], v[72:75], v[144:147]
  ds_read_b128 a[168:171], v3 offset:26624
  buffer_load_dwordx4 v2, s[48:51], s27 offen offset:0 sc1 lds
  v_add_f32 v226, v226, v218
  v_mfma_f32_16x16x32_bf16 v[152:155], a[136:139], v[76:79], v[152:155]
  v_exp_f32 v219, v131
  v_mfma_f32_16x16x32_bf16 v[148:151], a[140:143], v[72:75], v[148:151]
  ds_read_b128 a[172:175], v3 offset:27648
  v_add_f32 v226, v226, v219
  v_cvt_pk_bf16_f32 v177, v218, v219
  v_mfma_f32_16x16x32_bf16 v[156:159], a[140:143], v[76:79], v[156:159]
  s_add_u32 s14, s13, 8192
  s_waitcnt lgkmcnt(4)
  buffer_load_dwordx4 a[36:39], v2, s[40:43], s14 offen offset:1024 sc1
  v_exp_f32 v220, v132
  v_mfma_f32_16x16x32_bf16 v[144:147], a[144:147], v[80:83], v[144:147]
  ds_read_b128 a[176:179], v3 offset:28672
  v_add_f32 v226, v226, v220
  v_mfma_f32_16x16x32_bf16 v[152:155], a[144:147], v[84:87], v[152:155]
  v_exp_f32 v221, v133
  v_mfma_f32_16x16x32_bf16 v[148:151], a[148:151], v[80:83], v[148:151]
  ds_read_b128 a[180:183], v3 offset:29696
  buffer_load_dwordx4 v2, s[48:51], s27 offen offset:1024 sc1 lds
  v_add_f32 v226, v226, v221
  v_mfma_f32_16x16x32_bf16 v[156:159], a[148:151], v[84:87], v[156:159]
  v_exp_f32 v222, v134
  v_cvt_pk_bf16_f32 v178, v220, v221
  v_mfma_f32_16x16x32_bf16 v[144:147], a[152:155], v[88:91], v[144:147]
  ds_read_b128 a[184:187], v3 offset:30720
  v_add_f32 v226, v226, v222
  v_mfma_f32_16x16x32_bf16 v[152:155], a[152:155], v[92:95], v[152:155]
  v_exp_f32 v223, v135
  v_exp_f32 v216, v136
  v_mfma_f32_16x16x32_bf16 v[148:151], a[156:159], v[88:91], v[148:151]
  ds_read_b128 a[188:191], v3 offset:31744
  buffer_load_dwordx4 a[40:43], v2, s[40:43], s14 offen offset:2048 sc1
  v_mfma_f32_16x16x32_bf16 v[156:159], a[156:159], v[92:95], v[156:159]
  s_waitcnt lgkmcnt(4)
  v_exp_f32 v217, v137
  v_mfma_f32_16x16x32_bf16 a[64:67], a[160:163], v[184:187], a[64:67]
  ds_read_b128 a[128:131], v3 offset:8192
  v_add_f32 v226, v226, v223
  v_mfma_f32_16x16x32_bf16 a[68:71], a[160:163], v[188:191], a[68:71]
  v_exp_f32 v218, v138
  v_cvt_pk_bf16_f32 v179, v222, v223
  v_mfma_f32_16x16x32_bf16 a[72:75], a[164:167], v[184:187], a[72:75]
  ds_read_b128 a[132:135], v3 offset:9216
  buffer_load_dwordx4 v2, s[48:51], s27 offen offset:2048 sc1 lds
  v_mfma_f32_16x16x32_bf16 a[76:79], a[164:167], v[188:191], a[76:79]
  v_exp_f32 v219, v139
  v_add_f32 v227, v216, v217
  v_mfma_f32_16x16x32_bf16 a[80:83], a[168:171], v[184:187], a[80:83]
  ds_read_b128 a[136:139], v3 offset:10240
  v_cvt_pk_bf16_f32 v180, v216, v217
  v_add_f32 v227, v227, v218
  v_mfma_f32_16x16x32_bf16 a[84:87], a[168:171], v[188:191], a[84:87]
  buffer_load_dwordx4 a[44:47], v2, s[40:43], s14 offen offset:3072 sc1
  v_add_f32 v227, v227, v219
  v_mfma_f32_16x16x32_bf16 a[88:91], a[172:175], v[184:187], a[88:91]
  ds_read_b128 a[140:143], v3 offset:11264
  v_cvt_pk_bf16_f32 v181, v218, v219
  v_exp_f32 v220, v140
  v_mfma_f32_16x16x32_bf16 a[92:95], a[172:175], v[188:191], a[92:95]
  s_waitcnt lgkmcnt(4)
  v_exp_f32 v221, v141
  v_mfma_f32_16x16x32_bf16 a[96:99], a[176:179], v[184:187], a[96:99]
  ds_read_b128 a[144:147], v3 offset:12288
  buffer_load_dwordx4 v2, s[48:51], s27 offen offset:3072 sc1 lds
  v_mfma_f32_16x16x32_bf16 a[100:103], a[176:179], v[188:191], a[100:103]
  s_add_u32 s27, s27, 16384
  v_exp_f32 v222, v142
  v_mfma_f32_16x16x32_bf16 a[104:107], a[180:183], v[184:187], a[104:107]
  s_add_u32 s25, s25, 32768
  ds_read_b128 a[148:151], v3 offset:13312
  v_add_f32 v227, v227, v220
  v_add_f32 v227, v227, v221
  v_mfma_f32_16x16x32_bf16 a[108:111], a[180:183], v[188:191], a[108:111]
  s_and_b32 s25, s25, 0x1ffff
  v_exp_f32 v223, v143
  v_mfma_f32_16x16x32_bf16 a[112:115], a[184:187], v[184:187], a[112:115]
  ds_read_b128 a[152:155], v3 offset:14336
  v_cvt_pk_bf16_f32 v182, v220, v221
  v_add_f32 v227, v227, v222
  v_mfma_f32_16x16x32_bf16 a[116:119], a[184:187], v[188:191], a[116:119]
  v_add_f32 v227, v227, v223
  v_cvt_pk_bf16_f32 v183, v222, v223
  v_mfma_f32_16x16x32_bf16 a[120:123], a[188:191], v[184:187], a[120:123]
  s_waitcnt lgkmcnt(3)
  ds_read_b128 a[156:159], v3 offset:15360
  v_max_f32 v5, v226, v227
  v_cmp_lt_f32 vcc, s81, v5
  v_mfma_f32_16x16x32_bf16 a[124:127], a[188:191], v[188:191], a[124:127]
  s_cbranch_vccnz fa_stub14
fa_back14:
  v_add_f32 v230, v230, v226
  v_add_f32 v231, v231, v227
  v_add_u32 v3, 32768, v3
  v_and_b32 v3, 0x1ffff, v3
fa_SSW6:
  v_mfma_f32_16x16x32_bf16 v[128:131], a[128:131], v[64:67], v[200:203]
  s_waitcnt vmcnt(12)
  v_exp_f32 v216, v144
  v_exp_f32 v217, v145
  v_mfma_f32_16x16x32_bf16 v[136:139], a[128:131], v[68:71], v[204:207]
  s_barrier
  v_exp_f32 v218, v146
  v_mfma_f32_16x16x32_bf16 v[132:135], a[132:135], v[64:67], v[200:203]
  s_cmp_ge_u32 s26, s32
  ds_read_b128 a[160:163], v3 offset:16384
  ds_read_b128 a[164:167], v3 offset:17408
  v_mfma_f32_16x16x32_bf16 v[140:143], a[132:135], v[68:71], v[204:207]
  s_cbranch_scc1 fa_hk7
fa_hb7:
  s_mov_b32 m0, s24
  v_exp_f32 v219, v147
  v_mfma_f32_16x16x32_bf16 v[128:131], a[136:139], v[72:75], v[128:131]
  ds_read_b128 a[168:171], v3 offset:18432
  buffer_load_dwordx4 v2, s[44:47], s26 offen offset:0 sc1 lds
  v_add_f32 v226, v216, v217
  v_mfma_f32_16x16x32_bf16 v[136:139], a[136:139], v[76:79], v[136:139]
  v_exp_f32 v220, v148
  v_mfma_f32_16x16x32_bf16 v[132:135], a[140:143], v[72:75], v[132:135]
  ds_read_b128 a[172:175], v3 offset:19456
  v_cvt_pk_bf16_f32 v184, v216, v217
  v_add_f32 v226, v226, v218
  v_mfma_f32_16x16x32_bf16 v[140:143], a[140:143], v[76:79], v[140:143]
  s_add_u32 s14, s13, 12288
  s_waitcnt lgkmcnt(4)
  buffer_load_dwordx4 a[48:51], v2, s[40:43], s14 offen offset:0 sc1
  v_add_f32 v226, v226, v219
  v_mfma_f32_16x16x32_bf16 v[128:131], a[144:147], v[80:83], v[128:131]
  ds_read_b128 a[176:179], v3 offset:20480
  v_cvt_pk_bf16_f32 v185, v218, v219
  v_add_f32 v226, v226, v220
  v_mfma_f32_16x16x32_bf16 v[136:139], a[144:147], v[84:87], v[136:139]
  v_exp_f32 v221, v149
  v_mfma_f32_16x16x32_bf16 v[132:135], a[148:151], v[80:83], v[132:135]
  ds_read_b128 a[180:183], v3 offset:21504
  buffer_load_dwordx4 v2, s[44:47], s26 offen offset:1024 sc1 lds
  v_add_f32 v226, v226, v221
  v_mfma_f32_16x16x32_bf16 v[140:143], a[148:151], v[84:87], v[140:143]
  v_exp_f32 v222, v150
  v_cvt_pk_bf16_f32 v186, v220, v221
  v_mfma_f32_16x16x32_bf16 v[128:131], a[152:155], v[88:91], v[128:131]
  ds_read_b128 a[184:187], v3 offset:22528
  v_add_f32 v226, v226, v222
  v_mfma_f32_16x16x32_bf16 v[136:139], a[152:155], v[92:95], v[136:139]
  v_exp_f32 v223, v151
  v_exp_f32 v216, v152
  v_mfma_f32_16x16x32_bf16 v[132:135], a[156:159], v[88:91], v[132:135]
  ds_read_b128 a[188:191], v3 offset:23552
  buffer_load_dwordx4 a[52:55], v2, s[40:43], s14 offen offset:1024 sc1
  v_mfma_f32_16x16x32_bf16 v[140:143], a[156:159], v[92:95], v[140:143]
  s_waitcnt lgkmcnt(4)
  v_exp_f32 v217, v153
  v_mfma_f32_16x16x32_bf16 a[64:67], a[160:163], v[176:179], a[64:67]
  ds_read_b128 a[128:131], v3 offset:0
  v_add_f32 v226, v226, v223
  v_mfma_f32_16x16x32_bf16 a[68:71], a[160:163], v[180:183], a[68:71]
  v_exp_f32 v218, v154
  v_cvt_pk_bf16_f32 v187, v222, v223
  v_mfma_f32_16x16x32_bf16 a[72:75], a[164:167], v[176:179], a[72:75]
  ds_read_b128 a[132:135], v3 offset:1024
  buffer_load_dwordx4 v2, s[44:47], s26 offen offset:2048 sc1 lds
  v_mfma_f32_16x16x32_bf16 a[76:79], a[164:167], v[180:183], a[76:79]
  v_exp_f32 v219, v155
  v_add_f32 v227, v216, v217
  v_mfma_f32_16x16x32_bf16 a[80:83], a[168:171], v[176:179], a[80:83]
  ds_read_b128 a[136:139], v3 offset:2048
  v_cvt_pk_bf16_f32 v188, v216, v217
  v_add_f32 v227, v227, v218
  v_mfma_f32_16x16x32_bf16 a[84:87], a[168:171], v[180:183], a[84:87]
  buffer_load_dwordx4 a[56:59], v2, s[40:43], s14 offen offset:2048 sc1
  v_add_f32 v227, v227, v219
  v_mfma_f32_16x16x32_bf16 a[88:91], a[172:175], v[176:179], a[88:91]
  ds_read_b128 a[140:143], v3 offset:3072
  v_cvt_pk_bf16_f32 v189, v218, v219
  v_exp_f32 v220, v156
  v_mfma_f32_16x16x32_bf16 a[92:95], a[172:175], v[180:183], a[92:95]
  s_waitcnt lgkmcnt(4)
  v_exp_f32 v221, v157
  v_mfma_f32_16x16x32_bf16 a[96:99], a[176:179], v[176:179], a[96:99]
  ds_read_b128 a[144:147], v3 offset:4096
  buffer_load_dwordx4 v2, s[44:47], s26 offen offset:3072 sc1 lds
  v_mfma_f32_16x16x32_bf16 a[100:103], a[176:179], v[180:183], a[100:103]
  s_add_u32 s26, s26, 16384
  v_exp_f32 v222, v158
  v_mfma_f32_16x16x32_bf16 a[104:107], a[180:183], v[176:179], a[104:107]
  s_add_u32 s24, s24, 32768
  ds_read_b128 a[148:151], v3 offset:5120
  v_add_f32 v227, v227, v220
  v_add_f32 v227, v227, v221
  v_mfma_f32_16x16x32_bf16 a[108:111], a[180:183], v[180:183], a[108:111]
  s_and_b32 s24, s24, 0x1ffff
  v_exp_f32 v223, v159
  v_mfma_f32_16x16x32_bf16 a[112:115], a[184:187], v[176:179], a[112:115]
  ds_read_b128 a[152:155], v3 offset:6144
  v_cvt_pk_bf16_f32 v190, v220, v221
  v_add_f32 v227, v227, v222
  v_mfma_f32_16x16x32_bf16 a[116:119], a[184:187], v[180:183], a[116:119]
  v_add_f32 v227, v227, v223
  v_cvt_pk_bf16_f32 v191, v222, v223
  v_mfma_f32_16x16x32_bf16 a[120:123], a[188:191], v[176:179], a[120:123]
  s_waitcnt lgkmcnt(3)
  ds_read_b128 a[156:159], v3 offset:7168
  v_max_f32 v5, v226, v227
  v_cmp_lt_f32 vcc, s81, v5
  v_mfma_f32_16x16x32_bf16 a[124:127], a[188:191], v[180:183], a[124:127]
  s_cbranch_vccnz fa_stub15
fa_back15:
  v_add_f32 v230, v230, v226
  v_add_f32 v231, v231, v227
  v_mfma_f32_16x16x32_bf16 v[144:147], a[128:131], v[64:67], v[200:203]
  ds_read_b128 a[160:163], v3 offset:24576
  v_exp_f32 v216, v128
  v_mfma_f32_16x16x32_bf16 v[152:155], a[128:131], v[68:71], v[204:207]
  v_exp_f32 v217, v129
  v_mfma_f32_16x16x32_bf16 v[148:151], a[132:135], v[64:67], v[200:203]
  ds_read_b128 a[164:167], v3 offset:25600
  v_add_f32 v226, v216, v217
  v_cvt_pk_bf16_f32 v176, v216, v217
  v_mfma_f32_16x16x32_bf16 v[156:159], a[132:135], v[68:71], v[204:207]
  s_mov_b32 m0, s25
  v_exp_f32 v218, v130
  v_mfma_f32_16x16x32_bf16 v[144:147], a[136:139], v[72:75], v[144:147]
  ds_read_b128 a[168:171], v3 offset:26624
  buffer_load_dwordx4 v2, s[48:51], s27 offen offset:0 sc1 lds
  v_add_f32 v226, v226, v218
  v_mfma_f32_16x16x32_bf16 v[152:155], a[136:139], v[76:79], v[152:155]
  v_exp_f32 v219, v131
  v_mfma_f32_16x16x32_bf16 v[148:151], a[140:143], v[72:75], v[148:151]
  ds_read_b128 a[172:175], v3 offset:27648
  v_add_f32 v226, v226, v219
  v_cvt_pk_bf16_f32 v177, v218, v219
  v_mfma_f32_16x16x32_bf16 v[156:159], a[140:143], v[76:79], v[156:159]
  s_add_u32 s14, s13, 12288
  s_waitcnt lgkmcnt(4)
  buffer_load_dwordx4 a[60:63], v2, s[40:43], s14 offen offset:3072 sc1
  v_exp_f32 v220, v132
  v_mfma_f32_16x16x32_bf16 v[144:147], a[144:147], v[80:83], v[144:147]
  ds_read_b128 a[176:179], v3 offset:28672
  v_add_f32 v226, v226, v220
  v_mfma_f32_16x16x32_bf16 v[152:155], a[144:147], v[84:87], v[152:155]
  v_exp_f32 v221, v133
  v_mfma_f32_16x16x32_bf16 v[148:151], a[148:151], v[80:83], v[148:151]
  ds_read_b128 a[180:183], v3 offset:29696
  buffer_load_dwordx4 v2, s[48:51], s27 offen offset:1024 sc1 lds
  v_add_f32 v226, v226, v221
  v_mfma_f32_16x16x32_bf16 v[156:159], a[148:151], v[84:87], v[156:159]
  v_exp_f32 v222, v134
  v_cvt_pk_bf16_f32 v178, v220, v221
  v_mfma_f32_16x16x32_bf16 v[144:147], a[152:155], v[88:91], v[144:147]
  ds_read_b128 a[184:187], v3 offset:30720
  v_add_f32 v226, v226, v222
  v_mfma_f32_16x16x32_bf16 v[152:155], a[152:155], v[92:95], v[152:155]
  v_exp_f32 v223, v135
  v_exp_f32 v216, v136
  v_mfma_f32_16x16x32_bf16 v[148:151], a[156:159], v[88:91], v[148:151]
  s_add_u32 s14, s13, 16384
  ds_read_b128 a[188:191], v3 offset:31744
  buffer_load_dwordx4 a[192:195], v2, s[40:43], s14 offen offset:0 sc1
  v_mfma_f32_16x16x32_bf16 v[156:159], a[156:159], v[92:95], v[156:159]
  s_waitcnt lgkmcnt(4)
  v_exp_f32 v217, v137
  v_mfma_f32_16x16x32_bf16 a[64:67], a[160:163], v[184:187], a[64:67]
  ds_read_b128 a[128:131], v3 offset:8192
  v_add_f32 v226, v226, v223
  v_mfma_f32_16x16x32_bf16 a[68:71], a[160:163], v[188:191], a[68:71]
  v_exp_f32 v218, v138
  v_cvt_pk_bf16_f32 v179, v222, v223
  v_mfma_f32_16x16x32_bf16 a[72:75], a[164:167], v[184:187], a[72:75]
  ds_read_b128 a[132:135], v3 offset:9216
  buffer_load_dwordx4 v2, s[48:51], s27 offen offset:2048 sc1 lds
  v_mfma_f32_16x16x32_bf16 a[76:79], a[164:167], v[188:191], a[76:79]
  v_exp_f32 v219, v139
  v_add_f32 v227, v216, v217
  v_mfma_f32_16x16x32_bf16 a[80:83], a[168:171], v[184:187], a[80:83]
  ds_read_b128 a[136:139], v3 offset:10240
  v_cvt_pk_bf16_f32 v180, v216, v217
  v_add_f32 v227, v227, v218
  v_mfma_f32_16x16x32_bf16 a[84:87], a[168:171], v[188:191], a[84:87]
  buffer_load_dwordx4 a[196:199], v2, s[40:43], s14 offen offset:1024 sc1
  v_add_f32 v227, v227, v219
  v_mfma_f32_16x16x32_bf16 a[88:91], a[172:175], v[184:187], a[88:91]
  ds_read_b128 a[140:143], v3 offset:11264
  v_cvt_pk_bf16_f32 v181, v218, v219
  v_exp_f32 v220, v140
  v_mfma_f32_16x16x32_bf16 a[92:95], a[172:175], v[188:191], a[92:95]
  s_waitcnt lgkmcnt(4)
  v_exp_f32 v221, v141
  v_mfma_f32_16x16x32_bf16 a[96:99], a[176:179], v[184:187], a[96:99]
  ds_read_b128 a[144:147], v3 offset:12288
  buffer_load_dwordx4 v2, s[48:51], s27 offen offset:3072 sc1 lds
  v_mfma_f32_16x16x32_bf16 a[100:103], a[176:179], v[188:191], a[100:103]
  s_add_u32 s27, s27, 16384
  v_exp_f32 v222, v142
  v_mfma_f32_16x16x32_bf16 a[104:107], a[180:183], v[184:187], a[104:107]
  s_add_u32 s25, s25, 32768
  ds_read_b128 a[148:151], v3 offset:13312
  v_add_f32 v227, v227, v220
  v_add_f32 v227, v227, v221
  v_mfma_f32_16x16x32_bf16 a[108:111], a[180:183], v[188:191], a[108:111]
  s_and_b32 s25, s25, 0x1ffff
  v_exp_f32 v223, v143
  v_mfma_f32_16x16x32_bf16 a[112:115], a[184:187], v[184:187], a[112:115]
  ds_read_b128 a[152:155], v3 offset:14336
  v_cvt_pk_bf16_f32 v182, v220, v221
  v_add_f32 v227, v227, v222
  v_mfma_f32_16x16x32_bf16 a[116:119], a[184:187], v[188:191], a[116:119]
  v_add_f32 v227, v227, v223
  v_cvt_pk_bf16_f32 v183, v222, v223
  v_mfma_f32_16x16x32_bf16 a[120:123], a[188:191], v[184:187], a[120:123]
  s_waitcnt lgkmcnt(3)
  ds_read_b128 a[156:159], v3 offset:15360
  v_max_f32 v5, v226, v227
  v_cmp_lt_f32 vcc, s81, v5
  v_mfma_f32_16x16x32_bf16 a[124:127], a[188:191], v[188:191], a[124:127]
  s_cbranch_vccnz fa_stub16
fa_back16:
  v_add_f32 v230, v230, v226
  v_add_f32 v231, v231, v227
  v_add_u32 v3, 32768, v3
  v_and_b32 v3, 0x1ffff, v3
fa_SSW5:
  v_mfma_f32_16x16x32_bf16 v[128:131], a[128:131], v[64:67], v[200:203]
  s_waitcnt vmcnt(12)
  v_exp_f32 v216, v144
  v_exp_f32 v217, v145
  v_mfma_f32_16x16x32_bf16 v[136:139], a[128:131], v[68:71], v[204:207]
  s_barrier
  v_exp_f32 v218, v146
  v_mfma_f32_16x16x32_bf16 v[132:135], a[132:135], v[64:67], v[200:203]
  s_cmp_ge_u32 s26, s32
  ds_read_b128 a[160:163], v3 offset:16384
  ds_read_b128 a[164:167], v3 offset:17408
  v_mfma_f32_16x16x32_bf16 v[140:143], a[132:135], v[68:71], v[204:207]
  s_cbranch_scc1 fa_hk8
fa_hb8:
  s_mov_b32 m0, s24
  v_exp_f32 v219, v147
  v_mfma_f32_16x16x32_bf16 v[128:131], a[136:139], v[72:75], v[128:131]
  ds_read_b128 a[168:171], v3 offset:18432
  buffer_load_dwordx4 v2, s[44:47], s26 offen offset:0 sc1 lds
  v_add_f32 v226, v216, v217
  v_mfma_f32_16x16x32_bf16 v[136:139], a[136:139], v[76:79], v[136:139]
  v_exp_f32 v220, v148
  v_mfma_f32_16x16x32_bf16 v[132:135], a[140:143], v[72:75], v[132:135]
  ds_read_b128 a[172:175], v3 offset:19456
  v_cvt_pk_bf16_f32 v184, v216, v217
  v_add_f32 v226, v226, v218
  v_mfma_f32_16x16x32_bf16 v[140:143], a[140:143], v[76:79], v[140:143]
  s_add_u32 s14, s13, 16384
  s_waitcnt lgkmcnt(4)
  buffer_load_dwordx4 a[200:203], v2, s[40:43], s14 offen offset:2048 sc1
  v_add_f32 v226, v226, v219
  v_mfma_f32_16x16x32_bf16 v[128:131], a[144:147], v[80:83], v[128:131]
  ds_read_b128 a[176:179], v3 offset:20480
  v_cvt_pk_bf16_f32 v185, v218, v219
  v_add_f32 v226, v226, v220
  v_mfma_f32_16x16x32_bf16 v[136:139], a[144:147], v[84:87], v[136:139]
  v_exp_f32 v221, v149
  v_mfma_f32_16x16x32_bf16 v[132:135], a[148:151], v[80:83], v[132:135]
  ds_read_b128 a[180:183], v3 offset:21504
  buffer_load_dwordx4 v2, s[44:47], s26 offen offset:1024 sc1 lds
  v_add_f32 v226, v226, v221
  v_mfma_f32_16x16x32_bf16 v[140:143], a[148:151], v[84:87], v[140:143]
  v_exp_f32 v222, v150
  v_cvt_pk_bf16_f32 v186, v220, v221
  v_mfma_f32_16x16x32_bf16 v[128:131], a[152:155], v[88:91], v[128:131]
  ds_read_b128 a[184:187], v3 offset:22528
  v_add_f32 v226, v226, v222
  v_mfma_f32_16x16x32_bf16 v[136:139], a[152:155], v[92:95], v[136:139]
  v_exp_f32 v223, v151
  v_exp_f32 v216, v152
  v_mfma_f32_16x16x32_bf16 v[132:135], a[156:159], v[88:91], v[132:135]
  ds_read_b128 a[188:191], v3 offset:23552
  buffer_load_dwordx4 a[204:207], v2, s[40:43], s14 offen offset:3072 sc1
  v_mfma_f32_16x16x32_bf16 v[140:143], a[156:159], v[92:95], v[140:143]
  s_waitcnt lgkmcnt(4)
  v_exp_f32 v217, v153
  v_mfma_f32_16x16x32_bf16 a[64:67], a[160:163], v[176:179], a[64:67]
  ds_read_b128 a[128:131], v3 offset:0
  v_add_f32 v226, v226, v223
  v_mfma_f32_16x16x32_bf16 a[68:71], a[160:163], v[180:183], a[68:71]
  v_exp_f32 v218, v154
  v_cvt_pk_bf16_f32 v187, v222, v223
  v_mfma_f32_16x16x32_bf16 a[72:75], a[164:167], v[176:179], a[72:75]
  ds_read_b128 a[132:135], v3 offset:1024
  buffer_load_dwordx4 v2, s[44:47], s26 offen offset:2048 sc1 lds
  v_mfma_f32_16x16x32_bf16 a[76:79], a[164:167], v[180:183], a[76:79]
  v_exp_f32 v219, v155
  v_add_f32 v227, v216, v217
  v_mfma_f32_16x16x32_bf16 a[80:83], a[168:171], v[176:179], a[80:83]
  ds_read_b128 a[136:139], v3 offset:2048
  v_cvt_pk_bf16_f32 v188, v216, v217
  v_add_f32 v227, v227, v218
  v_mfma_f32_16x16x32_bf16 a[84:87], a[168:171], v[180:183], a[84:87]
  s_add_u32 s14, s13, 20480
  buffer_load_dwordx4 a[208:211], v2, s[40:43], s14 offen offset:0 sc1
  v_add_f32 v227, v227, v219
  v_mfma_f32_16x16x32_bf16 a[88:91], a[172:175], v[176:179], a[88:91]
  ds_read_b128 a[140:143], v3 offset:3072
  v_cvt_pk_bf16_f32 v189, v218, v219
  v_exp_f32 v220, v156
  v_mfma_f32_16x16x32_bf16 a[92:95], a[172:175], v[180:183], a[92:95]
  s_waitcnt lgkmcnt(4)
  v_exp_f32 v221, v157
  v_mfma_f32_16x16x32_bf16 a[96:99], a[176:179], v[176:179], a[96:99]
  ds_read_b128 a[144:147], v3 offset:4096
  buffer_load_dwordx4 v2, s[44:47], s26 offen offset:3072 sc1 lds
  v_mfma_f32_16x16x32_bf16 a[100:103], a[176:179], v[180:183], a[100:103]
  s_add_u32 s26, s26, 16384
  v_exp_f32 v222, v158
  v_mfma_f32_16x16x32_bf16 a[104:107], a[180:183], v[176:179], a[104:107]
  s_add_u32 s24, s24, 32768
  ds_read_b128 a[148:151], v3 offset:5120
  v_add_f32 v227, v227, v220
  v_add_f32 v227, v227, v221
  v_mfma_f32_16x16x32_bf16 a[108:111], a[180:183], v[180:183], a[108:111]
  s_and_b32 s24, s24, 0x1ffff
  v_exp_f32 v223, v159
  v_mfma_f32_16x16x32_bf16 a[112:115], a[184:187], v[176:179], a[112:115]
  ds_read_b128 a[152:155], v3 offset:6144
  v_cvt_pk_bf16_f32 v190, v220, v221
  v_add_f32 v227, v227, v222
  v_mfma_f32_16x16x32_bf16 a[116:119], a[184:187], v[180:183], a[116:119]
  v_add_f32 v227, v227, v223
  v_cvt_pk_bf16_f32 v191, v222, v223
  v_mfma_f32_16x16x32_bf16 a[120:123], a[188:191], v[176:179], a[120:123]
  s_waitcnt lgkmcnt(3)
  ds_read_b128 a[156:159], v3 offset:7168
  v_max_f32 v5, v226, v227
  v_cmp_lt_f32 vcc, s81, v5
  v_mfma_f32_16x16x32_bf16 a[124:127], a[188:191], v[180:183], a[124:127]
  s_cbranch_vccnz fa_stub17
fa_back17:
  v_add_f32 v230, v230, v226
  v_add_f32 v231, v231, v227
  v_mfma_f32_16x16x32_bf16 v[144:147], a[128:131], v[64:67], v[200:203]
  ds_read_b128 a[160:163], v3 offset:24576
  v_exp_f32 v216, v128
  v_mfma_f32_16x16x32_bf16 v[152:155], a[128:131], v[68:71], v[204:207]
  v_exp_f32 v217, v129
  v_mfma_f32_16x16x32_bf16 v[148:151], a[132:135], v[64:67], v[200:203]
  ds_read_b128 a[164:167], v3 offset:25600
  v_add_f32 v226, v216, v217
  v_cvt_pk_bf16_f32 v176, v216, v217
  v_mfma_f32_16x16x32_bf16 v[156:159], a[132:135], v[68:71], v[204:207]
  s_mov_b32 m0, s25
  v_exp_f32 v218, v130
  v_mfma_f32_16x16x32_bf16 v[144:147], a[136:139], v[72:75], v[144:147]
  ds_read_b128 a[168:171], v3 offset:26624
  buffer_load_dwordx4 v2, s[48:51], s27 offen offset:0 sc1 lds
  v_add_f32 v226, v226, v218
  v_mfma_f32_16x16x32_bf16 v[152:155], a[136:139], v[76:79], v[152:155]
  v_exp_f32 v219, v131
  v_mfma_f32_16x16x32_bf16 v[148:151], a[140:143], v[72:75], v[148:151]
  ds_read_b128 a[172:175], v3 offset:27648
  v_add_f32 v226, v226, v219
  v_cvt_pk_bf16_f32 v177, v218, v219
  v_mfma_f32_16x16x32_bf16 v[156:159], a[140:143], v[76:79], v[156:159]
  s_add_u32 s14, s13, 20480
  s_waitcnt lgkmcnt(4)
  buffer_load_dwordx4 a[212:215], v2, s[40:43], s14 offen offset:1024 sc1
  v_exp_f32 v220, v132
  v_mfma_f32_16x16x32_bf16 v[144:147], a[144:147], v[80:83], v[144:147]
  ds_read_b128 a[176:179], v3 offset:28672
  v_add_f32 v226, v226, v220
  v_mfma_f32_16x16x32_bf16 v[152:155], a[144:147], v[84:87], v[152:155]
  v_exp_f32 v221, v133
  v_mfma_f32_16x16x32_bf16 v[148:151], a[148:151], v[80:83], v[148:151]
  ds_read_b128 a[180:183], v3 offset:29696
  buffer_load_dwordx4 v2, s[48:51], s27 offen offset:1024 sc1 lds
  v_add_f32 v226, v226, v221
  v_mfma_f32_16x16x32_bf16 v[156:159], a[148:151], v[84:87], v[156:159]
  v_exp_f32 v222, v134
  v_cvt_pk_bf16_f32 v178, v220, v221
  v_mfma_f32_16x16x32_bf16 v[144:147], a[152:155], v[88:91], v[144:147]
  ds_read_b128 a[184:187], v3 offset:30720
  v_add_f32 v226, v226, v222
  v_mfma_f32_16x16x32_bf16 v[152:155], a[152:155], v[92:95], v[152:155]
  v_exp_f32 v223, v135
  v_exp_f32 v216, v136
  v_mfma_f32_16x16x32_bf16 v[148:151], a[156:159], v[88:91], v[148:151]
  ds_read_b128 a[188:191], v3 offset:31744
  buffer_load_dwordx4 a[216:219], v2, s[40:43], s14 offen offset:2048 sc1
  v_mfma_f32_16x16x32_bf16 v[156:159], a[156:159], v[92:95], v[156:159]
  s_waitcnt lgkmcnt(4)
  v_exp_f32 v217, v137
  v_mfma_f32_16x16x32_bf16 a[64:67], a[160:163], v[184:187], a[64:67]
  ds_read_b128 a[128:131], v3 offset:8192
  v_add_f32 v226, v226, v223
  v_mfma_f32_16x16x32_bf16 a[68:71], a[160:163], v[188:191], a[68:71]
  v_exp_f32 v218, v138
  v_cvt_pk_bf16_f32 v179, v222, v223
  v_mfma_f32_16x16x32_bf16 a[72:75], a[164:167], v[184:187], a[72:75]
  ds_read_b128 a[132:135], v3 offset:9216
  buffer_load_dwordx4 v2, s[48:51], s27 offen offset:2048 sc1 lds
  v_mfma_f32_16x16x32_bf16 a[76:79], a[164:167], v[188:191], a[76:79]
  v_exp_f32 v219, v139
  v_add_f32 v227, v216, v217
  v_mfma_f32_16x16x32_bf16 a[80:83], a[168:171], v[184:187], a[80:83]
  ds_read_b128 a[136:139], v3 offset:10240
  v_cvt_pk_bf16_f32 v180, v216, v217
  v_add_f32 v227, v227, v218
  v_mfma_f32_16x16x32_bf16 a[84:87], a[168:171], v[188:191], a[84:87]
  buffer_load_dwordx4 a[220:223], v2, s[40:43], s14 offen offset:3072 sc1
  v_add_f32 v227, v227, v219
  v_mfma_f32_16x16x32_bf16 a[88:91], a[172:175], v[184:187], a[88:91]
  ds_read_b128 a[140:143], v3 offset:11264
  v_cvt_pk_bf16_f32 v181, v218, v219
  v_exp_f32 v220, v140
  v_mfma_f32_16x16x32_bf16 a[92:95], a[172:175], v[188:191], a[92:95]
  s_waitcnt lgkmcnt(4)
  v_exp_f32 v221, v141
  v_mfma_f32_16x16x32_bf16 a[96:99], a[176:179], v[184:187], a[96:99]
  ds_read_b128 a[144:147], v3 offset:12288
  buffer_load_dwordx4 v2, s[48:51], s27 offen offset:3072 sc1 lds
  v_mfma_f32_16x16x32_bf16 a[100:103], a[176:179], v[188:191], a[100:103]
  s_add_u32 s27, s27, 16384
  v_exp_f32 v222, v142
  v_mfma_f32_16x16x32_bf16 a[104:107], a[180:183], v[184:187], a[104:107]
  s_add_u32 s25, s25, 32768
  ds_read_b128 a[148:151], v3 offset:13312
  v_add_f32 v227, v227, v220
  v_add_f32 v227, v227, v221
  v_mfma_f32_16x16x32_bf16 a[108:111], a[180:183], v[188:191], a[108:111]
  s_and_b32 s25, s25, 0x1ffff
  v_exp_f32 v223, v143
  v_mfma_f32_16x16x32_bf16 a[112:115], a[184:187], v[184:187], a[112:115]
  ds_read_b128 a[152:155], v3 offset:14336
  v_cvt_pk_bf16_f32 v182, v220, v221
  v_add_f32 v227, v227, v222
  v_mfma_f32_16x16x32_bf16 a[116:119], a[184:187], v[188:191], a[116:119]
  v_add_f32 v227, v227, v223
  v_cvt_pk_bf16_f32 v183, v222, v223
  v_mfma_f32_16x16x32_bf16 a[120:123], a[188:191], v[184:187], a[120:123]
  s_waitcnt lgkmcnt(3)
  ds_read_b128 a[156:159], v3 offset:15360
  v_max_f32 v5, v226, v227
  v_cmp_lt_f32 vcc, s81, v5
  v_mfma_f32_16x16x32_bf16 a[124:127], a[188:191], v[188:191], a[124:127]
  s_cbranch_vccnz fa_stub18
fa_back18:
  v_add_f32 v230, v230, v226
  v_add_f32 v231, v231, v227
  v_add_u32 v3, 32768, v3
  v_and_b32 v3, 0x1ffff, v3
fa_SSW4:
  v_mfma_f32_16x16x32_bf16 v[128:131], a[128:131], v[64:67], v[200:203]
  s_waitcnt vmcnt(12)
  v_exp_f32 v216, v144
  v_exp_f32 v217, v145
  v_mfma_f32_16x16x32_bf16 v[136:139], a[128:131], v[68:71], v[204:207]
  s_barrier
  v_exp_f32 v218, v146
  v_mfma_f32_16x16x32_bf16 v[132:135], a[132:135], v[64:67], v[200:203]
  s_cmp_ge_u32 s26, s32
  ds_read_b128 a[160:163], v3 offset:16384
  ds_read_b128 a[164:167], v3 offset:17408
  v_mfma_f32_16x16x32_bf16 v[140:143], a[132:135], v[68:71], v[204:207]
  s_cbranch_scc1 fa_hk9
fa_hb9:
  s_mov_b32 m0, s24
  v_exp_f32 v219, v147
  v_mfma_f32_16x16x32_bf16 v[128:131], a[136:139], v[72:75], v[128:131]
  ds_read_b128 a[168:171], v3 offset:18432
  buffer_load_dwordx4 v2, s[44:47], s26 offen offset:0 sc1 lds
  v_add_f32 v226, v216, v217
  v_mfma_f32_16x16x32_bf16 v[136:139], a[136:139], v[76:79], v[136:139]
  v_exp_f32 v220, v148
  v_mfma_f32_16x16x32_bf16 v[132:135], a[140:143], v[72:75], v[132:135]
  ds_read_b128 a[172:175], v3 offset:19456
  v_cvt_pk_bf16_f32 v184, v216, v217
  v_add_f32 v226, v226, v218
  v_mfma_f32_16x16x32_bf16 v[140:143], a[140:143], v[76:79], v[140:143]
  s_add_u32 s14, s13, 24576
  s_waitcnt lgkmcnt(4)
  buffer_load_dwordx4 a[224:227], v2, s[40:43], s14 offen offset:0 sc1
  v_add_f32 v226, v226, v219
  v_mfma_f32_16x16x32_bf16 v[128:131], a[144:147], v[80:83], v[128:131]
  ds_read_b128 a[176:179], v3 offset:20480
  v_cvt_pk_bf16_f32 v185, v218, v219
  v_add_f32 v226, v226, v220
  v_mfma_f32_16x16x32_bf16 v[136:139], a[144:147], v[84:87], v[136:139]
  v_exp_f32 v221, v149
  v_mfma_f32_16x16x32_bf16 v[132:135], a[148:151], v[80:83], v[132:135]
  ds_read_b128 a[180:183], v3 offset:21504
  buffer_load_dwordx4 v2, s[44:47], s26 offen offset:1024 sc1 lds
  v_add_f32 v226, v226, v221
  v_mfma_f32_16x16x32_bf16 v[140:143], a[148:151], v[84:87], v[140:143]
  v_exp_f32 v222, v150
  v_cvt_pk_bf16_f32 v186, v220, v221
  v_mfma_f32_16x16x32_bf16 v[128:131], a[152:155], v[88:91], v[128:131]
  ds_read_b128 a[184:187], v3 offset:22528
  v_add_f32 v226, v226, v222
  v_mfma_f32_16x16x32_bf16 v[136:139], a[152:155], v[92:95], v[136:139]
  v_exp_f32 v223, v151
  v_exp_f32 v216, v152
  v_mfma_f32_16x16x32_bf16 v[132:135], a[156:159], v[88:91], v[132:135]
  ds_read_b128 a[188:191], v3 offset:23552
  buffer_load_dwordx4 a[228:231], v2, s[40:43], s14 offen offset:1024 sc1
  v_mfma_f32_16x16x32_bf16 v[140:143], a[156:159], v[92:95], v[140:143]
  s_waitcnt lgkmcnt(4)
  v_exp_f32 v217, v153
  v_mfma_f32_16x16x32_bf16 a[64:67], a[160:163], v[176:179], a[64:67]
  ds_read_b128 a[128:131], v3 offset:0
  v_add_f32 v226, v226, v223
  v_mfma_f32_16x16x32_bf16 a[68:71], a[160:163], v[180:183], a[68:71]
  v_exp_f32 v218, v154
  v_cvt_pk_bf16_f32 v187, v222, v223
  v_mfma_f32_16x16x32_bf16 a[72:75], a[164:167], v[176:179], a[72:75]
  ds_read_b128 a[132:135], v3 offset:1024
  buffer_load_dwordx4 v2, s[44:47], s26 offen offset:2048 sc1 lds
  v_mfma_f32_16x16x32_bf16 a[76:79], a[164:167], v[180:183], a[76:79]
  v_exp_f32 v219, v155
  v_add_f32 v227, v216, v217
  v_mfma_f32_16x16x32_bf16 a[80:83], a[168:171], v[176:179], a[80:83]
  ds_read_b128 a[136:139], v3 offset:2048
  v_cvt_pk_bf16_f32 v188, v216, v217
  v_add_f32 v227, v227, v218
  v_mfma_f32_16x16x32_bf16 a[84:87], a[168:171], v[180:183], a[84:87]
  buffer_load_dwordx4 a[232:235], v2, s[40:43], s14 offen offset:2048 sc1
  v_add_f32 v227, v227, v219
  v_mfma_f32_16x16x32_bf16 a[88:91], a[172:175], v[176:179], a[88:91]
  ds_read_b128 a[140:143], v3 offset:3072
  v_cvt_pk_bf16_f32 v189, v218, v219
  v_exp_f32 v220, v156
  v_mfma_f32_16x16x32_bf16 a[92:95], a[172:175], v[180:183], a[92:95]
  s_waitcnt lgkmcnt(4)
  v_exp_f32 v221, v157
  v_mfma_f32_16x16x32_bf16 a[96:99], a[176:179], v[176:179], a[96:99]
  ds_read_b128 a[144:147], v3 offset:4096
  buffer_load_dwordx4 v2, s[44:47], s26 offen offset:3072 sc1 lds
  v_mfma_f32_16x16x32_bf16 a[100:103], a[176:179], v[180:183], a[100:103]
  s_add_u32 s26, s26, 16384
  v_exp_f32 v222, v158
  v_mfma_f32_16x16x32_bf16 a[104:107], a[180:183], v[176:179], a[104:107]
  s_add_u32 s24, s24, 32768
  ds_read_b128 a[148:151], v3 offset:5120
  v_add_f32 v227, v227, v220
  v_add_f32 v227, v227, v221
  v_mfma_f32_16x16x32_bf16 a[108:111], a[180:183], v[180:183], a[108:111]
  s_and_b32 s24, s24, 0x1ffff
  v_exp_f32 v223, v159
  v_mfma_f32_16x16x32_bf16 a[112:115], a[184:187], v[176:179], a[112:115]
  ds_read_b128 a[152:155], v3 offset:6144
  v_cvt_pk_bf16_f32 v190, v220, v221
  v_add_f32 v227, v227, v222
  v_mfma_f32_16x16x32_bf16 a[116:119], a[184:187], v[180:183], a[116:119]
  v_add_f32 v227, v227, v223
  v_cvt_pk_bf16_f32 v191, v222, v223
  v_mfma_f32_16x16x32_bf16 a[120:123], a[188:191], v[176:179], a[120:123]
  s_waitcnt lgkmcnt(3)
  ds_read_b128 a[156:159], v3 offset:7168
  v_max_f32 v5, v226, v227
  v_cmp_lt_f32 vcc, s81, v5
  v_mfma_f32_16x16x32_bf16 a[124:127], a[188:191], v[180:183], a[124:127]
  s_cbranch_vccnz fa_stub19
fa_back19:
  v_add_f32 v230, v230, v226
  v_add_f32 v231, v231, v227
  v_mfma_f32_16x16x32_bf16 v[144:147], a[128:131], v[64:67], v[200:203]
  ds_read_b128 a[160:163], v3 offset:24576
  v_exp_f32 v216, v128
  v_mfma_f32_16x16x32_bf16 v[152:155], a[128:131], v[68:71], v[204:207]
  v_exp_f32 v217, v129
  v_mfma_f32_16x16x32_bf16 v[148:151], a[132:135], v[64:67], v[200:203]
  ds_read_b128 a[164:167], v3 offset:25600
  v_add_f32 v226, v216, v217
  v_cvt_pk_bf16_f32 v176, v216, v217
  v_mfma_f32_16x16x32_bf16 v[156:159], a[132:135], v[68:71], v[204:207]
  s_mov_b32 m0, s25
  v_exp_f32 v218, v130
  v_mfma_f32_16x16x32_bf16 v[144:147], a[136:139], v[72:75], v[144:147]
  ds_read_b128 a[168:171], v3 offset:26624
  buffer_load_dwordx4 v2, s[48:51], s27 offen offset:0 sc1 lds
  v_add_f32 v226, v226, v218
  v_mfma_f32_16x16x32_bf16 v[152:155], a[136:139], v[76:79], v[152:155]
  v_exp_f32 v219, v131
  v_mfma_f32_16x16x32_bf16 v[148:151], a[140:143], v[72:75], v[148:151]
  ds_read_b128 a[172:175], v3 offset:27648
  v_add_f32 v226, v226, v219
  v_cvt_pk_bf16_f32 v177, v218, v219
  v_mfma_f32_16x16x32_bf16 v[156:159], a[140:143], v[76:79], v[156:159]
  s_add_u32 s14, s13, 24576
  s_waitcnt lgkmcnt(4)
  buffer_load_dwordx4 a[236:239], v2, s[40:43], s14 offen offset:3072 sc1
  v_exp_f32 v220, v132
  v_mfma_f32_16x16x32_bf16 v[144:147], a[144:147], v[80:83], v[144:147]
  ds_read_b128 a[176:179], v3 offset:28672
  v_add_f32 v226, v226, v220
  v_mfma_f32_16x16x32_bf16 v[152:155], a[144:147], v[84:87], v[152:155]
  v_exp_f32 v221, v133
  v_mfma_f32_16x16x32_bf16 v[148:151], a[148:151], v[80:83], v[148:151]
  ds_read_b128 a[180:183], v3 offset:29696
  buffer_load_dwordx4 v2, s[48:51], s27 offen offset:1024 sc1 lds
  v_add_f32 v226, v226, v221
  v_mfma_f32_16x16x32_bf16 v[156:159], a[148:151], v[84:87], v[156:159]
  v_exp_f32 v222, v134
  v_cvt_pk_bf16_f32 v178, v220, v221
  v_mfma_f32_16x16x32_bf16 v[144:147], a[152:155], v[88:91], v[144:147]
  ds_read_b128 a[184:187], v3 offset:30720
  v_add_f32 v226, v226, v222
  v_mfma_f32_16x16x32_bf16 v[152:155], a[152:155], v[92:95], v[152:155]
  v_exp_f32 v223, v135
  v_exp_f32 v216, v136
  v_mfma_f32_16x16x32_bf16 v[148:151], a[156:159], v[88:91], v[148:151]
  s_add_u32 s14, s13, 28672
  ds_read_b128 a[188:191], v3 offset:31744
  buffer_load_dwordx4 a[240:243], v2, s[40:43], s14 offen offset:0 sc1
  v_mfma_f32_16x16x32_bf16 v[156:159], a[156:159], v[92:95], v[156:159]
  s_waitcnt lgkmcnt(4)
  v_exp_f32 v217, v137
  v_mfma_f32_16x16x32_bf16 a[64:67], a[160:163], v[184:187], a[64:67]
  ds_read_b128 a[128:131], v3 offset:8192
  v_add_f32 v226, v226, v223
  v_mfma_f32_16x16x32_bf16 a[68:71], a[160:163], v[188:191], a[68:71]
  v_exp_f32 v218, v138
  v_cvt_pk_bf16_f32 v179, v222, v223
  v_mfma_f32_16x16x32_bf16 a[72:75], a[164:167], v[184:187], a[72:75]
  ds_read_b128 a[132:135], v3 offset:9216
  buffer_load_dwordx4 v2, s[48:51], s27 offen offset:2048 sc1 lds
  v_mfma_f32_16x16x32_bf16 a[76:79], a[164:167], v[188:191], a[76:79]
  v_exp_f32 v219, v139
  v_add_f32 v227, v216, v217
  v_mfma_f32_16x16x32_bf16 a[80:83], a[168:171], v[184:187], a[80:83]
  ds_read_b128 a[136:139], v3 offset:10240
  v_cvt_pk_bf16_f32 v180, v216, v217
  v_add_f32 v227, v227, v218
  v_mfma_f32_16x16x32_bf16 a[84:87], a[168:171], v[188:191], a[84:87]
  buffer_load_dwordx4 a[244:247], v2, s[40:43], s14 offen offset:1024 sc1
  v_add_f32 v227, v227, v219
  v_mfma_f32_16x16x32_bf16 a[88:91], a[172:175], v[184:187], a[88:91]
  ds_read_b128 a[140:143], v3 offset:11264
  v_cvt_pk_bf16_f32 v181, v218, v219
  v_exp_f32 v220, v140
  v_mfma_f32_16x16x32_bf16 a[92:95], a[172:175], v[188:191], a[92:95]
  s_waitcnt lgkmcnt(4)
  v_exp_f32 v221, v141
  v_mfma_f32_16x16x32_bf16 a[96:99], a[176:179], v[184:187], a[96:99]
  ds_read_b128 a[144:147], v3 offset:12288
  buffer_load_dwordx4 v2, s[48:51], s27 offen offset:3072 sc1 lds
  v_mfma_f32_16x16x32_bf16 a[100:103], a[176:179], v[188:191], a[100:103]
  s_add_u32 s27, s27, 16384
  v_exp_f32 v222, v142
  v_mfma_f32_16x16x32_bf16 a[104:107], a[180:183], v[184:187], a[104:107]
  s_add_u32 s25, s25, 32768
  ds_read_b128 a[148:151], v3 offset:13312
  v_add_f32 v227, v227, v220
  v_add_f32 v227, v227, v221
  v_mfma_f32_16x16x32_bf16 a[108:111], a[180:183], v[188:191], a[108:111]
  s_and_b32 s25, s25, 0x1ffff
  v_exp_f32 v223, v143
  v_mfma_f32_16x16x32_bf16 a[112:115], a[184:187], v[184:187], a[112:115]
  ds_read_b128 a[152:155], v3 offset:14336
  v_cvt_pk_bf16_f32 v182, v220, v221
  v_add_f32 v227, v227, v222
  v_mfma_f32_16x16x32_bf16 a[116:119], a[184:187], v[188:191], a[116:119]
  v_add_f32 v227, v227, v223
  v_cvt_pk_bf16_f32 v183, v222, v223
  v_mfma_f32_16x16x32_bf16 a[120:123], a[188:191], v[184:187], a[120:123]
  s_waitcnt lgkmcnt(3)
  ds_read_b128 a[156:159], v3 offset:15360
  v_max_f32 v5, v226, v227
  v_cmp_lt_f32 vcc, s81, v5
  v_mfma_f32_16x16x32_bf16 a[124:127], a[188:191], v[188:191], a[124:127]
  s_cbranch_vccnz fa_stub20
fa_back20:
  v_add_f32 v230, v230, v226
  v_add_f32 v231, v231, v227
  v_add_u32 v3, 32768, v3
  v_and_b32 v3, 0x1ffff, v3
fa_SSW3:
fa_hb10:
  s_cmp_lt_u32 s12, 3
  s_cbranch_scc1 fa_hk10
  v_mfma_f32_16x16x32_bf16 v[128:131], a[128:131], v[64:67], v[200:203]
  s_waitcnt vmcnt(12)
  v_exp_f32 v216, v144
  v_exp_f32 v217, v145
  v_mfma_f32_16x16x32_bf16 v[136:139], a[128:131], v[68:71], v[204:207]
  s_barrier
  v_exp_f32 v218, v146
  v_mfma_f32_16x16x32_bf16 v[132:135], a[132:135], v[64:67], v[200:203]
  ds_read_b128 a[160:163], v3 offset:16384
  ds_read_b128 a[164:167], v3 offset:17408
  v_mfma_f32_16x16x32_bf16 v[140:143], a[132:135], v[68:71], v[204:207]
  s_mov_b32 m0, s24
  v_exp_f32 v219, v147
  v_mfma_f32_16x16x32_bf16 v[128:131], a[136:139], v[72:75], v[128:131]
  ds_read_b128 a[168:171], v3 offset:18432
  buffer_load_dwordx4 v2, s[44:47], s26 offen offset:0 sc1 lds
  v_add_f32 v226, v216, v217
  v_mfma_f32_16x16x32_bf16 v[136:139], a[136:139], v[76:79], v[136:139]
  v_exp_f32 v220, v148
  v_mfma_f32_16x16x32_bf16 v[132:135], a[140:143], v[72:75], v[132:135]
  ds_read_b128 a[172:175], v3 offset:19456
  v_cvt_pk_bf16_f32 v184, v216, v217
  v_add_f32 v226, v226, v218
  v_mfma_f32_16x16x32_bf16 v[140:143], a[140:143], v[76:79], v[140:143]
  s_add_u32 s14, s13, 28672
  s_waitcnt lgkmcnt(4)
  buffer_load_dwordx4 a[248:251], v2, s[40:43], s14 offen offset:2048 sc1
  v_add_f32 v226, v226, v219
  v_mfma_f32_16x16x32_bf16 v[128:131], a[144:147], v[80:83], v[128:131]
  ds_read_b128 a[176:179], v3 offset:20480
  v_cvt_pk_bf16_f32 v185, v218, v219
  v_add_f32 v226, v226, v220
  v_mfma_f32_16x16x32_bf16 v[136:139], a[144:147], v[84:87], v[136:139]
  v_exp_f32 v221, v149
  v_mfma_f32_16x16x32_bf16 v[132:135], a[148:151], v[80:83], v[132:135]
  ds_read_b128 a[180:183], v3 offset:21504
  buffer_load_dwordx4 v2, s[44:47], s26 offen offset:1024 sc1 lds
  v_add_f32 v226, v226, v221
  v_mfma_f32_16x16x32_bf16 v[140:143], a[148:151], v[84:87], v[140:143]
  v_exp_f32 v222, v150
  v_cvt_pk_bf16_f32 v186, v220, v221
  v_mfma_f32_16x16x32_bf16 v[128:131], a[152:155], v[88:91], v[128:131]
  ds_read_b128 a[184:187], v3 offset:22528
  v_add_f32 v226, v226, v222
  v_mfma_f32_16x16x32_bf16 v[136:139], a[152:155], v[92:95], v[136:139]
  v_exp_f32 v223, v151
  v_exp_f32 v216, v152
  v_mfma_f32_16x16x32_bf16 v[132:135], a[156:159], v[88:91], v[132:135]
  ds_read_b128 a[188:191], v3 offset:23552
  buffer_load_dwordx4 a[252:255], v2, s[40:43], s14 offen offset:3072 sc1
  v_mfma_f32_16x16x32_bf16 v[140:143], a[156:159], v[92:95], v[140:143]
  s_waitcnt lgkmcnt(4)
  v_exp_f32 v217, v153
  v_mfma_f32_16x16x32_bf16 a[64:67], a[160:163], v[176:179], a[64:67]
  ds_read_b128 a[128:131], v3 offset:0
  v_add_f32 v226, v226, v223
  v_mfma_f32_16x16x32_bf16 a[68:71], a[160:163], v[180:183], a[68:71]
  v_exp_f32 v218, v154
  v_cvt_pk_bf16_f32 v187, v222, v223
  v_mfma_f32_16x16x32_bf16 a[72:75], a[164:167], v[176:179], a[72:75]
  ds_read_b128 a[132:135], v3 offset:1024
  buffer_load_dwordx4 v2, s[44:47], s26 offen offset:2048 sc1 lds
  v_mfma_f32_16x16x32_bf16 a[76:79], a[164:167], v[180:183], a[76:79]
  v_exp_f32 v219, v155
  v_add_f32 v227, v216, v217
  v_mfma_f32_16x16x32_bf16 a[80:83], a[168:171], v[176:179], a[80:83]
  ds_read_b128 a[136:139], v3 offset:2048
  v_cvt_pk_bf16_f32 v188, v216, v217
  v_add_f32 v227, v227, v218
  v_mfma_f32_16x16x32_bf16 a[84:87], a[168:171], v[180:183], a[84:87]
  s_add_u32 s14, s13, 32768
  buffer_load_dwordx4 v[32:35], v2, s[40:43], s14 offen offset:0 sc1
  v_add_f32 v227, v227, v219
  v_mfma_f32_16x16x32_bf16 a[88:91], a[172:175], v[176:179], a[88:91]
  ds_read_b128 a[140:143], v3 offset:3072
  v_cvt_pk_bf16_f32 v189, v218, v219
  v_exp_f32 v220, v156
  v_mfma_f32_16x16x32_bf16 a[92:95], a[172:175], v[180:183], a[92:95]
  s_waitcnt lgkmcnt(4)
  v_exp_f32 v221, v157
  v_mfma_f32_16x16x32_bf16 a[96:99], a[176:179], v[176:179], a[96:99]
  ds_read_b128 a[144:147], v3 offset:4096
  buffer_load_dwordx4 v2, s[44:47], s26 offen offset:3072 sc1 lds
  v_mfma_f32_16x16x32_bf16 a[100:103], a[176:179], v[180:183], a[100:103]
  s_add_u32 s26, s26, 16384
  v_exp_f32 v222, v158
  v_mfma_f32_16x16x32_bf16 a[104:107], a[180:183], v[176:179], a[104:107]
  s_add_u32 s24, s24, 32768
  ds_read_b128 a[148:151], v3 offset:5120
  v_add_f32 v227, v227, v220
  v_add_f32 v227, v227, v221
  v_mfma_f32_16x16x32_bf16 a[108:111], a[180:183], v[180:183], a[108:111]
  s_and_b32 s24, s24, 0x1ffff
  v_exp_f32 v223, v159
  v_mfma_f32_16x16x32_bf16 a[112:115], a[184:187], v[176:179], a[112:115]
  ds_read_b128 a[152:155], v3 offset:6144
  v_cvt_pk_bf16_f32 v190, v220, v221
  v_add_f32 v227, v227, v222
  v_mfma_f32_16x16x32_bf16 a[116:119], a[184:187], v[180:183], a[116:119]
  v_add_f32 v227, v227, v223
  v_cvt_pk_bf16_f32 v191, v222, v223
  v_mfma_f32_16x16x32_bf16 a[120:123], a[188:191], v[176:179], a[120:123]
  s_waitcnt lgkmcnt(3)
  ds_read_b128 a[156:159], v3 offset:7168
  v_max_f32 v5, v226, v227
  v_cmp_lt_f32 vcc, s81, v5
  v_mfma_f32_16x16x32_bf16 a[124:127], a[188:191], v[180:183], a[124:127]
  s_cbranch_vccnz fa_stub21
fa_back21:
  v_add_f32 v230, v230, v226
  v_add_f32 v231, v231, v227
  v_mfma_f32_16x16x32_bf16 v[144:147], a[128:131], v[64:67], v[200:203]
  ds_read_b128 a[160:163], v3 offset:24576
  v_exp_f32 v216, v128
  v_mfma_f32_16x16x32_bf16 v[152:155], a[128:131], v[68:71], v[204:207]
  v_exp_f32 v217, v129
  v_mfma_f32_16x16x32_bf16 v[148:151], a[132:135], v[64:67], v[200:203]
  ds_read_b128 a[164:167], v3 offset:25600
  v_add_f32 v226, v216, v217
  v_cvt_pk_bf16_f32 v176, v216, v217
  v_mfma_f32_16x16x32_bf16 v[156:159], a[132:135], v[68:71], v[204:207]
  s_mov_b32 m0, s25
  v_exp_f32 v218, v130
  v_mfma_f32_16x16x32_bf16 v[144:147], a[136:139], v[72:75], v[144:147]
  ds_read_b128 a[168:171], v3 offset:26624
  buffer_load_dwordx4 v2, s[48:51], s27 offen offset:0 sc1 lds
  v_add_f32 v226, v226, v218
  v_mfma_f32_16x16x32_bf16 v[152:155], a[136:139], v[76:79], v[152:155]
  v_exp_f32 v219, v131
  v_mfma_f32_16x16x32_bf16 v[148:151], a[140:143], v[72:75], v[148:151]
  ds_read_b128 a[172:175], v3 offset:27648
  v_add_f32 v226, v226, v219
  v_cvt_pk_bf16_f32 v177, v218, v219
  v_mfma_f32_16x16x32_bf16 v[156:159], a[140:143], v[76:79], v[156:159]
  s_add_u32 s14, s13, 32768
  s_waitcnt lgkmcnt(4)
  buffer_load_dwordx4 v[36:39], v2, s[40:43], s14 offen offset:1024 sc1
  v_exp_f32 v220, v132
  v_mfma_f32_16x16x32_bf16 v[144:147], a[144:147], v[80:83], v[144:147]
  ds_read_b128 a[176:179], v3 offset:28672
  v_add_f32 v226, v226, v220
  v_mfma_f32_16x16x32_bf16 v[152:155], a[144:147], v[84:87], v[152:155]
  v_exp_f32 v221, v133
  v_mfma_f32_16x16x32_bf16 v[148:151], a[148:151], v[80:83], v[148:151]
  ds_read_b128 a[180:183], v3 offset:29696
  buffer_load_dwordx4 v2, s[48:51], s27 offen offset:1024 sc1 lds
  v_add_f32 v226, v226, v221
  v_mfma_f32_16x16x32_bf16 v[156:159], a[148:151], v[84:87], v[156:159]
  v_exp_f32 v222, v134
  v_cvt_pk_bf16_f32 v178, v220, v221
  v_mfma_f32_16x16x32_bf16 v[144:147], a[152:155], v[88:91], v[144:147]
  ds_read_b128 a[184:187], v3 offset:30720
  v_add_f32 v226, v226, v222
  v_mfma_f32_16x16x32_bf16 v[152:155], a[152:155], v[92:95], v[152:155]
  v_exp_f32 v223, v135
  v_exp_f32 v216, v136
  v_mfma_f32_16x16x32_bf16 v[148:151], a[156:159], v[88:91], v[148:151]
  ds_read_b128 a[188:191], v3 offset:31744
  buffer_load_dwordx4 v[40:43], v2, s[40:43], s14 offen offset:2048 sc1
  v_mfma_f32_16x16x32_bf16 v[156:159], a[156:159], v[92:95], v[156:159]
  s_waitcnt lgkmcnt(4)
  v_exp_f32 v217, v137
  v_mfma_f32_16x16x32_bf16 a[64:67], a[160:163], v[184:187], a[64:67]
  ds_read_b128 a[128:131], v3 offset:8192
  v_add_f32 v226, v226, v223
  v_mfma_f32_16x16x32_bf16 a[68:71], a[160:163], v[188:191], a[68:71]
  v_exp_f32 v218, v138
  v_cvt_pk_bf16_f32 v179, v222, v223
  v_mfma_f32_16x16x32_bf16 a[72:75], a[164:167], v[184:187], a[72:75]
  ds_read_b128 a[132:135], v3 offset:9216
  buffer_load_dwordx4 v2, s[48:51], s27 offen offset:2048 sc1 lds
  v_mfma_f32_16x16x32_bf16 a[76:79], a[164:167], v[188:191], a[76:79]
  v_exp_f32 v219, v139
  v_add_f32 v227, v216, v217
  v_mfma_f32_16x16x32_bf16 a[80:83], a[168:171], v[184:187], a[80:83]
  ds_read_b128 a[136:139], v3 offset:10240
  v_cvt_pk_bf16_f32 v180, v216, v217
  v_add_f32 v227, v227, v218
  v_mfma_f32_16x16x32_bf16 a[84:87], a[168:171], v[188:191], a[84:87]
  buffer_load_dwordx4 v[44:47], v2, s[40:43], s14 offen offset:3072 sc1
  v_add_f32 v227, v227, v219
  v_mfma_f32_16x16x32_bf16 a[88:91], a[172:175], v[184:187], a[88:91]
  ds_read_b128 a[140:143], v3 offset:11264
  v_cvt_pk_bf16_f32 v181, v218, v219
  v_exp_f32 v220, v140
  v_mfma_f32_16x16x32_bf16 a[92:95], a[172:175], v[188:191], a[92:95]
  s_waitcnt lgkmcnt(4)
  v_exp_f32 v221, v141
  v_mfma_f32_16x16x32_bf16 a[96:99], a[176:179], v[184:187], a[96:99]
  ds_read_b128 a[144:147], v3 offset:12288
  buffer_load_dwordx4 v2, s[48:51], s27 offen offset:3072 sc1 lds
  v_mfma_f32_16x16x32_bf16 a[100:103], a[176:179], v[188:191], a[100:103]
  s_add_u32 s27, s27, 16384
  v_exp_f32 v222, v142
  v_mfma_f32_16x16x32_bf16 a[104:107], a[180:183], v[184:187], a[104:107]
  s_add_u32 s25, s25, 32768
  ds_read_b128 a[148:151], v3 offset:13312
  v_add_f32 v227, v227, v220
  v_add_f32 v227, v227, v221
  v_mfma_f32_16x16x32_bf16 a[108:111], a[180:183], v[188:191], a[108:111]
  s_and_b32 s25, s25, 0x1ffff
  v_exp_f32 v223, v143
  v_mfma_f32_16x16x32_bf16 a[112:115], a[184:187], v[184:187], a[112:115]
  ds_read_b128 a[152:155], v3 offset:14336
  v_cvt_pk_bf16_f32 v182, v220, v221
  v_add_f32 v227, v227, v222
  v_mfma_f32_16x16x32_bf16 a[116:119], a[184:187], v[188:191], a[116:119]
  v_add_f32 v227, v227, v223
  v_cvt_pk_bf16_f32 v183, v222, v223
  v_mfma_f32_16x16x32_bf16 a[120:123], a[188:191], v[184:187], a[120:123]
  s_waitcnt lgkmcnt(3)
  ds_read_b128 a[156:159], v3 offset:15360
  v_max_f32 v5, v226, v227
  v_cmp_lt_f32 vcc, s81, v5
  v_mfma_f32_16x16x32_bf16 a[124:127], a[188:191], v[188:191], a[124:127]
  s_cbranch_vccnz fa_stub22
fa_back22:
  v_add_f32 v230, v230, v226
  v_add_f32 v231, v231, v227
  v_add_u32 v3, 32768, v3
  v_and_b32 v3, 0x1ffff, v3
fa_SSW2:
  v_mfma_f32_16x16x32_bf16 v[128:131], a[128:131], v[64:67], v[200:203]
  s_waitcnt vmcnt(12)
  v_exp_f32 v216, v144
  v_exp_f32 v217, v145
  v_mfma_f32_16x16x32_bf16 v[136:139], a[128:131], v[68:71], v[204:207]
  s_barrier
  v_exp_f32 v218, v146
  v_mfma_f32_16x16x32_bf16 v[132:135], a[132:135], v[64:67], v[200:203]
  ds_read_b128 a[160:163], v3 offset:16384
  ds_read_b128 a[164:167], v3 offset:17408
  v_mfma_f32_16x16x32_bf16 v[140:143], a[132:135], v[68:71], v[204:207]
  s_mov_b32 m0, s24
  v_exp_f32 v219, v147
  v_mfma_f32_16x16x32_bf16 v[128:131], a[136:139], v[72:75], v[128:131]
  ds_read_b128 a[168:171], v3 offset:18432
  buffer_load_dwordx4 v2, s[44:47], s26 offen offset:0 sc1 lds
  v_add_f32 v226, v216, v217
  v_mfma_f32_16x16x32_bf16 v[136:139], a[136:139], v[76:79], v[136:139]
  v_exp_f32 v220, v148
  v_mfma_f32_16x16x32_bf16 v[132:135], a[140:143], v[72:75], v[132:135]
  ds_read_b128 a[172:175], v3 offset:19456
  v_cvt_pk_bf16_f32 v184, v216, v217
  v_add_f32 v226, v226, v218
  v_mfma_f32_16x16x32_bf16 v[140:143], a[140:143], v[76:79], v[140:143]
  s_add_u32 s14, s13, 36864
  s_waitcnt lgkmcnt(4)
  buffer_load_dwordx4 v[48:51], v2, s[40:43], s14 offen offset:0 sc1
  v_add_f32 v226, v226, v219
  v_mfma_f32_16x16x32_bf16 v[128:131], a[144:147], v[80:83], v[128:131]
  ds_read_b128 a[176:179], v3 offset:20480
  v_cvt_pk_bf16_f32 v185, v218, v219
  v_add_f32 v226, v226, v220
  v_mfma_f32_16x16x32_bf16 v[136:139], a[144:147], v[84:87], v[136:139]
  v_exp_f32 v221, v149
  v_mfma_f32_16x16x32_bf16 v[132:135], a[148:151], v[80:83], v[132:135]
  ds_read_b128 a[180:183], v3 offset:21504
  buffer_load_dwordx4 v2, s[44:47], s26 offen offset:1024 sc1 lds
  v_add_f32 v226, v226, v221
  v_mfma_f32_16x16x32_bf16 v[140:143], a[148:151], v[84:87], v[140:143]
  v_exp_f32 v222, v150
  v_cvt_pk_bf16_f32 v186, v220, v221
  v_mfma_f32_16x16x32_bf16 v[128:131], a[152:155], v[88:91], v[128:131]
  ds_read_b128 a[184:187], v3 offset:22528
  v_add_f32 v226, v226, v222
  v_mfma_f32_16x16x32_bf16 v[136:139], a[152:155], v[92:95], v[136:139]
  v_exp_f32 v223, v151
  v_exp_f32 v216, v152
  v_mfma_f32_16x16x32_bf16 v[132:135], a[156:159], v[88:91], v[132:135]
  ds_read_b128 a[188:191], v3 offset:23552
  buffer_load_dwordx4 v[52:55], v2, s[40:43], s14 offen offset:1024 sc1
  v_mfma_f32_16x16x32_bf16 v[140:143], a[156:159], v[92:95], v[140:143]
  s_waitcnt lgkmcnt(4)
  v_exp_f32 v217, v153
  v_mfma_f32_16x16x32_bf16 a[64:67], a[160:163], v[176:179], a[64:67]
  ds_read_b128 a[128:131], v3 offset:0
  v_add_f32 v226, v226, v223
  v_mfma_f32_16x16x32_bf16 a[68:71], a[160:163], v[180:183], a[68:71]
  v_exp_f32 v218, v154
  v_cvt_pk_bf16_f32 v187, v222, v223
  v_mfma_f32_16x16x32_bf16 a[72:75], a[164:167], v[176:179], a[72:75]
  ds_read_b128 a[132:135], v3 offset:1024
  buffer_load_dwordx4 v2, s[44:47], s26 offen offset:2048 sc1 lds
  v_mfma_f32_16x16x32_bf16 a[76:79], a[164:167], v[180:183], a[76:79]
  v_exp_f32 v219, v155
  v_add_f32 v227, v216, v217
  v_mfma_f32_16x16x32_bf16 a[80:83], a[168:171], v[176:179], a[80:83]
  ds_read_b128 a[136:139], v3 offset:2048
  v_cvt_pk_bf16_f32 v188, v216, v217
  v_add_f32 v227, v227, v218
  v_mfma_f32_16x16x32_bf16 a[84:87], a[168:171], v[180:183], a[84:87]
  buffer_load_dwordx4 v[56:59], v2, s[40:43], s14 offen offset:2048 sc1
  v_add_f32 v227, v227, v219
  v_mfma_f32_16x16x32_bf16 a[88:91], a[172:175], v[176:179], a[88:91]
  ds_read_b128 a[140:143], v3 offset:3072
  v_cvt_pk_bf16_f32 v189, v218, v219
  v_exp_f32 v220, v156
  v_mfma_f32_16x16x32_bf16 a[92:95], a[172:175], v[180:183], a[92:95]
  s_waitcnt lgkmcnt(4)
  v_exp_f32 v221, v157
  v_mfma_f32_16x16x32_bf16 a[96:99], a[176:179], v[176:179], a[96:99]
  ds_read_b128 a[144:147], v3 offset:4096
  buffer_load_dwordx4 v2, s[44:47], s26 offen offset:3072 sc1 lds
  v_mfma_f32_16x16x32_bf16 a[100:103], a[176:179], v[180:183], a[100:103]
  s_add_u32 s26, s26, 16384
  v_exp_f32 v222, v158
  v_mfma_f32_16x16x32_bf16 a[104:107], a[180:183], v[176:179], a[104:107]
  s_add_u32 s24, s24, 32768
  ds_read_b128 a[148:151], v3 offset:5120
  v_add_f32 v227, v227, v220
  v_add_f32 v227, v227, v221
  v_mfma_f32_16x16x32_bf16 a[108:111], a[180:183], v[180:183], a[108:111]
  s_and_b32 s24, s24, 0x1ffff
  v_exp_f32 v223, v159
  v_mfma_f32_16x16x32_bf16 a[112:115], a[184:187], v[176:179], a[112:115]
  ds_read_b128 a[152:155], v3 offset:6144
  v_cvt_pk_bf16_f32 v190, v220, v221
  v_add_f32 v227, v227, v222
  v_mfma_f32_16x16x32_bf16 a[116:119], a[184:187], v[180:183], a[116:119]
  v_add_f32 v227, v227, v223
  v_cvt_pk_bf16_f32 v191, v222, v223
  v_mfma_f32_16x16x32_bf16 a[120:123], a[188:191], v[176:179], a[120:123]
  s_waitcnt lgkmcnt(3)
  ds_read_b128 a[156:159], v3 offset:7168
  v_max_f32 v5, v226, v227
  v_cmp_lt_f32 vcc, s81, v5
  v_mfma_f32_16x16x32_bf16 a[124:127], a[188:191], v[180:183], a[124:127]
  s_cbranch_vccnz fa_stub23
fa_back23:
  v_add_f32 v230, v230, v226
  v_add_f32 v231, v231, v227
  v_mfma_f32_16x16x32_bf16 v[144:147], a[128:131], v[64:67], v[200:203]
  ds_read_b128 a[160:163], v3 offset:24576
  v_exp_f32 v216, v128
  v_mfma_f32_16x16x32_bf16 v[152:155], a[128:131], v[68:71], v[204:207]
  v_exp_f32 v217, v129
  v_mfma_f32_16x16x32_bf16 v[148:151], a[132:135], v[64:67], v[200:203]
  ds_read_b128 a[164:167], v3 offset:25600
  v_add_f32 v226, v216, v217
  v_cvt_pk_bf16_f32 v176, v216, v217
  v_mfma_f32_16x16x32_bf16 v[156:159], a[132:135], v[68:71], v[204:207]
  s_mov_b32 m0, s25
  v_exp_f32 v218, v130
  v_mfma_f32_16x16x32_bf16 v[144:147], a[136:139], v[72:75], v[144:147]
  ds_read_b128 a[168:171], v3 offset:26624
  buffer_load_dwordx4 v2, s[48:51], s27 offen offset:0 sc1 lds
  v_add_f32 v226, v226, v218
  v_mfma_f32_16x16x32_bf16 v[152:155], a[136:139], v[76:79], v[152:155]
  v_exp_f32 v219, v131
  v_mfma_f32_16x16x32_bf16 v[148:151], a[140:143], v[72:75], v[148:151]
  ds_read_b128 a[172:175], v3 offset:27648
  v_add_f32 v226, v226, v219
  v_cvt_pk_bf16_f32 v177, v218, v219
  v_mfma_f32_16x16x32_bf16 v[156:159], a[140:143], v[76:79], v[156:159]
  s_add_u32 s14, s13, 36864
  s_waitcnt lgkmcnt(4)
  buffer_load_dwordx4 v[60:63], v2, s[40:43], s14 offen offset:3072 sc1
  v_exp_f32 v220, v132
  v_mfma_f32_16x16x32_bf16 v[144:147], a[144:147], v[80:83], v[144:147]
  ds_read_b128 a[176:179], v3 offset:28672
  v_add_f32 v226, v226, v220
  v_mfma_f32_16x16x32_bf16 v[152:155], a[144:147], v[84:87], v[152:155]
  v_exp_f32 v221, v133
  v_mfma_f32_16x16x32_bf16 v[148:151], a[148:151], v[80:83], v[148:151]
  ds_read_b128 a[180:183], v3 offset:29696
  buffer_load_dwordx4 v2, s[48:51], s27 offen offset:1024 sc1 lds
  v_add_f32 v226, v226, v221
  v_mfma_f32_16x16x32_bf16 v[156:159], a[148:151], v[84:87], v[156:159]
  v_exp_f32 v222, v134
  v_cvt_pk_bf16_f32 v178, v220, v221
  v_mfma_f32_16x16x32_bf16 v[144:147], a[152:155], v[88:91], v[144:147]
  ds_read_b128 a[184:187], v3 offset:30720
  v_add_f32 v226, v226, v222
  v_mfma_f32_16x16x32_bf16 v[152:155], a[152:155], v[92:95], v[152:155]
  v_exp_f32 v223, v135
  v_exp_f32 v216, v136
  v_mfma_f32_16x16x32_bf16 v[148:151], a[156:159], v[88:91], v[148:151]
  s_add_u32 s14, s13, 40960
  ds_read_b128 a[188:191], v3 offset:31744
  buffer_load_dwordx4 v[96:99], v2, s[40:43], s14 offen offset:0 sc1
  v_mfma_f32_16x16x32_bf16 v[156:159], a[156:159], v[92:95], v[156:159]
  s_waitcnt lgkmcnt(4)
  v_exp_f32 v217, v137
  v_mfma_f32_16x16x32_bf16 a[64:67], a[160:163], v[184:187], a[64:67]
  ds_read_b128 a[128:131], v3 offset:8192
  v_add_f32 v226, v226, v223
  v_mfma_f32_16x16x32_bf16 a[68:71], a[160:163], v[188:191], a[68:71]
  v_exp_f32 v218, v138
  v_cvt_pk_bf16_f32 v179, v222, v223
  v_mfma_f32_16x16x32_bf16 a[72:75], a[164:167], v[184:187], a[72:75]
  ds_read_b128 a[132:135], v3 offset:9216
  buffer_load_dwordx4 v2, s[48:51], s27 offen offset:2048 sc1 lds
  v_mfma_f32_16x16x32_bf16 a[76:79], a[164:167], v[188:191], a[76:79]
  v_exp_f32 v219, v139
  v_add_f32 v227, v216, v217
  v_mfma_f32_16x16x32_bf16 a[80:83], a[168:171], v[184:187], a[80:83]
  ds_read_b128 a[136:139], v3 offset:10240
  v_cvt_pk_bf16_f32 v180, v216, v217
  v_add_f32 v227, v227, v218
  v_mfma_f32_16x16x32_bf16 a[84:87], a[168:171], v[188:191], a[84:87]
  buffer_load_dwordx4 v[100:103], v2, s[40:43], s14 offen offset:1024 sc1
  v_add_f32 v227, v227, v219
  v_mfma_f32_16x16x32_bf16 a[88:91], a[172:175], v[184:187], a[88:91]
  ds_read_b128 a[140:143], v3 offset:11264
  v_cvt_pk_bf16_f32 v181, v218, v219
  v_exp_f32 v220, v140
  v_mfma_f32_16x16x32_bf16 a[92:95], a[172:175], v[188:191], a[92:95]
  s_waitcnt lgkmcnt(4)
  v_exp_f32 v221, v141
  v_mfma_f32_16x16x32_bf16 a[96:99], a[176:179], v[184:187], a[96:99]
  ds_read_b128 a[144:147], v3 offset:12288
  buffer_load_dwordx4 v2, s[48:51], s27 offen offset:3072 sc1 lds
  v_mfma_f32_16x16x32_bf16 a[100:103], a[176:179], v[188:191], a[100:103]
  s_add_u32 s27, s27, 16384
  v_exp_f32 v222, v142
  v_mfma_f32_16x16x32_bf16 a[104:107], a[180:183], v[184:187], a[104:107]
  s_add_u32 s25, s25, 32768
  ds_read_b128 a[148:151], v3 offset:13312
  v_add_f32 v227, v227, v220
  v_add_f32 v227, v227, v221
  v_mfma_f32_16x16x32_bf16 a[108:111], a[180:183], v[188:191], a[108:111]
  s_and_b32 s25, s25, 0x1ffff
  v_exp_f32 v223, v143
  v_mfma_f32_16x16x32_bf16 a[112:115], a[184:187], v[184:187], a[112:115]
  ds_read_b128 a[152:155], v3 offset:14336
  v_cvt_pk_bf16_f32 v182, v220, v221
  v_add_f32 v227, v227, v222
  v_mfma_f32_16x16x32_bf16 a[116:119], a[184:187], v[188:191], a[116:119]
  v_add_f32 v227, v227, v223
  v_cvt_pk_bf16_f32 v183, v222, v223
  v_mfma_f32_16x16x32_bf16 a[120:123], a[188:191], v[184:187], a[120:123]
  s_waitcnt lgkmcnt(3)
  ds_read_b128 a[156:159], v3 offset:15360
  v_max_f32 v5, v226, v227
  v_cmp_lt_f32 vcc, s81, v5
  v_mfma_f32_16x16x32_bf16 a[124:127], a[188:191], v[188:191], a[124:127]
  s_cbranch_vccnz fa_stub24
fa_back24:
  v_add_f32 v230, v230, v226
  v_add_f32 v231, v231, v227
  v_add_u32 v3, 32768, v3
  v_and_b32 v3, 0x1ffff, v3
fa_SSW1:
  v_mfma_f32_16x16x32_bf16 v[128:131], a[128:131], v[64:67], v[200:203]
  s_waitcnt vmcnt(12)
  v_exp_f32 v216, v144
  v_exp_f32 v217, v145
  v_mfma_f32_16x16x32_bf16 v[136:139], a[128:131], v[68:71], v[204:207]
  s_barrier
  v_exp_f32 v218, v146
  v_mfma_f32_16x16x32_bf16 v[132:135], a[132:135], v[64:67], v[200:203]
  ds_read_b128 a[160:163], v3 offset:16384
  ds_read_b128 a[164:167], v3 offset:17408
  v_mfma_f32_16x16x32_bf16 v[140:143], a[132:135], v[68:71], v[204:207]
  s_mov_b32 m0, s24
  v_exp_f32 v219, v147
  v_mfma_f32_16x16x32_bf16 v[128:131], a[136:139], v[72:75], v[128:131]
  ds_read_b128 a[168:171], v3 offset:18432
  buffer_load_dwordx4 v2, s[44:47], s26 offen offset:0 sc1 lds
  v_add_f32 v226, v216, v217
  v_mfma_f32_16x16x32_bf16 v[136:139], a[136:139], v[76:79], v[136:139]
  v_exp_f32 v220, v148
  v_mfma_f32_16x16x32_bf16 v[132:135], a[140:143], v[72:75], v[132:135]
  ds_read_b128 a[172:175], v3 offset:19456
  v_cvt_pk_bf16_f32 v184, v216, v217
  v_add_f32 v226, v226, v218
  v_mfma_f32_16x16x32_bf16 v[140:143], a[140:143], v[76:79], v[140:143]
  s_add_u32 s14, s13, 40960
  s_waitcnt lgkmcnt(4)
  buffer_load_dwordx4 v[104:107], v2, s[40:43], s14 offen offset:2048 sc1
  v_add_f32 v226, v226, v219
  v_mfma_f32_16x16x32_bf16 v[128:131], a[144:147], v[80:83], v[128:131]
  ds_read_b128 a[176:179], v3 offset:20480
  v_cvt_pk_bf16_f32 v185, v218, v219
  v_add_f32 v226, v226, v220
  v_mfma_f32_16x16x32_bf16 v[136:139], a[144:147], v[84:87], v[136:139]
  v_exp_f32 v221, v149
  v_mfma_f32_16x16x32_bf16 v[132:135], a[148:151], v[80:83], v[132:135]
  ds_read_b128 a[180:183], v3 offset:21504
  buffer_load_dwordx4 v2, s[44:47], s26 offen offset:1024 sc1 lds
  v_add_f32 v226, v226, v221
  v_mfma_f32_16x16x32_bf16 v[140:143], a[148:151], v[84:87], v[140:143]
  v_exp_f32 v222, v150
  v_cvt_pk_bf16_f32 v186, v220, v221
  v_mfma_f32_16x16x32_bf16 v[128:131], a[152:155], v[88:91], v[128:131]
  ds_read_b128 a[184:187], v3 offset:22528
  v_add_f32 v226, v226, v222
  v_mfma_f32_16x16x32_bf16 v[136:139], a[152:155], v[92:95], v[136:139]
  v_exp_f32 v223, v151
  v_exp_f32 v216, v152
  v_mfma_f32_16x16x32_bf16 v[132:135], a[156:159], v[88:91], v[132:135]
  ds_read_b128 a[188:191], v3 offset:23552
  buffer_load_dwordx4 v[108:111], v2, s[40:43], s14 offen offset:3072 sc1
  v_mfma_f32_16x16x32_bf16 v[140:143], a[156:159], v[92:95], v[140:143]
  s_waitcnt lgkmcnt(4)
  v_exp_f32 v217, v153
  v_mfma_f32_16x16x32_bf16 a[64:67], a[160:163], v[176:179], a[64:67]
  ds_read_b128 a[128:131], v3 offset:0
  v_add_f32 v226, v226, v223
  v_mfma_f32_16x16x32_bf16 a[68:71], a[160:163], v[180:183], a[68:71]
  v_exp_f32 v218, v154
  v_cvt_pk_bf16_f32 v187, v222, v223
  v_mfma_f32_16x16x32_bf16 a[72:75], a[164:167], v[176:179], a[72:75]
  ds_read_b128 a[132:135], v3 offset:1024
  buffer_load_dwordx4 v2, s[44:47], s26 offen offset:2048 sc1 lds
  v_mfma_f32_16x16x32_bf16 a[76:79], a[164:167], v[180:183], a[76:79]
  v_exp_f32 v219, v155
  v_add_f32 v227, v216, v217
  v_mfma_f32_16x16x32_bf16 a[80:83], a[168:171], v[176:179], a[80:83]
  ds_read_b128 a[136:139], v3 offset:2048
  v_cvt_pk_bf16_f32 v188, v216, v217
  v_add_f32 v227, v227, v218
  v_mfma_f32_16x16x32_bf16 a[84:87], a[168:171], v[180:183], a[84:87]
  s_add_u32 s14, s13, 45056
  buffer_load_dwordx4 v[112:115], v2, s[40:43], s14 offen offset:0 sc1
  v_add_f32 v227, v227, v219
  v_mfma_f32_16x16x32_bf16 a[88:91], a[172:175], v[176:179], a[88:91]
  ds_read_b128 a[140:143], v3 offset:3072
  v_cvt_pk_bf16_f32 v189, v218, v219
  v_exp_f32 v220, v156
  v_mfma_f32_16x16x32_bf16 a[92:95], a[172:175], v[180:183], a[92:95]
  s_waitcnt lgkmcnt(4)
  v_exp_f32 v221, v157
  v_mfma_f32_16x16x32_bf16 a[96:99], a[176:179], v[176:179], a[96:99]
  ds_read_b128 a[144:147], v3 offset:4096
  buffer_load_dwordx4 v2, s[44:47], s26 offen offset:3072 sc1 lds
  v_mfma_f32_16x16x32_bf16 a[100:103], a[176:179], v[180:183], a[100:103]
  s_add_u32 s26, s26, 16384
  v_exp_f32 v222, v158
  v_mfma_f32_16x16x32_bf16 a[104:107], a[180:183], v[176:179], a[104:107]
  s_add_u32 s24, s24, 32768
  ds_read_b128 a[148:151], v3 offset:5120
  v_add_f32 v227, v227, v220
  v_add_f32 v227, v227, v221
  v_mfma_f32_16x16x32_bf16 a[108:111], a[180:183], v[180:183], a[108:111]
  s_and_b32 s24, s24, 0x1ffff
  v_exp_f32 v223, v159
  v_mfma_f32_16x16x32_bf16 a[112:115], a[184:187], v[176:179], a[112:115]
  ds_read_b128 a[152:155], v3 offset:6144
  v_cvt_pk_bf16_f32 v190, v220, v221
  v_add_f32 v227, v227, v222
  v_mfma_f32_16x16x32_bf16 a[116:119], a[184:187], v[180:183], a[116:119]
  v_add_f32 v227, v227, v223
  v_cvt_pk_bf16_f32 v191, v222, v223
  v_mfma_f32_16x16x32_bf16 a[120:123], a[188:191], v[176:179], a[120:123]
  s_waitcnt lgkmcnt(3)
  ds_read_b128 a[156:159], v3 offset:7168
  v_max_f32 v5, v226, v227
  v_cmp_lt_f32 vcc, s81, v5
  v_mfma_f32_16x16x32_bf16 a[124:127], a[188:191], v[180:183], a[124:127]
  s_cbranch_vccnz fa_stub25
fa_back25:
  v_add_f32 v230, v230, v226
  v_add_f32 v231, v231, v227
  v_mfma_f32_16x16x32_bf16 v[144:147], a[128:131], v[64:67], v[200:203]
  ds_read_b128 a[160:163], v3 offset:24576
  v_exp_f32 v216, v128
  v_mfma_f32_16x16x32_bf16 v[152:155], a[128:131], v[68:71], v[204:207]
  v_exp_f32 v217, v129
  v_mfma_f32_16x16x32_bf16 v[148:151], a[132:135], v[64:67], v[200:203]
  ds_read_b128 a[164:167], v3 offset:25600
  v_add_f32 v226, v216, v217
  v_cvt_pk_bf16_f32 v176, v216, v217
  v_mfma_f32_16x16x32_bf16 v[156:159], a[132:135], v[68:71], v[204:207]
  s_mov_b32 m0, s25
  v_exp_f32 v218, v130
  v_mfma_f32_16x16x32_bf16 v[144:147], a[136:139], v[72:75], v[144:147]
  ds_read_b128 a[168:171], v3 offset:26624
  buffer_load_dwordx4 v2, s[48:51], s27 offen offset:0 sc1 lds
  v_add_f32 v226, v226, v218
  v_mfma_f32_16x16x32_bf16 v[152:155], a[136:139], v[76:79], v[152:155]
  v_exp_f32 v219, v131
  v_mfma_f32_16x16x32_bf16 v[148:151], a[140:143], v[72:75], v[148:151]
  ds_read_b128 a[172:175], v3 offset:27648
  v_add_f32 v226, v226, v219
  v_cvt_pk_bf16_f32 v177, v218, v219
  v_mfma_f32_16x16x32_bf16 v[156:159], a[140:143], v[76:79], v[156:159]
  s_add_u32 s14, s13, 45056
  s_waitcnt lgkmcnt(4)
  buffer_load_dwordx4 v[116:119], v2, s[40:43], s14 offen offset:1024 sc1
  v_exp_f32 v220, v132
  v_mfma_f32_16x16x32_bf16 v[144:147], a[144:147], v[80:83], v[144:147]
  ds_read_b128 a[176:179], v3 offset:28672
  v_add_f32 v226, v226, v220
  v_mfma_f32_16x16x32_bf16 v[152:155], a[144:147], v[84:87], v[152:155]
  v_exp_f32 v221, v133
  v_mfma_f32_16x16x32_bf16 v[148:151], a[148:151], v[80:83], v[148:151]
  ds_read_b128 a[180:183], v3 offset:29696
  buffer_load_dwordx4 v2, s[48:51], s27 offen offset:1024 sc1 lds
  v_add_f32 v226, v226, v221
  v_mfma_f32_16x16x32_bf16 v[156:159], a[148:151], v[84:87], v[156:159]
  v_exp_f32 v222, v134
  v_cvt_pk_bf16_f32 v178, v220, v221
  v_mfma_f32_16x16x32_bf16 v[144:147], a[152:155], v[88:91], v[144:147]
  ds_read_b128 a[184:187], v3 offset:30720
  v_add_f32 v226, v226, v222
  v_mfma_f32_16x16x32_bf16 v[152:155], a[152:155], v[92:95], v[152:155]
  v_exp_f32 v223, v135
  v_exp_f32 v216, v136
  v_mfma_f32_16x16x32_bf16 v[148:151], a[156:159], v[88:91], v[148:151]
  ds_read_b128 a[188:191], v3 offset:31744
  buffer_load_dwordx4 v[120:123], v2, s[40:43], s14 offen offset:2048 sc1
  v_mfma_f32_16x16x32_bf16 v[156:159], a[156:159], v[92:95], v[156:159]
  s_waitcnt lgkmcnt(4)
  v_exp_f32 v217, v137
  v_mfma_f32_16x16x32_bf16 a[64:67], a[160:163], v[184:187], a[64:67]
  ds_read_b128 a[128:131], v3 offset:8192
  v_add_f32 v226, v226, v223
  v_mfma_f32_16x16x32_bf16 a[68:71], a[160:163], v[188:191], a[68:71]
  v_exp_f32 v218, v138
  v_cvt_pk_bf16_f32 v179, v222, v223
  v_mfma_f32_16x16x32_bf16 a[72:75], a[164:167], v[184:187], a[72:75]
  ds_read_b128 a[132:135], v3 offset:9216
  buffer_load_dwordx4 v2, s[48:51], s27 offen offset:2048 sc1 lds
  v_mfma_f32_16x16x32_bf16 a[76:79], a[164:167], v[188:191], a[76:79]
  v_exp_f32 v219, v139
  v_add_f32 v227, v216, v217
  v_mfma_f32_16x16x32_bf16 a[80:83], a[168:171], v[184:187], a[80:83]
  ds_read_b128 a[136:139], v3 offset:10240
  v_cvt_pk_bf16_f32 v180, v216, v217
  v_add_f32 v227, v227, v218
  v_mfma_f32_16x16x32_bf16 a[84:87], a[168:171], v[188:191], a[84:87]
  buffer_load_dwordx4 v[124:127], v2, s[40:43], s14 offen offset:3072 sc1
  v_add_f32 v227, v227, v219
  v_mfma_f32_16x16x32_bf16 a[88:91], a[172:175], v[184:187], a[88:91]
  ds_read_b128 a[140:143], v3 offset:11264
  v_cvt_pk_bf16_f32 v181, v218, v219
  v_exp_f32 v220, v140
  v_mfma_f32_16x16x32_bf16 a[92:95], a[172:175], v[188:191], a[92:95]
  s_waitcnt lgkmcnt(4)
  v_exp_f32 v221, v141
  v_mfma_f32_16x16x32_bf16 a[96:99], a[176:179], v[184:187], a[96:99]
  ds_read_b128 a[144:147], v3 offset:12288
  buffer_load_dwordx4 v2, s[48:51], s27 offen offset:3072 sc1 lds
  v_mfma_f32_16x16x32_bf16 a[100:103], a[176:179], v[188:191], a[100:103]
  s_add_u32 s27, s27, 16384
  v_exp_f32 v222, v142
  v_mfma_f32_16x16x32_bf16 a[104:107], a[180:183], v[184:187], a[104:107]
  s_add_u32 s25, s25, 32768
  ds_read_b128 a[148:151], v3 offset:13312
  v_add_f32 v227, v227, v220
  v_add_f32 v227, v227, v221
  v_mfma_f32_16x16x32_bf16 a[108:111], a[180:183], v[188:191], a[108:111]
  s_and_b32 s25, s25, 0x1ffff
  v_exp_f32 v223, v143
  v_mfma_f32_16x16x32_bf16 a[112:115], a[184:187], v[184:187], a[112:115]
  ds_read_b128 a[152:155], v3 offset:14336
  v_cvt_pk_bf16_f32 v182, v220, v221
  v_add_f32 v227, v227, v222
  v_mfma_f32_16x16x32_bf16 a[116:119], a[184:187], v[188:191], a[116:119]
  v_add_f32 v227, v227, v223
  v_cvt_pk_bf16_f32 v183, v222, v223
  v_mfma_f32_16x16x32_bf16 a[120:123], a[188:191], v[184:187], a[120:123]
  s_waitcnt lgkmcnt(3)
  ds_read_b128 a[156:159], v3 offset:15360
  v_max_f32 v5, v226, v227
  v_cmp_lt_f32 vcc, s81, v5
  v_mfma_f32_16x16x32_bf16 a[124:127], a[188:191], v[188:191], a[124:127]
  s_cbranch_vccnz fa_stub26
fa_back26:
  v_add_f32 v230, v230, v226
  v_add_f32 v231, v231, v227
  v_add_u32 v3, 32768, v3
  v_and_b32 v3, 0x1ffff, v3
fa_Bexit:
  s_bitcmp1_b32 s20, 0
  s_cbranch_scc1 fa_Bodd
  v_mfma_f32_16x16x32_bf16 v[128:131], a[128:131], v[64:67], v[200:203]
  s_waitcnt vmcnt(0)
  v_exp_f32 v216, v144
  v_mfma_f32_16x16x32_bf16 v[136:139], a[128:131], v[68:71], v[204:207]
  s_barrier
  v_exp_f32 v217, v145
  v_exp_f32 v218, v146
  v_mfma_f32_16x16x32_bf16 v[132:135], a[132:135], v[64:67], v[200:203]
  ds_read_b128 a[160:163], v3 offset:16384
  ds_read_b128 a[164:167], v3 offset:17408
  v_mfma_f32_16x16x32_bf16 v[140:143], a[132:135], v[68:71], v[204:207]
  s_add_u32 s14, s13, 49152
  buffer_load_dwordx4 v[160:163], v2, s[40:43], s14 offen offset:0 sc1
  v_mfma_f32_16x16x32_bf16 v[128:131], a[136:139], v[72:75], v[128:131]
  ds_read_b128 a[168:171], v3 offset:18432
  v_add_f32 v226, v216, v217
  v_mfma_f32_16x16x32_bf16 v[136:139], a[136:139], v[76:79], v[136:139]
  v_exp_f32 v219, v147
  v_cvt_pk_bf16_f32 v184, v216, v217
  v_mfma_f32_16x16x32_bf16 v[132:135], a[140:143], v[72:75], v[132:135]
  ds_read_b128 a[172:175], v3 offset:19456
  v_add_f32 v226, v226, v218
  v_mfma_f32_16x16x32_bf16 v[140:143], a[140:143], v[76:79], v[140:143]
  s_waitcnt lgkmcnt(4)
  buffer_load_dwordx4 v[164:167], v2, s[40:43], s14 offen offset:1024 sc1
  v_add_f32 v226, v226, v219
  v_mfma_f32_16x16x32_bf16 v[128:131], a[144:147], v[80:83], v[128:131]
  ds_read_b128 a[176:179], v3 offset:20480
  v_cvt_pk_bf16_f32 v185, v218, v219
  v_mfma_f32_16x16x32_bf16 v[136:139], a[144:147], v[84:87], v[136:139]
  v_exp_f32 v220, v148
  v_exp_f32 v221, v149
  v_mfma_f32_16x16x32_bf16 v[132:135], a[148:151], v[80:83], v[132:135]
  ds_read_b128 a[180:183], v3 offset:21504
  v_mfma_f32_16x16x32_bf16 v[140:143], a[148:151], v[84:87], v[140:143]
  v_exp_f32 v222, v150
  v_mfma_f32_16x16x32_bf16 v[128:131], a[152:155], v[88:91], v[128:131]
  ds_read_b128 a[184:187], v3 offset:22528
  buffer_load_dwordx4 v[168:171], v2, s[40:43], s14 offen offset:2048 sc1
  v_mfma_f32_16x16x32_bf16 v[136:139], a[152:155], v[92:95], v[136:139]
  v_exp_f32 v223, v151
  v_add_f32 v226, v226, v220
  v_mfma_f32_16x16x32_bf16 v[132:135], a[156:159], v[88:91], v[132:135]
  ds_read_b128 a[188:191], v3 offset:23552
  v_add_f32 v226, v226, v221
  v_mfma_f32_16x16x32_bf16 v[140:143], a[156:159], v[92:95], v[140:143]
  s_waitcnt lgkmcnt(4)
  v_exp_f32 v216, v152
  v_mfma_f32_16x16x32_bf16 a[64:67], a[160:163], v[176:179], a[64:67]
  v_exp_f32 v217, v153
  v_mfma_f32_16x16x32_bf16 a[68:71], a[160:163], v[180:183], a[68:71]
  buffer_load_dwordx4 v[172:175], v2, s[40:43], s14 offen offset:3072 sc1
  v_cvt_pk_bf16_f32 v186, v220, v221
  v_add_f32 v226, v226, v222
  v_mfma_f32_16x16x32_bf16 a[72:75], a[164:167], v[176:179], a[72:75]
  v_exp_f32 v218, v154
  v_mfma_f32_16x16x32_bf16 a[76:79], a[164:167], v[180:183], a[76:79]
  v_exp_f32 v219, v155
  v_mfma_f32_16x16x32_bf16 a[80:83], a[168:171], v[176:179], a[80:83]
  v_exp_f32 v220, v156
  v_mfma_f32_16x16x32_bf16 a[84:87], a[168:171], v[180:183], a[84:87]
  s_add_u32 s14, s13, 53248
  buffer_load_dwordx4 v[192:195], v2, s[40:43], s14 offen offset:0 sc1
  v_add_f32 v226, v226, v223
  v_cvt_pk_bf16_f32 v187, v222, v223
  v_mfma_f32_16x16x32_bf16 a[88:91], a[172:175], v[176:179], a[88:91]
  v_exp_f32 v221, v157
  v_mfma_f32_16x16x32_bf16 a[92:95], a[172:175], v[180:183], a[92:95]
  s_waitcnt lgkmcnt(0)
  v_exp_f32 v222, v158
  v_mfma_f32_16x16x32_bf16 a[96:99], a[176:179], v[176:179], a[96:99]
  v_exp_f32 v223, v159
  v_mfma_f32_16x16x32_bf16 a[100:103], a[176:179], v[180:183], a[100:103]
  v_add_f32 v227, v216, v217
  v_cvt_pk_bf16_f32 v188, v216, v217
  v_add_f32 v227, v227, v218
  v_mfma_f32_16x16x32_bf16 a[104:107], a[180:183], v[176:179], a[104:107]
  buffer_load_dwordx4 v[196:199], v2, s[40:43], s14 offen offset:1024 sc1
  v_add_f32 v227, v227, v219
  v_mfma_f32_16x16x32_bf16 a[108:111], a[180:183], v[180:183], a[108:111]
  v_cvt_pk_bf16_f32 v189, v218, v219
  v_add_f32 v227, v227, v220
  v_mfma_f32_16x16x32_bf16 a[112:115], a[184:187], v[176:179], a[112:115]
  v_add_f32 v227, v227, v221
  v_cvt_pk_bf16_f32 v190, v220, v221
  v_mfma_f32_16x16x32_bf16 a[116:119], a[184:187], v[180:183], a[116:119]
  v_add_f32 v227, v227, v222
  v_add_f32 v227, v227, v223
  v_cvt_pk_bf16_f32 v191, v222, v223
  v_mfma_f32_16x16x32_bf16 a[120:123], a[188:191], v[176:179], a[120:123]
  v_max_f32 v5, v226, v227
  v_cmp_lt_f32 vcc, s81, v5
  v_mfma_f32_16x16x32_bf16 a[124:127], a[188:191], v[180:183], a[124:127]
  s_cbranch_vccnz fa_stub27
fa_back27:
  v_add_f32 v230, v230, v226
  v_add_f32 v231, v231, v227
  ds_read_b128 a[160:163], v3 offset:24576
  ds_read_b128 a[164:167], v3 offset:25600
  ds_read_b128 a[168:171], v3 offset:26624
  ds_read_b128 a[172:175], v3 offset:27648
  ds_read_b128 a[176:179], v3 offset:28672
  ds_read_b128 a[180:183], v3 offset:29696
  ds_read_b128 a[184:187], v3 offset:30720
  ds_read_b128 a[188:191], v3 offset:31744
  v_cndmask_b32 v128, v4, v128, s[68:69]
  v_cndmask_b32 v129, v4, v129, s[70:71]
  v_cndmask_b32 v130, v4, v130, s[72:73]
  v_cndmask_b32 v131, v4, v131, s[74:75]
  v_mov_b32 v132, v4
  v_mov_b32 v133, v4
  v_mov_b32 v134, v4
  v_mov_b32 v135, v4
  v_cndmask_b32 v140, v4, v140, s[68:69]
  v_cndmask_b32 v141, v4, v141, s[70:71]
  v_cndmask_b32 v142, v4, v142, s[72:73]
  v_cndmask_b32 v143, v4, v143, s[74:75]
  v_exp_f32 v216, v128
  v_exp_f32 v217, v129
  v_exp_f32 v218, v130
  v_exp_f32 v219, v131
  v_exp_f32 v220, v132
  v_exp_f32 v221, v133
  v_exp_f32 v222, v134
  v_exp_f32 v223, v135
  v_add_f32 v226, v216, v217
  v_cvt_pk_bf16_f32 v176, v216, v217
  s_waitcnt lgkmcnt(4)
  v_mfma_f32_16x16x32_bf16 a[64:67], a[160:163], v[184:187], a[64:67]
  v_exp_f32 v216, v136
  v_add_f32 v226, v226, v218
  v_mfma_f32_16x16x32_bf16 a[68:71], a[160:163], v[188:191], a[68:71]
  s_add_u32 s14, s13, 53248
  buffer_load_dwordx4 v[208:211], v2, s[40:43], s14 offen offset:2048 sc1
  v_add_f32 v226, v226, v219
  v_cvt_pk_bf16_f32 v177, v218, v219
  v_mfma_f32_16x16x32_bf16 a[72:75], a[164:167], v[184:187], a[72:75]
  v_exp_f32 v217, v137
  v_mfma_f32_16x16x32_bf16 a[76:79], a[164:167], v[188:191], a[76:79]
  v_exp_f32 v218, v138
  v_add_f32 v226, v226, v220
  v_mfma_f32_16x16x32_bf16 a[80:83], a[168:171], v[184:187], a[80:83]
  buffer_load_dwordx4 v[212:215], v2, s[40:43], s14 offen offset:3072 sc1
  v_add_f32 v226, v226, v221
  v_cvt_pk_bf16_f32 v178, v220, v221
  v_mfma_f32_16x16x32_bf16 a[84:87], a[168:171], v[188:191], a[84:87]
  v_exp_f32 v219, v139
  v_add_f32 v226, v226, v222
  v_mfma_f32_16x16x32_bf16 a[88:91], a[172:175], v[184:187], a[88:91]
  v_exp_f32 v220, v140
  v_add_f32 v226, v226, v223
  v_mfma_f32_16x16x32_bf16 a[92:95], a[172:175], v[188:191], a[92:95]
  s_waitcnt lgkmcnt(0)
  v_exp_f32 v221, v141
  v_mfma_f32_16x16x32_bf16 a[96:99], a[176:179], v[184:187], a[96:99]
  s_add_u32 s14, s13, 57344
  buffer_load_dwordx4 v[232:235], v2, s[40:43], s14 offen offset:0 sc1
  v_cvt_pk_bf16_f32 v179, v222, v223
  v_add_f32 v227, v216, v217
  v_mfma_f32_16x16x32_bf16 a[100:103], a[176:179], v[188:191], a[100:103]
  v_exp_f32 v222, v142
  v_cvt_pk_bf16_f32 v180, v216, v217
  v_mfma_f32_16x16x32_bf16 a[104:107], a[180:183], v[184:187], a[104:107]
  v_exp_f32 v223, v143
  v_add_f32 v227, v227, v218
  v_mfma_f32_16x16x32_bf16 a[108:111], a[180:183], v[188:191], a[108:111]
  buffer_load_dwordx4 v[236:239], v2, s[40:43], s14 offen offset:1024 sc1
  v_add_f32 v227, v227, v219
  v_cvt_pk_bf16_f32 v181, v218, v219
  v_mfma_f32_16x16x32_bf16 a[112:115], a[184:187], v[184:187], a[112:115]
  v_add_f32 v227, v227, v220
  v_add_f32 v227, v227, v221
  v_mfma_f32_16x16x32_bf16 a[116:119], a[184:187], v[188:191], a[116:119]
  v_cvt_pk_bf16_f32 v182, v220, v221
  v_add_f32 v227, v227, v222
  v_add_f32 v227, v227, v223
  v_mfma_f32_16x16x32_bf16 a[120:123], a[188:191], v[184:187], a[120:123]
  v_cvt_pk_bf16_f32 v183, v222, v223
  v_max_f32 v5, v226, v227
  v_cmp_lt_f32 vcc, s81, v5
  v_mfma_f32_16x16x32_bf16 a[124:127], a[188:191], v[188:191], a[124:127]
  s_cbranch_vccnz fa_stub28
fa_back28:
  v_add_f32 v230, v230, v226
  v_add_f32 v231, v231, v227
  v_add_u32 v3, 32768, v3
  v_and_b32 v3, 0x1ffff, v3
  s_waitcnt vmcnt(10)
  s_barrier
  ds_read_b128 a[160:163], v3 offset:16384
  ds_read_b128 a[164:167], v3 offset:17408
  ds_read_b128 a[168:171], v3 offset:18432
  ds_read_b128 a[172:175], v3 offset:19456
  ds_read_b128 a[176:179], v3 offset:20480
  ds_read_b128 a[180:183], v3 offset:21504
  ds_read_b128 a[184:187], v3 offset:22528
  ds_read_b128 a[188:191], v3 offset:23552
  s_waitcnt lgkmcnt(4)
  v_mfma_f32_16x16x32_bf16 a[64:67], a[160:163], v[176:179], a[64:67]
  v_mfma_f32_16x16x32_bf16 a[68:71], a[160:163], v[180:183], a[68:71]
  s_add_u32 s14, s13, 57344
  buffer_load_dwordx4 v[240:243], v2, s[40:43], s14 offen offset:2048 sc1
  v_mfma_f32_16x16x32_bf16 a[72:75], a[164:167], v[176:179], a[72:75]
  v_mfma_f32_16x16x32_bf16 a[76:79], a[164:167], v[180:183], a[76:79]
  v_mfma_f32_16x16x32_bf16 a[80:83], a[168:171], v[176:179], a[80:83]
  v_mfma_f32_16x16x32_bf16 a[84:87], a[168:171], v[180:183], a[84:87]
  v_mfma_f32_16x16x32_bf16 a[88:91], a[172:175], v[176:179], a[88:91]
  v_mfma_f32_16x16x32_bf16 a[92:95], a[172:175], v[180:183], a[92:95]
  s_waitcnt lgkmcnt(0)
  v_mfma_f32_16x16x32_bf16 a[96:99], a[176:179], v[176:179], a[96:99]
  buffer_load_dwordx4 v[244:247], v2, s[40:43], s14 offen offset:3072 sc1
  v_mfma_f32_16x16x32_bf16 a[100:103], a[176:179], v[180:183], a[100:103]
  v_mfma_f32_16x16x32_bf16 a[104:107], a[180:183], v[176:179], a[104:107]
  v_mfma_f32_16x16x32_bf16 a[108:111], a[180:183], v[180:183], a[108:111]
  v_mfma_f32_16x16x32_bf16 a[112:115], a[184:187], v[176:179], a[112:115]
  v_mfma_f32_16x16x32_bf16 a[116:119], a[184:187], v[180:183], a[116:119]
  v_mfma_f32_16x16x32_bf16 a[120:123], a[188:191], v[176:179], a[120:123]
  v_mfma_f32_16x16x32_bf16 a[124:127], a[188:191], v[180:183], a[124:127]
  s_branch fa_Bdone
fa_Bodd:
  s_waitcnt vmcnt(0)
  s_barrier
  ds_read_b128 a[160:163], v3 offset:16384
  ds_read_b128 a[164:167], v3 offset:17408
  ds_read_b128 a[168:171], v3 offset:18432
  ds_read_b128 a[172:175], v3 offset:19456
  ds_read_b128 a[176:179], v3 offset:20480
  ds_read_b128 a[180:183], v3 offset:21504
  ds_read_b128 a[184:187], v3 offset:22528
  ds_read_b128 a[188:191], v3 offset:23552
  v_cndmask_b32 v144, v4, v144, s[68:69]
  v_cndmask_b32 v145, v4, v145, s[70:71]
  v_cndmask_b32 v146, v4, v146, s[72:73]
  v_cndmask_b32 v147, v4, v147, s[74:75]
  v_mov_b32 v148, v4
  v_mov_b32 v149, v4
  v_mov_b32 v150, v4
  v_mov_b32 v151, v4
  v_cndmask_b32 v156, v4, v156, s[68:69]
  v_cndmask_b32 v157, v4, v157, s[70:71]
  v_cndmask_b32 v158, v4, v158, s[72:73]
  v_cndmask_b32 v159, v4, v159, s[74:75]
  v_exp_f32 v216, v144
  v_exp_f32 v217, v145
  v_exp_f32 v218, v146
  v_exp_f32 v219, v147
  v_exp_f32 v220, v148
  v_exp_f32 v221, v149
  v_exp_f32 v222, v150
  v_exp_f32 v223, v151
  v_add_f32 v226, v216, v217
  v_cvt_pk_bf16_f32 v184, v216, v217
  s_waitcnt lgkmcnt(4)
  v_mfma_f32_16x16x32_bf16 a[64:67], a[160:163], v[176:179], a[64:67]
  v_exp_f32 v216, v152
  v_add_f32 v226, v226, v218
  v_mfma_f32_16x16x32_bf16 a[68:71], a[160:163], v[180:183], a[68:71]
  s_add_u32 s14, s13, 49152
  buffer_load_dwordx4 v[160:163], v2, s[40:43], s14 offen offset:0 sc1
  v_add_f32 v226, v226, v219
  v_cvt_pk_bf16_f32 v185, v218, v219
  v_mfma_f32_16x16x32_bf16 a[72:75], a[164:167], v[176:179], a[72:75]
  v_exp_f32 v217, v153
  v_add_f32 v226, v226, v220
  v_mfma_f32_16x16x32_bf16 a[76:79], a[164:167], v[180:183], a[76:79]
  buffer_load_dwordx4 v[164:167], v2, s[40:43], s14 offen offset:1024 sc1
  v_add_f32 v226, v226, v221
  v_cvt_pk_bf16_f32 v186, v220, v221
  v_mfma_f32_16x16x32_bf16 a[80:83], a[168:171], v[176:179], a[80:83]
  v_exp_f32 v218, v154
  v_add_f32 v226, v226, v222
  v_mfma_f32_16x16x32_bf16 a[84:87], a[168:171], v[180:183], a[84:87]
  buffer_load_dwordx4 v[168:171], v2, s[40:43], s14 offen offset:2048 sc1
  v_add_f32 v226, v226, v223
  v_cvt_pk_bf16_f32 v187, v222, v223
  v_mfma_f32_16x16x32_bf16 a[88:91], a[172:175], v[176:179], a[88:91]
  v_exp_f32 v219, v155
  v_add_f32 v227, v216, v217
  v_mfma_f32_16x16x32_bf16 a[92:95], a[172:175], v[180:183], a[92:95]
  s_waitcnt lgkmcnt(0)
  buffer_load_dwordx4 v[172:175], v2, s[40:43], s14 offen offset:3072 sc1
  v_cvt_pk_bf16_f32 v188, v216, v217
  v_add_f32 v227, v227, v218
  v_mfma_f32_16x16x32_bf16 a[96:99], a[176:179], v[176:179], a[96:99]
  v_exp_f32 v220, v156
  v_add_f32 v227, v227, v219
  v_mfma_f32_16x16x32_bf16 a[100:103], a[176:179], v[180:183], a[100:103]
  s_add_u32 s14, s13, 53248
  buffer_load_dwordx4 v[192:195], v2, s[40:43], s14 offen offset:0 sc1
  v_cvt_pk_bf16_f32 v189, v218, v219
  v_add_f32 v227, v227, v220
  v_mfma_f32_16x16x32_bf16 a[104:107], a[180:183], v[176:179], a[104:107]
  v_exp_f32 v221, v157
  v_exp_f32 v222, v158
  v_mfma_f32_16x16x32_bf16 a[108:111], a[180:183], v[180:183], a[108:111]
  buffer_load_dwordx4 v[196:199], v2, s[40:43], s14 offen offset:1024 sc1
  v_add_f32 v227, v227, v221
  v_mfma_f32_16x16x32_bf16 a[112:115], a[184:187], v[176:179], a[112:115]
  v_exp_f32 v223, v159
  v_cvt_pk_bf16_f32 v190, v220, v221
  v_mfma_f32_16x16x32_bf16 a[116:119], a[184:187], v[180:183], a[116:119]
  buffer_load_dwordx4 v[208:211], v2, s[40:43], s14 offen offset:2048 sc1
  v_add_f32 v227, v227, v222
  v_add_f32 v227, v227, v223
  v_mfma_f32_16x16x32_bf16 a[120:123], a[188:191], v[176:179], a[120:123]
  v_cvt_pk_bf16_f32 v191, v222, v223
  v_max_f32 v5, v226, v227
  v_cmp_lt_f32 vcc, s81, v5
  v_mfma_f32_16x16x32_bf16 a[124:127], a[188:191], v[180:183], a[124:127]
  s_cbranch_vccnz fa_stub29
fa_back29:
  v_add_f32 v230, v230, v226
  v_add_f32 v231, v231, v227
  ds_read_b128 a[160:163], v3 offset:24576
  ds_read_b128 a[164:167], v3 offset:25600
  ds_read_b128 a[168:171], v3 offset:26624
  ds_read_b128 a[172:175], v3 offset:27648
  ds_read_b128 a[176:179], v3 offset:28672
  ds_read_b128 a[180:183], v3 offset:29696
  ds_read_b128 a[184:187], v3 offset:30720
  ds_read_b128 a[188:191], v3 offset:31744
  s_waitcnt lgkmcnt(4)
  v_mfma_f32_16x16x32_bf16 a[64:67], a[160:163], v[184:187], a[64:67]
  v_mfma_f32_16x16x32_bf16 a[68:71], a[160:163], v[188:191], a[68:71]
  s_add_u32 s14, s13, 53248
  buffer_load_dwordx4 v[212:215], v2, s[40:43], s14 offen offset:3072 sc1
  v_mfma_f32_16x16x32_bf16 a[72:75], a[164:167], v[184:187], a[72:75]
  v_mfma_f32_16x16x32_bf16 a[76:79], a[164:167], v[188:191], a[76:79]
  s_add_u32 s14, s13, 57344
  buffer_load_dwordx4 v[232:235], v2, s[40:43], s14 offen offset:0 sc1
  v_mfma_f32_16x16x32_bf16 a[80:83], a[168:171], v[184:187], a[80:83]
  v_mfma_f32_16x16x32_bf16 a[84:87], a[168:171], v[188:191], a[84:87]
  v_mfma_f32_16x16x32_bf16 a[88:91], a[172:175], v[184:187], a[88:91]
  buffer_load_dwordx4 v[236:239], v2, s[40:43], s14 offen offset:1024 sc1
  v_mfma_f32_16x16x32_bf16 a[92:95], a[172:175], v[188:191], a[92:95]
  s_waitcnt lgkmcnt(0)
  v_mfma_f32_16x16x32_bf16 a[96:99], a[176:179], v[184:187], a[96:99]
  v_mfma_f32_16x16x32_bf16 a[100:103], a[176:179], v[188:191], a[100:103]
  buffer_load_dwordx4 v[240:243], v2, s[40:43], s14 offen offset:2048 sc1
  v_mfma_f32_16x16x32_bf16 a[104:107], a[180:183], v[184:187], a[104:107]
  v_mfma_f32_16x16x32_bf16 a[108:111], a[180:183], v[188:191], a[108:111]
  v_mfma_f32_16x16x32_bf16 a[112:115], a[184:187], v[184:187], a[112:115]
  buffer_load_dwordx4 v[244:247], v2, s[40:43], s14 offen offset:3072 sc1
  v_mfma_f32_16x16x32_bf16 a[116:119], a[184:187], v[188:191], a[116:119]
  v_mfma_f32_16x16x32_bf16 a[120:123], a[188:191], v[184:187], a[120:123]
  v_mfma_f32_16x16x32_bf16 a[124:127], a[188:191], v[188:191], a[124:127]
  v_add_u32 v3, 32768, v3
  v_and_b32 v3, 0x1ffff, v3
fa_Bdone:
  s_cmp_ge_u32 s20, 2
  s_cbranch_scc1 fa_epi
  s_barrier
fa_epi:
  v_mov_b32 v20, v230
  v_mov_b32 v21, v231
  s_nop 1
  v_permlane16_swap_b32 v230, v20
  v_permlane16_swap_b32 v231, v21
  v_add_f32 v230, v230, v20
  v_add_f32 v231, v231, v21
  v_mov_b32 v20, v230
  v_mov_b32 v21, v231
  s_nop 1
  v_permlane32_swap_b32 v230, v20
  v_permlane32_swap_b32 v231, v21
  v_add_f32 v230, v230, v20
  v_add_f32 v231, v231, v21
  v_rcp_f32 v16, v230
  v_rcp_f32 v18, v231
  s_sub_u32 s23, 15, s22
  s_lshl_b32 s23, s23, 2
  v_mov_b32 v17, v16
  v_mov_b32 v19, v18
  s_add_u32 s23, s23, s20
  s_lshl_b32 s23, s23, 18
  s_lshl_b32 s31, s21, 12
  s_add_u32 s31, s31, 50331648
  s_add_u32 s64, s23, s31
  s_add_u32 s65, s64, 131072
  v_accvgpr_read_b32 v68, a64
  v_accvgpr_read_b32 v69, a65
  v_accvgpr_read_b32 v70, a66
  v_accvgpr_read_b32 v71, a67
  v_accvgpr_read_b32 v72, a72
  v_accvgpr_read_b32 v73, a73
  v_accvgpr_read_b32 v74, a74
  v_accvgpr_read_b32 v75, a75
  v_pk_mul_f32 v[68:69], v[68:69], v[16:17]
  v_pk_mul_f32 v[70:71], v[70:71], v[16:17]
  v_pk_mul_f32 v[72:73], v[72:73], v[16:17]
  v_pk_mul_f32 v[74:75], v[74:75], v[16:17]
  v_cvt_pk_bf16_f32 v64, v68, v69
  v_cvt_pk_bf16_f32 v65, v70, v71
  v_cvt_pk_bf16_f32 v66, v72, v73
  v_cvt_pk_bf16_f32 v67, v74, v75
  buffer_store_dwordx4 v[64:67], v2, s[40:43], s64 offen offset:0 sc1
  v_accvgpr_read_b32 v80, a80
  v_accvgpr_read_b32 v81, a81
  v_accvgpr_read_b32 v82, a82
  v_accvgpr_read_b32 v83, a83
  v_accvgpr_read_b32 v84, a88
  v_accvgpr_read_b32 v85, a89
  v_accvgpr_read_b32 v86, a90
  v_accvgpr_read_b32 v87, a91
  v_pk_mul_f32 v[80:81], v[80:81], v[16:17]
  v_pk_mul_f32 v[82:83], v[82:83], v[16:17]
  v_pk_mul_f32 v[84:85], v[84:85], v[16:17]
  v_pk_mul_f32 v[86:87], v[86:87], v[16:17]
  v_cvt_pk_bf16_f32 v76, v80, v81
  v_cvt_pk_bf16_f32 v77, v82, v83
  v_cvt_pk_bf16_f32 v78, v84, v85
  v_cvt_pk_bf16_f32 v79, v86, v87
  buffer_store_dwordx4 v[76:79], v2, s[40:43], s64 offen offset:1024 sc1
  v_accvgpr_read_b32 v132, a96
  v_accvgpr_read_b32 v133, a97
  v_accvgpr_read_b32 v134, a98
  v_accvgpr_read_b32 v135, a99
  v_accvgpr_read_b32 v136, a104
  v_accvgpr_read_b32 v137, a105
  v_accvgpr_read_b32 v138, a106
  v_accvgpr_read_b32 v139, a107
  v_pk_mul_f32 v[132:133], v[132:133], v[16:17]
  v_pk_mul_f32 v[134:135], v[134:135], v[16:17]
  v_pk_mul_f32 v[136:137], v[136:137], v[16:17]
  v_pk_mul_f32 v[138:139], v[138:139], v[16:17]
  v_cvt_pk_bf16_f32 v128, v132, v133
  v_cvt_pk_bf16_f32 v129, v134, v135
  v_cvt_pk_bf16_f32 v130, v136, v137
  v_cvt_pk_bf16_f32 v131, v138, v139
  buffer_store_dwordx4 v[128:131], v2, s[40:43], s64 offen offset:2048 sc1
  v_accvgpr_read_b32 v144, a112
  v_accvgpr_read_b32 v145, a113
  v_accvgpr_read_b32 v146, a114
  v_accvgpr_read_b32 v147, a115
  v_accvgpr_read_b32 v148, a120
  v_accvgpr_read_b32 v149, a121
  v_accvgpr_read_b32 v150, a122
  v_accvgpr_read_b32 v151, a123
  v_pk_mul_f32 v[144:145], v[144:145], v[16:17]
  v_pk_mul_f32 v[146:147], v[146:147], v[16:17]
  v_pk_mul_f32 v[148:149], v[148:149], v[16:17]
  v_pk_mul_f32 v[150:151], v[150:151], v[16:17]
  v_cvt_pk_bf16_f32 v140, v144, v145
  v_cvt_pk_bf16_f32 v141, v146, v147
  v_cvt_pk_bf16_f32 v142, v148, v149
  v_cvt_pk_bf16_f32 v143, v150, v151
  buffer_store_dwordx4 v[140:143], v2, s[40:43], s64 offen offset:3072 sc1
  v_accvgpr_read_b32 v68, a68
  v_accvgpr_read_b32 v69, a69
  v_accvgpr_read_b32 v70, a70
  v_accvgpr_read_b32 v71, a71
  v_accvgpr_read_b32 v72, a76
  v_accvgpr_read_b32 v73, a77
  v_accvgpr_read_b32 v74, a78
  v_accvgpr_read_b32 v75, a79
  v_pk_mul_f32 v[68:69], v[68:69], v[18:19]
  v_pk_mul_f32 v[70:71], v[70:71], v[18:19]
  v_pk_mul_f32 v[72:73], v[72:73], v[18:19]
  v_pk_mul_f32 v[74:75], v[74:75], v[18:19]
  v_cvt_pk_bf16_f32 v64, v68, v69
  v_cvt_pk_bf16_f32 v65, v70, v71
  v_cvt_pk_bf16_f32 v66, v72, v73
  v_cvt_pk_bf16_f32 v67, v74, v75
  buffer_store_dwordx4 v[64:67], v2, s[40:43], s65 offen offset:0 sc1
  v_accvgpr_read_b32 v80, a84
  v_accvgpr_read_b32 v81, a85
  v_accvgpr_read_b32 v82, a86
  v_accvgpr_read_b32 v83, a87
  v_accvgpr_read_b32 v84, a92
  v_accvgpr_read_b32 v85, a93
  v_accvgpr_read_b32 v86, a94
  v_accvgpr_read_b32 v87, a95
  v_pk_mul_f32 v[80:81], v[80:81], v[18:19]
  v_pk_mul_f32 v[82:83], v[82:83], v[18:19]
  v_pk_mul_f32 v[84:85], v[84:85], v[18:19]
  v_pk_mul_f32 v[86:87], v[86:87], v[18:19]
  v_cvt_pk_bf16_f32 v76, v80, v81
  v_cvt_pk_bf16_f32 v77, v82, v83
  v_cvt_pk_bf16_f32 v78, v84, v85
  v_cvt_pk_bf16_f32 v79, v86, v87
  buffer_store_dwordx4 v[76:79], v2, s[40:43], s65 offen offset:1024 sc1
  v_accvgpr_read_b32 v132, a100
  v_accvgpr_read_b32 v133, a101
  v_accvgpr_read_b32 v134, a102
  v_accvgpr_read_b32 v135, a103
  v_accvgpr_read_b32 v136, a108
  v_accvgpr_read_b32 v137, a109
  v_accvgpr_read_b32 v138, a110
  v_accvgpr_read_b32 v139, a111
  v_pk_mul_f32 v[132:133], v[132:133], v[18:19]
  v_pk_mul_f32 v[134:135], v[134:135], v[18:19]
  v_pk_mul_f32 v[136:137], v[136:137], v[18:19]
  v_pk_mul_f32 v[138:139], v[138:139], v[18:19]
  v_cvt_pk_bf16_f32 v128, v132, v133
  v_cvt_pk_bf16_f32 v129, v134, v135
  v_cvt_pk_bf16_f32 v130, v136, v137
  v_cvt_pk_bf16_f32 v131, v138, v139
  buffer_store_dwordx4 v[128:131], v2, s[40:43], s65 offen offset:2048 sc1
  v_accvgpr_read_b32 v144, a116
  v_accvgpr_read_b32 v145, a117
  v_accvgpr_read_b32 v146, a118
  v_accvgpr_read_b32 v147, a119
  v_accvgpr_read_b32 v148, a124
  v_accvgpr_read_b32 v149, a125
  v_accvgpr_read_b32 v150, a126
  v_accvgpr_read_b32 v151, a127
  v_pk_mul_f32 v[144:145], v[144:145], v[18:19]
  v_pk_mul_f32 v[146:147], v[146:147], v[18:19]
  v_pk_mul_f32 v[148:149], v[148:149], v[18:19]
  v_pk_mul_f32 v[150:151], v[150:151], v[18:19]
  v_cvt_pk_bf16_f32 v140, v144, v145
  v_cvt_pk_bf16_f32 v141, v146, v147
  v_cvt_pk_bf16_f32 v142, v148, v149
  v_cvt_pk_bf16_f32 v143, v150, v151
  buffer_store_dwordx4 v[140:143], v2, s[40:43], s65 offen offset:3072 sc1
  s_load_dwordx2 s[4:5], s[0:1], 0
  s_load_dwordx2 s[6:7], s[0:1], 88
  v_mov_b32 v30, 1073741824
  v_mov_b32 v31, 1
  v_writelane_b32 v30, s80, 0
  v_writelane_b32 v30, s3, 1
  s_lshl_b32 s64, s21, 19
  s_lshl_b32 s23, s20, 15
  s_add_u32 s64, s64, s23
  s_add_u32 s64, s64, 50331648
  s_add_u32 s65, s64, 131072
  s_add_u32 s66, s64, 262144
  s_add_u32 s67, s64, 393216
  v_bfe_u32 v12, v1, 3, 1
  v_lshlrev_b32 v12, 7, v12
  v_and_b32 v13, 7, v1
  v_lshl_add_u32 v12, v13, 2, v12
  s_lshl_b32 s23, s21, 8
  s_lshl_b32 s31, s20, 5
  s_add_u32 s23, s23, s31
  s_add_u32 s23, s23, 2641920
  v_add_u32 v12, s23, v12
  s_lshl_b32 s25, s21, 6
  s_mul_i32 s26, s22, 160
  s_mul_i32 s27, s22, 2560
  v_add_u32 v16, 0, v0
  v_mul_u32_u24 v17, 6554, v16
  v_lshrrev_b32 v17, 16, v17
  v_mul_u32_u24 v18, 10, v17
  v_sub_u32 v18, v16, v18
  v_mul_u32_u24 v251, 336, v17
  v_lshl_add_u32 v251, v18, 5, v251
  v_lshlrev_b32 v203, 5, v18
  v_add_u32 v17, s25, v17
  v_add_u32 v24, 1, v17
  v_mul_u32_u24 v248, 1280, v17
  v_lshl_add_u32 v248, v18, 4, v248
  v_add_u32 v248, s26, v248
  v_lshrrev_b32 v19, 4, v17
  v_mul_u32_u24 v19, 20480, v19
  v_and_b32 v17, 15, v17
  v_lshl_add_u32 v19, v17, 4, v19
  v_lshl_add_u32 v200, v18, 8, v19
  v_mov_b32 v27, 8
  v_add_u32 v16, 256, v0
  v_mul_u32_u24 v17, 6554, v16
  v_lshrrev_b32 v17, 16, v17
  v_mul_u32_u24 v18, 10, v17
  v_sub_u32 v18, v16, v18
  v_mul_u32_u24 v252, 336, v17
  v_lshl_add_u32 v252, v18, 5, v252
  v_lshlrev_b32 v204, 5, v18
  v_add_u32 v17, s25, v17
  v_add_u32 v25, 1, v17
  v_mul_u32_u24 v249, 1280, v17
  v_lshl_add_u32 v249, v18, 4, v249
  v_add_u32 v249, s26, v249
  v_lshrrev_b32 v19, 4, v17
  v_mul_u32_u24 v19, 20480, v19
  v_and_b32 v17, 15, v17
  v_lshl_add_u32 v19, v17, 4, v19
  v_lshl_add_u32 v201, v18, 8, v19
  v_mov_b32 v28, 8
  v_add_u32 v16, 512, v0
  v_mul_u32_u24 v17, 6554, v16
  v_lshrrev_b32 v17, 16, v17
  v_mul_u32_u24 v18, 10, v17
  v_sub_u32 v18, v16, v18
  v_mul_u32_u24 v253, 336, v17
  v_lshl_add_u32 v253, v18, 5, v253
  v_lshlrev_b32 v205, 5, v18
  v_add_u32 v17, s25, v17
  v_add_u32 v26, 1, v17
  v_mul_u32_u24 v250, 1280, v17
  v_lshl_add_u32 v250, v18, 4, v250
  v_add_u32 v250, s26, v250
  v_lshrrev_b32 v19, 4, v17
  v_mul_u32_u24 v19, 20480, v19
  v_and_b32 v17, 15, v17
  v_lshl_add_u32 v19, v17, 4, v19
  v_lshl_add_u32 v202, v18, 8, v19
  v_mov_b32 v29, 8
  v_cmp_gt_u32 vcc, 128, v0
  v_mov_b32 v16, 1073741824
  v_mov_b32 v17, 0
  v_cndmask_b32 v250, v16, v250, vcc
  v_cndmask_b32 v202, v16, v202, vcc
  v_cndmask_b32 v253, v17, v253, vcc
  v_mov_b32 v20, 0
  v_mov_b32 v21, 0
  v_mov_b32 v22, 0
  v_mov_b32 v23, 0
  v_add_u32 v16, 133632, v2
  ds_write_b128 v16, v[20:23]
  s_waitcnt vmcnt(0) lgkmcnt(0)
  buffer_store_dword v31, v30, s[40:43], 0 offen sc1
  s_cmp_lt_u32 s29, 8
  s_cbranch_scc1 fa_left
fa_leftb:
  s_add_u32 s13, s13, 61440
  buffer_load_dwordx4 v[64:67], v2, s[40:43], s13 offen offset:0 sc1
  buffer_load_dwordx4 v[68:71], v2, s[40:43], s13 offen offset:1024 sc1
  buffer_load_dwordx4 v[72:75], v2, s[40:43], s13 offen offset:2048 sc1
  buffer_load_dwordx4 v[76:79], v2, s[40:43], s13 offen offset:3072 sc1
  s_add_u32 s13, s13, 4096
  buffer_load_dwordx4 v[80:83], v2, s[40:43], s13 offen offset:0 sc1
  buffer_load_dwordx4 v[84:87], v2, s[40:43], s13 offen offset:1024 sc1
  buffer_load_dwordx4 v[88:91], v2, s[40:43], s13 offen offset:2048 sc1
  buffer_load_dwordx4 v[92:95], v2, s[40:43], s13 offen offset:3072 sc1
  s_add_u32 s13, s13, 4096
  buffer_load_dword v13, v12, s[40:43], 0 offen sc1
  buffer_load_dwordx4 v[128:131], v2, s[40:43], s13 offen offset:0 sc1
  buffer_load_dwordx4 v[132:135], v2, s[40:43], s13 offen offset:1024 sc1
  buffer_load_dwordx4 v[136:139], v2, s[40:43], s13 offen offset:2048 sc1
  buffer_load_dwordx4 v[140:143], v2, s[40:43], s13 offen offset:3072 sc1
  s_add_u32 s13, s13, 4096
  buffer_load_dwordx4 v[144:147], v2, s[40:43], s13 offen offset:0 sc1
  buffer_load_dwordx4 v[148:151], v2, s[40:43], s13 offen offset:1024 sc1
  buffer_load_dwordx4 v[152:155], v2, s[40:43], s13 offen offset:2048 sc1
  buffer_load_dwordx4 v[156:159], v2, s[40:43], s13 offen offset:3072 sc1
  s_add_u32 s13, s13, 4096
  buffer_load_dwordx4 v[176:179], v2, s[40:43], s13 offen offset:0 sc1
  buffer_load_dwordx4 v[180:183], v2, s[40:43], s13 offen offset:1024 sc1
  buffer_load_dwordx4 v[184:187], v2, s[40:43], s13 offen offset:2048 sc1
  buffer_load_dwordx4 v[188:191], v2, s[40:43], s13 offen offset:3072 sc1
  s_add_u32 s13, s13, 4096
  s_mov_b32 s44, s4
  s_mov_b32 s45, s5
  s_mov_b32 s46, 2621440
  s_mov_b32 s47, 0x20000
  s_mov_b32 s48, s6
  s_mov_b32 s49, s7
  s_mov_b32 s50, 2621440
  s_mov_b32 s51, 0x20000
  v_readlane_b32 s68, v15, 0
  v_readlane_b32 s69, v15, 1
  v_readlane_b32 s70, v15, 2
  v_readlane_b32 s71, v15, 3
  v_readlane_b32 s72, v15, 4
  v_readlane_b32 s73, v15, 5
  v_readlane_b32 s74, v15, 6
  v_readlane_b32 s75, v15, 7
  v_cmp_eq_u32 s[52:53], s68, v24
  v_cmp_eq_u32 s[54:55], s68, v25
  v_cmp_eq_u32 s[56:57], s68, v26
  v_cndmask_b32 v27, v27, 0, s[52:53]
  v_cndmask_b32 v28, v28, 0, s[54:55]
  v_cndmask_b32 v29, v29, 0, s[56:57]
  v_cmp_eq_u32 s[52:53], s69, v24
  v_cmp_eq_u32 s[54:55], s69, v25
  v_cmp_eq_u32 s[56:57], s69, v26
  v_cndmask_b32 v27, v27, 1, s[52:53]
  v_cndmask_b32 v28, v28, 1, s[54:55]
  v_cndmask_b32 v29, v29, 1, s[56:57]
  v_cmp_eq_u32 s[52:53], s70, v24
  v_cmp_eq_u32 s[54:55], s70, v25
  v_cmp_eq_u32 s[56:57], s70, v26
  v_cndmask_b32 v27, v27, 2, s[52:53]
  v_cndmask_b32 v28, v28, 2, s[54:55]
  v_cndmask_b32 v29, v29, 2, s[56:57]
  v_cmp_eq_u32 s[52:53], s71, v24
  v_cmp_eq_u32 s[54:55], s71, v25
  v_cmp_eq_u32 s[56:57], s71, v26
  v_cndmask_b32 v27, v27, 3, s[52:53]
  v_cndmask_b32 v28, v28, 3, s[54:55]
  v_cndmask_b32 v29, v29, 3, s[56:57]
  v_cmp_eq_u32 s[52:53], s72, v24
  v_cmp_eq_u32 s[54:55], s72, v25
  v_cmp_eq_u32 s[56:57], s72, v26
  v_cndmask_b32 v27, v27, 4, s[52:53]
  v_cndmask_b32 v28, v28, 4, s[54:55]
  v_cndmask_b32 v29, v29, 4, s[56:57]
  v_cmp_eq_u32 s[52:53], s73, v24
  v_cmp_eq_u32 s[54:55], s73, v25
  v_cmp_eq_u32 s[56:57], s73, v26
  v_cndmask_b32 v27, v27, 5, s[52:53]
  v_cndmask_b32 v28, v28, 5, s[54:55]
  v_cndmask_b32 v29, v29, 5, s[56:57]
  v_cmp_eq_u32 s[52:53], s74, v24
  v_cmp_eq_u32 s[54:55], s74, v25
  v_cmp_eq_u32 s[56:57], s74, v26
  v_cndmask_b32 v27, v27, 6, s[52:53]
  v_cndmask_b32 v28, v28, 6, s[54:55]
  v_cndmask_b32 v29, v29, 6, s[56:57]
  v_cmp_eq_u32 s[52:53], s75, v24
  v_cmp_eq_u32 s[54:55], s75, v25
  v_cmp_eq_u32 s[56:57], s75, v26
  v_cndmask_b32 v27, v27, 7, s[52:53]
  v_cndmask_b32 v28, v28, 7, s[54:55]
  v_cndmask_b32 v29, v29, 7, s[56:57]
  v_mul_u32_u24 v27, 320, v27
  v_add_u32 v203, v203, v27
  v_mul_u32_u24 v28, 320, v28
  v_add_u32 v204, v204, v28
  v_mul_u32_u24 v29, 320, v29
  v_add_u32 v205, v205, v29
  v_add_u32 v203, 131072, v203
  v_add_u32 v204, 131072, v204
  v_add_u32 v205, 131072, v205
  s_waitcnt vmcnt(12)
  v_cmp_eq_u32 vcc, 0, v13
  s_cbranch_vccnz fa_ctx_spin
fa_ctx_ok:
  buffer_load_dwordx4 a[144:147], v2, s[40:43], s64 offen offset:0 sc1
  buffer_load_dwordx4 a[148:151], v2, s[40:43], s65 offen offset:0 sc1
  buffer_load_dwordx4 a[152:155], v2, s[40:43], s66 offen offset:0 sc1
  buffer_load_dwordx4 a[156:159], v2, s[40:43], s67 offen offset:0 sc1
  buffer_load_dwordx4 a[160:163], v2, s[40:43], s64 offen offset:1024 sc1
  buffer_load_dwordx4 a[164:167], v2, s[40:43], s65 offen offset:1024 sc1
  buffer_load_dwordx4 a[168:171], v2, s[40:43], s66 offen offset:1024 sc1
  buffer_load_dwordx4 a[172:175], v2, s[40:43], s67 offen offset:1024 sc1
  buffer_load_dwordx4 a[176:179], v2, s[40:43], s64 offen offset:2048 sc1
  buffer_load_dwordx4 a[180:183], v2, s[40:43], s65 offen offset:2048 sc1
  buffer_load_dwordx4 a[184:187], v2, s[40:43], s66 offen offset:2048 sc1
  buffer_load_dwordx4 a[188:191], v2, s[40:43], s67 offen offset:2048 sc1
  buffer_load_dwordx4 v[216:219], v2, s[40:43], s64 offen offset:3072 sc1
  buffer_load_dwordx4 v[220:223], v2, s[40:43], s65 offen offset:3072 sc1
  buffer_load_dwordx4 v[224:227], v2, s[40:43], s66 offen offset:3072 sc1
  buffer_load_dwordx4 v[228:231], v2, s[40:43], s67 offen offset:3072 sc1
  s_add_u32 s64, s64, 4096
  s_add_u32 s65, s65, 4096
  s_add_u32 s66, s66, 4096
  s_add_u32 s67, s67, 4096
  s_waitcnt vmcnt(12)
  v_mfma_f32_16x16x32_bf16 a[64:67], a[0:3], a[144:147], 0
  v_mfma_f32_16x16x32_bf16 a[68:71], a[0:3], a[148:151], 0
  v_mfma_f32_16x16x32_bf16 a[72:75], a[0:3], a[152:155], 0
  v_mfma_f32_16x16x32_bf16 a[76:79], a[0:3], a[156:159], 0
  buffer_load_dwordx4 a[0:3], v2, s[40:43], s13 offen offset:0 sc1
  v_mfma_f32_16x16x32_bf16 a[80:83], a[4:7], a[144:147], 0
  v_mfma_f32_16x16x32_bf16 a[84:87], a[4:7], a[148:151], 0
  v_mfma_f32_16x16x32_bf16 a[88:91], a[4:7], a[152:155], 0
  v_mfma_f32_16x16x32_bf16 a[92:95], a[4:7], a[156:159], 0
  buffer_load_dwordx4 a[4:7], v2, s[40:43], s13 offen offset:1024 sc1
  v_mfma_f32_16x16x32_bf16 a[96:99], a[8:11], a[144:147], 0
  v_mfma_f32_16x16x32_bf16 a[100:103], a[8:11], a[148:151], 0
  v_mfma_f32_16x16x32_bf16 a[104:107], a[8:11], a[152:155], 0
  v_mfma_f32_16x16x32_bf16 a[108:111], a[8:11], a[156:159], 0
  buffer_load_dwordx4 a[8:11], v2, s[40:43], s13 offen offset:2048 sc1
  v_mfma_f32_16x16x32_bf16 a[112:115], a[12:15], a[144:147], 0
  v_mfma_f32_16x16x32_bf16 a[116:119], a[12:15], a[148:151], 0
  v_mfma_f32_16x16x32_bf16 a[120:123], a[12:15], a[152:155], 0
  v_mfma_f32_16x16x32_bf16 a[124:127], a[12:15], a[156:159], 0
  v_mfma_f32_16x16x32_bf16 a[128:131], a[16:19], a[144:147], 0
  buffer_load_dwordx4 a[144:147], v2, s[40:43], s64 offen offset:0 sc1
  v_mfma_f32_16x16x32_bf16 a[132:135], a[16:19], a[148:151], 0
  buffer_load_dwordx4 a[148:151], v2, s[40:43], s65 offen offset:0 sc1
  v_mfma_f32_16x16x32_bf16 a[136:139], a[16:19], a[152:155], 0
  buffer_load_dwordx4 a[152:155], v2, s[40:43], s66 offen offset:0 sc1
  v_mfma_f32_16x16x32_bf16 a[140:143], a[16:19], a[156:159], 0
  buffer_load_dwordx4 a[156:159], v2, s[40:43], s67 offen offset:0 sc1
  s_waitcnt vmcnt(15)
  v_mfma_f32_16x16x32_bf16 a[64:67], a[20:23], a[160:163], a[64:67]
  v_mfma_f32_16x16x32_bf16 a[68:71], a[20:23], a[164:167], a[68:71]
  v_mfma_f32_16x16x32_bf16 a[72:75], a[20:23], a[168:171], a[72:75]
  v_mfma_f32_16x16x32_bf16 a[76:79], a[20:23], a[172:175], a[76:79]
  buffer_load_dwordx4 a[12:15], v2, s[40:43], s13 offen offset:3072 sc1
  v_mfma_f32_16x16x32_bf16 a[80:83], a[24:27], a[160:163], a[80:83]
  s_add_u32 s13, s13, 4096
  v_mfma_f32_16x16x32_bf16 a[84:87], a[24:27], a[164:167], a[84:87]
  v_mfma_f32_16x16x32_bf16 a[88:91], a[24:27], a[168:171], a[88:91]
  v_mfma_f32_16x16x32_bf16 a[92:95], a[24:27], a[172:175], a[92:95]
  buffer_load_dwordx4 a[16:19], v2, s[40:43], s13 offen offset:0 sc1
  v_mfma_f32_16x16x32_bf16 a[96:99], a[28:31], a[160:163], a[96:99]
  v_mfma_f32_16x16x32_bf16 a[100:103], a[28:31], a[164:167], a[100:103]
  v_mfma_f32_16x16x32_bf16 a[104:107], a[28:31], a[168:171], a[104:107]
  v_mfma_f32_16x16x32_bf16 a[108:111], a[28:31], a[172:175], a[108:111]
  buffer_load_dwordx4 a[20:23], v2, s[40:43], s13 offen offset:1024 sc1
  v_mfma_f32_16x16x32_bf16 a[112:115], a[32:35], a[160:163], a[112:115]
  v_mfma_f32_16x16x32_bf16 a[116:119], a[32:35], a[164:167], a[116:119]
  v_mfma_f32_16x16x32_bf16 a[120:123], a[32:35], a[168:171], a[120:123]
  v_mfma_f32_16x16x32_bf16 a[124:127], a[32:35], a[172:175], a[124:127]
  v_mfma_f32_16x16x32_bf16 a[128:131], a[36:39], a[160:163], a[128:131]
  buffer_load_dwordx4 a[160:163], v2, s[40:43], s64 offen offset:1024 sc1
  v_mfma_f32_16x16x32_bf16 a[132:135], a[36:39], a[164:167], a[132:135]
  buffer_load_dwordx4 a[164:167], v2, s[40:43], s65 offen offset:1024 sc1
  v_mfma_f32_16x16x32_bf16 a[136:139], a[36:39], a[168:171], a[136:139]
  buffer_load_dwordx4 a[168:171], v2, s[40:43], s66 offen offset:1024 sc1
  v_mfma_f32_16x16x32_bf16 a[140:143], a[36:39], a[172:175], a[140:143]
  buffer_load_dwordx4 a[172:175], v2, s[40:43], s67 offen offset:1024 sc1
  s_waitcnt vmcnt(18)
  v_mfma_f32_16x16x32_bf16 a[64:67], a[40:43], a[176:179], a[64:67]
  v_mfma_f32_16x16x32_bf16 a[68:71], a[40:43], a[180:183], a[68:71]
  v_mfma_f32_16x16x32_bf16 a[72:75], a[40:43], a[184:187], a[72:75]
  v_mfma_f32_16x16x32_bf16 a[76:79], a[40:43], a[188:191], a[76:79]
  buffer_load_dwordx4 a[24:27], v2, s[40:43], s13 offen offset:2048 sc1
  v_mfma_f32_16x16x32_bf16 a[80:83], a[44:47], a[176:179], a[80:83]
  v_mfma_f32_16x16x32_bf16 a[84:87], a[44:47], a[180:183], a[84:87]
  v_mfma_f32_16x16x32_bf16 a[88:91], a[44:47], a[184:187], a[88:91]
  v_mfma_f32_16x16x32_bf16 a[92:95], a[44:47], a[188:191], a[92:95]
  buffer_load_dwordx4 a[28:31], v2, s[40:43], s13 offen offset:3072 sc1
  v_mfma_f32_16x16x32_bf16 a[96:99], a[48:51], a[176:179], a[96:99]
  s_add_u32 s13, s13, 4096
  v_mfma_f32_16x16x32_bf16 a[100:103], a[48:51], a[180:183], a[100:103]
  v_mfma_f32_16x16x32_bf16 a[104:107], a[48:51], a[184:187], a[104:107]
  v_mfma_f32_16x16x32_bf16 a[108:111], a[48:51], a[188:191], a[108:111]
  buffer_load_dwordx4 a[32:35], v2, s[40:43], s13 offen offset:0 sc1
  v_mfma_f32_16x16x32_bf16 a[112:115], a[52:55], a[176:179], a[112:115]
  v_mfma_f32_16x16x32_bf16 a[116:119], a[52:55], a[180:183], a[116:119]
  v_mfma_f32_16x16x32_bf16 a[120:123], a[52:55], a[184:187], a[120:123]
  v_mfma_f32_16x16x32_bf16 a[124:127], a[52:55], a[188:191], a[124:127]
  v_mfma_f32_16x16x32_bf16 a[128:131], a[56:59], a[176:179], a[128:131]
  buffer_load_dwordx4 a[176:179], v2, s[40:43], s64 offen offset:2048 sc1
  v_mfma_f32_16x16x32_bf16 a[132:135], a[56:59], a[180:183], a[132:135]
  buffer_load_dwordx4 a[180:183], v2, s[40:43], s65 offen offset:2048 sc1
  v_mfma_f32_16x16x32_bf16 a[136:139], a[56:59], a[184:187], a[136:139]
  buffer_load_dwordx4 a[184:187], v2, s[40:43], s66 offen offset:2048 sc1
  v_mfma_f32_16x16x32_bf16 a[140:143], a[56:59], a[188:191], a[140:143]
  buffer_load_dwordx4 a[188:191], v2, s[40:43], s67 offen offset:2048 sc1
  s_waitcnt vmcnt(21)
  v_mfma_f32_16x16x32_bf16 a[64:67], a[60:63], v[216:219], a[64:67]
  v_mfma_f32_16x16x32_bf16 a[68:71], a[60:63], v[220:223], a[68:71]
  v_mfma_f32_16x16x32_bf16 a[72:75], a[60:63], v[224:227], a[72:75]
  v_mfma_f32_16x16x32_bf16 a[76:79], a[60:63], v[228:231], a[76:79]
  buffer_load_dwordx4 a[36:39], v2, s[40:43], s13 offen offset:1024 sc1
  v_mfma_f32_16x16x32_bf16 a[80:83], a[192:195], v[216:219], a[80:83]
  v_mfma_f32_16x16x32_bf16 a[84:87], a[192:195], v[220:223], a[84:87]
  v_mfma_f32_16x16x32_bf16 a[88:91], a[192:195], v[224:227], a[88:91]
  v_mfma_f32_16x16x32_bf16 a[92:95], a[192:195], v[228:231], a[92:95]
  buffer_load_dwordx4 a[40:43], v2, s[40:43], s13 offen offset:2048 sc1
  v_mfma_f32_16x16x32_bf16 a[96:99], a[196:199], v[216:219], a[96:99]
  v_mfma_f32_16x16x32_bf16 a[100:103], a[196:199], v[220:223], a[100:103]
  v_mfma_f32_16x16x32_bf16 a[104:107], a[196:199], v[224:227], a[104:107]
  v_mfma_f32_16x16x32_bf16 a[108:111], a[196:199], v[228:231], a[108:111]
  buffer_load_dwordx4 a[44:47], v2, s[40:43], s13 offen offset:3072 sc1
  v_mfma_f32_16x16x32_bf16 a[112:115], a[200:203], v[216:219], a[112:115]
  s_add_u32 s13, s13, 4096
  v_mfma_f32_16x16x32_bf16 a[116:119], a[200:203], v[220:223], a[116:119]
  v_mfma_f32_16x16x32_bf16 a[120:123], a[200:203], v[224:227], a[120:123]
  v_mfma_f32_16x16x32_bf16 a[124:127], a[200:203], v[228:231], a[124:127]
  v_mfma_f32_16x16x32_bf16 a[128:131], a[204:207], v[216:219], a[128:131]
  buffer_load_dwordx4 v[216:219], v2, s[40:43], s64 offen offset:3072 sc1
  v_mfma_f32_16x16x32_bf16 a[132:135], a[204:207], v[220:223], a[132:135]
  buffer_load_dwordx4 v[220:223], v2, s[40:43], s65 offen offset:3072 sc1
  v_mfma_f32_16x16x32_bf16 a[136:139], a[204:207], v[224:227], a[136:139]
  buffer_load_dwordx4 v[224:227], v2, s[40:43], s66 offen offset:3072 sc1
  v_mfma_f32_16x16x32_bf16 a[140:143], a[204:207], v[228:231], a[140:143]
  buffer_load_dwordx4 v[228:231], v2, s[40:43], s67 offen offset:3072 sc1
  s_waitcnt vmcnt(21)
  v_mfma_f32_16x16x32_bf16 a[64:67], a[208:211], a[144:147], a[64:67]
  s_add_u32 s64, s64, 4096
  v_mfma_f32_16x16x32_bf16 a[68:71], a[208:211], a[148:151], a[68:71]
  s_add_u32 s65, s65, 4096
  v_mfma_f32_16x16x32_bf16 a[72:75], a[208:211], a[152:155], a[72:75]
  s_add_u32 s66, s66, 4096
  v_mfma_f32_16x16x32_bf16 a[76:79], a[208:211], a[156:159], a[76:79]
  buffer_load_dwordx4 a[48:51], v2, s[40:43], s13 offen offset:0 sc1
  v_mfma_f32_16x16x32_bf16 a[80:83], a[212:215], a[144:147], a[80:83]
  v_mfma_f32_16x16x32_bf16 a[84:87], a[212:215], a[148:151], a[84:87]
  v_mfma_f32_16x16x32_bf16 a[88:91], a[212:215], a[152:155], a[88:91]
  s_add_u32 s67, s67, 4096
  v_mfma_f32_16x16x32_bf16 a[92:95], a[212:215], a[156:159], a[92:95]
  buffer_load_dwordx4 a[52:55], v2, s[40:43], s13 offen offset:1024 sc1
  v_mfma_f32_16x16x32_bf16 a[96:99], a[216:219], a[144:147], a[96:99]
  v_mfma_f32_16x16x32_bf16 a[100:103], a[216:219], a[148:151], a[100:103]
  v_mfma_f32_16x16x32_bf16 a[104:107], a[216:219], a[152:155], a[104:107]
  v_mfma_f32_16x16x32_bf16 a[108:111], a[216:219], a[156:159], a[108:111]
  buffer_load_dwordx4 a[56:59], v2, s[40:43], s13 offen offset:2048 sc1
  v_mfma_f32_16x16x32_bf16 a[112:115], a[220:223], a[144:147], a[112:115]
  v_mfma_f32_16x16x32_bf16 a[116:119], a[220:223], a[148:151], a[116:119]
  v_mfma_f32_16x16x32_bf16 a[120:123], a[220:223], a[152:155], a[120:123]
  v_mfma_f32_16x16x32_bf16 a[124:127], a[220:223], a[156:159], a[124:127]
  v_mfma_f32_16x16x32_bf16 a[128:131], a[224:227], a[144:147], a[128:131]
  buffer_load_dwordx4 a[144:147], v2, s[40:43], s64 offen offset:0 sc1
  v_mfma_f32_16x16x32_bf16 a[132:135], a[224:227], a[148:151], a[132:135]
  buffer_load_dwordx4 a[148:151], v2, s[40:43], s65 offen offset:0 sc1
  v_mfma_f32_16x16x32_bf16 a[136:139], a[224:227], a[152:155], a[136:139]
  buffer_load_dwordx4 a[152:155], v2, s[40:43], s66 offen offset:0 sc1
  v_mfma_f32_16x16x32_bf16 a[140:143], a[224:227], a[156:159], a[140:143]
  buffer_load_dwordx4 a[156:159], v2, s[40:43], s67 offen offset:0 sc1
  s_waitcnt vmcnt(21)
  v_mfma_f32_16x16x32_bf16 a[64:67], a[228:231], a[160:163], a[64:67]
  v_mfma_f32_16x16x32_bf16 a[68:71], a[228:231], a[164:167], a[68:71]
  v_mfma_f32_16x16x32_bf16 a[72:75], a[228:231], a[168:171], a[72:75]
  v_mfma_f32_16x16x32_bf16 a[76:79], a[228:231], a[172:175], a[76:79]
  buffer_load_dwordx4 a[60:63], v2, s[40:43], s13 offen offset:3072 sc1
  v_mfma_f32_16x16x32_bf16 a[80:83], a[232:235], a[160:163], a[80:83]
  s_add_u32 s13, s13, 4096
  v_mfma_f32_16x16x32_bf16 a[84:87], a[232:235], a[164:167], a[84:87]
  v_mfma_f32_16x16x32_bf16 a[88:91], a[232:235], a[168:171], a[88:91]
  v_mfma_f32_16x16x32_bf16 a[92:95], a[232:235], a[172:175], a[92:95]
  buffer_load_dwordx4 a[192:195], v2, s[40:43], s13 offen offset:0 sc1
  v_mfma_f32_16x16x32_bf16 a[96:99], a[236:239], a[160:163], a[96:99]
  v_mfma_f32_16x16x32_bf16 a[100:103], a[236:239], a[164:167], a[100:103]
  v_mfma_f32_16x16x32_bf16 a[104:107], a[236:239], a[168:171], a[104:107]
  v_mfma_f32_16x16x32_bf16 a[108:111], a[236:239], a[172:175], a[108:111]
  buffer_load_dwordx4 a[196:199], v2, s[40:43], s13 offen offset:1024 sc1
  v_mfma_f32_16x16x32_bf16 a[112:115], a[240:243], a[160:163], a[112:115]
  v_mfma_f32_16x16x32_bf16 a[116:119], a[240:243], a[164:167], a[116:119]
  v_mfma_f32_16x16x32_bf16 a[120:123], a[240:243], a[168:171], a[120:123]
  v_mfma_f32_16x16x32_bf16 a[124:127], a[240:243], a[172:175], a[124:127]
  v_mfma_f32_16x16x32_bf16 a[128:131], a[244:247], a[160:163], a[128:131]
  buffer_load_dwordx4 a[160:163], v2, s[40:43], s64 offen offset:1024 sc1
  v_mfma_f32_16x16x32_bf16 a[132:135], a[244:247], a[164:167], a[132:135]
  buffer_load_dwordx4 a[164:167], v2, s[40:43], s65 offen offset:1024 sc1
  v_mfma_f32_16x16x32_bf16 a[136:139], a[244:247], a[168:171], a[136:139]
  buffer_load_dwordx4 a[168:171], v2, s[40:43], s66 offen offset:1024 sc1
  v_mfma_f32_16x16x32_bf16 a[140:143], a[244:247], a[172:175], a[140:143]
  buffer_load_dwordx4 a[172:175], v2, s[40:43], s67 offen offset:1024 sc1
  s_waitcnt vmcnt(21)
  v_mfma_f32_16x16x32_bf16 a[64:67], a[248:251], a[176:179], a[64:67]
  v_mfma_f32_16x16x32_bf16 a[68:71], a[248:251], a[180:183], a[68:71]
  v_mfma_f32_16x16x32_bf16 a[72:75], a[248:251], a[184:187], a[72:75]
  v_mfma_f32_16x16x32_bf16 a[76:79], a[248:251], a[188:191], a[76:79]
  buffer_load_dwordx4 a[200:203], v2, s[40:43], s13 offen offset:2048 sc1
  v_mfma_f32_16x16x32_bf16 a[80:83], a[252:255], a[176:179], a[80:83]
  v_mfma_f32_16x16x32_bf16 a[84:87], a[252:255], a[180:183], a[84:87]
  v_mfma_f32_16x16x32_bf16 a[88:91], a[252:255], a[184:187], a[88:91]
  v_mfma_f32_16x16x32_bf16 a[92:95], a[252:255], a[188:191], a[92:95]
  buffer_load_dwordx4 a[204:207], v2, s[40:43], s13 offen offset:3072 sc1
  v_mfma_f32_16x16x32_bf16 a[96:99], v[32:35], a[176:179], a[96:99]
  s_add_u32 s13, s13, 4096
  v_mfma_f32_16x16x32_bf16 a[100:103], v[32:35], a[180:183], a[100:103]
  v_mfma_f32_16x16x32_bf16 a[104:107], v[32:35], a[184:187], a[104:107]
  v_mfma_f32_16x16x32_bf16 a[108:111], v[32:35], a[188:191], a[108:111]
  buffer_load_dwordx4 a[208:211], v2, s[40:43], s13 offen offset:0 sc1
  v_mfma_f32_16x16x32_bf16 a[112:115], v[36:39], a[176:179], a[112:115]
  v_mfma_f32_16x16x32_bf16 a[116:119], v[36:39], a[180:183], a[116:119]
  v_mfma_f32_16x16x32_bf16 a[120:123], v[36:39], a[184:187], a[120:123]
  v_mfma_f32_16x16x32_bf16 a[124:127], v[36:39], a[188:191], a[124:127]
  v_mfma_f32_16x16x32_bf16 a[128:131], v[40:43], a[176:179], a[128:131]
  buffer_load_dwordx4 a[176:179], v2, s[40:43], s64 offen offset:2048 sc1
  v_mfma_f32_16x16x32_bf16 a[132:135], v[40:43], a[180:183], a[132:135]
  buffer_load_dwordx4 a[180:183], v2, s[40:43], s65 offen offset:2048 sc1
  v_mfma_f32_16x16x32_bf16 a[136:139], v[40:43], a[184:187], a[136:139]
  buffer_load_dwordx4 a[184:187], v2, s[40:43], s66 offen offset:2048 sc1
  v_mfma_f32_16x16x32_bf16 a[140:143], v[40:43], a[188:191], a[140:143]
  buffer_load_dwordx4 a[188:191], v2, s[40:43], s67 offen offset:2048 sc1
  s_waitcnt vmcnt(21)
  v_mfma_f32_16x16x32_bf16 a[64:67], v[44:47], v[216:219], a[64:67]
  v_mfma_f32_16x16x32_bf16 a[68:71], v[44:47], v[220:223], a[68:71]
  v_mfma_f32_16x16x32_bf16 a[72:75], v[44:47], v[224:227], a[72:75]
  v_mfma_f32_16x16x32_bf16 a[76:79], v[44:47], v[228:231], a[76:79]
  buffer_load_dwordx4 a[212:215], v2, s[40:43], s13 offen offset:1024 sc1
  v_mfma_f32_16x16x32_bf16 a[80:83], v[48:51], v[216:219], a[80:83]
  v_mfma_f32_16x16x32_bf16 a[84:87], v[48:51], v[220:223], a[84:87]
  v_mfma_f32_16x16x32_bf16 a[88:91], v[48:51], v[224:227], a[88:91]
  v_mfma_f32_16x16x32_bf16 a[92:95], v[48:51], v[228:231], a[92:95]
  buffer_load_dwordx4 a[216:219], v2, s[40:43], s13 offen offset:2048 sc1
  v_mfma_f32_16x16x32_bf16 a[96:99], v[52:55], v[216:219], a[96:99]
  v_mfma_f32_16x16x32_bf16 a[100:103], v[52:55], v[220:223], a[100:103]
  v_mfma_f32_16x16x32_bf16 a[104:107], v[52:55], v[224:227], a[104:107]
  v_mfma_f32_16x16x32_bf16 a[108:111], v[52:55], v[228:231], a[108:111]
  buffer_load_dwordx4 a[220:223], v2, s[40:43], s13 offen offset:3072 sc1
  v_mfma_f32_16x16x32_bf16 a[112:115], v[56:59], v[216:219], a[112:115]
  s_add_u32 s13, s13, 4096
  v_mfma_f32_16x16x32_bf16 a[116:119], v[56:59], v[220:223], a[116:119]
  v_mfma_f32_16x16x32_bf16 a[120:123], v[56:59], v[224:227], a[120:123]
  v_mfma_f32_16x16x32_bf16 a[124:127], v[56:59], v[228:231], a[124:127]
  v_mfma_f32_16x16x32_bf16 a[128:131], v[60:63], v[216:219], a[128:131]
  buffer_load_dwordx4 v[216:219], v2, s[40:43], s64 offen offset:3072 sc1
  v_mfma_f32_16x16x32_bf16 a[132:135], v[60:63], v[220:223], a[132:135]
  buffer_load_dwordx4 v[220:223], v2, s[40:43], s65 offen offset:3072 sc1
  v_mfma_f32_16x16x32_bf16 a[136:139], v[60:63], v[224:227], a[136:139]
  buffer_load_dwordx4 v[224:227], v2, s[40:43], s66 offen offset:3072 sc1
  v_mfma_f32_16x16x32_bf16 a[140:143], v[60:63], v[228:231], a[140:143]
  buffer_load_dwordx4 v[228:231], v2, s[40:43], s67 offen offset:3072 sc1
  s_waitcnt vmcnt(21)
  v_mfma_f32_16x16x32_bf16 a[64:67], v[96:99], a[144:147], a[64:67]
  s_add_u32 s64, s64, 4096
  v_mfma_f32_16x16x32_bf16 a[68:71], v[96:99], a[148:151], a[68:71]
  s_add_u32 s65, s65, 4096
  v_mfma_f32_16x16x32_bf16 a[72:75], v[96:99], a[152:155], a[72:75]
  s_add_u32 s66, s66, 4096
  v_mfma_f32_16x16x32_bf16 a[76:79], v[96:99], a[156:159], a[76:79]
  buffer_load_dwordx4 a[224:227], v2, s[40:43], s13 offen offset:0 sc1
  v_mfma_f32_16x16x32_bf16 a[80:83], v[100:103], a[144:147], a[80:83]
  v_mfma_f32_16x16x32_bf16 a[84:87], v[100:103], a[148:151], a[84:87]
  v_mfma_f32_16x16x32_bf16 a[88:91], v[100:103], a[152:155], a[88:91]
  s_add_u32 s67, s67, 4096
  v_mfma_f32_16x16x32_bf16 a[92:95], v[100:103], a[156:159], a[92:95]
  buffer_load_dwordx4 a[228:231], v2, s[40:43], s13 offen offset:1024 sc1
  v_mfma_f32_16x16x32_bf16 a[96:99], v[104:107], a[144:147], a[96:99]
  v_mfma_f32_16x16x32_bf16 a[100:103], v[104:107], a[148:151], a[100:103]
  v_mfma_f32_16x16x32_bf16 a[104:107], v[104:107], a[152:155], a[104:107]
  v_mfma_f32_16x16x32_bf16 a[108:111], v[104:107], a[156:159], a[108:111]
  buffer_load_dwordx4 a[232:235], v2, s[40:43], s13 offen offset:2048 sc1
  v_mfma_f32_16x16x32_bf16 a[112:115], v[108:111], a[144:147], a[112:115]
  v_mfma_f32_16x16x32_bf16 a[116:119], v[108:111], a[148:151], a[116:119]
  v_mfma_f32_16x16x32_bf16 a[120:123], v[108:111], a[152:155], a[120:123]
  v_mfma_f32_16x16x32_bf16 a[124:127], v[108:111], a[156:159], a[124:127]
  v_mfma_f32_16x16x32_bf16 a[128:131], v[112:115], a[144:147], a[128:131]
  buffer_load_dwordx4 a[144:147], v2, s[40:43], s64 offen offset:0 sc1
  v_mfma_f32_16x16x32_bf16 a[132:135], v[112:115], a[148:151], a[132:135]
  buffer_load_dwordx4 a[148:151], v2, s[40:43], s65 offen offset:0 sc1
  v_mfma_f32_16x16x32_bf16 a[136:139], v[112:115], a[152:155], a[136:139]
  buffer_load_dwordx4 a[152:155], v2, s[40:43], s66 offen offset:0 sc1
  v_mfma_f32_16x16x32_bf16 a[140:143], v[112:115], a[156:159], a[140:143]
  buffer_load_dwordx4 a[156:159], v2, s[40:43], s67 offen offset:0 sc1
  s_waitcnt vmcnt(21)
  v_mfma_f32_16x16x32_bf16 a[64:67], v[116:119], a[160:163], a[64:67]
  v_mfma_f32_16x16x32_bf16 a[68:71], v[116:119], a[164:167], a[68:71]
  v_mfma_f32_16x16x32_bf16 a[72:75], v[116:119], a[168:171], a[72:75]
  v_mfma_f32_16x16x32_bf16 a[76:79], v[116:119], a[172:175], a[76:79]
  buffer_load_dwordx4 a[236:239], v2, s[40:43], s13 offen offset:3072 sc1
  v_mfma_f32_16x16x32_bf16 a[80:83], v[120:123], a[160:163], a[80:83]
  s_add_u32 s13, s13, 4096
  v_mfma_f32_16x16x32_bf16 a[84:87], v[120:123], a[164:167], a[84:87]
  v_mfma_f32_16x16x32_bf16 a[88:91], v[120:123], a[168:171], a[88:91]
  v_mfma_f32_16x16x32_bf16 a[92:95], v[120:123], a[172:175], a[92:95]
  buffer_load_dwordx4 a[240:243], v2, s[40:43], s13 offen offset:0 sc1
  v_mfma_f32_16x16x32_bf16 a[96:99], v[124:127], a[160:163], a[96:99]
  v_mfma_f32_16x16x32_bf16 a[100:103], v[124:127], a[164:167], a[100:103]
  v_mfma_f32_16x16x32_bf16 a[104:107], v[124:127], a[168:171], a[104:107]
  v_mfma_f32_16x16x32_bf16 a[108:111], v[124:127], a[172:175], a[108:111]
  buffer_load_dwordx4 a[244:247], v2, s[40:43], s13 offen offset:1024 sc1
  v_mfma_f32_16x16x32_bf16 a[112:115], v[160:163], a[160:163], a[112:115]
  v_mfma_f32_16x16x32_bf16 a[116:119], v[160:163], a[164:167], a[116:119]
  v_mfma_f32_16x16x32_bf16 a[120:123], v[160:163], a[168:171], a[120:123]
  v_mfma_f32_16x16x32_bf16 a[124:127], v[160:163], a[172:175], a[124:127]
  v_mfma_f32_16x16x32_bf16 a[128:131], v[164:167], a[160:163], a[128:131]
  buffer_load_dwordx4 a[160:163], v2, s[40:43], s64 offen offset:1024 sc1
  v_mfma_f32_16x16x32_bf16 a[132:135], v[164:167], a[164:167], a[132:135]
  buffer_load_dwordx4 a[164:167], v2, s[40:43], s65 offen offset:1024 sc1
  v_mfma_f32_16x16x32_bf16 a[136:139], v[164:167], a[168:171], a[136:139]
  buffer_load_dwordx4 a[168:171], v2, s[40:43], s66 offen offset:1024 sc1
  v_mfma_f32_16x16x32_bf16 a[140:143], v[164:167], a[172:175], a[140:143]
  buffer_load_dwordx4 a[172:175], v2, s[40:43], s67 offen offset:1024 sc1
  s_waitcnt vmcnt(21)
  v_mfma_f32_16x16x32_bf16 a[64:67], v[168:171], a[176:179], a[64:67]
  v_mfma_f32_16x16x32_bf16 a[68:71], v[168:171], a[180:183], a[68:71]
  v_mfma_f32_16x16x32_bf16 a[72:75], v[168:171], a[184:187], a[72:75]
  v_mfma_f32_16x16x32_bf16 a[76:79], v[168:171], a[188:191], a[76:79]
  buffer_load_dwordx4 a[248:251], v2, s[40:43], s13 offen offset:2048 sc1
  v_mfma_f32_16x16x32_bf16 a[80:83], v[172:175], a[176:179], a[80:83]
  v_mfma_f32_16x16x32_bf16 a[84:87], v[172:175], a[180:183], a[84:87]
  v_mfma_f32_16x16x32_bf16 a[88:91], v[172:175], a[184:187], a[88:91]
  v_mfma_f32_16x16x32_bf16 a[92:95], v[172:175], a[188:191], a[92:95]
  buffer_load_dwordx4 a[252:255], v2, s[40:43], s13 offen offset:3072 sc1
  v_mfma_f32_16x16x32_bf16 a[96:99], v[192:195], a[176:179], a[96:99]
  s_add_u32 s13, s13, 4096
  v_mfma_f32_16x16x32_bf16 a[100:103], v[192:195], a[180:183], a[100:103]
  v_mfma_f32_16x16x32_bf16 a[104:107], v[192:195], a[184:187], a[104:107]
  v_mfma_f32_16x16x32_bf16 a[108:111], v[192:195], a[188:191], a[108:111]
  buffer_load_dwordx4 v[32:35], v2, s[40:43], s13 offen offset:0 sc1
  v_mfma_f32_16x16x32_bf16 a[112:115], v[196:199], a[176:179], a[112:115]
  v_mfma_f32_16x16x32_bf16 a[116:119], v[196:199], a[180:183], a[116:119]
  v_mfma_f32_16x16x32_bf16 a[120:123], v[196:199], a[184:187], a[120:123]
  v_mfma_f32_16x16x32_bf16 a[124:127], v[196:199], a[188:191], a[124:127]
  v_mfma_f32_16x16x32_bf16 a[128:131], v[208:211], a[176:179], a[128:131]
  buffer_load_dwordx4 a[176:179], v2, s[40:43], s64 offen offset:2048 sc1
  v_mfma_f32_16x16x32_bf16 a[132:135], v[208:211], a[180:183], a[132:135]
  buffer_load_dwordx4 a[180:183], v2, s[40:43], s65 offen offset:2048 sc1
  v_mfma_f32_16x16x32_bf16 a[136:139], v[208:211], a[184:187], a[136:139]
  buffer_load_dwordx4 a[184:187], v2, s[40:43], s66 offen offset:2048 sc1
  v_mfma_f32_16x16x32_bf16 a[140:143], v[208:211], a[188:191], a[140:143]
  buffer_load_dwordx4 a[188:191], v2, s[40:43], s67 offen offset:2048 sc1
  s_waitcnt vmcnt(21)
  v_mfma_f32_16x16x32_bf16 a[64:67], v[212:215], v[216:219], a[64:67]
  v_mfma_f32_16x16x32_bf16 a[68:71], v[212:215], v[220:223], a[68:71]
  v_mfma_f32_16x16x32_bf16 a[72:75], v[212:215], v[224:227], a[72:75]
  v_mfma_f32_16x16x32_bf16 a[76:79], v[212:215], v[228:231], a[76:79]
  buffer_load_dwordx4 v[36:39], v2, s[40:43], s13 offen offset:1024 sc1
  v_mfma_f32_16x16x32_bf16 a[80:83], v[232:235], v[216:219], a[80:83]
  v_mfma_f32_16x16x32_bf16 a[84:87], v[232:235], v[220:223], a[84:87]
  v_mfma_f32_16x16x32_bf16 a[88:91], v[232:235], v[224:227], a[88:91]
  v_mfma_f32_16x16x32_bf16 a[92:95], v[232:235], v[228:231], a[92:95]
  buffer_load_dwordx4 v[40:43], v2, s[40:43], s13 offen offset:2048 sc1
  v_mfma_f32_16x16x32_bf16 a[96:99], v[236:239], v[216:219], a[96:99]
  v_mfma_f32_16x16x32_bf16 a[100:103], v[236:239], v[220:223], a[100:103]
  v_mfma_f32_16x16x32_bf16 a[104:107], v[236:239], v[224:227], a[104:107]
  v_mfma_f32_16x16x32_bf16 a[108:111], v[236:239], v[228:231], a[108:111]
  buffer_load_dwordx4 v[44:47], v2, s[40:43], s13 offen offset:3072 sc1
  v_mfma_f32_16x16x32_bf16 a[112:115], v[240:243], v[216:219], a[112:115]
  s_add_u32 s13, s13, 4096
  v_mfma_f32_16x16x32_bf16 a[116:119], v[240:243], v[220:223], a[116:119]
  v_mfma_f32_16x16x32_bf16 a[120:123], v[240:243], v[224:227], a[120:123]
  v_mfma_f32_16x16x32_bf16 a[124:127], v[240:243], v[228:231], a[124:127]
  v_mfma_f32_16x16x32_bf16 a[128:131], v[244:247], v[216:219], a[128:131]
  buffer_load_dwordx4 v[216:219], v2, s[40:43], s64 offen offset:3072 sc1
  v_mfma_f32_16x16x32_bf16 a[132:135], v[244:247], v[220:223], a[132:135]
  buffer_load_dwordx4 v[220:223], v2, s[40:43], s65 offen offset:3072 sc1
  v_mfma_f32_16x16x32_bf16 a[136:139], v[244:247], v[224:227], a[136:139]
  buffer_load_dwordx4 v[224:227], v2, s[40:43], s66 offen offset:3072 sc1
  v_mfma_f32_16x16x32_bf16 a[140:143], v[244:247], v[228:231], a[140:143]
  buffer_load_dwordx4 v[228:231], v2, s[40:43], s67 offen offset:3072 sc1
  s_waitcnt vmcnt(21)
  v_mfma_f32_16x16x32_bf16 a[64:67], v[64:67], a[144:147], a[64:67]
  s_add_u32 s64, s64, 4096
  v_mfma_f32_16x16x32_bf16 a[68:71], v[64:67], a[148:151], a[68:71]
  s_add_u32 s65, s65, 4096
  v_mfma_f32_16x16x32_bf16 a[72:75], v[64:67], a[152:155], a[72:75]
  s_add_u32 s66, s66, 4096
  v_mfma_f32_16x16x32_bf16 a[76:79], v[64:67], a[156:159], a[76:79]
  buffer_load_dwordx4 v[48:51], v2, s[40:43], s13 offen offset:0 sc1
  v_mfma_f32_16x16x32_bf16 a[80:83], v[68:71], a[144:147], a[80:83]
  v_mfma_f32_16x16x32_bf16 a[84:87], v[68:71], a[148:151], a[84:87]
  v_mfma_f32_16x16x32_bf16 a[88:91], v[68:71], a[152:155], a[88:91]
  s_add_u32 s67, s67, 4096
  v_mfma_f32_16x16x32_bf16 a[92:95], v[68:71], a[156:159], a[92:95]
  buffer_load_dwordx4 v[52:55], v2, s[40:43], s13 offen offset:1024 sc1
  v_mfma_f32_16x16x32_bf16 a[96:99], v[72:75], a[144:147], a[96:99]
  v_mfma_f32_16x16x32_bf16 a[100:103], v[72:75], a[148:151], a[100:103]
  v_mfma_f32_16x16x32_bf16 a[104:107], v[72:75], a[152:155], a[104:107]
  v_mfma_f32_16x16x32_bf16 a[108:111], v[72:75], a[156:159], a[108:111]
  buffer_load_dwordx4 v[56:59], v2, s[40:43], s13 offen offset:2048 sc1
  v_mfma_f32_16x16x32_bf16 a[112:115], v[76:79], a[144:147], a[112:115]
  v_mfma_f32_16x16x32_bf16 a[116:119], v[76:79], a[148:151], a[116:119]
  v_mfma_f32_16x16x32_bf16 a[120:123], v[76:79], a[152:155], a[120:123]
  v_mfma_f32_16x16x32_bf16 a[124:127], v[76:79], a[156:159], a[124:127]
  v_mfma_f32_16x16x32_bf16 a[128:131], v[80:83], a[144:147], a[128:131]
  buffer_load_dwordx4 a[144:147], v2, s[40:43], s64 offen offset:0 sc1
  v_mfma_f32_16x16x32_bf16 a[132:135], v[80:83], a[148:151], a[132:135]
  buffer_load_dwordx4 a[148:151], v2, s[40:43], s65 offen offset:0 sc1
  v_mfma_f32_16x16x32_bf16 a[136:139], v[80:83], a[152:155], a[136:139]
  buffer_load_dwordx4 a[152:155], v2, s[40:43], s66 offen offset:0 sc1
  v_mfma_f32_16x16x32_bf16 a[140:143], v[80:83], a[156:159], a[140:143]
  buffer_load_dwordx4 a[156:159], v2, s[40:43], s67 offen offset:0 sc1
  s_waitcnt vmcnt(21)
  v_mfma_f32_16x16x32_bf16 a[64:67], v[84:87], a[160:163], a[64:67]
  v_mfma_f32_16x16x32_bf16 a[68:71], v[84:87], a[164:167], a[68:71]
  v_mfma_f32_16x16x32_bf16 a[72:75], v[84:87], a[168:171], a[72:75]
  v_mfma_f32_16x16x32_bf16 a[76:79], v[84:87], a[172:175], a[76:79]
  buffer_load_dwordx4 v[60:63], v2, s[40:43], s13 offen offset:3072 sc1
  v_mfma_f32_16x16x32_bf16 a[80:83], v[88:91], a[160:163], a[80:83]
  s_add_u32 s13, s13, 4096
  v_mfma_f32_16x16x32_bf16 a[84:87], v[88:91], a[164:167], a[84:87]
  v_mfma_f32_16x16x32_bf16 a[88:91], v[88:91], a[168:171], a[88:91]
  v_mfma_f32_16x16x32_bf16 a[92:95], v[88:91], a[172:175], a[92:95]
  buffer_load_dwordx4 v[96:99], v2, s[40:43], s13 offen offset:0 sc1
  v_mfma_f32_16x16x32_bf16 a[96:99], v[92:95], a[160:163], a[96:99]
  v_mfma_f32_16x16x32_bf16 a[100:103], v[92:95], a[164:167], a[100:103]
  v_mfma_f32_16x16x32_bf16 a[104:107], v[92:95], a[168:171], a[104:107]
  v_mfma_f32_16x16x32_bf16 a[108:111], v[92:95], a[172:175], a[108:111]
  buffer_load_dwordx4 v[100:103], v2, s[40:43], s13 offen offset:1024 sc1
  v_mfma_f32_16x16x32_bf16 a[112:115], v[128:131], a[160:163], a[112:115]
  v_mfma_f32_16x16x32_bf16 a[116:119], v[128:131], a[164:167], a[116:119]
  v_mfma_f32_16x16x32_bf16 a[120:123], v[128:131], a[168:171], a[120:123]
  v_mfma_f32_16x16x32_bf16 a[124:127], v[128:131], a[172:175], a[124:127]
  v_mfma_f32_16x16x32_bf16 a[128:131], v[132:135], a[160:163], a[128:131]
  buffer_load_dwordx4 a[160:163], v2, s[40:43], s64 offen offset:1024 sc1
  v_mfma_f32_16x16x32_bf16 a[132:135], v[132:135], a[164:167], a[132:135]
  buffer_load_dwordx4 a[164:167], v2, s[40:43], s65 offen offset:1024 sc1
  v_mfma_f32_16x16x32_bf16 a[136:139], v[132:135], a[168:171], a[136:139]
  buffer_load_dwordx4 a[168:171], v2, s[40:43], s66 offen offset:1024 sc1
  v_mfma_f32_16x16x32_bf16 a[140:143], v[132:135], a[172:175], a[140:143]
  buffer_load_dwordx4 a[172:175], v2, s[40:43], s67 offen offset:1024 sc1
  s_waitcnt vmcnt(21)
  v_mfma_f32_16x16x32_bf16 a[64:67], v[136:139], a[176:179], a[64:67]
  v_mfma_f32_16x16x32_bf16 a[68:71], v[136:139], a[180:183], a[68:71]
  v_mfma_f32_16x16x32_bf16 a[72:75], v[136:139], a[184:187], a[72:75]
  v_mfma_f32_16x16x32_bf16 a[76:79], v[136:139], a[188:191], a[76:79]
  buffer_load_dwordx4 v[104:107], v2, s[40:43], s13 offen offset:2048 sc1
  v_mfma_f32_16x16x32_bf16 a[80:83], v[140:143], a[176:179], a[80:83]
  v_mfma_f32_16x16x32_bf16 a[84:87], v[140:143], a[180:183], a[84:87]
  v_mfma_f32_16x16x32_bf16 a[88:91], v[140:143], a[184:187], a[88:91]
  v_mfma_f32_16x16x32_bf16 a[92:95], v[140:143], a[188:191], a[92:95]
  buffer_load_dwordx4 v[108:111], v2, s[40:43], s13 offen offset:3072 sc1
  v_mfma_f32_16x16x32_bf16 a[96:99], v[144:147], a[176:179], a[96:99]
  s_add_u32 s13, s13, 4096
  v_mfma_f32_16x16x32_bf16 a[100:103], v[144:147], a[180:183], a[100:103]
  v_mfma_f32_16x16x32_bf16 a[104:107], v[144:147], a[184:187], a[104:107]
  v_mfma_f32_16x16x32_bf16 a[108:111], v[144:147], a[188:191], a[108:111]
  buffer_load_dwordx4 v[112:115], v2, s[40:43], s13 offen offset:0 sc1
  v_mfma_f32_16x16x32_bf16 a[112:115], v[148:151], a[176:179], a[112:115]
  v_mfma_f32_16x16x32_bf16 a[116:119], v[148:151], a[180:183], a[116:119]
  v_mfma_f32_16x16x32_bf16 a[120:123], v[148:151], a[184:187], a[120:123]
  v_mfma_f32_16x16x32_bf16 a[124:127], v[148:151], a[188:191], a[124:127]
  v_mfma_f32_16x16x32_bf16 a[128:131], v[152:155], a[176:179], a[128:131]
  buffer_load_dwordx4 a[176:179], v2, s[40:43], s64 offen offset:2048 sc1
  v_mfma_f32_16x16x32_bf16 a[132:135], v[152:155], a[180:183], a[132:135]
  buffer_load_dwordx4 a[180:183], v2, s[40:43], s65 offen offset:2048 sc1
  v_mfma_f32_16x16x32_bf16 a[136:139], v[152:155], a[184:187], a[136:139]
  buffer_load_dwordx4 a[184:187], v2, s[40:43], s66 offen offset:2048 sc1
  v_mfma_f32_16x16x32_bf16 a[140:143], v[152:155], a[188:191], a[140:143]
  buffer_load_dwordx4 a[188:191], v2, s[40:43], s67 offen offset:2048 sc1
  s_waitcnt vmcnt(21)
  v_mfma_f32_16x16x32_bf16 a[64:67], v[156:159], v[216:219], a[64:67]
  v_mfma_f32_16x16x32_bf16 a[68:71], v[156:159], v[220:223], a[68:71]
  v_mfma_f32_16x16x32_bf16 a[72:75], v[156:159], v[224:227], a[72:75]
  v_mfma_f32_16x16x32_bf16 a[76:79], v[156:159], v[228:231], a[76:79]
  buffer_load_dwordx4 v[116:119], v2, s[40:43], s13 offen offset:1024 sc1
  v_mfma_f32_16x16x32_bf16 a[80:83], v[176:179], v[216:219], a[80:83]
  v_mfma_f32_16x16x32_bf16 a[84:87], v[176:179], v[220:223], a[84:87]
  v_mfma_f32_16x16x32_bf16 a[88:91], v[176:179], v[224:227], a[88:91]
  v_mfma_f32_16x16x32_bf16 a[92:95], v[176:179], v[228:231], a[92:95]
  buffer_load_dwordx4 v[120:123], v2, s[40:43], s13 offen offset:2048 sc1
  v_mfma_f32_16x16x32_bf16 a[96:99], v[180:183], v[216:219], a[96:99]
  v_mfma_f32_16x16x32_bf16 a[100:103], v[180:183], v[220:223], a[100:103]
  v_mfma_f32_16x16x32_bf16 a[104:107], v[180:183], v[224:227], a[104:107]
  v_mfma_f32_16x16x32_bf16 a[108:111], v[180:183], v[228:231], a[108:111]
  buffer_load_dwordx4 v[124:127], v2, s[40:43], s13 offen offset:3072 sc1
  v_mfma_f32_16x16x32_bf16 a[112:115], v[184:187], v[216:219], a[112:115]
  s_add_u32 s13, s13, 4096
  v_mfma_f32_16x16x32_bf16 a[116:119], v[184:187], v[220:223], a[116:119]
  v_mfma_f32_16x16x32_bf16 a[120:123], v[184:187], v[224:227], a[120:123]
  v_mfma_f32_16x16x32_bf16 a[124:127], v[184:187], v[228:231], a[124:127]
  v_mfma_f32_16x16x32_bf16 a[128:131], v[188:191], v[216:219], a[128:131]
  buffer_load_dwordx4 v[216:219], v2, s[40:43], s64 offen offset:3072 sc1
  v_mfma_f32_16x16x32_bf16 a[132:135], v[188:191], v[220:223], a[132:135]
  buffer_load_dwordx4 v[220:223], v2, s[40:43], s65 offen offset:3072 sc1
  v_mfma_f32_16x16x32_bf16 a[136:139], v[188:191], v[224:227], a[136:139]
  buffer_load_dwordx4 v[224:227], v2, s[40:43], s66 offen offset:3072 sc1
  v_mfma_f32_16x16x32_bf16 a[140:143], v[188:191], v[228:231], a[140:143]
  buffer_load_dwordx4 v[228:231], v2, s[40:43], s67 offen offset:3072 sc1
  s_waitcnt vmcnt(21)
  v_mfma_f32_16x16x32_bf16 a[64:67], a[0:3], a[144:147], a[64:67]
  s_add_u32 s64, s64, 4096
  v_mfma_f32_16x16x32_bf16 a[68:71], a[0:3], a[148:151], a[68:71]
  s_add_u32 s65, s65, 4096
  v_mfma_f32_16x16x32_bf16 a[72:75], a[0:3], a[152:155], a[72:75]
  s_add_u32 s66, s66, 4096
  v_mfma_f32_16x16x32_bf16 a[76:79], a[0:3], a[156:159], a[76:79]
  buffer_load_dwordx4 v[160:163], v2, s[40:43], s13 offen offset:0 sc1
  v_mfma_f32_16x16x32_bf16 a[80:83], a[4:7], a[144:147], a[80:83]
  v_mfma_f32_16x16x32_bf16 a[84:87], a[4:7], a[148:151], a[84:87]
  v_mfma_f32_16x16x32_bf16 a[88:91], a[4:7], a[152:155], a[88:91]
  s_add_u32 s67, s67, 4096
  v_mfma_f32_16x16x32_bf16 a[92:95], a[4:7], a[156:159], a[92:95]
  buffer_load_dwordx4 v[164:167], v2, s[40:43], s13 offen offset:1024 sc1
  v_mfma_f32_16x16x32_bf16 a[96:99], a[8:11], a[144:147], a[96:99]
  v_mfma_f32_16x16x32_bf16 a[100:103], a[8:11], a[148:151], a[100:103]
  v_mfma_f32_16x16x32_bf16 a[104:107], a[8:11], a[152:155], a[104:107]
  v_mfma_f32_16x16x32_bf16 a[108:111], a[8:11], a[156:159], a[108:111]
  buffer_load_dwordx4 v[168:171], v2, s[40:43], s13 offen offset:2048 sc1
  v_mfma_f32_16x16x32_bf16 a[112:115], a[12:15], a[144:147], a[112:115]
  v_mfma_f32_16x16x32_bf16 a[116:119], a[12:15], a[148:151], a[116:119]
  v_mfma_f32_16x16x32_bf16 a[120:123], a[12:15], a[152:155], a[120:123]
  v_mfma_f32_16x16x32_bf16 a[124:127], a[12:15], a[156:159], a[124:127]
  v_mfma_f32_16x16x32_bf16 a[128:131], a[16:19], a[144:147], a[128:131]
  buffer_load_dwordx4 a[144:147], v2, s[40:43], s64 offen offset:0 sc1
  v_mfma_f32_16x16x32_bf16 a[132:135], a[16:19], a[148:151], a[132:135]
  buffer_load_dwordx4 a[148:151], v2, s[40:43], s65 offen offset:0 sc1
  v_mfma_f32_16x16x32_bf16 a[136:139], a[16:19], a[152:155], a[136:139]
  buffer_load_dwordx4 a[152:155], v2, s[40:43], s66 offen offset:0 sc1
  v_mfma_f32_16x16x32_bf16 a[140:143], a[16:19], a[156:159], a[140:143]
  buffer_load_dwordx4 a[156:159], v2, s[40:43], s67 offen offset:0 sc1
  s_waitcnt vmcnt(21)
  v_mfma_f32_16x16x32_bf16 a[64:67], a[20:23], a[160:163], a[64:67]
  v_mfma_f32_16x16x32_bf16 a[68:71], a[20:23], a[164:167], a[68:71]
  v_mfma_f32_16x16x32_bf16 a[72:75], a[20:23], a[168:171], a[72:75]
  v_mfma_f32_16x16x32_bf16 a[76:79], a[20:23], a[172:175], a[76:79]
  buffer_load_dwordx4 v[172:175], v2, s[40:43], s13 offen offset:3072 sc1
  v_mfma_f32_16x16x32_bf16 a[80:83], a[24:27], a[160:163], a[80:83]
  s_add_u32 s13, s13, 4096
  v_mfma_f32_16x16x32_bf16 a[84:87], a[24:27], a[164:167], a[84:87]
  v_mfma_f32_16x16x32_bf16 a[88:91], a[24:27], a[168:171], a[88:91]
  v_mfma_f32_16x16x32_bf16 a[92:95], a[24:27], a[172:175], a[92:95]
  buffer_load_dwordx4 v[192:195], v2, s[40:43], s13 offen offset:0 sc1
  v_mfma_f32_16x16x32_bf16 a[96:99], a[28:31], a[160:163], a[96:99]
  v_mfma_f32_16x16x32_bf16 a[100:103], a[28:31], a[164:167], a[100:103]
  v_mfma_f32_16x16x32_bf16 a[104:107], a[28:31], a[168:171], a[104:107]
  v_mfma_f32_16x16x32_bf16 a[108:111], a[28:31], a[172:175], a[108:111]
  buffer_load_dwordx4 v[196:199], v2, s[40:43], s13 offen offset:1024 sc1
  v_mfma_f32_16x16x32_bf16 a[112:115], a[32:35], a[160:163], a[112:115]
  v_mfma_f32_16x16x32_bf16 a[116:119], a[32:35], a[164:167], a[116:119]
  v_mfma_f32_16x16x32_bf16 a[120:123], a[32:35], a[168:171], a[120:123]
  v_mfma_f32_16x16x32_bf16 a[124:127], a[32:35], a[172:175], a[124:127]
  v_mfma_f32_16x16x32_bf16 a[128:131], a[36:39], a[160:163], a[128:131]
  buffer_load_dwordx4 a[160:163], v2, s[40:43], s64 offen offset:1024 sc1
  v_mfma_f32_16x16x32_bf16 a[132:135], a[36:39], a[164:167], a[132:135]
  buffer_load_dwordx4 a[164:167], v2, s[40:43], s65 offen offset:1024 sc1
  v_mfma_f32_16x16x32_bf16 a[136:139], a[36:39], a[168:171], a[136:139]
  buffer_load_dwordx4 a[168:171], v2, s[40:43], s66 offen offset:1024 sc1
  v_mfma_f32_16x16x32_bf16 a[140:143], a[36:39], a[172:175], a[140:143]
  buffer_load_dwordx4 a[172:175], v2, s[40:43], s67 offen offset:1024 sc1
  s_waitcnt vmcnt(21)
  v_mfma_f32_16x16x32_bf16 a[64:67], a[40:43], a[176:179], a[64:67]
  v_mfma_f32_16x16x32_bf16 a[68:71], a[40:43], a[180:183], a[68:71]
  v_mfma_f32_16x16x32_bf16 a[72:75], a[40:43], a[184:187], a[72:75]
  v_mfma_f32_16x16x32_bf16 a[76:79], a[40:43], a[188:191], a[76:79]
  buffer_load_dwordx4 v[208:211], v2, s[40:43], s13 offen offset:2048 sc1
  v_mfma_f32_16x16x32_bf16 a[80:83], a[44:47], a[176:179], a[80:83]
  v_mfma_f32_16x16x32_bf16 a[84:87], a[44:47], a[180:183], a[84:87]
  v_mfma_f32_16x16x32_bf16 a[88:91], a[44:47], a[184:187], a[88:91]
  v_mfma_f32_16x16x32_bf16 a[92:95], a[44:47], a[188:191], a[92:95]
  buffer_load_dwordx4 v[212:215], v2, s[40:43], s13 offen offset:3072 sc1
  v_mfma_f32_16x16x32_bf16 a[96:99], a[48:51], a[176:179], a[96:99]
  s_add_u32 s13, s13, 4096
  v_mfma_f32_16x16x32_bf16 a[100:103], a[48:51], a[180:183], a[100:103]
  v_mfma_f32_16x16x32_bf16 a[104:107], a[48:51], a[184:187], a[104:107]
  v_mfma_f32_16x16x32_bf16 a[108:111], a[48:51], a[188:191], a[108:111]
  buffer_load_dwordx4 v[232:235], v2, s[40:43], s13 offen offset:0 sc1
  v_mfma_f32_16x16x32_bf16 a[112:115], a[52:55], a[176:179], a[112:115]
  v_mfma_f32_16x16x32_bf16 a[116:119], a[52:55], a[180:183], a[116:119]
  v_mfma_f32_16x16x32_bf16 a[120:123], a[52:55], a[184:187], a[120:123]
  v_mfma_f32_16x16x32_bf16 a[124:127], a[52:55], a[188:191], a[124:127]
  v_mfma_f32_16x16x32_bf16 a[128:131], a[56:59], a[176:179], a[128:131]
  buffer_load_dwordx4 a[176:179], v2, s[40:43], s64 offen offset:2048 sc1
  v_mfma_f32_16x16x32_bf16 a[132:135], a[56:59], a[180:183], a[132:135]
  buffer_load_dwordx4 a[180:183], v2, s[40:43], s65 offen offset:2048 sc1
  v_mfma_f32_16x16x32_bf16 a[136:139], a[56:59], a[184:187], a[136:139]
  buffer_load_dwordx4 a[184:187], v2, s[40:43], s66 offen offset:2048 sc1
  v_mfma_f32_16x16x32_bf16 a[140:143], a[56:59], a[188:191], a[140:143]
  buffer_load_dwordx4 a[188:191], v2, s[40:43], s67 offen offset:2048 sc1
  s_waitcnt vmcnt(21)
  v_mfma_f32_16x16x32_bf16 a[64:67], a[60:63], v[216:219], a[64:67]
  v_mfma_f32_16x16x32_bf16 a[68:71], a[60:63], v[220:223], a[68:71]
  v_mfma_f32_16x16x32_bf16 a[72:75], a[60:63], v[224:227], a[72:75]
  v_mfma_f32_16x16x32_bf16 a[76:79], a[60:63], v[228:231], a[76:79]
  buffer_load_dwordx4 v[236:239], v2, s[40:43], s13 offen offset:1024 sc1
  v_mfma_f32_16x16x32_bf16 a[80:83], a[192:195], v[216:219], a[80:83]
  v_mfma_f32_16x16x32_bf16 a[84:87], a[192:195], v[220:223], a[84:87]
  v_mfma_f32_16x16x32_bf16 a[88:91], a[192:195], v[224:227], a[88:91]
  v_mfma_f32_16x16x32_bf16 a[92:95], a[192:195], v[228:231], a[92:95]
  buffer_load_dwordx4 v[240:243], v2, s[40:43], s13 offen offset:2048 sc1
  v_mfma_f32_16x16x32_bf16 a[96:99], a[196:199], v[216:219], a[96:99]
  v_mfma_f32_16x16x32_bf16 a[100:103], a[196:199], v[220:223], a[100:103]
  v_mfma_f32_16x16x32_bf16 a[104:107], a[196:199], v[224:227], a[104:107]
  v_mfma_f32_16x16x32_bf16 a[108:111], a[196:199], v[228:231], a[108:111]
  buffer_load_dwordx4 v[244:247], v2, s[40:43], s13 offen offset:3072 sc1
  v_mfma_f32_16x16x32_bf16 a[112:115], a[200:203], v[216:219], a[112:115]
  s_add_u32 s13, s13, 4096
  v_mfma_f32_16x16x32_bf16 a[116:119], a[200:203], v[220:223], a[116:119]
  v_mfma_f32_16x16x32_bf16 a[120:123], a[200:203], v[224:227], a[120:123]
  v_mfma_f32_16x16x32_bf16 a[124:127], a[200:203], v[228:231], a[124:127]
  v_mfma_f32_16x16x32_bf16 a[128:131], a[204:207], v[216:219], a[128:131]
  buffer_load_dwordx4 v[216:219], v2, s[40:43], s64 offen offset:3072 sc1
  v_mfma_f32_16x16x32_bf16 a[132:135], a[204:207], v[220:223], a[132:135]
  buffer_load_dwordx4 v[220:223], v2, s[40:43], s65 offen offset:3072 sc1
  v_mfma_f32_16x16x32_bf16 a[136:139], a[204:207], v[224:227], a[136:139]
  buffer_load_dwordx4 v[224:227], v2, s[40:43], s66 offen offset:3072 sc1
  v_mfma_f32_16x16x32_bf16 a[140:143], a[204:207], v[228:231], a[140:143]
  buffer_load_dwordx4 v[228:231], v2, s[40:43], s67 offen offset:3072 sc1
  s_waitcnt vmcnt(21)
  v_mfma_f32_16x16x32_bf16 a[64:67], a[208:211], a[144:147], a[64:67]
  s_add_u32 s64, s64, 4096
  v_mfma_f32_16x16x32_bf16 a[68:71], a[208:211], a[148:151], a[68:71]
  s_add_u32 s65, s65, 4096
  v_mfma_f32_16x16x32_bf16 a[72:75], a[208:211], a[152:155], a[72:75]
  s_add_u32 s66, s66, 4096
  v_mfma_f32_16x16x32_bf16 a[76:79], a[208:211], a[156:159], a[76:79]
  buffer_load_dwordx4 v[64:67], v2, s[40:43], s13 offen offset:0 sc1
  v_mfma_f32_16x16x32_bf16 a[80:83], a[212:215], a[144:147], a[80:83]
  v_mfma_f32_16x16x32_bf16 a[84:87], a[212:215], a[148:151], a[84:87]
  v_mfma_f32_16x16x32_bf16 a[88:91], a[212:215], a[152:155], a[88:91]
  s_add_u32 s67, s67, 4096
  v_mfma_f32_16x16x32_bf16 a[92:95], a[212:215], a[156:159], a[92:95]
  buffer_load_dwordx4 v[68:71], v2, s[40:43], s13 offen offset:1024 sc1
  v_mfma_f32_16x16x32_bf16 a[96:99], a[216:219], a[144:147], a[96:99]
  v_mfma_f32_16x16x32_bf16 a[100:103], a[216:219], a[148:151], a[100:103]
  v_mfma_f32_16x16x32_bf16 a[104:107], a[216:219], a[152:155], a[104:107]
  v_mfma_f32_16x16x32_bf16 a[108:111], a[216:219], a[156:159], a[108:111]
  buffer_load_dwordx4 v[72:75], v2, s[40:43], s13 offen offset:2048 sc1
  v_mfma_f32_16x16x32_bf16 a[112:115], a[220:223], a[144:147], a[112:115]
  v_mfma_f32_16x16x32_bf16 a[116:119], a[220:223], a[148:151], a[116:119]
  v_mfma_f32_16x16x32_bf16 a[120:123], a[220:223], a[152:155], a[120:123]
  v_mfma_f32_16x16x32_bf16 a[124:127], a[220:223], a[156:159], a[124:127]
  v_mfma_f32_16x16x32_bf16 a[128:131], a[224:227], a[144:147], a[128:131]
  buffer_load_dwordx4 a[144:147], v2, s[40:43], s64 offen offset:0 sc1
  v_mfma_f32_16x16x32_bf16 a[132:135], a[224:227], a[148:151], a[132:135]
  buffer_load_dwordx4 a[148:151], v2, s[40:43], s65 offen offset:0 sc1
  v_mfma_f32_16x16x32_bf16 a[136:139], a[224:227], a[152:155], a[136:139]
  buffer_load_dwordx4 a[152:155], v2, s[40:43], s66 offen offset:0 sc1
  v_mfma_f32_16x16x32_bf16 a[140:143], a[224:227], a[156:159], a[140:143]
  buffer_load_dwordx4 a[156:159], v2, s[40:43], s67 offen offset:0 sc1
  s_waitcnt vmcnt(21)
  v_mfma_f32_16x16x32_bf16 a[64:67], a[228:231], a[160:163], a[64:67]
  v_mfma_f32_16x16x32_bf16 a[68:71], a[228:231], a[164:167], a[68:71]
  v_mfma_f32_16x16x32_bf16 a[72:75], a[228:231], a[168:171], a[72:75]
  v_mfma_f32_16x16x32_bf16 a[76:79], a[228:231], a[172:175], a[76:79]
  buffer_load_dwordx4 v[76:79], v2, s[40:43], s13 offen offset:3072 sc1
  v_mfma_f32_16x16x32_bf16 a[80:83], a[232:235], a[160:163], a[80:83]
  s_add_u32 s13, s13, 4096
  v_mfma_f32_16x16x32_bf16 a[84:87], a[232:235], a[164:167], a[84:87]
  v_mfma_f32_16x16x32_bf16 a[88:91], a[232:235], a[168:171], a[88:91]
  v_mfma_f32_16x16x32_bf16 a[92:95], a[232:235], a[172:175], a[92:95]
  buffer_load_dwordx4 v[80:83], v2, s[40:43], s13 offen offset:0 sc1
  v_mfma_f32_16x16x32_bf16 a[96:99], a[236:239], a[160:163], a[96:99]
  v_mfma_f32_16x16x32_bf16 a[100:103], a[236:239], a[164:167], a[100:103]
  v_mfma_f32_16x16x32_bf16 a[104:107], a[236:239], a[168:171], a[104:107]
  v_mfma_f32_16x16x32_bf16 a[108:111], a[236:239], a[172:175], a[108:111]
  buffer_load_dwordx4 v[84:87], v2, s[40:43], s13 offen offset:1024 sc1
  v_mfma_f32_16x16x32_bf16 a[112:115], a[240:243], a[160:163], a[112:115]
  v_mfma_f32_16x16x32_bf16 a[116:119], a[240:243], a[164:167], a[116:119]
  v_mfma_f32_16x16x32_bf16 a[120:123], a[240:243], a[168:171], a[120:123]
  v_mfma_f32_16x16x32_bf16 a[124:127], a[240:243], a[172:175], a[124:127]
  v_mfma_f32_16x16x32_bf16 a[128:131], a[244:247], a[160:163], a[128:131]
  buffer_load_dwordx4 a[160:163], v2, s[40:43], s64 offen offset:1024 sc1
  v_mfma_f32_16x16x32_bf16 a[132:135], a[244:247], a[164:167], a[132:135]
  buffer_load_dwordx4 a[164:167], v2, s[40:43], s65 offen offset:1024 sc1
  v_mfma_f32_16x16x32_bf16 a[136:139], a[244:247], a[168:171], a[136:139]
  buffer_load_dwordx4 a[168:171], v2, s[40:43], s66 offen offset:1024 sc1
  v_mfma_f32_16x16x32_bf16 a[140:143], a[244:247], a[172:175], a[140:143]
  buffer_load_dwordx4 a[172:175], v2, s[40:43], s67 offen offset:1024 sc1
  s_waitcnt vmcnt(21)
  v_mfma_f32_16x16x32_bf16 a[64:67], a[248:251], a[176:179], a[64:67]
  v_mfma_f32_16x16x32_bf16 a[68:71], a[248:251], a[180:183], a[68:71]
  v_mfma_f32_16x16x32_bf16 a[72:75], a[248:251], a[184:187], a[72:75]
  v_mfma_f32_16x16x32_bf16 a[76:79], a[248:251], a[188:191], a[76:79]
  buffer_load_dwordx4 v[88:91], v2, s[40:43], s13 offen offset:2048 sc1
  v_mfma_f32_16x16x32_bf16 a[80:83], a[252:255], a[176:179], a[80:83]
  v_mfma_f32_16x16x32_bf16 a[84:87], a[252:255], a[180:183], a[84:87]
  v_mfma_f32_16x16x32_bf16 a[88:91], a[252:255], a[184:187], a[88:91]
  v_mfma_f32_16x16x32_bf16 a[92:95], a[252:255], a[188:191], a[92:95]
  buffer_load_dwordx4 v[92:95], v2, s[40:43], s13 offen offset:3072 sc1
  v_mfma_f32_16x16x32_bf16 a[96:99], v[32:35], a[176:179], a[96:99]
  s_add_u32 s13, s13, 4096
  v_mfma_f32_16x16x32_bf16 a[100:103], v[32:35], a[180:183], a[100:103]
  v_mfma_f32_16x16x32_bf16 a[104:107], v[32:35], a[184:187], a[104:107]
  v_mfma_f32_16x16x32_bf16 a[108:111], v[32:35], a[188:191], a[108:111]
  buffer_load_dwordx4 v[128:131], v2, s[40:43], s13 offen offset:0 sc1
  v_mfma_f32_16x16x32_bf16 a[112:115], v[36:39], a[176:179], a[112:115]
  v_mfma_f32_16x16x32_bf16 a[116:119], v[36:39], a[180:183], a[116:119]
  v_mfma_f32_16x16x32_bf16 a[120:123], v[36:39], a[184:187], a[120:123]
  v_mfma_f32_16x16x32_bf16 a[124:127], v[36:39], a[188:191], a[124:127]
  v_mfma_f32_16x16x32_bf16 a[128:131], v[40:43], a[176:179], a[128:131]
  buffer_load_dwordx4 a[176:179], v2, s[40:43], s64 offen offset:2048 sc1
  v_mfma_f32_16x16x32_bf16 a[132:135], v[40:43], a[180:183], a[132:135]
  buffer_load_dwordx4 a[180:183], v2, s[40:43], s65 offen offset:2048 sc1
  v_mfma_f32_16x16x32_bf16 a[136:139], v[40:43], a[184:187], a[136:139]
  buffer_load_dwordx4 a[184:187], v2, s[40:43], s66 offen offset:2048 sc1
  v_mfma_f32_16x16x32_bf16 a[140:143], v[40:43], a[188:191], a[140:143]
  buffer_load_dwordx4 a[188:191], v2, s[40:43], s67 offen offset:2048 sc1
  s_waitcnt vmcnt(21)
  v_mfma_f32_16x16x32_bf16 a[64:67], v[44:47], v[216:219], a[64:67]
  v_mfma_f32_16x16x32_bf16 a[68:71], v[44:47], v[220:223], a[68:71]
  v_mfma_f32_16x16x32_bf16 a[72:75], v[44:47], v[224:227], a[72:75]
  v_mfma_f32_16x16x32_bf16 a[76:79], v[44:47], v[228:231], a[76:79]
  buffer_load_dwordx4 v[132:135], v2, s[40:43], s13 offen offset:1024 sc1
  v_mfma_f32_16x16x32_bf16 a[80:83], v[48:51], v[216:219], a[80:83]
  v_mfma_f32_16x16x32_bf16 a[84:87], v[48:51], v[220:223], a[84:87]
  v_mfma_f32_16x16x32_bf16 a[88:91], v[48:51], v[224:227], a[88:91]
  v_mfma_f32_16x16x32_bf16 a[92:95], v[48:51], v[228:231], a[92:95]
  buffer_load_dwordx4 v[136:139], v2, s[40:43], s13 offen offset:2048 sc1
  v_mfma_f32_16x16x32_bf16 a[96:99], v[52:55], v[216:219], a[96:99]
  v_mfma_f32_16x16x32_bf16 a[100:103], v[52:55], v[220:223], a[100:103]
  v_mfma_f32_16x16x32_bf16 a[104:107], v[52:55], v[224:227], a[104:107]
  v_mfma_f32_16x16x32_bf16 a[108:111], v[52:55], v[228:231], a[108:111]
  buffer_load_dwordx4 v[140:143], v2, s[40:43], s13 offen offset:3072 sc1
  v_mfma_f32_16x16x32_bf16 a[112:115], v[56:59], v[216:219], a[112:115]
  s_add_u32 s13, s13, 4096
  v_mfma_f32_16x16x32_bf16 a[116:119], v[56:59], v[220:223], a[116:119]
  v_mfma_f32_16x16x32_bf16 a[120:123], v[56:59], v[224:227], a[120:123]
  v_mfma_f32_16x16x32_bf16 a[124:127], v[56:59], v[228:231], a[124:127]
  v_mfma_f32_16x16x32_bf16 a[128:131], v[60:63], v[216:219], a[128:131]
  buffer_load_dwordx4 v[216:219], v2, s[40:43], s64 offen offset:3072 sc1
  v_mfma_f32_16x16x32_bf16 a[132:135], v[60:63], v[220:223], a[132:135]
  buffer_load_dwordx4 v[220:223], v2, s[40:43], s65 offen offset:3072 sc1
  v_mfma_f32_16x16x32_bf16 a[136:139], v[60:63], v[224:227], a[136:139]
  buffer_load_dwordx4 v[224:227], v2, s[40:43], s66 offen offset:3072 sc1
  v_mfma_f32_16x16x32_bf16 a[140:143], v[60:63], v[228:231], a[140:143]
  buffer_load_dwordx4 v[228:231], v2, s[40:43], s67 offen offset:3072 sc1
  s_waitcnt vmcnt(21)
  v_mfma_f32_16x16x32_bf16 a[64:67], v[96:99], a[144:147], a[64:67]
  s_add_u32 s64, s64, 4096
  v_mfma_f32_16x16x32_bf16 a[68:71], v[96:99], a[148:151], a[68:71]
  s_add_u32 s65, s65, 4096
  v_mfma_f32_16x16x32_bf16 a[72:75], v[96:99], a[152:155], a[72:75]
  s_add_u32 s66, s66, 4096
  v_mfma_f32_16x16x32_bf16 a[76:79], v[96:99], a[156:159], a[76:79]
  buffer_load_dwordx4 v[144:147], v2, s[40:43], s13 offen offset:0 sc1
  v_mfma_f32_16x16x32_bf16 a[80:83], v[100:103], a[144:147], a[80:83]
  v_mfma_f32_16x16x32_bf16 a[84:87], v[100:103], a[148:151], a[84:87]
  v_mfma_f32_16x16x32_bf16 a[88:91], v[100:103], a[152:155], a[88:91]
  s_add_u32 s67, s67, 4096
  v_mfma_f32_16x16x32_bf16 a[92:95], v[100:103], a[156:159], a[92:95]
  buffer_load_dwordx4 v[148:151], v2, s[40:43], s13 offen offset:1024 sc1
  v_mfma_f32_16x16x32_bf16 a[96:99], v[104:107], a[144:147], a[96:99]
  v_mfma_f32_16x16x32_bf16 a[100:103], v[104:107], a[148:151], a[100:103]
  v_mfma_f32_16x16x32_bf16 a[104:107], v[104:107], a[152:155], a[104:107]
  v_mfma_f32_16x16x32_bf16 a[108:111], v[104:107], a[156:159], a[108:111]
  buffer_load_dwordx4 v[152:155], v2, s[40:43], s13 offen offset:2048 sc1
  v_mfma_f32_16x16x32_bf16 a[112:115], v[108:111], a[144:147], a[112:115]
  v_mfma_f32_16x16x32_bf16 a[116:119], v[108:111], a[148:151], a[116:119]
  v_mfma_f32_16x16x32_bf16 a[120:123], v[108:111], a[152:155], a[120:123]
  v_mfma_f32_16x16x32_bf16 a[124:127], v[108:111], a[156:159], a[124:127]
  v_mfma_f32_16x16x32_bf16 a[128:131], v[112:115], a[144:147], a[128:131]
  buffer_load_dwordx4 a[144:147], v2, s[40:43], s64 offen offset:0 sc1
  v_mfma_f32_16x16x32_bf16 a[132:135], v[112:115], a[148:151], a[132:135]
  buffer_load_dwordx4 a[148:151], v2, s[40:43], s65 offen offset:0 sc1
  v_mfma_f32_16x16x32_bf16 a[136:139], v[112:115], a[152:155], a[136:139]
  buffer_load_dwordx4 a[152:155], v2, s[40:43], s66 offen offset:0 sc1
  v_mfma_f32_16x16x32_bf16 a[140:143], v[112:115], a[156:159], a[140:143]
  buffer_load_dwordx4 a[156:159], v2, s[40:43], s67 offen offset:0 sc1
  s_waitcnt vmcnt(21)
  v_mfma_f32_16x16x32_bf16 a[64:67], v[116:119], a[160:163], a[64:67]
  v_mfma_f32_16x16x32_bf16 a[68:71], v[116:119], a[164:167], a[68:71]
  v_mfma_f32_16x16x32_bf16 a[72:75], v[116:119], a[168:171], a[72:75]
  v_mfma_f32_16x16x32_bf16 a[76:79], v[116:119], a[172:175], a[76:79]
  buffer_load_dwordx4 v[156:159], v2, s[40:43], s13 offen offset:3072 sc1
  v_mfma_f32_16x16x32_bf16 a[80:83], v[120:123], a[160:163], a[80:83]
  s_add_u32 s13, s13, 4096
  v_mfma_f32_16x16x32_bf16 a[84:87], v[120:123], a[164:167], a[84:87]
  v_mfma_f32_16x16x32_bf16 a[88:91], v[120:123], a[168:171], a[88:91]
  v_mfma_f32_16x16x32_bf16 a[92:95], v[120:123], a[172:175], a[92:95]
  buffer_load_dwordx4 v[176:179], v2, s[40:43], s13 offen offset:0 sc1
  v_mfma_f32_16x16x32_bf16 a[96:99], v[124:127], a[160:163], a[96:99]
  v_mfma_f32_16x16x32_bf16 a[100:103], v[124:127], a[164:167], a[100:103]
  v_mfma_f32_16x16x32_bf16 a[104:107], v[124:127], a[168:171], a[104:107]
  v_mfma_f32_16x16x32_bf16 a[108:111], v[124:127], a[172:175], a[108:111]
  buffer_load_dwordx4 v[180:183], v2, s[40:43], s13 offen offset:1024 sc1
  v_mfma_f32_16x16x32_bf16 a[112:115], v[160:163], a[160:163], a[112:115]
  v_mfma_f32_16x16x32_bf16 a[116:119], v[160:163], a[164:167], a[116:119]
  v_mfma_f32_16x16x32_bf16 a[120:123], v[160:163], a[168:171], a[120:123]
  v_mfma_f32_16x16x32_bf16 a[124:127], v[160:163], a[172:175], a[124:127]
  v_mfma_f32_16x16x32_bf16 a[128:131], v[164:167], a[160:163], a[128:131]
  buffer_load_dwordx4 a[160:163], v2, s[40:43], s64 offen offset:1024 sc1
  v_mfma_f32_16x16x32_bf16 a[132:135], v[164:167], a[164:167], a[132:135]
  buffer_load_dwordx4 a[164:167], v2, s[40:43], s65 offen offset:1024 sc1
  v_mfma_f32_16x16x32_bf16 a[136:139], v[164:167], a[168:171], a[136:139]
  buffer_load_dwordx4 a[168:171], v2, s[40:43], s66 offen offset:1024 sc1
  v_mfma_f32_16x16x32_bf16 a[140:143], v[164:167], a[172:175], a[140:143]
  buffer_load_dwordx4 a[172:175], v2, s[40:43], s67 offen offset:1024 sc1
  s_waitcnt vmcnt(21)
  v_mfma_f32_16x16x32_bf16 a[64:67], v[168:171], a[176:179], a[64:67]
  v_mfma_f32_16x16x32_bf16 a[68:71], v[168:171], a[180:183], a[68:71]
  v_mfma_f32_16x16x32_bf16 a[72:75], v[168:171], a[184:187], a[72:75]
  v_mfma_f32_16x16x32_bf16 a[76:79], v[168:171], a[188:191], a[76:79]
  buffer_load_dwordx4 v[184:187], v2, s[40:43], s13 offen offset:2048 sc1
  v_mfma_f32_16x16x32_bf16 a[80:83], v[172:175], a[176:179], a[80:83]
  v_mfma_f32_16x16x32_bf16 a[84:87], v[172:175], a[180:183], a[84:87]
  v_mfma_f32_16x16x32_bf16 a[88:91], v[172:175], a[184:187], a[88:91]
  v_mfma_f32_16x16x32_bf16 a[92:95], v[172:175], a[188:191], a[92:95]
  buffer_load_dwordx4 v[188:191], v2, s[40:43], s13 offen offset:3072 sc1
  v_mfma_f32_16x16x32_bf16 a[96:99], v[192:195], a[176:179], a[96:99]
  s_add_u32 s13, s13, 4096
  v_mfma_f32_16x16x32_bf16 a[100:103], v[192:195], a[180:183], a[100:103]
  v_mfma_f32_16x16x32_bf16 a[104:107], v[192:195], a[184:187], a[104:107]
  v_mfma_f32_16x16x32_bf16 a[108:111], v[192:195], a[188:191], a[108:111]
  v_mfma_f32_16x16x32_bf16 a[112:115], v[196:199], a[176:179], a[112:115]
  v_mfma_f32_16x16x32_bf16 a[116:119], v[196:199], a[180:183], a[116:119]
  v_mfma_f32_16x16x32_bf16 a[120:123], v[196:199], a[184:187], a[120:123]
  v_mfma_f32_16x16x32_bf16 a[124:127], v[196:199], a[188:191], a[124:127]
  v_mfma_f32_16x16x32_bf16 a[128:131], v[208:211], a[176:179], a[128:131]
  buffer_load_dwordx4 a[176:179], v2, s[40:43], s64 offen offset:2048 sc1
  v_mfma_f32_16x16x32_bf16 a[132:135], v[208:211], a[180:183], a[132:135]
  buffer_load_dwordx4 a[180:183], v2, s[40:43], s65 offen offset:2048 sc1
  v_mfma_f32_16x16x32_bf16 a[136:139], v[208:211], a[184:187], a[136:139]
  buffer_load_dwordx4 a[184:187], v2, s[40:43], s66 offen offset:2048 sc1
  v_mfma_f32_16x16x32_bf16 a[140:143], v[208:211], a[188:191], a[140:143]
  buffer_load_dwordx4 a[188:191], v2, s[40:43], s67 offen offset:2048 sc1
  s_waitcnt vmcnt(20)
  v_mfma_f32_16x16x32_bf16 a[64:67], v[212:215], v[216:219], a[64:67]
  v_mfma_f32_16x16x32_bf16 a[68:71], v[212:215], v[220:223], a[68:71]
  v_mfma_f32_16x16x32_bf16 a[72:75], v[212:215], v[224:227], a[72:75]
  v_mfma_f32_16x16x32_bf16 a[76:79], v[212:215], v[228:231], a[76:79]
  v_mfma_f32_16x16x32_bf16 a[80:83], v[232:235], v[216:219], a[80:83]
  v_mfma_f32_16x16x32_bf16 a[84:87], v[232:235], v[220:223], a[84:87]
  v_mfma_f32_16x16x32_bf16 a[88:91], v[232:235], v[224:227], a[88:91]
  v_mfma_f32_16x16x32_bf16 a[92:95], v[232:235], v[228:231], a[92:95]
  v_mfma_f32_16x16x32_bf16 a[96:99], v[236:239], v[216:219], a[96:99]
  v_mfma_f32_16x16x32_bf16 a[100:103], v[236:239], v[220:223], a[100:103]
  v_mfma_f32_16x16x32_bf16 a[104:107], v[236:239], v[224:227], a[104:107]
  v_mfma_f32_16x16x32_bf16 a[108:111], v[236:239], v[228:231], a[108:111]
  v_mfma_f32_16x16x32_bf16 a[112:115], v[240:243], v[216:219], a[112:115]
  v_mfma_f32_16x16x32_bf16 a[116:119], v[240:243], v[220:223], a[116:119]
  v_mfma_f32_16x16x32_bf16 a[120:123], v[240:243], v[224:227], a[120:123]
  v_mfma_f32_16x16x32_bf16 a[124:127], v[240:243], v[228:231], a[124:127]
  v_mfma_f32_16x16x32_bf16 a[128:131], v[244:247], v[216:219], a[128:131]
  buffer_load_dwordx4 v[216:219], v2, s[40:43], s64 offen offset:3072 sc1
  v_mfma_f32_16x16x32_bf16 a[132:135], v[244:247], v[220:223], a[132:135]
  buffer_load_dwordx4 v[220:223], v2, s[40:43], s65 offen offset:3072 sc1
  v_mfma_f32_16x16x32_bf16 a[136:139], v[244:247], v[224:227], a[136:139]
  buffer_load_dwordx4 v[224:227], v2, s[40:43], s66 offen offset:3072 sc1
  v_mfma_f32_16x16x32_bf16 a[140:143], v[244:247], v[228:231], a[140:143]
  buffer_load_dwordx4 v[228:231], v2, s[40:43], s67 offen offset:3072 sc1
  s_waitcnt vmcnt(17)
  v_mfma_f32_16x16x32_bf16 a[64:67], v[64:67], a[144:147], a[64:67]
  v_mfma_f32_16x16x32_bf16 a[68:71], v[64:67], a[148:151], a[68:71]
  v_mfma_f32_16x16x32_bf16 a[72:75], v[64:67], a[152:155], a[72:75]
  v_mfma_f32_16x16x32_bf16 a[76:79], v[64:67], a[156:159], a[76:79]
  buffer_load_dwordx4 v[160:163], v248, s[44:47], 0 offen
  v_mfma_f32_16x16x32_bf16 a[80:83], v[68:71], a[144:147], a[80:83]
  v_mfma_f32_16x16x32_bf16 a[84:87], v[68:71], a[148:151], a[84:87]
  buffer_load_dwordx4 v[172:175], v200, s[40:43], s27 offen sc1
  v_mfma_f32_16x16x32_bf16 a[88:91], v[68:71], a[152:155], a[88:91]
  v_mfma_f32_16x16x32_bf16 a[92:95], v[68:71], a[156:159], a[92:95]
  buffer_load_dwordx4 v[164:167], v249, s[44:47], 0 offen
  v_mfma_f32_16x16x32_bf16 a[96:99], v[72:75], a[144:147], a[96:99]
  v_mfma_f32_16x16x32_bf16 a[100:103], v[72:75], a[148:151], a[100:103]
  buffer_load_dwordx4 v[192:195], v201, s[40:43], s27 offen sc1
  v_mfma_f32_16x16x32_bf16 a[104:107], v[72:75], a[152:155], a[104:107]
  v_mfma_f32_16x16x32_bf16 a[108:111], v[72:75], a[156:159], a[108:111]
  buffer_load_dwordx4 v[168:171], v250, s[44:47], 0 offen
  v_mfma_f32_16x16x32_bf16 a[112:115], v[76:79], a[144:147], a[112:115]
  v_mfma_f32_16x16x32_bf16 a[116:119], v[76:79], a[148:151], a[116:119]
  buffer_load_dwordx4 v[196:199], v202, s[40:43], s27 offen sc1
  v_mfma_f32_16x16x32_bf16 a[120:123], v[76:79], a[152:155], a[120:123]
  v_mfma_f32_16x16x32_bf16 a[124:127], v[76:79], a[156:159], a[124:127]
  v_mfma_f32_16x16x32_bf16 a[128:131], v[80:83], a[144:147], a[128:131]
  v_mfma_f32_16x16x32_bf16 a[132:135], v[80:83], a[148:151], a[132:135]
  v_mfma_f32_16x16x32_bf16 a[136:139], v[80:83], a[152:155], a[136:139]
  v_mfma_f32_16x16x32_bf16 a[140:143], v[80:83], a[156:159], a[140:143]
  s_waitcnt vmcnt(16)
  v_mfma_f32_16x16x32_bf16 a[64:67], v[84:87], a[160:163], a[64:67]
  v_mfma_f32_16x16x32_bf16 a[68:71], v[84:87], a[164:167], a[68:71]
  v_mfma_f32_16x16x32_bf16 a[72:75], v[84:87], a[168:171], a[72:75]
  v_mfma_f32_16x16x32_bf16 a[76:79], v[84:87], a[172:175], a[76:79]
  v_mfma_f32_16x16x32_bf16 a[80:83], v[88:91], a[160:163], a[80:83]
  v_mfma_f32_16x16x32_bf16 a[84:87], v[88:91], a[164:167], a[84:87]
  v_mfma_f32_16x16x32_bf16 a[88:91], v[88:91], a[168:171], a[88:91]
  v_mfma_f32_16x16x32_bf16 a[92:95], v[88:91], a[172:175], a[92:95]
  v_mfma_f32_16x16x32_bf16 a[96:99], v[92:95], a[160:163], a[96:99]
  v_mfma_f32_16x16x32_bf16 a[100:103], v[92:95], a[164:167], a[100:103]
  v_mfma_f32_16x16x32_bf16 a[104:107], v[92:95], a[168:171], a[104:107]
  v_mfma_f32_16x16x32_bf16 a[108:111], v[92:95], a[172:175], a[108:111]
  v_mfma_f32_16x16x32_bf16 a[112:115], v[128:131], a[160:163], a[112:115]
  v_mfma_f32_16x16x32_bf16 a[116:119], v[128:131], a[164:167], a[116:119]
  v_mfma_f32_16x16x32_bf16 a[120:123], v[128:131], a[168:171], a[120:123]
  v_mfma_f32_16x16x32_bf16 a[124:127], v[128:131], a[172:175], a[124:127]
  v_mfma_f32_16x16x32_bf16 a[128:131], v[132:135], a[160:163], a[128:131]
  v_mfma_f32_16x16x32_bf16 a[132:135], v[132:135], a[164:167], a[132:135]
  v_mfma_f32_16x16x32_bf16 a[136:139], v[132:135], a[168:171], a[136:139]
  v_mfma_f32_16x16x32_bf16 a[140:143], v[132:135], a[172:175], a[140:143]
  s_waitcnt vmcnt(10)
  v_mfma_f32_16x16x32_bf16 a[64:67], v[136:139], a[176:179], a[64:67]
  v_mfma_f32_16x16x32_bf16 a[68:71], v[136:139], a[180:183], a[68:71]
  v_mfma_f32_16x16x32_bf16 a[72:75], v[136:139], a[184:187], a[72:75]
  v_mfma_f32_16x16x32_bf16 a[76:79], v[136:139], a[188:191], a[76:79]
  v_mfma_f32_16x16x32_bf16 a[80:83], v[140:143], a[176:179], a[80:83]
  v_mfma_f32_16x16x32_bf16 a[84:87], v[140:143], a[180:183], a[84:87]
  v_mfma_f32_16x16x32_bf16 a[88:91], v[140:143], a[184:187], a[88:91]
  v_mfma_f32_16x16x32_bf16 a[92:95], v[140:143], a[188:191], a[92:95]
  v_mfma_f32_16x16x32_bf16 a[96:99], v[144:147], a[176:179], a[96:99]
  v_mfma_f32_16x16x32_bf16 a[100:103], v[144:147], a[180:183], a[100:103]
  v_mfma_f32_16x16x32_bf16 a[104:107], v[144:147], a[184:187], a[104:107]
  v_mfma_f32_16x16x32_bf16 a[108:111], v[144:147], a[188:191], a[108:111]
  v_mfma_f32_16x16x32_bf16 a[112:115], v[148:151], a[176:179], a[112:115]
  v_mfma_f32_16x16x32_bf16 a[116:119], v[148:151], a[180:183], a[116:119]
  v_mfma_f32_16x16x32_bf16 a[120:123], v[148:151], a[184:187], a[120:123]
  v_mfma_f32_16x16x32_bf16 a[124:127], v[148:151], a[188:191], a[124:127]
  v_mfma_f32_16x16x32_bf16 a[128:131], v[152:155], a[176:179], a[128:131]
  v_mfma_f32_16x16x32_bf16 a[132:135], v[152:155], a[180:183], a[132:135]
  v_mfma_f32_16x16x32_bf16 a[136:139], v[152:155], a[184:187], a[136:139]
  v_mfma_f32_16x16x32_bf16 a[140:143], v[152:155], a[188:191], a[140:143]
  s_waitcnt vmcnt(6)
  v_mfma_f32_16x16x32_bf16 a[64:67], v[156:159], v[216:219], a[64:67]
  v_mfma_f32_16x16x32_bf16 a[68:71], v[156:159], v[220:223], a[68:71]
  v_mfma_f32_16x16x32_bf16 a[72:75], v[156:159], v[224:227], a[72:75]
  v_mfma_f32_16x16x32_bf16 a[76:79], v[156:159], v[228:231], a[76:79]
  v_mfma_f32_16x16x32_bf16 a[80:83], v[176:179], v[216:219], a[80:83]
  v_mfma_f32_16x16x32_bf16 a[84:87], v[176:179], v[220:223], a[84:87]
  v_mfma_f32_16x16x32_bf16 a[88:91], v[176:179], v[224:227], a[88:91]
  v_mfma_f32_16x16x32_bf16 a[92:95], v[176:179], v[228:231], a[92:95]
  v_mfma_f32_16x16x32_bf16 a[96:99], v[180:183], v[216:219], a[96:99]
  v_mfma_f32_16x16x32_bf16 a[100:103], v[180:183], v[220:223], a[100:103]
  v_mfma_f32_16x16x32_bf16 a[104:107], v[180:183], v[224:227], a[104:107]
  v_mfma_f32_16x16x32_bf16 a[108:111], v[180:183], v[228:231], a[108:111]
  v_mfma_f32_16x16x32_bf16 a[112:115], v[184:187], v[216:219], a[112:115]
  v_mfma_f32_16x16x32_bf16 a[116:119], v[184:187], v[220:223], a[116:119]
  v_mfma_f32_16x16x32_bf16 a[120:123], v[184:187], v[224:227], a[120:123]
  v_mfma_f32_16x16x32_bf16 a[124:127], v[184:187], v[228:231], a[124:127]
  v_mfma_f32_16x16x32_bf16 a[128:131], v[188:191], v[216:219], a[128:131]
  v_mfma_f32_16x16x32_bf16 a[132:135], v[188:191], v[220:223], a[132:135]
  v_mfma_f32_16x16x32_bf16 a[136:139], v[188:191], v[224:227], a[136:139]
  v_mfma_f32_16x16x32_bf16 a[140:143], v[188:191], v[228:231], a[140:143]
  v_and_b32 v16, 15, v1
  v_mul_u32_u24 v16, 336, v16
  v_lshrrev_b32 v17, 4, v1
  v_lshl_add_u32 v16, v17, 4, v16
  s_mul_i32 s23, s20, 21504
  v_add_u32 v16, s23, v16
  s_barrier
  ds_write_b128 v16, a[64:67] offset:0
  ds_write_b128 v16, a[68:71] offset:5376
  ds_write_b128 v16, a[72:75] offset:10752
  ds_write_b128 v16, a[76:79] offset:16128
  ds_write_b128 v16, a[80:83] offset:64
  ds_write_b128 v16, a[84:87] offset:5440
  ds_write_b128 v16, a[88:91] offset:10816
  ds_write_b128 v16, a[92:95] offset:16192
  ds_write_b128 v16, a[96:99] offset:128
  ds_write_b128 v16, a[100:103] offset:5504
  ds_write_b128 v16, a[104:107] offset:10880
  ds_write_b128 v16, a[108:111] offset:16256
  ds_write_b128 v16, a[112:115] offset:192
  ds_write_b128 v16, a[116:119] offset:5568
  ds_write_b128 v16, a[120:123] offset:10944
  ds_write_b128 v16, a[124:127] offset:16320
  ds_write_b128 v16, a[128:131] offset:256
  ds_write_b128 v16, a[132:135] offset:5632
  ds_write_b128 v16, a[136:139] offset:11008
  ds_write_b128 v16, a[140:143] offset:16384
  s_waitcnt vmcnt(0) lgkmcnt(0)
  s_barrier
  ds_read_b128 v[32:35], v251 offset:0
  ds_read_b128 v[36:39], v251 offset:16
  ds_read_b128 v[40:43], v251 offset:21504
  ds_read_b128 v[44:47], v251 offset:21520
  ds_read_b128 v[48:51], v251 offset:43008
  ds_read_b128 v[52:55], v251 offset:43024
  ds_read_b128 v[56:59], v251 offset:64512
  ds_read_b128 v[60:63], v251 offset:64528
  ds_read_b128 v[64:67], v203 offset:0
  ds_read_b128 v[68:71], v203 offset:16
  ds_read_b128 v[72:75], v252 offset:0
  ds_read_b128 v[76:79], v252 offset:16
  ds_read_b128 v[80:83], v252 offset:21504
  ds_read_b128 v[84:87], v252 offset:21520
  ds_read_b128 v[88:91], v252 offset:43008
  ds_read_b128 v[92:95], v252 offset:43024
  ds_read_b128 v[96:99], v252 offset:64512
  ds_read_b128 v[100:103], v252 offset:64528
  ds_read_b128 v[104:107], v204 offset:0
  ds_read_b128 v[108:111], v204 offset:16
  ds_read_b128 v[112:115], v253 offset:0
  ds_read_b128 v[116:119], v253 offset:16
  ds_read_b128 v[120:123], v253 offset:21504
  ds_read_b128 v[124:127], v253 offset:21520
  ds_read_b128 v[128:131], v253 offset:43008
  ds_read_b128 v[132:135], v253 offset:43024
  ds_read_b128 v[136:139], v253 offset:64512
  ds_read_b128 v[140:143], v253 offset:64528
  ds_read_b128 v[144:147], v205 offset:0
  ds_read_b128 v[148:151], v205 offset:16
  s_waitcnt lgkmcnt(10)
  v_add_f32 v32, v32, v40
  v_add_f32 v48, v48, v56
  v_add_f32 v33, v33, v41
  v_add_f32 v49, v49, v57
  v_add_f32 v34, v34, v42
  v_add_f32 v50, v50, v58
  v_add_f32 v35, v35, v43
  v_add_f32 v51, v51, v59
  v_add_f32 v36, v36, v44
  v_add_f32 v52, v52, v60
  v_add_f32 v37, v37, v45
  v_add_f32 v53, v53, v61
  v_add_f32 v38, v38, v46
  v_add_f32 v54, v54, v62
  v_add_f32 v39, v39, v47
  v_add_f32 v55, v55, v63
  v_add_f32 v32, v32, v48
  v_add_f32 v33, v33, v49
  v_add_f32 v34, v34, v50
  v_add_f32 v35, v35, v51
  v_add_f32 v36, v36, v52
  v_add_f32 v37, v37, v53
  v_add_f32 v38, v38, v54
  v_add_f32 v39, v39, v55
  v_cvt_pk_bf16_f32 v40, v32, v33
  v_lshlrev_b32 v42, 16, v160
  v_and_b32 v43, 0xffff0000, v160
  v_and_b32 v41, 0xffff0000, v40
  v_lshlrev_b32 v40, 16, v40
  v_add_f32 v40, v40, v42
  v_add_f32 v41, v41, v43
  v_cvt_pk_bf16_f32 v40, v40, v41
  v_lshlrev_b32 v42, 16, v172
  v_and_b32 v43, 0xffff0000, v172
  v_add_f32 v42, v42, v64
  v_add_f32 v43, v43, v65
  v_cvt_pk_bf16_f32 v42, v42, v43
  v_and_b32 v41, 0xffff0000, v40
  v_lshlrev_b32 v40, 16, v40
  v_and_b32 v43, 0xffff0000, v42
  v_lshlrev_b32 v42, 16, v42
  v_add_f32 v40, v40, v42
  v_add_f32 v41, v41, v43
  v_cvt_pk_bf16_f32 v44, v40, v41
  v_cvt_pk_bf16_f32 v40, v34, v35
  v_lshlrev_b32 v42, 16, v161
  v_and_b32 v43, 0xffff0000, v161
  v_and_b32 v41, 0xffff0000, v40
  v_lshlrev_b32 v40, 16, v40
  v_add_f32 v40, v40, v42
  v_add_f32 v41, v41, v43
  v_cvt_pk_bf16_f32 v40, v40, v41
  v_lshlrev_b32 v42, 16, v173
  v_and_b32 v43, 0xffff0000, v173
  v_add_f32 v42, v42, v66
  v_add_f32 v43, v43, v67
  v_cvt_pk_bf16_f32 v42, v42, v43
  v_and_b32 v41, 0xffff0000, v40
  v_lshlrev_b32 v40, 16, v40
  v_and_b32 v43, 0xffff0000, v42
  v_lshlrev_b32 v42, 16, v42
  v_add_f32 v40, v40, v42
  v_add_f32 v41, v41, v43
  v_cvt_pk_bf16_f32 v45, v40, v41
  v_cvt_pk_bf16_f32 v40, v36, v37
  v_lshlrev_b32 v42, 16, v162
  v_and_b32 v43, 0xffff0000, v162
  v_and_b32 v41, 0xffff0000, v40
  v_lshlrev_b32 v40, 16, v40
  v_add_f32 v40, v40, v42
  v_add_f32 v41, v41, v43
  v_cvt_pk_bf16_f32 v40, v40, v41
  v_lshlrev_b32 v42, 16, v174
  v_and_b32 v43, 0xffff0000, v174
  v_add_f32 v42, v42, v68
  v_add_f32 v43, v43, v69
  v_cvt_pk_bf16_f32 v42, v42, v43
  v_and_b32 v41, 0xffff0000, v40
  v_lshlrev_b32 v40, 16, v40
  v_and_b32 v43, 0xffff0000, v42
  v_lshlrev_b32 v42, 16, v42
  v_add_f32 v40, v40, v42
  v_add_f32 v41, v41, v43
  v_cvt_pk_bf16_f32 v46, v40, v41
  v_cvt_pk_bf16_f32 v40, v38, v39
  v_lshlrev_b32 v42, 16, v163
  v_and_b32 v43, 0xffff0000, v163
  v_and_b32 v41, 0xffff0000, v40
  v_lshlrev_b32 v40, 16, v40
  v_add_f32 v40, v40, v42
  v_add_f32 v41, v41, v43
  v_cvt_pk_bf16_f32 v40, v40, v41
  v_lshlrev_b32 v42, 16, v175
  v_and_b32 v43, 0xffff0000, v175
  v_add_f32 v42, v42, v70
  v_add_f32 v43, v43, v71
  v_cvt_pk_bf16_f32 v42, v42, v43
  v_and_b32 v41, 0xffff0000, v40
  v_lshlrev_b32 v40, 16, v40
  v_and_b32 v43, 0xffff0000, v42
  v_lshlrev_b32 v42, 16, v42
  v_add_f32 v40, v40, v42
  v_add_f32 v41, v41, v43
  v_cvt_pk_bf16_f32 v47, v40, v41
  buffer_store_dwordx4 v[44:47], v248, s[48:51], 0 offen
  s_waitcnt lgkmcnt(10)
  v_add_f32 v72, v72, v80
  v_add_f32 v88, v88, v96
  v_add_f32 v73, v73, v81
  v_add_f32 v89, v89, v97
  v_add_f32 v74, v74, v82
  v_add_f32 v90, v90, v98
  v_add_f32 v75, v75, v83
  v_add_f32 v91, v91, v99
  v_add_f32 v76, v76, v84
  v_add_f32 v92, v92, v100
  v_add_f32 v77, v77, v85
  v_add_f32 v93, v93, v101
  v_add_f32 v78, v78, v86
  v_add_f32 v94, v94, v102
  v_add_f32 v79, v79, v87
  v_add_f32 v95, v95, v103
  v_add_f32 v72, v72, v88
  v_add_f32 v73, v73, v89
  v_add_f32 v74, v74, v90
  v_add_f32 v75, v75, v91
  v_add_f32 v76, v76, v92
  v_add_f32 v77, v77, v93
  v_add_f32 v78, v78, v94
  v_add_f32 v79, v79, v95
  v_cvt_pk_bf16_f32 v80, v72, v73
  v_lshlrev_b32 v82, 16, v164
  v_and_b32 v83, 0xffff0000, v164
  v_and_b32 v81, 0xffff0000, v80
  v_lshlrev_b32 v80, 16, v80
  v_add_f32 v80, v80, v82
  v_add_f32 v81, v81, v83
  v_cvt_pk_bf16_f32 v80, v80, v81
  v_lshlrev_b32 v82, 16, v192
  v_and_b32 v83, 0xffff0000, v192
  v_add_f32 v82, v82, v104
  v_add_f32 v83, v83, v105
  v_cvt_pk_bf16_f32 v82, v82, v83
  v_and_b32 v81, 0xffff0000, v80
  v_lshlrev_b32 v80, 16, v80
  v_and_b32 v83, 0xffff0000, v82
  v_lshlrev_b32 v82, 16, v82
  v_add_f32 v80, v80, v82
  v_add_f32 v81, v81, v83
  v_cvt_pk_bf16_f32 v84, v80, v81
  v_cvt_pk_bf16_f32 v80, v74, v75
  v_lshlrev_b32 v82, 16, v165
  v_and_b32 v83, 0xffff0000, v165
  v_and_b32 v81, 0xffff0000, v80
  v_lshlrev_b32 v80, 16, v80
  v_add_f32 v80, v80, v82
  v_add_f32 v81, v81, v83
  v_cvt_pk_bf16_f32 v80, v80, v81
  v_lshlrev_b32 v82, 16, v193
  v_and_b32 v83, 0xffff0000, v193
  v_add_f32 v82, v82, v106
  v_add_f32 v83, v83, v107
  v_cvt_pk_bf16_f32 v82, v82, v83
  v_and_b32 v81, 0xffff0000, v80
  v_lshlrev_b32 v80, 16, v80
  v_and_b32 v83, 0xffff0000, v82
  v_lshlrev_b32 v82, 16, v82
  v_add_f32 v80, v80, v82
  v_add_f32 v81, v81, v83
  v_cvt_pk_bf16_f32 v85, v80, v81
  v_cvt_pk_bf16_f32 v80, v76, v77
  v_lshlrev_b32 v82, 16, v166
  v_and_b32 v83, 0xffff0000, v166
  v_and_b32 v81, 0xffff0000, v80
  v_lshlrev_b32 v80, 16, v80
  v_add_f32 v80, v80, v82
  v_add_f32 v81, v81, v83
  v_cvt_pk_bf16_f32 v80, v80, v81
  v_lshlrev_b32 v82, 16, v194
  v_and_b32 v83, 0xffff0000, v194
  v_add_f32 v82, v82, v108
  v_add_f32 v83, v83, v109
  v_cvt_pk_bf16_f32 v82, v82, v83
  v_and_b32 v81, 0xffff0000, v80
  v_lshlrev_b32 v80, 16, v80
  v_and_b32 v83, 0xffff0000, v82
  v_lshlrev_b32 v82, 16, v82
  v_add_f32 v80, v80, v82
  v_add_f32 v81, v81, v83
  v_cvt_pk_bf16_f32 v86, v80, v81
  v_cvt_pk_bf16_f32 v80, v78, v79
  v_lshlrev_b32 v82, 16, v167
  v_and_b32 v83, 0xffff0000, v167
  v_and_b32 v81, 0xffff0000, v80
  v_lshlrev_b32 v80, 16, v80
  v_add_f32 v80, v80, v82
  v_add_f32 v81, v81, v83
  v_cvt_pk_bf16_f32 v80, v80, v81
  v_lshlrev_b32 v82, 16, v195
  v_and_b32 v83, 0xffff0000, v195
  v_add_f32 v82, v82, v110
  v_add_f32 v83, v83, v111
  v_cvt_pk_bf16_f32 v82, v82, v83
  v_and_b32 v81, 0xffff0000, v80
  v_lshlrev_b32 v80, 16, v80
  v_and_b32 v83, 0xffff0000, v82
  v_lshlrev_b32 v82, 16, v82
  v_add_f32 v80, v80, v82
  v_add_f32 v81, v81, v83
  v_cvt_pk_bf16_f32 v87, v80, v81
  buffer_store_dwordx4 v[84:87], v249, s[48:51], 0 offen
  s_waitcnt lgkmcnt(0)
  v_add_f32 v112, v112, v120
  v_add_f32 v128, v128, v136
  v_add_f32 v113, v113, v121
  v_add_f32 v129, v129, v137
  v_add_f32 v114, v114, v122
  v_add_f32 v130, v130, v138
  v_add_f32 v115, v115, v123
  v_add_f32 v131, v131, v139
  v_add_f32 v116, v116, v124
  v_add_f32 v132, v132, v140
  v_add_f32 v117, v117, v125
  v_add_f32 v133, v133, v141
  v_add_f32 v118, v118, v126
  v_add_f32 v134, v134, v142
  v_add_f32 v119, v119, v127
  v_add_f32 v135, v135, v143
  v_add_f32 v112, v112, v128
  v_add_f32 v113, v113, v129
  v_add_f32 v114, v114, v130
  v_add_f32 v115, v115, v131
  v_add_f32 v116, v116, v132
  v_add_f32 v117, v117, v133
  v_add_f32 v118, v118, v134
  v_add_f32 v119, v119, v135
  v_cvt_pk_bf16_f32 v120, v112, v113
  v_lshlrev_b32 v122, 16, v168
  v_and_b32 v123, 0xffff0000, v168
  v_and_b32 v121, 0xffff0000, v120
  v_lshlrev_b32 v120, 16, v120
  v_add_f32 v120, v120, v122
  v_add_f32 v121, v121, v123
  v_cvt_pk_bf16_f32 v120, v120, v121
  v_lshlrev_b32 v122, 16, v196
  v_and_b32 v123, 0xffff0000, v196
  v_add_f32 v122, v122, v144
  v_add_f32 v123, v123, v145
  v_cvt_pk_bf16_f32 v122, v122, v123
  v_and_b32 v121, 0xffff0000, v120
  v_lshlrev_b32 v120, 16, v120
  v_and_b32 v123, 0xffff0000, v122
  v_lshlrev_b32 v122, 16, v122
  v_add_f32 v120, v120, v122
  v_add_f32 v121, v121, v123
  v_cvt_pk_bf16_f32 v124, v120, v121
  v_cvt_pk_bf16_f32 v120, v114, v115
  v_lshlrev_b32 v122, 16, v169
  v_and_b32 v123, 0xffff0000, v169
  v_and_b32 v121, 0xffff0000, v120
  v_lshlrev_b32 v120, 16, v120
  v_add_f32 v120, v120, v122
  v_add_f32 v121, v121, v123
  v_cvt_pk_bf16_f32 v120, v120, v121
  v_lshlrev_b32 v122, 16, v197
  v_and_b32 v123, 0xffff0000, v197
  v_add_f32 v122, v122, v146
  v_add_f32 v123, v123, v147
  v_cvt_pk_bf16_f32 v122, v122, v123
  v_and_b32 v121, 0xffff0000, v120
  v_lshlrev_b32 v120, 16, v120
  v_and_b32 v123, 0xffff0000, v122
  v_lshlrev_b32 v122, 16, v122
  v_add_f32 v120, v120, v122
  v_add_f32 v121, v121, v123
  v_cvt_pk_bf16_f32 v125, v120, v121
  v_cvt_pk_bf16_f32 v120, v116, v117
  v_lshlrev_b32 v122, 16, v170
  v_and_b32 v123, 0xffff0000, v170
  v_and_b32 v121, 0xffff0000, v120
  v_lshlrev_b32 v120, 16, v120
  v_add_f32 v120, v120, v122
  v_add_f32 v121, v121, v123
  v_cvt_pk_bf16_f32 v120, v120, v121
  v_lshlrev_b32 v122, 16, v198
  v_and_b32 v123, 0xffff0000, v198
  v_add_f32 v122, v122, v148
  v_add_f32 v123, v123, v149
  v_cvt_pk_bf16_f32 v122, v122, v123
  v_and_b32 v121, 0xffff0000, v120
  v_lshlrev_b32 v120, 16, v120
  v_and_b32 v123, 0xffff0000, v122
  v_lshlrev_b32 v122, 16, v122
  v_add_f32 v120, v120, v122
  v_add_f32 v121, v121, v123
  v_cvt_pk_bf16_f32 v126, v120, v121
  v_cvt_pk_bf16_f32 v120, v118, v119
  v_lshlrev_b32 v122, 16, v171
  v_and_b32 v123, 0xffff0000, v171
  v_and_b32 v121, 0xffff0000, v120
  v_lshlrev_b32 v120, 16, v120
  v_add_f32 v120, v120, v122
  v_add_f32 v121, v121, v123
  v_cvt_pk_bf16_f32 v120, v120, v121
  v_lshlrev_b32 v122, 16, v199
  v_and_b32 v123, 0xffff0000, v199
  v_add_f32 v122, v122, v150
  v_add_f32 v123, v123, v151
  v_cvt_pk_bf16_f32 v122, v122, v123
  v_and_b32 v121, 0xffff0000, v120
  v_lshlrev_b32 v120, 16, v120
  v_and_b32 v123, 0xffff0000, v122
  v_lshlrev_b32 v122, 16, v122
  v_add_f32 v120, v120, v122
  v_add_f32 v121, v121, v123
  v_cvt_pk_bf16_f32 v127, v120, v121
  buffer_store_dwordx4 v[124:127], v250, s[48:51], 0 offen
fa_end:
  s_endpgm
fa_ln_spin:
  s_mov_b32 s83, 200000
fa_ln_spin2:
  buffer_load_dword v15, v229, s[56:59], 0 offen sc1
  s_waitcnt vmcnt(0)
  v_cmp_ne_u32 vcc, 0x01010101, v15
  s_cbranch_vccz fa_ln_ok
  s_sleep 8
  s_sub_u32 s83, s83, 1
  s_cmp_lg_u32 s83, 0
  s_cbranch_scc1 fa_ln_spin2
  s_branch fa_ln_ok
fa_p1stubK:
  s_call_b64 s[76:77], fa_p1sub
  s_branch fa_p1backK
fa_p1stubV:
  s_call_b64 s[76:77], fa_p1sub
  s_branch fa_p1backV
fa_p1sub:
  s_cmp_ge_u32 s28, 5
  s_cbranch_scc1 fa_p1sub5
  s_cmp_eq_u32 s28, 3
  s_cbranch_scc0 fa_p1sub0
  s_mov_b32 s48, s60
  s_mov_b32 s49, s61
  s_mov_b32 s50, s75
  s_lshl_b32 s74, s22, 2
  s_add_u32 s74, s74, s20
  s_lshl_b32 s74, s74, 16
  s_mov_b32 s73, 2097152
fa_p1sub0:
  s_cmp_eq_u32 s28, s71
  s_cselect_b32 s23, s70, 1073741824
  v_mov_b32 v16, 1073741824
  v_mov_b32 v17, 1
  v_writelane_b32 v16, s23, 0
  buffer_store_byte v17, v16, s[56:59], 0 offen sc1
  s_setpc_b64 s[76:77]
fa_p1sub5:
  s_cmp_eq_u32 s28, 6
  s_cbranch_scc1 fa_p1sub6
  v_lshlrev_b32 v229, 2, v1
  buffer_load_dword v15, v229, s[56:59], 0 offen sc1
  s_setpc_b64 s[76:77]
fa_p1sub6:
  v_cmp_ne_u32 vcc, 0x01010101, v15
  s_cbranch_vccnz fa_ln_spin
fa_ln_ok:
  s_mov_b32 s36, s60
  s_mov_b32 s37, s61
  s_mov_b32 s38, s75
  s_lshr_b32 s27, s20, 1
  s_lshl_b32 s27, s27, 18
  s_mov_b32 s25, 524288
  s_mov_b32 s32, s18
  s_mov_b32 s33, s19
  s_mov_b32 s34, 2621440
  s_mov_b32 s26, 0
  s_movk_i32 s79, 1024
  s_lshl_b32 s23, s22, 2
  s_add_u32 s23, s23, s20
  s_mul_i32 s23, s23, 40960
  v_add_u32 v3, s23, v2
  s_sub_u32 s23, 15, s22
  s_lshl_b32 s23, s23, 2
  s_add_u32 s23, s23, s20
  s_mul_i32 s23, s23, 40960
  s_sub_u32 s23, s23, 2048
  v_add_u32 v5, s23, v2
  v_add_u32 v4, 19456, v3
  v_add_u32 v6, 19456, v5
  s_setpc_b64 s[76:77]
fa_kv_spin:
  s_mov_b32 s83, 200000
fa_kv_spin2:
  buffer_load_dword v15, v8, s[40:43], 0 offen sc1
  s_waitcnt vmcnt(0)
  v_cmp_eq_u32 vcc, 0, v15
  s_cbranch_vccz fa_kv_ok
  s_sleep 8
  s_sub_u32 s83, s83, 1
  s_cmp_lg_u32 s83, 0
  s_cbranch_scc1 fa_kv_spin2
  s_branch fa_kv_ok
fa_top8:
  s_cmp_lg_u32 s20, 0
  s_cbranch_scc1 fa_notop
  s_mov_b32 s23, 2621440
  s_mov_b32 s31, 2625536
  buffer_load_dwordx4 v[96:99], v2, s[40:43], s23 offen offset:0 sc1
  buffer_load_dwordx4 v[100:103], v2, s[40:43], s23 offen offset:1024 sc1
  buffer_load_dwordx4 v[104:107], v2, s[40:43], s23 offen offset:2048 sc1
  buffer_load_dwordx4 v[108:111], v2, s[40:43], s23 offen offset:3072 sc1
  buffer_load_dwordx4 v[112:115], v2, s[40:43], s31 offen offset:0 sc1
  buffer_load_dwordx4 v[116:119], v2, s[40:43], s31 offen offset:1024 sc1
  buffer_load_dwordx4 v[120:123], v2, s[40:43], s31 offen offset:2048 sc1
  buffer_load_dwordx4 v[124:127], v2, s[40:43], s31 offen offset:3072 sc1
  v_mov_b32 v21, 0
  v_mov_b32 v22, 0
  v_and_b32 v23, 7, v1
  s_mov_b32 s23, 0
  s_waitcnt vmcnt(0)
fa_top:
  v_max3_u32 v20, v96, v97, v98
  v_max3_u32 v24, v99, v100, v101
  v_max3_u32 v20, v20, v102, v103
  v_max3_u32 v24, v24, v104, v105
  v_max3_u32 v20, v20, v106, v107
  v_max3_u32 v24, v24, v108, v109
  v_max3_u32 v20, v20, v110, v111
  v_max3_u32 v24, v24, v112, v113
  v_max3_u32 v20, v20, v114, v115
  v_max3_u32 v24, v24, v116, v117
  v_max3_u32 v20, v20, v118, v119
  v_max3_u32 v24, v24, v120, v121
  v_max3_u32 v20, v20, v122, v123
  v_max3_u32 v24, v24, v124, v125
  v_max3_u32 v20, v20, v126, v127
  v_max_u32 v20, v20, v24
  s_nop 1
  v_max_u32_dpp v20, v20, v20 quad_perm:[1,0,3,2] row_mask:0xf bank_mask:0xf
  s_nop 1
  v_max_u32_dpp v20, v20, v20 quad_perm:[2,3,0,1] row_mask:0xf bank_mask:0xf
  s_nop 1
  v_max_u32_dpp v20, v20, v20 row_half_mirror row_mask:0xf bank_mask:0xf
  s_nop 1
  v_max_u32_dpp v20, v20, v20 row_mirror row_mask:0xf bank_mask:0xf
  v_mov_b32 v24, v20
  s_nop 1
  v_permlane16_swap_b32 v20, v24
  v_max_u32 v20, v20, v24
  v_mov_b32 v24, v20
  s_nop 1
  v_permlane32_swap_b32 v20, v24
  v_max_u32 v20, v20, v24
  v_add_u32 v21, v21, v20
  v_cmp_eq_u32 vcc, s23, v23
  v_sub_u32 v96, v96, v20
  v_sub_u32 v97, v97, v20
  v_sub_u32 v98, v98, v20
  v_sub_u32 v99, v99, v20
  v_sub_u32 v100, v100, v20
  v_sub_u32 v101, v101, v20
  v_sub_u32 v102, v102, v20
  v_sub_u32 v103, v103, v20
  v_sub_u32 v104, v104, v20
  v_sub_u32 v105, v105, v20
  v_sub_u32 v106, v106, v20
  v_sub_u32 v107, v107, v20
  v_sub_u32 v108, v108, v20
  v_sub_u32 v109, v109, v20
  v_sub_u32 v110, v110, v20
  v_sub_u32 v111, v111, v20
  v_sub_u32 v112, v112, v20
  v_sub_u32 v113, v113, v20
  v_sub_u32 v114, v114, v20
  v_sub_u32 v115, v115, v20
  v_sub_u32 v116, v116, v20
  v_sub_u32 v117, v117, v20
  v_sub_u32 v118, v118, v20
  v_sub_u32 v119, v119, v20
  v_sub_u32 v120, v120, v20
  v_sub_u32 v121, v121, v20
  v_sub_u32 v122, v122, v20
  v_sub_u32 v123, v123, v20
  v_sub_u32 v124, v124, v20
  v_sub_u32 v125, v125, v20
  v_sub_u32 v126, v126, v20
  v_sub_u32 v127, v127, v20
  v_cndmask_b32 v22, v22, v21, vcc
  s_add_u32 s23, s23, 1
  s_cmp_lt_u32 s23, 8
  s_cbranch_scc1 fa_top
  v_and_b32 v25, 0xffff, v22
  v_sub_u32 v25, 0xffff, v25
  v_and_b32 v25, 2047, v25
  v_ashrrev_i32 v20, 31, v22
  v_not_b32 v20, v20
  v_or_b32 v20, 0x80000000, v20
  v_xor_b32 v26, v22, v20
  v_and_b32 v26, 0xffff0000, v26
  v_mul_f32 v26, 0xbfb8aa3b, v26
  v_exp_f32 v26, v26
  s_nop 0
  v_add_f32 v26, 1.0, v26
  v_rcp_f32 v26, v26
  s_nop 0
  v_cvt_pk_bf16_f32 v26, v26, v26
  v_and_b32 v26, 0xffff0000, v26
  v_lshlrev_b32 v20, 2, v1
  v_add_u32 v20, 2629632, v20
  v_mov_b32 v21, 1073741824
  v_cmp_gt_u32 vcc, 16, v1
  v_add_u32 v25, 1, v25
  v_or_b32 v26, 1, v26
  v_cndmask_b32 v20, v21, v20, vcc
  v_cmp_gt_u32 vcc, 8, v1
  s_nop 1
  v_cndmask_b32 v26, v26, v25, vcc
  buffer_store_dword v26, v20, s[40:43], 0 offen sc1
  s_branch fa_notop
fa_hk0:
  s_getpc_b64 s[38:39]
fa_hp0:
  s_add_u32 s36, s36, 4
  s_addc_u32 s37, s37, 0
  s_sub_u32 s38, s38, fa_hp0-fa_hb0
  s_subb_u32 s39, s39, 0
  s_setpc_b64 s[36:37]
fa_hk1:
  s_getpc_b64 s[38:39]
fa_hp1:
  s_add_u32 s36, s36, 4
  s_addc_u32 s37, s37, 0
  s_sub_u32 s38, s38, fa_hp1-fa_hb1
  s_subb_u32 s39, s39, 0
  s_setpc_b64 s[36:37]
fa_sel_spin:
  s_mov_b32 s83, 200000
fa_sel_spin2:
  buffer_load_dword v15, v12, s[40:43], 0 offen sc1
  s_waitcnt vmcnt(0)
  v_cmp_eq_u32 vcc, 0, v15
  s_cbranch_vccz fa_sel_ok
  s_sleep 8
  s_sub_u32 s83, s83, 1
  s_cmp_lg_u32 s83, 0
  s_cbranch_scc1 fa_sel_spin2
  s_branch fa_sel_ok
fa_wof_spin:
  s_mov_b32 s83, 200000
fa_wof_spin2:
  buffer_load_dword v8, v9, s[40:43], 0 offen sc1
  s_waitcnt vmcnt(0)
  v_cmp_eq_u32 vcc, 0, v8
  s_cbranch_vccz fa_wof_ok
  s_sleep 8
  s_sub_u32 s83, s83, 1
  s_cmp_lg_u32 s83, 0
  s_cbranch_scc1 fa_wof_spin2
  s_branch fa_wof_ok
fa_sel4_spin:
  s_mov_b32 s83, 200000
fa_sel4_spin2:
  buffer_load_dword v15, v10, s[40:43], 0 offen sc1
  s_waitcnt vmcnt(0)
  v_cmp_eq_u32 vcc, 0, v15
  s_cbranch_vccz fa_sel4_ok
  s_sleep 8
  s_sub_u32 s83, s83, 1
  s_cmp_lg_u32 s83, 0
  s_cbranch_scc1 fa_sel4_spin2
  s_branch fa_sel4_ok
fa_yf_spin:
  s_mov_b32 s83, 200000
fa_yf_spin2:
  buffer_load_dword v14, v11, s[40:43], 0 offen sc1
  s_waitcnt vmcnt(0)
  v_cmp_eq_u32 vcc, 0, v14
  s_cbranch_vccz fa_yf_ok
  s_sleep 8
  s_sub_u32 s83, s83, 1
  s_cmp_lg_u32 s83, 0
  s_cbranch_scc1 fa_yf_spin2
  s_branch fa_yf_ok
fa_co:
  s_waitcnt vmcnt(8)
  ds_read_b64_tr_b16 v[232:233], v6 offset:0
  ds_read_b64_tr_b16 v[234:235], v6 offset:2560
  ds_read_b64_tr_b16 v[236:237], v6 offset:32
  ds_read_b64_tr_b16 v[238:239], v6 offset:2592
  ds_read_b64_tr_b16 v[240:241], v6 offset:64
  ds_read_b64_tr_b16 v[242:243], v6 offset:2624
  ds_read_b64_tr_b16 v[244:245], v6 offset:96
  ds_read_b64_tr_b16 v[246:247], v6 offset:2656
  ds_read_b64_tr_b16 v[248:249], v6 offset:128
  ds_read_b64_tr_b16 v[250:251], v6 offset:2688
  s_sub_u32 s14, s2, 192
  s_cmp_lt_u32 s14, 54
  s_cbranch_scc1 fa_coF
  s_sub_u32 s14, s2, 64
  s_cmp_lt_u32 s14, 128
  s_cbranch_scc1 fa_coT
  s_getpc_b64 s[36:37]
  s_setpc_b64 s[38:39]
  s_add_u32 s31, s30, 4096
  buffer_store_dwordx4 v[232:235], v2, s[40:43], s30 offen offset:0 sc1
  buffer_store_dwordx4 v[236:239], v2, s[40:43], s30 offen offset:1024 sc1
  buffer_store_dwordx4 v[240:243], v2, s[40:43], s30 offen offset:2048 sc1
  buffer_store_dwordx4 v[244:247], v2, s[40:43], s30 offen offset:3072 sc1
  buffer_store_dwordx4 v[248:251], v2, s[40:43], s31 offen offset:0 sc1
  s_getpc_b64 s[36:37]
  s_setpc_b64 s[38:39]
  s_getpc_b64 s[36:37]
  s_setpc_b64 s[38:39]
  s_and_b32 s23, s2, 1
  s_lshl_b32 s23, s23, 2
  s_add_u32 s23, s23, s20
  s_lshl_b32 s23, s23, 7
  s_lshr_b32 s31, s2, 1
  s_add_u32 s23, s23, s31
  s_lshl_b32 s23, s23, 2
  s_add_u32 s23, s23, 2654208
  v_mov_b32 v16, 1073741824
  v_mov_b32 v17, 1
  v_writelane_b32 v16, s23, 0
  s_waitcnt vmcnt(8)
  buffer_store_dword v17, v16, s[40:43], 0 offen sc1
  s_branch fa_coW
fa_coT:
  v_min_u32 v8, 16, v1
  v_lshlrev_b32 v8, 7, v8
  s_lshl_b32 s33, s14, 1
  s_and_b32 s31, s20, 1
  s_add_u32 s33, s33, s31
  s_mul_i32 s33, s33, 2176
  s_lshl_b32 s35, s14, 2
  s_add_u32 s35, s35, s20
  s_mul_i32 s35, s35, 4352
  buffer_load_dword v255, v8, s[52:55], s33 offen
  s_add_u32 s33, s33, 552960
  s_getpc_b64 s[36:37]
  s_setpc_b64 s[38:39]
  s_add_u32 s31, s30, 4096
  buffer_store_dwordx4 v[232:235], v2, s[40:43], s30 offen offset:0 sc1
  buffer_store_dwordx4 v[236:239], v2, s[40:43], s30 offen offset:1024 sc1
  buffer_store_dwordx4 v[240:243], v2, s[40:43], s30 offen offset:2048 sc1
  buffer_store_dwordx4 v[244:247], v2, s[40:43], s30 offen offset:3072 sc1
  buffer_store_dwordx4 v[248:251], v2, s[40:43], s31 offen offset:0 sc1
  buffer_load_dword v255, v8, s[52:55], s33 offen
  s_add_u32 s33, s33, 552960
  s_getpc_b64 s[36:37]
  s_setpc_b64 s[38:39]
  buffer_load_dword v255, v8, s[52:55], s33 offen
  s_add_u32 s33, s33, 552960
  s_getpc_b64 s[36:37]
  s_setpc_b64 s[38:39]
  s_and_b32 s23, s2, 1
  s_lshl_b32 s23, s23, 2
  s_add_u32 s23, s23, s20
  s_lshl_b32 s23, s23, 7
  s_lshr_b32 s31, s2, 1
  s_add_u32 s23, s23, s31
  s_lshl_b32 s23, s23, 2
  s_add_u32 s23, s23, 2654208
  v_mov_b32 v16, 1073741824
  v_mov_b32 v17, 1
  v_writelane_b32 v16, s23, 0
  s_waitcnt vmcnt(10)
  buffer_store_dword v17, v16, s[40:43], 0 offen sc1
  buffer_load_dword v255, v8, s[52:55], s33 offen
  s_add_u32 s33, s33, 552960
  s_getpc_b64 s[36:37]
  s_setpc_b64 s[38:39]
  buffer_load_dword v255, v8, s[60:63], s35 offen
  s_getpc_b64 s[36:37]
  s_setpc_b64 s[38:39]
  buffer_load_dword v255, v8, s[60:63], s35 offen offset:2176
  s_branch fa_coW
fa_coF:
  s_getpc_b64 s[36:37]
  s_setpc_b64 s[38:39]
  s_add_u32 s31, s30, 4096
  buffer_store_dwordx4 v[232:235], v2, s[40:43], s30 offen offset:0 sc1
  buffer_store_dwordx4 v[236:239], v2, s[40:43], s30 offen offset:1024 sc1
  buffer_store_dwordx4 v[240:243], v2, s[40:43], s30 offen offset:2048 sc1
  buffer_store_dwordx4 v[244:247], v2, s[40:43], s30 offen offset:3072 sc1
  buffer_store_dwordx4 v[248:251], v2, s[40:43], s31 offen offset:0 sc1
  s_lshl_b32 s33, s14, 6
  s_and_b32 s31, s20, 1
  s_lshl_b32 s31, s31, 5
  s_add_u32 s33, s33, s31
  s_mul_i32 s35, s14, 40960
  s_mul_i32 s31, s20, 320
  s_add_u32 s35, s35, s31
  s_mul_i32 s10, s14, 20480
  s_mul_i32 s31, s20, 640
  s_add_u32 s10, s10, s31
  s_add_u32 s10, s10, 2686976
  s_getpc_b64 s[36:37]
  s_setpc_b64 s[38:39]
  v_and_b32 v11, 7, v1
  v_lshlrev_b32 v12, 2, v11
  v_add_u32 v12, 2629632, v12
  buffer_load_dword v15, v12, s[40:43], 0 offen sc1
  v_lshrrev_b32 v17, 1, v1
  v_mul_u32_u24 v8, 3456, v17
  v_and_b32 v17, 1, v1
  v_lshl_add_u32 v8, v17, 4, v8
  v_lshrrev_b32 v17, 4, v1
  v_lshrrev_b32 v18, 2, v1
  v_lshl_add_u32 v18, v17, 2, v18
  v_lshlrev_b32 v18, 5, v18
  v_and_b32 v19, 3, v1
  v_lshl_add_u32 v9, v19, 3, v18
  v_add_u32 v9, s34, v9
  v_lshlrev_b32 v10, 4, v11
  v_lshl_add_u32 v10, v17, 7, v10
  v_add_u32 v10, 151552, v10
  v_and_b32 v18, 8, v1
  v_mul_u32_u24 v11, 2560, v11
  v_lshl_add_u32 v11, v17, 4, v11
  v_lshl_add_u32 v11, v18, 27, v11
  s_getpc_b64 s[36:37]
  s_setpc_b64 s[38:39]
  s_and_b32 s23, s2, 1
  s_lshl_b32 s23, s23, 2
  s_add_u32 s23, s23, s20
  s_lshl_b32 s23, s23, 7
  s_lshr_b32 s31, s2, 1
  s_add_u32 s23, s23, s31
  s_lshl_b32 s23, s23, 2
  s_add_u32 s23, s23, 2654208
  v_mov_b32 v16, 1073741824
  v_mov_b32 v17, 1
  v_writelane_b32 v16, s23, 0
  s_waitcnt vmcnt(9)
  buffer_store_dword v17, v16, s[40:43], 0 offen sc1
  s_add_u32 m0, s34, 0
  s_nop 0
  buffer_load_dwordx4 v8, s[52:55], s33 offen lds
  s_add_u32 s33, s33, 110592
  s_add_u32 m0, s34, 1024
  s_nop 0
  buffer_load_dwordx4 v8, s[52:55], s33 offen lds
  s_add_u32 s33, s33, 110592
  s_add_u32 m0, s34, 2048
  s_nop 0
  buffer_load_dwordx4 v8, s[52:55], s33 offen lds
  s_add_u32 s33, s33, 110592
  s_add_u32 m0, s34, 3072
  s_nop 0
  buffer_load_dwordx4 v8, s[52:55], s33 offen lds
  s_add_u32 s33, s33, 110592
  s_add_u32 m0, s34, 4096
  s_nop 0
  buffer_load_dwordx4 v8, s[52:55], s33 offen lds
  s_add_u32 s33, s33, 110592
  s_getpc_b64 s[36:37]
  s_setpc_b64 s[38:39]
  s_waitcnt vmcnt(14)
  v_cmp_eq_u32 vcc, 0, v15
  s_cbranch_vccnz fa_sel_spin
fa_sel_ok:
  v_add_u32 v18, -1, v15
  v_and_b32 v18, 2047, v18
  v_lshrrev_b32 v19, 4, v18
  v_mul_u32_u24 v19, 20480, v19
  v_and_b32 v18, 15, v18
  v_lshl_add_u32 v19, v18, 4, v19
  v_lshrrev_b32 v18, 3, v1
  v_lshl_add_u32 v19, v18, 8, v19
  s_lshl_b32 s23, s20, 11
  s_lshl_b32 s31, s20, 10
  s_add_u32 s31, s31, 151552
  s_mov_b32 m0, s31
  s_add_u32 s31, s31, 4096
  buffer_load_dwordx4 v19, s[40:43], s23 offen sc1 lds
  s_add_u32 s23, s23, 8192
  s_mov_b32 m0, s31
  s_add_u32 s31, s31, 4096
  buffer_load_dwordx4 v19, s[40:43], s23 offen sc1 lds
  s_add_u32 s23, s23, 8192
  s_mov_b32 m0, s31
  s_add_u32 s31, s31, 4096
  buffer_load_dwordx4 v19, s[40:43], s23 offen sc1 lds
  s_add_u32 s23, s23, 8192
  s_getpc_b64 s[36:37]
  s_setpc_b64 s[38:39]
  s_waitcnt vmcnt(4)
  s_getpc_b64 s[36:37]
  s_setpc_b64 s[38:39]
  ds_read_b64_tr_b16 a[192:193], v9 offset:0
  ds_read_b64_tr_b16 a[194:195], v9 offset:128
  ds_read_b128 a[212:215], v10 offset:0
  ds_read_b64_tr_b16 a[196:197], v9 offset:1024
  ds_read_b64_tr_b16 a[198:199], v9 offset:1152
  ds_read_b128 a[216:219], v10 offset:512
  ds_read_b64_tr_b16 a[200:201], v9 offset:2048
  ds_read_b64_tr_b16 a[202:203], v9 offset:2176
  ds_read_b128 a[220:223], v10 offset:1024
  ds_read_b64_tr_b16 a[204:205], v9 offset:3072
  ds_read_b64_tr_b16 a[206:207], v9 offset:3200
  ds_read_b128 a[224:227], v10 offset:1536
  ds_read_b64_tr_b16 a[208:209], v9 offset:4096
  ds_read_b64_tr_b16 a[210:211], v9 offset:4224
  ds_read_b128 a[228:231], v10 offset:2048
  s_getpc_b64 s[36:37]
  s_setpc_b64 s[38:39]
  v_mfma_f32_16x16x32_bf16 v[232:235], a[192:195], a[212:215], 0
  v_mfma_f32_16x16x32_bf16 v[232:235], a[196:199], a[216:219], v[232:235]
  v_mfma_f32_16x16x32_bf16 v[232:235], a[200:203], a[220:223], v[232:235]
  v_mfma_f32_16x16x32_bf16 v[232:235], a[204:207], a[224:227], v[232:235]
  v_mfma_f32_16x16x32_bf16 v[232:235], a[208:211], a[228:231], v[232:235]
  s_add_u32 m0, s34, 0
  s_nop 0
  buffer_load_dwordx4 v8, s[52:55], s33 offen lds
  s_add_u32 s33, s33, 110592
  s_add_u32 m0, s34, 1024
  s_nop 0
  buffer_load_dwordx4 v8, s[52:55], s33 offen lds
  s_add_u32 s33, s33, 110592
  s_add_u32 m0, s34, 2048
  s_nop 0
  buffer_load_dwordx4 v8, s[52:55], s33 offen lds
  s_add_u32 s33, s33, 110592
  s_add_u32 m0, s34, 3072
  s_nop 0
  buffer_load_dwordx4 v8, s[52:55], s33 offen lds
  s_add_u32 s33, s33, 110592
  s_add_u32 m0, s34, 4096
  s_nop 0
  buffer_load_dwordx4 v8, s[52:55], s33 offen lds
  s_add_u32 s33, s33, 110592
  s_getpc_b64 s[36:37]
  s_setpc_b64 s[38:39]
  s_getpc_b64 s[36:37]
  s_setpc_b64 s[38:39]
  s_waitcnt vmcnt(8)
  ds_read_b64_tr_b16 a[192:193], v9 offset:0
  ds_read_b64_tr_b16 a[194:195], v9 offset:128
  ds_read_b128 a[212:215], v10 offset:2560
  ds_read_b64_tr_b16 a[196:197], v9 offset:1024
  ds_read_b64_tr_b16 a[198:199], v9 offset:1152
  ds_read_b128 a[216:219], v10 offset:3072
  ds_read_b64_tr_b16 a[200:201], v9 offset:2048
  ds_read_b64_tr_b16 a[202:203], v9 offset:2176
  ds_read_b128 a[220:223], v10 offset:3584
  ds_read_b64_tr_b16 a[204:205], v9 offset:3072
  ds_read_b64_tr_b16 a[206:207], v9 offset:3200
  ds_read_b128 a[224:227], v10 offset:4096
  ds_read_b64_tr_b16 a[208:209], v9 offset:4096
  ds_read_b64_tr_b16 a[210:211], v9 offset:4224
  ds_read_b128 a[228:231], v10 offset:4608
  s_getpc_b64 s[36:37]
  s_setpc_b64 s[38:39]
  v_mfma_f32_16x16x32_bf16 v[232:235], a[192:195], a[212:215], v[232:235]
  v_mfma_f32_16x16x32_bf16 v[232:235], a[196:199], a[216:219], v[232:235]
  v_mfma_f32_16x16x32_bf16 v[232:235], a[200:203], a[220:223], v[232:235]
  v_mfma_f32_16x16x32_bf16 v[232:235], a[204:207], a[224:227], v[232:235]
  v_mfma_f32_16x16x32_bf16 v[232:235], a[208:211], a[228:231], v[232:235]
  s_add_u32 m0, s34, 0
  s_nop 0
  buffer_load_dwordx4 v8, s[52:55], s33 offen lds
  s_add_u32 s33, s33, 110592
  s_add_u32 m0, s34, 1024
  s_nop 0
  buffer_load_dwordx4 v8, s[52:55], s33 offen lds
  s_add_u32 s33, s33, 110592
  s_add_u32 m0, s34, 2048
  s_nop 0
  buffer_load_dwordx4 v8, s[52:55], s33 offen lds
  s_add_u32 s33, s33, 110592
  s_add_u32 m0, s34, 3072
  s_nop 0
  buffer_load_dwordx4 v8, s[52:55], s33 offen lds
  s_add_u32 s33, s33, 110592
  s_add_u32 m0, s34, 4096
  s_nop 0
  buffer_load_dwordx4 v8, s[52:55], s33 offen lds
  s_add_u32 s33, s33, 110592
  s_getpc_b64 s[36:37]
  s_setpc_b64 s[38:39]
  s_getpc_b64 s[36:37]
  s_setpc_b64 s[38:39]
  s_waitcnt vmcnt(8)
  ds_read_b64_tr_b16 a[192:193], v9 offset:0
  ds_read_b64_tr_b16 a[194:195], v9 offset:128
  ds_read_b128 a[212:215], v10 offset:5120
  ds_read_b64_tr_b16 a[196:197], v9 offset:1024
  ds_read_b64_tr_b16 a[198:199], v9 offset:1152
  ds_read_b128 a[216:219], v10 offset:5632
  ds_read_b64_tr_b16 a[200:201], v9 offset:2048
  ds_read_b64_tr_b16 a[202:203], v9 offset:2176
  ds_read_b128 a[220:223], v10 offset:6144
  ds_read_b64_tr_b16 a[204:205], v9 offset:3072
  ds_read_b64_tr_b16 a[206:207], v9 offset:3200
  ds_read_b128 a[224:227], v10 offset:6656
  ds_read_b64_tr_b16 a[208:209], v9 offset:4096
  ds_read_b64_tr_b16 a[210:211], v9 offset:4224
  ds_read_b128 a[228:231], v10 offset:7168
  s_getpc_b64 s[36:37]
  s_setpc_b64 s[38:39]
  v_mfma_f32_16x16x32_bf16 v[232:235], a[192:195], a[212:215], v[232:235]
  v_mfma_f32_16x16x32_bf16 v[232:235], a[196:199], a[216:219], v[232:235]
  v_mfma_f32_16x16x32_bf16 v[232:235], a[200:203], a[220:223], v[232:235]
  v_mfma_f32_16x16x32_bf16 v[232:235], a[204:207], a[224:227], v[232:235]
  v_mfma_f32_16x16x32_bf16 v[232:235], a[208:211], a[228:231], v[232:235]
  s_add_u32 m0, s34, 0
  s_nop 0
  buffer_load_dwordx4 v8, s[52:55], s33 offen lds
  s_add_u32 s33, s33, 110592
  s_add_u32 m0, s34, 1024
  s_nop 0
  buffer_load_dwordx4 v8, s[52:55], s33 offen lds
  s_add_u32 s33, s33, 110592
  s_add_u32 m0, s34, 2048
  s_nop 0
  buffer_load_dwordx4 v8, s[52:55], s33 offen lds
  s_add_u32 s33, s33, 110592
  s_add_u32 m0, s34, 3072
  s_nop 0
  buffer_load_dwordx4 v8, s[52:55], s33 offen lds
  s_add_u32 s33, s33, 110592
  s_add_u32 m0, s34, 4096
  s_nop 0
  buffer_load_dwordx4 v8, s[52:55], s33 offen lds
  s_add_u32 s33, s33, 110592
  s_getpc_b64 s[36:37]
  s_setpc_b64 s[38:39]
  s_getpc_b64 s[36:37]
  s_setpc_b64 s[38:39]
  s_waitcnt vmcnt(8)
  ds_read_b64_tr_b16 a[192:193], v9 offset:0
  ds_read_b64_tr_b16 a[194:195], v9 offset:128
  ds_read_b128 a[212:215], v10 offset:7680
  ds_read_b64_tr_b16 a[196:197], v9 offset:1024
  ds_read_b64_tr_b16 a[198:199], v9 offset:1152
  ds_read_b128 a[216:219], v10 offset:8192
  ds_read_b64_tr_b16 a[200:201], v9 offset:2048
  ds_read_b64_tr_b16 a[202:203], v9 offset:2176
  ds_read_b128 a[220:223], v10 offset:8704
  ds_read_b64_tr_b16 a[204:205], v9 offset:3072
  ds_read_b64_tr_b16 a[206:207], v9 offset:3200
  ds_read_b128 a[224:227], v10 offset:9216
  ds_read_b64_tr_b16 a[208:209], v9 offset:4096
  ds_read_b64_tr_b16 a[210:211], v9 offset:4224
  ds_read_b128 a[228:231], v10 offset:9728
  s_getpc_b64 s[36:37]
  s_setpc_b64 s[38:39]
  v_mfma_f32_16x16x32_bf16 v[232:235], a[192:195], a[212:215], v[232:235]
  v_mfma_f32_16x16x32_bf16 v[232:235], a[196:199], a[216:219], v[232:235]
  v_mfma_f32_16x16x32_bf16 v[232:235], a[200:203], a[220:223], v[232:235]
  v_mfma_f32_16x16x32_bf16 v[232:235], a[204:207], a[224:227], v[232:235]
  v_mfma_f32_16x16x32_bf16 v[232:235], a[208:211], a[228:231], v[232:235]
  s_add_u32 m0, s34, 0
  v_accvgpr_read_b32 v19, a248
  buffer_load_dwordx4 v19, s[60:63], s35 offen lds
  s_add_u32 m0, s34, 1024
  v_accvgpr_read_b32 v19, a249
  buffer_load_dwordx4 v19, s[60:63], s35 offen lds
  s_add_u32 m0, s34, 2048
  v_accvgpr_read_b32 v19, a250
  buffer_load_dwordx4 v19, s[60:63], s35 offen lds
  s_add_u32 m0, s34, 3072
  v_accvgpr_read_b32 v19, a251
  buffer_load_dwordx4 v19, s[60:63], s35 offen lds
  s_add_u32 m0, s34, 4096
  v_accvgpr_read_b32 v19, a252
  buffer_load_dwordx4 v19, s[60:63], s35 offen lds
  s_add_u32 s35, s35, 160
  s_lshl_b32 s23, s20, 9
  v_add_u32 v16, s23, v10
  ds_write_b128 v16, v[232:235] offset:10240
  s_getpc_b64 s[36:37]
  s_setpc_b64 s[38:39]
  s_getpc_b64 s[36:37]
  s_setpc_b64 s[38:39]
  ds_read_b128 v[236:239], v10 offset:10240
  ds_read_b128 v[240:243], v10 offset:10752
  ds_read_b128 v[244:247], v10 offset:11264
  ds_read_b128 v[248:251], v10 offset:11776
  s_waitcnt vmcnt(8)
  ds_read_b64_tr_b16 a[192:193], v6 offset:0
  ds_read_b64_tr_b16 a[194:195], v6 offset:2560
  ds_read_b64_tr_b16 a[196:197], v6 offset:32
  ds_read_b64_tr_b16 a[198:199], v6 offset:2592
  ds_read_b64_tr_b16 a[200:201], v6 offset:64
  ds_read_b64_tr_b16 a[202:203], v6 offset:2624
  ds_read_b64_tr_b16 a[204:205], v6 offset:96
  ds_read_b64_tr_b16 a[206:207], v6 offset:2656
  ds_read_b64_tr_b16 a[208:209], v6 offset:128
  ds_read_b64_tr_b16 a[210:211], v6 offset:2688
  s_getpc_b64 s[36:37]
  s_setpc_b64 s[38:39]
  v_cvt_pk_bf16_f32 v236, v236, v244
  v_cvt_pk_bf16_f32 v237, v237, v245
  v_cvt_pk_bf16_f32 v238, v238, v246
  v_cvt_pk_bf16_f32 v239, v239, v247
  v_cvt_pk_bf16_f32 v240, v240, v248
  v_cvt_pk_bf16_f32 v241, v241, v249
  v_cvt_pk_bf16_f32 v242, v242, v250
  v_cvt_pk_bf16_f32 v243, v243, v251
  v_lshlrev_b32 v244, 16, v236
  v_lshlrev_b32 v245, 16, v237
  v_lshlrev_b32 v246, 16, v238
  v_lshlrev_b32 v247, 16, v239
  v_lshlrev_b32 v248, 16, v240
  v_lshlrev_b32 v249, 16, v241
  v_lshlrev_b32 v250, 16, v242
  v_lshlrev_b32 v251, 16, v243
  v_mul_f32 v16, 0xbfb8aa3b, v244
  v_mul_f32 v17, 0xbfb8aa3b, v245
  v_mul_f32 v18, 0xbfb8aa3b, v246
  v_mul_f32 v19, 0xbfb8aa3b, v247
  v_mul_f32 v20, 0xbfb8aa3b, v248
  v_mul_f32 v21, 0xbfb8aa3b, v249
  v_mul_f32 v22, 0xbfb8aa3b, v250
  v_mul_f32 v23, 0xbfb8aa3b, v251
  v_exp_f32 v16, v16
  v_exp_f32 v17, v17
  v_exp_f32 v18, v18
  v_exp_f32 v19, v19
  v_exp_f32 v20, v20
  v_exp_f32 v21, v21
  v_exp_f32 v22, v22
  v_exp_f32 v23, v23
  v_add_f32 v16, 1.0, v16
  v_add_f32 v17, 1.0, v17
  v_add_f32 v18, 1.0, v18
  v_add_f32 v19, 1.0, v19
  v_add_f32 v20, 1.0, v20
  v_add_f32 v21, 1.0, v21
  v_add_f32 v22, 1.0, v22
  v_add_f32 v23, 1.0, v23
  v_rcp_f32 v16, v16
  v_rcp_f32 v17, v17
  v_rcp_f32 v18, v18
  v_rcp_f32 v19, v19
  v_rcp_f32 v20, v20
  v_rcp_f32 v21, v21
  v_rcp_f32 v22, v22
  v_rcp_f32 v23, v23
  v_mul_f32 v244, v244, v16
  v_mul_f32 v245, v245, v17
  v_mul_f32 v246, v246, v18
  v_mul_f32 v247, v247, v19
  v_mul_f32 v248, v248, v20
  v_mul_f32 v249, v249, v21
  v_mul_f32 v250, v250, v22
  v_mul_f32 v251, v251, v23
  v_cvt_pk_bf16_f32 v16, v244, v245
  v_cvt_pk_bf16_f32 v17, v246, v247
  v_cvt_pk_bf16_f32 v18, v248, v249
  v_cvt_pk_bf16_f32 v19, v250, v251
  v_and_b32 v236, 0xffff0000, v236
  v_and_b32 v237, 0xffff0000, v237
  v_and_b32 v238, 0xffff0000, v238
  v_and_b32 v239, 0xffff0000, v239
  v_and_b32 v240, 0xffff0000, v240
  v_and_b32 v241, 0xffff0000, v241
  v_and_b32 v242, 0xffff0000, v242
  v_and_b32 v243, 0xffff0000, v243
  v_lshlrev_b32 v244, 16, v16
  v_and_b32 v245, 0xffff0000, v16
  v_lshlrev_b32 v246, 16, v17
  v_and_b32 v247, 0xffff0000, v17
  v_lshlrev_b32 v248, 16, v18
  v_and_b32 v249, 0xffff0000, v18
  v_lshlrev_b32 v250, 16, v19
  v_and_b32 v251, 0xffff0000, v19
  v_mul_f32 v236, v236, v244
  v_mul_f32 v237, v237, v245
  v_mul_f32 v238, v238, v246
  v_mul_f32 v239, v239, v247
  v_mul_f32 v240, v240, v248
  v_mul_f32 v241, v241, v249
  v_mul_f32 v242, v242, v250
  v_mul_f32 v243, v243, v251
  v_cvt_pk_bf16_f32 v232, v236, v237
  v_cvt_pk_bf16_f32 v233, v238, v239
  v_cvt_pk_bf16_f32 v234, v240, v241
  v_cvt_pk_bf16_f32 v235, v242, v243
  s_nop 1
  v_mfma_f32_16x16x32_bf16 v[236:239], a[192:195], v[232:235], 0
  v_mfma_f32_16x16x32_bf16 v[240:243], a[196:199], v[232:235], 0
  v_mfma_f32_16x16x32_bf16 v[244:247], a[200:203], v[232:235], 0
  v_mfma_f32_16x16x32_bf16 v[248:251], a[204:207], v[232:235], 0
  v_mfma_f32_16x16x32_bf16 v[252:255], a[208:211], v[232:235], 0
  s_add_u32 m0, s34, 0
  v_accvgpr_read_b32 v19, a248
  buffer_load_dwordx4 v19, s[60:63], s35 offen lds
  s_add_u32 m0, s34, 1024
  v_accvgpr_read_b32 v19, a249
  buffer_load_dwordx4 v19, s[60:63], s35 offen lds
  s_add_u32 m0, s34, 2048
  v_accvgpr_read_b32 v19, a250
  buffer_load_dwordx4 v19, s[60:63], s35 offen lds
  s_add_u32 m0, s34, 3072
  v_accvgpr_read_b32 v19, a251
  buffer_load_dwordx4 v19, s[60:63], s35 offen lds
  s_add_u32 m0, s34, 4096
  v_accvgpr_read_b32 v19, a252
  buffer_load_dwordx4 v19, s[60:63], s35 offen lds
  s_add_u32 s35, s35, 160
  buffer_store_dwordx4 v[236:239], v11, s[40:43], s10 offen offset:0 sc1
  buffer_store_dwordx4 v[240:243], v11, s[40:43], s10 offen offset:64 sc1
  buffer_store_dwordx4 v[244:247], v11, s[40:43], s10 offen offset:128 sc1
  buffer_store_dwordx4 v[248:251], v11, s[40:43], s10 offen offset:192 sc1
  buffer_store_dwordx4 v[252:255], v11, s[40:43], s10 offen offset:256 sc1
  s_add_u32 s10, s10, 320
  s_getpc_b64 s[36:37]
  s_setpc_b64 s[38:39]
  s_getpc_b64 s[36:37]
  s_setpc_b64 s[38:39]
  s_waitcnt vmcnt(13)
  ds_read_b64_tr_b16 a[192:193], v6 offset:0
  ds_read_b64_tr_b16 a[194:195], v6 offset:2560
  ds_read_b64_tr_b16 a[196:197], v6 offset:32
  ds_read_b64_tr_b16 a[198:199], v6 offset:2592
  ds_read_b64_tr_b16 a[200:201], v6 offset:64
  ds_read_b64_tr_b16 a[202:203], v6 offset:2624
  ds_read_b64_tr_b16 a[204:205], v6 offset:96
  ds_read_b64_tr_b16 a[206:207], v6 offset:2656
  ds_read_b64_tr_b16 a[208:209], v6 offset:128
  ds_read_b64_tr_b16 a[210:211], v6 offset:2688
  s_waitcnt lgkmcnt(0)
  v_mfma_f32_16x16x32_bf16 v[236:239], a[192:195], v[232:235], 0
  v_mfma_f32_16x16x32_bf16 v[240:243], a[196:199], v[232:235], 0
  v_mfma_f32_16x16x32_bf16 v[244:247], a[200:203], v[232:235], 0
  v_mfma_f32_16x16x32_bf16 v[248:251], a[204:207], v[232:235], 0
  v_mfma_f32_16x16x32_bf16 v[252:255], a[208:211], v[232:235], 0
  s_nop 7
  buffer_store_dwordx4 v[236:239], v11, s[40:43], s10 offen offset:0 sc1
  buffer_store_dwordx4 v[240:243], v11, s[40:43], s10 offen offset:64 sc1
  buffer_store_dwordx4 v[244:247], v11, s[40:43], s10 offen offset:128 sc1
  buffer_store_dwordx4 v[248:251], v11, s[40:43], s10 offen offset:192 sc1
  buffer_store_dwordx4 v[252:255], v11, s[40:43], s10 offen offset:256 sc1
  s_add_u32 s10, s10, 320
  s_getpc_b64 s[36:37]
  s_setpc_b64 s[38:39]
  s_and_b32 s23, s2, 63
  s_lshl_b32 s31, s20, 6
  s_add_u32 s23, s23, s31
  s_lshl_b32 s23, s23, 2
  s_add_u32 s23, s23, 2650112
  v_mov_b32 v16, 1073741824
  v_mov_b32 v17, 1
  v_writelane_b32 v16, s23, 0
  s_waitcnt vmcnt(4)
  buffer_store_dword v17, v16, s[40:43], 0 offen sc1
fa_coW:
  s_mov_b32 s12, 1
  s_cmp_lg_u32 s11, 0
  s_cselect_b32 s32, s15, -1
  s_getpc_b64 s[36:37]
  s_setpc_b64 s[38:39]
  s_lshl_b32 s23, s22, 2
  s_add_u32 s23, s23, s20
  s_mul_i32 s13, s23, 163840
  s_add_u32 s13, s13, 4194304
  s_lshl_b32 s23, s23, 7
  s_add_u32 s23, s23, 2654208
  v_and_b32 v9, 31, v1
  v_lshl_add_u32 v9, v9, 2, s23
  v_and_b32 v10, 15, v1
  v_lshlrev_b32 v10, 2, v10
  v_add_u32 v10, 2629632, v10
  buffer_load_dword v8, v9, s[40:43], 0 offen sc1
  buffer_load_dword v15, v10, s[40:43], 0 offen sc1
  v_mov_b32 v20, v228
  v_mov_b32 v21, v229
  s_nop 1
  v_permlane16_swap_b32 v228, v20
  v_permlane16_swap_b32 v229, v21
  v_add_f32 v228, v228, v20
  v_add_f32 v229, v229, v21
  v_mov_b32 v20, v228
  v_mov_b32 v21, v229
  s_nop 1
  v_permlane32_swap_b32 v228, v20
  v_permlane32_swap_b32 v229, v21
  v_add_f32 v228, v228, v20
  v_add_f32 v229, v229, v21
  v_rcp_f32 v16, v228
  v_rcp_f32 v18, v229
  s_lshl_b32 s23, s22, 2
  v_mov_b32 v17, v16
  v_mov_b32 v19, v18
  s_add_u32 s23, s23, s20
  s_lshl_b32 s23, s23, 18
  s_lshl_b32 s31, s21, 12
  s_add_u32 s31, s31, 50331648
  s_add_u32 s64, s23, s31
  s_add_u32 s65, s64, 131072
  v_accvgpr_read_b32 v36, a0
  v_accvgpr_read_b32 v37, a1
  v_accvgpr_read_b32 v38, a2
  v_accvgpr_read_b32 v39, a3
  v_accvgpr_read_b32 v40, a8
  v_accvgpr_read_b32 v41, a9
  v_accvgpr_read_b32 v42, a10
  v_accvgpr_read_b32 v43, a11
  v_pk_mul_f32 v[36:37], v[36:37], v[16:17]
  v_pk_mul_f32 v[38:39], v[38:39], v[16:17]
  v_pk_mul_f32 v[40:41], v[40:41], v[16:17]
  v_pk_mul_f32 v[42:43], v[42:43], v[16:17]
  v_cvt_pk_bf16_f32 v32, v36, v37
  v_cvt_pk_bf16_f32 v33, v38, v39
  v_cvt_pk_bf16_f32 v34, v40, v41
  v_cvt_pk_bf16_f32 v35, v42, v43
  buffer_store_dwordx4 v[32:35], v2, s[40:43], s64 offen offset:0 sc1
  v_accvgpr_read_b32 v48, a16
  v_accvgpr_read_b32 v49, a17
  v_accvgpr_read_b32 v50, a18
  v_accvgpr_read_b32 v51, a19
  v_accvgpr_read_b32 v52, a24
  v_accvgpr_read_b32 v53, a25
  v_accvgpr_read_b32 v54, a26
  v_accvgpr_read_b32 v55, a27
  v_pk_mul_f32 v[48:49], v[48:49], v[16:17]
  v_pk_mul_f32 v[50:51], v[50:51], v[16:17]
  v_pk_mul_f32 v[52:53], v[52:53], v[16:17]
  v_pk_mul_f32 v[54:55], v[54:55], v[16:17]
  v_cvt_pk_bf16_f32 v44, v48, v49
  v_cvt_pk_bf16_f32 v45, v50, v51
  v_cvt_pk_bf16_f32 v46, v52, v53
  v_cvt_pk_bf16_f32 v47, v54, v55
  buffer_store_dwordx4 v[44:47], v2, s[40:43], s64 offen offset:1024 sc1
  v_accvgpr_read_b32 v100, a32
  v_accvgpr_read_b32 v101, a33
  v_accvgpr_read_b32 v102, a34
  v_accvgpr_read_b32 v103, a35
  v_accvgpr_read_b32 v104, a40
  v_accvgpr_read_b32 v105, a41
  v_accvgpr_read_b32 v106, a42
  v_accvgpr_read_b32 v107, a43
  v_pk_mul_f32 v[100:101], v[100:101], v[16:17]
  v_pk_mul_f32 v[102:103], v[102:103], v[16:17]
  v_pk_mul_f32 v[104:105], v[104:105], v[16:17]
  v_pk_mul_f32 v[106:107], v[106:107], v[16:17]
  v_cvt_pk_bf16_f32 v96, v100, v101
  v_cvt_pk_bf16_f32 v97, v102, v103
  v_cvt_pk_bf16_f32 v98, v104, v105
  v_cvt_pk_bf16_f32 v99, v106, v107
  buffer_store_dwordx4 v[96:99], v2, s[40:43], s64 offen offset:2048 sc1
  v_accvgpr_read_b32 v112, a48
  v_accvgpr_read_b32 v113, a49
  v_accvgpr_read_b32 v114, a50
  v_accvgpr_read_b32 v115, a51
  v_accvgpr_read_b32 v116, a56
  v_accvgpr_read_b32 v117, a57
  v_accvgpr_read_b32 v118, a58
  v_accvgpr_read_b32 v119, a59
  v_pk_mul_f32 v[112:113], v[112:113], v[16:17]
  v_pk_mul_f32 v[114:115], v[114:115], v[16:17]
  v_pk_mul_f32 v[116:117], v[116:117], v[16:17]
  v_pk_mul_f32 v[118:119], v[118:119], v[16:17]
  v_cvt_pk_bf16_f32 v108, v112, v113
  v_cvt_pk_bf16_f32 v109, v114, v115
  v_cvt_pk_bf16_f32 v110, v116, v117
  v_cvt_pk_bf16_f32 v111, v118, v119
  buffer_store_dwordx4 v[108:111], v2, s[40:43], s64 offen offset:3072 sc1
  v_accvgpr_read_b32 v36, a4
  v_accvgpr_read_b32 v37, a5
  v_accvgpr_read_b32 v38, a6
  v_accvgpr_read_b32 v39, a7
  v_accvgpr_read_b32 v40, a12
  v_accvgpr_read_b32 v41, a13
  v_accvgpr_read_b32 v42, a14
  v_accvgpr_read_b32 v43, a15
  v_pk_mul_f32 v[36:37], v[36:37], v[18:19]
  v_pk_mul_f32 v[38:39], v[38:39], v[18:19]
  v_pk_mul_f32 v[40:41], v[40:41], v[18:19]
  v_pk_mul_f32 v[42:43], v[42:43], v[18:19]
  v_cvt_pk_bf16_f32 v32, v36, v37
  v_cvt_pk_bf16_f32 v33, v38, v39
  v_cvt_pk_bf16_f32 v34, v40, v41
  v_cvt_pk_bf16_f32 v35, v42, v43
  buffer_store_dwordx4 v[32:35], v2, s[40:43], s65 offen offset:0 sc1
  v_accvgpr_read_b32 v48, a20
  v_accvgpr_read_b32 v49, a21
  v_accvgpr_read_b32 v50, a22
  v_accvgpr_read_b32 v51, a23
  v_accvgpr_read_b32 v52, a28
  v_accvgpr_read_b32 v53, a29
  v_accvgpr_read_b32 v54, a30
  v_accvgpr_read_b32 v55, a31
  v_pk_mul_f32 v[48:49], v[48:49], v[18:19]
  v_pk_mul_f32 v[50:51], v[50:51], v[18:19]
  v_pk_mul_f32 v[52:53], v[52:53], v[18:19]
  v_pk_mul_f32 v[54:55], v[54:55], v[18:19]
  v_cvt_pk_bf16_f32 v44, v48, v49
  v_cvt_pk_bf16_f32 v45, v50, v51
  v_cvt_pk_bf16_f32 v46, v52, v53
  v_cvt_pk_bf16_f32 v47, v54, v55
  buffer_store_dwordx4 v[44:47], v2, s[40:43], s65 offen offset:1024 sc1
  v_accvgpr_read_b32 v100, a36
  v_accvgpr_read_b32 v101, a37
  v_accvgpr_read_b32 v102, a38
  v_accvgpr_read_b32 v103, a39
  v_accvgpr_read_b32 v104, a44
  v_accvgpr_read_b32 v105, a45
  v_accvgpr_read_b32 v106, a46
  v_accvgpr_read_b32 v107, a47
  v_pk_mul_f32 v[100:101], v[100:101], v[18:19]
  v_pk_mul_f32 v[102:103], v[102:103], v[18:19]
  v_pk_mul_f32 v[104:105], v[104:105], v[18:19]
  v_pk_mul_f32 v[106:107], v[106:107], v[18:19]
  v_cvt_pk_bf16_f32 v96, v100, v101
  v_cvt_pk_bf16_f32 v97, v102, v103
  v_cvt_pk_bf16_f32 v98, v104, v105
  v_cvt_pk_bf16_f32 v99, v106, v107
  buffer_store_dwordx4 v[96:99], v2, s[40:43], s65 offen offset:2048 sc1
  v_accvgpr_read_b32 v112, a52
  v_accvgpr_read_b32 v113, a53
  v_accvgpr_read_b32 v114, a54
  v_accvgpr_read_b32 v115, a55
  v_accvgpr_read_b32 v116, a60
  v_accvgpr_read_b32 v117, a61
  v_accvgpr_read_b32 v118, a62
  v_accvgpr_read_b32 v119, a63
  v_pk_mul_f32 v[112:113], v[112:113], v[18:19]
  v_pk_mul_f32 v[114:115], v[114:115], v[18:19]
  v_pk_mul_f32 v[116:117], v[116:117], v[18:19]
  v_pk_mul_f32 v[118:119], v[118:119], v[18:19]
  v_cvt_pk_bf16_f32 v108, v112, v113
  v_cvt_pk_bf16_f32 v109, v114, v115
  v_cvt_pk_bf16_f32 v110, v116, v117
  v_cvt_pk_bf16_f32 v111, v118, v119
  buffer_store_dwordx4 v[108:111], v2, s[40:43], s65 offen offset:3072 sc1
  s_waitcnt vmcnt(8)
  v_cmp_eq_u32 vcc, 0, v8
  s_cbranch_vccnz fa_wof_spin
fa_wof_ok:
  v_cmp_eq_u32 vcc, 0, v15
  s_cbranch_vccnz fa_sel4_spin
fa_sel4_ok:
  s_lshl_b32 s23, s20, 1
  s_add_u32 s31, s23, 1
  v_readlane_b32 s33, v15, s23
  v_readlane_b32 s35, v15, s31
  s_lshl_b32 s31, s21, 6
  s_add_u32 s31, s31, 1
  s_sub_u32 s33, s33, s31
  s_sub_u32 s35, s35, s31
  s_cmp_lt_u32 s33, 64
  s_cselect_b32 s10, 1, 0
  s_cmp_lt_u32 s35, 64
  s_cselect_b32 s31, 2, 0
  s_or_b32 s10, s10, s31
  s_cbranch_scc0 fa_coEnd
  s_mov_b32 s12, 2
  s_add_u32 s32, s15, 65536
  s_getpc_b64 s[36:37]
  s_setpc_b64 s[38:39]
  v_min_u32 v11, 53, v1
  s_lshr_b32 s23, s22, 1
  s_lshl_b32 s23, s23, 8
  s_add_u32 s23, s23, 2650112
  v_lshl_add_u32 v11, v11, 2, s23
  v_mov_b32 v14, 0
  v_cmp_eq_u32 vcc, 0, v14
  s_cbranch_vccnz fa_yf_spin
fa_yf_ok:
  v_mul_u32_u24 v16, 3277, v1
  v_lshrrev_b32 v16, 16, v16
  v_mul_u32_u24 v12, 20, v16
  v_sub_u32 v12, v1, v12
  v_lshlrev_b32 v12, 4, v12
  v_mul_u32_u24 v13, 368640, v16
  v_add_u32 v13, v13, v12
  v_cmp_gt_u32 vcc, 3, v16
  v_mov_b32 v19, 1073741824
  s_nop 0
  v_cndmask_b32 v13, v19, v13, vcc
fa_coY:
  s_ff1_i32_b32 s33, s10
  s_bitset0_b32 s10, s33
  s_lshl_b32 s23, s20, 1
  s_add_u32 s33, s33, s23
  s_mul_i32 s14, s33, 2560
  s_mul_i32 s23, s22, 320
  s_add_u32 s14, s14, s23
  s_add_u32 s14, s14, 2686976
  buffer_load_dwordx4 v[32:35], v13, s[40:43], s14 offen sc1
  s_add_u32 s14, s14, 20480
  buffer_load_dwordx4 v[36:39], v13, s[40:43], s14 offen sc1
  s_add_u32 s14, s14, 20480
  buffer_load_dwordx4 v[40:43], v13, s[40:43], s14 offen sc1
  s_add_u32 s14, s14, 20480
  buffer_load_dwordx4 v[44:47], v13, s[40:43], s14 offen sc1
  s_add_u32 s14, s14, 20480
  buffer_load_dwordx4 v[48:51], v13, s[40:43], s14 offen sc1
  s_add_u32 s14, s14, 20480
  buffer_load_dwordx4 v[52:55], v13, s[40:43], s14 offen sc1
  s_add_u32 s14, s14, 20480
  buffer_load_dwordx4 v[56:59], v13, s[40:43], s14 offen sc1
  s_add_u32 s14, s14, 20480
  buffer_load_dwordx4 v[60:63], v13, s[40:43], s14 offen sc1
  s_add_u32 s14, s14, 20480
  buffer_load_dwordx4 v[96:99], v13, s[40:43], s14 offen sc1
  s_add_u32 s14, s14, 20480
  buffer_load_dwordx4 v[100:103], v13, s[40:43], s14 offen sc1
  s_add_u32 s14, s14, 20480
  buffer_load_dwordx4 v[104:107], v13, s[40:43], s14 offen sc1
  s_add_u32 s14, s14, 20480
  buffer_load_dwordx4 v[108:111], v13, s[40:43], s14 offen sc1
  s_add_u32 s14, s14, 20480
  buffer_load_dwordx4 v[112:115], v13, s[40:43], s14 offen sc1
  s_add_u32 s14, s14, 20480
  buffer_load_dwordx4 v[116:119], v13, s[40:43], s14 offen sc1
  s_add_u32 s14, s14, 20480
  buffer_load_dwordx4 v[120:123], v13, s[40:43], s14 offen sc1
  s_add_u32 s14, s14, 20480
  buffer_load_dwordx4 v[124:127], v13, s[40:43], s14 offen sc1
  s_add_u32 s14, s14, 20480
  buffer_load_dwordx4 v[160:163], v13, s[40:43], s14 offen sc1
  s_add_u32 s14, s14, 20480
  buffer_load_dwordx4 v[164:167], v13, s[40:43], s14 offen sc1
  s_add_u32 s14, s14, 20480
  s_lshl_b32 s14, s20, 10
  s_add_u32 s14, s14, 135168
  v_add_u32 v19, s14, v2
  s_add_u32 s23, s33, 8
  v_readlane_b32 s35, v15, s23
  s_waitcnt vmcnt(0)
  v_pk_add_f32 v[32:33], v[32:33], v[36:37]
  v_pk_add_f32 v[34:35], v[34:35], v[38:39]
  v_pk_add_f32 v[32:33], v[32:33], v[40:41]
  v_pk_add_f32 v[34:35], v[34:35], v[42:43]
  v_pk_add_f32 v[32:33], v[32:33], v[44:45]
  v_pk_add_f32 v[34:35], v[34:35], v[46:47]
  v_pk_add_f32 v[32:33], v[32:33], v[48:49]
  v_pk_add_f32 v[34:35], v[34:35], v[50:51]
  v_pk_add_f32 v[32:33], v[32:33], v[52:53]
  v_pk_add_f32 v[34:35], v[34:35], v[54:55]
  v_pk_add_f32 v[32:33], v[32:33], v[56:57]
  v_pk_add_f32 v[34:35], v[34:35], v[58:59]
  v_pk_add_f32 v[32:33], v[32:33], v[60:61]
  v_pk_add_f32 v[34:35], v[34:35], v[62:63]
  v_pk_add_f32 v[32:33], v[32:33], v[96:97]
  v_pk_add_f32 v[34:35], v[34:35], v[98:99]
  v_pk_add_f32 v[32:33], v[32:33], v[100:101]
  v_pk_add_f32 v[34:35], v[34:35], v[102:103]
  v_pk_add_f32 v[32:33], v[32:33], v[104:105]
  v_pk_add_f32 v[34:35], v[34:35], v[106:107]
  v_pk_add_f32 v[32:33], v[32:33], v[108:109]
  v_pk_add_f32 v[34:35], v[34:35], v[110:111]
  v_pk_add_f32 v[32:33], v[32:33], v[112:113]
  v_pk_add_f32 v[34:35], v[34:35], v[114:115]
  v_pk_add_f32 v[32:33], v[32:33], v[116:117]
  v_pk_add_f32 v[34:35], v[34:35], v[118:119]
  v_pk_add_f32 v[32:33], v[32:33], v[120:121]
  v_pk_add_f32 v[34:35], v[34:35], v[122:123]
  v_pk_add_f32 v[32:33], v[32:33], v[124:125]
  v_pk_add_f32 v[34:35], v[34:35], v[126:127]
  v_pk_add_f32 v[32:33], v[32:33], v[160:161]
  v_pk_add_f32 v[34:35], v[34:35], v[162:163]
  v_pk_add_f32 v[32:33], v[32:33], v[164:165]
  v_pk_add_f32 v[34:35], v[34:35], v[166:167]
  ds_write_b128 v19, v[32:35]
  v_add_u32 v19, s14, v12
  s_and_b32 s35, s35, 0xffff0000
  s_waitcnt lgkmcnt(0)
  ds_read_b128 v[32:35], v19
  ds_read_b128 v[36:39], v19 offset:320
  ds_read_b128 v[40:43], v19 offset:640
  s_mul_i32 s14, s33, 320
  s_add_u32 s14, s14, 131072
  v_add_u32 v19, s14, v12
  s_waitcnt lgkmcnt(0)
  v_add_f32 v32, v32, v36
  v_add_f32 v32, v32, v40
  v_cvt_pk_bf16_f32 v32, v32, v32
  v_and_b32 v32, 0xffff0000, v32
  v_mul_f32 v32, s35, v32
  v_cvt_pk_bf16_f32 v32, v32, v32
  v_and_b32 v32, 0xffff0000, v32
  v_add_f32 v33, v33, v37
  v_add_f32 v33, v33, v41
  v_cvt_pk_bf16_f32 v33, v33, v33
  v_and_b32 v33, 0xffff0000, v33
  v_mul_f32 v33, s35, v33
  v_cvt_pk_bf16_f32 v33, v33, v33
  v_and_b32 v33, 0xffff0000, v33
  v_add_f32 v34, v34, v38
  v_add_f32 v34, v34, v42
  v_cvt_pk_bf16_f32 v34, v34, v34
  v_and_b32 v34, 0xffff0000, v34
  v_mul_f32 v34, s35, v34
  v_cvt_pk_bf16_f32 v34, v34, v34
  v_and_b32 v34, 0xffff0000, v34
  v_add_f32 v35, v35, v39
  v_add_f32 v35, v35, v43
  v_cvt_pk_bf16_f32 v35, v35, v35
  v_and_b32 v35, 0xffff0000, v35
  v_mul_f32 v35, s35, v35
  v_cvt_pk_bf16_f32 v35, v35, v35
  v_and_b32 v35, 0xffff0000, v35
  ds_write_b128 v19, v[32:35]
  s_waitcnt lgkmcnt(0)
  s_cmp_lg_u32 s10, 0
  s_cbranch_scc1 fa_coY
fa_coEnd:
  s_mov_b32 s12, 3
  s_mov_b32 s32, -1
  s_setpc_b64 s[38:39]
fa_hk2:
  s_getpc_b64 s[38:39]
fa_hp2:
  s_add_u32 s36, s36, 4
  s_addc_u32 s37, s37, 0
  s_sub_u32 s38, s38, fa_hp2-fa_hb2
  s_subb_u32 s39, s39, 0
  s_setpc_b64 s[36:37]
fa_hk3:
  s_getpc_b64 s[38:39]
fa_hp3:
  s_add_u32 s36, s36, 4
  s_addc_u32 s37, s37, 0
  s_sub_u32 s38, s38, fa_hp3-fa_hb3
  s_subb_u32 s39, s39, 0
  s_setpc_b64 s[36:37]
fa_hk4:
  s_getpc_b64 s[38:39]
fa_hp4:
  s_add_u32 s36, s36, 4
  s_addc_u32 s37, s37, 0
  s_add_u32 s38, s38, fa_hb4-fa_hp4
  s_addc_u32 s39, s39, 0
  s_setpc_b64 s[36:37]
fa_disp:
  s_cmp_eq_u32 s29, 7
  s_cbranch_scc1 fa_SSW7
  s_cmp_eq_u32 s29, 6
  s_cbranch_scc1 fa_SSW6
  s_cmp_eq_u32 s29, 5
  s_cbranch_scc1 fa_SSW5
  s_cmp_eq_u32 s29, 4
  s_cbranch_scc1 fa_SSW4
  s_cmp_eq_u32 s29, 3
  s_cbranch_scc1 fa_SSW3
fa_hb4:
  s_cmp_lt_u32 s12, 3
  s_cbranch_scc1 fa_hk4
  s_cmp_eq_u32 s29, 2
  s_cbranch_scc1 fa_SSW2
  s_cmp_eq_u32 s29, 1
  s_cbranch_scc1 fa_SSW1
  s_branch fa_Bexit
fa_hk5:
  s_getpc_b64 s[38:39]
fa_hp5:
  s_add_u32 s36, s36, 4
  s_addc_u32 s37, s37, 0
  s_sub_u32 s38, s38, fa_hp5-fa_hb5
  s_subb_u32 s39, s39, 0
  s_setpc_b64 s[36:37]
fa_hk6:
  s_getpc_b64 s[38:39]
fa_hp6:
  s_add_u32 s36, s36, 4
  s_addc_u32 s37, s37, 0
  s_sub_u32 s38, s38, fa_hp6-fa_hb6
  s_subb_u32 s39, s39, 0
  s_setpc_b64 s[36:37]
fa_hk7:
  s_getpc_b64 s[38:39]
fa_hp7:
  s_add_u32 s36, s36, 4
  s_addc_u32 s37, s37, 0
  s_sub_u32 s38, s38, fa_hp7-fa_hb7
  s_subb_u32 s39, s39, 0
  s_setpc_b64 s[36:37]
fa_hk8:
  s_getpc_b64 s[38:39]
fa_hp8:
  s_add_u32 s36, s36, 4
  s_addc_u32 s37, s37, 0
  s_sub_u32 s38, s38, fa_hp8-fa_hb8
  s_subb_u32 s39, s39, 0
  s_setpc_b64 s[36:37]
fa_hk9:
  s_getpc_b64 s[38:39]
fa_hp9:
  s_add_u32 s36, s36, 4
  s_addc_u32 s37, s37, 0
  s_sub_u32 s38, s38, fa_hp9-fa_hb9
  s_subb_u32 s39, s39, 0
  s_setpc_b64 s[36:37]
fa_hk10:
  s_getpc_b64 s[38:39]
fa_hp10:
  s_add_u32 s36, s36, 4
  s_addc_u32 s37, s37, 0
  s_sub_u32 s38, s38, fa_hp10-fa_hb10
  s_subb_u32 s39, s39, 0
  s_setpc_b64 s[36:37]
fa_left:
  s_add_u32 s14, s13, 0
  buffer_load_dwordx4 a[0:3], v2, s[40:43], s14 offen offset:0 sc1
  buffer_load_dwordx4 a[4:7], v2, s[40:43], s14 offen offset:1024 sc1
  buffer_load_dwordx4 a[8:11], v2, s[40:43], s14 offen offset:2048 sc1
  buffer_load_dwordx4 a[12:15], v2, s[40:43], s14 offen offset:3072 sc1
  s_add_u32 s14, s13, 4096
  buffer_load_dwordx4 a[16:19], v2, s[40:43], s14 offen offset:0 sc1
  buffer_load_dwordx4 a[20:23], v2, s[40:43], s14 offen offset:1024 sc1
  s_cmp_ge_u32 s29, 7
  s_cbranch_scc1 fa_leftb
  s_add_u32 s14, s13, 4096
  buffer_load_dwordx4 a[24:27], v2, s[40:43], s14 offen offset:2048 sc1
  buffer_load_dwordx4 a[28:31], v2, s[40:43], s14 offen offset:3072 sc1
  s_add_u32 s14, s13, 8192
  buffer_load_dwordx4 a[32:35], v2, s[40:43], s14 offen offset:0 sc1
  buffer_load_dwordx4 a[36:39], v2, s[40:43], s14 offen offset:1024 sc1
  buffer_load_dwordx4 a[40:43], v2, s[40:43], s14 offen offset:2048 sc1
  buffer_load_dwordx4 a[44:47], v2, s[40:43], s14 offen offset:3072 sc1
  s_cmp_ge_u32 s29, 6
  s_cbranch_scc1 fa_leftb
  s_add_u32 s14, s13, 12288
  buffer_load_dwordx4 a[48:51], v2, s[40:43], s14 offen offset:0 sc1
  buffer_load_dwordx4 a[52:55], v2, s[40:43], s14 offen offset:1024 sc1
  buffer_load_dwordx4 a[56:59], v2, s[40:43], s14 offen offset:2048 sc1
  buffer_load_dwordx4 a[60:63], v2, s[40:43], s14 offen offset:3072 sc1
  s_add_u32 s14, s13, 16384
  buffer_load_dwordx4 a[192:195], v2, s[40:43], s14 offen offset:0 sc1
  buffer_load_dwordx4 a[196:199], v2, s[40:43], s14 offen offset:1024 sc1
  s_cmp_ge_u32 s29, 5
  s_cbranch_scc1 fa_leftb
  s_add_u32 s14, s13, 16384
  buffer_load_dwordx4 a[200:203], v2, s[40:43], s14 offen offset:2048 sc1
  buffer_load_dwordx4 a[204:207], v2, s[40:43], s14 offen offset:3072 sc1
  s_add_u32 s14, s13, 20480
  buffer_load_dwordx4 a[208:211], v2, s[40:43], s14 offen offset:0 sc1
  buffer_load_dwordx4 a[212:215], v2, s[40:43], s14 offen offset:1024 sc1
  buffer_load_dwordx4 a[216:219], v2, s[40:43], s14 offen offset:2048 sc1
  buffer_load_dwordx4 a[220:223], v2, s[40:43], s14 offen offset:3072 sc1
  s_cmp_ge_u32 s29, 4
  s_cbranch_scc1 fa_leftb
  s_add_u32 s14, s13, 24576
  buffer_load_dwordx4 a[224:227], v2, s[40:43], s14 offen offset:0 sc1
  buffer_load_dwordx4 a[228:231], v2, s[40:43], s14 offen offset:1024 sc1
  buffer_load_dwordx4 a[232:235], v2, s[40:43], s14 offen offset:2048 sc1
  buffer_load_dwordx4 a[236:239], v2, s[40:43], s14 offen offset:3072 sc1
  s_add_u32 s14, s13, 28672
  buffer_load_dwordx4 a[240:243], v2, s[40:43], s14 offen offset:0 sc1
  buffer_load_dwordx4 a[244:247], v2, s[40:43], s14 offen offset:1024 sc1
  s_cmp_ge_u32 s29, 3
  s_cbranch_scc1 fa_leftb
  s_add_u32 s14, s13, 28672
  buffer_load_dwordx4 a[248:251], v2, s[40:43], s14 offen offset:2048 sc1
  buffer_load_dwordx4 a[252:255], v2, s[40:43], s14 offen offset:3072 sc1
  s_add_u32 s14, s13, 32768
  buffer_load_dwordx4 v[32:35], v2, s[40:43], s14 offen offset:0 sc1
  buffer_load_dwordx4 v[36:39], v2, s[40:43], s14 offen offset:1024 sc1
  buffer_load_dwordx4 v[40:43], v2, s[40:43], s14 offen offset:2048 sc1
  buffer_load_dwordx4 v[44:47], v2, s[40:43], s14 offen offset:3072 sc1
  s_cmp_ge_u32 s29, 2
  s_cbranch_scc1 fa_leftb
  s_add_u32 s14, s13, 36864
  buffer_load_dwordx4 v[48:51], v2, s[40:43], s14 offen offset:0 sc1
  buffer_load_dwordx4 v[52:55], v2, s[40:43], s14 offen offset:1024 sc1
  buffer_load_dwordx4 v[56:59], v2, s[40:43], s14 offen offset:2048 sc1
  buffer_load_dwordx4 v[60:63], v2, s[40:43], s14 offen offset:3072 sc1
  s_add_u32 s14, s13, 40960
  buffer_load_dwordx4 v[96:99], v2, s[40:43], s14 offen offset:0 sc1
  buffer_load_dwordx4 v[100:103], v2, s[40:43], s14 offen offset:1024 sc1
  s_cmp_ge_u32 s29, 1
  s_cbranch_scc1 fa_leftb
  s_add_u32 s14, s13, 40960
  buffer_load_dwordx4 v[104:107], v2, s[40:43], s14 offen offset:2048 sc1
  buffer_load_dwordx4 v[108:111], v2, s[40:43], s14 offen offset:3072 sc1
  s_add_u32 s14, s13, 45056
  buffer_load_dwordx4 v[112:115], v2, s[40:43], s14 offen offset:0 sc1
  buffer_load_dwordx4 v[116:119], v2, s[40:43], s14 offen offset:1024 sc1
  buffer_load_dwordx4 v[120:123], v2, s[40:43], s14 offen offset:2048 sc1
  buffer_load_dwordx4 v[124:127], v2, s[40:43], s14 offen offset:3072 sc1
  s_branch fa_leftb
fa_ctx_spin:
  s_mov_b32 s83, 200000
fa_ctx_spin2:
  buffer_load_dword v13, v12, s[40:43], 0 offen sc1
  s_waitcnt vmcnt(0)
  v_cmp_eq_u32 vcc, 0, v13
  s_cbranch_vccz fa_ctx_ok
  s_sleep 8
  s_sub_u32 s83, s83, 1
  s_cmp_lg_u32 s83, 0
  s_cbranch_scc1 fa_ctx_spin2
  s_branch fa_ctx_ok
fa_stub0:
  s_call_b64 s[76:77], fa_rare00
  s_call_b64 s[76:77], fa_rare10
  s_branch fa_back0
fa_stub1:
  s_call_b64 s[76:77], fa_rare01
  s_call_b64 s[76:77], fa_rare11
  s_branch fa_back1
fa_stub2:
  s_call_b64 s[76:77], fa_rare00
  s_call_b64 s[76:77], fa_rare10
  s_branch fa_back2
fa_stub3:
  s_call_b64 s[76:77], fa_rare01
  s_call_b64 s[76:77], fa_rare11
  s_branch fa_back3
fa_stub4:
  s_call_b64 s[76:77], fa_rare00
  s_call_b64 s[76:77], fa_rare10
  s_branch fa_back4
fa_stub5:
  s_call_b64 s[76:77], fa_rare11
  s_branch fa_back5
fa_stub6:
  s_call_b64 s[76:77], fa_rare10
  s_branch fa_back6
fa_stub7:
  s_call_b64 s[76:77], fa_rare01
  s_call_b64 s[76:77], fa_rare11
  s_branch fa_back7
fa_stub8:
  s_call_b64 s[76:77], fa_rare10
  s_branch fa_back8
fa_stub9:
  s_call_b64 s[76:77], fa_rare11
  s_branch fa_back9
fa_stub10:
  s_call_b64 s[76:77], fa_rare10
  s_branch fa_back10
fa_stub11:
  s_call_b64 s[76:77], fa_rare11
  s_branch fa_back11
fa_stub12:
  s_call_b64 s[76:77], fa_rare10
  s_branch fa_back12
fa_stub13:
  s_call_b64 s[76:77], fa_rare11
  s_branch fa_back13
fa_stub14:
  s_call_b64 s[76:77], fa_rare10
  s_branch fa_back14
fa_stub15:
  s_call_b64 s[76:77], fa_rare11
  s_branch fa_back15
fa_stub16:
  s_call_b64 s[76:77], fa_rare10
  s_branch fa_back16
fa_stub17:
  s_call_b64 s[76:77], fa_rare11
  s_branch fa_back17
fa_stub18:
  s_call_b64 s[76:77], fa_rare10
  s_branch fa_back18
fa_stub19:
  s_call_b64 s[76:77], fa_rare11
  s_branch fa_back19
fa_stub20:
  s_call_b64 s[76:77], fa_rare10
  s_branch fa_back20
fa_stub21:
  s_call_b64 s[76:77], fa_rare11
  s_branch fa_back21
fa_stub22:
  s_call_b64 s[76:77], fa_rare10
  s_branch fa_back22
fa_stub23:
  s_call_b64 s[76:77], fa_rare11
  s_branch fa_back23
fa_stub24:
  s_call_b64 s[76:77], fa_rare10
  s_branch fa_back24
fa_stub25:
  s_call_b64 s[76:77], fa_rare11
  s_branch fa_back25
fa_stub26:
  s_call_b64 s[76:77], fa_rare10
  s_branch fa_back26
fa_stub27:
  s_call_b64 s[76:77], fa_rare11
  s_branch fa_back27
fa_stub28:
  s_call_b64 s[76:77], fa_rare10
  s_branch fa_back28
fa_stub29:
  s_call_b64 s[76:77], fa_rare11
  s_branch fa_back29
fa_codeend:
fa_rare00:
  s_nop 7
  v_max3_f32 v16, v96, v97, v98
  v_max3_f32 v16, v16, v99, v100
  v_max3_f32 v16, v16, v101, v102
  v_max3_f32 v16, v16, v103, 0
  v_mov_b32 v18, v16
  s_nop 1
  v_permlane16_swap_b32 v16, v18
  v_max_f32 v16, v16, v18
  v_mov_b32 v18, v16
  s_nop 1
  v_permlane32_swap_b32 v16, v18
  v_max_f32 v16, v16, v18
  v_sub_f32 v96, v96, v16
  v_sub_f32 v112, v112, v16
  v_sub_f32 v97, v97, v16
  v_sub_f32 v113, v113, v16
  v_sub_f32 v98, v98, v16
  v_sub_f32 v114, v114, v16
  v_sub_f32 v99, v99, v16
  v_sub_f32 v115, v115, v16
  v_sub_f32 v100, v100, v16
  v_sub_f32 v116, v116, v16
  v_sub_f32 v101, v101, v16
  v_sub_f32 v117, v117, v16
  v_sub_f32 v102, v102, v16
  v_sub_f32 v118, v118, v16
  v_sub_f32 v103, v103, v16
  v_sub_f32 v119, v119, v16
  v_max3_f32 v17, v104, v105, v106
  v_max3_f32 v17, v17, v107, v108
  v_max3_f32 v17, v17, v109, v110
  v_max3_f32 v17, v17, v111, 0
  v_mov_b32 v18, v17
  s_nop 1
  v_permlane16_swap_b32 v17, v18
  v_max_f32 v17, v17, v18
  v_mov_b32 v18, v17
  s_nop 1
  v_permlane32_swap_b32 v17, v18
  v_max_f32 v17, v17, v18
  v_sub_f32 v104, v104, v17
  v_sub_f32 v120, v120, v17
  v_sub_f32 v105, v105, v17
  v_sub_f32 v121, v121, v17
  v_sub_f32 v106, v106, v17
  v_sub_f32 v122, v122, v17
  v_sub_f32 v107, v107, v17
  v_sub_f32 v123, v123, v17
  v_sub_f32 v108, v108, v17
  v_sub_f32 v124, v124, v17
  v_sub_f32 v109, v109, v17
  v_sub_f32 v125, v125, v17
  v_sub_f32 v110, v110, v17
  v_sub_f32 v126, v126, v17
  v_sub_f32 v111, v111, v17
  v_sub_f32 v127, v127, v17
  s_call_b64 s[78:79], fa_resc0
  v_exp_f32 v208, v96
  v_exp_f32 v209, v97
  v_exp_f32 v210, v98
  v_add_f32 v224, v208, v209
  v_cvt_pk_bf16_f32 v160, v208, v209
  v_exp_f32 v211, v99
  v_add_f32 v224, v224, v210
  v_exp_f32 v212, v100
  v_add_f32 v224, v224, v211
  v_cvt_pk_bf16_f32 v161, v210, v211
  v_exp_f32 v213, v101
  v_add_f32 v224, v224, v212
  v_exp_f32 v214, v102
  v_add_f32 v224, v224, v213
  v_cvt_pk_bf16_f32 v162, v212, v213
  v_exp_f32 v215, v103
  v_add_f32 v224, v224, v214
  v_exp_f32 v208, v104
  v_add_f32 v224, v224, v215
  v_cvt_pk_bf16_f32 v163, v214, v215
  v_exp_f32 v209, v105
  v_exp_f32 v210, v106
  v_add_f32 v225, v208, v209
  v_cvt_pk_bf16_f32 v164, v208, v209
  v_exp_f32 v211, v107
  v_add_f32 v225, v225, v210
  v_exp_f32 v212, v108
  v_add_f32 v225, v225, v211
  v_cvt_pk_bf16_f32 v165, v210, v211
  v_exp_f32 v213, v109
  v_add_f32 v225, v225, v212
  v_exp_f32 v214, v110
  v_add_f32 v225, v225, v213
  v_cvt_pk_bf16_f32 v166, v212, v213
  v_exp_f32 v215, v111
  v_add_f32 v225, v225, v214
  s_nop 0
  v_add_f32 v225, v225, v215
  v_cvt_pk_bf16_f32 v167, v214, v215
  s_nop 1
  s_setpc_b64 s[76:77]
fa_rare01:
  s_nop 7
  v_max3_f32 v16, v112, v113, v114
  v_max3_f32 v16, v16, v115, v116
  v_max3_f32 v16, v16, v117, v118
  v_max3_f32 v16, v16, v119, 0
  v_mov_b32 v18, v16
  s_nop 1
  v_permlane16_swap_b32 v16, v18
  v_max_f32 v16, v16, v18
  v_mov_b32 v18, v16
  s_nop 1
  v_permlane32_swap_b32 v16, v18
  v_max_f32 v16, v16, v18
  v_sub_f32 v112, v112, v16
  v_sub_f32 v96, v96, v16
  v_sub_f32 v113, v113, v16
  v_sub_f32 v97, v97, v16
  v_sub_f32 v114, v114, v16
  v_sub_f32 v98, v98, v16
  v_sub_f32 v115, v115, v16
  v_sub_f32 v99, v99, v16
  v_sub_f32 v116, v116, v16
  v_sub_f32 v100, v100, v16
  v_sub_f32 v117, v117, v16
  v_sub_f32 v101, v101, v16
  v_sub_f32 v118, v118, v16
  v_sub_f32 v102, v102, v16
  v_sub_f32 v119, v119, v16
  v_sub_f32 v103, v103, v16
  v_max3_f32 v17, v120, v121, v122
  v_max3_f32 v17, v17, v123, v124
  v_max3_f32 v17, v17, v125, v126
  v_max3_f32 v17, v17, v127, 0
  v_mov_b32 v18, v17
  s_nop 1
  v_permlane16_swap_b32 v17, v18
  v_max_f32 v17, v17, v18
  v_mov_b32 v18, v17
  s_nop 1
  v_permlane32_swap_b32 v17, v18
  v_max_f32 v17, v17, v18
  v_sub_f32 v120, v120, v17
  v_sub_f32 v104, v104, v17
  v_sub_f32 v121, v121, v17
  v_sub_f32 v105, v105, v17
  v_sub_f32 v122, v122, v17
  v_sub_f32 v106, v106, v17
  v_sub_f32 v123, v123, v17
  v_sub_f32 v107, v107, v17
  v_sub_f32 v124, v124, v17
  v_sub_f32 v108, v108, v17
  v_sub_f32 v125, v125, v17
  v_sub_f32 v109, v109, v17
  v_sub_f32 v126, v126, v17
  v_sub_f32 v110, v110, v17
  v_sub_f32 v127, v127, v17
  v_sub_f32 v111, v111, v17
  s_call_b64 s[78:79], fa_resc0
  v_exp_f32 v208, v112
  v_exp_f32 v209, v113
  v_exp_f32 v210, v114
  v_add_f32 v224, v208, v209
  v_cvt_pk_bf16_f32 v168, v208, v209
  v_exp_f32 v211, v115
  v_add_f32 v224, v224, v210
  v_exp_f32 v212, v116
  v_add_f32 v224, v224, v211
  v_cvt_pk_bf16_f32 v169, v210, v211
  v_exp_f32 v213, v117
  v_add_f32 v224, v224, v212
  v_exp_f32 v214, v118
  v_add_f32 v224, v224, v213
  v_cvt_pk_bf16_f32 v170, v212, v213
  v_exp_f32 v215, v119
  v_add_f32 v224, v224, v214
  v_exp_f32 v208, v120
  v_add_f32 v224, v224, v215
  v_cvt_pk_bf16_f32 v171, v214, v215
  v_exp_f32 v209, v121
  v_exp_f32 v210, v122
  v_add_f32 v225, v208, v209
  v_cvt_pk_bf16_f32 v172, v208, v209
  v_exp_f32 v211, v123
  v_add_f32 v225, v225, v210
  v_exp_f32 v212, v124
  v_add_f32 v225, v225, v211
  v_cvt_pk_bf16_f32 v173, v210, v211
  v_exp_f32 v213, v125
  v_add_f32 v225, v225, v212
  v_exp_f32 v214, v126
  v_add_f32 v225, v225, v213
  v_cvt_pk_bf16_f32 v174, v212, v213
  v_exp_f32 v215, v127
  v_add_f32 v225, v225, v214
  s_nop 0
  v_add_f32 v225, v225, v215
  v_cvt_pk_bf16_f32 v175, v214, v215
  s_nop 1
  s_setpc_b64 s[76:77]
fa_resc0:
  v_sub_f32 v192, v192, v16
  v_sub_f32 v193, v193, v16
  v_sub_f32 v194, v194, v16
  v_sub_f32 v195, v195, v16
  v_exp_f32 v18, -v16
  v_sub_f32 v196, v196, v17
  v_sub_f32 v197, v197, v17
  v_sub_f32 v198, v198, v17
  v_sub_f32 v199, v199, v17
  v_exp_f32 v19, -v17
  s_nop 0
  v_mul_f32 v228, v228, v18
  v_mul_f32 v229, v229, v19
  v_accvgpr_read_b32 v20, a0
  v_accvgpr_read_b32 v21, a1
  v_accvgpr_read_b32 v22, a2
  v_accvgpr_read_b32 v23, a3
  v_mul_f32 v20, v20, v18
  v_mul_f32 v21, v21, v18
  v_mul_f32 v22, v22, v18
  v_mul_f32 v23, v23, v18
  v_accvgpr_write_b32 a0, v20
  v_accvgpr_write_b32 a1, v21
  v_accvgpr_write_b32 a2, v22
  v_accvgpr_write_b32 a3, v23
  v_accvgpr_read_b32 v20, a4
  v_accvgpr_read_b32 v21, a5
  v_accvgpr_read_b32 v22, a6
  v_accvgpr_read_b32 v23, a7
  v_mul_f32 v20, v20, v19
  v_mul_f32 v21, v21, v19
  v_mul_f32 v22, v22, v19
  v_mul_f32 v23, v23, v19
  v_accvgpr_write_b32 a4, v20
  v_accvgpr_write_b32 a5, v21
  v_accvgpr_write_b32 a6, v22
  v_accvgpr_write_b32 a7, v23
  v_accvgpr_read_b32 v20, a8
  v_accvgpr_read_b32 v21, a9
  v_accvgpr_read_b32 v22, a10
  v_accvgpr_read_b32 v23, a11
  v_mul_f32 v20, v20, v18
  v_mul_f32 v21, v21, v18
  v_mul_f32 v22, v22, v18
  v_mul_f32 v23, v23, v18
  v_accvgpr_write_b32 a8, v20
  v_accvgpr_write_b32 a9, v21
  v_accvgpr_write_b32 a10, v22
  v_accvgpr_write_b32 a11, v23
  v_accvgpr_read_b32 v20, a12
  v_accvgpr_read_b32 v21, a13
  v_accvgpr_read_b32 v22, a14
  v_accvgpr_read_b32 v23, a15
  v_mul_f32 v20, v20, v19
  v_mul_f32 v21, v21, v19
  v_mul_f32 v22, v22, v19
  v_mul_f32 v23, v23, v19
  v_accvgpr_write_b32 a12, v20
  v_accvgpr_write_b32 a13, v21
  v_accvgpr_write_b32 a14, v22
  v_accvgpr_write_b32 a15, v23
  v_accvgpr_read_b32 v20, a16
  v_accvgpr_read_b32 v21, a17
  v_accvgpr_read_b32 v22, a18
  v_accvgpr_read_b32 v23, a19
  v_mul_f32 v20, v20, v18
  v_mul_f32 v21, v21, v18
  v_mul_f32 v22, v22, v18
  v_mul_f32 v23, v23, v18
  v_accvgpr_write_b32 a16, v20
  v_accvgpr_write_b32 a17, v21
  v_accvgpr_write_b32 a18, v22
  v_accvgpr_write_b32 a19, v23
  v_accvgpr_read_b32 v20, a20
  v_accvgpr_read_b32 v21, a21
  v_accvgpr_read_b32 v22, a22
  v_accvgpr_read_b32 v23, a23
  v_mul_f32 v20, v20, v19
  v_mul_f32 v21, v21, v19
  v_mul_f32 v22, v22, v19
  v_mul_f32 v23, v23, v19
  v_accvgpr_write_b32 a20, v20
  v_accvgpr_write_b32 a21, v21
  v_accvgpr_write_b32 a22, v22
  v_accvgpr_write_b32 a23, v23
  v_accvgpr_read_b32 v20, a24
  v_accvgpr_read_b32 v21, a25
  v_accvgpr_read_b32 v22, a26
  v_accvgpr_read_b32 v23, a27
  v_mul_f32 v20, v20, v18
  v_mul_f32 v21, v21, v18
  v_mul_f32 v22, v22, v18
  v_mul_f32 v23, v23, v18
  v_accvgpr_write_b32 a24, v20
  v_accvgpr_write_b32 a25, v21
  v_accvgpr_write_b32 a26, v22
  v_accvgpr_write_b32 a27, v23
  v_accvgpr_read_b32 v20, a28
  v_accvgpr_read_b32 v21, a29
  v_accvgpr_read_b32 v22, a30
  v_accvgpr_read_b32 v23, a31
  v_mul_f32 v20, v20, v19
  v_mul_f32 v21, v21, v19
  v_mul_f32 v22, v22, v19
  v_mul_f32 v23, v23, v19
  v_accvgpr_write_b32 a28, v20
  v_accvgpr_write_b32 a29, v21
  v_accvgpr_write_b32 a30, v22
  v_accvgpr_write_b32 a31, v23
  v_accvgpr_read_b32 v20, a32
  v_accvgpr_read_b32 v21, a33
  v_accvgpr_read_b32 v22, a34
  v_accvgpr_read_b32 v23, a35
  v_mul_f32 v20, v20, v18
  v_mul_f32 v21, v21, v18
  v_mul_f32 v22, v22, v18
  v_mul_f32 v23, v23, v18
  v_accvgpr_write_b32 a32, v20
  v_accvgpr_write_b32 a33, v21
  v_accvgpr_write_b32 a34, v22
  v_accvgpr_write_b32 a35, v23
  v_accvgpr_read_b32 v20, a36
  v_accvgpr_read_b32 v21, a37
  v_accvgpr_read_b32 v22, a38
  v_accvgpr_read_b32 v23, a39
  v_mul_f32 v20, v20, v19
  v_mul_f32 v21, v21, v19
  v_mul_f32 v22, v22, v19
  v_mul_f32 v23, v23, v19
  v_accvgpr_write_b32 a36, v20
  v_accvgpr_write_b32 a37, v21
  v_accvgpr_write_b32 a38, v22
  v_accvgpr_write_b32 a39, v23
  v_accvgpr_read_b32 v20, a40
  v_accvgpr_read_b32 v21, a41
  v_accvgpr_read_b32 v22, a42
  v_accvgpr_read_b32 v23, a43
  v_mul_f32 v20, v20, v18
  v_mul_f32 v21, v21, v18
  v_mul_f32 v22, v22, v18
  v_mul_f32 v23, v23, v18
  v_accvgpr_write_b32 a40, v20
  v_accvgpr_write_b32 a41, v21
  v_accvgpr_write_b32 a42, v22
  v_accvgpr_write_b32 a43, v23
  v_accvgpr_read_b32 v20, a44
  v_accvgpr_read_b32 v21, a45
  v_accvgpr_read_b32 v22, a46
  v_accvgpr_read_b32 v23, a47
  v_mul_f32 v20, v20, v19
  v_mul_f32 v21, v21, v19
  v_mul_f32 v22, v22, v19
  v_mul_f32 v23, v23, v19
  v_accvgpr_write_b32 a44, v20
  v_accvgpr_write_b32 a45, v21
  v_accvgpr_write_b32 a46, v22
  v_accvgpr_write_b32 a47, v23
  v_accvgpr_read_b32 v20, a48
  v_accvgpr_read_b32 v21, a49
  v_accvgpr_read_b32 v22, a50
  v_accvgpr_read_b32 v23, a51
  v_mul_f32 v20, v20, v18
  v_mul_f32 v21, v21, v18
  v_mul_f32 v22, v22, v18
  v_mul_f32 v23, v23, v18
  v_accvgpr_write_b32 a48, v20
  v_accvgpr_write_b32 a49, v21
  v_accvgpr_write_b32 a50, v22
  v_accvgpr_write_b32 a51, v23
  v_accvgpr_read_b32 v20, a52
  v_accvgpr_read_b32 v21, a53
  v_accvgpr_read_b32 v22, a54
  v_accvgpr_read_b32 v23, a55
  v_mul_f32 v20, v20, v19
  v_mul_f32 v21, v21, v19
  v_mul_f32 v22, v22, v19
  v_mul_f32 v23, v23, v19
  v_accvgpr_write_b32 a52, v20
  v_accvgpr_write_b32 a53, v21
  v_accvgpr_write_b32 a54, v22
  v_accvgpr_write_b32 a55, v23
  v_accvgpr_read_b32 v20, a56
  v_accvgpr_read_b32 v21, a57
  v_accvgpr_read_b32 v22, a58
  v_accvgpr_read_b32 v23, a59
  v_mul_f32 v20, v20, v18
  v_mul_f32 v21, v21, v18
  v_mul_f32 v22, v22, v18
  v_mul_f32 v23, v23, v18
  v_accvgpr_write_b32 a56, v20
  v_accvgpr_write_b32 a57, v21
  v_accvgpr_write_b32 a58, v22
  v_accvgpr_write_b32 a59, v23
  v_accvgpr_read_b32 v20, a60
  v_accvgpr_read_b32 v21, a61
  v_accvgpr_read_b32 v22, a62
  v_accvgpr_read_b32 v23, a63
  v_mul_f32 v20, v20, v19
  v_mul_f32 v21, v21, v19
  v_mul_f32 v22, v22, v19
  v_mul_f32 v23, v23, v19
  v_accvgpr_write_b32 a60, v20
  v_accvgpr_write_b32 a61, v21
  v_accvgpr_write_b32 a62, v22
  v_accvgpr_write_b32 a63, v23
  s_setpc_b64 s[78:79]
fa_rare10:
  s_nop 7
  v_max3_f32 v16, v128, v129, v130
  v_max3_f32 v16, v16, v131, v132
  v_max3_f32 v16, v16, v133, v134
  v_max3_f32 v16, v16, v135, 0
  v_mov_b32 v18, v16
  s_nop 1
  v_permlane16_swap_b32 v16, v18
  v_max_f32 v16, v16, v18
  v_mov_b32 v18, v16
  s_nop 1
  v_permlane32_swap_b32 v16, v18
  v_max_f32 v16, v16, v18
  v_sub_f32 v128, v128, v16
  v_sub_f32 v144, v144, v16
  v_sub_f32 v129, v129, v16
  v_sub_f32 v145, v145, v16
  v_sub_f32 v130, v130, v16
  v_sub_f32 v146, v146, v16
  v_sub_f32 v131, v131, v16
  v_sub_f32 v147, v147, v16
  v_sub_f32 v132, v132, v16
  v_sub_f32 v148, v148, v16
  v_sub_f32 v133, v133, v16
  v_sub_f32 v149, v149, v16
  v_sub_f32 v134, v134, v16
  v_sub_f32 v150, v150, v16
  v_sub_f32 v135, v135, v16
  v_sub_f32 v151, v151, v16
  v_max3_f32 v17, v136, v137, v138
  v_max3_f32 v17, v17, v139, v140
  v_max3_f32 v17, v17, v141, v142
  v_max3_f32 v17, v17, v143, 0
  v_mov_b32 v18, v17
  s_nop 1
  v_permlane16_swap_b32 v17, v18
  v_max_f32 v17, v17, v18
  v_mov_b32 v18, v17
  s_nop 1
  v_permlane32_swap_b32 v17, v18
  v_max_f32 v17, v17, v18
  v_sub_f32 v136, v136, v17
  v_sub_f32 v152, v152, v17
  v_sub_f32 v137, v137, v17
  v_sub_f32 v153, v153, v17
  v_sub_f32 v138, v138, v17
  v_sub_f32 v154, v154, v17
  v_sub_f32 v139, v139, v17
  v_sub_f32 v155, v155, v17
  v_sub_f32 v140, v140, v17
  v_sub_f32 v156, v156, v17
  v_sub_f32 v141, v141, v17
  v_sub_f32 v157, v157, v17
  v_sub_f32 v142, v142, v17
  v_sub_f32 v158, v158, v17
  v_sub_f32 v143, v143, v17
  v_sub_f32 v159, v159, v17
  s_call_b64 s[78:79], fa_resc1
  v_exp_f32 v216, v128
  v_exp_f32 v217, v129
  v_exp_f32 v218, v130
  v_add_f32 v226, v216, v217
  v_cvt_pk_bf16_f32 v176, v216, v217
  v_exp_f32 v219, v131
  v_add_f32 v226, v226, v218
  v_exp_f32 v220, v132
  v_add_f32 v226, v226, v219
  v_cvt_pk_bf16_f32 v177, v218, v219
  v_exp_f32 v221, v133
  v_add_f32 v226, v226, v220
  v_exp_f32 v222, v134
  v_add_f32 v226, v226, v221
  v_cvt_pk_bf16_f32 v178, v220, v221
  v_exp_f32 v223, v135
  v_add_f32 v226, v226, v222
  v_exp_f32 v216, v136
  v_add_f32 v226, v226, v223
  v_cvt_pk_bf16_f32 v179, v222, v223
  v_exp_f32 v217, v137
  v_exp_f32 v218, v138
  v_add_f32 v227, v216, v217
  v_cvt_pk_bf16_f32 v180, v216, v217
  v_exp_f32 v219, v139
  v_add_f32 v227, v227, v218
  v_exp_f32 v220, v140
  v_add_f32 v227, v227, v219
  v_cvt_pk_bf16_f32 v181, v218, v219
  v_exp_f32 v221, v141
  v_add_f32 v227, v227, v220
  v_exp_f32 v222, v142
  v_add_f32 v227, v227, v221
  v_cvt_pk_bf16_f32 v182, v220, v221
  v_exp_f32 v223, v143
  v_add_f32 v227, v227, v222
  s_nop 0
  v_add_f32 v227, v227, v223
  v_cvt_pk_bf16_f32 v183, v222, v223
  s_nop 1
  s_setpc_b64 s[76:77]
fa_rare11:
  s_nop 7
  v_max3_f32 v16, v144, v145, v146
  v_max3_f32 v16, v16, v147, v148
  v_max3_f32 v16, v16, v149, v150
  v_max3_f32 v16, v16, v151, 0
  v_mov_b32 v18, v16
  s_nop 1
  v_permlane16_swap_b32 v16, v18
  v_max_f32 v16, v16, v18
  v_mov_b32 v18, v16
  s_nop 1
  v_permlane32_swap_b32 v16, v18
  v_max_f32 v16, v16, v18
  v_sub_f32 v144, v144, v16
  v_sub_f32 v128, v128, v16
  v_sub_f32 v145, v145, v16
  v_sub_f32 v129, v129, v16
  v_sub_f32 v146, v146, v16
  v_sub_f32 v130, v130, v16
  v_sub_f32 v147, v147, v16
  v_sub_f32 v131, v131, v16
  v_sub_f32 v148, v148, v16
  v_sub_f32 v132, v132, v16
  v_sub_f32 v149, v149, v16
  v_sub_f32 v133, v133, v16
  v_sub_f32 v150, v150, v16
  v_sub_f32 v134, v134, v16
  v_sub_f32 v151, v151, v16
  v_sub_f32 v135, v135, v16
  v_max3_f32 v17, v152, v153, v154
  v_max3_f32 v17, v17, v155, v156
  v_max3_f32 v17, v17, v157, v158
  v_max3_f32 v17, v17, v159, 0
  v_mov_b32 v18, v17
  s_nop 1
  v_permlane16_swap_b32 v17, v18
  v_max_f32 v17, v17, v18
  v_mov_b32 v18, v17
  s_nop 1
  v_permlane32_swap_b32 v17, v18
  v_max_f32 v17, v17, v18
  v_sub_f32 v152, v152, v17
  v_sub_f32 v136, v136, v17
  v_sub_f32 v153, v153, v17
  v_sub_f32 v137, v137, v17
  v_sub_f32 v154, v154, v17
  v_sub_f32 v138, v138, v17
  v_sub_f32 v155, v155, v17
  v_sub_f32 v139, v139, v17
  v_sub_f32 v156, v156, v17
  v_sub_f32 v140, v140, v17
  v_sub_f32 v157, v157, v17
  v_sub_f32 v141, v141, v17
  v_sub_f32 v158, v158, v17
  v_sub_f32 v142, v142, v17
  v_sub_f32 v159, v159, v17
  v_sub_f32 v143, v143, v17
  s_call_b64 s[78:79], fa_resc1
  v_exp_f32 v216, v144
  v_exp_f32 v217, v145
  v_exp_f32 v218, v146
  v_add_f32 v226, v216, v217
  v_cvt_pk_bf16_f32 v184, v216, v217
  v_exp_f32 v219, v147
  v_add_f32 v226, v226, v218
  v_exp_f32 v220, v148
  v_add_f32 v226, v226, v219
  v_cvt_pk_bf16_f32 v185, v218, v219
  v_exp_f32 v221, v149
  v_add_f32 v226, v226, v220
  v_exp_f32 v222, v150
  v_add_f32 v226, v226, v221
  v_cvt_pk_bf16_f32 v186, v220, v221
  v_exp_f32 v223, v151
  v_add_f32 v226, v226, v222
  v_exp_f32 v216, v152
  v_add_f32 v226, v226, v223
  v_cvt_pk_bf16_f32 v187, v222, v223
  v_exp_f32 v217, v153
  v_exp_f32 v218, v154
  v_add_f32 v227, v216, v217
  v_cvt_pk_bf16_f32 v188, v216, v217
  v_exp_f32 v219, v155
  v_add_f32 v227, v227, v218
  v_exp_f32 v220, v156
  v_add_f32 v227, v227, v219
  v_cvt_pk_bf16_f32 v189, v218, v219
  v_exp_f32 v221, v157
  v_add_f32 v227, v227, v220
  v_exp_f32 v222, v158
  v_add_f32 v227, v227, v221
  v_cvt_pk_bf16_f32 v190, v220, v221
  v_exp_f32 v223, v159
  v_add_f32 v227, v227, v222
  s_nop 0
  v_add_f32 v227, v227, v223
  v_cvt_pk_bf16_f32 v191, v222, v223
  s_nop 1
  s_setpc_b64 s[76:77]
fa_resc1:
  v_sub_f32 v200, v200, v16
  v_sub_f32 v201, v201, v16
  v_sub_f32 v202, v202, v16
  v_sub_f32 v203, v203, v16
  v_exp_f32 v18, -v16
  v_sub_f32 v204, v204, v17
  v_sub_f32 v205, v205, v17
  v_sub_f32 v206, v206, v17
  v_sub_f32 v207, v207, v17
  v_exp_f32 v19, -v17
  s_nop 0
  v_mul_f32 v230, v230, v18
  v_mul_f32 v231, v231, v19
  v_accvgpr_read_b32 v20, a64
  v_accvgpr_read_b32 v21, a65
  v_accvgpr_read_b32 v22, a66
  v_accvgpr_read_b32 v23, a67
  v_mul_f32 v20, v20, v18
  v_mul_f32 v21, v21, v18
  v_mul_f32 v22, v22, v18
  v_mul_f32 v23, v23, v18
  v_accvgpr_write_b32 a64, v20
  v_accvgpr_write_b32 a65, v21
  v_accvgpr_write_b32 a66, v22
  v_accvgpr_write_b32 a67, v23
  v_accvgpr_read_b32 v20, a68
  v_accvgpr_read_b32 v21, a69
  v_accvgpr_read_b32 v22, a70
  v_accvgpr_read_b32 v23, a71
  v_mul_f32 v20, v20, v19
  v_mul_f32 v21, v21, v19
  v_mul_f32 v22, v22, v19
  v_mul_f32 v23, v23, v19
  v_accvgpr_write_b32 a68, v20
  v_accvgpr_write_b32 a69, v21
  v_accvgpr_write_b32 a70, v22
  v_accvgpr_write_b32 a71, v23
  v_accvgpr_read_b32 v20, a72
  v_accvgpr_read_b32 v21, a73
  v_accvgpr_read_b32 v22, a74
  v_accvgpr_read_b32 v23, a75
  v_mul_f32 v20, v20, v18
  v_mul_f32 v21, v21, v18
  v_mul_f32 v22, v22, v18
  v_mul_f32 v23, v23, v18
  v_accvgpr_write_b32 a72, v20
  v_accvgpr_write_b32 a73, v21
  v_accvgpr_write_b32 a74, v22
  v_accvgpr_write_b32 a75, v23
  v_accvgpr_read_b32 v20, a76
  v_accvgpr_read_b32 v21, a77
  v_accvgpr_read_b32 v22, a78
  v_accvgpr_read_b32 v23, a79
  v_mul_f32 v20, v20, v19
  v_mul_f32 v21, v21, v19
  v_mul_f32 v22, v22, v19
  v_mul_f32 v23, v23, v19
  v_accvgpr_write_b32 a76, v20
  v_accvgpr_write_b32 a77, v21
  v_accvgpr_write_b32 a78, v22
  v_accvgpr_write_b32 a79, v23
  v_accvgpr_read_b32 v20, a80
  v_accvgpr_read_b32 v21, a81
  v_accvgpr_read_b32 v22, a82
  v_accvgpr_read_b32 v23, a83
  v_mul_f32 v20, v20, v18
  v_mul_f32 v21, v21, v18
  v_mul_f32 v22, v22, v18
  v_mul_f32 v23, v23, v18
  v_accvgpr_write_b32 a80, v20
  v_accvgpr_write_b32 a81, v21
  v_accvgpr_write_b32 a82, v22
  v_accvgpr_write_b32 a83, v23
  v_accvgpr_read_b32 v20, a84
  v_accvgpr_read_b32 v21, a85
  v_accvgpr_read_b32 v22, a86
  v_accvgpr_read_b32 v23, a87
  v_mul_f32 v20, v20, v19
  v_mul_f32 v21, v21, v19
  v_mul_f32 v22, v22, v19
  v_mul_f32 v23, v23, v19
  v_accvgpr_write_b32 a84, v20
  v_accvgpr_write_b32 a85, v21
  v_accvgpr_write_b32 a86, v22
  v_accvgpr_write_b32 a87, v23
  v_accvgpr_read_b32 v20, a88
  v_accvgpr_read_b32 v21, a89
  v_accvgpr_read_b32 v22, a90
  v_accvgpr_read_b32 v23, a91
  v_mul_f32 v20, v20, v18
  v_mul_f32 v21, v21, v18
  v_mul_f32 v22, v22, v18
  v_mul_f32 v23, v23, v18
  v_accvgpr_write_b32 a88, v20
  v_accvgpr_write_b32 a89, v21
  v_accvgpr_write_b32 a90, v22
  v_accvgpr_write_b32 a91, v23
  v_accvgpr_read_b32 v20, a92
  v_accvgpr_read_b32 v21, a93
  v_accvgpr_read_b32 v22, a94
  v_accvgpr_read_b32 v23, a95
  v_mul_f32 v20, v20, v19
  v_mul_f32 v21, v21, v19
  v_mul_f32 v22, v22, v19
  v_mul_f32 v23, v23, v19
  v_accvgpr_write_b32 a92, v20
  v_accvgpr_write_b32 a93, v21
  v_accvgpr_write_b32 a94, v22
  v_accvgpr_write_b32 a95, v23
  v_accvgpr_read_b32 v20, a96
  v_accvgpr_read_b32 v21, a97
  v_accvgpr_read_b32 v22, a98
  v_accvgpr_read_b32 v23, a99
  v_mul_f32 v20, v20, v18
  v_mul_f32 v21, v21, v18
  v_mul_f32 v22, v22, v18
  v_mul_f32 v23, v23, v18
  v_accvgpr_write_b32 a96, v20
  v_accvgpr_write_b32 a97, v21
  v_accvgpr_write_b32 a98, v22
  v_accvgpr_write_b32 a99, v23
  v_accvgpr_read_b32 v20, a100
  v_accvgpr_read_b32 v21, a101
  v_accvgpr_read_b32 v22, a102
  v_accvgpr_read_b32 v23, a103
  v_mul_f32 v20, v20, v19
  v_mul_f32 v21, v21, v19
  v_mul_f32 v22, v22, v19
  v_mul_f32 v23, v23, v19
  v_accvgpr_write_b32 a100, v20
  v_accvgpr_write_b32 a101, v21
  v_accvgpr_write_b32 a102, v22
  v_accvgpr_write_b32 a103, v23
  v_accvgpr_read_b32 v20, a104
  v_accvgpr_read_b32 v21, a105
  v_accvgpr_read_b32 v22, a106
  v_accvgpr_read_b32 v23, a107
  v_mul_f32 v20, v20, v18
  v_mul_f32 v21, v21, v18
  v_mul_f32 v22, v22, v18
  v_mul_f32 v23, v23, v18
  v_accvgpr_write_b32 a104, v20
  v_accvgpr_write_b32 a105, v21
  v_accvgpr_write_b32 a106, v22
  v_accvgpr_write_b32 a107, v23
  v_accvgpr_read_b32 v20, a108
  v_accvgpr_read_b32 v21, a109
  v_accvgpr_read_b32 v22, a110
  v_accvgpr_read_b32 v23, a111
  v_mul_f32 v20, v20, v19
  v_mul_f32 v21, v21, v19
  v_mul_f32 v22, v22, v19
  v_mul_f32 v23, v23, v19
  v_accvgpr_write_b32 a108, v20
  v_accvgpr_write_b32 a109, v21
  v_accvgpr_write_b32 a110, v22
  v_accvgpr_write_b32 a111, v23
  v_accvgpr_read_b32 v20, a112
  v_accvgpr_read_b32 v21, a113
  v_accvgpr_read_b32 v22, a114
  v_accvgpr_read_b32 v23, a115
  v_mul_f32 v20, v20, v18
  v_mul_f32 v21, v21, v18
  v_mul_f32 v22, v22, v18
  v_mul_f32 v23, v23, v18
  v_accvgpr_write_b32 a112, v20
  v_accvgpr_write_b32 a113, v21
  v_accvgpr_write_b32 a114, v22
  v_accvgpr_write_b32 a115, v23
  v_accvgpr_read_b32 v20, a116
  v_accvgpr_read_b32 v21, a117
  v_accvgpr_read_b32 v22, a118
  v_accvgpr_read_b32 v23, a119
  v_mul_f32 v20, v20, v19
  v_mul_f32 v21, v21, v19
  v_mul_f32 v22, v22, v19
  v_mul_f32 v23, v23, v19
  v_accvgpr_write_b32 a116, v20
  v_accvgpr_write_b32 a117, v21
  v_accvgpr_write_b32 a118, v22
  v_accvgpr_write_b32 a119, v23
  v_accvgpr_read_b32 v20, a120
  v_accvgpr_read_b32 v21, a121
  v_accvgpr_read_b32 v22, a122
  v_accvgpr_read_b32 v23, a123
  v_mul_f32 v20, v20, v18
  v_mul_f32 v21, v21, v18
  v_mul_f32 v22, v22, v18
  v_mul_f32 v23, v23, v18
  v_accvgpr_write_b32 a120, v20
  v_accvgpr_write_b32 a121, v21
  v_accvgpr_write_b32 a122, v22
  v_accvgpr_write_b32 a123, v23
  v_accvgpr_read_b32 v20, a124
  v_accvgpr_read_b32 v21, a125
  v_accvgpr_read_b32 v22, a126
  v_accvgpr_read_b32 v23, a127
  v_mul_f32 v20, v20, v19
  v_mul_f32 v21, v21, v19
  v_mul_f32 v22, v22, v19
  v_mul_f32 v23, v23, v19
  v_accvgpr_write_b32 a124, v20
  v_accvgpr_write_b32 a125, v21
  v_accvgpr_write_b32 a126, v22
  v_accvgpr_write_b32 a127, v23
  s_setpc_b64 s[78:79]
.section .rodata,"a"
.p2align 6
.amdhsa_kernel fa_kernel
  .amdhsa_next_free_vgpr 512
  .amdhsa_next_free_sgpr 102
  .amdhsa_accum_offset 256
  .amdhsa_group_segment_fixed_size 0
  .amdhsa_kernarg_size 112
  .amdhsa_user_sgpr_count 2
  .amdhsa_user_sgpr_kernarg_segment_ptr 1
  .amdhsa_system_sgpr_workgroup_id_x 1
  .amdhsa_float_denorm_mode_32 3
.end_amdhsa_kernel
.text
```

```asm
; @launch kernel=fa_kernel grid=(256,1,1) block=(256,1,1) lds=163840
.amdgcn_target "amdgcn-amd-amdhsa--gfx950"
.text
.globl fa_kernel
.p2align 8
.type fa_kernel,@function
fa_kernel:
  s_cmp_ge_u32 s2, 256
  s_cbranch_scc1 fa_end
  s_load_dwordx4 s[4:7], s[0:1], 0
  s_load_dwordx2 s[14:15], s[0:1], 56
  s_load_dwordx4 s[8:11], s[0:1], 24
  s_load_dwordx2 s[12:13], s[0:1], 40
  s_load_dwordx4 s[16:19], s[0:1], 96
  s_load_dwordx2 s[60:61], s[0:1], 16
  v_lshrrev_b32 v16, 6, v0
  v_and_b32 v1, 63, v0
  v_readfirstlane_b32 s20, v16
  s_and_b32 s21, s2, 7
  s_lshl_b32 s21, s21, 2
  s_lshr_b32 s23, s2, 3
  s_and_b32 s23, s23, 3
  s_add_u32 s21, s21, s23
  s_lshr_b32 s22, s2, 5
  v_and_b32 v208, 31, v1
  v_lshrrev_b32 v209, 5, v1
  s_lshl_b32 s23, s2, 2
  s_add_u32 s23, s23, s20
  s_lshl_b32 s23, s23, 1
  v_add_u32 v209, s23, v209
  v_lshlrev_b32 v212, 4, v208
  v_mul_u32_u24 v210, 1280, v209
  v_add_u32 v210, v210, v212
  v_cmp_gt_u32 s[64:65], 16, v208
  v_mov_b32 v211, 1073741824
  v_lshlrev_b32 v2, 4, v1
  v_cndmask_b32 v211, v211, v210, s[64:65]
  v_lshrrev_b32 v16, 2, v1
  v_lshrrev_b32 v17, 5, v1
  v_mul_u32_u24 v17, 3, v17
  v_and_b32 v18, 3, v1
  v_xor_b32 v17, v17, v18
  v_lshlrev_b32 v17, 4, v17
  v_lshl_add_u32 v3, v16, 10, v17
  s_lshl_b32 s23, s20, 16
  v_add_u32 v3, s23, v3
  v_add_u32 v4, 15360, v3
  v_add_u32 v5, 30720, v3
  v_add_u32 v6, 46080, v3
  v_and_b32 v16, 3, v16
  v_lshrrev_b32 v17, 4, v1
  v_lshlrev_b32 v17, 6, v17
  v_lshl_add_u32 v16, v16, 13, v17
  s_and_b32 s23, s20, 1
  s_lshl_b32 s23, s23, 17
  v_add_u32 v16, s23, v16
  v_lshl_add_u32 v8, v18, 4, v16
  v_xor_b32 v18, 2, v18
  v_lshl_add_u32 v10, v18, 4, v16
  v_add_u32 v9, 31744, v8
  v_add_u32 v11, 95232, v10
  v_add_u32 v10, 63488, v10
  s_lshl_b32 s24, s20, 12
  s_mov_b32 s26, 0
  s_mov_b32 s27, 0
  s_mov_b32 s25, 262144
  s_mov_b32 s79, 64
  v_bfe_u32 v17, v1, 1, 3
  v_lshlrev_b32 v17, 13, v17
  v_and_b32 v18, 1, v1
  v_lshl_add_u32 v235, v18, 7, v17
  s_lshl_b32 s74, s22, 1
  s_and_b32 s31, s20, 1
  s_add_u32 s74, s74, s31
  s_lshl_b32 s74, s74, 16
  s_mov_b32 s73, 1048576
  s_and_b32 s29, s2, 31
  s_lshl_b32 s29, s29, 2
  s_add_u32 s29, s29, s20
  s_lshl_b32 s29, s29, 11
  v_and_b32 v16, 15, v1
  v_lshlrev_b32 v234, 7, v16
  v_lshlrev_b32 v17, 10, v16
  v_and_b32 v18, 16, v1
  v_lshl_add_u32 v233, v18, 3, v17
  s_and_b32 s30, s21, 3
  s_lshl_b32 s30, s30, 2
  s_add_u32 s30, s30, s20
  s_lshl_b32 s30, s30, 14
  s_waitcnt lgkmcnt(0)
  s_mov_b32 s44, s4
  s_mov_b32 s45, s5
  s_mov_b32 s46, 2621440
  s_mov_b32 s47, 0x20000
  s_mov_b32 s48, s14
  s_mov_b32 s49, s15
  s_mov_b32 s50, 1280
  s_mov_b32 s51, 0x20000
  buffer_load_dwordx4 v[160:163], v210, s[44:47], 0 offen
  buffer_load_dwordx4 v[164:167], v210, s[44:47], 0 offen offset:512
  buffer_load_dwordx4 v[168:171], v211, s[44:47], 0 offen offset:1024
  buffer_load_dwordx4 v[172:175], v212, s[48:51], 0 offen offset:0
  buffer_load_dwordx4 v[176:179], v212, s[48:51], 0 offen offset:512
  buffer_load_dwordx4 v[180:183], v212, s[48:51], 0 offen offset:1024
  s_lshl_b32 s23, s22, 18
  s_add_u32 s62, s6, s23
  s_addc_u32 s63, s7, 0
  s_mov_b32 s32, s62
  s_mov_b32 s33, s63
  s_mov_b32 s34, 262144
  s_mov_b32 s35, 0x20000
  s_cmp_ge_u32 s20, 2
  s_cselect_b32 s62, s10, s8
  s_cselect_b32 s63, s11, s9
  s_lshl_b32 s23, s21, 8
  s_add_u32 s62, s62, s23
  s_addc_u32 s63, s63, 0
  s_mov_b32 s36, s62
  s_mov_b32 s37, s63
  s_mov_b32 s38, 0
  s_mov_b32 s39, 0x20000
  s_sub_u32 s38, 4194304, s23
  buffer_load_dword v231, v235, s[36:39], s74 offen
  buffer_load_dword v232, v233, s[32:35], s30 offen
  s_add_u32 s74, s74, s73
  s_add_u32 s60, s60, s23
  s_addc_u32 s61, s61, 0
  s_sub_u32 s75, 5242880, s23
  s_mov_b32 s48, s62
  s_mov_b32 s49, s63
  s_mov_b32 s50, s38
  s_mov_b32 s51, 0x20000
  s_mov_b32 s40, s18
  s_mov_b32 s41, s19
  s_mov_b32 s42, 67108864
  s_mov_b32 s43, 0x20000
  s_mov_b32 s52, s12
  s_mov_b32 s53, s13
  s_mov_b32 s54, 5242880
  s_mov_b32 s55, 0x20000
  s_mov_b32 s56, s16
  s_mov_b32 s57, s17
  s_mov_b32 s58, 256
  s_mov_b32 s59, 0x20000
  s_lshl_b32 s23, s20, 5
  s_add_u32 s23, s23, s21
  s_lshl_b32 s23, s23, 2
  s_add_u32 s23, s23, 2641920
  s_lshl_b32 s31, s22, 9
  s_add_u32 s80, s23, s31
  s_sub_u32 s31, 7680, s31
  s_add_u32 s3, s23, s31
  s_lshl_b32 s23, s21, 7
  s_lshl_b32 s31, s22, 2
  s_add_u32 s23, s23, s31
  s_add_u32 s82, s23, 2637824
  s_and_b32 s69, s2, 63
  s_lshl_b32 s31, s20, 6
  s_add_u32 s69, s69, s31
  s_lshl_b32 s69, s69, 2
  s_add_u32 s69, s69, 2650112
  s_cmp_ge_u32 s2, 192
  s_cselect_b32 s69, s69, 1073741824
  s_cmp_eq_u32 s20, 0
  s_cselect_b32 s31, s82, 1073741824
  s_cmp_eq_u32 s2, 255
  s_cselect_b32 s23, 2629632, 1073741824
  v_lshl_add_u32 v19, v16, 2, s23
  v_mov_b32 v229, 0
  v_writelane_b32 v19, s80, 0
  v_writelane_b32 v19, s3, 1
  v_writelane_b32 v19, s31, 2
  s_and_b32 s23, s2, 1
  s_lshl_b32 s23, s23, 2
  s_add_u32 s23, s23, s20
  s_lshl_b32 s23, s23, 7
  s_lshr_b32 s31, s2, 1
  s_add_u32 s23, s23, s31
  s_lshl_b32 s23, s23, 2
  s_add_u32 s23, s23, 2654208
  v_writelane_b32 v19, s23, 3
  v_writelane_b32 v19, s69, 4
  buffer_store_dword v229, v19, s[40:43], 0 offen sc1
  s_and_b32 s71, s21, 3
  s_max_u32 s71, s71, 1
  s_lshl_b32 s72, 1, s71
  s_or_b32 s72, s72, 0x68
  s_cmp_eq_u32 s20, 0
  s_cselect_b32 s70, s2, 1073741824
  v_mov_b32 v20, 0
  v_mov_b32 v21, 0
  v_mov_b32 v22, 0
  v_mov_b32 v23, 0
  v_and_b32 v16, 15, v1
  v_lshrrev_b32 v17, 4, v1
  v_lshrrev_b32 v18, 3, v16
  v_mul_u32_u24 v18, 3, v18
  v_xor_b32 v18, v18, v17
  v_lshlrev_b32 v18, 4, v18
  v_lshl_add_u32 v14, v16, 6, v18
  s_and_b32 s23, s20, 1
  s_lshl_b32 s23, s23, 13
  v_add_u32 v14, s23, v14
  v_mfma_f32_32x32x16_bf16 a[0:15], v[20:23], v[20:23], 0
  v_mfma_f32_32x32x16_bf16 a[16:31], v[20:23], v[20:23], 0
  v_mfma_f32_32x32x16_bf16 a[32:47], v[20:23], v[20:23], 0
  v_mfma_f32_32x32x16_bf16 a[48:63], v[20:23], v[20:23], 0
  v_mfma_f32_32x32x16_bf16 a[64:79], v[20:23], v[20:23], 0
  v_mfma_f32_32x32x16_bf16 a[80:95], v[20:23], v[20:23], 0
  v_mfma_f32_32x32x16_bf16 a[96:111], v[20:23], v[20:23], 0
  v_mfma_f32_32x32x16_bf16 a[112:127], v[20:23], v[20:23], 0
  v_mfma_f32_32x32x16_bf16 a[128:143], v[20:23], v[20:23], 0
  v_mfma_f32_32x32x16_bf16 a[144:159], v[20:23], v[20:23], 0
  v_mfma_f32_32x32x16_bf16 a[160:175], v[20:23], v[20:23], 0
  v_mfma_f32_32x32x16_bf16 a[176:191], v[20:23], v[20:23], 0
  v_mfma_f32_32x32x16_bf16 a[192:207], v[20:23], v[20:23], 0
  v_mfma_f32_32x32x16_bf16 a[208:223], v[20:23], v[20:23], 0
  v_mfma_f32_32x32x16_bf16 a[224:239], v[20:23], v[20:23], 0
  v_mfma_f32_32x32x16_bf16 a[240:255], v[20:23], v[20:23], 0
  v_lshrrev_b32 v18, 2, v16
  v_lshlrev_b32 v18, 6, v18
  v_lshl_add_u32 v18, v17, 11, v18
  v_and_b32 v19, 1, v1
  v_lshl_add_u32 v18, v19, 3, v18
  v_bfe_u32 v19, v1, 1, 1
  v_and_b32 v17, 1, v17
  v_lshl_or_b32 v19, v17, 1, v19
  s_lshr_b32 s23, s20, 1
  s_lshl_b32 s23, s23, 13
  s_add_u32 s23, s23, 16384
  v_add_u32 v18, s23, v18
  v_lshl_add_u32 v12, v19, 4, v18
  v_xor_b32 v13, 32, v12
  s_waitcnt vmcnt(3)
  s_mov_b32 m0, s24
  s_nop 0
  buffer_load_dwordx4 v3, s[32:35], s26 offen offset:0 sc1 lds
  buffer_load_dwordx4 v4, s[32:35], s26 offen offset:1024 sc1 lds
  buffer_load_dwordx4 v5, s[32:35], s26 offen offset:2048 sc1 lds
  buffer_load_dwordx4 v6, s[32:35], s26 offen offset:3072 sc1 lds
  s_add_u32 m0, s24, 16384
  s_nop 0
  buffer_load_dwordx4 v8, s[36:39], s27 offen offset:0 lds
  buffer_load_dwordx4 v9, s[36:39], s27 offen offset:1024 lds
  buffer_load_dwordx4 v10, s[36:39], s27 offen offset:2048 lds
  buffer_load_dwordx4 v11, s[36:39], s27 offen offset:3072 lds
  s_add_u32 s26, s26, s79
  s_add_u32 s27, s27, s25
  s_add_u32 s24, s24, 32768
  s_and_b32 s24, s24, 0x1ffff
  v_lshlrev_b32 v184, 16, v160
  v_and_b32 v185, 0xffff0000, v160
  v_lshlrev_b32 v186, 16, v161
  v_and_b32 v187, 0xffff0000, v161
  v_lshlrev_b32 v188, 16, v162
  v_and_b32 v189, 0xffff0000, v162
  v_lshlrev_b32 v190, 16, v163
  v_and_b32 v191, 0xffff0000, v163
  v_lshlrev_b32 v192, 16, v164
  v_and_b32 v193, 0xffff0000, v164
  v_lshlrev_b32 v194, 16, v165
  v_and_b32 v195, 0xffff0000, v165
  v_lshlrev_b32 v196, 16, v166
  v_and_b32 v197, 0xffff0000, v166
  v_lshlrev_b32 v198, 16, v167
  v_and_b32 v199, 0xffff0000, v167
  v_lshlrev_b32 v200, 16, v168
  v_and_b32 v201, 0xffff0000, v168
  v_lshlrev_b32 v202, 16, v169
  v_and_b32 v203, 0xffff0000, v169
  v_lshlrev_b32 v204, 16, v170
  v_and_b32 v205, 0xffff0000, v170
  v_lshlrev_b32 v206, 16, v171
  v_and_b32 v207, 0xffff0000, v171
  v_add_f32 v213, v184, v185
  v_add_f32 v214, v186, v187
  v_add_f32 v213, v213, v188
  v_add_f32 v214, v214, v189
  v_add_f32 v213, v213, v190
  v_add_f32 v214, v214, v191
  v_add_f32 v213, v213, v192
  v_add_f32 v214, v214, v193
  v_add_f32 v213, v213, v194
  v_add_f32 v214, v214, v195
  v_add_f32 v213, v213, v196
  v_add_f32 v214, v214, v197
  v_add_f32 v213, v213, v198
  v_add_f32 v214, v214, v199
  v_add_f32 v213, v213, v200
  v_add_f32 v214, v214, v201
  v_add_f32 v213, v213, v202
  v_add_f32 v214, v214, v203
  v_add_f32 v213, v213, v204
  v_add_f32 v214, v214, v205
  v_add_f32 v213, v213, v206
  v_add_f32 v214, v214, v207
  v_add_f32 v213, v213, v214
  s_nop 1
  v_add_f32_dpp v213, v213, v213 quad_perm:[1,0,3,2] row_mask:0xf bank_mask:0xf
  s_nop 1
  v_add_f32_dpp v213, v213, v213 quad_perm:[2,3,0,1] row_mask:0xf bank_mask:0xf
  s_nop 1
  v_add_f32_dpp v213, v213, v213 row_half_mirror row_mask:0xf bank_mask:0xf
  s_nop 1
  v_add_f32_dpp v213, v213, v213 row_mirror row_mask:0xf bank_mask:0xf
  v_mov_b32 v214, v213
  s_nop 1
  v_permlane16_swap_b32 v213, v214
  v_add_f32 v213, v213, v214
  v_mul_f32 v215, 0x3acccccd, v213
  v_mov_b32 v218, 0
  v_mov_b32 v213, 0
  v_sub_f32 v16, v184, v215
  v_fmac_f32 v218, v16, v16
  v_sub_f32 v17, v185, v215
  v_fmac_f32 v218, v17, v17
  v_sub_f32 v18, v186, v215
  v_fmac_f32 v218, v18, v18
  v_sub_f32 v19, v187, v215
  v_fmac_f32 v218, v19, v19
  v_sub_f32 v16, v188, v215
  v_fmac_f32 v218, v16, v16
  v_sub_f32 v17, v189, v215
  v_fmac_f32 v218, v17, v17
  v_sub_f32 v18, v190, v215
  v_fmac_f32 v218, v18, v18
  v_sub_f32 v19, v191, v215
  v_fmac_f32 v218, v19, v19
  v_sub_f32 v16, v192, v215
  v_fmac_f32 v218, v16, v16
  v_sub_f32 v17, v193, v215
  v_fmac_f32 v218, v17, v17
  v_sub_f32 v18, v194, v215
  v_fmac_f32 v218, v18, v18
  v_sub_f32 v19, v195, v215
  v_fmac_f32 v218, v19, v19
  v_sub_f32 v16, v196, v215
  v_fmac_f32 v218, v16, v16
  v_sub_f32 v17, v197, v215
  v_fmac_f32 v218, v17, v17
  v_sub_f32 v18, v198, v215
  v_fmac_f32 v218, v18, v18
  v_sub_f32 v19, v199, v215
  v_fmac_f32 v218, v19, v19
  v_sub_f32 v16, v200, v215
  v_fmac_f32 v213, v16, v16
  v_sub_f32 v17, v201, v215
  v_fmac_f32 v213, v17, v17
  v_sub_f32 v18, v202, v215
  v_fmac_f32 v213, v18, v18
  v_sub_f32 v19, v203, v215
  v_fmac_f32 v213, v19, v19
  v_sub_f32 v16, v204, v215
  v_fmac_f32 v213, v16, v16
  v_sub_f32 v17, v205, v215
  v_fmac_f32 v213, v17, v17
  v_sub_f32 v18, v206, v215
  v_fmac_f32 v213, v18, v18
  v_sub_f32 v19, v207, v215
  v_fmac_f32 v213, v19, v19
  v_cndmask_b32 v213, 0, v213, s[64:65]
  v_add_f32 v213, v213, v218
  s_nop 1
  v_add_f32_dpp v213, v213, v213 quad_perm:[1,0,3,2] row_mask:0xf bank_mask:0xf
  s_nop 1
  v_add_f32_dpp v213, v213, v213 quad_perm:[2,3,0,1] row_mask:0xf bank_mask:0xf
  s_nop 1
  v_add_f32_dpp v213, v213, v213 row_half_mirror row_mask:0xf bank_mask:0xf
  s_nop 1
  v_add_f32_dpp v213, v213, v213 row_mirror row_mask:0xf bank_mask:0xf
  v_mov_b32 v214, v213
  s_nop 1
  v_permlane16_swap_b32 v213, v214
  v_add_f32 v213, v213, v214
  v_mul_f32 v213, 0x3acccccd, v213
  v_cvt_pk_bf16_f32 v213, v213, v213
  v_and_b32 v213, 0xffff0000, v213
  v_add_f32 v213, 0x3727c5ac, v213
  v_cvt_pk_bf16_f32 v213, v213, v213
  v_and_b32 v213, 0xffff0000, v213
  v_sqrt_f32 v213, v213
  v_mov_b32 v216, v215
  v_cvt_pk_bf16_f32 v213, v213, v213
  v_and_b32 v213, 0xffff0000, v213
  v_rcp_f32 v217, v213
  v_cvt_pk_bf16_f32 v216, v216, v216
  v_and_b32 v216, 0xffff0000, v216
  s_mov_b32 m0, s24
  s_nop 0
  buffer_load_dwordx4 v3, s[32:35], s26 offen offset:0 sc1 lds
  buffer_load_dwordx4 v4, s[32:35], s26 offen offset:1024 sc1 lds
  buffer_load_dwordx4 v5, s[32:35], s26 offen offset:2048 sc1 lds
  buffer_load_dwordx4 v6, s[32:35], s26 offen offset:3072 sc1 lds
  s_add_u32 m0, s24, 16384
  s_nop 0
  buffer_load_dwordx4 v8, s[36:39], s27 offen offset:0 lds
  buffer_load_dwordx4 v9, s[36:39], s27 offen offset:1024 lds
  buffer_load_dwordx4 v10, s[36:39], s27 offen offset:2048 lds
  buffer_load_dwordx4 v11, s[36:39], s27 offen offset:3072 lds
  s_add_u32 s26, s26, s79
  s_add_u32 s27, s27, s25
  s_add_u32 s24, s24, 32768
  s_and_b32 s24, s24, 0x1ffff
  v_mov_b32 v218, 0
  v_sub_f32 v184, v184, v216
  v_sub_f32 v185, v185, v216
  v_cvt_pk_bf16_f32 v16, v184, v185
  v_lshlrev_b32 v184, 16, v16
  v_and_b32 v185, 0xffff0000, v16
  v_mul_f32 v184, v184, v217
  v_mul_f32 v185, v185, v217
  v_cvt_pk_bf16_f32 v160, v184, v185
  v_lshlrev_b32 v184, 16, v160
  v_and_b32 v185, 0xffff0000, v160
  v_lshlrev_b32 v17, 16, v172
  v_and_b32 v18, 0xffff0000, v172
  v_fmac_f32 v218, v184, v17
  v_fmac_f32 v218, v185, v18
  v_sub_f32 v186, v186, v216
  v_sub_f32 v187, v187, v216
  v_cvt_pk_bf16_f32 v16, v186, v187
  v_lshlrev_b32 v186, 16, v16
  v_and_b32 v187, 0xffff0000, v16
  v_mul_f32 v186, v186, v217
  v_mul_f32 v187, v187, v217
  v_cvt_pk_bf16_f32 v161, v186, v187
  v_lshlrev_b32 v186, 16, v161
  v_and_b32 v187, 0xffff0000, v161
  v_lshlrev_b32 v17, 16, v173
  v_and_b32 v18, 0xffff0000, v173
  v_fmac_f32 v218, v186, v17
  v_fmac_f32 v218, v187, v18
  v_sub_f32 v188, v188, v216
  v_sub_f32 v189, v189, v216
  v_cvt_pk_bf16_f32 v16, v188, v189
  v_lshlrev_b32 v188, 16, v16
  v_and_b32 v189, 0xffff0000, v16
  v_mul_f32 v188, v188, v217
  v_mul_f32 v189, v189, v217
  v_cvt_pk_bf16_f32 v162, v188, v189
  v_lshlrev_b32 v188, 16, v162
  v_and_b32 v189, 0xffff0000, v162
  v_lshlrev_b32 v17, 16, v174
  v_and_b32 v18, 0xffff0000, v174
  v_fmac_f32 v218, v188, v17
  v_fmac_f32 v218, v189, v18
  v_sub_f32 v190, v190, v216
  v_sub_f32 v191, v191, v216
  v_cvt_pk_bf16_f32 v16, v190, v191
  v_lshlrev_b32 v190, 16, v16
  v_and_b32 v191, 0xffff0000, v16
  v_mul_f32 v190, v190, v217
  v_mul_f32 v191, v191, v217
  v_cvt_pk_bf16_f32 v163, v190, v191
  v_lshlrev_b32 v190, 16, v163
  v_and_b32 v191, 0xffff0000, v163
  v_lshlrev_b32 v17, 16, v175
  v_and_b32 v18, 0xffff0000, v175
  v_fmac_f32 v218, v190, v17
  v_fmac_f32 v218, v191, v18
  v_sub_f32 v192, v192, v216
  v_sub_f32 v193, v193, v216
  v_cvt_pk_bf16_f32 v16, v192, v193
  v_lshlrev_b32 v192, 16, v16
  v_and_b32 v193, 0xffff0000, v16
  v_mul_f32 v192, v192, v217
  v_mul_f32 v193, v193, v217
  v_cvt_pk_bf16_f32 v164, v192, v193
  v_lshlrev_b32 v192, 16, v164
  v_and_b32 v193, 0xffff0000, v164
  v_lshlrev_b32 v17, 16, v176
  v_and_b32 v18, 0xffff0000, v176
  v_fmac_f32 v218, v192, v17
  v_fmac_f32 v218, v193, v18
  v_sub_f32 v194, v194, v216
  v_sub_f32 v195, v195, v216
  v_cvt_pk_bf16_f32 v16, v194, v195
  v_lshlrev_b32 v194, 16, v16
  v_and_b32 v195, 0xffff0000, v16
  v_mul_f32 v194, v194, v217
  v_mul_f32 v195, v195, v217
  v_cvt_pk_bf16_f32 v165, v194, v195
  v_lshlrev_b32 v194, 16, v165
  v_and_b32 v195, 0xffff0000, v165
  v_lshlrev_b32 v17, 16, v177
  v_and_b32 v18, 0xffff0000, v177
  v_fmac_f32 v218, v194, v17
  v_fmac_f32 v218, v195, v18
  v_sub_f32 v196, v196, v216
  v_sub_f32 v197, v197, v216
  v_cvt_pk_bf16_f32 v16, v196, v197
  v_lshlrev_b32 v196, 16, v16
  v_and_b32 v197, 0xffff0000, v16
  v_mul_f32 v196, v196, v217
  v_mul_f32 v197, v197, v217
  v_cvt_pk_bf16_f32 v166, v196, v197
  v_lshlrev_b32 v196, 16, v166
  v_and_b32 v197, 0xffff0000, v166
  v_lshlrev_b32 v17, 16, v178
  v_and_b32 v18, 0xffff0000, v178
  v_fmac_f32 v218, v196, v17
  v_fmac_f32 v218, v197, v18
  v_sub_f32 v198, v198, v216
  v_sub_f32 v199, v199, v216
  v_cvt_pk_bf16_f32 v16, v198, v199
  v_lshlrev_b32 v198, 16, v16
  v_and_b32 v199, 0xffff0000, v16
  v_mul_f32 v198, v198, v217
  v_mul_f32 v199, v199, v217
  v_cvt_pk_bf16_f32 v167, v198, v199
  v_lshlrev_b32 v198, 16, v167
  v_and_b32 v199, 0xffff0000, v167
  v_lshlrev_b32 v17, 16, v179
  v_and_b32 v18, 0xffff0000, v179
  v_fmac_f32 v218, v198, v17
  v_fmac_f32 v218, v199, v18
  v_sub_f32 v200, v200, v216
  v_sub_f32 v201, v201, v216
  v_cvt_pk_bf16_f32 v16, v200, v201
  v_lshlrev_b32 v200, 16, v16
  v_and_b32 v201, 0xffff0000, v16
  v_mul_f32 v200, v200, v217
  v_mul_f32 v201, v201, v217
  v_cvt_pk_bf16_f32 v168, v200, v201
  v_lshlrev_b32 v200, 16, v168
  v_and_b32 v201, 0xffff0000, v168
  v_lshlrev_b32 v17, 16, v180
  v_and_b32 v18, 0xffff0000, v180
  v_fmac_f32 v218, v200, v17
  v_fmac_f32 v218, v201, v18
  v_sub_f32 v202, v202, v216
  v_sub_f32 v203, v203, v216
  v_cvt_pk_bf16_f32 v16, v202, v203
  v_lshlrev_b32 v202, 16, v16
  v_and_b32 v203, 0xffff0000, v16
  v_mul_f32 v202, v202, v217
  v_mul_f32 v203, v203, v217
  v_cvt_pk_bf16_f32 v169, v202, v203
  v_lshlrev_b32 v202, 16, v169
  v_and_b32 v203, 0xffff0000, v169
  v_lshlrev_b32 v17, 16, v181
  v_and_b32 v18, 0xffff0000, v181
  v_fmac_f32 v218, v202, v17
  v_fmac_f32 v218, v203, v18
  v_sub_f32 v204, v204, v216
  v_sub_f32 v205, v205, v216
  v_cvt_pk_bf16_f32 v16, v204, v205
  v_lshlrev_b32 v204, 16, v16
  v_and_b32 v205, 0xffff0000, v16
  v_mul_f32 v204, v204, v217
  v_mul_f32 v205, v205, v217
  v_cvt_pk_bf16_f32 v170, v204, v205
  v_lshlrev_b32 v204, 16, v170
  v_and_b32 v205, 0xffff0000, v170
  v_lshlrev_b32 v17, 16, v182
  v_and_b32 v18, 0xffff0000, v182
  v_fmac_f32 v218, v204, v17
  v_fmac_f32 v218, v205, v18
  v_sub_f32 v206, v206, v216
  v_sub_f32 v207, v207, v216
  v_cvt_pk_bf16_f32 v16, v206, v207
  v_lshlrev_b32 v206, 16, v16
  v_and_b32 v207, 0xffff0000, v16
  v_mul_f32 v206, v206, v217
  v_mul_f32 v207, v207, v217
  v_cvt_pk_bf16_f32 v171, v206, v207
  v_lshlrev_b32 v206, 16, v171
  v_and_b32 v207, 0xffff0000, v171
  v_lshlrev_b32 v17, 16, v183
  v_and_b32 v18, 0xffff0000, v183
  v_fmac_f32 v218, v206, v17
  v_fmac_f32 v218, v207, v18
  s_mov_b32 m0, s24
  s_nop 0
  buffer_load_dwordx4 v3, s[32:35], s26 offen offset:0 sc1 lds
  buffer_load_dwordx4 v4, s[32:35], s26 offen offset:1024 sc1 lds
  buffer_load_dwordx4 v5, s[32:35], s26 offen offset:2048 sc1 lds
  buffer_load_dwordx4 v6, s[32:35], s26 offen offset:3072 sc1 lds
  s_add_u32 m0, s24, 16384
  s_nop 0
  buffer_load_dwordx4 v8, s[36:39], s27 offen offset:0 lds
  buffer_load_dwordx4 v9, s[36:39], s27 offen offset:1024 lds
  buffer_load_dwordx4 v10, s[36:39], s27 offen offset:2048 lds
  buffer_load_dwordx4 v11, s[36:39], s27 offen offset:3072 lds
  s_add_u32 s26, s26, s79
  s_add_u32 s27, s27, s25
  s_add_u32 s24, s24, 32768
  s_and_b32 s24, s24, 0x1ffff
  v_and_b32 v16, 7, v209
  v_lshlrev_b32 v16, 4, v16
  v_lshl_add_u32 v16, v208, 7, v16
  v_add_u32 v16, 131072, v16
  ds_write_b128 v16, v[160:163] offset:0
  ds_write_b128 v16, v[164:167] offset:4096
  ds_write_b128 v16, v[168:171] offset:8192
  s_nop 1
  v_add_f32_dpp v218, v218, v218 quad_perm:[1,0,3,2] row_mask:0xf bank_mask:0xf
  s_nop 1
  v_add_f32_dpp v218, v218, v218 quad_perm:[2,3,0,1] row_mask:0xf bank_mask:0xf
  s_nop 1
  v_add_f32_dpp v218, v218, v218 row_half_mirror row_mask:0xf bank_mask:0xf
  s_nop 1
  v_add_f32_dpp v218, v218, v218 row_mirror row_mask:0xf bank_mask:0xf
  v_mov_b32 v214, v218
  s_nop 1
  v_permlane16_swap_b32 v218, v214
  v_add_f32 v218, v218, v214
  v_cvt_pk_bf16_f32 v218, v218, v218
  v_and_b32 v218, 0xffff0000, v218
  v_ashrrev_i32 v214, 31, v218
  v_or_b32 v214, 0x80000000, v214
  v_xor_b32 v218, v218, v214
  v_and_b32 v218, 0xffff0000, v218
  v_sub_u32 v214, 0xffff, v209
  v_or_b32 v218, v218, v214
  v_lshlrev_b32 v214, 2, v209
  v_add_u32 v214, 2621440, v214
  v_mov_b32 v19, 1073741824
  v_cmp_eq_u32 vcc, 0, v208
  v_lshlrev_b32 v16, 4, v0
  v_add_u32 v16, 131072, v16
  v_cndmask_b32 v214, v19, v214, vcc
  v_lshrrev_b32 v17, 3, v0
  v_and_b32 v18, 7, v0
  v_lshlrev_b32 v18, 4, v18
  v_lshl_add_u32 v17, v17, 8, v18
  v_cmp_gt_u32 vcc, 128, v0
  s_lshr_b32 s23, s2, 1
  s_mul_i32 s23, s23, 20480
  s_and_b32 s31, s2, 1
  s_lshl_b32 s31, s31, 7
  s_add_u32 s23, s23, s31
  v_cndmask_b32 v18, v19, v17, vcc
  s_mov_b32 s66, s23
  s_add_u32 s67, s23, 8192
  s_add_u32 s68, s23, 16384
  s_mov_b32 m0, s24
  s_nop 0
  buffer_load_dwordx4 v3, s[32:35], s26 offen offset:0 sc1 lds
  buffer_load_dwordx4 v4, s[32:35], s26 offen offset:1024 sc1 lds
  buffer_load_dwordx4 v5, s[32:35], s26 offen offset:2048 sc1 lds
  buffer_load_dwordx4 v6, s[32:35], s26 offen offset:3072 sc1 lds
  s_add_u32 m0, s24, 16384
  s_nop 0
  buffer_load_dwordx4 v8, s[36:39], s27 offen offset:0 lds
  buffer_load_dwordx4 v9, s[36:39], s27 offen offset:1024 lds
  buffer_load_dwordx4 v10, s[36:39], s27 offen offset:2048 lds
  buffer_load_dwordx4 v11, s[36:39], s27 offen offset:3072 lds
  s_add_u32 s26, s26, s79
  s_add_u32 s27, s27, s25
  s_add_u32 s24, s24, 32768
  s_and_b32 s24, s24, 0x1ffff
  s_waitcnt vmcnt(24) lgkmcnt(0)
  s_barrier
  ds_read_b128 v[160:163], v16 offset:0
  ds_read_b128 v[164:167], v16 offset:4096
  ds_read_b128 v[168:171], v16 offset:8192
  buffer_load_dword v231, v235, s[36:39], s74 offen
  buffer_load_dword v232, v234, s[32:35], s29 offen
  s_getpc_b64 s[62:63]
fa_pc:
  s_lshr_b32 s23, s2, 3
  s_and_b32 s23, s23, 15
  s_lshl_b32 s23, s23, 2
  s_add_u32 s23, s23, s20
  s_lshl_b32 s23, s23, 11
  s_min_u32 s23, s23, fa_codeend-fa_pc-2048
  v_add_u32 v234, s23, v234
  global_load_dword v231, v234, s[62:63]
  buffer_store_dword v218, v214, s[40:43], 0 offen sc1
  s_mov_b32 s28, 0
  s_waitcnt lgkmcnt(0)
  buffer_store_dwordx4 v[160:163], v17, s[40:43], s66 offen sc1
  buffer_store_dwordx4 v[164:167], v17, s[40:43], s67 offen sc1
  buffer_store_dwordx4 v[168:171], v18, s[40:43], s68 offen sc1
  s_cmp_ge_u32 s20, 2
  s_cbranch_scc1 fa_roleV
  ds_read_b128 v[96:99], v14 offset:0
  ds_read_b128 v[100:103], v14 offset:1024
  ds_read_b128 v[104:107], v14 offset:2048
  ds_read_b128 v[108:111], v14 offset:3072
  ds_read_b128 v[112:115], v14 offset:4096
  ds_read_b128 v[116:119], v14 offset:5120
  ds_read_b128 v[120:123], v14 offset:6144
  ds_read_b128 v[124:127], v14 offset:7168
  ds_read_b64_tr_b16 v[32:33], v12 offset:0
  ds_read_b64_tr_b16 v[34:35], v12 offset:1024
  ds_read_b64_tr_b16 v[36:37], v13 offset:0
  ds_read_b64_tr_b16 v[38:39], v13 offset:1024
  ds_read_b64_tr_b16 v[40:41], v12 offset:256
  ds_read_b64_tr_b16 v[42:43], v12 offset:1280
  ds_read_b64_tr_b16 v[44:45], v13 offset:256
  ds_read_b64_tr_b16 v[46:47], v13 offset:1280
  ds_read_b64_tr_b16 v[48:49], v12 offset:512
  ds_read_b64_tr_b16 v[50:51], v12 offset:1536
  ds_read_b64_tr_b16 v[52:53], v13 offset:512
  ds_read_b64_tr_b16 v[54:55], v13 offset:1536
  ds_read_b64_tr_b16 v[56:57], v12 offset:768
  ds_read_b64_tr_b16 v[58:59], v12 offset:1792
  ds_read_b64_tr_b16 v[60:61], v13 offset:768
  ds_read_b64_tr_b16 v[62:63], v13 offset:1792
  s_waitcnt lgkmcnt(0)
.p2align 6
fa_loopK:
  v_mfma_f32_16x16x32_bf16 a[0:3], v[32:35], v[96:99], a[0:3]
  s_waitcnt vmcnt(17)
  v_mfma_f32_16x16x32_bf16 a[4:7], v[32:35], v[100:103], a[4:7]
  s_barrier
  v_mfma_f32_16x16x32_bf16 a[8:11], v[32:35], v[104:107], a[8:11]
  s_bitcmp1_b32 s72, s28
  ds_read_b64_tr_b16 v[64:65], v12 offset:32768
  v_mfma_f32_16x16x32_bf16 a[12:15], v[32:35], v[108:111], a[12:15]
  s_cbranch_scc1 fa_p1stubK
fa_p1backK:
  v_mfma_f32_16x16x32_bf16 a[16:19], v[32:35], v[112:115], a[16:19]
  s_mov_b32 m0, s24
  ds_read_b64_tr_b16 v[66:67], v12 offset:33792
  v_mfma_f32_16x16x32_bf16 a[20:23], v[32:35], v[116:119], a[20:23]
  buffer_load_dwordx4 v3, s[32:35], s26 offen offset:0 sc1 lds
  v_mfma_f32_16x16x32_bf16 a[24:27], v[32:35], v[120:123], a[24:27]
  ds_read_b128 v[128:131], v14 offset:32768
  v_mfma_f32_16x16x32_bf16 a[28:31], v[32:35], v[124:127], a[28:31]
  buffer_load_dwordx4 v4, s[32:35], s26 offen offset:1024 sc1 lds
  v_mfma_f32_16x16x32_bf16 a[32:35], v[36:39], v[96:99], a[32:35]
  ds_read_b64_tr_b16 v[68:69], v13 offset:32768
  v_mfma_f32_16x16x32_bf16 a[36:39], v[36:39], v[100:103], a[36:39]
  buffer_load_dwordx4 v5, s[32:35], s26 offen offset:2048 sc1 lds
  v_mfma_f32_16x16x32_bf16 a[40:43], v[36:39], v[104:107], a[40:43]
  ds_read_b64_tr_b16 v[70:71], v13 offset:33792
  v_mfma_f32_16x16x32_bf16 a[44:47], v[36:39], v[108:111], a[44:47]
  buffer_load_dwordx4 v6, s[32:35], s26 offen offset:3072 sc1 lds
  v_mfma_f32_16x16x32_bf16 a[48:51], v[36:39], v[112:115], a[48:51]
  s_add_u32 m0, s24, 16384
  ds_read_b128 v[132:135], v14 offset:33792
  v_mfma_f32_16x16x32_bf16 a[52:55], v[36:39], v[116:119], a[52:55]
  buffer_load_dwordx4 v8, s[36:39], s27 offen offset:0 lds
  v_mfma_f32_16x16x32_bf16 a[56:59], v[36:39], v[120:123], a[56:59]
  ds_read_b64_tr_b16 v[72:73], v12 offset:33024
  v_mfma_f32_16x16x32_bf16 a[60:63], v[36:39], v[124:127], a[60:63]
  buffer_load_dwordx4 v9, s[36:39], s27 offen offset:1024 lds
  v_mfma_f32_16x16x32_bf16 a[64:67], v[40:43], v[96:99], a[64:67]
  ds_read_b64_tr_b16 v[74:75], v12 offset:34048
  v_mfma_f32_16x16x32_bf16 a[68:71], v[40:43], v[100:103], a[68:71]
  buffer_load_dwordx4 v10, s[36:39], s27 offen offset:2048 lds
  v_mfma_f32_16x16x32_bf16 a[72:75], v[40:43], v[104:107], a[72:75]
  ds_read_b128 v[136:139], v14 offset:34816
  v_mfma_f32_16x16x32_bf16 a[76:79], v[40:43], v[108:111], a[76:79]
  buffer_load_dwordx4 v11, s[36:39], s27 offen offset:3072 lds
  v_mfma_f32_16x16x32_bf16 a[80:83], v[40:43], v[112:115], a[80:83]
  ds_read_b64_tr_b16 v[76:77], v13 offset:33024
  v_mfma_f32_16x16x32_bf16 a[84:87], v[40:43], v[116:119], a[84:87]
  buffer_load_dword v231, v235, s[48:51], s74 offen
  v_mfma_f32_16x16x32_bf16 a[88:91], v[40:43], v[120:123], a[88:91]
  s_add_u32 s74, s74, s73
  ds_read_b64_tr_b16 v[78:79], v13 offset:34048
  v_mfma_f32_16x16x32_bf16 a[92:95], v[40:43], v[124:127], a[92:95]
  v_mfma_f32_16x16x32_bf16 a[96:99], v[44:47], v[96:99], a[96:99]
  ds_read_b128 v[140:143], v14 offset:35840
  v_mfma_f32_16x16x32_bf16 a[100:103], v[44:47], v[100:103], a[100:103]
  v_mfma_f32_16x16x32_bf16 a[104:107], v[44:47], v[104:107], a[104:107]
  ds_read_b64_tr_b16 v[80:81], v12 offset:33280
  v_mfma_f32_16x16x32_bf16 a[108:111], v[44:47], v[108:111], a[108:111]
  v_mfma_f32_16x16x32_bf16 a[112:115], v[44:47], v[112:115], a[112:115]
  ds_read_b64_tr_b16 v[82:83], v12 offset:34304
  v_mfma_f32_16x16x32_bf16 a[116:119], v[44:47], v[116:119], a[116:119]
  v_mfma_f32_16x16x32_bf16 a[120:123], v[44:47], v[120:123], a[120:123]
  ds_read_b128 v[144:147], v14 offset:36864
  v_mfma_f32_16x16x32_bf16 a[124:127], v[44:47], v[124:127], a[124:127]
  v_mfma_f32_16x16x32_bf16 a[128:131], v[48:51], v[96:99], a[128:131]
  ds_read_b64_tr_b16 v[84:85], v13 offset:33280
  v_mfma_f32_16x16x32_bf16 a[132:135], v[48:51], v[100:103], a[132:135]
  v_mfma_f32_16x16x32_bf16 a[136:139], v[48:51], v[104:107], a[136:139]
  ds_read_b64_tr_b16 v[86:87], v13 offset:34304
  v_mfma_f32_16x16x32_bf16 a[140:143], v[48:51], v[108:111], a[140:143]
  v_mfma_f32_16x16x32_bf16 a[144:147], v[48:51], v[112:115], a[144:147]
  ds_read_b128 v[148:151], v14 offset:37888
  v_mfma_f32_16x16x32_bf16 a[148:151], v[48:51], v[116:119], a[148:151]
  v_mfma_f32_16x16x32_bf16 a[152:155], v[48:51], v[120:123], a[152:155]
  ds_read_b64_tr_b16 v[88:89], v12 offset:33536
  v_mfma_f32_16x16x32_bf16 a[156:159], v[48:51], v[124:127], a[156:159]
  v_mfma_f32_16x16x32_bf16 a[160:163], v[52:55], v[96:99], a[160:163]
  ds_read_b64_tr_b16 v[90:91], v12 offset:34560
  v_mfma_f32_16x16x32_bf16 a[164:167], v[52:55], v[100:103], a[164:167]
  v_mfma_f32_16x16x32_bf16 a[168:171], v[52:55], v[104:107], a[168:171]
  ds_read_b128 v[152:155], v14 offset:38912
  v_mfma_f32_16x16x32_bf16 a[172:175], v[52:55], v[108:111], a[172:175]
  v_mfma_f32_16x16x32_bf16 a[176:179], v[52:55], v[112:115], a[176:179]
  ds_read_b64_tr_b16 v[92:93], v13 offset:33536
  v_mfma_f32_16x16x32_bf16 a[180:183], v[52:55], v[116:119], a[180:183]
  v_mfma_f32_16x16x32_bf16 a[184:187], v[52:55], v[120:123], a[184:187]
  ds_read_b64_tr_b16 v[94:95], v13 offset:34560
  v_mfma_f32_16x16x32_bf16 a[188:191], v[52:55], v[124:127], a[188:191]
  v_mfma_f32_16x16x32_bf16 a[192:195], v[56:59], v[96:99], a[192:195]
  s_add_u32 s26, s26, s79
  ds_read_b128 v[156:159], v14 offset:39936
  v_mfma_f32_16x16x32_bf16 a[196:199], v[56:59], v[100:103], a[196:199]
  s_add_u32 s27, s27, s25
  v_mfma_f32_16x16x32_bf16 a[200:203], v[56:59], v[104:107], a[200:203]
  s_add_u32 s24, s24, 32768
  v_mfma_f32_16x16x32_bf16 a[204:207], v[56:59], v[108:111], a[204:207]
  s_and_b32 s24, s24, 0x1ffff
  v_mfma_f32_16x16x32_bf16 a[208:211], v[56:59], v[112:115], a[208:211]
  v_xor_b32 v14, 0x10000, v14
  v_mfma_f32_16x16x32_bf16 a[212:215], v[56:59], v[116:119], a[212:215]
  v_xor_b32 v12, 0x10000, v12
  v_mfma_f32_16x16x32_bf16 a[216:219], v[56:59], v[120:123], a[216:219]
  v_xor_b32 v13, 0x10000, v13
  v_mfma_f32_16x16x32_bf16 a[220:223], v[56:59], v[124:127], a[220:223]
  v_mfma_f32_16x16x32_bf16 a[224:227], v[60:63], v[96:99], a[224:227]
  v_mfma_f32_16x16x32_bf16 a[228:231], v[60:63], v[100:103], a[228:231]
  v_mfma_f32_16x16x32_bf16 a[232:235], v[60:63], v[104:107], a[232:235]
  v_mfma_f32_16x16x32_bf16 a[236:239], v[60:63], v[108:111], a[236:239]
  v_mfma_f32_16x16x32_bf16 a[240:243], v[60:63], v[112:115], a[240:243]
  v_mfma_f32_16x16x32_bf16 a[244:247], v[60:63], v[116:119], a[244:247]
  v_mfma_f32_16x16x32_bf16 a[248:251], v[60:63], v[120:123], a[248:251]
  v_mfma_f32_16x16x32_bf16 a[252:255], v[60:63], v[124:127], a[252:255]
  s_waitcnt lgkmcnt(0)
  v_mfma_f32_16x16x32_bf16 a[0:3], v[64:67], v[128:131], a[0:3]
  s_waitcnt vmcnt(18)
  v_mfma_f32_16x16x32_bf16 a[4:7], v[64:67], v[132:135], a[4:7]
  s_barrier
  v_mfma_f32_16x16x32_bf16 a[8:11], v[64:67], v[136:139], a[8:11]
  ds_read_b64_tr_b16 v[32:33], v12 offset:0
  v_mfma_f32_16x16x32_bf16 a[12:15], v[64:67], v[140:143], a[12:15]
  v_mfma_f32_16x16x32_bf16 a[16:19], v[64:67], v[144:147], a[16:19]
  s_mov_b32 m0, s24
  ds_read_b64_tr_b16 v[34:35], v12 offset:1024
  v_mfma_f32_16x16x32_bf16 a[20:23], v[64:67], v[148:151], a[20:23]
  buffer_load_dwordx4 v3, s[32:35], s26 offen offset:0 sc1 lds
  v_mfma_f32_16x16x32_bf16 a[24:27], v[64:67], v[152:155], a[24:27]
  ds_read_b128 v[96:99], v14 offset:0
  v_mfma_f32_16x16x32_bf16 a[28:31], v[64:67], v[156:159], a[28:31]
  v_mfma_f32_16x16x32_bf16 a[32:35], v[68:71], v[128:131], a[32:35]
  ds_read_b64_tr_b16 v[36:37], v13 offset:0
  v_mfma_f32_16x16x32_bf16 a[36:39], v[68:71], v[132:135], a[36:39]
  v_mfma_f32_16x16x32_bf16 a[40:43], v[68:71], v[136:139], a[40:43]
  ds_read_b64_tr_b16 v[38:39], v13 offset:1024
  v_mfma_f32_16x16x32_bf16 a[44:47], v[68:71], v[140:143], a[44:47]
  buffer_load_dwordx4 v4, s[32:35], s26 offen offset:1024 sc1 lds
  v_mfma_f32_16x16x32_bf16 a[48:51], v[68:71], v[144:147], a[48:51]
  ds_read_b128 v[100:103], v14 offset:1024
  v_mfma_f32_16x16x32_bf16 a[52:55], v[68:71], v[148:151], a[52:55]
  v_mfma_f32_16x16x32_bf16 a[56:59], v[68:71], v[152:155], a[56:59]
  ds_read_b64_tr_b16 v[40:41], v12 offset:256
  v_mfma_f32_16x16x32_bf16 a[60:63], v[68:71], v[156:159], a[60:63]
  v_mfma_f32_16x16x32_bf16 a[64:67], v[72:75], v[128:131], a[64:67]
  ds_read_b64_tr_b16 v[42:43], v12 offset:1280
  v_mfma_f32_16x16x32_bf16 a[68:71], v[72:75], v[132:135], a[68:71]
  buffer_load_dwordx4 v5, s[32:35], s26 offen offset:2048 sc1 lds
  v_mfma_f32_16x16x32_bf16 a[72:75], v[72:75], v[136:139], a[72:75]
  ds_read_b128 v[104:107], v14 offset:2048
  v_mfma_f32_16x16x32_bf16 a[76:79], v[72:75], v[140:143], a[76:79]
  v_mfma_f32_16x16x32_bf16 a[80:83], v[72:75], v[144:147], a[80:83]
  ds_read_b64_tr_b16 v[44:45], v13 offset:256
  v_mfma_f32_16x16x32_bf16 a[84:87], v[72:75], v[148:151], a[84:87]
  v_mfma_f32_16x16x32_bf16 a[88:91], v[72:75], v[152:155], a[88:91]
  ds_read_b64_tr_b16 v[46:47], v13 offset:1280
  v_mfma_f32_16x16x32_bf16 a[92:95], v[72:75], v[156:159], a[92:95]
  buffer_load_dwordx4 v6, s[32:35], s26 offen offset:3072 sc1 lds
  v_mfma_f32_16x16x32_bf16 a[96:99], v[76:79], v[128:131], a[96:99]
  ds_read_b128 v[108:111], v14 offset:3072
  v_mfma_f32_16x16x32_bf16 a[100:103], v[76:79], v[132:135], a[100:103]
  v_mfma_f32_16x16x32_bf16 a[104:107], v[76:79], v[136:139], a[104:107]
  ds_read_b64_tr_b16 v[48:49], v12 offset:512
  v_mfma_f32_16x16x32_bf16 a[108:111], v[76:79], v[140:143], a[108:111]
  v_mfma_f32_16x16x32_bf16 a[112:115], v[76:79], v[144:147], a[112:115]
  s_add_u32 m0, s24, 16384
  ds_read_b64_tr_b16 v[50:51], v12 offset:1536
  v_mfma_f32_16x16x32_bf16 a[116:119], v[76:79], v[148:151], a[116:119]
  buffer_load_dwordx4 v8, s[36:39], s27 offen offset:0 lds
  v_mfma_f32_16x16x32_bf16 a[120:123], v[76:79], v[152:155], a[120:123]
  ds_read_b128 v[112:115], v14 offset:4096
  v_mfma_f32_16x16x32_bf16 a[124:127], v[76:79], v[156:159], a[124:127]
  v_mfma_f32_16x16x32_bf16 a[128:131], v[80:83], v[128:131], a[128:131]
  ds_read_b64_tr_b16 v[52:53], v13 offset:512
  v_mfma_f32_16x16x32_bf16 a[132:135], v[80:83], v[132:135], a[132:135]
  v_mfma_f32_16x16x32_bf16 a[136:139], v[80:83], v[136:139], a[136:139]
  ds_read_b64_tr_b16 v[54:55], v13 offset:1536
  v_mfma_f32_16x16x32_bf16 a[140:143], v[80:83], v[140:143], a[140:143]
  buffer_load_dwordx4 v9, s[36:39], s27 offen offset:1024 lds
  v_mfma_f32_16x16x32_bf16 a[144:147], v[80:83], v[144:147], a[144:147]
  ds_read_b128 v[116:119], v14 offset:5120
  v_mfma_f32_16x16x32_bf16 a[148:151], v[80:83], v[148:151], a[148:151]
  v_mfma_f32_16x16x32_bf16 a[152:155], v[80:83], v[152:155], a[152:155]
  ds_read_b64_tr_b16 v[56:57], v12 offset:768
  v_mfma_f32_16x16x32_bf16 a[156:159], v[80:83], v[156:159], a[156:159]
  v_mfma_f32_16x16x32_bf16 a[160:163], v[84:87], v[128:131], a[160:163]
  ds_read_b64_tr_b16 v[58:59], v12 offset:1792
  v_mfma_f32_16x16x32_bf16 a[164:167], v[84:87], v[132:135], a[164:167]
  buffer_load_dwordx4 v10, s[36:39], s27 offen offset:2048 lds
  v_mfma_f32_16x16x32_bf16 a[168:171], v[84:87], v[136:139], a[168:171]
  ds_read_b128 v[120:123], v14 offset:6144
  v_mfma_f32_16x16x32_bf16 a[172:175], v[84:87], v[140:143], a[172:175]
  v_mfma_f32_16x16x32_bf16 a[176:179], v[84:87], v[144:147], a[176:179]
  ds_read_b64_tr_b16 v[60:61], v13 offset:768
  v_mfma_f32_16x16x32_bf16 a[180:183], v[84:87], v[148:151], a[180:183]
  v_mfma_f32_16x16x32_bf16 a[184:187], v[84:87], v[152:155], a[184:187]
  ds_read_b64_tr_b16 v[62:63], v13 offset:1792
  v_mfma_f32_16x16x32_bf16 a[188:191], v[84:87], v[156:159], a[188:191]
  buffer_load_dwordx4 v11, s[36:39], s27 offen offset:3072 lds
  v_mfma_f32_16x16x32_bf16 a[192:195], v[88:91], v[128:131], a[192:195]
  s_add_u32 s26, s26, s79
  ds_read_b128 v[124:127], v14 offset:7168
  v_mfma_f32_16x16x32_bf16 a[196:199], v[88:91], v[132:135], a[196:199]
  s_add_u32 s27, s27, s25
  v_mfma_f32_16x16x32_bf16 a[200:203], v[88:91], v[136:139], a[200:203]
  s_add_u32 s24, s24, 32768
  v_mfma_f32_16x16x32_bf16 a[204:207], v[88:91], v[140:143], a[204:207]
  s_and_b32 s24, s24, 0x1ffff
  v_mfma_f32_16x16x32_bf16 a[208:211], v[88:91], v[144:147], a[208:211]
  v_mfma_f32_16x16x32_bf16 a[212:215], v[88:91], v[148:151], a[212:215]
  v_mfma_f32_16x16x32_bf16 a[216:219], v[88:91], v[152:155], a[216:219]
  s_add_u32 s28, s28, 1
  v_mfma_f32_16x16x32_bf16 a[220:223], v[88:91], v[156:159], a[220:223]
  v_mfma_f32_16x16x32_bf16 a[224:227], v[92:95], v[128:131], a[224:227]
  v_mfma_f32_16x16x32_bf16 a[228:231], v[92:95], v[132:135], a[228:231]
  v_mfma_f32_16x16x32_bf16 a[232:235], v[92:95], v[136:139], a[232:235]
  v_mfma_f32_16x16x32_bf16 a[236:239], v[92:95], v[140:143], a[236:239]
  v_mfma_f32_16x16x32_bf16 a[240:243], v[92:95], v[144:147], a[240:243]
  v_mfma_f32_16x16x32_bf16 a[244:247], v[92:95], v[148:151], a[244:247]
  s_cmp_lt_u32 s28, 8
  v_mfma_f32_16x16x32_bf16 a[248:251], v[92:95], v[152:155], a[248:251]
  s_waitcnt lgkmcnt(0)
  v_mfma_f32_16x16x32_bf16 a[252:255], v[92:95], v[156:159], a[252:255]
  s_cbranch_scc1 fa_loopK
  s_mov_b32 s60, 2048
  s_mov_b32 s61, 8192
  s_mov_b32 s62, 16777216
  s_branch fa_p1epi
fa_roleV:
  ds_read_b128 v[32:35], v14 offset:0
  ds_read_b128 v[36:39], v14 offset:1024
  ds_read_b128 v[40:43], v14 offset:2048
  ds_read_b128 v[44:47], v14 offset:3072
  ds_read_b128 v[48:51], v14 offset:4096
  ds_read_b128 v[52:55], v14 offset:5120
  ds_read_b128 v[56:59], v14 offset:6144
  ds_read_b128 v[60:63], v14 offset:7168
  ds_read_b64_tr_b16 v[96:97], v12 offset:0
  ds_read_b64_tr_b16 v[98:99], v12 offset:1024
  ds_read_b64_tr_b16 v[100:101], v13 offset:0
  ds_read_b64_tr_b16 v[102:103], v13 offset:1024
  ds_read_b64_tr_b16 v[104:105], v12 offset:256
  ds_read_b64_tr_b16 v[106:107], v12 offset:1280
  ds_read_b64_tr_b16 v[108:109], v13 offset:256
  ds_read_b64_tr_b16 v[110:111], v13 offset:1280
  ds_read_b64_tr_b16 v[112:113], v12 offset:512
  ds_read_b64_tr_b16 v[114:115], v12 offset:1536
  ds_read_b64_tr_b16 v[116:117], v13 offset:512
  ds_read_b64_tr_b16 v[118:119], v13 offset:1536
  ds_read_b64_tr_b16 v[120:121], v12 offset:768
  ds_read_b64_tr_b16 v[122:123], v12 offset:1792
  ds_read_b64_tr_b16 v[124:125], v13 offset:768
  ds_read_b64_tr_b16 v[126:127], v13 offset:1792
  s_waitcnt lgkmcnt(0)
.p2align 6
fa_loopV:
  v_mfma_f32_16x16x32_bf16 a[0:3], v[32:35], v[96:99], a[0:3]
  s_waitcnt vmcnt(17)
  v_mfma_f32_16x16x32_bf16 a[4:7], v[32:35], v[100:103], a[4:7]
  s_barrier
  v_mfma_f32_16x16x32_bf16 a[8:11], v[32:35], v[104:107], a[8:11]
  s_bitcmp1_b32 s72, s28
  ds_read_b64_tr_b16 v[128:129], v12 offset:32768
  v_mfma_f32_16x16x32_bf16 a[12:15], v[32:35], v[108:111], a[12:15]
  s_cbranch_scc1 fa_p1stubV
fa_p1backV:
  v_mfma_f32_16x16x32_bf16 a[16:19], v[32:35], v[112:115], a[16:19]
  s_mov_b32 m0, s24
  ds_read_b64_tr_b16 v[130:131], v12 offset:33792
  v_mfma_f32_16x16x32_bf16 a[20:23], v[32:35], v[116:119], a[20:23]
  buffer_load_dwordx4 v3, s[32:35], s26 offen offset:0 sc1 lds
  v_mfma_f32_16x16x32_bf16 a[24:27], v[32:35], v[120:123], a[24:27]
  ds_read_b128 v[64:67], v14 offset:32768
  v_mfma_f32_16x16x32_bf16 a[28:31], v[32:35], v[124:127], a[28:31]
  buffer_load_dwordx4 v4, s[32:35], s26 offen offset:1024 sc1 lds
  v_mfma_f32_16x16x32_bf16 a[32:35], v[36:39], v[96:99], a[32:35]
  ds_read_b64_tr_b16 v[132:133], v13 offset:32768
  v_mfma_f32_16x16x32_bf16 a[36:39], v[36:39], v[100:103], a[36:39]
  buffer_load_dwordx4 v5, s[32:35], s26 offen offset:2048 sc1 lds
  v_mfma_f32_16x16x32_bf16 a[40:43], v[36:39], v[104:107], a[40:43]
  ds_read_b64_tr_b16 v[134:135], v13 offset:33792
  v_mfma_f32_16x16x32_bf16 a[44:47], v[36:39], v[108:111], a[44:47]
  buffer_load_dwordx4 v6, s[32:35], s26 offen offset:3072 sc1 lds
  v_mfma_f32_16x16x32_bf16 a[48:51], v[36:39], v[112:115], a[48:51]
  s_add_u32 m0, s24, 16384
  ds_read_b128 v[68:71], v14 offset:33792
  v_mfma_f32_16x16x32_bf16 a[52:55], v[36:39], v[116:119], a[52:55]
  buffer_load_dwordx4 v8, s[36:39], s27 offen offset:0 lds
  v_mfma_f32_16x16x32_bf16 a[56:59], v[36:39], v[120:123], a[56:59]
  ds_read_b64_tr_b16 v[136:137], v12 offset:33024
  v_mfma_f32_16x16x32_bf16 a[60:63], v[36:39], v[124:127], a[60:63]
  buffer_load_dwordx4 v9, s[36:39], s27 offen offset:1024 lds
  v_mfma_f32_16x16x32_bf16 a[64:67], v[40:43], v[96:99], a[64:67]
  ds_read_b64_tr_b16 v[138:139], v12 offset:34048
  v_mfma_f32_16x16x32_bf16 a[68:71], v[40:43], v[100:103], a[68:71]
  buffer_load_dwordx4 v10, s[36:39], s27 offen offset:2048 lds
  v_mfma_f32_16x16x32_bf16 a[72:75], v[40:43], v[104:107], a[72:75]
  ds_read_b128 v[72:75], v14 offset:34816
  v_mfma_f32_16x16x32_bf16 a[76:79], v[40:43], v[108:111], a[76:79]
  buffer_load_dwordx4 v11, s[36:39], s27 offen offset:3072 lds
  v_mfma_f32_16x16x32_bf16 a[80:83], v[40:43], v[112:115], a[80:83]
  ds_read_b64_tr_b16 v[140:141], v13 offset:33024
  v_mfma_f32_16x16x32_bf16 a[84:87], v[40:43], v[116:119], a[84:87]
  buffer_load_dword v231, v235, s[48:51], s74 offen
  v_mfma_f32_16x16x32_bf16 a[88:91], v[40:43], v[120:123], a[88:91]
  s_add_u32 s74, s74, s73
  ds_read_b64_tr_b16 v[142:143], v13 offset:34048
  v_mfma_f32_16x16x32_bf16 a[92:95], v[40:43], v[124:127], a[92:95]
  v_mfma_f32_16x16x32_bf16 a[96:99], v[44:47], v[96:99], a[96:99]
  ds_read_b128 v[76:79], v14 offset:35840
  v_mfma_f32_16x16x32_bf16 a[100:103], v[44:47], v[100:103], a[100:103]
  v_mfma_f32_16x16x32_bf16 a[104:107], v[44:47], v[104:107], a[104:107]
  ds_read_b64_tr_b16 v[144:145], v12 offset:33280
  v_mfma_f32_16x16x32_bf16 a[108:111], v[44:47], v[108:111], a[108:111]
  v_mfma_f32_16x16x32_bf16 a[112:115], v[44:47], v[112:115], a[112:115]
  ds_read_b64_tr_b16 v[146:147], v12 offset:34304
  v_mfma_f32_16x16x32_bf16 a[116:119], v[44:47], v[116:119], a[116:119]
  v_mfma_f32_16x16x32_bf16 a[120:123], v[44:47], v[120:123], a[120:123]
  ds_read_b128 v[80:83], v14 offset:36864
  v_mfma_f32_16x16x32_bf16 a[124:127], v[44:47], v[124:127], a[124:127]
  v_mfma_f32_16x16x32_bf16 a[128:131], v[48:51], v[96:99], a[128:131]
  ds_read_b64_tr_b16 v[148:149], v13 offset:33280
  v_mfma_f32_16x16x32_bf16 a[132:135], v[48:51], v[100:103], a[132:135]
  v_mfma_f32_16x16x32_bf16 a[136:139], v[48:51], v[104:107], a[136:139]
  ds_read_b64_tr_b16 v[150:151], v13 offset:34304
  v_mfma_f32_16x16x32_bf16 a[140:143], v[48:51], v[108:111], a[140:143]
  v_mfma_f32_16x16x32_bf16 a[144:147], v[48:51], v[112:115], a[144:147]
  ds_read_b128 v[84:87], v14 offset:37888
  v_mfma_f32_16x16x32_bf16 a[148:151], v[48:51], v[116:119], a[148:151]
  v_mfma_f32_16x16x32_bf16 a[152:155], v[48:51], v[120:123], a[152:155]
  ds_read_b64_tr_b16 v[152:153], v12 offset:33536
  v_mfma_f32_16x16x32_bf16 a[156:159], v[48:51], v[124:127], a[156:159]
  v_mfma_f32_16x16x32_bf16 a[160:163], v[52:55], v[96:99], a[160:163]
  ds_read_b64_tr_b16 v[154:155], v12 offset:34560
  v_mfma_f32_16x16x32_bf16 a[164:167], v[52:55], v[100:103], a[164:167]
  v_mfma_f32_16x16x32_bf16 a[168:171], v[52:55], v[104:107], a[168:171]
  ds_read_b128 v[88:91], v14 offset:38912
  v_mfma_f32_16x16x32_bf16 a[172:175], v[52:55], v[108:111], a[172:175]
  v_mfma_f32_16x16x32_bf16 a[176:179], v[52:55], v[112:115], a[176:179]
  ds_read_b64_tr_b16 v[156:157], v13 offset:33536
  v_mfma_f32_16x16x32_bf16 a[180:183], v[52:55], v[116:119], a[180:183]
  v_mfma_f32_16x16x32_bf16 a[184:187], v[52:55], v[120:123], a[184:187]
  ds_read_b64_tr_b16 v[158:159], v13 offset:34560
  v_mfma_f32_16x16x32_bf16 a[188:191], v[52:55], v[124:127], a[188:191]
  v_mfma_f32_16x16x32_bf16 a[192:195], v[56:59], v[96:99], a[192:195]
  s_add_u32 s26, s26, s79
  ds_read_b128 v[92:95], v14 offset:39936
  v_mfma_f32_16x16x32_bf16 a[196:199], v[56:59], v[100:103], a[196:199]
  s_add_u32 s27, s27, s25
  v_mfma_f32_16x16x32_bf16 a[200:203], v[56:59], v[104:107], a[200:203]
  s_add_u32 s24, s24, 32768
  v_mfma_f32_16x16x32_bf16 a[204:207], v[56:59], v[108:111], a[204:207]
  s_and_b32 s24, s24, 0x1ffff
  v_mfma_f32_16x16x32_bf16 a[208:211], v[56:59], v[112:115], a[208:211]
  v_xor_b32 v14, 0x10000, v14
  v_mfma_f32_16x16x32_bf16 a[212:215], v[56:59], v[116:119], a[212:215]
  v_xor_b32 v12, 0x10000, v12
  v_mfma_f32_16x16x32_bf16 a[216:219], v[56:59], v[120:123], a[216:219]
  v_xor_b32 v13, 0x10000, v13
  v_mfma_f32_16x16x32_bf16 a[220:223], v[56:59], v[124:127], a[220:223]
  v_mfma_f32_16x16x32_bf16 a[224:227], v[60:63], v[96:99], a[224:227]
  v_mfma_f32_16x16x32_bf16 a[228:231], v[60:63], v[100:103], a[228:231]
  v_mfma_f32_16x16x32_bf16 a[232:235], v[60:63], v[104:107], a[232:235]
  v_mfma_f32_16x16x32_bf16 a[236:239], v[60:63], v[108:111], a[236:239]
  v_mfma_f32_16x16x32_bf16 a[240:243], v[60:63], v[112:115], a[240:243]
  v_mfma_f32_16x16x32_bf16 a[244:247], v[60:63], v[116:119], a[244:247]
  v_mfma_f32_16x16x32_bf16 a[248:251], v[60:63], v[120:123], a[248:251]
  v_mfma_f32_16x16x32_bf16 a[252:255], v[60:63], v[124:127], a[252:255]
  s_waitcnt lgkmcnt(0)
  v_mfma_f32_16x16x32_bf16 a[0:3], v[64:67], v[128:131], a[0:3]
  s_waitcnt vmcnt(18)
  v_mfma_f32_16x16x32_bf16 a[4:7], v[64:67], v[132:135], a[4:7]
  s_barrier
  v_mfma_f32_16x16x32_bf16 a[8:11], v[64:67], v[136:139], a[8:11]
  ds_read_b64_tr_b16 v[96:97], v12 offset:0
  v_mfma_f32_16x16x32_bf16 a[12:15], v[64:67], v[140:143], a[12:15]
  v_mfma_f32_16x16x32_bf16 a[16:19], v[64:67], v[144:147], a[16:19]
  s_mov_b32 m0, s24
  ds_read_b64_tr_b16 v[98:99], v12 offset:1024
  v_mfma_f32_16x16x32_bf16 a[20:23], v[64:67], v[148:151], a[20:23]
  buffer_load_dwordx4 v3, s[32:35], s26 offen offset:0 sc1 lds
  v_mfma_f32_16x16x32_bf16 a[24:27], v[64:67], v[152:155], a[24:27]
  ds_read_b128 v[32:35], v14 offset:0
  v_mfma_f32_16x16x32_bf16 a[28:31], v[64:67], v[156:159], a[28:31]
  v_mfma_f32_16x16x32_bf16 a[32:35], v[68:71], v[128:131], a[32:35]
  ds_read_b64_tr_b16 v[100:101], v13 offset:0
  v_mfma_f32_16x16x32_bf16 a[36:39], v[68:71], v[132:135], a[36:39]
  v_mfma_f32_16x16x32_bf16 a[40:43], v[68:71], v[136:139], a[40:43]
  ds_read_b64_tr_b16 v[102:103], v13 offset:1024
  v_mfma_f32_16x16x32_bf16 a[44:47], v[68:71], v[140:143], a[44:47]
  buffer_load_dwordx4 v4, s[32:35], s26 offen offset:1024 sc1 lds
  v_mfma_f32_16x16x32_bf16 a[48:51], v[68:71], v[144:147], a[48:51]
  ds_read_b128 v[36:39], v14 offset:1024
  v_mfma_f32_16x16x32_bf16 a[52:55], v[68:71], v[148:151], a[52:55]
  v_mfma_f32_16x16x32_bf16 a[56:59], v[68:71], v[152:155], a[56:59]
  ds_read_b64_tr_b16 v[104:105], v12 offset:256
  v_mfma_f32_16x16x32_bf16 a[60:63], v[68:71], v[156:159], a[60:63]
  v_mfma_f32_16x16x32_bf16 a[64:67], v[72:75], v[128:131], a[64:67]
  ds_read_b64_tr_b16 v[106:107], v12 offset:1280
  v_mfma_f32_16x16x32_bf16 a[68:71], v[72:75], v[132:135], a[68:71]
  buffer_load_dwordx4 v5, s[32:35], s26 offen offset:2048 sc1 lds
  v_mfma_f32_16x16x32_bf16 a[72:75], v[72:75], v[136:139], a[72:75]
  ds_read_b128 v[40:43], v14 offset:2048
  v_mfma_f32_16x16x32_bf16 a[76:79], v[72:75], v[140:143], a[76:79]
  v_mfma_f32_16x16x32_bf16 a[80:83], v[72:75], v[144:147], a[80:83]
  ds_read_b64_tr_b16 v[108:109], v13 offset:256
  v_mfma_f32_16x16x32_bf16 a[84:87], v[72:75], v[148:151], a[84:87]
  v_mfma_f32_16x16x32_bf16 a[88:91], v[72:75], v[152:155], a[88:91]
  ds_read_b64_tr_b16 v[110:111], v13 offset:1280
  v_mfma_f32_16x16x32_bf16 a[92:95], v[72:75], v[156:159], a[92:95]
  buffer_load_dwordx4 v6, s[32:35], s26 offen offset:3072 sc1 lds
  v_mfma_f32_16x16x32_bf16 a[96:99], v[76:79], v[128:131], a[96:99]
  ds_read_b128 v[44:47], v14 offset:3072
  v_mfma_f32_16x16x32_bf16 a[100:103], v[76:79], v[132:135], a[100:103]
  v_mfma_f32_16x16x32_bf16 a[104:107], v[76:79], v[136:139], a[104:107]
  ds_read_b64_tr_b16 v[112:113], v12 offset:512
  v_mfma_f32_16x16x32_bf16 a[108:111], v[76:79], v[140:143], a[108:111]
  v_mfma_f32_16x16x32_bf16 a[112:115], v[76:79], v[144:147], a[112:115]
  s_add_u32 m0, s24, 16384
  ds_read_b64_tr_b16 v[114:115], v12 offset:1536
  v_mfma_f32_16x16x32_bf16 a[116:119], v[76:79], v[148:151], a[116:119]
  buffer_load_dwordx4 v8, s[36:39], s27 offen offset:0 lds
  v_mfma_f32_16x16x32_bf16 a[120:123], v[76:79], v[152:155], a[120:123]
  ds_read_b128 v[48:51], v14 offset:4096
  v_mfma_f32_16x16x32_bf16 a[124:127], v[76:79], v[156:159], a[124:127]
  v_mfma_f32_16x16x32_bf16 a[128:131], v[80:83], v[128:131], a[128:131]
  ds_read_b64_tr_b16 v[116:117], v13 offset:512
  v_mfma_f32_16x16x32_bf16 a[132:135], v[80:83], v[132:135], a[132:135]
  v_mfma_f32_16x16x32_bf16 a[136:139], v[80:83], v[136:139], a[136:139]
  ds_read_b64_tr_b16 v[118:119], v13 offset:1536
  v_mfma_f32_16x16x32_bf16 a[140:143], v[80:83], v[140:143], a[140:143]
  buffer_load_dwordx4 v9, s[36:39], s27 offen offset:1024 lds
  v_mfma_f32_16x16x32_bf16 a[144:147], v[80:83], v[144:147], a[144:147]
  ds_read_b128 v[52:55], v14 offset:5120
  v_mfma_f32_16x16x32_bf16 a[148:151], v[80:83], v[148:151], a[148:151]
  v_mfma_f32_16x16x32_bf16 a[152:155], v[80:83], v[152:155], a[152:155]
  ds_read_b64_tr_b16 v[120:121], v12 offset:768
  v_mfma_f32_16x16x32_bf16 a[156:159], v[80:83], v[156:159], a[156:159]
  v_mfma_f32_16x16x32_bf16 a[160:163], v[84:87], v[128:131], a[160:163]
  ds_read_b64_tr_b16 v[122:123], v12 offset:1792
  v_mfma_f32_16x16x32_bf16 a[164:167], v[84:87], v[132:135], a[164:167]
  buffer_load_dwordx4 v10, s[36:39], s27 offen offset:2048 lds
  v_mfma_f32_16x16x32_bf16 a[168:171], v[84:87], v[136:139], a[168:171]
  ds_read_b128 v[56:59], v14 offset:6144
  v_mfma_f32_16x16x32_bf16 a[172:175], v[84:87], v[140:143], a[172:175]
  v_mfma_f32_16x16x32_bf16 a[176:179], v[84:87], v[144:147], a[176:179]
  ds_read_b64_tr_b16 v[124:125], v13 offset:768
  v_mfma_f32_16x16x32_bf16 a[180:183], v[84:87], v[148:151], a[180:183]
  v_mfma_f32_16x16x32_bf16 a[184:187], v[84:87], v[152:155], a[184:187]
  ds_read_b64_tr_b16 v[126:127], v13 offset:1792
  v_mfma_f32_16x16x32_bf16 a[188:191], v[84:87], v[156:159], a[188:191]
  buffer_load_dwordx4 v11, s[36:39], s27 offen offset:3072 lds
  v_mfma_f32_16x16x32_bf16 a[192:195], v[88:91], v[128:131], a[192:195]
  s_add_u32 s26, s26, s79
  ds_read_b128 v[60:63], v14 offset:7168
  v_mfma_f32_16x16x32_bf16 a[196:199], v[88:91], v[132:135], a[196:199]
  s_add_u32 s27, s27, s25
  v_mfma_f32_16x16x32_bf16 a[200:203], v[88:91], v[136:139], a[200:203]
  s_add_u32 s24, s24, 32768
  v_mfma_f32_16x16x32_bf16 a[204:207], v[88:91], v[140:143], a[204:207]
  s_and_b32 s24, s24, 0x1ffff
  v_mfma_f32_16x16x32_bf16 a[208:211], v[88:91], v[144:147], a[208:211]
  v_mfma_f32_16x16x32_bf16 a[212:215], v[88:91], v[148:151], a[212:215]
  v_mfma_f32_16x16x32_bf16 a[216:219], v[88:91], v[152:155], a[216:219]
  s_add_u32 s28, s28, 1
  v_mfma_f32_16x16x32_bf16 a[220:223], v[88:91], v[156:159], a[220:223]
  v_mfma_f32_16x16x32_bf16 a[224:227], v[92:95], v[128:131], a[224:227]
  v_mfma_f32_16x16x32_bf16 a[228:231], v[92:95], v[132:135], a[228:231]
  v_mfma_f32_16x16x32_bf16 a[232:235], v[92:95], v[136:139], a[232:235]
  v_mfma_f32_16x16x32_bf16 a[236:239], v[92:95], v[140:143], a[236:239]
  v_mfma_f32_16x16x32_bf16 a[240:243], v[92:95], v[144:147], a[240:243]
  v_mfma_f32_16x16x32_bf16 a[244:247], v[92:95], v[148:151], a[244:247]
  s_cmp_lt_u32 s28, 8
  v_mfma_f32_16x16x32_bf16 a[248:251], v[92:95], v[152:155], a[248:251]
  s_waitcnt lgkmcnt(0)
  v_mfma_f32_16x16x32_bf16 a[252:255], v[92:95], v[156:159], a[252:255]
  s_cbranch_scc1 fa_loopV
  s_mov_b32 s60, 8192
  s_mov_b32 s61, 2048
  s_mov_b32 s62, 33554432
fa_p1epi:
  s_lshr_b32 s23, s20, 1
  s_lshl_b32 s23, s23, 13
  v_subrev_u32 v12, s23, v12
  v_subrev_u32 v13, s23, v13
  s_lshl_b32 s24, s20, 12
  v_add_u32 v14, s24, v2
  ds_read_b64_tr_b16 v[32:33], v12 offset:0
  ds_read_b64_tr_b16 v[34:35], v12 offset:1024
  ds_read_b64_tr_b16 v[36:37], v13 offset:0
  ds_read_b64_tr_b16 v[38:39], v13 offset:1024
  ds_read_b64_tr_b16 v[40:41], v12 offset:256
  ds_read_b64_tr_b16 v[42:43], v12 offset:1280
  ds_read_b64_tr_b16 v[44:45], v13 offset:256
  ds_read_b64_tr_b16 v[46:47], v13 offset:1280
  ds_read_b64_tr_b16 v[48:49], v12 offset:512
  ds_read_b64_tr_b16 v[50:51], v12 offset:1536
  ds_read_b64_tr_b16 v[52:53], v13 offset:512
  ds_read_b64_tr_b16 v[54:55], v13 offset:1536
  ds_read_b64_tr_b16 v[56:57], v12 offset:768
  ds_read_b64_tr_b16 v[58:59], v12 offset:1792
  ds_read_b64_tr_b16 v[60:61], v13 offset:768
  ds_read_b64_tr_b16 v[62:63], v13 offset:1792
  s_waitcnt vmcnt(8)
  ds_read_b128 v[224:227], v14 offset:0
  ds_read_b128 v[228:231], v14 offset:1024
  ds_read_b128 v[232:235], v14 offset:2048
  ds_read_b128 v[236:239], v14 offset:3072
  s_lshl_b32 s23, s21, 19
  s_add_u32 s62, s62, s23
  s_lshl_b32 s23, s22, 16
  s_add_u32 s62, s62, s23
  s_and_b32 s23, s20, 1
  s_lshl_b32 s23, s23, 15
  s_add_u32 s62, s62, s23
  s_lshl_b32 s23, s21, 19
  s_add_u32 s23, s23, 16777216
  s_add_u32 s6, s18, s23
  s_addc_u32 s7, s19, 0
  s_add_u32 s8, s6, 16777216
  s_addc_u32 s9, s7, 0
  s_sub_u32 s23, 16, s22
  s_lshl_b32 s23, s23, 15
  s_mov_b32 s44, s6
  s_mov_b32 s45, s7
  s_mov_b32 s46, s23
  s_mov_b32 s47, 0x20000
  s_mov_b32 s48, s8
  s_mov_b32 s49, s9
  s_mov_b32 s50, s23
  s_mov_b32 s51, 0x20000
  s_lshl_b32 s30, s21, 7
  s_add_u32 s30, s30, 2637824
  s_mov_b32 s81, 0x47800000
  s_cmp_eq_u32 s20, 0
  s_cselect_b32 s29, s82, 1073741824
  s_waitcnt vmcnt(21) lgkmcnt(0)
  v_mfma_f32_16x16x32_bf16 v[96:99], v[32:35], v[224:227], 0
  s_mul_i32 s63, s60, 0
  v_accvgpr_read_b32 v16, a0
  v_accvgpr_read_b32 v17, a1
  v_mfma_f32_16x16x32_bf16 v[112:115], v[36:39], v[224:227], 0
  s_add_u32 s63, s63, s62
  ds_read_b64_tr_b16 v[64:65], v12 offset:8192
  v_accvgpr_read_b32 v18, a2
  v_mfma_f32_16x16x32_bf16 v[128:131], v[40:43], v[224:227], 0
  s_add_u32 m0, s24, 0
  ds_read_b64_tr_b16 v[66:67], v12 offset:9216
  v_accvgpr_read_b32 v19, a3
  v_mfma_f32_16x16x32_bf16 v[144:147], v[44:47], v[224:227], 0
  buffer_load_dwordx4 v3, s[32:35], s26 offen offset:0 sc1 lds
  v_accvgpr_read_b32 v20, a32
  v_mfma_f32_16x16x32_bf16 v[160:163], v[48:51], v[224:227], 0
  ds_read_b64_tr_b16 v[68:69], v13 offset:8192
  v_accvgpr_read_b32 v21, a33
  v_mfma_f32_16x16x32_bf16 v[176:179], v[52:55], v[224:227], 0
  ds_read_b64_tr_b16 v[70:71], v13 offset:9216
  v_accvgpr_read_b32 v22, a34
  v_mfma_f32_16x16x32_bf16 v[192:195], v[56:59], v[224:227], 0
  ds_read_b64_tr_b16 v[72:73], v12 offset:8448
  v_accvgpr_read_b32 v23, a35
  v_mfma_f32_16x16x32_bf16 v[208:211], v[60:63], v[224:227], 0
  ds_read_b64_tr_b16 v[74:75], v12 offset:9472
  v_cvt_pk_bf16_f32 v24, v16, v17
  v_mfma_f32_16x16x32_bf16 v[100:103], v[32:35], v[228:231], 0
  buffer_load_dwordx4 v4, s[32:35], s26 offen offset:1024 sc1 lds
  v_cvt_pk_bf16_f32 v25, v18, v19
  v_mfma_f32_16x16x32_bf16 v[116:119], v[36:39], v[228:231], 0
  ds_read_b64_tr_b16 v[76:77], v13 offset:8448
  v_cvt_pk_bf16_f32 v26, v20, v21
  v_mfma_f32_16x16x32_bf16 v[132:135], v[40:43], v[228:231], 0
  ds_read_b64_tr_b16 v[78:79], v13 offset:9472
  v_cvt_pk_bf16_f32 v27, v22, v23
  v_mfma_f32_16x16x32_bf16 v[148:151], v[44:47], v[228:231], 0
  ds_read_b128 v[240:243], v14 offset:32768
  buffer_store_dwordx4 v[24:27], v2, s[40:43], s63 offen offset:0 sc1
  v_mfma_f32_16x16x32_bf16 v[164:167], v[48:51], v[228:231], 0
  ds_read_b128 v[244:247], v14 offset:33792
  v_accvgpr_read_b32 v16, a4
  v_mfma_f32_16x16x32_bf16 v[180:183], v[52:55], v[228:231], 0
  buffer_load_dwordx4 v5, s[32:35], s26 offen offset:2048 sc1 lds
  v_accvgpr_read_b32 v17, a5
  v_mfma_f32_16x16x32_bf16 v[196:199], v[56:59], v[228:231], 0
  ds_read_b64_tr_b16 v[80:81], v12 offset:8704
  v_accvgpr_read_b32 v18, a6
  v_mfma_f32_16x16x32_bf16 v[212:215], v[60:63], v[228:231], 0
  ds_read_b64_tr_b16 v[82:83], v12 offset:9728
  v_accvgpr_read_b32 v19, a7
  v_mfma_f32_16x16x32_bf16 v[104:107], v[32:35], v[232:235], 0
  ds_read_b64_tr_b16 v[84:85], v13 offset:8704
  v_accvgpr_read_b32 v20, a36
  v_mfma_f32_16x16x32_bf16 v[120:123], v[36:39], v[232:235], 0
  ds_read_b64_tr_b16 v[86:87], v13 offset:9728
  v_accvgpr_read_b32 v21, a37
  v_mfma_f32_16x16x32_bf16 v[136:139], v[40:43], v[232:235], 0
  buffer_load_dwordx4 v6, s[32:35], s26 offen offset:3072 sc1 lds
  v_accvgpr_read_b32 v22, a38
  v_mfma_f32_16x16x32_bf16 v[152:155], v[44:47], v[232:235], 0
  s_add_u32 s26, s26, 1024
  ds_read_b64_tr_b16 v[88:89], v12 offset:8960
  v_accvgpr_read_b32 v23, a39
  v_mfma_f32_16x16x32_bf16 v[168:171], v[48:51], v[232:235], 0
  ds_read_b64_tr_b16 v[90:91], v12 offset:9984
  v_cvt_pk_bf16_f32 v28, v16, v17
  v_mfma_f32_16x16x32_bf16 v[184:187], v[52:55], v[232:235], 0
  ds_read_b64_tr_b16 v[92:93], v13 offset:8960
  v_cvt_pk_bf16_f32 v29, v18, v19
  v_mfma_f32_16x16x32_bf16 v[200:203], v[56:59], v[232:235], 0
  ds_read_b64_tr_b16 v[94:95], v13 offset:9984
  v_cvt_pk_bf16_f32 v30, v20, v21
  v_mfma_f32_16x16x32_bf16 v[216:219], v[60:63], v[232:235], 0
  v_cvt_pk_bf16_f32 v31, v22, v23
  v_mfma_f32_16x16x32_bf16 v[108:111], v[32:35], v[236:239], 0
  ds_read_b128 v[248:251], v14 offset:34816
  buffer_store_dwordx4 v[28:31], v2, s[40:43], s63 offen offset:1024 sc1
  v_mfma_f32_16x16x32_bf16 v[124:127], v[36:39], v[236:239], 0
  ds_read_b128 v[252:255], v14 offset:35840
  v_accvgpr_write_b32 a0, 0
  v_mfma_f32_16x16x32_bf16 v[140:143], v[40:43], v[236:239], 0
  v_accvgpr_write_b32 a1, 0
  v_accvgpr_write_b32 a2, 0
  v_mfma_f32_16x16x32_bf16 v[156:159], v[44:47], v[236:239], 0
  v_xor_b32 v14, 0x10000, v14
  v_accvgpr_write_b32 a3, 0
  v_mfma_f32_16x16x32_bf16 v[172:175], v[48:51], v[236:239], 0
  v_accvgpr_write_b32 a32, 0
  v_accvgpr_write_b32 a33, 0
  v_mfma_f32_16x16x32_bf16 v[188:191], v[52:55], v[236:239], 0
  v_accvgpr_write_b32 a34, 0
  v_accvgpr_write_b32 a35, 0
  v_mfma_f32_16x16x32_bf16 v[204:207], v[56:59], v[236:239], 0
  v_mfma_f32_16x16x32_bf16 v[220:223], v[60:63], v[236:239], 0
  s_waitcnt vmcnt(19) lgkmcnt(0)
  v_mfma_f32_16x16x32_bf16 v[96:99], v[64:67], v[240:243], v[96:99]
  s_barrier
  v_accvgpr_read_b32 v16, a8
  v_accvgpr_read_b32 v17, a9
  v_mfma_f32_16x16x32_bf16 v[112:115], v[68:71], v[240:243], v[112:115]
  s_add_u32 s63, s63, s61
  ds_read_b64_tr_b16 v[32:33], v12 offset:32768
  v_accvgpr_read_b32 v18, a10
  v_mfma_f32_16x16x32_bf16 v[128:131], v[72:75], v[240:243], v[128:131]
  s_add_u32 m0, s24, 32768
  ds_read_b64_tr_b16 v[34:35], v12 offset:33792
  v_accvgpr_read_b32 v19, a11
  v_mfma_f32_16x16x32_bf16 v[144:147], v[76:79], v[240:243], v[144:147]
  buffer_load_dwordx4 v3, s[32:35], s26 offen offset:0 sc1 lds
  v_accvgpr_read_b32 v20, a40
  v_mfma_f32_16x16x32_bf16 v[160:163], v[80:83], v[240:243], v[160:163]
  ds_read_b64_tr_b16 v[36:37], v13 offset:32768
  v_accvgpr_read_b32 v21, a41
  v_mfma_f32_16x16x32_bf16 v[176:179], v[84:87], v[240:243], v[176:179]
  ds_read_b64_tr_b16 v[38:39], v13 offset:33792
  v_accvgpr_read_b32 v22, a42
  v_mfma_f32_16x16x32_bf16 v[192:195], v[88:91], v[240:243], v[192:195]
  ds_read_b64_tr_b16 v[40:41], v12 offset:33024
  v_accvgpr_read_b32 v23, a43
  v_mfma_f32_16x16x32_bf16 v[208:211], v[92:95], v[240:243], v[208:211]
  ds_read_b64_tr_b16 v[42:43], v12 offset:34048
  v_cvt_pk_bf16_f32 v24, v16, v17
  v_mfma_f32_16x16x32_bf16 v[100:103], v[64:67], v[244:247], v[100:103]
  buffer_load_dwordx4 v4, s[32:35], s26 offen offset:1024 sc1 lds
  v_cvt_pk_bf16_f32 v25, v18, v19
  v_mfma_f32_16x16x32_bf16 v[116:119], v[68:71], v[244:247], v[116:119]
  ds_read_b64_tr_b16 v[44:45], v13 offset:33024
  v_cvt_pk_bf16_f32 v26, v20, v21
  v_mfma_f32_16x16x32_bf16 v[132:135], v[72:75], v[244:247], v[132:135]
  ds_read_b64_tr_b16 v[46:47], v13 offset:34048
  v_cvt_pk_bf16_f32 v27, v22, v23
  v_mfma_f32_16x16x32_bf16 v[148:151], v[76:79], v[244:247], v[148:151]
  ds_read_b128 v[224:227], v14 offset:0
  buffer_store_dwordx4 v[24:27], v2, s[40:43], s63 offen offset:0 sc1
  v_mfma_f32_16x16x32_bf16 v[164:167], v[80:83], v[244:247], v[164:167]
  ds_read_b128 v[228:231], v14 offset:1024
  v_accvgpr_read_b32 v16, a12
  v_mfma_f32_16x16x32_bf16 v[180:183], v[84:87], v[244:247], v[180:183]
  buffer_load_dwordx4 v5, s[32:35], s26 offen offset:2048 sc1 lds
  v_accvgpr_read_b32 v17, a13
  v_mfma_f32_16x16x32_bf16 v[196:199], v[88:91], v[244:247], v[196:199]
  ds_read_b64_tr_b16 v[48:49], v12 offset:33280
  v_accvgpr_read_b32 v18, a14
  v_mfma_f32_16x16x32_bf16 v[212:215], v[92:95], v[244:247], v[212:215]
  ds_read_b64_tr_b16 v[50:51], v12 offset:34304
  v_accvgpr_read_b32 v19, a15
  v_mfma_f32_16x16x32_bf16 v[104:107], v[64:67], v[248:251], v[104:107]
  ds_read_b64_tr_b16 v[52:53], v13 offset:33280
  v_accvgpr_read_b32 v20, a44
  v_mfma_f32_16x16x32_bf16 v[120:123], v[68:71], v[248:251], v[120:123]
  ds_read_b64_tr_b16 v[54:55], v13 offset:34304
  v_accvgpr_read_b32 v21, a45
  v_mfma_f32_16x16x32_bf16 v[136:139], v[72:75], v[248:251], v[136:139]
  buffer_load_dwordx4 v6, s[32:35], s26 offen offset:3072 sc1 lds
  v_accvgpr_read_b32 v22, a46
  v_mfma_f32_16x16x32_bf16 v[152:155], v[76:79], v[248:251], v[152:155]
  s_add_u32 s26, s26, 1024
  ds_read_b64_tr_b16 v[56:57], v12 offset:33536
  v_accvgpr_read_b32 v23, a47
  v_mfma_f32_16x16x32_bf16 v[168:171], v[80:83], v[248:251], v[168:171]
  ds_read_b64_tr_b16 v[58:59], v12 offset:34560
  v_cvt_pk_bf16_f32 v28, v16, v17
  v_mfma_f32_16x16x32_bf16 v[184:187], v[84:87], v[248:251], v[184:187]
  ds_read_b64_tr_b16 v[60:61], v13 offset:33536
  v_cvt_pk_bf16_f32 v29, v18, v19
  v_mfma_f32_16x16x32_bf16 v[200:203], v[88:91], v[248:251], v[200:203]
  s_add_u32 m0, s24, 16384
  ds_read_b64_tr_b16 v[62:63], v13 offset:34560
  v_cvt_pk_bf16_f32 v30, v20, v21
  v_mfma_f32_16x16x32_bf16 v[216:219], v[92:95], v[248:251], v[216:219]
  buffer_load_dwordx4 v8, s[36:39], s27 offen offset:0 lds
  v_cvt_pk_bf16_f32 v31, v22, v23
  v_mfma_f32_16x16x32_bf16 v[108:111], v[64:67], v[252:255], v[108:111]
  ds_read_b128 v[232:235], v14 offset:2048
  buffer_store_dwordx4 v[28:31], v2, s[40:43], s63 offen offset:1024 sc1
  v_mfma_f32_16x16x32_bf16 v[124:127], v[68:71], v[252:255], v[124:127]
  ds_read_b128 v[236:239], v14 offset:3072
  v_accvgpr_write_b32 a4, 0
  v_mfma_f32_16x16x32_bf16 v[140:143], v[72:75], v[252:255], v[140:143]
  v_accvgpr_write_b32 a5, 0
  v_accvgpr_write_b32 a6, 0
  v_mfma_f32_16x16x32_bf16 v[156:159], v[76:79], v[252:255], v[156:159]
  v_accvgpr_write_b32 a7, 0
  v_accvgpr_write_b32 a36, 0
  v_mfma_f32_16x16x32_bf16 v[172:175], v[80:83], v[252:255], v[172:175]
  buffer_load_dwordx4 v9, s[36:39], s27 offen offset:1024 lds
  v_accvgpr_write_b32 a37, 0
  v_mfma_f32_16x16x32_bf16 v[188:191], v[84:87], v[252:255], v[188:191]
  v_accvgpr_write_b32 a38, 0
  v_mfma_f32_16x16x32_bf16 v[204:207], v[88:91], v[252:255], v[204:207]
  v_mfma_f32_16x16x32_bf16 v[220:223], v[92:95], v[252:255], v[220:223]
  s_waitcnt vmcnt(18) lgkmcnt(0)
  v_mfma_f32_16x16x32_bf16 v[96:99], v[32:35], v[224:227], v[96:99]
  s_add_u32 s63, s63, s61
  v_accvgpr_read_b32 v16, a16
  v_accvgpr_read_b32 v17, a17
  v_mfma_f32_16x16x32_bf16 v[112:115], v[36:39], v[224:227], v[112:115]
  ds_read_b64_tr_b16 v[64:65], v12 offset:40960
  v_accvgpr_read_b32 v18, a18
  v_mfma_f32_16x16x32_bf16 v[128:131], v[40:43], v[224:227], v[128:131]
  s_add_u32 m0, s24, 65536
  ds_read_b64_tr_b16 v[66:67], v12 offset:41984
  v_accvgpr_read_b32 v19, a19
  v_mfma_f32_16x16x32_bf16 v[144:147], v[44:47], v[224:227], v[144:147]
  buffer_load_dwordx4 v3, s[32:35], s26 offen offset:0 sc1 lds
  v_accvgpr_read_b32 v20, a48
  v_mfma_f32_16x16x32_bf16 v[160:163], v[48:51], v[224:227], v[160:163]
  ds_read_b64_tr_b16 v[68:69], v13 offset:40960
  v_accvgpr_read_b32 v21, a49
  v_mfma_f32_16x16x32_bf16 v[176:179], v[52:55], v[224:227], v[176:179]
  ds_read_b64_tr_b16 v[70:71], v13 offset:41984
  v_accvgpr_read_b32 v22, a50
  v_mfma_f32_16x16x32_bf16 v[192:195], v[56:59], v[224:227], v[192:195]
  ds_read_b64_tr_b16 v[72:73], v12 offset:41216
  v_accvgpr_read_b32 v23, a51
  v_mfma_f32_16x16x32_bf16 v[208:211], v[60:63], v[224:227], v[208:211]
  ds_read_b64_tr_b16 v[74:75], v12 offset:42240
  v_cvt_pk_bf16_f32 v24, v16, v17
  v_mfma_f32_16x16x32_bf16 v[100:103], v[32:35], v[228:231], v[100:103]
  buffer_load_dwordx4 v4, s[32:35], s26 offen offset:1024 sc1 lds
  v_cvt_pk_bf16_f32 v25, v18, v19
  v_mfma_f32_16x16x32_bf16 v[116:119], v[36:39], v[228:231], v[116:119]
  ds_read_b64_tr_b16 v[76:77], v13 offset:41216
  v_cvt_pk_bf16_f32 v26, v20, v21
  v_mfma_f32_16x16x32_bf16 v[132:135], v[40:43], v[228:231], v[132:135]
  ds_read_b64_tr_b16 v[78:79], v13 offset:42240
  v_cvt_pk_bf16_f32 v27, v22, v23
  v_mfma_f32_16x16x32_bf16 v[148:151], v[44:47], v[228:231], v[148:151]
  ds_read_b128 v[240:243], v14 offset:32768
  buffer_store_dwordx4 v[24:27], v2, s[40:43], s63 offen offset:0 sc1
  v_mfma_f32_16x16x32_bf16 v[164:167], v[48:51], v[228:231], v[164:167]
  ds_read_b128 v[244:247], v14 offset:33792
  v_accvgpr_read_b32 v16, a20
  v_mfma_f32_16x16x32_bf16 v[180:183], v[52:55], v[228:231], v[180:183]
  buffer_load_dwordx4 v5, s[32:35], s26 offen offset:2048 sc1 lds
  v_accvgpr_read_b32 v17, a21
  v_mfma_f32_16x16x32_bf16 v[196:199], v[56:59], v[228:231], v[196:199]
  ds_read_b64_tr_b16 v[80:81], v12 offset:41472
  v_accvgpr_read_b32 v18, a22
  v_mfma_f32_16x16x32_bf16 v[212:215], v[60:63], v[228:231], v[212:215]
  ds_read_b64_tr_b16 v[82:83], v12 offset:42496
  v_accvgpr_read_b32 v19, a23
  v_mfma_f32_16x16x32_bf16 v[104:107], v[32:35], v[232:235], v[104:107]
  ds_read_b64_tr_b16 v[84:85], v13 offset:41472
  v_accvgpr_read_b32 v20, a52
  v_mfma_f32_16x16x32_bf16 v[120:123], v[36:39], v[232:235], v[120:123]
  ds_read_b64_tr_b16 v[86:87], v13 offset:42496
  v_accvgpr_read_b32 v21, a53
  v_mfma_f32_16x16x32_bf16 v[136:139], v[40:43], v[232:235], v[136:139]
  buffer_load_dwordx4 v6, s[32:35], s26 offen offset:3072 sc1 lds
  v_accvgpr_read_b32 v22, a54
  v_mfma_f32_16x16x32_bf16 v[152:155], v[44:47], v[232:235], v[152:155]
  s_add_u32 s26, s26, 1024
  ds_read_b64_tr_b16 v[88:89], v12 offset:41728
  v_accvgpr_read_b32 v23, a55
  v_mfma_f32_16x16x32_bf16 v[168:171], v[48:51], v[232:235], v[168:171]
  ds_read_b64_tr_b16 v[90:91], v12 offset:42752
  v_cvt_pk_bf16_f32 v28, v16, v17
  v_mfma_f32_16x16x32_bf16 v[184:187], v[52:55], v[232:235], v[184:187]
  ds_read_b64_tr_b16 v[92:93], v13 offset:41728
  v_cvt_pk_bf16_f32 v29, v18, v19
  v_mfma_f32_16x16x32_bf16 v[200:203], v[56:59], v[232:235], v[200:203]
  s_add_u32 m0, s24, 16384
  ds_read_b64_tr_b16 v[94:95], v13 offset:42752
  v_cvt_pk_bf16_f32 v30, v20, v21
  v_mfma_f32_16x16x32_bf16 v[216:219], v[60:63], v[232:235], v[216:219]
  buffer_load_dwordx4 v10, s[36:39], s27 offen offset:2048 lds
  v_cvt_pk_bf16_f32 v31, v22, v23
  v_mfma_f32_16x16x32_bf16 v[108:111], v[32:35], v[236:239], v[108:111]
  ds_read_b128 v[248:251], v14 offset:34816
  buffer_store_dwordx4 v[28:31], v2, s[40:43], s63 offen offset:1024 sc1
  v_mfma_f32_16x16x32_bf16 v[124:127], v[36:39], v[236:239], v[124:127]
  ds_read_b128 v[252:255], v14 offset:35840
  v_accvgpr_write_b32 a39, 0
  v_mfma_f32_16x16x32_bf16 v[140:143], v[40:43], v[236:239], v[140:143]
  v_accvgpr_write_b32 a8, 0
  v_accvgpr_write_b32 a9, 0
  v_mfma_f32_16x16x32_bf16 v[156:159], v[44:47], v[236:239], v[156:159]
  v_xor_b32 v14, 0x10000, v14
  v_accvgpr_write_b32 a10, 0
  v_mfma_f32_16x16x32_bf16 v[172:175], v[48:51], v[236:239], v[172:175]
  buffer_load_dwordx4 v11, s[36:39], s27 offen offset:3072 lds
  v_mfma_f32_16x16x32_bf16 v[188:191], v[52:55], v[236:239], v[188:191]
  s_add_u32 s27, s27, 524288
  v_xor_b32 v12, 0x10000, v12
  v_mfma_f32_16x16x32_bf16 v[204:207], v[56:59], v[236:239], v[204:207]
  v_xor_b32 v13, 0x10000, v13
  v_mfma_f32_16x16x32_bf16 v[220:223], v[60:63], v[236:239], v[220:223]
  s_waitcnt vmcnt(17) lgkmcnt(0)
  v_mfma_f32_16x16x32_bf16 v[96:99], v[64:67], v[240:243], v[96:99]
  s_barrier
  v_accvgpr_read_b32 v16, a24
  v_accvgpr_read_b32 v17, a25
  v_mfma_f32_16x16x32_bf16 v[112:115], v[68:71], v[240:243], v[112:115]
  s_add_u32 s63, s63, s61
  ds_read_b64_tr_b16 v[32:33], v12 offset:0
  v_accvgpr_read_b32 v18, a26
  v_mfma_f32_16x16x32_bf16 v[128:131], v[72:75], v[240:243], v[128:131]
  s_add_u32 m0, s24, 98304
  ds_read_b64_tr_b16 v[34:35], v12 offset:1024
  v_accvgpr_read_b32 v19, a27
  v_mfma_f32_16x16x32_bf16 v[144:147], v[76:79], v[240:243], v[144:147]
  buffer_load_dwordx4 v3, s[32:35], s26 offen offset:0 sc1 lds
  v_accvgpr_read_b32 v20, a56
  v_mfma_f32_16x16x32_bf16 v[160:163], v[80:83], v[240:243], v[160:163]
  ds_read_b64_tr_b16 v[36:37], v13 offset:0
  v_accvgpr_read_b32 v21, a57
  v_mfma_f32_16x16x32_bf16 v[176:179], v[84:87], v[240:243], v[176:179]
  ds_read_b64_tr_b16 v[38:39], v13 offset:1024
  v_accvgpr_read_b32 v22, a58
  v_mfma_f32_16x16x32_bf16 v[192:195], v[88:91], v[240:243], v[192:195]
  ds_read_b64_tr_b16 v[40:41], v12 offset:256
  v_accvgpr_read_b32 v23, a59
  v_mfma_f32_16x16x32_bf16 v[208:211], v[92:95], v[240:243], v[208:211]
  ds_read_b64_tr_b16 v[42:43], v12 offset:1280
  v_cvt_pk_bf16_f32 v24, v16, v17
  v_mfma_f32_16x16x32_bf16 v[100:103], v[64:67], v[244:247], v[100:103]
  buffer_load_dwordx4 v4, s[32:35], s26 offen offset:1024 sc1 lds
  v_cvt_pk_bf16_f32 v25, v18, v19
  v_mfma_f32_16x16x32_bf16 v[116:119], v[68:71], v[244:247], v[116:119]
  ds_read_b64_tr_b16 v[44:45], v13 offset:256
  v_cvt_pk_bf16_f32 v26, v20, v21
  v_mfma_f32_16x16x32_bf16 v[132:135], v[72:75], v[244:247], v[132:135]
  ds_read_b64_tr_b16 v[46:47], v13 offset:1280
  v_cvt_pk_bf16_f32 v27, v22, v23
  v_mfma_f32_16x16x32_bf16 v[148:151], v[76:79], v[244:247], v[148:151]
  ds_read_b128 v[224:227], v14 offset:0
  buffer_store_dwordx4 v[24:27], v2, s[40:43], s63 offen offset:0 sc1
  v_mfma_f32_16x16x32_bf16 v[164:167], v[80:83], v[244:247], v[164:167]
  ds_read_b128 v[228:231], v14 offset:1024
  v_accvgpr_read_b32 v16, a28
  v_mfma_f32_16x16x32_bf16 v[180:183], v[84:87], v[244:247], v[180:183]
  buffer_load_dwordx4 v5, s[32:35], s26 offen offset:2048 sc1 lds
  v_accvgpr_read_b32 v17, a29
  v_mfma_f32_16x16x32_bf16 v[196:199], v[88:91], v[244:247], v[196:199]
  ds_read_b64_tr_b16 v[48:49], v12 offset:512
  v_accvgpr_read_b32 v18, a30
  v_mfma_f32_16x16x32_bf16 v[212:215], v[92:95], v[244:247], v[212:215]
  ds_read_b64_tr_b16 v[50:51], v12 offset:1536
  v_accvgpr_read_b32 v19, a31
  v_mfma_f32_16x16x32_bf16 v[104:107], v[64:67], v[248:251], v[104:107]
  ds_read_b64_tr_b16 v[52:53], v13 offset:512
  v_accvgpr_read_b32 v20, a60
  v_mfma_f32_16x16x32_bf16 v[120:123], v[68:71], v[248:251], v[120:123]
  ds_read_b64_tr_b16 v[54:55], v13 offset:1536
  v_accvgpr_read_b32 v21, a61
  v_mfma_f32_16x16x32_bf16 v[136:139], v[72:75], v[248:251], v[136:139]
  buffer_load_dwordx4 v6, s[32:35], s26 offen offset:3072 sc1 lds
  v_accvgpr_read_b32 v22, a62
  v_mfma_f32_16x16x32_bf16 v[152:155], v[76:79], v[248:251], v[152:155]
  s_add_u32 s26, s26, 1024
  ds_read_b64_tr_b16 v[56:57], v12 offset:768
  v_accvgpr_read_b32 v23, a63
  v_mfma_f32_16x16x32_bf16 v[168:171], v[80:83], v[248:251], v[168:171]
  ds_read_b64_tr_b16 v[58:59], v12 offset:1792
  v_cvt_pk_bf16_f32 v28, v16, v17
  v_mfma_f32_16x16x32_bf16 v[184:187], v[84:87], v[248:251], v[184:187]
  ds_read_b64_tr_b16 v[60:61], v13 offset:768
  v_cvt_pk_bf16_f32 v29, v18, v19
  v_mfma_f32_16x16x32_bf16 v[200:203], v[88:91], v[248:251], v[200:203]
  s_add_u32 m0, s24, 49152
  ds_read_b64_tr_b16 v[62:63], v13 offset:1792
  v_cvt_pk_bf16_f32 v30, v20, v21
  v_mfma_f32_16x16x32_bf16 v[216:219], v[92:95], v[248:251], v[216:219]
  buffer_load_dwordx4 v8, s[36:39], s27 offen offset:0 lds
  v_cvt_pk_bf16_f32 v31, v22, v23
  v_mfma_f32_16x16x32_bf16 v[108:111], v[64:67], v[252:255], v[108:111]
  ds_read_b128 v[232:235], v14 offset:2048
  buffer_store_dwordx4 v[28:31], v2, s[40:43], s63 offen offset:1024 sc1
  v_mfma_f32_16x16x32_bf16 v[124:127], v[68:71], v[252:255], v[124:127]
  ds_read_b128 v[236:239], v14 offset:3072
  v_accvgpr_write_b32 a11, 0
  v_mfma_f32_16x16x32_bf16 v[140:143], v[72:75], v[252:255], v[140:143]
  v_accvgpr_write_b32 a40, 0
  v_accvgpr_write_b32 a41, 0
  v_mfma_f32_16x16x32_bf16 v[156:159], v[76:79], v[252:255], v[156:159]
  v_accvgpr_write_b32 a42, 0
  v_accvgpr_write_b32 a43, 0
  v_mfma_f32_16x16x32_bf16 v[172:175], v[80:83], v[252:255], v[172:175]
  buffer_load_dwordx4 v9, s[36:39], s27 offen offset:1024 lds
  v_accvgpr_write_b32 a12, 0
  v_mfma_f32_16x16x32_bf16 v[188:191], v[84:87], v[252:255], v[188:191]
  v_accvgpr_write_b32 a13, 0
  v_mfma_f32_16x16x32_bf16 v[204:207], v[88:91], v[252:255], v[204:207]
  v_mfma_f32_16x16x32_bf16 v[220:223], v[92:95], v[252:255], v[220:223]
  s_waitcnt vmcnt(19) lgkmcnt(0)
  v_mfma_f32_16x16x32_bf16 v[96:99], v[32:35], v[224:227], v[96:99]
  s_mul_i32 s63, s60, 1
  v_accvgpr_read_b32 v16, a64
  v_accvgpr_read_b32 v17, a65
  v_mfma_f32_16x16x32_bf16 v[112:115], v[36:39], v[224:227], v[112:115]
  s_add_u32 s63, s63, s62
  ds_read_b64_tr_b16 v[64:65], v12 offset:8192
  v_accvgpr_read_b32 v18, a66
  v_mfma_f32_16x16x32_bf16 v[128:131], v[40:43], v[224:227], v[128:131]
  s_add_u32 m0, s24, 0
  ds_read_b64_tr_b16 v[66:67], v12 offset:9216
  v_accvgpr_read_b32 v19, a67
  v_mfma_f32_16x16x32_bf16 v[144:147], v[44:47], v[224:227], v[144:147]
  buffer_load_dwordx4 v3, s[32:35], s26 offen offset:0 sc1 lds
  v_accvgpr_read_b32 v20, a96
  v_mfma_f32_16x16x32_bf16 v[160:163], v[48:51], v[224:227], v[160:163]
  ds_read_b64_tr_b16 v[68:69], v13 offset:8192
  v_accvgpr_read_b32 v21, a97
  v_mfma_f32_16x16x32_bf16 v[176:179], v[52:55], v[224:227], v[176:179]
  ds_read_b64_tr_b16 v[70:71], v13 offset:9216
  v_accvgpr_read_b32 v22, a98
  v_mfma_f32_16x16x32_bf16 v[192:195], v[56:59], v[224:227], v[192:195]
  ds_read_b64_tr_b16 v[72:73], v12 offset:8448
  v_accvgpr_read_b32 v23, a99
  v_mfma_f32_16x16x32_bf16 v[208:211], v[60:63], v[224:227], v[208:211]
  ds_read_b64_tr_b16 v[74:75], v12 offset:9472
  v_cvt_pk_bf16_f32 v24, v16, v17
  v_mfma_f32_16x16x32_bf16 v[100:103], v[32:35], v[228:231], v[100:103]
  buffer_load_dwordx4 v4, s[32:35], s26 offen offset:1024 sc1 lds
  v_cvt_pk_bf16_f32 v25, v18, v19
  v_mfma_f32_16x16x32_bf16 v[116:119], v[36:39], v[228:231], v[116:119]
  ds_read_b64_tr_b16 v[76:77], v13 offset:8448
  v_cvt_pk_bf16_f32 v26, v20, v21
  v_mfma_f32_16x16x32_bf16 v[132:135], v[40:43], v[228:231], v[132:135]
  ds_read_b64_tr_b16 v[78:79], v13 offset:9472
  v_cvt_pk_bf16_f32 v27, v22, v23
  v_mfma_f32_16x16x32_bf16 v[148:151], v[44:47], v[228:231], v[148:151]
  ds_read_b128 v[240:243], v14 offset:32768
  buffer_store_dwordx4 v[24:27], v2, s[40:43], s63 offen offset:0 sc1
  v_mfma_f32_16x16x32_bf16 v[164:167], v[48:51], v[228:231], v[164:167]
  ds_read_b128 v[244:247], v14 offset:33792
  v_accvgpr_read_b32 v16, a68
  v_mfma_f32_16x16x32_bf16 v[180:183], v[52:55], v[228:231], v[180:183]
  buffer_load_dwordx4 v5, s[32:35], s26 offen offset:2048 sc1 lds
  v_accvgpr_read_b32 v17, a69
  v_mfma_f32_16x16x32_bf16 v[196:199], v[56:59], v[228:231], v[196:199]
  ds_read_b64_tr_b16 v[80:81], v12 offset:8704
  v_accvgpr_read_b32 v18, a70
  v_mfma_f32_16x16x32_bf16 v[212:215], v[60:63], v[228:231], v[212:215]
  ds_read_b64_tr_b16 v[82:83], v12 offset:9728
  v_accvgpr_read_b32 v19, a71
  v_mfma_f32_16x16x32_bf16 v[104:107], v[32:35], v[232:235], v[104:107]
  ds_read_b64_tr_b16 v[84:85], v13 offset:8704
  v_accvgpr_read_b32 v20, a100
  v_mfma_f32_16x16x32_bf16 v[120:123], v[36:39], v[232:235], v[120:123]
  ds_read_b64_tr_b16 v[86:87], v13 offset:9728
  v_accvgpr_read_b32 v21, a101
  v_mfma_f32_16x16x32_bf16 v[136:139], v[40:43], v[232:235], v[136:139]
  buffer_load_dwordx4 v6, s[32:35], s26 offen offset:3072 sc1 lds
  v_accvgpr_read_b32 v22, a102
  v_mfma_f32_16x16x32_bf16 v[152:155], v[44:47], v[232:235], v[152:155]
  s_add_u32 s26, s26, 1024
  ds_read_b64_tr_b16 v[88:89], v12 offset:8960
  v_accvgpr_read_b32 v23, a103
  v_mfma_f32_16x16x32_bf16 v[168:171], v[48:51], v[232:235], v[168:171]
  ds_read_b64_tr_b16 v[90:91], v12 offset:9984
  v_cvt_pk_bf16_f32 v28, v16, v17
  v_mfma_f32_16x16x32_bf16 v[184:187], v[52:55], v[232:235], v[184:187]
  ds_read_b64_tr_b16 v[92:93], v13 offset:8960
  v_cvt_pk_bf16_f32 v29, v18, v19
  v_mfma_f32_16x16x32_bf16 v[200:203], v[56:59], v[232:235], v[200:203]
  s_add_u32 m0, s24, 49152
  ds_read_b64_tr_b16 v[94:95], v13 offset:9984
  v_cvt_pk_bf16_f32 v30, v20, v21
  v_mfma_f32_16x16x32_bf16 v[216:219], v[60:63], v[232:235], v[216:219]
  buffer_load_dwordx4 v10, s[36:39], s27 offen offset:2048 lds
  v_cvt_pk_bf16_f32 v31, v22, v23
  v_mfma_f32_16x16x32_bf16 v[108:111], v[32:35], v[236:239], v[108:111]
  ds_read_b128 v[248:251], v14 offset:34816
  buffer_store_dwordx4 v[28:31], v2, s[40:43], s63 offen offset:1024 sc1
  v_mfma_f32_16x16x32_bf16 v[124:127], v[36:39], v[236:239], v[124:127]
  ds_read_b128 v[252:255], v14 offset:35840
  v_accvgpr_write_b32 a14, 0
  v_mfma_f32_16x16x32_bf16 v[140:143], v[40:43], v[236:239], v[140:143]
  v_accvgpr_write_b32 a15, 0
  v_accvgpr_write_b32 a44, 0
  v_mfma_f32_16x16x32_bf16 v[156:159], v[44:47], v[236:239], v[156:159]
  v_xor_b32 v14, 0x10000, v14
  v_accvgpr_write_b32 a45, 0
  v_mfma_f32_16x16x32_bf16 v[172:175], v[48:51], v[236:239], v[172:175]
  buffer_load_dwordx4 v11, s[36:39], s27 offen offset:3072 lds
  v_accvgpr_write_b32 a46, 0
  v_mfma_f32_16x16x32_bf16 v[188:191], v[52:55], v[236:239], v[188:191]
  s_add_u32 s27, s27, 524288
  v_accvgpr_write_b32 a47, 0
  v_mfma_f32_16x16x32_bf16 v[204:207], v[56:59], v[236:239], v[204:207]
  v_mfma_f32_16x16x32_bf16 v[220:223], v[60:63], v[236:239], v[220:223]
  s_waitcnt vmcnt(19) lgkmcnt(0)
  v_mfma_f32_16x16x32_bf16 v[96:99], v[64:67], v[240:243], v[96:99]
  s_barrier
  v_accvgpr_read_b32 v16, a72
  v_accvgpr_read_b32 v17, a73
  v_mfma_f32_16x16x32_bf16 v[112:115], v[68:71], v[240:243], v[112:115]
  s_add_u32 s63, s63, s61
  ds_read_b64_tr_b16 v[32:33], v12 offset:32768
  v_accvgpr_read_b32 v18, a74
  v_mfma_f32_16x16x32_bf16 v[128:131], v[72:75], v[240:243], v[128:131]
  s_add_u32 m0, s24, 32768
  ds_read_b64_tr_b16 v[34:35], v12 offset:33792
  v_accvgpr_read_b32 v19, a75
  v_mfma_f32_16x16x32_bf16 v[144:147], v[76:79], v[240:243], v[144:147]
  buffer_load_dwordx4 v3, s[32:35], s26 offen offset:0 sc1 lds
  v_accvgpr_read_b32 v20, a104
  v_mfma_f32_16x16x32_bf16 v[160:163], v[80:83], v[240:243], v[160:163]
  ds_read_b64_tr_b16 v[36:37], v13 offset:32768
  v_accvgpr_read_b32 v21, a105
  v_mfma_f32_16x16x32_bf16 v[176:179], v[84:87], v[240:243], v[176:179]
  ds_read_b64_tr_b16 v[38:39], v13 offset:33792
  v_accvgpr_read_b32 v22, a106
  v_mfma_f32_16x16x32_bf16 v[192:195], v[88:91], v[240:243], v[192:195]
  ds_read_b64_tr_b16 v[40:41], v12 offset:33024
  v_accvgpr_read_b32 v23, a107
  v_mfma_f32_16x16x32_bf16 v[208:211], v[92:95], v[240:243], v[208:211]
  ds_read_b64_tr_b16 v[42:43], v12 offset:34048
  v_cvt_pk_bf16_f32 v24, v16, v17
  v_mfma_f32_16x16x32_bf16 v[100:103], v[64:67], v[244:247], v[100:103]
  buffer_load_dwordx4 v4, s[32:35], s26 offen offset:1024 sc1 lds
  v_cvt_pk_bf16_f32 v25, v18, v19
  v_mfma_f32_16x16x32_bf16 v[116:119], v[68:71], v[244:247], v[116:119]
  ds_read_b64_tr_b16 v[44:45], v13 offset:33024
  v_cvt_pk_bf16_f32 v26, v20, v21
  v_mfma_f32_16x16x32_bf16 v[132:135], v[72:75], v[244:247], v[132:135]
  ds_read_b64_tr_b16 v[46:47], v13 offset:34048
  v_cvt_pk_bf16_f32 v27, v22, v23
  v_mfma_f32_16x16x32_bf16 v[148:151], v[76:79], v[244:247], v[148:151]
  ds_read_b128 v[224:227], v14 offset:0
  buffer_store_dwordx4 v[24:27], v2, s[40:43], s63 offen offset:0 sc1
  v_mfma_f32_16x16x32_bf16 v[164:167], v[80:83], v[244:247], v[164:167]
  ds_read_b128 v[228:231], v14 offset:1024
  v_accvgpr_read_b32 v16, a76
  v_mfma_f32_16x16x32_bf16 v[180:183], v[84:87], v[244:247], v[180:183]
  buffer_load_dwordx4 v5, s[32:35], s26 offen offset:2048 sc1 lds
  v_accvgpr_read_b32 v17, a77
  v_mfma_f32_16x16x32_bf16 v[196:199], v[88:91], v[244:247], v[196:199]
  ds_read_b64_tr_b16 v[48:49], v12 offset:33280
  v_accvgpr_read_b32 v18, a78
  v_mfma_f32_16x16x32_bf16 v[212:215], v[92:95], v[244:247], v[212:215]
  ds_read_b64_tr_b16 v[50:51], v12 offset:34304
  v_accvgpr_read_b32 v19, a79
  v_mfma_f32_16x16x32_bf16 v[104:107], v[64:67], v[248:251], v[104:107]
  ds_read_b64_tr_b16 v[52:53], v13 offset:33280
  v_accvgpr_read_b32 v20, a108
  v_mfma_f32_16x16x32_bf16 v[120:123], v[68:71], v[248:251], v[120:123]
  ds_read_b64_tr_b16 v[54:55], v13 offset:34304
  v_accvgpr_read_b32 v21, a109
  v_mfma_f32_16x16x32_bf16 v[136:139], v[72:75], v[248:251], v[136:139]
  buffer_load_dwordx4 v6, s[32:35], s26 offen offset:3072 sc1 lds
  v_accvgpr_read_b32 v22, a110
  v_mfma_f32_16x16x32_bf16 v[152:155], v[76:79], v[248:251], v[152:155]
  s_add_u32 s26, s26, 1024
  ds_read_b64_tr_b16 v[56:57], v12 offset:33536
  v_accvgpr_read_b32 v23, a111
  v_mfma_f32_16x16x32_bf16 v[168:171], v[80:83], v[248:251], v[168:171]
  ds_read_b64_tr_b16 v[58:59], v12 offset:34560
  v_cvt_pk_bf16_f32 v28, v16, v17
  v_mfma_f32_16x16x32_bf16 v[184:187], v[84:87], v[248:251], v[184:187]
  ds_read_b64_tr_b16 v[60:61], v13 offset:33536
  v_cvt_pk_bf16_f32 v29, v18, v19
  v_mfma_f32_16x16x32_bf16 v[200:203], v[88:91], v[248:251], v[200:203]
  s_add_u32 m0, s24, 81920
  ds_read_b64_tr_b16 v[62:63], v13 offset:34560
  v_cvt_pk_bf16_f32 v30, v20, v21
  v_mfma_f32_16x16x32_bf16 v[216:219], v[92:95], v[248:251], v[216:219]
  buffer_load_dwordx4 v8, s[36:39], s27 offen offset:0 lds
  v_cvt_pk_bf16_f32 v31, v22, v23
  v_mfma_f32_16x16x32_bf16 v[108:111], v[64:67], v[252:255], v[108:111]
  ds_read_b128 v[232:235], v14 offset:2048
  buffer_store_dwordx4 v[28:31], v2, s[40:43], s63 offen offset:1024 sc1
  v_mfma_f32_16x16x32_bf16 v[124:127], v[68:71], v[252:255], v[124:127]
  ds_read_b128 v[236:239], v14 offset:3072
  v_accvgpr_write_b32 a16, 0
  v_mfma_f32_16x16x32_bf16 v[140:143], v[72:75], v[252:255], v[140:143]
  v_accvgpr_write_b32 a17, 0
  v_accvgpr_write_b32 a18, 0
  v_mfma_f32_16x16x32_bf16 v[156:159], v[76:79], v[252:255], v[156:159]
  v_accvgpr_write_b32 a19, 0
  v_accvgpr_write_b32 a48, 0
  v_mfma_f32_16x16x32_bf16 v[172:175], v[80:83], v[252:255], v[172:175]
  buffer_load_dwordx4 v9, s[36:39], s27 offen offset:1024 lds
  v_accvgpr_write_b32 a49, 0
  v_mfma_f32_16x16x32_bf16 v[188:191], v[84:87], v[252:255], v[188:191]
  v_accvgpr_write_b32 a50, 0
  v_mfma_f32_16x16x32_bf16 v[204:207], v[88:91], v[252:255], v[204:207]
  v_mfma_f32_16x16x32_bf16 v[220:223], v[92:95], v[252:255], v[220:223]
  s_waitcnt vmcnt(19) lgkmcnt(0)
  v_mfma_f32_16x16x32_bf16 v[96:99], v[32:35], v[224:227], v[96:99]
  s_add_u32 s63, s63, s61
  v_accvgpr_read_b32 v16, a80
  v_accvgpr_read_b32 v17, a81
  v_mfma_f32_16x16x32_bf16 v[112:115], v[36:39], v[224:227], v[112:115]
  ds_read_b64_tr_b16 v[64:65], v12 offset:40960
  v_accvgpr_read_b32 v18, a82
  v_mfma_f32_16x16x32_bf16 v[128:131], v[40:43], v[224:227], v[128:131]
  s_add_u32 m0, s24, 65536
  ds_read_b64_tr_b16 v[66:67], v12 offset:41984
  v_accvgpr_read_b32 v19, a83
  v_mfma_f32_16x16x32_bf16 v[144:147], v[44:47], v[224:227], v[144:147]
  buffer_load_dwordx4 v3, s[32:35], s26 offen offset:0 sc1 lds
  v_accvgpr_read_b32 v20, a112
  v_mfma_f32_16x16x32_bf16 v[160:163], v[48:51], v[224:227], v[160:163]
  ds_read_b64_tr_b16 v[68:69], v13 offset:40960
  v_accvgpr_read_b32 v21, a113
  v_mfma_f32_16x16x32_bf16 v[176:179], v[52:55], v[224:227], v[176:179]
  ds_read_b64_tr_b16 v[70:71], v13 offset:41984
  v_accvgpr_read_b32 v22, a114
  v_mfma_f32_16x16x32_bf16 v[192:195], v[56:59], v[224:227], v[192:195]
  ds_read_b64_tr_b16 v[72:73], v12 offset:41216
  v_accvgpr_read_b32 v23, a115
  v_mfma_f32_16x16x32_bf16 v[208:211], v[60:63], v[224:227], v[208:211]
  ds_read_b64_tr_b16 v[74:75], v12 offset:42240
  v_cvt_pk_bf16_f32 v24, v16, v17
  v_mfma_f32_16x16x32_bf16 v[100:103], v[32:35], v[228:231], v[100:103]
  buffer_load_dwordx4 v4, s[32:35], s26 offen offset:1024 sc1 lds
  v_cvt_pk_bf16_f32 v25, v18, v19
  v_mfma_f32_16x16x32_bf16 v[116:119], v[36:39], v[228:231], v[116:119]
  ds_read_b64_tr_b16 v[76:77], v13 offset:41216
  v_cvt_pk_bf16_f32 v26, v20, v21
  v_mfma_f32_16x16x32_bf16 v[132:135], v[40:43], v[228:231], v[132:135]
  ds_read_b64_tr_b16 v[78:79], v13 offset:42240
  v_cvt_pk_bf16_f32 v27, v22, v23
  v_mfma_f32_16x16x32_bf16 v[148:151], v[44:47], v[228:231], v[148:151]
  ds_read_b128 v[240:243], v14 offset:32768
  buffer_store_dwordx4 v[24:27], v2, s[40:43], s63 offen offset:0 sc1
  v_mfma_f32_16x16x32_bf16 v[164:167], v[48:51], v[228:231], v[164:167]
  ds_read_b128 v[244:247], v14 offset:33792
  v_accvgpr_read_b32 v16, a84
  v_mfma_f32_16x16x32_bf16 v[180:183], v[52:55], v[228:231], v[180:183]
  buffer_load_dwordx4 v5, s[32:35], s26 offen offset:2048 sc1 lds
  v_accvgpr_read_b32 v17, a85
  v_mfma_f32_16x16x32_bf16 v[196:199], v[56:59], v[228:231], v[196:199]
  ds_read_b64_tr_b16 v[80:81], v12 offset:41472
  v_accvgpr_read_b32 v18, a86
  v_mfma_f32_16x16x32_bf16 v[212:215], v[60:63], v[228:231], v[212:215]
  ds_read_b64_tr_b16 v[82:83], v12 offset:42496
  v_accvgpr_read_b32 v19, a87
  v_mfma_f32_16x16x32_bf16 v[104:107], v[32:35], v[232:235], v[104:107]
  ds_read_b64_tr_b16 v[84:85], v13 offset:41472
  v_accvgpr_read_b32 v20, a116
  v_mfma_f32_16x16x32_bf16 v[120:123], v[36:39], v[232:235], v[120:123]
  ds_read_b64_tr_b16 v[86:87], v13 offset:42496
  v_accvgpr_read_b32 v21, a117
  v_mfma_f32_16x16x32_bf16 v[136:139], v[40:43], v[232:235], v[136:139]
  buffer_load_dwordx4 v6, s[32:35], s26 offen offset:3072 sc1 lds
  v_accvgpr_read_b32 v22, a118
  v_mfma_f32_16x16x32_bf16 v[152:155], v[44:47], v[232:235], v[152:155]
  s_add_u32 s26, s26, 1024
  ds_read_b64_tr_b16 v[88:89], v12 offset:41728
  v_accvgpr_read_b32 v23, a119
  v_mfma_f32_16x16x32_bf16 v[168:171], v[48:51], v[232:235], v[168:171]
  ds_read_b64_tr_b16 v[90:91], v12 offset:42752
  v_cvt_pk_bf16_f32 v28, v16, v17
  v_mfma_f32_16x16x32_bf16 v[184:187], v[52:55], v[232:235], v[184:187]
  ds_read_b64_tr_b16 v[92:93], v13 offset:41728
  v_cvt_pk_bf16_f32 v29, v18, v19
  v_mfma_f32_16x16x32_bf16 v[200:203], v[56:59], v[232:235], v[200:203]
  s_add_u32 m0, s24, 81920
  ds_read_b64_tr_b16 v[94:95], v13 offset:42752
  v_cvt_pk_bf16_f32 v30, v20, v21
  v_mfma_f32_16x16x32_bf16 v[216:219], v[60:63], v[232:235], v[216:219]
  buffer_load_dwordx4 v10, s[36:39], s27 offen offset:2048 lds
  v_cvt_pk_bf16_f32 v31, v22, v23
  v_mfma_f32_16x16x32_bf16 v[108:111], v[32:35], v[236:239], v[108:111]
  ds_read_b128 v[248:251], v14 offset:34816
  buffer_store_dwordx4 v[28:31], v2, s[40:43], s63 offen offset:1024 sc1
  v_mfma_f32_16x16x32_bf16 v[124:127], v[36:39], v[236:239], v[124:127]
  ds_read_b128 v[252:255], v14 offset:35840
  v_accvgpr_write_b32 a51, 0
  v_mfma_f32_16x16x32_bf16 v[140:143], v[40:43], v[236:239], v[140:143]
  v_accvgpr_write_b32 a20, 0
  v_accvgpr_write_b32 a21, 0
  v_mfma_f32_16x16x32_bf16 v[156:159], v[44:47], v[236:239], v[156:159]
  v_xor_b32 v14, 0x10000, v14
  v_accvgpr_write_b32 a22, 0
  v_mfma_f32_16x16x32_bf16 v[172:175], v[48:51], v[236:239], v[172:175]
  buffer_load_dwordx4 v11, s[36:39], s27 offen offset:3072 lds
  v_mfma_f32_16x16x32_bf16 v[188:191], v[52:55], v[236:239], v[188:191]
  s_add_u32 s27, s27, 524288
  v_xor_b32 v12, 0x10000, v12
  v_mfma_f32_16x16x32_bf16 v[204:207], v[56:59], v[236:239], v[204:207]
  v_xor_b32 v13, 0x10000, v13
  v_mfma_f32_16x16x32_bf16 v[220:223], v[60:63], v[236:239], v[220:223]
  s_waitcnt vmcnt(19) lgkmcnt(0)
  v_mfma_f32_16x16x32_bf16 v[96:99], v[64:67], v[240:243], v[96:99]
  s_barrier
  v_accvgpr_read_b32 v16, a88
  v_accvgpr_read_b32 v17, a89
  v_mfma_f32_16x16x32_bf16 v[112:115], v[68:71], v[240:243], v[112:115]
  s_add_u32 s63, s63, s61
  ds_read_b64_tr_b16 v[32:33], v12 offset:0
  v_accvgpr_read_b32 v18, a90
  v_mfma_f32_16x16x32_bf16 v[128:131], v[72:75], v[240:243], v[128:131]
  s_add_u32 m0, s24, 98304
  ds_read_b64_tr_b16 v[34:35], v12 offset:1024
  v_accvgpr_read_b32 v19, a91
  v_mfma_f32_16x16x32_bf16 v[144:147], v[76:79], v[240:243], v[144:147]
  buffer_load_dwordx4 v3, s[32:35], s26 offen offset:0 sc1 lds
  v_accvgpr_read_b32 v20, a120
  v_mfma_f32_16x16x32_bf16 v[160:163], v[80:83], v[240:243], v[160:163]
  ds_read_b64_tr_b16 v[36:37], v13 offset:0
  v_accvgpr_read_b32 v21, a121
  v_mfma_f32_16x16x32_bf16 v[176:179], v[84:87], v[240:243], v[176:179]
  ds_read_b64_tr_b16 v[38:39], v13 offset:1024
  v_accvgpr_read_b32 v22, a122
  v_mfma_f32_16x16x32_bf16 v[192:195], v[88:91], v[240:243], v[192:195]
  ds_read_b64_tr_b16 v[40:41], v12 offset:256
  v_accvgpr_read_b32 v23, a123
  v_mfma_f32_16x16x32_bf16 v[208:211], v[92:95], v[240:243], v[208:211]
  ds_read_b64_tr_b16 v[42:43], v12 offset:1280
  v_cvt_pk_bf16_f32 v24, v16, v17
  v_mfma_f32_16x16x32_bf16 v[100:103], v[64:67], v[244:247], v[100:103]
  buffer_load_dwordx4 v4, s[32:35], s26 offen offset:1024 sc1 lds
  v_cvt_pk_bf16_f32 v25, v18, v19
  v_mfma_f32_16x16x32_bf16 v[116:119], v[68:71], v[244:247], v[116:119]
  ds_read_b64_tr_b16 v[44:45], v13 offset:256
  v_cvt_pk_bf16_f32 v26, v20, v21
  v_mfma_f32_16x16x32_bf16 v[132:135], v[72:75], v[244:247], v[132:135]
  ds_read_b64_tr_b16 v[46:47], v13 offset:1280
  v_cvt_pk_bf16_f32 v27, v22, v23
  v_mfma_f32_16x16x32_bf16 v[148:151], v[76:79], v[244:247], v[148:151]
  ds_read_b128 v[224:227], v14 offset:0
  buffer_store_dwordx4 v[24:27], v2, s[40:43], s63 offen offset:0 sc1
  v_mfma_f32_16x16x32_bf16 v[164:167], v[80:83], v[244:247], v[164:167]
  ds_read_b128 v[228:231], v14 offset:1024
  v_accvgpr_read_b32 v16, a92
  v_mfma_f32_16x16x32_bf16 v[180:183], v[84:87], v[244:247], v[180:183]
  buffer_load_dwordx4 v5, s[32:35], s26 offen offset:2048 sc1 lds
  v_accvgpr_read_b32 v17, a93
  v_mfma_f32_16x16x32_bf16 v[196:199], v[88:91], v[244:247], v[196:199]
  ds_read_b64_tr_b16 v[48:49], v12 offset:512
  v_accvgpr_read_b32 v18, a94
  v_mfma_f32_16x16x32_bf16 v[212:215], v[92:95], v[244:247], v[212:215]
  ds_read_b64_tr_b16 v[50:51], v12 offset:1536
  v_accvgpr_read_b32 v19, a95
  v_mfma_f32_16x16x32_bf16 v[104:107], v[64:67], v[248:251], v[104:107]
  ds_read_b64_tr_b16 v[52:53], v13 offset:512
  v_accvgpr_read_b32 v20, a124
  v_mfma_f32_16x16x32_bf16 v[120:123], v[68:71], v[248:251], v[120:123]
  ds_read_b64_tr_b16 v[54:55], v13 offset:1536
  v_accvgpr_read_b32 v21, a125
  v_mfma_f32_16x16x32_bf16 v[136:139], v[72:75], v[248:251], v[136:139]
  buffer_load_dwordx4 v6, s[32:35], s26 offen offset:3072 sc1 lds
  v_accvgpr_read_b32 v22, a126
  v_mfma_f32_16x16x32_bf16 v[152:155], v[76:79], v[248:251], v[152:155]
  s_add_u32 s26, s26, 1024
  ds_read_b64_tr_b16 v[56:57], v12 offset:768
  v_accvgpr_read_b32 v23, a127
  v_mfma_f32_16x16x32_bf16 v[168:171], v[80:83], v[248:251], v[168:171]
  ds_read_b64_tr_b16 v[58:59], v12 offset:1792
  v_cvt_pk_bf16_f32 v28, v16, v17
  v_mfma_f32_16x16x32_bf16 v[184:187], v[84:87], v[248:251], v[184:187]
  ds_read_b64_tr_b16 v[60:61], v13 offset:768
  v_cvt_pk_bf16_f32 v29, v18, v19
  v_mfma_f32_16x16x32_bf16 v[200:203], v[88:91], v[248:251], v[200:203]
  s_add_u32 m0, s24, 114688
  ds_read_b64_tr_b16 v[62:63], v13 offset:1792
  v_cvt_pk_bf16_f32 v30, v20, v21
  v_mfma_f32_16x16x32_bf16 v[216:219], v[92:95], v[248:251], v[216:219]
  buffer_load_dwordx4 v8, s[36:39], s27 offen offset:0 lds
  v_cvt_pk_bf16_f32 v31, v22, v23
  v_mfma_f32_16x16x32_bf16 v[108:111], v[64:67], v[252:255], v[108:111]
  ds_read_b128 v[232:235], v14 offset:2048
  buffer_store_dwordx4 v[28:31], v2, s[40:43], s63 offen offset:1024 sc1
  v_mfma_f32_16x16x32_bf16 v[124:127], v[68:71], v[252:255], v[124:127]
  ds_read_b128 v[236:239], v14 offset:3072
  v_accvgpr_write_b32 a23, 0
  v_mfma_f32_16x16x32_bf16 v[140:143], v[72:75], v[252:255], v[140:143]
  v_accvgpr_write_b32 a52, 0
  v_accvgpr_write_b32 a53, 0
  v_mfma_f32_16x16x32_bf16 v[156:159], v[76:79], v[252:255], v[156:159]
  v_accvgpr_write_b32 a54, 0
  v_accvgpr_write_b32 a55, 0
  v_mfma_f32_16x16x32_bf16 v[172:175], v[80:83], v[252:255], v[172:175]
  buffer_load_dwordx4 v9, s[36:39], s27 offen offset:1024 lds
  v_accvgpr_write_b32 a24, 0
  v_mfma_f32_16x16x32_bf16 v[188:191], v[84:87], v[252:255], v[188:191]
  v_accvgpr_write_b32 a25, 0
  v_mfma_f32_16x16x32_bf16 v[204:207], v[88:91], v[252:255], v[204:207]
  v_mfma_f32_16x16x32_bf16 v[220:223], v[92:95], v[252:255], v[220:223]
  s_waitcnt vmcnt(19) lgkmcnt(0)
  v_mfma_f32_16x16x32_bf16 v[96:99], v[32:35], v[224:227], v[96:99]
  s_mul_i32 s63, s60, 2
  v_accvgpr_read_b32 v16, a128
  v_accvgpr_read_b32 v17, a129
  v_mfma_f32_16x16x32_bf16 v[112:115], v[36:39], v[224:227], v[112:115]
  s_add_u32 s63, s63, s62
  ds_read_b64_tr_b16 v[64:65], v12 offset:8192
  v_accvgpr_read_b32 v18, a130
  v_mfma_f32_16x16x32_bf16 v[128:131], v[40:43], v[224:227], v[128:131]
  s_add_u32 m0, s24, 0
  ds_read_b64_tr_b16 v[66:67], v12 offset:9216
  v_accvgpr_read_b32 v19, a131
  v_mfma_f32_16x16x32_bf16 v[144:147], v[44:47], v[224:227], v[144:147]
  buffer_load_dwordx4 v3, s[32:35], s26 offen offset:0 sc1 lds
  v_accvgpr_read_b32 v20, a160
  v_mfma_f32_16x16x32_bf16 v[160:163], v[48:51], v[224:227], v[160:163]
  ds_read_b64_tr_b16 v[68:69], v13 offset:8192
  v_accvgpr_read_b32 v21, a161
  v_mfma_f32_16x16x32_bf16 v[176:179], v[52:55], v[224:227], v[176:179]
  ds_read_b64_tr_b16 v[70:71], v13 offset:9216
  v_accvgpr_read_b32 v22, a162
  v_mfma_f32_16x16x32_bf16 v[192:195], v[56:59], v[224:227], v[192:195]
  ds_read_b64_tr_b16 v[72:73], v12 offset:8448
  v_accvgpr_read_b32 v23, a163
  v_mfma_f32_16x16x32_bf16 v[208:211], v[60:63], v[224:227], v[208:211]
  ds_read_b64_tr_b16 v[74:75], v12 offset:9472
  v_cvt_pk_bf16_f32 v24, v16, v17
  v_mfma_f32_16x16x32_bf16 v[100:103], v[32:35], v[228:231], v[100:103]
  buffer_load_dwordx4 v4, s[32:35], s26 offen offset:1024 sc1 lds
  v_cvt_pk_bf16_f32 v25, v18, v19
  v_mfma_f32_16x16x32_bf16 v[116:119], v[36:39], v[228:231], v[116:119]
  ds_read_b64_tr_b16 v[76:77], v13 offset:8448
  v_cvt_pk_bf16_f32 v26, v20, v21
  v_mfma_f32_16x16x32_bf16 v[132:135], v[40:43], v[228:231], v[132:135]
  ds_read_b64_tr_b16 v[78:79], v13 offset:9472
  v_cvt_pk_bf16_f32 v27, v22, v23
  v_mfma_f32_16x16x32_bf16 v[148:151], v[44:47], v[228:231], v[148:151]
  ds_read_b128 v[240:243], v14 offset:32768
  buffer_store_dwordx4 v[24:27], v2, s[40:43], s63 offen offset:0 sc1
  v_mfma_f32_16x16x32_bf16 v[164:167], v[48:51], v[228:231], v[164:167]
  ds_read_b128 v[244:247], v14 offset:33792
  v_accvgpr_read_b32 v16, a132
  v_mfma_f32_16x16x32_bf16 v[180:183], v[52:55], v[228:231], v[180:183]
  buffer_load_dwordx4 v5, s[32:35], s26 offen offset:2048 sc1 lds
  v_accvgpr_read_b32 v17, a133
  v_mfma_f32_16x16x32_bf16 v[196:199], v[56:59], v[228:231], v[196:199]
  ds_read_b64_tr_b16 v[80:81], v12 offset:8704
  v_accvgpr_read_b32 v18, a134
  v_mfma_f32_16x16x32_bf16 v[212:215], v[60:63], v[228:231], v[212:215]
  ds_read_b64_tr_b16 v[82:83], v12 offset:9728
  v_accvgpr_read_b32 v19, a135
  v_mfma_f32_16x16x32_bf16 v[104:107], v[32:35], v[232:235], v[104:107]
  ds_read_b64_tr_b16 v[84:85], v13 offset:8704
  v_accvgpr_read_b32 v20, a164
  v_mfma_f32_16x16x32_bf16 v[120:123], v[36:39], v[232:235], v[120:123]
  ds_read_b64_tr_b16 v[86:87], v13 offset:9728
  v_accvgpr_read_b32 v21, a165
  v_mfma_f32_16x16x32_bf16 v[136:139], v[40:43], v[232:235], v[136:139]
  buffer_load_dwordx4 v6, s[32:35], s26 offen offset:3072 sc1 lds
  v_accvgpr_read_b32 v22, a166
  v_mfma_f32_16x16x32_bf16 v[152:155], v[44:47], v[232:235], v[152:155]
  s_add_u32 s26, s26, 1024
  ds_read_b64_tr_b16 v[88:89], v12 offset:8960
  v_accvgpr_read_b32 v23, a167
  v_mfma_f32_16x16x32_bf16 v[168:171], v[48:51], v[232:235], v[168:171]
  ds_read_b64_tr_b16 v[90:91], v12 offset:9984
  v_cvt_pk_bf16_f32 v28, v16, v17
  v_mfma_f32_16x16x32_bf16 v[184:187], v[52:55], v[232:235], v[184:187]
  ds_read_b64_tr_b16 v[92:93], v13 offset:8960
  v_cvt_pk_bf16_f32 v29, v18, v19
  v_mfma_f32_16x16x32_bf16 v[200:203], v[56:59], v[232:235], v[200:203]
  s_add_u32 m0, s24, 114688
  ds_read_b64_tr_b16 v[94:95], v13 offset:9984
  v_cvt_pk_bf16_f32 v30, v20, v21
  v_mfma_f32_16x16x32_bf16 v[216:219], v[60:63], v[232:235], v[216:219]
  buffer_load_dwordx4 v10, s[36:39], s27 offen offset:2048 lds
  v_cvt_pk_bf16_f32 v31, v22, v23
  v_mfma_f32_16x16x32_bf16 v[108:111], v[32:35], v[236:239], v[108:111]
  ds_read_b128 v[248:251], v14 offset:34816
  buffer_store_dwordx4 v[28:31], v2, s[40:43], s63 offen offset:1024 sc1
  v_mfma_f32_16x16x32_bf16 v[124:127], v[36:39], v[236:239], v[124:127]
  ds_read_b128 v[252:255], v14 offset:35840
  v_accvgpr_write_b32 a26, 0
  v_mfma_f32_16x16x32_bf16 v[140:143], v[40:43], v[236:239], v[140:143]
  v_accvgpr_write_b32 a27, 0
  v_accvgpr_write_b32 a56, 0
  v_mfma_f32_16x16x32_bf16 v[156:159], v[44:47], v[236:239], v[156:159]
  v_xor_b32 v14, 0x10000, v14
  v_accvgpr_write_b32 a57, 0
  v_mfma_f32_16x16x32_bf16 v[172:175], v[48:51], v[236:239], v[172:175]
  buffer_load_dwordx4 v11, s[36:39], s27 offen offset:3072 lds
  v_accvgpr_write_b32 a58, 0
  v_mfma_f32_16x16x32_bf16 v[188:191], v[52:55], v[236:239], v[188:191]
  s_add_u32 s27, s27, 524288
  v_accvgpr_write_b32 a59, 0
  v_mfma_f32_16x16x32_bf16 v[204:207], v[56:59], v[236:239], v[204:207]
  v_mfma_f32_16x16x32_bf16 v[220:223], v[60:63], v[236:239], v[220:223]
  s_waitcnt vmcnt(19) lgkmcnt(0)
  v_mfma_f32_16x16x32_bf16 v[96:99], v[64:67], v[240:243], v[96:99]
  s_barrier
  v_accvgpr_read_b32 v16, a136
  v_accvgpr_read_b32 v17, a137
  v_mfma_f32_16x16x32_bf16 v[112:115], v[68:71], v[240:243], v[112:115]
  s_add_u32 s63, s63, s61
  ds_read_b64_tr_b16 v[32:33], v12 offset:32768
  v_accvgpr_read_b32 v18, a138
  v_mfma_f32_16x16x32_bf16 v[128:131], v[72:75], v[240:243], v[128:131]
  s_add_u32 m0, s24, 32768
  ds_read_b64_tr_b16 v[34:35], v12 offset:33792
  v_accvgpr_read_b32 v19, a139
  v_mfma_f32_16x16x32_bf16 v[144:147], v[76:79], v[240:243], v[144:147]
  buffer_load_dwordx4 v3, s[32:35], s26 offen offset:0 sc1 lds
  v_accvgpr_read_b32 v20, a168
  v_mfma_f32_16x16x32_bf16 v[160:163], v[80:83], v[240:243], v[160:163]
  ds_read_b64_tr_b16 v[36:37], v13 offset:32768
  v_accvgpr_read_b32 v21, a169
  v_mfma_f32_16x16x32_bf16 v[176:179], v[84:87], v[240:243], v[176:179]
  ds_read_b64_tr_b16 v[38:39], v13 offset:33792
  v_accvgpr_read_b32 v22, a170
  v_mfma_f32_16x16x32_bf16 v[192:195], v[88:91], v[240:243], v[192:195]
  ds_read_b64_tr_b16 v[40:41], v12 offset:33024
  v_accvgpr_read_b32 v23, a171
  v_mfma_f32_16x16x32_bf16 v[208:211], v[92:95], v[240:243], v[208:211]
  ds_read_b64_tr_b16 v[42:43], v12 offset:34048
  v_cvt_pk_bf16_f32 v24, v16, v17
  v_mfma_f32_16x16x32_bf16 v[100:103], v[64:67], v[244:247], v[100:103]
  buffer_load_dwordx4 v4, s[32:35], s26 offen offset:1024 sc1 lds
  v_cvt_pk_bf16_f32 v25, v18, v19
  v_mfma_f32_16x16x32_bf16 v[116:119], v[68:71], v[244:247], v[116:119]
  ds_read_b64_tr_b16 v[44:45], v13 offset:33024
  v_cvt_pk_bf16_f32 v26, v20, v21
  v_mfma_f32_16x16x32_bf16 v[132:135], v[72:75], v[244:247], v[132:135]
  ds_read_b64_tr_b16 v[46:47], v13 offset:34048
  v_cvt_pk_bf16_f32 v27, v22, v23
  v_mfma_f32_16x16x32_bf16 v[148:151], v[76:79], v[244:247], v[148:151]
  ds_read_b128 v[224:227], v14 offset:0
  buffer_store_dwordx4 v[24:27], v2, s[40:43], s63 offen offset:0 sc1
  v_mfma_f32_16x16x32_bf16 v[164:167], v[80:83], v[244:247], v[164:167]
  ds_read_b128 v[228:231], v14 offset:1024
  v_accvgpr_read_b32 v16, a140
  v_mfma_f32_16x16x32_bf16 v[180:183], v[84:87], v[244:247], v[180:183]
  buffer_load_dwordx4 v5, s[32:35], s26 offen offset:2048 sc1 lds
  v_accvgpr_read_b32 v17, a141
  v_mfma_f32_16x16x32_bf16 v[196:199], v[88:91], v[244:247], v[196:199]
  ds_read_b64_tr_b16 v[48:49], v12 offset:33280
  v_accvgpr_read_b32 v18, a142
  v_mfma_f32_16x16x32_bf16 v[212:215], v[92:95], v[244:247], v[212:215]
  ds_read_b64_tr_b16 v[50:51], v12 offset:34304
  v_accvgpr_read_b32 v19, a143
  v_mfma_f32_16x16x32_bf16 v[104:107], v[64:67], v[248:251], v[104:107]
  ds_read_b64_tr_b16 v[52:53], v13 offset:33280
  v_accvgpr_read_b32 v20, a172
  v_mfma_f32_16x16x32_bf16 v[120:123], v[68:71], v[248:251], v[120:123]
  ds_read_b64_tr_b16 v[54:55], v13 offset:34304
  v_accvgpr_read_b32 v21, a173
  v_mfma_f32_16x16x32_bf16 v[136:139], v[72:75], v[248:251], v[136:139]
  buffer_load_dwordx4 v6, s[32:35], s26 offen offset:3072 sc1 lds
  v_accvgpr_read_b32 v22, a174
  v_mfma_f32_16x16x32_bf16 v[152:155], v[76:79], v[248:251], v[152:155]
  s_add_u32 s26, s26, 1024
  ds_read_b64_tr_b16 v[56:57], v12 offset:33536
  v_accvgpr_read_b32 v23, a175
  v_mfma_f32_16x16x32_bf16 v[168:171], v[80:83], v[248:251], v[168:171]
  ds_read_b64_tr_b16 v[58:59], v12 offset:34560
  v_cvt_pk_bf16_f32 v28, v16, v17
  v_mfma_f32_16x16x32_bf16 v[184:187], v[84:87], v[248:251], v[184:187]
  ds_read_b64_tr_b16 v[60:61], v13 offset:33536
  v_cvt_pk_bf16_f32 v29, v18, v19
  v_mfma_f32_16x16x32_bf16 v[200:203], v[88:91], v[248:251], v[200:203]
  s_add_u32 m0, s24, 16384
  ds_read_b64_tr_b16 v[62:63], v13 offset:34560
  v_cvt_pk_bf16_f32 v30, v20, v21
  v_mfma_f32_16x16x32_bf16 v[216:219], v[92:95], v[248:251], v[216:219]
  buffer_load_dwordx4 v8, s[36:39], s27 offen offset:0 lds
  v_cvt_pk_bf16_f32 v31, v22, v23
  v_mfma_f32_16x16x32_bf16 v[108:111], v[64:67], v[252:255], v[108:111]
  ds_read_b128 v[232:235], v14 offset:2048
  buffer_store_dwordx4 v[28:31], v2, s[40:43], s63 offen offset:1024 sc1
  v_mfma_f32_16x16x32_bf16 v[124:127], v[68:71], v[252:255], v[124:127]
  ds_read_b128 v[236:239], v14 offset:3072
  v_accvgpr_write_b32 a28, 0
  v_mfma_f32_16x16x32_bf16 v[140:143], v[72:75], v[252:255], v[140:143]
  v_accvgpr_write_b32 a29, 0
  v_accvgpr_write_b32 a30, 0
  v_mfma_f32_16x16x32_bf16 v[156:159], v[76:79], v[252:255], v[156:159]
  v_accvgpr_write_b32 a31, 0
  v_accvgpr_write_b32 a60, 0
  v_mfma_f32_16x16x32_bf16 v[172:175], v[80:83], v[252:255], v[172:175]
  buffer_load_dwordx4 v9, s[36:39], s27 offen offset:1024 lds
  v_accvgpr_write_b32 a61, 0
  v_mfma_f32_16x16x32_bf16 v[188:191], v[84:87], v[252:255], v[188:191]
  v_accvgpr_write_b32 a62, 0
  v_mfma_f32_16x16x32_bf16 v[204:207], v[88:91], v[252:255], v[204:207]
  v_mfma_f32_16x16x32_bf16 v[220:223], v[92:95], v[252:255], v[220:223]
  s_waitcnt vmcnt(19) lgkmcnt(0)
  v_mfma_f32_16x16x32_bf16 v[96:99], v[32:35], v[224:227], v[96:99]
  s_add_u32 s63, s63, s61
  v_accvgpr_read_b32 v16, a144
  v_accvgpr_read_b32 v17, a145
  v_mfma_f32_16x16x32_bf16 v[112:115], v[36:39], v[224:227], v[112:115]
  ds_read_b64_tr_b16 v[64:65], v12 offset:40960
  v_accvgpr_read_b32 v18, a146
  v_mfma_f32_16x16x32_bf16 v[128:131], v[40:43], v[224:227], v[128:131]
  s_add_u32 m0, s24, 65536
  ds_read_b64_tr_b16 v[66:67], v12 offset:41984
  v_accvgpr_read_b32 v19, a147
  v_mfma_f32_16x16x32_bf16 v[144:147], v[44:47], v[224:227], v[144:147]
  buffer_load_dwordx4 v3, s[32:35], s26 offen offset:0 sc1 lds
  v_accvgpr_read_b32 v20, a176
  v_mfma_f32_16x16x32_bf16 v[160:163], v[48:51], v[224:227], v[160:163]
  ds_read_b64_tr_b16 v[68:69], v13 offset:40960
  v_accvgpr_read_b32 v21, a177
  v_mfma_f32_16x16x32_bf16 v[176:179], v[52:55], v[224:227], v[176:179]
  ds_read_b64_tr_b16 v[70:71], v13 offset:41984
  v_accvgpr_read_b32 v22, a178
  v_mfma_f32_16x16x32_bf16 v[192:195], v[56:59], v[224:227], v[192:195]
  ds_read_b64_tr_b16 v[72:73], v12 offset:41216
  v_accvgpr_read_b32 v23, a179
  v_mfma_f32_16x16x32_bf16 v[208:211], v[60:63], v[224:227], v[208:211]
  ds_read_b64_tr_b16 v[74:75], v12 offset:42240
  v_cvt_pk_bf16_f32 v24, v16, v17
  v_mfma_f32_16x16x32_bf16 v[100:103], v[32:35], v[228:231], v[100:103]
  buffer_load_dwordx4 v4, s[32:35], s26 offen offset:1024 sc1 lds
  v_cvt_pk_bf16_f32 v25, v18, v19
  v_mfma_f32_16x16x32_bf16 v[116:119], v[36:39], v[228:231], v[116:119]
  ds_read_b64_tr_b16 v[76:77], v13 offset:41216
  v_cvt_pk_bf16_f32 v26, v20, v21
  v_mfma_f32_16x16x32_bf16 v[132:135], v[40:43], v[228:231], v[132:135]
  ds_read_b64_tr_b16 v[78:79], v13 offset:42240
  v_cvt_pk_bf16_f32 v27, v22, v23
  v_mfma_f32_16x16x32_bf16 v[148:151], v[44:47], v[228:231], v[148:151]
  ds_read_b128 v[240:243], v14 offset:32768
  buffer_store_dwordx4 v[24:27], v2, s[40:43], s63 offen offset:0 sc1
  v_mfma_f32_16x16x32_bf16 v[164:167], v[48:51], v[228:231], v[164:167]
  ds_read_b128 v[244:247], v14 offset:33792
  v_accvgpr_read_b32 v16, a148
  v_mfma_f32_16x16x32_bf16 v[180:183], v[52:55], v[228:231], v[180:183]
  buffer_load_dwordx4 v5, s[32:35], s26 offen offset:2048 sc1 lds
  v_accvgpr_read_b32 v17, a149
  v_mfma_f32_16x16x32_bf16 v[196:199], v[56:59], v[228:231], v[196:199]
  ds_read_b64_tr_b16 v[80:81], v12 offset:41472
  v_accvgpr_read_b32 v18, a150
  v_mfma_f32_16x16x32_bf16 v[212:215], v[60:63], v[228:231], v[212:215]
  ds_read_b64_tr_b16 v[82:83], v12 offset:42496
  v_accvgpr_read_b32 v19, a151
  v_mfma_f32_16x16x32_bf16 v[104:107], v[32:35], v[232:235], v[104:107]
  ds_read_b64_tr_b16 v[84:85], v13 offset:41472
  v_accvgpr_read_b32 v20, a180
  v_mfma_f32_16x16x32_bf16 v[120:123], v[36:39], v[232:235], v[120:123]
  ds_read_b64_tr_b16 v[86:87], v13 offset:42496
  v_accvgpr_read_b32 v21, a181
  v_mfma_f32_16x16x32_bf16 v[136:139], v[40:43], v[232:235], v[136:139]
  buffer_load_dwordx4 v6, s[32:35], s26 offen offset:3072 sc1 lds
  v_accvgpr_read_b32 v22, a182
  v_mfma_f32_16x16x32_bf16 v[152:155], v[44:47], v[232:235], v[152:155]
  s_add_u32 s26, s26, 1024
  ds_read_b64_tr_b16 v[88:89], v12 offset:41728
  v_accvgpr_read_b32 v23, a183
  v_mfma_f32_16x16x32_bf16 v[168:171], v[48:51], v[232:235], v[168:171]
  ds_read_b64_tr_b16 v[90:91], v12 offset:42752
  v_cvt_pk_bf16_f32 v28, v16, v17
  v_mfma_f32_16x16x32_bf16 v[184:187], v[52:55], v[232:235], v[184:187]
  ds_read_b64_tr_b16 v[92:93], v13 offset:41728
  v_cvt_pk_bf16_f32 v29, v18, v19
  v_mfma_f32_16x16x32_bf16 v[200:203], v[56:59], v[232:235], v[200:203]
  s_add_u32 m0, s24, 16384
  ds_read_b64_tr_b16 v[94:95], v13 offset:42752
  v_cvt_pk_bf16_f32 v30, v20, v21
  v_mfma_f32_16x16x32_bf16 v[216:219], v[60:63], v[232:235], v[216:219]
  buffer_load_dwordx4 v10, s[36:39], s27 offen offset:2048 lds
  v_cvt_pk_bf16_f32 v31, v22, v23
  v_mfma_f32_16x16x32_bf16 v[108:111], v[32:35], v[236:239], v[108:111]
  ds_read_b128 v[248:251], v14 offset:34816
  buffer_store_dwordx4 v[28:31], v2, s[40:43], s63 offen offset:1024 sc1
  v_mfma_f32_16x16x32_bf16 v[124:127], v[36:39], v[236:239], v[124:127]
  ds_read_b128 v[252:255], v14 offset:35840
  v_accvgpr_write_b32 a63, 0
  v_mfma_f32_16x16x32_bf16 v[140:143], v[40:43], v[236:239], v[140:143]
  v_accvgpr_write_b32 a64, 0
  v_accvgpr_write_b32 a65, 0
  v_mfma_f32_16x16x32_bf16 v[156:159], v[44:47], v[236:239], v[156:159]
  v_xor_b32 v14, 0x10000, v14
  v_accvgpr_write_b32 a66, 0
  v_mfma_f32_16x16x32_bf16 v[172:175], v[48:51], v[236:239], v[172:175]
  buffer_load_dwordx4 v11, s[36:39], s27 offen offset:3072 lds
  v_mfma_f32_16x16x32_bf16 v[188:191], v[52:55], v[236:239], v[188:191]
  s_add_u32 s27, s27, 524288
  v_xor_b32 v12, 0x10000, v12
  v_mfma_f32_16x16x32_bf16 v[204:207], v[56:59], v[236:239], v[204:207]
  v_xor_b32 v13, 0x10000, v13
  v_mfma_f32_16x16x32_bf16 v[220:223], v[60:63], v[236:239], v[220:223]
  s_waitcnt vmcnt(19) lgkmcnt(0)
  v_mfma_f32_16x16x32_bf16 v[96:99], v[64:67], v[240:243], v[96:99]
  s_barrier
  v_accvgpr_read_b32 v16, a152
  v_accvgpr_read_b32 v17, a153
  v_mfma_f32_16x16x32_bf16 v[112:115], v[68:71], v[240:243], v[112:115]
  s_add_u32 s63, s63, s61
  ds_read_b64_tr_b16 v[32:33], v12 offset:0
  v_accvgpr_read_b32 v18, a154
  v_mfma_f32_16x16x32_bf16 v[128:131], v[72:75], v[240:243], v[128:131]
  s_add_u32 m0, s24, 98304
  ds_read_b64_tr_b16 v[34:35], v12 offset:1024
  v_accvgpr_read_b32 v19, a155
  v_mfma_f32_16x16x32_bf16 v[144:147], v[76:79], v[240:243], v[144:147]
  buffer_load_dwordx4 v3, s[32:35], s26 offen offset:0 sc1 lds
  v_accvgpr_read_b32 v20, a184
  v_mfma_f32_16x16x32_bf16 v[160:163], v[80:83], v[240:243], v[160:163]
  ds_read_b64_tr_b16 v[36:37], v13 offset:0
  v_accvgpr_read_b32 v21, a185
  v_mfma_f32_16x16x32_bf16 v[176:179], v[84:87], v[240:243], v[176:179]
  ds_read_b64_tr_b16 v[38:39], v13 offset:1024
  v_accvgpr_read_b32 v22, a186
  v_mfma_f32_16x16x32_bf16 v[192:195], v[88:91], v[240:243], v[192:195]
  ds_read_b64_tr_b16 v[40:41], v12 offset:256
  v_accvgpr_read_b32 v23, a187
  v_mfma_f32_16x16x32_bf16 v[208:211], v[92:95], v[240:243], v[208:211]
  ds_read_b64_tr_b16 v[42:43], v12 offset:1280
  v_cvt_pk_bf16_f32 v24, v16, v17
  v_mfma_f32_16x16x32_bf16 v[100:103], v[64:67], v[244:247], v[100:103]
  buffer_load_dwordx4 v4, s[32:35], s26 offen offset:1024 sc1 lds
  v_cvt_pk_bf16_f32 v25, v18, v19
  v_mfma_f32_16x16x32_bf16 v[116:119], v[68:71], v[244:247], v[116:119]
  ds_read_b64_tr_b16 v[44:45], v13 offset:256
  v_cvt_pk_bf16_f32 v26, v20, v21
  v_mfma_f32_16x16x32_bf16 v[132:135], v[72:75], v[244:247], v[132:135]
  ds_read_b64_tr_b16 v[46:47], v13 offset:1280
  v_cvt_pk_bf16_f32 v27, v22, v23
  v_mfma_f32_16x16x32_bf16 v[148:151], v[76:79], v[244:247], v[148:151]
  ds_read_b128 v[224:227], v14 offset:0
  buffer_store_dwordx4 v[24:27], v2, s[40:43], s63 offen offset:0 sc1
  v_mfma_f32_16x16x32_bf16 v[164:167], v[80:83], v[244:247], v[164:167]
  ds_read_b128 v[228:231], v14 offset:1024
  v_accvgpr_read_b32 v16, a156
  v_mfma_f32_16x16x32_bf16 v[180:183], v[84:87], v[244:247], v[180:183]
  buffer_load_dwordx4 v5, s[32:35], s26 offen offset:2048 sc1 lds
  v_accvgpr_read_b32 v17, a157
  v_mfma_f32_16x16x32_bf16 v[196:199], v[88:91], v[244:247], v[196:199]
  ds_read_b64_tr_b16 v[48:49], v12 offset:512
  v_accvgpr_read_b32 v18, a158
  v_mfma_f32_16x16x32_bf16 v[212:215], v[92:95], v[244:247], v[212:215]
  ds_read_b64_tr_b16 v[50:51], v12 offset:1536
  v_accvgpr_read_b32 v19, a159
  v_mfma_f32_16x16x32_bf16 v[104:107], v[64:67], v[248:251], v[104:107]
  ds_read_b64_tr_b16 v[52:53], v13 offset:512
  v_accvgpr_read_b32 v20, a188
  v_mfma_f32_16x16x32_bf16 v[120:123], v[68:71], v[248:251], v[120:123]
  ds_read_b64_tr_b16 v[54:55], v13 offset:1536
  v_accvgpr_read_b32 v21, a189
  v_mfma_f32_16x16x32_bf16 v[136:139], v[72:75], v[248:251], v[136:139]
  buffer_load_dwordx4 v6, s[32:35], s26 offen offset:3072 sc1 lds
  v_accvgpr_read_b32 v22, a190
  v_mfma_f32_16x16x32_bf16 v[152:155], v[76:79], v[248:251], v[152:155]
  s_add_u32 s26, s26, 1024
  ds_read_b64_tr_b16 v[56:57], v12 offset:768
  v_accvgpr_read_b32 v23, a191
  v_mfma_f32_16x16x32_bf16 v[168:171], v[80:83], v[248:251], v[168:171]
  ds_read_b64_tr_b16 v[58:59], v12 offset:1792
  v_cvt_pk_bf16_f32 v28, v16, v17
  v_mfma_f32_16x16x32_bf16 v[184:187], v[84:87], v[248:251], v[184:187]
  ds_read_b64_tr_b16 v[60:61], v13 offset:768
  v_cvt_pk_bf16_f32 v29, v18, v19
  v_mfma_f32_16x16x32_bf16 v[200:203], v[88:91], v[248:251], v[200:203]
  s_add_u32 m0, s24, 49152
  ds_read_b64_tr_b16 v[62:63], v13 offset:1792
  v_cvt_pk_bf16_f32 v30, v20, v21
  v_mfma_f32_16x16x32_bf16 v[216:219], v[92:95], v[248:251], v[216:219]
  buffer_load_dwordx4 v8, s[36:39], s27 offen offset:0 lds
  v_cvt_pk_bf16_f32 v31, v22, v23
  v_mfma_f32_16x16x32_bf16 v[108:111], v[64:67], v[252:255], v[108:111]
  ds_read_b128 v[232:235], v14 offset:2048
  buffer_store_dwordx4 v[28:31], v2, s[40:43], s63 offen offset:1024 sc1
  v_mfma_f32_16x16x32_bf16 v[124:127], v[68:71], v[252:255], v[124:127]
  ds_read_b128 v[236:239], v14 offset:3072
  v_accvgpr_write_b32 a67, 0
  v_mfma_f32_16x16x32_bf16 v[140:143], v[72:75], v[252:255], v[140:143]
  v_accvgpr_write_b32 a96, 0
  v_accvgpr_write_b32 a97, 0
  v_mfma_f32_16x16x32_bf16 v[156:159], v[76:79], v[252:255], v[156:159]
  v_accvgpr_write_b32 a98, 0
  v_accvgpr_write_b32 a99, 0
  v_mfma_f32_16x16x32_bf16 v[172:175], v[80:83], v[252:255], v[172:175]
  buffer_load_dwordx4 v9, s[36:39], s27 offen offset:1024 lds
  v_accvgpr_write_b32 a68, 0
  v_mfma_f32_16x16x32_bf16 v[188:191], v[84:87], v[252:255], v[188:191]
  v_accvgpr_write_b32 a69, 0
  v_mfma_f32_16x16x32_bf16 v[204:207], v[88:91], v[252:255], v[204:207]
  v_mfma_f32_16x16x32_bf16 v[220:223], v[92:95], v[252:255], v[220:223]
  s_waitcnt vmcnt(19) lgkmcnt(0)
  v_mfma_f32_16x16x32_bf16 v[96:99], v[32:35], v[224:227], v[96:99]
  s_mul_i32 s63, s60, 3
  v_accvgpr_read_b32 v16, a192
  v_accvgpr_read_b32 v17, a193
  v_accvgpr_read_b32 v18, a194
  v_mfma_f32_16x16x32_bf16 v[112:115], v[36:39], v[224:227], v[112:115]
  s_add_u32 s63, s63, s62
  ds_read_b64_tr_b16 v[64:65], v12 offset:8192
  v_accvgpr_read_b32 v19, a195
  v_mfma_f32_16x16x32_bf16 v[128:131], v[40:43], v[224:227], v[128:131]
  s_add_u32 m0, s24, 0
  ds_read_b64_tr_b16 v[66:67], v12 offset:9216
  v_accvgpr_read_b32 v20, a224
  v_mfma_f32_16x16x32_bf16 v[144:147], v[44:47], v[224:227], v[144:147]
  buffer_load_dwordx4 v3, s[32:35], s26 offen offset:0 sc1 lds
  v_accvgpr_read_b32 v21, a225
  v_accvgpr_read_b32 v22, a226
  v_mfma_f32_16x16x32_bf16 v[160:163], v[48:51], v[224:227], v[160:163]
  ds_read_b64_tr_b16 v[68:69], v13 offset:8192
  v_accvgpr_read_b32 v23, a227
  v_mfma_f32_16x16x32_bf16 v[176:179], v[52:55], v[224:227], v[176:179]
  ds_read_b64_tr_b16 v[70:71], v13 offset:9216
  v_cvt_pk_bf16_f32 v24, v16, v17
  v_mfma_f32_16x16x32_bf16 v[192:195], v[56:59], v[224:227], v[192:195]
  ds_read_b64_tr_b16 v[72:73], v12 offset:8448
  v_cvt_pk_bf16_f32 v25, v18, v19
  v_mfma_f32_16x16x32_bf16 v[208:211], v[60:63], v[224:227], v[208:211]
  ds_read_b64_tr_b16 v[74:75], v12 offset:9472
  v_cvt_pk_bf16_f32 v26, v20, v21
  v_cvt_pk_bf16_f32 v27, v22, v23
  v_mfma_f32_16x16x32_bf16 v[100:103], v[32:35], v[228:231], v[100:103]
  buffer_load_dwordx4 v4, s[32:35], s26 offen offset:1024 sc1 lds
  buffer_store_dwordx4 v[24:27], v2, s[40:43], s63 offen offset:0 sc1
  v_mfma_f32_16x16x32_bf16 v[116:119], v[36:39], v[228:231], v[116:119]
  ds_read_b64_tr_b16 v[76:77], v13 offset:8448
  v_accvgpr_read_b32 v16, a196
  v_mfma_f32_16x16x32_bf16 v[132:135], v[40:43], v[228:231], v[132:135]
  ds_read_b64_tr_b16 v[78:79], v13 offset:9472
  v_accvgpr_read_b32 v17, a197
  v_mfma_f32_16x16x32_bf16 v[148:151], v[44:47], v[228:231], v[148:151]
  ds_read_b128 v[240:243], v14 offset:32768
  v_accvgpr_read_b32 v18, a198
  v_accvgpr_read_b32 v19, a199
  v_mfma_f32_16x16x32_bf16 v[164:167], v[48:51], v[228:231], v[164:167]
  ds_read_b128 v[244:247], v14 offset:33792
  v_accvgpr_read_b32 v20, a228
  v_mfma_f32_16x16x32_bf16 v[180:183], v[52:55], v[228:231], v[180:183]
  buffer_load_dwordx4 v5, s[32:35], s26 offen offset:2048 sc1 lds
  v_accvgpr_read_b32 v21, a229
  v_mfma_f32_16x16x32_bf16 v[196:199], v[56:59], v[228:231], v[196:199]
  ds_read_b64_tr_b16 v[80:81], v12 offset:8704
  v_accvgpr_read_b32 v22, a230
  v_mfma_f32_16x16x32_bf16 v[212:215], v[60:63], v[228:231], v[212:215]
  ds_read_b64_tr_b16 v[82:83], v12 offset:9728
  v_accvgpr_read_b32 v23, a231
  v_cvt_pk_bf16_f32 v28, v16, v17
  v_mfma_f32_16x16x32_bf16 v[104:107], v[32:35], v[232:235], v[104:107]
  ds_read_b64_tr_b16 v[84:85], v13 offset:8704
  v_cvt_pk_bf16_f32 v29, v18, v19
  v_mfma_f32_16x16x32_bf16 v[120:123], v[36:39], v[232:235], v[120:123]
  ds_read_b64_tr_b16 v[86:87], v13 offset:9728
  v_cvt_pk_bf16_f32 v30, v20, v21
  v_mfma_f32_16x16x32_bf16 v[136:139], v[40:43], v[232:235], v[136:139]
  buffer_load_dwordx4 v6, s[32:35], s26 offen offset:3072 sc1 lds
  v_cvt_pk_bf16_f32 v31, v22, v23
  v_mfma_f32_16x16x32_bf16 v[152:155], v[44:47], v[232:235], v[152:155]
  s_add_u32 s26, s26, 1024
  ds_read_b64_tr_b16 v[88:89], v12 offset:8960
  buffer_store_dwordx4 v[28:31], v2, s[40:43], s63 offen offset:1024 sc1
  v_mfma_f32_16x16x32_bf16 v[168:171], v[48:51], v[232:235], v[168:171]
  s_add_u32 s63, s63, s61
  ds_read_b64_tr_b16 v[90:91], v12 offset:9984
  v_accvgpr_read_b32 v16, a200
  v_mfma_f32_16x16x32_bf16 v[184:187], v[52:55], v[232:235], v[184:187]
  ds_read_b64_tr_b16 v[92:93], v13 offset:8960
  v_accvgpr_read_b32 v17, a201
  v_mfma_f32_16x16x32_bf16 v[200:203], v[56:59], v[232:235], v[200:203]
  s_add_u32 m0, s24, 49152
  ds_read_b64_tr_b16 v[94:95], v13 offset:9984
  v_accvgpr_read_b32 v18, a202
  v_accvgpr_read_b32 v19, a203
  v_mfma_f32_16x16x32_bf16 v[216:219], v[60:63], v[232:235], v[216:219]
  buffer_load_dwordx4 v10, s[36:39], s27 offen offset:2048 lds
  v_accvgpr_read_b32 v20, a232
  v_mfma_f32_16x16x32_bf16 v[108:111], v[32:35], v[236:239], v[108:111]
  ds_read_b128 v[248:251], v14 offset:34816
  v_accvgpr_read_b32 v21, a233
  v_mfma_f32_16x16x32_bf16 v[124:127], v[36:39], v[236:239], v[124:127]
  ds_read_b128 v[252:255], v14 offset:35840
  v_accvgpr_read_b32 v22, a234
  v_mfma_f32_16x16x32_bf16 v[140:143], v[40:43], v[236:239], v[140:143]
  v_accvgpr_read_b32 v23, a235
  v_cvt_pk_bf16_f32 v24, v16, v17
  v_cvt_pk_bf16_f32 v25, v18, v19
  v_mfma_f32_16x16x32_bf16 v[156:159], v[44:47], v[236:239], v[156:159]
  v_xor_b32 v14, 0x10000, v14
  v_cvt_pk_bf16_f32 v26, v20, v21
  v_mfma_f32_16x16x32_bf16 v[172:175], v[48:51], v[236:239], v[172:175]
  buffer_load_dwordx4 v11, s[36:39], s27 offen offset:3072 lds
  v_cvt_pk_bf16_f32 v27, v22, v23
  v_mfma_f32_16x16x32_bf16 v[188:191], v[52:55], v[236:239], v[188:191]
  s_add_u32 s27, s27, 524288
  buffer_store_dwordx4 v[24:27], v2, s[40:43], s63 offen offset:0 sc1
  v_mfma_f32_16x16x32_bf16 v[204:207], v[56:59], v[236:239], v[204:207]
  v_mfma_f32_16x16x32_bf16 v[220:223], v[60:63], v[236:239], v[220:223]
  s_waitcnt vmcnt(20) lgkmcnt(0)
  v_mfma_f32_16x16x32_bf16 v[96:99], v[64:67], v[240:243], v[96:99]
  s_barrier
  v_accvgpr_read_b32 v16, a204
  v_accvgpr_read_b32 v17, a205
  v_accvgpr_read_b32 v18, a206
  v_mfma_f32_16x16x32_bf16 v[112:115], v[68:71], v[240:243], v[112:115]
  ds_read_b64_tr_b16 v[32:33], v12 offset:32768
  v_accvgpr_read_b32 v19, a207
  v_accvgpr_read_b32 v20, a236
  v_mfma_f32_16x16x32_bf16 v[128:131], v[72:75], v[240:243], v[128:131]
  s_add_u32 m0, s24, 32768
  ds_read_b64_tr_b16 v[34:35], v12 offset:33792
  v_accvgpr_read_b32 v21, a237
  v_mfma_f32_16x16x32_bf16 v[144:147], v[76:79], v[240:243], v[144:147]
  buffer_load_dwordx4 v3, s[32:35], s26 offen offset:0 sc1 lds
  v_accvgpr_read_b32 v22, a238
  v_accvgpr_read_b32 v23, a239
  v_mfma_f32_16x16x32_bf16 v[160:163], v[80:83], v[240:243], v[160:163]
  ds_read_b64_tr_b16 v[36:37], v13 offset:32768
  v_cvt_pk_bf16_f32 v28, v16, v17
  v_cvt_pk_bf16_f32 v29, v18, v19
  v_mfma_f32_16x16x32_bf16 v[176:179], v[84:87], v[240:243], v[176:179]
  ds_read_b64_tr_b16 v[38:39], v13 offset:33792
  v_cvt_pk_bf16_f32 v30, v20, v21
  v_mfma_f32_16x16x32_bf16 v[192:195], v[88:91], v[240:243], v[192:195]
  ds_read_b64_tr_b16 v[40:41], v12 offset:33024
  v_cvt_pk_bf16_f32 v31, v22, v23
  v_mfma_f32_16x16x32_bf16 v[208:211], v[92:95], v[240:243], v[208:211]
  ds_read_b64_tr_b16 v[42:43], v12 offset:34048
  buffer_store_dwordx4 v[28:31], v2, s[40:43], s63 offen offset:1024 sc1
  v_accvgpr_read_b32 v16, a208
  v_mfma_f32_16x16x32_bf16 v[100:103], v[64:67], v[244:247], v[100:103]
  s_add_u32 s63, s63, s61
  buffer_load_dwordx4 v4, s[32:35], s26 offen offset:1024 sc1 lds
  v_accvgpr_read_b32 v17, a209
  v_mfma_f32_16x16x32_bf16 v[116:119], v[68:71], v[244:247], v[116:119]
  ds_read_b64_tr_b16 v[44:45], v13 offset:33024
  v_accvgpr_read_b32 v18, a210
  v_accvgpr_read_b32 v19, a211
  v_mfma_f32_16x16x32_bf16 v[132:135], v[72:75], v[244:247], v[132:135]
  ds_read_b64_tr_b16 v[46:47], v13 offset:34048
  v_accvgpr_read_b32 v20, a240
  v_mfma_f32_16x16x32_bf16 v[148:151], v[76:79], v[244:247], v[148:151]
  ds_read_b128 v[224:227], v14 offset:0
  v_accvgpr_read_b32 v21, a241
  v_accvgpr_read_b32 v22, a242
  v_mfma_f32_16x16x32_bf16 v[164:167], v[80:83], v[244:247], v[164:167]
  ds_read_b128 v[228:231], v14 offset:1024
  v_accvgpr_read_b32 v23, a243
  v_cvt_pk_bf16_f32 v24, v16, v17
  v_mfma_f32_16x16x32_bf16 v[180:183], v[84:87], v[244:247], v[180:183]
  buffer_load_dwordx4 v5, s[32:35], s26 offen offset:2048 sc1 lds
  v_cvt_pk_bf16_f32 v25, v18, v19
  v_mfma_f32_16x16x32_bf16 v[196:199], v[88:91], v[244:247], v[196:199]
  ds_read_b64_tr_b16 v[48:49], v12 offset:33280
  v_cvt_pk_bf16_f32 v26, v20, v21
  v_cvt_pk_bf16_f32 v27, v22, v23
  v_mfma_f32_16x16x32_bf16 v[212:215], v[92:95], v[244:247], v[212:215]
  ds_read_b64_tr_b16 v[50:51], v12 offset:34304
  buffer_store_dwordx4 v[24:27], v2, s[40:43], s63 offen offset:0 sc1
  v_accvgpr_read_b32 v16, a212
  v_mfma_f32_16x16x32_bf16 v[104:107], v[64:67], v[248:251], v[104:107]
  ds_read_b64_tr_b16 v[52:53], v13 offset:33280
  v_accvgpr_read_b32 v17, a213
  v_mfma_f32_16x16x32_bf16 v[120:123], v[68:71], v[248:251], v[120:123]
  ds_read_b64_tr_b16 v[54:55], v13 offset:34304
  v_accvgpr_read_b32 v18, a214
  v_accvgpr_read_b32 v19, a215
  v_mfma_f32_16x16x32_bf16 v[136:139], v[72:75], v[248:251], v[136:139]
  buffer_load_dwordx4 v6, s[32:35], s26 offen offset:3072 sc1 lds
  v_accvgpr_read_b32 v20, a244
  v_accvgpr_read_b32 v21, a245
  v_mfma_f32_16x16x32_bf16 v[152:155], v[76:79], v[248:251], v[152:155]
  s_add_u32 s26, s26, 1024
  ds_read_b64_tr_b16 v[56:57], v12 offset:33536
  v_accvgpr_read_b32 v22, a246
  v_mfma_f32_16x16x32_bf16 v[168:171], v[80:83], v[248:251], v[168:171]
  ds_read_b64_tr_b16 v[58:59], v12 offset:34560
  v_accvgpr_read_b32 v23, a247
  v_cvt_pk_bf16_f32 v28, v16, v17
  v_mfma_f32_16x16x32_bf16 v[184:187], v[84:87], v[248:251], v[184:187]
  ds_read_b64_tr_b16 v[60:61], v13 offset:33536
  v_cvt_pk_bf16_f32 v29, v18, v19
  v_mfma_f32_16x16x32_bf16 v[200:203], v[88:91], v[248:251], v[200:203]
  ds_read_b64_tr_b16 v[62:63], v13 offset:34560
  v_cvt_pk_bf16_f32 v30, v20, v21
  v_cvt_pk_bf16_f32 v31, v22, v23
  v_mfma_f32_16x16x32_bf16 v[216:219], v[92:95], v[248:251], v[216:219]
  buffer_store_dwordx4 v[28:31], v2, s[40:43], s63 offen offset:1024 sc1
  v_and_b32 v11, 15, v1
  v_lshrrev_b32 v10, 4, v1
  v_mfma_f32_16x16x32_bf16 v[108:111], v[64:67], v[252:255], v[108:111]
  ds_read_b128 v[232:235], v14 offset:2048
  v_lshlrev_b32 v10, 2, v10
  v_mfma_f32_16x16x32_bf16 v[124:127], v[68:71], v[252:255], v[124:127]
  ds_read_b128 v[236:239], v14 offset:3072
  v_sub_u32 v11, v11, v10
  v_cmp_le_i32 s[68:69], 0, v11
  v_mfma_f32_16x16x32_bf16 v[140:143], v[72:75], v[252:255], v[140:143]
  v_cmp_le_i32 s[70:71], 1, v11
  v_cmp_le_i32 s[72:73], 2, v11
  v_cmp_le_i32 s[74:75], 3, v11
  v_mfma_f32_16x16x32_bf16 v[156:159], v[76:79], v[252:255], v[156:159]
  v_and_b32 v8, 7, v1
  v_lshlrev_b32 v8, 2, v8
  v_mfma_f32_16x16x32_bf16 v[172:175], v[80:83], v[252:255], v[172:175]
  v_add_u32 v8, s30, v8
  v_mov_b32 v9, 1073741824
  v_mov_b32 v10, 1
  v_mfma_f32_16x16x32_bf16 v[188:191], v[84:87], v[252:255], v[188:191]
  v_writelane_b32 v9, s29, 0
  v_mfma_f32_16x16x32_bf16 v[204:207], v[88:91], v[252:255], v[204:207]
  v_mfma_f32_16x16x32_bf16 v[220:223], v[92:95], v[252:255], v[220:223]
  s_waitcnt vmcnt(19) lgkmcnt(0)
  v_mfma_f32_16x16x32_bf16 v[96:99], v[32:35], v[224:227], v[96:99]
  s_add_u32 s63, s63, s61
  v_accvgpr_read_b32 v16, a216
  v_accvgpr_read_b32 v17, a217
  v_mfma_f32_16x16x32_bf16 v[112:115], v[36:39], v[224:227], v[112:115]
  ds_read_b64_tr_b16 v[64:65], v12 offset:40960
  v_accvgpr_read_b32 v18, a218
  v_mfma_f32_16x16x32_bf16 v[128:131], v[40:43], v[224:227], v[128:131]
  s_add_u32 m0, s24, 65536
  ds_read_b64_tr_b16 v[66:67], v12 offset:41984
  v_accvgpr_read_b32 v19, a219
  v_mfma_f32_16x16x32_bf16 v[144:147], v[44:47], v[224:227], v[144:147]
  buffer_load_dwordx4 v3, s[32:35], s26 offen offset:0 sc1 lds
  v_accvgpr_read_b32 v20, a248
  v_mfma_f32_16x16x32_bf16 v[160:163], v[48:51], v[224:227], v[160:163]
  ds_read_b64_tr_b16 v[68:69], v13 offset:40960
  v_accvgpr_read_b32 v21, a249
  v_mfma_f32_16x16x32_bf16 v[176:179], v[52:55], v[224:227], v[176:179]
  ds_read_b64_tr_b16 v[70:71], v13 offset:41984
  v_accvgpr_read_b32 v22, a250
  v_mfma_f32_16x16x32_bf16 v[192:195], v[56:59], v[224:227], v[192:195]
  ds_read_b64_tr_b16 v[72:73], v12 offset:41216
  v_accvgpr_read_b32 v23, a251
  v_mfma_f32_16x16x32_bf16 v[208:211], v[60:63], v[224:227], v[208:211]
  ds_read_b64_tr_b16 v[74:75], v12 offset:42240
  v_cvt_pk_bf16_f32 v24, v16, v17
  v_mfma_f32_16x16x32_bf16 v[100:103], v[32:35], v[228:231], v[100:103]
  buffer_load_dwordx4 v4, s[32:35], s26 offen offset:1024 sc1 lds
  v_cvt_pk_bf16_f32 v25, v18, v19
  v_mfma_f32_16x16x32_bf16 v[116:119], v[36:39], v[228:231], v[116:119]
  ds_read_b64_tr_b16 v[76:77], v13 offset:41216
  v_cvt_pk_bf16_f32 v26, v20, v21
  v_mfma_f32_16x16x32_bf16 v[132:135], v[40:43], v[228:231], v[132:135]
  ds_read_b64_tr_b16 v[78:79], v13 offset:42240
  v_cvt_pk_bf16_f32 v27, v22, v23
  v_mfma_f32_16x16x32_bf16 v[148:151], v[44:47], v[228:231], v[148:151]
  ds_read_b128 v[240:243], v14 offset:32768
  buffer_store_dwordx4 v[24:27], v2, s[40:43], s63 offen offset:0 sc1
  v_mfma_f32_16x16x32_bf16 v[164:167], v[48:51], v[228:231], v[164:167]
  ds_read_b128 v[244:247], v14 offset:33792
  v_accvgpr_read_b32 v16, a220
  v_mfma_f32_16x16x32_bf16 v[180:183], v[52:55], v[228:231], v[180:183]
  buffer_load_dwordx4 v5, s[32:35], s26 offen offset:2048 sc1 lds
  v_accvgpr_read_b32 v17, a221
  v_mfma_f32_16x16x32_bf16 v[196:199], v[56:59], v[228:231], v[196:199]
  ds_read_b64_tr_b16 v[80:81], v12 offset:41472
  v_accvgpr_read_b32 v18, a222
  v_mfma_f32_16x16x32_bf16 v[212:215], v[60:63], v[228:231], v[212:215]
  ds_read_b64_tr_b16 v[82:83], v12 offset:42496
  v_accvgpr_read_b32 v19, a223
  v_mfma_f32_16x16x32_bf16 v[104:107], v[32:35], v[232:235], v[104:107]
  ds_read_b64_tr_b16 v[84:85], v13 offset:41472
  v_accvgpr_read_b32 v20, a252
  v_mfma_f32_16x16x32_bf16 v[120:123], v[36:39], v[232:235], v[120:123]
  ds_read_b64_tr_b16 v[86:87], v13 offset:42496
  v_accvgpr_read_b32 v21, a253
  v_mfma_f32_16x16x32_bf16 v[136:139], v[40:43], v[232:235], v[136:139]
  buffer_load_dwordx4 v6, s[32:35], s26 offen offset:3072 sc1 lds
  v_accvgpr_read_b32 v22, a254
  v_mfma_f32_16x16x32_bf16 v[152:155], v[44:47], v[232:235], v[152:155]
  s_add_u32 s26, s26, 1024
  ds_read_b64_tr_b16 v[88:89], v12 offset:41728
  v_accvgpr_read_b32 v23, a255
  v_mfma_f32_16x16x32_bf16 v[168:171], v[48:51], v[232:235], v[168:171]
  ds_read_b64_tr_b16 v[90:91], v12 offset:42752
  v_cvt_pk_bf16_f32 v28, v16, v17
  v_mfma_f32_16x16x32_bf16 v[184:187], v[52:55], v[232:235], v[184:187]
  ds_read_b64_tr_b16 v[92:93], v13 offset:41728
  v_cvt_pk_bf16_f32 v29, v18, v19
  v_mfma_f32_16x16x32_bf16 v[200:203], v[56:59], v[232:235], v[200:203]
  ds_read_b64_tr_b16 v[94:95], v13 offset:42752
  v_cvt_pk_bf16_f32 v30, v20, v21
  v_mfma_f32_16x16x32_bf16 v[216:219], v[60:63], v[232:235], v[216:219]
  v_cvt_pk_bf16_f32 v31, v22, v23
  v_mfma_f32_16x16x32_bf16 v[108:111], v[32:35], v[236:239], v[108:111]
  ds_read_b128 v[248:251], v14 offset:34816
  buffer_store_dwordx4 v[28:31], v2, s[40:43], s63 offen offset:1024 sc1
  v_mfma_f32_16x16x32_bf16 v[124:127], v[36:39], v[236:239], v[124:127]
  ds_read_b128 v[252:255], v14 offset:35840
  v_accvgpr_write_b32 a70, 0
  v_mfma_f32_16x16x32_bf16 v[140:143], v[40:43], v[236:239], v[140:143]
  v_accvgpr_write_b32 a71, 0
  v_accvgpr_write_b32 a100, 0
  v_mfma_f32_16x16x32_bf16 v[156:159], v[44:47], v[236:239], v[156:159]
  v_xor_b32 v14, 0x10000, v14
  v_accvgpr_write_b32 a101, 0
  v_mfma_f32_16x16x32_bf16 v[172:175], v[48:51], v[236:239], v[172:175]
  v_accvgpr_write_b32 a102, 0
  v_accvgpr_write_b32 a103, 0
  v_mfma_f32_16x16x32_bf16 v[188:191], v[52:55], v[236:239], v[188:191]
  v_xor_b32 v12, 0x10000, v12
  v_mfma_f32_16x16x32_bf16 v[204:207], v[56:59], v[236:239], v[204:207]
  v_xor_b32 v13, 0x10000, v13
  v_mfma_f32_16x16x32_bf16 v[220:223], v[60:63], v[236:239], v[220:223]
  s_waitcnt vmcnt(17) lgkmcnt(0)
  v_mfma_f32_16x16x32_bf16 v[96:99], v[64:67], v[240:243], v[96:99]
  s_barrier
  v_accvgpr_write_b32 a72, 0
  v_accvgpr_write_b32 a73, 0
  v_mfma_f32_16x16x32_bf16 v[112:115], v[68:71], v[240:243], v[112:115]
  ds_read_b64_tr_b16 v[32:33], v12 offset:0
  v_accvgpr_write_b32 a74, 0
  v_mfma_f32_16x16x32_bf16 v[128:131], v[72:75], v[240:243], v[128:131]
  s_add_u32 m0, s24, 98304
  ds_read_b64_tr_b16 v[34:35], v12 offset:1024
  v_accvgpr_write_b32 a75, 0
  v_mfma_f32_16x16x32_bf16 v[144:147], v[76:79], v[240:243], v[144:147]
  buffer_load_dwordx4 v3, s[32:35], s26 offen offset:0 sc1 lds
  v_accvgpr_write_b32 a104, 0
  v_mfma_f32_16x16x32_bf16 v[160:163], v[80:83], v[240:243], v[160:163]
  ds_read_b64_tr_b16 v[36:37], v13 offset:0
  v_accvgpr_write_b32 a105, 0
  v_mfma_f32_16x16x32_bf16 v[176:179], v[84:87], v[240:243], v[176:179]
  ds_read_b64_tr_b16 v[38:39], v13 offset:1024
  v_accvgpr_write_b32 a106, 0
  v_mfma_f32_16x16x32_bf16 v[192:195], v[88:91], v[240:243], v[192:195]
  ds_read_b64_tr_b16 v[40:41], v12 offset:256
  v_accvgpr_write_b32 a107, 0
  v_mfma_f32_16x16x32_bf16 v[208:211], v[92:95], v[240:243], v[208:211]
  ds_read_b64_tr_b16 v[42:43], v12 offset:1280
  v_accvgpr_write_b32 a76, 0
  v_mfma_f32_16x16x32_bf16 v[100:103], v[64:67], v[244:247], v[100:103]
  buffer_load_dwordx4 v4, s[32:35], s26 offen offset:1024 sc1 lds
  v_accvgpr_write_b32 a77, 0
  v_mfma_f32_16x16x32_bf16 v[116:119], v[68:71], v[244:247], v[116:119]
  ds_read_b64_tr_b16 v[44:45], v13 offset:256
  v_accvgpr_write_b32 a78, 0
  v_mfma_f32_16x16x32_bf16 v[132:135], v[72:75], v[244:247], v[132:135]
  ds_read_b64_tr_b16 v[46:47], v13 offset:1280
  v_accvgpr_write_b32 a79, 0
  v_mfma_f32_16x16x32_bf16 v[148:151], v[76:79], v[244:247], v[148:151]
  ds_read_b128 v[224:227], v14 offset:0
  v_accvgpr_write_b32 a108, 0
  v_mfma_f32_16x16x32_bf16 v[164:167], v[80:83], v[244:247], v[164:167]
  ds_read_b128 v[228:231], v14 offset:1024
  v_accvgpr_write_b32 a109, 0
  v_mfma_f32_16x16x32_bf16 v[180:183], v[84:87], v[244:247], v[180:183]
  buffer_load_dwordx4 v5, s[32:35], s26 offen offset:2048 sc1 lds
  v_accvgpr_write_b32 a110, 0
  v_mfma_f32_16x16x32_bf16 v[196:199], v[88:91], v[244:247], v[196:199]
  ds_read_b64_tr_b16 v[48:49], v12 offset:512
  v_accvgpr_write_b32 a111, 0
  v_mfma_f32_16x16x32_bf16 v[212:215], v[92:95], v[244:247], v[212:215]
  ds_read_b64_tr_b16 v[50:51], v12 offset:1536
  v_accvgpr_write_b32 a80, 0
  v_mfma_f32_16x16x32_bf16 v[104:107], v[64:67], v[248:251], v[104:107]
  ds_read_b64_tr_b16 v[52:53], v13 offset:512
  v_accvgpr_write_b32 a81, 0
  v_mfma_f32_16x16x32_bf16 v[120:123], v[68:71], v[248:251], v[120:123]
  ds_read_b64_tr_b16 v[54:55], v13 offset:1536
  v_accvgpr_write_b32 a82, 0
  v_mfma_f32_16x16x32_bf16 v[136:139], v[72:75], v[248:251], v[136:139]
  buffer_load_dwordx4 v6, s[32:35], s26 offen offset:3072 sc1 lds
  v_accvgpr_write_b32 a83, 0
  v_mfma_f32_16x16x32_bf16 v[152:155], v[76:79], v[248:251], v[152:155]
  s_add_u32 s26, s26, 1024
  ds_read_b64_tr_b16 v[56:57], v12 offset:768
  v_accvgpr_write_b32 a112, 0
  v_mfma_f32_16x16x32_bf16 v[168:171], v[80:83], v[248:251], v[168:171]
  ds_read_b64_tr_b16 v[58:59], v12 offset:1792
  v_accvgpr_write_b32 a113, 0
  v_mfma_f32_16x16x32_bf16 v[184:187], v[84:87], v[248:251], v[184:187]
  ds_read_b64_tr_b16 v[60:61], v13 offset:768
  v_accvgpr_write_b32 a114, 0
  v_mfma_f32_16x16x32_bf16 v[200:203], v[88:91], v[248:251], v[200:203]
  ds_read_b64_tr_b16 v[62:63], v13 offset:1792
  v_accvgpr_write_b32 a115, 0
  v_mfma_f32_16x16x32_bf16 v[216:219], v[92:95], v[248:251], v[216:219]
  v_accvgpr_write_b32 a84, 0
  v_accvgpr_write_b32 a85, 0
  v_mfma_f32_16x16x32_bf16 v[108:111], v[64:67], v[252:255], v[108:111]
  ds_read_b128 v[232:235], v14 offset:2048
  v_accvgpr_write_b32 a86, 0
  v_mfma_f32_16x16x32_bf16 v[124:127], v[68:71], v[252:255], v[124:127]
  ds_read_b128 v[236:239], v14 offset:3072
  v_accvgpr_write_b32 a87, 0
  v_mfma_f32_16x16x32_bf16 v[140:143], v[72:75], v[252:255], v[140:143]
  v_accvgpr_write_b32 a116, 0
  v_accvgpr_write_b32 a117, 0
  v_mfma_f32_16x16x32_bf16 v[156:159], v[76:79], v[252:255], v[156:159]
  v_accvgpr_write_b32 a118, 0
  v_accvgpr_write_b32 a119, 0
  v_mfma_f32_16x16x32_bf16 v[172:175], v[80:83], v[252:255], v[172:175]
  v_accvgpr_write_b32 a88, 0
  v_accvgpr_write_b32 a89, 0
  v_mfma_f32_16x16x32_bf16 v[188:191], v[84:87], v[252:255], v[188:191]
  v_accvgpr_write_b32 a90, 0
  v_accvgpr_write_b32 a91, 0
  v_mfma_f32_16x16x32_bf16 v[204:207], v[88:91], v[252:255], v[204:207]
  v_accvgpr_write_b32 a120, 0
  v_mfma_f32_16x16x32_bf16 v[220:223], v[92:95], v[252:255], v[220:223]
  s_waitcnt vmcnt(11) lgkmcnt(0)
  v_mfma_f32_16x16x32_bf16 v[96:99], v[32:35], v[224:227], v[96:99]
  v_accvgpr_write_b32 a121, 0
  v_accvgpr_write_b32 a122, 0
  v_mfma_f32_16x16x32_bf16 v[112:115], v[36:39], v[224:227], v[112:115]
  ds_read_b64_tr_b16 v[64:65], v12 offset:8192
  v_accvgpr_write_b32 a123, 0
  v_mfma_f32_16x16x32_bf16 v[128:131], v[40:43], v[224:227], v[128:131]
  ds_read_b64_tr_b16 v[66:67], v12 offset:9216
  v_accvgpr_write_b32 a92, 0
  v_mfma_f32_16x16x32_bf16 v[144:147], v[44:47], v[224:227], v[144:147]
  v_accvgpr_write_b32 a93, 0
  v_accvgpr_write_b32 a94, 0
  v_mfma_f32_16x16x32_bf16 v[160:163], v[48:51], v[224:227], v[160:163]
  ds_read_b64_tr_b16 v[68:69], v13 offset:8192
  v_accvgpr_write_b32 a95, 0
  v_mfma_f32_16x16x32_bf16 v[176:179], v[52:55], v[224:227], v[176:179]
  ds_read_b64_tr_b16 v[70:71], v13 offset:9216
  v_accvgpr_write_b32 a124, 0
  v_mfma_f32_16x16x32_bf16 v[192:195], v[56:59], v[224:227], v[192:195]
  ds_read_b64_tr_b16 v[72:73], v12 offset:8448
  v_accvgpr_write_b32 a125, 0
  v_mfma_f32_16x16x32_bf16 v[208:211], v[60:63], v[224:227], v[208:211]
  ds_read_b64_tr_b16 v[74:75], v12 offset:9472
  v_accvgpr_write_b32 a126, 0
  v_mfma_f32_16x16x32_bf16 v[100:103], v[32:35], v[228:231], v[100:103]
  v_accvgpr_write_b32 a127, 0
  v_mfma_f32_16x16x32_bf16 v[116:119], v[36:39], v[228:231], v[116:119]
  ds_read_b64_tr_b16 v[76:77], v13 offset:8448
  v_mfma_f32_16x16x32_bf16 v[132:135], v[40:43], v[228:231], v[132:135]
  ds_read_b64_tr_b16 v[78:79], v13 offset:9472
  v_mfma_f32_16x16x32_bf16 v[148:151], v[44:47], v[228:231], v[148:151]
  ds_read_b128 v[240:243], v14 offset:32768
  v_mfma_f32_16x16x32_bf16 v[164:167], v[48:51], v[228:231], v[164:167]
  ds_read_b128 v[244:247], v14 offset:33792
  v_mfma_f32_16x16x32_bf16 v[180:183], v[52:55], v[228:231], v[180:183]
  v_mfma_f32_16x16x32_bf16 v[196:199], v[56:59], v[228:231], v[196:199]
  ds_read_b64_tr_b16 v[80:81], v12 offset:8704
  v_mfma_f32_16x16x32_bf16 v[212:215], v[60:63], v[228:231], v[212:215]
  ds_read_b64_tr_b16 v[82:83], v12 offset:9728
  v_mfma_f32_16x16x32_bf16 v[104:107], v[32:35], v[232:235], v[104:107]
  ds_read_b64_tr_b16 v[84:85], v13 offset:8704
  v_mfma_f32_16x16x32_bf16 v[120:123], v[36:39], v[232:235], v[120:123]
  ds_read_b64_tr_b16 v[86:87], v13 offset:9728
  v_mfma_f32_16x16x32_bf16 v[136:139], v[40:43], v[232:235], v[136:139]
  v_mfma_f32_16x16x32_bf16 v[152:155], v[44:47], v[232:235], v[152:155]
  ds_read_b64_tr_b16 v[88:89], v12 offset:8960
  v_mfma_f32_16x16x32_bf16 v[168:171], v[48:51], v[232:235], v[168:171]
  ds_read_b64_tr_b16 v[90:91], v12 offset:9984
  v_mfma_f32_16x16x32_bf16 v[184:187], v[52:55], v[232:235], v[184:187]
  ds_read_b64_tr_b16 v[92:93], v13 offset:8960
  v_mfma_f32_16x16x32_bf16 v[200:203], v[56:59], v[232:235], v[200:203]
  ds_read_b64_tr_b16 v[94:95], v13 offset:9984
  v_mfma_f32_16x16x32_bf16 v[216:219], v[60:63], v[232:235], v[216:219]
  v_mfma_f32_16x16x32_bf16 v[108:111], v[32:35], v[236:239], v[108:111]
  ds_read_b128 v[248:251], v14 offset:34816
  v_mfma_f32_16x16x32_bf16 v[124:127], v[36:39], v[236:239], v[124:127]
  ds_read_b128 v[252:255], v14 offset:35840
  v_mfma_f32_16x16x32_bf16 v[140:143], v[40:43], v[236:239], v[140:143]
  v_mfma_f32_16x16x32_bf16 v[156:159], v[44:47], v[236:239], v[156:159]
  v_xor_b32 v14, 0x10000, v14
  v_mfma_f32_16x16x32_bf16 v[172:175], v[48:51], v[236:239], v[172:175]
  v_mfma_f32_16x16x32_bf16 v[188:191], v[52:55], v[236:239], v[188:191]
  v_mfma_f32_16x16x32_bf16 v[204:207], v[56:59], v[236:239], v[204:207]
  v_mfma_f32_16x16x32_bf16 v[220:223], v[60:63], v[236:239], v[220:223]
  s_waitcnt vmcnt(4) lgkmcnt(0)
  v_mfma_f32_16x16x32_bf16 v[96:99], v[64:67], v[240:243], v[96:99]
  s_barrier
  buffer_store_dword v10, v9, s[40:43], 0 offen sc1
  v_mfma_f32_16x16x32_bf16 v[112:115], v[68:71], v[240:243], v[112:115]
  ds_read_b64_tr_b16 v[32:33], v12 offset:32768
  v_mfma_f32_16x16x32_bf16 v[128:131], v[72:75], v[240:243], v[128:131]
  ds_read_b64_tr_b16 v[34:35], v12 offset:33792
  v_mfma_f32_16x16x32_bf16 v[144:147], v[76:79], v[240:243], v[144:147]
  v_mfma_f32_16x16x32_bf16 v[160:163], v[80:83], v[240:243], v[160:163]
  ds_read_b64_tr_b16 v[36:37], v13 offset:32768
  v_mfma_f32_16x16x32_bf16 v[176:179], v[84:87], v[240:243], v[176:179]
  ds_read_b64_tr_b16 v[38:39], v13 offset:33792
  v_mfma_f32_16x16x32_bf16 v[192:195], v[88:91], v[240:243], v[192:195]
  ds_read_b64_tr_b16 v[40:41], v12 offset:33024
  v_mfma_f32_16x16x32_bf16 v[208:211], v[92:95], v[240:243], v[208:211]
  ds_read_b64_tr_b16 v[42:43], v12 offset:34048
  v_mfma_f32_16x16x32_bf16 v[100:103], v[64:67], v[244:247], v[100:103]
  v_mfma_f32_16x16x32_bf16 v[116:119], v[68:71], v[244:247], v[116:119]
  ds_read_b64_tr_b16 v[44:45], v13 offset:33024
  v_mfma_f32_16x16x32_bf16 v[132:135], v[72:75], v[244:247], v[132:135]
  ds_read_b64_tr_b16 v[46:47], v13 offset:34048
  v_mfma_f32_16x16x32_bf16 v[148:151], v[76:79], v[244:247], v[148:151]
  ds_read_b128 v[224:227], v14 offset:0
  v_mfma_f32_16x16x32_bf16 v[164:167], v[80:83], v[244:247], v[164:167]
  ds_read_b128 v[228:231], v14 offset:1024
  v_mfma_f32_16x16x32_bf16 v[180:183], v[84:87], v[244:247], v[180:183]
  v_mfma_f32_16x16x32_bf16 v[196:199], v[88:91], v[244:247], v[196:199]
  ds_read_b64_tr_b16 v[48:49], v12 offset:33280
  v_mfma_f32_16x16x32_bf16 v[212:215], v[92:95], v[244:247], v[212:215]
  ds_read_b64_tr_b16 v[50:51], v12 offset:34304
  v_mfma_f32_16x16x32_bf16 v[104:107], v[64:67], v[248:251], v[104:107]
  ds_read_b64_tr_b16 v[52:53], v13 offset:33280
  v_mfma_f32_16x16x32_bf16 v[120:123], v[68:71], v[248:251], v[120:123]
  ds_read_b64_tr_b16 v[54:55], v13 offset:34304
  v_mfma_f32_16x16x32_bf16 v[136:139], v[72:75], v[248:251], v[136:139]
  v_mfma_f32_16x16x32_bf16 v[152:155], v[76:79], v[248:251], v[152:155]
  ds_read_b64_tr_b16 v[56:57], v12 offset:33536
  v_mfma_f32_16x16x32_bf16 v[168:171], v[80:83], v[248:251], v[168:171]
  ds_read_b64_tr_b16 v[58:59], v12 offset:34560
  v_mfma_f32_16x16x32_bf16 v[184:187], v[84:87], v[248:251], v[184:187]
  ds_read_b64_tr_b16 v[60:61], v13 offset:33536
  v_mfma_f32_16x16x32_bf16 v[200:203], v[88:91], v[248:251], v[200:203]
  ds_read_b64_tr_b16 v[62:63], v13 offset:34560
  v_mfma_f32_16x16x32_bf16 v[216:219], v[92:95], v[248:251], v[216:219]
  v_mfma_f32_16x16x32_bf16 v[108:111], v[64:67], v[252:255], v[108:111]
  ds_read_b128 v[232:235], v14 offset:2048
  v_mfma_f32_16x16x32_bf16 v[124:127], v[68:71], v[252:255], v[124:127]
  ds_read_b128 v[236:239], v14 offset:3072
  v_mfma_f32_16x16x32_bf16 v[140:143], v[72:75], v[252:255], v[140:143]
  v_mfma_f32_16x16x32_bf16 v[156:159], v[76:79], v[252:255], v[156:159]
  v_mfma_f32_16x16x32_bf16 v[172:175], v[80:83], v[252:255], v[172:175]
  v_mfma_f32_16x16x32_bf16 v[188:191], v[84:87], v[252:255], v[188:191]
  v_mfma_f32_16x16x32_bf16 v[204:207], v[88:91], v[252:255], v[204:207]
  v_mfma_f32_16x16x32_bf16 v[220:223], v[92:95], v[252:255], v[220:223]
  s_waitcnt vmcnt(1) lgkmcnt(0)
  v_mfma_f32_16x16x32_bf16 v[96:99], v[32:35], v[224:227], v[96:99]
  v_mfma_f32_16x16x32_bf16 v[112:115], v[36:39], v[224:227], v[112:115]
  ds_read_b64_tr_b16 v[64:65], v12 offset:40960
  v_mfma_f32_16x16x32_bf16 v[128:131], v[40:43], v[224:227], v[128:131]
  ds_read_b64_tr_b16 v[66:67], v12 offset:41984
  v_mfma_f32_16x16x32_bf16 v[144:147], v[44:47], v[224:227], v[144:147]
  buffer_load_dword v15, v8, s[40:43], 0 offen sc1
  v_mfma_f32_16x16x32_bf16 v[160:163], v[48:51], v[224:227], v[160:163]
  ds_read_b64_tr_b16 v[68:69], v13 offset:40960
  v_mfma_f32_16x16x32_bf16 v[176:179], v[52:55], v[224:227], v[176:179]
  ds_read_b64_tr_b16 v[70:71], v13 offset:41984
  v_mfma_f32_16x16x32_bf16 v[192:195], v[56:59], v[224:227], v[192:195]
  ds_read_b64_tr_b16 v[72:73], v12 offset:41216
  v_mfma_f32_16x16x32_bf16 v[208:211], v[60:63], v[224:227], v[208:211]
  ds_read_b64_tr_b16 v[74:75], v12 offset:42240
  v_mfma_f32_16x16x32_bf16 v[100:103], v[32:35], v[228:231], v[100:103]
  v_mfma_f32_16x16x32_bf16 v[116:119], v[36:39], v[228:231], v[116:119]
  ds_read_b64_tr_b16 v[76:77], v13 offset:41216
  v_mfma_f32_16x16x32_bf16 v[132:135], v[40:43], v[228:231], v[132:135]
  ds_read_b64_tr_b16 v[78:79], v13 offset:42240
  v_mfma_f32_16x16x32_bf16 v[148:151], v[44:47], v[228:231], v[148:151]
  ds_read_b128 v[240:243], v14 offset:32768
  v_mfma_f32_16x16x32_bf16 v[164:167], v[48:51], v[228:231], v[164:167]
  ds_read_b128 v[244:247], v14 offset:33792
  v_mfma_f32_16x16x32_bf16 v[180:183], v[52:55], v[228:231], v[180:183]
  v_mfma_f32_16x16x32_bf16 v[196:199], v[56:59], v[228:231], v[196:199]
  ds_read_b64_tr_b16 v[80:81], v12 offset:41472
  v_mfma_f32_16x16x32_bf16 v[212:215], v[60:63], v[228:231], v[212:215]
  ds_read_b64_tr_b16 v[82:83], v12 offset:42496
  v_mfma_f32_16x16x32_bf16 v[104:107], v[32:35], v[232:235], v[104:107]
  ds_read_b64_tr_b16 v[84:85], v13 offset:41472
  v_mfma_f32_16x16x32_bf16 v[120:123], v[36:39], v[232:235], v[120:123]
  ds_read_b64_tr_b16 v[86:87], v13 offset:42496
  v_mfma_f32_16x16x32_bf16 v[136:139], v[40:43], v[232:235], v[136:139]
  v_mfma_f32_16x16x32_bf16 v[152:155], v[44:47], v[232:235], v[152:155]
  ds_read_b64_tr_b16 v[88:89], v12 offset:41728
  v_mfma_f32_16x16x32_bf16 v[168:171], v[48:51], v[232:235], v[168:171]
  ds_read_b64_tr_b16 v[90:91], v12 offset:42752
  v_mfma_f32_16x16x32_bf16 v[184:187], v[52:55], v[232:235], v[184:187]
  ds_read_b64_tr_b16 v[92:93], v13 offset:41728
  v_mfma_f32_16x16x32_bf16 v[200:203], v[56:59], v[232:235], v[200:203]
  ds_read_b64_tr_b16 v[94:95], v13 offset:42752
  v_mfma_f32_16x16x32_bf16 v[216:219], v[60:63], v[232:235], v[216:219]
  v_mfma_f32_16x16x32_bf16 v[108:111], v[32:35], v[236:239], v[108:111]
  ds_read_b128 v[248:251], v14 offset:34816
  v_mfma_f32_16x16x32_bf16 v[124:127], v[36:39], v[236:239], v[124:127]
  ds_read_b128 v[252:255], v14 offset:35840
  v_mfma_f32_16x16x32_bf16 v[140:143], v[40:43], v[236:239], v[140:143]
  v_mfma_f32_16x16x32_bf16 v[156:159], v[44:47], v[236:239], v[156:159]
  v_xor_b32 v14, 0x10000, v14
  v_mfma_f32_16x16x32_bf16 v[172:175], v[48:51], v[236:239], v[172:175]
  v_mfma_f32_16x16x32_bf16 v[188:191], v[52:55], v[236:239], v[188:191]
  v_xor_b32 v12, 0x10000, v12
  v_mfma_f32_16x16x32_bf16 v[204:207], v[56:59], v[236:239], v[204:207]
  v_xor_b32 v13, 0x10000, v13
  v_mfma_f32_16x16x32_bf16 v[220:223], v[60:63], v[236:239], v[220:223]
  s_waitcnt lgkmcnt(0)
  v_mfma_f32_16x16x32_bf16 v[96:99], v[64:67], v[240:243], v[96:99]
  s_barrier
  v_mfma_f32_16x16x32_bf16 v[112:115], v[68:71], v[240:243], v[112:115]
  v_mfma_f32_16x16x32_bf16 v[128:131], v[72:75], v[240:243], v[128:131]
  v_mfma_f32_16x16x32_bf16 v[144:147], v[76:79], v[240:243], v[144:147]
  v_mfma_f32_16x16x32_bf16 v[160:163], v[80:83], v[240:243], v[160:163]
  v_mfma_f32_16x16x32_bf16 v[176:179], v[84:87], v[240:243], v[176:179]
  v_mfma_f32_16x16x32_bf16 v[192:195], v[88:91], v[240:243], v[192:195]
  v_mfma_f32_16x16x32_bf16 v[208:211], v[92:95], v[240:243], v[208:211]
  v_mfma_f32_16x16x32_bf16 v[100:103], v[64:67], v[244:247], v[100:103]
  v_mfma_f32_16x16x32_bf16 v[116:119], v[68:71], v[244:247], v[116:119]
  v_mfma_f32_16x16x32_bf16 v[132:135], v[72:75], v[244:247], v[132:135]
  v_mfma_f32_16x16x32_bf16 v[148:151], v[76:79], v[244:247], v[148:151]
  v_mfma_f32_16x16x32_bf16 v[164:167], v[80:83], v[244:247], v[164:167]
  v_mfma_f32_16x16x32_bf16 v[180:183], v[84:87], v[244:247], v[180:183]
  v_mfma_f32_16x16x32_bf16 v[196:199], v[88:91], v[244:247], v[196:199]
  v_mfma_f32_16x16x32_bf16 v[212:215], v[92:95], v[244:247], v[212:215]
  v_mfma_f32_16x16x32_bf16 v[104:107], v[64:67], v[248:251], v[104:107]
  v_mfma_f32_16x16x32_bf16 v[120:123], v[68:71], v[248:251], v[120:123]
  v_mfma_f32_16x16x32_bf16 v[136:139], v[72:75], v[248:251], v[136:139]
  v_mfma_f32_16x16x32_bf16 v[152:155], v[76:79], v[248:251], v[152:155]
  v_mfma_f32_16x16x32_bf16 v[168:171], v[80:83], v[248:251], v[168:171]
  v_mfma_f32_16x16x32_bf16 v[184:187], v[84:87], v[248:251], v[184:187]
  v_mfma_f32_16x16x32_bf16 v[200:203], v[88:91], v[248:251], v[200:203]
  v_mfma_f32_16x16x32_bf16 v[216:219], v[92:95], v[248:251], v[216:219]
  v_mfma_f32_16x16x32_bf16 v[108:111], v[64:67], v[252:255], v[108:111]
  v_mfma_f32_16x16x32_bf16 v[124:127], v[68:71], v[252:255], v[124:127]
  v_mfma_f32_16x16x32_bf16 v[140:143], v[72:75], v[252:255], v[140:143]
  v_mfma_f32_16x16x32_bf16 v[156:159], v[76:79], v[252:255], v[156:159]
  v_mfma_f32_16x16x32_bf16 v[172:175], v[80:83], v[252:255], v[172:175]
  v_mfma_f32_16x16x32_bf16 v[188:191], v[84:87], v[252:255], v[188:191]
  v_mfma_f32_16x16x32_bf16 v[204:207], v[88:91], v[252:255], v[204:207]
  v_mfma_f32_16x16x32_bf16 v[220:223], v[92:95], v[252:255], v[220:223]
  s_and_b32 s23, s20, 1
  s_lshl_b32 s23, s23, 12
  s_cmp_lt_u32 s20, 2
  s_cselect_b32 s24, 106496, 0
  s_add_u32 s24, s24, s23
  s_lshl_b32 s26, s20, 12
  s_mov_b32 s27, s26
  s_add_u32 s25, s27, 49152
  s_load_dwordx4 s[4:7], s[0:1], 64
  s_load_dwordx2 s[8:9], s[0:1], 80
  v_mov_b32 v12, 0x3e0293ee
  v_mov_b32 v13, 0x3e0293ee
  s_waitcnt vmcnt(0)
  v_cmp_eq_u32 vcc, 0, v15
  s_cbranch_vccnz fa_kv_spin
fa_kv_ok:
  s_mov_b32 m0, s24
  s_nop 0
  buffer_load_dwordx4 v2, s[44:47], s26 offen offset:0 sc1 lds
  v_pk_mul_f32 v[96:97], v[96:97], v[12:13]
  v_pk_mul_f32 v[98:99], v[98:99], v[12:13]
  v_cvt_pk_bf16_f32 v32, v96, v97
  v_cvt_pk_bf16_f32 v33, v98, v99
  v_pk_mul_f32 v[112:113], v[112:113], v[12:13]
  v_pk_mul_f32 v[114:115], v[114:115], v[12:13]
  v_cvt_pk_bf16_f32 v34, v112, v113
  buffer_load_dwordx4 v2, s[44:47], s26 offen offset:1024 sc1 lds
  v_cvt_pk_bf16_f32 v35, v114, v115
  v_pk_mul_f32 v[100:101], v[100:101], v[12:13]
  v_pk_mul_f32 v[102:103], v[102:103], v[12:13]
  v_cvt_pk_bf16_f32 v36, v100, v101
  v_cvt_pk_bf16_f32 v37, v102, v103
  v_pk_mul_f32 v[116:117], v[116:117], v[12:13]
  v_pk_mul_f32 v[118:119], v[118:119], v[12:13]
  buffer_load_dwordx4 v2, s[44:47], s26 offen offset:2048 sc1 lds
  v_cvt_pk_bf16_f32 v38, v116, v117
  v_cvt_pk_bf16_f32 v39, v118, v119
  v_pk_mul_f32 v[128:129], v[128:129], v[12:13]
  v_pk_mul_f32 v[130:131], v[130:131], v[12:13]
  v_cvt_pk_bf16_f32 v40, v128, v129
  v_cvt_pk_bf16_f32 v41, v130, v131
  v_pk_mul_f32 v[144:145], v[144:145], v[12:13]
  buffer_load_dwordx4 v2, s[44:47], s26 offen offset:3072 sc1 lds
  v_pk_mul_f32 v[146:147], v[146:147], v[12:13]
  v_cvt_pk_bf16_f32 v42, v144, v145
  v_cvt_pk_bf16_f32 v43, v146, v147
  v_pk_mul_f32 v[132:133], v[132:133], v[12:13]
  v_pk_mul_f32 v[134:135], v[134:135], v[12:13]
  v_cvt_pk_bf16_f32 v44, v132, v133
  v_cvt_pk_bf16_f32 v45, v134, v135
  s_add_u32 s26, s26, 16384
  s_add_u32 s24, s24, 32768
  s_and_b32 s24, s24, 0x1ffff
  s_mov_b32 m0, s24
  s_nop 0
  buffer_load_dwordx4 v2, s[44:47], s26 offen offset:0 sc1 lds
  v_pk_mul_f32 v[148:149], v[148:149], v[12:13]
  v_pk_mul_f32 v[150:151], v[150:151], v[12:13]
  v_cvt_pk_bf16_f32 v46, v148, v149
  v_cvt_pk_bf16_f32 v47, v150, v151
  v_pk_mul_f32 v[160:161], v[160:161], v[12:13]
  v_pk_mul_f32 v[162:163], v[162:163], v[12:13]
  v_cvt_pk_bf16_f32 v48, v160, v161
  buffer_load_dwordx4 v2, s[44:47], s26 offen offset:1024 sc1 lds
  v_cvt_pk_bf16_f32 v49, v162, v163
  v_pk_mul_f32 v[176:177], v[176:177], v[12:13]
  v_pk_mul_f32 v[178:179], v[178:179], v[12:13]
  v_cvt_pk_bf16_f32 v50, v176, v177
  v_cvt_pk_bf16_f32 v51, v178, v179
  v_pk_mul_f32 v[164:165], v[164:165], v[12:13]
  v_pk_mul_f32 v[166:167], v[166:167], v[12:13]
  buffer_load_dwordx4 v2, s[44:47], s26 offen offset:2048 sc1 lds
  v_cvt_pk_bf16_f32 v52, v164, v165
  v_cvt_pk_bf16_f32 v53, v166, v167
  v_pk_mul_f32 v[180:181], v[180:181], v[12:13]
  v_pk_mul_f32 v[182:183], v[182:183], v[12:13]
  v_cvt_pk_bf16_f32 v54, v180, v181
  v_cvt_pk_bf16_f32 v55, v182, v183
  v_pk_mul_f32 v[192:193], v[192:193], v[12:13]
  buffer_load_dwordx4 v2, s[44:47], s26 offen offset:3072 sc1 lds
  v_pk_mul_f32 v[194:195], v[194:195], v[12:13]
  v_cvt_pk_bf16_f32 v56, v192, v193
  v_cvt_pk_bf16_f32 v57, v194, v195
  v_pk_mul_f32 v[208:209], v[208:209], v[12:13]
  v_pk_mul_f32 v[210:211], v[210:211], v[12:13]
  v_cvt_pk_bf16_f32 v58, v208, v209
  v_cvt_pk_bf16_f32 v59, v210, v211
  s_add_u32 s26, s26, 16384
  s_add_u32 s24, s24, 32768
  s_and_b32 s24, s24, 0x1ffff
  s_mov_b32 m0, s24
  s_nop 0
  buffer_load_dwordx4 v2, s[44:47], s26 offen offset:0 sc1 lds
  v_pk_mul_f32 v[196:197], v[196:197], v[12:13]
  v_pk_mul_f32 v[198:199], v[198:199], v[12:13]
  v_cvt_pk_bf16_f32 v60, v196, v197
  v_cvt_pk_bf16_f32 v61, v198, v199
  v_pk_mul_f32 v[212:213], v[212:213], v[12:13]
  v_pk_mul_f32 v[214:215], v[214:215], v[12:13]
  v_cvt_pk_bf16_f32 v62, v212, v213
  buffer_load_dwordx4 v2, s[44:47], s26 offen offset:1024 sc1 lds
  v_cvt_pk_bf16_f32 v63, v214, v215
  v_pk_mul_f32 v[104:105], v[104:105], v[12:13]
  v_pk_mul_f32 v[106:107], v[106:107], v[12:13]
  v_cvt_pk_bf16_f32 v64, v104, v105
  v_cvt_pk_bf16_f32 v65, v106, v107
  v_pk_mul_f32 v[120:121], v[120:121], v[12:13]
  v_pk_mul_f32 v[122:123], v[122:123], v[12:13]
  buffer_load_dwordx4 v2, s[44:47], s26 offen offset:2048 sc1 lds
  v_cvt_pk_bf16_f32 v66, v120, v121
  v_cvt_pk_bf16_f32 v67, v122, v123
  v_pk_mul_f32 v[108:109], v[108:109], v[12:13]
  v_pk_mul_f32 v[110:111], v[110:111], v[12:13]
  v_cvt_pk_bf16_f32 v68, v108, v109
  v_cvt_pk_bf16_f32 v69, v110, v111
  v_pk_mul_f32 v[124:125], v[124:125], v[12:13]
  buffer_load_dwordx4 v2, s[44:47], s26 offen offset:3072 sc1 lds
  v_pk_mul_f32 v[126:127], v[126:127], v[12:13]
  v_cvt_pk_bf16_f32 v70, v124, v125
  v_cvt_pk_bf16_f32 v71, v126, v127
  v_pk_mul_f32 v[136:137], v[136:137], v[12:13]
  v_pk_mul_f32 v[138:139], v[138:139], v[12:13]
  v_cvt_pk_bf16_f32 v72, v136, v137
  v_cvt_pk_bf16_f32 v73, v138, v139
  s_add_u32 s26, s26, 16384
  s_add_u32 s24, s24, 32768
  s_and_b32 s24, s24, 0x1ffff
  s_mov_b32 m0, s25
  s_nop 0
  buffer_load_dwordx4 v2, s[48:51], s27 offen offset:0 sc1 lds
  v_pk_mul_f32 v[152:153], v[152:153], v[12:13]
  v_pk_mul_f32 v[154:155], v[154:155], v[12:13]
  v_cvt_pk_bf16_f32 v74, v152, v153
  v_cvt_pk_bf16_f32 v75, v154, v155
  v_pk_mul_f32 v[140:141], v[140:141], v[12:13]
  v_pk_mul_f32 v[142:143], v[142:143], v[12:13]
  v_cvt_pk_bf16_f32 v76, v140, v141
  buffer_load_dwordx4 v2, s[48:51], s27 offen offset:1024 sc1 lds
  v_cvt_pk_bf16_f32 v77, v142, v143
  v_pk_mul_f32 v[156:157], v[156:157], v[12:13]
  v_pk_mul_f32 v[158:159], v[158:159], v[12:13]
  v_cvt_pk_bf16_f32 v78, v156, v157
  v_cvt_pk_bf16_f32 v79, v158, v159
  v_pk_mul_f32 v[168:169], v[168:169], v[12:13]
  v_pk_mul_f32 v[170:171], v[170:171], v[12:13]
  buffer_load_dwordx4 v2, s[48:51], s27 offen offset:2048 sc1 lds
  v_cvt_pk_bf16_f32 v80, v168, v169
  v_cvt_pk_bf16_f32 v81, v170, v171
  v_pk_mul_f32 v[184:185], v[184:185], v[12:13]
  v_pk_mul_f32 v[186:187], v[186:187], v[12:13]
  v_cvt_pk_bf16_f32 v82, v184, v185
  v_cvt_pk_bf16_f32 v83, v186, v187
  v_pk_mul_f32 v[172:173], v[172:173], v[12:13]
  buffer_load_dwordx4 v2, s[48:51], s27 offen offset:3072 sc1 lds
  v_pk_mul_f32 v[174:175], v[174:175], v[12:13]
  v_cvt_pk_bf16_f32 v84, v172, v173
  v_cvt_pk_bf16_f32 v85, v174, v175
  v_pk_mul_f32 v[188:189], v[188:189], v[12:13]
  v_pk_mul_f32 v[190:191], v[190:191], v[12:13]
  v_cvt_pk_bf16_f32 v86, v188, v189
  v_cvt_pk_bf16_f32 v87, v190, v191
  s_add_u32 s27, s27, 16384
  s_add_u32 s25, s25, 32768
  s_and_b32 s25, s25, 0x1ffff
  s_mov_b32 m0, s25
  s_nop 0
  buffer_load_dwordx4 v2, s[48:51], s27 offen offset:0 sc1 lds
  v_pk_mul_f32 v[200:201], v[200:201], v[12:13]
  v_pk_mul_f32 v[202:203], v[202:203], v[12:13]
  v_cvt_pk_bf16_f32 v88, v200, v201
  v_cvt_pk_bf16_f32 v89, v202, v203
  v_pk_mul_f32 v[216:217], v[216:217], v[12:13]
  v_pk_mul_f32 v[218:219], v[218:219], v[12:13]
  v_cvt_pk_bf16_f32 v90, v216, v217
  buffer_load_dwordx4 v2, s[48:51], s27 offen offset:1024 sc1 lds
  v_cvt_pk_bf16_f32 v91, v218, v219
  v_pk_mul_f32 v[204:205], v[204:205], v[12:13]
  v_pk_mul_f32 v[206:207], v[206:207], v[12:13]
  v_cvt_pk_bf16_f32 v92, v204, v205
  v_cvt_pk_bf16_f32 v93, v206, v207
  v_pk_mul_f32 v[220:221], v[220:221], v[12:13]
  v_pk_mul_f32 v[222:223], v[222:223], v[12:13]
  buffer_load_dwordx4 v2, s[48:51], s27 offen offset:2048 sc1 lds
  v_cvt_pk_bf16_f32 v94, v220, v221
  v_cvt_pk_bf16_f32 v95, v222, v223
  buffer_load_dwordx4 v2, s[48:51], s27 offen offset:3072 sc1 lds
  s_add_u32 s27, s27, 16384
  s_add_u32 s25, s25, 32768
  s_and_b32 s25, s25, 0x1ffff
  v_add_u32 v18, 106496, v2
  s_waitcnt vmcnt(12)
  s_barrier
  ds_read_b128 a[128:131], v18 offset:0
  ds_read_b128 a[132:135], v18 offset:1024
  ds_read_b128 a[136:139], v18 offset:2048
  ds_read_b128 a[140:143], v18 offset:3072
  ds_read_b128 a[144:147], v18 offset:4096
  ds_read_b128 a[148:151], v18 offset:5120
  ds_read_b128 a[152:155], v18 offset:6144
  ds_read_b128 a[156:159], v18 offset:7168
  s_and_b32 s62, s2, 1
  s_lshl_b32 s62, s62, 2
  s_add_u32 s62, s62, s20
  s_lshr_b32 s63, s2, 1
  s_mul_i32 s23, s63, 40960
  s_mul_i32 s31, s62, 160
  s_add_u32 s23, s23, s31
  s_mul_i32 s34, s20, 5120
  s_add_u32 s34, s34, 131072
  v_add_u32 v20, 0, v1
  v_mul_u32_u24 v19, 6554, v20
  s_add_u32 m0, s34, 0
  v_lshrrev_b32 v19, 16, v19
  v_mul_u32_u24 v19, 1120, v19
  v_lshl_add_u32 v19, v20, 4, v19
  buffer_load_dwordx4 v19, s[52:55], s23 offen lds
  v_accvgpr_write_b32 a248, v19
  v_add_u32 v20, 64, v1
  v_mul_u32_u24 v19, 6554, v20
  s_add_u32 m0, s34, 1024
  v_lshrrev_b32 v19, 16, v19
  v_mul_u32_u24 v19, 1120, v19
  v_lshl_add_u32 v19, v20, 4, v19
  buffer_load_dwordx4 v19, s[52:55], s23 offen lds
  v_accvgpr_write_b32 a249, v19
  v_add_u32 v20, 128, v1
  v_mul_u32_u24 v19, 6554, v20
  s_add_u32 m0, s34, 2048
  v_lshrrev_b32 v19, 16, v19
  v_mul_u32_u24 v19, 1120, v19
  v_lshl_add_u32 v19, v20, 4, v19
  buffer_load_dwordx4 v19, s[52:55], s23 offen lds
  v_accvgpr_write_b32 a250, v19
  v_add_u32 v20, 192, v1
  v_mul_u32_u24 v19, 6554, v20
  s_add_u32 m0, s34, 3072
  v_lshrrev_b32 v19, 16, v19
  v_mul_u32_u24 v19, 1120, v19
  v_lshl_add_u32 v19, v20, 4, v19
  buffer_load_dwordx4 v19, s[52:55], s23 offen lds
  v_accvgpr_write_b32 a251, v19
  v_add_u32 v20, 256, v1
  v_mul_u32_u24 v19, 6554, v20
  s_add_u32 m0, s34, 4096
  v_lshrrev_b32 v19, 16, v19
  v_mul_u32_u24 v19, 1120, v19
  v_lshl_add_u32 v19, v20, 4, v19
  buffer_load_dwordx4 v19, s[52:55], s23 offen lds
  v_accvgpr_write_b32 a252, v19
  v_lshrrev_b32 v6, 2, v1
  v_mul_u32_u24 v6, 160, v6
  v_and_b32 v19, 3, v1
  v_lshl_add_u32 v6, v19, 3, v6
  v_add_u32 v6, s34, v6
  s_lshl_b32 s30, s62, 7
  s_add_u32 s30, s30, s63
  s_mul_i32 s30, s30, 5120
  s_add_u32 s30, s30, 4194304
  s_waitcnt lgkmcnt(0)
  s_cmp_ge_u32 s20, 2
  s_cselect_b32 s4, s6, s4
  s_cselect_b32 s5, s7, s5
  s_mov_b32 s52, s4
  s_mov_b32 s53, s5
  s_mov_b32 s54, 2211840
  s_mov_b32 s55, 0x20000
  s_mov_b32 s60, s8
  s_mov_b32 s61, s9
  s_mov_b32 s62, 2211840
  s_mov_b32 s63, 0x20000
  v_mov_b32 v228, 0
  v_mov_b32 v229, 0
  v_mov_b32 v230, 0
  v_mov_b32 v231, 0
  s_add_u32 s23, s20, 1
  s_lshr_b32 s23, s23, 1
  s_lshl_b32 s28, s22, 1
  s_add_u32 s28, s28, s23
  s_lshl_b32 s23, s22, 2
  s_sub_u32 s29, 28, s23
  s_and_b32 s23, s20, 1
  s_add_u32 s29, s29, s23
  v_mov_b32 v3, v2
  v_mov_b32 v4, 0xff800000
  s_cmp_eq_u32 s2, 255
  s_cbranch_scc1 fa_top8
fa_notop:
  s_mov_b32 s32, 0
  s_mov_b32 s9, 0
  s_mov_b32 s8, 0
  s_mov_b32 s11, 0
  s_mov_b32 s12, 0
  s_lshl_b32 s15, s22, 1
  s_sub_u32 s15, 24, s15
  s_lshl_b32 s15, s15, 14
  s_getpc_b64 s[36:37]
fa_copc:
  s_add_u32 s36, s36, fa_co-fa_copc-4
  s_addc_u32 s37, s37, 0
  s_waitcnt lgkmcnt(0)
  v_mfma_f32_16x16x32_bf16 v[96:99], a[128:131], v[32:35], 0
  v_mfma_f32_16x16x32_bf16 v[104:107], a[128:131], v[36:39], 0
  v_mfma_f32_16x16x32_bf16 v[128:131], a[128:131], v[64:67], 0
  v_mfma_f32_16x16x32_bf16 v[136:139], a[128:131], v[68:71], 0
  s_mov_b32 m0, s24
  ds_read_b128 a[128:131], v3 offset:0
  v_mfma_f32_16x16x32_bf16 v[100:103], a[132:135], v[32:35], 0
  buffer_load_dwordx4 v2, s[44:47], s26 offen offset:0 sc1 lds
  v_mfma_f32_16x16x32_bf16 v[108:111], a[132:135], v[36:39], 0
  v_mfma_f32_16x16x32_bf16 v[132:135], a[132:135], v[64:67], 0
  v_mfma_f32_16x16x32_bf16 v[140:143], a[132:135], v[68:71], 0
  ds_read_b128 a[132:135], v3 offset:1024
  v_mfma_f32_16x16x32_bf16 v[96:99], a[136:139], v[40:43], v[96:99]
  v_mfma_f32_16x16x32_bf16 v[104:107], a[136:139], v[44:47], v[104:107]
  v_mfma_f32_16x16x32_bf16 v[128:131], a[136:139], v[72:75], v[128:131]
  buffer_load_dwordx4 v2, s[44:47], s26 offen offset:1024 sc1 lds
  v_mfma_f32_16x16x32_bf16 v[136:139], a[136:139], v[76:79], v[136:139]
  ds_read_b128 a[136:139], v3 offset:2048
  v_mfma_f32_16x16x32_bf16 v[100:103], a[140:143], v[40:43], v[100:103]
  v_mfma_f32_16x16x32_bf16 v[108:111], a[140:143], v[44:47], v[108:111]
  v_mfma_f32_16x16x32_bf16 v[132:135], a[140:143], v[72:75], v[132:135]
  v_mfma_f32_16x16x32_bf16 v[140:143], a[140:143], v[76:79], v[140:143]
  s_waitcnt lgkmcnt(3)
  ds_read_b128 a[140:143], v3 offset:3072
  v_mfma_f32_16x16x32_bf16 v[96:99], a[144:147], v[48:51], v[96:99]
  v_mfma_f32_16x16x32_bf16 v[104:107], a[144:147], v[52:55], v[104:107]
  v_mfma_f32_16x16x32_bf16 v[128:131], a[144:147], v[80:83], v[128:131]
  buffer_load_dwordx4 v2, s[44:47], s26 offen offset:2048 sc1 lds
  v_mfma_f32_16x16x32_bf16 v[136:139], a[144:147], v[84:87], v[136:139]
  ds_read_b128 a[144:147], v3 offset:4096
  v_mfma_f32_16x16x32_bf16 v[100:103], a[148:151], v[48:51], v[100:103]
  v_mfma_f32_16x16x32_bf16 v[108:111], a[148:151], v[52:55], v[108:111]
  v_mfma_f32_16x16x32_bf16 v[132:135], a[148:151], v[80:83], v[132:135]
  v_mfma_f32_16x16x32_bf16 v[140:143], a[148:151], v[84:87], v[140:143]
  ds_read_b128 a[148:151], v3 offset:5120
  v_mfma_f32_16x16x32_bf16 v[96:99], a[152:155], v[56:59], v[96:99]
  buffer_load_dwordx4 v2, s[44:47], s26 offen offset:3072 sc1 lds
  v_mfma_f32_16x16x32_bf16 v[104:107], a[152:155], v[60:63], v[104:107]
  s_add_u32 s26, s26, 16384
  v_mfma_f32_16x16x32_bf16 v[128:131], a[152:155], v[88:91], v[128:131]
  s_add_u32 s24, s24, 32768
  v_mfma_f32_16x16x32_bf16 v[136:139], a[152:155], v[92:95], v[136:139]
  s_and_b32 s24, s24, 0x1ffff
  ds_read_b128 a[152:155], v3 offset:6144
  v_mfma_f32_16x16x32_bf16 v[100:103], a[156:159], v[56:59], v[100:103]
  v_mfma_f32_16x16x32_bf16 v[108:111], a[156:159], v[60:63], v[108:111]
  v_mfma_f32_16x16x32_bf16 v[132:135], a[156:159], v[88:91], v[132:135]
  v_mfma_f32_16x16x32_bf16 v[140:143], a[156:159], v[92:95], v[140:143]
  s_waitcnt lgkmcnt(3)
  ds_read_b128 a[156:159], v3 offset:7168
  s_nop 7
  s_cmp_lg_u32 s28, 0
  s_cbranch_scc1 fa_nomask0
  v_cndmask_b32 v96, v4, v96, s[68:69]
  v_cndmask_b32 v97, v4, v97, s[70:71]
  v_cndmask_b32 v98, v4, v98, s[72:73]
  v_cndmask_b32 v99, v4, v99, s[74:75]
  v_mov_b32 v100, v4
  v_mov_b32 v101, v4
  v_mov_b32 v102, v4
  v_mov_b32 v103, v4
  v_cndmask_b32 v108, v4, v108, s[68:69]
  v_cndmask_b32 v109, v4, v109, s[70:71]
  v_cndmask_b32 v110, v4, v110, s[72:73]
  v_cndmask_b32 v111, v4, v111, s[74:75]
fa_nomask0:
  v_max3_f32 v16, v96, v97, v98
  v_max3_f32 v16, v16, v99, v100
  v_max3_f32 v16, v16, v101, v102
  v_max_f32 v16, v16, v103
  v_max3_f32 v17, v104, v105, v106
  v_max3_f32 v17, v17, v107, v108
  v_max3_f32 v17, v17, v109, v110
  v_max_f32 v17, v17, v111
  v_max3_f32 v18, v128, v129, v130
  v_max3_f32 v18, v18, v131, v132
  v_max3_f32 v18, v18, v133, v134
  v_max_f32 v18, v18, v135
  v_max3_f32 v19, v136, v137, v138
  v_max3_f32 v19, v19, v139, v140
  v_max3_f32 v19, v19, v141, v142
  v_max_f32 v19, v19, v143
  v_mov_b32 v20, v16
  v_mov_b32 v21, v17
  v_mov_b32 v22, v18
  v_mov_b32 v23, v19
  s_nop 0
  v_permlane16_swap_b32 v16, v20
  v_permlane16_swap_b32 v17, v21
  v_permlane16_swap_b32 v18, v22
  v_permlane16_swap_b32 v19, v23
  v_max_f32 v16, v16, v20
  v_max_f32 v17, v17, v21
  v_max_f32 v18, v18, v22
  v_max_f32 v19, v19, v23
  v_mov_b32 v20, v16
  v_mov_b32 v21, v17
  v_mov_b32 v22, v18
  v_mov_b32 v23, v19
  s_nop 0
  v_permlane32_swap_b32 v16, v20
  v_permlane32_swap_b32 v17, v21
  v_permlane32_swap_b32 v18, v22
  v_permlane32_swap_b32 v19, v23
  v_max_f32 v16, v16, v20
  v_max_f32 v17, v17, v21
  v_max_f32 v18, v18, v22
  v_max_f32 v19, v19, v23
  v_sub_f32 v192, 0, v16
  v_sub_f32 v193, 0, v16
  v_sub_f32 v194, 0, v16
  v_sub_f32 v195, 0, v16
  v_sub_f32 v196, 0, v17
  v_sub_f32 v197, 0, v17
  v_sub_f32 v198, 0, v17
  v_sub_f32 v199, 0, v17
  v_sub_f32 v200, 0, v18
  v_sub_f32 v201, 0, v18
  v_sub_f32 v202, 0, v18
  v_sub_f32 v203, 0, v18
  v_sub_f32 v204, 0, v19
  v_sub_f32 v205, 0, v19
  v_sub_f32 v206, 0, v19
  v_sub_f32 v207, 0, v19
  v_sub_f32 v96, v96, v16
  v_sub_f32 v97, v97, v16
  v_sub_f32 v98, v98, v16
  v_sub_f32 v99, v99, v16
  v_sub_f32 v100, v100, v16
  v_sub_f32 v101, v101, v16
  v_sub_f32 v102, v102, v16
  v_sub_f32 v103, v103, v16
  v_sub_f32 v104, v104, v17
  v_sub_f32 v105, v105, v17
  v_sub_f32 v106, v106, v17
  v_sub_f32 v107, v107, v17
  v_sub_f32 v108, v108, v17
  v_sub_f32 v109, v109, v17
  v_sub_f32 v110, v110, v17
  v_sub_f32 v111, v111, v17
  v_sub_f32 v128, v128, v18
  v_sub_f32 v129, v129, v18
  v_sub_f32 v130, v130, v18
  v_sub_f32 v131, v131, v18
  v_sub_f32 v132, v132, v18
  v_sub_f32 v133, v133, v18
  v_sub_f32 v134, v134, v18
  v_sub_f32 v135, v135, v18
  v_sub_f32 v136, v136, v19
  v_sub_f32 v137, v137, v19
  v_sub_f32 v138, v138, v19
  v_sub_f32 v139, v139, v19
  v_sub_f32 v140, v140, v19
  v_sub_f32 v141, v141, v19
  v_sub_f32 v142, v142, v19
  v_sub_f32 v143, v143, v19
  v_mfma_f32_16x16x32_bf16 v[112:115], a[128:131], v[32:35], v[192:195]
  v_exp_f32 v208, v96
  v_exp_f32 v209, v97
  v_mfma_f32_16x16x32_bf16 v[120:123], a[128:131], v[36:39], v[196:199]
  v_exp_f32 v210, v98
  v_exp_f32 v211, v99
  v_mfma_f32_16x16x32_bf16 v[144:147], a[128:131], v[64:67], v[200:203]
  v_exp_f32 v212, v100
  v_exp_f32 v213, v101
  v_mfma_f32_16x16x32_bf16 v[152:155], a[128:131], v[68:71], v[204:207]
  s_mov_b32 m0, s25
  ds_read_b128 a[128:131], v3 offset:8192
  v_exp_f32 v214, v102
  v_add_f32 v224, v208, v209
  v_mfma_f32_16x16x32_bf16 v[116:119], a[132:135], v[32:35], v[192:195]
  buffer_load_dwordx4 v2, s[48:51], s27 offen offset:0 sc1 lds
  v_exp_f32 v215, v103
  v_cvt_pk_bf16_f32 v160, v208, v209
  v_mfma_f32_16x16x32_bf16 v[124:127], a[132:135], v[36:39], v[196:199]
  v_exp_f32 v208, v104
  v_add_f32 v224, v224, v210
  v_add_f32 v224, v224, v211
  v_mfma_f32_16x16x32_bf16 v[148:151], a[132:135], v[64:67], v[200:203]
  v_exp_f32 v209, v105
  v_cvt_pk_bf16_f32 v161, v210, v211
  v_add_f32 v224, v224, v212
  v_mfma_f32_16x16x32_bf16 v[156:159], a[132:135], v[68:71], v[204:207]
  ds_read_b128 a[132:135], v3 offset:9216
  v_exp_f32 v210, v106
  v_mfma_f32_16x16x32_bf16 v[112:115], a[136:139], v[40:43], v[112:115]
  v_exp_f32 v211, v107
  v_add_f32 v224, v224, v213
  v_cvt_pk_bf16_f32 v162, v212, v213
  v_mfma_f32_16x16x32_bf16 v[120:123], a[136:139], v[44:47], v[120:123]
  v_exp_f32 v212, v108
  v_add_f32 v224, v224, v214
  v_add_f32 v224, v224, v215
  v_mfma_f32_16x16x32_bf16 v[144:147], a[136:139], v[72:75], v[144:147]
  buffer_load_dwordx4 v2, s[48:51], s27 offen offset:1024 sc1 lds
  v_exp_f32 v213, v109
  v_cvt_pk_bf16_f32 v163, v214, v215
  v_mfma_f32_16x16x32_bf16 v[152:155], a[136:139], v[76:79], v[152:155]
  ds_read_b128 a[136:139], v3 offset:10240
  v_exp_f32 v214, v110
  v_add_f32 v225, v208, v209
  v_mfma_f32_16x16x32_bf16 v[116:119], a[140:143], v[40:43], v[116:119]
  v_exp_f32 v215, v111
  v_exp_f32 v216, v128
  v_mfma_f32_16x16x32_bf16 v[124:127], a[140:143], v[44:47], v[124:127]
  v_exp_f32 v217, v129
  v_exp_f32 v218, v130
  v_mfma_f32_16x16x32_bf16 v[148:151], a[140:143], v[72:75], v[148:151]
  v_exp_f32 v219, v131
  v_exp_f32 v220, v132
  v_mfma_f32_16x16x32_bf16 v[156:159], a[140:143], v[76:79], v[156:159]
  s_waitcnt lgkmcnt(3)
  ds_read_b128 a[140:143], v3 offset:11264
  v_exp_f32 v221, v133
  v_cvt_pk_bf16_f32 v164, v208, v209
  v_mfma_f32_16x16x32_bf16 v[112:115], a[144:147], v[48:51], v[112:115]
  v_exp_f32 v222, v134
  v_exp_f32 v223, v135
  v_mfma_f32_16x16x32_bf16 v[120:123], a[144:147], v[52:55], v[120:123]
  v_add_f32 v225, v225, v210
  v_add_f32 v225, v225, v211
  v_cvt_pk_bf16_f32 v165, v210, v211
  v_add_f32 v225, v225, v212
  v_mfma_f32_16x16x32_bf16 v[144:147], a[144:147], v[80:83], v[144:147]
  buffer_load_dwordx4 v2, s[48:51], s27 offen offset:2048 sc1 lds
  v_add_f32 v225, v225, v213
  v_cvt_pk_bf16_f32 v166, v212, v213
  v_add_f32 v225, v225, v214
  v_mfma_f32_16x16x32_bf16 v[152:155], a[144:147], v[84:87], v[152:155]
  ds_read_b128 a[144:147], v3 offset:12288
  v_add_f32 v225, v225, v215
  v_cvt_pk_bf16_f32 v167, v214, v215
  v_add_f32 v226, v216, v217
  v_mfma_f32_16x16x32_bf16 v[116:119], a[148:151], v[48:51], v[116:119]
  v_cvt_pk_bf16_f32 v176, v216, v217
  v_exp_f32 v216, v136
  v_add_f32 v226, v226, v218
  v_mfma_f32_16x16x32_bf16 v[124:127], a[148:151], v[52:55], v[124:127]
  v_exp_f32 v217, v137
  v_add_f32 v226, v226, v219
  v_cvt_pk_bf16_f32 v177, v218, v219
  v_mfma_f32_16x16x32_bf16 v[148:151], a[148:151], v[80:83], v[148:151]
  v_exp_f32 v218, v138
  v_add_f32 v226, v226, v220
  v_add_f32 v226, v226, v221
  v_mfma_f32_16x16x32_bf16 v[156:159], a[148:151], v[84:87], v[156:159]
  ds_read_b128 a[148:151], v3 offset:13312
  v_exp_f32 v219, v139
  v_mfma_f32_16x16x32_bf16 v[112:115], a[152:155], v[56:59], v[112:115]
  buffer_load_dwordx4 v2, s[48:51], s27 offen offset:3072 sc1 lds
  v_cvt_pk_bf16_f32 v178, v220, v221
  v_exp_f32 v220, v140
  v_mfma_f32_16x16x32_bf16 v[120:123], a[152:155], v[60:63], v[120:123]
  s_add_u32 s27, s27, 16384
  v_add_f32 v226, v226, v222
  v_add_f32 v226, v226, v223
  v_cvt_pk_bf16_f32 v179, v222, v223
  v_add_f32 v227, v216, v217
  v_mfma_f32_16x16x32_bf16 v[144:147], a[152:155], v[88:91], v[144:147]
  s_add_u32 s25, s25, 32768
  v_exp_f32 v221, v141
  v_cvt_pk_bf16_f32 v180, v216, v217
  v_add_f32 v227, v227, v218
  v_mfma_f32_16x16x32_bf16 v[152:155], a[152:155], v[92:95], v[152:155]
  s_and_b32 s25, s25, 0x1ffff
  ds_read_b128 a[152:155], v3 offset:14336
  v_add_f32 v227, v227, v219
  v_cvt_pk_bf16_f32 v181, v218, v219
  v_max3_f32 v5, v224, v225, v226
  v_mfma_f32_16x16x32_bf16 v[116:119], a[156:159], v[56:59], v[116:119]
  v_exp_f32 v222, v142
  v_add_f32 v227, v227, v220
  v_add_f32 v227, v227, v221
  v_mfma_f32_16x16x32_bf16 v[124:127], a[156:159], v[60:63], v[124:127]
  v_exp_f32 v223, v143
  v_cvt_pk_bf16_f32 v182, v220, v221
  v_add_f32 v227, v227, v222
  v_mfma_f32_16x16x32_bf16 v[148:151], a[156:159], v[88:91], v[148:151]
  v_add_f32 v227, v227, v223
  v_cvt_pk_bf16_f32 v183, v222, v223
  v_max_f32 v5, v5, v227
  v_cmp_lt_f32 vcc, s81, v5
  v_mfma_f32_16x16x32_bf16 v[156:159], a[156:159], v[92:95], v[156:159]
  s_waitcnt lgkmcnt(3)
  s_cbranch_vccnz fa_stub0
fa_back0:
  ds_read_b128 a[156:159], v3 offset:15360
  v_add_f32 v228, v228, v224
  v_add_f32 v229, v229, v225
  v_add_f32 v230, v230, v226
  v_add_f32 v231, v231, v227
  v_add_u32 v3, 32768, v3
  v_and_b32 v3, 0x1ffff, v3
  s_cmp_eq_u32 s28, 0
  s_cbranch_scc1 fa_AV
  s_sub_u32 s28, s28, 1
  s_cmp_eq_u32 s28, 0
  s_cbranch_scc1 fa_Aexit
.p2align 6
fa_DD:
  v_mfma_f32_16x16x32_bf16 v[96:99], a[128:131], v[32:35], v[192:195]
  s_waitcnt vmcnt(12)
  v_exp_f32 v208, v112
  v_mfma_f32_16x16x32_bf16 v[104:107], a[128:131], v[36:39], v[196:199]
  s_barrier
  v_exp_f32 v209, v113
  v_mfma_f32_16x16x32_bf16 v[128:131], a[128:131], v[64:67], v[200:203]
  s_cmp_ge_u32 s26, s32
  ds_read_b128 a[160:163], v3 offset:16384
  v_add_f32 v224, v208, v209
  v_mfma_f32_16x16x32_bf16 v[136:139], a[128:131], v[68:71], v[204:207]
  s_cbranch_scc1 fa_hk0
fa_hb0:
  v_exp_f32 v210, v114
  v_mfma_f32_16x16x32_bf16 v[100:103], a[132:135], v[32:35], v[192:195]
  ds_read_b128 a[164:167], v3 offset:17408
  v_cvt_pk_bf16_f32 v168, v208, v209
  v_mfma_f32_16x16x32_bf16 v[108:111], a[132:135], v[36:39], v[196:199]
  s_mov_b32 m0, s24
  v_exp_f32 v211, v115
  v_mfma_f32_16x16x32_bf16 v[132:135], a[132:135], v[64:67], v[200:203]
  buffer_load_dwordx4 v2, s[44:47], s26 offen offset:0 sc1 lds
  v_add_f32 v224, v224, v210
  v_add_f32 v224, v224, v211
  v_mfma_f32_16x16x32_bf16 v[140:143], a[132:135], v[68:71], v[204:207]
  v_exp_f32 v212, v116
  v_mfma_f32_16x16x32_bf16 v[96:99], a[136:139], v[40:43], v[96:99]
  ds_read_b128 a[168:171], v3 offset:18432
  v_cvt_pk_bf16_f32 v169, v210, v211
  v_mfma_f32_16x16x32_bf16 v[104:107], a[136:139], v[44:47], v[104:107]
  v_exp_f32 v213, v117
  v_mfma_f32_16x16x32_bf16 v[128:131], a[136:139], v[72:75], v[128:131]
  v_exp_f32 v214, v118
  v_mfma_f32_16x16x32_bf16 v[136:139], a[136:139], v[76:79], v[136:139]
  v_exp_f32 v215, v119
  v_mfma_f32_16x16x32_bf16 v[100:103], a[140:143], v[40:43], v[100:103]
  ds_read_b128 a[172:175], v3 offset:19456
  v_add_f32 v224, v224, v212
  v_mfma_f32_16x16x32_bf16 v[108:111], a[140:143], v[44:47], v[108:111]
  v_exp_f32 v208, v120
  v_mfma_f32_16x16x32_bf16 v[132:135], a[140:143], v[72:75], v[132:135]
  v_exp_f32 v209, v121
  v_mfma_f32_16x16x32_bf16 v[140:143], a[140:143], v[76:79], v[140:143]
  s_waitcnt lgkmcnt(4)
  v_exp_f32 v210, v122
  v_mfma_f32_16x16x32_bf16 v[96:99], a[144:147], v[48:51], v[96:99]
  ds_read_b128 a[176:179], v3 offset:20480
  v_add_f32 v224, v224, v213
  v_mfma_f32_16x16x32_bf16 v[104:107], a[144:147], v[52:55], v[104:107]
  v_exp_f32 v211, v123
  v_mfma_f32_16x16x32_bf16 v[128:131], a[144:147], v[80:83], v[128:131]
  v_cvt_pk_bf16_f32 v170, v212, v213
  v_add_f32 v224, v224, v214
  v_add_f32 v224, v224, v215
  v_mfma_f32_16x16x32_bf16 v[136:139], a[144:147], v[84:87], v[136:139]
  v_exp_f32 v212, v124
  v_mfma_f32_16x16x32_bf16 v[100:103], a[148:151], v[48:51], v[100:103]
  ds_read_b128 a[180:183], v3 offset:21504
  v_cvt_pk_bf16_f32 v171, v214, v215
  v_mfma_f32_16x16x32_bf16 v[108:111], a[148:151], v[52:55], v[108:111]
  v_exp_f32 v213, v125
  v_mfma_f32_16x16x32_bf16 v[132:135], a[148:151], v[80:83], v[132:135]
  buffer_load_dwordx4 v2, s[44:47], s26 offen offset:1024 sc1 lds
  v_add_f32 v225, v208, v209
  v_mfma_f32_16x16x32_bf16 v[140:143], a[148:151], v[84:87], v[140:143]
  v_exp_f32 v214, v126
  v_mfma_f32_16x16x32_bf16 v[96:99], a[152:155], v[56:59], v[96:99]
  ds_read_b128 a[184:187], v3 offset:22528
  v_cvt_pk_bf16_f32 v172, v208, v209
  v_mfma_f32_16x16x32_bf16 v[104:107], a[152:155], v[60:63], v[104:107]
  v_exp_f32 v215, v127
  v_mfma_f32_16x16x32_bf16 v[128:131], a[152:155], v[88:91], v[128:131]
  v_exp_f32 v216, v144
  v_mfma_f32_16x16x32_bf16 v[136:139], a[152:155], v[92:95], v[136:139]
  v_exp_f32 v217, v145
  v_mfma_f32_16x16x32_bf16 v[100:103], a[156:159], v[56:59], v[100:103]
  ds_read_b128 a[188:191], v3 offset:23552
  v_add_f32 v225, v225, v210
  v_mfma_f32_16x16x32_bf16 v[108:111], a[156:159], v[60:63], v[108:111]
  v_exp_f32 v218, v146
  v_mfma_f32_16x16x32_bf16 v[132:135], a[156:159], v[88:91], v[132:135]
  v_exp_f32 v219, v147
  v_mfma_f32_16x16x32_bf16 v[140:143], a[156:159], v[92:95], v[140:143]
  s_waitcnt lgkmcnt(4)
  v_exp_f32 v220, v148
  v_add_f32 v225, v225, v211
  v_mfma_f32_16x16x32_bf16 a[0:3], a[160:163], v[160:163], a[0:3]
  ds_read_b128 a[128:131], v3 offset:0
  v_cvt_pk_bf16_f32 v173, v210, v211
  v_mfma_f32_16x16x32_bf16 a[4:7], a[160:163], v[164:167], a[4:7]
  v_exp_f32 v221, v149
  v_mfma_f32_16x16x32_bf16 a[64:67], a[160:163], v[176:179], a[64:67]
  v_exp_f32 v222, v150
  v_mfma_f32_16x16x32_bf16 a[68:71], a[160:163], v[180:183], a[68:71]
  v_exp_f32 v223, v151
  v_mfma_f32_16x16x32_bf16 a[8:11], a[164:167], v[160:163], a[8:11]
  ds_read_b128 a[132:135], v3 offset:1024
  v_add_f32 v225, v225, v212
  v_mfma_f32_16x16x32_bf16 a[12:15], a[164:167], v[164:167], a[12:15]
  v_add_f32 v225, v225, v213
  v_cvt_pk_bf16_f32 v174, v212, v213
  v_mfma_f32_16x16x32_bf16 a[72:75], a[164:167], v[176:179], a[72:75]
  buffer_load_dwordx4 v2, s[44:47], s26 offen offset:2048 sc1 lds
  v_add_f32 v225, v225, v214
  v_mfma_f32_16x16x32_bf16 a[76:79], a[164:167], v[180:183], a[76:79]
  v_add_f32 v225, v225, v215
  v_cvt_pk_bf16_f32 v175, v214, v215
  v_mfma_f32_16x16x32_bf16 a[16:19], a[168:171], v[160:163], a[16:19]
  ds_read_b128 a[136:139], v3 offset:2048
  v_add_f32 v226, v216, v217
  v_mfma_f32_16x16x32_bf16 a[20:23], a[168:171], v[164:167], a[20:23]
  v_cvt_pk_bf16_f32 v184, v216, v217
  v_add_f32 v226, v226, v218
  v_mfma_f32_16x16x32_bf16 a[80:83], a[168:171], v[176:179], a[80:83]
  v_exp_f32 v216, v152
  v_mfma_f32_16x16x32_bf16 a[84:87], a[168:171], v[180:183], a[84:87]
  v_exp_f32 v217, v153
  v_mfma_f32_16x16x32_bf16 a[24:27], a[172:175], v[160:163], a[24:27]
  ds_read_b128 a[140:143], v3 offset:3072
  v_add_f32 v226, v226, v219
  v_cvt_pk_bf16_f32 v185, v218, v219
  v_mfma_f32_16x16x32_bf16 a[28:31], a[172:175], v[164:167], a[28:31]
  v_exp_f32 v218, v154
  v_mfma_f32_16x16x32_bf16 a[88:91], a[172:175], v[176:179], a[88:91]
  v_add_f32 v226, v226, v220
  v_add_f32 v226, v226, v221
  v_mfma_f32_16x16x32_bf16 a[92:95], a[172:175], v[180:183], a[92:95]
  s_waitcnt lgkmcnt(4)
  v_exp_f32 v219, v155
  v_mfma_f32_16x16x32_bf16 a[32:35], a[176:179], v[160:163], a[32:35]
  ds_read_b128 a[144:147], v3 offset:4096
  v_cvt_pk_bf16_f32 v186, v220, v221
  v_mfma_f32_16x16x32_bf16 a[36:39], a[176:179], v[164:167], a[36:39]
  v_exp_f32 v220, v156
  v_mfma_f32_16x16x32_bf16 a[96:99], a[176:179], v[176:179], a[96:99]
  v_add_f32 v226, v226, v222
  v_add_f32 v226, v226, v223
  v_mfma_f32_16x16x32_bf16 a[100:103], a[176:179], v[180:183], a[100:103]
  v_exp_f32 v221, v157
  v_mfma_f32_16x16x32_bf16 a[40:43], a[180:183], v[160:163], a[40:43]
  ds_read_b128 a[148:151], v3 offset:5120
  v_cvt_pk_bf16_f32 v187, v222, v223
  v_mfma_f32_16x16x32_bf16 a[44:47], a[180:183], v[164:167], a[44:47]
  v_exp_f32 v222, v158
  v_mfma_f32_16x16x32_bf16 a[104:107], a[180:183], v[176:179], a[104:107]
  buffer_load_dwordx4 v2, s[44:47], s26 offen offset:3072 sc1 lds
  v_add_f32 v227, v216, v217
  v_mfma_f32_16x16x32_bf16 a[108:111], a[180:183], v[180:183], a[108:111]
  s_add_u32 s26, s26, 16384
  v_exp_f32 v223, v159
  v_mfma_f32_16x16x32_bf16 a[48:51], a[184:187], v[160:163], a[48:51]
  s_add_u32 s24, s24, 32768
  ds_read_b128 a[152:155], v3 offset:6144
  v_cvt_pk_bf16_f32 v188, v216, v217
  v_add_f32 v227, v227, v218
  v_mfma_f32_16x16x32_bf16 a[52:55], a[184:187], v[164:167], a[52:55]
  s_and_b32 s24, s24, 0x1ffff
  v_add_f32 v227, v227, v219
  v_cvt_pk_bf16_f32 v189, v218, v219
  v_mfma_f32_16x16x32_bf16 a[112:115], a[184:187], v[176:179], a[112:115]
  v_max3_f32 v5, v224, v225, v226
  v_add_f32 v227, v227, v220
  v_mfma_f32_16x16x32_bf16 a[116:119], a[184:187], v[180:183], a[116:119]
  v_add_f32 v227, v227, v221
  v_cvt_pk_bf16_f32 v190, v220, v221
  v_mfma_f32_16x16x32_bf16 a[56:59], a[188:191], v[160:163], a[56:59]
  ds_read_b128 a[156:159], v3 offset:7168
  v_add_f32 v227, v227, v222
  v_mfma_f32_16x16x32_bf16 a[60:63], a[188:191], v[164:167], a[60:63]
  v_add_f32 v227, v227, v223
  v_cvt_pk_bf16_f32 v191, v222, v223
  v_mfma_f32_16x16x32_bf16 a[120:123], a[188:191], v[176:179], a[120:123]
  s_waitcnt lgkmcnt(4)
  v_max_f32 v5, v5, v227
  v_cmp_lt_f32 vcc, s81, v5
  v_mfma_f32_16x16x32_bf16 a[124:127], a[188:191], v[180:183], a[124:127]
  s_cbranch_vccnz fa_stub1
fa_back1:
  v_add_f32 v228, v228, v224
  v_add_f32 v229, v229, v225
  v_add_f32 v230, v230, v226
  v_add_f32 v231, v231, v227
fa_DDe:
  v_mfma_f32_16x16x32_bf16 v[112:115], a[128:131], v[32:35], v[192:195]
  ds_read_b128 a[160:163], v3 offset:24576
  v_exp_f32 v208, v96
  v_mfma_f32_16x16x32_bf16 v[120:123], a[128:131], v[36:39], v[196:199]
  v_exp_f32 v209, v97
  v_mfma_f32_16x16x32_bf16 v[144:147], a[128:131], v[64:67], v[200:203]
  s_cmp_ge_u32 s26, s9
  v_exp_f32 v210, v98
  v_mfma_f32_16x16x32_bf16 v[152:155], a[128:131], v[68:71], v[204:207]
  s_cbranch_scc1 fa_hk1
fa_hb1:
  v_exp_f32 v211, v99
  v_mfma_f32_16x16x32_bf16 v[116:119], a[132:135], v[32:35], v[192:195]
  ds_read_b128 a[164:167], v3 offset:25600
  v_mfma_f32_16x16x32_bf16 v[124:127], a[132:135], v[36:39], v[196:199]
  s_mov_b32 m0, s25
  v_exp_f32 v212, v100
  v_mfma_f32_16x16x32_bf16 v[148:151], a[132:135], v[64:67], v[200:203]
  buffer_load_dwordx4 v2, s[48:51], s27 offen offset:0 sc1 lds
  v_add_f32 v224, v208, v209
  v_cvt_pk_bf16_f32 v160, v208, v209
  v_mfma_f32_16x16x32_bf16 v[156:159], a[132:135], v[68:71], v[204:207]
  v_exp_f32 v213, v101
  v_mfma_f32_16x16x32_bf16 v[112:115], a[136:139], v[40:43], v[112:115]
  ds_read_b128 a[168:171], v3 offset:26624
  v_add_f32 v224, v224, v210
  v_mfma_f32_16x16x32_bf16 v[120:123], a[136:139], v[44:47], v[120:123]
  v_exp_f32 v214, v102
  v_mfma_f32_16x16x32_bf16 v[144:147], a[136:139], v[72:75], v[144:147]
  v_exp_f32 v215, v103
  v_mfma_f32_16x16x32_bf16 v[152:155], a[136:139], v[76:79], v[152:155]
  v_exp_f32 v208, v104
  v_mfma_f32_16x16x32_bf16 v[116:119], a[140:143], v[40:43], v[116:119]
  ds_read_b128 a[172:175], v3 offset:27648
  v_add_f32 v224, v224, v211
  v_mfma_f32_16x16x32_bf16 v[124:127], a[140:143], v[44:47], v[124:127]
  v_exp_f32 v209, v105
  v_mfma_f32_16x16x32_bf16 v[148:151], a[140:143], v[72:75], v[148:151]
  v_cvt_pk_bf16_f32 v161, v210, v211
  v_add_f32 v224, v224, v212
  v_mfma_f32_16x16x32_bf16 v[156:159], a[140:143], v[76:79], v[156:159]
  s_waitcnt lgkmcnt(4)
  v_exp_f32 v210, v106
  v_mfma_f32_16x16x32_bf16 v[112:115], a[144:147], v[48:51], v[112:115]
  ds_read_b128 a[176:179], v3 offset:28672
  v_add_f32 v224, v224, v213
  v_mfma_f32_16x16x32_bf16 v[120:123], a[144:147], v[52:55], v[120:123]
  v_exp_f32 v211, v107
  v_mfma_f32_16x16x32_bf16 v[144:147], a[144:147], v[80:83], v[144:147]
  v_cvt_pk_bf16_f32 v162, v212, v213
  v_add_f32 v224, v224, v214
  v_add_f32 v224, v224, v215
  v_mfma_f32_16x16x32_bf16 v[152:155], a[144:147], v[84:87], v[152:155]
  v_exp_f32 v212, v108
  v_mfma_f32_16x16x32_bf16 v[116:119], a[148:151], v[48:51], v[116:119]
  ds_read_b128 a[180:183], v3 offset:29696
  v_cvt_pk_bf16_f32 v163, v214, v215
  v_mfma_f32_16x16x32_bf16 v[124:127], a[148:151], v[52:55], v[124:127]
  v_exp_f32 v213, v109
  v_mfma_f32_16x16x32_bf16 v[148:151], a[148:151], v[80:83], v[148:151]
  buffer_load_dwordx4 v2, s[48:51], s27 offen offset:1024 sc1 lds
  v_add_f32 v225, v208, v209
  v_mfma_f32_16x16x32_bf16 v[156:159], a[148:151], v[84:87], v[156:159]
  v_exp_f32 v214, v110
  v_mfma_f32_16x16x32_bf16 v[112:115], a[152:155], v[56:59], v[112:115]
  ds_read_b128 a[184:187], v3 offset:30720
  v_cvt_pk_bf16_f32 v164, v208, v209
  v_mfma_f32_16x16x32_bf16 v[120:123], a[152:155], v[60:63], v[120:123]
  v_exp_f32 v215, v111
  v_mfma_f32_16x16x32_bf16 v[144:147], a[152:155], v[88:91], v[144:147]
  v_exp_f32 v216, v128
  v_mfma_f32_16x16x32_bf16 v[152:155], a[152:155], v[92:95], v[152:155]
  v_exp_f32 v217, v129
  v_mfma_f32_16x16x32_bf16 v[116:119], a[156:159], v[56:59], v[116:119]
  ds_read_b128 a[188:191], v3 offset:31744
  v_add_f32 v225, v225, v210
  v_mfma_f32_16x16x32_bf16 v[124:127], a[156:159], v[60:63], v[124:127]
  v_exp_f32 v218, v130
  v_mfma_f32_16x16x32_bf16 v[148:151], a[156:159], v[88:91], v[148:151]
  v_exp_f32 v219, v131
  v_mfma_f32_16x16x32_bf16 v[156:159], a[156:159], v[92:95], v[156:159]
  s_waitcnt lgkmcnt(4)
  v_exp_f32 v220, v132
  v_add_f32 v225, v225, v211
  v_mfma_f32_16x16x32_bf16 a[0:3], a[160:163], v[168:171], a[0:3]
  ds_read_b128 a[128:131], v3 offset:8192
  v_cvt_pk_bf16_f32 v165, v210, v211
  v_mfma_f32_16x16x32_bf16 a[4:7], a[160:163], v[172:175], a[4:7]
  v_exp_f32 v221, v133
  v_mfma_f32_16x16x32_bf16 a[64:67], a[160:163], v[184:187], a[64:67]
  v_exp_f32 v222, v134
  v_mfma_f32_16x16x32_bf16 a[68:71], a[160:163], v[188:191], a[68:71]
  v_exp_f32 v223, v135
  v_mfma_f32_16x16x32_bf16 a[8:11], a[164:167], v[168:171], a[8:11]
  ds_read_b128 a[132:135], v3 offset:9216
  v_add_f32 v225, v225, v212
  v_mfma_f32_16x16x32_bf16 a[12:15], a[164:167], v[172:175], a[12:15]
  v_add_f32 v225, v225, v213
  v_cvt_pk_bf16_f32 v166, v212, v213
  v_mfma_f32_16x16x32_bf16 a[72:75], a[164:167], v[184:187], a[72:75]
  buffer_load_dwordx4 v2, s[48:51], s27 offen offset:2048 sc1 lds
  v_add_f32 v225, v225, v214
  v_mfma_f32_16x16x32_bf16 a[76:79], a[164:167], v[188:191], a[76:79]
  v_add_f32 v225, v225, v215
  v_cvt_pk_bf16_f32 v167, v214, v215
  v_mfma_f32_16x16x32_bf16 a[16:19], a[168:171], v[168:171], a[16:19]
  ds_read_b128 a[136:139], v3 offset:10240
  v_add_f32 v226, v216, v217
  v_mfma_f32_16x16x32_bf16 a[20:23], a[168:171], v[172:175], a[20:23]
  v_cvt_pk_bf16_f32 v176, v216, v217
  v_add_f32 v226, v226, v218
  v_mfma_f32_16x16x32_bf16 a[80:83], a[168:171], v[184:187], a[80:83]
  v_exp_f32 v216, v136
  v_mfma_f32_16x16x32_bf16 a[84:87], a[168:171], v[188:191], a[84:87]
  v_exp_f32 v217, v137
  v_mfma_f32_16x16x32_bf16 a[24:27], a[172:175], v[168:171], a[24:27]
  ds_read_b128 a[140:143], v3 offset:11264
  v_add_f32 v226, v226, v219
  v_cvt_pk_bf16_f32 v177, v218, v219
  v_mfma_f32_16x16x32_bf16 a[28:31], a[172:175], v[172:175], a[28:31]
  v_exp_f32 v218, v138
  v_mfma_f32_16x16x32_bf16 a[88:91], a[172:175], v[184:187], a[88:91]
  v_add_f32 v226, v226, v220
  v_add_f32 v226, v226, v221
  v_mfma_f32_16x16x32_bf16 a[92:95], a[172:175], v[188:191], a[92:95]
  s_waitcnt lgkmcnt(4)
  v_exp_f32 v219, v139
  v_mfma_f32_16x16x32_bf16 a[32:35], a[176:179], v[168:171], a[32:35]
  ds_read_b128 a[144:147], v3 offset:12288
  v_cvt_pk_bf16_f32 v178, v220, v221
  v_mfma_f32_16x16x32_bf16 a[36:39], a[176:179], v[172:175], a[36:39]
  v_exp_f32 v220, v140
  v_mfma_f32_16x16x32_bf16 a[96:99], a[176:179], v[184:187], a[96:99]
  v_add_f32 v226, v226, v222
  v_add_f32 v226, v226, v223
  v_mfma_f32_16x16x32_bf16 a[100:103], a[176:179], v[188:191], a[100:103]
  v_exp_f32 v221, v141
  v_mfma_f32_16x16x32_bf16 a[40:43], a[180:183], v[168:171], a[40:43]
  ds_read_b128 a[148:151], v3 offset:13312
  v_cvt_pk_bf16_f32 v179, v222, v223
  v_mfma_f32_16x16x32_bf16 a[44:47], a[180:183], v[172:175], a[44:47]
  v_exp_f32 v222, v142
  v_mfma_f32_16x16x32_bf16 a[104:107], a[180:183], v[184:187], a[104:107]
  buffer_load_dwordx4 v2, s[48:51], s27 offen offset:3072 sc1 lds
  v_add_f32 v227, v216, v217
  v_mfma_f32_16x16x32_bf16 a[108:111], a[180:183], v[188:191], a[108:111]
  s_add_u32 s27, s27, 16384
  v_exp_f32 v223, v143
  v_mfma_f32_16x16x32_bf16 a[48:51], a[184:187], v[168:171], a[48:51]
  s_add_u32 s25, s25, 32768
  ds_read_b128 a[152:155], v3 offset:14336
  v_cvt_pk_bf16_f32 v180, v216, v217
  v_add_f32 v227, v227, v218
  v_mfma_f32_16x16x32_bf16 a[52:55], a[184:187], v[172:175], a[52:55]
  s_and_b32 s25, s25, 0x1ffff
  v_add_f32 v227, v227, v219
  v_cvt_pk_bf16_f32 v181, v218, v219
  v_mfma_f32_16x16x32_bf16 a[112:115], a[184:187], v[184:187], a[112:115]
  v_max3_f32 v5, v224, v225, v226
  v_add_f32 v227, v227, v220
  v_mfma_f32_16x16x32_bf16 a[116:119], a[184:187], v[188:191], a[116:119]
  v_add_f32 v227, v227, v221
  v_cvt_pk_bf16_f32 v182, v220, v221
  v_mfma_f32_16x16x32_bf16 a[56:59], a[188:191], v[168:171], a[56:59]
  ds_read_b128 a[156:159], v3 offset:15360
  v_add_f32 v227, v227, v222
  v_mfma_f32_16x16x32_bf16 a[60:63], a[188:191], v[172:175], a[60:63]
  s_sub_u32 s28, s28, 1
  v_add_f32 v227, v227, v223
  v_cvt_pk_bf16_f32 v183, v222, v223
  v_mfma_f32_16x16x32_bf16 a[120:123], a[188:191], v[184:187], a[120:123]
  s_waitcnt lgkmcnt(4)
  v_max_f32 v5, v5, v227
  v_cmp_lt_f32 vcc, s81, v5
  v_mfma_f32_16x16x32_bf16 a[124:127], a[188:191], v[188:191], a[124:127]
  s_cbranch_vccnz fa_stub2
fa_back2:
  v_add_f32 v228, v228, v224
  v_add_f32 v229, v229, v225
  v_add_f32 v230, v230, v226
  v_add_f32 v231, v231, v227
  v_add_u32 v3, 32768, v3
  v_and_b32 v3, 0x1ffff, v3
  s_cmp_lg_u32 s8, 0
  s_cbranch_scc1 fa_DDF
  s_cmp_lg_u32 s28, 0
  s_cbranch_scc1 fa_DD
fa_Aexit:
  s_bitcmp1_b32 s20, 0
  s_cbranch_scc1 fa_Aodd
  v_mfma_f32_16x16x32_bf16 v[96:99], a[128:131], v[32:35], v[192:195]
  s_waitcnt vmcnt(12)
  v_exp_f32 v208, v112
  v_mfma_f32_16x16x32_bf16 v[104:107], a[128:131], v[36:39], v[196:199]
  s_barrier
  v_exp_f32 v209, v113
  v_mfma_f32_16x16x32_bf16 v[128:131], a[128:131], v[64:67], v[200:203]
  ds_read_b128 a[160:163], v3 offset:16384
  v_add_f32 v224, v208, v209
  v_mfma_f32_16x16x32_bf16 v[136:139], a[128:131], v[68:71], v[204:207]
  v_exp_f32 v210, v114
  v_mfma_f32_16x16x32_bf16 v[100:103], a[132:135], v[32:35], v[192:195]
  ds_read_b128 a[164:167], v3 offset:17408
  v_cvt_pk_bf16_f32 v168, v208, v209
  v_mfma_f32_16x16x32_bf16 v[108:111], a[132:135], v[36:39], v[196:199]
  s_mov_b32 m0, s24
  v_exp_f32 v211, v115
  v_mfma_f32_16x16x32_bf16 v[132:135], a[132:135], v[64:67], v[200:203]
  buffer_load_dwordx4 v2, s[44:47], s26 offen offset:0 sc1 lds
  v_add_f32 v224, v224, v210
  v_add_f32 v224, v224, v211
  v_mfma_f32_16x16x32_bf16 v[140:143], a[132:135], v[68:71], v[204:207]
  v_exp_f32 v212, v116
  v_mfma_f32_16x16x32_bf16 v[96:99], a[136:139], v[40:43], v[96:99]
  ds_read_b128 a[168:171], v3 offset:18432
  v_cvt_pk_bf16_f32 v169, v210, v211
  v_mfma_f32_16x16x32_bf16 v[104:107], a[136:139], v[44:47], v[104:107]
  v_exp_f32 v213, v117
  v_mfma_f32_16x16x32_bf16 v[128:131], a[136:139], v[72:75], v[128:131]
  v_exp_f32 v214, v118
  v_mfma_f32_16x16x32_bf16 v[136:139], a[136:139], v[76:79], v[136:139]
  v_exp_f32 v215, v119
  v_mfma_f32_16x16x32_bf16 v[100:103], a[140:143], v[40:43], v[100:103]
  ds_read_b128 a[172:175], v3 offset:19456
  v_add_f32 v224, v224, v212
  v_mfma_f32_16x16x32_bf16 v[108:111], a[140:143], v[44:47], v[108:111]
  v_exp_f32 v208, v120
  v_mfma_f32_16x16x32_bf16 v[132:135], a[140:143], v[72:75], v[132:135]
  v_exp_f32 v209, v121
  v_mfma_f32_16x16x32_bf16 v[140:143], a[140:143], v[76:79], v[140:143]
  s_waitcnt lgkmcnt(4)
  v_exp_f32 v210, v122
  v_mfma_f32_16x16x32_bf16 v[96:99], a[144:147], v[48:51], v[96:99]
  ds_read_b128 a[176:179], v3 offset:20480
  v_add_f32 v224, v224, v213
  v_mfma_f32_16x16x32_bf16 v[104:107], a[144:147], v[52:55], v[104:107]
  v_exp_f32 v211, v123
  v_mfma_f32_16x16x32_bf16 v[128:131], a[144:147], v[80:83], v[128:131]
  v_cvt_pk_bf16_f32 v170, v212, v213
  v_add_f32 v224, v224, v214
  v_add_f32 v224, v224, v215
  v_mfma_f32_16x16x32_bf16 v[136:139], a[144:147], v[84:87], v[136:139]
  v_exp_f32 v212, v124
  v_mfma_f32_16x16x32_bf16 v[100:103], a[148:151], v[48:51], v[100:103]
  ds_read_b128 a[180:183], v3 offset:21504
  v_cvt_pk_bf16_f32 v171, v214, v215
  v_mfma_f32_16x16x32_bf16 v[108:111], a[148:151], v[52:55], v[108:111]
  v_exp_f32 v213, v125
  v_mfma_f32_16x16x32_bf16 v[132:135], a[148:151], v[80:83], v[132:135]
  buffer_load_dwordx4 v2, s[44:47], s26 offen offset:1024 sc1 lds
  v_add_f32 v225, v208, v209
  v_mfma_f32_16x16x32_bf16 v[140:143], a[148:151], v[84:87], v[140:143]
  v_exp_f32 v214, v126
  v_mfma_f32_16x16x32_bf16 v[96:99], a[152:155], v[56:59], v[96:99]
  ds_read_b128 a[184:187], v3 offset:22528
  v_cvt_pk_bf16_f32 v172, v208, v209
  v_mfma_f32_16x16x32_bf16 v[104:107], a[152:155], v[60:63], v[104:107]
  v_exp_f32 v215, v127
  v_mfma_f32_16x16x32_bf16 v[128:131], a[152:155], v[88:91], v[128:131]
  v_exp_f32 v216, v144
  v_mfma_f32_16x16x32_bf16 v[136:139], a[152:155], v[92:95], v[136:139]
  v_exp_f32 v217, v145
  v_mfma_f32_16x16x32_bf16 v[100:103], a[156:159], v[56:59], v[100:103]
  ds_read_b128 a[188:191], v3 offset:23552
  v_add_f32 v225, v225, v210
  v_mfma_f32_16x16x32_bf16 v[108:111], a[156:159], v[60:63], v[108:111]
  v_exp_f32 v218, v146
  v_mfma_f32_16x16x32_bf16 v[132:135], a[156:159], v[88:91], v[132:135]
  v_exp_f32 v219, v147
  v_mfma_f32_16x16x32_bf16 v[140:143], a[156:159], v[92:95], v[140:143]
  s_waitcnt lgkmcnt(4)
  v_exp_f32 v220, v148
  v_add_f32 v225, v225, v211
  v_mfma_f32_16x16x32_bf16 a[0:3], a[160:163], v[160:163], a[0:3]
  ds_read_b128 a[128:131], v3 offset:0
  v_cvt_pk_bf16_f32 v173, v210, v211
  v_mfma_f32_16x16x32_bf16 a[4:7], a[160:163], v[164:167], a[4:7]
  v_exp_f32 v221, v149
  v_mfma_f32_16x16x32_bf16 a[64:67], a[160:163], v[176:179], a[64:67]
  v_exp_f32 v222, v150
  v_mfma_f32_16x16x32_bf16 a[68:71], a[160:163], v[180:183], a[68:71]
  v_exp_f32 v223, v151
  v_mfma_f32_16x16x32_bf16 a[8:11], a[164:167], v[160:163], a[8:11]
  ds_read_b128 a[132:135], v3 offset:1024
  v_add_f32 v225, v225, v212
  v_mfma_f32_16x16x32_bf16 a[12:15], a[164:167], v[164:167], a[12:15]
  v_add_f32 v225, v225, v213
  v_cvt_pk_bf16_f32 v174, v212, v213
  v_mfma_f32_16x16x32_bf16 a[72:75], a[164:167], v[176:179], a[72:75]
  buffer_load_dwordx4 v2, s[44:47], s26 offen offset:2048 sc1 lds
  v_add_f32 v225, v225, v214
  v_mfma_f32_16x16x32_bf16 a[76:79], a[164:167], v[180:183], a[76:79]
  v_add_f32 v225, v225, v215
  v_cvt_pk_bf16_f32 v175, v214, v215
  v_mfma_f32_16x16x32_bf16 a[16:19], a[168:171], v[160:163], a[16:19]
  ds_read_b128 a[136:139], v3 offset:2048
  v_add_f32 v226, v216, v217
  v_mfma_f32_16x16x32_bf16 a[20:23], a[168:171], v[164:167], a[20:23]
  v_cvt_pk_bf16_f32 v184, v216, v217
  v_add_f32 v226, v226, v218
  v_mfma_f32_16x16x32_bf16 a[80:83], a[168:171], v[176:179], a[80:83]
  v_exp_f32 v216, v152
  v_mfma_f32_16x16x32_bf16 a[84:87], a[168:171], v[180:183], a[84:87]
  v_exp_f32 v217, v153
  v_mfma_f32_16x16x32_bf16 a[24:27], a[172:175], v[160:163], a[24:27]
  ds_read_b128 a[140:143], v3 offset:3072
  v_add_f32 v226, v226, v219
  v_cvt_pk_bf16_f32 v185, v218, v219
  v_mfma_f32_16x16x32_bf16 a[28:31], a[172:175], v[164:167], a[28:31]
  v_exp_f32 v218, v154
  v_mfma_f32_16x16x32_bf16 a[88:91], a[172:175], v[176:179], a[88:91]
  v_add_f32 v226, v226, v220
  v_add_f32 v226, v226, v221
  v_mfma_f32_16x16x32_bf16 a[92:95], a[172:175], v[180:183], a[92:95]
  s_waitcnt lgkmcnt(4)
  v_exp_f32 v219, v155
  v_mfma_f32_16x16x32_bf16 a[32:35], a[176:179], v[160:163], a[32:35]
  ds_read_b128 a[144:147], v3 offset:4096
  v_cvt_pk_bf16_f32 v186, v220, v221
  v_mfma_f32_16x16x32_bf16 a[36:39], a[176:179], v[164:167], a[36:39]
  v_exp_f32 v220, v156
  v_mfma_f32_16x16x32_bf16 a[96:99], a[176:179], v[176:179], a[96:99]
  v_add_f32 v226, v226, v222
  v_add_f32 v226, v226, v223
  v_mfma_f32_16x16x32_bf16 a[100:103], a[176:179], v[180:183], a[100:103]
  v_exp_f32 v221, v157
  v_mfma_f32_16x16x32_bf16 a[40:43], a[180:183], v[160:163], a[40:43]
  ds_read_b128 a[148:151], v3 offset:5120
  v_cvt_pk_bf16_f32 v187, v222, v223
  v_mfma_f32_16x16x32_bf16 a[44:47], a[180:183], v[164:167], a[44:47]
  v_exp_f32 v222, v158
  v_mfma_f32_16x16x32_bf16 a[104:107], a[180:183], v[176:179], a[104:107]
  buffer_load_dwordx4 v2, s[44:47], s26 offen offset:3072 sc1 lds
  v_add_f32 v227, v216, v217
  v_mfma_f32_16x16x32_bf16 a[108:111], a[180:183], v[180:183], a[108:111]
  s_add_u32 s26, s26, 16384
  v_exp_f32 v223, v159
  v_mfma_f32_16x16x32_bf16 a[48:51], a[184:187], v[160:163], a[48:51]
  s_add_u32 s24, s24, 32768
  ds_read_b128 a[152:155], v3 offset:6144
  v_cvt_pk_bf16_f32 v188, v216, v217
  v_add_f32 v227, v227, v218
  v_mfma_f32_16x16x32_bf16 a[52:55], a[184:187], v[164:167], a[52:55]
  s_and_b32 s24, s24, 0x1ffff
  v_add_f32 v227, v227, v219
  v_cvt_pk_bf16_f32 v189, v218, v219
  v_mfma_f32_16x16x32_bf16 a[112:115], a[184:187], v[176:179], a[112:115]
  v_max3_f32 v5, v224, v225, v226
  v_add_f32 v227, v227, v220
  v_mfma_f32_16x16x32_bf16 a[116:119], a[184:187], v[180:183], a[116:119]
  v_add_f32 v227, v227, v221
  v_cvt_pk_bf16_f32 v190, v220, v221
  v_mfma_f32_16x16x32_bf16 a[56:59], a[188:191], v[160:163], a[56:59]
  ds_read_b128 a[156:159], v3 offset:7168
  v_add_f32 v227, v227, v222
  v_mfma_f32_16x16x32_bf16 a[60:63], a[188:191], v[164:167], a[60:63]
  v_add_f32 v227, v227, v223
  v_cvt_pk_bf16_f32 v191, v222, v223
  v_mfma_f32_16x16x32_bf16 a[120:123], a[188:191], v[176:179], a[120:123]
  s_waitcnt lgkmcnt(4)
  v_max_f32 v5, v5, v227
  v_cmp_lt_f32 vcc, s81, v5
  v_mfma_f32_16x16x32_bf16 a[124:127], a[188:191], v[180:183], a[124:127]
  s_cbranch_vccnz fa_stub4
fa_back4:
  v_add_f32 v228, v228, v224
  v_add_f32 v229, v229, v225
  v_add_f32 v230, v230, v226
  v_add_f32 v231, v231, v227
  v_mfma_f32_16x16x32_bf16 v[144:147], a[128:131], v[64:67], v[200:203]
  ds_read_b128 a[160:163], v3 offset:24576
  v_cndmask_b32 v96, v4, v96, s[68:69]
  v_cndmask_b32 v97, v4, v97, s[70:71]
  v_mfma_f32_16x16x32_bf16 v[152:155], a[128:131], v[68:71], v[204:207]
  v_cndmask_b32 v98, v4, v98, s[72:73]
  v_cndmask_b32 v99, v4, v99, s[74:75]
  v_mov_b32 v100, v4
  v_mfma_f32_16x16x32_bf16 v[148:151], a[132:135], v[64:67], v[200:203]
  ds_read_b128 a[164:167], v3 offset:25600
  v_mov_b32 v101, v4
  v_mov_b32 v102, v4
  v_mfma_f32_16x16x32_bf16 v[156:159], a[132:135], v[68:71], v[204:207]
  v_mov_b32 v103, v4
  v_cndmask_b32 v108, v4, v108, s[68:69]
  v_cndmask_b32 v109, v4, v109, s[70:71]
  v_mfma_f32_16x16x32_bf16 v[144:147], a[136:139], v[72:75], v[144:147]
  ds_read_b128 a[168:171], v3 offset:26624
  v_cndmask_b32 v110, v4, v110, s[72:73]
  v_cndmask_b32 v111, v4, v111, s[74:75]
  v_mfma_f32_16x16x32_bf16 v[152:155], a[136:139], v[76:79], v[152:155]
  s_mov_b32 m0, s25
  v_exp_f32 v208, v96
  v_exp_f32 v209, v97
  v_mfma_f32_16x16x32_bf16 v[148:151], a[140:143], v[72:75], v[148:151]
  ds_read_b128 a[172:175], v3 offset:27648
  buffer_load_dwordx4 v2, s[48:51], s27 offen offset:0 sc1 lds
  v_mfma_f32_16x16x32_bf16 v[156:159], a[140:143], v[76:79], v[156:159]
  s_waitcnt lgkmcnt(4)
  v_exp_f32 v210, v98
  v_add_f32 v224, v208, v209
  v_mfma_f32_16x16x32_bf16 v[144:147], a[144:147], v[80:83], v[144:147]
  ds_read_b128 a[176:179], v3 offset:28672
  v_exp_f32 v211, v99
  v_mfma_f32_16x16x32_bf16 v[152:155], a[144:147], v[84:87], v[152:155]
  v_exp_f32 v212, v100
  v_cvt_pk_bf16_f32 v160, v208, v209
  v_mfma_f32_16x16x32_bf16 v[148:151], a[148:151], v[80:83], v[148:151]
  ds_read_b128 a[180:183], v3 offset:29696
  v_exp_f32 v213, v101
  v_mfma_f32_16x16x32_bf16 v[156:159], a[148:151], v[84:87], v[156:159]
  v_exp_f32 v214, v102
  v_add_f32 v224, v224, v210
  v_add_f32 v224, v224, v211
  v_mfma_f32_16x16x32_bf16 v[144:147], a[152:155], v[88:91], v[144:147]
  ds_read_b128 a[184:187], v3 offset:30720
  v_cvt_pk_bf16_f32 v161, v210, v211
  v_add_f32 v224, v224, v212
  v_mfma_f32_16x16x32_bf16 v[152:155], a[152:155], v[92:95], v[152:155]
  v_exp_f32 v215, v103
  v_add_f32 v224, v224, v213
  v_mfma_f32_16x16x32_bf16 v[148:151], a[156:159], v[88:91], v[148:151]
  ds_read_b128 a[188:191], v3 offset:31744
  v_cvt_pk_bf16_f32 v162, v212, v213
  v_add_f32 v224, v224, v214
  v_mfma_f32_16x16x32_bf16 v[156:159], a[156:159], v[92:95], v[156:159]
  s_waitcnt lgkmcnt(4)
  v_exp_f32 v208, v104
  v_add_f32 v224, v224, v215
  v_mfma_f32_16x16x32_bf16 a[0:3], a[160:163], v[168:171], a[0:3]
  ds_read_b128 a[128:131], v3 offset:8192
  v_cvt_pk_bf16_f32 v163, v214, v215
  v_exp_f32 v209, v105
  v_mfma_f32_16x16x32_bf16 a[4:7], a[160:163], v[172:175], a[4:7]
  v_exp_f32 v210, v106
  v_mfma_f32_16x16x32_bf16 a[64:67], a[160:163], v[184:187], a[64:67]
  buffer_load_dwordx4 v2, s[48:51], s27 offen offset:1024 sc1 lds
  v_exp_f32 v211, v107
  v_mfma_f32_16x16x32_bf16 a[68:71], a[160:163], v[188:191], a[68:71]
  v_exp_f32 v212, v108
  v_add_f32 v225, v208, v209
  v_mfma_f32_16x16x32_bf16 a[8:11], a[164:167], v[168:171], a[8:11]
  ds_read_b128 a[132:135], v3 offset:9216
  v_exp_f32 v213, v109
  v_mfma_f32_16x16x32_bf16 a[12:15], a[164:167], v[172:175], a[12:15]
  v_exp_f32 v214, v110
  v_cvt_pk_bf16_f32 v164, v208, v209
  v_mfma_f32_16x16x32_bf16 a[72:75], a[164:167], v[184:187], a[72:75]
  v_exp_f32 v215, v111
  v_add_f32 v225, v225, v210
  v_mfma_f32_16x16x32_bf16 a[76:79], a[164:167], v[188:191], a[76:79]
  v_exp_f32 v216, v128
  v_add_f32 v225, v225, v211
  v_mfma_f32_16x16x32_bf16 a[16:19], a[168:171], v[168:171], a[16:19]
  ds_read_b128 a[136:139], v3 offset:10240
  v_exp_f32 v217, v129
  v_mfma_f32_16x16x32_bf16 a[20:23], a[168:171], v[172:175], a[20:23]
  v_exp_f32 v218, v130
  v_cvt_pk_bf16_f32 v165, v210, v211
  v_mfma_f32_16x16x32_bf16 a[80:83], a[168:171], v[184:187], a[80:83]
  v_exp_f32 v219, v131
  v_add_f32 v225, v225, v212
  v_mfma_f32_16x16x32_bf16 a[84:87], a[168:171], v[188:191], a[84:87]
  v_exp_f32 v220, v132
  v_add_f32 v225, v225, v213
  v_mfma_f32_16x16x32_bf16 a[24:27], a[172:175], v[168:171], a[24:27]
  ds_read_b128 a[140:143], v3 offset:11264
  v_exp_f32 v221, v133
  v_mfma_f32_16x16x32_bf16 a[28:31], a[172:175], v[172:175], a[28:31]
  v_exp_f32 v222, v134
  v_cvt_pk_bf16_f32 v166, v212, v213
  v_mfma_f32_16x16x32_bf16 a[88:91], a[172:175], v[184:187], a[88:91]
  buffer_load_dwordx4 v2, s[48:51], s27 offen offset:2048 sc1 lds
  v_exp_f32 v223, v135
  v_mfma_f32_16x16x32_bf16 a[92:95], a[172:175], v[188:191], a[92:95]
  s_waitcnt lgkmcnt(4)
  v_add_f32 v225, v225, v214
  v_add_f32 v225, v225, v215
  v_cvt_pk_bf16_f32 v167, v214, v215
  v_mfma_f32_16x16x32_bf16 a[32:35], a[176:179], v[168:171], a[32:35]
  ds_read_b128 a[144:147], v3 offset:12288
  v_add_f32 v226, v216, v217
  v_cvt_pk_bf16_f32 v176, v216, v217
  v_mfma_f32_16x16x32_bf16 a[36:39], a[176:179], v[172:175], a[36:39]
  v_exp_f32 v216, v136
  v_add_f32 v226, v226, v218
  v_mfma_f32_16x16x32_bf16 a[96:99], a[176:179], v[184:187], a[96:99]
  v_exp_f32 v217, v137
  v_add_f32 v226, v226, v219
  v_mfma_f32_16x16x32_bf16 a[100:103], a[176:179], v[188:191], a[100:103]
  v_cvt_pk_bf16_f32 v177, v218, v219
  v_add_f32 v226, v226, v220
  v_add_f32 v226, v226, v221
  v_cvt_pk_bf16_f32 v178, v220, v221
  v_mfma_f32_16x16x32_bf16 a[40:43], a[180:183], v[168:171], a[40:43]
  ds_read_b128 a[148:151], v3 offset:13312
  v_add_f32 v226, v226, v222
  v_add_f32 v226, v226, v223
  v_mfma_f32_16x16x32_bf16 a[44:47], a[180:183], v[172:175], a[44:47]
  v_exp_f32 v218, v138
  v_cvt_pk_bf16_f32 v179, v222, v223
  v_mfma_f32_16x16x32_bf16 a[104:107], a[180:183], v[184:187], a[104:107]
  v_exp_f32 v219, v139
  v_add_f32 v227, v216, v217
  v_mfma_f32_16x16x32_bf16 a[108:111], a[180:183], v[188:191], a[108:111]
  v_exp_f32 v220, v140
  v_cvt_pk_bf16_f32 v180, v216, v217
  v_mfma_f32_16x16x32_bf16 a[48:51], a[184:187], v[168:171], a[48:51]
  ds_read_b128 a[152:155], v3 offset:14336
  v_add_f32 v227, v227, v218
  v_add_f32 v227, v227, v219
  v_mfma_f32_16x16x32_bf16 a[52:55], a[184:187], v[172:175], a[52:55]
  v_exp_f32 v221, v141
  v_cvt_pk_bf16_f32 v181, v218, v219
  v_mfma_f32_16x16x32_bf16 a[112:115], a[184:187], v[184:187], a[112:115]
  buffer_load_dwordx4 v2, s[48:51], s27 offen offset:3072 sc1 lds
  v_max3_f32 v5, v224, v225, v226
  v_add_f32 v227, v227, v220
  v_mfma_f32_16x16x32_bf16 a[116:119], a[184:187], v[188:191], a[116:119]
  s_add_u32 s27, s27, 16384
  v_exp_f32 v222, v142
  v_add_f32 v227, v227, v221
  v_mfma_f32_16x16x32_bf16 a[56:59], a[188:191], v[168:171], a[56:59]
  s_add_u32 s25, s25, 32768
  ds_read_b128 a[156:159], v3 offset:15360
  v_cvt_pk_bf16_f32 v182, v220, v221
  v_add_f32 v227, v227, v222
  v_mfma_f32_16x16x32_bf16 a[60:63], a[188:191], v[172:175], a[60:63]
  s_and_b32 s25, s25, 0x1ffff
  v_exp_f32 v223, v143
  v_mfma_f32_16x16x32_bf16 a[120:123], a[188:191], v[184:187], a[120:123]
  s_waitcnt lgkmcnt(4)
  v_add_f32 v227, v227, v223
  v_cvt_pk_bf16_f32 v183, v222, v223
  v_max_f32 v5, v5, v227
  v_cmp_lt_f32 vcc, s81, v5
  v_mfma_f32_16x16x32_bf16 a[124:127], a[188:191], v[188:191], a[124:127]
  s_cbranch_vccnz fa_stub5
fa_back5:
  v_add_f32 v228, v228, v224
  v_add_f32 v229, v229, v225
  v_add_f32 v230, v230, v226
  v_add_f32 v231, v231, v227
  v_add_u32 v3, 32768, v3
  v_and_b32 v3, 0x1ffff, v3
fa_AV:
  v_mfma_f32_16x16x32_bf16 v[128:131], a[128:131], v[64:67], v[200:203]
  s_waitcnt vmcnt(12)
  v_exp_f32 v216, v144
  v_mfma_f32_16x16x32_bf16 v[136:139], a[128:131], v[68:71], v[204:207]
  s_barrier
  v_exp_f32 v217, v145
  v_mfma_f32_16x16x32_bf16 v[132:135], a[132:135], v[64:67], v[200:203]
  ds_read_b128 a[160:163], v3 offset:16384
  ds_read_b128 a[164:167], v3 offset:17408
  v_mfma_f32_16x16x32_bf16 v[140:143], a[132:135], v[68:71], v[204:207]
  v_exp_f32 v218, v146
  v_mfma_f32_16x16x32_bf16 v[128:131], a[136:139], v[72:75], v[128:131]
  ds_read_b128 a[168:171], v3 offset:18432
  v_add_f32 v226, v216, v217
  v_mfma_f32_16x16x32_bf16 v[136:139], a[136:139], v[76:79], v[136:139]
  s_mov_b32 m0, s24
  v_exp_f32 v219, v147
  v_mfma_f32_16x16x32_bf16 v[132:135], a[140:143], v[72:75], v[132:135]
  ds_read_b128 a[172:175], v3 offset:19456
  buffer_load_dwordx4 v2, s[44:47], s26 offen offset:0 sc1 lds
  v_mfma_f32_16x16x32_bf16 v[140:143], a[140:143], v[76:79], v[140:143]
  s_waitcnt lgkmcnt(4)
  v_exp_f32 v220, v148
  v_mfma_f32_16x16x32_bf16 v[128:131], a[144:147], v[80:83], v[128:131]
  ds_read_b128 a[176:179], v3 offset:20480
  v_cvt_pk_bf16_f32 v184, v216, v217
  v_mfma_f32_16x16x32_bf16 v[136:139], a[144:147], v[84:87], v[136:139]
  v_exp_f32 v221, v149
  v_mfma_f32_16x16x32_bf16 v[132:135], a[148:151], v[80:83], v[132:135]
  ds_read_b128 a[180:183], v3 offset:21504
  v_add_f32 v226, v226, v218
  v_mfma_f32_16x16x32_bf16 v[140:143], a[148:151], v[84:87], v[140:143]
  v_exp_f32 v222, v150
  v_mfma_f32_16x16x32_bf16 v[128:131], a[152:155], v[88:91], v[128:131]
  ds_read_b128 a[184:187], v3 offset:22528
  v_add_f32 v226, v226, v219
  v_mfma_f32_16x16x32_bf16 v[136:139], a[152:155], v[92:95], v[136:139]
  v_exp_f32 v223, v151
  v_mfma_f32_16x16x32_bf16 v[132:135], a[156:159], v[88:91], v[132:135]
  ds_read_b128 a[188:191], v3 offset:23552
  v_cvt_pk_bf16_f32 v185, v218, v219
  v_mfma_f32_16x16x32_bf16 v[140:143], a[156:159], v[92:95], v[140:143]
  s_waitcnt lgkmcnt(4)
  v_exp_f32 v216, v152
  v_mfma_f32_16x16x32_bf16 a[0:3], a[160:163], v[160:163], a[0:3]
  ds_read_b128 a[128:131], v3 offset:0
  v_add_f32 v226, v226, v220
  v_mfma_f32_16x16x32_bf16 a[4:7], a[160:163], v[164:167], a[4:7]
  v_exp_f32 v217, v153
  v_mfma_f32_16x16x32_bf16 a[64:67], a[160:163], v[176:179], a[64:67]
  buffer_load_dwordx4 v2, s[44:47], s26 offen offset:1024 sc1 lds
  v_add_f32 v226, v226, v221
  v_mfma_f32_16x16x32_bf16 a[68:71], a[160:163], v[180:183], a[68:71]
  v_exp_f32 v218, v154
  v_mfma_f32_16x16x32_bf16 a[8:11], a[164:167], v[160:163], a[8:11]
  ds_read_b128 a[132:135], v3 offset:1024
  v_cvt_pk_bf16_f32 v186, v220, v221
  v_mfma_f32_16x16x32_bf16 a[12:15], a[164:167], v[164:167], a[12:15]
  v_exp_f32 v219, v155
  v_mfma_f32_16x16x32_bf16 a[72:75], a[164:167], v[176:179], a[72:75]
  v_exp_f32 v220, v156
  v_mfma_f32_16x16x32_bf16 a[76:79], a[164:167], v[180:183], a[76:79]
  v_add_f32 v226, v226, v222
  v_add_f32 v226, v226, v223
  v_mfma_f32_16x16x32_bf16 a[16:19], a[168:171], v[160:163], a[16:19]
  ds_read_b128 a[136:139], v3 offset:2048
  v_cvt_pk_bf16_f32 v187, v222, v223
  v_mfma_f32_16x16x32_bf16 a[20:23], a[168:171], v[164:167], a[20:23]
  v_exp_f32 v221, v157
  v_mfma_f32_16x16x32_bf16 a[80:83], a[168:171], v[176:179], a[80:83]
  v_exp_f32 v222, v158
  v_mfma_f32_16x16x32_bf16 a[84:87], a[168:171], v[180:183], a[84:87]
  v_exp_f32 v223, v159
  v_mfma_f32_16x16x32_bf16 a[24:27], a[172:175], v[160:163], a[24:27]
  ds_read_b128 a[140:143], v3 offset:3072
  v_add_f32 v227, v216, v217
  v_mfma_f32_16x16x32_bf16 a[28:31], a[172:175], v[164:167], a[28:31]
  v_cvt_pk_bf16_f32 v188, v216, v217
  v_add_f32 v227, v227, v218
  v_mfma_f32_16x16x32_bf16 a[88:91], a[172:175], v[176:179], a[88:91]
  buffer_load_dwordx4 v2, s[44:47], s26 offen offset:2048 sc1 lds
  v_add_f32 v227, v227, v219
  v_mfma_f32_16x16x32_bf16 a[92:95], a[172:175], v[180:183], a[92:95]
  s_waitcnt lgkmcnt(4)
  v_cvt_pk_bf16_f32 v189, v218, v219
  v_add_f32 v227, v227, v220
  v_mfma_f32_16x16x32_bf16 a[32:35], a[176:179], v[160:163], a[32:35]
  ds_read_b128 a[144:147], v3 offset:4096
  v_add_f32 v227, v227, v221
  v_mfma_f32_16x16x32_bf16 a[36:39], a[176:179], v[164:167], a[36:39]
  v_cvt_pk_bf16_f32 v190, v220, v221
  v_add_f32 v227, v227, v222
  v_mfma_f32_16x16x32_bf16 a[96:99], a[176:179], v[176:179], a[96:99]
  v_add_f32 v227, v227, v223
  v_cvt_pk_bf16_f32 v191, v222, v223
  v_mfma_f32_16x16x32_bf16 a[100:103], a[176:179], v[180:183], a[100:103]
  v_max_f32 v5, v226, v227
  v_cmp_lt_f32 vcc, s81, v5
  v_mfma_f32_16x16x32_bf16 a[40:43], a[180:183], v[160:163], a[40:43]
  ds_read_b128 a[148:151], v3 offset:5120
  v_mfma_f32_16x16x32_bf16 a[44:47], a[180:183], v[164:167], a[44:47]
  v_mfma_f32_16x16x32_bf16 a[104:107], a[180:183], v[176:179], a[104:107]
  v_mfma_f32_16x16x32_bf16 a[108:111], a[180:183], v[180:183], a[108:111]
  v_mfma_f32_16x16x32_bf16 a[48:51], a[184:187], v[160:163], a[48:51]
  ds_read_b128 a[152:155], v3 offset:6144
  v_mfma_f32_16x16x32_bf16 a[52:55], a[184:187], v[164:167], a[52:55]
  v_mfma_f32_16x16x32_bf16 a[112:115], a[184:187], v[176:179], a[112:115]
  buffer_load_dwordx4 v2, s[44:47], s26 offen offset:3072 sc1 lds
  v_mfma_f32_16x16x32_bf16 a[116:119], a[184:187], v[180:183], a[116:119]
  s_add_u32 s26, s26, 16384
  v_mfma_f32_16x16x32_bf16 a[56:59], a[188:191], v[160:163], a[56:59]
  s_add_u32 s24, s24, 32768
  ds_read_b128 a[156:159], v3 offset:7168
  v_mfma_f32_16x16x32_bf16 a[60:63], a[188:191], v[164:167], a[60:63]
  s_and_b32 s24, s24, 0x1ffff
  v_mfma_f32_16x16x32_bf16 a[120:123], a[188:191], v[176:179], a[120:123]
  s_waitcnt lgkmcnt(4)
  v_mfma_f32_16x16x32_bf16 a[124:127], a[188:191], v[180:183], a[124:127]
  s_cbranch_vccnz fa_stub6
fa_back6:
  v_add_f32 v230, v230, v226
  v_add_f32 v231, v231, v227
  v_mfma_f32_16x16x32_bf16 v[144:147], a[128:131], v[64:67], v[200:203]
  ds_read_b128 a[160:163], v3 offset:24576
  v_exp_f32 v216, v128
  v_mfma_f32_16x16x32_bf16 v[152:155], a[128:131], v[68:71], v[204:207]
  v_exp_f32 v217, v129
  v_mfma_f32_16x16x32_bf16 v[148:151], a[132:135], v[64:67], v[200:203]
  ds_read_b128 a[164:167], v3 offset:25600
  v_add_f32 v226, v216, v217
  v_mfma_f32_16x16x32_bf16 v[156:159], a[132:135], v[68:71], v[204:207]
  s_mov_b32 m0, s25
  v_exp_f32 v218, v130
  v_cvt_pk_bf16_f32 v176, v216, v217
  v_mfma_f32_16x16x32_bf16 v[144:147], a[136:139], v[72:75], v[144:147]
  ds_read_b128 a[168:171], v3 offset:26624
  buffer_load_dwordx4 v2, s[48:51], s27 offen offset:0 sc1 lds
  v_mfma_f32_16x16x32_bf16 v[152:155], a[136:139], v[76:79], v[152:155]
  v_exp_f32 v219, v131
  v_add_f32 v226, v226, v218
  v_mfma_f32_16x16x32_bf16 v[148:151], a[140:143], v[72:75], v[148:151]
  ds_read_b128 a[172:175], v3 offset:27648
  v_add_f32 v226, v226, v219
  v_mfma_f32_16x16x32_bf16 v[156:159], a[140:143], v[76:79], v[156:159]
  s_waitcnt lgkmcnt(4)
  v_exp_f32 v220, v132
  v_cvt_pk_bf16_f32 v177, v218, v219
  v_mfma_f32_16x16x32_bf16 v[144:147], a[144:147], v[80:83], v[144:147]
  ds_read_b128 a[176:179], v3 offset:28672
  v_add_f32 v226, v226, v220
  v_mfma_f32_16x16x32_bf16 v[152:155], a[144:147], v[84:87], v[152:155]
  v_exp_f32 v221, v133
  v_exp_f32 v222, v134
  v_mfma_f32_16x16x32_bf16 v[148:151], a[148:151], v[80:83], v[148:151]
  ds_read_b128 a[180:183], v3 offset:29696
  buffer_load_dwordx4 v2, s[48:51], s27 offen offset:1024 sc1 lds
  v_mfma_f32_16x16x32_bf16 v[156:159], a[148:151], v[84:87], v[156:159]
  v_exp_f32 v223, v135
  v_mfma_f32_16x16x32_bf16 v[144:147], a[152:155], v[88:91], v[144:147]
  ds_read_b128 a[184:187], v3 offset:30720
  v_add_f32 v226, v226, v221
  v_mfma_f32_16x16x32_bf16 v[152:155], a[152:155], v[92:95], v[152:155]
  v_exp_f32 v216, v136
  v_mfma_f32_16x16x32_bf16 v[148:151], a[156:159], v[88:91], v[148:151]
  ds_read_b128 a[188:191], v3 offset:31744
  v_cvt_pk_bf16_f32 v178, v220, v221
  v_add_f32 v226, v226, v222
  v_mfma_f32_16x16x32_bf16 v[156:159], a[156:159], v[92:95], v[156:159]
  s_waitcnt lgkmcnt(4)
  v_exp_f32 v217, v137
  v_mfma_f32_16x16x32_bf16 a[64:67], a[160:163], v[184:187], a[64:67]
  ds_read_b128 a[128:131], v3 offset:8192
  v_add_f32 v226, v226, v223
  v_cvt_pk_bf16_f32 v179, v222, v223
  v_mfma_f32_16x16x32_bf16 a[68:71], a[160:163], v[188:191], a[68:71]
  v_exp_f32 v218, v138
  v_mfma_f32_16x16x32_bf16 a[72:75], a[164:167], v[184:187], a[72:75]
  ds_read_b128 a[132:135], v3 offset:9216
  buffer_load_dwordx4 v2, s[48:51], s27 offen offset:2048 sc1 lds
  v_add_f32 v227, v216, v217
  v_mfma_f32_16x16x32_bf16 a[76:79], a[164:167], v[188:191], a[76:79]
  v_exp_f32 v219, v139
  v_mfma_f32_16x16x32_bf16 a[80:83], a[168:171], v[184:187], a[80:83]
  ds_read_b128 a[136:139], v3 offset:10240
  v_cvt_pk_bf16_f32 v180, v216, v217
  v_mfma_f32_16x16x32_bf16 a[84:87], a[168:171], v[188:191], a[84:87]
  v_exp_f32 v220, v140
  v_add_f32 v227, v227, v218
  v_mfma_f32_16x16x32_bf16 a[88:91], a[172:175], v[184:187], a[88:91]
  ds_read_b128 a[140:143], v3 offset:11264
  v_add_f32 v227, v227, v219
  v_mfma_f32_16x16x32_bf16 a[92:95], a[172:175], v[188:191], a[92:95]
  s_waitcnt lgkmcnt(4)
  v_exp_f32 v221, v141
  v_cvt_pk_bf16_f32 v181, v218, v219
  v_mfma_f32_16x16x32_bf16 a[96:99], a[176:179], v[184:187], a[96:99]
  ds_read_b128 a[144:147], v3 offset:12288
  buffer_load_dwordx4 v2, s[48:51], s27 offen offset:3072 sc1 lds
  v_mfma_f32_16x16x32_bf16 a[100:103], a[176:179], v[188:191], a[100:103]
  s_add_u32 s27, s27, 16384
  v_exp_f32 v222, v142
  v_add_f32 v227, v227, v220
  v_mfma_f32_16x16x32_bf16 a[104:107], a[180:183], v[184:187], a[104:107]
  s_add_u32 s25, s25, 32768
  ds_read_b128 a[148:151], v3 offset:13312
  v_add_f32 v227, v227, v221
  v_mfma_f32_16x16x32_bf16 a[108:111], a[180:183], v[188:191], a[108:111]
  s_and_b32 s25, s25, 0x1ffff
  v_exp_f32 v223, v143
  v_cvt_pk_bf16_f32 v182, v220, v221
  v_mfma_f32_16x16x32_bf16 a[112:115], a[184:187], v[184:187], a[112:115]
  ds_read_b128 a[152:155], v3 offset:14336
  v_add_f32 v227, v227, v222
  v_mfma_f32_16x16x32_bf16 a[116:119], a[184:187], v[188:191], a[116:119]
  v_add_f32 v227, v227, v223
  v_cvt_pk_bf16_f32 v183, v222, v223
  v_max_f32 v5, v226, v227
  v_mfma_f32_16x16x32_bf16 a[120:123], a[188:191], v[184:187], a[120:123]
  s_waitcnt lgkmcnt(3)
  ds_read_b128 a[156:159], v3 offset:15360
  v_cmp_lt_f32 vcc, s81, v5
  v_mfma_f32_16x16x32_bf16 a[124:127], a[188:191], v[188:191], a[124:127]
  s_cbranch_vccnz fa_stub7
fa_back7:
  v_add_f32 v230, v230, v226
  v_add_f32 v231, v231, v227
  v_add_u32 v3, 32768, v3
  v_and_b32 v3, 0x1ffff, v3
  s_branch fa_SSpre
fa_Aodd:
  v_mfma_f32_16x16x32_bf16 v[128:131], a[128:131], v[64:67], v[200:203]
  s_waitcnt vmcnt(12)
  v_cndmask_b32 v112, v4, v112, s[68:69]
  v_cndmask_b32 v113, v4, v113, s[70:71]
  v_cndmask_b32 v114, v4, v114, s[72:73]
  v_mfma_f32_16x16x32_bf16 v[136:139], a[128:131], v[68:71], v[204:207]
  s_barrier
  v_cndmask_b32 v115, v4, v115, s[74:75]
  v_mov_b32 v116, v4
  v_mov_b32 v117, v4
  v_mfma_f32_16x16x32_bf16 v[132:135], a[132:135], v[64:67], v[200:203]
  ds_read_b128 a[160:163], v3 offset:16384
  ds_read_b128 a[164:167], v3 offset:17408
  v_mov_b32 v118, v4
  v_mfma_f32_16x16x32_bf16 v[140:143], a[132:135], v[68:71], v[204:207]
  v_mov_b32 v119, v4
  v_cndmask_b32 v124, v4, v124, s[68:69]
  v_cndmask_b32 v125, v4, v125, s[70:71]
  v_mfma_f32_16x16x32_bf16 v[128:131], a[136:139], v[72:75], v[128:131]
  ds_read_b128 a[168:171], v3 offset:18432
  v_cndmask_b32 v126, v4, v126, s[72:73]
  v_cndmask_b32 v127, v4, v127, s[74:75]
  v_mfma_f32_16x16x32_bf16 v[136:139], a[136:139], v[76:79], v[136:139]
  s_mov_b32 m0, s24
  v_exp_f32 v208, v112
  v_exp_f32 v209, v113
  v_mfma_f32_16x16x32_bf16 v[132:135], a[140:143], v[72:75], v[132:135]
  ds_read_b128 a[172:175], v3 offset:19456
  buffer_load_dwordx4 v2, s[44:47], s26 offen offset:0 sc1 lds
  v_mfma_f32_16x16x32_bf16 v[140:143], a[140:143], v[76:79], v[140:143]
  s_waitcnt lgkmcnt(4)
  v_exp_f32 v210, v114
  v_add_f32 v224, v208, v209
  v_mfma_f32_16x16x32_bf16 v[128:131], a[144:147], v[80:83], v[128:131]
  ds_read_b128 a[176:179], v3 offset:20480
  v_exp_f32 v211, v115
  v_mfma_f32_16x16x32_bf16 v[136:139], a[144:147], v[84:87], v[136:139]
  v_exp_f32 v212, v116
  v_cvt_pk_bf16_f32 v168, v208, v209
  v_mfma_f32_16x16x32_bf16 v[132:135], a[148:151], v[80:83], v[132:135]
  ds_read_b128 a[180:183], v3 offset:21504
  v_exp_f32 v213, v117
  v_mfma_f32_16x16x32_bf16 v[140:143], a[148:151], v[84:87], v[140:143]
  v_exp_f32 v214, v118
  v_add_f32 v224, v224, v210
  v_add_f32 v224, v224, v211
  v_mfma_f32_16x16x32_bf16 v[128:131], a[152:155], v[88:91], v[128:131]
  ds_read_b128 a[184:187], v3 offset:22528
  v_cvt_pk_bf16_f32 v169, v210, v211
  v_add_f32 v224, v224, v212
  v_mfma_f32_16x16x32_bf16 v[136:139], a[152:155], v[92:95], v[136:139]
  v_exp_f32 v215, v119
  v_add_f32 v224, v224, v213
  v_mfma_f32_16x16x32_bf16 v[132:135], a[156:159], v[88:91], v[132:135]
  ds_read_b128 a[188:191], v3 offset:23552
  v_cvt_pk_bf16_f32 v170, v212, v213
  v_add_f32 v224, v224, v214
  v_mfma_f32_16x16x32_bf16 v[140:143], a[156:159], v[92:95], v[140:143]
  s_waitcnt lgkmcnt(4)
  v_exp_f32 v208, v120
  v_add_f32 v224, v224, v215
  v_mfma_f32_16x16x32_bf16 a[0:3], a[160:163], v[160:163], a[0:3]
  ds_read_b128 a[128:131], v3 offset:0
  v_cvt_pk_bf16_f32 v171, v214, v215
  v_exp_f32 v209, v121
  v_mfma_f32_16x16x32_bf16 a[4:7], a[160:163], v[164:167], a[4:7]
  v_exp_f32 v210, v122
  v_mfma_f32_16x16x32_bf16 a[64:67], a[160:163], v[176:179], a[64:67]
  buffer_load_dwordx4 v2, s[44:47], s26 offen offset:1024 sc1 lds
  v_exp_f32 v211, v123
  v_mfma_f32_16x16x32_bf16 a[68:71], a[160:163], v[180:183], a[68:71]
  v_exp_f32 v212, v124
  v_add_f32 v225, v208, v209
  v_mfma_f32_16x16x32_bf16 a[8:11], a[164:167], v[160:163], a[8:11]
  ds_read_b128 a[132:135], v3 offset:1024
  v_exp_f32 v213, v125
  v_mfma_f32_16x16x32_bf16 a[12:15], a[164:167], v[164:167], a[12:15]
  v_exp_f32 v214, v126
  v_cvt_pk_bf16_f32 v172, v208, v209
  v_mfma_f32_16x16x32_bf16 a[72:75], a[164:167], v[176:179], a[72:75]
  v_exp_f32 v215, v127
  v_add_f32 v225, v225, v210
  v_mfma_f32_16x16x32_bf16 a[76:79], a[164:167], v[180:183], a[76:79]
  v_exp_f32 v216, v144
  v_add_f32 v225, v225, v211
  v_mfma_f32_16x16x32_bf16 a[16:19], a[168:171], v[160:163], a[16:19]
  ds_read_b128 a[136:139], v3 offset:2048
  v_exp_f32 v217, v145
  v_mfma_f32_16x16x32_bf16 a[20:23], a[168:171], v[164:167], a[20:23]
  v_exp_f32 v218, v146
  v_cvt_pk_bf16_f32 v173, v210, v211
  v_mfma_f32_16x16x32_bf16 a[80:83], a[168:171], v[176:179], a[80:83]
  v_exp_f32 v219, v147
  v_add_f32 v225, v225, v212
  v_mfma_f32_16x16x32_bf16 a[84:87], a[168:171], v[180:183], a[84:87]
  v_exp_f32 v220, v148
  v_add_f32 v225, v225, v213
  v_mfma_f32_16x16x32_bf16 a[24:27], a[172:175], v[160:163], a[24:27]
  ds_read_b128 a[140:143], v3 offset:3072
  v_exp_f32 v221, v149
  v_mfma_f32_16x16x32_bf16 a[28:31], a[172:175], v[164:167], a[28:31]
  v_exp_f32 v222, v150
  v_cvt_pk_bf16_f32 v174, v212, v213
  v_mfma_f32_16x16x32_bf16 a[88:91], a[172:175], v[176:179], a[88:91]
  buffer_load_dwordx4 v2, s[44:47], s26 offen offset:2048 sc1 lds
  v_exp_f32 v223, v151
  v_mfma_f32_16x16x32_bf16 a[92:95], a[172:175], v[180:183], a[92:95]
  s_waitcnt lgkmcnt(4)
  v_add_f32 v225, v225, v214
  v_add_f32 v225, v225, v215
  v_cvt_pk_bf16_f32 v175, v214, v215
  v_mfma_f32_16x16x32_bf16 a[32:35], a[176:179], v[160:163], a[32:35]
  ds_read_b128 a[144:147], v3 offset:4096
  v_add_f32 v226, v216, v217
  v_cvt_pk_bf16_f32 v184, v216, v217
  v_mfma_f32_16x16x32_bf16 a[36:39], a[176:179], v[164:167], a[36:39]
  v_exp_f32 v216, v152
  v_add_f32 v226, v226, v218
  v_mfma_f32_16x16x32_bf16 a[96:99], a[176:179], v[176:179], a[96:99]
  v_exp_f32 v217, v153
  v_add_f32 v226, v226, v219
  v_mfma_f32_16x16x32_bf16 a[100:103], a[176:179], v[180:183], a[100:103]
  v_cvt_pk_bf16_f32 v185, v218, v219
  v_add_f32 v226, v226, v220
  v_add_f32 v226, v226, v221
  v_cvt_pk_bf16_f32 v186, v220, v221
  v_mfma_f32_16x16x32_bf16 a[40:43], a[180:183], v[160:163], a[40:43]
  ds_read_b128 a[148:151], v3 offset:5120
  v_add_f32 v226, v226, v222
  v_add_f32 v226, v226, v223
  v_mfma_f32_16x16x32_bf16 a[44:47], a[180:183], v[164:167], a[44:47]
  v_exp_f32 v218, v154
  v_cvt_pk_bf16_f32 v187, v222, v223
  v_mfma_f32_16x16x32_bf16 a[104:107], a[180:183], v[176:179], a[104:107]
  v_exp_f32 v219, v155
  v_add_f32 v227, v216, v217
  v_mfma_f32_16x16x32_bf16 a[108:111], a[180:183], v[180:183], a[108:111]
  v_exp_f32 v220, v156
  v_cvt_pk_bf16_f32 v188, v216, v217
  v_mfma_f32_16x16x32_bf16 a[48:51], a[184:187], v[160:163], a[48:51]
  ds_read_b128 a[152:155], v3 offset:6144
  v_add_f32 v227, v227, v218
  v_add_f32 v227, v227, v219
  v_mfma_f32_16x16x32_bf16 a[52:55], a[184:187], v[164:167], a[52:55]
  v_exp_f32 v221, v157
  v_cvt_pk_bf16_f32 v189, v218, v219
  v_mfma_f32_16x16x32_bf16 a[112:115], a[184:187], v[176:179], a[112:115]
  buffer_load_dwordx4 v2, s[44:47], s26 offen offset:3072 sc1 lds
  v_max3_f32 v5, v224, v225, v226
  v_add_f32 v227, v227, v220
  v_mfma_f32_16x16x32_bf16 a[116:119], a[184:187], v[180:183], a[116:119]
  s_add_u32 s26, s26, 16384
  v_exp_f32 v222, v158
  v_add_f32 v227, v227, v221
  v_mfma_f32_16x16x32_bf16 a[56:59], a[188:191], v[160:163], a[56:59]
  s_add_u32 s24, s24, 32768
  ds_read_b128 a[156:159], v3 offset:7168
  v_cvt_pk_bf16_f32 v190, v220, v221
  v_add_f32 v227, v227, v222
  v_mfma_f32_16x16x32_bf16 a[60:63], a[188:191], v[164:167], a[60:63]
  s_and_b32 s24, s24, 0x1ffff
  v_exp_f32 v223, v159
  v_mfma_f32_16x16x32_bf16 a[120:123], a[188:191], v[176:179], a[120:123]
  s_waitcnt lgkmcnt(4)
  v_add_f32 v227, v227, v223
  v_cvt_pk_bf16_f32 v191, v222, v223
  v_max_f32 v5, v5, v227
  v_cmp_lt_f32 vcc, s81, v5
  v_mfma_f32_16x16x32_bf16 a[124:127], a[188:191], v[180:183], a[124:127]
  s_cbranch_vccnz fa_stub8
fa_back8:
  v_add_f32 v228, v228, v224
  v_add_f32 v229, v229, v225
  v_add_f32 v230, v230, v226
  v_add_f32 v231, v231, v227
  v_mfma_f32_16x16x32_bf16 v[144:147], a[128:131], v[64:67], v[200:203]
  ds_read_b128 a[160:163], v3 offset:24576
  v_exp_f32 v216, v128
  v_mfma_f32_16x16x32_bf16 v[152:155], a[128:131], v[68:71], v[204:207]
  v_exp_f32 v217, v129
  v_mfma_f32_16x16x32_bf16 v[148:151], a[132:135], v[64:67], v[200:203]
  ds_read_b128 a[164:167], v3 offset:25600
  v_mfma_f32_16x16x32_bf16 v[156:159], a[132:135], v[68:71], v[204:207]
  v_exp_f32 v218, v130
  v_mfma_f32_16x16x32_bf16 v[144:147], a[136:139], v[72:75], v[144:147]
  ds_read_b128 a[168:171], v3 offset:26624
  v_add_f32 v226, v216, v217
  v_mfma_f32_16x16x32_bf16 v[152:155], a[136:139], v[76:79], v[152:155]
  s_mov_b32 m0, s25
  v_exp_f32 v219, v131
  v_mfma_f32_16x16x32_bf16 v[148:151], a[140:143], v[72:75], v[148:151]
  ds_read_b128 a[172:175], v3 offset:27648
  buffer_load_dwordx4 v2, s[48:51], s27 offen offset:0 sc1 lds
  v_mfma_f32_16x16x32_bf16 v[156:159], a[140:143], v[76:79], v[156:159]
  s_waitcnt lgkmcnt(4)
  v_exp_f32 v220, v132
  v_mfma_f32_16x16x32_bf16 v[144:147], a[144:147], v[80:83], v[144:147]
  ds_read_b128 a[176:179], v3 offset:28672
  v_cvt_pk_bf16_f32 v176, v216, v217
  v_mfma_f32_16x16x32_bf16 v[152:155], a[144:147], v[84:87], v[152:155]
  v_exp_f32 v221, v133
  v_mfma_f32_16x16x32_bf16 v[148:151], a[148:151], v[80:83], v[148:151]
  ds_read_b128 a[180:183], v3 offset:29696
  v_add_f32 v226, v226, v218
  v_mfma_f32_16x16x32_bf16 v[156:159], a[148:151], v[84:87], v[156:159]
  v_exp_f32 v222, v134
  v_mfma_f32_16x16x32_bf16 v[144:147], a[152:155], v[88:91], v[144:147]
  ds_read_b128 a[184:187], v3 offset:30720
  v_add_f32 v226, v226, v219
  v_mfma_f32_16x16x32_bf16 v[152:155], a[152:155], v[92:95], v[152:155]
  v_exp_f32 v223, v135
  v_mfma_f32_16x16x32_bf16 v[148:151], a[156:159], v[88:91], v[148:151]
  ds_read_b128 a[188:191], v3 offset:31744
  v_cvt_pk_bf16_f32 v177, v218, v219
  v_mfma_f32_16x16x32_bf16 v[156:159], a[156:159], v[92:95], v[156:159]
  s_waitcnt lgkmcnt(4)
  v_exp_f32 v216, v136
  v_mfma_f32_16x16x32_bf16 a[0:3], a[160:163], v[168:171], a[0:3]
  ds_read_b128 a[128:131], v3 offset:8192
  v_add_f32 v226, v226, v220
  v_mfma_f32_16x16x32_bf16 a[4:7], a[160:163], v[172:175], a[4:7]
  v_exp_f32 v217, v137
  v_mfma_f32_16x16x32_bf16 a[64:67], a[160:163], v[184:187], a[64:67]
  buffer_load_dwordx4 v2, s[48:51], s27 offen offset:1024 sc1 lds
  v_add_f32 v226, v226, v221
  v_mfma_f32_16x16x32_bf16 a[68:71], a[160:163], v[188:191], a[68:71]
  v_exp_f32 v218, v138
  v_mfma_f32_16x16x32_bf16 a[8:11], a[164:167], v[168:171], a[8:11]
  ds_read_b128 a[132:135], v3 offset:9216
  v_cvt_pk_bf16_f32 v178, v220, v221
  v_mfma_f32_16x16x32_bf16 a[12:15], a[164:167], v[172:175], a[12:15]
  v_exp_f32 v219, v139
  v_mfma_f32_16x16x32_bf16 a[72:75], a[164:167], v[184:187], a[72:75]
  v_exp_f32 v220, v140
  v_mfma_f32_16x16x32_bf16 a[76:79], a[164:167], v[188:191], a[76:79]
  v_add_f32 v226, v226, v222
  v_add_f32 v226, v226, v223
  v_mfma_f32_16x16x32_bf16 a[16:19], a[168:171], v[168:171], a[16:19]
  ds_read_b128 a[136:139], v3 offset:10240
  v_cvt_pk_bf16_f32 v179, v222, v223
  v_mfma_f32_16x16x32_bf16 a[20:23], a[168:171], v[172:175], a[20:23]
  v_exp_f32 v221, v141
  v_mfma_f32_16x16x32_bf16 a[80:83], a[168:171], v[184:187], a[80:83]
  v_exp_f32 v222, v142
  v_mfma_f32_16x16x32_bf16 a[84:87], a[168:171], v[188:191], a[84:87]
  v_exp_f32 v223, v143
  v_mfma_f32_16x16x32_bf16 a[24:27], a[172:175], v[168:171], a[24:27]
  ds_read_b128 a[140:143], v3 offset:11264
  v_add_f32 v227, v216, v217
  v_mfma_f32_16x16x32_bf16 a[28:31], a[172:175], v[172:175], a[28:31]
  v_cvt_pk_bf16_f32 v180, v216, v217
  v_add_f32 v227, v227, v218
  v_mfma_f32_16x16x32_bf16 a[88:91], a[172:175], v[184:187], a[88:91]
  buffer_load_dwordx4 v2, s[48:51], s27 offen offset:2048 sc1 lds
  v_add_f32 v227, v227, v219
  v_mfma_f32_16x16x32_bf16 a[92:95], a[172:175], v[188:191], a[92:95]
  s_waitcnt lgkmcnt(4)
  v_cvt_pk_bf16_f32 v181, v218, v219
  v_add_f32 v227, v227, v220
  v_mfma_f32_16x16x32_bf16 a[32:35], a[176:179], v[168:171], a[32:35]
  ds_read_b128 a[144:147], v3 offset:12288
  v_add_f32 v227, v227, v221
  v_mfma_f32_16x16x32_bf16 a[36:39], a[176:179], v[172:175], a[36:39]
  v_cvt_pk_bf16_f32 v182, v220, v221
  v_add_f32 v227, v227, v222
  v_mfma_f32_16x16x32_bf16 a[96:99], a[176:179], v[184:187], a[96:99]
  v_add_f32 v227, v227, v223
  v_cvt_pk_bf16_f32 v183, v222, v223
  v_mfma_f32_16x16x32_bf16 a[100:103], a[176:179], v[188:191], a[100:103]
  v_max_f32 v5, v226, v227
  v_cmp_lt_f32 vcc, s81, v5
  v_mfma_f32_16x16x32_bf16 a[40:43], a[180:183], v[168:171], a[40:43]
  ds_read_b128 a[148:151], v3 offset:13312
  v_mfma_f32_16x16x32_bf16 a[44:47], a[180:183], v[172:175], a[44:47]
  v_mfma_f32_16x16x32_bf16 a[104:107], a[180:183], v[184:187], a[104:107]
  v_mfma_f32_16x16x32_bf16 a[108:111], a[180:183], v[188:191], a[108:111]
  v_mfma_f32_16x16x32_bf16 a[48:51], a[184:187], v[168:171], a[48:51]
  ds_read_b128 a[152:155], v3 offset:14336
  v_mfma_f32_16x16x32_bf16 a[52:55], a[184:187], v[172:175], a[52:55]
  v_mfma_f32_16x16x32_bf16 a[112:115], a[184:187], v[184:187], a[112:115]
  buffer_load_dwordx4 v2, s[48:51], s27 offen offset:3072 sc1 lds
  v_mfma_f32_16x16x32_bf16 a[116:119], a[184:187], v[188:191], a[116:119]
  s_add_u32 s27, s27, 16384
  v_mfma_f32_16x16x32_bf16 a[56:59], a[188:191], v[168:171], a[56:59]
  s_add_u32 s25, s25, 32768
  ds_read_b128 a[156:159], v3 offset:15360
  v_mfma_f32_16x16x32_bf16 a[60:63], a[188:191], v[172:175], a[60:63]
  s_and_b32 s25, s25, 0x1ffff
  v_mfma_f32_16x16x32_bf16 a[120:123], a[188:191], v[184:187], a[120:123]
  s_waitcnt lgkmcnt(4)
  v_mfma_f32_16x16x32_bf16 a[124:127], a[188:191], v[188:191], a[124:127]
  s_cbranch_vccnz fa_stub9
fa_back9:
  v_add_f32 v230, v230, v226
  v_add_f32 v231, v231, v227
  v_add_u32 v3, 32768, v3
  v_and_b32 v3, 0x1ffff, v3
fa_SSpre:
  s_mov_b32 s11, 1
  s_cmp_lg_u32 s12, 0
  s_cselect_b32 s32, s15, s32
  s_cmp_le_u32 s29, 8
  s_cbranch_scc1 fa_chain
.p2align 6
fa_SS:
  v_mfma_f32_16x16x32_bf16 v[128:131], a[128:131], v[64:67], v[200:203]
  s_waitcnt vmcnt(12)
  v_exp_f32 v216, v144
  v_mfma_f32_16x16x32_bf16 v[136:139], a[128:131], v[68:71], v[204:207]
  s_barrier
  v_exp_f32 v217, v145
  v_exp_f32 v218, v146
  v_mfma_f32_16x16x32_bf16 v[132:135], a[132:135], v[64:67], v[200:203]
  s_cmp_ge_u32 s26, s32
  ds_read_b128 a[160:163], v3 offset:16384
  ds_read_b128 a[164:167], v3 offset:17408
  v_mfma_f32_16x16x32_bf16 v[140:143], a[132:135], v[68:71], v[204:207]
  s_cbranch_scc1 fa_hk3
fa_hb3:
  s_mov_b32 m0, s24
  v_exp_f32 v219, v147
  v_mfma_f32_16x16x32_bf16 v[128:131], a[136:139], v[72:75], v[128:131]
  ds_read_b128 a[168:171], v3 offset:18432
  buffer_load_dwordx4 v2, s[44:47], s26 offen offset:0 sc1 lds
  v_mfma_f32_16x16x32_bf16 v[136:139], a[136:139], v[76:79], v[136:139]
  v_exp_f32 v220, v148
  v_add_f32 v226, v216, v217
  v_mfma_f32_16x16x32_bf16 v[132:135], a[140:143], v[72:75], v[132:135]
  ds_read_b128 a[172:175], v3 offset:19456
  v_cvt_pk_bf16_f32 v184, v216, v217
  v_mfma_f32_16x16x32_bf16 v[140:143], a[140:143], v[76:79], v[140:143]
  s_waitcnt lgkmcnt(4)
  v_exp_f32 v221, v149
  v_add_f32 v226, v226, v218
  v_mfma_f32_16x16x32_bf16 v[128:131], a[144:147], v[80:83], v[128:131]
  ds_read_b128 a[176:179], v3 offset:20480
  v_add_f32 v226, v226, v219
  v_mfma_f32_16x16x32_bf16 v[136:139], a[144:147], v[84:87], v[136:139]
  v_exp_f32 v222, v150
  v_cvt_pk_bf16_f32 v185, v218, v219
  v_mfma_f32_16x16x32_bf16 v[132:135], a[148:151], v[80:83], v[132:135]
  ds_read_b128 a[180:183], v3 offset:21504
  buffer_load_dwordx4 v2, s[44:47], s26 offen offset:1024 sc1 lds
  v_mfma_f32_16x16x32_bf16 v[140:143], a[148:151], v[84:87], v[140:143]
  v_exp_f32 v223, v151
  v_mfma_f32_16x16x32_bf16 v[128:131], a[152:155], v[88:91], v[128:131]
  ds_read_b128 a[184:187], v3 offset:22528
  v_add_f32 v226, v226, v220
  v_add_f32 v226, v226, v221
  v_mfma_f32_16x16x32_bf16 v[136:139], a[152:155], v[92:95], v[136:139]
  v_exp_f32 v216, v152
  v_mfma_f32_16x16x32_bf16 v[132:135], a[156:159], v[88:91], v[132:135]
  ds_read_b128 a[188:191], v3 offset:23552
  v_cvt_pk_bf16_f32 v186, v220, v221
  v_add_f32 v226, v226, v222
  v_mfma_f32_16x16x32_bf16 v[140:143], a[156:159], v[92:95], v[140:143]
  s_waitcnt lgkmcnt(4)
  v_exp_f32 v217, v153
  v_mfma_f32_16x16x32_bf16 a[64:67], a[160:163], v[176:179], a[64:67]
  ds_read_b128 a[128:131], v3 offset:0
  v_add_f32 v226, v226, v223
  v_cvt_pk_bf16_f32 v187, v222, v223
  v_mfma_f32_16x16x32_bf16 a[68:71], a[160:163], v[180:183], a[68:71]
  v_exp_f32 v218, v154
  v_mfma_f32_16x16x32_bf16 a[72:75], a[164:167], v[176:179], a[72:75]
  ds_read_b128 a[132:135], v3 offset:1024
  buffer_load_dwordx4 v2, s[44:47], s26 offen offset:2048 sc1 lds
  v_add_f32 v227, v216, v217
  v_mfma_f32_16x16x32_bf16 a[76:79], a[164:167], v[180:183], a[76:79]
  v_exp_f32 v219, v155
  v_mfma_f32_16x16x32_bf16 a[80:83], a[168:171], v[176:179], a[80:83]
  ds_read_b128 a[136:139], v3 offset:2048
  v_cvt_pk_bf16_f32 v188, v216, v217
  v_mfma_f32_16x16x32_bf16 a[84:87], a[168:171], v[180:183], a[84:87]
  v_exp_f32 v220, v156
  v_add_f32 v227, v227, v218
  v_mfma_f32_16x16x32_bf16 a[88:91], a[172:175], v[176:179], a[88:91]
  ds_read_b128 a[140:143], v3 offset:3072
  v_add_f32 v227, v227, v219
  v_mfma_f32_16x16x32_bf16 a[92:95], a[172:175], v[180:183], a[92:95]
  s_waitcnt lgkmcnt(4)
  v_exp_f32 v221, v157
  v_cvt_pk_bf16_f32 v189, v218, v219
  v_mfma_f32_16x16x32_bf16 a[96:99], a[176:179], v[176:179], a[96:99]
  ds_read_b128 a[144:147], v3 offset:4096
  buffer_load_dwordx4 v2, s[44:47], s26 offen offset:3072 sc1 lds
  v_mfma_f32_16x16x32_bf16 a[100:103], a[176:179], v[180:183], a[100:103]
  s_add_u32 s26, s26, 16384
  v_exp_f32 v222, v158
  v_add_f32 v227, v227, v220
  v_mfma_f32_16x16x32_bf16 a[104:107], a[180:183], v[176:179], a[104:107]
  s_add_u32 s24, s24, 32768
  ds_read_b128 a[148:151], v3 offset:5120
  v_add_f32 v227, v227, v221
  v_mfma_f32_16x16x32_bf16 a[108:111], a[180:183], v[180:183], a[108:111]
  s_and_b32 s24, s24, 0x1ffff
  v_exp_f32 v223, v159
  v_cvt_pk_bf16_f32 v190, v220, v221
  v_mfma_f32_16x16x32_bf16 a[112:115], a[184:187], v[176:179], a[112:115]
  ds_read_b128 a[152:155], v3 offset:6144
  v_add_f32 v227, v227, v222
  v_mfma_f32_16x16x32_bf16 a[116:119], a[184:187], v[180:183], a[116:119]
  v_add_f32 v227, v227, v223
  v_cvt_pk_bf16_f32 v191, v222, v223
  v_max_f32 v5, v226, v227
  v_mfma_f32_16x16x32_bf16 a[120:123], a[188:191], v[176:179], a[120:123]
  s_waitcnt lgkmcnt(3)
  ds_read_b128 a[156:159], v3 offset:7168
  v_cmp_lt_f32 vcc, s81, v5
  v_mfma_f32_16x16x32_bf16 a[124:127], a[188:191], v[180:183], a[124:127]
  s_cbranch_vccnz fa_stub10
fa_back10:
  v_add_f32 v230, v230, v226
  v_add_f32 v231, v231, v227
  v_mfma_f32_16x16x32_bf16 v[144:147], a[128:131], v[64:67], v[200:203]
  ds_read_b128 a[160:163], v3 offset:24576
  v_exp_f32 v216, v128
  v_mfma_f32_16x16x32_bf16 v[152:155], a[128:131], v[68:71], v[204:207]
  v_exp_f32 v217, v129
  v_mfma_f32_16x16x32_bf16 v[148:151], a[132:135], v[64:67], v[200:203]
  ds_read_b128 a[164:167], v3 offset:25600
  v_add_f32 v226, v216, v217
  v_mfma_f32_16x16x32_bf16 v[156:159], a[132:135], v[68:71], v[204:207]
  s_mov_b32 m0, s25
  v_exp_f32 v218, v130
  v_cvt_pk_bf16_f32 v176, v216, v217
  v_mfma_f32_16x16x32_bf16 v[144:147], a[136:139], v[72:75], v[144:147]
  ds_read_b128 a[168:171], v3 offset:26624
  buffer_load_dwordx4 v2, s[48:51], s27 offen offset:0 sc1 lds
  v_mfma_f32_16x16x32_bf16 v[152:155], a[136:139], v[76:79], v[152:155]
  v_exp_f32 v219, v131
  v_add_f32 v226, v226, v218
  v_mfma_f32_16x16x32_bf16 v[148:151], a[140:143], v[72:75], v[148:151]
  ds_read_b128 a[172:175], v3 offset:27648
  v_add_f32 v226, v226, v219
  v_mfma_f32_16x16x32_bf16 v[156:159], a[140:143], v[76:79], v[156:159]
  s_waitcnt lgkmcnt(4)
  v_exp_f32 v220, v132
  v_cvt_pk_bf16_f32 v177, v218, v219
  v_mfma_f32_16x16x32_bf16 v[144:147], a[144:147], v[80:83], v[144:147]
  ds_read_b128 a[176:179], v3 offset:28672
  v_add_f32 v226, v226, v220
  v_mfma_f32_16x16x32_bf16 v[152:155], a[144:147], v[84:87], v[152:155]
  v_exp_f32 v221, v133
  v_exp_f32 v222, v134
  v_mfma_f32_16x16x32_bf16 v[148:151], a[148:151], v[80:83], v[148:151]
  ds_read_b128 a[180:183], v3 offset:29696
  buffer_load_dwordx4 v2, s[48:51], s27 offen offset:1024 sc1 lds
  v_mfma_f32_16x16x32_bf16 v[156:159], a[148:151], v[84:87], v[156:159]
  v_exp_f32 v223, v135
  v_mfma_f32_16x16x32_bf16 v[144:147], a[152:155], v[88:91], v[144:147]
  ds_read_b128 a[184:187], v3 offset:30720
  v_add_f32 v226, v226, v221
  v_mfma_f32_16x16x32_bf16 v[152:155], a[152:155], v[92:95], v[152:155]
  v_exp_f32 v216, v136
  v_mfma_f32_16x16x32_bf16 v[148:151], a[156:159], v[88:91], v[148:151]
  ds_read_b128 a[188:191], v3 offset:31744
  v_cvt_pk_bf16_f32 v178, v220, v221
  v_add_f32 v226, v226, v222
  v_mfma_f32_16x16x32_bf16 v[156:159], a[156:159], v[92:95], v[156:159]
  s_waitcnt lgkmcnt(4)
  v_exp_f32 v217, v137
  v_mfma_f32_16x16x32_bf16 a[64:67], a[160:163], v[184:187], a[64:67]
  ds_read_b128 a[128:131], v3 offset:8192
  v_add_f32 v226, v226, v223
  v_cvt_pk_bf16_f32 v179, v222, v223
  v_mfma_f32_16x16x32_bf16 a[68:71], a[160:163], v[188:191], a[68:71]
  v_exp_f32 v218, v138
  v_mfma_f32_16x16x32_bf16 a[72:75], a[164:167], v[184:187], a[72:75]
  ds_read_b128 a[132:135], v3 offset:9216
  buffer_load_dwordx4 v2, s[48:51], s27 offen offset:2048 sc1 lds
  v_add_f32 v227, v216, v217
  v_mfma_f32_16x16x32_bf16 a[76:79], a[164:167], v[188:191], a[76:79]
  v_exp_f32 v219, v139
  v_mfma_f32_16x16x32_bf16 a[80:83], a[168:171], v[184:187], a[80:83]
  ds_read_b128 a[136:139], v3 offset:10240
  v_cvt_pk_bf16_f32 v180, v216, v217
  v_mfma_f32_16x16x32_bf16 a[84:87], a[168:171], v[188:191], a[84:87]
  v_exp_f32 v220, v140
  v_add_f32 v227, v227, v218
  v_mfma_f32_16x16x32_bf16 a[88:91], a[172:175], v[184:187], a[88:91]
  ds_read_b128 a[140:143], v3 offset:11264
  v_add_f32 v227, v227, v219
  v_mfma_f32_16x16x32_bf16 a[92:95], a[172:175], v[188:191], a[92:95]
  s_waitcnt lgkmcnt(4)
  v_exp_f32 v221, v141
  v_cvt_pk_bf16_f32 v181, v218, v219
  v_mfma_f32_16x16x32_bf16 a[96:99], a[176:179], v[184:187], a[96:99]
  ds_read_b128 a[144:147], v3 offset:12288
  buffer_load_dwordx4 v2, s[48:51], s27 offen offset:3072 sc1 lds
  v_mfma_f32_16x16x32_bf16 a[100:103], a[176:179], v[188:191], a[100:103]
  s_add_u32 s27, s27, 16384
  v_exp_f32 v222, v142
  v_add_f32 v227, v227, v220
  v_mfma_f32_16x16x32_bf16 a[104:107], a[180:183], v[184:187], a[104:107]
  s_add_u32 s25, s25, 32768
  ds_read_b128 a[148:151], v3 offset:13312
  v_add_f32 v227, v227, v221
  v_mfma_f32_16x16x32_bf16 a[108:111], a[180:183], v[188:191], a[108:111]
  s_and_b32 s25, s25, 0x1ffff
  v_exp_f32 v223, v143
  v_cvt_pk_bf16_f32 v182, v220, v221
  v_mfma_f32_16x16x32_bf16 a[112:115], a[184:187], v[184:187], a[112:115]
  ds_read_b128 a[152:155], v3 offset:14336
  v_add_f32 v227, v227, v222
  v_mfma_f32_16x16x32_bf16 a[116:119], a[184:187], v[188:191], a[116:119]
  s_sub_u32 s29, s29, 1
  v_add_f32 v227, v227, v223
  v_cvt_pk_bf16_f32 v183, v222, v223
  v_max_f32 v5, v226, v227
  v_mfma_f32_16x16x32_bf16 a[120:123], a[188:191], v[184:187], a[120:123]
  s_waitcnt lgkmcnt(3)
  ds_read_b128 a[156:159], v3 offset:15360
  v_cmp_lt_f32 vcc, s81, v5
  v_mfma_f32_16x16x32_bf16 a[124:127], a[188:191], v[188:191], a[124:127]
  s_cbranch_vccnz fa_stub11
fa_back11:
  v_add_f32 v230, v230, v226
  v_add_f32 v231, v231, v227
  v_add_u32 v3, 32768, v3
  v_and_b32 v3, 0x1ffff, v3
  s_cmp_gt_u32 s29, 8
  s_cbranch_scc1 fa_SS
fa_chain:
fa_hb4:
  s_cmp_lt_u32 s12, 2
  s_cbranch_scc1 fa_hk4
  s_cmp_eq_u32 s29, 8
  s_cbranch_scc0 fa_disp
fa_SSW8:
  v_mfma_f32_16x16x32_bf16 v[128:131], a[128:131], v[64:67], v[200:203]
  s_waitcnt vmcnt(12)
  v_exp_f32 v216, v144
  v_exp_f32 v217, v145
  v_mfma_f32_16x16x32_bf16 v[136:139], a[128:131], v[68:71], v[204:207]
  s_barrier
  v_exp_f32 v218, v146
  v_mfma_f32_16x16x32_bf16 v[132:135], a[132:135], v[64:67], v[200:203]
  ds_read_b128 a[160:163], v3 offset:16384
  ds_read_b128 a[164:167], v3 offset:17408
  v_mfma_f32_16x16x32_bf16 v[140:143], a[132:135], v[68:71], v[204:207]
  s_mov_b32 m0, s24
  v_exp_f32 v219, v147
  v_mfma_f32_16x16x32_bf16 v[128:131], a[136:139], v[72:75], v[128:131]
  ds_read_b128 a[168:171], v3 offset:18432
  buffer_load_dwordx4 v2, s[44:47], s26 offen offset:0 sc1 lds
  v_add_f32 v226, v216, v217
  v_mfma_f32_16x16x32_bf16 v[136:139], a[136:139], v[76:79], v[136:139]
  v_exp_f32 v220, v148
  v_mfma_f32_16x16x32_bf16 v[132:135], a[140:143], v[72:75], v[132:135]
  ds_read_b128 a[172:175], v3 offset:19456
  v_cvt_pk_bf16_f32 v184, v216, v217
  v_add_f32 v226, v226, v218
  v_mfma_f32_16x16x32_bf16 v[140:143], a[140:143], v[76:79], v[140:143]
  s_add_u32 s14, s13, 0
  s_waitcnt lgkmcnt(4)
  buffer_load_dwordx4 a[0:3], v2, s[40:43], s14 offen offset:0 sc1
  v_add_f32 v226, v226, v219
  v_mfma_f32_16x16x32_bf16 v[128:131], a[144:147], v[80:83], v[128:131]
  ds_read_b128 a[176:179], v3 offset:20480
  v_cvt_pk_bf16_f32 v185, v218, v219
  v_add_f32 v226, v226, v220
  v_mfma_f32_16x16x32_bf16 v[136:139], a[144:147], v[84:87], v[136:139]
  v_exp_f32 v221, v149
  v_mfma_f32_16x16x32_bf16 v[132:135], a[148:151], v[80:83], v[132:135]
  ds_read_b128 a[180:183], v3 offset:21504
  buffer_load_dwordx4 v2, s[44:47], s26 offen offset:1024 sc1 lds
  v_add_f32 v226, v226, v221
  v_mfma_f32_16x16x32_bf16 v[140:143], a[148:151], v[84:87], v[140:143]
  v_exp_f32 v222, v150
  v_cvt_pk_bf16_f32 v186, v220, v221
  v_mfma_f32_16x16x32_bf16 v[128:131], a[152:155], v[88:91], v[128:131]
  ds_read_b128 a[184:187], v3 offset:22528
  v_add_f32 v226, v226, v222
  v_mfma_f32_16x16x32_bf16 v[136:139], a[152:155], v[92:95], v[136:139]
  v_exp_f32 v223, v151
  v_exp_f32 v216, v152
  v_mfma_f32_16x16x32_bf16 v[132:135], a[156:159], v[88:91], v[132:135]
  ds_read_b128 a[188:191], v3 offset:23552
  buffer_load_dwordx4 a[4:7], v2, s[40:43], s14 offen offset:1024 sc1
  v_mfma_f32_16x16x32_bf16 v[140:143], a[156:159], v[92:95], v[140:143]
  s_waitcnt lgkmcnt(4)
  v_exp_f32 v217, v153
  v_mfma_f32_16x16x32_bf16 a[64:67], a[160:163], v[176:179], a[64:67]
  ds_read_b128 a[128:131], v3 offset:0
  v_add_f32 v226, v226, v223
  v_mfma_f32_16x16x32_bf16 a[68:71], a[160:163], v[180:183], a[68:71]
  v_exp_f32 v218, v154
  v_cvt_pk_bf16_f32 v187, v222, v223
  v_mfma_f32_16x16x32_bf16 a[72:75], a[164:167], v[176:179], a[72:75]
  ds_read_b128 a[132:135], v3 offset:1024
  buffer_load_dwordx4 v2, s[44:47], s26 offen offset:2048 sc1 lds
  v_mfma_f32_16x16x32_bf16 a[76:79], a[164:167], v[180:183], a[76:79]
  v_exp_f32 v219, v155
  v_add_f32 v227, v216, v217
  v_mfma_f32_16x16x32_bf16 a[80:83], a[168:171], v[176:179], a[80:83]
  ds_read_b128 a[136:139], v3 offset:2048
  v_cvt_pk_bf16_f32 v188, v216, v217
  v_add_f32 v227, v227, v218
  v_mfma_f32_16x16x32_bf16 a[84:87], a[168:171], v[180:183], a[84:87]
  buffer_load_dwordx4 a[8:11], v2, s[40:43], s14 offen offset:2048 sc1
  v_add_f32 v227, v227, v219
  v_mfma_f32_16x16x32_bf16 a[88:91], a[172:175], v[176:179], a[88:91]
  ds_read_b128 a[140:143], v3 offset:3072
  v_cvt_pk_bf16_f32 v189, v218, v219
  v_exp_f32 v220, v156
  v_mfma_f32_16x16x32_bf16 a[92:95], a[172:175], v[180:183], a[92:95]
  s_waitcnt lgkmcnt(4)
  v_exp_f32 v221, v157
  v_mfma_f32_16x16x32_bf16 a[96:99], a[176:179], v[176:179], a[96:99]
  ds_read_b128 a[144:147], v3 offset:4096
  buffer_load_dwordx4 v2, s[44:47], s26 offen offset:3072 sc1 lds
  v_mfma_f32_16x16x32_bf16 a[100:103], a[176:179], v[180:183], a[100:103]
  s_add_u32 s26, s26, 16384
  v_exp_f32 v222, v158
  v_mfma_f32_16x16x32_bf16 a[104:107], a[180:183], v[176:179], a[104:107]
  s_add_u32 s24, s24, 32768
  ds_read_b128 a[148:151], v3 offset:5120
  v_add_f32 v227, v227, v220
  v_add_f32 v227, v227, v221
  v_mfma_f32_16x16x32_bf16 a[108:111], a[180:183], v[180:183], a[108:111]
  s_and_b32 s24, s24, 0x1ffff
  v_exp_f32 v223, v159
  v_mfma_f32_16x16x32_bf16 a[112:115], a[184:187], v[176:179], a[112:115]
  ds_read_b128 a[152:155], v3 offset:6144
  v_cvt_pk_bf16_f32 v190, v220, v221
  v_add_f32 v227, v227, v222
  v_mfma_f32_16x16x32_bf16 a[116:119], a[184:187], v[180:183], a[116:119]
  v_add_f32 v227, v227, v223
  v_cvt_pk_bf16_f32 v191, v222, v223
  v_mfma_f32_16x16x32_bf16 a[120:123], a[188:191], v[176:179], a[120:123]
  s_waitcnt lgkmcnt(3)
  ds_read_b128 a[156:159], v3 offset:7168
  v_max_f32 v5, v226, v227
  v_cmp_lt_f32 vcc, s81, v5
  v_mfma_f32_16x16x32_bf16 a[124:127], a[188:191], v[180:183], a[124:127]
  s_cbranch_vccnz fa_stub12
fa_back12:
  v_add_f32 v230, v230, v226
  v_add_f32 v231, v231, v227
  v_mfma_f32_16x16x32_bf16 v[144:147], a[128:131], v[64:67], v[200:203]
  ds_read_b128 a[160:163], v3 offset:24576
  v_exp_f32 v216, v128
  v_mfma_f32_16x16x32_bf16 v[152:155], a[128:131], v[68:71], v[204:207]
  v_exp_f32 v217, v129
  v_mfma_f32_16x16x32_bf16 v[148:151], a[132:135], v[64:67], v[200:203]
  ds_read_b128 a[164:167], v3 offset:25600
  v_add_f32 v226, v216, v217
  v_cvt_pk_bf16_f32 v176, v216, v217
  v_mfma_f32_16x16x32_bf16 v[156:159], a[132:135], v[68:71], v[204:207]
  s_mov_b32 m0, s25
  v_exp_f32 v218, v130
  v_mfma_f32_16x16x32_bf16 v[144:147], a[136:139], v[72:75], v[144:147]
  ds_read_b128 a[168:171], v3 offset:26624
  buffer_load_dwordx4 v2, s[48:51], s27 offen offset:0 sc1 lds
  v_add_f32 v226, v226, v218
  v_mfma_f32_16x16x32_bf16 v[152:155], a[136:139], v[76:79], v[152:155]
  v_exp_f32 v219, v131
  v_mfma_f32_16x16x32_bf16 v[148:151], a[140:143], v[72:75], v[148:151]
  ds_read_b128 a[172:175], v3 offset:27648
  v_add_f32 v226, v226, v219
  v_cvt_pk_bf16_f32 v177, v218, v219
  v_mfma_f32_16x16x32_bf16 v[156:159], a[140:143], v[76:79], v[156:159]
  s_add_u32 s14, s13, 0
  s_waitcnt lgkmcnt(4)
  buffer_load_dwordx4 a[12:15], v2, s[40:43], s14 offen offset:3072 sc1
  v_exp_f32 v220, v132
  v_mfma_f32_16x16x32_bf16 v[144:147], a[144:147], v[80:83], v[144:147]
  ds_read_b128 a[176:179], v3 offset:28672
  v_add_f32 v226, v226, v220
  v_mfma_f32_16x16x32_bf16 v[152:155], a[144:147], v[84:87], v[152:155]
  v_exp_f32 v221, v133
  v_mfma_f32_16x16x32_bf16 v[148:151], a[148:151], v[80:83], v[148:151]
  ds_read_b128 a[180:183], v3 offset:29696
  buffer_load_dwordx4 v2, s[48:51], s27 offen offset:1024 sc1 lds
  v_add_f32 v226, v226, v221
  v_mfma_f32_16x16x32_bf16 v[156:159], a[148:151], v[84:87], v[156:159]
  v_exp_f32 v222, v134
  v_cvt_pk_bf16_f32 v178, v220, v221
  v_mfma_f32_16x16x32_bf16 v[144:147], a[152:155], v[88:91], v[144:147]
  ds_read_b128 a[184:187], v3 offset:30720
  v_add_f32 v226, v226, v222
  v_mfma_f32_16x16x32_bf16 v[152:155], a[152:155], v[92:95], v[152:155]
  v_exp_f32 v223, v135
  v_exp_f32 v216, v136
  v_mfma_f32_16x16x32_bf16 v[148:151], a[156:159], v[88:91], v[148:151]
  s_add_u32 s14, s13, 4096
  ds_read_b128 a[188:191], v3 offset:31744
  buffer_load_dwordx4 a[16:19], v2, s[40:43], s14 offen offset:0 sc1
  v_mfma_f32_16x16x32_bf16 v[156:159], a[156:159], v[92:95], v[156:159]
  s_waitcnt lgkmcnt(4)
  v_exp_f32 v217, v137
  v_mfma_f32_16x16x32_bf16 a[64:67], a[160:163], v[184:187], a[64:67]
  ds_read_b128 a[128:131], v3 offset:8192
  v_add_f32 v226, v226, v223
  v_mfma_f32_16x16x32_bf16 a[68:71], a[160:163], v[188:191], a[68:71]
  v_exp_f32 v218, v138
  v_cvt_pk_bf16_f32 v179, v222, v223
  v_mfma_f32_16x16x32_bf16 a[72:75], a[164:167], v[184:187], a[72:75]
  ds_read_b128 a[132:135], v3 offset:9216
  buffer_load_dwordx4 v2, s[48:51], s27 offen offset:2048 sc1 lds
  v_mfma_f32_16x16x32_bf16 a[76:79], a[164:167], v[188:191], a[76:79]
  v_exp_f32 v219, v139
  v_add_f32 v227, v216, v217
  v_mfma_f32_16x16x32_bf16 a[80:83], a[168:171], v[184:187], a[80:83]
  ds_read_b128 a[136:139], v3 offset:10240
  v_cvt_pk_bf16_f32 v180, v216, v217
  v_add_f32 v227, v227, v218
  v_mfma_f32_16x16x32_bf16 a[84:87], a[168:171], v[188:191], a[84:87]
  buffer_load_dwordx4 a[20:23], v2, s[40:43], s14 offen offset:1024 sc1
  v_add_f32 v227, v227, v219
  v_mfma_f32_16x16x32_bf16 a[88:91], a[172:175], v[184:187], a[88:91]
  ds_read_b128 a[140:143], v3 offset:11264
  v_cvt_pk_bf16_f32 v181, v218, v219
  v_exp_f32 v220, v140
  v_mfma_f32_16x16x32_bf16 a[92:95], a[172:175], v[188:191], a[92:95]
  s_waitcnt lgkmcnt(4)
  v_exp_f32 v221, v141
  v_mfma_f32_16x16x32_bf16 a[96:99], a[176:179], v[184:187], a[96:99]
  ds_read_b128 a[144:147], v3 offset:12288
  buffer_load_dwordx4 v2, s[48:51], s27 offen offset:3072 sc1 lds
  v_mfma_f32_16x16x32_bf16 a[100:103], a[176:179], v[188:191], a[100:103]
  s_add_u32 s27, s27, 16384
  v_exp_f32 v222, v142
  v_mfma_f32_16x16x32_bf16 a[104:107], a[180:183], v[184:187], a[104:107]
  s_add_u32 s25, s25, 32768
  ds_read_b128 a[148:151], v3 offset:13312
  v_add_f32 v227, v227, v220
  v_add_f32 v227, v227, v221
  v_mfma_f32_16x16x32_bf16 a[108:111], a[180:183], v[188:191], a[108:111]
  s_and_b32 s25, s25, 0x1ffff
  v_exp_f32 v223, v143
  v_mfma_f32_16x16x32_bf16 a[112:115], a[184:187], v[184:187], a[112:115]
  ds_read_b128 a[152:155], v3 offset:14336
  v_cvt_pk_bf16_f32 v182, v220, v221
  v_add_f32 v227, v227, v222
  v_mfma_f32_16x16x32_bf16 a[116:119], a[184:187], v[188:191], a[116:119]
  v_add_f32 v227, v227, v223
  v_cvt_pk_bf16_f32 v183, v222, v223
  v_mfma_f32_16x16x32_bf16 a[120:123], a[188:191], v[184:187], a[120:123]
  s_waitcnt lgkmcnt(3)
  ds_read_b128 a[156:159], v3 offset:15360
  v_max_f32 v5, v226, v227
  v_cmp_lt_f32 vcc, s81, v5
  v_mfma_f32_16x16x32_bf16 a[124:127], a[188:191], v[188:191], a[124:127]
  s_cbranch_vccnz fa_stub13
fa_back13:
  v_add_f32 v230, v230, v226
  v_add_f32 v231, v231, v227
  v_add_u32 v3, 32768, v3
  v_and_b32 v3, 0x1ffff, v3
fa_SSW7:
  v_mfma_f32_16x16x32_bf16 v[128:131], a[128:131], v[64:67], v[200:203]
  s_waitcnt vmcnt(12)
  v_exp_f32 v216, v144
  v_exp_f32 v217, v145
  v_mfma_f32_16x16x32_bf16 v[136:139], a[128:131], v[68:71], v[204:207]
  s_barrier
  v_exp_f32 v218, v146
  v_mfma_f32_16x16x32_bf16 v[132:135], a[132:135], v[64:67], v[200:203]
  ds_read_b128 a[160:163], v3 offset:16384
  ds_read_b128 a[164:167], v3 offset:17408
  v_mfma_f32_16x16x32_bf16 v[140:143], a[132:135], v[68:71], v[204:207]
  s_mov_b32 m0, s24
  v_exp_f32 v219, v147
  v_mfma_f32_16x16x32_bf16 v[128:131], a[136:139], v[72:75], v[128:131]
  ds_read_b128 a[168:171], v3 offset:18432
  buffer_load_dwordx4 v2, s[44:47], s26 offen offset:0 sc1 lds
  v_add_f32 v226, v216, v217
  v_mfma_f32_16x16x32_bf16 v[136:139], a[136:139], v[76:79], v[136:139]
  v_exp_f32 v220, v148
  v_mfma_f32_16x16x32_bf16 v[132:135], a[140:143], v[72:75], v[132:135]
  ds_read_b128 a[172:175], v3 offset:19456
  v_cvt_pk_bf16_f32 v184, v216, v217
  v_add_f32 v226, v226, v218
  v_mfma_f32_16x16x32_bf16 v[140:143], a[140:143], v[76:79], v[140:143]
  s_add_u32 s14, s13, 4096
  s_waitcnt lgkmcnt(4)
  buffer_load_dwordx4 a[24:27], v2, s[40:43], s14 offen offset:2048 sc1
  v_add_f32 v226, v226, v219
  v_mfma_f32_16x16x32_bf16 v[128:131], a[144:147], v[80:83], v[128:131]
  ds_read_b128 a[176:179], v3 offset:20480
  v_cvt_pk_bf16_f32 v185, v218, v219
  v_add_f32 v226, v226, v220
  v_mfma_f32_16x16x32_bf16 v[136:139], a[144:147], v[84:87], v[136:139]
  v_exp_f32 v221, v149
  v_mfma_f32_16x16x32_bf16 v[132:135], a[148:151], v[80:83], v[132:135]
  ds_read_b128 a[180:183], v3 offset:21504
  buffer_load_dwordx4 v2, s[44:47], s26 offen offset:1024 sc1 lds
  v_add_f32 v226, v226, v221
  v_mfma_f32_16x16x32_bf16 v[140:143], a[148:151], v[84:87], v[140:143]
  v_exp_f32 v222, v150
  v_cvt_pk_bf16_f32 v186, v220, v221
  v_mfma_f32_16x16x32_bf16 v[128:131], a[152:155], v[88:91], v[128:131]
  ds_read_b128 a[184:187], v3 offset:22528
  v_add_f32 v226, v226, v222
  v_mfma_f32_16x16x32_bf16 v[136:139], a[152:155], v[92:95], v[136:139]
  v_exp_f32 v223, v151
  v_exp_f32 v216, v152
  v_mfma_f32_16x16x32_bf16 v[132:135], a[156:159], v[88:91], v[132:135]
  ds_read_b128 a[188:191], v3 offset:23552
  buffer_load_dwordx4 a[28:31], v2, s[40:43], s14 offen offset:3072 sc1
  v_mfma_f32_16x16x32_bf16 v[140:143], a[156:159], v[92:95], v[140:143]
  s_waitcnt lgkmcnt(4)
  v_exp_f32 v217, v153
  v_mfma_f32_16x16x32_bf16 a[64:67], a[160:163], v[176:179], a[64:67]
  ds_read_b128 a[128:131], v3 offset:0
  v_add_f32 v226, v226, v223
  v_mfma_f32_16x16x32_bf16 a[68:71], a[160:163], v[180:183], a[68:71]
  v_exp_f32 v218, v154
  v_cvt_pk_bf16_f32 v187, v222, v223
  v_mfma_f32_16x16x32_bf16 a[72:75], a[164:167], v[176:179], a[72:75]
  ds_read_b128 a[132:135], v3 offset:1024
  buffer_load_dwordx4 v2, s[44:47], s26 offen offset:2048 sc1 lds
  v_mfma_f32_16x16x32_bf16 a[76:79], a[164:167], v[180:183], a[76:79]
  v_exp_f32 v219, v155
  v_add_f32 v227, v216, v217
  v_mfma_f32_16x16x32_bf16 a[80:83], a[168:171], v[176:179], a[80:83]
  ds_read_b128 a[136:139], v3 offset:2048
  v_cvt_pk_bf16_f32 v188, v216, v217
  v_add_f32 v227, v227, v218
  v_mfma_f32_16x16x32_bf16 a[84:87], a[168:171], v[180:183], a[84:87]
  s_add_u32 s14, s13, 8192
  buffer_load_dwordx4 a[32:35], v2, s[40:43], s14 offen offset:0 sc1
  v_add_f32 v227, v227, v219
  v_mfma_f32_16x16x32_bf16 a[88:91], a[172:175], v[176:179], a[88:91]
  ds_read_b128 a[140:143], v3 offset:3072
  v_cvt_pk_bf16_f32 v189, v218, v219
  v_exp_f32 v220, v156
  v_mfma_f32_16x16x32_bf16 a[92:95], a[172:175], v[180:183], a[92:95]
  s_waitcnt lgkmcnt(4)
  v_exp_f32 v221, v157
  v_mfma_f32_16x16x32_bf16 a[96:99], a[176:179], v[176:179], a[96:99]
  ds_read_b128 a[144:147], v3 offset:4096
  buffer_load_dwordx4 v2, s[44:47], s26 offen offset:3072 sc1 lds
  v_mfma_f32_16x16x32_bf16 a[100:103], a[176:179], v[180:183], a[100:103]
  s_add_u32 s26, s26, 16384
  v_exp_f32 v222, v158
  v_mfma_f32_16x16x32_bf16 a[104:107], a[180:183], v[176:179], a[104:107]
  s_add_u32 s24, s24, 32768
  ds_read_b128 a[148:151], v3 offset:5120
  v_add_f32 v227, v227, v220
  v_add_f32 v227, v227, v221
  v_mfma_f32_16x16x32_bf16 a[108:111], a[180:183], v[180:183], a[108:111]
  s_and_b32 s24, s24, 0x1ffff
  v_exp_f32 v223, v159
  v_mfma_f32_16x16x32_bf16 a[112:115], a[184:187], v[176:179], a[112:115]
  ds_read_b128 a[152:155], v3 offset:6144
  v_cvt_pk_bf16_f32 v190, v220, v221
  v_add_f32 v227, v227, v222
  v_mfma_f32_16x16x32_bf16 a[116:119], a[184:187], v[180:183], a[116:119]
  v_add_f32 v227, v227, v223
  v_cvt_pk_bf16_f32 v191, v222, v223
  v_mfma_f32_16x16x32_bf16 a[120:123], a[188:191], v[176:179], a[120:123]
  s_waitcnt lgkmcnt(3)
  ds_read_b128 a[156:159], v3 offset:7168
  v_max_f32 v5, v226, v227
  v_cmp_lt_f32 vcc, s81, v5
  v_mfma_f32_16x16x32_bf16 a[124:127], a[188:191], v[180:183], a[124:127]
  s_cbranch_vccnz fa_stub14
fa_back14:
  v_add_f32 v230, v230, v226
  v_add_f32 v231, v231, v227
  v_mfma_f32_16x16x32_bf16 v[144:147], a[128:131], v[64:67], v[200:203]
  ds_read_b128 a[160:163], v3 offset:24576
  v_exp_f32 v216, v128
  v_mfma_f32_16x16x32_bf16 v[152:155], a[128:131], v[68:71], v[204:207]
  v_exp_f32 v217, v129
  v_mfma_f32_16x16x32_bf16 v[148:151], a[132:135], v[64:67], v[200:203]
  ds_read_b128 a[164:167], v3 offset:25600
  v_add_f32 v226, v216, v217
  v_cvt_pk_bf16_f32 v176, v216, v217
  v_mfma_f32_16x16x32_bf16 v[156:159], a[132:135], v[68:71], v[204:207]
  s_mov_b32 m0, s25
  v_exp_f32 v218, v130
  v_mfma_f32_16x16x32_bf16 v[144:147], a[136:139], v[72:75], v[144:147]
  ds_read_b128 a[168:171], v3 offset:26624
  buffer_load_dwordx4 v2, s[48:51], s27 offen offset:0 sc1 lds
  v_add_f32 v226, v226, v218
  v_mfma_f32_16x16x32_bf16 v[152:155], a[136:139], v[76:79], v[152:155]
  v_exp_f32 v219, v131
  v_mfma_f32_16x16x32_bf16 v[148:151], a[140:143], v[72:75], v[148:151]
  ds_read_b128 a[172:175], v3 offset:27648
  v_add_f32 v226, v226, v219
  v_cvt_pk_bf16_f32 v177, v218, v219
  v_mfma_f32_16x16x32_bf16 v[156:159], a[140:143], v[76:79], v[156:159]
  s_add_u32 s14, s13, 8192
  s_waitcnt lgkmcnt(4)
  buffer_load_dwordx4 a[36:39], v2, s[40:43], s14 offen offset:1024 sc1
  v_exp_f32 v220, v132
  v_mfma_f32_16x16x32_bf16 v[144:147], a[144:147], v[80:83], v[144:147]
  ds_read_b128 a[176:179], v3 offset:28672
  v_add_f32 v226, v226, v220
  v_mfma_f32_16x16x32_bf16 v[152:155], a[144:147], v[84:87], v[152:155]
  v_exp_f32 v221, v133
  v_mfma_f32_16x16x32_bf16 v[148:151], a[148:151], v[80:83], v[148:151]
  ds_read_b128 a[180:183], v3 offset:29696
  buffer_load_dwordx4 v2, s[48:51], s27 offen offset:1024 sc1 lds
  v_add_f32 v226, v226, v221
  v_mfma_f32_16x16x32_bf16 v[156:159], a[148:151], v[84:87], v[156:159]
  v_exp_f32 v222, v134
  v_cvt_pk_bf16_f32 v178, v220, v221
  v_mfma_f32_16x16x32_bf16 v[144:147], a[152:155], v[88:91], v[144:147]
  ds_read_b128 a[184:187], v3 offset:30720
  v_add_f32 v226, v226, v222
  v_mfma_f32_16x16x32_bf16 v[152:155], a[152:155], v[92:95], v[152:155]
  v_exp_f32 v223, v135
  v_exp_f32 v216, v136
  v_mfma_f32_16x16x32_bf16 v[148:151], a[156:159], v[88:91], v[148:151]
  ds_read_b128 a[188:191], v3 offset:31744
  buffer_load_dwordx4 a[40:43], v2, s[40:43], s14 offen offset:2048 sc1
  v_mfma_f32_16x16x32_bf16 v[156:159], a[156:159], v[92:95], v[156:159]
  s_waitcnt lgkmcnt(4)
  v_exp_f32 v217, v137
  v_mfma_f32_16x16x32_bf16 a[64:67], a[160:163], v[184:187], a[64:67]
  ds_read_b128 a[128:131], v3 offset:8192
  v_add_f32 v226, v226, v223
  v_mfma_f32_16x16x32_bf16 a[68:71], a[160:163], v[188:191], a[68:71]
  v_exp_f32 v218, v138
  v_cvt_pk_bf16_f32 v179, v222, v223
  v_mfma_f32_16x16x32_bf16 a[72:75], a[164:167], v[184:187], a[72:75]
  ds_read_b128 a[132:135], v3 offset:9216
  buffer_load_dwordx4 v2, s[48:51], s27 offen offset:2048 sc1 lds
  v_mfma_f32_16x16x32_bf16 a[76:79], a[164:167], v[188:191], a[76:79]
  v_exp_f32 v219, v139
  v_add_f32 v227, v216, v217
  v_mfma_f32_16x16x32_bf16 a[80:83], a[168:171], v[184:187], a[80:83]
  ds_read_b128 a[136:139], v3 offset:10240
  v_cvt_pk_bf16_f32 v180, v216, v217
  v_add_f32 v227, v227, v218
  v_mfma_f32_16x16x32_bf16 a[84:87], a[168:171], v[188:191], a[84:87]
  buffer_load_dwordx4 a[44:47], v2, s[40:43], s14 offen offset:3072 sc1
  v_add_f32 v227, v227, v219
  v_mfma_f32_16x16x32_bf16 a[88:91], a[172:175], v[184:187], a[88:91]
  ds_read_b128 a[140:143], v3 offset:11264
  v_cvt_pk_bf16_f32 v181, v218, v219
  v_exp_f32 v220, v140
  v_mfma_f32_16x16x32_bf16 a[92:95], a[172:175], v[188:191], a[92:95]
  s_waitcnt lgkmcnt(4)
  v_exp_f32 v221, v141
  v_mfma_f32_16x16x32_bf16 a[96:99], a[176:179], v[184:187], a[96:99]
  ds_read_b128 a[144:147], v3 offset:12288
  buffer_load_dwordx4 v2, s[48:51], s27 offen offset:3072 sc1 lds
  v_mfma_f32_16x16x32_bf16 a[100:103], a[176:179], v[188:191], a[100:103]
  s_add_u32 s27, s27, 16384
  v_exp_f32 v222, v142
  v_mfma_f32_16x16x32_bf16 a[104:107], a[180:183], v[184:187], a[104:107]
  s_add_u32 s25, s25, 32768
  ds_read_b128 a[148:151], v3 offset:13312
  v_add_f32 v227, v227, v220
  v_add_f32 v227, v227, v221
  v_mfma_f32_16x16x32_bf16 a[108:111], a[180:183], v[188:191], a[108:111]
  s_and_b32 s25, s25, 0x1ffff
  v_exp_f32 v223, v143
  v_mfma_f32_16x16x32_bf16 a[112:115], a[184:187], v[184:187], a[112:115]
  ds_read_b128 a[152:155], v3 offset:14336
  v_cvt_pk_bf16_f32 v182, v220, v221
  v_add_f32 v227, v227, v222
  v_mfma_f32_16x16x32_bf16 a[116:119], a[184:187], v[188:191], a[116:119]
  v_add_f32 v227, v227, v223
  v_cvt_pk_bf16_f32 v183, v222, v223
  v_mfma_f32_16x16x32_bf16 a[120:123], a[188:191], v[184:187], a[120:123]
  s_waitcnt lgkmcnt(3)
  ds_read_b128 a[156:159], v3 offset:15360
  v_max_f32 v5, v226, v227
  v_cmp_lt_f32 vcc, s81, v5
  v_mfma_f32_16x16x32_bf16 a[124:127], a[188:191], v[188:191], a[124:127]
  s_cbranch_vccnz fa_stub15
fa_back15:
  v_add_f32 v230, v230, v226
  v_add_f32 v231, v231, v227
  v_add_u32 v3, 32768, v3
  v_and_b32 v3, 0x1ffff, v3
fa_SSW6:
  v_mfma_f32_16x16x32_bf16 v[128:131], a[128:131], v[64:67], v[200:203]
  s_waitcnt vmcnt(12)
  v_exp_f32 v216, v144
  v_exp_f32 v217, v145
  v_mfma_f32_16x16x32_bf16 v[136:139], a[128:131], v[68:71], v[204:207]
  s_barrier
  v_exp_f32 v218, v146
  v_mfma_f32_16x16x32_bf16 v[132:135], a[132:135], v[64:67], v[200:203]
  ds_read_b128 a[160:163], v3 offset:16384
  ds_read_b128 a[164:167], v3 offset:17408
  v_mfma_f32_16x16x32_bf16 v[140:143], a[132:135], v[68:71], v[204:207]
  s_mov_b32 m0, s24
  v_exp_f32 v219, v147
  v_mfma_f32_16x16x32_bf16 v[128:131], a[136:139], v[72:75], v[128:131]
  ds_read_b128 a[168:171], v3 offset:18432
  buffer_load_dwordx4 v2, s[44:47], s26 offen offset:0 sc1 lds
  v_add_f32 v226, v216, v217
  v_mfma_f32_16x16x32_bf16 v[136:139], a[136:139], v[76:79], v[136:139]
  v_exp_f32 v220, v148
  v_mfma_f32_16x16x32_bf16 v[132:135], a[140:143], v[72:75], v[132:135]
  ds_read_b128 a[172:175], v3 offset:19456
  v_cvt_pk_bf16_f32 v184, v216, v217
  v_add_f32 v226, v226, v218
  v_mfma_f32_16x16x32_bf16 v[140:143], a[140:143], v[76:79], v[140:143]
  s_add_u32 s14, s13, 12288
  s_waitcnt lgkmcnt(4)
  buffer_load_dwordx4 a[48:51], v2, s[40:43], s14 offen offset:0 sc1
  v_add_f32 v226, v226, v219
  v_mfma_f32_16x16x32_bf16 v[128:131], a[144:147], v[80:83], v[128:131]
  ds_read_b128 a[176:179], v3 offset:20480
  v_cvt_pk_bf16_f32 v185, v218, v219
  v_add_f32 v226, v226, v220
  v_mfma_f32_16x16x32_bf16 v[136:139], a[144:147], v[84:87], v[136:139]
  v_exp_f32 v221, v149
  v_mfma_f32_16x16x32_bf16 v[132:135], a[148:151], v[80:83], v[132:135]
  ds_read_b128 a[180:183], v3 offset:21504
  buffer_load_dwordx4 v2, s[44:47], s26 offen offset:1024 sc1 lds
  v_add_f32 v226, v226, v221
  v_mfma_f32_16x16x32_bf16 v[140:143], a[148:151], v[84:87], v[140:143]
  v_exp_f32 v222, v150
  v_cvt_pk_bf16_f32 v186, v220, v221
  v_mfma_f32_16x16x32_bf16 v[128:131], a[152:155], v[88:91], v[128:131]
  ds_read_b128 a[184:187], v3 offset:22528
  v_add_f32 v226, v226, v222
  v_mfma_f32_16x16x32_bf16 v[136:139], a[152:155], v[92:95], v[136:139]
  v_exp_f32 v223, v151
  v_exp_f32 v216, v152
  v_mfma_f32_16x16x32_bf16 v[132:135], a[156:159], v[88:91], v[132:135]
  ds_read_b128 a[188:191], v3 offset:23552
  buffer_load_dwordx4 a[52:55], v2, s[40:43], s14 offen offset:1024 sc1
  v_mfma_f32_16x16x32_bf16 v[140:143], a[156:159], v[92:95], v[140:143]
  s_waitcnt lgkmcnt(4)
  v_exp_f32 v217, v153
  v_mfma_f32_16x16x32_bf16 a[64:67], a[160:163], v[176:179], a[64:67]
  ds_read_b128 a[128:131], v3 offset:0
  v_add_f32 v226, v226, v223
  v_mfma_f32_16x16x32_bf16 a[68:71], a[160:163], v[180:183], a[68:71]
  v_exp_f32 v218, v154
  v_cvt_pk_bf16_f32 v187, v222, v223
  v_mfma_f32_16x16x32_bf16 a[72:75], a[164:167], v[176:179], a[72:75]
  ds_read_b128 a[132:135], v3 offset:1024
  buffer_load_dwordx4 v2, s[44:47], s26 offen offset:2048 sc1 lds
  v_mfma_f32_16x16x32_bf16 a[76:79], a[164:167], v[180:183], a[76:79]
  v_exp_f32 v219, v155
  v_add_f32 v227, v216, v217
  v_mfma_f32_16x16x32_bf16 a[80:83], a[168:171], v[176:179], a[80:83]
  ds_read_b128 a[136:139], v3 offset:2048
  v_cvt_pk_bf16_f32 v188, v216, v217
  v_add_f32 v227, v227, v218
  v_mfma_f32_16x16x32_bf16 a[84:87], a[168:171], v[180:183], a[84:87]
  buffer_load_dwordx4 a[56:59], v2, s[40:43], s14 offen offset:2048 sc1
  v_add_f32 v227, v227, v219
  v_mfma_f32_16x16x32_bf16 a[88:91], a[172:175], v[176:179], a[88:91]
  ds_read_b128 a[140:143], v3 offset:3072
  v_cvt_pk_bf16_f32 v189, v218, v219
  v_exp_f32 v220, v156
  v_mfma_f32_16x16x32_bf16 a[92:95], a[172:175], v[180:183], a[92:95]
  s_waitcnt lgkmcnt(4)
  v_exp_f32 v221, v157
  v_mfma_f32_16x16x32_bf16 a[96:99], a[176:179], v[176:179], a[96:99]
  ds_read_b128 a[144:147], v3 offset:4096
  buffer_load_dwordx4 v2, s[44:47], s26 offen offset:3072 sc1 lds
  v_mfma_f32_16x16x32_bf16 a[100:103], a[176:179], v[180:183], a[100:103]
  s_add_u32 s26, s26, 16384
  v_exp_f32 v222, v158
  v_mfma_f32_16x16x32_bf16 a[104:107], a[180:183], v[176:179], a[104:107]
  s_add_u32 s24, s24, 32768
  ds_read_b128 a[148:151], v3 offset:5120
  v_add_f32 v227, v227, v220
  v_add_f32 v227, v227, v221
  v_mfma_f32_16x16x32_bf16 a[108:111], a[180:183], v[180:183], a[108:111]
  s_and_b32 s24, s24, 0x1ffff
  v_exp_f32 v223, v159
  v_mfma_f32_16x16x32_bf16 a[112:115], a[184:187], v[176:179], a[112:115]
  ds_read_b128 a[152:155], v3 offset:6144
  v_cvt_pk_bf16_f32 v190, v220, v221
  v_add_f32 v227, v227, v222
  v_mfma_f32_16x16x32_bf16 a[116:119], a[184:187], v[180:183], a[116:119]
  v_add_f32 v227, v227, v223
  v_cvt_pk_bf16_f32 v191, v222, v223
  v_mfma_f32_16x16x32_bf16 a[120:123], a[188:191], v[176:179], a[120:123]
  s_waitcnt lgkmcnt(3)
  ds_read_b128 a[156:159], v3 offset:7168
  v_max_f32 v5, v226, v227
  v_cmp_lt_f32 vcc, s81, v5
  v_mfma_f32_16x16x32_bf16 a[124:127], a[188:191], v[180:183], a[124:127]
  s_cbranch_vccnz fa_stub16
fa_back16:
  v_add_f32 v230, v230, v226
  v_add_f32 v231, v231, v227
  v_mfma_f32_16x16x32_bf16 v[144:147], a[128:131], v[64:67], v[200:203]
  ds_read_b128 a[160:163], v3 offset:24576
  v_exp_f32 v216, v128
  v_mfma_f32_16x16x32_bf16 v[152:155], a[128:131], v[68:71], v[204:207]
  v_exp_f32 v217, v129
  v_mfma_f32_16x16x32_bf16 v[148:151], a[132:135], v[64:67], v[200:203]
  ds_read_b128 a[164:167], v3 offset:25600
  v_add_f32 v226, v216, v217
  v_cvt_pk_bf16_f32 v176, v216, v217
  v_mfma_f32_16x16x32_bf16 v[156:159], a[132:135], v[68:71], v[204:207]
  s_mov_b32 m0, s25
  v_exp_f32 v218, v130
  v_mfma_f32_16x16x32_bf16 v[144:147], a[136:139], v[72:75], v[144:147]
  ds_read_b128 a[168:171], v3 offset:26624
  buffer_load_dwordx4 v2, s[48:51], s27 offen offset:0 sc1 lds
  v_add_f32 v226, v226, v218
  v_mfma_f32_16x16x32_bf16 v[152:155], a[136:139], v[76:79], v[152:155]
  v_exp_f32 v219, v131
  v_mfma_f32_16x16x32_bf16 v[148:151], a[140:143], v[72:75], v[148:151]
  ds_read_b128 a[172:175], v3 offset:27648
  v_add_f32 v226, v226, v219
  v_cvt_pk_bf16_f32 v177, v218, v219
  v_mfma_f32_16x16x32_bf16 v[156:159], a[140:143], v[76:79], v[156:159]
  s_add_u32 s14, s13, 12288
  s_waitcnt lgkmcnt(4)
  buffer_load_dwordx4 a[60:63], v2, s[40:43], s14 offen offset:3072 sc1
  v_exp_f32 v220, v132
  v_mfma_f32_16x16x32_bf16 v[144:147], a[144:147], v[80:83], v[144:147]
  ds_read_b128 a[176:179], v3 offset:28672
  v_add_f32 v226, v226, v220
  v_mfma_f32_16x16x32_bf16 v[152:155], a[144:147], v[84:87], v[152:155]
  v_exp_f32 v221, v133
  v_mfma_f32_16x16x32_bf16 v[148:151], a[148:151], v[80:83], v[148:151]
  ds_read_b128 a[180:183], v3 offset:29696
  buffer_load_dwordx4 v2, s[48:51], s27 offen offset:1024 sc1 lds
  v_add_f32 v226, v226, v221
  v_mfma_f32_16x16x32_bf16 v[156:159], a[148:151], v[84:87], v[156:159]
  v_exp_f32 v222, v134
  v_cvt_pk_bf16_f32 v178, v220, v221
  v_mfma_f32_16x16x32_bf16 v[144:147], a[152:155], v[88:91], v[144:147]
  ds_read_b128 a[184:187], v3 offset:30720
  v_add_f32 v226, v226, v222
  v_mfma_f32_16x16x32_bf16 v[152:155], a[152:155], v[92:95], v[152:155]
  v_exp_f32 v223, v135
  v_exp_f32 v216, v136
  v_mfma_f32_16x16x32_bf16 v[148:151], a[156:159], v[88:91], v[148:151]
  s_add_u32 s14, s13, 16384
  ds_read_b128 a[188:191], v3 offset:31744
  buffer_load_dwordx4 a[192:195], v2, s[40:43], s14 offen offset:0 sc1
  v_mfma_f32_16x16x32_bf16 v[156:159], a[156:159], v[92:95], v[156:159]
  s_waitcnt lgkmcnt(4)
  v_exp_f32 v217, v137
  v_mfma_f32_16x16x32_bf16 a[64:67], a[160:163], v[184:187], a[64:67]
  ds_read_b128 a[128:131], v3 offset:8192
  v_add_f32 v226, v226, v223
  v_mfma_f32_16x16x32_bf16 a[68:71], a[160:163], v[188:191], a[68:71]
  v_exp_f32 v218, v138
  v_cvt_pk_bf16_f32 v179, v222, v223
  v_mfma_f32_16x16x32_bf16 a[72:75], a[164:167], v[184:187], a[72:75]
  ds_read_b128 a[132:135], v3 offset:9216
  buffer_load_dwordx4 v2, s[48:51], s27 offen offset:2048 sc1 lds
  v_mfma_f32_16x16x32_bf16 a[76:79], a[164:167], v[188:191], a[76:79]
  v_exp_f32 v219, v139
  v_add_f32 v227, v216, v217
  v_mfma_f32_16x16x32_bf16 a[80:83], a[168:171], v[184:187], a[80:83]
  ds_read_b128 a[136:139], v3 offset:10240
  v_cvt_pk_bf16_f32 v180, v216, v217
  v_add_f32 v227, v227, v218
  v_mfma_f32_16x16x32_bf16 a[84:87], a[168:171], v[188:191], a[84:87]
  buffer_load_dwordx4 a[196:199], v2, s[40:43], s14 offen offset:1024 sc1
  v_add_f32 v227, v227, v219
  v_mfma_f32_16x16x32_bf16 a[88:91], a[172:175], v[184:187], a[88:91]
  ds_read_b128 a[140:143], v3 offset:11264
  v_cvt_pk_bf16_f32 v181, v218, v219
  v_exp_f32 v220, v140
  v_mfma_f32_16x16x32_bf16 a[92:95], a[172:175], v[188:191], a[92:95]
  s_waitcnt lgkmcnt(4)
  v_exp_f32 v221, v141
  v_mfma_f32_16x16x32_bf16 a[96:99], a[176:179], v[184:187], a[96:99]
  ds_read_b128 a[144:147], v3 offset:12288
  buffer_load_dwordx4 v2, s[48:51], s27 offen offset:3072 sc1 lds
  v_mfma_f32_16x16x32_bf16 a[100:103], a[176:179], v[188:191], a[100:103]
  s_add_u32 s27, s27, 16384
  v_exp_f32 v222, v142
  v_mfma_f32_16x16x32_bf16 a[104:107], a[180:183], v[184:187], a[104:107]
  s_add_u32 s25, s25, 32768
  ds_read_b128 a[148:151], v3 offset:13312
  v_add_f32 v227, v227, v220
  v_add_f32 v227, v227, v221
  v_mfma_f32_16x16x32_bf16 a[108:111], a[180:183], v[188:191], a[108:111]
  s_and_b32 s25, s25, 0x1ffff
  v_exp_f32 v223, v143
  v_mfma_f32_16x16x32_bf16 a[112:115], a[184:187], v[184:187], a[112:115]
  ds_read_b128 a[152:155], v3 offset:14336
  v_cvt_pk_bf16_f32 v182, v220, v221
  v_add_f32 v227, v227, v222
  v_mfma_f32_16x16x32_bf16 a[116:119], a[184:187], v[188:191], a[116:119]
  v_add_f32 v227, v227, v223
  v_cvt_pk_bf16_f32 v183, v222, v223
  v_mfma_f32_16x16x32_bf16 a[120:123], a[188:191], v[184:187], a[120:123]
  s_waitcnt lgkmcnt(3)
  ds_read_b128 a[156:159], v3 offset:15360
  v_max_f32 v5, v226, v227
  v_cmp_lt_f32 vcc, s81, v5
  v_mfma_f32_16x16x32_bf16 a[124:127], a[188:191], v[188:191], a[124:127]
  s_cbranch_vccnz fa_stub17
fa_back17:
  v_add_f32 v230, v230, v226
  v_add_f32 v231, v231, v227
  v_add_u32 v3, 32768, v3
  v_and_b32 v3, 0x1ffff, v3
fa_SSW5:
  v_mfma_f32_16x16x32_bf16 v[128:131], a[128:131], v[64:67], v[200:203]
  s_waitcnt vmcnt(12)
  v_exp_f32 v216, v144
  v_exp_f32 v217, v145
  v_mfma_f32_16x16x32_bf16 v[136:139], a[128:131], v[68:71], v[204:207]
  s_barrier
  v_exp_f32 v218, v146
  v_mfma_f32_16x16x32_bf16 v[132:135], a[132:135], v[64:67], v[200:203]
  ds_read_b128 a[160:163], v3 offset:16384
  ds_read_b128 a[164:167], v3 offset:17408
  v_mfma_f32_16x16x32_bf16 v[140:143], a[132:135], v[68:71], v[204:207]
  s_mov_b32 m0, s24
  v_exp_f32 v219, v147
  v_mfma_f32_16x16x32_bf16 v[128:131], a[136:139], v[72:75], v[128:131]
  ds_read_b128 a[168:171], v3 offset:18432
  buffer_load_dwordx4 v2, s[44:47], s26 offen offset:0 sc1 lds
  v_add_f32 v226, v216, v217
  v_mfma_f32_16x16x32_bf16 v[136:139], a[136:139], v[76:79], v[136:139]
  v_exp_f32 v220, v148
  v_mfma_f32_16x16x32_bf16 v[132:135], a[140:143], v[72:75], v[132:135]
  ds_read_b128 a[172:175], v3 offset:19456
  v_cvt_pk_bf16_f32 v184, v216, v217
  v_add_f32 v226, v226, v218
  v_mfma_f32_16x16x32_bf16 v[140:143], a[140:143], v[76:79], v[140:143]
  s_add_u32 s14, s13, 16384
  s_waitcnt lgkmcnt(4)
  buffer_load_dwordx4 a[200:203], v2, s[40:43], s14 offen offset:2048 sc1
  v_add_f32 v226, v226, v219
  v_mfma_f32_16x16x32_bf16 v[128:131], a[144:147], v[80:83], v[128:131]
  ds_read_b128 a[176:179], v3 offset:20480
  v_cvt_pk_bf16_f32 v185, v218, v219
  v_add_f32 v226, v226, v220
  v_mfma_f32_16x16x32_bf16 v[136:139], a[144:147], v[84:87], v[136:139]
  v_exp_f32 v221, v149
  v_mfma_f32_16x16x32_bf16 v[132:135], a[148:151], v[80:83], v[132:135]
  ds_read_b128 a[180:183], v3 offset:21504
  buffer_load_dwordx4 v2, s[44:47], s26 offen offset:1024 sc1 lds
  v_add_f32 v226, v226, v221
  v_mfma_f32_16x16x32_bf16 v[140:143], a[148:151], v[84:87], v[140:143]
  v_exp_f32 v222, v150
  v_cvt_pk_bf16_f32 v186, v220, v221
  v_mfma_f32_16x16x32_bf16 v[128:131], a[152:155], v[88:91], v[128:131]
  ds_read_b128 a[184:187], v3 offset:22528
  v_add_f32 v226, v226, v222
  v_mfma_f32_16x16x32_bf16 v[136:139], a[152:155], v[92:95], v[136:139]
  v_exp_f32 v223, v151
  v_exp_f32 v216, v152
  v_mfma_f32_16x16x32_bf16 v[132:135], a[156:159], v[88:91], v[132:135]
  ds_read_b128 a[188:191], v3 offset:23552
  buffer_load_dwordx4 a[204:207], v2, s[40:43], s14 offen offset:3072 sc1
  v_mfma_f32_16x16x32_bf16 v[140:143], a[156:159], v[92:95], v[140:143]
  s_waitcnt lgkmcnt(4)
  v_exp_f32 v217, v153
  v_mfma_f32_16x16x32_bf16 a[64:67], a[160:163], v[176:179], a[64:67]
  ds_read_b128 a[128:131], v3 offset:0
  v_add_f32 v226, v226, v223
  v_mfma_f32_16x16x32_bf16 a[68:71], a[160:163], v[180:183], a[68:71]
  v_exp_f32 v218, v154
  v_cvt_pk_bf16_f32 v187, v222, v223
  v_mfma_f32_16x16x32_bf16 a[72:75], a[164:167], v[176:179], a[72:75]
  ds_read_b128 a[132:135], v3 offset:1024
  buffer_load_dwordx4 v2, s[44:47], s26 offen offset:2048 sc1 lds
  v_mfma_f32_16x16x32_bf16 a[76:79], a[164:167], v[180:183], a[76:79]
  v_exp_f32 v219, v155
  v_add_f32 v227, v216, v217
  v_mfma_f32_16x16x32_bf16 a[80:83], a[168:171], v[176:179], a[80:83]
  ds_read_b128 a[136:139], v3 offset:2048
  v_cvt_pk_bf16_f32 v188, v216, v217
  v_add_f32 v227, v227, v218
  v_mfma_f32_16x16x32_bf16 a[84:87], a[168:171], v[180:183], a[84:87]
  s_add_u32 s14, s13, 20480
  buffer_load_dwordx4 a[208:211], v2, s[40:43], s14 offen offset:0 sc1
  v_add_f32 v227, v227, v219
  v_mfma_f32_16x16x32_bf16 a[88:91], a[172:175], v[176:179], a[88:91]
  ds_read_b128 a[140:143], v3 offset:3072
  v_cvt_pk_bf16_f32 v189, v218, v219
  v_exp_f32 v220, v156
  v_mfma_f32_16x16x32_bf16 a[92:95], a[172:175], v[180:183], a[92:95]
  s_waitcnt lgkmcnt(4)
  v_exp_f32 v221, v157
  v_mfma_f32_16x16x32_bf16 a[96:99], a[176:179], v[176:179], a[96:99]
  ds_read_b128 a[144:147], v3 offset:4096
  buffer_load_dwordx4 v2, s[44:47], s26 offen offset:3072 sc1 lds
  v_mfma_f32_16x16x32_bf16 a[100:103], a[176:179], v[180:183], a[100:103]
  s_add_u32 s26, s26, 16384
  v_exp_f32 v222, v158
  v_mfma_f32_16x16x32_bf16 a[104:107], a[180:183], v[176:179], a[104:107]
  s_add_u32 s24, s24, 32768
  ds_read_b128 a[148:151], v3 offset:5120
  v_add_f32 v227, v227, v220
  v_add_f32 v227, v227, v221
  v_mfma_f32_16x16x32_bf16 a[108:111], a[180:183], v[180:183], a[108:111]
  s_and_b32 s24, s24, 0x1ffff
  v_exp_f32 v223, v159
  v_mfma_f32_16x16x32_bf16 a[112:115], a[184:187], v[176:179], a[112:115]
  ds_read_b128 a[152:155], v3 offset:6144
  v_cvt_pk_bf16_f32 v190, v220, v221
  v_add_f32 v227, v227, v222
  v_mfma_f32_16x16x32_bf16 a[116:119], a[184:187], v[180:183], a[116:119]
  v_add_f32 v227, v227, v223
  v_cvt_pk_bf16_f32 v191, v222, v223
  v_mfma_f32_16x16x32_bf16 a[120:123], a[188:191], v[176:179], a[120:123]
  s_waitcnt lgkmcnt(3)
  ds_read_b128 a[156:159], v3 offset:7168
  v_max_f32 v5, v226, v227
  v_cmp_lt_f32 vcc, s81, v5
  v_mfma_f32_16x16x32_bf16 a[124:127], a[188:191], v[180:183], a[124:127]
  s_cbranch_vccnz fa_stub18
fa_back18:
  v_add_f32 v230, v230, v226
  v_add_f32 v231, v231, v227
  v_mfma_f32_16x16x32_bf16 v[144:147], a[128:131], v[64:67], v[200:203]
  ds_read_b128 a[160:163], v3 offset:24576
  v_exp_f32 v216, v128
  v_mfma_f32_16x16x32_bf16 v[152:155], a[128:131], v[68:71], v[204:207]
  v_exp_f32 v217, v129
  v_mfma_f32_16x16x32_bf16 v[148:151], a[132:135], v[64:67], v[200:203]
  ds_read_b128 a[164:167], v3 offset:25600
  v_add_f32 v226, v216, v217
  v_cvt_pk_bf16_f32 v176, v216, v217
  v_mfma_f32_16x16x32_bf16 v[156:159], a[132:135], v[68:71], v[204:207]
  s_mov_b32 m0, s25
  v_exp_f32 v218, v130
  v_mfma_f32_16x16x32_bf16 v[144:147], a[136:139], v[72:75], v[144:147]
  ds_read_b128 a[168:171], v3 offset:26624
  buffer_load_dwordx4 v2, s[48:51], s27 offen offset:0 sc1 lds
  v_add_f32 v226, v226, v218
  v_mfma_f32_16x16x32_bf16 v[152:155], a[136:139], v[76:79], v[152:155]
  v_exp_f32 v219, v131
  v_mfma_f32_16x16x32_bf16 v[148:151], a[140:143], v[72:75], v[148:151]
  ds_read_b128 a[172:175], v3 offset:27648
  v_add_f32 v226, v226, v219
  v_cvt_pk_bf16_f32 v177, v218, v219
  v_mfma_f32_16x16x32_bf16 v[156:159], a[140:143], v[76:79], v[156:159]
  s_add_u32 s14, s13, 20480
  s_waitcnt lgkmcnt(4)
  buffer_load_dwordx4 a[212:215], v2, s[40:43], s14 offen offset:1024 sc1
  v_exp_f32 v220, v132
  v_mfma_f32_16x16x32_bf16 v[144:147], a[144:147], v[80:83], v[144:147]
  ds_read_b128 a[176:179], v3 offset:28672
  v_add_f32 v226, v226, v220
  v_mfma_f32_16x16x32_bf16 v[152:155], a[144:147], v[84:87], v[152:155]
  v_exp_f32 v221, v133
  v_mfma_f32_16x16x32_bf16 v[148:151], a[148:151], v[80:83], v[148:151]
  ds_read_b128 a[180:183], v3 offset:29696
  buffer_load_dwordx4 v2, s[48:51], s27 offen offset:1024 sc1 lds
  v_add_f32 v226, v226, v221
  v_mfma_f32_16x16x32_bf16 v[156:159], a[148:151], v[84:87], v[156:159]
  v_exp_f32 v222, v134
  v_cvt_pk_bf16_f32 v178, v220, v221
  v_mfma_f32_16x16x32_bf16 v[144:147], a[152:155], v[88:91], v[144:147]
  ds_read_b128 a[184:187], v3 offset:30720
  v_add_f32 v226, v226, v222
  v_mfma_f32_16x16x32_bf16 v[152:155], a[152:155], v[92:95], v[152:155]
  v_exp_f32 v223, v135
  v_exp_f32 v216, v136
  v_mfma_f32_16x16x32_bf16 v[148:151], a[156:159], v[88:91], v[148:151]
  ds_read_b128 a[188:191], v3 offset:31744
  buffer_load_dwordx4 a[216:219], v2, s[40:43], s14 offen offset:2048 sc1
  v_mfma_f32_16x16x32_bf16 v[156:159], a[156:159], v[92:95], v[156:159]
  s_waitcnt lgkmcnt(4)
  v_exp_f32 v217, v137
  v_mfma_f32_16x16x32_bf16 a[64:67], a[160:163], v[184:187], a[64:67]
  ds_read_b128 a[128:131], v3 offset:8192
  v_add_f32 v226, v226, v223
  v_mfma_f32_16x16x32_bf16 a[68:71], a[160:163], v[188:191], a[68:71]
  v_exp_f32 v218, v138
  v_cvt_pk_bf16_f32 v179, v222, v223
  v_mfma_f32_16x16x32_bf16 a[72:75], a[164:167], v[184:187], a[72:75]
  ds_read_b128 a[132:135], v3 offset:9216
  buffer_load_dwordx4 v2, s[48:51], s27 offen offset:2048 sc1 lds
  v_mfma_f32_16x16x32_bf16 a[76:79], a[164:167], v[188:191], a[76:79]
  v_exp_f32 v219, v139
  v_add_f32 v227, v216, v217
  v_mfma_f32_16x16x32_bf16 a[80:83], a[168:171], v[184:187], a[80:83]
  ds_read_b128 a[136:139], v3 offset:10240
  v_cvt_pk_bf16_f32 v180, v216, v217
  v_add_f32 v227, v227, v218
  v_mfma_f32_16x16x32_bf16 a[84:87], a[168:171], v[188:191], a[84:87]
  buffer_load_dwordx4 a[220:223], v2, s[40:43], s14 offen offset:3072 sc1
  v_add_f32 v227, v227, v219
  v_mfma_f32_16x16x32_bf16 a[88:91], a[172:175], v[184:187], a[88:91]
  ds_read_b128 a[140:143], v3 offset:11264
  v_cvt_pk_bf16_f32 v181, v218, v219
  v_exp_f32 v220, v140
  v_mfma_f32_16x16x32_bf16 a[92:95], a[172:175], v[188:191], a[92:95]
  s_waitcnt lgkmcnt(4)
  v_exp_f32 v221, v141
  v_mfma_f32_16x16x32_bf16 a[96:99], a[176:179], v[184:187], a[96:99]
  ds_read_b128 a[144:147], v3 offset:12288
  buffer_load_dwordx4 v2, s[48:51], s27 offen offset:3072 sc1 lds
  v_mfma_f32_16x16x32_bf16 a[100:103], a[176:179], v[188:191], a[100:103]
  s_add_u32 s27, s27, 16384
  v_exp_f32 v222, v142
  v_mfma_f32_16x16x32_bf16 a[104:107], a[180:183], v[184:187], a[104:107]
  s_add_u32 s25, s25, 32768
  ds_read_b128 a[148:151], v3 offset:13312
  v_add_f32 v227, v227, v220
  v_add_f32 v227, v227, v221
  v_mfma_f32_16x16x32_bf16 a[108:111], a[180:183], v[188:191], a[108:111]
  s_and_b32 s25, s25, 0x1ffff
  v_exp_f32 v223, v143
  v_mfma_f32_16x16x32_bf16 a[112:115], a[184:187], v[184:187], a[112:115]
  ds_read_b128 a[152:155], v3 offset:14336
  v_cvt_pk_bf16_f32 v182, v220, v221
  v_add_f32 v227, v227, v222
  v_mfma_f32_16x16x32_bf16 a[116:119], a[184:187], v[188:191], a[116:119]
  v_add_f32 v227, v227, v223
  v_cvt_pk_bf16_f32 v183, v222, v223
  v_mfma_f32_16x16x32_bf16 a[120:123], a[188:191], v[184:187], a[120:123]
  s_waitcnt lgkmcnt(3)
  ds_read_b128 a[156:159], v3 offset:15360
  v_max_f32 v5, v226, v227
  v_cmp_lt_f32 vcc, s81, v5
  v_mfma_f32_16x16x32_bf16 a[124:127], a[188:191], v[188:191], a[124:127]
  s_cbranch_vccnz fa_stub19
fa_back19:
  v_add_f32 v230, v230, v226
  v_add_f32 v231, v231, v227
  v_add_u32 v3, 32768, v3
  v_and_b32 v3, 0x1ffff, v3
fa_SSW4:
  v_mfma_f32_16x16x32_bf16 v[128:131], a[128:131], v[64:67], v[200:203]
  s_waitcnt vmcnt(12)
  v_exp_f32 v216, v144
  v_exp_f32 v217, v145
  v_mfma_f32_16x16x32_bf16 v[136:139], a[128:131], v[68:71], v[204:207]
  s_barrier
  v_exp_f32 v218, v146
  v_mfma_f32_16x16x32_bf16 v[132:135], a[132:135], v[64:67], v[200:203]
  ds_read_b128 a[160:163], v3 offset:16384
  ds_read_b128 a[164:167], v3 offset:17408
  v_mfma_f32_16x16x32_bf16 v[140:143], a[132:135], v[68:71], v[204:207]
  s_mov_b32 m0, s24
  v_exp_f32 v219, v147
  v_mfma_f32_16x16x32_bf16 v[128:131], a[136:139], v[72:75], v[128:131]
  ds_read_b128 a[168:171], v3 offset:18432
  buffer_load_dwordx4 v2, s[44:47], s26 offen offset:0 sc1 lds
  v_add_f32 v226, v216, v217
  v_mfma_f32_16x16x32_bf16 v[136:139], a[136:139], v[76:79], v[136:139]
  v_exp_f32 v220, v148
  v_mfma_f32_16x16x32_bf16 v[132:135], a[140:143], v[72:75], v[132:135]
  ds_read_b128 a[172:175], v3 offset:19456
  v_cvt_pk_bf16_f32 v184, v216, v217
  v_add_f32 v226, v226, v218
  v_mfma_f32_16x16x32_bf16 v[140:143], a[140:143], v[76:79], v[140:143]
  s_add_u32 s14, s13, 24576
  s_waitcnt lgkmcnt(4)
  buffer_load_dwordx4 a[224:227], v2, s[40:43], s14 offen offset:0 sc1
  v_add_f32 v226, v226, v219
  v_mfma_f32_16x16x32_bf16 v[128:131], a[144:147], v[80:83], v[128:131]
  ds_read_b128 a[176:179], v3 offset:20480
  v_cvt_pk_bf16_f32 v185, v218, v219
  v_add_f32 v226, v226, v220
  v_mfma_f32_16x16x32_bf16 v[136:139], a[144:147], v[84:87], v[136:139]
  v_exp_f32 v221, v149
  v_mfma_f32_16x16x32_bf16 v[132:135], a[148:151], v[80:83], v[132:135]
  ds_read_b128 a[180:183], v3 offset:21504
  buffer_load_dwordx4 v2, s[44:47], s26 offen offset:1024 sc1 lds
  v_add_f32 v226, v226, v221
  v_mfma_f32_16x16x32_bf16 v[140:143], a[148:151], v[84:87], v[140:143]
  v_exp_f32 v222, v150
  v_cvt_pk_bf16_f32 v186, v220, v221
  v_mfma_f32_16x16x32_bf16 v[128:131], a[152:155], v[88:91], v[128:131]
  ds_read_b128 a[184:187], v3 offset:22528
  v_add_f32 v226, v226, v222
  v_mfma_f32_16x16x32_bf16 v[136:139], a[152:155], v[92:95], v[136:139]
  v_exp_f32 v223, v151
  v_exp_f32 v216, v152
  v_mfma_f32_16x16x32_bf16 v[132:135], a[156:159], v[88:91], v[132:135]
  ds_read_b128 a[188:191], v3 offset:23552
  buffer_load_dwordx4 a[228:231], v2, s[40:43], s14 offen offset:1024 sc1
  v_mfma_f32_16x16x32_bf16 v[140:143], a[156:159], v[92:95], v[140:143]
  s_waitcnt lgkmcnt(4)
  v_exp_f32 v217, v153
  v_mfma_f32_16x16x32_bf16 a[64:67], a[160:163], v[176:179], a[64:67]
  ds_read_b128 a[128:131], v3 offset:0
  v_add_f32 v226, v226, v223
  v_mfma_f32_16x16x32_bf16 a[68:71], a[160:163], v[180:183], a[68:71]
  v_exp_f32 v218, v154
  v_cvt_pk_bf16_f32 v187, v222, v223
  v_mfma_f32_16x16x32_bf16 a[72:75], a[164:167], v[176:179], a[72:75]
  ds_read_b128 a[132:135], v3 offset:1024
  buffer_load_dwordx4 v2, s[44:47], s26 offen offset:2048 sc1 lds
  v_mfma_f32_16x16x32_bf16 a[76:79], a[164:167], v[180:183], a[76:79]
  v_exp_f32 v219, v155
  v_add_f32 v227, v216, v217
  v_mfma_f32_16x16x32_bf16 a[80:83], a[168:171], v[176:179], a[80:83]
  ds_read_b128 a[136:139], v3 offset:2048
  v_cvt_pk_bf16_f32 v188, v216, v217
  v_add_f32 v227, v227, v218
  v_mfma_f32_16x16x32_bf16 a[84:87], a[168:171], v[180:183], a[84:87]
  buffer_load_dwordx4 a[232:235], v2, s[40:43], s14 offen offset:2048 sc1
  v_add_f32 v227, v227, v219
  v_mfma_f32_16x16x32_bf16 a[88:91], a[172:175], v[176:179], a[88:91]
  ds_read_b128 a[140:143], v3 offset:3072
  v_cvt_pk_bf16_f32 v189, v218, v219
  v_exp_f32 v220, v156
  v_mfma_f32_16x16x32_bf16 a[92:95], a[172:175], v[180:183], a[92:95]
  s_waitcnt lgkmcnt(4)
  v_exp_f32 v221, v157
  v_mfma_f32_16x16x32_bf16 a[96:99], a[176:179], v[176:179], a[96:99]
  ds_read_b128 a[144:147], v3 offset:4096
  buffer_load_dwordx4 v2, s[44:47], s26 offen offset:3072 sc1 lds
  v_mfma_f32_16x16x32_bf16 a[100:103], a[176:179], v[180:183], a[100:103]
  s_add_u32 s26, s26, 16384
  v_exp_f32 v222, v158
  v_mfma_f32_16x16x32_bf16 a[104:107], a[180:183], v[176:179], a[104:107]
  s_add_u32 s24, s24, 32768
  ds_read_b128 a[148:151], v3 offset:5120
  v_add_f32 v227, v227, v220
  v_add_f32 v227, v227, v221
  v_mfma_f32_16x16x32_bf16 a[108:111], a[180:183], v[180:183], a[108:111]
  s_and_b32 s24, s24, 0x1ffff
  v_exp_f32 v223, v159
  v_mfma_f32_16x16x32_bf16 a[112:115], a[184:187], v[176:179], a[112:115]
  ds_read_b128 a[152:155], v3 offset:6144
  v_cvt_pk_bf16_f32 v190, v220, v221
  v_add_f32 v227, v227, v222
  v_mfma_f32_16x16x32_bf16 a[116:119], a[184:187], v[180:183], a[116:119]
  v_add_f32 v227, v227, v223
  v_cvt_pk_bf16_f32 v191, v222, v223
  v_mfma_f32_16x16x32_bf16 a[120:123], a[188:191], v[176:179], a[120:123]
  s_waitcnt lgkmcnt(3)
  ds_read_b128 a[156:159], v3 offset:7168
  v_max_f32 v5, v226, v227
  v_cmp_lt_f32 vcc, s81, v5
  v_mfma_f32_16x16x32_bf16 a[124:127], a[188:191], v[180:183], a[124:127]
  s_cbranch_vccnz fa_stub20
fa_back20:
  v_add_f32 v230, v230, v226
  v_add_f32 v231, v231, v227
  v_mfma_f32_16x16x32_bf16 v[144:147], a[128:131], v[64:67], v[200:203]
  ds_read_b128 a[160:163], v3 offset:24576
  v_exp_f32 v216, v128
  v_mfma_f32_16x16x32_bf16 v[152:155], a[128:131], v[68:71], v[204:207]
  v_exp_f32 v217, v129
  v_mfma_f32_16x16x32_bf16 v[148:151], a[132:135], v[64:67], v[200:203]
  ds_read_b128 a[164:167], v3 offset:25600
  v_add_f32 v226, v216, v217
  v_cvt_pk_bf16_f32 v176, v216, v217
  v_mfma_f32_16x16x32_bf16 v[156:159], a[132:135], v[68:71], v[204:207]
  s_mov_b32 m0, s25
  v_exp_f32 v218, v130
  v_mfma_f32_16x16x32_bf16 v[144:147], a[136:139], v[72:75], v[144:147]
  ds_read_b128 a[168:171], v3 offset:26624
  buffer_load_dwordx4 v2, s[48:51], s27 offen offset:0 sc1 lds
  v_add_f32 v226, v226, v218
  v_mfma_f32_16x16x32_bf16 v[152:155], a[136:139], v[76:79], v[152:155]
  v_exp_f32 v219, v131
  v_mfma_f32_16x16x32_bf16 v[148:151], a[140:143], v[72:75], v[148:151]
  ds_read_b128 a[172:175], v3 offset:27648
  v_add_f32 v226, v226, v219
  v_cvt_pk_bf16_f32 v177, v218, v219
  v_mfma_f32_16x16x32_bf16 v[156:159], a[140:143], v[76:79], v[156:159]
  s_add_u32 s14, s13, 24576
  s_waitcnt lgkmcnt(4)
  buffer_load_dwordx4 a[236:239], v2, s[40:43], s14 offen offset:3072 sc1
  v_exp_f32 v220, v132
  v_mfma_f32_16x16x32_bf16 v[144:147], a[144:147], v[80:83], v[144:147]
  ds_read_b128 a[176:179], v3 offset:28672
  v_add_f32 v226, v226, v220
  v_mfma_f32_16x16x32_bf16 v[152:155], a[144:147], v[84:87], v[152:155]
  v_exp_f32 v221, v133
  v_mfma_f32_16x16x32_bf16 v[148:151], a[148:151], v[80:83], v[148:151]
  ds_read_b128 a[180:183], v3 offset:29696
  buffer_load_dwordx4 v2, s[48:51], s27 offen offset:1024 sc1 lds
  v_add_f32 v226, v226, v221
  v_mfma_f32_16x16x32_bf16 v[156:159], a[148:151], v[84:87], v[156:159]
  v_exp_f32 v222, v134
  v_cvt_pk_bf16_f32 v178, v220, v221
  v_mfma_f32_16x16x32_bf16 v[144:147], a[152:155], v[88:91], v[144:147]
  ds_read_b128 a[184:187], v3 offset:30720
  v_add_f32 v226, v226, v222
  v_mfma_f32_16x16x32_bf16 v[152:155], a[152:155], v[92:95], v[152:155]
  v_exp_f32 v223, v135
  v_exp_f32 v216, v136
  v_mfma_f32_16x16x32_bf16 v[148:151], a[156:159], v[88:91], v[148:151]
  s_add_u32 s14, s13, 28672
  ds_read_b128 a[188:191], v3 offset:31744
  buffer_load_dwordx4 a[240:243], v2, s[40:43], s14 offen offset:0 sc1
  v_mfma_f32_16x16x32_bf16 v[156:159], a[156:159], v[92:95], v[156:159]
  s_waitcnt lgkmcnt(4)
  v_exp_f32 v217, v137
  v_mfma_f32_16x16x32_bf16 a[64:67], a[160:163], v[184:187], a[64:67]
  ds_read_b128 a[128:131], v3 offset:8192
  v_add_f32 v226, v226, v223
  v_mfma_f32_16x16x32_bf16 a[68:71], a[160:163], v[188:191], a[68:71]
  v_exp_f32 v218, v138
  v_cvt_pk_bf16_f32 v179, v222, v223
  v_mfma_f32_16x16x32_bf16 a[72:75], a[164:167], v[184:187], a[72:75]
  ds_read_b128 a[132:135], v3 offset:9216
  buffer_load_dwordx4 v2, s[48:51], s27 offen offset:2048 sc1 lds
  v_mfma_f32_16x16x32_bf16 a[76:79], a[164:167], v[188:191], a[76:79]
  v_exp_f32 v219, v139
  v_add_f32 v227, v216, v217
  v_mfma_f32_16x16x32_bf16 a[80:83], a[168:171], v[184:187], a[80:83]
  ds_read_b128 a[136:139], v3 offset:10240
  v_cvt_pk_bf16_f32 v180, v216, v217
  v_add_f32 v227, v227, v218
  v_mfma_f32_16x16x32_bf16 a[84:87], a[168:171], v[188:191], a[84:87]
  buffer_load_dwordx4 a[244:247], v2, s[40:43], s14 offen offset:1024 sc1
  v_add_f32 v227, v227, v219
  v_mfma_f32_16x16x32_bf16 a[88:91], a[172:175], v[184:187], a[88:91]
  ds_read_b128 a[140:143], v3 offset:11264
  v_cvt_pk_bf16_f32 v181, v218, v219
  v_exp_f32 v220, v140
  v_mfma_f32_16x16x32_bf16 a[92:95], a[172:175], v[188:191], a[92:95]
  s_waitcnt lgkmcnt(4)
  v_exp_f32 v221, v141
  v_mfma_f32_16x16x32_bf16 a[96:99], a[176:179], v[184:187], a[96:99]
  ds_read_b128 a[144:147], v3 offset:12288
  buffer_load_dwordx4 v2, s[48:51], s27 offen offset:3072 sc1 lds
  v_mfma_f32_16x16x32_bf16 a[100:103], a[176:179], v[188:191], a[100:103]
  s_add_u32 s27, s27, 16384
  v_exp_f32 v222, v142
  v_mfma_f32_16x16x32_bf16 a[104:107], a[180:183], v[184:187], a[104:107]
  s_add_u32 s25, s25, 32768
  ds_read_b128 a[148:151], v3 offset:13312
  v_add_f32 v227, v227, v220
  v_add_f32 v227, v227, v221
  v_mfma_f32_16x16x32_bf16 a[108:111], a[180:183], v[188:191], a[108:111]
  s_and_b32 s25, s25, 0x1ffff
  v_exp_f32 v223, v143
  v_mfma_f32_16x16x32_bf16 a[112:115], a[184:187], v[184:187], a[112:115]
  ds_read_b128 a[152:155], v3 offset:14336
  v_cvt_pk_bf16_f32 v182, v220, v221
  v_add_f32 v227, v227, v222
  v_mfma_f32_16x16x32_bf16 a[116:119], a[184:187], v[188:191], a[116:119]
  v_add_f32 v227, v227, v223
  v_cvt_pk_bf16_f32 v183, v222, v223
  v_mfma_f32_16x16x32_bf16 a[120:123], a[188:191], v[184:187], a[120:123]
  s_waitcnt lgkmcnt(3)
  ds_read_b128 a[156:159], v3 offset:15360
  v_max_f32 v5, v226, v227
  v_cmp_lt_f32 vcc, s81, v5
  v_mfma_f32_16x16x32_bf16 a[124:127], a[188:191], v[188:191], a[124:127]
  s_cbranch_vccnz fa_stub21
fa_back21:
  v_add_f32 v230, v230, v226
  v_add_f32 v231, v231, v227
  v_add_u32 v3, 32768, v3
  v_and_b32 v3, 0x1ffff, v3
fa_SSW3:
  v_mfma_f32_16x16x32_bf16 v[128:131], a[128:131], v[64:67], v[200:203]
  s_waitcnt vmcnt(12)
  v_exp_f32 v216, v144
  v_exp_f32 v217, v145
  v_mfma_f32_16x16x32_bf16 v[136:139], a[128:131], v[68:71], v[204:207]
  s_barrier
  v_exp_f32 v218, v146
  v_mfma_f32_16x16x32_bf16 v[132:135], a[132:135], v[64:67], v[200:203]
  ds_read_b128 a[160:163], v3 offset:16384
  ds_read_b128 a[164:167], v3 offset:17408
  v_mfma_f32_16x16x32_bf16 v[140:143], a[132:135], v[68:71], v[204:207]
  s_mov_b32 m0, s24
  v_exp_f32 v219, v147
  v_mfma_f32_16x16x32_bf16 v[128:131], a[136:139], v[72:75], v[128:131]
  ds_read_b128 a[168:171], v3 offset:18432
  buffer_load_dwordx4 v2, s[44:47], s26 offen offset:0 sc1 lds
  v_add_f32 v226, v216, v217
  v_mfma_f32_16x16x32_bf16 v[136:139], a[136:139], v[76:79], v[136:139]
  v_exp_f32 v220, v148
  v_mfma_f32_16x16x32_bf16 v[132:135], a[140:143], v[72:75], v[132:135]
  ds_read_b128 a[172:175], v3 offset:19456
  v_cvt_pk_bf16_f32 v184, v216, v217
  v_add_f32 v226, v226, v218
  v_mfma_f32_16x16x32_bf16 v[140:143], a[140:143], v[76:79], v[140:143]
  s_add_u32 s14, s13, 28672
  s_waitcnt lgkmcnt(4)
  buffer_load_dwordx4 a[248:251], v2, s[40:43], s14 offen offset:2048 sc1
  v_add_f32 v226, v226, v219
  v_mfma_f32_16x16x32_bf16 v[128:131], a[144:147], v[80:83], v[128:131]
  ds_read_b128 a[176:179], v3 offset:20480
  v_cvt_pk_bf16_f32 v185, v218, v219
  v_add_f32 v226, v226, v220
  v_mfma_f32_16x16x32_bf16 v[136:139], a[144:147], v[84:87], v[136:139]
  v_exp_f32 v221, v149
  v_mfma_f32_16x16x32_bf16 v[132:135], a[148:151], v[80:83], v[132:135]
  ds_read_b128 a[180:183], v3 offset:21504
  buffer_load_dwordx4 v2, s[44:47], s26 offen offset:1024 sc1 lds
  v_add_f32 v226, v226, v221
  v_mfma_f32_16x16x32_bf16 v[140:143], a[148:151], v[84:87], v[140:143]
  v_exp_f32 v222, v150
  v_cvt_pk_bf16_f32 v186, v220, v221
  v_mfma_f32_16x16x32_bf16 v[128:131], a[152:155], v[88:91], v[128:131]
  ds_read_b128 a[184:187], v3 offset:22528
  v_add_f32 v226, v226, v222
  v_mfma_f32_16x16x32_bf16 v[136:139], a[152:155], v[92:95], v[136:139]
  v_exp_f32 v223, v151
  v_exp_f32 v216, v152
  v_mfma_f32_16x16x32_bf16 v[132:135], a[156:159], v[88:91], v[132:135]
  ds_read_b128 a[188:191], v3 offset:23552
  buffer_load_dwordx4 a[252:255], v2, s[40:43], s14 offen offset:3072 sc1
  v_mfma_f32_16x16x32_bf16 v[140:143], a[156:159], v[92:95], v[140:143]
  s_waitcnt lgkmcnt(4)
  v_exp_f32 v217, v153
  v_mfma_f32_16x16x32_bf16 a[64:67], a[160:163], v[176:179], a[64:67]
  ds_read_b128 a[128:131], v3 offset:0
  v_add_f32 v226, v226, v223
  v_mfma_f32_16x16x32_bf16 a[68:71], a[160:163], v[180:183], a[68:71]
  v_exp_f32 v218, v154
  v_cvt_pk_bf16_f32 v187, v222, v223
  v_mfma_f32_16x16x32_bf16 a[72:75], a[164:167], v[176:179], a[72:75]
  ds_read_b128 a[132:135], v3 offset:1024
  buffer_load_dwordx4 v2, s[44:47], s26 offen offset:2048 sc1 lds
  v_mfma_f32_16x16x32_bf16 a[76:79], a[164:167], v[180:183], a[76:79]
  v_exp_f32 v219, v155
  v_add_f32 v227, v216, v217
  v_mfma_f32_16x16x32_bf16 a[80:83], a[168:171], v[176:179], a[80:83]
  ds_read_b128 a[136:139], v3 offset:2048
  v_cvt_pk_bf16_f32 v188, v216, v217
  v_add_f32 v227, v227, v218
  v_mfma_f32_16x16x32_bf16 a[84:87], a[168:171], v[180:183], a[84:87]
  s_add_u32 s14, s13, 32768
  buffer_load_dwordx4 v[32:35], v2, s[40:43], s14 offen offset:0 sc1
  v_add_f32 v227, v227, v219
  v_mfma_f32_16x16x32_bf16 a[88:91], a[172:175], v[176:179], a[88:91]
  ds_read_b128 a[140:143], v3 offset:3072
  v_cvt_pk_bf16_f32 v189, v218, v219
  v_exp_f32 v220, v156
  v_mfma_f32_16x16x32_bf16 a[92:95], a[172:175], v[180:183], a[92:95]
  s_waitcnt lgkmcnt(4)
  v_exp_f32 v221, v157
  v_mfma_f32_16x16x32_bf16 a[96:99], a[176:179], v[176:179], a[96:99]
  ds_read_b128 a[144:147], v3 offset:4096
  buffer_load_dwordx4 v2, s[44:47], s26 offen offset:3072 sc1 lds
  v_mfma_f32_16x16x32_bf16 a[100:103], a[176:179], v[180:183], a[100:103]
  s_add_u32 s26, s26, 16384
  v_exp_f32 v222, v158
  v_mfma_f32_16x16x32_bf16 a[104:107], a[180:183], v[176:179], a[104:107]
  s_add_u32 s24, s24, 32768
  ds_read_b128 a[148:151], v3 offset:5120
  v_add_f32 v227, v227, v220
  v_add_f32 v227, v227, v221
  v_mfma_f32_16x16x32_bf16 a[108:111], a[180:183], v[180:183], a[108:111]
  s_and_b32 s24, s24, 0x1ffff
  v_exp_f32 v223, v159
  v_mfma_f32_16x16x32_bf16 a[112:115], a[184:187], v[176:179], a[112:115]
  ds_read_b128 a[152:155], v3 offset:6144
  v_cvt_pk_bf16_f32 v190, v220, v221
  v_add_f32 v227, v227, v222
  v_mfma_f32_16x16x32_bf16 a[116:119], a[184:187], v[180:183], a[116:119]
  v_add_f32 v227, v227, v223
  v_cvt_pk_bf16_f32 v191, v222, v223
  v_mfma_f32_16x16x32_bf16 a[120:123], a[188:191], v[176:179], a[120:123]
  s_waitcnt lgkmcnt(3)
  ds_read_b128 a[156:159], v3 offset:7168
  v_max_f32 v5, v226, v227
  v_cmp_lt_f32 vcc, s81, v5
  v_mfma_f32_16x16x32_bf16 a[124:127], a[188:191], v[180:183], a[124:127]
  s_cbranch_vccnz fa_stub22
fa_back22:
  v_add_f32 v230, v230, v226
  v_add_f32 v231, v231, v227
  v_mfma_f32_16x16x32_bf16 v[144:147], a[128:131], v[64:67], v[200:203]
  ds_read_b128 a[160:163], v3 offset:24576
  v_exp_f32 v216, v128
  v_mfma_f32_16x16x32_bf16 v[152:155], a[128:131], v[68:71], v[204:207]
  v_exp_f32 v217, v129
  v_mfma_f32_16x16x32_bf16 v[148:151], a[132:135], v[64:67], v[200:203]
  ds_read_b128 a[164:167], v3 offset:25600
  v_add_f32 v226, v216, v217
  v_cvt_pk_bf16_f32 v176, v216, v217
  v_mfma_f32_16x16x32_bf16 v[156:159], a[132:135], v[68:71], v[204:207]
  s_mov_b32 m0, s25
  v_exp_f32 v218, v130
  v_mfma_f32_16x16x32_bf16 v[144:147], a[136:139], v[72:75], v[144:147]
  ds_read_b128 a[168:171], v3 offset:26624
  buffer_load_dwordx4 v2, s[48:51], s27 offen offset:0 sc1 lds
  v_add_f32 v226, v226, v218
  v_mfma_f32_16x16x32_bf16 v[152:155], a[136:139], v[76:79], v[152:155]
  v_exp_f32 v219, v131
  v_mfma_f32_16x16x32_bf16 v[148:151], a[140:143], v[72:75], v[148:151]
  ds_read_b128 a[172:175], v3 offset:27648
  v_add_f32 v226, v226, v219
  v_cvt_pk_bf16_f32 v177, v218, v219
  v_mfma_f32_16x16x32_bf16 v[156:159], a[140:143], v[76:79], v[156:159]
  s_add_u32 s14, s13, 32768
  s_waitcnt lgkmcnt(4)
  buffer_load_dwordx4 v[36:39], v2, s[40:43], s14 offen offset:1024 sc1
  v_exp_f32 v220, v132
  v_mfma_f32_16x16x32_bf16 v[144:147], a[144:147], v[80:83], v[144:147]
  ds_read_b128 a[176:179], v3 offset:28672
  v_add_f32 v226, v226, v220
  v_mfma_f32_16x16x32_bf16 v[152:155], a[144:147], v[84:87], v[152:155]
  v_exp_f32 v221, v133
  v_mfma_f32_16x16x32_bf16 v[148:151], a[148:151], v[80:83], v[148:151]
  ds_read_b128 a[180:183], v3 offset:29696
  buffer_load_dwordx4 v2, s[48:51], s27 offen offset:1024 sc1 lds
  v_add_f32 v226, v226, v221
  v_mfma_f32_16x16x32_bf16 v[156:159], a[148:151], v[84:87], v[156:159]
  v_exp_f32 v222, v134
  v_cvt_pk_bf16_f32 v178, v220, v221
  v_mfma_f32_16x16x32_bf16 v[144:147], a[152:155], v[88:91], v[144:147]
  ds_read_b128 a[184:187], v3 offset:30720
  v_add_f32 v226, v226, v222
  v_mfma_f32_16x16x32_bf16 v[152:155], a[152:155], v[92:95], v[152:155]
  v_exp_f32 v223, v135
  v_exp_f32 v216, v136
  v_mfma_f32_16x16x32_bf16 v[148:151], a[156:159], v[88:91], v[148:151]
  ds_read_b128 a[188:191], v3 offset:31744
  buffer_load_dwordx4 v[40:43], v2, s[40:43], s14 offen offset:2048 sc1
  v_mfma_f32_16x16x32_bf16 v[156:159], a[156:159], v[92:95], v[156:159]
  s_waitcnt lgkmcnt(4)
  v_exp_f32 v217, v137
  v_mfma_f32_16x16x32_bf16 a[64:67], a[160:163], v[184:187], a[64:67]
  ds_read_b128 a[128:131], v3 offset:8192
  v_add_f32 v226, v226, v223
  v_mfma_f32_16x16x32_bf16 a[68:71], a[160:163], v[188:191], a[68:71]
  v_exp_f32 v218, v138
  v_cvt_pk_bf16_f32 v179, v222, v223
  v_mfma_f32_16x16x32_bf16 a[72:75], a[164:167], v[184:187], a[72:75]
  ds_read_b128 a[132:135], v3 offset:9216
  buffer_load_dwordx4 v2, s[48:51], s27 offen offset:2048 sc1 lds
  v_mfma_f32_16x16x32_bf16 a[76:79], a[164:167], v[188:191], a[76:79]
  v_exp_f32 v219, v139
  v_add_f32 v227, v216, v217
  v_mfma_f32_16x16x32_bf16 a[80:83], a[168:171], v[184:187], a[80:83]
  ds_read_b128 a[136:139], v3 offset:10240
  v_cvt_pk_bf16_f32 v180, v216, v217
  v_add_f32 v227, v227, v218
  v_mfma_f32_16x16x32_bf16 a[84:87], a[168:171], v[188:191], a[84:87]
  buffer_load_dwordx4 v[44:47], v2, s[40:43], s14 offen offset:3072 sc1
  v_add_f32 v227, v227, v219
  v_mfma_f32_16x16x32_bf16 a[88:91], a[172:175], v[184:187], a[88:91]
  ds_read_b128 a[140:143], v3 offset:11264
  v_cvt_pk_bf16_f32 v181, v218, v219
  v_exp_f32 v220, v140
  v_mfma_f32_16x16x32_bf16 a[92:95], a[172:175], v[188:191], a[92:95]
  s_waitcnt lgkmcnt(4)
  v_exp_f32 v221, v141
  v_mfma_f32_16x16x32_bf16 a[96:99], a[176:179], v[184:187], a[96:99]
  ds_read_b128 a[144:147], v3 offset:12288
  buffer_load_dwordx4 v2, s[48:51], s27 offen offset:3072 sc1 lds
  v_mfma_f32_16x16x32_bf16 a[100:103], a[176:179], v[188:191], a[100:103]
  s_add_u32 s27, s27, 16384
  v_exp_f32 v222, v142
  v_mfma_f32_16x16x32_bf16 a[104:107], a[180:183], v[184:187], a[104:107]
  s_add_u32 s25, s25, 32768
  ds_read_b128 a[148:151], v3 offset:13312
  v_add_f32 v227, v227, v220
  v_add_f32 v227, v227, v221
  v_mfma_f32_16x16x32_bf16 a[108:111], a[180:183], v[188:191], a[108:111]
  s_and_b32 s25, s25, 0x1ffff
  v_exp_f32 v223, v143
  v_mfma_f32_16x16x32_bf16 a[112:115], a[184:187], v[184:187], a[112:115]
  ds_read_b128 a[152:155], v3 offset:14336
  v_cvt_pk_bf16_f32 v182, v220, v221
  v_add_f32 v227, v227, v222
  v_mfma_f32_16x16x32_bf16 a[116:119], a[184:187], v[188:191], a[116:119]
  v_add_f32 v227, v227, v223
  v_cvt_pk_bf16_f32 v183, v222, v223
  v_mfma_f32_16x16x32_bf16 a[120:123], a[188:191], v[184:187], a[120:123]
  s_waitcnt lgkmcnt(3)
  ds_read_b128 a[156:159], v3 offset:15360
  v_max_f32 v5, v226, v227
  v_cmp_lt_f32 vcc, s81, v5
  v_mfma_f32_16x16x32_bf16 a[124:127], a[188:191], v[188:191], a[124:127]
  s_cbranch_vccnz fa_stub23
fa_back23:
  v_add_f32 v230, v230, v226
  v_add_f32 v231, v231, v227
  v_add_u32 v3, 32768, v3
  v_and_b32 v3, 0x1ffff, v3
fa_SSW2:
  v_mfma_f32_16x16x32_bf16 v[128:131], a[128:131], v[64:67], v[200:203]
  s_waitcnt vmcnt(12)
  v_exp_f32 v216, v144
  v_exp_f32 v217, v145
  v_mfma_f32_16x16x32_bf16 v[136:139], a[128:131], v[68:71], v[204:207]
  s_barrier
  v_exp_f32 v218, v146
  v_mfma_f32_16x16x32_bf16 v[132:135], a[132:135], v[64:67], v[200:203]
  ds_read_b128 a[160:163], v3 offset:16384
  ds_read_b128 a[164:167], v3 offset:17408
  v_mfma_f32_16x16x32_bf16 v[140:143], a[132:135], v[68:71], v[204:207]
  s_mov_b32 m0, s24
  v_exp_f32 v219, v147
  v_mfma_f32_16x16x32_bf16 v[128:131], a[136:139], v[72:75], v[128:131]
  ds_read_b128 a[168:171], v3 offset:18432
  buffer_load_dwordx4 v2, s[44:47], s26 offen offset:0 sc1 lds
  v_add_f32 v226, v216, v217
  v_mfma_f32_16x16x32_bf16 v[136:139], a[136:139], v[76:79], v[136:139]
  v_exp_f32 v220, v148
  v_mfma_f32_16x16x32_bf16 v[132:135], a[140:143], v[72:75], v[132:135]
  ds_read_b128 a[172:175], v3 offset:19456
  v_cvt_pk_bf16_f32 v184, v216, v217
  v_add_f32 v226, v226, v218
  v_mfma_f32_16x16x32_bf16 v[140:143], a[140:143], v[76:79], v[140:143]
  s_add_u32 s14, s13, 36864
  s_waitcnt lgkmcnt(4)
  buffer_load_dwordx4 v[48:51], v2, s[40:43], s14 offen offset:0 sc1
  v_add_f32 v226, v226, v219
  v_mfma_f32_16x16x32_bf16 v[128:131], a[144:147], v[80:83], v[128:131]
  ds_read_b128 a[176:179], v3 offset:20480
  v_cvt_pk_bf16_f32 v185, v218, v219
  v_add_f32 v226, v226, v220
  v_mfma_f32_16x16x32_bf16 v[136:139], a[144:147], v[84:87], v[136:139]
  v_exp_f32 v221, v149
  v_mfma_f32_16x16x32_bf16 v[132:135], a[148:151], v[80:83], v[132:135]
  ds_read_b128 a[180:183], v3 offset:21504
  buffer_load_dwordx4 v2, s[44:47], s26 offen offset:1024 sc1 lds
  v_add_f32 v226, v226, v221
  v_mfma_f32_16x16x32_bf16 v[140:143], a[148:151], v[84:87], v[140:143]
  v_exp_f32 v222, v150
  v_cvt_pk_bf16_f32 v186, v220, v221
  v_mfma_f32_16x16x32_bf16 v[128:131], a[152:155], v[88:91], v[128:131]
  ds_read_b128 a[184:187], v3 offset:22528
  v_add_f32 v226, v226, v222
  v_mfma_f32_16x16x32_bf16 v[136:139], a[152:155], v[92:95], v[136:139]
  v_exp_f32 v223, v151
  v_exp_f32 v216, v152
  v_mfma_f32_16x16x32_bf16 v[132:135], a[156:159], v[88:91], v[132:135]
  ds_read_b128 a[188:191], v3 offset:23552
  buffer_load_dwordx4 v[52:55], v2, s[40:43], s14 offen offset:1024 sc1
  v_mfma_f32_16x16x32_bf16 v[140:143], a[156:159], v[92:95], v[140:143]
  s_waitcnt lgkmcnt(4)
  v_exp_f32 v217, v153
  v_mfma_f32_16x16x32_bf16 a[64:67], a[160:163], v[176:179], a[64:67]
  ds_read_b128 a[128:131], v3 offset:0
  v_add_f32 v226, v226, v223
  v_mfma_f32_16x16x32_bf16 a[68:71], a[160:163], v[180:183], a[68:71]
  v_exp_f32 v218, v154
  v_cvt_pk_bf16_f32 v187, v222, v223
  v_mfma_f32_16x16x32_bf16 a[72:75], a[164:167], v[176:179], a[72:75]
  ds_read_b128 a[132:135], v3 offset:1024
  buffer_load_dwordx4 v2, s[44:47], s26 offen offset:2048 sc1 lds
  v_mfma_f32_16x16x32_bf16 a[76:79], a[164:167], v[180:183], a[76:79]
  v_exp_f32 v219, v155
  v_add_f32 v227, v216, v217
  v_mfma_f32_16x16x32_bf16 a[80:83], a[168:171], v[176:179], a[80:83]
  ds_read_b128 a[136:139], v3 offset:2048
  v_cvt_pk_bf16_f32 v188, v216, v217
  v_add_f32 v227, v227, v218
  v_mfma_f32_16x16x32_bf16 a[84:87], a[168:171], v[180:183], a[84:87]
  buffer_load_dwordx4 v[56:59], v2, s[40:43], s14 offen offset:2048 sc1
  v_add_f32 v227, v227, v219
  v_mfma_f32_16x16x32_bf16 a[88:91], a[172:175], v[176:179], a[88:91]
  ds_read_b128 a[140:143], v3 offset:3072
  v_cvt_pk_bf16_f32 v189, v218, v219
  v_exp_f32 v220, v156
  v_mfma_f32_16x16x32_bf16 a[92:95], a[172:175], v[180:183], a[92:95]
  s_waitcnt lgkmcnt(4)
  v_exp_f32 v221, v157
  v_mfma_f32_16x16x32_bf16 a[96:99], a[176:179], v[176:179], a[96:99]
  ds_read_b128 a[144:147], v3 offset:4096
  buffer_load_dwordx4 v2, s[44:47], s26 offen offset:3072 sc1 lds
  v_mfma_f32_16x16x32_bf16 a[100:103], a[176:179], v[180:183], a[100:103]
  s_add_u32 s26, s26, 16384
  v_exp_f32 v222, v158
  v_mfma_f32_16x16x32_bf16 a[104:107], a[180:183], v[176:179], a[104:107]
  s_add_u32 s24, s24, 32768
  ds_read_b128 a[148:151], v3 offset:5120
  v_add_f32 v227, v227, v220
  v_add_f32 v227, v227, v221
  v_mfma_f32_16x16x32_bf16 a[108:111], a[180:183], v[180:183], a[108:111]
  s_and_b32 s24, s24, 0x1ffff
  v_exp_f32 v223, v159
  v_mfma_f32_16x16x32_bf16 a[112:115], a[184:187], v[176:179], a[112:115]
  ds_read_b128 a[152:155], v3 offset:6144
  v_cvt_pk_bf16_f32 v190, v220, v221
  v_add_f32 v227, v227, v222
  v_mfma_f32_16x16x32_bf16 a[116:119], a[184:187], v[180:183], a[116:119]
  v_add_f32 v227, v227, v223
  v_cvt_pk_bf16_f32 v191, v222, v223
  v_mfma_f32_16x16x32_bf16 a[120:123], a[188:191], v[176:179], a[120:123]
  s_waitcnt lgkmcnt(3)
  ds_read_b128 a[156:159], v3 offset:7168
  v_max_f32 v5, v226, v227
  v_cmp_lt_f32 vcc, s81, v5
  v_mfma_f32_16x16x32_bf16 a[124:127], a[188:191], v[180:183], a[124:127]
  s_cbranch_vccnz fa_stub24
fa_back24:
  v_add_f32 v230, v230, v226
  v_add_f32 v231, v231, v227
  v_mfma_f32_16x16x32_bf16 v[144:147], a[128:131], v[64:67], v[200:203]
  ds_read_b128 a[160:163], v3 offset:24576
  v_exp_f32 v216, v128
  v_mfma_f32_16x16x32_bf16 v[152:155], a[128:131], v[68:71], v[204:207]
  v_exp_f32 v217, v129
  v_mfma_f32_16x16x32_bf16 v[148:151], a[132:135], v[64:67], v[200:203]
  ds_read_b128 a[164:167], v3 offset:25600
  v_add_f32 v226, v216, v217
  v_cvt_pk_bf16_f32 v176, v216, v217
  v_mfma_f32_16x16x32_bf16 v[156:159], a[132:135], v[68:71], v[204:207]
  s_mov_b32 m0, s25
  v_exp_f32 v218, v130
  v_mfma_f32_16x16x32_bf16 v[144:147], a[136:139], v[72:75], v[144:147]
  ds_read_b128 a[168:171], v3 offset:26624
  buffer_load_dwordx4 v2, s[48:51], s27 offen offset:0 sc1 lds
  v_add_f32 v226, v226, v218
  v_mfma_f32_16x16x32_bf16 v[152:155], a[136:139], v[76:79], v[152:155]
  v_exp_f32 v219, v131
  v_mfma_f32_16x16x32_bf16 v[148:151], a[140:143], v[72:75], v[148:151]
  ds_read_b128 a[172:175], v3 offset:27648
  v_add_f32 v226, v226, v219
  v_cvt_pk_bf16_f32 v177, v218, v219
  v_mfma_f32_16x16x32_bf16 v[156:159], a[140:143], v[76:79], v[156:159]
  s_add_u32 s14, s13, 36864
  s_waitcnt lgkmcnt(4)
  buffer_load_dwordx4 v[60:63], v2, s[40:43], s14 offen offset:3072 sc1
  v_exp_f32 v220, v132
  v_mfma_f32_16x16x32_bf16 v[144:147], a[144:147], v[80:83], v[144:147]
  ds_read_b128 a[176:179], v3 offset:28672
  v_add_f32 v226, v226, v220
  v_mfma_f32_16x16x32_bf16 v[152:155], a[144:147], v[84:87], v[152:155]
  v_exp_f32 v221, v133
  v_mfma_f32_16x16x32_bf16 v[148:151], a[148:151], v[80:83], v[148:151]
  ds_read_b128 a[180:183], v3 offset:29696
  buffer_load_dwordx4 v2, s[48:51], s27 offen offset:1024 sc1 lds
  v_add_f32 v226, v226, v221
  v_mfma_f32_16x16x32_bf16 v[156:159], a[148:151], v[84:87], v[156:159]
  v_exp_f32 v222, v134
  v_cvt_pk_bf16_f32 v178, v220, v221
  v_mfma_f32_16x16x32_bf16 v[144:147], a[152:155], v[88:91], v[144:147]
  ds_read_b128 a[184:187], v3 offset:30720
  v_add_f32 v226, v226, v222
  v_mfma_f32_16x16x32_bf16 v[152:155], a[152:155], v[92:95], v[152:155]
  v_exp_f32 v223, v135
  v_exp_f32 v216, v136
  v_mfma_f32_16x16x32_bf16 v[148:151], a[156:159], v[88:91], v[148:151]
  s_add_u32 s14, s13, 40960
  ds_read_b128 a[188:191], v3 offset:31744
  buffer_load_dwordx4 v[96:99], v2, s[40:43], s14 offen offset:0 sc1
  v_mfma_f32_16x16x32_bf16 v[156:159], a[156:159], v[92:95], v[156:159]
  s_waitcnt lgkmcnt(4)
  v_exp_f32 v217, v137
  v_mfma_f32_16x16x32_bf16 a[64:67], a[160:163], v[184:187], a[64:67]
  ds_read_b128 a[128:131], v3 offset:8192
  v_add_f32 v226, v226, v223
  v_mfma_f32_16x16x32_bf16 a[68:71], a[160:163], v[188:191], a[68:71]
  v_exp_f32 v218, v138
  v_cvt_pk_bf16_f32 v179, v222, v223
  v_mfma_f32_16x16x32_bf16 a[72:75], a[164:167], v[184:187], a[72:75]
  ds_read_b128 a[132:135], v3 offset:9216
  buffer_load_dwordx4 v2, s[48:51], s27 offen offset:2048 sc1 lds
  v_mfma_f32_16x16x32_bf16 a[76:79], a[164:167], v[188:191], a[76:79]
  v_exp_f32 v219, v139
  v_add_f32 v227, v216, v217
  v_mfma_f32_16x16x32_bf16 a[80:83], a[168:171], v[184:187], a[80:83]
  ds_read_b128 a[136:139], v3 offset:10240
  v_cvt_pk_bf16_f32 v180, v216, v217
  v_add_f32 v227, v227, v218
  v_mfma_f32_16x16x32_bf16 a[84:87], a[168:171], v[188:191], a[84:87]
  buffer_load_dwordx4 v[100:103], v2, s[40:43], s14 offen offset:1024 sc1
  v_add_f32 v227, v227, v219
  v_mfma_f32_16x16x32_bf16 a[88:91], a[172:175], v[184:187], a[88:91]
  ds_read_b128 a[140:143], v3 offset:11264
  v_cvt_pk_bf16_f32 v181, v218, v219
  v_exp_f32 v220, v140
  v_mfma_f32_16x16x32_bf16 a[92:95], a[172:175], v[188:191], a[92:95]
  s_waitcnt lgkmcnt(4)
  v_exp_f32 v221, v141
  v_mfma_f32_16x16x32_bf16 a[96:99], a[176:179], v[184:187], a[96:99]
  ds_read_b128 a[144:147], v3 offset:12288
  buffer_load_dwordx4 v2, s[48:51], s27 offen offset:3072 sc1 lds
  v_mfma_f32_16x16x32_bf16 a[100:103], a[176:179], v[188:191], a[100:103]
  s_add_u32 s27, s27, 16384
  v_exp_f32 v222, v142
  v_mfma_f32_16x16x32_bf16 a[104:107], a[180:183], v[184:187], a[104:107]
  s_add_u32 s25, s25, 32768
  ds_read_b128 a[148:151], v3 offset:13312
  v_add_f32 v227, v227, v220
  v_add_f32 v227, v227, v221
  v_mfma_f32_16x16x32_bf16 a[108:111], a[180:183], v[188:191], a[108:111]
  s_and_b32 s25, s25, 0x1ffff
  v_exp_f32 v223, v143
  v_mfma_f32_16x16x32_bf16 a[112:115], a[184:187], v[184:187], a[112:115]
  ds_read_b128 a[152:155], v3 offset:14336
  v_cvt_pk_bf16_f32 v182, v220, v221
  v_add_f32 v227, v227, v222
  v_mfma_f32_16x16x32_bf16 a[116:119], a[184:187], v[188:191], a[116:119]
  v_add_f32 v227, v227, v223
  v_cvt_pk_bf16_f32 v183, v222, v223
  v_mfma_f32_16x16x32_bf16 a[120:123], a[188:191], v[184:187], a[120:123]
  s_waitcnt lgkmcnt(3)
  ds_read_b128 a[156:159], v3 offset:15360
  v_max_f32 v5, v226, v227
  v_cmp_lt_f32 vcc, s81, v5
  v_mfma_f32_16x16x32_bf16 a[124:127], a[188:191], v[188:191], a[124:127]
  s_cbranch_vccnz fa_stub25
fa_back25:
  v_add_f32 v230, v230, v226
  v_add_f32 v231, v231, v227
  v_add_u32 v3, 32768, v3
  v_and_b32 v3, 0x1ffff, v3
fa_SSW1:
  v_mfma_f32_16x16x32_bf16 v[128:131], a[128:131], v[64:67], v[200:203]
  s_waitcnt vmcnt(12)
  v_exp_f32 v216, v144
  v_exp_f32 v217, v145
  v_mfma_f32_16x16x32_bf16 v[136:139], a[128:131], v[68:71], v[204:207]
  s_barrier
  v_exp_f32 v218, v146
  v_mfma_f32_16x16x32_bf16 v[132:135], a[132:135], v[64:67], v[200:203]
  ds_read_b128 a[160:163], v3 offset:16384
  ds_read_b128 a[164:167], v3 offset:17408
  v_mfma_f32_16x16x32_bf16 v[140:143], a[132:135], v[68:71], v[204:207]
  s_mov_b32 m0, s24
  v_exp_f32 v219, v147
  v_mfma_f32_16x16x32_bf16 v[128:131], a[136:139], v[72:75], v[128:131]
  ds_read_b128 a[168:171], v3 offset:18432
  buffer_load_dwordx4 v2, s[44:47], s26 offen offset:0 sc1 lds
  v_add_f32 v226, v216, v217
  v_mfma_f32_16x16x32_bf16 v[136:139], a[136:139], v[76:79], v[136:139]
  v_exp_f32 v220, v148
  v_mfma_f32_16x16x32_bf16 v[132:135], a[140:143], v[72:75], v[132:135]
  ds_read_b128 a[172:175], v3 offset:19456
  v_cvt_pk_bf16_f32 v184, v216, v217
  v_add_f32 v226, v226, v218
  v_mfma_f32_16x16x32_bf16 v[140:143], a[140:143], v[76:79], v[140:143]
  s_add_u32 s14, s13, 40960
  s_waitcnt lgkmcnt(4)
  buffer_load_dwordx4 v[104:107], v2, s[40:43], s14 offen offset:2048 sc1
  v_add_f32 v226, v226, v219
  v_mfma_f32_16x16x32_bf16 v[128:131], a[144:147], v[80:83], v[128:131]
  ds_read_b128 a[176:179], v3 offset:20480
  v_cvt_pk_bf16_f32 v185, v218, v219
  v_add_f32 v226, v226, v220
  v_mfma_f32_16x16x32_bf16 v[136:139], a[144:147], v[84:87], v[136:139]
  v_exp_f32 v221, v149
  v_mfma_f32_16x16x32_bf16 v[132:135], a[148:151], v[80:83], v[132:135]
  ds_read_b128 a[180:183], v3 offset:21504
  buffer_load_dwordx4 v2, s[44:47], s26 offen offset:1024 sc1 lds
  v_add_f32 v226, v226, v221
  v_mfma_f32_16x16x32_bf16 v[140:143], a[148:151], v[84:87], v[140:143]
  v_exp_f32 v222, v150
  v_cvt_pk_bf16_f32 v186, v220, v221
  v_mfma_f32_16x16x32_bf16 v[128:131], a[152:155], v[88:91], v[128:131]
  ds_read_b128 a[184:187], v3 offset:22528
  v_add_f32 v226, v226, v222
  v_mfma_f32_16x16x32_bf16 v[136:139], a[152:155], v[92:95], v[136:139]
  v_exp_f32 v223, v151
  v_exp_f32 v216, v152
  v_mfma_f32_16x16x32_bf16 v[132:135], a[156:159], v[88:91], v[132:135]
  ds_read_b128 a[188:191], v3 offset:23552
  buffer_load_dwordx4 v[108:111], v2, s[40:43], s14 offen offset:3072 sc1
  v_mfma_f32_16x16x32_bf16 v[140:143], a[156:159], v[92:95], v[140:143]
  s_waitcnt lgkmcnt(4)
  v_exp_f32 v217, v153
  v_mfma_f32_16x16x32_bf16 a[64:67], a[160:163], v[176:179], a[64:67]
  ds_read_b128 a[128:131], v3 offset:0
  v_add_f32 v226, v226, v223
  v_mfma_f32_16x16x32_bf16 a[68:71], a[160:163], v[180:183], a[68:71]
  v_exp_f32 v218, v154
  v_cvt_pk_bf16_f32 v187, v222, v223
  v_mfma_f32_16x16x32_bf16 a[72:75], a[164:167], v[176:179], a[72:75]
  ds_read_b128 a[132:135], v3 offset:1024
  buffer_load_dwordx4 v2, s[44:47], s26 offen offset:2048 sc1 lds
  v_mfma_f32_16x16x32_bf16 a[76:79], a[164:167], v[180:183], a[76:79]
  v_exp_f32 v219, v155
  v_add_f32 v227, v216, v217
  v_mfma_f32_16x16x32_bf16 a[80:83], a[168:171], v[176:179], a[80:83]
  ds_read_b128 a[136:139], v3 offset:2048
  v_cvt_pk_bf16_f32 v188, v216, v217
  v_add_f32 v227, v227, v218
  v_mfma_f32_16x16x32_bf16 a[84:87], a[168:171], v[180:183], a[84:87]
  s_add_u32 s14, s13, 45056
  buffer_load_dwordx4 v[112:115], v2, s[40:43], s14 offen offset:0 sc1
  v_add_f32 v227, v227, v219
  v_mfma_f32_16x16x32_bf16 a[88:91], a[172:175], v[176:179], a[88:91]
  ds_read_b128 a[140:143], v3 offset:3072
  v_cvt_pk_bf16_f32 v189, v218, v219
  v_exp_f32 v220, v156
  v_mfma_f32_16x16x32_bf16 a[92:95], a[172:175], v[180:183], a[92:95]
  s_waitcnt lgkmcnt(4)
  v_exp_f32 v221, v157
  v_mfma_f32_16x16x32_bf16 a[96:99], a[176:179], v[176:179], a[96:99]
  ds_read_b128 a[144:147], v3 offset:4096
  buffer_load_dwordx4 v2, s[44:47], s26 offen offset:3072 sc1 lds
  v_mfma_f32_16x16x32_bf16 a[100:103], a[176:179], v[180:183], a[100:103]
  s_add_u32 s26, s26, 16384
  v_exp_f32 v222, v158
  v_mfma_f32_16x16x32_bf16 a[104:107], a[180:183], v[176:179], a[104:107]
  s_add_u32 s24, s24, 32768
  ds_read_b128 a[148:151], v3 offset:5120
  v_add_f32 v227, v227, v220
  v_add_f32 v227, v227, v221
  v_mfma_f32_16x16x32_bf16 a[108:111], a[180:183], v[180:183], a[108:111]
  s_and_b32 s24, s24, 0x1ffff
  v_exp_f32 v223, v159
  v_mfma_f32_16x16x32_bf16 a[112:115], a[184:187], v[176:179], a[112:115]
  ds_read_b128 a[152:155], v3 offset:6144
  v_cvt_pk_bf16_f32 v190, v220, v221
  v_add_f32 v227, v227, v222
  v_mfma_f32_16x16x32_bf16 a[116:119], a[184:187], v[180:183], a[116:119]
  v_add_f32 v227, v227, v223
  v_cvt_pk_bf16_f32 v191, v222, v223
  v_mfma_f32_16x16x32_bf16 a[120:123], a[188:191], v[176:179], a[120:123]
  s_waitcnt lgkmcnt(3)
  ds_read_b128 a[156:159], v3 offset:7168
  v_max_f32 v5, v226, v227
  v_cmp_lt_f32 vcc, s81, v5
  v_mfma_f32_16x16x32_bf16 a[124:127], a[188:191], v[180:183], a[124:127]
  s_cbranch_vccnz fa_stub26
fa_back26:
  v_add_f32 v230, v230, v226
  v_add_f32 v231, v231, v227
  v_mfma_f32_16x16x32_bf16 v[144:147], a[128:131], v[64:67], v[200:203]
  ds_read_b128 a[160:163], v3 offset:24576
  v_exp_f32 v216, v128
  v_mfma_f32_16x16x32_bf16 v[152:155], a[128:131], v[68:71], v[204:207]
  v_exp_f32 v217, v129
  v_mfma_f32_16x16x32_bf16 v[148:151], a[132:135], v[64:67], v[200:203]
  ds_read_b128 a[164:167], v3 offset:25600
  v_add_f32 v226, v216, v217
  v_cvt_pk_bf16_f32 v176, v216, v217
  v_mfma_f32_16x16x32_bf16 v[156:159], a[132:135], v[68:71], v[204:207]
  s_mov_b32 m0, s25
  v_exp_f32 v218, v130
  v_mfma_f32_16x16x32_bf16 v[144:147], a[136:139], v[72:75], v[144:147]
  ds_read_b128 a[168:171], v3 offset:26624
  buffer_load_dwordx4 v2, s[48:51], s27 offen offset:0 sc1 lds
  v_add_f32 v226, v226, v218
  v_mfma_f32_16x16x32_bf16 v[152:155], a[136:139], v[76:79], v[152:155]
  v_exp_f32 v219, v131
  v_mfma_f32_16x16x32_bf16 v[148:151], a[140:143], v[72:75], v[148:151]
  ds_read_b128 a[172:175], v3 offset:27648
  v_add_f32 v226, v226, v219
  v_cvt_pk_bf16_f32 v177, v218, v219
  v_mfma_f32_16x16x32_bf16 v[156:159], a[140:143], v[76:79], v[156:159]
  s_add_u32 s14, s13, 45056
  s_waitcnt lgkmcnt(4)
  buffer_load_dwordx4 v[116:119], v2, s[40:43], s14 offen offset:1024 sc1
  v_exp_f32 v220, v132
  v_mfma_f32_16x16x32_bf16 v[144:147], a[144:147], v[80:83], v[144:147]
  ds_read_b128 a[176:179], v3 offset:28672
  v_add_f32 v226, v226, v220
  v_mfma_f32_16x16x32_bf16 v[152:155], a[144:147], v[84:87], v[152:155]
  v_exp_f32 v221, v133
  v_mfma_f32_16x16x32_bf16 v[148:151], a[148:151], v[80:83], v[148:151]
  ds_read_b128 a[180:183], v3 offset:29696
  buffer_load_dwordx4 v2, s[48:51], s27 offen offset:1024 sc1 lds
  v_add_f32 v226, v226, v221
  v_mfma_f32_16x16x32_bf16 v[156:159], a[148:151], v[84:87], v[156:159]
  v_exp_f32 v222, v134
  v_cvt_pk_bf16_f32 v178, v220, v221
  v_mfma_f32_16x16x32_bf16 v[144:147], a[152:155], v[88:91], v[144:147]
  ds_read_b128 a[184:187], v3 offset:30720
  v_add_f32 v226, v226, v222
  v_mfma_f32_16x16x32_bf16 v[152:155], a[152:155], v[92:95], v[152:155]
  v_exp_f32 v223, v135
  v_exp_f32 v216, v136
  v_mfma_f32_16x16x32_bf16 v[148:151], a[156:159], v[88:91], v[148:151]
  ds_read_b128 a[188:191], v3 offset:31744
  buffer_load_dwordx4 v[120:123], v2, s[40:43], s14 offen offset:2048 sc1
  v_mfma_f32_16x16x32_bf16 v[156:159], a[156:159], v[92:95], v[156:159]
  s_waitcnt lgkmcnt(4)
  v_exp_f32 v217, v137
  v_mfma_f32_16x16x32_bf16 a[64:67], a[160:163], v[184:187], a[64:67]
  ds_read_b128 a[128:131], v3 offset:8192
  v_add_f32 v226, v226, v223
  v_mfma_f32_16x16x32_bf16 a[68:71], a[160:163], v[188:191], a[68:71]
  v_exp_f32 v218, v138
  v_cvt_pk_bf16_f32 v179, v222, v223
  v_mfma_f32_16x16x32_bf16 a[72:75], a[164:167], v[184:187], a[72:75]
  ds_read_b128 a[132:135], v3 offset:9216
  buffer_load_dwordx4 v2, s[48:51], s27 offen offset:2048 sc1 lds
  v_mfma_f32_16x16x32_bf16 a[76:79], a[164:167], v[188:191], a[76:79]
  v_exp_f32 v219, v139
  v_add_f32 v227, v216, v217
  v_mfma_f32_16x16x32_bf16 a[80:83], a[168:171], v[184:187], a[80:83]
  ds_read_b128 a[136:139], v3 offset:10240
  v_cvt_pk_bf16_f32 v180, v216, v217
  v_add_f32 v227, v227, v218
  v_mfma_f32_16x16x32_bf16 a[84:87], a[168:171], v[188:191], a[84:87]
  buffer_load_dwordx4 v[124:127], v2, s[40:43], s14 offen offset:3072 sc1
  v_add_f32 v227, v227, v219
  v_mfma_f32_16x16x32_bf16 a[88:91], a[172:175], v[184:187], a[88:91]
  ds_read_b128 a[140:143], v3 offset:11264
  v_cvt_pk_bf16_f32 v181, v218, v219
  v_exp_f32 v220, v140
  v_mfma_f32_16x16x32_bf16 a[92:95], a[172:175], v[188:191], a[92:95]
  s_waitcnt lgkmcnt(4)
  v_exp_f32 v221, v141
  v_mfma_f32_16x16x32_bf16 a[96:99], a[176:179], v[184:187], a[96:99]
  ds_read_b128 a[144:147], v3 offset:12288
  buffer_load_dwordx4 v2, s[48:51], s27 offen offset:3072 sc1 lds
  v_mfma_f32_16x16x32_bf16 a[100:103], a[176:179], v[188:191], a[100:103]
  s_add_u32 s27, s27, 16384
  v_exp_f32 v222, v142
  v_mfma_f32_16x16x32_bf16 a[104:107], a[180:183], v[184:187], a[104:107]
  s_add_u32 s25, s25, 32768
  ds_read_b128 a[148:151], v3 offset:13312
  v_add_f32 v227, v227, v220
  v_add_f32 v227, v227, v221
  v_mfma_f32_16x16x32_bf16 a[108:111], a[180:183], v[188:191], a[108:111]
  s_and_b32 s25, s25, 0x1ffff
  v_exp_f32 v223, v143
  v_mfma_f32_16x16x32_bf16 a[112:115], a[184:187], v[184:187], a[112:115]
  ds_read_b128 a[152:155], v3 offset:14336
  v_cvt_pk_bf16_f32 v182, v220, v221
  v_add_f32 v227, v227, v222
  v_mfma_f32_16x16x32_bf16 a[116:119], a[184:187], v[188:191], a[116:119]
  v_add_f32 v227, v227, v223
  v_cvt_pk_bf16_f32 v183, v222, v223
  v_mfma_f32_16x16x32_bf16 a[120:123], a[188:191], v[184:187], a[120:123]
  s_waitcnt lgkmcnt(3)
  ds_read_b128 a[156:159], v3 offset:15360
  v_max_f32 v5, v226, v227
  v_cmp_lt_f32 vcc, s81, v5
  v_mfma_f32_16x16x32_bf16 a[124:127], a[188:191], v[188:191], a[124:127]
  s_cbranch_vccnz fa_stub27
fa_back27:
  v_add_f32 v230, v230, v226
  v_add_f32 v231, v231, v227
  v_add_u32 v3, 32768, v3
  v_and_b32 v3, 0x1ffff, v3
fa_Bexit:
  s_bitcmp1_b32 s20, 0
  s_cbranch_scc1 fa_Bodd
  v_mfma_f32_16x16x32_bf16 v[128:131], a[128:131], v[64:67], v[200:203]
  s_waitcnt vmcnt(0)
  v_exp_f32 v216, v144
  v_mfma_f32_16x16x32_bf16 v[136:139], a[128:131], v[68:71], v[204:207]
  s_barrier
  v_exp_f32 v217, v145
  v_exp_f32 v218, v146
  v_mfma_f32_16x16x32_bf16 v[132:135], a[132:135], v[64:67], v[200:203]
  ds_read_b128 a[160:163], v3 offset:16384
  ds_read_b128 a[164:167], v3 offset:17408
  v_mfma_f32_16x16x32_bf16 v[140:143], a[132:135], v[68:71], v[204:207]
  s_add_u32 s14, s13, 49152
  buffer_load_dwordx4 v[160:163], v2, s[40:43], s14 offen offset:0 sc1
  v_mfma_f32_16x16x32_bf16 v[128:131], a[136:139], v[72:75], v[128:131]
  ds_read_b128 a[168:171], v3 offset:18432
  v_add_f32 v226, v216, v217
  v_mfma_f32_16x16x32_bf16 v[136:139], a[136:139], v[76:79], v[136:139]
  v_exp_f32 v219, v147
  v_cvt_pk_bf16_f32 v184, v216, v217
  v_mfma_f32_16x16x32_bf16 v[132:135], a[140:143], v[72:75], v[132:135]
  ds_read_b128 a[172:175], v3 offset:19456
  v_add_f32 v226, v226, v218
  v_mfma_f32_16x16x32_bf16 v[140:143], a[140:143], v[76:79], v[140:143]
  s_waitcnt lgkmcnt(4)
  buffer_load_dwordx4 v[164:167], v2, s[40:43], s14 offen offset:1024 sc1
  v_add_f32 v226, v226, v219
  v_mfma_f32_16x16x32_bf16 v[128:131], a[144:147], v[80:83], v[128:131]
  ds_read_b128 a[176:179], v3 offset:20480
  v_cvt_pk_bf16_f32 v185, v218, v219
  v_mfma_f32_16x16x32_bf16 v[136:139], a[144:147], v[84:87], v[136:139]
  v_exp_f32 v220, v148
  v_exp_f32 v221, v149
  v_mfma_f32_16x16x32_bf16 v[132:135], a[148:151], v[80:83], v[132:135]
  ds_read_b128 a[180:183], v3 offset:21504
  v_mfma_f32_16x16x32_bf16 v[140:143], a[148:151], v[84:87], v[140:143]
  v_exp_f32 v222, v150
  v_mfma_f32_16x16x32_bf16 v[128:131], a[152:155], v[88:91], v[128:131]
  ds_read_b128 a[184:187], v3 offset:22528
  buffer_load_dwordx4 v[168:171], v2, s[40:43], s14 offen offset:2048 sc1
  v_mfma_f32_16x16x32_bf16 v[136:139], a[152:155], v[92:95], v[136:139]
  v_exp_f32 v223, v151
  v_add_f32 v226, v226, v220
  v_mfma_f32_16x16x32_bf16 v[132:135], a[156:159], v[88:91], v[132:135]
  ds_read_b128 a[188:191], v3 offset:23552
  v_add_f32 v226, v226, v221
  v_mfma_f32_16x16x32_bf16 v[140:143], a[156:159], v[92:95], v[140:143]
  s_waitcnt lgkmcnt(4)
  v_exp_f32 v216, v152
  v_mfma_f32_16x16x32_bf16 a[64:67], a[160:163], v[176:179], a[64:67]
  v_exp_f32 v217, v153
  v_mfma_f32_16x16x32_bf16 a[68:71], a[160:163], v[180:183], a[68:71]
  buffer_load_dwordx4 v[172:175], v2, s[40:43], s14 offen offset:3072 sc1
  v_cvt_pk_bf16_f32 v186, v220, v221
  v_add_f32 v226, v226, v222
  v_mfma_f32_16x16x32_bf16 a[72:75], a[164:167], v[176:179], a[72:75]
  v_exp_f32 v218, v154
  v_mfma_f32_16x16x32_bf16 a[76:79], a[164:167], v[180:183], a[76:79]
  v_exp_f32 v219, v155
  v_mfma_f32_16x16x32_bf16 a[80:83], a[168:171], v[176:179], a[80:83]
  v_exp_f32 v220, v156
  v_mfma_f32_16x16x32_bf16 a[84:87], a[168:171], v[180:183], a[84:87]
  s_add_u32 s14, s13, 53248
  buffer_load_dwordx4 v[192:195], v2, s[40:43], s14 offen offset:0 sc1
  v_add_f32 v226, v226, v223
  v_cvt_pk_bf16_f32 v187, v222, v223
  v_mfma_f32_16x16x32_bf16 a[88:91], a[172:175], v[176:179], a[88:91]
  v_exp_f32 v221, v157
  v_mfma_f32_16x16x32_bf16 a[92:95], a[172:175], v[180:183], a[92:95]
  s_waitcnt lgkmcnt(0)
  v_exp_f32 v222, v158
  v_mfma_f32_16x16x32_bf16 a[96:99], a[176:179], v[176:179], a[96:99]
  v_exp_f32 v223, v159
  v_mfma_f32_16x16x32_bf16 a[100:103], a[176:179], v[180:183], a[100:103]
  v_add_f32 v227, v216, v217
  v_cvt_pk_bf16_f32 v188, v216, v217
  v_add_f32 v227, v227, v218
  v_mfma_f32_16x16x32_bf16 a[104:107], a[180:183], v[176:179], a[104:107]
  buffer_load_dwordx4 v[196:199], v2, s[40:43], s14 offen offset:1024 sc1
  v_add_f32 v227, v227, v219
  v_mfma_f32_16x16x32_bf16 a[108:111], a[180:183], v[180:183], a[108:111]
  v_cvt_pk_bf16_f32 v189, v218, v219
  v_add_f32 v227, v227, v220
  v_mfma_f32_16x16x32_bf16 a[112:115], a[184:187], v[176:179], a[112:115]
  v_add_f32 v227, v227, v221
  v_cvt_pk_bf16_f32 v190, v220, v221
  v_mfma_f32_16x16x32_bf16 a[116:119], a[184:187], v[180:183], a[116:119]
  v_add_f32 v227, v227, v222
  v_add_f32 v227, v227, v223
  v_cvt_pk_bf16_f32 v191, v222, v223
  v_mfma_f32_16x16x32_bf16 a[120:123], a[188:191], v[176:179], a[120:123]
  v_max_f32 v5, v226, v227
  v_cmp_lt_f32 vcc, s81, v5
  v_mfma_f32_16x16x32_bf16 a[124:127], a[188:191], v[180:183], a[124:127]
  s_cbranch_vccnz fa_stub28
fa_back28:
  v_add_f32 v230, v230, v226
  v_add_f32 v231, v231, v227
  ds_read_b128 a[160:163], v3 offset:24576
  ds_read_b128 a[164:167], v3 offset:25600
  ds_read_b128 a[168:171], v3 offset:26624
  ds_read_b128 a[172:175], v3 offset:27648
  ds_read_b128 a[176:179], v3 offset:28672
  ds_read_b128 a[180:183], v3 offset:29696
  ds_read_b128 a[184:187], v3 offset:30720
  ds_read_b128 a[188:191], v3 offset:31744
  v_cndmask_b32 v128, v4, v128, s[68:69]
  v_cndmask_b32 v129, v4, v129, s[70:71]
  v_cndmask_b32 v130, v4, v130, s[72:73]
  v_cndmask_b32 v131, v4, v131, s[74:75]
  v_mov_b32 v132, v4
  v_mov_b32 v133, v4
  v_mov_b32 v134, v4
  v_mov_b32 v135, v4
  v_cndmask_b32 v140, v4, v140, s[68:69]
  v_cndmask_b32 v141, v4, v141, s[70:71]
  v_cndmask_b32 v142, v4, v142, s[72:73]
  v_cndmask_b32 v143, v4, v143, s[74:75]
  v_exp_f32 v216, v128
  v_exp_f32 v217, v129
  v_exp_f32 v218, v130
  v_exp_f32 v219, v131
  v_exp_f32 v220, v132
  v_exp_f32 v221, v133
  v_exp_f32 v222, v134
  v_exp_f32 v223, v135
  v_add_f32 v226, v216, v217
  v_cvt_pk_bf16_f32 v176, v216, v217
  s_waitcnt lgkmcnt(4)
  v_mfma_f32_16x16x32_bf16 a[64:67], a[160:163], v[184:187], a[64:67]
  v_exp_f32 v216, v136
  v_add_f32 v226, v226, v218
  v_mfma_f32_16x16x32_bf16 a[68:71], a[160:163], v[188:191], a[68:71]
  s_add_u32 s14, s13, 53248
  buffer_load_dwordx4 v[208:211], v2, s[40:43], s14 offen offset:2048 sc1
  v_add_f32 v226, v226, v219
  v_cvt_pk_bf16_f32 v177, v218, v219
  v_mfma_f32_16x16x32_bf16 a[72:75], a[164:167], v[184:187], a[72:75]
  v_exp_f32 v217, v137
  v_mfma_f32_16x16x32_bf16 a[76:79], a[164:167], v[188:191], a[76:79]
  v_exp_f32 v218, v138
  v_add_f32 v226, v226, v220
  v_mfma_f32_16x16x32_bf16 a[80:83], a[168:171], v[184:187], a[80:83]
  buffer_load_dwordx4 v[212:215], v2, s[40:43], s14 offen offset:3072 sc1
  v_add_f32 v226, v226, v221
  v_cvt_pk_bf16_f32 v178, v220, v221
  v_mfma_f32_16x16x32_bf16 a[84:87], a[168:171], v[188:191], a[84:87]
  v_exp_f32 v219, v139
  v_add_f32 v226, v226, v222
  v_mfma_f32_16x16x32_bf16 a[88:91], a[172:175], v[184:187], a[88:91]
  v_exp_f32 v220, v140
  v_add_f32 v226, v226, v223
  v_mfma_f32_16x16x32_bf16 a[92:95], a[172:175], v[188:191], a[92:95]
  s_waitcnt lgkmcnt(0)
  v_exp_f32 v221, v141
  v_mfma_f32_16x16x32_bf16 a[96:99], a[176:179], v[184:187], a[96:99]
  s_add_u32 s14, s13, 57344
  buffer_load_dwordx4 v[232:235], v2, s[40:43], s14 offen offset:0 sc1
  v_cvt_pk_bf16_f32 v179, v222, v223
  v_add_f32 v227, v216, v217
  v_mfma_f32_16x16x32_bf16 a[100:103], a[176:179], v[188:191], a[100:103]
  v_exp_f32 v222, v142
  v_cvt_pk_bf16_f32 v180, v216, v217
  v_mfma_f32_16x16x32_bf16 a[104:107], a[180:183], v[184:187], a[104:107]
  v_exp_f32 v223, v143
  v_add_f32 v227, v227, v218
  v_mfma_f32_16x16x32_bf16 a[108:111], a[180:183], v[188:191], a[108:111]
  buffer_load_dwordx4 v[236:239], v2, s[40:43], s14 offen offset:1024 sc1
  v_add_f32 v227, v227, v219
  v_cvt_pk_bf16_f32 v181, v218, v219
  v_mfma_f32_16x16x32_bf16 a[112:115], a[184:187], v[184:187], a[112:115]
  v_add_f32 v227, v227, v220
  v_add_f32 v227, v227, v221
  v_mfma_f32_16x16x32_bf16 a[116:119], a[184:187], v[188:191], a[116:119]
  v_cvt_pk_bf16_f32 v182, v220, v221
  v_add_f32 v227, v227, v222
  v_add_f32 v227, v227, v223
  v_mfma_f32_16x16x32_bf16 a[120:123], a[188:191], v[184:187], a[120:123]
  v_cvt_pk_bf16_f32 v183, v222, v223
  v_max_f32 v5, v226, v227
  v_cmp_lt_f32 vcc, s81, v5
  v_mfma_f32_16x16x32_bf16 a[124:127], a[188:191], v[188:191], a[124:127]
  s_cbranch_vccnz fa_stub29
fa_back29:
  v_add_f32 v230, v230, v226
  v_add_f32 v231, v231, v227
  v_add_u32 v3, 32768, v3
  v_and_b32 v3, 0x1ffff, v3
  s_waitcnt vmcnt(10)
  s_barrier
  ds_read_b128 a[160:163], v3 offset:16384
  ds_read_b128 a[164:167], v3 offset:17408
  ds_read_b128 a[168:171], v3 offset:18432
  ds_read_b128 a[172:175], v3 offset:19456
  ds_read_b128 a[176:179], v3 offset:20480
  ds_read_b128 a[180:183], v3 offset:21504
  ds_read_b128 a[184:187], v3 offset:22528
  ds_read_b128 a[188:191], v3 offset:23552
  s_waitcnt lgkmcnt(4)
  v_mfma_f32_16x16x32_bf16 a[64:67], a[160:163], v[176:179], a[64:67]
  v_mfma_f32_16x16x32_bf16 a[68:71], a[160:163], v[180:183], a[68:71]
  s_add_u32 s14, s13, 57344
  buffer_load_dwordx4 v[240:243], v2, s[40:43], s14 offen offset:2048 sc1
  v_mfma_f32_16x16x32_bf16 a[72:75], a[164:167], v[176:179], a[72:75]
  v_mfma_f32_16x16x32_bf16 a[76:79], a[164:167], v[180:183], a[76:79]
  v_mfma_f32_16x16x32_bf16 a[80:83], a[168:171], v[176:179], a[80:83]
  v_mfma_f32_16x16x32_bf16 a[84:87], a[168:171], v[180:183], a[84:87]
  v_mfma_f32_16x16x32_bf16 a[88:91], a[172:175], v[176:179], a[88:91]
  v_mfma_f32_16x16x32_bf16 a[92:95], a[172:175], v[180:183], a[92:95]
  s_waitcnt lgkmcnt(0)
  v_mfma_f32_16x16x32_bf16 a[96:99], a[176:179], v[176:179], a[96:99]
  buffer_load_dwordx4 v[244:247], v2, s[40:43], s14 offen offset:3072 sc1
  v_mfma_f32_16x16x32_bf16 a[100:103], a[176:179], v[180:183], a[100:103]
  v_mfma_f32_16x16x32_bf16 a[104:107], a[180:183], v[176:179], a[104:107]
  v_mfma_f32_16x16x32_bf16 a[108:111], a[180:183], v[180:183], a[108:111]
  v_mfma_f32_16x16x32_bf16 a[112:115], a[184:187], v[176:179], a[112:115]
  v_mfma_f32_16x16x32_bf16 a[116:119], a[184:187], v[180:183], a[116:119]
  v_mfma_f32_16x16x32_bf16 a[120:123], a[188:191], v[176:179], a[120:123]
  v_mfma_f32_16x16x32_bf16 a[124:127], a[188:191], v[180:183], a[124:127]
  s_branch fa_Bdone
fa_Bodd:
  s_waitcnt vmcnt(0)
  s_barrier
  ds_read_b128 a[160:163], v3 offset:16384
  ds_read_b128 a[164:167], v3 offset:17408
  ds_read_b128 a[168:171], v3 offset:18432
  ds_read_b128 a[172:175], v3 offset:19456
  ds_read_b128 a[176:179], v3 offset:20480
  ds_read_b128 a[180:183], v3 offset:21504
  ds_read_b128 a[184:187], v3 offset:22528
  ds_read_b128 a[188:191], v3 offset:23552
  v_cndmask_b32 v144, v4, v144, s[68:69]
  v_cndmask_b32 v145, v4, v145, s[70:71]
  v_cndmask_b32 v146, v4, v146, s[72:73]
  v_cndmask_b32 v147, v4, v147, s[74:75]
  v_mov_b32 v148, v4
  v_mov_b32 v149, v4
  v_mov_b32 v150, v4
  v_mov_b32 v151, v4
  v_cndmask_b32 v156, v4, v156, s[68:69]
  v_cndmask_b32 v157, v4, v157, s[70:71]
  v_cndmask_b32 v158, v4, v158, s[72:73]
  v_cndmask_b32 v159, v4, v159, s[74:75]
  v_exp_f32 v216, v144
  v_exp_f32 v217, v145
  v_exp_f32 v218, v146
  v_exp_f32 v219, v147
  v_exp_f32 v220, v148
  v_exp_f32 v221, v149
  v_exp_f32 v222, v150
  v_exp_f32 v223, v151
  v_add_f32 v226, v216, v217
  v_cvt_pk_bf16_f32 v184, v216, v217
  s_waitcnt lgkmcnt(4)
  v_mfma_f32_16x16x32_bf16 a[64:67], a[160:163], v[176:179], a[64:67]
  v_exp_f32 v216, v152
  v_add_f32 v226, v226, v218
  v_mfma_f32_16x16x32_bf16 a[68:71], a[160:163], v[180:183], a[68:71]
  s_add_u32 s14, s13, 49152
  buffer_load_dwordx4 v[160:163], v2, s[40:43], s14 offen offset:0 sc1
  v_add_f32 v226, v226, v219
  v_cvt_pk_bf16_f32 v185, v218, v219
  v_mfma_f32_16x16x32_bf16 a[72:75], a[164:167], v[176:179], a[72:75]
  v_exp_f32 v217, v153
  v_add_f32 v226, v226, v220
  v_mfma_f32_16x16x32_bf16 a[76:79], a[164:167], v[180:183], a[76:79]
  buffer_load_dwordx4 v[164:167], v2, s[40:43], s14 offen offset:1024 sc1
  v_add_f32 v226, v226, v221
  v_cvt_pk_bf16_f32 v186, v220, v221
  v_mfma_f32_16x16x32_bf16 a[80:83], a[168:171], v[176:179], a[80:83]
  v_exp_f32 v218, v154
  v_add_f32 v226, v226, v222
  v_mfma_f32_16x16x32_bf16 a[84:87], a[168:171], v[180:183], a[84:87]
  buffer_load_dwordx4 v[168:171], v2, s[40:43], s14 offen offset:2048 sc1
  v_add_f32 v226, v226, v223
  v_cvt_pk_bf16_f32 v187, v222, v223
  v_mfma_f32_16x16x32_bf16 a[88:91], a[172:175], v[176:179], a[88:91]
  v_exp_f32 v219, v155
  v_add_f32 v227, v216, v217
  v_mfma_f32_16x16x32_bf16 a[92:95], a[172:175], v[180:183], a[92:95]
  s_waitcnt lgkmcnt(0)
  buffer_load_dwordx4 v[172:175], v2, s[40:43], s14 offen offset:3072 sc1
  v_cvt_pk_bf16_f32 v188, v216, v217
  v_add_f32 v227, v227, v218
  v_mfma_f32_16x16x32_bf16 a[96:99], a[176:179], v[176:179], a[96:99]
  v_exp_f32 v220, v156
  v_add_f32 v227, v227, v219
  v_mfma_f32_16x16x32_bf16 a[100:103], a[176:179], v[180:183], a[100:103]
  s_add_u32 s14, s13, 53248
  buffer_load_dwordx4 v[192:195], v2, s[40:43], s14 offen offset:0 sc1
  v_cvt_pk_bf16_f32 v189, v218, v219
  v_add_f32 v227, v227, v220
  v_mfma_f32_16x16x32_bf16 a[104:107], a[180:183], v[176:179], a[104:107]
  v_exp_f32 v221, v157
  v_exp_f32 v222, v158
  v_mfma_f32_16x16x32_bf16 a[108:111], a[180:183], v[180:183], a[108:111]
  buffer_load_dwordx4 v[196:199], v2, s[40:43], s14 offen offset:1024 sc1
  v_add_f32 v227, v227, v221
  v_mfma_f32_16x16x32_bf16 a[112:115], a[184:187], v[176:179], a[112:115]
  v_exp_f32 v223, v159
  v_cvt_pk_bf16_f32 v190, v220, v221
  v_mfma_f32_16x16x32_bf16 a[116:119], a[184:187], v[180:183], a[116:119]
  buffer_load_dwordx4 v[208:211], v2, s[40:43], s14 offen offset:2048 sc1
  v_add_f32 v227, v227, v222
  v_add_f32 v227, v227, v223
  v_mfma_f32_16x16x32_bf16 a[120:123], a[188:191], v[176:179], a[120:123]
  v_cvt_pk_bf16_f32 v191, v222, v223
  v_max_f32 v5, v226, v227
  v_cmp_lt_f32 vcc, s81, v5
  v_mfma_f32_16x16x32_bf16 a[124:127], a[188:191], v[180:183], a[124:127]
  s_cbranch_vccnz fa_stub30
fa_back30:
  v_add_f32 v230, v230, v226
  v_add_f32 v231, v231, v227
  ds_read_b128 a[160:163], v3 offset:24576
  ds_read_b128 a[164:167], v3 offset:25600
  ds_read_b128 a[168:171], v3 offset:26624
  ds_read_b128 a[172:175], v3 offset:27648
  ds_read_b128 a[176:179], v3 offset:28672
  ds_read_b128 a[180:183], v3 offset:29696
  ds_read_b128 a[184:187], v3 offset:30720
  ds_read_b128 a[188:191], v3 offset:31744
  s_waitcnt lgkmcnt(4)
  v_mfma_f32_16x16x32_bf16 a[64:67], a[160:163], v[184:187], a[64:67]
  v_mfma_f32_16x16x32_bf16 a[68:71], a[160:163], v[188:191], a[68:71]
  s_add_u32 s14, s13, 53248
  buffer_load_dwordx4 v[212:215], v2, s[40:43], s14 offen offset:3072 sc1
  v_mfma_f32_16x16x32_bf16 a[72:75], a[164:167], v[184:187], a[72:75]
  v_mfma_f32_16x16x32_bf16 a[76:79], a[164:167], v[188:191], a[76:79]
  s_add_u32 s14, s13, 57344
  buffer_load_dwordx4 v[232:235], v2, s[40:43], s14 offen offset:0 sc1
  v_mfma_f32_16x16x32_bf16 a[80:83], a[168:171], v[184:187], a[80:83]
  v_mfma_f32_16x16x32_bf16 a[84:87], a[168:171], v[188:191], a[84:87]
  v_mfma_f32_16x16x32_bf16 a[88:91], a[172:175], v[184:187], a[88:91]
  buffer_load_dwordx4 v[236:239], v2, s[40:43], s14 offen offset:1024 sc1
  v_mfma_f32_16x16x32_bf16 a[92:95], a[172:175], v[188:191], a[92:95]
  s_waitcnt lgkmcnt(0)
  v_mfma_f32_16x16x32_bf16 a[96:99], a[176:179], v[184:187], a[96:99]
  v_mfma_f32_16x16x32_bf16 a[100:103], a[176:179], v[188:191], a[100:103]
  buffer_load_dwordx4 v[240:243], v2, s[40:43], s14 offen offset:2048 sc1
  v_mfma_f32_16x16x32_bf16 a[104:107], a[180:183], v[184:187], a[104:107]
  v_mfma_f32_16x16x32_bf16 a[108:111], a[180:183], v[188:191], a[108:111]
  v_mfma_f32_16x16x32_bf16 a[112:115], a[184:187], v[184:187], a[112:115]
  buffer_load_dwordx4 v[244:247], v2, s[40:43], s14 offen offset:3072 sc1
  v_mfma_f32_16x16x32_bf16 a[116:119], a[184:187], v[188:191], a[116:119]
  v_mfma_f32_16x16x32_bf16 a[120:123], a[188:191], v[184:187], a[120:123]
  v_mfma_f32_16x16x32_bf16 a[124:127], a[188:191], v[188:191], a[124:127]
  v_add_u32 v3, 32768, v3
  v_and_b32 v3, 0x1ffff, v3
fa_Bdone:
  s_cmp_ge_u32 s20, 2
  s_cbranch_scc1 fa_epi
  s_barrier
fa_epi:
  v_mov_b32 v20, v230
  v_mov_b32 v21, v231
  s_nop 1
  v_permlane16_swap_b32 v230, v20
  v_permlane16_swap_b32 v231, v21
  v_add_f32 v230, v230, v20
  v_add_f32 v231, v231, v21
  v_mov_b32 v20, v230
  v_mov_b32 v21, v231
  s_nop 1
  v_permlane32_swap_b32 v230, v20
  v_permlane32_swap_b32 v231, v21
  v_add_f32 v230, v230, v20
  v_add_f32 v231, v231, v21
  v_rcp_f32 v16, v230
  v_rcp_f32 v18, v231
  s_sub_u32 s23, 15, s22
  s_lshl_b32 s23, s23, 2
  v_mov_b32 v17, v16
  v_mov_b32 v19, v18
  s_add_u32 s23, s23, s20
  s_lshl_b32 s23, s23, 18
  s_lshl_b32 s31, s21, 12
  s_add_u32 s31, s31, 50331648
  s_add_u32 s64, s23, s31
  s_add_u32 s65, s64, 131072
  v_accvgpr_read_b32 v68, a64
  v_accvgpr_read_b32 v69, a65
  v_accvgpr_read_b32 v70, a66
  v_accvgpr_read_b32 v71, a67
  v_accvgpr_read_b32 v72, a72
  v_accvgpr_read_b32 v73, a73
  v_accvgpr_read_b32 v74, a74
  v_accvgpr_read_b32 v75, a75
  v_pk_mul_f32 v[68:69], v[68:69], v[16:17]
  v_pk_mul_f32 v[70:71], v[70:71], v[16:17]
  v_pk_mul_f32 v[72:73], v[72:73], v[16:17]
  v_pk_mul_f32 v[74:75], v[74:75], v[16:17]
  v_cvt_pk_bf16_f32 v64, v68, v69
  v_cvt_pk_bf16_f32 v65, v70, v71
  v_cvt_pk_bf16_f32 v66, v72, v73
  v_cvt_pk_bf16_f32 v67, v74, v75
  buffer_store_dwordx4 v[64:67], v2, s[40:43], s64 offen offset:0 sc1
  v_accvgpr_read_b32 v80, a80
  v_accvgpr_read_b32 v81, a81
  v_accvgpr_read_b32 v82, a82
  v_accvgpr_read_b32 v83, a83
  v_accvgpr_read_b32 v84, a88
  v_accvgpr_read_b32 v85, a89
  v_accvgpr_read_b32 v86, a90
  v_accvgpr_read_b32 v87, a91
  v_pk_mul_f32 v[80:81], v[80:81], v[16:17]
  v_pk_mul_f32 v[82:83], v[82:83], v[16:17]
  v_pk_mul_f32 v[84:85], v[84:85], v[16:17]
  v_pk_mul_f32 v[86:87], v[86:87], v[16:17]
  v_cvt_pk_bf16_f32 v76, v80, v81
  v_cvt_pk_bf16_f32 v77, v82, v83
  v_cvt_pk_bf16_f32 v78, v84, v85
  v_cvt_pk_bf16_f32 v79, v86, v87
  buffer_store_dwordx4 v[76:79], v2, s[40:43], s64 offen offset:1024 sc1
  v_accvgpr_read_b32 v132, a96
  v_accvgpr_read_b32 v133, a97
  v_accvgpr_read_b32 v134, a98
  v_accvgpr_read_b32 v135, a99
  v_accvgpr_read_b32 v136, a104
  v_accvgpr_read_b32 v137, a105
  v_accvgpr_read_b32 v138, a106
  v_accvgpr_read_b32 v139, a107
  v_pk_mul_f32 v[132:133], v[132:133], v[16:17]
  v_pk_mul_f32 v[134:135], v[134:135], v[16:17]
  v_pk_mul_f32 v[136:137], v[136:137], v[16:17]
  v_pk_mul_f32 v[138:139], v[138:139], v[16:17]
  v_cvt_pk_bf16_f32 v128, v132, v133
  v_cvt_pk_bf16_f32 v129, v134, v135
  v_cvt_pk_bf16_f32 v130, v136, v137
  v_cvt_pk_bf16_f32 v131, v138, v139
  buffer_store_dwordx4 v[128:131], v2, s[40:43], s64 offen offset:2048 sc1
  v_accvgpr_read_b32 v144, a112
  v_accvgpr_read_b32 v145, a113
  v_accvgpr_read_b32 v146, a114
  v_accvgpr_read_b32 v147, a115
  v_accvgpr_read_b32 v148, a120
  v_accvgpr_read_b32 v149, a121
  v_accvgpr_read_b32 v150, a122
  v_accvgpr_read_b32 v151, a123
  v_pk_mul_f32 v[144:145], v[144:145], v[16:17]
  v_pk_mul_f32 v[146:147], v[146:147], v[16:17]
  v_pk_mul_f32 v[148:149], v[148:149], v[16:17]
  v_pk_mul_f32 v[150:151], v[150:151], v[16:17]
  v_cvt_pk_bf16_f32 v140, v144, v145
  v_cvt_pk_bf16_f32 v141, v146, v147
  v_cvt_pk_bf16_f32 v142, v148, v149
  v_cvt_pk_bf16_f32 v143, v150, v151
  buffer_store_dwordx4 v[140:143], v2, s[40:43], s64 offen offset:3072 sc1
  v_accvgpr_read_b32 v68, a68
  v_accvgpr_read_b32 v69, a69
  v_accvgpr_read_b32 v70, a70
  v_accvgpr_read_b32 v71, a71
  v_accvgpr_read_b32 v72, a76
  v_accvgpr_read_b32 v73, a77
  v_accvgpr_read_b32 v74, a78
  v_accvgpr_read_b32 v75, a79
  v_pk_mul_f32 v[68:69], v[68:69], v[18:19]
  v_pk_mul_f32 v[70:71], v[70:71], v[18:19]
  v_pk_mul_f32 v[72:73], v[72:73], v[18:19]
  v_pk_mul_f32 v[74:75], v[74:75], v[18:19]
  v_cvt_pk_bf16_f32 v64, v68, v69
  v_cvt_pk_bf16_f32 v65, v70, v71
  v_cvt_pk_bf16_f32 v66, v72, v73
  v_cvt_pk_bf16_f32 v67, v74, v75
  buffer_store_dwordx4 v[64:67], v2, s[40:43], s65 offen offset:0 sc1
  v_accvgpr_read_b32 v80, a84
  v_accvgpr_read_b32 v81, a85
  v_accvgpr_read_b32 v82, a86
  v_accvgpr_read_b32 v83, a87
  v_accvgpr_read_b32 v84, a92
  v_accvgpr_read_b32 v85, a93
  v_accvgpr_read_b32 v86, a94
  v_accvgpr_read_b32 v87, a95
  v_pk_mul_f32 v[80:81], v[80:81], v[18:19]
  v_pk_mul_f32 v[82:83], v[82:83], v[18:19]
  v_pk_mul_f32 v[84:85], v[84:85], v[18:19]
  v_pk_mul_f32 v[86:87], v[86:87], v[18:19]
  v_cvt_pk_bf16_f32 v76, v80, v81
  v_cvt_pk_bf16_f32 v77, v82, v83
  v_cvt_pk_bf16_f32 v78, v84, v85
  v_cvt_pk_bf16_f32 v79, v86, v87
  buffer_store_dwordx4 v[76:79], v2, s[40:43], s65 offen offset:1024 sc1
  v_accvgpr_read_b32 v132, a100
  v_accvgpr_read_b32 v133, a101
  v_accvgpr_read_b32 v134, a102
  v_accvgpr_read_b32 v135, a103
  v_accvgpr_read_b32 v136, a108
  v_accvgpr_read_b32 v137, a109
  v_accvgpr_read_b32 v138, a110
  v_accvgpr_read_b32 v139, a111
  v_pk_mul_f32 v[132:133], v[132:133], v[18:19]
  v_pk_mul_f32 v[134:135], v[134:135], v[18:19]
  v_pk_mul_f32 v[136:137], v[136:137], v[18:19]
  v_pk_mul_f32 v[138:139], v[138:139], v[18:19]
  v_cvt_pk_bf16_f32 v128, v132, v133
  v_cvt_pk_bf16_f32 v129, v134, v135
  v_cvt_pk_bf16_f32 v130, v136, v137
  v_cvt_pk_bf16_f32 v131, v138, v139
  buffer_store_dwordx4 v[128:131], v2, s[40:43], s65 offen offset:2048 sc1
  v_accvgpr_read_b32 v144, a116
  v_accvgpr_read_b32 v145, a117
  v_accvgpr_read_b32 v146, a118
  v_accvgpr_read_b32 v147, a119
  v_accvgpr_read_b32 v148, a124
  v_accvgpr_read_b32 v149, a125
  v_accvgpr_read_b32 v150, a126
  v_accvgpr_read_b32 v151, a127
  v_pk_mul_f32 v[144:145], v[144:145], v[18:19]
  v_pk_mul_f32 v[146:147], v[146:147], v[18:19]
  v_pk_mul_f32 v[148:149], v[148:149], v[18:19]
  v_pk_mul_f32 v[150:151], v[150:151], v[18:19]
  v_cvt_pk_bf16_f32 v140, v144, v145
  v_cvt_pk_bf16_f32 v141, v146, v147
  v_cvt_pk_bf16_f32 v142, v148, v149
  v_cvt_pk_bf16_f32 v143, v150, v151
  buffer_store_dwordx4 v[140:143], v2, s[40:43], s65 offen offset:3072 sc1
  s_load_dwordx2 s[4:5], s[0:1], 0
  s_load_dwordx2 s[6:7], s[0:1], 88
  v_mov_b32 v30, 1073741824
  v_mov_b32 v31, 1
  v_writelane_b32 v30, s80, 0
  v_writelane_b32 v30, s3, 1
  s_lshl_b32 s64, s21, 19
  s_lshl_b32 s23, s20, 15
  s_add_u32 s64, s64, s23
  s_add_u32 s64, s64, 50331648
  s_add_u32 s65, s64, 131072
  s_add_u32 s66, s64, 262144
  s_add_u32 s67, s64, 393216
  v_bfe_u32 v12, v1, 3, 1
  v_lshlrev_b32 v12, 7, v12
  v_and_b32 v13, 7, v1
  v_lshl_add_u32 v12, v13, 2, v12
  s_lshl_b32 s23, s21, 8
  s_lshl_b32 s31, s20, 5
  s_add_u32 s23, s23, s31
  s_add_u32 s23, s23, 2641920
  v_add_u32 v12, s23, v12
  s_lshl_b32 s25, s21, 6
  s_mul_i32 s26, s22, 160
  s_mul_i32 s27, s22, 2560
  v_add_u32 v16, 0, v0
  v_mul_u32_u24 v17, 6554, v16
  v_lshrrev_b32 v17, 16, v17
  v_mul_u32_u24 v18, 10, v17
  v_sub_u32 v18, v16, v18
  v_mul_u32_u24 v251, 336, v17
  v_lshl_add_u32 v251, v18, 5, v251
  v_lshlrev_b32 v203, 5, v18
  v_add_u32 v17, s25, v17
  v_add_u32 v24, 1, v17
  v_mul_u32_u24 v248, 1280, v17
  v_lshl_add_u32 v248, v18, 4, v248
  v_add_u32 v248, s26, v248
  v_lshrrev_b32 v19, 4, v17
  v_mul_u32_u24 v19, 20480, v19
  v_and_b32 v17, 15, v17
  v_lshl_add_u32 v19, v17, 4, v19
  v_lshl_add_u32 v200, v18, 8, v19
  v_mov_b32 v27, 8
  v_add_u32 v16, 256, v0
  v_mul_u32_u24 v17, 6554, v16
  v_lshrrev_b32 v17, 16, v17
  v_mul_u32_u24 v18, 10, v17
  v_sub_u32 v18, v16, v18
  v_mul_u32_u24 v252, 336, v17
  v_lshl_add_u32 v252, v18, 5, v252
  v_lshlrev_b32 v204, 5, v18
  v_add_u32 v17, s25, v17
  v_add_u32 v25, 1, v17
  v_mul_u32_u24 v249, 1280, v17
  v_lshl_add_u32 v249, v18, 4, v249
  v_add_u32 v249, s26, v249
  v_lshrrev_b32 v19, 4, v17
  v_mul_u32_u24 v19, 20480, v19
  v_and_b32 v17, 15, v17
  v_lshl_add_u32 v19, v17, 4, v19
  v_lshl_add_u32 v201, v18, 8, v19
  v_mov_b32 v28, 8
  v_add_u32 v16, 512, v0
  v_mul_u32_u24 v17, 6554, v16
  v_lshrrev_b32 v17, 16, v17
  v_mul_u32_u24 v18, 10, v17
  v_sub_u32 v18, v16, v18
  v_mul_u32_u24 v253, 336, v17
  v_lshl_add_u32 v253, v18, 5, v253
  v_lshlrev_b32 v205, 5, v18
  v_add_u32 v17, s25, v17
  v_add_u32 v26, 1, v17
  v_mul_u32_u24 v250, 1280, v17
  v_lshl_add_u32 v250, v18, 4, v250
  v_add_u32 v250, s26, v250
  v_lshrrev_b32 v19, 4, v17
  v_mul_u32_u24 v19, 20480, v19
  v_and_b32 v17, 15, v17
  v_lshl_add_u32 v19, v17, 4, v19
  v_lshl_add_u32 v202, v18, 8, v19
  v_mov_b32 v29, 8
  v_cmp_gt_u32 vcc, 128, v0
  v_mov_b32 v16, 1073741824
  v_mov_b32 v17, 0
  v_cndmask_b32 v250, v16, v250, vcc
  v_cndmask_b32 v202, v16, v202, vcc
  v_cndmask_b32 v253, v17, v253, vcc
  v_mov_b32 v20, 0
  v_mov_b32 v21, 0
  v_mov_b32 v22, 0
  v_mov_b32 v23, 0
  v_add_u32 v16, 133632, v2
  ds_write_b128 v16, v[20:23]
  s_waitcnt vmcnt(0) lgkmcnt(0)
  buffer_store_dword v31, v30, s[40:43], 0 offen sc1
  s_cmp_lt_u32 s29, 8
  s_cbranch_scc1 fa_left
fa_leftb:
  s_cmp_lt_u32 s12, 3
  s_cbranch_scc1 fa_hk5
fa_hb5:
  s_add_u32 s13, s13, 61440
  buffer_load_dwordx4 v[64:67], v2, s[40:43], s13 offen offset:0 sc1
  buffer_load_dwordx4 v[68:71], v2, s[40:43], s13 offen offset:1024 sc1
  buffer_load_dwordx4 v[72:75], v2, s[40:43], s13 offen offset:2048 sc1
  buffer_load_dwordx4 v[76:79], v2, s[40:43], s13 offen offset:3072 sc1
  s_add_u32 s13, s13, 4096
  buffer_load_dwordx4 v[80:83], v2, s[40:43], s13 offen offset:0 sc1
  buffer_load_dwordx4 v[84:87], v2, s[40:43], s13 offen offset:1024 sc1
  buffer_load_dwordx4 v[88:91], v2, s[40:43], s13 offen offset:2048 sc1
  buffer_load_dwordx4 v[92:95], v2, s[40:43], s13 offen offset:3072 sc1
  s_add_u32 s13, s13, 4096
  buffer_load_dword v13, v12, s[40:43], 0 offen sc1
  buffer_load_dwordx4 v[128:131], v2, s[40:43], s13 offen offset:0 sc1
  buffer_load_dwordx4 v[132:135], v2, s[40:43], s13 offen offset:1024 sc1
  buffer_load_dwordx4 v[136:139], v2, s[40:43], s13 offen offset:2048 sc1
  buffer_load_dwordx4 v[140:143], v2, s[40:43], s13 offen offset:3072 sc1
  s_add_u32 s13, s13, 4096
  buffer_load_dwordx4 v[144:147], v2, s[40:43], s13 offen offset:0 sc1
  buffer_load_dwordx4 v[148:151], v2, s[40:43], s13 offen offset:1024 sc1
  buffer_load_dwordx4 v[152:155], v2, s[40:43], s13 offen offset:2048 sc1
  buffer_load_dwordx4 v[156:159], v2, s[40:43], s13 offen offset:3072 sc1
  s_add_u32 s13, s13, 4096
  buffer_load_dwordx4 v[176:179], v2, s[40:43], s13 offen offset:0 sc1
  buffer_load_dwordx4 v[180:183], v2, s[40:43], s13 offen offset:1024 sc1
  buffer_load_dwordx4 v[184:187], v2, s[40:43], s13 offen offset:2048 sc1
  buffer_load_dwordx4 v[188:191], v2, s[40:43], s13 offen offset:3072 sc1
  s_add_u32 s13, s13, 4096
  s_mov_b32 s44, s4
  s_mov_b32 s45, s5
  s_mov_b32 s46, 2621440
  s_mov_b32 s47, 0x20000
  s_mov_b32 s48, s6
  s_mov_b32 s49, s7
  s_mov_b32 s50, 2621440
  s_mov_b32 s51, 0x20000
  v_readlane_b32 s68, v15, 0
  v_readlane_b32 s69, v15, 1
  v_readlane_b32 s70, v15, 2
  v_readlane_b32 s71, v15, 3
  v_readlane_b32 s72, v15, 4
  v_readlane_b32 s73, v15, 5
  v_readlane_b32 s74, v15, 6
  v_readlane_b32 s75, v15, 7
  v_cmp_eq_u32 s[52:53], s68, v24
  v_cmp_eq_u32 s[54:55], s68, v25
  v_cmp_eq_u32 s[56:57], s68, v26
  v_cndmask_b32 v27, v27, 0, s[52:53]
  v_cndmask_b32 v28, v28, 0, s[54:55]
  v_cndmask_b32 v29, v29, 0, s[56:57]
  v_cmp_eq_u32 s[52:53], s69, v24
  v_cmp_eq_u32 s[54:55], s69, v25
  v_cmp_eq_u32 s[56:57], s69, v26
  v_cndmask_b32 v27, v27, 1, s[52:53]
  v_cndmask_b32 v28, v28, 1, s[54:55]
  v_cndmask_b32 v29, v29, 1, s[56:57]
  v_cmp_eq_u32 s[52:53], s70, v24
  v_cmp_eq_u32 s[54:55], s70, v25
  v_cmp_eq_u32 s[56:57], s70, v26
  v_cndmask_b32 v27, v27, 2, s[52:53]
  v_cndmask_b32 v28, v28, 2, s[54:55]
  v_cndmask_b32 v29, v29, 2, s[56:57]
  v_cmp_eq_u32 s[52:53], s71, v24
  v_cmp_eq_u32 s[54:55], s71, v25
  v_cmp_eq_u32 s[56:57], s71, v26
  v_cndmask_b32 v27, v27, 3, s[52:53]
  v_cndmask_b32 v28, v28, 3, s[54:55]
  v_cndmask_b32 v29, v29, 3, s[56:57]
  v_cmp_eq_u32 s[52:53], s72, v24
  v_cmp_eq_u32 s[54:55], s72, v25
  v_cmp_eq_u32 s[56:57], s72, v26
  v_cndmask_b32 v27, v27, 4, s[52:53]
  v_cndmask_b32 v28, v28, 4, s[54:55]
  v_cndmask_b32 v29, v29, 4, s[56:57]
  v_cmp_eq_u32 s[52:53], s73, v24
  v_cmp_eq_u32 s[54:55], s73, v25
  v_cmp_eq_u32 s[56:57], s73, v26
  v_cndmask_b32 v27, v27, 5, s[52:53]
  v_cndmask_b32 v28, v28, 5, s[54:55]
  v_cndmask_b32 v29, v29, 5, s[56:57]
  v_cmp_eq_u32 s[52:53], s74, v24
  v_cmp_eq_u32 s[54:55], s74, v25
  v_cmp_eq_u32 s[56:57], s74, v26
  v_cndmask_b32 v27, v27, 6, s[52:53]
  v_cndmask_b32 v28, v28, 6, s[54:55]
  v_cndmask_b32 v29, v29, 6, s[56:57]
  v_cmp_eq_u32 s[52:53], s75, v24
  v_cmp_eq_u32 s[54:55], s75, v25
  v_cmp_eq_u32 s[56:57], s75, v26
  v_cndmask_b32 v27, v27, 7, s[52:53]
  v_cndmask_b32 v28, v28, 7, s[54:55]
  v_cndmask_b32 v29, v29, 7, s[56:57]
  v_mul_u32_u24 v27, 320, v27
  v_add_u32 v203, v203, v27
  v_mul_u32_u24 v28, 320, v28
  v_add_u32 v204, v204, v28
  v_mul_u32_u24 v29, 320, v29
  v_add_u32 v205, v205, v29
  v_add_u32 v203, 131072, v203
  v_add_u32 v204, 131072, v204
  v_add_u32 v205, 131072, v205
  s_waitcnt vmcnt(12)
  v_cmp_eq_u32 vcc, 0, v13
  s_cbranch_vccnz fa_ctx_spin
fa_ctx_ok:
  buffer_load_dwordx4 a[144:147], v2, s[40:43], s64 offen offset:0 sc1
  buffer_load_dwordx4 a[148:151], v2, s[40:43], s65 offen offset:0 sc1
  buffer_load_dwordx4 a[152:155], v2, s[40:43], s66 offen offset:0 sc1
  buffer_load_dwordx4 a[156:159], v2, s[40:43], s67 offen offset:0 sc1
  buffer_load_dwordx4 a[160:163], v2, s[40:43], s64 offen offset:1024 sc1
  buffer_load_dwordx4 a[164:167], v2, s[40:43], s65 offen offset:1024 sc1
  buffer_load_dwordx4 a[168:171], v2, s[40:43], s66 offen offset:1024 sc1
  buffer_load_dwordx4 a[172:175], v2, s[40:43], s67 offen offset:1024 sc1
  buffer_load_dwordx4 a[176:179], v2, s[40:43], s64 offen offset:2048 sc1
  buffer_load_dwordx4 a[180:183], v2, s[40:43], s65 offen offset:2048 sc1
  buffer_load_dwordx4 a[184:187], v2, s[40:43], s66 offen offset:2048 sc1
  buffer_load_dwordx4 a[188:191], v2, s[40:43], s67 offen offset:2048 sc1
  buffer_load_dwordx4 v[216:219], v2, s[40:43], s64 offen offset:3072 sc1
  buffer_load_dwordx4 v[220:223], v2, s[40:43], s65 offen offset:3072 sc1
  buffer_load_dwordx4 v[224:227], v2, s[40:43], s66 offen offset:3072 sc1
  buffer_load_dwordx4 v[228:231], v2, s[40:43], s67 offen offset:3072 sc1
  s_add_u32 s64, s64, 4096
  s_add_u32 s65, s65, 4096
  s_add_u32 s66, s66, 4096
  s_add_u32 s67, s67, 4096
  s_waitcnt vmcnt(12)
  v_mfma_f32_16x16x32_bf16 a[64:67], a[0:3], a[144:147], 0
  v_mfma_f32_16x16x32_bf16 a[68:71], a[0:3], a[148:151], 0
  v_mfma_f32_16x16x32_bf16 a[72:75], a[0:3], a[152:155], 0
  v_mfma_f32_16x16x32_bf16 a[76:79], a[0:3], a[156:159], 0
  buffer_load_dwordx4 a[0:3], v2, s[40:43], s13 offen offset:0 sc1
  v_mfma_f32_16x16x32_bf16 a[80:83], a[4:7], a[144:147], 0
  v_mfma_f32_16x16x32_bf16 a[84:87], a[4:7], a[148:151], 0
  v_mfma_f32_16x16x32_bf16 a[88:91], a[4:7], a[152:155], 0
  v_mfma_f32_16x16x32_bf16 a[92:95], a[4:7], a[156:159], 0
  buffer_load_dwordx4 a[4:7], v2, s[40:43], s13 offen offset:1024 sc1
  v_mfma_f32_16x16x32_bf16 a[96:99], a[8:11], a[144:147], 0
  v_mfma_f32_16x16x32_bf16 a[100:103], a[8:11], a[148:151], 0
  v_mfma_f32_16x16x32_bf16 a[104:107], a[8:11], a[152:155], 0
  v_mfma_f32_16x16x32_bf16 a[108:111], a[8:11], a[156:159], 0
  buffer_load_dwordx4 a[8:11], v2, s[40:43], s13 offen offset:2048 sc1
  v_mfma_f32_16x16x32_bf16 a[112:115], a[12:15], a[144:147], 0
  v_mfma_f32_16x16x32_bf16 a[116:119], a[12:15], a[148:151], 0
  v_mfma_f32_16x16x32_bf16 a[120:123], a[12:15], a[152:155], 0
  v_mfma_f32_16x16x32_bf16 a[124:127], a[12:15], a[156:159], 0
  v_mfma_f32_16x16x32_bf16 a[128:131], a[16:19], a[144:147], 0
  buffer_load_dwordx4 a[144:147], v2, s[40:43], s64 offen offset:0 sc1
  v_mfma_f32_16x16x32_bf16 a[132:135], a[16:19], a[148:151], 0
  buffer_load_dwordx4 a[148:151], v2, s[40:43], s65 offen offset:0 sc1
  v_mfma_f32_16x16x32_bf16 a[136:139], a[16:19], a[152:155], 0
  buffer_load_dwordx4 a[152:155], v2, s[40:43], s66 offen offset:0 sc1
  v_mfma_f32_16x16x32_bf16 a[140:143], a[16:19], a[156:159], 0
  buffer_load_dwordx4 a[156:159], v2, s[40:43], s67 offen offset:0 sc1
  s_waitcnt vmcnt(15)
  v_mfma_f32_16x16x32_bf16 a[64:67], a[20:23], a[160:163], a[64:67]
  v_mfma_f32_16x16x32_bf16 a[68:71], a[20:23], a[164:167], a[68:71]
  v_mfma_f32_16x16x32_bf16 a[72:75], a[20:23], a[168:171], a[72:75]
  v_mfma_f32_16x16x32_bf16 a[76:79], a[20:23], a[172:175], a[76:79]
  buffer_load_dwordx4 a[12:15], v2, s[40:43], s13 offen offset:3072 sc1
  v_mfma_f32_16x16x32_bf16 a[80:83], a[24:27], a[160:163], a[80:83]
  s_add_u32 s13, s13, 4096
  v_mfma_f32_16x16x32_bf16 a[84:87], a[24:27], a[164:167], a[84:87]
  v_mfma_f32_16x16x32_bf16 a[88:91], a[24:27], a[168:171], a[88:91]
  v_mfma_f32_16x16x32_bf16 a[92:95], a[24:27], a[172:175], a[92:95]
  buffer_load_dwordx4 a[16:19], v2, s[40:43], s13 offen offset:0 sc1
  v_mfma_f32_16x16x32_bf16 a[96:99], a[28:31], a[160:163], a[96:99]
  v_mfma_f32_16x16x32_bf16 a[100:103], a[28:31], a[164:167], a[100:103]
  v_mfma_f32_16x16x32_bf16 a[104:107], a[28:31], a[168:171], a[104:107]
  v_mfma_f32_16x16x32_bf16 a[108:111], a[28:31], a[172:175], a[108:111]
  buffer_load_dwordx4 a[20:23], v2, s[40:43], s13 offen offset:1024 sc1
  v_mfma_f32_16x16x32_bf16 a[112:115], a[32:35], a[160:163], a[112:115]
  v_mfma_f32_16x16x32_bf16 a[116:119], a[32:35], a[164:167], a[116:119]
  v_mfma_f32_16x16x32_bf16 a[120:123], a[32:35], a[168:171], a[120:123]
  v_mfma_f32_16x16x32_bf16 a[124:127], a[32:35], a[172:175], a[124:127]
  v_mfma_f32_16x16x32_bf16 a[128:131], a[36:39], a[160:163], a[128:131]
  buffer_load_dwordx4 a[160:163], v2, s[40:43], s64 offen offset:1024 sc1
  v_mfma_f32_16x16x32_bf16 a[132:135], a[36:39], a[164:167], a[132:135]
  buffer_load_dwordx4 a[164:167], v2, s[40:43], s65 offen offset:1024 sc1
  v_mfma_f32_16x16x32_bf16 a[136:139], a[36:39], a[168:171], a[136:139]
  buffer_load_dwordx4 a[168:171], v2, s[40:43], s66 offen offset:1024 sc1
  v_mfma_f32_16x16x32_bf16 a[140:143], a[36:39], a[172:175], a[140:143]
  buffer_load_dwordx4 a[172:175], v2, s[40:43], s67 offen offset:1024 sc1
  s_waitcnt vmcnt(18)
  v_mfma_f32_16x16x32_bf16 a[64:67], a[40:43], a[176:179], a[64:67]
  v_mfma_f32_16x16x32_bf16 a[68:71], a[40:43], a[180:183], a[68:71]
  v_mfma_f32_16x16x32_bf16 a[72:75], a[40:43], a[184:187], a[72:75]
  v_mfma_f32_16x16x32_bf16 a[76:79], a[40:43], a[188:191], a[76:79]
  buffer_load_dwordx4 a[24:27], v2, s[40:43], s13 offen offset:2048 sc1
  v_mfma_f32_16x16x32_bf16 a[80:83], a[44:47], a[176:179], a[80:83]
  v_mfma_f32_16x16x32_bf16 a[84:87], a[44:47], a[180:183], a[84:87]
  v_mfma_f32_16x16x32_bf16 a[88:91], a[44:47], a[184:187], a[88:91]
  v_mfma_f32_16x16x32_bf16 a[92:95], a[44:47], a[188:191], a[92:95]
  buffer_load_dwordx4 a[28:31], v2, s[40:43], s13 offen offset:3072 sc1
  v_mfma_f32_16x16x32_bf16 a[96:99], a[48:51], a[176:179], a[96:99]
  s_add_u32 s13, s13, 4096
  v_mfma_f32_16x16x32_bf16 a[100:103], a[48:51], a[180:183], a[100:103]
  v_mfma_f32_16x16x32_bf16 a[104:107], a[48:51], a[184:187], a[104:107]
  v_mfma_f32_16x16x32_bf16 a[108:111], a[48:51], a[188:191], a[108:111]
  buffer_load_dwordx4 a[32:35], v2, s[40:43], s13 offen offset:0 sc1
  v_mfma_f32_16x16x32_bf16 a[112:115], a[52:55], a[176:179], a[112:115]
  v_mfma_f32_16x16x32_bf16 a[116:119], a[52:55], a[180:183], a[116:119]
  v_mfma_f32_16x16x32_bf16 a[120:123], a[52:55], a[184:187], a[120:123]
  v_mfma_f32_16x16x32_bf16 a[124:127], a[52:55], a[188:191], a[124:127]
  v_mfma_f32_16x16x32_bf16 a[128:131], a[56:59], a[176:179], a[128:131]
  buffer_load_dwordx4 a[176:179], v2, s[40:43], s64 offen offset:2048 sc1
  v_mfma_f32_16x16x32_bf16 a[132:135], a[56:59], a[180:183], a[132:135]
  buffer_load_dwordx4 a[180:183], v2, s[40:43], s65 offen offset:2048 sc1
  v_mfma_f32_16x16x32_bf16 a[136:139], a[56:59], a[184:187], a[136:139]
  buffer_load_dwordx4 a[184:187], v2, s[40:43], s66 offen offset:2048 sc1
  v_mfma_f32_16x16x32_bf16 a[140:143], a[56:59], a[188:191], a[140:143]
  buffer_load_dwordx4 a[188:191], v2, s[40:43], s67 offen offset:2048 sc1
  s_waitcnt vmcnt(21)
  v_mfma_f32_16x16x32_bf16 a[64:67], a[60:63], v[216:219], a[64:67]
  v_mfma_f32_16x16x32_bf16 a[68:71], a[60:63], v[220:223], a[68:71]
  v_mfma_f32_16x16x32_bf16 a[72:75], a[60:63], v[224:227], a[72:75]
  v_mfma_f32_16x16x32_bf16 a[76:79], a[60:63], v[228:231], a[76:79]
  buffer_load_dwordx4 a[36:39], v2, s[40:43], s13 offen offset:1024 sc1
  v_mfma_f32_16x16x32_bf16 a[80:83], a[192:195], v[216:219], a[80:83]
  v_mfma_f32_16x16x32_bf16 a[84:87], a[192:195], v[220:223], a[84:87]
  v_mfma_f32_16x16x32_bf16 a[88:91], a[192:195], v[224:227], a[88:91]
  v_mfma_f32_16x16x32_bf16 a[92:95], a[192:195], v[228:231], a[92:95]
  buffer_load_dwordx4 a[40:43], v2, s[40:43], s13 offen offset:2048 sc1
  v_mfma_f32_16x16x32_bf16 a[96:99], a[196:199], v[216:219], a[96:99]
  v_mfma_f32_16x16x32_bf16 a[100:103], a[196:199], v[220:223], a[100:103]
  v_mfma_f32_16x16x32_bf16 a[104:107], a[196:199], v[224:227], a[104:107]
  v_mfma_f32_16x16x32_bf16 a[108:111], a[196:199], v[228:231], a[108:111]
  buffer_load_dwordx4 a[44:47], v2, s[40:43], s13 offen offset:3072 sc1
  v_mfma_f32_16x16x32_bf16 a[112:115], a[200:203], v[216:219], a[112:115]
  s_add_u32 s13, s13, 4096
  v_mfma_f32_16x16x32_bf16 a[116:119], a[200:203], v[220:223], a[116:119]
  v_mfma_f32_16x16x32_bf16 a[120:123], a[200:203], v[224:227], a[120:123]
  v_mfma_f32_16x16x32_bf16 a[124:127], a[200:203], v[228:231], a[124:127]
  v_mfma_f32_16x16x32_bf16 a[128:131], a[204:207], v[216:219], a[128:131]
  buffer_load_dwordx4 v[216:219], v2, s[40:43], s64 offen offset:3072 sc1
  v_mfma_f32_16x16x32_bf16 a[132:135], a[204:207], v[220:223], a[132:135]
  buffer_load_dwordx4 v[220:223], v2, s[40:43], s65 offen offset:3072 sc1
  v_mfma_f32_16x16x32_bf16 a[136:139], a[204:207], v[224:227], a[136:139]
  buffer_load_dwordx4 v[224:227], v2, s[40:43], s66 offen offset:3072 sc1
  v_mfma_f32_16x16x32_bf16 a[140:143], a[204:207], v[228:231], a[140:143]
  buffer_load_dwordx4 v[228:231], v2, s[40:43], s67 offen offset:3072 sc1
  s_waitcnt vmcnt(21)
  v_mfma_f32_16x16x32_bf16 a[64:67], a[208:211], a[144:147], a[64:67]
  s_add_u32 s64, s64, 4096
  v_mfma_f32_16x16x32_bf16 a[68:71], a[208:211], a[148:151], a[68:71]
  s_add_u32 s65, s65, 4096
  v_mfma_f32_16x16x32_bf16 a[72:75], a[208:211], a[152:155], a[72:75]
  s_add_u32 s66, s66, 4096
  v_mfma_f32_16x16x32_bf16 a[76:79], a[208:211], a[156:159], a[76:79]
  buffer_load_dwordx4 a[48:51], v2, s[40:43], s13 offen offset:0 sc1
  v_mfma_f32_16x16x32_bf16 a[80:83], a[212:215], a[144:147], a[80:83]
  v_mfma_f32_16x16x32_bf16 a[84:87], a[212:215], a[148:151], a[84:87]
  v_mfma_f32_16x16x32_bf16 a[88:91], a[212:215], a[152:155], a[88:91]
  s_add_u32 s67, s67, 4096
  v_mfma_f32_16x16x32_bf16 a[92:95], a[212:215], a[156:159], a[92:95]
  buffer_load_dwordx4 a[52:55], v2, s[40:43], s13 offen offset:1024 sc1
  v_mfma_f32_16x16x32_bf16 a[96:99], a[216:219], a[144:147], a[96:99]
  v_mfma_f32_16x16x32_bf16 a[100:103], a[216:219], a[148:151], a[100:103]
  v_mfma_f32_16x16x32_bf16 a[104:107], a[216:219], a[152:155], a[104:107]
  v_mfma_f32_16x16x32_bf16 a[108:111], a[216:219], a[156:159], a[108:111]
  buffer_load_dwordx4 a[56:59], v2, s[40:43], s13 offen offset:2048 sc1
  v_mfma_f32_16x16x32_bf16 a[112:115], a[220:223], a[144:147], a[112:115]
  v_mfma_f32_16x16x32_bf16 a[116:119], a[220:223], a[148:151], a[116:119]
  v_mfma_f32_16x16x32_bf16 a[120:123], a[220:223], a[152:155], a[120:123]
  v_mfma_f32_16x16x32_bf16 a[124:127], a[220:223], a[156:159], a[124:127]
  v_mfma_f32_16x16x32_bf16 a[128:131], a[224:227], a[144:147], a[128:131]
  buffer_load_dwordx4 a[144:147], v2, s[40:43], s64 offen offset:0 sc1
  v_mfma_f32_16x16x32_bf16 a[132:135], a[224:227], a[148:151], a[132:135]
  buffer_load_dwordx4 a[148:151], v2, s[40:43], s65 offen offset:0 sc1
  v_mfma_f32_16x16x32_bf16 a[136:139], a[224:227], a[152:155], a[136:139]
  buffer_load_dwordx4 a[152:155], v2, s[40:43], s66 offen offset:0 sc1
  v_mfma_f32_16x16x32_bf16 a[140:143], a[224:227], a[156:159], a[140:143]
  buffer_load_dwordx4 a[156:159], v2, s[40:43], s67 offen offset:0 sc1
  s_waitcnt vmcnt(21)
  v_mfma_f32_16x16x32_bf16 a[64:67], a[228:231], a[160:163], a[64:67]
  v_mfma_f32_16x16x32_bf16 a[68:71], a[228:231], a[164:167], a[68:71]
  v_mfma_f32_16x16x32_bf16 a[72:75], a[228:231], a[168:171], a[72:75]
  v_mfma_f32_16x16x32_bf16 a[76:79], a[228:231], a[172:175], a[76:79]
  buffer_load_dwordx4 a[60:63], v2, s[40:43], s13 offen offset:3072 sc1
  v_mfma_f32_16x16x32_bf16 a[80:83], a[232:235], a[160:163], a[80:83]
  s_add_u32 s13, s13, 4096
  v_mfma_f32_16x16x32_bf16 a[84:87], a[232:235], a[164:167], a[84:87]
  v_mfma_f32_16x16x32_bf16 a[88:91], a[232:235], a[168:171], a[88:91]
  v_mfma_f32_16x16x32_bf16 a[92:95], a[232:235], a[172:175], a[92:95]
  buffer_load_dwordx4 a[192:195], v2, s[40:43], s13 offen offset:0 sc1
  v_mfma_f32_16x16x32_bf16 a[96:99], a[236:239], a[160:163], a[96:99]
  v_mfma_f32_16x16x32_bf16 a[100:103], a[236:239], a[164:167], a[100:103]
  v_mfma_f32_16x16x32_bf16 a[104:107], a[236:239], a[168:171], a[104:107]
  v_mfma_f32_16x16x32_bf16 a[108:111], a[236:239], a[172:175], a[108:111]
  buffer_load_dwordx4 a[196:199], v2, s[40:43], s13 offen offset:1024 sc1
  v_mfma_f32_16x16x32_bf16 a[112:115], a[240:243], a[160:163], a[112:115]
  v_mfma_f32_16x16x32_bf16 a[116:119], a[240:243], a[164:167], a[116:119]
  v_mfma_f32_16x16x32_bf16 a[120:123], a[240:243], a[168:171], a[120:123]
  v_mfma_f32_16x16x32_bf16 a[124:127], a[240:243], a[172:175], a[124:127]
  v_mfma_f32_16x16x32_bf16 a[128:131], a[244:247], a[160:163], a[128:131]
  buffer_load_dwordx4 a[160:163], v2, s[40:43], s64 offen offset:1024 sc1
  v_mfma_f32_16x16x32_bf16 a[132:135], a[244:247], a[164:167], a[132:135]
  buffer_load_dwordx4 a[164:167], v2, s[40:43], s65 offen offset:1024 sc1
  v_mfma_f32_16x16x32_bf16 a[136:139], a[244:247], a[168:171], a[136:139]
  buffer_load_dwordx4 a[168:171], v2, s[40:43], s66 offen offset:1024 sc1
  v_mfma_f32_16x16x32_bf16 a[140:143], a[244:247], a[172:175], a[140:143]
  buffer_load_dwordx4 a[172:175], v2, s[40:43], s67 offen offset:1024 sc1
  s_waitcnt vmcnt(21)
  v_mfma_f32_16x16x32_bf16 a[64:67], a[248:251], a[176:179], a[64:67]
  v_mfma_f32_16x16x32_bf16 a[68:71], a[248:251], a[180:183], a[68:71]
  v_mfma_f32_16x16x32_bf16 a[72:75], a[248:251], a[184:187], a[72:75]
  v_mfma_f32_16x16x32_bf16 a[76:79], a[248:251], a[188:191], a[76:79]
  buffer_load_dwordx4 a[200:203], v2, s[40:43], s13 offen offset:2048 sc1
  v_mfma_f32_16x16x32_bf16 a[80:83], a[252:255], a[176:179], a[80:83]
  v_mfma_f32_16x16x32_bf16 a[84:87], a[252:255], a[180:183], a[84:87]
  v_mfma_f32_16x16x32_bf16 a[88:91], a[252:255], a[184:187], a[88:91]
  v_mfma_f32_16x16x32_bf16 a[92:95], a[252:255], a[188:191], a[92:95]
  buffer_load_dwordx4 a[204:207], v2, s[40:43], s13 offen offset:3072 sc1
  v_mfma_f32_16x16x32_bf16 a[96:99], v[32:35], a[176:179], a[96:99]
  s_add_u32 s13, s13, 4096
  v_mfma_f32_16x16x32_bf16 a[100:103], v[32:35], a[180:183], a[100:103]
  v_mfma_f32_16x16x32_bf16 a[104:107], v[32:35], a[184:187], a[104:107]
  v_mfma_f32_16x16x32_bf16 a[108:111], v[32:35], a[188:191], a[108:111]
  buffer_load_dwordx4 a[208:211], v2, s[40:43], s13 offen offset:0 sc1
  v_mfma_f32_16x16x32_bf16 a[112:115], v[36:39], a[176:179], a[112:115]
  v_mfma_f32_16x16x32_bf16 a[116:119], v[36:39], a[180:183], a[116:119]
  v_mfma_f32_16x16x32_bf16 a[120:123], v[36:39], a[184:187], a[120:123]
  v_mfma_f32_16x16x32_bf16 a[124:127], v[36:39], a[188:191], a[124:127]
  v_mfma_f32_16x16x32_bf16 a[128:131], v[40:43], a[176:179], a[128:131]
  buffer_load_dwordx4 a[176:179], v2, s[40:43], s64 offen offset:2048 sc1
  v_mfma_f32_16x16x32_bf16 a[132:135], v[40:43], a[180:183], a[132:135]
  buffer_load_dwordx4 a[180:183], v2, s[40:43], s65 offen offset:2048 sc1
  v_mfma_f32_16x16x32_bf16 a[136:139], v[40:43], a[184:187], a[136:139]
  buffer_load_dwordx4 a[184:187], v2, s[40:43], s66 offen offset:2048 sc1
  v_mfma_f32_16x16x32_bf16 a[140:143], v[40:43], a[188:191], a[140:143]
  buffer_load_dwordx4 a[188:191], v2, s[40:43], s67 offen offset:2048 sc1
  s_waitcnt vmcnt(21)
  v_mfma_f32_16x16x32_bf16 a[64:67], v[44:47], v[216:219], a[64:67]
  v_mfma_f32_16x16x32_bf16 a[68:71], v[44:47], v[220:223], a[68:71]
  v_mfma_f32_16x16x32_bf16 a[72:75], v[44:47], v[224:227], a[72:75]
  v_mfma_f32_16x16x32_bf16 a[76:79], v[44:47], v[228:231], a[76:79]
  buffer_load_dwordx4 a[212:215], v2, s[40:43], s13 offen offset:1024 sc1
  v_mfma_f32_16x16x32_bf16 a[80:83], v[48:51], v[216:219], a[80:83]
  v_mfma_f32_16x16x32_bf16 a[84:87], v[48:51], v[220:223], a[84:87]
  v_mfma_f32_16x16x32_bf16 a[88:91], v[48:51], v[224:227], a[88:91]
  v_mfma_f32_16x16x32_bf16 a[92:95], v[48:51], v[228:231], a[92:95]
  buffer_load_dwordx4 a[216:219], v2, s[40:43], s13 offen offset:2048 sc1
  v_mfma_f32_16x16x32_bf16 a[96:99], v[52:55], v[216:219], a[96:99]
  v_mfma_f32_16x16x32_bf16 a[100:103], v[52:55], v[220:223], a[100:103]
  v_mfma_f32_16x16x32_bf16 a[104:107], v[52:55], v[224:227], a[104:107]
  v_mfma_f32_16x16x32_bf16 a[108:111], v[52:55], v[228:231], a[108:111]
  buffer_load_dwordx4 a[220:223], v2, s[40:43], s13 offen offset:3072 sc1
  v_mfma_f32_16x16x32_bf16 a[112:115], v[56:59], v[216:219], a[112:115]
  s_add_u32 s13, s13, 4096
  v_mfma_f32_16x16x32_bf16 a[116:119], v[56:59], v[220:223], a[116:119]
  v_mfma_f32_16x16x32_bf16 a[120:123], v[56:59], v[224:227], a[120:123]
  v_mfma_f32_16x16x32_bf16 a[124:127], v[56:59], v[228:231], a[124:127]
  v_mfma_f32_16x16x32_bf16 a[128:131], v[60:63], v[216:219], a[128:131]
  buffer_load_dwordx4 v[216:219], v2, s[40:43], s64 offen offset:3072 sc1
  v_mfma_f32_16x16x32_bf16 a[132:135], v[60:63], v[220:223], a[132:135]
  buffer_load_dwordx4 v[220:223], v2, s[40:43], s65 offen offset:3072 sc1
  v_mfma_f32_16x16x32_bf16 a[136:139], v[60:63], v[224:227], a[136:139]
  buffer_load_dwordx4 v[224:227], v2, s[40:43], s66 offen offset:3072 sc1
  v_mfma_f32_16x16x32_bf16 a[140:143], v[60:63], v[228:231], a[140:143]
  buffer_load_dwordx4 v[228:231], v2, s[40:43], s67 offen offset:3072 sc1
  s_waitcnt vmcnt(21)
  v_mfma_f32_16x16x32_bf16 a[64:67], v[96:99], a[144:147], a[64:67]
  s_add_u32 s64, s64, 4096
  v_mfma_f32_16x16x32_bf16 a[68:71], v[96:99], a[148:151], a[68:71]
  s_add_u32 s65, s65, 4096
  v_mfma_f32_16x16x32_bf16 a[72:75], v[96:99], a[152:155], a[72:75]
  s_add_u32 s66, s66, 4096
  v_mfma_f32_16x16x32_bf16 a[76:79], v[96:99], a[156:159], a[76:79]
  buffer_load_dwordx4 a[224:227], v2, s[40:43], s13 offen offset:0 sc1
  v_mfma_f32_16x16x32_bf16 a[80:83], v[100:103], a[144:147], a[80:83]
  v_mfma_f32_16x16x32_bf16 a[84:87], v[100:103], a[148:151], a[84:87]
  v_mfma_f32_16x16x32_bf16 a[88:91], v[100:103], a[152:155], a[88:91]
  s_add_u32 s67, s67, 4096
  v_mfma_f32_16x16x32_bf16 a[92:95], v[100:103], a[156:159], a[92:95]
  buffer_load_dwordx4 a[228:231], v2, s[40:43], s13 offen offset:1024 sc1
  v_mfma_f32_16x16x32_bf16 a[96:99], v[104:107], a[144:147], a[96:99]
  v_mfma_f32_16x16x32_bf16 a[100:103], v[104:107], a[148:151], a[100:103]
  v_mfma_f32_16x16x32_bf16 a[104:107], v[104:107], a[152:155], a[104:107]
  v_mfma_f32_16x16x32_bf16 a[108:111], v[104:107], a[156:159], a[108:111]
  buffer_load_dwordx4 a[232:235], v2, s[40:43], s13 offen offset:2048 sc1
  v_mfma_f32_16x16x32_bf16 a[112:115], v[108:111], a[144:147], a[112:115]
  v_mfma_f32_16x16x32_bf16 a[116:119], v[108:111], a[148:151], a[116:119]
  v_mfma_f32_16x16x32_bf16 a[120:123], v[108:111], a[152:155], a[120:123]
  v_mfma_f32_16x16x32_bf16 a[124:127], v[108:111], a[156:159], a[124:127]
  v_mfma_f32_16x16x32_bf16 a[128:131], v[112:115], a[144:147], a[128:131]
  buffer_load_dwordx4 a[144:147], v2, s[40:43], s64 offen offset:0 sc1
  v_mfma_f32_16x16x32_bf16 a[132:135], v[112:115], a[148:151], a[132:135]
  buffer_load_dwordx4 a[148:151], v2, s[40:43], s65 offen offset:0 sc1
  v_mfma_f32_16x16x32_bf16 a[136:139], v[112:115], a[152:155], a[136:139]
  buffer_load_dwordx4 a[152:155], v2, s[40:43], s66 offen offset:0 sc1
  v_mfma_f32_16x16x32_bf16 a[140:143], v[112:115], a[156:159], a[140:143]
  buffer_load_dwordx4 a[156:159], v2, s[40:43], s67 offen offset:0 sc1
  s_waitcnt vmcnt(21)
  v_mfma_f32_16x16x32_bf16 a[64:67], v[116:119], a[160:163], a[64:67]
  v_mfma_f32_16x16x32_bf16 a[68:71], v[116:119], a[164:167], a[68:71]
  v_mfma_f32_16x16x32_bf16 a[72:75], v[116:119], a[168:171], a[72:75]
  v_mfma_f32_16x16x32_bf16 a[76:79], v[116:119], a[172:175], a[76:79]
  buffer_load_dwordx4 a[236:239], v2, s[40:43], s13 offen offset:3072 sc1
  v_mfma_f32_16x16x32_bf16 a[80:83], v[120:123], a[160:163], a[80:83]
  s_add_u32 s13, s13, 4096
  v_mfma_f32_16x16x32_bf16 a[84:87], v[120:123], a[164:167], a[84:87]
  v_mfma_f32_16x16x32_bf16 a[88:91], v[120:123], a[168:171], a[88:91]
  v_mfma_f32_16x16x32_bf16 a[92:95], v[120:123], a[172:175], a[92:95]
  buffer_load_dwordx4 a[240:243], v2, s[40:43], s13 offen offset:0 sc1
  v_mfma_f32_16x16x32_bf16 a[96:99], v[124:127], a[160:163], a[96:99]
  v_mfma_f32_16x16x32_bf16 a[100:103], v[124:127], a[164:167], a[100:103]
  v_mfma_f32_16x16x32_bf16 a[104:107], v[124:127], a[168:171], a[104:107]
  v_mfma_f32_16x16x32_bf16 a[108:111], v[124:127], a[172:175], a[108:111]
  buffer_load_dwordx4 a[244:247], v2, s[40:43], s13 offen offset:1024 sc1
  v_mfma_f32_16x16x32_bf16 a[112:115], v[160:163], a[160:163], a[112:115]
  v_mfma_f32_16x16x32_bf16 a[116:119], v[160:163], a[164:167], a[116:119]
  v_mfma_f32_16x16x32_bf16 a[120:123], v[160:163], a[168:171], a[120:123]
  v_mfma_f32_16x16x32_bf16 a[124:127], v[160:163], a[172:175], a[124:127]
  v_mfma_f32_16x16x32_bf16 a[128:131], v[164:167], a[160:163], a[128:131]
  buffer_load_dwordx4 a[160:163], v2, s[40:43], s64 offen offset:1024 sc1
  v_mfma_f32_16x16x32_bf16 a[132:135], v[164:167], a[164:167], a[132:135]
  buffer_load_dwordx4 a[164:167], v2, s[40:43], s65 offen offset:1024 sc1
  v_mfma_f32_16x16x32_bf16 a[136:139], v[164:167], a[168:171], a[136:139]
  buffer_load_dwordx4 a[168:171], v2, s[40:43], s66 offen offset:1024 sc1
  v_mfma_f32_16x16x32_bf16 a[140:143], v[164:167], a[172:175], a[140:143]
  buffer_load_dwordx4 a[172:175], v2, s[40:43], s67 offen offset:1024 sc1
  s_waitcnt vmcnt(21)
  v_mfma_f32_16x16x32_bf16 a[64:67], v[168:171], a[176:179], a[64:67]
  v_mfma_f32_16x16x32_bf16 a[68:71], v[168:171], a[180:183], a[68:71]
  v_mfma_f32_16x16x32_bf16 a[72:75], v[168:171], a[184:187], a[72:75]
  v_mfma_f32_16x16x32_bf16 a[76:79], v[168:171], a[188:191], a[76:79]
  buffer_load_dwordx4 a[248:251], v2, s[40:43], s13 offen offset:2048 sc1
  v_mfma_f32_16x16x32_bf16 a[80:83], v[172:175], a[176:179], a[80:83]
  v_mfma_f32_16x16x32_bf16 a[84:87], v[172:175], a[180:183], a[84:87]
  v_mfma_f32_16x16x32_bf16 a[88:91], v[172:175], a[184:187], a[88:91]
  v_mfma_f32_16x16x32_bf16 a[92:95], v[172:175], a[188:191], a[92:95]
  buffer_load_dwordx4 a[252:255], v2, s[40:43], s13 offen offset:3072 sc1
  v_mfma_f32_16x16x32_bf16 a[96:99], v[192:195], a[176:179], a[96:99]
  s_add_u32 s13, s13, 4096
  v_mfma_f32_16x16x32_bf16 a[100:103], v[192:195], a[180:183], a[100:103]
  v_mfma_f32_16x16x32_bf16 a[104:107], v[192:195], a[184:187], a[104:107]
  v_mfma_f32_16x16x32_bf16 a[108:111], v[192:195], a[188:191], a[108:111]
  buffer_load_dwordx4 v[32:35], v2, s[40:43], s13 offen offset:0 sc1
  v_mfma_f32_16x16x32_bf16 a[112:115], v[196:199], a[176:179], a[112:115]
  v_mfma_f32_16x16x32_bf16 a[116:119], v[196:199], a[180:183], a[116:119]
  v_mfma_f32_16x16x32_bf16 a[120:123], v[196:199], a[184:187], a[120:123]
  v_mfma_f32_16x16x32_bf16 a[124:127], v[196:199], a[188:191], a[124:127]
  v_mfma_f32_16x16x32_bf16 a[128:131], v[208:211], a[176:179], a[128:131]
  buffer_load_dwordx4 a[176:179], v2, s[40:43], s64 offen offset:2048 sc1
  v_mfma_f32_16x16x32_bf16 a[132:135], v[208:211], a[180:183], a[132:135]
  buffer_load_dwordx4 a[180:183], v2, s[40:43], s65 offen offset:2048 sc1
  v_mfma_f32_16x16x32_bf16 a[136:139], v[208:211], a[184:187], a[136:139]
  buffer_load_dwordx4 a[184:187], v2, s[40:43], s66 offen offset:2048 sc1
  v_mfma_f32_16x16x32_bf16 a[140:143], v[208:211], a[188:191], a[140:143]
  buffer_load_dwordx4 a[188:191], v2, s[40:43], s67 offen offset:2048 sc1
  s_waitcnt vmcnt(21)
  v_mfma_f32_16x16x32_bf16 a[64:67], v[212:215], v[216:219], a[64:67]
  v_mfma_f32_16x16x32_bf16 a[68:71], v[212:215], v[220:223], a[68:71]
  v_mfma_f32_16x16x32_bf16 a[72:75], v[212:215], v[224:227], a[72:75]
  v_mfma_f32_16x16x32_bf16 a[76:79], v[212:215], v[228:231], a[76:79]
  buffer_load_dwordx4 v[36:39], v2, s[40:43], s13 offen offset:1024 sc1
  v_mfma_f32_16x16x32_bf16 a[80:83], v[232:235], v[216:219], a[80:83]
  v_mfma_f32_16x16x32_bf16 a[84:87], v[232:235], v[220:223], a[84:87]
  v_mfma_f32_16x16x32_bf16 a[88:91], v[232:235], v[224:227], a[88:91]
  v_mfma_f32_16x16x32_bf16 a[92:95], v[232:235], v[228:231], a[92:95]
  buffer_load_dwordx4 v[40:43], v2, s[40:43], s13 offen offset:2048 sc1
  v_mfma_f32_16x16x32_bf16 a[96:99], v[236:239], v[216:219], a[96:99]
  v_mfma_f32_16x16x32_bf16 a[100:103], v[236:239], v[220:223], a[100:103]
  v_mfma_f32_16x16x32_bf16 a[104:107], v[236:239], v[224:227], a[104:107]
  v_mfma_f32_16x16x32_bf16 a[108:111], v[236:239], v[228:231], a[108:111]
  buffer_load_dwordx4 v[44:47], v2, s[40:43], s13 offen offset:3072 sc1
  v_mfma_f32_16x16x32_bf16 a[112:115], v[240:243], v[216:219], a[112:115]
  s_add_u32 s13, s13, 4096
  v_mfma_f32_16x16x32_bf16 a[116:119], v[240:243], v[220:223], a[116:119]
  v_mfma_f32_16x16x32_bf16 a[120:123], v[240:243], v[224:227], a[120:123]
  v_mfma_f32_16x16x32_bf16 a[124:127], v[240:243], v[228:231], a[124:127]
  v_mfma_f32_16x16x32_bf16 a[128:131], v[244:247], v[216:219], a[128:131]
  buffer_load_dwordx4 v[216:219], v2, s[40:43], s64 offen offset:3072 sc1
  v_mfma_f32_16x16x32_bf16 a[132:135], v[244:247], v[220:223], a[132:135]
  buffer_load_dwordx4 v[220:223], v2, s[40:43], s65 offen offset:3072 sc1
  v_mfma_f32_16x16x32_bf16 a[136:139], v[244:247], v[224:227], a[136:139]
  buffer_load_dwordx4 v[224:227], v2, s[40:43], s66 offen offset:3072 sc1
  v_mfma_f32_16x16x32_bf16 a[140:143], v[244:247], v[228:231], a[140:143]
  buffer_load_dwordx4 v[228:231], v2, s[40:43], s67 offen offset:3072 sc1
  s_waitcnt vmcnt(21)
  v_mfma_f32_16x16x32_bf16 a[64:67], v[64:67], a[144:147], a[64:67]
  s_add_u32 s64, s64, 4096
  v_mfma_f32_16x16x32_bf16 a[68:71], v[64:67], a[148:151], a[68:71]
  s_add_u32 s65, s65, 4096
  v_mfma_f32_16x16x32_bf16 a[72:75], v[64:67], a[152:155], a[72:75]
  s_add_u32 s66, s66, 4096
  v_mfma_f32_16x16x32_bf16 a[76:79], v[64:67], a[156:159], a[76:79]
  buffer_load_dwordx4 v[48:51], v2, s[40:43], s13 offen offset:0 sc1
  v_mfma_f32_16x16x32_bf16 a[80:83], v[68:71], a[144:147], a[80:83]
  v_mfma_f32_16x16x32_bf16 a[84:87], v[68:71], a[148:151], a[84:87]
  v_mfma_f32_16x16x32_bf16 a[88:91], v[68:71], a[152:155], a[88:91]
  s_add_u32 s67, s67, 4096
  v_mfma_f32_16x16x32_bf16 a[92:95], v[68:71], a[156:159], a[92:95]
  buffer_load_dwordx4 v[52:55], v2, s[40:43], s13 offen offset:1024 sc1
  v_mfma_f32_16x16x32_bf16 a[96:99], v[72:75], a[144:147], a[96:99]
  v_mfma_f32_16x16x32_bf16 a[100:103], v[72:75], a[148:151], a[100:103]
  v_mfma_f32_16x16x32_bf16 a[104:107], v[72:75], a[152:155], a[104:107]
  v_mfma_f32_16x16x32_bf16 a[108:111], v[72:75], a[156:159], a[108:111]
  buffer_load_dwordx4 v[56:59], v2, s[40:43], s13 offen offset:2048 sc1
  v_mfma_f32_16x16x32_bf16 a[112:115], v[76:79], a[144:147], a[112:115]
  v_mfma_f32_16x16x32_bf16 a[116:119], v[76:79], a[148:151], a[116:119]
  v_mfma_f32_16x16x32_bf16 a[120:123], v[76:79], a[152:155], a[120:123]
  v_mfma_f32_16x16x32_bf16 a[124:127], v[76:79], a[156:159], a[124:127]
  v_mfma_f32_16x16x32_bf16 a[128:131], v[80:83], a[144:147], a[128:131]
  buffer_load_dwordx4 a[144:147], v2, s[40:43], s64 offen offset:0 sc1
  v_mfma_f32_16x16x32_bf16 a[132:135], v[80:83], a[148:151], a[132:135]
  buffer_load_dwordx4 a[148:151], v2, s[40:43], s65 offen offset:0 sc1
  v_mfma_f32_16x16x32_bf16 a[136:139], v[80:83], a[152:155], a[136:139]
  buffer_load_dwordx4 a[152:155], v2, s[40:43], s66 offen offset:0 sc1
  v_mfma_f32_16x16x32_bf16 a[140:143], v[80:83], a[156:159], a[140:143]
  buffer_load_dwordx4 a[156:159], v2, s[40:43], s67 offen offset:0 sc1
  s_waitcnt vmcnt(21)
  v_mfma_f32_16x16x32_bf16 a[64:67], v[84:87], a[160:163], a[64:67]
  v_mfma_f32_16x16x32_bf16 a[68:71], v[84:87], a[164:167], a[68:71]
  v_mfma_f32_16x16x32_bf16 a[72:75], v[84:87], a[168:171], a[72:75]
  v_mfma_f32_16x16x32_bf16 a[76:79], v[84:87], a[172:175], a[76:79]
  buffer_load_dwordx4 v[60:63], v2, s[40:43], s13 offen offset:3072 sc1
  v_mfma_f32_16x16x32_bf16 a[80:83], v[88:91], a[160:163], a[80:83]
  s_add_u32 s13, s13, 4096
  v_mfma_f32_16x16x32_bf16 a[84:87], v[88:91], a[164:167], a[84:87]
  v_mfma_f32_16x16x32_bf16 a[88:91], v[88:91], a[168:171], a[88:91]
  v_mfma_f32_16x16x32_bf16 a[92:95], v[88:91], a[172:175], a[92:95]
  buffer_load_dwordx4 v[96:99], v2, s[40:43], s13 offen offset:0 sc1
  v_mfma_f32_16x16x32_bf16 a[96:99], v[92:95], a[160:163], a[96:99]
  v_mfma_f32_16x16x32_bf16 a[100:103], v[92:95], a[164:167], a[100:103]
  v_mfma_f32_16x16x32_bf16 a[104:107], v[92:95], a[168:171], a[104:107]
  v_mfma_f32_16x16x32_bf16 a[108:111], v[92:95], a[172:175], a[108:111]
  buffer_load_dwordx4 v[100:103], v2, s[40:43], s13 offen offset:1024 sc1
  v_mfma_f32_16x16x32_bf16 a[112:115], v[128:131], a[160:163], a[112:115]
  v_mfma_f32_16x16x32_bf16 a[116:119], v[128:131], a[164:167], a[116:119]
  v_mfma_f32_16x16x32_bf16 a[120:123], v[128:131], a[168:171], a[120:123]
  v_mfma_f32_16x16x32_bf16 a[124:127], v[128:131], a[172:175], a[124:127]
  v_mfma_f32_16x16x32_bf16 a[128:131], v[132:135], a[160:163], a[128:131]
  buffer_load_dwordx4 a[160:163], v2, s[40:43], s64 offen offset:1024 sc1
  v_mfma_f32_16x16x32_bf16 a[132:135], v[132:135], a[164:167], a[132:135]
  buffer_load_dwordx4 a[164:167], v2, s[40:43], s65 offen offset:1024 sc1
  v_mfma_f32_16x16x32_bf16 a[136:139], v[132:135], a[168:171], a[136:139]
  buffer_load_dwordx4 a[168:171], v2, s[40:43], s66 offen offset:1024 sc1
  v_mfma_f32_16x16x32_bf16 a[140:143], v[132:135], a[172:175], a[140:143]
  buffer_load_dwordx4 a[172:175], v2, s[40:43], s67 offen offset:1024 sc1
  s_waitcnt vmcnt(21)
  v_mfma_f32_16x16x32_bf16 a[64:67], v[136:139], a[176:179], a[64:67]
  v_mfma_f32_16x16x32_bf16 a[68:71], v[136:139], a[180:183], a[68:71]
  v_mfma_f32_16x16x32_bf16 a[72:75], v[136:139], a[184:187], a[72:75]
  v_mfma_f32_16x16x32_bf16 a[76:79], v[136:139], a[188:191], a[76:79]
  buffer_load_dwordx4 v[104:107], v2, s[40:43], s13 offen offset:2048 sc1
  v_mfma_f32_16x16x32_bf16 a[80:83], v[140:143], a[176:179], a[80:83]
  v_mfma_f32_16x16x32_bf16 a[84:87], v[140:143], a[180:183], a[84:87]
  v_mfma_f32_16x16x32_bf16 a[88:91], v[140:143], a[184:187], a[88:91]
  v_mfma_f32_16x16x32_bf16 a[92:95], v[140:143], a[188:191], a[92:95]
  buffer_load_dwordx4 v[108:111], v2, s[40:43], s13 offen offset:3072 sc1
  v_mfma_f32_16x16x32_bf16 a[96:99], v[144:147], a[176:179], a[96:99]
  s_add_u32 s13, s13, 4096
  v_mfma_f32_16x16x32_bf16 a[100:103], v[144:147], a[180:183], a[100:103]
  v_mfma_f32_16x16x32_bf16 a[104:107], v[144:147], a[184:187], a[104:107]
  v_mfma_f32_16x16x32_bf16 a[108:111], v[144:147], a[188:191], a[108:111]
  buffer_load_dwordx4 v[112:115], v2, s[40:43], s13 offen offset:0 sc1
  v_mfma_f32_16x16x32_bf16 a[112:115], v[148:151], a[176:179], a[112:115]
  v_mfma_f32_16x16x32_bf16 a[116:119], v[148:151], a[180:183], a[116:119]
  v_mfma_f32_16x16x32_bf16 a[120:123], v[148:151], a[184:187], a[120:123]
  v_mfma_f32_16x16x32_bf16 a[124:127], v[148:151], a[188:191], a[124:127]
  v_mfma_f32_16x16x32_bf16 a[128:131], v[152:155], a[176:179], a[128:131]
  buffer_load_dwordx4 a[176:179], v2, s[40:43], s64 offen offset:2048 sc1
  v_mfma_f32_16x16x32_bf16 a[132:135], v[152:155], a[180:183], a[132:135]
  buffer_load_dwordx4 a[180:183], v2, s[40:43], s65 offen offset:2048 sc1
  v_mfma_f32_16x16x32_bf16 a[136:139], v[152:155], a[184:187], a[136:139]
  buffer_load_dwordx4 a[184:187], v2, s[40:43], s66 offen offset:2048 sc1
  v_mfma_f32_16x16x32_bf16 a[140:143], v[152:155], a[188:191], a[140:143]
  buffer_load_dwordx4 a[188:191], v2, s[40:43], s67 offen offset:2048 sc1
  s_waitcnt vmcnt(21)
  v_mfma_f32_16x16x32_bf16 a[64:67], v[156:159], v[216:219], a[64:67]
  v_mfma_f32_16x16x32_bf16 a[68:71], v[156:159], v[220:223], a[68:71]
  v_mfma_f32_16x16x32_bf16 a[72:75], v[156:159], v[224:227], a[72:75]
  v_mfma_f32_16x16x32_bf16 a[76:79], v[156:159], v[228:231], a[76:79]
  buffer_load_dwordx4 v[116:119], v2, s[40:43], s13 offen offset:1024 sc1
  v_mfma_f32_16x16x32_bf16 a[80:83], v[176:179], v[216:219], a[80:83]
  v_mfma_f32_16x16x32_bf16 a[84:87], v[176:179], v[220:223], a[84:87]
  v_mfma_f32_16x16x32_bf16 a[88:91], v[176:179], v[224:227], a[88:91]
  v_mfma_f32_16x16x32_bf16 a[92:95], v[176:179], v[228:231], a[92:95]
  buffer_load_dwordx4 v[120:123], v2, s[40:43], s13 offen offset:2048 sc1
  v_mfma_f32_16x16x32_bf16 a[96:99], v[180:183], v[216:219], a[96:99]
  v_mfma_f32_16x16x32_bf16 a[100:103], v[180:183], v[220:223], a[100:103]
  v_mfma_f32_16x16x32_bf16 a[104:107], v[180:183], v[224:227], a[104:107]
  v_mfma_f32_16x16x32_bf16 a[108:111], v[180:183], v[228:231], a[108:111]
  buffer_load_dwordx4 v[124:127], v2, s[40:43], s13 offen offset:3072 sc1
  v_mfma_f32_16x16x32_bf16 a[112:115], v[184:187], v[216:219], a[112:115]
  s_add_u32 s13, s13, 4096
  v_mfma_f32_16x16x32_bf16 a[116:119], v[184:187], v[220:223], a[116:119]
  v_mfma_f32_16x16x32_bf16 a[120:123], v[184:187], v[224:227], a[120:123]
  v_mfma_f32_16x16x32_bf16 a[124:127], v[184:187], v[228:231], a[124:127]
  v_mfma_f32_16x16x32_bf16 a[128:131], v[188:191], v[216:219], a[128:131]
  buffer_load_dwordx4 v[216:219], v2, s[40:43], s64 offen offset:3072 sc1
  v_mfma_f32_16x16x32_bf16 a[132:135], v[188:191], v[220:223], a[132:135]
  buffer_load_dwordx4 v[220:223], v2, s[40:43], s65 offen offset:3072 sc1
  v_mfma_f32_16x16x32_bf16 a[136:139], v[188:191], v[224:227], a[136:139]
  buffer_load_dwordx4 v[224:227], v2, s[40:43], s66 offen offset:3072 sc1
  v_mfma_f32_16x16x32_bf16 a[140:143], v[188:191], v[228:231], a[140:143]
  buffer_load_dwordx4 v[228:231], v2, s[40:43], s67 offen offset:3072 sc1
  s_waitcnt vmcnt(21)
  v_mfma_f32_16x16x32_bf16 a[64:67], a[0:3], a[144:147], a[64:67]
  s_add_u32 s64, s64, 4096
  v_mfma_f32_16x16x32_bf16 a[68:71], a[0:3], a[148:151], a[68:71]
  s_add_u32 s65, s65, 4096
  v_mfma_f32_16x16x32_bf16 a[72:75], a[0:3], a[152:155], a[72:75]
  s_add_u32 s66, s66, 4096
  v_mfma_f32_16x16x32_bf16 a[76:79], a[0:3], a[156:159], a[76:79]
  buffer_load_dwordx4 v[160:163], v2, s[40:43], s13 offen offset:0 sc1
  v_mfma_f32_16x16x32_bf16 a[80:83], a[4:7], a[144:147], a[80:83]
  v_mfma_f32_16x16x32_bf16 a[84:87], a[4:7], a[148:151], a[84:87]
  v_mfma_f32_16x16x32_bf16 a[88:91], a[4:7], a[152:155], a[88:91]
  s_add_u32 s67, s67, 4096
  v_mfma_f32_16x16x32_bf16 a[92:95], a[4:7], a[156:159], a[92:95]
  buffer_load_dwordx4 v[164:167], v2, s[40:43], s13 offen offset:1024 sc1
  v_mfma_f32_16x16x32_bf16 a[96:99], a[8:11], a[144:147], a[96:99]
  v_mfma_f32_16x16x32_bf16 a[100:103], a[8:11], a[148:151], a[100:103]
  v_mfma_f32_16x16x32_bf16 a[104:107], a[8:11], a[152:155], a[104:107]
  v_mfma_f32_16x16x32_bf16 a[108:111], a[8:11], a[156:159], a[108:111]
  buffer_load_dwordx4 v[168:171], v2, s[40:43], s13 offen offset:2048 sc1
  v_mfma_f32_16x16x32_bf16 a[112:115], a[12:15], a[144:147], a[112:115]
  v_mfma_f32_16x16x32_bf16 a[116:119], a[12:15], a[148:151], a[116:119]
  v_mfma_f32_16x16x32_bf16 a[120:123], a[12:15], a[152:155], a[120:123]
  v_mfma_f32_16x16x32_bf16 a[124:127], a[12:15], a[156:159], a[124:127]
  v_mfma_f32_16x16x32_bf16 a[128:131], a[16:19], a[144:147], a[128:131]
  buffer_load_dwordx4 a[144:147], v2, s[40:43], s64 offen offset:0 sc1
  v_mfma_f32_16x16x32_bf16 a[132:135], a[16:19], a[148:151], a[132:135]
  buffer_load_dwordx4 a[148:151], v2, s[40:43], s65 offen offset:0 sc1
  v_mfma_f32_16x16x32_bf16 a[136:139], a[16:19], a[152:155], a[136:139]
  buffer_load_dwordx4 a[152:155], v2, s[40:43], s66 offen offset:0 sc1
  v_mfma_f32_16x16x32_bf16 a[140:143], a[16:19], a[156:159], a[140:143]
  buffer_load_dwordx4 a[156:159], v2, s[40:43], s67 offen offset:0 sc1
  s_waitcnt vmcnt(21)
  v_mfma_f32_16x16x32_bf16 a[64:67], a[20:23], a[160:163], a[64:67]
  v_mfma_f32_16x16x32_bf16 a[68:71], a[20:23], a[164:167], a[68:71]
  v_mfma_f32_16x16x32_bf16 a[72:75], a[20:23], a[168:171], a[72:75]
  v_mfma_f32_16x16x32_bf16 a[76:79], a[20:23], a[172:175], a[76:79]
  buffer_load_dwordx4 v[172:175], v2, s[40:43], s13 offen offset:3072 sc1
  v_mfma_f32_16x16x32_bf16 a[80:83], a[24:27], a[160:163], a[80:83]
  s_add_u32 s13, s13, 4096
  v_mfma_f32_16x16x32_bf16 a[84:87], a[24:27], a[164:167], a[84:87]
  v_mfma_f32_16x16x32_bf16 a[88:91], a[24:27], a[168:171], a[88:91]
  v_mfma_f32_16x16x32_bf16 a[92:95], a[24:27], a[172:175], a[92:95]
  buffer_load_dwordx4 v[192:195], v2, s[40:43], s13 offen offset:0 sc1
  v_mfma_f32_16x16x32_bf16 a[96:99], a[28:31], a[160:163], a[96:99]
  v_mfma_f32_16x16x32_bf16 a[100:103], a[28:31], a[164:167], a[100:103]
  v_mfma_f32_16x16x32_bf16 a[104:107], a[28:31], a[168:171], a[104:107]
  v_mfma_f32_16x16x32_bf16 a[108:111], a[28:31], a[172:175], a[108:111]
  buffer_load_dwordx4 v[196:199], v2, s[40:43], s13 offen offset:1024 sc1
  v_mfma_f32_16x16x32_bf16 a[112:115], a[32:35], a[160:163], a[112:115]
  v_mfma_f32_16x16x32_bf16 a[116:119], a[32:35], a[164:167], a[116:119]
  v_mfma_f32_16x16x32_bf16 a[120:123], a[32:35], a[168:171], a[120:123]
  v_mfma_f32_16x16x32_bf16 a[124:127], a[32:35], a[172:175], a[124:127]
  v_mfma_f32_16x16x32_bf16 a[128:131], a[36:39], a[160:163], a[128:131]
  buffer_load_dwordx4 a[160:163], v2, s[40:43], s64 offen offset:1024 sc1
  v_mfma_f32_16x16x32_bf16 a[132:135], a[36:39], a[164:167], a[132:135]
  buffer_load_dwordx4 a[164:167], v2, s[40:43], s65 offen offset:1024 sc1
  v_mfma_f32_16x16x32_bf16 a[136:139], a[36:39], a[168:171], a[136:139]
  buffer_load_dwordx4 a[168:171], v2, s[40:43], s66 offen offset:1024 sc1
  v_mfma_f32_16x16x32_bf16 a[140:143], a[36:39], a[172:175], a[140:143]
  buffer_load_dwordx4 a[172:175], v2, s[40:43], s67 offen offset:1024 sc1
  s_waitcnt vmcnt(21)
  v_mfma_f32_16x16x32_bf16 a[64:67], a[40:43], a[176:179], a[64:67]
  v_mfma_f32_16x16x32_bf16 a[68:71], a[40:43], a[180:183], a[68:71]
  v_mfma_f32_16x16x32_bf16 a[72:75], a[40:43], a[184:187], a[72:75]
  v_mfma_f32_16x16x32_bf16 a[76:79], a[40:43], a[188:191], a[76:79]
  buffer_load_dwordx4 v[208:211], v2, s[40:43], s13 offen offset:2048 sc1
  v_mfma_f32_16x16x32_bf16 a[80:83], a[44:47], a[176:179], a[80:83]
  v_mfma_f32_16x16x32_bf16 a[84:87], a[44:47], a[180:183], a[84:87]
  v_mfma_f32_16x16x32_bf16 a[88:91], a[44:47], a[184:187], a[88:91]
  v_mfma_f32_16x16x32_bf16 a[92:95], a[44:47], a[188:191], a[92:95]
  buffer_load_dwordx4 v[212:215], v2, s[40:43], s13 offen offset:3072 sc1
  v_mfma_f32_16x16x32_bf16 a[96:99], a[48:51], a[176:179], a[96:99]
  s_add_u32 s13, s13, 4096
  v_mfma_f32_16x16x32_bf16 a[100:103], a[48:51], a[180:183], a[100:103]
  v_mfma_f32_16x16x32_bf16 a[104:107], a[48:51], a[184:187], a[104:107]
  v_mfma_f32_16x16x32_bf16 a[108:111], a[48:51], a[188:191], a[108:111]
  buffer_load_dwordx4 v[232:235], v2, s[40:43], s13 offen offset:0 sc1
  v_mfma_f32_16x16x32_bf16 a[112:115], a[52:55], a[176:179], a[112:115]
  v_mfma_f32_16x16x32_bf16 a[116:119], a[52:55], a[180:183], a[116:119]
  v_mfma_f32_16x16x32_bf16 a[120:123], a[52:55], a[184:187], a[120:123]
  v_mfma_f32_16x16x32_bf16 a[124:127], a[52:55], a[188:191], a[124:127]
  v_mfma_f32_16x16x32_bf16 a[128:131], a[56:59], a[176:179], a[128:131]
  buffer_load_dwordx4 a[176:179], v2, s[40:43], s64 offen offset:2048 sc1
  v_mfma_f32_16x16x32_bf16 a[132:135], a[56:59], a[180:183], a[132:135]
  buffer_load_dwordx4 a[180:183], v2, s[40:43], s65 offen offset:2048 sc1
  v_mfma_f32_16x16x32_bf16 a[136:139], a[56:59], a[184:187], a[136:139]
  buffer_load_dwordx4 a[184:187], v2, s[40:43], s66 offen offset:2048 sc1
  v_mfma_f32_16x16x32_bf16 a[140:143], a[56:59], a[188:191], a[140:143]
  buffer_load_dwordx4 a[188:191], v2, s[40:43], s67 offen offset:2048 sc1
  s_waitcnt vmcnt(21)
  v_mfma_f32_16x16x32_bf16 a[64:67], a[60:63], v[216:219], a[64:67]
  v_mfma_f32_16x16x32_bf16 a[68:71], a[60:63], v[220:223], a[68:71]
  v_mfma_f32_16x16x32_bf16 a[72:75], a[60:63], v[224:227], a[72:75]
  v_mfma_f32_16x16x32_bf16 a[76:79], a[60:63], v[228:231], a[76:79]
  buffer_load_dwordx4 v[236:239], v2, s[40:43], s13 offen offset:1024 sc1
  v_mfma_f32_16x16x32_bf16 a[80:83], a[192:195], v[216:219], a[80:83]
  v_mfma_f32_16x16x32_bf16 a[84:87], a[192:195], v[220:223], a[84:87]
  v_mfma_f32_16x16x32_bf16 a[88:91], a[192:195], v[224:227], a[88:91]
  v_mfma_f32_16x16x32_bf16 a[92:95], a[192:195], v[228:231], a[92:95]
  buffer_load_dwordx4 v[240:243], v2, s[40:43], s13 offen offset:2048 sc1
  v_mfma_f32_16x16x32_bf16 a[96:99], a[196:199], v[216:219], a[96:99]
  v_mfma_f32_16x16x32_bf16 a[100:103], a[196:199], v[220:223], a[100:103]
  v_mfma_f32_16x16x32_bf16 a[104:107], a[196:199], v[224:227], a[104:107]
  v_mfma_f32_16x16x32_bf16 a[108:111], a[196:199], v[228:231], a[108:111]
  buffer_load_dwordx4 v[244:247], v2, s[40:43], s13 offen offset:3072 sc1
  v_mfma_f32_16x16x32_bf16 a[112:115], a[200:203], v[216:219], a[112:115]
  s_add_u32 s13, s13, 4096
  v_mfma_f32_16x16x32_bf16 a[116:119], a[200:203], v[220:223], a[116:119]
  v_mfma_f32_16x16x32_bf16 a[120:123], a[200:203], v[224:227], a[120:123]
  v_mfma_f32_16x16x32_bf16 a[124:127], a[200:203], v[228:231], a[124:127]
  v_mfma_f32_16x16x32_bf16 a[128:131], a[204:207], v[216:219], a[128:131]
  buffer_load_dwordx4 v[216:219], v2, s[40:43], s64 offen offset:3072 sc1
  v_mfma_f32_16x16x32_bf16 a[132:135], a[204:207], v[220:223], a[132:135]
  buffer_load_dwordx4 v[220:223], v2, s[40:43], s65 offen offset:3072 sc1
  v_mfma_f32_16x16x32_bf16 a[136:139], a[204:207], v[224:227], a[136:139]
  buffer_load_dwordx4 v[224:227], v2, s[40:43], s66 offen offset:3072 sc1
  v_mfma_f32_16x16x32_bf16 a[140:143], a[204:207], v[228:231], a[140:143]
  buffer_load_dwordx4 v[228:231], v2, s[40:43], s67 offen offset:3072 sc1
  s_waitcnt vmcnt(21)
  v_mfma_f32_16x16x32_bf16 a[64:67], a[208:211], a[144:147], a[64:67]
  s_add_u32 s64, s64, 4096
  v_mfma_f32_16x16x32_bf16 a[68:71], a[208:211], a[148:151], a[68:71]
  s_add_u32 s65, s65, 4096
  v_mfma_f32_16x16x32_bf16 a[72:75], a[208:211], a[152:155], a[72:75]
  s_add_u32 s66, s66, 4096
  v_mfma_f32_16x16x32_bf16 a[76:79], a[208:211], a[156:159], a[76:79]
  buffer_load_dwordx4 v[64:67], v2, s[40:43], s13 offen offset:0 sc1
  v_mfma_f32_16x16x32_bf16 a[80:83], a[212:215], a[144:147], a[80:83]
  v_mfma_f32_16x16x32_bf16 a[84:87], a[212:215], a[148:151], a[84:87]
  v_mfma_f32_16x16x32_bf16 a[88:91], a[212:215], a[152:155], a[88:91]
  s_add_u32 s67, s67, 4096
  v_mfma_f32_16x16x32_bf16 a[92:95], a[212:215], a[156:159], a[92:95]
  buffer_load_dwordx4 v[68:71], v2, s[40:43], s13 offen offset:1024 sc1
  v_mfma_f32_16x16x32_bf16 a[96:99], a[216:219], a[144:147], a[96:99]
  v_mfma_f32_16x16x32_bf16 a[100:103], a[216:219], a[148:151], a[100:103]
  v_mfma_f32_16x16x32_bf16 a[104:107], a[216:219], a[152:155], a[104:107]
  v_mfma_f32_16x16x32_bf16 a[108:111], a[216:219], a[156:159], a[108:111]
  buffer_load_dwordx4 v[72:75], v2, s[40:43], s13 offen offset:2048 sc1
  v_mfma_f32_16x16x32_bf16 a[112:115], a[220:223], a[144:147], a[112:115]
  v_mfma_f32_16x16x32_bf16 a[116:119], a[220:223], a[148:151], a[116:119]
  v_mfma_f32_16x16x32_bf16 a[120:123], a[220:223], a[152:155], a[120:123]
  v_mfma_f32_16x16x32_bf16 a[124:127], a[220:223], a[156:159], a[124:127]
  v_mfma_f32_16x16x32_bf16 a[128:131], a[224:227], a[144:147], a[128:131]
  buffer_load_dwordx4 a[144:147], v2, s[40:43], s64 offen offset:0 sc1
  v_mfma_f32_16x16x32_bf16 a[132:135], a[224:227], a[148:151], a[132:135]
  buffer_load_dwordx4 a[148:151], v2, s[40:43], s65 offen offset:0 sc1
  v_mfma_f32_16x16x32_bf16 a[136:139], a[224:227], a[152:155], a[136:139]
  buffer_load_dwordx4 a[152:155], v2, s[40:43], s66 offen offset:0 sc1
  v_mfma_f32_16x16x32_bf16 a[140:143], a[224:227], a[156:159], a[140:143]
  buffer_load_dwordx4 a[156:159], v2, s[40:43], s67 offen offset:0 sc1
  s_waitcnt vmcnt(21)
  v_mfma_f32_16x16x32_bf16 a[64:67], a[228:231], a[160:163], a[64:67]
  v_mfma_f32_16x16x32_bf16 a[68:71], a[228:231], a[164:167], a[68:71]
  v_mfma_f32_16x16x32_bf16 a[72:75], a[228:231], a[168:171], a[72:75]
  v_mfma_f32_16x16x32_bf16 a[76:79], a[228:231], a[172:175], a[76:79]
  buffer_load_dwordx4 v[76:79], v2, s[40:43], s13 offen offset:3072 sc1
  v_mfma_f32_16x16x32_bf16 a[80:83], a[232:235], a[160:163], a[80:83]
  s_add_u32 s13, s13, 4096
  v_mfma_f32_16x16x32_bf16 a[84:87], a[232:235], a[164:167], a[84:87]
  v_mfma_f32_16x16x32_bf16 a[88:91], a[232:235], a[168:171], a[88:91]
  v_mfma_f32_16x16x32_bf16 a[92:95], a[232:235], a[172:175], a[92:95]
  buffer_load_dwordx4 v[80:83], v2, s[40:43], s13 offen offset:0 sc1
  v_mfma_f32_16x16x32_bf16 a[96:99], a[236:239], a[160:163], a[96:99]
  v_mfma_f32_16x16x32_bf16 a[100:103], a[236:239], a[164:167], a[100:103]
  v_mfma_f32_16x16x32_bf16 a[104:107], a[236:239], a[168:171], a[104:107]
  v_mfma_f32_16x16x32_bf16 a[108:111], a[236:239], a[172:175], a[108:111]
  buffer_load_dwordx4 v[84:87], v2, s[40:43], s13 offen offset:1024 sc1
  v_mfma_f32_16x16x32_bf16 a[112:115], a[240:243], a[160:163], a[112:115]
  v_mfma_f32_16x16x32_bf16 a[116:119], a[240:243], a[164:167], a[116:119]
  v_mfma_f32_16x16x32_bf16 a[120:123], a[240:243], a[168:171], a[120:123]
  v_mfma_f32_16x16x32_bf16 a[124:127], a[240:243], a[172:175], a[124:127]
  v_mfma_f32_16x16x32_bf16 a[128:131], a[244:247], a[160:163], a[128:131]
  buffer_load_dwordx4 a[160:163], v2, s[40:43], s64 offen offset:1024 sc1
  v_mfma_f32_16x16x32_bf16 a[132:135], a[244:247], a[164:167], a[132:135]
  buffer_load_dwordx4 a[164:167], v2, s[40:43], s65 offen offset:1024 sc1
  v_mfma_f32_16x16x32_bf16 a[136:139], a[244:247], a[168:171], a[136:139]
  buffer_load_dwordx4 a[168:171], v2, s[40:43], s66 offen offset:1024 sc1
  v_mfma_f32_16x16x32_bf16 a[140:143], a[244:247], a[172:175], a[140:143]
  buffer_load_dwordx4 a[172:175], v2, s[40:43], s67 offen offset:1024 sc1
  s_waitcnt vmcnt(21)
  v_mfma_f32_16x16x32_bf16 a[64:67], a[248:251], a[176:179], a[64:67]
  v_mfma_f32_16x16x32_bf16 a[68:71], a[248:251], a[180:183], a[68:71]
  v_mfma_f32_16x16x32_bf16 a[72:75], a[248:251], a[184:187], a[72:75]
  v_mfma_f32_16x16x32_bf16 a[76:79], a[248:251], a[188:191], a[76:79]
  buffer_load_dwordx4 v[88:91], v2, s[40:43], s13 offen offset:2048 sc1
  v_mfma_f32_16x16x32_bf16 a[80:83], a[252:255], a[176:179], a[80:83]
  v_mfma_f32_16x16x32_bf16 a[84:87], a[252:255], a[180:183], a[84:87]
  v_mfma_f32_16x16x32_bf16 a[88:91], a[252:255], a[184:187], a[88:91]
  v_mfma_f32_16x16x32_bf16 a[92:95], a[252:255], a[188:191], a[92:95]
  buffer_load_dwordx4 v[92:95], v2, s[40:43], s13 offen offset:3072 sc1
  v_mfma_f32_16x16x32_bf16 a[96:99], v[32:35], a[176:179], a[96:99]
  s_add_u32 s13, s13, 4096
  v_mfma_f32_16x16x32_bf16 a[100:103], v[32:35], a[180:183], a[100:103]
  v_mfma_f32_16x16x32_bf16 a[104:107], v[32:35], a[184:187], a[104:107]
  v_mfma_f32_16x16x32_bf16 a[108:111], v[32:35], a[188:191], a[108:111]
  buffer_load_dwordx4 v[128:131], v2, s[40:43], s13 offen offset:0 sc1
  v_mfma_f32_16x16x32_bf16 a[112:115], v[36:39], a[176:179], a[112:115]
  v_mfma_f32_16x16x32_bf16 a[116:119], v[36:39], a[180:183], a[116:119]
  v_mfma_f32_16x16x32_bf16 a[120:123], v[36:39], a[184:187], a[120:123]
  v_mfma_f32_16x16x32_bf16 a[124:127], v[36:39], a[188:191], a[124:127]
  v_mfma_f32_16x16x32_bf16 a[128:131], v[40:43], a[176:179], a[128:131]
  buffer_load_dwordx4 a[176:179], v2, s[40:43], s64 offen offset:2048 sc1
  v_mfma_f32_16x16x32_bf16 a[132:135], v[40:43], a[180:183], a[132:135]
  buffer_load_dwordx4 a[180:183], v2, s[40:43], s65 offen offset:2048 sc1
  v_mfma_f32_16x16x32_bf16 a[136:139], v[40:43], a[184:187], a[136:139]
  buffer_load_dwordx4 a[184:187], v2, s[40:43], s66 offen offset:2048 sc1
  v_mfma_f32_16x16x32_bf16 a[140:143], v[40:43], a[188:191], a[140:143]
  buffer_load_dwordx4 a[188:191], v2, s[40:43], s67 offen offset:2048 sc1
  s_waitcnt vmcnt(21)
  v_mfma_f32_16x16x32_bf16 a[64:67], v[44:47], v[216:219], a[64:67]
  v_mfma_f32_16x16x32_bf16 a[68:71], v[44:47], v[220:223], a[68:71]
  v_mfma_f32_16x16x32_bf16 a[72:75], v[44:47], v[224:227], a[72:75]
  v_mfma_f32_16x16x32_bf16 a[76:79], v[44:47], v[228:231], a[76:79]
  buffer_load_dwordx4 v[132:135], v2, s[40:43], s13 offen offset:1024 sc1
  v_mfma_f32_16x16x32_bf16 a[80:83], v[48:51], v[216:219], a[80:83]
  v_mfma_f32_16x16x32_bf16 a[84:87], v[48:51], v[220:223], a[84:87]
  v_mfma_f32_16x16x32_bf16 a[88:91], v[48:51], v[224:227], a[88:91]
  v_mfma_f32_16x16x32_bf16 a[92:95], v[48:51], v[228:231], a[92:95]
  buffer_load_dwordx4 v[136:139], v2, s[40:43], s13 offen offset:2048 sc1
  v_mfma_f32_16x16x32_bf16 a[96:99], v[52:55], v[216:219], a[96:99]
  v_mfma_f32_16x16x32_bf16 a[100:103], v[52:55], v[220:223], a[100:103]
  v_mfma_f32_16x16x32_bf16 a[104:107], v[52:55], v[224:227], a[104:107]
  v_mfma_f32_16x16x32_bf16 a[108:111], v[52:55], v[228:231], a[108:111]
  buffer_load_dwordx4 v[140:143], v2, s[40:43], s13 offen offset:3072 sc1
  v_mfma_f32_16x16x32_bf16 a[112:115], v[56:59], v[216:219], a[112:115]
  s_add_u32 s13, s13, 4096
  v_mfma_f32_16x16x32_bf16 a[116:119], v[56:59], v[220:223], a[116:119]
  v_mfma_f32_16x16x32_bf16 a[120:123], v[56:59], v[224:227], a[120:123]
  v_mfma_f32_16x16x32_bf16 a[124:127], v[56:59], v[228:231], a[124:127]
  v_mfma_f32_16x16x32_bf16 a[128:131], v[60:63], v[216:219], a[128:131]
  buffer_load_dwordx4 v[216:219], v2, s[40:43], s64 offen offset:3072 sc1
  v_mfma_f32_16x16x32_bf16 a[132:135], v[60:63], v[220:223], a[132:135]
  buffer_load_dwordx4 v[220:223], v2, s[40:43], s65 offen offset:3072 sc1
  v_mfma_f32_16x16x32_bf16 a[136:139], v[60:63], v[224:227], a[136:139]
  buffer_load_dwordx4 v[224:227], v2, s[40:43], s66 offen offset:3072 sc1
  v_mfma_f32_16x16x32_bf16 a[140:143], v[60:63], v[228:231], a[140:143]
  buffer_load_dwordx4 v[228:231], v2, s[40:43], s67 offen offset:3072 sc1
  s_waitcnt vmcnt(21)
  v_mfma_f32_16x16x32_bf16 a[64:67], v[96:99], a[144:147], a[64:67]
  s_add_u32 s64, s64, 4096
  v_mfma_f32_16x16x32_bf16 a[68:71], v[96:99], a[148:151], a[68:71]
  s_add_u32 s65, s65, 4096
  v_mfma_f32_16x16x32_bf16 a[72:75], v[96:99], a[152:155], a[72:75]
  s_add_u32 s66, s66, 4096
  v_mfma_f32_16x16x32_bf16 a[76:79], v[96:99], a[156:159], a[76:79]
  buffer_load_dwordx4 v[144:147], v2, s[40:43], s13 offen offset:0 sc1
  v_mfma_f32_16x16x32_bf16 a[80:83], v[100:103], a[144:147], a[80:83]
  v_mfma_f32_16x16x32_bf16 a[84:87], v[100:103], a[148:151], a[84:87]
  v_mfma_f32_16x16x32_bf16 a[88:91], v[100:103], a[152:155], a[88:91]
  s_add_u32 s67, s67, 4096
  v_mfma_f32_16x16x32_bf16 a[92:95], v[100:103], a[156:159], a[92:95]
  buffer_load_dwordx4 v[148:151], v2, s[40:43], s13 offen offset:1024 sc1
  v_mfma_f32_16x16x32_bf16 a[96:99], v[104:107], a[144:147], a[96:99]
  v_mfma_f32_16x16x32_bf16 a[100:103], v[104:107], a[148:151], a[100:103]
  v_mfma_f32_16x16x32_bf16 a[104:107], v[104:107], a[152:155], a[104:107]
  v_mfma_f32_16x16x32_bf16 a[108:111], v[104:107], a[156:159], a[108:111]
  buffer_load_dwordx4 v[152:155], v2, s[40:43], s13 offen offset:2048 sc1
  v_mfma_f32_16x16x32_bf16 a[112:115], v[108:111], a[144:147], a[112:115]
  v_mfma_f32_16x16x32_bf16 a[116:119], v[108:111], a[148:151], a[116:119]
  v_mfma_f32_16x16x32_bf16 a[120:123], v[108:111], a[152:155], a[120:123]
  v_mfma_f32_16x16x32_bf16 a[124:127], v[108:111], a[156:159], a[124:127]
  v_mfma_f32_16x16x32_bf16 a[128:131], v[112:115], a[144:147], a[128:131]
  buffer_load_dwordx4 a[144:147], v2, s[40:43], s64 offen offset:0 sc1
  v_mfma_f32_16x16x32_bf16 a[132:135], v[112:115], a[148:151], a[132:135]
  buffer_load_dwordx4 a[148:151], v2, s[40:43], s65 offen offset:0 sc1
  v_mfma_f32_16x16x32_bf16 a[136:139], v[112:115], a[152:155], a[136:139]
  buffer_load_dwordx4 a[152:155], v2, s[40:43], s66 offen offset:0 sc1
  v_mfma_f32_16x16x32_bf16 a[140:143], v[112:115], a[156:159], a[140:143]
  buffer_load_dwordx4 a[156:159], v2, s[40:43], s67 offen offset:0 sc1
  s_waitcnt vmcnt(21)
  v_mfma_f32_16x16x32_bf16 a[64:67], v[116:119], a[160:163], a[64:67]
  v_mfma_f32_16x16x32_bf16 a[68:71], v[116:119], a[164:167], a[68:71]
  v_mfma_f32_16x16x32_bf16 a[72:75], v[116:119], a[168:171], a[72:75]
  v_mfma_f32_16x16x32_bf16 a[76:79], v[116:119], a[172:175], a[76:79]
  buffer_load_dwordx4 v[156:159], v2, s[40:43], s13 offen offset:3072 sc1
  v_mfma_f32_16x16x32_bf16 a[80:83], v[120:123], a[160:163], a[80:83]
  s_add_u32 s13, s13, 4096
  v_mfma_f32_16x16x32_bf16 a[84:87], v[120:123], a[164:167], a[84:87]
  v_mfma_f32_16x16x32_bf16 a[88:91], v[120:123], a[168:171], a[88:91]
  v_mfma_f32_16x16x32_bf16 a[92:95], v[120:123], a[172:175], a[92:95]
  buffer_load_dwordx4 v[176:179], v2, s[40:43], s13 offen offset:0 sc1
  v_mfma_f32_16x16x32_bf16 a[96:99], v[124:127], a[160:163], a[96:99]
  v_mfma_f32_16x16x32_bf16 a[100:103], v[124:127], a[164:167], a[100:103]
  v_mfma_f32_16x16x32_bf16 a[104:107], v[124:127], a[168:171], a[104:107]
  v_mfma_f32_16x16x32_bf16 a[108:111], v[124:127], a[172:175], a[108:111]
  buffer_load_dwordx4 v[180:183], v2, s[40:43], s13 offen offset:1024 sc1
  v_mfma_f32_16x16x32_bf16 a[112:115], v[160:163], a[160:163], a[112:115]
  v_mfma_f32_16x16x32_bf16 a[116:119], v[160:163], a[164:167], a[116:119]
  v_mfma_f32_16x16x32_bf16 a[120:123], v[160:163], a[168:171], a[120:123]
  v_mfma_f32_16x16x32_bf16 a[124:127], v[160:163], a[172:175], a[124:127]
  v_mfma_f32_16x16x32_bf16 a[128:131], v[164:167], a[160:163], a[128:131]
  buffer_load_dwordx4 a[160:163], v2, s[40:43], s64 offen offset:1024 sc1
  v_mfma_f32_16x16x32_bf16 a[132:135], v[164:167], a[164:167], a[132:135]
  buffer_load_dwordx4 a[164:167], v2, s[40:43], s65 offen offset:1024 sc1
  v_mfma_f32_16x16x32_bf16 a[136:139], v[164:167], a[168:171], a[136:139]
  buffer_load_dwordx4 a[168:171], v2, s[40:43], s66 offen offset:1024 sc1
  v_mfma_f32_16x16x32_bf16 a[140:143], v[164:167], a[172:175], a[140:143]
  buffer_load_dwordx4 a[172:175], v2, s[40:43], s67 offen offset:1024 sc1
  s_waitcnt vmcnt(21)
  v_mfma_f32_16x16x32_bf16 a[64:67], v[168:171], a[176:179], a[64:67]
  v_mfma_f32_16x16x32_bf16 a[68:71], v[168:171], a[180:183], a[68:71]
  v_mfma_f32_16x16x32_bf16 a[72:75], v[168:171], a[184:187], a[72:75]
  v_mfma_f32_16x16x32_bf16 a[76:79], v[168:171], a[188:191], a[76:79]
  buffer_load_dwordx4 v[184:187], v2, s[40:43], s13 offen offset:2048 sc1
  v_mfma_f32_16x16x32_bf16 a[80:83], v[172:175], a[176:179], a[80:83]
  v_mfma_f32_16x16x32_bf16 a[84:87], v[172:175], a[180:183], a[84:87]
  v_mfma_f32_16x16x32_bf16 a[88:91], v[172:175], a[184:187], a[88:91]
  v_mfma_f32_16x16x32_bf16 a[92:95], v[172:175], a[188:191], a[92:95]
  buffer_load_dwordx4 v[188:191], v2, s[40:43], s13 offen offset:3072 sc1
  v_mfma_f32_16x16x32_bf16 a[96:99], v[192:195], a[176:179], a[96:99]
  s_add_u32 s13, s13, 4096
  v_mfma_f32_16x16x32_bf16 a[100:103], v[192:195], a[180:183], a[100:103]
  v_mfma_f32_16x16x32_bf16 a[104:107], v[192:195], a[184:187], a[104:107]
  v_mfma_f32_16x16x32_bf16 a[108:111], v[192:195], a[188:191], a[108:111]
  v_mfma_f32_16x16x32_bf16 a[112:115], v[196:199], a[176:179], a[112:115]
  v_mfma_f32_16x16x32_bf16 a[116:119], v[196:199], a[180:183], a[116:119]
  v_mfma_f32_16x16x32_bf16 a[120:123], v[196:199], a[184:187], a[120:123]
  v_mfma_f32_16x16x32_bf16 a[124:127], v[196:199], a[188:191], a[124:127]
  v_mfma_f32_16x16x32_bf16 a[128:131], v[208:211], a[176:179], a[128:131]
  buffer_load_dwordx4 a[176:179], v2, s[40:43], s64 offen offset:2048 sc1
  v_mfma_f32_16x16x32_bf16 a[132:135], v[208:211], a[180:183], a[132:135]
  buffer_load_dwordx4 a[180:183], v2, s[40:43], s65 offen offset:2048 sc1
  v_mfma_f32_16x16x32_bf16 a[136:139], v[208:211], a[184:187], a[136:139]
  buffer_load_dwordx4 a[184:187], v2, s[40:43], s66 offen offset:2048 sc1
  v_mfma_f32_16x16x32_bf16 a[140:143], v[208:211], a[188:191], a[140:143]
  buffer_load_dwordx4 a[188:191], v2, s[40:43], s67 offen offset:2048 sc1
  s_waitcnt vmcnt(20)
  v_mfma_f32_16x16x32_bf16 a[64:67], v[212:215], v[216:219], a[64:67]
  v_mfma_f32_16x16x32_bf16 a[68:71], v[212:215], v[220:223], a[68:71]
  v_mfma_f32_16x16x32_bf16 a[72:75], v[212:215], v[224:227], a[72:75]
  v_mfma_f32_16x16x32_bf16 a[76:79], v[212:215], v[228:231], a[76:79]
  v_mfma_f32_16x16x32_bf16 a[80:83], v[232:235], v[216:219], a[80:83]
  v_mfma_f32_16x16x32_bf16 a[84:87], v[232:235], v[220:223], a[84:87]
  v_mfma_f32_16x16x32_bf16 a[88:91], v[232:235], v[224:227], a[88:91]
  v_mfma_f32_16x16x32_bf16 a[92:95], v[232:235], v[228:231], a[92:95]
  v_mfma_f32_16x16x32_bf16 a[96:99], v[236:239], v[216:219], a[96:99]
  v_mfma_f32_16x16x32_bf16 a[100:103], v[236:239], v[220:223], a[100:103]
  v_mfma_f32_16x16x32_bf16 a[104:107], v[236:239], v[224:227], a[104:107]
  v_mfma_f32_16x16x32_bf16 a[108:111], v[236:239], v[228:231], a[108:111]
  v_mfma_f32_16x16x32_bf16 a[112:115], v[240:243], v[216:219], a[112:115]
  v_mfma_f32_16x16x32_bf16 a[116:119], v[240:243], v[220:223], a[116:119]
  v_mfma_f32_16x16x32_bf16 a[120:123], v[240:243], v[224:227], a[120:123]
  v_mfma_f32_16x16x32_bf16 a[124:127], v[240:243], v[228:231], a[124:127]
  v_mfma_f32_16x16x32_bf16 a[128:131], v[244:247], v[216:219], a[128:131]
  buffer_load_dwordx4 v[216:219], v2, s[40:43], s64 offen offset:3072 sc1
  v_mfma_f32_16x16x32_bf16 a[132:135], v[244:247], v[220:223], a[132:135]
  buffer_load_dwordx4 v[220:223], v2, s[40:43], s65 offen offset:3072 sc1
  v_mfma_f32_16x16x32_bf16 a[136:139], v[244:247], v[224:227], a[136:139]
  buffer_load_dwordx4 v[224:227], v2, s[40:43], s66 offen offset:3072 sc1
  v_mfma_f32_16x16x32_bf16 a[140:143], v[244:247], v[228:231], a[140:143]
  buffer_load_dwordx4 v[228:231], v2, s[40:43], s67 offen offset:3072 sc1
  s_waitcnt vmcnt(17)
  v_mfma_f32_16x16x32_bf16 a[64:67], v[64:67], a[144:147], a[64:67]
  v_mfma_f32_16x16x32_bf16 a[68:71], v[64:67], a[148:151], a[68:71]
  v_mfma_f32_16x16x32_bf16 a[72:75], v[64:67], a[152:155], a[72:75]
  v_mfma_f32_16x16x32_bf16 a[76:79], v[64:67], a[156:159], a[76:79]
  buffer_load_dwordx4 v[160:163], v248, s[44:47], 0 offen
  v_mfma_f32_16x16x32_bf16 a[80:83], v[68:71], a[144:147], a[80:83]
  v_mfma_f32_16x16x32_bf16 a[84:87], v[68:71], a[148:151], a[84:87]
  buffer_load_dwordx4 v[172:175], v200, s[40:43], s27 offen sc1
  v_mfma_f32_16x16x32_bf16 a[88:91], v[68:71], a[152:155], a[88:91]
  v_mfma_f32_16x16x32_bf16 a[92:95], v[68:71], a[156:159], a[92:95]
  buffer_load_dwordx4 v[164:167], v249, s[44:47], 0 offen
  v_mfma_f32_16x16x32_bf16 a[96:99], v[72:75], a[144:147], a[96:99]
  v_mfma_f32_16x16x32_bf16 a[100:103], v[72:75], a[148:151], a[100:103]
  buffer_load_dwordx4 v[192:195], v201, s[40:43], s27 offen sc1
  v_mfma_f32_16x16x32_bf16 a[104:107], v[72:75], a[152:155], a[104:107]
  v_mfma_f32_16x16x32_bf16 a[108:111], v[72:75], a[156:159], a[108:111]
  buffer_load_dwordx4 v[168:171], v250, s[44:47], 0 offen
  v_mfma_f32_16x16x32_bf16 a[112:115], v[76:79], a[144:147], a[112:115]
  v_mfma_f32_16x16x32_bf16 a[116:119], v[76:79], a[148:151], a[116:119]
  buffer_load_dwordx4 v[196:199], v202, s[40:43], s27 offen sc1
  v_mfma_f32_16x16x32_bf16 a[120:123], v[76:79], a[152:155], a[120:123]
  v_mfma_f32_16x16x32_bf16 a[124:127], v[76:79], a[156:159], a[124:127]
  v_mfma_f32_16x16x32_bf16 a[128:131], v[80:83], a[144:147], a[128:131]
  v_mfma_f32_16x16x32_bf16 a[132:135], v[80:83], a[148:151], a[132:135]
  v_mfma_f32_16x16x32_bf16 a[136:139], v[80:83], a[152:155], a[136:139]
  v_mfma_f32_16x16x32_bf16 a[140:143], v[80:83], a[156:159], a[140:143]
  s_waitcnt vmcnt(16)
  v_mfma_f32_16x16x32_bf16 a[64:67], v[84:87], a[160:163], a[64:67]
  v_mfma_f32_16x16x32_bf16 a[68:71], v[84:87], a[164:167], a[68:71]
  v_mfma_f32_16x16x32_bf16 a[72:75], v[84:87], a[168:171], a[72:75]
  v_mfma_f32_16x16x32_bf16 a[76:79], v[84:87], a[172:175], a[76:79]
  v_mfma_f32_16x16x32_bf16 a[80:83], v[88:91], a[160:163], a[80:83]
  v_mfma_f32_16x16x32_bf16 a[84:87], v[88:91], a[164:167], a[84:87]
  v_mfma_f32_16x16x32_bf16 a[88:91], v[88:91], a[168:171], a[88:91]
  v_mfma_f32_16x16x32_bf16 a[92:95], v[88:91], a[172:175], a[92:95]
  v_mfma_f32_16x16x32_bf16 a[96:99], v[92:95], a[160:163], a[96:99]
  v_mfma_f32_16x16x32_bf16 a[100:103], v[92:95], a[164:167], a[100:103]
  v_mfma_f32_16x16x32_bf16 a[104:107], v[92:95], a[168:171], a[104:107]
  v_mfma_f32_16x16x32_bf16 a[108:111], v[92:95], a[172:175], a[108:111]
  v_mfma_f32_16x16x32_bf16 a[112:115], v[128:131], a[160:163], a[112:115]
  v_mfma_f32_16x16x32_bf16 a[116:119], v[128:131], a[164:167], a[116:119]
  v_mfma_f32_16x16x32_bf16 a[120:123], v[128:131], a[168:171], a[120:123]
  v_mfma_f32_16x16x32_bf16 a[124:127], v[128:131], a[172:175], a[124:127]
  v_mfma_f32_16x16x32_bf16 a[128:131], v[132:135], a[160:163], a[128:131]
  v_mfma_f32_16x16x32_bf16 a[132:135], v[132:135], a[164:167], a[132:135]
  v_mfma_f32_16x16x32_bf16 a[136:139], v[132:135], a[168:171], a[136:139]
  v_mfma_f32_16x16x32_bf16 a[140:143], v[132:135], a[172:175], a[140:143]
  s_waitcnt vmcnt(10)
  v_mfma_f32_16x16x32_bf16 a[64:67], v[136:139], a[176:179], a[64:67]
  v_mfma_f32_16x16x32_bf16 a[68:71], v[136:139], a[180:183], a[68:71]
  v_mfma_f32_16x16x32_bf16 a[72:75], v[136:139], a[184:187], a[72:75]
  v_mfma_f32_16x16x32_bf16 a[76:79], v[136:139], a[188:191], a[76:79]
  v_mfma_f32_16x16x32_bf16 a[80:83], v[140:143], a[176:179], a[80:83]
  v_mfma_f32_16x16x32_bf16 a[84:87], v[140:143], a[180:183], a[84:87]
  v_mfma_f32_16x16x32_bf16 a[88:91], v[140:143], a[184:187], a[88:91]
  v_mfma_f32_16x16x32_bf16 a[92:95], v[140:143], a[188:191], a[92:95]
  v_mfma_f32_16x16x32_bf16 a[96:99], v[144:147], a[176:179], a[96:99]
  v_mfma_f32_16x16x32_bf16 a[100:103], v[144:147], a[180:183], a[100:103]
  v_mfma_f32_16x16x32_bf16 a[104:107], v[144:147], a[184:187], a[104:107]
  v_mfma_f32_16x16x32_bf16 a[108:111], v[144:147], a[188:191], a[108:111]
  v_mfma_f32_16x16x32_bf16 a[112:115], v[148:151], a[176:179], a[112:115]
  v_mfma_f32_16x16x32_bf16 a[116:119], v[148:151], a[180:183], a[116:119]
  v_mfma_f32_16x16x32_bf16 a[120:123], v[148:151], a[184:187], a[120:123]
  v_mfma_f32_16x16x32_bf16 a[124:127], v[148:151], a[188:191], a[124:127]
  v_mfma_f32_16x16x32_bf16 a[128:131], v[152:155], a[176:179], a[128:131]
  v_mfma_f32_16x16x32_bf16 a[132:135], v[152:155], a[180:183], a[132:135]
  v_mfma_f32_16x16x32_bf16 a[136:139], v[152:155], a[184:187], a[136:139]
  v_mfma_f32_16x16x32_bf16 a[140:143], v[152:155], a[188:191], a[140:143]
  s_waitcnt vmcnt(6)
  v_mfma_f32_16x16x32_bf16 a[64:67], v[156:159], v[216:219], a[64:67]
  v_mfma_f32_16x16x32_bf16 a[68:71], v[156:159], v[220:223], a[68:71]
  v_mfma_f32_16x16x32_bf16 a[72:75], v[156:159], v[224:227], a[72:75]
  v_mfma_f32_16x16x32_bf16 a[76:79], v[156:159], v[228:231], a[76:79]
  v_mfma_f32_16x16x32_bf16 a[80:83], v[176:179], v[216:219], a[80:83]
  v_mfma_f32_16x16x32_bf16 a[84:87], v[176:179], v[220:223], a[84:87]
  v_mfma_f32_16x16x32_bf16 a[88:91], v[176:179], v[224:227], a[88:91]
  v_mfma_f32_16x16x32_bf16 a[92:95], v[176:179], v[228:231], a[92:95]
  v_mfma_f32_16x16x32_bf16 a[96:99], v[180:183], v[216:219], a[96:99]
  v_mfma_f32_16x16x32_bf16 a[100:103], v[180:183], v[220:223], a[100:103]
  v_mfma_f32_16x16x32_bf16 a[104:107], v[180:183], v[224:227], a[104:107]
  v_mfma_f32_16x16x32_bf16 a[108:111], v[180:183], v[228:231], a[108:111]
  v_mfma_f32_16x16x32_bf16 a[112:115], v[184:187], v[216:219], a[112:115]
  v_mfma_f32_16x16x32_bf16 a[116:119], v[184:187], v[220:223], a[116:119]
  v_mfma_f32_16x16x32_bf16 a[120:123], v[184:187], v[224:227], a[120:123]
  v_mfma_f32_16x16x32_bf16 a[124:127], v[184:187], v[228:231], a[124:127]
  v_mfma_f32_16x16x32_bf16 a[128:131], v[188:191], v[216:219], a[128:131]
  v_mfma_f32_16x16x32_bf16 a[132:135], v[188:191], v[220:223], a[132:135]
  v_mfma_f32_16x16x32_bf16 a[136:139], v[188:191], v[224:227], a[136:139]
  v_mfma_f32_16x16x32_bf16 a[140:143], v[188:191], v[228:231], a[140:143]
  v_and_b32 v16, 15, v1
  v_mul_u32_u24 v16, 336, v16
  v_lshrrev_b32 v17, 4, v1
  v_lshl_add_u32 v16, v17, 4, v16
  s_mul_i32 s23, s20, 21504
  v_add_u32 v16, s23, v16
  s_barrier
  ds_write_b128 v16, a[64:67] offset:0
  ds_write_b128 v16, a[68:71] offset:5376
  ds_write_b128 v16, a[72:75] offset:10752
  ds_write_b128 v16, a[76:79] offset:16128
  ds_write_b128 v16, a[80:83] offset:64
  ds_write_b128 v16, a[84:87] offset:5440
  ds_write_b128 v16, a[88:91] offset:10816
  ds_write_b128 v16, a[92:95] offset:16192
  ds_write_b128 v16, a[96:99] offset:128
  ds_write_b128 v16, a[100:103] offset:5504
  ds_write_b128 v16, a[104:107] offset:10880
  ds_write_b128 v16, a[108:111] offset:16256
  ds_write_b128 v16, a[112:115] offset:192
  ds_write_b128 v16, a[116:119] offset:5568
  ds_write_b128 v16, a[120:123] offset:10944
  ds_write_b128 v16, a[124:127] offset:16320
  ds_write_b128 v16, a[128:131] offset:256
  ds_write_b128 v16, a[132:135] offset:5632
  ds_write_b128 v16, a[136:139] offset:11008
  ds_write_b128 v16, a[140:143] offset:16384
  s_waitcnt vmcnt(0) lgkmcnt(0)
  s_barrier
  ds_read_b128 v[32:35], v251 offset:0
  ds_read_b128 v[36:39], v251 offset:16
  ds_read_b128 v[40:43], v251 offset:21504
  ds_read_b128 v[44:47], v251 offset:21520
  ds_read_b128 v[48:51], v251 offset:43008
  ds_read_b128 v[52:55], v251 offset:43024
  ds_read_b128 v[56:59], v251 offset:64512
  ds_read_b128 v[60:63], v251 offset:64528
  ds_read_b128 v[64:67], v203 offset:0
  ds_read_b128 v[68:71], v203 offset:16
  ds_read_b128 v[72:75], v252 offset:0
  ds_read_b128 v[76:79], v252 offset:16
  ds_read_b128 v[80:83], v252 offset:21504
  ds_read_b128 v[84:87], v252 offset:21520
  ds_read_b128 v[88:91], v252 offset:43008
  ds_read_b128 v[92:95], v252 offset:43024
  ds_read_b128 v[96:99], v252 offset:64512
  ds_read_b128 v[100:103], v252 offset:64528
  ds_read_b128 v[104:107], v204 offset:0
  ds_read_b128 v[108:111], v204 offset:16
  ds_read_b128 v[112:115], v253 offset:0
  ds_read_b128 v[116:119], v253 offset:16
  ds_read_b128 v[120:123], v253 offset:21504
  ds_read_b128 v[124:127], v253 offset:21520
  ds_read_b128 v[128:131], v253 offset:43008
  ds_read_b128 v[132:135], v253 offset:43024
  ds_read_b128 v[136:139], v253 offset:64512
  ds_read_b128 v[140:143], v253 offset:64528
  ds_read_b128 v[144:147], v205 offset:0
  ds_read_b128 v[148:151], v205 offset:16
  s_waitcnt lgkmcnt(10)
  v_add_f32 v32, v32, v40
  v_add_f32 v48, v48, v56
  v_add_f32 v33, v33, v41
  v_add_f32 v49, v49, v57
  v_add_f32 v34, v34, v42
  v_add_f32 v50, v50, v58
  v_add_f32 v35, v35, v43
  v_add_f32 v51, v51, v59
  v_add_f32 v36, v36, v44
  v_add_f32 v52, v52, v60
  v_add_f32 v37, v37, v45
  v_add_f32 v53, v53, v61
  v_add_f32 v38, v38, v46
  v_add_f32 v54, v54, v62
  v_add_f32 v39, v39, v47
  v_add_f32 v55, v55, v63
  v_add_f32 v32, v32, v48
  v_add_f32 v33, v33, v49
  v_add_f32 v34, v34, v50
  v_add_f32 v35, v35, v51
  v_add_f32 v36, v36, v52
  v_add_f32 v37, v37, v53
  v_add_f32 v38, v38, v54
  v_add_f32 v39, v39, v55
  v_cvt_pk_bf16_f32 v40, v32, v33
  v_lshlrev_b32 v42, 16, v160
  v_and_b32 v43, 0xffff0000, v160
  v_and_b32 v41, 0xffff0000, v40
  v_lshlrev_b32 v40, 16, v40
  v_add_f32 v40, v40, v42
  v_add_f32 v41, v41, v43
  v_cvt_pk_bf16_f32 v40, v40, v41
  v_lshlrev_b32 v42, 16, v172
  v_and_b32 v43, 0xffff0000, v172
  v_add_f32 v42, v42, v64
  v_add_f32 v43, v43, v65
  v_cvt_pk_bf16_f32 v42, v42, v43
  v_and_b32 v41, 0xffff0000, v40
  v_lshlrev_b32 v40, 16, v40
  v_and_b32 v43, 0xffff0000, v42
  v_lshlrev_b32 v42, 16, v42
  v_add_f32 v40, v40, v42
  v_add_f32 v41, v41, v43
  v_cvt_pk_bf16_f32 v44, v40, v41
  v_cvt_pk_bf16_f32 v40, v34, v35
  v_lshlrev_b32 v42, 16, v161
  v_and_b32 v43, 0xffff0000, v161
  v_and_b32 v41, 0xffff0000, v40
  v_lshlrev_b32 v40, 16, v40
  v_add_f32 v40, v40, v42
  v_add_f32 v41, v41, v43
  v_cvt_pk_bf16_f32 v40, v40, v41
  v_lshlrev_b32 v42, 16, v173
  v_and_b32 v43, 0xffff0000, v173
  v_add_f32 v42, v42, v66
  v_add_f32 v43, v43, v67
  v_cvt_pk_bf16_f32 v42, v42, v43
  v_and_b32 v41, 0xffff0000, v40
  v_lshlrev_b32 v40, 16, v40
  v_and_b32 v43, 0xffff0000, v42
  v_lshlrev_b32 v42, 16, v42
  v_add_f32 v40, v40, v42
  v_add_f32 v41, v41, v43
  v_cvt_pk_bf16_f32 v45, v40, v41
  v_cvt_pk_bf16_f32 v40, v36, v37
  v_lshlrev_b32 v42, 16, v162
  v_and_b32 v43, 0xffff0000, v162
  v_and_b32 v41, 0xffff0000, v40
  v_lshlrev_b32 v40, 16, v40
  v_add_f32 v40, v40, v42
  v_add_f32 v41, v41, v43
  v_cvt_pk_bf16_f32 v40, v40, v41
  v_lshlrev_b32 v42, 16, v174
  v_and_b32 v43, 0xffff0000, v174
  v_add_f32 v42, v42, v68
  v_add_f32 v43, v43, v69
  v_cvt_pk_bf16_f32 v42, v42, v43
  v_and_b32 v41, 0xffff0000, v40
  v_lshlrev_b32 v40, 16, v40
  v_and_b32 v43, 0xffff0000, v42
  v_lshlrev_b32 v42, 16, v42
  v_add_f32 v40, v40, v42
  v_add_f32 v41, v41, v43
  v_cvt_pk_bf16_f32 v46, v40, v41
  v_cvt_pk_bf16_f32 v40, v38, v39
  v_lshlrev_b32 v42, 16, v163
  v_and_b32 v43, 0xffff0000, v163
  v_and_b32 v41, 0xffff0000, v40
  v_lshlrev_b32 v40, 16, v40
  v_add_f32 v40, v40, v42
  v_add_f32 v41, v41, v43
  v_cvt_pk_bf16_f32 v40, v40, v41
  v_lshlrev_b32 v42, 16, v175
  v_and_b32 v43, 0xffff0000, v175
  v_add_f32 v42, v42, v70
  v_add_f32 v43, v43, v71
  v_cvt_pk_bf16_f32 v42, v42, v43
  v_and_b32 v41, 0xffff0000, v40
  v_lshlrev_b32 v40, 16, v40
  v_and_b32 v43, 0xffff0000, v42
  v_lshlrev_b32 v42, 16, v42
  v_add_f32 v40, v40, v42
  v_add_f32 v41, v41, v43
  v_cvt_pk_bf16_f32 v47, v40, v41
  buffer_store_dwordx4 v[44:47], v248, s[48:51], 0 offen
  s_waitcnt lgkmcnt(10)
  v_add_f32 v72, v72, v80
  v_add_f32 v88, v88, v96
  v_add_f32 v73, v73, v81
  v_add_f32 v89, v89, v97
  v_add_f32 v74, v74, v82
  v_add_f32 v90, v90, v98
  v_add_f32 v75, v75, v83
  v_add_f32 v91, v91, v99
  v_add_f32 v76, v76, v84
  v_add_f32 v92, v92, v100
  v_add_f32 v77, v77, v85
  v_add_f32 v93, v93, v101
  v_add_f32 v78, v78, v86
  v_add_f32 v94, v94, v102
  v_add_f32 v79, v79, v87
  v_add_f32 v95, v95, v103
  v_add_f32 v72, v72, v88
  v_add_f32 v73, v73, v89
  v_add_f32 v74, v74, v90
  v_add_f32 v75, v75, v91
  v_add_f32 v76, v76, v92
  v_add_f32 v77, v77, v93
  v_add_f32 v78, v78, v94
  v_add_f32 v79, v79, v95
  v_cvt_pk_bf16_f32 v80, v72, v73
  v_lshlrev_b32 v82, 16, v164
  v_and_b32 v83, 0xffff0000, v164
  v_and_b32 v81, 0xffff0000, v80
  v_lshlrev_b32 v80, 16, v80
  v_add_f32 v80, v80, v82
  v_add_f32 v81, v81, v83
  v_cvt_pk_bf16_f32 v80, v80, v81
  v_lshlrev_b32 v82, 16, v192
  v_and_b32 v83, 0xffff0000, v192
  v_add_f32 v82, v82, v104
  v_add_f32 v83, v83, v105
  v_cvt_pk_bf16_f32 v82, v82, v83
  v_and_b32 v81, 0xffff0000, v80
  v_lshlrev_b32 v80, 16, v80
  v_and_b32 v83, 0xffff0000, v82
  v_lshlrev_b32 v82, 16, v82
  v_add_f32 v80, v80, v82
  v_add_f32 v81, v81, v83
  v_cvt_pk_bf16_f32 v84, v80, v81
  v_cvt_pk_bf16_f32 v80, v74, v75
  v_lshlrev_b32 v82, 16, v165
  v_and_b32 v83, 0xffff0000, v165
  v_and_b32 v81, 0xffff0000, v80
  v_lshlrev_b32 v80, 16, v80
  v_add_f32 v80, v80, v82
  v_add_f32 v81, v81, v83
  v_cvt_pk_bf16_f32 v80, v80, v81
  v_lshlrev_b32 v82, 16, v193
  v_and_b32 v83, 0xffff0000, v193
  v_add_f32 v82, v82, v106
  v_add_f32 v83, v83, v107
  v_cvt_pk_bf16_f32 v82, v82, v83
  v_and_b32 v81, 0xffff0000, v80
  v_lshlrev_b32 v80, 16, v80
  v_and_b32 v83, 0xffff0000, v82
  v_lshlrev_b32 v82, 16, v82
  v_add_f32 v80, v80, v82
  v_add_f32 v81, v81, v83
  v_cvt_pk_bf16_f32 v85, v80, v81
  v_cvt_pk_bf16_f32 v80, v76, v77
  v_lshlrev_b32 v82, 16, v166
  v_and_b32 v83, 0xffff0000, v166
  v_and_b32 v81, 0xffff0000, v80
  v_lshlrev_b32 v80, 16, v80
  v_add_f32 v80, v80, v82
  v_add_f32 v81, v81, v83
  v_cvt_pk_bf16_f32 v80, v80, v81
  v_lshlrev_b32 v82, 16, v194
  v_and_b32 v83, 0xffff0000, v194
  v_add_f32 v82, v82, v108
  v_add_f32 v83, v83, v109
  v_cvt_pk_bf16_f32 v82, v82, v83
  v_and_b32 v81, 0xffff0000, v80
  v_lshlrev_b32 v80, 16, v80
  v_and_b32 v83, 0xffff0000, v82
  v_lshlrev_b32 v82, 16, v82
  v_add_f32 v80, v80, v82
  v_add_f32 v81, v81, v83
  v_cvt_pk_bf16_f32 v86, v80, v81
  v_cvt_pk_bf16_f32 v80, v78, v79
  v_lshlrev_b32 v82, 16, v167
  v_and_b32 v83, 0xffff0000, v167
  v_and_b32 v81, 0xffff0000, v80
  v_lshlrev_b32 v80, 16, v80
  v_add_f32 v80, v80, v82
  v_add_f32 v81, v81, v83
  v_cvt_pk_bf16_f32 v80, v80, v81
  v_lshlrev_b32 v82, 16, v195
  v_and_b32 v83, 0xffff0000, v195
  v_add_f32 v82, v82, v110
  v_add_f32 v83, v83, v111
  v_cvt_pk_bf16_f32 v82, v82, v83
  v_and_b32 v81, 0xffff0000, v80
  v_lshlrev_b32 v80, 16, v80
  v_and_b32 v83, 0xffff0000, v82
  v_lshlrev_b32 v82, 16, v82
  v_add_f32 v80, v80, v82
  v_add_f32 v81, v81, v83
  v_cvt_pk_bf16_f32 v87, v80, v81
  buffer_store_dwordx4 v[84:87], v249, s[48:51], 0 offen
  s_waitcnt lgkmcnt(0)
  v_add_f32 v112, v112, v120
  v_add_f32 v128, v128, v136
  v_add_f32 v113, v113, v121
  v_add_f32 v129, v129, v137
  v_add_f32 v114, v114, v122
  v_add_f32 v130, v130, v138
  v_add_f32 v115, v115, v123
  v_add_f32 v131, v131, v139
  v_add_f32 v116, v116, v124
  v_add_f32 v132, v132, v140
  v_add_f32 v117, v117, v125
  v_add_f32 v133, v133, v141
  v_add_f32 v118, v118, v126
  v_add_f32 v134, v134, v142
  v_add_f32 v119, v119, v127
  v_add_f32 v135, v135, v143
  v_add_f32 v112, v112, v128
  v_add_f32 v113, v113, v129
  v_add_f32 v114, v114, v130
  v_add_f32 v115, v115, v131
  v_add_f32 v116, v116, v132
  v_add_f32 v117, v117, v133
  v_add_f32 v118, v118, v134
  v_add_f32 v119, v119, v135
  v_cvt_pk_bf16_f32 v120, v112, v113
  v_lshlrev_b32 v122, 16, v168
  v_and_b32 v123, 0xffff0000, v168
  v_and_b32 v121, 0xffff0000, v120
  v_lshlrev_b32 v120, 16, v120
  v_add_f32 v120, v120, v122
  v_add_f32 v121, v121, v123
  v_cvt_pk_bf16_f32 v120, v120, v121
  v_lshlrev_b32 v122, 16, v196
  v_and_b32 v123, 0xffff0000, v196
  v_add_f32 v122, v122, v144
  v_add_f32 v123, v123, v145
  v_cvt_pk_bf16_f32 v122, v122, v123
  v_and_b32 v121, 0xffff0000, v120
  v_lshlrev_b32 v120, 16, v120
  v_and_b32 v123, 0xffff0000, v122
  v_lshlrev_b32 v122, 16, v122
  v_add_f32 v120, v120, v122
  v_add_f32 v121, v121, v123
  v_cvt_pk_bf16_f32 v124, v120, v121
  v_cvt_pk_bf16_f32 v120, v114, v115
  v_lshlrev_b32 v122, 16, v169
  v_and_b32 v123, 0xffff0000, v169
  v_and_b32 v121, 0xffff0000, v120
  v_lshlrev_b32 v120, 16, v120
  v_add_f32 v120, v120, v122
  v_add_f32 v121, v121, v123
  v_cvt_pk_bf16_f32 v120, v120, v121
  v_lshlrev_b32 v122, 16, v197
  v_and_b32 v123, 0xffff0000, v197
  v_add_f32 v122, v122, v146
  v_add_f32 v123, v123, v147
  v_cvt_pk_bf16_f32 v122, v122, v123
  v_and_b32 v121, 0xffff0000, v120
  v_lshlrev_b32 v120, 16, v120
  v_and_b32 v123, 0xffff0000, v122
  v_lshlrev_b32 v122, 16, v122
  v_add_f32 v120, v120, v122
  v_add_f32 v121, v121, v123
  v_cvt_pk_bf16_f32 v125, v120, v121
  v_cvt_pk_bf16_f32 v120, v116, v117
  v_lshlrev_b32 v122, 16, v170
  v_and_b32 v123, 0xffff0000, v170
  v_and_b32 v121, 0xffff0000, v120
  v_lshlrev_b32 v120, 16, v120
  v_add_f32 v120, v120, v122
  v_add_f32 v121, v121, v123
  v_cvt_pk_bf16_f32 v120, v120, v121
  v_lshlrev_b32 v122, 16, v198
  v_and_b32 v123, 0xffff0000, v198
  v_add_f32 v122, v122, v148
  v_add_f32 v123, v123, v149
  v_cvt_pk_bf16_f32 v122, v122, v123
  v_and_b32 v121, 0xffff0000, v120
  v_lshlrev_b32 v120, 16, v120
  v_and_b32 v123, 0xffff0000, v122
  v_lshlrev_b32 v122, 16, v122
  v_add_f32 v120, v120, v122
  v_add_f32 v121, v121, v123
  v_cvt_pk_bf16_f32 v126, v120, v121
  v_cvt_pk_bf16_f32 v120, v118, v119
  v_lshlrev_b32 v122, 16, v171
  v_and_b32 v123, 0xffff0000, v171
  v_and_b32 v121, 0xffff0000, v120
  v_lshlrev_b32 v120, 16, v120
  v_add_f32 v120, v120, v122
  v_add_f32 v121, v121, v123
  v_cvt_pk_bf16_f32 v120, v120, v121
  v_lshlrev_b32 v122, 16, v199
  v_and_b32 v123, 0xffff0000, v199
  v_add_f32 v122, v122, v150
  v_add_f32 v123, v123, v151
  v_cvt_pk_bf16_f32 v122, v122, v123
  v_and_b32 v121, 0xffff0000, v120
  v_lshlrev_b32 v120, 16, v120
  v_and_b32 v123, 0xffff0000, v122
  v_lshlrev_b32 v122, 16, v122
  v_add_f32 v120, v120, v122
  v_add_f32 v121, v121, v123
  v_cvt_pk_bf16_f32 v127, v120, v121
  buffer_store_dwordx4 v[124:127], v250, s[48:51], 0 offen
fa_end:
  s_endpgm
fa_ln_spin:
  s_mov_b32 s83, 200000
fa_ln_spin2:
  buffer_load_dword v15, v229, s[56:59], 0 offen sc1
  s_waitcnt vmcnt(0)
  v_cmp_ne_u32 vcc, 0x01010101, v15
  s_cbranch_vccz fa_ln_ok
  s_sleep 8
  s_sub_u32 s83, s83, 1
  s_cmp_lg_u32 s83, 0
  s_cbranch_scc1 fa_ln_spin2
  s_branch fa_ln_ok
fa_p1stubK:
  s_call_b64 s[76:77], fa_p1sub
  s_branch fa_p1backK
fa_p1stubV:
  s_call_b64 s[76:77], fa_p1sub
  s_branch fa_p1backV
fa_p1sub:
  s_cmp_ge_u32 s28, 5
  s_cbranch_scc1 fa_p1sub5
  s_cmp_eq_u32 s28, 3
  s_cbranch_scc0 fa_p1sub0
  s_mov_b32 s48, s60
  s_mov_b32 s49, s61
  s_mov_b32 s50, s75
  s_lshl_b32 s74, s22, 2
  s_add_u32 s74, s74, s20
  s_lshl_b32 s74, s74, 16
  s_mov_b32 s73, 2097152
fa_p1sub0:
  s_cmp_eq_u32 s28, s71
  s_cselect_b32 s23, s70, 1073741824
  v_mov_b32 v16, 1073741824
  v_mov_b32 v17, 1
  v_writelane_b32 v16, s23, 0
  buffer_store_byte v17, v16, s[56:59], 0 offen sc1
  s_setpc_b64 s[76:77]
fa_p1sub5:
  s_cmp_eq_u32 s28, 6
  s_cbranch_scc1 fa_p1sub6
  v_lshlrev_b32 v229, 2, v1
  buffer_load_dword v15, v229, s[56:59], 0 offen sc1
  s_setpc_b64 s[76:77]
fa_p1sub6:
  v_cmp_ne_u32 vcc, 0x01010101, v15
  s_cbranch_vccnz fa_ln_spin
fa_ln_ok:
  s_mov_b32 s36, s60
  s_mov_b32 s37, s61
  s_mov_b32 s38, s75
  s_lshr_b32 s27, s20, 1
  s_lshl_b32 s27, s27, 18
  s_mov_b32 s25, 524288
  s_mov_b32 s32, s18
  s_mov_b32 s33, s19
  s_mov_b32 s34, 2621440
  s_mov_b32 s26, 0
  s_movk_i32 s79, 1024
  s_lshl_b32 s23, s22, 2
  s_add_u32 s23, s23, s20
  s_mul_i32 s23, s23, 40960
  v_add_u32 v3, s23, v2
  s_sub_u32 s23, 15, s22
  s_lshl_b32 s23, s23, 2
  s_add_u32 s23, s23, s20
  s_mul_i32 s23, s23, 40960
  s_sub_u32 s23, s23, 2048
  v_add_u32 v5, s23, v2
  v_add_u32 v4, 19456, v3
  v_add_u32 v6, 19456, v5
  s_setpc_b64 s[76:77]
fa_kv_spin:
  s_mov_b32 s83, 200000
fa_kv_spin2:
  buffer_load_dword v15, v8, s[40:43], 0 offen sc1
  s_waitcnt vmcnt(0)
  v_cmp_eq_u32 vcc, 0, v15
  s_cbranch_vccz fa_kv_ok
  s_sleep 8
  s_sub_u32 s83, s83, 1
  s_cmp_lg_u32 s83, 0
  s_cbranch_scc1 fa_kv_spin2
  s_branch fa_kv_ok
fa_top8:
  s_cmp_lg_u32 s20, 0
  s_cbranch_scc1 fa_notop
  s_mov_b32 s23, 2621440
  s_mov_b32 s31, 2625536
  buffer_load_dwordx4 v[96:99], v2, s[40:43], s23 offen offset:0 sc1
  buffer_load_dwordx4 v[100:103], v2, s[40:43], s23 offen offset:1024 sc1
  buffer_load_dwordx4 v[104:107], v2, s[40:43], s23 offen offset:2048 sc1
  buffer_load_dwordx4 v[108:111], v2, s[40:43], s23 offen offset:3072 sc1
  buffer_load_dwordx4 v[112:115], v2, s[40:43], s31 offen offset:0 sc1
  buffer_load_dwordx4 v[116:119], v2, s[40:43], s31 offen offset:1024 sc1
  buffer_load_dwordx4 v[120:123], v2, s[40:43], s31 offen offset:2048 sc1
  buffer_load_dwordx4 v[124:127], v2, s[40:43], s31 offen offset:3072 sc1
  v_mov_b32 v21, 0
  v_mov_b32 v22, 0
  v_and_b32 v23, 7, v1
  s_mov_b32 s23, 0
  s_waitcnt vmcnt(0)
fa_top:
  v_max3_u32 v20, v96, v97, v98
  v_max3_u32 v24, v99, v100, v101
  v_max3_u32 v20, v20, v102, v103
  v_max3_u32 v24, v24, v104, v105
  v_max3_u32 v20, v20, v106, v107
  v_max3_u32 v24, v24, v108, v109
  v_max3_u32 v20, v20, v110, v111
  v_max3_u32 v24, v24, v112, v113
  v_max3_u32 v20, v20, v114, v115
  v_max3_u32 v24, v24, v116, v117
  v_max3_u32 v20, v20, v118, v119
  v_max3_u32 v24, v24, v120, v121
  v_max3_u32 v20, v20, v122, v123
  v_max3_u32 v24, v24, v124, v125
  v_max3_u32 v20, v20, v126, v127
  v_max_u32 v20, v20, v24
  s_nop 1
  v_max_u32_dpp v20, v20, v20 quad_perm:[1,0,3,2] row_mask:0xf bank_mask:0xf
  s_nop 1
  v_max_u32_dpp v20, v20, v20 quad_perm:[2,3,0,1] row_mask:0xf bank_mask:0xf
  s_nop 1
  v_max_u32_dpp v20, v20, v20 row_half_mirror row_mask:0xf bank_mask:0xf
  s_nop 1
  v_max_u32_dpp v20, v20, v20 row_mirror row_mask:0xf bank_mask:0xf
  v_mov_b32 v24, v20
  s_nop 1
  v_permlane16_swap_b32 v20, v24
  v_max_u32 v20, v20, v24
  v_mov_b32 v24, v20
  s_nop 1
  v_permlane32_swap_b32 v20, v24
  v_max_u32 v20, v20, v24
  v_add_u32 v21, v21, v20
  v_cmp_eq_u32 vcc, s23, v23
  v_sub_u32 v96, v96, v20
  v_sub_u32 v97, v97, v20
  v_sub_u32 v98, v98, v20
  v_sub_u32 v99, v99, v20
  v_sub_u32 v100, v100, v20
  v_sub_u32 v101, v101, v20
  v_sub_u32 v102, v102, v20
  v_sub_u32 v103, v103, v20
  v_sub_u32 v104, v104, v20
  v_sub_u32 v105, v105, v20
  v_sub_u32 v106, v106, v20
  v_sub_u32 v107, v107, v20
  v_sub_u32 v108, v108, v20
  v_sub_u32 v109, v109, v20
  v_sub_u32 v110, v110, v20
  v_sub_u32 v111, v111, v20
  v_sub_u32 v112, v112, v20
  v_sub_u32 v113, v113, v20
  v_sub_u32 v114, v114, v20
  v_sub_u32 v115, v115, v20
  v_sub_u32 v116, v116, v20
  v_sub_u32 v117, v117, v20
  v_sub_u32 v118, v118, v20
  v_sub_u32 v119, v119, v20
  v_sub_u32 v120, v120, v20
  v_sub_u32 v121, v121, v20
  v_sub_u32 v122, v122, v20
  v_sub_u32 v123, v123, v20
  v_sub_u32 v124, v124, v20
  v_sub_u32 v125, v125, v20
  v_sub_u32 v126, v126, v20
  v_sub_u32 v127, v127, v20
  v_cndmask_b32 v22, v22, v21, vcc
  s_add_u32 s23, s23, 1
  s_cmp_lt_u32 s23, 8
  s_cbranch_scc1 fa_top
  v_and_b32 v25, 0xffff, v22
  v_sub_u32 v25, 0xffff, v25
  v_and_b32 v25, 2047, v25
  v_ashrrev_i32 v20, 31, v22
  v_not_b32 v20, v20
  v_or_b32 v20, 0x80000000, v20
  v_xor_b32 v26, v22, v20
  v_and_b32 v26, 0xffff0000, v26
  v_mul_f32 v26, 0xbfb8aa3b, v26
  v_exp_f32 v26, v26
  s_nop 0
  v_add_f32 v26, 1.0, v26
  v_rcp_f32 v26, v26
  s_nop 0
  v_cvt_pk_bf16_f32 v26, v26, v26
  v_and_b32 v26, 0xffff0000, v26
  v_lshlrev_b32 v20, 2, v1
  v_add_u32 v20, 2629632, v20
  v_mov_b32 v21, 1073741824
  v_cmp_gt_u32 vcc, 16, v1
  v_add_u32 v25, 1, v25
  v_or_b32 v26, 1, v26
  v_cndmask_b32 v20, v21, v20, vcc
  v_cmp_gt_u32 vcc, 8, v1
  s_nop 1
  v_cndmask_b32 v26, v26, v25, vcc
  buffer_store_dword v26, v20, s[40:43], 0 offen sc1
  s_branch fa_notop
fa_hk0:
  s_getpc_b64 s[38:39]
fa_hp0:
  s_add_u32 s36, s36, 4
  s_addc_u32 s37, s37, 0
  s_sub_u32 s38, s38, fa_hp0-fa_hb0
  s_subb_u32 s39, s39, 0
  s_setpc_b64 s[36:37]
fa_hk1:
  s_getpc_b64 s[38:39]
fa_hp1:
  s_add_u32 s36, s36, 4
  s_addc_u32 s37, s37, 0
  s_sub_u32 s38, s38, fa_hp1-fa_hb1
  s_subb_u32 s39, s39, 0
  s_setpc_b64 s[36:37]
fa_hk2:
  s_getpc_b64 s[38:39]
fa_hp2:
  s_add_u32 s36, s36, 4
  s_addc_u32 s37, s37, 0
  s_add_u32 s38, s38, fa_hb2-fa_hp2
  s_addc_u32 s39, s39, 0
  s_setpc_b64 s[36:37]
fa_DDF:
  v_mfma_f32_16x16x32_bf16 v[96:99], a[128:131], v[32:35], v[192:195]
  s_waitcnt vmcnt(12)
  v_exp_f32 v208, v112
  v_mfma_f32_16x16x32_bf16 v[104:107], a[128:131], v[36:39], v[196:199]
  s_barrier
  v_exp_f32 v209, v113
  v_mfma_f32_16x16x32_bf16 v[128:131], a[128:131], v[64:67], v[200:203]
  s_cmp_ge_u32 s26, s32
  ds_read_b128 a[160:163], v3 offset:16384
  v_add_f32 v224, v208, v209
  v_mfma_f32_16x16x32_bf16 v[136:139], a[128:131], v[68:71], v[204:207]
  s_cbranch_scc1 fa_hk2
fa_hb2:
  v_exp_f32 v210, v114
  v_cvt_pk_bf16_f32 v168, v208, v209
  v_mfma_f32_16x16x32_bf16 v[100:103], a[132:135], v[32:35], v[192:195]
  ds_read_b128 a[164:167], v3 offset:17408
  v_add_f32 v224, v224, v210
  v_mfma_f32_16x16x32_bf16 v[108:111], a[132:135], v[36:39], v[196:199]
  s_mov_b32 m0, s24
  v_exp_f32 v211, v115
  v_mfma_f32_16x16x32_bf16 v[132:135], a[132:135], v[64:67], v[200:203]
  buffer_load_dwordx4 v2, s[44:47], s26 offen offset:0 sc1 lds
  v_add_f32 v224, v224, v211
  v_mfma_f32_16x16x32_bf16 v[140:143], a[132:135], v[68:71], v[204:207]
  v_exp_f32 v212, v116
  v_mfma_f32_16x16x32_bf16 v[96:99], a[136:139], v[40:43], v[96:99]
  ds_read_b128 a[168:171], v3 offset:18432
  v_cvt_pk_bf16_f32 v169, v210, v211
  v_mfma_f32_16x16x32_bf16 v[104:107], a[136:139], v[44:47], v[104:107]
  v_exp_f32 v213, v117
  v_add_f32 v224, v224, v212
  v_mfma_f32_16x16x32_bf16 v[128:131], a[136:139], v[72:75], v[128:131]
  v_exp_f32 v214, v118
  v_mfma_f32_16x16x32_bf16 v[136:139], a[136:139], v[76:79], v[136:139]
  v_exp_f32 v215, v119
  v_mfma_f32_16x16x32_bf16 v[100:103], a[140:143], v[40:43], v[100:103]
  ds_read_b128 a[172:175], v3 offset:19456
  v_add_f32 v224, v224, v213
  v_mfma_f32_16x16x32_bf16 v[108:111], a[140:143], v[44:47], v[108:111]
  buffer_load_dwordx4 v2, s[44:47], s26 offen offset:1024 sc1 lds
  v_cvt_pk_bf16_f32 v170, v212, v213
  v_mfma_f32_16x16x32_bf16 v[132:135], a[140:143], v[72:75], v[132:135]
  v_exp_f32 v208, v120
  v_mfma_f32_16x16x32_bf16 v[140:143], a[140:143], v[76:79], v[140:143]
  s_waitcnt lgkmcnt(4)
  v_exp_f32 v209, v121
  v_add_f32 v224, v224, v214
  v_mfma_f32_16x16x32_bf16 v[96:99], a[144:147], v[48:51], v[96:99]
  ds_read_b128 a[176:179], v3 offset:20480
  v_add_f32 v224, v224, v215
  v_mfma_f32_16x16x32_bf16 v[104:107], a[144:147], v[52:55], v[104:107]
  v_exp_f32 v210, v122
  v_mfma_f32_16x16x32_bf16 v[128:131], a[144:147], v[80:83], v[128:131]
  v_exp_f32 v211, v123
  v_mfma_f32_16x16x32_bf16 v[136:139], a[144:147], v[84:87], v[136:139]
  buffer_load_dwordx4 v2, s[44:47], s26 offen offset:2048 sc1 lds
  v_cvt_pk_bf16_f32 v171, v214, v215
  v_mfma_f32_16x16x32_bf16 v[100:103], a[148:151], v[48:51], v[100:103]
  ds_read_b128 a[180:183], v3 offset:21504
  v_add_f32 v225, v208, v209
  v_mfma_f32_16x16x32_bf16 v[108:111], a[148:151], v[52:55], v[108:111]
  v_exp_f32 v212, v124
  v_mfma_f32_16x16x32_bf16 v[132:135], a[148:151], v[80:83], v[132:135]
  v_exp_f32 v213, v125
  v_cvt_pk_bf16_f32 v172, v208, v209
  v_mfma_f32_16x16x32_bf16 v[140:143], a[148:151], v[84:87], v[140:143]
  v_exp_f32 v214, v126
  v_mfma_f32_16x16x32_bf16 v[96:99], a[152:155], v[56:59], v[96:99]
  ds_read_b128 a[184:187], v3 offset:22528
  v_add_f32 v225, v225, v210
  v_mfma_f32_16x16x32_bf16 v[104:107], a[152:155], v[60:63], v[104:107]
  buffer_load_dwordx4 v2, s[44:47], s26 offen offset:3072 sc1 lds
  v_add_f32 v225, v225, v211
  v_mfma_f32_16x16x32_bf16 v[128:131], a[152:155], v[88:91], v[128:131]
  s_add_u32 s26, s26, 16384
  v_exp_f32 v215, v127
  v_mfma_f32_16x16x32_bf16 v[136:139], a[152:155], v[92:95], v[136:139]
  s_add_u32 s24, s24, 32768
  v_exp_f32 v216, v144
  v_mfma_f32_16x16x32_bf16 v[100:103], a[156:159], v[56:59], v[100:103]
  s_and_b32 s24, s24, 0x1ffff
  ds_read_b128 a[188:191], v3 offset:23552
  v_cvt_pk_bf16_f32 v173, v210, v211
  v_add_f32 v225, v225, v212
  v_mfma_f32_16x16x32_bf16 v[108:111], a[156:159], v[60:63], v[108:111]
  v_exp_f32 v217, v145
  v_mfma_f32_16x16x32_bf16 v[132:135], a[156:159], v[88:91], v[132:135]
  s_add_u32 m0, s34, 0
  v_exp_f32 v218, v146
  v_mfma_f32_16x16x32_bf16 v[140:143], a[156:159], v[92:95], v[140:143]
  s_waitcnt lgkmcnt(4)
  buffer_load_dwordx4 v8, s[52:55], s33 offen offset:0 lds
  v_add_f32 v225, v225, v213
  v_mfma_f32_16x16x32_bf16 a[0:3], a[160:163], v[160:163], a[0:3]
  ds_read_b128 a[128:131], v3 offset:0
  v_cvt_pk_bf16_f32 v174, v212, v213
  v_mfma_f32_16x16x32_bf16 a[4:7], a[160:163], v[164:167], a[4:7]
  v_exp_f32 v219, v147
  v_mfma_f32_16x16x32_bf16 a[64:67], a[160:163], v[176:179], a[64:67]
  v_exp_f32 v220, v148
  v_add_f32 v225, v225, v214
  v_mfma_f32_16x16x32_bf16 a[68:71], a[160:163], v[180:183], a[68:71]
  v_exp_f32 v221, v149
  v_mfma_f32_16x16x32_bf16 a[8:11], a[164:167], v[160:163], a[8:11]
  ds_read_b128 a[132:135], v3 offset:1024
  v_add_f32 v225, v225, v215
  v_mfma_f32_16x16x32_bf16 a[12:15], a[164:167], v[164:167], a[12:15]
  buffer_load_dwordx4 v11, s[52:55], s33 offen offset:1024 lds
  v_cvt_pk_bf16_f32 v175, v214, v215
  v_mfma_f32_16x16x32_bf16 a[72:75], a[164:167], v[176:179], a[72:75]
  v_exp_f32 v222, v150
  v_mfma_f32_16x16x32_bf16 a[76:79], a[164:167], v[180:183], a[76:79]
  v_exp_f32 v223, v151
  v_mfma_f32_16x16x32_bf16 a[16:19], a[168:171], v[160:163], a[16:19]
  ds_read_b128 a[136:139], v3 offset:2048
  v_add_f32 v226, v216, v217
  v_cvt_pk_bf16_f32 v184, v216, v217
  v_mfma_f32_16x16x32_bf16 a[20:23], a[168:171], v[164:167], a[20:23]
  v_exp_f32 v216, v152
  v_mfma_f32_16x16x32_bf16 a[80:83], a[168:171], v[176:179], a[80:83]
  v_add_f32 v226, v226, v218
  v_add_f32 v226, v226, v219
  v_mfma_f32_16x16x32_bf16 a[84:87], a[168:171], v[180:183], a[84:87]
  buffer_load_dwordx4 v12, s[52:55], s33 offen offset:2048 lds
  v_cvt_pk_bf16_f32 v185, v218, v219
  v_mfma_f32_16x16x32_bf16 a[24:27], a[172:175], v[160:163], a[24:27]
  ds_read_b128 a[140:143], v3 offset:3072
  v_add_f32 v226, v226, v220
  v_mfma_f32_16x16x32_bf16 a[28:31], a[172:175], v[164:167], a[28:31]
  v_exp_f32 v217, v153
  v_mfma_f32_16x16x32_bf16 a[88:91], a[172:175], v[176:179], a[88:91]
  v_exp_f32 v218, v154
  v_mfma_f32_16x16x32_bf16 a[92:95], a[172:175], v[180:183], a[92:95]
  s_waitcnt lgkmcnt(4)
  v_exp_f32 v219, v155
  v_add_f32 v226, v226, v221
  v_mfma_f32_16x16x32_bf16 a[32:35], a[176:179], v[160:163], a[32:35]
  ds_read_b128 a[144:147], v3 offset:4096
  v_cvt_pk_bf16_f32 v186, v220, v221
  v_mfma_f32_16x16x32_bf16 a[36:39], a[176:179], v[164:167], a[36:39]
  buffer_load_dwordx4 v13, s[52:55], s33 offen offset:3072 lds
  v_add_f32 v226, v226, v222
  v_mfma_f32_16x16x32_bf16 a[96:99], a[176:179], v[176:179], a[96:99]
  v_exp_f32 v220, v156
  v_mfma_f32_16x16x32_bf16 a[100:103], a[176:179], v[180:183], a[100:103]
  v_exp_f32 v221, v157
  v_mfma_f32_16x16x32_bf16 a[40:43], a[180:183], v[160:163], a[40:43]
  ds_read_b128 a[148:151], v3 offset:5120
  v_add_f32 v226, v226, v223
  v_mfma_f32_16x16x32_bf16 a[44:47], a[180:183], v[164:167], a[44:47]
  v_cvt_pk_bf16_f32 v187, v222, v223
  v_add_f32 v227, v216, v217
  v_cvt_pk_bf16_f32 v188, v216, v217
  v_mfma_f32_16x16x32_bf16 a[104:107], a[180:183], v[176:179], a[104:107]
  s_add_u32 m0, s34, 4096
  v_exp_f32 v222, v158
  v_mfma_f32_16x16x32_bf16 a[108:111], a[180:183], v[180:183], a[108:111]
  buffer_load_dwordx4 v14, s[52:55], s33 offen offset:0 lds
  v_add_f32 v227, v227, v218
  v_mfma_f32_16x16x32_bf16 a[48:51], a[184:187], v[160:163], a[48:51]
  ds_read_b128 a[152:155], v3 offset:6144
  v_add_f32 v227, v227, v219
  v_mfma_f32_16x16x32_bf16 a[52:55], a[184:187], v[164:167], a[52:55]
  v_exp_f32 v223, v159
  v_mfma_f32_16x16x32_bf16 a[112:115], a[184:187], v[176:179], a[112:115]
  v_cvt_pk_bf16_f32 v189, v218, v219
  v_max3_f32 v5, v224, v225, v226
  v_mfma_f32_16x16x32_bf16 a[116:119], a[184:187], v[180:183], a[116:119]
  v_add_f32 v227, v227, v220
  v_add_f32 v227, v227, v221
  v_cvt_pk_bf16_f32 v190, v220, v221
  v_mfma_f32_16x16x32_bf16 a[56:59], a[188:191], v[160:163], a[56:59]
  ds_read_b128 a[156:159], v3 offset:7168
  v_add_f32 v227, v227, v222
  v_mfma_f32_16x16x32_bf16 a[60:63], a[188:191], v[164:167], a[60:63]
  v_add_f32 v227, v227, v223
  v_cvt_pk_bf16_f32 v191, v222, v223
  v_mfma_f32_16x16x32_bf16 a[120:123], a[188:191], v[176:179], a[120:123]
  s_waitcnt lgkmcnt(4)
  v_max_f32 v5, v5, v227
  v_cmp_lt_f32 vcc, s81, v5
  v_mfma_f32_16x16x32_bf16 a[124:127], a[188:191], v[180:183], a[124:127]
  s_cbranch_vccnz fa_stub3
fa_back3:
  v_add_f32 v228, v228, v224
  v_add_f32 v229, v229, v225
  v_add_f32 v230, v230, v226
  v_add_f32 v231, v231, v227
  s_branch fa_DDe
fa_sel_spin:
  s_mov_b32 s83, 200000
fa_sel_spin2:
  buffer_load_dword v15, v252, s[40:43], 0 offen sc1
  s_waitcnt vmcnt(0)
  v_cmp_eq_u32 vcc, 0, v15
  s_cbranch_vccz fa_sel_ok
  s_sleep 8
  s_sub_u32 s83, s83, 1
  s_cmp_lg_u32 s83, 0
  s_cbranch_scc1 fa_sel_spin2
  s_branch fa_sel_ok
fa_wof_spin:
  s_mov_b32 s83, 200000
fa_wof_spin2:
  buffer_load_dword v8, v9, s[40:43], 0 offen sc1
  s_waitcnt vmcnt(0)
  v_cmp_eq_u32 vcc, 0, v8
  s_cbranch_vccz fa_wof_ok
  s_sleep 8
  s_sub_u32 s83, s83, 1
  s_cmp_lg_u32 s83, 0
  s_cbranch_scc1 fa_wof_spin2
  s_branch fa_wof_ok
fa_sel4_spin:
  s_mov_b32 s83, 200000
fa_sel4_spin2:
  buffer_load_dword v15, v10, s[40:43], 0 offen sc1
  s_waitcnt vmcnt(0)
  v_cmp_eq_u32 vcc, 0, v15
  s_cbranch_vccz fa_sel4_ok
  s_sleep 8
  s_sub_u32 s83, s83, 1
  s_cmp_lg_u32 s83, 0
  s_cbranch_scc1 fa_sel4_spin2
  s_branch fa_sel4_ok
fa_yf_spin:
  s_mov_b32 s83, 200000
fa_yf_spin2:
  buffer_load_dword v14, v11, s[40:43], 0 offen sc1
  s_waitcnt vmcnt(0)
  v_cmp_eq_u32 vcc, 0, v14
  s_cbranch_vccz fa_yf_ok
  s_sleep 8
  s_sub_u32 s83, s83, 1
  s_cmp_lg_u32 s83, 0
  s_cbranch_scc1 fa_yf_spin2
  s_branch fa_yf_ok
fa_co:
  s_waitcnt vmcnt(8)
  ds_read_b64_tr_b16 v[232:233], v6 offset:0
  ds_read_b64_tr_b16 v[234:235], v6 offset:2560
  ds_read_b64_tr_b16 v[236:237], v6 offset:32
  ds_read_b64_tr_b16 v[238:239], v6 offset:2592
  ds_read_b64_tr_b16 v[240:241], v6 offset:64
  ds_read_b64_tr_b16 v[242:243], v6 offset:2624
  ds_read_b64_tr_b16 v[244:245], v6 offset:96
  ds_read_b64_tr_b16 v[246:247], v6 offset:2656
  ds_read_b64_tr_b16 v[248:249], v6 offset:128
  ds_read_b64_tr_b16 v[250:251], v6 offset:2688
  s_sub_u32 s14, s2, 192
  s_cmp_lt_u32 s14, 54
  s_cbranch_scc1 fa_coF
  s_sub_u32 s14, s2, 64
  s_cmp_lt_u32 s14, 128
  s_cbranch_scc1 fa_coT
  s_getpc_b64 s[36:37]
  s_setpc_b64 s[38:39]
  s_add_u32 s31, s30, 4096
  buffer_store_dwordx4 v[232:235], v2, s[40:43], s30 offen offset:0 sc1
  buffer_store_dwordx4 v[236:239], v2, s[40:43], s30 offen offset:1024 sc1
  buffer_store_dwordx4 v[240:243], v2, s[40:43], s30 offen offset:2048 sc1
  buffer_store_dwordx4 v[244:247], v2, s[40:43], s30 offen offset:3072 sc1
  buffer_store_dwordx4 v[248:251], v2, s[40:43], s31 offen offset:0 sc1
  s_getpc_b64 s[36:37]
  s_setpc_b64 s[38:39]
  s_getpc_b64 s[36:37]
  s_setpc_b64 s[38:39]
  s_and_b32 s23, s2, 1
  s_lshl_b32 s23, s23, 2
  s_add_u32 s23, s23, s20
  s_lshl_b32 s23, s23, 7
  s_lshr_b32 s31, s2, 1
  s_add_u32 s23, s23, s31
  s_lshl_b32 s23, s23, 2
  s_add_u32 s23, s23, 2654208
  v_mov_b32 v16, 1073741824
  v_mov_b32 v17, 1
  v_writelane_b32 v16, s23, 0
  s_waitcnt vmcnt(8)
  buffer_store_dword v17, v16, s[40:43], 0 offen sc1
  s_branch fa_coW
fa_coT:
  v_min_u32 v8, 16, v1
  v_lshlrev_b32 v8, 7, v8
  s_lshl_b32 s33, s14, 1
  s_and_b32 s31, s20, 1
  s_add_u32 s33, s33, s31
  s_mul_i32 s33, s33, 2176
  s_lshl_b32 s35, s14, 2
  s_add_u32 s35, s35, s20
  s_mul_i32 s35, s35, 4352
  buffer_load_dword v255, v8, s[52:55], s33 offen
  s_add_u32 s33, s33, 552960
  s_getpc_b64 s[36:37]
  s_setpc_b64 s[38:39]
  s_add_u32 s31, s30, 4096
  buffer_store_dwordx4 v[232:235], v2, s[40:43], s30 offen offset:0 sc1
  buffer_store_dwordx4 v[236:239], v2, s[40:43], s30 offen offset:1024 sc1
  buffer_store_dwordx4 v[240:243], v2, s[40:43], s30 offen offset:2048 sc1
  buffer_store_dwordx4 v[244:247], v2, s[40:43], s30 offen offset:3072 sc1
  buffer_store_dwordx4 v[248:251], v2, s[40:43], s31 offen offset:0 sc1
  buffer_load_dword v255, v8, s[52:55], s33 offen
  s_add_u32 s33, s33, 552960
  s_getpc_b64 s[36:37]
  s_setpc_b64 s[38:39]
  buffer_load_dword v255, v8, s[52:55], s33 offen
  s_add_u32 s33, s33, 552960
  s_getpc_b64 s[36:37]
  s_setpc_b64 s[38:39]
  s_and_b32 s23, s2, 1
  s_lshl_b32 s23, s23, 2
  s_add_u32 s23, s23, s20
  s_lshl_b32 s23, s23, 7
  s_lshr_b32 s31, s2, 1
  s_add_u32 s23, s23, s31
  s_lshl_b32 s23, s23, 2
  s_add_u32 s23, s23, 2654208
  v_mov_b32 v16, 1073741824
  v_mov_b32 v17, 1
  v_writelane_b32 v16, s23, 0
  s_waitcnt vmcnt(10)
  buffer_store_dword v17, v16, s[40:43], 0 offen sc1
  buffer_load_dword v255, v8, s[52:55], s33 offen
  s_add_u32 s33, s33, 552960
  s_getpc_b64 s[36:37]
  s_setpc_b64 s[38:39]
  buffer_load_dword v255, v8, s[60:63], s35 offen
  s_getpc_b64 s[36:37]
  s_setpc_b64 s[38:39]
  buffer_load_dword v255, v8, s[60:63], s35 offen offset:2176
  s_branch fa_coW
fa_coF:
  s_getpc_b64 s[36:37]
  s_setpc_b64 s[38:39]
  s_add_u32 s31, s30, 4096
  buffer_store_dwordx4 v[232:235], v2, s[40:43], s30 offen offset:0 sc1
  buffer_store_dwordx4 v[236:239], v2, s[40:43], s30 offen offset:1024 sc1
  buffer_store_dwordx4 v[240:243], v2, s[40:43], s30 offen offset:2048 sc1
  buffer_store_dwordx4 v[244:247], v2, s[40:43], s30 offen offset:3072 sc1
  buffer_store_dwordx4 v[248:251], v2, s[40:43], s31 offen offset:0 sc1
  s_lshl_b32 s33, s14, 6
  s_and_b32 s31, s20, 1
  s_lshl_b32 s31, s31, 5
  s_add_u32 s33, s33, s31
  s_mul_i32 s35, s14, 40960
  s_mul_i32 s31, s20, 320
  s_add_u32 s35, s35, s31
  s_mul_i32 s10, s14, 20480
  s_mul_i32 s31, s20, 640
  s_add_u32 s10, s10, s31
  s_add_u32 s10, s10, 2686976
  s_mov_b32 s9, -1
  s_getpc_b64 s[36:37]
  s_setpc_b64 s[38:39]
  v_and_b32 v16, 7, v1
  v_lshlrev_b32 v252, 2, v16
  v_add_u32 v252, 2629632, v252
  buffer_load_dword v15, v252, s[40:43], 0 offen sc1
  v_lshrrev_b32 v17, 1, v1
  v_mul_u32_u24 v8, 3456, v17
  v_and_b32 v17, 1, v1
  v_lshl_add_u32 v8, v17, 4, v8
  v_add_u32 v11, 109568, v8
  v_add_u32 v12, 219136, v8
  v_add_u32 v13, 328704, v8
  v_add_u32 v14, 442368, v8
  v_lshrrev_b32 v17, 4, v1
  v_lshrrev_b32 v18, 2, v1
  v_lshl_add_u32 v18, v17, 2, v18
  v_lshlrev_b32 v18, 5, v18
  v_and_b32 v19, 3, v1
  v_lshl_add_u32 v9, v19, 3, v18
  v_add_u32 v9, s34, v9
  v_lshlrev_b32 v10, 4, v16
  v_lshl_add_u32 v10, v17, 7, v10
  v_add_u32 v10, 151552, v10
  s_mov_b32 s8, 1
  v_mov_b32 v232, 0
  v_mov_b32 v233, 0
  v_mov_b32 v234, 0
  v_mov_b32 v235, 0
  s_getpc_b64 s[36:37]
  s_setpc_b64 s[38:39]
  s_and_b32 s23, s2, 1
  s_lshl_b32 s23, s23, 2
  s_add_u32 s23, s23, s20
  s_lshl_b32 s23, s23, 7
  s_lshr_b32 s31, s2, 1
  s_add_u32 s23, s23, s31
  s_lshl_b32 s23, s23, 2
  s_add_u32 s23, s23, 2654208
  v_mov_b32 v16, 1073741824
  v_mov_b32 v17, 1
  v_writelane_b32 v16, s23, 0
  s_waitcnt vmcnt(8)
  buffer_store_dword v17, v16, s[40:43], 0 offen sc1
  v_cmp_eq_u32 vcc, 0, v15
  s_cbranch_vccnz fa_sel_spin
fa_sel_ok:
  v_add_u32 v18, -1, v15
  v_and_b32 v18, 2047, v18
  v_lshrrev_b32 v19, 4, v18
  v_mul_u32_u24 v19, 20480, v19
  v_and_b32 v18, 15, v18
  v_lshl_add_u32 v19, v18, 4, v19
  v_lshrrev_b32 v18, 3, v1
  v_lshl_add_u32 v19, v18, 8, v19
  s_lshl_b32 s23, s20, 11
  s_lshl_b32 s31, s20, 10
  s_add_u32 s31, s31, 151552
  s_mov_b32 s14, 4
  s_mov_b32 m0, s31
  s_add_u32 s31, s31, 4096
  buffer_load_dwordx4 v19, s[40:43], s23 offen sc1 lds
  s_add_u32 s23, s23, 8192
  s_mov_b32 m0, s31
  s_add_u32 s31, s31, 4096
  buffer_load_dwordx4 v19, s[40:43], s23 offen sc1 lds
  s_add_u32 s23, s23, 8192
  s_mov_b32 m0, s31
  s_add_u32 s31, s31, 4096
  buffer_load_dwordx4 v19, s[40:43], s23 offen sc1 lds
  s_add_u32 s23, s23, 8192
fa_coG:
  s_getpc_b64 s[36:37]
  s_setpc_b64 s[38:39]
  s_waitcnt vmcnt(4)
  ds_read_b64_tr_b16 a[192:193], v9 offset:0
  ds_read_b64_tr_b16 a[194:195], v9 offset:128
  ds_read_b128 a[212:215], v10 offset:0
  ds_read_b64_tr_b16 a[196:197], v9 offset:1024
  ds_read_b64_tr_b16 a[198:199], v9 offset:1152
  ds_read_b128 a[216:219], v10 offset:512
  ds_read_b64_tr_b16 a[200:201], v9 offset:2048
  ds_read_b64_tr_b16 a[202:203], v9 offset:2176
  ds_read_b128 a[220:223], v10 offset:1024
  ds_read_b64_tr_b16 a[204:205], v9 offset:3072
  ds_read_b64_tr_b16 a[206:207], v9 offset:3200
  ds_read_b128 a[224:227], v10 offset:1536
  ds_read_b64_tr_b16 a[208:209], v9 offset:4096
  ds_read_b64_tr_b16 a[210:211], v9 offset:4224
  ds_read_b128 a[228:231], v10 offset:2048
  v_add_u32 v10, 2560, v10
  s_add_u32 s33, s33, 552960
  s_sub_u32 s14, s14, 1
  s_waitcnt lgkmcnt(12)
  v_mfma_f32_16x16x32_bf16 v[232:235], a[192:195], a[212:215], v[232:235]
  s_waitcnt lgkmcnt(9)
  v_mfma_f32_16x16x32_bf16 v[232:235], a[196:199], a[216:219], v[232:235]
  s_waitcnt lgkmcnt(6)
  v_mfma_f32_16x16x32_bf16 v[232:235], a[200:203], a[220:223], v[232:235]
  s_waitcnt lgkmcnt(3)
  v_mfma_f32_16x16x32_bf16 v[232:235], a[204:207], a[224:227], v[232:235]
  s_waitcnt lgkmcnt(0)
  v_mfma_f32_16x16x32_bf16 v[232:235], a[208:211], a[228:231], v[232:235]
  s_cmp_lg_u32 s14, 0
  s_cbranch_scc1 fa_coG
  v_accvgpr_read_b32 v8, a248
  v_accvgpr_read_b32 v11, a249
  v_accvgpr_read_b32 v12, a250
  v_accvgpr_read_b32 v13, a251
  v_accvgpr_read_b32 v14, a252
  v_subrev_u32 v11, 1024, v11
  v_subrev_u32 v12, 2048, v12
  v_subrev_u32 v13, 3072, v13
  s_mov_b32 s52, s60
  s_mov_b32 s53, s61
  s_mov_b32 s33, s35
  s_lshl_b32 s23, s20, 9
  v_add_u32 v16, s23, v10
  ds_write_b128 v16, v[232:235]
  v_and_b32 v17, 7, v1
  v_mul_u32_u24 v9, 2560, v17
  v_lshrrev_b32 v17, 4, v1
  v_lshl_add_u32 v9, v17, 4, v9
  v_and_b32 v17, 8, v1
  v_lshl_add_u32 v9, v17, 27, v9
  s_getpc_b64 s[36:37]
  s_setpc_b64 s[38:39]
  ds_read_b128 v[236:239], v10 offset:0
  ds_read_b128 v[240:243], v10 offset:512
  ds_read_b128 v[244:247], v10 offset:1024
  ds_read_b128 v[248:251], v10 offset:1536
  s_waitcnt vmcnt(4)
  ds_read_b64_tr_b16 a[192:193], v6 offset:0
  ds_read_b64_tr_b16 a[194:195], v6 offset:2560
  ds_read_b64_tr_b16 a[196:197], v6 offset:32
  ds_read_b64_tr_b16 a[198:199], v6 offset:2592
  ds_read_b64_tr_b16 a[200:201], v6 offset:64
  ds_read_b64_tr_b16 a[202:203], v6 offset:2624
  ds_read_b64_tr_b16 a[204:205], v6 offset:96
  ds_read_b64_tr_b16 a[206:207], v6 offset:2656
  ds_read_b64_tr_b16 a[208:209], v6 offset:128
  ds_read_b64_tr_b16 a[210:211], v6 offset:2688
  s_add_u32 s33, s33, 160
  s_mov_b32 s8, 0
  s_waitcnt lgkmcnt(10)
  v_cvt_pk_bf16_f32 v236, v236, v244
  v_cvt_pk_bf16_f32 v237, v237, v245
  v_cvt_pk_bf16_f32 v238, v238, v246
  v_cvt_pk_bf16_f32 v239, v239, v247
  v_cvt_pk_bf16_f32 v240, v240, v248
  v_cvt_pk_bf16_f32 v241, v241, v249
  v_cvt_pk_bf16_f32 v242, v242, v250
  v_cvt_pk_bf16_f32 v243, v243, v251
  v_lshlrev_b32 v244, 16, v236
  v_lshlrev_b32 v245, 16, v237
  v_lshlrev_b32 v246, 16, v238
  v_lshlrev_b32 v247, 16, v239
  v_lshlrev_b32 v248, 16, v240
  v_lshlrev_b32 v249, 16, v241
  v_lshlrev_b32 v250, 16, v242
  v_lshlrev_b32 v251, 16, v243
  v_mul_f32 v16, 0xbfb8aa3b, v244
  v_mul_f32 v17, 0xbfb8aa3b, v245
  v_mul_f32 v18, 0xbfb8aa3b, v246
  v_mul_f32 v19, 0xbfb8aa3b, v247
  v_mul_f32 v20, 0xbfb8aa3b, v248
  v_mul_f32 v21, 0xbfb8aa3b, v249
  v_mul_f32 v22, 0xbfb8aa3b, v250
  v_mul_f32 v23, 0xbfb8aa3b, v251
  v_exp_f32 v16, v16
  v_exp_f32 v17, v17
  v_exp_f32 v18, v18
  v_exp_f32 v19, v19
  v_exp_f32 v20, v20
  v_exp_f32 v21, v21
  v_exp_f32 v22, v22
  v_exp_f32 v23, v23
  v_add_f32 v16, 1.0, v16
  v_add_f32 v17, 1.0, v17
  v_add_f32 v18, 1.0, v18
  v_add_f32 v19, 1.0, v19
  v_add_f32 v20, 1.0, v20
  v_add_f32 v21, 1.0, v21
  v_add_f32 v22, 1.0, v22
  v_add_f32 v23, 1.0, v23
  v_rcp_f32 v16, v16
  v_rcp_f32 v17, v17
  v_rcp_f32 v18, v18
  v_rcp_f32 v19, v19
  v_rcp_f32 v20, v20
  v_rcp_f32 v21, v21
  v_rcp_f32 v22, v22
  v_rcp_f32 v23, v23
  v_mul_f32 v244, v244, v16
  v_mul_f32 v245, v245, v17
  v_mul_f32 v246, v246, v18
  v_mul_f32 v247, v247, v19
  v_mul_f32 v248, v248, v20
  v_mul_f32 v249, v249, v21
  v_mul_f32 v250, v250, v22
  v_mul_f32 v251, v251, v23
  v_cvt_pk_bf16_f32 v16, v244, v245
  v_cvt_pk_bf16_f32 v17, v246, v247
  v_cvt_pk_bf16_f32 v18, v248, v249
  v_cvt_pk_bf16_f32 v19, v250, v251
  v_and_b32 v236, 0xffff0000, v236
  v_and_b32 v237, 0xffff0000, v237
  v_and_b32 v238, 0xffff0000, v238
  v_and_b32 v239, 0xffff0000, v239
  v_and_b32 v240, 0xffff0000, v240
  v_and_b32 v241, 0xffff0000, v241
  v_and_b32 v242, 0xffff0000, v242
  v_and_b32 v243, 0xffff0000, v243
  v_lshlrev_b32 v244, 16, v16
  v_and_b32 v245, 0xffff0000, v16
  v_lshlrev_b32 v246, 16, v17
  v_and_b32 v247, 0xffff0000, v17
  v_lshlrev_b32 v248, 16, v18
  v_and_b32 v249, 0xffff0000, v18
  v_lshlrev_b32 v250, 16, v19
  v_and_b32 v251, 0xffff0000, v19
  v_mul_f32 v236, v236, v244
  v_mul_f32 v237, v237, v245
  v_mul_f32 v238, v238, v246
  v_mul_f32 v239, v239, v247
  v_mul_f32 v240, v240, v248
  v_mul_f32 v241, v241, v249
  v_mul_f32 v242, v242, v250
  v_mul_f32 v243, v243, v251
  v_cvt_pk_bf16_f32 v232, v236, v237
  v_cvt_pk_bf16_f32 v233, v238, v239
  v_cvt_pk_bf16_f32 v234, v240, v241
  v_cvt_pk_bf16_f32 v235, v242, v243
  s_nop 0
  s_waitcnt lgkmcnt(0)
  v_mfma_f32_16x16x32_bf16 v[236:239], a[192:195], v[232:235], 0
  v_mfma_f32_16x16x32_bf16 v[240:243], a[196:199], v[232:235], 0
  v_mfma_f32_16x16x32_bf16 v[244:247], a[200:203], v[232:235], 0
  v_mfma_f32_16x16x32_bf16 v[248:251], a[204:207], v[232:235], 0
  v_mfma_f32_16x16x32_bf16 v[252:255], a[208:211], v[232:235], 0
  s_nop 3
  buffer_store_dwordx4 v[236:239], v9, s[40:43], s10 offen offset:0 sc1
  buffer_store_dwordx4 v[240:243], v9, s[40:43], s10 offen offset:64 sc1
  buffer_store_dwordx4 v[244:247], v9, s[40:43], s10 offen offset:128 sc1
  buffer_store_dwordx4 v[248:251], v9, s[40:43], s10 offen offset:192 sc1
  buffer_store_dwordx4 v[252:255], v9, s[40:43], s10 offen offset:256 sc1
  s_add_u32 s10, s10, 320
  s_getpc_b64 s[36:37]
  s_setpc_b64 s[38:39]
  s_waitcnt vmcnt(4)
  ds_read_b64_tr_b16 a[192:193], v6 offset:0
  ds_read_b64_tr_b16 a[194:195], v6 offset:2560
  ds_read_b64_tr_b16 a[196:197], v6 offset:32
  ds_read_b64_tr_b16 a[198:199], v6 offset:2592
  ds_read_b64_tr_b16 a[200:201], v6 offset:64
  ds_read_b64_tr_b16 a[202:203], v6 offset:2624
  ds_read_b64_tr_b16 a[204:205], v6 offset:96
  ds_read_b64_tr_b16 a[206:207], v6 offset:2656
  ds_read_b64_tr_b16 a[208:209], v6 offset:128
  ds_read_b64_tr_b16 a[210:211], v6 offset:2688
  s_waitcnt lgkmcnt(0)
  v_mfma_f32_16x16x32_bf16 v[236:239], a[192:195], v[232:235], 0
  v_mfma_f32_16x16x32_bf16 v[240:243], a[196:199], v[232:235], 0
  v_mfma_f32_16x16x32_bf16 v[244:247], a[200:203], v[232:235], 0
  v_mfma_f32_16x16x32_bf16 v[248:251], a[204:207], v[232:235], 0
  v_mfma_f32_16x16x32_bf16 v[252:255], a[208:211], v[232:235], 0
  s_nop 3
  buffer_store_dwordx4 v[236:239], v9, s[40:43], s10 offen offset:0 sc1
  buffer_store_dwordx4 v[240:243], v9, s[40:43], s10 offen offset:64 sc1
  buffer_store_dwordx4 v[244:247], v9, s[40:43], s10 offen offset:128 sc1
  buffer_store_dwordx4 v[248:251], v9, s[40:43], s10 offen offset:192 sc1
  buffer_store_dwordx4 v[252:255], v9, s[40:43], s10 offen offset:256 sc1
  s_add_u32 s10, s10, 320
  s_getpc_b64 s[36:37]
  s_setpc_b64 s[38:39]
  s_and_b32 s23, s2, 63
  s_lshl_b32 s31, s20, 6
  s_add_u32 s23, s23, s31
  s_lshl_b32 s23, s23, 2
  s_add_u32 s23, s23, 2650112
  v_mov_b32 v16, 1073741824
  v_mov_b32 v17, 1
  v_writelane_b32 v16, s23, 0
  s_waitcnt vmcnt(8)
  buffer_store_dword v17, v16, s[40:43], 0 offen sc1
fa_coW:
  s_mov_b32 s12, 1
  s_mov_b32 s9, -1
  s_cmp_lg_u32 s11, 0
  s_cselect_b32 s32, s15, -1
  s_getpc_b64 s[36:37]
  s_setpc_b64 s[38:39]
  s_lshl_b32 s23, s22, 2
  s_add_u32 s23, s23, s20
  s_mul_i32 s13, s23, 163840
  s_add_u32 s13, s13, 4194304
  s_lshl_b32 s23, s23, 7
  s_add_u32 s23, s23, 2654208
  v_and_b32 v9, 31, v1
  v_lshl_add_u32 v9, v9, 2, s23
  v_and_b32 v10, 15, v1
  v_lshlrev_b32 v10, 2, v10
  v_add_u32 v10, 2629632, v10
  buffer_load_dword v8, v9, s[40:43], 0 offen sc1
  buffer_load_dword v15, v10, s[40:43], 0 offen sc1
  v_mov_b32 v20, v228
  v_mov_b32 v21, v229
  s_nop 1
  v_permlane16_swap_b32 v228, v20
  v_permlane16_swap_b32 v229, v21
  v_add_f32 v228, v228, v20
  v_add_f32 v229, v229, v21
  v_mov_b32 v20, v228
  v_mov_b32 v21, v229
  s_nop 1
  v_permlane32_swap_b32 v228, v20
  v_permlane32_swap_b32 v229, v21
  v_add_f32 v228, v228, v20
  v_add_f32 v229, v229, v21
  v_rcp_f32 v16, v228
  v_rcp_f32 v18, v229
  s_lshl_b32 s23, s22, 2
  v_mov_b32 v17, v16
  v_mov_b32 v19, v18
  s_add_u32 s23, s23, s20
  s_lshl_b32 s23, s23, 18
  s_lshl_b32 s31, s21, 12
  s_add_u32 s31, s31, 50331648
  s_add_u32 s64, s23, s31
  s_add_u32 s65, s64, 131072
  v_accvgpr_read_b32 v36, a0
  v_accvgpr_read_b32 v37, a1
  v_accvgpr_read_b32 v38, a2
  v_accvgpr_read_b32 v39, a3
  v_accvgpr_read_b32 v40, a8
  v_accvgpr_read_b32 v41, a9
  v_accvgpr_read_b32 v42, a10
  v_accvgpr_read_b32 v43, a11
  v_pk_mul_f32 v[36:37], v[36:37], v[16:17]
  v_pk_mul_f32 v[38:39], v[38:39], v[16:17]
  v_pk_mul_f32 v[40:41], v[40:41], v[16:17]
  v_pk_mul_f32 v[42:43], v[42:43], v[16:17]
  v_cvt_pk_bf16_f32 v32, v36, v37
  v_cvt_pk_bf16_f32 v33, v38, v39
  v_cvt_pk_bf16_f32 v34, v40, v41
  v_cvt_pk_bf16_f32 v35, v42, v43
  buffer_store_dwordx4 v[32:35], v2, s[40:43], s64 offen offset:0 sc1
  v_accvgpr_read_b32 v48, a16
  v_accvgpr_read_b32 v49, a17
  v_accvgpr_read_b32 v50, a18
  v_accvgpr_read_b32 v51, a19
  v_accvgpr_read_b32 v52, a24
  v_accvgpr_read_b32 v53, a25
  v_accvgpr_read_b32 v54, a26
  v_accvgpr_read_b32 v55, a27
  v_pk_mul_f32 v[48:49], v[48:49], v[16:17]
  v_pk_mul_f32 v[50:51], v[50:51], v[16:17]
  v_pk_mul_f32 v[52:53], v[52:53], v[16:17]
  v_pk_mul_f32 v[54:55], v[54:55], v[16:17]
  v_cvt_pk_bf16_f32 v44, v48, v49
  v_cvt_pk_bf16_f32 v45, v50, v51
  v_cvt_pk_bf16_f32 v46, v52, v53
  v_cvt_pk_bf16_f32 v47, v54, v55
  buffer_store_dwordx4 v[44:47], v2, s[40:43], s64 offen offset:1024 sc1
  v_accvgpr_read_b32 v100, a32
  v_accvgpr_read_b32 v101, a33
  v_accvgpr_read_b32 v102, a34
  v_accvgpr_read_b32 v103, a35
  v_accvgpr_read_b32 v104, a40
  v_accvgpr_read_b32 v105, a41
  v_accvgpr_read_b32 v106, a42
  v_accvgpr_read_b32 v107, a43
  v_pk_mul_f32 v[100:101], v[100:101], v[16:17]
  v_pk_mul_f32 v[102:103], v[102:103], v[16:17]
  v_pk_mul_f32 v[104:105], v[104:105], v[16:17]
  v_pk_mul_f32 v[106:107], v[106:107], v[16:17]
  v_cvt_pk_bf16_f32 v96, v100, v101
  v_cvt_pk_bf16_f32 v97, v102, v103
  v_cvt_pk_bf16_f32 v98, v104, v105
  v_cvt_pk_bf16_f32 v99, v106, v107
  buffer_store_dwordx4 v[96:99], v2, s[40:43], s64 offen offset:2048 sc1
  v_accvgpr_read_b32 v112, a48
  v_accvgpr_read_b32 v113, a49
  v_accvgpr_read_b32 v114, a50
  v_accvgpr_read_b32 v115, a51
  v_accvgpr_read_b32 v116, a56
  v_accvgpr_read_b32 v117, a57
  v_accvgpr_read_b32 v118, a58
  v_accvgpr_read_b32 v119, a59
  v_pk_mul_f32 v[112:113], v[112:113], v[16:17]
  v_pk_mul_f32 v[114:115], v[114:115], v[16:17]
  v_pk_mul_f32 v[116:117], v[116:117], v[16:17]
  v_pk_mul_f32 v[118:119], v[118:119], v[16:17]
  v_cvt_pk_bf16_f32 v108, v112, v113
  v_cvt_pk_bf16_f32 v109, v114, v115
  v_cvt_pk_bf16_f32 v110, v116, v117
  v_cvt_pk_bf16_f32 v111, v118, v119
  buffer_store_dwordx4 v[108:111], v2, s[40:43], s64 offen offset:3072 sc1
  v_accvgpr_read_b32 v36, a4
  v_accvgpr_read_b32 v37, a5
  v_accvgpr_read_b32 v38, a6
  v_accvgpr_read_b32 v39, a7
  v_accvgpr_read_b32 v40, a12
  v_accvgpr_read_b32 v41, a13
  v_accvgpr_read_b32 v42, a14
  v_accvgpr_read_b32 v43, a15
  v_pk_mul_f32 v[36:37], v[36:37], v[18:19]
  v_pk_mul_f32 v[38:39], v[38:39], v[18:19]
  v_pk_mul_f32 v[40:41], v[40:41], v[18:19]
  v_pk_mul_f32 v[42:43], v[42:43], v[18:19]
  v_cvt_pk_bf16_f32 v32, v36, v37
  v_cvt_pk_bf16_f32 v33, v38, v39
  v_cvt_pk_bf16_f32 v34, v40, v41
  v_cvt_pk_bf16_f32 v35, v42, v43
  buffer_store_dwordx4 v[32:35], v2, s[40:43], s65 offen offset:0 sc1
  v_accvgpr_read_b32 v48, a20
  v_accvgpr_read_b32 v49, a21
  v_accvgpr_read_b32 v50, a22
  v_accvgpr_read_b32 v51, a23
  v_accvgpr_read_b32 v52, a28
  v_accvgpr_read_b32 v53, a29
  v_accvgpr_read_b32 v54, a30
  v_accvgpr_read_b32 v55, a31
  v_pk_mul_f32 v[48:49], v[48:49], v[18:19]
  v_pk_mul_f32 v[50:51], v[50:51], v[18:19]
  v_pk_mul_f32 v[52:53], v[52:53], v[18:19]
  v_pk_mul_f32 v[54:55], v[54:55], v[18:19]
  v_cvt_pk_bf16_f32 v44, v48, v49
  v_cvt_pk_bf16_f32 v45, v50, v51
  v_cvt_pk_bf16_f32 v46, v52, v53
  v_cvt_pk_bf16_f32 v47, v54, v55
  buffer_store_dwordx4 v[44:47], v2, s[40:43], s65 offen offset:1024 sc1
  v_accvgpr_read_b32 v100, a36
  v_accvgpr_read_b32 v101, a37
  v_accvgpr_read_b32 v102, a38
  v_accvgpr_read_b32 v103, a39
  v_accvgpr_read_b32 v104, a44
  v_accvgpr_read_b32 v105, a45
  v_accvgpr_read_b32 v106, a46
  v_accvgpr_read_b32 v107, a47
  v_pk_mul_f32 v[100:101], v[100:101], v[18:19]
  v_pk_mul_f32 v[102:103], v[102:103], v[18:19]
  v_pk_mul_f32 v[104:105], v[104:105], v[18:19]
  v_pk_mul_f32 v[106:107], v[106:107], v[18:19]
  v_cvt_pk_bf16_f32 v96, v100, v101
  v_cvt_pk_bf16_f32 v97, v102, v103
  v_cvt_pk_bf16_f32 v98, v104, v105
  v_cvt_pk_bf16_f32 v99, v106, v107
  buffer_store_dwordx4 v[96:99], v2, s[40:43], s65 offen offset:2048 sc1
  v_accvgpr_read_b32 v112, a52
  v_accvgpr_read_b32 v113, a53
  v_accvgpr_read_b32 v114, a54
  v_accvgpr_read_b32 v115, a55
  v_accvgpr_read_b32 v116, a60
  v_accvgpr_read_b32 v117, a61
  v_accvgpr_read_b32 v118, a62
  v_accvgpr_read_b32 v119, a63
  v_pk_mul_f32 v[112:113], v[112:113], v[18:19]
  v_pk_mul_f32 v[114:115], v[114:115], v[18:19]
  v_pk_mul_f32 v[116:117], v[116:117], v[18:19]
  v_pk_mul_f32 v[118:119], v[118:119], v[18:19]
  v_cvt_pk_bf16_f32 v108, v112, v113
  v_cvt_pk_bf16_f32 v109, v114, v115
  v_cvt_pk_bf16_f32 v110, v116, v117
  v_cvt_pk_bf16_f32 v111, v118, v119
  buffer_store_dwordx4 v[108:111], v2, s[40:43], s65 offen offset:3072 sc1
  s_waitcnt vmcnt(8)
  v_cmp_eq_u32 vcc, 0, v8
  s_cbranch_vccnz fa_wof_spin
fa_wof_ok:
  v_cmp_eq_u32 vcc, 0, v15
  s_cbranch_vccnz fa_sel4_spin
fa_sel4_ok:
  s_lshl_b32 s23, s20, 1
  s_add_u32 s31, s23, 1
  v_readlane_b32 s33, v15, s23
  v_readlane_b32 s35, v15, s31
  s_lshl_b32 s31, s21, 6
  s_add_u32 s31, s31, 1
  s_sub_u32 s33, s33, s31
  s_sub_u32 s35, s35, s31
  s_cmp_lt_u32 s33, 64
  s_cselect_b32 s10, 1, 0
  s_cmp_lt_u32 s35, 64
  s_cselect_b32 s31, 2, 0
  s_or_b32 s10, s10, s31
  s_cbranch_scc0 fa_coEnd
  s_mov_b32 s12, 2
  s_mov_b32 s32, -1
  s_getpc_b64 s[36:37]
  s_setpc_b64 s[38:39]
  v_min_u32 v11, 53, v1
  s_lshr_b32 s23, s22, 1
  s_lshl_b32 s23, s23, 8
  s_add_u32 s23, s23, 2650112
  v_lshl_add_u32 v11, v11, 2, s23
  v_mov_b32 v14, 0
  v_cmp_eq_u32 vcc, 0, v14
  s_cbranch_vccnz fa_yf_spin
fa_yf_ok:
  v_mul_u32_u24 v16, 3277, v1
  v_lshrrev_b32 v16, 16, v16
  v_mul_u32_u24 v8, 20, v16
  v_sub_u32 v8, v1, v8
  v_lshlrev_b32 v8, 4, v8
  v_mul_u32_u24 v9, 368640, v16
  v_add_u32 v9, v9, v8
  v_cmp_gt_u32 vcc, 3, v16
  v_mov_b32 v19, 1073741824
  s_nop 0
  v_cndmask_b32 v9, v19, v9, vcc
fa_coY:
  s_ff1_i32_b32 s33, s10
  s_bitset0_b32 s10, s33
  s_lshl_b32 s23, s20, 1
  s_add_u32 s33, s33, s23
  s_mul_i32 s14, s33, 2560
  s_mul_i32 s23, s22, 320
  s_add_u32 s14, s14, s23
  s_add_u32 s14, s14, 2686976
  buffer_load_dwordx4 v[64:67], v9, s[40:43], s14 offen sc1
  s_add_u32 s14, s14, 20480
  buffer_load_dwordx4 v[68:71], v9, s[40:43], s14 offen sc1
  s_add_u32 s14, s14, 20480
  buffer_load_dwordx4 v[72:75], v9, s[40:43], s14 offen sc1
  s_add_u32 s14, s14, 20480
  buffer_load_dwordx4 v[76:79], v9, s[40:43], s14 offen sc1
  s_add_u32 s14, s14, 20480
  buffer_load_dwordx4 v[80:83], v9, s[40:43], s14 offen sc1
  s_add_u32 s14, s14, 20480
  buffer_load_dwordx4 v[84:87], v9, s[40:43], s14 offen sc1
  s_add_u32 s14, s14, 20480
  buffer_load_dwordx4 v[88:91], v9, s[40:43], s14 offen sc1
  s_add_u32 s14, s14, 20480
  buffer_load_dwordx4 v[92:95], v9, s[40:43], s14 offen sc1
  s_add_u32 s14, s14, 20480
  buffer_load_dwordx4 v[128:131], v9, s[40:43], s14 offen sc1
  s_add_u32 s14, s14, 20480
  buffer_load_dwordx4 v[132:135], v9, s[40:43], s14 offen sc1
  s_add_u32 s14, s14, 20480
  buffer_load_dwordx4 v[136:139], v9, s[40:43], s14 offen sc1
  s_add_u32 s14, s14, 20480
  buffer_load_dwordx4 v[140:143], v9, s[40:43], s14 offen sc1
  s_add_u32 s14, s14, 20480
  buffer_load_dwordx4 v[144:147], v9, s[40:43], s14 offen sc1
  s_add_u32 s14, s14, 20480
  buffer_load_dwordx4 v[148:151], v9, s[40:43], s14 offen sc1
  s_add_u32 s14, s14, 20480
  buffer_load_dwordx4 v[152:155], v9, s[40:43], s14 offen sc1
  s_add_u32 s14, s14, 20480
  buffer_load_dwordx4 v[156:159], v9, s[40:43], s14 offen sc1
  s_add_u32 s14, s14, 20480
  buffer_load_dwordx4 v[176:179], v9, s[40:43], s14 offen sc1
  s_add_u32 s14, s14, 20480
  buffer_load_dwordx4 v[180:183], v9, s[40:43], s14 offen sc1
  s_add_u32 s14, s14, 20480
  s_lshl_b32 s14, s20, 10
  s_add_u32 s14, s14, 135168
  v_add_u32 v19, s14, v2
  s_add_u32 s23, s33, 8
  v_readlane_b32 s35, v15, s23
  s_waitcnt vmcnt(0)
  v_pk_add_f32 v[64:65], v[64:65], v[68:69]
  v_pk_add_f32 v[66:67], v[66:67], v[70:71]
  v_pk_add_f32 v[64:65], v[64:65], v[72:73]
  v_pk_add_f32 v[66:67], v[66:67], v[74:75]
  v_pk_add_f32 v[64:65], v[64:65], v[76:77]
  v_pk_add_f32 v[66:67], v[66:67], v[78:79]
  v_pk_add_f32 v[64:65], v[64:65], v[80:81]
  v_pk_add_f32 v[66:67], v[66:67], v[82:83]
  v_pk_add_f32 v[64:65], v[64:65], v[84:85]
  v_pk_add_f32 v[66:67], v[66:67], v[86:87]
  v_pk_add_f32 v[64:65], v[64:65], v[88:89]
  v_pk_add_f32 v[66:67], v[66:67], v[90:91]
  v_pk_add_f32 v[64:65], v[64:65], v[92:93]
  v_pk_add_f32 v[66:67], v[66:67], v[94:95]
  v_pk_add_f32 v[64:65], v[64:65], v[128:129]
  v_pk_add_f32 v[66:67], v[66:67], v[130:131]
  v_pk_add_f32 v[64:65], v[64:65], v[132:133]
  v_pk_add_f32 v[66:67], v[66:67], v[134:135]
  v_pk_add_f32 v[64:65], v[64:65], v[136:137]
  v_pk_add_f32 v[66:67], v[66:67], v[138:139]
  v_pk_add_f32 v[64:65], v[64:65], v[140:141]
  v_pk_add_f32 v[66:67], v[66:67], v[142:143]
  v_pk_add_f32 v[64:65], v[64:65], v[144:145]
  v_pk_add_f32 v[66:67], v[66:67], v[146:147]
  v_pk_add_f32 v[64:65], v[64:65], v[148:149]
  v_pk_add_f32 v[66:67], v[66:67], v[150:151]
  v_pk_add_f32 v[64:65], v[64:65], v[152:153]
  v_pk_add_f32 v[66:67], v[66:67], v[154:155]
  v_pk_add_f32 v[64:65], v[64:65], v[156:157]
  v_pk_add_f32 v[66:67], v[66:67], v[158:159]
  v_pk_add_f32 v[64:65], v[64:65], v[176:177]
  v_pk_add_f32 v[66:67], v[66:67], v[178:179]
  v_pk_add_f32 v[64:65], v[64:65], v[180:181]
  v_pk_add_f32 v[66:67], v[66:67], v[182:183]
  ds_write_b128 v19, v[64:67]
  v_add_u32 v19, s14, v8
  s_and_b32 s35, s35, 0xffff0000
  s_waitcnt lgkmcnt(0)
  ds_read_b128 v[64:67], v19
  ds_read_b128 v[68:71], v19 offset:320
  ds_read_b128 v[72:75], v19 offset:640
  s_mul_i32 s14, s33, 320
  s_add_u32 s14, s14, 131072
  v_add_u32 v19, s14, v8
  s_waitcnt lgkmcnt(0)
  v_add_f32 v64, v64, v68
  v_add_f32 v64, v64, v72
  v_cvt_pk_bf16_f32 v64, v64, v64
  v_and_b32 v64, 0xffff0000, v64
  v_mul_f32 v64, s35, v64
  v_cvt_pk_bf16_f32 v64, v64, v64
  v_and_b32 v64, 0xffff0000, v64
  v_add_f32 v65, v65, v69
  v_add_f32 v65, v65, v73
  v_cvt_pk_bf16_f32 v65, v65, v65
  v_and_b32 v65, 0xffff0000, v65
  v_mul_f32 v65, s35, v65
  v_cvt_pk_bf16_f32 v65, v65, v65
  v_and_b32 v65, 0xffff0000, v65
  v_add_f32 v66, v66, v70
  v_add_f32 v66, v66, v74
  v_cvt_pk_bf16_f32 v66, v66, v66
  v_and_b32 v66, 0xffff0000, v66
  v_mul_f32 v66, s35, v66
  v_cvt_pk_bf16_f32 v66, v66, v66
  v_and_b32 v66, 0xffff0000, v66
  v_add_f32 v67, v67, v71
  v_add_f32 v67, v67, v75
  v_cvt_pk_bf16_f32 v67, v67, v67
  v_and_b32 v67, 0xffff0000, v67
  v_mul_f32 v67, s35, v67
  v_cvt_pk_bf16_f32 v67, v67, v67
  v_and_b32 v67, 0xffff0000, v67
  ds_write_b128 v19, v[64:67]
  s_waitcnt lgkmcnt(0)
  s_cmp_lg_u32 s10, 0
  s_cbranch_scc1 fa_coY
fa_coEnd:
  s_mov_b32 s12, 3
  s_mov_b32 s32, -1
  s_setpc_b64 s[38:39]
fa_hk3:
  s_getpc_b64 s[38:39]
fa_hp3:
  s_add_u32 s36, s36, 4
  s_addc_u32 s37, s37, 0
  s_sub_u32 s38, s38, fa_hp3-fa_hb3
  s_subb_u32 s39, s39, 0
  s_setpc_b64 s[36:37]
fa_hk4:
  s_getpc_b64 s[38:39]
fa_hp4:
  s_add_u32 s36, s36, 4
  s_addc_u32 s37, s37, 0
  s_sub_u32 s38, s38, fa_hp4-fa_hb4
  s_subb_u32 s39, s39, 0
  s_setpc_b64 s[36:37]
fa_disp:
  s_cmp_eq_u32 s29, 7
  s_cbranch_scc1 fa_SSW7
  s_cmp_eq_u32 s29, 6
  s_cbranch_scc1 fa_SSW6
  s_cmp_eq_u32 s29, 5
  s_cbranch_scc1 fa_SSW5
  s_cmp_eq_u32 s29, 4
  s_cbranch_scc1 fa_SSW4
  s_cmp_eq_u32 s29, 3
  s_cbranch_scc1 fa_SSW3
  s_cmp_eq_u32 s29, 2
  s_cbranch_scc1 fa_SSW2
  s_cmp_eq_u32 s29, 1
  s_cbranch_scc1 fa_SSW1
  s_branch fa_Bexit
fa_left:
  s_add_u32 s14, s13, 0
  buffer_load_dwordx4 a[0:3], v2, s[40:43], s14 offen offset:0 sc1
  buffer_load_dwordx4 a[4:7], v2, s[40:43], s14 offen offset:1024 sc1
  buffer_load_dwordx4 a[8:11], v2, s[40:43], s14 offen offset:2048 sc1
  buffer_load_dwordx4 a[12:15], v2, s[40:43], s14 offen offset:3072 sc1
  s_add_u32 s14, s13, 4096
  buffer_load_dwordx4 a[16:19], v2, s[40:43], s14 offen offset:0 sc1
  buffer_load_dwordx4 a[20:23], v2, s[40:43], s14 offen offset:1024 sc1
  s_cmp_ge_u32 s29, 7
  s_cbranch_scc1 fa_leftb
  s_add_u32 s14, s13, 4096
  buffer_load_dwordx4 a[24:27], v2, s[40:43], s14 offen offset:2048 sc1
  buffer_load_dwordx4 a[28:31], v2, s[40:43], s14 offen offset:3072 sc1
  s_add_u32 s14, s13, 8192
  buffer_load_dwordx4 a[32:35], v2, s[40:43], s14 offen offset:0 sc1
  buffer_load_dwordx4 a[36:39], v2, s[40:43], s14 offen offset:1024 sc1
  buffer_load_dwordx4 a[40:43], v2, s[40:43], s14 offen offset:2048 sc1
  buffer_load_dwordx4 a[44:47], v2, s[40:43], s14 offen offset:3072 sc1
  s_cmp_ge_u32 s29, 6
  s_cbranch_scc1 fa_leftb
  s_add_u32 s14, s13, 12288
  buffer_load_dwordx4 a[48:51], v2, s[40:43], s14 offen offset:0 sc1
  buffer_load_dwordx4 a[52:55], v2, s[40:43], s14 offen offset:1024 sc1
  buffer_load_dwordx4 a[56:59], v2, s[40:43], s14 offen offset:2048 sc1
  buffer_load_dwordx4 a[60:63], v2, s[40:43], s14 offen offset:3072 sc1
  s_add_u32 s14, s13, 16384
  buffer_load_dwordx4 a[192:195], v2, s[40:43], s14 offen offset:0 sc1
  buffer_load_dwordx4 a[196:199], v2, s[40:43], s14 offen offset:1024 sc1
  s_cmp_ge_u32 s29, 5
  s_cbranch_scc1 fa_leftb
  s_add_u32 s14, s13, 16384
  buffer_load_dwordx4 a[200:203], v2, s[40:43], s14 offen offset:2048 sc1
  buffer_load_dwordx4 a[204:207], v2, s[40:43], s14 offen offset:3072 sc1
  s_add_u32 s14, s13, 20480
  buffer_load_dwordx4 a[208:211], v2, s[40:43], s14 offen offset:0 sc1
  buffer_load_dwordx4 a[212:215], v2, s[40:43], s14 offen offset:1024 sc1
  buffer_load_dwordx4 a[216:219], v2, s[40:43], s14 offen offset:2048 sc1
  buffer_load_dwordx4 a[220:223], v2, s[40:43], s14 offen offset:3072 sc1
  s_cmp_ge_u32 s29, 4
  s_cbranch_scc1 fa_leftb
  s_add_u32 s14, s13, 24576
  buffer_load_dwordx4 a[224:227], v2, s[40:43], s14 offen offset:0 sc1
  buffer_load_dwordx4 a[228:231], v2, s[40:43], s14 offen offset:1024 sc1
  buffer_load_dwordx4 a[232:235], v2, s[40:43], s14 offen offset:2048 sc1
  buffer_load_dwordx4 a[236:239], v2, s[40:43], s14 offen offset:3072 sc1
  s_add_u32 s14, s13, 28672
  buffer_load_dwordx4 a[240:243], v2, s[40:43], s14 offen offset:0 sc1
  buffer_load_dwordx4 a[244:247], v2, s[40:43], s14 offen offset:1024 sc1
  s_cmp_ge_u32 s29, 3
  s_cbranch_scc1 fa_leftb
  s_add_u32 s14, s13, 28672
  buffer_load_dwordx4 a[248:251], v2, s[40:43], s14 offen offset:2048 sc1
  buffer_load_dwordx4 a[252:255], v2, s[40:43], s14 offen offset:3072 sc1
  s_add_u32 s14, s13, 32768
  buffer_load_dwordx4 v[32:35], v2, s[40:43], s14 offen offset:0 sc1
  buffer_load_dwordx4 v[36:39], v2, s[40:43], s14 offen offset:1024 sc1
  buffer_load_dwordx4 v[40:43], v2, s[40:43], s14 offen offset:2048 sc1
  buffer_load_dwordx4 v[44:47], v2, s[40:43], s14 offen offset:3072 sc1
  s_cmp_ge_u32 s29, 2
  s_cbranch_scc1 fa_leftb
  s_add_u32 s14, s13, 36864
  buffer_load_dwordx4 v[48:51], v2, s[40:43], s14 offen offset:0 sc1
  buffer_load_dwordx4 v[52:55], v2, s[40:43], s14 offen offset:1024 sc1
  buffer_load_dwordx4 v[56:59], v2, s[40:43], s14 offen offset:2048 sc1
  buffer_load_dwordx4 v[60:63], v2, s[40:43], s14 offen offset:3072 sc1
  s_add_u32 s14, s13, 40960
  buffer_load_dwordx4 v[96:99], v2, s[40:43], s14 offen offset:0 sc1
  buffer_load_dwordx4 v[100:103], v2, s[40:43], s14 offen offset:1024 sc1
  s_cmp_ge_u32 s29, 1
  s_cbranch_scc1 fa_leftb
  s_add_u32 s14, s13, 40960
  buffer_load_dwordx4 v[104:107], v2, s[40:43], s14 offen offset:2048 sc1
  buffer_load_dwordx4 v[108:111], v2, s[40:43], s14 offen offset:3072 sc1
  s_add_u32 s14, s13, 45056
  buffer_load_dwordx4 v[112:115], v2, s[40:43], s14 offen offset:0 sc1
  buffer_load_dwordx4 v[116:119], v2, s[40:43], s14 offen offset:1024 sc1
  buffer_load_dwordx4 v[120:123], v2, s[40:43], s14 offen offset:2048 sc1
  buffer_load_dwordx4 v[124:127], v2, s[40:43], s14 offen offset:3072 sc1
  s_branch fa_leftb
fa_hk5:
  s_getpc_b64 s[38:39]
fa_hp5:
  s_add_u32 s36, s36, 4
  s_addc_u32 s37, s37, 0
  s_sub_u32 s38, s38, fa_hp5-fa_hb5
  s_subb_u32 s39, s39, 0
  s_setpc_b64 s[36:37]
fa_ctx_spin:
  s_mov_b32 s83, 200000
fa_ctx_spin2:
  buffer_load_dword v13, v12, s[40:43], 0 offen sc1
  s_waitcnt vmcnt(0)
  v_cmp_eq_u32 vcc, 0, v13
  s_cbranch_vccz fa_ctx_ok
  s_sleep 8
  s_sub_u32 s83, s83, 1
  s_cmp_lg_u32 s83, 0
  s_cbranch_scc1 fa_ctx_spin2
  s_branch fa_ctx_ok
fa_stub0:
  s_call_b64 s[76:77], fa_rare00
  s_call_b64 s[76:77], fa_rare10
  s_branch fa_back0
fa_stub1:
  s_call_b64 s[76:77], fa_rare01
  s_call_b64 s[76:77], fa_rare11
  s_branch fa_back1
fa_stub2:
  s_call_b64 s[76:77], fa_rare00
  s_call_b64 s[76:77], fa_rare10
  s_branch fa_back2
fa_stub3:
  s_call_b64 s[76:77], fa_rare01
  s_call_b64 s[76:77], fa_rare11
  s_branch fa_back3
fa_stub4:
  s_call_b64 s[76:77], fa_rare01
  s_call_b64 s[76:77], fa_rare11
  s_branch fa_back4
fa_stub5:
  s_call_b64 s[76:77], fa_rare00
  s_call_b64 s[76:77], fa_rare10
  s_branch fa_back5
fa_stub6:
  s_call_b64 s[76:77], fa_rare11
  s_branch fa_back6
fa_stub7:
  s_call_b64 s[76:77], fa_rare10
  s_branch fa_back7
fa_stub8:
  s_call_b64 s[76:77], fa_rare01
  s_call_b64 s[76:77], fa_rare11
  s_branch fa_back8
fa_stub9:
  s_call_b64 s[76:77], fa_rare10
  s_branch fa_back9
fa_stub10:
  s_call_b64 s[76:77], fa_rare11
  s_branch fa_back10
fa_stub11:
  s_call_b64 s[76:77], fa_rare10
  s_branch fa_back11
fa_stub12:
  s_call_b64 s[76:77], fa_rare11
  s_branch fa_back12
fa_stub13:
  s_call_b64 s[76:77], fa_rare10
  s_branch fa_back13
fa_stub14:
  s_call_b64 s[76:77], fa_rare11
  s_branch fa_back14
fa_stub15:
  s_call_b64 s[76:77], fa_rare10
  s_branch fa_back15
fa_stub16:
  s_call_b64 s[76:77], fa_rare11
  s_branch fa_back16
fa_stub17:
  s_call_b64 s[76:77], fa_rare10
  s_branch fa_back17
fa_stub18:
  s_call_b64 s[76:77], fa_rare11
  s_branch fa_back18
fa_stub19:
  s_call_b64 s[76:77], fa_rare10
  s_branch fa_back19
fa_stub20:
  s_call_b64 s[76:77], fa_rare11
  s_branch fa_back20
fa_stub21:
  s_call_b64 s[76:77], fa_rare10
  s_branch fa_back21
fa_stub22:
  s_call_b64 s[76:77], fa_rare11
  s_branch fa_back22
fa_stub23:
  s_call_b64 s[76:77], fa_rare10
  s_branch fa_back23
fa_stub24:
  s_call_b64 s[76:77], fa_rare11
  s_branch fa_back24
fa_stub25:
  s_call_b64 s[76:77], fa_rare10
  s_branch fa_back25
fa_stub26:
  s_call_b64 s[76:77], fa_rare11
  s_branch fa_back26
fa_stub27:
  s_call_b64 s[76:77], fa_rare10
  s_branch fa_back27
fa_stub28:
  s_call_b64 s[76:77], fa_rare11
  s_branch fa_back28
fa_stub29:
  s_call_b64 s[76:77], fa_rare10
  s_branch fa_back29
fa_stub30:
  s_call_b64 s[76:77], fa_rare11
  s_branch fa_back30
fa_codeend:
fa_rare00:
  s_nop 7
  v_max3_f32 v16, v96, v97, v98
  v_max3_f32 v16, v16, v99, v100
  v_max3_f32 v16, v16, v101, v102
  v_max3_f32 v16, v16, v103, 0
  v_mov_b32 v18, v16
  s_nop 1
  v_permlane16_swap_b32 v16, v18
  v_max_f32 v16, v16, v18
  v_mov_b32 v18, v16
  s_nop 1
  v_permlane32_swap_b32 v16, v18
  v_max_f32 v16, v16, v18
  v_sub_f32 v96, v96, v16
  v_sub_f32 v112, v112, v16
  v_sub_f32 v97, v97, v16
  v_sub_f32 v113, v113, v16
  v_sub_f32 v98, v98, v16
  v_sub_f32 v114, v114, v16
  v_sub_f32 v99, v99, v16
  v_sub_f32 v115, v115, v16
  v_sub_f32 v100, v100, v16
  v_sub_f32 v116, v116, v16
  v_sub_f32 v101, v101, v16
  v_sub_f32 v117, v117, v16
  v_sub_f32 v102, v102, v16
  v_sub_f32 v118, v118, v16
  v_sub_f32 v103, v103, v16
  v_sub_f32 v119, v119, v16
  v_max3_f32 v17, v104, v105, v106
  v_max3_f32 v17, v17, v107, v108
  v_max3_f32 v17, v17, v109, v110
  v_max3_f32 v17, v17, v111, 0
  v_mov_b32 v18, v17
  s_nop 1
  v_permlane16_swap_b32 v17, v18
  v_max_f32 v17, v17, v18
  v_mov_b32 v18, v17
  s_nop 1
  v_permlane32_swap_b32 v17, v18
  v_max_f32 v17, v17, v18
  v_sub_f32 v104, v104, v17
  v_sub_f32 v120, v120, v17
  v_sub_f32 v105, v105, v17
  v_sub_f32 v121, v121, v17
  v_sub_f32 v106, v106, v17
  v_sub_f32 v122, v122, v17
  v_sub_f32 v107, v107, v17
  v_sub_f32 v123, v123, v17
  v_sub_f32 v108, v108, v17
  v_sub_f32 v124, v124, v17
  v_sub_f32 v109, v109, v17
  v_sub_f32 v125, v125, v17
  v_sub_f32 v110, v110, v17
  v_sub_f32 v126, v126, v17
  v_sub_f32 v111, v111, v17
  v_sub_f32 v127, v127, v17
  s_call_b64 s[78:79], fa_resc0
  v_exp_f32 v208, v96
  v_exp_f32 v209, v97
  v_exp_f32 v210, v98
  v_add_f32 v224, v208, v209
  v_cvt_pk_bf16_f32 v160, v208, v209
  v_exp_f32 v211, v99
  v_add_f32 v224, v224, v210
  v_exp_f32 v212, v100
  v_add_f32 v224, v224, v211
  v_cvt_pk_bf16_f32 v161, v210, v211
  v_exp_f32 v213, v101
  v_add_f32 v224, v224, v212
  v_exp_f32 v214, v102
  v_add_f32 v224, v224, v213
  v_cvt_pk_bf16_f32 v162, v212, v213
  v_exp_f32 v215, v103
  v_add_f32 v224, v224, v214
  v_exp_f32 v208, v104
  v_add_f32 v224, v224, v215
  v_cvt_pk_bf16_f32 v163, v214, v215
  v_exp_f32 v209, v105
  v_exp_f32 v210, v106
  v_add_f32 v225, v208, v209
  v_cvt_pk_bf16_f32 v164, v208, v209
  v_exp_f32 v211, v107
  v_add_f32 v225, v225, v210
  v_exp_f32 v212, v108
  v_add_f32 v225, v225, v211
  v_cvt_pk_bf16_f32 v165, v210, v211
  v_exp_f32 v213, v109
  v_add_f32 v225, v225, v212
  v_exp_f32 v214, v110
  v_add_f32 v225, v225, v213
  v_cvt_pk_bf16_f32 v166, v212, v213
  v_exp_f32 v215, v111
  v_add_f32 v225, v225, v214
  s_nop 0
  v_add_f32 v225, v225, v215
  v_cvt_pk_bf16_f32 v167, v214, v215
  s_nop 1
  s_setpc_b64 s[76:77]
fa_rare01:
  s_nop 7
  v_max3_f32 v16, v112, v113, v114
  v_max3_f32 v16, v16, v115, v116
  v_max3_f32 v16, v16, v117, v118
  v_max3_f32 v16, v16, v119, 0
  v_mov_b32 v18, v16
  s_nop 1
  v_permlane16_swap_b32 v16, v18
  v_max_f32 v16, v16, v18
  v_mov_b32 v18, v16
  s_nop 1
  v_permlane32_swap_b32 v16, v18
  v_max_f32 v16, v16, v18
  v_sub_f32 v112, v112, v16
  v_sub_f32 v96, v96, v16
  v_sub_f32 v113, v113, v16
  v_sub_f32 v97, v97, v16
  v_sub_f32 v114, v114, v16
  v_sub_f32 v98, v98, v16
  v_sub_f32 v115, v115, v16
  v_sub_f32 v99, v99, v16
  v_sub_f32 v116, v116, v16
  v_sub_f32 v100, v100, v16
  v_sub_f32 v117, v117, v16
  v_sub_f32 v101, v101, v16
  v_sub_f32 v118, v118, v16
  v_sub_f32 v102, v102, v16
  v_sub_f32 v119, v119, v16
  v_sub_f32 v103, v103, v16
  v_max3_f32 v17, v120, v121, v122
  v_max3_f32 v17, v17, v123, v124
  v_max3_f32 v17, v17, v125, v126
  v_max3_f32 v17, v17, v127, 0
  v_mov_b32 v18, v17
  s_nop 1
  v_permlane16_swap_b32 v17, v18
  v_max_f32 v17, v17, v18
  v_mov_b32 v18, v17
  s_nop 1
  v_permlane32_swap_b32 v17, v18
  v_max_f32 v17, v17, v18
  v_sub_f32 v120, v120, v17
  v_sub_f32 v104, v104, v17
  v_sub_f32 v121, v121, v17
  v_sub_f32 v105, v105, v17
  v_sub_f32 v122, v122, v17
  v_sub_f32 v106, v106, v17
  v_sub_f32 v123, v123, v17
  v_sub_f32 v107, v107, v17
  v_sub_f32 v124, v124, v17
  v_sub_f32 v108, v108, v17
  v_sub_f32 v125, v125, v17
  v_sub_f32 v109, v109, v17
  v_sub_f32 v126, v126, v17
  v_sub_f32 v110, v110, v17
  v_sub_f32 v127, v127, v17
  v_sub_f32 v111, v111, v17
  s_call_b64 s[78:79], fa_resc0
  v_exp_f32 v208, v112
  v_exp_f32 v209, v113
  v_exp_f32 v210, v114
  v_add_f32 v224, v208, v209
  v_cvt_pk_bf16_f32 v168, v208, v209
  v_exp_f32 v211, v115
  v_add_f32 v224, v224, v210
  v_exp_f32 v212, v116
  v_add_f32 v224, v224, v211
  v_cvt_pk_bf16_f32 v169, v210, v211
  v_exp_f32 v213, v117
  v_add_f32 v224, v224, v212
  v_exp_f32 v214, v118
  v_add_f32 v224, v224, v213
  v_cvt_pk_bf16_f32 v170, v212, v213
  v_exp_f32 v215, v119
  v_add_f32 v224, v224, v214
  v_exp_f32 v208, v120
  v_add_f32 v224, v224, v215
  v_cvt_pk_bf16_f32 v171, v214, v215
  v_exp_f32 v209, v121
  v_exp_f32 v210, v122
  v_add_f32 v225, v208, v209
  v_cvt_pk_bf16_f32 v172, v208, v209
  v_exp_f32 v211, v123
  v_add_f32 v225, v225, v210
  v_exp_f32 v212, v124
  v_add_f32 v225, v225, v211
  v_cvt_pk_bf16_f32 v173, v210, v211
  v_exp_f32 v213, v125
  v_add_f32 v225, v225, v212
  v_exp_f32 v214, v126
  v_add_f32 v225, v225, v213
  v_cvt_pk_bf16_f32 v174, v212, v213
  v_exp_f32 v215, v127
  v_add_f32 v225, v225, v214
  s_nop 0
  v_add_f32 v225, v225, v215
  v_cvt_pk_bf16_f32 v175, v214, v215
  s_nop 1
  s_setpc_b64 s[76:77]
fa_resc0:
  v_sub_f32 v192, v192, v16
  v_sub_f32 v193, v193, v16
  v_sub_f32 v194, v194, v16
  v_sub_f32 v195, v195, v16
  v_exp_f32 v18, -v16
  v_sub_f32 v196, v196, v17
  v_sub_f32 v197, v197, v17
  v_sub_f32 v198, v198, v17
  v_sub_f32 v199, v199, v17
  v_exp_f32 v19, -v17
  s_nop 0
  v_mul_f32 v228, v228, v18
  v_mul_f32 v229, v229, v19
  v_accvgpr_read_b32 v20, a0
  v_accvgpr_read_b32 v21, a1
  v_accvgpr_read_b32 v22, a2
  v_accvgpr_read_b32 v23, a3
  v_mul_f32 v20, v20, v18
  v_mul_f32 v21, v21, v18
  v_mul_f32 v22, v22, v18
  v_mul_f32 v23, v23, v18
  v_accvgpr_write_b32 a0, v20
  v_accvgpr_write_b32 a1, v21
  v_accvgpr_write_b32 a2, v22
  v_accvgpr_write_b32 a3, v23
  v_accvgpr_read_b32 v20, a4
  v_accvgpr_read_b32 v21, a5
  v_accvgpr_read_b32 v22, a6
  v_accvgpr_read_b32 v23, a7
  v_mul_f32 v20, v20, v19
  v_mul_f32 v21, v21, v19
  v_mul_f32 v22, v22, v19
  v_mul_f32 v23, v23, v19
  v_accvgpr_write_b32 a4, v20
  v_accvgpr_write_b32 a5, v21
  v_accvgpr_write_b32 a6, v22
  v_accvgpr_write_b32 a7, v23
  v_accvgpr_read_b32 v20, a8
  v_accvgpr_read_b32 v21, a9
  v_accvgpr_read_b32 v22, a10
  v_accvgpr_read_b32 v23, a11
  v_mul_f32 v20, v20, v18
  v_mul_f32 v21, v21, v18
  v_mul_f32 v22, v22, v18
  v_mul_f32 v23, v23, v18
  v_accvgpr_write_b32 a8, v20
  v_accvgpr_write_b32 a9, v21
  v_accvgpr_write_b32 a10, v22
  v_accvgpr_write_b32 a11, v23
  v_accvgpr_read_b32 v20, a12
  v_accvgpr_read_b32 v21, a13
  v_accvgpr_read_b32 v22, a14
  v_accvgpr_read_b32 v23, a15
  v_mul_f32 v20, v20, v19
  v_mul_f32 v21, v21, v19
  v_mul_f32 v22, v22, v19
  v_mul_f32 v23, v23, v19
  v_accvgpr_write_b32 a12, v20
  v_accvgpr_write_b32 a13, v21
  v_accvgpr_write_b32 a14, v22
  v_accvgpr_write_b32 a15, v23
  v_accvgpr_read_b32 v20, a16
  v_accvgpr_read_b32 v21, a17
  v_accvgpr_read_b32 v22, a18
  v_accvgpr_read_b32 v23, a19
  v_mul_f32 v20, v20, v18
  v_mul_f32 v21, v21, v18
  v_mul_f32 v22, v22, v18
  v_mul_f32 v23, v23, v18
  v_accvgpr_write_b32 a16, v20
  v_accvgpr_write_b32 a17, v21
  v_accvgpr_write_b32 a18, v22
  v_accvgpr_write_b32 a19, v23
  v_accvgpr_read_b32 v20, a20
  v_accvgpr_read_b32 v21, a21
  v_accvgpr_read_b32 v22, a22
  v_accvgpr_read_b32 v23, a23
  v_mul_f32 v20, v20, v19
  v_mul_f32 v21, v21, v19
  v_mul_f32 v22, v22, v19
  v_mul_f32 v23, v23, v19
  v_accvgpr_write_b32 a20, v20
  v_accvgpr_write_b32 a21, v21
  v_accvgpr_write_b32 a22, v22
  v_accvgpr_write_b32 a23, v23
  v_accvgpr_read_b32 v20, a24
  v_accvgpr_read_b32 v21, a25
  v_accvgpr_read_b32 v22, a26
  v_accvgpr_read_b32 v23, a27
  v_mul_f32 v20, v20, v18
  v_mul_f32 v21, v21, v18
  v_mul_f32 v22, v22, v18
  v_mul_f32 v23, v23, v18
  v_accvgpr_write_b32 a24, v20
  v_accvgpr_write_b32 a25, v21
  v_accvgpr_write_b32 a26, v22
  v_accvgpr_write_b32 a27, v23
  v_accvgpr_read_b32 v20, a28
  v_accvgpr_read_b32 v21, a29
  v_accvgpr_read_b32 v22, a30
  v_accvgpr_read_b32 v23, a31
  v_mul_f32 v20, v20, v19
  v_mul_f32 v21, v21, v19
  v_mul_f32 v22, v22, v19
  v_mul_f32 v23, v23, v19
  v_accvgpr_write_b32 a28, v20
  v_accvgpr_write_b32 a29, v21
  v_accvgpr_write_b32 a30, v22
  v_accvgpr_write_b32 a31, v23
  v_accvgpr_read_b32 v20, a32
  v_accvgpr_read_b32 v21, a33
  v_accvgpr_read_b32 v22, a34
  v_accvgpr_read_b32 v23, a35
  v_mul_f32 v20, v20, v18
  v_mul_f32 v21, v21, v18
  v_mul_f32 v22, v22, v18
  v_mul_f32 v23, v23, v18
  v_accvgpr_write_b32 a32, v20
  v_accvgpr_write_b32 a33, v21
  v_accvgpr_write_b32 a34, v22
  v_accvgpr_write_b32 a35, v23
  v_accvgpr_read_b32 v20, a36
  v_accvgpr_read_b32 v21, a37
  v_accvgpr_read_b32 v22, a38
  v_accvgpr_read_b32 v23, a39
  v_mul_f32 v20, v20, v19
  v_mul_f32 v21, v21, v19
  v_mul_f32 v22, v22, v19
  v_mul_f32 v23, v23, v19
  v_accvgpr_write_b32 a36, v20
  v_accvgpr_write_b32 a37, v21
  v_accvgpr_write_b32 a38, v22
  v_accvgpr_write_b32 a39, v23
  v_accvgpr_read_b32 v20, a40
  v_accvgpr_read_b32 v21, a41
  v_accvgpr_read_b32 v22, a42
  v_accvgpr_read_b32 v23, a43
  v_mul_f32 v20, v20, v18
  v_mul_f32 v21, v21, v18
  v_mul_f32 v22, v22, v18
  v_mul_f32 v23, v23, v18
  v_accvgpr_write_b32 a40, v20
  v_accvgpr_write_b32 a41, v21
  v_accvgpr_write_b32 a42, v22
  v_accvgpr_write_b32 a43, v23
  v_accvgpr_read_b32 v20, a44
  v_accvgpr_read_b32 v21, a45
  v_accvgpr_read_b32 v22, a46
  v_accvgpr_read_b32 v23, a47
  v_mul_f32 v20, v20, v19
  v_mul_f32 v21, v21, v19
  v_mul_f32 v22, v22, v19
  v_mul_f32 v23, v23, v19
  v_accvgpr_write_b32 a44, v20
  v_accvgpr_write_b32 a45, v21
  v_accvgpr_write_b32 a46, v22
  v_accvgpr_write_b32 a47, v23
  v_accvgpr_read_b32 v20, a48
  v_accvgpr_read_b32 v21, a49
  v_accvgpr_read_b32 v22, a50
  v_accvgpr_read_b32 v23, a51
  v_mul_f32 v20, v20, v18
  v_mul_f32 v21, v21, v18
  v_mul_f32 v22, v22, v18
  v_mul_f32 v23, v23, v18
  v_accvgpr_write_b32 a48, v20
  v_accvgpr_write_b32 a49, v21
  v_accvgpr_write_b32 a50, v22
  v_accvgpr_write_b32 a51, v23
  v_accvgpr_read_b32 v20, a52
  v_accvgpr_read_b32 v21, a53
  v_accvgpr_read_b32 v22, a54
  v_accvgpr_read_b32 v23, a55
  v_mul_f32 v20, v20, v19
  v_mul_f32 v21, v21, v19
  v_mul_f32 v22, v22, v19
  v_mul_f32 v23, v23, v19
  v_accvgpr_write_b32 a52, v20
  v_accvgpr_write_b32 a53, v21
  v_accvgpr_write_b32 a54, v22
  v_accvgpr_write_b32 a55, v23
  v_accvgpr_read_b32 v20, a56
  v_accvgpr_read_b32 v21, a57
  v_accvgpr_read_b32 v22, a58
  v_accvgpr_read_b32 v23, a59
  v_mul_f32 v20, v20, v18
  v_mul_f32 v21, v21, v18
  v_mul_f32 v22, v22, v18
  v_mul_f32 v23, v23, v18
  v_accvgpr_write_b32 a56, v20
  v_accvgpr_write_b32 a57, v21
  v_accvgpr_write_b32 a58, v22
  v_accvgpr_write_b32 a59, v23
  v_accvgpr_read_b32 v20, a60
  v_accvgpr_read_b32 v21, a61
  v_accvgpr_read_b32 v22, a62
  v_accvgpr_read_b32 v23, a63
  v_mul_f32 v20, v20, v19
  v_mul_f32 v21, v21, v19
  v_mul_f32 v22, v22, v19
  v_mul_f32 v23, v23, v19
  v_accvgpr_write_b32 a60, v20
  v_accvgpr_write_b32 a61, v21
  v_accvgpr_write_b32 a62, v22
  v_accvgpr_write_b32 a63, v23
  s_setpc_b64 s[78:79]
fa_rare10:
  s_nop 7
  v_max3_f32 v16, v128, v129, v130
  v_max3_f32 v16, v16, v131, v132
  v_max3_f32 v16, v16, v133, v134
  v_max3_f32 v16, v16, v135, 0
  v_mov_b32 v18, v16
  s_nop 1
  v_permlane16_swap_b32 v16, v18
  v_max_f32 v16, v16, v18
  v_mov_b32 v18, v16
  s_nop 1
  v_permlane32_swap_b32 v16, v18
  v_max_f32 v16, v16, v18
  v_sub_f32 v128, v128, v16
  v_sub_f32 v144, v144, v16
  v_sub_f32 v129, v129, v16
  v_sub_f32 v145, v145, v16
  v_sub_f32 v130, v130, v16
  v_sub_f32 v146, v146, v16
  v_sub_f32 v131, v131, v16
  v_sub_f32 v147, v147, v16
  v_sub_f32 v132, v132, v16
  v_sub_f32 v148, v148, v16
  v_sub_f32 v133, v133, v16
  v_sub_f32 v149, v149, v16
  v_sub_f32 v134, v134, v16
  v_sub_f32 v150, v150, v16
  v_sub_f32 v135, v135, v16
  v_sub_f32 v151, v151, v16
  v_max3_f32 v17, v136, v137, v138
  v_max3_f32 v17, v17, v139, v140
  v_max3_f32 v17, v17, v141, v142
  v_max3_f32 v17, v17, v143, 0
  v_mov_b32 v18, v17
  s_nop 1
  v_permlane16_swap_b32 v17, v18
  v_max_f32 v17, v17, v18
  v_mov_b32 v18, v17
  s_nop 1
  v_permlane32_swap_b32 v17, v18
  v_max_f32 v17, v17, v18
  v_sub_f32 v136, v136, v17
  v_sub_f32 v152, v152, v17
  v_sub_f32 v137, v137, v17
  v_sub_f32 v153, v153, v17
  v_sub_f32 v138, v138, v17
  v_sub_f32 v154, v154, v17
  v_sub_f32 v139, v139, v17
  v_sub_f32 v155, v155, v17
  v_sub_f32 v140, v140, v17
  v_sub_f32 v156, v156, v17
  v_sub_f32 v141, v141, v17
  v_sub_f32 v157, v157, v17
  v_sub_f32 v142, v142, v17
  v_sub_f32 v158, v158, v17
  v_sub_f32 v143, v143, v17
  v_sub_f32 v159, v159, v17
  s_call_b64 s[78:79], fa_resc1
  v_exp_f32 v216, v128
  v_exp_f32 v217, v129
  v_exp_f32 v218, v130
  v_add_f32 v226, v216, v217
  v_cvt_pk_bf16_f32 v176, v216, v217
  v_exp_f32 v219, v131
  v_add_f32 v226, v226, v218
  v_exp_f32 v220, v132
  v_add_f32 v226, v226, v219
  v_cvt_pk_bf16_f32 v177, v218, v219
  v_exp_f32 v221, v133
  v_add_f32 v226, v226, v220
  v_exp_f32 v222, v134
  v_add_f32 v226, v226, v221
  v_cvt_pk_bf16_f32 v178, v220, v221
  v_exp_f32 v223, v135
  v_add_f32 v226, v226, v222
  v_exp_f32 v216, v136
  v_add_f32 v226, v226, v223
  v_cvt_pk_bf16_f32 v179, v222, v223
  v_exp_f32 v217, v137
  v_exp_f32 v218, v138
  v_add_f32 v227, v216, v217
  v_cvt_pk_bf16_f32 v180, v216, v217
  v_exp_f32 v219, v139
  v_add_f32 v227, v227, v218
  v_exp_f32 v220, v140
  v_add_f32 v227, v227, v219
  v_cvt_pk_bf16_f32 v181, v218, v219
  v_exp_f32 v221, v141
  v_add_f32 v227, v227, v220
  v_exp_f32 v222, v142
  v_add_f32 v227, v227, v221
  v_cvt_pk_bf16_f32 v182, v220, v221
  v_exp_f32 v223, v143
  v_add_f32 v227, v227, v222
  s_nop 0
  v_add_f32 v227, v227, v223
  v_cvt_pk_bf16_f32 v183, v222, v223
  s_nop 1
  s_setpc_b64 s[76:77]
fa_rare11:
  s_nop 7
  v_max3_f32 v16, v144, v145, v146
  v_max3_f32 v16, v16, v147, v148
  v_max3_f32 v16, v16, v149, v150
  v_max3_f32 v16, v16, v151, 0
  v_mov_b32 v18, v16
  s_nop 1
  v_permlane16_swap_b32 v16, v18
  v_max_f32 v16, v16, v18
  v_mov_b32 v18, v16
  s_nop 1
  v_permlane32_swap_b32 v16, v18
  v_max_f32 v16, v16, v18
  v_sub_f32 v144, v144, v16
  v_sub_f32 v128, v128, v16
  v_sub_f32 v145, v145, v16
  v_sub_f32 v129, v129, v16
  v_sub_f32 v146, v146, v16
  v_sub_f32 v130, v130, v16
  v_sub_f32 v147, v147, v16
  v_sub_f32 v131, v131, v16
  v_sub_f32 v148, v148, v16
  v_sub_f32 v132, v132, v16
  v_sub_f32 v149, v149, v16
  v_sub_f32 v133, v133, v16
  v_sub_f32 v150, v150, v16
  v_sub_f32 v134, v134, v16
  v_sub_f32 v151, v151, v16
  v_sub_f32 v135, v135, v16
  v_max3_f32 v17, v152, v153, v154
  v_max3_f32 v17, v17, v155, v156
  v_max3_f32 v17, v17, v157, v158
  v_max3_f32 v17, v17, v159, 0
  v_mov_b32 v18, v17
  s_nop 1
  v_permlane16_swap_b32 v17, v18
  v_max_f32 v17, v17, v18
  v_mov_b32 v18, v17
  s_nop 1
  v_permlane32_swap_b32 v17, v18
  v_max_f32 v17, v17, v18
  v_sub_f32 v152, v152, v17
  v_sub_f32 v136, v136, v17
  v_sub_f32 v153, v153, v17
  v_sub_f32 v137, v137, v17
  v_sub_f32 v154, v154, v17
  v_sub_f32 v138, v138, v17
  v_sub_f32 v155, v155, v17
  v_sub_f32 v139, v139, v17
  v_sub_f32 v156, v156, v17
  v_sub_f32 v140, v140, v17
  v_sub_f32 v157, v157, v17
  v_sub_f32 v141, v141, v17
  v_sub_f32 v158, v158, v17
  v_sub_f32 v142, v142, v17
  v_sub_f32 v159, v159, v17
  v_sub_f32 v143, v143, v17
  s_call_b64 s[78:79], fa_resc1
  v_exp_f32 v216, v144
  v_exp_f32 v217, v145
  v_exp_f32 v218, v146
  v_add_f32 v226, v216, v217
  v_cvt_pk_bf16_f32 v184, v216, v217
  v_exp_f32 v219, v147
  v_add_f32 v226, v226, v218
  v_exp_f32 v220, v148
  v_add_f32 v226, v226, v219
  v_cvt_pk_bf16_f32 v185, v218, v219
  v_exp_f32 v221, v149
  v_add_f32 v226, v226, v220
  v_exp_f32 v222, v150
  v_add_f32 v226, v226, v221
  v_cvt_pk_bf16_f32 v186, v220, v221
  v_exp_f32 v223, v151
  v_add_f32 v226, v226, v222
  v_exp_f32 v216, v152
  v_add_f32 v226, v226, v223
  v_cvt_pk_bf16_f32 v187, v222, v223
  v_exp_f32 v217, v153
  v_exp_f32 v218, v154
  v_add_f32 v227, v216, v217
  v_cvt_pk_bf16_f32 v188, v216, v217
  v_exp_f32 v219, v155
  v_add_f32 v227, v227, v218
  v_exp_f32 v220, v156
  v_add_f32 v227, v227, v219
  v_cvt_pk_bf16_f32 v189, v218, v219
  v_exp_f32 v221, v157
  v_add_f32 v227, v227, v220
  v_exp_f32 v222, v158
  v_add_f32 v227, v227, v221
  v_cvt_pk_bf16_f32 v190, v220, v221
  v_exp_f32 v223, v159
  v_add_f32 v227, v227, v222
  s_nop 0
  v_add_f32 v227, v227, v223
  v_cvt_pk_bf16_f32 v191, v222, v223
  s_nop 1
  s_setpc_b64 s[76:77]
fa_resc1:
  v_sub_f32 v200, v200, v16
  v_sub_f32 v201, v201, v16
  v_sub_f32 v202, v202, v16
  v_sub_f32 v203, v203, v16
  v_exp_f32 v18, -v16
  v_sub_f32 v204, v204, v17
  v_sub_f32 v205, v205, v17
  v_sub_f32 v206, v206, v17
  v_sub_f32 v207, v207, v17
  v_exp_f32 v19, -v17
  s_nop 0
  v_mul_f32 v230, v230, v18
  v_mul_f32 v231, v231, v19
  v_accvgpr_read_b32 v20, a64
  v_accvgpr_read_b32 v21, a65
  v_accvgpr_read_b32 v22, a66
  v_accvgpr_read_b32 v23, a67
  v_mul_f32 v20, v20, v18
  v_mul_f32 v21, v21, v18
  v_mul_f32 v22, v22, v18
  v_mul_f32 v23, v23, v18
  v_accvgpr_write_b32 a64, v20
  v_accvgpr_write_b32 a65, v21
  v_accvgpr_write_b32 a66, v22
  v_accvgpr_write_b32 a67, v23
  v_accvgpr_read_b32 v20, a68
  v_accvgpr_read_b32 v21, a69
  v_accvgpr_read_b32 v22, a70
  v_accvgpr_read_b32 v23, a71
  v_mul_f32 v20, v20, v19
  v_mul_f32 v21, v21, v19
  v_mul_f32 v22, v22, v19
  v_mul_f32 v23, v23, v19
  v_accvgpr_write_b32 a68, v20
  v_accvgpr_write_b32 a69, v21
  v_accvgpr_write_b32 a70, v22
  v_accvgpr_write_b32 a71, v23
  v_accvgpr_read_b32 v20, a72
  v_accvgpr_read_b32 v21, a73
  v_accvgpr_read_b32 v22, a74
  v_accvgpr_read_b32 v23, a75
  v_mul_f32 v20, v20, v18
  v_mul_f32 v21, v21, v18
  v_mul_f32 v22, v22, v18
  v_mul_f32 v23, v23, v18
  v_accvgpr_write_b32 a72, v20
  v_accvgpr_write_b32 a73, v21
  v_accvgpr_write_b32 a74, v22
  v_accvgpr_write_b32 a75, v23
  v_accvgpr_read_b32 v20, a76
  v_accvgpr_read_b32 v21, a77
  v_accvgpr_read_b32 v22, a78
  v_accvgpr_read_b32 v23, a79
  v_mul_f32 v20, v20, v19
  v_mul_f32 v21, v21, v19
  v_mul_f32 v22, v22, v19
  v_mul_f32 v23, v23, v19
  v_accvgpr_write_b32 a76, v20
  v_accvgpr_write_b32 a77, v21
  v_accvgpr_write_b32 a78, v22
  v_accvgpr_write_b32 a79, v23
  v_accvgpr_read_b32 v20, a80
  v_accvgpr_read_b32 v21, a81
  v_accvgpr_read_b32 v22, a82
  v_accvgpr_read_b32 v23, a83
  v_mul_f32 v20, v20, v18
  v_mul_f32 v21, v21, v18
  v_mul_f32 v22, v22, v18
  v_mul_f32 v23, v23, v18
  v_accvgpr_write_b32 a80, v20
  v_accvgpr_write_b32 a81, v21
  v_accvgpr_write_b32 a82, v22
  v_accvgpr_write_b32 a83, v23
  v_accvgpr_read_b32 v20, a84
  v_accvgpr_read_b32 v21, a85
  v_accvgpr_read_b32 v22, a86
  v_accvgpr_read_b32 v23, a87
  v_mul_f32 v20, v20, v19
  v_mul_f32 v21, v21, v19
  v_mul_f32 v22, v22, v19
  v_mul_f32 v23, v23, v19
  v_accvgpr_write_b32 a84, v20
  v_accvgpr_write_b32 a85, v21
  v_accvgpr_write_b32 a86, v22
  v_accvgpr_write_b32 a87, v23
  v_accvgpr_read_b32 v20, a88
  v_accvgpr_read_b32 v21, a89
  v_accvgpr_read_b32 v22, a90
  v_accvgpr_read_b32 v23, a91
  v_mul_f32 v20, v20, v18
  v_mul_f32 v21, v21, v18
  v_mul_f32 v22, v22, v18
  v_mul_f32 v23, v23, v18
  v_accvgpr_write_b32 a88, v20
  v_accvgpr_write_b32 a89, v21
  v_accvgpr_write_b32 a90, v22
  v_accvgpr_write_b32 a91, v23
  v_accvgpr_read_b32 v20, a92
  v_accvgpr_read_b32 v21, a93
  v_accvgpr_read_b32 v22, a94
  v_accvgpr_read_b32 v23, a95
  v_mul_f32 v20, v20, v19
  v_mul_f32 v21, v21, v19
  v_mul_f32 v22, v22, v19
  v_mul_f32 v23, v23, v19
  v_accvgpr_write_b32 a92, v20
  v_accvgpr_write_b32 a93, v21
  v_accvgpr_write_b32 a94, v22
  v_accvgpr_write_b32 a95, v23
  v_accvgpr_read_b32 v20, a96
  v_accvgpr_read_b32 v21, a97
  v_accvgpr_read_b32 v22, a98
  v_accvgpr_read_b32 v23, a99
  v_mul_f32 v20, v20, v18
  v_mul_f32 v21, v21, v18
  v_mul_f32 v22, v22, v18
  v_mul_f32 v23, v23, v18
  v_accvgpr_write_b32 a96, v20
  v_accvgpr_write_b32 a97, v21
  v_accvgpr_write_b32 a98, v22
  v_accvgpr_write_b32 a99, v23
  v_accvgpr_read_b32 v20, a100
  v_accvgpr_read_b32 v21, a101
  v_accvgpr_read_b32 v22, a102
  v_accvgpr_read_b32 v23, a103
  v_mul_f32 v20, v20, v19
  v_mul_f32 v21, v21, v19
  v_mul_f32 v22, v22, v19
  v_mul_f32 v23, v23, v19
  v_accvgpr_write_b32 a100, v20
  v_accvgpr_write_b32 a101, v21
  v_accvgpr_write_b32 a102, v22
  v_accvgpr_write_b32 a103, v23
  v_accvgpr_read_b32 v20, a104
  v_accvgpr_read_b32 v21, a105
  v_accvgpr_read_b32 v22, a106
  v_accvgpr_read_b32 v23, a107
  v_mul_f32 v20, v20, v18
  v_mul_f32 v21, v21, v18
  v_mul_f32 v22, v22, v18
  v_mul_f32 v23, v23, v18
  v_accvgpr_write_b32 a104, v20
  v_accvgpr_write_b32 a105, v21
  v_accvgpr_write_b32 a106, v22
  v_accvgpr_write_b32 a107, v23
  v_accvgpr_read_b32 v20, a108
  v_accvgpr_read_b32 v21, a109
  v_accvgpr_read_b32 v22, a110
  v_accvgpr_read_b32 v23, a111
  v_mul_f32 v20, v20, v19
  v_mul_f32 v21, v21, v19
  v_mul_f32 v22, v22, v19
  v_mul_f32 v23, v23, v19
  v_accvgpr_write_b32 a108, v20
  v_accvgpr_write_b32 a109, v21
  v_accvgpr_write_b32 a110, v22
  v_accvgpr_write_b32 a111, v23
  v_accvgpr_read_b32 v20, a112
  v_accvgpr_read_b32 v21, a113
  v_accvgpr_read_b32 v22, a114
  v_accvgpr_read_b32 v23, a115
  v_mul_f32 v20, v20, v18
  v_mul_f32 v21, v21, v18
  v_mul_f32 v22, v22, v18
  v_mul_f32 v23, v23, v18
  v_accvgpr_write_b32 a112, v20
  v_accvgpr_write_b32 a113, v21
  v_accvgpr_write_b32 a114, v22
  v_accvgpr_write_b32 a115, v23
  v_accvgpr_read_b32 v20, a116
  v_accvgpr_read_b32 v21, a117
  v_accvgpr_read_b32 v22, a118
  v_accvgpr_read_b32 v23, a119
  v_mul_f32 v20, v20, v19
  v_mul_f32 v21, v21, v19
  v_mul_f32 v22, v22, v19
  v_mul_f32 v23, v23, v19
  v_accvgpr_write_b32 a116, v20
  v_accvgpr_write_b32 a117, v21
  v_accvgpr_write_b32 a118, v22
  v_accvgpr_write_b32 a119, v23
  v_accvgpr_read_b32 v20, a120
  v_accvgpr_read_b32 v21, a121
  v_accvgpr_read_b32 v22, a122
  v_accvgpr_read_b32 v23, a123
  v_mul_f32 v20, v20, v18
  v_mul_f32 v21, v21, v18
  v_mul_f32 v22, v22, v18
  v_mul_f32 v23, v23, v18
  v_accvgpr_write_b32 a120, v20
  v_accvgpr_write_b32 a121, v21
  v_accvgpr_write_b32 a122, v22
  v_accvgpr_write_b32 a123, v23
  v_accvgpr_read_b32 v20, a124
  v_accvgpr_read_b32 v21, a125
  v_accvgpr_read_b32 v22, a126
  v_accvgpr_read_b32 v23, a127
  v_mul_f32 v20, v20, v19
  v_mul_f32 v21, v21, v19
  v_mul_f32 v22, v22, v19
  v_mul_f32 v23, v23, v19
  v_accvgpr_write_b32 a124, v20
  v_accvgpr_write_b32 a125, v21
  v_accvgpr_write_b32 a126, v22
  v_accvgpr_write_b32 a127, v23
  s_setpc_b64 s[78:79]
.section .rodata,"a"
.p2align 6
.amdhsa_kernel fa_kernel
  .amdhsa_next_free_vgpr 512
  .amdhsa_next_free_sgpr 102
  .amdhsa_accum_offset 256
  .amdhsa_group_segment_fixed_size 0
  .amdhsa_kernarg_size 112
  .amdhsa_user_sgpr_count 2
  .amdhsa_user_sgpr_kernarg_segment_ptr 1
  .amdhsa_system_sgpr_workgroup_id_x 1
  .amdhsa_float_denorm_mode_32 3
.end_amdhsa_kernel
.text
```

```asm
; @launch kernel=fa_kernel grid=(256,1,1) block=(256,1,1) lds=163840
.amdgcn_target "amdgcn-amd-amdhsa--gfx950"
.text
.globl fa_kernel
.p2align 8
.type fa_kernel,@function
fa_kernel:
  s_cmp_ge_u32 s2, 256
  s_cbranch_scc1 fa_end
  s_getpc_b64 s[62:63]
  v_and_b32 v230, 127, v0
  v_lshlrev_b32 v230, 7, v230
  global_load_dword v231, v230, s[62:63]
  s_load_dwordx4 s[4:7], s[0:1], 0
  s_load_dwordx4 s[8:11], s[0:1], 24
  s_load_dwordx2 s[14:15], s[0:1], 56
  s_load_dwordx2 s[12:13], s[0:1], 40
  s_load_dwordx4 s[16:19], s[0:1], 96
  s_load_dwordx2 s[60:61], s[0:1], 16
  v_lshrrev_b32 v16, 6, v0
  v_and_b32 v1, 63, v0
  v_readfirstlane_b32 s20, v16
  s_and_b32 s21, s2, 7
  s_lshl_b32 s21, s21, 2
  s_lshr_b32 s23, s2, 3
  s_and_b32 s23, s23, 3
  s_add_u32 s21, s21, s23
  s_lshr_b32 s22, s2, 5
  v_and_b32 v208, 31, v1
  v_lshrrev_b32 v209, 5, v1
  s_lshl_b32 s31, s2, 2
  s_add_u32 s31, s31, s20
  s_lshl_b32 s31, s31, 1
  v_add_u32 v209, s31, v209
  v_lshlrev_b32 v212, 4, v208
  v_mul_u32_u24 v210, 1280, v209
  v_add_u32 v210, v210, v212
  v_cmp_gt_u32 s[64:65], 16, v208
  v_mov_b32 v19, 1073741824
  v_and_b32 v220, 7, v209
  v_cndmask_b32 v211, v19, v210, s[64:65]
  v_bfe_u32 v17, v1, 1, 3
  v_lshlrev_b32 v17, 13, v17
  v_and_b32 v18, 1, v1
  v_lshl_add_u32 v235, v18, 7, v17
  s_lshl_b32 s74, s22, 1
  s_and_b32 s31, s20, 1
  s_add_u32 s74, s74, s31
  s_lshl_b32 s74, s74, 16
  s_mov_b32 s73, 1048576
  v_and_b32 v16, 15, v1
  v_lshlrev_b32 v17, 10, v16
  v_and_b32 v18, 16, v1
  v_lshl_add_u32 v233, v18, 3, v17
  s_lshl_b32 s30, s23, 2
  s_add_u32 s30, s30, s20
  s_lshl_b32 s30, s30, 14
  s_lshl_b32 s29, s22, 18
  s_lshl_b32 s23, s21, 8
  s_cmp_ge_u32 s20, 2
  s_waitcnt lgkmcnt(0)
  s_mov_b32 s44, s4
  s_mov_b32 s45, s5
  s_mov_b32 s46, 2621440
  s_mov_b32 s47, 0x20000
  s_mov_b32 s68, s14
  s_mov_b32 s69, s15
  s_mov_b32 s70, 1280
  s_mov_b32 s71, 0x20000
  buffer_load_dwordx4 v[160:163], v210, s[44:47], 0 offen
  buffer_load_dwordx4 v[164:167], v210, s[44:47], 0 offen offset:512
  buffer_load_dwordx4 v[168:171], v211, s[44:47], 0 offen offset:1024
  buffer_load_dwordx4 v[172:175], v212, s[68:71], 0 offen offset:0
  buffer_load_dwordx4 v[176:179], v212, s[68:71], 0 offen offset:512
  buffer_load_dwordx4 v[180:183], v212, s[68:71], 0 offen offset:1024
  s_cselect_b32 s62, s10, s8
  s_cselect_b32 s63, s11, s9
  s_add_u32 s62, s62, s23
  s_addc_u32 s63, s63, 0
  s_mov_b32 s36, s62
  s_mov_b32 s37, s63
  s_mov_b32 s38, 0
  s_mov_b32 s39, 0x20000
  s_sub_u32 s38, 4194304, s23
  buffer_load_dword v231, v235, s[36:39], s74 offen
  s_add_u32 s6, s6, s29
  s_addc_u32 s7, s7, 0
  s_mov_b32 s32, s6
  s_mov_b32 s33, s7
  s_mov_b32 s34, 262144
  s_mov_b32 s35, 0x20000
  buffer_load_dword v232, v233, s[32:35], s30 offen
  s_add_u32 s74, s74, s73
  buffer_load_dword v231, v235, s[36:39], s74 offen
  buffer_load_dword v232, v233, s[32:35], s30 offen offset:256
  s_getpc_b64 s[8:9]
fa_pc:
  s_lshr_b32 s31, s2, 3
  s_and_b32 s31, s31, 15
  s_lshl_b32 s31, s31, 2
  s_add_u32 s31, s31, s20
  s_lshl_b32 s31, s31, 11
  s_min_u32 s31, s31, fa_codeend-fa_pc-2048
  v_lshlrev_b32 v234, 7, v16
  v_add_u32 v230, s31, v234
  global_load_dword v231, v230, s[8:9]
  s_add_u32 s8, s8, fa_co1-fa_pc-4
  s_addc_u32 s9, s9, 0
  s_add_u32 s60, s60, s23
  s_addc_u32 s61, s61, 0
  s_sub_u32 s75, 5242880, s23
  s_mov_b32 s48, s62
  s_mov_b32 s49, s63
  s_mov_b32 s50, s38
  s_mov_b32 s51, 0x20000
  v_lshlrev_b32 v2, 4, v1
  v_lshrrev_b32 v19, 2, v1
  v_lshrrev_b32 v17, 5, v1
  v_mul_u32_u24 v17, 3, v17
  v_and_b32 v18, 3, v1
  v_xor_b32 v17, v17, v18
  v_lshlrev_b32 v17, 4, v17
  v_lshl_add_u32 v3, v19, 10, v17
  s_lshl_b32 s23, s20, 16
  v_add_u32 v3, s23, v3
  v_add_u32 v4, 15360, v3
  v_add_u32 v5, 30720, v3
  v_add_u32 v6, 46080, v3
  v_and_b32 v19, 3, v19
  v_lshrrev_b32 v17, 4, v1
  v_lshlrev_b32 v17, 6, v17
  v_lshl_add_u32 v19, v19, 13, v17
  s_and_b32 s23, s20, 1
  s_lshl_b32 s23, s23, 17
  v_add_u32 v19, s23, v19
  v_lshl_add_u32 v8, v18, 4, v19
  v_xor_b32 v18, 2, v18
  v_lshl_add_u32 v10, v18, 4, v19
  v_add_u32 v9, 31744, v8
  v_add_u32 v11, 95232, v10
  v_add_u32 v10, 63488, v10
  s_lshl_b32 s24, s20, 12
  s_mov_b32 s26, 0
  s_mov_b32 s27, 0
  s_mov_b32 s25, 262144
  s_mov_b32 s79, 64
  s_mov_b32 s40, s18
  s_mov_b32 s41, s19
  s_mov_b32 s42, 67108864
  s_mov_b32 s43, 0x20000
  s_mov_b32 s52, s12
  s_mov_b32 s53, s13
  s_mov_b32 s54, 5242880
  s_mov_b32 s55, 0x20000
  s_mov_b32 s56, s16
  s_mov_b32 s57, s17
  s_mov_b32 s58, 256
  s_mov_b32 s59, 0x20000
  s_and_b32 s29, s2, 31
  s_lshl_b32 s29, s29, 2
  s_add_u32 s29, s29, s20
  s_lshl_b32 s29, s29, 11
  s_lshl_b32 s23, s20, 5
  s_add_u32 s23, s23, s21
  s_lshl_b32 s23, s23, 2
  s_add_u32 s23, s23, 2641920
  s_lshl_b32 s31, s22, 9
  s_add_u32 s80, s23, s31
  s_sub_u32 s31, 7680, s31
  s_add_u32 s3, s23, s31
  s_lshl_b32 s23, s21, 7
  s_lshl_b32 s31, s22, 2
  s_add_u32 s23, s23, s31
  s_add_u32 s82, s23, 2637824
  s_sub_u32 s62, s2, 170
  s_lshl_b32 s31, s20, 6
  s_add_u32 s62, s62, s31
  s_lshl_b32 s62, s62, 2
  s_add_u32 s62, s62, 2650112
  s_sub_u32 s23, s2, 170
  s_cmp_lt_u32 s23, 54
  s_cselect_b32 s62, s62, 1073741824
  s_cmp_eq_u32 s20, 0
  s_cselect_b32 s31, s82, 1073741824
  s_cselect_b32 s77, s2, 1073741824
  s_cmp_eq_u32 s2, 255
  s_cselect_b32 s23, 2629632, 1073741824
  v_lshl_add_u32 v225, v16, 2, s23
  v_mov_b32 v229, 0
  v_writelane_b32 v225, s80, 0
  v_writelane_b32 v225, s3, 1
  v_writelane_b32 v225, s31, 2
  s_and_b32 s23, s2, 1
  s_lshl_b32 s23, s23, 2
  s_add_u32 s23, s23, s20
  s_lshl_b32 s23, s23, 7
  s_lshr_b32 s31, s2, 1
  s_add_u32 s23, s23, s31
  s_lshl_b32 s23, s23, 2
  s_add_u32 s23, s23, 2654208
  v_writelane_b32 v225, s23, 3
  v_writelane_b32 v225, s62, 4
  s_and_b32 s23, s21, 3
  s_lshr_b32 s31, s23, 1
  s_lshl_b32 s31, 4, s31
  s_bitcmp1_b32 s23, 0
  s_cselect_b32 s76, s31, 0
  s_cselect_b32 s72, 0, s31
  s_or_b32 s76, s76, 0x20
  s_or_b32 s72, s72, 0x25
  v_mov_b32 v20, 0
  v_mov_b32 v21, 0
  v_mov_b32 v22, 0
  v_mov_b32 v23, 0
  v_lshrrev_b32 v17, 4, v1
  v_lshrrev_b32 v18, 3, v16
  v_mul_u32_u24 v18, 3, v18
  v_xor_b32 v18, v18, v17
  v_lshlrev_b32 v18, 4, v18
  v_lshl_add_u32 v14, v16, 6, v18
  s_and_b32 s23, s20, 1
  s_lshl_b32 s23, s23, 13
  v_add_u32 v14, s23, v14
  v_mfma_f32_32x32x16_bf16 a[0:15], v[20:23], v[20:23], 0
  v_lshrrev_b32 v18, 2, v16
  v_lshlrev_b32 v18, 6, v18
  v_lshl_add_u32 v18, v17, 11, v18
  v_and_b32 v19, 1, v1
  v_mfma_f32_32x32x16_bf16 a[16:31], v[20:23], v[20:23], 0
  v_lshl_add_u32 v18, v19, 3, v18
  v_bfe_u32 v19, v1, 1, 1
  v_and_b32 v17, 1, v17
  v_lshl_or_b32 v19, v17, 1, v19
  v_mfma_f32_32x32x16_bf16 a[32:47], v[20:23], v[20:23], 0
  s_lshr_b32 s23, s20, 1
  s_lshl_b32 s23, s23, 13
  s_add_u32 s23, s23, 16384
  v_add_u32 v18, s23, v18
  v_mfma_f32_32x32x16_bf16 a[48:63], v[20:23], v[20:23], 0
  v_lshl_add_u32 v12, v19, 4, v18
  v_xor_b32 v13, 32, v12
  v_mov_b32 v19, 1073741824
  v_lshlrev_b32 v220, 4, v220
  v_mfma_f32_32x32x16_bf16 a[64:79], v[20:23], v[20:23], 0
  v_lshl_add_u32 v220, v208, 7, v220
  v_add_u32 v220, 131072, v220
  v_lshlrev_b32 v222, 2, v209
  v_cmp_eq_u32 vcc, 0, v208
  v_mfma_f32_32x32x16_bf16 a[80:95], v[20:23], v[20:23], 0
  v_add_u32 v222, 2621440, v222
  v_lshlrev_b32 v221, 4, v0
  v_cndmask_b32 v222, v19, v222, vcc
  v_add_u32 v221, 131072, v221
  v_mfma_f32_32x32x16_bf16 a[96:111], v[20:23], v[20:23], 0
  v_sub_u32 v209, 0xffff, v209
  v_lshrrev_b32 v223, 3, v0
  v_and_b32 v18, 7, v0
  v_lshlrev_b32 v18, 4, v18
  v_mfma_f32_32x32x16_bf16 a[112:127], v[20:23], v[20:23], 0
  v_cmp_gt_u32 vcc, 128, v0
  v_lshl_add_u32 v223, v223, 8, v18
  s_lshr_b32 s66, s2, 1
  s_mul_i32 s66, s66, 20480
  v_mfma_f32_32x32x16_bf16 a[128:143], v[20:23], v[20:23], 0
  s_and_b32 s31, s2, 1
  s_lshl_b32 s31, s31, 7
  s_add_u32 s66, s66, s31
  v_cndmask_b32 v224, v19, v223, vcc
  v_mfma_f32_32x32x16_bf16 a[144:159], v[20:23], v[20:23], 0
  s_add_u32 s67, s66, 8192
  s_add_u32 s78, s66, 16384
  s_mov_b32 s28, 0
  v_mfma_f32_32x32x16_bf16 a[160:175], v[20:23], v[20:23], 0
  v_mfma_f32_32x32x16_bf16 a[176:191], v[20:23], v[20:23], 0
  v_mfma_f32_32x32x16_bf16 a[192:207], v[20:23], v[20:23], 0
  v_mfma_f32_32x32x16_bf16 a[208:223], v[20:23], v[20:23], 0
  v_mfma_f32_32x32x16_bf16 a[224:239], v[20:23], v[20:23], 0
  v_mfma_f32_32x32x16_bf16 a[240:255], v[20:23], v[20:23], 0
  s_waitcnt vmcnt(5)
  v_lshlrev_b32 v184, 16, v160
  v_and_b32 v185, 0xffff0000, v160
  v_lshlrev_b32 v186, 16, v161
  v_and_b32 v187, 0xffff0000, v161
  v_lshlrev_b32 v188, 16, v162
  v_and_b32 v189, 0xffff0000, v162
  v_lshlrev_b32 v190, 16, v163
  v_and_b32 v191, 0xffff0000, v163
  v_lshlrev_b32 v192, 16, v164
  v_and_b32 v193, 0xffff0000, v164
  v_lshlrev_b32 v194, 16, v165
  v_and_b32 v195, 0xffff0000, v165
  v_lshlrev_b32 v196, 16, v166
  v_and_b32 v197, 0xffff0000, v166
  v_lshlrev_b32 v198, 16, v167
  v_and_b32 v199, 0xffff0000, v167
  v_lshlrev_b32 v200, 16, v168
  v_and_b32 v201, 0xffff0000, v168
  v_lshlrev_b32 v202, 16, v169
  v_and_b32 v203, 0xffff0000, v169
  v_lshlrev_b32 v204, 16, v170
  v_and_b32 v205, 0xffff0000, v170
  v_lshlrev_b32 v206, 16, v171
  v_and_b32 v207, 0xffff0000, v171
  v_pk_add_f32 v[16:17], v[184:185], v[186:187]
  v_pk_add_f32 v[18:19], v[188:189], v[190:191]
  v_pk_add_f32 v[16:17], v[16:17], v[192:193]
  v_pk_add_f32 v[18:19], v[18:19], v[194:195]
  v_pk_add_f32 v[16:17], v[16:17], v[196:197]
  v_pk_add_f32 v[18:19], v[18:19], v[198:199]
  v_pk_add_f32 v[16:17], v[16:17], v[200:201]
  v_pk_add_f32 v[18:19], v[18:19], v[202:203]
  v_pk_add_f32 v[16:17], v[16:17], v[204:205]
  v_pk_add_f32 v[18:19], v[18:19], v[206:207]
  v_pk_add_f32 v[16:17], v[16:17], v[18:19]
  v_add_f32 v213, v16, v17
  s_nop 1
  v_add_f32_dpp v213, v213, v213 quad_perm:[1,0,3,2] row_mask:0xf bank_mask:0xf
  s_nop 1
  v_add_f32_dpp v213, v213, v213 quad_perm:[2,3,0,1] row_mask:0xf bank_mask:0xf
  s_nop 1
  v_add_f32_dpp v213, v213, v213 row_half_mirror row_mask:0xf bank_mask:0xf
  s_nop 1
  v_add_f32_dpp v213, v213, v213 row_mirror row_mask:0xf bank_mask:0xf
  v_mov_b32 v214, v213
  s_nop 1
  v_permlane16_swap_b32 v213, v214
  v_add_f32 v213, v213, v214
  v_mul_f32 v216, 0xbacccccd, v213
  v_mul_f32 v217, 0xbacccccd, v213
  v_pk_add_f32 v[20:21], v[184:185], v[216:217]
  v_pk_mul_f32 v[16:17], v[20:21], v[20:21]
  v_pk_add_f32 v[22:23], v[186:187], v[216:217]
  v_pk_fma_f32 v[16:17], v[22:23], v[22:23], v[16:17]
  v_pk_add_f32 v[24:25], v[188:189], v[216:217]
  v_pk_fma_f32 v[16:17], v[24:25], v[24:25], v[16:17]
  v_pk_add_f32 v[26:27], v[190:191], v[216:217]
  v_pk_fma_f32 v[16:17], v[26:27], v[26:27], v[16:17]
  v_pk_add_f32 v[20:21], v[192:193], v[216:217]
  v_pk_fma_f32 v[16:17], v[20:21], v[20:21], v[16:17]
  v_pk_add_f32 v[22:23], v[194:195], v[216:217]
  v_pk_fma_f32 v[16:17], v[22:23], v[22:23], v[16:17]
  v_pk_add_f32 v[24:25], v[196:197], v[216:217]
  v_pk_fma_f32 v[16:17], v[24:25], v[24:25], v[16:17]
  v_pk_add_f32 v[26:27], v[198:199], v[216:217]
  v_pk_fma_f32 v[16:17], v[26:27], v[26:27], v[16:17]
  v_pk_add_f32 v[20:21], v[200:201], v[216:217]
  v_pk_mul_f32 v[18:19], v[20:21], v[20:21]
  v_pk_add_f32 v[22:23], v[202:203], v[216:217]
  v_pk_fma_f32 v[18:19], v[22:23], v[22:23], v[18:19]
  v_pk_add_f32 v[24:25], v[204:205], v[216:217]
  v_pk_fma_f32 v[18:19], v[24:25], v[24:25], v[18:19]
  v_pk_add_f32 v[26:27], v[206:207], v[216:217]
  v_pk_fma_f32 v[18:19], v[26:27], v[26:27], v[18:19]
  v_add_f32 v18, v18, v19
  v_add_f32 v213, v16, v17
  v_cndmask_b32 v18, 0, v18, s[64:65]
  v_add_f32 v213, v213, v18
  s_nop 1
  v_add_f32_dpp v213, v213, v213 quad_perm:[1,0,3,2] row_mask:0xf bank_mask:0xf
  s_nop 1
  v_add_f32_dpp v213, v213, v213 quad_perm:[2,3,0,1] row_mask:0xf bank_mask:0xf
  s_nop 1
  v_add_f32_dpp v213, v213, v213 row_half_mirror row_mask:0xf bank_mask:0xf
  s_nop 1
  v_add_f32_dpp v213, v213, v213 row_mirror row_mask:0xf bank_mask:0xf
  v_mov_b32 v214, v213
  s_nop 1
  v_permlane16_swap_b32 v213, v214
  v_add_f32 v213, v213, v214
  v_mul_f32 v213, 0x3acccccd, v213
  v_cvt_pk_bf16_f32 v213, v213, v213
  v_and_b32 v213, 0xffff0000, v213
  v_add_f32 v213, 0x3727c5ac, v213
  v_cvt_pk_bf16_f32 v213, v213, v213
  v_and_b32 v213, 0xffff0000, v213
  v_sqrt_f32 v213, v213
  v_cvt_pk_bf16_f32 v216, v216, v216
  v_and_b32 v216, 0xffff0000, v216
  v_cvt_pk_bf16_f32 v213, v213, v213
  v_and_b32 v213, 0xffff0000, v213
  v_rcp_f32 v28, v213
  v_mov_b32 v217, v216
  v_mov_b32 v29, v28
  v_pk_add_f32 v[184:185], v[184:185], v[216:217]
  v_lshlrev_b32 v16, 16, v172
  v_cvt_pk_bf16_f32 v185, v184, v185
  v_and_b32 v17, 0xffff0000, v172
  v_lshlrev_b32 v184, 16, v185
  v_and_b32 v185, 0xffff0000, v185
  v_pk_mul_f32 v[184:185], v[184:185], v[28:29]
  v_cvt_pk_bf16_f32 v160, v184, v185
  v_lshlrev_b32 v184, 16, v160
  v_and_b32 v185, 0xffff0000, v160
  v_pk_mul_f32 v[218:219], v[184:185], v[16:17]
  v_pk_add_f32 v[186:187], v[186:187], v[216:217]
  v_lshlrev_b32 v18, 16, v173
  v_cvt_pk_bf16_f32 v187, v186, v187
  v_and_b32 v19, 0xffff0000, v173
  v_lshlrev_b32 v186, 16, v187
  v_and_b32 v187, 0xffff0000, v187
  v_pk_mul_f32 v[186:187], v[186:187], v[28:29]
  v_cvt_pk_bf16_f32 v161, v186, v187
  v_lshlrev_b32 v186, 16, v161
  v_and_b32 v187, 0xffff0000, v161
  v_pk_fma_f32 v[218:219], v[186:187], v[18:19], v[218:219]
  v_pk_add_f32 v[188:189], v[188:189], v[216:217]
  v_lshlrev_b32 v16, 16, v174
  v_cvt_pk_bf16_f32 v189, v188, v189
  v_and_b32 v17, 0xffff0000, v174
  v_lshlrev_b32 v188, 16, v189
  v_and_b32 v189, 0xffff0000, v189
  v_pk_mul_f32 v[188:189], v[188:189], v[28:29]
  v_cvt_pk_bf16_f32 v162, v188, v189
  v_lshlrev_b32 v188, 16, v162
  v_and_b32 v189, 0xffff0000, v162
  v_pk_fma_f32 v[218:219], v[188:189], v[16:17], v[218:219]
  v_pk_add_f32 v[190:191], v[190:191], v[216:217]
  v_lshlrev_b32 v18, 16, v175
  v_cvt_pk_bf16_f32 v191, v190, v191
  v_and_b32 v19, 0xffff0000, v175
  v_lshlrev_b32 v190, 16, v191
  v_and_b32 v191, 0xffff0000, v191
  v_pk_mul_f32 v[190:191], v[190:191], v[28:29]
  v_cvt_pk_bf16_f32 v163, v190, v191
  v_lshlrev_b32 v190, 16, v163
  v_and_b32 v191, 0xffff0000, v163
  v_pk_fma_f32 v[218:219], v[190:191], v[18:19], v[218:219]
  ds_write_b128 v220, v[160:163] offset:0
  v_pk_add_f32 v[192:193], v[192:193], v[216:217]
  v_lshlrev_b32 v16, 16, v176
  v_cvt_pk_bf16_f32 v193, v192, v193
  v_and_b32 v17, 0xffff0000, v176
  v_lshlrev_b32 v192, 16, v193
  v_and_b32 v193, 0xffff0000, v193
  v_pk_mul_f32 v[192:193], v[192:193], v[28:29]
  v_cvt_pk_bf16_f32 v164, v192, v193
  v_lshlrev_b32 v192, 16, v164
  v_and_b32 v193, 0xffff0000, v164
  v_pk_fma_f32 v[218:219], v[192:193], v[16:17], v[218:219]
  v_pk_add_f32 v[194:195], v[194:195], v[216:217]
  v_lshlrev_b32 v18, 16, v177
  v_cvt_pk_bf16_f32 v195, v194, v195
  v_and_b32 v19, 0xffff0000, v177
  v_lshlrev_b32 v194, 16, v195
  v_and_b32 v195, 0xffff0000, v195
  v_pk_mul_f32 v[194:195], v[194:195], v[28:29]
  v_cvt_pk_bf16_f32 v165, v194, v195
  v_lshlrev_b32 v194, 16, v165
  v_and_b32 v195, 0xffff0000, v165
  v_pk_fma_f32 v[218:219], v[194:195], v[18:19], v[218:219]
  v_pk_add_f32 v[196:197], v[196:197], v[216:217]
  v_lshlrev_b32 v16, 16, v178
  v_cvt_pk_bf16_f32 v197, v196, v197
  v_and_b32 v17, 0xffff0000, v178
  v_lshlrev_b32 v196, 16, v197
  v_and_b32 v197, 0xffff0000, v197
  v_pk_mul_f32 v[196:197], v[196:197], v[28:29]
  v_cvt_pk_bf16_f32 v166, v196, v197
  v_lshlrev_b32 v196, 16, v166
  v_and_b32 v197, 0xffff0000, v166
  v_pk_fma_f32 v[218:219], v[196:197], v[16:17], v[218:219]
  v_pk_add_f32 v[198:199], v[198:199], v[216:217]
  v_lshlrev_b32 v18, 16, v179
  v_cvt_pk_bf16_f32 v199, v198, v199
  v_and_b32 v19, 0xffff0000, v179
  v_lshlrev_b32 v198, 16, v199
  v_and_b32 v199, 0xffff0000, v199
  v_pk_mul_f32 v[198:199], v[198:199], v[28:29]
  v_cvt_pk_bf16_f32 v167, v198, v199
  v_lshlrev_b32 v198, 16, v167
  v_and_b32 v199, 0xffff0000, v167
  v_pk_fma_f32 v[218:219], v[198:199], v[18:19], v[218:219]
  ds_write_b128 v220, v[164:167] offset:4096
  v_pk_add_f32 v[200:201], v[200:201], v[216:217]
  v_lshlrev_b32 v16, 16, v180
  v_cvt_pk_bf16_f32 v201, v200, v201
  v_and_b32 v17, 0xffff0000, v180
  v_lshlrev_b32 v200, 16, v201
  v_and_b32 v201, 0xffff0000, v201
  v_pk_mul_f32 v[200:201], v[200:201], v[28:29]
  v_cvt_pk_bf16_f32 v168, v200, v201
  v_lshlrev_b32 v200, 16, v168
  v_and_b32 v201, 0xffff0000, v168
  v_pk_fma_f32 v[218:219], v[200:201], v[16:17], v[218:219]
  v_pk_add_f32 v[202:203], v[202:203], v[216:217]
  v_lshlrev_b32 v18, 16, v181
  v_cvt_pk_bf16_f32 v203, v202, v203
  v_and_b32 v19, 0xffff0000, v181
  v_lshlrev_b32 v202, 16, v203
  v_and_b32 v203, 0xffff0000, v203
  v_pk_mul_f32 v[202:203], v[202:203], v[28:29]
  v_cvt_pk_bf16_f32 v169, v202, v203
  v_lshlrev_b32 v202, 16, v169
  v_and_b32 v203, 0xffff0000, v169
  v_pk_fma_f32 v[218:219], v[202:203], v[18:19], v[218:219]
  v_pk_add_f32 v[204:205], v[204:205], v[216:217]
  v_lshlrev_b32 v16, 16, v182
  v_cvt_pk_bf16_f32 v205, v204, v205
  v_and_b32 v17, 0xffff0000, v182
  v_lshlrev_b32 v204, 16, v205
  v_and_b32 v205, 0xffff0000, v205
  v_pk_mul_f32 v[204:205], v[204:205], v[28:29]
  v_cvt_pk_bf16_f32 v170, v204, v205
  v_lshlrev_b32 v204, 16, v170
  v_and_b32 v205, 0xffff0000, v170
  v_pk_fma_f32 v[218:219], v[204:205], v[16:17], v[218:219]
  v_pk_add_f32 v[206:207], v[206:207], v[216:217]
  v_lshlrev_b32 v18, 16, v183
  v_cvt_pk_bf16_f32 v207, v206, v207
  v_and_b32 v19, 0xffff0000, v183
  v_lshlrev_b32 v206, 16, v207
  v_and_b32 v207, 0xffff0000, v207
  v_pk_mul_f32 v[206:207], v[206:207], v[28:29]
  v_cvt_pk_bf16_f32 v171, v206, v207
  v_lshlrev_b32 v206, 16, v171
  v_and_b32 v207, 0xffff0000, v171
  v_pk_fma_f32 v[218:219], v[206:207], v[18:19], v[218:219]
  ds_write_b128 v220, v[168:171] offset:8192
  v_add_f32 v218, v218, v219
  s_nop 1
  v_add_f32_dpp v218, v218, v218 quad_perm:[1,0,3,2] row_mask:0xf bank_mask:0xf
  s_nop 1
  v_add_f32_dpp v218, v218, v218 quad_perm:[2,3,0,1] row_mask:0xf bank_mask:0xf
  s_nop 1
  v_add_f32_dpp v218, v218, v218 row_half_mirror row_mask:0xf bank_mask:0xf
  s_nop 1
  v_add_f32_dpp v218, v218, v218 row_mirror row_mask:0xf bank_mask:0xf
  v_mov_b32 v214, v218
  s_nop 1
  v_permlane16_swap_b32 v218, v214
  v_add_f32 v218, v218, v214
  v_cvt_pk_bf16_f32 v218, v218, v218
  v_and_b32 v218, 0xffff0000, v218
  v_ashrrev_i32 v214, 31, v218
  v_or_b32 v214, 0x80000000, v214
  v_xor_b32 v218, v218, v214
  v_and_b32 v218, 0xffff0000, v218
  v_or_b32 v218, v218, v209
  v_mov_b32 v19, 1073741824
  s_mov_b32 m0, s24
  s_nop 0
  buffer_load_dwordx4 v3, s[32:35], s26 offen offset:0 sc1 lds
  buffer_load_dwordx4 v4, s[32:35], s26 offen offset:1024 sc1 lds
  buffer_load_dwordx4 v5, s[32:35], s26 offen offset:2048 sc1 lds
  buffer_load_dwordx4 v6, s[32:35], s26 offen offset:3072 sc1 lds
  s_add_u32 m0, s24, 16384
  s_nop 0
  buffer_load_dwordx4 v8, s[36:39], s27 offen offset:0 lds
  buffer_load_dwordx4 v9, s[36:39], s27 offen offset:1024 lds
  buffer_load_dwordx4 v10, s[36:39], s27 offen offset:2048 lds
  buffer_load_dwordx4 v11, s[36:39], s27 offen offset:3072 lds
  s_add_u32 s26, s26, s79
  s_add_u32 s27, s27, s25
  s_add_u32 s24, s24, 32768
  s_and_b32 s24, s24, 0x1ffff
  s_mov_b32 m0, s24
  s_nop 0
  buffer_load_dwordx4 v3, s[32:35], s26 offen offset:0 sc1 lds
  buffer_load_dwordx4 v4, s[32:35], s26 offen offset:1024 sc1 lds
  buffer_load_dwordx4 v5, s[32:35], s26 offen offset:2048 sc1 lds
  buffer_load_dwordx4 v6, s[32:35], s26 offen offset:3072 sc1 lds
  s_add_u32 m0, s24, 16384
  s_nop 0
  buffer_load_dwordx4 v8, s[36:39], s27 offen offset:0 lds
  buffer_load_dwordx4 v9, s[36:39], s27 offen offset:1024 lds
  buffer_load_dwordx4 v10, s[36:39], s27 offen offset:2048 lds
  buffer_load_dwordx4 v11, s[36:39], s27 offen offset:3072 lds
  s_add_u32 s26, s26, s79
  s_add_u32 s27, s27, s25
  s_add_u32 s24, s24, 32768
  s_and_b32 s24, s24, 0x1ffff
  s_mov_b32 m0, s24
  s_nop 0
  buffer_load_dwordx4 v3, s[32:35], s26 offen offset:0 sc1 lds
  buffer_load_dwordx4 v4, s[32:35], s26 offen offset:1024 sc1 lds
  buffer_load_dwordx4 v5, s[32:35], s26 offen offset:2048 sc1 lds
  buffer_load_dwordx4 v6, s[32:35], s26 offen offset:3072 sc1 lds
  s_add_u32 m0, s24, 16384
  s_nop 0
  buffer_load_dwordx4 v8, s[36:39], s27 offen offset:0 lds
  buffer_load_dwordx4 v9, s[36:39], s27 offen offset:1024 lds
  buffer_load_dwordx4 v10, s[36:39], s27 offen offset:2048 lds
  buffer_load_dwordx4 v11, s[36:39], s27 offen offset:3072 lds
  s_add_u32 s26, s26, s79
  s_add_u32 s27, s27, s25
  s_add_u32 s24, s24, 32768
  s_and_b32 s24, s24, 0x1ffff
  buffer_load_dword v231, v19, s[32:35], 0 offen
  s_mov_b32 m0, s24
  s_nop 0
  buffer_load_dwordx4 v3, s[32:35], s26 offen offset:0 sc1 lds
  buffer_load_dwordx4 v4, s[32:35], s26 offen offset:1024 sc1 lds
  buffer_load_dwordx4 v5, s[32:35], s26 offen offset:2048 sc1 lds
  buffer_load_dwordx4 v6, s[32:35], s26 offen offset:3072 sc1 lds
  s_add_u32 m0, s24, 16384
  s_nop 0
  buffer_load_dwordx4 v8, s[36:39], s27 offen offset:0 lds
  buffer_load_dwordx4 v9, s[36:39], s27 offen offset:1024 lds
  buffer_load_dwordx4 v10, s[36:39], s27 offen offset:2048 lds
  buffer_load_dwordx4 v11, s[36:39], s27 offen offset:3072 lds
  s_add_u32 s26, s26, s79
  s_add_u32 s27, s27, s25
  s_add_u32 s24, s24, 32768
  s_and_b32 s24, s24, 0x1ffff
  s_waitcnt vmcnt(25) lgkmcnt(0)
  s_barrier
  s_cmp_ge_u32 s20, 2
  s_cbranch_scc1 fa_roleV
  ds_read_b128 v[96:99], v14 offset:0
  ds_read_b128 v[100:103], v14 offset:1024
  ds_read_b128 v[104:107], v14 offset:2048
  ds_read_b128 v[108:111], v14 offset:3072
  ds_read_b128 v[112:115], v14 offset:4096
  ds_read_b128 v[116:119], v14 offset:5120
  ds_read_b128 v[120:123], v14 offset:6144
  ds_read_b128 v[124:127], v14 offset:7168
  ds_read_b64_tr_b16 v[32:33], v12 offset:0
  ds_read_b64_tr_b16 v[34:35], v12 offset:1024
  ds_read_b64_tr_b16 v[36:37], v13 offset:0
  ds_read_b64_tr_b16 v[38:39], v13 offset:1024
  ds_read_b64_tr_b16 v[40:41], v12 offset:256
  ds_read_b64_tr_b16 v[42:43], v12 offset:1280
  ds_read_b64_tr_b16 v[44:45], v13 offset:256
  ds_read_b64_tr_b16 v[46:47], v13 offset:1280
  ds_read_b64_tr_b16 v[48:49], v12 offset:512
  ds_read_b64_tr_b16 v[50:51], v12 offset:1536
  ds_read_b64_tr_b16 v[52:53], v13 offset:512
  ds_read_b64_tr_b16 v[54:55], v13 offset:1536
  ds_read_b64_tr_b16 v[56:57], v12 offset:768
  ds_read_b64_tr_b16 v[58:59], v12 offset:1792
  ds_read_b64_tr_b16 v[60:61], v13 offset:768
  ds_read_b64_tr_b16 v[62:63], v13 offset:1792
  s_waitcnt lgkmcnt(0)
.p2align 6
fa_loopK:
  v_mfma_f32_16x16x32_bf16 a[0:3], v[32:35], v[96:99], a[0:3]
  s_waitcnt vmcnt(17)
  v_mfma_f32_16x16x32_bf16 a[4:7], v[32:35], v[100:103], a[4:7]
  s_barrier
  v_mfma_f32_16x16x32_bf16 a[8:11], v[32:35], v[104:107], a[8:11]
  ds_read_b64_tr_b16 v[64:65], v12 offset:32768
  v_mfma_f32_16x16x32_bf16 a[12:15], v[32:35], v[108:111], a[12:15]
  v_mfma_f32_16x16x32_bf16 a[16:19], v[32:35], v[112:115], a[16:19]
  s_mov_b32 m0, s24
  ds_read_b64_tr_b16 v[66:67], v12 offset:33792
  v_mfma_f32_16x16x32_bf16 a[20:23], v[32:35], v[116:119], a[20:23]
  buffer_load_dwordx4 v3, s[32:35], s26 offen offset:0 sc1 lds
  v_mfma_f32_16x16x32_bf16 a[24:27], v[32:35], v[120:123], a[24:27]
  ds_read_b128 v[128:131], v14 offset:32768
  v_mfma_f32_16x16x32_bf16 a[28:31], v[32:35], v[124:127], a[28:31]
  buffer_load_dwordx4 v4, s[32:35], s26 offen offset:1024 sc1 lds
  v_mfma_f32_16x16x32_bf16 a[32:35], v[36:39], v[96:99], a[32:35]
  ds_read_b64_tr_b16 v[68:69], v13 offset:32768
  v_mfma_f32_16x16x32_bf16 a[36:39], v[36:39], v[100:103], a[36:39]
  buffer_load_dwordx4 v5, s[32:35], s26 offen offset:2048 sc1 lds
  v_mfma_f32_16x16x32_bf16 a[40:43], v[36:39], v[104:107], a[40:43]
  ds_read_b64_tr_b16 v[70:71], v13 offset:33792
  v_mfma_f32_16x16x32_bf16 a[44:47], v[36:39], v[108:111], a[44:47]
  buffer_load_dwordx4 v6, s[32:35], s26 offen offset:3072 sc1 lds
  v_mfma_f32_16x16x32_bf16 a[48:51], v[36:39], v[112:115], a[48:51]
  s_add_u32 m0, s24, 16384
  ds_read_b128 v[132:135], v14 offset:33792
  v_mfma_f32_16x16x32_bf16 a[52:55], v[36:39], v[116:119], a[52:55]
  buffer_load_dwordx4 v8, s[36:39], s27 offen offset:0 lds
  v_mfma_f32_16x16x32_bf16 a[56:59], v[36:39], v[120:123], a[56:59]
  ds_read_b64_tr_b16 v[72:73], v12 offset:33024
  v_mfma_f32_16x16x32_bf16 a[60:63], v[36:39], v[124:127], a[60:63]
  buffer_load_dwordx4 v9, s[36:39], s27 offen offset:1024 lds
  v_mfma_f32_16x16x32_bf16 a[64:67], v[40:43], v[96:99], a[64:67]
  ds_read_b64_tr_b16 v[74:75], v12 offset:34048
  v_mfma_f32_16x16x32_bf16 a[68:71], v[40:43], v[100:103], a[68:71]
  buffer_load_dwordx4 v10, s[36:39], s27 offen offset:2048 lds
  v_mfma_f32_16x16x32_bf16 a[72:75], v[40:43], v[104:107], a[72:75]
  ds_read_b128 v[136:139], v14 offset:34816
  v_mfma_f32_16x16x32_bf16 a[76:79], v[40:43], v[108:111], a[76:79]
  buffer_load_dwordx4 v11, s[36:39], s27 offen offset:3072 lds
  v_mfma_f32_16x16x32_bf16 a[80:83], v[40:43], v[112:115], a[80:83]
  ds_read_b64_tr_b16 v[76:77], v13 offset:33024
  v_mfma_f32_16x16x32_bf16 a[84:87], v[40:43], v[116:119], a[84:87]
  buffer_load_dword v231, v235, s[48:51], s74 offen
  v_mfma_f32_16x16x32_bf16 a[88:91], v[40:43], v[120:123], a[88:91]
  s_add_u32 s74, s74, s73
  ds_read_b64_tr_b16 v[78:79], v13 offset:34048
  v_mfma_f32_16x16x32_bf16 a[92:95], v[40:43], v[124:127], a[92:95]
  s_bitcmp1_b32 s72, s28
  v_mfma_f32_16x16x32_bf16 a[96:99], v[44:47], v[96:99], a[96:99]
  s_cbranch_scc1 fa_hk0
fa_hb0:
  ds_read_b128 v[140:143], v14 offset:35840
  v_mfma_f32_16x16x32_bf16 a[100:103], v[44:47], v[100:103], a[100:103]
  v_mfma_f32_16x16x32_bf16 a[104:107], v[44:47], v[104:107], a[104:107]
  ds_read_b64_tr_b16 v[80:81], v12 offset:33280
  v_mfma_f32_16x16x32_bf16 a[108:111], v[44:47], v[108:111], a[108:111]
  v_mfma_f32_16x16x32_bf16 a[112:115], v[44:47], v[112:115], a[112:115]
  ds_read_b64_tr_b16 v[82:83], v12 offset:34304
  v_mfma_f32_16x16x32_bf16 a[116:119], v[44:47], v[116:119], a[116:119]
  v_mfma_f32_16x16x32_bf16 a[120:123], v[44:47], v[120:123], a[120:123]
  ds_read_b128 v[144:147], v14 offset:36864
  v_mfma_f32_16x16x32_bf16 a[124:127], v[44:47], v[124:127], a[124:127]
  v_mfma_f32_16x16x32_bf16 a[128:131], v[48:51], v[96:99], a[128:131]
  ds_read_b64_tr_b16 v[84:85], v13 offset:33280
  v_mfma_f32_16x16x32_bf16 a[132:135], v[48:51], v[100:103], a[132:135]
  v_mfma_f32_16x16x32_bf16 a[136:139], v[48:51], v[104:107], a[136:139]
  ds_read_b64_tr_b16 v[86:87], v13 offset:34304
  v_mfma_f32_16x16x32_bf16 a[140:143], v[48:51], v[108:111], a[140:143]
  v_mfma_f32_16x16x32_bf16 a[144:147], v[48:51], v[112:115], a[144:147]
  ds_read_b128 v[148:151], v14 offset:37888
  v_mfma_f32_16x16x32_bf16 a[148:151], v[48:51], v[116:119], a[148:151]
  v_mfma_f32_16x16x32_bf16 a[152:155], v[48:51], v[120:123], a[152:155]
  ds_read_b64_tr_b16 v[88:89], v12 offset:33536
  v_mfma_f32_16x16x32_bf16 a[156:159], v[48:51], v[124:127], a[156:159]
  v_mfma_f32_16x16x32_bf16 a[160:163], v[52:55], v[96:99], a[160:163]
  ds_read_b64_tr_b16 v[90:91], v12 offset:34560
  v_mfma_f32_16x16x32_bf16 a[164:167], v[52:55], v[100:103], a[164:167]
  v_mfma_f32_16x16x32_bf16 a[168:171], v[52:55], v[104:107], a[168:171]
  ds_read_b128 v[152:155], v14 offset:38912
  v_mfma_f32_16x16x32_bf16 a[172:175], v[52:55], v[108:111], a[172:175]
  v_mfma_f32_16x16x32_bf16 a[176:179], v[52:55], v[112:115], a[176:179]
  ds_read_b64_tr_b16 v[92:93], v13 offset:33536
  v_mfma_f32_16x16x32_bf16 a[180:183], v[52:55], v[116:119], a[180:183]
  v_mfma_f32_16x16x32_bf16 a[184:187], v[52:55], v[120:123], a[184:187]
  ds_read_b64_tr_b16 v[94:95], v13 offset:34560
  v_mfma_f32_16x16x32_bf16 a[188:191], v[52:55], v[124:127], a[188:191]
  v_mfma_f32_16x16x32_bf16 a[192:195], v[56:59], v[96:99], a[192:195]
  s_add_u32 s26, s26, s79
  ds_read_b128 v[156:159], v14 offset:39936
  v_mfma_f32_16x16x32_bf16 a[196:199], v[56:59], v[100:103], a[196:199]
  s_add_u32 s27, s27, s25
  v_mfma_f32_16x16x32_bf16 a[200:203], v[56:59], v[104:107], a[200:203]
  s_add_u32 s24, s24, 32768
  v_mfma_f32_16x16x32_bf16 a[204:207], v[56:59], v[108:111], a[204:207]
  s_and_b32 s24, s24, 0x1ffff
  v_mfma_f32_16x16x32_bf16 a[208:211], v[56:59], v[112:115], a[208:211]
  v_xor_b32 v14, 0x10000, v14
  v_mfma_f32_16x16x32_bf16 a[212:215], v[56:59], v[116:119], a[212:215]
  v_xor_b32 v12, 0x10000, v12
  v_mfma_f32_16x16x32_bf16 a[216:219], v[56:59], v[120:123], a[216:219]
  v_xor_b32 v13, 0x10000, v13
  v_mfma_f32_16x16x32_bf16 a[220:223], v[56:59], v[124:127], a[220:223]
  v_mfma_f32_16x16x32_bf16 a[224:227], v[60:63], v[96:99], a[224:227]
  v_mfma_f32_16x16x32_bf16 a[228:231], v[60:63], v[100:103], a[228:231]
  v_mfma_f32_16x16x32_bf16 a[232:235], v[60:63], v[104:107], a[232:235]
  v_mfma_f32_16x16x32_bf16 a[236:239], v[60:63], v[108:111], a[236:239]
  v_mfma_f32_16x16x32_bf16 a[240:243], v[60:63], v[112:115], a[240:243]
  v_mfma_f32_16x16x32_bf16 a[244:247], v[60:63], v[116:119], a[244:247]
  v_mfma_f32_16x16x32_bf16 a[248:251], v[60:63], v[120:123], a[248:251]
  v_mfma_f32_16x16x32_bf16 a[252:255], v[60:63], v[124:127], a[252:255]
  s_waitcnt lgkmcnt(0)
  v_mfma_f32_16x16x32_bf16 a[0:3], v[64:67], v[128:131], a[0:3]
  s_waitcnt vmcnt(18)
  v_mfma_f32_16x16x32_bf16 a[4:7], v[64:67], v[132:135], a[4:7]
  s_barrier
  v_mfma_f32_16x16x32_bf16 a[8:11], v[64:67], v[136:139], a[8:11]
  ds_read_b64_tr_b16 v[32:33], v12 offset:0
  v_mfma_f32_16x16x32_bf16 a[12:15], v[64:67], v[140:143], a[12:15]
  v_mfma_f32_16x16x32_bf16 a[16:19], v[64:67], v[144:147], a[16:19]
  s_mov_b32 m0, s24
  ds_read_b64_tr_b16 v[34:35], v12 offset:1024
  v_mfma_f32_16x16x32_bf16 a[20:23], v[64:67], v[148:151], a[20:23]
  buffer_load_dwordx4 v3, s[32:35], s26 offen offset:0 sc1 lds
  v_mfma_f32_16x16x32_bf16 a[24:27], v[64:67], v[152:155], a[24:27]
  ds_read_b128 v[96:99], v14 offset:0
  v_mfma_f32_16x16x32_bf16 a[28:31], v[64:67], v[156:159], a[28:31]
  v_mfma_f32_16x16x32_bf16 a[32:35], v[68:71], v[128:131], a[32:35]
  ds_read_b64_tr_b16 v[36:37], v13 offset:0
  v_mfma_f32_16x16x32_bf16 a[36:39], v[68:71], v[132:135], a[36:39]
  v_mfma_f32_16x16x32_bf16 a[40:43], v[68:71], v[136:139], a[40:43]
  ds_read_b64_tr_b16 v[38:39], v13 offset:1024
  v_mfma_f32_16x16x32_bf16 a[44:47], v[68:71], v[140:143], a[44:47]
  buffer_load_dwordx4 v4, s[32:35], s26 offen offset:1024 sc1 lds
  v_mfma_f32_16x16x32_bf16 a[48:51], v[68:71], v[144:147], a[48:51]
  ds_read_b128 v[100:103], v14 offset:1024
  v_mfma_f32_16x16x32_bf16 a[52:55], v[68:71], v[148:151], a[52:55]
  v_mfma_f32_16x16x32_bf16 a[56:59], v[68:71], v[152:155], a[56:59]
  ds_read_b64_tr_b16 v[40:41], v12 offset:256
  v_mfma_f32_16x16x32_bf16 a[60:63], v[68:71], v[156:159], a[60:63]
  v_mfma_f32_16x16x32_bf16 a[64:67], v[72:75], v[128:131], a[64:67]
  ds_read_b64_tr_b16 v[42:43], v12 offset:1280
  v_mfma_f32_16x16x32_bf16 a[68:71], v[72:75], v[132:135], a[68:71]
  buffer_load_dwordx4 v5, s[32:35], s26 offen offset:2048 sc1 lds
  v_mfma_f32_16x16x32_bf16 a[72:75], v[72:75], v[136:139], a[72:75]
  ds_read_b128 v[104:107], v14 offset:2048
  v_mfma_f32_16x16x32_bf16 a[76:79], v[72:75], v[140:143], a[76:79]
  v_mfma_f32_16x16x32_bf16 a[80:83], v[72:75], v[144:147], a[80:83]
  ds_read_b64_tr_b16 v[44:45], v13 offset:256
  v_mfma_f32_16x16x32_bf16 a[84:87], v[72:75], v[148:151], a[84:87]
  v_mfma_f32_16x16x32_bf16 a[88:91], v[72:75], v[152:155], a[88:91]
  ds_read_b64_tr_b16 v[46:47], v13 offset:1280
  v_mfma_f32_16x16x32_bf16 a[92:95], v[72:75], v[156:159], a[92:95]
  buffer_load_dwordx4 v6, s[32:35], s26 offen offset:3072 sc1 lds
  v_mfma_f32_16x16x32_bf16 a[96:99], v[76:79], v[128:131], a[96:99]
  ds_read_b128 v[108:111], v14 offset:3072
  v_mfma_f32_16x16x32_bf16 a[100:103], v[76:79], v[132:135], a[100:103]
  v_mfma_f32_16x16x32_bf16 a[104:107], v[76:79], v[136:139], a[104:107]
  ds_read_b64_tr_b16 v[48:49], v12 offset:512
  v_mfma_f32_16x16x32_bf16 a[108:111], v[76:79], v[140:143], a[108:111]
  v_mfma_f32_16x16x32_bf16 a[112:115], v[76:79], v[144:147], a[112:115]
  s_add_u32 m0, s24, 16384
  ds_read_b64_tr_b16 v[50:51], v12 offset:1536
  v_mfma_f32_16x16x32_bf16 a[116:119], v[76:79], v[148:151], a[116:119]
  buffer_load_dwordx4 v8, s[36:39], s27 offen offset:0 lds
  v_mfma_f32_16x16x32_bf16 a[120:123], v[76:79], v[152:155], a[120:123]
  ds_read_b128 v[112:115], v14 offset:4096
  v_mfma_f32_16x16x32_bf16 a[124:127], v[76:79], v[156:159], a[124:127]
  v_mfma_f32_16x16x32_bf16 a[128:131], v[80:83], v[128:131], a[128:131]
  ds_read_b64_tr_b16 v[52:53], v13 offset:512
  v_mfma_f32_16x16x32_bf16 a[132:135], v[80:83], v[132:135], a[132:135]
  v_mfma_f32_16x16x32_bf16 a[136:139], v[80:83], v[136:139], a[136:139]
  ds_read_b64_tr_b16 v[54:55], v13 offset:1536
  v_mfma_f32_16x16x32_bf16 a[140:143], v[80:83], v[140:143], a[140:143]
  buffer_load_dwordx4 v9, s[36:39], s27 offen offset:1024 lds
  v_mfma_f32_16x16x32_bf16 a[144:147], v[80:83], v[144:147], a[144:147]
  ds_read_b128 v[116:119], v14 offset:5120
  v_mfma_f32_16x16x32_bf16 a[148:151], v[80:83], v[148:151], a[148:151]
  v_mfma_f32_16x16x32_bf16 a[152:155], v[80:83], v[152:155], a[152:155]
  ds_read_b64_tr_b16 v[56:57], v12 offset:768
  v_mfma_f32_16x16x32_bf16 a[156:159], v[80:83], v[156:159], a[156:159]
  v_mfma_f32_16x16x32_bf16 a[160:163], v[84:87], v[128:131], a[160:163]
  ds_read_b64_tr_b16 v[58:59], v12 offset:1792
  v_mfma_f32_16x16x32_bf16 a[164:167], v[84:87], v[132:135], a[164:167]
  buffer_load_dwordx4 v10, s[36:39], s27 offen offset:2048 lds
  v_mfma_f32_16x16x32_bf16 a[168:171], v[84:87], v[136:139], a[168:171]
  ds_read_b128 v[120:123], v14 offset:6144
  v_mfma_f32_16x16x32_bf16 a[172:175], v[84:87], v[140:143], a[172:175]
  v_mfma_f32_16x16x32_bf16 a[176:179], v[84:87], v[144:147], a[176:179]
  ds_read_b64_tr_b16 v[60:61], v13 offset:768
  v_mfma_f32_16x16x32_bf16 a[180:183], v[84:87], v[148:151], a[180:183]
  v_mfma_f32_16x16x32_bf16 a[184:187], v[84:87], v[152:155], a[184:187]
  ds_read_b64_tr_b16 v[62:63], v13 offset:1792
  v_mfma_f32_16x16x32_bf16 a[188:191], v[84:87], v[156:159], a[188:191]
  buffer_load_dwordx4 v11, s[36:39], s27 offen offset:3072 lds
  v_mfma_f32_16x16x32_bf16 a[192:195], v[88:91], v[128:131], a[192:195]
  s_add_u32 s26, s26, s79
  ds_read_b128 v[124:127], v14 offset:7168
  v_mfma_f32_16x16x32_bf16 a[196:199], v[88:91], v[132:135], a[196:199]
  s_add_u32 s27, s27, s25
  v_mfma_f32_16x16x32_bf16 a[200:203], v[88:91], v[136:139], a[200:203]
  s_add_u32 s24, s24, 32768
  v_mfma_f32_16x16x32_bf16 a[204:207], v[88:91], v[140:143], a[204:207]
  s_and_b32 s24, s24, 0x1ffff
  v_mfma_f32_16x16x32_bf16 a[208:211], v[88:91], v[144:147], a[208:211]
  v_mfma_f32_16x16x32_bf16 a[212:215], v[88:91], v[148:151], a[212:215]
  s_bitcmp1_b32 s76, s28
  v_mfma_f32_16x16x32_bf16 a[216:219], v[88:91], v[152:155], a[216:219]
  s_cbranch_scc1 fa_hk1
fa_hb1:
  v_mfma_f32_16x16x32_bf16 a[220:223], v[88:91], v[156:159], a[220:223]
  v_mfma_f32_16x16x32_bf16 a[224:227], v[92:95], v[128:131], a[224:227]
  v_mfma_f32_16x16x32_bf16 a[228:231], v[92:95], v[132:135], a[228:231]
  s_add_u32 s28, s28, 1
  v_mfma_f32_16x16x32_bf16 a[232:235], v[92:95], v[136:139], a[232:235]
  v_mfma_f32_16x16x32_bf16 a[236:239], v[92:95], v[140:143], a[236:239]
  v_mfma_f32_16x16x32_bf16 a[240:243], v[92:95], v[144:147], a[240:243]
  v_mfma_f32_16x16x32_bf16 a[244:247], v[92:95], v[148:151], a[244:247]
  s_cmp_lt_u32 s28, 8
  v_mfma_f32_16x16x32_bf16 a[248:251], v[92:95], v[152:155], a[248:251]
  s_waitcnt lgkmcnt(0)
  v_mfma_f32_16x16x32_bf16 a[252:255], v[92:95], v[156:159], a[252:255]
  s_cbranch_scc1 fa_loopK
  s_mov_b32 s60, 2048
  s_mov_b32 s61, 8192
  s_mov_b32 s62, 16777216
  s_branch fa_p1epi
fa_roleV:
  ds_read_b128 v[32:35], v14 offset:0
  ds_read_b128 v[36:39], v14 offset:1024
  ds_read_b128 v[40:43], v14 offset:2048
  ds_read_b128 v[44:47], v14 offset:3072
  ds_read_b128 v[48:51], v14 offset:4096
  ds_read_b128 v[52:55], v14 offset:5120
  ds_read_b128 v[56:59], v14 offset:6144
  ds_read_b128 v[60:63], v14 offset:7168
  ds_read_b64_tr_b16 v[96:97], v12 offset:0
  ds_read_b64_tr_b16 v[98:99], v12 offset:1024
  ds_read_b64_tr_b16 v[100:101], v13 offset:0
  ds_read_b64_tr_b16 v[102:103], v13 offset:1024
  ds_read_b64_tr_b16 v[104:105], v12 offset:256
  ds_read_b64_tr_b16 v[106:107], v12 offset:1280
  ds_read_b64_tr_b16 v[108:109], v13 offset:256
  ds_read_b64_tr_b16 v[110:111], v13 offset:1280
  ds_read_b64_tr_b16 v[112:113], v12 offset:512
  ds_read_b64_tr_b16 v[114:115], v12 offset:1536
  ds_read_b64_tr_b16 v[116:117], v13 offset:512
  ds_read_b64_tr_b16 v[118:119], v13 offset:1536
  ds_read_b64_tr_b16 v[120:121], v12 offset:768
  ds_read_b64_tr_b16 v[122:123], v12 offset:1792
  ds_read_b64_tr_b16 v[124:125], v13 offset:768
  ds_read_b64_tr_b16 v[126:127], v13 offset:1792
  s_waitcnt lgkmcnt(0)
.p2align 6
fa_loopV:
  v_mfma_f32_16x16x32_bf16 a[0:3], v[32:35], v[96:99], a[0:3]
  s_waitcnt vmcnt(17)
  v_mfma_f32_16x16x32_bf16 a[4:7], v[32:35], v[100:103], a[4:7]
  s_barrier
  v_mfma_f32_16x16x32_bf16 a[8:11], v[32:35], v[104:107], a[8:11]
  ds_read_b64_tr_b16 v[128:129], v12 offset:32768
  v_mfma_f32_16x16x32_bf16 a[12:15], v[32:35], v[108:111], a[12:15]
  v_mfma_f32_16x16x32_bf16 a[16:19], v[32:35], v[112:115], a[16:19]
  s_mov_b32 m0, s24
  ds_read_b64_tr_b16 v[130:131], v12 offset:33792
  v_mfma_f32_16x16x32_bf16 a[20:23], v[32:35], v[116:119], a[20:23]
  buffer_load_dwordx4 v3, s[32:35], s26 offen offset:0 sc1 lds
  v_mfma_f32_16x16x32_bf16 a[24:27], v[32:35], v[120:123], a[24:27]
  ds_read_b128 v[64:67], v14 offset:32768
  v_mfma_f32_16x16x32_bf16 a[28:31], v[32:35], v[124:127], a[28:31]
  buffer_load_dwordx4 v4, s[32:35], s26 offen offset:1024 sc1 lds
  v_mfma_f32_16x16x32_bf16 a[32:35], v[36:39], v[96:99], a[32:35]
  ds_read_b64_tr_b16 v[132:133], v13 offset:32768
  v_mfma_f32_16x16x32_bf16 a[36:39], v[36:39], v[100:103], a[36:39]
  buffer_load_dwordx4 v5, s[32:35], s26 offen offset:2048 sc1 lds
  v_mfma_f32_16x16x32_bf16 a[40:43], v[36:39], v[104:107], a[40:43]
  ds_read_b64_tr_b16 v[134:135], v13 offset:33792
  v_mfma_f32_16x16x32_bf16 a[44:47], v[36:39], v[108:111], a[44:47]
  buffer_load_dwordx4 v6, s[32:35], s26 offen offset:3072 sc1 lds
  v_mfma_f32_16x16x32_bf16 a[48:51], v[36:39], v[112:115], a[48:51]
  s_add_u32 m0, s24, 16384
  ds_read_b128 v[68:71], v14 offset:33792
  v_mfma_f32_16x16x32_bf16 a[52:55], v[36:39], v[116:119], a[52:55]
  buffer_load_dwordx4 v8, s[36:39], s27 offen offset:0 lds
  v_mfma_f32_16x16x32_bf16 a[56:59], v[36:39], v[120:123], a[56:59]
  ds_read_b64_tr_b16 v[136:137], v12 offset:33024
  v_mfma_f32_16x16x32_bf16 a[60:63], v[36:39], v[124:127], a[60:63]
  buffer_load_dwordx4 v9, s[36:39], s27 offen offset:1024 lds
  v_mfma_f32_16x16x32_bf16 a[64:67], v[40:43], v[96:99], a[64:67]
  ds_read_b64_tr_b16 v[138:139], v12 offset:34048
  v_mfma_f32_16x16x32_bf16 a[68:71], v[40:43], v[100:103], a[68:71]
  buffer_load_dwordx4 v10, s[36:39], s27 offen offset:2048 lds
  v_mfma_f32_16x16x32_bf16 a[72:75], v[40:43], v[104:107], a[72:75]
  ds_read_b128 v[72:75], v14 offset:34816
  v_mfma_f32_16x16x32_bf16 a[76:79], v[40:43], v[108:111], a[76:79]
  buffer_load_dwordx4 v11, s[36:39], s27 offen offset:3072 lds
  v_mfma_f32_16x16x32_bf16 a[80:83], v[40:43], v[112:115], a[80:83]
  ds_read_b64_tr_b16 v[140:141], v13 offset:33024
  v_mfma_f32_16x16x32_bf16 a[84:87], v[40:43], v[116:119], a[84:87]
  buffer_load_dword v231, v235, s[48:51], s74 offen
  v_mfma_f32_16x16x32_bf16 a[88:91], v[40:43], v[120:123], a[88:91]
  s_add_u32 s74, s74, s73
  ds_read_b64_tr_b16 v[142:143], v13 offset:34048
  v_mfma_f32_16x16x32_bf16 a[92:95], v[40:43], v[124:127], a[92:95]
  s_bitcmp1_b32 s72, s28
  v_mfma_f32_16x16x32_bf16 a[96:99], v[44:47], v[96:99], a[96:99]
  s_cbranch_scc1 fa_hk2
fa_hb2:
  ds_read_b128 v[76:79], v14 offset:35840
  v_mfma_f32_16x16x32_bf16 a[100:103], v[44:47], v[100:103], a[100:103]
  v_mfma_f32_16x16x32_bf16 a[104:107], v[44:47], v[104:107], a[104:107]
  ds_read_b64_tr_b16 v[144:145], v12 offset:33280
  v_mfma_f32_16x16x32_bf16 a[108:111], v[44:47], v[108:111], a[108:111]
  v_mfma_f32_16x16x32_bf16 a[112:115], v[44:47], v[112:115], a[112:115]
  ds_read_b64_tr_b16 v[146:147], v12 offset:34304
  v_mfma_f32_16x16x32_bf16 a[116:119], v[44:47], v[116:119], a[116:119]
  v_mfma_f32_16x16x32_bf16 a[120:123], v[44:47], v[120:123], a[120:123]
  ds_read_b128 v[80:83], v14 offset:36864
  v_mfma_f32_16x16x32_bf16 a[124:127], v[44:47], v[124:127], a[124:127]
  v_mfma_f32_16x16x32_bf16 a[128:131], v[48:51], v[96:99], a[128:131]
  ds_read_b64_tr_b16 v[148:149], v13 offset:33280
  v_mfma_f32_16x16x32_bf16 a[132:135], v[48:51], v[100:103], a[132:135]
  v_mfma_f32_16x16x32_bf16 a[136:139], v[48:51], v[104:107], a[136:139]
  ds_read_b64_tr_b16 v[150:151], v13 offset:34304
  v_mfma_f32_16x16x32_bf16 a[140:143], v[48:51], v[108:111], a[140:143]
  v_mfma_f32_16x16x32_bf16 a[144:147], v[48:51], v[112:115], a[144:147]
  ds_read_b128 v[84:87], v14 offset:37888
  v_mfma_f32_16x16x32_bf16 a[148:151], v[48:51], v[116:119], a[148:151]
  v_mfma_f32_16x16x32_bf16 a[152:155], v[48:51], v[120:123], a[152:155]
  ds_read_b64_tr_b16 v[152:153], v12 offset:33536
  v_mfma_f32_16x16x32_bf16 a[156:159], v[48:51], v[124:127], a[156:159]
  v_mfma_f32_16x16x32_bf16 a[160:163], v[52:55], v[96:99], a[160:163]
  ds_read_b64_tr_b16 v[154:155], v12 offset:34560
  v_mfma_f32_16x16x32_bf16 a[164:167], v[52:55], v[100:103], a[164:167]
  v_mfma_f32_16x16x32_bf16 a[168:171], v[52:55], v[104:107], a[168:171]
  ds_read_b128 v[88:91], v14 offset:38912
  v_mfma_f32_16x16x32_bf16 a[172:175], v[52:55], v[108:111], a[172:175]
  v_mfma_f32_16x16x32_bf16 a[176:179], v[52:55], v[112:115], a[176:179]
  ds_read_b64_tr_b16 v[156:157], v13 offset:33536
  v_mfma_f32_16x16x32_bf16 a[180:183], v[52:55], v[116:119], a[180:183]
  v_mfma_f32_16x16x32_bf16 a[184:187], v[52:55], v[120:123], a[184:187]
  ds_read_b64_tr_b16 v[158:159], v13 offset:34560
  v_mfma_f32_16x16x32_bf16 a[188:191], v[52:55], v[124:127], a[188:191]
  v_mfma_f32_16x16x32_bf16 a[192:195], v[56:59], v[96:99], a[192:195]
  s_add_u32 s26, s26, s79
  ds_read_b128 v[92:95], v14 offset:39936
  v_mfma_f32_16x16x32_bf16 a[196:199], v[56:59], v[100:103], a[196:199]
  s_add_u32 s27, s27, s25
  v_mfma_f32_16x16x32_bf16 a[200:203], v[56:59], v[104:107], a[200:203]
  s_add_u32 s24, s24, 32768
  v_mfma_f32_16x16x32_bf16 a[204:207], v[56:59], v[108:111], a[204:207]
  s_and_b32 s24, s24, 0x1ffff
  v_mfma_f32_16x16x32_bf16 a[208:211], v[56:59], v[112:115], a[208:211]
  v_xor_b32 v14, 0x10000, v14
  v_mfma_f32_16x16x32_bf16 a[212:215], v[56:59], v[116:119], a[212:215]
  v_xor_b32 v12, 0x10000, v12
  v_mfma_f32_16x16x32_bf16 a[216:219], v[56:59], v[120:123], a[216:219]
  v_xor_b32 v13, 0x10000, v13
  v_mfma_f32_16x16x32_bf16 a[220:223], v[56:59], v[124:127], a[220:223]
  v_mfma_f32_16x16x32_bf16 a[224:227], v[60:63], v[96:99], a[224:227]
  v_mfma_f32_16x16x32_bf16 a[228:231], v[60:63], v[100:103], a[228:231]
  v_mfma_f32_16x16x32_bf16 a[232:235], v[60:63], v[104:107], a[232:235]
  v_mfma_f32_16x16x32_bf16 a[236:239], v[60:63], v[108:111], a[236:239]
  v_mfma_f32_16x16x32_bf16 a[240:243], v[60:63], v[112:115], a[240:243]
  v_mfma_f32_16x16x32_bf16 a[244:247], v[60:63], v[116:119], a[244:247]
  v_mfma_f32_16x16x32_bf16 a[248:251], v[60:63], v[120:123], a[248:251]
  v_mfma_f32_16x16x32_bf16 a[252:255], v[60:63], v[124:127], a[252:255]
  s_waitcnt lgkmcnt(0)
  v_mfma_f32_16x16x32_bf16 a[0:3], v[64:67], v[128:131], a[0:3]
  s_waitcnt vmcnt(18)
  v_mfma_f32_16x16x32_bf16 a[4:7], v[64:67], v[132:135], a[4:7]
  s_barrier
  v_mfma_f32_16x16x32_bf16 a[8:11], v[64:67], v[136:139], a[8:11]
  ds_read_b64_tr_b16 v[96:97], v12 offset:0
  v_mfma_f32_16x16x32_bf16 a[12:15], v[64:67], v[140:143], a[12:15]
  v_mfma_f32_16x16x32_bf16 a[16:19], v[64:67], v[144:147], a[16:19]
  s_mov_b32 m0, s24
  ds_read_b64_tr_b16 v[98:99], v12 offset:1024
  v_mfma_f32_16x16x32_bf16 a[20:23], v[64:67], v[148:151], a[20:23]
  buffer_load_dwordx4 v3, s[32:35], s26 offen offset:0 sc1 lds
  v_mfma_f32_16x16x32_bf16 a[24:27], v[64:67], v[152:155], a[24:27]
  ds_read_b128 v[32:35], v14 offset:0
  v_mfma_f32_16x16x32_bf16 a[28:31], v[64:67], v[156:159], a[28:31]
  v_mfma_f32_16x16x32_bf16 a[32:35], v[68:71], v[128:131], a[32:35]
  ds_read_b64_tr_b16 v[100:101], v13 offset:0
  v_mfma_f32_16x16x32_bf16 a[36:39], v[68:71], v[132:135], a[36:39]
  v_mfma_f32_16x16x32_bf16 a[40:43], v[68:71], v[136:139], a[40:43]
  ds_read_b64_tr_b16 v[102:103], v13 offset:1024
  v_mfma_f32_16x16x32_bf16 a[44:47], v[68:71], v[140:143], a[44:47]
  buffer_load_dwordx4 v4, s[32:35], s26 offen offset:1024 sc1 lds
  v_mfma_f32_16x16x32_bf16 a[48:51], v[68:71], v[144:147], a[48:51]
  ds_read_b128 v[36:39], v14 offset:1024
  v_mfma_f32_16x16x32_bf16 a[52:55], v[68:71], v[148:151], a[52:55]
  v_mfma_f32_16x16x32_bf16 a[56:59], v[68:71], v[152:155], a[56:59]
  ds_read_b64_tr_b16 v[104:105], v12 offset:256
  v_mfma_f32_16x16x32_bf16 a[60:63], v[68:71], v[156:159], a[60:63]
  v_mfma_f32_16x16x32_bf16 a[64:67], v[72:75], v[128:131], a[64:67]
  ds_read_b64_tr_b16 v[106:107], v12 offset:1280
  v_mfma_f32_16x16x32_bf16 a[68:71], v[72:75], v[132:135], a[68:71]
  buffer_load_dwordx4 v5, s[32:35], s26 offen offset:2048 sc1 lds
  v_mfma_f32_16x16x32_bf16 a[72:75], v[72:75], v[136:139], a[72:75]
  ds_read_b128 v[40:43], v14 offset:2048
  v_mfma_f32_16x16x32_bf16 a[76:79], v[72:75], v[140:143], a[76:79]
  v_mfma_f32_16x16x32_bf16 a[80:83], v[72:75], v[144:147], a[80:83]
  ds_read_b64_tr_b16 v[108:109], v13 offset:256
  v_mfma_f32_16x16x32_bf16 a[84:87], v[72:75], v[148:151], a[84:87]
  v_mfma_f32_16x16x32_bf16 a[88:91], v[72:75], v[152:155], a[88:91]
  ds_read_b64_tr_b16 v[110:111], v13 offset:1280
  v_mfma_f32_16x16x32_bf16 a[92:95], v[72:75], v[156:159], a[92:95]
  buffer_load_dwordx4 v6, s[32:35], s26 offen offset:3072 sc1 lds
  v_mfma_f32_16x16x32_bf16 a[96:99], v[76:79], v[128:131], a[96:99]
  ds_read_b128 v[44:47], v14 offset:3072
  v_mfma_f32_16x16x32_bf16 a[100:103], v[76:79], v[132:135], a[100:103]
  v_mfma_f32_16x16x32_bf16 a[104:107], v[76:79], v[136:139], a[104:107]
  ds_read_b64_tr_b16 v[112:113], v12 offset:512
  v_mfma_f32_16x16x32_bf16 a[108:111], v[76:79], v[140:143], a[108:111]
  v_mfma_f32_16x16x32_bf16 a[112:115], v[76:79], v[144:147], a[112:115]
  s_add_u32 m0, s24, 16384
  ds_read_b64_tr_b16 v[114:115], v12 offset:1536
  v_mfma_f32_16x16x32_bf16 a[116:119], v[76:79], v[148:151], a[116:119]
  buffer_load_dwordx4 v8, s[36:39], s27 offen offset:0 lds
  v_mfma_f32_16x16x32_bf16 a[120:123], v[76:79], v[152:155], a[120:123]
  ds_read_b128 v[48:51], v14 offset:4096
  v_mfma_f32_16x16x32_bf16 a[124:127], v[76:79], v[156:159], a[124:127]
  v_mfma_f32_16x16x32_bf16 a[128:131], v[80:83], v[128:131], a[128:131]
  ds_read_b64_tr_b16 v[116:117], v13 offset:512
  v_mfma_f32_16x16x32_bf16 a[132:135], v[80:83], v[132:135], a[132:135]
  v_mfma_f32_16x16x32_bf16 a[136:139], v[80:83], v[136:139], a[136:139]
  ds_read_b64_tr_b16 v[118:119], v13 offset:1536
  v_mfma_f32_16x16x32_bf16 a[140:143], v[80:83], v[140:143], a[140:143]
  buffer_load_dwordx4 v9, s[36:39], s27 offen offset:1024 lds
  v_mfma_f32_16x16x32_bf16 a[144:147], v[80:83], v[144:147], a[144:147]
  ds_read_b128 v[52:55], v14 offset:5120
  v_mfma_f32_16x16x32_bf16 a[148:151], v[80:83], v[148:151], a[148:151]
  v_mfma_f32_16x16x32_bf16 a[152:155], v[80:83], v[152:155], a[152:155]
  ds_read_b64_tr_b16 v[120:121], v12 offset:768
  v_mfma_f32_16x16x32_bf16 a[156:159], v[80:83], v[156:159], a[156:159]
  v_mfma_f32_16x16x32_bf16 a[160:163], v[84:87], v[128:131], a[160:163]
  ds_read_b64_tr_b16 v[122:123], v12 offset:1792
  v_mfma_f32_16x16x32_bf16 a[164:167], v[84:87], v[132:135], a[164:167]
  buffer_load_dwordx4 v10, s[36:39], s27 offen offset:2048 lds
  v_mfma_f32_16x16x32_bf16 a[168:171], v[84:87], v[136:139], a[168:171]
  ds_read_b128 v[56:59], v14 offset:6144
  v_mfma_f32_16x16x32_bf16 a[172:175], v[84:87], v[140:143], a[172:175]
  v_mfma_f32_16x16x32_bf16 a[176:179], v[84:87], v[144:147], a[176:179]
  ds_read_b64_tr_b16 v[124:125], v13 offset:768
  v_mfma_f32_16x16x32_bf16 a[180:183], v[84:87], v[148:151], a[180:183]
  v_mfma_f32_16x16x32_bf16 a[184:187], v[84:87], v[152:155], a[184:187]
  ds_read_b64_tr_b16 v[126:127], v13 offset:1792
  v_mfma_f32_16x16x32_bf16 a[188:191], v[84:87], v[156:159], a[188:191]
  buffer_load_dwordx4 v11, s[36:39], s27 offen offset:3072 lds
  v_mfma_f32_16x16x32_bf16 a[192:195], v[88:91], v[128:131], a[192:195]
  s_add_u32 s26, s26, s79
  ds_read_b128 v[60:63], v14 offset:7168
  v_mfma_f32_16x16x32_bf16 a[196:199], v[88:91], v[132:135], a[196:199]
  s_add_u32 s27, s27, s25
  v_mfma_f32_16x16x32_bf16 a[200:203], v[88:91], v[136:139], a[200:203]
  s_add_u32 s24, s24, 32768
  v_mfma_f32_16x16x32_bf16 a[204:207], v[88:91], v[140:143], a[204:207]
  s_and_b32 s24, s24, 0x1ffff
  v_mfma_f32_16x16x32_bf16 a[208:211], v[88:91], v[144:147], a[208:211]
  v_mfma_f32_16x16x32_bf16 a[212:215], v[88:91], v[148:151], a[212:215]
  s_bitcmp1_b32 s76, s28
  v_mfma_f32_16x16x32_bf16 a[216:219], v[88:91], v[152:155], a[216:219]
  s_cbranch_scc1 fa_hk3
fa_hb3:
  v_mfma_f32_16x16x32_bf16 a[220:223], v[88:91], v[156:159], a[220:223]
  v_mfma_f32_16x16x32_bf16 a[224:227], v[92:95], v[128:131], a[224:227]
  v_mfma_f32_16x16x32_bf16 a[228:231], v[92:95], v[132:135], a[228:231]
  s_add_u32 s28, s28, 1
  v_mfma_f32_16x16x32_bf16 a[232:235], v[92:95], v[136:139], a[232:235]
  v_mfma_f32_16x16x32_bf16 a[236:239], v[92:95], v[140:143], a[236:239]
  v_mfma_f32_16x16x32_bf16 a[240:243], v[92:95], v[144:147], a[240:243]
  v_mfma_f32_16x16x32_bf16 a[244:247], v[92:95], v[148:151], a[244:247]
  s_cmp_lt_u32 s28, 8
  v_mfma_f32_16x16x32_bf16 a[248:251], v[92:95], v[152:155], a[248:251]
  s_waitcnt lgkmcnt(0)
  v_mfma_f32_16x16x32_bf16 a[252:255], v[92:95], v[156:159], a[252:255]
  s_cbranch_scc1 fa_loopV
  s_mov_b32 s60, 8192
  s_mov_b32 s61, 2048
  s_mov_b32 s62, 33554432
fa_p1epi:
  s_lshr_b32 s23, s20, 1
  s_lshl_b32 s23, s23, 13
  v_subrev_u32 v12, s23, v12
  v_subrev_u32 v13, s23, v13
  s_lshl_b32 s24, s20, 12
  v_add_u32 v14, s24, v2
  ds_read_b64_tr_b16 v[32:33], v12 offset:0
  ds_read_b64_tr_b16 v[34:35], v12 offset:1024
  ds_read_b64_tr_b16 v[36:37], v13 offset:0
  ds_read_b64_tr_b16 v[38:39], v13 offset:1024
  ds_read_b64_tr_b16 v[40:41], v12 offset:256
  ds_read_b64_tr_b16 v[42:43], v12 offset:1280
  ds_read_b64_tr_b16 v[44:45], v13 offset:256
  ds_read_b64_tr_b16 v[46:47], v13 offset:1280
  ds_read_b64_tr_b16 v[48:49], v12 offset:512
  ds_read_b64_tr_b16 v[50:51], v12 offset:1536
  ds_read_b64_tr_b16 v[52:53], v13 offset:512
  ds_read_b64_tr_b16 v[54:55], v13 offset:1536
  ds_read_b64_tr_b16 v[56:57], v12 offset:768
  ds_read_b64_tr_b16 v[58:59], v12 offset:1792
  ds_read_b64_tr_b16 v[60:61], v13 offset:768
  ds_read_b64_tr_b16 v[62:63], v13 offset:1792
  s_waitcnt vmcnt(8)
  ds_read_b128 v[224:227], v14 offset:0
  ds_read_b128 v[228:231], v14 offset:1024
  ds_read_b128 v[232:235], v14 offset:2048
  ds_read_b128 v[236:239], v14 offset:3072
  s_lshl_b32 s23, s21, 19
  s_add_u32 s62, s62, s23
  s_lshl_b32 s23, s22, 16
  s_add_u32 s62, s62, s23
  s_and_b32 s23, s20, 1
  s_lshl_b32 s23, s23, 15
  s_add_u32 s62, s62, s23
  s_lshl_b32 s23, s21, 19
  s_add_u32 s23, s23, 16777216
  s_add_u32 s6, s18, s23
  s_addc_u32 s7, s19, 0
  s_add_u32 s8, s6, 16777216
  s_addc_u32 s9, s7, 0
  s_sub_u32 s23, 16, s22
  s_lshl_b32 s23, s23, 15
  s_mov_b32 s44, s6
  s_mov_b32 s45, s7
  s_mov_b32 s46, s23
  s_mov_b32 s47, 0x20000
  s_mov_b32 s48, s8
  s_mov_b32 s49, s9
  s_mov_b32 s50, s23
  s_mov_b32 s51, 0x20000
  s_lshl_b32 s30, s21, 7
  s_add_u32 s30, s30, 2637824
  s_mov_b32 s81, 0x47800000
  s_cmp_eq_u32 s20, 0
  s_cselect_b32 s29, s82, 1073741824
  s_waitcnt vmcnt(21) lgkmcnt(0)
  v_mfma_f32_16x16x32_bf16 v[96:99], v[32:35], v[224:227], 0
  s_mul_i32 s63, s60, 0
  v_accvgpr_read_b32 v16, a0
  v_accvgpr_read_b32 v17, a1
  v_mfma_f32_16x16x32_bf16 v[112:115], v[36:39], v[224:227], 0
  s_add_u32 s63, s63, s62
  ds_read_b64_tr_b16 v[64:65], v12 offset:8192
  v_accvgpr_read_b32 v18, a2
  v_mfma_f32_16x16x32_bf16 v[128:131], v[40:43], v[224:227], 0
  s_add_u32 m0, s24, 0
  ds_read_b64_tr_b16 v[66:67], v12 offset:9216
  v_accvgpr_read_b32 v19, a3
  v_mfma_f32_16x16x32_bf16 v[144:147], v[44:47], v[224:227], 0
  buffer_load_dwordx4 v3, s[32:35], s26 offen offset:0 sc1 lds
  v_accvgpr_read_b32 v20, a32
  v_mfma_f32_16x16x32_bf16 v[160:163], v[48:51], v[224:227], 0
  ds_read_b64_tr_b16 v[68:69], v13 offset:8192
  v_accvgpr_read_b32 v21, a33
  v_mfma_f32_16x16x32_bf16 v[176:179], v[52:55], v[224:227], 0
  ds_read_b64_tr_b16 v[70:71], v13 offset:9216
  v_accvgpr_read_b32 v22, a34
  v_mfma_f32_16x16x32_bf16 v[192:195], v[56:59], v[224:227], 0
  ds_read_b64_tr_b16 v[72:73], v12 offset:8448
  v_accvgpr_read_b32 v23, a35
  v_mfma_f32_16x16x32_bf16 v[208:211], v[60:63], v[224:227], 0
  ds_read_b64_tr_b16 v[74:75], v12 offset:9472
  v_cvt_pk_bf16_f32 v24, v16, v17
  v_mfma_f32_16x16x32_bf16 v[100:103], v[32:35], v[228:231], 0
  buffer_load_dwordx4 v4, s[32:35], s26 offen offset:1024 sc1 lds
  v_cvt_pk_bf16_f32 v25, v18, v19
  v_mfma_f32_16x16x32_bf16 v[116:119], v[36:39], v[228:231], 0
  ds_read_b64_tr_b16 v[76:77], v13 offset:8448
  v_cvt_pk_bf16_f32 v26, v20, v21
  v_mfma_f32_16x16x32_bf16 v[132:135], v[40:43], v[228:231], 0
  ds_read_b64_tr_b16 v[78:79], v13 offset:9472
  v_cvt_pk_bf16_f32 v27, v22, v23
  v_mfma_f32_16x16x32_bf16 v[148:151], v[44:47], v[228:231], 0
  ds_read_b128 v[240:243], v14 offset:32768
  buffer_store_dwordx4 v[24:27], v2, s[40:43], s63 offen offset:0 sc1
  v_mfma_f32_16x16x32_bf16 v[164:167], v[48:51], v[228:231], 0
  ds_read_b128 v[244:247], v14 offset:33792
  v_accvgpr_read_b32 v16, a4
  v_mfma_f32_16x16x32_bf16 v[180:183], v[52:55], v[228:231], 0
  buffer_load_dwordx4 v5, s[32:35], s26 offen offset:2048 sc1 lds
  v_accvgpr_read_b32 v17, a5
  v_mfma_f32_16x16x32_bf16 v[196:199], v[56:59], v[228:231], 0
  ds_read_b64_tr_b16 v[80:81], v12 offset:8704
  v_accvgpr_read_b32 v18, a6
  v_mfma_f32_16x16x32_bf16 v[212:215], v[60:63], v[228:231], 0
  ds_read_b64_tr_b16 v[82:83], v12 offset:9728
  v_accvgpr_read_b32 v19, a7
  v_mfma_f32_16x16x32_bf16 v[104:107], v[32:35], v[232:235], 0
  ds_read_b64_tr_b16 v[84:85], v13 offset:8704
  v_accvgpr_read_b32 v20, a36
  v_mfma_f32_16x16x32_bf16 v[120:123], v[36:39], v[232:235], 0
  ds_read_b64_tr_b16 v[86:87], v13 offset:9728
  v_accvgpr_read_b32 v21, a37
  v_mfma_f32_16x16x32_bf16 v[136:139], v[40:43], v[232:235], 0
  buffer_load_dwordx4 v6, s[32:35], s26 offen offset:3072 sc1 lds
  v_accvgpr_read_b32 v22, a38
  v_mfma_f32_16x16x32_bf16 v[152:155], v[44:47], v[232:235], 0
  s_add_u32 s26, s26, 1024
  ds_read_b64_tr_b16 v[88:89], v12 offset:8960
  v_accvgpr_read_b32 v23, a39
  v_mfma_f32_16x16x32_bf16 v[168:171], v[48:51], v[232:235], 0
  ds_read_b64_tr_b16 v[90:91], v12 offset:9984
  v_cvt_pk_bf16_f32 v28, v16, v17
  v_mfma_f32_16x16x32_bf16 v[184:187], v[52:55], v[232:235], 0
  ds_read_b64_tr_b16 v[92:93], v13 offset:8960
  v_cvt_pk_bf16_f32 v29, v18, v19
  v_mfma_f32_16x16x32_bf16 v[200:203], v[56:59], v[232:235], 0
  ds_read_b64_tr_b16 v[94:95], v13 offset:9984
  v_cvt_pk_bf16_f32 v30, v20, v21
  v_mfma_f32_16x16x32_bf16 v[216:219], v[60:63], v[232:235], 0
  v_cvt_pk_bf16_f32 v31, v22, v23
  v_mfma_f32_16x16x32_bf16 v[108:111], v[32:35], v[236:239], 0
  ds_read_b128 v[248:251], v14 offset:34816
  buffer_store_dwordx4 v[28:31], v2, s[40:43], s63 offen offset:1024 sc1
  v_mfma_f32_16x16x32_bf16 v[124:127], v[36:39], v[236:239], 0
  ds_read_b128 v[252:255], v14 offset:35840
  v_accvgpr_write_b32 a0, 0
  v_mfma_f32_16x16x32_bf16 v[140:143], v[40:43], v[236:239], 0
  v_accvgpr_write_b32 a1, 0
  v_accvgpr_write_b32 a2, 0
  v_mfma_f32_16x16x32_bf16 v[156:159], v[44:47], v[236:239], 0
  v_xor_b32 v14, 0x10000, v14
  v_accvgpr_write_b32 a3, 0
  v_mfma_f32_16x16x32_bf16 v[172:175], v[48:51], v[236:239], 0
  v_accvgpr_write_b32 a32, 0
  v_accvgpr_write_b32 a33, 0
  v_mfma_f32_16x16x32_bf16 v[188:191], v[52:55], v[236:239], 0
  v_accvgpr_write_b32 a34, 0
  v_accvgpr_write_b32 a35, 0
  v_mfma_f32_16x16x32_bf16 v[204:207], v[56:59], v[236:239], 0
  v_mfma_f32_16x16x32_bf16 v[220:223], v[60:63], v[236:239], 0
  s_waitcnt vmcnt(19) lgkmcnt(0)
  v_mfma_f32_16x16x32_bf16 v[96:99], v[64:67], v[240:243], v[96:99]
  s_barrier
  v_accvgpr_read_b32 v16, a8
  v_accvgpr_read_b32 v17, a9
  v_mfma_f32_16x16x32_bf16 v[112:115], v[68:71], v[240:243], v[112:115]
  s_add_u32 s63, s63, s61
  ds_read_b64_tr_b16 v[32:33], v12 offset:32768
  v_accvgpr_read_b32 v18, a10
  v_mfma_f32_16x16x32_bf16 v[128:131], v[72:75], v[240:243], v[128:131]
  s_add_u32 m0, s24, 32768
  ds_read_b64_tr_b16 v[34:35], v12 offset:33792
  v_accvgpr_read_b32 v19, a11
  v_mfma_f32_16x16x32_bf16 v[144:147], v[76:79], v[240:243], v[144:147]
  buffer_load_dwordx4 v3, s[32:35], s26 offen offset:0 sc1 lds
  v_accvgpr_read_b32 v20, a40
  v_mfma_f32_16x16x32_bf16 v[160:163], v[80:83], v[240:243], v[160:163]
  ds_read_b64_tr_b16 v[36:37], v13 offset:32768
  v_accvgpr_read_b32 v21, a41
  v_mfma_f32_16x16x32_bf16 v[176:179], v[84:87], v[240:243], v[176:179]
  ds_read_b64_tr_b16 v[38:39], v13 offset:33792
  v_accvgpr_read_b32 v22, a42
  v_mfma_f32_16x16x32_bf16 v[192:195], v[88:91], v[240:243], v[192:195]
  ds_read_b64_tr_b16 v[40:41], v12 offset:33024
  v_accvgpr_read_b32 v23, a43
  v_mfma_f32_16x16x32_bf16 v[208:211], v[92:95], v[240:243], v[208:211]
  ds_read_b64_tr_b16 v[42:43], v12 offset:34048
  v_cvt_pk_bf16_f32 v24, v16, v17
  v_mfma_f32_16x16x32_bf16 v[100:103], v[64:67], v[244:247], v[100:103]
  buffer_load_dwordx4 v4, s[32:35], s26 offen offset:1024 sc1 lds
  v_cvt_pk_bf16_f32 v25, v18, v19
  v_mfma_f32_16x16x32_bf16 v[116:119], v[68:71], v[244:247], v[116:119]
  ds_read_b64_tr_b16 v[44:45], v13 offset:33024
  v_cvt_pk_bf16_f32 v26, v20, v21
  v_mfma_f32_16x16x32_bf16 v[132:135], v[72:75], v[244:247], v[132:135]
  ds_read_b64_tr_b16 v[46:47], v13 offset:34048
  v_cvt_pk_bf16_f32 v27, v22, v23
  v_mfma_f32_16x16x32_bf16 v[148:151], v[76:79], v[244:247], v[148:151]
  ds_read_b128 v[224:227], v14 offset:0
  buffer_store_dwordx4 v[24:27], v2, s[40:43], s63 offen offset:0 sc1
  v_mfma_f32_16x16x32_bf16 v[164:167], v[80:83], v[244:247], v[164:167]
  ds_read_b128 v[228:231], v14 offset:1024
  v_accvgpr_read_b32 v16, a12
  v_mfma_f32_16x16x32_bf16 v[180:183], v[84:87], v[244:247], v[180:183]
  buffer_load_dwordx4 v5, s[32:35], s26 offen offset:2048 sc1 lds
  v_accvgpr_read_b32 v17, a13
  v_mfma_f32_16x16x32_bf16 v[196:199], v[88:91], v[244:247], v[196:199]
  ds_read_b64_tr_b16 v[48:49], v12 offset:33280
  v_accvgpr_read_b32 v18, a14
  v_mfma_f32_16x16x32_bf16 v[212:215], v[92:95], v[244:247], v[212:215]
  ds_read_b64_tr_b16 v[50:51], v12 offset:34304
  v_accvgpr_read_b32 v19, a15
  v_mfma_f32_16x16x32_bf16 v[104:107], v[64:67], v[248:251], v[104:107]
  ds_read_b64_tr_b16 v[52:53], v13 offset:33280
  v_accvgpr_read_b32 v20, a44
  v_mfma_f32_16x16x32_bf16 v[120:123], v[68:71], v[248:251], v[120:123]
  ds_read_b64_tr_b16 v[54:55], v13 offset:34304
  v_accvgpr_read_b32 v21, a45
  v_mfma_f32_16x16x32_bf16 v[136:139], v[72:75], v[248:251], v[136:139]
  buffer_load_dwordx4 v6, s[32:35], s26 offen offset:3072 sc1 lds
  v_accvgpr_read_b32 v22, a46
  v_mfma_f32_16x16x32_bf16 v[152:155], v[76:79], v[248:251], v[152:155]
  s_add_u32 s26, s26, 1024
  ds_read_b64_tr_b16 v[56:57], v12 offset:33536
  v_accvgpr_read_b32 v23, a47
  v_mfma_f32_16x16x32_bf16 v[168:171], v[80:83], v[248:251], v[168:171]
  ds_read_b64_tr_b16 v[58:59], v12 offset:34560
  v_cvt_pk_bf16_f32 v28, v16, v17
  v_mfma_f32_16x16x32_bf16 v[184:187], v[84:87], v[248:251], v[184:187]
  ds_read_b64_tr_b16 v[60:61], v13 offset:33536
  v_cvt_pk_bf16_f32 v29, v18, v19
  v_mfma_f32_16x16x32_bf16 v[200:203], v[88:91], v[248:251], v[200:203]
  s_add_u32 m0, s24, 16384
  ds_read_b64_tr_b16 v[62:63], v13 offset:34560
  v_cvt_pk_bf16_f32 v30, v20, v21
  v_mfma_f32_16x16x32_bf16 v[216:219], v[92:95], v[248:251], v[216:219]
  buffer_load_dwordx4 v8, s[36:39], s27 offen offset:0 lds
  v_cvt_pk_bf16_f32 v31, v22, v23
  v_mfma_f32_16x16x32_bf16 v[108:111], v[64:67], v[252:255], v[108:111]
  ds_read_b128 v[232:235], v14 offset:2048
  buffer_store_dwordx4 v[28:31], v2, s[40:43], s63 offen offset:1024 sc1
  v_mfma_f32_16x16x32_bf16 v[124:127], v[68:71], v[252:255], v[124:127]
  ds_read_b128 v[236:239], v14 offset:3072
  v_accvgpr_write_b32 a4, 0
  v_mfma_f32_16x16x32_bf16 v[140:143], v[72:75], v[252:255], v[140:143]
  v_accvgpr_write_b32 a5, 0
  v_accvgpr_write_b32 a6, 0
  v_mfma_f32_16x16x32_bf16 v[156:159], v[76:79], v[252:255], v[156:159]
  v_accvgpr_write_b32 a7, 0
  v_accvgpr_write_b32 a36, 0
  v_mfma_f32_16x16x32_bf16 v[172:175], v[80:83], v[252:255], v[172:175]
  buffer_load_dwordx4 v9, s[36:39], s27 offen offset:1024 lds
  v_accvgpr_write_b32 a37, 0
  v_mfma_f32_16x16x32_bf16 v[188:191], v[84:87], v[252:255], v[188:191]
  v_accvgpr_write_b32 a38, 0
  v_mfma_f32_16x16x32_bf16 v[204:207], v[88:91], v[252:255], v[204:207]
  v_mfma_f32_16x16x32_bf16 v[220:223], v[92:95], v[252:255], v[220:223]
  s_waitcnt vmcnt(18) lgkmcnt(0)
  v_mfma_f32_16x16x32_bf16 v[96:99], v[32:35], v[224:227], v[96:99]
  s_add_u32 s63, s63, s61
  v_accvgpr_read_b32 v16, a16
  v_accvgpr_read_b32 v17, a17
  v_mfma_f32_16x16x32_bf16 v[112:115], v[36:39], v[224:227], v[112:115]
  ds_read_b64_tr_b16 v[64:65], v12 offset:40960
  v_accvgpr_read_b32 v18, a18
  v_mfma_f32_16x16x32_bf16 v[128:131], v[40:43], v[224:227], v[128:131]
  s_add_u32 m0, s24, 65536
  ds_read_b64_tr_b16 v[66:67], v12 offset:41984
  v_accvgpr_read_b32 v19, a19
  v_mfma_f32_16x16x32_bf16 v[144:147], v[44:47], v[224:227], v[144:147]
  buffer_load_dwordx4 v3, s[32:35], s26 offen offset:0 sc1 lds
  v_accvgpr_read_b32 v20, a48
  v_mfma_f32_16x16x32_bf16 v[160:163], v[48:51], v[224:227], v[160:163]
  ds_read_b64_tr_b16 v[68:69], v13 offset:40960
  v_accvgpr_read_b32 v21, a49
  v_mfma_f32_16x16x32_bf16 v[176:179], v[52:55], v[224:227], v[176:179]
  ds_read_b64_tr_b16 v[70:71], v13 offset:41984
  v_accvgpr_read_b32 v22, a50
  v_mfma_f32_16x16x32_bf16 v[192:195], v[56:59], v[224:227], v[192:195]
  ds_read_b64_tr_b16 v[72:73], v12 offset:41216
  v_accvgpr_read_b32 v23, a51
  v_mfma_f32_16x16x32_bf16 v[208:211], v[60:63], v[224:227], v[208:211]
  ds_read_b64_tr_b16 v[74:75], v12 offset:42240
  v_cvt_pk_bf16_f32 v24, v16, v17
  v_mfma_f32_16x16x32_bf16 v[100:103], v[32:35], v[228:231], v[100:103]
  buffer_load_dwordx4 v4, s[32:35], s26 offen offset:1024 sc1 lds
  v_cvt_pk_bf16_f32 v25, v18, v19
  v_mfma_f32_16x16x32_bf16 v[116:119], v[36:39], v[228:231], v[116:119]
  ds_read_b64_tr_b16 v[76:77], v13 offset:41216
  v_cvt_pk_bf16_f32 v26, v20, v21
  v_mfma_f32_16x16x32_bf16 v[132:135], v[40:43], v[228:231], v[132:135]
  ds_read_b64_tr_b16 v[78:79], v13 offset:42240
  v_cvt_pk_bf16_f32 v27, v22, v23
  v_mfma_f32_16x16x32_bf16 v[148:151], v[44:47], v[228:231], v[148:151]
  ds_read_b128 v[240:243], v14 offset:32768
  buffer_store_dwordx4 v[24:27], v2, s[40:43], s63 offen offset:0 sc1
  v_mfma_f32_16x16x32_bf16 v[164:167], v[48:51], v[228:231], v[164:167]
  ds_read_b128 v[244:247], v14 offset:33792
  v_accvgpr_read_b32 v16, a20
  v_mfma_f32_16x16x32_bf16 v[180:183], v[52:55], v[228:231], v[180:183]
  buffer_load_dwordx4 v5, s[32:35], s26 offen offset:2048 sc1 lds
  v_accvgpr_read_b32 v17, a21
  v_mfma_f32_16x16x32_bf16 v[196:199], v[56:59], v[228:231], v[196:199]
  ds_read_b64_tr_b16 v[80:81], v12 offset:41472
  v_accvgpr_read_b32 v18, a22
  v_mfma_f32_16x16x32_bf16 v[212:215], v[60:63], v[228:231], v[212:215]
  ds_read_b64_tr_b16 v[82:83], v12 offset:42496
  v_accvgpr_read_b32 v19, a23
  v_mfma_f32_16x16x32_bf16 v[104:107], v[32:35], v[232:235], v[104:107]
  ds_read_b64_tr_b16 v[84:85], v13 offset:41472
  v_accvgpr_read_b32 v20, a52
  v_mfma_f32_16x16x32_bf16 v[120:123], v[36:39], v[232:235], v[120:123]
  ds_read_b64_tr_b16 v[86:87], v13 offset:42496
  v_accvgpr_read_b32 v21, a53
  v_mfma_f32_16x16x32_bf16 v[136:139], v[40:43], v[232:235], v[136:139]
  buffer_load_dwordx4 v6, s[32:35], s26 offen offset:3072 sc1 lds
  v_accvgpr_read_b32 v22, a54
  v_mfma_f32_16x16x32_bf16 v[152:155], v[44:47], v[232:235], v[152:155]
  s_add_u32 s26, s26, 1024
  ds_read_b64_tr_b16 v[88:89], v12 offset:41728
  v_accvgpr_read_b32 v23, a55
  v_mfma_f32_16x16x32_bf16 v[168:171], v[48:51], v[232:235], v[168:171]
  ds_read_b64_tr_b16 v[90:91], v12 offset:42752
  v_cvt_pk_bf16_f32 v28, v16, v17
  v_mfma_f32_16x16x32_bf16 v[184:187], v[52:55], v[232:235], v[184:187]
  ds_read_b64_tr_b16 v[92:93], v13 offset:41728
  v_cvt_pk_bf16_f32 v29, v18, v19
  v_mfma_f32_16x16x32_bf16 v[200:203], v[56:59], v[232:235], v[200:203]
  s_add_u32 m0, s24, 16384
  ds_read_b64_tr_b16 v[94:95], v13 offset:42752
  v_cvt_pk_bf16_f32 v30, v20, v21
  v_mfma_f32_16x16x32_bf16 v[216:219], v[60:63], v[232:235], v[216:219]
  buffer_load_dwordx4 v10, s[36:39], s27 offen offset:2048 lds
  v_cvt_pk_bf16_f32 v31, v22, v23
  v_mfma_f32_16x16x32_bf16 v[108:111], v[32:35], v[236:239], v[108:111]
  ds_read_b128 v[248:251], v14 offset:34816
  buffer_store_dwordx4 v[28:31], v2, s[40:43], s63 offen offset:1024 sc1
  v_mfma_f32_16x16x32_bf16 v[124:127], v[36:39], v[236:239], v[124:127]
  ds_read_b128 v[252:255], v14 offset:35840
  v_accvgpr_write_b32 a39, 0
  v_mfma_f32_16x16x32_bf16 v[140:143], v[40:43], v[236:239], v[140:143]
  v_accvgpr_write_b32 a8, 0
  v_accvgpr_write_b32 a9, 0
  v_mfma_f32_16x16x32_bf16 v[156:159], v[44:47], v[236:239], v[156:159]
  v_xor_b32 v14, 0x10000, v14
  v_accvgpr_write_b32 a10, 0
  v_mfma_f32_16x16x32_bf16 v[172:175], v[48:51], v[236:239], v[172:175]
  buffer_load_dwordx4 v11, s[36:39], s27 offen offset:3072 lds
  v_mfma_f32_16x16x32_bf16 v[188:191], v[52:55], v[236:239], v[188:191]
  s_add_u32 s27, s27, 524288
  v_xor_b32 v12, 0x10000, v12
  v_mfma_f32_16x16x32_bf16 v[204:207], v[56:59], v[236:239], v[204:207]
  v_xor_b32 v13, 0x10000, v13
  v_mfma_f32_16x16x32_bf16 v[220:223], v[60:63], v[236:239], v[220:223]
  s_waitcnt vmcnt(17) lgkmcnt(0)
  v_mfma_f32_16x16x32_bf16 v[96:99], v[64:67], v[240:243], v[96:99]
  s_barrier
  v_accvgpr_read_b32 v16, a24
  v_accvgpr_read_b32 v17, a25
  v_mfma_f32_16x16x32_bf16 v[112:115], v[68:71], v[240:243], v[112:115]
  s_add_u32 s63, s63, s61
  ds_read_b64_tr_b16 v[32:33], v12 offset:0
  v_accvgpr_read_b32 v18, a26
  v_mfma_f32_16x16x32_bf16 v[128:131], v[72:75], v[240:243], v[128:131]
  s_add_u32 m0, s24, 98304
  ds_read_b64_tr_b16 v[34:35], v12 offset:1024
  v_accvgpr_read_b32 v19, a27
  v_mfma_f32_16x16x32_bf16 v[144:147], v[76:79], v[240:243], v[144:147]
  buffer_load_dwordx4 v3, s[32:35], s26 offen offset:0 sc1 lds
  v_accvgpr_read_b32 v20, a56
  v_mfma_f32_16x16x32_bf16 v[160:163], v[80:83], v[240:243], v[160:163]
  ds_read_b64_tr_b16 v[36:37], v13 offset:0
  v_accvgpr_read_b32 v21, a57
  v_mfma_f32_16x16x32_bf16 v[176:179], v[84:87], v[240:243], v[176:179]
  ds_read_b64_tr_b16 v[38:39], v13 offset:1024
  v_accvgpr_read_b32 v22, a58
  v_mfma_f32_16x16x32_bf16 v[192:195], v[88:91], v[240:243], v[192:195]
  ds_read_b64_tr_b16 v[40:41], v12 offset:256
  v_accvgpr_read_b32 v23, a59
  v_mfma_f32_16x16x32_bf16 v[208:211], v[92:95], v[240:243], v[208:211]
  ds_read_b64_tr_b16 v[42:43], v12 offset:1280
  v_cvt_pk_bf16_f32 v24, v16, v17
  v_mfma_f32_16x16x32_bf16 v[100:103], v[64:67], v[244:247], v[100:103]
  buffer_load_dwordx4 v4, s[32:35], s26 offen offset:1024 sc1 lds
  v_cvt_pk_bf16_f32 v25, v18, v19
  v_mfma_f32_16x16x32_bf16 v[116:119], v[68:71], v[244:247], v[116:119]
  ds_read_b64_tr_b16 v[44:45], v13 offset:256
  v_cvt_pk_bf16_f32 v26, v20, v21
  v_mfma_f32_16x16x32_bf16 v[132:135], v[72:75], v[244:247], v[132:135]
  ds_read_b64_tr_b16 v[46:47], v13 offset:1280
  v_cvt_pk_bf16_f32 v27, v22, v23
  v_mfma_f32_16x16x32_bf16 v[148:151], v[76:79], v[244:247], v[148:151]
  ds_read_b128 v[224:227], v14 offset:0
  buffer_store_dwordx4 v[24:27], v2, s[40:43], s63 offen offset:0 sc1
  v_mfma_f32_16x16x32_bf16 v[164:167], v[80:83], v[244:247], v[164:167]
  ds_read_b128 v[228:231], v14 offset:1024
  v_accvgpr_read_b32 v16, a28
  v_mfma_f32_16x16x32_bf16 v[180:183], v[84:87], v[244:247], v[180:183]
  buffer_load_dwordx4 v5, s[32:35], s26 offen offset:2048 sc1 lds
  v_accvgpr_read_b32 v17, a29
  v_mfma_f32_16x16x32_bf16 v[196:199], v[88:91], v[244:247], v[196:199]
  ds_read_b64_tr_b16 v[48:49], v12 offset:512
  v_accvgpr_read_b32 v18, a30
  v_mfma_f32_16x16x32_bf16 v[212:215], v[92:95], v[244:247], v[212:215]
  ds_read_b64_tr_b16 v[50:51], v12 offset:1536
  v_accvgpr_read_b32 v19, a31
  v_mfma_f32_16x16x32_bf16 v[104:107], v[64:67], v[248:251], v[104:107]
  ds_read_b64_tr_b16 v[52:53], v13 offset:512
  v_accvgpr_read_b32 v20, a60
  v_mfma_f32_16x16x32_bf16 v[120:123], v[68:71], v[248:251], v[120:123]
  ds_read_b64_tr_b16 v[54:55], v13 offset:1536
  v_accvgpr_read_b32 v21, a61
  v_mfma_f32_16x16x32_bf16 v[136:139], v[72:75], v[248:251], v[136:139]
  buffer_load_dwordx4 v6, s[32:35], s26 offen offset:3072 sc1 lds
  v_accvgpr_read_b32 v22, a62
  v_mfma_f32_16x16x32_bf16 v[152:155], v[76:79], v[248:251], v[152:155]
  s_add_u32 s26, s26, 1024
  ds_read_b64_tr_b16 v[56:57], v12 offset:768
  v_accvgpr_read_b32 v23, a63
  v_mfma_f32_16x16x32_bf16 v[168:171], v[80:83], v[248:251], v[168:171]
  ds_read_b64_tr_b16 v[58:59], v12 offset:1792
  v_cvt_pk_bf16_f32 v28, v16, v17
  v_mfma_f32_16x16x32_bf16 v[184:187], v[84:87], v[248:251], v[184:187]
  ds_read_b64_tr_b16 v[60:61], v13 offset:768
  v_cvt_pk_bf16_f32 v29, v18, v19
  v_mfma_f32_16x16x32_bf16 v[200:203], v[88:91], v[248:251], v[200:203]
  s_add_u32 m0, s24, 49152
  ds_read_b64_tr_b16 v[62:63], v13 offset:1792
  v_cvt_pk_bf16_f32 v30, v20, v21
  v_mfma_f32_16x16x32_bf16 v[216:219], v[92:95], v[248:251], v[216:219]
  buffer_load_dwordx4 v8, s[36:39], s27 offen offset:0 lds
  v_cvt_pk_bf16_f32 v31, v22, v23
  v_mfma_f32_16x16x32_bf16 v[108:111], v[64:67], v[252:255], v[108:111]
  ds_read_b128 v[232:235], v14 offset:2048
  buffer_store_dwordx4 v[28:31], v2, s[40:43], s63 offen offset:1024 sc1
  v_mfma_f32_16x16x32_bf16 v[124:127], v[68:71], v[252:255], v[124:127]
  ds_read_b128 v[236:239], v14 offset:3072
  v_accvgpr_write_b32 a11, 0
  v_mfma_f32_16x16x32_bf16 v[140:143], v[72:75], v[252:255], v[140:143]
  v_accvgpr_write_b32 a40, 0
  v_accvgpr_write_b32 a41, 0
  v_mfma_f32_16x16x32_bf16 v[156:159], v[76:79], v[252:255], v[156:159]
  v_accvgpr_write_b32 a42, 0
  v_accvgpr_write_b32 a43, 0
  v_mfma_f32_16x16x32_bf16 v[172:175], v[80:83], v[252:255], v[172:175]
  buffer_load_dwordx4 v9, s[36:39], s27 offen offset:1024 lds
  v_accvgpr_write_b32 a12, 0
  v_mfma_f32_16x16x32_bf16 v[188:191], v[84:87], v[252:255], v[188:191]
  v_accvgpr_write_b32 a13, 0
  v_mfma_f32_16x16x32_bf16 v[204:207], v[88:91], v[252:255], v[204:207]
  v_mfma_f32_16x16x32_bf16 v[220:223], v[92:95], v[252:255], v[220:223]
  s_waitcnt vmcnt(19) lgkmcnt(0)
  v_mfma_f32_16x16x32_bf16 v[96:99], v[32:35], v[224:227], v[96:99]
  s_mul_i32 s63, s60, 1
  v_accvgpr_read_b32 v16, a64
  v_accvgpr_read_b32 v17, a65
  v_mfma_f32_16x16x32_bf16 v[112:115], v[36:39], v[224:227], v[112:115]
  s_add_u32 s63, s63, s62
  ds_read_b64_tr_b16 v[64:65], v12 offset:8192
  v_accvgpr_read_b32 v18, a66
  v_mfma_f32_16x16x32_bf16 v[128:131], v[40:43], v[224:227], v[128:131]
  s_add_u32 m0, s24, 0
  ds_read_b64_tr_b16 v[66:67], v12 offset:9216
  v_accvgpr_read_b32 v19, a67
  v_mfma_f32_16x16x32_bf16 v[144:147], v[44:47], v[224:227], v[144:147]
  buffer_load_dwordx4 v3, s[32:35], s26 offen offset:0 sc1 lds
  v_accvgpr_read_b32 v20, a96
  v_mfma_f32_16x16x32_bf16 v[160:163], v[48:51], v[224:227], v[160:163]
  ds_read_b64_tr_b16 v[68:69], v13 offset:8192
  v_accvgpr_read_b32 v21, a97
  v_mfma_f32_16x16x32_bf16 v[176:179], v[52:55], v[224:227], v[176:179]
  ds_read_b64_tr_b16 v[70:71], v13 offset:9216
  v_accvgpr_read_b32 v22, a98
  v_mfma_f32_16x16x32_bf16 v[192:195], v[56:59], v[224:227], v[192:195]
  ds_read_b64_tr_b16 v[72:73], v12 offset:8448
  v_accvgpr_read_b32 v23, a99
  v_mfma_f32_16x16x32_bf16 v[208:211], v[60:63], v[224:227], v[208:211]
  ds_read_b64_tr_b16 v[74:75], v12 offset:9472
  v_cvt_pk_bf16_f32 v24, v16, v17
  v_mfma_f32_16x16x32_bf16 v[100:103], v[32:35], v[228:231], v[100:103]
  buffer_load_dwordx4 v4, s[32:35], s26 offen offset:1024 sc1 lds
  v_cvt_pk_bf16_f32 v25, v18, v19
  v_mfma_f32_16x16x32_bf16 v[116:119], v[36:39], v[228:231], v[116:119]
  ds_read_b64_tr_b16 v[76:77], v13 offset:8448
  v_cvt_pk_bf16_f32 v26, v20, v21
  v_mfma_f32_16x16x32_bf16 v[132:135], v[40:43], v[228:231], v[132:135]
  ds_read_b64_tr_b16 v[78:79], v13 offset:9472
  v_cvt_pk_bf16_f32 v27, v22, v23
  v_mfma_f32_16x16x32_bf16 v[148:151], v[44:47], v[228:231], v[148:151]
  ds_read_b128 v[240:243], v14 offset:32768
  buffer_store_dwordx4 v[24:27], v2, s[40:43], s63 offen offset:0 sc1
  v_mfma_f32_16x16x32_bf16 v[164:167], v[48:51], v[228:231], v[164:167]
  ds_read_b128 v[244:247], v14 offset:33792
  v_accvgpr_read_b32 v16, a68
  v_mfma_f32_16x16x32_bf16 v[180:183], v[52:55], v[228:231], v[180:183]
  buffer_load_dwordx4 v5, s[32:35], s26 offen offset:2048 sc1 lds
  v_accvgpr_read_b32 v17, a69
  v_mfma_f32_16x16x32_bf16 v[196:199], v[56:59], v[228:231], v[196:199]
  ds_read_b64_tr_b16 v[80:81], v12 offset:8704
  v_accvgpr_read_b32 v18, a70
  v_mfma_f32_16x16x32_bf16 v[212:215], v[60:63], v[228:231], v[212:215]
  ds_read_b64_tr_b16 v[82:83], v12 offset:9728
  v_accvgpr_read_b32 v19, a71
  v_mfma_f32_16x16x32_bf16 v[104:107], v[32:35], v[232:235], v[104:107]
  ds_read_b64_tr_b16 v[84:85], v13 offset:8704
  v_accvgpr_read_b32 v20, a100
  v_mfma_f32_16x16x32_bf16 v[120:123], v[36:39], v[232:235], v[120:123]
  ds_read_b64_tr_b16 v[86:87], v13 offset:9728
  v_accvgpr_read_b32 v21, a101
  v_mfma_f32_16x16x32_bf16 v[136:139], v[40:43], v[232:235], v[136:139]
  buffer_load_dwordx4 v6, s[32:35], s26 offen offset:3072 sc1 lds
  v_accvgpr_read_b32 v22, a102
  v_mfma_f32_16x16x32_bf16 v[152:155], v[44:47], v[232:235], v[152:155]
  s_add_u32 s26, s26, 1024
  ds_read_b64_tr_b16 v[88:89], v12 offset:8960
  v_accvgpr_read_b32 v23, a103
  v_mfma_f32_16x16x32_bf16 v[168:171], v[48:51], v[232:235], v[168:171]
  ds_read_b64_tr_b16 v[90:91], v12 offset:9984
  v_cvt_pk_bf16_f32 v28, v16, v17
  v_mfma_f32_16x16x32_bf16 v[184:187], v[52:55], v[232:235], v[184:187]
  ds_read_b64_tr_b16 v[92:93], v13 offset:8960
  v_cvt_pk_bf16_f32 v29, v18, v19
  v_mfma_f32_16x16x32_bf16 v[200:203], v[56:59], v[232:235], v[200:203]
  s_add_u32 m0, s24, 49152
  ds_read_b64_tr_b16 v[94:95], v13 offset:9984
  v_cvt_pk_bf16_f32 v30, v20, v21
  v_mfma_f32_16x16x32_bf16 v[216:219], v[60:63], v[232:235], v[216:219]
  buffer_load_dwordx4 v10, s[36:39], s27 offen offset:2048 lds
  v_cvt_pk_bf16_f32 v31, v22, v23
  v_mfma_f32_16x16x32_bf16 v[108:111], v[32:35], v[236:239], v[108:111]
  ds_read_b128 v[248:251], v14 offset:34816
  buffer_store_dwordx4 v[28:31], v2, s[40:43], s63 offen offset:1024 sc1
  v_mfma_f32_16x16x32_bf16 v[124:127], v[36:39], v[236:239], v[124:127]
  ds_read_b128 v[252:255], v14 offset:35840
  v_accvgpr_write_b32 a14, 0
  v_mfma_f32_16x16x32_bf16 v[140:143], v[40:43], v[236:239], v[140:143]
  v_accvgpr_write_b32 a15, 0
  v_accvgpr_write_b32 a44, 0
  v_mfma_f32_16x16x32_bf16 v[156:159], v[44:47], v[236:239], v[156:159]
  v_xor_b32 v14, 0x10000, v14
  v_accvgpr_write_b32 a45, 0
  v_mfma_f32_16x16x32_bf16 v[172:175], v[48:51], v[236:239], v[172:175]
  buffer_load_dwordx4 v11, s[36:39], s27 offen offset:3072 lds
  v_accvgpr_write_b32 a46, 0
  v_mfma_f32_16x16x32_bf16 v[188:191], v[52:55], v[236:239], v[188:191]
  s_add_u32 s27, s27, 524288
  v_accvgpr_write_b32 a47, 0
  v_mfma_f32_16x16x32_bf16 v[204:207], v[56:59], v[236:239], v[204:207]
  v_mfma_f32_16x16x32_bf16 v[220:223], v[60:63], v[236:239], v[220:223]
  s_waitcnt vmcnt(19) lgkmcnt(0)
  v_mfma_f32_16x16x32_bf16 v[96:99], v[64:67], v[240:243], v[96:99]
  s_barrier
  v_accvgpr_read_b32 v16, a72
  v_accvgpr_read_b32 v17, a73
  v_mfma_f32_16x16x32_bf16 v[112:115], v[68:71], v[240:243], v[112:115]
  s_add_u32 s63, s63, s61
  ds_read_b64_tr_b16 v[32:33], v12 offset:32768
  v_accvgpr_read_b32 v18, a74
  v_mfma_f32_16x16x32_bf16 v[128:131], v[72:75], v[240:243], v[128:131]
  s_add_u32 m0, s24, 32768
  ds_read_b64_tr_b16 v[34:35], v12 offset:33792
  v_accvgpr_read_b32 v19, a75
  v_mfma_f32_16x16x32_bf16 v[144:147], v[76:79], v[240:243], v[144:147]
  buffer_load_dwordx4 v3, s[32:35], s26 offen offset:0 sc1 lds
  v_accvgpr_read_b32 v20, a104
  v_mfma_f32_16x16x32_bf16 v[160:163], v[80:83], v[240:243], v[160:163]
  ds_read_b64_tr_b16 v[36:37], v13 offset:32768
  v_accvgpr_read_b32 v21, a105
  v_mfma_f32_16x16x32_bf16 v[176:179], v[84:87], v[240:243], v[176:179]
  ds_read_b64_tr_b16 v[38:39], v13 offset:33792
  v_accvgpr_read_b32 v22, a106
  v_mfma_f32_16x16x32_bf16 v[192:195], v[88:91], v[240:243], v[192:195]
  ds_read_b64_tr_b16 v[40:41], v12 offset:33024
  v_accvgpr_read_b32 v23, a107
  v_mfma_f32_16x16x32_bf16 v[208:211], v[92:95], v[240:243], v[208:211]
  ds_read_b64_tr_b16 v[42:43], v12 offset:34048
  v_cvt_pk_bf16_f32 v24, v16, v17
  v_mfma_f32_16x16x32_bf16 v[100:103], v[64:67], v[244:247], v[100:103]
  buffer_load_dwordx4 v4, s[32:35], s26 offen offset:1024 sc1 lds
  v_cvt_pk_bf16_f32 v25, v18, v19
  v_mfma_f32_16x16x32_bf16 v[116:119], v[68:71], v[244:247], v[116:119]
  ds_read_b64_tr_b16 v[44:45], v13 offset:33024
  v_cvt_pk_bf16_f32 v26, v20, v21
  v_mfma_f32_16x16x32_bf16 v[132:135], v[72:75], v[244:247], v[132:135]
  ds_read_b64_tr_b16 v[46:47], v13 offset:34048
  v_cvt_pk_bf16_f32 v27, v22, v23
  v_mfma_f32_16x16x32_bf16 v[148:151], v[76:79], v[244:247], v[148:151]
  ds_read_b128 v[224:227], v14 offset:0
  buffer_store_dwordx4 v[24:27], v2, s[40:43], s63 offen offset:0 sc1
  v_mfma_f32_16x16x32_bf16 v[164:167], v[80:83], v[244:247], v[164:167]
  ds_read_b128 v[228:231], v14 offset:1024
  v_accvgpr_read_b32 v16, a76
  v_mfma_f32_16x16x32_bf16 v[180:183], v[84:87], v[244:247], v[180:183]
  buffer_load_dwordx4 v5, s[32:35], s26 offen offset:2048 sc1 lds
  v_accvgpr_read_b32 v17, a77
  v_mfma_f32_16x16x32_bf16 v[196:199], v[88:91], v[244:247], v[196:199]
  ds_read_b64_tr_b16 v[48:49], v12 offset:33280
  v_accvgpr_read_b32 v18, a78
  v_mfma_f32_16x16x32_bf16 v[212:215], v[92:95], v[244:247], v[212:215]
  ds_read_b64_tr_b16 v[50:51], v12 offset:34304
  v_accvgpr_read_b32 v19, a79
  v_mfma_f32_16x16x32_bf16 v[104:107], v[64:67], v[248:251], v[104:107]
  ds_read_b64_tr_b16 v[52:53], v13 offset:33280
  v_accvgpr_read_b32 v20, a108
  v_mfma_f32_16x16x32_bf16 v[120:123], v[68:71], v[248:251], v[120:123]
  ds_read_b64_tr_b16 v[54:55], v13 offset:34304
  v_accvgpr_read_b32 v21, a109
  v_mfma_f32_16x16x32_bf16 v[136:139], v[72:75], v[248:251], v[136:139]
  buffer_load_dwordx4 v6, s[32:35], s26 offen offset:3072 sc1 lds
  v_accvgpr_read_b32 v22, a110
  v_mfma_f32_16x16x32_bf16 v[152:155], v[76:79], v[248:251], v[152:155]
  s_add_u32 s26, s26, 1024
  ds_read_b64_tr_b16 v[56:57], v12 offset:33536
  v_accvgpr_read_b32 v23, a111
  v_mfma_f32_16x16x32_bf16 v[168:171], v[80:83], v[248:251], v[168:171]
  ds_read_b64_tr_b16 v[58:59], v12 offset:34560
  v_cvt_pk_bf16_f32 v28, v16, v17
  v_mfma_f32_16x16x32_bf16 v[184:187], v[84:87], v[248:251], v[184:187]
  ds_read_b64_tr_b16 v[60:61], v13 offset:33536
  v_cvt_pk_bf16_f32 v29, v18, v19
  v_mfma_f32_16x16x32_bf16 v[200:203], v[88:91], v[248:251], v[200:203]
  s_add_u32 m0, s24, 81920
  ds_read_b64_tr_b16 v[62:63], v13 offset:34560
  v_cvt_pk_bf16_f32 v30, v20, v21
  v_mfma_f32_16x16x32_bf16 v[216:219], v[92:95], v[248:251], v[216:219]
  buffer_load_dwordx4 v8, s[36:39], s27 offen offset:0 lds
  v_cvt_pk_bf16_f32 v31, v22, v23
  v_mfma_f32_16x16x32_bf16 v[108:111], v[64:67], v[252:255], v[108:111]
  ds_read_b128 v[232:235], v14 offset:2048
  buffer_store_dwordx4 v[28:31], v2, s[40:43], s63 offen offset:1024 sc1
  v_mfma_f32_16x16x32_bf16 v[124:127], v[68:71], v[252:255], v[124:127]
  ds_read_b128 v[236:239], v14 offset:3072
  v_accvgpr_write_b32 a16, 0
  v_mfma_f32_16x16x32_bf16 v[140:143], v[72:75], v[252:255], v[140:143]
  v_accvgpr_write_b32 a17, 0
  v_accvgpr_write_b32 a18, 0
  v_mfma_f32_16x16x32_bf16 v[156:159], v[76:79], v[252:255], v[156:159]
  v_accvgpr_write_b32 a19, 0
  v_accvgpr_write_b32 a48, 0
  v_mfma_f32_16x16x32_bf16 v[172:175], v[80:83], v[252:255], v[172:175]
  buffer_load_dwordx4 v9, s[36:39], s27 offen offset:1024 lds
  v_accvgpr_write_b32 a49, 0
  v_mfma_f32_16x16x32_bf16 v[188:191], v[84:87], v[252:255], v[188:191]
  v_accvgpr_write_b32 a50, 0
  v_mfma_f32_16x16x32_bf16 v[204:207], v[88:91], v[252:255], v[204:207]
  v_mfma_f32_16x16x32_bf16 v[220:223], v[92:95], v[252:255], v[220:223]
  s_waitcnt vmcnt(19) lgkmcnt(0)
  v_mfma_f32_16x16x32_bf16 v[96:99], v[32:35], v[224:227], v[96:99]
  s_add_u32 s63, s63, s61
  v_accvgpr_read_b32 v16, a80
  v_accvgpr_read_b32 v17, a81
  v_mfma_f32_16x16x32_bf16 v[112:115], v[36:39], v[224:227], v[112:115]
  ds_read_b64_tr_b16 v[64:65], v12 offset:40960
  v_accvgpr_read_b32 v18, a82
  v_mfma_f32_16x16x32_bf16 v[128:131], v[40:43], v[224:227], v[128:131]
  s_add_u32 m0, s24, 65536
  ds_read_b64_tr_b16 v[66:67], v12 offset:41984
  v_accvgpr_read_b32 v19, a83
  v_mfma_f32_16x16x32_bf16 v[144:147], v[44:47], v[224:227], v[144:147]
  buffer_load_dwordx4 v3, s[32:35], s26 offen offset:0 sc1 lds
  v_accvgpr_read_b32 v20, a112
  v_mfma_f32_16x16x32_bf16 v[160:163], v[48:51], v[224:227], v[160:163]
  ds_read_b64_tr_b16 v[68:69], v13 offset:40960
  v_accvgpr_read_b32 v21, a113
  v_mfma_f32_16x16x32_bf16 v[176:179], v[52:55], v[224:227], v[176:179]
  ds_read_b64_tr_b16 v[70:71], v13 offset:41984
  v_accvgpr_read_b32 v22, a114
  v_mfma_f32_16x16x32_bf16 v[192:195], v[56:59], v[224:227], v[192:195]
  ds_read_b64_tr_b16 v[72:73], v12 offset:41216
  v_accvgpr_read_b32 v23, a115
  v_mfma_f32_16x16x32_bf16 v[208:211], v[60:63], v[224:227], v[208:211]
  ds_read_b64_tr_b16 v[74:75], v12 offset:42240
  v_cvt_pk_bf16_f32 v24, v16, v17
  v_mfma_f32_16x16x32_bf16 v[100:103], v[32:35], v[228:231], v[100:103]
  buffer_load_dwordx4 v4, s[32:35], s26 offen offset:1024 sc1 lds
  v_cvt_pk_bf16_f32 v25, v18, v19
  v_mfma_f32_16x16x32_bf16 v[116:119], v[36:39], v[228:231], v[116:119]
  ds_read_b64_tr_b16 v[76:77], v13 offset:41216
  v_cvt_pk_bf16_f32 v26, v20, v21
  v_mfma_f32_16x16x32_bf16 v[132:135], v[40:43], v[228:231], v[132:135]
  ds_read_b64_tr_b16 v[78:79], v13 offset:42240
  v_cvt_pk_bf16_f32 v27, v22, v23
  v_mfma_f32_16x16x32_bf16 v[148:151], v[44:47], v[228:231], v[148:151]
  ds_read_b128 v[240:243], v14 offset:32768
  buffer_store_dwordx4 v[24:27], v2, s[40:43], s63 offen offset:0 sc1
  v_mfma_f32_16x16x32_bf16 v[164:167], v[48:51], v[228:231], v[164:167]
  ds_read_b128 v[244:247], v14 offset:33792
  v_accvgpr_read_b32 v16, a84
  v_mfma_f32_16x16x32_bf16 v[180:183], v[52:55], v[228:231], v[180:183]
  buffer_load_dwordx4 v5, s[32:35], s26 offen offset:2048 sc1 lds
  v_accvgpr_read_b32 v17, a85
  v_mfma_f32_16x16x32_bf16 v[196:199], v[56:59], v[228:231], v[196:199]
  ds_read_b64_tr_b16 v[80:81], v12 offset:41472
  v_accvgpr_read_b32 v18, a86
  v_mfma_f32_16x16x32_bf16 v[212:215], v[60:63], v[228:231], v[212:215]
  ds_read_b64_tr_b16 v[82:83], v12 offset:42496
  v_accvgpr_read_b32 v19, a87
  v_mfma_f32_16x16x32_bf16 v[104:107], v[32:35], v[232:235], v[104:107]
  ds_read_b64_tr_b16 v[84:85], v13 offset:41472
  v_accvgpr_read_b32 v20, a116
  v_mfma_f32_16x16x32_bf16 v[120:123], v[36:39], v[232:235], v[120:123]
  ds_read_b64_tr_b16 v[86:87], v13 offset:42496
  v_accvgpr_read_b32 v21, a117
  v_mfma_f32_16x16x32_bf16 v[136:139], v[40:43], v[232:235], v[136:139]
  buffer_load_dwordx4 v6, s[32:35], s26 offen offset:3072 sc1 lds
  v_accvgpr_read_b32 v22, a118
  v_mfma_f32_16x16x32_bf16 v[152:155], v[44:47], v[232:235], v[152:155]
  s_add_u32 s26, s26, 1024
  ds_read_b64_tr_b16 v[88:89], v12 offset:41728
  v_accvgpr_read_b32 v23, a119
  v_mfma_f32_16x16x32_bf16 v[168:171], v[48:51], v[232:235], v[168:171]
  ds_read_b64_tr_b16 v[90:91], v12 offset:42752
  v_cvt_pk_bf16_f32 v28, v16, v17
  v_mfma_f32_16x16x32_bf16 v[184:187], v[52:55], v[232:235], v[184:187]
  ds_read_b64_tr_b16 v[92:93], v13 offset:41728
  v_cvt_pk_bf16_f32 v29, v18, v19
  v_mfma_f32_16x16x32_bf16 v[200:203], v[56:59], v[232:235], v[200:203]
  s_add_u32 m0, s24, 81920
  ds_read_b64_tr_b16 v[94:95], v13 offset:42752
  v_cvt_pk_bf16_f32 v30, v20, v21
  v_mfma_f32_16x16x32_bf16 v[216:219], v[60:63], v[232:235], v[216:219]
  buffer_load_dwordx4 v10, s[36:39], s27 offen offset:2048 lds
  v_cvt_pk_bf16_f32 v31, v22, v23
  v_mfma_f32_16x16x32_bf16 v[108:111], v[32:35], v[236:239], v[108:111]
  ds_read_b128 v[248:251], v14 offset:34816
  buffer_store_dwordx4 v[28:31], v2, s[40:43], s63 offen offset:1024 sc1
  v_mfma_f32_16x16x32_bf16 v[124:127], v[36:39], v[236:239], v[124:127]
  ds_read_b128 v[252:255], v14 offset:35840
  v_accvgpr_write_b32 a51, 0
  v_mfma_f32_16x16x32_bf16 v[140:143], v[40:43], v[236:239], v[140:143]
  v_accvgpr_write_b32 a20, 0
  v_accvgpr_write_b32 a21, 0
  v_mfma_f32_16x16x32_bf16 v[156:159], v[44:47], v[236:239], v[156:159]
  v_xor_b32 v14, 0x10000, v14
  v_accvgpr_write_b32 a22, 0
  v_mfma_f32_16x16x32_bf16 v[172:175], v[48:51], v[236:239], v[172:175]
  buffer_load_dwordx4 v11, s[36:39], s27 offen offset:3072 lds
  v_mfma_f32_16x16x32_bf16 v[188:191], v[52:55], v[236:239], v[188:191]
  s_add_u32 s27, s27, 524288
  v_xor_b32 v12, 0x10000, v12
  v_mfma_f32_16x16x32_bf16 v[204:207], v[56:59], v[236:239], v[204:207]
  v_xor_b32 v13, 0x10000, v13
  v_mfma_f32_16x16x32_bf16 v[220:223], v[60:63], v[236:239], v[220:223]
  s_waitcnt vmcnt(19) lgkmcnt(0)
  v_mfma_f32_16x16x32_bf16 v[96:99], v[64:67], v[240:243], v[96:99]
  s_barrier
  v_accvgpr_read_b32 v16, a88
  v_accvgpr_read_b32 v17, a89
  v_mfma_f32_16x16x32_bf16 v[112:115], v[68:71], v[240:243], v[112:115]
  s_add_u32 s63, s63, s61
  ds_read_b64_tr_b16 v[32:33], v12 offset:0
  v_accvgpr_read_b32 v18, a90
  v_mfma_f32_16x16x32_bf16 v[128:131], v[72:75], v[240:243], v[128:131]
  s_add_u32 m0, s24, 98304
  ds_read_b64_tr_b16 v[34:35], v12 offset:1024
  v_accvgpr_read_b32 v19, a91
  v_mfma_f32_16x16x32_bf16 v[144:147], v[76:79], v[240:243], v[144:147]
  buffer_load_dwordx4 v3, s[32:35], s26 offen offset:0 sc1 lds
  v_accvgpr_read_b32 v20, a120
  v_mfma_f32_16x16x32_bf16 v[160:163], v[80:83], v[240:243], v[160:163]
  ds_read_b64_tr_b16 v[36:37], v13 offset:0
  v_accvgpr_read_b32 v21, a121
  v_mfma_f32_16x16x32_bf16 v[176:179], v[84:87], v[240:243], v[176:179]
  ds_read_b64_tr_b16 v[38:39], v13 offset:1024
  v_accvgpr_read_b32 v22, a122
  v_mfma_f32_16x16x32_bf16 v[192:195], v[88:91], v[240:243], v[192:195]
  ds_read_b64_tr_b16 v[40:41], v12 offset:256
  v_accvgpr_read_b32 v23, a123
  v_mfma_f32_16x16x32_bf16 v[208:211], v[92:95], v[240:243], v[208:211]
  ds_read_b64_tr_b16 v[42:43], v12 offset:1280
  v_cvt_pk_bf16_f32 v24, v16, v17
  v_mfma_f32_16x16x32_bf16 v[100:103], v[64:67], v[244:247], v[100:103]
  buffer_load_dwordx4 v4, s[32:35], s26 offen offset:1024 sc1 lds
  v_cvt_pk_bf16_f32 v25, v18, v19
  v_mfma_f32_16x16x32_bf16 v[116:119], v[68:71], v[244:247], v[116:119]
  ds_read_b64_tr_b16 v[44:45], v13 offset:256
  v_cvt_pk_bf16_f32 v26, v20, v21
  v_mfma_f32_16x16x32_bf16 v[132:135], v[72:75], v[244:247], v[132:135]
  ds_read_b64_tr_b16 v[46:47], v13 offset:1280
  v_cvt_pk_bf16_f32 v27, v22, v23
  v_mfma_f32_16x16x32_bf16 v[148:151], v[76:79], v[244:247], v[148:151]
  ds_read_b128 v[224:227], v14 offset:0
  buffer_store_dwordx4 v[24:27], v2, s[40:43], s63 offen offset:0 sc1
  v_mfma_f32_16x16x32_bf16 v[164:167], v[80:83], v[244:247], v[164:167]
  ds_read_b128 v[228:231], v14 offset:1024
  v_accvgpr_read_b32 v16, a92
  v_mfma_f32_16x16x32_bf16 v[180:183], v[84:87], v[244:247], v[180:183]
  buffer_load_dwordx4 v5, s[32:35], s26 offen offset:2048 sc1 lds
  v_accvgpr_read_b32 v17, a93
  v_mfma_f32_16x16x32_bf16 v[196:199], v[88:91], v[244:247], v[196:199]
  ds_read_b64_tr_b16 v[48:49], v12 offset:512
  v_accvgpr_read_b32 v18, a94
  v_mfma_f32_16x16x32_bf16 v[212:215], v[92:95], v[244:247], v[212:215]
  ds_read_b64_tr_b16 v[50:51], v12 offset:1536
  v_accvgpr_read_b32 v19, a95
  v_mfma_f32_16x16x32_bf16 v[104:107], v[64:67], v[248:251], v[104:107]
  ds_read_b64_tr_b16 v[52:53], v13 offset:512
  v_accvgpr_read_b32 v20, a124
  v_mfma_f32_16x16x32_bf16 v[120:123], v[68:71], v[248:251], v[120:123]
  ds_read_b64_tr_b16 v[54:55], v13 offset:1536
  v_accvgpr_read_b32 v21, a125
  v_mfma_f32_16x16x32_bf16 v[136:139], v[72:75], v[248:251], v[136:139]
  buffer_load_dwordx4 v6, s[32:35], s26 offen offset:3072 sc1 lds
  v_accvgpr_read_b32 v22, a126
  v_mfma_f32_16x16x32_bf16 v[152:155], v[76:79], v[248:251], v[152:155]
  s_add_u32 s26, s26, 1024
  ds_read_b64_tr_b16 v[56:57], v12 offset:768
  v_accvgpr_read_b32 v23, a127
  v_mfma_f32_16x16x32_bf16 v[168:171], v[80:83], v[248:251], v[168:171]
  ds_read_b64_tr_b16 v[58:59], v12 offset:1792
  v_cvt_pk_bf16_f32 v28, v16, v17
  v_mfma_f32_16x16x32_bf16 v[184:187], v[84:87], v[248:251], v[184:187]
  ds_read_b64_tr_b16 v[60:61], v13 offset:768
  v_cvt_pk_bf16_f32 v29, v18, v19
  v_mfma_f32_16x16x32_bf16 v[200:203], v[88:91], v[248:251], v[200:203]
  s_add_u32 m0, s24, 114688
  ds_read_b64_tr_b16 v[62:63], v13 offset:1792
  v_cvt_pk_bf16_f32 v30, v20, v21
  v_mfma_f32_16x16x32_bf16 v[216:219], v[92:95], v[248:251], v[216:219]
  buffer_load_dwordx4 v8, s[36:39], s27 offen offset:0 lds
  v_cvt_pk_bf16_f32 v31, v22, v23
  v_mfma_f32_16x16x32_bf16 v[108:111], v[64:67], v[252:255], v[108:111]
  ds_read_b128 v[232:235], v14 offset:2048
  buffer_store_dwordx4 v[28:31], v2, s[40:43], s63 offen offset:1024 sc1
  v_mfma_f32_16x16x32_bf16 v[124:127], v[68:71], v[252:255], v[124:127]
  ds_read_b128 v[236:239], v14 offset:3072
  v_accvgpr_write_b32 a23, 0
  v_mfma_f32_16x16x32_bf16 v[140:143], v[72:75], v[252:255], v[140:143]
  v_accvgpr_write_b32 a52, 0
  v_accvgpr_write_b32 a53, 0
  v_mfma_f32_16x16x32_bf16 v[156:159], v[76:79], v[252:255], v[156:159]
  v_accvgpr_write_b32 a54, 0
  v_accvgpr_write_b32 a55, 0
  v_mfma_f32_16x16x32_bf16 v[172:175], v[80:83], v[252:255], v[172:175]
  buffer_load_dwordx4 v9, s[36:39], s27 offen offset:1024 lds
  v_accvgpr_write_b32 a24, 0
  v_mfma_f32_16x16x32_bf16 v[188:191], v[84:87], v[252:255], v[188:191]
  v_accvgpr_write_b32 a25, 0
  v_mfma_f32_16x16x32_bf16 v[204:207], v[88:91], v[252:255], v[204:207]
  v_mfma_f32_16x16x32_bf16 v[220:223], v[92:95], v[252:255], v[220:223]
  s_waitcnt vmcnt(19) lgkmcnt(0)
  v_mfma_f32_16x16x32_bf16 v[96:99], v[32:35], v[224:227], v[96:99]
  s_mul_i32 s63, s60, 2
  v_accvgpr_read_b32 v16, a128
  v_accvgpr_read_b32 v17, a129
  v_mfma_f32_16x16x32_bf16 v[112:115], v[36:39], v[224:227], v[112:115]
  s_add_u32 s63, s63, s62
  ds_read_b64_tr_b16 v[64:65], v12 offset:8192
  v_accvgpr_read_b32 v18, a130
  v_mfma_f32_16x16x32_bf16 v[128:131], v[40:43], v[224:227], v[128:131]
  s_add_u32 m0, s24, 0
  ds_read_b64_tr_b16 v[66:67], v12 offset:9216
  v_accvgpr_read_b32 v19, a131
  v_mfma_f32_16x16x32_bf16 v[144:147], v[44:47], v[224:227], v[144:147]
  buffer_load_dwordx4 v3, s[32:35], s26 offen offset:0 sc1 lds
  v_accvgpr_read_b32 v20, a160
  v_mfma_f32_16x16x32_bf16 v[160:163], v[48:51], v[224:227], v[160:163]
  ds_read_b64_tr_b16 v[68:69], v13 offset:8192
  v_accvgpr_read_b32 v21, a161
  v_mfma_f32_16x16x32_bf16 v[176:179], v[52:55], v[224:227], v[176:179]
  ds_read_b64_tr_b16 v[70:71], v13 offset:9216
  v_accvgpr_read_b32 v22, a162
  v_mfma_f32_16x16x32_bf16 v[192:195], v[56:59], v[224:227], v[192:195]
  ds_read_b64_tr_b16 v[72:73], v12 offset:8448
  v_accvgpr_read_b32 v23, a163
  v_mfma_f32_16x16x32_bf16 v[208:211], v[60:63], v[224:227], v[208:211]
  ds_read_b64_tr_b16 v[74:75], v12 offset:9472
  v_cvt_pk_bf16_f32 v24, v16, v17
  v_mfma_f32_16x16x32_bf16 v[100:103], v[32:35], v[228:231], v[100:103]
  buffer_load_dwordx4 v4, s[32:35], s26 offen offset:1024 sc1 lds
  v_cvt_pk_bf16_f32 v25, v18, v19
  v_mfma_f32_16x16x32_bf16 v[116:119], v[36:39], v[228:231], v[116:119]
  ds_read_b64_tr_b16 v[76:77], v13 offset:8448
  v_cvt_pk_bf16_f32 v26, v20, v21
  v_mfma_f32_16x16x32_bf16 v[132:135], v[40:43], v[228:231], v[132:135]
  ds_read_b64_tr_b16 v[78:79], v13 offset:9472
  v_cvt_pk_bf16_f32 v27, v22, v23
  v_mfma_f32_16x16x32_bf16 v[148:151], v[44:47], v[228:231], v[148:151]
  ds_read_b128 v[240:243], v14 offset:32768
  buffer_store_dwordx4 v[24:27], v2, s[40:43], s63 offen offset:0 sc1
  v_mfma_f32_16x16x32_bf16 v[164:167], v[48:51], v[228:231], v[164:167]
  ds_read_b128 v[244:247], v14 offset:33792
  v_accvgpr_read_b32 v16, a132
  v_mfma_f32_16x16x32_bf16 v[180:183], v[52:55], v[228:231], v[180:183]
  buffer_load_dwordx4 v5, s[32:35], s26 offen offset:2048 sc1 lds
  v_accvgpr_read_b32 v17, a133
  v_mfma_f32_16x16x32_bf16 v[196:199], v[56:59], v[228:231], v[196:199]
  ds_read_b64_tr_b16 v[80:81], v12 offset:8704
  v_accvgpr_read_b32 v18, a134
  v_mfma_f32_16x16x32_bf16 v[212:215], v[60:63], v[228:231], v[212:215]
  ds_read_b64_tr_b16 v[82:83], v12 offset:9728
  v_accvgpr_read_b32 v19, a135
  v_mfma_f32_16x16x32_bf16 v[104:107], v[32:35], v[232:235], v[104:107]
  ds_read_b64_tr_b16 v[84:85], v13 offset:8704
  v_accvgpr_read_b32 v20, a164
  v_mfma_f32_16x16x32_bf16 v[120:123], v[36:39], v[232:235], v[120:123]
  ds_read_b64_tr_b16 v[86:87], v13 offset:9728
  v_accvgpr_read_b32 v21, a165
  v_mfma_f32_16x16x32_bf16 v[136:139], v[40:43], v[232:235], v[136:139]
  buffer_load_dwordx4 v6, s[32:35], s26 offen offset:3072 sc1 lds
  v_accvgpr_read_b32 v22, a166
  v_mfma_f32_16x16x32_bf16 v[152:155], v[44:47], v[232:235], v[152:155]
  s_add_u32 s26, s26, 1024
  ds_read_b64_tr_b16 v[88:89], v12 offset:8960
  v_accvgpr_read_b32 v23, a167
  v_mfma_f32_16x16x32_bf16 v[168:171], v[48:51], v[232:235], v[168:171]
  ds_read_b64_tr_b16 v[90:91], v12 offset:9984
  v_cvt_pk_bf16_f32 v28, v16, v17
  v_mfma_f32_16x16x32_bf16 v[184:187], v[52:55], v[232:235], v[184:187]
  ds_read_b64_tr_b16 v[92:93], v13 offset:8960
  v_cvt_pk_bf16_f32 v29, v18, v19
  v_mfma_f32_16x16x32_bf16 v[200:203], v[56:59], v[232:235], v[200:203]
  s_add_u32 m0, s24, 114688
  ds_read_b64_tr_b16 v[94:95], v13 offset:9984
  v_cvt_pk_bf16_f32 v30, v20, v21
  v_mfma_f32_16x16x32_bf16 v[216:219], v[60:63], v[232:235], v[216:219]
  buffer_load_dwordx4 v10, s[36:39], s27 offen offset:2048 lds
  v_cvt_pk_bf16_f32 v31, v22, v23
  v_mfma_f32_16x16x32_bf16 v[108:111], v[32:35], v[236:239], v[108:111]
  ds_read_b128 v[248:251], v14 offset:34816
  buffer_store_dwordx4 v[28:31], v2, s[40:43], s63 offen offset:1024 sc1
  v_mfma_f32_16x16x32_bf16 v[124:127], v[36:39], v[236:239], v[124:127]
  ds_read_b128 v[252:255], v14 offset:35840
  v_accvgpr_write_b32 a26, 0
  v_mfma_f32_16x16x32_bf16 v[140:143], v[40:43], v[236:239], v[140:143]
  v_accvgpr_write_b32 a27, 0
  v_accvgpr_write_b32 a56, 0
  v_mfma_f32_16x16x32_bf16 v[156:159], v[44:47], v[236:239], v[156:159]
  v_xor_b32 v14, 0x10000, v14
  v_accvgpr_write_b32 a57, 0
  v_mfma_f32_16x16x32_bf16 v[172:175], v[48:51], v[236:239], v[172:175]
  buffer_load_dwordx4 v11, s[36:39], s27 offen offset:3072 lds
  v_accvgpr_write_b32 a58, 0
  v_mfma_f32_16x16x32_bf16 v[188:191], v[52:55], v[236:239], v[188:191]
  s_add_u32 s27, s27, 524288
  v_accvgpr_write_b32 a59, 0
  v_mfma_f32_16x16x32_bf16 v[204:207], v[56:59], v[236:239], v[204:207]
  v_mfma_f32_16x16x32_bf16 v[220:223], v[60:63], v[236:239], v[220:223]
  s_waitcnt vmcnt(19) lgkmcnt(0)
  v_mfma_f32_16x16x32_bf16 v[96:99], v[64:67], v[240:243], v[96:99]
  s_barrier
  v_accvgpr_read_b32 v16, a136
  v_accvgpr_read_b32 v17, a137
  v_mfma_f32_16x16x32_bf16 v[112:115], v[68:71], v[240:243], v[112:115]
  s_add_u32 s63, s63, s61
  ds_read_b64_tr_b16 v[32:33], v12 offset:32768
  v_accvgpr_read_b32 v18, a138
  v_mfma_f32_16x16x32_bf16 v[128:131], v[72:75], v[240:243], v[128:131]
  s_add_u32 m0, s24, 32768
  ds_read_b64_tr_b16 v[34:35], v12 offset:33792
  v_accvgpr_read_b32 v19, a139
  v_mfma_f32_16x16x32_bf16 v[144:147], v[76:79], v[240:243], v[144:147]
  buffer_load_dwordx4 v3, s[32:35], s26 offen offset:0 sc1 lds
  v_accvgpr_read_b32 v20, a168
  v_mfma_f32_16x16x32_bf16 v[160:163], v[80:83], v[240:243], v[160:163]
  ds_read_b64_tr_b16 v[36:37], v13 offset:32768
  v_accvgpr_read_b32 v21, a169
  v_mfma_f32_16x16x32_bf16 v[176:179], v[84:87], v[240:243], v[176:179]
  ds_read_b64_tr_b16 v[38:39], v13 offset:33792
  v_accvgpr_read_b32 v22, a170
  v_mfma_f32_16x16x32_bf16 v[192:195], v[88:91], v[240:243], v[192:195]
  ds_read_b64_tr_b16 v[40:41], v12 offset:33024
  v_accvgpr_read_b32 v23, a171
  v_mfma_f32_16x16x32_bf16 v[208:211], v[92:95], v[240:243], v[208:211]
  ds_read_b64_tr_b16 v[42:43], v12 offset:34048
  v_cvt_pk_bf16_f32 v24, v16, v17
  v_mfma_f32_16x16x32_bf16 v[100:103], v[64:67], v[244:247], v[100:103]
  buffer_load_dwordx4 v4, s[32:35], s26 offen offset:1024 sc1 lds
  v_cvt_pk_bf16_f32 v25, v18, v19
  v_mfma_f32_16x16x32_bf16 v[116:119], v[68:71], v[244:247], v[116:119]
  ds_read_b64_tr_b16 v[44:45], v13 offset:33024
  v_cvt_pk_bf16_f32 v26, v20, v21
  v_mfma_f32_16x16x32_bf16 v[132:135], v[72:75], v[244:247], v[132:135]
  ds_read_b64_tr_b16 v[46:47], v13 offset:34048
  v_cvt_pk_bf16_f32 v27, v22, v23
  v_mfma_f32_16x16x32_bf16 v[148:151], v[76:79], v[244:247], v[148:151]
  ds_read_b128 v[224:227], v14 offset:0
  buffer_store_dwordx4 v[24:27], v2, s[40:43], s63 offen offset:0 sc1
  v_mfma_f32_16x16x32_bf16 v[164:167], v[80:83], v[244:247], v[164:167]
  ds_read_b128 v[228:231], v14 offset:1024
  v_accvgpr_read_b32 v16, a140
  v_mfma_f32_16x16x32_bf16 v[180:183], v[84:87], v[244:247], v[180:183]
  buffer_load_dwordx4 v5, s[32:35], s26 offen offset:2048 sc1 lds
  v_accvgpr_read_b32 v17, a141
  v_mfma_f32_16x16x32_bf16 v[196:199], v[88:91], v[244:247], v[196:199]
  ds_read_b64_tr_b16 v[48:49], v12 offset:33280
  v_accvgpr_read_b32 v18, a142
  v_mfma_f32_16x16x32_bf16 v[212:215], v[92:95], v[244:247], v[212:215]
  ds_read_b64_tr_b16 v[50:51], v12 offset:34304
  v_accvgpr_read_b32 v19, a143
  v_mfma_f32_16x16x32_bf16 v[104:107], v[64:67], v[248:251], v[104:107]
  ds_read_b64_tr_b16 v[52:53], v13 offset:33280
  v_accvgpr_read_b32 v20, a172
  v_mfma_f32_16x16x32_bf16 v[120:123], v[68:71], v[248:251], v[120:123]
  ds_read_b64_tr_b16 v[54:55], v13 offset:34304
  v_accvgpr_read_b32 v21, a173
  v_mfma_f32_16x16x32_bf16 v[136:139], v[72:75], v[248:251], v[136:139]
  buffer_load_dwordx4 v6, s[32:35], s26 offen offset:3072 sc1 lds
  v_accvgpr_read_b32 v22, a174
  v_mfma_f32_16x16x32_bf16 v[152:155], v[76:79], v[248:251], v[152:155]
  s_add_u32 s26, s26, 1024
  ds_read_b64_tr_b16 v[56:57], v12 offset:33536
  v_accvgpr_read_b32 v23, a175
  v_mfma_f32_16x16x32_bf16 v[168:171], v[80:83], v[248:251], v[168:171]
  ds_read_b64_tr_b16 v[58:59], v12 offset:34560
  v_cvt_pk_bf16_f32 v28, v16, v17
  v_mfma_f32_16x16x32_bf16 v[184:187], v[84:87], v[248:251], v[184:187]
  ds_read_b64_tr_b16 v[60:61], v13 offset:33536
  v_cvt_pk_bf16_f32 v29, v18, v19
  v_mfma_f32_16x16x32_bf16 v[200:203], v[88:91], v[248:251], v[200:203]
  s_add_u32 m0, s24, 16384
  ds_read_b64_tr_b16 v[62:63], v13 offset:34560
  v_cvt_pk_bf16_f32 v30, v20, v21
  v_mfma_f32_16x16x32_bf16 v[216:219], v[92:95], v[248:251], v[216:219]
  buffer_load_dwordx4 v8, s[36:39], s27 offen offset:0 lds
  v_cvt_pk_bf16_f32 v31, v22, v23
  v_mfma_f32_16x16x32_bf16 v[108:111], v[64:67], v[252:255], v[108:111]
  ds_read_b128 v[232:235], v14 offset:2048
  buffer_store_dwordx4 v[28:31], v2, s[40:43], s63 offen offset:1024 sc1
  v_mfma_f32_16x16x32_bf16 v[124:127], v[68:71], v[252:255], v[124:127]
  ds_read_b128 v[236:239], v14 offset:3072
  v_accvgpr_write_b32 a28, 0
  v_mfma_f32_16x16x32_bf16 v[140:143], v[72:75], v[252:255], v[140:143]
  v_accvgpr_write_b32 a29, 0
  v_accvgpr_write_b32 a30, 0
  v_mfma_f32_16x16x32_bf16 v[156:159], v[76:79], v[252:255], v[156:159]
  v_accvgpr_write_b32 a31, 0
  v_accvgpr_write_b32 a60, 0
  v_mfma_f32_16x16x32_bf16 v[172:175], v[80:83], v[252:255], v[172:175]
  buffer_load_dwordx4 v9, s[36:39], s27 offen offset:1024 lds
  v_accvgpr_write_b32 a61, 0
  v_mfma_f32_16x16x32_bf16 v[188:191], v[84:87], v[252:255], v[188:191]
  v_accvgpr_write_b32 a62, 0
  v_mfma_f32_16x16x32_bf16 v[204:207], v[88:91], v[252:255], v[204:207]
  v_mfma_f32_16x16x32_bf16 v[220:223], v[92:95], v[252:255], v[220:223]
  s_waitcnt vmcnt(19) lgkmcnt(0)
  v_mfma_f32_16x16x32_bf16 v[96:99], v[32:35], v[224:227], v[96:99]
  s_add_u32 s63, s63, s61
  v_accvgpr_read_b32 v16, a144
  v_accvgpr_read_b32 v17, a145
  v_mfma_f32_16x16x32_bf16 v[112:115], v[36:39], v[224:227], v[112:115]
  ds_read_b64_tr_b16 v[64:65], v12 offset:40960
  v_accvgpr_read_b32 v18, a146
  v_mfma_f32_16x16x32_bf16 v[128:131], v[40:43], v[224:227], v[128:131]
  s_add_u32 m0, s24, 65536
  ds_read_b64_tr_b16 v[66:67], v12 offset:41984
  v_accvgpr_read_b32 v19, a147
  v_mfma_f32_16x16x32_bf16 v[144:147], v[44:47], v[224:227], v[144:147]
  buffer_load_dwordx4 v3, s[32:35], s26 offen offset:0 sc1 lds
  v_accvgpr_read_b32 v20, a176
  v_mfma_f32_16x16x32_bf16 v[160:163], v[48:51], v[224:227], v[160:163]
  ds_read_b64_tr_b16 v[68:69], v13 offset:40960
  v_accvgpr_read_b32 v21, a177
  v_mfma_f32_16x16x32_bf16 v[176:179], v[52:55], v[224:227], v[176:179]
  ds_read_b64_tr_b16 v[70:71], v13 offset:41984
  v_accvgpr_read_b32 v22, a178
  v_mfma_f32_16x16x32_bf16 v[192:195], v[56:59], v[224:227], v[192:195]
  ds_read_b64_tr_b16 v[72:73], v12 offset:41216
  v_accvgpr_read_b32 v23, a179
  v_mfma_f32_16x16x32_bf16 v[208:211], v[60:63], v[224:227], v[208:211]
  ds_read_b64_tr_b16 v[74:75], v12 offset:42240
  v_cvt_pk_bf16_f32 v24, v16, v17
  v_mfma_f32_16x16x32_bf16 v[100:103], v[32:35], v[228:231], v[100:103]
  buffer_load_dwordx4 v4, s[32:35], s26 offen offset:1024 sc1 lds
  v_cvt_pk_bf16_f32 v25, v18, v19
  v_mfma_f32_16x16x32_bf16 v[116:119], v[36:39], v[228:231], v[116:119]
  ds_read_b64_tr_b16 v[76:77], v13 offset:41216
  v_cvt_pk_bf16_f32 v26, v20, v21
  v_mfma_f32_16x16x32_bf16 v[132:135], v[40:43], v[228:231], v[132:135]
  ds_read_b64_tr_b16 v[78:79], v13 offset:42240
  v_cvt_pk_bf16_f32 v27, v22, v23
  v_mfma_f32_16x16x32_bf16 v[148:151], v[44:47], v[228:231], v[148:151]
  ds_read_b128 v[240:243], v14 offset:32768
  buffer_store_dwordx4 v[24:27], v2, s[40:43], s63 offen offset:0 sc1
  v_mfma_f32_16x16x32_bf16 v[164:167], v[48:51], v[228:231], v[164:167]
  ds_read_b128 v[244:247], v14 offset:33792
  v_accvgpr_read_b32 v16, a148
  v_mfma_f32_16x16x32_bf16 v[180:183], v[52:55], v[228:231], v[180:183]
  buffer_load_dwordx4 v5, s[32:35], s26 offen offset:2048 sc1 lds
  v_accvgpr_read_b32 v17, a149
  v_mfma_f32_16x16x32_bf16 v[196:199], v[56:59], v[228:231], v[196:199]
  ds_read_b64_tr_b16 v[80:81], v12 offset:41472
  v_accvgpr_read_b32 v18, a150
  v_mfma_f32_16x16x32_bf16 v[212:215], v[60:63], v[228:231], v[212:215]
  ds_read_b64_tr_b16 v[82:83], v12 offset:42496
  v_accvgpr_read_b32 v19, a151
  v_mfma_f32_16x16x32_bf16 v[104:107], v[32:35], v[232:235], v[104:107]
  ds_read_b64_tr_b16 v[84:85], v13 offset:41472
  v_accvgpr_read_b32 v20, a180
  v_mfma_f32_16x16x32_bf16 v[120:123], v[36:39], v[232:235], v[120:123]
  ds_read_b64_tr_b16 v[86:87], v13 offset:42496
  v_accvgpr_read_b32 v21, a181
  v_mfma_f32_16x16x32_bf16 v[136:139], v[40:43], v[232:235], v[136:139]
  buffer_load_dwordx4 v6, s[32:35], s26 offen offset:3072 sc1 lds
  v_accvgpr_read_b32 v22, a182
  v_mfma_f32_16x16x32_bf16 v[152:155], v[44:47], v[232:235], v[152:155]
  s_add_u32 s26, s26, 1024
  ds_read_b64_tr_b16 v[88:89], v12 offset:41728
  v_accvgpr_read_b32 v23, a183
  v_mfma_f32_16x16x32_bf16 v[168:171], v[48:51], v[232:235], v[168:171]
  ds_read_b64_tr_b16 v[90:91], v12 offset:42752
  v_cvt_pk_bf16_f32 v28, v16, v17
  v_mfma_f32_16x16x32_bf16 v[184:187], v[52:55], v[232:235], v[184:187]
  ds_read_b64_tr_b16 v[92:93], v13 offset:41728
  v_cvt_pk_bf16_f32 v29, v18, v19
  v_mfma_f32_16x16x32_bf16 v[200:203], v[56:59], v[232:235], v[200:203]
  s_add_u32 m0, s24, 16384
  ds_read_b64_tr_b16 v[94:95], v13 offset:42752
  v_cvt_pk_bf16_f32 v30, v20, v21
  v_mfma_f32_16x16x32_bf16 v[216:219], v[60:63], v[232:235], v[216:219]
  buffer_load_dwordx4 v10, s[36:39], s27 offen offset:2048 lds
  v_cvt_pk_bf16_f32 v31, v22, v23
  v_mfma_f32_16x16x32_bf16 v[108:111], v[32:35], v[236:239], v[108:111]
  ds_read_b128 v[248:251], v14 offset:34816
  buffer_store_dwordx4 v[28:31], v2, s[40:43], s63 offen offset:1024 sc1
  v_mfma_f32_16x16x32_bf16 v[124:127], v[36:39], v[236:239], v[124:127]
  ds_read_b128 v[252:255], v14 offset:35840
  v_accvgpr_write_b32 a63, 0
  v_mfma_f32_16x16x32_bf16 v[140:143], v[40:43], v[236:239], v[140:143]
  v_accvgpr_write_b32 a64, 0
  v_accvgpr_write_b32 a65, 0
  v_mfma_f32_16x16x32_bf16 v[156:159], v[44:47], v[236:239], v[156:159]
  v_xor_b32 v14, 0x10000, v14
  v_accvgpr_write_b32 a66, 0
  v_mfma_f32_16x16x32_bf16 v[172:175], v[48:51], v[236:239], v[172:175]
  buffer_load_dwordx4 v11, s[36:39], s27 offen offset:3072 lds
  v_mfma_f32_16x16x32_bf16 v[188:191], v[52:55], v[236:239], v[188:191]
  s_add_u32 s27, s27, 524288
  v_xor_b32 v12, 0x10000, v12
  v_mfma_f32_16x16x32_bf16 v[204:207], v[56:59], v[236:239], v[204:207]
  v_xor_b32 v13, 0x10000, v13
  v_mfma_f32_16x16x32_bf16 v[220:223], v[60:63], v[236:239], v[220:223]
  s_waitcnt vmcnt(19) lgkmcnt(0)
  v_mfma_f32_16x16x32_bf16 v[96:99], v[64:67], v[240:243], v[96:99]
  s_barrier
  v_accvgpr_read_b32 v16, a152
  v_accvgpr_read_b32 v17, a153
  v_mfma_f32_16x16x32_bf16 v[112:115], v[68:71], v[240:243], v[112:115]
  s_add_u32 s63, s63, s61
  ds_read_b64_tr_b16 v[32:33], v12 offset:0
  v_accvgpr_read_b32 v18, a154
  v_mfma_f32_16x16x32_bf16 v[128:131], v[72:75], v[240:243], v[128:131]
  s_add_u32 m0, s24, 98304
  ds_read_b64_tr_b16 v[34:35], v12 offset:1024
  v_accvgpr_read_b32 v19, a155
  v_mfma_f32_16x16x32_bf16 v[144:147], v[76:79], v[240:243], v[144:147]
  buffer_load_dwordx4 v3, s[32:35], s26 offen offset:0 sc1 lds
  v_accvgpr_read_b32 v20, a184
  v_mfma_f32_16x16x32_bf16 v[160:163], v[80:83], v[240:243], v[160:163]
  ds_read_b64_tr_b16 v[36:37], v13 offset:0
  v_accvgpr_read_b32 v21, a185
  v_mfma_f32_16x16x32_bf16 v[176:179], v[84:87], v[240:243], v[176:179]
  ds_read_b64_tr_b16 v[38:39], v13 offset:1024
  v_accvgpr_read_b32 v22, a186
  v_mfma_f32_16x16x32_bf16 v[192:195], v[88:91], v[240:243], v[192:195]
  ds_read_b64_tr_b16 v[40:41], v12 offset:256
  v_accvgpr_read_b32 v23, a187
  v_mfma_f32_16x16x32_bf16 v[208:211], v[92:95], v[240:243], v[208:211]
  ds_read_b64_tr_b16 v[42:43], v12 offset:1280
  v_cvt_pk_bf16_f32 v24, v16, v17
  v_mfma_f32_16x16x32_bf16 v[100:103], v[64:67], v[244:247], v[100:103]
  buffer_load_dwordx4 v4, s[32:35], s26 offen offset:1024 sc1 lds
  v_cvt_pk_bf16_f32 v25, v18, v19
  v_mfma_f32_16x16x32_bf16 v[116:119], v[68:71], v[244:247], v[116:119]
  ds_read_b64_tr_b16 v[44:45], v13 offset:256
  v_cvt_pk_bf16_f32 v26, v20, v21
  v_mfma_f32_16x16x32_bf16 v[132:135], v[72:75], v[244:247], v[132:135]
  ds_read_b64_tr_b16 v[46:47], v13 offset:1280
  v_cvt_pk_bf16_f32 v27, v22, v23
  v_mfma_f32_16x16x32_bf16 v[148:151], v[76:79], v[244:247], v[148:151]
  ds_read_b128 v[224:227], v14 offset:0
  buffer_store_dwordx4 v[24:27], v2, s[40:43], s63 offen offset:0 sc1
  v_mfma_f32_16x16x32_bf16 v[164:167], v[80:83], v[244:247], v[164:167]
  ds_read_b128 v[228:231], v14 offset:1024
  v_accvgpr_read_b32 v16, a156
  v_mfma_f32_16x16x32_bf16 v[180:183], v[84:87], v[244:247], v[180:183]
  buffer_load_dwordx4 v5, s[32:35], s26 offen offset:2048 sc1 lds
  v_accvgpr_read_b32 v17, a157
  v_mfma_f32_16x16x32_bf16 v[196:199], v[88:91], v[244:247], v[196:199]
  ds_read_b64_tr_b16 v[48:49], v12 offset:512
  v_accvgpr_read_b32 v18, a158
  v_mfma_f32_16x16x32_bf16 v[212:215], v[92:95], v[244:247], v[212:215]
  ds_read_b64_tr_b16 v[50:51], v12 offset:1536
  v_accvgpr_read_b32 v19, a159
  v_mfma_f32_16x16x32_bf16 v[104:107], v[64:67], v[248:251], v[104:107]
  ds_read_b64_tr_b16 v[52:53], v13 offset:512
  v_accvgpr_read_b32 v20, a188
  v_mfma_f32_16x16x32_bf16 v[120:123], v[68:71], v[248:251], v[120:123]
  ds_read_b64_tr_b16 v[54:55], v13 offset:1536
  v_accvgpr_read_b32 v21, a189
  v_mfma_f32_16x16x32_bf16 v[136:139], v[72:75], v[248:251], v[136:139]
  buffer_load_dwordx4 v6, s[32:35], s26 offen offset:3072 sc1 lds
  v_accvgpr_read_b32 v22, a190
  v_mfma_f32_16x16x32_bf16 v[152:155], v[76:79], v[248:251], v[152:155]
  s_add_u32 s26, s26, 1024
  ds_read_b64_tr_b16 v[56:57], v12 offset:768
  v_accvgpr_read_b32 v23, a191
  v_mfma_f32_16x16x32_bf16 v[168:171], v[80:83], v[248:251], v[168:171]
  ds_read_b64_tr_b16 v[58:59], v12 offset:1792
  v_cvt_pk_bf16_f32 v28, v16, v17
  v_mfma_f32_16x16x32_bf16 v[184:187], v[84:87], v[248:251], v[184:187]
  ds_read_b64_tr_b16 v[60:61], v13 offset:768
  v_cvt_pk_bf16_f32 v29, v18, v19
  v_mfma_f32_16x16x32_bf16 v[200:203], v[88:91], v[248:251], v[200:203]
  s_add_u32 m0, s24, 49152
  ds_read_b64_tr_b16 v[62:63], v13 offset:1792
  v_cvt_pk_bf16_f32 v30, v20, v21
  v_mfma_f32_16x16x32_bf16 v[216:219], v[92:95], v[248:251], v[216:219]
  buffer_load_dwordx4 v8, s[36:39], s27 offen offset:0 lds
  v_cvt_pk_bf16_f32 v31, v22, v23
  v_mfma_f32_16x16x32_bf16 v[108:111], v[64:67], v[252:255], v[108:111]
  ds_read_b128 v[232:235], v14 offset:2048
  buffer_store_dwordx4 v[28:31], v2, s[40:43], s63 offen offset:1024 sc1
  v_mfma_f32_16x16x32_bf16 v[124:127], v[68:71], v[252:255], v[124:127]
  ds_read_b128 v[236:239], v14 offset:3072
  v_accvgpr_write_b32 a67, 0
  v_mfma_f32_16x16x32_bf16 v[140:143], v[72:75], v[252:255], v[140:143]
  v_accvgpr_write_b32 a96, 0
  v_accvgpr_write_b32 a97, 0
  v_mfma_f32_16x16x32_bf16 v[156:159], v[76:79], v[252:255], v[156:159]
  v_accvgpr_write_b32 a98, 0
  v_accvgpr_write_b32 a99, 0
  v_mfma_f32_16x16x32_bf16 v[172:175], v[80:83], v[252:255], v[172:175]
  buffer_load_dwordx4 v9, s[36:39], s27 offen offset:1024 lds
  v_accvgpr_write_b32 a68, 0
  v_mfma_f32_16x16x32_bf16 v[188:191], v[84:87], v[252:255], v[188:191]
  v_accvgpr_write_b32 a69, 0
  v_mfma_f32_16x16x32_bf16 v[204:207], v[88:91], v[252:255], v[204:207]
  v_mfma_f32_16x16x32_bf16 v[220:223], v[92:95], v[252:255], v[220:223]
  s_waitcnt vmcnt(19) lgkmcnt(0)
  v_mfma_f32_16x16x32_bf16 v[96:99], v[32:35], v[224:227], v[96:99]
  s_mul_i32 s63, s60, 3
  v_accvgpr_read_b32 v16, a192
  v_accvgpr_read_b32 v17, a193
  v_accvgpr_read_b32 v18, a194
  v_mfma_f32_16x16x32_bf16 v[112:115], v[36:39], v[224:227], v[112:115]
  s_add_u32 s63, s63, s62
  ds_read_b64_tr_b16 v[64:65], v12 offset:8192
  v_accvgpr_read_b32 v19, a195
  v_mfma_f32_16x16x32_bf16 v[128:131], v[40:43], v[224:227], v[128:131]
  s_add_u32 m0, s24, 0
  ds_read_b64_tr_b16 v[66:67], v12 offset:9216
  v_accvgpr_read_b32 v20, a224
  v_mfma_f32_16x16x32_bf16 v[144:147], v[44:47], v[224:227], v[144:147]
  buffer_load_dwordx4 v3, s[32:35], s26 offen offset:0 sc1 lds
  v_accvgpr_read_b32 v21, a225
  v_accvgpr_read_b32 v22, a226
  v_mfma_f32_16x16x32_bf16 v[160:163], v[48:51], v[224:227], v[160:163]
  ds_read_b64_tr_b16 v[68:69], v13 offset:8192
  v_accvgpr_read_b32 v23, a227
  v_mfma_f32_16x16x32_bf16 v[176:179], v[52:55], v[224:227], v[176:179]
  ds_read_b64_tr_b16 v[70:71], v13 offset:9216
  v_cvt_pk_bf16_f32 v24, v16, v17
  v_mfma_f32_16x16x32_bf16 v[192:195], v[56:59], v[224:227], v[192:195]
  ds_read_b64_tr_b16 v[72:73], v12 offset:8448
  v_cvt_pk_bf16_f32 v25, v18, v19
  v_mfma_f32_16x16x32_bf16 v[208:211], v[60:63], v[224:227], v[208:211]
  ds_read_b64_tr_b16 v[74:75], v12 offset:9472
  v_cvt_pk_bf16_f32 v26, v20, v21
  v_cvt_pk_bf16_f32 v27, v22, v23
  v_mfma_f32_16x16x32_bf16 v[100:103], v[32:35], v[228:231], v[100:103]
  buffer_load_dwordx4 v4, s[32:35], s26 offen offset:1024 sc1 lds
  buffer_store_dwordx4 v[24:27], v2, s[40:43], s63 offen offset:0 sc1
  v_mfma_f32_16x16x32_bf16 v[116:119], v[36:39], v[228:231], v[116:119]
  ds_read_b64_tr_b16 v[76:77], v13 offset:8448
  v_accvgpr_read_b32 v16, a196
  v_mfma_f32_16x16x32_bf16 v[132:135], v[40:43], v[228:231], v[132:135]
  ds_read_b64_tr_b16 v[78:79], v13 offset:9472
  v_accvgpr_read_b32 v17, a197
  v_mfma_f32_16x16x32_bf16 v[148:151], v[44:47], v[228:231], v[148:151]
  ds_read_b128 v[240:243], v14 offset:32768
  v_accvgpr_read_b32 v18, a198
  v_accvgpr_read_b32 v19, a199
  v_mfma_f32_16x16x32_bf16 v[164:167], v[48:51], v[228:231], v[164:167]
  ds_read_b128 v[244:247], v14 offset:33792
  v_accvgpr_read_b32 v20, a228
  v_mfma_f32_16x16x32_bf16 v[180:183], v[52:55], v[228:231], v[180:183]
  buffer_load_dwordx4 v5, s[32:35], s26 offen offset:2048 sc1 lds
  v_accvgpr_read_b32 v21, a229
  v_mfma_f32_16x16x32_bf16 v[196:199], v[56:59], v[228:231], v[196:199]
  ds_read_b64_tr_b16 v[80:81], v12 offset:8704
  v_accvgpr_read_b32 v22, a230
  v_mfma_f32_16x16x32_bf16 v[212:215], v[60:63], v[228:231], v[212:215]
  ds_read_b64_tr_b16 v[82:83], v12 offset:9728
  v_accvgpr_read_b32 v23, a231
  v_cvt_pk_bf16_f32 v28, v16, v17
  v_mfma_f32_16x16x32_bf16 v[104:107], v[32:35], v[232:235], v[104:107]
  ds_read_b64_tr_b16 v[84:85], v13 offset:8704
  v_cvt_pk_bf16_f32 v29, v18, v19
  v_mfma_f32_16x16x32_bf16 v[120:123], v[36:39], v[232:235], v[120:123]
  ds_read_b64_tr_b16 v[86:87], v13 offset:9728
  v_cvt_pk_bf16_f32 v30, v20, v21
  v_mfma_f32_16x16x32_bf16 v[136:139], v[40:43], v[232:235], v[136:139]
  buffer_load_dwordx4 v6, s[32:35], s26 offen offset:3072 sc1 lds
  v_cvt_pk_bf16_f32 v31, v22, v23
  v_mfma_f32_16x16x32_bf16 v[152:155], v[44:47], v[232:235], v[152:155]
  s_add_u32 s26, s26, 1024
  ds_read_b64_tr_b16 v[88:89], v12 offset:8960
  buffer_store_dwordx4 v[28:31], v2, s[40:43], s63 offen offset:1024 sc1
  v_mfma_f32_16x16x32_bf16 v[168:171], v[48:51], v[232:235], v[168:171]
  s_add_u32 s63, s63, s61
  ds_read_b64_tr_b16 v[90:91], v12 offset:9984
  v_accvgpr_read_b32 v16, a200
  v_mfma_f32_16x16x32_bf16 v[184:187], v[52:55], v[232:235], v[184:187]
  ds_read_b64_tr_b16 v[92:93], v13 offset:8960
  v_accvgpr_read_b32 v17, a201
  v_mfma_f32_16x16x32_bf16 v[200:203], v[56:59], v[232:235], v[200:203]
  s_add_u32 m0, s24, 49152
  ds_read_b64_tr_b16 v[94:95], v13 offset:9984
  v_accvgpr_read_b32 v18, a202
  v_accvgpr_read_b32 v19, a203
  v_mfma_f32_16x16x32_bf16 v[216:219], v[60:63], v[232:235], v[216:219]
  buffer_load_dwordx4 v10, s[36:39], s27 offen offset:2048 lds
  v_accvgpr_read_b32 v20, a232
  v_mfma_f32_16x16x32_bf16 v[108:111], v[32:35], v[236:239], v[108:111]
  ds_read_b128 v[248:251], v14 offset:34816
  v_accvgpr_read_b32 v21, a233
  v_mfma_f32_16x16x32_bf16 v[124:127], v[36:39], v[236:239], v[124:127]
  ds_read_b128 v[252:255], v14 offset:35840
  v_accvgpr_read_b32 v22, a234
  v_mfma_f32_16x16x32_bf16 v[140:143], v[40:43], v[236:239], v[140:143]
  v_accvgpr_read_b32 v23, a235
  v_cvt_pk_bf16_f32 v24, v16, v17
  v_cvt_pk_bf16_f32 v25, v18, v19
  v_mfma_f32_16x16x32_bf16 v[156:159], v[44:47], v[236:239], v[156:159]
  v_xor_b32 v14, 0x10000, v14
  v_cvt_pk_bf16_f32 v26, v20, v21
  v_mfma_f32_16x16x32_bf16 v[172:175], v[48:51], v[236:239], v[172:175]
  buffer_load_dwordx4 v11, s[36:39], s27 offen offset:3072 lds
  v_cvt_pk_bf16_f32 v27, v22, v23
  v_mfma_f32_16x16x32_bf16 v[188:191], v[52:55], v[236:239], v[188:191]
  s_add_u32 s27, s27, 524288
  buffer_store_dwordx4 v[24:27], v2, s[40:43], s63 offen offset:0 sc1
  v_mfma_f32_16x16x32_bf16 v[204:207], v[56:59], v[236:239], v[204:207]
  v_mfma_f32_16x16x32_bf16 v[220:223], v[60:63], v[236:239], v[220:223]
  s_waitcnt vmcnt(20) lgkmcnt(0)
  v_mfma_f32_16x16x32_bf16 v[96:99], v[64:67], v[240:243], v[96:99]
  s_barrier
  v_accvgpr_read_b32 v16, a204
  v_accvgpr_read_b32 v17, a205
  v_accvgpr_read_b32 v18, a206
  v_mfma_f32_16x16x32_bf16 v[112:115], v[68:71], v[240:243], v[112:115]
  ds_read_b64_tr_b16 v[32:33], v12 offset:32768
  v_accvgpr_read_b32 v19, a207
  v_accvgpr_read_b32 v20, a236
  v_mfma_f32_16x16x32_bf16 v[128:131], v[72:75], v[240:243], v[128:131]
  s_add_u32 m0, s24, 32768
  ds_read_b64_tr_b16 v[34:35], v12 offset:33792
  v_accvgpr_read_b32 v21, a237
  v_mfma_f32_16x16x32_bf16 v[144:147], v[76:79], v[240:243], v[144:147]
  buffer_load_dwordx4 v3, s[32:35], s26 offen offset:0 sc1 lds
  v_accvgpr_read_b32 v22, a238
  v_accvgpr_read_b32 v23, a239
  v_mfma_f32_16x16x32_bf16 v[160:163], v[80:83], v[240:243], v[160:163]
  ds_read_b64_tr_b16 v[36:37], v13 offset:32768
  v_cvt_pk_bf16_f32 v28, v16, v17
  v_cvt_pk_bf16_f32 v29, v18, v19
  v_mfma_f32_16x16x32_bf16 v[176:179], v[84:87], v[240:243], v[176:179]
  ds_read_b64_tr_b16 v[38:39], v13 offset:33792
  v_cvt_pk_bf16_f32 v30, v20, v21
  v_mfma_f32_16x16x32_bf16 v[192:195], v[88:91], v[240:243], v[192:195]
  ds_read_b64_tr_b16 v[40:41], v12 offset:33024
  v_cvt_pk_bf16_f32 v31, v22, v23
  v_mfma_f32_16x16x32_bf16 v[208:211], v[92:95], v[240:243], v[208:211]
  ds_read_b64_tr_b16 v[42:43], v12 offset:34048
  buffer_store_dwordx4 v[28:31], v2, s[40:43], s63 offen offset:1024 sc1
  v_accvgpr_read_b32 v16, a208
  v_mfma_f32_16x16x32_bf16 v[100:103], v[64:67], v[244:247], v[100:103]
  s_add_u32 s63, s63, s61
  buffer_load_dwordx4 v4, s[32:35], s26 offen offset:1024 sc1 lds
  v_accvgpr_read_b32 v17, a209
  v_mfma_f32_16x16x32_bf16 v[116:119], v[68:71], v[244:247], v[116:119]
  ds_read_b64_tr_b16 v[44:45], v13 offset:33024
  v_accvgpr_read_b32 v18, a210
  v_accvgpr_read_b32 v19, a211
  v_mfma_f32_16x16x32_bf16 v[132:135], v[72:75], v[244:247], v[132:135]
  ds_read_b64_tr_b16 v[46:47], v13 offset:34048
  v_accvgpr_read_b32 v20, a240
  v_mfma_f32_16x16x32_bf16 v[148:151], v[76:79], v[244:247], v[148:151]
  ds_read_b128 v[224:227], v14 offset:0
  v_accvgpr_read_b32 v21, a241
  v_accvgpr_read_b32 v22, a242
  v_mfma_f32_16x16x32_bf16 v[164:167], v[80:83], v[244:247], v[164:167]
  ds_read_b128 v[228:231], v14 offset:1024
  v_accvgpr_read_b32 v23, a243
  v_cvt_pk_bf16_f32 v24, v16, v17
  v_mfma_f32_16x16x32_bf16 v[180:183], v[84:87], v[244:247], v[180:183]
  buffer_load_dwordx4 v5, s[32:35], s26 offen offset:2048 sc1 lds
  v_cvt_pk_bf16_f32 v25, v18, v19
  v_mfma_f32_16x16x32_bf16 v[196:199], v[88:91], v[244:247], v[196:199]
  ds_read_b64_tr_b16 v[48:49], v12 offset:33280
  v_cvt_pk_bf16_f32 v26, v20, v21
  v_cvt_pk_bf16_f32 v27, v22, v23
  v_mfma_f32_16x16x32_bf16 v[212:215], v[92:95], v[244:247], v[212:215]
  ds_read_b64_tr_b16 v[50:51], v12 offset:34304
  buffer_store_dwordx4 v[24:27], v2, s[40:43], s63 offen offset:0 sc1
  v_accvgpr_read_b32 v16, a212
  v_mfma_f32_16x16x32_bf16 v[104:107], v[64:67], v[248:251], v[104:107]
  ds_read_b64_tr_b16 v[52:53], v13 offset:33280
  v_accvgpr_read_b32 v17, a213
  v_mfma_f32_16x16x32_bf16 v[120:123], v[68:71], v[248:251], v[120:123]
  ds_read_b64_tr_b16 v[54:55], v13 offset:34304
  v_accvgpr_read_b32 v18, a214
  v_accvgpr_read_b32 v19, a215
  v_mfma_f32_16x16x32_bf16 v[136:139], v[72:75], v[248:251], v[136:139]
  buffer_load_dwordx4 v6, s[32:35], s26 offen offset:3072 sc1 lds
  v_accvgpr_read_b32 v20, a244
  v_accvgpr_read_b32 v21, a245
  v_mfma_f32_16x16x32_bf16 v[152:155], v[76:79], v[248:251], v[152:155]
  s_add_u32 s26, s26, 1024
  ds_read_b64_tr_b16 v[56:57], v12 offset:33536
  v_accvgpr_read_b32 v22, a246
  v_mfma_f32_16x16x32_bf16 v[168:171], v[80:83], v[248:251], v[168:171]
  ds_read_b64_tr_b16 v[58:59], v12 offset:34560
  v_accvgpr_read_b32 v23, a247
  v_cvt_pk_bf16_f32 v28, v16, v17
  v_mfma_f32_16x16x32_bf16 v[184:187], v[84:87], v[248:251], v[184:187]
  ds_read_b64_tr_b16 v[60:61], v13 offset:33536
  v_cvt_pk_bf16_f32 v29, v18, v19
  v_mfma_f32_16x16x32_bf16 v[200:203], v[88:91], v[248:251], v[200:203]
  ds_read_b64_tr_b16 v[62:63], v13 offset:34560
  v_cvt_pk_bf16_f32 v30, v20, v21
  v_cvt_pk_bf16_f32 v31, v22, v23
  v_mfma_f32_16x16x32_bf16 v[216:219], v[92:95], v[248:251], v[216:219]
  buffer_store_dwordx4 v[28:31], v2, s[40:43], s63 offen offset:1024 sc1
  v_and_b32 v11, 15, v1
  v_lshrrev_b32 v10, 4, v1
  v_mfma_f32_16x16x32_bf16 v[108:111], v[64:67], v[252:255], v[108:111]
  ds_read_b128 v[232:235], v14 offset:2048
  v_lshlrev_b32 v10, 2, v10
  v_mfma_f32_16x16x32_bf16 v[124:127], v[68:71], v[252:255], v[124:127]
  ds_read_b128 v[236:239], v14 offset:3072
  v_sub_u32 v11, v11, v10
  v_cmp_le_i32 s[68:69], 0, v11
  v_mfma_f32_16x16x32_bf16 v[140:143], v[72:75], v[252:255], v[140:143]
  v_cmp_le_i32 s[70:71], 1, v11
  v_cmp_le_i32 s[72:73], 2, v11
  v_cmp_le_i32 s[74:75], 3, v11
  v_mfma_f32_16x16x32_bf16 v[156:159], v[76:79], v[252:255], v[156:159]
  v_and_b32 v8, 7, v1
  v_lshlrev_b32 v8, 2, v8
  v_mfma_f32_16x16x32_bf16 v[172:175], v[80:83], v[252:255], v[172:175]
  v_add_u32 v8, s30, v8
  v_mov_b32 v9, 1073741824
  v_mov_b32 v10, 1
  v_mfma_f32_16x16x32_bf16 v[188:191], v[84:87], v[252:255], v[188:191]
  v_writelane_b32 v9, s29, 0
  v_mfma_f32_16x16x32_bf16 v[204:207], v[88:91], v[252:255], v[204:207]
  v_mfma_f32_16x16x32_bf16 v[220:223], v[92:95], v[252:255], v[220:223]
  s_waitcnt vmcnt(19) lgkmcnt(0)
  v_mfma_f32_16x16x32_bf16 v[96:99], v[32:35], v[224:227], v[96:99]
  s_add_u32 s63, s63, s61
  v_accvgpr_read_b32 v16, a216
  v_accvgpr_read_b32 v17, a217
  v_mfma_f32_16x16x32_bf16 v[112:115], v[36:39], v[224:227], v[112:115]
  ds_read_b64_tr_b16 v[64:65], v12 offset:40960
  v_accvgpr_read_b32 v18, a218
  v_mfma_f32_16x16x32_bf16 v[128:131], v[40:43], v[224:227], v[128:131]
  s_add_u32 m0, s24, 65536
  ds_read_b64_tr_b16 v[66:67], v12 offset:41984
  v_accvgpr_read_b32 v19, a219
  v_mfma_f32_16x16x32_bf16 v[144:147], v[44:47], v[224:227], v[144:147]
  buffer_load_dwordx4 v3, s[32:35], s26 offen offset:0 sc1 lds
  v_accvgpr_read_b32 v20, a248
  v_mfma_f32_16x16x32_bf16 v[160:163], v[48:51], v[224:227], v[160:163]
  ds_read_b64_tr_b16 v[68:69], v13 offset:40960
  v_accvgpr_read_b32 v21, a249
  v_mfma_f32_16x16x32_bf16 v[176:179], v[52:55], v[224:227], v[176:179]
  ds_read_b64_tr_b16 v[70:71], v13 offset:41984
  v_accvgpr_read_b32 v22, a250
  v_mfma_f32_16x16x32_bf16 v[192:195], v[56:59], v[224:227], v[192:195]
  ds_read_b64_tr_b16 v[72:73], v12 offset:41216
  v_accvgpr_read_b32 v23, a251
  v_mfma_f32_16x16x32_bf16 v[208:211], v[60:63], v[224:227], v[208:211]
  ds_read_b64_tr_b16 v[74:75], v12 offset:42240
  v_cvt_pk_bf16_f32 v24, v16, v17
  v_mfma_f32_16x16x32_bf16 v[100:103], v[32:35], v[228:231], v[100:103]
  buffer_load_dwordx4 v4, s[32:35], s26 offen offset:1024 sc1 lds
  v_cvt_pk_bf16_f32 v25, v18, v19
  v_mfma_f32_16x16x32_bf16 v[116:119], v[36:39], v[228:231], v[116:119]
  ds_read_b64_tr_b16 v[76:77], v13 offset:41216
  v_cvt_pk_bf16_f32 v26, v20, v21
  v_mfma_f32_16x16x32_bf16 v[132:135], v[40:43], v[228:231], v[132:135]
  ds_read_b64_tr_b16 v[78:79], v13 offset:42240
  v_cvt_pk_bf16_f32 v27, v22, v23
  v_mfma_f32_16x16x32_bf16 v[148:151], v[44:47], v[228:231], v[148:151]
  ds_read_b128 v[240:243], v14 offset:32768
  buffer_store_dwordx4 v[24:27], v2, s[40:43], s63 offen offset:0 sc1
  v_mfma_f32_16x16x32_bf16 v[164:167], v[48:51], v[228:231], v[164:167]
  ds_read_b128 v[244:247], v14 offset:33792
  v_accvgpr_read_b32 v16, a220
  v_mfma_f32_16x16x32_bf16 v[180:183], v[52:55], v[228:231], v[180:183]
  buffer_load_dwordx4 v5, s[32:35], s26 offen offset:2048 sc1 lds
  v_accvgpr_read_b32 v17, a221
  v_mfma_f32_16x16x32_bf16 v[196:199], v[56:59], v[228:231], v[196:199]
  ds_read_b64_tr_b16 v[80:81], v12 offset:41472
  v_accvgpr_read_b32 v18, a222
  v_mfma_f32_16x16x32_bf16 v[212:215], v[60:63], v[228:231], v[212:215]
  ds_read_b64_tr_b16 v[82:83], v12 offset:42496
  v_accvgpr_read_b32 v19, a223
  v_mfma_f32_16x16x32_bf16 v[104:107], v[32:35], v[232:235], v[104:107]
  ds_read_b64_tr_b16 v[84:85], v13 offset:41472
  v_accvgpr_read_b32 v20, a252
  v_mfma_f32_16x16x32_bf16 v[120:123], v[36:39], v[232:235], v[120:123]
  ds_read_b64_tr_b16 v[86:87], v13 offset:42496
  v_accvgpr_read_b32 v21, a253
  v_mfma_f32_16x16x32_bf16 v[136:139], v[40:43], v[232:235], v[136:139]
  buffer_load_dwordx4 v6, s[32:35], s26 offen offset:3072 sc1 lds
  v_accvgpr_read_b32 v22, a254
  v_mfma_f32_16x16x32_bf16 v[152:155], v[44:47], v[232:235], v[152:155]
  s_add_u32 s26, s26, 1024
  ds_read_b64_tr_b16 v[88:89], v12 offset:41728
  v_accvgpr_read_b32 v23, a255
  v_mfma_f32_16x16x32_bf16 v[168:171], v[48:51], v[232:235], v[168:171]
  ds_read_b64_tr_b16 v[90:91], v12 offset:42752
  v_cvt_pk_bf16_f32 v28, v16, v17
  v_mfma_f32_16x16x32_bf16 v[184:187], v[52:55], v[232:235], v[184:187]
  ds_read_b64_tr_b16 v[92:93], v13 offset:41728
  v_cvt_pk_bf16_f32 v29, v18, v19
  v_mfma_f32_16x16x32_bf16 v[200:203], v[56:59], v[232:235], v[200:203]
  ds_read_b64_tr_b16 v[94:95], v13 offset:42752
  v_cvt_pk_bf16_f32 v30, v20, v21
  v_mfma_f32_16x16x32_bf16 v[216:219], v[60:63], v[232:235], v[216:219]
  v_cvt_pk_bf16_f32 v31, v22, v23
  v_mfma_f32_16x16x32_bf16 v[108:111], v[32:35], v[236:239], v[108:111]
  ds_read_b128 v[248:251], v14 offset:34816
  buffer_store_dwordx4 v[28:31], v2, s[40:43], s63 offen offset:1024 sc1
  v_mfma_f32_16x16x32_bf16 v[124:127], v[36:39], v[236:239], v[124:127]
  ds_read_b128 v[252:255], v14 offset:35840
  v_accvgpr_write_b32 a70, 0
  v_mfma_f32_16x16x32_bf16 v[140:143], v[40:43], v[236:239], v[140:143]
  v_accvgpr_write_b32 a71, 0
  v_accvgpr_write_b32 a100, 0
  v_mfma_f32_16x16x32_bf16 v[156:159], v[44:47], v[236:239], v[156:159]
  v_xor_b32 v14, 0x10000, v14
  v_accvgpr_write_b32 a101, 0
  v_mfma_f32_16x16x32_bf16 v[172:175], v[48:51], v[236:239], v[172:175]
  v_accvgpr_write_b32 a102, 0
  v_accvgpr_write_b32 a103, 0
  v_mfma_f32_16x16x32_bf16 v[188:191], v[52:55], v[236:239], v[188:191]
  v_xor_b32 v12, 0x10000, v12
  v_mfma_f32_16x16x32_bf16 v[204:207], v[56:59], v[236:239], v[204:207]
  v_xor_b32 v13, 0x10000, v13
  v_mfma_f32_16x16x32_bf16 v[220:223], v[60:63], v[236:239], v[220:223]
  s_waitcnt vmcnt(17) lgkmcnt(0)
  v_mfma_f32_16x16x32_bf16 v[96:99], v[64:67], v[240:243], v[96:99]
  s_barrier
  v_accvgpr_write_b32 a72, 0
  v_accvgpr_write_b32 a73, 0
  v_mfma_f32_16x16x32_bf16 v[112:115], v[68:71], v[240:243], v[112:115]
  ds_read_b64_tr_b16 v[32:33], v12 offset:0
  v_accvgpr_write_b32 a74, 0
  v_mfma_f32_16x16x32_bf16 v[128:131], v[72:75], v[240:243], v[128:131]
  s_add_u32 m0, s24, 98304
  ds_read_b64_tr_b16 v[34:35], v12 offset:1024
  v_accvgpr_write_b32 a75, 0
  v_mfma_f32_16x16x32_bf16 v[144:147], v[76:79], v[240:243], v[144:147]
  buffer_load_dwordx4 v3, s[32:35], s26 offen offset:0 sc1 lds
  v_accvgpr_write_b32 a104, 0
  v_mfma_f32_16x16x32_bf16 v[160:163], v[80:83], v[240:243], v[160:163]
  ds_read_b64_tr_b16 v[36:37], v13 offset:0
  v_accvgpr_write_b32 a105, 0
  v_mfma_f32_16x16x32_bf16 v[176:179], v[84:87], v[240:243], v[176:179]
  ds_read_b64_tr_b16 v[38:39], v13 offset:1024
  v_accvgpr_write_b32 a106, 0
  v_mfma_f32_16x16x32_bf16 v[192:195], v[88:91], v[240:243], v[192:195]
  ds_read_b64_tr_b16 v[40:41], v12 offset:256
  v_accvgpr_write_b32 a107, 0
  v_mfma_f32_16x16x32_bf16 v[208:211], v[92:95], v[240:243], v[208:211]
  ds_read_b64_tr_b16 v[42:43], v12 offset:1280
  v_accvgpr_write_b32 a76, 0
  v_mfma_f32_16x16x32_bf16 v[100:103], v[64:67], v[244:247], v[100:103]
  buffer_load_dwordx4 v4, s[32:35], s26 offen offset:1024 sc1 lds
  v_accvgpr_write_b32 a77, 0
  v_mfma_f32_16x16x32_bf16 v[116:119], v[68:71], v[244:247], v[116:119]
  ds_read_b64_tr_b16 v[44:45], v13 offset:256
  v_accvgpr_write_b32 a78, 0
  v_mfma_f32_16x16x32_bf16 v[132:135], v[72:75], v[244:247], v[132:135]
  ds_read_b64_tr_b16 v[46:47], v13 offset:1280
  v_accvgpr_write_b32 a79, 0
  v_mfma_f32_16x16x32_bf16 v[148:151], v[76:79], v[244:247], v[148:151]
  ds_read_b128 v[224:227], v14 offset:0
  v_accvgpr_write_b32 a108, 0
  v_mfma_f32_16x16x32_bf16 v[164:167], v[80:83], v[244:247], v[164:167]
  ds_read_b128 v[228:231], v14 offset:1024
  v_accvgpr_write_b32 a109, 0
  v_mfma_f32_16x16x32_bf16 v[180:183], v[84:87], v[244:247], v[180:183]
  buffer_load_dwordx4 v5, s[32:35], s26 offen offset:2048 sc1 lds
  v_accvgpr_write_b32 a110, 0
  v_mfma_f32_16x16x32_bf16 v[196:199], v[88:91], v[244:247], v[196:199]
  ds_read_b64_tr_b16 v[48:49], v12 offset:512
  v_accvgpr_write_b32 a111, 0
  v_mfma_f32_16x16x32_bf16 v[212:215], v[92:95], v[244:247], v[212:215]
  ds_read_b64_tr_b16 v[50:51], v12 offset:1536
  v_accvgpr_write_b32 a80, 0
  v_mfma_f32_16x16x32_bf16 v[104:107], v[64:67], v[248:251], v[104:107]
  ds_read_b64_tr_b16 v[52:53], v13 offset:512
  v_accvgpr_write_b32 a81, 0
  v_mfma_f32_16x16x32_bf16 v[120:123], v[68:71], v[248:251], v[120:123]
  ds_read_b64_tr_b16 v[54:55], v13 offset:1536
  v_accvgpr_write_b32 a82, 0
  v_mfma_f32_16x16x32_bf16 v[136:139], v[72:75], v[248:251], v[136:139]
  buffer_load_dwordx4 v6, s[32:35], s26 offen offset:3072 sc1 lds
  v_accvgpr_write_b32 a83, 0
  v_mfma_f32_16x16x32_bf16 v[152:155], v[76:79], v[248:251], v[152:155]
  s_add_u32 s26, s26, 1024
  ds_read_b64_tr_b16 v[56:57], v12 offset:768
  v_accvgpr_write_b32 a112, 0
  v_mfma_f32_16x16x32_bf16 v[168:171], v[80:83], v[248:251], v[168:171]
  ds_read_b64_tr_b16 v[58:59], v12 offset:1792
  v_accvgpr_write_b32 a113, 0
  v_mfma_f32_16x16x32_bf16 v[184:187], v[84:87], v[248:251], v[184:187]
  ds_read_b64_tr_b16 v[60:61], v13 offset:768
  v_accvgpr_write_b32 a114, 0
  v_mfma_f32_16x16x32_bf16 v[200:203], v[88:91], v[248:251], v[200:203]
  ds_read_b64_tr_b16 v[62:63], v13 offset:1792
  v_accvgpr_write_b32 a115, 0
  v_mfma_f32_16x16x32_bf16 v[216:219], v[92:95], v[248:251], v[216:219]
  v_accvgpr_write_b32 a84, 0
  v_accvgpr_write_b32 a85, 0
  v_mfma_f32_16x16x32_bf16 v[108:111], v[64:67], v[252:255], v[108:111]
  ds_read_b128 v[232:235], v14 offset:2048
  v_accvgpr_write_b32 a86, 0
  v_mfma_f32_16x16x32_bf16 v[124:127], v[68:71], v[252:255], v[124:127]
  ds_read_b128 v[236:239], v14 offset:3072
  v_accvgpr_write_b32 a87, 0
  v_mfma_f32_16x16x32_bf16 v[140:143], v[72:75], v[252:255], v[140:143]
  v_accvgpr_write_b32 a116, 0
  v_accvgpr_write_b32 a117, 0
  v_mfma_f32_16x16x32_bf16 v[156:159], v[76:79], v[252:255], v[156:159]
  v_accvgpr_write_b32 a118, 0
  v_accvgpr_write_b32 a119, 0
  v_mfma_f32_16x16x32_bf16 v[172:175], v[80:83], v[252:255], v[172:175]
  v_accvgpr_write_b32 a88, 0
  v_accvgpr_write_b32 a89, 0
  v_mfma_f32_16x16x32_bf16 v[188:191], v[84:87], v[252:255], v[188:191]
  v_accvgpr_write_b32 a90, 0
  v_accvgpr_write_b32 a91, 0
  v_mfma_f32_16x16x32_bf16 v[204:207], v[88:91], v[252:255], v[204:207]
  v_accvgpr_write_b32 a120, 0
  v_mfma_f32_16x16x32_bf16 v[220:223], v[92:95], v[252:255], v[220:223]
  s_waitcnt vmcnt(11) lgkmcnt(0)
  v_mfma_f32_16x16x32_bf16 v[96:99], v[32:35], v[224:227], v[96:99]
  v_accvgpr_write_b32 a121, 0
  v_accvgpr_write_b32 a122, 0
  v_mfma_f32_16x16x32_bf16 v[112:115], v[36:39], v[224:227], v[112:115]
  ds_read_b64_tr_b16 v[64:65], v12 offset:8192
  v_accvgpr_write_b32 a123, 0
  v_mfma_f32_16x16x32_bf16 v[128:131], v[40:43], v[224:227], v[128:131]
  ds_read_b64_tr_b16 v[66:67], v12 offset:9216
  v_accvgpr_write_b32 a92, 0
  v_mfma_f32_16x16x32_bf16 v[144:147], v[44:47], v[224:227], v[144:147]
  v_accvgpr_write_b32 a93, 0
  v_accvgpr_write_b32 a94, 0
  v_mfma_f32_16x16x32_bf16 v[160:163], v[48:51], v[224:227], v[160:163]
  ds_read_b64_tr_b16 v[68:69], v13 offset:8192
  v_accvgpr_write_b32 a95, 0
  v_mfma_f32_16x16x32_bf16 v[176:179], v[52:55], v[224:227], v[176:179]
  ds_read_b64_tr_b16 v[70:71], v13 offset:9216
  v_accvgpr_write_b32 a124, 0
  v_mfma_f32_16x16x32_bf16 v[192:195], v[56:59], v[224:227], v[192:195]
  ds_read_b64_tr_b16 v[72:73], v12 offset:8448
  v_accvgpr_write_b32 a125, 0
  v_mfma_f32_16x16x32_bf16 v[208:211], v[60:63], v[224:227], v[208:211]
  ds_read_b64_tr_b16 v[74:75], v12 offset:9472
  v_accvgpr_write_b32 a126, 0
  v_mfma_f32_16x16x32_bf16 v[100:103], v[32:35], v[228:231], v[100:103]
  v_accvgpr_write_b32 a127, 0
  v_mfma_f32_16x16x32_bf16 v[116:119], v[36:39], v[228:231], v[116:119]
  ds_read_b64_tr_b16 v[76:77], v13 offset:8448
  v_mfma_f32_16x16x32_bf16 v[132:135], v[40:43], v[228:231], v[132:135]
  ds_read_b64_tr_b16 v[78:79], v13 offset:9472
  v_mfma_f32_16x16x32_bf16 v[148:151], v[44:47], v[228:231], v[148:151]
  ds_read_b128 v[240:243], v14 offset:32768
  v_mfma_f32_16x16x32_bf16 v[164:167], v[48:51], v[228:231], v[164:167]
  ds_read_b128 v[244:247], v14 offset:33792
  v_mfma_f32_16x16x32_bf16 v[180:183], v[52:55], v[228:231], v[180:183]
  v_mfma_f32_16x16x32_bf16 v[196:199], v[56:59], v[228:231], v[196:199]
  ds_read_b64_tr_b16 v[80:81], v12 offset:8704
  v_mfma_f32_16x16x32_bf16 v[212:215], v[60:63], v[228:231], v[212:215]
  ds_read_b64_tr_b16 v[82:83], v12 offset:9728
  v_mfma_f32_16x16x32_bf16 v[104:107], v[32:35], v[232:235], v[104:107]
  ds_read_b64_tr_b16 v[84:85], v13 offset:8704
  v_mfma_f32_16x16x32_bf16 v[120:123], v[36:39], v[232:235], v[120:123]
  ds_read_b64_tr_b16 v[86:87], v13 offset:9728
  v_mfma_f32_16x16x32_bf16 v[136:139], v[40:43], v[232:235], v[136:139]
  v_mfma_f32_16x16x32_bf16 v[152:155], v[44:47], v[232:235], v[152:155]
  ds_read_b64_tr_b16 v[88:89], v12 offset:8960
  v_mfma_f32_16x16x32_bf16 v[168:171], v[48:51], v[232:235], v[168:171]
  ds_read_b64_tr_b16 v[90:91], v12 offset:9984
  v_mfma_f32_16x16x32_bf16 v[184:187], v[52:55], v[232:235], v[184:187]
  ds_read_b64_tr_b16 v[92:93], v13 offset:8960
  v_mfma_f32_16x16x32_bf16 v[200:203], v[56:59], v[232:235], v[200:203]
  ds_read_b64_tr_b16 v[94:95], v13 offset:9984
  v_mfma_f32_16x16x32_bf16 v[216:219], v[60:63], v[232:235], v[216:219]
  v_mfma_f32_16x16x32_bf16 v[108:111], v[32:35], v[236:239], v[108:111]
  ds_read_b128 v[248:251], v14 offset:34816
  v_mfma_f32_16x16x32_bf16 v[124:127], v[36:39], v[236:239], v[124:127]
  ds_read_b128 v[252:255], v14 offset:35840
  v_mfma_f32_16x16x32_bf16 v[140:143], v[40:43], v[236:239], v[140:143]
  v_mfma_f32_16x16x32_bf16 v[156:159], v[44:47], v[236:239], v[156:159]
  v_xor_b32 v14, 0x10000, v14
  v_mfma_f32_16x16x32_bf16 v[172:175], v[48:51], v[236:239], v[172:175]
  v_mfma_f32_16x16x32_bf16 v[188:191], v[52:55], v[236:239], v[188:191]
  v_mfma_f32_16x16x32_bf16 v[204:207], v[56:59], v[236:239], v[204:207]
  v_mfma_f32_16x16x32_bf16 v[220:223], v[60:63], v[236:239], v[220:223]
  s_waitcnt vmcnt(4) lgkmcnt(0)
  v_mfma_f32_16x16x32_bf16 v[96:99], v[64:67], v[240:243], v[96:99]
  s_barrier
  buffer_store_dword v10, v9, s[40:43], 0 offen sc1
  v_mfma_f32_16x16x32_bf16 v[112:115], v[68:71], v[240:243], v[112:115]
  ds_read_b64_tr_b16 v[32:33], v12 offset:32768
  v_mfma_f32_16x16x32_bf16 v[128:131], v[72:75], v[240:243], v[128:131]
  ds_read_b64_tr_b16 v[34:35], v12 offset:33792
  v_mfma_f32_16x16x32_bf16 v[144:147], v[76:79], v[240:243], v[144:147]
  v_mfma_f32_16x16x32_bf16 v[160:163], v[80:83], v[240:243], v[160:163]
  ds_read_b64_tr_b16 v[36:37], v13 offset:32768
  v_mfma_f32_16x16x32_bf16 v[176:179], v[84:87], v[240:243], v[176:179]
  ds_read_b64_tr_b16 v[38:39], v13 offset:33792
  v_mfma_f32_16x16x32_bf16 v[192:195], v[88:91], v[240:243], v[192:195]
  ds_read_b64_tr_b16 v[40:41], v12 offset:33024
  v_mfma_f32_16x16x32_bf16 v[208:211], v[92:95], v[240:243], v[208:211]
  ds_read_b64_tr_b16 v[42:43], v12 offset:34048
  v_mfma_f32_16x16x32_bf16 v[100:103], v[64:67], v[244:247], v[100:103]
  v_mfma_f32_16x16x32_bf16 v[116:119], v[68:71], v[244:247], v[116:119]
  ds_read_b64_tr_b16 v[44:45], v13 offset:33024
  v_mfma_f32_16x16x32_bf16 v[132:135], v[72:75], v[244:247], v[132:135]
  ds_read_b64_tr_b16 v[46:47], v13 offset:34048
  v_mfma_f32_16x16x32_bf16 v[148:151], v[76:79], v[244:247], v[148:151]
  ds_read_b128 v[224:227], v14 offset:0
  v_mfma_f32_16x16x32_bf16 v[164:167], v[80:83], v[244:247], v[164:167]
  ds_read_b128 v[228:231], v14 offset:1024
  v_mfma_f32_16x16x32_bf16 v[180:183], v[84:87], v[244:247], v[180:183]
  v_mfma_f32_16x16x32_bf16 v[196:199], v[88:91], v[244:247], v[196:199]
  ds_read_b64_tr_b16 v[48:49], v12 offset:33280
  v_mfma_f32_16x16x32_bf16 v[212:215], v[92:95], v[244:247], v[212:215]
  ds_read_b64_tr_b16 v[50:51], v12 offset:34304
  v_mfma_f32_16x16x32_bf16 v[104:107], v[64:67], v[248:251], v[104:107]
  ds_read_b64_tr_b16 v[52:53], v13 offset:33280
  v_mfma_f32_16x16x32_bf16 v[120:123], v[68:71], v[248:251], v[120:123]
  ds_read_b64_tr_b16 v[54:55], v13 offset:34304
  v_mfma_f32_16x16x32_bf16 v[136:139], v[72:75], v[248:251], v[136:139]
  v_mfma_f32_16x16x32_bf16 v[152:155], v[76:79], v[248:251], v[152:155]
  ds_read_b64_tr_b16 v[56:57], v12 offset:33536
  v_mfma_f32_16x16x32_bf16 v[168:171], v[80:83], v[248:251], v[168:171]
  ds_read_b64_tr_b16 v[58:59], v12 offset:34560
  v_mfma_f32_16x16x32_bf16 v[184:187], v[84:87], v[248:251], v[184:187]
  ds_read_b64_tr_b16 v[60:61], v13 offset:33536
  v_mfma_f32_16x16x32_bf16 v[200:203], v[88:91], v[248:251], v[200:203]
  ds_read_b64_tr_b16 v[62:63], v13 offset:34560
  v_mfma_f32_16x16x32_bf16 v[216:219], v[92:95], v[248:251], v[216:219]
  v_mfma_f32_16x16x32_bf16 v[108:111], v[64:67], v[252:255], v[108:111]
  ds_read_b128 v[232:235], v14 offset:2048
  v_mfma_f32_16x16x32_bf16 v[124:127], v[68:71], v[252:255], v[124:127]
  ds_read_b128 v[236:239], v14 offset:3072
  v_mfma_f32_16x16x32_bf16 v[140:143], v[72:75], v[252:255], v[140:143]
  v_mfma_f32_16x16x32_bf16 v[156:159], v[76:79], v[252:255], v[156:159]
  v_mfma_f32_16x16x32_bf16 v[172:175], v[80:83], v[252:255], v[172:175]
  v_mfma_f32_16x16x32_bf16 v[188:191], v[84:87], v[252:255], v[188:191]
  v_mfma_f32_16x16x32_bf16 v[204:207], v[88:91], v[252:255], v[204:207]
  v_mfma_f32_16x16x32_bf16 v[220:223], v[92:95], v[252:255], v[220:223]
  s_waitcnt vmcnt(1) lgkmcnt(0)
  v_mfma_f32_16x16x32_bf16 v[96:99], v[32:35], v[224:227], v[96:99]
  v_mfma_f32_16x16x32_bf16 v[112:115], v[36:39], v[224:227], v[112:115]
  ds_read_b64_tr_b16 v[64:65], v12 offset:40960
  v_mfma_f32_16x16x32_bf16 v[128:131], v[40:43], v[224:227], v[128:131]
  ds_read_b64_tr_b16 v[66:67], v12 offset:41984
  v_mfma_f32_16x16x32_bf16 v[144:147], v[44:47], v[224:227], v[144:147]
  buffer_load_dword v15, v8, s[40:43], 0 offen sc1
  v_mfma_f32_16x16x32_bf16 v[160:163], v[48:51], v[224:227], v[160:163]
  ds_read_b64_tr_b16 v[68:69], v13 offset:40960
  v_mfma_f32_16x16x32_bf16 v[176:179], v[52:55], v[224:227], v[176:179]
  ds_read_b64_tr_b16 v[70:71], v13 offset:41984
  v_mfma_f32_16x16x32_bf16 v[192:195], v[56:59], v[224:227], v[192:195]
  ds_read_b64_tr_b16 v[72:73], v12 offset:41216
  v_mfma_f32_16x16x32_bf16 v[208:211], v[60:63], v[224:227], v[208:211]
  ds_read_b64_tr_b16 v[74:75], v12 offset:42240
  v_mfma_f32_16x16x32_bf16 v[100:103], v[32:35], v[228:231], v[100:103]
  v_mfma_f32_16x16x32_bf16 v[116:119], v[36:39], v[228:231], v[116:119]
  ds_read_b64_tr_b16 v[76:77], v13 offset:41216
  v_mfma_f32_16x16x32_bf16 v[132:135], v[40:43], v[228:231], v[132:135]
  ds_read_b64_tr_b16 v[78:79], v13 offset:42240
  v_mfma_f32_16x16x32_bf16 v[148:151], v[44:47], v[228:231], v[148:151]
  ds_read_b128 v[240:243], v14 offset:32768
  v_mfma_f32_16x16x32_bf16 v[164:167], v[48:51], v[228:231], v[164:167]
  ds_read_b128 v[244:247], v14 offset:33792
  v_mfma_f32_16x16x32_bf16 v[180:183], v[52:55], v[228:231], v[180:183]
  v_mfma_f32_16x16x32_bf16 v[196:199], v[56:59], v[228:231], v[196:199]
  ds_read_b64_tr_b16 v[80:81], v12 offset:41472
  v_mfma_f32_16x16x32_bf16 v[212:215], v[60:63], v[228:231], v[212:215]
  ds_read_b64_tr_b16 v[82:83], v12 offset:42496
  v_mfma_f32_16x16x32_bf16 v[104:107], v[32:35], v[232:235], v[104:107]
  ds_read_b64_tr_b16 v[84:85], v13 offset:41472
  v_mfma_f32_16x16x32_bf16 v[120:123], v[36:39], v[232:235], v[120:123]
  ds_read_b64_tr_b16 v[86:87], v13 offset:42496
  v_mfma_f32_16x16x32_bf16 v[136:139], v[40:43], v[232:235], v[136:139]
  v_mfma_f32_16x16x32_bf16 v[152:155], v[44:47], v[232:235], v[152:155]
  ds_read_b64_tr_b16 v[88:89], v12 offset:41728
  v_mfma_f32_16x16x32_bf16 v[168:171], v[48:51], v[232:235], v[168:171]
  ds_read_b64_tr_b16 v[90:91], v12 offset:42752
  v_mfma_f32_16x16x32_bf16 v[184:187], v[52:55], v[232:235], v[184:187]
  ds_read_b64_tr_b16 v[92:93], v13 offset:41728
  v_mfma_f32_16x16x32_bf16 v[200:203], v[56:59], v[232:235], v[200:203]
  ds_read_b64_tr_b16 v[94:95], v13 offset:42752
  v_mfma_f32_16x16x32_bf16 v[216:219], v[60:63], v[232:235], v[216:219]
  v_mfma_f32_16x16x32_bf16 v[108:111], v[32:35], v[236:239], v[108:111]
  ds_read_b128 v[248:251], v14 offset:34816
  v_mfma_f32_16x16x32_bf16 v[124:127], v[36:39], v[236:239], v[124:127]
  ds_read_b128 v[252:255], v14 offset:35840
  v_mfma_f32_16x16x32_bf16 v[140:143], v[40:43], v[236:239], v[140:143]
  v_mfma_f32_16x16x32_bf16 v[156:159], v[44:47], v[236:239], v[156:159]
  v_xor_b32 v14, 0x10000, v14
  v_mfma_f32_16x16x32_bf16 v[172:175], v[48:51], v[236:239], v[172:175]
  v_mfma_f32_16x16x32_bf16 v[188:191], v[52:55], v[236:239], v[188:191]
  v_xor_b32 v12, 0x10000, v12
  v_mfma_f32_16x16x32_bf16 v[204:207], v[56:59], v[236:239], v[204:207]
  v_xor_b32 v13, 0x10000, v13
  v_mfma_f32_16x16x32_bf16 v[220:223], v[60:63], v[236:239], v[220:223]
  s_waitcnt lgkmcnt(0)
  v_mfma_f32_16x16x32_bf16 v[96:99], v[64:67], v[240:243], v[96:99]
  s_barrier
  v_mfma_f32_16x16x32_bf16 v[112:115], v[68:71], v[240:243], v[112:115]
  v_mfma_f32_16x16x32_bf16 v[128:131], v[72:75], v[240:243], v[128:131]
  v_mfma_f32_16x16x32_bf16 v[144:147], v[76:79], v[240:243], v[144:147]
  v_mfma_f32_16x16x32_bf16 v[160:163], v[80:83], v[240:243], v[160:163]
  v_mfma_f32_16x16x32_bf16 v[176:179], v[84:87], v[240:243], v[176:179]
  v_mfma_f32_16x16x32_bf16 v[192:195], v[88:91], v[240:243], v[192:195]
  v_mfma_f32_16x16x32_bf16 v[208:211], v[92:95], v[240:243], v[208:211]
  v_mfma_f32_16x16x32_bf16 v[100:103], v[64:67], v[244:247], v[100:103]
  v_mfma_f32_16x16x32_bf16 v[116:119], v[68:71], v[244:247], v[116:119]
  v_mfma_f32_16x16x32_bf16 v[132:135], v[72:75], v[244:247], v[132:135]
  v_mfma_f32_16x16x32_bf16 v[148:151], v[76:79], v[244:247], v[148:151]
  v_mfma_f32_16x16x32_bf16 v[164:167], v[80:83], v[244:247], v[164:167]
  v_mfma_f32_16x16x32_bf16 v[180:183], v[84:87], v[244:247], v[180:183]
  v_mfma_f32_16x16x32_bf16 v[196:199], v[88:91], v[244:247], v[196:199]
  v_mfma_f32_16x16x32_bf16 v[212:215], v[92:95], v[244:247], v[212:215]
  v_mfma_f32_16x16x32_bf16 v[104:107], v[64:67], v[248:251], v[104:107]
  v_mfma_f32_16x16x32_bf16 v[120:123], v[68:71], v[248:251], v[120:123]
  v_mfma_f32_16x16x32_bf16 v[136:139], v[72:75], v[248:251], v[136:139]
  v_mfma_f32_16x16x32_bf16 v[152:155], v[76:79], v[248:251], v[152:155]
  v_mfma_f32_16x16x32_bf16 v[168:171], v[80:83], v[248:251], v[168:171]
  v_mfma_f32_16x16x32_bf16 v[184:187], v[84:87], v[248:251], v[184:187]
  v_mfma_f32_16x16x32_bf16 v[200:203], v[88:91], v[248:251], v[200:203]
  v_mfma_f32_16x16x32_bf16 v[216:219], v[92:95], v[248:251], v[216:219]
  v_mfma_f32_16x16x32_bf16 v[108:111], v[64:67], v[252:255], v[108:111]
  v_mfma_f32_16x16x32_bf16 v[124:127], v[68:71], v[252:255], v[124:127]
  v_mfma_f32_16x16x32_bf16 v[140:143], v[72:75], v[252:255], v[140:143]
  v_mfma_f32_16x16x32_bf16 v[156:159], v[76:79], v[252:255], v[156:159]
  v_mfma_f32_16x16x32_bf16 v[172:175], v[80:83], v[252:255], v[172:175]
  v_mfma_f32_16x16x32_bf16 v[188:191], v[84:87], v[252:255], v[188:191]
  v_mfma_f32_16x16x32_bf16 v[204:207], v[88:91], v[252:255], v[204:207]
  v_mfma_f32_16x16x32_bf16 v[220:223], v[92:95], v[252:255], v[220:223]
  s_and_b32 s23, s20, 1
  s_lshl_b32 s23, s23, 12
  s_cmp_lt_u32 s20, 2
  s_cselect_b32 s24, 106496, 0
  s_add_u32 s24, s24, s23
  s_lshl_b32 s26, s20, 12
  s_mov_b32 s27, s26
  s_add_u32 s25, s27, 49152
  s_load_dwordx4 s[4:7], s[0:1], 64
  s_load_dwordx2 s[8:9], s[0:1], 80
  v_mov_b32 v12, 0x3e0293ee
  v_mov_b32 v13, 0x3e0293ee
  s_waitcnt vmcnt(0)
  v_cmp_eq_u32 vcc, 0, v15
  s_cbranch_vccnz fa_kv_spin
fa_kv_ok:
  s_mov_b32 m0, s24
  s_nop 0
  buffer_load_dwordx4 v2, s[44:47], s26 offen offset:0 sc1 lds
  v_pk_mul_f32 v[96:97], v[96:97], v[12:13]
  v_pk_mul_f32 v[98:99], v[98:99], v[12:13]
  v_cvt_pk_bf16_f32 v32, v96, v97
  v_cvt_pk_bf16_f32 v33, v98, v99
  v_pk_mul_f32 v[112:113], v[112:113], v[12:13]
  v_pk_mul_f32 v[114:115], v[114:115], v[12:13]
  v_cvt_pk_bf16_f32 v34, v112, v113
  buffer_load_dwordx4 v2, s[44:47], s26 offen offset:1024 sc1 lds
  v_cvt_pk_bf16_f32 v35, v114, v115
  v_pk_mul_f32 v[100:101], v[100:101], v[12:13]
  v_pk_mul_f32 v[102:103], v[102:103], v[12:13]
  v_cvt_pk_bf16_f32 v36, v100, v101
  v_cvt_pk_bf16_f32 v37, v102, v103
  v_pk_mul_f32 v[116:117], v[116:117], v[12:13]
  v_pk_mul_f32 v[118:119], v[118:119], v[12:13]
  buffer_load_dwordx4 v2, s[44:47], s26 offen offset:2048 sc1 lds
  v_cvt_pk_bf16_f32 v38, v116, v117
  v_cvt_pk_bf16_f32 v39, v118, v119
  v_pk_mul_f32 v[128:129], v[128:129], v[12:13]
  v_pk_mul_f32 v[130:131], v[130:131], v[12:13]
  v_cvt_pk_bf16_f32 v40, v128, v129
  v_cvt_pk_bf16_f32 v41, v130, v131
  v_pk_mul_f32 v[144:145], v[144:145], v[12:13]
  buffer_load_dwordx4 v2, s[44:47], s26 offen offset:3072 sc1 lds
  v_pk_mul_f32 v[146:147], v[146:147], v[12:13]
  v_cvt_pk_bf16_f32 v42, v144, v145
  v_cvt_pk_bf16_f32 v43, v146, v147
  v_pk_mul_f32 v[132:133], v[132:133], v[12:13]
  v_pk_mul_f32 v[134:135], v[134:135], v[12:13]
  v_cvt_pk_bf16_f32 v44, v132, v133
  v_cvt_pk_bf16_f32 v45, v134, v135
  s_add_u32 s26, s26, 16384
  s_add_u32 s24, s24, 32768
  s_and_b32 s24, s24, 0x1ffff
  s_mov_b32 m0, s24
  s_nop 0
  buffer_load_dwordx4 v2, s[44:47], s26 offen offset:0 sc1 lds
  v_pk_mul_f32 v[148:149], v[148:149], v[12:13]
  v_pk_mul_f32 v[150:151], v[150:151], v[12:13]
  v_cvt_pk_bf16_f32 v46, v148, v149
  v_cvt_pk_bf16_f32 v47, v150, v151
  v_pk_mul_f32 v[160:161], v[160:161], v[12:13]
  v_pk_mul_f32 v[162:163], v[162:163], v[12:13]
  v_cvt_pk_bf16_f32 v48, v160, v161
  buffer_load_dwordx4 v2, s[44:47], s26 offen offset:1024 sc1 lds
  v_cvt_pk_bf16_f32 v49, v162, v163
  v_pk_mul_f32 v[176:177], v[176:177], v[12:13]
  v_pk_mul_f32 v[178:179], v[178:179], v[12:13]
  v_cvt_pk_bf16_f32 v50, v176, v177
  v_cvt_pk_bf16_f32 v51, v178, v179
  v_pk_mul_f32 v[164:165], v[164:165], v[12:13]
  v_pk_mul_f32 v[166:167], v[166:167], v[12:13]
  buffer_load_dwordx4 v2, s[44:47], s26 offen offset:2048 sc1 lds
  v_cvt_pk_bf16_f32 v52, v164, v165
  v_cvt_pk_bf16_f32 v53, v166, v167
  v_pk_mul_f32 v[180:181], v[180:181], v[12:13]
  v_pk_mul_f32 v[182:183], v[182:183], v[12:13]
  v_cvt_pk_bf16_f32 v54, v180, v181
  v_cvt_pk_bf16_f32 v55, v182, v183
  v_pk_mul_f32 v[192:193], v[192:193], v[12:13]
  buffer_load_dwordx4 v2, s[44:47], s26 offen offset:3072 sc1 lds
  v_pk_mul_f32 v[194:195], v[194:195], v[12:13]
  v_cvt_pk_bf16_f32 v56, v192, v193
  v_cvt_pk_bf16_f32 v57, v194, v195
  v_pk_mul_f32 v[208:209], v[208:209], v[12:13]
  v_pk_mul_f32 v[210:211], v[210:211], v[12:13]
  v_cvt_pk_bf16_f32 v58, v208, v209
  v_cvt_pk_bf16_f32 v59, v210, v211
  s_add_u32 s26, s26, 16384
  s_add_u32 s24, s24, 32768
  s_and_b32 s24, s24, 0x1ffff
  s_mov_b32 m0, s24
  s_nop 0
  buffer_load_dwordx4 v2, s[44:47], s26 offen offset:0 sc1 lds
  v_pk_mul_f32 v[196:197], v[196:197], v[12:13]
  v_pk_mul_f32 v[198:199], v[198:199], v[12:13]
  v_cvt_pk_bf16_f32 v60, v196, v197
  v_cvt_pk_bf16_f32 v61, v198, v199
  v_pk_mul_f32 v[212:213], v[212:213], v[12:13]
  v_pk_mul_f32 v[214:215], v[214:215], v[12:13]
  v_cvt_pk_bf16_f32 v62, v212, v213
  buffer_load_dwordx4 v2, s[44:47], s26 offen offset:1024 sc1 lds
  v_cvt_pk_bf16_f32 v63, v214, v215
  v_pk_mul_f32 v[104:105], v[104:105], v[12:13]
  v_pk_mul_f32 v[106:107], v[106:107], v[12:13]
  v_cvt_pk_bf16_f32 v64, v104, v105
  v_cvt_pk_bf16_f32 v65, v106, v107
  v_pk_mul_f32 v[120:121], v[120:121], v[12:13]
  v_pk_mul_f32 v[122:123], v[122:123], v[12:13]
  buffer_load_dwordx4 v2, s[44:47], s26 offen offset:2048 sc1 lds
  v_cvt_pk_bf16_f32 v66, v120, v121
  v_cvt_pk_bf16_f32 v67, v122, v123
  v_pk_mul_f32 v[108:109], v[108:109], v[12:13]
  v_pk_mul_f32 v[110:111], v[110:111], v[12:13]
  v_cvt_pk_bf16_f32 v68, v108, v109
  v_cvt_pk_bf16_f32 v69, v110, v111
  v_pk_mul_f32 v[124:125], v[124:125], v[12:13]
  buffer_load_dwordx4 v2, s[44:47], s26 offen offset:3072 sc1 lds
  v_pk_mul_f32 v[126:127], v[126:127], v[12:13]
  v_cvt_pk_bf16_f32 v70, v124, v125
  v_cvt_pk_bf16_f32 v71, v126, v127
  v_pk_mul_f32 v[136:137], v[136:137], v[12:13]
  v_pk_mul_f32 v[138:139], v[138:139], v[12:13]
  v_cvt_pk_bf16_f32 v72, v136, v137
  v_cvt_pk_bf16_f32 v73, v138, v139
  s_add_u32 s26, s26, 16384
  s_add_u32 s24, s24, 32768
  s_and_b32 s24, s24, 0x1ffff
  s_mov_b32 m0, s25
  s_nop 0
  buffer_load_dwordx4 v2, s[48:51], s27 offen offset:0 sc1 lds
  v_pk_mul_f32 v[152:153], v[152:153], v[12:13]
  v_pk_mul_f32 v[154:155], v[154:155], v[12:13]
  v_cvt_pk_bf16_f32 v74, v152, v153
  v_cvt_pk_bf16_f32 v75, v154, v155
  v_pk_mul_f32 v[140:141], v[140:141], v[12:13]
  v_pk_mul_f32 v[142:143], v[142:143], v[12:13]
  v_cvt_pk_bf16_f32 v76, v140, v141
  buffer_load_dwordx4 v2, s[48:51], s27 offen offset:1024 sc1 lds
  v_cvt_pk_bf16_f32 v77, v142, v143
  v_pk_mul_f32 v[156:157], v[156:157], v[12:13]
  v_pk_mul_f32 v[158:159], v[158:159], v[12:13]
  v_cvt_pk_bf16_f32 v78, v156, v157
  v_cvt_pk_bf16_f32 v79, v158, v159
  v_pk_mul_f32 v[168:169], v[168:169], v[12:13]
  v_pk_mul_f32 v[170:171], v[170:171], v[12:13]
  buffer_load_dwordx4 v2, s[48:51], s27 offen offset:2048 sc1 lds
  v_cvt_pk_bf16_f32 v80, v168, v169
  v_cvt_pk_bf16_f32 v81, v170, v171
  v_pk_mul_f32 v[184:185], v[184:185], v[12:13]
  v_pk_mul_f32 v[186:187], v[186:187], v[12:13]
  v_cvt_pk_bf16_f32 v82, v184, v185
  v_cvt_pk_bf16_f32 v83, v186, v187
  v_pk_mul_f32 v[172:173], v[172:173], v[12:13]
  buffer_load_dwordx4 v2, s[48:51], s27 offen offset:3072 sc1 lds
  v_pk_mul_f32 v[174:175], v[174:175], v[12:13]
  v_cvt_pk_bf16_f32 v84, v172, v173
  v_cvt_pk_bf16_f32 v85, v174, v175
  v_pk_mul_f32 v[188:189], v[188:189], v[12:13]
  v_pk_mul_f32 v[190:191], v[190:191], v[12:13]
  v_cvt_pk_bf16_f32 v86, v188, v189
  v_cvt_pk_bf16_f32 v87, v190, v191
  s_add_u32 s27, s27, 16384
  s_add_u32 s25, s25, 32768
  s_and_b32 s25, s25, 0x1ffff
  s_mov_b32 m0, s25
  s_nop 0
  buffer_load_dwordx4 v2, s[48:51], s27 offen offset:0 sc1 lds
  v_pk_mul_f32 v[200:201], v[200:201], v[12:13]
  v_pk_mul_f32 v[202:203], v[202:203], v[12:13]
  v_cvt_pk_bf16_f32 v88, v200, v201
  v_cvt_pk_bf16_f32 v89, v202, v203
  v_pk_mul_f32 v[216:217], v[216:217], v[12:13]
  v_pk_mul_f32 v[218:219], v[218:219], v[12:13]
  v_cvt_pk_bf16_f32 v90, v216, v217
  buffer_load_dwordx4 v2, s[48:51], s27 offen offset:1024 sc1 lds
  v_cvt_pk_bf16_f32 v91, v218, v219
  v_pk_mul_f32 v[204:205], v[204:205], v[12:13]
  v_pk_mul_f32 v[206:207], v[206:207], v[12:13]
  v_cvt_pk_bf16_f32 v92, v204, v205
  v_cvt_pk_bf16_f32 v93, v206, v207
  v_pk_mul_f32 v[220:221], v[220:221], v[12:13]
  v_pk_mul_f32 v[222:223], v[222:223], v[12:13]
  buffer_load_dwordx4 v2, s[48:51], s27 offen offset:2048 sc1 lds
  v_cvt_pk_bf16_f32 v94, v220, v221
  v_cvt_pk_bf16_f32 v95, v222, v223
  buffer_load_dwordx4 v2, s[48:51], s27 offen offset:3072 sc1 lds
  s_add_u32 s27, s27, 16384
  s_add_u32 s25, s25, 32768
  s_and_b32 s25, s25, 0x1ffff
  v_add_u32 v18, 106496, v2
  s_waitcnt vmcnt(12)
  s_barrier
  ds_read_b128 a[128:131], v18 offset:0
  ds_read_b128 a[132:135], v18 offset:1024
  ds_read_b128 a[136:139], v18 offset:2048
  ds_read_b128 a[140:143], v18 offset:3072
  ds_read_b128 a[144:147], v18 offset:4096
  ds_read_b128 a[148:151], v18 offset:5120
  ds_read_b128 a[152:155], v18 offset:6144
  ds_read_b128 a[156:159], v18 offset:7168
  s_and_b32 s62, s2, 1
  s_lshl_b32 s62, s62, 2
  s_add_u32 s62, s62, s20
  s_lshr_b32 s63, s2, 1
  s_mul_i32 s23, s63, 40960
  s_mul_i32 s31, s62, 160
  s_add_u32 s23, s23, s31
  s_mul_i32 s34, s20, 5120
  s_add_u32 s34, s34, 131072
  v_add_u32 v20, 0, v1
  v_mul_u32_u24 v19, 6554, v20
  s_add_u32 m0, s34, 0
  v_lshrrev_b32 v19, 16, v19
  v_mul_u32_u24 v19, 1120, v19
  v_lshl_add_u32 v19, v20, 4, v19
  buffer_load_dwordx4 v19, s[52:55], s23 offen lds
  v_accvgpr_write_b32 a248, v19
  v_add_u32 v20, 64, v1
  v_mul_u32_u24 v19, 6554, v20
  s_add_u32 m0, s34, 1024
  v_lshrrev_b32 v19, 16, v19
  v_mul_u32_u24 v19, 1120, v19
  v_lshl_add_u32 v19, v20, 4, v19
  buffer_load_dwordx4 v19, s[52:55], s23 offen lds
  v_accvgpr_write_b32 a249, v19
  v_add_u32 v20, 128, v1
  v_mul_u32_u24 v19, 6554, v20
  s_add_u32 m0, s34, 2048
  v_lshrrev_b32 v19, 16, v19
  v_mul_u32_u24 v19, 1120, v19
  v_lshl_add_u32 v19, v20, 4, v19
  buffer_load_dwordx4 v19, s[52:55], s23 offen lds
  v_accvgpr_write_b32 a250, v19
  v_add_u32 v20, 192, v1
  v_mul_u32_u24 v19, 6554, v20
  s_add_u32 m0, s34, 3072
  v_lshrrev_b32 v19, 16, v19
  v_mul_u32_u24 v19, 1120, v19
  v_lshl_add_u32 v19, v20, 4, v19
  buffer_load_dwordx4 v19, s[52:55], s23 offen lds
  v_accvgpr_write_b32 a251, v19
  v_add_u32 v20, 256, v1
  v_mul_u32_u24 v19, 6554, v20
  s_add_u32 m0, s34, 4096
  v_lshrrev_b32 v19, 16, v19
  v_mul_u32_u24 v19, 1120, v19
  v_lshl_add_u32 v19, v20, 4, v19
  buffer_load_dwordx4 v19, s[52:55], s23 offen lds
  v_accvgpr_write_b32 a252, v19
  v_lshrrev_b32 v6, 2, v1
  v_mul_u32_u24 v6, 160, v6
  v_and_b32 v19, 3, v1
  v_lshl_add_u32 v6, v19, 3, v6
  v_add_u32 v6, s34, v6
  s_lshl_b32 s30, s62, 7
  s_add_u32 s30, s30, s63
  s_mul_i32 s30, s30, 5120
  s_add_u32 s30, s30, 4194304
  s_waitcnt lgkmcnt(0)
  s_cmp_ge_u32 s20, 2
  s_cselect_b32 s4, s6, s4
  s_cselect_b32 s5, s7, s5
  s_mov_b32 s52, s4
  s_mov_b32 s53, s5
  s_mov_b32 s54, 2211840
  s_mov_b32 s55, 0x20000
  s_mov_b32 s60, s8
  s_mov_b32 s61, s9
  s_mov_b32 s62, 2211840
  s_mov_b32 s63, 0x20000
  v_mov_b32 v228, 0
  v_mov_b32 v229, 0
  v_mov_b32 v230, 0
  v_mov_b32 v231, 0
  s_add_u32 s23, s20, 1
  s_lshr_b32 s23, s23, 1
  s_lshl_b32 s28, s22, 1
  s_add_u32 s28, s28, s23
  s_lshl_b32 s23, s22, 2
  s_sub_u32 s29, 28, s23
  s_and_b32 s23, s20, 1
  s_add_u32 s29, s29, s23
  v_mov_b32 v3, v2
  v_mov_b32 v4, 0xff800000
  s_cmp_eq_u32 s2, 255
  s_cbranch_scc1 fa_top8
fa_notop:
  s_mov_b32 s32, 0
  s_mov_b32 s9, 0
  s_mov_b32 s8, 0
  s_mov_b32 s11, 0
  s_mov_b32 s12, 0
  s_lshl_b32 s15, s22, 1
  s_add_u32 s23, s15, 6
  s_sub_u32 s15, 24, s15
  s_max_u32 s15, s15, s23
  s_lshl_b32 s15, s15, 14
  s_getpc_b64 s[36:37]
fa_copc:
  s_add_u32 s36, s36, fa_co-fa_copc-4
  s_addc_u32 s37, s37, 0
  s_waitcnt lgkmcnt(0)
  v_mfma_f32_16x16x32_bf16 v[96:99], a[128:131], v[32:35], 0
  v_mfma_f32_16x16x32_bf16 v[104:107], a[128:131], v[36:39], 0
  v_mfma_f32_16x16x32_bf16 v[128:131], a[128:131], v[64:67], 0
  v_mfma_f32_16x16x32_bf16 v[136:139], a[128:131], v[68:71], 0
  s_mov_b32 m0, s24
  ds_read_b128 a[128:131], v3 offset:0
  v_mfma_f32_16x16x32_bf16 v[100:103], a[132:135], v[32:35], 0
  buffer_load_dwordx4 v2, s[44:47], s26 offen offset:0 sc1 lds
  v_mfma_f32_16x16x32_bf16 v[108:111], a[132:135], v[36:39], 0
  v_mfma_f32_16x16x32_bf16 v[132:135], a[132:135], v[64:67], 0
  v_mfma_f32_16x16x32_bf16 v[140:143], a[132:135], v[68:71], 0
  ds_read_b128 a[132:135], v3 offset:1024
  v_mfma_f32_16x16x32_bf16 v[96:99], a[136:139], v[40:43], v[96:99]
  v_mfma_f32_16x16x32_bf16 v[104:107], a[136:139], v[44:47], v[104:107]
  v_mfma_f32_16x16x32_bf16 v[128:131], a[136:139], v[72:75], v[128:131]
  buffer_load_dwordx4 v2, s[44:47], s26 offen offset:1024 sc1 lds
  v_mfma_f32_16x16x32_bf16 v[136:139], a[136:139], v[76:79], v[136:139]
  ds_read_b128 a[136:139], v3 offset:2048
  v_mfma_f32_16x16x32_bf16 v[100:103], a[140:143], v[40:43], v[100:103]
  v_mfma_f32_16x16x32_bf16 v[108:111], a[140:143], v[44:47], v[108:111]
  v_mfma_f32_16x16x32_bf16 v[132:135], a[140:143], v[72:75], v[132:135]
  v_mfma_f32_16x16x32_bf16 v[140:143], a[140:143], v[76:79], v[140:143]
  s_waitcnt lgkmcnt(3)
  ds_read_b128 a[140:143], v3 offset:3072
  v_mfma_f32_16x16x32_bf16 v[96:99], a[144:147], v[48:51], v[96:99]
  v_mfma_f32_16x16x32_bf16 v[104:107], a[144:147], v[52:55], v[104:107]
  v_mfma_f32_16x16x32_bf16 v[128:131], a[144:147], v[80:83], v[128:131]
  buffer_load_dwordx4 v2, s[44:47], s26 offen offset:2048 sc1 lds
  v_mfma_f32_16x16x32_bf16 v[136:139], a[144:147], v[84:87], v[136:139]
  ds_read_b128 a[144:147], v3 offset:4096
  v_mfma_f32_16x16x32_bf16 v[100:103], a[148:151], v[48:51], v[100:103]
  v_mfma_f32_16x16x32_bf16 v[108:111], a[148:151], v[52:55], v[108:111]
  v_mfma_f32_16x16x32_bf16 v[132:135], a[148:151], v[80:83], v[132:135]
  v_mfma_f32_16x16x32_bf16 v[140:143], a[148:151], v[84:87], v[140:143]
  ds_read_b128 a[148:151], v3 offset:5120
  v_mfma_f32_16x16x32_bf16 v[96:99], a[152:155], v[56:59], v[96:99]
  buffer_load_dwordx4 v2, s[44:47], s26 offen offset:3072 sc1 lds
  v_mfma_f32_16x16x32_bf16 v[104:107], a[152:155], v[60:63], v[104:107]
  s_add_u32 s26, s26, 16384
  v_mfma_f32_16x16x32_bf16 v[128:131], a[152:155], v[88:91], v[128:131]
  s_add_u32 s24, s24, 32768
  v_mfma_f32_16x16x32_bf16 v[136:139], a[152:155], v[92:95], v[136:139]
  s_and_b32 s24, s24, 0x1ffff
  ds_read_b128 a[152:155], v3 offset:6144
  v_mfma_f32_16x16x32_bf16 v[100:103], a[156:159], v[56:59], v[100:103]
  v_mfma_f32_16x16x32_bf16 v[108:111], a[156:159], v[60:63], v[108:111]
  v_mfma_f32_16x16x32_bf16 v[132:135], a[156:159], v[88:91], v[132:135]
  v_mfma_f32_16x16x32_bf16 v[140:143], a[156:159], v[92:95], v[140:143]
  s_waitcnt lgkmcnt(3)
  ds_read_b128 a[156:159], v3 offset:7168
  s_nop 7
  s_cmp_lg_u32 s28, 0
  s_cbranch_scc1 fa_nomask0
  v_cndmask_b32 v96, v4, v96, s[68:69]
  v_cndmask_b32 v97, v4, v97, s[70:71]
  v_cndmask_b32 v98, v4, v98, s[72:73]
  v_cndmask_b32 v99, v4, v99, s[74:75]
  v_mov_b32 v100, v4
  v_mov_b32 v101, v4
  v_mov_b32 v102, v4
  v_mov_b32 v103, v4
  v_cndmask_b32 v108, v4, v108, s[68:69]
  v_cndmask_b32 v109, v4, v109, s[70:71]
  v_cndmask_b32 v110, v4, v110, s[72:73]
  v_cndmask_b32 v111, v4, v111, s[74:75]
fa_nomask0:
  v_max3_f32 v16, v96, v97, v98
  v_max3_f32 v16, v16, v99, v100
  v_max3_f32 v16, v16, v101, v102
  v_max_f32 v16, v16, v103
  v_max3_f32 v17, v104, v105, v106
  v_max3_f32 v17, v17, v107, v108
  v_max3_f32 v17, v17, v109, v110
  v_max_f32 v17, v17, v111
  v_max3_f32 v18, v128, v129, v130
  v_max3_f32 v18, v18, v131, v132
  v_max3_f32 v18, v18, v133, v134
  v_max_f32 v18, v18, v135
  v_max3_f32 v19, v136, v137, v138
  v_max3_f32 v19, v19, v139, v140
  v_max3_f32 v19, v19, v141, v142
  v_max_f32 v19, v19, v143
  v_mov_b32 v20, v16
  v_mov_b32 v21, v17
  v_mov_b32 v22, v18
  v_mov_b32 v23, v19
  s_nop 0
  v_permlane16_swap_b32 v16, v20
  v_permlane16_swap_b32 v17, v21
  v_permlane16_swap_b32 v18, v22
  v_permlane16_swap_b32 v19, v23
  v_max_f32 v16, v16, v20
  v_max_f32 v17, v17, v21
  v_max_f32 v18, v18, v22
  v_max_f32 v19, v19, v23
  v_mov_b32 v20, v16
  v_mov_b32 v21, v17
  v_mov_b32 v22, v18
  v_mov_b32 v23, v19
  s_nop 0
  v_permlane32_swap_b32 v16, v20
  v_permlane32_swap_b32 v17, v21
  v_permlane32_swap_b32 v18, v22
  v_permlane32_swap_b32 v19, v23
  v_max_f32 v16, v16, v20
  v_max_f32 v17, v17, v21
  v_max_f32 v18, v18, v22
  v_max_f32 v19, v19, v23
  v_sub_f32 v192, 0, v16
  v_sub_f32 v193, 0, v16
  v_sub_f32 v194, 0, v16
  v_sub_f32 v195, 0, v16
  v_sub_f32 v196, 0, v17
  v_sub_f32 v197, 0, v17
  v_sub_f32 v198, 0, v17
  v_sub_f32 v199, 0, v17
  v_sub_f32 v200, 0, v18
  v_sub_f32 v201, 0, v18
  v_sub_f32 v202, 0, v18
  v_sub_f32 v203, 0, v18
  v_sub_f32 v204, 0, v19
  v_sub_f32 v205, 0, v19
  v_sub_f32 v206, 0, v19
  v_sub_f32 v207, 0, v19
  v_sub_f32 v96, v96, v16
  v_sub_f32 v97, v97, v16
  v_sub_f32 v98, v98, v16
  v_sub_f32 v99, v99, v16
  v_sub_f32 v100, v100, v16
  v_sub_f32 v101, v101, v16
  v_sub_f32 v102, v102, v16
  v_sub_f32 v103, v103, v16
  v_sub_f32 v104, v104, v17
  v_sub_f32 v105, v105, v17
  v_sub_f32 v106, v106, v17
  v_sub_f32 v107, v107, v17
  v_sub_f32 v108, v108, v17
  v_sub_f32 v109, v109, v17
  v_sub_f32 v110, v110, v17
  v_sub_f32 v111, v111, v17
  v_sub_f32 v128, v128, v18
  v_sub_f32 v129, v129, v18
  v_sub_f32 v130, v130, v18
  v_sub_f32 v131, v131, v18
  v_sub_f32 v132, v132, v18
  v_sub_f32 v133, v133, v18
  v_sub_f32 v134, v134, v18
  v_sub_f32 v135, v135, v18
  v_sub_f32 v136, v136, v19
  v_sub_f32 v137, v137, v19
  v_sub_f32 v138, v138, v19
  v_sub_f32 v139, v139, v19
  v_sub_f32 v140, v140, v19
  v_sub_f32 v141, v141, v19
  v_sub_f32 v142, v142, v19
  v_sub_f32 v143, v143, v19
  v_mfma_f32_16x16x32_bf16 v[112:115], a[128:131], v[32:35], v[192:195]
  v_exp_f32 v208, v96
  v_exp_f32 v209, v97
  v_mfma_f32_16x16x32_bf16 v[120:123], a[128:131], v[36:39], v[196:199]
  v_exp_f32 v210, v98
  v_exp_f32 v211, v99
  v_mfma_f32_16x16x32_bf16 v[144:147], a[128:131], v[64:67], v[200:203]
  v_exp_f32 v212, v100
  v_exp_f32 v213, v101
  v_mfma_f32_16x16x32_bf16 v[152:155], a[128:131], v[68:71], v[204:207]
  s_mov_b32 m0, s25
  ds_read_b128 a[128:131], v3 offset:8192
  v_exp_f32 v214, v102
  v_add_f32 v224, v208, v209
  v_mfma_f32_16x16x32_bf16 v[116:119], a[132:135], v[32:35], v[192:195]
  buffer_load_dwordx4 v2, s[48:51], s27 offen offset:0 sc1 lds
  v_exp_f32 v215, v103
  v_cvt_pk_bf16_f32 v160, v208, v209
  v_mfma_f32_16x16x32_bf16 v[124:127], a[132:135], v[36:39], v[196:199]
  v_exp_f32 v208, v104
  v_add_f32 v224, v224, v210
  v_add_f32 v224, v224, v211
  v_mfma_f32_16x16x32_bf16 v[148:151], a[132:135], v[64:67], v[200:203]
  v_exp_f32 v209, v105
  v_cvt_pk_bf16_f32 v161, v210, v211
  v_add_f32 v224, v224, v212
  v_mfma_f32_16x16x32_bf16 v[156:159], a[132:135], v[68:71], v[204:207]
  ds_read_b128 a[132:135], v3 offset:9216
  v_exp_f32 v210, v106
  v_mfma_f32_16x16x32_bf16 v[112:115], a[136:139], v[40:43], v[112:115]
  v_exp_f32 v211, v107
  v_add_f32 v224, v224, v213
  v_cvt_pk_bf16_f32 v162, v212, v213
  v_mfma_f32_16x16x32_bf16 v[120:123], a[136:139], v[44:47], v[120:123]
  v_exp_f32 v212, v108
  v_add_f32 v224, v224, v214
  v_add_f32 v224, v224, v215
  v_mfma_f32_16x16x32_bf16 v[144:147], a[136:139], v[72:75], v[144:147]
  buffer_load_dwordx4 v2, s[48:51], s27 offen offset:1024 sc1 lds
  v_exp_f32 v213, v109
  v_cvt_pk_bf16_f32 v163, v214, v215
  v_mfma_f32_16x16x32_bf16 v[152:155], a[136:139], v[76:79], v[152:155]
  ds_read_b128 a[136:139], v3 offset:10240
  v_exp_f32 v214, v110
  v_add_f32 v225, v208, v209
  v_mfma_f32_16x16x32_bf16 v[116:119], a[140:143], v[40:43], v[116:119]
  v_exp_f32 v215, v111
  v_exp_f32 v216, v128
  v_mfma_f32_16x16x32_bf16 v[124:127], a[140:143], v[44:47], v[124:127]
  v_exp_f32 v217, v129
  v_exp_f32 v218, v130
  v_mfma_f32_16x16x32_bf16 v[148:151], a[140:143], v[72:75], v[148:151]
  v_exp_f32 v219, v131
  v_exp_f32 v220, v132
  v_mfma_f32_16x16x32_bf16 v[156:159], a[140:143], v[76:79], v[156:159]
  s_waitcnt lgkmcnt(3)
  ds_read_b128 a[140:143], v3 offset:11264
  v_exp_f32 v221, v133
  v_cvt_pk_bf16_f32 v164, v208, v209
  v_mfma_f32_16x16x32_bf16 v[112:115], a[144:147], v[48:51], v[112:115]
  v_exp_f32 v222, v134
  v_exp_f32 v223, v135
  v_mfma_f32_16x16x32_bf16 v[120:123], a[144:147], v[52:55], v[120:123]
  v_add_f32 v225, v225, v210
  v_add_f32 v225, v225, v211
  v_cvt_pk_bf16_f32 v165, v210, v211
  v_add_f32 v225, v225, v212
  v_mfma_f32_16x16x32_bf16 v[144:147], a[144:147], v[80:83], v[144:147]
  buffer_load_dwordx4 v2, s[48:51], s27 offen offset:2048 sc1 lds
  v_add_f32 v225, v225, v213
  v_cvt_pk_bf16_f32 v166, v212, v213
  v_add_f32 v225, v225, v214
  v_mfma_f32_16x16x32_bf16 v[152:155], a[144:147], v[84:87], v[152:155]
  ds_read_b128 a[144:147], v3 offset:12288
  v_add_f32 v225, v225, v215
  v_cvt_pk_bf16_f32 v167, v214, v215
  v_add_f32 v226, v216, v217
  v_mfma_f32_16x16x32_bf16 v[116:119], a[148:151], v[48:51], v[116:119]
  v_cvt_pk_bf16_f32 v176, v216, v217
  v_exp_f32 v216, v136
  v_add_f32 v226, v226, v218
  v_mfma_f32_16x16x32_bf16 v[124:127], a[148:151], v[52:55], v[124:127]
  v_exp_f32 v217, v137
  v_add_f32 v226, v226, v219
  v_cvt_pk_bf16_f32 v177, v218, v219
  v_mfma_f32_16x16x32_bf16 v[148:151], a[148:151], v[80:83], v[148:151]
  v_exp_f32 v218, v138
  v_add_f32 v226, v226, v220
  v_add_f32 v226, v226, v221
  v_mfma_f32_16x16x32_bf16 v[156:159], a[148:151], v[84:87], v[156:159]
  ds_read_b128 a[148:151], v3 offset:13312
  v_exp_f32 v219, v139
  v_mfma_f32_16x16x32_bf16 v[112:115], a[152:155], v[56:59], v[112:115]
  buffer_load_dwordx4 v2, s[48:51], s27 offen offset:3072 sc1 lds
  v_cvt_pk_bf16_f32 v178, v220, v221
  v_exp_f32 v220, v140
  v_mfma_f32_16x16x32_bf16 v[120:123], a[152:155], v[60:63], v[120:123]
  s_add_u32 s27, s27, 16384
  v_add_f32 v226, v226, v222
  v_add_f32 v226, v226, v223
  v_cvt_pk_bf16_f32 v179, v222, v223
  v_add_f32 v227, v216, v217
  v_mfma_f32_16x16x32_bf16 v[144:147], a[152:155], v[88:91], v[144:147]
  s_add_u32 s25, s25, 32768
  v_exp_f32 v221, v141
  v_cvt_pk_bf16_f32 v180, v216, v217
  v_add_f32 v227, v227, v218
  v_mfma_f32_16x16x32_bf16 v[152:155], a[152:155], v[92:95], v[152:155]
  s_and_b32 s25, s25, 0x1ffff
  ds_read_b128 a[152:155], v3 offset:14336
  v_add_f32 v227, v227, v219
  v_cvt_pk_bf16_f32 v181, v218, v219
  v_max3_f32 v5, v224, v225, v226
  v_mfma_f32_16x16x32_bf16 v[116:119], a[156:159], v[56:59], v[116:119]
  v_exp_f32 v222, v142
  v_add_f32 v227, v227, v220
  v_add_f32 v227, v227, v221
  v_mfma_f32_16x16x32_bf16 v[124:127], a[156:159], v[60:63], v[124:127]
  v_exp_f32 v223, v143
  v_cvt_pk_bf16_f32 v182, v220, v221
  v_add_f32 v227, v227, v222
  v_mfma_f32_16x16x32_bf16 v[148:151], a[156:159], v[88:91], v[148:151]
  v_add_f32 v227, v227, v223
  v_cvt_pk_bf16_f32 v183, v222, v223
  v_max_f32 v5, v5, v227
  v_cmp_lt_f32 vcc, s81, v5
  v_mfma_f32_16x16x32_bf16 v[156:159], a[156:159], v[92:95], v[156:159]
  s_waitcnt lgkmcnt(3)
  s_cbranch_vccnz fa_stub0
fa_back0:
  ds_read_b128 a[156:159], v3 offset:15360
  v_add_f32 v228, v228, v224
  v_add_f32 v229, v229, v225
  v_add_f32 v230, v230, v226
  v_add_f32 v231, v231, v227
  v_add_u32 v3, 32768, v3
  v_and_b32 v3, 0x1ffff, v3
  s_cmp_eq_u32 s28, 0
  s_cbranch_scc1 fa_AV
  s_sub_u32 s28, s28, 1
  s_cmp_eq_u32 s28, 0
  s_cbranch_scc1 fa_Aexit
.p2align 6
fa_DD:
  v_mfma_f32_16x16x32_bf16 v[96:99], a[128:131], v[32:35], v[192:195]
  s_waitcnt vmcnt(12)
  v_exp_f32 v208, v112
  v_mfma_f32_16x16x32_bf16 v[104:107], a[128:131], v[36:39], v[196:199]
  s_barrier
  v_exp_f32 v209, v113
  v_mfma_f32_16x16x32_bf16 v[128:131], a[128:131], v[64:67], v[200:203]
  s_cmp_ge_u32 s26, s32
  ds_read_b128 a[160:163], v3 offset:16384
  v_add_f32 v224, v208, v209
  v_mfma_f32_16x16x32_bf16 v[136:139], a[128:131], v[68:71], v[204:207]
  s_cbranch_scc1 fa_hk4
fa_hb4:
  v_exp_f32 v210, v114
  v_mfma_f32_16x16x32_bf16 v[100:103], a[132:135], v[32:35], v[192:195]
  ds_read_b128 a[164:167], v3 offset:17408
  v_cvt_pk_bf16_f32 v168, v208, v209
  v_mfma_f32_16x16x32_bf16 v[108:111], a[132:135], v[36:39], v[196:199]
  s_mov_b32 m0, s24
  v_exp_f32 v211, v115
  v_mfma_f32_16x16x32_bf16 v[132:135], a[132:135], v[64:67], v[200:203]
  buffer_load_dwordx4 v2, s[44:47], s26 offen offset:0 sc1 lds
  v_add_f32 v224, v224, v210
  v_add_f32 v224, v224, v211
  v_mfma_f32_16x16x32_bf16 v[140:143], a[132:135], v[68:71], v[204:207]
  v_exp_f32 v212, v116
  v_mfma_f32_16x16x32_bf16 v[96:99], a[136:139], v[40:43], v[96:99]
  ds_read_b128 a[168:171], v3 offset:18432
  v_cvt_pk_bf16_f32 v169, v210, v211
  v_mfma_f32_16x16x32_bf16 v[104:107], a[136:139], v[44:47], v[104:107]
  v_exp_f32 v213, v117
  v_mfma_f32_16x16x32_bf16 v[128:131], a[136:139], v[72:75], v[128:131]
  v_exp_f32 v214, v118
  v_mfma_f32_16x16x32_bf16 v[136:139], a[136:139], v[76:79], v[136:139]
  v_exp_f32 v215, v119
  v_mfma_f32_16x16x32_bf16 v[100:103], a[140:143], v[40:43], v[100:103]
  ds_read_b128 a[172:175], v3 offset:19456
  v_add_f32 v224, v224, v212
  v_mfma_f32_16x16x32_bf16 v[108:111], a[140:143], v[44:47], v[108:111]
  v_exp_f32 v208, v120
  v_mfma_f32_16x16x32_bf16 v[132:135], a[140:143], v[72:75], v[132:135]
  v_exp_f32 v209, v121
  v_mfma_f32_16x16x32_bf16 v[140:143], a[140:143], v[76:79], v[140:143]
  s_waitcnt lgkmcnt(4)
  v_exp_f32 v210, v122
  v_mfma_f32_16x16x32_bf16 v[96:99], a[144:147], v[48:51], v[96:99]
  ds_read_b128 a[176:179], v3 offset:20480
  v_add_f32 v224, v224, v213
  v_mfma_f32_16x16x32_bf16 v[104:107], a[144:147], v[52:55], v[104:107]
  v_exp_f32 v211, v123
  v_mfma_f32_16x16x32_bf16 v[128:131], a[144:147], v[80:83], v[128:131]
  v_cvt_pk_bf16_f32 v170, v212, v213
  v_add_f32 v224, v224, v214
  v_add_f32 v224, v224, v215
  v_mfma_f32_16x16x32_bf16 v[136:139], a[144:147], v[84:87], v[136:139]
  v_exp_f32 v212, v124
  v_mfma_f32_16x16x32_bf16 v[100:103], a[148:151], v[48:51], v[100:103]
  ds_read_b128 a[180:183], v3 offset:21504
  v_cvt_pk_bf16_f32 v171, v214, v215
  v_mfma_f32_16x16x32_bf16 v[108:111], a[148:151], v[52:55], v[108:111]
  v_exp_f32 v213, v125
  v_mfma_f32_16x16x32_bf16 v[132:135], a[148:151], v[80:83], v[132:135]
  buffer_load_dwordx4 v2, s[44:47], s26 offen offset:1024 sc1 lds
  v_add_f32 v225, v208, v209
  v_mfma_f32_16x16x32_bf16 v[140:143], a[148:151], v[84:87], v[140:143]
  v_exp_f32 v214, v126
  v_mfma_f32_16x16x32_bf16 v[96:99], a[152:155], v[56:59], v[96:99]
  ds_read_b128 a[184:187], v3 offset:22528
  v_cvt_pk_bf16_f32 v172, v208, v209
  v_mfma_f32_16x16x32_bf16 v[104:107], a[152:155], v[60:63], v[104:107]
  v_exp_f32 v215, v127
  v_mfma_f32_16x16x32_bf16 v[128:131], a[152:155], v[88:91], v[128:131]
  v_exp_f32 v216, v144
  v_mfma_f32_16x16x32_bf16 v[136:139], a[152:155], v[92:95], v[136:139]
  v_exp_f32 v217, v145
  v_mfma_f32_16x16x32_bf16 v[100:103], a[156:159], v[56:59], v[100:103]
  ds_read_b128 a[188:191], v3 offset:23552
  v_add_f32 v225, v225, v210
  v_mfma_f32_16x16x32_bf16 v[108:111], a[156:159], v[60:63], v[108:111]
  v_exp_f32 v218, v146
  v_mfma_f32_16x16x32_bf16 v[132:135], a[156:159], v[88:91], v[132:135]
  v_exp_f32 v219, v147
  v_mfma_f32_16x16x32_bf16 v[140:143], a[156:159], v[92:95], v[140:143]
  s_waitcnt lgkmcnt(4)
  v_exp_f32 v220, v148
  v_add_f32 v225, v225, v211
  v_mfma_f32_16x16x32_bf16 a[0:3], a[160:163], v[160:163], a[0:3]
  ds_read_b128 a[128:131], v3 offset:0
  v_cvt_pk_bf16_f32 v173, v210, v211
  v_mfma_f32_16x16x32_bf16 a[4:7], a[160:163], v[164:167], a[4:7]
  v_exp_f32 v221, v149
  v_mfma_f32_16x16x32_bf16 a[64:67], a[160:163], v[176:179], a[64:67]
  v_exp_f32 v222, v150
  v_mfma_f32_16x16x32_bf16 a[68:71], a[160:163], v[180:183], a[68:71]
  v_exp_f32 v223, v151
  v_mfma_f32_16x16x32_bf16 a[8:11], a[164:167], v[160:163], a[8:11]
  ds_read_b128 a[132:135], v3 offset:1024
  v_add_f32 v225, v225, v212
  v_mfma_f32_16x16x32_bf16 a[12:15], a[164:167], v[164:167], a[12:15]
  v_add_f32 v225, v225, v213
  v_cvt_pk_bf16_f32 v174, v212, v213
  v_mfma_f32_16x16x32_bf16 a[72:75], a[164:167], v[176:179], a[72:75]
  buffer_load_dwordx4 v2, s[44:47], s26 offen offset:2048 sc1 lds
  v_add_f32 v225, v225, v214
  v_mfma_f32_16x16x32_bf16 a[76:79], a[164:167], v[180:183], a[76:79]
  v_add_f32 v225, v225, v215
  v_cvt_pk_bf16_f32 v175, v214, v215
  v_mfma_f32_16x16x32_bf16 a[16:19], a[168:171], v[160:163], a[16:19]
  ds_read_b128 a[136:139], v3 offset:2048
  v_add_f32 v226, v216, v217
  v_mfma_f32_16x16x32_bf16 a[20:23], a[168:171], v[164:167], a[20:23]
  v_cvt_pk_bf16_f32 v184, v216, v217
  v_add_f32 v226, v226, v218
  v_mfma_f32_16x16x32_bf16 a[80:83], a[168:171], v[176:179], a[80:83]
  v_exp_f32 v216, v152
  v_mfma_f32_16x16x32_bf16 a[84:87], a[168:171], v[180:183], a[84:87]
  v_exp_f32 v217, v153
  v_mfma_f32_16x16x32_bf16 a[24:27], a[172:175], v[160:163], a[24:27]
  ds_read_b128 a[140:143], v3 offset:3072
  v_add_f32 v226, v226, v219
  v_cvt_pk_bf16_f32 v185, v218, v219
  v_mfma_f32_16x16x32_bf16 a[28:31], a[172:175], v[164:167], a[28:31]
  v_exp_f32 v218, v154
  v_mfma_f32_16x16x32_bf16 a[88:91], a[172:175], v[176:179], a[88:91]
  v_add_f32 v226, v226, v220
  v_add_f32 v226, v226, v221
  v_mfma_f32_16x16x32_bf16 a[92:95], a[172:175], v[180:183], a[92:95]
  s_waitcnt lgkmcnt(4)
  v_exp_f32 v219, v155
  v_mfma_f32_16x16x32_bf16 a[32:35], a[176:179], v[160:163], a[32:35]
  ds_read_b128 a[144:147], v3 offset:4096
  v_cvt_pk_bf16_f32 v186, v220, v221
  v_mfma_f32_16x16x32_bf16 a[36:39], a[176:179], v[164:167], a[36:39]
  v_exp_f32 v220, v156
  v_mfma_f32_16x16x32_bf16 a[96:99], a[176:179], v[176:179], a[96:99]
  v_add_f32 v226, v226, v222
  v_add_f32 v226, v226, v223
  v_mfma_f32_16x16x32_bf16 a[100:103], a[176:179], v[180:183], a[100:103]
  v_exp_f32 v221, v157
  v_mfma_f32_16x16x32_bf16 a[40:43], a[180:183], v[160:163], a[40:43]
  ds_read_b128 a[148:151], v3 offset:5120
  v_cvt_pk_bf16_f32 v187, v222, v223
  v_mfma_f32_16x16x32_bf16 a[44:47], a[180:183], v[164:167], a[44:47]
  v_exp_f32 v222, v158
  v_mfma_f32_16x16x32_bf16 a[104:107], a[180:183], v[176:179], a[104:107]
  buffer_load_dwordx4 v2, s[44:47], s26 offen offset:3072 sc1 lds
  v_add_f32 v227, v216, v217
  v_mfma_f32_16x16x32_bf16 a[108:111], a[180:183], v[180:183], a[108:111]
  s_add_u32 s26, s26, 16384
  v_exp_f32 v223, v159
  v_mfma_f32_16x16x32_bf16 a[48:51], a[184:187], v[160:163], a[48:51]
  s_add_u32 s24, s24, 32768
  ds_read_b128 a[152:155], v3 offset:6144
  v_cvt_pk_bf16_f32 v188, v216, v217
  v_add_f32 v227, v227, v218
  v_mfma_f32_16x16x32_bf16 a[52:55], a[184:187], v[164:167], a[52:55]
  s_and_b32 s24, s24, 0x1ffff
  v_add_f32 v227, v227, v219
  v_cvt_pk_bf16_f32 v189, v218, v219
  v_mfma_f32_16x16x32_bf16 a[112:115], a[184:187], v[176:179], a[112:115]
  v_max3_f32 v5, v224, v225, v226
  v_add_f32 v227, v227, v220
  v_mfma_f32_16x16x32_bf16 a[116:119], a[184:187], v[180:183], a[116:119]
  v_add_f32 v227, v227, v221
  v_cvt_pk_bf16_f32 v190, v220, v221
  v_mfma_f32_16x16x32_bf16 a[56:59], a[188:191], v[160:163], a[56:59]
  ds_read_b128 a[156:159], v3 offset:7168
  v_add_f32 v227, v227, v222
  v_mfma_f32_16x16x32_bf16 a[60:63], a[188:191], v[164:167], a[60:63]
  v_add_f32 v227, v227, v223
  v_cvt_pk_bf16_f32 v191, v222, v223
  v_mfma_f32_16x16x32_bf16 a[120:123], a[188:191], v[176:179], a[120:123]
  s_waitcnt lgkmcnt(4)
  v_max_f32 v5, v5, v227
  v_cmp_lt_f32 vcc, s81, v5
  v_mfma_f32_16x16x32_bf16 a[124:127], a[188:191], v[180:183], a[124:127]
  s_cbranch_vccnz fa_stub1
fa_back1:
  v_add_f32 v228, v228, v224
  v_add_f32 v229, v229, v225
  v_add_f32 v230, v230, v226
  v_add_f32 v231, v231, v227
fa_DDe:
  v_mfma_f32_16x16x32_bf16 v[112:115], a[128:131], v[32:35], v[192:195]
  ds_read_b128 a[160:163], v3 offset:24576
  v_exp_f32 v208, v96
  v_mfma_f32_16x16x32_bf16 v[120:123], a[128:131], v[36:39], v[196:199]
  v_exp_f32 v209, v97
  v_mfma_f32_16x16x32_bf16 v[144:147], a[128:131], v[64:67], v[200:203]
  s_cmp_ge_u32 s26, s9
  v_exp_f32 v210, v98
  v_mfma_f32_16x16x32_bf16 v[152:155], a[128:131], v[68:71], v[204:207]
  s_cbranch_scc1 fa_hk5
fa_hb5:
  v_exp_f32 v211, v99
  v_mfma_f32_16x16x32_bf16 v[116:119], a[132:135], v[32:35], v[192:195]
  ds_read_b128 a[164:167], v3 offset:25600
  v_mfma_f32_16x16x32_bf16 v[124:127], a[132:135], v[36:39], v[196:199]
  s_mov_b32 m0, s25
  v_exp_f32 v212, v100
  v_mfma_f32_16x16x32_bf16 v[148:151], a[132:135], v[64:67], v[200:203]
  buffer_load_dwordx4 v2, s[48:51], s27 offen offset:0 sc1 lds
  v_add_f32 v224, v208, v209
  v_cvt_pk_bf16_f32 v160, v208, v209
  v_mfma_f32_16x16x32_bf16 v[156:159], a[132:135], v[68:71], v[204:207]
  v_exp_f32 v213, v101
  v_mfma_f32_16x16x32_bf16 v[112:115], a[136:139], v[40:43], v[112:115]
  ds_read_b128 a[168:171], v3 offset:26624
  v_add_f32 v224, v224, v210
  v_mfma_f32_16x16x32_bf16 v[120:123], a[136:139], v[44:47], v[120:123]
  v_exp_f32 v214, v102
  v_mfma_f32_16x16x32_bf16 v[144:147], a[136:139], v[72:75], v[144:147]
  v_exp_f32 v215, v103
  v_mfma_f32_16x16x32_bf16 v[152:155], a[136:139], v[76:79], v[152:155]
  v_exp_f32 v208, v104
  v_mfma_f32_16x16x32_bf16 v[116:119], a[140:143], v[40:43], v[116:119]
  ds_read_b128 a[172:175], v3 offset:27648
  v_add_f32 v224, v224, v211
  v_mfma_f32_16x16x32_bf16 v[124:127], a[140:143], v[44:47], v[124:127]
  v_exp_f32 v209, v105
  v_mfma_f32_16x16x32_bf16 v[148:151], a[140:143], v[72:75], v[148:151]
  v_cvt_pk_bf16_f32 v161, v210, v211
  v_add_f32 v224, v224, v212
  v_mfma_f32_16x16x32_bf16 v[156:159], a[140:143], v[76:79], v[156:159]
  s_waitcnt lgkmcnt(4)
  v_exp_f32 v210, v106
  v_mfma_f32_16x16x32_bf16 v[112:115], a[144:147], v[48:51], v[112:115]
  ds_read_b128 a[176:179], v3 offset:28672
  v_add_f32 v224, v224, v213
  v_mfma_f32_16x16x32_bf16 v[120:123], a[144:147], v[52:55], v[120:123]
  v_exp_f32 v211, v107
  v_mfma_f32_16x16x32_bf16 v[144:147], a[144:147], v[80:83], v[144:147]
  v_cvt_pk_bf16_f32 v162, v212, v213
  v_add_f32 v224, v224, v214
  v_add_f32 v224, v224, v215
  v_mfma_f32_16x16x32_bf16 v[152:155], a[144:147], v[84:87], v[152:155]
  v_exp_f32 v212, v108
  v_mfma_f32_16x16x32_bf16 v[116:119], a[148:151], v[48:51], v[116:119]
  ds_read_b128 a[180:183], v3 offset:29696
  v_cvt_pk_bf16_f32 v163, v214, v215
  v_mfma_f32_16x16x32_bf16 v[124:127], a[148:151], v[52:55], v[124:127]
  v_exp_f32 v213, v109
  v_mfma_f32_16x16x32_bf16 v[148:151], a[148:151], v[80:83], v[148:151]
  buffer_load_dwordx4 v2, s[48:51], s27 offen offset:1024 sc1 lds
  v_add_f32 v225, v208, v209
  v_mfma_f32_16x16x32_bf16 v[156:159], a[148:151], v[84:87], v[156:159]
  v_exp_f32 v214, v110
  v_mfma_f32_16x16x32_bf16 v[112:115], a[152:155], v[56:59], v[112:115]
  ds_read_b128 a[184:187], v3 offset:30720
  v_cvt_pk_bf16_f32 v164, v208, v209
  v_mfma_f32_16x16x32_bf16 v[120:123], a[152:155], v[60:63], v[120:123]
  v_exp_f32 v215, v111
  v_mfma_f32_16x16x32_bf16 v[144:147], a[152:155], v[88:91], v[144:147]
  v_exp_f32 v216, v128
  v_mfma_f32_16x16x32_bf16 v[152:155], a[152:155], v[92:95], v[152:155]
  v_exp_f32 v217, v129
  v_mfma_f32_16x16x32_bf16 v[116:119], a[156:159], v[56:59], v[116:119]
  ds_read_b128 a[188:191], v3 offset:31744
  v_add_f32 v225, v225, v210
  v_mfma_f32_16x16x32_bf16 v[124:127], a[156:159], v[60:63], v[124:127]
  v_exp_f32 v218, v130
  v_mfma_f32_16x16x32_bf16 v[148:151], a[156:159], v[88:91], v[148:151]
  v_exp_f32 v219, v131
  v_mfma_f32_16x16x32_bf16 v[156:159], a[156:159], v[92:95], v[156:159]
  s_waitcnt lgkmcnt(4)
  v_exp_f32 v220, v132
  v_add_f32 v225, v225, v211
  v_mfma_f32_16x16x32_bf16 a[0:3], a[160:163], v[168:171], a[0:3]
  ds_read_b128 a[128:131], v3 offset:8192
  v_cvt_pk_bf16_f32 v165, v210, v211
  v_mfma_f32_16x16x32_bf16 a[4:7], a[160:163], v[172:175], a[4:7]
  v_exp_f32 v221, v133
  v_mfma_f32_16x16x32_bf16 a[64:67], a[160:163], v[184:187], a[64:67]
  v_exp_f32 v222, v134
  v_mfma_f32_16x16x32_bf16 a[68:71], a[160:163], v[188:191], a[68:71]
  v_exp_f32 v223, v135
  v_mfma_f32_16x16x32_bf16 a[8:11], a[164:167], v[168:171], a[8:11]
  ds_read_b128 a[132:135], v3 offset:9216
  v_add_f32 v225, v225, v212
  v_mfma_f32_16x16x32_bf16 a[12:15], a[164:167], v[172:175], a[12:15]
  v_add_f32 v225, v225, v213
  v_cvt_pk_bf16_f32 v166, v212, v213
  v_mfma_f32_16x16x32_bf16 a[72:75], a[164:167], v[184:187], a[72:75]
  buffer_load_dwordx4 v2, s[48:51], s27 offen offset:2048 sc1 lds
  v_add_f32 v225, v225, v214
  v_mfma_f32_16x16x32_bf16 a[76:79], a[164:167], v[188:191], a[76:79]
  v_add_f32 v225, v225, v215
  v_cvt_pk_bf16_f32 v167, v214, v215
  v_mfma_f32_16x16x32_bf16 a[16:19], a[168:171], v[168:171], a[16:19]
  ds_read_b128 a[136:139], v3 offset:10240
  v_add_f32 v226, v216, v217
  v_mfma_f32_16x16x32_bf16 a[20:23], a[168:171], v[172:175], a[20:23]
  v_cvt_pk_bf16_f32 v176, v216, v217
  v_add_f32 v226, v226, v218
  v_mfma_f32_16x16x32_bf16 a[80:83], a[168:171], v[184:187], a[80:83]
  v_exp_f32 v216, v136
  v_mfma_f32_16x16x32_bf16 a[84:87], a[168:171], v[188:191], a[84:87]
  v_exp_f32 v217, v137
  v_mfma_f32_16x16x32_bf16 a[24:27], a[172:175], v[168:171], a[24:27]
  ds_read_b128 a[140:143], v3 offset:11264
  v_add_f32 v226, v226, v219
  v_cvt_pk_bf16_f32 v177, v218, v219
  v_mfma_f32_16x16x32_bf16 a[28:31], a[172:175], v[172:175], a[28:31]
  v_exp_f32 v218, v138
  v_mfma_f32_16x16x32_bf16 a[88:91], a[172:175], v[184:187], a[88:91]
  v_add_f32 v226, v226, v220
  v_add_f32 v226, v226, v221
  v_mfma_f32_16x16x32_bf16 a[92:95], a[172:175], v[188:191], a[92:95]
  s_waitcnt lgkmcnt(4)
  v_exp_f32 v219, v139
  v_mfma_f32_16x16x32_bf16 a[32:35], a[176:179], v[168:171], a[32:35]
  ds_read_b128 a[144:147], v3 offset:12288
  v_cvt_pk_bf16_f32 v178, v220, v221
  v_mfma_f32_16x16x32_bf16 a[36:39], a[176:179], v[172:175], a[36:39]
  v_exp_f32 v220, v140
  v_mfma_f32_16x16x32_bf16 a[96:99], a[176:179], v[184:187], a[96:99]
  v_add_f32 v226, v226, v222
  v_add_f32 v226, v226, v223
  v_mfma_f32_16x16x32_bf16 a[100:103], a[176:179], v[188:191], a[100:103]
  v_exp_f32 v221, v141
  v_mfma_f32_16x16x32_bf16 a[40:43], a[180:183], v[168:171], a[40:43]
  ds_read_b128 a[148:151], v3 offset:13312
  v_cvt_pk_bf16_f32 v179, v222, v223
  v_mfma_f32_16x16x32_bf16 a[44:47], a[180:183], v[172:175], a[44:47]
  v_exp_f32 v222, v142
  v_mfma_f32_16x16x32_bf16 a[104:107], a[180:183], v[184:187], a[104:107]
  buffer_load_dwordx4 v2, s[48:51], s27 offen offset:3072 sc1 lds
  v_add_f32 v227, v216, v217
  v_mfma_f32_16x16x32_bf16 a[108:111], a[180:183], v[188:191], a[108:111]
  s_add_u32 s27, s27, 16384
  v_exp_f32 v223, v143
  v_mfma_f32_16x16x32_bf16 a[48:51], a[184:187], v[168:171], a[48:51]
  s_add_u32 s25, s25, 32768
  ds_read_b128 a[152:155], v3 offset:14336
  v_cvt_pk_bf16_f32 v180, v216, v217
  v_add_f32 v227, v227, v218
  v_mfma_f32_16x16x32_bf16 a[52:55], a[184:187], v[172:175], a[52:55]
  s_and_b32 s25, s25, 0x1ffff
  v_add_f32 v227, v227, v219
  v_cvt_pk_bf16_f32 v181, v218, v219
  v_mfma_f32_16x16x32_bf16 a[112:115], a[184:187], v[184:187], a[112:115]
  v_max3_f32 v5, v224, v225, v226
  v_add_f32 v227, v227, v220
  v_mfma_f32_16x16x32_bf16 a[116:119], a[184:187], v[188:191], a[116:119]
  v_add_f32 v227, v227, v221
  v_cvt_pk_bf16_f32 v182, v220, v221
  v_mfma_f32_16x16x32_bf16 a[56:59], a[188:191], v[168:171], a[56:59]
  ds_read_b128 a[156:159], v3 offset:15360
  v_add_f32 v227, v227, v222
  v_mfma_f32_16x16x32_bf16 a[60:63], a[188:191], v[172:175], a[60:63]
  s_sub_u32 s28, s28, 1
  v_add_f32 v227, v227, v223
  v_cvt_pk_bf16_f32 v183, v222, v223
  v_mfma_f32_16x16x32_bf16 a[120:123], a[188:191], v[184:187], a[120:123]
  s_waitcnt lgkmcnt(4)
  v_max_f32 v5, v5, v227
  v_cmp_lt_f32 vcc, s81, v5
  v_mfma_f32_16x16x32_bf16 a[124:127], a[188:191], v[188:191], a[124:127]
  s_cbranch_vccnz fa_stub2
fa_back2:
  v_add_f32 v228, v228, v224
  v_add_f32 v229, v229, v225
  v_add_f32 v230, v230, v226
  v_add_f32 v231, v231, v227
  v_add_u32 v3, 32768, v3
  v_and_b32 v3, 0x1ffff, v3
  s_cmp_lg_u32 s8, 0
  s_cbranch_scc1 fa_DDF
  s_cmp_lg_u32 s28, 0
  s_cbranch_scc1 fa_DD
fa_Aexit:
  s_bitcmp1_b32 s20, 0
  s_cbranch_scc1 fa_Aodd
  v_mfma_f32_16x16x32_bf16 v[96:99], a[128:131], v[32:35], v[192:195]
  s_waitcnt vmcnt(12)
  v_exp_f32 v208, v112
  v_mfma_f32_16x16x32_bf16 v[104:107], a[128:131], v[36:39], v[196:199]
  s_barrier
  v_exp_f32 v209, v113
  v_mfma_f32_16x16x32_bf16 v[128:131], a[128:131], v[64:67], v[200:203]
  ds_read_b128 a[160:163], v3 offset:16384
  v_add_f32 v224, v208, v209
  v_mfma_f32_16x16x32_bf16 v[136:139], a[128:131], v[68:71], v[204:207]
  v_exp_f32 v210, v114
  v_mfma_f32_16x16x32_bf16 v[100:103], a[132:135], v[32:35], v[192:195]
  ds_read_b128 a[164:167], v3 offset:17408
  v_cvt_pk_bf16_f32 v168, v208, v209
  v_mfma_f32_16x16x32_bf16 v[108:111], a[132:135], v[36:39], v[196:199]
  s_mov_b32 m0, s24
  v_exp_f32 v211, v115
  v_mfma_f32_16x16x32_bf16 v[132:135], a[132:135], v[64:67], v[200:203]
  buffer_load_dwordx4 v2, s[44:47], s26 offen offset:0 sc1 lds
  v_add_f32 v224, v224, v210
  v_add_f32 v224, v224, v211
  v_mfma_f32_16x16x32_bf16 v[140:143], a[132:135], v[68:71], v[204:207]
  v_exp_f32 v212, v116
  v_mfma_f32_16x16x32_bf16 v[96:99], a[136:139], v[40:43], v[96:99]
  ds_read_b128 a[168:171], v3 offset:18432
  v_cvt_pk_bf16_f32 v169, v210, v211
  v_mfma_f32_16x16x32_bf16 v[104:107], a[136:139], v[44:47], v[104:107]
  v_exp_f32 v213, v117
  v_mfma_f32_16x16x32_bf16 v[128:131], a[136:139], v[72:75], v[128:131]
  v_exp_f32 v214, v118
  v_mfma_f32_16x16x32_bf16 v[136:139], a[136:139], v[76:79], v[136:139]
  v_exp_f32 v215, v119
  v_mfma_f32_16x16x32_bf16 v[100:103], a[140:143], v[40:43], v[100:103]
  ds_read_b128 a[172:175], v3 offset:19456
  v_add_f32 v224, v224, v212
  v_mfma_f32_16x16x32_bf16 v[108:111], a[140:143], v[44:47], v[108:111]
  v_exp_f32 v208, v120
  v_mfma_f32_16x16x32_bf16 v[132:135], a[140:143], v[72:75], v[132:135]
  v_exp_f32 v209, v121
  v_mfma_f32_16x16x32_bf16 v[140:143], a[140:143], v[76:79], v[140:143]
  s_waitcnt lgkmcnt(4)
  v_exp_f32 v210, v122
  v_mfma_f32_16x16x32_bf16 v[96:99], a[144:147], v[48:51], v[96:99]
  ds_read_b128 a[176:179], v3 offset:20480
  v_add_f32 v224, v224, v213
  v_mfma_f32_16x16x32_bf16 v[104:107], a[144:147], v[52:55], v[104:107]
  v_exp_f32 v211, v123
  v_mfma_f32_16x16x32_bf16 v[128:131], a[144:147], v[80:83], v[128:131]
  v_cvt_pk_bf16_f32 v170, v212, v213
  v_add_f32 v224, v224, v214
  v_add_f32 v224, v224, v215
  v_mfma_f32_16x16x32_bf16 v[136:139], a[144:147], v[84:87], v[136:139]
  v_exp_f32 v212, v124
  v_mfma_f32_16x16x32_bf16 v[100:103], a[148:151], v[48:51], v[100:103]
  ds_read_b128 a[180:183], v3 offset:21504
  v_cvt_pk_bf16_f32 v171, v214, v215
  v_mfma_f32_16x16x32_bf16 v[108:111], a[148:151], v[52:55], v[108:111]
  v_exp_f32 v213, v125
  v_mfma_f32_16x16x32_bf16 v[132:135], a[148:151], v[80:83], v[132:135]
  buffer_load_dwordx4 v2, s[44:47], s26 offen offset:1024 sc1 lds
  v_add_f32 v225, v208, v209
  v_mfma_f32_16x16x32_bf16 v[140:143], a[148:151], v[84:87], v[140:143]
  v_exp_f32 v214, v126
  v_mfma_f32_16x16x32_bf16 v[96:99], a[152:155], v[56:59], v[96:99]
  ds_read_b128 a[184:187], v3 offset:22528
  v_cvt_pk_bf16_f32 v172, v208, v209
  v_mfma_f32_16x16x32_bf16 v[104:107], a[152:155], v[60:63], v[104:107]
  v_exp_f32 v215, v127
  v_mfma_f32_16x16x32_bf16 v[128:131], a[152:155], v[88:91], v[128:131]
  v_exp_f32 v216, v144
  v_mfma_f32_16x16x32_bf16 v[136:139], a[152:155], v[92:95], v[136:139]
  v_exp_f32 v217, v145
  v_mfma_f32_16x16x32_bf16 v[100:103], a[156:159], v[56:59], v[100:103]
  ds_read_b128 a[188:191], v3 offset:23552
  v_add_f32 v225, v225, v210
  v_mfma_f32_16x16x32_bf16 v[108:111], a[156:159], v[60:63], v[108:111]
  v_exp_f32 v218, v146
  v_mfma_f32_16x16x32_bf16 v[132:135], a[156:159], v[88:91], v[132:135]
  v_exp_f32 v219, v147
  v_mfma_f32_16x16x32_bf16 v[140:143], a[156:159], v[92:95], v[140:143]
  s_waitcnt lgkmcnt(4)
  v_exp_f32 v220, v148
  v_add_f32 v225, v225, v211
  v_mfma_f32_16x16x32_bf16 a[0:3], a[160:163], v[160:163], a[0:3]
  ds_read_b128 a[128:131], v3 offset:0
  v_cvt_pk_bf16_f32 v173, v210, v211
  v_mfma_f32_16x16x32_bf16 a[4:7], a[160:163], v[164:167], a[4:7]
  v_exp_f32 v221, v149
  v_mfma_f32_16x16x32_bf16 a[64:67], a[160:163], v[176:179], a[64:67]
  v_exp_f32 v222, v150
  v_mfma_f32_16x16x32_bf16 a[68:71], a[160:163], v[180:183], a[68:71]
  v_exp_f32 v223, v151
  v_mfma_f32_16x16x32_bf16 a[8:11], a[164:167], v[160:163], a[8:11]
  ds_read_b128 a[132:135], v3 offset:1024
  v_add_f32 v225, v225, v212
  v_mfma_f32_16x16x32_bf16 a[12:15], a[164:167], v[164:167], a[12:15]
  v_add_f32 v225, v225, v213
  v_cvt_pk_bf16_f32 v174, v212, v213
  v_mfma_f32_16x16x32_bf16 a[72:75], a[164:167], v[176:179], a[72:75]
  buffer_load_dwordx4 v2, s[44:47], s26 offen offset:2048 sc1 lds
  v_add_f32 v225, v225, v214
  v_mfma_f32_16x16x32_bf16 a[76:79], a[164:167], v[180:183], a[76:79]
  v_add_f32 v225, v225, v215
  v_cvt_pk_bf16_f32 v175, v214, v215
  v_mfma_f32_16x16x32_bf16 a[16:19], a[168:171], v[160:163], a[16:19]
  ds_read_b128 a[136:139], v3 offset:2048
  v_add_f32 v226, v216, v217
  v_mfma_f32_16x16x32_bf16 a[20:23], a[168:171], v[164:167], a[20:23]
  v_cvt_pk_bf16_f32 v184, v216, v217
  v_add_f32 v226, v226, v218
  v_mfma_f32_16x16x32_bf16 a[80:83], a[168:171], v[176:179], a[80:83]
  v_exp_f32 v216, v152
  v_mfma_f32_16x16x32_bf16 a[84:87], a[168:171], v[180:183], a[84:87]
  v_exp_f32 v217, v153
  v_mfma_f32_16x16x32_bf16 a[24:27], a[172:175], v[160:163], a[24:27]
  ds_read_b128 a[140:143], v3 offset:3072
  v_add_f32 v226, v226, v219
  v_cvt_pk_bf16_f32 v185, v218, v219
  v_mfma_f32_16x16x32_bf16 a[28:31], a[172:175], v[164:167], a[28:31]
  v_exp_f32 v218, v154
  v_mfma_f32_16x16x32_bf16 a[88:91], a[172:175], v[176:179], a[88:91]
  v_add_f32 v226, v226, v220
  v_add_f32 v226, v226, v221
  v_mfma_f32_16x16x32_bf16 a[92:95], a[172:175], v[180:183], a[92:95]
  s_waitcnt lgkmcnt(4)
  v_exp_f32 v219, v155
  v_mfma_f32_16x16x32_bf16 a[32:35], a[176:179], v[160:163], a[32:35]
  ds_read_b128 a[144:147], v3 offset:4096
  v_cvt_pk_bf16_f32 v186, v220, v221
  v_mfma_f32_16x16x32_bf16 a[36:39], a[176:179], v[164:167], a[36:39]
  v_exp_f32 v220, v156
  v_mfma_f32_16x16x32_bf16 a[96:99], a[176:179], v[176:179], a[96:99]
  v_add_f32 v226, v226, v222
  v_add_f32 v226, v226, v223
  v_mfma_f32_16x16x32_bf16 a[100:103], a[176:179], v[180:183], a[100:103]
  v_exp_f32 v221, v157
  v_mfma_f32_16x16x32_bf16 a[40:43], a[180:183], v[160:163], a[40:43]
  ds_read_b128 a[148:151], v3 offset:5120
  v_cvt_pk_bf16_f32 v187, v222, v223
  v_mfma_f32_16x16x32_bf16 a[44:47], a[180:183], v[164:167], a[44:47]
  v_exp_f32 v222, v158
  v_mfma_f32_16x16x32_bf16 a[104:107], a[180:183], v[176:179], a[104:107]
  buffer_load_dwordx4 v2, s[44:47], s26 offen offset:3072 sc1 lds
  v_add_f32 v227, v216, v217
  v_mfma_f32_16x16x32_bf16 a[108:111], a[180:183], v[180:183], a[108:111]
  s_add_u32 s26, s26, 16384
  v_exp_f32 v223, v159
  v_mfma_f32_16x16x32_bf16 a[48:51], a[184:187], v[160:163], a[48:51]
  s_add_u32 s24, s24, 32768
  ds_read_b128 a[152:155], v3 offset:6144
  v_cvt_pk_bf16_f32 v188, v216, v217
  v_add_f32 v227, v227, v218
  v_mfma_f32_16x16x32_bf16 a[52:55], a[184:187], v[164:167], a[52:55]
  s_and_b32 s24, s24, 0x1ffff
  v_add_f32 v227, v227, v219
  v_cvt_pk_bf16_f32 v189, v218, v219
  v_mfma_f32_16x16x32_bf16 a[112:115], a[184:187], v[176:179], a[112:115]
  v_max3_f32 v5, v224, v225, v226
  v_add_f32 v227, v227, v220
  v_mfma_f32_16x16x32_bf16 a[116:119], a[184:187], v[180:183], a[116:119]
  v_add_f32 v227, v227, v221
  v_cvt_pk_bf16_f32 v190, v220, v221
  v_mfma_f32_16x16x32_bf16 a[56:59], a[188:191], v[160:163], a[56:59]
  ds_read_b128 a[156:159], v3 offset:7168
  v_add_f32 v227, v227, v222
  v_mfma_f32_16x16x32_bf16 a[60:63], a[188:191], v[164:167], a[60:63]
  v_add_f32 v227, v227, v223
  v_cvt_pk_bf16_f32 v191, v222, v223
  v_mfma_f32_16x16x32_bf16 a[120:123], a[188:191], v[176:179], a[120:123]
  s_waitcnt lgkmcnt(4)
  v_max_f32 v5, v5, v227
  v_cmp_lt_f32 vcc, s81, v5
  v_mfma_f32_16x16x32_bf16 a[124:127], a[188:191], v[180:183], a[124:127]
  s_cbranch_vccnz fa_stub4
fa_back4:
  v_add_f32 v228, v228, v224
  v_add_f32 v229, v229, v225
  v_add_f32 v230, v230, v226
  v_add_f32 v231, v231, v227
  v_mfma_f32_16x16x32_bf16 v[144:147], a[128:131], v[64:67], v[200:203]
  ds_read_b128 a[160:163], v3 offset:24576
  v_cndmask_b32 v96, v4, v96, s[68:69]
  v_cndmask_b32 v97, v4, v97, s[70:71]
  v_mfma_f32_16x16x32_bf16 v[152:155], a[128:131], v[68:71], v[204:207]
  v_cndmask_b32 v98, v4, v98, s[72:73]
  v_cndmask_b32 v99, v4, v99, s[74:75]
  v_mov_b32 v100, v4
  v_mfma_f32_16x16x32_bf16 v[148:151], a[132:135], v[64:67], v[200:203]
  ds_read_b128 a[164:167], v3 offset:25600
  v_mov_b32 v101, v4
  v_mov_b32 v102, v4
  v_mfma_f32_16x16x32_bf16 v[156:159], a[132:135], v[68:71], v[204:207]
  v_mov_b32 v103, v4
  v_cndmask_b32 v108, v4, v108, s[68:69]
  v_cndmask_b32 v109, v4, v109, s[70:71]
  v_mfma_f32_16x16x32_bf16 v[144:147], a[136:139], v[72:75], v[144:147]
  ds_read_b128 a[168:171], v3 offset:26624
  v_cndmask_b32 v110, v4, v110, s[72:73]
  v_cndmask_b32 v111, v4, v111, s[74:75]
  v_mfma_f32_16x16x32_bf16 v[152:155], a[136:139], v[76:79], v[152:155]
  s_mov_b32 m0, s25
  v_exp_f32 v208, v96
  v_exp_f32 v209, v97
  v_mfma_f32_16x16x32_bf16 v[148:151], a[140:143], v[72:75], v[148:151]
  ds_read_b128 a[172:175], v3 offset:27648
  buffer_load_dwordx4 v2, s[48:51], s27 offen offset:0 sc1 lds
  v_mfma_f32_16x16x32_bf16 v[156:159], a[140:143], v[76:79], v[156:159]
  s_waitcnt lgkmcnt(4)
  v_exp_f32 v210, v98
  v_add_f32 v224, v208, v209
  v_mfma_f32_16x16x32_bf16 v[144:147], a[144:147], v[80:83], v[144:147]
  ds_read_b128 a[176:179], v3 offset:28672
  v_exp_f32 v211, v99
  v_mfma_f32_16x16x32_bf16 v[152:155], a[144:147], v[84:87], v[152:155]
  v_exp_f32 v212, v100
  v_cvt_pk_bf16_f32 v160, v208, v209
  v_mfma_f32_16x16x32_bf16 v[148:151], a[148:151], v[80:83], v[148:151]
  ds_read_b128 a[180:183], v3 offset:29696
  v_exp_f32 v213, v101
  v_mfma_f32_16x16x32_bf16 v[156:159], a[148:151], v[84:87], v[156:159]
  v_exp_f32 v214, v102
  v_add_f32 v224, v224, v210
  v_add_f32 v224, v224, v211
  v_mfma_f32_16x16x32_bf16 v[144:147], a[152:155], v[88:91], v[144:147]
  ds_read_b128 a[184:187], v3 offset:30720
  v_cvt_pk_bf16_f32 v161, v210, v211
  v_add_f32 v224, v224, v212
  v_mfma_f32_16x16x32_bf16 v[152:155], a[152:155], v[92:95], v[152:155]
  v_exp_f32 v215, v103
  v_add_f32 v224, v224, v213
  v_mfma_f32_16x16x32_bf16 v[148:151], a[156:159], v[88:91], v[148:151]
  ds_read_b128 a[188:191], v3 offset:31744
  v_cvt_pk_bf16_f32 v162, v212, v213
  v_add_f32 v224, v224, v214
  v_mfma_f32_16x16x32_bf16 v[156:159], a[156:159], v[92:95], v[156:159]
  s_waitcnt lgkmcnt(4)
  v_exp_f32 v208, v104
  v_add_f32 v224, v224, v215
  v_mfma_f32_16x16x32_bf16 a[0:3], a[160:163], v[168:171], a[0:3]
  ds_read_b128 a[128:131], v3 offset:8192
  v_cvt_pk_bf16_f32 v163, v214, v215
  v_exp_f32 v209, v105
  v_mfma_f32_16x16x32_bf16 a[4:7], a[160:163], v[172:175], a[4:7]
  v_exp_f32 v210, v106
  v_mfma_f32_16x16x32_bf16 a[64:67], a[160:163], v[184:187], a[64:67]
  buffer_load_dwordx4 v2, s[48:51], s27 offen offset:1024 sc1 lds
  v_exp_f32 v211, v107
  v_mfma_f32_16x16x32_bf16 a[68:71], a[160:163], v[188:191], a[68:71]
  v_exp_f32 v212, v108
  v_add_f32 v225, v208, v209
  v_mfma_f32_16x16x32_bf16 a[8:11], a[164:167], v[168:171], a[8:11]
  ds_read_b128 a[132:135], v3 offset:9216
  v_exp_f32 v213, v109
  v_mfma_f32_16x16x32_bf16 a[12:15], a[164:167], v[172:175], a[12:15]
  v_exp_f32 v214, v110
  v_cvt_pk_bf16_f32 v164, v208, v209
  v_mfma_f32_16x16x32_bf16 a[72:75], a[164:167], v[184:187], a[72:75]
  v_exp_f32 v215, v111
  v_add_f32 v225, v225, v210
  v_mfma_f32_16x16x32_bf16 a[76:79], a[164:167], v[188:191], a[76:79]
  v_exp_f32 v216, v128
  v_add_f32 v225, v225, v211
  v_mfma_f32_16x16x32_bf16 a[16:19], a[168:171], v[168:171], a[16:19]
  ds_read_b128 a[136:139], v3 offset:10240
  v_exp_f32 v217, v129
  v_mfma_f32_16x16x32_bf16 a[20:23], a[168:171], v[172:175], a[20:23]
  v_exp_f32 v218, v130
  v_cvt_pk_bf16_f32 v165, v210, v211
  v_mfma_f32_16x16x32_bf16 a[80:83], a[168:171], v[184:187], a[80:83]
  v_exp_f32 v219, v131
  v_add_f32 v225, v225, v212
  v_mfma_f32_16x16x32_bf16 a[84:87], a[168:171], v[188:191], a[84:87]
  v_exp_f32 v220, v132
  v_add_f32 v225, v225, v213
  v_mfma_f32_16x16x32_bf16 a[24:27], a[172:175], v[168:171], a[24:27]
  ds_read_b128 a[140:143], v3 offset:11264
  v_exp_f32 v221, v133
  v_mfma_f32_16x16x32_bf16 a[28:31], a[172:175], v[172:175], a[28:31]
  v_exp_f32 v222, v134
  v_cvt_pk_bf16_f32 v166, v212, v213
  v_mfma_f32_16x16x32_bf16 a[88:91], a[172:175], v[184:187], a[88:91]
  buffer_load_dwordx4 v2, s[48:51], s27 offen offset:2048 sc1 lds
  v_exp_f32 v223, v135
  v_mfma_f32_16x16x32_bf16 a[92:95], a[172:175], v[188:191], a[92:95]
  s_waitcnt lgkmcnt(4)
  v_add_f32 v225, v225, v214
  v_add_f32 v225, v225, v215
  v_cvt_pk_bf16_f32 v167, v214, v215
  v_mfma_f32_16x16x32_bf16 a[32:35], a[176:179], v[168:171], a[32:35]
  ds_read_b128 a[144:147], v3 offset:12288
  v_add_f32 v226, v216, v217
  v_cvt_pk_bf16_f32 v176, v216, v217
  v_mfma_f32_16x16x32_bf16 a[36:39], a[176:179], v[172:175], a[36:39]
  v_exp_f32 v216, v136
  v_add_f32 v226, v226, v218
  v_mfma_f32_16x16x32_bf16 a[96:99], a[176:179], v[184:187], a[96:99]
  v_exp_f32 v217, v137
  v_add_f32 v226, v226, v219
  v_mfma_f32_16x16x32_bf16 a[100:103], a[176:179], v[188:191], a[100:103]
  v_cvt_pk_bf16_f32 v177, v218, v219
  v_add_f32 v226, v226, v220
  v_add_f32 v226, v226, v221
  v_cvt_pk_bf16_f32 v178, v220, v221
  v_mfma_f32_16x16x32_bf16 a[40:43], a[180:183], v[168:171], a[40:43]
  ds_read_b128 a[148:151], v3 offset:13312
  v_add_f32 v226, v226, v222
  v_add_f32 v226, v226, v223
  v_mfma_f32_16x16x32_bf16 a[44:47], a[180:183], v[172:175], a[44:47]
  v_exp_f32 v218, v138
  v_cvt_pk_bf16_f32 v179, v222, v223
  v_mfma_f32_16x16x32_bf16 a[104:107], a[180:183], v[184:187], a[104:107]
  v_exp_f32 v219, v139
  v_add_f32 v227, v216, v217
  v_mfma_f32_16x16x32_bf16 a[108:111], a[180:183], v[188:191], a[108:111]
  v_exp_f32 v220, v140
  v_cvt_pk_bf16_f32 v180, v216, v217
  v_mfma_f32_16x16x32_bf16 a[48:51], a[184:187], v[168:171], a[48:51]
  ds_read_b128 a[152:155], v3 offset:14336
  v_add_f32 v227, v227, v218
  v_add_f32 v227, v227, v219
  v_mfma_f32_16x16x32_bf16 a[52:55], a[184:187], v[172:175], a[52:55]
  v_exp_f32 v221, v141
  v_cvt_pk_bf16_f32 v181, v218, v219
  v_mfma_f32_16x16x32_bf16 a[112:115], a[184:187], v[184:187], a[112:115]
  buffer_load_dwordx4 v2, s[48:51], s27 offen offset:3072 sc1 lds
  v_max3_f32 v5, v224, v225, v226
  v_add_f32 v227, v227, v220
  v_mfma_f32_16x16x32_bf16 a[116:119], a[184:187], v[188:191], a[116:119]
  s_add_u32 s27, s27, 16384
  v_exp_f32 v222, v142
  v_add_f32 v227, v227, v221
  v_mfma_f32_16x16x32_bf16 a[56:59], a[188:191], v[168:171], a[56:59]
  s_add_u32 s25, s25, 32768
  ds_read_b128 a[156:159], v3 offset:15360
  v_cvt_pk_bf16_f32 v182, v220, v221
  v_add_f32 v227, v227, v222
  v_mfma_f32_16x16x32_bf16 a[60:63], a[188:191], v[172:175], a[60:63]
  s_and_b32 s25, s25, 0x1ffff
  v_exp_f32 v223, v143
  v_mfma_f32_16x16x32_bf16 a[120:123], a[188:191], v[184:187], a[120:123]
  s_waitcnt lgkmcnt(4)
  v_add_f32 v227, v227, v223
  v_cvt_pk_bf16_f32 v183, v222, v223
  v_max_f32 v5, v5, v227
  v_cmp_lt_f32 vcc, s81, v5
  v_mfma_f32_16x16x32_bf16 a[124:127], a[188:191], v[188:191], a[124:127]
  s_cbranch_vccnz fa_stub5
fa_back5:
  v_add_f32 v228, v228, v224
  v_add_f32 v229, v229, v225
  v_add_f32 v230, v230, v226
  v_add_f32 v231, v231, v227
  v_add_u32 v3, 32768, v3
  v_and_b32 v3, 0x1ffff, v3
fa_AV:
  v_mfma_f32_16x16x32_bf16 v[128:131], a[128:131], v[64:67], v[200:203]
  s_waitcnt vmcnt(12)
  v_exp_f32 v216, v144
  v_mfma_f32_16x16x32_bf16 v[136:139], a[128:131], v[68:71], v[204:207]
  s_barrier
  v_exp_f32 v217, v145
  v_mfma_f32_16x16x32_bf16 v[132:135], a[132:135], v[64:67], v[200:203]
  ds_read_b128 a[160:163], v3 offset:16384
  ds_read_b128 a[164:167], v3 offset:17408
  v_mfma_f32_16x16x32_bf16 v[140:143], a[132:135], v[68:71], v[204:207]
  v_exp_f32 v218, v146
  v_mfma_f32_16x16x32_bf16 v[128:131], a[136:139], v[72:75], v[128:131]
  ds_read_b128 a[168:171], v3 offset:18432
  v_add_f32 v226, v216, v217
  v_mfma_f32_16x16x32_bf16 v[136:139], a[136:139], v[76:79], v[136:139]
  s_mov_b32 m0, s24
  v_exp_f32 v219, v147
  v_mfma_f32_16x16x32_bf16 v[132:135], a[140:143], v[72:75], v[132:135]
  ds_read_b128 a[172:175], v3 offset:19456
  buffer_load_dwordx4 v2, s[44:47], s26 offen offset:0 sc1 lds
  v_mfma_f32_16x16x32_bf16 v[140:143], a[140:143], v[76:79], v[140:143]
  s_waitcnt lgkmcnt(4)
  v_exp_f32 v220, v148
  v_mfma_f32_16x16x32_bf16 v[128:131], a[144:147], v[80:83], v[128:131]
  ds_read_b128 a[176:179], v3 offset:20480
  v_cvt_pk_bf16_f32 v184, v216, v217
  v_mfma_f32_16x16x32_bf16 v[136:139], a[144:147], v[84:87], v[136:139]
  v_exp_f32 v221, v149
  v_mfma_f32_16x16x32_bf16 v[132:135], a[148:151], v[80:83], v[132:135]
  ds_read_b128 a[180:183], v3 offset:21504
  v_add_f32 v226, v226, v218
  v_mfma_f32_16x16x32_bf16 v[140:143], a[148:151], v[84:87], v[140:143]
  v_exp_f32 v222, v150
  v_mfma_f32_16x16x32_bf16 v[128:131], a[152:155], v[88:91], v[128:131]
  ds_read_b128 a[184:187], v3 offset:22528
  v_add_f32 v226, v226, v219
  v_mfma_f32_16x16x32_bf16 v[136:139], a[152:155], v[92:95], v[136:139]
  v_exp_f32 v223, v151
  v_mfma_f32_16x16x32_bf16 v[132:135], a[156:159], v[88:91], v[132:135]
  ds_read_b128 a[188:191], v3 offset:23552
  v_cvt_pk_bf16_f32 v185, v218, v219
  v_mfma_f32_16x16x32_bf16 v[140:143], a[156:159], v[92:95], v[140:143]
  s_waitcnt lgkmcnt(4)
  v_exp_f32 v216, v152
  v_mfma_f32_16x16x32_bf16 a[0:3], a[160:163], v[160:163], a[0:3]
  ds_read_b128 a[128:131], v3 offset:0
  v_add_f32 v226, v226, v220
  v_mfma_f32_16x16x32_bf16 a[4:7], a[160:163], v[164:167], a[4:7]
  v_exp_f32 v217, v153
  v_mfma_f32_16x16x32_bf16 a[64:67], a[160:163], v[176:179], a[64:67]
  buffer_load_dwordx4 v2, s[44:47], s26 offen offset:1024 sc1 lds
  v_add_f32 v226, v226, v221
  v_mfma_f32_16x16x32_bf16 a[68:71], a[160:163], v[180:183], a[68:71]
  v_exp_f32 v218, v154
  v_mfma_f32_16x16x32_bf16 a[8:11], a[164:167], v[160:163], a[8:11]
  ds_read_b128 a[132:135], v3 offset:1024
  v_cvt_pk_bf16_f32 v186, v220, v221
  v_mfma_f32_16x16x32_bf16 a[12:15], a[164:167], v[164:167], a[12:15]
  v_exp_f32 v219, v155
  v_mfma_f32_16x16x32_bf16 a[72:75], a[164:167], v[176:179], a[72:75]
  v_exp_f32 v220, v156
  v_mfma_f32_16x16x32_bf16 a[76:79], a[164:167], v[180:183], a[76:79]
  v_add_f32 v226, v226, v222
  v_add_f32 v226, v226, v223
  v_mfma_f32_16x16x32_bf16 a[16:19], a[168:171], v[160:163], a[16:19]
  ds_read_b128 a[136:139], v3 offset:2048
  v_cvt_pk_bf16_f32 v187, v222, v223
  v_mfma_f32_16x16x32_bf16 a[20:23], a[168:171], v[164:167], a[20:23]
  v_exp_f32 v221, v157
  v_mfma_f32_16x16x32_bf16 a[80:83], a[168:171], v[176:179], a[80:83]
  v_exp_f32 v222, v158
  v_mfma_f32_16x16x32_bf16 a[84:87], a[168:171], v[180:183], a[84:87]
  v_exp_f32 v223, v159
  v_mfma_f32_16x16x32_bf16 a[24:27], a[172:175], v[160:163], a[24:27]
  ds_read_b128 a[140:143], v3 offset:3072
  v_add_f32 v227, v216, v217
  v_mfma_f32_16x16x32_bf16 a[28:31], a[172:175], v[164:167], a[28:31]
  v_cvt_pk_bf16_f32 v188, v216, v217
  v_add_f32 v227, v227, v218
  v_mfma_f32_16x16x32_bf16 a[88:91], a[172:175], v[176:179], a[88:91]
  buffer_load_dwordx4 v2, s[44:47], s26 offen offset:2048 sc1 lds
  v_add_f32 v227, v227, v219
  v_mfma_f32_16x16x32_bf16 a[92:95], a[172:175], v[180:183], a[92:95]
  s_waitcnt lgkmcnt(4)
  v_cvt_pk_bf16_f32 v189, v218, v219
  v_add_f32 v227, v227, v220
  v_mfma_f32_16x16x32_bf16 a[32:35], a[176:179], v[160:163], a[32:35]
  ds_read_b128 a[144:147], v3 offset:4096
  v_add_f32 v227, v227, v221
  v_mfma_f32_16x16x32_bf16 a[36:39], a[176:179], v[164:167], a[36:39]
  v_cvt_pk_bf16_f32 v190, v220, v221
  v_add_f32 v227, v227, v222
  v_mfma_f32_16x16x32_bf16 a[96:99], a[176:179], v[176:179], a[96:99]
  v_add_f32 v227, v227, v223
  v_cvt_pk_bf16_f32 v191, v222, v223
  v_mfma_f32_16x16x32_bf16 a[100:103], a[176:179], v[180:183], a[100:103]
  v_max_f32 v5, v226, v227
  v_cmp_lt_f32 vcc, s81, v5
  v_mfma_f32_16x16x32_bf16 a[40:43], a[180:183], v[160:163], a[40:43]
  ds_read_b128 a[148:151], v3 offset:5120
  v_mfma_f32_16x16x32_bf16 a[44:47], a[180:183], v[164:167], a[44:47]
  v_mfma_f32_16x16x32_bf16 a[104:107], a[180:183], v[176:179], a[104:107]
  v_mfma_f32_16x16x32_bf16 a[108:111], a[180:183], v[180:183], a[108:111]
  v_mfma_f32_16x16x32_bf16 a[48:51], a[184:187], v[160:163], a[48:51]
  ds_read_b128 a[152:155], v3 offset:6144
  v_mfma_f32_16x16x32_bf16 a[52:55], a[184:187], v[164:167], a[52:55]
  v_mfma_f32_16x16x32_bf16 a[112:115], a[184:187], v[176:179], a[112:115]
  buffer_load_dwordx4 v2, s[44:47], s26 offen offset:3072 sc1 lds
  v_mfma_f32_16x16x32_bf16 a[116:119], a[184:187], v[180:183], a[116:119]
  s_add_u32 s26, s26, 16384
  v_mfma_f32_16x16x32_bf16 a[56:59], a[188:191], v[160:163], a[56:59]
  s_add_u32 s24, s24, 32768
  ds_read_b128 a[156:159], v3 offset:7168
  v_mfma_f32_16x16x32_bf16 a[60:63], a[188:191], v[164:167], a[60:63]
  s_and_b32 s24, s24, 0x1ffff
  v_mfma_f32_16x16x32_bf16 a[120:123], a[188:191], v[176:179], a[120:123]
  s_waitcnt lgkmcnt(4)
  v_mfma_f32_16x16x32_bf16 a[124:127], a[188:191], v[180:183], a[124:127]
  s_cbranch_vccnz fa_stub6
fa_back6:
  v_add_f32 v230, v230, v226
  v_add_f32 v231, v231, v227
  v_mfma_f32_16x16x32_bf16 v[144:147], a[128:131], v[64:67], v[200:203]
  ds_read_b128 a[160:163], v3 offset:24576
  v_exp_f32 v216, v128
  v_mfma_f32_16x16x32_bf16 v[152:155], a[128:131], v[68:71], v[204:207]
  v_exp_f32 v217, v129
  v_mfma_f32_16x16x32_bf16 v[148:151], a[132:135], v[64:67], v[200:203]
  ds_read_b128 a[164:167], v3 offset:25600
  v_add_f32 v226, v216, v217
  v_mfma_f32_16x16x32_bf16 v[156:159], a[132:135], v[68:71], v[204:207]
  s_mov_b32 m0, s25
  v_exp_f32 v218, v130
  v_cvt_pk_bf16_f32 v176, v216, v217
  v_mfma_f32_16x16x32_bf16 v[144:147], a[136:139], v[72:75], v[144:147]
  ds_read_b128 a[168:171], v3 offset:26624
  buffer_load_dwordx4 v2, s[48:51], s27 offen offset:0 sc1 lds
  v_mfma_f32_16x16x32_bf16 v[152:155], a[136:139], v[76:79], v[152:155]
  v_exp_f32 v219, v131
  v_add_f32 v226, v226, v218
  v_mfma_f32_16x16x32_bf16 v[148:151], a[140:143], v[72:75], v[148:151]
  ds_read_b128 a[172:175], v3 offset:27648
  v_add_f32 v226, v226, v219
  v_mfma_f32_16x16x32_bf16 v[156:159], a[140:143], v[76:79], v[156:159]
  s_waitcnt lgkmcnt(4)
  v_exp_f32 v220, v132
  v_cvt_pk_bf16_f32 v177, v218, v219
  v_mfma_f32_16x16x32_bf16 v[144:147], a[144:147], v[80:83], v[144:147]
  ds_read_b128 a[176:179], v3 offset:28672
  v_add_f32 v226, v226, v220
  v_mfma_f32_16x16x32_bf16 v[152:155], a[144:147], v[84:87], v[152:155]
  v_exp_f32 v221, v133
  v_exp_f32 v222, v134
  v_mfma_f32_16x16x32_bf16 v[148:151], a[148:151], v[80:83], v[148:151]
  ds_read_b128 a[180:183], v3 offset:29696
  buffer_load_dwordx4 v2, s[48:51], s27 offen offset:1024 sc1 lds
  v_mfma_f32_16x16x32_bf16 v[156:159], a[148:151], v[84:87], v[156:159]
  v_exp_f32 v223, v135
  v_mfma_f32_16x16x32_bf16 v[144:147], a[152:155], v[88:91], v[144:147]
  ds_read_b128 a[184:187], v3 offset:30720
  v_add_f32 v226, v226, v221
  v_mfma_f32_16x16x32_bf16 v[152:155], a[152:155], v[92:95], v[152:155]
  v_exp_f32 v216, v136
  v_mfma_f32_16x16x32_bf16 v[148:151], a[156:159], v[88:91], v[148:151]
  ds_read_b128 a[188:191], v3 offset:31744
  v_cvt_pk_bf16_f32 v178, v220, v221
  v_add_f32 v226, v226, v222
  v_mfma_f32_16x16x32_bf16 v[156:159], a[156:159], v[92:95], v[156:159]
  s_waitcnt lgkmcnt(4)
  v_exp_f32 v217, v137
  v_mfma_f32_16x16x32_bf16 a[64:67], a[160:163], v[184:187], a[64:67]
  ds_read_b128 a[128:131], v3 offset:8192
  v_add_f32 v226, v226, v223
  v_cvt_pk_bf16_f32 v179, v222, v223
  v_mfma_f32_16x16x32_bf16 a[68:71], a[160:163], v[188:191], a[68:71]
  v_exp_f32 v218, v138
  v_mfma_f32_16x16x32_bf16 a[72:75], a[164:167], v[184:187], a[72:75]
  ds_read_b128 a[132:135], v3 offset:9216
  buffer_load_dwordx4 v2, s[48:51], s27 offen offset:2048 sc1 lds
  v_add_f32 v227, v216, v217
  v_mfma_f32_16x16x32_bf16 a[76:79], a[164:167], v[188:191], a[76:79]
  v_exp_f32 v219, v139
  v_mfma_f32_16x16x32_bf16 a[80:83], a[168:171], v[184:187], a[80:83]
  ds_read_b128 a[136:139], v3 offset:10240
  v_cvt_pk_bf16_f32 v180, v216, v217
  v_mfma_f32_16x16x32_bf16 a[84:87], a[168:171], v[188:191], a[84:87]
  v_exp_f32 v220, v140
  v_add_f32 v227, v227, v218
  v_mfma_f32_16x16x32_bf16 a[88:91], a[172:175], v[184:187], a[88:91]
  ds_read_b128 a[140:143], v3 offset:11264
  v_add_f32 v227, v227, v219
  v_mfma_f32_16x16x32_bf16 a[92:95], a[172:175], v[188:191], a[92:95]
  s_waitcnt lgkmcnt(4)
  v_exp_f32 v221, v141
  v_cvt_pk_bf16_f32 v181, v218, v219
  v_mfma_f32_16x16x32_bf16 a[96:99], a[176:179], v[184:187], a[96:99]
  ds_read_b128 a[144:147], v3 offset:12288
  buffer_load_dwordx4 v2, s[48:51], s27 offen offset:3072 sc1 lds
  v_mfma_f32_16x16x32_bf16 a[100:103], a[176:179], v[188:191], a[100:103]
  s_add_u32 s27, s27, 16384
  v_exp_f32 v222, v142
  v_add_f32 v227, v227, v220
  v_mfma_f32_16x16x32_bf16 a[104:107], a[180:183], v[184:187], a[104:107]
  s_add_u32 s25, s25, 32768
  ds_read_b128 a[148:151], v3 offset:13312
  v_add_f32 v227, v227, v221
  v_mfma_f32_16x16x32_bf16 a[108:111], a[180:183], v[188:191], a[108:111]
  s_and_b32 s25, s25, 0x1ffff
  v_exp_f32 v223, v143
  v_cvt_pk_bf16_f32 v182, v220, v221
  v_mfma_f32_16x16x32_bf16 a[112:115], a[184:187], v[184:187], a[112:115]
  ds_read_b128 a[152:155], v3 offset:14336
  v_add_f32 v227, v227, v222
  v_mfma_f32_16x16x32_bf16 a[116:119], a[184:187], v[188:191], a[116:119]
  v_add_f32 v227, v227, v223
  v_cvt_pk_bf16_f32 v183, v222, v223
  v_max_f32 v5, v226, v227
  v_mfma_f32_16x16x32_bf16 a[120:123], a[188:191], v[184:187], a[120:123]
  s_waitcnt lgkmcnt(3)
  ds_read_b128 a[156:159], v3 offset:15360
  v_cmp_lt_f32 vcc, s81, v5
  v_mfma_f32_16x16x32_bf16 a[124:127], a[188:191], v[188:191], a[124:127]
  s_cbranch_vccnz fa_stub7
fa_back7:
  v_add_f32 v230, v230, v226
  v_add_f32 v231, v231, v227
  v_add_u32 v3, 32768, v3
  v_and_b32 v3, 0x1ffff, v3
  s_branch fa_SSpre
fa_Aodd:
  v_mfma_f32_16x16x32_bf16 v[128:131], a[128:131], v[64:67], v[200:203]
  s_waitcnt vmcnt(12)
  v_cndmask_b32 v112, v4, v112, s[68:69]
  v_cndmask_b32 v113, v4, v113, s[70:71]
  v_cndmask_b32 v114, v4, v114, s[72:73]
  v_mfma_f32_16x16x32_bf16 v[136:139], a[128:131], v[68:71], v[204:207]
  s_barrier
  v_cndmask_b32 v115, v4, v115, s[74:75]
  v_mov_b32 v116, v4
  v_mov_b32 v117, v4
  v_mfma_f32_16x16x32_bf16 v[132:135], a[132:135], v[64:67], v[200:203]
  ds_read_b128 a[160:163], v3 offset:16384
  ds_read_b128 a[164:167], v3 offset:17408
  v_mov_b32 v118, v4
  v_mfma_f32_16x16x32_bf16 v[140:143], a[132:135], v[68:71], v[204:207]
  v_mov_b32 v119, v4
  v_cndmask_b32 v124, v4, v124, s[68:69]
  v_cndmask_b32 v125, v4, v125, s[70:71]
  v_mfma_f32_16x16x32_bf16 v[128:131], a[136:139], v[72:75], v[128:131]
  ds_read_b128 a[168:171], v3 offset:18432
  v_cndmask_b32 v126, v4, v126, s[72:73]
  v_cndmask_b32 v127, v4, v127, s[74:75]
  v_mfma_f32_16x16x32_bf16 v[136:139], a[136:139], v[76:79], v[136:139]
  s_mov_b32 m0, s24
  v_exp_f32 v208, v112
  v_exp_f32 v209, v113
  v_mfma_f32_16x16x32_bf16 v[132:135], a[140:143], v[72:75], v[132:135]
  ds_read_b128 a[172:175], v3 offset:19456
  buffer_load_dwordx4 v2, s[44:47], s26 offen offset:0 sc1 lds
  v_mfma_f32_16x16x32_bf16 v[140:143], a[140:143], v[76:79], v[140:143]
  s_waitcnt lgkmcnt(4)
  v_exp_f32 v210, v114
  v_add_f32 v224, v208, v209
  v_mfma_f32_16x16x32_bf16 v[128:131], a[144:147], v[80:83], v[128:131]
  ds_read_b128 a[176:179], v3 offset:20480
  v_exp_f32 v211, v115
  v_mfma_f32_16x16x32_bf16 v[136:139], a[144:147], v[84:87], v[136:139]
  v_exp_f32 v212, v116
  v_cvt_pk_bf16_f32 v168, v208, v209
  v_mfma_f32_16x16x32_bf16 v[132:135], a[148:151], v[80:83], v[132:135]
  ds_read_b128 a[180:183], v3 offset:21504
  v_exp_f32 v213, v117
  v_mfma_f32_16x16x32_bf16 v[140:143], a[148:151], v[84:87], v[140:143]
  v_exp_f32 v214, v118
  v_add_f32 v224, v224, v210
  v_add_f32 v224, v224, v211
  v_mfma_f32_16x16x32_bf16 v[128:131], a[152:155], v[88:91], v[128:131]
  ds_read_b128 a[184:187], v3 offset:22528
  v_cvt_pk_bf16_f32 v169, v210, v211
  v_add_f32 v224, v224, v212
  v_mfma_f32_16x16x32_bf16 v[136:139], a[152:155], v[92:95], v[136:139]
  v_exp_f32 v215, v119
  v_add_f32 v224, v224, v213
  v_mfma_f32_16x16x32_bf16 v[132:135], a[156:159], v[88:91], v[132:135]
  ds_read_b128 a[188:191], v3 offset:23552
  v_cvt_pk_bf16_f32 v170, v212, v213
  v_add_f32 v224, v224, v214
  v_mfma_f32_16x16x32_bf16 v[140:143], a[156:159], v[92:95], v[140:143]
  s_waitcnt lgkmcnt(4)
  v_exp_f32 v208, v120
  v_add_f32 v224, v224, v215
  v_mfma_f32_16x16x32_bf16 a[0:3], a[160:163], v[160:163], a[0:3]
  ds_read_b128 a[128:131], v3 offset:0
  v_cvt_pk_bf16_f32 v171, v214, v215
  v_exp_f32 v209, v121
  v_mfma_f32_16x16x32_bf16 a[4:7], a[160:163], v[164:167], a[4:7]
  v_exp_f32 v210, v122
  v_mfma_f32_16x16x32_bf16 a[64:67], a[160:163], v[176:179], a[64:67]
  buffer_load_dwordx4 v2, s[44:47], s26 offen offset:1024 sc1 lds
  v_exp_f32 v211, v123
  v_mfma_f32_16x16x32_bf16 a[68:71], a[160:163], v[180:183], a[68:71]
  v_exp_f32 v212, v124
  v_add_f32 v225, v208, v209
  v_mfma_f32_16x16x32_bf16 a[8:11], a[164:167], v[160:163], a[8:11]
  ds_read_b128 a[132:135], v3 offset:1024
  v_exp_f32 v213, v125
  v_mfma_f32_16x16x32_bf16 a[12:15], a[164:167], v[164:167], a[12:15]
  v_exp_f32 v214, v126
  v_cvt_pk_bf16_f32 v172, v208, v209
  v_mfma_f32_16x16x32_bf16 a[72:75], a[164:167], v[176:179], a[72:75]
  v_exp_f32 v215, v127
  v_add_f32 v225, v225, v210
  v_mfma_f32_16x16x32_bf16 a[76:79], a[164:167], v[180:183], a[76:79]
  v_exp_f32 v216, v144
  v_add_f32 v225, v225, v211
  v_mfma_f32_16x16x32_bf16 a[16:19], a[168:171], v[160:163], a[16:19]
  ds_read_b128 a[136:139], v3 offset:2048
  v_exp_f32 v217, v145
  v_mfma_f32_16x16x32_bf16 a[20:23], a[168:171], v[164:167], a[20:23]
  v_exp_f32 v218, v146
  v_cvt_pk_bf16_f32 v173, v210, v211
  v_mfma_f32_16x16x32_bf16 a[80:83], a[168:171], v[176:179], a[80:83]
  v_exp_f32 v219, v147
  v_add_f32 v225, v225, v212
  v_mfma_f32_16x16x32_bf16 a[84:87], a[168:171], v[180:183], a[84:87]
  v_exp_f32 v220, v148
  v_add_f32 v225, v225, v213
  v_mfma_f32_16x16x32_bf16 a[24:27], a[172:175], v[160:163], a[24:27]
  ds_read_b128 a[140:143], v3 offset:3072
  v_exp_f32 v221, v149
  v_mfma_f32_16x16x32_bf16 a[28:31], a[172:175], v[164:167], a[28:31]
  v_exp_f32 v222, v150
  v_cvt_pk_bf16_f32 v174, v212, v213
  v_mfma_f32_16x16x32_bf16 a[88:91], a[172:175], v[176:179], a[88:91]
  buffer_load_dwordx4 v2, s[44:47], s26 offen offset:2048 sc1 lds
  v_exp_f32 v223, v151
  v_mfma_f32_16x16x32_bf16 a[92:95], a[172:175], v[180:183], a[92:95]
  s_waitcnt lgkmcnt(4)
  v_add_f32 v225, v225, v214
  v_add_f32 v225, v225, v215
  v_cvt_pk_bf16_f32 v175, v214, v215
  v_mfma_f32_16x16x32_bf16 a[32:35], a[176:179], v[160:163], a[32:35]
  ds_read_b128 a[144:147], v3 offset:4096
  v_add_f32 v226, v216, v217
  v_cvt_pk_bf16_f32 v184, v216, v217
  v_mfma_f32_16x16x32_bf16 a[36:39], a[176:179], v[164:167], a[36:39]
  v_exp_f32 v216, v152
  v_add_f32 v226, v226, v218
  v_mfma_f32_16x16x32_bf16 a[96:99], a[176:179], v[176:179], a[96:99]
  v_exp_f32 v217, v153
  v_add_f32 v226, v226, v219
  v_mfma_f32_16x16x32_bf16 a[100:103], a[176:179], v[180:183], a[100:103]
  v_cvt_pk_bf16_f32 v185, v218, v219
  v_add_f32 v226, v226, v220
  v_add_f32 v226, v226, v221
  v_cvt_pk_bf16_f32 v186, v220, v221
  v_mfma_f32_16x16x32_bf16 a[40:43], a[180:183], v[160:163], a[40:43]
  ds_read_b128 a[148:151], v3 offset:5120
  v_add_f32 v226, v226, v222
  v_add_f32 v226, v226, v223
  v_mfma_f32_16x16x32_bf16 a[44:47], a[180:183], v[164:167], a[44:47]
  v_exp_f32 v218, v154
  v_cvt_pk_bf16_f32 v187, v222, v223
  v_mfma_f32_16x16x32_bf16 a[104:107], a[180:183], v[176:179], a[104:107]
  v_exp_f32 v219, v155
  v_add_f32 v227, v216, v217
  v_mfma_f32_16x16x32_bf16 a[108:111], a[180:183], v[180:183], a[108:111]
  v_exp_f32 v220, v156
  v_cvt_pk_bf16_f32 v188, v216, v217
  v_mfma_f32_16x16x32_bf16 a[48:51], a[184:187], v[160:163], a[48:51]
  ds_read_b128 a[152:155], v3 offset:6144
  v_add_f32 v227, v227, v218
  v_add_f32 v227, v227, v219
  v_mfma_f32_16x16x32_bf16 a[52:55], a[184:187], v[164:167], a[52:55]
  v_exp_f32 v221, v157
  v_cvt_pk_bf16_f32 v189, v218, v219
  v_mfma_f32_16x16x32_bf16 a[112:115], a[184:187], v[176:179], a[112:115]
  buffer_load_dwordx4 v2, s[44:47], s26 offen offset:3072 sc1 lds
  v_max3_f32 v5, v224, v225, v226
  v_add_f32 v227, v227, v220
  v_mfma_f32_16x16x32_bf16 a[116:119], a[184:187], v[180:183], a[116:119]
  s_add_u32 s26, s26, 16384
  v_exp_f32 v222, v158
  v_add_f32 v227, v227, v221
  v_mfma_f32_16x16x32_bf16 a[56:59], a[188:191], v[160:163], a[56:59]
  s_add_u32 s24, s24, 32768
  ds_read_b128 a[156:159], v3 offset:7168
  v_cvt_pk_bf16_f32 v190, v220, v221
  v_add_f32 v227, v227, v222
  v_mfma_f32_16x16x32_bf16 a[60:63], a[188:191], v[164:167], a[60:63]
  s_and_b32 s24, s24, 0x1ffff
  v_exp_f32 v223, v159
  v_mfma_f32_16x16x32_bf16 a[120:123], a[188:191], v[176:179], a[120:123]
  s_waitcnt lgkmcnt(4)
  v_add_f32 v227, v227, v223
  v_cvt_pk_bf16_f32 v191, v222, v223
  v_max_f32 v5, v5, v227
  v_cmp_lt_f32 vcc, s81, v5
  v_mfma_f32_16x16x32_bf16 a[124:127], a[188:191], v[180:183], a[124:127]
  s_cbranch_vccnz fa_stub8
fa_back8:
  v_add_f32 v228, v228, v224
  v_add_f32 v229, v229, v225
  v_add_f32 v230, v230, v226
  v_add_f32 v231, v231, v227
  v_mfma_f32_16x16x32_bf16 v[144:147], a[128:131], v[64:67], v[200:203]
  ds_read_b128 a[160:163], v3 offset:24576
  v_exp_f32 v216, v128
  v_mfma_f32_16x16x32_bf16 v[152:155], a[128:131], v[68:71], v[204:207]
  v_exp_f32 v217, v129
  v_mfma_f32_16x16x32_bf16 v[148:151], a[132:135], v[64:67], v[200:203]
  ds_read_b128 a[164:167], v3 offset:25600
  v_mfma_f32_16x16x32_bf16 v[156:159], a[132:135], v[68:71], v[204:207]
  v_exp_f32 v218, v130
  v_mfma_f32_16x16x32_bf16 v[144:147], a[136:139], v[72:75], v[144:147]
  ds_read_b128 a[168:171], v3 offset:26624
  v_add_f32 v226, v216, v217
  v_mfma_f32_16x16x32_bf16 v[152:155], a[136:139], v[76:79], v[152:155]
  s_mov_b32 m0, s25
  v_exp_f32 v219, v131
  v_mfma_f32_16x16x32_bf16 v[148:151], a[140:143], v[72:75], v[148:151]
  ds_read_b128 a[172:175], v3 offset:27648
  buffer_load_dwordx4 v2, s[48:51], s27 offen offset:0 sc1 lds
  v_mfma_f32_16x16x32_bf16 v[156:159], a[140:143], v[76:79], v[156:159]
  s_waitcnt lgkmcnt(4)
  v_exp_f32 v220, v132
  v_mfma_f32_16x16x32_bf16 v[144:147], a[144:147], v[80:83], v[144:147]
  ds_read_b128 a[176:179], v3 offset:28672
  v_cvt_pk_bf16_f32 v176, v216, v217
  v_mfma_f32_16x16x32_bf16 v[152:155], a[144:147], v[84:87], v[152:155]
  v_exp_f32 v221, v133
  v_mfma_f32_16x16x32_bf16 v[148:151], a[148:151], v[80:83], v[148:151]
  ds_read_b128 a[180:183], v3 offset:29696
  v_add_f32 v226, v226, v218
  v_mfma_f32_16x16x32_bf16 v[156:159], a[148:151], v[84:87], v[156:159]
  v_exp_f32 v222, v134
  v_mfma_f32_16x16x32_bf16 v[144:147], a[152:155], v[88:91], v[144:147]
  ds_read_b128 a[184:187], v3 offset:30720
  v_add_f32 v226, v226, v219
  v_mfma_f32_16x16x32_bf16 v[152:155], a[152:155], v[92:95], v[152:155]
  v_exp_f32 v223, v135
  v_mfma_f32_16x16x32_bf16 v[148:151], a[156:159], v[88:91], v[148:151]
  ds_read_b128 a[188:191], v3 offset:31744
  v_cvt_pk_bf16_f32 v177, v218, v219
  v_mfma_f32_16x16x32_bf16 v[156:159], a[156:159], v[92:95], v[156:159]
  s_waitcnt lgkmcnt(4)
  v_exp_f32 v216, v136
  v_mfma_f32_16x16x32_bf16 a[0:3], a[160:163], v[168:171], a[0:3]
  ds_read_b128 a[128:131], v3 offset:8192
  v_add_f32 v226, v226, v220
  v_mfma_f32_16x16x32_bf16 a[4:7], a[160:163], v[172:175], a[4:7]
  v_exp_f32 v217, v137
  v_mfma_f32_16x16x32_bf16 a[64:67], a[160:163], v[184:187], a[64:67]
  buffer_load_dwordx4 v2, s[48:51], s27 offen offset:1024 sc1 lds
  v_add_f32 v226, v226, v221
  v_mfma_f32_16x16x32_bf16 a[68:71], a[160:163], v[188:191], a[68:71]
  v_exp_f32 v218, v138
  v_mfma_f32_16x16x32_bf16 a[8:11], a[164:167], v[168:171], a[8:11]
  ds_read_b128 a[132:135], v3 offset:9216
  v_cvt_pk_bf16_f32 v178, v220, v221
  v_mfma_f32_16x16x32_bf16 a[12:15], a[164:167], v[172:175], a[12:15]
  v_exp_f32 v219, v139
  v_mfma_f32_16x16x32_bf16 a[72:75], a[164:167], v[184:187], a[72:75]
  v_exp_f32 v220, v140
  v_mfma_f32_16x16x32_bf16 a[76:79], a[164:167], v[188:191], a[76:79]
  v_add_f32 v226, v226, v222
  v_add_f32 v226, v226, v223
  v_mfma_f32_16x16x32_bf16 a[16:19], a[168:171], v[168:171], a[16:19]
  ds_read_b128 a[136:139], v3 offset:10240
  v_cvt_pk_bf16_f32 v179, v222, v223
  v_mfma_f32_16x16x32_bf16 a[20:23], a[168:171], v[172:175], a[20:23]
  v_exp_f32 v221, v141
  v_mfma_f32_16x16x32_bf16 a[80:83], a[168:171], v[184:187], a[80:83]
  v_exp_f32 v222, v142
  v_mfma_f32_16x16x32_bf16 a[84:87], a[168:171], v[188:191], a[84:87]
  v_exp_f32 v223, v143
  v_mfma_f32_16x16x32_bf16 a[24:27], a[172:175], v[168:171], a[24:27]
  ds_read_b128 a[140:143], v3 offset:11264
  v_add_f32 v227, v216, v217
  v_mfma_f32_16x16x32_bf16 a[28:31], a[172:175], v[172:175], a[28:31]
  v_cvt_pk_bf16_f32 v180, v216, v217
  v_add_f32 v227, v227, v218
  v_mfma_f32_16x16x32_bf16 a[88:91], a[172:175], v[184:187], a[88:91]
  buffer_load_dwordx4 v2, s[48:51], s27 offen offset:2048 sc1 lds
  v_add_f32 v227, v227, v219
  v_mfma_f32_16x16x32_bf16 a[92:95], a[172:175], v[188:191], a[92:95]
  s_waitcnt lgkmcnt(4)
  v_cvt_pk_bf16_f32 v181, v218, v219
  v_add_f32 v227, v227, v220
  v_mfma_f32_16x16x32_bf16 a[32:35], a[176:179], v[168:171], a[32:35]
  ds_read_b128 a[144:147], v3 offset:12288
  v_add_f32 v227, v227, v221
  v_mfma_f32_16x16x32_bf16 a[36:39], a[176:179], v[172:175], a[36:39]
  v_cvt_pk_bf16_f32 v182, v220, v221
  v_add_f32 v227, v227, v222
  v_mfma_f32_16x16x32_bf16 a[96:99], a[176:179], v[184:187], a[96:99]
  v_add_f32 v227, v227, v223
  v_cvt_pk_bf16_f32 v183, v222, v223
  v_mfma_f32_16x16x32_bf16 a[100:103], a[176:179], v[188:191], a[100:103]
  v_max_f32 v5, v226, v227
  v_cmp_lt_f32 vcc, s81, v5
  v_mfma_f32_16x16x32_bf16 a[40:43], a[180:183], v[168:171], a[40:43]
  ds_read_b128 a[148:151], v3 offset:13312
  v_mfma_f32_16x16x32_bf16 a[44:47], a[180:183], v[172:175], a[44:47]
  v_mfma_f32_16x16x32_bf16 a[104:107], a[180:183], v[184:187], a[104:107]
  v_mfma_f32_16x16x32_bf16 a[108:111], a[180:183], v[188:191], a[108:111]
  v_mfma_f32_16x16x32_bf16 a[48:51], a[184:187], v[168:171], a[48:51]
  ds_read_b128 a[152:155], v3 offset:14336
  v_mfma_f32_16x16x32_bf16 a[52:55], a[184:187], v[172:175], a[52:55]
  v_mfma_f32_16x16x32_bf16 a[112:115], a[184:187], v[184:187], a[112:115]
  buffer_load_dwordx4 v2, s[48:51], s27 offen offset:3072 sc1 lds
  v_mfma_f32_16x16x32_bf16 a[116:119], a[184:187], v[188:191], a[116:119]
  s_add_u32 s27, s27, 16384
  v_mfma_f32_16x16x32_bf16 a[56:59], a[188:191], v[168:171], a[56:59]
  s_add_u32 s25, s25, 32768
  ds_read_b128 a[156:159], v3 offset:15360
  v_mfma_f32_16x16x32_bf16 a[60:63], a[188:191], v[172:175], a[60:63]
  s_and_b32 s25, s25, 0x1ffff
  v_mfma_f32_16x16x32_bf16 a[120:123], a[188:191], v[184:187], a[120:123]
  s_waitcnt lgkmcnt(4)
  v_mfma_f32_16x16x32_bf16 a[124:127], a[188:191], v[188:191], a[124:127]
  s_cbranch_vccnz fa_stub9
fa_back9:
  v_add_f32 v230, v230, v226
  v_add_f32 v231, v231, v227
  v_add_u32 v3, 32768, v3
  v_and_b32 v3, 0x1ffff, v3
fa_SSpre:
  s_mov_b32 s11, 1
  s_cmp_lg_u32 s12, 0
  s_cselect_b32 s32, s15, s32
  s_cmp_ge_u32 s20, 2
  s_cselect_b32 s23, 8, 0
  s_cmp_le_u32 s29, s23
  s_cbranch_scc1 fa_chain
.p2align 6
fa_SS:
  v_mfma_f32_16x16x32_bf16 v[128:131], a[128:131], v[64:67], v[200:203]
  s_waitcnt vmcnt(12)
  v_exp_f32 v216, v144
  v_mfma_f32_16x16x32_bf16 v[136:139], a[128:131], v[68:71], v[204:207]
  s_barrier
  v_exp_f32 v217, v145
  v_exp_f32 v218, v146
  v_mfma_f32_16x16x32_bf16 v[132:135], a[132:135], v[64:67], v[200:203]
  s_cmp_ge_u32 s26, s32
  ds_read_b128 a[160:163], v3 offset:16384
  ds_read_b128 a[164:167], v3 offset:17408
  v_mfma_f32_16x16x32_bf16 v[140:143], a[132:135], v[68:71], v[204:207]
  s_cbranch_scc1 fa_hk7
fa_hb7:
  s_mov_b32 m0, s24
  v_exp_f32 v219, v147
  v_mfma_f32_16x16x32_bf16 v[128:131], a[136:139], v[72:75], v[128:131]
  ds_read_b128 a[168:171], v3 offset:18432
  buffer_load_dwordx4 v2, s[44:47], s26 offen offset:0 sc1 lds
  v_mfma_f32_16x16x32_bf16 v[136:139], a[136:139], v[76:79], v[136:139]
  v_exp_f32 v220, v148
  v_add_f32 v226, v216, v217
  v_mfma_f32_16x16x32_bf16 v[132:135], a[140:143], v[72:75], v[132:135]
  ds_read_b128 a[172:175], v3 offset:19456
  v_cvt_pk_bf16_f32 v184, v216, v217
  v_mfma_f32_16x16x32_bf16 v[140:143], a[140:143], v[76:79], v[140:143]
  s_waitcnt lgkmcnt(4)
  v_exp_f32 v221, v149
  v_add_f32 v226, v226, v218
  v_mfma_f32_16x16x32_bf16 v[128:131], a[144:147], v[80:83], v[128:131]
  ds_read_b128 a[176:179], v3 offset:20480
  v_add_f32 v226, v226, v219
  v_mfma_f32_16x16x32_bf16 v[136:139], a[144:147], v[84:87], v[136:139]
  v_exp_f32 v222, v150
  v_cvt_pk_bf16_f32 v185, v218, v219
  v_mfma_f32_16x16x32_bf16 v[132:135], a[148:151], v[80:83], v[132:135]
  ds_read_b128 a[180:183], v3 offset:21504
  buffer_load_dwordx4 v2, s[44:47], s26 offen offset:1024 sc1 lds
  v_mfma_f32_16x16x32_bf16 v[140:143], a[148:151], v[84:87], v[140:143]
  v_exp_f32 v223, v151
  v_mfma_f32_16x16x32_bf16 v[128:131], a[152:155], v[88:91], v[128:131]
  ds_read_b128 a[184:187], v3 offset:22528
  v_add_f32 v226, v226, v220
  v_add_f32 v226, v226, v221
  v_mfma_f32_16x16x32_bf16 v[136:139], a[152:155], v[92:95], v[136:139]
  v_exp_f32 v216, v152
  v_mfma_f32_16x16x32_bf16 v[132:135], a[156:159], v[88:91], v[132:135]
  ds_read_b128 a[188:191], v3 offset:23552
  v_cvt_pk_bf16_f32 v186, v220, v221
  v_add_f32 v226, v226, v222
  v_mfma_f32_16x16x32_bf16 v[140:143], a[156:159], v[92:95], v[140:143]
  s_waitcnt lgkmcnt(4)
  v_exp_f32 v217, v153
  v_mfma_f32_16x16x32_bf16 a[64:67], a[160:163], v[176:179], a[64:67]
  ds_read_b128 a[128:131], v3 offset:0
  v_add_f32 v226, v226, v223
  v_cvt_pk_bf16_f32 v187, v222, v223
  v_mfma_f32_16x16x32_bf16 a[68:71], a[160:163], v[180:183], a[68:71]
  v_exp_f32 v218, v154
  v_mfma_f32_16x16x32_bf16 a[72:75], a[164:167], v[176:179], a[72:75]
  ds_read_b128 a[132:135], v3 offset:1024
  buffer_load_dwordx4 v2, s[44:47], s26 offen offset:2048 sc1 lds
  v_add_f32 v227, v216, v217
  v_mfma_f32_16x16x32_bf16 a[76:79], a[164:167], v[180:183], a[76:79]
  v_exp_f32 v219, v155
  v_mfma_f32_16x16x32_bf16 a[80:83], a[168:171], v[176:179], a[80:83]
  ds_read_b128 a[136:139], v3 offset:2048
  v_cvt_pk_bf16_f32 v188, v216, v217
  v_mfma_f32_16x16x32_bf16 a[84:87], a[168:171], v[180:183], a[84:87]
  v_exp_f32 v220, v156
  v_add_f32 v227, v227, v218
  v_mfma_f32_16x16x32_bf16 a[88:91], a[172:175], v[176:179], a[88:91]
  ds_read_b128 a[140:143], v3 offset:3072
  v_add_f32 v227, v227, v219
  v_mfma_f32_16x16x32_bf16 a[92:95], a[172:175], v[180:183], a[92:95]
  s_waitcnt lgkmcnt(4)
  v_exp_f32 v221, v157
  v_cvt_pk_bf16_f32 v189, v218, v219
  v_mfma_f32_16x16x32_bf16 a[96:99], a[176:179], v[176:179], a[96:99]
  ds_read_b128 a[144:147], v3 offset:4096
  buffer_load_dwordx4 v2, s[44:47], s26 offen offset:3072 sc1 lds
  v_mfma_f32_16x16x32_bf16 a[100:103], a[176:179], v[180:183], a[100:103]
  s_add_u32 s26, s26, 16384
  v_exp_f32 v222, v158
  v_add_f32 v227, v227, v220
  v_mfma_f32_16x16x32_bf16 a[104:107], a[180:183], v[176:179], a[104:107]
  s_add_u32 s24, s24, 32768
  ds_read_b128 a[148:151], v3 offset:5120
  v_add_f32 v227, v227, v221
  v_mfma_f32_16x16x32_bf16 a[108:111], a[180:183], v[180:183], a[108:111]
  s_and_b32 s24, s24, 0x1ffff
  v_exp_f32 v223, v159
  v_cvt_pk_bf16_f32 v190, v220, v221
  v_mfma_f32_16x16x32_bf16 a[112:115], a[184:187], v[176:179], a[112:115]
  ds_read_b128 a[152:155], v3 offset:6144
  v_add_f32 v227, v227, v222
  v_mfma_f32_16x16x32_bf16 a[116:119], a[184:187], v[180:183], a[116:119]
  v_add_f32 v227, v227, v223
  v_cvt_pk_bf16_f32 v191, v222, v223
  v_max_f32 v5, v226, v227
  v_mfma_f32_16x16x32_bf16 a[120:123], a[188:191], v[176:179], a[120:123]
  s_waitcnt lgkmcnt(3)
  ds_read_b128 a[156:159], v3 offset:7168
  v_cmp_lt_f32 vcc, s81, v5
  v_mfma_f32_16x16x32_bf16 a[124:127], a[188:191], v[180:183], a[124:127]
  s_cbranch_vccnz fa_stub10
fa_back10:
  v_add_f32 v230, v230, v226
  v_add_f32 v231, v231, v227
  v_mfma_f32_16x16x32_bf16 v[144:147], a[128:131], v[64:67], v[200:203]
  ds_read_b128 a[160:163], v3 offset:24576
  v_exp_f32 v216, v128
  v_mfma_f32_16x16x32_bf16 v[152:155], a[128:131], v[68:71], v[204:207]
  v_exp_f32 v217, v129
  v_mfma_f32_16x16x32_bf16 v[148:151], a[132:135], v[64:67], v[200:203]
  ds_read_b128 a[164:167], v3 offset:25600
  v_add_f32 v226, v216, v217
  v_mfma_f32_16x16x32_bf16 v[156:159], a[132:135], v[68:71], v[204:207]
  s_mov_b32 m0, s25
  v_exp_f32 v218, v130
  v_cvt_pk_bf16_f32 v176, v216, v217
  v_mfma_f32_16x16x32_bf16 v[144:147], a[136:139], v[72:75], v[144:147]
  ds_read_b128 a[168:171], v3 offset:26624
  buffer_load_dwordx4 v2, s[48:51], s27 offen offset:0 sc1 lds
  v_mfma_f32_16x16x32_bf16 v[152:155], a[136:139], v[76:79], v[152:155]
  v_exp_f32 v219, v131
  v_add_f32 v226, v226, v218
  v_mfma_f32_16x16x32_bf16 v[148:151], a[140:143], v[72:75], v[148:151]
  ds_read_b128 a[172:175], v3 offset:27648
  v_add_f32 v226, v226, v219
  v_mfma_f32_16x16x32_bf16 v[156:159], a[140:143], v[76:79], v[156:159]
  s_waitcnt lgkmcnt(4)
  v_exp_f32 v220, v132
  v_cvt_pk_bf16_f32 v177, v218, v219
  v_mfma_f32_16x16x32_bf16 v[144:147], a[144:147], v[80:83], v[144:147]
  ds_read_b128 a[176:179], v3 offset:28672
  v_add_f32 v226, v226, v220
  v_mfma_f32_16x16x32_bf16 v[152:155], a[144:147], v[84:87], v[152:155]
  v_exp_f32 v221, v133
  v_exp_f32 v222, v134
  v_mfma_f32_16x16x32_bf16 v[148:151], a[148:151], v[80:83], v[148:151]
  ds_read_b128 a[180:183], v3 offset:29696
  buffer_load_dwordx4 v2, s[48:51], s27 offen offset:1024 sc1 lds
  v_mfma_f32_16x16x32_bf16 v[156:159], a[148:151], v[84:87], v[156:159]
  v_exp_f32 v223, v135
  v_mfma_f32_16x16x32_bf16 v[144:147], a[152:155], v[88:91], v[144:147]
  ds_read_b128 a[184:187], v3 offset:30720
  v_add_f32 v226, v226, v221
  v_mfma_f32_16x16x32_bf16 v[152:155], a[152:155], v[92:95], v[152:155]
  v_exp_f32 v216, v136
  v_mfma_f32_16x16x32_bf16 v[148:151], a[156:159], v[88:91], v[148:151]
  ds_read_b128 a[188:191], v3 offset:31744
  v_cvt_pk_bf16_f32 v178, v220, v221
  v_add_f32 v226, v226, v222
  v_mfma_f32_16x16x32_bf16 v[156:159], a[156:159], v[92:95], v[156:159]
  s_waitcnt lgkmcnt(4)
  v_exp_f32 v217, v137
  v_mfma_f32_16x16x32_bf16 a[64:67], a[160:163], v[184:187], a[64:67]
  ds_read_b128 a[128:131], v3 offset:8192
  v_add_f32 v226, v226, v223
  v_cvt_pk_bf16_f32 v179, v222, v223
  v_mfma_f32_16x16x32_bf16 a[68:71], a[160:163], v[188:191], a[68:71]
  v_exp_f32 v218, v138
  v_mfma_f32_16x16x32_bf16 a[72:75], a[164:167], v[184:187], a[72:75]
  ds_read_b128 a[132:135], v3 offset:9216
  buffer_load_dwordx4 v2, s[48:51], s27 offen offset:2048 sc1 lds
  v_add_f32 v227, v216, v217
  v_mfma_f32_16x16x32_bf16 a[76:79], a[164:167], v[188:191], a[76:79]
  v_exp_f32 v219, v139
  v_mfma_f32_16x16x32_bf16 a[80:83], a[168:171], v[184:187], a[80:83]
  ds_read_b128 a[136:139], v3 offset:10240
  v_cvt_pk_bf16_f32 v180, v216, v217
  v_mfma_f32_16x16x32_bf16 a[84:87], a[168:171], v[188:191], a[84:87]
  v_exp_f32 v220, v140
  v_add_f32 v227, v227, v218
  v_mfma_f32_16x16x32_bf16 a[88:91], a[172:175], v[184:187], a[88:91]
  ds_read_b128 a[140:143], v3 offset:11264
  v_add_f32 v227, v227, v219
  v_mfma_f32_16x16x32_bf16 a[92:95], a[172:175], v[188:191], a[92:95]
  s_waitcnt lgkmcnt(4)
  v_exp_f32 v221, v141
  v_cvt_pk_bf16_f32 v181, v218, v219
  v_mfma_f32_16x16x32_bf16 a[96:99], a[176:179], v[184:187], a[96:99]
  ds_read_b128 a[144:147], v3 offset:12288
  buffer_load_dwordx4 v2, s[48:51], s27 offen offset:3072 sc1 lds
  v_mfma_f32_16x16x32_bf16 a[100:103], a[176:179], v[188:191], a[100:103]
  s_add_u32 s27, s27, 16384
  v_exp_f32 v222, v142
  v_add_f32 v227, v227, v220
  v_mfma_f32_16x16x32_bf16 a[104:107], a[180:183], v[184:187], a[104:107]
  s_add_u32 s25, s25, 32768
  ds_read_b128 a[148:151], v3 offset:13312
  v_add_f32 v227, v227, v221
  v_mfma_f32_16x16x32_bf16 a[108:111], a[180:183], v[188:191], a[108:111]
  s_and_b32 s25, s25, 0x1ffff
  v_exp_f32 v223, v143
  v_cvt_pk_bf16_f32 v182, v220, v221
  v_mfma_f32_16x16x32_bf16 a[112:115], a[184:187], v[184:187], a[112:115]
  ds_read_b128 a[152:155], v3 offset:14336
  v_add_f32 v227, v227, v222
  v_mfma_f32_16x16x32_bf16 a[116:119], a[184:187], v[188:191], a[116:119]
  s_sub_u32 s29, s29, 1
  v_add_f32 v227, v227, v223
  v_cvt_pk_bf16_f32 v183, v222, v223
  v_max_f32 v5, v226, v227
  v_mfma_f32_16x16x32_bf16 a[120:123], a[188:191], v[184:187], a[120:123]
  s_waitcnt lgkmcnt(3)
  ds_read_b128 a[156:159], v3 offset:15360
  v_cmp_lt_f32 vcc, s81, v5
  v_mfma_f32_16x16x32_bf16 a[124:127], a[188:191], v[188:191], a[124:127]
  s_cbranch_vccnz fa_stub11
fa_back11:
  v_add_f32 v230, v230, v226
  v_add_f32 v231, v231, v227
  v_add_u32 v3, 32768, v3
  v_and_b32 v3, 0x1ffff, v3
  s_cmp_gt_u32 s29, 8
  s_cbranch_scc1 fa_SS
fa_chain:
fa_hb8:
  s_cmp_lt_u32 s12, 2
  s_cbranch_scc1 fa_hk8
  s_cmp_eq_u32 s29, 8
  s_cbranch_scc0 fa_disp
fa_SSW8:
  v_mfma_f32_16x16x32_bf16 v[128:131], a[128:131], v[64:67], v[200:203]
  s_waitcnt vmcnt(12)
  v_exp_f32 v216, v144
  v_exp_f32 v217, v145
  v_mfma_f32_16x16x32_bf16 v[136:139], a[128:131], v[68:71], v[204:207]
  s_barrier
  v_exp_f32 v218, v146
  v_mfma_f32_16x16x32_bf16 v[132:135], a[132:135], v[64:67], v[200:203]
  ds_read_b128 a[160:163], v3 offset:16384
  ds_read_b128 a[164:167], v3 offset:17408
  v_mfma_f32_16x16x32_bf16 v[140:143], a[132:135], v[68:71], v[204:207]
  s_mov_b32 m0, s24
  v_exp_f32 v219, v147
  v_mfma_f32_16x16x32_bf16 v[128:131], a[136:139], v[72:75], v[128:131]
  ds_read_b128 a[168:171], v3 offset:18432
  buffer_load_dwordx4 v2, s[44:47], s26 offen offset:0 sc1 lds
  v_add_f32 v226, v216, v217
  v_mfma_f32_16x16x32_bf16 v[136:139], a[136:139], v[76:79], v[136:139]
  v_exp_f32 v220, v148
  v_mfma_f32_16x16x32_bf16 v[132:135], a[140:143], v[72:75], v[132:135]
  ds_read_b128 a[172:175], v3 offset:19456
  v_cvt_pk_bf16_f32 v184, v216, v217
  v_add_f32 v226, v226, v218
  v_mfma_f32_16x16x32_bf16 v[140:143], a[140:143], v[76:79], v[140:143]
  s_add_u32 s14, s13, 0
  s_waitcnt lgkmcnt(4)
  buffer_load_dwordx4 a[0:3], v2, s[40:43], s14 offen offset:0 sc1
  v_add_f32 v226, v226, v219
  v_mfma_f32_16x16x32_bf16 v[128:131], a[144:147], v[80:83], v[128:131]
  ds_read_b128 a[176:179], v3 offset:20480
  v_cvt_pk_bf16_f32 v185, v218, v219
  v_add_f32 v226, v226, v220
  v_mfma_f32_16x16x32_bf16 v[136:139], a[144:147], v[84:87], v[136:139]
  v_exp_f32 v221, v149
  v_mfma_f32_16x16x32_bf16 v[132:135], a[148:151], v[80:83], v[132:135]
  ds_read_b128 a[180:183], v3 offset:21504
  buffer_load_dwordx4 v2, s[44:47], s26 offen offset:1024 sc1 lds
  v_add_f32 v226, v226, v221
  v_mfma_f32_16x16x32_bf16 v[140:143], a[148:151], v[84:87], v[140:143]
  v_exp_f32 v222, v150
  v_cvt_pk_bf16_f32 v186, v220, v221
  v_mfma_f32_16x16x32_bf16 v[128:131], a[152:155], v[88:91], v[128:131]
  ds_read_b128 a[184:187], v3 offset:22528
  v_add_f32 v226, v226, v222
  v_mfma_f32_16x16x32_bf16 v[136:139], a[152:155], v[92:95], v[136:139]
  v_exp_f32 v223, v151
  v_exp_f32 v216, v152
  v_mfma_f32_16x16x32_bf16 v[132:135], a[156:159], v[88:91], v[132:135]
  ds_read_b128 a[188:191], v3 offset:23552
  buffer_load_dwordx4 a[4:7], v2, s[40:43], s14 offen offset:1024 sc1
  v_mfma_f32_16x16x32_bf16 v[140:143], a[156:159], v[92:95], v[140:143]
  s_waitcnt lgkmcnt(4)
  v_exp_f32 v217, v153
  v_mfma_f32_16x16x32_bf16 a[64:67], a[160:163], v[176:179], a[64:67]
  ds_read_b128 a[128:131], v3 offset:0
  v_add_f32 v226, v226, v223
  v_mfma_f32_16x16x32_bf16 a[68:71], a[160:163], v[180:183], a[68:71]
  v_exp_f32 v218, v154
  v_cvt_pk_bf16_f32 v187, v222, v223
  v_mfma_f32_16x16x32_bf16 a[72:75], a[164:167], v[176:179], a[72:75]
  ds_read_b128 a[132:135], v3 offset:1024
  buffer_load_dwordx4 v2, s[44:47], s26 offen offset:2048 sc1 lds
  v_mfma_f32_16x16x32_bf16 a[76:79], a[164:167], v[180:183], a[76:79]
  v_exp_f32 v219, v155
  v_add_f32 v227, v216, v217
  v_mfma_f32_16x16x32_bf16 a[80:83], a[168:171], v[176:179], a[80:83]
  ds_read_b128 a[136:139], v3 offset:2048
  v_cvt_pk_bf16_f32 v188, v216, v217
  v_add_f32 v227, v227, v218
  v_mfma_f32_16x16x32_bf16 a[84:87], a[168:171], v[180:183], a[84:87]
  buffer_load_dwordx4 a[8:11], v2, s[40:43], s14 offen offset:2048 sc1
  v_add_f32 v227, v227, v219
  v_mfma_f32_16x16x32_bf16 a[88:91], a[172:175], v[176:179], a[88:91]
  ds_read_b128 a[140:143], v3 offset:3072
  v_cvt_pk_bf16_f32 v189, v218, v219
  v_exp_f32 v220, v156
  v_mfma_f32_16x16x32_bf16 a[92:95], a[172:175], v[180:183], a[92:95]
  s_waitcnt lgkmcnt(4)
  v_exp_f32 v221, v157
  v_mfma_f32_16x16x32_bf16 a[96:99], a[176:179], v[176:179], a[96:99]
  ds_read_b128 a[144:147], v3 offset:4096
  buffer_load_dwordx4 v2, s[44:47], s26 offen offset:3072 sc1 lds
  v_mfma_f32_16x16x32_bf16 a[100:103], a[176:179], v[180:183], a[100:103]
  s_add_u32 s26, s26, 16384
  v_exp_f32 v222, v158
  v_mfma_f32_16x16x32_bf16 a[104:107], a[180:183], v[176:179], a[104:107]
  s_add_u32 s24, s24, 32768
  ds_read_b128 a[148:151], v3 offset:5120
  v_add_f32 v227, v227, v220
  v_add_f32 v227, v227, v221
  v_mfma_f32_16x16x32_bf16 a[108:111], a[180:183], v[180:183], a[108:111]
  s_and_b32 s24, s24, 0x1ffff
  v_exp_f32 v223, v159
  v_mfma_f32_16x16x32_bf16 a[112:115], a[184:187], v[176:179], a[112:115]
  ds_read_b128 a[152:155], v3 offset:6144
  v_cvt_pk_bf16_f32 v190, v220, v221
  v_add_f32 v227, v227, v222
  v_mfma_f32_16x16x32_bf16 a[116:119], a[184:187], v[180:183], a[116:119]
  v_add_f32 v227, v227, v223
  v_cvt_pk_bf16_f32 v191, v222, v223
  v_mfma_f32_16x16x32_bf16 a[120:123], a[188:191], v[176:179], a[120:123]
  s_waitcnt lgkmcnt(3)
  ds_read_b128 a[156:159], v3 offset:7168
  v_max_f32 v5, v226, v227
  v_cmp_lt_f32 vcc, s81, v5
  v_mfma_f32_16x16x32_bf16 a[124:127], a[188:191], v[180:183], a[124:127]
  s_cbranch_vccnz fa_stub12
fa_back12:
  v_add_f32 v230, v230, v226
  v_add_f32 v231, v231, v227
  v_mfma_f32_16x16x32_bf16 v[144:147], a[128:131], v[64:67], v[200:203]
  ds_read_b128 a[160:163], v3 offset:24576
  v_exp_f32 v216, v128
  v_mfma_f32_16x16x32_bf16 v[152:155], a[128:131], v[68:71], v[204:207]
  v_exp_f32 v217, v129
  v_mfma_f32_16x16x32_bf16 v[148:151], a[132:135], v[64:67], v[200:203]
  ds_read_b128 a[164:167], v3 offset:25600
  v_add_f32 v226, v216, v217
  v_cvt_pk_bf16_f32 v176, v216, v217
  v_mfma_f32_16x16x32_bf16 v[156:159], a[132:135], v[68:71], v[204:207]
  s_mov_b32 m0, s25
  v_exp_f32 v218, v130
  v_mfma_f32_16x16x32_bf16 v[144:147], a[136:139], v[72:75], v[144:147]
  ds_read_b128 a[168:171], v3 offset:26624
  buffer_load_dwordx4 v2, s[48:51], s27 offen offset:0 sc1 lds
  v_add_f32 v226, v226, v218
  v_mfma_f32_16x16x32_bf16 v[152:155], a[136:139], v[76:79], v[152:155]
  v_exp_f32 v219, v131
  v_mfma_f32_16x16x32_bf16 v[148:151], a[140:143], v[72:75], v[148:151]
  ds_read_b128 a[172:175], v3 offset:27648
  v_add_f32 v226, v226, v219
  v_cvt_pk_bf16_f32 v177, v218, v219
  v_mfma_f32_16x16x32_bf16 v[156:159], a[140:143], v[76:79], v[156:159]
  s_add_u32 s14, s13, 0
  s_waitcnt lgkmcnt(4)
  buffer_load_dwordx4 a[12:15], v2, s[40:43], s14 offen offset:3072 sc1
  v_exp_f32 v220, v132
  v_mfma_f32_16x16x32_bf16 v[144:147], a[144:147], v[80:83], v[144:147]
  ds_read_b128 a[176:179], v3 offset:28672
  v_add_f32 v226, v226, v220
  v_mfma_f32_16x16x32_bf16 v[152:155], a[144:147], v[84:87], v[152:155]
  v_exp_f32 v221, v133
  v_mfma_f32_16x16x32_bf16 v[148:151], a[148:151], v[80:83], v[148:151]
  ds_read_b128 a[180:183], v3 offset:29696
  buffer_load_dwordx4 v2, s[48:51], s27 offen offset:1024 sc1 lds
  v_add_f32 v226, v226, v221
  v_mfma_f32_16x16x32_bf16 v[156:159], a[148:151], v[84:87], v[156:159]
  v_exp_f32 v222, v134
  v_cvt_pk_bf16_f32 v178, v220, v221
  v_mfma_f32_16x16x32_bf16 v[144:147], a[152:155], v[88:91], v[144:147]
  ds_read_b128 a[184:187], v3 offset:30720
  v_add_f32 v226, v226, v222
  v_mfma_f32_16x16x32_bf16 v[152:155], a[152:155], v[92:95], v[152:155]
  v_exp_f32 v223, v135
  v_exp_f32 v216, v136
  v_mfma_f32_16x16x32_bf16 v[148:151], a[156:159], v[88:91], v[148:151]
  s_add_u32 s14, s13, 4096
  ds_read_b128 a[188:191], v3 offset:31744
  buffer_load_dwordx4 a[16:19], v2, s[40:43], s14 offen offset:0 sc1
  v_mfma_f32_16x16x32_bf16 v[156:159], a[156:159], v[92:95], v[156:159]
  s_waitcnt lgkmcnt(4)
  v_exp_f32 v217, v137
  v_mfma_f32_16x16x32_bf16 a[64:67], a[160:163], v[184:187], a[64:67]
  ds_read_b128 a[128:131], v3 offset:8192
  v_add_f32 v226, v226, v223
  v_mfma_f32_16x16x32_bf16 a[68:71], a[160:163], v[188:191], a[68:71]
  v_exp_f32 v218, v138
  v_cvt_pk_bf16_f32 v179, v222, v223
  v_mfma_f32_16x16x32_bf16 a[72:75], a[164:167], v[184:187], a[72:75]
  ds_read_b128 a[132:135], v3 offset:9216
  buffer_load_dwordx4 v2, s[48:51], s27 offen offset:2048 sc1 lds
  v_mfma_f32_16x16x32_bf16 a[76:79], a[164:167], v[188:191], a[76:79]
  v_exp_f32 v219, v139
  v_add_f32 v227, v216, v217
  v_mfma_f32_16x16x32_bf16 a[80:83], a[168:171], v[184:187], a[80:83]
  ds_read_b128 a[136:139], v3 offset:10240
  v_cvt_pk_bf16_f32 v180, v216, v217
  v_add_f32 v227, v227, v218
  v_mfma_f32_16x16x32_bf16 a[84:87], a[168:171], v[188:191], a[84:87]
  buffer_load_dwordx4 a[20:23], v2, s[40:43], s14 offen offset:1024 sc1
  v_add_f32 v227, v227, v219
  v_mfma_f32_16x16x32_bf16 a[88:91], a[172:175], v[184:187], a[88:91]
  ds_read_b128 a[140:143], v3 offset:11264
  v_cvt_pk_bf16_f32 v181, v218, v219
  v_exp_f32 v220, v140
  v_mfma_f32_16x16x32_bf16 a[92:95], a[172:175], v[188:191], a[92:95]
  s_waitcnt lgkmcnt(4)
  v_exp_f32 v221, v141
  v_mfma_f32_16x16x32_bf16 a[96:99], a[176:179], v[184:187], a[96:99]
  ds_read_b128 a[144:147], v3 offset:12288
  buffer_load_dwordx4 v2, s[48:51], s27 offen offset:3072 sc1 lds
  v_mfma_f32_16x16x32_bf16 a[100:103], a[176:179], v[188:191], a[100:103]
  s_add_u32 s27, s27, 16384
  v_exp_f32 v222, v142
  v_mfma_f32_16x16x32_bf16 a[104:107], a[180:183], v[184:187], a[104:107]
  s_add_u32 s25, s25, 32768
  ds_read_b128 a[148:151], v3 offset:13312
  v_add_f32 v227, v227, v220
  v_add_f32 v227, v227, v221
  v_mfma_f32_16x16x32_bf16 a[108:111], a[180:183], v[188:191], a[108:111]
  s_and_b32 s25, s25, 0x1ffff
  v_exp_f32 v223, v143
  v_mfma_f32_16x16x32_bf16 a[112:115], a[184:187], v[184:187], a[112:115]
  ds_read_b128 a[152:155], v3 offset:14336
  v_cvt_pk_bf16_f32 v182, v220, v221
  v_add_f32 v227, v227, v222
  v_mfma_f32_16x16x32_bf16 a[116:119], a[184:187], v[188:191], a[116:119]
  v_add_f32 v227, v227, v223
  v_cvt_pk_bf16_f32 v183, v222, v223
  v_mfma_f32_16x16x32_bf16 a[120:123], a[188:191], v[184:187], a[120:123]
  s_waitcnt lgkmcnt(3)
  ds_read_b128 a[156:159], v3 offset:15360
  v_max_f32 v5, v226, v227
  v_cmp_lt_f32 vcc, s81, v5
  v_mfma_f32_16x16x32_bf16 a[124:127], a[188:191], v[188:191], a[124:127]
  s_cbranch_vccnz fa_stub13
fa_back13:
  v_add_f32 v230, v230, v226
  v_add_f32 v231, v231, v227
  v_add_u32 v3, 32768, v3
  v_and_b32 v3, 0x1ffff, v3
fa_SSW7:
  v_mfma_f32_16x16x32_bf16 v[128:131], a[128:131], v[64:67], v[200:203]
  s_waitcnt vmcnt(12)
  v_exp_f32 v216, v144
  v_exp_f32 v217, v145
  v_mfma_f32_16x16x32_bf16 v[136:139], a[128:131], v[68:71], v[204:207]
  s_barrier
  v_exp_f32 v218, v146
  v_mfma_f32_16x16x32_bf16 v[132:135], a[132:135], v[64:67], v[200:203]
  ds_read_b128 a[160:163], v3 offset:16384
  ds_read_b128 a[164:167], v3 offset:17408
  v_mfma_f32_16x16x32_bf16 v[140:143], a[132:135], v[68:71], v[204:207]
  s_mov_b32 m0, s24
  v_exp_f32 v219, v147
  v_mfma_f32_16x16x32_bf16 v[128:131], a[136:139], v[72:75], v[128:131]
  ds_read_b128 a[168:171], v3 offset:18432
  buffer_load_dwordx4 v2, s[44:47], s26 offen offset:0 sc1 lds
  v_add_f32 v226, v216, v217
  v_mfma_f32_16x16x32_bf16 v[136:139], a[136:139], v[76:79], v[136:139]
  v_exp_f32 v220, v148
  v_mfma_f32_16x16x32_bf16 v[132:135], a[140:143], v[72:75], v[132:135]
  ds_read_b128 a[172:175], v3 offset:19456
  v_cvt_pk_bf16_f32 v184, v216, v217
  v_add_f32 v226, v226, v218
  v_mfma_f32_16x16x32_bf16 v[140:143], a[140:143], v[76:79], v[140:143]
  s_add_u32 s14, s13, 4096
  s_waitcnt lgkmcnt(4)
  buffer_load_dwordx4 a[24:27], v2, s[40:43], s14 offen offset:2048 sc1
  v_add_f32 v226, v226, v219
  v_mfma_f32_16x16x32_bf16 v[128:131], a[144:147], v[80:83], v[128:131]
  ds_read_b128 a[176:179], v3 offset:20480
  v_cvt_pk_bf16_f32 v185, v218, v219
  v_add_f32 v226, v226, v220
  v_mfma_f32_16x16x32_bf16 v[136:139], a[144:147], v[84:87], v[136:139]
  v_exp_f32 v221, v149
  v_mfma_f32_16x16x32_bf16 v[132:135], a[148:151], v[80:83], v[132:135]
  ds_read_b128 a[180:183], v3 offset:21504
  buffer_load_dwordx4 v2, s[44:47], s26 offen offset:1024 sc1 lds
  v_add_f32 v226, v226, v221
  v_mfma_f32_16x16x32_bf16 v[140:143], a[148:151], v[84:87], v[140:143]
  v_exp_f32 v222, v150
  v_cvt_pk_bf16_f32 v186, v220, v221
  v_mfma_f32_16x16x32_bf16 v[128:131], a[152:155], v[88:91], v[128:131]
  ds_read_b128 a[184:187], v3 offset:22528
  v_add_f32 v226, v226, v222
  v_mfma_f32_16x16x32_bf16 v[136:139], a[152:155], v[92:95], v[136:139]
  v_exp_f32 v223, v151
  v_exp_f32 v216, v152
  v_mfma_f32_16x16x32_bf16 v[132:135], a[156:159], v[88:91], v[132:135]
  ds_read_b128 a[188:191], v3 offset:23552
  buffer_load_dwordx4 a[28:31], v2, s[40:43], s14 offen offset:3072 sc1
  v_mfma_f32_16x16x32_bf16 v[140:143], a[156:159], v[92:95], v[140:143]
  s_waitcnt lgkmcnt(4)
  v_exp_f32 v217, v153
  v_mfma_f32_16x16x32_bf16 a[64:67], a[160:163], v[176:179], a[64:67]
  ds_read_b128 a[128:131], v3 offset:0
  v_add_f32 v226, v226, v223
  v_mfma_f32_16x16x32_bf16 a[68:71], a[160:163], v[180:183], a[68:71]
  v_exp_f32 v218, v154
  v_cvt_pk_bf16_f32 v187, v222, v223
  v_mfma_f32_16x16x32_bf16 a[72:75], a[164:167], v[176:179], a[72:75]
  ds_read_b128 a[132:135], v3 offset:1024
  buffer_load_dwordx4 v2, s[44:47], s26 offen offset:2048 sc1 lds
  v_mfma_f32_16x16x32_bf16 a[76:79], a[164:167], v[180:183], a[76:79]
  v_exp_f32 v219, v155
  v_add_f32 v227, v216, v217
  v_mfma_f32_16x16x32_bf16 a[80:83], a[168:171], v[176:179], a[80:83]
  ds_read_b128 a[136:139], v3 offset:2048
  v_cvt_pk_bf16_f32 v188, v216, v217
  v_add_f32 v227, v227, v218
  v_mfma_f32_16x16x32_bf16 a[84:87], a[168:171], v[180:183], a[84:87]
  s_add_u32 s14, s13, 8192
  buffer_load_dwordx4 a[32:35], v2, s[40:43], s14 offen offset:0 sc1
  v_add_f32 v227, v227, v219
  v_mfma_f32_16x16x32_bf16 a[88:91], a[172:175], v[176:179], a[88:91]
  ds_read_b128 a[140:143], v3 offset:3072
  v_cvt_pk_bf16_f32 v189, v218, v219
  v_exp_f32 v220, v156
  v_mfma_f32_16x16x32_bf16 a[92:95], a[172:175], v[180:183], a[92:95]
  s_waitcnt lgkmcnt(4)
  v_exp_f32 v221, v157
  v_mfma_f32_16x16x32_bf16 a[96:99], a[176:179], v[176:179], a[96:99]
  ds_read_b128 a[144:147], v3 offset:4096
  buffer_load_dwordx4 v2, s[44:47], s26 offen offset:3072 sc1 lds
  v_mfma_f32_16x16x32_bf16 a[100:103], a[176:179], v[180:183], a[100:103]
  s_add_u32 s26, s26, 16384
  v_exp_f32 v222, v158
  v_mfma_f32_16x16x32_bf16 a[104:107], a[180:183], v[176:179], a[104:107]
  s_add_u32 s24, s24, 32768
  ds_read_b128 a[148:151], v3 offset:5120
  v_add_f32 v227, v227, v220
  v_add_f32 v227, v227, v221
  v_mfma_f32_16x16x32_bf16 a[108:111], a[180:183], v[180:183], a[108:111]
  s_and_b32 s24, s24, 0x1ffff
  v_exp_f32 v223, v159
  v_mfma_f32_16x16x32_bf16 a[112:115], a[184:187], v[176:179], a[112:115]
  ds_read_b128 a[152:155], v3 offset:6144
  v_cvt_pk_bf16_f32 v190, v220, v221
  v_add_f32 v227, v227, v222
  v_mfma_f32_16x16x32_bf16 a[116:119], a[184:187], v[180:183], a[116:119]
  v_add_f32 v227, v227, v223
  v_cvt_pk_bf16_f32 v191, v222, v223
  v_mfma_f32_16x16x32_bf16 a[120:123], a[188:191], v[176:179], a[120:123]
  s_waitcnt lgkmcnt(3)
  ds_read_b128 a[156:159], v3 offset:7168
  v_max_f32 v5, v226, v227
  v_cmp_lt_f32 vcc, s81, v5
  v_mfma_f32_16x16x32_bf16 a[124:127], a[188:191], v[180:183], a[124:127]
  s_cbranch_vccnz fa_stub14
fa_back14:
  v_add_f32 v230, v230, v226
  v_add_f32 v231, v231, v227
  v_mfma_f32_16x16x32_bf16 v[144:147], a[128:131], v[64:67], v[200:203]
  ds_read_b128 a[160:163], v3 offset:24576
  v_exp_f32 v216, v128
  v_mfma_f32_16x16x32_bf16 v[152:155], a[128:131], v[68:71], v[204:207]
  v_exp_f32 v217, v129
  v_mfma_f32_16x16x32_bf16 v[148:151], a[132:135], v[64:67], v[200:203]
  ds_read_b128 a[164:167], v3 offset:25600
  v_add_f32 v226, v216, v217
  v_cvt_pk_bf16_f32 v176, v216, v217
  v_mfma_f32_16x16x32_bf16 v[156:159], a[132:135], v[68:71], v[204:207]
  s_mov_b32 m0, s25
  v_exp_f32 v218, v130
  v_mfma_f32_16x16x32_bf16 v[144:147], a[136:139], v[72:75], v[144:147]
  ds_read_b128 a[168:171], v3 offset:26624
  buffer_load_dwordx4 v2, s[48:51], s27 offen offset:0 sc1 lds
  v_add_f32 v226, v226, v218
  v_mfma_f32_16x16x32_bf16 v[152:155], a[136:139], v[76:79], v[152:155]
  v_exp_f32 v219, v131
  v_mfma_f32_16x16x32_bf16 v[148:151], a[140:143], v[72:75], v[148:151]
  ds_read_b128 a[172:175], v3 offset:27648
  v_add_f32 v226, v226, v219
  v_cvt_pk_bf16_f32 v177, v218, v219
  v_mfma_f32_16x16x32_bf16 v[156:159], a[140:143], v[76:79], v[156:159]
  s_add_u32 s14, s13, 8192
  s_waitcnt lgkmcnt(4)
  buffer_load_dwordx4 a[36:39], v2, s[40:43], s14 offen offset:1024 sc1
  v_exp_f32 v220, v132
  v_mfma_f32_16x16x32_bf16 v[144:147], a[144:147], v[80:83], v[144:147]
  ds_read_b128 a[176:179], v3 offset:28672
  v_add_f32 v226, v226, v220
  v_mfma_f32_16x16x32_bf16 v[152:155], a[144:147], v[84:87], v[152:155]
  v_exp_f32 v221, v133
  v_mfma_f32_16x16x32_bf16 v[148:151], a[148:151], v[80:83], v[148:151]
  ds_read_b128 a[180:183], v3 offset:29696
  buffer_load_dwordx4 v2, s[48:51], s27 offen offset:1024 sc1 lds
  v_add_f32 v226, v226, v221
  v_mfma_f32_16x16x32_bf16 v[156:159], a[148:151], v[84:87], v[156:159]
  v_exp_f32 v222, v134
  v_cvt_pk_bf16_f32 v178, v220, v221
  v_mfma_f32_16x16x32_bf16 v[144:147], a[152:155], v[88:91], v[144:147]
  ds_read_b128 a[184:187], v3 offset:30720
  v_add_f32 v226, v226, v222
  v_mfma_f32_16x16x32_bf16 v[152:155], a[152:155], v[92:95], v[152:155]
  v_exp_f32 v223, v135
  v_exp_f32 v216, v136
  v_mfma_f32_16x16x32_bf16 v[148:151], a[156:159], v[88:91], v[148:151]
  ds_read_b128 a[188:191], v3 offset:31744
  buffer_load_dwordx4 a[40:43], v2, s[40:43], s14 offen offset:2048 sc1
  v_mfma_f32_16x16x32_bf16 v[156:159], a[156:159], v[92:95], v[156:159]
  s_waitcnt lgkmcnt(4)
  v_exp_f32 v217, v137
  v_mfma_f32_16x16x32_bf16 a[64:67], a[160:163], v[184:187], a[64:67]
  ds_read_b128 a[128:131], v3 offset:8192
  v_add_f32 v226, v226, v223
  v_mfma_f32_16x16x32_bf16 a[68:71], a[160:163], v[188:191], a[68:71]
  v_exp_f32 v218, v138
  v_cvt_pk_bf16_f32 v179, v222, v223
  v_mfma_f32_16x16x32_bf16 a[72:75], a[164:167], v[184:187], a[72:75]
  ds_read_b128 a[132:135], v3 offset:9216
  buffer_load_dwordx4 v2, s[48:51], s27 offen offset:2048 sc1 lds
  v_mfma_f32_16x16x32_bf16 a[76:79], a[164:167], v[188:191], a[76:79]
  v_exp_f32 v219, v139
  v_add_f32 v227, v216, v217
  v_mfma_f32_16x16x32_bf16 a[80:83], a[168:171], v[184:187], a[80:83]
  ds_read_b128 a[136:139], v3 offset:10240
  v_cvt_pk_bf16_f32 v180, v216, v217
  v_add_f32 v227, v227, v218
  v_mfma_f32_16x16x32_bf16 a[84:87], a[168:171], v[188:191], a[84:87]
  buffer_load_dwordx4 a[44:47], v2, s[40:43], s14 offen offset:3072 sc1
  v_add_f32 v227, v227, v219
  v_mfma_f32_16x16x32_bf16 a[88:91], a[172:175], v[184:187], a[88:91]
  ds_read_b128 a[140:143], v3 offset:11264
  v_cvt_pk_bf16_f32 v181, v218, v219
  v_exp_f32 v220, v140
  v_mfma_f32_16x16x32_bf16 a[92:95], a[172:175], v[188:191], a[92:95]
  s_waitcnt lgkmcnt(4)
  v_exp_f32 v221, v141
  v_mfma_f32_16x16x32_bf16 a[96:99], a[176:179], v[184:187], a[96:99]
  ds_read_b128 a[144:147], v3 offset:12288
  buffer_load_dwordx4 v2, s[48:51], s27 offen offset:3072 sc1 lds
  v_mfma_f32_16x16x32_bf16 a[100:103], a[176:179], v[188:191], a[100:103]
  s_add_u32 s27, s27, 16384
  v_exp_f32 v222, v142
  v_mfma_f32_16x16x32_bf16 a[104:107], a[180:183], v[184:187], a[104:107]
  s_add_u32 s25, s25, 32768
  ds_read_b128 a[148:151], v3 offset:13312
  v_add_f32 v227, v227, v220
  v_add_f32 v227, v227, v221
  v_mfma_f32_16x16x32_bf16 a[108:111], a[180:183], v[188:191], a[108:111]
  s_and_b32 s25, s25, 0x1ffff
  v_exp_f32 v223, v143
  v_mfma_f32_16x16x32_bf16 a[112:115], a[184:187], v[184:187], a[112:115]
  ds_read_b128 a[152:155], v3 offset:14336
  v_cvt_pk_bf16_f32 v182, v220, v221
  v_add_f32 v227, v227, v222
  v_mfma_f32_16x16x32_bf16 a[116:119], a[184:187], v[188:191], a[116:119]
  v_add_f32 v227, v227, v223
  v_cvt_pk_bf16_f32 v183, v222, v223
  v_mfma_f32_16x16x32_bf16 a[120:123], a[188:191], v[184:187], a[120:123]
  s_waitcnt lgkmcnt(3)
  ds_read_b128 a[156:159], v3 offset:15360
  v_max_f32 v5, v226, v227
  v_cmp_lt_f32 vcc, s81, v5
  v_mfma_f32_16x16x32_bf16 a[124:127], a[188:191], v[188:191], a[124:127]
  s_cbranch_vccnz fa_stub15
fa_back15:
  v_add_f32 v230, v230, v226
  v_add_f32 v231, v231, v227
  v_add_u32 v3, 32768, v3
  v_and_b32 v3, 0x1ffff, v3
fa_SSW6:
  v_mfma_f32_16x16x32_bf16 v[128:131], a[128:131], v[64:67], v[200:203]
  s_waitcnt vmcnt(12)
  v_exp_f32 v216, v144
  v_exp_f32 v217, v145
  v_mfma_f32_16x16x32_bf16 v[136:139], a[128:131], v[68:71], v[204:207]
  s_barrier
  v_exp_f32 v218, v146
  v_mfma_f32_16x16x32_bf16 v[132:135], a[132:135], v[64:67], v[200:203]
  ds_read_b128 a[160:163], v3 offset:16384
  ds_read_b128 a[164:167], v3 offset:17408
  v_mfma_f32_16x16x32_bf16 v[140:143], a[132:135], v[68:71], v[204:207]
  s_mov_b32 m0, s24
  v_exp_f32 v219, v147
  v_mfma_f32_16x16x32_bf16 v[128:131], a[136:139], v[72:75], v[128:131]
  ds_read_b128 a[168:171], v3 offset:18432
  buffer_load_dwordx4 v2, s[44:47], s26 offen offset:0 sc1 lds
  v_add_f32 v226, v216, v217
  v_mfma_f32_16x16x32_bf16 v[136:139], a[136:139], v[76:79], v[136:139]
  v_exp_f32 v220, v148
  v_mfma_f32_16x16x32_bf16 v[132:135], a[140:143], v[72:75], v[132:135]
  ds_read_b128 a[172:175], v3 offset:19456
  v_cvt_pk_bf16_f32 v184, v216, v217
  v_add_f32 v226, v226, v218
  v_mfma_f32_16x16x32_bf16 v[140:143], a[140:143], v[76:79], v[140:143]
  s_add_u32 s14, s13, 12288
  s_waitcnt lgkmcnt(4)
  buffer_load_dwordx4 a[48:51], v2, s[40:43], s14 offen offset:0 sc1
  v_add_f32 v226, v226, v219
  v_mfma_f32_16x16x32_bf16 v[128:131], a[144:147], v[80:83], v[128:131]
  ds_read_b128 a[176:179], v3 offset:20480
  v_cvt_pk_bf16_f32 v185, v218, v219
  v_add_f32 v226, v226, v220
  v_mfma_f32_16x16x32_bf16 v[136:139], a[144:147], v[84:87], v[136:139]
  v_exp_f32 v221, v149
  v_mfma_f32_16x16x32_bf16 v[132:135], a[148:151], v[80:83], v[132:135]
  ds_read_b128 a[180:183], v3 offset:21504
  buffer_load_dwordx4 v2, s[44:47], s26 offen offset:1024 sc1 lds
  v_add_f32 v226, v226, v221
  v_mfma_f32_16x16x32_bf16 v[140:143], a[148:151], v[84:87], v[140:143]
  v_exp_f32 v222, v150
  v_cvt_pk_bf16_f32 v186, v220, v221
  v_mfma_f32_16x16x32_bf16 v[128:131], a[152:155], v[88:91], v[128:131]
  ds_read_b128 a[184:187], v3 offset:22528
  v_add_f32 v226, v226, v222
  v_mfma_f32_16x16x32_bf16 v[136:139], a[152:155], v[92:95], v[136:139]
  v_exp_f32 v223, v151
  v_exp_f32 v216, v152
  v_mfma_f32_16x16x32_bf16 v[132:135], a[156:159], v[88:91], v[132:135]
  ds_read_b128 a[188:191], v3 offset:23552
  buffer_load_dwordx4 a[52:55], v2, s[40:43], s14 offen offset:1024 sc1
  v_mfma_f32_16x16x32_bf16 v[140:143], a[156:159], v[92:95], v[140:143]
  s_waitcnt lgkmcnt(4)
  v_exp_f32 v217, v153
  v_mfma_f32_16x16x32_bf16 a[64:67], a[160:163], v[176:179], a[64:67]
  ds_read_b128 a[128:131], v3 offset:0
  v_add_f32 v226, v226, v223
  v_mfma_f32_16x16x32_bf16 a[68:71], a[160:163], v[180:183], a[68:71]
  v_exp_f32 v218, v154
  v_cvt_pk_bf16_f32 v187, v222, v223
  v_mfma_f32_16x16x32_bf16 a[72:75], a[164:167], v[176:179], a[72:75]
  ds_read_b128 a[132:135], v3 offset:1024
  buffer_load_dwordx4 v2, s[44:47], s26 offen offset:2048 sc1 lds
  v_mfma_f32_16x16x32_bf16 a[76:79], a[164:167], v[180:183], a[76:79]
  v_exp_f32 v219, v155
  v_add_f32 v227, v216, v217
  v_mfma_f32_16x16x32_bf16 a[80:83], a[168:171], v[176:179], a[80:83]
  ds_read_b128 a[136:139], v3 offset:2048
  v_cvt_pk_bf16_f32 v188, v216, v217
  v_add_f32 v227, v227, v218
  v_mfma_f32_16x16x32_bf16 a[84:87], a[168:171], v[180:183], a[84:87]
  buffer_load_dwordx4 a[56:59], v2, s[40:43], s14 offen offset:2048 sc1
  v_add_f32 v227, v227, v219
  v_mfma_f32_16x16x32_bf16 a[88:91], a[172:175], v[176:179], a[88:91]
  ds_read_b128 a[140:143], v3 offset:3072
  v_cvt_pk_bf16_f32 v189, v218, v219
  v_exp_f32 v220, v156
  v_mfma_f32_16x16x32_bf16 a[92:95], a[172:175], v[180:183], a[92:95]
  s_waitcnt lgkmcnt(4)
  v_exp_f32 v221, v157
  v_mfma_f32_16x16x32_bf16 a[96:99], a[176:179], v[176:179], a[96:99]
  ds_read_b128 a[144:147], v3 offset:4096
  buffer_load_dwordx4 v2, s[44:47], s26 offen offset:3072 sc1 lds
  v_mfma_f32_16x16x32_bf16 a[100:103], a[176:179], v[180:183], a[100:103]
  s_add_u32 s26, s26, 16384
  v_exp_f32 v222, v158
  v_mfma_f32_16x16x32_bf16 a[104:107], a[180:183], v[176:179], a[104:107]
  s_add_u32 s24, s24, 32768
  ds_read_b128 a[148:151], v3 offset:5120
  v_add_f32 v227, v227, v220
  v_add_f32 v227, v227, v221
  v_mfma_f32_16x16x32_bf16 a[108:111], a[180:183], v[180:183], a[108:111]
  s_and_b32 s24, s24, 0x1ffff
  v_exp_f32 v223, v159
  v_mfma_f32_16x16x32_bf16 a[112:115], a[184:187], v[176:179], a[112:115]
  ds_read_b128 a[152:155], v3 offset:6144
  v_cvt_pk_bf16_f32 v190, v220, v221
  v_add_f32 v227, v227, v222
  v_mfma_f32_16x16x32_bf16 a[116:119], a[184:187], v[180:183], a[116:119]
  v_add_f32 v227, v227, v223
  v_cvt_pk_bf16_f32 v191, v222, v223
  v_mfma_f32_16x16x32_bf16 a[120:123], a[188:191], v[176:179], a[120:123]
  s_waitcnt lgkmcnt(3)
  ds_read_b128 a[156:159], v3 offset:7168
  v_max_f32 v5, v226, v227
  v_cmp_lt_f32 vcc, s81, v5
  v_mfma_f32_16x16x32_bf16 a[124:127], a[188:191], v[180:183], a[124:127]
  s_cbranch_vccnz fa_stub16
fa_back16:
  v_add_f32 v230, v230, v226
  v_add_f32 v231, v231, v227
  v_mfma_f32_16x16x32_bf16 v[144:147], a[128:131], v[64:67], v[200:203]
  ds_read_b128 a[160:163], v3 offset:24576
  v_exp_f32 v216, v128
  v_mfma_f32_16x16x32_bf16 v[152:155], a[128:131], v[68:71], v[204:207]
  v_exp_f32 v217, v129
  v_mfma_f32_16x16x32_bf16 v[148:151], a[132:135], v[64:67], v[200:203]
  ds_read_b128 a[164:167], v3 offset:25600
  v_add_f32 v226, v216, v217
  v_cvt_pk_bf16_f32 v176, v216, v217
  v_mfma_f32_16x16x32_bf16 v[156:159], a[132:135], v[68:71], v[204:207]
  s_mov_b32 m0, s25
  v_exp_f32 v218, v130
  v_mfma_f32_16x16x32_bf16 v[144:147], a[136:139], v[72:75], v[144:147]
  ds_read_b128 a[168:171], v3 offset:26624
  buffer_load_dwordx4 v2, s[48:51], s27 offen offset:0 sc1 lds
  v_add_f32 v226, v226, v218
  v_mfma_f32_16x16x32_bf16 v[152:155], a[136:139], v[76:79], v[152:155]
  v_exp_f32 v219, v131
  v_mfma_f32_16x16x32_bf16 v[148:151], a[140:143], v[72:75], v[148:151]
  ds_read_b128 a[172:175], v3 offset:27648
  v_add_f32 v226, v226, v219
  v_cvt_pk_bf16_f32 v177, v218, v219
  v_mfma_f32_16x16x32_bf16 v[156:159], a[140:143], v[76:79], v[156:159]
  s_add_u32 s14, s13, 12288
  s_waitcnt lgkmcnt(4)
  buffer_load_dwordx4 a[60:63], v2, s[40:43], s14 offen offset:3072 sc1
  v_exp_f32 v220, v132
  v_mfma_f32_16x16x32_bf16 v[144:147], a[144:147], v[80:83], v[144:147]
  ds_read_b128 a[176:179], v3 offset:28672
  v_add_f32 v226, v226, v220
  v_mfma_f32_16x16x32_bf16 v[152:155], a[144:147], v[84:87], v[152:155]
  v_exp_f32 v221, v133
  v_mfma_f32_16x16x32_bf16 v[148:151], a[148:151], v[80:83], v[148:151]
  ds_read_b128 a[180:183], v3 offset:29696
  buffer_load_dwordx4 v2, s[48:51], s27 offen offset:1024 sc1 lds
  v_add_f32 v226, v226, v221
  v_mfma_f32_16x16x32_bf16 v[156:159], a[148:151], v[84:87], v[156:159]
  v_exp_f32 v222, v134
  v_cvt_pk_bf16_f32 v178, v220, v221
  v_mfma_f32_16x16x32_bf16 v[144:147], a[152:155], v[88:91], v[144:147]
  ds_read_b128 a[184:187], v3 offset:30720
  v_add_f32 v226, v226, v222
  v_mfma_f32_16x16x32_bf16 v[152:155], a[152:155], v[92:95], v[152:155]
  v_exp_f32 v223, v135
  v_exp_f32 v216, v136
  v_mfma_f32_16x16x32_bf16 v[148:151], a[156:159], v[88:91], v[148:151]
  s_add_u32 s14, s13, 16384
  ds_read_b128 a[188:191], v3 offset:31744
  buffer_load_dwordx4 a[192:195], v2, s[40:43], s14 offen offset:0 sc1
  v_mfma_f32_16x16x32_bf16 v[156:159], a[156:159], v[92:95], v[156:159]
  s_waitcnt lgkmcnt(4)
  v_exp_f32 v217, v137
  v_mfma_f32_16x16x32_bf16 a[64:67], a[160:163], v[184:187], a[64:67]
  ds_read_b128 a[128:131], v3 offset:8192
  v_add_f32 v226, v226, v223
  v_mfma_f32_16x16x32_bf16 a[68:71], a[160:163], v[188:191], a[68:71]
  v_exp_f32 v218, v138
  v_cvt_pk_bf16_f32 v179, v222, v223
  v_mfma_f32_16x16x32_bf16 a[72:75], a[164:167], v[184:187], a[72:75]
  ds_read_b128 a[132:135], v3 offset:9216
  buffer_load_dwordx4 v2, s[48:51], s27 offen offset:2048 sc1 lds
  v_mfma_f32_16x16x32_bf16 a[76:79], a[164:167], v[188:191], a[76:79]
  v_exp_f32 v219, v139
  v_add_f32 v227, v216, v217
  v_mfma_f32_16x16x32_bf16 a[80:83], a[168:171], v[184:187], a[80:83]
  ds_read_b128 a[136:139], v3 offset:10240
  v_cvt_pk_bf16_f32 v180, v216, v217
  v_add_f32 v227, v227, v218
  v_mfma_f32_16x16x32_bf16 a[84:87], a[168:171], v[188:191], a[84:87]
  buffer_load_dwordx4 a[196:199], v2, s[40:43], s14 offen offset:1024 sc1
  v_add_f32 v227, v227, v219
  v_mfma_f32_16x16x32_bf16 a[88:91], a[172:175], v[184:187], a[88:91]
  ds_read_b128 a[140:143], v3 offset:11264
  v_cvt_pk_bf16_f32 v181, v218, v219
  v_exp_f32 v220, v140
  v_mfma_f32_16x16x32_bf16 a[92:95], a[172:175], v[188:191], a[92:95]
  s_waitcnt lgkmcnt(4)
  v_exp_f32 v221, v141
  v_mfma_f32_16x16x32_bf16 a[96:99], a[176:179], v[184:187], a[96:99]
  ds_read_b128 a[144:147], v3 offset:12288
  buffer_load_dwordx4 v2, s[48:51], s27 offen offset:3072 sc1 lds
  v_mfma_f32_16x16x32_bf16 a[100:103], a[176:179], v[188:191], a[100:103]
  s_add_u32 s27, s27, 16384
  v_exp_f32 v222, v142
  v_mfma_f32_16x16x32_bf16 a[104:107], a[180:183], v[184:187], a[104:107]
  s_add_u32 s25, s25, 32768
  ds_read_b128 a[148:151], v3 offset:13312
  v_add_f32 v227, v227, v220
  v_add_f32 v227, v227, v221
  v_mfma_f32_16x16x32_bf16 a[108:111], a[180:183], v[188:191], a[108:111]
  s_and_b32 s25, s25, 0x1ffff
  v_exp_f32 v223, v143
  v_mfma_f32_16x16x32_bf16 a[112:115], a[184:187], v[184:187], a[112:115]
  ds_read_b128 a[152:155], v3 offset:14336
  v_cvt_pk_bf16_f32 v182, v220, v221
  v_add_f32 v227, v227, v222
  v_mfma_f32_16x16x32_bf16 a[116:119], a[184:187], v[188:191], a[116:119]
  v_add_f32 v227, v227, v223
  v_cvt_pk_bf16_f32 v183, v222, v223
  v_mfma_f32_16x16x32_bf16 a[120:123], a[188:191], v[184:187], a[120:123]
  s_waitcnt lgkmcnt(3)
  ds_read_b128 a[156:159], v3 offset:15360
  v_max_f32 v5, v226, v227
  v_cmp_lt_f32 vcc, s81, v5
  v_mfma_f32_16x16x32_bf16 a[124:127], a[188:191], v[188:191], a[124:127]
  s_cbranch_vccnz fa_stub17
fa_back17:
  v_add_f32 v230, v230, v226
  v_add_f32 v231, v231, v227
  v_add_u32 v3, 32768, v3
  v_and_b32 v3, 0x1ffff, v3
fa_SSW5:
  v_mfma_f32_16x16x32_bf16 v[128:131], a[128:131], v[64:67], v[200:203]
  s_waitcnt vmcnt(12)
  v_exp_f32 v216, v144
  v_exp_f32 v217, v145
  v_mfma_f32_16x16x32_bf16 v[136:139], a[128:131], v[68:71], v[204:207]
  s_barrier
  v_exp_f32 v218, v146
  v_mfma_f32_16x16x32_bf16 v[132:135], a[132:135], v[64:67], v[200:203]
  ds_read_b128 a[160:163], v3 offset:16384
  ds_read_b128 a[164:167], v3 offset:17408
  v_mfma_f32_16x16x32_bf16 v[140:143], a[132:135], v[68:71], v[204:207]
  s_mov_b32 m0, s24
  v_exp_f32 v219, v147
  v_mfma_f32_16x16x32_bf16 v[128:131], a[136:139], v[72:75], v[128:131]
  ds_read_b128 a[168:171], v3 offset:18432
  buffer_load_dwordx4 v2, s[44:47], s26 offen offset:0 sc1 lds
  v_add_f32 v226, v216, v217
  v_mfma_f32_16x16x32_bf16 v[136:139], a[136:139], v[76:79], v[136:139]
  v_exp_f32 v220, v148
  v_mfma_f32_16x16x32_bf16 v[132:135], a[140:143], v[72:75], v[132:135]
  ds_read_b128 a[172:175], v3 offset:19456
  v_cvt_pk_bf16_f32 v184, v216, v217
  v_add_f32 v226, v226, v218
  v_mfma_f32_16x16x32_bf16 v[140:143], a[140:143], v[76:79], v[140:143]
  s_add_u32 s14, s13, 16384
  s_waitcnt lgkmcnt(4)
  buffer_load_dwordx4 a[200:203], v2, s[40:43], s14 offen offset:2048 sc1
  v_add_f32 v226, v226, v219
  v_mfma_f32_16x16x32_bf16 v[128:131], a[144:147], v[80:83], v[128:131]
  ds_read_b128 a[176:179], v3 offset:20480
  v_cvt_pk_bf16_f32 v185, v218, v219
  v_add_f32 v226, v226, v220
  v_mfma_f32_16x16x32_bf16 v[136:139], a[144:147], v[84:87], v[136:139]
  v_exp_f32 v221, v149
  v_mfma_f32_16x16x32_bf16 v[132:135], a[148:151], v[80:83], v[132:135]
  ds_read_b128 a[180:183], v3 offset:21504
  buffer_load_dwordx4 v2, s[44:47], s26 offen offset:1024 sc1 lds
  v_add_f32 v226, v226, v221
  v_mfma_f32_16x16x32_bf16 v[140:143], a[148:151], v[84:87], v[140:143]
  v_exp_f32 v222, v150
  v_cvt_pk_bf16_f32 v186, v220, v221
  v_mfma_f32_16x16x32_bf16 v[128:131], a[152:155], v[88:91], v[128:131]
  ds_read_b128 a[184:187], v3 offset:22528
  v_add_f32 v226, v226, v222
  v_mfma_f32_16x16x32_bf16 v[136:139], a[152:155], v[92:95], v[136:139]
  v_exp_f32 v223, v151
  v_exp_f32 v216, v152
  v_mfma_f32_16x16x32_bf16 v[132:135], a[156:159], v[88:91], v[132:135]
  ds_read_b128 a[188:191], v3 offset:23552
  buffer_load_dwordx4 a[204:207], v2, s[40:43], s14 offen offset:3072 sc1
  v_mfma_f32_16x16x32_bf16 v[140:143], a[156:159], v[92:95], v[140:143]
  s_waitcnt lgkmcnt(4)
  v_exp_f32 v217, v153
  v_mfma_f32_16x16x32_bf16 a[64:67], a[160:163], v[176:179], a[64:67]
  ds_read_b128 a[128:131], v3 offset:0
  v_add_f32 v226, v226, v223
  v_mfma_f32_16x16x32_bf16 a[68:71], a[160:163], v[180:183], a[68:71]
  v_exp_f32 v218, v154
  v_cvt_pk_bf16_f32 v187, v222, v223
  v_mfma_f32_16x16x32_bf16 a[72:75], a[164:167], v[176:179], a[72:75]
  ds_read_b128 a[132:135], v3 offset:1024
  buffer_load_dwordx4 v2, s[44:47], s26 offen offset:2048 sc1 lds
  v_mfma_f32_16x16x32_bf16 a[76:79], a[164:167], v[180:183], a[76:79]
  v_exp_f32 v219, v155
  v_add_f32 v227, v216, v217
  v_mfma_f32_16x16x32_bf16 a[80:83], a[168:171], v[176:179], a[80:83]
  ds_read_b128 a[136:139], v3 offset:2048
  v_cvt_pk_bf16_f32 v188, v216, v217
  v_add_f32 v227, v227, v218
  v_mfma_f32_16x16x32_bf16 a[84:87], a[168:171], v[180:183], a[84:87]
  s_add_u32 s14, s13, 20480
  buffer_load_dwordx4 a[208:211], v2, s[40:43], s14 offen offset:0 sc1
  v_add_f32 v227, v227, v219
  v_mfma_f32_16x16x32_bf16 a[88:91], a[172:175], v[176:179], a[88:91]
  ds_read_b128 a[140:143], v3 offset:3072
  v_cvt_pk_bf16_f32 v189, v218, v219
  v_exp_f32 v220, v156
  v_mfma_f32_16x16x32_bf16 a[92:95], a[172:175], v[180:183], a[92:95]
  s_waitcnt lgkmcnt(4)
  v_exp_f32 v221, v157
  v_mfma_f32_16x16x32_bf16 a[96:99], a[176:179], v[176:179], a[96:99]
  ds_read_b128 a[144:147], v3 offset:4096
  buffer_load_dwordx4 v2, s[44:47], s26 offen offset:3072 sc1 lds
  v_mfma_f32_16x16x32_bf16 a[100:103], a[176:179], v[180:183], a[100:103]
  s_add_u32 s26, s26, 16384
  v_exp_f32 v222, v158
  v_mfma_f32_16x16x32_bf16 a[104:107], a[180:183], v[176:179], a[104:107]
  s_add_u32 s24, s24, 32768
  ds_read_b128 a[148:151], v3 offset:5120
  v_add_f32 v227, v227, v220
  v_add_f32 v227, v227, v221
  v_mfma_f32_16x16x32_bf16 a[108:111], a[180:183], v[180:183], a[108:111]
  s_and_b32 s24, s24, 0x1ffff
  v_exp_f32 v223, v159
  v_mfma_f32_16x16x32_bf16 a[112:115], a[184:187], v[176:179], a[112:115]
  ds_read_b128 a[152:155], v3 offset:6144
  v_cvt_pk_bf16_f32 v190, v220, v221
  v_add_f32 v227, v227, v222
  v_mfma_f32_16x16x32_bf16 a[116:119], a[184:187], v[180:183], a[116:119]
  v_add_f32 v227, v227, v223
  v_cvt_pk_bf16_f32 v191, v222, v223
  v_mfma_f32_16x16x32_bf16 a[120:123], a[188:191], v[176:179], a[120:123]
  s_waitcnt lgkmcnt(3)
  ds_read_b128 a[156:159], v3 offset:7168
  v_max_f32 v5, v226, v227
  v_cmp_lt_f32 vcc, s81, v5
  v_mfma_f32_16x16x32_bf16 a[124:127], a[188:191], v[180:183], a[124:127]
  s_cbranch_vccnz fa_stub18
fa_back18:
  v_add_f32 v230, v230, v226
  v_add_f32 v231, v231, v227
  v_mfma_f32_16x16x32_bf16 v[144:147], a[128:131], v[64:67], v[200:203]
  ds_read_b128 a[160:163], v3 offset:24576
  v_exp_f32 v216, v128
  v_mfma_f32_16x16x32_bf16 v[152:155], a[128:131], v[68:71], v[204:207]
  v_exp_f32 v217, v129
  v_mfma_f32_16x16x32_bf16 v[148:151], a[132:135], v[64:67], v[200:203]
  ds_read_b128 a[164:167], v3 offset:25600
  v_add_f32 v226, v216, v217
  v_cvt_pk_bf16_f32 v176, v216, v217
  v_mfma_f32_16x16x32_bf16 v[156:159], a[132:135], v[68:71], v[204:207]
  s_mov_b32 m0, s25
  v_exp_f32 v218, v130
  v_mfma_f32_16x16x32_bf16 v[144:147], a[136:139], v[72:75], v[144:147]
  ds_read_b128 a[168:171], v3 offset:26624
  buffer_load_dwordx4 v2, s[48:51], s27 offen offset:0 sc1 lds
  v_add_f32 v226, v226, v218
  v_mfma_f32_16x16x32_bf16 v[152:155], a[136:139], v[76:79], v[152:155]
  v_exp_f32 v219, v131
  v_mfma_f32_16x16x32_bf16 v[148:151], a[140:143], v[72:75], v[148:151]
  ds_read_b128 a[172:175], v3 offset:27648
  v_add_f32 v226, v226, v219
  v_cvt_pk_bf16_f32 v177, v218, v219
  v_mfma_f32_16x16x32_bf16 v[156:159], a[140:143], v[76:79], v[156:159]
  s_add_u32 s14, s13, 20480
  s_waitcnt lgkmcnt(4)
  buffer_load_dwordx4 a[212:215], v2, s[40:43], s14 offen offset:1024 sc1
  v_exp_f32 v220, v132
  v_mfma_f32_16x16x32_bf16 v[144:147], a[144:147], v[80:83], v[144:147]
  ds_read_b128 a[176:179], v3 offset:28672
  v_add_f32 v226, v226, v220
  v_mfma_f32_16x16x32_bf16 v[152:155], a[144:147], v[84:87], v[152:155]
  v_exp_f32 v221, v133
  v_mfma_f32_16x16x32_bf16 v[148:151], a[148:151], v[80:83], v[148:151]
  ds_read_b128 a[180:183], v3 offset:29696
  buffer_load_dwordx4 v2, s[48:51], s27 offen offset:1024 sc1 lds
  v_add_f32 v226, v226, v221
  v_mfma_f32_16x16x32_bf16 v[156:159], a[148:151], v[84:87], v[156:159]
  v_exp_f32 v222, v134
  v_cvt_pk_bf16_f32 v178, v220, v221
  v_mfma_f32_16x16x32_bf16 v[144:147], a[152:155], v[88:91], v[144:147]
  ds_read_b128 a[184:187], v3 offset:30720
  v_add_f32 v226, v226, v222
  v_mfma_f32_16x16x32_bf16 v[152:155], a[152:155], v[92:95], v[152:155]
  v_exp_f32 v223, v135
  v_exp_f32 v216, v136
  v_mfma_f32_16x16x32_bf16 v[148:151], a[156:159], v[88:91], v[148:151]
  ds_read_b128 a[188:191], v3 offset:31744
  buffer_load_dwordx4 a[216:219], v2, s[40:43], s14 offen offset:2048 sc1
  v_mfma_f32_16x16x32_bf16 v[156:159], a[156:159], v[92:95], v[156:159]
  s_waitcnt lgkmcnt(4)
  v_exp_f32 v217, v137
  v_mfma_f32_16x16x32_bf16 a[64:67], a[160:163], v[184:187], a[64:67]
  ds_read_b128 a[128:131], v3 offset:8192
  v_add_f32 v226, v226, v223
  v_mfma_f32_16x16x32_bf16 a[68:71], a[160:163], v[188:191], a[68:71]
  v_exp_f32 v218, v138
  v_cvt_pk_bf16_f32 v179, v222, v223
  v_mfma_f32_16x16x32_bf16 a[72:75], a[164:167], v[184:187], a[72:75]
  ds_read_b128 a[132:135], v3 offset:9216
  buffer_load_dwordx4 v2, s[48:51], s27 offen offset:2048 sc1 lds
  v_mfma_f32_16x16x32_bf16 a[76:79], a[164:167], v[188:191], a[76:79]
  v_exp_f32 v219, v139
  v_add_f32 v227, v216, v217
  v_mfma_f32_16x16x32_bf16 a[80:83], a[168:171], v[184:187], a[80:83]
  ds_read_b128 a[136:139], v3 offset:10240
  v_cvt_pk_bf16_f32 v180, v216, v217
  v_add_f32 v227, v227, v218
  v_mfma_f32_16x16x32_bf16 a[84:87], a[168:171], v[188:191], a[84:87]
  buffer_load_dwordx4 a[220:223], v2, s[40:43], s14 offen offset:3072 sc1
  v_add_f32 v227, v227, v219
  v_mfma_f32_16x16x32_bf16 a[88:91], a[172:175], v[184:187], a[88:91]
  ds_read_b128 a[140:143], v3 offset:11264
  v_cvt_pk_bf16_f32 v181, v218, v219
  v_exp_f32 v220, v140
  v_mfma_f32_16x16x32_bf16 a[92:95], a[172:175], v[188:191], a[92:95]
  s_waitcnt lgkmcnt(4)
  v_exp_f32 v221, v141
  v_mfma_f32_16x16x32_bf16 a[96:99], a[176:179], v[184:187], a[96:99]
  ds_read_b128 a[144:147], v3 offset:12288
  buffer_load_dwordx4 v2, s[48:51], s27 offen offset:3072 sc1 lds
  v_mfma_f32_16x16x32_bf16 a[100:103], a[176:179], v[188:191], a[100:103]
  s_add_u32 s27, s27, 16384
  v_exp_f32 v222, v142
  v_mfma_f32_16x16x32_bf16 a[104:107], a[180:183], v[184:187], a[104:107]
  s_add_u32 s25, s25, 32768
  ds_read_b128 a[148:151], v3 offset:13312
  v_add_f32 v227, v227, v220
  v_add_f32 v227, v227, v221
  v_mfma_f32_16x16x32_bf16 a[108:111], a[180:183], v[188:191], a[108:111]
  s_and_b32 s25, s25, 0x1ffff
  v_exp_f32 v223, v143
  v_mfma_f32_16x16x32_bf16 a[112:115], a[184:187], v[184:187], a[112:115]
  ds_read_b128 a[152:155], v3 offset:14336
  v_cvt_pk_bf16_f32 v182, v220, v221
  v_add_f32 v227, v227, v222
  v_mfma_f32_16x16x32_bf16 a[116:119], a[184:187], v[188:191], a[116:119]
  v_add_f32 v227, v227, v223
  v_cvt_pk_bf16_f32 v183, v222, v223
  v_mfma_f32_16x16x32_bf16 a[120:123], a[188:191], v[184:187], a[120:123]
  s_waitcnt lgkmcnt(3)
  ds_read_b128 a[156:159], v3 offset:15360
  v_max_f32 v5, v226, v227
  v_cmp_lt_f32 vcc, s81, v5
  v_mfma_f32_16x16x32_bf16 a[124:127], a[188:191], v[188:191], a[124:127]
  s_cbranch_vccnz fa_stub19
fa_back19:
  v_add_f32 v230, v230, v226
  v_add_f32 v231, v231, v227
  v_add_u32 v3, 32768, v3
  v_and_b32 v3, 0x1ffff, v3
fa_SSW4:
  v_mfma_f32_16x16x32_bf16 v[128:131], a[128:131], v[64:67], v[200:203]
  s_waitcnt vmcnt(12)
  v_exp_f32 v216, v144
  v_exp_f32 v217, v145
  v_mfma_f32_16x16x32_bf16 v[136:139], a[128:131], v[68:71], v[204:207]
  s_barrier
  v_exp_f32 v218, v146
  v_mfma_f32_16x16x32_bf16 v[132:135], a[132:135], v[64:67], v[200:203]
  ds_read_b128 a[160:163], v3 offset:16384
  ds_read_b128 a[164:167], v3 offset:17408
  v_mfma_f32_16x16x32_bf16 v[140:143], a[132:135], v[68:71], v[204:207]
  s_mov_b32 m0, s24
  v_exp_f32 v219, v147
  v_mfma_f32_16x16x32_bf16 v[128:131], a[136:139], v[72:75], v[128:131]
  ds_read_b128 a[168:171], v3 offset:18432
  buffer_load_dwordx4 v2, s[44:47], s26 offen offset:0 sc1 lds
  v_add_f32 v226, v216, v217
  v_mfma_f32_16x16x32_bf16 v[136:139], a[136:139], v[76:79], v[136:139]
  v_exp_f32 v220, v148
  v_mfma_f32_16x16x32_bf16 v[132:135], a[140:143], v[72:75], v[132:135]
  ds_read_b128 a[172:175], v3 offset:19456
  v_cvt_pk_bf16_f32 v184, v216, v217
  v_add_f32 v226, v226, v218
  v_mfma_f32_16x16x32_bf16 v[140:143], a[140:143], v[76:79], v[140:143]
  s_add_u32 s14, s13, 24576
  s_waitcnt lgkmcnt(4)
  buffer_load_dwordx4 a[224:227], v2, s[40:43], s14 offen offset:0 sc1
  v_add_f32 v226, v226, v219
  v_mfma_f32_16x16x32_bf16 v[128:131], a[144:147], v[80:83], v[128:131]
  ds_read_b128 a[176:179], v3 offset:20480
  v_cvt_pk_bf16_f32 v185, v218, v219
  v_add_f32 v226, v226, v220
  v_mfma_f32_16x16x32_bf16 v[136:139], a[144:147], v[84:87], v[136:139]
  v_exp_f32 v221, v149
  v_mfma_f32_16x16x32_bf16 v[132:135], a[148:151], v[80:83], v[132:135]
  ds_read_b128 a[180:183], v3 offset:21504
  buffer_load_dwordx4 v2, s[44:47], s26 offen offset:1024 sc1 lds
  v_add_f32 v226, v226, v221
  v_mfma_f32_16x16x32_bf16 v[140:143], a[148:151], v[84:87], v[140:143]
  v_exp_f32 v222, v150
  v_cvt_pk_bf16_f32 v186, v220, v221
  v_mfma_f32_16x16x32_bf16 v[128:131], a[152:155], v[88:91], v[128:131]
  ds_read_b128 a[184:187], v3 offset:22528
  v_add_f32 v226, v226, v222
  v_mfma_f32_16x16x32_bf16 v[136:139], a[152:155], v[92:95], v[136:139]
  v_exp_f32 v223, v151
  v_exp_f32 v216, v152
  v_mfma_f32_16x16x32_bf16 v[132:135], a[156:159], v[88:91], v[132:135]
  ds_read_b128 a[188:191], v3 offset:23552
  buffer_load_dwordx4 a[228:231], v2, s[40:43], s14 offen offset:1024 sc1
  v_mfma_f32_16x16x32_bf16 v[140:143], a[156:159], v[92:95], v[140:143]
  s_waitcnt lgkmcnt(4)
  v_exp_f32 v217, v153
  v_mfma_f32_16x16x32_bf16 a[64:67], a[160:163], v[176:179], a[64:67]
  ds_read_b128 a[128:131], v3 offset:0
  v_add_f32 v226, v226, v223
  v_mfma_f32_16x16x32_bf16 a[68:71], a[160:163], v[180:183], a[68:71]
  v_exp_f32 v218, v154
  v_cvt_pk_bf16_f32 v187, v222, v223
  v_mfma_f32_16x16x32_bf16 a[72:75], a[164:167], v[176:179], a[72:75]
  ds_read_b128 a[132:135], v3 offset:1024
  buffer_load_dwordx4 v2, s[44:47], s26 offen offset:2048 sc1 lds
  v_mfma_f32_16x16x32_bf16 a[76:79], a[164:167], v[180:183], a[76:79]
  v_exp_f32 v219, v155
  v_add_f32 v227, v216, v217
  v_mfma_f32_16x16x32_bf16 a[80:83], a[168:171], v[176:179], a[80:83]
  ds_read_b128 a[136:139], v3 offset:2048
  v_cvt_pk_bf16_f32 v188, v216, v217
  v_add_f32 v227, v227, v218
  v_mfma_f32_16x16x32_bf16 a[84:87], a[168:171], v[180:183], a[84:87]
  buffer_load_dwordx4 a[232:235], v2, s[40:43], s14 offen offset:2048 sc1
  v_add_f32 v227, v227, v219
  v_mfma_f32_16x16x32_bf16 a[88:91], a[172:175], v[176:179], a[88:91]
  ds_read_b128 a[140:143], v3 offset:3072
  v_cvt_pk_bf16_f32 v189, v218, v219
  v_exp_f32 v220, v156
  v_mfma_f32_16x16x32_bf16 a[92:95], a[172:175], v[180:183], a[92:95]
  s_waitcnt lgkmcnt(4)
  v_exp_f32 v221, v157
  v_mfma_f32_16x16x32_bf16 a[96:99], a[176:179], v[176:179], a[96:99]
  ds_read_b128 a[144:147], v3 offset:4096
  buffer_load_dwordx4 v2, s[44:47], s26 offen offset:3072 sc1 lds
  v_mfma_f32_16x16x32_bf16 a[100:103], a[176:179], v[180:183], a[100:103]
  s_add_u32 s26, s26, 16384
  v_exp_f32 v222, v158
  v_mfma_f32_16x16x32_bf16 a[104:107], a[180:183], v[176:179], a[104:107]
  s_add_u32 s24, s24, 32768
  ds_read_b128 a[148:151], v3 offset:5120
  v_add_f32 v227, v227, v220
  v_add_f32 v227, v227, v221
  v_mfma_f32_16x16x32_bf16 a[108:111], a[180:183], v[180:183], a[108:111]
  s_and_b32 s24, s24, 0x1ffff
  v_exp_f32 v223, v159
  v_mfma_f32_16x16x32_bf16 a[112:115], a[184:187], v[176:179], a[112:115]
  ds_read_b128 a[152:155], v3 offset:6144
  v_cvt_pk_bf16_f32 v190, v220, v221
  v_add_f32 v227, v227, v222
  v_mfma_f32_16x16x32_bf16 a[116:119], a[184:187], v[180:183], a[116:119]
  v_add_f32 v227, v227, v223
  v_cvt_pk_bf16_f32 v191, v222, v223
  v_mfma_f32_16x16x32_bf16 a[120:123], a[188:191], v[176:179], a[120:123]
  s_waitcnt lgkmcnt(3)
  ds_read_b128 a[156:159], v3 offset:7168
  v_max_f32 v5, v226, v227
  v_cmp_lt_f32 vcc, s81, v5
  v_mfma_f32_16x16x32_bf16 a[124:127], a[188:191], v[180:183], a[124:127]
  s_cbranch_vccnz fa_stub20
fa_back20:
  v_add_f32 v230, v230, v226
  v_add_f32 v231, v231, v227
  v_mfma_f32_16x16x32_bf16 v[144:147], a[128:131], v[64:67], v[200:203]
  ds_read_b128 a[160:163], v3 offset:24576
  v_exp_f32 v216, v128
  v_mfma_f32_16x16x32_bf16 v[152:155], a[128:131], v[68:71], v[204:207]
  v_exp_f32 v217, v129
  v_mfma_f32_16x16x32_bf16 v[148:151], a[132:135], v[64:67], v[200:203]
  ds_read_b128 a[164:167], v3 offset:25600
  v_add_f32 v226, v216, v217
  v_cvt_pk_bf16_f32 v176, v216, v217
  v_mfma_f32_16x16x32_bf16 v[156:159], a[132:135], v[68:71], v[204:207]
  s_mov_b32 m0, s25
  v_exp_f32 v218, v130
  v_mfma_f32_16x16x32_bf16 v[144:147], a[136:139], v[72:75], v[144:147]
  ds_read_b128 a[168:171], v3 offset:26624
  buffer_load_dwordx4 v2, s[48:51], s27 offen offset:0 sc1 lds
  v_add_f32 v226, v226, v218
  v_mfma_f32_16x16x32_bf16 v[152:155], a[136:139], v[76:79], v[152:155]
  v_exp_f32 v219, v131
  v_mfma_f32_16x16x32_bf16 v[148:151], a[140:143], v[72:75], v[148:151]
  ds_read_b128 a[172:175], v3 offset:27648
  v_add_f32 v226, v226, v219
  v_cvt_pk_bf16_f32 v177, v218, v219
  v_mfma_f32_16x16x32_bf16 v[156:159], a[140:143], v[76:79], v[156:159]
  s_add_u32 s14, s13, 24576
  s_waitcnt lgkmcnt(4)
  buffer_load_dwordx4 a[236:239], v2, s[40:43], s14 offen offset:3072 sc1
  v_exp_f32 v220, v132
  v_mfma_f32_16x16x32_bf16 v[144:147], a[144:147], v[80:83], v[144:147]
  ds_read_b128 a[176:179], v3 offset:28672
  v_add_f32 v226, v226, v220
  v_mfma_f32_16x16x32_bf16 v[152:155], a[144:147], v[84:87], v[152:155]
  v_exp_f32 v221, v133
  v_mfma_f32_16x16x32_bf16 v[148:151], a[148:151], v[80:83], v[148:151]
  ds_read_b128 a[180:183], v3 offset:29696
  buffer_load_dwordx4 v2, s[48:51], s27 offen offset:1024 sc1 lds
  v_add_f32 v226, v226, v221
  v_mfma_f32_16x16x32_bf16 v[156:159], a[148:151], v[84:87], v[156:159]
  v_exp_f32 v222, v134
  v_cvt_pk_bf16_f32 v178, v220, v221
  v_mfma_f32_16x16x32_bf16 v[144:147], a[152:155], v[88:91], v[144:147]
  ds_read_b128 a[184:187], v3 offset:30720
  v_add_f32 v226, v226, v222
  v_mfma_f32_16x16x32_bf16 v[152:155], a[152:155], v[92:95], v[152:155]
  v_exp_f32 v223, v135
  v_exp_f32 v216, v136
  v_mfma_f32_16x16x32_bf16 v[148:151], a[156:159], v[88:91], v[148:151]
  s_add_u32 s14, s13, 28672
  ds_read_b128 a[188:191], v3 offset:31744
  buffer_load_dwordx4 a[240:243], v2, s[40:43], s14 offen offset:0 sc1
  v_mfma_f32_16x16x32_bf16 v[156:159], a[156:159], v[92:95], v[156:159]
  s_waitcnt lgkmcnt(4)
  v_exp_f32 v217, v137
  v_mfma_f32_16x16x32_bf16 a[64:67], a[160:163], v[184:187], a[64:67]
  ds_read_b128 a[128:131], v3 offset:8192
  v_add_f32 v226, v226, v223
  v_mfma_f32_16x16x32_bf16 a[68:71], a[160:163], v[188:191], a[68:71]
  v_exp_f32 v218, v138
  v_cvt_pk_bf16_f32 v179, v222, v223
  v_mfma_f32_16x16x32_bf16 a[72:75], a[164:167], v[184:187], a[72:75]
  ds_read_b128 a[132:135], v3 offset:9216
  buffer_load_dwordx4 v2, s[48:51], s27 offen offset:2048 sc1 lds
  v_mfma_f32_16x16x32_bf16 a[76:79], a[164:167], v[188:191], a[76:79]
  v_exp_f32 v219, v139
  v_add_f32 v227, v216, v217
  v_mfma_f32_16x16x32_bf16 a[80:83], a[168:171], v[184:187], a[80:83]
  ds_read_b128 a[136:139], v3 offset:10240
  v_cvt_pk_bf16_f32 v180, v216, v217
  v_add_f32 v227, v227, v218
  v_mfma_f32_16x16x32_bf16 a[84:87], a[168:171], v[188:191], a[84:87]
  buffer_load_dwordx4 a[244:247], v2, s[40:43], s14 offen offset:1024 sc1
  v_add_f32 v227, v227, v219
  v_mfma_f32_16x16x32_bf16 a[88:91], a[172:175], v[184:187], a[88:91]
  ds_read_b128 a[140:143], v3 offset:11264
  v_cvt_pk_bf16_f32 v181, v218, v219
  v_exp_f32 v220, v140
  v_mfma_f32_16x16x32_bf16 a[92:95], a[172:175], v[188:191], a[92:95]
  s_waitcnt lgkmcnt(4)
  v_exp_f32 v221, v141
  v_mfma_f32_16x16x32_bf16 a[96:99], a[176:179], v[184:187], a[96:99]
  ds_read_b128 a[144:147], v3 offset:12288
  buffer_load_dwordx4 v2, s[48:51], s27 offen offset:3072 sc1 lds
  v_mfma_f32_16x16x32_bf16 a[100:103], a[176:179], v[188:191], a[100:103]
  s_add_u32 s27, s27, 16384
  v_exp_f32 v222, v142
  v_mfma_f32_16x16x32_bf16 a[104:107], a[180:183], v[184:187], a[104:107]
  s_add_u32 s25, s25, 32768
  ds_read_b128 a[148:151], v3 offset:13312
  v_add_f32 v227, v227, v220
  v_add_f32 v227, v227, v221
  v_mfma_f32_16x16x32_bf16 a[108:111], a[180:183], v[188:191], a[108:111]
  s_and_b32 s25, s25, 0x1ffff
  v_exp_f32 v223, v143
  v_mfma_f32_16x16x32_bf16 a[112:115], a[184:187], v[184:187], a[112:115]
  ds_read_b128 a[152:155], v3 offset:14336
  v_cvt_pk_bf16_f32 v182, v220, v221
  v_add_f32 v227, v227, v222
  v_mfma_f32_16x16x32_bf16 a[116:119], a[184:187], v[188:191], a[116:119]
  v_add_f32 v227, v227, v223
  v_cvt_pk_bf16_f32 v183, v222, v223
  v_mfma_f32_16x16x32_bf16 a[120:123], a[188:191], v[184:187], a[120:123]
  s_waitcnt lgkmcnt(3)
  ds_read_b128 a[156:159], v3 offset:15360
  v_max_f32 v5, v226, v227
  v_cmp_lt_f32 vcc, s81, v5
  v_mfma_f32_16x16x32_bf16 a[124:127], a[188:191], v[188:191], a[124:127]
  s_cbranch_vccnz fa_stub21
fa_back21:
  v_add_f32 v230, v230, v226
  v_add_f32 v231, v231, v227
  v_add_u32 v3, 32768, v3
  v_and_b32 v3, 0x1ffff, v3
fa_SSW3:
  v_mfma_f32_16x16x32_bf16 v[128:131], a[128:131], v[64:67], v[200:203]
  s_waitcnt vmcnt(12)
  v_exp_f32 v216, v144
  v_exp_f32 v217, v145
  v_mfma_f32_16x16x32_bf16 v[136:139], a[128:131], v[68:71], v[204:207]
  s_barrier
  v_exp_f32 v218, v146
  v_mfma_f32_16x16x32_bf16 v[132:135], a[132:135], v[64:67], v[200:203]
  ds_read_b128 a[160:163], v3 offset:16384
  ds_read_b128 a[164:167], v3 offset:17408
  v_mfma_f32_16x16x32_bf16 v[140:143], a[132:135], v[68:71], v[204:207]
  s_mov_b32 m0, s24
  v_exp_f32 v219, v147
  v_mfma_f32_16x16x32_bf16 v[128:131], a[136:139], v[72:75], v[128:131]
  ds_read_b128 a[168:171], v3 offset:18432
  buffer_load_dwordx4 v2, s[44:47], s26 offen offset:0 sc1 lds
  v_add_f32 v226, v216, v217
  v_mfma_f32_16x16x32_bf16 v[136:139], a[136:139], v[76:79], v[136:139]
  v_exp_f32 v220, v148
  v_mfma_f32_16x16x32_bf16 v[132:135], a[140:143], v[72:75], v[132:135]
  ds_read_b128 a[172:175], v3 offset:19456
  v_cvt_pk_bf16_f32 v184, v216, v217
  v_add_f32 v226, v226, v218
  v_mfma_f32_16x16x32_bf16 v[140:143], a[140:143], v[76:79], v[140:143]
  s_add_u32 s14, s13, 28672
  s_waitcnt lgkmcnt(4)
  buffer_load_dwordx4 a[248:251], v2, s[40:43], s14 offen offset:2048 sc1
  v_add_f32 v226, v226, v219
  v_mfma_f32_16x16x32_bf16 v[128:131], a[144:147], v[80:83], v[128:131]
  ds_read_b128 a[176:179], v3 offset:20480
  v_cvt_pk_bf16_f32 v185, v218, v219
  v_add_f32 v226, v226, v220
  v_mfma_f32_16x16x32_bf16 v[136:139], a[144:147], v[84:87], v[136:139]
  v_exp_f32 v221, v149
  v_mfma_f32_16x16x32_bf16 v[132:135], a[148:151], v[80:83], v[132:135]
  ds_read_b128 a[180:183], v3 offset:21504
  buffer_load_dwordx4 v2, s[44:47], s26 offen offset:1024 sc1 lds
  v_add_f32 v226, v226, v221
  v_mfma_f32_16x16x32_bf16 v[140:143], a[148:151], v[84:87], v[140:143]
  v_exp_f32 v222, v150
  v_cvt_pk_bf16_f32 v186, v220, v221
  v_mfma_f32_16x16x32_bf16 v[128:131], a[152:155], v[88:91], v[128:131]
  ds_read_b128 a[184:187], v3 offset:22528
  v_add_f32 v226, v226, v222
  v_mfma_f32_16x16x32_bf16 v[136:139], a[152:155], v[92:95], v[136:139]
  v_exp_f32 v223, v151
  v_exp_f32 v216, v152
  v_mfma_f32_16x16x32_bf16 v[132:135], a[156:159], v[88:91], v[132:135]
  ds_read_b128 a[188:191], v3 offset:23552
  buffer_load_dwordx4 a[252:255], v2, s[40:43], s14 offen offset:3072 sc1
  v_mfma_f32_16x16x32_bf16 v[140:143], a[156:159], v[92:95], v[140:143]
  s_waitcnt lgkmcnt(4)
  v_exp_f32 v217, v153
  v_mfma_f32_16x16x32_bf16 a[64:67], a[160:163], v[176:179], a[64:67]
  ds_read_b128 a[128:131], v3 offset:0
  v_add_f32 v226, v226, v223
  v_mfma_f32_16x16x32_bf16 a[68:71], a[160:163], v[180:183], a[68:71]
  v_exp_f32 v218, v154
  v_cvt_pk_bf16_f32 v187, v222, v223
  v_mfma_f32_16x16x32_bf16 a[72:75], a[164:167], v[176:179], a[72:75]
  ds_read_b128 a[132:135], v3 offset:1024
  buffer_load_dwordx4 v2, s[44:47], s26 offen offset:2048 sc1 lds
  v_mfma_f32_16x16x32_bf16 a[76:79], a[164:167], v[180:183], a[76:79]
  v_exp_f32 v219, v155
  v_add_f32 v227, v216, v217
  v_mfma_f32_16x16x32_bf16 a[80:83], a[168:171], v[176:179], a[80:83]
  ds_read_b128 a[136:139], v3 offset:2048
  v_cvt_pk_bf16_f32 v188, v216, v217
  v_add_f32 v227, v227, v218
  v_mfma_f32_16x16x32_bf16 a[84:87], a[168:171], v[180:183], a[84:87]
  s_add_u32 s14, s13, 32768
  buffer_load_dwordx4 v[32:35], v2, s[40:43], s14 offen offset:0 sc1
  v_add_f32 v227, v227, v219
  v_mfma_f32_16x16x32_bf16 a[88:91], a[172:175], v[176:179], a[88:91]
  ds_read_b128 a[140:143], v3 offset:3072
  v_cvt_pk_bf16_f32 v189, v218, v219
  v_exp_f32 v220, v156
  v_mfma_f32_16x16x32_bf16 a[92:95], a[172:175], v[180:183], a[92:95]
  s_waitcnt lgkmcnt(4)
  v_exp_f32 v221, v157
  v_mfma_f32_16x16x32_bf16 a[96:99], a[176:179], v[176:179], a[96:99]
  ds_read_b128 a[144:147], v3 offset:4096
  buffer_load_dwordx4 v2, s[44:47], s26 offen offset:3072 sc1 lds
  v_mfma_f32_16x16x32_bf16 a[100:103], a[176:179], v[180:183], a[100:103]
  s_add_u32 s26, s26, 16384
  v_exp_f32 v222, v158
  v_mfma_f32_16x16x32_bf16 a[104:107], a[180:183], v[176:179], a[104:107]
  s_add_u32 s24, s24, 32768
  ds_read_b128 a[148:151], v3 offset:5120
  v_add_f32 v227, v227, v220
  v_add_f32 v227, v227, v221
  v_mfma_f32_16x16x32_bf16 a[108:111], a[180:183], v[180:183], a[108:111]
  s_and_b32 s24, s24, 0x1ffff
  v_exp_f32 v223, v159
  v_mfma_f32_16x16x32_bf16 a[112:115], a[184:187], v[176:179], a[112:115]
  ds_read_b128 a[152:155], v3 offset:6144
  v_cvt_pk_bf16_f32 v190, v220, v221
  v_add_f32 v227, v227, v222
  v_mfma_f32_16x16x32_bf16 a[116:119], a[184:187], v[180:183], a[116:119]
  v_add_f32 v227, v227, v223
  v_cvt_pk_bf16_f32 v191, v222, v223
  v_mfma_f32_16x16x32_bf16 a[120:123], a[188:191], v[176:179], a[120:123]
  s_waitcnt lgkmcnt(3)
  ds_read_b128 a[156:159], v3 offset:7168
  v_max_f32 v5, v226, v227
  v_cmp_lt_f32 vcc, s81, v5
  v_mfma_f32_16x16x32_bf16 a[124:127], a[188:191], v[180:183], a[124:127]
  s_cbranch_vccnz fa_stub22
fa_back22:
  v_add_f32 v230, v230, v226
  v_add_f32 v231, v231, v227
  v_mfma_f32_16x16x32_bf16 v[144:147], a[128:131], v[64:67], v[200:203]
  ds_read_b128 a[160:163], v3 offset:24576
  v_exp_f32 v216, v128
  v_mfma_f32_16x16x32_bf16 v[152:155], a[128:131], v[68:71], v[204:207]
  v_exp_f32 v217, v129
  v_mfma_f32_16x16x32_bf16 v[148:151], a[132:135], v[64:67], v[200:203]
  ds_read_b128 a[164:167], v3 offset:25600
  v_add_f32 v226, v216, v217
  v_cvt_pk_bf16_f32 v176, v216, v217
  v_mfma_f32_16x16x32_bf16 v[156:159], a[132:135], v[68:71], v[204:207]
  s_mov_b32 m0, s25
  v_exp_f32 v218, v130
  v_mfma_f32_16x16x32_bf16 v[144:147], a[136:139], v[72:75], v[144:147]
  ds_read_b128 a[168:171], v3 offset:26624
  buffer_load_dwordx4 v2, s[48:51], s27 offen offset:0 sc1 lds
  v_add_f32 v226, v226, v218
  v_mfma_f32_16x16x32_bf16 v[152:155], a[136:139], v[76:79], v[152:155]
  v_exp_f32 v219, v131
  v_mfma_f32_16x16x32_bf16 v[148:151], a[140:143], v[72:75], v[148:151]
  ds_read_b128 a[172:175], v3 offset:27648
  v_add_f32 v226, v226, v219
  v_cvt_pk_bf16_f32 v177, v218, v219
  v_mfma_f32_16x16x32_bf16 v[156:159], a[140:143], v[76:79], v[156:159]
  s_add_u32 s14, s13, 32768
  s_waitcnt lgkmcnt(4)
  buffer_load_dwordx4 v[36:39], v2, s[40:43], s14 offen offset:1024 sc1
  v_exp_f32 v220, v132
  v_mfma_f32_16x16x32_bf16 v[144:147], a[144:147], v[80:83], v[144:147]
  ds_read_b128 a[176:179], v3 offset:28672
  v_add_f32 v226, v226, v220
  v_mfma_f32_16x16x32_bf16 v[152:155], a[144:147], v[84:87], v[152:155]
  v_exp_f32 v221, v133
  v_mfma_f32_16x16x32_bf16 v[148:151], a[148:151], v[80:83], v[148:151]
  ds_read_b128 a[180:183], v3 offset:29696
  buffer_load_dwordx4 v2, s[48:51], s27 offen offset:1024 sc1 lds
  v_add_f32 v226, v226, v221
  v_mfma_f32_16x16x32_bf16 v[156:159], a[148:151], v[84:87], v[156:159]
  v_exp_f32 v222, v134
  v_cvt_pk_bf16_f32 v178, v220, v221
  v_mfma_f32_16x16x32_bf16 v[144:147], a[152:155], v[88:91], v[144:147]
  ds_read_b128 a[184:187], v3 offset:30720
  v_add_f32 v226, v226, v222
  v_mfma_f32_16x16x32_bf16 v[152:155], a[152:155], v[92:95], v[152:155]
  v_exp_f32 v223, v135
  v_exp_f32 v216, v136
  v_mfma_f32_16x16x32_bf16 v[148:151], a[156:159], v[88:91], v[148:151]
  ds_read_b128 a[188:191], v3 offset:31744
  buffer_load_dwordx4 v[40:43], v2, s[40:43], s14 offen offset:2048 sc1
  v_mfma_f32_16x16x32_bf16 v[156:159], a[156:159], v[92:95], v[156:159]
  s_waitcnt lgkmcnt(4)
  v_exp_f32 v217, v137
  v_mfma_f32_16x16x32_bf16 a[64:67], a[160:163], v[184:187], a[64:67]
  ds_read_b128 a[128:131], v3 offset:8192
  v_add_f32 v226, v226, v223
  v_mfma_f32_16x16x32_bf16 a[68:71], a[160:163], v[188:191], a[68:71]
  v_exp_f32 v218, v138
  v_cvt_pk_bf16_f32 v179, v222, v223
  v_mfma_f32_16x16x32_bf16 a[72:75], a[164:167], v[184:187], a[72:75]
  ds_read_b128 a[132:135], v3 offset:9216
  buffer_load_dwordx4 v2, s[48:51], s27 offen offset:2048 sc1 lds
  v_mfma_f32_16x16x32_bf16 a[76:79], a[164:167], v[188:191], a[76:79]
  v_exp_f32 v219, v139
  v_add_f32 v227, v216, v217
  v_mfma_f32_16x16x32_bf16 a[80:83], a[168:171], v[184:187], a[80:83]
  ds_read_b128 a[136:139], v3 offset:10240
  v_cvt_pk_bf16_f32 v180, v216, v217
  v_add_f32 v227, v227, v218
  v_mfma_f32_16x16x32_bf16 a[84:87], a[168:171], v[188:191], a[84:87]
  buffer_load_dwordx4 v[44:47], v2, s[40:43], s14 offen offset:3072 sc1
  v_add_f32 v227, v227, v219
  v_mfma_f32_16x16x32_bf16 a[88:91], a[172:175], v[184:187], a[88:91]
  ds_read_b128 a[140:143], v3 offset:11264
  v_cvt_pk_bf16_f32 v181, v218, v219
  v_exp_f32 v220, v140
  v_mfma_f32_16x16x32_bf16 a[92:95], a[172:175], v[188:191], a[92:95]
  s_waitcnt lgkmcnt(4)
  v_exp_f32 v221, v141
  v_mfma_f32_16x16x32_bf16 a[96:99], a[176:179], v[184:187], a[96:99]
  ds_read_b128 a[144:147], v3 offset:12288
  buffer_load_dwordx4 v2, s[48:51], s27 offen offset:3072 sc1 lds
  v_mfma_f32_16x16x32_bf16 a[100:103], a[176:179], v[188:191], a[100:103]
  s_add_u32 s27, s27, 16384
  v_exp_f32 v222, v142
  v_mfma_f32_16x16x32_bf16 a[104:107], a[180:183], v[184:187], a[104:107]
  s_add_u32 s25, s25, 32768
  ds_read_b128 a[148:151], v3 offset:13312
  v_add_f32 v227, v227, v220
  v_add_f32 v227, v227, v221
  v_mfma_f32_16x16x32_bf16 a[108:111], a[180:183], v[188:191], a[108:111]
  s_and_b32 s25, s25, 0x1ffff
  v_exp_f32 v223, v143
  v_mfma_f32_16x16x32_bf16 a[112:115], a[184:187], v[184:187], a[112:115]
  ds_read_b128 a[152:155], v3 offset:14336
  v_cvt_pk_bf16_f32 v182, v220, v221
  v_add_f32 v227, v227, v222
  v_mfma_f32_16x16x32_bf16 a[116:119], a[184:187], v[188:191], a[116:119]
  v_add_f32 v227, v227, v223
  v_cvt_pk_bf16_f32 v183, v222, v223
  v_mfma_f32_16x16x32_bf16 a[120:123], a[188:191], v[184:187], a[120:123]
  s_waitcnt lgkmcnt(3)
  ds_read_b128 a[156:159], v3 offset:15360
  v_max_f32 v5, v226, v227
  v_cmp_lt_f32 vcc, s81, v5
  v_mfma_f32_16x16x32_bf16 a[124:127], a[188:191], v[188:191], a[124:127]
  s_cbranch_vccnz fa_stub23
fa_back23:
  v_add_f32 v230, v230, v226
  v_add_f32 v231, v231, v227
  v_add_u32 v3, 32768, v3
  v_and_b32 v3, 0x1ffff, v3
fa_SSW2:
  v_mfma_f32_16x16x32_bf16 v[128:131], a[128:131], v[64:67], v[200:203]
  s_waitcnt vmcnt(12)
  v_exp_f32 v216, v144
  v_exp_f32 v217, v145
  v_mfma_f32_16x16x32_bf16 v[136:139], a[128:131], v[68:71], v[204:207]
  s_barrier
  v_exp_f32 v218, v146
  v_mfma_f32_16x16x32_bf16 v[132:135], a[132:135], v[64:67], v[200:203]
  ds_read_b128 a[160:163], v3 offset:16384
  ds_read_b128 a[164:167], v3 offset:17408
  v_mfma_f32_16x16x32_bf16 v[140:143], a[132:135], v[68:71], v[204:207]
  s_mov_b32 m0, s24
  v_exp_f32 v219, v147
  v_mfma_f32_16x16x32_bf16 v[128:131], a[136:139], v[72:75], v[128:131]
  ds_read_b128 a[168:171], v3 offset:18432
  buffer_load_dwordx4 v2, s[44:47], s26 offen offset:0 sc1 lds
  v_add_f32 v226, v216, v217
  v_mfma_f32_16x16x32_bf16 v[136:139], a[136:139], v[76:79], v[136:139]
  v_exp_f32 v220, v148
  v_mfma_f32_16x16x32_bf16 v[132:135], a[140:143], v[72:75], v[132:135]
  ds_read_b128 a[172:175], v3 offset:19456
  v_cvt_pk_bf16_f32 v184, v216, v217
  v_add_f32 v226, v226, v218
  v_mfma_f32_16x16x32_bf16 v[140:143], a[140:143], v[76:79], v[140:143]
  s_add_u32 s14, s13, 36864
  s_waitcnt lgkmcnt(4)
  buffer_load_dwordx4 v[48:51], v2, s[40:43], s14 offen offset:0 sc1
  v_add_f32 v226, v226, v219
  v_mfma_f32_16x16x32_bf16 v[128:131], a[144:147], v[80:83], v[128:131]
  ds_read_b128 a[176:179], v3 offset:20480
  v_cvt_pk_bf16_f32 v185, v218, v219
  v_add_f32 v226, v226, v220
  v_mfma_f32_16x16x32_bf16 v[136:139], a[144:147], v[84:87], v[136:139]
  v_exp_f32 v221, v149
  v_mfma_f32_16x16x32_bf16 v[132:135], a[148:151], v[80:83], v[132:135]
  ds_read_b128 a[180:183], v3 offset:21504
  buffer_load_dwordx4 v2, s[44:47], s26 offen offset:1024 sc1 lds
  v_add_f32 v226, v226, v221
  v_mfma_f32_16x16x32_bf16 v[140:143], a[148:151], v[84:87], v[140:143]
  v_exp_f32 v222, v150
  v_cvt_pk_bf16_f32 v186, v220, v221
  v_mfma_f32_16x16x32_bf16 v[128:131], a[152:155], v[88:91], v[128:131]
  ds_read_b128 a[184:187], v3 offset:22528
  v_add_f32 v226, v226, v222
  v_mfma_f32_16x16x32_bf16 v[136:139], a[152:155], v[92:95], v[136:139]
  v_exp_f32 v223, v151
  v_exp_f32 v216, v152
  v_mfma_f32_16x16x32_bf16 v[132:135], a[156:159], v[88:91], v[132:135]
  ds_read_b128 a[188:191], v3 offset:23552
  buffer_load_dwordx4 v[52:55], v2, s[40:43], s14 offen offset:1024 sc1
  v_mfma_f32_16x16x32_bf16 v[140:143], a[156:159], v[92:95], v[140:143]
  s_waitcnt lgkmcnt(4)
  v_exp_f32 v217, v153
  v_mfma_f32_16x16x32_bf16 a[64:67], a[160:163], v[176:179], a[64:67]
  ds_read_b128 a[128:131], v3 offset:0
  v_add_f32 v226, v226, v223
  v_mfma_f32_16x16x32_bf16 a[68:71], a[160:163], v[180:183], a[68:71]
  v_exp_f32 v218, v154
  v_cvt_pk_bf16_f32 v187, v222, v223
  v_mfma_f32_16x16x32_bf16 a[72:75], a[164:167], v[176:179], a[72:75]
  ds_read_b128 a[132:135], v3 offset:1024
  buffer_load_dwordx4 v2, s[44:47], s26 offen offset:2048 sc1 lds
  v_mfma_f32_16x16x32_bf16 a[76:79], a[164:167], v[180:183], a[76:79]
  v_exp_f32 v219, v155
  v_add_f32 v227, v216, v217
  v_mfma_f32_16x16x32_bf16 a[80:83], a[168:171], v[176:179], a[80:83]
  ds_read_b128 a[136:139], v3 offset:2048
  v_cvt_pk_bf16_f32 v188, v216, v217
  v_add_f32 v227, v227, v218
  v_mfma_f32_16x16x32_bf16 a[84:87], a[168:171], v[180:183], a[84:87]
  buffer_load_dwordx4 v[56:59], v2, s[40:43], s14 offen offset:2048 sc1
  v_add_f32 v227, v227, v219
  v_mfma_f32_16x16x32_bf16 a[88:91], a[172:175], v[176:179], a[88:91]
  ds_read_b128 a[140:143], v3 offset:3072
  v_cvt_pk_bf16_f32 v189, v218, v219
  v_exp_f32 v220, v156
  v_mfma_f32_16x16x32_bf16 a[92:95], a[172:175], v[180:183], a[92:95]
  s_waitcnt lgkmcnt(4)
  v_exp_f32 v221, v157
  v_mfma_f32_16x16x32_bf16 a[96:99], a[176:179], v[176:179], a[96:99]
  ds_read_b128 a[144:147], v3 offset:4096
  buffer_load_dwordx4 v2, s[44:47], s26 offen offset:3072 sc1 lds
  v_mfma_f32_16x16x32_bf16 a[100:103], a[176:179], v[180:183], a[100:103]
  s_add_u32 s26, s26, 16384
  v_exp_f32 v222, v158
  v_mfma_f32_16x16x32_bf16 a[104:107], a[180:183], v[176:179], a[104:107]
  s_add_u32 s24, s24, 32768
  ds_read_b128 a[148:151], v3 offset:5120
  v_add_f32 v227, v227, v220
  v_add_f32 v227, v227, v221
  v_mfma_f32_16x16x32_bf16 a[108:111], a[180:183], v[180:183], a[108:111]
  s_and_b32 s24, s24, 0x1ffff
  v_exp_f32 v223, v159
  v_mfma_f32_16x16x32_bf16 a[112:115], a[184:187], v[176:179], a[112:115]
  ds_read_b128 a[152:155], v3 offset:6144
  v_cvt_pk_bf16_f32 v190, v220, v221
  v_add_f32 v227, v227, v222
  v_mfma_f32_16x16x32_bf16 a[116:119], a[184:187], v[180:183], a[116:119]
  v_add_f32 v227, v227, v223
  v_cvt_pk_bf16_f32 v191, v222, v223
  v_mfma_f32_16x16x32_bf16 a[120:123], a[188:191], v[176:179], a[120:123]
  s_waitcnt lgkmcnt(3)
  ds_read_b128 a[156:159], v3 offset:7168
  v_max_f32 v5, v226, v227
  v_cmp_lt_f32 vcc, s81, v5
  v_mfma_f32_16x16x32_bf16 a[124:127], a[188:191], v[180:183], a[124:127]
  s_cbranch_vccnz fa_stub24
fa_back24:
  v_add_f32 v230, v230, v226
  v_add_f32 v231, v231, v227
  v_mfma_f32_16x16x32_bf16 v[144:147], a[128:131], v[64:67], v[200:203]
  ds_read_b128 a[160:163], v3 offset:24576
  v_exp_f32 v216, v128
  v_mfma_f32_16x16x32_bf16 v[152:155], a[128:131], v[68:71], v[204:207]
  v_exp_f32 v217, v129
  v_mfma_f32_16x16x32_bf16 v[148:151], a[132:135], v[64:67], v[200:203]
  ds_read_b128 a[164:167], v3 offset:25600
  v_add_f32 v226, v216, v217
  v_cvt_pk_bf16_f32 v176, v216, v217
  v_mfma_f32_16x16x32_bf16 v[156:159], a[132:135], v[68:71], v[204:207]
  s_mov_b32 m0, s25
  v_exp_f32 v218, v130
  v_mfma_f32_16x16x32_bf16 v[144:147], a[136:139], v[72:75], v[144:147]
  ds_read_b128 a[168:171], v3 offset:26624
  buffer_load_dwordx4 v2, s[48:51], s27 offen offset:0 sc1 lds
  v_add_f32 v226, v226, v218
  v_mfma_f32_16x16x32_bf16 v[152:155], a[136:139], v[76:79], v[152:155]
  v_exp_f32 v219, v131
  v_mfma_f32_16x16x32_bf16 v[148:151], a[140:143], v[72:75], v[148:151]
  ds_read_b128 a[172:175], v3 offset:27648
  v_add_f32 v226, v226, v219
  v_cvt_pk_bf16_f32 v177, v218, v219
  v_mfma_f32_16x16x32_bf16 v[156:159], a[140:143], v[76:79], v[156:159]
  s_add_u32 s14, s13, 36864
  s_waitcnt lgkmcnt(4)
  buffer_load_dwordx4 v[60:63], v2, s[40:43], s14 offen offset:3072 sc1
  v_exp_f32 v220, v132
  v_mfma_f32_16x16x32_bf16 v[144:147], a[144:147], v[80:83], v[144:147]
  ds_read_b128 a[176:179], v3 offset:28672
  v_add_f32 v226, v226, v220
  v_mfma_f32_16x16x32_bf16 v[152:155], a[144:147], v[84:87], v[152:155]
  v_exp_f32 v221, v133
  v_mfma_f32_16x16x32_bf16 v[148:151], a[148:151], v[80:83], v[148:151]
  ds_read_b128 a[180:183], v3 offset:29696
  buffer_load_dwordx4 v2, s[48:51], s27 offen offset:1024 sc1 lds
  v_add_f32 v226, v226, v221
  v_mfma_f32_16x16x32_bf16 v[156:159], a[148:151], v[84:87], v[156:159]
  v_exp_f32 v222, v134
  v_cvt_pk_bf16_f32 v178, v220, v221
  v_mfma_f32_16x16x32_bf16 v[144:147], a[152:155], v[88:91], v[144:147]
  ds_read_b128 a[184:187], v3 offset:30720
  v_add_f32 v226, v226, v222
  v_mfma_f32_16x16x32_bf16 v[152:155], a[152:155], v[92:95], v[152:155]
  v_exp_f32 v223, v135
  v_exp_f32 v216, v136
  v_mfma_f32_16x16x32_bf16 v[148:151], a[156:159], v[88:91], v[148:151]
  s_add_u32 s14, s13, 40960
  ds_read_b128 a[188:191], v3 offset:31744
  buffer_load_dwordx4 v[96:99], v2, s[40:43], s14 offen offset:0 sc1
  v_mfma_f32_16x16x32_bf16 v[156:159], a[156:159], v[92:95], v[156:159]
  s_waitcnt lgkmcnt(4)
  v_exp_f32 v217, v137
  v_mfma_f32_16x16x32_bf16 a[64:67], a[160:163], v[184:187], a[64:67]
  ds_read_b128 a[128:131], v3 offset:8192
  v_add_f32 v226, v226, v223
  v_mfma_f32_16x16x32_bf16 a[68:71], a[160:163], v[188:191], a[68:71]
  v_exp_f32 v218, v138
  v_cvt_pk_bf16_f32 v179, v222, v223
  v_mfma_f32_16x16x32_bf16 a[72:75], a[164:167], v[184:187], a[72:75]
  ds_read_b128 a[132:135], v3 offset:9216
  buffer_load_dwordx4 v2, s[48:51], s27 offen offset:2048 sc1 lds
  v_mfma_f32_16x16x32_bf16 a[76:79], a[164:167], v[188:191], a[76:79]
  v_exp_f32 v219, v139
  v_add_f32 v227, v216, v217
  v_mfma_f32_16x16x32_bf16 a[80:83], a[168:171], v[184:187], a[80:83]
  ds_read_b128 a[136:139], v3 offset:10240
  v_cvt_pk_bf16_f32 v180, v216, v217
  v_add_f32 v227, v227, v218
  v_mfma_f32_16x16x32_bf16 a[84:87], a[168:171], v[188:191], a[84:87]
  buffer_load_dwordx4 v[100:103], v2, s[40:43], s14 offen offset:1024 sc1
  v_add_f32 v227, v227, v219
  v_mfma_f32_16x16x32_bf16 a[88:91], a[172:175], v[184:187], a[88:91]
  ds_read_b128 a[140:143], v3 offset:11264
  v_cvt_pk_bf16_f32 v181, v218, v219
  v_exp_f32 v220, v140
  v_mfma_f32_16x16x32_bf16 a[92:95], a[172:175], v[188:191], a[92:95]
  s_waitcnt lgkmcnt(4)
  v_exp_f32 v221, v141
  v_mfma_f32_16x16x32_bf16 a[96:99], a[176:179], v[184:187], a[96:99]
  ds_read_b128 a[144:147], v3 offset:12288
  buffer_load_dwordx4 v2, s[48:51], s27 offen offset:3072 sc1 lds
  v_mfma_f32_16x16x32_bf16 a[100:103], a[176:179], v[188:191], a[100:103]
  s_add_u32 s27, s27, 16384
  v_exp_f32 v222, v142
  v_mfma_f32_16x16x32_bf16 a[104:107], a[180:183], v[184:187], a[104:107]
  s_add_u32 s25, s25, 32768
  ds_read_b128 a[148:151], v3 offset:13312
  v_add_f32 v227, v227, v220
  v_add_f32 v227, v227, v221
  v_mfma_f32_16x16x32_bf16 a[108:111], a[180:183], v[188:191], a[108:111]
  s_and_b32 s25, s25, 0x1ffff
  v_exp_f32 v223, v143
  v_mfma_f32_16x16x32_bf16 a[112:115], a[184:187], v[184:187], a[112:115]
  ds_read_b128 a[152:155], v3 offset:14336
  v_cvt_pk_bf16_f32 v182, v220, v221
  v_add_f32 v227, v227, v222
  v_mfma_f32_16x16x32_bf16 a[116:119], a[184:187], v[188:191], a[116:119]
  v_add_f32 v227, v227, v223
  v_cvt_pk_bf16_f32 v183, v222, v223
  v_mfma_f32_16x16x32_bf16 a[120:123], a[188:191], v[184:187], a[120:123]
  s_waitcnt lgkmcnt(3)
  ds_read_b128 a[156:159], v3 offset:15360
  v_max_f32 v5, v226, v227
  v_cmp_lt_f32 vcc, s81, v5
  v_mfma_f32_16x16x32_bf16 a[124:127], a[188:191], v[188:191], a[124:127]
  s_cbranch_vccnz fa_stub25
fa_back25:
  v_add_f32 v230, v230, v226
  v_add_f32 v231, v231, v227
  v_add_u32 v3, 32768, v3
  v_and_b32 v3, 0x1ffff, v3
fa_SSW1:
  v_mfma_f32_16x16x32_bf16 v[128:131], a[128:131], v[64:67], v[200:203]
  s_waitcnt vmcnt(12)
  v_exp_f32 v216, v144
  v_exp_f32 v217, v145
  v_mfma_f32_16x16x32_bf16 v[136:139], a[128:131], v[68:71], v[204:207]
  s_barrier
  v_exp_f32 v218, v146
  v_mfma_f32_16x16x32_bf16 v[132:135], a[132:135], v[64:67], v[200:203]
  ds_read_b128 a[160:163], v3 offset:16384
  ds_read_b128 a[164:167], v3 offset:17408
  v_mfma_f32_16x16x32_bf16 v[140:143], a[132:135], v[68:71], v[204:207]
  s_mov_b32 m0, s24
  v_exp_f32 v219, v147
  v_mfma_f32_16x16x32_bf16 v[128:131], a[136:139], v[72:75], v[128:131]
  ds_read_b128 a[168:171], v3 offset:18432
  buffer_load_dwordx4 v2, s[44:47], s26 offen offset:0 sc1 lds
  v_add_f32 v226, v216, v217
  v_mfma_f32_16x16x32_bf16 v[136:139], a[136:139], v[76:79], v[136:139]
  v_exp_f32 v220, v148
  v_mfma_f32_16x16x32_bf16 v[132:135], a[140:143], v[72:75], v[132:135]
  ds_read_b128 a[172:175], v3 offset:19456
  v_cvt_pk_bf16_f32 v184, v216, v217
  v_add_f32 v226, v226, v218
  v_mfma_f32_16x16x32_bf16 v[140:143], a[140:143], v[76:79], v[140:143]
  s_add_u32 s14, s13, 40960
  s_waitcnt lgkmcnt(4)
  buffer_load_dwordx4 v[104:107], v2, s[40:43], s14 offen offset:2048 sc1
  v_add_f32 v226, v226, v219
  v_mfma_f32_16x16x32_bf16 v[128:131], a[144:147], v[80:83], v[128:131]
  ds_read_b128 a[176:179], v3 offset:20480
  v_cvt_pk_bf16_f32 v185, v218, v219
  v_add_f32 v226, v226, v220
  v_mfma_f32_16x16x32_bf16 v[136:139], a[144:147], v[84:87], v[136:139]
  v_exp_f32 v221, v149
  v_mfma_f32_16x16x32_bf16 v[132:135], a[148:151], v[80:83], v[132:135]
  ds_read_b128 a[180:183], v3 offset:21504
  buffer_load_dwordx4 v2, s[44:47], s26 offen offset:1024 sc1 lds
  v_add_f32 v226, v226, v221
  v_mfma_f32_16x16x32_bf16 v[140:143], a[148:151], v[84:87], v[140:143]
  v_exp_f32 v222, v150
  v_cvt_pk_bf16_f32 v186, v220, v221
  v_mfma_f32_16x16x32_bf16 v[128:131], a[152:155], v[88:91], v[128:131]
  ds_read_b128 a[184:187], v3 offset:22528
  v_add_f32 v226, v226, v222
  v_mfma_f32_16x16x32_bf16 v[136:139], a[152:155], v[92:95], v[136:139]
  v_exp_f32 v223, v151
  v_exp_f32 v216, v152
  v_mfma_f32_16x16x32_bf16 v[132:135], a[156:159], v[88:91], v[132:135]
  ds_read_b128 a[188:191], v3 offset:23552
  buffer_load_dwordx4 v[108:111], v2, s[40:43], s14 offen offset:3072 sc1
  v_mfma_f32_16x16x32_bf16 v[140:143], a[156:159], v[92:95], v[140:143]
  s_waitcnt lgkmcnt(4)
  v_exp_f32 v217, v153
  v_mfma_f32_16x16x32_bf16 a[64:67], a[160:163], v[176:179], a[64:67]
  ds_read_b128 a[128:131], v3 offset:0
  v_add_f32 v226, v226, v223
  v_mfma_f32_16x16x32_bf16 a[68:71], a[160:163], v[180:183], a[68:71]
  v_exp_f32 v218, v154
  v_cvt_pk_bf16_f32 v187, v222, v223
  v_mfma_f32_16x16x32_bf16 a[72:75], a[164:167], v[176:179], a[72:75]
  ds_read_b128 a[132:135], v3 offset:1024
  buffer_load_dwordx4 v2, s[44:47], s26 offen offset:2048 sc1 lds
  v_mfma_f32_16x16x32_bf16 a[76:79], a[164:167], v[180:183], a[76:79]
  v_exp_f32 v219, v155
  v_add_f32 v227, v216, v217
  v_mfma_f32_16x16x32_bf16 a[80:83], a[168:171], v[176:179], a[80:83]
  ds_read_b128 a[136:139], v3 offset:2048
  v_cvt_pk_bf16_f32 v188, v216, v217
  v_add_f32 v227, v227, v218
  v_mfma_f32_16x16x32_bf16 a[84:87], a[168:171], v[180:183], a[84:87]
  s_add_u32 s14, s13, 45056
  buffer_load_dwordx4 v[112:115], v2, s[40:43], s14 offen offset:0 sc1
  v_add_f32 v227, v227, v219
  v_mfma_f32_16x16x32_bf16 a[88:91], a[172:175], v[176:179], a[88:91]
  ds_read_b128 a[140:143], v3 offset:3072
  v_cvt_pk_bf16_f32 v189, v218, v219
  v_exp_f32 v220, v156
  v_mfma_f32_16x16x32_bf16 a[92:95], a[172:175], v[180:183], a[92:95]
  s_waitcnt lgkmcnt(4)
  v_exp_f32 v221, v157
  v_mfma_f32_16x16x32_bf16 a[96:99], a[176:179], v[176:179], a[96:99]
  ds_read_b128 a[144:147], v3 offset:4096
  buffer_load_dwordx4 v2, s[44:47], s26 offen offset:3072 sc1 lds
  v_mfma_f32_16x16x32_bf16 a[100:103], a[176:179], v[180:183], a[100:103]
  s_add_u32 s26, s26, 16384
  v_exp_f32 v222, v158
  v_mfma_f32_16x16x32_bf16 a[104:107], a[180:183], v[176:179], a[104:107]
  s_add_u32 s24, s24, 32768
  ds_read_b128 a[148:151], v3 offset:5120
  v_add_f32 v227, v227, v220
  v_add_f32 v227, v227, v221
  v_mfma_f32_16x16x32_bf16 a[108:111], a[180:183], v[180:183], a[108:111]
  s_and_b32 s24, s24, 0x1ffff
  v_exp_f32 v223, v159
  v_mfma_f32_16x16x32_bf16 a[112:115], a[184:187], v[176:179], a[112:115]
  ds_read_b128 a[152:155], v3 offset:6144
  v_cvt_pk_bf16_f32 v190, v220, v221
  v_add_f32 v227, v227, v222
  v_mfma_f32_16x16x32_bf16 a[116:119], a[184:187], v[180:183], a[116:119]
  v_add_f32 v227, v227, v223
  v_cvt_pk_bf16_f32 v191, v222, v223
  v_mfma_f32_16x16x32_bf16 a[120:123], a[188:191], v[176:179], a[120:123]
  s_waitcnt lgkmcnt(3)
  ds_read_b128 a[156:159], v3 offset:7168
  v_max_f32 v5, v226, v227
  v_cmp_lt_f32 vcc, s81, v5
  v_mfma_f32_16x16x32_bf16 a[124:127], a[188:191], v[180:183], a[124:127]
  s_cbranch_vccnz fa_stub26
fa_back26:
  v_add_f32 v230, v230, v226
  v_add_f32 v231, v231, v227
  v_mfma_f32_16x16x32_bf16 v[144:147], a[128:131], v[64:67], v[200:203]
  ds_read_b128 a[160:163], v3 offset:24576
  v_exp_f32 v216, v128
  v_mfma_f32_16x16x32_bf16 v[152:155], a[128:131], v[68:71], v[204:207]
  v_exp_f32 v217, v129
  v_mfma_f32_16x16x32_bf16 v[148:151], a[132:135], v[64:67], v[200:203]
  ds_read_b128 a[164:167], v3 offset:25600
  v_add_f32 v226, v216, v217
  v_cvt_pk_bf16_f32 v176, v216, v217
  v_mfma_f32_16x16x32_bf16 v[156:159], a[132:135], v[68:71], v[204:207]
  s_mov_b32 m0, s25
  v_exp_f32 v218, v130
  v_mfma_f32_16x16x32_bf16 v[144:147], a[136:139], v[72:75], v[144:147]
  ds_read_b128 a[168:171], v3 offset:26624
  buffer_load_dwordx4 v2, s[48:51], s27 offen offset:0 sc1 lds
  v_add_f32 v226, v226, v218
  v_mfma_f32_16x16x32_bf16 v[152:155], a[136:139], v[76:79], v[152:155]
  v_exp_f32 v219, v131
  v_mfma_f32_16x16x32_bf16 v[148:151], a[140:143], v[72:75], v[148:151]
  ds_read_b128 a[172:175], v3 offset:27648
  v_add_f32 v226, v226, v219
  v_cvt_pk_bf16_f32 v177, v218, v219
  v_mfma_f32_16x16x32_bf16 v[156:159], a[140:143], v[76:79], v[156:159]
  s_add_u32 s14, s13, 45056
  s_waitcnt lgkmcnt(4)
  buffer_load_dwordx4 v[116:119], v2, s[40:43], s14 offen offset:1024 sc1
  v_exp_f32 v220, v132
  v_mfma_f32_16x16x32_bf16 v[144:147], a[144:147], v[80:83], v[144:147]
  ds_read_b128 a[176:179], v3 offset:28672
  v_add_f32 v226, v226, v220
  v_mfma_f32_16x16x32_bf16 v[152:155], a[144:147], v[84:87], v[152:155]
  v_exp_f32 v221, v133
  v_mfma_f32_16x16x32_bf16 v[148:151], a[148:151], v[80:83], v[148:151]
  ds_read_b128 a[180:183], v3 offset:29696
  buffer_load_dwordx4 v2, s[48:51], s27 offen offset:1024 sc1 lds
  v_add_f32 v226, v226, v221
  v_mfma_f32_16x16x32_bf16 v[156:159], a[148:151], v[84:87], v[156:159]
  v_exp_f32 v222, v134
  v_cvt_pk_bf16_f32 v178, v220, v221
  v_mfma_f32_16x16x32_bf16 v[144:147], a[152:155], v[88:91], v[144:147]
  ds_read_b128 a[184:187], v3 offset:30720
  v_add_f32 v226, v226, v222
  v_mfma_f32_16x16x32_bf16 v[152:155], a[152:155], v[92:95], v[152:155]
  v_exp_f32 v223, v135
  v_exp_f32 v216, v136
  v_mfma_f32_16x16x32_bf16 v[148:151], a[156:159], v[88:91], v[148:151]
  ds_read_b128 a[188:191], v3 offset:31744
  buffer_load_dwordx4 v[120:123], v2, s[40:43], s14 offen offset:2048 sc1
  v_mfma_f32_16x16x32_bf16 v[156:159], a[156:159], v[92:95], v[156:159]
  s_waitcnt lgkmcnt(4)
  v_exp_f32 v217, v137
  v_mfma_f32_16x16x32_bf16 a[64:67], a[160:163], v[184:187], a[64:67]
  ds_read_b128 a[128:131], v3 offset:8192
  v_add_f32 v226, v226, v223
  v_mfma_f32_16x16x32_bf16 a[68:71], a[160:163], v[188:191], a[68:71]
  v_exp_f32 v218, v138
  v_cvt_pk_bf16_f32 v179, v222, v223
  v_mfma_f32_16x16x32_bf16 a[72:75], a[164:167], v[184:187], a[72:75]
  ds_read_b128 a[132:135], v3 offset:9216
  buffer_load_dwordx4 v2, s[48:51], s27 offen offset:2048 sc1 lds
  v_mfma_f32_16x16x32_bf16 a[76:79], a[164:167], v[188:191], a[76:79]
  v_exp_f32 v219, v139
  v_add_f32 v227, v216, v217
  v_mfma_f32_16x16x32_bf16 a[80:83], a[168:171], v[184:187], a[80:83]
  ds_read_b128 a[136:139], v3 offset:10240
  v_cvt_pk_bf16_f32 v180, v216, v217
  v_add_f32 v227, v227, v218
  v_mfma_f32_16x16x32_bf16 a[84:87], a[168:171], v[188:191], a[84:87]
  buffer_load_dwordx4 v[124:127], v2, s[40:43], s14 offen offset:3072 sc1
  v_add_f32 v227, v227, v219
  v_mfma_f32_16x16x32_bf16 a[88:91], a[172:175], v[184:187], a[88:91]
  ds_read_b128 a[140:143], v3 offset:11264
  v_cvt_pk_bf16_f32 v181, v218, v219
  v_exp_f32 v220, v140
  v_mfma_f32_16x16x32_bf16 a[92:95], a[172:175], v[188:191], a[92:95]
  s_waitcnt lgkmcnt(4)
  v_exp_f32 v221, v141
  v_mfma_f32_16x16x32_bf16 a[96:99], a[176:179], v[184:187], a[96:99]
  ds_read_b128 a[144:147], v3 offset:12288
  buffer_load_dwordx4 v2, s[48:51], s27 offen offset:3072 sc1 lds
  v_mfma_f32_16x16x32_bf16 a[100:103], a[176:179], v[188:191], a[100:103]
  s_add_u32 s27, s27, 16384
  v_exp_f32 v222, v142
  v_mfma_f32_16x16x32_bf16 a[104:107], a[180:183], v[184:187], a[104:107]
  s_add_u32 s25, s25, 32768
  ds_read_b128 a[148:151], v3 offset:13312
  v_add_f32 v227, v227, v220
  v_add_f32 v227, v227, v221
  v_mfma_f32_16x16x32_bf16 a[108:111], a[180:183], v[188:191], a[108:111]
  s_and_b32 s25, s25, 0x1ffff
  v_exp_f32 v223, v143
  v_mfma_f32_16x16x32_bf16 a[112:115], a[184:187], v[184:187], a[112:115]
  ds_read_b128 a[152:155], v3 offset:14336
  v_cvt_pk_bf16_f32 v182, v220, v221
  v_add_f32 v227, v227, v222
  v_mfma_f32_16x16x32_bf16 a[116:119], a[184:187], v[188:191], a[116:119]
  v_add_f32 v227, v227, v223
  v_cvt_pk_bf16_f32 v183, v222, v223
  v_mfma_f32_16x16x32_bf16 a[120:123], a[188:191], v[184:187], a[120:123]
  s_waitcnt lgkmcnt(3)
  ds_read_b128 a[156:159], v3 offset:15360
  v_max_f32 v5, v226, v227
  v_cmp_lt_f32 vcc, s81, v5
  v_mfma_f32_16x16x32_bf16 a[124:127], a[188:191], v[188:191], a[124:127]
  s_cbranch_vccnz fa_stub27
fa_back27:
  v_add_f32 v230, v230, v226
  v_add_f32 v231, v231, v227
  v_add_u32 v3, 32768, v3
  v_and_b32 v3, 0x1ffff, v3
fa_Bexit:
  s_bitcmp1_b32 s20, 0
  s_cbranch_scc1 fa_Bodd
  v_mfma_f32_16x16x32_bf16 v[128:131], a[128:131], v[64:67], v[200:203]
  s_waitcnt vmcnt(0)
  v_exp_f32 v216, v144
  v_mfma_f32_16x16x32_bf16 v[136:139], a[128:131], v[68:71], v[204:207]
  s_barrier
  v_exp_f32 v217, v145
  v_exp_f32 v218, v146
  v_mfma_f32_16x16x32_bf16 v[132:135], a[132:135], v[64:67], v[200:203]
  ds_read_b128 a[160:163], v3 offset:16384
  ds_read_b128 a[164:167], v3 offset:17408
  v_mfma_f32_16x16x32_bf16 v[140:143], a[132:135], v[68:71], v[204:207]
  s_add_u32 s14, s13, 49152
  buffer_load_dwordx4 v[160:163], v2, s[40:43], s14 offen offset:0 sc1
  v_mfma_f32_16x16x32_bf16 v[128:131], a[136:139], v[72:75], v[128:131]
  ds_read_b128 a[168:171], v3 offset:18432
  v_add_f32 v226, v216, v217
  v_mfma_f32_16x16x32_bf16 v[136:139], a[136:139], v[76:79], v[136:139]
  v_exp_f32 v219, v147
  v_cvt_pk_bf16_f32 v184, v216, v217
  v_mfma_f32_16x16x32_bf16 v[132:135], a[140:143], v[72:75], v[132:135]
  ds_read_b128 a[172:175], v3 offset:19456
  v_add_f32 v226, v226, v218
  v_mfma_f32_16x16x32_bf16 v[140:143], a[140:143], v[76:79], v[140:143]
  s_waitcnt lgkmcnt(4)
  buffer_load_dwordx4 v[164:167], v2, s[40:43], s14 offen offset:1024 sc1
  v_add_f32 v226, v226, v219
  v_mfma_f32_16x16x32_bf16 v[128:131], a[144:147], v[80:83], v[128:131]
  ds_read_b128 a[176:179], v3 offset:20480
  v_cvt_pk_bf16_f32 v185, v218, v219
  v_mfma_f32_16x16x32_bf16 v[136:139], a[144:147], v[84:87], v[136:139]
  v_exp_f32 v220, v148
  v_exp_f32 v221, v149
  v_mfma_f32_16x16x32_bf16 v[132:135], a[148:151], v[80:83], v[132:135]
  ds_read_b128 a[180:183], v3 offset:21504
  v_mfma_f32_16x16x32_bf16 v[140:143], a[148:151], v[84:87], v[140:143]
  v_exp_f32 v222, v150
  v_mfma_f32_16x16x32_bf16 v[128:131], a[152:155], v[88:91], v[128:131]
  ds_read_b128 a[184:187], v3 offset:22528
  buffer_load_dwordx4 v[168:171], v2, s[40:43], s14 offen offset:2048 sc1
  v_mfma_f32_16x16x32_bf16 v[136:139], a[152:155], v[92:95], v[136:139]
  v_exp_f32 v223, v151
  v_add_f32 v226, v226, v220
  v_mfma_f32_16x16x32_bf16 v[132:135], a[156:159], v[88:91], v[132:135]
  ds_read_b128 a[188:191], v3 offset:23552
  v_add_f32 v226, v226, v221
  v_mfma_f32_16x16x32_bf16 v[140:143], a[156:159], v[92:95], v[140:143]
  s_waitcnt lgkmcnt(4)
  v_exp_f32 v216, v152
  v_mfma_f32_16x16x32_bf16 a[64:67], a[160:163], v[176:179], a[64:67]
  v_exp_f32 v217, v153
  v_mfma_f32_16x16x32_bf16 a[68:71], a[160:163], v[180:183], a[68:71]
  buffer_load_dwordx4 v[172:175], v2, s[40:43], s14 offen offset:3072 sc1
  v_cvt_pk_bf16_f32 v186, v220, v221
  v_add_f32 v226, v226, v222
  v_mfma_f32_16x16x32_bf16 a[72:75], a[164:167], v[176:179], a[72:75]
  v_exp_f32 v218, v154
  v_mfma_f32_16x16x32_bf16 a[76:79], a[164:167], v[180:183], a[76:79]
  v_exp_f32 v219, v155
  v_mfma_f32_16x16x32_bf16 a[80:83], a[168:171], v[176:179], a[80:83]
  v_exp_f32 v220, v156
  v_mfma_f32_16x16x32_bf16 a[84:87], a[168:171], v[180:183], a[84:87]
  s_add_u32 s14, s13, 53248
  buffer_load_dwordx4 v[192:195], v2, s[40:43], s14 offen offset:0 sc1
  v_add_f32 v226, v226, v223
  v_cvt_pk_bf16_f32 v187, v222, v223
  v_mfma_f32_16x16x32_bf16 a[88:91], a[172:175], v[176:179], a[88:91]
  v_exp_f32 v221, v157
  v_mfma_f32_16x16x32_bf16 a[92:95], a[172:175], v[180:183], a[92:95]
  s_waitcnt lgkmcnt(0)
  v_exp_f32 v222, v158
  v_mfma_f32_16x16x32_bf16 a[96:99], a[176:179], v[176:179], a[96:99]
  v_exp_f32 v223, v159
  v_mfma_f32_16x16x32_bf16 a[100:103], a[176:179], v[180:183], a[100:103]
  v_add_f32 v227, v216, v217
  v_cvt_pk_bf16_f32 v188, v216, v217
  v_add_f32 v227, v227, v218
  v_mfma_f32_16x16x32_bf16 a[104:107], a[180:183], v[176:179], a[104:107]
  buffer_load_dwordx4 v[196:199], v2, s[40:43], s14 offen offset:1024 sc1
  v_add_f32 v227, v227, v219
  v_mfma_f32_16x16x32_bf16 a[108:111], a[180:183], v[180:183], a[108:111]
  v_cvt_pk_bf16_f32 v189, v218, v219
  v_add_f32 v227, v227, v220
  v_mfma_f32_16x16x32_bf16 a[112:115], a[184:187], v[176:179], a[112:115]
  v_add_f32 v227, v227, v221
  v_cvt_pk_bf16_f32 v190, v220, v221
  v_mfma_f32_16x16x32_bf16 a[116:119], a[184:187], v[180:183], a[116:119]
  v_add_f32 v227, v227, v222
  v_add_f32 v227, v227, v223
  v_cvt_pk_bf16_f32 v191, v222, v223
  v_mfma_f32_16x16x32_bf16 a[120:123], a[188:191], v[176:179], a[120:123]
  v_max_f32 v5, v226, v227
  v_cmp_lt_f32 vcc, s81, v5
  v_mfma_f32_16x16x32_bf16 a[124:127], a[188:191], v[180:183], a[124:127]
  s_cbranch_vccnz fa_stub28
fa_back28:
  v_add_f32 v230, v230, v226
  v_add_f32 v231, v231, v227
  ds_read_b128 a[160:163], v3 offset:24576
  ds_read_b128 a[164:167], v3 offset:25600
  ds_read_b128 a[168:171], v3 offset:26624
  ds_read_b128 a[172:175], v3 offset:27648
  ds_read_b128 a[176:179], v3 offset:28672
  ds_read_b128 a[180:183], v3 offset:29696
  ds_read_b128 a[184:187], v3 offset:30720
  ds_read_b128 a[188:191], v3 offset:31744
  v_cndmask_b32 v128, v4, v128, s[68:69]
  v_cndmask_b32 v129, v4, v129, s[70:71]
  v_cndmask_b32 v130, v4, v130, s[72:73]
  v_cndmask_b32 v131, v4, v131, s[74:75]
  v_mov_b32 v132, v4
  v_mov_b32 v133, v4
  v_mov_b32 v134, v4
  v_mov_b32 v135, v4
  v_cndmask_b32 v140, v4, v140, s[68:69]
  v_cndmask_b32 v141, v4, v141, s[70:71]
  v_cndmask_b32 v142, v4, v142, s[72:73]
  v_cndmask_b32 v143, v4, v143, s[74:75]
  v_exp_f32 v216, v128
  v_exp_f32 v217, v129
  v_exp_f32 v218, v130
  v_exp_f32 v219, v131
  v_exp_f32 v220, v132
  v_exp_f32 v221, v133
  v_exp_f32 v222, v134
  v_exp_f32 v223, v135
  v_add_f32 v226, v216, v217
  v_cvt_pk_bf16_f32 v176, v216, v217
  s_waitcnt lgkmcnt(4)
  v_mfma_f32_16x16x32_bf16 a[64:67], a[160:163], v[184:187], a[64:67]
  v_exp_f32 v216, v136
  v_add_f32 v226, v226, v218
  v_mfma_f32_16x16x32_bf16 a[68:71], a[160:163], v[188:191], a[68:71]
  s_add_u32 s14, s13, 53248
  buffer_load_dwordx4 v[208:211], v2, s[40:43], s14 offen offset:2048 sc1
  v_add_f32 v226, v226, v219
  v_cvt_pk_bf16_f32 v177, v218, v219
  v_mfma_f32_16x16x32_bf16 a[72:75], a[164:167], v[184:187], a[72:75]
  v_exp_f32 v217, v137
  v_mfma_f32_16x16x32_bf16 a[76:79], a[164:167], v[188:191], a[76:79]
  v_exp_f32 v218, v138
  v_add_f32 v226, v226, v220
  v_mfma_f32_16x16x32_bf16 a[80:83], a[168:171], v[184:187], a[80:83]
  buffer_load_dwordx4 v[212:215], v2, s[40:43], s14 offen offset:3072 sc1
  v_add_f32 v226, v226, v221
  v_cvt_pk_bf16_f32 v178, v220, v221
  v_mfma_f32_16x16x32_bf16 a[84:87], a[168:171], v[188:191], a[84:87]
  v_exp_f32 v219, v139
  v_add_f32 v226, v226, v222
  v_mfma_f32_16x16x32_bf16 a[88:91], a[172:175], v[184:187], a[88:91]
  v_exp_f32 v220, v140
  v_add_f32 v226, v226, v223
  v_mfma_f32_16x16x32_bf16 a[92:95], a[172:175], v[188:191], a[92:95]
  s_waitcnt lgkmcnt(0)
  v_exp_f32 v221, v141
  v_mfma_f32_16x16x32_bf16 a[96:99], a[176:179], v[184:187], a[96:99]
  s_add_u32 s14, s13, 57344
  buffer_load_dwordx4 v[232:235], v2, s[40:43], s14 offen offset:0 sc1
  v_cvt_pk_bf16_f32 v179, v222, v223
  v_add_f32 v227, v216, v217
  v_mfma_f32_16x16x32_bf16 a[100:103], a[176:179], v[188:191], a[100:103]
  v_exp_f32 v222, v142
  v_cvt_pk_bf16_f32 v180, v216, v217
  v_mfma_f32_16x16x32_bf16 a[104:107], a[180:183], v[184:187], a[104:107]
  v_exp_f32 v223, v143
  v_add_f32 v227, v227, v218
  v_mfma_f32_16x16x32_bf16 a[108:111], a[180:183], v[188:191], a[108:111]
  buffer_load_dwordx4 v[236:239], v2, s[40:43], s14 offen offset:1024 sc1
  v_add_f32 v227, v227, v219
  v_cvt_pk_bf16_f32 v181, v218, v219
  v_mfma_f32_16x16x32_bf16 a[112:115], a[184:187], v[184:187], a[112:115]
  v_add_f32 v227, v227, v220
  v_add_f32 v227, v227, v221
  v_mfma_f32_16x16x32_bf16 a[116:119], a[184:187], v[188:191], a[116:119]
  v_cvt_pk_bf16_f32 v182, v220, v221
  v_add_f32 v227, v227, v222
  v_add_f32 v227, v227, v223
  v_mfma_f32_16x16x32_bf16 a[120:123], a[188:191], v[184:187], a[120:123]
  v_cvt_pk_bf16_f32 v183, v222, v223
  v_max_f32 v5, v226, v227
  v_cmp_lt_f32 vcc, s81, v5
  v_mfma_f32_16x16x32_bf16 a[124:127], a[188:191], v[188:191], a[124:127]
  s_cbranch_vccnz fa_stub29
fa_back29:
  v_add_f32 v230, v230, v226
  v_add_f32 v231, v231, v227
  v_add_u32 v3, 32768, v3
  v_and_b32 v3, 0x1ffff, v3
  s_waitcnt vmcnt(10)
  s_barrier
  ds_read_b128 a[160:163], v3 offset:16384
  ds_read_b128 a[164:167], v3 offset:17408
  ds_read_b128 a[168:171], v3 offset:18432
  ds_read_b128 a[172:175], v3 offset:19456
  ds_read_b128 a[176:179], v3 offset:20480
  ds_read_b128 a[180:183], v3 offset:21504
  ds_read_b128 a[184:187], v3 offset:22528
  ds_read_b128 a[188:191], v3 offset:23552
  s_waitcnt lgkmcnt(4)
  v_mfma_f32_16x16x32_bf16 a[64:67], a[160:163], v[176:179], a[64:67]
  v_mfma_f32_16x16x32_bf16 a[68:71], a[160:163], v[180:183], a[68:71]
  s_add_u32 s14, s13, 57344
  buffer_load_dwordx4 v[240:243], v2, s[40:43], s14 offen offset:2048 sc1
  v_mfma_f32_16x16x32_bf16 a[72:75], a[164:167], v[176:179], a[72:75]
  v_mfma_f32_16x16x32_bf16 a[76:79], a[164:167], v[180:183], a[76:79]
  v_mfma_f32_16x16x32_bf16 a[80:83], a[168:171], v[176:179], a[80:83]
  v_mfma_f32_16x16x32_bf16 a[84:87], a[168:171], v[180:183], a[84:87]
  v_mfma_f32_16x16x32_bf16 a[88:91], a[172:175], v[176:179], a[88:91]
  v_mfma_f32_16x16x32_bf16 a[92:95], a[172:175], v[180:183], a[92:95]
  s_waitcnt lgkmcnt(0)
  v_mfma_f32_16x16x32_bf16 a[96:99], a[176:179], v[176:179], a[96:99]
  buffer_load_dwordx4 v[244:247], v2, s[40:43], s14 offen offset:3072 sc1
  v_mfma_f32_16x16x32_bf16 a[100:103], a[176:179], v[180:183], a[100:103]
  v_mfma_f32_16x16x32_bf16 a[104:107], a[180:183], v[176:179], a[104:107]
  v_mfma_f32_16x16x32_bf16 a[108:111], a[180:183], v[180:183], a[108:111]
  v_mfma_f32_16x16x32_bf16 a[112:115], a[184:187], v[176:179], a[112:115]
  v_mfma_f32_16x16x32_bf16 a[116:119], a[184:187], v[180:183], a[116:119]
  v_mfma_f32_16x16x32_bf16 a[120:123], a[188:191], v[176:179], a[120:123]
  v_mfma_f32_16x16x32_bf16 a[124:127], a[188:191], v[180:183], a[124:127]
  s_branch fa_Bdone
fa_Bodd:
  s_waitcnt vmcnt(0)
  s_barrier
  ds_read_b128 a[160:163], v3 offset:16384
  ds_read_b128 a[164:167], v3 offset:17408
  ds_read_b128 a[168:171], v3 offset:18432
  ds_read_b128 a[172:175], v3 offset:19456
  ds_read_b128 a[176:179], v3 offset:20480
  ds_read_b128 a[180:183], v3 offset:21504
  ds_read_b128 a[184:187], v3 offset:22528
  ds_read_b128 a[188:191], v3 offset:23552
  v_cndmask_b32 v144, v4, v144, s[68:69]
  v_cndmask_b32 v145, v4, v145, s[70:71]
  v_cndmask_b32 v146, v4, v146, s[72:73]
  v_cndmask_b32 v147, v4, v147, s[74:75]
  v_mov_b32 v148, v4
  v_mov_b32 v149, v4
  v_mov_b32 v150, v4
  v_mov_b32 v151, v4
  v_cndmask_b32 v156, v4, v156, s[68:69]
  v_cndmask_b32 v157, v4, v157, s[70:71]
  v_cndmask_b32 v158, v4, v158, s[72:73]
  v_cndmask_b32 v159, v4, v159, s[74:75]
  v_exp_f32 v216, v144
  v_exp_f32 v217, v145
  v_exp_f32 v218, v146
  v_exp_f32 v219, v147
  v_exp_f32 v220, v148
  v_exp_f32 v221, v149
  v_exp_f32 v222, v150
  v_exp_f32 v223, v151
  v_add_f32 v226, v216, v217
  v_cvt_pk_bf16_f32 v184, v216, v217
  s_waitcnt lgkmcnt(4)
  v_mfma_f32_16x16x32_bf16 a[64:67], a[160:163], v[176:179], a[64:67]
  v_exp_f32 v216, v152
  v_add_f32 v226, v226, v218
  v_mfma_f32_16x16x32_bf16 a[68:71], a[160:163], v[180:183], a[68:71]
  s_add_u32 s14, s13, 49152
  buffer_load_dwordx4 v[160:163], v2, s[40:43], s14 offen offset:0 sc1
  v_add_f32 v226, v226, v219
  v_cvt_pk_bf16_f32 v185, v218, v219
  v_mfma_f32_16x16x32_bf16 a[72:75], a[164:167], v[176:179], a[72:75]
  v_exp_f32 v217, v153
  v_add_f32 v226, v226, v220
  v_mfma_f32_16x16x32_bf16 a[76:79], a[164:167], v[180:183], a[76:79]
  buffer_load_dwordx4 v[164:167], v2, s[40:43], s14 offen offset:1024 sc1
  v_add_f32 v226, v226, v221
  v_cvt_pk_bf16_f32 v186, v220, v221
  v_mfma_f32_16x16x32_bf16 a[80:83], a[168:171], v[176:179], a[80:83]
  v_exp_f32 v218, v154
  v_add_f32 v226, v226, v222
  v_mfma_f32_16x16x32_bf16 a[84:87], a[168:171], v[180:183], a[84:87]
  buffer_load_dwordx4 v[168:171], v2, s[40:43], s14 offen offset:2048 sc1
  v_add_f32 v226, v226, v223
  v_cvt_pk_bf16_f32 v187, v222, v223
  v_mfma_f32_16x16x32_bf16 a[88:91], a[172:175], v[176:179], a[88:91]
  v_exp_f32 v219, v155
  v_add_f32 v227, v216, v217
  v_mfma_f32_16x16x32_bf16 a[92:95], a[172:175], v[180:183], a[92:95]
  s_waitcnt lgkmcnt(0)
  buffer_load_dwordx4 v[172:175], v2, s[40:43], s14 offen offset:3072 sc1
  v_cvt_pk_bf16_f32 v188, v216, v217
  v_add_f32 v227, v227, v218
  v_mfma_f32_16x16x32_bf16 a[96:99], a[176:179], v[176:179], a[96:99]
  v_exp_f32 v220, v156
  v_add_f32 v227, v227, v219
  v_mfma_f32_16x16x32_bf16 a[100:103], a[176:179], v[180:183], a[100:103]
  s_add_u32 s14, s13, 53248
  buffer_load_dwordx4 v[192:195], v2, s[40:43], s14 offen offset:0 sc1
  v_cvt_pk_bf16_f32 v189, v218, v219
  v_add_f32 v227, v227, v220
  v_mfma_f32_16x16x32_bf16 a[104:107], a[180:183], v[176:179], a[104:107]
  v_exp_f32 v221, v157
  v_exp_f32 v222, v158
  v_mfma_f32_16x16x32_bf16 a[108:111], a[180:183], v[180:183], a[108:111]
  buffer_load_dwordx4 v[196:199], v2, s[40:43], s14 offen offset:1024 sc1
  v_add_f32 v227, v227, v221
  v_mfma_f32_16x16x32_bf16 a[112:115], a[184:187], v[176:179], a[112:115]
  v_exp_f32 v223, v159
  v_cvt_pk_bf16_f32 v190, v220, v221
  v_mfma_f32_16x16x32_bf16 a[116:119], a[184:187], v[180:183], a[116:119]
  buffer_load_dwordx4 v[208:211], v2, s[40:43], s14 offen offset:2048 sc1
  v_add_f32 v227, v227, v222
  v_add_f32 v227, v227, v223
  v_mfma_f32_16x16x32_bf16 a[120:123], a[188:191], v[176:179], a[120:123]
  v_cvt_pk_bf16_f32 v191, v222, v223
  v_max_f32 v5, v226, v227
  v_cmp_lt_f32 vcc, s81, v5
  v_mfma_f32_16x16x32_bf16 a[124:127], a[188:191], v[180:183], a[124:127]
  s_cbranch_vccnz fa_stub30
fa_back30:
  v_add_f32 v230, v230, v226
  v_add_f32 v231, v231, v227
  ds_read_b128 a[160:163], v3 offset:24576
  ds_read_b128 a[164:167], v3 offset:25600
  ds_read_b128 a[168:171], v3 offset:26624
  ds_read_b128 a[172:175], v3 offset:27648
  ds_read_b128 a[176:179], v3 offset:28672
  ds_read_b128 a[180:183], v3 offset:29696
  ds_read_b128 a[184:187], v3 offset:30720
  ds_read_b128 a[188:191], v3 offset:31744
  s_waitcnt lgkmcnt(4)
  v_mfma_f32_16x16x32_bf16 a[64:67], a[160:163], v[184:187], a[64:67]
  v_mfma_f32_16x16x32_bf16 a[68:71], a[160:163], v[188:191], a[68:71]
  s_add_u32 s14, s13, 53248
  buffer_load_dwordx4 v[212:215], v2, s[40:43], s14 offen offset:3072 sc1
  v_mfma_f32_16x16x32_bf16 a[72:75], a[164:167], v[184:187], a[72:75]
  v_mfma_f32_16x16x32_bf16 a[76:79], a[164:167], v[188:191], a[76:79]
  s_add_u32 s14, s13, 57344
  buffer_load_dwordx4 v[232:235], v2, s[40:43], s14 offen offset:0 sc1
  v_mfma_f32_16x16x32_bf16 a[80:83], a[168:171], v[184:187], a[80:83]
  v_mfma_f32_16x16x32_bf16 a[84:87], a[168:171], v[188:191], a[84:87]
  v_mfma_f32_16x16x32_bf16 a[88:91], a[172:175], v[184:187], a[88:91]
  buffer_load_dwordx4 v[236:239], v2, s[40:43], s14 offen offset:1024 sc1
  v_mfma_f32_16x16x32_bf16 a[92:95], a[172:175], v[188:191], a[92:95]
  s_waitcnt lgkmcnt(0)
  v_mfma_f32_16x16x32_bf16 a[96:99], a[176:179], v[184:187], a[96:99]
  v_mfma_f32_16x16x32_bf16 a[100:103], a[176:179], v[188:191], a[100:103]
  buffer_load_dwordx4 v[240:243], v2, s[40:43], s14 offen offset:2048 sc1
  v_mfma_f32_16x16x32_bf16 a[104:107], a[180:183], v[184:187], a[104:107]
  v_mfma_f32_16x16x32_bf16 a[108:111], a[180:183], v[188:191], a[108:111]
  v_mfma_f32_16x16x32_bf16 a[112:115], a[184:187], v[184:187], a[112:115]
  buffer_load_dwordx4 v[244:247], v2, s[40:43], s14 offen offset:3072 sc1
  v_mfma_f32_16x16x32_bf16 a[116:119], a[184:187], v[188:191], a[116:119]
  v_mfma_f32_16x16x32_bf16 a[120:123], a[188:191], v[184:187], a[120:123]
  v_mfma_f32_16x16x32_bf16 a[124:127], a[188:191], v[188:191], a[124:127]
  v_add_u32 v3, 32768, v3
  v_and_b32 v3, 0x1ffff, v3
fa_Bdone:
  s_cmp_ge_u32 s20, 2
  s_cbranch_scc1 fa_epi
  s_barrier
fa_epi:
  v_mov_b32 v20, v230
  v_mov_b32 v21, v231
  s_nop 1
  v_permlane16_swap_b32 v230, v20
  v_permlane16_swap_b32 v231, v21
  v_add_f32 v230, v230, v20
  v_add_f32 v231, v231, v21
  v_mov_b32 v20, v230
  v_mov_b32 v21, v231
  s_nop 1
  v_permlane32_swap_b32 v230, v20
  v_permlane32_swap_b32 v231, v21
  v_add_f32 v230, v230, v20
  v_add_f32 v231, v231, v21
  v_rcp_f32 v16, v230
  v_rcp_f32 v18, v231
  s_sub_u32 s23, 15, s22
  s_lshl_b32 s23, s23, 2
  v_mov_b32 v17, v16
  v_mov_b32 v19, v18
  s_add_u32 s23, s23, s20
  s_lshl_b32 s23, s23, 18
  s_lshl_b32 s31, s21, 12
  s_add_u32 s31, s31, 50331648
  s_add_u32 s64, s23, s31
  s_add_u32 s65, s64, 131072
  v_accvgpr_read_b32 v68, a64
  v_accvgpr_read_b32 v69, a65
  v_accvgpr_read_b32 v70, a66
  v_accvgpr_read_b32 v71, a67
  v_accvgpr_read_b32 v72, a72
  v_accvgpr_read_b32 v73, a73
  v_accvgpr_read_b32 v74, a74
  v_accvgpr_read_b32 v75, a75
  v_pk_mul_f32 v[68:69], v[68:69], v[16:17]
  v_pk_mul_f32 v[70:71], v[70:71], v[16:17]
  v_pk_mul_f32 v[72:73], v[72:73], v[16:17]
  v_pk_mul_f32 v[74:75], v[74:75], v[16:17]
  v_cvt_pk_bf16_f32 v64, v68, v69
  v_cvt_pk_bf16_f32 v65, v70, v71
  v_cvt_pk_bf16_f32 v66, v72, v73
  v_cvt_pk_bf16_f32 v67, v74, v75
  buffer_store_dwordx4 v[64:67], v2, s[40:43], s64 offen offset:0 sc1
  v_accvgpr_read_b32 v80, a80
  v_accvgpr_read_b32 v81, a81
  v_accvgpr_read_b32 v82, a82
  v_accvgpr_read_b32 v83, a83
  v_accvgpr_read_b32 v84, a88
  v_accvgpr_read_b32 v85, a89
  v_accvgpr_read_b32 v86, a90
  v_accvgpr_read_b32 v87, a91
  v_pk_mul_f32 v[80:81], v[80:81], v[16:17]
  v_pk_mul_f32 v[82:83], v[82:83], v[16:17]
  v_pk_mul_f32 v[84:85], v[84:85], v[16:17]
  v_pk_mul_f32 v[86:87], v[86:87], v[16:17]
  v_cvt_pk_bf16_f32 v76, v80, v81
  v_cvt_pk_bf16_f32 v77, v82, v83
  v_cvt_pk_bf16_f32 v78, v84, v85
  v_cvt_pk_bf16_f32 v79, v86, v87
  buffer_store_dwordx4 v[76:79], v2, s[40:43], s64 offen offset:1024 sc1
  v_accvgpr_read_b32 v132, a96
  v_accvgpr_read_b32 v133, a97
  v_accvgpr_read_b32 v134, a98
  v_accvgpr_read_b32 v135, a99
  v_accvgpr_read_b32 v136, a104
  v_accvgpr_read_b32 v137, a105
  v_accvgpr_read_b32 v138, a106
  v_accvgpr_read_b32 v139, a107
  v_pk_mul_f32 v[132:133], v[132:133], v[16:17]
  v_pk_mul_f32 v[134:135], v[134:135], v[16:17]
  v_pk_mul_f32 v[136:137], v[136:137], v[16:17]
  v_pk_mul_f32 v[138:139], v[138:139], v[16:17]
  v_cvt_pk_bf16_f32 v128, v132, v133
  v_cvt_pk_bf16_f32 v129, v134, v135
  v_cvt_pk_bf16_f32 v130, v136, v137
  v_cvt_pk_bf16_f32 v131, v138, v139
  buffer_store_dwordx4 v[128:131], v2, s[40:43], s64 offen offset:2048 sc1
  v_accvgpr_read_b32 v144, a112
  v_accvgpr_read_b32 v145, a113
  v_accvgpr_read_b32 v146, a114
  v_accvgpr_read_b32 v147, a115
  v_accvgpr_read_b32 v148, a120
  v_accvgpr_read_b32 v149, a121
  v_accvgpr_read_b32 v150, a122
  v_accvgpr_read_b32 v151, a123
  v_pk_mul_f32 v[144:145], v[144:145], v[16:17]
  v_pk_mul_f32 v[146:147], v[146:147], v[16:17]
  v_pk_mul_f32 v[148:149], v[148:149], v[16:17]
  v_pk_mul_f32 v[150:151], v[150:151], v[16:17]
  v_cvt_pk_bf16_f32 v140, v144, v145
  v_cvt_pk_bf16_f32 v141, v146, v147
  v_cvt_pk_bf16_f32 v142, v148, v149
  v_cvt_pk_bf16_f32 v143, v150, v151
  buffer_store_dwordx4 v[140:143], v2, s[40:43], s64 offen offset:3072 sc1
  v_accvgpr_read_b32 v68, a68
  v_accvgpr_read_b32 v69, a69
  v_accvgpr_read_b32 v70, a70
  v_accvgpr_read_b32 v71, a71
  v_accvgpr_read_b32 v72, a76
  v_accvgpr_read_b32 v73, a77
  v_accvgpr_read_b32 v74, a78
  v_accvgpr_read_b32 v75, a79
  v_pk_mul_f32 v[68:69], v[68:69], v[18:19]
  v_pk_mul_f32 v[70:71], v[70:71], v[18:19]
  v_pk_mul_f32 v[72:73], v[72:73], v[18:19]
  v_pk_mul_f32 v[74:75], v[74:75], v[18:19]
  v_cvt_pk_bf16_f32 v64, v68, v69
  v_cvt_pk_bf16_f32 v65, v70, v71
  v_cvt_pk_bf16_f32 v66, v72, v73
  v_cvt_pk_bf16_f32 v67, v74, v75
  buffer_store_dwordx4 v[64:67], v2, s[40:43], s65 offen offset:0 sc1
  v_accvgpr_read_b32 v80, a84
  v_accvgpr_read_b32 v81, a85
  v_accvgpr_read_b32 v82, a86
  v_accvgpr_read_b32 v83, a87
  v_accvgpr_read_b32 v84, a92
  v_accvgpr_read_b32 v85, a93
  v_accvgpr_read_b32 v86, a94
  v_accvgpr_read_b32 v87, a95
  v_pk_mul_f32 v[80:81], v[80:81], v[18:19]
  v_pk_mul_f32 v[82:83], v[82:83], v[18:19]
  v_pk_mul_f32 v[84:85], v[84:85], v[18:19]
  v_pk_mul_f32 v[86:87], v[86:87], v[18:19]
  v_cvt_pk_bf16_f32 v76, v80, v81
  v_cvt_pk_bf16_f32 v77, v82, v83
  v_cvt_pk_bf16_f32 v78, v84, v85
  v_cvt_pk_bf16_f32 v79, v86, v87
  buffer_store_dwordx4 v[76:79], v2, s[40:43], s65 offen offset:1024 sc1
  v_accvgpr_read_b32 v132, a100
  v_accvgpr_read_b32 v133, a101
  v_accvgpr_read_b32 v134, a102
  v_accvgpr_read_b32 v135, a103
  v_accvgpr_read_b32 v136, a108
  v_accvgpr_read_b32 v137, a109
  v_accvgpr_read_b32 v138, a110
  v_accvgpr_read_b32 v139, a111
  v_pk_mul_f32 v[132:133], v[132:133], v[18:19]
  v_pk_mul_f32 v[134:135], v[134:135], v[18:19]
  v_pk_mul_f32 v[136:137], v[136:137], v[18:19]
  v_pk_mul_f32 v[138:139], v[138:139], v[18:19]
  v_cvt_pk_bf16_f32 v128, v132, v133
  v_cvt_pk_bf16_f32 v129, v134, v135
  v_cvt_pk_bf16_f32 v130, v136, v137
  v_cvt_pk_bf16_f32 v131, v138, v139
  buffer_store_dwordx4 v[128:131], v2, s[40:43], s65 offen offset:2048 sc1
  v_accvgpr_read_b32 v144, a116
  v_accvgpr_read_b32 v145, a117
  v_accvgpr_read_b32 v146, a118
  v_accvgpr_read_b32 v147, a119
  v_accvgpr_read_b32 v148, a124
  v_accvgpr_read_b32 v149, a125
  v_accvgpr_read_b32 v150, a126
  v_accvgpr_read_b32 v151, a127
  v_pk_mul_f32 v[144:145], v[144:145], v[18:19]
  v_pk_mul_f32 v[146:147], v[146:147], v[18:19]
  v_pk_mul_f32 v[148:149], v[148:149], v[18:19]
  v_pk_mul_f32 v[150:151], v[150:151], v[18:19]
  v_cvt_pk_bf16_f32 v140, v144, v145
  v_cvt_pk_bf16_f32 v141, v146, v147
  v_cvt_pk_bf16_f32 v142, v148, v149
  v_cvt_pk_bf16_f32 v143, v150, v151
  buffer_store_dwordx4 v[140:143], v2, s[40:43], s65 offen offset:3072 sc1
  s_cmp_lt_u32 s12, 3
  s_cbranch_scc1 fa_hk9
fa_hb9:
  s_load_dwordx2 s[4:5], s[0:1], 0
  s_load_dwordx2 s[6:7], s[0:1], 88
  v_mov_b32 v30, 1073741824
  v_mov_b32 v31, 1
  v_writelane_b32 v30, s80, 0
  v_writelane_b32 v30, s3, 1
  s_lshl_b32 s64, s21, 19
  s_lshl_b32 s23, s20, 15
  s_add_u32 s64, s64, s23
  s_add_u32 s64, s64, 50331648
  s_add_u32 s65, s64, 131072
  s_add_u32 s66, s64, 262144
  s_add_u32 s67, s64, 393216
  v_bfe_u32 v12, v1, 3, 1
  v_lshlrev_b32 v12, 7, v12
  v_and_b32 v13, 7, v1
  v_lshl_add_u32 v12, v13, 2, v12
  s_lshl_b32 s23, s21, 8
  s_lshl_b32 s31, s20, 5
  s_add_u32 s23, s23, s31
  s_add_u32 s23, s23, 2641920
  v_add_u32 v12, s23, v12
  s_lshl_b32 s25, s21, 6
  s_mul_i32 s26, s22, 160
  s_mul_i32 s27, s22, 2560
  v_add_u32 v16, 0, v0
  v_mul_u32_u24 v17, 6554, v16
  v_lshrrev_b32 v17, 16, v17
  v_mul_u32_u24 v18, 10, v17
  v_sub_u32 v18, v16, v18
  v_mul_u32_u24 v251, 336, v17
  v_lshl_add_u32 v251, v18, 5, v251
  v_lshlrev_b32 v203, 5, v18
  v_add_u32 v17, s25, v17
  v_add_u32 v24, 1, v17
  v_mul_u32_u24 v248, 1280, v17
  v_lshl_add_u32 v248, v18, 4, v248
  v_add_u32 v248, s26, v248
  v_lshrrev_b32 v19, 4, v17
  v_mul_u32_u24 v19, 20480, v19
  v_and_b32 v17, 15, v17
  v_lshl_add_u32 v19, v17, 4, v19
  v_lshl_add_u32 v200, v18, 8, v19
  v_mov_b32 v27, 8
  v_add_u32 v16, 256, v0
  v_mul_u32_u24 v17, 6554, v16
  v_lshrrev_b32 v17, 16, v17
  v_mul_u32_u24 v18, 10, v17
  v_sub_u32 v18, v16, v18
  v_mul_u32_u24 v252, 336, v17
  v_lshl_add_u32 v252, v18, 5, v252
  v_lshlrev_b32 v204, 5, v18
  v_add_u32 v17, s25, v17
  v_add_u32 v25, 1, v17
  v_mul_u32_u24 v249, 1280, v17
  v_lshl_add_u32 v249, v18, 4, v249
  v_add_u32 v249, s26, v249
  v_lshrrev_b32 v19, 4, v17
  v_mul_u32_u24 v19, 20480, v19
  v_and_b32 v17, 15, v17
  v_lshl_add_u32 v19, v17, 4, v19
  v_lshl_add_u32 v201, v18, 8, v19
  v_mov_b32 v28, 8
  v_add_u32 v16, 512, v0
  v_mul_u32_u24 v17, 6554, v16
  v_lshrrev_b32 v17, 16, v17
  v_mul_u32_u24 v18, 10, v17
  v_sub_u32 v18, v16, v18
  v_mul_u32_u24 v253, 336, v17
  v_lshl_add_u32 v253, v18, 5, v253
  v_lshlrev_b32 v205, 5, v18
  v_add_u32 v17, s25, v17
  v_add_u32 v26, 1, v17
  v_mul_u32_u24 v250, 1280, v17
  v_lshl_add_u32 v250, v18, 4, v250
  v_add_u32 v250, s26, v250
  v_lshrrev_b32 v19, 4, v17
  v_mul_u32_u24 v19, 20480, v19
  v_and_b32 v17, 15, v17
  v_lshl_add_u32 v19, v17, 4, v19
  v_lshl_add_u32 v202, v18, 8, v19
  v_mov_b32 v29, 8
  v_cmp_gt_u32 vcc, 128, v0
  v_mov_b32 v16, 1073741824
  v_mov_b32 v17, 0
  v_cndmask_b32 v250, v16, v250, vcc
  v_cndmask_b32 v202, v16, v202, vcc
  v_cndmask_b32 v253, v17, v253, vcc
  v_mov_b32 v20, 0
  v_mov_b32 v21, 0
  v_mov_b32 v22, 0
  v_mov_b32 v23, 0
  v_add_u32 v16, 158208, v2
  ds_write_b128 v16, v[20:23]
  s_cmp_lt_u32 s12, 3
  s_waitcnt vmcnt(18) lgkmcnt(0)
  s_cbranch_scc1 fa_pub
  s_waitcnt vmcnt(0)
fa_pub:
  buffer_store_dword v31, v30, s[40:43], 0 offen sc1
  s_cmp_lt_u32 s12, 3
  s_cbranch_scc1 fa_hk10
fa_hb10:
  s_cmp_lt_u32 s29, 8
  s_cbranch_scc1 fa_left
fa_leftb:
  s_add_u32 s13, s13, 61440
  buffer_load_dwordx4 v[64:67], v2, s[40:43], s13 offen offset:0 sc1
  buffer_load_dwordx4 v[68:71], v2, s[40:43], s13 offen offset:1024 sc1
  buffer_load_dwordx4 v[72:75], v2, s[40:43], s13 offen offset:2048 sc1
  buffer_load_dwordx4 v[76:79], v2, s[40:43], s13 offen offset:3072 sc1
  s_add_u32 s13, s13, 4096
  buffer_load_dwordx4 v[80:83], v2, s[40:43], s13 offen offset:0 sc1
  buffer_load_dwordx4 v[84:87], v2, s[40:43], s13 offen offset:1024 sc1
  buffer_load_dwordx4 v[88:91], v2, s[40:43], s13 offen offset:2048 sc1
  buffer_load_dwordx4 v[92:95], v2, s[40:43], s13 offen offset:3072 sc1
  s_add_u32 s13, s13, 4096
  buffer_load_dwordx4 v[128:131], v2, s[40:43], s13 offen offset:0 sc1
  buffer_load_dwordx4 v[132:135], v2, s[40:43], s13 offen offset:1024 sc1
  buffer_load_dwordx4 v[136:139], v2, s[40:43], s13 offen offset:2048 sc1
  buffer_load_dwordx4 v[140:143], v2, s[40:43], s13 offen offset:3072 sc1
  s_add_u32 s13, s13, 4096
  buffer_load_dwordx4 v[144:147], v2, s[40:43], s13 offen offset:0 sc1
  buffer_load_dwordx4 v[148:151], v2, s[40:43], s13 offen offset:1024 sc1
  buffer_load_dwordx4 v[152:155], v2, s[40:43], s13 offen offset:2048 sc1
  buffer_load_dwordx4 v[156:159], v2, s[40:43], s13 offen offset:3072 sc1
  s_add_u32 s13, s13, 4096
  buffer_load_dwordx4 v[176:179], v2, s[40:43], s13 offen offset:0 sc1
  buffer_load_dwordx4 v[180:183], v2, s[40:43], s13 offen offset:1024 sc1
  buffer_load_dwordx4 v[184:187], v2, s[40:43], s13 offen offset:2048 sc1
  buffer_load_dwordx4 v[188:191], v2, s[40:43], s13 offen offset:3072 sc1
  s_add_u32 s13, s13, 4096
  s_barrier
  s_add_u32 s14, s13, 45056
  s_mul_i32 s23, s20, 38912
  v_add_u32 v11, s23, v2
  s_add_u32 m0, s23, 0
  s_nop 0
  buffer_load_dwordx4 v2, s[40:43], s14 offen offset:0 sc1 lds
  buffer_load_dwordx4 v2, s[40:43], s14 offen offset:1024 sc1 lds
  buffer_load_dwordx4 v2, s[40:43], s14 offen offset:2048 sc1 lds
  buffer_load_dwordx4 v2, s[40:43], s14 offen offset:3072 sc1 lds
  s_add_u32 s14, s14, 4096
  s_add_u32 m0, s23, 4096
  s_nop 0
  buffer_load_dwordx4 v2, s[40:43], s14 offen offset:0 sc1 lds
  buffer_load_dwordx4 v2, s[40:43], s14 offen offset:1024 sc1 lds
  buffer_load_dwordx4 v2, s[40:43], s14 offen offset:2048 sc1 lds
  buffer_load_dwordx4 v2, s[40:43], s14 offen offset:3072 sc1 lds
  s_add_u32 s14, s14, 4096
  s_add_u32 m0, s23, 8192
  s_nop 0
  buffer_load_dwordx4 v2, s[40:43], s14 offen offset:0 sc1 lds
  buffer_load_dwordx4 v2, s[40:43], s14 offen offset:1024 sc1 lds
  buffer_load_dwordx4 v2, s[40:43], s14 offen offset:2048 sc1 lds
  buffer_load_dwordx4 v2, s[40:43], s14 offen offset:3072 sc1 lds
  s_add_u32 s14, s14, 4096
  s_add_u32 m0, s23, 12288
  s_nop 0
  buffer_load_dwordx4 v2, s[40:43], s14 offen offset:0 sc1 lds
  buffer_load_dwordx4 v2, s[40:43], s14 offen offset:1024 sc1 lds
  buffer_load_dwordx4 v2, s[40:43], s14 offen offset:2048 sc1 lds
  buffer_load_dwordx4 v2, s[40:43], s14 offen offset:3072 sc1 lds
  s_add_u32 s14, s14, 4096
  s_add_u32 m0, s23, 16384
  s_nop 0
  buffer_load_dwordx4 v2, s[40:43], s14 offen offset:0 sc1 lds
  buffer_load_dwordx4 v2, s[40:43], s14 offen offset:1024 sc1 lds
  buffer_load_dwordx4 v2, s[40:43], s14 offen offset:2048 sc1 lds
  buffer_load_dwordx4 v2, s[40:43], s14 offen offset:3072 sc1 lds
  s_add_u32 s14, s14, 4096
  s_add_u32 m0, s23, 20480
  s_nop 0
  buffer_load_dwordx4 v2, s[40:43], s14 offen offset:0 sc1 lds
  buffer_load_dwordx4 v2, s[40:43], s14 offen offset:1024 sc1 lds
  buffer_load_dwordx4 v2, s[40:43], s14 offen offset:2048 sc1 lds
  buffer_load_dwordx4 v2, s[40:43], s14 offen offset:3072 sc1 lds
  s_add_u32 s14, s14, 4096
  buffer_load_dword v13, v12, s[40:43], 0 offen sc1
  s_add_u32 m0, s23, 24576
  s_nop 0
  buffer_load_dwordx4 v2, s[40:43], s14 offen offset:0 sc1 lds
  buffer_load_dwordx4 v2, s[40:43], s14 offen offset:1024 sc1 lds
  buffer_load_dwordx4 v2, s[40:43], s14 offen offset:2048 sc1 lds
  buffer_load_dwordx4 v2, s[40:43], s14 offen offset:3072 sc1 lds
  s_add_u32 s14, s14, 4096
  s_add_u32 m0, s23, 28672
  s_nop 0
  buffer_load_dwordx4 v2, s[40:43], s14 offen offset:0 sc1 lds
  buffer_load_dwordx4 v2, s[40:43], s14 offen offset:1024 sc1 lds
  buffer_load_dwordx4 v2, s[40:43], s14 offen offset:2048 sc1 lds
  buffer_load_dwordx4 v2, s[40:43], s14 offen offset:3072 sc1 lds
  s_add_u32 s14, s14, 4096
  s_add_u32 m0, s23, 32768
  s_nop 0
  buffer_load_dwordx4 v2, s[40:43], s14 offen offset:0 sc1 lds
  buffer_load_dwordx4 v2, s[40:43], s14 offen offset:1024 sc1 lds
  buffer_load_dwordx4 v2, s[40:43], s14 offen offset:2048 sc1 lds
  buffer_load_dwordx4 v2, s[40:43], s14 offen offset:3072 sc1 lds
  s_add_u32 s14, s14, 4096
  s_mov_b32 s44, s4
  s_mov_b32 s45, s5
  s_mov_b32 s46, 2621440
  s_mov_b32 s47, 0x20000
  s_mov_b32 s48, s6
  s_mov_b32 s49, s7
  s_mov_b32 s50, 2621440
  s_mov_b32 s51, 0x20000
  v_readlane_b32 s68, v15, 0
  v_readlane_b32 s69, v15, 1
  v_readlane_b32 s70, v15, 2
  v_readlane_b32 s71, v15, 3
  v_readlane_b32 s72, v15, 4
  v_readlane_b32 s73, v15, 5
  v_readlane_b32 s74, v15, 6
  v_readlane_b32 s75, v15, 7
  v_cmp_eq_u32 s[52:53], s68, v24
  v_cmp_eq_u32 s[54:55], s68, v25
  v_cmp_eq_u32 s[56:57], s68, v26
  v_cndmask_b32 v27, v27, 0, s[52:53]
  v_cndmask_b32 v28, v28, 0, s[54:55]
  v_cndmask_b32 v29, v29, 0, s[56:57]
  v_cmp_eq_u32 s[52:53], s69, v24
  v_cmp_eq_u32 s[54:55], s69, v25
  v_cmp_eq_u32 s[56:57], s69, v26
  v_cndmask_b32 v27, v27, 1, s[52:53]
  v_cndmask_b32 v28, v28, 1, s[54:55]
  v_cndmask_b32 v29, v29, 1, s[56:57]
  v_cmp_eq_u32 s[52:53], s70, v24
  v_cmp_eq_u32 s[54:55], s70, v25
  v_cmp_eq_u32 s[56:57], s70, v26
  v_cndmask_b32 v27, v27, 2, s[52:53]
  v_cndmask_b32 v28, v28, 2, s[54:55]
  v_cndmask_b32 v29, v29, 2, s[56:57]
  v_cmp_eq_u32 s[52:53], s71, v24
  v_cmp_eq_u32 s[54:55], s71, v25
  v_cmp_eq_u32 s[56:57], s71, v26
  v_cndmask_b32 v27, v27, 3, s[52:53]
  v_cndmask_b32 v28, v28, 3, s[54:55]
  v_cndmask_b32 v29, v29, 3, s[56:57]
  v_cmp_eq_u32 s[52:53], s72, v24
  v_cmp_eq_u32 s[54:55], s72, v25
  v_cmp_eq_u32 s[56:57], s72, v26
  v_cndmask_b32 v27, v27, 4, s[52:53]
  v_cndmask_b32 v28, v28, 4, s[54:55]
  v_cndmask_b32 v29, v29, 4, s[56:57]
  v_cmp_eq_u32 s[52:53], s73, v24
  v_cmp_eq_u32 s[54:55], s73, v25
  v_cmp_eq_u32 s[56:57], s73, v26
  v_cndmask_b32 v27, v27, 5, s[52:53]
  v_cndmask_b32 v28, v28, 5, s[54:55]
  v_cndmask_b32 v29, v29, 5, s[56:57]
  v_cmp_eq_u32 s[52:53], s74, v24
  v_cmp_eq_u32 s[54:55], s74, v25
  v_cmp_eq_u32 s[56:57], s74, v26
  v_cndmask_b32 v27, v27, 6, s[52:53]
  v_cndmask_b32 v28, v28, 6, s[54:55]
  v_cndmask_b32 v29, v29, 6, s[56:57]
  v_cmp_eq_u32 s[52:53], s75, v24
  v_cmp_eq_u32 s[54:55], s75, v25
  v_cmp_eq_u32 s[56:57], s75, v26
  v_cndmask_b32 v27, v27, 7, s[52:53]
  v_cndmask_b32 v28, v28, 7, s[54:55]
  v_cndmask_b32 v29, v29, 7, s[56:57]
  v_mul_u32_u24 v27, 320, v27
  v_add_u32 v203, v203, v27
  v_mul_u32_u24 v28, 320, v28
  v_add_u32 v204, v204, v28
  v_mul_u32_u24 v29, 320, v29
  v_add_u32 v205, v205, v29
  v_add_u32 v203, 155648, v203
  v_add_u32 v204, 155648, v204
  v_add_u32 v205, 155648, v205
  s_waitcnt vmcnt(12)
  v_cmp_eq_u32 vcc, 0, v13
  s_cbranch_vccnz fa_ctx_spin
fa_ctx_ok:
  buffer_load_dwordx4 a[144:147], v2, s[40:43], s64 offen offset:0 sc1
  buffer_load_dwordx4 a[148:151], v2, s[40:43], s65 offen offset:0 sc1
  buffer_load_dwordx4 a[152:155], v2, s[40:43], s66 offen offset:0 sc1
  buffer_load_dwordx4 a[156:159], v2, s[40:43], s67 offen offset:0 sc1
  buffer_load_dwordx4 a[160:163], v2, s[40:43], s64 offen offset:1024 sc1
  buffer_load_dwordx4 a[164:167], v2, s[40:43], s65 offen offset:1024 sc1
  buffer_load_dwordx4 a[168:171], v2, s[40:43], s66 offen offset:1024 sc1
  buffer_load_dwordx4 a[172:175], v2, s[40:43], s67 offen offset:1024 sc1
  buffer_load_dwordx4 a[176:179], v2, s[40:43], s64 offen offset:2048 sc1
  buffer_load_dwordx4 a[180:183], v2, s[40:43], s65 offen offset:2048 sc1
  buffer_load_dwordx4 a[184:187], v2, s[40:43], s66 offen offset:2048 sc1
  buffer_load_dwordx4 a[188:191], v2, s[40:43], s67 offen offset:2048 sc1
  buffer_load_dwordx4 v[216:219], v2, s[40:43], s64 offen offset:3072 sc1
  buffer_load_dwordx4 v[220:223], v2, s[40:43], s65 offen offset:3072 sc1
  buffer_load_dwordx4 v[224:227], v2, s[40:43], s66 offen offset:3072 sc1
  buffer_load_dwordx4 v[228:231], v2, s[40:43], s67 offen offset:3072 sc1
  s_add_u32 s64, s64, 4096
  s_add_u32 s65, s65, 4096
  s_add_u32 s66, s66, 4096
  s_add_u32 s67, s67, 4096
  s_waitcnt vmcnt(12)
  v_mfma_f32_16x16x32_bf16 a[64:67], a[0:3], a[144:147], 0
  v_mfma_f32_16x16x32_bf16 a[68:71], a[0:3], a[148:151], 0
  v_mfma_f32_16x16x32_bf16 a[72:75], a[0:3], a[152:155], 0
  v_mfma_f32_16x16x32_bf16 a[76:79], a[0:3], a[156:159], 0
  buffer_load_dwordx4 a[0:3], v2, s[40:43], s13 offen offset:0 sc1
  v_mfma_f32_16x16x32_bf16 a[80:83], a[4:7], a[144:147], 0
  v_mfma_f32_16x16x32_bf16 a[84:87], a[4:7], a[148:151], 0
  v_mfma_f32_16x16x32_bf16 a[88:91], a[4:7], a[152:155], 0
  v_mfma_f32_16x16x32_bf16 a[92:95], a[4:7], a[156:159], 0
  buffer_load_dwordx4 a[4:7], v2, s[40:43], s13 offen offset:1024 sc1
  v_mfma_f32_16x16x32_bf16 a[96:99], a[8:11], a[144:147], 0
  v_mfma_f32_16x16x32_bf16 a[100:103], a[8:11], a[148:151], 0
  v_mfma_f32_16x16x32_bf16 a[104:107], a[8:11], a[152:155], 0
  v_mfma_f32_16x16x32_bf16 a[108:111], a[8:11], a[156:159], 0
  buffer_load_dwordx4 a[8:11], v2, s[40:43], s13 offen offset:2048 sc1
  v_mfma_f32_16x16x32_bf16 a[112:115], a[12:15], a[144:147], 0
  v_mfma_f32_16x16x32_bf16 a[116:119], a[12:15], a[148:151], 0
  v_mfma_f32_16x16x32_bf16 a[120:123], a[12:15], a[152:155], 0
  v_mfma_f32_16x16x32_bf16 a[124:127], a[12:15], a[156:159], 0
  v_mfma_f32_16x16x32_bf16 a[128:131], a[16:19], a[144:147], 0
  buffer_load_dwordx4 a[144:147], v2, s[40:43], s64 offen offset:0 sc1
  v_mfma_f32_16x16x32_bf16 a[132:135], a[16:19], a[148:151], 0
  buffer_load_dwordx4 a[148:151], v2, s[40:43], s65 offen offset:0 sc1
  v_mfma_f32_16x16x32_bf16 a[136:139], a[16:19], a[152:155], 0
  buffer_load_dwordx4 a[152:155], v2, s[40:43], s66 offen offset:0 sc1
  v_mfma_f32_16x16x32_bf16 a[140:143], a[16:19], a[156:159], 0
  buffer_load_dwordx4 a[156:159], v2, s[40:43], s67 offen offset:0 sc1
  s_waitcnt vmcnt(15)
  v_mfma_f32_16x16x32_bf16 a[64:67], a[20:23], a[160:163], a[64:67]
  v_mfma_f32_16x16x32_bf16 a[68:71], a[20:23], a[164:167], a[68:71]
  v_mfma_f32_16x16x32_bf16 a[72:75], a[20:23], a[168:171], a[72:75]
  v_mfma_f32_16x16x32_bf16 a[76:79], a[20:23], a[172:175], a[76:79]
  buffer_load_dwordx4 a[12:15], v2, s[40:43], s13 offen offset:3072 sc1
  v_mfma_f32_16x16x32_bf16 a[80:83], a[24:27], a[160:163], a[80:83]
  s_add_u32 s13, s13, 4096
  v_mfma_f32_16x16x32_bf16 a[84:87], a[24:27], a[164:167], a[84:87]
  v_mfma_f32_16x16x32_bf16 a[88:91], a[24:27], a[168:171], a[88:91]
  v_mfma_f32_16x16x32_bf16 a[92:95], a[24:27], a[172:175], a[92:95]
  buffer_load_dwordx4 a[16:19], v2, s[40:43], s13 offen offset:0 sc1
  v_mfma_f32_16x16x32_bf16 a[96:99], a[28:31], a[160:163], a[96:99]
  v_mfma_f32_16x16x32_bf16 a[100:103], a[28:31], a[164:167], a[100:103]
  v_mfma_f32_16x16x32_bf16 a[104:107], a[28:31], a[168:171], a[104:107]
  v_mfma_f32_16x16x32_bf16 a[108:111], a[28:31], a[172:175], a[108:111]
  v_mfma_f32_16x16x32_bf16 a[112:115], a[32:35], a[160:163], a[112:115]
  v_mfma_f32_16x16x32_bf16 a[116:119], a[32:35], a[164:167], a[116:119]
  v_mfma_f32_16x16x32_bf16 a[120:123], a[32:35], a[168:171], a[120:123]
  v_mfma_f32_16x16x32_bf16 a[124:127], a[32:35], a[172:175], a[124:127]
  v_mfma_f32_16x16x32_bf16 a[128:131], a[36:39], a[160:163], a[128:131]
  buffer_load_dwordx4 a[160:163], v2, s[40:43], s64 offen offset:1024 sc1
  v_mfma_f32_16x16x32_bf16 a[132:135], a[36:39], a[164:167], a[132:135]
  buffer_load_dwordx4 a[164:167], v2, s[40:43], s65 offen offset:1024 sc1
  v_mfma_f32_16x16x32_bf16 a[136:139], a[36:39], a[168:171], a[136:139]
  buffer_load_dwordx4 a[168:171], v2, s[40:43], s66 offen offset:1024 sc1
  v_mfma_f32_16x16x32_bf16 a[140:143], a[36:39], a[172:175], a[140:143]
  buffer_load_dwordx4 a[172:175], v2, s[40:43], s67 offen offset:1024 sc1
  s_waitcnt vmcnt(17)
  v_mfma_f32_16x16x32_bf16 a[64:67], a[40:43], a[176:179], a[64:67]
  v_mfma_f32_16x16x32_bf16 a[68:71], a[40:43], a[180:183], a[68:71]
  v_mfma_f32_16x16x32_bf16 a[72:75], a[40:43], a[184:187], a[72:75]
  v_mfma_f32_16x16x32_bf16 a[76:79], a[40:43], a[188:191], a[76:79]
  buffer_load_dwordx4 a[20:23], v2, s[40:43], s13 offen offset:1024 sc1
  v_mfma_f32_16x16x32_bf16 a[80:83], a[44:47], a[176:179], a[80:83]
  v_mfma_f32_16x16x32_bf16 a[84:87], a[44:47], a[180:183], a[84:87]
  v_mfma_f32_16x16x32_bf16 a[88:91], a[44:47], a[184:187], a[88:91]
  v_mfma_f32_16x16x32_bf16 a[92:95], a[44:47], a[188:191], a[92:95]
  buffer_load_dwordx4 a[24:27], v2, s[40:43], s13 offen offset:2048 sc1
  v_mfma_f32_16x16x32_bf16 a[96:99], a[48:51], a[176:179], a[96:99]
  v_mfma_f32_16x16x32_bf16 a[100:103], a[48:51], a[180:183], a[100:103]
  v_mfma_f32_16x16x32_bf16 a[104:107], a[48:51], a[184:187], a[104:107]
  v_mfma_f32_16x16x32_bf16 a[108:111], a[48:51], a[188:191], a[108:111]
  v_mfma_f32_16x16x32_bf16 a[112:115], a[52:55], a[176:179], a[112:115]
  v_mfma_f32_16x16x32_bf16 a[116:119], a[52:55], a[180:183], a[116:119]
  v_mfma_f32_16x16x32_bf16 a[120:123], a[52:55], a[184:187], a[120:123]
  v_mfma_f32_16x16x32_bf16 a[124:127], a[52:55], a[188:191], a[124:127]
  v_mfma_f32_16x16x32_bf16 a[128:131], a[56:59], a[176:179], a[128:131]
  buffer_load_dwordx4 a[176:179], v2, s[40:43], s64 offen offset:2048 sc1
  v_mfma_f32_16x16x32_bf16 a[132:135], a[56:59], a[180:183], a[132:135]
  buffer_load_dwordx4 a[180:183], v2, s[40:43], s65 offen offset:2048 sc1
  v_mfma_f32_16x16x32_bf16 a[136:139], a[56:59], a[184:187], a[136:139]
  buffer_load_dwordx4 a[184:187], v2, s[40:43], s66 offen offset:2048 sc1
  v_mfma_f32_16x16x32_bf16 a[140:143], a[56:59], a[188:191], a[140:143]
  buffer_load_dwordx4 a[188:191], v2, s[40:43], s67 offen offset:2048 sc1
  s_waitcnt vmcnt(19)
  v_mfma_f32_16x16x32_bf16 a[64:67], a[60:63], v[216:219], a[64:67]
  v_mfma_f32_16x16x32_bf16 a[68:71], a[60:63], v[220:223], a[68:71]
  v_mfma_f32_16x16x32_bf16 a[72:75], a[60:63], v[224:227], a[72:75]
  v_mfma_f32_16x16x32_bf16 a[76:79], a[60:63], v[228:231], a[76:79]
  buffer_load_dwordx4 a[28:31], v2, s[40:43], s13 offen offset:3072 sc1
  v_mfma_f32_16x16x32_bf16 a[80:83], a[192:195], v[216:219], a[80:83]
  s_add_u32 s13, s13, 4096
  v_mfma_f32_16x16x32_bf16 a[84:87], a[192:195], v[220:223], a[84:87]
  v_mfma_f32_16x16x32_bf16 a[88:91], a[192:195], v[224:227], a[88:91]
  v_mfma_f32_16x16x32_bf16 a[92:95], a[192:195], v[228:231], a[92:95]
  buffer_load_dwordx4 a[32:35], v2, s[40:43], s13 offen offset:0 sc1
  v_mfma_f32_16x16x32_bf16 a[96:99], a[196:199], v[216:219], a[96:99]
  v_mfma_f32_16x16x32_bf16 a[100:103], a[196:199], v[220:223], a[100:103]
  v_mfma_f32_16x16x32_bf16 a[104:107], a[196:199], v[224:227], a[104:107]
  v_mfma_f32_16x16x32_bf16 a[108:111], a[196:199], v[228:231], a[108:111]
  v_mfma_f32_16x16x32_bf16 a[112:115], a[200:203], v[216:219], a[112:115]
  v_mfma_f32_16x16x32_bf16 a[116:119], a[200:203], v[220:223], a[116:119]
  v_mfma_f32_16x16x32_bf16 a[120:123], a[200:203], v[224:227], a[120:123]
  v_mfma_f32_16x16x32_bf16 a[124:127], a[200:203], v[228:231], a[124:127]
  v_mfma_f32_16x16x32_bf16 a[128:131], a[204:207], v[216:219], a[128:131]
  buffer_load_dwordx4 v[216:219], v2, s[40:43], s64 offen offset:3072 sc1
  v_mfma_f32_16x16x32_bf16 a[132:135], a[204:207], v[220:223], a[132:135]
  buffer_load_dwordx4 v[220:223], v2, s[40:43], s65 offen offset:3072 sc1
  v_mfma_f32_16x16x32_bf16 a[136:139], a[204:207], v[224:227], a[136:139]
  buffer_load_dwordx4 v[224:227], v2, s[40:43], s66 offen offset:3072 sc1
  v_mfma_f32_16x16x32_bf16 a[140:143], a[204:207], v[228:231], a[140:143]
  buffer_load_dwordx4 v[228:231], v2, s[40:43], s67 offen offset:3072 sc1
  s_waitcnt vmcnt(18)
  v_mfma_f32_16x16x32_bf16 a[64:67], a[208:211], a[144:147], a[64:67]
  s_add_u32 s64, s64, 4096
  v_mfma_f32_16x16x32_bf16 a[68:71], a[208:211], a[148:151], a[68:71]
  s_add_u32 s65, s65, 4096
  v_mfma_f32_16x16x32_bf16 a[72:75], a[208:211], a[152:155], a[72:75]
  s_add_u32 s66, s66, 4096
  v_mfma_f32_16x16x32_bf16 a[76:79], a[208:211], a[156:159], a[76:79]
  buffer_load_dwordx4 a[36:39], v2, s[40:43], s13 offen offset:1024 sc1
  v_mfma_f32_16x16x32_bf16 a[80:83], a[212:215], a[144:147], a[80:83]
  v_mfma_f32_16x16x32_bf16 a[84:87], a[212:215], a[148:151], a[84:87]
  v_mfma_f32_16x16x32_bf16 a[88:91], a[212:215], a[152:155], a[88:91]
  s_add_u32 s67, s67, 4096
  v_mfma_f32_16x16x32_bf16 a[92:95], a[212:215], a[156:159], a[92:95]
  buffer_load_dwordx4 a[40:43], v2, s[40:43], s13 offen offset:2048 sc1
  v_mfma_f32_16x16x32_bf16 a[96:99], a[216:219], a[144:147], a[96:99]
  v_mfma_f32_16x16x32_bf16 a[100:103], a[216:219], a[148:151], a[100:103]
  v_mfma_f32_16x16x32_bf16 a[104:107], a[216:219], a[152:155], a[104:107]
  v_mfma_f32_16x16x32_bf16 a[108:111], a[216:219], a[156:159], a[108:111]
  v_mfma_f32_16x16x32_bf16 a[112:115], a[220:223], a[144:147], a[112:115]
  v_mfma_f32_16x16x32_bf16 a[116:119], a[220:223], a[148:151], a[116:119]
  v_mfma_f32_16x16x32_bf16 a[120:123], a[220:223], a[152:155], a[120:123]
  v_mfma_f32_16x16x32_bf16 a[124:127], a[220:223], a[156:159], a[124:127]
  v_mfma_f32_16x16x32_bf16 a[128:131], a[224:227], a[144:147], a[128:131]
  buffer_load_dwordx4 a[144:147], v2, s[40:43], s64 offen offset:0 sc1
  v_mfma_f32_16x16x32_bf16 a[132:135], a[224:227], a[148:151], a[132:135]
  buffer_load_dwordx4 a[148:151], v2, s[40:43], s65 offen offset:0 sc1
  v_mfma_f32_16x16x32_bf16 a[136:139], a[224:227], a[152:155], a[136:139]
  buffer_load_dwordx4 a[152:155], v2, s[40:43], s66 offen offset:0 sc1
  v_mfma_f32_16x16x32_bf16 a[140:143], a[224:227], a[156:159], a[140:143]
  buffer_load_dwordx4 a[156:159], v2, s[40:43], s67 offen offset:0 sc1
  s_waitcnt vmcnt(18)
  v_mfma_f32_16x16x32_bf16 a[64:67], a[228:231], a[160:163], a[64:67]
  v_mfma_f32_16x16x32_bf16 a[68:71], a[228:231], a[164:167], a[68:71]
  v_mfma_f32_16x16x32_bf16 a[72:75], a[228:231], a[168:171], a[72:75]
  v_mfma_f32_16x16x32_bf16 a[76:79], a[228:231], a[172:175], a[76:79]
  buffer_load_dwordx4 a[44:47], v2, s[40:43], s13 offen offset:3072 sc1
  v_mfma_f32_16x16x32_bf16 a[80:83], a[232:235], a[160:163], a[80:83]
  s_add_u32 s13, s13, 4096
  v_mfma_f32_16x16x32_bf16 a[84:87], a[232:235], a[164:167], a[84:87]
  v_mfma_f32_16x16x32_bf16 a[88:91], a[232:235], a[168:171], a[88:91]
  v_mfma_f32_16x16x32_bf16 a[92:95], a[232:235], a[172:175], a[92:95]
  buffer_load_dwordx4 a[48:51], v2, s[40:43], s13 offen offset:0 sc1
  v_mfma_f32_16x16x32_bf16 a[96:99], a[236:239], a[160:163], a[96:99]
  v_mfma_f32_16x16x32_bf16 a[100:103], a[236:239], a[164:167], a[100:103]
  v_mfma_f32_16x16x32_bf16 a[104:107], a[236:239], a[168:171], a[104:107]
  v_mfma_f32_16x16x32_bf16 a[108:111], a[236:239], a[172:175], a[108:111]
  buffer_load_dwordx4 a[52:55], v2, s[40:43], s13 offen offset:1024 sc1
  v_mfma_f32_16x16x32_bf16 a[112:115], a[240:243], a[160:163], a[112:115]
  v_mfma_f32_16x16x32_bf16 a[116:119], a[240:243], a[164:167], a[116:119]
  v_mfma_f32_16x16x32_bf16 a[120:123], a[240:243], a[168:171], a[120:123]
  v_mfma_f32_16x16x32_bf16 a[124:127], a[240:243], a[172:175], a[124:127]
  v_mfma_f32_16x16x32_bf16 a[128:131], a[244:247], a[160:163], a[128:131]
  buffer_load_dwordx4 a[160:163], v2, s[40:43], s64 offen offset:1024 sc1
  v_mfma_f32_16x16x32_bf16 a[132:135], a[244:247], a[164:167], a[132:135]
  buffer_load_dwordx4 a[164:167], v2, s[40:43], s65 offen offset:1024 sc1
  v_mfma_f32_16x16x32_bf16 a[136:139], a[244:247], a[168:171], a[136:139]
  buffer_load_dwordx4 a[168:171], v2, s[40:43], s66 offen offset:1024 sc1
  v_mfma_f32_16x16x32_bf16 a[140:143], a[244:247], a[172:175], a[140:143]
  buffer_load_dwordx4 a[172:175], v2, s[40:43], s67 offen offset:1024 sc1
  s_waitcnt vmcnt(19)
  v_mfma_f32_16x16x32_bf16 a[64:67], a[248:251], a[176:179], a[64:67]
  v_mfma_f32_16x16x32_bf16 a[68:71], a[248:251], a[180:183], a[68:71]
  v_mfma_f32_16x16x32_bf16 a[72:75], a[248:251], a[184:187], a[72:75]
  v_mfma_f32_16x16x32_bf16 a[76:79], a[248:251], a[188:191], a[76:79]
  buffer_load_dwordx4 a[56:59], v2, s[40:43], s13 offen offset:2048 sc1
  v_mfma_f32_16x16x32_bf16 a[80:83], a[252:255], a[176:179], a[80:83]
  v_mfma_f32_16x16x32_bf16 a[84:87], a[252:255], a[180:183], a[84:87]
  v_mfma_f32_16x16x32_bf16 a[88:91], a[252:255], a[184:187], a[88:91]
  v_mfma_f32_16x16x32_bf16 a[92:95], a[252:255], a[188:191], a[92:95]
  buffer_load_dwordx4 a[60:63], v2, s[40:43], s13 offen offset:3072 sc1
  v_mfma_f32_16x16x32_bf16 a[96:99], v[32:35], a[176:179], a[96:99]
  s_add_u32 s13, s13, 4096
  v_mfma_f32_16x16x32_bf16 a[100:103], v[32:35], a[180:183], a[100:103]
  v_mfma_f32_16x16x32_bf16 a[104:107], v[32:35], a[184:187], a[104:107]
  v_mfma_f32_16x16x32_bf16 a[108:111], v[32:35], a[188:191], a[108:111]
  v_mfma_f32_16x16x32_bf16 a[112:115], v[36:39], a[176:179], a[112:115]
  v_mfma_f32_16x16x32_bf16 a[116:119], v[36:39], a[180:183], a[116:119]
  v_mfma_f32_16x16x32_bf16 a[120:123], v[36:39], a[184:187], a[120:123]
  v_mfma_f32_16x16x32_bf16 a[124:127], v[36:39], a[188:191], a[124:127]
  v_mfma_f32_16x16x32_bf16 a[128:131], v[40:43], a[176:179], a[128:131]
  buffer_load_dwordx4 a[176:179], v2, s[40:43], s64 offen offset:2048 sc1
  v_mfma_f32_16x16x32_bf16 a[132:135], v[40:43], a[180:183], a[132:135]
  buffer_load_dwordx4 a[180:183], v2, s[40:43], s65 offen offset:2048 sc1
  v_mfma_f32_16x16x32_bf16 a[136:139], v[40:43], a[184:187], a[136:139]
  buffer_load_dwordx4 a[184:187], v2, s[40:43], s66 offen offset:2048 sc1
  v_mfma_f32_16x16x32_bf16 a[140:143], v[40:43], a[188:191], a[140:143]
  buffer_load_dwordx4 a[188:191], v2, s[40:43], s67 offen offset:2048 sc1
  s_waitcnt vmcnt(19)
  v_mfma_f32_16x16x32_bf16 a[64:67], v[44:47], v[216:219], a[64:67]
  v_mfma_f32_16x16x32_bf16 a[68:71], v[44:47], v[220:223], a[68:71]
  v_mfma_f32_16x16x32_bf16 a[72:75], v[44:47], v[224:227], a[72:75]
  v_mfma_f32_16x16x32_bf16 a[76:79], v[44:47], v[228:231], a[76:79]
  buffer_load_dwordx4 a[192:195], v2, s[40:43], s13 offen offset:0 sc1
  v_mfma_f32_16x16x32_bf16 a[80:83], v[48:51], v[216:219], a[80:83]
  v_mfma_f32_16x16x32_bf16 a[84:87], v[48:51], v[220:223], a[84:87]
  v_mfma_f32_16x16x32_bf16 a[88:91], v[48:51], v[224:227], a[88:91]
  v_mfma_f32_16x16x32_bf16 a[92:95], v[48:51], v[228:231], a[92:95]
  buffer_load_dwordx4 a[196:199], v2, s[40:43], s13 offen offset:1024 sc1
  v_mfma_f32_16x16x32_bf16 a[96:99], v[52:55], v[216:219], a[96:99]
  v_mfma_f32_16x16x32_bf16 a[100:103], v[52:55], v[220:223], a[100:103]
  v_mfma_f32_16x16x32_bf16 a[104:107], v[52:55], v[224:227], a[104:107]
  v_mfma_f32_16x16x32_bf16 a[108:111], v[52:55], v[228:231], a[108:111]
  v_mfma_f32_16x16x32_bf16 a[112:115], v[56:59], v[216:219], a[112:115]
  v_mfma_f32_16x16x32_bf16 a[116:119], v[56:59], v[220:223], a[116:119]
  v_mfma_f32_16x16x32_bf16 a[120:123], v[56:59], v[224:227], a[120:123]
  v_mfma_f32_16x16x32_bf16 a[124:127], v[56:59], v[228:231], a[124:127]
  v_mfma_f32_16x16x32_bf16 a[128:131], v[60:63], v[216:219], a[128:131]
  buffer_load_dwordx4 v[216:219], v2, s[40:43], s64 offen offset:3072 sc1
  v_mfma_f32_16x16x32_bf16 a[132:135], v[60:63], v[220:223], a[132:135]
  buffer_load_dwordx4 v[220:223], v2, s[40:43], s65 offen offset:3072 sc1
  v_mfma_f32_16x16x32_bf16 a[136:139], v[60:63], v[224:227], a[136:139]
  buffer_load_dwordx4 v[224:227], v2, s[40:43], s66 offen offset:3072 sc1
  v_mfma_f32_16x16x32_bf16 a[140:143], v[60:63], v[228:231], a[140:143]
  buffer_load_dwordx4 v[228:231], v2, s[40:43], s67 offen offset:3072 sc1
  s_waitcnt vmcnt(19)
  v_mfma_f32_16x16x32_bf16 a[64:67], v[96:99], a[144:147], a[64:67]
  s_add_u32 s64, s64, 4096
  v_mfma_f32_16x16x32_bf16 a[68:71], v[96:99], a[148:151], a[68:71]
  s_add_u32 s65, s65, 4096
  v_mfma_f32_16x16x32_bf16 a[72:75], v[96:99], a[152:155], a[72:75]
  s_add_u32 s66, s66, 4096
  v_mfma_f32_16x16x32_bf16 a[76:79], v[96:99], a[156:159], a[76:79]
  buffer_load_dwordx4 a[200:203], v2, s[40:43], s13 offen offset:2048 sc1
  v_mfma_f32_16x16x32_bf16 a[80:83], v[100:103], a[144:147], a[80:83]
  v_mfma_f32_16x16x32_bf16 a[84:87], v[100:103], a[148:151], a[84:87]
  v_mfma_f32_16x16x32_bf16 a[88:91], v[100:103], a[152:155], a[88:91]
  s_add_u32 s67, s67, 4096
  v_mfma_f32_16x16x32_bf16 a[92:95], v[100:103], a[156:159], a[92:95]
  buffer_load_dwordx4 a[204:207], v2, s[40:43], s13 offen offset:3072 sc1
  v_mfma_f32_16x16x32_bf16 a[96:99], v[104:107], a[144:147], a[96:99]
  s_add_u32 s13, s13, 4096
  v_mfma_f32_16x16x32_bf16 a[100:103], v[104:107], a[148:151], a[100:103]
  v_mfma_f32_16x16x32_bf16 a[104:107], v[104:107], a[152:155], a[104:107]
  v_mfma_f32_16x16x32_bf16 a[108:111], v[104:107], a[156:159], a[108:111]
  v_mfma_f32_16x16x32_bf16 a[112:115], v[108:111], a[144:147], a[112:115]
  v_mfma_f32_16x16x32_bf16 a[116:119], v[108:111], a[148:151], a[116:119]
  v_mfma_f32_16x16x32_bf16 a[120:123], v[108:111], a[152:155], a[120:123]
  v_mfma_f32_16x16x32_bf16 a[124:127], v[108:111], a[156:159], a[124:127]
  v_mfma_f32_16x16x32_bf16 a[128:131], v[112:115], a[144:147], a[128:131]
  buffer_load_dwordx4 a[144:147], v2, s[40:43], s64 offen offset:0 sc1
  v_mfma_f32_16x16x32_bf16 a[132:135], v[112:115], a[148:151], a[132:135]
  buffer_load_dwordx4 a[148:151], v2, s[40:43], s65 offen offset:0 sc1
  v_mfma_f32_16x16x32_bf16 a[136:139], v[112:115], a[152:155], a[136:139]
  buffer_load_dwordx4 a[152:155], v2, s[40:43], s66 offen offset:0 sc1
  v_mfma_f32_16x16x32_bf16 a[140:143], v[112:115], a[156:159], a[140:143]
  buffer_load_dwordx4 a[156:159], v2, s[40:43], s67 offen offset:0 sc1
  s_waitcnt vmcnt(18)
  v_mfma_f32_16x16x32_bf16 a[64:67], v[116:119], a[160:163], a[64:67]
  v_mfma_f32_16x16x32_bf16 a[68:71], v[116:119], a[164:167], a[68:71]
  ds_read_b128 v[112:115], v11 offset:0
  v_mfma_f32_16x16x32_bf16 a[72:75], v[116:119], a[168:171], a[72:75]
  v_mfma_f32_16x16x32_bf16 a[76:79], v[116:119], a[172:175], a[76:79]
  buffer_load_dwordx4 a[208:211], v2, s[40:43], s13 offen offset:0 sc1
  v_mfma_f32_16x16x32_bf16 a[80:83], v[120:123], a[160:163], a[80:83]
  v_mfma_f32_16x16x32_bf16 a[84:87], v[120:123], a[164:167], a[84:87]
  v_mfma_f32_16x16x32_bf16 a[88:91], v[120:123], a[168:171], a[88:91]
  v_mfma_f32_16x16x32_bf16 a[92:95], v[120:123], a[172:175], a[92:95]
  buffer_load_dwordx4 a[212:215], v2, s[40:43], s13 offen offset:1024 sc1
  v_mfma_f32_16x16x32_bf16 a[96:99], v[124:127], a[160:163], a[96:99]
  v_mfma_f32_16x16x32_bf16 a[100:103], v[124:127], a[164:167], a[100:103]
  v_mfma_f32_16x16x32_bf16 a[104:107], v[124:127], a[168:171], a[104:107]
  v_mfma_f32_16x16x32_bf16 a[108:111], v[124:127], a[172:175], a[108:111]
  v_mfma_f32_16x16x32_bf16 a[112:115], v[160:163], a[160:163], a[112:115]
  v_mfma_f32_16x16x32_bf16 a[116:119], v[160:163], a[164:167], a[116:119]
  v_mfma_f32_16x16x32_bf16 a[120:123], v[160:163], a[168:171], a[120:123]
  v_mfma_f32_16x16x32_bf16 a[124:127], v[160:163], a[172:175], a[124:127]
  v_mfma_f32_16x16x32_bf16 a[128:131], v[164:167], a[160:163], a[128:131]
  buffer_load_dwordx4 a[160:163], v2, s[40:43], s64 offen offset:1024 sc1
  v_mfma_f32_16x16x32_bf16 a[132:135], v[164:167], a[164:167], a[132:135]
  buffer_load_dwordx4 a[164:167], v2, s[40:43], s65 offen offset:1024 sc1
  v_mfma_f32_16x16x32_bf16 a[136:139], v[164:167], a[168:171], a[136:139]
  buffer_load_dwordx4 a[168:171], v2, s[40:43], s66 offen offset:1024 sc1
  v_mfma_f32_16x16x32_bf16 a[140:143], v[164:167], a[172:175], a[140:143]
  buffer_load_dwordx4 a[172:175], v2, s[40:43], s67 offen offset:1024 sc1
  s_waitcnt vmcnt(18)
  v_mfma_f32_16x16x32_bf16 a[64:67], v[168:171], a[176:179], a[64:67]
  v_mfma_f32_16x16x32_bf16 a[68:71], v[168:171], a[180:183], a[68:71]
  ds_read_b128 v[116:119], v11 offset:1024
  v_mfma_f32_16x16x32_bf16 a[72:75], v[168:171], a[184:187], a[72:75]
  v_mfma_f32_16x16x32_bf16 a[76:79], v[168:171], a[188:191], a[76:79]
  buffer_load_dwordx4 a[216:219], v2, s[40:43], s13 offen offset:2048 sc1
  v_mfma_f32_16x16x32_bf16 a[80:83], v[172:175], a[176:179], a[80:83]
  v_mfma_f32_16x16x32_bf16 a[84:87], v[172:175], a[180:183], a[84:87]
  ds_read_b128 v[120:123], v11 offset:2048
  v_mfma_f32_16x16x32_bf16 a[88:91], v[172:175], a[184:187], a[88:91]
  v_mfma_f32_16x16x32_bf16 a[92:95], v[172:175], a[188:191], a[92:95]
  buffer_load_dwordx4 a[220:223], v2, s[40:43], s13 offen offset:3072 sc1
  v_mfma_f32_16x16x32_bf16 a[96:99], v[192:195], a[176:179], a[96:99]
  s_add_u32 s13, s13, 4096
  v_mfma_f32_16x16x32_bf16 a[100:103], v[192:195], a[180:183], a[100:103]
  ds_read_b128 v[124:127], v11 offset:3072
  v_mfma_f32_16x16x32_bf16 a[104:107], v[192:195], a[184:187], a[104:107]
  v_mfma_f32_16x16x32_bf16 a[108:111], v[192:195], a[188:191], a[108:111]
  buffer_load_dwordx4 a[224:227], v2, s[40:43], s13 offen offset:0 sc1
  v_mfma_f32_16x16x32_bf16 a[112:115], v[196:199], a[176:179], a[112:115]
  v_mfma_f32_16x16x32_bf16 a[116:119], v[196:199], a[180:183], a[116:119]
  ds_read_b128 v[160:163], v11 offset:4096
  v_mfma_f32_16x16x32_bf16 a[120:123], v[196:199], a[184:187], a[120:123]
  v_mfma_f32_16x16x32_bf16 a[124:127], v[196:199], a[188:191], a[124:127]
  v_mfma_f32_16x16x32_bf16 a[128:131], v[208:211], a[176:179], a[128:131]
  buffer_load_dwordx4 a[176:179], v2, s[40:43], s64 offen offset:2048 sc1
  v_mfma_f32_16x16x32_bf16 a[132:135], v[208:211], a[180:183], a[132:135]
  buffer_load_dwordx4 a[180:183], v2, s[40:43], s65 offen offset:2048 sc1
  v_mfma_f32_16x16x32_bf16 a[136:139], v[208:211], a[184:187], a[136:139]
  buffer_load_dwordx4 a[184:187], v2, s[40:43], s66 offen offset:2048 sc1
  v_mfma_f32_16x16x32_bf16 a[140:143], v[208:211], a[188:191], a[140:143]
  buffer_load_dwordx4 a[188:191], v2, s[40:43], s67 offen offset:2048 sc1
  s_waitcnt vmcnt(19)
  v_mfma_f32_16x16x32_bf16 a[64:67], v[212:215], v[216:219], a[64:67]
  v_mfma_f32_16x16x32_bf16 a[68:71], v[212:215], v[220:223], a[68:71]
  ds_read_b128 v[164:167], v11 offset:5120
  v_mfma_f32_16x16x32_bf16 a[72:75], v[212:215], v[224:227], a[72:75]
  v_mfma_f32_16x16x32_bf16 a[76:79], v[212:215], v[228:231], a[76:79]
  buffer_load_dwordx4 a[228:231], v2, s[40:43], s13 offen offset:1024 sc1
  v_mfma_f32_16x16x32_bf16 a[80:83], v[232:235], v[216:219], a[80:83]
  v_mfma_f32_16x16x32_bf16 a[84:87], v[232:235], v[220:223], a[84:87]
  ds_read_b128 v[168:171], v11 offset:6144
  v_mfma_f32_16x16x32_bf16 a[88:91], v[232:235], v[224:227], a[88:91]
  v_mfma_f32_16x16x32_bf16 a[92:95], v[232:235], v[228:231], a[92:95]
  buffer_load_dwordx4 a[232:235], v2, s[40:43], s13 offen offset:2048 sc1
  v_mfma_f32_16x16x32_bf16 a[96:99], v[236:239], v[216:219], a[96:99]
  v_mfma_f32_16x16x32_bf16 a[100:103], v[236:239], v[220:223], a[100:103]
  ds_read_b128 v[172:175], v11 offset:7168
  v_mfma_f32_16x16x32_bf16 a[104:107], v[236:239], v[224:227], a[104:107]
  v_mfma_f32_16x16x32_bf16 a[108:111], v[236:239], v[228:231], a[108:111]
  v_mfma_f32_16x16x32_bf16 a[112:115], v[240:243], v[216:219], a[112:115]
  v_mfma_f32_16x16x32_bf16 a[116:119], v[240:243], v[220:223], a[116:119]
  ds_read_b128 v[192:195], v11 offset:8192
  v_mfma_f32_16x16x32_bf16 a[120:123], v[240:243], v[224:227], a[120:123]
  v_mfma_f32_16x16x32_bf16 a[124:127], v[240:243], v[228:231], a[124:127]
  v_mfma_f32_16x16x32_bf16 a[128:131], v[244:247], v[216:219], a[128:131]
  buffer_load_dwordx4 v[216:219], v2, s[40:43], s64 offen offset:3072 sc1
  v_mfma_f32_16x16x32_bf16 a[132:135], v[244:247], v[220:223], a[132:135]
  buffer_load_dwordx4 v[220:223], v2, s[40:43], s65 offen offset:3072 sc1
  v_mfma_f32_16x16x32_bf16 a[136:139], v[244:247], v[224:227], a[136:139]
  buffer_load_dwordx4 v[224:227], v2, s[40:43], s66 offen offset:3072 sc1
  v_mfma_f32_16x16x32_bf16 a[140:143], v[244:247], v[228:231], a[140:143]
  buffer_load_dwordx4 v[228:231], v2, s[40:43], s67 offen offset:3072 sc1
  s_waitcnt vmcnt(19)
  v_mfma_f32_16x16x32_bf16 a[64:67], v[64:67], a[144:147], a[64:67]
  s_add_u32 s64, s64, 4096
  v_mfma_f32_16x16x32_bf16 a[68:71], v[64:67], a[148:151], a[68:71]
  s_add_u32 s65, s65, 4096
  ds_read_b128 v[196:199], v11 offset:9216
  v_mfma_f32_16x16x32_bf16 a[72:75], v[64:67], a[152:155], a[72:75]
  s_add_u32 s66, s66, 4096
  v_mfma_f32_16x16x32_bf16 a[76:79], v[64:67], a[156:159], a[76:79]
  buffer_load_dwordx4 a[236:239], v2, s[40:43], s13 offen offset:3072 sc1
  v_mfma_f32_16x16x32_bf16 a[80:83], v[68:71], a[144:147], a[80:83]
  s_add_u32 s13, s13, 4096
  v_mfma_f32_16x16x32_bf16 a[84:87], v[68:71], a[148:151], a[84:87]
  ds_read_b128 v[208:211], v11 offset:10240
  v_mfma_f32_16x16x32_bf16 a[88:91], v[68:71], a[152:155], a[88:91]
  s_add_u32 s67, s67, 4096
  v_mfma_f32_16x16x32_bf16 a[92:95], v[68:71], a[156:159], a[92:95]
  buffer_load_dwordx4 a[240:243], v2, s[40:43], s13 offen offset:0 sc1
  v_mfma_f32_16x16x32_bf16 a[96:99], v[72:75], a[144:147], a[96:99]
  v_mfma_f32_16x16x32_bf16 a[100:103], v[72:75], a[148:151], a[100:103]
  ds_read_b128 v[212:215], v11 offset:11264
  v_mfma_f32_16x16x32_bf16 a[104:107], v[72:75], a[152:155], a[104:107]
  v_mfma_f32_16x16x32_bf16 a[108:111], v[72:75], a[156:159], a[108:111]
  v_mfma_f32_16x16x32_bf16 a[112:115], v[76:79], a[144:147], a[112:115]
  v_mfma_f32_16x16x32_bf16 a[116:119], v[76:79], a[148:151], a[116:119]
  ds_read_b128 v[232:235], v11 offset:12288
  v_mfma_f32_16x16x32_bf16 a[120:123], v[76:79], a[152:155], a[120:123]
  v_mfma_f32_16x16x32_bf16 a[124:127], v[76:79], a[156:159], a[124:127]
  v_mfma_f32_16x16x32_bf16 a[128:131], v[80:83], a[144:147], a[128:131]
  buffer_load_dwordx4 a[144:147], v2, s[40:43], s64 offen offset:0 sc1
  v_mfma_f32_16x16x32_bf16 a[132:135], v[80:83], a[148:151], a[132:135]
  buffer_load_dwordx4 a[148:151], v2, s[40:43], s65 offen offset:0 sc1
  v_mfma_f32_16x16x32_bf16 a[136:139], v[80:83], a[152:155], a[136:139]
  buffer_load_dwordx4 a[152:155], v2, s[40:43], s66 offen offset:0 sc1
  v_mfma_f32_16x16x32_bf16 a[140:143], v[80:83], a[156:159], a[140:143]
  buffer_load_dwordx4 a[156:159], v2, s[40:43], s67 offen offset:0 sc1
  s_waitcnt vmcnt(19)
  v_mfma_f32_16x16x32_bf16 a[64:67], v[84:87], a[160:163], a[64:67]
  v_mfma_f32_16x16x32_bf16 a[68:71], v[84:87], a[164:167], a[68:71]
  ds_read_b128 v[236:239], v11 offset:13312
  v_mfma_f32_16x16x32_bf16 a[72:75], v[84:87], a[168:171], a[72:75]
  v_mfma_f32_16x16x32_bf16 a[76:79], v[84:87], a[172:175], a[76:79]
  buffer_load_dwordx4 a[244:247], v2, s[40:43], s13 offen offset:1024 sc1
  v_mfma_f32_16x16x32_bf16 a[80:83], v[88:91], a[160:163], a[80:83]
  v_mfma_f32_16x16x32_bf16 a[84:87], v[88:91], a[164:167], a[84:87]
  ds_read_b128 v[240:243], v11 offset:14336
  v_mfma_f32_16x16x32_bf16 a[88:91], v[88:91], a[168:171], a[88:91]
  v_mfma_f32_16x16x32_bf16 a[92:95], v[88:91], a[172:175], a[92:95]
  buffer_load_dwordx4 a[248:251], v2, s[40:43], s13 offen offset:2048 sc1
  v_mfma_f32_16x16x32_bf16 a[96:99], v[92:95], a[160:163], a[96:99]
  v_mfma_f32_16x16x32_bf16 a[100:103], v[92:95], a[164:167], a[100:103]
  ds_read_b128 v[244:247], v11 offset:15360
  v_mfma_f32_16x16x32_bf16 a[104:107], v[92:95], a[168:171], a[104:107]
  v_mfma_f32_16x16x32_bf16 a[108:111], v[92:95], a[172:175], a[108:111]
  v_mfma_f32_16x16x32_bf16 a[112:115], v[128:131], a[160:163], a[112:115]
  v_mfma_f32_16x16x32_bf16 a[116:119], v[128:131], a[164:167], a[116:119]
  ds_read_b128 v[64:67], v11 offset:16384
  v_mfma_f32_16x16x32_bf16 a[120:123], v[128:131], a[168:171], a[120:123]
  v_mfma_f32_16x16x32_bf16 a[124:127], v[128:131], a[172:175], a[124:127]
  v_mfma_f32_16x16x32_bf16 a[128:131], v[132:135], a[160:163], a[128:131]
  buffer_load_dwordx4 a[160:163], v2, s[40:43], s64 offen offset:1024 sc1
  v_mfma_f32_16x16x32_bf16 a[132:135], v[132:135], a[164:167], a[132:135]
  buffer_load_dwordx4 a[164:167], v2, s[40:43], s65 offen offset:1024 sc1
  v_mfma_f32_16x16x32_bf16 a[136:139], v[132:135], a[168:171], a[136:139]
  buffer_load_dwordx4 a[168:171], v2, s[40:43], s66 offen offset:1024 sc1
  v_mfma_f32_16x16x32_bf16 a[140:143], v[132:135], a[172:175], a[140:143]
  buffer_load_dwordx4 a[172:175], v2, s[40:43], s67 offen offset:1024 sc1
  s_waitcnt vmcnt(18)
  v_mfma_f32_16x16x32_bf16 a[64:67], v[136:139], a[176:179], a[64:67]
  v_mfma_f32_16x16x32_bf16 a[68:71], v[136:139], a[180:183], a[68:71]
  ds_read_b128 v[68:71], v11 offset:17408
  v_mfma_f32_16x16x32_bf16 a[72:75], v[136:139], a[184:187], a[72:75]
  v_mfma_f32_16x16x32_bf16 a[76:79], v[136:139], a[188:191], a[76:79]
  buffer_load_dwordx4 a[252:255], v2, s[40:43], s13 offen offset:3072 sc1
  v_mfma_f32_16x16x32_bf16 a[80:83], v[140:143], a[176:179], a[80:83]
  s_add_u32 s13, s13, 4096
  v_mfma_f32_16x16x32_bf16 a[84:87], v[140:143], a[180:183], a[84:87]
  ds_read_b128 v[72:75], v11 offset:18432
  v_mfma_f32_16x16x32_bf16 a[88:91], v[140:143], a[184:187], a[88:91]
  v_mfma_f32_16x16x32_bf16 a[92:95], v[140:143], a[188:191], a[92:95]
  buffer_load_dwordx4 v[32:35], v2, s[40:43], s13 offen offset:0 sc1
  v_mfma_f32_16x16x32_bf16 a[96:99], v[144:147], a[176:179], a[96:99]
  v_mfma_f32_16x16x32_bf16 a[100:103], v[144:147], a[180:183], a[100:103]
  ds_read_b128 v[76:79], v11 offset:19456
  v_mfma_f32_16x16x32_bf16 a[104:107], v[144:147], a[184:187], a[104:107]
  v_mfma_f32_16x16x32_bf16 a[108:111], v[144:147], a[188:191], a[108:111]
  v_mfma_f32_16x16x32_bf16 a[112:115], v[148:151], a[176:179], a[112:115]
  v_mfma_f32_16x16x32_bf16 a[116:119], v[148:151], a[180:183], a[116:119]
  ds_read_b128 v[80:83], v11 offset:20480
  v_mfma_f32_16x16x32_bf16 a[120:123], v[148:151], a[184:187], a[120:123]
  v_mfma_f32_16x16x32_bf16 a[124:127], v[148:151], a[188:191], a[124:127]
  v_mfma_f32_16x16x32_bf16 a[128:131], v[152:155], a[176:179], a[128:131]
  buffer_load_dwordx4 a[176:179], v2, s[40:43], s64 offen offset:2048 sc1
  v_mfma_f32_16x16x32_bf16 a[132:135], v[152:155], a[180:183], a[132:135]
  buffer_load_dwordx4 a[180:183], v2, s[40:43], s65 offen offset:2048 sc1
  v_mfma_f32_16x16x32_bf16 a[136:139], v[152:155], a[184:187], a[136:139]
  buffer_load_dwordx4 a[184:187], v2, s[40:43], s66 offen offset:2048 sc1
  v_mfma_f32_16x16x32_bf16 a[140:143], v[152:155], a[188:191], a[140:143]
  buffer_load_dwordx4 a[188:191], v2, s[40:43], s67 offen offset:2048 sc1
  s_waitcnt vmcnt(18)
  v_mfma_f32_16x16x32_bf16 a[64:67], v[156:159], v[216:219], a[64:67]
  v_mfma_f32_16x16x32_bf16 a[68:71], v[156:159], v[220:223], a[68:71]
  ds_read_b128 v[84:87], v11 offset:21504
  v_mfma_f32_16x16x32_bf16 a[72:75], v[156:159], v[224:227], a[72:75]
  v_mfma_f32_16x16x32_bf16 a[76:79], v[156:159], v[228:231], a[76:79]
  buffer_load_dwordx4 v[36:39], v2, s[40:43], s13 offen offset:1024 sc1
  v_mfma_f32_16x16x32_bf16 a[80:83], v[176:179], v[216:219], a[80:83]
  v_mfma_f32_16x16x32_bf16 a[84:87], v[176:179], v[220:223], a[84:87]
  ds_read_b128 v[88:91], v11 offset:22528
  v_mfma_f32_16x16x32_bf16 a[88:91], v[176:179], v[224:227], a[88:91]
  v_mfma_f32_16x16x32_bf16 a[92:95], v[176:179], v[228:231], a[92:95]
  buffer_load_dwordx4 v[40:43], v2, s[40:43], s13 offen offset:2048 sc1
  v_mfma_f32_16x16x32_bf16 a[96:99], v[180:183], v[216:219], a[96:99]
  v_mfma_f32_16x16x32_bf16 a[100:103], v[180:183], v[220:223], a[100:103]
  ds_read_b128 v[92:95], v11 offset:23552
  v_mfma_f32_16x16x32_bf16 a[104:107], v[180:183], v[224:227], a[104:107]
  v_mfma_f32_16x16x32_bf16 a[108:111], v[180:183], v[228:231], a[108:111]
  buffer_load_dwordx4 v[44:47], v2, s[40:43], s13 offen offset:3072 sc1
  v_mfma_f32_16x16x32_bf16 a[112:115], v[184:187], v[216:219], a[112:115]
  s_add_u32 s13, s13, 4096
  v_mfma_f32_16x16x32_bf16 a[116:119], v[184:187], v[220:223], a[116:119]
  ds_read_b128 v[128:131], v11 offset:24576
  v_mfma_f32_16x16x32_bf16 a[120:123], v[184:187], v[224:227], a[120:123]
  v_mfma_f32_16x16x32_bf16 a[124:127], v[184:187], v[228:231], a[124:127]
  v_mfma_f32_16x16x32_bf16 a[128:131], v[188:191], v[216:219], a[128:131]
  buffer_load_dwordx4 v[216:219], v2, s[40:43], s64 offen offset:3072 sc1
  v_mfma_f32_16x16x32_bf16 a[132:135], v[188:191], v[220:223], a[132:135]
  buffer_load_dwordx4 v[220:223], v2, s[40:43], s65 offen offset:3072 sc1
  v_mfma_f32_16x16x32_bf16 a[136:139], v[188:191], v[224:227], a[136:139]
  buffer_load_dwordx4 v[224:227], v2, s[40:43], s66 offen offset:3072 sc1
  v_mfma_f32_16x16x32_bf16 a[140:143], v[188:191], v[228:231], a[140:143]
  buffer_load_dwordx4 v[228:231], v2, s[40:43], s67 offen offset:3072 sc1
  s_waitcnt vmcnt(19)
  v_mfma_f32_16x16x32_bf16 a[64:67], a[0:3], a[144:147], a[64:67]
  s_add_u32 s64, s64, 4096
  v_mfma_f32_16x16x32_bf16 a[68:71], a[0:3], a[148:151], a[68:71]
  s_add_u32 s65, s65, 4096
  ds_read_b128 v[132:135], v11 offset:25600
  v_mfma_f32_16x16x32_bf16 a[72:75], a[0:3], a[152:155], a[72:75]
  s_add_u32 s66, s66, 4096
  v_mfma_f32_16x16x32_bf16 a[76:79], a[0:3], a[156:159], a[76:79]
  buffer_load_dwordx4 v[48:51], v2, s[40:43], s13 offen offset:0 sc1
  v_mfma_f32_16x16x32_bf16 a[80:83], a[4:7], a[144:147], a[80:83]
  v_mfma_f32_16x16x32_bf16 a[84:87], a[4:7], a[148:151], a[84:87]
  ds_read_b128 v[136:139], v11 offset:26624
  v_mfma_f32_16x16x32_bf16 a[88:91], a[4:7], a[152:155], a[88:91]
  s_add_u32 s67, s67, 4096
  v_mfma_f32_16x16x32_bf16 a[92:95], a[4:7], a[156:159], a[92:95]
  buffer_load_dwordx4 v[52:55], v2, s[40:43], s13 offen offset:1024 sc1
  v_mfma_f32_16x16x32_bf16 a[96:99], a[8:11], a[144:147], a[96:99]
  v_mfma_f32_16x16x32_bf16 a[100:103], a[8:11], a[148:151], a[100:103]
  ds_read_b128 v[140:143], v11 offset:27648
  v_mfma_f32_16x16x32_bf16 a[104:107], a[8:11], a[152:155], a[104:107]
  v_mfma_f32_16x16x32_bf16 a[108:111], a[8:11], a[156:159], a[108:111]
  v_mfma_f32_16x16x32_bf16 a[112:115], a[12:15], a[144:147], a[112:115]
  v_mfma_f32_16x16x32_bf16 a[116:119], a[12:15], a[148:151], a[116:119]
  ds_read_b128 v[144:147], v11 offset:28672
  v_mfma_f32_16x16x32_bf16 a[120:123], a[12:15], a[152:155], a[120:123]
  v_mfma_f32_16x16x32_bf16 a[124:127], a[12:15], a[156:159], a[124:127]
  v_mfma_f32_16x16x32_bf16 a[128:131], a[16:19], a[144:147], a[128:131]
  buffer_load_dwordx4 a[144:147], v2, s[40:43], s64 offen offset:0 sc1
  v_mfma_f32_16x16x32_bf16 a[132:135], a[16:19], a[148:151], a[132:135]
  buffer_load_dwordx4 a[148:151], v2, s[40:43], s65 offen offset:0 sc1
  v_mfma_f32_16x16x32_bf16 a[136:139], a[16:19], a[152:155], a[136:139]
  buffer_load_dwordx4 a[152:155], v2, s[40:43], s66 offen offset:0 sc1
  v_mfma_f32_16x16x32_bf16 a[140:143], a[16:19], a[156:159], a[140:143]
  buffer_load_dwordx4 a[156:159], v2, s[40:43], s67 offen offset:0 sc1
  s_waitcnt vmcnt(19)
  v_mfma_f32_16x16x32_bf16 a[64:67], a[20:23], a[160:163], a[64:67]
  v_mfma_f32_16x16x32_bf16 a[68:71], a[20:23], a[164:167], a[68:71]
  ds_read_b128 v[148:151], v11 offset:29696
  v_mfma_f32_16x16x32_bf16 a[72:75], a[20:23], a[168:171], a[72:75]
  v_mfma_f32_16x16x32_bf16 a[76:79], a[20:23], a[172:175], a[76:79]
  buffer_load_dwordx4 v[56:59], v2, s[40:43], s13 offen offset:2048 sc1
  v_mfma_f32_16x16x32_bf16 a[80:83], a[24:27], a[160:163], a[80:83]
  v_mfma_f32_16x16x32_bf16 a[84:87], a[24:27], a[164:167], a[84:87]
  ds_read_b128 v[152:155], v11 offset:30720
  v_mfma_f32_16x16x32_bf16 a[88:91], a[24:27], a[168:171], a[88:91]
  v_mfma_f32_16x16x32_bf16 a[92:95], a[24:27], a[172:175], a[92:95]
  buffer_load_dwordx4 v[60:63], v2, s[40:43], s13 offen offset:3072 sc1
  v_mfma_f32_16x16x32_bf16 a[96:99], a[28:31], a[160:163], a[96:99]
  s_add_u32 s13, s13, 4096
  v_mfma_f32_16x16x32_bf16 a[100:103], a[28:31], a[164:167], a[100:103]
  ds_read_b128 v[156:159], v11 offset:31744
  v_mfma_f32_16x16x32_bf16 a[104:107], a[28:31], a[168:171], a[104:107]
  v_mfma_f32_16x16x32_bf16 a[108:111], a[28:31], a[172:175], a[108:111]
  v_mfma_f32_16x16x32_bf16 a[112:115], a[32:35], a[160:163], a[112:115]
  v_mfma_f32_16x16x32_bf16 a[116:119], a[32:35], a[164:167], a[116:119]
  ds_read_b128 v[176:179], v11 offset:32768
  v_mfma_f32_16x16x32_bf16 a[120:123], a[32:35], a[168:171], a[120:123]
  v_mfma_f32_16x16x32_bf16 a[124:127], a[32:35], a[172:175], a[124:127]
  v_mfma_f32_16x16x32_bf16 a[128:131], a[36:39], a[160:163], a[128:131]
  buffer_load_dwordx4 a[160:163], v2, s[40:43], s64 offen offset:1024 sc1
  v_mfma_f32_16x16x32_bf16 a[132:135], a[36:39], a[164:167], a[132:135]
  buffer_load_dwordx4 a[164:167], v2, s[40:43], s65 offen offset:1024 sc1
  v_mfma_f32_16x16x32_bf16 a[136:139], a[36:39], a[168:171], a[136:139]
  buffer_load_dwordx4 a[168:171], v2, s[40:43], s66 offen offset:1024 sc1
  v_mfma_f32_16x16x32_bf16 a[140:143], a[36:39], a[172:175], a[140:143]
  buffer_load_dwordx4 a[172:175], v2, s[40:43], s67 offen offset:1024 sc1
  s_waitcnt vmcnt(19)
  v_mfma_f32_16x16x32_bf16 a[64:67], a[40:43], a[176:179], a[64:67]
  v_mfma_f32_16x16x32_bf16 a[68:71], a[40:43], a[180:183], a[68:71]
  ds_read_b128 v[180:183], v11 offset:33792
  v_mfma_f32_16x16x32_bf16 a[72:75], a[40:43], a[184:187], a[72:75]
  v_mfma_f32_16x16x32_bf16 a[76:79], a[40:43], a[188:191], a[76:79]
  buffer_load_dwordx4 v[96:99], v2, s[40:43], s13 offen offset:0 sc1
  v_mfma_f32_16x16x32_bf16 a[80:83], a[44:47], a[176:179], a[80:83]
  v_mfma_f32_16x16x32_bf16 a[84:87], a[44:47], a[180:183], a[84:87]
  ds_read_b128 v[184:187], v11 offset:34816
  v_mfma_f32_16x16x32_bf16 a[88:91], a[44:47], a[184:187], a[88:91]
  v_mfma_f32_16x16x32_bf16 a[92:95], a[44:47], a[188:191], a[92:95]
  buffer_load_dwordx4 v[100:103], v2, s[40:43], s13 offen offset:1024 sc1
  v_mfma_f32_16x16x32_bf16 a[96:99], a[48:51], a[176:179], a[96:99]
  v_mfma_f32_16x16x32_bf16 a[100:103], a[48:51], a[180:183], a[100:103]
  ds_read_b128 v[188:191], v11 offset:35840
  v_mfma_f32_16x16x32_bf16 a[104:107], a[48:51], a[184:187], a[104:107]
  v_mfma_f32_16x16x32_bf16 a[108:111], a[48:51], a[188:191], a[108:111]
  v_mfma_f32_16x16x32_bf16 a[112:115], a[52:55], a[176:179], a[112:115]
  v_mfma_f32_16x16x32_bf16 a[116:119], a[52:55], a[180:183], a[116:119]
  v_mfma_f32_16x16x32_bf16 a[120:123], a[52:55], a[184:187], a[120:123]
  v_mfma_f32_16x16x32_bf16 a[124:127], a[52:55], a[188:191], a[124:127]
  v_mfma_f32_16x16x32_bf16 a[128:131], a[56:59], a[176:179], a[128:131]
  buffer_load_dwordx4 a[176:179], v2, s[40:43], s64 offen offset:2048 sc1
  v_mfma_f32_16x16x32_bf16 a[132:135], a[56:59], a[180:183], a[132:135]
  buffer_load_dwordx4 a[180:183], v2, s[40:43], s65 offen offset:2048 sc1
  v_mfma_f32_16x16x32_bf16 a[136:139], a[56:59], a[184:187], a[136:139]
  buffer_load_dwordx4 a[184:187], v2, s[40:43], s66 offen offset:2048 sc1
  v_mfma_f32_16x16x32_bf16 a[140:143], a[56:59], a[188:191], a[140:143]
  buffer_load_dwordx4 a[188:191], v2, s[40:43], s67 offen offset:2048 sc1
  s_waitcnt vmcnt(18)
  v_mfma_f32_16x16x32_bf16 a[64:67], a[60:63], v[216:219], a[64:67]
  v_mfma_f32_16x16x32_bf16 a[68:71], a[60:63], v[220:223], a[68:71]
  v_mfma_f32_16x16x32_bf16 a[72:75], a[60:63], v[224:227], a[72:75]
  v_mfma_f32_16x16x32_bf16 a[76:79], a[60:63], v[228:231], a[76:79]
  buffer_load_dwordx4 v[104:107], v2, s[40:43], s13 offen offset:2048 sc1
  v_mfma_f32_16x16x32_bf16 a[80:83], a[192:195], v[216:219], a[80:83]
  v_mfma_f32_16x16x32_bf16 a[84:87], a[192:195], v[220:223], a[84:87]
  v_mfma_f32_16x16x32_bf16 a[88:91], a[192:195], v[224:227], a[88:91]
  v_mfma_f32_16x16x32_bf16 a[92:95], a[192:195], v[228:231], a[92:95]
  buffer_load_dwordx4 v[108:111], v2, s[40:43], s13 offen offset:3072 sc1
  v_mfma_f32_16x16x32_bf16 a[96:99], a[196:199], v[216:219], a[96:99]
  s_add_u32 s13, s13, 4096
  v_mfma_f32_16x16x32_bf16 a[100:103], a[196:199], v[220:223], a[100:103]
  v_mfma_f32_16x16x32_bf16 a[104:107], a[196:199], v[224:227], a[104:107]
  v_mfma_f32_16x16x32_bf16 a[108:111], a[196:199], v[228:231], a[108:111]
  v_mfma_f32_16x16x32_bf16 a[112:115], a[200:203], v[216:219], a[112:115]
  v_mfma_f32_16x16x32_bf16 a[116:119], a[200:203], v[220:223], a[116:119]
  v_mfma_f32_16x16x32_bf16 a[120:123], a[200:203], v[224:227], a[120:123]
  v_mfma_f32_16x16x32_bf16 a[124:127], a[200:203], v[228:231], a[124:127]
  v_mfma_f32_16x16x32_bf16 a[128:131], a[204:207], v[216:219], a[128:131]
  buffer_load_dwordx4 v[216:219], v2, s[40:43], s64 offen offset:3072 sc1
  v_mfma_f32_16x16x32_bf16 a[132:135], a[204:207], v[220:223], a[132:135]
  buffer_load_dwordx4 v[220:223], v2, s[40:43], s65 offen offset:3072 sc1
  v_mfma_f32_16x16x32_bf16 a[136:139], a[204:207], v[224:227], a[136:139]
  buffer_load_dwordx4 v[224:227], v2, s[40:43], s66 offen offset:3072 sc1
  v_mfma_f32_16x16x32_bf16 a[140:143], a[204:207], v[228:231], a[140:143]
  buffer_load_dwordx4 v[228:231], v2, s[40:43], s67 offen offset:3072 sc1
  s_waitcnt vmcnt(18)
  v_mfma_f32_16x16x32_bf16 a[64:67], a[208:211], a[144:147], a[64:67]
  s_add_u32 s64, s64, 4096
  v_mfma_f32_16x16x32_bf16 a[68:71], a[208:211], a[148:151], a[68:71]
  s_add_u32 s65, s65, 4096
  v_mfma_f32_16x16x32_bf16 a[72:75], a[208:211], a[152:155], a[72:75]
  s_add_u32 s66, s66, 4096
  v_mfma_f32_16x16x32_bf16 a[76:79], a[208:211], a[156:159], a[76:79]
  v_mfma_f32_16x16x32_bf16 a[80:83], a[212:215], a[144:147], a[80:83]
  v_mfma_f32_16x16x32_bf16 a[84:87], a[212:215], a[148:151], a[84:87]
  v_mfma_f32_16x16x32_bf16 a[88:91], a[212:215], a[152:155], a[88:91]
  s_add_u32 s67, s67, 4096
  v_mfma_f32_16x16x32_bf16 a[92:95], a[212:215], a[156:159], a[92:95]
  v_mfma_f32_16x16x32_bf16 a[96:99], a[216:219], a[144:147], a[96:99]
  v_mfma_f32_16x16x32_bf16 a[100:103], a[216:219], a[148:151], a[100:103]
  v_mfma_f32_16x16x32_bf16 a[104:107], a[216:219], a[152:155], a[104:107]
  v_mfma_f32_16x16x32_bf16 a[108:111], a[216:219], a[156:159], a[108:111]
  v_mfma_f32_16x16x32_bf16 a[112:115], a[220:223], a[144:147], a[112:115]
  v_mfma_f32_16x16x32_bf16 a[116:119], a[220:223], a[148:151], a[116:119]
  v_mfma_f32_16x16x32_bf16 a[120:123], a[220:223], a[152:155], a[120:123]
  v_mfma_f32_16x16x32_bf16 a[124:127], a[220:223], a[156:159], a[124:127]
  v_mfma_f32_16x16x32_bf16 a[128:131], a[224:227], a[144:147], a[128:131]
  buffer_load_dwordx4 a[144:147], v2, s[40:43], s64 offen offset:0 sc1
  v_mfma_f32_16x16x32_bf16 a[132:135], a[224:227], a[148:151], a[132:135]
  buffer_load_dwordx4 a[148:151], v2, s[40:43], s65 offen offset:0 sc1
  v_mfma_f32_16x16x32_bf16 a[136:139], a[224:227], a[152:155], a[136:139]
  buffer_load_dwordx4 a[152:155], v2, s[40:43], s66 offen offset:0 sc1
  v_mfma_f32_16x16x32_bf16 a[140:143], a[224:227], a[156:159], a[140:143]
  buffer_load_dwordx4 a[156:159], v2, s[40:43], s67 offen offset:0 sc1
  s_waitcnt vmcnt(16)
  v_mfma_f32_16x16x32_bf16 a[64:67], a[228:231], a[160:163], a[64:67]
  v_mfma_f32_16x16x32_bf16 a[68:71], a[228:231], a[164:167], a[68:71]
  v_mfma_f32_16x16x32_bf16 a[72:75], a[228:231], a[168:171], a[72:75]
  v_mfma_f32_16x16x32_bf16 a[76:79], a[228:231], a[172:175], a[76:79]
  v_mfma_f32_16x16x32_bf16 a[80:83], a[232:235], a[160:163], a[80:83]
  v_mfma_f32_16x16x32_bf16 a[84:87], a[232:235], a[164:167], a[84:87]
  v_mfma_f32_16x16x32_bf16 a[88:91], a[232:235], a[168:171], a[88:91]
  v_mfma_f32_16x16x32_bf16 a[92:95], a[232:235], a[172:175], a[92:95]
  v_mfma_f32_16x16x32_bf16 a[96:99], a[236:239], a[160:163], a[96:99]
  v_mfma_f32_16x16x32_bf16 a[100:103], a[236:239], a[164:167], a[100:103]
  v_mfma_f32_16x16x32_bf16 a[104:107], a[236:239], a[168:171], a[104:107]
  v_mfma_f32_16x16x32_bf16 a[108:111], a[236:239], a[172:175], a[108:111]
  v_mfma_f32_16x16x32_bf16 a[112:115], a[240:243], a[160:163], a[112:115]
  v_mfma_f32_16x16x32_bf16 a[116:119], a[240:243], a[164:167], a[116:119]
  v_mfma_f32_16x16x32_bf16 a[120:123], a[240:243], a[168:171], a[120:123]
  v_mfma_f32_16x16x32_bf16 a[124:127], a[240:243], a[172:175], a[124:127]
  v_mfma_f32_16x16x32_bf16 a[128:131], a[244:247], a[160:163], a[128:131]
  buffer_load_dwordx4 a[160:163], v2, s[40:43], s64 offen offset:1024 sc1
  v_mfma_f32_16x16x32_bf16 a[132:135], a[244:247], a[164:167], a[132:135]
  buffer_load_dwordx4 a[164:167], v2, s[40:43], s65 offen offset:1024 sc1
  v_mfma_f32_16x16x32_bf16 a[136:139], a[244:247], a[168:171], a[136:139]
  buffer_load_dwordx4 a[168:171], v2, s[40:43], s66 offen offset:1024 sc1
  v_mfma_f32_16x16x32_bf16 a[140:143], a[244:247], a[172:175], a[140:143]
  buffer_load_dwordx4 a[172:175], v2, s[40:43], s67 offen offset:1024 sc1
  s_waitcnt vmcnt(14)
  v_mfma_f32_16x16x32_bf16 a[64:67], a[248:251], a[176:179], a[64:67]
  v_mfma_f32_16x16x32_bf16 a[68:71], a[248:251], a[180:183], a[68:71]
  v_mfma_f32_16x16x32_bf16 a[72:75], a[248:251], a[184:187], a[72:75]
  v_mfma_f32_16x16x32_bf16 a[76:79], a[248:251], a[188:191], a[76:79]
  v_mfma_f32_16x16x32_bf16 a[80:83], a[252:255], a[176:179], a[80:83]
  v_mfma_f32_16x16x32_bf16 a[84:87], a[252:255], a[180:183], a[84:87]
  v_mfma_f32_16x16x32_bf16 a[88:91], a[252:255], a[184:187], a[88:91]
  v_mfma_f32_16x16x32_bf16 a[92:95], a[252:255], a[188:191], a[92:95]
  v_mfma_f32_16x16x32_bf16 a[96:99], v[32:35], a[176:179], a[96:99]
  v_mfma_f32_16x16x32_bf16 a[100:103], v[32:35], a[180:183], a[100:103]
  v_mfma_f32_16x16x32_bf16 a[104:107], v[32:35], a[184:187], a[104:107]
  v_mfma_f32_16x16x32_bf16 a[108:111], v[32:35], a[188:191], a[108:111]
  v_mfma_f32_16x16x32_bf16 a[112:115], v[36:39], a[176:179], a[112:115]
  v_mfma_f32_16x16x32_bf16 a[116:119], v[36:39], a[180:183], a[116:119]
  v_mfma_f32_16x16x32_bf16 a[120:123], v[36:39], a[184:187], a[120:123]
  v_mfma_f32_16x16x32_bf16 a[124:127], v[36:39], a[188:191], a[124:127]
  v_mfma_f32_16x16x32_bf16 a[128:131], v[40:43], a[176:179], a[128:131]
  buffer_load_dwordx4 a[176:179], v2, s[40:43], s64 offen offset:2048 sc1
  v_mfma_f32_16x16x32_bf16 a[132:135], v[40:43], a[180:183], a[132:135]
  buffer_load_dwordx4 a[180:183], v2, s[40:43], s65 offen offset:2048 sc1
  v_mfma_f32_16x16x32_bf16 a[136:139], v[40:43], a[184:187], a[136:139]
  buffer_load_dwordx4 a[184:187], v2, s[40:43], s66 offen offset:2048 sc1
  v_mfma_f32_16x16x32_bf16 a[140:143], v[40:43], a[188:191], a[140:143]
  buffer_load_dwordx4 a[188:191], v2, s[40:43], s67 offen offset:2048 sc1
  s_waitcnt vmcnt(12)
  v_mfma_f32_16x16x32_bf16 a[64:67], v[44:47], v[216:219], a[64:67]
  v_mfma_f32_16x16x32_bf16 a[68:71], v[44:47], v[220:223], a[68:71]
  v_mfma_f32_16x16x32_bf16 a[72:75], v[44:47], v[224:227], a[72:75]
  v_mfma_f32_16x16x32_bf16 a[76:79], v[44:47], v[228:231], a[76:79]
  v_mfma_f32_16x16x32_bf16 a[80:83], v[48:51], v[216:219], a[80:83]
  v_mfma_f32_16x16x32_bf16 a[84:87], v[48:51], v[220:223], a[84:87]
  v_mfma_f32_16x16x32_bf16 a[88:91], v[48:51], v[224:227], a[88:91]
  v_mfma_f32_16x16x32_bf16 a[92:95], v[48:51], v[228:231], a[92:95]
  v_mfma_f32_16x16x32_bf16 a[96:99], v[52:55], v[216:219], a[96:99]
  v_mfma_f32_16x16x32_bf16 a[100:103], v[52:55], v[220:223], a[100:103]
  v_mfma_f32_16x16x32_bf16 a[104:107], v[52:55], v[224:227], a[104:107]
  v_mfma_f32_16x16x32_bf16 a[108:111], v[52:55], v[228:231], a[108:111]
  v_mfma_f32_16x16x32_bf16 a[112:115], v[56:59], v[216:219], a[112:115]
  v_mfma_f32_16x16x32_bf16 a[116:119], v[56:59], v[220:223], a[116:119]
  v_mfma_f32_16x16x32_bf16 a[120:123], v[56:59], v[224:227], a[120:123]
  v_mfma_f32_16x16x32_bf16 a[124:127], v[56:59], v[228:231], a[124:127]
  v_mfma_f32_16x16x32_bf16 a[128:131], v[60:63], v[216:219], a[128:131]
  buffer_load_dwordx4 v[216:219], v2, s[40:43], s64 offen offset:3072 sc1
  v_mfma_f32_16x16x32_bf16 a[132:135], v[60:63], v[220:223], a[132:135]
  buffer_load_dwordx4 v[220:223], v2, s[40:43], s65 offen offset:3072 sc1
  v_mfma_f32_16x16x32_bf16 a[136:139], v[60:63], v[224:227], a[136:139]
  buffer_load_dwordx4 v[224:227], v2, s[40:43], s66 offen offset:3072 sc1
  v_mfma_f32_16x16x32_bf16 a[140:143], v[60:63], v[228:231], a[140:143]
  buffer_load_dwordx4 v[228:231], v2, s[40:43], s67 offen offset:3072 sc1
  s_waitcnt vmcnt(12) lgkmcnt(0)
  v_mfma_f32_16x16x32_bf16 a[64:67], v[96:99], a[144:147], a[64:67]
  s_add_u32 s64, s64, 4096
  v_mfma_f32_16x16x32_bf16 a[68:71], v[96:99], a[148:151], a[68:71]
  s_add_u32 s65, s65, 4096
  v_mfma_f32_16x16x32_bf16 a[72:75], v[96:99], a[152:155], a[72:75]
  s_add_u32 s66, s66, 4096
  v_mfma_f32_16x16x32_bf16 a[76:79], v[96:99], a[156:159], a[76:79]
  buffer_load_dwordx4 v[32:35], v248, s[44:47], 0 offen
  v_mfma_f32_16x16x32_bf16 a[80:83], v[100:103], a[144:147], a[80:83]
  v_mfma_f32_16x16x32_bf16 a[84:87], v[100:103], a[148:151], a[84:87]
  buffer_load_dwordx4 v[44:47], v200, s[40:43], s27 offen sc1
  v_mfma_f32_16x16x32_bf16 a[88:91], v[100:103], a[152:155], a[88:91]
  s_add_u32 s67, s67, 4096
  v_mfma_f32_16x16x32_bf16 a[92:95], v[100:103], a[156:159], a[92:95]
  buffer_load_dwordx4 v[36:39], v249, s[44:47], 0 offen
  v_mfma_f32_16x16x32_bf16 a[96:99], v[104:107], a[144:147], a[96:99]
  v_mfma_f32_16x16x32_bf16 a[100:103], v[104:107], a[148:151], a[100:103]
  buffer_load_dwordx4 v[48:51], v201, s[40:43], s27 offen sc1
  v_mfma_f32_16x16x32_bf16 a[104:107], v[104:107], a[152:155], a[104:107]
  v_mfma_f32_16x16x32_bf16 a[108:111], v[104:107], a[156:159], a[108:111]
  buffer_load_dwordx4 v[40:43], v250, s[44:47], 0 offen
  v_mfma_f32_16x16x32_bf16 a[112:115], v[108:111], a[144:147], a[112:115]
  v_mfma_f32_16x16x32_bf16 a[116:119], v[108:111], a[148:151], a[116:119]
  buffer_load_dwordx4 v[52:55], v202, s[40:43], s27 offen sc1
  v_mfma_f32_16x16x32_bf16 a[120:123], v[108:111], a[152:155], a[120:123]
  v_mfma_f32_16x16x32_bf16 a[124:127], v[108:111], a[156:159], a[124:127]
  v_mfma_f32_16x16x32_bf16 a[128:131], v[112:115], a[144:147], a[128:131]
  buffer_load_dwordx4 a[144:147], v2, s[40:43], s64 offen offset:0 sc1
  v_mfma_f32_16x16x32_bf16 a[132:135], v[112:115], a[148:151], a[132:135]
  buffer_load_dwordx4 a[148:151], v2, s[40:43], s65 offen offset:0 sc1
  v_mfma_f32_16x16x32_bf16 a[136:139], v[112:115], a[152:155], a[136:139]
  buffer_load_dwordx4 a[152:155], v2, s[40:43], s66 offen offset:0 sc1
  v_mfma_f32_16x16x32_bf16 a[140:143], v[112:115], a[156:159], a[140:143]
  buffer_load_dwordx4 a[156:159], v2, s[40:43], s67 offen offset:0 sc1
  s_waitcnt vmcnt(18)
  v_mfma_f32_16x16x32_bf16 a[64:67], v[116:119], a[160:163], a[64:67]
  v_mfma_f32_16x16x32_bf16 a[68:71], v[116:119], a[164:167], a[68:71]
  v_mfma_f32_16x16x32_bf16 a[72:75], v[116:119], a[168:171], a[72:75]
  v_mfma_f32_16x16x32_bf16 a[76:79], v[116:119], a[172:175], a[76:79]
  v_mfma_f32_16x16x32_bf16 a[80:83], v[120:123], a[160:163], a[80:83]
  v_mfma_f32_16x16x32_bf16 a[84:87], v[120:123], a[164:167], a[84:87]
  v_mfma_f32_16x16x32_bf16 a[88:91], v[120:123], a[168:171], a[88:91]
  v_mfma_f32_16x16x32_bf16 a[92:95], v[120:123], a[172:175], a[92:95]
  v_mfma_f32_16x16x32_bf16 a[96:99], v[124:127], a[160:163], a[96:99]
  v_mfma_f32_16x16x32_bf16 a[100:103], v[124:127], a[164:167], a[100:103]
  v_mfma_f32_16x16x32_bf16 a[104:107], v[124:127], a[168:171], a[104:107]
  v_mfma_f32_16x16x32_bf16 a[108:111], v[124:127], a[172:175], a[108:111]
  v_mfma_f32_16x16x32_bf16 a[112:115], v[160:163], a[160:163], a[112:115]
  v_mfma_f32_16x16x32_bf16 a[116:119], v[160:163], a[164:167], a[116:119]
  v_mfma_f32_16x16x32_bf16 a[120:123], v[160:163], a[168:171], a[120:123]
  v_mfma_f32_16x16x32_bf16 a[124:127], v[160:163], a[172:175], a[124:127]
  v_mfma_f32_16x16x32_bf16 a[128:131], v[164:167], a[160:163], a[128:131]
  buffer_load_dwordx4 a[160:163], v2, s[40:43], s64 offen offset:1024 sc1
  v_mfma_f32_16x16x32_bf16 a[132:135], v[164:167], a[164:167], a[132:135]
  buffer_load_dwordx4 a[164:167], v2, s[40:43], s65 offen offset:1024 sc1
  v_mfma_f32_16x16x32_bf16 a[136:139], v[164:167], a[168:171], a[136:139]
  buffer_load_dwordx4 a[168:171], v2, s[40:43], s66 offen offset:1024 sc1
  v_mfma_f32_16x16x32_bf16 a[140:143], v[164:167], a[172:175], a[140:143]
  buffer_load_dwordx4 a[172:175], v2, s[40:43], s67 offen offset:1024 sc1
  s_waitcnt vmcnt(18)
  v_mfma_f32_16x16x32_bf16 a[64:67], v[168:171], a[176:179], a[64:67]
  v_mfma_f32_16x16x32_bf16 a[68:71], v[168:171], a[180:183], a[68:71]
  v_mfma_f32_16x16x32_bf16 a[72:75], v[168:171], a[184:187], a[72:75]
  v_mfma_f32_16x16x32_bf16 a[76:79], v[168:171], a[188:191], a[76:79]
  v_mfma_f32_16x16x32_bf16 a[80:83], v[172:175], a[176:179], a[80:83]
  v_mfma_f32_16x16x32_bf16 a[84:87], v[172:175], a[180:183], a[84:87]
  v_mfma_f32_16x16x32_bf16 a[88:91], v[172:175], a[184:187], a[88:91]
  v_mfma_f32_16x16x32_bf16 a[92:95], v[172:175], a[188:191], a[92:95]
  v_mfma_f32_16x16x32_bf16 a[96:99], v[192:195], a[176:179], a[96:99]
  v_mfma_f32_16x16x32_bf16 a[100:103], v[192:195], a[180:183], a[100:103]
  v_mfma_f32_16x16x32_bf16 a[104:107], v[192:195], a[184:187], a[104:107]
  v_mfma_f32_16x16x32_bf16 a[108:111], v[192:195], a[188:191], a[108:111]
  v_mfma_f32_16x16x32_bf16 a[112:115], v[196:199], a[176:179], a[112:115]
  v_mfma_f32_16x16x32_bf16 a[116:119], v[196:199], a[180:183], a[116:119]
  v_mfma_f32_16x16x32_bf16 a[120:123], v[196:199], a[184:187], a[120:123]
  v_mfma_f32_16x16x32_bf16 a[124:127], v[196:199], a[188:191], a[124:127]
  v_mfma_f32_16x16x32_bf16 a[128:131], v[208:211], a[176:179], a[128:131]
  buffer_load_dwordx4 a[176:179], v2, s[40:43], s64 offen offset:2048 sc1
  v_mfma_f32_16x16x32_bf16 a[132:135], v[208:211], a[180:183], a[132:135]
  buffer_load_dwordx4 a[180:183], v2, s[40:43], s65 offen offset:2048 sc1
  v_mfma_f32_16x16x32_bf16 a[136:139], v[208:211], a[184:187], a[136:139]
  buffer_load_dwordx4 a[184:187], v2, s[40:43], s66 offen offset:2048 sc1
  v_mfma_f32_16x16x32_bf16 a[140:143], v[208:211], a[188:191], a[140:143]
  buffer_load_dwordx4 a[188:191], v2, s[40:43], s67 offen offset:2048 sc1
  s_waitcnt vmcnt(18)
  v_mfma_f32_16x16x32_bf16 a[64:67], v[212:215], v[216:219], a[64:67]
  v_mfma_f32_16x16x32_bf16 a[68:71], v[212:215], v[220:223], a[68:71]
  ds_read_b128 v[120:123], v203 offset:0
  v_mfma_f32_16x16x32_bf16 a[72:75], v[212:215], v[224:227], a[72:75]
  v_add_u32 v20, 77824, v251
  v_mfma_f32_16x16x32_bf16 a[76:79], v[212:215], v[228:231], a[76:79]
  ds_read_b128 v[124:127], v203 offset:16
  v_mfma_f32_16x16x32_bf16 a[80:83], v[232:235], v[216:219], a[80:83]
  v_mfma_f32_16x16x32_bf16 a[84:87], v[232:235], v[220:223], a[84:87]
  ds_read_b128 v[160:163], v204 offset:0
  v_mfma_f32_16x16x32_bf16 a[88:91], v[232:235], v[224:227], a[88:91]
  v_add_u32 v21, 77824, v252
  v_mfma_f32_16x16x32_bf16 a[92:95], v[232:235], v[228:231], a[92:95]
  ds_read_b128 v[164:167], v204 offset:16
  v_mfma_f32_16x16x32_bf16 a[96:99], v[236:239], v[216:219], a[96:99]
  v_mfma_f32_16x16x32_bf16 a[100:103], v[236:239], v[220:223], a[100:103]
  ds_read_b128 v[168:171], v205 offset:0
  v_mfma_f32_16x16x32_bf16 a[104:107], v[236:239], v[224:227], a[104:107]
  v_add_u32 v22, 77824, v253
  v_mfma_f32_16x16x32_bf16 a[108:111], v[236:239], v[228:231], a[108:111]
  ds_read_b128 v[172:175], v205 offset:16
  v_mfma_f32_16x16x32_bf16 a[112:115], v[240:243], v[216:219], a[112:115]
  v_mfma_f32_16x16x32_bf16 a[116:119], v[240:243], v[220:223], a[116:119]
  v_mfma_f32_16x16x32_bf16 a[120:123], v[240:243], v[224:227], a[120:123]
  s_mul_i32 s23, s20, 38912
  v_and_b32 v16, 15, v1
  v_mul_u32_u24 v16, 336, v16
  v_mfma_f32_16x16x32_bf16 a[124:127], v[240:243], v[228:231], a[124:127]
  v_lshrrev_b32 v17, 4, v1
  v_lshl_add_u32 v16, v17, 4, v16
  v_mfma_f32_16x16x32_bf16 a[128:131], v[244:247], v[216:219], a[128:131]
  buffer_load_dwordx4 v[216:219], v2, s[40:43], s64 offen offset:3072 sc1
  v_add_u32 v16, s23, v16
  v_mfma_f32_16x16x32_bf16 a[132:135], v[244:247], v[220:223], a[132:135]
  buffer_load_dwordx4 v[220:223], v2, s[40:43], s65 offen offset:3072 sc1
  v_mfma_f32_16x16x32_bf16 a[136:139], v[244:247], v[224:227], a[136:139]
  s_waitcnt lgkmcnt(0)
  buffer_load_dwordx4 v[224:227], v2, s[40:43], s66 offen offset:3072 sc1
  v_mfma_f32_16x16x32_bf16 a[140:143], v[244:247], v[228:231], a[140:143]
  buffer_load_dwordx4 v[228:231], v2, s[40:43], s67 offen offset:3072 sc1
  s_waitcnt vmcnt(12)
  v_mfma_f32_16x16x32_bf16 a[64:67], v[64:67], a[144:147], a[64:67]
  v_lshlrev_b32 v18, 16, v44
  v_and_b32 v19, 0xffff0000, v44
  v_mfma_f32_16x16x32_bf16 a[68:71], v[64:67], a[148:151], a[68:71]
  v_add_f32 v120, v120, v18
  v_add_f32 v121, v121, v19
  v_mfma_f32_16x16x32_bf16 a[72:75], v[64:67], a[152:155], a[72:75]
  v_cvt_pk_bf16_f32 v18, v120, v121
  v_lshlrev_b32 v96, 16, v32
  v_mfma_f32_16x16x32_bf16 a[76:79], v[64:67], a[156:159], a[76:79]
  v_and_b32 v97, 0xffff0000, v32
  v_lshlrev_b32 v120, 16, v18
  v_mfma_f32_16x16x32_bf16 a[80:83], v[68:71], a[144:147], a[80:83]
  v_and_b32 v121, 0xffff0000, v18
  v_lshlrev_b32 v18, 16, v45
  v_mfma_f32_16x16x32_bf16 a[84:87], v[68:71], a[148:151], a[84:87]
  v_and_b32 v19, 0xffff0000, v45
  v_add_f32 v122, v122, v18
  v_mfma_f32_16x16x32_bf16 a[88:91], v[68:71], a[152:155], a[88:91]
  v_add_f32 v123, v123, v19
  v_cvt_pk_bf16_f32 v18, v122, v123
  v_mfma_f32_16x16x32_bf16 a[92:95], v[68:71], a[156:159], a[92:95]
  v_lshlrev_b32 v98, 16, v33
  v_and_b32 v99, 0xffff0000, v33
  v_mfma_f32_16x16x32_bf16 a[96:99], v[72:75], a[144:147], a[96:99]
  v_lshlrev_b32 v122, 16, v18
  v_and_b32 v123, 0xffff0000, v18
  v_mfma_f32_16x16x32_bf16 a[100:103], v[72:75], a[148:151], a[100:103]
  v_lshlrev_b32 v18, 16, v46
  v_and_b32 v19, 0xffff0000, v46
  v_mfma_f32_16x16x32_bf16 a[104:107], v[72:75], a[152:155], a[104:107]
  v_add_f32 v124, v124, v18
  v_add_f32 v125, v125, v19
  v_mfma_f32_16x16x32_bf16 a[108:111], v[72:75], a[156:159], a[108:111]
  v_cvt_pk_bf16_f32 v18, v124, v125
  v_lshlrev_b32 v100, 16, v34
  v_mfma_f32_16x16x32_bf16 a[112:115], v[76:79], a[144:147], a[112:115]
  v_and_b32 v101, 0xffff0000, v34
  v_lshlrev_b32 v124, 16, v18
  v_mfma_f32_16x16x32_bf16 a[116:119], v[76:79], a[148:151], a[116:119]
  v_and_b32 v125, 0xffff0000, v18
  v_lshlrev_b32 v18, 16, v47
  v_mfma_f32_16x16x32_bf16 a[120:123], v[76:79], a[152:155], a[120:123]
  v_and_b32 v19, 0xffff0000, v47
  v_add_f32 v126, v126, v18
  v_mfma_f32_16x16x32_bf16 a[124:127], v[76:79], a[156:159], a[124:127]
  v_add_f32 v127, v127, v19
  v_cvt_pk_bf16_f32 v18, v126, v127
  v_mfma_f32_16x16x32_bf16 a[128:131], v[80:83], a[144:147], a[128:131]
  v_lshlrev_b32 v102, 16, v35
  v_and_b32 v103, 0xffff0000, v35
  v_mfma_f32_16x16x32_bf16 a[132:135], v[80:83], a[148:151], a[132:135]
  v_lshlrev_b32 v126, 16, v18
  v_and_b32 v127, 0xffff0000, v18
  v_mfma_f32_16x16x32_bf16 a[136:139], v[80:83], a[152:155], a[136:139]
  v_mfma_f32_16x16x32_bf16 a[140:143], v[80:83], a[156:159], a[140:143]
  s_waitcnt vmcnt(8)
  v_mfma_f32_16x16x32_bf16 a[64:67], v[84:87], a[160:163], a[64:67]
  v_lshlrev_b32 v18, 16, v48
  v_and_b32 v19, 0xffff0000, v48
  v_mfma_f32_16x16x32_bf16 a[68:71], v[84:87], a[164:167], a[68:71]
  v_add_f32 v160, v160, v18
  v_add_f32 v161, v161, v19
  v_mfma_f32_16x16x32_bf16 a[72:75], v[84:87], a[168:171], a[72:75]
  v_cvt_pk_bf16_f32 v18, v160, v161
  v_lshlrev_b32 v104, 16, v36
  v_mfma_f32_16x16x32_bf16 a[76:79], v[84:87], a[172:175], a[76:79]
  v_and_b32 v105, 0xffff0000, v36
  v_lshlrev_b32 v160, 16, v18
  v_mfma_f32_16x16x32_bf16 a[80:83], v[88:91], a[160:163], a[80:83]
  v_and_b32 v161, 0xffff0000, v18
  v_lshlrev_b32 v18, 16, v49
  v_mfma_f32_16x16x32_bf16 a[84:87], v[88:91], a[164:167], a[84:87]
  v_and_b32 v19, 0xffff0000, v49
  v_add_f32 v162, v162, v18
  v_mfma_f32_16x16x32_bf16 a[88:91], v[88:91], a[168:171], a[88:91]
  v_add_f32 v163, v163, v19
  v_cvt_pk_bf16_f32 v18, v162, v163
  v_mfma_f32_16x16x32_bf16 a[92:95], v[88:91], a[172:175], a[92:95]
  v_lshlrev_b32 v106, 16, v37
  v_and_b32 v107, 0xffff0000, v37
  v_mfma_f32_16x16x32_bf16 a[96:99], v[92:95], a[160:163], a[96:99]
  v_lshlrev_b32 v162, 16, v18
  v_and_b32 v163, 0xffff0000, v18
  v_mfma_f32_16x16x32_bf16 a[100:103], v[92:95], a[164:167], a[100:103]
  v_lshlrev_b32 v18, 16, v50
  v_and_b32 v19, 0xffff0000, v50
  v_mfma_f32_16x16x32_bf16 a[104:107], v[92:95], a[168:171], a[104:107]
  v_add_f32 v164, v164, v18
  v_add_f32 v165, v165, v19
  v_mfma_f32_16x16x32_bf16 a[108:111], v[92:95], a[172:175], a[108:111]
  v_cvt_pk_bf16_f32 v18, v164, v165
  v_lshlrev_b32 v108, 16, v38
  v_mfma_f32_16x16x32_bf16 a[112:115], v[128:131], a[160:163], a[112:115]
  v_and_b32 v109, 0xffff0000, v38
  v_lshlrev_b32 v164, 16, v18
  v_mfma_f32_16x16x32_bf16 a[116:119], v[128:131], a[164:167], a[116:119]
  v_and_b32 v165, 0xffff0000, v18
  v_lshlrev_b32 v18, 16, v51
  v_mfma_f32_16x16x32_bf16 a[120:123], v[128:131], a[168:171], a[120:123]
  v_and_b32 v19, 0xffff0000, v51
  v_add_f32 v166, v166, v18
  v_mfma_f32_16x16x32_bf16 a[124:127], v[128:131], a[172:175], a[124:127]
  v_add_f32 v167, v167, v19
  v_cvt_pk_bf16_f32 v18, v166, v167
  v_mfma_f32_16x16x32_bf16 a[128:131], v[132:135], a[160:163], a[128:131]
  v_lshlrev_b32 v110, 16, v39
  v_and_b32 v111, 0xffff0000, v39
  v_mfma_f32_16x16x32_bf16 a[132:135], v[132:135], a[164:167], a[132:135]
  v_lshlrev_b32 v166, 16, v18
  v_and_b32 v167, 0xffff0000, v18
  v_mfma_f32_16x16x32_bf16 a[136:139], v[132:135], a[168:171], a[136:139]
  v_mfma_f32_16x16x32_bf16 a[140:143], v[132:135], a[172:175], a[140:143]
  s_waitcnt vmcnt(4)
  v_mfma_f32_16x16x32_bf16 a[64:67], v[136:139], a[176:179], a[64:67]
  v_lshlrev_b32 v18, 16, v52
  v_and_b32 v19, 0xffff0000, v52
  v_mfma_f32_16x16x32_bf16 a[68:71], v[136:139], a[180:183], a[68:71]
  v_add_f32 v168, v168, v18
  v_add_f32 v169, v169, v19
  v_mfma_f32_16x16x32_bf16 a[72:75], v[136:139], a[184:187], a[72:75]
  v_cvt_pk_bf16_f32 v18, v168, v169
  v_lshlrev_b32 v112, 16, v40
  v_mfma_f32_16x16x32_bf16 a[76:79], v[136:139], a[188:191], a[76:79]
  v_and_b32 v113, 0xffff0000, v40
  v_lshlrev_b32 v168, 16, v18
  v_mfma_f32_16x16x32_bf16 a[80:83], v[140:143], a[176:179], a[80:83]
  v_and_b32 v169, 0xffff0000, v18
  v_lshlrev_b32 v18, 16, v53
  v_mfma_f32_16x16x32_bf16 a[84:87], v[140:143], a[180:183], a[84:87]
  v_and_b32 v19, 0xffff0000, v53
  v_add_f32 v170, v170, v18
  v_mfma_f32_16x16x32_bf16 a[88:91], v[140:143], a[184:187], a[88:91]
  v_add_f32 v171, v171, v19
  v_cvt_pk_bf16_f32 v18, v170, v171
  v_mfma_f32_16x16x32_bf16 a[92:95], v[140:143], a[188:191], a[92:95]
  v_lshlrev_b32 v114, 16, v41
  v_and_b32 v115, 0xffff0000, v41
  v_mfma_f32_16x16x32_bf16 a[96:99], v[144:147], a[176:179], a[96:99]
  v_lshlrev_b32 v170, 16, v18
  v_and_b32 v171, 0xffff0000, v18
  v_mfma_f32_16x16x32_bf16 a[100:103], v[144:147], a[180:183], a[100:103]
  v_lshlrev_b32 v18, 16, v54
  v_and_b32 v19, 0xffff0000, v54
  v_mfma_f32_16x16x32_bf16 a[104:107], v[144:147], a[184:187], a[104:107]
  v_add_f32 v172, v172, v18
  v_add_f32 v173, v173, v19
  v_mfma_f32_16x16x32_bf16 a[108:111], v[144:147], a[188:191], a[108:111]
  v_cvt_pk_bf16_f32 v18, v172, v173
  v_lshlrev_b32 v116, 16, v42
  v_mfma_f32_16x16x32_bf16 a[112:115], v[148:151], a[176:179], a[112:115]
  v_and_b32 v117, 0xffff0000, v42
  v_lshlrev_b32 v172, 16, v18
  v_mfma_f32_16x16x32_bf16 a[116:119], v[148:151], a[180:183], a[116:119]
  v_and_b32 v173, 0xffff0000, v18
  v_lshlrev_b32 v18, 16, v55
  v_mfma_f32_16x16x32_bf16 a[120:123], v[148:151], a[184:187], a[120:123]
  v_and_b32 v19, 0xffff0000, v55
  v_add_f32 v174, v174, v18
  v_mfma_f32_16x16x32_bf16 a[124:127], v[148:151], a[188:191], a[124:127]
  v_add_f32 v175, v175, v19
  v_cvt_pk_bf16_f32 v18, v174, v175
  v_mfma_f32_16x16x32_bf16 a[128:131], v[152:155], a[176:179], a[128:131]
  v_lshlrev_b32 v118, 16, v43
  v_and_b32 v119, 0xffff0000, v43
  v_mfma_f32_16x16x32_bf16 a[132:135], v[152:155], a[180:183], a[132:135]
  v_lshlrev_b32 v174, 16, v18
  v_and_b32 v175, 0xffff0000, v18
  v_mfma_f32_16x16x32_bf16 a[136:139], v[152:155], a[184:187], a[136:139]
  v_mfma_f32_16x16x32_bf16 a[140:143], v[152:155], a[188:191], a[140:143]
  s_waitcnt vmcnt(0)
  v_mfma_f32_16x16x32_bf16 a[64:67], v[156:159], v[216:219], a[64:67]
  v_mfma_f32_16x16x32_bf16 a[68:71], v[156:159], v[220:223], a[68:71]
  v_mfma_f32_16x16x32_bf16 a[72:75], v[156:159], v[224:227], a[72:75]
  v_mfma_f32_16x16x32_bf16 a[76:79], v[156:159], v[228:231], a[76:79]
  v_mfma_f32_16x16x32_bf16 a[80:83], v[176:179], v[216:219], a[80:83]
  v_mfma_f32_16x16x32_bf16 a[84:87], v[176:179], v[220:223], a[84:87]
  v_mfma_f32_16x16x32_bf16 a[88:91], v[176:179], v[224:227], a[88:91]
  v_mfma_f32_16x16x32_bf16 a[92:95], v[176:179], v[228:231], a[92:95]
  v_mfma_f32_16x16x32_bf16 a[96:99], v[180:183], v[216:219], a[96:99]
  v_mfma_f32_16x16x32_bf16 a[100:103], v[180:183], v[220:223], a[100:103]
  ds_write_b128 v16, a[64:67] offset:0
  v_mfma_f32_16x16x32_bf16 a[104:107], v[180:183], v[224:227], a[104:107]
  ds_write_b128 v16, a[68:71] offset:5376
  v_mfma_f32_16x16x32_bf16 a[108:111], v[180:183], v[228:231], a[108:111]
  ds_write_b128 v16, a[72:75] offset:10752
  v_mfma_f32_16x16x32_bf16 a[112:115], v[184:187], v[216:219], a[112:115]
  ds_write_b128 v16, a[76:79] offset:16128
  v_mfma_f32_16x16x32_bf16 a[116:119], v[184:187], v[220:223], a[116:119]
  ds_write_b128 v16, a[80:83] offset:64
  v_mfma_f32_16x16x32_bf16 a[120:123], v[184:187], v[224:227], a[120:123]
  ds_write_b128 v16, a[84:87] offset:5440
  v_mfma_f32_16x16x32_bf16 a[124:127], v[184:187], v[228:231], a[124:127]
  ds_write_b128 v16, a[88:91] offset:10816
  v_mfma_f32_16x16x32_bf16 a[128:131], v[188:191], v[216:219], a[128:131]
  ds_write_b128 v16, a[92:95] offset:16192
  v_mfma_f32_16x16x32_bf16 a[132:135], v[188:191], v[220:223], a[132:135]
  ds_write_b128 v16, a[96:99] offset:128
  v_mfma_f32_16x16x32_bf16 a[136:139], v[188:191], v[224:227], a[136:139]
  ds_write_b128 v16, a[100:103] offset:5504
  v_mfma_f32_16x16x32_bf16 a[140:143], v[188:191], v[228:231], a[140:143]
  ds_write_b128 v16, a[104:107] offset:10880
  ds_write_b128 v16, a[108:111] offset:16256
  ds_write_b128 v16, a[112:115] offset:192
  ds_write_b128 v16, a[116:119] offset:5568
  ds_write_b128 v16, a[120:123] offset:10944
  ds_write_b128 v16, a[124:127] offset:16320
  ds_write_b128 v16, a[128:131] offset:256
  ds_write_b128 v16, a[132:135] offset:5632
  ds_write_b128 v16, a[136:139] offset:11008
  ds_write_b128 v16, a[140:143] offset:16384
  s_waitcnt lgkmcnt(0)
  s_barrier
  ds_read_b128 v[32:35], v251 offset:0
  ds_read_b128 v[36:39], v251 offset:16
  ds_read_b128 v[40:43], v251 offset:38912
  ds_read_b128 v[44:47], v251 offset:38928
  ds_read_b128 v[48:51], v20 offset:0
  ds_read_b128 v[52:55], v20 offset:16
  ds_read_b128 v[56:59], v20 offset:38912
  ds_read_b128 v[60:63], v20 offset:38928
  ds_read_b128 v[64:67], v252 offset:0
  ds_read_b128 v[68:71], v252 offset:16
  ds_read_b128 v[72:75], v252 offset:38912
  ds_read_b128 v[76:79], v252 offset:38928
  ds_read_b128 v[80:83], v21 offset:0
  ds_read_b128 v[84:87], v21 offset:16
  ds_read_b128 v[88:91], v21 offset:38912
  ds_read_b128 v[92:95], v21 offset:38928
  ds_read_b128 v[128:131], v253 offset:0
  ds_read_b128 v[132:135], v253 offset:16
  ds_read_b128 v[136:139], v253 offset:38912
  ds_read_b128 v[140:143], v253 offset:38928
  ds_read_b128 v[144:147], v22 offset:0
  ds_read_b128 v[148:151], v22 offset:16
  ds_read_b128 v[152:155], v22 offset:38912
  ds_read_b128 v[156:159], v22 offset:38928
  s_waitcnt lgkmcnt(15)
  v_pk_add_f32 v[32:33], v[32:33], v[40:41]
  v_pk_add_f32 v[48:49], v[48:49], v[56:57]
  v_pk_add_f32 v[34:35], v[34:35], v[42:43]
  v_pk_add_f32 v[50:51], v[50:51], v[58:59]
  v_pk_add_f32 v[36:37], v[36:37], v[44:45]
  v_pk_add_f32 v[52:53], v[52:53], v[60:61]
  v_pk_add_f32 v[38:39], v[38:39], v[46:47]
  v_pk_add_f32 v[54:55], v[54:55], v[62:63]
  v_pk_add_f32 v[32:33], v[32:33], v[48:49]
  v_pk_add_f32 v[34:35], v[34:35], v[50:51]
  v_pk_add_f32 v[36:37], v[36:37], v[52:53]
  v_pk_add_f32 v[38:39], v[38:39], v[54:55]
  v_cvt_pk_bf16_f32 v40, v32, v33
  v_cvt_pk_bf16_f32 v41, v34, v35
  v_cvt_pk_bf16_f32 v42, v36, v37
  v_cvt_pk_bf16_f32 v43, v38, v39
  v_lshlrev_b32 v32, 16, v40
  v_and_b32 v33, 0xffff0000, v40
  v_lshlrev_b32 v34, 16, v41
  v_and_b32 v35, 0xffff0000, v41
  v_lshlrev_b32 v36, 16, v42
  v_and_b32 v37, 0xffff0000, v42
  v_lshlrev_b32 v38, 16, v43
  v_and_b32 v39, 0xffff0000, v43
  v_pk_add_f32 v[32:33], v[32:33], v[96:97]
  v_pk_add_f32 v[34:35], v[34:35], v[98:99]
  v_pk_add_f32 v[36:37], v[36:37], v[100:101]
  v_pk_add_f32 v[38:39], v[38:39], v[102:103]
  v_cvt_pk_bf16_f32 v40, v32, v33
  v_cvt_pk_bf16_f32 v41, v34, v35
  v_cvt_pk_bf16_f32 v42, v36, v37
  v_cvt_pk_bf16_f32 v43, v38, v39
  v_lshlrev_b32 v32, 16, v40
  v_and_b32 v33, 0xffff0000, v40
  v_lshlrev_b32 v34, 16, v41
  v_and_b32 v35, 0xffff0000, v41
  v_lshlrev_b32 v36, 16, v42
  v_and_b32 v37, 0xffff0000, v42
  v_lshlrev_b32 v38, 16, v43
  v_and_b32 v39, 0xffff0000, v43
  v_pk_add_f32 v[32:33], v[32:33], v[120:121]
  v_pk_add_f32 v[34:35], v[34:35], v[122:123]
  v_pk_add_f32 v[36:37], v[36:37], v[124:125]
  v_pk_add_f32 v[38:39], v[38:39], v[126:127]
  v_cvt_pk_bf16_f32 v44, v32, v33
  v_cvt_pk_bf16_f32 v45, v34, v35
  v_cvt_pk_bf16_f32 v46, v36, v37
  v_cvt_pk_bf16_f32 v47, v38, v39
  buffer_store_dwordx4 v[44:47], v248, s[48:51], 0 offen
  s_waitcnt lgkmcnt(8)
  v_pk_add_f32 v[64:65], v[64:65], v[72:73]
  v_pk_add_f32 v[80:81], v[80:81], v[88:89]
  v_pk_add_f32 v[66:67], v[66:67], v[74:75]
  v_pk_add_f32 v[82:83], v[82:83], v[90:91]
  v_pk_add_f32 v[68:69], v[68:69], v[76:77]
  v_pk_add_f32 v[84:85], v[84:85], v[92:93]
  v_pk_add_f32 v[70:71], v[70:71], v[78:79]
  v_pk_add_f32 v[86:87], v[86:87], v[94:95]
  v_pk_add_f32 v[64:65], v[64:65], v[80:81]
  v_pk_add_f32 v[66:67], v[66:67], v[82:83]
  v_pk_add_f32 v[68:69], v[68:69], v[84:85]
  v_pk_add_f32 v[70:71], v[70:71], v[86:87]
  v_cvt_pk_bf16_f32 v72, v64, v65
  v_cvt_pk_bf16_f32 v73, v66, v67
  v_cvt_pk_bf16_f32 v74, v68, v69
  v_cvt_pk_bf16_f32 v75, v70, v71
  v_lshlrev_b32 v64, 16, v72
  v_and_b32 v65, 0xffff0000, v72
  v_lshlrev_b32 v66, 16, v73
  v_and_b32 v67, 0xffff0000, v73
  v_lshlrev_b32 v68, 16, v74
  v_and_b32 v69, 0xffff0000, v74
  v_lshlrev_b32 v70, 16, v75
  v_and_b32 v71, 0xffff0000, v75
  v_pk_add_f32 v[64:65], v[64:65], v[104:105]
  v_pk_add_f32 v[66:67], v[66:67], v[106:107]
  v_pk_add_f32 v[68:69], v[68:69], v[108:109]
  v_pk_add_f32 v[70:71], v[70:71], v[110:111]
  v_cvt_pk_bf16_f32 v72, v64, v65
  v_cvt_pk_bf16_f32 v73, v66, v67
  v_cvt_pk_bf16_f32 v74, v68, v69
  v_cvt_pk_bf16_f32 v75, v70, v71
  v_lshlrev_b32 v64, 16, v72
  v_and_b32 v65, 0xffff0000, v72
  v_lshlrev_b32 v66, 16, v73
  v_and_b32 v67, 0xffff0000, v73
  v_lshlrev_b32 v68, 16, v74
  v_and_b32 v69, 0xffff0000, v74
  v_lshlrev_b32 v70, 16, v75
  v_and_b32 v71, 0xffff0000, v75
  v_pk_add_f32 v[64:65], v[64:65], v[160:161]
  v_pk_add_f32 v[66:67], v[66:67], v[162:163]
  v_pk_add_f32 v[68:69], v[68:69], v[164:165]
  v_pk_add_f32 v[70:71], v[70:71], v[166:167]
  v_cvt_pk_bf16_f32 v76, v64, v65
  v_cvt_pk_bf16_f32 v77, v66, v67
  v_cvt_pk_bf16_f32 v78, v68, v69
  v_cvt_pk_bf16_f32 v79, v70, v71
  buffer_store_dwordx4 v[76:79], v249, s[48:51], 0 offen
  s_waitcnt lgkmcnt(0)
  v_pk_add_f32 v[128:129], v[128:129], v[136:137]
  v_pk_add_f32 v[144:145], v[144:145], v[152:153]
  v_pk_add_f32 v[130:131], v[130:131], v[138:139]
  v_pk_add_f32 v[146:147], v[146:147], v[154:155]
  v_pk_add_f32 v[132:133], v[132:133], v[140:141]
  v_pk_add_f32 v[148:149], v[148:149], v[156:157]
  v_pk_add_f32 v[134:135], v[134:135], v[142:143]
  v_pk_add_f32 v[150:151], v[150:151], v[158:159]
  v_pk_add_f32 v[128:129], v[128:129], v[144:145]
  v_pk_add_f32 v[130:131], v[130:131], v[146:147]
  v_pk_add_f32 v[132:133], v[132:133], v[148:149]
  v_pk_add_f32 v[134:135], v[134:135], v[150:151]
  v_cvt_pk_bf16_f32 v136, v128, v129
  v_cvt_pk_bf16_f32 v137, v130, v131
  v_cvt_pk_bf16_f32 v138, v132, v133
  v_cvt_pk_bf16_f32 v139, v134, v135
  v_lshlrev_b32 v128, 16, v136
  v_and_b32 v129, 0xffff0000, v136
  v_lshlrev_b32 v130, 16, v137
  v_and_b32 v131, 0xffff0000, v137
  v_lshlrev_b32 v132, 16, v138
  v_and_b32 v133, 0xffff0000, v138
  v_lshlrev_b32 v134, 16, v139
  v_and_b32 v135, 0xffff0000, v139
  v_pk_add_f32 v[128:129], v[128:129], v[112:113]
  v_pk_add_f32 v[130:131], v[130:131], v[114:115]
  v_pk_add_f32 v[132:133], v[132:133], v[116:117]
  v_pk_add_f32 v[134:135], v[134:135], v[118:119]
  v_cvt_pk_bf16_f32 v136, v128, v129
  v_cvt_pk_bf16_f32 v137, v130, v131
  v_cvt_pk_bf16_f32 v138, v132, v133
  v_cvt_pk_bf16_f32 v139, v134, v135
  v_lshlrev_b32 v128, 16, v136
  v_and_b32 v129, 0xffff0000, v136
  v_lshlrev_b32 v130, 16, v137
  v_and_b32 v131, 0xffff0000, v137
  v_lshlrev_b32 v132, 16, v138
  v_and_b32 v133, 0xffff0000, v138
  v_lshlrev_b32 v134, 16, v139
  v_and_b32 v135, 0xffff0000, v139
  v_pk_add_f32 v[128:129], v[128:129], v[168:169]
  v_pk_add_f32 v[130:131], v[130:131], v[170:171]
  v_pk_add_f32 v[132:133], v[132:133], v[172:173]
  v_pk_add_f32 v[134:135], v[134:135], v[174:175]
  v_cvt_pk_bf16_f32 v140, v128, v129
  v_cvt_pk_bf16_f32 v141, v130, v131
  v_cvt_pk_bf16_f32 v142, v132, v133
  v_cvt_pk_bf16_f32 v143, v134, v135
  buffer_store_dwordx4 v[140:143], v250, s[48:51], 0 offen
fa_end:
  s_endpgm
fa_hk0:
  s_getpc_b64 s[10:11]
fa_hp0:
  s_add_u32 s8, s8, 4
  s_addc_u32 s9, s9, 0
  s_sub_u32 s10, s10, fa_hp0-fa_hb0
  s_subb_u32 s11, s11, 0
  s_setpc_b64 s[8:9]
fa_hk1:
  s_getpc_b64 s[10:11]
fa_hp1:
  s_add_u32 s8, s8, 4
  s_addc_u32 s9, s9, 0
  s_sub_u32 s10, s10, fa_hp1-fa_hb1
  s_subb_u32 s11, s11, 0
  s_setpc_b64 s[8:9]
fa_hk2:
  s_getpc_b64 s[10:11]
fa_hp2:
  s_add_u32 s8, s8, 4
  s_addc_u32 s9, s9, 0
  s_sub_u32 s10, s10, fa_hp2-fa_hb2
  s_subb_u32 s11, s11, 0
  s_setpc_b64 s[8:9]
fa_hk3:
  s_getpc_b64 s[10:11]
fa_hp3:
  s_add_u32 s8, s8, 4
  s_addc_u32 s9, s9, 0
  s_sub_u32 s10, s10, fa_hp3-fa_hb3
  s_subb_u32 s11, s11, 0
  s_setpc_b64 s[8:9]
fa_ln_spin:
  s_mov_b32 s83, 200000
fa_ln_spin2:
  buffer_load_dword v15, v229, s[56:59], 0 offen sc1
  s_waitcnt vmcnt(0)
  v_cmp_ne_u32 vcc, 0x01010101, v15
  s_cbranch_vccz fa_ln_ok
  s_sleep 8
  s_sub_u32 s83, s83, 1
  s_cmp_lg_u32 s83, 0
  s_cbranch_scc1 fa_ln_spin2
  s_branch fa_ln_ok
fa_co1:
  buffer_load_dword v232, v234, s[32:35], s29 offen
  buffer_store_dword v229, v225, s[40:43], 0 offen sc1
  ds_read_b128 v[160:163], v221 offset:0
  ds_read_b128 v[164:167], v221 offset:4096
  ds_read_b128 v[168:171], v221 offset:8192
  buffer_store_dword v218, v222, s[40:43], 0 offen sc1
  s_waitcnt lgkmcnt(0)
  buffer_store_dwordx4 v[160:163], v223, s[40:43], s66 offen sc1
  buffer_store_dwordx4 v[164:167], v223, s[40:43], s67 offen sc1
  buffer_store_dwordx4 v[168:171], v224, s[40:43], s78 offen sc1
  s_getpc_b64 s[8:9]
  s_setpc_b64 s[10:11]
  s_mov_b32 s48, s60
  s_mov_b32 s49, s61
  s_mov_b32 s50, s75
  s_lshl_b32 s74, s22, 2
  s_add_u32 s74, s74, s20
  s_lshl_b32 s74, s74, 16
  s_mov_b32 s73, 2097152
  v_mov_b32 v213, 1073741824
  v_mov_b32 v214, 1
  v_writelane_b32 v213, s77, 0
  v_lshlrev_b32 v229, 2, v1
  s_and_b32 s23, s21, 3
  s_cbranch_scc0 fa_arr
  s_getpc_b64 s[8:9]
  s_setpc_b64 s[10:11]
fa_arr:
  buffer_store_byte v214, v213, s[56:59], 0 offen sc1
  s_getpc_b64 s[8:9]
  s_setpc_b64 s[10:11]
  buffer_load_dword v15, v229, s[56:59], 0 offen sc1
  s_getpc_b64 s[8:9]
  s_setpc_b64 s[10:11]
  s_mov_b32 s36, s60
  s_mov_b32 s37, s61
  s_mov_b32 s38, s75
  s_lshr_b32 s27, s20, 1
  s_lshl_b32 s27, s27, 18
  s_mov_b32 s25, 524288
  s_mov_b32 s32, s18
  s_mov_b32 s33, s19
  s_mov_b32 s34, 2621440
  s_mov_b32 s26, 0
  s_movk_i32 s79, 1024
  s_lshl_b32 s23, s22, 2
  s_add_u32 s23, s23, s20
  s_mul_i32 s23, s23, 40960
  v_add_u32 v3, s23, v2
  s_sub_u32 s23, 15, s22
  s_lshl_b32 s23, s23, 2
  s_add_u32 s23, s23, s20
  s_mul_i32 s23, s23, 40960
  s_sub_u32 s23, s23, 2048
  v_add_u32 v5, s23, v2
  v_add_u32 v4, 19456, v3
  v_add_u32 v6, 19456, v5
  s_waitcnt vmcnt(8)
  v_cmp_ne_u32 vcc, 0x01010101, v15
  s_cbranch_vccnz fa_ln_spin
fa_ln_ok:
  s_setpc_b64 s[10:11]
fa_kv_spin:
  s_mov_b32 s83, 200000
fa_kv_spin2:
  buffer_load_dword v15, v8, s[40:43], 0 offen sc1
  s_waitcnt vmcnt(0)
  v_cmp_eq_u32 vcc, 0, v15
  s_cbranch_vccz fa_kv_ok
  s_sleep 8
  s_sub_u32 s83, s83, 1
  s_cmp_lg_u32 s83, 0
  s_cbranch_scc1 fa_kv_spin2
  s_branch fa_kv_ok
fa_top8:
  s_cmp_lg_u32 s20, 0
  s_cbranch_scc1 fa_notop
  s_mov_b32 s23, 2621440
  s_mov_b32 s31, 2625536
  buffer_load_dwordx4 v[96:99], v2, s[40:43], s23 offen offset:0 sc1
  buffer_load_dwordx4 v[100:103], v2, s[40:43], s23 offen offset:1024 sc1
  buffer_load_dwordx4 v[104:107], v2, s[40:43], s23 offen offset:2048 sc1
  buffer_load_dwordx4 v[108:111], v2, s[40:43], s23 offen offset:3072 sc1
  buffer_load_dwordx4 v[112:115], v2, s[40:43], s31 offen offset:0 sc1
  buffer_load_dwordx4 v[116:119], v2, s[40:43], s31 offen offset:1024 sc1
  buffer_load_dwordx4 v[120:123], v2, s[40:43], s31 offen offset:2048 sc1
  buffer_load_dwordx4 v[124:127], v2, s[40:43], s31 offen offset:3072 sc1
  v_mov_b32 v21, 0
  v_mov_b32 v22, 0
  v_and_b32 v23, 7, v1
  s_mov_b32 s23, 0
  s_waitcnt vmcnt(0)
fa_top:
  v_max3_u32 v20, v96, v97, v98
  v_max3_u32 v24, v99, v100, v101
  v_max3_u32 v20, v20, v102, v103
  v_max3_u32 v24, v24, v104, v105
  v_max3_u32 v20, v20, v106, v107
  v_max3_u32 v24, v24, v108, v109
  v_max3_u32 v20, v20, v110, v111
  v_max3_u32 v24, v24, v112, v113
  v_max3_u32 v20, v20, v114, v115
  v_max3_u32 v24, v24, v116, v117
  v_max3_u32 v20, v20, v118, v119
  v_max3_u32 v24, v24, v120, v121
  v_max3_u32 v20, v20, v122, v123
  v_max3_u32 v24, v24, v124, v125
  v_max3_u32 v20, v20, v126, v127
  v_max_u32 v20, v20, v24
  s_nop 1
  v_max_u32_dpp v20, v20, v20 quad_perm:[1,0,3,2] row_mask:0xf bank_mask:0xf
  s_nop 1
  v_max_u32_dpp v20, v20, v20 quad_perm:[2,3,0,1] row_mask:0xf bank_mask:0xf
  s_nop 1
  v_max_u32_dpp v20, v20, v20 row_half_mirror row_mask:0xf bank_mask:0xf
  s_nop 1
  v_max_u32_dpp v20, v20, v20 row_mirror row_mask:0xf bank_mask:0xf
  v_mov_b32 v24, v20
  s_nop 1
  v_permlane16_swap_b32 v20, v24
  v_max_u32 v20, v20, v24
  v_mov_b32 v24, v20
  s_nop 1
  v_permlane32_swap_b32 v20, v24
  v_max_u32 v20, v20, v24
  v_add_u32 v21, v21, v20
  v_cmp_eq_u32 vcc, s23, v23
  v_sub_u32 v96, v96, v20
  v_sub_u32 v97, v97, v20
  v_sub_u32 v98, v98, v20
  v_sub_u32 v99, v99, v20
  v_sub_u32 v100, v100, v20
  v_sub_u32 v101, v101, v20
  v_sub_u32 v102, v102, v20
  v_sub_u32 v103, v103, v20
  v_sub_u32 v104, v104, v20
  v_sub_u32 v105, v105, v20
  v_sub_u32 v106, v106, v20
  v_sub_u32 v107, v107, v20
  v_sub_u32 v108, v108, v20
  v_sub_u32 v109, v109, v20
  v_sub_u32 v110, v110, v20
  v_sub_u32 v111, v111, v20
  v_sub_u32 v112, v112, v20
  v_sub_u32 v113, v113, v20
  v_sub_u32 v114, v114, v20
  v_sub_u32 v115, v115, v20
  v_sub_u32 v116, v116, v20
  v_sub_u32 v117, v117, v20
  v_sub_u32 v118, v118, v20
  v_sub_u32 v119, v119, v20
  v_sub_u32 v120, v120, v20
  v_sub_u32 v121, v121, v20
  v_sub_u32 v122, v122, v20
  v_sub_u32 v123, v123, v20
  v_sub_u32 v124, v124, v20
  v_sub_u32 v125, v125, v20
  v_sub_u32 v126, v126, v20
  v_sub_u32 v127, v127, v20
  v_cndmask_b32 v22, v22, v21, vcc
  s_add_u32 s23, s23, 1
  s_cmp_lt_u32 s23, 8
  s_cbranch_scc1 fa_top
  v_and_b32 v25, 0xffff, v22
  v_sub_u32 v25, 0xffff, v25
  v_and_b32 v25, 2047, v25
  v_ashrrev_i32 v20, 31, v22
  v_not_b32 v20, v20
  v_or_b32 v20, 0x80000000, v20
  v_xor_b32 v26, v22, v20
  v_and_b32 v26, 0xffff0000, v26
  v_mul_f32 v26, 0xbfb8aa3b, v26
  v_exp_f32 v26, v26
  s_nop 0
  v_add_f32 v26, 1.0, v26
  v_rcp_f32 v26, v26
  s_nop 0
  v_cvt_pk_bf16_f32 v26, v26, v26
  v_and_b32 v26, 0xffff0000, v26
  v_lshlrev_b32 v20, 2, v1
  v_add_u32 v20, 2629632, v20
  v_mov_b32 v21, 1073741824
  v_cmp_gt_u32 vcc, 16, v1
  v_add_u32 v25, 1, v25
  v_or_b32 v26, 1, v26
  v_cndmask_b32 v20, v21, v20, vcc
  v_cmp_gt_u32 vcc, 8, v1
  s_nop 1
  v_cndmask_b32 v26, v26, v25, vcc
  buffer_store_dword v26, v20, s[40:43], 0 offen sc1
  s_branch fa_notop
fa_hk4:
  s_getpc_b64 s[38:39]
fa_hp4:
  s_add_u32 s36, s36, 4
  s_addc_u32 s37, s37, 0
  s_sub_u32 s38, s38, fa_hp4-fa_hb4
  s_subb_u32 s39, s39, 0
  s_setpc_b64 s[36:37]
fa_hk5:
  s_getpc_b64 s[38:39]
fa_hp5:
  s_add_u32 s36, s36, 4
  s_addc_u32 s37, s37, 0
  s_sub_u32 s38, s38, fa_hp5-fa_hb5
  s_subb_u32 s39, s39, 0
  s_setpc_b64 s[36:37]
fa_hk6:
  s_getpc_b64 s[38:39]
fa_hp6:
  s_add_u32 s36, s36, 4
  s_addc_u32 s37, s37, 0
  s_add_u32 s38, s38, fa_hb6-fa_hp6
  s_addc_u32 s39, s39, 0
  s_setpc_b64 s[36:37]
fa_DDF:
  v_mfma_f32_16x16x32_bf16 v[96:99], a[128:131], v[32:35], v[192:195]
  s_waitcnt vmcnt(12)
  v_exp_f32 v208, v112
  v_mfma_f32_16x16x32_bf16 v[104:107], a[128:131], v[36:39], v[196:199]
  s_barrier
  v_exp_f32 v209, v113
  v_mfma_f32_16x16x32_bf16 v[128:131], a[128:131], v[64:67], v[200:203]
  s_cmp_ge_u32 s26, s32
  ds_read_b128 a[160:163], v3 offset:16384
  v_add_f32 v224, v208, v209
  v_mfma_f32_16x16x32_bf16 v[136:139], a[128:131], v[68:71], v[204:207]
  s_cbranch_scc1 fa_hk6
fa_hb6:
  v_exp_f32 v210, v114
  v_cvt_pk_bf16_f32 v168, v208, v209
  v_mfma_f32_16x16x32_bf16 v[100:103], a[132:135], v[32:35], v[192:195]
  ds_read_b128 a[164:167], v3 offset:17408
  v_add_f32 v224, v224, v210
  v_mfma_f32_16x16x32_bf16 v[108:111], a[132:135], v[36:39], v[196:199]
  s_mov_b32 m0, s24
  v_exp_f32 v211, v115
  v_mfma_f32_16x16x32_bf16 v[132:135], a[132:135], v[64:67], v[200:203]
  buffer_load_dwordx4 v2, s[44:47], s26 offen offset:0 sc1 lds
  v_add_f32 v224, v224, v211
  v_mfma_f32_16x16x32_bf16 v[140:143], a[132:135], v[68:71], v[204:207]
  v_exp_f32 v212, v116
  v_mfma_f32_16x16x32_bf16 v[96:99], a[136:139], v[40:43], v[96:99]
  ds_read_b128 a[168:171], v3 offset:18432
  v_cvt_pk_bf16_f32 v169, v210, v211
  v_mfma_f32_16x16x32_bf16 v[104:107], a[136:139], v[44:47], v[104:107]
  v_exp_f32 v213, v117
  v_add_f32 v224, v224, v212
  v_mfma_f32_16x16x32_bf16 v[128:131], a[136:139], v[72:75], v[128:131]
  v_exp_f32 v214, v118
  v_mfma_f32_16x16x32_bf16 v[136:139], a[136:139], v[76:79], v[136:139]
  v_exp_f32 v215, v119
  v_mfma_f32_16x16x32_bf16 v[100:103], a[140:143], v[40:43], v[100:103]
  ds_read_b128 a[172:175], v3 offset:19456
  v_add_f32 v224, v224, v213
  v_mfma_f32_16x16x32_bf16 v[108:111], a[140:143], v[44:47], v[108:111]
  buffer_load_dwordx4 v2, s[44:47], s26 offen offset:1024 sc1 lds
  v_cvt_pk_bf16_f32 v170, v212, v213
  v_mfma_f32_16x16x32_bf16 v[132:135], a[140:143], v[72:75], v[132:135]
  v_exp_f32 v208, v120
  v_mfma_f32_16x16x32_bf16 v[140:143], a[140:143], v[76:79], v[140:143]
  s_waitcnt lgkmcnt(4)
  v_exp_f32 v209, v121
  v_add_f32 v224, v224, v214
  v_mfma_f32_16x16x32_bf16 v[96:99], a[144:147], v[48:51], v[96:99]
  ds_read_b128 a[176:179], v3 offset:20480
  v_add_f32 v224, v224, v215
  v_mfma_f32_16x16x32_bf16 v[104:107], a[144:147], v[52:55], v[104:107]
  v_exp_f32 v210, v122
  v_mfma_f32_16x16x32_bf16 v[128:131], a[144:147], v[80:83], v[128:131]
  v_exp_f32 v211, v123
  v_mfma_f32_16x16x32_bf16 v[136:139], a[144:147], v[84:87], v[136:139]
  buffer_load_dwordx4 v2, s[44:47], s26 offen offset:2048 sc1 lds
  v_cvt_pk_bf16_f32 v171, v214, v215
  v_mfma_f32_16x16x32_bf16 v[100:103], a[148:151], v[48:51], v[100:103]
  ds_read_b128 a[180:183], v3 offset:21504
  v_add_f32 v225, v208, v209
  v_mfma_f32_16x16x32_bf16 v[108:111], a[148:151], v[52:55], v[108:111]
  v_exp_f32 v212, v124
  v_mfma_f32_16x16x32_bf16 v[132:135], a[148:151], v[80:83], v[132:135]
  v_exp_f32 v213, v125
  v_cvt_pk_bf16_f32 v172, v208, v209
  v_mfma_f32_16x16x32_bf16 v[140:143], a[148:151], v[84:87], v[140:143]
  v_exp_f32 v214, v126
  v_mfma_f32_16x16x32_bf16 v[96:99], a[152:155], v[56:59], v[96:99]
  ds_read_b128 a[184:187], v3 offset:22528
  v_add_f32 v225, v225, v210
  v_mfma_f32_16x16x32_bf16 v[104:107], a[152:155], v[60:63], v[104:107]
  buffer_load_dwordx4 v2, s[44:47], s26 offen offset:3072 sc1 lds
  v_add_f32 v225, v225, v211
  v_mfma_f32_16x16x32_bf16 v[128:131], a[152:155], v[88:91], v[128:131]
  s_add_u32 s26, s26, 16384
  v_exp_f32 v215, v127
  v_mfma_f32_16x16x32_bf16 v[136:139], a[152:155], v[92:95], v[136:139]
  s_add_u32 s24, s24, 32768
  v_exp_f32 v216, v144
  v_mfma_f32_16x16x32_bf16 v[100:103], a[156:159], v[56:59], v[100:103]
  s_and_b32 s24, s24, 0x1ffff
  ds_read_b128 a[188:191], v3 offset:23552
  v_cvt_pk_bf16_f32 v173, v210, v211
  v_add_f32 v225, v225, v212
  v_mfma_f32_16x16x32_bf16 v[108:111], a[156:159], v[60:63], v[108:111]
  v_exp_f32 v217, v145
  v_mfma_f32_16x16x32_bf16 v[132:135], a[156:159], v[88:91], v[132:135]
  s_add_u32 m0, s34, 0
  v_exp_f32 v218, v146
  v_mfma_f32_16x16x32_bf16 v[140:143], a[156:159], v[92:95], v[140:143]
  s_waitcnt lgkmcnt(4)
  buffer_load_dwordx4 v8, s[52:55], s33 offen offset:0 lds
  v_add_f32 v225, v225, v213
  v_mfma_f32_16x16x32_bf16 a[0:3], a[160:163], v[160:163], a[0:3]
  ds_read_b128 a[128:131], v3 offset:0
  v_cvt_pk_bf16_f32 v174, v212, v213
  v_mfma_f32_16x16x32_bf16 a[4:7], a[160:163], v[164:167], a[4:7]
  v_exp_f32 v219, v147
  v_mfma_f32_16x16x32_bf16 a[64:67], a[160:163], v[176:179], a[64:67]
  v_exp_f32 v220, v148
  v_add_f32 v225, v225, v214
  v_mfma_f32_16x16x32_bf16 a[68:71], a[160:163], v[180:183], a[68:71]
  v_exp_f32 v221, v149
  v_mfma_f32_16x16x32_bf16 a[8:11], a[164:167], v[160:163], a[8:11]
  ds_read_b128 a[132:135], v3 offset:1024
  v_add_f32 v225, v225, v215
  v_mfma_f32_16x16x32_bf16 a[12:15], a[164:167], v[164:167], a[12:15]
  buffer_load_dwordx4 v11, s[52:55], s33 offen offset:1024 lds
  v_cvt_pk_bf16_f32 v175, v214, v215
  v_mfma_f32_16x16x32_bf16 a[72:75], a[164:167], v[176:179], a[72:75]
  v_exp_f32 v222, v150
  v_mfma_f32_16x16x32_bf16 a[76:79], a[164:167], v[180:183], a[76:79]
  v_exp_f32 v223, v151
  v_mfma_f32_16x16x32_bf16 a[16:19], a[168:171], v[160:163], a[16:19]
  ds_read_b128 a[136:139], v3 offset:2048
  v_add_f32 v226, v216, v217
  v_cvt_pk_bf16_f32 v184, v216, v217
  v_mfma_f32_16x16x32_bf16 a[20:23], a[168:171], v[164:167], a[20:23]
  v_exp_f32 v216, v152
  v_mfma_f32_16x16x32_bf16 a[80:83], a[168:171], v[176:179], a[80:83]
  v_add_f32 v226, v226, v218
  v_add_f32 v226, v226, v219
  v_mfma_f32_16x16x32_bf16 a[84:87], a[168:171], v[180:183], a[84:87]
  buffer_load_dwordx4 v12, s[52:55], s33 offen offset:2048 lds
  v_cvt_pk_bf16_f32 v185, v218, v219
  v_mfma_f32_16x16x32_bf16 a[24:27], a[172:175], v[160:163], a[24:27]
  ds_read_b128 a[140:143], v3 offset:3072
  v_add_f32 v226, v226, v220
  v_mfma_f32_16x16x32_bf16 a[28:31], a[172:175], v[164:167], a[28:31]
  v_exp_f32 v217, v153
  v_mfma_f32_16x16x32_bf16 a[88:91], a[172:175], v[176:179], a[88:91]
  v_exp_f32 v218, v154
  v_mfma_f32_16x16x32_bf16 a[92:95], a[172:175], v[180:183], a[92:95]
  s_waitcnt lgkmcnt(4)
  v_exp_f32 v219, v155
  v_add_f32 v226, v226, v221
  v_mfma_f32_16x16x32_bf16 a[32:35], a[176:179], v[160:163], a[32:35]
  ds_read_b128 a[144:147], v3 offset:4096
  v_cvt_pk_bf16_f32 v186, v220, v221
  v_mfma_f32_16x16x32_bf16 a[36:39], a[176:179], v[164:167], a[36:39]
  buffer_load_dwordx4 v13, s[52:55], s33 offen offset:3072 lds
  v_add_f32 v226, v226, v222
  v_mfma_f32_16x16x32_bf16 a[96:99], a[176:179], v[176:179], a[96:99]
  v_exp_f32 v220, v156
  v_mfma_f32_16x16x32_bf16 a[100:103], a[176:179], v[180:183], a[100:103]
  v_exp_f32 v221, v157
  v_mfma_f32_16x16x32_bf16 a[40:43], a[180:183], v[160:163], a[40:43]
  ds_read_b128 a[148:151], v3 offset:5120
  v_add_f32 v226, v226, v223
  v_mfma_f32_16x16x32_bf16 a[44:47], a[180:183], v[164:167], a[44:47]
  v_cvt_pk_bf16_f32 v187, v222, v223
  v_add_f32 v227, v216, v217
  v_cvt_pk_bf16_f32 v188, v216, v217
  v_mfma_f32_16x16x32_bf16 a[104:107], a[180:183], v[176:179], a[104:107]
  s_add_u32 m0, s34, 4096
  v_exp_f32 v222, v158
  v_mfma_f32_16x16x32_bf16 a[108:111], a[180:183], v[180:183], a[108:111]
  buffer_load_dwordx4 v14, s[52:55], s33 offen offset:0 lds
  v_add_f32 v227, v227, v218
  v_mfma_f32_16x16x32_bf16 a[48:51], a[184:187], v[160:163], a[48:51]
  ds_read_b128 a[152:155], v3 offset:6144
  v_add_f32 v227, v227, v219
  v_mfma_f32_16x16x32_bf16 a[52:55], a[184:187], v[164:167], a[52:55]
  v_exp_f32 v223, v159
  v_mfma_f32_16x16x32_bf16 a[112:115], a[184:187], v[176:179], a[112:115]
  v_cvt_pk_bf16_f32 v189, v218, v219
  v_max3_f32 v5, v224, v225, v226
  v_mfma_f32_16x16x32_bf16 a[116:119], a[184:187], v[180:183], a[116:119]
  v_add_f32 v227, v227, v220
  v_add_f32 v227, v227, v221
  v_cvt_pk_bf16_f32 v190, v220, v221
  v_mfma_f32_16x16x32_bf16 a[56:59], a[188:191], v[160:163], a[56:59]
  ds_read_b128 a[156:159], v3 offset:7168
  v_add_f32 v227, v227, v222
  v_mfma_f32_16x16x32_bf16 a[60:63], a[188:191], v[164:167], a[60:63]
  v_add_f32 v227, v227, v223
  v_cvt_pk_bf16_f32 v191, v222, v223
  v_mfma_f32_16x16x32_bf16 a[120:123], a[188:191], v[176:179], a[120:123]
  s_waitcnt lgkmcnt(4)
  v_max_f32 v5, v5, v227
  v_cmp_lt_f32 vcc, s81, v5
  v_mfma_f32_16x16x32_bf16 a[124:127], a[188:191], v[180:183], a[124:127]
  s_cbranch_vccnz fa_stub3
fa_back3:
  v_add_f32 v228, v228, v224
  v_add_f32 v229, v229, v225
  v_add_f32 v230, v230, v226
  v_add_f32 v231, v231, v227
  s_branch fa_DDe
fa_sel_spin:
  s_mov_b32 s83, 200000
fa_sel_spin2:
  buffer_load_dword v15, v252, s[40:43], 0 offen sc1
  s_waitcnt vmcnt(0)
  v_cmp_eq_u32 vcc, 0, v15
  s_cbranch_vccz fa_sel_ok
  s_sleep 8
  s_sub_u32 s83, s83, 1
  s_cmp_lg_u32 s83, 0
  s_cbranch_scc1 fa_sel_spin2
  s_branch fa_sel_ok
fa_wof_spin:
  s_mov_b32 s83, 200000
fa_wof_spin2:
  buffer_load_dword v8, v9, s[40:43], 0 offen sc1
  s_waitcnt vmcnt(0)
  v_cmp_eq_u32 vcc, 0, v8
  s_cbranch_vccz fa_wof_ok
  s_sleep 8
  s_sub_u32 s83, s83, 1
  s_cmp_lg_u32 s83, 0
  s_cbranch_scc1 fa_wof_spin2
  s_branch fa_wof_ok
fa_sel4_spin:
  s_mov_b32 s83, 200000
fa_sel4_spin2:
  buffer_load_dword v15, v10, s[40:43], 0 offen sc1
  s_waitcnt vmcnt(0)
  v_cmp_eq_u32 vcc, 0, v15
  s_cbranch_vccz fa_sel4_ok
  s_sleep 8
  s_sub_u32 s83, s83, 1
  s_cmp_lg_u32 s83, 0
  s_cbranch_scc1 fa_sel4_spin2
  s_branch fa_sel4_ok
fa_yf_spin:
  s_mov_b32 s83, 200000
fa_yf_spin2:
  buffer_load_dword v14, v11, s[40:43], 0 offen sc1
  s_waitcnt vmcnt(0)
  v_cmp_eq_u32 vcc, 0, v14
  s_cbranch_vccz fa_yf_ok
  s_sleep 8
  s_sub_u32 s83, s83, 1
  s_cmp_lg_u32 s83, 0
  s_cbranch_scc1 fa_yf_spin2
  s_branch fa_yf_ok
fa_co:
  s_waitcnt vmcnt(8)
  ds_read_b64_tr_b16 v[232:233], v6 offset:0
  ds_read_b64_tr_b16 v[234:235], v6 offset:2560
  ds_read_b64_tr_b16 v[236:237], v6 offset:32
  ds_read_b64_tr_b16 v[238:239], v6 offset:2592
  ds_read_b64_tr_b16 v[240:241], v6 offset:64
  ds_read_b64_tr_b16 v[242:243], v6 offset:2624
  ds_read_b64_tr_b16 v[244:245], v6 offset:96
  ds_read_b64_tr_b16 v[246:247], v6 offset:2656
  ds_read_b64_tr_b16 v[248:249], v6 offset:128
  ds_read_b64_tr_b16 v[250:251], v6 offset:2688
  s_sub_u32 s14, s2, 170
  s_cmp_lt_u32 s14, 54
  s_cbranch_scc1 fa_coF
  s_sub_u32 s14, s2, 64
  s_cmp_lt_u32 s14, 96
  s_cbranch_scc1 fa_coT
  s_sub_u32 s14, s2, 128
  s_cmp_ge_u32 s2, 224
  s_cbranch_scc1 fa_coT
  s_getpc_b64 s[36:37]
  s_setpc_b64 s[38:39]
  s_add_u32 s31, s30, 4096
  buffer_store_dwordx4 v[232:235], v2, s[40:43], s30 offen offset:0 sc1
  buffer_store_dwordx4 v[236:239], v2, s[40:43], s30 offen offset:1024 sc1
  buffer_store_dwordx4 v[240:243], v2, s[40:43], s30 offen offset:2048 sc1
  buffer_store_dwordx4 v[244:247], v2, s[40:43], s30 offen offset:3072 sc1
  buffer_store_dwordx4 v[248:251], v2, s[40:43], s31 offen offset:0 sc1
  s_getpc_b64 s[36:37]
  s_setpc_b64 s[38:39]
  s_getpc_b64 s[36:37]
  s_setpc_b64 s[38:39]
  s_and_b32 s23, s2, 1
  s_lshl_b32 s23, s23, 2
  s_add_u32 s23, s23, s20
  s_lshl_b32 s23, s23, 7
  s_lshr_b32 s31, s2, 1
  s_add_u32 s23, s23, s31
  s_lshl_b32 s23, s23, 2
  s_add_u32 s23, s23, 2654208
  v_mov_b32 v16, 1073741824
  v_mov_b32 v17, 1
  v_writelane_b32 v16, s23, 0
  s_waitcnt vmcnt(8)
  buffer_store_dword v17, v16, s[40:43], 0 offen sc1
  s_branch fa_coW
fa_coT:
  v_min_u32 v8, 16, v1
  v_lshlrev_b32 v8, 7, v8
  s_lshl_b32 s33, s14, 1
  s_and_b32 s31, s20, 1
  s_add_u32 s33, s33, s31
  s_mul_i32 s33, s33, 2176
  s_lshl_b32 s35, s14, 2
  s_add_u32 s35, s35, s20
  s_mul_i32 s35, s35, 4352
  buffer_load_dword v255, v8, s[52:55], s33 offen
  s_add_u32 s33, s33, 552960
  s_getpc_b64 s[36:37]
  s_setpc_b64 s[38:39]
  s_add_u32 s31, s30, 4096
  buffer_store_dwordx4 v[232:235], v2, s[40:43], s30 offen offset:0 sc1
  buffer_store_dwordx4 v[236:239], v2, s[40:43], s30 offen offset:1024 sc1
  buffer_store_dwordx4 v[240:243], v2, s[40:43], s30 offen offset:2048 sc1
  buffer_store_dwordx4 v[244:247], v2, s[40:43], s30 offen offset:3072 sc1
  buffer_store_dwordx4 v[248:251], v2, s[40:43], s31 offen offset:0 sc1
  buffer_load_dword v255, v8, s[52:55], s33 offen
  s_add_u32 s33, s33, 552960
  s_getpc_b64 s[36:37]
  s_setpc_b64 s[38:39]
  buffer_load_dword v255, v8, s[52:55], s33 offen
  s_add_u32 s33, s33, 552960
  s_getpc_b64 s[36:37]
  s_setpc_b64 s[38:39]
  s_and_b32 s23, s2, 1
  s_lshl_b32 s23, s23, 2
  s_add_u32 s23, s23, s20
  s_lshl_b32 s23, s23, 7
  s_lshr_b32 s31, s2, 1
  s_add_u32 s23, s23, s31
  s_lshl_b32 s23, s23, 2
  s_add_u32 s23, s23, 2654208
  v_mov_b32 v16, 1073741824
  v_mov_b32 v17, 1
  v_writelane_b32 v16, s23, 0
  s_waitcnt vmcnt(10)
  buffer_store_dword v17, v16, s[40:43], 0 offen sc1
  buffer_load_dword v255, v8, s[52:55], s33 offen
  s_add_u32 s33, s33, 552960
  s_getpc_b64 s[36:37]
  s_setpc_b64 s[38:39]
  buffer_load_dword v255, v8, s[60:63], s35 offen
  s_getpc_b64 s[36:37]
  s_setpc_b64 s[38:39]
  buffer_load_dword v255, v8, s[60:63], s35 offen offset:2176
  s_branch fa_coW
fa_coF:
  s_getpc_b64 s[36:37]
  s_setpc_b64 s[38:39]
  s_add_u32 s31, s30, 4096
  buffer_store_dwordx4 v[232:235], v2, s[40:43], s30 offen offset:0 sc1
  buffer_store_dwordx4 v[236:239], v2, s[40:43], s30 offen offset:1024 sc1
  buffer_store_dwordx4 v[240:243], v2, s[40:43], s30 offen offset:2048 sc1
  buffer_store_dwordx4 v[244:247], v2, s[40:43], s30 offen offset:3072 sc1
  buffer_store_dwordx4 v[248:251], v2, s[40:43], s31 offen offset:0 sc1
  s_lshl_b32 s33, s14, 6
  s_and_b32 s31, s20, 1
  s_lshl_b32 s31, s31, 5
  s_add_u32 s33, s33, s31
  s_mul_i32 s35, s14, 40960
  s_mul_i32 s31, s20, 320
  s_add_u32 s35, s35, s31
  s_mul_i32 s10, s14, 20480
  s_mul_i32 s31, s20, 640
  s_add_u32 s10, s10, s31
  s_add_u32 s10, s10, 2686976
  s_mov_b32 s9, -1
  s_getpc_b64 s[36:37]
  s_setpc_b64 s[38:39]
  v_and_b32 v16, 7, v1
  v_lshlrev_b32 v252, 2, v16
  v_add_u32 v252, 2629632, v252
  buffer_load_dword v15, v252, s[40:43], 0 offen sc1
  v_lshrrev_b32 v17, 1, v1
  v_mul_u32_u24 v8, 3456, v17
  v_and_b32 v17, 1, v1
  v_lshl_add_u32 v8, v17, 4, v8
  v_add_u32 v11, 109568, v8
  v_add_u32 v12, 219136, v8
  v_add_u32 v13, 328704, v8
  v_add_u32 v14, 442368, v8
  v_lshrrev_b32 v17, 4, v1
  v_lshrrev_b32 v18, 2, v1
  v_lshl_add_u32 v18, v17, 2, v18
  v_lshlrev_b32 v18, 5, v18
  v_and_b32 v19, 3, v1
  v_lshl_add_u32 v9, v19, 3, v18
  v_add_u32 v9, s34, v9
  v_lshlrev_b32 v10, 4, v16
  v_lshl_add_u32 v10, v17, 7, v10
  v_add_u32 v10, 151552, v10
  s_mov_b32 s8, 1
  v_mov_b32 v232, 0
  v_mov_b32 v233, 0
  v_mov_b32 v234, 0
  v_mov_b32 v235, 0
  s_getpc_b64 s[36:37]
  s_setpc_b64 s[38:39]
  s_and_b32 s23, s2, 1
  s_lshl_b32 s23, s23, 2
  s_add_u32 s23, s23, s20
  s_lshl_b32 s23, s23, 7
  s_lshr_b32 s31, s2, 1
  s_add_u32 s23, s23, s31
  s_lshl_b32 s23, s23, 2
  s_add_u32 s23, s23, 2654208
  v_mov_b32 v16, 1073741824
  v_mov_b32 v17, 1
  v_writelane_b32 v16, s23, 0
  s_waitcnt vmcnt(8)
  buffer_store_dword v17, v16, s[40:43], 0 offen sc1
  v_cmp_eq_u32 vcc, 0, v15
  s_cbranch_vccnz fa_sel_spin
fa_sel_ok:
  v_add_u32 v18, -1, v15
  v_and_b32 v18, 2047, v18
  v_lshrrev_b32 v19, 4, v18
  v_mul_u32_u24 v19, 20480, v19
  v_and_b32 v18, 15, v18
  v_lshl_add_u32 v19, v18, 4, v19
  v_lshrrev_b32 v18, 3, v1
  v_lshl_add_u32 v19, v18, 8, v19
  s_lshl_b32 s23, s20, 11
  s_lshl_b32 s31, s20, 10
  s_add_u32 s31, s31, 151552
  s_mov_b32 s14, 4
  s_mov_b32 m0, s31
  s_add_u32 s31, s31, 4096
  buffer_load_dwordx4 v19, s[40:43], s23 offen sc1 lds
  s_add_u32 s23, s23, 8192
  s_mov_b32 m0, s31
  s_add_u32 s31, s31, 4096
  buffer_load_dwordx4 v19, s[40:43], s23 offen sc1 lds
  s_add_u32 s23, s23, 8192
  s_mov_b32 m0, s31
  s_add_u32 s31, s31, 4096
  buffer_load_dwordx4 v19, s[40:43], s23 offen sc1 lds
  s_add_u32 s23, s23, 8192
fa_coG:
  s_getpc_b64 s[36:37]
  s_setpc_b64 s[38:39]
  s_waitcnt vmcnt(4)
  ds_read_b64_tr_b16 a[192:193], v9 offset:0
  ds_read_b64_tr_b16 a[194:195], v9 offset:128
  ds_read_b128 a[212:215], v10 offset:0
  ds_read_b64_tr_b16 a[196:197], v9 offset:1024
  ds_read_b64_tr_b16 a[198:199], v9 offset:1152
  ds_read_b128 a[216:219], v10 offset:512
  ds_read_b64_tr_b16 a[200:201], v9 offset:2048
  ds_read_b64_tr_b16 a[202:203], v9 offset:2176
  ds_read_b128 a[220:223], v10 offset:1024
  ds_read_b64_tr_b16 a[204:205], v9 offset:3072
  ds_read_b64_tr_b16 a[206:207], v9 offset:3200
  ds_read_b128 a[224:227], v10 offset:1536
  ds_read_b64_tr_b16 a[208:209], v9 offset:4096
  ds_read_b64_tr_b16 a[210:211], v9 offset:4224
  ds_read_b128 a[228:231], v10 offset:2048
  v_add_u32 v10, 2560, v10
  s_add_u32 s33, s33, 552960
  s_sub_u32 s14, s14, 1
  s_waitcnt lgkmcnt(12)
  v_mfma_f32_16x16x32_bf16 v[232:235], a[192:195], a[212:215], v[232:235]
  s_waitcnt lgkmcnt(9)
  v_mfma_f32_16x16x32_bf16 v[232:235], a[196:199], a[216:219], v[232:235]
  s_waitcnt lgkmcnt(6)
  v_mfma_f32_16x16x32_bf16 v[232:235], a[200:203], a[220:223], v[232:235]
  s_waitcnt lgkmcnt(3)
  v_mfma_f32_16x16x32_bf16 v[232:235], a[204:207], a[224:227], v[232:235]
  s_waitcnt lgkmcnt(0)
  v_mfma_f32_16x16x32_bf16 v[232:235], a[208:211], a[228:231], v[232:235]
  s_cmp_lg_u32 s14, 0
  s_cbranch_scc1 fa_coG
  v_accvgpr_read_b32 v8, a248
  v_accvgpr_read_b32 v11, a249
  v_accvgpr_read_b32 v12, a250
  v_accvgpr_read_b32 v13, a251
  v_accvgpr_read_b32 v14, a252
  v_subrev_u32 v11, 1024, v11
  v_subrev_u32 v12, 2048, v12
  v_subrev_u32 v13, 3072, v13
  s_mov_b32 s52, s60
  s_mov_b32 s53, s61
  s_mov_b32 s33, s35
  s_lshl_b32 s23, s20, 9
  v_add_u32 v16, s23, v10
  ds_write_b128 v16, v[232:235]
  v_and_b32 v17, 7, v1
  v_mul_u32_u24 v9, 2560, v17
  v_lshrrev_b32 v17, 4, v1
  v_lshl_add_u32 v9, v17, 4, v9
  v_and_b32 v17, 8, v1
  v_lshl_add_u32 v9, v17, 27, v9
  s_getpc_b64 s[36:37]
  s_setpc_b64 s[38:39]
  ds_read_b128 v[236:239], v10 offset:0
  ds_read_b128 v[240:243], v10 offset:512
  ds_read_b128 v[244:247], v10 offset:1024
  ds_read_b128 v[248:251], v10 offset:1536
  s_waitcnt vmcnt(4)
  ds_read_b64_tr_b16 a[192:193], v6 offset:0
  ds_read_b64_tr_b16 a[194:195], v6 offset:2560
  ds_read_b64_tr_b16 a[196:197], v6 offset:32
  ds_read_b64_tr_b16 a[198:199], v6 offset:2592
  ds_read_b64_tr_b16 a[200:201], v6 offset:64
  ds_read_b64_tr_b16 a[202:203], v6 offset:2624
  ds_read_b64_tr_b16 a[204:205], v6 offset:96
  ds_read_b64_tr_b16 a[206:207], v6 offset:2656
  ds_read_b64_tr_b16 a[208:209], v6 offset:128
  ds_read_b64_tr_b16 a[210:211], v6 offset:2688
  s_add_u32 s33, s33, 160
  s_mov_b32 s8, 0
  s_waitcnt lgkmcnt(10)
  v_cvt_pk_bf16_f32 v236, v236, v244
  v_cvt_pk_bf16_f32 v237, v237, v245
  v_cvt_pk_bf16_f32 v238, v238, v246
  v_cvt_pk_bf16_f32 v239, v239, v247
  v_cvt_pk_bf16_f32 v240, v240, v248
  v_cvt_pk_bf16_f32 v241, v241, v249
  v_cvt_pk_bf16_f32 v242, v242, v250
  v_cvt_pk_bf16_f32 v243, v243, v251
  v_lshlrev_b32 v244, 16, v236
  v_lshlrev_b32 v245, 16, v237
  v_lshlrev_b32 v246, 16, v238
  v_lshlrev_b32 v247, 16, v239
  v_lshlrev_b32 v248, 16, v240
  v_lshlrev_b32 v249, 16, v241
  v_lshlrev_b32 v250, 16, v242
  v_lshlrev_b32 v251, 16, v243
  v_mul_f32 v16, 0xbfb8aa3b, v244
  v_mul_f32 v17, 0xbfb8aa3b, v245
  v_mul_f32 v18, 0xbfb8aa3b, v246
  v_mul_f32 v19, 0xbfb8aa3b, v247
  v_mul_f32 v20, 0xbfb8aa3b, v248
  v_mul_f32 v21, 0xbfb8aa3b, v249
  v_mul_f32 v22, 0xbfb8aa3b, v250
  v_mul_f32 v23, 0xbfb8aa3b, v251
  v_exp_f32 v16, v16
  v_exp_f32 v17, v17
  v_exp_f32 v18, v18
  v_exp_f32 v19, v19
  v_exp_f32 v20, v20
  v_exp_f32 v21, v21
  v_exp_f32 v22, v22
  v_exp_f32 v23, v23
  v_add_f32 v16, 1.0, v16
  v_add_f32 v17, 1.0, v17
  v_add_f32 v18, 1.0, v18
  v_add_f32 v19, 1.0, v19
  v_add_f32 v20, 1.0, v20
  v_add_f32 v21, 1.0, v21
  v_add_f32 v22, 1.0, v22
  v_add_f32 v23, 1.0, v23
  v_rcp_f32 v16, v16
  v_rcp_f32 v17, v17
  v_rcp_f32 v18, v18
  v_rcp_f32 v19, v19
  v_rcp_f32 v20, v20
  v_rcp_f32 v21, v21
  v_rcp_f32 v22, v22
  v_rcp_f32 v23, v23
  v_mul_f32 v244, v244, v16
  v_mul_f32 v245, v245, v17
  v_mul_f32 v246, v246, v18
  v_mul_f32 v247, v247, v19
  v_mul_f32 v248, v248, v20
  v_mul_f32 v249, v249, v21
  v_mul_f32 v250, v250, v22
  v_mul_f32 v251, v251, v23
  v_cvt_pk_bf16_f32 v16, v244, v245
  v_cvt_pk_bf16_f32 v17, v246, v247
  v_cvt_pk_bf16_f32 v18, v248, v249
  v_cvt_pk_bf16_f32 v19, v250, v251
  v_and_b32 v236, 0xffff0000, v236
  v_and_b32 v237, 0xffff0000, v237
  v_and_b32 v238, 0xffff0000, v238
  v_and_b32 v239, 0xffff0000, v239
  v_and_b32 v240, 0xffff0000, v240
  v_and_b32 v241, 0xffff0000, v241
  v_and_b32 v242, 0xffff0000, v242
  v_and_b32 v243, 0xffff0000, v243
  v_lshlrev_b32 v244, 16, v16
  v_and_b32 v245, 0xffff0000, v16
  v_lshlrev_b32 v246, 16, v17
  v_and_b32 v247, 0xffff0000, v17
  v_lshlrev_b32 v248, 16, v18
  v_and_b32 v249, 0xffff0000, v18
  v_lshlrev_b32 v250, 16, v19
  v_and_b32 v251, 0xffff0000, v19
  v_mul_f32 v236, v236, v244
  v_mul_f32 v237, v237, v245
  v_mul_f32 v238, v238, v246
  v_mul_f32 v239, v239, v247
  v_mul_f32 v240, v240, v248
  v_mul_f32 v241, v241, v249
  v_mul_f32 v242, v242, v250
  v_mul_f32 v243, v243, v251
  v_cvt_pk_bf16_f32 v232, v236, v237
  v_cvt_pk_bf16_f32 v233, v238, v239
  v_cvt_pk_bf16_f32 v234, v240, v241
  v_cvt_pk_bf16_f32 v235, v242, v243
  s_nop 0
  s_waitcnt lgkmcnt(0)
  v_mfma_f32_16x16x32_bf16 v[236:239], a[192:195], v[232:235], 0
  v_mfma_f32_16x16x32_bf16 v[240:243], a[196:199], v[232:235], 0
  v_mfma_f32_16x16x32_bf16 v[244:247], a[200:203], v[232:235], 0
  v_mfma_f32_16x16x32_bf16 v[248:251], a[204:207], v[232:235], 0
  v_mfma_f32_16x16x32_bf16 v[252:255], a[208:211], v[232:235], 0
  s_nop 3
  buffer_store_dwordx4 v[236:239], v9, s[40:43], s10 offen offset:0 sc1
  buffer_store_dwordx4 v[240:243], v9, s[40:43], s10 offen offset:64 sc1
  buffer_store_dwordx4 v[244:247], v9, s[40:43], s10 offen offset:128 sc1
  buffer_store_dwordx4 v[248:251], v9, s[40:43], s10 offen offset:192 sc1
  buffer_store_dwordx4 v[252:255], v9, s[40:43], s10 offen offset:256 sc1
  s_add_u32 s10, s10, 320
  s_getpc_b64 s[36:37]
  s_setpc_b64 s[38:39]
  s_waitcnt vmcnt(4)
  ds_read_b64_tr_b16 a[192:193], v6 offset:0
  ds_read_b64_tr_b16 a[194:195], v6 offset:2560
  ds_read_b64_tr_b16 a[196:197], v6 offset:32
  ds_read_b64_tr_b16 a[198:199], v6 offset:2592
  ds_read_b64_tr_b16 a[200:201], v6 offset:64
  ds_read_b64_tr_b16 a[202:203], v6 offset:2624
  ds_read_b64_tr_b16 a[204:205], v6 offset:96
  ds_read_b64_tr_b16 a[206:207], v6 offset:2656
  ds_read_b64_tr_b16 a[208:209], v6 offset:128
  ds_read_b64_tr_b16 a[210:211], v6 offset:2688
  s_waitcnt lgkmcnt(0)
  v_mfma_f32_16x16x32_bf16 v[236:239], a[192:195], v[232:235], 0
  v_mfma_f32_16x16x32_bf16 v[240:243], a[196:199], v[232:235], 0
  v_mfma_f32_16x16x32_bf16 v[244:247], a[200:203], v[232:235], 0
  v_mfma_f32_16x16x32_bf16 v[248:251], a[204:207], v[232:235], 0
  v_mfma_f32_16x16x32_bf16 v[252:255], a[208:211], v[232:235], 0
  s_nop 3
  buffer_store_dwordx4 v[236:239], v9, s[40:43], s10 offen offset:0 sc1
  buffer_store_dwordx4 v[240:243], v9, s[40:43], s10 offen offset:64 sc1
  buffer_store_dwordx4 v[244:247], v9, s[40:43], s10 offen offset:128 sc1
  buffer_store_dwordx4 v[248:251], v9, s[40:43], s10 offen offset:192 sc1
  buffer_store_dwordx4 v[252:255], v9, s[40:43], s10 offen offset:256 sc1
  s_add_u32 s10, s10, 320
  s_getpc_b64 s[36:37]
  s_setpc_b64 s[38:39]
  s_sub_u32 s23, s2, 170
  s_lshl_b32 s31, s20, 6
  s_add_u32 s23, s23, s31
  s_lshl_b32 s23, s23, 2
  s_add_u32 s23, s23, 2650112
  v_mov_b32 v16, 1073741824
  v_mov_b32 v17, 1
  v_writelane_b32 v16, s23, 0
  s_waitcnt vmcnt(8)
  buffer_store_dword v17, v16, s[40:43], 0 offen sc1
fa_coW:
  s_mov_b32 s12, 1
  s_mov_b32 s9, -1
  s_cmp_lg_u32 s11, 0
  s_cselect_b32 s32, s15, -1
  s_getpc_b64 s[36:37]
  s_setpc_b64 s[38:39]
  s_lshl_b32 s23, s22, 2
  s_add_u32 s23, s23, s20
  s_mul_i32 s13, s23, 163840
  s_add_u32 s13, s13, 4194304
  s_lshl_b32 s23, s23, 7
  s_add_u32 s23, s23, 2654208
  v_and_b32 v9, 31, v1
  v_lshl_add_u32 v9, v9, 2, s23
  v_and_b32 v10, 15, v1
  v_lshlrev_b32 v10, 2, v10
  v_add_u32 v10, 2629632, v10
  buffer_load_dword v8, v9, s[40:43], 0 offen sc1
  buffer_load_dword v15, v10, s[40:43], 0 offen sc1
  v_mov_b32 v20, v228
  v_mov_b32 v21, v229
  s_nop 1
  v_permlane16_swap_b32 v228, v20
  v_permlane16_swap_b32 v229, v21
  v_add_f32 v228, v228, v20
  v_add_f32 v229, v229, v21
  v_mov_b32 v20, v228
  v_mov_b32 v21, v229
  s_nop 1
  v_permlane32_swap_b32 v228, v20
  v_permlane32_swap_b32 v229, v21
  v_add_f32 v228, v228, v20
  v_add_f32 v229, v229, v21
  v_rcp_f32 v16, v228
  v_rcp_f32 v18, v229
  s_lshl_b32 s23, s22, 2
  v_mov_b32 v17, v16
  v_mov_b32 v19, v18
  s_add_u32 s23, s23, s20
  s_lshl_b32 s23, s23, 18
  s_lshl_b32 s31, s21, 12
  s_add_u32 s31, s31, 50331648
  s_add_u32 s64, s23, s31
  s_add_u32 s65, s64, 131072
  v_accvgpr_read_b32 v36, a0
  v_accvgpr_read_b32 v37, a1
  v_accvgpr_read_b32 v38, a2
  v_accvgpr_read_b32 v39, a3
  v_accvgpr_read_b32 v40, a8
  v_accvgpr_read_b32 v41, a9
  v_accvgpr_read_b32 v42, a10
  v_accvgpr_read_b32 v43, a11
  v_pk_mul_f32 v[36:37], v[36:37], v[16:17]
  v_pk_mul_f32 v[38:39], v[38:39], v[16:17]
  v_pk_mul_f32 v[40:41], v[40:41], v[16:17]
  v_pk_mul_f32 v[42:43], v[42:43], v[16:17]
  v_cvt_pk_bf16_f32 v32, v36, v37
  v_cvt_pk_bf16_f32 v33, v38, v39
  v_cvt_pk_bf16_f32 v34, v40, v41
  v_cvt_pk_bf16_f32 v35, v42, v43
  buffer_store_dwordx4 v[32:35], v2, s[40:43], s64 offen offset:0 sc1
  v_accvgpr_read_b32 v48, a16
  v_accvgpr_read_b32 v49, a17
  v_accvgpr_read_b32 v50, a18
  v_accvgpr_read_b32 v51, a19
  v_accvgpr_read_b32 v52, a24
  v_accvgpr_read_b32 v53, a25
  v_accvgpr_read_b32 v54, a26
  v_accvgpr_read_b32 v55, a27
  v_pk_mul_f32 v[48:49], v[48:49], v[16:17]
  v_pk_mul_f32 v[50:51], v[50:51], v[16:17]
  v_pk_mul_f32 v[52:53], v[52:53], v[16:17]
  v_pk_mul_f32 v[54:55], v[54:55], v[16:17]
  v_cvt_pk_bf16_f32 v44, v48, v49
  v_cvt_pk_bf16_f32 v45, v50, v51
  v_cvt_pk_bf16_f32 v46, v52, v53
  v_cvt_pk_bf16_f32 v47, v54, v55
  buffer_store_dwordx4 v[44:47], v2, s[40:43], s64 offen offset:1024 sc1
  v_accvgpr_read_b32 v100, a32
  v_accvgpr_read_b32 v101, a33
  v_accvgpr_read_b32 v102, a34
  v_accvgpr_read_b32 v103, a35
  v_accvgpr_read_b32 v104, a40
  v_accvgpr_read_b32 v105, a41
  v_accvgpr_read_b32 v106, a42
  v_accvgpr_read_b32 v107, a43
  v_pk_mul_f32 v[100:101], v[100:101], v[16:17]
  v_pk_mul_f32 v[102:103], v[102:103], v[16:17]
  v_pk_mul_f32 v[104:105], v[104:105], v[16:17]
  v_pk_mul_f32 v[106:107], v[106:107], v[16:17]
  v_cvt_pk_bf16_f32 v96, v100, v101
  v_cvt_pk_bf16_f32 v97, v102, v103
  v_cvt_pk_bf16_f32 v98, v104, v105
  v_cvt_pk_bf16_f32 v99, v106, v107
  buffer_store_dwordx4 v[96:99], v2, s[40:43], s64 offen offset:2048 sc1
  v_accvgpr_read_b32 v112, a48
  v_accvgpr_read_b32 v113, a49
  v_accvgpr_read_b32 v114, a50
  v_accvgpr_read_b32 v115, a51
  v_accvgpr_read_b32 v116, a56
  v_accvgpr_read_b32 v117, a57
  v_accvgpr_read_b32 v118, a58
  v_accvgpr_read_b32 v119, a59
  v_pk_mul_f32 v[112:113], v[112:113], v[16:17]
  v_pk_mul_f32 v[114:115], v[114:115], v[16:17]
  v_pk_mul_f32 v[116:117], v[116:117], v[16:17]
  v_pk_mul_f32 v[118:119], v[118:119], v[16:17]
  v_cvt_pk_bf16_f32 v108, v112, v113
  v_cvt_pk_bf16_f32 v109, v114, v115
  v_cvt_pk_bf16_f32 v110, v116, v117
  v_cvt_pk_bf16_f32 v111, v118, v119
  buffer_store_dwordx4 v[108:111], v2, s[40:43], s64 offen offset:3072 sc1
  v_accvgpr_read_b32 v36, a4
  v_accvgpr_read_b32 v37, a5
  v_accvgpr_read_b32 v38, a6
  v_accvgpr_read_b32 v39, a7
  v_accvgpr_read_b32 v40, a12
  v_accvgpr_read_b32 v41, a13
  v_accvgpr_read_b32 v42, a14
  v_accvgpr_read_b32 v43, a15
  v_pk_mul_f32 v[36:37], v[36:37], v[18:19]
  v_pk_mul_f32 v[38:39], v[38:39], v[18:19]
  v_pk_mul_f32 v[40:41], v[40:41], v[18:19]
  v_pk_mul_f32 v[42:43], v[42:43], v[18:19]
  v_cvt_pk_bf16_f32 v32, v36, v37
  v_cvt_pk_bf16_f32 v33, v38, v39
  v_cvt_pk_bf16_f32 v34, v40, v41
  v_cvt_pk_bf16_f32 v35, v42, v43
  buffer_store_dwordx4 v[32:35], v2, s[40:43], s65 offen offset:0 sc1
  v_accvgpr_read_b32 v48, a20
  v_accvgpr_read_b32 v49, a21
  v_accvgpr_read_b32 v50, a22
  v_accvgpr_read_b32 v51, a23
  v_accvgpr_read_b32 v52, a28
  v_accvgpr_read_b32 v53, a29
  v_accvgpr_read_b32 v54, a30
  v_accvgpr_read_b32 v55, a31
  v_pk_mul_f32 v[48:49], v[48:49], v[18:19]
  v_pk_mul_f32 v[50:51], v[50:51], v[18:19]
  v_pk_mul_f32 v[52:53], v[52:53], v[18:19]
  v_pk_mul_f32 v[54:55], v[54:55], v[18:19]
  v_cvt_pk_bf16_f32 v44, v48, v49
  v_cvt_pk_bf16_f32 v45, v50, v51
  v_cvt_pk_bf16_f32 v46, v52, v53
  v_cvt_pk_bf16_f32 v47, v54, v55
  buffer_store_dwordx4 v[44:47], v2, s[40:43], s65 offen offset:1024 sc1
  v_accvgpr_read_b32 v100, a36
  v_accvgpr_read_b32 v101, a37
  v_accvgpr_read_b32 v102, a38
  v_accvgpr_read_b32 v103, a39
  v_accvgpr_read_b32 v104, a44
  v_accvgpr_read_b32 v105, a45
  v_accvgpr_read_b32 v106, a46
  v_accvgpr_read_b32 v107, a47
  v_pk_mul_f32 v[100:101], v[100:101], v[18:19]
  v_pk_mul_f32 v[102:103], v[102:103], v[18:19]
  v_pk_mul_f32 v[104:105], v[104:105], v[18:19]
  v_pk_mul_f32 v[106:107], v[106:107], v[18:19]
  v_cvt_pk_bf16_f32 v96, v100, v101
  v_cvt_pk_bf16_f32 v97, v102, v103
  v_cvt_pk_bf16_f32 v98, v104, v105
  v_cvt_pk_bf16_f32 v99, v106, v107
  buffer_store_dwordx4 v[96:99], v2, s[40:43], s65 offen offset:2048 sc1
  v_accvgpr_read_b32 v112, a52
  v_accvgpr_read_b32 v113, a53
  v_accvgpr_read_b32 v114, a54
  v_accvgpr_read_b32 v115, a55
  v_accvgpr_read_b32 v116, a60
  v_accvgpr_read_b32 v117, a61
  v_accvgpr_read_b32 v118, a62
  v_accvgpr_read_b32 v119, a63
  v_pk_mul_f32 v[112:113], v[112:113], v[18:19]
  v_pk_mul_f32 v[114:115], v[114:115], v[18:19]
  v_pk_mul_f32 v[116:117], v[116:117], v[18:19]
  v_pk_mul_f32 v[118:119], v[118:119], v[18:19]
  v_cvt_pk_bf16_f32 v108, v112, v113
  v_cvt_pk_bf16_f32 v109, v114, v115
  v_cvt_pk_bf16_f32 v110, v116, v117
  v_cvt_pk_bf16_f32 v111, v118, v119
  buffer_store_dwordx4 v[108:111], v2, s[40:43], s65 offen offset:3072 sc1
  s_waitcnt vmcnt(8)
  v_cmp_eq_u32 vcc, 0, v8
  s_cbranch_vccnz fa_wof_spin
fa_wof_ok:
  v_cmp_eq_u32 vcc, 0, v15
  s_cbranch_vccnz fa_sel4_spin
fa_sel4_ok:
  s_lshl_b32 s23, s20, 1
  s_add_u32 s31, s23, 1
  v_readlane_b32 s33, v15, s23
  v_readlane_b32 s35, v15, s31
  s_lshl_b32 s31, s21, 6
  s_add_u32 s31, s31, 1
  s_sub_u32 s33, s33, s31
  s_sub_u32 s35, s35, s31
  s_cmp_lt_u32 s33, 64
  s_cselect_b32 s10, 1, 0
  s_cmp_lt_u32 s35, 64
  s_cselect_b32 s31, 2, 0
  s_or_b32 s10, s10, s31
  s_cbranch_scc0 fa_coEnd
  v_min_u32 v11, 53, v1
  s_lshr_b32 s23, s22, 1
  s_lshl_b32 s23, s23, 8
  s_add_u32 s23, s23, 2650112
  v_lshl_add_u32 v11, v11, 2, s23
  buffer_load_dword v14, v11, s[40:43], 0 offen sc1
  v_mul_u32_u24 v16, 3277, v1
  v_lshrrev_b32 v16, 16, v16
  v_mul_u32_u24 v8, 20, v16
  v_sub_u32 v8, v1, v8
  v_lshlrev_b32 v8, 4, v8
  v_mul_u32_u24 v9, 368640, v16
  v_add_u32 v9, v9, v8
  v_cmp_gt_u32 vcc, 3, v16
  v_mov_b32 v19, 1073741824
  s_nop 0
  v_cndmask_b32 v9, v19, v9, vcc
  s_mov_b32 s12, 2
  s_mov_b32 s32, -1
  s_mov_b32 s11, 0
  s_getpc_b64 s[36:37]
  s_setpc_b64 s[38:39]
  v_cmp_eq_u32 vcc, 0, v14
  s_cbranch_vccnz fa_yf_spin
fa_yf_ok:
fa_coY:
  s_ff1_i32_b32 s33, s10
  s_bitset0_b32 s10, s33
  s_lshl_b32 s23, s20, 1
  s_add_u32 s33, s33, s23
  s_mul_i32 s14, s33, 2560
  s_mul_i32 s23, s22, 320
  s_add_u32 s14, s14, s23
  s_add_u32 s14, s14, 2686976
  buffer_load_dwordx4 v[64:67], v9, s[40:43], s14 offen sc1
  s_add_u32 s14, s14, 20480
  buffer_load_dwordx4 v[68:71], v9, s[40:43], s14 offen sc1
  s_add_u32 s14, s14, 20480
  buffer_load_dwordx4 v[72:75], v9, s[40:43], s14 offen sc1
  s_add_u32 s14, s14, 20480
  buffer_load_dwordx4 v[76:79], v9, s[40:43], s14 offen sc1
  s_add_u32 s14, s14, 20480
  buffer_load_dwordx4 v[80:83], v9, s[40:43], s14 offen sc1
  s_add_u32 s14, s14, 20480
  buffer_load_dwordx4 v[84:87], v9, s[40:43], s14 offen sc1
  s_add_u32 s14, s14, 20480
  buffer_load_dwordx4 v[88:91], v9, s[40:43], s14 offen sc1
  s_add_u32 s14, s14, 20480
  buffer_load_dwordx4 v[92:95], v9, s[40:43], s14 offen sc1
  s_add_u32 s14, s14, 20480
  buffer_load_dwordx4 v[128:131], v9, s[40:43], s14 offen sc1
  s_add_u32 s14, s14, 20480
  buffer_load_dwordx4 v[132:135], v9, s[40:43], s14 offen sc1
  s_add_u32 s14, s14, 20480
  buffer_load_dwordx4 v[136:139], v9, s[40:43], s14 offen sc1
  s_add_u32 s14, s14, 20480
  buffer_load_dwordx4 v[140:143], v9, s[40:43], s14 offen sc1
  s_add_u32 s14, s14, 20480
  buffer_load_dwordx4 v[144:147], v9, s[40:43], s14 offen sc1
  s_add_u32 s14, s14, 20480
  buffer_load_dwordx4 v[148:151], v9, s[40:43], s14 offen sc1
  s_add_u32 s14, s14, 20480
  buffer_load_dwordx4 v[152:155], v9, s[40:43], s14 offen sc1
  s_add_u32 s14, s14, 20480
  buffer_load_dwordx4 v[156:159], v9, s[40:43], s14 offen sc1
  s_add_u32 s14, s14, 20480
  buffer_load_dwordx4 v[176:179], v9, s[40:43], s14 offen sc1
  s_add_u32 s14, s14, 20480
  buffer_load_dwordx4 v[180:183], v9, s[40:43], s14 offen sc1
  s_add_u32 s14, s14, 20480
  s_cmp_eq_u32 s11, 0
  s_cbranch_scc1 fa_coY1
  s_waitcnt vmcnt(0)
  s_branch fa_coY2
fa_coY1:
  s_mov_b32 s11, 1
  s_getpc_b64 s[36:37]
  s_setpc_b64 s[38:39]
fa_coY2:
  s_lshl_b32 s14, s20, 10
  s_add_u32 s14, s14, 159744
  v_add_u32 v19, s14, v2
  s_add_u32 s23, s33, 8
  v_readlane_b32 s35, v15, s23
  s_waitcnt vmcnt(1)
  v_pk_add_f32 v[64:65], v[64:65], v[68:69]
  v_pk_add_f32 v[66:67], v[66:67], v[70:71]
  v_pk_add_f32 v[64:65], v[64:65], v[72:73]
  v_pk_add_f32 v[66:67], v[66:67], v[74:75]
  v_pk_add_f32 v[64:65], v[64:65], v[76:77]
  v_pk_add_f32 v[66:67], v[66:67], v[78:79]
  v_pk_add_f32 v[64:65], v[64:65], v[80:81]
  v_pk_add_f32 v[66:67], v[66:67], v[82:83]
  v_pk_add_f32 v[64:65], v[64:65], v[84:85]
  v_pk_add_f32 v[66:67], v[66:67], v[86:87]
  v_pk_add_f32 v[64:65], v[64:65], v[88:89]
  v_pk_add_f32 v[66:67], v[66:67], v[90:91]
  v_pk_add_f32 v[64:65], v[64:65], v[92:93]
  v_pk_add_f32 v[66:67], v[66:67], v[94:95]
  v_pk_add_f32 v[64:65], v[64:65], v[128:129]
  v_pk_add_f32 v[66:67], v[66:67], v[130:131]
  v_pk_add_f32 v[64:65], v[64:65], v[132:133]
  v_pk_add_f32 v[66:67], v[66:67], v[134:135]
  v_pk_add_f32 v[64:65], v[64:65], v[136:137]
  v_pk_add_f32 v[66:67], v[66:67], v[138:139]
  v_pk_add_f32 v[64:65], v[64:65], v[140:141]
  v_pk_add_f32 v[66:67], v[66:67], v[142:143]
  v_pk_add_f32 v[64:65], v[64:65], v[144:145]
  v_pk_add_f32 v[66:67], v[66:67], v[146:147]
  v_pk_add_f32 v[64:65], v[64:65], v[148:149]
  v_pk_add_f32 v[66:67], v[66:67], v[150:151]
  v_pk_add_f32 v[64:65], v[64:65], v[152:153]
  v_pk_add_f32 v[66:67], v[66:67], v[154:155]
  v_pk_add_f32 v[64:65], v[64:65], v[156:157]
  v_pk_add_f32 v[66:67], v[66:67], v[158:159]
  v_pk_add_f32 v[64:65], v[64:65], v[176:177]
  v_pk_add_f32 v[66:67], v[66:67], v[178:179]
  v_pk_add_f32 v[64:65], v[64:65], v[180:181]
  v_pk_add_f32 v[66:67], v[66:67], v[182:183]
  ds_write_b128 v19, v[64:67]
  v_add_u32 v19, s14, v8
  s_and_b32 s35, s35, 0xffff0000
  s_waitcnt lgkmcnt(0)
  ds_read_b128 v[64:67], v19
  ds_read_b128 v[68:71], v19 offset:320
  ds_read_b128 v[72:75], v19 offset:640
  s_mul_i32 s14, s33, 320
  s_add_u32 s14, s14, 155648
  v_add_u32 v19, s14, v8
  s_waitcnt lgkmcnt(0)
  v_add_f32 v64, v64, v68
  v_add_f32 v64, v64, v72
  v_cvt_pk_bf16_f32 v64, v64, v64
  v_and_b32 v64, 0xffff0000, v64
  v_mul_f32 v64, s35, v64
  v_cvt_pk_bf16_f32 v64, v64, v64
  v_and_b32 v64, 0xffff0000, v64
  v_add_f32 v65, v65, v69
  v_add_f32 v65, v65, v73
  v_cvt_pk_bf16_f32 v65, v65, v65
  v_and_b32 v65, 0xffff0000, v65
  v_mul_f32 v65, s35, v65
  v_cvt_pk_bf16_f32 v65, v65, v65
  v_and_b32 v65, 0xffff0000, v65
  v_add_f32 v66, v66, v70
  v_add_f32 v66, v66, v74
  v_cvt_pk_bf16_f32 v66, v66, v66
  v_and_b32 v66, 0xffff0000, v66
  v_mul_f32 v66, s35, v66
  v_cvt_pk_bf16_f32 v66, v66, v66
  v_and_b32 v66, 0xffff0000, v66
  v_add_f32 v67, v67, v71
  v_add_f32 v67, v67, v75
  v_cvt_pk_bf16_f32 v67, v67, v67
  v_and_b32 v67, 0xffff0000, v67
  v_mul_f32 v67, s35, v67
  v_cvt_pk_bf16_f32 v67, v67, v67
  v_and_b32 v67, 0xffff0000, v67
  ds_write_b128 v19, v[64:67]
  s_waitcnt lgkmcnt(0)
  s_cmp_lg_u32 s10, 0
  s_cbranch_scc1 fa_coY
fa_coEnd:
  s_mov_b32 s12, 3
  s_mov_b32 s32, -1
  s_setpc_b64 s[38:39]
fa_hk7:
  s_getpc_b64 s[38:39]
fa_hp7:
  s_add_u32 s36, s36, 4
  s_addc_u32 s37, s37, 0
  s_sub_u32 s38, s38, fa_hp7-fa_hb7
  s_subb_u32 s39, s39, 0
  s_setpc_b64 s[36:37]
fa_hk8:
  s_getpc_b64 s[38:39]
fa_hp8:
  s_add_u32 s36, s36, 4
  s_addc_u32 s37, s37, 0
  s_sub_u32 s38, s38, fa_hp8-fa_hb8
  s_subb_u32 s39, s39, 0
  s_setpc_b64 s[36:37]
fa_disp:
  s_cmp_eq_u32 s29, 7
  s_cbranch_scc1 fa_SSW7
  s_cmp_eq_u32 s29, 6
  s_cbranch_scc1 fa_SSW6
  s_cmp_eq_u32 s29, 5
  s_cbranch_scc1 fa_SSW5
  s_cmp_eq_u32 s29, 4
  s_cbranch_scc1 fa_SSW4
  s_cmp_eq_u32 s29, 3
  s_cbranch_scc1 fa_SSW3
  s_cmp_eq_u32 s29, 2
  s_cbranch_scc1 fa_SSW2
  s_cmp_eq_u32 s29, 1
  s_cbranch_scc1 fa_SSW1
  s_branch fa_Bexit
fa_hk9:
  s_getpc_b64 s[38:39]
fa_hp9:
  s_add_u32 s36, s36, 4
  s_addc_u32 s37, s37, 0
  s_sub_u32 s38, s38, fa_hp9-fa_hb9
  s_subb_u32 s39, s39, 0
  s_setpc_b64 s[36:37]
fa_hk10:
  s_getpc_b64 s[38:39]
fa_hp10:
  s_add_u32 s36, s36, 4
  s_addc_u32 s37, s37, 0
  s_sub_u32 s38, s38, fa_hp10-fa_hb10
  s_subb_u32 s39, s39, 0
  s_setpc_b64 s[36:37]
fa_left:
  s_add_u32 s14, s13, 0
  buffer_load_dwordx4 a[0:3], v2, s[40:43], s14 offen offset:0 sc1
  buffer_load_dwordx4 a[4:7], v2, s[40:43], s14 offen offset:1024 sc1
  buffer_load_dwordx4 a[8:11], v2, s[40:43], s14 offen offset:2048 sc1
  buffer_load_dwordx4 a[12:15], v2, s[40:43], s14 offen offset:3072 sc1
  s_add_u32 s14, s13, 4096
  buffer_load_dwordx4 a[16:19], v2, s[40:43], s14 offen offset:0 sc1
  buffer_load_dwordx4 a[20:23], v2, s[40:43], s14 offen offset:1024 sc1
  s_cmp_ge_u32 s29, 7
  s_cbranch_scc1 fa_leftb
  s_add_u32 s14, s13, 4096
  buffer_load_dwordx4 a[24:27], v2, s[40:43], s14 offen offset:2048 sc1
  buffer_load_dwordx4 a[28:31], v2, s[40:43], s14 offen offset:3072 sc1
  s_add_u32 s14, s13, 8192
  buffer_load_dwordx4 a[32:35], v2, s[40:43], s14 offen offset:0 sc1
  buffer_load_dwordx4 a[36:39], v2, s[40:43], s14 offen offset:1024 sc1
  buffer_load_dwordx4 a[40:43], v2, s[40:43], s14 offen offset:2048 sc1
  buffer_load_dwordx4 a[44:47], v2, s[40:43], s14 offen offset:3072 sc1
  s_cmp_ge_u32 s29, 6
  s_cbranch_scc1 fa_leftb
  s_add_u32 s14, s13, 12288
  buffer_load_dwordx4 a[48:51], v2, s[40:43], s14 offen offset:0 sc1
  buffer_load_dwordx4 a[52:55], v2, s[40:43], s14 offen offset:1024 sc1
  buffer_load_dwordx4 a[56:59], v2, s[40:43], s14 offen offset:2048 sc1
  buffer_load_dwordx4 a[60:63], v2, s[40:43], s14 offen offset:3072 sc1
  s_add_u32 s14, s13, 16384
  buffer_load_dwordx4 a[192:195], v2, s[40:43], s14 offen offset:0 sc1
  buffer_load_dwordx4 a[196:199], v2, s[40:43], s14 offen offset:1024 sc1
  s_cmp_ge_u32 s29, 5
  s_cbranch_scc1 fa_leftb
  s_add_u32 s14, s13, 16384
  buffer_load_dwordx4 a[200:203], v2, s[40:43], s14 offen offset:2048 sc1
  buffer_load_dwordx4 a[204:207], v2, s[40:43], s14 offen offset:3072 sc1
  s_add_u32 s14, s13, 20480
  buffer_load_dwordx4 a[208:211], v2, s[40:43], s14 offen offset:0 sc1
  buffer_load_dwordx4 a[212:215], v2, s[40:43], s14 offen offset:1024 sc1
  buffer_load_dwordx4 a[216:219], v2, s[40:43], s14 offen offset:2048 sc1
  buffer_load_dwordx4 a[220:223], v2, s[40:43], s14 offen offset:3072 sc1
  s_cmp_ge_u32 s29, 4
  s_cbranch_scc1 fa_leftb
  s_add_u32 s14, s13, 24576
  buffer_load_dwordx4 a[224:227], v2, s[40:43], s14 offen offset:0 sc1
  buffer_load_dwordx4 a[228:231], v2, s[40:43], s14 offen offset:1024 sc1
  buffer_load_dwordx4 a[232:235], v2, s[40:43], s14 offen offset:2048 sc1
  buffer_load_dwordx4 a[236:239], v2, s[40:43], s14 offen offset:3072 sc1
  s_add_u32 s14, s13, 28672
  buffer_load_dwordx4 a[240:243], v2, s[40:43], s14 offen offset:0 sc1
  buffer_load_dwordx4 a[244:247], v2, s[40:43], s14 offen offset:1024 sc1
  s_cmp_ge_u32 s29, 3
  s_cbranch_scc1 fa_leftb
  s_add_u32 s14, s13, 28672
  buffer_load_dwordx4 a[248:251], v2, s[40:43], s14 offen offset:2048 sc1
  buffer_load_dwordx4 a[252:255], v2, s[40:43], s14 offen offset:3072 sc1
  s_add_u32 s14, s13, 32768
  buffer_load_dwordx4 v[32:35], v2, s[40:43], s14 offen offset:0 sc1
  buffer_load_dwordx4 v[36:39], v2, s[40:43], s14 offen offset:1024 sc1
  buffer_load_dwordx4 v[40:43], v2, s[40:43], s14 offen offset:2048 sc1
  buffer_load_dwordx4 v[44:47], v2, s[40:43], s14 offen offset:3072 sc1
  s_cmp_ge_u32 s29, 2
  s_cbranch_scc1 fa_leftb
  s_add_u32 s14, s13, 36864
  buffer_load_dwordx4 v[48:51], v2, s[40:43], s14 offen offset:0 sc1
  buffer_load_dwordx4 v[52:55], v2, s[40:43], s14 offen offset:1024 sc1
  buffer_load_dwordx4 v[56:59], v2, s[40:43], s14 offen offset:2048 sc1
  buffer_load_dwordx4 v[60:63], v2, s[40:43], s14 offen offset:3072 sc1
  s_add_u32 s14, s13, 40960
  buffer_load_dwordx4 v[96:99], v2, s[40:43], s14 offen offset:0 sc1
  buffer_load_dwordx4 v[100:103], v2, s[40:43], s14 offen offset:1024 sc1
  s_cmp_ge_u32 s29, 1
  s_cbranch_scc1 fa_leftb
  s_add_u32 s14, s13, 40960
  buffer_load_dwordx4 v[104:107], v2, s[40:43], s14 offen offset:2048 sc1
  buffer_load_dwordx4 v[108:111], v2, s[40:43], s14 offen offset:3072 sc1
  s_add_u32 s14, s13, 45056
  buffer_load_dwordx4 v[112:115], v2, s[40:43], s14 offen offset:0 sc1
  buffer_load_dwordx4 v[116:119], v2, s[40:43], s14 offen offset:1024 sc1
  buffer_load_dwordx4 v[120:123], v2, s[40:43], s14 offen offset:2048 sc1
  buffer_load_dwordx4 v[124:127], v2, s[40:43], s14 offen offset:3072 sc1
  s_branch fa_leftb
fa_ctx_spin:
  s_mov_b32 s83, 200000
fa_ctx_spin2:
  buffer_load_dword v13, v12, s[40:43], 0 offen sc1
  s_waitcnt vmcnt(0)
  v_cmp_eq_u32 vcc, 0, v13
  s_cbranch_vccz fa_ctx_ok
  s_sleep 8
  s_sub_u32 s83, s83, 1
  s_cmp_lg_u32 s83, 0
  s_cbranch_scc1 fa_ctx_spin2
  s_branch fa_ctx_ok
fa_stub0:
  s_call_b64 s[76:77], fa_rare00
  s_call_b64 s[76:77], fa_rare10
  s_branch fa_back0
fa_stub1:
  s_call_b64 s[76:77], fa_rare01
  s_call_b64 s[76:77], fa_rare11
  s_branch fa_back1
fa_stub2:
  s_call_b64 s[76:77], fa_rare00
  s_call_b64 s[76:77], fa_rare10
  s_branch fa_back2
fa_stub3:
  s_call_b64 s[76:77], fa_rare01
  s_call_b64 s[76:77], fa_rare11
  s_branch fa_back3
fa_stub4:
  s_call_b64 s[76:77], fa_rare01
  s_call_b64 s[76:77], fa_rare11
  s_branch fa_back4
fa_stub5:
  s_call_b64 s[76:77], fa_rare00
  s_call_b64 s[76:77], fa_rare10
  s_branch fa_back5
fa_stub6:
  s_call_b64 s[76:77], fa_rare11
  s_branch fa_back6
fa_stub7:
  s_call_b64 s[76:77], fa_rare10
  s_branch fa_back7
fa_stub8:
  s_call_b64 s[76:77], fa_rare01
  s_call_b64 s[76:77], fa_rare11
  s_branch fa_back8
fa_stub9:
  s_call_b64 s[76:77], fa_rare10
  s_branch fa_back9
fa_stub10:
  s_call_b64 s[76:77], fa_rare11
  s_branch fa_back10
fa_stub11:
  s_call_b64 s[76:77], fa_rare10
  s_branch fa_back11
fa_stub12:
  s_call_b64 s[76:77], fa_rare11
  s_branch fa_back12
fa_stub13:
  s_call_b64 s[76:77], fa_rare10
  s_branch fa_back13
fa_stub14:
  s_call_b64 s[76:77], fa_rare11
  s_branch fa_back14
fa_stub15:
  s_call_b64 s[76:77], fa_rare10
  s_branch fa_back15
fa_stub16:
  s_call_b64 s[76:77], fa_rare11
  s_branch fa_back16
fa_stub17:
  s_call_b64 s[76:77], fa_rare10
  s_branch fa_back17
fa_stub18:
  s_call_b64 s[76:77], fa_rare11
  s_branch fa_back18
fa_stub19:
  s_call_b64 s[76:77], fa_rare10
  s_branch fa_back19
fa_stub20:
  s_call_b64 s[76:77], fa_rare11
  s_branch fa_back20
fa_stub21:
  s_call_b64 s[76:77], fa_rare10
  s_branch fa_back21
fa_stub22:
  s_call_b64 s[76:77], fa_rare11
  s_branch fa_back22
fa_stub23:
  s_call_b64 s[76:77], fa_rare10
  s_branch fa_back23
fa_stub24:
  s_call_b64 s[76:77], fa_rare11
  s_branch fa_back24
fa_stub25:
  s_call_b64 s[76:77], fa_rare10
  s_branch fa_back25
fa_stub26:
  s_call_b64 s[76:77], fa_rare11
  s_branch fa_back26
fa_stub27:
  s_call_b64 s[76:77], fa_rare10
  s_branch fa_back27
fa_stub28:
  s_call_b64 s[76:77], fa_rare11
  s_branch fa_back28
fa_stub29:
  s_call_b64 s[76:77], fa_rare10
  s_branch fa_back29
fa_stub30:
  s_call_b64 s[76:77], fa_rare11
  s_branch fa_back30
fa_codeend:
fa_rare00:
  s_nop 7
  v_max3_f32 v16, v96, v97, v98
  v_max3_f32 v16, v16, v99, v100
  v_max3_f32 v16, v16, v101, v102
  v_max3_f32 v16, v16, v103, 0
  v_mov_b32 v18, v16
  s_nop 1
  v_permlane16_swap_b32 v16, v18
  v_max_f32 v16, v16, v18
  v_mov_b32 v18, v16
  s_nop 1
  v_permlane32_swap_b32 v16, v18
  v_max_f32 v16, v16, v18
  v_sub_f32 v96, v96, v16
  v_sub_f32 v112, v112, v16
  v_sub_f32 v97, v97, v16
  v_sub_f32 v113, v113, v16
  v_sub_f32 v98, v98, v16
  v_sub_f32 v114, v114, v16
  v_sub_f32 v99, v99, v16
  v_sub_f32 v115, v115, v16
  v_sub_f32 v100, v100, v16
  v_sub_f32 v116, v116, v16
  v_sub_f32 v101, v101, v16
  v_sub_f32 v117, v117, v16
  v_sub_f32 v102, v102, v16
  v_sub_f32 v118, v118, v16
  v_sub_f32 v103, v103, v16
  v_sub_f32 v119, v119, v16
  v_max3_f32 v17, v104, v105, v106
  v_max3_f32 v17, v17, v107, v108
  v_max3_f32 v17, v17, v109, v110
  v_max3_f32 v17, v17, v111, 0
  v_mov_b32 v18, v17
  s_nop 1
  v_permlane16_swap_b32 v17, v18
  v_max_f32 v17, v17, v18
  v_mov_b32 v18, v17
  s_nop 1
  v_permlane32_swap_b32 v17, v18
  v_max_f32 v17, v17, v18
  v_sub_f32 v104, v104, v17
  v_sub_f32 v120, v120, v17
  v_sub_f32 v105, v105, v17
  v_sub_f32 v121, v121, v17
  v_sub_f32 v106, v106, v17
  v_sub_f32 v122, v122, v17
  v_sub_f32 v107, v107, v17
  v_sub_f32 v123, v123, v17
  v_sub_f32 v108, v108, v17
  v_sub_f32 v124, v124, v17
  v_sub_f32 v109, v109, v17
  v_sub_f32 v125, v125, v17
  v_sub_f32 v110, v110, v17
  v_sub_f32 v126, v126, v17
  v_sub_f32 v111, v111, v17
  v_sub_f32 v127, v127, v17
  s_call_b64 s[78:79], fa_resc0
  v_exp_f32 v208, v96
  v_exp_f32 v209, v97
  v_exp_f32 v210, v98
  v_add_f32 v224, v208, v209
  v_cvt_pk_bf16_f32 v160, v208, v209
  v_exp_f32 v211, v99
  v_add_f32 v224, v224, v210
  v_exp_f32 v212, v100
  v_add_f32 v224, v224, v211
  v_cvt_pk_bf16_f32 v161, v210, v211
  v_exp_f32 v213, v101
  v_add_f32 v224, v224, v212
  v_exp_f32 v214, v102
  v_add_f32 v224, v224, v213
  v_cvt_pk_bf16_f32 v162, v212, v213
  v_exp_f32 v215, v103
  v_add_f32 v224, v224, v214
  v_exp_f32 v208, v104
  v_add_f32 v224, v224, v215
  v_cvt_pk_bf16_f32 v163, v214, v215
  v_exp_f32 v209, v105
  v_exp_f32 v210, v106
  v_add_f32 v225, v208, v209
  v_cvt_pk_bf16_f32 v164, v208, v209
  v_exp_f32 v211, v107
  v_add_f32 v225, v225, v210
  v_exp_f32 v212, v108
  v_add_f32 v225, v225, v211
  v_cvt_pk_bf16_f32 v165, v210, v211
  v_exp_f32 v213, v109
  v_add_f32 v225, v225, v212
  v_exp_f32 v214, v110
  v_add_f32 v225, v225, v213
  v_cvt_pk_bf16_f32 v166, v212, v213
  v_exp_f32 v215, v111
  v_add_f32 v225, v225, v214
  s_nop 0
  v_add_f32 v225, v225, v215
  v_cvt_pk_bf16_f32 v167, v214, v215
  s_nop 1
  s_setpc_b64 s[76:77]
fa_rare01:
  s_nop 7
  v_max3_f32 v16, v112, v113, v114
  v_max3_f32 v16, v16, v115, v116
  v_max3_f32 v16, v16, v117, v118
  v_max3_f32 v16, v16, v119, 0
  v_mov_b32 v18, v16
  s_nop 1
  v_permlane16_swap_b32 v16, v18
  v_max_f32 v16, v16, v18
  v_mov_b32 v18, v16
  s_nop 1
  v_permlane32_swap_b32 v16, v18
  v_max_f32 v16, v16, v18
  v_sub_f32 v112, v112, v16
  v_sub_f32 v96, v96, v16
  v_sub_f32 v113, v113, v16
  v_sub_f32 v97, v97, v16
  v_sub_f32 v114, v114, v16
  v_sub_f32 v98, v98, v16
  v_sub_f32 v115, v115, v16
  v_sub_f32 v99, v99, v16
  v_sub_f32 v116, v116, v16
  v_sub_f32 v100, v100, v16
  v_sub_f32 v117, v117, v16
  v_sub_f32 v101, v101, v16
  v_sub_f32 v118, v118, v16
  v_sub_f32 v102, v102, v16
  v_sub_f32 v119, v119, v16
  v_sub_f32 v103, v103, v16
  v_max3_f32 v17, v120, v121, v122
  v_max3_f32 v17, v17, v123, v124
  v_max3_f32 v17, v17, v125, v126
  v_max3_f32 v17, v17, v127, 0
  v_mov_b32 v18, v17
  s_nop 1
  v_permlane16_swap_b32 v17, v18
  v_max_f32 v17, v17, v18
  v_mov_b32 v18, v17
  s_nop 1
  v_permlane32_swap_b32 v17, v18
  v_max_f32 v17, v17, v18
  v_sub_f32 v120, v120, v17
  v_sub_f32 v104, v104, v17
  v_sub_f32 v121, v121, v17
  v_sub_f32 v105, v105, v17
  v_sub_f32 v122, v122, v17
  v_sub_f32 v106, v106, v17
  v_sub_f32 v123, v123, v17
  v_sub_f32 v107, v107, v17
  v_sub_f32 v124, v124, v17
  v_sub_f32 v108, v108, v17
  v_sub_f32 v125, v125, v17
  v_sub_f32 v109, v109, v17
  v_sub_f32 v126, v126, v17
  v_sub_f32 v110, v110, v17
  v_sub_f32 v127, v127, v17
  v_sub_f32 v111, v111, v17
  s_call_b64 s[78:79], fa_resc0
  v_exp_f32 v208, v112
  v_exp_f32 v209, v113
  v_exp_f32 v210, v114
  v_add_f32 v224, v208, v209
  v_cvt_pk_bf16_f32 v168, v208, v209
  v_exp_f32 v211, v115
  v_add_f32 v224, v224, v210
  v_exp_f32 v212, v116
  v_add_f32 v224, v224, v211
  v_cvt_pk_bf16_f32 v169, v210, v211
  v_exp_f32 v213, v117
  v_add_f32 v224, v224, v212
  v_exp_f32 v214, v118
  v_add_f32 v224, v224, v213
  v_cvt_pk_bf16_f32 v170, v212, v213
  v_exp_f32 v215, v119
  v_add_f32 v224, v224, v214
  v_exp_f32 v208, v120
  v_add_f32 v224, v224, v215
  v_cvt_pk_bf16_f32 v171, v214, v215
  v_exp_f32 v209, v121
  v_exp_f32 v210, v122
  v_add_f32 v225, v208, v209
  v_cvt_pk_bf16_f32 v172, v208, v209
  v_exp_f32 v211, v123
  v_add_f32 v225, v225, v210
  v_exp_f32 v212, v124
  v_add_f32 v225, v225, v211
  v_cvt_pk_bf16_f32 v173, v210, v211
  v_exp_f32 v213, v125
  v_add_f32 v225, v225, v212
  v_exp_f32 v214, v126
  v_add_f32 v225, v225, v213
  v_cvt_pk_bf16_f32 v174, v212, v213
  v_exp_f32 v215, v127
  v_add_f32 v225, v225, v214
  s_nop 0
  v_add_f32 v225, v225, v215
  v_cvt_pk_bf16_f32 v175, v214, v215
  s_nop 1
  s_setpc_b64 s[76:77]
fa_resc0:
  v_sub_f32 v192, v192, v16
  v_sub_f32 v193, v193, v16
  v_sub_f32 v194, v194, v16
  v_sub_f32 v195, v195, v16
  v_exp_f32 v18, -v16
  v_sub_f32 v196, v196, v17
  v_sub_f32 v197, v197, v17
  v_sub_f32 v198, v198, v17
  v_sub_f32 v199, v199, v17
  v_exp_f32 v19, -v17
  s_nop 0
  v_mul_f32 v228, v228, v18
  v_mul_f32 v229, v229, v19
  v_accvgpr_read_b32 v20, a0
  v_accvgpr_read_b32 v21, a1
  v_accvgpr_read_b32 v22, a2
  v_accvgpr_read_b32 v23, a3
  v_mul_f32 v20, v20, v18
  v_mul_f32 v21, v21, v18
  v_mul_f32 v22, v22, v18
  v_mul_f32 v23, v23, v18
  v_accvgpr_write_b32 a0, v20
  v_accvgpr_write_b32 a1, v21
  v_accvgpr_write_b32 a2, v22
  v_accvgpr_write_b32 a3, v23
  v_accvgpr_read_b32 v20, a4
  v_accvgpr_read_b32 v21, a5
  v_accvgpr_read_b32 v22, a6
  v_accvgpr_read_b32 v23, a7
  v_mul_f32 v20, v20, v19
  v_mul_f32 v21, v21, v19
  v_mul_f32 v22, v22, v19
  v_mul_f32 v23, v23, v19
  v_accvgpr_write_b32 a4, v20
  v_accvgpr_write_b32 a5, v21
  v_accvgpr_write_b32 a6, v22
  v_accvgpr_write_b32 a7, v23
  v_accvgpr_read_b32 v20, a8
  v_accvgpr_read_b32 v21, a9
  v_accvgpr_read_b32 v22, a10
  v_accvgpr_read_b32 v23, a11
  v_mul_f32 v20, v20, v18
  v_mul_f32 v21, v21, v18
  v_mul_f32 v22, v22, v18
  v_mul_f32 v23, v23, v18
  v_accvgpr_write_b32 a8, v20
  v_accvgpr_write_b32 a9, v21
  v_accvgpr_write_b32 a10, v22
  v_accvgpr_write_b32 a11, v23
  v_accvgpr_read_b32 v20, a12
  v_accvgpr_read_b32 v21, a13
  v_accvgpr_read_b32 v22, a14
  v_accvgpr_read_b32 v23, a15
  v_mul_f32 v20, v20, v19
  v_mul_f32 v21, v21, v19
  v_mul_f32 v22, v22, v19
  v_mul_f32 v23, v23, v19
  v_accvgpr_write_b32 a12, v20
  v_accvgpr_write_b32 a13, v21
  v_accvgpr_write_b32 a14, v22
  v_accvgpr_write_b32 a15, v23
  v_accvgpr_read_b32 v20, a16
  v_accvgpr_read_b32 v21, a17
  v_accvgpr_read_b32 v22, a18
  v_accvgpr_read_b32 v23, a19
  v_mul_f32 v20, v20, v18
  v_mul_f32 v21, v21, v18
  v_mul_f32 v22, v22, v18
  v_mul_f32 v23, v23, v18
  v_accvgpr_write_b32 a16, v20
  v_accvgpr_write_b32 a17, v21
  v_accvgpr_write_b32 a18, v22
  v_accvgpr_write_b32 a19, v23
  v_accvgpr_read_b32 v20, a20
  v_accvgpr_read_b32 v21, a21
  v_accvgpr_read_b32 v22, a22
  v_accvgpr_read_b32 v23, a23
  v_mul_f32 v20, v20, v19
  v_mul_f32 v21, v21, v19
  v_mul_f32 v22, v22, v19
  v_mul_f32 v23, v23, v19
  v_accvgpr_write_b32 a20, v20
  v_accvgpr_write_b32 a21, v21
  v_accvgpr_write_b32 a22, v22
  v_accvgpr_write_b32 a23, v23
  v_accvgpr_read_b32 v20, a24
  v_accvgpr_read_b32 v21, a25
  v_accvgpr_read_b32 v22, a26
  v_accvgpr_read_b32 v23, a27
  v_mul_f32 v20, v20, v18
  v_mul_f32 v21, v21, v18
  v_mul_f32 v22, v22, v18
  v_mul_f32 v23, v23, v18
  v_accvgpr_write_b32 a24, v20
  v_accvgpr_write_b32 a25, v21
  v_accvgpr_write_b32 a26, v22
  v_accvgpr_write_b32 a27, v23
  v_accvgpr_read_b32 v20, a28
  v_accvgpr_read_b32 v21, a29
  v_accvgpr_read_b32 v22, a30
  v_accvgpr_read_b32 v23, a31
  v_mul_f32 v20, v20, v19
  v_mul_f32 v21, v21, v19
  v_mul_f32 v22, v22, v19
  v_mul_f32 v23, v23, v19
  v_accvgpr_write_b32 a28, v20
  v_accvgpr_write_b32 a29, v21
  v_accvgpr_write_b32 a30, v22
  v_accvgpr_write_b32 a31, v23
  v_accvgpr_read_b32 v20, a32
  v_accvgpr_read_b32 v21, a33
  v_accvgpr_read_b32 v22, a34
  v_accvgpr_read_b32 v23, a35
  v_mul_f32 v20, v20, v18
  v_mul_f32 v21, v21, v18
  v_mul_f32 v22, v22, v18
  v_mul_f32 v23, v23, v18
  v_accvgpr_write_b32 a32, v20
  v_accvgpr_write_b32 a33, v21
  v_accvgpr_write_b32 a34, v22
  v_accvgpr_write_b32 a35, v23
  v_accvgpr_read_b32 v20, a36
  v_accvgpr_read_b32 v21, a37
  v_accvgpr_read_b32 v22, a38
  v_accvgpr_read_b32 v23, a39
  v_mul_f32 v20, v20, v19
  v_mul_f32 v21, v21, v19
  v_mul_f32 v22, v22, v19
  v_mul_f32 v23, v23, v19
  v_accvgpr_write_b32 a36, v20
  v_accvgpr_write_b32 a37, v21
  v_accvgpr_write_b32 a38, v22
  v_accvgpr_write_b32 a39, v23
  v_accvgpr_read_b32 v20, a40
  v_accvgpr_read_b32 v21, a41
  v_accvgpr_read_b32 v22, a42
  v_accvgpr_read_b32 v23, a43
  v_mul_f32 v20, v20, v18
  v_mul_f32 v21, v21, v18
  v_mul_f32 v22, v22, v18
  v_mul_f32 v23, v23, v18
  v_accvgpr_write_b32 a40, v20
  v_accvgpr_write_b32 a41, v21
  v_accvgpr_write_b32 a42, v22
  v_accvgpr_write_b32 a43, v23
  v_accvgpr_read_b32 v20, a44
  v_accvgpr_read_b32 v21, a45
  v_accvgpr_read_b32 v22, a46
  v_accvgpr_read_b32 v23, a47
  v_mul_f32 v20, v20, v19
  v_mul_f32 v21, v21, v19
  v_mul_f32 v22, v22, v19
  v_mul_f32 v23, v23, v19
  v_accvgpr_write_b32 a44, v20
  v_accvgpr_write_b32 a45, v21
  v_accvgpr_write_b32 a46, v22
  v_accvgpr_write_b32 a47, v23
  v_accvgpr_read_b32 v20, a48
  v_accvgpr_read_b32 v21, a49
  v_accvgpr_read_b32 v22, a50
  v_accvgpr_read_b32 v23, a51
  v_mul_f32 v20, v20, v18
  v_mul_f32 v21, v21, v18
  v_mul_f32 v22, v22, v18
  v_mul_f32 v23, v23, v18
  v_accvgpr_write_b32 a48, v20
  v_accvgpr_write_b32 a49, v21
  v_accvgpr_write_b32 a50, v22
  v_accvgpr_write_b32 a51, v23
  v_accvgpr_read_b32 v20, a52
  v_accvgpr_read_b32 v21, a53
  v_accvgpr_read_b32 v22, a54
  v_accvgpr_read_b32 v23, a55
  v_mul_f32 v20, v20, v19
  v_mul_f32 v21, v21, v19
  v_mul_f32 v22, v22, v19
  v_mul_f32 v23, v23, v19
  v_accvgpr_write_b32 a52, v20
  v_accvgpr_write_b32 a53, v21
  v_accvgpr_write_b32 a54, v22
  v_accvgpr_write_b32 a55, v23
  v_accvgpr_read_b32 v20, a56
  v_accvgpr_read_b32 v21, a57
  v_accvgpr_read_b32 v22, a58
  v_accvgpr_read_b32 v23, a59
  v_mul_f32 v20, v20, v18
  v_mul_f32 v21, v21, v18
  v_mul_f32 v22, v22, v18
  v_mul_f32 v23, v23, v18
  v_accvgpr_write_b32 a56, v20
  v_accvgpr_write_b32 a57, v21
  v_accvgpr_write_b32 a58, v22
  v_accvgpr_write_b32 a59, v23
  v_accvgpr_read_b32 v20, a60
  v_accvgpr_read_b32 v21, a61
  v_accvgpr_read_b32 v22, a62
  v_accvgpr_read_b32 v23, a63
  v_mul_f32 v20, v20, v19
  v_mul_f32 v21, v21, v19
  v_mul_f32 v22, v22, v19
  v_mul_f32 v23, v23, v19
  v_accvgpr_write_b32 a60, v20
  v_accvgpr_write_b32 a61, v21
  v_accvgpr_write_b32 a62, v22
  v_accvgpr_write_b32 a63, v23
  s_setpc_b64 s[78:79]
fa_rare10:
  s_nop 7
  v_max3_f32 v16, v128, v129, v130
  v_max3_f32 v16, v16, v131, v132
  v_max3_f32 v16, v16, v133, v134
  v_max3_f32 v16, v16, v135, 0
  v_mov_b32 v18, v16
  s_nop 1
  v_permlane16_swap_b32 v16, v18
  v_max_f32 v16, v16, v18
  v_mov_b32 v18, v16
  s_nop 1
  v_permlane32_swap_b32 v16, v18
  v_max_f32 v16, v16, v18
  v_sub_f32 v128, v128, v16
  v_sub_f32 v144, v144, v16
  v_sub_f32 v129, v129, v16
  v_sub_f32 v145, v145, v16
  v_sub_f32 v130, v130, v16
  v_sub_f32 v146, v146, v16
  v_sub_f32 v131, v131, v16
  v_sub_f32 v147, v147, v16
  v_sub_f32 v132, v132, v16
  v_sub_f32 v148, v148, v16
  v_sub_f32 v133, v133, v16
  v_sub_f32 v149, v149, v16
  v_sub_f32 v134, v134, v16
  v_sub_f32 v150, v150, v16
  v_sub_f32 v135, v135, v16
  v_sub_f32 v151, v151, v16
  v_max3_f32 v17, v136, v137, v138
  v_max3_f32 v17, v17, v139, v140
  v_max3_f32 v17, v17, v141, v142
  v_max3_f32 v17, v17, v143, 0
  v_mov_b32 v18, v17
  s_nop 1
  v_permlane16_swap_b32 v17, v18
  v_max_f32 v17, v17, v18
  v_mov_b32 v18, v17
  s_nop 1
  v_permlane32_swap_b32 v17, v18
  v_max_f32 v17, v17, v18
  v_sub_f32 v136, v136, v17
  v_sub_f32 v152, v152, v17
  v_sub_f32 v137, v137, v17
  v_sub_f32 v153, v153, v17
  v_sub_f32 v138, v138, v17
  v_sub_f32 v154, v154, v17
  v_sub_f32 v139, v139, v17
  v_sub_f32 v155, v155, v17
  v_sub_f32 v140, v140, v17
  v_sub_f32 v156, v156, v17
  v_sub_f32 v141, v141, v17
  v_sub_f32 v157, v157, v17
  v_sub_f32 v142, v142, v17
  v_sub_f32 v158, v158, v17
  v_sub_f32 v143, v143, v17
  v_sub_f32 v159, v159, v17
  s_call_b64 s[78:79], fa_resc1
  v_exp_f32 v216, v128
  v_exp_f32 v217, v129
  v_exp_f32 v218, v130
  v_add_f32 v226, v216, v217
  v_cvt_pk_bf16_f32 v176, v216, v217
  v_exp_f32 v219, v131
  v_add_f32 v226, v226, v218
  v_exp_f32 v220, v132
  v_add_f32 v226, v226, v219
  v_cvt_pk_bf16_f32 v177, v218, v219
  v_exp_f32 v221, v133
  v_add_f32 v226, v226, v220
  v_exp_f32 v222, v134
  v_add_f32 v226, v226, v221
  v_cvt_pk_bf16_f32 v178, v220, v221
  v_exp_f32 v223, v135
  v_add_f32 v226, v226, v222
  v_exp_f32 v216, v136
  v_add_f32 v226, v226, v223
  v_cvt_pk_bf16_f32 v179, v222, v223
  v_exp_f32 v217, v137
  v_exp_f32 v218, v138
  v_add_f32 v227, v216, v217
  v_cvt_pk_bf16_f32 v180, v216, v217
  v_exp_f32 v219, v139
  v_add_f32 v227, v227, v218
  v_exp_f32 v220, v140
  v_add_f32 v227, v227, v219
  v_cvt_pk_bf16_f32 v181, v218, v219
  v_exp_f32 v221, v141
  v_add_f32 v227, v227, v220
  v_exp_f32 v222, v142
  v_add_f32 v227, v227, v221
  v_cvt_pk_bf16_f32 v182, v220, v221
  v_exp_f32 v223, v143
  v_add_f32 v227, v227, v222
  s_nop 0
  v_add_f32 v227, v227, v223
  v_cvt_pk_bf16_f32 v183, v222, v223
  s_nop 1
  s_setpc_b64 s[76:77]
fa_rare11:
  s_nop 7
  v_max3_f32 v16, v144, v145, v146
  v_max3_f32 v16, v16, v147, v148
  v_max3_f32 v16, v16, v149, v150
  v_max3_f32 v16, v16, v151, 0
  v_mov_b32 v18, v16
  s_nop 1
  v_permlane16_swap_b32 v16, v18
  v_max_f32 v16, v16, v18
  v_mov_b32 v18, v16
  s_nop 1
  v_permlane32_swap_b32 v16, v18
  v_max_f32 v16, v16, v18
  v_sub_f32 v144, v144, v16
  v_sub_f32 v128, v128, v16
  v_sub_f32 v145, v145, v16
  v_sub_f32 v129, v129, v16
  v_sub_f32 v146, v146, v16
  v_sub_f32 v130, v130, v16
  v_sub_f32 v147, v147, v16
  v_sub_f32 v131, v131, v16
  v_sub_f32 v148, v148, v16
  v_sub_f32 v132, v132, v16
  v_sub_f32 v149, v149, v16
  v_sub_f32 v133, v133, v16
  v_sub_f32 v150, v150, v16
  v_sub_f32 v134, v134, v16
  v_sub_f32 v151, v151, v16
  v_sub_f32 v135, v135, v16
  v_max3_f32 v17, v152, v153, v154
  v_max3_f32 v17, v17, v155, v156
  v_max3_f32 v17, v17, v157, v158
  v_max3_f32 v17, v17, v159, 0
  v_mov_b32 v18, v17
  s_nop 1
  v_permlane16_swap_b32 v17, v18
  v_max_f32 v17, v17, v18
  v_mov_b32 v18, v17
  s_nop 1
  v_permlane32_swap_b32 v17, v18
  v_max_f32 v17, v17, v18
  v_sub_f32 v152, v152, v17
  v_sub_f32 v136, v136, v17
  v_sub_f32 v153, v153, v17
  v_sub_f32 v137, v137, v17
  v_sub_f32 v154, v154, v17
  v_sub_f32 v138, v138, v17
  v_sub_f32 v155, v155, v17
  v_sub_f32 v139, v139, v17
  v_sub_f32 v156, v156, v17
  v_sub_f32 v140, v140, v17
  v_sub_f32 v157, v157, v17
  v_sub_f32 v141, v141, v17
  v_sub_f32 v158, v158, v17
  v_sub_f32 v142, v142, v17
  v_sub_f32 v159, v159, v17
  v_sub_f32 v143, v143, v17
  s_call_b64 s[78:79], fa_resc1
  v_exp_f32 v216, v144
  v_exp_f32 v217, v145
  v_exp_f32 v218, v146
  v_add_f32 v226, v216, v217
  v_cvt_pk_bf16_f32 v184, v216, v217
  v_exp_f32 v219, v147
  v_add_f32 v226, v226, v218
  v_exp_f32 v220, v148
  v_add_f32 v226, v226, v219
  v_cvt_pk_bf16_f32 v185, v218, v219
  v_exp_f32 v221, v149
  v_add_f32 v226, v226, v220
  v_exp_f32 v222, v150
  v_add_f32 v226, v226, v221
  v_cvt_pk_bf16_f32 v186, v220, v221
  v_exp_f32 v223, v151
  v_add_f32 v226, v226, v222
  v_exp_f32 v216, v152
  v_add_f32 v226, v226, v223
  v_cvt_pk_bf16_f32 v187, v222, v223
  v_exp_f32 v217, v153
  v_exp_f32 v218, v154
  v_add_f32 v227, v216, v217
  v_cvt_pk_bf16_f32 v188, v216, v217
  v_exp_f32 v219, v155
  v_add_f32 v227, v227, v218
  v_exp_f32 v220, v156
  v_add_f32 v227, v227, v219
  v_cvt_pk_bf16_f32 v189, v218, v219
  v_exp_f32 v221, v157
  v_add_f32 v227, v227, v220
  v_exp_f32 v222, v158
  v_add_f32 v227, v227, v221
  v_cvt_pk_bf16_f32 v190, v220, v221
  v_exp_f32 v223, v159
  v_add_f32 v227, v227, v222
  s_nop 0
  v_add_f32 v227, v227, v223
  v_cvt_pk_bf16_f32 v191, v222, v223
  s_nop 1
  s_setpc_b64 s[76:77]
fa_resc1:
  v_sub_f32 v200, v200, v16
  v_sub_f32 v201, v201, v16
  v_sub_f32 v202, v202, v16
  v_sub_f32 v203, v203, v16
  v_exp_f32 v18, -v16
  v_sub_f32 v204, v204, v17
  v_sub_f32 v205, v205, v17
  v_sub_f32 v206, v206, v17
  v_sub_f32 v207, v207, v17
  v_exp_f32 v19, -v17
  s_nop 0
  v_mul_f32 v230, v230, v18
  v_mul_f32 v231, v231, v19
  v_accvgpr_read_b32 v20, a64
  v_accvgpr_read_b32 v21, a65
  v_accvgpr_read_b32 v22, a66
  v_accvgpr_read_b32 v23, a67
  v_mul_f32 v20, v20, v18
  v_mul_f32 v21, v21, v18
  v_mul_f32 v22, v22, v18
  v_mul_f32 v23, v23, v18
  v_accvgpr_write_b32 a64, v20
  v_accvgpr_write_b32 a65, v21
  v_accvgpr_write_b32 a66, v22
  v_accvgpr_write_b32 a67, v23
  v_accvgpr_read_b32 v20, a68
  v_accvgpr_read_b32 v21, a69
  v_accvgpr_read_b32 v22, a70
  v_accvgpr_read_b32 v23, a71
  v_mul_f32 v20, v20, v19
  v_mul_f32 v21, v21, v19
  v_mul_f32 v22, v22, v19
  v_mul_f32 v23, v23, v19
  v_accvgpr_write_b32 a68, v20
  v_accvgpr_write_b32 a69, v21
  v_accvgpr_write_b32 a70, v22
  v_accvgpr_write_b32 a71, v23
  v_accvgpr_read_b32 v20, a72
  v_accvgpr_read_b32 v21, a73
  v_accvgpr_read_b32 v22, a74
  v_accvgpr_read_b32 v23, a75
  v_mul_f32 v20, v20, v18
  v_mul_f32 v21, v21, v18
  v_mul_f32 v22, v22, v18
  v_mul_f32 v23, v23, v18
  v_accvgpr_write_b32 a72, v20
  v_accvgpr_write_b32 a73, v21
  v_accvgpr_write_b32 a74, v22
  v_accvgpr_write_b32 a75, v23
  v_accvgpr_read_b32 v20, a76
  v_accvgpr_read_b32 v21, a77
  v_accvgpr_read_b32 v22, a78
  v_accvgpr_read_b32 v23, a79
  v_mul_f32 v20, v20, v19
  v_mul_f32 v21, v21, v19
  v_mul_f32 v22, v22, v19
  v_mul_f32 v23, v23, v19
  v_accvgpr_write_b32 a76, v20
  v_accvgpr_write_b32 a77, v21
  v_accvgpr_write_b32 a78, v22
  v_accvgpr_write_b32 a79, v23
  v_accvgpr_read_b32 v20, a80
  v_accvgpr_read_b32 v21, a81
  v_accvgpr_read_b32 v22, a82
  v_accvgpr_read_b32 v23, a83
  v_mul_f32 v20, v20, v18
  v_mul_f32 v21, v21, v18
  v_mul_f32 v22, v22, v18
  v_mul_f32 v23, v23, v18
  v_accvgpr_write_b32 a80, v20
  v_accvgpr_write_b32 a81, v21
  v_accvgpr_write_b32 a82, v22
  v_accvgpr_write_b32 a83, v23
  v_accvgpr_read_b32 v20, a84
  v_accvgpr_read_b32 v21, a85
  v_accvgpr_read_b32 v22, a86
  v_accvgpr_read_b32 v23, a87
  v_mul_f32 v20, v20, v19
  v_mul_f32 v21, v21, v19
  v_mul_f32 v22, v22, v19
  v_mul_f32 v23, v23, v19
  v_accvgpr_write_b32 a84, v20
  v_accvgpr_write_b32 a85, v21
  v_accvgpr_write_b32 a86, v22
  v_accvgpr_write_b32 a87, v23
  v_accvgpr_read_b32 v20, a88
  v_accvgpr_read_b32 v21, a89
  v_accvgpr_read_b32 v22, a90
  v_accvgpr_read_b32 v23, a91
  v_mul_f32 v20, v20, v18
  v_mul_f32 v21, v21, v18
  v_mul_f32 v22, v22, v18
  v_mul_f32 v23, v23, v18
  v_accvgpr_write_b32 a88, v20
  v_accvgpr_write_b32 a89, v21
  v_accvgpr_write_b32 a90, v22
  v_accvgpr_write_b32 a91, v23
  v_accvgpr_read_b32 v20, a92
  v_accvgpr_read_b32 v21, a93
  v_accvgpr_read_b32 v22, a94
  v_accvgpr_read_b32 v23, a95
  v_mul_f32 v20, v20, v19
  v_mul_f32 v21, v21, v19
  v_mul_f32 v22, v22, v19
  v_mul_f32 v23, v23, v19
  v_accvgpr_write_b32 a92, v20
  v_accvgpr_write_b32 a93, v21
  v_accvgpr_write_b32 a94, v22
  v_accvgpr_write_b32 a95, v23
  v_accvgpr_read_b32 v20, a96
  v_accvgpr_read_b32 v21, a97
  v_accvgpr_read_b32 v22, a98
  v_accvgpr_read_b32 v23, a99
  v_mul_f32 v20, v20, v18
  v_mul_f32 v21, v21, v18
  v_mul_f32 v22, v22, v18
  v_mul_f32 v23, v23, v18
  v_accvgpr_write_b32 a96, v20
  v_accvgpr_write_b32 a97, v21
  v_accvgpr_write_b32 a98, v22
  v_accvgpr_write_b32 a99, v23
  v_accvgpr_read_b32 v20, a100
  v_accvgpr_read_b32 v21, a101
  v_accvgpr_read_b32 v22, a102
  v_accvgpr_read_b32 v23, a103
  v_mul_f32 v20, v20, v19
  v_mul_f32 v21, v21, v19
  v_mul_f32 v22, v22, v19
  v_mul_f32 v23, v23, v19
  v_accvgpr_write_b32 a100, v20
  v_accvgpr_write_b32 a101, v21
  v_accvgpr_write_b32 a102, v22
  v_accvgpr_write_b32 a103, v23
  v_accvgpr_read_b32 v20, a104
  v_accvgpr_read_b32 v21, a105
  v_accvgpr_read_b32 v22, a106
  v_accvgpr_read_b32 v23, a107
  v_mul_f32 v20, v20, v18
  v_mul_f32 v21, v21, v18
  v_mul_f32 v22, v22, v18
  v_mul_f32 v23, v23, v18
  v_accvgpr_write_b32 a104, v20
  v_accvgpr_write_b32 a105, v21
  v_accvgpr_write_b32 a106, v22
  v_accvgpr_write_b32 a107, v23
  v_accvgpr_read_b32 v20, a108
  v_accvgpr_read_b32 v21, a109
  v_accvgpr_read_b32 v22, a110
  v_accvgpr_read_b32 v23, a111
  v_mul_f32 v20, v20, v19
  v_mul_f32 v21, v21, v19
  v_mul_f32 v22, v22, v19
  v_mul_f32 v23, v23, v19
  v_accvgpr_write_b32 a108, v20
  v_accvgpr_write_b32 a109, v21
  v_accvgpr_write_b32 a110, v22
  v_accvgpr_write_b32 a111, v23
  v_accvgpr_read_b32 v20, a112
  v_accvgpr_read_b32 v21, a113
  v_accvgpr_read_b32 v22, a114
  v_accvgpr_read_b32 v23, a115
  v_mul_f32 v20, v20, v18
  v_mul_f32 v21, v21, v18
  v_mul_f32 v22, v22, v18
  v_mul_f32 v23, v23, v18
  v_accvgpr_write_b32 a112, v20
  v_accvgpr_write_b32 a113, v21
  v_accvgpr_write_b32 a114, v22
  v_accvgpr_write_b32 a115, v23
  v_accvgpr_read_b32 v20, a116
  v_accvgpr_read_b32 v21, a117
  v_accvgpr_read_b32 v22, a118
  v_accvgpr_read_b32 v23, a119
  v_mul_f32 v20, v20, v19
  v_mul_f32 v21, v21, v19
  v_mul_f32 v22, v22, v19
  v_mul_f32 v23, v23, v19
  v_accvgpr_write_b32 a116, v20
  v_accvgpr_write_b32 a117, v21
  v_accvgpr_write_b32 a118, v22
  v_accvgpr_write_b32 a119, v23
  v_accvgpr_read_b32 v20, a120
  v_accvgpr_read_b32 v21, a121
  v_accvgpr_read_b32 v22, a122
  v_accvgpr_read_b32 v23, a123
  v_mul_f32 v20, v20, v18
  v_mul_f32 v21, v21, v18
  v_mul_f32 v22, v22, v18
  v_mul_f32 v23, v23, v18
  v_accvgpr_write_b32 a120, v20
  v_accvgpr_write_b32 a121, v21
  v_accvgpr_write_b32 a122, v22
  v_accvgpr_write_b32 a123, v23
  v_accvgpr_read_b32 v20, a124
  v_accvgpr_read_b32 v21, a125
  v_accvgpr_read_b32 v22, a126
  v_accvgpr_read_b32 v23, a127
  v_mul_f32 v20, v20, v19
  v_mul_f32 v21, v21, v19
  v_mul_f32 v22, v22, v19
  v_mul_f32 v23, v23, v19
  v_accvgpr_write_b32 a124, v20
  v_accvgpr_write_b32 a125, v21
  v_accvgpr_write_b32 a126, v22
  v_accvgpr_write_b32 a127, v23
  s_setpc_b64 s[78:79]
.section .rodata,"a"
.p2align 6
.amdhsa_kernel fa_kernel
  .amdhsa_next_free_vgpr 512
  .amdhsa_next_free_sgpr 102
  .amdhsa_accum_offset 256
  .amdhsa_group_segment_fixed_size 0
  .amdhsa_kernarg_size 112
  .amdhsa_user_sgpr_count 2
  .amdhsa_user_sgpr_kernarg_segment_ptr 1
  .amdhsa_system_sgpr_workgroup_id_x 1
  .amdhsa_float_denorm_mode_32 3
.end_amdhsa_kernel
.text
```

```asm
; @launch kernel=fa_kernel grid=(256,1,1) block=(256,1,1) lds=163840
.amdgcn_target "amdgcn-amd-amdhsa--gfx950"
.text
.globl fa_kernel
.p2align 8
.type fa_kernel,@function
fa_kernel:
  s_cmp_ge_u32 s2, 256
  s_cbranch_scc1 fa_end
  s_getpc_b64 s[62:63]
  v_and_b32 v230, 127, v0
  v_lshlrev_b32 v230, 7, v230
  global_load_dword v231, v230, s[62:63]
  s_load_dwordx4 s[4:7], s[0:1], 0
  s_load_dwordx4 s[8:11], s[0:1], 24
  s_load_dwordx2 s[14:15], s[0:1], 56
  s_load_dwordx2 s[12:13], s[0:1], 40
  s_load_dwordx4 s[16:19], s[0:1], 96
  s_load_dwordx2 s[60:61], s[0:1], 16
  v_lshrrev_b32 v16, 6, v0
  v_and_b32 v1, 63, v0
  v_readfirstlane_b32 s20, v16
  s_and_b32 s21, s2, 7
  s_lshl_b32 s21, s21, 2
  s_lshr_b32 s23, s2, 3
  s_and_b32 s23, s23, 3
  s_add_u32 s21, s21, s23
  s_lshr_b32 s22, s2, 5
  v_and_b32 v208, 31, v1
  v_lshrrev_b32 v209, 5, v1
  s_lshl_b32 s31, s2, 2
  s_add_u32 s31, s31, s20
  s_lshl_b32 s31, s31, 1
  v_add_u32 v209, s31, v209
  v_lshlrev_b32 v212, 4, v208
  v_mul_u32_u24 v210, 1280, v209
  v_add_u32 v210, v210, v212
  v_cmp_gt_u32 s[64:65], 16, v208
  v_mov_b32 v19, 1073741824
  v_and_b32 v220, 7, v209
  v_cndmask_b32 v211, v19, v210, s[64:65]
  v_bfe_u32 v17, v1, 1, 3
  v_lshlrev_b32 v17, 13, v17
  v_and_b32 v18, 1, v1
  v_lshl_add_u32 v235, v18, 7, v17
  s_lshl_b32 s74, s22, 1
  s_and_b32 s31, s20, 1
  s_add_u32 s74, s74, s31
  s_lshl_b32 s74, s74, 16
  s_mov_b32 s73, 1048576
  v_and_b32 v16, 15, v1
  v_lshlrev_b32 v17, 10, v16
  v_and_b32 v18, 16, v1
  v_lshl_add_u32 v233, v18, 3, v17
  s_lshl_b32 s30, s23, 2
  s_add_u32 s30, s30, s20
  s_lshl_b32 s30, s30, 14
  s_lshl_b32 s29, s22, 18
  s_lshl_b32 s23, s21, 8
  s_cmp_ge_u32 s20, 2
  s_waitcnt lgkmcnt(0)
  s_mov_b32 s44, s4
  s_mov_b32 s45, s5
  s_mov_b32 s46, 2621440
  s_mov_b32 s47, 0x20000
  s_mov_b32 s68, s14
  s_mov_b32 s69, s15
  s_mov_b32 s70, 1280
  s_mov_b32 s71, 0x20000
  buffer_load_dwordx4 v[160:163], v210, s[44:47], 0 offen
  buffer_load_dwordx4 v[164:167], v210, s[44:47], 0 offen offset:512
  buffer_load_dwordx4 v[168:171], v211, s[44:47], 0 offen offset:1024
  buffer_load_dwordx4 v[172:175], v212, s[68:71], 0 offen offset:0
  buffer_load_dwordx4 v[176:179], v212, s[68:71], 0 offen offset:512
  buffer_load_dwordx4 v[180:183], v212, s[68:71], 0 offen offset:1024
  s_cselect_b32 s62, s10, s8
  s_cselect_b32 s63, s11, s9
  s_add_u32 s62, s62, s23
  s_addc_u32 s63, s63, 0
  s_mov_b32 s36, s62
  s_mov_b32 s37, s63
  s_mov_b32 s38, 0
  s_mov_b32 s39, 0x20000
  s_sub_u32 s38, 4194304, s23
  buffer_load_dword v231, v235, s[36:39], s74 offen
  s_add_u32 s6, s6, s29
  s_addc_u32 s7, s7, 0
  s_mov_b32 s32, s6
  s_mov_b32 s33, s7
  s_mov_b32 s34, 262144
  s_mov_b32 s35, 0x20000
  buffer_load_dword v232, v233, s[32:35], s30 offen
  s_add_u32 s74, s74, s73
  buffer_load_dword v231, v235, s[36:39], s74 offen
  buffer_load_dword v232, v233, s[32:35], s30 offen offset:256
  s_getpc_b64 s[8:9]
fa_pc:
  s_lshr_b32 s31, s2, 3
  s_and_b32 s31, s31, 15
  s_lshl_b32 s31, s31, 2
  s_add_u32 s31, s31, s20
  s_lshl_b32 s31, s31, 11
  s_min_u32 s31, s31, fa_codeend-fa_pc-2048
  v_lshlrev_b32 v234, 7, v16
  v_add_u32 v230, s31, v234
  global_load_dword v231, v230, s[8:9]
  s_add_u32 s8, s8, fa_co1-fa_pc-4
  s_addc_u32 s9, s9, 0
  s_add_u32 s60, s60, s23
  s_addc_u32 s61, s61, 0
  s_sub_u32 s75, 5242880, s23
  s_mov_b32 s48, s62
  s_mov_b32 s49, s63
  s_mov_b32 s50, s38
  s_mov_b32 s51, 0x20000
  v_lshlrev_b32 v2, 4, v1
  v_lshrrev_b32 v19, 2, v1
  v_lshrrev_b32 v17, 5, v1
  v_mul_u32_u24 v17, 3, v17
  v_and_b32 v18, 3, v1
  v_xor_b32 v17, v17, v18
  v_lshlrev_b32 v17, 4, v17
  v_lshl_add_u32 v3, v19, 10, v17
  s_lshl_b32 s23, s20, 16
  v_add_u32 v3, s23, v3
  v_add_u32 v4, 15360, v3
  v_add_u32 v5, 30720, v3
  v_add_u32 v6, 46080, v3
  v_and_b32 v19, 3, v19
  v_lshrrev_b32 v17, 4, v1
  v_lshlrev_b32 v17, 6, v17
  v_lshl_add_u32 v19, v19, 13, v17
  s_and_b32 s23, s20, 1
  s_lshl_b32 s23, s23, 17
  v_add_u32 v19, s23, v19
  v_lshl_add_u32 v8, v18, 4, v19
  v_xor_b32 v18, 2, v18
  v_lshl_add_u32 v10, v18, 4, v19
  v_add_u32 v9, 31744, v8
  v_add_u32 v11, 95232, v10
  v_add_u32 v10, 63488, v10
  s_lshl_b32 s24, s20, 12
  s_mov_b32 s26, 0
  s_mov_b32 s27, 0
  s_mov_b32 s25, 262144
  s_mov_b32 s79, 64
  s_mov_b32 s40, s18
  s_mov_b32 s41, s19
  s_mov_b32 s42, 67108864
  s_mov_b32 s43, 0x20000
  s_mov_b32 s52, s12
  s_mov_b32 s53, s13
  s_mov_b32 s54, 5242880
  s_mov_b32 s55, 0x20000
  s_mov_b32 s56, s16
  s_mov_b32 s57, s17
  s_mov_b32 s58, 256
  s_mov_b32 s59, 0x20000
  s_and_b32 s29, s2, 31
  s_lshl_b32 s29, s29, 2
  s_add_u32 s29, s29, s20
  s_lshl_b32 s29, s29, 11
  s_lshl_b32 s23, s20, 5
  s_add_u32 s23, s23, s21
  s_lshl_b32 s23, s23, 2
  s_add_u32 s23, s23, 2641920
  s_lshl_b32 s31, s22, 9
  s_add_u32 s80, s23, s31
  s_sub_u32 s31, 7680, s31
  s_add_u32 s3, s23, s31
  s_lshl_b32 s23, s21, 7
  s_lshl_b32 s31, s22, 2
  s_add_u32 s23, s23, s31
  s_add_u32 s82, s23, 2637824
  s_sub_u32 s62, s2, 170
  s_lshl_b32 s31, s20, 6
  s_add_u32 s62, s62, s31
  s_lshl_b32 s62, s62, 2
  s_add_u32 s62, s62, 2650112
  s_sub_u32 s23, s2, 170
  s_cmp_lt_u32 s23, 54
  s_cselect_b32 s62, s62, 1073741824
  s_cmp_eq_u32 s20, 0
  s_cselect_b32 s31, s82, 1073741824
  s_cselect_b32 s77, s2, 1073741824
  s_cmp_eq_u32 s2, 255
  s_cselect_b32 s23, 2629632, 1073741824
  v_lshl_add_u32 v225, v16, 2, s23
  v_mov_b32 v229, 0
  v_writelane_b32 v225, s80, 0
  v_writelane_b32 v225, s3, 1
  v_writelane_b32 v225, s31, 2
  s_and_b32 s23, s2, 1
  s_lshl_b32 s23, s23, 2
  s_add_u32 s23, s23, s20
  s_lshl_b32 s23, s23, 7
  s_lshr_b32 s31, s2, 1
  s_add_u32 s23, s23, s31
  s_lshl_b32 s23, s23, 2
  s_add_u32 s23, s23, 2654208
  v_writelane_b32 v225, s23, 3
  v_writelane_b32 v225, s62, 4
  s_and_b32 s23, s21, 3
  s_lshr_b32 s31, s23, 1
  s_lshl_b32 s31, 4, s31
  s_bitcmp1_b32 s23, 0
  s_cselect_b32 s76, s31, 0
  s_cselect_b32 s72, 0, s31
  s_or_b32 s76, s76, 0x20
  s_or_b32 s72, s72, 0x25
  v_mov_b32 v20, 0
  v_mov_b32 v21, 0
  v_mov_b32 v22, 0
  v_mov_b32 v23, 0
  v_lshrrev_b32 v17, 4, v1
  v_lshrrev_b32 v18, 3, v16
  v_mul_u32_u24 v18, 3, v18
  v_xor_b32 v18, v18, v17
  v_lshlrev_b32 v18, 4, v18
  v_lshl_add_u32 v14, v16, 6, v18
  s_and_b32 s23, s20, 1
  s_lshl_b32 s23, s23, 13
  v_add_u32 v14, s23, v14
  v_mfma_f32_32x32x16_bf16 a[0:15], v[20:23], v[20:23], 0
  v_lshrrev_b32 v18, 2, v16
  v_lshlrev_b32 v18, 6, v18
  v_lshl_add_u32 v18, v17, 11, v18
  v_and_b32 v19, 1, v1
  v_mfma_f32_32x32x16_bf16 a[16:31], v[20:23], v[20:23], 0
  v_lshl_add_u32 v18, v19, 3, v18
  v_bfe_u32 v19, v1, 1, 1
  v_and_b32 v17, 1, v17
  v_lshl_or_b32 v19, v17, 1, v19
  v_mfma_f32_32x32x16_bf16 a[32:47], v[20:23], v[20:23], 0
  s_lshr_b32 s23, s20, 1
  s_lshl_b32 s23, s23, 13
  s_add_u32 s23, s23, 16384
  v_add_u32 v18, s23, v18
  v_mfma_f32_32x32x16_bf16 a[48:63], v[20:23], v[20:23], 0
  v_lshl_add_u32 v12, v19, 4, v18
  v_xor_b32 v13, 32, v12
  v_mov_b32 v19, 1073741824
  v_lshlrev_b32 v220, 4, v220
  v_mfma_f32_32x32x16_bf16 a[64:79], v[20:23], v[20:23], 0
  v_lshl_add_u32 v220, v208, 7, v220
  v_add_u32 v220, 131072, v220
  v_lshlrev_b32 v222, 2, v209
  v_cmp_eq_u32 vcc, 0, v208
  v_mfma_f32_32x32x16_bf16 a[80:95], v[20:23], v[20:23], 0
  v_add_u32 v222, 2621440, v222
  v_lshlrev_b32 v221, 4, v0
  v_cndmask_b32 v222, v19, v222, vcc
  v_add_u32 v221, 131072, v221
  v_mfma_f32_32x32x16_bf16 a[96:111], v[20:23], v[20:23], 0
  v_sub_u32 v209, 0xffff, v209
  v_lshrrev_b32 v223, 3, v0
  v_and_b32 v18, 7, v0
  v_lshlrev_b32 v18, 4, v18
  v_mfma_f32_32x32x16_bf16 a[112:127], v[20:23], v[20:23], 0
  v_cmp_gt_u32 vcc, 128, v0
  v_lshl_add_u32 v223, v223, 8, v18
  s_lshr_b32 s66, s2, 1
  s_mul_i32 s66, s66, 20480
  v_mfma_f32_32x32x16_bf16 a[128:143], v[20:23], v[20:23], 0
  s_and_b32 s31, s2, 1
  s_lshl_b32 s31, s31, 7
  s_add_u32 s66, s66, s31
  v_cndmask_b32 v224, v19, v223, vcc
  v_mfma_f32_32x32x16_bf16 a[144:159], v[20:23], v[20:23], 0
  s_add_u32 s67, s66, 8192
  s_add_u32 s78, s66, 16384
  s_mov_b32 s28, 0
  v_mfma_f32_32x32x16_bf16 a[160:175], v[20:23], v[20:23], 0
  v_mfma_f32_32x32x16_bf16 a[176:191], v[20:23], v[20:23], 0
  v_mfma_f32_32x32x16_bf16 a[192:207], v[20:23], v[20:23], 0
  v_mfma_f32_32x32x16_bf16 a[208:223], v[20:23], v[20:23], 0
  v_mfma_f32_32x32x16_bf16 a[224:239], v[20:23], v[20:23], 0
  v_mfma_f32_32x32x16_bf16 a[240:255], v[20:23], v[20:23], 0
  s_waitcnt vmcnt(5)
  v_lshlrev_b32 v184, 16, v160
  v_and_b32 v185, 0xffff0000, v160
  v_lshlrev_b32 v186, 16, v161
  v_and_b32 v187, 0xffff0000, v161
  v_lshlrev_b32 v188, 16, v162
  v_and_b32 v189, 0xffff0000, v162
  v_lshlrev_b32 v190, 16, v163
  v_and_b32 v191, 0xffff0000, v163
  v_lshlrev_b32 v192, 16, v164
  v_and_b32 v193, 0xffff0000, v164
  v_lshlrev_b32 v194, 16, v165
  v_and_b32 v195, 0xffff0000, v165
  v_lshlrev_b32 v196, 16, v166
  v_and_b32 v197, 0xffff0000, v166
  v_lshlrev_b32 v198, 16, v167
  v_and_b32 v199, 0xffff0000, v167
  v_lshlrev_b32 v200, 16, v168
  v_and_b32 v201, 0xffff0000, v168
  v_lshlrev_b32 v202, 16, v169
  v_and_b32 v203, 0xffff0000, v169
  v_lshlrev_b32 v204, 16, v170
  v_and_b32 v205, 0xffff0000, v170
  v_lshlrev_b32 v206, 16, v171
  v_and_b32 v207, 0xffff0000, v171
  v_pk_add_f32 v[16:17], v[184:185], v[186:187]
  v_pk_add_f32 v[18:19], v[188:189], v[190:191]
  v_pk_add_f32 v[16:17], v[16:17], v[192:193]
  v_pk_add_f32 v[18:19], v[18:19], v[194:195]
  v_pk_add_f32 v[16:17], v[16:17], v[196:197]
  v_pk_add_f32 v[18:19], v[18:19], v[198:199]
  v_pk_add_f32 v[16:17], v[16:17], v[200:201]
  v_pk_add_f32 v[18:19], v[18:19], v[202:203]
  v_pk_add_f32 v[16:17], v[16:17], v[204:205]
  v_pk_add_f32 v[18:19], v[18:19], v[206:207]
  v_pk_add_f32 v[16:17], v[16:17], v[18:19]
  v_add_f32 v213, v16, v17
  s_nop 1
  v_add_f32_dpp v213, v213, v213 quad_perm:[1,0,3,2] row_mask:0xf bank_mask:0xf
  s_nop 1
  v_add_f32_dpp v213, v213, v213 quad_perm:[2,3,0,1] row_mask:0xf bank_mask:0xf
  s_nop 1
  v_add_f32_dpp v213, v213, v213 row_half_mirror row_mask:0xf bank_mask:0xf
  s_nop 1
  v_add_f32_dpp v213, v213, v213 row_mirror row_mask:0xf bank_mask:0xf
  v_mov_b32 v214, v213
  s_nop 1
  v_permlane16_swap_b32 v213, v214
  v_add_f32 v213, v213, v214
  v_mul_f32 v216, 0xbacccccd, v213
  v_mul_f32 v217, 0xbacccccd, v213
  v_pk_add_f32 v[20:21], v[184:185], v[216:217]
  v_pk_mul_f32 v[16:17], v[20:21], v[20:21]
  v_pk_add_f32 v[22:23], v[186:187], v[216:217]
  v_pk_fma_f32 v[16:17], v[22:23], v[22:23], v[16:17]
  v_pk_add_f32 v[24:25], v[188:189], v[216:217]
  v_pk_fma_f32 v[16:17], v[24:25], v[24:25], v[16:17]
  v_pk_add_f32 v[26:27], v[190:191], v[216:217]
  v_pk_fma_f32 v[16:17], v[26:27], v[26:27], v[16:17]
  v_pk_add_f32 v[20:21], v[192:193], v[216:217]
  v_pk_fma_f32 v[16:17], v[20:21], v[20:21], v[16:17]
  v_pk_add_f32 v[22:23], v[194:195], v[216:217]
  v_pk_fma_f32 v[16:17], v[22:23], v[22:23], v[16:17]
  v_pk_add_f32 v[24:25], v[196:197], v[216:217]
  v_pk_fma_f32 v[16:17], v[24:25], v[24:25], v[16:17]
  v_pk_add_f32 v[26:27], v[198:199], v[216:217]
  v_pk_fma_f32 v[16:17], v[26:27], v[26:27], v[16:17]
  v_pk_add_f32 v[20:21], v[200:201], v[216:217]
  v_pk_mul_f32 v[18:19], v[20:21], v[20:21]
  v_pk_add_f32 v[22:23], v[202:203], v[216:217]
  v_pk_fma_f32 v[18:19], v[22:23], v[22:23], v[18:19]
  v_pk_add_f32 v[24:25], v[204:205], v[216:217]
  v_pk_fma_f32 v[18:19], v[24:25], v[24:25], v[18:19]
  v_pk_add_f32 v[26:27], v[206:207], v[216:217]
  v_pk_fma_f32 v[18:19], v[26:27], v[26:27], v[18:19]
  v_add_f32 v18, v18, v19
  v_add_f32 v213, v16, v17
  v_cndmask_b32 v18, 0, v18, s[64:65]
  v_add_f32 v213, v213, v18
  s_nop 1
  v_add_f32_dpp v213, v213, v213 quad_perm:[1,0,3,2] row_mask:0xf bank_mask:0xf
  s_nop 1
  v_add_f32_dpp v213, v213, v213 quad_perm:[2,3,0,1] row_mask:0xf bank_mask:0xf
  s_nop 1
  v_add_f32_dpp v213, v213, v213 row_half_mirror row_mask:0xf bank_mask:0xf
  s_nop 1
  v_add_f32_dpp v213, v213, v213 row_mirror row_mask:0xf bank_mask:0xf
  v_mov_b32 v214, v213
  s_nop 1
  v_permlane16_swap_b32 v213, v214
  v_add_f32 v213, v213, v214
  v_mul_f32 v213, 0x3acccccd, v213
  v_cvt_pk_bf16_f32 v213, v213, v213
  v_and_b32 v213, 0xffff0000, v213
  v_add_f32 v213, 0x3727c5ac, v213
  v_cvt_pk_bf16_f32 v213, v213, v213
  v_and_b32 v213, 0xffff0000, v213
  v_sqrt_f32 v213, v213
  v_cvt_pk_bf16_f32 v216, v216, v216
  v_and_b32 v216, 0xffff0000, v216
  v_cvt_pk_bf16_f32 v213, v213, v213
  v_and_b32 v213, 0xffff0000, v213
  v_rcp_f32 v28, v213
  v_mov_b32 v217, v216
  v_mov_b32 v29, v28
  v_pk_add_f32 v[184:185], v[184:185], v[216:217]
  v_lshlrev_b32 v16, 16, v172
  v_cvt_pk_bf16_f32 v185, v184, v185
  v_and_b32 v17, 0xffff0000, v172
  v_lshlrev_b32 v184, 16, v185
  v_and_b32 v185, 0xffff0000, v185
  v_pk_mul_f32 v[184:185], v[184:185], v[28:29]
  v_cvt_pk_bf16_f32 v160, v184, v185
  v_lshlrev_b32 v184, 16, v160
  v_and_b32 v185, 0xffff0000, v160
  v_pk_mul_f32 v[218:219], v[184:185], v[16:17]
  v_pk_add_f32 v[186:187], v[186:187], v[216:217]
  v_lshlrev_b32 v18, 16, v173
  v_cvt_pk_bf16_f32 v187, v186, v187
  v_and_b32 v19, 0xffff0000, v173
  v_lshlrev_b32 v186, 16, v187
  v_and_b32 v187, 0xffff0000, v187
  v_pk_mul_f32 v[186:187], v[186:187], v[28:29]
  v_cvt_pk_bf16_f32 v161, v186, v187
  v_lshlrev_b32 v186, 16, v161
  v_and_b32 v187, 0xffff0000, v161
  v_pk_fma_f32 v[218:219], v[186:187], v[18:19], v[218:219]
  v_pk_add_f32 v[188:189], v[188:189], v[216:217]
  v_lshlrev_b32 v16, 16, v174
  v_cvt_pk_bf16_f32 v189, v188, v189
  v_and_b32 v17, 0xffff0000, v174
  v_lshlrev_b32 v188, 16, v189
  v_and_b32 v189, 0xffff0000, v189
  v_pk_mul_f32 v[188:189], v[188:189], v[28:29]
  v_cvt_pk_bf16_f32 v162, v188, v189
  v_lshlrev_b32 v188, 16, v162
  v_and_b32 v189, 0xffff0000, v162
  v_pk_fma_f32 v[218:219], v[188:189], v[16:17], v[218:219]
  v_pk_add_f32 v[190:191], v[190:191], v[216:217]
  v_lshlrev_b32 v18, 16, v175
  v_cvt_pk_bf16_f32 v191, v190, v191
  v_and_b32 v19, 0xffff0000, v175
  v_lshlrev_b32 v190, 16, v191
  v_and_b32 v191, 0xffff0000, v191
  v_pk_mul_f32 v[190:191], v[190:191], v[28:29]
  v_cvt_pk_bf16_f32 v163, v190, v191
  v_lshlrev_b32 v190, 16, v163
  v_and_b32 v191, 0xffff0000, v163
  v_pk_fma_f32 v[218:219], v[190:191], v[18:19], v[218:219]
  ds_write_b128 v220, v[160:163] offset:0
  v_pk_add_f32 v[192:193], v[192:193], v[216:217]
  v_lshlrev_b32 v16, 16, v176
  v_cvt_pk_bf16_f32 v193, v192, v193
  v_and_b32 v17, 0xffff0000, v176
  v_lshlrev_b32 v192, 16, v193
  v_and_b32 v193, 0xffff0000, v193
  v_pk_mul_f32 v[192:193], v[192:193], v[28:29]
  v_cvt_pk_bf16_f32 v164, v192, v193
  v_lshlrev_b32 v192, 16, v164
  v_and_b32 v193, 0xffff0000, v164
  v_pk_fma_f32 v[218:219], v[192:193], v[16:17], v[218:219]
  v_pk_add_f32 v[194:195], v[194:195], v[216:217]
  v_lshlrev_b32 v18, 16, v177
  v_cvt_pk_bf16_f32 v195, v194, v195
  v_and_b32 v19, 0xffff0000, v177
  v_lshlrev_b32 v194, 16, v195
  v_and_b32 v195, 0xffff0000, v195
  v_pk_mul_f32 v[194:195], v[194:195], v[28:29]
  v_cvt_pk_bf16_f32 v165, v194, v195
  v_lshlrev_b32 v194, 16, v165
  v_and_b32 v195, 0xffff0000, v165
  v_pk_fma_f32 v[218:219], v[194:195], v[18:19], v[218:219]
  v_pk_add_f32 v[196:197], v[196:197], v[216:217]
  v_lshlrev_b32 v16, 16, v178
  v_cvt_pk_bf16_f32 v197, v196, v197
  v_and_b32 v17, 0xffff0000, v178
  v_lshlrev_b32 v196, 16, v197
  v_and_b32 v197, 0xffff0000, v197
  v_pk_mul_f32 v[196:197], v[196:197], v[28:29]
  v_cvt_pk_bf16_f32 v166, v196, v197
  v_lshlrev_b32 v196, 16, v166
  v_and_b32 v197, 0xffff0000, v166
  v_pk_fma_f32 v[218:219], v[196:197], v[16:17], v[218:219]
  v_pk_add_f32 v[198:199], v[198:199], v[216:217]
  v_lshlrev_b32 v18, 16, v179
  v_cvt_pk_bf16_f32 v199, v198, v199
  v_and_b32 v19, 0xffff0000, v179
  v_lshlrev_b32 v198, 16, v199
  v_and_b32 v199, 0xffff0000, v199
  v_pk_mul_f32 v[198:199], v[198:199], v[28:29]
  v_cvt_pk_bf16_f32 v167, v198, v199
  v_lshlrev_b32 v198, 16, v167
  v_and_b32 v199, 0xffff0000, v167
  v_pk_fma_f32 v[218:219], v[198:199], v[18:19], v[218:219]
  ds_write_b128 v220, v[164:167] offset:4096
  v_pk_add_f32 v[200:201], v[200:201], v[216:217]
  v_lshlrev_b32 v16, 16, v180
  v_cvt_pk_bf16_f32 v201, v200, v201
  v_and_b32 v17, 0xffff0000, v180
  v_lshlrev_b32 v200, 16, v201
  v_and_b32 v201, 0xffff0000, v201
  v_pk_mul_f32 v[200:201], v[200:201], v[28:29]
  v_cvt_pk_bf16_f32 v168, v200, v201
  v_lshlrev_b32 v200, 16, v168
  v_and_b32 v201, 0xffff0000, v168
  v_pk_fma_f32 v[218:219], v[200:201], v[16:17], v[218:219]
  v_pk_add_f32 v[202:203], v[202:203], v[216:217]
  v_lshlrev_b32 v18, 16, v181
  v_cvt_pk_bf16_f32 v203, v202, v203
  v_and_b32 v19, 0xffff0000, v181
  v_lshlrev_b32 v202, 16, v203
  v_and_b32 v203, 0xffff0000, v203
  v_pk_mul_f32 v[202:203], v[202:203], v[28:29]
  v_cvt_pk_bf16_f32 v169, v202, v203
  v_lshlrev_b32 v202, 16, v169
  v_and_b32 v203, 0xffff0000, v169
  v_pk_fma_f32 v[218:219], v[202:203], v[18:19], v[218:219]
  v_pk_add_f32 v[204:205], v[204:205], v[216:217]
  v_lshlrev_b32 v16, 16, v182
  v_cvt_pk_bf16_f32 v205, v204, v205
  v_and_b32 v17, 0xffff0000, v182
  v_lshlrev_b32 v204, 16, v205
  v_and_b32 v205, 0xffff0000, v205
  v_pk_mul_f32 v[204:205], v[204:205], v[28:29]
  v_cvt_pk_bf16_f32 v170, v204, v205
  v_lshlrev_b32 v204, 16, v170
  v_and_b32 v205, 0xffff0000, v170
  v_pk_fma_f32 v[218:219], v[204:205], v[16:17], v[218:219]
  v_pk_add_f32 v[206:207], v[206:207], v[216:217]
  v_lshlrev_b32 v18, 16, v183
  v_cvt_pk_bf16_f32 v207, v206, v207
  v_and_b32 v19, 0xffff0000, v183
  v_lshlrev_b32 v206, 16, v207
  v_and_b32 v207, 0xffff0000, v207
  v_pk_mul_f32 v[206:207], v[206:207], v[28:29]
  v_cvt_pk_bf16_f32 v171, v206, v207
  v_lshlrev_b32 v206, 16, v171
  v_and_b32 v207, 0xffff0000, v171
  v_pk_fma_f32 v[218:219], v[206:207], v[18:19], v[218:219]
  ds_write_b128 v220, v[168:171] offset:8192
  v_add_f32 v218, v218, v219
  s_nop 1
  v_add_f32_dpp v218, v218, v218 quad_perm:[1,0,3,2] row_mask:0xf bank_mask:0xf
  s_nop 1
  v_add_f32_dpp v218, v218, v218 quad_perm:[2,3,0,1] row_mask:0xf bank_mask:0xf
  s_nop 1
  v_add_f32_dpp v218, v218, v218 row_half_mirror row_mask:0xf bank_mask:0xf
  s_nop 1
  v_add_f32_dpp v218, v218, v218 row_mirror row_mask:0xf bank_mask:0xf
  v_mov_b32 v214, v218
  s_nop 1
  v_permlane16_swap_b32 v218, v214
  v_add_f32 v218, v218, v214
  v_cvt_pk_bf16_f32 v218, v218, v218
  v_and_b32 v218, 0xffff0000, v218
  v_ashrrev_i32 v214, 31, v218
  v_or_b32 v214, 0x80000000, v214
  v_xor_b32 v218, v218, v214
  v_and_b32 v218, 0xffff0000, v218
  v_or_b32 v218, v218, v209
  v_mov_b32 v19, 1073741824
  s_mov_b32 m0, s24
  s_nop 0
  buffer_load_dwordx4 v3, s[32:35], s26 offen offset:0 sc1 lds
  buffer_load_dwordx4 v4, s[32:35], s26 offen offset:1024 sc1 lds
  buffer_load_dwordx4 v5, s[32:35], s26 offen offset:2048 sc1 lds
  buffer_load_dwordx4 v6, s[32:35], s26 offen offset:3072 sc1 lds
  s_add_u32 m0, s24, 16384
  s_nop 0
  buffer_load_dwordx4 v8, s[36:39], s27 offen offset:0 lds
  buffer_load_dwordx4 v9, s[36:39], s27 offen offset:1024 lds
  buffer_load_dwordx4 v10, s[36:39], s27 offen offset:2048 lds
  buffer_load_dwordx4 v11, s[36:39], s27 offen offset:3072 lds
  s_add_u32 s26, s26, s79
  s_add_u32 s27, s27, s25
  s_add_u32 s24, s24, 32768
  s_and_b32 s24, s24, 0x1ffff
  s_mov_b32 m0, s24
  s_nop 0
  buffer_load_dwordx4 v3, s[32:35], s26 offen offset:0 sc1 lds
  buffer_load_dwordx4 v4, s[32:35], s26 offen offset:1024 sc1 lds
  buffer_load_dwordx4 v5, s[32:35], s26 offen offset:2048 sc1 lds
  buffer_load_dwordx4 v6, s[32:35], s26 offen offset:3072 sc1 lds
  s_add_u32 m0, s24, 16384
  s_nop 0
  buffer_load_dwordx4 v8, s[36:39], s27 offen offset:0 lds
  buffer_load_dwordx4 v9, s[36:39], s27 offen offset:1024 lds
  buffer_load_dwordx4 v10, s[36:39], s27 offen offset:2048 lds
  buffer_load_dwordx4 v11, s[36:39], s27 offen offset:3072 lds
  s_add_u32 s26, s26, s79
  s_add_u32 s27, s27, s25
  s_add_u32 s24, s24, 32768
  s_and_b32 s24, s24, 0x1ffff
  s_mov_b32 m0, s24
  s_nop 0
  buffer_load_dwordx4 v3, s[32:35], s26 offen offset:0 sc1 lds
  buffer_load_dwordx4 v4, s[32:35], s26 offen offset:1024 sc1 lds
  buffer_load_dwordx4 v5, s[32:35], s26 offen offset:2048 sc1 lds
  buffer_load_dwordx4 v6, s[32:35], s26 offen offset:3072 sc1 lds
  s_add_u32 m0, s24, 16384
  s_nop 0
  buffer_load_dwordx4 v8, s[36:39], s27 offen offset:0 lds
  buffer_load_dwordx4 v9, s[36:39], s27 offen offset:1024 lds
  buffer_load_dwordx4 v10, s[36:39], s27 offen offset:2048 lds
  buffer_load_dwordx4 v11, s[36:39], s27 offen offset:3072 lds
  s_add_u32 s26, s26, s79
  s_add_u32 s27, s27, s25
  s_add_u32 s24, s24, 32768
  s_and_b32 s24, s24, 0x1ffff
  buffer_load_dword v231, v19, s[32:35], 0 offen
  s_mov_b32 m0, s24
  s_nop 0
  buffer_load_dwordx4 v3, s[32:35], s26 offen offset:0 sc1 lds
  buffer_load_dwordx4 v4, s[32:35], s26 offen offset:1024 sc1 lds
  buffer_load_dwordx4 v5, s[32:35], s26 offen offset:2048 sc1 lds
  buffer_load_dwordx4 v6, s[32:35], s26 offen offset:3072 sc1 lds
  s_add_u32 m0, s24, 16384
  s_nop 0
  buffer_load_dwordx4 v8, s[36:39], s27 offen offset:0 lds
  buffer_load_dwordx4 v9, s[36:39], s27 offen offset:1024 lds
  buffer_load_dwordx4 v10, s[36:39], s27 offen offset:2048 lds
  buffer_load_dwordx4 v11, s[36:39], s27 offen offset:3072 lds
  s_add_u32 s26, s26, s79
  s_add_u32 s27, s27, s25
  s_add_u32 s24, s24, 32768
  s_and_b32 s24, s24, 0x1ffff
  s_waitcnt vmcnt(25) lgkmcnt(0)
  s_barrier
  s_cmp_ge_u32 s20, 2
  s_cbranch_scc1 fa_roleV
  ds_read_b128 v[96:99], v14 offset:0
  ds_read_b128 v[100:103], v14 offset:1024
  ds_read_b128 v[104:107], v14 offset:2048
  ds_read_b128 v[108:111], v14 offset:3072
  ds_read_b128 v[112:115], v14 offset:4096
  ds_read_b128 v[116:119], v14 offset:5120
  ds_read_b128 v[120:123], v14 offset:6144
  ds_read_b128 v[124:127], v14 offset:7168
  ds_read_b64_tr_b16 v[32:33], v12 offset:0
  ds_read_b64_tr_b16 v[34:35], v12 offset:1024
  ds_read_b64_tr_b16 v[36:37], v13 offset:0
  ds_read_b64_tr_b16 v[38:39], v13 offset:1024
  ds_read_b64_tr_b16 v[40:41], v12 offset:256
  ds_read_b64_tr_b16 v[42:43], v12 offset:1280
  ds_read_b64_tr_b16 v[44:45], v13 offset:256
  ds_read_b64_tr_b16 v[46:47], v13 offset:1280
  ds_read_b64_tr_b16 v[48:49], v12 offset:512
  ds_read_b64_tr_b16 v[50:51], v12 offset:1536
  ds_read_b64_tr_b16 v[52:53], v13 offset:512
  ds_read_b64_tr_b16 v[54:55], v13 offset:1536
  ds_read_b64_tr_b16 v[56:57], v12 offset:768
  ds_read_b64_tr_b16 v[58:59], v12 offset:1792
  ds_read_b64_tr_b16 v[60:61], v13 offset:768
  ds_read_b64_tr_b16 v[62:63], v13 offset:1792
  s_waitcnt lgkmcnt(0)
.p2align 6
fa_loopK:
  v_mfma_f32_16x16x32_bf16 a[0:3], v[32:35], v[96:99], a[0:3]
  s_waitcnt vmcnt(17)
  v_mfma_f32_16x16x32_bf16 a[4:7], v[32:35], v[100:103], a[4:7]
  s_barrier
  v_mfma_f32_16x16x32_bf16 a[8:11], v[32:35], v[104:107], a[8:11]
  ds_read_b64_tr_b16 v[64:65], v12 offset:32768
  v_mfma_f32_16x16x32_bf16 a[12:15], v[32:35], v[108:111], a[12:15]
  v_mfma_f32_16x16x32_bf16 a[16:19], v[32:35], v[112:115], a[16:19]
  s_mov_b32 m0, s24
  ds_read_b64_tr_b16 v[66:67], v12 offset:33792
  v_mfma_f32_16x16x32_bf16 a[20:23], v[32:35], v[116:119], a[20:23]
  buffer_load_dwordx4 v3, s[32:35], s26 offen offset:0 sc1 lds
  v_mfma_f32_16x16x32_bf16 a[24:27], v[32:35], v[120:123], a[24:27]
  ds_read_b128 v[128:131], v14 offset:32768
  v_mfma_f32_16x16x32_bf16 a[28:31], v[32:35], v[124:127], a[28:31]
  buffer_load_dwordx4 v4, s[32:35], s26 offen offset:1024 sc1 lds
  v_mfma_f32_16x16x32_bf16 a[32:35], v[36:39], v[96:99], a[32:35]
  ds_read_b64_tr_b16 v[68:69], v13 offset:32768
  v_mfma_f32_16x16x32_bf16 a[36:39], v[36:39], v[100:103], a[36:39]
  buffer_load_dwordx4 v5, s[32:35], s26 offen offset:2048 sc1 lds
  v_mfma_f32_16x16x32_bf16 a[40:43], v[36:39], v[104:107], a[40:43]
  ds_read_b64_tr_b16 v[70:71], v13 offset:33792
  v_mfma_f32_16x16x32_bf16 a[44:47], v[36:39], v[108:111], a[44:47]
  buffer_load_dwordx4 v6, s[32:35], s26 offen offset:3072 sc1 lds
  v_mfma_f32_16x16x32_bf16 a[48:51], v[36:39], v[112:115], a[48:51]
  s_add_u32 m0, s24, 16384
  ds_read_b128 v[132:135], v14 offset:33792
  v_mfma_f32_16x16x32_bf16 a[52:55], v[36:39], v[116:119], a[52:55]
  buffer_load_dwordx4 v8, s[36:39], s27 offen offset:0 lds
  v_mfma_f32_16x16x32_bf16 a[56:59], v[36:39], v[120:123], a[56:59]
  ds_read_b64_tr_b16 v[72:73], v12 offset:33024
  v_mfma_f32_16x16x32_bf16 a[60:63], v[36:39], v[124:127], a[60:63]
  buffer_load_dwordx4 v9, s[36:39], s27 offen offset:1024 lds
  v_mfma_f32_16x16x32_bf16 a[64:67], v[40:43], v[96:99], a[64:67]
  ds_read_b64_tr_b16 v[74:75], v12 offset:34048
  v_mfma_f32_16x16x32_bf16 a[68:71], v[40:43], v[100:103], a[68:71]
  buffer_load_dwordx4 v10, s[36:39], s27 offen offset:2048 lds
  v_mfma_f32_16x16x32_bf16 a[72:75], v[40:43], v[104:107], a[72:75]
  ds_read_b128 v[136:139], v14 offset:34816
  v_mfma_f32_16x16x32_bf16 a[76:79], v[40:43], v[108:111], a[76:79]
  buffer_load_dwordx4 v11, s[36:39], s27 offen offset:3072 lds
  v_mfma_f32_16x16x32_bf16 a[80:83], v[40:43], v[112:115], a[80:83]
  ds_read_b64_tr_b16 v[76:77], v13 offset:33024
  v_mfma_f32_16x16x32_bf16 a[84:87], v[40:43], v[116:119], a[84:87]
  buffer_load_dword v231, v235, s[48:51], s74 offen sc1
  v_mfma_f32_16x16x32_bf16 a[88:91], v[40:43], v[120:123], a[88:91]
  s_add_u32 s74, s74, s73
  ds_read_b64_tr_b16 v[78:79], v13 offset:34048
  v_mfma_f32_16x16x32_bf16 a[92:95], v[40:43], v[124:127], a[92:95]
  s_bitcmp1_b32 s72, s28
  v_mfma_f32_16x16x32_bf16 a[96:99], v[44:47], v[96:99], a[96:99]
  s_cbranch_scc1 fa_hk0
fa_hb0:
  ds_read_b128 v[140:143], v14 offset:35840
  v_mfma_f32_16x16x32_bf16 a[100:103], v[44:47], v[100:103], a[100:103]
  v_mfma_f32_16x16x32_bf16 a[104:107], v[44:47], v[104:107], a[104:107]
  ds_read_b64_tr_b16 v[80:81], v12 offset:33280
  v_mfma_f32_16x16x32_bf16 a[108:111], v[44:47], v[108:111], a[108:111]
  v_mfma_f32_16x16x32_bf16 a[112:115], v[44:47], v[112:115], a[112:115]
  ds_read_b64_tr_b16 v[82:83], v12 offset:34304
  v_mfma_f32_16x16x32_bf16 a[116:119], v[44:47], v[116:119], a[116:119]
  v_mfma_f32_16x16x32_bf16 a[120:123], v[44:47], v[120:123], a[120:123]
  ds_read_b128 v[144:147], v14 offset:36864
  v_mfma_f32_16x16x32_bf16 a[124:127], v[44:47], v[124:127], a[124:127]
  v_mfma_f32_16x16x32_bf16 a[128:131], v[48:51], v[96:99], a[128:131]
  ds_read_b64_tr_b16 v[84:85], v13 offset:33280
  v_mfma_f32_16x16x32_bf16 a[132:135], v[48:51], v[100:103], a[132:135]
  v_mfma_f32_16x16x32_bf16 a[136:139], v[48:51], v[104:107], a[136:139]
  ds_read_b64_tr_b16 v[86:87], v13 offset:34304
  v_mfma_f32_16x16x32_bf16 a[140:143], v[48:51], v[108:111], a[140:143]
  v_mfma_f32_16x16x32_bf16 a[144:147], v[48:51], v[112:115], a[144:147]
  ds_read_b128 v[148:151], v14 offset:37888
  v_mfma_f32_16x16x32_bf16 a[148:151], v[48:51], v[116:119], a[148:151]
  v_mfma_f32_16x16x32_bf16 a[152:155], v[48:51], v[120:123], a[152:155]
  ds_read_b64_tr_b16 v[88:89], v12 offset:33536
  v_mfma_f32_16x16x32_bf16 a[156:159], v[48:51], v[124:127], a[156:159]
  v_mfma_f32_16x16x32_bf16 a[160:163], v[52:55], v[96:99], a[160:163]
  ds_read_b64_tr_b16 v[90:91], v12 offset:34560
  v_mfma_f32_16x16x32_bf16 a[164:167], v[52:55], v[100:103], a[164:167]
  v_mfma_f32_16x16x32_bf16 a[168:171], v[52:55], v[104:107], a[168:171]
  ds_read_b128 v[152:155], v14 offset:38912
  v_mfma_f32_16x16x32_bf16 a[172:175], v[52:55], v[108:111], a[172:175]
  v_mfma_f32_16x16x32_bf16 a[176:179], v[52:55], v[112:115], a[176:179]
  ds_read_b64_tr_b16 v[92:93], v13 offset:33536
  v_mfma_f32_16x16x32_bf16 a[180:183], v[52:55], v[116:119], a[180:183]
  v_mfma_f32_16x16x32_bf16 a[184:187], v[52:55], v[120:123], a[184:187]
  ds_read_b64_tr_b16 v[94:95], v13 offset:34560
  v_mfma_f32_16x16x32_bf16 a[188:191], v[52:55], v[124:127], a[188:191]
  v_mfma_f32_16x16x32_bf16 a[192:195], v[56:59], v[96:99], a[192:195]
  s_add_u32 s26, s26, s79
  ds_read_b128 v[156:159], v14 offset:39936
  v_mfma_f32_16x16x32_bf16 a[196:199], v[56:59], v[100:103], a[196:199]
  s_add_u32 s27, s27, s25
  v_mfma_f32_16x16x32_bf16 a[200:203], v[56:59], v[104:107], a[200:203]
  s_add_u32 s24, s24, 32768
  v_mfma_f32_16x16x32_bf16 a[204:207], v[56:59], v[108:111], a[204:207]
  s_and_b32 s24, s24, 0x1ffff
  v_mfma_f32_16x16x32_bf16 a[208:211], v[56:59], v[112:115], a[208:211]
  v_xor_b32 v14, 0x10000, v14
  v_mfma_f32_16x16x32_bf16 a[212:215], v[56:59], v[116:119], a[212:215]
  v_xor_b32 v12, 0x10000, v12
  v_mfma_f32_16x16x32_bf16 a[216:219], v[56:59], v[120:123], a[216:219]
  v_xor_b32 v13, 0x10000, v13
  v_mfma_f32_16x16x32_bf16 a[220:223], v[56:59], v[124:127], a[220:223]
  v_mfma_f32_16x16x32_bf16 a[224:227], v[60:63], v[96:99], a[224:227]
  v_mfma_f32_16x16x32_bf16 a[228:231], v[60:63], v[100:103], a[228:231]
  v_mfma_f32_16x16x32_bf16 a[232:235], v[60:63], v[104:107], a[232:235]
  v_mfma_f32_16x16x32_bf16 a[236:239], v[60:63], v[108:111], a[236:239]
  v_mfma_f32_16x16x32_bf16 a[240:243], v[60:63], v[112:115], a[240:243]
  v_mfma_f32_16x16x32_bf16 a[244:247], v[60:63], v[116:119], a[244:247]
  v_mfma_f32_16x16x32_bf16 a[248:251], v[60:63], v[120:123], a[248:251]
  v_mfma_f32_16x16x32_bf16 a[252:255], v[60:63], v[124:127], a[252:255]
  s_waitcnt lgkmcnt(0)
  v_mfma_f32_16x16x32_bf16 a[0:3], v[64:67], v[128:131], a[0:3]
  s_waitcnt vmcnt(18)
  v_mfma_f32_16x16x32_bf16 a[4:7], v[64:67], v[132:135], a[4:7]
  s_barrier
  v_mfma_f32_16x16x32_bf16 a[8:11], v[64:67], v[136:139], a[8:11]
  ds_read_b64_tr_b16 v[32:33], v12 offset:0
  v_mfma_f32_16x16x32_bf16 a[12:15], v[64:67], v[140:143], a[12:15]
  v_mfma_f32_16x16x32_bf16 a[16:19], v[64:67], v[144:147], a[16:19]
  s_mov_b32 m0, s24
  ds_read_b64_tr_b16 v[34:35], v12 offset:1024
  v_mfma_f32_16x16x32_bf16 a[20:23], v[64:67], v[148:151], a[20:23]
  buffer_load_dwordx4 v3, s[32:35], s26 offen offset:0 sc1 lds
  v_mfma_f32_16x16x32_bf16 a[24:27], v[64:67], v[152:155], a[24:27]
  ds_read_b128 v[96:99], v14 offset:0
  v_mfma_f32_16x16x32_bf16 a[28:31], v[64:67], v[156:159], a[28:31]
  v_mfma_f32_16x16x32_bf16 a[32:35], v[68:71], v[128:131], a[32:35]
  ds_read_b64_tr_b16 v[36:37], v13 offset:0
  v_mfma_f32_16x16x32_bf16 a[36:39], v[68:71], v[132:135], a[36:39]
  v_mfma_f32_16x16x32_bf16 a[40:43], v[68:71], v[136:139], a[40:43]
  ds_read_b64_tr_b16 v[38:39], v13 offset:1024
  v_mfma_f32_16x16x32_bf16 a[44:47], v[68:71], v[140:143], a[44:47]
  buffer_load_dwordx4 v4, s[32:35], s26 offen offset:1024 sc1 lds
  v_mfma_f32_16x16x32_bf16 a[48:51], v[68:71], v[144:147], a[48:51]
  ds_read_b128 v[100:103], v14 offset:1024
  v_mfma_f32_16x16x32_bf16 a[52:55], v[68:71], v[148:151], a[52:55]
  v_mfma_f32_16x16x32_bf16 a[56:59], v[68:71], v[152:155], a[56:59]
  ds_read_b64_tr_b16 v[40:41], v12 offset:256
  v_mfma_f32_16x16x32_bf16 a[60:63], v[68:71], v[156:159], a[60:63]
  v_mfma_f32_16x16x32_bf16 a[64:67], v[72:75], v[128:131], a[64:67]
  ds_read_b64_tr_b16 v[42:43], v12 offset:1280
  v_mfma_f32_16x16x32_bf16 a[68:71], v[72:75], v[132:135], a[68:71]
  buffer_load_dwordx4 v5, s[32:35], s26 offen offset:2048 sc1 lds
  v_mfma_f32_16x16x32_bf16 a[72:75], v[72:75], v[136:139], a[72:75]
  ds_read_b128 v[104:107], v14 offset:2048
  v_mfma_f32_16x16x32_bf16 a[76:79], v[72:75], v[140:143], a[76:79]
  v_mfma_f32_16x16x32_bf16 a[80:83], v[72:75], v[144:147], a[80:83]
  ds_read_b64_tr_b16 v[44:45], v13 offset:256
  v_mfma_f32_16x16x32_bf16 a[84:87], v[72:75], v[148:151], a[84:87]
  v_mfma_f32_16x16x32_bf16 a[88:91], v[72:75], v[152:155], a[88:91]
  ds_read_b64_tr_b16 v[46:47], v13 offset:1280
  v_mfma_f32_16x16x32_bf16 a[92:95], v[72:75], v[156:159], a[92:95]
  buffer_load_dwordx4 v6, s[32:35], s26 offen offset:3072 sc1 lds
  v_mfma_f32_16x16x32_bf16 a[96:99], v[76:79], v[128:131], a[96:99]
  ds_read_b128 v[108:111], v14 offset:3072
  v_mfma_f32_16x16x32_bf16 a[100:103], v[76:79], v[132:135], a[100:103]
  v_mfma_f32_16x16x32_bf16 a[104:107], v[76:79], v[136:139], a[104:107]
  ds_read_b64_tr_b16 v[48:49], v12 offset:512
  v_mfma_f32_16x16x32_bf16 a[108:111], v[76:79], v[140:143], a[108:111]
  v_mfma_f32_16x16x32_bf16 a[112:115], v[76:79], v[144:147], a[112:115]
  s_add_u32 m0, s24, 16384
  ds_read_b64_tr_b16 v[50:51], v12 offset:1536
  v_mfma_f32_16x16x32_bf16 a[116:119], v[76:79], v[148:151], a[116:119]
  buffer_load_dwordx4 v8, s[36:39], s27 offen offset:0 lds
  v_mfma_f32_16x16x32_bf16 a[120:123], v[76:79], v[152:155], a[120:123]
  ds_read_b128 v[112:115], v14 offset:4096
  v_mfma_f32_16x16x32_bf16 a[124:127], v[76:79], v[156:159], a[124:127]
  v_mfma_f32_16x16x32_bf16 a[128:131], v[80:83], v[128:131], a[128:131]
  ds_read_b64_tr_b16 v[52:53], v13 offset:512
  v_mfma_f32_16x16x32_bf16 a[132:135], v[80:83], v[132:135], a[132:135]
  v_mfma_f32_16x16x32_bf16 a[136:139], v[80:83], v[136:139], a[136:139]
  ds_read_b64_tr_b16 v[54:55], v13 offset:1536
  v_mfma_f32_16x16x32_bf16 a[140:143], v[80:83], v[140:143], a[140:143]
  buffer_load_dwordx4 v9, s[36:39], s27 offen offset:1024 lds
  v_mfma_f32_16x16x32_bf16 a[144:147], v[80:83], v[144:147], a[144:147]
  ds_read_b128 v[116:119], v14 offset:5120
  v_mfma_f32_16x16x32_bf16 a[148:151], v[80:83], v[148:151], a[148:151]
  v_mfma_f32_16x16x32_bf16 a[152:155], v[80:83], v[152:155], a[152:155]
  ds_read_b64_tr_b16 v[56:57], v12 offset:768
  v_mfma_f32_16x16x32_bf16 a[156:159], v[80:83], v[156:159], a[156:159]
  v_mfma_f32_16x16x32_bf16 a[160:163], v[84:87], v[128:131], a[160:163]
  ds_read_b64_tr_b16 v[58:59], v12 offset:1792
  v_mfma_f32_16x16x32_bf16 a[164:167], v[84:87], v[132:135], a[164:167]
  buffer_load_dwordx4 v10, s[36:39], s27 offen offset:2048 lds
  v_mfma_f32_16x16x32_bf16 a[168:171], v[84:87], v[136:139], a[168:171]
  ds_read_b128 v[120:123], v14 offset:6144
  v_mfma_f32_16x16x32_bf16 a[172:175], v[84:87], v[140:143], a[172:175]
  v_mfma_f32_16x16x32_bf16 a[176:179], v[84:87], v[144:147], a[176:179]
  ds_read_b64_tr_b16 v[60:61], v13 offset:768
  v_mfma_f32_16x16x32_bf16 a[180:183], v[84:87], v[148:151], a[180:183]
  v_mfma_f32_16x16x32_bf16 a[184:187], v[84:87], v[152:155], a[184:187]
  ds_read_b64_tr_b16 v[62:63], v13 offset:1792
  v_mfma_f32_16x16x32_bf16 a[188:191], v[84:87], v[156:159], a[188:191]
  buffer_load_dwordx4 v11, s[36:39], s27 offen offset:3072 lds
  v_mfma_f32_16x16x32_bf16 a[192:195], v[88:91], v[128:131], a[192:195]
  s_add_u32 s26, s26, s79
  ds_read_b128 v[124:127], v14 offset:7168
  v_mfma_f32_16x16x32_bf16 a[196:199], v[88:91], v[132:135], a[196:199]
  s_add_u32 s27, s27, s25
  v_mfma_f32_16x16x32_bf16 a[200:203], v[88:91], v[136:139], a[200:203]
  s_add_u32 s24, s24, 32768
  v_mfma_f32_16x16x32_bf16 a[204:207], v[88:91], v[140:143], a[204:207]
  s_and_b32 s24, s24, 0x1ffff
  v_mfma_f32_16x16x32_bf16 a[208:211], v[88:91], v[144:147], a[208:211]
  v_mfma_f32_16x16x32_bf16 a[212:215], v[88:91], v[148:151], a[212:215]
  s_bitcmp1_b32 s76, s28
  v_mfma_f32_16x16x32_bf16 a[216:219], v[88:91], v[152:155], a[216:219]
  s_cbranch_scc1 fa_hk1
fa_hb1:
  v_mfma_f32_16x16x32_bf16 a[220:223], v[88:91], v[156:159], a[220:223]
  v_mfma_f32_16x16x32_bf16 a[224:227], v[92:95], v[128:131], a[224:227]
  v_mfma_f32_16x16x32_bf16 a[228:231], v[92:95], v[132:135], a[228:231]
  s_add_u32 s28, s28, 1
  v_mfma_f32_16x16x32_bf16 a[232:235], v[92:95], v[136:139], a[232:235]
  v_mfma_f32_16x16x32_bf16 a[236:239], v[92:95], v[140:143], a[236:239]
  v_mfma_f32_16x16x32_bf16 a[240:243], v[92:95], v[144:147], a[240:243]
  v_mfma_f32_16x16x32_bf16 a[244:247], v[92:95], v[148:151], a[244:247]
  s_cmp_lt_u32 s28, 8
  v_mfma_f32_16x16x32_bf16 a[248:251], v[92:95], v[152:155], a[248:251]
  s_waitcnt lgkmcnt(0)
  v_mfma_f32_16x16x32_bf16 a[252:255], v[92:95], v[156:159], a[252:255]
  s_cbranch_scc1 fa_loopK
  s_mov_b32 s60, 2048
  s_mov_b32 s61, 8192
  s_mov_b32 s62, 16777216
  s_mov_b32 s76, 0x3e0293ee
  s_branch fa_p1epi
fa_roleV:
  ds_read_b128 v[32:35], v14 offset:0
  ds_read_b128 v[36:39], v14 offset:1024
  ds_read_b128 v[40:43], v14 offset:2048
  ds_read_b128 v[44:47], v14 offset:3072
  ds_read_b128 v[48:51], v14 offset:4096
  ds_read_b128 v[52:55], v14 offset:5120
  ds_read_b128 v[56:59], v14 offset:6144
  ds_read_b128 v[60:63], v14 offset:7168
  ds_read_b64_tr_b16 v[96:97], v12 offset:0
  ds_read_b64_tr_b16 v[98:99], v12 offset:1024
  ds_read_b64_tr_b16 v[100:101], v13 offset:0
  ds_read_b64_tr_b16 v[102:103], v13 offset:1024
  ds_read_b64_tr_b16 v[104:105], v12 offset:256
  ds_read_b64_tr_b16 v[106:107], v12 offset:1280
  ds_read_b64_tr_b16 v[108:109], v13 offset:256
  ds_read_b64_tr_b16 v[110:111], v13 offset:1280
  ds_read_b64_tr_b16 v[112:113], v12 offset:512
  ds_read_b64_tr_b16 v[114:115], v12 offset:1536
  ds_read_b64_tr_b16 v[116:117], v13 offset:512
  ds_read_b64_tr_b16 v[118:119], v13 offset:1536
  ds_read_b64_tr_b16 v[120:121], v12 offset:768
  ds_read_b64_tr_b16 v[122:123], v12 offset:1792
  ds_read_b64_tr_b16 v[124:125], v13 offset:768
  ds_read_b64_tr_b16 v[126:127], v13 offset:1792
  s_waitcnt lgkmcnt(0)
.p2align 6
fa_loopV:
  v_mfma_f32_16x16x32_bf16 a[0:3], v[32:35], v[96:99], a[0:3]
  s_waitcnt vmcnt(17)
  v_mfma_f32_16x16x32_bf16 a[4:7], v[32:35], v[100:103], a[4:7]
  s_barrier
  v_mfma_f32_16x16x32_bf16 a[8:11], v[32:35], v[104:107], a[8:11]
  ds_read_b64_tr_b16 v[128:129], v12 offset:32768
  v_mfma_f32_16x16x32_bf16 a[12:15], v[32:35], v[108:111], a[12:15]
  v_mfma_f32_16x16x32_bf16 a[16:19], v[32:35], v[112:115], a[16:19]
  s_mov_b32 m0, s24
  ds_read_b64_tr_b16 v[130:131], v12 offset:33792
  v_mfma_f32_16x16x32_bf16 a[20:23], v[32:35], v[116:119], a[20:23]
  buffer_load_dwordx4 v3, s[32:35], s26 offen offset:0 sc1 lds
  v_mfma_f32_16x16x32_bf16 a[24:27], v[32:35], v[120:123], a[24:27]
  ds_read_b128 v[64:67], v14 offset:32768
  v_mfma_f32_16x16x32_bf16 a[28:31], v[32:35], v[124:127], a[28:31]
  buffer_load_dwordx4 v4, s[32:35], s26 offen offset:1024 sc1 lds
  v_mfma_f32_16x16x32_bf16 a[32:35], v[36:39], v[96:99], a[32:35]
  ds_read_b64_tr_b16 v[132:133], v13 offset:32768
  v_mfma_f32_16x16x32_bf16 a[36:39], v[36:39], v[100:103], a[36:39]
  buffer_load_dwordx4 v5, s[32:35], s26 offen offset:2048 sc1 lds
  v_mfma_f32_16x16x32_bf16 a[40:43], v[36:39], v[104:107], a[40:43]
  ds_read_b64_tr_b16 v[134:135], v13 offset:33792
  v_mfma_f32_16x16x32_bf16 a[44:47], v[36:39], v[108:111], a[44:47]
  buffer_load_dwordx4 v6, s[32:35], s26 offen offset:3072 sc1 lds
  v_mfma_f32_16x16x32_bf16 a[48:51], v[36:39], v[112:115], a[48:51]
  s_add_u32 m0, s24, 16384
  ds_read_b128 v[68:71], v14 offset:33792
  v_mfma_f32_16x16x32_bf16 a[52:55], v[36:39], v[116:119], a[52:55]
  buffer_load_dwordx4 v8, s[36:39], s27 offen offset:0 lds
  v_mfma_f32_16x16x32_bf16 a[56:59], v[36:39], v[120:123], a[56:59]
  ds_read_b64_tr_b16 v[136:137], v12 offset:33024
  v_mfma_f32_16x16x32_bf16 a[60:63], v[36:39], v[124:127], a[60:63]
  buffer_load_dwordx4 v9, s[36:39], s27 offen offset:1024 lds
  v_mfma_f32_16x16x32_bf16 a[64:67], v[40:43], v[96:99], a[64:67]
  ds_read_b64_tr_b16 v[138:139], v12 offset:34048
  v_mfma_f32_16x16x32_bf16 a[68:71], v[40:43], v[100:103], a[68:71]
  buffer_load_dwordx4 v10, s[36:39], s27 offen offset:2048 lds
  v_mfma_f32_16x16x32_bf16 a[72:75], v[40:43], v[104:107], a[72:75]
  ds_read_b128 v[72:75], v14 offset:34816
  v_mfma_f32_16x16x32_bf16 a[76:79], v[40:43], v[108:111], a[76:79]
  buffer_load_dwordx4 v11, s[36:39], s27 offen offset:3072 lds
  v_mfma_f32_16x16x32_bf16 a[80:83], v[40:43], v[112:115], a[80:83]
  ds_read_b64_tr_b16 v[140:141], v13 offset:33024
  v_mfma_f32_16x16x32_bf16 a[84:87], v[40:43], v[116:119], a[84:87]
  buffer_load_dword v231, v235, s[48:51], s74 offen sc1
  v_mfma_f32_16x16x32_bf16 a[88:91], v[40:43], v[120:123], a[88:91]
  s_add_u32 s74, s74, s73
  ds_read_b64_tr_b16 v[142:143], v13 offset:34048
  v_mfma_f32_16x16x32_bf16 a[92:95], v[40:43], v[124:127], a[92:95]
  s_bitcmp1_b32 s72, s28
  v_mfma_f32_16x16x32_bf16 a[96:99], v[44:47], v[96:99], a[96:99]
  s_cbranch_scc1 fa_hk2
fa_hb2:
  ds_read_b128 v[76:79], v14 offset:35840
  v_mfma_f32_16x16x32_bf16 a[100:103], v[44:47], v[100:103], a[100:103]
  v_mfma_f32_16x16x32_bf16 a[104:107], v[44:47], v[104:107], a[104:107]
  ds_read_b64_tr_b16 v[144:145], v12 offset:33280
  v_mfma_f32_16x16x32_bf16 a[108:111], v[44:47], v[108:111], a[108:111]
  v_mfma_f32_16x16x32_bf16 a[112:115], v[44:47], v[112:115], a[112:115]
  ds_read_b64_tr_b16 v[146:147], v12 offset:34304
  v_mfma_f32_16x16x32_bf16 a[116:119], v[44:47], v[116:119], a[116:119]
  v_mfma_f32_16x16x32_bf16 a[120:123], v[44:47], v[120:123], a[120:123]
  ds_read_b128 v[80:83], v14 offset:36864
  v_mfma_f32_16x16x32_bf16 a[124:127], v[44:47], v[124:127], a[124:127]
  v_mfma_f32_16x16x32_bf16 a[128:131], v[48:51], v[96:99], a[128:131]
  ds_read_b64_tr_b16 v[148:149], v13 offset:33280
  v_mfma_f32_16x16x32_bf16 a[132:135], v[48:51], v[100:103], a[132:135]
  v_mfma_f32_16x16x32_bf16 a[136:139], v[48:51], v[104:107], a[136:139]
  ds_read_b64_tr_b16 v[150:151], v13 offset:34304
  v_mfma_f32_16x16x32_bf16 a[140:143], v[48:51], v[108:111], a[140:143]
  v_mfma_f32_16x16x32_bf16 a[144:147], v[48:51], v[112:115], a[144:147]
  ds_read_b128 v[84:87], v14 offset:37888
  v_mfma_f32_16x16x32_bf16 a[148:151], v[48:51], v[116:119], a[148:151]
  v_mfma_f32_16x16x32_bf16 a[152:155], v[48:51], v[120:123], a[152:155]
  ds_read_b64_tr_b16 v[152:153], v12 offset:33536
  v_mfma_f32_16x16x32_bf16 a[156:159], v[48:51], v[124:127], a[156:159]
  v_mfma_f32_16x16x32_bf16 a[160:163], v[52:55], v[96:99], a[160:163]
  ds_read_b64_tr_b16 v[154:155], v12 offset:34560
  v_mfma_f32_16x16x32_bf16 a[164:167], v[52:55], v[100:103], a[164:167]
  v_mfma_f32_16x16x32_bf16 a[168:171], v[52:55], v[104:107], a[168:171]
  ds_read_b128 v[88:91], v14 offset:38912
  v_mfma_f32_16x16x32_bf16 a[172:175], v[52:55], v[108:111], a[172:175]
  v_mfma_f32_16x16x32_bf16 a[176:179], v[52:55], v[112:115], a[176:179]
  ds_read_b64_tr_b16 v[156:157], v13 offset:33536
  v_mfma_f32_16x16x32_bf16 a[180:183], v[52:55], v[116:119], a[180:183]
  v_mfma_f32_16x16x32_bf16 a[184:187], v[52:55], v[120:123], a[184:187]
  ds_read_b64_tr_b16 v[158:159], v13 offset:34560
  v_mfma_f32_16x16x32_bf16 a[188:191], v[52:55], v[124:127], a[188:191]
  v_mfma_f32_16x16x32_bf16 a[192:195], v[56:59], v[96:99], a[192:195]
  s_add_u32 s26, s26, s79
  ds_read_b128 v[92:95], v14 offset:39936
  v_mfma_f32_16x16x32_bf16 a[196:199], v[56:59], v[100:103], a[196:199]
  s_add_u32 s27, s27, s25
  v_mfma_f32_16x16x32_bf16 a[200:203], v[56:59], v[104:107], a[200:203]
  s_add_u32 s24, s24, 32768
  v_mfma_f32_16x16x32_bf16 a[204:207], v[56:59], v[108:111], a[204:207]
  s_and_b32 s24, s24, 0x1ffff
  v_mfma_f32_16x16x32_bf16 a[208:211], v[56:59], v[112:115], a[208:211]
  v_xor_b32 v14, 0x10000, v14
  v_mfma_f32_16x16x32_bf16 a[212:215], v[56:59], v[116:119], a[212:215]
  v_xor_b32 v12, 0x10000, v12
  v_mfma_f32_16x16x32_bf16 a[216:219], v[56:59], v[120:123], a[216:219]
  v_xor_b32 v13, 0x10000, v13
  v_mfma_f32_16x16x32_bf16 a[220:223], v[56:59], v[124:127], a[220:223]
  v_mfma_f32_16x16x32_bf16 a[224:227], v[60:63], v[96:99], a[224:227]
  v_mfma_f32_16x16x32_bf16 a[228:231], v[60:63], v[100:103], a[228:231]
  v_mfma_f32_16x16x32_bf16 a[232:235], v[60:63], v[104:107], a[232:235]
  v_mfma_f32_16x16x32_bf16 a[236:239], v[60:63], v[108:111], a[236:239]
  v_mfma_f32_16x16x32_bf16 a[240:243], v[60:63], v[112:115], a[240:243]
  v_mfma_f32_16x16x32_bf16 a[244:247], v[60:63], v[116:119], a[244:247]
  v_mfma_f32_16x16x32_bf16 a[248:251], v[60:63], v[120:123], a[248:251]
  v_mfma_f32_16x16x32_bf16 a[252:255], v[60:63], v[124:127], a[252:255]
  s_waitcnt lgkmcnt(0)
  v_mfma_f32_16x16x32_bf16 a[0:3], v[64:67], v[128:131], a[0:3]
  s_waitcnt vmcnt(18)
  v_mfma_f32_16x16x32_bf16 a[4:7], v[64:67], v[132:135], a[4:7]
  s_barrier
  v_mfma_f32_16x16x32_bf16 a[8:11], v[64:67], v[136:139], a[8:11]
  ds_read_b64_tr_b16 v[96:97], v12 offset:0
  v_mfma_f32_16x16x32_bf16 a[12:15], v[64:67], v[140:143], a[12:15]
  v_mfma_f32_16x16x32_bf16 a[16:19], v[64:67], v[144:147], a[16:19]
  s_mov_b32 m0, s24
  ds_read_b64_tr_b16 v[98:99], v12 offset:1024
  v_mfma_f32_16x16x32_bf16 a[20:23], v[64:67], v[148:151], a[20:23]
  buffer_load_dwordx4 v3, s[32:35], s26 offen offset:0 sc1 lds
  v_mfma_f32_16x16x32_bf16 a[24:27], v[64:67], v[152:155], a[24:27]
  ds_read_b128 v[32:35], v14 offset:0
  v_mfma_f32_16x16x32_bf16 a[28:31], v[64:67], v[156:159], a[28:31]
  v_mfma_f32_16x16x32_bf16 a[32:35], v[68:71], v[128:131], a[32:35]
  ds_read_b64_tr_b16 v[100:101], v13 offset:0
  v_mfma_f32_16x16x32_bf16 a[36:39], v[68:71], v[132:135], a[36:39]
  v_mfma_f32_16x16x32_bf16 a[40:43], v[68:71], v[136:139], a[40:43]
  ds_read_b64_tr_b16 v[102:103], v13 offset:1024
  v_mfma_f32_16x16x32_bf16 a[44:47], v[68:71], v[140:143], a[44:47]
  buffer_load_dwordx4 v4, s[32:35], s26 offen offset:1024 sc1 lds
  v_mfma_f32_16x16x32_bf16 a[48:51], v[68:71], v[144:147], a[48:51]
  ds_read_b128 v[36:39], v14 offset:1024
  v_mfma_f32_16x16x32_bf16 a[52:55], v[68:71], v[148:151], a[52:55]
  v_mfma_f32_16x16x32_bf16 a[56:59], v[68:71], v[152:155], a[56:59]
  ds_read_b64_tr_b16 v[104:105], v12 offset:256
  v_mfma_f32_16x16x32_bf16 a[60:63], v[68:71], v[156:159], a[60:63]
  v_mfma_f32_16x16x32_bf16 a[64:67], v[72:75], v[128:131], a[64:67]
  ds_read_b64_tr_b16 v[106:107], v12 offset:1280
  v_mfma_f32_16x16x32_bf16 a[68:71], v[72:75], v[132:135], a[68:71]
  buffer_load_dwordx4 v5, s[32:35], s26 offen offset:2048 sc1 lds
  v_mfma_f32_16x16x32_bf16 a[72:75], v[72:75], v[136:139], a[72:75]
  ds_read_b128 v[40:43], v14 offset:2048
  v_mfma_f32_16x16x32_bf16 a[76:79], v[72:75], v[140:143], a[76:79]
  v_mfma_f32_16x16x32_bf16 a[80:83], v[72:75], v[144:147], a[80:83]
  ds_read_b64_tr_b16 v[108:109], v13 offset:256
  v_mfma_f32_16x16x32_bf16 a[84:87], v[72:75], v[148:151], a[84:87]
  v_mfma_f32_16x16x32_bf16 a[88:91], v[72:75], v[152:155], a[88:91]
  ds_read_b64_tr_b16 v[110:111], v13 offset:1280
  v_mfma_f32_16x16x32_bf16 a[92:95], v[72:75], v[156:159], a[92:95]
  buffer_load_dwordx4 v6, s[32:35], s26 offen offset:3072 sc1 lds
  v_mfma_f32_16x16x32_bf16 a[96:99], v[76:79], v[128:131], a[96:99]
  ds_read_b128 v[44:47], v14 offset:3072
  v_mfma_f32_16x16x32_bf16 a[100:103], v[76:79], v[132:135], a[100:103]
  v_mfma_f32_16x16x32_bf16 a[104:107], v[76:79], v[136:139], a[104:107]
  ds_read_b64_tr_b16 v[112:113], v12 offset:512
  v_mfma_f32_16x16x32_bf16 a[108:111], v[76:79], v[140:143], a[108:111]
  v_mfma_f32_16x16x32_bf16 a[112:115], v[76:79], v[144:147], a[112:115]
  s_add_u32 m0, s24, 16384
  ds_read_b64_tr_b16 v[114:115], v12 offset:1536
  v_mfma_f32_16x16x32_bf16 a[116:119], v[76:79], v[148:151], a[116:119]
  buffer_load_dwordx4 v8, s[36:39], s27 offen offset:0 lds
  v_mfma_f32_16x16x32_bf16 a[120:123], v[76:79], v[152:155], a[120:123]
  ds_read_b128 v[48:51], v14 offset:4096
  v_mfma_f32_16x16x32_bf16 a[124:127], v[76:79], v[156:159], a[124:127]
  v_mfma_f32_16x16x32_bf16 a[128:131], v[80:83], v[128:131], a[128:131]
  ds_read_b64_tr_b16 v[116:117], v13 offset:512
  v_mfma_f32_16x16x32_bf16 a[132:135], v[80:83], v[132:135], a[132:135]
  v_mfma_f32_16x16x32_bf16 a[136:139], v[80:83], v[136:139], a[136:139]
  ds_read_b64_tr_b16 v[118:119], v13 offset:1536
  v_mfma_f32_16x16x32_bf16 a[140:143], v[80:83], v[140:143], a[140:143]
  buffer_load_dwordx4 v9, s[36:39], s27 offen offset:1024 lds
  v_mfma_f32_16x16x32_bf16 a[144:147], v[80:83], v[144:147], a[144:147]
  ds_read_b128 v[52:55], v14 offset:5120
  v_mfma_f32_16x16x32_bf16 a[148:151], v[80:83], v[148:151], a[148:151]
  v_mfma_f32_16x16x32_bf16 a[152:155], v[80:83], v[152:155], a[152:155]
  ds_read_b64_tr_b16 v[120:121], v12 offset:768
  v_mfma_f32_16x16x32_bf16 a[156:159], v[80:83], v[156:159], a[156:159]
  v_mfma_f32_16x16x32_bf16 a[160:163], v[84:87], v[128:131], a[160:163]
  ds_read_b64_tr_b16 v[122:123], v12 offset:1792
  v_mfma_f32_16x16x32_bf16 a[164:167], v[84:87], v[132:135], a[164:167]
  buffer_load_dwordx4 v10, s[36:39], s27 offen offset:2048 lds
  v_mfma_f32_16x16x32_bf16 a[168:171], v[84:87], v[136:139], a[168:171]
  ds_read_b128 v[56:59], v14 offset:6144
  v_mfma_f32_16x16x32_bf16 a[172:175], v[84:87], v[140:143], a[172:175]
  v_mfma_f32_16x16x32_bf16 a[176:179], v[84:87], v[144:147], a[176:179]
  ds_read_b64_tr_b16 v[124:125], v13 offset:768
  v_mfma_f32_16x16x32_bf16 a[180:183], v[84:87], v[148:151], a[180:183]
  v_mfma_f32_16x16x32_bf16 a[184:187], v[84:87], v[152:155], a[184:187]
  ds_read_b64_tr_b16 v[126:127], v13 offset:1792
  v_mfma_f32_16x16x32_bf16 a[188:191], v[84:87], v[156:159], a[188:191]
  buffer_load_dwordx4 v11, s[36:39], s27 offen offset:3072 lds
  v_mfma_f32_16x16x32_bf16 a[192:195], v[88:91], v[128:131], a[192:195]
  s_add_u32 s26, s26, s79
  ds_read_b128 v[60:63], v14 offset:7168
  v_mfma_f32_16x16x32_bf16 a[196:199], v[88:91], v[132:135], a[196:199]
  s_add_u32 s27, s27, s25
  v_mfma_f32_16x16x32_bf16 a[200:203], v[88:91], v[136:139], a[200:203]
  s_add_u32 s24, s24, 32768
  v_mfma_f32_16x16x32_bf16 a[204:207], v[88:91], v[140:143], a[204:207]
  s_and_b32 s24, s24, 0x1ffff
  v_mfma_f32_16x16x32_bf16 a[208:211], v[88:91], v[144:147], a[208:211]
  v_mfma_f32_16x16x32_bf16 a[212:215], v[88:91], v[148:151], a[212:215]
  s_bitcmp1_b32 s76, s28
  v_mfma_f32_16x16x32_bf16 a[216:219], v[88:91], v[152:155], a[216:219]
  s_cbranch_scc1 fa_hk3
fa_hb3:
  v_mfma_f32_16x16x32_bf16 a[220:223], v[88:91], v[156:159], a[220:223]
  v_mfma_f32_16x16x32_bf16 a[224:227], v[92:95], v[128:131], a[224:227]
  v_mfma_f32_16x16x32_bf16 a[228:231], v[92:95], v[132:135], a[228:231]
  s_add_u32 s28, s28, 1
  v_mfma_f32_16x16x32_bf16 a[232:235], v[92:95], v[136:139], a[232:235]
  v_mfma_f32_16x16x32_bf16 a[236:239], v[92:95], v[140:143], a[236:239]
  v_mfma_f32_16x16x32_bf16 a[240:243], v[92:95], v[144:147], a[240:243]
  v_mfma_f32_16x16x32_bf16 a[244:247], v[92:95], v[148:151], a[244:247]
  s_cmp_lt_u32 s28, 8
  v_mfma_f32_16x16x32_bf16 a[248:251], v[92:95], v[152:155], a[248:251]
  s_waitcnt lgkmcnt(0)
  v_mfma_f32_16x16x32_bf16 a[252:255], v[92:95], v[156:159], a[252:255]
  s_cbranch_scc1 fa_loopV
  s_mov_b32 s60, 8192
  s_mov_b32 s61, 2048
  s_mov_b32 s62, 33554432
  s_mov_b32 s76, 1.0
fa_p1epi:
  s_lshr_b32 s23, s20, 1
  s_lshl_b32 s23, s23, 13
  v_subrev_u32 v12, s23, v12
  v_subrev_u32 v13, s23, v13
  s_lshl_b32 s24, s20, 12
  v_add_u32 v14, s24, v2
  ds_read_b64_tr_b16 v[32:33], v12 offset:0
  ds_read_b64_tr_b16 v[34:35], v12 offset:1024
  ds_read_b64_tr_b16 v[36:37], v13 offset:0
  ds_read_b64_tr_b16 v[38:39], v13 offset:1024
  ds_read_b64_tr_b16 v[40:41], v12 offset:256
  ds_read_b64_tr_b16 v[42:43], v12 offset:1280
  ds_read_b64_tr_b16 v[44:45], v13 offset:256
  ds_read_b64_tr_b16 v[46:47], v13 offset:1280
  ds_read_b64_tr_b16 v[48:49], v12 offset:512
  ds_read_b64_tr_b16 v[50:51], v12 offset:1536
  ds_read_b64_tr_b16 v[52:53], v13 offset:512
  ds_read_b64_tr_b16 v[54:55], v13 offset:1536
  ds_read_b64_tr_b16 v[56:57], v12 offset:768
  ds_read_b64_tr_b16 v[58:59], v12 offset:1792
  ds_read_b64_tr_b16 v[60:61], v13 offset:768
  ds_read_b64_tr_b16 v[62:63], v13 offset:1792
  s_waitcnt vmcnt(8)
  ds_read_b128 v[224:227], v14 offset:0
  ds_read_b128 v[228:231], v14 offset:1024
  ds_read_b128 v[232:235], v14 offset:2048
  ds_read_b128 v[236:239], v14 offset:3072
  s_lshl_b32 s23, s21, 19
  s_add_u32 s62, s62, s23
  s_lshl_b32 s23, s22, 16
  s_add_u32 s62, s62, s23
  s_and_b32 s23, s20, 1
  s_lshl_b32 s23, s23, 15
  s_add_u32 s62, s62, s23
  s_lshl_b32 s23, s21, 19
  s_add_u32 s23, s23, 16777216
  s_add_u32 s6, s18, s23
  s_addc_u32 s7, s19, 0
  s_add_u32 s8, s6, 16777216
  s_addc_u32 s9, s7, 0
  s_sub_u32 s23, 16, s22
  s_lshl_b32 s23, s23, 15
  s_mov_b32 s44, s6
  s_mov_b32 s45, s7
  s_mov_b32 s46, s23
  s_mov_b32 s47, 0x20000
  s_mov_b32 s48, s8
  s_mov_b32 s49, s9
  s_mov_b32 s50, s23
  s_mov_b32 s51, 0x20000
  s_lshl_b32 s30, s21, 7
  s_add_u32 s30, s30, 2637824
  s_mov_b32 s81, 0x47800000
  s_cmp_eq_u32 s20, 0
  s_cselect_b32 s29, s82, 1073741824
  s_waitcnt vmcnt(21) lgkmcnt(0)
  v_mfma_f32_16x16x32_bf16 v[96:99], v[32:35], v[224:227], 0
  s_mul_i32 s63, s60, 0
  v_accvgpr_read_b32 v16, a0
  v_accvgpr_read_b32 v17, a1
  v_accvgpr_read_b32 v18, a2
  v_mfma_f32_16x16x32_bf16 v[112:115], v[36:39], v[224:227], 0
  s_add_u32 s63, s63, s62
  ds_read_b64_tr_b16 v[64:65], v12 offset:8192
  v_accvgpr_read_b32 v19, a3
  v_accvgpr_read_b32 v20, a32
  v_mfma_f32_16x16x32_bf16 v[128:131], v[40:43], v[224:227], 0
  s_add_u32 m0, s24, 0
  ds_read_b64_tr_b16 v[66:67], v12 offset:9216
  v_accvgpr_read_b32 v21, a33
  v_accvgpr_read_b32 v22, a34
  v_mfma_f32_16x16x32_bf16 v[144:147], v[44:47], v[224:227], 0
  buffer_load_dwordx4 v3, s[32:35], s26 offen offset:0 sc1 lds
  v_accvgpr_read_b32 v23, a35
  v_mul_f32 v16, s76, v16
  v_mfma_f32_16x16x32_bf16 v[160:163], v[48:51], v[224:227], 0
  ds_read_b64_tr_b16 v[68:69], v13 offset:8192
  v_mul_f32 v17, s76, v17
  v_mul_f32 v18, s76, v18
  v_mfma_f32_16x16x32_bf16 v[176:179], v[52:55], v[224:227], 0
  ds_read_b64_tr_b16 v[70:71], v13 offset:9216
  v_mul_f32 v19, s76, v19
  v_mul_f32 v20, s76, v20
  v_mfma_f32_16x16x32_bf16 v[192:195], v[56:59], v[224:227], 0
  ds_read_b64_tr_b16 v[72:73], v12 offset:8448
  v_mul_f32 v21, s76, v21
  v_mul_f32 v22, s76, v22
  v_mfma_f32_16x16x32_bf16 v[208:211], v[60:63], v[224:227], 0
  ds_read_b64_tr_b16 v[74:75], v12 offset:9472
  v_mul_f32 v23, s76, v23
  v_cvt_pk_bf16_f32 v24, v16, v17
  v_mfma_f32_16x16x32_bf16 v[100:103], v[32:35], v[228:231], 0
  buffer_load_dwordx4 v4, s[32:35], s26 offen offset:1024 sc1 lds
  v_cvt_pk_bf16_f32 v25, v18, v19
  v_cvt_pk_bf16_f32 v26, v20, v21
  v_mfma_f32_16x16x32_bf16 v[116:119], v[36:39], v[228:231], 0
  ds_read_b64_tr_b16 v[76:77], v13 offset:8448
  v_cvt_pk_bf16_f32 v27, v22, v23
  v_mfma_f32_16x16x32_bf16 v[132:135], v[40:43], v[228:231], 0
  ds_read_b64_tr_b16 v[78:79], v13 offset:9472
  buffer_store_dwordx4 v[24:27], v2, s[40:43], s63 offen offset:0 sc1
  v_accvgpr_read_b32 v16, a4
  v_mfma_f32_16x16x32_bf16 v[148:151], v[44:47], v[228:231], 0
  ds_read_b128 v[240:243], v14 offset:32768
  v_accvgpr_read_b32 v17, a5
  v_accvgpr_read_b32 v18, a6
  v_mfma_f32_16x16x32_bf16 v[164:167], v[48:51], v[228:231], 0
  ds_read_b128 v[244:247], v14 offset:33792
  v_accvgpr_read_b32 v19, a7
  v_accvgpr_read_b32 v20, a36
  v_mfma_f32_16x16x32_bf16 v[180:183], v[52:55], v[228:231], 0
  buffer_load_dwordx4 v5, s[32:35], s26 offen offset:2048 sc1 lds
  v_accvgpr_read_b32 v21, a37
  v_accvgpr_read_b32 v22, a38
  v_mfma_f32_16x16x32_bf16 v[196:199], v[56:59], v[228:231], 0
  ds_read_b64_tr_b16 v[80:81], v12 offset:8704
  v_accvgpr_read_b32 v23, a39
  v_mul_f32 v16, s76, v16
  v_mfma_f32_16x16x32_bf16 v[212:215], v[60:63], v[228:231], 0
  ds_read_b64_tr_b16 v[82:83], v12 offset:9728
  v_mul_f32 v17, s76, v17
  v_mul_f32 v18, s76, v18
  v_mfma_f32_16x16x32_bf16 v[104:107], v[32:35], v[232:235], 0
  ds_read_b64_tr_b16 v[84:85], v13 offset:8704
  v_mul_f32 v19, s76, v19
  v_mul_f32 v20, s76, v20
  v_mfma_f32_16x16x32_bf16 v[120:123], v[36:39], v[232:235], 0
  ds_read_b64_tr_b16 v[86:87], v13 offset:9728
  v_mul_f32 v21, s76, v21
  v_mul_f32 v22, s76, v22
  v_mfma_f32_16x16x32_bf16 v[136:139], v[40:43], v[232:235], 0
  buffer_load_dwordx4 v6, s[32:35], s26 offen offset:3072 sc1 lds
  v_mul_f32 v23, s76, v23
  v_cvt_pk_bf16_f32 v28, v16, v17
  v_mfma_f32_16x16x32_bf16 v[152:155], v[44:47], v[232:235], 0
  s_add_u32 s26, s26, 1024
  ds_read_b64_tr_b16 v[88:89], v12 offset:8960
  v_cvt_pk_bf16_f32 v29, v18, v19
  v_cvt_pk_bf16_f32 v30, v20, v21
  v_mfma_f32_16x16x32_bf16 v[168:171], v[48:51], v[232:235], 0
  ds_read_b64_tr_b16 v[90:91], v12 offset:9984
  v_cvt_pk_bf16_f32 v31, v22, v23
  v_mfma_f32_16x16x32_bf16 v[184:187], v[52:55], v[232:235], 0
  ds_read_b64_tr_b16 v[92:93], v13 offset:8960
  buffer_store_dwordx4 v[28:31], v2, s[40:43], s63 offen offset:1024 sc1
  v_accvgpr_read_b32 v16, a8
  v_mfma_f32_16x16x32_bf16 v[200:203], v[56:59], v[232:235], 0
  s_add_u32 s63, s63, s61
  ds_read_b64_tr_b16 v[94:95], v13 offset:9984
  v_accvgpr_read_b32 v17, a9
  v_accvgpr_read_b32 v18, a10
  v_mfma_f32_16x16x32_bf16 v[216:219], v[60:63], v[232:235], 0
  v_accvgpr_read_b32 v19, a11
  v_accvgpr_read_b32 v20, a40
  v_accvgpr_read_b32 v21, a41
  v_mfma_f32_16x16x32_bf16 v[108:111], v[32:35], v[236:239], 0
  ds_read_b128 v[248:251], v14 offset:34816
  v_accvgpr_read_b32 v22, a42
  v_accvgpr_read_b32 v23, a43
  v_mfma_f32_16x16x32_bf16 v[124:127], v[36:39], v[236:239], 0
  ds_read_b128 v[252:255], v14 offset:35840
  v_mul_f32 v16, s76, v16
  v_mul_f32 v17, s76, v17
  v_mfma_f32_16x16x32_bf16 v[140:143], v[40:43], v[236:239], 0
  v_mul_f32 v18, s76, v18
  v_mul_f32 v19, s76, v19
  v_mul_f32 v20, s76, v20
  v_mfma_f32_16x16x32_bf16 v[156:159], v[44:47], v[236:239], 0
  v_xor_b32 v14, 0x10000, v14
  v_mul_f32 v21, s76, v21
  v_mul_f32 v22, s76, v22
  v_mfma_f32_16x16x32_bf16 v[172:175], v[48:51], v[236:239], 0
  v_mul_f32 v23, s76, v23
  v_cvt_pk_bf16_f32 v24, v16, v17
  v_cvt_pk_bf16_f32 v25, v18, v19
  v_mfma_f32_16x16x32_bf16 v[188:191], v[52:55], v[236:239], 0
  v_cvt_pk_bf16_f32 v26, v20, v21
  v_cvt_pk_bf16_f32 v27, v22, v23
  v_mfma_f32_16x16x32_bf16 v[204:207], v[56:59], v[236:239], 0
  buffer_store_dwordx4 v[24:27], v2, s[40:43], s63 offen offset:0 sc1
  v_mfma_f32_16x16x32_bf16 v[220:223], v[60:63], v[236:239], 0
  s_waitcnt vmcnt(20) lgkmcnt(0)
  v_mfma_f32_16x16x32_bf16 v[96:99], v[64:67], v[240:243], v[96:99]
  s_barrier
  v_accvgpr_read_b32 v16, a12
  v_accvgpr_read_b32 v17, a13
  v_accvgpr_read_b32 v18, a14
  v_accvgpr_read_b32 v19, a15
  v_mfma_f32_16x16x32_bf16 v[112:115], v[68:71], v[240:243], v[112:115]
  ds_read_b64_tr_b16 v[32:33], v12 offset:32768
  v_accvgpr_read_b32 v20, a44
  v_accvgpr_read_b32 v21, a45
  v_mfma_f32_16x16x32_bf16 v[128:131], v[72:75], v[240:243], v[128:131]
  s_add_u32 m0, s24, 32768
  ds_read_b64_tr_b16 v[34:35], v12 offset:33792
  v_accvgpr_read_b32 v22, a46
  v_accvgpr_read_b32 v23, a47
  v_mfma_f32_16x16x32_bf16 v[144:147], v[76:79], v[240:243], v[144:147]
  buffer_load_dwordx4 v3, s[32:35], s26 offen offset:0 sc1 lds
  v_mul_f32 v16, s76, v16
  v_mul_f32 v17, s76, v17
  v_mfma_f32_16x16x32_bf16 v[160:163], v[80:83], v[240:243], v[160:163]
  ds_read_b64_tr_b16 v[36:37], v13 offset:32768
  v_mul_f32 v18, s76, v18
  v_mul_f32 v19, s76, v19
  v_mfma_f32_16x16x32_bf16 v[176:179], v[84:87], v[240:243], v[176:179]
  ds_read_b64_tr_b16 v[38:39], v13 offset:33792
  v_mul_f32 v20, s76, v20
  v_mul_f32 v21, s76, v21
  v_mfma_f32_16x16x32_bf16 v[192:195], v[88:91], v[240:243], v[192:195]
  ds_read_b64_tr_b16 v[40:41], v12 offset:33024
  v_mul_f32 v22, s76, v22
  v_mul_f32 v23, s76, v23
  v_mfma_f32_16x16x32_bf16 v[208:211], v[92:95], v[240:243], v[208:211]
  ds_read_b64_tr_b16 v[42:43], v12 offset:34048
  v_cvt_pk_bf16_f32 v28, v16, v17
  v_cvt_pk_bf16_f32 v29, v18, v19
  v_mfma_f32_16x16x32_bf16 v[100:103], v[64:67], v[244:247], v[100:103]
  buffer_load_dwordx4 v4, s[32:35], s26 offen offset:1024 sc1 lds
  v_cvt_pk_bf16_f32 v30, v20, v21
  v_cvt_pk_bf16_f32 v31, v22, v23
  v_mfma_f32_16x16x32_bf16 v[116:119], v[68:71], v[244:247], v[116:119]
  ds_read_b64_tr_b16 v[44:45], v13 offset:33024
  buffer_store_dwordx4 v[28:31], v2, s[40:43], s63 offen offset:1024 sc1
  v_accvgpr_read_b32 v16, a16
  v_mfma_f32_16x16x32_bf16 v[132:135], v[72:75], v[244:247], v[132:135]
  s_add_u32 s63, s63, s61
  ds_read_b64_tr_b16 v[46:47], v13 offset:34048
  v_accvgpr_read_b32 v17, a17
  v_accvgpr_read_b32 v18, a18
  v_mfma_f32_16x16x32_bf16 v[148:151], v[76:79], v[244:247], v[148:151]
  ds_read_b128 v[224:227], v14 offset:0
  v_accvgpr_read_b32 v19, a19
  v_accvgpr_read_b32 v20, a48
  v_mfma_f32_16x16x32_bf16 v[164:167], v[80:83], v[244:247], v[164:167]
  ds_read_b128 v[228:231], v14 offset:1024
  v_accvgpr_read_b32 v21, a49
  v_accvgpr_read_b32 v22, a50
  v_mfma_f32_16x16x32_bf16 v[180:183], v[84:87], v[244:247], v[180:183]
  buffer_load_dwordx4 v5, s[32:35], s26 offen offset:2048 sc1 lds
  v_accvgpr_read_b32 v23, a51
  v_mul_f32 v16, s76, v16
  v_mfma_f32_16x16x32_bf16 v[196:199], v[88:91], v[244:247], v[196:199]
  ds_read_b64_tr_b16 v[48:49], v12 offset:33280
  v_mul_f32 v17, s76, v17
  v_mul_f32 v18, s76, v18
  v_mfma_f32_16x16x32_bf16 v[212:215], v[92:95], v[244:247], v[212:215]
  ds_read_b64_tr_b16 v[50:51], v12 offset:34304
  v_mul_f32 v19, s76, v19
  v_mul_f32 v20, s76, v20
  v_mfma_f32_16x16x32_bf16 v[104:107], v[64:67], v[248:251], v[104:107]
  ds_read_b64_tr_b16 v[52:53], v13 offset:33280
  v_mul_f32 v21, s76, v21
  v_mul_f32 v22, s76, v22
  v_mfma_f32_16x16x32_bf16 v[120:123], v[68:71], v[248:251], v[120:123]
  ds_read_b64_tr_b16 v[54:55], v13 offset:34304
  v_mul_f32 v23, s76, v23
  v_cvt_pk_bf16_f32 v24, v16, v17
  v_mfma_f32_16x16x32_bf16 v[136:139], v[72:75], v[248:251], v[136:139]
  buffer_load_dwordx4 v6, s[32:35], s26 offen offset:3072 sc1 lds
  v_cvt_pk_bf16_f32 v25, v18, v19
  v_cvt_pk_bf16_f32 v26, v20, v21
  v_mfma_f32_16x16x32_bf16 v[152:155], v[76:79], v[248:251], v[152:155]
  s_add_u32 s26, s26, 1024
  ds_read_b64_tr_b16 v[56:57], v12 offset:33536
  v_cvt_pk_bf16_f32 v27, v22, v23
  v_mfma_f32_16x16x32_bf16 v[168:171], v[80:83], v[248:251], v[168:171]
  ds_read_b64_tr_b16 v[58:59], v12 offset:34560
  buffer_store_dwordx4 v[24:27], v2, s[40:43], s63 offen offset:0 sc1
  v_accvgpr_read_b32 v16, a20
  v_mfma_f32_16x16x32_bf16 v[184:187], v[84:87], v[248:251], v[184:187]
  ds_read_b64_tr_b16 v[60:61], v13 offset:33536
  v_accvgpr_read_b32 v17, a21
  v_accvgpr_read_b32 v18, a22
  v_mfma_f32_16x16x32_bf16 v[200:203], v[88:91], v[248:251], v[200:203]
  s_add_u32 m0, s24, 16384
  ds_read_b64_tr_b16 v[62:63], v13 offset:34560
  v_accvgpr_read_b32 v19, a23
  v_accvgpr_read_b32 v20, a52
  v_mfma_f32_16x16x32_bf16 v[216:219], v[92:95], v[248:251], v[216:219]
  buffer_load_dwordx4 v8, s[36:39], s27 offen offset:0 lds
  v_accvgpr_read_b32 v21, a53
  v_accvgpr_read_b32 v22, a54
  v_mfma_f32_16x16x32_bf16 v[108:111], v[64:67], v[252:255], v[108:111]
  ds_read_b128 v[232:235], v14 offset:2048
  v_accvgpr_read_b32 v23, a55
  v_mul_f32 v16, s76, v16
  v_mfma_f32_16x16x32_bf16 v[124:127], v[68:71], v[252:255], v[124:127]
  ds_read_b128 v[236:239], v14 offset:3072
  v_mul_f32 v17, s76, v17
  v_mul_f32 v18, s76, v18
  v_mfma_f32_16x16x32_bf16 v[140:143], v[72:75], v[252:255], v[140:143]
  v_mul_f32 v19, s76, v19
  v_mul_f32 v20, s76, v20
  v_mul_f32 v21, s76, v21
  v_mfma_f32_16x16x32_bf16 v[156:159], v[76:79], v[252:255], v[156:159]
  v_mul_f32 v22, s76, v22
  v_mul_f32 v23, s76, v23
  v_cvt_pk_bf16_f32 v28, v16, v17
  v_mfma_f32_16x16x32_bf16 v[172:175], v[80:83], v[252:255], v[172:175]
  buffer_load_dwordx4 v9, s[36:39], s27 offen offset:1024 lds
  v_cvt_pk_bf16_f32 v29, v18, v19
  v_cvt_pk_bf16_f32 v30, v20, v21
  v_mfma_f32_16x16x32_bf16 v[188:191], v[84:87], v[252:255], v[188:191]
  v_cvt_pk_bf16_f32 v31, v22, v23
  v_mfma_f32_16x16x32_bf16 v[204:207], v[88:91], v[252:255], v[204:207]
  buffer_store_dwordx4 v[28:31], v2, s[40:43], s63 offen offset:1024 sc1
  v_mfma_f32_16x16x32_bf16 v[220:223], v[92:95], v[252:255], v[220:223]
  s_waitcnt vmcnt(20) lgkmcnt(0)
  v_mfma_f32_16x16x32_bf16 v[96:99], v[32:35], v[224:227], v[96:99]
  s_add_u32 s63, s63, s61
  v_accvgpr_read_b32 v16, a24
  v_accvgpr_read_b32 v17, a25
  v_accvgpr_read_b32 v18, a26
  v_accvgpr_read_b32 v19, a27
  v_mfma_f32_16x16x32_bf16 v[112:115], v[36:39], v[224:227], v[112:115]
  ds_read_b64_tr_b16 v[64:65], v12 offset:40960
  v_accvgpr_read_b32 v20, a56
  v_accvgpr_read_b32 v21, a57
  v_mfma_f32_16x16x32_bf16 v[128:131], v[40:43], v[224:227], v[128:131]
  s_add_u32 m0, s24, 65536
  ds_read_b64_tr_b16 v[66:67], v12 offset:41984
  v_accvgpr_read_b32 v22, a58
  v_accvgpr_read_b32 v23, a59
  v_mfma_f32_16x16x32_bf16 v[144:147], v[44:47], v[224:227], v[144:147]
  buffer_load_dwordx4 v3, s[32:35], s26 offen offset:0 sc1 lds
  v_mul_f32 v16, s76, v16
  v_mul_f32 v17, s76, v17
  v_mfma_f32_16x16x32_bf16 v[160:163], v[48:51], v[224:227], v[160:163]
  ds_read_b64_tr_b16 v[68:69], v13 offset:40960
  v_mul_f32 v18, s76, v18
  v_mul_f32 v19, s76, v19
  v_mfma_f32_16x16x32_bf16 v[176:179], v[52:55], v[224:227], v[176:179]
  ds_read_b64_tr_b16 v[70:71], v13 offset:41984
  v_mul_f32 v20, s76, v20
  v_mul_f32 v21, s76, v21
  v_mfma_f32_16x16x32_bf16 v[192:195], v[56:59], v[224:227], v[192:195]
  ds_read_b64_tr_b16 v[72:73], v12 offset:41216
  v_mul_f32 v22, s76, v22
  v_mul_f32 v23, s76, v23
  v_mfma_f32_16x16x32_bf16 v[208:211], v[60:63], v[224:227], v[208:211]
  ds_read_b64_tr_b16 v[74:75], v12 offset:42240
  v_cvt_pk_bf16_f32 v24, v16, v17
  v_cvt_pk_bf16_f32 v25, v18, v19
  v_cvt_pk_bf16_f32 v26, v20, v21
  v_mfma_f32_16x16x32_bf16 v[100:103], v[32:35], v[228:231], v[100:103]
  buffer_load_dwordx4 v4, s[32:35], s26 offen offset:1024 sc1 lds
  v_cvt_pk_bf16_f32 v27, v22, v23
  v_mfma_f32_16x16x32_bf16 v[116:119], v[36:39], v[228:231], v[116:119]
  ds_read_b64_tr_b16 v[76:77], v13 offset:41216
  buffer_store_dwordx4 v[24:27], v2, s[40:43], s63 offen offset:0 sc1
  v_accvgpr_read_b32 v16, a28
  v_mfma_f32_16x16x32_bf16 v[132:135], v[40:43], v[228:231], v[132:135]
  ds_read_b64_tr_b16 v[78:79], v13 offset:42240
  v_accvgpr_read_b32 v17, a29
  v_accvgpr_read_b32 v18, a30
  v_mfma_f32_16x16x32_bf16 v[148:151], v[44:47], v[228:231], v[148:151]
  ds_read_b128 v[240:243], v14 offset:32768
  v_accvgpr_read_b32 v19, a31
  v_accvgpr_read_b32 v20, a60
  v_mfma_f32_16x16x32_bf16 v[164:167], v[48:51], v[228:231], v[164:167]
  ds_read_b128 v[244:247], v14 offset:33792
  v_accvgpr_read_b32 v21, a61
  v_accvgpr_read_b32 v22, a62
  v_mfma_f32_16x16x32_bf16 v[180:183], v[52:55], v[228:231], v[180:183]
  buffer_load_dwordx4 v5, s[32:35], s26 offen offset:2048 sc1 lds
  v_accvgpr_read_b32 v23, a63
  v_mul_f32 v16, s76, v16
  v_mfma_f32_16x16x32_bf16 v[196:199], v[56:59], v[228:231], v[196:199]
  ds_read_b64_tr_b16 v[80:81], v12 offset:41472
  v_mul_f32 v17, s76, v17
  v_mul_f32 v18, s76, v18
  v_mfma_f32_16x16x32_bf16 v[212:215], v[60:63], v[228:231], v[212:215]
  ds_read_b64_tr_b16 v[82:83], v12 offset:42496
  v_mul_f32 v19, s76, v19
  v_mul_f32 v20, s76, v20
  v_mul_f32 v21, s76, v21
  v_mfma_f32_16x16x32_bf16 v[104:107], v[32:35], v[232:235], v[104:107]
  ds_read_b64_tr_b16 v[84:85], v13 offset:41472
  v_mul_f32 v22, s76, v22
  v_mul_f32 v23, s76, v23
  v_mfma_f32_16x16x32_bf16 v[120:123], v[36:39], v[232:235], v[120:123]
  ds_read_b64_tr_b16 v[86:87], v13 offset:42496
  v_cvt_pk_bf16_f32 v28, v16, v17
  v_cvt_pk_bf16_f32 v29, v18, v19
  v_mfma_f32_16x16x32_bf16 v[136:139], v[40:43], v[232:235], v[136:139]
  buffer_load_dwordx4 v6, s[32:35], s26 offen offset:3072 sc1 lds
  v_cvt_pk_bf16_f32 v30, v20, v21
  v_cvt_pk_bf16_f32 v31, v22, v23
  v_mfma_f32_16x16x32_bf16 v[152:155], v[44:47], v[232:235], v[152:155]
  s_add_u32 s26, s26, 1024
  ds_read_b64_tr_b16 v[88:89], v12 offset:41728
  buffer_store_dwordx4 v[28:31], v2, s[40:43], s63 offen offset:1024 sc1
  v_accvgpr_read_b32 v16, a64
  v_mfma_f32_16x16x32_bf16 v[168:171], v[48:51], v[232:235], v[168:171]
  s_mul_i32 s63, s60, 1
  ds_read_b64_tr_b16 v[90:91], v12 offset:42752
  v_accvgpr_read_b32 v17, a65
  v_accvgpr_read_b32 v18, a66
  v_mfma_f32_16x16x32_bf16 v[184:187], v[52:55], v[232:235], v[184:187]
  s_add_u32 s63, s63, s62
  ds_read_b64_tr_b16 v[92:93], v13 offset:41728
  v_accvgpr_read_b32 v19, a67
  v_accvgpr_read_b32 v20, a96
  v_mfma_f32_16x16x32_bf16 v[200:203], v[56:59], v[232:235], v[200:203]
  s_add_u32 m0, s24, 16384
  ds_read_b64_tr_b16 v[94:95], v13 offset:42752
  v_accvgpr_read_b32 v21, a97
  v_accvgpr_read_b32 v22, a98
  v_accvgpr_read_b32 v23, a99
  v_mfma_f32_16x16x32_bf16 v[216:219], v[60:63], v[232:235], v[216:219]
  buffer_load_dwordx4 v10, s[36:39], s27 offen offset:2048 lds
  v_mul_f32 v16, s76, v16
  v_mul_f32 v17, s76, v17
  v_mfma_f32_16x16x32_bf16 v[108:111], v[32:35], v[236:239], v[108:111]
  ds_read_b128 v[248:251], v14 offset:34816
  v_mul_f32 v18, s76, v18
  v_mul_f32 v19, s76, v19
  v_mfma_f32_16x16x32_bf16 v[124:127], v[36:39], v[236:239], v[124:127]
  ds_read_b128 v[252:255], v14 offset:35840
  v_mul_f32 v20, s76, v20
  v_mul_f32 v21, s76, v21
  v_mfma_f32_16x16x32_bf16 v[140:143], v[40:43], v[236:239], v[140:143]
  v_mul_f32 v22, s76, v22
  v_mul_f32 v23, s76, v23
  v_cvt_pk_bf16_f32 v24, v16, v17
  v_mfma_f32_16x16x32_bf16 v[156:159], v[44:47], v[236:239], v[156:159]
  v_xor_b32 v14, 0x10000, v14
  v_cvt_pk_bf16_f32 v25, v18, v19
  v_cvt_pk_bf16_f32 v26, v20, v21
  v_mfma_f32_16x16x32_bf16 v[172:175], v[48:51], v[236:239], v[172:175]
  buffer_load_dwordx4 v11, s[36:39], s27 offen offset:3072 lds
  v_cvt_pk_bf16_f32 v27, v22, v23
  v_mfma_f32_16x16x32_bf16 v[188:191], v[52:55], v[236:239], v[188:191]
  s_add_u32 s27, s27, 524288
  buffer_store_dwordx4 v[24:27], v2, s[40:43], s63 offen offset:0 sc1
  v_xor_b32 v12, 0x10000, v12
  v_mfma_f32_16x16x32_bf16 v[204:207], v[56:59], v[236:239], v[204:207]
  v_xor_b32 v13, 0x10000, v13
  v_mfma_f32_16x16x32_bf16 v[220:223], v[60:63], v[236:239], v[220:223]
  s_waitcnt vmcnt(20) lgkmcnt(0)
  v_mfma_f32_16x16x32_bf16 v[96:99], v[64:67], v[240:243], v[96:99]
  s_barrier
  v_accvgpr_read_b32 v16, a68
  v_accvgpr_read_b32 v17, a69
  v_accvgpr_read_b32 v18, a70
  v_accvgpr_read_b32 v19, a71
  v_mfma_f32_16x16x32_bf16 v[112:115], v[68:71], v[240:243], v[112:115]
  ds_read_b64_tr_b16 v[32:33], v12 offset:0
  v_accvgpr_read_b32 v20, a100
  v_accvgpr_read_b32 v21, a101
  v_mfma_f32_16x16x32_bf16 v[128:131], v[72:75], v[240:243], v[128:131]
  s_add_u32 m0, s24, 98304
  ds_read_b64_tr_b16 v[34:35], v12 offset:1024
  v_accvgpr_read_b32 v22, a102
  v_accvgpr_read_b32 v23, a103
  v_mfma_f32_16x16x32_bf16 v[144:147], v[76:79], v[240:243], v[144:147]
  buffer_load_dwordx4 v3, s[32:35], s26 offen offset:0 sc1 lds
  v_mul_f32 v16, s76, v16
  v_mul_f32 v17, s76, v17
  v_mfma_f32_16x16x32_bf16 v[160:163], v[80:83], v[240:243], v[160:163]
  ds_read_b64_tr_b16 v[36:37], v13 offset:0
  v_mul_f32 v18, s76, v18
  v_mul_f32 v19, s76, v19
  v_mfma_f32_16x16x32_bf16 v[176:179], v[84:87], v[240:243], v[176:179]
  ds_read_b64_tr_b16 v[38:39], v13 offset:1024
  v_mul_f32 v20, s76, v20
  v_mul_f32 v21, s76, v21
  v_mfma_f32_16x16x32_bf16 v[192:195], v[88:91], v[240:243], v[192:195]
  ds_read_b64_tr_b16 v[40:41], v12 offset:256
  v_mul_f32 v22, s76, v22
  v_mul_f32 v23, s76, v23
  v_mfma_f32_16x16x32_bf16 v[208:211], v[92:95], v[240:243], v[208:211]
  ds_read_b64_tr_b16 v[42:43], v12 offset:1280
  v_cvt_pk_bf16_f32 v28, v16, v17
  v_cvt_pk_bf16_f32 v29, v18, v19
  v_mfma_f32_16x16x32_bf16 v[100:103], v[64:67], v[244:247], v[100:103]
  buffer_load_dwordx4 v4, s[32:35], s26 offen offset:1024 sc1 lds
  v_cvt_pk_bf16_f32 v30, v20, v21
  v_cvt_pk_bf16_f32 v31, v22, v23
  v_mfma_f32_16x16x32_bf16 v[116:119], v[68:71], v[244:247], v[116:119]
  ds_read_b64_tr_b16 v[44:45], v13 offset:256
  buffer_store_dwordx4 v[28:31], v2, s[40:43], s63 offen offset:1024 sc1
  v_accvgpr_read_b32 v16, a72
  v_mfma_f32_16x16x32_bf16 v[132:135], v[72:75], v[244:247], v[132:135]
  s_add_u32 s63, s63, s61
  ds_read_b64_tr_b16 v[46:47], v13 offset:1280
  v_accvgpr_read_b32 v17, a73
  v_accvgpr_read_b32 v18, a74
  v_mfma_f32_16x16x32_bf16 v[148:151], v[76:79], v[244:247], v[148:151]
  ds_read_b128 v[224:227], v14 offset:0
  v_accvgpr_read_b32 v19, a75
  v_accvgpr_read_b32 v20, a104
  v_mfma_f32_16x16x32_bf16 v[164:167], v[80:83], v[244:247], v[164:167]
  ds_read_b128 v[228:231], v14 offset:1024
  v_accvgpr_read_b32 v21, a105
  v_accvgpr_read_b32 v22, a106
  v_mfma_f32_16x16x32_bf16 v[180:183], v[84:87], v[244:247], v[180:183]
  buffer_load_dwordx4 v5, s[32:35], s26 offen offset:2048 sc1 lds
  v_accvgpr_read_b32 v23, a107
  v_mul_f32 v16, s76, v16
  v_mfma_f32_16x16x32_bf16 v[196:199], v[88:91], v[244:247], v[196:199]
  ds_read_b64_tr_b16 v[48:49], v12 offset:512
  v_mul_f32 v17, s76, v17
  v_mul_f32 v18, s76, v18
  v_mfma_f32_16x16x32_bf16 v[212:215], v[92:95], v[244:247], v[212:215]
  ds_read_b64_tr_b16 v[50:51], v12 offset:1536
  v_mul_f32 v19, s76, v19
  v_mul_f32 v20, s76, v20
  v_mfma_f32_16x16x32_bf16 v[104:107], v[64:67], v[248:251], v[104:107]
  ds_read_b64_tr_b16 v[52:53], v13 offset:512
  v_mul_f32 v21, s76, v21
  v_mul_f32 v22, s76, v22
  v_mfma_f32_16x16x32_bf16 v[120:123], v[68:71], v[248:251], v[120:123]
  ds_read_b64_tr_b16 v[54:55], v13 offset:1536
  v_mul_f32 v23, s76, v23
  v_cvt_pk_bf16_f32 v24, v16, v17
  v_mfma_f32_16x16x32_bf16 v[136:139], v[72:75], v[248:251], v[136:139]
  buffer_load_dwordx4 v6, s[32:35], s26 offen offset:3072 sc1 lds
  v_cvt_pk_bf16_f32 v25, v18, v19
  v_cvt_pk_bf16_f32 v26, v20, v21
  v_mfma_f32_16x16x32_bf16 v[152:155], v[76:79], v[248:251], v[152:155]
  s_add_u32 s26, s26, 1024
  ds_read_b64_tr_b16 v[56:57], v12 offset:768
  v_cvt_pk_bf16_f32 v27, v22, v23
  v_mfma_f32_16x16x32_bf16 v[168:171], v[80:83], v[248:251], v[168:171]
  ds_read_b64_tr_b16 v[58:59], v12 offset:1792
  buffer_store_dwordx4 v[24:27], v2, s[40:43], s63 offen offset:0 sc1
  v_accvgpr_read_b32 v16, a76
  v_mfma_f32_16x16x32_bf16 v[184:187], v[84:87], v[248:251], v[184:187]
  ds_read_b64_tr_b16 v[60:61], v13 offset:768
  v_accvgpr_read_b32 v17, a77
  v_accvgpr_read_b32 v18, a78
  v_mfma_f32_16x16x32_bf16 v[200:203], v[88:91], v[248:251], v[200:203]
  s_add_u32 m0, s24, 49152
  ds_read_b64_tr_b16 v[62:63], v13 offset:1792
  v_accvgpr_read_b32 v19, a79
  v_accvgpr_read_b32 v20, a108
  v_mfma_f32_16x16x32_bf16 v[216:219], v[92:95], v[248:251], v[216:219]
  buffer_load_dwordx4 v8, s[36:39], s27 offen offset:0 lds
  v_accvgpr_read_b32 v21, a109
  v_accvgpr_read_b32 v22, a110
  v_mfma_f32_16x16x32_bf16 v[108:111], v[64:67], v[252:255], v[108:111]
  ds_read_b128 v[232:235], v14 offset:2048
  v_accvgpr_read_b32 v23, a111
  v_mul_f32 v16, s76, v16
  v_mfma_f32_16x16x32_bf16 v[124:127], v[68:71], v[252:255], v[124:127]
  ds_read_b128 v[236:239], v14 offset:3072
  v_mul_f32 v17, s76, v17
  v_mul_f32 v18, s76, v18
  v_mfma_f32_16x16x32_bf16 v[140:143], v[72:75], v[252:255], v[140:143]
  v_mul_f32 v19, s76, v19
  v_mul_f32 v20, s76, v20
  v_mul_f32 v21, s76, v21
  v_mfma_f32_16x16x32_bf16 v[156:159], v[76:79], v[252:255], v[156:159]
  v_mul_f32 v22, s76, v22
  v_mul_f32 v23, s76, v23
  v_cvt_pk_bf16_f32 v28, v16, v17
  v_mfma_f32_16x16x32_bf16 v[172:175], v[80:83], v[252:255], v[172:175]
  buffer_load_dwordx4 v9, s[36:39], s27 offen offset:1024 lds
  v_cvt_pk_bf16_f32 v29, v18, v19
  v_cvt_pk_bf16_f32 v30, v20, v21
  v_mfma_f32_16x16x32_bf16 v[188:191], v[84:87], v[252:255], v[188:191]
  v_cvt_pk_bf16_f32 v31, v22, v23
  v_mfma_f32_16x16x32_bf16 v[204:207], v[88:91], v[252:255], v[204:207]
  buffer_store_dwordx4 v[28:31], v2, s[40:43], s63 offen offset:1024 sc1
  v_mfma_f32_16x16x32_bf16 v[220:223], v[92:95], v[252:255], v[220:223]
  s_waitcnt vmcnt(22) lgkmcnt(0)
  v_mfma_f32_16x16x32_bf16 v[96:99], v[32:35], v[224:227], v[96:99]
  s_add_u32 s63, s63, s61
  v_accvgpr_read_b32 v16, a80
  v_accvgpr_read_b32 v17, a81
  v_accvgpr_read_b32 v18, a82
  v_accvgpr_read_b32 v19, a83
  v_mfma_f32_16x16x32_bf16 v[112:115], v[36:39], v[224:227], v[112:115]
  ds_read_b64_tr_b16 v[64:65], v12 offset:8192
  v_accvgpr_read_b32 v20, a112
  v_accvgpr_read_b32 v21, a113
  v_mfma_f32_16x16x32_bf16 v[128:131], v[40:43], v[224:227], v[128:131]
  s_add_u32 m0, s24, 0
  ds_read_b64_tr_b16 v[66:67], v12 offset:9216
  v_accvgpr_read_b32 v22, a114
  v_accvgpr_read_b32 v23, a115
  v_mfma_f32_16x16x32_bf16 v[144:147], v[44:47], v[224:227], v[144:147]
  buffer_load_dwordx4 v3, s[32:35], s26 offen offset:0 sc1 lds
  v_mul_f32 v16, s76, v16
  v_mul_f32 v17, s76, v17
  v_mfma_f32_16x16x32_bf16 v[160:163], v[48:51], v[224:227], v[160:163]
  ds_read_b64_tr_b16 v[68:69], v13 offset:8192
  v_mul_f32 v18, s76, v18
  v_mul_f32 v19, s76, v19
  v_mfma_f32_16x16x32_bf16 v[176:179], v[52:55], v[224:227], v[176:179]
  ds_read_b64_tr_b16 v[70:71], v13 offset:9216
  v_mul_f32 v20, s76, v20
  v_mul_f32 v21, s76, v21
  v_mfma_f32_16x16x32_bf16 v[192:195], v[56:59], v[224:227], v[192:195]
  ds_read_b64_tr_b16 v[72:73], v12 offset:8448
  v_mul_f32 v22, s76, v22
  v_mul_f32 v23, s76, v23
  v_mfma_f32_16x16x32_bf16 v[208:211], v[60:63], v[224:227], v[208:211]
  ds_read_b64_tr_b16 v[74:75], v12 offset:9472
  v_cvt_pk_bf16_f32 v24, v16, v17
  v_cvt_pk_bf16_f32 v25, v18, v19
  v_mfma_f32_16x16x32_bf16 v[100:103], v[32:35], v[228:231], v[100:103]
  buffer_load_dwordx4 v4, s[32:35], s26 offen offset:1024 sc1 lds
  v_cvt_pk_bf16_f32 v26, v20, v21
  v_cvt_pk_bf16_f32 v27, v22, v23
  v_mfma_f32_16x16x32_bf16 v[116:119], v[36:39], v[228:231], v[116:119]
  ds_read_b64_tr_b16 v[76:77], v13 offset:8448
  buffer_store_dwordx4 v[24:27], v2, s[40:43], s63 offen offset:0 sc1
  v_accvgpr_read_b32 v16, a84
  v_mfma_f32_16x16x32_bf16 v[132:135], v[40:43], v[228:231], v[132:135]
  ds_read_b64_tr_b16 v[78:79], v13 offset:9472
  v_accvgpr_read_b32 v17, a85
  v_accvgpr_read_b32 v18, a86
  v_mfma_f32_16x16x32_bf16 v[148:151], v[44:47], v[228:231], v[148:151]
  ds_read_b128 v[240:243], v14 offset:32768
  v_accvgpr_read_b32 v19, a87
  v_accvgpr_read_b32 v20, a116
  v_mfma_f32_16x16x32_bf16 v[164:167], v[48:51], v[228:231], v[164:167]
  ds_read_b128 v[244:247], v14 offset:33792
  v_accvgpr_read_b32 v21, a117
  v_accvgpr_read_b32 v22, a118
  v_mfma_f32_16x16x32_bf16 v[180:183], v[52:55], v[228:231], v[180:183]
  buffer_load_dwordx4 v5, s[32:35], s26 offen offset:2048 sc1 lds
  v_accvgpr_read_b32 v23, a119
  v_mul_f32 v16, s76, v16
  v_mfma_f32_16x16x32_bf16 v[196:199], v[56:59], v[228:231], v[196:199]
  ds_read_b64_tr_b16 v[80:81], v12 offset:8704
  v_mul_f32 v17, s76, v17
  v_mul_f32 v18, s76, v18
  v_mfma_f32_16x16x32_bf16 v[212:215], v[60:63], v[228:231], v[212:215]
  ds_read_b64_tr_b16 v[82:83], v12 offset:9728
  v_mul_f32 v19, s76, v19
  v_mul_f32 v20, s76, v20
  v_mul_f32 v21, s76, v21
  v_mfma_f32_16x16x32_bf16 v[104:107], v[32:35], v[232:235], v[104:107]
  ds_read_b64_tr_b16 v[84:85], v13 offset:8704
  v_mul_f32 v22, s76, v22
  v_mul_f32 v23, s76, v23
  v_mfma_f32_16x16x32_bf16 v[120:123], v[36:39], v[232:235], v[120:123]
  ds_read_b64_tr_b16 v[86:87], v13 offset:9728
  v_cvt_pk_bf16_f32 v28, v16, v17
  v_cvt_pk_bf16_f32 v29, v18, v19
  v_mfma_f32_16x16x32_bf16 v[136:139], v[40:43], v[232:235], v[136:139]
  buffer_load_dwordx4 v6, s[32:35], s26 offen offset:3072 sc1 lds
  v_cvt_pk_bf16_f32 v30, v20, v21
  v_cvt_pk_bf16_f32 v31, v22, v23
  v_mfma_f32_16x16x32_bf16 v[152:155], v[44:47], v[232:235], v[152:155]
  s_add_u32 s26, s26, 1024
  ds_read_b64_tr_b16 v[88:89], v12 offset:8960
  buffer_store_dwordx4 v[28:31], v2, s[40:43], s63 offen offset:1024 sc1
  v_accvgpr_read_b32 v16, a88
  v_mfma_f32_16x16x32_bf16 v[168:171], v[48:51], v[232:235], v[168:171]
  s_add_u32 s63, s63, s61
  ds_read_b64_tr_b16 v[90:91], v12 offset:9984
  v_accvgpr_read_b32 v17, a89
  v_accvgpr_read_b32 v18, a90
  v_mfma_f32_16x16x32_bf16 v[184:187], v[52:55], v[232:235], v[184:187]
  ds_read_b64_tr_b16 v[92:93], v13 offset:8960
  v_accvgpr_read_b32 v19, a91
  v_accvgpr_read_b32 v20, a120
  v_mfma_f32_16x16x32_bf16 v[200:203], v[56:59], v[232:235], v[200:203]
  s_add_u32 m0, s24, 49152
  ds_read_b64_tr_b16 v[94:95], v13 offset:9984
  v_accvgpr_read_b32 v21, a121
  v_accvgpr_read_b32 v22, a122
  v_mfma_f32_16x16x32_bf16 v[216:219], v[60:63], v[232:235], v[216:219]
  buffer_load_dwordx4 v10, s[36:39], s27 offen offset:2048 lds
  v_accvgpr_read_b32 v23, a123
  v_mul_f32 v16, s76, v16
  v_mfma_f32_16x16x32_bf16 v[108:111], v[32:35], v[236:239], v[108:111]
  ds_read_b128 v[248:251], v14 offset:34816
  v_mul_f32 v17, s76, v17
  v_mul_f32 v18, s76, v18
  v_mfma_f32_16x16x32_bf16 v[124:127], v[36:39], v[236:239], v[124:127]
  ds_read_b128 v[252:255], v14 offset:35840
  v_mul_f32 v19, s76, v19
  v_mul_f32 v20, s76, v20
  v_mfma_f32_16x16x32_bf16 v[140:143], v[40:43], v[236:239], v[140:143]
  v_mul_f32 v21, s76, v21
  v_mul_f32 v22, s76, v22
  v_mul_f32 v23, s76, v23
  v_mfma_f32_16x16x32_bf16 v[156:159], v[44:47], v[236:239], v[156:159]
  v_xor_b32 v14, 0x10000, v14
  v_cvt_pk_bf16_f32 v24, v16, v17
  v_cvt_pk_bf16_f32 v25, v18, v19
  v_mfma_f32_16x16x32_bf16 v[172:175], v[48:51], v[236:239], v[172:175]
  buffer_load_dwordx4 v11, s[36:39], s27 offen offset:3072 lds
  v_cvt_pk_bf16_f32 v26, v20, v21
  v_cvt_pk_bf16_f32 v27, v22, v23
  v_mfma_f32_16x16x32_bf16 v[188:191], v[52:55], v[236:239], v[188:191]
  s_add_u32 s27, s27, 524288
  buffer_store_dwordx4 v[24:27], v2, s[40:43], s63 offen offset:0 sc1
  v_mfma_f32_16x16x32_bf16 v[204:207], v[56:59], v[236:239], v[204:207]
  v_mfma_f32_16x16x32_bf16 v[220:223], v[60:63], v[236:239], v[220:223]
  s_waitcnt vmcnt(22) lgkmcnt(0)
  v_mfma_f32_16x16x32_bf16 v[96:99], v[64:67], v[240:243], v[96:99]
  s_barrier
  v_accvgpr_read_b32 v16, a92
  v_accvgpr_read_b32 v17, a93
  v_accvgpr_read_b32 v18, a94
  v_accvgpr_read_b32 v19, a95
  v_mfma_f32_16x16x32_bf16 v[112:115], v[68:71], v[240:243], v[112:115]
  ds_read_b64_tr_b16 v[32:33], v12 offset:32768
  v_accvgpr_read_b32 v20, a124
  v_accvgpr_read_b32 v21, a125
  v_mfma_f32_16x16x32_bf16 v[128:131], v[72:75], v[240:243], v[128:131]
  s_add_u32 m0, s24, 32768
  ds_read_b64_tr_b16 v[34:35], v12 offset:33792
  v_accvgpr_read_b32 v22, a126
  v_accvgpr_read_b32 v23, a127
  v_mfma_f32_16x16x32_bf16 v[144:147], v[76:79], v[240:243], v[144:147]
  buffer_load_dwordx4 v3, s[32:35], s26 offen offset:0 sc1 lds
  v_mul_f32 v16, s76, v16
  v_mul_f32 v17, s76, v17
  v_mfma_f32_16x16x32_bf16 v[160:163], v[80:83], v[240:243], v[160:163]
  ds_read_b64_tr_b16 v[36:37], v13 offset:32768
  v_mul_f32 v18, s76, v18
  v_mul_f32 v19, s76, v19
  v_mfma_f32_16x16x32_bf16 v[176:179], v[84:87], v[240:243], v[176:179]
  ds_read_b64_tr_b16 v[38:39], v13 offset:33792
  v_mul_f32 v20, s76, v20
  v_mul_f32 v21, s76, v21
  v_mfma_f32_16x16x32_bf16 v[192:195], v[88:91], v[240:243], v[192:195]
  ds_read_b64_tr_b16 v[40:41], v12 offset:33024
  v_mul_f32 v22, s76, v22
  v_mul_f32 v23, s76, v23
  v_mfma_f32_16x16x32_bf16 v[208:211], v[92:95], v[240:243], v[208:211]
  ds_read_b64_tr_b16 v[42:43], v12 offset:34048
  v_cvt_pk_bf16_f32 v28, v16, v17
  v_cvt_pk_bf16_f32 v29, v18, v19
  v_mfma_f32_16x16x32_bf16 v[100:103], v[64:67], v[244:247], v[100:103]
  buffer_load_dwordx4 v4, s[32:35], s26 offen offset:1024 sc1 lds
  v_cvt_pk_bf16_f32 v30, v20, v21
  v_cvt_pk_bf16_f32 v31, v22, v23
  v_mfma_f32_16x16x32_bf16 v[116:119], v[68:71], v[244:247], v[116:119]
  ds_read_b64_tr_b16 v[44:45], v13 offset:33024
  buffer_store_dwordx4 v[28:31], v2, s[40:43], s63 offen offset:1024 sc1
  v_accvgpr_read_b32 v16, a128
  v_mfma_f32_16x16x32_bf16 v[132:135], v[72:75], v[244:247], v[132:135]
  s_mul_i32 s63, s60, 2
  ds_read_b64_tr_b16 v[46:47], v13 offset:34048
  v_accvgpr_read_b32 v17, a129
  v_accvgpr_read_b32 v18, a130
  v_mfma_f32_16x16x32_bf16 v[148:151], v[76:79], v[244:247], v[148:151]
  s_add_u32 s63, s63, s62
  ds_read_b128 v[224:227], v14 offset:0
  v_accvgpr_read_b32 v19, a131
  v_accvgpr_read_b32 v20, a160
  v_mfma_f32_16x16x32_bf16 v[164:167], v[80:83], v[244:247], v[164:167]
  ds_read_b128 v[228:231], v14 offset:1024
  v_accvgpr_read_b32 v21, a161
  v_accvgpr_read_b32 v22, a162
  v_mfma_f32_16x16x32_bf16 v[180:183], v[84:87], v[244:247], v[180:183]
  buffer_load_dwordx4 v5, s[32:35], s26 offen offset:2048 sc1 lds
  v_accvgpr_read_b32 v23, a163
  v_mul_f32 v16, s76, v16
  v_mfma_f32_16x16x32_bf16 v[196:199], v[88:91], v[244:247], v[196:199]
  ds_read_b64_tr_b16 v[48:49], v12 offset:33280
  v_mul_f32 v17, s76, v17
  v_mul_f32 v18, s76, v18
  v_mfma_f32_16x16x32_bf16 v[212:215], v[92:95], v[244:247], v[212:215]
  ds_read_b64_tr_b16 v[50:51], v12 offset:34304
  v_mul_f32 v19, s76, v19
  v_mul_f32 v20, s76, v20
  v_mfma_f32_16x16x32_bf16 v[104:107], v[64:67], v[248:251], v[104:107]
  ds_read_b64_tr_b16 v[52:53], v13 offset:33280
  v_mul_f32 v21, s76, v21
  v_mul_f32 v22, s76, v22
  v_mfma_f32_16x16x32_bf16 v[120:123], v[68:71], v[248:251], v[120:123]
  ds_read_b64_tr_b16 v[54:55], v13 offset:34304
  v_mul_f32 v23, s76, v23
  v_cvt_pk_bf16_f32 v24, v16, v17
  v_mfma_f32_16x16x32_bf16 v[136:139], v[72:75], v[248:251], v[136:139]
  buffer_load_dwordx4 v6, s[32:35], s26 offen offset:3072 sc1 lds
  v_cvt_pk_bf16_f32 v25, v18, v19
  v_cvt_pk_bf16_f32 v26, v20, v21
  v_mfma_f32_16x16x32_bf16 v[152:155], v[76:79], v[248:251], v[152:155]
  s_add_u32 s26, s26, 1024
  ds_read_b64_tr_b16 v[56:57], v12 offset:33536
  v_cvt_pk_bf16_f32 v27, v22, v23
  v_mfma_f32_16x16x32_bf16 v[168:171], v[80:83], v[248:251], v[168:171]
  ds_read_b64_tr_b16 v[58:59], v12 offset:34560
  buffer_store_dwordx4 v[24:27], v2, s[40:43], s63 offen offset:0 sc1
  v_accvgpr_read_b32 v16, a132
  v_mfma_f32_16x16x32_bf16 v[184:187], v[84:87], v[248:251], v[184:187]
  ds_read_b64_tr_b16 v[60:61], v13 offset:33536
  v_accvgpr_read_b32 v17, a133
  v_accvgpr_read_b32 v18, a134
  v_mfma_f32_16x16x32_bf16 v[200:203], v[88:91], v[248:251], v[200:203]
  s_add_u32 m0, s24, 81920
  ds_read_b64_tr_b16 v[62:63], v13 offset:34560
  v_accvgpr_read_b32 v19, a135
  v_accvgpr_read_b32 v20, a164
  v_mfma_f32_16x16x32_bf16 v[216:219], v[92:95], v[248:251], v[216:219]
  buffer_load_dwordx4 v8, s[36:39], s27 offen offset:0 lds
  v_accvgpr_read_b32 v21, a165
  v_accvgpr_read_b32 v22, a166
  v_mfma_f32_16x16x32_bf16 v[108:111], v[64:67], v[252:255], v[108:111]
  ds_read_b128 v[232:235], v14 offset:2048
  v_accvgpr_read_b32 v23, a167
  v_mul_f32 v16, s76, v16
  v_mfma_f32_16x16x32_bf16 v[124:127], v[68:71], v[252:255], v[124:127]
  ds_read_b128 v[236:239], v14 offset:3072
  v_mul_f32 v17, s76, v17
  v_mul_f32 v18, s76, v18
  v_mfma_f32_16x16x32_bf16 v[140:143], v[72:75], v[252:255], v[140:143]
  v_mul_f32 v19, s76, v19
  v_mul_f32 v20, s76, v20
  v_mul_f32 v21, s76, v21
  v_mfma_f32_16x16x32_bf16 v[156:159], v[76:79], v[252:255], v[156:159]
  v_mul_f32 v22, s76, v22
  v_mul_f32 v23, s76, v23
  v_cvt_pk_bf16_f32 v28, v16, v17
  v_mfma_f32_16x16x32_bf16 v[172:175], v[80:83], v[252:255], v[172:175]
  buffer_load_dwordx4 v9, s[36:39], s27 offen offset:1024 lds
  v_cvt_pk_bf16_f32 v29, v18, v19
  v_cvt_pk_bf16_f32 v30, v20, v21
  v_mfma_f32_16x16x32_bf16 v[188:191], v[84:87], v[252:255], v[188:191]
  v_cvt_pk_bf16_f32 v31, v22, v23
  v_mfma_f32_16x16x32_bf16 v[204:207], v[88:91], v[252:255], v[204:207]
  buffer_store_dwordx4 v[28:31], v2, s[40:43], s63 offen offset:1024 sc1
  v_mfma_f32_16x16x32_bf16 v[220:223], v[92:95], v[252:255], v[220:223]
  s_waitcnt vmcnt(22) lgkmcnt(0)
  v_mfma_f32_16x16x32_bf16 v[96:99], v[32:35], v[224:227], v[96:99]
  s_add_u32 s63, s63, s61
  v_accvgpr_read_b32 v16, a136
  v_accvgpr_read_b32 v17, a137
  v_accvgpr_read_b32 v18, a138
  v_mfma_f32_16x16x32_bf16 v[112:115], v[36:39], v[224:227], v[112:115]
  ds_read_b64_tr_b16 v[64:65], v12 offset:40960
  v_accvgpr_read_b32 v19, a139
  v_mfma_f32_16x16x32_bf16 v[128:131], v[40:43], v[224:227], v[128:131]
  s_add_u32 m0, s24, 65536
  ds_read_b64_tr_b16 v[66:67], v12 offset:41984
  v_accvgpr_read_b32 v20, a168
  v_accvgpr_read_b32 v21, a169
  v_mfma_f32_16x16x32_bf16 v[144:147], v[44:47], v[224:227], v[144:147]
  buffer_load_dwordx4 v3, s[32:35], s26 offen offset:0 sc1 lds
  v_accvgpr_read_b32 v22, a170
  v_mfma_f32_16x16x32_bf16 v[160:163], v[48:51], v[224:227], v[160:163]
  ds_read_b64_tr_b16 v[68:69], v13 offset:40960
  v_accvgpr_read_b32 v23, a171
  v_mfma_f32_16x16x32_bf16 v[176:179], v[52:55], v[224:227], v[176:179]
  ds_read_b64_tr_b16 v[70:71], v13 offset:41984
  v_mul_f32 v16, s76, v16
  v_mul_f32 v17, s76, v17
  v_mfma_f32_16x16x32_bf16 v[192:195], v[56:59], v[224:227], v[192:195]
  ds_read_b64_tr_b16 v[72:73], v12 offset:41216
  v_mul_f32 v18, s76, v18
  v_mfma_f32_16x16x32_bf16 v[208:211], v[60:63], v[224:227], v[208:211]
  ds_read_b64_tr_b16 v[74:75], v12 offset:42240
  v_mul_f32 v19, s76, v19
  v_mul_f32 v20, s76, v20
  v_mfma_f32_16x16x32_bf16 v[100:103], v[32:35], v[228:231], v[100:103]
  buffer_load_dwordx4 v4, s[32:35], s26 offen offset:1024 sc1 lds
  v_mul_f32 v21, s76, v21
  v_mfma_f32_16x16x32_bf16 v[116:119], v[36:39], v[228:231], v[116:119]
  ds_read_b64_tr_b16 v[76:77], v13 offset:41216
  v_mul_f32 v22, s76, v22
  v_mfma_f32_16x16x32_bf16 v[132:135], v[40:43], v[228:231], v[132:135]
  ds_read_b64_tr_b16 v[78:79], v13 offset:42240
  v_mul_f32 v23, s76, v23
  v_cvt_pk_bf16_f32 v24, v16, v17
  v_mfma_f32_16x16x32_bf16 v[148:151], v[44:47], v[228:231], v[148:151]
  ds_read_b128 v[240:243], v14 offset:32768
  v_cvt_pk_bf16_f32 v25, v18, v19
  v_mfma_f32_16x16x32_bf16 v[164:167], v[48:51], v[228:231], v[164:167]
  ds_read_b128 v[244:247], v14 offset:33792
  v_cvt_pk_bf16_f32 v26, v20, v21
  v_cvt_pk_bf16_f32 v27, v22, v23
  v_mfma_f32_16x16x32_bf16 v[180:183], v[52:55], v[228:231], v[180:183]
  buffer_load_dwordx4 v5, s[32:35], s26 offen offset:2048 sc1 lds
  buffer_store_dwordx4 v[24:27], v2, s[40:43], s63 offen offset:0 sc1
  v_mfma_f32_16x16x32_bf16 v[196:199], v[56:59], v[228:231], v[196:199]
  ds_read_b64_tr_b16 v[80:81], v12 offset:41472
  v_accvgpr_read_b32 v16, a140
  v_mfma_f32_16x16x32_bf16 v[212:215], v[60:63], v[228:231], v[212:215]
  ds_read_b64_tr_b16 v[82:83], v12 offset:42496
  v_accvgpr_read_b32 v17, a141
  v_accvgpr_read_b32 v18, a142
  v_mfma_f32_16x16x32_bf16 v[104:107], v[32:35], v[232:235], v[104:107]
  ds_read_b64_tr_b16 v[84:85], v13 offset:41472
  v_accvgpr_read_b32 v19, a143
  v_mfma_f32_16x16x32_bf16 v[120:123], v[36:39], v[232:235], v[120:123]
  ds_read_b64_tr_b16 v[86:87], v13 offset:42496
  v_accvgpr_read_b32 v20, a172
  v_accvgpr_read_b32 v21, a173
  v_mfma_f32_16x16x32_bf16 v[136:139], v[40:43], v[232:235], v[136:139]
  buffer_load_dwordx4 v6, s[32:35], s26 offen offset:3072 sc1 lds
  v_accvgpr_read_b32 v22, a174
  v_mfma_f32_16x16x32_bf16 v[152:155], v[44:47], v[232:235], v[152:155]
  s_add_u32 s26, s26, 1024
  ds_read_b64_tr_b16 v[88:89], v12 offset:41728
  v_accvgpr_read_b32 v23, a175
  v_mfma_f32_16x16x32_bf16 v[168:171], v[48:51], v[232:235], v[168:171]
  ds_read_b64_tr_b16 v[90:91], v12 offset:42752
  v_mul_f32 v16, s76, v16
  v_mul_f32 v17, s76, v17
  v_mfma_f32_16x16x32_bf16 v[184:187], v[52:55], v[232:235], v[184:187]
  ds_read_b64_tr_b16 v[92:93], v13 offset:41728
  v_mul_f32 v18, s76, v18
  v_mfma_f32_16x16x32_bf16 v[200:203], v[56:59], v[232:235], v[200:203]
  s_add_u32 m0, s24, 81920
  ds_read_b64_tr_b16 v[94:95], v13 offset:42752
  v_mul_f32 v19, s76, v19
  v_mul_f32 v20, s76, v20
  v_mfma_f32_16x16x32_bf16 v[216:219], v[60:63], v[232:235], v[216:219]
  buffer_load_dwordx4 v10, s[36:39], s27 offen offset:2048 lds
  v_mul_f32 v21, s76, v21
  v_mfma_f32_16x16x32_bf16 v[108:111], v[32:35], v[236:239], v[108:111]
  ds_read_b128 v[248:251], v14 offset:34816
  v_mul_f32 v22, s76, v22
  v_mfma_f32_16x16x32_bf16 v[124:127], v[36:39], v[236:239], v[124:127]
  ds_read_b128 v[252:255], v14 offset:35840
  v_mul_f32 v23, s76, v23
  v_cvt_pk_bf16_f32 v28, v16, v17
  v_mfma_f32_16x16x32_bf16 v[140:143], v[40:43], v[236:239], v[140:143]
  v_cvt_pk_bf16_f32 v29, v18, v19
  v_cvt_pk_bf16_f32 v30, v20, v21
  v_mfma_f32_16x16x32_bf16 v[156:159], v[44:47], v[236:239], v[156:159]
  v_xor_b32 v14, 0x10000, v14
  v_cvt_pk_bf16_f32 v31, v22, v23
  v_mfma_f32_16x16x32_bf16 v[172:175], v[48:51], v[236:239], v[172:175]
  buffer_load_dwordx4 v11, s[36:39], s27 offen offset:3072 lds
  buffer_store_dwordx4 v[28:31], v2, s[40:43], s63 offen offset:1024 sc1
  v_mfma_f32_16x16x32_bf16 v[188:191], v[52:55], v[236:239], v[188:191]
  s_add_u32 s27, s27, 524288
  v_xor_b32 v12, 0x10000, v12
  v_mfma_f32_16x16x32_bf16 v[204:207], v[56:59], v[236:239], v[204:207]
  v_xor_b32 v13, 0x10000, v13
  v_mfma_f32_16x16x32_bf16 v[220:223], v[60:63], v[236:239], v[220:223]
  s_waitcnt vmcnt(21) lgkmcnt(0)
  v_mfma_f32_16x16x32_bf16 v[96:99], v[64:67], v[240:243], v[96:99]
  s_barrier
  v_accvgpr_read_b32 v16, a144
  v_accvgpr_read_b32 v17, a145
  v_accvgpr_read_b32 v18, a146
  v_mfma_f32_16x16x32_bf16 v[112:115], v[68:71], v[240:243], v[112:115]
  s_add_u32 s63, s63, s61
  ds_read_b64_tr_b16 v[32:33], v12 offset:0
  v_accvgpr_read_b32 v19, a147
  v_mfma_f32_16x16x32_bf16 v[128:131], v[72:75], v[240:243], v[128:131]
  s_add_u32 m0, s24, 98304
  ds_read_b64_tr_b16 v[34:35], v12 offset:1024
  v_accvgpr_read_b32 v20, a176
  v_mfma_f32_16x16x32_bf16 v[144:147], v[76:79], v[240:243], v[144:147]
  buffer_load_dwordx4 v3, s[32:35], s26 offen offset:0 sc1 lds
  v_accvgpr_read_b32 v21, a177
  v_accvgpr_read_b32 v22, a178
  v_mfma_f32_16x16x32_bf16 v[160:163], v[80:83], v[240:243], v[160:163]
  ds_read_b64_tr_b16 v[36:37], v13 offset:0
  v_accvgpr_read_b32 v23, a179
  v_mfma_f32_16x16x32_bf16 v[176:179], v[84:87], v[240:243], v[176:179]
  ds_read_b64_tr_b16 v[38:39], v13 offset:1024
  v_mul_f32 v16, s76, v16
  v_mfma_f32_16x16x32_bf16 v[192:195], v[88:91], v[240:243], v[192:195]
  ds_read_b64_tr_b16 v[40:41], v12 offset:256
  v_mul_f32 v17, s76, v17
  v_mul_f32 v18, s76, v18
  v_mfma_f32_16x16x32_bf16 v[208:211], v[92:95], v[240:243], v[208:211]
  ds_read_b64_tr_b16 v[42:43], v12 offset:1280
  v_mul_f32 v19, s76, v19
  v_mfma_f32_16x16x32_bf16 v[100:103], v[64:67], v[244:247], v[100:103]
  buffer_load_dwordx4 v4, s[32:35], s26 offen offset:1024 sc1 lds
  v_mul_f32 v20, s76, v20
  v_mfma_f32_16x16x32_bf16 v[116:119], v[68:71], v[244:247], v[116:119]
  ds_read_b64_tr_b16 v[44:45], v13 offset:256
  v_mul_f32 v21, s76, v21
  v_mfma_f32_16x16x32_bf16 v[132:135], v[72:75], v[244:247], v[132:135]
  ds_read_b64_tr_b16 v[46:47], v13 offset:1280
  v_mul_f32 v22, s76, v22
  v_mul_f32 v23, s76, v23
  v_mfma_f32_16x16x32_bf16 v[148:151], v[76:79], v[244:247], v[148:151]
  ds_read_b128 v[224:227], v14 offset:0
  v_cvt_pk_bf16_f32 v24, v16, v17
  v_mfma_f32_16x16x32_bf16 v[164:167], v[80:83], v[244:247], v[164:167]
  ds_read_b128 v[228:231], v14 offset:1024
  v_cvt_pk_bf16_f32 v25, v18, v19
  v_mfma_f32_16x16x32_bf16 v[180:183], v[84:87], v[244:247], v[180:183]
  buffer_load_dwordx4 v5, s[32:35], s26 offen offset:2048 sc1 lds
  v_cvt_pk_bf16_f32 v26, v20, v21
  v_cvt_pk_bf16_f32 v27, v22, v23
  v_mfma_f32_16x16x32_bf16 v[196:199], v[88:91], v[244:247], v[196:199]
  ds_read_b64_tr_b16 v[48:49], v12 offset:512
  buffer_store_dwordx4 v[24:27], v2, s[40:43], s63 offen offset:0 sc1
  v_mfma_f32_16x16x32_bf16 v[212:215], v[92:95], v[244:247], v[212:215]
  ds_read_b64_tr_b16 v[50:51], v12 offset:1536
  v_accvgpr_read_b32 v16, a148
  v_mfma_f32_16x16x32_bf16 v[104:107], v[64:67], v[248:251], v[104:107]
  ds_read_b64_tr_b16 v[52:53], v13 offset:512
  v_accvgpr_read_b32 v17, a149
  v_accvgpr_read_b32 v18, a150
  v_mfma_f32_16x16x32_bf16 v[120:123], v[68:71], v[248:251], v[120:123]
  ds_read_b64_tr_b16 v[54:55], v13 offset:1536
  v_accvgpr_read_b32 v19, a151
  v_mfma_f32_16x16x32_bf16 v[136:139], v[72:75], v[248:251], v[136:139]
  buffer_load_dwordx4 v6, s[32:35], s26 offen offset:3072 sc1 lds
  v_accvgpr_read_b32 v20, a180
  v_mfma_f32_16x16x32_bf16 v[152:155], v[76:79], v[248:251], v[152:155]
  s_add_u32 s26, s26, 1024
  ds_read_b64_tr_b16 v[56:57], v12 offset:768
  v_accvgpr_read_b32 v21, a181
  v_mfma_f32_16x16x32_bf16 v[168:171], v[80:83], v[248:251], v[168:171]
  ds_read_b64_tr_b16 v[58:59], v12 offset:1792
  v_accvgpr_read_b32 v22, a182
  v_accvgpr_read_b32 v23, a183
  v_mfma_f32_16x16x32_bf16 v[184:187], v[84:87], v[248:251], v[184:187]
  ds_read_b64_tr_b16 v[60:61], v13 offset:768
  v_mul_f32 v16, s76, v16
  v_mfma_f32_16x16x32_bf16 v[200:203], v[88:91], v[248:251], v[200:203]
  s_add_u32 m0, s24, 114688
  ds_read_b64_tr_b16 v[62:63], v13 offset:1792
  v_mul_f32 v17, s76, v17
  v_mfma_f32_16x16x32_bf16 v[216:219], v[92:95], v[248:251], v[216:219]
  buffer_load_dwordx4 v8, s[36:39], s27 offen offset:0 lds
  v_mul_f32 v18, s76, v18
  v_mul_f32 v19, s76, v19
  v_mfma_f32_16x16x32_bf16 v[108:111], v[64:67], v[252:255], v[108:111]
  ds_read_b128 v[232:235], v14 offset:2048
  v_mul_f32 v20, s76, v20
  v_mfma_f32_16x16x32_bf16 v[124:127], v[68:71], v[252:255], v[124:127]
  ds_read_b128 v[236:239], v14 offset:3072
  v_mul_f32 v21, s76, v21
  v_mfma_f32_16x16x32_bf16 v[140:143], v[72:75], v[252:255], v[140:143]
  v_mul_f32 v22, s76, v22
  v_mul_f32 v23, s76, v23
  v_cvt_pk_bf16_f32 v28, v16, v17
  v_mfma_f32_16x16x32_bf16 v[156:159], v[76:79], v[252:255], v[156:159]
  v_cvt_pk_bf16_f32 v29, v18, v19
  v_cvt_pk_bf16_f32 v30, v20, v21
  v_mfma_f32_16x16x32_bf16 v[172:175], v[80:83], v[252:255], v[172:175]
  buffer_load_dwordx4 v9, s[36:39], s27 offen offset:1024 lds
  v_cvt_pk_bf16_f32 v31, v22, v23
  v_mfma_f32_16x16x32_bf16 v[188:191], v[84:87], v[252:255], v[188:191]
  buffer_store_dwordx4 v[28:31], v2, s[40:43], s63 offen offset:1024 sc1
  v_mfma_f32_16x16x32_bf16 v[204:207], v[88:91], v[252:255], v[204:207]
  v_mfma_f32_16x16x32_bf16 v[220:223], v[92:95], v[252:255], v[220:223]
  s_waitcnt vmcnt(20) lgkmcnt(0)
  v_mfma_f32_16x16x32_bf16 v[96:99], v[32:35], v[224:227], v[96:99]
  s_add_u32 s63, s63, s61
  v_accvgpr_read_b32 v16, a152
  v_accvgpr_read_b32 v17, a153
  v_accvgpr_read_b32 v18, a154
  v_mfma_f32_16x16x32_bf16 v[112:115], v[36:39], v[224:227], v[112:115]
  ds_read_b64_tr_b16 v[64:65], v12 offset:8192
  v_accvgpr_read_b32 v19, a155
  v_mfma_f32_16x16x32_bf16 v[128:131], v[40:43], v[224:227], v[128:131]
  s_add_u32 m0, s24, 0
  ds_read_b64_tr_b16 v[66:67], v12 offset:9216
  v_accvgpr_read_b32 v20, a184
  v_mfma_f32_16x16x32_bf16 v[144:147], v[44:47], v[224:227], v[144:147]
  buffer_load_dwordx4 v3, s[32:35], s26 offen offset:0 sc1 lds
  v_accvgpr_read_b32 v21, a185
  v_accvgpr_read_b32 v22, a186
  v_mfma_f32_16x16x32_bf16 v[160:163], v[48:51], v[224:227], v[160:163]
  ds_read_b64_tr_b16 v[68:69], v13 offset:8192
  v_accvgpr_read_b32 v23, a187
  v_mfma_f32_16x16x32_bf16 v[176:179], v[52:55], v[224:227], v[176:179]
  ds_read_b64_tr_b16 v[70:71], v13 offset:9216
  v_mul_f32 v16, s76, v16
  v_mfma_f32_16x16x32_bf16 v[192:195], v[56:59], v[224:227], v[192:195]
  ds_read_b64_tr_b16 v[72:73], v12 offset:8448
  v_mul_f32 v17, s76, v17
  v_mul_f32 v18, s76, v18
  v_mfma_f32_16x16x32_bf16 v[208:211], v[60:63], v[224:227], v[208:211]
  ds_read_b64_tr_b16 v[74:75], v12 offset:9472
  v_mul_f32 v19, s76, v19
  v_mfma_f32_16x16x32_bf16 v[100:103], v[32:35], v[228:231], v[100:103]
  buffer_load_dwordx4 v4, s[32:35], s26 offen offset:1024 sc1 lds
  v_mul_f32 v20, s76, v20
  v_mfma_f32_16x16x32_bf16 v[116:119], v[36:39], v[228:231], v[116:119]
  ds_read_b64_tr_b16 v[76:77], v13 offset:8448
  v_mul_f32 v21, s76, v21
  v_mul_f32 v22, s76, v22
  v_mfma_f32_16x16x32_bf16 v[132:135], v[40:43], v[228:231], v[132:135]
  ds_read_b64_tr_b16 v[78:79], v13 offset:9472
  v_mul_f32 v23, s76, v23
  v_mfma_f32_16x16x32_bf16 v[148:151], v[44:47], v[228:231], v[148:151]
  ds_read_b128 v[240:243], v14 offset:32768
  v_cvt_pk_bf16_f32 v24, v16, v17
  v_mfma_f32_16x16x32_bf16 v[164:167], v[48:51], v[228:231], v[164:167]
  ds_read_b128 v[244:247], v14 offset:33792
  v_cvt_pk_bf16_f32 v25, v18, v19
  v_cvt_pk_bf16_f32 v26, v20, v21
  v_mfma_f32_16x16x32_bf16 v[180:183], v[52:55], v[228:231], v[180:183]
  buffer_load_dwordx4 v5, s[32:35], s26 offen offset:2048 sc1 lds
  v_cvt_pk_bf16_f32 v27, v22, v23
  v_mfma_f32_16x16x32_bf16 v[196:199], v[56:59], v[228:231], v[196:199]
  ds_read_b64_tr_b16 v[80:81], v12 offset:8704
  buffer_store_dwordx4 v[24:27], v2, s[40:43], s63 offen offset:0 sc1
  v_mfma_f32_16x16x32_bf16 v[212:215], v[60:63], v[228:231], v[212:215]
  ds_read_b64_tr_b16 v[82:83], v12 offset:9728
  v_accvgpr_read_b32 v16, a156
  v_accvgpr_read_b32 v17, a157
  v_mfma_f32_16x16x32_bf16 v[104:107], v[32:35], v[232:235], v[104:107]
  ds_read_b64_tr_b16 v[84:85], v13 offset:8704
  v_accvgpr_read_b32 v18, a158
  v_mfma_f32_16x16x32_bf16 v[120:123], v[36:39], v[232:235], v[120:123]
  ds_read_b64_tr_b16 v[86:87], v13 offset:9728
  v_accvgpr_read_b32 v19, a159
  v_mfma_f32_16x16x32_bf16 v[136:139], v[40:43], v[232:235], v[136:139]
  buffer_load_dwordx4 v6, s[32:35], s26 offen offset:3072 sc1 lds
  v_accvgpr_read_b32 v20, a188
  v_accvgpr_read_b32 v21, a189
  v_mfma_f32_16x16x32_bf16 v[152:155], v[44:47], v[232:235], v[152:155]
  s_add_u32 s26, s26, 1024
  ds_read_b64_tr_b16 v[88:89], v12 offset:8960
  v_accvgpr_read_b32 v22, a190
  v_mfma_f32_16x16x32_bf16 v[168:171], v[48:51], v[232:235], v[168:171]
  ds_read_b64_tr_b16 v[90:91], v12 offset:9984
  v_accvgpr_read_b32 v23, a191
  v_mfma_f32_16x16x32_bf16 v[184:187], v[52:55], v[232:235], v[184:187]
  ds_read_b64_tr_b16 v[92:93], v13 offset:8960
  v_mul_f32 v16, s76, v16
  v_mul_f32 v17, s76, v17
  v_mfma_f32_16x16x32_bf16 v[200:203], v[56:59], v[232:235], v[200:203]
  s_add_u32 m0, s24, 114688
  ds_read_b64_tr_b16 v[94:95], v13 offset:9984
  v_mul_f32 v18, s76, v18
  v_mfma_f32_16x16x32_bf16 v[216:219], v[60:63], v[232:235], v[216:219]
  buffer_load_dwordx4 v10, s[36:39], s27 offen offset:2048 lds
  v_mul_f32 v19, s76, v19
  v_mfma_f32_16x16x32_bf16 v[108:111], v[32:35], v[236:239], v[108:111]
  ds_read_b128 v[248:251], v14 offset:34816
  v_mul_f32 v20, s76, v20
  v_mul_f32 v21, s76, v21
  v_mfma_f32_16x16x32_bf16 v[124:127], v[36:39], v[236:239], v[124:127]
  ds_read_b128 v[252:255], v14 offset:35840
  v_mul_f32 v22, s76, v22
  v_mfma_f32_16x16x32_bf16 v[140:143], v[40:43], v[236:239], v[140:143]
  v_mul_f32 v23, s76, v23
  v_cvt_pk_bf16_f32 v28, v16, v17
  v_mfma_f32_16x16x32_bf16 v[156:159], v[44:47], v[236:239], v[156:159]
  v_xor_b32 v14, 0x10000, v14
  v_cvt_pk_bf16_f32 v29, v18, v19
  v_cvt_pk_bf16_f32 v30, v20, v21
  v_mfma_f32_16x16x32_bf16 v[172:175], v[48:51], v[236:239], v[172:175]
  buffer_load_dwordx4 v11, s[36:39], s27 offen offset:3072 lds
  v_cvt_pk_bf16_f32 v31, v22, v23
  v_mfma_f32_16x16x32_bf16 v[188:191], v[52:55], v[236:239], v[188:191]
  s_add_u32 s27, s27, 524288
  buffer_store_dwordx4 v[28:31], v2, s[40:43], s63 offen offset:1024 sc1
  v_mfma_f32_16x16x32_bf16 v[204:207], v[56:59], v[236:239], v[204:207]
  v_mfma_f32_16x16x32_bf16 v[220:223], v[60:63], v[236:239], v[220:223]
  s_waitcnt vmcnt(19) lgkmcnt(0)
  v_mfma_f32_16x16x32_bf16 v[96:99], v[64:67], v[240:243], v[96:99]
  s_barrier
  v_accvgpr_read_b32 v16, a192
  v_accvgpr_read_b32 v17, a193
  v_accvgpr_read_b32 v18, a194
  v_mfma_f32_16x16x32_bf16 v[112:115], v[68:71], v[240:243], v[112:115]
  s_mul_i32 s63, s60, 3
  ds_read_b64_tr_b16 v[32:33], v12 offset:32768
  v_accvgpr_read_b32 v19, a195
  v_mfma_f32_16x16x32_bf16 v[128:131], v[72:75], v[240:243], v[128:131]
  s_add_u32 m0, s24, 32768
  ds_read_b64_tr_b16 v[34:35], v12 offset:33792
  v_accvgpr_read_b32 v20, a224
  v_mfma_f32_16x16x32_bf16 v[144:147], v[76:79], v[240:243], v[144:147]
  s_add_u32 s63, s63, s62
  buffer_load_dwordx4 v3, s[32:35], s26 offen offset:0 sc1 lds
  v_accvgpr_read_b32 v21, a225
  v_accvgpr_read_b32 v22, a226
  v_mfma_f32_16x16x32_bf16 v[160:163], v[80:83], v[240:243], v[160:163]
  ds_read_b64_tr_b16 v[36:37], v13 offset:32768
  v_accvgpr_read_b32 v23, a227
  v_mfma_f32_16x16x32_bf16 v[176:179], v[84:87], v[240:243], v[176:179]
  ds_read_b64_tr_b16 v[38:39], v13 offset:33792
  v_mul_f32 v16, s76, v16
  v_mfma_f32_16x16x32_bf16 v[192:195], v[88:91], v[240:243], v[192:195]
  ds_read_b64_tr_b16 v[40:41], v12 offset:33024
  v_mul_f32 v17, s76, v17
  v_mul_f32 v18, s76, v18
  v_mfma_f32_16x16x32_bf16 v[208:211], v[92:95], v[240:243], v[208:211]
  ds_read_b64_tr_b16 v[42:43], v12 offset:34048
  v_mul_f32 v19, s76, v19
  v_mfma_f32_16x16x32_bf16 v[100:103], v[64:67], v[244:247], v[100:103]
  buffer_load_dwordx4 v4, s[32:35], s26 offen offset:1024 sc1 lds
  v_mul_f32 v20, s76, v20
  v_mfma_f32_16x16x32_bf16 v[116:119], v[68:71], v[244:247], v[116:119]
  ds_read_b64_tr_b16 v[44:45], v13 offset:33024
  v_mul_f32 v21, s76, v21
  v_mfma_f32_16x16x32_bf16 v[132:135], v[72:75], v[244:247], v[132:135]
  ds_read_b64_tr_b16 v[46:47], v13 offset:34048
  v_mul_f32 v22, s76, v22
  v_mul_f32 v23, s76, v23
  v_mfma_f32_16x16x32_bf16 v[148:151], v[76:79], v[244:247], v[148:151]
  ds_read_b128 v[224:227], v14 offset:0
  v_cvt_pk_bf16_f32 v24, v16, v17
  v_mfma_f32_16x16x32_bf16 v[164:167], v[80:83], v[244:247], v[164:167]
  ds_read_b128 v[228:231], v14 offset:1024
  v_cvt_pk_bf16_f32 v25, v18, v19
  v_mfma_f32_16x16x32_bf16 v[180:183], v[84:87], v[244:247], v[180:183]
  buffer_load_dwordx4 v5, s[32:35], s26 offen offset:2048 sc1 lds
  v_cvt_pk_bf16_f32 v26, v20, v21
  v_cvt_pk_bf16_f32 v27, v22, v23
  v_mfma_f32_16x16x32_bf16 v[196:199], v[88:91], v[244:247], v[196:199]
  ds_read_b64_tr_b16 v[48:49], v12 offset:33280
  buffer_store_dwordx4 v[24:27], v2, s[40:43], s63 offen offset:0 sc1
  v_mfma_f32_16x16x32_bf16 v[212:215], v[92:95], v[244:247], v[212:215]
  ds_read_b64_tr_b16 v[50:51], v12 offset:34304
  v_accvgpr_read_b32 v16, a196
  v_mfma_f32_16x16x32_bf16 v[104:107], v[64:67], v[248:251], v[104:107]
  ds_read_b64_tr_b16 v[52:53], v13 offset:33280
  v_accvgpr_read_b32 v17, a197
  v_accvgpr_read_b32 v18, a198
  v_mfma_f32_16x16x32_bf16 v[120:123], v[68:71], v[248:251], v[120:123]
  ds_read_b64_tr_b16 v[54:55], v13 offset:34304
  v_accvgpr_read_b32 v19, a199
  v_mfma_f32_16x16x32_bf16 v[136:139], v[72:75], v[248:251], v[136:139]
  buffer_load_dwordx4 v6, s[32:35], s26 offen offset:3072 sc1 lds
  v_accvgpr_read_b32 v20, a228
  v_mfma_f32_16x16x32_bf16 v[152:155], v[76:79], v[248:251], v[152:155]
  s_add_u32 s26, s26, 1024
  ds_read_b64_tr_b16 v[56:57], v12 offset:33536
  v_accvgpr_read_b32 v21, a229
  v_mfma_f32_16x16x32_bf16 v[168:171], v[80:83], v[248:251], v[168:171]
  ds_read_b64_tr_b16 v[58:59], v12 offset:34560
  v_accvgpr_read_b32 v22, a230
  v_accvgpr_read_b32 v23, a231
  v_mfma_f32_16x16x32_bf16 v[184:187], v[84:87], v[248:251], v[184:187]
  ds_read_b64_tr_b16 v[60:61], v13 offset:33536
  v_mul_f32 v16, s76, v16
  v_mfma_f32_16x16x32_bf16 v[200:203], v[88:91], v[248:251], v[200:203]
  s_add_u32 m0, s24, 16384
  ds_read_b64_tr_b16 v[62:63], v13 offset:34560
  v_mul_f32 v17, s76, v17
  v_mfma_f32_16x16x32_bf16 v[216:219], v[92:95], v[248:251], v[216:219]
  buffer_load_dwordx4 v8, s[36:39], s27 offen offset:0 lds
  v_mul_f32 v18, s76, v18
  v_mul_f32 v19, s76, v19
  v_mfma_f32_16x16x32_bf16 v[108:111], v[64:67], v[252:255], v[108:111]
  ds_read_b128 v[232:235], v14 offset:2048
  v_mul_f32 v20, s76, v20
  v_mfma_f32_16x16x32_bf16 v[124:127], v[68:71], v[252:255], v[124:127]
  ds_read_b128 v[236:239], v14 offset:3072
  v_mul_f32 v21, s76, v21
  v_mfma_f32_16x16x32_bf16 v[140:143], v[72:75], v[252:255], v[140:143]
  v_mul_f32 v22, s76, v22
  v_mul_f32 v23, s76, v23
  v_cvt_pk_bf16_f32 v28, v16, v17
  v_mfma_f32_16x16x32_bf16 v[156:159], v[76:79], v[252:255], v[156:159]
  v_cvt_pk_bf16_f32 v29, v18, v19
  v_cvt_pk_bf16_f32 v30, v20, v21
  v_mfma_f32_16x16x32_bf16 v[172:175], v[80:83], v[252:255], v[172:175]
  buffer_load_dwordx4 v9, s[36:39], s27 offen offset:1024 lds
  v_cvt_pk_bf16_f32 v31, v22, v23
  v_mfma_f32_16x16x32_bf16 v[188:191], v[84:87], v[252:255], v[188:191]
  buffer_store_dwordx4 v[28:31], v2, s[40:43], s63 offen offset:1024 sc1
  v_mfma_f32_16x16x32_bf16 v[204:207], v[88:91], v[252:255], v[204:207]
  v_mfma_f32_16x16x32_bf16 v[220:223], v[92:95], v[252:255], v[220:223]
  s_waitcnt vmcnt(19) lgkmcnt(0)
  v_mfma_f32_16x16x32_bf16 v[96:99], v[32:35], v[224:227], v[96:99]
  s_add_u32 s63, s63, s61
  v_accvgpr_read_b32 v16, a200
  v_accvgpr_read_b32 v17, a201
  v_accvgpr_read_b32 v18, a202
  v_mfma_f32_16x16x32_bf16 v[112:115], v[36:39], v[224:227], v[112:115]
  ds_read_b64_tr_b16 v[64:65], v12 offset:40960
  v_accvgpr_read_b32 v19, a203
  v_mfma_f32_16x16x32_bf16 v[128:131], v[40:43], v[224:227], v[128:131]
  s_add_u32 m0, s24, 65536
  ds_read_b64_tr_b16 v[66:67], v12 offset:41984
  v_accvgpr_read_b32 v20, a232
  v_accvgpr_read_b32 v21, a233
  v_mfma_f32_16x16x32_bf16 v[144:147], v[44:47], v[224:227], v[144:147]
  buffer_load_dwordx4 v3, s[32:35], s26 offen offset:0 sc1 lds
  v_accvgpr_read_b32 v22, a234
  v_mfma_f32_16x16x32_bf16 v[160:163], v[48:51], v[224:227], v[160:163]
  ds_read_b64_tr_b16 v[68:69], v13 offset:40960
  v_accvgpr_read_b32 v23, a235
  v_mfma_f32_16x16x32_bf16 v[176:179], v[52:55], v[224:227], v[176:179]
  ds_read_b64_tr_b16 v[70:71], v13 offset:41984
  v_mul_f32 v16, s76, v16
  v_mul_f32 v17, s76, v17
  v_mfma_f32_16x16x32_bf16 v[192:195], v[56:59], v[224:227], v[192:195]
  ds_read_b64_tr_b16 v[72:73], v12 offset:41216
  v_mul_f32 v18, s76, v18
  v_mfma_f32_16x16x32_bf16 v[208:211], v[60:63], v[224:227], v[208:211]
  ds_read_b64_tr_b16 v[74:75], v12 offset:42240
  v_mul_f32 v19, s76, v19
  v_mul_f32 v20, s76, v20
  v_mfma_f32_16x16x32_bf16 v[100:103], v[32:35], v[228:231], v[100:103]
  buffer_load_dwordx4 v4, s[32:35], s26 offen offset:1024 sc1 lds
  v_mul_f32 v21, s76, v21
  v_mfma_f32_16x16x32_bf16 v[116:119], v[36:39], v[228:231], v[116:119]
  ds_read_b64_tr_b16 v[76:77], v13 offset:41216
  v_mul_f32 v22, s76, v22
  v_mfma_f32_16x16x32_bf16 v[132:135], v[40:43], v[228:231], v[132:135]
  ds_read_b64_tr_b16 v[78:79], v13 offset:42240
  v_mul_f32 v23, s76, v23
  v_cvt_pk_bf16_f32 v24, v16, v17
  v_mfma_f32_16x16x32_bf16 v[148:151], v[44:47], v[228:231], v[148:151]
  ds_read_b128 v[240:243], v14 offset:32768
  v_cvt_pk_bf16_f32 v25, v18, v19
  v_mfma_f32_16x16x32_bf16 v[164:167], v[48:51], v[228:231], v[164:167]
  ds_read_b128 v[244:247], v14 offset:33792
  v_cvt_pk_bf16_f32 v26, v20, v21
  v_cvt_pk_bf16_f32 v27, v22, v23
  v_mfma_f32_16x16x32_bf16 v[180:183], v[52:55], v[228:231], v[180:183]
  buffer_load_dwordx4 v5, s[32:35], s26 offen offset:2048 sc1 lds
  buffer_store_dwordx4 v[24:27], v2, s[40:43], s63 offen offset:0 sc1
  v_mfma_f32_16x16x32_bf16 v[196:199], v[56:59], v[228:231], v[196:199]
  ds_read_b64_tr_b16 v[80:81], v12 offset:41472
  v_accvgpr_read_b32 v16, a204
  v_mfma_f32_16x16x32_bf16 v[212:215], v[60:63], v[228:231], v[212:215]
  ds_read_b64_tr_b16 v[82:83], v12 offset:42496
  v_accvgpr_read_b32 v17, a205
  v_accvgpr_read_b32 v18, a206
  v_mfma_f32_16x16x32_bf16 v[104:107], v[32:35], v[232:235], v[104:107]
  ds_read_b64_tr_b16 v[84:85], v13 offset:41472
  v_accvgpr_read_b32 v19, a207
  v_mfma_f32_16x16x32_bf16 v[120:123], v[36:39], v[232:235], v[120:123]
  ds_read_b64_tr_b16 v[86:87], v13 offset:42496
  v_accvgpr_read_b32 v20, a236
  v_accvgpr_read_b32 v21, a237
  v_mfma_f32_16x16x32_bf16 v[136:139], v[40:43], v[232:235], v[136:139]
  buffer_load_dwordx4 v6, s[32:35], s26 offen offset:3072 sc1 lds
  v_accvgpr_read_b32 v22, a238
  v_mfma_f32_16x16x32_bf16 v[152:155], v[44:47], v[232:235], v[152:155]
  s_add_u32 s26, s26, 1024
  ds_read_b64_tr_b16 v[88:89], v12 offset:41728
  v_accvgpr_read_b32 v23, a239
  v_mfma_f32_16x16x32_bf16 v[168:171], v[48:51], v[232:235], v[168:171]
  ds_read_b64_tr_b16 v[90:91], v12 offset:42752
  v_mul_f32 v16, s76, v16
  v_mul_f32 v17, s76, v17
  v_mfma_f32_16x16x32_bf16 v[184:187], v[52:55], v[232:235], v[184:187]
  ds_read_b64_tr_b16 v[92:93], v13 offset:41728
  v_mul_f32 v18, s76, v18
  v_mfma_f32_16x16x32_bf16 v[200:203], v[56:59], v[232:235], v[200:203]
  s_add_u32 m0, s24, 16384
  ds_read_b64_tr_b16 v[94:95], v13 offset:42752
  v_mul_f32 v19, s76, v19
  v_mul_f32 v20, s76, v20
  v_mfma_f32_16x16x32_bf16 v[216:219], v[60:63], v[232:235], v[216:219]
  buffer_load_dwordx4 v10, s[36:39], s27 offen offset:2048 lds
  v_mul_f32 v21, s76, v21
  v_mfma_f32_16x16x32_bf16 v[108:111], v[32:35], v[236:239], v[108:111]
  ds_read_b128 v[248:251], v14 offset:34816
  v_mul_f32 v22, s76, v22
  v_mfma_f32_16x16x32_bf16 v[124:127], v[36:39], v[236:239], v[124:127]
  ds_read_b128 v[252:255], v14 offset:35840
  v_mul_f32 v23, s76, v23
  v_cvt_pk_bf16_f32 v28, v16, v17
  v_mfma_f32_16x16x32_bf16 v[140:143], v[40:43], v[236:239], v[140:143]
  v_cvt_pk_bf16_f32 v29, v18, v19
  v_cvt_pk_bf16_f32 v30, v20, v21
  v_mfma_f32_16x16x32_bf16 v[156:159], v[44:47], v[236:239], v[156:159]
  v_xor_b32 v14, 0x10000, v14
  v_cvt_pk_bf16_f32 v31, v22, v23
  v_mfma_f32_16x16x32_bf16 v[172:175], v[48:51], v[236:239], v[172:175]
  buffer_load_dwordx4 v11, s[36:39], s27 offen offset:3072 lds
  buffer_store_dwordx4 v[28:31], v2, s[40:43], s63 offen offset:1024 sc1
  v_mfma_f32_16x16x32_bf16 v[188:191], v[52:55], v[236:239], v[188:191]
  s_add_u32 s27, s27, 524288
  v_xor_b32 v12, 0x10000, v12
  v_mfma_f32_16x16x32_bf16 v[204:207], v[56:59], v[236:239], v[204:207]
  v_xor_b32 v13, 0x10000, v13
  v_mfma_f32_16x16x32_bf16 v[220:223], v[60:63], v[236:239], v[220:223]
  s_waitcnt vmcnt(19) lgkmcnt(0)
  v_mfma_f32_16x16x32_bf16 v[96:99], v[64:67], v[240:243], v[96:99]
  s_barrier
  v_accvgpr_read_b32 v16, a208
  v_accvgpr_read_b32 v17, a209
  v_accvgpr_read_b32 v18, a210
  v_mfma_f32_16x16x32_bf16 v[112:115], v[68:71], v[240:243], v[112:115]
  s_add_u32 s63, s63, s61
  ds_read_b64_tr_b16 v[32:33], v12 offset:0
  v_accvgpr_read_b32 v19, a211
  v_mfma_f32_16x16x32_bf16 v[128:131], v[72:75], v[240:243], v[128:131]
  s_add_u32 m0, s24, 98304
  ds_read_b64_tr_b16 v[34:35], v12 offset:1024
  v_accvgpr_read_b32 v20, a240
  v_mfma_f32_16x16x32_bf16 v[144:147], v[76:79], v[240:243], v[144:147]
  buffer_load_dwordx4 v3, s[32:35], s26 offen offset:0 sc1 lds
  v_accvgpr_read_b32 v21, a241
  v_accvgpr_read_b32 v22, a242
  v_mfma_f32_16x16x32_bf16 v[160:163], v[80:83], v[240:243], v[160:163]
  ds_read_b64_tr_b16 v[36:37], v13 offset:0
  v_accvgpr_read_b32 v23, a243
  v_mfma_f32_16x16x32_bf16 v[176:179], v[84:87], v[240:243], v[176:179]
  ds_read_b64_tr_b16 v[38:39], v13 offset:1024
  v_mul_f32 v16, s76, v16
  v_mfma_f32_16x16x32_bf16 v[192:195], v[88:91], v[240:243], v[192:195]
  ds_read_b64_tr_b16 v[40:41], v12 offset:256
  v_mul_f32 v17, s76, v17
  v_mul_f32 v18, s76, v18
  v_mfma_f32_16x16x32_bf16 v[208:211], v[92:95], v[240:243], v[208:211]
  ds_read_b64_tr_b16 v[42:43], v12 offset:1280
  v_mul_f32 v19, s76, v19
  v_mfma_f32_16x16x32_bf16 v[100:103], v[64:67], v[244:247], v[100:103]
  buffer_load_dwordx4 v4, s[32:35], s26 offen offset:1024 sc1 lds
  v_mul_f32 v20, s76, v20
  v_mfma_f32_16x16x32_bf16 v[116:119], v[68:71], v[244:247], v[116:119]
  ds_read_b64_tr_b16 v[44:45], v13 offset:256
  v_mul_f32 v21, s76, v21
  v_mfma_f32_16x16x32_bf16 v[132:135], v[72:75], v[244:247], v[132:135]
  ds_read_b64_tr_b16 v[46:47], v13 offset:1280
  v_mul_f32 v22, s76, v22
  v_mul_f32 v23, s76, v23
  v_mfma_f32_16x16x32_bf16 v[148:151], v[76:79], v[244:247], v[148:151]
  ds_read_b128 v[224:227], v14 offset:0
  v_cvt_pk_bf16_f32 v24, v16, v17
  v_mfma_f32_16x16x32_bf16 v[164:167], v[80:83], v[244:247], v[164:167]
  ds_read_b128 v[228:231], v14 offset:1024
  v_cvt_pk_bf16_f32 v25, v18, v19
  v_mfma_f32_16x16x32_bf16 v[180:183], v[84:87], v[244:247], v[180:183]
  buffer_load_dwordx4 v5, s[32:35], s26 offen offset:2048 sc1 lds
  v_cvt_pk_bf16_f32 v26, v20, v21
  v_cvt_pk_bf16_f32 v27, v22, v23
  v_mfma_f32_16x16x32_bf16 v[196:199], v[88:91], v[244:247], v[196:199]
  ds_read_b64_tr_b16 v[48:49], v12 offset:512
  buffer_store_dwordx4 v[24:27], v2, s[40:43], s63 offen offset:0 sc1
  v_mfma_f32_16x16x32_bf16 v[212:215], v[92:95], v[244:247], v[212:215]
  ds_read_b64_tr_b16 v[50:51], v12 offset:1536
  v_accvgpr_read_b32 v16, a212
  v_mfma_f32_16x16x32_bf16 v[104:107], v[64:67], v[248:251], v[104:107]
  ds_read_b64_tr_b16 v[52:53], v13 offset:512
  v_accvgpr_read_b32 v17, a213
  v_accvgpr_read_b32 v18, a214
  v_mfma_f32_16x16x32_bf16 v[120:123], v[68:71], v[248:251], v[120:123]
  ds_read_b64_tr_b16 v[54:55], v13 offset:1536
  v_accvgpr_read_b32 v19, a215
  v_mfma_f32_16x16x32_bf16 v[136:139], v[72:75], v[248:251], v[136:139]
  buffer_load_dwordx4 v6, s[32:35], s26 offen offset:3072 sc1 lds
  v_accvgpr_read_b32 v20, a244
  v_mfma_f32_16x16x32_bf16 v[152:155], v[76:79], v[248:251], v[152:155]
  s_add_u32 s26, s26, 1024
  ds_read_b64_tr_b16 v[56:57], v12 offset:768
  v_accvgpr_read_b32 v21, a245
  v_mfma_f32_16x16x32_bf16 v[168:171], v[80:83], v[248:251], v[168:171]
  ds_read_b64_tr_b16 v[58:59], v12 offset:1792
  v_accvgpr_read_b32 v22, a246
  v_accvgpr_read_b32 v23, a247
  v_mfma_f32_16x16x32_bf16 v[184:187], v[84:87], v[248:251], v[184:187]
  ds_read_b64_tr_b16 v[60:61], v13 offset:768
  v_mul_f32 v16, s76, v16
  v_mfma_f32_16x16x32_bf16 v[200:203], v[88:91], v[248:251], v[200:203]
  s_add_u32 m0, s24, 49152
  ds_read_b64_tr_b16 v[62:63], v13 offset:1792
  v_mul_f32 v17, s76, v17
  v_mfma_f32_16x16x32_bf16 v[216:219], v[92:95], v[248:251], v[216:219]
  buffer_load_dwordx4 v8, s[36:39], s27 offen offset:0 lds
  v_mul_f32 v18, s76, v18
  v_mul_f32 v19, s76, v19
  v_mfma_f32_16x16x32_bf16 v[108:111], v[64:67], v[252:255], v[108:111]
  ds_read_b128 v[232:235], v14 offset:2048
  v_mul_f32 v20, s76, v20
  v_mfma_f32_16x16x32_bf16 v[124:127], v[68:71], v[252:255], v[124:127]
  ds_read_b128 v[236:239], v14 offset:3072
  v_mul_f32 v21, s76, v21
  v_mfma_f32_16x16x32_bf16 v[140:143], v[72:75], v[252:255], v[140:143]
  v_mul_f32 v22, s76, v22
  v_mul_f32 v23, s76, v23
  v_cvt_pk_bf16_f32 v28, v16, v17
  v_mfma_f32_16x16x32_bf16 v[156:159], v[76:79], v[252:255], v[156:159]
  v_cvt_pk_bf16_f32 v29, v18, v19
  v_cvt_pk_bf16_f32 v30, v20, v21
  v_mfma_f32_16x16x32_bf16 v[172:175], v[80:83], v[252:255], v[172:175]
  buffer_load_dwordx4 v9, s[36:39], s27 offen offset:1024 lds
  v_cvt_pk_bf16_f32 v31, v22, v23
  v_mfma_f32_16x16x32_bf16 v[188:191], v[84:87], v[252:255], v[188:191]
  buffer_store_dwordx4 v[28:31], v2, s[40:43], s63 offen offset:1024 sc1
  v_mfma_f32_16x16x32_bf16 v[204:207], v[88:91], v[252:255], v[204:207]
  v_mfma_f32_16x16x32_bf16 v[220:223], v[92:95], v[252:255], v[220:223]
  s_waitcnt vmcnt(19) lgkmcnt(0)
  v_mfma_f32_16x16x32_bf16 v[96:99], v[32:35], v[224:227], v[96:99]
  s_add_u32 s63, s63, s61
  v_accvgpr_read_b32 v16, a216
  v_accvgpr_read_b32 v17, a217
  v_accvgpr_read_b32 v18, a218
  v_mfma_f32_16x16x32_bf16 v[112:115], v[36:39], v[224:227], v[112:115]
  ds_read_b64_tr_b16 v[64:65], v12 offset:8192
  v_accvgpr_read_b32 v19, a219
  v_mfma_f32_16x16x32_bf16 v[128:131], v[40:43], v[224:227], v[128:131]
  s_add_u32 m0, s24, 0
  ds_read_b64_tr_b16 v[66:67], v12 offset:9216
  v_accvgpr_read_b32 v20, a248
  v_mfma_f32_16x16x32_bf16 v[144:147], v[44:47], v[224:227], v[144:147]
  buffer_load_dwordx4 v3, s[32:35], s26 offen offset:0 sc1 lds
  v_accvgpr_read_b32 v21, a249
  v_accvgpr_read_b32 v22, a250
  v_mfma_f32_16x16x32_bf16 v[160:163], v[48:51], v[224:227], v[160:163]
  ds_read_b64_tr_b16 v[68:69], v13 offset:8192
  v_accvgpr_read_b32 v23, a251
  v_mfma_f32_16x16x32_bf16 v[176:179], v[52:55], v[224:227], v[176:179]
  ds_read_b64_tr_b16 v[70:71], v13 offset:9216
  v_mul_f32 v16, s76, v16
  v_mfma_f32_16x16x32_bf16 v[192:195], v[56:59], v[224:227], v[192:195]
  ds_read_b64_tr_b16 v[72:73], v12 offset:8448
  v_mul_f32 v17, s76, v17
  v_mul_f32 v18, s76, v18
  v_mfma_f32_16x16x32_bf16 v[208:211], v[60:63], v[224:227], v[208:211]
  ds_read_b64_tr_b16 v[74:75], v12 offset:9472
  v_mul_f32 v19, s76, v19
  v_mfma_f32_16x16x32_bf16 v[100:103], v[32:35], v[228:231], v[100:103]
  buffer_load_dwordx4 v4, s[32:35], s26 offen offset:1024 sc1 lds
  v_mul_f32 v20, s76, v20
  v_mfma_f32_16x16x32_bf16 v[116:119], v[36:39], v[228:231], v[116:119]
  ds_read_b64_tr_b16 v[76:77], v13 offset:8448
  v_mul_f32 v21, s76, v21
  v_mul_f32 v22, s76, v22
  v_mfma_f32_16x16x32_bf16 v[132:135], v[40:43], v[228:231], v[132:135]
  ds_read_b64_tr_b16 v[78:79], v13 offset:9472
  v_mul_f32 v23, s76, v23
  v_mfma_f32_16x16x32_bf16 v[148:151], v[44:47], v[228:231], v[148:151]
  ds_read_b128 v[240:243], v14 offset:32768
  v_cvt_pk_bf16_f32 v24, v16, v17
  v_mfma_f32_16x16x32_bf16 v[164:167], v[48:51], v[228:231], v[164:167]
  ds_read_b128 v[244:247], v14 offset:33792
  v_cvt_pk_bf16_f32 v25, v18, v19
  v_cvt_pk_bf16_f32 v26, v20, v21
  v_mfma_f32_16x16x32_bf16 v[180:183], v[52:55], v[228:231], v[180:183]
  buffer_load_dwordx4 v5, s[32:35], s26 offen offset:2048 sc1 lds
  v_cvt_pk_bf16_f32 v27, v22, v23
  v_mfma_f32_16x16x32_bf16 v[196:199], v[56:59], v[228:231], v[196:199]
  ds_read_b64_tr_b16 v[80:81], v12 offset:8704
  buffer_store_dwordx4 v[24:27], v2, s[40:43], s63 offen offset:0 sc1
  v_mfma_f32_16x16x32_bf16 v[212:215], v[60:63], v[228:231], v[212:215]
  ds_read_b64_tr_b16 v[82:83], v12 offset:9728
  v_accvgpr_read_b32 v16, a220
  v_accvgpr_read_b32 v17, a221
  v_mfma_f32_16x16x32_bf16 v[104:107], v[32:35], v[232:235], v[104:107]
  ds_read_b64_tr_b16 v[84:85], v13 offset:8704
  v_accvgpr_read_b32 v18, a222
  v_mfma_f32_16x16x32_bf16 v[120:123], v[36:39], v[232:235], v[120:123]
  ds_read_b64_tr_b16 v[86:87], v13 offset:9728
  v_accvgpr_read_b32 v19, a223
  v_mfma_f32_16x16x32_bf16 v[136:139], v[40:43], v[232:235], v[136:139]
  buffer_load_dwordx4 v6, s[32:35], s26 offen offset:3072 sc1 lds
  v_accvgpr_read_b32 v20, a252
  v_accvgpr_read_b32 v21, a253
  v_mfma_f32_16x16x32_bf16 v[152:155], v[44:47], v[232:235], v[152:155]
  s_add_u32 s26, s26, 1024
  ds_read_b64_tr_b16 v[88:89], v12 offset:8960
  v_accvgpr_read_b32 v22, a254
  v_mfma_f32_16x16x32_bf16 v[168:171], v[48:51], v[232:235], v[168:171]
  ds_read_b64_tr_b16 v[90:91], v12 offset:9984
  v_accvgpr_read_b32 v23, a255
  v_mfma_f32_16x16x32_bf16 v[184:187], v[52:55], v[232:235], v[184:187]
  ds_read_b64_tr_b16 v[92:93], v13 offset:8960
  v_mul_f32 v16, s76, v16
  v_mul_f32 v17, s76, v17
  v_mfma_f32_16x16x32_bf16 v[200:203], v[56:59], v[232:235], v[200:203]
  s_add_u32 m0, s24, 49152
  ds_read_b64_tr_b16 v[94:95], v13 offset:9984
  v_mul_f32 v18, s76, v18
  v_mfma_f32_16x16x32_bf16 v[216:219], v[60:63], v[232:235], v[216:219]
  buffer_load_dwordx4 v10, s[36:39], s27 offen offset:2048 lds
  v_mul_f32 v19, s76, v19
  v_mfma_f32_16x16x32_bf16 v[108:111], v[32:35], v[236:239], v[108:111]
  ds_read_b128 v[248:251], v14 offset:34816
  v_mul_f32 v20, s76, v20
  v_mul_f32 v21, s76, v21
  v_mfma_f32_16x16x32_bf16 v[124:127], v[36:39], v[236:239], v[124:127]
  ds_read_b128 v[252:255], v14 offset:35840
  v_mul_f32 v22, s76, v22
  v_mfma_f32_16x16x32_bf16 v[140:143], v[40:43], v[236:239], v[140:143]
  v_mul_f32 v23, s76, v23
  v_cvt_pk_bf16_f32 v28, v16, v17
  v_mfma_f32_16x16x32_bf16 v[156:159], v[44:47], v[236:239], v[156:159]
  v_xor_b32 v14, 0x10000, v14
  v_cvt_pk_bf16_f32 v29, v18, v19
  v_cvt_pk_bf16_f32 v30, v20, v21
  v_mfma_f32_16x16x32_bf16 v[172:175], v[48:51], v[236:239], v[172:175]
  buffer_load_dwordx4 v11, s[36:39], s27 offen offset:3072 lds
  v_cvt_pk_bf16_f32 v31, v22, v23
  v_mfma_f32_16x16x32_bf16 v[188:191], v[52:55], v[236:239], v[188:191]
  s_add_u32 s27, s27, 524288
  buffer_store_dwordx4 v[28:31], v2, s[40:43], s63 offen offset:1024 sc1
  v_mfma_f32_16x16x32_bf16 v[204:207], v[56:59], v[236:239], v[204:207]
  v_mfma_f32_16x16x32_bf16 v[220:223], v[60:63], v[236:239], v[220:223]
  s_waitcnt vmcnt(19) lgkmcnt(0)
  v_mfma_f32_16x16x32_bf16 v[96:99], v[64:67], v[240:243], v[96:99]
  s_barrier
  v_and_b32 v11, 15, v1
  v_lshrrev_b32 v10, 4, v1
  v_mfma_f32_16x16x32_bf16 v[112:115], v[68:71], v[240:243], v[112:115]
  ds_read_b64_tr_b16 v[32:33], v12 offset:32768
  v_lshlrev_b32 v10, 2, v10
  v_mfma_f32_16x16x32_bf16 v[128:131], v[72:75], v[240:243], v[128:131]
  s_add_u32 m0, s24, 32768
  ds_read_b64_tr_b16 v[34:35], v12 offset:33792
  v_sub_u32 v11, v11, v10
  v_mfma_f32_16x16x32_bf16 v[144:147], v[76:79], v[240:243], v[144:147]
  buffer_load_dwordx4 v3, s[32:35], s26 offen offset:0 sc1 lds
  v_cmp_le_i32 s[68:69], 0, v11
  v_mfma_f32_16x16x32_bf16 v[160:163], v[80:83], v[240:243], v[160:163]
  ds_read_b64_tr_b16 v[36:37], v13 offset:32768
  v_cmp_le_i32 s[70:71], 1, v11
  v_mfma_f32_16x16x32_bf16 v[176:179], v[84:87], v[240:243], v[176:179]
  ds_read_b64_tr_b16 v[38:39], v13 offset:33792
  v_cmp_le_i32 s[72:73], 2, v11
  v_mfma_f32_16x16x32_bf16 v[192:195], v[88:91], v[240:243], v[192:195]
  ds_read_b64_tr_b16 v[40:41], v12 offset:33024
  v_cmp_le_i32 s[74:75], 3, v11
  v_mfma_f32_16x16x32_bf16 v[208:211], v[92:95], v[240:243], v[208:211]
  ds_read_b64_tr_b16 v[42:43], v12 offset:34048
  v_and_b32 v8, 7, v1
  v_mfma_f32_16x16x32_bf16 v[100:103], v[64:67], v[244:247], v[100:103]
  buffer_load_dwordx4 v4, s[32:35], s26 offen offset:1024 sc1 lds
  v_lshlrev_b32 v8, 2, v8
  v_mfma_f32_16x16x32_bf16 v[116:119], v[68:71], v[244:247], v[116:119]
  ds_read_b64_tr_b16 v[44:45], v13 offset:33024
  v_add_u32 v8, s30, v8
  v_mfma_f32_16x16x32_bf16 v[132:135], v[72:75], v[244:247], v[132:135]
  ds_read_b64_tr_b16 v[46:47], v13 offset:34048
  v_mov_b32 v9, 1073741824
  v_mfma_f32_16x16x32_bf16 v[148:151], v[76:79], v[244:247], v[148:151]
  ds_read_b128 v[224:227], v14 offset:0
  v_mov_b32 v10, 1
  v_mfma_f32_16x16x32_bf16 v[164:167], v[80:83], v[244:247], v[164:167]
  ds_read_b128 v[228:231], v14 offset:1024
  v_writelane_b32 v9, s29, 0
  v_mfma_f32_16x16x32_bf16 v[180:183], v[84:87], v[244:247], v[180:183]
  buffer_load_dwordx4 v5, s[32:35], s26 offen offset:2048 sc1 lds
  v_accvgpr_write_b32 a0, 0
  v_mfma_f32_16x16x32_bf16 v[196:199], v[88:91], v[244:247], v[196:199]
  ds_read_b64_tr_b16 v[48:49], v12 offset:33280
  v_accvgpr_write_b32 a1, 0
  v_mfma_f32_16x16x32_bf16 v[212:215], v[92:95], v[244:247], v[212:215]
  ds_read_b64_tr_b16 v[50:51], v12 offset:34304
  v_accvgpr_write_b32 a2, 0
  v_mfma_f32_16x16x32_bf16 v[104:107], v[64:67], v[248:251], v[104:107]
  ds_read_b64_tr_b16 v[52:53], v13 offset:33280
  v_accvgpr_write_b32 a3, 0
  v_mfma_f32_16x16x32_bf16 v[120:123], v[68:71], v[248:251], v[120:123]
  ds_read_b64_tr_b16 v[54:55], v13 offset:34304
  v_accvgpr_write_b32 a32, 0
  v_mfma_f32_16x16x32_bf16 v[136:139], v[72:75], v[248:251], v[136:139]
  buffer_load_dwordx4 v6, s[32:35], s26 offen offset:3072 sc1 lds
  v_accvgpr_write_b32 a33, 0
  v_mfma_f32_16x16x32_bf16 v[152:155], v[76:79], v[248:251], v[152:155]
  s_add_u32 s26, s26, 1024
  ds_read_b64_tr_b16 v[56:57], v12 offset:33536
  v_accvgpr_write_b32 a34, 0
  v_mfma_f32_16x16x32_bf16 v[168:171], v[80:83], v[248:251], v[168:171]
  ds_read_b64_tr_b16 v[58:59], v12 offset:34560
  v_accvgpr_write_b32 a35, 0
  v_mfma_f32_16x16x32_bf16 v[184:187], v[84:87], v[248:251], v[184:187]
  ds_read_b64_tr_b16 v[60:61], v13 offset:33536
  v_accvgpr_write_b32 a4, 0
  v_mfma_f32_16x16x32_bf16 v[200:203], v[88:91], v[248:251], v[200:203]
  ds_read_b64_tr_b16 v[62:63], v13 offset:34560
  v_accvgpr_write_b32 a5, 0
  v_mfma_f32_16x16x32_bf16 v[216:219], v[92:95], v[248:251], v[216:219]
  v_accvgpr_write_b32 a6, 0
  v_accvgpr_write_b32 a7, 0
  v_mfma_f32_16x16x32_bf16 v[108:111], v[64:67], v[252:255], v[108:111]
  ds_read_b128 v[232:235], v14 offset:2048
  v_accvgpr_write_b32 a36, 0
  v_mfma_f32_16x16x32_bf16 v[124:127], v[68:71], v[252:255], v[124:127]
  ds_read_b128 v[236:239], v14 offset:3072
  v_accvgpr_write_b32 a37, 0
  v_mfma_f32_16x16x32_bf16 v[140:143], v[72:75], v[252:255], v[140:143]
  v_accvgpr_write_b32 a38, 0
  v_accvgpr_write_b32 a39, 0
  v_mfma_f32_16x16x32_bf16 v[156:159], v[76:79], v[252:255], v[156:159]
  v_accvgpr_write_b32 a8, 0
  v_accvgpr_write_b32 a9, 0
  v_mfma_f32_16x16x32_bf16 v[172:175], v[80:83], v[252:255], v[172:175]
  v_accvgpr_write_b32 a10, 0
  v_accvgpr_write_b32 a11, 0
  v_mfma_f32_16x16x32_bf16 v[188:191], v[84:87], v[252:255], v[188:191]
  v_accvgpr_write_b32 a40, 0
  v_accvgpr_write_b32 a41, 0
  v_mfma_f32_16x16x32_bf16 v[204:207], v[88:91], v[252:255], v[204:207]
  v_accvgpr_write_b32 a42, 0
  v_mfma_f32_16x16x32_bf16 v[220:223], v[92:95], v[252:255], v[220:223]
  s_waitcnt vmcnt(15) lgkmcnt(0)
  v_mfma_f32_16x16x32_bf16 v[96:99], v[32:35], v[224:227], v[96:99]
  v_accvgpr_write_b32 a43, 0
  v_accvgpr_write_b32 a12, 0
  v_mfma_f32_16x16x32_bf16 v[112:115], v[36:39], v[224:227], v[112:115]
  ds_read_b64_tr_b16 v[64:65], v12 offset:40960
  v_accvgpr_write_b32 a13, 0
  v_mfma_f32_16x16x32_bf16 v[128:131], v[40:43], v[224:227], v[128:131]
  s_add_u32 m0, s24, 65536
  ds_read_b64_tr_b16 v[66:67], v12 offset:41984
  v_accvgpr_write_b32 a14, 0
  v_mfma_f32_16x16x32_bf16 v[144:147], v[44:47], v[224:227], v[144:147]
  buffer_load_dwordx4 v3, s[32:35], s26 offen offset:0 sc1 lds
  v_accvgpr_write_b32 a15, 0
  v_mfma_f32_16x16x32_bf16 v[160:163], v[48:51], v[224:227], v[160:163]
  ds_read_b64_tr_b16 v[68:69], v13 offset:40960
  v_accvgpr_write_b32 a44, 0
  v_mfma_f32_16x16x32_bf16 v[176:179], v[52:55], v[224:227], v[176:179]
  ds_read_b64_tr_b16 v[70:71], v13 offset:41984
  v_accvgpr_write_b32 a45, 0
  v_mfma_f32_16x16x32_bf16 v[192:195], v[56:59], v[224:227], v[192:195]
  ds_read_b64_tr_b16 v[72:73], v12 offset:41216
  v_accvgpr_write_b32 a46, 0
  v_mfma_f32_16x16x32_bf16 v[208:211], v[60:63], v[224:227], v[208:211]
  ds_read_b64_tr_b16 v[74:75], v12 offset:42240
  v_accvgpr_write_b32 a47, 0
  v_mfma_f32_16x16x32_bf16 v[100:103], v[32:35], v[228:231], v[100:103]
  buffer_load_dwordx4 v4, s[32:35], s26 offen offset:1024 sc1 lds
  v_accvgpr_write_b32 a16, 0
  v_mfma_f32_16x16x32_bf16 v[116:119], v[36:39], v[228:231], v[116:119]
  ds_read_b64_tr_b16 v[76:77], v13 offset:41216
  v_accvgpr_write_b32 a17, 0
  v_mfma_f32_16x16x32_bf16 v[132:135], v[40:43], v[228:231], v[132:135]
  ds_read_b64_tr_b16 v[78:79], v13 offset:42240
  v_accvgpr_write_b32 a18, 0
  v_mfma_f32_16x16x32_bf16 v[148:151], v[44:47], v[228:231], v[148:151]
  ds_read_b128 v[240:243], v14 offset:32768
  v_accvgpr_write_b32 a19, 0
  v_mfma_f32_16x16x32_bf16 v[164:167], v[48:51], v[228:231], v[164:167]
  ds_read_b128 v[244:247], v14 offset:33792
  v_accvgpr_write_b32 a48, 0
  v_mfma_f32_16x16x32_bf16 v[180:183], v[52:55], v[228:231], v[180:183]
  buffer_load_dwordx4 v5, s[32:35], s26 offen offset:2048 sc1 lds
  v_accvgpr_write_b32 a49, 0
  v_mfma_f32_16x16x32_bf16 v[196:199], v[56:59], v[228:231], v[196:199]
  ds_read_b64_tr_b16 v[80:81], v12 offset:41472
  v_accvgpr_write_b32 a50, 0
  v_mfma_f32_16x16x32_bf16 v[212:215], v[60:63], v[228:231], v[212:215]
  ds_read_b64_tr_b16 v[82:83], v12 offset:42496
  v_accvgpr_write_b32 a51, 0
  v_mfma_f32_16x16x32_bf16 v[104:107], v[32:35], v[232:235], v[104:107]
  ds_read_b64_tr_b16 v[84:85], v13 offset:41472
  v_accvgpr_write_b32 a20, 0
  v_mfma_f32_16x16x32_bf16 v[120:123], v[36:39], v[232:235], v[120:123]
  ds_read_b64_tr_b16 v[86:87], v13 offset:42496
  v_accvgpr_write_b32 a21, 0
  v_mfma_f32_16x16x32_bf16 v[136:139], v[40:43], v[232:235], v[136:139]
  buffer_load_dwordx4 v6, s[32:35], s26 offen offset:3072 sc1 lds
  v_accvgpr_write_b32 a22, 0
  v_mfma_f32_16x16x32_bf16 v[152:155], v[44:47], v[232:235], v[152:155]
  s_add_u32 s26, s26, 1024
  ds_read_b64_tr_b16 v[88:89], v12 offset:41728
  v_accvgpr_write_b32 a23, 0
  v_mfma_f32_16x16x32_bf16 v[168:171], v[48:51], v[232:235], v[168:171]
  ds_read_b64_tr_b16 v[90:91], v12 offset:42752
  v_accvgpr_write_b32 a52, 0
  v_mfma_f32_16x16x32_bf16 v[184:187], v[52:55], v[232:235], v[184:187]
  ds_read_b64_tr_b16 v[92:93], v13 offset:41728
  v_accvgpr_write_b32 a53, 0
  v_mfma_f32_16x16x32_bf16 v[200:203], v[56:59], v[232:235], v[200:203]
  ds_read_b64_tr_b16 v[94:95], v13 offset:42752
  v_accvgpr_write_b32 a54, 0
  v_mfma_f32_16x16x32_bf16 v[216:219], v[60:63], v[232:235], v[216:219]
  v_accvgpr_write_b32 a55, 0
  v_accvgpr_write_b32 a24, 0
  v_mfma_f32_16x16x32_bf16 v[108:111], v[32:35], v[236:239], v[108:111]
  ds_read_b128 v[248:251], v14 offset:34816
  v_accvgpr_write_b32 a25, 0
  v_mfma_f32_16x16x32_bf16 v[124:127], v[36:39], v[236:239], v[124:127]
  ds_read_b128 v[252:255], v14 offset:35840
  v_accvgpr_write_b32 a26, 0
  v_mfma_f32_16x16x32_bf16 v[140:143], v[40:43], v[236:239], v[140:143]
  v_accvgpr_write_b32 a27, 0
  v_accvgpr_write_b32 a56, 0
  v_mfma_f32_16x16x32_bf16 v[156:159], v[44:47], v[236:239], v[156:159]
  v_xor_b32 v14, 0x10000, v14
  v_accvgpr_write_b32 a57, 0
  v_mfma_f32_16x16x32_bf16 v[172:175], v[48:51], v[236:239], v[172:175]
  v_accvgpr_write_b32 a58, 0
  v_accvgpr_write_b32 a59, 0
  v_mfma_f32_16x16x32_bf16 v[188:191], v[52:55], v[236:239], v[188:191]
  v_xor_b32 v12, 0x10000, v12
  v_accvgpr_write_b32 a28, 0
  v_mfma_f32_16x16x32_bf16 v[204:207], v[56:59], v[236:239], v[204:207]
  v_xor_b32 v13, 0x10000, v13
  v_mfma_f32_16x16x32_bf16 v[220:223], v[60:63], v[236:239], v[220:223]
  s_waitcnt vmcnt(8) lgkmcnt(0)
  v_mfma_f32_16x16x32_bf16 v[96:99], v[64:67], v[240:243], v[96:99]
  s_barrier
  buffer_store_dword v10, v9, s[40:43], 0 offen sc1
  v_accvgpr_write_b32 a29, 0
  v_mfma_f32_16x16x32_bf16 v[112:115], v[68:71], v[240:243], v[112:115]
  ds_read_b64_tr_b16 v[32:33], v12 offset:0
  v_accvgpr_write_b32 a30, 0
  v_mfma_f32_16x16x32_bf16 v[128:131], v[72:75], v[240:243], v[128:131]
  s_add_u32 m0, s24, 98304
  ds_read_b64_tr_b16 v[34:35], v12 offset:1024
  v_accvgpr_write_b32 a31, 0
  v_mfma_f32_16x16x32_bf16 v[144:147], v[76:79], v[240:243], v[144:147]
  buffer_load_dwordx4 v3, s[32:35], s26 offen offset:0 sc1 lds
  v_accvgpr_write_b32 a60, 0
  v_mfma_f32_16x16x32_bf16 v[160:163], v[80:83], v[240:243], v[160:163]
  ds_read_b64_tr_b16 v[36:37], v13 offset:0
  v_accvgpr_write_b32 a61, 0
  v_mfma_f32_16x16x32_bf16 v[176:179], v[84:87], v[240:243], v[176:179]
  ds_read_b64_tr_b16 v[38:39], v13 offset:1024
  v_accvgpr_write_b32 a62, 0
  v_mfma_f32_16x16x32_bf16 v[192:195], v[88:91], v[240:243], v[192:195]
  ds_read_b64_tr_b16 v[40:41], v12 offset:256
  v_accvgpr_write_b32 a63, 0
  v_mfma_f32_16x16x32_bf16 v[208:211], v[92:95], v[240:243], v[208:211]
  ds_read_b64_tr_b16 v[42:43], v12 offset:1280
  v_accvgpr_write_b32 a64, 0
  v_mfma_f32_16x16x32_bf16 v[100:103], v[64:67], v[244:247], v[100:103]
  buffer_load_dwordx4 v4, s[32:35], s26 offen offset:1024 sc1 lds
  v_accvgpr_write_b32 a65, 0
  v_mfma_f32_16x16x32_bf16 v[116:119], v[68:71], v[244:247], v[116:119]
  ds_read_b64_tr_b16 v[44:45], v13 offset:256
  v_accvgpr_write_b32 a66, 0
  v_mfma_f32_16x16x32_bf16 v[132:135], v[72:75], v[244:247], v[132:135]
  ds_read_b64_tr_b16 v[46:47], v13 offset:1280
  v_accvgpr_write_b32 a67, 0
  v_mfma_f32_16x16x32_bf16 v[148:151], v[76:79], v[244:247], v[148:151]
  ds_read_b128 v[224:227], v14 offset:0
  v_accvgpr_write_b32 a96, 0
  v_mfma_f32_16x16x32_bf16 v[164:167], v[80:83], v[244:247], v[164:167]
  ds_read_b128 v[228:231], v14 offset:1024
  v_accvgpr_write_b32 a97, 0
  v_mfma_f32_16x16x32_bf16 v[180:183], v[84:87], v[244:247], v[180:183]
  buffer_load_dwordx4 v5, s[32:35], s26 offen offset:2048 sc1 lds
  v_accvgpr_write_b32 a98, 0
  v_mfma_f32_16x16x32_bf16 v[196:199], v[88:91], v[244:247], v[196:199]
  ds_read_b64_tr_b16 v[48:49], v12 offset:512
  v_accvgpr_write_b32 a99, 0
  v_mfma_f32_16x16x32_bf16 v[212:215], v[92:95], v[244:247], v[212:215]
  ds_read_b64_tr_b16 v[50:51], v12 offset:1536
  v_accvgpr_write_b32 a68, 0
  v_mfma_f32_16x16x32_bf16 v[104:107], v[64:67], v[248:251], v[104:107]
  ds_read_b64_tr_b16 v[52:53], v13 offset:512
  v_accvgpr_write_b32 a69, 0
  v_mfma_f32_16x16x32_bf16 v[120:123], v[68:71], v[248:251], v[120:123]
  ds_read_b64_tr_b16 v[54:55], v13 offset:1536
  v_accvgpr_write_b32 a70, 0
  v_mfma_f32_16x16x32_bf16 v[136:139], v[72:75], v[248:251], v[136:139]
  buffer_load_dwordx4 v6, s[32:35], s26 offen offset:3072 sc1 lds
  v_accvgpr_write_b32 a71, 0
  v_mfma_f32_16x16x32_bf16 v[152:155], v[76:79], v[248:251], v[152:155]
  s_add_u32 s26, s26, 1024
  ds_read_b64_tr_b16 v[56:57], v12 offset:768
  v_accvgpr_write_b32 a100, 0
  v_mfma_f32_16x16x32_bf16 v[168:171], v[80:83], v[248:251], v[168:171]
  ds_read_b64_tr_b16 v[58:59], v12 offset:1792
  v_accvgpr_write_b32 a101, 0
  v_mfma_f32_16x16x32_bf16 v[184:187], v[84:87], v[248:251], v[184:187]
  ds_read_b64_tr_b16 v[60:61], v13 offset:768
  v_accvgpr_write_b32 a102, 0
  v_mfma_f32_16x16x32_bf16 v[200:203], v[88:91], v[248:251], v[200:203]
  ds_read_b64_tr_b16 v[62:63], v13 offset:1792
  v_accvgpr_write_b32 a103, 0
  v_mfma_f32_16x16x32_bf16 v[216:219], v[92:95], v[248:251], v[216:219]
  v_accvgpr_write_b32 a72, 0
  v_accvgpr_write_b32 a73, 0
  v_mfma_f32_16x16x32_bf16 v[108:111], v[64:67], v[252:255], v[108:111]
  ds_read_b128 v[232:235], v14 offset:2048
  v_accvgpr_write_b32 a74, 0
  v_mfma_f32_16x16x32_bf16 v[124:127], v[68:71], v[252:255], v[124:127]
  ds_read_b128 v[236:239], v14 offset:3072
  v_accvgpr_write_b32 a75, 0
  v_mfma_f32_16x16x32_bf16 v[140:143], v[72:75], v[252:255], v[140:143]
  v_accvgpr_write_b32 a104, 0
  v_accvgpr_write_b32 a105, 0
  v_mfma_f32_16x16x32_bf16 v[156:159], v[76:79], v[252:255], v[156:159]
  v_accvgpr_write_b32 a106, 0
  v_accvgpr_write_b32 a107, 0
  v_mfma_f32_16x16x32_bf16 v[172:175], v[80:83], v[252:255], v[172:175]
  v_accvgpr_write_b32 a76, 0
  v_accvgpr_write_b32 a77, 0
  v_mfma_f32_16x16x32_bf16 v[188:191], v[84:87], v[252:255], v[188:191]
  v_accvgpr_write_b32 a78, 0
  v_accvgpr_write_b32 a79, 0
  v_mfma_f32_16x16x32_bf16 v[204:207], v[88:91], v[252:255], v[204:207]
  v_accvgpr_write_b32 a108, 0
  v_mfma_f32_16x16x32_bf16 v[220:223], v[92:95], v[252:255], v[220:223]
  s_waitcnt vmcnt(9) lgkmcnt(0)
  v_mfma_f32_16x16x32_bf16 v[96:99], v[32:35], v[224:227], v[96:99]
  s_and_b32 s62, s2, 1
  v_add_u32 v20, 0, v1
  v_mul_u32_u24 v19, 6554, v20
  v_mfma_f32_16x16x32_bf16 v[112:115], v[36:39], v[224:227], v[112:115]
  s_lshl_b32 s62, s62, 2
  ds_read_b64_tr_b16 v[64:65], v12 offset:8192
  v_lshrrev_b32 v19, 16, v19
  v_mfma_f32_16x16x32_bf16 v[128:131], v[40:43], v[224:227], v[128:131]
  s_add_u32 s62, s62, s20
  ds_read_b64_tr_b16 v[66:67], v12 offset:9216
  v_mul_u32_u24 v19, 1120, v19
  v_mfma_f32_16x16x32_bf16 v[144:147], v[44:47], v[224:227], v[144:147]
  s_lshr_b32 s63, s2, 1
  v_lshl_add_u32 v24, v20, 4, v19
  v_accvgpr_write_b32 a248, v24
  v_mfma_f32_16x16x32_bf16 v[160:163], v[48:51], v[224:227], v[160:163]
  s_mul_i32 s33, s63, 40960
  ds_read_b64_tr_b16 v[68:69], v13 offset:8192
  v_add_u32 v20, 64, v1
  v_mfma_f32_16x16x32_bf16 v[176:179], v[52:55], v[224:227], v[176:179]
  s_mul_i32 s31, s62, 160
  ds_read_b64_tr_b16 v[70:71], v13 offset:9216
  v_mul_u32_u24 v19, 6554, v20
  v_mfma_f32_16x16x32_bf16 v[192:195], v[56:59], v[224:227], v[192:195]
  s_add_u32 s33, s33, s31
  ds_read_b64_tr_b16 v[72:73], v12 offset:8448
  v_lshrrev_b32 v19, 16, v19
  v_mfma_f32_16x16x32_bf16 v[208:211], v[60:63], v[224:227], v[208:211]
  s_mul_i32 s34, s20, 5120
  ds_read_b64_tr_b16 v[74:75], v12 offset:9472
  v_mul_u32_u24 v19, 1120, v19
  v_mfma_f32_16x16x32_bf16 v[100:103], v[32:35], v[228:231], v[100:103]
  s_add_u32 s34, s34, 131072
  v_lshl_add_u32 v25, v20, 4, v19
  v_accvgpr_write_b32 a249, v25
  v_mfma_f32_16x16x32_bf16 v[116:119], v[36:39], v[228:231], v[116:119]
  s_lshl_b32 s30, s62, 7
  ds_read_b64_tr_b16 v[76:77], v13 offset:8448
  v_add_u32 v20, 128, v1
  v_mfma_f32_16x16x32_bf16 v[132:135], v[40:43], v[228:231], v[132:135]
  s_add_u32 s30, s30, s63
  ds_read_b64_tr_b16 v[78:79], v13 offset:9472
  v_mul_u32_u24 v19, 6554, v20
  v_mfma_f32_16x16x32_bf16 v[148:151], v[44:47], v[228:231], v[148:151]
  s_mul_i32 s30, s30, 5120
  ds_read_b128 v[240:243], v14 offset:32768
  v_lshrrev_b32 v19, 16, v19
  v_mfma_f32_16x16x32_bf16 v[164:167], v[48:51], v[228:231], v[164:167]
  s_add_u32 s30, s30, 4194304
  ds_read_b128 v[244:247], v14 offset:33792
  v_mul_u32_u24 v19, 1120, v19
  v_mfma_f32_16x16x32_bf16 v[180:183], v[52:55], v[228:231], v[180:183]
  v_lshl_add_u32 v26, v20, 4, v19
  v_accvgpr_write_b32 a250, v26
  v_mfma_f32_16x16x32_bf16 v[196:199], v[56:59], v[228:231], v[196:199]
  ds_read_b64_tr_b16 v[80:81], v12 offset:8704
  v_add_u32 v20, 192, v1
  v_mfma_f32_16x16x32_bf16 v[212:215], v[60:63], v[228:231], v[212:215]
  ds_read_b64_tr_b16 v[82:83], v12 offset:9728
  v_mul_u32_u24 v19, 6554, v20
  v_mfma_f32_16x16x32_bf16 v[104:107], v[32:35], v[232:235], v[104:107]
  ds_read_b64_tr_b16 v[84:85], v13 offset:8704
  v_lshrrev_b32 v19, 16, v19
  v_mfma_f32_16x16x32_bf16 v[120:123], v[36:39], v[232:235], v[120:123]
  ds_read_b64_tr_b16 v[86:87], v13 offset:9728
  v_mul_u32_u24 v19, 1120, v19
  v_mfma_f32_16x16x32_bf16 v[136:139], v[40:43], v[232:235], v[136:139]
  v_lshl_add_u32 v27, v20, 4, v19
  v_accvgpr_write_b32 a251, v27
  v_mfma_f32_16x16x32_bf16 v[152:155], v[44:47], v[232:235], v[152:155]
  ds_read_b64_tr_b16 v[88:89], v12 offset:8960
  v_add_u32 v20, 256, v1
  v_mfma_f32_16x16x32_bf16 v[168:171], v[48:51], v[232:235], v[168:171]
  ds_read_b64_tr_b16 v[90:91], v12 offset:9984
  v_mul_u32_u24 v19, 6554, v20
  v_mfma_f32_16x16x32_bf16 v[184:187], v[52:55], v[232:235], v[184:187]
  ds_read_b64_tr_b16 v[92:93], v13 offset:8960
  v_lshrrev_b32 v19, 16, v19
  v_mfma_f32_16x16x32_bf16 v[200:203], v[56:59], v[232:235], v[200:203]
  ds_read_b64_tr_b16 v[94:95], v13 offset:9984
  v_mul_u32_u24 v19, 1120, v19
  v_mfma_f32_16x16x32_bf16 v[216:219], v[60:63], v[232:235], v[216:219]
  v_lshl_add_u32 v28, v20, 4, v19
  v_accvgpr_write_b32 a252, v28
  v_mfma_f32_16x16x32_bf16 v[108:111], v[32:35], v[236:239], v[108:111]
  ds_read_b128 v[248:251], v14 offset:34816
  v_accvgpr_write_b32 a109, 0
  v_mfma_f32_16x16x32_bf16 v[124:127], v[36:39], v[236:239], v[124:127]
  ds_read_b128 v[252:255], v14 offset:35840
  v_accvgpr_write_b32 a110, 0
  v_mfma_f32_16x16x32_bf16 v[140:143], v[40:43], v[236:239], v[140:143]
  v_accvgpr_write_b32 a111, 0
  v_accvgpr_write_b32 a80, 0
  v_mfma_f32_16x16x32_bf16 v[156:159], v[44:47], v[236:239], v[156:159]
  v_xor_b32 v14, 0x10000, v14
  v_accvgpr_write_b32 a81, 0
  v_mfma_f32_16x16x32_bf16 v[172:175], v[48:51], v[236:239], v[172:175]
  v_accvgpr_write_b32 a82, 0
  v_accvgpr_write_b32 a83, 0
  v_mfma_f32_16x16x32_bf16 v[188:191], v[52:55], v[236:239], v[188:191]
  v_accvgpr_write_b32 a112, 0
  v_accvgpr_write_b32 a113, 0
  v_mfma_f32_16x16x32_bf16 v[204:207], v[56:59], v[236:239], v[204:207]
  v_accvgpr_write_b32 a114, 0
  v_mfma_f32_16x16x32_bf16 v[220:223], v[60:63], v[236:239], v[220:223]
  s_waitcnt vmcnt(5) lgkmcnt(0)
  v_mfma_f32_16x16x32_bf16 v[96:99], v[64:67], v[240:243], v[96:99]
  s_barrier
  v_lshrrev_b32 v6, 2, v1
  v_mul_u32_u24 v6, 160, v6
  v_mfma_f32_16x16x32_bf16 v[112:115], v[68:71], v[240:243], v[112:115]
  s_and_b32 s23, s20, 1
  ds_read_b64_tr_b16 v[32:33], v12 offset:32768
  v_and_b32 v19, 3, v1
  v_mfma_f32_16x16x32_bf16 v[128:131], v[72:75], v[240:243], v[128:131]
  s_lshl_b32 s23, s23, 12
  ds_read_b64_tr_b16 v[34:35], v12 offset:33792
  v_lshl_add_u32 v6, v19, 3, v6
  v_mfma_f32_16x16x32_bf16 v[144:147], v[76:79], v[240:243], v[144:147]
  s_cmp_lt_u32 s20, 2
  buffer_load_dword v15, v8, s[40:43], 0 offen sc1
  v_add_u32 v6, s34, v6
  v_mfma_f32_16x16x32_bf16 v[160:163], v[80:83], v[240:243], v[160:163]
  s_cselect_b32 s24, 106496, 0
  ds_read_b64_tr_b16 v[36:37], v13 offset:32768
  v_mov_b32 v3, v2
  v_mfma_f32_16x16x32_bf16 v[176:179], v[84:87], v[240:243], v[176:179]
  s_add_u32 s24, s24, s23
  ds_read_b64_tr_b16 v[38:39], v13 offset:33792
  v_mov_b32 v4, 0xff800000
  v_mfma_f32_16x16x32_bf16 v[192:195], v[88:91], v[240:243], v[192:195]
  s_lshl_b32 s26, s20, 12
  ds_read_b64_tr_b16 v[40:41], v12 offset:33024
  v_add_u32 v18, 106496, v2
  v_mfma_f32_16x16x32_bf16 v[208:211], v[92:95], v[240:243], v[208:211]
  s_mov_b32 s27, s26
  ds_read_b64_tr_b16 v[42:43], v12 offset:34048
  v_accvgpr_write_b32 a115, 0
  v_mfma_f32_16x16x32_bf16 v[100:103], v[64:67], v[244:247], v[100:103]
  s_add_u32 s25, s27, 49152
  v_accvgpr_write_b32 a84, 0
  v_accvgpr_write_b32 a85, 0
  v_mfma_f32_16x16x32_bf16 v[116:119], v[68:71], v[244:247], v[116:119]
  s_load_dwordx4 s[4:7], s[0:1], 64
  ds_read_b64_tr_b16 v[44:45], v13 offset:33024
  v_accvgpr_write_b32 a86, 0
  v_mfma_f32_16x16x32_bf16 v[132:135], v[72:75], v[244:247], v[132:135]
  s_load_dwordx2 s[8:9], s[0:1], 80
  ds_read_b64_tr_b16 v[46:47], v13 offset:34048
  v_accvgpr_write_b32 a87, 0
  v_mfma_f32_16x16x32_bf16 v[148:151], v[76:79], v[244:247], v[148:151]
  s_add_u32 s23, s20, 1
  ds_read_b128 v[224:227], v14 offset:0
  v_accvgpr_write_b32 a116, 0
  v_mfma_f32_16x16x32_bf16 v[164:167], v[80:83], v[244:247], v[164:167]
  s_lshr_b32 s23, s23, 1
  ds_read_b128 v[228:231], v14 offset:1024
  v_accvgpr_write_b32 a117, 0
  v_mfma_f32_16x16x32_bf16 v[180:183], v[84:87], v[244:247], v[180:183]
  s_lshl_b32 s28, s22, 1
  v_accvgpr_write_b32 a118, 0
  v_accvgpr_write_b32 a119, 0
  v_mfma_f32_16x16x32_bf16 v[196:199], v[88:91], v[244:247], v[196:199]
  s_add_u32 s28, s28, s23
  ds_read_b64_tr_b16 v[48:49], v12 offset:33280
  v_accvgpr_write_b32 a88, 0
  v_mfma_f32_16x16x32_bf16 v[212:215], v[92:95], v[244:247], v[212:215]
  s_lshl_b32 s23, s22, 2
  ds_read_b64_tr_b16 v[50:51], v12 offset:34304
  v_accvgpr_write_b32 a89, 0
  v_mfma_f32_16x16x32_bf16 v[104:107], v[64:67], v[248:251], v[104:107]
  s_sub_u32 s29, 28, s23
  ds_read_b64_tr_b16 v[52:53], v13 offset:33280
  v_accvgpr_write_b32 a90, 0
  v_mfma_f32_16x16x32_bf16 v[120:123], v[68:71], v[248:251], v[120:123]
  s_and_b32 s23, s20, 1
  ds_read_b64_tr_b16 v[54:55], v13 offset:34304
  v_accvgpr_write_b32 a91, 0
  v_mfma_f32_16x16x32_bf16 v[136:139], v[72:75], v[248:251], v[136:139]
  s_add_u32 s29, s29, s23
  v_accvgpr_write_b32 a120, 0
  v_accvgpr_write_b32 a121, 0
  v_mfma_f32_16x16x32_bf16 v[152:155], v[76:79], v[248:251], v[152:155]
  ds_read_b64_tr_b16 v[56:57], v12 offset:33536
  v_accvgpr_write_b32 a122, 0
  v_mfma_f32_16x16x32_bf16 v[168:171], v[80:83], v[248:251], v[168:171]
  ds_read_b64_tr_b16 v[58:59], v12 offset:34560
  v_accvgpr_write_b32 a123, 0
  v_mfma_f32_16x16x32_bf16 v[184:187], v[84:87], v[248:251], v[184:187]
  ds_read_b64_tr_b16 v[60:61], v13 offset:33536
  v_accvgpr_write_b32 a92, 0
  v_mfma_f32_16x16x32_bf16 v[200:203], v[88:91], v[248:251], v[200:203]
  ds_read_b64_tr_b16 v[62:63], v13 offset:34560
  v_accvgpr_write_b32 a93, 0
  v_mfma_f32_16x16x32_bf16 v[216:219], v[92:95], v[248:251], v[216:219]
  v_accvgpr_write_b32 a94, 0
  v_accvgpr_write_b32 a95, 0
  v_mfma_f32_16x16x32_bf16 v[108:111], v[64:67], v[252:255], v[108:111]
  ds_read_b128 v[232:235], v14 offset:2048
  v_accvgpr_write_b32 a124, 0
  v_mfma_f32_16x16x32_bf16 v[124:127], v[68:71], v[252:255], v[124:127]
  ds_read_b128 v[236:239], v14 offset:3072
  v_accvgpr_write_b32 a125, 0
  v_mfma_f32_16x16x32_bf16 v[140:143], v[72:75], v[252:255], v[140:143]
  v_accvgpr_write_b32 a126, 0
  v_accvgpr_write_b32 a127, 0
  v_mfma_f32_16x16x32_bf16 v[156:159], v[76:79], v[252:255], v[156:159]
  v_mfma_f32_16x16x32_bf16 v[172:175], v[80:83], v[252:255], v[172:175]
  v_mfma_f32_16x16x32_bf16 v[188:191], v[84:87], v[252:255], v[188:191]
  v_mfma_f32_16x16x32_bf16 v[204:207], v[88:91], v[252:255], v[204:207]
  v_mfma_f32_16x16x32_bf16 v[220:223], v[92:95], v[252:255], v[220:223]
  s_waitcnt vmcnt(1) lgkmcnt(0)
  v_mfma_f32_16x16x32_bf16 v[96:99], v[32:35], v[224:227], v[96:99]
  s_cmp_ge_u32 s20, 2
  v_mfma_f32_16x16x32_bf16 v[112:115], v[36:39], v[224:227], v[112:115]
  s_cselect_b32 s4, s6, s4
  ds_read_b64_tr_b16 v[64:65], v12 offset:40960
  v_mfma_f32_16x16x32_bf16 v[128:131], v[40:43], v[224:227], v[128:131]
  s_cselect_b32 s5, s7, s5
  ds_read_b64_tr_b16 v[66:67], v12 offset:41984
  v_mfma_f32_16x16x32_bf16 v[144:147], v[44:47], v[224:227], v[144:147]
  s_mov_b32 s60, s8
  v_mfma_f32_16x16x32_bf16 v[160:163], v[48:51], v[224:227], v[160:163]
  s_mov_b32 s61, s9
  ds_read_b64_tr_b16 v[68:69], v13 offset:40960
  v_mfma_f32_16x16x32_bf16 v[176:179], v[52:55], v[224:227], v[176:179]
  s_mov_b32 s62, 2211840
  ds_read_b64_tr_b16 v[70:71], v13 offset:41984
  v_mfma_f32_16x16x32_bf16 v[192:195], v[56:59], v[224:227], v[192:195]
  s_mov_b32 s63, 0x20000
  ds_read_b64_tr_b16 v[72:73], v12 offset:41216
  v_mfma_f32_16x16x32_bf16 v[208:211], v[60:63], v[224:227], v[208:211]
  s_mov_b64 s[56:57], s[52:53]
  ds_read_b64_tr_b16 v[74:75], v12 offset:42240
  v_mfma_f32_16x16x32_bf16 v[100:103], v[32:35], v[228:231], v[100:103]
  s_mov_b32 s58, s54
  v_mfma_f32_16x16x32_bf16 v[116:119], v[36:39], v[228:231], v[116:119]
  s_mov_b64 s[52:53], s[4:5]
  ds_read_b64_tr_b16 v[76:77], v13 offset:41216
  v_mfma_f32_16x16x32_bf16 v[132:135], v[40:43], v[228:231], v[132:135]
  s_mov_b32 s54, 2211840
  ds_read_b64_tr_b16 v[78:79], v13 offset:42240
  v_mfma_f32_16x16x32_bf16 v[148:151], v[44:47], v[228:231], v[148:151]
  s_and_b32 s32, s21, 3
  ds_read_b128 v[240:243], v14 offset:32768
  v_mfma_f32_16x16x32_bf16 v[164:167], v[48:51], v[228:231], v[164:167]
  s_add_u32 s32, s32, 6
  ds_read_b128 v[244:247], v14 offset:33792
  v_mfma_f32_16x16x32_bf16 v[180:183], v[52:55], v[228:231], v[180:183]
  s_lshl_b32 s32, s32, 14
  v_mfma_f32_16x16x32_bf16 v[196:199], v[56:59], v[228:231], v[196:199]
  s_cmp_lt_u32 s2, 64
  ds_read_b64_tr_b16 v[80:81], v12 offset:41472
  v_mfma_f32_16x16x32_bf16 v[212:215], v[60:63], v[228:231], v[212:215]
  s_cselect_b32 s32, s32, 0
  ds_read_b64_tr_b16 v[82:83], v12 offset:42496
  v_mfma_f32_16x16x32_bf16 v[104:107], v[32:35], v[232:235], v[104:107]
  s_cselect_b32 s9, -1, 0
  ds_read_b64_tr_b16 v[84:85], v13 offset:41472
  v_mfma_f32_16x16x32_bf16 v[120:123], v[36:39], v[232:235], v[120:123]
  s_mov_b32 s8, 0
  ds_read_b64_tr_b16 v[86:87], v13 offset:42496
  v_mfma_f32_16x16x32_bf16 v[136:139], v[40:43], v[232:235], v[136:139]
  s_mov_b32 s11, 0
  v_mfma_f32_16x16x32_bf16 v[152:155], v[44:47], v[232:235], v[152:155]
  s_mov_b32 s12, 0
  ds_read_b64_tr_b16 v[88:89], v12 offset:41728
  v_mfma_f32_16x16x32_bf16 v[168:171], v[48:51], v[232:235], v[168:171]
  s_lshl_b32 s15, s22, 1
  ds_read_b64_tr_b16 v[90:91], v12 offset:42752
  v_mfma_f32_16x16x32_bf16 v[184:187], v[52:55], v[232:235], v[184:187]
  s_add_u32 s23, s15, 6
  ds_read_b64_tr_b16 v[92:93], v13 offset:41728
  v_mfma_f32_16x16x32_bf16 v[200:203], v[56:59], v[232:235], v[200:203]
  s_sub_u32 s15, 24, s15
  ds_read_b64_tr_b16 v[94:95], v13 offset:42752
  v_mfma_f32_16x16x32_bf16 v[216:219], v[60:63], v[232:235], v[216:219]
  s_max_u32 s15, s15, s23
  v_mfma_f32_16x16x32_bf16 v[108:111], v[32:35], v[236:239], v[108:111]
  s_lshl_b32 s15, s15, 14
  ds_read_b128 v[248:251], v14 offset:34816
  v_mfma_f32_16x16x32_bf16 v[124:127], v[36:39], v[236:239], v[124:127]
  s_getpc_b64 s[36:37]
fa_copc:
  ds_read_b128 v[252:255], v14 offset:35840
  v_mfma_f32_16x16x32_bf16 v[140:143], v[40:43], v[236:239], v[140:143]
  s_add_u32 s36, s36, fa_co-fa_copc-4
  v_mfma_f32_16x16x32_bf16 v[156:159], v[44:47], v[236:239], v[156:159]
  s_addc_u32 s37, s37, 0
  v_xor_b32 v14, 0x10000, v14
  v_mfma_f32_16x16x32_bf16 v[172:175], v[48:51], v[236:239], v[172:175]
  v_mfma_f32_16x16x32_bf16 v[188:191], v[52:55], v[236:239], v[188:191]
  v_xor_b32 v12, 0x10000, v12
  v_mfma_f32_16x16x32_bf16 v[204:207], v[56:59], v[236:239], v[204:207]
  v_xor_b32 v13, 0x10000, v13
  v_mfma_f32_16x16x32_bf16 v[220:223], v[60:63], v[236:239], v[220:223]
  s_waitcnt vmcnt(0) lgkmcnt(0)
  v_mfma_f32_16x16x32_bf16 v[96:99], v[64:67], v[240:243], v[96:99]
  s_barrier
  v_cmp_eq_u32 vcc, 0, v15
  v_mfma_f32_16x16x32_bf16 v[112:115], v[68:71], v[240:243], v[112:115]
  s_cbranch_vccnz fa_kv_spin
fa_kv_ok:
  v_mfma_f32_16x16x32_bf16 v[128:131], v[72:75], v[240:243], v[128:131]
  s_mov_b32 m0, s24
  v_mfma_f32_16x16x32_bf16 v[144:147], v[76:79], v[240:243], v[144:147]
  buffer_load_dwordx4 v2, s[44:47], s26 offen offset:0 sc1 lds
  v_mfma_f32_16x16x32_bf16 v[160:163], v[80:83], v[240:243], v[160:163]
  s_add_u32 s24, s24, 32768
  v_mfma_f32_16x16x32_bf16 v[176:179], v[84:87], v[240:243], v[176:179]
  s_and_b32 s24, s24, 0x1ffff
  buffer_load_dwordx4 v2, s[44:47], s26 offen offset:1024 sc1 lds
  v_mfma_f32_16x16x32_bf16 v[192:195], v[88:91], v[240:243], v[192:195]
  v_mfma_f32_16x16x32_bf16 v[208:211], v[92:95], v[240:243], v[208:211]
  buffer_load_dwordx4 v2, s[44:47], s26 offen offset:2048 sc1 lds
  v_mfma_f32_16x16x32_bf16 v[100:103], v[64:67], v[244:247], v[100:103]
  v_mfma_f32_16x16x32_bf16 v[116:119], v[68:71], v[244:247], v[116:119]
  buffer_load_dwordx4 v2, s[44:47], s26 offen offset:3072 sc1 lds
  v_mfma_f32_16x16x32_bf16 v[132:135], v[72:75], v[244:247], v[132:135]
  s_add_u32 s26, s26, 16384
  v_cvt_pk_bf16_f32 v32, v96, v97
  v_cvt_pk_bf16_f32 v33, v98, v99
  v_mfma_f32_16x16x32_bf16 v[148:151], v[76:79], v[244:247], v[148:151]
  v_cvt_pk_bf16_f32 v34, v112, v113
  v_cvt_pk_bf16_f32 v35, v114, v115
  v_mfma_f32_16x16x32_bf16 v[164:167], v[80:83], v[244:247], v[164:167]
  s_mov_b32 m0, s24
  v_cvt_pk_bf16_f32 v40, v128, v129
  v_mfma_f32_16x16x32_bf16 v[180:183], v[84:87], v[244:247], v[180:183]
  buffer_load_dwordx4 v2, s[44:47], s26 offen offset:0 sc1 lds
  v_cvt_pk_bf16_f32 v41, v130, v131
  v_cvt_pk_bf16_f32 v42, v144, v145
  v_mfma_f32_16x16x32_bf16 v[196:199], v[88:91], v[244:247], v[196:199]
  s_add_u32 s24, s24, 32768
  v_cvt_pk_bf16_f32 v43, v146, v147
  v_mfma_f32_16x16x32_bf16 v[212:215], v[92:95], v[244:247], v[212:215]
  s_and_b32 s24, s24, 0x1ffff
  buffer_load_dwordx4 v2, s[44:47], s26 offen offset:1024 sc1 lds
  v_cvt_pk_bf16_f32 v48, v160, v161
  v_cvt_pk_bf16_f32 v49, v162, v163
  v_mfma_f32_16x16x32_bf16 v[104:107], v[64:67], v[248:251], v[104:107]
  v_cvt_pk_bf16_f32 v50, v176, v177
  v_cvt_pk_bf16_f32 v51, v178, v179
  v_mfma_f32_16x16x32_bf16 v[120:123], v[68:71], v[248:251], v[120:123]
  buffer_load_dwordx4 v2, s[44:47], s26 offen offset:2048 sc1 lds
  v_cvt_pk_bf16_f32 v56, v192, v193
  v_mfma_f32_16x16x32_bf16 v[136:139], v[72:75], v[248:251], v[136:139]
  v_cvt_pk_bf16_f32 v57, v194, v195
  v_cvt_pk_bf16_f32 v58, v208, v209
  v_mfma_f32_16x16x32_bf16 v[152:155], v[76:79], v[248:251], v[152:155]
  buffer_load_dwordx4 v2, s[44:47], s26 offen offset:3072 sc1 lds
  v_cvt_pk_bf16_f32 v59, v210, v211
  v_mfma_f32_16x16x32_bf16 v[168:171], v[80:83], v[248:251], v[168:171]
  s_add_u32 s26, s26, 16384
  v_cvt_pk_bf16_f32 v36, v100, v101
  v_cvt_pk_bf16_f32 v37, v102, v103
  v_mfma_f32_16x16x32_bf16 v[184:187], v[84:87], v[248:251], v[184:187]
  v_cvt_pk_bf16_f32 v38, v116, v117
  v_mfma_f32_16x16x32_bf16 v[200:203], v[88:91], v[248:251], v[200:203]
  s_mov_b32 m0, s24
  v_cvt_pk_bf16_f32 v39, v118, v119
  v_cvt_pk_bf16_f32 v44, v132, v133
  v_mfma_f32_16x16x32_bf16 v[216:219], v[92:95], v[248:251], v[216:219]
  buffer_load_dwordx4 v2, s[44:47], s26 offen offset:0 sc1 lds
  v_cvt_pk_bf16_f32 v45, v134, v135
  v_mfma_f32_16x16x32_bf16 v[108:111], v[64:67], v[252:255], v[108:111]
  s_add_u32 s24, s24, 32768
  v_cvt_pk_bf16_f32 v46, v148, v149
  v_cvt_pk_bf16_f32 v47, v150, v151
  v_mfma_f32_16x16x32_bf16 v[124:127], v[68:71], v[252:255], v[124:127]
  s_and_b32 s24, s24, 0x1ffff
  buffer_load_dwordx4 v2, s[44:47], s26 offen offset:1024 sc1 lds
  v_cvt_pk_bf16_f32 v52, v164, v165
  v_mfma_f32_16x16x32_bf16 v[140:143], v[72:75], v[252:255], v[140:143]
  v_cvt_pk_bf16_f32 v53, v166, v167
  v_cvt_pk_bf16_f32 v54, v180, v181
  v_mfma_f32_16x16x32_bf16 v[156:159], v[76:79], v[252:255], v[156:159]
  buffer_load_dwordx4 v2, s[44:47], s26 offen offset:2048 sc1 lds
  v_cvt_pk_bf16_f32 v55, v182, v183
  v_mfma_f32_16x16x32_bf16 v[172:175], v[80:83], v[252:255], v[172:175]
  v_cvt_pk_bf16_f32 v60, v196, v197
  v_cvt_pk_bf16_f32 v61, v198, v199
  v_mfma_f32_16x16x32_bf16 v[188:191], v[84:87], v[252:255], v[188:191]
  buffer_load_dwordx4 v2, s[44:47], s26 offen offset:3072 sc1 lds
  v_cvt_pk_bf16_f32 v62, v212, v213
  v_mfma_f32_16x16x32_bf16 v[204:207], v[88:91], v[252:255], v[204:207]
  s_add_u32 s26, s26, 16384
  v_cvt_pk_bf16_f32 v63, v214, v215
  v_mfma_f32_16x16x32_bf16 v[220:223], v[92:95], v[252:255], v[220:223]
  s_mov_b32 m0, s25
  s_nop 0
  buffer_load_dwordx4 v2, s[48:51], s27 offen offset:0 sc1 lds
  v_cvt_pk_bf16_f32 v64, v104, v105
  v_cvt_pk_bf16_f32 v65, v106, v107
  v_cvt_pk_bf16_f32 v66, v120, v121
  v_cvt_pk_bf16_f32 v67, v122, v123
  v_cvt_pk_bf16_f32 v72, v136, v137
  buffer_load_dwordx4 v2, s[48:51], s27 offen offset:1024 sc1 lds
  v_cvt_pk_bf16_f32 v73, v138, v139
  v_cvt_pk_bf16_f32 v74, v152, v153
  v_cvt_pk_bf16_f32 v75, v154, v155
  v_cvt_pk_bf16_f32 v80, v168, v169
  v_cvt_pk_bf16_f32 v81, v170, v171
  buffer_load_dwordx4 v2, s[48:51], s27 offen offset:2048 sc1 lds
  v_cvt_pk_bf16_f32 v82, v184, v185
  v_cvt_pk_bf16_f32 v83, v186, v187
  v_cvt_pk_bf16_f32 v88, v200, v201
  v_cvt_pk_bf16_f32 v89, v202, v203
  v_cvt_pk_bf16_f32 v90, v216, v217
  buffer_load_dwordx4 v2, s[48:51], s27 offen offset:3072 sc1 lds
  v_cvt_pk_bf16_f32 v91, v218, v219
  v_cvt_pk_bf16_f32 v68, v108, v109
  v_cvt_pk_bf16_f32 v69, v110, v111
  v_cvt_pk_bf16_f32 v70, v124, v125
  v_cvt_pk_bf16_f32 v71, v126, v127
  s_add_u32 s27, s27, 16384
  s_add_u32 s25, s25, 32768
  s_and_b32 s25, s25, 0x1ffff
  s_mov_b32 m0, s25
  s_nop 0
  buffer_load_dwordx4 v2, s[48:51], s27 offen offset:0 sc1 lds
  v_cvt_pk_bf16_f32 v76, v140, v141
  v_cvt_pk_bf16_f32 v77, v142, v143
  v_cvt_pk_bf16_f32 v78, v156, v157
  v_cvt_pk_bf16_f32 v79, v158, v159
  v_cvt_pk_bf16_f32 v84, v172, v173
  buffer_load_dwordx4 v2, s[48:51], s27 offen offset:1024 sc1 lds
  v_cvt_pk_bf16_f32 v85, v174, v175
  v_cvt_pk_bf16_f32 v86, v188, v189
  v_cvt_pk_bf16_f32 v87, v190, v191
  v_cvt_pk_bf16_f32 v92, v204, v205
  v_cvt_pk_bf16_f32 v93, v206, v207
  buffer_load_dwordx4 v2, s[48:51], s27 offen offset:2048 sc1 lds
  v_cvt_pk_bf16_f32 v94, v220, v221
  v_cvt_pk_bf16_f32 v95, v222, v223
  v_mov_b32 v228, 0
  v_mov_b32 v229, 0
  v_mov_b32 v230, 0
  buffer_load_dwordx4 v2, s[48:51], s27 offen offset:3072 sc1 lds
  v_mov_b32 v231, 0
  s_add_u32 s27, s27, 16384
  s_add_u32 s25, s25, 32768
  s_and_b32 s25, s25, 0x1ffff
  s_waitcnt vmcnt(12)
  s_barrier
  ds_read_b128 a[128:131], v18 offset:0
  ds_read_b128 a[132:135], v18 offset:1024
  ds_read_b128 a[136:139], v18 offset:2048
  ds_read_b128 a[140:143], v18 offset:3072
  ds_read_b128 a[144:147], v18 offset:4096
  ds_read_b128 a[148:151], v18 offset:5120
  ds_read_b128 a[152:155], v18 offset:6144
  ds_read_b128 a[156:159], v18 offset:7168
  s_sub_u32 s23, s2, 170
  s_cmp_lt_u32 s23, 54
  s_cbranch_scc1 fa_wo0
fa_wo0b:
  s_cmp_eq_u32 s2, 255
  s_cbranch_scc1 fa_top8
fa_notop:
  s_waitcnt lgkmcnt(4)
  v_mfma_f32_16x16x32_bf16 v[96:99], a[128:131], v[32:35], 0
  v_mfma_f32_16x16x32_bf16 v[104:107], a[128:131], v[36:39], 0
  v_mfma_f32_16x16x32_bf16 v[128:131], a[128:131], v[64:67], 0
  v_mfma_f32_16x16x32_bf16 v[136:139], a[128:131], v[68:71], 0
  s_mov_b32 m0, s24
  ds_read_b128 a[128:131], v3 offset:0
  v_mfma_f32_16x16x32_bf16 v[100:103], a[132:135], v[32:35], 0
  buffer_load_dwordx4 v2, s[44:47], s26 offen offset:0 sc1 lds
  v_mfma_f32_16x16x32_bf16 v[108:111], a[132:135], v[36:39], 0
  v_mfma_f32_16x16x32_bf16 v[132:135], a[132:135], v[64:67], 0
  v_mfma_f32_16x16x32_bf16 v[140:143], a[132:135], v[68:71], 0
  ds_read_b128 a[132:135], v3 offset:1024
  v_mfma_f32_16x16x32_bf16 v[96:99], a[136:139], v[40:43], v[96:99]
  v_mfma_f32_16x16x32_bf16 v[104:107], a[136:139], v[44:47], v[104:107]
  v_mfma_f32_16x16x32_bf16 v[128:131], a[136:139], v[72:75], v[128:131]
  buffer_load_dwordx4 v2, s[44:47], s26 offen offset:1024 sc1 lds
  v_mfma_f32_16x16x32_bf16 v[136:139], a[136:139], v[76:79], v[136:139]
  ds_read_b128 a[136:139], v3 offset:2048
  v_mfma_f32_16x16x32_bf16 v[100:103], a[140:143], v[40:43], v[100:103]
  v_mfma_f32_16x16x32_bf16 v[108:111], a[140:143], v[44:47], v[108:111]
  v_mfma_f32_16x16x32_bf16 v[132:135], a[140:143], v[72:75], v[132:135]
  v_mfma_f32_16x16x32_bf16 v[140:143], a[140:143], v[76:79], v[140:143]
  s_waitcnt lgkmcnt(3)
  ds_read_b128 a[140:143], v3 offset:3072
  v_mfma_f32_16x16x32_bf16 v[96:99], a[144:147], v[48:51], v[96:99]
  v_mfma_f32_16x16x32_bf16 v[104:107], a[144:147], v[52:55], v[104:107]
  v_mfma_f32_16x16x32_bf16 v[128:131], a[144:147], v[80:83], v[128:131]
  buffer_load_dwordx4 v2, s[44:47], s26 offen offset:2048 sc1 lds
  v_mfma_f32_16x16x32_bf16 v[136:139], a[144:147], v[84:87], v[136:139]
  ds_read_b128 a[144:147], v3 offset:4096
  v_mfma_f32_16x16x32_bf16 v[100:103], a[148:151], v[48:51], v[100:103]
  v_mfma_f32_16x16x32_bf16 v[108:111], a[148:151], v[52:55], v[108:111]
  v_mfma_f32_16x16x32_bf16 v[132:135], a[148:151], v[80:83], v[132:135]
  v_mfma_f32_16x16x32_bf16 v[140:143], a[148:151], v[84:87], v[140:143]
  ds_read_b128 a[148:151], v3 offset:5120
  v_mfma_f32_16x16x32_bf16 v[96:99], a[152:155], v[56:59], v[96:99]
  buffer_load_dwordx4 v2, s[44:47], s26 offen offset:3072 sc1 lds
  v_mfma_f32_16x16x32_bf16 v[104:107], a[152:155], v[60:63], v[104:107]
  s_add_u32 s26, s26, 16384
  v_mfma_f32_16x16x32_bf16 v[128:131], a[152:155], v[88:91], v[128:131]
  s_add_u32 s24, s24, 32768
  v_mfma_f32_16x16x32_bf16 v[136:139], a[152:155], v[92:95], v[136:139]
  s_and_b32 s24, s24, 0x1ffff
  ds_read_b128 a[152:155], v3 offset:6144
  v_mfma_f32_16x16x32_bf16 v[100:103], a[156:159], v[56:59], v[100:103]
  v_mfma_f32_16x16x32_bf16 v[108:111], a[156:159], v[60:63], v[108:111]
  v_mfma_f32_16x16x32_bf16 v[132:135], a[156:159], v[88:91], v[132:135]
  v_mfma_f32_16x16x32_bf16 v[140:143], a[156:159], v[92:95], v[140:143]
  s_waitcnt lgkmcnt(3)
  ds_read_b128 a[156:159], v3 offset:7168
  s_nop 7
  s_cmp_lg_u32 s28, 0
  s_cbranch_scc1 fa_nomask0
  v_cndmask_b32 v96, v4, v96, s[68:69]
  v_cndmask_b32 v97, v4, v97, s[70:71]
  v_cndmask_b32 v98, v4, v98, s[72:73]
  v_cndmask_b32 v99, v4, v99, s[74:75]
  v_mov_b32 v100, v4
  v_mov_b32 v101, v4
  v_mov_b32 v102, v4
  v_mov_b32 v103, v4
  v_cndmask_b32 v108, v4, v108, s[68:69]
  v_cndmask_b32 v109, v4, v109, s[70:71]
  v_cndmask_b32 v110, v4, v110, s[72:73]
  v_cndmask_b32 v111, v4, v111, s[74:75]
fa_nomask0:
  v_max3_f32 v16, v96, v97, v98
  v_max3_f32 v16, v16, v99, v100
  v_max3_f32 v16, v16, v101, v102
  v_max_f32 v16, v16, v103
  v_max3_f32 v17, v104, v105, v106
  v_max3_f32 v17, v17, v107, v108
  v_max3_f32 v17, v17, v109, v110
  v_max_f32 v17, v17, v111
  v_max3_f32 v18, v128, v129, v130
  v_max3_f32 v18, v18, v131, v132
  v_max3_f32 v18, v18, v133, v134
  v_max_f32 v18, v18, v135
  v_max3_f32 v19, v136, v137, v138
  v_max3_f32 v19, v19, v139, v140
  v_max3_f32 v19, v19, v141, v142
  v_max_f32 v19, v19, v143
  v_mov_b32 v20, v16
  v_mov_b32 v21, v17
  v_mov_b32 v22, v18
  v_mov_b32 v23, v19
  s_nop 0
  v_permlane16_swap_b32 v16, v20
  v_permlane16_swap_b32 v17, v21
  v_permlane16_swap_b32 v18, v22
  v_permlane16_swap_b32 v19, v23
  v_max_f32 v16, v16, v20
  v_max_f32 v17, v17, v21
  v_max_f32 v18, v18, v22
  v_max_f32 v19, v19, v23
  v_mov_b32 v20, v16
  v_mov_b32 v21, v17
  v_mov_b32 v22, v18
  v_mov_b32 v23, v19
  s_nop 0
  v_permlane32_swap_b32 v16, v20
  v_permlane32_swap_b32 v17, v21
  v_permlane32_swap_b32 v18, v22
  v_permlane32_swap_b32 v19, v23
  v_max_f32 v16, v16, v20
  v_max_f32 v17, v17, v21
  v_max_f32 v18, v18, v22
  v_max_f32 v19, v19, v23
  v_sub_f32 v192, 0, v16
  v_sub_f32 v193, 0, v16
  v_sub_f32 v194, 0, v16
  v_sub_f32 v195, 0, v16
  v_sub_f32 v196, 0, v17
  v_sub_f32 v197, 0, v17
  v_sub_f32 v198, 0, v17
  v_sub_f32 v199, 0, v17
  v_sub_f32 v200, 0, v18
  v_sub_f32 v201, 0, v18
  v_sub_f32 v202, 0, v18
  v_sub_f32 v203, 0, v18
  v_sub_f32 v204, 0, v19
  v_sub_f32 v205, 0, v19
  v_sub_f32 v206, 0, v19
  v_sub_f32 v207, 0, v19
  v_sub_f32 v96, v96, v16
  v_sub_f32 v97, v97, v16
  v_sub_f32 v98, v98, v16
  v_sub_f32 v99, v99, v16
  v_sub_f32 v100, v100, v16
  v_sub_f32 v101, v101, v16
  v_sub_f32 v102, v102, v16
  v_sub_f32 v103, v103, v16
  v_sub_f32 v104, v104, v17
  v_sub_f32 v105, v105, v17
  v_sub_f32 v106, v106, v17
  v_sub_f32 v107, v107, v17
  v_sub_f32 v108, v108, v17
  v_sub_f32 v109, v109, v17
  v_sub_f32 v110, v110, v17
  v_sub_f32 v111, v111, v17
  v_sub_f32 v128, v128, v18
  v_sub_f32 v129, v129, v18
  v_sub_f32 v130, v130, v18
  v_sub_f32 v131, v131, v18
  v_sub_f32 v132, v132, v18
  v_sub_f32 v133, v133, v18
  v_sub_f32 v134, v134, v18
  v_sub_f32 v135, v135, v18
  v_sub_f32 v136, v136, v19
  v_sub_f32 v137, v137, v19
  v_sub_f32 v138, v138, v19
  v_sub_f32 v139, v139, v19
  v_sub_f32 v140, v140, v19
  v_sub_f32 v141, v141, v19
  v_sub_f32 v142, v142, v19
  v_sub_f32 v143, v143, v19
  v_mfma_f32_16x16x32_bf16 v[112:115], a[128:131], v[32:35], v[192:195]
  v_exp_f32 v208, v96
  v_exp_f32 v209, v97
  v_mfma_f32_16x16x32_bf16 v[120:123], a[128:131], v[36:39], v[196:199]
  v_exp_f32 v210, v98
  v_exp_f32 v211, v99
  v_mfma_f32_16x16x32_bf16 v[144:147], a[128:131], v[64:67], v[200:203]
  v_exp_f32 v212, v100
  v_exp_f32 v213, v101
  v_mfma_f32_16x16x32_bf16 v[152:155], a[128:131], v[68:71], v[204:207]
  s_mov_b32 m0, s25
  ds_read_b128 a[128:131], v3 offset:8192
  v_exp_f32 v214, v102
  v_add_f32 v224, v208, v209
  v_mfma_f32_16x16x32_bf16 v[116:119], a[132:135], v[32:35], v[192:195]
  buffer_load_dwordx4 v2, s[48:51], s27 offen offset:0 sc1 lds
  v_exp_f32 v215, v103
  v_cvt_pk_bf16_f32 v160, v208, v209
  v_mfma_f32_16x16x32_bf16 v[124:127], a[132:135], v[36:39], v[196:199]
  v_exp_f32 v208, v104
  v_add_f32 v224, v224, v210
  v_add_f32 v224, v224, v211
  v_mfma_f32_16x16x32_bf16 v[148:151], a[132:135], v[64:67], v[200:203]
  v_exp_f32 v209, v105
  v_cvt_pk_bf16_f32 v161, v210, v211
  v_add_f32 v224, v224, v212
  v_mfma_f32_16x16x32_bf16 v[156:159], a[132:135], v[68:71], v[204:207]
  ds_read_b128 a[132:135], v3 offset:9216
  v_exp_f32 v210, v106
  v_mfma_f32_16x16x32_bf16 v[112:115], a[136:139], v[40:43], v[112:115]
  v_exp_f32 v211, v107
  v_add_f32 v224, v224, v213
  v_cvt_pk_bf16_f32 v162, v212, v213
  v_mfma_f32_16x16x32_bf16 v[120:123], a[136:139], v[44:47], v[120:123]
  v_exp_f32 v212, v108
  v_add_f32 v224, v224, v214
  v_add_f32 v224, v224, v215
  v_mfma_f32_16x16x32_bf16 v[144:147], a[136:139], v[72:75], v[144:147]
  buffer_load_dwordx4 v2, s[48:51], s27 offen offset:1024 sc1 lds
  v_exp_f32 v213, v109
  v_cvt_pk_bf16_f32 v163, v214, v215
  v_mfma_f32_16x16x32_bf16 v[152:155], a[136:139], v[76:79], v[152:155]
  ds_read_b128 a[136:139], v3 offset:10240
  v_exp_f32 v214, v110
  v_add_f32 v225, v208, v209
  v_mfma_f32_16x16x32_bf16 v[116:119], a[140:143], v[40:43], v[116:119]
  v_exp_f32 v215, v111
  v_exp_f32 v216, v128
  v_mfma_f32_16x16x32_bf16 v[124:127], a[140:143], v[44:47], v[124:127]
  v_exp_f32 v217, v129
  v_exp_f32 v218, v130
  v_mfma_f32_16x16x32_bf16 v[148:151], a[140:143], v[72:75], v[148:151]
  v_exp_f32 v219, v131
  v_exp_f32 v220, v132
  v_mfma_f32_16x16x32_bf16 v[156:159], a[140:143], v[76:79], v[156:159]
  s_waitcnt lgkmcnt(3)
  ds_read_b128 a[140:143], v3 offset:11264
  v_exp_f32 v221, v133
  v_cvt_pk_bf16_f32 v164, v208, v209
  v_mfma_f32_16x16x32_bf16 v[112:115], a[144:147], v[48:51], v[112:115]
  v_exp_f32 v222, v134
  v_exp_f32 v223, v135
  v_mfma_f32_16x16x32_bf16 v[120:123], a[144:147], v[52:55], v[120:123]
  v_add_f32 v225, v225, v210
  v_add_f32 v225, v225, v211
  v_cvt_pk_bf16_f32 v165, v210, v211
  v_add_f32 v225, v225, v212
  v_mfma_f32_16x16x32_bf16 v[144:147], a[144:147], v[80:83], v[144:147]
  buffer_load_dwordx4 v2, s[48:51], s27 offen offset:2048 sc1 lds
  v_add_f32 v225, v225, v213
  v_cvt_pk_bf16_f32 v166, v212, v213
  v_add_f32 v225, v225, v214
  v_mfma_f32_16x16x32_bf16 v[152:155], a[144:147], v[84:87], v[152:155]
  ds_read_b128 a[144:147], v3 offset:12288
  v_add_f32 v225, v225, v215
  v_cvt_pk_bf16_f32 v167, v214, v215
  v_add_f32 v226, v216, v217
  v_mfma_f32_16x16x32_bf16 v[116:119], a[148:151], v[48:51], v[116:119]
  v_cvt_pk_bf16_f32 v176, v216, v217
  v_exp_f32 v216, v136
  v_add_f32 v226, v226, v218
  v_mfma_f32_16x16x32_bf16 v[124:127], a[148:151], v[52:55], v[124:127]
  v_exp_f32 v217, v137
  v_add_f32 v226, v226, v219
  v_cvt_pk_bf16_f32 v177, v218, v219
  v_mfma_f32_16x16x32_bf16 v[148:151], a[148:151], v[80:83], v[148:151]
  v_exp_f32 v218, v138
  v_add_f32 v226, v226, v220
  v_add_f32 v226, v226, v221
  v_mfma_f32_16x16x32_bf16 v[156:159], a[148:151], v[84:87], v[156:159]
  ds_read_b128 a[148:151], v3 offset:13312
  v_exp_f32 v219, v139
  v_mfma_f32_16x16x32_bf16 v[112:115], a[152:155], v[56:59], v[112:115]
  buffer_load_dwordx4 v2, s[48:51], s27 offen offset:3072 sc1 lds
  v_cvt_pk_bf16_f32 v178, v220, v221
  v_exp_f32 v220, v140
  v_mfma_f32_16x16x32_bf16 v[120:123], a[152:155], v[60:63], v[120:123]
  s_add_u32 s27, s27, 16384
  v_add_f32 v226, v226, v222
  v_add_f32 v226, v226, v223
  v_cvt_pk_bf16_f32 v179, v222, v223
  v_add_f32 v227, v216, v217
  v_mfma_f32_16x16x32_bf16 v[144:147], a[152:155], v[88:91], v[144:147]
  s_add_u32 s25, s25, 32768
  v_exp_f32 v221, v141
  v_cvt_pk_bf16_f32 v180, v216, v217
  v_add_f32 v227, v227, v218
  v_mfma_f32_16x16x32_bf16 v[152:155], a[152:155], v[92:95], v[152:155]
  s_and_b32 s25, s25, 0x1ffff
  ds_read_b128 a[152:155], v3 offset:14336
  v_add_f32 v227, v227, v219
  v_cvt_pk_bf16_f32 v181, v218, v219
  v_max3_f32 v5, v224, v225, v226
  v_mfma_f32_16x16x32_bf16 v[116:119], a[156:159], v[56:59], v[116:119]
  v_exp_f32 v222, v142
  v_add_f32 v227, v227, v220
  v_add_f32 v227, v227, v221
  v_mfma_f32_16x16x32_bf16 v[124:127], a[156:159], v[60:63], v[124:127]
  v_exp_f32 v223, v143
  v_cvt_pk_bf16_f32 v182, v220, v221
  v_add_f32 v227, v227, v222
  v_mfma_f32_16x16x32_bf16 v[148:151], a[156:159], v[88:91], v[148:151]
  v_add_f32 v227, v227, v223
  v_cvt_pk_bf16_f32 v183, v222, v223
  v_max_f32 v5, v5, v227
  v_cmp_lt_f32 vcc, s81, v5
  v_mfma_f32_16x16x32_bf16 v[156:159], a[156:159], v[92:95], v[156:159]
  s_waitcnt lgkmcnt(3)
  s_cbranch_vccnz fa_stub0
fa_back0:
  ds_read_b128 a[156:159], v3 offset:15360
  v_add_f32 v228, v228, v224
  v_add_f32 v229, v229, v225
  v_add_f32 v230, v230, v226
  v_add_f32 v231, v231, v227
  v_add_u32 v3, 32768, v3
  v_and_b32 v3, 0x1ffff, v3
  s_cmp_eq_u32 s28, 0
  s_cbranch_scc1 fa_AV
  s_sub_u32 s28, s28, 1
  s_cmp_eq_u32 s28, 0
  s_cbranch_scc1 fa_Aexit
.p2align 6
fa_DD:
  v_mfma_f32_16x16x32_bf16 v[96:99], a[128:131], v[32:35], v[192:195]
  s_waitcnt vmcnt(12)
  v_exp_f32 v208, v112
  v_mfma_f32_16x16x32_bf16 v[104:107], a[128:131], v[36:39], v[196:199]
  s_barrier
  v_exp_f32 v209, v113
  v_mfma_f32_16x16x32_bf16 v[128:131], a[128:131], v[64:67], v[200:203]
  s_cmp_ge_u32 s26, s32
  ds_read_b128 a[160:163], v3 offset:16384
  v_add_f32 v224, v208, v209
  v_mfma_f32_16x16x32_bf16 v[136:139], a[128:131], v[68:71], v[204:207]
  s_cbranch_scc1 fa_hk4
fa_hb4:
  v_exp_f32 v210, v114
  v_mfma_f32_16x16x32_bf16 v[100:103], a[132:135], v[32:35], v[192:195]
  ds_read_b128 a[164:167], v3 offset:17408
  v_cvt_pk_bf16_f32 v168, v208, v209
  v_mfma_f32_16x16x32_bf16 v[108:111], a[132:135], v[36:39], v[196:199]
  s_mov_b32 m0, s24
  v_exp_f32 v211, v115
  v_mfma_f32_16x16x32_bf16 v[132:135], a[132:135], v[64:67], v[200:203]
  buffer_load_dwordx4 v2, s[44:47], s26 offen offset:0 sc1 lds
  v_add_f32 v224, v224, v210
  v_add_f32 v224, v224, v211
  v_mfma_f32_16x16x32_bf16 v[140:143], a[132:135], v[68:71], v[204:207]
  v_exp_f32 v212, v116
  v_mfma_f32_16x16x32_bf16 v[96:99], a[136:139], v[40:43], v[96:99]
  ds_read_b128 a[168:171], v3 offset:18432
  v_cvt_pk_bf16_f32 v169, v210, v211
  v_mfma_f32_16x16x32_bf16 v[104:107], a[136:139], v[44:47], v[104:107]
  v_exp_f32 v213, v117
  v_mfma_f32_16x16x32_bf16 v[128:131], a[136:139], v[72:75], v[128:131]
  v_exp_f32 v214, v118
  v_mfma_f32_16x16x32_bf16 v[136:139], a[136:139], v[76:79], v[136:139]
  v_exp_f32 v215, v119
  v_mfma_f32_16x16x32_bf16 v[100:103], a[140:143], v[40:43], v[100:103]
  ds_read_b128 a[172:175], v3 offset:19456
  v_add_f32 v224, v224, v212
  v_mfma_f32_16x16x32_bf16 v[108:111], a[140:143], v[44:47], v[108:111]
  v_exp_f32 v208, v120
  v_mfma_f32_16x16x32_bf16 v[132:135], a[140:143], v[72:75], v[132:135]
  v_exp_f32 v209, v121
  v_mfma_f32_16x16x32_bf16 v[140:143], a[140:143], v[76:79], v[140:143]
  s_waitcnt lgkmcnt(4)
  v_exp_f32 v210, v122
  v_mfma_f32_16x16x32_bf16 v[96:99], a[144:147], v[48:51], v[96:99]
  ds_read_b128 a[176:179], v3 offset:20480
  v_add_f32 v224, v224, v213
  v_mfma_f32_16x16x32_bf16 v[104:107], a[144:147], v[52:55], v[104:107]
  v_exp_f32 v211, v123
  v_mfma_f32_16x16x32_bf16 v[128:131], a[144:147], v[80:83], v[128:131]
  v_cvt_pk_bf16_f32 v170, v212, v213
  v_add_f32 v224, v224, v214
  v_add_f32 v224, v224, v215
  v_mfma_f32_16x16x32_bf16 v[136:139], a[144:147], v[84:87], v[136:139]
  v_exp_f32 v212, v124
  v_mfma_f32_16x16x32_bf16 v[100:103], a[148:151], v[48:51], v[100:103]
  ds_read_b128 a[180:183], v3 offset:21504
  v_cvt_pk_bf16_f32 v171, v214, v215
  v_mfma_f32_16x16x32_bf16 v[108:111], a[148:151], v[52:55], v[108:111]
  v_exp_f32 v213, v125
  v_mfma_f32_16x16x32_bf16 v[132:135], a[148:151], v[80:83], v[132:135]
  buffer_load_dwordx4 v2, s[44:47], s26 offen offset:1024 sc1 lds
  v_add_f32 v225, v208, v209
  v_mfma_f32_16x16x32_bf16 v[140:143], a[148:151], v[84:87], v[140:143]
  v_exp_f32 v214, v126
  v_mfma_f32_16x16x32_bf16 v[96:99], a[152:155], v[56:59], v[96:99]
  ds_read_b128 a[184:187], v3 offset:22528
  v_cvt_pk_bf16_f32 v172, v208, v209
  v_mfma_f32_16x16x32_bf16 v[104:107], a[152:155], v[60:63], v[104:107]
  v_exp_f32 v215, v127
  v_mfma_f32_16x16x32_bf16 v[128:131], a[152:155], v[88:91], v[128:131]
  v_exp_f32 v216, v144
  v_mfma_f32_16x16x32_bf16 v[136:139], a[152:155], v[92:95], v[136:139]
  v_exp_f32 v217, v145
  v_mfma_f32_16x16x32_bf16 v[100:103], a[156:159], v[56:59], v[100:103]
  ds_read_b128 a[188:191], v3 offset:23552
  v_add_f32 v225, v225, v210
  v_mfma_f32_16x16x32_bf16 v[108:111], a[156:159], v[60:63], v[108:111]
  v_exp_f32 v218, v146
  v_mfma_f32_16x16x32_bf16 v[132:135], a[156:159], v[88:91], v[132:135]
  v_exp_f32 v219, v147
  v_mfma_f32_16x16x32_bf16 v[140:143], a[156:159], v[92:95], v[140:143]
  s_waitcnt lgkmcnt(4)
  v_exp_f32 v220, v148
  v_add_f32 v225, v225, v211
  v_mfma_f32_16x16x32_bf16 a[0:3], a[160:163], v[160:163], a[0:3]
  ds_read_b128 a[128:131], v3 offset:0
  v_cvt_pk_bf16_f32 v173, v210, v211
  v_mfma_f32_16x16x32_bf16 a[4:7], a[160:163], v[164:167], a[4:7]
  v_exp_f32 v221, v149
  v_mfma_f32_16x16x32_bf16 a[64:67], a[160:163], v[176:179], a[64:67]
  v_exp_f32 v222, v150
  v_mfma_f32_16x16x32_bf16 a[68:71], a[160:163], v[180:183], a[68:71]
  v_exp_f32 v223, v151
  v_mfma_f32_16x16x32_bf16 a[8:11], a[164:167], v[160:163], a[8:11]
  ds_read_b128 a[132:135], v3 offset:1024
  v_add_f32 v225, v225, v212
  v_mfma_f32_16x16x32_bf16 a[12:15], a[164:167], v[164:167], a[12:15]
  v_add_f32 v225, v225, v213
  v_cvt_pk_bf16_f32 v174, v212, v213
  v_mfma_f32_16x16x32_bf16 a[72:75], a[164:167], v[176:179], a[72:75]
  buffer_load_dwordx4 v2, s[44:47], s26 offen offset:2048 sc1 lds
  v_add_f32 v225, v225, v214
  v_mfma_f32_16x16x32_bf16 a[76:79], a[164:167], v[180:183], a[76:79]
  v_add_f32 v225, v225, v215
  v_cvt_pk_bf16_f32 v175, v214, v215
  v_mfma_f32_16x16x32_bf16 a[16:19], a[168:171], v[160:163], a[16:19]
  ds_read_b128 a[136:139], v3 offset:2048
  v_add_f32 v226, v216, v217
  v_mfma_f32_16x16x32_bf16 a[20:23], a[168:171], v[164:167], a[20:23]
  v_cvt_pk_bf16_f32 v184, v216, v217
  v_add_f32 v226, v226, v218
  v_mfma_f32_16x16x32_bf16 a[80:83], a[168:171], v[176:179], a[80:83]
  v_exp_f32 v216, v152
  v_mfma_f32_16x16x32_bf16 a[84:87], a[168:171], v[180:183], a[84:87]
  v_exp_f32 v217, v153
  v_mfma_f32_16x16x32_bf16 a[24:27], a[172:175], v[160:163], a[24:27]
  ds_read_b128 a[140:143], v3 offset:3072
  v_add_f32 v226, v226, v219
  v_cvt_pk_bf16_f32 v185, v218, v219
  v_mfma_f32_16x16x32_bf16 a[28:31], a[172:175], v[164:167], a[28:31]
  v_exp_f32 v218, v154
  v_mfma_f32_16x16x32_bf16 a[88:91], a[172:175], v[176:179], a[88:91]
  v_add_f32 v226, v226, v220
  v_add_f32 v226, v226, v221
  v_mfma_f32_16x16x32_bf16 a[92:95], a[172:175], v[180:183], a[92:95]
  s_waitcnt lgkmcnt(4)
  v_exp_f32 v219, v155
  v_mfma_f32_16x16x32_bf16 a[32:35], a[176:179], v[160:163], a[32:35]
  ds_read_b128 a[144:147], v3 offset:4096
  v_cvt_pk_bf16_f32 v186, v220, v221
  v_mfma_f32_16x16x32_bf16 a[36:39], a[176:179], v[164:167], a[36:39]
  v_exp_f32 v220, v156
  v_mfma_f32_16x16x32_bf16 a[96:99], a[176:179], v[176:179], a[96:99]
  v_add_f32 v226, v226, v222
  v_add_f32 v226, v226, v223
  v_mfma_f32_16x16x32_bf16 a[100:103], a[176:179], v[180:183], a[100:103]
  v_exp_f32 v221, v157
  v_mfma_f32_16x16x32_bf16 a[40:43], a[180:183], v[160:163], a[40:43]
  ds_read_b128 a[148:151], v3 offset:5120
  v_cvt_pk_bf16_f32 v187, v222, v223
  v_mfma_f32_16x16x32_bf16 a[44:47], a[180:183], v[164:167], a[44:47]
  v_exp_f32 v222, v158
  v_mfma_f32_16x16x32_bf16 a[104:107], a[180:183], v[176:179], a[104:107]
  buffer_load_dwordx4 v2, s[44:47], s26 offen offset:3072 sc1 lds
  v_add_f32 v227, v216, v217
  v_mfma_f32_16x16x32_bf16 a[108:111], a[180:183], v[180:183], a[108:111]
  s_add_u32 s26, s26, 16384
  v_exp_f32 v223, v159
  v_mfma_f32_16x16x32_bf16 a[48:51], a[184:187], v[160:163], a[48:51]
  s_add_u32 s24, s24, 32768
  ds_read_b128 a[152:155], v3 offset:6144
  v_cvt_pk_bf16_f32 v188, v216, v217
  v_add_f32 v227, v227, v218
  v_mfma_f32_16x16x32_bf16 a[52:55], a[184:187], v[164:167], a[52:55]
  s_and_b32 s24, s24, 0x1ffff
  v_add_f32 v227, v227, v219
  v_cvt_pk_bf16_f32 v189, v218, v219
  v_mfma_f32_16x16x32_bf16 a[112:115], a[184:187], v[176:179], a[112:115]
  v_max3_f32 v5, v224, v225, v226
  v_add_f32 v227, v227, v220
  v_mfma_f32_16x16x32_bf16 a[116:119], a[184:187], v[180:183], a[116:119]
  v_add_f32 v227, v227, v221
  v_cvt_pk_bf16_f32 v190, v220, v221
  v_mfma_f32_16x16x32_bf16 a[56:59], a[188:191], v[160:163], a[56:59]
  ds_read_b128 a[156:159], v3 offset:7168
  v_add_f32 v227, v227, v222
  v_mfma_f32_16x16x32_bf16 a[60:63], a[188:191], v[164:167], a[60:63]
  v_add_f32 v227, v227, v223
  v_cvt_pk_bf16_f32 v191, v222, v223
  v_mfma_f32_16x16x32_bf16 a[120:123], a[188:191], v[176:179], a[120:123]
  s_waitcnt lgkmcnt(4)
  v_max_f32 v5, v5, v227
  v_cmp_lt_f32 vcc, s81, v5
  v_mfma_f32_16x16x32_bf16 a[124:127], a[188:191], v[180:183], a[124:127]
  s_cbranch_vccnz fa_stub1
fa_back1:
  v_add_f32 v228, v228, v224
  v_add_f32 v229, v229, v225
  v_add_f32 v230, v230, v226
  v_add_f32 v231, v231, v227
fa_DDe:
  v_mfma_f32_16x16x32_bf16 v[112:115], a[128:131], v[32:35], v[192:195]
  ds_read_b128 a[160:163], v3 offset:24576
  v_exp_f32 v208, v96
  v_mfma_f32_16x16x32_bf16 v[120:123], a[128:131], v[36:39], v[196:199]
  v_exp_f32 v209, v97
  v_mfma_f32_16x16x32_bf16 v[144:147], a[128:131], v[64:67], v[200:203]
  s_cmp_ge_u32 s26, s9
  v_exp_f32 v210, v98
  v_mfma_f32_16x16x32_bf16 v[152:155], a[128:131], v[68:71], v[204:207]
  s_cbranch_scc1 fa_hk5
fa_hb5:
  v_exp_f32 v211, v99
  v_mfma_f32_16x16x32_bf16 v[116:119], a[132:135], v[32:35], v[192:195]
  ds_read_b128 a[164:167], v3 offset:25600
  v_mfma_f32_16x16x32_bf16 v[124:127], a[132:135], v[36:39], v[196:199]
  s_mov_b32 m0, s25
  v_exp_f32 v212, v100
  v_mfma_f32_16x16x32_bf16 v[148:151], a[132:135], v[64:67], v[200:203]
  buffer_load_dwordx4 v2, s[48:51], s27 offen offset:0 sc1 lds
  v_add_f32 v224, v208, v209
  v_cvt_pk_bf16_f32 v160, v208, v209
  v_mfma_f32_16x16x32_bf16 v[156:159], a[132:135], v[68:71], v[204:207]
  v_exp_f32 v213, v101
  v_mfma_f32_16x16x32_bf16 v[112:115], a[136:139], v[40:43], v[112:115]
  ds_read_b128 a[168:171], v3 offset:26624
  v_add_f32 v224, v224, v210
  v_mfma_f32_16x16x32_bf16 v[120:123], a[136:139], v[44:47], v[120:123]
  v_exp_f32 v214, v102
  v_mfma_f32_16x16x32_bf16 v[144:147], a[136:139], v[72:75], v[144:147]
  v_exp_f32 v215, v103
  v_mfma_f32_16x16x32_bf16 v[152:155], a[136:139], v[76:79], v[152:155]
  v_exp_f32 v208, v104
  v_mfma_f32_16x16x32_bf16 v[116:119], a[140:143], v[40:43], v[116:119]
  ds_read_b128 a[172:175], v3 offset:27648
  v_add_f32 v224, v224, v211
  v_mfma_f32_16x16x32_bf16 v[124:127], a[140:143], v[44:47], v[124:127]
  v_exp_f32 v209, v105
  v_mfma_f32_16x16x32_bf16 v[148:151], a[140:143], v[72:75], v[148:151]
  v_cvt_pk_bf16_f32 v161, v210, v211
  v_add_f32 v224, v224, v212
  v_mfma_f32_16x16x32_bf16 v[156:159], a[140:143], v[76:79], v[156:159]
  s_waitcnt lgkmcnt(4)
  v_exp_f32 v210, v106
  v_mfma_f32_16x16x32_bf16 v[112:115], a[144:147], v[48:51], v[112:115]
  ds_read_b128 a[176:179], v3 offset:28672
  v_add_f32 v224, v224, v213
  v_mfma_f32_16x16x32_bf16 v[120:123], a[144:147], v[52:55], v[120:123]
  v_exp_f32 v211, v107
  v_mfma_f32_16x16x32_bf16 v[144:147], a[144:147], v[80:83], v[144:147]
  v_cvt_pk_bf16_f32 v162, v212, v213
  v_add_f32 v224, v224, v214
  v_add_f32 v224, v224, v215
  v_mfma_f32_16x16x32_bf16 v[152:155], a[144:147], v[84:87], v[152:155]
  v_exp_f32 v212, v108
  v_mfma_f32_16x16x32_bf16 v[116:119], a[148:151], v[48:51], v[116:119]
  ds_read_b128 a[180:183], v3 offset:29696
  v_cvt_pk_bf16_f32 v163, v214, v215
  v_mfma_f32_16x16x32_bf16 v[124:127], a[148:151], v[52:55], v[124:127]
  v_exp_f32 v213, v109
  v_mfma_f32_16x16x32_bf16 v[148:151], a[148:151], v[80:83], v[148:151]
  buffer_load_dwordx4 v2, s[48:51], s27 offen offset:1024 sc1 lds
  v_add_f32 v225, v208, v209
  v_mfma_f32_16x16x32_bf16 v[156:159], a[148:151], v[84:87], v[156:159]
  v_exp_f32 v214, v110
  v_mfma_f32_16x16x32_bf16 v[112:115], a[152:155], v[56:59], v[112:115]
  ds_read_b128 a[184:187], v3 offset:30720
  v_cvt_pk_bf16_f32 v164, v208, v209
  v_mfma_f32_16x16x32_bf16 v[120:123], a[152:155], v[60:63], v[120:123]
  v_exp_f32 v215, v111
  v_mfma_f32_16x16x32_bf16 v[144:147], a[152:155], v[88:91], v[144:147]
  v_exp_f32 v216, v128
  v_mfma_f32_16x16x32_bf16 v[152:155], a[152:155], v[92:95], v[152:155]
  v_exp_f32 v217, v129
  v_mfma_f32_16x16x32_bf16 v[116:119], a[156:159], v[56:59], v[116:119]
  ds_read_b128 a[188:191], v3 offset:31744
  v_add_f32 v225, v225, v210
  v_mfma_f32_16x16x32_bf16 v[124:127], a[156:159], v[60:63], v[124:127]
  v_exp_f32 v218, v130
  v_mfma_f32_16x16x32_bf16 v[148:151], a[156:159], v[88:91], v[148:151]
  v_exp_f32 v219, v131
  v_mfma_f32_16x16x32_bf16 v[156:159], a[156:159], v[92:95], v[156:159]
  s_waitcnt lgkmcnt(4)
  v_exp_f32 v220, v132
  v_add_f32 v225, v225, v211
  v_mfma_f32_16x16x32_bf16 a[0:3], a[160:163], v[168:171], a[0:3]
  ds_read_b128 a[128:131], v3 offset:8192
  v_cvt_pk_bf16_f32 v165, v210, v211
  v_mfma_f32_16x16x32_bf16 a[4:7], a[160:163], v[172:175], a[4:7]
  v_exp_f32 v221, v133
  v_mfma_f32_16x16x32_bf16 a[64:67], a[160:163], v[184:187], a[64:67]
  v_exp_f32 v222, v134
  v_mfma_f32_16x16x32_bf16 a[68:71], a[160:163], v[188:191], a[68:71]
  v_exp_f32 v223, v135
  v_mfma_f32_16x16x32_bf16 a[8:11], a[164:167], v[168:171], a[8:11]
  ds_read_b128 a[132:135], v3 offset:9216
  v_add_f32 v225, v225, v212
  v_mfma_f32_16x16x32_bf16 a[12:15], a[164:167], v[172:175], a[12:15]
  v_add_f32 v225, v225, v213
  v_cvt_pk_bf16_f32 v166, v212, v213
  v_mfma_f32_16x16x32_bf16 a[72:75], a[164:167], v[184:187], a[72:75]
  buffer_load_dwordx4 v2, s[48:51], s27 offen offset:2048 sc1 lds
  v_add_f32 v225, v225, v214
  v_mfma_f32_16x16x32_bf16 a[76:79], a[164:167], v[188:191], a[76:79]
  v_add_f32 v225, v225, v215
  v_cvt_pk_bf16_f32 v167, v214, v215
  v_mfma_f32_16x16x32_bf16 a[16:19], a[168:171], v[168:171], a[16:19]
  ds_read_b128 a[136:139], v3 offset:10240
  v_add_f32 v226, v216, v217
  v_mfma_f32_16x16x32_bf16 a[20:23], a[168:171], v[172:175], a[20:23]
  v_cvt_pk_bf16_f32 v176, v216, v217
  v_add_f32 v226, v226, v218
  v_mfma_f32_16x16x32_bf16 a[80:83], a[168:171], v[184:187], a[80:83]
  v_exp_f32 v216, v136
  v_mfma_f32_16x16x32_bf16 a[84:87], a[168:171], v[188:191], a[84:87]
  v_exp_f32 v217, v137
  v_mfma_f32_16x16x32_bf16 a[24:27], a[172:175], v[168:171], a[24:27]
  ds_read_b128 a[140:143], v3 offset:11264
  v_add_f32 v226, v226, v219
  v_cvt_pk_bf16_f32 v177, v218, v219
  v_mfma_f32_16x16x32_bf16 a[28:31], a[172:175], v[172:175], a[28:31]
  v_exp_f32 v218, v138
  v_mfma_f32_16x16x32_bf16 a[88:91], a[172:175], v[184:187], a[88:91]
  v_add_f32 v226, v226, v220
  v_add_f32 v226, v226, v221
  v_mfma_f32_16x16x32_bf16 a[92:95], a[172:175], v[188:191], a[92:95]
  s_waitcnt lgkmcnt(4)
  v_exp_f32 v219, v139
  v_mfma_f32_16x16x32_bf16 a[32:35], a[176:179], v[168:171], a[32:35]
  ds_read_b128 a[144:147], v3 offset:12288
  v_cvt_pk_bf16_f32 v178, v220, v221
  v_mfma_f32_16x16x32_bf16 a[36:39], a[176:179], v[172:175], a[36:39]
  v_exp_f32 v220, v140
  v_mfma_f32_16x16x32_bf16 a[96:99], a[176:179], v[184:187], a[96:99]
  v_add_f32 v226, v226, v222
  v_add_f32 v226, v226, v223
  v_mfma_f32_16x16x32_bf16 a[100:103], a[176:179], v[188:191], a[100:103]
  v_exp_f32 v221, v141
  v_mfma_f32_16x16x32_bf16 a[40:43], a[180:183], v[168:171], a[40:43]
  ds_read_b128 a[148:151], v3 offset:13312
  v_cvt_pk_bf16_f32 v179, v222, v223
  v_mfma_f32_16x16x32_bf16 a[44:47], a[180:183], v[172:175], a[44:47]
  v_exp_f32 v222, v142
  v_mfma_f32_16x16x32_bf16 a[104:107], a[180:183], v[184:187], a[104:107]
  buffer_load_dwordx4 v2, s[48:51], s27 offen offset:3072 sc1 lds
  v_add_f32 v227, v216, v217
  v_mfma_f32_16x16x32_bf16 a[108:111], a[180:183], v[188:191], a[108:111]
  s_add_u32 s27, s27, 16384
  v_exp_f32 v223, v143
  v_mfma_f32_16x16x32_bf16 a[48:51], a[184:187], v[168:171], a[48:51]
  s_add_u32 s25, s25, 32768
  ds_read_b128 a[152:155], v3 offset:14336
  v_cvt_pk_bf16_f32 v180, v216, v217
  v_add_f32 v227, v227, v218
  v_mfma_f32_16x16x32_bf16 a[52:55], a[184:187], v[172:175], a[52:55]
  s_and_b32 s25, s25, 0x1ffff
  v_add_f32 v227, v227, v219
  v_cvt_pk_bf16_f32 v181, v218, v219
  v_mfma_f32_16x16x32_bf16 a[112:115], a[184:187], v[184:187], a[112:115]
  v_max3_f32 v5, v224, v225, v226
  v_add_f32 v227, v227, v220
  v_mfma_f32_16x16x32_bf16 a[116:119], a[184:187], v[188:191], a[116:119]
  v_add_f32 v227, v227, v221
  v_cvt_pk_bf16_f32 v182, v220, v221
  v_mfma_f32_16x16x32_bf16 a[56:59], a[188:191], v[168:171], a[56:59]
  ds_read_b128 a[156:159], v3 offset:15360
  v_add_f32 v227, v227, v222
  v_mfma_f32_16x16x32_bf16 a[60:63], a[188:191], v[172:175], a[60:63]
  s_sub_u32 s28, s28, 1
  v_add_f32 v227, v227, v223
  v_cvt_pk_bf16_f32 v183, v222, v223
  v_mfma_f32_16x16x32_bf16 a[120:123], a[188:191], v[184:187], a[120:123]
  s_waitcnt lgkmcnt(4)
  v_max_f32 v5, v5, v227
  v_cmp_lt_f32 vcc, s81, v5
  v_mfma_f32_16x16x32_bf16 a[124:127], a[188:191], v[188:191], a[124:127]
  s_cbranch_vccnz fa_stub2
fa_back2:
  v_add_f32 v228, v228, v224
  v_add_f32 v229, v229, v225
  v_add_f32 v230, v230, v226
  v_add_f32 v231, v231, v227
  v_add_u32 v3, 32768, v3
  v_and_b32 v3, 0x1ffff, v3
  s_cmp_lg_u32 s8, 0
  s_cbranch_scc1 fa_DDF
  s_cmp_lg_u32 s28, 0
  s_cbranch_scc1 fa_DD
fa_Aexit:
  s_bitcmp1_b32 s20, 0
  s_cbranch_scc1 fa_Aodd
  v_mfma_f32_16x16x32_bf16 v[96:99], a[128:131], v[32:35], v[192:195]
  s_waitcnt vmcnt(12)
  v_exp_f32 v208, v112
  v_mfma_f32_16x16x32_bf16 v[104:107], a[128:131], v[36:39], v[196:199]
  s_barrier
  v_exp_f32 v209, v113
  v_mfma_f32_16x16x32_bf16 v[128:131], a[128:131], v[64:67], v[200:203]
  ds_read_b128 a[160:163], v3 offset:16384
  v_add_f32 v224, v208, v209
  v_mfma_f32_16x16x32_bf16 v[136:139], a[128:131], v[68:71], v[204:207]
  v_exp_f32 v210, v114
  v_mfma_f32_16x16x32_bf16 v[100:103], a[132:135], v[32:35], v[192:195]
  ds_read_b128 a[164:167], v3 offset:17408
  v_cvt_pk_bf16_f32 v168, v208, v209
  v_mfma_f32_16x16x32_bf16 v[108:111], a[132:135], v[36:39], v[196:199]
  s_mov_b32 m0, s24
  v_exp_f32 v211, v115
  v_mfma_f32_16x16x32_bf16 v[132:135], a[132:135], v[64:67], v[200:203]
  buffer_load_dwordx4 v2, s[44:47], s26 offen offset:0 sc1 lds
  v_add_f32 v224, v224, v210
  v_add_f32 v224, v224, v211
  v_mfma_f32_16x16x32_bf16 v[140:143], a[132:135], v[68:71], v[204:207]
  v_exp_f32 v212, v116
  v_mfma_f32_16x16x32_bf16 v[96:99], a[136:139], v[40:43], v[96:99]
  ds_read_b128 a[168:171], v3 offset:18432
  v_cvt_pk_bf16_f32 v169, v210, v211
  v_mfma_f32_16x16x32_bf16 v[104:107], a[136:139], v[44:47], v[104:107]
  v_exp_f32 v213, v117
  v_mfma_f32_16x16x32_bf16 v[128:131], a[136:139], v[72:75], v[128:131]
  v_exp_f32 v214, v118
  v_mfma_f32_16x16x32_bf16 v[136:139], a[136:139], v[76:79], v[136:139]
  v_exp_f32 v215, v119
  v_mfma_f32_16x16x32_bf16 v[100:103], a[140:143], v[40:43], v[100:103]
  ds_read_b128 a[172:175], v3 offset:19456
  v_add_f32 v224, v224, v212
  v_mfma_f32_16x16x32_bf16 v[108:111], a[140:143], v[44:47], v[108:111]
  v_exp_f32 v208, v120
  v_mfma_f32_16x16x32_bf16 v[132:135], a[140:143], v[72:75], v[132:135]
  v_exp_f32 v209, v121
  v_mfma_f32_16x16x32_bf16 v[140:143], a[140:143], v[76:79], v[140:143]
  s_waitcnt lgkmcnt(4)
  v_exp_f32 v210, v122
  v_mfma_f32_16x16x32_bf16 v[96:99], a[144:147], v[48:51], v[96:99]
  ds_read_b128 a[176:179], v3 offset:20480
  v_add_f32 v224, v224, v213
  v_mfma_f32_16x16x32_bf16 v[104:107], a[144:147], v[52:55], v[104:107]
  v_exp_f32 v211, v123
  v_mfma_f32_16x16x32_bf16 v[128:131], a[144:147], v[80:83], v[128:131]
  v_cvt_pk_bf16_f32 v170, v212, v213
  v_add_f32 v224, v224, v214
  v_add_f32 v224, v224, v215
  v_mfma_f32_16x16x32_bf16 v[136:139], a[144:147], v[84:87], v[136:139]
  v_exp_f32 v212, v124
  v_mfma_f32_16x16x32_bf16 v[100:103], a[148:151], v[48:51], v[100:103]
  ds_read_b128 a[180:183], v3 offset:21504
  v_cvt_pk_bf16_f32 v171, v214, v215
  v_mfma_f32_16x16x32_bf16 v[108:111], a[148:151], v[52:55], v[108:111]
  v_exp_f32 v213, v125
  v_mfma_f32_16x16x32_bf16 v[132:135], a[148:151], v[80:83], v[132:135]
  buffer_load_dwordx4 v2, s[44:47], s26 offen offset:1024 sc1 lds
  v_add_f32 v225, v208, v209
  v_mfma_f32_16x16x32_bf16 v[140:143], a[148:151], v[84:87], v[140:143]
  v_exp_f32 v214, v126
  v_mfma_f32_16x16x32_bf16 v[96:99], a[152:155], v[56:59], v[96:99]
  ds_read_b128 a[184:187], v3 offset:22528
  v_cvt_pk_bf16_f32 v172, v208, v209
  v_mfma_f32_16x16x32_bf16 v[104:107], a[152:155], v[60:63], v[104:107]
  v_exp_f32 v215, v127
  v_mfma_f32_16x16x32_bf16 v[128:131], a[152:155], v[88:91], v[128:131]
  v_exp_f32 v216, v144
  v_mfma_f32_16x16x32_bf16 v[136:139], a[152:155], v[92:95], v[136:139]
  v_exp_f32 v217, v145
  v_mfma_f32_16x16x32_bf16 v[100:103], a[156:159], v[56:59], v[100:103]
  ds_read_b128 a[188:191], v3 offset:23552
  v_add_f32 v225, v225, v210
  v_mfma_f32_16x16x32_bf16 v[108:111], a[156:159], v[60:63], v[108:111]
  v_exp_f32 v218, v146
  v_mfma_f32_16x16x32_bf16 v[132:135], a[156:159], v[88:91], v[132:135]
  v_exp_f32 v219, v147
  v_mfma_f32_16x16x32_bf16 v[140:143], a[156:159], v[92:95], v[140:143]
  s_waitcnt lgkmcnt(4)
  v_exp_f32 v220, v148
  v_add_f32 v225, v225, v211
  v_mfma_f32_16x16x32_bf16 a[0:3], a[160:163], v[160:163], a[0:3]
  ds_read_b128 a[128:131], v3 offset:0
  v_cvt_pk_bf16_f32 v173, v210, v211
  v_mfma_f32_16x16x32_bf16 a[4:7], a[160:163], v[164:167], a[4:7]
  v_exp_f32 v221, v149
  v_mfma_f32_16x16x32_bf16 a[64:67], a[160:163], v[176:179], a[64:67]
  v_exp_f32 v222, v150
  v_mfma_f32_16x16x32_bf16 a[68:71], a[160:163], v[180:183], a[68:71]
  v_exp_f32 v223, v151
  v_mfma_f32_16x16x32_bf16 a[8:11], a[164:167], v[160:163], a[8:11]
  ds_read_b128 a[132:135], v3 offset:1024
  v_add_f32 v225, v225, v212
  v_mfma_f32_16x16x32_bf16 a[12:15], a[164:167], v[164:167], a[12:15]
  v_add_f32 v225, v225, v213
  v_cvt_pk_bf16_f32 v174, v212, v213
  v_mfma_f32_16x16x32_bf16 a[72:75], a[164:167], v[176:179], a[72:75]
  buffer_load_dwordx4 v2, s[44:47], s26 offen offset:2048 sc1 lds
  v_add_f32 v225, v225, v214
  v_mfma_f32_16x16x32_bf16 a[76:79], a[164:167], v[180:183], a[76:79]
  v_add_f32 v225, v225, v215
  v_cvt_pk_bf16_f32 v175, v214, v215
  v_mfma_f32_16x16x32_bf16 a[16:19], a[168:171], v[160:163], a[16:19]
  ds_read_b128 a[136:139], v3 offset:2048
  v_add_f32 v226, v216, v217
  v_mfma_f32_16x16x32_bf16 a[20:23], a[168:171], v[164:167], a[20:23]
  v_cvt_pk_bf16_f32 v184, v216, v217
  v_add_f32 v226, v226, v218
  v_mfma_f32_16x16x32_bf16 a[80:83], a[168:171], v[176:179], a[80:83]
  v_exp_f32 v216, v152
  v_mfma_f32_16x16x32_bf16 a[84:87], a[168:171], v[180:183], a[84:87]
  v_exp_f32 v217, v153
  v_mfma_f32_16x16x32_bf16 a[24:27], a[172:175], v[160:163], a[24:27]
  ds_read_b128 a[140:143], v3 offset:3072
  v_add_f32 v226, v226, v219
  v_cvt_pk_bf16_f32 v185, v218, v219
  v_mfma_f32_16x16x32_bf16 a[28:31], a[172:175], v[164:167], a[28:31]
  v_exp_f32 v218, v154
  v_mfma_f32_16x16x32_bf16 a[88:91], a[172:175], v[176:179], a[88:91]
  v_add_f32 v226, v226, v220
  v_add_f32 v226, v226, v221
  v_mfma_f32_16x16x32_bf16 a[92:95], a[172:175], v[180:183], a[92:95]
  s_waitcnt lgkmcnt(4)
  v_exp_f32 v219, v155
  v_mfma_f32_16x16x32_bf16 a[32:35], a[176:179], v[160:163], a[32:35]
  ds_read_b128 a[144:147], v3 offset:4096
  v_cvt_pk_bf16_f32 v186, v220, v221
  v_mfma_f32_16x16x32_bf16 a[36:39], a[176:179], v[164:167], a[36:39]
  v_exp_f32 v220, v156
  v_mfma_f32_16x16x32_bf16 a[96:99], a[176:179], v[176:179], a[96:99]
  v_add_f32 v226, v226, v222
  v_add_f32 v226, v226, v223
  v_mfma_f32_16x16x32_bf16 a[100:103], a[176:179], v[180:183], a[100:103]
  v_exp_f32 v221, v157
  v_mfma_f32_16x16x32_bf16 a[40:43], a[180:183], v[160:163], a[40:43]
  ds_read_b128 a[148:151], v3 offset:5120
  v_cvt_pk_bf16_f32 v187, v222, v223
  v_mfma_f32_16x16x32_bf16 a[44:47], a[180:183], v[164:167], a[44:47]
  v_exp_f32 v222, v158
  v_mfma_f32_16x16x32_bf16 a[104:107], a[180:183], v[176:179], a[104:107]
  buffer_load_dwordx4 v2, s[44:47], s26 offen offset:3072 sc1 lds
  v_add_f32 v227, v216, v217
  v_mfma_f32_16x16x32_bf16 a[108:111], a[180:183], v[180:183], a[108:111]
  s_add_u32 s26, s26, 16384
  v_exp_f32 v223, v159
  v_mfma_f32_16x16x32_bf16 a[48:51], a[184:187], v[160:163], a[48:51]
  s_add_u32 s24, s24, 32768
  ds_read_b128 a[152:155], v3 offset:6144
  v_cvt_pk_bf16_f32 v188, v216, v217
  v_add_f32 v227, v227, v218
  v_mfma_f32_16x16x32_bf16 a[52:55], a[184:187], v[164:167], a[52:55]
  s_and_b32 s24, s24, 0x1ffff
  v_add_f32 v227, v227, v219
  v_cvt_pk_bf16_f32 v189, v218, v219
  v_mfma_f32_16x16x32_bf16 a[112:115], a[184:187], v[176:179], a[112:115]
  v_max3_f32 v5, v224, v225, v226
  v_add_f32 v227, v227, v220
  v_mfma_f32_16x16x32_bf16 a[116:119], a[184:187], v[180:183], a[116:119]
  v_add_f32 v227, v227, v221
  v_cvt_pk_bf16_f32 v190, v220, v221
  v_mfma_f32_16x16x32_bf16 a[56:59], a[188:191], v[160:163], a[56:59]
  ds_read_b128 a[156:159], v3 offset:7168
  v_add_f32 v227, v227, v222
  v_mfma_f32_16x16x32_bf16 a[60:63], a[188:191], v[164:167], a[60:63]
  v_add_f32 v227, v227, v223
  v_cvt_pk_bf16_f32 v191, v222, v223
  v_mfma_f32_16x16x32_bf16 a[120:123], a[188:191], v[176:179], a[120:123]
  s_waitcnt lgkmcnt(4)
  v_max_f32 v5, v5, v227
  v_cmp_lt_f32 vcc, s81, v5
  v_mfma_f32_16x16x32_bf16 a[124:127], a[188:191], v[180:183], a[124:127]
  s_cbranch_vccnz fa_stub4
fa_back4:
  v_add_f32 v228, v228, v224
  v_add_f32 v229, v229, v225
  v_add_f32 v230, v230, v226
  v_add_f32 v231, v231, v227
  v_mfma_f32_16x16x32_bf16 v[144:147], a[128:131], v[64:67], v[200:203]
  ds_read_b128 a[160:163], v3 offset:24576
  v_cndmask_b32 v96, v4, v96, s[68:69]
  v_cndmask_b32 v97, v4, v97, s[70:71]
  v_mfma_f32_16x16x32_bf16 v[152:155], a[128:131], v[68:71], v[204:207]
  v_cndmask_b32 v98, v4, v98, s[72:73]
  v_cndmask_b32 v99, v4, v99, s[74:75]
  v_mov_b32 v100, v4
  v_mfma_f32_16x16x32_bf16 v[148:151], a[132:135], v[64:67], v[200:203]
  ds_read_b128 a[164:167], v3 offset:25600
  v_mov_b32 v101, v4
  v_mov_b32 v102, v4
  v_mfma_f32_16x16x32_bf16 v[156:159], a[132:135], v[68:71], v[204:207]
  v_mov_b32 v103, v4
  v_cndmask_b32 v108, v4, v108, s[68:69]
  v_cndmask_b32 v109, v4, v109, s[70:71]
  v_mfma_f32_16x16x32_bf16 v[144:147], a[136:139], v[72:75], v[144:147]
  ds_read_b128 a[168:171], v3 offset:26624
  v_cndmask_b32 v110, v4, v110, s[72:73]
  v_cndmask_b32 v111, v4, v111, s[74:75]
  v_mfma_f32_16x16x32_bf16 v[152:155], a[136:139], v[76:79], v[152:155]
  s_mov_b32 m0, s25
  v_exp_f32 v208, v96
  v_exp_f32 v209, v97
  v_mfma_f32_16x16x32_bf16 v[148:151], a[140:143], v[72:75], v[148:151]
  ds_read_b128 a[172:175], v3 offset:27648
  buffer_load_dwordx4 v2, s[48:51], s27 offen offset:0 sc1 lds
  v_mfma_f32_16x16x32_bf16 v[156:159], a[140:143], v[76:79], v[156:159]
  s_waitcnt lgkmcnt(4)
  v_exp_f32 v210, v98
  v_add_f32 v224, v208, v209
  v_mfma_f32_16x16x32_bf16 v[144:147], a[144:147], v[80:83], v[144:147]
  ds_read_b128 a[176:179], v3 offset:28672
  v_exp_f32 v211, v99
  v_mfma_f32_16x16x32_bf16 v[152:155], a[144:147], v[84:87], v[152:155]
  v_exp_f32 v212, v100
  v_cvt_pk_bf16_f32 v160, v208, v209
  v_mfma_f32_16x16x32_bf16 v[148:151], a[148:151], v[80:83], v[148:151]
  ds_read_b128 a[180:183], v3 offset:29696
  v_exp_f32 v213, v101
  v_mfma_f32_16x16x32_bf16 v[156:159], a[148:151], v[84:87], v[156:159]
  v_exp_f32 v214, v102
  v_add_f32 v224, v224, v210
  v_add_f32 v224, v224, v211
  v_mfma_f32_16x16x32_bf16 v[144:147], a[152:155], v[88:91], v[144:147]
  ds_read_b128 a[184:187], v3 offset:30720
  v_cvt_pk_bf16_f32 v161, v210, v211
  v_add_f32 v224, v224, v212
  v_mfma_f32_16x16x32_bf16 v[152:155], a[152:155], v[92:95], v[152:155]
  v_exp_f32 v215, v103
  v_add_f32 v224, v224, v213
  v_mfma_f32_16x16x32_bf16 v[148:151], a[156:159], v[88:91], v[148:151]
  ds_read_b128 a[188:191], v3 offset:31744
  v_cvt_pk_bf16_f32 v162, v212, v213
  v_add_f32 v224, v224, v214
  v_mfma_f32_16x16x32_bf16 v[156:159], a[156:159], v[92:95], v[156:159]
  s_waitcnt lgkmcnt(4)
  v_exp_f32 v208, v104
  v_add_f32 v224, v224, v215
  v_mfma_f32_16x16x32_bf16 a[0:3], a[160:163], v[168:171], a[0:3]
  ds_read_b128 a[128:131], v3 offset:8192
  v_cvt_pk_bf16_f32 v163, v214, v215
  v_exp_f32 v209, v105
  v_mfma_f32_16x16x32_bf16 a[4:7], a[160:163], v[172:175], a[4:7]
  v_exp_f32 v210, v106
  v_mfma_f32_16x16x32_bf16 a[64:67], a[160:163], v[184:187], a[64:67]
  buffer_load_dwordx4 v2, s[48:51], s27 offen offset:1024 sc1 lds
  v_exp_f32 v211, v107
  v_mfma_f32_16x16x32_bf16 a[68:71], a[160:163], v[188:191], a[68:71]
  v_exp_f32 v212, v108
  v_add_f32 v225, v208, v209
  v_mfma_f32_16x16x32_bf16 a[8:11], a[164:167], v[168:171], a[8:11]
  ds_read_b128 a[132:135], v3 offset:9216
  v_exp_f32 v213, v109
  v_mfma_f32_16x16x32_bf16 a[12:15], a[164:167], v[172:175], a[12:15]
  v_exp_f32 v214, v110
  v_cvt_pk_bf16_f32 v164, v208, v209
  v_mfma_f32_16x16x32_bf16 a[72:75], a[164:167], v[184:187], a[72:75]
  v_exp_f32 v215, v111
  v_add_f32 v225, v225, v210
  v_mfma_f32_16x16x32_bf16 a[76:79], a[164:167], v[188:191], a[76:79]
  v_exp_f32 v216, v128
  v_add_f32 v225, v225, v211
  v_mfma_f32_16x16x32_bf16 a[16:19], a[168:171], v[168:171], a[16:19]
  ds_read_b128 a[136:139], v3 offset:10240
  v_exp_f32 v217, v129
  v_mfma_f32_16x16x32_bf16 a[20:23], a[168:171], v[172:175], a[20:23]
  v_exp_f32 v218, v130
  v_cvt_pk_bf16_f32 v165, v210, v211
  v_mfma_f32_16x16x32_bf16 a[80:83], a[168:171], v[184:187], a[80:83]
  v_exp_f32 v219, v131
  v_add_f32 v225, v225, v212
  v_mfma_f32_16x16x32_bf16 a[84:87], a[168:171], v[188:191], a[84:87]
  v_exp_f32 v220, v132
  v_add_f32 v225, v225, v213
  v_mfma_f32_16x16x32_bf16 a[24:27], a[172:175], v[168:171], a[24:27]
  ds_read_b128 a[140:143], v3 offset:11264
  v_exp_f32 v221, v133
  v_mfma_f32_16x16x32_bf16 a[28:31], a[172:175], v[172:175], a[28:31]
  v_exp_f32 v222, v134
  v_cvt_pk_bf16_f32 v166, v212, v213
  v_mfma_f32_16x16x32_bf16 a[88:91], a[172:175], v[184:187], a[88:91]
  buffer_load_dwordx4 v2, s[48:51], s27 offen offset:2048 sc1 lds
  v_exp_f32 v223, v135
  v_mfma_f32_16x16x32_bf16 a[92:95], a[172:175], v[188:191], a[92:95]
  s_waitcnt lgkmcnt(4)
  v_add_f32 v225, v225, v214
  v_add_f32 v225, v225, v215
  v_cvt_pk_bf16_f32 v167, v214, v215
  v_mfma_f32_16x16x32_bf16 a[32:35], a[176:179], v[168:171], a[32:35]
  ds_read_b128 a[144:147], v3 offset:12288
  v_add_f32 v226, v216, v217
  v_cvt_pk_bf16_f32 v176, v216, v217
  v_mfma_f32_16x16x32_bf16 a[36:39], a[176:179], v[172:175], a[36:39]
  v_exp_f32 v216, v136
  v_add_f32 v226, v226, v218
  v_mfma_f32_16x16x32_bf16 a[96:99], a[176:179], v[184:187], a[96:99]
  v_exp_f32 v217, v137
  v_add_f32 v226, v226, v219
  v_mfma_f32_16x16x32_bf16 a[100:103], a[176:179], v[188:191], a[100:103]
  v_cvt_pk_bf16_f32 v177, v218, v219
  v_add_f32 v226, v226, v220
  v_add_f32 v226, v226, v221
  v_cvt_pk_bf16_f32 v178, v220, v221
  v_mfma_f32_16x16x32_bf16 a[40:43], a[180:183], v[168:171], a[40:43]
  ds_read_b128 a[148:151], v3 offset:13312
  v_add_f32 v226, v226, v222
  v_add_f32 v226, v226, v223
  v_mfma_f32_16x16x32_bf16 a[44:47], a[180:183], v[172:175], a[44:47]
  v_exp_f32 v218, v138
  v_cvt_pk_bf16_f32 v179, v222, v223
  v_mfma_f32_16x16x32_bf16 a[104:107], a[180:183], v[184:187], a[104:107]
  v_exp_f32 v219, v139
  v_add_f32 v227, v216, v217
  v_mfma_f32_16x16x32_bf16 a[108:111], a[180:183], v[188:191], a[108:111]
  v_exp_f32 v220, v140
  v_cvt_pk_bf16_f32 v180, v216, v217
  v_mfma_f32_16x16x32_bf16 a[48:51], a[184:187], v[168:171], a[48:51]
  ds_read_b128 a[152:155], v3 offset:14336
  v_add_f32 v227, v227, v218
  v_add_f32 v227, v227, v219
  v_mfma_f32_16x16x32_bf16 a[52:55], a[184:187], v[172:175], a[52:55]
  v_exp_f32 v221, v141
  v_cvt_pk_bf16_f32 v181, v218, v219
  v_mfma_f32_16x16x32_bf16 a[112:115], a[184:187], v[184:187], a[112:115]
  buffer_load_dwordx4 v2, s[48:51], s27 offen offset:3072 sc1 lds
  v_max3_f32 v5, v224, v225, v226
  v_add_f32 v227, v227, v220
  v_mfma_f32_16x16x32_bf16 a[116:119], a[184:187], v[188:191], a[116:119]
  s_add_u32 s27, s27, 16384
  v_exp_f32 v222, v142
  v_add_f32 v227, v227, v221
  v_mfma_f32_16x16x32_bf16 a[56:59], a[188:191], v[168:171], a[56:59]
  s_add_u32 s25, s25, 32768
  ds_read_b128 a[156:159], v3 offset:15360
  v_cvt_pk_bf16_f32 v182, v220, v221
  v_add_f32 v227, v227, v222
  v_mfma_f32_16x16x32_bf16 a[60:63], a[188:191], v[172:175], a[60:63]
  s_and_b32 s25, s25, 0x1ffff
  v_exp_f32 v223, v143
  v_mfma_f32_16x16x32_bf16 a[120:123], a[188:191], v[184:187], a[120:123]
  s_waitcnt lgkmcnt(4)
  v_add_f32 v227, v227, v223
  v_cvt_pk_bf16_f32 v183, v222, v223
  v_max_f32 v5, v5, v227
  v_cmp_lt_f32 vcc, s81, v5
  v_mfma_f32_16x16x32_bf16 a[124:127], a[188:191], v[188:191], a[124:127]
  s_cbranch_vccnz fa_stub5
fa_back5:
  v_add_f32 v228, v228, v224
  v_add_f32 v229, v229, v225
  v_add_f32 v230, v230, v226
  v_add_f32 v231, v231, v227
  v_add_u32 v3, 32768, v3
  v_and_b32 v3, 0x1ffff, v3
fa_AV:
  v_mfma_f32_16x16x32_bf16 v[128:131], a[128:131], v[64:67], v[200:203]
  s_waitcnt vmcnt(12)
  v_exp_f32 v216, v144
  v_mfma_f32_16x16x32_bf16 v[136:139], a[128:131], v[68:71], v[204:207]
  s_barrier
  v_exp_f32 v217, v145
  v_mfma_f32_16x16x32_bf16 v[132:135], a[132:135], v[64:67], v[200:203]
  ds_read_b128 a[160:163], v3 offset:16384
  ds_read_b128 a[164:167], v3 offset:17408
  v_mfma_f32_16x16x32_bf16 v[140:143], a[132:135], v[68:71], v[204:207]
  v_exp_f32 v218, v146
  v_mfma_f32_16x16x32_bf16 v[128:131], a[136:139], v[72:75], v[128:131]
  ds_read_b128 a[168:171], v3 offset:18432
  v_add_f32 v226, v216, v217
  v_mfma_f32_16x16x32_bf16 v[136:139], a[136:139], v[76:79], v[136:139]
  s_mov_b32 m0, s24
  v_exp_f32 v219, v147
  v_mfma_f32_16x16x32_bf16 v[132:135], a[140:143], v[72:75], v[132:135]
  ds_read_b128 a[172:175], v3 offset:19456
  buffer_load_dwordx4 v2, s[44:47], s26 offen offset:0 sc1 lds
  v_mfma_f32_16x16x32_bf16 v[140:143], a[140:143], v[76:79], v[140:143]
  s_waitcnt lgkmcnt(4)
  v_exp_f32 v220, v148
  v_mfma_f32_16x16x32_bf16 v[128:131], a[144:147], v[80:83], v[128:131]
  ds_read_b128 a[176:179], v3 offset:20480
  v_cvt_pk_bf16_f32 v184, v216, v217
  v_mfma_f32_16x16x32_bf16 v[136:139], a[144:147], v[84:87], v[136:139]
  v_exp_f32 v221, v149
  v_mfma_f32_16x16x32_bf16 v[132:135], a[148:151], v[80:83], v[132:135]
  ds_read_b128 a[180:183], v3 offset:21504
  v_add_f32 v226, v226, v218
  v_mfma_f32_16x16x32_bf16 v[140:143], a[148:151], v[84:87], v[140:143]
  v_exp_f32 v222, v150
  v_mfma_f32_16x16x32_bf16 v[128:131], a[152:155], v[88:91], v[128:131]
  ds_read_b128 a[184:187], v3 offset:22528
  v_add_f32 v226, v226, v219
  v_mfma_f32_16x16x32_bf16 v[136:139], a[152:155], v[92:95], v[136:139]
  v_exp_f32 v223, v151
  v_mfma_f32_16x16x32_bf16 v[132:135], a[156:159], v[88:91], v[132:135]
  ds_read_b128 a[188:191], v3 offset:23552
  v_cvt_pk_bf16_f32 v185, v218, v219
  v_mfma_f32_16x16x32_bf16 v[140:143], a[156:159], v[92:95], v[140:143]
  s_waitcnt lgkmcnt(4)
  v_exp_f32 v216, v152
  v_mfma_f32_16x16x32_bf16 a[0:3], a[160:163], v[160:163], a[0:3]
  ds_read_b128 a[128:131], v3 offset:0
  v_add_f32 v226, v226, v220
  v_mfma_f32_16x16x32_bf16 a[4:7], a[160:163], v[164:167], a[4:7]
  v_exp_f32 v217, v153
  v_mfma_f32_16x16x32_bf16 a[64:67], a[160:163], v[176:179], a[64:67]
  buffer_load_dwordx4 v2, s[44:47], s26 offen offset:1024 sc1 lds
  v_add_f32 v226, v226, v221
  v_mfma_f32_16x16x32_bf16 a[68:71], a[160:163], v[180:183], a[68:71]
  v_exp_f32 v218, v154
  v_mfma_f32_16x16x32_bf16 a[8:11], a[164:167], v[160:163], a[8:11]
  ds_read_b128 a[132:135], v3 offset:1024
  v_cvt_pk_bf16_f32 v186, v220, v221
  v_mfma_f32_16x16x32_bf16 a[12:15], a[164:167], v[164:167], a[12:15]
  v_exp_f32 v219, v155
  v_mfma_f32_16x16x32_bf16 a[72:75], a[164:167], v[176:179], a[72:75]
  v_exp_f32 v220, v156
  v_mfma_f32_16x16x32_bf16 a[76:79], a[164:167], v[180:183], a[76:79]
  v_add_f32 v226, v226, v222
  v_add_f32 v226, v226, v223
  v_mfma_f32_16x16x32_bf16 a[16:19], a[168:171], v[160:163], a[16:19]
  ds_read_b128 a[136:139], v3 offset:2048
  v_cvt_pk_bf16_f32 v187, v222, v223
  v_mfma_f32_16x16x32_bf16 a[20:23], a[168:171], v[164:167], a[20:23]
  v_exp_f32 v221, v157
  v_mfma_f32_16x16x32_bf16 a[80:83], a[168:171], v[176:179], a[80:83]
  v_exp_f32 v222, v158
  v_mfma_f32_16x16x32_bf16 a[84:87], a[168:171], v[180:183], a[84:87]
  v_exp_f32 v223, v159
  v_mfma_f32_16x16x32_bf16 a[24:27], a[172:175], v[160:163], a[24:27]
  ds_read_b128 a[140:143], v3 offset:3072
  v_add_f32 v227, v216, v217
  v_mfma_f32_16x16x32_bf16 a[28:31], a[172:175], v[164:167], a[28:31]
  v_cvt_pk_bf16_f32 v188, v216, v217
  v_add_f32 v227, v227, v218
  v_mfma_f32_16x16x32_bf16 a[88:91], a[172:175], v[176:179], a[88:91]
  buffer_load_dwordx4 v2, s[44:47], s26 offen offset:2048 sc1 lds
  v_add_f32 v227, v227, v219
  v_mfma_f32_16x16x32_bf16 a[92:95], a[172:175], v[180:183], a[92:95]
  s_waitcnt lgkmcnt(4)
  v_cvt_pk_bf16_f32 v189, v218, v219
  v_add_f32 v227, v227, v220
  v_mfma_f32_16x16x32_bf16 a[32:35], a[176:179], v[160:163], a[32:35]
  ds_read_b128 a[144:147], v3 offset:4096
  v_add_f32 v227, v227, v221
  v_mfma_f32_16x16x32_bf16 a[36:39], a[176:179], v[164:167], a[36:39]
  v_cvt_pk_bf16_f32 v190, v220, v221
  v_add_f32 v227, v227, v222
  v_mfma_f32_16x16x32_bf16 a[96:99], a[176:179], v[176:179], a[96:99]
  v_add_f32 v227, v227, v223
  v_cvt_pk_bf16_f32 v191, v222, v223
  v_mfma_f32_16x16x32_bf16 a[100:103], a[176:179], v[180:183], a[100:103]
  v_max_f32 v5, v226, v227
  v_cmp_lt_f32 vcc, s81, v5
  v_mfma_f32_16x16x32_bf16 a[40:43], a[180:183], v[160:163], a[40:43]
  ds_read_b128 a[148:151], v3 offset:5120
  v_mfma_f32_16x16x32_bf16 a[44:47], a[180:183], v[164:167], a[44:47]
  v_mfma_f32_16x16x32_bf16 a[104:107], a[180:183], v[176:179], a[104:107]
  v_mfma_f32_16x16x32_bf16 a[108:111], a[180:183], v[180:183], a[108:111]
  v_mfma_f32_16x16x32_bf16 a[48:51], a[184:187], v[160:163], a[48:51]
  ds_read_b128 a[152:155], v3 offset:6144
  v_mfma_f32_16x16x32_bf16 a[52:55], a[184:187], v[164:167], a[52:55]
  v_mfma_f32_16x16x32_bf16 a[112:115], a[184:187], v[176:179], a[112:115]
  buffer_load_dwordx4 v2, s[44:47], s26 offen offset:3072 sc1 lds
  v_mfma_f32_16x16x32_bf16 a[116:119], a[184:187], v[180:183], a[116:119]
  s_add_u32 s26, s26, 16384
  v_mfma_f32_16x16x32_bf16 a[56:59], a[188:191], v[160:163], a[56:59]
  s_add_u32 s24, s24, 32768
  ds_read_b128 a[156:159], v3 offset:7168
  v_mfma_f32_16x16x32_bf16 a[60:63], a[188:191], v[164:167], a[60:63]
  s_and_b32 s24, s24, 0x1ffff
  v_mfma_f32_16x16x32_bf16 a[120:123], a[188:191], v[176:179], a[120:123]
  s_waitcnt lgkmcnt(4)
  v_mfma_f32_16x16x32_bf16 a[124:127], a[188:191], v[180:183], a[124:127]
  s_cbranch_vccnz fa_stub6
fa_back6:
  v_add_f32 v230, v230, v226
  v_add_f32 v231, v231, v227
  v_mfma_f32_16x16x32_bf16 v[144:147], a[128:131], v[64:67], v[200:203]
  ds_read_b128 a[160:163], v3 offset:24576
  v_exp_f32 v216, v128
  v_mfma_f32_16x16x32_bf16 v[152:155], a[128:131], v[68:71], v[204:207]
  v_exp_f32 v217, v129
  v_mfma_f32_16x16x32_bf16 v[148:151], a[132:135], v[64:67], v[200:203]
  ds_read_b128 a[164:167], v3 offset:25600
  v_add_f32 v226, v216, v217
  v_mfma_f32_16x16x32_bf16 v[156:159], a[132:135], v[68:71], v[204:207]
  s_mov_b32 m0, s25
  v_exp_f32 v218, v130
  v_cvt_pk_bf16_f32 v176, v216, v217
  v_mfma_f32_16x16x32_bf16 v[144:147], a[136:139], v[72:75], v[144:147]
  ds_read_b128 a[168:171], v3 offset:26624
  buffer_load_dwordx4 v2, s[48:51], s27 offen offset:0 sc1 lds
  v_mfma_f32_16x16x32_bf16 v[152:155], a[136:139], v[76:79], v[152:155]
  v_exp_f32 v219, v131
  v_add_f32 v226, v226, v218
  v_mfma_f32_16x16x32_bf16 v[148:151], a[140:143], v[72:75], v[148:151]
  ds_read_b128 a[172:175], v3 offset:27648
  v_add_f32 v226, v226, v219
  v_mfma_f32_16x16x32_bf16 v[156:159], a[140:143], v[76:79], v[156:159]
  s_waitcnt lgkmcnt(4)
  v_exp_f32 v220, v132
  v_cvt_pk_bf16_f32 v177, v218, v219
  v_mfma_f32_16x16x32_bf16 v[144:147], a[144:147], v[80:83], v[144:147]
  ds_read_b128 a[176:179], v3 offset:28672
  v_add_f32 v226, v226, v220
  v_mfma_f32_16x16x32_bf16 v[152:155], a[144:147], v[84:87], v[152:155]
  v_exp_f32 v221, v133
  v_exp_f32 v222, v134
  v_mfma_f32_16x16x32_bf16 v[148:151], a[148:151], v[80:83], v[148:151]
  ds_read_b128 a[180:183], v3 offset:29696
  buffer_load_dwordx4 v2, s[48:51], s27 offen offset:1024 sc1 lds
  v_mfma_f32_16x16x32_bf16 v[156:159], a[148:151], v[84:87], v[156:159]
  v_exp_f32 v223, v135
  v_mfma_f32_16x16x32_bf16 v[144:147], a[152:155], v[88:91], v[144:147]
  ds_read_b128 a[184:187], v3 offset:30720
  v_add_f32 v226, v226, v221
  v_mfma_f32_16x16x32_bf16 v[152:155], a[152:155], v[92:95], v[152:155]
  v_exp_f32 v216, v136
  v_mfma_f32_16x16x32_bf16 v[148:151], a[156:159], v[88:91], v[148:151]
  ds_read_b128 a[188:191], v3 offset:31744
  v_cvt_pk_bf16_f32 v178, v220, v221
  v_add_f32 v226, v226, v222
  v_mfma_f32_16x16x32_bf16 v[156:159], a[156:159], v[92:95], v[156:159]
  s_waitcnt lgkmcnt(4)
  v_exp_f32 v217, v137
  v_mfma_f32_16x16x32_bf16 a[64:67], a[160:163], v[184:187], a[64:67]
  ds_read_b128 a[128:131], v3 offset:8192
  v_add_f32 v226, v226, v223
  v_cvt_pk_bf16_f32 v179, v222, v223
  v_mfma_f32_16x16x32_bf16 a[68:71], a[160:163], v[188:191], a[68:71]
  v_exp_f32 v218, v138
  v_mfma_f32_16x16x32_bf16 a[72:75], a[164:167], v[184:187], a[72:75]
  ds_read_b128 a[132:135], v3 offset:9216
  buffer_load_dwordx4 v2, s[48:51], s27 offen offset:2048 sc1 lds
  v_add_f32 v227, v216, v217
  v_mfma_f32_16x16x32_bf16 a[76:79], a[164:167], v[188:191], a[76:79]
  v_exp_f32 v219, v139
  v_mfma_f32_16x16x32_bf16 a[80:83], a[168:171], v[184:187], a[80:83]
  ds_read_b128 a[136:139], v3 offset:10240
  v_cvt_pk_bf16_f32 v180, v216, v217
  v_mfma_f32_16x16x32_bf16 a[84:87], a[168:171], v[188:191], a[84:87]
  v_exp_f32 v220, v140
  v_add_f32 v227, v227, v218
  v_mfma_f32_16x16x32_bf16 a[88:91], a[172:175], v[184:187], a[88:91]
  ds_read_b128 a[140:143], v3 offset:11264
  v_add_f32 v227, v227, v219
  v_mfma_f32_16x16x32_bf16 a[92:95], a[172:175], v[188:191], a[92:95]
  s_waitcnt lgkmcnt(4)
  v_exp_f32 v221, v141
  v_cvt_pk_bf16_f32 v181, v218, v219
  v_mfma_f32_16x16x32_bf16 a[96:99], a[176:179], v[184:187], a[96:99]
  ds_read_b128 a[144:147], v3 offset:12288
  buffer_load_dwordx4 v2, s[48:51], s27 offen offset:3072 sc1 lds
  v_mfma_f32_16x16x32_bf16 a[100:103], a[176:179], v[188:191], a[100:103]
  s_add_u32 s27, s27, 16384
  v_exp_f32 v222, v142
  v_add_f32 v227, v227, v220
  v_mfma_f32_16x16x32_bf16 a[104:107], a[180:183], v[184:187], a[104:107]
  s_add_u32 s25, s25, 32768
  ds_read_b128 a[148:151], v3 offset:13312
  v_add_f32 v227, v227, v221
  v_mfma_f32_16x16x32_bf16 a[108:111], a[180:183], v[188:191], a[108:111]
  s_and_b32 s25, s25, 0x1ffff
  v_exp_f32 v223, v143
  v_cvt_pk_bf16_f32 v182, v220, v221
  v_mfma_f32_16x16x32_bf16 a[112:115], a[184:187], v[184:187], a[112:115]
  ds_read_b128 a[152:155], v3 offset:14336
  v_add_f32 v227, v227, v222
  v_mfma_f32_16x16x32_bf16 a[116:119], a[184:187], v[188:191], a[116:119]
  v_add_f32 v227, v227, v223
  v_cvt_pk_bf16_f32 v183, v222, v223
  v_max_f32 v5, v226, v227
  v_mfma_f32_16x16x32_bf16 a[120:123], a[188:191], v[184:187], a[120:123]
  s_waitcnt lgkmcnt(3)
  ds_read_b128 a[156:159], v3 offset:15360
  v_cmp_lt_f32 vcc, s81, v5
  v_mfma_f32_16x16x32_bf16 a[124:127], a[188:191], v[188:191], a[124:127]
  s_cbranch_vccnz fa_stub7
fa_back7:
  v_add_f32 v230, v230, v226
  v_add_f32 v231, v231, v227
  v_add_u32 v3, 32768, v3
  v_and_b32 v3, 0x1ffff, v3
  s_branch fa_SSpre
fa_Aodd:
  v_mfma_f32_16x16x32_bf16 v[128:131], a[128:131], v[64:67], v[200:203]
  s_waitcnt vmcnt(12)
  v_cndmask_b32 v112, v4, v112, s[68:69]
  v_cndmask_b32 v113, v4, v113, s[70:71]
  v_cndmask_b32 v114, v4, v114, s[72:73]
  v_mfma_f32_16x16x32_bf16 v[136:139], a[128:131], v[68:71], v[204:207]
  s_barrier
  v_cndmask_b32 v115, v4, v115, s[74:75]
  v_mov_b32 v116, v4
  v_mov_b32 v117, v4
  v_mfma_f32_16x16x32_bf16 v[132:135], a[132:135], v[64:67], v[200:203]
  ds_read_b128 a[160:163], v3 offset:16384
  ds_read_b128 a[164:167], v3 offset:17408
  v_mov_b32 v118, v4
  v_mfma_f32_16x16x32_bf16 v[140:143], a[132:135], v[68:71], v[204:207]
  v_mov_b32 v119, v4
  v_cndmask_b32 v124, v4, v124, s[68:69]
  v_cndmask_b32 v125, v4, v125, s[70:71]
  v_mfma_f32_16x16x32_bf16 v[128:131], a[136:139], v[72:75], v[128:131]
  ds_read_b128 a[168:171], v3 offset:18432
  v_cndmask_b32 v126, v4, v126, s[72:73]
  v_cndmask_b32 v127, v4, v127, s[74:75]
  v_mfma_f32_16x16x32_bf16 v[136:139], a[136:139], v[76:79], v[136:139]
  s_mov_b32 m0, s24
  v_exp_f32 v208, v112
  v_exp_f32 v209, v113
  v_mfma_f32_16x16x32_bf16 v[132:135], a[140:143], v[72:75], v[132:135]
  ds_read_b128 a[172:175], v3 offset:19456
  buffer_load_dwordx4 v2, s[44:47], s26 offen offset:0 sc1 lds
  v_mfma_f32_16x16x32_bf16 v[140:143], a[140:143], v[76:79], v[140:143]
  s_waitcnt lgkmcnt(4)
  v_exp_f32 v210, v114
  v_add_f32 v224, v208, v209
  v_mfma_f32_16x16x32_bf16 v[128:131], a[144:147], v[80:83], v[128:131]
  ds_read_b128 a[176:179], v3 offset:20480
  v_exp_f32 v211, v115
  v_mfma_f32_16x16x32_bf16 v[136:139], a[144:147], v[84:87], v[136:139]
  v_exp_f32 v212, v116
  v_cvt_pk_bf16_f32 v168, v208, v209
  v_mfma_f32_16x16x32_bf16 v[132:135], a[148:151], v[80:83], v[132:135]
  ds_read_b128 a[180:183], v3 offset:21504
  v_exp_f32 v213, v117
  v_mfma_f32_16x16x32_bf16 v[140:143], a[148:151], v[84:87], v[140:143]
  v_exp_f32 v214, v118
  v_add_f32 v224, v224, v210
  v_add_f32 v224, v224, v211
  v_mfma_f32_16x16x32_bf16 v[128:131], a[152:155], v[88:91], v[128:131]
  ds_read_b128 a[184:187], v3 offset:22528
  v_cvt_pk_bf16_f32 v169, v210, v211
  v_add_f32 v224, v224, v212
  v_mfma_f32_16x16x32_bf16 v[136:139], a[152:155], v[92:95], v[136:139]
  v_exp_f32 v215, v119
  v_add_f32 v224, v224, v213
  v_mfma_f32_16x16x32_bf16 v[132:135], a[156:159], v[88:91], v[132:135]
  ds_read_b128 a[188:191], v3 offset:23552
  v_cvt_pk_bf16_f32 v170, v212, v213
  v_add_f32 v224, v224, v214
  v_mfma_f32_16x16x32_bf16 v[140:143], a[156:159], v[92:95], v[140:143]
  s_waitcnt lgkmcnt(4)
  v_exp_f32 v208, v120
  v_add_f32 v224, v224, v215
  v_mfma_f32_16x16x32_bf16 a[0:3], a[160:163], v[160:163], a[0:3]
  ds_read_b128 a[128:131], v3 offset:0
  v_cvt_pk_bf16_f32 v171, v214, v215
  v_exp_f32 v209, v121
  v_mfma_f32_16x16x32_bf16 a[4:7], a[160:163], v[164:167], a[4:7]
  v_exp_f32 v210, v122
  v_mfma_f32_16x16x32_bf16 a[64:67], a[160:163], v[176:179], a[64:67]
  buffer_load_dwordx4 v2, s[44:47], s26 offen offset:1024 sc1 lds
  v_exp_f32 v211, v123
  v_mfma_f32_16x16x32_bf16 a[68:71], a[160:163], v[180:183], a[68:71]
  v_exp_f32 v212, v124
  v_add_f32 v225, v208, v209
  v_mfma_f32_16x16x32_bf16 a[8:11], a[164:167], v[160:163], a[8:11]
  ds_read_b128 a[132:135], v3 offset:1024
  v_exp_f32 v213, v125
  v_mfma_f32_16x16x32_bf16 a[12:15], a[164:167], v[164:167], a[12:15]
  v_exp_f32 v214, v126
  v_cvt_pk_bf16_f32 v172, v208, v209
  v_mfma_f32_16x16x32_bf16 a[72:75], a[164:167], v[176:179], a[72:75]
  v_exp_f32 v215, v127
  v_add_f32 v225, v225, v210
  v_mfma_f32_16x16x32_bf16 a[76:79], a[164:167], v[180:183], a[76:79]
  v_exp_f32 v216, v144
  v_add_f32 v225, v225, v211
  v_mfma_f32_16x16x32_bf16 a[16:19], a[168:171], v[160:163], a[16:19]
  ds_read_b128 a[136:139], v3 offset:2048
  v_exp_f32 v217, v145
  v_mfma_f32_16x16x32_bf16 a[20:23], a[168:171], v[164:167], a[20:23]
  v_exp_f32 v218, v146
  v_cvt_pk_bf16_f32 v173, v210, v211
  v_mfma_f32_16x16x32_bf16 a[80:83], a[168:171], v[176:179], a[80:83]
  v_exp_f32 v219, v147
  v_add_f32 v225, v225, v212
  v_mfma_f32_16x16x32_bf16 a[84:87], a[168:171], v[180:183], a[84:87]
  v_exp_f32 v220, v148
  v_add_f32 v225, v225, v213
  v_mfma_f32_16x16x32_bf16 a[24:27], a[172:175], v[160:163], a[24:27]
  ds_read_b128 a[140:143], v3 offset:3072
  v_exp_f32 v221, v149
  v_mfma_f32_16x16x32_bf16 a[28:31], a[172:175], v[164:167], a[28:31]
  v_exp_f32 v222, v150
  v_cvt_pk_bf16_f32 v174, v212, v213
  v_mfma_f32_16x16x32_bf16 a[88:91], a[172:175], v[176:179], a[88:91]
  buffer_load_dwordx4 v2, s[44:47], s26 offen offset:2048 sc1 lds
  v_exp_f32 v223, v151
  v_mfma_f32_16x16x32_bf16 a[92:95], a[172:175], v[180:183], a[92:95]
  s_waitcnt lgkmcnt(4)
  v_add_f32 v225, v225, v214
  v_add_f32 v225, v225, v215
  v_cvt_pk_bf16_f32 v175, v214, v215
  v_mfma_f32_16x16x32_bf16 a[32:35], a[176:179], v[160:163], a[32:35]
  ds_read_b128 a[144:147], v3 offset:4096
  v_add_f32 v226, v216, v217
  v_cvt_pk_bf16_f32 v184, v216, v217
  v_mfma_f32_16x16x32_bf16 a[36:39], a[176:179], v[164:167], a[36:39]
  v_exp_f32 v216, v152
  v_add_f32 v226, v226, v218
  v_mfma_f32_16x16x32_bf16 a[96:99], a[176:179], v[176:179], a[96:99]
  v_exp_f32 v217, v153
  v_add_f32 v226, v226, v219
  v_mfma_f32_16x16x32_bf16 a[100:103], a[176:179], v[180:183], a[100:103]
  v_cvt_pk_bf16_f32 v185, v218, v219
  v_add_f32 v226, v226, v220
  v_add_f32 v226, v226, v221
  v_cvt_pk_bf16_f32 v186, v220, v221
  v_mfma_f32_16x16x32_bf16 a[40:43], a[180:183], v[160:163], a[40:43]
  ds_read_b128 a[148:151], v3 offset:5120
  v_add_f32 v226, v226, v222
  v_add_f32 v226, v226, v223
  v_mfma_f32_16x16x32_bf16 a[44:47], a[180:183], v[164:167], a[44:47]
  v_exp_f32 v218, v154
  v_cvt_pk_bf16_f32 v187, v222, v223
  v_mfma_f32_16x16x32_bf16 a[104:107], a[180:183], v[176:179], a[104:107]
  v_exp_f32 v219, v155
  v_add_f32 v227, v216, v217
  v_mfma_f32_16x16x32_bf16 a[108:111], a[180:183], v[180:183], a[108:111]
  v_exp_f32 v220, v156
  v_cvt_pk_bf16_f32 v188, v216, v217
  v_mfma_f32_16x16x32_bf16 a[48:51], a[184:187], v[160:163], a[48:51]
  ds_read_b128 a[152:155], v3 offset:6144
  v_add_f32 v227, v227, v218
  v_add_f32 v227, v227, v219
  v_mfma_f32_16x16x32_bf16 a[52:55], a[184:187], v[164:167], a[52:55]
  v_exp_f32 v221, v157
  v_cvt_pk_bf16_f32 v189, v218, v219
  v_mfma_f32_16x16x32_bf16 a[112:115], a[184:187], v[176:179], a[112:115]
  buffer_load_dwordx4 v2, s[44:47], s26 offen offset:3072 sc1 lds
  v_max3_f32 v5, v224, v225, v226
  v_add_f32 v227, v227, v220
  v_mfma_f32_16x16x32_bf16 a[116:119], a[184:187], v[180:183], a[116:119]
  s_add_u32 s26, s26, 16384
  v_exp_f32 v222, v158
  v_add_f32 v227, v227, v221
  v_mfma_f32_16x16x32_bf16 a[56:59], a[188:191], v[160:163], a[56:59]
  s_add_u32 s24, s24, 32768
  ds_read_b128 a[156:159], v3 offset:7168
  v_cvt_pk_bf16_f32 v190, v220, v221
  v_add_f32 v227, v227, v222
  v_mfma_f32_16x16x32_bf16 a[60:63], a[188:191], v[164:167], a[60:63]
  s_and_b32 s24, s24, 0x1ffff
  v_exp_f32 v223, v159
  v_mfma_f32_16x16x32_bf16 a[120:123], a[188:191], v[176:179], a[120:123]
  s_waitcnt lgkmcnt(4)
  v_add_f32 v227, v227, v223
  v_cvt_pk_bf16_f32 v191, v222, v223
  v_max_f32 v5, v5, v227
  v_cmp_lt_f32 vcc, s81, v5
  v_mfma_f32_16x16x32_bf16 a[124:127], a[188:191], v[180:183], a[124:127]
  s_cbranch_vccnz fa_stub8
fa_back8:
  v_add_f32 v228, v228, v224
  v_add_f32 v229, v229, v225
  v_add_f32 v230, v230, v226
  v_add_f32 v231, v231, v227
  v_mfma_f32_16x16x32_bf16 v[144:147], a[128:131], v[64:67], v[200:203]
  ds_read_b128 a[160:163], v3 offset:24576
  v_exp_f32 v216, v128
  v_mfma_f32_16x16x32_bf16 v[152:155], a[128:131], v[68:71], v[204:207]
  v_exp_f32 v217, v129
  v_mfma_f32_16x16x32_bf16 v[148:151], a[132:135], v[64:67], v[200:203]
  ds_read_b128 a[164:167], v3 offset:25600
  v_mfma_f32_16x16x32_bf16 v[156:159], a[132:135], v[68:71], v[204:207]
  v_exp_f32 v218, v130
  v_mfma_f32_16x16x32_bf16 v[144:147], a[136:139], v[72:75], v[144:147]
  ds_read_b128 a[168:171], v3 offset:26624
  v_add_f32 v226, v216, v217
  v_mfma_f32_16x16x32_bf16 v[152:155], a[136:139], v[76:79], v[152:155]
  s_mov_b32 m0, s25
  v_exp_f32 v219, v131
  v_mfma_f32_16x16x32_bf16 v[148:151], a[140:143], v[72:75], v[148:151]
  ds_read_b128 a[172:175], v3 offset:27648
  buffer_load_dwordx4 v2, s[48:51], s27 offen offset:0 sc1 lds
  v_mfma_f32_16x16x32_bf16 v[156:159], a[140:143], v[76:79], v[156:159]
  s_waitcnt lgkmcnt(4)
  v_exp_f32 v220, v132
  v_mfma_f32_16x16x32_bf16 v[144:147], a[144:147], v[80:83], v[144:147]
  ds_read_b128 a[176:179], v3 offset:28672
  v_cvt_pk_bf16_f32 v176, v216, v217
  v_mfma_f32_16x16x32_bf16 v[152:155], a[144:147], v[84:87], v[152:155]
  v_exp_f32 v221, v133
  v_mfma_f32_16x16x32_bf16 v[148:151], a[148:151], v[80:83], v[148:151]
  ds_read_b128 a[180:183], v3 offset:29696
  v_add_f32 v226, v226, v218
  v_mfma_f32_16x16x32_bf16 v[156:159], a[148:151], v[84:87], v[156:159]
  v_exp_f32 v222, v134
  v_mfma_f32_16x16x32_bf16 v[144:147], a[152:155], v[88:91], v[144:147]
  ds_read_b128 a[184:187], v3 offset:30720
  v_add_f32 v226, v226, v219
  v_mfma_f32_16x16x32_bf16 v[152:155], a[152:155], v[92:95], v[152:155]
  v_exp_f32 v223, v135
  v_mfma_f32_16x16x32_bf16 v[148:151], a[156:159], v[88:91], v[148:151]
  ds_read_b128 a[188:191], v3 offset:31744
  v_cvt_pk_bf16_f32 v177, v218, v219
  v_mfma_f32_16x16x32_bf16 v[156:159], a[156:159], v[92:95], v[156:159]
  s_waitcnt lgkmcnt(4)
  v_exp_f32 v216, v136
  v_mfma_f32_16x16x32_bf16 a[0:3], a[160:163], v[168:171], a[0:3]
  ds_read_b128 a[128:131], v3 offset:8192
  v_add_f32 v226, v226, v220
  v_mfma_f32_16x16x32_bf16 a[4:7], a[160:163], v[172:175], a[4:7]
  v_exp_f32 v217, v137
  v_mfma_f32_16x16x32_bf16 a[64:67], a[160:163], v[184:187], a[64:67]
  buffer_load_dwordx4 v2, s[48:51], s27 offen offset:1024 sc1 lds
  v_add_f32 v226, v226, v221
  v_mfma_f32_16x16x32_bf16 a[68:71], a[160:163], v[188:191], a[68:71]
  v_exp_f32 v218, v138
  v_mfma_f32_16x16x32_bf16 a[8:11], a[164:167], v[168:171], a[8:11]
  ds_read_b128 a[132:135], v3 offset:9216
  v_cvt_pk_bf16_f32 v178, v220, v221
  v_mfma_f32_16x16x32_bf16 a[12:15], a[164:167], v[172:175], a[12:15]
  v_exp_f32 v219, v139
  v_mfma_f32_16x16x32_bf16 a[72:75], a[164:167], v[184:187], a[72:75]
  v_exp_f32 v220, v140
  v_mfma_f32_16x16x32_bf16 a[76:79], a[164:167], v[188:191], a[76:79]
  v_add_f32 v226, v226, v222
  v_add_f32 v226, v226, v223
  v_mfma_f32_16x16x32_bf16 a[16:19], a[168:171], v[168:171], a[16:19]
  ds_read_b128 a[136:139], v3 offset:10240
  v_cvt_pk_bf16_f32 v179, v222, v223
  v_mfma_f32_16x16x32_bf16 a[20:23], a[168:171], v[172:175], a[20:23]
  v_exp_f32 v221, v141
  v_mfma_f32_16x16x32_bf16 a[80:83], a[168:171], v[184:187], a[80:83]
  v_exp_f32 v222, v142
  v_mfma_f32_16x16x32_bf16 a[84:87], a[168:171], v[188:191], a[84:87]
  v_exp_f32 v223, v143
  v_mfma_f32_16x16x32_bf16 a[24:27], a[172:175], v[168:171], a[24:27]
  ds_read_b128 a[140:143], v3 offset:11264
  v_add_f32 v227, v216, v217
  v_mfma_f32_16x16x32_bf16 a[28:31], a[172:175], v[172:175], a[28:31]
  v_cvt_pk_bf16_f32 v180, v216, v217
  v_add_f32 v227, v227, v218
  v_mfma_f32_16x16x32_bf16 a[88:91], a[172:175], v[184:187], a[88:91]
  buffer_load_dwordx4 v2, s[48:51], s27 offen offset:2048 sc1 lds
  v_add_f32 v227, v227, v219
  v_mfma_f32_16x16x32_bf16 a[92:95], a[172:175], v[188:191], a[92:95]
  s_waitcnt lgkmcnt(4)
  v_cvt_pk_bf16_f32 v181, v218, v219
  v_add_f32 v227, v227, v220
  v_mfma_f32_16x16x32_bf16 a[32:35], a[176:179], v[168:171], a[32:35]
  ds_read_b128 a[144:147], v3 offset:12288
  v_add_f32 v227, v227, v221
  v_mfma_f32_16x16x32_bf16 a[36:39], a[176:179], v[172:175], a[36:39]
  v_cvt_pk_bf16_f32 v182, v220, v221
  v_add_f32 v227, v227, v222
  v_mfma_f32_16x16x32_bf16 a[96:99], a[176:179], v[184:187], a[96:99]
  v_add_f32 v227, v227, v223
  v_cvt_pk_bf16_f32 v183, v222, v223
  v_mfma_f32_16x16x32_bf16 a[100:103], a[176:179], v[188:191], a[100:103]
  v_max_f32 v5, v226, v227
  v_cmp_lt_f32 vcc, s81, v5
  v_mfma_f32_16x16x32_bf16 a[40:43], a[180:183], v[168:171], a[40:43]
  ds_read_b128 a[148:151], v3 offset:13312
  v_mfma_f32_16x16x32_bf16 a[44:47], a[180:183], v[172:175], a[44:47]
  v_mfma_f32_16x16x32_bf16 a[104:107], a[180:183], v[184:187], a[104:107]
  v_mfma_f32_16x16x32_bf16 a[108:111], a[180:183], v[188:191], a[108:111]
  v_mfma_f32_16x16x32_bf16 a[48:51], a[184:187], v[168:171], a[48:51]
  ds_read_b128 a[152:155], v3 offset:14336
  v_mfma_f32_16x16x32_bf16 a[52:55], a[184:187], v[172:175], a[52:55]
  v_mfma_f32_16x16x32_bf16 a[112:115], a[184:187], v[184:187], a[112:115]
  buffer_load_dwordx4 v2, s[48:51], s27 offen offset:3072 sc1 lds
  v_mfma_f32_16x16x32_bf16 a[116:119], a[184:187], v[188:191], a[116:119]
  s_add_u32 s27, s27, 16384
  v_mfma_f32_16x16x32_bf16 a[56:59], a[188:191], v[168:171], a[56:59]
  s_add_u32 s25, s25, 32768
  ds_read_b128 a[156:159], v3 offset:15360
  v_mfma_f32_16x16x32_bf16 a[60:63], a[188:191], v[172:175], a[60:63]
  s_and_b32 s25, s25, 0x1ffff
  v_mfma_f32_16x16x32_bf16 a[120:123], a[188:191], v[184:187], a[120:123]
  s_waitcnt lgkmcnt(4)
  v_mfma_f32_16x16x32_bf16 a[124:127], a[188:191], v[188:191], a[124:127]
  s_cbranch_vccnz fa_stub9
fa_back9:
  v_add_f32 v230, v230, v226
  v_add_f32 v231, v231, v227
  v_add_u32 v3, 32768, v3
  v_and_b32 v3, 0x1ffff, v3
fa_SSpre:
  s_mov_b32 s11, 1
  s_cmp_lg_u32 s12, 0
  s_cselect_b32 s32, s15, s32
  s_cmp_ge_u32 s20, 2
  s_cselect_b32 s23, 8, 0
  s_cmp_le_u32 s29, s23
  s_cbranch_scc1 fa_chain
.p2align 6
fa_SS:
  v_mfma_f32_16x16x32_bf16 v[128:131], a[128:131], v[64:67], v[200:203]
  s_waitcnt vmcnt(12)
  v_exp_f32 v216, v144
  v_mfma_f32_16x16x32_bf16 v[136:139], a[128:131], v[68:71], v[204:207]
  s_barrier
  v_exp_f32 v217, v145
  v_exp_f32 v218, v146
  v_mfma_f32_16x16x32_bf16 v[132:135], a[132:135], v[64:67], v[200:203]
  s_cmp_ge_u32 s26, s32
  ds_read_b128 a[160:163], v3 offset:16384
  ds_read_b128 a[164:167], v3 offset:17408
  v_mfma_f32_16x16x32_bf16 v[140:143], a[132:135], v[68:71], v[204:207]
  s_cbranch_scc1 fa_hk7
fa_hb7:
  s_mov_b32 m0, s24
  v_exp_f32 v219, v147
  v_mfma_f32_16x16x32_bf16 v[128:131], a[136:139], v[72:75], v[128:131]
  ds_read_b128 a[168:171], v3 offset:18432
  buffer_load_dwordx4 v2, s[44:47], s26 offen offset:0 sc1 lds
  v_mfma_f32_16x16x32_bf16 v[136:139], a[136:139], v[76:79], v[136:139]
  v_exp_f32 v220, v148
  v_add_f32 v226, v216, v217
  v_mfma_f32_16x16x32_bf16 v[132:135], a[140:143], v[72:75], v[132:135]
  ds_read_b128 a[172:175], v3 offset:19456
  v_cvt_pk_bf16_f32 v184, v216, v217
  v_mfma_f32_16x16x32_bf16 v[140:143], a[140:143], v[76:79], v[140:143]
  s_waitcnt lgkmcnt(4)
  v_exp_f32 v221, v149
  v_add_f32 v226, v226, v218
  v_mfma_f32_16x16x32_bf16 v[128:131], a[144:147], v[80:83], v[128:131]
  ds_read_b128 a[176:179], v3 offset:20480
  v_add_f32 v226, v226, v219
  v_mfma_f32_16x16x32_bf16 v[136:139], a[144:147], v[84:87], v[136:139]
  v_exp_f32 v222, v150
  v_cvt_pk_bf16_f32 v185, v218, v219
  v_mfma_f32_16x16x32_bf16 v[132:135], a[148:151], v[80:83], v[132:135]
  ds_read_b128 a[180:183], v3 offset:21504
  buffer_load_dwordx4 v2, s[44:47], s26 offen offset:1024 sc1 lds
  v_mfma_f32_16x16x32_bf16 v[140:143], a[148:151], v[84:87], v[140:143]
  v_exp_f32 v223, v151
  v_mfma_f32_16x16x32_bf16 v[128:131], a[152:155], v[88:91], v[128:131]
  ds_read_b128 a[184:187], v3 offset:22528
  v_add_f32 v226, v226, v220
  v_add_f32 v226, v226, v221
  v_mfma_f32_16x16x32_bf16 v[136:139], a[152:155], v[92:95], v[136:139]
  v_exp_f32 v216, v152
  v_mfma_f32_16x16x32_bf16 v[132:135], a[156:159], v[88:91], v[132:135]
  ds_read_b128 a[188:191], v3 offset:23552
  v_cvt_pk_bf16_f32 v186, v220, v221
  v_add_f32 v226, v226, v222
  v_mfma_f32_16x16x32_bf16 v[140:143], a[156:159], v[92:95], v[140:143]
  s_waitcnt lgkmcnt(4)
  v_exp_f32 v217, v153
  v_mfma_f32_16x16x32_bf16 a[64:67], a[160:163], v[176:179], a[64:67]
  ds_read_b128 a[128:131], v3 offset:0
  v_add_f32 v226, v226, v223
  v_cvt_pk_bf16_f32 v187, v222, v223
  v_mfma_f32_16x16x32_bf16 a[68:71], a[160:163], v[180:183], a[68:71]
  v_exp_f32 v218, v154
  v_mfma_f32_16x16x32_bf16 a[72:75], a[164:167], v[176:179], a[72:75]
  ds_read_b128 a[132:135], v3 offset:1024
  buffer_load_dwordx4 v2, s[44:47], s26 offen offset:2048 sc1 lds
  v_add_f32 v227, v216, v217
  v_mfma_f32_16x16x32_bf16 a[76:79], a[164:167], v[180:183], a[76:79]
  v_exp_f32 v219, v155
  v_mfma_f32_16x16x32_bf16 a[80:83], a[168:171], v[176:179], a[80:83]
  ds_read_b128 a[136:139], v3 offset:2048
  v_cvt_pk_bf16_f32 v188, v216, v217
  v_mfma_f32_16x16x32_bf16 a[84:87], a[168:171], v[180:183], a[84:87]
  v_exp_f32 v220, v156
  v_add_f32 v227, v227, v218
  v_mfma_f32_16x16x32_bf16 a[88:91], a[172:175], v[176:179], a[88:91]
  ds_read_b128 a[140:143], v3 offset:3072
  v_add_f32 v227, v227, v219
  v_mfma_f32_16x16x32_bf16 a[92:95], a[172:175], v[180:183], a[92:95]
  s_waitcnt lgkmcnt(4)
  v_exp_f32 v221, v157
  v_cvt_pk_bf16_f32 v189, v218, v219
  v_mfma_f32_16x16x32_bf16 a[96:99], a[176:179], v[176:179], a[96:99]
  ds_read_b128 a[144:147], v3 offset:4096
  buffer_load_dwordx4 v2, s[44:47], s26 offen offset:3072 sc1 lds
  v_mfma_f32_16x16x32_bf16 a[100:103], a[176:179], v[180:183], a[100:103]
  s_add_u32 s26, s26, 16384
  v_exp_f32 v222, v158
  v_add_f32 v227, v227, v220
  v_mfma_f32_16x16x32_bf16 a[104:107], a[180:183], v[176:179], a[104:107]
  s_add_u32 s24, s24, 32768
  ds_read_b128 a[148:151], v3 offset:5120
  v_add_f32 v227, v227, v221
  v_mfma_f32_16x16x32_bf16 a[108:111], a[180:183], v[180:183], a[108:111]
  s_and_b32 s24, s24, 0x1ffff
  v_exp_f32 v223, v159
  v_cvt_pk_bf16_f32 v190, v220, v221
  v_mfma_f32_16x16x32_bf16 a[112:115], a[184:187], v[176:179], a[112:115]
  ds_read_b128 a[152:155], v3 offset:6144
  v_add_f32 v227, v227, v222
  v_mfma_f32_16x16x32_bf16 a[116:119], a[184:187], v[180:183], a[116:119]
  v_add_f32 v227, v227, v223
  v_cvt_pk_bf16_f32 v191, v222, v223
  v_max_f32 v5, v226, v227
  v_mfma_f32_16x16x32_bf16 a[120:123], a[188:191], v[176:179], a[120:123]
  s_waitcnt lgkmcnt(3)
  ds_read_b128 a[156:159], v3 offset:7168
  v_cmp_lt_f32 vcc, s81, v5
  v_mfma_f32_16x16x32_bf16 a[124:127], a[188:191], v[180:183], a[124:127]
  s_cbranch_vccnz fa_stub10
fa_back10:
  v_add_f32 v230, v230, v226
  v_add_f32 v231, v231, v227
  v_mfma_f32_16x16x32_bf16 v[144:147], a[128:131], v[64:67], v[200:203]
  ds_read_b128 a[160:163], v3 offset:24576
  v_exp_f32 v216, v128
  v_mfma_f32_16x16x32_bf16 v[152:155], a[128:131], v[68:71], v[204:207]
  v_exp_f32 v217, v129
  v_mfma_f32_16x16x32_bf16 v[148:151], a[132:135], v[64:67], v[200:203]
  ds_read_b128 a[164:167], v3 offset:25600
  v_add_f32 v226, v216, v217
  v_mfma_f32_16x16x32_bf16 v[156:159], a[132:135], v[68:71], v[204:207]
  s_mov_b32 m0, s25
  v_exp_f32 v218, v130
  v_cvt_pk_bf16_f32 v176, v216, v217
  v_mfma_f32_16x16x32_bf16 v[144:147], a[136:139], v[72:75], v[144:147]
  ds_read_b128 a[168:171], v3 offset:26624
  buffer_load_dwordx4 v2, s[48:51], s27 offen offset:0 sc1 lds
  v_mfma_f32_16x16x32_bf16 v[152:155], a[136:139], v[76:79], v[152:155]
  v_exp_f32 v219, v131
  v_add_f32 v226, v226, v218
  v_mfma_f32_16x16x32_bf16 v[148:151], a[140:143], v[72:75], v[148:151]
  ds_read_b128 a[172:175], v3 offset:27648
  v_add_f32 v226, v226, v219
  v_mfma_f32_16x16x32_bf16 v[156:159], a[140:143], v[76:79], v[156:159]
  s_waitcnt lgkmcnt(4)
  v_exp_f32 v220, v132
  v_cvt_pk_bf16_f32 v177, v218, v219
  v_mfma_f32_16x16x32_bf16 v[144:147], a[144:147], v[80:83], v[144:147]
  ds_read_b128 a[176:179], v3 offset:28672
  v_add_f32 v226, v226, v220
  v_mfma_f32_16x16x32_bf16 v[152:155], a[144:147], v[84:87], v[152:155]
  v_exp_f32 v221, v133
  v_exp_f32 v222, v134
  v_mfma_f32_16x16x32_bf16 v[148:151], a[148:151], v[80:83], v[148:151]
  ds_read_b128 a[180:183], v3 offset:29696
  buffer_load_dwordx4 v2, s[48:51], s27 offen offset:1024 sc1 lds
  v_mfma_f32_16x16x32_bf16 v[156:159], a[148:151], v[84:87], v[156:159]
  v_exp_f32 v223, v135
  v_mfma_f32_16x16x32_bf16 v[144:147], a[152:155], v[88:91], v[144:147]
  ds_read_b128 a[184:187], v3 offset:30720
  v_add_f32 v226, v226, v221
  v_mfma_f32_16x16x32_bf16 v[152:155], a[152:155], v[92:95], v[152:155]
  v_exp_f32 v216, v136
  v_mfma_f32_16x16x32_bf16 v[148:151], a[156:159], v[88:91], v[148:151]
  ds_read_b128 a[188:191], v3 offset:31744
  v_cvt_pk_bf16_f32 v178, v220, v221
  v_add_f32 v226, v226, v222
  v_mfma_f32_16x16x32_bf16 v[156:159], a[156:159], v[92:95], v[156:159]
  s_waitcnt lgkmcnt(4)
  v_exp_f32 v217, v137
  v_mfma_f32_16x16x32_bf16 a[64:67], a[160:163], v[184:187], a[64:67]
  ds_read_b128 a[128:131], v3 offset:8192
  v_add_f32 v226, v226, v223
  v_cvt_pk_bf16_f32 v179, v222, v223
  v_mfma_f32_16x16x32_bf16 a[68:71], a[160:163], v[188:191], a[68:71]
  v_exp_f32 v218, v138
  v_mfma_f32_16x16x32_bf16 a[72:75], a[164:167], v[184:187], a[72:75]
  ds_read_b128 a[132:135], v3 offset:9216
  buffer_load_dwordx4 v2, s[48:51], s27 offen offset:2048 sc1 lds
  v_add_f32 v227, v216, v217
  v_mfma_f32_16x16x32_bf16 a[76:79], a[164:167], v[188:191], a[76:79]
  v_exp_f32 v219, v139
  v_mfma_f32_16x16x32_bf16 a[80:83], a[168:171], v[184:187], a[80:83]
  ds_read_b128 a[136:139], v3 offset:10240
  v_cvt_pk_bf16_f32 v180, v216, v217
  v_mfma_f32_16x16x32_bf16 a[84:87], a[168:171], v[188:191], a[84:87]
  v_exp_f32 v220, v140
  v_add_f32 v227, v227, v218
  v_mfma_f32_16x16x32_bf16 a[88:91], a[172:175], v[184:187], a[88:91]
  ds_read_b128 a[140:143], v3 offset:11264
  v_add_f32 v227, v227, v219
  v_mfma_f32_16x16x32_bf16 a[92:95], a[172:175], v[188:191], a[92:95]
  s_waitcnt lgkmcnt(4)
  v_exp_f32 v221, v141
  v_cvt_pk_bf16_f32 v181, v218, v219
  v_mfma_f32_16x16x32_bf16 a[96:99], a[176:179], v[184:187], a[96:99]
  ds_read_b128 a[144:147], v3 offset:12288
  buffer_load_dwordx4 v2, s[48:51], s27 offen offset:3072 sc1 lds
  v_mfma_f32_16x16x32_bf16 a[100:103], a[176:179], v[188:191], a[100:103]
  s_add_u32 s27, s27, 16384
  v_exp_f32 v222, v142
  v_add_f32 v227, v227, v220
  v_mfma_f32_16x16x32_bf16 a[104:107], a[180:183], v[184:187], a[104:107]
  s_add_u32 s25, s25, 32768
  ds_read_b128 a[148:151], v3 offset:13312
  v_add_f32 v227, v227, v221
  v_mfma_f32_16x16x32_bf16 a[108:111], a[180:183], v[188:191], a[108:111]
  s_and_b32 s25, s25, 0x1ffff
  v_exp_f32 v223, v143
  v_cvt_pk_bf16_f32 v182, v220, v221
  v_mfma_f32_16x16x32_bf16 a[112:115], a[184:187], v[184:187], a[112:115]
  ds_read_b128 a[152:155], v3 offset:14336
  v_add_f32 v227, v227, v222
  v_mfma_f32_16x16x32_bf16 a[116:119], a[184:187], v[188:191], a[116:119]
  s_sub_u32 s29, s29, 1
  v_add_f32 v227, v227, v223
  v_cvt_pk_bf16_f32 v183, v222, v223
  v_max_f32 v5, v226, v227
  v_mfma_f32_16x16x32_bf16 a[120:123], a[188:191], v[184:187], a[120:123]
  s_waitcnt lgkmcnt(3)
  ds_read_b128 a[156:159], v3 offset:15360
  v_cmp_lt_f32 vcc, s81, v5
  v_mfma_f32_16x16x32_bf16 a[124:127], a[188:191], v[188:191], a[124:127]
  s_cbranch_vccnz fa_stub11
fa_back11:
  v_add_f32 v230, v230, v226
  v_add_f32 v231, v231, v227
  v_add_u32 v3, 32768, v3
  v_and_b32 v3, 0x1ffff, v3
  s_cmp_gt_u32 s29, 8
  s_cbranch_scc1 fa_SS
fa_chain:
fa_hb8:
  s_cmp_lt_u32 s12, 2
  s_cbranch_scc1 fa_hk8
  s_cmp_eq_u32 s29, 8
  s_cbranch_scc0 fa_disp
fa_SSW8:
  v_mfma_f32_16x16x32_bf16 v[128:131], a[128:131], v[64:67], v[200:203]
  s_waitcnt vmcnt(12)
  v_exp_f32 v216, v144
  v_exp_f32 v217, v145
  v_mfma_f32_16x16x32_bf16 v[136:139], a[128:131], v[68:71], v[204:207]
  s_barrier
  v_exp_f32 v218, v146
  v_mfma_f32_16x16x32_bf16 v[132:135], a[132:135], v[64:67], v[200:203]
  ds_read_b128 a[160:163], v3 offset:16384
  ds_read_b128 a[164:167], v3 offset:17408
  v_mfma_f32_16x16x32_bf16 v[140:143], a[132:135], v[68:71], v[204:207]
  s_mov_b32 m0, s24
  v_exp_f32 v219, v147
  v_mfma_f32_16x16x32_bf16 v[128:131], a[136:139], v[72:75], v[128:131]
  ds_read_b128 a[168:171], v3 offset:18432
  buffer_load_dwordx4 v2, s[44:47], s26 offen offset:0 sc1 lds
  v_add_f32 v226, v216, v217
  v_mfma_f32_16x16x32_bf16 v[136:139], a[136:139], v[76:79], v[136:139]
  v_exp_f32 v220, v148
  v_mfma_f32_16x16x32_bf16 v[132:135], a[140:143], v[72:75], v[132:135]
  ds_read_b128 a[172:175], v3 offset:19456
  v_cvt_pk_bf16_f32 v184, v216, v217
  v_add_f32 v226, v226, v218
  v_mfma_f32_16x16x32_bf16 v[140:143], a[140:143], v[76:79], v[140:143]
  s_add_u32 s14, s13, 0
  s_waitcnt lgkmcnt(4)
  buffer_load_dwordx4 a[0:3], v2, s[40:43], s14 offen offset:0 sc1
  v_add_f32 v226, v226, v219
  v_mfma_f32_16x16x32_bf16 v[128:131], a[144:147], v[80:83], v[128:131]
  ds_read_b128 a[176:179], v3 offset:20480
  v_cvt_pk_bf16_f32 v185, v218, v219
  v_add_f32 v226, v226, v220
  v_mfma_f32_16x16x32_bf16 v[136:139], a[144:147], v[84:87], v[136:139]
  v_exp_f32 v221, v149
  v_mfma_f32_16x16x32_bf16 v[132:135], a[148:151], v[80:83], v[132:135]
  ds_read_b128 a[180:183], v3 offset:21504
  buffer_load_dwordx4 v2, s[44:47], s26 offen offset:1024 sc1 lds
  v_add_f32 v226, v226, v221
  v_mfma_f32_16x16x32_bf16 v[140:143], a[148:151], v[84:87], v[140:143]
  v_exp_f32 v222, v150
  v_cvt_pk_bf16_f32 v186, v220, v221
  v_mfma_f32_16x16x32_bf16 v[128:131], a[152:155], v[88:91], v[128:131]
  ds_read_b128 a[184:187], v3 offset:22528
  v_add_f32 v226, v226, v222
  v_mfma_f32_16x16x32_bf16 v[136:139], a[152:155], v[92:95], v[136:139]
  v_exp_f32 v223, v151
  v_exp_f32 v216, v152
  v_mfma_f32_16x16x32_bf16 v[132:135], a[156:159], v[88:91], v[132:135]
  ds_read_b128 a[188:191], v3 offset:23552
  buffer_load_dwordx4 a[4:7], v2, s[40:43], s14 offen offset:1024 sc1
  v_mfma_f32_16x16x32_bf16 v[140:143], a[156:159], v[92:95], v[140:143]
  s_waitcnt lgkmcnt(4)
  v_exp_f32 v217, v153
  v_mfma_f32_16x16x32_bf16 a[64:67], a[160:163], v[176:179], a[64:67]
  ds_read_b128 a[128:131], v3 offset:0
  v_add_f32 v226, v226, v223
  v_mfma_f32_16x16x32_bf16 a[68:71], a[160:163], v[180:183], a[68:71]
  v_exp_f32 v218, v154
  v_cvt_pk_bf16_f32 v187, v222, v223
  v_mfma_f32_16x16x32_bf16 a[72:75], a[164:167], v[176:179], a[72:75]
  ds_read_b128 a[132:135], v3 offset:1024
  buffer_load_dwordx4 v2, s[44:47], s26 offen offset:2048 sc1 lds
  v_mfma_f32_16x16x32_bf16 a[76:79], a[164:167], v[180:183], a[76:79]
  v_exp_f32 v219, v155
  v_add_f32 v227, v216, v217
  v_mfma_f32_16x16x32_bf16 a[80:83], a[168:171], v[176:179], a[80:83]
  ds_read_b128 a[136:139], v3 offset:2048
  v_cvt_pk_bf16_f32 v188, v216, v217
  v_add_f32 v227, v227, v218
  v_mfma_f32_16x16x32_bf16 a[84:87], a[168:171], v[180:183], a[84:87]
  buffer_load_dwordx4 a[8:11], v2, s[40:43], s14 offen offset:2048 sc1
  v_add_f32 v227, v227, v219
  v_mfma_f32_16x16x32_bf16 a[88:91], a[172:175], v[176:179], a[88:91]
  ds_read_b128 a[140:143], v3 offset:3072
  v_cvt_pk_bf16_f32 v189, v218, v219
  v_exp_f32 v220, v156
  v_mfma_f32_16x16x32_bf16 a[92:95], a[172:175], v[180:183], a[92:95]
  s_waitcnt lgkmcnt(4)
  v_exp_f32 v221, v157
  v_mfma_f32_16x16x32_bf16 a[96:99], a[176:179], v[176:179], a[96:99]
  ds_read_b128 a[144:147], v3 offset:4096
  buffer_load_dwordx4 v2, s[44:47], s26 offen offset:3072 sc1 lds
  v_mfma_f32_16x16x32_bf16 a[100:103], a[176:179], v[180:183], a[100:103]
  s_add_u32 s26, s26, 16384
  v_exp_f32 v222, v158
  v_mfma_f32_16x16x32_bf16 a[104:107], a[180:183], v[176:179], a[104:107]
  s_add_u32 s24, s24, 32768
  ds_read_b128 a[148:151], v3 offset:5120
  v_add_f32 v227, v227, v220
  v_add_f32 v227, v227, v221
  v_mfma_f32_16x16x32_bf16 a[108:111], a[180:183], v[180:183], a[108:111]
  s_and_b32 s24, s24, 0x1ffff
  v_exp_f32 v223, v159
  v_mfma_f32_16x16x32_bf16 a[112:115], a[184:187], v[176:179], a[112:115]
  ds_read_b128 a[152:155], v3 offset:6144
  v_cvt_pk_bf16_f32 v190, v220, v221
  v_add_f32 v227, v227, v222
  v_mfma_f32_16x16x32_bf16 a[116:119], a[184:187], v[180:183], a[116:119]
  v_add_f32 v227, v227, v223
  v_cvt_pk_bf16_f32 v191, v222, v223
  v_mfma_f32_16x16x32_bf16 a[120:123], a[188:191], v[176:179], a[120:123]
  s_waitcnt lgkmcnt(3)
  ds_read_b128 a[156:159], v3 offset:7168
  v_max_f32 v5, v226, v227
  v_cmp_lt_f32 vcc, s81, v5
  v_mfma_f32_16x16x32_bf16 a[124:127], a[188:191], v[180:183], a[124:127]
  s_cbranch_vccnz fa_stub12
fa_back12:
  v_add_f32 v230, v230, v226
  v_add_f32 v231, v231, v227
  v_mfma_f32_16x16x32_bf16 v[144:147], a[128:131], v[64:67], v[200:203]
  ds_read_b128 a[160:163], v3 offset:24576
  v_exp_f32 v216, v128
  v_mfma_f32_16x16x32_bf16 v[152:155], a[128:131], v[68:71], v[204:207]
  v_exp_f32 v217, v129
  v_mfma_f32_16x16x32_bf16 v[148:151], a[132:135], v[64:67], v[200:203]
  ds_read_b128 a[164:167], v3 offset:25600
  v_add_f32 v226, v216, v217
  v_cvt_pk_bf16_f32 v176, v216, v217
  v_mfma_f32_16x16x32_bf16 v[156:159], a[132:135], v[68:71], v[204:207]
  s_mov_b32 m0, s25
  v_exp_f32 v218, v130
  v_mfma_f32_16x16x32_bf16 v[144:147], a[136:139], v[72:75], v[144:147]
  ds_read_b128 a[168:171], v3 offset:26624
  buffer_load_dwordx4 v2, s[48:51], s27 offen offset:0 sc1 lds
  v_add_f32 v226, v226, v218
  v_mfma_f32_16x16x32_bf16 v[152:155], a[136:139], v[76:79], v[152:155]
  v_exp_f32 v219, v131
  v_mfma_f32_16x16x32_bf16 v[148:151], a[140:143], v[72:75], v[148:151]
  ds_read_b128 a[172:175], v3 offset:27648
  v_add_f32 v226, v226, v219
  v_cvt_pk_bf16_f32 v177, v218, v219
  v_mfma_f32_16x16x32_bf16 v[156:159], a[140:143], v[76:79], v[156:159]
  s_add_u32 s14, s13, 0
  s_waitcnt lgkmcnt(4)
  buffer_load_dwordx4 a[12:15], v2, s[40:43], s14 offen offset:3072 sc1
  v_exp_f32 v220, v132
  v_mfma_f32_16x16x32_bf16 v[144:147], a[144:147], v[80:83], v[144:147]
  ds_read_b128 a[176:179], v3 offset:28672
  v_add_f32 v226, v226, v220
  v_mfma_f32_16x16x32_bf16 v[152:155], a[144:147], v[84:87], v[152:155]
  v_exp_f32 v221, v133
  v_mfma_f32_16x16x32_bf16 v[148:151], a[148:151], v[80:83], v[148:151]
  ds_read_b128 a[180:183], v3 offset:29696
  buffer_load_dwordx4 v2, s[48:51], s27 offen offset:1024 sc1 lds
  v_add_f32 v226, v226, v221
  v_mfma_f32_16x16x32_bf16 v[156:159], a[148:151], v[84:87], v[156:159]
  v_exp_f32 v222, v134
  v_cvt_pk_bf16_f32 v178, v220, v221
  v_mfma_f32_16x16x32_bf16 v[144:147], a[152:155], v[88:91], v[144:147]
  ds_read_b128 a[184:187], v3 offset:30720
  v_add_f32 v226, v226, v222
  v_mfma_f32_16x16x32_bf16 v[152:155], a[152:155], v[92:95], v[152:155]
  v_exp_f32 v223, v135
  v_exp_f32 v216, v136
  v_mfma_f32_16x16x32_bf16 v[148:151], a[156:159], v[88:91], v[148:151]
  s_add_u32 s14, s13, 4096
  ds_read_b128 a[188:191], v3 offset:31744
  buffer_load_dwordx4 a[16:19], v2, s[40:43], s14 offen offset:0 sc1
  v_mfma_f32_16x16x32_bf16 v[156:159], a[156:159], v[92:95], v[156:159]
  s_waitcnt lgkmcnt(4)
  v_exp_f32 v217, v137
  v_mfma_f32_16x16x32_bf16 a[64:67], a[160:163], v[184:187], a[64:67]
  ds_read_b128 a[128:131], v3 offset:8192
  v_add_f32 v226, v226, v223
  v_mfma_f32_16x16x32_bf16 a[68:71], a[160:163], v[188:191], a[68:71]
  v_exp_f32 v218, v138
  v_cvt_pk_bf16_f32 v179, v222, v223
  v_mfma_f32_16x16x32_bf16 a[72:75], a[164:167], v[184:187], a[72:75]
  ds_read_b128 a[132:135], v3 offset:9216
  buffer_load_dwordx4 v2, s[48:51], s27 offen offset:2048 sc1 lds
  v_mfma_f32_16x16x32_bf16 a[76:79], a[164:167], v[188:191], a[76:79]
  v_exp_f32 v219, v139
  v_add_f32 v227, v216, v217
  v_mfma_f32_16x16x32_bf16 a[80:83], a[168:171], v[184:187], a[80:83]
  ds_read_b128 a[136:139], v3 offset:10240
  v_cvt_pk_bf16_f32 v180, v216, v217
  v_add_f32 v227, v227, v218
  v_mfma_f32_16x16x32_bf16 a[84:87], a[168:171], v[188:191], a[84:87]
  buffer_load_dwordx4 a[20:23], v2, s[40:43], s14 offen offset:1024 sc1
  v_add_f32 v227, v227, v219
  v_mfma_f32_16x16x32_bf16 a[88:91], a[172:175], v[184:187], a[88:91]
  ds_read_b128 a[140:143], v3 offset:11264
  v_cvt_pk_bf16_f32 v181, v218, v219
  v_exp_f32 v220, v140
  v_mfma_f32_16x16x32_bf16 a[92:95], a[172:175], v[188:191], a[92:95]
  s_waitcnt lgkmcnt(4)
  v_exp_f32 v221, v141
  v_mfma_f32_16x16x32_bf16 a[96:99], a[176:179], v[184:187], a[96:99]
  ds_read_b128 a[144:147], v3 offset:12288
  buffer_load_dwordx4 v2, s[48:51], s27 offen offset:3072 sc1 lds
  v_mfma_f32_16x16x32_bf16 a[100:103], a[176:179], v[188:191], a[100:103]
  s_add_u32 s27, s27, 16384
  v_exp_f32 v222, v142
  v_mfma_f32_16x16x32_bf16 a[104:107], a[180:183], v[184:187], a[104:107]
  s_add_u32 s25, s25, 32768
  ds_read_b128 a[148:151], v3 offset:13312
  v_add_f32 v227, v227, v220
  v_add_f32 v227, v227, v221
  v_mfma_f32_16x16x32_bf16 a[108:111], a[180:183], v[188:191], a[108:111]
  s_and_b32 s25, s25, 0x1ffff
  v_exp_f32 v223, v143
  v_mfma_f32_16x16x32_bf16 a[112:115], a[184:187], v[184:187], a[112:115]
  ds_read_b128 a[152:155], v3 offset:14336
  v_cvt_pk_bf16_f32 v182, v220, v221
  v_add_f32 v227, v227, v222
  v_mfma_f32_16x16x32_bf16 a[116:119], a[184:187], v[188:191], a[116:119]
  v_add_f32 v227, v227, v223
  v_cvt_pk_bf16_f32 v183, v222, v223
  v_mfma_f32_16x16x32_bf16 a[120:123], a[188:191], v[184:187], a[120:123]
  s_waitcnt lgkmcnt(3)
  ds_read_b128 a[156:159], v3 offset:15360
  v_max_f32 v5, v226, v227
  v_cmp_lt_f32 vcc, s81, v5
  v_mfma_f32_16x16x32_bf16 a[124:127], a[188:191], v[188:191], a[124:127]
  s_cbranch_vccnz fa_stub13
fa_back13:
  v_add_f32 v230, v230, v226
  v_add_f32 v231, v231, v227
  v_add_u32 v3, 32768, v3
  v_and_b32 v3, 0x1ffff, v3
fa_SSW7:
  v_mfma_f32_16x16x32_bf16 v[128:131], a[128:131], v[64:67], v[200:203]
  s_waitcnt vmcnt(12)
  v_exp_f32 v216, v144
  v_exp_f32 v217, v145
  v_mfma_f32_16x16x32_bf16 v[136:139], a[128:131], v[68:71], v[204:207]
  s_barrier
  v_exp_f32 v218, v146
  v_mfma_f32_16x16x32_bf16 v[132:135], a[132:135], v[64:67], v[200:203]
  ds_read_b128 a[160:163], v3 offset:16384
  ds_read_b128 a[164:167], v3 offset:17408
  v_mfma_f32_16x16x32_bf16 v[140:143], a[132:135], v[68:71], v[204:207]
  s_mov_b32 m0, s24
  v_exp_f32 v219, v147
  v_mfma_f32_16x16x32_bf16 v[128:131], a[136:139], v[72:75], v[128:131]
  ds_read_b128 a[168:171], v3 offset:18432
  buffer_load_dwordx4 v2, s[44:47], s26 offen offset:0 sc1 lds
  v_add_f32 v226, v216, v217
  v_mfma_f32_16x16x32_bf16 v[136:139], a[136:139], v[76:79], v[136:139]
  v_exp_f32 v220, v148
  v_mfma_f32_16x16x32_bf16 v[132:135], a[140:143], v[72:75], v[132:135]
  ds_read_b128 a[172:175], v3 offset:19456
  v_cvt_pk_bf16_f32 v184, v216, v217
  v_add_f32 v226, v226, v218
  v_mfma_f32_16x16x32_bf16 v[140:143], a[140:143], v[76:79], v[140:143]
  s_add_u32 s14, s13, 4096
  s_waitcnt lgkmcnt(4)
  buffer_load_dwordx4 a[24:27], v2, s[40:43], s14 offen offset:2048 sc1
  v_add_f32 v226, v226, v219
  v_mfma_f32_16x16x32_bf16 v[128:131], a[144:147], v[80:83], v[128:131]
  ds_read_b128 a[176:179], v3 offset:20480
  v_cvt_pk_bf16_f32 v185, v218, v219
  v_add_f32 v226, v226, v220
  v_mfma_f32_16x16x32_bf16 v[136:139], a[144:147], v[84:87], v[136:139]
  v_exp_f32 v221, v149
  v_mfma_f32_16x16x32_bf16 v[132:135], a[148:151], v[80:83], v[132:135]
  ds_read_b128 a[180:183], v3 offset:21504
  buffer_load_dwordx4 v2, s[44:47], s26 offen offset:1024 sc1 lds
  v_add_f32 v226, v226, v221
  v_mfma_f32_16x16x32_bf16 v[140:143], a[148:151], v[84:87], v[140:143]
  v_exp_f32 v222, v150
  v_cvt_pk_bf16_f32 v186, v220, v221
  v_mfma_f32_16x16x32_bf16 v[128:131], a[152:155], v[88:91], v[128:131]
  ds_read_b128 a[184:187], v3 offset:22528
  v_add_f32 v226, v226, v222
  v_mfma_f32_16x16x32_bf16 v[136:139], a[152:155], v[92:95], v[136:139]
  v_exp_f32 v223, v151
  v_exp_f32 v216, v152
  v_mfma_f32_16x16x32_bf16 v[132:135], a[156:159], v[88:91], v[132:135]
  ds_read_b128 a[188:191], v3 offset:23552
  buffer_load_dwordx4 a[28:31], v2, s[40:43], s14 offen offset:3072 sc1
  v_mfma_f32_16x16x32_bf16 v[140:143], a[156:159], v[92:95], v[140:143]
  s_waitcnt lgkmcnt(4)
  v_exp_f32 v217, v153
  v_mfma_f32_16x16x32_bf16 a[64:67], a[160:163], v[176:179], a[64:67]
  ds_read_b128 a[128:131], v3 offset:0
  v_add_f32 v226, v226, v223
  v_mfma_f32_16x16x32_bf16 a[68:71], a[160:163], v[180:183], a[68:71]
  v_exp_f32 v218, v154
  v_cvt_pk_bf16_f32 v187, v222, v223
  v_mfma_f32_16x16x32_bf16 a[72:75], a[164:167], v[176:179], a[72:75]
  ds_read_b128 a[132:135], v3 offset:1024
  buffer_load_dwordx4 v2, s[44:47], s26 offen offset:2048 sc1 lds
  v_mfma_f32_16x16x32_bf16 a[76:79], a[164:167], v[180:183], a[76:79]
  v_exp_f32 v219, v155
  v_add_f32 v227, v216, v217
  v_mfma_f32_16x16x32_bf16 a[80:83], a[168:171], v[176:179], a[80:83]
  ds_read_b128 a[136:139], v3 offset:2048
  v_cvt_pk_bf16_f32 v188, v216, v217
  v_add_f32 v227, v227, v218
  v_mfma_f32_16x16x32_bf16 a[84:87], a[168:171], v[180:183], a[84:87]
  s_add_u32 s14, s13, 8192
  buffer_load_dwordx4 a[32:35], v2, s[40:43], s14 offen offset:0 sc1
  v_add_f32 v227, v227, v219
  v_mfma_f32_16x16x32_bf16 a[88:91], a[172:175], v[176:179], a[88:91]
  ds_read_b128 a[140:143], v3 offset:3072
  v_cvt_pk_bf16_f32 v189, v218, v219
  v_exp_f32 v220, v156
  v_mfma_f32_16x16x32_bf16 a[92:95], a[172:175], v[180:183], a[92:95]
  s_waitcnt lgkmcnt(4)
  v_exp_f32 v221, v157
  v_mfma_f32_16x16x32_bf16 a[96:99], a[176:179], v[176:179], a[96:99]
  ds_read_b128 a[144:147], v3 offset:4096
  buffer_load_dwordx4 v2, s[44:47], s26 offen offset:3072 sc1 lds
  v_mfma_f32_16x16x32_bf16 a[100:103], a[176:179], v[180:183], a[100:103]
  s_add_u32 s26, s26, 16384
  v_exp_f32 v222, v158
  v_mfma_f32_16x16x32_bf16 a[104:107], a[180:183], v[176:179], a[104:107]
  s_add_u32 s24, s24, 32768
  ds_read_b128 a[148:151], v3 offset:5120
  v_add_f32 v227, v227, v220
  v_add_f32 v227, v227, v221
  v_mfma_f32_16x16x32_bf16 a[108:111], a[180:183], v[180:183], a[108:111]
  s_and_b32 s24, s24, 0x1ffff
  v_exp_f32 v223, v159
  v_mfma_f32_16x16x32_bf16 a[112:115], a[184:187], v[176:179], a[112:115]
  ds_read_b128 a[152:155], v3 offset:6144
  v_cvt_pk_bf16_f32 v190, v220, v221
  v_add_f32 v227, v227, v222
  v_mfma_f32_16x16x32_bf16 a[116:119], a[184:187], v[180:183], a[116:119]
  v_add_f32 v227, v227, v223
  v_cvt_pk_bf16_f32 v191, v222, v223
  v_mfma_f32_16x16x32_bf16 a[120:123], a[188:191], v[176:179], a[120:123]
  s_waitcnt lgkmcnt(3)
  ds_read_b128 a[156:159], v3 offset:7168
  v_max_f32 v5, v226, v227
  v_cmp_lt_f32 vcc, s81, v5
  v_mfma_f32_16x16x32_bf16 a[124:127], a[188:191], v[180:183], a[124:127]
  s_cbranch_vccnz fa_stub14
fa_back14:
  v_add_f32 v230, v230, v226
  v_add_f32 v231, v231, v227
  v_mfma_f32_16x16x32_bf16 v[144:147], a[128:131], v[64:67], v[200:203]
  ds_read_b128 a[160:163], v3 offset:24576
  v_exp_f32 v216, v128
  v_mfma_f32_16x16x32_bf16 v[152:155], a[128:131], v[68:71], v[204:207]
  v_exp_f32 v217, v129
  v_mfma_f32_16x16x32_bf16 v[148:151], a[132:135], v[64:67], v[200:203]
  ds_read_b128 a[164:167], v3 offset:25600
  v_add_f32 v226, v216, v217
  v_cvt_pk_bf16_f32 v176, v216, v217
  v_mfma_f32_16x16x32_bf16 v[156:159], a[132:135], v[68:71], v[204:207]
  s_mov_b32 m0, s25
  v_exp_f32 v218, v130
  v_mfma_f32_16x16x32_bf16 v[144:147], a[136:139], v[72:75], v[144:147]
  ds_read_b128 a[168:171], v3 offset:26624
  buffer_load_dwordx4 v2, s[48:51], s27 offen offset:0 sc1 lds
  v_add_f32 v226, v226, v218
  v_mfma_f32_16x16x32_bf16 v[152:155], a[136:139], v[76:79], v[152:155]
  v_exp_f32 v219, v131
  v_mfma_f32_16x16x32_bf16 v[148:151], a[140:143], v[72:75], v[148:151]
  ds_read_b128 a[172:175], v3 offset:27648
  v_add_f32 v226, v226, v219
  v_cvt_pk_bf16_f32 v177, v218, v219
  v_mfma_f32_16x16x32_bf16 v[156:159], a[140:143], v[76:79], v[156:159]
  s_add_u32 s14, s13, 8192
  s_waitcnt lgkmcnt(4)
  buffer_load_dwordx4 a[36:39], v2, s[40:43], s14 offen offset:1024 sc1
  v_exp_f32 v220, v132
  v_mfma_f32_16x16x32_bf16 v[144:147], a[144:147], v[80:83], v[144:147]
  ds_read_b128 a[176:179], v3 offset:28672
  v_add_f32 v226, v226, v220
  v_mfma_f32_16x16x32_bf16 v[152:155], a[144:147], v[84:87], v[152:155]
  v_exp_f32 v221, v133
  v_mfma_f32_16x16x32_bf16 v[148:151], a[148:151], v[80:83], v[148:151]
  ds_read_b128 a[180:183], v3 offset:29696
  buffer_load_dwordx4 v2, s[48:51], s27 offen offset:1024 sc1 lds
  v_add_f32 v226, v226, v221
  v_mfma_f32_16x16x32_bf16 v[156:159], a[148:151], v[84:87], v[156:159]
  v_exp_f32 v222, v134
  v_cvt_pk_bf16_f32 v178, v220, v221
  v_mfma_f32_16x16x32_bf16 v[144:147], a[152:155], v[88:91], v[144:147]
  ds_read_b128 a[184:187], v3 offset:30720
  v_add_f32 v226, v226, v222
  v_mfma_f32_16x16x32_bf16 v[152:155], a[152:155], v[92:95], v[152:155]
  v_exp_f32 v223, v135
  v_exp_f32 v216, v136
  v_mfma_f32_16x16x32_bf16 v[148:151], a[156:159], v[88:91], v[148:151]
  ds_read_b128 a[188:191], v3 offset:31744
  buffer_load_dwordx4 a[40:43], v2, s[40:43], s14 offen offset:2048 sc1
  v_mfma_f32_16x16x32_bf16 v[156:159], a[156:159], v[92:95], v[156:159]
  s_waitcnt lgkmcnt(4)
  v_exp_f32 v217, v137
  v_mfma_f32_16x16x32_bf16 a[64:67], a[160:163], v[184:187], a[64:67]
  ds_read_b128 a[128:131], v3 offset:8192
  v_add_f32 v226, v226, v223
  v_mfma_f32_16x16x32_bf16 a[68:71], a[160:163], v[188:191], a[68:71]
  v_exp_f32 v218, v138
  v_cvt_pk_bf16_f32 v179, v222, v223
  v_mfma_f32_16x16x32_bf16 a[72:75], a[164:167], v[184:187], a[72:75]
  ds_read_b128 a[132:135], v3 offset:9216
  buffer_load_dwordx4 v2, s[48:51], s27 offen offset:2048 sc1 lds
  v_mfma_f32_16x16x32_bf16 a[76:79], a[164:167], v[188:191], a[76:79]
  v_exp_f32 v219, v139
  v_add_f32 v227, v216, v217
  v_mfma_f32_16x16x32_bf16 a[80:83], a[168:171], v[184:187], a[80:83]
  ds_read_b128 a[136:139], v3 offset:10240
  v_cvt_pk_bf16_f32 v180, v216, v217
  v_add_f32 v227, v227, v218
  v_mfma_f32_16x16x32_bf16 a[84:87], a[168:171], v[188:191], a[84:87]
  buffer_load_dwordx4 a[44:47], v2, s[40:43], s14 offen offset:3072 sc1
  v_add_f32 v227, v227, v219
  v_mfma_f32_16x16x32_bf16 a[88:91], a[172:175], v[184:187], a[88:91]
  ds_read_b128 a[140:143], v3 offset:11264
  v_cvt_pk_bf16_f32 v181, v218, v219
  v_exp_f32 v220, v140
  v_mfma_f32_16x16x32_bf16 a[92:95], a[172:175], v[188:191], a[92:95]
  s_waitcnt lgkmcnt(4)
  v_exp_f32 v221, v141
  v_mfma_f32_16x16x32_bf16 a[96:99], a[176:179], v[184:187], a[96:99]
  ds_read_b128 a[144:147], v3 offset:12288
  buffer_load_dwordx4 v2, s[48:51], s27 offen offset:3072 sc1 lds
  v_mfma_f32_16x16x32_bf16 a[100:103], a[176:179], v[188:191], a[100:103]
  s_add_u32 s27, s27, 16384
  v_exp_f32 v222, v142
  v_mfma_f32_16x16x32_bf16 a[104:107], a[180:183], v[184:187], a[104:107]
  s_add_u32 s25, s25, 32768
  ds_read_b128 a[148:151], v3 offset:13312
  v_add_f32 v227, v227, v220
  v_add_f32 v227, v227, v221
  v_mfma_f32_16x16x32_bf16 a[108:111], a[180:183], v[188:191], a[108:111]
  s_and_b32 s25, s25, 0x1ffff
  v_exp_f32 v223, v143
  v_mfma_f32_16x16x32_bf16 a[112:115], a[184:187], v[184:187], a[112:115]
  ds_read_b128 a[152:155], v3 offset:14336
  v_cvt_pk_bf16_f32 v182, v220, v221
  v_add_f32 v227, v227, v222
  v_mfma_f32_16x16x32_bf16 a[116:119], a[184:187], v[188:191], a[116:119]
  v_add_f32 v227, v227, v223
  v_cvt_pk_bf16_f32 v183, v222, v223
  v_mfma_f32_16x16x32_bf16 a[120:123], a[188:191], v[184:187], a[120:123]
  s_waitcnt lgkmcnt(3)
  ds_read_b128 a[156:159], v3 offset:15360
  v_max_f32 v5, v226, v227
  v_cmp_lt_f32 vcc, s81, v5
  v_mfma_f32_16x16x32_bf16 a[124:127], a[188:191], v[188:191], a[124:127]
  s_cbranch_vccnz fa_stub15
fa_back15:
  v_add_f32 v230, v230, v226
  v_add_f32 v231, v231, v227
  v_add_u32 v3, 32768, v3
  v_and_b32 v3, 0x1ffff, v3
fa_SSW6:
  v_mfma_f32_16x16x32_bf16 v[128:131], a[128:131], v[64:67], v[200:203]
  s_waitcnt vmcnt(12)
  v_exp_f32 v216, v144
  v_exp_f32 v217, v145
  v_mfma_f32_16x16x32_bf16 v[136:139], a[128:131], v[68:71], v[204:207]
  s_barrier
  v_exp_f32 v218, v146
  v_mfma_f32_16x16x32_bf16 v[132:135], a[132:135], v[64:67], v[200:203]
  ds_read_b128 a[160:163], v3 offset:16384
  ds_read_b128 a[164:167], v3 offset:17408
  v_mfma_f32_16x16x32_bf16 v[140:143], a[132:135], v[68:71], v[204:207]
  s_mov_b32 m0, s24
  v_exp_f32 v219, v147
  v_mfma_f32_16x16x32_bf16 v[128:131], a[136:139], v[72:75], v[128:131]
  ds_read_b128 a[168:171], v3 offset:18432
  buffer_load_dwordx4 v2, s[44:47], s26 offen offset:0 sc1 lds
  v_add_f32 v226, v216, v217
  v_mfma_f32_16x16x32_bf16 v[136:139], a[136:139], v[76:79], v[136:139]
  v_exp_f32 v220, v148
  v_mfma_f32_16x16x32_bf16 v[132:135], a[140:143], v[72:75], v[132:135]
  ds_read_b128 a[172:175], v3 offset:19456
  v_cvt_pk_bf16_f32 v184, v216, v217
  v_add_f32 v226, v226, v218
  v_mfma_f32_16x16x32_bf16 v[140:143], a[140:143], v[76:79], v[140:143]
  s_add_u32 s14, s13, 12288
  s_waitcnt lgkmcnt(4)
  buffer_load_dwordx4 a[48:51], v2, s[40:43], s14 offen offset:0 sc1
  v_add_f32 v226, v226, v219
  v_mfma_f32_16x16x32_bf16 v[128:131], a[144:147], v[80:83], v[128:131]
  ds_read_b128 a[176:179], v3 offset:20480
  v_cvt_pk_bf16_f32 v185, v218, v219
  v_add_f32 v226, v226, v220
  v_mfma_f32_16x16x32_bf16 v[136:139], a[144:147], v[84:87], v[136:139]
  v_exp_f32 v221, v149
  v_mfma_f32_16x16x32_bf16 v[132:135], a[148:151], v[80:83], v[132:135]
  ds_read_b128 a[180:183], v3 offset:21504
  buffer_load_dwordx4 v2, s[44:47], s26 offen offset:1024 sc1 lds
  v_add_f32 v226, v226, v221
  v_mfma_f32_16x16x32_bf16 v[140:143], a[148:151], v[84:87], v[140:143]
  v_exp_f32 v222, v150
  v_cvt_pk_bf16_f32 v186, v220, v221
  v_mfma_f32_16x16x32_bf16 v[128:131], a[152:155], v[88:91], v[128:131]
  ds_read_b128 a[184:187], v3 offset:22528
  v_add_f32 v226, v226, v222
  v_mfma_f32_16x16x32_bf16 v[136:139], a[152:155], v[92:95], v[136:139]
  v_exp_f32 v223, v151
  v_exp_f32 v216, v152
  v_mfma_f32_16x16x32_bf16 v[132:135], a[156:159], v[88:91], v[132:135]
  ds_read_b128 a[188:191], v3 offset:23552
  buffer_load_dwordx4 a[52:55], v2, s[40:43], s14 offen offset:1024 sc1
  v_mfma_f32_16x16x32_bf16 v[140:143], a[156:159], v[92:95], v[140:143]
  s_waitcnt lgkmcnt(4)
  v_exp_f32 v217, v153
  v_mfma_f32_16x16x32_bf16 a[64:67], a[160:163], v[176:179], a[64:67]
  ds_read_b128 a[128:131], v3 offset:0
  v_add_f32 v226, v226, v223
  v_mfma_f32_16x16x32_bf16 a[68:71], a[160:163], v[180:183], a[68:71]
  v_exp_f32 v218, v154
  v_cvt_pk_bf16_f32 v187, v222, v223
  v_mfma_f32_16x16x32_bf16 a[72:75], a[164:167], v[176:179], a[72:75]
  ds_read_b128 a[132:135], v3 offset:1024
  buffer_load_dwordx4 v2, s[44:47], s26 offen offset:2048 sc1 lds
  v_mfma_f32_16x16x32_bf16 a[76:79], a[164:167], v[180:183], a[76:79]
  v_exp_f32 v219, v155
  v_add_f32 v227, v216, v217
  v_mfma_f32_16x16x32_bf16 a[80:83], a[168:171], v[176:179], a[80:83]
  ds_read_b128 a[136:139], v3 offset:2048
  v_cvt_pk_bf16_f32 v188, v216, v217
  v_add_f32 v227, v227, v218
  v_mfma_f32_16x16x32_bf16 a[84:87], a[168:171], v[180:183], a[84:87]
  buffer_load_dwordx4 a[56:59], v2, s[40:43], s14 offen offset:2048 sc1
  v_add_f32 v227, v227, v219
  v_mfma_f32_16x16x32_bf16 a[88:91], a[172:175], v[176:179], a[88:91]
  ds_read_b128 a[140:143], v3 offset:3072
  v_cvt_pk_bf16_f32 v189, v218, v219
  v_exp_f32 v220, v156
  v_mfma_f32_16x16x32_bf16 a[92:95], a[172:175], v[180:183], a[92:95]
  s_waitcnt lgkmcnt(4)
  v_exp_f32 v221, v157
  v_mfma_f32_16x16x32_bf16 a[96:99], a[176:179], v[176:179], a[96:99]
  ds_read_b128 a[144:147], v3 offset:4096
  buffer_load_dwordx4 v2, s[44:47], s26 offen offset:3072 sc1 lds
  v_mfma_f32_16x16x32_bf16 a[100:103], a[176:179], v[180:183], a[100:103]
  s_add_u32 s26, s26, 16384
  v_exp_f32 v222, v158
  v_mfma_f32_16x16x32_bf16 a[104:107], a[180:183], v[176:179], a[104:107]
  s_add_u32 s24, s24, 32768
  ds_read_b128 a[148:151], v3 offset:5120
  v_add_f32 v227, v227, v220
  v_add_f32 v227, v227, v221
  v_mfma_f32_16x16x32_bf16 a[108:111], a[180:183], v[180:183], a[108:111]
  s_and_b32 s24, s24, 0x1ffff
  v_exp_f32 v223, v159
  v_mfma_f32_16x16x32_bf16 a[112:115], a[184:187], v[176:179], a[112:115]
  ds_read_b128 a[152:155], v3 offset:6144
  v_cvt_pk_bf16_f32 v190, v220, v221
  v_add_f32 v227, v227, v222
  v_mfma_f32_16x16x32_bf16 a[116:119], a[184:187], v[180:183], a[116:119]
  v_add_f32 v227, v227, v223
  v_cvt_pk_bf16_f32 v191, v222, v223
  v_mfma_f32_16x16x32_bf16 a[120:123], a[188:191], v[176:179], a[120:123]
  s_waitcnt lgkmcnt(3)
  ds_read_b128 a[156:159], v3 offset:7168
  v_max_f32 v5, v226, v227
  v_cmp_lt_f32 vcc, s81, v5
  v_mfma_f32_16x16x32_bf16 a[124:127], a[188:191], v[180:183], a[124:127]
  s_cbranch_vccnz fa_stub16
fa_back16:
  v_add_f32 v230, v230, v226
  v_add_f32 v231, v231, v227
  v_mfma_f32_16x16x32_bf16 v[144:147], a[128:131], v[64:67], v[200:203]
  ds_read_b128 a[160:163], v3 offset:24576
  v_exp_f32 v216, v128
  v_mfma_f32_16x16x32_bf16 v[152:155], a[128:131], v[68:71], v[204:207]
  v_exp_f32 v217, v129
  v_mfma_f32_16x16x32_bf16 v[148:151], a[132:135], v[64:67], v[200:203]
  ds_read_b128 a[164:167], v3 offset:25600
  v_add_f32 v226, v216, v217
  v_cvt_pk_bf16_f32 v176, v216, v217
  v_mfma_f32_16x16x32_bf16 v[156:159], a[132:135], v[68:71], v[204:207]
  s_mov_b32 m0, s25
  v_exp_f32 v218, v130
  v_mfma_f32_16x16x32_bf16 v[144:147], a[136:139], v[72:75], v[144:147]
  ds_read_b128 a[168:171], v3 offset:26624
  buffer_load_dwordx4 v2, s[48:51], s27 offen offset:0 sc1 lds
  v_add_f32 v226, v226, v218
  v_mfma_f32_16x16x32_bf16 v[152:155], a[136:139], v[76:79], v[152:155]
  v_exp_f32 v219, v131
  v_mfma_f32_16x16x32_bf16 v[148:151], a[140:143], v[72:75], v[148:151]
  ds_read_b128 a[172:175], v3 offset:27648
  v_add_f32 v226, v226, v219
  v_cvt_pk_bf16_f32 v177, v218, v219
  v_mfma_f32_16x16x32_bf16 v[156:159], a[140:143], v[76:79], v[156:159]
  s_add_u32 s14, s13, 12288
  s_waitcnt lgkmcnt(4)
  buffer_load_dwordx4 a[60:63], v2, s[40:43], s14 offen offset:3072 sc1
  v_exp_f32 v220, v132
  v_mfma_f32_16x16x32_bf16 v[144:147], a[144:147], v[80:83], v[144:147]
  ds_read_b128 a[176:179], v3 offset:28672
  v_add_f32 v226, v226, v220
  v_mfma_f32_16x16x32_bf16 v[152:155], a[144:147], v[84:87], v[152:155]
  v_exp_f32 v221, v133
  v_mfma_f32_16x16x32_bf16 v[148:151], a[148:151], v[80:83], v[148:151]
  ds_read_b128 a[180:183], v3 offset:29696
  buffer_load_dwordx4 v2, s[48:51], s27 offen offset:1024 sc1 lds
  v_add_f32 v226, v226, v221
  v_mfma_f32_16x16x32_bf16 v[156:159], a[148:151], v[84:87], v[156:159]
  v_exp_f32 v222, v134
  v_cvt_pk_bf16_f32 v178, v220, v221
  v_mfma_f32_16x16x32_bf16 v[144:147], a[152:155], v[88:91], v[144:147]
  ds_read_b128 a[184:187], v3 offset:30720
  v_add_f32 v226, v226, v222
  v_mfma_f32_16x16x32_bf16 v[152:155], a[152:155], v[92:95], v[152:155]
  v_exp_f32 v223, v135
  v_exp_f32 v216, v136
  v_mfma_f32_16x16x32_bf16 v[148:151], a[156:159], v[88:91], v[148:151]
  s_add_u32 s14, s13, 16384
  ds_read_b128 a[188:191], v3 offset:31744
  buffer_load_dwordx4 a[192:195], v2, s[40:43], s14 offen offset:0 sc1
  v_mfma_f32_16x16x32_bf16 v[156:159], a[156:159], v[92:95], v[156:159]
  s_waitcnt lgkmcnt(4)
  v_exp_f32 v217, v137
  v_mfma_f32_16x16x32_bf16 a[64:67], a[160:163], v[184:187], a[64:67]
  ds_read_b128 a[128:131], v3 offset:8192
  v_add_f32 v226, v226, v223
  v_mfma_f32_16x16x32_bf16 a[68:71], a[160:163], v[188:191], a[68:71]
  v_exp_f32 v218, v138
  v_cvt_pk_bf16_f32 v179, v222, v223
  v_mfma_f32_16x16x32_bf16 a[72:75], a[164:167], v[184:187], a[72:75]
  ds_read_b128 a[132:135], v3 offset:9216
  buffer_load_dwordx4 v2, s[48:51], s27 offen offset:2048 sc1 lds
  v_mfma_f32_16x16x32_bf16 a[76:79], a[164:167], v[188:191], a[76:79]
  v_exp_f32 v219, v139
  v_add_f32 v227, v216, v217
  v_mfma_f32_16x16x32_bf16 a[80:83], a[168:171], v[184:187], a[80:83]
  ds_read_b128 a[136:139], v3 offset:10240
  v_cvt_pk_bf16_f32 v180, v216, v217
  v_add_f32 v227, v227, v218
  v_mfma_f32_16x16x32_bf16 a[84:87], a[168:171], v[188:191], a[84:87]
  buffer_load_dwordx4 a[196:199], v2, s[40:43], s14 offen offset:1024 sc1
  v_add_f32 v227, v227, v219
  v_mfma_f32_16x16x32_bf16 a[88:91], a[172:175], v[184:187], a[88:91]
  ds_read_b128 a[140:143], v3 offset:11264
  v_cvt_pk_bf16_f32 v181, v218, v219
  v_exp_f32 v220, v140
  v_mfma_f32_16x16x32_bf16 a[92:95], a[172:175], v[188:191], a[92:95]
  s_waitcnt lgkmcnt(4)
  v_exp_f32 v221, v141
  v_mfma_f32_16x16x32_bf16 a[96:99], a[176:179], v[184:187], a[96:99]
  ds_read_b128 a[144:147], v3 offset:12288
  buffer_load_dwordx4 v2, s[48:51], s27 offen offset:3072 sc1 lds
  v_mfma_f32_16x16x32_bf16 a[100:103], a[176:179], v[188:191], a[100:103]
  s_add_u32 s27, s27, 16384
  v_exp_f32 v222, v142
  v_mfma_f32_16x16x32_bf16 a[104:107], a[180:183], v[184:187], a[104:107]
  s_add_u32 s25, s25, 32768
  ds_read_b128 a[148:151], v3 offset:13312
  v_add_f32 v227, v227, v220
  v_add_f32 v227, v227, v221
  v_mfma_f32_16x16x32_bf16 a[108:111], a[180:183], v[188:191], a[108:111]
  s_and_b32 s25, s25, 0x1ffff
  v_exp_f32 v223, v143
  v_mfma_f32_16x16x32_bf16 a[112:115], a[184:187], v[184:187], a[112:115]
  ds_read_b128 a[152:155], v3 offset:14336
  v_cvt_pk_bf16_f32 v182, v220, v221
  v_add_f32 v227, v227, v222
  v_mfma_f32_16x16x32_bf16 a[116:119], a[184:187], v[188:191], a[116:119]
  v_add_f32 v227, v227, v223
  v_cvt_pk_bf16_f32 v183, v222, v223
  v_mfma_f32_16x16x32_bf16 a[120:123], a[188:191], v[184:187], a[120:123]
  s_waitcnt lgkmcnt(3)
  ds_read_b128 a[156:159], v3 offset:15360
  v_max_f32 v5, v226, v227
  v_cmp_lt_f32 vcc, s81, v5
  v_mfma_f32_16x16x32_bf16 a[124:127], a[188:191], v[188:191], a[124:127]
  s_cbranch_vccnz fa_stub17
fa_back17:
  v_add_f32 v230, v230, v226
  v_add_f32 v231, v231, v227
  v_add_u32 v3, 32768, v3
  v_and_b32 v3, 0x1ffff, v3
fa_SSW5:
  v_mfma_f32_16x16x32_bf16 v[128:131], a[128:131], v[64:67], v[200:203]
  s_waitcnt vmcnt(12)
  v_exp_f32 v216, v144
  v_exp_f32 v217, v145
  v_mfma_f32_16x16x32_bf16 v[136:139], a[128:131], v[68:71], v[204:207]
  s_barrier
  v_exp_f32 v218, v146
  v_mfma_f32_16x16x32_bf16 v[132:135], a[132:135], v[64:67], v[200:203]
  ds_read_b128 a[160:163], v3 offset:16384
  ds_read_b128 a[164:167], v3 offset:17408
  v_mfma_f32_16x16x32_bf16 v[140:143], a[132:135], v[68:71], v[204:207]
  s_mov_b32 m0, s24
  v_exp_f32 v219, v147
  v_mfma_f32_16x16x32_bf16 v[128:131], a[136:139], v[72:75], v[128:131]
  ds_read_b128 a[168:171], v3 offset:18432
  buffer_load_dwordx4 v2, s[44:47], s26 offen offset:0 sc1 lds
  v_add_f32 v226, v216, v217
  v_mfma_f32_16x16x32_bf16 v[136:139], a[136:139], v[76:79], v[136:139]
  v_exp_f32 v220, v148
  v_mfma_f32_16x16x32_bf16 v[132:135], a[140:143], v[72:75], v[132:135]
  ds_read_b128 a[172:175], v3 offset:19456
  v_cvt_pk_bf16_f32 v184, v216, v217
  v_add_f32 v226, v226, v218
  v_mfma_f32_16x16x32_bf16 v[140:143], a[140:143], v[76:79], v[140:143]
  s_add_u32 s14, s13, 16384
  s_waitcnt lgkmcnt(4)
  buffer_load_dwordx4 a[200:203], v2, s[40:43], s14 offen offset:2048 sc1
  v_add_f32 v226, v226, v219
  v_mfma_f32_16x16x32_bf16 v[128:131], a[144:147], v[80:83], v[128:131]
  ds_read_b128 a[176:179], v3 offset:20480
  v_cvt_pk_bf16_f32 v185, v218, v219
  v_add_f32 v226, v226, v220
  v_mfma_f32_16x16x32_bf16 v[136:139], a[144:147], v[84:87], v[136:139]
  v_exp_f32 v221, v149
  v_mfma_f32_16x16x32_bf16 v[132:135], a[148:151], v[80:83], v[132:135]
  ds_read_b128 a[180:183], v3 offset:21504
  buffer_load_dwordx4 v2, s[44:47], s26 offen offset:1024 sc1 lds
  v_add_f32 v226, v226, v221
  v_mfma_f32_16x16x32_bf16 v[140:143], a[148:151], v[84:87], v[140:143]
  v_exp_f32 v222, v150
  v_cvt_pk_bf16_f32 v186, v220, v221
  v_mfma_f32_16x16x32_bf16 v[128:131], a[152:155], v[88:91], v[128:131]
  ds_read_b128 a[184:187], v3 offset:22528
  v_add_f32 v226, v226, v222
  v_mfma_f32_16x16x32_bf16 v[136:139], a[152:155], v[92:95], v[136:139]
  v_exp_f32 v223, v151
  v_exp_f32 v216, v152
  v_mfma_f32_16x16x32_bf16 v[132:135], a[156:159], v[88:91], v[132:135]
  ds_read_b128 a[188:191], v3 offset:23552
  buffer_load_dwordx4 a[204:207], v2, s[40:43], s14 offen offset:3072 sc1
  v_mfma_f32_16x16x32_bf16 v[140:143], a[156:159], v[92:95], v[140:143]
  s_waitcnt lgkmcnt(4)
  v_exp_f32 v217, v153
  v_mfma_f32_16x16x32_bf16 a[64:67], a[160:163], v[176:179], a[64:67]
  ds_read_b128 a[128:131], v3 offset:0
  v_add_f32 v226, v226, v223
  v_mfma_f32_16x16x32_bf16 a[68:71], a[160:163], v[180:183], a[68:71]
  v_exp_f32 v218, v154
  v_cvt_pk_bf16_f32 v187, v222, v223
  v_mfma_f32_16x16x32_bf16 a[72:75], a[164:167], v[176:179], a[72:75]
  ds_read_b128 a[132:135], v3 offset:1024
  buffer_load_dwordx4 v2, s[44:47], s26 offen offset:2048 sc1 lds
  v_mfma_f32_16x16x32_bf16 a[76:79], a[164:167], v[180:183], a[76:79]
  v_exp_f32 v219, v155
  v_add_f32 v227, v216, v217
  v_mfma_f32_16x16x32_bf16 a[80:83], a[168:171], v[176:179], a[80:83]
  ds_read_b128 a[136:139], v3 offset:2048
  v_cvt_pk_bf16_f32 v188, v216, v217
  v_add_f32 v227, v227, v218
  v_mfma_f32_16x16x32_bf16 a[84:87], a[168:171], v[180:183], a[84:87]
  s_add_u32 s14, s13, 20480
  buffer_load_dwordx4 a[208:211], v2, s[40:43], s14 offen offset:0 sc1
  v_add_f32 v227, v227, v219
  v_mfma_f32_16x16x32_bf16 a[88:91], a[172:175], v[176:179], a[88:91]
  ds_read_b128 a[140:143], v3 offset:3072
  v_cvt_pk_bf16_f32 v189, v218, v219
  v_exp_f32 v220, v156
  v_mfma_f32_16x16x32_bf16 a[92:95], a[172:175], v[180:183], a[92:95]
  s_waitcnt lgkmcnt(4)
  v_exp_f32 v221, v157
  v_mfma_f32_16x16x32_bf16 a[96:99], a[176:179], v[176:179], a[96:99]
  ds_read_b128 a[144:147], v3 offset:4096
  buffer_load_dwordx4 v2, s[44:47], s26 offen offset:3072 sc1 lds
  v_mfma_f32_16x16x32_bf16 a[100:103], a[176:179], v[180:183], a[100:103]
  s_add_u32 s26, s26, 16384
  v_exp_f32 v222, v158
  v_mfma_f32_16x16x32_bf16 a[104:107], a[180:183], v[176:179], a[104:107]
  s_add_u32 s24, s24, 32768
  ds_read_b128 a[148:151], v3 offset:5120
  v_add_f32 v227, v227, v220
  v_add_f32 v227, v227, v221
  v_mfma_f32_16x16x32_bf16 a[108:111], a[180:183], v[180:183], a[108:111]
  s_and_b32 s24, s24, 0x1ffff
  v_exp_f32 v223, v159
  v_mfma_f32_16x16x32_bf16 a[112:115], a[184:187], v[176:179], a[112:115]
  ds_read_b128 a[152:155], v3 offset:6144
  v_cvt_pk_bf16_f32 v190, v220, v221
  v_add_f32 v227, v227, v222
  v_mfma_f32_16x16x32_bf16 a[116:119], a[184:187], v[180:183], a[116:119]
  v_add_f32 v227, v227, v223
  v_cvt_pk_bf16_f32 v191, v222, v223
  v_mfma_f32_16x16x32_bf16 a[120:123], a[188:191], v[176:179], a[120:123]
  s_waitcnt lgkmcnt(3)
  ds_read_b128 a[156:159], v3 offset:7168
  v_max_f32 v5, v226, v227
  v_cmp_lt_f32 vcc, s81, v5
  v_mfma_f32_16x16x32_bf16 a[124:127], a[188:191], v[180:183], a[124:127]
  s_cbranch_vccnz fa_stub18
fa_back18:
  v_add_f32 v230, v230, v226
  v_add_f32 v231, v231, v227
  v_mfma_f32_16x16x32_bf16 v[144:147], a[128:131], v[64:67], v[200:203]
  ds_read_b128 a[160:163], v3 offset:24576
  v_exp_f32 v216, v128
  v_mfma_f32_16x16x32_bf16 v[152:155], a[128:131], v[68:71], v[204:207]
  v_exp_f32 v217, v129
  v_mfma_f32_16x16x32_bf16 v[148:151], a[132:135], v[64:67], v[200:203]
  ds_read_b128 a[164:167], v3 offset:25600
  v_add_f32 v226, v216, v217
  v_cvt_pk_bf16_f32 v176, v216, v217
  v_mfma_f32_16x16x32_bf16 v[156:159], a[132:135], v[68:71], v[204:207]
  s_mov_b32 m0, s25
  v_exp_f32 v218, v130
  v_mfma_f32_16x16x32_bf16 v[144:147], a[136:139], v[72:75], v[144:147]
  ds_read_b128 a[168:171], v3 offset:26624
  buffer_load_dwordx4 v2, s[48:51], s27 offen offset:0 sc1 lds
  v_add_f32 v226, v226, v218
  v_mfma_f32_16x16x32_bf16 v[152:155], a[136:139], v[76:79], v[152:155]
  v_exp_f32 v219, v131
  v_mfma_f32_16x16x32_bf16 v[148:151], a[140:143], v[72:75], v[148:151]
  ds_read_b128 a[172:175], v3 offset:27648
  v_add_f32 v226, v226, v219
  v_cvt_pk_bf16_f32 v177, v218, v219
  v_mfma_f32_16x16x32_bf16 v[156:159], a[140:143], v[76:79], v[156:159]
  s_add_u32 s14, s13, 20480
  s_waitcnt lgkmcnt(4)
  buffer_load_dwordx4 a[212:215], v2, s[40:43], s14 offen offset:1024 sc1
  v_exp_f32 v220, v132
  v_mfma_f32_16x16x32_bf16 v[144:147], a[144:147], v[80:83], v[144:147]
  ds_read_b128 a[176:179], v3 offset:28672
  v_add_f32 v226, v226, v220
  v_mfma_f32_16x16x32_bf16 v[152:155], a[144:147], v[84:87], v[152:155]
  v_exp_f32 v221, v133
  v_mfma_f32_16x16x32_bf16 v[148:151], a[148:151], v[80:83], v[148:151]
  ds_read_b128 a[180:183], v3 offset:29696
  buffer_load_dwordx4 v2, s[48:51], s27 offen offset:1024 sc1 lds
  v_add_f32 v226, v226, v221
  v_mfma_f32_16x16x32_bf16 v[156:159], a[148:151], v[84:87], v[156:159]
  v_exp_f32 v222, v134
  v_cvt_pk_bf16_f32 v178, v220, v221
  v_mfma_f32_16x16x32_bf16 v[144:147], a[152:155], v[88:91], v[144:147]
  ds_read_b128 a[184:187], v3 offset:30720
  v_add_f32 v226, v226, v222
  v_mfma_f32_16x16x32_bf16 v[152:155], a[152:155], v[92:95], v[152:155]
  v_exp_f32 v223, v135
  v_exp_f32 v216, v136
  v_mfma_f32_16x16x32_bf16 v[148:151], a[156:159], v[88:91], v[148:151]
  ds_read_b128 a[188:191], v3 offset:31744
  buffer_load_dwordx4 a[216:219], v2, s[40:43], s14 offen offset:2048 sc1
  v_mfma_f32_16x16x32_bf16 v[156:159], a[156:159], v[92:95], v[156:159]
  s_waitcnt lgkmcnt(4)
  v_exp_f32 v217, v137
  v_mfma_f32_16x16x32_bf16 a[64:67], a[160:163], v[184:187], a[64:67]
  ds_read_b128 a[128:131], v3 offset:8192
  v_add_f32 v226, v226, v223
  v_mfma_f32_16x16x32_bf16 a[68:71], a[160:163], v[188:191], a[68:71]
  v_exp_f32 v218, v138
  v_cvt_pk_bf16_f32 v179, v222, v223
  v_mfma_f32_16x16x32_bf16 a[72:75], a[164:167], v[184:187], a[72:75]
  ds_read_b128 a[132:135], v3 offset:9216
  buffer_load_dwordx4 v2, s[48:51], s27 offen offset:2048 sc1 lds
  v_mfma_f32_16x16x32_bf16 a[76:79], a[164:167], v[188:191], a[76:79]
  v_exp_f32 v219, v139
  v_add_f32 v227, v216, v217
  v_mfma_f32_16x16x32_bf16 a[80:83], a[168:171], v[184:187], a[80:83]
  ds_read_b128 a[136:139], v3 offset:10240
  v_cvt_pk_bf16_f32 v180, v216, v217
  v_add_f32 v227, v227, v218
  v_mfma_f32_16x16x32_bf16 a[84:87], a[168:171], v[188:191], a[84:87]
  buffer_load_dwordx4 a[220:223], v2, s[40:43], s14 offen offset:3072 sc1
  v_add_f32 v227, v227, v219
  v_mfma_f32_16x16x32_bf16 a[88:91], a[172:175], v[184:187], a[88:91]
  ds_read_b128 a[140:143], v3 offset:11264
  v_cvt_pk_bf16_f32 v181, v218, v219
  v_exp_f32 v220, v140
  v_mfma_f32_16x16x32_bf16 a[92:95], a[172:175], v[188:191], a[92:95]
  s_waitcnt lgkmcnt(4)
  v_exp_f32 v221, v141
  v_mfma_f32_16x16x32_bf16 a[96:99], a[176:179], v[184:187], a[96:99]
  ds_read_b128 a[144:147], v3 offset:12288
  buffer_load_dwordx4 v2, s[48:51], s27 offen offset:3072 sc1 lds
  v_mfma_f32_16x16x32_bf16 a[100:103], a[176:179], v[188:191], a[100:103]
  s_add_u32 s27, s27, 16384
  v_exp_f32 v222, v142
  v_mfma_f32_16x16x32_bf16 a[104:107], a[180:183], v[184:187], a[104:107]
  s_add_u32 s25, s25, 32768
  ds_read_b128 a[148:151], v3 offset:13312
  v_add_f32 v227, v227, v220
  v_add_f32 v227, v227, v221
  v_mfma_f32_16x16x32_bf16 a[108:111], a[180:183], v[188:191], a[108:111]
  s_and_b32 s25, s25, 0x1ffff
  v_exp_f32 v223, v143
  v_mfma_f32_16x16x32_bf16 a[112:115], a[184:187], v[184:187], a[112:115]
  ds_read_b128 a[152:155], v3 offset:14336
  v_cvt_pk_bf16_f32 v182, v220, v221
  v_add_f32 v227, v227, v222
  v_mfma_f32_16x16x32_bf16 a[116:119], a[184:187], v[188:191], a[116:119]
  v_add_f32 v227, v227, v223
  v_cvt_pk_bf16_f32 v183, v222, v223
  v_mfma_f32_16x16x32_bf16 a[120:123], a[188:191], v[184:187], a[120:123]
  s_waitcnt lgkmcnt(3)
  ds_read_b128 a[156:159], v3 offset:15360
  v_max_f32 v5, v226, v227
  v_cmp_lt_f32 vcc, s81, v5
  v_mfma_f32_16x16x32_bf16 a[124:127], a[188:191], v[188:191], a[124:127]
  s_cbranch_vccnz fa_stub19
fa_back19:
  v_add_f32 v230, v230, v226
  v_add_f32 v231, v231, v227
  v_add_u32 v3, 32768, v3
  v_and_b32 v3, 0x1ffff, v3
fa_SSW4:
  v_mfma_f32_16x16x32_bf16 v[128:131], a[128:131], v[64:67], v[200:203]
  s_waitcnt vmcnt(12)
  v_exp_f32 v216, v144
  v_exp_f32 v217, v145
  v_mfma_f32_16x16x32_bf16 v[136:139], a[128:131], v[68:71], v[204:207]
  s_barrier
  v_exp_f32 v218, v146
  v_mfma_f32_16x16x32_bf16 v[132:135], a[132:135], v[64:67], v[200:203]
  ds_read_b128 a[160:163], v3 offset:16384
  ds_read_b128 a[164:167], v3 offset:17408
  v_mfma_f32_16x16x32_bf16 v[140:143], a[132:135], v[68:71], v[204:207]
  s_mov_b32 m0, s24
  v_exp_f32 v219, v147
  v_mfma_f32_16x16x32_bf16 v[128:131], a[136:139], v[72:75], v[128:131]
  ds_read_b128 a[168:171], v3 offset:18432
  buffer_load_dwordx4 v2, s[44:47], s26 offen offset:0 sc1 lds
  v_add_f32 v226, v216, v217
  v_mfma_f32_16x16x32_bf16 v[136:139], a[136:139], v[76:79], v[136:139]
  v_exp_f32 v220, v148
  v_mfma_f32_16x16x32_bf16 v[132:135], a[140:143], v[72:75], v[132:135]
  ds_read_b128 a[172:175], v3 offset:19456
  v_cvt_pk_bf16_f32 v184, v216, v217
  v_add_f32 v226, v226, v218
  v_mfma_f32_16x16x32_bf16 v[140:143], a[140:143], v[76:79], v[140:143]
  s_add_u32 s14, s13, 24576
  s_waitcnt lgkmcnt(4)
  buffer_load_dwordx4 a[224:227], v2, s[40:43], s14 offen offset:0 sc1
  v_add_f32 v226, v226, v219
  v_mfma_f32_16x16x32_bf16 v[128:131], a[144:147], v[80:83], v[128:131]
  ds_read_b128 a[176:179], v3 offset:20480
  v_cvt_pk_bf16_f32 v185, v218, v219
  v_add_f32 v226, v226, v220
  v_mfma_f32_16x16x32_bf16 v[136:139], a[144:147], v[84:87], v[136:139]
  v_exp_f32 v221, v149
  v_mfma_f32_16x16x32_bf16 v[132:135], a[148:151], v[80:83], v[132:135]
  ds_read_b128 a[180:183], v3 offset:21504
  buffer_load_dwordx4 v2, s[44:47], s26 offen offset:1024 sc1 lds
  v_add_f32 v226, v226, v221
  v_mfma_f32_16x16x32_bf16 v[140:143], a[148:151], v[84:87], v[140:143]
  v_exp_f32 v222, v150
  v_cvt_pk_bf16_f32 v186, v220, v221
  v_mfma_f32_16x16x32_bf16 v[128:131], a[152:155], v[88:91], v[128:131]
  ds_read_b128 a[184:187], v3 offset:22528
  v_add_f32 v226, v226, v222
  v_mfma_f32_16x16x32_bf16 v[136:139], a[152:155], v[92:95], v[136:139]
  v_exp_f32 v223, v151
  v_exp_f32 v216, v152
  v_mfma_f32_16x16x32_bf16 v[132:135], a[156:159], v[88:91], v[132:135]
  ds_read_b128 a[188:191], v3 offset:23552
  buffer_load_dwordx4 a[228:231], v2, s[40:43], s14 offen offset:1024 sc1
  v_mfma_f32_16x16x32_bf16 v[140:143], a[156:159], v[92:95], v[140:143]
  s_waitcnt lgkmcnt(4)
  v_exp_f32 v217, v153
  v_mfma_f32_16x16x32_bf16 a[64:67], a[160:163], v[176:179], a[64:67]
  ds_read_b128 a[128:131], v3 offset:0
  v_add_f32 v226, v226, v223
  v_mfma_f32_16x16x32_bf16 a[68:71], a[160:163], v[180:183], a[68:71]
  v_exp_f32 v218, v154
  v_cvt_pk_bf16_f32 v187, v222, v223
  v_mfma_f32_16x16x32_bf16 a[72:75], a[164:167], v[176:179], a[72:75]
  ds_read_b128 a[132:135], v3 offset:1024
  buffer_load_dwordx4 v2, s[44:47], s26 offen offset:2048 sc1 lds
  v_mfma_f32_16x16x32_bf16 a[76:79], a[164:167], v[180:183], a[76:79]
  v_exp_f32 v219, v155
  v_add_f32 v227, v216, v217
  v_mfma_f32_16x16x32_bf16 a[80:83], a[168:171], v[176:179], a[80:83]
  ds_read_b128 a[136:139], v3 offset:2048
  v_cvt_pk_bf16_f32 v188, v216, v217
  v_add_f32 v227, v227, v218
  v_mfma_f32_16x16x32_bf16 a[84:87], a[168:171], v[180:183], a[84:87]
  buffer_load_dwordx4 a[232:235], v2, s[40:43], s14 offen offset:2048 sc1
  v_add_f32 v227, v227, v219
  v_mfma_f32_16x16x32_bf16 a[88:91], a[172:175], v[176:179], a[88:91]
  ds_read_b128 a[140:143], v3 offset:3072
  v_cvt_pk_bf16_f32 v189, v218, v219
  v_exp_f32 v220, v156
  v_mfma_f32_16x16x32_bf16 a[92:95], a[172:175], v[180:183], a[92:95]
  s_waitcnt lgkmcnt(4)
  v_exp_f32 v221, v157
  v_mfma_f32_16x16x32_bf16 a[96:99], a[176:179], v[176:179], a[96:99]
  ds_read_b128 a[144:147], v3 offset:4096
  buffer_load_dwordx4 v2, s[44:47], s26 offen offset:3072 sc1 lds
  v_mfma_f32_16x16x32_bf16 a[100:103], a[176:179], v[180:183], a[100:103]
  s_add_u32 s26, s26, 16384
  v_exp_f32 v222, v158
  v_mfma_f32_16x16x32_bf16 a[104:107], a[180:183], v[176:179], a[104:107]
  s_add_u32 s24, s24, 32768
  ds_read_b128 a[148:151], v3 offset:5120
  v_add_f32 v227, v227, v220
  v_add_f32 v227, v227, v221
  v_mfma_f32_16x16x32_bf16 a[108:111], a[180:183], v[180:183], a[108:111]
  s_and_b32 s24, s24, 0x1ffff
  v_exp_f32 v223, v159
  v_mfma_f32_16x16x32_bf16 a[112:115], a[184:187], v[176:179], a[112:115]
  ds_read_b128 a[152:155], v3 offset:6144
  v_cvt_pk_bf16_f32 v190, v220, v221
  v_add_f32 v227, v227, v222
  v_mfma_f32_16x16x32_bf16 a[116:119], a[184:187], v[180:183], a[116:119]
  v_add_f32 v227, v227, v223
  v_cvt_pk_bf16_f32 v191, v222, v223
  v_mfma_f32_16x16x32_bf16 a[120:123], a[188:191], v[176:179], a[120:123]
  s_waitcnt lgkmcnt(3)
  ds_read_b128 a[156:159], v3 offset:7168
  v_max_f32 v5, v226, v227
  v_cmp_lt_f32 vcc, s81, v5
  v_mfma_f32_16x16x32_bf16 a[124:127], a[188:191], v[180:183], a[124:127]
  s_cbranch_vccnz fa_stub20
fa_back20:
  v_add_f32 v230, v230, v226
  v_add_f32 v231, v231, v227
  v_mfma_f32_16x16x32_bf16 v[144:147], a[128:131], v[64:67], v[200:203]
  ds_read_b128 a[160:163], v3 offset:24576
  v_exp_f32 v216, v128
  v_mfma_f32_16x16x32_bf16 v[152:155], a[128:131], v[68:71], v[204:207]
  v_exp_f32 v217, v129
  v_mfma_f32_16x16x32_bf16 v[148:151], a[132:135], v[64:67], v[200:203]
  ds_read_b128 a[164:167], v3 offset:25600
  v_add_f32 v226, v216, v217
  v_cvt_pk_bf16_f32 v176, v216, v217
  v_mfma_f32_16x16x32_bf16 v[156:159], a[132:135], v[68:71], v[204:207]
  s_mov_b32 m0, s25
  v_exp_f32 v218, v130
  v_mfma_f32_16x16x32_bf16 v[144:147], a[136:139], v[72:75], v[144:147]
  ds_read_b128 a[168:171], v3 offset:26624
  buffer_load_dwordx4 v2, s[48:51], s27 offen offset:0 sc1 lds
  v_add_f32 v226, v226, v218
  v_mfma_f32_16x16x32_bf16 v[152:155], a[136:139], v[76:79], v[152:155]
  v_exp_f32 v219, v131
  v_mfma_f32_16x16x32_bf16 v[148:151], a[140:143], v[72:75], v[148:151]
  ds_read_b128 a[172:175], v3 offset:27648
  v_add_f32 v226, v226, v219
  v_cvt_pk_bf16_f32 v177, v218, v219
  v_mfma_f32_16x16x32_bf16 v[156:159], a[140:143], v[76:79], v[156:159]
  s_add_u32 s14, s13, 24576
  s_waitcnt lgkmcnt(4)
  buffer_load_dwordx4 a[236:239], v2, s[40:43], s14 offen offset:3072 sc1
  v_exp_f32 v220, v132
  v_mfma_f32_16x16x32_bf16 v[144:147], a[144:147], v[80:83], v[144:147]
  ds_read_b128 a[176:179], v3 offset:28672
  v_add_f32 v226, v226, v220
  v_mfma_f32_16x16x32_bf16 v[152:155], a[144:147], v[84:87], v[152:155]
  v_exp_f32 v221, v133
  v_mfma_f32_16x16x32_bf16 v[148:151], a[148:151], v[80:83], v[148:151]
  ds_read_b128 a[180:183], v3 offset:29696
  buffer_load_dwordx4 v2, s[48:51], s27 offen offset:1024 sc1 lds
  v_add_f32 v226, v226, v221
  v_mfma_f32_16x16x32_bf16 v[156:159], a[148:151], v[84:87], v[156:159]
  v_exp_f32 v222, v134
  v_cvt_pk_bf16_f32 v178, v220, v221
  v_mfma_f32_16x16x32_bf16 v[144:147], a[152:155], v[88:91], v[144:147]
  ds_read_b128 a[184:187], v3 offset:30720
  v_add_f32 v226, v226, v222
  v_mfma_f32_16x16x32_bf16 v[152:155], a[152:155], v[92:95], v[152:155]
  v_exp_f32 v223, v135
  v_exp_f32 v216, v136
  v_mfma_f32_16x16x32_bf16 v[148:151], a[156:159], v[88:91], v[148:151]
  s_add_u32 s14, s13, 28672
  ds_read_b128 a[188:191], v3 offset:31744
  buffer_load_dwordx4 a[240:243], v2, s[40:43], s14 offen offset:0 sc1
  v_mfma_f32_16x16x32_bf16 v[156:159], a[156:159], v[92:95], v[156:159]
  s_waitcnt lgkmcnt(4)
  v_exp_f32 v217, v137
  v_mfma_f32_16x16x32_bf16 a[64:67], a[160:163], v[184:187], a[64:67]
  ds_read_b128 a[128:131], v3 offset:8192
  v_add_f32 v226, v226, v223
  v_mfma_f32_16x16x32_bf16 a[68:71], a[160:163], v[188:191], a[68:71]
  v_exp_f32 v218, v138
  v_cvt_pk_bf16_f32 v179, v222, v223
  v_mfma_f32_16x16x32_bf16 a[72:75], a[164:167], v[184:187], a[72:75]
  ds_read_b128 a[132:135], v3 offset:9216
  buffer_load_dwordx4 v2, s[48:51], s27 offen offset:2048 sc1 lds
  v_mfma_f32_16x16x32_bf16 a[76:79], a[164:167], v[188:191], a[76:79]
  v_exp_f32 v219, v139
  v_add_f32 v227, v216, v217
  v_mfma_f32_16x16x32_bf16 a[80:83], a[168:171], v[184:187], a[80:83]
  ds_read_b128 a[136:139], v3 offset:10240
  v_cvt_pk_bf16_f32 v180, v216, v217
  v_add_f32 v227, v227, v218
  v_mfma_f32_16x16x32_bf16 a[84:87], a[168:171], v[188:191], a[84:87]
  buffer_load_dwordx4 a[244:247], v2, s[40:43], s14 offen offset:1024 sc1
  v_add_f32 v227, v227, v219
  v_mfma_f32_16x16x32_bf16 a[88:91], a[172:175], v[184:187], a[88:91]
  ds_read_b128 a[140:143], v3 offset:11264
  v_cvt_pk_bf16_f32 v181, v218, v219
  v_exp_f32 v220, v140
  v_mfma_f32_16x16x32_bf16 a[92:95], a[172:175], v[188:191], a[92:95]
  s_waitcnt lgkmcnt(4)
  v_exp_f32 v221, v141
  v_mfma_f32_16x16x32_bf16 a[96:99], a[176:179], v[184:187], a[96:99]
  ds_read_b128 a[144:147], v3 offset:12288
  buffer_load_dwordx4 v2, s[48:51], s27 offen offset:3072 sc1 lds
  v_mfma_f32_16x16x32_bf16 a[100:103], a[176:179], v[188:191], a[100:103]
  s_add_u32 s27, s27, 16384
  v_exp_f32 v222, v142
  v_mfma_f32_16x16x32_bf16 a[104:107], a[180:183], v[184:187], a[104:107]
  s_add_u32 s25, s25, 32768
  ds_read_b128 a[148:151], v3 offset:13312
  v_add_f32 v227, v227, v220
  v_add_f32 v227, v227, v221
  v_mfma_f32_16x16x32_bf16 a[108:111], a[180:183], v[188:191], a[108:111]
  s_and_b32 s25, s25, 0x1ffff
  v_exp_f32 v223, v143
  v_mfma_f32_16x16x32_bf16 a[112:115], a[184:187], v[184:187], a[112:115]
  ds_read_b128 a[152:155], v3 offset:14336
  v_cvt_pk_bf16_f32 v182, v220, v221
  v_add_f32 v227, v227, v222
  v_mfma_f32_16x16x32_bf16 a[116:119], a[184:187], v[188:191], a[116:119]
  v_add_f32 v227, v227, v223
  v_cvt_pk_bf16_f32 v183, v222, v223
  v_mfma_f32_16x16x32_bf16 a[120:123], a[188:191], v[184:187], a[120:123]
  s_waitcnt lgkmcnt(3)
  ds_read_b128 a[156:159], v3 offset:15360
  v_max_f32 v5, v226, v227
  v_cmp_lt_f32 vcc, s81, v5
  v_mfma_f32_16x16x32_bf16 a[124:127], a[188:191], v[188:191], a[124:127]
  s_cbranch_vccnz fa_stub21
fa_back21:
  v_add_f32 v230, v230, v226
  v_add_f32 v231, v231, v227
  v_add_u32 v3, 32768, v3
  v_and_b32 v3, 0x1ffff, v3
fa_SSW3:
  v_mfma_f32_16x16x32_bf16 v[128:131], a[128:131], v[64:67], v[200:203]
  s_waitcnt vmcnt(12)
  v_exp_f32 v216, v144
  v_exp_f32 v217, v145
  v_mfma_f32_16x16x32_bf16 v[136:139], a[128:131], v[68:71], v[204:207]
  s_barrier
  v_exp_f32 v218, v146
  v_mfma_f32_16x16x32_bf16 v[132:135], a[132:135], v[64:67], v[200:203]
  ds_read_b128 a[160:163], v3 offset:16384
  ds_read_b128 a[164:167], v3 offset:17408
  v_mfma_f32_16x16x32_bf16 v[140:143], a[132:135], v[68:71], v[204:207]
  s_mov_b32 m0, s24
  v_exp_f32 v219, v147
  v_mfma_f32_16x16x32_bf16 v[128:131], a[136:139], v[72:75], v[128:131]
  ds_read_b128 a[168:171], v3 offset:18432
  buffer_load_dwordx4 v2, s[44:47], s26 offen offset:0 sc1 lds
  v_add_f32 v226, v216, v217
  v_mfma_f32_16x16x32_bf16 v[136:139], a[136:139], v[76:79], v[136:139]
  v_exp_f32 v220, v148
  v_mfma_f32_16x16x32_bf16 v[132:135], a[140:143], v[72:75], v[132:135]
  ds_read_b128 a[172:175], v3 offset:19456
  v_cvt_pk_bf16_f32 v184, v216, v217
  v_add_f32 v226, v226, v218
  v_mfma_f32_16x16x32_bf16 v[140:143], a[140:143], v[76:79], v[140:143]
  s_add_u32 s14, s13, 28672
  s_waitcnt lgkmcnt(4)
  buffer_load_dwordx4 a[248:251], v2, s[40:43], s14 offen offset:2048 sc1
  v_add_f32 v226, v226, v219
  v_mfma_f32_16x16x32_bf16 v[128:131], a[144:147], v[80:83], v[128:131]
  ds_read_b128 a[176:179], v3 offset:20480
  v_cvt_pk_bf16_f32 v185, v218, v219
  v_add_f32 v226, v226, v220
  v_mfma_f32_16x16x32_bf16 v[136:139], a[144:147], v[84:87], v[136:139]
  v_exp_f32 v221, v149
  v_mfma_f32_16x16x32_bf16 v[132:135], a[148:151], v[80:83], v[132:135]
  ds_read_b128 a[180:183], v3 offset:21504
  buffer_load_dwordx4 v2, s[44:47], s26 offen offset:1024 sc1 lds
  v_add_f32 v226, v226, v221
  v_mfma_f32_16x16x32_bf16 v[140:143], a[148:151], v[84:87], v[140:143]
  v_exp_f32 v222, v150
  v_cvt_pk_bf16_f32 v186, v220, v221
  v_mfma_f32_16x16x32_bf16 v[128:131], a[152:155], v[88:91], v[128:131]
  ds_read_b128 a[184:187], v3 offset:22528
  v_add_f32 v226, v226, v222
  v_mfma_f32_16x16x32_bf16 v[136:139], a[152:155], v[92:95], v[136:139]
  v_exp_f32 v223, v151
  v_exp_f32 v216, v152
  v_mfma_f32_16x16x32_bf16 v[132:135], a[156:159], v[88:91], v[132:135]
  ds_read_b128 a[188:191], v3 offset:23552
  buffer_load_dwordx4 a[252:255], v2, s[40:43], s14 offen offset:3072 sc1
  v_mfma_f32_16x16x32_bf16 v[140:143], a[156:159], v[92:95], v[140:143]
  s_waitcnt lgkmcnt(4)
  v_exp_f32 v217, v153
  v_mfma_f32_16x16x32_bf16 a[64:67], a[160:163], v[176:179], a[64:67]
  ds_read_b128 a[128:131], v3 offset:0
  v_add_f32 v226, v226, v223
  v_mfma_f32_16x16x32_bf16 a[68:71], a[160:163], v[180:183], a[68:71]
  v_exp_f32 v218, v154
  v_cvt_pk_bf16_f32 v187, v222, v223
  v_mfma_f32_16x16x32_bf16 a[72:75], a[164:167], v[176:179], a[72:75]
  ds_read_b128 a[132:135], v3 offset:1024
  buffer_load_dwordx4 v2, s[44:47], s26 offen offset:2048 sc1 lds
  v_mfma_f32_16x16x32_bf16 a[76:79], a[164:167], v[180:183], a[76:79]
  v_exp_f32 v219, v155
  v_add_f32 v227, v216, v217
  v_mfma_f32_16x16x32_bf16 a[80:83], a[168:171], v[176:179], a[80:83]
  ds_read_b128 a[136:139], v3 offset:2048
  v_cvt_pk_bf16_f32 v188, v216, v217
  v_add_f32 v227, v227, v218
  v_mfma_f32_16x16x32_bf16 a[84:87], a[168:171], v[180:183], a[84:87]
  s_add_u32 s14, s13, 32768
  buffer_load_dwordx4 v[32:35], v2, s[40:43], s14 offen offset:0 sc1
  v_add_f32 v227, v227, v219
  v_mfma_f32_16x16x32_bf16 a[88:91], a[172:175], v[176:179], a[88:91]
  ds_read_b128 a[140:143], v3 offset:3072
  v_cvt_pk_bf16_f32 v189, v218, v219
  v_exp_f32 v220, v156
  v_mfma_f32_16x16x32_bf16 a[92:95], a[172:175], v[180:183], a[92:95]
  s_waitcnt lgkmcnt(4)
  v_exp_f32 v221, v157
  v_mfma_f32_16x16x32_bf16 a[96:99], a[176:179], v[176:179], a[96:99]
  ds_read_b128 a[144:147], v3 offset:4096
  buffer_load_dwordx4 v2, s[44:47], s26 offen offset:3072 sc1 lds
  v_mfma_f32_16x16x32_bf16 a[100:103], a[176:179], v[180:183], a[100:103]
  s_add_u32 s26, s26, 16384
  v_exp_f32 v222, v158
  v_mfma_f32_16x16x32_bf16 a[104:107], a[180:183], v[176:179], a[104:107]
  s_add_u32 s24, s24, 32768
  ds_read_b128 a[148:151], v3 offset:5120
  v_add_f32 v227, v227, v220
  v_add_f32 v227, v227, v221
  v_mfma_f32_16x16x32_bf16 a[108:111], a[180:183], v[180:183], a[108:111]
  s_and_b32 s24, s24, 0x1ffff
  v_exp_f32 v223, v159
  v_mfma_f32_16x16x32_bf16 a[112:115], a[184:187], v[176:179], a[112:115]
  ds_read_b128 a[152:155], v3 offset:6144
  v_cvt_pk_bf16_f32 v190, v220, v221
  v_add_f32 v227, v227, v222
  v_mfma_f32_16x16x32_bf16 a[116:119], a[184:187], v[180:183], a[116:119]
  v_add_f32 v227, v227, v223
  v_cvt_pk_bf16_f32 v191, v222, v223
  v_mfma_f32_16x16x32_bf16 a[120:123], a[188:191], v[176:179], a[120:123]
  s_waitcnt lgkmcnt(3)
  ds_read_b128 a[156:159], v3 offset:7168
  v_max_f32 v5, v226, v227
  v_cmp_lt_f32 vcc, s81, v5
  v_mfma_f32_16x16x32_bf16 a[124:127], a[188:191], v[180:183], a[124:127]
  s_cbranch_vccnz fa_stub22
fa_back22:
  v_add_f32 v230, v230, v226
  v_add_f32 v231, v231, v227
  v_mfma_f32_16x16x32_bf16 v[144:147], a[128:131], v[64:67], v[200:203]
  ds_read_b128 a[160:163], v3 offset:24576
  v_exp_f32 v216, v128
  v_mfma_f32_16x16x32_bf16 v[152:155], a[128:131], v[68:71], v[204:207]
  v_exp_f32 v217, v129
  v_mfma_f32_16x16x32_bf16 v[148:151], a[132:135], v[64:67], v[200:203]
  ds_read_b128 a[164:167], v3 offset:25600
  v_add_f32 v226, v216, v217
  v_cvt_pk_bf16_f32 v176, v216, v217
  v_mfma_f32_16x16x32_bf16 v[156:159], a[132:135], v[68:71], v[204:207]
  s_mov_b32 m0, s25
  v_exp_f32 v218, v130
  v_mfma_f32_16x16x32_bf16 v[144:147], a[136:139], v[72:75], v[144:147]
  ds_read_b128 a[168:171], v3 offset:26624
  buffer_load_dwordx4 v2, s[48:51], s27 offen offset:0 sc1 lds
  v_add_f32 v226, v226, v218
  v_mfma_f32_16x16x32_bf16 v[152:155], a[136:139], v[76:79], v[152:155]
  v_exp_f32 v219, v131
  v_mfma_f32_16x16x32_bf16 v[148:151], a[140:143], v[72:75], v[148:151]
  ds_read_b128 a[172:175], v3 offset:27648
  v_add_f32 v226, v226, v219
  v_cvt_pk_bf16_f32 v177, v218, v219
  v_mfma_f32_16x16x32_bf16 v[156:159], a[140:143], v[76:79], v[156:159]
  s_add_u32 s14, s13, 32768
  s_waitcnt lgkmcnt(4)
  buffer_load_dwordx4 v[36:39], v2, s[40:43], s14 offen offset:1024 sc1
  v_exp_f32 v220, v132
  v_mfma_f32_16x16x32_bf16 v[144:147], a[144:147], v[80:83], v[144:147]
  ds_read_b128 a[176:179], v3 offset:28672
  v_add_f32 v226, v226, v220
  v_mfma_f32_16x16x32_bf16 v[152:155], a[144:147], v[84:87], v[152:155]
  v_exp_f32 v221, v133
  v_mfma_f32_16x16x32_bf16 v[148:151], a[148:151], v[80:83], v[148:151]
  ds_read_b128 a[180:183], v3 offset:29696
  buffer_load_dwordx4 v2, s[48:51], s27 offen offset:1024 sc1 lds
  v_add_f32 v226, v226, v221
  v_mfma_f32_16x16x32_bf16 v[156:159], a[148:151], v[84:87], v[156:159]
  v_exp_f32 v222, v134
  v_cvt_pk_bf16_f32 v178, v220, v221
  v_mfma_f32_16x16x32_bf16 v[144:147], a[152:155], v[88:91], v[144:147]
  ds_read_b128 a[184:187], v3 offset:30720
  v_add_f32 v226, v226, v222
  v_mfma_f32_16x16x32_bf16 v[152:155], a[152:155], v[92:95], v[152:155]
  v_exp_f32 v223, v135
  v_exp_f32 v216, v136
  v_mfma_f32_16x16x32_bf16 v[148:151], a[156:159], v[88:91], v[148:151]
  ds_read_b128 a[188:191], v3 offset:31744
  buffer_load_dwordx4 v[40:43], v2, s[40:43], s14 offen offset:2048 sc1
  v_mfma_f32_16x16x32_bf16 v[156:159], a[156:159], v[92:95], v[156:159]
  s_waitcnt lgkmcnt(4)
  v_exp_f32 v217, v137
  v_mfma_f32_16x16x32_bf16 a[64:67], a[160:163], v[184:187], a[64:67]
  ds_read_b128 a[128:131], v3 offset:8192
  v_add_f32 v226, v226, v223
  v_mfma_f32_16x16x32_bf16 a[68:71], a[160:163], v[188:191], a[68:71]
  v_exp_f32 v218, v138
  v_cvt_pk_bf16_f32 v179, v222, v223
  v_mfma_f32_16x16x32_bf16 a[72:75], a[164:167], v[184:187], a[72:75]
  ds_read_b128 a[132:135], v3 offset:9216
  buffer_load_dwordx4 v2, s[48:51], s27 offen offset:2048 sc1 lds
  v_mfma_f32_16x16x32_bf16 a[76:79], a[164:167], v[188:191], a[76:79]
  v_exp_f32 v219, v139
  v_add_f32 v227, v216, v217
  v_mfma_f32_16x16x32_bf16 a[80:83], a[168:171], v[184:187], a[80:83]
  ds_read_b128 a[136:139], v3 offset:10240
  v_cvt_pk_bf16_f32 v180, v216, v217
  v_add_f32 v227, v227, v218
  v_mfma_f32_16x16x32_bf16 a[84:87], a[168:171], v[188:191], a[84:87]
  buffer_load_dwordx4 v[44:47], v2, s[40:43], s14 offen offset:3072 sc1
  v_add_f32 v227, v227, v219
  v_mfma_f32_16x16x32_bf16 a[88:91], a[172:175], v[184:187], a[88:91]
  ds_read_b128 a[140:143], v3 offset:11264
  v_cvt_pk_bf16_f32 v181, v218, v219
  v_exp_f32 v220, v140
  v_mfma_f32_16x16x32_bf16 a[92:95], a[172:175], v[188:191], a[92:95]
  s_waitcnt lgkmcnt(4)
  v_exp_f32 v221, v141
  v_mfma_f32_16x16x32_bf16 a[96:99], a[176:179], v[184:187], a[96:99]
  ds_read_b128 a[144:147], v3 offset:12288
  buffer_load_dwordx4 v2, s[48:51], s27 offen offset:3072 sc1 lds
  v_mfma_f32_16x16x32_bf16 a[100:103], a[176:179], v[188:191], a[100:103]
  s_add_u32 s27, s27, 16384
  v_exp_f32 v222, v142
  v_mfma_f32_16x16x32_bf16 a[104:107], a[180:183], v[184:187], a[104:107]
  s_add_u32 s25, s25, 32768
  ds_read_b128 a[148:151], v3 offset:13312
  v_add_f32 v227, v227, v220
  v_add_f32 v227, v227, v221
  v_mfma_f32_16x16x32_bf16 a[108:111], a[180:183], v[188:191], a[108:111]
  s_and_b32 s25, s25, 0x1ffff
  v_exp_f32 v223, v143
  v_mfma_f32_16x16x32_bf16 a[112:115], a[184:187], v[184:187], a[112:115]
  ds_read_b128 a[152:155], v3 offset:14336
  v_cvt_pk_bf16_f32 v182, v220, v221
  v_add_f32 v227, v227, v222
  v_mfma_f32_16x16x32_bf16 a[116:119], a[184:187], v[188:191], a[116:119]
  v_add_f32 v227, v227, v223
  v_cvt_pk_bf16_f32 v183, v222, v223
  v_mfma_f32_16x16x32_bf16 a[120:123], a[188:191], v[184:187], a[120:123]
  s_waitcnt lgkmcnt(3)
  ds_read_b128 a[156:159], v3 offset:15360
  v_max_f32 v5, v226, v227
  v_cmp_lt_f32 vcc, s81, v5
  v_mfma_f32_16x16x32_bf16 a[124:127], a[188:191], v[188:191], a[124:127]
  s_cbranch_vccnz fa_stub23
fa_back23:
  v_add_f32 v230, v230, v226
  v_add_f32 v231, v231, v227
  v_add_u32 v3, 32768, v3
  v_and_b32 v3, 0x1ffff, v3
fa_SSW2:
  v_mfma_f32_16x16x32_bf16 v[128:131], a[128:131], v[64:67], v[200:203]
  s_waitcnt vmcnt(12)
  v_exp_f32 v216, v144
  v_exp_f32 v217, v145
  v_mfma_f32_16x16x32_bf16 v[136:139], a[128:131], v[68:71], v[204:207]
  s_barrier
  v_exp_f32 v218, v146
  v_mfma_f32_16x16x32_bf16 v[132:135], a[132:135], v[64:67], v[200:203]
  ds_read_b128 a[160:163], v3 offset:16384
  ds_read_b128 a[164:167], v3 offset:17408
  v_mfma_f32_16x16x32_bf16 v[140:143], a[132:135], v[68:71], v[204:207]
  s_mov_b32 m0, s24
  v_exp_f32 v219, v147
  v_mfma_f32_16x16x32_bf16 v[128:131], a[136:139], v[72:75], v[128:131]
  ds_read_b128 a[168:171], v3 offset:18432
  buffer_load_dwordx4 v2, s[44:47], s26 offen offset:0 sc1 lds
  v_add_f32 v226, v216, v217
  v_mfma_f32_16x16x32_bf16 v[136:139], a[136:139], v[76:79], v[136:139]
  v_exp_f32 v220, v148
  v_mfma_f32_16x16x32_bf16 v[132:135], a[140:143], v[72:75], v[132:135]
  ds_read_b128 a[172:175], v3 offset:19456
  v_cvt_pk_bf16_f32 v184, v216, v217
  v_add_f32 v226, v226, v218
  v_mfma_f32_16x16x32_bf16 v[140:143], a[140:143], v[76:79], v[140:143]
  s_add_u32 s14, s13, 36864
  s_waitcnt lgkmcnt(4)
  buffer_load_dwordx4 v[48:51], v2, s[40:43], s14 offen offset:0 sc1
  v_add_f32 v226, v226, v219
  v_mfma_f32_16x16x32_bf16 v[128:131], a[144:147], v[80:83], v[128:131]
  ds_read_b128 a[176:179], v3 offset:20480
  v_cvt_pk_bf16_f32 v185, v218, v219
  v_add_f32 v226, v226, v220
  v_mfma_f32_16x16x32_bf16 v[136:139], a[144:147], v[84:87], v[136:139]
  v_exp_f32 v221, v149
  v_mfma_f32_16x16x32_bf16 v[132:135], a[148:151], v[80:83], v[132:135]
  ds_read_b128 a[180:183], v3 offset:21504
  buffer_load_dwordx4 v2, s[44:47], s26 offen offset:1024 sc1 lds
  v_add_f32 v226, v226, v221
  v_mfma_f32_16x16x32_bf16 v[140:143], a[148:151], v[84:87], v[140:143]
  v_exp_f32 v222, v150
  v_cvt_pk_bf16_f32 v186, v220, v221
  v_mfma_f32_16x16x32_bf16 v[128:131], a[152:155], v[88:91], v[128:131]
  ds_read_b128 a[184:187], v3 offset:22528
  v_add_f32 v226, v226, v222
  v_mfma_f32_16x16x32_bf16 v[136:139], a[152:155], v[92:95], v[136:139]
  v_exp_f32 v223, v151
  v_exp_f32 v216, v152
  v_mfma_f32_16x16x32_bf16 v[132:135], a[156:159], v[88:91], v[132:135]
  ds_read_b128 a[188:191], v3 offset:23552
  buffer_load_dwordx4 v[52:55], v2, s[40:43], s14 offen offset:1024 sc1
  v_mfma_f32_16x16x32_bf16 v[140:143], a[156:159], v[92:95], v[140:143]
  s_waitcnt lgkmcnt(4)
  v_exp_f32 v217, v153
  v_mfma_f32_16x16x32_bf16 a[64:67], a[160:163], v[176:179], a[64:67]
  ds_read_b128 a[128:131], v3 offset:0
  v_add_f32 v226, v226, v223
  v_mfma_f32_16x16x32_bf16 a[68:71], a[160:163], v[180:183], a[68:71]
  v_exp_f32 v218, v154
  v_cvt_pk_bf16_f32 v187, v222, v223
  v_mfma_f32_16x16x32_bf16 a[72:75], a[164:167], v[176:179], a[72:75]
  ds_read_b128 a[132:135], v3 offset:1024
  buffer_load_dwordx4 v2, s[44:47], s26 offen offset:2048 sc1 lds
  v_mfma_f32_16x16x32_bf16 a[76:79], a[164:167], v[180:183], a[76:79]
  v_exp_f32 v219, v155
  v_add_f32 v227, v216, v217
  v_mfma_f32_16x16x32_bf16 a[80:83], a[168:171], v[176:179], a[80:83]
  ds_read_b128 a[136:139], v3 offset:2048
  v_cvt_pk_bf16_f32 v188, v216, v217
  v_add_f32 v227, v227, v218
  v_mfma_f32_16x16x32_bf16 a[84:87], a[168:171], v[180:183], a[84:87]
  buffer_load_dwordx4 v[56:59], v2, s[40:43], s14 offen offset:2048 sc1
  v_add_f32 v227, v227, v219
  v_mfma_f32_16x16x32_bf16 a[88:91], a[172:175], v[176:179], a[88:91]
  ds_read_b128 a[140:143], v3 offset:3072
  v_cvt_pk_bf16_f32 v189, v218, v219
  v_exp_f32 v220, v156
  v_mfma_f32_16x16x32_bf16 a[92:95], a[172:175], v[180:183], a[92:95]
  s_waitcnt lgkmcnt(4)
  v_exp_f32 v221, v157
  v_mfma_f32_16x16x32_bf16 a[96:99], a[176:179], v[176:179], a[96:99]
  ds_read_b128 a[144:147], v3 offset:4096
  buffer_load_dwordx4 v2, s[44:47], s26 offen offset:3072 sc1 lds
  v_mfma_f32_16x16x32_bf16 a[100:103], a[176:179], v[180:183], a[100:103]
  s_add_u32 s26, s26, 16384
  v_exp_f32 v222, v158
  v_mfma_f32_16x16x32_bf16 a[104:107], a[180:183], v[176:179], a[104:107]
  s_add_u32 s24, s24, 32768
  ds_read_b128 a[148:151], v3 offset:5120
  v_add_f32 v227, v227, v220
  v_add_f32 v227, v227, v221
  v_mfma_f32_16x16x32_bf16 a[108:111], a[180:183], v[180:183], a[108:111]
  s_and_b32 s24, s24, 0x1ffff
  v_exp_f32 v223, v159
  v_mfma_f32_16x16x32_bf16 a[112:115], a[184:187], v[176:179], a[112:115]
  ds_read_b128 a[152:155], v3 offset:6144
  v_cvt_pk_bf16_f32 v190, v220, v221
  v_add_f32 v227, v227, v222
  v_mfma_f32_16x16x32_bf16 a[116:119], a[184:187], v[180:183], a[116:119]
  v_add_f32 v227, v227, v223
  v_cvt_pk_bf16_f32 v191, v222, v223
  v_mfma_f32_16x16x32_bf16 a[120:123], a[188:191], v[176:179], a[120:123]
  s_waitcnt lgkmcnt(3)
  ds_read_b128 a[156:159], v3 offset:7168
  v_max_f32 v5, v226, v227
  v_cmp_lt_f32 vcc, s81, v5
  v_mfma_f32_16x16x32_bf16 a[124:127], a[188:191], v[180:183], a[124:127]
  s_cbranch_vccnz fa_stub24
fa_back24:
  v_add_f32 v230, v230, v226
  v_add_f32 v231, v231, v227
  v_mfma_f32_16x16x32_bf16 v[144:147], a[128:131], v[64:67], v[200:203]
  ds_read_b128 a[160:163], v3 offset:24576
  v_exp_f32 v216, v128
  v_mfma_f32_16x16x32_bf16 v[152:155], a[128:131], v[68:71], v[204:207]
  v_exp_f32 v217, v129
  v_mfma_f32_16x16x32_bf16 v[148:151], a[132:135], v[64:67], v[200:203]
  ds_read_b128 a[164:167], v3 offset:25600
  v_add_f32 v226, v216, v217
  v_cvt_pk_bf16_f32 v176, v216, v217
  v_mfma_f32_16x16x32_bf16 v[156:159], a[132:135], v[68:71], v[204:207]
  s_mov_b32 m0, s25
  v_exp_f32 v218, v130
  v_mfma_f32_16x16x32_bf16 v[144:147], a[136:139], v[72:75], v[144:147]
  ds_read_b128 a[168:171], v3 offset:26624
  buffer_load_dwordx4 v2, s[48:51], s27 offen offset:0 sc1 lds
  v_add_f32 v226, v226, v218
  v_mfma_f32_16x16x32_bf16 v[152:155], a[136:139], v[76:79], v[152:155]
  v_exp_f32 v219, v131
  v_mfma_f32_16x16x32_bf16 v[148:151], a[140:143], v[72:75], v[148:151]
  ds_read_b128 a[172:175], v3 offset:27648
  v_add_f32 v226, v226, v219
  v_cvt_pk_bf16_f32 v177, v218, v219
  v_mfma_f32_16x16x32_bf16 v[156:159], a[140:143], v[76:79], v[156:159]
  s_add_u32 s14, s13, 36864
  s_waitcnt lgkmcnt(4)
  buffer_load_dwordx4 v[60:63], v2, s[40:43], s14 offen offset:3072 sc1
  v_exp_f32 v220, v132
  v_mfma_f32_16x16x32_bf16 v[144:147], a[144:147], v[80:83], v[144:147]
  ds_read_b128 a[176:179], v3 offset:28672
  v_add_f32 v226, v226, v220
  v_mfma_f32_16x16x32_bf16 v[152:155], a[144:147], v[84:87], v[152:155]
  v_exp_f32 v221, v133
  v_mfma_f32_16x16x32_bf16 v[148:151], a[148:151], v[80:83], v[148:151]
  ds_read_b128 a[180:183], v3 offset:29696
  buffer_load_dwordx4 v2, s[48:51], s27 offen offset:1024 sc1 lds
  v_add_f32 v226, v226, v221
  v_mfma_f32_16x16x32_bf16 v[156:159], a[148:151], v[84:87], v[156:159]
  v_exp_f32 v222, v134
  v_cvt_pk_bf16_f32 v178, v220, v221
  v_mfma_f32_16x16x32_bf16 v[144:147], a[152:155], v[88:91], v[144:147]
  ds_read_b128 a[184:187], v3 offset:30720
  v_add_f32 v226, v226, v222
  v_mfma_f32_16x16x32_bf16 v[152:155], a[152:155], v[92:95], v[152:155]
  v_exp_f32 v223, v135
  v_exp_f32 v216, v136
  v_mfma_f32_16x16x32_bf16 v[148:151], a[156:159], v[88:91], v[148:151]
  s_add_u32 s14, s13, 40960
  ds_read_b128 a[188:191], v3 offset:31744
  buffer_load_dwordx4 v[96:99], v2, s[40:43], s14 offen offset:0 sc1
  v_mfma_f32_16x16x32_bf16 v[156:159], a[156:159], v[92:95], v[156:159]
  s_waitcnt lgkmcnt(4)
  v_exp_f32 v217, v137
  v_mfma_f32_16x16x32_bf16 a[64:67], a[160:163], v[184:187], a[64:67]
  ds_read_b128 a[128:131], v3 offset:8192
  v_add_f32 v226, v226, v223
  v_mfma_f32_16x16x32_bf16 a[68:71], a[160:163], v[188:191], a[68:71]
  v_exp_f32 v218, v138
  v_cvt_pk_bf16_f32 v179, v222, v223
  v_mfma_f32_16x16x32_bf16 a[72:75], a[164:167], v[184:187], a[72:75]
  ds_read_b128 a[132:135], v3 offset:9216
  buffer_load_dwordx4 v2, s[48:51], s27 offen offset:2048 sc1 lds
  v_mfma_f32_16x16x32_bf16 a[76:79], a[164:167], v[188:191], a[76:79]
  v_exp_f32 v219, v139
  v_add_f32 v227, v216, v217
  v_mfma_f32_16x16x32_bf16 a[80:83], a[168:171], v[184:187], a[80:83]
  ds_read_b128 a[136:139], v3 offset:10240
  v_cvt_pk_bf16_f32 v180, v216, v217
  v_add_f32 v227, v227, v218
  v_mfma_f32_16x16x32_bf16 a[84:87], a[168:171], v[188:191], a[84:87]
  buffer_load_dwordx4 v[100:103], v2, s[40:43], s14 offen offset:1024 sc1
  v_add_f32 v227, v227, v219
  v_mfma_f32_16x16x32_bf16 a[88:91], a[172:175], v[184:187], a[88:91]
  ds_read_b128 a[140:143], v3 offset:11264
  v_cvt_pk_bf16_f32 v181, v218, v219
  v_exp_f32 v220, v140
  v_mfma_f32_16x16x32_bf16 a[92:95], a[172:175], v[188:191], a[92:95]
  s_waitcnt lgkmcnt(4)
  v_exp_f32 v221, v141
  v_mfma_f32_16x16x32_bf16 a[96:99], a[176:179], v[184:187], a[96:99]
  ds_read_b128 a[144:147], v3 offset:12288
  buffer_load_dwordx4 v2, s[48:51], s27 offen offset:3072 sc1 lds
  v_mfma_f32_16x16x32_bf16 a[100:103], a[176:179], v[188:191], a[100:103]
  s_add_u32 s27, s27, 16384
  v_exp_f32 v222, v142
  v_mfma_f32_16x16x32_bf16 a[104:107], a[180:183], v[184:187], a[104:107]
  s_add_u32 s25, s25, 32768
  ds_read_b128 a[148:151], v3 offset:13312
  v_add_f32 v227, v227, v220
  v_add_f32 v227, v227, v221
  v_mfma_f32_16x16x32_bf16 a[108:111], a[180:183], v[188:191], a[108:111]
  s_and_b32 s25, s25, 0x1ffff
  v_exp_f32 v223, v143
  v_mfma_f32_16x16x32_bf16 a[112:115], a[184:187], v[184:187], a[112:115]
  ds_read_b128 a[152:155], v3 offset:14336
  v_cvt_pk_bf16_f32 v182, v220, v221
  v_add_f32 v227, v227, v222
  v_mfma_f32_16x16x32_bf16 a[116:119], a[184:187], v[188:191], a[116:119]
  v_add_f32 v227, v227, v223
  v_cvt_pk_bf16_f32 v183, v222, v223
  v_mfma_f32_16x16x32_bf16 a[120:123], a[188:191], v[184:187], a[120:123]
  s_waitcnt lgkmcnt(3)
  ds_read_b128 a[156:159], v3 offset:15360
  v_max_f32 v5, v226, v227
  v_cmp_lt_f32 vcc, s81, v5
  v_mfma_f32_16x16x32_bf16 a[124:127], a[188:191], v[188:191], a[124:127]
  s_cbranch_vccnz fa_stub25
fa_back25:
  v_add_f32 v230, v230, v226
  v_add_f32 v231, v231, v227
  v_add_u32 v3, 32768, v3
  v_and_b32 v3, 0x1ffff, v3
fa_SSW1:
  v_mfma_f32_16x16x32_bf16 v[128:131], a[128:131], v[64:67], v[200:203]
  s_waitcnt vmcnt(12)
  v_exp_f32 v216, v144
  v_exp_f32 v217, v145
  v_mfma_f32_16x16x32_bf16 v[136:139], a[128:131], v[68:71], v[204:207]
  s_barrier
  v_exp_f32 v218, v146
  v_mfma_f32_16x16x32_bf16 v[132:135], a[132:135], v[64:67], v[200:203]
  ds_read_b128 a[160:163], v3 offset:16384
  ds_read_b128 a[164:167], v3 offset:17408
  v_mfma_f32_16x16x32_bf16 v[140:143], a[132:135], v[68:71], v[204:207]
  s_mov_b32 m0, s24
  v_exp_f32 v219, v147
  v_mfma_f32_16x16x32_bf16 v[128:131], a[136:139], v[72:75], v[128:131]
  ds_read_b128 a[168:171], v3 offset:18432
  buffer_load_dwordx4 v2, s[44:47], s26 offen offset:0 sc1 lds
  v_add_f32 v226, v216, v217
  v_mfma_f32_16x16x32_bf16 v[136:139], a[136:139], v[76:79], v[136:139]
  v_exp_f32 v220, v148
  v_mfma_f32_16x16x32_bf16 v[132:135], a[140:143], v[72:75], v[132:135]
  ds_read_b128 a[172:175], v3 offset:19456
  v_cvt_pk_bf16_f32 v184, v216, v217
  v_add_f32 v226, v226, v218
  v_mfma_f32_16x16x32_bf16 v[140:143], a[140:143], v[76:79], v[140:143]
  s_add_u32 s14, s13, 40960
  s_waitcnt lgkmcnt(4)
  buffer_load_dwordx4 v[104:107], v2, s[40:43], s14 offen offset:2048 sc1
  v_add_f32 v226, v226, v219
  v_mfma_f32_16x16x32_bf16 v[128:131], a[144:147], v[80:83], v[128:131]
  ds_read_b128 a[176:179], v3 offset:20480
  v_cvt_pk_bf16_f32 v185, v218, v219
  v_add_f32 v226, v226, v220
  v_mfma_f32_16x16x32_bf16 v[136:139], a[144:147], v[84:87], v[136:139]
  v_exp_f32 v221, v149
  v_mfma_f32_16x16x32_bf16 v[132:135], a[148:151], v[80:83], v[132:135]
  ds_read_b128 a[180:183], v3 offset:21504
  buffer_load_dwordx4 v2, s[44:47], s26 offen offset:1024 sc1 lds
  v_add_f32 v226, v226, v221
  v_mfma_f32_16x16x32_bf16 v[140:143], a[148:151], v[84:87], v[140:143]
  v_exp_f32 v222, v150
  v_cvt_pk_bf16_f32 v186, v220, v221
  v_mfma_f32_16x16x32_bf16 v[128:131], a[152:155], v[88:91], v[128:131]
  ds_read_b128 a[184:187], v3 offset:22528
  v_add_f32 v226, v226, v222
  v_mfma_f32_16x16x32_bf16 v[136:139], a[152:155], v[92:95], v[136:139]
  v_exp_f32 v223, v151
  v_exp_f32 v216, v152
  v_mfma_f32_16x16x32_bf16 v[132:135], a[156:159], v[88:91], v[132:135]
  ds_read_b128 a[188:191], v3 offset:23552
  buffer_load_dwordx4 v[108:111], v2, s[40:43], s14 offen offset:3072 sc1
  v_mfma_f32_16x16x32_bf16 v[140:143], a[156:159], v[92:95], v[140:143]
  s_waitcnt lgkmcnt(4)
  v_exp_f32 v217, v153
  v_mfma_f32_16x16x32_bf16 a[64:67], a[160:163], v[176:179], a[64:67]
  ds_read_b128 a[128:131], v3 offset:0
  v_add_f32 v226, v226, v223
  v_mfma_f32_16x16x32_bf16 a[68:71], a[160:163], v[180:183], a[68:71]
  v_exp_f32 v218, v154
  v_cvt_pk_bf16_f32 v187, v222, v223
  v_mfma_f32_16x16x32_bf16 a[72:75], a[164:167], v[176:179], a[72:75]
  ds_read_b128 a[132:135], v3 offset:1024
  buffer_load_dwordx4 v2, s[44:47], s26 offen offset:2048 sc1 lds
  v_mfma_f32_16x16x32_bf16 a[76:79], a[164:167], v[180:183], a[76:79]
  v_exp_f32 v219, v155
  v_add_f32 v227, v216, v217
  v_mfma_f32_16x16x32_bf16 a[80:83], a[168:171], v[176:179], a[80:83]
  ds_read_b128 a[136:139], v3 offset:2048
  v_cvt_pk_bf16_f32 v188, v216, v217
  v_add_f32 v227, v227, v218
  v_mfma_f32_16x16x32_bf16 a[84:87], a[168:171], v[180:183], a[84:87]
  s_add_u32 s14, s13, 45056
  buffer_load_dwordx4 v[112:115], v2, s[40:43], s14 offen offset:0 sc1
  v_add_f32 v227, v227, v219
  v_mfma_f32_16x16x32_bf16 a[88:91], a[172:175], v[176:179], a[88:91]
  ds_read_b128 a[140:143], v3 offset:3072
  v_cvt_pk_bf16_f32 v189, v218, v219
  v_exp_f32 v220, v156
  v_mfma_f32_16x16x32_bf16 a[92:95], a[172:175], v[180:183], a[92:95]
  s_waitcnt lgkmcnt(4)
  v_exp_f32 v221, v157
  v_mfma_f32_16x16x32_bf16 a[96:99], a[176:179], v[176:179], a[96:99]
  ds_read_b128 a[144:147], v3 offset:4096
  buffer_load_dwordx4 v2, s[44:47], s26 offen offset:3072 sc1 lds
  v_mfma_f32_16x16x32_bf16 a[100:103], a[176:179], v[180:183], a[100:103]
  s_add_u32 s26, s26, 16384
  v_exp_f32 v222, v158
  v_mfma_f32_16x16x32_bf16 a[104:107], a[180:183], v[176:179], a[104:107]
  s_add_u32 s24, s24, 32768
  ds_read_b128 a[148:151], v3 offset:5120
  v_add_f32 v227, v227, v220
  v_add_f32 v227, v227, v221
  v_mfma_f32_16x16x32_bf16 a[108:111], a[180:183], v[180:183], a[108:111]
  s_and_b32 s24, s24, 0x1ffff
  v_exp_f32 v223, v159
  v_mfma_f32_16x16x32_bf16 a[112:115], a[184:187], v[176:179], a[112:115]
  ds_read_b128 a[152:155], v3 offset:6144
  v_cvt_pk_bf16_f32 v190, v220, v221
  v_add_f32 v227, v227, v222
  v_mfma_f32_16x16x32_bf16 a[116:119], a[184:187], v[180:183], a[116:119]
  v_add_f32 v227, v227, v223
  v_cvt_pk_bf16_f32 v191, v222, v223
  v_mfma_f32_16x16x32_bf16 a[120:123], a[188:191], v[176:179], a[120:123]
  s_waitcnt lgkmcnt(3)
  ds_read_b128 a[156:159], v3 offset:7168
  v_max_f32 v5, v226, v227
  v_cmp_lt_f32 vcc, s81, v5
  v_mfma_f32_16x16x32_bf16 a[124:127], a[188:191], v[180:183], a[124:127]
  s_cbranch_vccnz fa_stub26
fa_back26:
  v_add_f32 v230, v230, v226
  v_add_f32 v231, v231, v227
  v_mfma_f32_16x16x32_bf16 v[144:147], a[128:131], v[64:67], v[200:203]
  ds_read_b128 a[160:163], v3 offset:24576
  v_exp_f32 v216, v128
  v_mfma_f32_16x16x32_bf16 v[152:155], a[128:131], v[68:71], v[204:207]
  v_exp_f32 v217, v129
  v_mfma_f32_16x16x32_bf16 v[148:151], a[132:135], v[64:67], v[200:203]
  ds_read_b128 a[164:167], v3 offset:25600
  v_add_f32 v226, v216, v217
  v_cvt_pk_bf16_f32 v176, v216, v217
  v_mfma_f32_16x16x32_bf16 v[156:159], a[132:135], v[68:71], v[204:207]
  s_mov_b32 m0, s25
  v_exp_f32 v218, v130
  v_mfma_f32_16x16x32_bf16 v[144:147], a[136:139], v[72:75], v[144:147]
  ds_read_b128 a[168:171], v3 offset:26624
  buffer_load_dwordx4 v2, s[48:51], s27 offen offset:0 sc1 lds
  v_add_f32 v226, v226, v218
  v_mfma_f32_16x16x32_bf16 v[152:155], a[136:139], v[76:79], v[152:155]
  v_exp_f32 v219, v131
  v_mfma_f32_16x16x32_bf16 v[148:151], a[140:143], v[72:75], v[148:151]
  ds_read_b128 a[172:175], v3 offset:27648
  v_add_f32 v226, v226, v219
  v_cvt_pk_bf16_f32 v177, v218, v219
  v_mfma_f32_16x16x32_bf16 v[156:159], a[140:143], v[76:79], v[156:159]
  s_add_u32 s14, s13, 45056
  s_waitcnt lgkmcnt(4)
  buffer_load_dwordx4 v[116:119], v2, s[40:43], s14 offen offset:1024 sc1
  v_exp_f32 v220, v132
  v_mfma_f32_16x16x32_bf16 v[144:147], a[144:147], v[80:83], v[144:147]
  ds_read_b128 a[176:179], v3 offset:28672
  v_add_f32 v226, v226, v220
  v_mfma_f32_16x16x32_bf16 v[152:155], a[144:147], v[84:87], v[152:155]
  v_exp_f32 v221, v133
  v_mfma_f32_16x16x32_bf16 v[148:151], a[148:151], v[80:83], v[148:151]
  ds_read_b128 a[180:183], v3 offset:29696
  buffer_load_dwordx4 v2, s[48:51], s27 offen offset:1024 sc1 lds
  v_add_f32 v226, v226, v221
  v_mfma_f32_16x16x32_bf16 v[156:159], a[148:151], v[84:87], v[156:159]
  v_exp_f32 v222, v134
  v_cvt_pk_bf16_f32 v178, v220, v221
  v_mfma_f32_16x16x32_bf16 v[144:147], a[152:155], v[88:91], v[144:147]
  ds_read_b128 a[184:187], v3 offset:30720
  v_add_f32 v226, v226, v222
  v_mfma_f32_16x16x32_bf16 v[152:155], a[152:155], v[92:95], v[152:155]
  v_exp_f32 v223, v135
  v_exp_f32 v216, v136
  v_mfma_f32_16x16x32_bf16 v[148:151], a[156:159], v[88:91], v[148:151]
  ds_read_b128 a[188:191], v3 offset:31744
  buffer_load_dwordx4 v[120:123], v2, s[40:43], s14 offen offset:2048 sc1
  v_mfma_f32_16x16x32_bf16 v[156:159], a[156:159], v[92:95], v[156:159]
  s_waitcnt lgkmcnt(4)
  v_exp_f32 v217, v137
  v_mfma_f32_16x16x32_bf16 a[64:67], a[160:163], v[184:187], a[64:67]
  ds_read_b128 a[128:131], v3 offset:8192
  v_add_f32 v226, v226, v223
  v_mfma_f32_16x16x32_bf16 a[68:71], a[160:163], v[188:191], a[68:71]
  v_exp_f32 v218, v138
  v_cvt_pk_bf16_f32 v179, v222, v223
  v_mfma_f32_16x16x32_bf16 a[72:75], a[164:167], v[184:187], a[72:75]
  ds_read_b128 a[132:135], v3 offset:9216
  buffer_load_dwordx4 v2, s[48:51], s27 offen offset:2048 sc1 lds
  v_mfma_f32_16x16x32_bf16 a[76:79], a[164:167], v[188:191], a[76:79]
  v_exp_f32 v219, v139
  v_add_f32 v227, v216, v217
  v_mfma_f32_16x16x32_bf16 a[80:83], a[168:171], v[184:187], a[80:83]
  ds_read_b128 a[136:139], v3 offset:10240
  v_cvt_pk_bf16_f32 v180, v216, v217
  v_add_f32 v227, v227, v218
  v_mfma_f32_16x16x32_bf16 a[84:87], a[168:171], v[188:191], a[84:87]
  buffer_load_dwordx4 v[124:127], v2, s[40:43], s14 offen offset:3072 sc1
  v_add_f32 v227, v227, v219
  v_mfma_f32_16x16x32_bf16 a[88:91], a[172:175], v[184:187], a[88:91]
  ds_read_b128 a[140:143], v3 offset:11264
  v_cvt_pk_bf16_f32 v181, v218, v219
  v_exp_f32 v220, v140
  v_mfma_f32_16x16x32_bf16 a[92:95], a[172:175], v[188:191], a[92:95]
  s_waitcnt lgkmcnt(4)
  v_exp_f32 v221, v141
  v_mfma_f32_16x16x32_bf16 a[96:99], a[176:179], v[184:187], a[96:99]
  ds_read_b128 a[144:147], v3 offset:12288
  buffer_load_dwordx4 v2, s[48:51], s27 offen offset:3072 sc1 lds
  v_mfma_f32_16x16x32_bf16 a[100:103], a[176:179], v[188:191], a[100:103]
  s_add_u32 s27, s27, 16384
  v_exp_f32 v222, v142
  v_mfma_f32_16x16x32_bf16 a[104:107], a[180:183], v[184:187], a[104:107]
  s_add_u32 s25, s25, 32768
  ds_read_b128 a[148:151], v3 offset:13312
  v_add_f32 v227, v227, v220
  v_add_f32 v227, v227, v221
  v_mfma_f32_16x16x32_bf16 a[108:111], a[180:183], v[188:191], a[108:111]
  s_and_b32 s25, s25, 0x1ffff
  v_exp_f32 v223, v143
  v_mfma_f32_16x16x32_bf16 a[112:115], a[184:187], v[184:187], a[112:115]
  ds_read_b128 a[152:155], v3 offset:14336
  v_cvt_pk_bf16_f32 v182, v220, v221
  v_add_f32 v227, v227, v222
  v_mfma_f32_16x16x32_bf16 a[116:119], a[184:187], v[188:191], a[116:119]
  v_add_f32 v227, v227, v223
  v_cvt_pk_bf16_f32 v183, v222, v223
  v_mfma_f32_16x16x32_bf16 a[120:123], a[188:191], v[184:187], a[120:123]
  s_waitcnt lgkmcnt(3)
  ds_read_b128 a[156:159], v3 offset:15360
  v_max_f32 v5, v226, v227
  v_cmp_lt_f32 vcc, s81, v5
  v_mfma_f32_16x16x32_bf16 a[124:127], a[188:191], v[188:191], a[124:127]
  s_cbranch_vccnz fa_stub27
fa_back27:
  v_add_f32 v230, v230, v226
  v_add_f32 v231, v231, v227
  v_add_u32 v3, 32768, v3
  v_and_b32 v3, 0x1ffff, v3
fa_Bexit:
  s_bitcmp1_b32 s20, 0
  s_cbranch_scc1 fa_Bodd
  v_mfma_f32_16x16x32_bf16 v[128:131], a[128:131], v[64:67], v[200:203]
  s_waitcnt vmcnt(0)
  v_exp_f32 v216, v144
  v_mfma_f32_16x16x32_bf16 v[136:139], a[128:131], v[68:71], v[204:207]
  s_barrier
  v_exp_f32 v217, v145
  v_exp_f32 v218, v146
  v_mfma_f32_16x16x32_bf16 v[132:135], a[132:135], v[64:67], v[200:203]
  ds_read_b128 a[160:163], v3 offset:16384
  ds_read_b128 a[164:167], v3 offset:17408
  v_mfma_f32_16x16x32_bf16 v[140:143], a[132:135], v[68:71], v[204:207]
  s_add_u32 s14, s13, 49152
  buffer_load_dwordx4 v[160:163], v2, s[40:43], s14 offen offset:0 sc1
  v_mfma_f32_16x16x32_bf16 v[128:131], a[136:139], v[72:75], v[128:131]
  ds_read_b128 a[168:171], v3 offset:18432
  v_add_f32 v226, v216, v217
  v_mfma_f32_16x16x32_bf16 v[136:139], a[136:139], v[76:79], v[136:139]
  v_exp_f32 v219, v147
  v_cvt_pk_bf16_f32 v184, v216, v217
  v_mfma_f32_16x16x32_bf16 v[132:135], a[140:143], v[72:75], v[132:135]
  ds_read_b128 a[172:175], v3 offset:19456
  v_add_f32 v226, v226, v218
  v_mfma_f32_16x16x32_bf16 v[140:143], a[140:143], v[76:79], v[140:143]
  s_waitcnt lgkmcnt(4)
  buffer_load_dwordx4 v[164:167], v2, s[40:43], s14 offen offset:1024 sc1
  v_add_f32 v226, v226, v219
  v_mfma_f32_16x16x32_bf16 v[128:131], a[144:147], v[80:83], v[128:131]
  ds_read_b128 a[176:179], v3 offset:20480
  v_cvt_pk_bf16_f32 v185, v218, v219
  v_mfma_f32_16x16x32_bf16 v[136:139], a[144:147], v[84:87], v[136:139]
  v_exp_f32 v220, v148
  v_exp_f32 v221, v149
  v_mfma_f32_16x16x32_bf16 v[132:135], a[148:151], v[80:83], v[132:135]
  ds_read_b128 a[180:183], v3 offset:21504
  v_mfma_f32_16x16x32_bf16 v[140:143], a[148:151], v[84:87], v[140:143]
  v_exp_f32 v222, v150
  v_mfma_f32_16x16x32_bf16 v[128:131], a[152:155], v[88:91], v[128:131]
  ds_read_b128 a[184:187], v3 offset:22528
  buffer_load_dwordx4 v[168:171], v2, s[40:43], s14 offen offset:2048 sc1
  v_mfma_f32_16x16x32_bf16 v[136:139], a[152:155], v[92:95], v[136:139]
  v_exp_f32 v223, v151
  v_add_f32 v226, v226, v220
  v_mfma_f32_16x16x32_bf16 v[132:135], a[156:159], v[88:91], v[132:135]
  ds_read_b128 a[188:191], v3 offset:23552
  v_add_f32 v226, v226, v221
  v_mfma_f32_16x16x32_bf16 v[140:143], a[156:159], v[92:95], v[140:143]
  s_waitcnt lgkmcnt(4)
  v_exp_f32 v216, v152
  v_mfma_f32_16x16x32_bf16 a[64:67], a[160:163], v[176:179], a[64:67]
  v_exp_f32 v217, v153
  v_mfma_f32_16x16x32_bf16 a[68:71], a[160:163], v[180:183], a[68:71]
  buffer_load_dwordx4 v[172:175], v2, s[40:43], s14 offen offset:3072 sc1
  v_cvt_pk_bf16_f32 v186, v220, v221
  v_add_f32 v226, v226, v222
  v_mfma_f32_16x16x32_bf16 a[72:75], a[164:167], v[176:179], a[72:75]
  v_exp_f32 v218, v154
  v_mfma_f32_16x16x32_bf16 a[76:79], a[164:167], v[180:183], a[76:79]
  v_exp_f32 v219, v155
  v_mfma_f32_16x16x32_bf16 a[80:83], a[168:171], v[176:179], a[80:83]
  v_exp_f32 v220, v156
  v_mfma_f32_16x16x32_bf16 a[84:87], a[168:171], v[180:183], a[84:87]
  s_add_u32 s14, s13, 53248
  buffer_load_dwordx4 v[192:195], v2, s[40:43], s14 offen offset:0 sc1
  v_add_f32 v226, v226, v223
  v_cvt_pk_bf16_f32 v187, v222, v223
  v_mfma_f32_16x16x32_bf16 a[88:91], a[172:175], v[176:179], a[88:91]
  v_exp_f32 v221, v157
  v_mfma_f32_16x16x32_bf16 a[92:95], a[172:175], v[180:183], a[92:95]
  s_waitcnt lgkmcnt(0)
  v_exp_f32 v222, v158
  v_mfma_f32_16x16x32_bf16 a[96:99], a[176:179], v[176:179], a[96:99]
  v_exp_f32 v223, v159
  v_mfma_f32_16x16x32_bf16 a[100:103], a[176:179], v[180:183], a[100:103]
  v_add_f32 v227, v216, v217
  v_cvt_pk_bf16_f32 v188, v216, v217
  v_add_f32 v227, v227, v218
  v_mfma_f32_16x16x32_bf16 a[104:107], a[180:183], v[176:179], a[104:107]
  buffer_load_dwordx4 v[196:199], v2, s[40:43], s14 offen offset:1024 sc1
  v_add_f32 v227, v227, v219
  v_mfma_f32_16x16x32_bf16 a[108:111], a[180:183], v[180:183], a[108:111]
  v_cvt_pk_bf16_f32 v189, v218, v219
  v_add_f32 v227, v227, v220
  v_mfma_f32_16x16x32_bf16 a[112:115], a[184:187], v[176:179], a[112:115]
  v_add_f32 v227, v227, v221
  v_cvt_pk_bf16_f32 v190, v220, v221
  v_mfma_f32_16x16x32_bf16 a[116:119], a[184:187], v[180:183], a[116:119]
  v_add_f32 v227, v227, v222
  v_add_f32 v227, v227, v223
  v_cvt_pk_bf16_f32 v191, v222, v223
  v_mfma_f32_16x16x32_bf16 a[120:123], a[188:191], v[176:179], a[120:123]
  v_max_f32 v5, v226, v227
  v_cmp_lt_f32 vcc, s81, v5
  v_mfma_f32_16x16x32_bf16 a[124:127], a[188:191], v[180:183], a[124:127]
  s_cbranch_vccnz fa_stub28
fa_back28:
  v_add_f32 v230, v230, v226
  v_add_f32 v231, v231, v227
  ds_read_b128 a[160:163], v3 offset:24576
  ds_read_b128 a[164:167], v3 offset:25600
  ds_read_b128 a[168:171], v3 offset:26624
  ds_read_b128 a[172:175], v3 offset:27648
  ds_read_b128 a[176:179], v3 offset:28672
  ds_read_b128 a[180:183], v3 offset:29696
  ds_read_b128 a[184:187], v3 offset:30720
  ds_read_b128 a[188:191], v3 offset:31744
  v_cndmask_b32 v128, v4, v128, s[68:69]
  v_cndmask_b32 v129, v4, v129, s[70:71]
  v_cndmask_b32 v130, v4, v130, s[72:73]
  v_cndmask_b32 v131, v4, v131, s[74:75]
  v_mov_b32 v132, v4
  v_mov_b32 v133, v4
  v_mov_b32 v134, v4
  v_mov_b32 v135, v4
  v_cndmask_b32 v140, v4, v140, s[68:69]
  v_cndmask_b32 v141, v4, v141, s[70:71]
  v_cndmask_b32 v142, v4, v142, s[72:73]
  v_cndmask_b32 v143, v4, v143, s[74:75]
  v_exp_f32 v216, v128
  v_exp_f32 v217, v129
  v_exp_f32 v218, v130
  v_exp_f32 v219, v131
  v_exp_f32 v220, v132
  v_exp_f32 v221, v133
  v_exp_f32 v222, v134
  v_exp_f32 v223, v135
  v_add_f32 v226, v216, v217
  v_cvt_pk_bf16_f32 v176, v216, v217
  s_waitcnt lgkmcnt(4)
  v_mfma_f32_16x16x32_bf16 a[64:67], a[160:163], v[184:187], a[64:67]
  v_exp_f32 v216, v136
  v_add_f32 v226, v226, v218
  v_mfma_f32_16x16x32_bf16 a[68:71], a[160:163], v[188:191], a[68:71]
  s_add_u32 s14, s13, 53248
  buffer_load_dwordx4 v[208:211], v2, s[40:43], s14 offen offset:2048 sc1
  v_add_f32 v226, v226, v219
  v_cvt_pk_bf16_f32 v177, v218, v219
  v_mfma_f32_16x16x32_bf16 a[72:75], a[164:167], v[184:187], a[72:75]
  v_exp_f32 v217, v137
  v_mfma_f32_16x16x32_bf16 a[76:79], a[164:167], v[188:191], a[76:79]
  v_exp_f32 v218, v138
  v_add_f32 v226, v226, v220
  v_mfma_f32_16x16x32_bf16 a[80:83], a[168:171], v[184:187], a[80:83]
  buffer_load_dwordx4 v[212:215], v2, s[40:43], s14 offen offset:3072 sc1
  v_add_f32 v226, v226, v221
  v_cvt_pk_bf16_f32 v178, v220, v221
  v_mfma_f32_16x16x32_bf16 a[84:87], a[168:171], v[188:191], a[84:87]
  v_exp_f32 v219, v139
  v_add_f32 v226, v226, v222
  v_mfma_f32_16x16x32_bf16 a[88:91], a[172:175], v[184:187], a[88:91]
  v_exp_f32 v220, v140
  v_add_f32 v226, v226, v223
  v_mfma_f32_16x16x32_bf16 a[92:95], a[172:175], v[188:191], a[92:95]
  s_waitcnt lgkmcnt(0)
  v_exp_f32 v221, v141
  v_mfma_f32_16x16x32_bf16 a[96:99], a[176:179], v[184:187], a[96:99]
  s_add_u32 s14, s13, 57344
  buffer_load_dwordx4 v[232:235], v2, s[40:43], s14 offen offset:0 sc1
  v_cvt_pk_bf16_f32 v179, v222, v223
  v_add_f32 v227, v216, v217
  v_mfma_f32_16x16x32_bf16 a[100:103], a[176:179], v[188:191], a[100:103]
  v_exp_f32 v222, v142
  v_cvt_pk_bf16_f32 v180, v216, v217
  v_mfma_f32_16x16x32_bf16 a[104:107], a[180:183], v[184:187], a[104:107]
  v_exp_f32 v223, v143
  v_add_f32 v227, v227, v218
  v_mfma_f32_16x16x32_bf16 a[108:111], a[180:183], v[188:191], a[108:111]
  buffer_load_dwordx4 v[236:239], v2, s[40:43], s14 offen offset:1024 sc1
  v_add_f32 v227, v227, v219
  v_cvt_pk_bf16_f32 v181, v218, v219
  v_mfma_f32_16x16x32_bf16 a[112:115], a[184:187], v[184:187], a[112:115]
  v_add_f32 v227, v227, v220
  v_add_f32 v227, v227, v221
  v_mfma_f32_16x16x32_bf16 a[116:119], a[184:187], v[188:191], a[116:119]
  v_cvt_pk_bf16_f32 v182, v220, v221
  v_add_f32 v227, v227, v222
  v_add_f32 v227, v227, v223
  v_mfma_f32_16x16x32_bf16 a[120:123], a[188:191], v[184:187], a[120:123]
  v_cvt_pk_bf16_f32 v183, v222, v223
  v_max_f32 v5, v226, v227
  v_cmp_lt_f32 vcc, s81, v5
  v_mfma_f32_16x16x32_bf16 a[124:127], a[188:191], v[188:191], a[124:127]
  s_cbranch_vccnz fa_stub29
fa_back29:
  v_add_f32 v230, v230, v226
  v_add_f32 v231, v231, v227
  v_add_u32 v3, 32768, v3
  v_and_b32 v3, 0x1ffff, v3
  s_waitcnt vmcnt(10)
  s_barrier
  ds_read_b128 a[160:163], v3 offset:16384
  ds_read_b128 a[164:167], v3 offset:17408
  ds_read_b128 a[168:171], v3 offset:18432
  ds_read_b128 a[172:175], v3 offset:19456
  ds_read_b128 a[176:179], v3 offset:20480
  ds_read_b128 a[180:183], v3 offset:21504
  ds_read_b128 a[184:187], v3 offset:22528
  ds_read_b128 a[188:191], v3 offset:23552
  s_waitcnt lgkmcnt(4)
  v_mfma_f32_16x16x32_bf16 a[64:67], a[160:163], v[176:179], a[64:67]
  v_mfma_f32_16x16x32_bf16 a[68:71], a[160:163], v[180:183], a[68:71]
  s_add_u32 s14, s13, 57344
  buffer_load_dwordx4 v[240:243], v2, s[40:43], s14 offen offset:2048 sc1
  v_mfma_f32_16x16x32_bf16 a[72:75], a[164:167], v[176:179], a[72:75]
  v_mfma_f32_16x16x32_bf16 a[76:79], a[164:167], v[180:183], a[76:79]
  v_mfma_f32_16x16x32_bf16 a[80:83], a[168:171], v[176:179], a[80:83]
  v_mfma_f32_16x16x32_bf16 a[84:87], a[168:171], v[180:183], a[84:87]
  v_mfma_f32_16x16x32_bf16 a[88:91], a[172:175], v[176:179], a[88:91]
  v_mfma_f32_16x16x32_bf16 a[92:95], a[172:175], v[180:183], a[92:95]
  s_waitcnt lgkmcnt(0)
  v_mfma_f32_16x16x32_bf16 a[96:99], a[176:179], v[176:179], a[96:99]
  buffer_load_dwordx4 v[244:247], v2, s[40:43], s14 offen offset:3072 sc1
  v_mfma_f32_16x16x32_bf16 a[100:103], a[176:179], v[180:183], a[100:103]
  v_mfma_f32_16x16x32_bf16 a[104:107], a[180:183], v[176:179], a[104:107]
  v_mfma_f32_16x16x32_bf16 a[108:111], a[180:183], v[180:183], a[108:111]
  v_mfma_f32_16x16x32_bf16 a[112:115], a[184:187], v[176:179], a[112:115]
  v_mfma_f32_16x16x32_bf16 a[116:119], a[184:187], v[180:183], a[116:119]
  v_mfma_f32_16x16x32_bf16 a[120:123], a[188:191], v[176:179], a[120:123]
  v_mfma_f32_16x16x32_bf16 a[124:127], a[188:191], v[180:183], a[124:127]
  s_branch fa_Bdone
fa_Bodd:
  s_waitcnt vmcnt(0)
  s_barrier
  ds_read_b128 a[160:163], v3 offset:16384
  ds_read_b128 a[164:167], v3 offset:17408
  ds_read_b128 a[168:171], v3 offset:18432
  ds_read_b128 a[172:175], v3 offset:19456
  ds_read_b128 a[176:179], v3 offset:20480
  ds_read_b128 a[180:183], v3 offset:21504
  ds_read_b128 a[184:187], v3 offset:22528
  ds_read_b128 a[188:191], v3 offset:23552
  v_cndmask_b32 v144, v4, v144, s[68:69]
  v_cndmask_b32 v145, v4, v145, s[70:71]
  v_cndmask_b32 v146, v4, v146, s[72:73]
  v_cndmask_b32 v147, v4, v147, s[74:75]
  v_mov_b32 v148, v4
  v_mov_b32 v149, v4
  v_mov_b32 v150, v4
  v_mov_b32 v151, v4
  v_cndmask_b32 v156, v4, v156, s[68:69]
  v_cndmask_b32 v157, v4, v157, s[70:71]
  v_cndmask_b32 v158, v4, v158, s[72:73]
  v_cndmask_b32 v159, v4, v159, s[74:75]
  v_exp_f32 v216, v144
  v_exp_f32 v217, v145
  v_exp_f32 v218, v146
  v_exp_f32 v219, v147
  v_exp_f32 v220, v148
  v_exp_f32 v221, v149
  v_exp_f32 v222, v150
  v_exp_f32 v223, v151
  v_add_f32 v226, v216, v217
  v_cvt_pk_bf16_f32 v184, v216, v217
  s_waitcnt lgkmcnt(4)
  v_mfma_f32_16x16x32_bf16 a[64:67], a[160:163], v[176:179], a[64:67]
  v_exp_f32 v216, v152
  v_add_f32 v226, v226, v218
  v_mfma_f32_16x16x32_bf16 a[68:71], a[160:163], v[180:183], a[68:71]
  s_add_u32 s14, s13, 49152
  buffer_load_dwordx4 v[160:163], v2, s[40:43], s14 offen offset:0 sc1
  v_add_f32 v226, v226, v219
  v_cvt_pk_bf16_f32 v185, v218, v219
  v_mfma_f32_16x16x32_bf16 a[72:75], a[164:167], v[176:179], a[72:75]
  v_exp_f32 v217, v153
  v_add_f32 v226, v226, v220
  v_mfma_f32_16x16x32_bf16 a[76:79], a[164:167], v[180:183], a[76:79]
  buffer_load_dwordx4 v[164:167], v2, s[40:43], s14 offen offset:1024 sc1
  v_add_f32 v226, v226, v221
  v_cvt_pk_bf16_f32 v186, v220, v221
  v_mfma_f32_16x16x32_bf16 a[80:83], a[168:171], v[176:179], a[80:83]
  v_exp_f32 v218, v154
  v_add_f32 v226, v226, v222
  v_mfma_f32_16x16x32_bf16 a[84:87], a[168:171], v[180:183], a[84:87]
  buffer_load_dwordx4 v[168:171], v2, s[40:43], s14 offen offset:2048 sc1
  v_add_f32 v226, v226, v223
  v_cvt_pk_bf16_f32 v187, v222, v223
  v_mfma_f32_16x16x32_bf16 a[88:91], a[172:175], v[176:179], a[88:91]
  v_exp_f32 v219, v155
  v_add_f32 v227, v216, v217
  v_mfma_f32_16x16x32_bf16 a[92:95], a[172:175], v[180:183], a[92:95]
  s_waitcnt lgkmcnt(0)
  buffer_load_dwordx4 v[172:175], v2, s[40:43], s14 offen offset:3072 sc1
  v_cvt_pk_bf16_f32 v188, v216, v217
  v_add_f32 v227, v227, v218
  v_mfma_f32_16x16x32_bf16 a[96:99], a[176:179], v[176:179], a[96:99]
  v_exp_f32 v220, v156
  v_add_f32 v227, v227, v219
  v_mfma_f32_16x16x32_bf16 a[100:103], a[176:179], v[180:183], a[100:103]
  s_add_u32 s14, s13, 53248
  buffer_load_dwordx4 v[192:195], v2, s[40:43], s14 offen offset:0 sc1
  v_cvt_pk_bf16_f32 v189, v218, v219
  v_add_f32 v227, v227, v220
  v_mfma_f32_16x16x32_bf16 a[104:107], a[180:183], v[176:179], a[104:107]
  v_exp_f32 v221, v157
  v_exp_f32 v222, v158
  v_mfma_f32_16x16x32_bf16 a[108:111], a[180:183], v[180:183], a[108:111]
  buffer_load_dwordx4 v[196:199], v2, s[40:43], s14 offen offset:1024 sc1
  v_add_f32 v227, v227, v221
  v_mfma_f32_16x16x32_bf16 a[112:115], a[184:187], v[176:179], a[112:115]
  v_exp_f32 v223, v159
  v_cvt_pk_bf16_f32 v190, v220, v221
  v_mfma_f32_16x16x32_bf16 a[116:119], a[184:187], v[180:183], a[116:119]
  buffer_load_dwordx4 v[208:211], v2, s[40:43], s14 offen offset:2048 sc1
  v_add_f32 v227, v227, v222
  v_add_f32 v227, v227, v223
  v_mfma_f32_16x16x32_bf16 a[120:123], a[188:191], v[176:179], a[120:123]
  v_cvt_pk_bf16_f32 v191, v222, v223
  v_max_f32 v5, v226, v227
  v_cmp_lt_f32 vcc, s81, v5
  v_mfma_f32_16x16x32_bf16 a[124:127], a[188:191], v[180:183], a[124:127]
  s_cbranch_vccnz fa_stub30
fa_back30:
  v_add_f32 v230, v230, v226
  v_add_f32 v231, v231, v227
  ds_read_b128 a[160:163], v3 offset:24576
  ds_read_b128 a[164:167], v3 offset:25600
  ds_read_b128 a[168:171], v3 offset:26624
  ds_read_b128 a[172:175], v3 offset:27648
  ds_read_b128 a[176:179], v3 offset:28672
  ds_read_b128 a[180:183], v3 offset:29696
  ds_read_b128 a[184:187], v3 offset:30720
  ds_read_b128 a[188:191], v3 offset:31744
  s_waitcnt lgkmcnt(4)
  v_mfma_f32_16x16x32_bf16 a[64:67], a[160:163], v[184:187], a[64:67]
  v_mfma_f32_16x16x32_bf16 a[68:71], a[160:163], v[188:191], a[68:71]
  s_add_u32 s14, s13, 53248
  buffer_load_dwordx4 v[212:215], v2, s[40:43], s14 offen offset:3072 sc1
  v_mfma_f32_16x16x32_bf16 a[72:75], a[164:167], v[184:187], a[72:75]
  v_mfma_f32_16x16x32_bf16 a[76:79], a[164:167], v[188:191], a[76:79]
  s_add_u32 s14, s13, 57344
  buffer_load_dwordx4 v[232:235], v2, s[40:43], s14 offen offset:0 sc1
  v_mfma_f32_16x16x32_bf16 a[80:83], a[168:171], v[184:187], a[80:83]
  v_mfma_f32_16x16x32_bf16 a[84:87], a[168:171], v[188:191], a[84:87]
  v_mfma_f32_16x16x32_bf16 a[88:91], a[172:175], v[184:187], a[88:91]
  buffer_load_dwordx4 v[236:239], v2, s[40:43], s14 offen offset:1024 sc1
  v_mfma_f32_16x16x32_bf16 a[92:95], a[172:175], v[188:191], a[92:95]
  s_waitcnt lgkmcnt(0)
  v_mfma_f32_16x16x32_bf16 a[96:99], a[176:179], v[184:187], a[96:99]
  v_mfma_f32_16x16x32_bf16 a[100:103], a[176:179], v[188:191], a[100:103]
  buffer_load_dwordx4 v[240:243], v2, s[40:43], s14 offen offset:2048 sc1
  v_mfma_f32_16x16x32_bf16 a[104:107], a[180:183], v[184:187], a[104:107]
  v_mfma_f32_16x16x32_bf16 a[108:111], a[180:183], v[188:191], a[108:111]
  v_mfma_f32_16x16x32_bf16 a[112:115], a[184:187], v[184:187], a[112:115]
  buffer_load_dwordx4 v[244:247], v2, s[40:43], s14 offen offset:3072 sc1
  v_mfma_f32_16x16x32_bf16 a[116:119], a[184:187], v[188:191], a[116:119]
  v_mfma_f32_16x16x32_bf16 a[120:123], a[188:191], v[184:187], a[120:123]
  v_mfma_f32_16x16x32_bf16 a[124:127], a[188:191], v[188:191], a[124:127]
  v_add_u32 v3, 32768, v3
  v_and_b32 v3, 0x1ffff, v3
fa_Bdone:
  s_cmp_ge_u32 s20, 2
  s_cbranch_scc1 fa_epi
  s_barrier
fa_epi:
  v_mov_b32 v20, v230
  v_mov_b32 v21, v231
  s_nop 1
  v_permlane16_swap_b32 v230, v20
  v_permlane16_swap_b32 v231, v21
  v_add_f32 v230, v230, v20
  v_add_f32 v231, v231, v21
  v_mov_b32 v20, v230
  v_mov_b32 v21, v231
  s_nop 1
  v_permlane32_swap_b32 v230, v20
  v_permlane32_swap_b32 v231, v21
  v_add_f32 v230, v230, v20
  v_add_f32 v231, v231, v21
  v_rcp_f32 v16, v230
  v_rcp_f32 v18, v231
  s_sub_u32 s23, 15, s22
  s_lshl_b32 s23, s23, 2
  v_mov_b32 v17, v16
  v_mov_b32 v19, v18
  s_add_u32 s23, s23, s20
  s_lshl_b32 s23, s23, 18
  s_lshl_b32 s31, s21, 12
  s_add_u32 s31, s31, 50331648
  s_add_u32 s64, s23, s31
  s_add_u32 s65, s64, 131072
  v_accvgpr_read_b32 v68, a64
  v_accvgpr_read_b32 v69, a65
  v_accvgpr_read_b32 v70, a66
  v_accvgpr_read_b32 v71, a67
  v_accvgpr_read_b32 v72, a72
  v_accvgpr_read_b32 v73, a73
  v_accvgpr_read_b32 v74, a74
  v_accvgpr_read_b32 v75, a75
  v_pk_mul_f32 v[68:69], v[68:69], v[16:17]
  v_pk_mul_f32 v[70:71], v[70:71], v[16:17]
  v_pk_mul_f32 v[72:73], v[72:73], v[16:17]
  v_pk_mul_f32 v[74:75], v[74:75], v[16:17]
  v_cvt_pk_bf16_f32 v64, v68, v69
  v_cvt_pk_bf16_f32 v65, v70, v71
  v_cvt_pk_bf16_f32 v66, v72, v73
  v_cvt_pk_bf16_f32 v67, v74, v75
  buffer_store_dwordx4 v[64:67], v2, s[40:43], s64 offen offset:0 sc1
  v_accvgpr_read_b32 v80, a80
  v_accvgpr_read_b32 v81, a81
  v_accvgpr_read_b32 v82, a82
  v_accvgpr_read_b32 v83, a83
  v_accvgpr_read_b32 v84, a88
  v_accvgpr_read_b32 v85, a89
  v_accvgpr_read_b32 v86, a90
  v_accvgpr_read_b32 v87, a91
  v_pk_mul_f32 v[80:81], v[80:81], v[16:17]
  v_pk_mul_f32 v[82:83], v[82:83], v[16:17]
  v_pk_mul_f32 v[84:85], v[84:85], v[16:17]
  v_pk_mul_f32 v[86:87], v[86:87], v[16:17]
  v_cvt_pk_bf16_f32 v76, v80, v81
  v_cvt_pk_bf16_f32 v77, v82, v83
  v_cvt_pk_bf16_f32 v78, v84, v85
  v_cvt_pk_bf16_f32 v79, v86, v87
  buffer_store_dwordx4 v[76:79], v2, s[40:43], s64 offen offset:1024 sc1
  v_accvgpr_read_b32 v132, a96
  v_accvgpr_read_b32 v133, a97
  v_accvgpr_read_b32 v134, a98
  v_accvgpr_read_b32 v135, a99
  v_accvgpr_read_b32 v136, a104
  v_accvgpr_read_b32 v137, a105
  v_accvgpr_read_b32 v138, a106
  v_accvgpr_read_b32 v139, a107
  v_pk_mul_f32 v[132:133], v[132:133], v[16:17]
  v_pk_mul_f32 v[134:135], v[134:135], v[16:17]
  v_pk_mul_f32 v[136:137], v[136:137], v[16:17]
  v_pk_mul_f32 v[138:139], v[138:139], v[16:17]
  v_cvt_pk_bf16_f32 v128, v132, v133
  v_cvt_pk_bf16_f32 v129, v134, v135
  v_cvt_pk_bf16_f32 v130, v136, v137
  v_cvt_pk_bf16_f32 v131, v138, v139
  buffer_store_dwordx4 v[128:131], v2, s[40:43], s64 offen offset:2048 sc1
  v_accvgpr_read_b32 v144, a112
  v_accvgpr_read_b32 v145, a113
  v_accvgpr_read_b32 v146, a114
  v_accvgpr_read_b32 v147, a115
  v_accvgpr_read_b32 v148, a120
  v_accvgpr_read_b32 v149, a121
  v_accvgpr_read_b32 v150, a122
  v_accvgpr_read_b32 v151, a123
  v_pk_mul_f32 v[144:145], v[144:145], v[16:17]
  v_pk_mul_f32 v[146:147], v[146:147], v[16:17]
  v_pk_mul_f32 v[148:149], v[148:149], v[16:17]
  v_pk_mul_f32 v[150:151], v[150:151], v[16:17]
  v_cvt_pk_bf16_f32 v140, v144, v145
  v_cvt_pk_bf16_f32 v141, v146, v147
  v_cvt_pk_bf16_f32 v142, v148, v149
  v_cvt_pk_bf16_f32 v143, v150, v151
  buffer_store_dwordx4 v[140:143], v2, s[40:43], s64 offen offset:3072 sc1
  v_accvgpr_read_b32 v68, a68
  v_accvgpr_read_b32 v69, a69
  v_accvgpr_read_b32 v70, a70
  v_accvgpr_read_b32 v71, a71
  v_accvgpr_read_b32 v72, a76
  v_accvgpr_read_b32 v73, a77
  v_accvgpr_read_b32 v74, a78
  v_accvgpr_read_b32 v75, a79
  v_pk_mul_f32 v[68:69], v[68:69], v[18:19]
  v_pk_mul_f32 v[70:71], v[70:71], v[18:19]
  v_pk_mul_f32 v[72:73], v[72:73], v[18:19]
  v_pk_mul_f32 v[74:75], v[74:75], v[18:19]
  v_cvt_pk_bf16_f32 v64, v68, v69
  v_cvt_pk_bf16_f32 v65, v70, v71
  v_cvt_pk_bf16_f32 v66, v72, v73
  v_cvt_pk_bf16_f32 v67, v74, v75
  buffer_store_dwordx4 v[64:67], v2, s[40:43], s65 offen offset:0 sc1
  v_accvgpr_read_b32 v80, a84
  v_accvgpr_read_b32 v81, a85
  v_accvgpr_read_b32 v82, a86
  v_accvgpr_read_b32 v83, a87
  v_accvgpr_read_b32 v84, a92
  v_accvgpr_read_b32 v85, a93
  v_accvgpr_read_b32 v86, a94
  v_accvgpr_read_b32 v87, a95
  v_pk_mul_f32 v[80:81], v[80:81], v[18:19]
  v_pk_mul_f32 v[82:83], v[82:83], v[18:19]
  v_pk_mul_f32 v[84:85], v[84:85], v[18:19]
  v_pk_mul_f32 v[86:87], v[86:87], v[18:19]
  v_cvt_pk_bf16_f32 v76, v80, v81
  v_cvt_pk_bf16_f32 v77, v82, v83
  v_cvt_pk_bf16_f32 v78, v84, v85
  v_cvt_pk_bf16_f32 v79, v86, v87
  buffer_store_dwordx4 v[76:79], v2, s[40:43], s65 offen offset:1024 sc1
  v_accvgpr_read_b32 v132, a100
  v_accvgpr_read_b32 v133, a101
  v_accvgpr_read_b32 v134, a102
  v_accvgpr_read_b32 v135, a103
  v_accvgpr_read_b32 v136, a108
  v_accvgpr_read_b32 v137, a109
  v_accvgpr_read_b32 v138, a110
  v_accvgpr_read_b32 v139, a111
  v_pk_mul_f32 v[132:133], v[132:133], v[18:19]
  v_pk_mul_f32 v[134:135], v[134:135], v[18:19]
  v_pk_mul_f32 v[136:137], v[136:137], v[18:19]
  v_pk_mul_f32 v[138:139], v[138:139], v[18:19]
  v_cvt_pk_bf16_f32 v128, v132, v133
  v_cvt_pk_bf16_f32 v129, v134, v135
  v_cvt_pk_bf16_f32 v130, v136, v137
  v_cvt_pk_bf16_f32 v131, v138, v139
  buffer_store_dwordx4 v[128:131], v2, s[40:43], s65 offen offset:2048 sc1
  v_accvgpr_read_b32 v144, a116
  v_accvgpr_read_b32 v145, a117
  v_accvgpr_read_b32 v146, a118
  v_accvgpr_read_b32 v147, a119
  v_accvgpr_read_b32 v148, a124
  v_accvgpr_read_b32 v149, a125
  v_accvgpr_read_b32 v150, a126
  v_accvgpr_read_b32 v151, a127
  v_pk_mul_f32 v[144:145], v[144:145], v[18:19]
  v_pk_mul_f32 v[146:147], v[146:147], v[18:19]
  v_pk_mul_f32 v[148:149], v[148:149], v[18:19]
  v_pk_mul_f32 v[150:151], v[150:151], v[18:19]
  v_cvt_pk_bf16_f32 v140, v144, v145
  v_cvt_pk_bf16_f32 v141, v146, v147
  v_cvt_pk_bf16_f32 v142, v148, v149
  v_cvt_pk_bf16_f32 v143, v150, v151
  buffer_store_dwordx4 v[140:143], v2, s[40:43], s65 offen offset:3072 sc1
  s_cmp_lt_u32 s12, 3
  s_cbranch_scc1 fa_hk9
fa_hb9:
  s_load_dwordx2 s[4:5], s[0:1], 0
  s_load_dwordx2 s[6:7], s[0:1], 88
  v_mov_b32 v30, 1073741824
  v_mov_b32 v31, 1
  v_writelane_b32 v30, s80, 0
  v_writelane_b32 v30, s3, 1
  s_lshl_b32 s64, s21, 19
  s_lshl_b32 s23, s20, 15
  s_add_u32 s64, s64, s23
  s_add_u32 s64, s64, 50331648
  s_add_u32 s65, s64, 131072
  s_add_u32 s66, s64, 262144
  s_add_u32 s67, s64, 393216
  v_bfe_u32 v12, v1, 3, 1
  v_lshlrev_b32 v12, 7, v12
  v_and_b32 v13, 7, v1
  v_lshl_add_u32 v12, v13, 2, v12
  s_lshl_b32 s23, s21, 8
  s_lshl_b32 s31, s20, 5
  s_add_u32 s23, s23, s31
  s_add_u32 s23, s23, 2641920
  v_add_u32 v12, s23, v12
  s_lshl_b32 s25, s21, 6
  s_mul_i32 s26, s22, 160
  s_mul_i32 s27, s22, 2560
  v_add_u32 v16, 0, v0
  v_mul_u32_u24 v17, 6554, v16
  v_lshrrev_b32 v17, 16, v17
  v_mul_u32_u24 v18, 10, v17
  v_sub_u32 v18, v16, v18
  v_mul_u32_u24 v251, 336, v17
  v_lshl_add_u32 v251, v18, 5, v251
  v_lshlrev_b32 v203, 5, v18
  v_add_u32 v17, s25, v17
  v_add_u32 v24, 1, v17
  v_mul_u32_u24 v248, 1280, v17
  v_lshl_add_u32 v248, v18, 4, v248
  v_add_u32 v248, s26, v248
  v_lshrrev_b32 v19, 4, v17
  v_mul_u32_u24 v19, 20480, v19
  v_and_b32 v17, 15, v17
  v_lshl_add_u32 v19, v17, 4, v19
  v_lshl_add_u32 v200, v18, 8, v19
  v_mov_b32 v27, 8
  v_add_u32 v16, 256, v0
  v_mul_u32_u24 v17, 6554, v16
  v_lshrrev_b32 v17, 16, v17
  v_mul_u32_u24 v18, 10, v17
  v_sub_u32 v18, v16, v18
  v_mul_u32_u24 v252, 336, v17
  v_lshl_add_u32 v252, v18, 5, v252
  v_lshlrev_b32 v204, 5, v18
  v_add_u32 v17, s25, v17
  v_add_u32 v25, 1, v17
  v_mul_u32_u24 v249, 1280, v17
  v_lshl_add_u32 v249, v18, 4, v249
  v_add_u32 v249, s26, v249
  v_lshrrev_b32 v19, 4, v17
  v_mul_u32_u24 v19, 20480, v19
  v_and_b32 v17, 15, v17
  v_lshl_add_u32 v19, v17, 4, v19
  v_lshl_add_u32 v201, v18, 8, v19
  v_mov_b32 v28, 8
  v_add_u32 v16, 512, v0
  v_mul_u32_u24 v17, 6554, v16
  v_lshrrev_b32 v17, 16, v17
  v_mul_u32_u24 v18, 10, v17
  v_sub_u32 v18, v16, v18
  v_mul_u32_u24 v253, 336, v17
  v_lshl_add_u32 v253, v18, 5, v253
  v_lshlrev_b32 v205, 5, v18
  v_add_u32 v17, s25, v17
  v_add_u32 v26, 1, v17
  v_mul_u32_u24 v250, 1280, v17
  v_lshl_add_u32 v250, v18, 4, v250
  v_add_u32 v250, s26, v250
  v_lshrrev_b32 v19, 4, v17
  v_mul_u32_u24 v19, 20480, v19
  v_and_b32 v17, 15, v17
  v_lshl_add_u32 v19, v17, 4, v19
  v_lshl_add_u32 v202, v18, 8, v19
  v_mov_b32 v29, 8
  v_cmp_gt_u32 vcc, 128, v0
  v_mov_b32 v16, 1073741824
  v_mov_b32 v17, 0
  v_cndmask_b32 v250, v16, v250, vcc
  v_cndmask_b32 v202, v16, v202, vcc
  v_cndmask_b32 v253, v17, v253, vcc
  v_mov_b32 v20, 0
  v_mov_b32 v21, 0
  v_mov_b32 v22, 0
  v_mov_b32 v23, 0
  v_add_u32 v16, 158208, v2
  ds_write_b128 v16, v[20:23]
  s_cmp_lt_u32 s12, 3
  s_waitcnt vmcnt(18) lgkmcnt(0)
  s_cbranch_scc1 fa_pub
  s_waitcnt vmcnt(0)
fa_pub:
  buffer_store_dword v31, v30, s[40:43], 0 offen sc1
  s_cmp_lt_u32 s12, 3
  s_cbranch_scc1 fa_hk10
fa_hb10:
  s_cmp_lt_u32 s29, 8
  s_cbranch_scc1 fa_left
fa_leftb:
  s_add_u32 s13, s13, 61440
  buffer_load_dwordx4 v[64:67], v2, s[40:43], s13 offen offset:0 sc1
  buffer_load_dwordx4 v[68:71], v2, s[40:43], s13 offen offset:1024 sc1
  buffer_load_dwordx4 v[72:75], v2, s[40:43], s13 offen offset:2048 sc1
  buffer_load_dwordx4 v[76:79], v2, s[40:43], s13 offen offset:3072 sc1
  s_add_u32 s13, s13, 4096
  buffer_load_dwordx4 v[80:83], v2, s[40:43], s13 offen offset:0 sc1
  buffer_load_dwordx4 v[84:87], v2, s[40:43], s13 offen offset:1024 sc1
  buffer_load_dwordx4 v[88:91], v2, s[40:43], s13 offen offset:2048 sc1
  buffer_load_dwordx4 v[92:95], v2, s[40:43], s13 offen offset:3072 sc1
  s_add_u32 s13, s13, 4096
  buffer_load_dwordx4 v[128:131], v2, s[40:43], s13 offen offset:0 sc1
  buffer_load_dwordx4 v[132:135], v2, s[40:43], s13 offen offset:1024 sc1
  buffer_load_dwordx4 v[136:139], v2, s[40:43], s13 offen offset:2048 sc1
  buffer_load_dwordx4 v[140:143], v2, s[40:43], s13 offen offset:3072 sc1
  s_add_u32 s13, s13, 4096
  buffer_load_dwordx4 v[144:147], v2, s[40:43], s13 offen offset:0 sc1
  buffer_load_dwordx4 v[148:151], v2, s[40:43], s13 offen offset:1024 sc1
  buffer_load_dwordx4 v[152:155], v2, s[40:43], s13 offen offset:2048 sc1
  buffer_load_dwordx4 v[156:159], v2, s[40:43], s13 offen offset:3072 sc1
  s_add_u32 s13, s13, 4096
  buffer_load_dwordx4 v[176:179], v2, s[40:43], s13 offen offset:0 sc1
  buffer_load_dwordx4 v[180:183], v2, s[40:43], s13 offen offset:1024 sc1
  buffer_load_dwordx4 v[184:187], v2, s[40:43], s13 offen offset:2048 sc1
  buffer_load_dwordx4 v[188:191], v2, s[40:43], s13 offen offset:3072 sc1
  s_add_u32 s13, s13, 4096
  s_barrier
  s_add_u32 s14, s13, 45056
  s_mul_i32 s23, s20, 38912
  v_add_u32 v11, s23, v2
  s_add_u32 m0, s23, 0
  s_nop 0
  buffer_load_dwordx4 v2, s[40:43], s14 offen offset:0 sc1 lds
  buffer_load_dwordx4 v2, s[40:43], s14 offen offset:1024 sc1 lds
  buffer_load_dwordx4 v2, s[40:43], s14 offen offset:2048 sc1 lds
  buffer_load_dwordx4 v2, s[40:43], s14 offen offset:3072 sc1 lds
  s_add_u32 s14, s14, 4096
  s_add_u32 m0, s23, 4096
  s_nop 0
  buffer_load_dwordx4 v2, s[40:43], s14 offen offset:0 sc1 lds
  buffer_load_dwordx4 v2, s[40:43], s14 offen offset:1024 sc1 lds
  buffer_load_dwordx4 v2, s[40:43], s14 offen offset:2048 sc1 lds
  buffer_load_dwordx4 v2, s[40:43], s14 offen offset:3072 sc1 lds
  s_add_u32 s14, s14, 4096
  s_add_u32 m0, s23, 8192
  s_nop 0
  buffer_load_dwordx4 v2, s[40:43], s14 offen offset:0 sc1 lds
  buffer_load_dwordx4 v2, s[40:43], s14 offen offset:1024 sc1 lds
  buffer_load_dwordx4 v2, s[40:43], s14 offen offset:2048 sc1 lds
  buffer_load_dwordx4 v2, s[40:43], s14 offen offset:3072 sc1 lds
  s_add_u32 s14, s14, 4096
  s_add_u32 m0, s23, 12288
  s_nop 0
  buffer_load_dwordx4 v2, s[40:43], s14 offen offset:0 sc1 lds
  buffer_load_dwordx4 v2, s[40:43], s14 offen offset:1024 sc1 lds
  buffer_load_dwordx4 v2, s[40:43], s14 offen offset:2048 sc1 lds
  buffer_load_dwordx4 v2, s[40:43], s14 offen offset:3072 sc1 lds
  s_add_u32 s14, s14, 4096
  s_add_u32 m0, s23, 16384
  s_nop 0
  buffer_load_dwordx4 v2, s[40:43], s14 offen offset:0 sc1 lds
  buffer_load_dwordx4 v2, s[40:43], s14 offen offset:1024 sc1 lds
  buffer_load_dwordx4 v2, s[40:43], s14 offen offset:2048 sc1 lds
  buffer_load_dwordx4 v2, s[40:43], s14 offen offset:3072 sc1 lds
  s_add_u32 s14, s14, 4096
  s_add_u32 m0, s23, 20480
  s_nop 0
  buffer_load_dwordx4 v2, s[40:43], s14 offen offset:0 sc1 lds
  buffer_load_dwordx4 v2, s[40:43], s14 offen offset:1024 sc1 lds
  buffer_load_dwordx4 v2, s[40:43], s14 offen offset:2048 sc1 lds
  buffer_load_dwordx4 v2, s[40:43], s14 offen offset:3072 sc1 lds
  s_add_u32 s14, s14, 4096
  buffer_load_dword v13, v12, s[40:43], 0 offen sc1
  s_add_u32 m0, s23, 24576
  s_nop 0
  buffer_load_dwordx4 v2, s[40:43], s14 offen offset:0 sc1 lds
  buffer_load_dwordx4 v2, s[40:43], s14 offen offset:1024 sc1 lds
  buffer_load_dwordx4 v2, s[40:43], s14 offen offset:2048 sc1 lds
  buffer_load_dwordx4 v2, s[40:43], s14 offen offset:3072 sc1 lds
  s_add_u32 s14, s14, 4096
  s_add_u32 m0, s23, 28672
  s_nop 0
  buffer_load_dwordx4 v2, s[40:43], s14 offen offset:0 sc1 lds
  buffer_load_dwordx4 v2, s[40:43], s14 offen offset:1024 sc1 lds
  buffer_load_dwordx4 v2, s[40:43], s14 offen offset:2048 sc1 lds
  buffer_load_dwordx4 v2, s[40:43], s14 offen offset:3072 sc1 lds
  s_add_u32 s14, s14, 4096
  s_add_u32 m0, s23, 32768
  s_nop 0
  buffer_load_dwordx4 v2, s[40:43], s14 offen offset:0 sc1 lds
  buffer_load_dwordx4 v2, s[40:43], s14 offen offset:1024 sc1 lds
  buffer_load_dwordx4 v2, s[40:43], s14 offen offset:2048 sc1 lds
  buffer_load_dwordx4 v2, s[40:43], s14 offen offset:3072 sc1 lds
  s_add_u32 s14, s14, 4096
  s_mov_b32 s44, s4
  s_mov_b32 s45, s5
  s_mov_b32 s46, 2621440
  s_mov_b32 s47, 0x20000
  s_mov_b32 s48, s6
  s_mov_b32 s49, s7
  s_mov_b32 s50, 2621440
  s_mov_b32 s51, 0x20000
  v_readlane_b32 s68, v15, 0
  v_readlane_b32 s69, v15, 1
  v_readlane_b32 s70, v15, 2
  v_readlane_b32 s71, v15, 3
  v_readlane_b32 s72, v15, 4
  v_readlane_b32 s73, v15, 5
  v_readlane_b32 s74, v15, 6
  v_readlane_b32 s75, v15, 7
  v_cmp_eq_u32 s[52:53], s68, v24
  v_cmp_eq_u32 s[54:55], s68, v25
  v_cmp_eq_u32 s[56:57], s68, v26
  v_cndmask_b32 v27, v27, 0, s[52:53]
  v_cndmask_b32 v28, v28, 0, s[54:55]
  v_cndmask_b32 v29, v29, 0, s[56:57]
  v_cmp_eq_u32 s[52:53], s69, v24
  v_cmp_eq_u32 s[54:55], s69, v25
  v_cmp_eq_u32 s[56:57], s69, v26
  v_cndmask_b32 v27, v27, 1, s[52:53]
  v_cndmask_b32 v28, v28, 1, s[54:55]
  v_cndmask_b32 v29, v29, 1, s[56:57]
  v_cmp_eq_u32 s[52:53], s70, v24
  v_cmp_eq_u32 s[54:55], s70, v25
  v_cmp_eq_u32 s[56:57], s70, v26
  v_cndmask_b32 v27, v27, 2, s[52:53]
  v_cndmask_b32 v28, v28, 2, s[54:55]
  v_cndmask_b32 v29, v29, 2, s[56:57]
  v_cmp_eq_u32 s[52:53], s71, v24
  v_cmp_eq_u32 s[54:55], s71, v25
  v_cmp_eq_u32 s[56:57], s71, v26
  v_cndmask_b32 v27, v27, 3, s[52:53]
  v_cndmask_b32 v28, v28, 3, s[54:55]
  v_cndmask_b32 v29, v29, 3, s[56:57]
  v_cmp_eq_u32 s[52:53], s72, v24
  v_cmp_eq_u32 s[54:55], s72, v25
  v_cmp_eq_u32 s[56:57], s72, v26
  v_cndmask_b32 v27, v27, 4, s[52:53]
  v_cndmask_b32 v28, v28, 4, s[54:55]
  v_cndmask_b32 v29, v29, 4, s[56:57]
  v_cmp_eq_u32 s[52:53], s73, v24
  v_cmp_eq_u32 s[54:55], s73, v25
  v_cmp_eq_u32 s[56:57], s73, v26
  v_cndmask_b32 v27, v27, 5, s[52:53]
  v_cndmask_b32 v28, v28, 5, s[54:55]
  v_cndmask_b32 v29, v29, 5, s[56:57]
  v_cmp_eq_u32 s[52:53], s74, v24
  v_cmp_eq_u32 s[54:55], s74, v25
  v_cmp_eq_u32 s[56:57], s74, v26
  v_cndmask_b32 v27, v27, 6, s[52:53]
  v_cndmask_b32 v28, v28, 6, s[54:55]
  v_cndmask_b32 v29, v29, 6, s[56:57]
  v_cmp_eq_u32 s[52:53], s75, v24
  v_cmp_eq_u32 s[54:55], s75, v25
  v_cmp_eq_u32 s[56:57], s75, v26
  v_cndmask_b32 v27, v27, 7, s[52:53]
  v_cndmask_b32 v28, v28, 7, s[54:55]
  v_cndmask_b32 v29, v29, 7, s[56:57]
  v_mul_u32_u24 v27, 320, v27
  v_add_u32 v203, v203, v27
  v_mul_u32_u24 v28, 320, v28
  v_add_u32 v204, v204, v28
  v_mul_u32_u24 v29, 320, v29
  v_add_u32 v205, v205, v29
  v_add_u32 v203, 155648, v203
  v_add_u32 v204, 155648, v204
  v_add_u32 v205, 155648, v205
  s_waitcnt vmcnt(12)
  v_cmp_eq_u32 vcc, 0, v13
  s_cbranch_vccnz fa_ctx_spin
fa_ctx_ok:
  buffer_load_dwordx4 a[144:147], v2, s[40:43], s64 offen offset:0 sc1
  buffer_load_dwordx4 a[148:151], v2, s[40:43], s65 offen offset:0 sc1
  buffer_load_dwordx4 a[152:155], v2, s[40:43], s66 offen offset:0 sc1
  buffer_load_dwordx4 a[156:159], v2, s[40:43], s67 offen offset:0 sc1
  buffer_load_dwordx4 a[160:163], v2, s[40:43], s64 offen offset:1024 sc1
  buffer_load_dwordx4 a[164:167], v2, s[40:43], s65 offen offset:1024 sc1
  buffer_load_dwordx4 a[168:171], v2, s[40:43], s66 offen offset:1024 sc1
  buffer_load_dwordx4 a[172:175], v2, s[40:43], s67 offen offset:1024 sc1
  buffer_load_dwordx4 a[176:179], v2, s[40:43], s64 offen offset:2048 sc1
  buffer_load_dwordx4 a[180:183], v2, s[40:43], s65 offen offset:2048 sc1
  buffer_load_dwordx4 a[184:187], v2, s[40:43], s66 offen offset:2048 sc1
  buffer_load_dwordx4 a[188:191], v2, s[40:43], s67 offen offset:2048 sc1
  buffer_load_dwordx4 v[216:219], v2, s[40:43], s64 offen offset:3072 sc1
  buffer_load_dwordx4 v[220:223], v2, s[40:43], s65 offen offset:3072 sc1
  buffer_load_dwordx4 v[224:227], v2, s[40:43], s66 offen offset:3072 sc1
  buffer_load_dwordx4 v[228:231], v2, s[40:43], s67 offen offset:3072 sc1
  s_add_u32 s64, s64, 4096
  s_add_u32 s65, s65, 4096
  s_add_u32 s66, s66, 4096
  s_add_u32 s67, s67, 4096
  s_waitcnt vmcnt(12)
  v_mfma_f32_16x16x32_bf16 a[64:67], a[0:3], a[144:147], 0
  v_mfma_f32_16x16x32_bf16 a[68:71], a[0:3], a[148:151], 0
  v_mfma_f32_16x16x32_bf16 a[72:75], a[0:3], a[152:155], 0
  v_mfma_f32_16x16x32_bf16 a[76:79], a[0:3], a[156:159], 0
  buffer_load_dwordx4 a[0:3], v2, s[40:43], s13 offen offset:0 sc1
  v_mfma_f32_16x16x32_bf16 a[80:83], a[4:7], a[144:147], 0
  v_mfma_f32_16x16x32_bf16 a[84:87], a[4:7], a[148:151], 0
  v_mfma_f32_16x16x32_bf16 a[88:91], a[4:7], a[152:155], 0
  v_mfma_f32_16x16x32_bf16 a[92:95], a[4:7], a[156:159], 0
  buffer_load_dwordx4 a[4:7], v2, s[40:43], s13 offen offset:1024 sc1
  v_mfma_f32_16x16x32_bf16 a[96:99], a[8:11], a[144:147], 0
  v_mfma_f32_16x16x32_bf16 a[100:103], a[8:11], a[148:151], 0
  v_mfma_f32_16x16x32_bf16 a[104:107], a[8:11], a[152:155], 0
  v_mfma_f32_16x16x32_bf16 a[108:111], a[8:11], a[156:159], 0
  buffer_load_dwordx4 a[8:11], v2, s[40:43], s13 offen offset:2048 sc1
  v_mfma_f32_16x16x32_bf16 a[112:115], a[12:15], a[144:147], 0
  v_mfma_f32_16x16x32_bf16 a[116:119], a[12:15], a[148:151], 0
  v_mfma_f32_16x16x32_bf16 a[120:123], a[12:15], a[152:155], 0
  v_mfma_f32_16x16x32_bf16 a[124:127], a[12:15], a[156:159], 0
  v_mfma_f32_16x16x32_bf16 a[128:131], a[16:19], a[144:147], 0
  buffer_load_dwordx4 a[144:147], v2, s[40:43], s64 offen offset:0 sc1
  v_mfma_f32_16x16x32_bf16 a[132:135], a[16:19], a[148:151], 0
  buffer_load_dwordx4 a[148:151], v2, s[40:43], s65 offen offset:0 sc1
  v_mfma_f32_16x16x32_bf16 a[136:139], a[16:19], a[152:155], 0
  buffer_load_dwordx4 a[152:155], v2, s[40:43], s66 offen offset:0 sc1
  v_mfma_f32_16x16x32_bf16 a[140:143], a[16:19], a[156:159], 0
  buffer_load_dwordx4 a[156:159], v2, s[40:43], s67 offen offset:0 sc1
  s_waitcnt vmcnt(15)
  v_mfma_f32_16x16x32_bf16 a[64:67], a[20:23], a[160:163], a[64:67]
  v_mfma_f32_16x16x32_bf16 a[68:71], a[20:23], a[164:167], a[68:71]
  v_mfma_f32_16x16x32_bf16 a[72:75], a[20:23], a[168:171], a[72:75]
  v_mfma_f32_16x16x32_bf16 a[76:79], a[20:23], a[172:175], a[76:79]
  buffer_load_dwordx4 a[12:15], v2, s[40:43], s13 offen offset:3072 sc1
  v_mfma_f32_16x16x32_bf16 a[80:83], a[24:27], a[160:163], a[80:83]
  s_add_u32 s13, s13, 4096
  v_mfma_f32_16x16x32_bf16 a[84:87], a[24:27], a[164:167], a[84:87]
  v_mfma_f32_16x16x32_bf16 a[88:91], a[24:27], a[168:171], a[88:91]
  v_mfma_f32_16x16x32_bf16 a[92:95], a[24:27], a[172:175], a[92:95]
  buffer_load_dwordx4 a[16:19], v2, s[40:43], s13 offen offset:0 sc1
  v_mfma_f32_16x16x32_bf16 a[96:99], a[28:31], a[160:163], a[96:99]
  v_mfma_f32_16x16x32_bf16 a[100:103], a[28:31], a[164:167], a[100:103]
  v_mfma_f32_16x16x32_bf16 a[104:107], a[28:31], a[168:171], a[104:107]
  v_mfma_f32_16x16x32_bf16 a[108:111], a[28:31], a[172:175], a[108:111]
  v_mfma_f32_16x16x32_bf16 a[112:115], a[32:35], a[160:163], a[112:115]
  v_mfma_f32_16x16x32_bf16 a[116:119], a[32:35], a[164:167], a[116:119]
  v_mfma_f32_16x16x32_bf16 a[120:123], a[32:35], a[168:171], a[120:123]
  v_mfma_f32_16x16x32_bf16 a[124:127], a[32:35], a[172:175], a[124:127]
  v_mfma_f32_16x16x32_bf16 a[128:131], a[36:39], a[160:163], a[128:131]
  buffer_load_dwordx4 a[160:163], v2, s[40:43], s64 offen offset:1024 sc1
  v_mfma_f32_16x16x32_bf16 a[132:135], a[36:39], a[164:167], a[132:135]
  buffer_load_dwordx4 a[164:167], v2, s[40:43], s65 offen offset:1024 sc1
  v_mfma_f32_16x16x32_bf16 a[136:139], a[36:39], a[168:171], a[136:139]
  buffer_load_dwordx4 a[168:171], v2, s[40:43], s66 offen offset:1024 sc1
  v_mfma_f32_16x16x32_bf16 a[140:143], a[36:39], a[172:175], a[140:143]
  buffer_load_dwordx4 a[172:175], v2, s[40:43], s67 offen offset:1024 sc1
  s_waitcnt vmcnt(17)
  v_mfma_f32_16x16x32_bf16 a[64:67], a[40:43], a[176:179], a[64:67]
  v_mfma_f32_16x16x32_bf16 a[68:71], a[40:43], a[180:183], a[68:71]
  v_mfma_f32_16x16x32_bf16 a[72:75], a[40:43], a[184:187], a[72:75]
  v_mfma_f32_16x16x32_bf16 a[76:79], a[40:43], a[188:191], a[76:79]
  buffer_load_dwordx4 a[20:23], v2, s[40:43], s13 offen offset:1024 sc1
  v_mfma_f32_16x16x32_bf16 a[80:83], a[44:47], a[176:179], a[80:83]
  v_mfma_f32_16x16x32_bf16 a[84:87], a[44:47], a[180:183], a[84:87]
  v_mfma_f32_16x16x32_bf16 a[88:91], a[44:47], a[184:187], a[88:91]
  v_mfma_f32_16x16x32_bf16 a[92:95], a[44:47], a[188:191], a[92:95]
  buffer_load_dwordx4 a[24:27], v2, s[40:43], s13 offen offset:2048 sc1
  v_mfma_f32_16x16x32_bf16 a[96:99], a[48:51], a[176:179], a[96:99]
  v_mfma_f32_16x16x32_bf16 a[100:103], a[48:51], a[180:183], a[100:103]
  v_mfma_f32_16x16x32_bf16 a[104:107], a[48:51], a[184:187], a[104:107]
  v_mfma_f32_16x16x32_bf16 a[108:111], a[48:51], a[188:191], a[108:111]
  v_mfma_f32_16x16x32_bf16 a[112:115], a[52:55], a[176:179], a[112:115]
  v_mfma_f32_16x16x32_bf16 a[116:119], a[52:55], a[180:183], a[116:119]
  v_mfma_f32_16x16x32_bf16 a[120:123], a[52:55], a[184:187], a[120:123]
  v_mfma_f32_16x16x32_bf16 a[124:127], a[52:55], a[188:191], a[124:127]
  v_mfma_f32_16x16x32_bf16 a[128:131], a[56:59], a[176:179], a[128:131]
  buffer_load_dwordx4 a[176:179], v2, s[40:43], s64 offen offset:2048 sc1
  v_mfma_f32_16x16x32_bf16 a[132:135], a[56:59], a[180:183], a[132:135]
  buffer_load_dwordx4 a[180:183], v2, s[40:43], s65 offen offset:2048 sc1
  v_mfma_f32_16x16x32_bf16 a[136:139], a[56:59], a[184:187], a[136:139]
  buffer_load_dwordx4 a[184:187], v2, s[40:43], s66 offen offset:2048 sc1
  v_mfma_f32_16x16x32_bf16 a[140:143], a[56:59], a[188:191], a[140:143]
  buffer_load_dwordx4 a[188:191], v2, s[40:43], s67 offen offset:2048 sc1
  s_waitcnt vmcnt(19)
  v_mfma_f32_16x16x32_bf16 a[64:67], a[60:63], v[216:219], a[64:67]
  v_mfma_f32_16x16x32_bf16 a[68:71], a[60:63], v[220:223], a[68:71]
  v_mfma_f32_16x16x32_bf16 a[72:75], a[60:63], v[224:227], a[72:75]
  v_mfma_f32_16x16x32_bf16 a[76:79], a[60:63], v[228:231], a[76:79]
  buffer_load_dwordx4 a[28:31], v2, s[40:43], s13 offen offset:3072 sc1
  v_mfma_f32_16x16x32_bf16 a[80:83], a[192:195], v[216:219], a[80:83]
  s_add_u32 s13, s13, 4096
  v_mfma_f32_16x16x32_bf16 a[84:87], a[192:195], v[220:223], a[84:87]
  v_mfma_f32_16x16x32_bf16 a[88:91], a[192:195], v[224:227], a[88:91]
  v_mfma_f32_16x16x32_bf16 a[92:95], a[192:195], v[228:231], a[92:95]
  buffer_load_dwordx4 a[32:35], v2, s[40:43], s13 offen offset:0 sc1
  v_mfma_f32_16x16x32_bf16 a[96:99], a[196:199], v[216:219], a[96:99]
  v_mfma_f32_16x16x32_bf16 a[100:103], a[196:199], v[220:223], a[100:103]
  v_mfma_f32_16x16x32_bf16 a[104:107], a[196:199], v[224:227], a[104:107]
  v_mfma_f32_16x16x32_bf16 a[108:111], a[196:199], v[228:231], a[108:111]
  v_mfma_f32_16x16x32_bf16 a[112:115], a[200:203], v[216:219], a[112:115]
  v_mfma_f32_16x16x32_bf16 a[116:119], a[200:203], v[220:223], a[116:119]
  v_mfma_f32_16x16x32_bf16 a[120:123], a[200:203], v[224:227], a[120:123]
  v_mfma_f32_16x16x32_bf16 a[124:127], a[200:203], v[228:231], a[124:127]
  v_mfma_f32_16x16x32_bf16 a[128:131], a[204:207], v[216:219], a[128:131]
  buffer_load_dwordx4 v[216:219], v2, s[40:43], s64 offen offset:3072 sc1
  v_mfma_f32_16x16x32_bf16 a[132:135], a[204:207], v[220:223], a[132:135]
  buffer_load_dwordx4 v[220:223], v2, s[40:43], s65 offen offset:3072 sc1
  v_mfma_f32_16x16x32_bf16 a[136:139], a[204:207], v[224:227], a[136:139]
  buffer_load_dwordx4 v[224:227], v2, s[40:43], s66 offen offset:3072 sc1
  v_mfma_f32_16x16x32_bf16 a[140:143], a[204:207], v[228:231], a[140:143]
  buffer_load_dwordx4 v[228:231], v2, s[40:43], s67 offen offset:3072 sc1
  s_waitcnt vmcnt(18)
  v_mfma_f32_16x16x32_bf16 a[64:67], a[208:211], a[144:147], a[64:67]
  s_add_u32 s64, s64, 4096
  v_mfma_f32_16x16x32_bf16 a[68:71], a[208:211], a[148:151], a[68:71]
  s_add_u32 s65, s65, 4096
  v_mfma_f32_16x16x32_bf16 a[72:75], a[208:211], a[152:155], a[72:75]
  s_add_u32 s66, s66, 4096
  v_mfma_f32_16x16x32_bf16 a[76:79], a[208:211], a[156:159], a[76:79]
  buffer_load_dwordx4 a[36:39], v2, s[40:43], s13 offen offset:1024 sc1
  v_mfma_f32_16x16x32_bf16 a[80:83], a[212:215], a[144:147], a[80:83]
  v_mfma_f32_16x16x32_bf16 a[84:87], a[212:215], a[148:151], a[84:87]
  v_mfma_f32_16x16x32_bf16 a[88:91], a[212:215], a[152:155], a[88:91]
  s_add_u32 s67, s67, 4096
  v_mfma_f32_16x16x32_bf16 a[92:95], a[212:215], a[156:159], a[92:95]
  buffer_load_dwordx4 a[40:43], v2, s[40:43], s13 offen offset:2048 sc1
  v_mfma_f32_16x16x32_bf16 a[96:99], a[216:219], a[144:147], a[96:99]
  v_mfma_f32_16x16x32_bf16 a[100:103], a[216:219], a[148:151], a[100:103]
  v_mfma_f32_16x16x32_bf16 a[104:107], a[216:219], a[152:155], a[104:107]
  v_mfma_f32_16x16x32_bf16 a[108:111], a[216:219], a[156:159], a[108:111]
  v_mfma_f32_16x16x32_bf16 a[112:115], a[220:223], a[144:147], a[112:115]
  v_mfma_f32_16x16x32_bf16 a[116:119], a[220:223], a[148:151], a[116:119]
  v_mfma_f32_16x16x32_bf16 a[120:123], a[220:223], a[152:155], a[120:123]
  v_mfma_f32_16x16x32_bf16 a[124:127], a[220:223], a[156:159], a[124:127]
  v_mfma_f32_16x16x32_bf16 a[128:131], a[224:227], a[144:147], a[128:131]
  buffer_load_dwordx4 a[144:147], v2, s[40:43], s64 offen offset:0 sc1
  v_mfma_f32_16x16x32_bf16 a[132:135], a[224:227], a[148:151], a[132:135]
  buffer_load_dwordx4 a[148:151], v2, s[40:43], s65 offen offset:0 sc1
  v_mfma_f32_16x16x32_bf16 a[136:139], a[224:227], a[152:155], a[136:139]
  buffer_load_dwordx4 a[152:155], v2, s[40:43], s66 offen offset:0 sc1
  v_mfma_f32_16x16x32_bf16 a[140:143], a[224:227], a[156:159], a[140:143]
  buffer_load_dwordx4 a[156:159], v2, s[40:43], s67 offen offset:0 sc1
  s_waitcnt vmcnt(18)
  v_mfma_f32_16x16x32_bf16 a[64:67], a[228:231], a[160:163], a[64:67]
  v_mfma_f32_16x16x32_bf16 a[68:71], a[228:231], a[164:167], a[68:71]
  v_mfma_f32_16x16x32_bf16 a[72:75], a[228:231], a[168:171], a[72:75]
  v_mfma_f32_16x16x32_bf16 a[76:79], a[228:231], a[172:175], a[76:79]
  buffer_load_dwordx4 a[44:47], v2, s[40:43], s13 offen offset:3072 sc1
  v_mfma_f32_16x16x32_bf16 a[80:83], a[232:235], a[160:163], a[80:83]
  s_add_u32 s13, s13, 4096
  v_mfma_f32_16x16x32_bf16 a[84:87], a[232:235], a[164:167], a[84:87]
  v_mfma_f32_16x16x32_bf16 a[88:91], a[232:235], a[168:171], a[88:91]
  v_mfma_f32_16x16x32_bf16 a[92:95], a[232:235], a[172:175], a[92:95]
  buffer_load_dwordx4 a[48:51], v2, s[40:43], s13 offen offset:0 sc1
  v_mfma_f32_16x16x32_bf16 a[96:99], a[236:239], a[160:163], a[96:99]
  v_mfma_f32_16x16x32_bf16 a[100:103], a[236:239], a[164:167], a[100:103]
  v_mfma_f32_16x16x32_bf16 a[104:107], a[236:239], a[168:171], a[104:107]
  v_mfma_f32_16x16x32_bf16 a[108:111], a[236:239], a[172:175], a[108:111]
  buffer_load_dwordx4 a[52:55], v2, s[40:43], s13 offen offset:1024 sc1
  v_mfma_f32_16x16x32_bf16 a[112:115], a[240:243], a[160:163], a[112:115]
  v_mfma_f32_16x16x32_bf16 a[116:119], a[240:243], a[164:167], a[116:119]
  v_mfma_f32_16x16x32_bf16 a[120:123], a[240:243], a[168:171], a[120:123]
  v_mfma_f32_16x16x32_bf16 a[124:127], a[240:243], a[172:175], a[124:127]
  v_mfma_f32_16x16x32_bf16 a[128:131], a[244:247], a[160:163], a[128:131]
  buffer_load_dwordx4 a[160:163], v2, s[40:43], s64 offen offset:1024 sc1
  v_mfma_f32_16x16x32_bf16 a[132:135], a[244:247], a[164:167], a[132:135]
  buffer_load_dwordx4 a[164:167], v2, s[40:43], s65 offen offset:1024 sc1
  v_mfma_f32_16x16x32_bf16 a[136:139], a[244:247], a[168:171], a[136:139]
  buffer_load_dwordx4 a[168:171], v2, s[40:43], s66 offen offset:1024 sc1
  v_mfma_f32_16x16x32_bf16 a[140:143], a[244:247], a[172:175], a[140:143]
  buffer_load_dwordx4 a[172:175], v2, s[40:43], s67 offen offset:1024 sc1
  s_waitcnt vmcnt(19)
  v_mfma_f32_16x16x32_bf16 a[64:67], a[248:251], a[176:179], a[64:67]
  v_mfma_f32_16x16x32_bf16 a[68:71], a[248:251], a[180:183], a[68:71]
  v_mfma_f32_16x16x32_bf16 a[72:75], a[248:251], a[184:187], a[72:75]
  v_mfma_f32_16x16x32_bf16 a[76:79], a[248:251], a[188:191], a[76:79]
  buffer_load_dwordx4 a[56:59], v2, s[40:43], s13 offen offset:2048 sc1
  v_mfma_f32_16x16x32_bf16 a[80:83], a[252:255], a[176:179], a[80:83]
  v_mfma_f32_16x16x32_bf16 a[84:87], a[252:255], a[180:183], a[84:87]
  v_mfma_f32_16x16x32_bf16 a[88:91], a[252:255], a[184:187], a[88:91]
  v_mfma_f32_16x16x32_bf16 a[92:95], a[252:255], a[188:191], a[92:95]
  buffer_load_dwordx4 a[60:63], v2, s[40:43], s13 offen offset:3072 sc1
  v_mfma_f32_16x16x32_bf16 a[96:99], v[32:35], a[176:179], a[96:99]
  s_add_u32 s13, s13, 4096
  v_mfma_f32_16x16x32_bf16 a[100:103], v[32:35], a[180:183], a[100:103]
  v_mfma_f32_16x16x32_bf16 a[104:107], v[32:35], a[184:187], a[104:107]
  v_mfma_f32_16x16x32_bf16 a[108:111], v[32:35], a[188:191], a[108:111]
  v_mfma_f32_16x16x32_bf16 a[112:115], v[36:39], a[176:179], a[112:115]
  v_mfma_f32_16x16x32_bf16 a[116:119], v[36:39], a[180:183], a[116:119]
  v_mfma_f32_16x16x32_bf16 a[120:123], v[36:39], a[184:187], a[120:123]
  v_mfma_f32_16x16x32_bf16 a[124:127], v[36:39], a[188:191], a[124:127]
  v_mfma_f32_16x16x32_bf16 a[128:131], v[40:43], a[176:179], a[128:131]
  buffer_load_dwordx4 a[176:179], v2, s[40:43], s64 offen offset:2048 sc1
  v_mfma_f32_16x16x32_bf16 a[132:135], v[40:43], a[180:183], a[132:135]
  buffer_load_dwordx4 a[180:183], v2, s[40:43], s65 offen offset:2048 sc1
  v_mfma_f32_16x16x32_bf16 a[136:139], v[40:43], a[184:187], a[136:139]
  buffer_load_dwordx4 a[184:187], v2, s[40:43], s66 offen offset:2048 sc1
  v_mfma_f32_16x16x32_bf16 a[140:143], v[40:43], a[188:191], a[140:143]
  buffer_load_dwordx4 a[188:191], v2, s[40:43], s67 offen offset:2048 sc1
  s_waitcnt vmcnt(19)
  v_mfma_f32_16x16x32_bf16 a[64:67], v[44:47], v[216:219], a[64:67]
  v_mfma_f32_16x16x32_bf16 a[68:71], v[44:47], v[220:223], a[68:71]
  v_mfma_f32_16x16x32_bf16 a[72:75], v[44:47], v[224:227], a[72:75]
  v_mfma_f32_16x16x32_bf16 a[76:79], v[44:47], v[228:231], a[76:79]
  buffer_load_dwordx4 a[192:195], v2, s[40:43], s13 offen offset:0 sc1
  v_mfma_f32_16x16x32_bf16 a[80:83], v[48:51], v[216:219], a[80:83]
  v_mfma_f32_16x16x32_bf16 a[84:87], v[48:51], v[220:223], a[84:87]
  v_mfma_f32_16x16x32_bf16 a[88:91], v[48:51], v[224:227], a[88:91]
  v_mfma_f32_16x16x32_bf16 a[92:95], v[48:51], v[228:231], a[92:95]
  buffer_load_dwordx4 a[196:199], v2, s[40:43], s13 offen offset:1024 sc1
  v_mfma_f32_16x16x32_bf16 a[96:99], v[52:55], v[216:219], a[96:99]
  v_mfma_f32_16x16x32_bf16 a[100:103], v[52:55], v[220:223], a[100:103]
  v_mfma_f32_16x16x32_bf16 a[104:107], v[52:55], v[224:227], a[104:107]
  v_mfma_f32_16x16x32_bf16 a[108:111], v[52:55], v[228:231], a[108:111]
  v_mfma_f32_16x16x32_bf16 a[112:115], v[56:59], v[216:219], a[112:115]
  v_mfma_f32_16x16x32_bf16 a[116:119], v[56:59], v[220:223], a[116:119]
  v_mfma_f32_16x16x32_bf16 a[120:123], v[56:59], v[224:227], a[120:123]
  v_mfma_f32_16x16x32_bf16 a[124:127], v[56:59], v[228:231], a[124:127]
  v_mfma_f32_16x16x32_bf16 a[128:131], v[60:63], v[216:219], a[128:131]
  buffer_load_dwordx4 v[216:219], v2, s[40:43], s64 offen offset:3072 sc1
  v_mfma_f32_16x16x32_bf16 a[132:135], v[60:63], v[220:223], a[132:135]
  buffer_load_dwordx4 v[220:223], v2, s[40:43], s65 offen offset:3072 sc1
  v_mfma_f32_16x16x32_bf16 a[136:139], v[60:63], v[224:227], a[136:139]
  buffer_load_dwordx4 v[224:227], v2, s[40:43], s66 offen offset:3072 sc1
  v_mfma_f32_16x16x32_bf16 a[140:143], v[60:63], v[228:231], a[140:143]
  buffer_load_dwordx4 v[228:231], v2, s[40:43], s67 offen offset:3072 sc1
  s_waitcnt vmcnt(19)
  v_mfma_f32_16x16x32_bf16 a[64:67], v[96:99], a[144:147], a[64:67]
  s_add_u32 s64, s64, 4096
  v_mfma_f32_16x16x32_bf16 a[68:71], v[96:99], a[148:151], a[68:71]
  s_add_u32 s65, s65, 4096
  v_mfma_f32_16x16x32_bf16 a[72:75], v[96:99], a[152:155], a[72:75]
  s_add_u32 s66, s66, 4096
  v_mfma_f32_16x16x32_bf16 a[76:79], v[96:99], a[156:159], a[76:79]
  buffer_load_dwordx4 a[200:203], v2, s[40:43], s13 offen offset:2048 sc1
  v_mfma_f32_16x16x32_bf16 a[80:83], v[100:103], a[144:147], a[80:83]
  v_mfma_f32_16x16x32_bf16 a[84:87], v[100:103], a[148:151], a[84:87]
  v_mfma_f32_16x16x32_bf16 a[88:91], v[100:103], a[152:155], a[88:91]
  s_add_u32 s67, s67, 4096
  v_mfma_f32_16x16x32_bf16 a[92:95], v[100:103], a[156:159], a[92:95]
  buffer_load_dwordx4 a[204:207], v2, s[40:43], s13 offen offset:3072 sc1
  v_mfma_f32_16x16x32_bf16 a[96:99], v[104:107], a[144:147], a[96:99]
  s_add_u32 s13, s13, 4096
  v_mfma_f32_16x16x32_bf16 a[100:103], v[104:107], a[148:151], a[100:103]
  v_mfma_f32_16x16x32_bf16 a[104:107], v[104:107], a[152:155], a[104:107]
  v_mfma_f32_16x16x32_bf16 a[108:111], v[104:107], a[156:159], a[108:111]
  v_mfma_f32_16x16x32_bf16 a[112:115], v[108:111], a[144:147], a[112:115]
  v_mfma_f32_16x16x32_bf16 a[116:119], v[108:111], a[148:151], a[116:119]
  v_mfma_f32_16x16x32_bf16 a[120:123], v[108:111], a[152:155], a[120:123]
  v_mfma_f32_16x16x32_bf16 a[124:127], v[108:111], a[156:159], a[124:127]
  v_mfma_f32_16x16x32_bf16 a[128:131], v[112:115], a[144:147], a[128:131]
  buffer_load_dwordx4 a[144:147], v2, s[40:43], s64 offen offset:0 sc1
  v_mfma_f32_16x16x32_bf16 a[132:135], v[112:115], a[148:151], a[132:135]
  buffer_load_dwordx4 a[148:151], v2, s[40:43], s65 offen offset:0 sc1
  v_mfma_f32_16x16x32_bf16 a[136:139], v[112:115], a[152:155], a[136:139]
  buffer_load_dwordx4 a[152:155], v2, s[40:43], s66 offen offset:0 sc1
  v_mfma_f32_16x16x32_bf16 a[140:143], v[112:115], a[156:159], a[140:143]
  buffer_load_dwordx4 a[156:159], v2, s[40:43], s67 offen offset:0 sc1
  s_waitcnt vmcnt(18)
  v_mfma_f32_16x16x32_bf16 a[64:67], v[116:119], a[160:163], a[64:67]
  v_mfma_f32_16x16x32_bf16 a[68:71], v[116:119], a[164:167], a[68:71]
  ds_read_b128 v[112:115], v11 offset:0
  v_mfma_f32_16x16x32_bf16 a[72:75], v[116:119], a[168:171], a[72:75]
  v_mfma_f32_16x16x32_bf16 a[76:79], v[116:119], a[172:175], a[76:79]
  buffer_load_dwordx4 a[208:211], v2, s[40:43], s13 offen offset:0 sc1
  v_mfma_f32_16x16x32_bf16 a[80:83], v[120:123], a[160:163], a[80:83]
  v_mfma_f32_16x16x32_bf16 a[84:87], v[120:123], a[164:167], a[84:87]
  v_mfma_f32_16x16x32_bf16 a[88:91], v[120:123], a[168:171], a[88:91]
  v_mfma_f32_16x16x32_bf16 a[92:95], v[120:123], a[172:175], a[92:95]
  buffer_load_dwordx4 a[212:215], v2, s[40:43], s13 offen offset:1024 sc1
  v_mfma_f32_16x16x32_bf16 a[96:99], v[124:127], a[160:163], a[96:99]
  v_mfma_f32_16x16x32_bf16 a[100:103], v[124:127], a[164:167], a[100:103]
  v_mfma_f32_16x16x32_bf16 a[104:107], v[124:127], a[168:171], a[104:107]
  v_mfma_f32_16x16x32_bf16 a[108:111], v[124:127], a[172:175], a[108:111]
  v_mfma_f32_16x16x32_bf16 a[112:115], v[160:163], a[160:163], a[112:115]
  v_mfma_f32_16x16x32_bf16 a[116:119], v[160:163], a[164:167], a[116:119]
  v_mfma_f32_16x16x32_bf16 a[120:123], v[160:163], a[168:171], a[120:123]
  v_mfma_f32_16x16x32_bf16 a[124:127], v[160:163], a[172:175], a[124:127]
  v_mfma_f32_16x16x32_bf16 a[128:131], v[164:167], a[160:163], a[128:131]
  buffer_load_dwordx4 a[160:163], v2, s[40:43], s64 offen offset:1024 sc1
  v_mfma_f32_16x16x32_bf16 a[132:135], v[164:167], a[164:167], a[132:135]
  buffer_load_dwordx4 a[164:167], v2, s[40:43], s65 offen offset:1024 sc1
  v_mfma_f32_16x16x32_bf16 a[136:139], v[164:167], a[168:171], a[136:139]
  buffer_load_dwordx4 a[168:171], v2, s[40:43], s66 offen offset:1024 sc1
  v_mfma_f32_16x16x32_bf16 a[140:143], v[164:167], a[172:175], a[140:143]
  buffer_load_dwordx4 a[172:175], v2, s[40:43], s67 offen offset:1024 sc1
  s_waitcnt vmcnt(18)
  v_mfma_f32_16x16x32_bf16 a[64:67], v[168:171], a[176:179], a[64:67]
  v_mfma_f32_16x16x32_bf16 a[68:71], v[168:171], a[180:183], a[68:71]
  ds_read_b128 v[116:119], v11 offset:1024
  v_mfma_f32_16x16x32_bf16 a[72:75], v[168:171], a[184:187], a[72:75]
  v_mfma_f32_16x16x32_bf16 a[76:79], v[168:171], a[188:191], a[76:79]
  buffer_load_dwordx4 a[216:219], v2, s[40:43], s13 offen offset:2048 sc1
  v_mfma_f32_16x16x32_bf16 a[80:83], v[172:175], a[176:179], a[80:83]
  v_mfma_f32_16x16x32_bf16 a[84:87], v[172:175], a[180:183], a[84:87]
  ds_read_b128 v[120:123], v11 offset:2048
  v_mfma_f32_16x16x32_bf16 a[88:91], v[172:175], a[184:187], a[88:91]
  v_mfma_f32_16x16x32_bf16 a[92:95], v[172:175], a[188:191], a[92:95]
  buffer_load_dwordx4 a[220:223], v2, s[40:43], s13 offen offset:3072 sc1
  v_mfma_f32_16x16x32_bf16 a[96:99], v[192:195], a[176:179], a[96:99]
  s_add_u32 s13, s13, 4096
  v_mfma_f32_16x16x32_bf16 a[100:103], v[192:195], a[180:183], a[100:103]
  ds_read_b128 v[124:127], v11 offset:3072
  v_mfma_f32_16x16x32_bf16 a[104:107], v[192:195], a[184:187], a[104:107]
  v_mfma_f32_16x16x32_bf16 a[108:111], v[192:195], a[188:191], a[108:111]
  buffer_load_dwordx4 a[224:227], v2, s[40:43], s13 offen offset:0 sc1
  v_mfma_f32_16x16x32_bf16 a[112:115], v[196:199], a[176:179], a[112:115]
  v_mfma_f32_16x16x32_bf16 a[116:119], v[196:199], a[180:183], a[116:119]
  ds_read_b128 v[160:163], v11 offset:4096
  v_mfma_f32_16x16x32_bf16 a[120:123], v[196:199], a[184:187], a[120:123]
  v_mfma_f32_16x16x32_bf16 a[124:127], v[196:199], a[188:191], a[124:127]
  v_mfma_f32_16x16x32_bf16 a[128:131], v[208:211], a[176:179], a[128:131]
  buffer_load_dwordx4 a[176:179], v2, s[40:43], s64 offen offset:2048 sc1
  v_mfma_f32_16x16x32_bf16 a[132:135], v[208:211], a[180:183], a[132:135]
  buffer_load_dwordx4 a[180:183], v2, s[40:43], s65 offen offset:2048 sc1
  v_mfma_f32_16x16x32_bf16 a[136:139], v[208:211], a[184:187], a[136:139]
  buffer_load_dwordx4 a[184:187], v2, s[40:43], s66 offen offset:2048 sc1
  v_mfma_f32_16x16x32_bf16 a[140:143], v[208:211], a[188:191], a[140:143]
  buffer_load_dwordx4 a[188:191], v2, s[40:43], s67 offen offset:2048 sc1
  s_waitcnt vmcnt(19)
  v_mfma_f32_16x16x32_bf16 a[64:67], v[212:215], v[216:219], a[64:67]
  v_mfma_f32_16x16x32_bf16 a[68:71], v[212:215], v[220:223], a[68:71]
  ds_read_b128 v[164:167], v11 offset:5120
  v_mfma_f32_16x16x32_bf16 a[72:75], v[212:215], v[224:227], a[72:75]
  v_mfma_f32_16x16x32_bf16 a[76:79], v[212:215], v[228:231], a[76:79]
  buffer_load_dwordx4 a[228:231], v2, s[40:43], s13 offen offset:1024 sc1
  v_mfma_f32_16x16x32_bf16 a[80:83], v[232:235], v[216:219], a[80:83]
  v_mfma_f32_16x16x32_bf16 a[84:87], v[232:235], v[220:223], a[84:87]
  ds_read_b128 v[168:171], v11 offset:6144
  v_mfma_f32_16x16x32_bf16 a[88:91], v[232:235], v[224:227], a[88:91]
  v_mfma_f32_16x16x32_bf16 a[92:95], v[232:235], v[228:231], a[92:95]
  buffer_load_dwordx4 a[232:235], v2, s[40:43], s13 offen offset:2048 sc1
  v_mfma_f32_16x16x32_bf16 a[96:99], v[236:239], v[216:219], a[96:99]
  v_mfma_f32_16x16x32_bf16 a[100:103], v[236:239], v[220:223], a[100:103]
  ds_read_b128 v[172:175], v11 offset:7168
  v_mfma_f32_16x16x32_bf16 a[104:107], v[236:239], v[224:227], a[104:107]
  v_mfma_f32_16x16x32_bf16 a[108:111], v[236:239], v[228:231], a[108:111]
  v_mfma_f32_16x16x32_bf16 a[112:115], v[240:243], v[216:219], a[112:115]
  v_mfma_f32_16x16x32_bf16 a[116:119], v[240:243], v[220:223], a[116:119]
  ds_read_b128 v[192:195], v11 offset:8192
  v_mfma_f32_16x16x32_bf16 a[120:123], v[240:243], v[224:227], a[120:123]
  v_mfma_f32_16x16x32_bf16 a[124:127], v[240:243], v[228:231], a[124:127]
  v_mfma_f32_16x16x32_bf16 a[128:131], v[244:247], v[216:219], a[128:131]
  buffer_load_dwordx4 v[216:219], v2, s[40:43], s64 offen offset:3072 sc1
  v_mfma_f32_16x16x32_bf16 a[132:135], v[244:247], v[220:223], a[132:135]
  buffer_load_dwordx4 v[220:223], v2, s[40:43], s65 offen offset:3072 sc1
  v_mfma_f32_16x16x32_bf16 a[136:139], v[244:247], v[224:227], a[136:139]
  buffer_load_dwordx4 v[224:227], v2, s[40:43], s66 offen offset:3072 sc1
  v_mfma_f32_16x16x32_bf16 a[140:143], v[244:247], v[228:231], a[140:143]
  buffer_load_dwordx4 v[228:231], v2, s[40:43], s67 offen offset:3072 sc1
  s_waitcnt vmcnt(19)
  v_mfma_f32_16x16x32_bf16 a[64:67], v[64:67], a[144:147], a[64:67]
  s_add_u32 s64, s64, 4096
  v_mfma_f32_16x16x32_bf16 a[68:71], v[64:67], a[148:151], a[68:71]
  s_add_u32 s65, s65, 4096
  ds_read_b128 v[196:199], v11 offset:9216
  v_mfma_f32_16x16x32_bf16 a[72:75], v[64:67], a[152:155], a[72:75]
  s_add_u32 s66, s66, 4096
  v_mfma_f32_16x16x32_bf16 a[76:79], v[64:67], a[156:159], a[76:79]
  buffer_load_dwordx4 a[236:239], v2, s[40:43], s13 offen offset:3072 sc1
  v_mfma_f32_16x16x32_bf16 a[80:83], v[68:71], a[144:147], a[80:83]
  s_add_u32 s13, s13, 4096
  v_mfma_f32_16x16x32_bf16 a[84:87], v[68:71], a[148:151], a[84:87]
  ds_read_b128 v[208:211], v11 offset:10240
  v_mfma_f32_16x16x32_bf16 a[88:91], v[68:71], a[152:155], a[88:91]
  s_add_u32 s67, s67, 4096
  v_mfma_f32_16x16x32_bf16 a[92:95], v[68:71], a[156:159], a[92:95]
  buffer_load_dwordx4 a[240:243], v2, s[40:43], s13 offen offset:0 sc1
  v_mfma_f32_16x16x32_bf16 a[96:99], v[72:75], a[144:147], a[96:99]
  v_mfma_f32_16x16x32_bf16 a[100:103], v[72:75], a[148:151], a[100:103]
  ds_read_b128 v[212:215], v11 offset:11264
  v_mfma_f32_16x16x32_bf16 a[104:107], v[72:75], a[152:155], a[104:107]
  v_mfma_f32_16x16x32_bf16 a[108:111], v[72:75], a[156:159], a[108:111]
  v_mfma_f32_16x16x32_bf16 a[112:115], v[76:79], a[144:147], a[112:115]
  v_mfma_f32_16x16x32_bf16 a[116:119], v[76:79], a[148:151], a[116:119]
  ds_read_b128 v[232:235], v11 offset:12288
  v_mfma_f32_16x16x32_bf16 a[120:123], v[76:79], a[152:155], a[120:123]
  v_mfma_f32_16x16x32_bf16 a[124:127], v[76:79], a[156:159], a[124:127]
  v_mfma_f32_16x16x32_bf16 a[128:131], v[80:83], a[144:147], a[128:131]
  buffer_load_dwordx4 a[144:147], v2, s[40:43], s64 offen offset:0 sc1
  v_mfma_f32_16x16x32_bf16 a[132:135], v[80:83], a[148:151], a[132:135]
  buffer_load_dwordx4 a[148:151], v2, s[40:43], s65 offen offset:0 sc1
  v_mfma_f32_16x16x32_bf16 a[136:139], v[80:83], a[152:155], a[136:139]
  buffer_load_dwordx4 a[152:155], v2, s[40:43], s66 offen offset:0 sc1
  v_mfma_f32_16x16x32_bf16 a[140:143], v[80:83], a[156:159], a[140:143]
  buffer_load_dwordx4 a[156:159], v2, s[40:43], s67 offen offset:0 sc1
  s_waitcnt vmcnt(19)
  v_mfma_f32_16x16x32_bf16 a[64:67], v[84:87], a[160:163], a[64:67]
  v_mfma_f32_16x16x32_bf16 a[68:71], v[84:87], a[164:167], a[68:71]
  ds_read_b128 v[236:239], v11 offset:13312
  v_mfma_f32_16x16x32_bf16 a[72:75], v[84:87], a[168:171], a[72:75]
  v_mfma_f32_16x16x32_bf16 a[76:79], v[84:87], a[172:175], a[76:79]
  buffer_load_dwordx4 a[244:247], v2, s[40:43], s13 offen offset:1024 sc1
  v_mfma_f32_16x16x32_bf16 a[80:83], v[88:91], a[160:163], a[80:83]
  v_mfma_f32_16x16x32_bf16 a[84:87], v[88:91], a[164:167], a[84:87]
  ds_read_b128 v[240:243], v11 offset:14336
  v_mfma_f32_16x16x32_bf16 a[88:91], v[88:91], a[168:171], a[88:91]
  v_mfma_f32_16x16x32_bf16 a[92:95], v[88:91], a[172:175], a[92:95]
  buffer_load_dwordx4 a[248:251], v2, s[40:43], s13 offen offset:2048 sc1
  v_mfma_f32_16x16x32_bf16 a[96:99], v[92:95], a[160:163], a[96:99]
  v_mfma_f32_16x16x32_bf16 a[100:103], v[92:95], a[164:167], a[100:103]
  ds_read_b128 v[244:247], v11 offset:15360
  v_mfma_f32_16x16x32_bf16 a[104:107], v[92:95], a[168:171], a[104:107]
  v_mfma_f32_16x16x32_bf16 a[108:111], v[92:95], a[172:175], a[108:111]
  v_mfma_f32_16x16x32_bf16 a[112:115], v[128:131], a[160:163], a[112:115]
  v_mfma_f32_16x16x32_bf16 a[116:119], v[128:131], a[164:167], a[116:119]
  ds_read_b128 v[64:67], v11 offset:16384
  v_mfma_f32_16x16x32_bf16 a[120:123], v[128:131], a[168:171], a[120:123]
  v_mfma_f32_16x16x32_bf16 a[124:127], v[128:131], a[172:175], a[124:127]
  v_mfma_f32_16x16x32_bf16 a[128:131], v[132:135], a[160:163], a[128:131]
  buffer_load_dwordx4 a[160:163], v2, s[40:43], s64 offen offset:1024 sc1
  v_mfma_f32_16x16x32_bf16 a[132:135], v[132:135], a[164:167], a[132:135]
  buffer_load_dwordx4 a[164:167], v2, s[40:43], s65 offen offset:1024 sc1
  v_mfma_f32_16x16x32_bf16 a[136:139], v[132:135], a[168:171], a[136:139]
  buffer_load_dwordx4 a[168:171], v2, s[40:43], s66 offen offset:1024 sc1
  v_mfma_f32_16x16x32_bf16 a[140:143], v[132:135], a[172:175], a[140:143]
  buffer_load_dwordx4 a[172:175], v2, s[40:43], s67 offen offset:1024 sc1
  s_waitcnt vmcnt(18)
  v_mfma_f32_16x16x32_bf16 a[64:67], v[136:139], a[176:179], a[64:67]
  v_mfma_f32_16x16x32_bf16 a[68:71], v[136:139], a[180:183], a[68:71]
  ds_read_b128 v[68:71], v11 offset:17408
  v_mfma_f32_16x16x32_bf16 a[72:75], v[136:139], a[184:187], a[72:75]
  v_mfma_f32_16x16x32_bf16 a[76:79], v[136:139], a[188:191], a[76:79]
  buffer_load_dwordx4 a[252:255], v2, s[40:43], s13 offen offset:3072 sc1
  v_mfma_f32_16x16x32_bf16 a[80:83], v[140:143], a[176:179], a[80:83]
  s_add_u32 s13, s13, 4096
  v_mfma_f32_16x16x32_bf16 a[84:87], v[140:143], a[180:183], a[84:87]
  ds_read_b128 v[72:75], v11 offset:18432
  v_mfma_f32_16x16x32_bf16 a[88:91], v[140:143], a[184:187], a[88:91]
  v_mfma_f32_16x16x32_bf16 a[92:95], v[140:143], a[188:191], a[92:95]
  buffer_load_dwordx4 v[32:35], v2, s[40:43], s13 offen offset:0 sc1
  v_mfma_f32_16x16x32_bf16 a[96:99], v[144:147], a[176:179], a[96:99]
  v_mfma_f32_16x16x32_bf16 a[100:103], v[144:147], a[180:183], a[100:103]
  ds_read_b128 v[76:79], v11 offset:19456
  v_mfma_f32_16x16x32_bf16 a[104:107], v[144:147], a[184:187], a[104:107]
  v_mfma_f32_16x16x32_bf16 a[108:111], v[144:147], a[188:191], a[108:111]
  v_mfma_f32_16x16x32_bf16 a[112:115], v[148:151], a[176:179], a[112:115]
  v_mfma_f32_16x16x32_bf16 a[116:119], v[148:151], a[180:183], a[116:119]
  ds_read_b128 v[80:83], v11 offset:20480
  v_mfma_f32_16x16x32_bf16 a[120:123], v[148:151], a[184:187], a[120:123]
  v_mfma_f32_16x16x32_bf16 a[124:127], v[148:151], a[188:191], a[124:127]
  v_mfma_f32_16x16x32_bf16 a[128:131], v[152:155], a[176:179], a[128:131]
  buffer_load_dwordx4 a[176:179], v2, s[40:43], s64 offen offset:2048 sc1
  v_mfma_f32_16x16x32_bf16 a[132:135], v[152:155], a[180:183], a[132:135]
  buffer_load_dwordx4 a[180:183], v2, s[40:43], s65 offen offset:2048 sc1
  v_mfma_f32_16x16x32_bf16 a[136:139], v[152:155], a[184:187], a[136:139]
  buffer_load_dwordx4 a[184:187], v2, s[40:43], s66 offen offset:2048 sc1
  v_mfma_f32_16x16x32_bf16 a[140:143], v[152:155], a[188:191], a[140:143]
  buffer_load_dwordx4 a[188:191], v2, s[40:43], s67 offen offset:2048 sc1
  s_waitcnt vmcnt(18)
  v_mfma_f32_16x16x32_bf16 a[64:67], v[156:159], v[216:219], a[64:67]
  v_mfma_f32_16x16x32_bf16 a[68:71], v[156:159], v[220:223], a[68:71]
  ds_read_b128 v[84:87], v11 offset:21504
  v_mfma_f32_16x16x32_bf16 a[72:75], v[156:159], v[224:227], a[72:75]
  v_mfma_f32_16x16x32_bf16 a[76:79], v[156:159], v[228:231], a[76:79]
  buffer_load_dwordx4 v[36:39], v2, s[40:43], s13 offen offset:1024 sc1
  v_mfma_f32_16x16x32_bf16 a[80:83], v[176:179], v[216:219], a[80:83]
  v_mfma_f32_16x16x32_bf16 a[84:87], v[176:179], v[220:223], a[84:87]
  ds_read_b128 v[88:91], v11 offset:22528
  v_mfma_f32_16x16x32_bf16 a[88:91], v[176:179], v[224:227], a[88:91]
  v_mfma_f32_16x16x32_bf16 a[92:95], v[176:179], v[228:231], a[92:95]
  buffer_load_dwordx4 v[40:43], v2, s[40:43], s13 offen offset:2048 sc1
  v_mfma_f32_16x16x32_bf16 a[96:99], v[180:183], v[216:219], a[96:99]
  v_mfma_f32_16x16x32_bf16 a[100:103], v[180:183], v[220:223], a[100:103]
  ds_read_b128 v[92:95], v11 offset:23552
  v_mfma_f32_16x16x32_bf16 a[104:107], v[180:183], v[224:227], a[104:107]
  v_mfma_f32_16x16x32_bf16 a[108:111], v[180:183], v[228:231], a[108:111]
  buffer_load_dwordx4 v[44:47], v2, s[40:43], s13 offen offset:3072 sc1
  v_mfma_f32_16x16x32_bf16 a[112:115], v[184:187], v[216:219], a[112:115]
  s_add_u32 s13, s13, 4096
  v_mfma_f32_16x16x32_bf16 a[116:119], v[184:187], v[220:223], a[116:119]
  ds_read_b128 v[128:131], v11 offset:24576
  v_mfma_f32_16x16x32_bf16 a[120:123], v[184:187], v[224:227], a[120:123]
  v_mfma_f32_16x16x32_bf16 a[124:127], v[184:187], v[228:231], a[124:127]
  v_mfma_f32_16x16x32_bf16 a[128:131], v[188:191], v[216:219], a[128:131]
  buffer_load_dwordx4 v[216:219], v2, s[40:43], s64 offen offset:3072 sc1
  v_mfma_f32_16x16x32_bf16 a[132:135], v[188:191], v[220:223], a[132:135]
  buffer_load_dwordx4 v[220:223], v2, s[40:43], s65 offen offset:3072 sc1
  v_mfma_f32_16x16x32_bf16 a[136:139], v[188:191], v[224:227], a[136:139]
  buffer_load_dwordx4 v[224:227], v2, s[40:43], s66 offen offset:3072 sc1
  v_mfma_f32_16x16x32_bf16 a[140:143], v[188:191], v[228:231], a[140:143]
  buffer_load_dwordx4 v[228:231], v2, s[40:43], s67 offen offset:3072 sc1
  s_waitcnt vmcnt(19)
  v_mfma_f32_16x16x32_bf16 a[64:67], a[0:3], a[144:147], a[64:67]
  s_add_u32 s64, s64, 4096
  v_mfma_f32_16x16x32_bf16 a[68:71], a[0:3], a[148:151], a[68:71]
  s_add_u32 s65, s65, 4096
  ds_read_b128 v[132:135], v11 offset:25600
  v_mfma_f32_16x16x32_bf16 a[72:75], a[0:3], a[152:155], a[72:75]
  s_add_u32 s66, s66, 4096
  v_mfma_f32_16x16x32_bf16 a[76:79], a[0:3], a[156:159], a[76:79]
  buffer_load_dwordx4 v[48:51], v2, s[40:43], s13 offen offset:0 sc1
  v_mfma_f32_16x16x32_bf16 a[80:83], a[4:7], a[144:147], a[80:83]
  v_mfma_f32_16x16x32_bf16 a[84:87], a[4:7], a[148:151], a[84:87]
  ds_read_b128 v[136:139], v11 offset:26624
  v_mfma_f32_16x16x32_bf16 a[88:91], a[4:7], a[152:155], a[88:91]
  s_add_u32 s67, s67, 4096
  v_mfma_f32_16x16x32_bf16 a[92:95], a[4:7], a[156:159], a[92:95]
  buffer_load_dwordx4 v[52:55], v2, s[40:43], s13 offen offset:1024 sc1
  v_mfma_f32_16x16x32_bf16 a[96:99], a[8:11], a[144:147], a[96:99]
  v_mfma_f32_16x16x32_bf16 a[100:103], a[8:11], a[148:151], a[100:103]
  ds_read_b128 v[140:143], v11 offset:27648
  v_mfma_f32_16x16x32_bf16 a[104:107], a[8:11], a[152:155], a[104:107]
  v_mfma_f32_16x16x32_bf16 a[108:111], a[8:11], a[156:159], a[108:111]
  v_mfma_f32_16x16x32_bf16 a[112:115], a[12:15], a[144:147], a[112:115]
  v_mfma_f32_16x16x32_bf16 a[116:119], a[12:15], a[148:151], a[116:119]
  ds_read_b128 v[144:147], v11 offset:28672
  v_mfma_f32_16x16x32_bf16 a[120:123], a[12:15], a[152:155], a[120:123]
  v_mfma_f32_16x16x32_bf16 a[124:127], a[12:15], a[156:159], a[124:127]
  v_mfma_f32_16x16x32_bf16 a[128:131], a[16:19], a[144:147], a[128:131]
  buffer_load_dwordx4 a[144:147], v2, s[40:43], s64 offen offset:0 sc1
  v_mfma_f32_16x16x32_bf16 a[132:135], a[16:19], a[148:151], a[132:135]
  buffer_load_dwordx4 a[148:151], v2, s[40:43], s65 offen offset:0 sc1
  v_mfma_f32_16x16x32_bf16 a[136:139], a[16:19], a[152:155], a[136:139]
  buffer_load_dwordx4 a[152:155], v2, s[40:43], s66 offen offset:0 sc1
  v_mfma_f32_16x16x32_bf16 a[140:143], a[16:19], a[156:159], a[140:143]
  buffer_load_dwordx4 a[156:159], v2, s[40:43], s67 offen offset:0 sc1
  s_waitcnt vmcnt(19)
  v_mfma_f32_16x16x32_bf16 a[64:67], a[20:23], a[160:163], a[64:67]
  v_mfma_f32_16x16x32_bf16 a[68:71], a[20:23], a[164:167], a[68:71]
  ds_read_b128 v[148:151], v11 offset:29696
  v_mfma_f32_16x16x32_bf16 a[72:75], a[20:23], a[168:171], a[72:75]
  v_mfma_f32_16x16x32_bf16 a[76:79], a[20:23], a[172:175], a[76:79]
  buffer_load_dwordx4 v[56:59], v2, s[40:43], s13 offen offset:2048 sc1
  v_mfma_f32_16x16x32_bf16 a[80:83], a[24:27], a[160:163], a[80:83]
  v_mfma_f32_16x16x32_bf16 a[84:87], a[24:27], a[164:167], a[84:87]
  ds_read_b128 v[152:155], v11 offset:30720
  v_mfma_f32_16x16x32_bf16 a[88:91], a[24:27], a[168:171], a[88:91]
  v_mfma_f32_16x16x32_bf16 a[92:95], a[24:27], a[172:175], a[92:95]
  buffer_load_dwordx4 v[60:63], v2, s[40:43], s13 offen offset:3072 sc1
  v_mfma_f32_16x16x32_bf16 a[96:99], a[28:31], a[160:163], a[96:99]
  s_add_u32 s13, s13, 4096
  v_mfma_f32_16x16x32_bf16 a[100:103], a[28:31], a[164:167], a[100:103]
  ds_read_b128 v[156:159], v11 offset:31744
  v_mfma_f32_16x16x32_bf16 a[104:107], a[28:31], a[168:171], a[104:107]
  v_mfma_f32_16x16x32_bf16 a[108:111], a[28:31], a[172:175], a[108:111]
  v_mfma_f32_16x16x32_bf16 a[112:115], a[32:35], a[160:163], a[112:115]
  v_mfma_f32_16x16x32_bf16 a[116:119], a[32:35], a[164:167], a[116:119]
  ds_read_b128 v[176:179], v11 offset:32768
  v_mfma_f32_16x16x32_bf16 a[120:123], a[32:35], a[168:171], a[120:123]
  v_mfma_f32_16x16x32_bf16 a[124:127], a[32:35], a[172:175], a[124:127]
  v_mfma_f32_16x16x32_bf16 a[128:131], a[36:39], a[160:163], a[128:131]
  buffer_load_dwordx4 a[160:163], v2, s[40:43], s64 offen offset:1024 sc1
  v_mfma_f32_16x16x32_bf16 a[132:135], a[36:39], a[164:167], a[132:135]
  buffer_load_dwordx4 a[164:167], v2, s[40:43], s65 offen offset:1024 sc1
  v_mfma_f32_16x16x32_bf16 a[136:139], a[36:39], a[168:171], a[136:139]
  buffer_load_dwordx4 a[168:171], v2, s[40:43], s66 offen offset:1024 sc1
  v_mfma_f32_16x16x32_bf16 a[140:143], a[36:39], a[172:175], a[140:143]
  buffer_load_dwordx4 a[172:175], v2, s[40:43], s67 offen offset:1024 sc1
  s_waitcnt vmcnt(19)
  v_mfma_f32_16x16x32_bf16 a[64:67], a[40:43], a[176:179], a[64:67]
  v_mfma_f32_16x16x32_bf16 a[68:71], a[40:43], a[180:183], a[68:71]
  ds_read_b128 v[180:183], v11 offset:33792
  v_mfma_f32_16x16x32_bf16 a[72:75], a[40:43], a[184:187], a[72:75]
  v_mfma_f32_16x16x32_bf16 a[76:79], a[40:43], a[188:191], a[76:79]
  buffer_load_dwordx4 v[96:99], v2, s[40:43], s13 offen offset:0 sc1
  v_mfma_f32_16x16x32_bf16 a[80:83], a[44:47], a[176:179], a[80:83]
  v_mfma_f32_16x16x32_bf16 a[84:87], a[44:47], a[180:183], a[84:87]
  ds_read_b128 v[184:187], v11 offset:34816
  v_mfma_f32_16x16x32_bf16 a[88:91], a[44:47], a[184:187], a[88:91]
  v_mfma_f32_16x16x32_bf16 a[92:95], a[44:47], a[188:191], a[92:95]
  buffer_load_dwordx4 v[100:103], v2, s[40:43], s13 offen offset:1024 sc1
  v_mfma_f32_16x16x32_bf16 a[96:99], a[48:51], a[176:179], a[96:99]
  v_mfma_f32_16x16x32_bf16 a[100:103], a[48:51], a[180:183], a[100:103]
  ds_read_b128 v[188:191], v11 offset:35840
  v_mfma_f32_16x16x32_bf16 a[104:107], a[48:51], a[184:187], a[104:107]
  v_mfma_f32_16x16x32_bf16 a[108:111], a[48:51], a[188:191], a[108:111]
  v_mfma_f32_16x16x32_bf16 a[112:115], a[52:55], a[176:179], a[112:115]
  v_mfma_f32_16x16x32_bf16 a[116:119], a[52:55], a[180:183], a[116:119]
  v_mfma_f32_16x16x32_bf16 a[120:123], a[52:55], a[184:187], a[120:123]
  v_mfma_f32_16x16x32_bf16 a[124:127], a[52:55], a[188:191], a[124:127]
  v_mfma_f32_16x16x32_bf16 a[128:131], a[56:59], a[176:179], a[128:131]
  buffer_load_dwordx4 a[176:179], v2, s[40:43], s64 offen offset:2048 sc1
  v_mfma_f32_16x16x32_bf16 a[132:135], a[56:59], a[180:183], a[132:135]
  buffer_load_dwordx4 a[180:183], v2, s[40:43], s65 offen offset:2048 sc1
  v_mfma_f32_16x16x32_bf16 a[136:139], a[56:59], a[184:187], a[136:139]
  buffer_load_dwordx4 a[184:187], v2, s[40:43], s66 offen offset:2048 sc1
  v_mfma_f32_16x16x32_bf16 a[140:143], a[56:59], a[188:191], a[140:143]
  buffer_load_dwordx4 a[188:191], v2, s[40:43], s67 offen offset:2048 sc1
  s_waitcnt vmcnt(18)
  v_mfma_f32_16x16x32_bf16 a[64:67], a[60:63], v[216:219], a[64:67]
  v_mfma_f32_16x16x32_bf16 a[68:71], a[60:63], v[220:223], a[68:71]
  v_mfma_f32_16x16x32_bf16 a[72:75], a[60:63], v[224:227], a[72:75]
  v_mfma_f32_16x16x32_bf16 a[76:79], a[60:63], v[228:231], a[76:79]
  buffer_load_dwordx4 v[104:107], v2, s[40:43], s13 offen offset:2048 sc1
  v_mfma_f32_16x16x32_bf16 a[80:83], a[192:195], v[216:219], a[80:83]
  v_mfma_f32_16x16x32_bf16 a[84:87], a[192:195], v[220:223], a[84:87]
  v_mfma_f32_16x16x32_bf16 a[88:91], a[192:195], v[224:227], a[88:91]
  v_mfma_f32_16x16x32_bf16 a[92:95], a[192:195], v[228:231], a[92:95]
  buffer_load_dwordx4 v[108:111], v2, s[40:43], s13 offen offset:3072 sc1
  v_mfma_f32_16x16x32_bf16 a[96:99], a[196:199], v[216:219], a[96:99]
  s_add_u32 s13, s13, 4096
  v_mfma_f32_16x16x32_bf16 a[100:103], a[196:199], v[220:223], a[100:103]
  v_mfma_f32_16x16x32_bf16 a[104:107], a[196:199], v[224:227], a[104:107]
  v_mfma_f32_16x16x32_bf16 a[108:111], a[196:199], v[228:231], a[108:111]
  v_mfma_f32_16x16x32_bf16 a[112:115], a[200:203], v[216:219], a[112:115]
  v_mfma_f32_16x16x32_bf16 a[116:119], a[200:203], v[220:223], a[116:119]
  v_mfma_f32_16x16x32_bf16 a[120:123], a[200:203], v[224:227], a[120:123]
  v_mfma_f32_16x16x32_bf16 a[124:127], a[200:203], v[228:231], a[124:127]
  v_mfma_f32_16x16x32_bf16 a[128:131], a[204:207], v[216:219], a[128:131]
  buffer_load_dwordx4 v[216:219], v2, s[40:43], s64 offen offset:3072 sc1
  v_mfma_f32_16x16x32_bf16 a[132:135], a[204:207], v[220:223], a[132:135]
  buffer_load_dwordx4 v[220:223], v2, s[40:43], s65 offen offset:3072 sc1
  v_mfma_f32_16x16x32_bf16 a[136:139], a[204:207], v[224:227], a[136:139]
  buffer_load_dwordx4 v[224:227], v2, s[40:43], s66 offen offset:3072 sc1
  v_mfma_f32_16x16x32_bf16 a[140:143], a[204:207], v[228:231], a[140:143]
  buffer_load_dwordx4 v[228:231], v2, s[40:43], s67 offen offset:3072 sc1
  s_waitcnt vmcnt(18)
  v_mfma_f32_16x16x32_bf16 a[64:67], a[208:211], a[144:147], a[64:67]
  s_add_u32 s64, s64, 4096
  v_mfma_f32_16x16x32_bf16 a[68:71], a[208:211], a[148:151], a[68:71]
  s_add_u32 s65, s65, 4096
  v_mfma_f32_16x16x32_bf16 a[72:75], a[208:211], a[152:155], a[72:75]
  s_add_u32 s66, s66, 4096
  v_mfma_f32_16x16x32_bf16 a[76:79], a[208:211], a[156:159], a[76:79]
  v_mfma_f32_16x16x32_bf16 a[80:83], a[212:215], a[144:147], a[80:83]
  v_mfma_f32_16x16x32_bf16 a[84:87], a[212:215], a[148:151], a[84:87]
  v_mfma_f32_16x16x32_bf16 a[88:91], a[212:215], a[152:155], a[88:91]
  s_add_u32 s67, s67, 4096
  v_mfma_f32_16x16x32_bf16 a[92:95], a[212:215], a[156:159], a[92:95]
  v_mfma_f32_16x16x32_bf16 a[96:99], a[216:219], a[144:147], a[96:99]
  v_mfma_f32_16x16x32_bf16 a[100:103], a[216:219], a[148:151], a[100:103]
  v_mfma_f32_16x16x32_bf16 a[104:107], a[216:219], a[152:155], a[104:107]
  v_mfma_f32_16x16x32_bf16 a[108:111], a[216:219], a[156:159], a[108:111]
  v_mfma_f32_16x16x32_bf16 a[112:115], a[220:223], a[144:147], a[112:115]
  v_mfma_f32_16x16x32_bf16 a[116:119], a[220:223], a[148:151], a[116:119]
  v_mfma_f32_16x16x32_bf16 a[120:123], a[220:223], a[152:155], a[120:123]
  v_mfma_f32_16x16x32_bf16 a[124:127], a[220:223], a[156:159], a[124:127]
  v_mfma_f32_16x16x32_bf16 a[128:131], a[224:227], a[144:147], a[128:131]
  buffer_load_dwordx4 a[144:147], v2, s[40:43], s64 offen offset:0 sc1
  v_mfma_f32_16x16x32_bf16 a[132:135], a[224:227], a[148:151], a[132:135]
  buffer_load_dwordx4 a[148:151], v2, s[40:43], s65 offen offset:0 sc1
  v_mfma_f32_16x16x32_bf16 a[136:139], a[224:227], a[152:155], a[136:139]
  buffer_load_dwordx4 a[152:155], v2, s[40:43], s66 offen offset:0 sc1
  v_mfma_f32_16x16x32_bf16 a[140:143], a[224:227], a[156:159], a[140:143]
  buffer_load_dwordx4 a[156:159], v2, s[40:43], s67 offen offset:0 sc1
  s_waitcnt vmcnt(16)
  v_mfma_f32_16x16x32_bf16 a[64:67], a[228:231], a[160:163], a[64:67]
  v_mfma_f32_16x16x32_bf16 a[68:71], a[228:231], a[164:167], a[68:71]
  v_mfma_f32_16x16x32_bf16 a[72:75], a[228:231], a[168:171], a[72:75]
  v_mfma_f32_16x16x32_bf16 a[76:79], a[228:231], a[172:175], a[76:79]
  v_mfma_f32_16x16x32_bf16 a[80:83], a[232:235], a[160:163], a[80:83]
  v_mfma_f32_16x16x32_bf16 a[84:87], a[232:235], a[164:167], a[84:87]
  v_mfma_f32_16x16x32_bf16 a[88:91], a[232:235], a[168:171], a[88:91]
  v_mfma_f32_16x16x32_bf16 a[92:95], a[232:235], a[172:175], a[92:95]
  v_mfma_f32_16x16x32_bf16 a[96:99], a[236:239], a[160:163], a[96:99]
  v_mfma_f32_16x16x32_bf16 a[100:103], a[236:239], a[164:167], a[100:103]
  v_mfma_f32_16x16x32_bf16 a[104:107], a[236:239], a[168:171], a[104:107]
  v_mfma_f32_16x16x32_bf16 a[108:111], a[236:239], a[172:175], a[108:111]
  v_mfma_f32_16x16x32_bf16 a[112:115], a[240:243], a[160:163], a[112:115]
  v_mfma_f32_16x16x32_bf16 a[116:119], a[240:243], a[164:167], a[116:119]
  v_mfma_f32_16x16x32_bf16 a[120:123], a[240:243], a[168:171], a[120:123]
  v_mfma_f32_16x16x32_bf16 a[124:127], a[240:243], a[172:175], a[124:127]
  v_mfma_f32_16x16x32_bf16 a[128:131], a[244:247], a[160:163], a[128:131]
  buffer_load_dwordx4 a[160:163], v2, s[40:43], s64 offen offset:1024 sc1
  v_mfma_f32_16x16x32_bf16 a[132:135], a[244:247], a[164:167], a[132:135]
  buffer_load_dwordx4 a[164:167], v2, s[40:43], s65 offen offset:1024 sc1
  v_mfma_f32_16x16x32_bf16 a[136:139], a[244:247], a[168:171], a[136:139]
  buffer_load_dwordx4 a[168:171], v2, s[40:43], s66 offen offset:1024 sc1
  v_mfma_f32_16x16x32_bf16 a[140:143], a[244:247], a[172:175], a[140:143]
  buffer_load_dwordx4 a[172:175], v2, s[40:43], s67 offen offset:1024 sc1
  s_waitcnt vmcnt(14)
  v_mfma_f32_16x16x32_bf16 a[64:67], a[248:251], a[176:179], a[64:67]
  v_mfma_f32_16x16x32_bf16 a[68:71], a[248:251], a[180:183], a[68:71]
  v_mfma_f32_16x16x32_bf16 a[72:75], a[248:251], a[184:187], a[72:75]
  v_mfma_f32_16x16x32_bf16 a[76:79], a[248:251], a[188:191], a[76:79]
  v_mfma_f32_16x16x32_bf16 a[80:83], a[252:255], a[176:179], a[80:83]
  v_mfma_f32_16x16x32_bf16 a[84:87], a[252:255], a[180:183], a[84:87]
  v_mfma_f32_16x16x32_bf16 a[88:91], a[252:255], a[184:187], a[88:91]
  v_mfma_f32_16x16x32_bf16 a[92:95], a[252:255], a[188:191], a[92:95]
  v_mfma_f32_16x16x32_bf16 a[96:99], v[32:35], a[176:179], a[96:99]
  v_mfma_f32_16x16x32_bf16 a[100:103], v[32:35], a[180:183], a[100:103]
  v_mfma_f32_16x16x32_bf16 a[104:107], v[32:35], a[184:187], a[104:107]
  v_mfma_f32_16x16x32_bf16 a[108:111], v[32:35], a[188:191], a[108:111]
  v_mfma_f32_16x16x32_bf16 a[112:115], v[36:39], a[176:179], a[112:115]
  v_mfma_f32_16x16x32_bf16 a[116:119], v[36:39], a[180:183], a[116:119]
  v_mfma_f32_16x16x32_bf16 a[120:123], v[36:39], a[184:187], a[120:123]
  v_mfma_f32_16x16x32_bf16 a[124:127], v[36:39], a[188:191], a[124:127]
  v_mfma_f32_16x16x32_bf16 a[128:131], v[40:43], a[176:179], a[128:131]
  buffer_load_dwordx4 a[176:179], v2, s[40:43], s64 offen offset:2048 sc1
  v_mfma_f32_16x16x32_bf16 a[132:135], v[40:43], a[180:183], a[132:135]
  buffer_load_dwordx4 a[180:183], v2, s[40:43], s65 offen offset:2048 sc1
  v_mfma_f32_16x16x32_bf16 a[136:139], v[40:43], a[184:187], a[136:139]
  buffer_load_dwordx4 a[184:187], v2, s[40:43], s66 offen offset:2048 sc1
  v_mfma_f32_16x16x32_bf16 a[140:143], v[40:43], a[188:191], a[140:143]
  buffer_load_dwordx4 a[188:191], v2, s[40:43], s67 offen offset:2048 sc1
  s_waitcnt vmcnt(12)
  v_mfma_f32_16x16x32_bf16 a[64:67], v[44:47], v[216:219], a[64:67]
  v_mfma_f32_16x16x32_bf16 a[68:71], v[44:47], v[220:223], a[68:71]
  v_mfma_f32_16x16x32_bf16 a[72:75], v[44:47], v[224:227], a[72:75]
  v_mfma_f32_16x16x32_bf16 a[76:79], v[44:47], v[228:231], a[76:79]
  v_mfma_f32_16x16x32_bf16 a[80:83], v[48:51], v[216:219], a[80:83]
  v_mfma_f32_16x16x32_bf16 a[84:87], v[48:51], v[220:223], a[84:87]
  v_mfma_f32_16x16x32_bf16 a[88:91], v[48:51], v[224:227], a[88:91]
  v_mfma_f32_16x16x32_bf16 a[92:95], v[48:51], v[228:231], a[92:95]
  v_mfma_f32_16x16x32_bf16 a[96:99], v[52:55], v[216:219], a[96:99]
  v_mfma_f32_16x16x32_bf16 a[100:103], v[52:55], v[220:223], a[100:103]
  v_mfma_f32_16x16x32_bf16 a[104:107], v[52:55], v[224:227], a[104:107]
  v_mfma_f32_16x16x32_bf16 a[108:111], v[52:55], v[228:231], a[108:111]
  v_mfma_f32_16x16x32_bf16 a[112:115], v[56:59], v[216:219], a[112:115]
  v_mfma_f32_16x16x32_bf16 a[116:119], v[56:59], v[220:223], a[116:119]
  v_mfma_f32_16x16x32_bf16 a[120:123], v[56:59], v[224:227], a[120:123]
  v_mfma_f32_16x16x32_bf16 a[124:127], v[56:59], v[228:231], a[124:127]
  v_mfma_f32_16x16x32_bf16 a[128:131], v[60:63], v[216:219], a[128:131]
  buffer_load_dwordx4 v[216:219], v2, s[40:43], s64 offen offset:3072 sc1
  v_mfma_f32_16x16x32_bf16 a[132:135], v[60:63], v[220:223], a[132:135]
  buffer_load_dwordx4 v[220:223], v2, s[40:43], s65 offen offset:3072 sc1
  v_mfma_f32_16x16x32_bf16 a[136:139], v[60:63], v[224:227], a[136:139]
  buffer_load_dwordx4 v[224:227], v2, s[40:43], s66 offen offset:3072 sc1
  v_mfma_f32_16x16x32_bf16 a[140:143], v[60:63], v[228:231], a[140:143]
  buffer_load_dwordx4 v[228:231], v2, s[40:43], s67 offen offset:3072 sc1
  s_waitcnt vmcnt(12) lgkmcnt(0)
  v_mfma_f32_16x16x32_bf16 a[64:67], v[96:99], a[144:147], a[64:67]
  s_add_u32 s64, s64, 4096
  v_mfma_f32_16x16x32_bf16 a[68:71], v[96:99], a[148:151], a[68:71]
  s_add_u32 s65, s65, 4096
  v_mfma_f32_16x16x32_bf16 a[72:75], v[96:99], a[152:155], a[72:75]
  s_add_u32 s66, s66, 4096
  v_mfma_f32_16x16x32_bf16 a[76:79], v[96:99], a[156:159], a[76:79]
  buffer_load_dwordx4 v[32:35], v248, s[44:47], 0 offen
  v_mfma_f32_16x16x32_bf16 a[80:83], v[100:103], a[144:147], a[80:83]
  v_mfma_f32_16x16x32_bf16 a[84:87], v[100:103], a[148:151], a[84:87]
  buffer_load_dwordx4 v[44:47], v200, s[40:43], s27 offen sc1
  v_mfma_f32_16x16x32_bf16 a[88:91], v[100:103], a[152:155], a[88:91]
  s_add_u32 s67, s67, 4096
  v_mfma_f32_16x16x32_bf16 a[92:95], v[100:103], a[156:159], a[92:95]
  buffer_load_dwordx4 v[36:39], v249, s[44:47], 0 offen
  v_mfma_f32_16x16x32_bf16 a[96:99], v[104:107], a[144:147], a[96:99]
  v_mfma_f32_16x16x32_bf16 a[100:103], v[104:107], a[148:151], a[100:103]
  buffer_load_dwordx4 v[48:51], v201, s[40:43], s27 offen sc1
  v_mfma_f32_16x16x32_bf16 a[104:107], v[104:107], a[152:155], a[104:107]
  v_mfma_f32_16x16x32_bf16 a[108:111], v[104:107], a[156:159], a[108:111]
  buffer_load_dwordx4 v[40:43], v250, s[44:47], 0 offen
  v_mfma_f32_16x16x32_bf16 a[112:115], v[108:111], a[144:147], a[112:115]
  v_mfma_f32_16x16x32_bf16 a[116:119], v[108:111], a[148:151], a[116:119]
  buffer_load_dwordx4 v[52:55], v202, s[40:43], s27 offen sc1
  v_mfma_f32_16x16x32_bf16 a[120:123], v[108:111], a[152:155], a[120:123]
  v_mfma_f32_16x16x32_bf16 a[124:127], v[108:111], a[156:159], a[124:127]
  v_mfma_f32_16x16x32_bf16 a[128:131], v[112:115], a[144:147], a[128:131]
  buffer_load_dwordx4 a[144:147], v2, s[40:43], s64 offen offset:0 sc1
  v_mfma_f32_16x16x32_bf16 a[132:135], v[112:115], a[148:151], a[132:135]
  buffer_load_dwordx4 a[148:151], v2, s[40:43], s65 offen offset:0 sc1
  v_mfma_f32_16x16x32_bf16 a[136:139], v[112:115], a[152:155], a[136:139]
  buffer_load_dwordx4 a[152:155], v2, s[40:43], s66 offen offset:0 sc1
  v_mfma_f32_16x16x32_bf16 a[140:143], v[112:115], a[156:159], a[140:143]
  buffer_load_dwordx4 a[156:159], v2, s[40:43], s67 offen offset:0 sc1
  s_waitcnt vmcnt(18)
  v_mfma_f32_16x16x32_bf16 a[64:67], v[116:119], a[160:163], a[64:67]
  v_mfma_f32_16x16x32_bf16 a[68:71], v[116:119], a[164:167], a[68:71]
  v_mfma_f32_16x16x32_bf16 a[72:75], v[116:119], a[168:171], a[72:75]
  v_mfma_f32_16x16x32_bf16 a[76:79], v[116:119], a[172:175], a[76:79]
  v_mfma_f32_16x16x32_bf16 a[80:83], v[120:123], a[160:163], a[80:83]
  v_mfma_f32_16x16x32_bf16 a[84:87], v[120:123], a[164:167], a[84:87]
  v_mfma_f32_16x16x32_bf16 a[88:91], v[120:123], a[168:171], a[88:91]
  v_mfma_f32_16x16x32_bf16 a[92:95], v[120:123], a[172:175], a[92:95]
  v_mfma_f32_16x16x32_bf16 a[96:99], v[124:127], a[160:163], a[96:99]
  v_mfma_f32_16x16x32_bf16 a[100:103], v[124:127], a[164:167], a[100:103]
  v_mfma_f32_16x16x32_bf16 a[104:107], v[124:127], a[168:171], a[104:107]
  v_mfma_f32_16x16x32_bf16 a[108:111], v[124:127], a[172:175], a[108:111]
  v_mfma_f32_16x16x32_bf16 a[112:115], v[160:163], a[160:163], a[112:115]
  v_mfma_f32_16x16x32_bf16 a[116:119], v[160:163], a[164:167], a[116:119]
  v_mfma_f32_16x16x32_bf16 a[120:123], v[160:163], a[168:171], a[120:123]
  v_mfma_f32_16x16x32_bf16 a[124:127], v[160:163], a[172:175], a[124:127]
  v_mfma_f32_16x16x32_bf16 a[128:131], v[164:167], a[160:163], a[128:131]
  buffer_load_dwordx4 a[160:163], v2, s[40:43], s64 offen offset:1024 sc1
  v_mfma_f32_16x16x32_bf16 a[132:135], v[164:167], a[164:167], a[132:135]
  buffer_load_dwordx4 a[164:167], v2, s[40:43], s65 offen offset:1024 sc1
  v_mfma_f32_16x16x32_bf16 a[136:139], v[164:167], a[168:171], a[136:139]
  buffer_load_dwordx4 a[168:171], v2, s[40:43], s66 offen offset:1024 sc1
  v_mfma_f32_16x16x32_bf16 a[140:143], v[164:167], a[172:175], a[140:143]
  buffer_load_dwordx4 a[172:175], v2, s[40:43], s67 offen offset:1024 sc1
  s_waitcnt vmcnt(18)
  v_mfma_f32_16x16x32_bf16 a[64:67], v[168:171], a[176:179], a[64:67]
  v_mfma_f32_16x16x32_bf16 a[68:71], v[168:171], a[180:183], a[68:71]
  v_mfma_f32_16x16x32_bf16 a[72:75], v[168:171], a[184:187], a[72:75]
  v_mfma_f32_16x16x32_bf16 a[76:79], v[168:171], a[188:191], a[76:79]
  v_mfma_f32_16x16x32_bf16 a[80:83], v[172:175], a[176:179], a[80:83]
  v_mfma_f32_16x16x32_bf16 a[84:87], v[172:175], a[180:183], a[84:87]
  v_mfma_f32_16x16x32_bf16 a[88:91], v[172:175], a[184:187], a[88:91]
  v_mfma_f32_16x16x32_bf16 a[92:95], v[172:175], a[188:191], a[92:95]
  v_mfma_f32_16x16x32_bf16 a[96:99], v[192:195], a[176:179], a[96:99]
  v_mfma_f32_16x16x32_bf16 a[100:103], v[192:195], a[180:183], a[100:103]
  v_mfma_f32_16x16x32_bf16 a[104:107], v[192:195], a[184:187], a[104:107]
  v_mfma_f32_16x16x32_bf16 a[108:111], v[192:195], a[188:191], a[108:111]
  v_mfma_f32_16x16x32_bf16 a[112:115], v[196:199], a[176:179], a[112:115]
  v_mfma_f32_16x16x32_bf16 a[116:119], v[196:199], a[180:183], a[116:119]
  v_mfma_f32_16x16x32_bf16 a[120:123], v[196:199], a[184:187], a[120:123]
  v_mfma_f32_16x16x32_bf16 a[124:127], v[196:199], a[188:191], a[124:127]
  v_mfma_f32_16x16x32_bf16 a[128:131], v[208:211], a[176:179], a[128:131]
  buffer_load_dwordx4 a[176:179], v2, s[40:43], s64 offen offset:2048 sc1
  v_mfma_f32_16x16x32_bf16 a[132:135], v[208:211], a[180:183], a[132:135]
  buffer_load_dwordx4 a[180:183], v2, s[40:43], s65 offen offset:2048 sc1
  v_mfma_f32_16x16x32_bf16 a[136:139], v[208:211], a[184:187], a[136:139]
  buffer_load_dwordx4 a[184:187], v2, s[40:43], s66 offen offset:2048 sc1
  v_mfma_f32_16x16x32_bf16 a[140:143], v[208:211], a[188:191], a[140:143]
  buffer_load_dwordx4 a[188:191], v2, s[40:43], s67 offen offset:2048 sc1
  s_waitcnt vmcnt(18)
  v_mfma_f32_16x16x32_bf16 a[64:67], v[212:215], v[216:219], a[64:67]
  v_mfma_f32_16x16x32_bf16 a[68:71], v[212:215], v[220:223], a[68:71]
  ds_read_b128 v[120:123], v203 offset:0
  v_mfma_f32_16x16x32_bf16 a[72:75], v[212:215], v[224:227], a[72:75]
  v_add_u32 v20, 77824, v251
  v_mfma_f32_16x16x32_bf16 a[76:79], v[212:215], v[228:231], a[76:79]
  ds_read_b128 v[124:127], v203 offset:16
  v_mfma_f32_16x16x32_bf16 a[80:83], v[232:235], v[216:219], a[80:83]
  v_mfma_f32_16x16x32_bf16 a[84:87], v[232:235], v[220:223], a[84:87]
  ds_read_b128 v[160:163], v204 offset:0
  v_mfma_f32_16x16x32_bf16 a[88:91], v[232:235], v[224:227], a[88:91]
  v_add_u32 v21, 77824, v252
  v_mfma_f32_16x16x32_bf16 a[92:95], v[232:235], v[228:231], a[92:95]
  ds_read_b128 v[164:167], v204 offset:16
  v_mfma_f32_16x16x32_bf16 a[96:99], v[236:239], v[216:219], a[96:99]
  v_mfma_f32_16x16x32_bf16 a[100:103], v[236:239], v[220:223], a[100:103]
  ds_read_b128 v[168:171], v205 offset:0
  v_mfma_f32_16x16x32_bf16 a[104:107], v[236:239], v[224:227], a[104:107]
  v_add_u32 v22, 77824, v253
  v_mfma_f32_16x16x32_bf16 a[108:111], v[236:239], v[228:231], a[108:111]
  ds_read_b128 v[172:175], v205 offset:16
  v_mfma_f32_16x16x32_bf16 a[112:115], v[240:243], v[216:219], a[112:115]
  v_mfma_f32_16x16x32_bf16 a[116:119], v[240:243], v[220:223], a[116:119]
  v_mfma_f32_16x16x32_bf16 a[120:123], v[240:243], v[224:227], a[120:123]
  s_mul_i32 s23, s20, 38912
  v_and_b32 v16, 15, v1
  v_mul_u32_u24 v16, 336, v16
  v_mfma_f32_16x16x32_bf16 a[124:127], v[240:243], v[228:231], a[124:127]
  v_lshrrev_b32 v17, 4, v1
  v_lshl_add_u32 v16, v17, 4, v16
  v_mfma_f32_16x16x32_bf16 a[128:131], v[244:247], v[216:219], a[128:131]
  buffer_load_dwordx4 v[216:219], v2, s[40:43], s64 offen offset:3072 sc1
  v_add_u32 v16, s23, v16
  v_mfma_f32_16x16x32_bf16 a[132:135], v[244:247], v[220:223], a[132:135]
  buffer_load_dwordx4 v[220:223], v2, s[40:43], s65 offen offset:3072 sc1
  v_mfma_f32_16x16x32_bf16 a[136:139], v[244:247], v[224:227], a[136:139]
  s_waitcnt lgkmcnt(0)
  buffer_load_dwordx4 v[224:227], v2, s[40:43], s66 offen offset:3072 sc1
  v_mfma_f32_16x16x32_bf16 a[140:143], v[244:247], v[228:231], a[140:143]
  buffer_load_dwordx4 v[228:231], v2, s[40:43], s67 offen offset:3072 sc1
  s_waitcnt vmcnt(12)
  v_mfma_f32_16x16x32_bf16 a[64:67], v[64:67], a[144:147], a[64:67]
  v_lshlrev_b32 v18, 16, v44
  v_and_b32 v19, 0xffff0000, v44
  v_mfma_f32_16x16x32_bf16 a[68:71], v[64:67], a[148:151], a[68:71]
  v_add_f32 v120, v120, v18
  v_add_f32 v121, v121, v19
  v_mfma_f32_16x16x32_bf16 a[72:75], v[64:67], a[152:155], a[72:75]
  v_cvt_pk_bf16_f32 v18, v120, v121
  v_lshlrev_b32 v96, 16, v32
  v_mfma_f32_16x16x32_bf16 a[76:79], v[64:67], a[156:159], a[76:79]
  v_and_b32 v97, 0xffff0000, v32
  v_lshlrev_b32 v120, 16, v18
  v_mfma_f32_16x16x32_bf16 a[80:83], v[68:71], a[144:147], a[80:83]
  v_and_b32 v121, 0xffff0000, v18
  v_lshlrev_b32 v18, 16, v45
  v_mfma_f32_16x16x32_bf16 a[84:87], v[68:71], a[148:151], a[84:87]
  v_and_b32 v19, 0xffff0000, v45
  v_add_f32 v122, v122, v18
  v_mfma_f32_16x16x32_bf16 a[88:91], v[68:71], a[152:155], a[88:91]
  v_add_f32 v123, v123, v19
  v_cvt_pk_bf16_f32 v18, v122, v123
  v_mfma_f32_16x16x32_bf16 a[92:95], v[68:71], a[156:159], a[92:95]
  v_lshlrev_b32 v98, 16, v33
  v_and_b32 v99, 0xffff0000, v33
  v_mfma_f32_16x16x32_bf16 a[96:99], v[72:75], a[144:147], a[96:99]
  v_lshlrev_b32 v122, 16, v18
  v_and_b32 v123, 0xffff0000, v18
  v_mfma_f32_16x16x32_bf16 a[100:103], v[72:75], a[148:151], a[100:103]
  v_lshlrev_b32 v18, 16, v46
  v_and_b32 v19, 0xffff0000, v46
  v_mfma_f32_16x16x32_bf16 a[104:107], v[72:75], a[152:155], a[104:107]
  v_add_f32 v124, v124, v18
  v_add_f32 v125, v125, v19
  v_mfma_f32_16x16x32_bf16 a[108:111], v[72:75], a[156:159], a[108:111]
  v_cvt_pk_bf16_f32 v18, v124, v125
  v_lshlrev_b32 v100, 16, v34
  v_mfma_f32_16x16x32_bf16 a[112:115], v[76:79], a[144:147], a[112:115]
  v_and_b32 v101, 0xffff0000, v34
  v_lshlrev_b32 v124, 16, v18
  v_mfma_f32_16x16x32_bf16 a[116:119], v[76:79], a[148:151], a[116:119]
  v_and_b32 v125, 0xffff0000, v18
  v_lshlrev_b32 v18, 16, v47
  v_mfma_f32_16x16x32_bf16 a[120:123], v[76:79], a[152:155], a[120:123]
  v_and_b32 v19, 0xffff0000, v47
  v_add_f32 v126, v126, v18
  v_mfma_f32_16x16x32_bf16 a[124:127], v[76:79], a[156:159], a[124:127]
  v_add_f32 v127, v127, v19
  v_cvt_pk_bf16_f32 v18, v126, v127
  v_mfma_f32_16x16x32_bf16 a[128:131], v[80:83], a[144:147], a[128:131]
  v_lshlrev_b32 v102, 16, v35
  v_and_b32 v103, 0xffff0000, v35
  v_mfma_f32_16x16x32_bf16 a[132:135], v[80:83], a[148:151], a[132:135]
  v_lshlrev_b32 v126, 16, v18
  v_and_b32 v127, 0xffff0000, v18
  v_mfma_f32_16x16x32_bf16 a[136:139], v[80:83], a[152:155], a[136:139]
  v_mfma_f32_16x16x32_bf16 a[140:143], v[80:83], a[156:159], a[140:143]
  s_waitcnt vmcnt(8)
  v_mfma_f32_16x16x32_bf16 a[64:67], v[84:87], a[160:163], a[64:67]
  v_lshlrev_b32 v18, 16, v48
  v_and_b32 v19, 0xffff0000, v48
  v_mfma_f32_16x16x32_bf16 a[68:71], v[84:87], a[164:167], a[68:71]
  v_add_f32 v160, v160, v18
  v_add_f32 v161, v161, v19
  v_mfma_f32_16x16x32_bf16 a[72:75], v[84:87], a[168:171], a[72:75]
  v_cvt_pk_bf16_f32 v18, v160, v161
  v_lshlrev_b32 v104, 16, v36
  v_mfma_f32_16x16x32_bf16 a[76:79], v[84:87], a[172:175], a[76:79]
  v_and_b32 v105, 0xffff0000, v36
  v_lshlrev_b32 v160, 16, v18
  v_mfma_f32_16x16x32_bf16 a[80:83], v[88:91], a[160:163], a[80:83]
  v_and_b32 v161, 0xffff0000, v18
  v_lshlrev_b32 v18, 16, v49
  v_mfma_f32_16x16x32_bf16 a[84:87], v[88:91], a[164:167], a[84:87]
  v_and_b32 v19, 0xffff0000, v49
  v_add_f32 v162, v162, v18
  v_mfma_f32_16x16x32_bf16 a[88:91], v[88:91], a[168:171], a[88:91]
  v_add_f32 v163, v163, v19
  v_cvt_pk_bf16_f32 v18, v162, v163
  v_mfma_f32_16x16x32_bf16 a[92:95], v[88:91], a[172:175], a[92:95]
  v_lshlrev_b32 v106, 16, v37
  v_and_b32 v107, 0xffff0000, v37
  v_mfma_f32_16x16x32_bf16 a[96:99], v[92:95], a[160:163], a[96:99]
  v_lshlrev_b32 v162, 16, v18
  v_and_b32 v163, 0xffff0000, v18
  v_mfma_f32_16x16x32_bf16 a[100:103], v[92:95], a[164:167], a[100:103]
  v_lshlrev_b32 v18, 16, v50
  v_and_b32 v19, 0xffff0000, v50
  v_mfma_f32_16x16x32_bf16 a[104:107], v[92:95], a[168:171], a[104:107]
  v_add_f32 v164, v164, v18
  v_add_f32 v165, v165, v19
  v_mfma_f32_16x16x32_bf16 a[108:111], v[92:95], a[172:175], a[108:111]
  v_cvt_pk_bf16_f32 v18, v164, v165
  v_lshlrev_b32 v108, 16, v38
  v_mfma_f32_16x16x32_bf16 a[112:115], v[128:131], a[160:163], a[112:115]
  v_and_b32 v109, 0xffff0000, v38
  v_lshlrev_b32 v164, 16, v18
  v_mfma_f32_16x16x32_bf16 a[116:119], v[128:131], a[164:167], a[116:119]
  v_and_b32 v165, 0xffff0000, v18
  v_lshlrev_b32 v18, 16, v51
  v_mfma_f32_16x16x32_bf16 a[120:123], v[128:131], a[168:171], a[120:123]
  v_and_b32 v19, 0xffff0000, v51
  v_add_f32 v166, v166, v18
  v_mfma_f32_16x16x32_bf16 a[124:127], v[128:131], a[172:175], a[124:127]
  v_add_f32 v167, v167, v19
  v_cvt_pk_bf16_f32 v18, v166, v167
  v_mfma_f32_16x16x32_bf16 a[128:131], v[132:135], a[160:163], a[128:131]
  v_lshlrev_b32 v110, 16, v39
  v_and_b32 v111, 0xffff0000, v39
  v_mfma_f32_16x16x32_bf16 a[132:135], v[132:135], a[164:167], a[132:135]
  v_lshlrev_b32 v166, 16, v18
  v_and_b32 v167, 0xffff0000, v18
  v_mfma_f32_16x16x32_bf16 a[136:139], v[132:135], a[168:171], a[136:139]
  v_mfma_f32_16x16x32_bf16 a[140:143], v[132:135], a[172:175], a[140:143]
  s_waitcnt vmcnt(4)
  v_mfma_f32_16x16x32_bf16 a[64:67], v[136:139], a[176:179], a[64:67]
  v_lshlrev_b32 v18, 16, v52
  v_and_b32 v19, 0xffff0000, v52
  v_mfma_f32_16x16x32_bf16 a[68:71], v[136:139], a[180:183], a[68:71]
  v_add_f32 v168, v168, v18
  v_add_f32 v169, v169, v19
  v_mfma_f32_16x16x32_bf16 a[72:75], v[136:139], a[184:187], a[72:75]
  v_cvt_pk_bf16_f32 v18, v168, v169
  v_lshlrev_b32 v112, 16, v40
  v_mfma_f32_16x16x32_bf16 a[76:79], v[136:139], a[188:191], a[76:79]
  v_and_b32 v113, 0xffff0000, v40
  v_lshlrev_b32 v168, 16, v18
  v_mfma_f32_16x16x32_bf16 a[80:83], v[140:143], a[176:179], a[80:83]
  v_and_b32 v169, 0xffff0000, v18
  v_lshlrev_b32 v18, 16, v53
  v_mfma_f32_16x16x32_bf16 a[84:87], v[140:143], a[180:183], a[84:87]
  v_and_b32 v19, 0xffff0000, v53
  v_add_f32 v170, v170, v18
  v_mfma_f32_16x16x32_bf16 a[88:91], v[140:143], a[184:187], a[88:91]
  v_add_f32 v171, v171, v19
  v_cvt_pk_bf16_f32 v18, v170, v171
  v_mfma_f32_16x16x32_bf16 a[92:95], v[140:143], a[188:191], a[92:95]
  v_lshlrev_b32 v114, 16, v41
  v_and_b32 v115, 0xffff0000, v41
  v_mfma_f32_16x16x32_bf16 a[96:99], v[144:147], a[176:179], a[96:99]
  v_lshlrev_b32 v170, 16, v18
  v_and_b32 v171, 0xffff0000, v18
  v_mfma_f32_16x16x32_bf16 a[100:103], v[144:147], a[180:183], a[100:103]
  v_lshlrev_b32 v18, 16, v54
  v_and_b32 v19, 0xffff0000, v54
  v_mfma_f32_16x16x32_bf16 a[104:107], v[144:147], a[184:187], a[104:107]
  v_add_f32 v172, v172, v18
  v_add_f32 v173, v173, v19
  v_mfma_f32_16x16x32_bf16 a[108:111], v[144:147], a[188:191], a[108:111]
  v_cvt_pk_bf16_f32 v18, v172, v173
  v_lshlrev_b32 v116, 16, v42
  v_mfma_f32_16x16x32_bf16 a[112:115], v[148:151], a[176:179], a[112:115]
  v_and_b32 v117, 0xffff0000, v42
  v_lshlrev_b32 v172, 16, v18
  v_mfma_f32_16x16x32_bf16 a[116:119], v[148:151], a[180:183], a[116:119]
  v_and_b32 v173, 0xffff0000, v18
  v_lshlrev_b32 v18, 16, v55
  v_mfma_f32_16x16x32_bf16 a[120:123], v[148:151], a[184:187], a[120:123]
  v_and_b32 v19, 0xffff0000, v55
  v_add_f32 v174, v174, v18
  v_mfma_f32_16x16x32_bf16 a[124:127], v[148:151], a[188:191], a[124:127]
  v_add_f32 v175, v175, v19
  v_cvt_pk_bf16_f32 v18, v174, v175
  v_mfma_f32_16x16x32_bf16 a[128:131], v[152:155], a[176:179], a[128:131]
  v_lshlrev_b32 v118, 16, v43
  v_and_b32 v119, 0xffff0000, v43
  v_mfma_f32_16x16x32_bf16 a[132:135], v[152:155], a[180:183], a[132:135]
  v_lshlrev_b32 v174, 16, v18
  v_and_b32 v175, 0xffff0000, v18
  v_mfma_f32_16x16x32_bf16 a[136:139], v[152:155], a[184:187], a[136:139]
  v_mfma_f32_16x16x32_bf16 a[140:143], v[152:155], a[188:191], a[140:143]
  s_waitcnt vmcnt(0)
  v_mfma_f32_16x16x32_bf16 a[64:67], v[156:159], v[216:219], a[64:67]
  v_mfma_f32_16x16x32_bf16 a[68:71], v[156:159], v[220:223], a[68:71]
  v_mfma_f32_16x16x32_bf16 a[72:75], v[156:159], v[224:227], a[72:75]
  v_mfma_f32_16x16x32_bf16 a[76:79], v[156:159], v[228:231], a[76:79]
  v_mfma_f32_16x16x32_bf16 a[80:83], v[176:179], v[216:219], a[80:83]
  v_mfma_f32_16x16x32_bf16 a[84:87], v[176:179], v[220:223], a[84:87]
  v_mfma_f32_16x16x32_bf16 a[88:91], v[176:179], v[224:227], a[88:91]
  v_mfma_f32_16x16x32_bf16 a[92:95], v[176:179], v[228:231], a[92:95]
  v_mfma_f32_16x16x32_bf16 a[96:99], v[180:183], v[216:219], a[96:99]
  v_mfma_f32_16x16x32_bf16 a[100:103], v[180:183], v[220:223], a[100:103]
  ds_write_b128 v16, a[64:67] offset:0
  v_mfma_f32_16x16x32_bf16 a[104:107], v[180:183], v[224:227], a[104:107]
  ds_write_b128 v16, a[68:71] offset:5376
  v_mfma_f32_16x16x32_bf16 a[108:111], v[180:183], v[228:231], a[108:111]
  ds_write_b128 v16, a[72:75] offset:10752
  v_mfma_f32_16x16x32_bf16 a[112:115], v[184:187], v[216:219], a[112:115]
  ds_write_b128 v16, a[76:79] offset:16128
  v_mfma_f32_16x16x32_bf16 a[116:119], v[184:187], v[220:223], a[116:119]
  ds_write_b128 v16, a[80:83] offset:64
  v_mfma_f32_16x16x32_bf16 a[120:123], v[184:187], v[224:227], a[120:123]
  ds_write_b128 v16, a[84:87] offset:5440
  v_mfma_f32_16x16x32_bf16 a[124:127], v[184:187], v[228:231], a[124:127]
  ds_write_b128 v16, a[88:91] offset:10816
  v_mfma_f32_16x16x32_bf16 a[128:131], v[188:191], v[216:219], a[128:131]
  ds_write_b128 v16, a[92:95] offset:16192
  v_mfma_f32_16x16x32_bf16 a[132:135], v[188:191], v[220:223], a[132:135]
  ds_write_b128 v16, a[96:99] offset:128
  v_mfma_f32_16x16x32_bf16 a[136:139], v[188:191], v[224:227], a[136:139]
  ds_write_b128 v16, a[100:103] offset:5504
  v_mfma_f32_16x16x32_bf16 a[140:143], v[188:191], v[228:231], a[140:143]
  ds_write_b128 v16, a[104:107] offset:10880
  ds_write_b128 v16, a[108:111] offset:16256
  ds_write_b128 v16, a[112:115] offset:192
  ds_write_b128 v16, a[116:119] offset:5568
  ds_write_b128 v16, a[120:123] offset:10944
  ds_write_b128 v16, a[124:127] offset:16320
  ds_write_b128 v16, a[128:131] offset:256
  ds_write_b128 v16, a[132:135] offset:5632
  ds_write_b128 v16, a[136:139] offset:11008
  ds_write_b128 v16, a[140:143] offset:16384
  s_waitcnt lgkmcnt(0)
  s_barrier
  ds_read_b128 v[32:35], v251 offset:0
  ds_read_b128 v[36:39], v251 offset:16
  ds_read_b128 v[40:43], v251 offset:38912
  ds_read_b128 v[44:47], v251 offset:38928
  ds_read_b128 v[48:51], v20 offset:0
  ds_read_b128 v[52:55], v20 offset:16
  ds_read_b128 v[56:59], v20 offset:38912
  ds_read_b128 v[60:63], v20 offset:38928
  ds_read_b128 v[64:67], v252 offset:0
  ds_read_b128 v[68:71], v252 offset:16
  ds_read_b128 v[72:75], v252 offset:38912
  ds_read_b128 v[76:79], v252 offset:38928
  ds_read_b128 v[80:83], v21 offset:0
  ds_read_b128 v[84:87], v21 offset:16
  ds_read_b128 v[88:91], v21 offset:38912
  ds_read_b128 v[92:95], v21 offset:38928
  ds_read_b128 v[128:131], v253 offset:0
  ds_read_b128 v[132:135], v253 offset:16
  ds_read_b128 v[136:139], v253 offset:38912
  ds_read_b128 v[140:143], v253 offset:38928
  ds_read_b128 v[144:147], v22 offset:0
  ds_read_b128 v[148:151], v22 offset:16
  ds_read_b128 v[152:155], v22 offset:38912
  ds_read_b128 v[156:159], v22 offset:38928
  s_waitcnt lgkmcnt(15)
  v_pk_add_f32 v[32:33], v[32:33], v[40:41]
  v_pk_add_f32 v[48:49], v[48:49], v[56:57]
  v_pk_add_f32 v[34:35], v[34:35], v[42:43]
  v_pk_add_f32 v[50:51], v[50:51], v[58:59]
  v_pk_add_f32 v[36:37], v[36:37], v[44:45]
  v_pk_add_f32 v[52:53], v[52:53], v[60:61]
  v_pk_add_f32 v[38:39], v[38:39], v[46:47]
  v_pk_add_f32 v[54:55], v[54:55], v[62:63]
  v_pk_add_f32 v[32:33], v[32:33], v[48:49]
  v_pk_add_f32 v[34:35], v[34:35], v[50:51]
  v_pk_add_f32 v[36:37], v[36:37], v[52:53]
  v_pk_add_f32 v[38:39], v[38:39], v[54:55]
  v_cvt_pk_bf16_f32 v40, v32, v33
  v_cvt_pk_bf16_f32 v41, v34, v35
  v_cvt_pk_bf16_f32 v42, v36, v37
  v_cvt_pk_bf16_f32 v43, v38, v39
  v_lshlrev_b32 v32, 16, v40
  v_and_b32 v33, 0xffff0000, v40
  v_lshlrev_b32 v34, 16, v41
  v_and_b32 v35, 0xffff0000, v41
  v_lshlrev_b32 v36, 16, v42
  v_and_b32 v37, 0xffff0000, v42
  v_lshlrev_b32 v38, 16, v43
  v_and_b32 v39, 0xffff0000, v43
  v_pk_add_f32 v[32:33], v[32:33], v[96:97]
  v_pk_add_f32 v[34:35], v[34:35], v[98:99]
  v_pk_add_f32 v[36:37], v[36:37], v[100:101]
  v_pk_add_f32 v[38:39], v[38:39], v[102:103]
  v_cvt_pk_bf16_f32 v40, v32, v33
  v_cvt_pk_bf16_f32 v41, v34, v35
  v_cvt_pk_bf16_f32 v42, v36, v37
  v_cvt_pk_bf16_f32 v43, v38, v39
  v_lshlrev_b32 v32, 16, v40
  v_and_b32 v33, 0xffff0000, v40
  v_lshlrev_b32 v34, 16, v41
  v_and_b32 v35, 0xffff0000, v41
  v_lshlrev_b32 v36, 16, v42
  v_and_b32 v37, 0xffff0000, v42
  v_lshlrev_b32 v38, 16, v43
  v_and_b32 v39, 0xffff0000, v43
  v_pk_add_f32 v[32:33], v[32:33], v[120:121]
  v_pk_add_f32 v[34:35], v[34:35], v[122:123]
  v_pk_add_f32 v[36:37], v[36:37], v[124:125]
  v_pk_add_f32 v[38:39], v[38:39], v[126:127]
  v_cvt_pk_bf16_f32 v44, v32, v33
  v_cvt_pk_bf16_f32 v45, v34, v35
  v_cvt_pk_bf16_f32 v46, v36, v37
  v_cvt_pk_bf16_f32 v47, v38, v39
  buffer_store_dwordx4 v[44:47], v248, s[48:51], 0 offen
  s_waitcnt lgkmcnt(8)
  v_pk_add_f32 v[64:65], v[64:65], v[72:73]
  v_pk_add_f32 v[80:81], v[80:81], v[88:89]
  v_pk_add_f32 v[66:67], v[66:67], v[74:75]
  v_pk_add_f32 v[82:83], v[82:83], v[90:91]
  v_pk_add_f32 v[68:69], v[68:69], v[76:77]
  v_pk_add_f32 v[84:85], v[84:85], v[92:93]
  v_pk_add_f32 v[70:71], v[70:71], v[78:79]
  v_pk_add_f32 v[86:87], v[86:87], v[94:95]
  v_pk_add_f32 v[64:65], v[64:65], v[80:81]
  v_pk_add_f32 v[66:67], v[66:67], v[82:83]
  v_pk_add_f32 v[68:69], v[68:69], v[84:85]
  v_pk_add_f32 v[70:71], v[70:71], v[86:87]
  v_cvt_pk_bf16_f32 v72, v64, v65
  v_cvt_pk_bf16_f32 v73, v66, v67
  v_cvt_pk_bf16_f32 v74, v68, v69
  v_cvt_pk_bf16_f32 v75, v70, v71
  v_lshlrev_b32 v64, 16, v72
  v_and_b32 v65, 0xffff0000, v72
  v_lshlrev_b32 v66, 16, v73
  v_and_b32 v67, 0xffff0000, v73
  v_lshlrev_b32 v68, 16, v74
  v_and_b32 v69, 0xffff0000, v74
  v_lshlrev_b32 v70, 16, v75
  v_and_b32 v71, 0xffff0000, v75
  v_pk_add_f32 v[64:65], v[64:65], v[104:105]
  v_pk_add_f32 v[66:67], v[66:67], v[106:107]
  v_pk_add_f32 v[68:69], v[68:69], v[108:109]
  v_pk_add_f32 v[70:71], v[70:71], v[110:111]
  v_cvt_pk_bf16_f32 v72, v64, v65
  v_cvt_pk_bf16_f32 v73, v66, v67
  v_cvt_pk_bf16_f32 v74, v68, v69
  v_cvt_pk_bf16_f32 v75, v70, v71
  v_lshlrev_b32 v64, 16, v72
  v_and_b32 v65, 0xffff0000, v72
  v_lshlrev_b32 v66, 16, v73
  v_and_b32 v67, 0xffff0000, v73
  v_lshlrev_b32 v68, 16, v74
  v_and_b32 v69, 0xffff0000, v74
  v_lshlrev_b32 v70, 16, v75
  v_and_b32 v71, 0xffff0000, v75
  v_pk_add_f32 v[64:65], v[64:65], v[160:161]
  v_pk_add_f32 v[66:67], v[66:67], v[162:163]
  v_pk_add_f32 v[68:69], v[68:69], v[164:165]
  v_pk_add_f32 v[70:71], v[70:71], v[166:167]
  v_cvt_pk_bf16_f32 v76, v64, v65
  v_cvt_pk_bf16_f32 v77, v66, v67
  v_cvt_pk_bf16_f32 v78, v68, v69
  v_cvt_pk_bf16_f32 v79, v70, v71
  buffer_store_dwordx4 v[76:79], v249, s[48:51], 0 offen
  s_waitcnt lgkmcnt(0)
  v_pk_add_f32 v[128:129], v[128:129], v[136:137]
  v_pk_add_f32 v[144:145], v[144:145], v[152:153]
  v_pk_add_f32 v[130:131], v[130:131], v[138:139]
  v_pk_add_f32 v[146:147], v[146:147], v[154:155]
  v_pk_add_f32 v[132:133], v[132:133], v[140:141]
  v_pk_add_f32 v[148:149], v[148:149], v[156:157]
  v_pk_add_f32 v[134:135], v[134:135], v[142:143]
  v_pk_add_f32 v[150:151], v[150:151], v[158:159]
  v_pk_add_f32 v[128:129], v[128:129], v[144:145]
  v_pk_add_f32 v[130:131], v[130:131], v[146:147]
  v_pk_add_f32 v[132:133], v[132:133], v[148:149]
  v_pk_add_f32 v[134:135], v[134:135], v[150:151]
  v_cvt_pk_bf16_f32 v136, v128, v129
  v_cvt_pk_bf16_f32 v137, v130, v131
  v_cvt_pk_bf16_f32 v138, v132, v133
  v_cvt_pk_bf16_f32 v139, v134, v135
  v_lshlrev_b32 v128, 16, v136
  v_and_b32 v129, 0xffff0000, v136
  v_lshlrev_b32 v130, 16, v137
  v_and_b32 v131, 0xffff0000, v137
  v_lshlrev_b32 v132, 16, v138
  v_and_b32 v133, 0xffff0000, v138
  v_lshlrev_b32 v134, 16, v139
  v_and_b32 v135, 0xffff0000, v139
  v_pk_add_f32 v[128:129], v[128:129], v[112:113]
  v_pk_add_f32 v[130:131], v[130:131], v[114:115]
  v_pk_add_f32 v[132:133], v[132:133], v[116:117]
  v_pk_add_f32 v[134:135], v[134:135], v[118:119]
  v_cvt_pk_bf16_f32 v136, v128, v129
  v_cvt_pk_bf16_f32 v137, v130, v131
  v_cvt_pk_bf16_f32 v138, v132, v133
  v_cvt_pk_bf16_f32 v139, v134, v135
  v_lshlrev_b32 v128, 16, v136
  v_and_b32 v129, 0xffff0000, v136
  v_lshlrev_b32 v130, 16, v137
  v_and_b32 v131, 0xffff0000, v137
  v_lshlrev_b32 v132, 16, v138
  v_and_b32 v133, 0xffff0000, v138
  v_lshlrev_b32 v134, 16, v139
  v_and_b32 v135, 0xffff0000, v139
  v_pk_add_f32 v[128:129], v[128:129], v[168:169]
  v_pk_add_f32 v[130:131], v[130:131], v[170:171]
  v_pk_add_f32 v[132:133], v[132:133], v[172:173]
  v_pk_add_f32 v[134:135], v[134:135], v[174:175]
  v_cvt_pk_bf16_f32 v140, v128, v129
  v_cvt_pk_bf16_f32 v141, v130, v131
  v_cvt_pk_bf16_f32 v142, v132, v133
  v_cvt_pk_bf16_f32 v143, v134, v135
  buffer_store_dwordx4 v[140:143], v250, s[48:51], 0 offen
fa_end:
  s_endpgm
fa_hk0:
  s_getpc_b64 s[10:11]
fa_hp0:
  s_add_u32 s8, s8, 4
  s_addc_u32 s9, s9, 0
  s_sub_u32 s10, s10, fa_hp0-fa_hb0
  s_subb_u32 s11, s11, 0
  s_setpc_b64 s[8:9]
fa_hk1:
  s_getpc_b64 s[10:11]
fa_hp1:
  s_add_u32 s8, s8, 4
  s_addc_u32 s9, s9, 0
  s_sub_u32 s10, s10, fa_hp1-fa_hb1
  s_subb_u32 s11, s11, 0
  s_setpc_b64 s[8:9]
fa_hk2:
  s_getpc_b64 s[10:11]
fa_hp2:
  s_add_u32 s8, s8, 4
  s_addc_u32 s9, s9, 0
  s_sub_u32 s10, s10, fa_hp2-fa_hb2
  s_subb_u32 s11, s11, 0
  s_setpc_b64 s[8:9]
fa_hk3:
  s_getpc_b64 s[10:11]
fa_hp3:
  s_add_u32 s8, s8, 4
  s_addc_u32 s9, s9, 0
  s_sub_u32 s10, s10, fa_hp3-fa_hb3
  s_subb_u32 s11, s11, 0
  s_setpc_b64 s[8:9]
fa_ln_spin:
  s_mov_b32 s83, 200000
fa_ln_spin2:
  buffer_load_dword v15, v229, s[56:59], 0 offen sc1
  s_waitcnt vmcnt(0)
  v_cmp_ne_u32 vcc, 0x01010101, v15
  s_cbranch_vccz fa_ln_ok
  s_sleep 8
  s_sub_u32 s83, s83, 1
  s_cmp_lg_u32 s83, 0
  s_cbranch_scc1 fa_ln_spin2
  s_branch fa_ln_ok
fa_co1:
  buffer_load_dword v232, v234, s[32:35], s29 offen
  buffer_store_dword v229, v225, s[40:43], 0 offen sc1
  ds_read_b128 v[160:163], v221 offset:0
  ds_read_b128 v[164:167], v221 offset:4096
  ds_read_b128 v[168:171], v221 offset:8192
  buffer_store_dword v218, v222, s[40:43], 0 offen sc1
  s_waitcnt lgkmcnt(0)
  buffer_store_dwordx4 v[160:163], v223, s[40:43], s66 offen sc1
  buffer_store_dwordx4 v[164:167], v223, s[40:43], s67 offen sc1
  buffer_store_dwordx4 v[168:171], v224, s[40:43], s78 offen sc1
  s_getpc_b64 s[8:9]
  s_setpc_b64 s[10:11]
  s_mov_b32 s48, s60
  s_mov_b32 s49, s61
  s_mov_b32 s50, s75
  s_lshl_b32 s74, s22, 2
  s_add_u32 s74, s74, s20
  s_lshl_b32 s74, s74, 16
  s_mov_b32 s73, 2097152
  v_mov_b32 v213, 1073741824
  v_mov_b32 v214, 1
  v_writelane_b32 v213, s77, 0
  v_lshlrev_b32 v229, 2, v1
  s_and_b32 s23, s21, 3
  s_cbranch_scc0 fa_arr
  s_getpc_b64 s[8:9]
  s_setpc_b64 s[10:11]
fa_arr:
  buffer_store_byte v214, v213, s[56:59], 0 offen sc1
  s_getpc_b64 s[8:9]
  s_setpc_b64 s[10:11]
  buffer_load_dword v15, v229, s[56:59], 0 offen sc1
  s_getpc_b64 s[8:9]
  s_setpc_b64 s[10:11]
  s_mov_b32 s36, s60
  s_mov_b32 s37, s61
  s_mov_b32 s38, s75
  s_lshr_b32 s27, s20, 1
  s_lshl_b32 s27, s27, 18
  s_mov_b32 s25, 524288
  s_mov_b32 s32, s18
  s_mov_b32 s33, s19
  s_mov_b32 s34, 2621440
  s_mov_b32 s26, 0
  s_movk_i32 s79, 1024
  s_lshl_b32 s23, s22, 2
  s_add_u32 s23, s23, s20
  s_mul_i32 s23, s23, 40960
  v_add_u32 v3, s23, v2
  s_sub_u32 s23, 15, s22
  s_lshl_b32 s23, s23, 2
  s_add_u32 s23, s23, s20
  s_mul_i32 s23, s23, 40960
  s_sub_u32 s23, s23, 2048
  v_add_u32 v5, s23, v2
  v_add_u32 v4, 19456, v3
  v_add_u32 v6, 19456, v5
  s_waitcnt vmcnt(8)
  v_cmp_ne_u32 vcc, 0x01010101, v15
  s_cbranch_vccnz fa_ln_spin
fa_ln_ok:
  s_setpc_b64 s[10:11]
fa_kv_spin:
  s_mov_b32 s83, 200000
fa_kv_spin2:
  buffer_load_dword v15, v8, s[40:43], 0 offen sc1
  s_waitcnt vmcnt(0)
  v_cmp_eq_u32 vcc, 0, v15
  s_cbranch_vccz fa_kv_ok
  s_sleep 8
  s_sub_u32 s83, s83, 1
  s_cmp_lg_u32 s83, 0
  s_cbranch_scc1 fa_kv_spin2
  s_branch fa_kv_ok
fa_wo0:
  s_add_u32 m0, s34, 0
  s_nop 0
  buffer_load_dwordx4 v24, s[56:59], s33 offen lds
  s_add_u32 m0, s34, 1024
  s_nop 0
  buffer_load_dwordx4 v25, s[56:59], s33 offen lds
  s_add_u32 m0, s34, 2048
  s_nop 0
  buffer_load_dwordx4 v26, s[56:59], s33 offen lds
  s_add_u32 m0, s34, 3072
  s_nop 0
  buffer_load_dwordx4 v27, s[56:59], s33 offen lds
  s_add_u32 m0, s34, 4096
  s_nop 0
  buffer_load_dwordx4 v28, s[56:59], s33 offen lds
  s_branch fa_wo0b
fa_top8:
  s_cmp_lg_u32 s20, 0
  s_cbranch_scc1 fa_notop
  s_mov_b32 s23, 2621440
  s_mov_b32 s31, 2625536
  buffer_load_dwordx4 v[96:99], v2, s[40:43], s23 offen offset:0 sc1
  buffer_load_dwordx4 v[100:103], v2, s[40:43], s23 offen offset:1024 sc1
  buffer_load_dwordx4 v[104:107], v2, s[40:43], s23 offen offset:2048 sc1
  buffer_load_dwordx4 v[108:111], v2, s[40:43], s23 offen offset:3072 sc1
  buffer_load_dwordx4 v[112:115], v2, s[40:43], s31 offen offset:0 sc1
  buffer_load_dwordx4 v[116:119], v2, s[40:43], s31 offen offset:1024 sc1
  buffer_load_dwordx4 v[120:123], v2, s[40:43], s31 offen offset:2048 sc1
  buffer_load_dwordx4 v[124:127], v2, s[40:43], s31 offen offset:3072 sc1
  v_mov_b32 v21, 0
  v_mov_b32 v22, 0
  v_and_b32 v23, 7, v1
  s_mov_b32 s23, 0
  s_waitcnt vmcnt(0)
fa_top:
  v_max3_u32 v20, v96, v97, v98
  v_max3_u32 v24, v99, v100, v101
  v_max3_u32 v20, v20, v102, v103
  v_max3_u32 v24, v24, v104, v105
  v_max3_u32 v20, v20, v106, v107
  v_max3_u32 v24, v24, v108, v109
  v_max3_u32 v20, v20, v110, v111
  v_max3_u32 v24, v24, v112, v113
  v_max3_u32 v20, v20, v114, v115
  v_max3_u32 v24, v24, v116, v117
  v_max3_u32 v20, v20, v118, v119
  v_max3_u32 v24, v24, v120, v121
  v_max3_u32 v20, v20, v122, v123
  v_max3_u32 v24, v24, v124, v125
  v_max3_u32 v20, v20, v126, v127
  v_max_u32 v20, v20, v24
  s_nop 1
  v_max_u32_dpp v20, v20, v20 quad_perm:[1,0,3,2] row_mask:0xf bank_mask:0xf
  s_nop 1
  v_max_u32_dpp v20, v20, v20 quad_perm:[2,3,0,1] row_mask:0xf bank_mask:0xf
  s_nop 1
  v_max_u32_dpp v20, v20, v20 row_half_mirror row_mask:0xf bank_mask:0xf
  s_nop 1
  v_max_u32_dpp v20, v20, v20 row_mirror row_mask:0xf bank_mask:0xf
  v_mov_b32 v24, v20
  s_nop 1
  v_permlane16_swap_b32 v20, v24
  v_max_u32 v20, v20, v24
  v_mov_b32 v24, v20
  s_nop 1
  v_permlane32_swap_b32 v20, v24
  v_max_u32 v20, v20, v24
  v_add_u32 v21, v21, v20
  v_cmp_eq_u32 vcc, s23, v23
  v_sub_u32 v96, v96, v20
  v_sub_u32 v97, v97, v20
  v_sub_u32 v98, v98, v20
  v_sub_u32 v99, v99, v20
  v_sub_u32 v100, v100, v20
  v_sub_u32 v101, v101, v20
  v_sub_u32 v102, v102, v20
  v_sub_u32 v103, v103, v20
  v_sub_u32 v104, v104, v20
  v_sub_u32 v105, v105, v20
  v_sub_u32 v106, v106, v20
  v_sub_u32 v107, v107, v20
  v_sub_u32 v108, v108, v20
  v_sub_u32 v109, v109, v20
  v_sub_u32 v110, v110, v20
  v_sub_u32 v111, v111, v20
  v_sub_u32 v112, v112, v20
  v_sub_u32 v113, v113, v20
  v_sub_u32 v114, v114, v20
  v_sub_u32 v115, v115, v20
  v_sub_u32 v116, v116, v20
  v_sub_u32 v117, v117, v20
  v_sub_u32 v118, v118, v20
  v_sub_u32 v119, v119, v20
  v_sub_u32 v120, v120, v20
  v_sub_u32 v121, v121, v20
  v_sub_u32 v122, v122, v20
  v_sub_u32 v123, v123, v20
  v_sub_u32 v124, v124, v20
  v_sub_u32 v125, v125, v20
  v_sub_u32 v126, v126, v20
  v_sub_u32 v127, v127, v20
  v_cndmask_b32 v22, v22, v21, vcc
  s_add_u32 s23, s23, 1
  s_cmp_lt_u32 s23, 8
  s_cbranch_scc1 fa_top
  v_and_b32 v25, 0xffff, v22
  v_sub_u32 v25, 0xffff, v25
  v_and_b32 v25, 2047, v25
  v_ashrrev_i32 v20, 31, v22
  v_not_b32 v20, v20
  v_or_b32 v20, 0x80000000, v20
  v_xor_b32 v26, v22, v20
  v_and_b32 v26, 0xffff0000, v26
  v_mul_f32 v26, 0xbfb8aa3b, v26
  v_exp_f32 v26, v26
  s_nop 0
  v_add_f32 v26, 1.0, v26
  v_rcp_f32 v26, v26
  s_nop 0
  v_cvt_pk_bf16_f32 v26, v26, v26
  v_and_b32 v26, 0xffff0000, v26
  v_lshlrev_b32 v20, 2, v1
  v_add_u32 v20, 2629632, v20
  v_mov_b32 v21, 1073741824
  v_cmp_gt_u32 vcc, 16, v1
  v_add_u32 v25, 1, v25
  v_or_b32 v26, 1, v26
  v_cndmask_b32 v20, v21, v20, vcc
  v_cmp_gt_u32 vcc, 8, v1
  s_nop 1
  v_cndmask_b32 v26, v26, v25, vcc
  buffer_store_dword v26, v20, s[40:43], 0 offen sc1
  s_branch fa_notop
fa_hk4:
  s_getpc_b64 s[38:39]
fa_hp4:
  s_add_u32 s36, s36, 4
  s_addc_u32 s37, s37, 0
  s_sub_u32 s38, s38, fa_hp4-fa_hb4
  s_subb_u32 s39, s39, 0
  s_setpc_b64 s[36:37]
fa_hk5:
  s_getpc_b64 s[38:39]
fa_hp5:
  s_add_u32 s36, s36, 4
  s_addc_u32 s37, s37, 0
  s_sub_u32 s38, s38, fa_hp5-fa_hb5
  s_subb_u32 s39, s39, 0
  s_setpc_b64 s[36:37]
fa_hk6:
  s_getpc_b64 s[38:39]
fa_hp6:
  s_add_u32 s36, s36, 4
  s_addc_u32 s37, s37, 0
  s_add_u32 s38, s38, fa_hb6-fa_hp6
  s_addc_u32 s39, s39, 0
  s_setpc_b64 s[36:37]
fa_DDF:
  v_mfma_f32_16x16x32_bf16 v[96:99], a[128:131], v[32:35], v[192:195]
  s_waitcnt vmcnt(12)
  v_exp_f32 v208, v112
  v_mfma_f32_16x16x32_bf16 v[104:107], a[128:131], v[36:39], v[196:199]
  s_barrier
  v_exp_f32 v209, v113
  v_mfma_f32_16x16x32_bf16 v[128:131], a[128:131], v[64:67], v[200:203]
  s_cmp_ge_u32 s26, s32
  ds_read_b128 a[160:163], v3 offset:16384
  v_add_f32 v224, v208, v209
  v_mfma_f32_16x16x32_bf16 v[136:139], a[128:131], v[68:71], v[204:207]
  s_cbranch_scc1 fa_hk6
fa_hb6:
  v_exp_f32 v210, v114
  v_cvt_pk_bf16_f32 v168, v208, v209
  v_mfma_f32_16x16x32_bf16 v[100:103], a[132:135], v[32:35], v[192:195]
  ds_read_b128 a[164:167], v3 offset:17408
  v_add_f32 v224, v224, v210
  v_mfma_f32_16x16x32_bf16 v[108:111], a[132:135], v[36:39], v[196:199]
  s_mov_b32 m0, s24
  v_exp_f32 v211, v115
  v_mfma_f32_16x16x32_bf16 v[132:135], a[132:135], v[64:67], v[200:203]
  buffer_load_dwordx4 v2, s[44:47], s26 offen offset:0 sc1 lds
  v_add_f32 v224, v224, v211
  v_mfma_f32_16x16x32_bf16 v[140:143], a[132:135], v[68:71], v[204:207]
  v_exp_f32 v212, v116
  v_mfma_f32_16x16x32_bf16 v[96:99], a[136:139], v[40:43], v[96:99]
  ds_read_b128 a[168:171], v3 offset:18432
  v_cvt_pk_bf16_f32 v169, v210, v211
  v_mfma_f32_16x16x32_bf16 v[104:107], a[136:139], v[44:47], v[104:107]
  v_exp_f32 v213, v117
  v_add_f32 v224, v224, v212
  v_mfma_f32_16x16x32_bf16 v[128:131], a[136:139], v[72:75], v[128:131]
  v_exp_f32 v214, v118
  v_mfma_f32_16x16x32_bf16 v[136:139], a[136:139], v[76:79], v[136:139]
  v_exp_f32 v215, v119
  v_mfma_f32_16x16x32_bf16 v[100:103], a[140:143], v[40:43], v[100:103]
  ds_read_b128 a[172:175], v3 offset:19456
  v_add_f32 v224, v224, v213
  v_mfma_f32_16x16x32_bf16 v[108:111], a[140:143], v[44:47], v[108:111]
  buffer_load_dwordx4 v2, s[44:47], s26 offen offset:1024 sc1 lds
  v_cvt_pk_bf16_f32 v170, v212, v213
  v_mfma_f32_16x16x32_bf16 v[132:135], a[140:143], v[72:75], v[132:135]
  v_exp_f32 v208, v120
  v_mfma_f32_16x16x32_bf16 v[140:143], a[140:143], v[76:79], v[140:143]
  s_waitcnt lgkmcnt(4)
  v_exp_f32 v209, v121
  v_add_f32 v224, v224, v214
  v_mfma_f32_16x16x32_bf16 v[96:99], a[144:147], v[48:51], v[96:99]
  ds_read_b128 a[176:179], v3 offset:20480
  v_add_f32 v224, v224, v215
  v_mfma_f32_16x16x32_bf16 v[104:107], a[144:147], v[52:55], v[104:107]
  v_exp_f32 v210, v122
  v_mfma_f32_16x16x32_bf16 v[128:131], a[144:147], v[80:83], v[128:131]
  v_exp_f32 v211, v123
  v_mfma_f32_16x16x32_bf16 v[136:139], a[144:147], v[84:87], v[136:139]
  buffer_load_dwordx4 v2, s[44:47], s26 offen offset:2048 sc1 lds
  v_cvt_pk_bf16_f32 v171, v214, v215
  v_mfma_f32_16x16x32_bf16 v[100:103], a[148:151], v[48:51], v[100:103]
  ds_read_b128 a[180:183], v3 offset:21504
  v_add_f32 v225, v208, v209
  v_mfma_f32_16x16x32_bf16 v[108:111], a[148:151], v[52:55], v[108:111]
  v_exp_f32 v212, v124
  v_mfma_f32_16x16x32_bf16 v[132:135], a[148:151], v[80:83], v[132:135]
  v_exp_f32 v213, v125
  v_cvt_pk_bf16_f32 v172, v208, v209
  v_mfma_f32_16x16x32_bf16 v[140:143], a[148:151], v[84:87], v[140:143]
  v_exp_f32 v214, v126
  v_mfma_f32_16x16x32_bf16 v[96:99], a[152:155], v[56:59], v[96:99]
  ds_read_b128 a[184:187], v3 offset:22528
  v_add_f32 v225, v225, v210
  v_mfma_f32_16x16x32_bf16 v[104:107], a[152:155], v[60:63], v[104:107]
  buffer_load_dwordx4 v2, s[44:47], s26 offen offset:3072 sc1 lds
  v_add_f32 v225, v225, v211
  v_mfma_f32_16x16x32_bf16 v[128:131], a[152:155], v[88:91], v[128:131]
  s_add_u32 s26, s26, 16384
  v_exp_f32 v215, v127
  v_mfma_f32_16x16x32_bf16 v[136:139], a[152:155], v[92:95], v[136:139]
  s_add_u32 s24, s24, 32768
  v_exp_f32 v216, v144
  v_mfma_f32_16x16x32_bf16 v[100:103], a[156:159], v[56:59], v[100:103]
  s_and_b32 s24, s24, 0x1ffff
  ds_read_b128 a[188:191], v3 offset:23552
  v_cvt_pk_bf16_f32 v173, v210, v211
  v_add_f32 v225, v225, v212
  v_mfma_f32_16x16x32_bf16 v[108:111], a[156:159], v[60:63], v[108:111]
  v_exp_f32 v217, v145
  v_mfma_f32_16x16x32_bf16 v[132:135], a[156:159], v[88:91], v[132:135]
  s_add_u32 m0, s34, 0
  v_exp_f32 v218, v146
  v_mfma_f32_16x16x32_bf16 v[140:143], a[156:159], v[92:95], v[140:143]
  s_waitcnt lgkmcnt(4)
  buffer_load_dwordx4 v8, s[52:55], s33 offen offset:0 lds
  v_add_f32 v225, v225, v213
  v_mfma_f32_16x16x32_bf16 a[0:3], a[160:163], v[160:163], a[0:3]
  ds_read_b128 a[128:131], v3 offset:0
  v_cvt_pk_bf16_f32 v174, v212, v213
  v_mfma_f32_16x16x32_bf16 a[4:7], a[160:163], v[164:167], a[4:7]
  v_exp_f32 v219, v147
  v_mfma_f32_16x16x32_bf16 a[64:67], a[160:163], v[176:179], a[64:67]
  v_exp_f32 v220, v148
  v_add_f32 v225, v225, v214
  v_mfma_f32_16x16x32_bf16 a[68:71], a[160:163], v[180:183], a[68:71]
  v_exp_f32 v221, v149
  v_mfma_f32_16x16x32_bf16 a[8:11], a[164:167], v[160:163], a[8:11]
  ds_read_b128 a[132:135], v3 offset:1024
  v_add_f32 v225, v225, v215
  v_mfma_f32_16x16x32_bf16 a[12:15], a[164:167], v[164:167], a[12:15]
  buffer_load_dwordx4 v11, s[52:55], s33 offen offset:1024 lds
  v_cvt_pk_bf16_f32 v175, v214, v215
  v_mfma_f32_16x16x32_bf16 a[72:75], a[164:167], v[176:179], a[72:75]
  v_exp_f32 v222, v150
  v_mfma_f32_16x16x32_bf16 a[76:79], a[164:167], v[180:183], a[76:79]
  v_exp_f32 v223, v151
  v_mfma_f32_16x16x32_bf16 a[16:19], a[168:171], v[160:163], a[16:19]
  ds_read_b128 a[136:139], v3 offset:2048
  v_add_f32 v226, v216, v217
  v_cvt_pk_bf16_f32 v184, v216, v217
  v_mfma_f32_16x16x32_bf16 a[20:23], a[168:171], v[164:167], a[20:23]
  v_exp_f32 v216, v152
  v_mfma_f32_16x16x32_bf16 a[80:83], a[168:171], v[176:179], a[80:83]
  v_add_f32 v226, v226, v218
  v_add_f32 v226, v226, v219
  v_mfma_f32_16x16x32_bf16 a[84:87], a[168:171], v[180:183], a[84:87]
  buffer_load_dwordx4 v12, s[52:55], s33 offen offset:2048 lds
  v_cvt_pk_bf16_f32 v185, v218, v219
  v_mfma_f32_16x16x32_bf16 a[24:27], a[172:175], v[160:163], a[24:27]
  ds_read_b128 a[140:143], v3 offset:3072
  v_add_f32 v226, v226, v220
  v_mfma_f32_16x16x32_bf16 a[28:31], a[172:175], v[164:167], a[28:31]
  v_exp_f32 v217, v153
  v_mfma_f32_16x16x32_bf16 a[88:91], a[172:175], v[176:179], a[88:91]
  v_exp_f32 v218, v154
  v_mfma_f32_16x16x32_bf16 a[92:95], a[172:175], v[180:183], a[92:95]
  s_waitcnt lgkmcnt(4)
  v_exp_f32 v219, v155
  v_add_f32 v226, v226, v221
  v_mfma_f32_16x16x32_bf16 a[32:35], a[176:179], v[160:163], a[32:35]
  ds_read_b128 a[144:147], v3 offset:4096
  v_cvt_pk_bf16_f32 v186, v220, v221
  v_mfma_f32_16x16x32_bf16 a[36:39], a[176:179], v[164:167], a[36:39]
  buffer_load_dwordx4 v13, s[52:55], s33 offen offset:3072 lds
  v_add_f32 v226, v226, v222
  v_mfma_f32_16x16x32_bf16 a[96:99], a[176:179], v[176:179], a[96:99]
  v_exp_f32 v220, v156
  v_mfma_f32_16x16x32_bf16 a[100:103], a[176:179], v[180:183], a[100:103]
  v_exp_f32 v221, v157
  v_mfma_f32_16x16x32_bf16 a[40:43], a[180:183], v[160:163], a[40:43]
  ds_read_b128 a[148:151], v3 offset:5120
  v_add_f32 v226, v226, v223
  v_mfma_f32_16x16x32_bf16 a[44:47], a[180:183], v[164:167], a[44:47]
  v_cvt_pk_bf16_f32 v187, v222, v223
  v_add_f32 v227, v216, v217
  v_cvt_pk_bf16_f32 v188, v216, v217
  v_mfma_f32_16x16x32_bf16 a[104:107], a[180:183], v[176:179], a[104:107]
  s_add_u32 m0, s34, 4096
  v_exp_f32 v222, v158
  v_mfma_f32_16x16x32_bf16 a[108:111], a[180:183], v[180:183], a[108:111]
  buffer_load_dwordx4 v14, s[52:55], s33 offen offset:0 lds
  v_add_f32 v227, v227, v218
  v_mfma_f32_16x16x32_bf16 a[48:51], a[184:187], v[160:163], a[48:51]
  ds_read_b128 a[152:155], v3 offset:6144
  v_add_f32 v227, v227, v219
  v_mfma_f32_16x16x32_bf16 a[52:55], a[184:187], v[164:167], a[52:55]
  v_exp_f32 v223, v159
  v_mfma_f32_16x16x32_bf16 a[112:115], a[184:187], v[176:179], a[112:115]
  v_cvt_pk_bf16_f32 v189, v218, v219
  v_max3_f32 v5, v224, v225, v226
  v_mfma_f32_16x16x32_bf16 a[116:119], a[184:187], v[180:183], a[116:119]
  v_add_f32 v227, v227, v220
  v_add_f32 v227, v227, v221
  v_cvt_pk_bf16_f32 v190, v220, v221
  v_mfma_f32_16x16x32_bf16 a[56:59], a[188:191], v[160:163], a[56:59]
  ds_read_b128 a[156:159], v3 offset:7168
  v_add_f32 v227, v227, v222
  v_mfma_f32_16x16x32_bf16 a[60:63], a[188:191], v[164:167], a[60:63]
  v_add_f32 v227, v227, v223
  v_cvt_pk_bf16_f32 v191, v222, v223
  v_mfma_f32_16x16x32_bf16 a[120:123], a[188:191], v[176:179], a[120:123]
  s_waitcnt lgkmcnt(4)
  v_max_f32 v5, v5, v227
  v_cmp_lt_f32 vcc, s81, v5
  v_mfma_f32_16x16x32_bf16 a[124:127], a[188:191], v[180:183], a[124:127]
  s_cbranch_vccnz fa_stub3
fa_back3:
  v_add_f32 v228, v228, v224
  v_add_f32 v229, v229, v225
  v_add_f32 v230, v230, v226
  v_add_f32 v231, v231, v227
  s_branch fa_DDe
fa_sel_spin:
  s_mov_b32 s83, 200000
fa_sel_spin2:
  buffer_load_dword v15, v252, s[40:43], 0 offen sc1
  s_waitcnt vmcnt(0)
  v_cmp_eq_u32 vcc, 0, v15
  s_cbranch_vccz fa_sel_ok
  s_sleep 8
  s_sub_u32 s83, s83, 1
  s_cmp_lg_u32 s83, 0
  s_cbranch_scc1 fa_sel_spin2
  s_branch fa_sel_ok
fa_wof_spin:
  s_mov_b32 s83, 200000
fa_wof_spin2:
  buffer_load_dword v8, v9, s[40:43], 0 offen sc1
  s_waitcnt vmcnt(0)
  v_cmp_eq_u32 vcc, 0, v8
  s_cbranch_vccz fa_wof_ok
  s_sleep 8
  s_sub_u32 s83, s83, 1
  s_cmp_lg_u32 s83, 0
  s_cbranch_scc1 fa_wof_spin2
  s_branch fa_wof_ok
fa_sel4_spin:
  s_mov_b32 s83, 200000
fa_sel4_spin2:
  buffer_load_dword v15, v10, s[40:43], 0 offen sc1
  s_waitcnt vmcnt(0)
  v_cmp_eq_u32 vcc, 0, v15
  s_cbranch_vccz fa_sel4_ok
  s_sleep 8
  s_sub_u32 s83, s83, 1
  s_cmp_lg_u32 s83, 0
  s_cbranch_scc1 fa_sel4_spin2
  s_branch fa_sel4_ok
fa_yf_spin:
  s_mov_b32 s83, 200000
fa_yf_spin2:
  buffer_load_dword v14, v11, s[40:43], 0 offen sc1
  s_waitcnt vmcnt(0)
  v_cmp_eq_u32 vcc, 0, v14
  s_cbranch_vccz fa_yf_ok
  s_sleep 8
  s_sub_u32 s83, s83, 1
  s_cmp_lg_u32 s83, 0
  s_cbranch_scc1 fa_yf_spin2
  s_branch fa_yf_ok
fa_co:
  s_sub_u32 s14, s2, 170
  s_cmp_lt_u32 s14, 54
  s_cbranch_scc1 fa_coF
  s_sub_u32 s14, s2, 64
  s_cmp_lt_u32 s14, 96
  s_cbranch_scc1 fa_coT
  s_sub_u32 s14, s2, 128
  s_cmp_ge_u32 s2, 224
  s_cbranch_scc0 fa_coO
fa_coT:
  v_min_u32 v8, 16, v1
  v_lshlrev_b32 v8, 7, v8
  s_lshl_b32 s10, s14, 1
  s_and_b32 s31, s20, 1
  s_add_u32 s10, s10, s31
  s_mul_i32 s10, s10, 2176
  s_lshl_b32 s35, s14, 2
  s_add_u32 s35, s35, s20
  s_mul_i32 s35, s35, 4352
  buffer_load_dword v255, v8, s[52:55], s10 offen
  s_add_u32 s10, s10, 552960
  s_getpc_b64 s[36:37]
  s_setpc_b64 s[38:39]
  buffer_load_dword v255, v8, s[52:55], s10 offen
  s_add_u32 s10, s10, 552960
  s_getpc_b64 s[36:37]
  s_setpc_b64 s[38:39]
  buffer_load_dword v255, v8, s[52:55], s10 offen
  s_add_u32 s10, s10, 552960
  buffer_load_dword v255, v8, s[60:63], s35 offen offset:0
  s_getpc_b64 s[36:37]
  s_setpc_b64 s[38:39]
  buffer_load_dword v255, v8, s[52:55], s10 offen
  s_add_u32 s10, s10, 552960
  buffer_load_dword v255, v8, s[60:63], s35 offen offset:2176
  s_mov_b32 s9, -1
  s_and_b32 s32, s21, 3
  s_add_u32 s32, s32, 7
  s_lshl_b32 s32, s32, 14
  s_getpc_b64 s[36:37]
  s_setpc_b64 s[38:39]
fa_coO:
  s_add_u32 m0, s34, 0
  v_accvgpr_read_b32 v19, a248
  buffer_load_dwordx4 v19, s[56:59], s33 offen lds
  s_add_u32 m0, s34, 1024
  v_accvgpr_read_b32 v19, a249
  buffer_load_dwordx4 v19, s[56:59], s33 offen lds
  s_add_u32 m0, s34, 2048
  v_accvgpr_read_b32 v19, a250
  buffer_load_dwordx4 v19, s[56:59], s33 offen lds
  s_add_u32 m0, s34, 3072
  v_accvgpr_read_b32 v19, a251
  buffer_load_dwordx4 v19, s[56:59], s33 offen lds
  s_add_u32 m0, s34, 4096
  v_accvgpr_read_b32 v19, a252
  buffer_load_dwordx4 v19, s[56:59], s33 offen lds
  s_add_u32 s32, s26, 32768
  s_mov_b32 s9, -1
  s_getpc_b64 s[36:37]
  s_setpc_b64 s[38:39]
  s_waitcnt vmcnt(8)
  ds_read_b64_tr_b16 v[232:233], v6 offset:0
  ds_read_b64_tr_b16 v[234:235], v6 offset:2560
  ds_read_b64_tr_b16 v[236:237], v6 offset:32
  ds_read_b64_tr_b16 v[238:239], v6 offset:2592
  ds_read_b64_tr_b16 v[240:241], v6 offset:64
  ds_read_b64_tr_b16 v[242:243], v6 offset:2624
  ds_read_b64_tr_b16 v[244:245], v6 offset:96
  ds_read_b64_tr_b16 v[246:247], v6 offset:2656
  ds_read_b64_tr_b16 v[248:249], v6 offset:128
  ds_read_b64_tr_b16 v[250:251], v6 offset:2688
  s_waitcnt lgkmcnt(0)
  s_add_u32 s31, s30, 4096
  buffer_store_dwordx4 v[232:235], v2, s[40:43], s30 offen offset:0 sc1
  buffer_store_dwordx4 v[236:239], v2, s[40:43], s30 offen offset:1024 sc1
  buffer_store_dwordx4 v[240:243], v2, s[40:43], s30 offen offset:2048 sc1
  buffer_store_dwordx4 v[244:247], v2, s[40:43], s30 offen offset:3072 sc1
  buffer_store_dwordx4 v[248:251], v2, s[40:43], s31 offen offset:0 sc1
  s_getpc_b64 s[36:37]
  s_setpc_b64 s[38:39]
  s_and_b32 s23, s2, 1
  s_lshl_b32 s23, s23, 2
  s_add_u32 s23, s23, s20
  s_lshl_b32 s23, s23, 7
  s_lshr_b32 s31, s2, 1
  s_add_u32 s23, s23, s31
  s_lshl_b32 s23, s23, 2
  s_add_u32 s23, s23, 2654208
  v_mov_b32 v16, 1073741824
  v_mov_b32 v17, 1
  v_writelane_b32 v16, s23, 0
  s_waitcnt vmcnt(8)
  buffer_store_dword v17, v16, s[40:43], 0 offen sc1
  s_branch fa_coW
fa_coF:
  s_waitcnt vmcnt(8)
  ds_read_b64_tr_b16 v[232:233], v6 offset:0
  ds_read_b64_tr_b16 v[234:235], v6 offset:2560
  ds_read_b64_tr_b16 v[236:237], v6 offset:32
  ds_read_b64_tr_b16 v[238:239], v6 offset:2592
  ds_read_b64_tr_b16 v[240:241], v6 offset:64
  ds_read_b64_tr_b16 v[242:243], v6 offset:2624
  ds_read_b64_tr_b16 v[244:245], v6 offset:96
  ds_read_b64_tr_b16 v[246:247], v6 offset:2656
  ds_read_b64_tr_b16 v[248:249], v6 offset:128
  ds_read_b64_tr_b16 v[250:251], v6 offset:2688
  s_getpc_b64 s[36:37]
  s_setpc_b64 s[38:39]
  s_add_u32 s31, s30, 4096
  buffer_store_dwordx4 v[232:235], v2, s[40:43], s30 offen offset:0 sc1
  buffer_store_dwordx4 v[236:239], v2, s[40:43], s30 offen offset:1024 sc1
  buffer_store_dwordx4 v[240:243], v2, s[40:43], s30 offen offset:2048 sc1
  buffer_store_dwordx4 v[244:247], v2, s[40:43], s30 offen offset:3072 sc1
  buffer_store_dwordx4 v[248:251], v2, s[40:43], s31 offen offset:0 sc1
  s_lshl_b32 s33, s14, 6
  s_and_b32 s31, s20, 1
  s_lshl_b32 s31, s31, 5
  s_add_u32 s33, s33, s31
  s_mul_i32 s35, s14, 40960
  s_mul_i32 s31, s20, 320
  s_add_u32 s35, s35, s31
  s_mul_i32 s10, s14, 20480
  s_mul_i32 s31, s20, 640
  s_add_u32 s10, s10, s31
  s_add_u32 s10, s10, 2686976
  s_mov_b32 s9, -1
  s_getpc_b64 s[36:37]
  s_setpc_b64 s[38:39]
  v_and_b32 v16, 7, v1
  v_lshlrev_b32 v252, 2, v16
  v_add_u32 v252, 2629632, v252
  buffer_load_dword v15, v252, s[40:43], 0 offen sc1
  v_lshrrev_b32 v17, 1, v1
  v_mul_u32_u24 v8, 3456, v17
  v_and_b32 v17, 1, v1
  v_lshl_add_u32 v8, v17, 4, v8
  v_add_u32 v11, 109568, v8
  v_add_u32 v12, 219136, v8
  v_add_u32 v13, 328704, v8
  v_add_u32 v14, 442368, v8
  v_lshrrev_b32 v17, 4, v1
  v_lshrrev_b32 v18, 2, v1
  v_lshl_add_u32 v18, v17, 2, v18
  v_lshlrev_b32 v18, 5, v18
  v_and_b32 v19, 3, v1
  v_lshl_add_u32 v9, v19, 3, v18
  v_add_u32 v9, s34, v9
  v_lshlrev_b32 v10, 4, v16
  v_lshl_add_u32 v10, v17, 7, v10
  v_add_u32 v10, 151552, v10
  s_mov_b32 s8, 1
  v_mov_b32 v232, 0
  v_mov_b32 v233, 0
  v_mov_b32 v234, 0
  v_mov_b32 v235, 0
  s_getpc_b64 s[36:37]
  s_setpc_b64 s[38:39]
  s_and_b32 s23, s2, 1
  s_lshl_b32 s23, s23, 2
  s_add_u32 s23, s23, s20
  s_lshl_b32 s23, s23, 7
  s_lshr_b32 s31, s2, 1
  s_add_u32 s23, s23, s31
  s_lshl_b32 s23, s23, 2
  s_add_u32 s23, s23, 2654208
  v_mov_b32 v16, 1073741824
  v_mov_b32 v17, 1
  v_writelane_b32 v16, s23, 0
  s_waitcnt vmcnt(8)
  buffer_store_dword v17, v16, s[40:43], 0 offen sc1
  v_cmp_eq_u32 vcc, 0, v15
  s_cbranch_vccnz fa_sel_spin
fa_sel_ok:
  v_add_u32 v18, -1, v15
  v_and_b32 v18, 2047, v18
  v_lshrrev_b32 v19, 4, v18
  v_mul_u32_u24 v19, 20480, v19
  v_and_b32 v18, 15, v18
  v_lshl_add_u32 v19, v18, 4, v19
  v_lshrrev_b32 v18, 3, v1
  v_lshl_add_u32 v19, v18, 8, v19
  s_lshl_b32 s23, s20, 11
  s_lshl_b32 s31, s20, 10
  s_add_u32 s31, s31, 151552
  s_mov_b32 s14, 4
  s_mov_b32 m0, s31
  s_add_u32 s31, s31, 4096
  buffer_load_dwordx4 v19, s[40:43], s23 offen sc1 lds
  s_add_u32 s23, s23, 8192
  s_mov_b32 m0, s31
  s_add_u32 s31, s31, 4096
  buffer_load_dwordx4 v19, s[40:43], s23 offen sc1 lds
  s_add_u32 s23, s23, 8192
  s_mov_b32 m0, s31
  s_add_u32 s31, s31, 4096
  buffer_load_dwordx4 v19, s[40:43], s23 offen sc1 lds
  s_add_u32 s23, s23, 8192
fa_coG:
  s_getpc_b64 s[36:37]
  s_setpc_b64 s[38:39]
  s_waitcnt vmcnt(4)
  ds_read_b64_tr_b16 a[192:193], v9 offset:0
  ds_read_b64_tr_b16 a[194:195], v9 offset:128
  ds_read_b128 a[212:215], v10 offset:0
  ds_read_b64_tr_b16 a[196:197], v9 offset:1024
  ds_read_b64_tr_b16 a[198:199], v9 offset:1152
  ds_read_b128 a[216:219], v10 offset:512
  ds_read_b64_tr_b16 a[200:201], v9 offset:2048
  ds_read_b64_tr_b16 a[202:203], v9 offset:2176
  ds_read_b128 a[220:223], v10 offset:1024
  ds_read_b64_tr_b16 a[204:205], v9 offset:3072
  ds_read_b64_tr_b16 a[206:207], v9 offset:3200
  ds_read_b128 a[224:227], v10 offset:1536
  ds_read_b64_tr_b16 a[208:209], v9 offset:4096
  ds_read_b64_tr_b16 a[210:211], v9 offset:4224
  ds_read_b128 a[228:231], v10 offset:2048
  v_add_u32 v10, 2560, v10
  s_add_u32 s33, s33, 552960
  s_sub_u32 s14, s14, 1
  s_waitcnt lgkmcnt(12)
  v_mfma_f32_16x16x32_bf16 v[232:235], a[192:195], a[212:215], v[232:235]
  s_waitcnt lgkmcnt(9)
  v_mfma_f32_16x16x32_bf16 v[232:235], a[196:199], a[216:219], v[232:235]
  s_waitcnt lgkmcnt(6)
  v_mfma_f32_16x16x32_bf16 v[232:235], a[200:203], a[220:223], v[232:235]
  s_waitcnt lgkmcnt(3)
  v_mfma_f32_16x16x32_bf16 v[232:235], a[204:207], a[224:227], v[232:235]
  s_waitcnt lgkmcnt(0)
  v_mfma_f32_16x16x32_bf16 v[232:235], a[208:211], a[228:231], v[232:235]
  s_cmp_lg_u32 s14, 0
  s_cbranch_scc1 fa_coG
  v_accvgpr_read_b32 v8, a248
  v_accvgpr_read_b32 v11, a249
  v_accvgpr_read_b32 v12, a250
  v_accvgpr_read_b32 v13, a251
  v_accvgpr_read_b32 v14, a252
  v_subrev_u32 v11, 1024, v11
  v_subrev_u32 v12, 2048, v12
  v_subrev_u32 v13, 3072, v13
  s_mov_b32 s52, s60
  s_mov_b32 s53, s61
  s_mov_b32 s33, s35
  s_lshl_b32 s23, s20, 9
  v_add_u32 v16, s23, v10
  ds_write_b128 v16, v[232:235]
  v_and_b32 v17, 7, v1
  v_mul_u32_u24 v9, 2560, v17
  v_lshrrev_b32 v17, 4, v1
  v_lshl_add_u32 v9, v17, 4, v9
  v_and_b32 v17, 8, v1
  v_lshl_add_u32 v9, v17, 27, v9
  s_getpc_b64 s[36:37]
  s_setpc_b64 s[38:39]
  ds_read_b128 v[236:239], v10 offset:0
  ds_read_b128 v[240:243], v10 offset:512
  ds_read_b128 v[244:247], v10 offset:1024
  ds_read_b128 v[248:251], v10 offset:1536
  s_waitcnt vmcnt(4)
  ds_read_b64_tr_b16 a[192:193], v6 offset:0
  ds_read_b64_tr_b16 a[194:195], v6 offset:2560
  ds_read_b64_tr_b16 a[196:197], v6 offset:32
  ds_read_b64_tr_b16 a[198:199], v6 offset:2592
  ds_read_b64_tr_b16 a[200:201], v6 offset:64
  ds_read_b64_tr_b16 a[202:203], v6 offset:2624
  ds_read_b64_tr_b16 a[204:205], v6 offset:96
  ds_read_b64_tr_b16 a[206:207], v6 offset:2656
  ds_read_b64_tr_b16 a[208:209], v6 offset:128
  ds_read_b64_tr_b16 a[210:211], v6 offset:2688
  s_add_u32 s33, s33, 160
  s_mov_b32 s8, 0
  s_waitcnt lgkmcnt(10)
  v_cvt_pk_bf16_f32 v236, v236, v244
  v_cvt_pk_bf16_f32 v237, v237, v245
  v_cvt_pk_bf16_f32 v238, v238, v246
  v_cvt_pk_bf16_f32 v239, v239, v247
  v_cvt_pk_bf16_f32 v240, v240, v248
  v_cvt_pk_bf16_f32 v241, v241, v249
  v_cvt_pk_bf16_f32 v242, v242, v250
  v_cvt_pk_bf16_f32 v243, v243, v251
  v_lshlrev_b32 v244, 16, v236
  v_lshlrev_b32 v245, 16, v237
  v_lshlrev_b32 v246, 16, v238
  v_lshlrev_b32 v247, 16, v239
  v_lshlrev_b32 v248, 16, v240
  v_lshlrev_b32 v249, 16, v241
  v_lshlrev_b32 v250, 16, v242
  v_lshlrev_b32 v251, 16, v243
  v_mul_f32 v16, 0xbfb8aa3b, v244
  v_mul_f32 v17, 0xbfb8aa3b, v245
  v_mul_f32 v18, 0xbfb8aa3b, v246
  v_mul_f32 v19, 0xbfb8aa3b, v247
  v_mul_f32 v20, 0xbfb8aa3b, v248
  v_mul_f32 v21, 0xbfb8aa3b, v249
  v_mul_f32 v22, 0xbfb8aa3b, v250
  v_mul_f32 v23, 0xbfb8aa3b, v251
  v_exp_f32 v16, v16
  v_exp_f32 v17, v17
  v_exp_f32 v18, v18
  v_exp_f32 v19, v19
  v_exp_f32 v20, v20
  v_exp_f32 v21, v21
  v_exp_f32 v22, v22
  v_exp_f32 v23, v23
  v_add_f32 v16, 1.0, v16
  v_add_f32 v17, 1.0, v17
  v_add_f32 v18, 1.0, v18
  v_add_f32 v19, 1.0, v19
  v_add_f32 v20, 1.0, v20
  v_add_f32 v21, 1.0, v21
  v_add_f32 v22, 1.0, v22
  v_add_f32 v23, 1.0, v23
  v_rcp_f32 v16, v16
  v_rcp_f32 v17, v17
  v_rcp_f32 v18, v18
  v_rcp_f32 v19, v19
  v_rcp_f32 v20, v20
  v_rcp_f32 v21, v21
  v_rcp_f32 v22, v22
  v_rcp_f32 v23, v23
  v_mul_f32 v244, v244, v16
  v_mul_f32 v245, v245, v17
  v_mul_f32 v246, v246, v18
  v_mul_f32 v247, v247, v19
  v_mul_f32 v248, v248, v20
  v_mul_f32 v249, v249, v21
  v_mul_f32 v250, v250, v22
  v_mul_f32 v251, v251, v23
  v_cvt_pk_bf16_f32 v16, v244, v245
  v_cvt_pk_bf16_f32 v17, v246, v247
  v_cvt_pk_bf16_f32 v18, v248, v249
  v_cvt_pk_bf16_f32 v19, v250, v251
  v_and_b32 v236, 0xffff0000, v236
  v_and_b32 v237, 0xffff0000, v237
  v_and_b32 v238, 0xffff0000, v238
  v_and_b32 v239, 0xffff0000, v239
  v_and_b32 v240, 0xffff0000, v240
  v_and_b32 v241, 0xffff0000, v241
  v_and_b32 v242, 0xffff0000, v242
  v_and_b32 v243, 0xffff0000, v243
  v_lshlrev_b32 v244, 16, v16
  v_and_b32 v245, 0xffff0000, v16
  v_lshlrev_b32 v246, 16, v17
  v_and_b32 v247, 0xffff0000, v17
  v_lshlrev_b32 v248, 16, v18
  v_and_b32 v249, 0xffff0000, v18
  v_lshlrev_b32 v250, 16, v19
  v_and_b32 v251, 0xffff0000, v19
  v_mul_f32 v236, v236, v244
  v_mul_f32 v237, v237, v245
  v_mul_f32 v238, v238, v246
  v_mul_f32 v239, v239, v247
  v_mul_f32 v240, v240, v248
  v_mul_f32 v241, v241, v249
  v_mul_f32 v242, v242, v250
  v_mul_f32 v243, v243, v251
  v_cvt_pk_bf16_f32 v232, v236, v237
  v_cvt_pk_bf16_f32 v233, v238, v239
  v_cvt_pk_bf16_f32 v234, v240, v241
  v_cvt_pk_bf16_f32 v235, v242, v243
  s_nop 0
  s_waitcnt lgkmcnt(0)
  v_mfma_f32_16x16x32_bf16 v[236:239], a[192:195], v[232:235], 0
  v_mfma_f32_16x16x32_bf16 v[240:243], a[196:199], v[232:235], 0
  v_mfma_f32_16x16x32_bf16 v[244:247], a[200:203], v[232:235], 0
  v_mfma_f32_16x16x32_bf16 v[248:251], a[204:207], v[232:235], 0
  v_mfma_f32_16x16x32_bf16 v[252:255], a[208:211], v[232:235], 0
  s_nop 3
  buffer_store_dwordx4 v[236:239], v9, s[40:43], s10 offen offset:0 sc1
  buffer_store_dwordx4 v[240:243], v9, s[40:43], s10 offen offset:64 sc1
  buffer_store_dwordx4 v[244:247], v9, s[40:43], s10 offen offset:128 sc1
  buffer_store_dwordx4 v[248:251], v9, s[40:43], s10 offen offset:192 sc1
  buffer_store_dwordx4 v[252:255], v9, s[40:43], s10 offen offset:256 sc1
  s_add_u32 s10, s10, 320
  s_getpc_b64 s[36:37]
  s_setpc_b64 s[38:39]
  s_waitcnt vmcnt(4)
  ds_read_b64_tr_b16 a[192:193], v6 offset:0
  ds_read_b64_tr_b16 a[194:195], v6 offset:2560
  ds_read_b64_tr_b16 a[196:197], v6 offset:32
  ds_read_b64_tr_b16 a[198:199], v6 offset:2592
  ds_read_b64_tr_b16 a[200:201], v6 offset:64
  ds_read_b64_tr_b16 a[202:203], v6 offset:2624
  ds_read_b64_tr_b16 a[204:205], v6 offset:96
  ds_read_b64_tr_b16 a[206:207], v6 offset:2656
  ds_read_b64_tr_b16 a[208:209], v6 offset:128
  ds_read_b64_tr_b16 a[210:211], v6 offset:2688
  s_waitcnt lgkmcnt(0)
  v_mfma_f32_16x16x32_bf16 v[236:239], a[192:195], v[232:235], 0
  v_mfma_f32_16x16x32_bf16 v[240:243], a[196:199], v[232:235], 0
  v_mfma_f32_16x16x32_bf16 v[244:247], a[200:203], v[232:235], 0
  v_mfma_f32_16x16x32_bf16 v[248:251], a[204:207], v[232:235], 0
  v_mfma_f32_16x16x32_bf16 v[252:255], a[208:211], v[232:235], 0
  s_nop 3
  buffer_store_dwordx4 v[236:239], v9, s[40:43], s10 offen offset:0 sc1
  buffer_store_dwordx4 v[240:243], v9, s[40:43], s10 offen offset:64 sc1
  buffer_store_dwordx4 v[244:247], v9, s[40:43], s10 offen offset:128 sc1
  buffer_store_dwordx4 v[248:251], v9, s[40:43], s10 offen offset:192 sc1
  buffer_store_dwordx4 v[252:255], v9, s[40:43], s10 offen offset:256 sc1
  s_add_u32 s10, s10, 320
  s_getpc_b64 s[36:37]
  s_setpc_b64 s[38:39]
  s_sub_u32 s23, s2, 170
  s_lshl_b32 s31, s20, 6
  s_add_u32 s23, s23, s31
  s_lshl_b32 s23, s23, 2
  s_add_u32 s23, s23, 2650112
  v_mov_b32 v16, 1073741824
  v_mov_b32 v17, 1
  v_writelane_b32 v16, s23, 0
  s_waitcnt vmcnt(8)
  buffer_store_dword v17, v16, s[40:43], 0 offen sc1
fa_coW:
  s_mov_b32 s12, 1
  s_mov_b32 s9, -1
  s_cmp_lg_u32 s11, 0
  s_cselect_b32 s32, s15, -1
  s_getpc_b64 s[36:37]
  s_setpc_b64 s[38:39]
  s_lshl_b32 s23, s22, 2
  s_add_u32 s23, s23, s20
  s_mul_i32 s13, s23, 163840
  s_add_u32 s13, s13, 4194304
  s_lshl_b32 s23, s23, 7
  s_add_u32 s23, s23, 2654208
  v_and_b32 v9, 31, v1
  v_lshl_add_u32 v9, v9, 2, s23
  v_and_b32 v10, 15, v1
  v_lshlrev_b32 v10, 2, v10
  v_add_u32 v10, 2629632, v10
  buffer_load_dword v8, v9, s[40:43], 0 offen sc1
  buffer_load_dword v15, v10, s[40:43], 0 offen sc1
  v_mov_b32 v20, v228
  v_mov_b32 v21, v229
  s_nop 1
  v_permlane16_swap_b32 v228, v20
  v_permlane16_swap_b32 v229, v21
  v_add_f32 v228, v228, v20
  v_add_f32 v229, v229, v21
  v_mov_b32 v20, v228
  v_mov_b32 v21, v229
  s_nop 1
  v_permlane32_swap_b32 v228, v20
  v_permlane32_swap_b32 v229, v21
  v_add_f32 v228, v228, v20
  v_add_f32 v229, v229, v21
  v_rcp_f32 v16, v228
  v_rcp_f32 v18, v229
  s_lshl_b32 s23, s22, 2
  v_mov_b32 v17, v16
  v_mov_b32 v19, v18
  s_add_u32 s23, s23, s20
  s_lshl_b32 s23, s23, 18
  s_lshl_b32 s31, s21, 12
  s_add_u32 s31, s31, 50331648
  s_add_u32 s64, s23, s31
  s_add_u32 s65, s64, 131072
  v_accvgpr_read_b32 v36, a0
  v_accvgpr_read_b32 v37, a1
  v_accvgpr_read_b32 v38, a2
  v_accvgpr_read_b32 v39, a3
  v_accvgpr_read_b32 v40, a8
  v_accvgpr_read_b32 v41, a9
  v_accvgpr_read_b32 v42, a10
  v_accvgpr_read_b32 v43, a11
  v_pk_mul_f32 v[36:37], v[36:37], v[16:17]
  v_pk_mul_f32 v[38:39], v[38:39], v[16:17]
  v_pk_mul_f32 v[40:41], v[40:41], v[16:17]
  v_pk_mul_f32 v[42:43], v[42:43], v[16:17]
  v_cvt_pk_bf16_f32 v32, v36, v37
  v_cvt_pk_bf16_f32 v33, v38, v39
  v_cvt_pk_bf16_f32 v34, v40, v41
  v_cvt_pk_bf16_f32 v35, v42, v43
  buffer_store_dwordx4 v[32:35], v2, s[40:43], s64 offen offset:0 sc1
  v_accvgpr_read_b32 v48, a16
  v_accvgpr_read_b32 v49, a17
  v_accvgpr_read_b32 v50, a18
  v_accvgpr_read_b32 v51, a19
  v_accvgpr_read_b32 v52, a24
  v_accvgpr_read_b32 v53, a25
  v_accvgpr_read_b32 v54, a26
  v_accvgpr_read_b32 v55, a27
  v_pk_mul_f32 v[48:49], v[48:49], v[16:17]
  v_pk_mul_f32 v[50:51], v[50:51], v[16:17]
  v_pk_mul_f32 v[52:53], v[52:53], v[16:17]
  v_pk_mul_f32 v[54:55], v[54:55], v[16:17]
  v_cvt_pk_bf16_f32 v44, v48, v49
  v_cvt_pk_bf16_f32 v45, v50, v51
  v_cvt_pk_bf16_f32 v46, v52, v53
  v_cvt_pk_bf16_f32 v47, v54, v55
  buffer_store_dwordx4 v[44:47], v2, s[40:43], s64 offen offset:1024 sc1
  v_accvgpr_read_b32 v100, a32
  v_accvgpr_read_b32 v101, a33
  v_accvgpr_read_b32 v102, a34
  v_accvgpr_read_b32 v103, a35
  v_accvgpr_read_b32 v104, a40
  v_accvgpr_read_b32 v105, a41
  v_accvgpr_read_b32 v106, a42
  v_accvgpr_read_b32 v107, a43
  v_pk_mul_f32 v[100:101], v[100:101], v[16:17]
  v_pk_mul_f32 v[102:103], v[102:103], v[16:17]
  v_pk_mul_f32 v[104:105], v[104:105], v[16:17]
  v_pk_mul_f32 v[106:107], v[106:107], v[16:17]
  v_cvt_pk_bf16_f32 v96, v100, v101
  v_cvt_pk_bf16_f32 v97, v102, v103
  v_cvt_pk_bf16_f32 v98, v104, v105
  v_cvt_pk_bf16_f32 v99, v106, v107
  buffer_store_dwordx4 v[96:99], v2, s[40:43], s64 offen offset:2048 sc1
  v_accvgpr_read_b32 v112, a48
  v_accvgpr_read_b32 v113, a49
  v_accvgpr_read_b32 v114, a50
  v_accvgpr_read_b32 v115, a51
  v_accvgpr_read_b32 v116, a56
  v_accvgpr_read_b32 v117, a57
  v_accvgpr_read_b32 v118, a58
  v_accvgpr_read_b32 v119, a59
  v_pk_mul_f32 v[112:113], v[112:113], v[16:17]
  v_pk_mul_f32 v[114:115], v[114:115], v[16:17]
  v_pk_mul_f32 v[116:117], v[116:117], v[16:17]
  v_pk_mul_f32 v[118:119], v[118:119], v[16:17]
  v_cvt_pk_bf16_f32 v108, v112, v113
  v_cvt_pk_bf16_f32 v109, v114, v115
  v_cvt_pk_bf16_f32 v110, v116, v117
  v_cvt_pk_bf16_f32 v111, v118, v119
  buffer_store_dwordx4 v[108:111], v2, s[40:43], s64 offen offset:3072 sc1
  v_accvgpr_read_b32 v36, a4
  v_accvgpr_read_b32 v37, a5
  v_accvgpr_read_b32 v38, a6
  v_accvgpr_read_b32 v39, a7
  v_accvgpr_read_b32 v40, a12
  v_accvgpr_read_b32 v41, a13
  v_accvgpr_read_b32 v42, a14
  v_accvgpr_read_b32 v43, a15
  v_pk_mul_f32 v[36:37], v[36:37], v[18:19]
  v_pk_mul_f32 v[38:39], v[38:39], v[18:19]
  v_pk_mul_f32 v[40:41], v[40:41], v[18:19]
  v_pk_mul_f32 v[42:43], v[42:43], v[18:19]
  v_cvt_pk_bf16_f32 v32, v36, v37
  v_cvt_pk_bf16_f32 v33, v38, v39
  v_cvt_pk_bf16_f32 v34, v40, v41
  v_cvt_pk_bf16_f32 v35, v42, v43
  buffer_store_dwordx4 v[32:35], v2, s[40:43], s65 offen offset:0 sc1
  v_accvgpr_read_b32 v48, a20
  v_accvgpr_read_b32 v49, a21
  v_accvgpr_read_b32 v50, a22
  v_accvgpr_read_b32 v51, a23
  v_accvgpr_read_b32 v52, a28
  v_accvgpr_read_b32 v53, a29
  v_accvgpr_read_b32 v54, a30
  v_accvgpr_read_b32 v55, a31
  v_pk_mul_f32 v[48:49], v[48:49], v[18:19]
  v_pk_mul_f32 v[50:51], v[50:51], v[18:19]
  v_pk_mul_f32 v[52:53], v[52:53], v[18:19]
  v_pk_mul_f32 v[54:55], v[54:55], v[18:19]
  v_cvt_pk_bf16_f32 v44, v48, v49
  v_cvt_pk_bf16_f32 v45, v50, v51
  v_cvt_pk_bf16_f32 v46, v52, v53
  v_cvt_pk_bf16_f32 v47, v54, v55
  buffer_store_dwordx4 v[44:47], v2, s[40:43], s65 offen offset:1024 sc1
  v_accvgpr_read_b32 v100, a36
  v_accvgpr_read_b32 v101, a37
  v_accvgpr_read_b32 v102, a38
  v_accvgpr_read_b32 v103, a39
  v_accvgpr_read_b32 v104, a44
  v_accvgpr_read_b32 v105, a45
  v_accvgpr_read_b32 v106, a46
  v_accvgpr_read_b32 v107, a47
  v_pk_mul_f32 v[100:101], v[100:101], v[18:19]
  v_pk_mul_f32 v[102:103], v[102:103], v[18:19]
  v_pk_mul_f32 v[104:105], v[104:105], v[18:19]
  v_pk_mul_f32 v[106:107], v[106:107], v[18:19]
  v_cvt_pk_bf16_f32 v96, v100, v101
  v_cvt_pk_bf16_f32 v97, v102, v103
  v_cvt_pk_bf16_f32 v98, v104, v105
  v_cvt_pk_bf16_f32 v99, v106, v107
  buffer_store_dwordx4 v[96:99], v2, s[40:43], s65 offen offset:2048 sc1
  v_accvgpr_read_b32 v112, a52
  v_accvgpr_read_b32 v113, a53
  v_accvgpr_read_b32 v114, a54
  v_accvgpr_read_b32 v115, a55
  v_accvgpr_read_b32 v116, a60
  v_accvgpr_read_b32 v117, a61
  v_accvgpr_read_b32 v118, a62
  v_accvgpr_read_b32 v119, a63
  v_pk_mul_f32 v[112:113], v[112:113], v[18:19]
  v_pk_mul_f32 v[114:115], v[114:115], v[18:19]
  v_pk_mul_f32 v[116:117], v[116:117], v[18:19]
  v_pk_mul_f32 v[118:119], v[118:119], v[18:19]
  v_cvt_pk_bf16_f32 v108, v112, v113
  v_cvt_pk_bf16_f32 v109, v114, v115
  v_cvt_pk_bf16_f32 v110, v116, v117
  v_cvt_pk_bf16_f32 v111, v118, v119
  buffer_store_dwordx4 v[108:111], v2, s[40:43], s65 offen offset:3072 sc1
  s_waitcnt vmcnt(8)
  v_cmp_eq_u32 vcc, 0, v8
  s_cbranch_vccnz fa_wof_spin
fa_wof_ok:
  v_cmp_eq_u32 vcc, 0, v15
  s_cbranch_vccnz fa_sel4_spin
fa_sel4_ok:
  s_lshl_b32 s23, s20, 1
  s_add_u32 s31, s23, 1
  v_readlane_b32 s33, v15, s23
  v_readlane_b32 s35, v15, s31
  s_lshl_b32 s31, s21, 6
  s_add_u32 s31, s31, 1
  s_sub_u32 s33, s33, s31
  s_sub_u32 s35, s35, s31
  s_cmp_lt_u32 s33, 64
  s_cselect_b32 s10, 1, 0
  s_cmp_lt_u32 s35, 64
  s_cselect_b32 s31, 2, 0
  s_or_b32 s10, s10, s31
  s_cbranch_scc0 fa_coEnd
  v_min_u32 v11, 53, v1
  s_lshr_b32 s23, s22, 1
  s_lshl_b32 s23, s23, 8
  s_add_u32 s23, s23, 2650112
  v_lshl_add_u32 v11, v11, 2, s23
  buffer_load_dword v14, v11, s[40:43], 0 offen sc1
  v_mul_u32_u24 v16, 3277, v1
  v_lshrrev_b32 v16, 16, v16
  v_mul_u32_u24 v8, 20, v16
  v_sub_u32 v8, v1, v8
  v_lshlrev_b32 v8, 4, v8
  v_mul_u32_u24 v9, 368640, v16
  v_add_u32 v9, v9, v8
  v_cmp_gt_u32 vcc, 3, v16
  v_mov_b32 v19, 1073741824
  s_nop 0
  v_cndmask_b32 v9, v19, v9, vcc
  s_mov_b32 s12, 2
  s_mov_b32 s32, -1
  s_mov_b32 s11, 0
  s_getpc_b64 s[36:37]
  s_setpc_b64 s[38:39]
  v_cmp_eq_u32 vcc, 0, v14
  s_cbranch_vccnz fa_yf_spin
fa_yf_ok:
fa_coY:
  s_ff1_i32_b32 s33, s10
  s_bitset0_b32 s10, s33
  s_lshl_b32 s23, s20, 1
  s_add_u32 s33, s33, s23
  s_mul_i32 s14, s33, 2560
  s_mul_i32 s23, s22, 320
  s_add_u32 s14, s14, s23
  s_add_u32 s14, s14, 2686976
  buffer_load_dwordx4 v[64:67], v9, s[40:43], s14 offen sc1
  s_add_u32 s14, s14, 20480
  buffer_load_dwordx4 v[68:71], v9, s[40:43], s14 offen sc1
  s_add_u32 s14, s14, 20480
  buffer_load_dwordx4 v[72:75], v9, s[40:43], s14 offen sc1
  s_add_u32 s14, s14, 20480
  buffer_load_dwordx4 v[76:79], v9, s[40:43], s14 offen sc1
  s_add_u32 s14, s14, 20480
  buffer_load_dwordx4 v[80:83], v9, s[40:43], s14 offen sc1
  s_add_u32 s14, s14, 20480
  buffer_load_dwordx4 v[84:87], v9, s[40:43], s14 offen sc1
  s_add_u32 s14, s14, 20480
  buffer_load_dwordx4 v[88:91], v9, s[40:43], s14 offen sc1
  s_add_u32 s14, s14, 20480
  buffer_load_dwordx4 v[92:95], v9, s[40:43], s14 offen sc1
  s_add_u32 s14, s14, 20480
  buffer_load_dwordx4 v[128:131], v9, s[40:43], s14 offen sc1
  s_add_u32 s14, s14, 20480
  buffer_load_dwordx4 v[132:135], v9, s[40:43], s14 offen sc1
  s_add_u32 s14, s14, 20480
  buffer_load_dwordx4 v[136:139], v9, s[40:43], s14 offen sc1
  s_add_u32 s14, s14, 20480
  buffer_load_dwordx4 v[140:143], v9, s[40:43], s14 offen sc1
  s_add_u32 s14, s14, 20480
  buffer_load_dwordx4 v[144:147], v9, s[40:43], s14 offen sc1
  s_add_u32 s14, s14, 20480
  buffer_load_dwordx4 v[148:151], v9, s[40:43], s14 offen sc1
  s_add_u32 s14, s14, 20480
  buffer_load_dwordx4 v[152:155], v9, s[40:43], s14 offen sc1
  s_add_u32 s14, s14, 20480
  buffer_load_dwordx4 v[156:159], v9, s[40:43], s14 offen sc1
  s_add_u32 s14, s14, 20480
  buffer_load_dwordx4 v[176:179], v9, s[40:43], s14 offen sc1
  s_add_u32 s14, s14, 20480
  buffer_load_dwordx4 v[180:183], v9, s[40:43], s14 offen sc1
  s_add_u32 s14, s14, 20480
  s_cmp_eq_u32 s11, 0
  s_cbranch_scc1 fa_coY1
  s_waitcnt vmcnt(0)
  s_branch fa_coY2
fa_coY1:
  s_mov_b32 s11, 1
  s_getpc_b64 s[36:37]
  s_setpc_b64 s[38:39]
fa_coY2:
  s_lshl_b32 s14, s20, 10
  s_add_u32 s14, s14, 159744
  v_add_u32 v19, s14, v2
  s_add_u32 s23, s33, 8
  v_readlane_b32 s35, v15, s23
  s_waitcnt vmcnt(1)
  v_pk_add_f32 v[64:65], v[64:65], v[68:69]
  v_pk_add_f32 v[66:67], v[66:67], v[70:71]
  v_pk_add_f32 v[64:65], v[64:65], v[72:73]
  v_pk_add_f32 v[66:67], v[66:67], v[74:75]
  v_pk_add_f32 v[64:65], v[64:65], v[76:77]
  v_pk_add_f32 v[66:67], v[66:67], v[78:79]
  v_pk_add_f32 v[64:65], v[64:65], v[80:81]
  v_pk_add_f32 v[66:67], v[66:67], v[82:83]
  v_pk_add_f32 v[64:65], v[64:65], v[84:85]
  v_pk_add_f32 v[66:67], v[66:67], v[86:87]
  v_pk_add_f32 v[64:65], v[64:65], v[88:89]
  v_pk_add_f32 v[66:67], v[66:67], v[90:91]
  v_pk_add_f32 v[64:65], v[64:65], v[92:93]
  v_pk_add_f32 v[66:67], v[66:67], v[94:95]
  v_pk_add_f32 v[64:65], v[64:65], v[128:129]
  v_pk_add_f32 v[66:67], v[66:67], v[130:131]
  v_pk_add_f32 v[64:65], v[64:65], v[132:133]
  v_pk_add_f32 v[66:67], v[66:67], v[134:135]
  v_pk_add_f32 v[64:65], v[64:65], v[136:137]
  v_pk_add_f32 v[66:67], v[66:67], v[138:139]
  v_pk_add_f32 v[64:65], v[64:65], v[140:141]
  v_pk_add_f32 v[66:67], v[66:67], v[142:143]
  v_pk_add_f32 v[64:65], v[64:65], v[144:145]
  v_pk_add_f32 v[66:67], v[66:67], v[146:147]
  v_pk_add_f32 v[64:65], v[64:65], v[148:149]
  v_pk_add_f32 v[66:67], v[66:67], v[150:151]
  v_pk_add_f32 v[64:65], v[64:65], v[152:153]
  v_pk_add_f32 v[66:67], v[66:67], v[154:155]
  v_pk_add_f32 v[64:65], v[64:65], v[156:157]
  v_pk_add_f32 v[66:67], v[66:67], v[158:159]
  v_pk_add_f32 v[64:65], v[64:65], v[176:177]
  v_pk_add_f32 v[66:67], v[66:67], v[178:179]
  v_pk_add_f32 v[64:65], v[64:65], v[180:181]
  v_pk_add_f32 v[66:67], v[66:67], v[182:183]
  ds_write_b128 v19, v[64:67]
  v_add_u32 v19, s14, v8
  s_and_b32 s35, s35, 0xffff0000
  s_waitcnt lgkmcnt(0)
  ds_read_b128 v[64:67], v19
  ds_read_b128 v[68:71], v19 offset:320
  ds_read_b128 v[72:75], v19 offset:640
  s_mul_i32 s14, s33, 320
  s_add_u32 s14, s14, 155648
  v_add_u32 v19, s14, v8
  s_waitcnt lgkmcnt(0)
  v_add_f32 v64, v64, v68
  v_add_f32 v64, v64, v72
  v_cvt_pk_bf16_f32 v64, v64, v64
  v_and_b32 v64, 0xffff0000, v64
  v_mul_f32 v64, s35, v64
  v_cvt_pk_bf16_f32 v64, v64, v64
  v_and_b32 v64, 0xffff0000, v64
  v_add_f32 v65, v65, v69
  v_add_f32 v65, v65, v73
  v_cvt_pk_bf16_f32 v65, v65, v65
  v_and_b32 v65, 0xffff0000, v65
  v_mul_f32 v65, s35, v65
  v_cvt_pk_bf16_f32 v65, v65, v65
  v_and_b32 v65, 0xffff0000, v65
  v_add_f32 v66, v66, v70
  v_add_f32 v66, v66, v74
  v_cvt_pk_bf16_f32 v66, v66, v66
  v_and_b32 v66, 0xffff0000, v66
  v_mul_f32 v66, s35, v66
  v_cvt_pk_bf16_f32 v66, v66, v66
  v_and_b32 v66, 0xffff0000, v66
  v_add_f32 v67, v67, v71
  v_add_f32 v67, v67, v75
  v_cvt_pk_bf16_f32 v67, v67, v67
  v_and_b32 v67, 0xffff0000, v67
  v_mul_f32 v67, s35, v67
  v_cvt_pk_bf16_f32 v67, v67, v67
  v_and_b32 v67, 0xffff0000, v67
  ds_write_b128 v19, v[64:67]
  s_waitcnt lgkmcnt(0)
  s_cmp_lg_u32 s10, 0
  s_cbranch_scc1 fa_coY
fa_coEnd:
  s_mov_b32 s12, 3
  s_mov_b32 s32, -1
  s_setpc_b64 s[38:39]
fa_hk7:
  s_getpc_b64 s[38:39]
fa_hp7:
  s_add_u32 s36, s36, 4
  s_addc_u32 s37, s37, 0
  s_sub_u32 s38, s38, fa_hp7-fa_hb7
  s_subb_u32 s39, s39, 0
  s_setpc_b64 s[36:37]
fa_hk8:
  s_getpc_b64 s[38:39]
fa_hp8:
  s_add_u32 s36, s36, 4
  s_addc_u32 s37, s37, 0
  s_sub_u32 s38, s38, fa_hp8-fa_hb8
  s_subb_u32 s39, s39, 0
  s_setpc_b64 s[36:37]
fa_disp:
  s_cmp_eq_u32 s29, 7
  s_cbranch_scc1 fa_SSW7
  s_cmp_eq_u32 s29, 6
  s_cbranch_scc1 fa_SSW6
  s_cmp_eq_u32 s29, 5
  s_cbranch_scc1 fa_SSW5
  s_cmp_eq_u32 s29, 4
  s_cbranch_scc1 fa_SSW4
  s_cmp_eq_u32 s29, 3
  s_cbranch_scc1 fa_SSW3
  s_cmp_eq_u32 s29, 2
  s_cbranch_scc1 fa_SSW2
  s_cmp_eq_u32 s29, 1
  s_cbranch_scc1 fa_SSW1
  s_branch fa_Bexit
fa_hk9:
  s_getpc_b64 s[38:39]
fa_hp9:
  s_add_u32 s36, s36, 4
  s_addc_u32 s37, s37, 0
  s_sub_u32 s38, s38, fa_hp9-fa_hb9
  s_subb_u32 s39, s39, 0
  s_setpc_b64 s[36:37]
fa_hk10:
  s_getpc_b64 s[38:39]
fa_hp10:
  s_add_u32 s36, s36, 4
  s_addc_u32 s37, s37, 0
  s_sub_u32 s38, s38, fa_hp10-fa_hb10
  s_subb_u32 s39, s39, 0
  s_setpc_b64 s[36:37]
fa_left:
  s_add_u32 s14, s13, 0
  buffer_load_dwordx4 a[0:3], v2, s[40:43], s14 offen offset:0 sc1
  buffer_load_dwordx4 a[4:7], v2, s[40:43], s14 offen offset:1024 sc1
  buffer_load_dwordx4 a[8:11], v2, s[40:43], s14 offen offset:2048 sc1
  buffer_load_dwordx4 a[12:15], v2, s[40:43], s14 offen offset:3072 sc1
  s_add_u32 s14, s13, 4096
  buffer_load_dwordx4 a[16:19], v2, s[40:43], s14 offen offset:0 sc1
  buffer_load_dwordx4 a[20:23], v2, s[40:43], s14 offen offset:1024 sc1
  s_cmp_ge_u32 s29, 7
  s_cbranch_scc1 fa_leftb
  s_add_u32 s14, s13, 4096
  buffer_load_dwordx4 a[24:27], v2, s[40:43], s14 offen offset:2048 sc1
  buffer_load_dwordx4 a[28:31], v2, s[40:43], s14 offen offset:3072 sc1
  s_add_u32 s14, s13, 8192
  buffer_load_dwordx4 a[32:35], v2, s[40:43], s14 offen offset:0 sc1
  buffer_load_dwordx4 a[36:39], v2, s[40:43], s14 offen offset:1024 sc1
  buffer_load_dwordx4 a[40:43], v2, s[40:43], s14 offen offset:2048 sc1
  buffer_load_dwordx4 a[44:47], v2, s[40:43], s14 offen offset:3072 sc1
  s_cmp_ge_u32 s29, 6
  s_cbranch_scc1 fa_leftb
  s_add_u32 s14, s13, 12288
  buffer_load_dwordx4 a[48:51], v2, s[40:43], s14 offen offset:0 sc1
  buffer_load_dwordx4 a[52:55], v2, s[40:43], s14 offen offset:1024 sc1
  buffer_load_dwordx4 a[56:59], v2, s[40:43], s14 offen offset:2048 sc1
  buffer_load_dwordx4 a[60:63], v2, s[40:43], s14 offen offset:3072 sc1
  s_add_u32 s14, s13, 16384
  buffer_load_dwordx4 a[192:195], v2, s[40:43], s14 offen offset:0 sc1
  buffer_load_dwordx4 a[196:199], v2, s[40:43], s14 offen offset:1024 sc1
  s_cmp_ge_u32 s29, 5
  s_cbranch_scc1 fa_leftb
  s_add_u32 s14, s13, 16384
  buffer_load_dwordx4 a[200:203], v2, s[40:43], s14 offen offset:2048 sc1
  buffer_load_dwordx4 a[204:207], v2, s[40:43], s14 offen offset:3072 sc1
  s_add_u32 s14, s13, 20480
  buffer_load_dwordx4 a[208:211], v2, s[40:43], s14 offen offset:0 sc1
  buffer_load_dwordx4 a[212:215], v2, s[40:43], s14 offen offset:1024 sc1
  buffer_load_dwordx4 a[216:219], v2, s[40:43], s14 offen offset:2048 sc1
  buffer_load_dwordx4 a[220:223], v2, s[40:43], s14 offen offset:3072 sc1
  s_cmp_ge_u32 s29, 4
  s_cbranch_scc1 fa_leftb
  s_add_u32 s14, s13, 24576
  buffer_load_dwordx4 a[224:227], v2, s[40:43], s14 offen offset:0 sc1
  buffer_load_dwordx4 a[228:231], v2, s[40:43], s14 offen offset:1024 sc1
  buffer_load_dwordx4 a[232:235], v2, s[40:43], s14 offen offset:2048 sc1
  buffer_load_dwordx4 a[236:239], v2, s[40:43], s14 offen offset:3072 sc1
  s_add_u32 s14, s13, 28672
  buffer_load_dwordx4 a[240:243], v2, s[40:43], s14 offen offset:0 sc1
  buffer_load_dwordx4 a[244:247], v2, s[40:43], s14 offen offset:1024 sc1
  s_cmp_ge_u32 s29, 3
  s_cbranch_scc1 fa_leftb
  s_add_u32 s14, s13, 28672
  buffer_load_dwordx4 a[248:251], v2, s[40:43], s14 offen offset:2048 sc1
  buffer_load_dwordx4 a[252:255], v2, s[40:43], s14 offen offset:3072 sc1
  s_add_u32 s14, s13, 32768
  buffer_load_dwordx4 v[32:35], v2, s[40:43], s14 offen offset:0 sc1
  buffer_load_dwordx4 v[36:39], v2, s[40:43], s14 offen offset:1024 sc1
  buffer_load_dwordx4 v[40:43], v2, s[40:43], s14 offen offset:2048 sc1
  buffer_load_dwordx4 v[44:47], v2, s[40:43], s14 offen offset:3072 sc1
  s_cmp_ge_u32 s29, 2
  s_cbranch_scc1 fa_leftb
  s_add_u32 s14, s13, 36864
  buffer_load_dwordx4 v[48:51], v2, s[40:43], s14 offen offset:0 sc1
  buffer_load_dwordx4 v[52:55], v2, s[40:43], s14 offen offset:1024 sc1
  buffer_load_dwordx4 v[56:59], v2, s[40:43], s14 offen offset:2048 sc1
  buffer_load_dwordx4 v[60:63], v2, s[40:43], s14 offen offset:3072 sc1
  s_add_u32 s14, s13, 40960
  buffer_load_dwordx4 v[96:99], v2, s[40:43], s14 offen offset:0 sc1
  buffer_load_dwordx4 v[100:103], v2, s[40:43], s14 offen offset:1024 sc1
  s_cmp_ge_u32 s29, 1
  s_cbranch_scc1 fa_leftb
  s_add_u32 s14, s13, 40960
  buffer_load_dwordx4 v[104:107], v2, s[40:43], s14 offen offset:2048 sc1
  buffer_load_dwordx4 v[108:111], v2, s[40:43], s14 offen offset:3072 sc1
  s_add_u32 s14, s13, 45056
  buffer_load_dwordx4 v[112:115], v2, s[40:43], s14 offen offset:0 sc1
  buffer_load_dwordx4 v[116:119], v2, s[40:43], s14 offen offset:1024 sc1
  buffer_load_dwordx4 v[120:123], v2, s[40:43], s14 offen offset:2048 sc1
  buffer_load_dwordx4 v[124:127], v2, s[40:43], s14 offen offset:3072 sc1
  s_branch fa_leftb
fa_ctx_spin:
  s_mov_b32 s83, 200000
fa_ctx_spin2:
  buffer_load_dword v13, v12, s[40:43], 0 offen sc1
  s_waitcnt vmcnt(0)
  v_cmp_eq_u32 vcc, 0, v13
  s_cbranch_vccz fa_ctx_ok
  s_sleep 8
  s_sub_u32 s83, s83, 1
  s_cmp_lg_u32 s83, 0
  s_cbranch_scc1 fa_ctx_spin2
  s_branch fa_ctx_ok
fa_stub0:
  s_call_b64 s[76:77], fa_rare00
  s_call_b64 s[76:77], fa_rare10
  s_branch fa_back0
fa_stub1:
  s_call_b64 s[76:77], fa_rare01
  s_call_b64 s[76:77], fa_rare11
  s_branch fa_back1
fa_stub2:
  s_call_b64 s[76:77], fa_rare00
  s_call_b64 s[76:77], fa_rare10
  s_branch fa_back2
fa_stub3:
  s_call_b64 s[76:77], fa_rare01
  s_call_b64 s[76:77], fa_rare11
  s_branch fa_back3
fa_stub4:
  s_call_b64 s[76:77], fa_rare01
  s_call_b64 s[76:77], fa_rare11
  s_branch fa_back4
fa_stub5:
  s_call_b64 s[76:77], fa_rare00
  s_call_b64 s[76:77], fa_rare10
  s_branch fa_back5
fa_stub6:
  s_call_b64 s[76:77], fa_rare11
  s_branch fa_back6
fa_stub7:
  s_call_b64 s[76:77], fa_rare10
  s_branch fa_back7
fa_stub8:
  s_call_b64 s[76:77], fa_rare01
  s_call_b64 s[76:77], fa_rare11
  s_branch fa_back8
fa_stub9:
  s_call_b64 s[76:77], fa_rare10
  s_branch fa_back9
fa_stub10:
  s_call_b64 s[76:77], fa_rare11
  s_branch fa_back10
fa_stub11:
  s_call_b64 s[76:77], fa_rare10
  s_branch fa_back11
fa_stub12:
  s_call_b64 s[76:77], fa_rare11
  s_branch fa_back12
fa_stub13:
  s_call_b64 s[76:77], fa_rare10
  s_branch fa_back13
fa_stub14:
  s_call_b64 s[76:77], fa_rare11
  s_branch fa_back14
fa_stub15:
  s_call_b64 s[76:77], fa_rare10
  s_branch fa_back15
fa_stub16:
  s_call_b64 s[76:77], fa_rare11
  s_branch fa_back16
fa_stub17:
  s_call_b64 s[76:77], fa_rare10
  s_branch fa_back17
fa_stub18:
  s_call_b64 s[76:77], fa_rare11
  s_branch fa_back18
fa_stub19:
  s_call_b64 s[76:77], fa_rare10
  s_branch fa_back19
fa_stub20:
  s_call_b64 s[76:77], fa_rare11
  s_branch fa_back20
fa_stub21:
  s_call_b64 s[76:77], fa_rare10
  s_branch fa_back21
fa_stub22:
  s_call_b64 s[76:77], fa_rare11
  s_branch fa_back22
fa_stub23:
  s_call_b64 s[76:77], fa_rare10
  s_branch fa_back23
fa_stub24:
  s_call_b64 s[76:77], fa_rare11
  s_branch fa_back24
fa_stub25:
  s_call_b64 s[76:77], fa_rare10
  s_branch fa_back25
fa_stub26:
  s_call_b64 s[76:77], fa_rare11
  s_branch fa_back26
fa_stub27:
  s_call_b64 s[76:77], fa_rare10
  s_branch fa_back27
fa_stub28:
  s_call_b64 s[76:77], fa_rare11
  s_branch fa_back28
fa_stub29:
  s_call_b64 s[76:77], fa_rare10
  s_branch fa_back29
fa_stub30:
  s_call_b64 s[76:77], fa_rare11
  s_branch fa_back30
fa_codeend:
fa_rare00:
  s_nop 7
  v_max3_f32 v16, v96, v97, v98
  v_max3_f32 v16, v16, v99, v100
  v_max3_f32 v16, v16, v101, v102
  v_max3_f32 v16, v16, v103, 0
  v_mov_b32 v18, v16
  s_nop 1
  v_permlane16_swap_b32 v16, v18
  v_max_f32 v16, v16, v18
  v_mov_b32 v18, v16
  s_nop 1
  v_permlane32_swap_b32 v16, v18
  v_max_f32 v16, v16, v18
  v_sub_f32 v96, v96, v16
  v_sub_f32 v112, v112, v16
  v_sub_f32 v97, v97, v16
  v_sub_f32 v113, v113, v16
  v_sub_f32 v98, v98, v16
  v_sub_f32 v114, v114, v16
  v_sub_f32 v99, v99, v16
  v_sub_f32 v115, v115, v16
  v_sub_f32 v100, v100, v16
  v_sub_f32 v116, v116, v16
  v_sub_f32 v101, v101, v16
  v_sub_f32 v117, v117, v16
  v_sub_f32 v102, v102, v16
  v_sub_f32 v118, v118, v16
  v_sub_f32 v103, v103, v16
  v_sub_f32 v119, v119, v16
  v_max3_f32 v17, v104, v105, v106
  v_max3_f32 v17, v17, v107, v108
  v_max3_f32 v17, v17, v109, v110
  v_max3_f32 v17, v17, v111, 0
  v_mov_b32 v18, v17
  s_nop 1
  v_permlane16_swap_b32 v17, v18
  v_max_f32 v17, v17, v18
  v_mov_b32 v18, v17
  s_nop 1
  v_permlane32_swap_b32 v17, v18
  v_max_f32 v17, v17, v18
  v_sub_f32 v104, v104, v17
  v_sub_f32 v120, v120, v17
  v_sub_f32 v105, v105, v17
  v_sub_f32 v121, v121, v17
  v_sub_f32 v106, v106, v17
  v_sub_f32 v122, v122, v17
  v_sub_f32 v107, v107, v17
  v_sub_f32 v123, v123, v17
  v_sub_f32 v108, v108, v17
  v_sub_f32 v124, v124, v17
  v_sub_f32 v109, v109, v17
  v_sub_f32 v125, v125, v17
  v_sub_f32 v110, v110, v17
  v_sub_f32 v126, v126, v17
  v_sub_f32 v111, v111, v17
  v_sub_f32 v127, v127, v17
  s_call_b64 s[78:79], fa_resc0
  v_exp_f32 v208, v96
  v_exp_f32 v209, v97
  v_exp_f32 v210, v98
  v_add_f32 v224, v208, v209
  v_cvt_pk_bf16_f32 v160, v208, v209
  v_exp_f32 v211, v99
  v_add_f32 v224, v224, v210
  v_exp_f32 v212, v100
  v_add_f32 v224, v224, v211
  v_cvt_pk_bf16_f32 v161, v210, v211
  v_exp_f32 v213, v101
  v_add_f32 v224, v224, v212
  v_exp_f32 v214, v102
  v_add_f32 v224, v224, v213
  v_cvt_pk_bf16_f32 v162, v212, v213
  v_exp_f32 v215, v103
  v_add_f32 v224, v224, v214
  v_exp_f32 v208, v104
  v_add_f32 v224, v224, v215
  v_cvt_pk_bf16_f32 v163, v214, v215
  v_exp_f32 v209, v105
  v_exp_f32 v210, v106
  v_add_f32 v225, v208, v209
  v_cvt_pk_bf16_f32 v164, v208, v209
  v_exp_f32 v211, v107
  v_add_f32 v225, v225, v210
  v_exp_f32 v212, v108
  v_add_f32 v225, v225, v211
  v_cvt_pk_bf16_f32 v165, v210, v211
  v_exp_f32 v213, v109
  v_add_f32 v225, v225, v212
  v_exp_f32 v214, v110
  v_add_f32 v225, v225, v213
  v_cvt_pk_bf16_f32 v166, v212, v213
  v_exp_f32 v215, v111
  v_add_f32 v225, v225, v214
  s_nop 0
  v_add_f32 v225, v225, v215
  v_cvt_pk_bf16_f32 v167, v214, v215
  s_nop 1
  s_setpc_b64 s[76:77]
fa_rare01:
  s_nop 7
  v_max3_f32 v16, v112, v113, v114
  v_max3_f32 v16, v16, v115, v116
  v_max3_f32 v16, v16, v117, v118
  v_max3_f32 v16, v16, v119, 0
  v_mov_b32 v18, v16
  s_nop 1
  v_permlane16_swap_b32 v16, v18
  v_max_f32 v16, v16, v18
  v_mov_b32 v18, v16
  s_nop 1
  v_permlane32_swap_b32 v16, v18
  v_max_f32 v16, v16, v18
  v_sub_f32 v112, v112, v16
  v_sub_f32 v96, v96, v16
  v_sub_f32 v113, v113, v16
  v_sub_f32 v97, v97, v16
  v_sub_f32 v114, v114, v16
  v_sub_f32 v98, v98, v16
  v_sub_f32 v115, v115, v16
  v_sub_f32 v99, v99, v16
  v_sub_f32 v116, v116, v16
  v_sub_f32 v100, v100, v16
  v_sub_f32 v117, v117, v16
  v_sub_f32 v101, v101, v16
  v_sub_f32 v118, v118, v16
  v_sub_f32 v102, v102, v16
  v_sub_f32 v119, v119, v16
  v_sub_f32 v103, v103, v16
  v_max3_f32 v17, v120, v121, v122
  v_max3_f32 v17, v17, v123, v124
  v_max3_f32 v17, v17, v125, v126
  v_max3_f32 v17, v17, v127, 0
  v_mov_b32 v18, v17
  s_nop 1
  v_permlane16_swap_b32 v17, v18
  v_max_f32 v17, v17, v18
  v_mov_b32 v18, v17
  s_nop 1
  v_permlane32_swap_b32 v17, v18
  v_max_f32 v17, v17, v18
  v_sub_f32 v120, v120, v17
  v_sub_f32 v104, v104, v17
  v_sub_f32 v121, v121, v17
  v_sub_f32 v105, v105, v17
  v_sub_f32 v122, v122, v17
  v_sub_f32 v106, v106, v17
  v_sub_f32 v123, v123, v17
  v_sub_f32 v107, v107, v17
  v_sub_f32 v124, v124, v17
  v_sub_f32 v108, v108, v17
  v_sub_f32 v125, v125, v17
  v_sub_f32 v109, v109, v17
  v_sub_f32 v126, v126, v17
  v_sub_f32 v110, v110, v17
  v_sub_f32 v127, v127, v17
  v_sub_f32 v111, v111, v17
  s_call_b64 s[78:79], fa_resc0
  v_exp_f32 v208, v112
  v_exp_f32 v209, v113
  v_exp_f32 v210, v114
  v_add_f32 v224, v208, v209
  v_cvt_pk_bf16_f32 v168, v208, v209
  v_exp_f32 v211, v115
  v_add_f32 v224, v224, v210
  v_exp_f32 v212, v116
  v_add_f32 v224, v224, v211
  v_cvt_pk_bf16_f32 v169, v210, v211
  v_exp_f32 v213, v117
  v_add_f32 v224, v224, v212
  v_exp_f32 v214, v118
  v_add_f32 v224, v224, v213
  v_cvt_pk_bf16_f32 v170, v212, v213
  v_exp_f32 v215, v119
  v_add_f32 v224, v224, v214
  v_exp_f32 v208, v120
  v_add_f32 v224, v224, v215
  v_cvt_pk_bf16_f32 v171, v214, v215
  v_exp_f32 v209, v121
  v_exp_f32 v210, v122
  v_add_f32 v225, v208, v209
  v_cvt_pk_bf16_f32 v172, v208, v209
  v_exp_f32 v211, v123
  v_add_f32 v225, v225, v210
  v_exp_f32 v212, v124
  v_add_f32 v225, v225, v211
  v_cvt_pk_bf16_f32 v173, v210, v211
  v_exp_f32 v213, v125
  v_add_f32 v225, v225, v212
  v_exp_f32 v214, v126
  v_add_f32 v225, v225, v213
  v_cvt_pk_bf16_f32 v174, v212, v213
  v_exp_f32 v215, v127
  v_add_f32 v225, v225, v214
  s_nop 0
  v_add_f32 v225, v225, v215
  v_cvt_pk_bf16_f32 v175, v214, v215
  s_nop 1
  s_setpc_b64 s[76:77]
fa_resc0:
  v_sub_f32 v192, v192, v16
  v_sub_f32 v193, v193, v16
  v_sub_f32 v194, v194, v16
  v_sub_f32 v195, v195, v16
  v_exp_f32 v18, -v16
  v_sub_f32 v196, v196, v17
  v_sub_f32 v197, v197, v17
  v_sub_f32 v198, v198, v17
  v_sub_f32 v199, v199, v17
  v_exp_f32 v19, -v17
  s_nop 0
  v_mul_f32 v228, v228, v18
  v_mul_f32 v229, v229, v19
  v_accvgpr_read_b32 v20, a0
  v_accvgpr_read_b32 v21, a1
  v_accvgpr_read_b32 v22, a2
  v_accvgpr_read_b32 v23, a3
  v_mul_f32 v20, v20, v18
  v_mul_f32 v21, v21, v18
  v_mul_f32 v22, v22, v18
  v_mul_f32 v23, v23, v18
  v_accvgpr_write_b32 a0, v20
  v_accvgpr_write_b32 a1, v21
  v_accvgpr_write_b32 a2, v22
  v_accvgpr_write_b32 a3, v23
  v_accvgpr_read_b32 v20, a4
  v_accvgpr_read_b32 v21, a5
  v_accvgpr_read_b32 v22, a6
  v_accvgpr_read_b32 v23, a7
  v_mul_f32 v20, v20, v19
  v_mul_f32 v21, v21, v19
  v_mul_f32 v22, v22, v19
  v_mul_f32 v23, v23, v19
  v_accvgpr_write_b32 a4, v20
  v_accvgpr_write_b32 a5, v21
  v_accvgpr_write_b32 a6, v22
  v_accvgpr_write_b32 a7, v23
  v_accvgpr_read_b32 v20, a8
  v_accvgpr_read_b32 v21, a9
  v_accvgpr_read_b32 v22, a10
  v_accvgpr_read_b32 v23, a11
  v_mul_f32 v20, v20, v18
  v_mul_f32 v21, v21, v18
  v_mul_f32 v22, v22, v18
  v_mul_f32 v23, v23, v18
  v_accvgpr_write_b32 a8, v20
  v_accvgpr_write_b32 a9, v21
  v_accvgpr_write_b32 a10, v22
  v_accvgpr_write_b32 a11, v23
  v_accvgpr_read_b32 v20, a12
  v_accvgpr_read_b32 v21, a13
  v_accvgpr_read_b32 v22, a14
  v_accvgpr_read_b32 v23, a15
  v_mul_f32 v20, v20, v19
  v_mul_f32 v21, v21, v19
  v_mul_f32 v22, v22, v19
  v_mul_f32 v23, v23, v19
  v_accvgpr_write_b32 a12, v20
  v_accvgpr_write_b32 a13, v21
  v_accvgpr_write_b32 a14, v22
  v_accvgpr_write_b32 a15, v23
  v_accvgpr_read_b32 v20, a16
  v_accvgpr_read_b32 v21, a17
  v_accvgpr_read_b32 v22, a18
  v_accvgpr_read_b32 v23, a19
  v_mul_f32 v20, v20, v18
  v_mul_f32 v21, v21, v18
  v_mul_f32 v22, v22, v18
  v_mul_f32 v23, v23, v18
  v_accvgpr_write_b32 a16, v20
  v_accvgpr_write_b32 a17, v21
  v_accvgpr_write_b32 a18, v22
  v_accvgpr_write_b32 a19, v23
  v_accvgpr_read_b32 v20, a20
  v_accvgpr_read_b32 v21, a21
  v_accvgpr_read_b32 v22, a22
  v_accvgpr_read_b32 v23, a23
  v_mul_f32 v20, v20, v19
  v_mul_f32 v21, v21, v19
  v_mul_f32 v22, v22, v19
  v_mul_f32 v23, v23, v19
  v_accvgpr_write_b32 a20, v20
  v_accvgpr_write_b32 a21, v21
  v_accvgpr_write_b32 a22, v22
  v_accvgpr_write_b32 a23, v23
  v_accvgpr_read_b32 v20, a24
  v_accvgpr_read_b32 v21, a25
  v_accvgpr_read_b32 v22, a26
  v_accvgpr_read_b32 v23, a27
  v_mul_f32 v20, v20, v18
  v_mul_f32 v21, v21, v18
  v_mul_f32 v22, v22, v18
  v_mul_f32 v23, v23, v18
  v_accvgpr_write_b32 a24, v20
  v_accvgpr_write_b32 a25, v21
  v_accvgpr_write_b32 a26, v22
  v_accvgpr_write_b32 a27, v23
  v_accvgpr_read_b32 v20, a28
  v_accvgpr_read_b32 v21, a29
  v_accvgpr_read_b32 v22, a30
  v_accvgpr_read_b32 v23, a31
  v_mul_f32 v20, v20, v19
  v_mul_f32 v21, v21, v19
  v_mul_f32 v22, v22, v19
  v_mul_f32 v23, v23, v19
  v_accvgpr_write_b32 a28, v20
  v_accvgpr_write_b32 a29, v21
  v_accvgpr_write_b32 a30, v22
  v_accvgpr_write_b32 a31, v23
  v_accvgpr_read_b32 v20, a32
  v_accvgpr_read_b32 v21, a33
  v_accvgpr_read_b32 v22, a34
  v_accvgpr_read_b32 v23, a35
  v_mul_f32 v20, v20, v18
  v_mul_f32 v21, v21, v18
  v_mul_f32 v22, v22, v18
  v_mul_f32 v23, v23, v18
  v_accvgpr_write_b32 a32, v20
  v_accvgpr_write_b32 a33, v21
  v_accvgpr_write_b32 a34, v22
  v_accvgpr_write_b32 a35, v23
  v_accvgpr_read_b32 v20, a36
  v_accvgpr_read_b32 v21, a37
  v_accvgpr_read_b32 v22, a38
  v_accvgpr_read_b32 v23, a39
  v_mul_f32 v20, v20, v19
  v_mul_f32 v21, v21, v19
  v_mul_f32 v22, v22, v19
  v_mul_f32 v23, v23, v19
  v_accvgpr_write_b32 a36, v20
  v_accvgpr_write_b32 a37, v21
  v_accvgpr_write_b32 a38, v22
  v_accvgpr_write_b32 a39, v23
  v_accvgpr_read_b32 v20, a40
  v_accvgpr_read_b32 v21, a41
  v_accvgpr_read_b32 v22, a42
  v_accvgpr_read_b32 v23, a43
  v_mul_f32 v20, v20, v18
  v_mul_f32 v21, v21, v18
  v_mul_f32 v22, v22, v18
  v_mul_f32 v23, v23, v18
  v_accvgpr_write_b32 a40, v20
  v_accvgpr_write_b32 a41, v21
  v_accvgpr_write_b32 a42, v22
  v_accvgpr_write_b32 a43, v23
  v_accvgpr_read_b32 v20, a44
  v_accvgpr_read_b32 v21, a45
  v_accvgpr_read_b32 v22, a46
  v_accvgpr_read_b32 v23, a47
  v_mul_f32 v20, v20, v19
  v_mul_f32 v21, v21, v19
  v_mul_f32 v22, v22, v19
  v_mul_f32 v23, v23, v19
  v_accvgpr_write_b32 a44, v20
  v_accvgpr_write_b32 a45, v21
  v_accvgpr_write_b32 a46, v22
  v_accvgpr_write_b32 a47, v23
  v_accvgpr_read_b32 v20, a48
  v_accvgpr_read_b32 v21, a49
  v_accvgpr_read_b32 v22, a50
  v_accvgpr_read_b32 v23, a51
  v_mul_f32 v20, v20, v18
  v_mul_f32 v21, v21, v18
  v_mul_f32 v22, v22, v18
  v_mul_f32 v23, v23, v18
  v_accvgpr_write_b32 a48, v20
  v_accvgpr_write_b32 a49, v21
  v_accvgpr_write_b32 a50, v22
  v_accvgpr_write_b32 a51, v23
  v_accvgpr_read_b32 v20, a52
  v_accvgpr_read_b32 v21, a53
  v_accvgpr_read_b32 v22, a54
  v_accvgpr_read_b32 v23, a55
  v_mul_f32 v20, v20, v19
  v_mul_f32 v21, v21, v19
  v_mul_f32 v22, v22, v19
  v_mul_f32 v23, v23, v19
  v_accvgpr_write_b32 a52, v20
  v_accvgpr_write_b32 a53, v21
  v_accvgpr_write_b32 a54, v22
  v_accvgpr_write_b32 a55, v23
  v_accvgpr_read_b32 v20, a56
  v_accvgpr_read_b32 v21, a57
  v_accvgpr_read_b32 v22, a58
  v_accvgpr_read_b32 v23, a59
  v_mul_f32 v20, v20, v18
  v_mul_f32 v21, v21, v18
  v_mul_f32 v22, v22, v18
  v_mul_f32 v23, v23, v18
  v_accvgpr_write_b32 a56, v20
  v_accvgpr_write_b32 a57, v21
  v_accvgpr_write_b32 a58, v22
  v_accvgpr_write_b32 a59, v23
  v_accvgpr_read_b32 v20, a60
  v_accvgpr_read_b32 v21, a61
  v_accvgpr_read_b32 v22, a62
  v_accvgpr_read_b32 v23, a63
  v_mul_f32 v20, v20, v19
  v_mul_f32 v21, v21, v19
  v_mul_f32 v22, v22, v19
  v_mul_f32 v23, v23, v19
  v_accvgpr_write_b32 a60, v20
  v_accvgpr_write_b32 a61, v21
  v_accvgpr_write_b32 a62, v22
  v_accvgpr_write_b32 a63, v23
  s_setpc_b64 s[78:79]
fa_rare10:
  s_nop 7
  v_max3_f32 v16, v128, v129, v130
  v_max3_f32 v16, v16, v131, v132
  v_max3_f32 v16, v16, v133, v134
  v_max3_f32 v16, v16, v135, 0
  v_mov_b32 v18, v16
  s_nop 1
  v_permlane16_swap_b32 v16, v18
  v_max_f32 v16, v16, v18
  v_mov_b32 v18, v16
  s_nop 1
  v_permlane32_swap_b32 v16, v18
  v_max_f32 v16, v16, v18
  v_sub_f32 v128, v128, v16
  v_sub_f32 v144, v144, v16
  v_sub_f32 v129, v129, v16
  v_sub_f32 v145, v145, v16
  v_sub_f32 v130, v130, v16
  v_sub_f32 v146, v146, v16
  v_sub_f32 v131, v131, v16
  v_sub_f32 v147, v147, v16
  v_sub_f32 v132, v132, v16
  v_sub_f32 v148, v148, v16
  v_sub_f32 v133, v133, v16
  v_sub_f32 v149, v149, v16
  v_sub_f32 v134, v134, v16
  v_sub_f32 v150, v150, v16
  v_sub_f32 v135, v135, v16
  v_sub_f32 v151, v151, v16
  v_max3_f32 v17, v136, v137, v138
  v_max3_f32 v17, v17, v139, v140
  v_max3_f32 v17, v17, v141, v142
  v_max3_f32 v17, v17, v143, 0
  v_mov_b32 v18, v17
  s_nop 1
  v_permlane16_swap_b32 v17, v18
  v_max_f32 v17, v17, v18
  v_mov_b32 v18, v17
  s_nop 1
  v_permlane32_swap_b32 v17, v18
  v_max_f32 v17, v17, v18
  v_sub_f32 v136, v136, v17
  v_sub_f32 v152, v152, v17
  v_sub_f32 v137, v137, v17
  v_sub_f32 v153, v153, v17
  v_sub_f32 v138, v138, v17
  v_sub_f32 v154, v154, v17
  v_sub_f32 v139, v139, v17
  v_sub_f32 v155, v155, v17
  v_sub_f32 v140, v140, v17
  v_sub_f32 v156, v156, v17
  v_sub_f32 v141, v141, v17
  v_sub_f32 v157, v157, v17
  v_sub_f32 v142, v142, v17
  v_sub_f32 v158, v158, v17
  v_sub_f32 v143, v143, v17
  v_sub_f32 v159, v159, v17
  s_call_b64 s[78:79], fa_resc1
  v_exp_f32 v216, v128
  v_exp_f32 v217, v129
  v_exp_f32 v218, v130
  v_add_f32 v226, v216, v217
  v_cvt_pk_bf16_f32 v176, v216, v217
  v_exp_f32 v219, v131
  v_add_f32 v226, v226, v218
  v_exp_f32 v220, v132
  v_add_f32 v226, v226, v219
  v_cvt_pk_bf16_f32 v177, v218, v219
  v_exp_f32 v221, v133
  v_add_f32 v226, v226, v220
  v_exp_f32 v222, v134
  v_add_f32 v226, v226, v221
  v_cvt_pk_bf16_f32 v178, v220, v221
  v_exp_f32 v223, v135
  v_add_f32 v226, v226, v222
  v_exp_f32 v216, v136
  v_add_f32 v226, v226, v223
  v_cvt_pk_bf16_f32 v179, v222, v223
  v_exp_f32 v217, v137
  v_exp_f32 v218, v138
  v_add_f32 v227, v216, v217
  v_cvt_pk_bf16_f32 v180, v216, v217
  v_exp_f32 v219, v139
  v_add_f32 v227, v227, v218
  v_exp_f32 v220, v140
  v_add_f32 v227, v227, v219
  v_cvt_pk_bf16_f32 v181, v218, v219
  v_exp_f32 v221, v141
  v_add_f32 v227, v227, v220
  v_exp_f32 v222, v142
  v_add_f32 v227, v227, v221
  v_cvt_pk_bf16_f32 v182, v220, v221
  v_exp_f32 v223, v143
  v_add_f32 v227, v227, v222
  s_nop 0
  v_add_f32 v227, v227, v223
  v_cvt_pk_bf16_f32 v183, v222, v223
  s_nop 1
  s_setpc_b64 s[76:77]
fa_rare11:
  s_nop 7
  v_max3_f32 v16, v144, v145, v146
  v_max3_f32 v16, v16, v147, v148
  v_max3_f32 v16, v16, v149, v150
  v_max3_f32 v16, v16, v151, 0
  v_mov_b32 v18, v16
  s_nop 1
  v_permlane16_swap_b32 v16, v18
  v_max_f32 v16, v16, v18
  v_mov_b32 v18, v16
  s_nop 1
  v_permlane32_swap_b32 v16, v18
  v_max_f32 v16, v16, v18
  v_sub_f32 v144, v144, v16
  v_sub_f32 v128, v128, v16
  v_sub_f32 v145, v145, v16
  v_sub_f32 v129, v129, v16
  v_sub_f32 v146, v146, v16
  v_sub_f32 v130, v130, v16
  v_sub_f32 v147, v147, v16
  v_sub_f32 v131, v131, v16
  v_sub_f32 v148, v148, v16
  v_sub_f32 v132, v132, v16
  v_sub_f32 v149, v149, v16
  v_sub_f32 v133, v133, v16
  v_sub_f32 v150, v150, v16
  v_sub_f32 v134, v134, v16
  v_sub_f32 v151, v151, v16
  v_sub_f32 v135, v135, v16
  v_max3_f32 v17, v152, v153, v154
  v_max3_f32 v17, v17, v155, v156
  v_max3_f32 v17, v17, v157, v158
  v_max3_f32 v17, v17, v159, 0
  v_mov_b32 v18, v17
  s_nop 1
  v_permlane16_swap_b32 v17, v18
  v_max_f32 v17, v17, v18
  v_mov_b32 v18, v17
  s_nop 1
  v_permlane32_swap_b32 v17, v18
  v_max_f32 v17, v17, v18
  v_sub_f32 v152, v152, v17
  v_sub_f32 v136, v136, v17
  v_sub_f32 v153, v153, v17
  v_sub_f32 v137, v137, v17
  v_sub_f32 v154, v154, v17
  v_sub_f32 v138, v138, v17
  v_sub_f32 v155, v155, v17
  v_sub_f32 v139, v139, v17
  v_sub_f32 v156, v156, v17
  v_sub_f32 v140, v140, v17
  v_sub_f32 v157, v157, v17
  v_sub_f32 v141, v141, v17
  v_sub_f32 v158, v158, v17
  v_sub_f32 v142, v142, v17
  v_sub_f32 v159, v159, v17
  v_sub_f32 v143, v143, v17
  s_call_b64 s[78:79], fa_resc1
  v_exp_f32 v216, v144
  v_exp_f32 v217, v145
  v_exp_f32 v218, v146
  v_add_f32 v226, v216, v217
  v_cvt_pk_bf16_f32 v184, v216, v217
  v_exp_f32 v219, v147
  v_add_f32 v226, v226, v218
  v_exp_f32 v220, v148
  v_add_f32 v226, v226, v219
  v_cvt_pk_bf16_f32 v185, v218, v219
  v_exp_f32 v221, v149
  v_add_f32 v226, v226, v220
  v_exp_f32 v222, v150
  v_add_f32 v226, v226, v221
  v_cvt_pk_bf16_f32 v186, v220, v221
  v_exp_f32 v223, v151
  v_add_f32 v226, v226, v222
  v_exp_f32 v216, v152
  v_add_f32 v226, v226, v223
  v_cvt_pk_bf16_f32 v187, v222, v223
  v_exp_f32 v217, v153
  v_exp_f32 v218, v154
  v_add_f32 v227, v216, v217
  v_cvt_pk_bf16_f32 v188, v216, v217
  v_exp_f32 v219, v155
  v_add_f32 v227, v227, v218
  v_exp_f32 v220, v156
  v_add_f32 v227, v227, v219
  v_cvt_pk_bf16_f32 v189, v218, v219
  v_exp_f32 v221, v157
  v_add_f32 v227, v227, v220
  v_exp_f32 v222, v158
  v_add_f32 v227, v227, v221
  v_cvt_pk_bf16_f32 v190, v220, v221
  v_exp_f32 v223, v159
  v_add_f32 v227, v227, v222
  s_nop 0
  v_add_f32 v227, v227, v223
  v_cvt_pk_bf16_f32 v191, v222, v223
  s_nop 1
  s_setpc_b64 s[76:77]
fa_resc1:
  v_sub_f32 v200, v200, v16
  v_sub_f32 v201, v201, v16
  v_sub_f32 v202, v202, v16
  v_sub_f32 v203, v203, v16
  v_exp_f32 v18, -v16
  v_sub_f32 v204, v204, v17
  v_sub_f32 v205, v205, v17
  v_sub_f32 v206, v206, v17
  v_sub_f32 v207, v207, v17
  v_exp_f32 v19, -v17
  s_nop 0
  v_mul_f32 v230, v230, v18
  v_mul_f32 v231, v231, v19
  v_accvgpr_read_b32 v20, a64
  v_accvgpr_read_b32 v21, a65
  v_accvgpr_read_b32 v22, a66
  v_accvgpr_read_b32 v23, a67
  v_mul_f32 v20, v20, v18
  v_mul_f32 v21, v21, v18
  v_mul_f32 v22, v22, v18
  v_mul_f32 v23, v23, v18
  v_accvgpr_write_b32 a64, v20
  v_accvgpr_write_b32 a65, v21
  v_accvgpr_write_b32 a66, v22
  v_accvgpr_write_b32 a67, v23
  v_accvgpr_read_b32 v20, a68
  v_accvgpr_read_b32 v21, a69
  v_accvgpr_read_b32 v22, a70
  v_accvgpr_read_b32 v23, a71
  v_mul_f32 v20, v20, v19
  v_mul_f32 v21, v21, v19
  v_mul_f32 v22, v22, v19
  v_mul_f32 v23, v23, v19
  v_accvgpr_write_b32 a68, v20
  v_accvgpr_write_b32 a69, v21
  v_accvgpr_write_b32 a70, v22
  v_accvgpr_write_b32 a71, v23
  v_accvgpr_read_b32 v20, a72
  v_accvgpr_read_b32 v21, a73
  v_accvgpr_read_b32 v22, a74
  v_accvgpr_read_b32 v23, a75
  v_mul_f32 v20, v20, v18
  v_mul_f32 v21, v21, v18
  v_mul_f32 v22, v22, v18
  v_mul_f32 v23, v23, v18
  v_accvgpr_write_b32 a72, v20
  v_accvgpr_write_b32 a73, v21
  v_accvgpr_write_b32 a74, v22
  v_accvgpr_write_b32 a75, v23
  v_accvgpr_read_b32 v20, a76
  v_accvgpr_read_b32 v21, a77
  v_accvgpr_read_b32 v22, a78
  v_accvgpr_read_b32 v23, a79
  v_mul_f32 v20, v20, v19
  v_mul_f32 v21, v21, v19
  v_mul_f32 v22, v22, v19
  v_mul_f32 v23, v23, v19
  v_accvgpr_write_b32 a76, v20
  v_accvgpr_write_b32 a77, v21
  v_accvgpr_write_b32 a78, v22
  v_accvgpr_write_b32 a79, v23
  v_accvgpr_read_b32 v20, a80
  v_accvgpr_read_b32 v21, a81
  v_accvgpr_read_b32 v22, a82
  v_accvgpr_read_b32 v23, a83
  v_mul_f32 v20, v20, v18
  v_mul_f32 v21, v21, v18
  v_mul_f32 v22, v22, v18
  v_mul_f32 v23, v23, v18
  v_accvgpr_write_b32 a80, v20
  v_accvgpr_write_b32 a81, v21
  v_accvgpr_write_b32 a82, v22
  v_accvgpr_write_b32 a83, v23
  v_accvgpr_read_b32 v20, a84
  v_accvgpr_read_b32 v21, a85
  v_accvgpr_read_b32 v22, a86
  v_accvgpr_read_b32 v23, a87
  v_mul_f32 v20, v20, v19
  v_mul_f32 v21, v21, v19
  v_mul_f32 v22, v22, v19
  v_mul_f32 v23, v23, v19
  v_accvgpr_write_b32 a84, v20
  v_accvgpr_write_b32 a85, v21
  v_accvgpr_write_b32 a86, v22
  v_accvgpr_write_b32 a87, v23
  v_accvgpr_read_b32 v20, a88
  v_accvgpr_read_b32 v21, a89
  v_accvgpr_read_b32 v22, a90
  v_accvgpr_read_b32 v23, a91
  v_mul_f32 v20, v20, v18
  v_mul_f32 v21, v21, v18
  v_mul_f32 v22, v22, v18
  v_mul_f32 v23, v23, v18
  v_accvgpr_write_b32 a88, v20
  v_accvgpr_write_b32 a89, v21
  v_accvgpr_write_b32 a90, v22
  v_accvgpr_write_b32 a91, v23
  v_accvgpr_read_b32 v20, a92
  v_accvgpr_read_b32 v21, a93
  v_accvgpr_read_b32 v22, a94
  v_accvgpr_read_b32 v23, a95
  v_mul_f32 v20, v20, v19
  v_mul_f32 v21, v21, v19
  v_mul_f32 v22, v22, v19
  v_mul_f32 v23, v23, v19
  v_accvgpr_write_b32 a92, v20
  v_accvgpr_write_b32 a93, v21
  v_accvgpr_write_b32 a94, v22
  v_accvgpr_write_b32 a95, v23
  v_accvgpr_read_b32 v20, a96
  v_accvgpr_read_b32 v21, a97
  v_accvgpr_read_b32 v22, a98
  v_accvgpr_read_b32 v23, a99
  v_mul_f32 v20, v20, v18
  v_mul_f32 v21, v21, v18
  v_mul_f32 v22, v22, v18
  v_mul_f32 v23, v23, v18
  v_accvgpr_write_b32 a96, v20
  v_accvgpr_write_b32 a97, v21
  v_accvgpr_write_b32 a98, v22
  v_accvgpr_write_b32 a99, v23
  v_accvgpr_read_b32 v20, a100
  v_accvgpr_read_b32 v21, a101
  v_accvgpr_read_b32 v22, a102
  v_accvgpr_read_b32 v23, a103
  v_mul_f32 v20, v20, v19
  v_mul_f32 v21, v21, v19
  v_mul_f32 v22, v22, v19
  v_mul_f32 v23, v23, v19
  v_accvgpr_write_b32 a100, v20
  v_accvgpr_write_b32 a101, v21
  v_accvgpr_write_b32 a102, v22
  v_accvgpr_write_b32 a103, v23
  v_accvgpr_read_b32 v20, a104
  v_accvgpr_read_b32 v21, a105
  v_accvgpr_read_b32 v22, a106
  v_accvgpr_read_b32 v23, a107
  v_mul_f32 v20, v20, v18
  v_mul_f32 v21, v21, v18
  v_mul_f32 v22, v22, v18
  v_mul_f32 v23, v23, v18
  v_accvgpr_write_b32 a104, v20
  v_accvgpr_write_b32 a105, v21
  v_accvgpr_write_b32 a106, v22
  v_accvgpr_write_b32 a107, v23
  v_accvgpr_read_b32 v20, a108
  v_accvgpr_read_b32 v21, a109
  v_accvgpr_read_b32 v22, a110
  v_accvgpr_read_b32 v23, a111
  v_mul_f32 v20, v20, v19
  v_mul_f32 v21, v21, v19
  v_mul_f32 v22, v22, v19
  v_mul_f32 v23, v23, v19
  v_accvgpr_write_b32 a108, v20
  v_accvgpr_write_b32 a109, v21
  v_accvgpr_write_b32 a110, v22
  v_accvgpr_write_b32 a111, v23
  v_accvgpr_read_b32 v20, a112
  v_accvgpr_read_b32 v21, a113
  v_accvgpr_read_b32 v22, a114
  v_accvgpr_read_b32 v23, a115
  v_mul_f32 v20, v20, v18
  v_mul_f32 v21, v21, v18
  v_mul_f32 v22, v22, v18
  v_mul_f32 v23, v23, v18
  v_accvgpr_write_b32 a112, v20
  v_accvgpr_write_b32 a113, v21
  v_accvgpr_write_b32 a114, v22
  v_accvgpr_write_b32 a115, v23
  v_accvgpr_read_b32 v20, a116
  v_accvgpr_read_b32 v21, a117
  v_accvgpr_read_b32 v22, a118
  v_accvgpr_read_b32 v23, a119
  v_mul_f32 v20, v20, v19
  v_mul_f32 v21, v21, v19
  v_mul_f32 v22, v22, v19
  v_mul_f32 v23, v23, v19
  v_accvgpr_write_b32 a116, v20
  v_accvgpr_write_b32 a117, v21
  v_accvgpr_write_b32 a118, v22
  v_accvgpr_write_b32 a119, v23
  v_accvgpr_read_b32 v20, a120
  v_accvgpr_read_b32 v21, a121
  v_accvgpr_read_b32 v22, a122
  v_accvgpr_read_b32 v23, a123
  v_mul_f32 v20, v20, v18
  v_mul_f32 v21, v21, v18
  v_mul_f32 v22, v22, v18
  v_mul_f32 v23, v23, v18
  v_accvgpr_write_b32 a120, v20
  v_accvgpr_write_b32 a121, v21
  v_accvgpr_write_b32 a122, v22
  v_accvgpr_write_b32 a123, v23
  v_accvgpr_read_b32 v20, a124
  v_accvgpr_read_b32 v21, a125
  v_accvgpr_read_b32 v22, a126
  v_accvgpr_read_b32 v23, a127
  v_mul_f32 v20, v20, v19
  v_mul_f32 v21, v21, v19
  v_mul_f32 v22, v22, v19
  v_mul_f32 v23, v23, v19
  v_accvgpr_write_b32 a124, v20
  v_accvgpr_write_b32 a125, v21
  v_accvgpr_write_b32 a126, v22
  v_accvgpr_write_b32 a127, v23
  s_setpc_b64 s[78:79]
.section .rodata,"a"
.p2align 6
.amdhsa_kernel fa_kernel
  .amdhsa_next_free_vgpr 512
  .amdhsa_next_free_sgpr 102
  .amdhsa_accum_offset 256
  .amdhsa_group_segment_fixed_size 0
  .amdhsa_kernarg_size 112
  .amdhsa_user_sgpr_count 2
  .amdhsa_user_sgpr_kernarg_segment_ptr 1
  .amdhsa_system_sgpr_workgroup_id_x 1
  .amdhsa_float_denorm_mode_32 3
.end_amdhsa_kernel
.text
```

```asm
; @launch kernel=fa_kernel grid=(256,1,1) block=(256,1,1) lds=163840
.amdgcn_target "amdgcn-amd-amdhsa--gfx950"
.text
.globl fa_kernel
.p2align 8
.type fa_kernel,@function
fa_kernel:
  s_cmp_ge_u32 s2, 256
  s_cbranch_scc1 fa_end
  s_getpc_b64 s[62:63]
  v_and_b32 v230, 127, v0
  v_lshlrev_b32 v230, 7, v230
  global_load_dword v231, v230, s[62:63]
  s_load_dwordx4 s[4:7], s[0:1], 0
  s_load_dwordx4 s[8:11], s[0:1], 24
  s_load_dwordx2 s[14:15], s[0:1], 56
  s_load_dwordx2 s[12:13], s[0:1], 40
  s_load_dwordx4 s[16:19], s[0:1], 96
  s_load_dwordx2 s[60:61], s[0:1], 16
  v_lshrrev_b32 v16, 6, v0
  v_and_b32 v1, 63, v0
  v_readfirstlane_b32 s20, v16
  s_and_b32 s21, s2, 7
  s_lshl_b32 s21, s21, 2
  s_lshr_b32 s23, s2, 3
  s_and_b32 s23, s23, 3
  s_add_u32 s21, s21, s23
  s_lshr_b32 s22, s2, 5
  v_and_b32 v208, 31, v1
  v_lshrrev_b32 v209, 5, v1
  s_lshl_b32 s31, s2, 2
  s_add_u32 s31, s31, s20
  s_lshl_b32 s31, s31, 1
  v_add_u32 v209, s31, v209
  v_lshlrev_b32 v212, 4, v208
  v_mul_u32_u24 v210, 1280, v209
  v_add_u32 v210, v210, v212
  v_cmp_gt_u32 s[64:65], 16, v208
  v_mov_b32 v19, 1073741824
  v_and_b32 v220, 7, v209
  v_cndmask_b32 v211, v19, v210, s[64:65]
  v_bfe_u32 v17, v1, 1, 3
  v_lshlrev_b32 v17, 13, v17
  v_and_b32 v18, 1, v1
  v_lshl_add_u32 v235, v18, 7, v17
  s_lshl_b32 s74, s22, 1
  s_and_b32 s31, s20, 1
  s_add_u32 s74, s74, s31
  s_lshl_b32 s74, s74, 16
  s_mov_b32 s73, 1048576
  v_and_b32 v16, 15, v1
  v_lshlrev_b32 v17, 10, v16
  v_and_b32 v18, 16, v1
  v_lshl_add_u32 v233, v18, 3, v17
  s_lshl_b32 s30, s23, 2
  s_add_u32 s30, s30, s20
  s_lshl_b32 s30, s30, 14
  s_lshl_b32 s29, s22, 18
  s_lshl_b32 s23, s21, 8
  s_cmp_ge_u32 s20, 2
  s_waitcnt lgkmcnt(0)
  s_mov_b32 s44, s4
  s_mov_b32 s45, s5
  s_mov_b32 s46, 2621440
  s_mov_b32 s47, 0x20000
  s_mov_b32 s68, s14
  s_mov_b32 s69, s15
  s_mov_b32 s70, 1280
  s_mov_b32 s71, 0x20000
  buffer_load_dwordx4 v[160:163], v210, s[44:47], 0 offen
  buffer_load_dwordx4 v[164:167], v210, s[44:47], 0 offen offset:512
  buffer_load_dwordx4 v[168:171], v211, s[44:47], 0 offen offset:1024
  buffer_load_dwordx4 v[172:175], v212, s[68:71], 0 offen offset:0
  buffer_load_dwordx4 v[176:179], v212, s[68:71], 0 offen offset:512
  buffer_load_dwordx4 v[180:183], v212, s[68:71], 0 offen offset:1024
  s_cselect_b32 s62, s10, s8
  s_cselect_b32 s63, s11, s9
  s_add_u32 s62, s62, s23
  s_addc_u32 s63, s63, 0
  s_mov_b32 s36, s62
  s_mov_b32 s37, s63
  s_mov_b32 s38, 0
  s_mov_b32 s39, 0x20000
  s_sub_u32 s38, 4194304, s23
  buffer_load_dword v231, v235, s[36:39], s74 offen
  s_add_u32 s6, s6, s29
  s_addc_u32 s7, s7, 0
  s_mov_b32 s32, s6
  s_mov_b32 s33, s7
  s_mov_b32 s34, 262144
  s_mov_b32 s35, 0x20000
  buffer_load_dword v232, v233, s[32:35], s30 offen
  s_add_u32 s74, s74, s73
  buffer_load_dword v231, v235, s[36:39], s74 offen
  buffer_load_dword v232, v233, s[32:35], s30 offen offset:256
  s_getpc_b64 s[8:9]
fa_pc:
  s_lshr_b32 s31, s2, 3
  s_and_b32 s31, s31, 15
  s_lshl_b32 s31, s31, 2
  s_add_u32 s31, s31, s20
  s_lshl_b32 s31, s31, 11
  s_min_u32 s31, s31, fa_codeend-fa_pc-2048
  v_lshlrev_b32 v234, 7, v16
  v_add_u32 v230, s31, v234
  global_load_dword v231, v230, s[8:9]
  s_add_u32 s8, s8, fa_co1-fa_pc-4
  s_addc_u32 s9, s9, 0
  s_add_u32 s60, s60, s23
  s_addc_u32 s61, s61, 0
  s_sub_u32 s75, 5242880, s23
  s_mov_b32 s48, s62
  s_mov_b32 s49, s63
  s_mov_b32 s50, s38
  s_mov_b32 s51, 0x20000
  v_lshlrev_b32 v2, 4, v1
  v_lshrrev_b32 v19, 2, v1
  v_lshrrev_b32 v17, 5, v1
  v_mul_u32_u24 v17, 3, v17
  v_and_b32 v18, 3, v1
  v_xor_b32 v17, v17, v18
  v_lshlrev_b32 v17, 4, v17
  v_lshl_add_u32 v3, v19, 10, v17
  s_lshl_b32 s23, s20, 16
  v_add_u32 v3, s23, v3
  v_add_u32 v4, 15360, v3
  v_add_u32 v5, 30720, v3
  v_add_u32 v6, 46080, v3
  v_and_b32 v19, 3, v19
  v_lshrrev_b32 v17, 4, v1
  v_lshlrev_b32 v17, 6, v17
  v_lshl_add_u32 v19, v19, 13, v17
  s_and_b32 s23, s20, 1
  s_lshl_b32 s23, s23, 17
  v_add_u32 v19, s23, v19
  v_lshl_add_u32 v8, v18, 4, v19
  v_xor_b32 v18, 2, v18
  v_lshl_add_u32 v10, v18, 4, v19
  v_add_u32 v9, 31744, v8
  v_add_u32 v11, 95232, v10
  v_add_u32 v10, 63488, v10
  s_lshl_b32 s24, s20, 12
  s_mov_b32 s26, 0
  s_mov_b32 s27, 0
  s_mov_b32 s25, 262144
  s_mov_b32 s79, 64
  s_mov_b32 s40, s18
  s_mov_b32 s41, s19
  s_mov_b32 s42, 67108864
  s_mov_b32 s43, 0x20000
  s_mov_b32 s52, s12
  s_mov_b32 s53, s13
  s_mov_b32 s54, 5242880
  s_mov_b32 s55, 0x20000
  s_mov_b32 s56, s16
  s_mov_b32 s57, s17
  s_mov_b32 s58, 256
  s_mov_b32 s59, 0x20000
  s_and_b32 s29, s2, 31
  s_lshl_b32 s29, s29, 2
  s_add_u32 s29, s29, s20
  s_lshl_b32 s29, s29, 11
  s_lshl_b32 s23, s20, 5
  s_add_u32 s23, s23, s21
  s_lshl_b32 s23, s23, 2
  s_add_u32 s23, s23, 2641920
  s_lshl_b32 s31, s22, 9
  s_add_u32 s80, s23, s31
  s_sub_u32 s31, 7680, s31
  s_add_u32 s3, s23, s31
  s_lshl_b32 s23, s21, 7
  s_lshl_b32 s31, s22, 2
  s_add_u32 s23, s23, s31
  s_add_u32 s82, s23, 2637824
  s_sub_u32 s62, s2, 170
  s_lshl_b32 s31, s20, 6
  s_add_u32 s62, s62, s31
  s_lshl_b32 s62, s62, 2
  s_add_u32 s62, s62, 2650112
  s_sub_u32 s23, s2, 170
  s_cmp_lt_u32 s23, 54
  s_cselect_b32 s62, s62, 1073741824
  s_cmp_eq_u32 s20, 0
  s_cselect_b32 s31, s82, 1073741824
  s_cselect_b32 s77, s2, 1073741824
  s_cmp_eq_u32 s2, 255
  s_cselect_b32 s23, 2629632, 1073741824
  v_lshl_add_u32 v225, v16, 2, s23
  v_mov_b32 v229, 0
  v_writelane_b32 v225, s80, 0
  v_writelane_b32 v225, s3, 1
  v_writelane_b32 v225, s31, 2
  s_and_b32 s23, s2, 1
  s_lshl_b32 s23, s23, 2
  s_add_u32 s23, s23, s20
  s_lshl_b32 s23, s23, 7
  s_lshr_b32 s31, s2, 1
  s_add_u32 s23, s23, s31
  s_lshl_b32 s23, s23, 2
  s_add_u32 s23, s23, 2654208
  v_writelane_b32 v225, s23, 3
  v_writelane_b32 v225, s62, 4
  s_and_b32 s23, s21, 3
  s_lshr_b32 s31, s23, 1
  s_lshl_b32 s31, 4, s31
  s_bitcmp1_b32 s23, 0
  s_cselect_b32 s76, s31, 0
  s_cselect_b32 s72, 0, s31
  s_or_b32 s76, s76, 0x20
  s_or_b32 s72, s72, 0x25
  v_mov_b32 v20, 0
  v_mov_b32 v21, 0
  v_mov_b32 v22, 0
  v_mov_b32 v23, 0
  v_lshrrev_b32 v17, 4, v1
  v_lshrrev_b32 v18, 3, v16
  v_mul_u32_u24 v18, 3, v18
  v_xor_b32 v18, v18, v17
  v_lshlrev_b32 v18, 4, v18
  v_lshl_add_u32 v14, v16, 6, v18
  s_and_b32 s23, s20, 1
  s_lshl_b32 s23, s23, 13
  v_add_u32 v14, s23, v14
  v_mfma_f32_32x32x16_bf16 a[0:15], v[20:23], v[20:23], 0
  v_lshrrev_b32 v18, 2, v16
  v_lshlrev_b32 v18, 6, v18
  v_lshl_add_u32 v18, v17, 11, v18
  v_and_b32 v19, 1, v1
  v_mfma_f32_32x32x16_bf16 a[16:31], v[20:23], v[20:23], 0
  v_lshl_add_u32 v18, v19, 3, v18
  v_bfe_u32 v19, v1, 1, 1
  v_and_b32 v17, 1, v17
  v_lshl_or_b32 v19, v17, 1, v19
  v_mfma_f32_32x32x16_bf16 a[32:47], v[20:23], v[20:23], 0
  s_lshr_b32 s23, s20, 1
  s_lshl_b32 s23, s23, 13
  s_add_u32 s23, s23, 16384
  v_add_u32 v18, s23, v18
  v_mfma_f32_32x32x16_bf16 a[48:63], v[20:23], v[20:23], 0
  v_lshl_add_u32 v12, v19, 4, v18
  v_xor_b32 v13, 32, v12
  v_mov_b32 v19, 1073741824
  v_lshlrev_b32 v220, 4, v220
  v_mfma_f32_32x32x16_bf16 a[64:79], v[20:23], v[20:23], 0
  v_lshl_add_u32 v220, v208, 7, v220
  v_add_u32 v220, 131072, v220
  v_lshlrev_b32 v222, 2, v209
  v_cmp_eq_u32 vcc, 0, v208
  v_mfma_f32_32x32x16_bf16 a[80:95], v[20:23], v[20:23], 0
  v_add_u32 v222, 2621440, v222
  v_lshlrev_b32 v221, 4, v0
  v_cndmask_b32 v222, v19, v222, vcc
  v_add_u32 v221, 131072, v221
  v_mfma_f32_32x32x16_bf16 a[96:111], v[20:23], v[20:23], 0
  v_sub_u32 v209, 0xffff, v209
  v_lshrrev_b32 v223, 3, v0
  v_and_b32 v18, 7, v0
  v_lshlrev_b32 v18, 4, v18
  v_mfma_f32_32x32x16_bf16 a[112:127], v[20:23], v[20:23], 0
  v_cmp_gt_u32 vcc, 128, v0
  v_lshl_add_u32 v223, v223, 8, v18
  s_lshr_b32 s66, s2, 1
  s_mul_i32 s66, s66, 20480
  v_mfma_f32_32x32x16_bf16 a[128:143], v[20:23], v[20:23], 0
  s_and_b32 s31, s2, 1
  s_lshl_b32 s31, s31, 7
  s_add_u32 s66, s66, s31
  v_cndmask_b32 v224, v19, v223, vcc
  v_mfma_f32_32x32x16_bf16 a[144:159], v[20:23], v[20:23], 0
  s_add_u32 s67, s66, 8192
  s_add_u32 s78, s66, 16384
  s_mov_b32 s28, 0
  v_mfma_f32_32x32x16_bf16 a[160:175], v[20:23], v[20:23], 0
  v_mfma_f32_32x32x16_bf16 a[176:191], v[20:23], v[20:23], 0
  v_mfma_f32_32x32x16_bf16 a[192:207], v[20:23], v[20:23], 0
  v_mfma_f32_32x32x16_bf16 a[208:223], v[20:23], v[20:23], 0
  v_mfma_f32_32x32x16_bf16 a[224:239], v[20:23], v[20:23], 0
  v_mfma_f32_32x32x16_bf16 a[240:255], v[20:23], v[20:23], 0
  s_waitcnt vmcnt(5)
  v_lshlrev_b32 v184, 16, v160
  v_and_b32 v185, 0xffff0000, v160
  v_lshlrev_b32 v186, 16, v161
  v_and_b32 v187, 0xffff0000, v161
  v_lshlrev_b32 v188, 16, v162
  v_and_b32 v189, 0xffff0000, v162
  v_lshlrev_b32 v190, 16, v163
  v_and_b32 v191, 0xffff0000, v163
  v_lshlrev_b32 v192, 16, v164
  v_and_b32 v193, 0xffff0000, v164
  v_lshlrev_b32 v194, 16, v165
  v_and_b32 v195, 0xffff0000, v165
  v_lshlrev_b32 v196, 16, v166
  v_and_b32 v197, 0xffff0000, v166
  v_lshlrev_b32 v198, 16, v167
  v_and_b32 v199, 0xffff0000, v167
  v_lshlrev_b32 v200, 16, v168
  v_and_b32 v201, 0xffff0000, v168
  v_lshlrev_b32 v202, 16, v169
  v_and_b32 v203, 0xffff0000, v169
  v_lshlrev_b32 v204, 16, v170
  v_and_b32 v205, 0xffff0000, v170
  v_lshlrev_b32 v206, 16, v171
  v_and_b32 v207, 0xffff0000, v171
  v_pk_add_f32 v[16:17], v[184:185], v[186:187]
  v_pk_add_f32 v[18:19], v[188:189], v[190:191]
  v_pk_add_f32 v[16:17], v[16:17], v[192:193]
  v_pk_add_f32 v[18:19], v[18:19], v[194:195]
  v_pk_add_f32 v[16:17], v[16:17], v[196:197]
  v_pk_add_f32 v[18:19], v[18:19], v[198:199]
  v_pk_add_f32 v[16:17], v[16:17], v[200:201]
  v_pk_add_f32 v[18:19], v[18:19], v[202:203]
  v_pk_add_f32 v[16:17], v[16:17], v[204:205]
  v_pk_add_f32 v[18:19], v[18:19], v[206:207]
  v_pk_add_f32 v[16:17], v[16:17], v[18:19]
  v_add_f32 v213, v16, v17
  s_nop 1
  v_add_f32_dpp v213, v213, v213 quad_perm:[1,0,3,2] row_mask:0xf bank_mask:0xf
  s_nop 1
  v_add_f32_dpp v213, v213, v213 quad_perm:[2,3,0,1] row_mask:0xf bank_mask:0xf
  s_nop 1
  v_add_f32_dpp v213, v213, v213 row_half_mirror row_mask:0xf bank_mask:0xf
  s_nop 1
  v_add_f32_dpp v213, v213, v213 row_mirror row_mask:0xf bank_mask:0xf
  v_mov_b32 v214, v213
  s_nop 1
  v_permlane16_swap_b32 v213, v214
  v_add_f32 v213, v213, v214
  v_mul_f32 v216, 0xbacccccd, v213
  v_mul_f32 v217, 0xbacccccd, v213
  v_pk_add_f32 v[20:21], v[184:185], v[216:217]
  v_pk_mul_f32 v[16:17], v[20:21], v[20:21]
  v_pk_add_f32 v[22:23], v[186:187], v[216:217]
  v_pk_fma_f32 v[16:17], v[22:23], v[22:23], v[16:17]
  v_pk_add_f32 v[24:25], v[188:189], v[216:217]
  v_pk_fma_f32 v[16:17], v[24:25], v[24:25], v[16:17]
  v_pk_add_f32 v[26:27], v[190:191], v[216:217]
  v_pk_fma_f32 v[16:17], v[26:27], v[26:27], v[16:17]
  v_pk_add_f32 v[20:21], v[192:193], v[216:217]
  v_pk_fma_f32 v[16:17], v[20:21], v[20:21], v[16:17]
  v_pk_add_f32 v[22:23], v[194:195], v[216:217]
  v_pk_fma_f32 v[16:17], v[22:23], v[22:23], v[16:17]
  v_pk_add_f32 v[24:25], v[196:197], v[216:217]
  v_pk_fma_f32 v[16:17], v[24:25], v[24:25], v[16:17]
  v_pk_add_f32 v[26:27], v[198:199], v[216:217]
  v_pk_fma_f32 v[16:17], v[26:27], v[26:27], v[16:17]
  v_pk_add_f32 v[20:21], v[200:201], v[216:217]
  v_pk_mul_f32 v[18:19], v[20:21], v[20:21]
  v_pk_add_f32 v[22:23], v[202:203], v[216:217]
  v_pk_fma_f32 v[18:19], v[22:23], v[22:23], v[18:19]
  v_pk_add_f32 v[24:25], v[204:205], v[216:217]
  v_pk_fma_f32 v[18:19], v[24:25], v[24:25], v[18:19]
  v_pk_add_f32 v[26:27], v[206:207], v[216:217]
  v_pk_fma_f32 v[18:19], v[26:27], v[26:27], v[18:19]
  v_add_f32 v18, v18, v19
  v_add_f32 v213, v16, v17
  v_cndmask_b32 v18, 0, v18, s[64:65]
  v_add_f32 v213, v213, v18
  s_nop 1
  v_add_f32_dpp v213, v213, v213 quad_perm:[1,0,3,2] row_mask:0xf bank_mask:0xf
  s_nop 1
  v_add_f32_dpp v213, v213, v213 quad_perm:[2,3,0,1] row_mask:0xf bank_mask:0xf
  s_nop 1
  v_add_f32_dpp v213, v213, v213 row_half_mirror row_mask:0xf bank_mask:0xf
  s_nop 1
  v_add_f32_dpp v213, v213, v213 row_mirror row_mask:0xf bank_mask:0xf
  v_mov_b32 v214, v213
  s_nop 1
  v_permlane16_swap_b32 v213, v214
  v_add_f32 v213, v213, v214
  v_mul_f32 v213, 0x3acccccd, v213
  v_cvt_pk_bf16_f32 v213, v213, v213
  v_and_b32 v213, 0xffff0000, v213
  v_add_f32 v213, 0x3727c5ac, v213
  v_cvt_pk_bf16_f32 v213, v213, v213
  v_and_b32 v213, 0xffff0000, v213
  v_sqrt_f32 v213, v213
  v_cvt_pk_bf16_f32 v216, v216, v216
  v_and_b32 v216, 0xffff0000, v216
  v_cvt_pk_bf16_f32 v213, v213, v213
  v_and_b32 v213, 0xffff0000, v213
  v_rcp_f32 v28, v213
  v_mov_b32 v217, v216
  v_mov_b32 v29, v28
  v_pk_add_f32 v[184:185], v[184:185], v[216:217]
  v_lshlrev_b32 v16, 16, v172
  v_cvt_pk_bf16_f32 v185, v184, v185
  v_and_b32 v17, 0xffff0000, v172
  v_lshlrev_b32 v184, 16, v185
  v_and_b32 v185, 0xffff0000, v185
  v_pk_mul_f32 v[184:185], v[184:185], v[28:29]
  v_cvt_pk_bf16_f32 v160, v184, v185
  v_lshlrev_b32 v184, 16, v160
  v_and_b32 v185, 0xffff0000, v160
  v_pk_mul_f32 v[218:219], v[184:185], v[16:17]
  v_pk_add_f32 v[186:187], v[186:187], v[216:217]
  v_lshlrev_b32 v18, 16, v173
  v_cvt_pk_bf16_f32 v187, v186, v187
  v_and_b32 v19, 0xffff0000, v173
  v_lshlrev_b32 v186, 16, v187
  v_and_b32 v187, 0xffff0000, v187
  v_pk_mul_f32 v[186:187], v[186:187], v[28:29]
  v_cvt_pk_bf16_f32 v161, v186, v187
  v_lshlrev_b32 v186, 16, v161
  v_and_b32 v187, 0xffff0000, v161
  v_pk_fma_f32 v[218:219], v[186:187], v[18:19], v[218:219]
  v_pk_add_f32 v[188:189], v[188:189], v[216:217]
  v_lshlrev_b32 v16, 16, v174
  v_cvt_pk_bf16_f32 v189, v188, v189
  v_and_b32 v17, 0xffff0000, v174
  v_lshlrev_b32 v188, 16, v189
  v_and_b32 v189, 0xffff0000, v189
  v_pk_mul_f32 v[188:189], v[188:189], v[28:29]
  v_cvt_pk_bf16_f32 v162, v188, v189
  v_lshlrev_b32 v188, 16, v162
  v_and_b32 v189, 0xffff0000, v162
  v_pk_fma_f32 v[218:219], v[188:189], v[16:17], v[218:219]
  v_pk_add_f32 v[190:191], v[190:191], v[216:217]
  v_lshlrev_b32 v18, 16, v175
  v_cvt_pk_bf16_f32 v191, v190, v191
  v_and_b32 v19, 0xffff0000, v175
  v_lshlrev_b32 v190, 16, v191
  v_and_b32 v191, 0xffff0000, v191
  v_pk_mul_f32 v[190:191], v[190:191], v[28:29]
  v_cvt_pk_bf16_f32 v163, v190, v191
  v_lshlrev_b32 v190, 16, v163
  v_and_b32 v191, 0xffff0000, v163
  v_pk_fma_f32 v[218:219], v[190:191], v[18:19], v[218:219]
  ds_write_b128 v220, v[160:163] offset:0
  v_pk_add_f32 v[192:193], v[192:193], v[216:217]
  v_lshlrev_b32 v16, 16, v176
  v_cvt_pk_bf16_f32 v193, v192, v193
  v_and_b32 v17, 0xffff0000, v176
  v_lshlrev_b32 v192, 16, v193
  v_and_b32 v193, 0xffff0000, v193
  v_pk_mul_f32 v[192:193], v[192:193], v[28:29]
  v_cvt_pk_bf16_f32 v164, v192, v193
  v_lshlrev_b32 v192, 16, v164
  v_and_b32 v193, 0xffff0000, v164
  v_pk_fma_f32 v[218:219], v[192:193], v[16:17], v[218:219]
  v_pk_add_f32 v[194:195], v[194:195], v[216:217]
  v_lshlrev_b32 v18, 16, v177
  v_cvt_pk_bf16_f32 v195, v194, v195
  v_and_b32 v19, 0xffff0000, v177
  v_lshlrev_b32 v194, 16, v195
  v_and_b32 v195, 0xffff0000, v195
  v_pk_mul_f32 v[194:195], v[194:195], v[28:29]
  v_cvt_pk_bf16_f32 v165, v194, v195
  v_lshlrev_b32 v194, 16, v165
  v_and_b32 v195, 0xffff0000, v165
  v_pk_fma_f32 v[218:219], v[194:195], v[18:19], v[218:219]
  v_pk_add_f32 v[196:197], v[196:197], v[216:217]
  v_lshlrev_b32 v16, 16, v178
  v_cvt_pk_bf16_f32 v197, v196, v197
  v_and_b32 v17, 0xffff0000, v178
  v_lshlrev_b32 v196, 16, v197
  v_and_b32 v197, 0xffff0000, v197
  v_pk_mul_f32 v[196:197], v[196:197], v[28:29]
  v_cvt_pk_bf16_f32 v166, v196, v197
  v_lshlrev_b32 v196, 16, v166
  v_and_b32 v197, 0xffff0000, v166
  v_pk_fma_f32 v[218:219], v[196:197], v[16:17], v[218:219]
  v_pk_add_f32 v[198:199], v[198:199], v[216:217]
  v_lshlrev_b32 v18, 16, v179
  v_cvt_pk_bf16_f32 v199, v198, v199
  v_and_b32 v19, 0xffff0000, v179
  v_lshlrev_b32 v198, 16, v199
  v_and_b32 v199, 0xffff0000, v199
  v_pk_mul_f32 v[198:199], v[198:199], v[28:29]
  v_cvt_pk_bf16_f32 v167, v198, v199
  v_lshlrev_b32 v198, 16, v167
  v_and_b32 v199, 0xffff0000, v167
  v_pk_fma_f32 v[218:219], v[198:199], v[18:19], v[218:219]
  ds_write_b128 v220, v[164:167] offset:4096
  v_pk_add_f32 v[200:201], v[200:201], v[216:217]
  v_lshlrev_b32 v16, 16, v180
  v_cvt_pk_bf16_f32 v201, v200, v201
  v_and_b32 v17, 0xffff0000, v180
  v_lshlrev_b32 v200, 16, v201
  v_and_b32 v201, 0xffff0000, v201
  v_pk_mul_f32 v[200:201], v[200:201], v[28:29]
  v_cvt_pk_bf16_f32 v168, v200, v201
  v_lshlrev_b32 v200, 16, v168
  v_and_b32 v201, 0xffff0000, v168
  v_pk_fma_f32 v[218:219], v[200:201], v[16:17], v[218:219]
  v_pk_add_f32 v[202:203], v[202:203], v[216:217]
  v_lshlrev_b32 v18, 16, v181
  v_cvt_pk_bf16_f32 v203, v202, v203
  v_and_b32 v19, 0xffff0000, v181
  v_lshlrev_b32 v202, 16, v203
  v_and_b32 v203, 0xffff0000, v203
  v_pk_mul_f32 v[202:203], v[202:203], v[28:29]
  v_cvt_pk_bf16_f32 v169, v202, v203
  v_lshlrev_b32 v202, 16, v169
  v_and_b32 v203, 0xffff0000, v169
  v_pk_fma_f32 v[218:219], v[202:203], v[18:19], v[218:219]
  v_pk_add_f32 v[204:205], v[204:205], v[216:217]
  v_lshlrev_b32 v16, 16, v182
  v_cvt_pk_bf16_f32 v205, v204, v205
  v_and_b32 v17, 0xffff0000, v182
  v_lshlrev_b32 v204, 16, v205
  v_and_b32 v205, 0xffff0000, v205
  v_pk_mul_f32 v[204:205], v[204:205], v[28:29]
  v_cvt_pk_bf16_f32 v170, v204, v205
  v_lshlrev_b32 v204, 16, v170
  v_and_b32 v205, 0xffff0000, v170
  v_pk_fma_f32 v[218:219], v[204:205], v[16:17], v[218:219]
  v_pk_add_f32 v[206:207], v[206:207], v[216:217]
  v_lshlrev_b32 v18, 16, v183
  v_cvt_pk_bf16_f32 v207, v206, v207
  v_and_b32 v19, 0xffff0000, v183
  v_lshlrev_b32 v206, 16, v207
  v_and_b32 v207, 0xffff0000, v207
  v_pk_mul_f32 v[206:207], v[206:207], v[28:29]
  v_cvt_pk_bf16_f32 v171, v206, v207
  v_lshlrev_b32 v206, 16, v171
  v_and_b32 v207, 0xffff0000, v171
  v_pk_fma_f32 v[218:219], v[206:207], v[18:19], v[218:219]
  ds_write_b128 v220, v[168:171] offset:8192
  v_add_f32 v218, v218, v219
  s_nop 1
  v_add_f32_dpp v218, v218, v218 quad_perm:[1,0,3,2] row_mask:0xf bank_mask:0xf
  s_nop 1
  v_add_f32_dpp v218, v218, v218 quad_perm:[2,3,0,1] row_mask:0xf bank_mask:0xf
  s_nop 1
  v_add_f32_dpp v218, v218, v218 row_half_mirror row_mask:0xf bank_mask:0xf
  s_nop 1
  v_add_f32_dpp v218, v218, v218 row_mirror row_mask:0xf bank_mask:0xf
  v_mov_b32 v214, v218
  s_nop 1
  v_permlane16_swap_b32 v218, v214
  v_add_f32 v218, v218, v214
  v_cvt_pk_bf16_f32 v218, v218, v218
  v_and_b32 v218, 0xffff0000, v218
  v_ashrrev_i32 v214, 31, v218
  v_or_b32 v214, 0x80000000, v214
  v_xor_b32 v218, v218, v214
  v_and_b32 v218, 0xffff0000, v218
  v_or_b32 v218, v218, v209
  v_mov_b32 v19, 1073741824
  s_mov_b32 m0, s24
  s_nop 0
  buffer_load_dwordx4 v3, s[32:35], s26 offen offset:0 sc1 lds
  buffer_load_dwordx4 v4, s[32:35], s26 offen offset:1024 sc1 lds
  buffer_load_dwordx4 v5, s[32:35], s26 offen offset:2048 sc1 lds
  buffer_load_dwordx4 v6, s[32:35], s26 offen offset:3072 sc1 lds
  s_add_u32 m0, s24, 16384
  s_nop 0
  buffer_load_dwordx4 v8, s[36:39], s27 offen offset:0 lds
  buffer_load_dwordx4 v9, s[36:39], s27 offen offset:1024 lds
  buffer_load_dwordx4 v10, s[36:39], s27 offen offset:2048 lds
  buffer_load_dwordx4 v11, s[36:39], s27 offen offset:3072 lds
  s_add_u32 s26, s26, s79
  s_add_u32 s27, s27, s25
  s_add_u32 s24, s24, 32768
  s_and_b32 s24, s24, 0x1ffff
  s_mov_b32 m0, s24
  s_nop 0
  buffer_load_dwordx4 v3, s[32:35], s26 offen offset:0 sc1 lds
  buffer_load_dwordx4 v4, s[32:35], s26 offen offset:1024 sc1 lds
  buffer_load_dwordx4 v5, s[32:35], s26 offen offset:2048 sc1 lds
  buffer_load_dwordx4 v6, s[32:35], s26 offen offset:3072 sc1 lds
  s_add_u32 m0, s24, 16384
  s_nop 0
  buffer_load_dwordx4 v8, s[36:39], s27 offen offset:0 lds
  buffer_load_dwordx4 v9, s[36:39], s27 offen offset:1024 lds
  buffer_load_dwordx4 v10, s[36:39], s27 offen offset:2048 lds
  buffer_load_dwordx4 v11, s[36:39], s27 offen offset:3072 lds
  s_add_u32 s26, s26, s79
  s_add_u32 s27, s27, s25
  s_add_u32 s24, s24, 32768
  s_and_b32 s24, s24, 0x1ffff
  s_mov_b32 m0, s24
  s_nop 0
  buffer_load_dwordx4 v3, s[32:35], s26 offen offset:0 sc1 lds
  buffer_load_dwordx4 v4, s[32:35], s26 offen offset:1024 sc1 lds
  buffer_load_dwordx4 v5, s[32:35], s26 offen offset:2048 sc1 lds
  buffer_load_dwordx4 v6, s[32:35], s26 offen offset:3072 sc1 lds
  s_add_u32 m0, s24, 16384
  s_nop 0
  buffer_load_dwordx4 v8, s[36:39], s27 offen offset:0 lds
  buffer_load_dwordx4 v9, s[36:39], s27 offen offset:1024 lds
  buffer_load_dwordx4 v10, s[36:39], s27 offen offset:2048 lds
  buffer_load_dwordx4 v11, s[36:39], s27 offen offset:3072 lds
  s_add_u32 s26, s26, s79
  s_add_u32 s27, s27, s25
  s_add_u32 s24, s24, 32768
  s_and_b32 s24, s24, 0x1ffff
  buffer_load_dword v231, v19, s[32:35], 0 offen
  s_mov_b32 m0, s24
  s_nop 0
  buffer_load_dwordx4 v3, s[32:35], s26 offen offset:0 sc1 lds
  buffer_load_dwordx4 v4, s[32:35], s26 offen offset:1024 sc1 lds
  buffer_load_dwordx4 v5, s[32:35], s26 offen offset:2048 sc1 lds
  buffer_load_dwordx4 v6, s[32:35], s26 offen offset:3072 sc1 lds
  s_add_u32 m0, s24, 16384
  s_nop 0
  buffer_load_dwordx4 v8, s[36:39], s27 offen offset:0 lds
  buffer_load_dwordx4 v9, s[36:39], s27 offen offset:1024 lds
  buffer_load_dwordx4 v10, s[36:39], s27 offen offset:2048 lds
  buffer_load_dwordx4 v11, s[36:39], s27 offen offset:3072 lds
  s_add_u32 s26, s26, s79
  s_add_u32 s27, s27, s25
  s_add_u32 s24, s24, 32768
  s_and_b32 s24, s24, 0x1ffff
  s_waitcnt vmcnt(25) lgkmcnt(0)
  s_barrier
  s_cmp_ge_u32 s20, 2
  s_cbranch_scc1 fa_roleV
  ds_read_b128 v[96:99], v14 offset:0
  ds_read_b128 v[100:103], v14 offset:1024
  ds_read_b128 v[104:107], v14 offset:2048
  ds_read_b128 v[108:111], v14 offset:3072
  ds_read_b128 v[112:115], v14 offset:4096
  ds_read_b128 v[116:119], v14 offset:5120
  ds_read_b128 v[120:123], v14 offset:6144
  ds_read_b128 v[124:127], v14 offset:7168
  ds_read_b64_tr_b16 v[32:33], v12 offset:0
  ds_read_b64_tr_b16 v[34:35], v12 offset:1024
  ds_read_b64_tr_b16 v[36:37], v13 offset:0
  ds_read_b64_tr_b16 v[38:39], v13 offset:1024
  ds_read_b64_tr_b16 v[40:41], v12 offset:256
  ds_read_b64_tr_b16 v[42:43], v12 offset:1280
  ds_read_b64_tr_b16 v[44:45], v13 offset:256
  ds_read_b64_tr_b16 v[46:47], v13 offset:1280
  ds_read_b64_tr_b16 v[48:49], v12 offset:512
  ds_read_b64_tr_b16 v[50:51], v12 offset:1536
  ds_read_b64_tr_b16 v[52:53], v13 offset:512
  ds_read_b64_tr_b16 v[54:55], v13 offset:1536
  ds_read_b64_tr_b16 v[56:57], v12 offset:768
  ds_read_b64_tr_b16 v[58:59], v12 offset:1792
  ds_read_b64_tr_b16 v[60:61], v13 offset:768
  ds_read_b64_tr_b16 v[62:63], v13 offset:1792
  s_waitcnt lgkmcnt(0)
.p2align 6
fa_loopK:
  v_mfma_f32_16x16x32_bf16 a[0:3], v[32:35], v[96:99], a[0:3]
  s_waitcnt vmcnt(17)
  v_mfma_f32_16x16x32_bf16 a[4:7], v[32:35], v[100:103], a[4:7]
  s_barrier
  v_mfma_f32_16x16x32_bf16 a[8:11], v[32:35], v[104:107], a[8:11]
  ds_read_b64_tr_b16 v[64:65], v12 offset:32768
  v_mfma_f32_16x16x32_bf16 a[12:15], v[32:35], v[108:111], a[12:15]
  v_mfma_f32_16x16x32_bf16 a[16:19], v[32:35], v[112:115], a[16:19]
  s_mov_b32 m0, s24
  ds_read_b64_tr_b16 v[66:67], v12 offset:33792
  v_mfma_f32_16x16x32_bf16 a[20:23], v[32:35], v[116:119], a[20:23]
  buffer_load_dwordx4 v3, s[32:35], s26 offen offset:0 sc1 lds
  v_mfma_f32_16x16x32_bf16 a[24:27], v[32:35], v[120:123], a[24:27]
  ds_read_b128 v[128:131], v14 offset:32768
  v_mfma_f32_16x16x32_bf16 a[28:31], v[32:35], v[124:127], a[28:31]
  buffer_load_dwordx4 v4, s[32:35], s26 offen offset:1024 sc1 lds
  v_mfma_f32_16x16x32_bf16 a[32:35], v[36:39], v[96:99], a[32:35]
  ds_read_b64_tr_b16 v[68:69], v13 offset:32768
  v_mfma_f32_16x16x32_bf16 a[36:39], v[36:39], v[100:103], a[36:39]
  buffer_load_dwordx4 v5, s[32:35], s26 offen offset:2048 sc1 lds
  v_mfma_f32_16x16x32_bf16 a[40:43], v[36:39], v[104:107], a[40:43]
  ds_read_b64_tr_b16 v[70:71], v13 offset:33792
  v_mfma_f32_16x16x32_bf16 a[44:47], v[36:39], v[108:111], a[44:47]
  buffer_load_dwordx4 v6, s[32:35], s26 offen offset:3072 sc1 lds
  v_mfma_f32_16x16x32_bf16 a[48:51], v[36:39], v[112:115], a[48:51]
  s_add_u32 m0, s24, 16384
  ds_read_b128 v[132:135], v14 offset:33792
  v_mfma_f32_16x16x32_bf16 a[52:55], v[36:39], v[116:119], a[52:55]
  buffer_load_dwordx4 v8, s[36:39], s27 offen offset:0 lds
  v_mfma_f32_16x16x32_bf16 a[56:59], v[36:39], v[120:123], a[56:59]
  ds_read_b64_tr_b16 v[72:73], v12 offset:33024
  v_mfma_f32_16x16x32_bf16 a[60:63], v[36:39], v[124:127], a[60:63]
  buffer_load_dwordx4 v9, s[36:39], s27 offen offset:1024 lds
  v_mfma_f32_16x16x32_bf16 a[64:67], v[40:43], v[96:99], a[64:67]
  ds_read_b64_tr_b16 v[74:75], v12 offset:34048
  v_mfma_f32_16x16x32_bf16 a[68:71], v[40:43], v[100:103], a[68:71]
  buffer_load_dwordx4 v10, s[36:39], s27 offen offset:2048 lds
  v_mfma_f32_16x16x32_bf16 a[72:75], v[40:43], v[104:107], a[72:75]
  ds_read_b128 v[136:139], v14 offset:34816
  v_mfma_f32_16x16x32_bf16 a[76:79], v[40:43], v[108:111], a[76:79]
  buffer_load_dwordx4 v11, s[36:39], s27 offen offset:3072 lds
  v_mfma_f32_16x16x32_bf16 a[80:83], v[40:43], v[112:115], a[80:83]
  ds_read_b64_tr_b16 v[76:77], v13 offset:33024
  v_mfma_f32_16x16x32_bf16 a[84:87], v[40:43], v[116:119], a[84:87]
  buffer_load_dword v231, v235, s[48:51], s74 offen sc1
  v_mfma_f32_16x16x32_bf16 a[88:91], v[40:43], v[120:123], a[88:91]
  s_add_u32 s74, s74, s73
  ds_read_b64_tr_b16 v[78:79], v13 offset:34048
  v_mfma_f32_16x16x32_bf16 a[92:95], v[40:43], v[124:127], a[92:95]
  s_bitcmp1_b32 s72, s28
  v_mfma_f32_16x16x32_bf16 a[96:99], v[44:47], v[96:99], a[96:99]
  s_cbranch_scc1 fa_hk0
fa_hb0:
  ds_read_b128 v[140:143], v14 offset:35840
  v_mfma_f32_16x16x32_bf16 a[100:103], v[44:47], v[100:103], a[100:103]
  v_mfma_f32_16x16x32_bf16 a[104:107], v[44:47], v[104:107], a[104:107]
  ds_read_b64_tr_b16 v[80:81], v12 offset:33280
  v_mfma_f32_16x16x32_bf16 a[108:111], v[44:47], v[108:111], a[108:111]
  v_mfma_f32_16x16x32_bf16 a[112:115], v[44:47], v[112:115], a[112:115]
  ds_read_b64_tr_b16 v[82:83], v12 offset:34304
  v_mfma_f32_16x16x32_bf16 a[116:119], v[44:47], v[116:119], a[116:119]
  v_mfma_f32_16x16x32_bf16 a[120:123], v[44:47], v[120:123], a[120:123]
  ds_read_b128 v[144:147], v14 offset:36864
  v_mfma_f32_16x16x32_bf16 a[124:127], v[44:47], v[124:127], a[124:127]
  v_mfma_f32_16x16x32_bf16 a[128:131], v[48:51], v[96:99], a[128:131]
  ds_read_b64_tr_b16 v[84:85], v13 offset:33280
  v_mfma_f32_16x16x32_bf16 a[132:135], v[48:51], v[100:103], a[132:135]
  v_mfma_f32_16x16x32_bf16 a[136:139], v[48:51], v[104:107], a[136:139]
  ds_read_b64_tr_b16 v[86:87], v13 offset:34304
  v_mfma_f32_16x16x32_bf16 a[140:143], v[48:51], v[108:111], a[140:143]
  v_mfma_f32_16x16x32_bf16 a[144:147], v[48:51], v[112:115], a[144:147]
  ds_read_b128 v[148:151], v14 offset:37888
  v_mfma_f32_16x16x32_bf16 a[148:151], v[48:51], v[116:119], a[148:151]
  v_mfma_f32_16x16x32_bf16 a[152:155], v[48:51], v[120:123], a[152:155]
  ds_read_b64_tr_b16 v[88:89], v12 offset:33536
  v_mfma_f32_16x16x32_bf16 a[156:159], v[48:51], v[124:127], a[156:159]
  v_mfma_f32_16x16x32_bf16 a[160:163], v[52:55], v[96:99], a[160:163]
  ds_read_b64_tr_b16 v[90:91], v12 offset:34560
  v_mfma_f32_16x16x32_bf16 a[164:167], v[52:55], v[100:103], a[164:167]
  v_mfma_f32_16x16x32_bf16 a[168:171], v[52:55], v[104:107], a[168:171]
  ds_read_b128 v[152:155], v14 offset:38912
  v_mfma_f32_16x16x32_bf16 a[172:175], v[52:55], v[108:111], a[172:175]
  v_mfma_f32_16x16x32_bf16 a[176:179], v[52:55], v[112:115], a[176:179]
  ds_read_b64_tr_b16 v[92:93], v13 offset:33536
  v_mfma_f32_16x16x32_bf16 a[180:183], v[52:55], v[116:119], a[180:183]
  v_mfma_f32_16x16x32_bf16 a[184:187], v[52:55], v[120:123], a[184:187]
  ds_read_b64_tr_b16 v[94:95], v13 offset:34560
  v_mfma_f32_16x16x32_bf16 a[188:191], v[52:55], v[124:127], a[188:191]
  v_mfma_f32_16x16x32_bf16 a[192:195], v[56:59], v[96:99], a[192:195]
  s_add_u32 s26, s26, s79
  ds_read_b128 v[156:159], v14 offset:39936
  v_mfma_f32_16x16x32_bf16 a[196:199], v[56:59], v[100:103], a[196:199]
  s_add_u32 s27, s27, s25
  v_mfma_f32_16x16x32_bf16 a[200:203], v[56:59], v[104:107], a[200:203]
  s_add_u32 s24, s24, 32768
  v_mfma_f32_16x16x32_bf16 a[204:207], v[56:59], v[108:111], a[204:207]
  s_and_b32 s24, s24, 0x1ffff
  v_mfma_f32_16x16x32_bf16 a[208:211], v[56:59], v[112:115], a[208:211]
  v_xor_b32 v14, 0x10000, v14
  v_mfma_f32_16x16x32_bf16 a[212:215], v[56:59], v[116:119], a[212:215]
  v_xor_b32 v12, 0x10000, v12
  v_mfma_f32_16x16x32_bf16 a[216:219], v[56:59], v[120:123], a[216:219]
  v_xor_b32 v13, 0x10000, v13
  v_mfma_f32_16x16x32_bf16 a[220:223], v[56:59], v[124:127], a[220:223]
  v_mfma_f32_16x16x32_bf16 a[224:227], v[60:63], v[96:99], a[224:227]
  v_mfma_f32_16x16x32_bf16 a[228:231], v[60:63], v[100:103], a[228:231]
  v_mfma_f32_16x16x32_bf16 a[232:235], v[60:63], v[104:107], a[232:235]
  v_mfma_f32_16x16x32_bf16 a[236:239], v[60:63], v[108:111], a[236:239]
  v_mfma_f32_16x16x32_bf16 a[240:243], v[60:63], v[112:115], a[240:243]
  v_mfma_f32_16x16x32_bf16 a[244:247], v[60:63], v[116:119], a[244:247]
  v_mfma_f32_16x16x32_bf16 a[248:251], v[60:63], v[120:123], a[248:251]
  v_mfma_f32_16x16x32_bf16 a[252:255], v[60:63], v[124:127], a[252:255]
  s_waitcnt lgkmcnt(0)
  v_mfma_f32_16x16x32_bf16 a[0:3], v[64:67], v[128:131], a[0:3]
  s_waitcnt vmcnt(18)
  v_mfma_f32_16x16x32_bf16 a[4:7], v[64:67], v[132:135], a[4:7]
  s_barrier
  v_mfma_f32_16x16x32_bf16 a[8:11], v[64:67], v[136:139], a[8:11]
  ds_read_b64_tr_b16 v[32:33], v12 offset:0
  v_mfma_f32_16x16x32_bf16 a[12:15], v[64:67], v[140:143], a[12:15]
  v_mfma_f32_16x16x32_bf16 a[16:19], v[64:67], v[144:147], a[16:19]
  s_mov_b32 m0, s24
  ds_read_b64_tr_b16 v[34:35], v12 offset:1024
  v_mfma_f32_16x16x32_bf16 a[20:23], v[64:67], v[148:151], a[20:23]
  buffer_load_dwordx4 v3, s[32:35], s26 offen offset:0 sc1 lds
  v_mfma_f32_16x16x32_bf16 a[24:27], v[64:67], v[152:155], a[24:27]
  ds_read_b128 v[96:99], v14 offset:0
  v_mfma_f32_16x16x32_bf16 a[28:31], v[64:67], v[156:159], a[28:31]
  v_mfma_f32_16x16x32_bf16 a[32:35], v[68:71], v[128:131], a[32:35]
  ds_read_b64_tr_b16 v[36:37], v13 offset:0
  v_mfma_f32_16x16x32_bf16 a[36:39], v[68:71], v[132:135], a[36:39]
  v_mfma_f32_16x16x32_bf16 a[40:43], v[68:71], v[136:139], a[40:43]
  ds_read_b64_tr_b16 v[38:39], v13 offset:1024
  v_mfma_f32_16x16x32_bf16 a[44:47], v[68:71], v[140:143], a[44:47]
  buffer_load_dwordx4 v4, s[32:35], s26 offen offset:1024 sc1 lds
  v_mfma_f32_16x16x32_bf16 a[48:51], v[68:71], v[144:147], a[48:51]
  ds_read_b128 v[100:103], v14 offset:1024
  v_mfma_f32_16x16x32_bf16 a[52:55], v[68:71], v[148:151], a[52:55]
  v_mfma_f32_16x16x32_bf16 a[56:59], v[68:71], v[152:155], a[56:59]
  ds_read_b64_tr_b16 v[40:41], v12 offset:256
  v_mfma_f32_16x16x32_bf16 a[60:63], v[68:71], v[156:159], a[60:63]
  v_mfma_f32_16x16x32_bf16 a[64:67], v[72:75], v[128:131], a[64:67]
  ds_read_b64_tr_b16 v[42:43], v12 offset:1280
  v_mfma_f32_16x16x32_bf16 a[68:71], v[72:75], v[132:135], a[68:71]
  buffer_load_dwordx4 v5, s[32:35], s26 offen offset:2048 sc1 lds
  v_mfma_f32_16x16x32_bf16 a[72:75], v[72:75], v[136:139], a[72:75]
  ds_read_b128 v[104:107], v14 offset:2048
  v_mfma_f32_16x16x32_bf16 a[76:79], v[72:75], v[140:143], a[76:79]
  v_mfma_f32_16x16x32_bf16 a[80:83], v[72:75], v[144:147], a[80:83]
  ds_read_b64_tr_b16 v[44:45], v13 offset:256
  v_mfma_f32_16x16x32_bf16 a[84:87], v[72:75], v[148:151], a[84:87]
  v_mfma_f32_16x16x32_bf16 a[88:91], v[72:75], v[152:155], a[88:91]
  ds_read_b64_tr_b16 v[46:47], v13 offset:1280
  v_mfma_f32_16x16x32_bf16 a[92:95], v[72:75], v[156:159], a[92:95]
  buffer_load_dwordx4 v6, s[32:35], s26 offen offset:3072 sc1 lds
  v_mfma_f32_16x16x32_bf16 a[96:99], v[76:79], v[128:131], a[96:99]
  ds_read_b128 v[108:111], v14 offset:3072
  v_mfma_f32_16x16x32_bf16 a[100:103], v[76:79], v[132:135], a[100:103]
  v_mfma_f32_16x16x32_bf16 a[104:107], v[76:79], v[136:139], a[104:107]
  ds_read_b64_tr_b16 v[48:49], v12 offset:512
  v_mfma_f32_16x16x32_bf16 a[108:111], v[76:79], v[140:143], a[108:111]
  v_mfma_f32_16x16x32_bf16 a[112:115], v[76:79], v[144:147], a[112:115]
  s_add_u32 m0, s24, 16384
  ds_read_b64_tr_b16 v[50:51], v12 offset:1536
  v_mfma_f32_16x16x32_bf16 a[116:119], v[76:79], v[148:151], a[116:119]
  buffer_load_dwordx4 v8, s[36:39], s27 offen offset:0 lds
  v_mfma_f32_16x16x32_bf16 a[120:123], v[76:79], v[152:155], a[120:123]
  ds_read_b128 v[112:115], v14 offset:4096
  v_mfma_f32_16x16x32_bf16 a[124:127], v[76:79], v[156:159], a[124:127]
  v_mfma_f32_16x16x32_bf16 a[128:131], v[80:83], v[128:131], a[128:131]
  ds_read_b64_tr_b16 v[52:53], v13 offset:512
  v_mfma_f32_16x16x32_bf16 a[132:135], v[80:83], v[132:135], a[132:135]
  v_mfma_f32_16x16x32_bf16 a[136:139], v[80:83], v[136:139], a[136:139]
  ds_read_b64_tr_b16 v[54:55], v13 offset:1536
  v_mfma_f32_16x16x32_bf16 a[140:143], v[80:83], v[140:143], a[140:143]
  buffer_load_dwordx4 v9, s[36:39], s27 offen offset:1024 lds
  v_mfma_f32_16x16x32_bf16 a[144:147], v[80:83], v[144:147], a[144:147]
  ds_read_b128 v[116:119], v14 offset:5120
  v_mfma_f32_16x16x32_bf16 a[148:151], v[80:83], v[148:151], a[148:151]
  v_mfma_f32_16x16x32_bf16 a[152:155], v[80:83], v[152:155], a[152:155]
  ds_read_b64_tr_b16 v[56:57], v12 offset:768
  v_mfma_f32_16x16x32_bf16 a[156:159], v[80:83], v[156:159], a[156:159]
  v_mfma_f32_16x16x32_bf16 a[160:163], v[84:87], v[128:131], a[160:163]
  ds_read_b64_tr_b16 v[58:59], v12 offset:1792
  v_mfma_f32_16x16x32_bf16 a[164:167], v[84:87], v[132:135], a[164:167]
  buffer_load_dwordx4 v10, s[36:39], s27 offen offset:2048 lds
  v_mfma_f32_16x16x32_bf16 a[168:171], v[84:87], v[136:139], a[168:171]
  ds_read_b128 v[120:123], v14 offset:6144
  v_mfma_f32_16x16x32_bf16 a[172:175], v[84:87], v[140:143], a[172:175]
  v_mfma_f32_16x16x32_bf16 a[176:179], v[84:87], v[144:147], a[176:179]
  ds_read_b64_tr_b16 v[60:61], v13 offset:768
  v_mfma_f32_16x16x32_bf16 a[180:183], v[84:87], v[148:151], a[180:183]
  v_mfma_f32_16x16x32_bf16 a[184:187], v[84:87], v[152:155], a[184:187]
  ds_read_b64_tr_b16 v[62:63], v13 offset:1792
  v_mfma_f32_16x16x32_bf16 a[188:191], v[84:87], v[156:159], a[188:191]
  buffer_load_dwordx4 v11, s[36:39], s27 offen offset:3072 lds
  v_mfma_f32_16x16x32_bf16 a[192:195], v[88:91], v[128:131], a[192:195]
  s_add_u32 s26, s26, s79
  ds_read_b128 v[124:127], v14 offset:7168
  v_mfma_f32_16x16x32_bf16 a[196:199], v[88:91], v[132:135], a[196:199]
  s_add_u32 s27, s27, s25
  v_mfma_f32_16x16x32_bf16 a[200:203], v[88:91], v[136:139], a[200:203]
  s_add_u32 s24, s24, 32768
  v_mfma_f32_16x16x32_bf16 a[204:207], v[88:91], v[140:143], a[204:207]
  s_and_b32 s24, s24, 0x1ffff
  v_mfma_f32_16x16x32_bf16 a[208:211], v[88:91], v[144:147], a[208:211]
  v_mfma_f32_16x16x32_bf16 a[212:215], v[88:91], v[148:151], a[212:215]
  s_bitcmp1_b32 s76, s28
  v_mfma_f32_16x16x32_bf16 a[216:219], v[88:91], v[152:155], a[216:219]
  s_cbranch_scc1 fa_hk1
fa_hb1:
  v_mfma_f32_16x16x32_bf16 a[220:223], v[88:91], v[156:159], a[220:223]
  v_mfma_f32_16x16x32_bf16 a[224:227], v[92:95], v[128:131], a[224:227]
  v_mfma_f32_16x16x32_bf16 a[228:231], v[92:95], v[132:135], a[228:231]
  s_add_u32 s28, s28, 1
  v_mfma_f32_16x16x32_bf16 a[232:235], v[92:95], v[136:139], a[232:235]
  v_mfma_f32_16x16x32_bf16 a[236:239], v[92:95], v[140:143], a[236:239]
  v_mfma_f32_16x16x32_bf16 a[240:243], v[92:95], v[144:147], a[240:243]
  v_mfma_f32_16x16x32_bf16 a[244:247], v[92:95], v[148:151], a[244:247]
  s_cmp_lt_u32 s28, 8
  v_mfma_f32_16x16x32_bf16 a[248:251], v[92:95], v[152:155], a[248:251]
  s_waitcnt lgkmcnt(0)
  v_mfma_f32_16x16x32_bf16 a[252:255], v[92:95], v[156:159], a[252:255]
  s_cbranch_scc1 fa_loopK
  s_mov_b32 s60, 2048
  s_mov_b32 s61, 8192
  s_mov_b32 s62, 16777216
  s_mov_b32 s76, 0x3e0293ee
  s_branch fa_p1epi
fa_roleV:
  ds_read_b128 v[32:35], v14 offset:0
  ds_read_b128 v[36:39], v14 offset:1024
  ds_read_b128 v[40:43], v14 offset:2048
  ds_read_b128 v[44:47], v14 offset:3072
  ds_read_b128 v[48:51], v14 offset:4096
  ds_read_b128 v[52:55], v14 offset:5120
  ds_read_b128 v[56:59], v14 offset:6144
  ds_read_b128 v[60:63], v14 offset:7168
  ds_read_b64_tr_b16 v[96:97], v12 offset:0
  ds_read_b64_tr_b16 v[98:99], v12 offset:1024
  ds_read_b64_tr_b16 v[100:101], v13 offset:0
  ds_read_b64_tr_b16 v[102:103], v13 offset:1024
  ds_read_b64_tr_b16 v[104:105], v12 offset:256
  ds_read_b64_tr_b16 v[106:107], v12 offset:1280
  ds_read_b64_tr_b16 v[108:109], v13 offset:256
  ds_read_b64_tr_b16 v[110:111], v13 offset:1280
  ds_read_b64_tr_b16 v[112:113], v12 offset:512
  ds_read_b64_tr_b16 v[114:115], v12 offset:1536
  ds_read_b64_tr_b16 v[116:117], v13 offset:512
  ds_read_b64_tr_b16 v[118:119], v13 offset:1536
  ds_read_b64_tr_b16 v[120:121], v12 offset:768
  ds_read_b64_tr_b16 v[122:123], v12 offset:1792
  ds_read_b64_tr_b16 v[124:125], v13 offset:768
  ds_read_b64_tr_b16 v[126:127], v13 offset:1792
  s_waitcnt lgkmcnt(0)
.p2align 6
fa_loopV:
  v_mfma_f32_16x16x32_bf16 a[0:3], v[32:35], v[96:99], a[0:3]
  s_waitcnt vmcnt(17)
  v_mfma_f32_16x16x32_bf16 a[4:7], v[32:35], v[100:103], a[4:7]
  s_barrier
  v_mfma_f32_16x16x32_bf16 a[8:11], v[32:35], v[104:107], a[8:11]
  ds_read_b64_tr_b16 v[128:129], v12 offset:32768
  v_mfma_f32_16x16x32_bf16 a[12:15], v[32:35], v[108:111], a[12:15]
  v_mfma_f32_16x16x32_bf16 a[16:19], v[32:35], v[112:115], a[16:19]
  s_mov_b32 m0, s24
  ds_read_b64_tr_b16 v[130:131], v12 offset:33792
  v_mfma_f32_16x16x32_bf16 a[20:23], v[32:35], v[116:119], a[20:23]
  buffer_load_dwordx4 v3, s[32:35], s26 offen offset:0 sc1 lds
  v_mfma_f32_16x16x32_bf16 a[24:27], v[32:35], v[120:123], a[24:27]
  ds_read_b128 v[64:67], v14 offset:32768
  v_mfma_f32_16x16x32_bf16 a[28:31], v[32:35], v[124:127], a[28:31]
  buffer_load_dwordx4 v4, s[32:35], s26 offen offset:1024 sc1 lds
  v_mfma_f32_16x16x32_bf16 a[32:35], v[36:39], v[96:99], a[32:35]
  ds_read_b64_tr_b16 v[132:133], v13 offset:32768
  v_mfma_f32_16x16x32_bf16 a[36:39], v[36:39], v[100:103], a[36:39]
  buffer_load_dwordx4 v5, s[32:35], s26 offen offset:2048 sc1 lds
  v_mfma_f32_16x16x32_bf16 a[40:43], v[36:39], v[104:107], a[40:43]
  ds_read_b64_tr_b16 v[134:135], v13 offset:33792
  v_mfma_f32_16x16x32_bf16 a[44:47], v[36:39], v[108:111], a[44:47]
  buffer_load_dwordx4 v6, s[32:35], s26 offen offset:3072 sc1 lds
  v_mfma_f32_16x16x32_bf16 a[48:51], v[36:39], v[112:115], a[48:51]
  s_add_u32 m0, s24, 16384
  ds_read_b128 v[68:71], v14 offset:33792
  v_mfma_f32_16x16x32_bf16 a[52:55], v[36:39], v[116:119], a[52:55]
  buffer_load_dwordx4 v8, s[36:39], s27 offen offset:0 lds
  v_mfma_f32_16x16x32_bf16 a[56:59], v[36:39], v[120:123], a[56:59]
  ds_read_b64_tr_b16 v[136:137], v12 offset:33024
  v_mfma_f32_16x16x32_bf16 a[60:63], v[36:39], v[124:127], a[60:63]
  buffer_load_dwordx4 v9, s[36:39], s27 offen offset:1024 lds
  v_mfma_f32_16x16x32_bf16 a[64:67], v[40:43], v[96:99], a[64:67]
  ds_read_b64_tr_b16 v[138:139], v12 offset:34048
  v_mfma_f32_16x16x32_bf16 a[68:71], v[40:43], v[100:103], a[68:71]
  buffer_load_dwordx4 v10, s[36:39], s27 offen offset:2048 lds
  v_mfma_f32_16x16x32_bf16 a[72:75], v[40:43], v[104:107], a[72:75]
  ds_read_b128 v[72:75], v14 offset:34816
  v_mfma_f32_16x16x32_bf16 a[76:79], v[40:43], v[108:111], a[76:79]
  buffer_load_dwordx4 v11, s[36:39], s27 offen offset:3072 lds
  v_mfma_f32_16x16x32_bf16 a[80:83], v[40:43], v[112:115], a[80:83]
  ds_read_b64_tr_b16 v[140:141], v13 offset:33024
  v_mfma_f32_16x16x32_bf16 a[84:87], v[40:43], v[116:119], a[84:87]
  buffer_load_dword v231, v235, s[48:51], s74 offen sc1
  v_mfma_f32_16x16x32_bf16 a[88:91], v[40:43], v[120:123], a[88:91]
  s_add_u32 s74, s74, s73
  ds_read_b64_tr_b16 v[142:143], v13 offset:34048
  v_mfma_f32_16x16x32_bf16 a[92:95], v[40:43], v[124:127], a[92:95]
  s_bitcmp1_b32 s72, s28
  v_mfma_f32_16x16x32_bf16 a[96:99], v[44:47], v[96:99], a[96:99]
  s_cbranch_scc1 fa_hk2
fa_hb2:
  ds_read_b128 v[76:79], v14 offset:35840
  v_mfma_f32_16x16x32_bf16 a[100:103], v[44:47], v[100:103], a[100:103]
  v_mfma_f32_16x16x32_bf16 a[104:107], v[44:47], v[104:107], a[104:107]
  ds_read_b64_tr_b16 v[144:145], v12 offset:33280
  v_mfma_f32_16x16x32_bf16 a[108:111], v[44:47], v[108:111], a[108:111]
  v_mfma_f32_16x16x32_bf16 a[112:115], v[44:47], v[112:115], a[112:115]
  ds_read_b64_tr_b16 v[146:147], v12 offset:34304
  v_mfma_f32_16x16x32_bf16 a[116:119], v[44:47], v[116:119], a[116:119]
  v_mfma_f32_16x16x32_bf16 a[120:123], v[44:47], v[120:123], a[120:123]
  ds_read_b128 v[80:83], v14 offset:36864
  v_mfma_f32_16x16x32_bf16 a[124:127], v[44:47], v[124:127], a[124:127]
  v_mfma_f32_16x16x32_bf16 a[128:131], v[48:51], v[96:99], a[128:131]
  ds_read_b64_tr_b16 v[148:149], v13 offset:33280
  v_mfma_f32_16x16x32_bf16 a[132:135], v[48:51], v[100:103], a[132:135]
  v_mfma_f32_16x16x32_bf16 a[136:139], v[48:51], v[104:107], a[136:139]
  ds_read_b64_tr_b16 v[150:151], v13 offset:34304
  v_mfma_f32_16x16x32_bf16 a[140:143], v[48:51], v[108:111], a[140:143]
  v_mfma_f32_16x16x32_bf16 a[144:147], v[48:51], v[112:115], a[144:147]
  ds_read_b128 v[84:87], v14 offset:37888
  v_mfma_f32_16x16x32_bf16 a[148:151], v[48:51], v[116:119], a[148:151]
  v_mfma_f32_16x16x32_bf16 a[152:155], v[48:51], v[120:123], a[152:155]
  ds_read_b64_tr_b16 v[152:153], v12 offset:33536
  v_mfma_f32_16x16x32_bf16 a[156:159], v[48:51], v[124:127], a[156:159]
  v_mfma_f32_16x16x32_bf16 a[160:163], v[52:55], v[96:99], a[160:163]
  ds_read_b64_tr_b16 v[154:155], v12 offset:34560
  v_mfma_f32_16x16x32_bf16 a[164:167], v[52:55], v[100:103], a[164:167]
  v_mfma_f32_16x16x32_bf16 a[168:171], v[52:55], v[104:107], a[168:171]
  ds_read_b128 v[88:91], v14 offset:38912
  v_mfma_f32_16x16x32_bf16 a[172:175], v[52:55], v[108:111], a[172:175]
  v_mfma_f32_16x16x32_bf16 a[176:179], v[52:55], v[112:115], a[176:179]
  ds_read_b64_tr_b16 v[156:157], v13 offset:33536
  v_mfma_f32_16x16x32_bf16 a[180:183], v[52:55], v[116:119], a[180:183]
  v_mfma_f32_16x16x32_bf16 a[184:187], v[52:55], v[120:123], a[184:187]
  ds_read_b64_tr_b16 v[158:159], v13 offset:34560
  v_mfma_f32_16x16x32_bf16 a[188:191], v[52:55], v[124:127], a[188:191]
  v_mfma_f32_16x16x32_bf16 a[192:195], v[56:59], v[96:99], a[192:195]
  s_add_u32 s26, s26, s79
  ds_read_b128 v[92:95], v14 offset:39936
  v_mfma_f32_16x16x32_bf16 a[196:199], v[56:59], v[100:103], a[196:199]
  s_add_u32 s27, s27, s25
  v_mfma_f32_16x16x32_bf16 a[200:203], v[56:59], v[104:107], a[200:203]
  s_add_u32 s24, s24, 32768
  v_mfma_f32_16x16x32_bf16 a[204:207], v[56:59], v[108:111], a[204:207]
  s_and_b32 s24, s24, 0x1ffff
  v_mfma_f32_16x16x32_bf16 a[208:211], v[56:59], v[112:115], a[208:211]
  v_xor_b32 v14, 0x10000, v14
  v_mfma_f32_16x16x32_bf16 a[212:215], v[56:59], v[116:119], a[212:215]
  v_xor_b32 v12, 0x10000, v12
  v_mfma_f32_16x16x32_bf16 a[216:219], v[56:59], v[120:123], a[216:219]
  v_xor_b32 v13, 0x10000, v13
  v_mfma_f32_16x16x32_bf16 a[220:223], v[56:59], v[124:127], a[220:223]
  v_mfma_f32_16x16x32_bf16 a[224:227], v[60:63], v[96:99], a[224:227]
  v_mfma_f32_16x16x32_bf16 a[228:231], v[60:63], v[100:103], a[228:231]
  v_mfma_f32_16x16x32_bf16 a[232:235], v[60:63], v[104:107], a[232:235]
  v_mfma_f32_16x16x32_bf16 a[236:239], v[60:63], v[108:111], a[236:239]
  v_mfma_f32_16x16x32_bf16 a[240:243], v[60:63], v[112:115], a[240:243]
  v_mfma_f32_16x16x32_bf16 a[244:247], v[60:63], v[116:119], a[244:247]
  v_mfma_f32_16x16x32_bf16 a[248:251], v[60:63], v[120:123], a[248:251]
  v_mfma_f32_16x16x32_bf16 a[252:255], v[60:63], v[124:127], a[252:255]
  s_waitcnt lgkmcnt(0)
  v_mfma_f32_16x16x32_bf16 a[0:3], v[64:67], v[128:131], a[0:3]
  s_waitcnt vmcnt(18)
  v_mfma_f32_16x16x32_bf16 a[4:7], v[64:67], v[132:135], a[4:7]
  s_barrier
  v_mfma_f32_16x16x32_bf16 a[8:11], v[64:67], v[136:139], a[8:11]
  ds_read_b64_tr_b16 v[96:97], v12 offset:0
  v_mfma_f32_16x16x32_bf16 a[12:15], v[64:67], v[140:143], a[12:15]
  v_mfma_f32_16x16x32_bf16 a[16:19], v[64:67], v[144:147], a[16:19]
  s_mov_b32 m0, s24
  ds_read_b64_tr_b16 v[98:99], v12 offset:1024
  v_mfma_f32_16x16x32_bf16 a[20:23], v[64:67], v[148:151], a[20:23]
  buffer_load_dwordx4 v3, s[32:35], s26 offen offset:0 sc1 lds
  v_mfma_f32_16x16x32_bf16 a[24:27], v[64:67], v[152:155], a[24:27]
  ds_read_b128 v[32:35], v14 offset:0
  v_mfma_f32_16x16x32_bf16 a[28:31], v[64:67], v[156:159], a[28:31]
  v_mfma_f32_16x16x32_bf16 a[32:35], v[68:71], v[128:131], a[32:35]
  ds_read_b64_tr_b16 v[100:101], v13 offset:0
  v_mfma_f32_16x16x32_bf16 a[36:39], v[68:71], v[132:135], a[36:39]
  v_mfma_f32_16x16x32_bf16 a[40:43], v[68:71], v[136:139], a[40:43]
  ds_read_b64_tr_b16 v[102:103], v13 offset:1024
  v_mfma_f32_16x16x32_bf16 a[44:47], v[68:71], v[140:143], a[44:47]
  buffer_load_dwordx4 v4, s[32:35], s26 offen offset:1024 sc1 lds
  v_mfma_f32_16x16x32_bf16 a[48:51], v[68:71], v[144:147], a[48:51]
  ds_read_b128 v[36:39], v14 offset:1024
  v_mfma_f32_16x16x32_bf16 a[52:55], v[68:71], v[148:151], a[52:55]
  v_mfma_f32_16x16x32_bf16 a[56:59], v[68:71], v[152:155], a[56:59]
  ds_read_b64_tr_b16 v[104:105], v12 offset:256
  v_mfma_f32_16x16x32_bf16 a[60:63], v[68:71], v[156:159], a[60:63]
  v_mfma_f32_16x16x32_bf16 a[64:67], v[72:75], v[128:131], a[64:67]
  ds_read_b64_tr_b16 v[106:107], v12 offset:1280
  v_mfma_f32_16x16x32_bf16 a[68:71], v[72:75], v[132:135], a[68:71]
  buffer_load_dwordx4 v5, s[32:35], s26 offen offset:2048 sc1 lds
  v_mfma_f32_16x16x32_bf16 a[72:75], v[72:75], v[136:139], a[72:75]
  ds_read_b128 v[40:43], v14 offset:2048
  v_mfma_f32_16x16x32_bf16 a[76:79], v[72:75], v[140:143], a[76:79]
  v_mfma_f32_16x16x32_bf16 a[80:83], v[72:75], v[144:147], a[80:83]
  ds_read_b64_tr_b16 v[108:109], v13 offset:256
  v_mfma_f32_16x16x32_bf16 a[84:87], v[72:75], v[148:151], a[84:87]
  v_mfma_f32_16x16x32_bf16 a[88:91], v[72:75], v[152:155], a[88:91]
  ds_read_b64_tr_b16 v[110:111], v13 offset:1280
  v_mfma_f32_16x16x32_bf16 a[92:95], v[72:75], v[156:159], a[92:95]
  buffer_load_dwordx4 v6, s[32:35], s26 offen offset:3072 sc1 lds
  v_mfma_f32_16x16x32_bf16 a[96:99], v[76:79], v[128:131], a[96:99]
  ds_read_b128 v[44:47], v14 offset:3072
  v_mfma_f32_16x16x32_bf16 a[100:103], v[76:79], v[132:135], a[100:103]
  v_mfma_f32_16x16x32_bf16 a[104:107], v[76:79], v[136:139], a[104:107]
  ds_read_b64_tr_b16 v[112:113], v12 offset:512
  v_mfma_f32_16x16x32_bf16 a[108:111], v[76:79], v[140:143], a[108:111]
  v_mfma_f32_16x16x32_bf16 a[112:115], v[76:79], v[144:147], a[112:115]
  s_add_u32 m0, s24, 16384
  ds_read_b64_tr_b16 v[114:115], v12 offset:1536
  v_mfma_f32_16x16x32_bf16 a[116:119], v[76:79], v[148:151], a[116:119]
  buffer_load_dwordx4 v8, s[36:39], s27 offen offset:0 lds
  v_mfma_f32_16x16x32_bf16 a[120:123], v[76:79], v[152:155], a[120:123]
  ds_read_b128 v[48:51], v14 offset:4096
  v_mfma_f32_16x16x32_bf16 a[124:127], v[76:79], v[156:159], a[124:127]
  v_mfma_f32_16x16x32_bf16 a[128:131], v[80:83], v[128:131], a[128:131]
  ds_read_b64_tr_b16 v[116:117], v13 offset:512
  v_mfma_f32_16x16x32_bf16 a[132:135], v[80:83], v[132:135], a[132:135]
  v_mfma_f32_16x16x32_bf16 a[136:139], v[80:83], v[136:139], a[136:139]
  ds_read_b64_tr_b16 v[118:119], v13 offset:1536
  v_mfma_f32_16x16x32_bf16 a[140:143], v[80:83], v[140:143], a[140:143]
  buffer_load_dwordx4 v9, s[36:39], s27 offen offset:1024 lds
  v_mfma_f32_16x16x32_bf16 a[144:147], v[80:83], v[144:147], a[144:147]
  ds_read_b128 v[52:55], v14 offset:5120
  v_mfma_f32_16x16x32_bf16 a[148:151], v[80:83], v[148:151], a[148:151]
  v_mfma_f32_16x16x32_bf16 a[152:155], v[80:83], v[152:155], a[152:155]
  ds_read_b64_tr_b16 v[120:121], v12 offset:768
  v_mfma_f32_16x16x32_bf16 a[156:159], v[80:83], v[156:159], a[156:159]
  v_mfma_f32_16x16x32_bf16 a[160:163], v[84:87], v[128:131], a[160:163]
  ds_read_b64_tr_b16 v[122:123], v12 offset:1792
  v_mfma_f32_16x16x32_bf16 a[164:167], v[84:87], v[132:135], a[164:167]
  buffer_load_dwordx4 v10, s[36:39], s27 offen offset:2048 lds
  v_mfma_f32_16x16x32_bf16 a[168:171], v[84:87], v[136:139], a[168:171]
  ds_read_b128 v[56:59], v14 offset:6144
  v_mfma_f32_16x16x32_bf16 a[172:175], v[84:87], v[140:143], a[172:175]
  v_mfma_f32_16x16x32_bf16 a[176:179], v[84:87], v[144:147], a[176:179]
  ds_read_b64_tr_b16 v[124:125], v13 offset:768
  v_mfma_f32_16x16x32_bf16 a[180:183], v[84:87], v[148:151], a[180:183]
  v_mfma_f32_16x16x32_bf16 a[184:187], v[84:87], v[152:155], a[184:187]
  ds_read_b64_tr_b16 v[126:127], v13 offset:1792
  v_mfma_f32_16x16x32_bf16 a[188:191], v[84:87], v[156:159], a[188:191]
  buffer_load_dwordx4 v11, s[36:39], s27 offen offset:3072 lds
  v_mfma_f32_16x16x32_bf16 a[192:195], v[88:91], v[128:131], a[192:195]
  s_add_u32 s26, s26, s79
  ds_read_b128 v[60:63], v14 offset:7168
  v_mfma_f32_16x16x32_bf16 a[196:199], v[88:91], v[132:135], a[196:199]
  s_add_u32 s27, s27, s25
  v_mfma_f32_16x16x32_bf16 a[200:203], v[88:91], v[136:139], a[200:203]
  s_add_u32 s24, s24, 32768
  v_mfma_f32_16x16x32_bf16 a[204:207], v[88:91], v[140:143], a[204:207]
  s_and_b32 s24, s24, 0x1ffff
  v_mfma_f32_16x16x32_bf16 a[208:211], v[88:91], v[144:147], a[208:211]
  v_mfma_f32_16x16x32_bf16 a[212:215], v[88:91], v[148:151], a[212:215]
  s_bitcmp1_b32 s76, s28
  v_mfma_f32_16x16x32_bf16 a[216:219], v[88:91], v[152:155], a[216:219]
  s_cbranch_scc1 fa_hk3
fa_hb3:
  v_mfma_f32_16x16x32_bf16 a[220:223], v[88:91], v[156:159], a[220:223]
  v_mfma_f32_16x16x32_bf16 a[224:227], v[92:95], v[128:131], a[224:227]
  v_mfma_f32_16x16x32_bf16 a[228:231], v[92:95], v[132:135], a[228:231]
  s_add_u32 s28, s28, 1
  v_mfma_f32_16x16x32_bf16 a[232:235], v[92:95], v[136:139], a[232:235]
  v_mfma_f32_16x16x32_bf16 a[236:239], v[92:95], v[140:143], a[236:239]
  v_mfma_f32_16x16x32_bf16 a[240:243], v[92:95], v[144:147], a[240:243]
  v_mfma_f32_16x16x32_bf16 a[244:247], v[92:95], v[148:151], a[244:247]
  s_cmp_lt_u32 s28, 8
  v_mfma_f32_16x16x32_bf16 a[248:251], v[92:95], v[152:155], a[248:251]
  s_waitcnt lgkmcnt(0)
  v_mfma_f32_16x16x32_bf16 a[252:255], v[92:95], v[156:159], a[252:255]
  s_cbranch_scc1 fa_loopV
  s_mov_b32 s60, 8192
  s_mov_b32 s61, 2048
  s_mov_b32 s62, 33554432
  s_mov_b32 s76, 1.0
fa_p1epi:
  s_lshr_b32 s23, s20, 1
  s_lshl_b32 s23, s23, 13
  v_subrev_u32 v12, s23, v12
  v_subrev_u32 v13, s23, v13
  s_lshl_b32 s24, s20, 12
  v_add_u32 v14, s24, v2
  ds_read_b64_tr_b16 v[32:33], v12 offset:0
  ds_read_b64_tr_b16 v[34:35], v12 offset:1024
  ds_read_b64_tr_b16 v[36:37], v13 offset:0
  ds_read_b64_tr_b16 v[38:39], v13 offset:1024
  ds_read_b64_tr_b16 v[40:41], v12 offset:256
  ds_read_b64_tr_b16 v[42:43], v12 offset:1280
  ds_read_b64_tr_b16 v[44:45], v13 offset:256
  ds_read_b64_tr_b16 v[46:47], v13 offset:1280
  ds_read_b64_tr_b16 v[48:49], v12 offset:512
  ds_read_b64_tr_b16 v[50:51], v12 offset:1536
  ds_read_b64_tr_b16 v[52:53], v13 offset:512
  ds_read_b64_tr_b16 v[54:55], v13 offset:1536
  ds_read_b64_tr_b16 v[56:57], v12 offset:768
  ds_read_b64_tr_b16 v[58:59], v12 offset:1792
  ds_read_b64_tr_b16 v[60:61], v13 offset:768
  ds_read_b64_tr_b16 v[62:63], v13 offset:1792
  s_waitcnt vmcnt(8)
  ds_read_b128 v[224:227], v14 offset:0
  ds_read_b128 v[228:231], v14 offset:1024
  ds_read_b128 v[232:235], v14 offset:2048
  ds_read_b128 v[236:239], v14 offset:3072
  s_lshl_b32 s23, s21, 19
  s_add_u32 s62, s62, s23
  s_lshl_b32 s23, s22, 16
  s_add_u32 s62, s62, s23
  s_and_b32 s23, s20, 1
  s_lshl_b32 s23, s23, 15
  s_add_u32 s62, s62, s23
  s_lshl_b32 s23, s21, 19
  s_add_u32 s23, s23, 16777216
  s_add_u32 s6, s18, s23
  s_addc_u32 s7, s19, 0
  s_add_u32 s8, s6, 16777216
  s_addc_u32 s9, s7, 0
  s_sub_u32 s23, 16, s22
  s_lshl_b32 s23, s23, 15
  s_mov_b32 s44, s6
  s_mov_b32 s45, s7
  s_mov_b32 s46, s23
  s_mov_b32 s47, 0x20000
  s_mov_b32 s48, s8
  s_mov_b32 s49, s9
  s_mov_b32 s50, s23
  s_mov_b32 s51, 0x20000
  s_lshl_b32 s30, s21, 7
  s_add_u32 s30, s30, 2637824
  s_mov_b32 s81, 0x47800000
  s_cmp_eq_u32 s20, 0
  s_cselect_b32 s29, s82, 1073741824
  s_waitcnt vmcnt(21) lgkmcnt(0)
  v_mfma_f32_16x16x32_bf16 v[96:99], v[32:35], v[224:227], 0
  s_mul_i32 s63, s60, 0
  v_accvgpr_read_b32 v16, a0
  v_accvgpr_read_b32 v17, a1
  v_accvgpr_read_b32 v18, a2
  v_mfma_f32_16x16x32_bf16 v[112:115], v[36:39], v[224:227], 0
  s_add_u32 s63, s63, s62
  ds_read_b64_tr_b16 v[64:65], v12 offset:8192
  v_accvgpr_read_b32 v19, a3
  v_accvgpr_read_b32 v20, a32
  v_mfma_f32_16x16x32_bf16 v[128:131], v[40:43], v[224:227], 0
  s_add_u32 m0, s24, 0
  ds_read_b64_tr_b16 v[66:67], v12 offset:9216
  v_accvgpr_read_b32 v21, a33
  v_accvgpr_read_b32 v22, a34
  v_mfma_f32_16x16x32_bf16 v[144:147], v[44:47], v[224:227], 0
  buffer_load_dwordx4 v3, s[32:35], s26 offen offset:0 sc1 lds
  v_accvgpr_read_b32 v23, a35
  v_mul_f32 v16, s76, v16
  v_mfma_f32_16x16x32_bf16 v[160:163], v[48:51], v[224:227], 0
  ds_read_b64_tr_b16 v[68:69], v13 offset:8192
  v_mul_f32 v17, s76, v17
  v_mul_f32 v18, s76, v18
  v_mfma_f32_16x16x32_bf16 v[176:179], v[52:55], v[224:227], 0
  ds_read_b64_tr_b16 v[70:71], v13 offset:9216
  v_mul_f32 v19, s76, v19
  v_mul_f32 v20, s76, v20
  v_mfma_f32_16x16x32_bf16 v[192:195], v[56:59], v[224:227], 0
  ds_read_b64_tr_b16 v[72:73], v12 offset:8448
  v_mul_f32 v21, s76, v21
  v_mul_f32 v22, s76, v22
  v_mfma_f32_16x16x32_bf16 v[208:211], v[60:63], v[224:227], 0
  ds_read_b64_tr_b16 v[74:75], v12 offset:9472
  v_mul_f32 v23, s76, v23
  v_cvt_pk_bf16_f32 v24, v16, v17
  v_mfma_f32_16x16x32_bf16 v[100:103], v[32:35], v[228:231], 0
  buffer_load_dwordx4 v4, s[32:35], s26 offen offset:1024 sc1 lds
  v_cvt_pk_bf16_f32 v25, v18, v19
  v_cvt_pk_bf16_f32 v26, v20, v21
  v_mfma_f32_16x16x32_bf16 v[116:119], v[36:39], v[228:231], 0
  ds_read_b64_tr_b16 v[76:77], v13 offset:8448
  v_cvt_pk_bf16_f32 v27, v22, v23
  v_mfma_f32_16x16x32_bf16 v[132:135], v[40:43], v[228:231], 0
  ds_read_b64_tr_b16 v[78:79], v13 offset:9472
  buffer_store_dwordx4 v[24:27], v2, s[40:43], s63 offen offset:0 sc1
  v_accvgpr_read_b32 v16, a4
  v_mfma_f32_16x16x32_bf16 v[148:151], v[44:47], v[228:231], 0
  ds_read_b128 v[240:243], v14 offset:32768
  v_accvgpr_read_b32 v17, a5
  v_accvgpr_read_b32 v18, a6
  v_mfma_f32_16x16x32_bf16 v[164:167], v[48:51], v[228:231], 0
  ds_read_b128 v[244:247], v14 offset:33792
  v_accvgpr_read_b32 v19, a7
  v_accvgpr_read_b32 v20, a36
  v_mfma_f32_16x16x32_bf16 v[180:183], v[52:55], v[228:231], 0
  buffer_load_dwordx4 v5, s[32:35], s26 offen offset:2048 sc1 lds
  v_accvgpr_read_b32 v21, a37
  v_accvgpr_read_b32 v22, a38
  v_mfma_f32_16x16x32_bf16 v[196:199], v[56:59], v[228:231], 0
  ds_read_b64_tr_b16 v[80:81], v12 offset:8704
  v_accvgpr_read_b32 v23, a39
  v_mul_f32 v16, s76, v16
  v_mfma_f32_16x16x32_bf16 v[212:215], v[60:63], v[228:231], 0
  ds_read_b64_tr_b16 v[82:83], v12 offset:9728
  v_mul_f32 v17, s76, v17
  v_mul_f32 v18, s76, v18
  v_mfma_f32_16x16x32_bf16 v[104:107], v[32:35], v[232:235], 0
  ds_read_b64_tr_b16 v[84:85], v13 offset:8704
  v_mul_f32 v19, s76, v19
  v_mul_f32 v20, s76, v20
  v_mfma_f32_16x16x32_bf16 v[120:123], v[36:39], v[232:235], 0
  ds_read_b64_tr_b16 v[86:87], v13 offset:9728
  v_mul_f32 v21, s76, v21
  v_mul_f32 v22, s76, v22
  v_mfma_f32_16x16x32_bf16 v[136:139], v[40:43], v[232:235], 0
  buffer_load_dwordx4 v6, s[32:35], s26 offen offset:3072 sc1 lds
  v_mul_f32 v23, s76, v23
  v_cvt_pk_bf16_f32 v28, v16, v17
  v_mfma_f32_16x16x32_bf16 v[152:155], v[44:47], v[232:235], 0
  s_add_u32 s26, s26, 1024
  ds_read_b64_tr_b16 v[88:89], v12 offset:8960
  v_cvt_pk_bf16_f32 v29, v18, v19
  v_cvt_pk_bf16_f32 v30, v20, v21
  v_mfma_f32_16x16x32_bf16 v[168:171], v[48:51], v[232:235], 0
  ds_read_b64_tr_b16 v[90:91], v12 offset:9984
  v_cvt_pk_bf16_f32 v31, v22, v23
  v_mfma_f32_16x16x32_bf16 v[184:187], v[52:55], v[232:235], 0
  ds_read_b64_tr_b16 v[92:93], v13 offset:8960
  buffer_store_dwordx4 v[28:31], v2, s[40:43], s63 offen offset:1024 sc1
  v_accvgpr_read_b32 v16, a8
  v_mfma_f32_16x16x32_bf16 v[200:203], v[56:59], v[232:235], 0
  s_add_u32 s63, s63, s61
  ds_read_b64_tr_b16 v[94:95], v13 offset:9984
  v_accvgpr_read_b32 v17, a9
  v_accvgpr_read_b32 v18, a10
  v_mfma_f32_16x16x32_bf16 v[216:219], v[60:63], v[232:235], 0
  v_accvgpr_read_b32 v19, a11
  v_accvgpr_read_b32 v20, a40
  v_accvgpr_read_b32 v21, a41
  v_mfma_f32_16x16x32_bf16 v[108:111], v[32:35], v[236:239], 0
  ds_read_b128 v[248:251], v14 offset:34816
  v_accvgpr_read_b32 v22, a42
  v_accvgpr_read_b32 v23, a43
  v_mfma_f32_16x16x32_bf16 v[124:127], v[36:39], v[236:239], 0
  ds_read_b128 v[252:255], v14 offset:35840
  v_mul_f32 v16, s76, v16
  v_mul_f32 v17, s76, v17
  v_mfma_f32_16x16x32_bf16 v[140:143], v[40:43], v[236:239], 0
  v_mul_f32 v18, s76, v18
  v_mul_f32 v19, s76, v19
  v_mul_f32 v20, s76, v20
  v_mfma_f32_16x16x32_bf16 v[156:159], v[44:47], v[236:239], 0
  v_xor_b32 v14, 0x10000, v14
  v_mul_f32 v21, s76, v21
  v_mul_f32 v22, s76, v22
  v_mfma_f32_16x16x32_bf16 v[172:175], v[48:51], v[236:239], 0
  v_mul_f32 v23, s76, v23
  v_cvt_pk_bf16_f32 v24, v16, v17
  v_cvt_pk_bf16_f32 v25, v18, v19
  v_mfma_f32_16x16x32_bf16 v[188:191], v[52:55], v[236:239], 0
  v_cvt_pk_bf16_f32 v26, v20, v21
  v_cvt_pk_bf16_f32 v27, v22, v23
  v_mfma_f32_16x16x32_bf16 v[204:207], v[56:59], v[236:239], 0
  buffer_store_dwordx4 v[24:27], v2, s[40:43], s63 offen offset:0 sc1
  v_mfma_f32_16x16x32_bf16 v[220:223], v[60:63], v[236:239], 0
  s_waitcnt vmcnt(20) lgkmcnt(0)
  v_mfma_f32_16x16x32_bf16 v[96:99], v[64:67], v[240:243], v[96:99]
  s_barrier
  v_accvgpr_read_b32 v16, a12
  v_accvgpr_read_b32 v17, a13
  v_accvgpr_read_b32 v18, a14
  v_accvgpr_read_b32 v19, a15
  v_mfma_f32_16x16x32_bf16 v[112:115], v[68:71], v[240:243], v[112:115]
  ds_read_b64_tr_b16 v[32:33], v12 offset:32768
  v_accvgpr_read_b32 v20, a44
  v_accvgpr_read_b32 v21, a45
  v_mfma_f32_16x16x32_bf16 v[128:131], v[72:75], v[240:243], v[128:131]
  s_add_u32 m0, s24, 32768
  ds_read_b64_tr_b16 v[34:35], v12 offset:33792
  v_accvgpr_read_b32 v22, a46
  v_accvgpr_read_b32 v23, a47
  v_mfma_f32_16x16x32_bf16 v[144:147], v[76:79], v[240:243], v[144:147]
  buffer_load_dwordx4 v3, s[32:35], s26 offen offset:0 sc1 lds
  v_mul_f32 v16, s76, v16
  v_mul_f32 v17, s76, v17
  v_mfma_f32_16x16x32_bf16 v[160:163], v[80:83], v[240:243], v[160:163]
  ds_read_b64_tr_b16 v[36:37], v13 offset:32768
  v_mul_f32 v18, s76, v18
  v_mul_f32 v19, s76, v19
  v_mfma_f32_16x16x32_bf16 v[176:179], v[84:87], v[240:243], v[176:179]
  ds_read_b64_tr_b16 v[38:39], v13 offset:33792
  v_mul_f32 v20, s76, v20
  v_mul_f32 v21, s76, v21
  v_mfma_f32_16x16x32_bf16 v[192:195], v[88:91], v[240:243], v[192:195]
  ds_read_b64_tr_b16 v[40:41], v12 offset:33024
  v_mul_f32 v22, s76, v22
  v_mul_f32 v23, s76, v23
  v_mfma_f32_16x16x32_bf16 v[208:211], v[92:95], v[240:243], v[208:211]
  ds_read_b64_tr_b16 v[42:43], v12 offset:34048
  v_cvt_pk_bf16_f32 v28, v16, v17
  v_cvt_pk_bf16_f32 v29, v18, v19
  v_mfma_f32_16x16x32_bf16 v[100:103], v[64:67], v[244:247], v[100:103]
  buffer_load_dwordx4 v4, s[32:35], s26 offen offset:1024 sc1 lds
  v_cvt_pk_bf16_f32 v30, v20, v21
  v_cvt_pk_bf16_f32 v31, v22, v23
  v_mfma_f32_16x16x32_bf16 v[116:119], v[68:71], v[244:247], v[116:119]
  ds_read_b64_tr_b16 v[44:45], v13 offset:33024
  buffer_store_dwordx4 v[28:31], v2, s[40:43], s63 offen offset:1024 sc1
  v_accvgpr_read_b32 v16, a16
  v_mfma_f32_16x16x32_bf16 v[132:135], v[72:75], v[244:247], v[132:135]
  s_add_u32 s63, s63, s61
  ds_read_b64_tr_b16 v[46:47], v13 offset:34048
  v_accvgpr_read_b32 v17, a17
  v_accvgpr_read_b32 v18, a18
  v_mfma_f32_16x16x32_bf16 v[148:151], v[76:79], v[244:247], v[148:151]
  ds_read_b128 v[224:227], v14 offset:0
  v_accvgpr_read_b32 v19, a19
  v_accvgpr_read_b32 v20, a48
  v_mfma_f32_16x16x32_bf16 v[164:167], v[80:83], v[244:247], v[164:167]
  ds_read_b128 v[228:231], v14 offset:1024
  v_accvgpr_read_b32 v21, a49
  v_accvgpr_read_b32 v22, a50
  v_mfma_f32_16x16x32_bf16 v[180:183], v[84:87], v[244:247], v[180:183]
  buffer_load_dwordx4 v5, s[32:35], s26 offen offset:2048 sc1 lds
  v_accvgpr_read_b32 v23, a51
  v_mul_f32 v16, s76, v16
  v_mfma_f32_16x16x32_bf16 v[196:199], v[88:91], v[244:247], v[196:199]
  ds_read_b64_tr_b16 v[48:49], v12 offset:33280
  v_mul_f32 v17, s76, v17
  v_mul_f32 v18, s76, v18
  v_mfma_f32_16x16x32_bf16 v[212:215], v[92:95], v[244:247], v[212:215]
  ds_read_b64_tr_b16 v[50:51], v12 offset:34304
  v_mul_f32 v19, s76, v19
  v_mul_f32 v20, s76, v20
  v_mfma_f32_16x16x32_bf16 v[104:107], v[64:67], v[248:251], v[104:107]
  ds_read_b64_tr_b16 v[52:53], v13 offset:33280
  v_mul_f32 v21, s76, v21
  v_mul_f32 v22, s76, v22
  v_mfma_f32_16x16x32_bf16 v[120:123], v[68:71], v[248:251], v[120:123]
  ds_read_b64_tr_b16 v[54:55], v13 offset:34304
  v_mul_f32 v23, s76, v23
  v_cvt_pk_bf16_f32 v24, v16, v17
  v_mfma_f32_16x16x32_bf16 v[136:139], v[72:75], v[248:251], v[136:139]
  buffer_load_dwordx4 v6, s[32:35], s26 offen offset:3072 sc1 lds
  v_cvt_pk_bf16_f32 v25, v18, v19
  v_cvt_pk_bf16_f32 v26, v20, v21
  v_mfma_f32_16x16x32_bf16 v[152:155], v[76:79], v[248:251], v[152:155]
  s_add_u32 s26, s26, 1024
  ds_read_b64_tr_b16 v[56:57], v12 offset:33536
  v_cvt_pk_bf16_f32 v27, v22, v23
  v_mfma_f32_16x16x32_bf16 v[168:171], v[80:83], v[248:251], v[168:171]
  ds_read_b64_tr_b16 v[58:59], v12 offset:34560
  buffer_store_dwordx4 v[24:27], v2, s[40:43], s63 offen offset:0 sc1
  v_accvgpr_read_b32 v16, a20
  v_mfma_f32_16x16x32_bf16 v[184:187], v[84:87], v[248:251], v[184:187]
  ds_read_b64_tr_b16 v[60:61], v13 offset:33536
  v_accvgpr_read_b32 v17, a21
  v_accvgpr_read_b32 v18, a22
  v_mfma_f32_16x16x32_bf16 v[200:203], v[88:91], v[248:251], v[200:203]
  s_add_u32 m0, s24, 16384
  ds_read_b64_tr_b16 v[62:63], v13 offset:34560
  v_accvgpr_read_b32 v19, a23
  v_accvgpr_read_b32 v20, a52
  v_mfma_f32_16x16x32_bf16 v[216:219], v[92:95], v[248:251], v[216:219]
  buffer_load_dwordx4 v8, s[36:39], s27 offen offset:0 lds
  v_accvgpr_read_b32 v21, a53
  v_accvgpr_read_b32 v22, a54
  v_mfma_f32_16x16x32_bf16 v[108:111], v[64:67], v[252:255], v[108:111]
  ds_read_b128 v[232:235], v14 offset:2048
  v_accvgpr_read_b32 v23, a55
  v_mul_f32 v16, s76, v16
  v_mfma_f32_16x16x32_bf16 v[124:127], v[68:71], v[252:255], v[124:127]
  ds_read_b128 v[236:239], v14 offset:3072
  v_mul_f32 v17, s76, v17
  v_mul_f32 v18, s76, v18
  v_mfma_f32_16x16x32_bf16 v[140:143], v[72:75], v[252:255], v[140:143]
  v_mul_f32 v19, s76, v19
  v_mul_f32 v20, s76, v20
  v_mul_f32 v21, s76, v21
  v_mfma_f32_16x16x32_bf16 v[156:159], v[76:79], v[252:255], v[156:159]
  v_mul_f32 v22, s76, v22
  v_mul_f32 v23, s76, v23
  v_cvt_pk_bf16_f32 v28, v16, v17
  v_mfma_f32_16x16x32_bf16 v[172:175], v[80:83], v[252:255], v[172:175]
  buffer_load_dwordx4 v9, s[36:39], s27 offen offset:1024 lds
  v_cvt_pk_bf16_f32 v29, v18, v19
  v_cvt_pk_bf16_f32 v30, v20, v21
  v_mfma_f32_16x16x32_bf16 v[188:191], v[84:87], v[252:255], v[188:191]
  v_cvt_pk_bf16_f32 v31, v22, v23
  v_mfma_f32_16x16x32_bf16 v[204:207], v[88:91], v[252:255], v[204:207]
  buffer_store_dwordx4 v[28:31], v2, s[40:43], s63 offen offset:1024 sc1
  v_mfma_f32_16x16x32_bf16 v[220:223], v[92:95], v[252:255], v[220:223]
  s_waitcnt vmcnt(20) lgkmcnt(0)
  v_mfma_f32_16x16x32_bf16 v[96:99], v[32:35], v[224:227], v[96:99]
  s_add_u32 s63, s63, s61
  v_accvgpr_read_b32 v16, a24
  v_accvgpr_read_b32 v17, a25
  v_accvgpr_read_b32 v18, a26
  v_accvgpr_read_b32 v19, a27
  v_mfma_f32_16x16x32_bf16 v[112:115], v[36:39], v[224:227], v[112:115]
  ds_read_b64_tr_b16 v[64:65], v12 offset:40960
  v_accvgpr_read_b32 v20, a56
  v_accvgpr_read_b32 v21, a57
  v_mfma_f32_16x16x32_bf16 v[128:131], v[40:43], v[224:227], v[128:131]
  s_add_u32 m0, s24, 65536
  ds_read_b64_tr_b16 v[66:67], v12 offset:41984
  v_accvgpr_read_b32 v22, a58
  v_accvgpr_read_b32 v23, a59
  v_mfma_f32_16x16x32_bf16 v[144:147], v[44:47], v[224:227], v[144:147]
  buffer_load_dwordx4 v3, s[32:35], s26 offen offset:0 sc1 lds
  v_mul_f32 v16, s76, v16
  v_mul_f32 v17, s76, v17
  v_mfma_f32_16x16x32_bf16 v[160:163], v[48:51], v[224:227], v[160:163]
  ds_read_b64_tr_b16 v[68:69], v13 offset:40960
  v_mul_f32 v18, s76, v18
  v_mul_f32 v19, s76, v19
  v_mfma_f32_16x16x32_bf16 v[176:179], v[52:55], v[224:227], v[176:179]
  ds_read_b64_tr_b16 v[70:71], v13 offset:41984
  v_mul_f32 v20, s76, v20
  v_mul_f32 v21, s76, v21
  v_mfma_f32_16x16x32_bf16 v[192:195], v[56:59], v[224:227], v[192:195]
  ds_read_b64_tr_b16 v[72:73], v12 offset:41216
  v_mul_f32 v22, s76, v22
  v_mul_f32 v23, s76, v23
  v_mfma_f32_16x16x32_bf16 v[208:211], v[60:63], v[224:227], v[208:211]
  ds_read_b64_tr_b16 v[74:75], v12 offset:42240
  v_cvt_pk_bf16_f32 v24, v16, v17
  v_cvt_pk_bf16_f32 v25, v18, v19
  v_cvt_pk_bf16_f32 v26, v20, v21
  v_mfma_f32_16x16x32_bf16 v[100:103], v[32:35], v[228:231], v[100:103]
  buffer_load_dwordx4 v4, s[32:35], s26 offen offset:1024 sc1 lds
  v_cvt_pk_bf16_f32 v27, v22, v23
  v_mfma_f32_16x16x32_bf16 v[116:119], v[36:39], v[228:231], v[116:119]
  ds_read_b64_tr_b16 v[76:77], v13 offset:41216
  buffer_store_dwordx4 v[24:27], v2, s[40:43], s63 offen offset:0 sc1
  v_accvgpr_read_b32 v16, a28
  v_mfma_f32_16x16x32_bf16 v[132:135], v[40:43], v[228:231], v[132:135]
  ds_read_b64_tr_b16 v[78:79], v13 offset:42240
  v_accvgpr_read_b32 v17, a29
  v_accvgpr_read_b32 v18, a30
  v_mfma_f32_16x16x32_bf16 v[148:151], v[44:47], v[228:231], v[148:151]
  ds_read_b128 v[240:243], v14 offset:32768
  v_accvgpr_read_b32 v19, a31
  v_accvgpr_read_b32 v20, a60
  v_mfma_f32_16x16x32_bf16 v[164:167], v[48:51], v[228:231], v[164:167]
  ds_read_b128 v[244:247], v14 offset:33792
  v_accvgpr_read_b32 v21, a61
  v_accvgpr_read_b32 v22, a62
  v_mfma_f32_16x16x32_bf16 v[180:183], v[52:55], v[228:231], v[180:183]
  buffer_load_dwordx4 v5, s[32:35], s26 offen offset:2048 sc1 lds
  v_accvgpr_read_b32 v23, a63
  v_mul_f32 v16, s76, v16
  v_mfma_f32_16x16x32_bf16 v[196:199], v[56:59], v[228:231], v[196:199]
  ds_read_b64_tr_b16 v[80:81], v12 offset:41472
  v_mul_f32 v17, s76, v17
  v_mul_f32 v18, s76, v18
  v_mfma_f32_16x16x32_bf16 v[212:215], v[60:63], v[228:231], v[212:215]
  ds_read_b64_tr_b16 v[82:83], v12 offset:42496
  v_mul_f32 v19, s76, v19
  v_mul_f32 v20, s76, v20
  v_mul_f32 v21, s76, v21
  v_mfma_f32_16x16x32_bf16 v[104:107], v[32:35], v[232:235], v[104:107]
  ds_read_b64_tr_b16 v[84:85], v13 offset:41472
  v_mul_f32 v22, s76, v22
  v_mul_f32 v23, s76, v23
  v_mfma_f32_16x16x32_bf16 v[120:123], v[36:39], v[232:235], v[120:123]
  ds_read_b64_tr_b16 v[86:87], v13 offset:42496
  v_cvt_pk_bf16_f32 v28, v16, v17
  v_cvt_pk_bf16_f32 v29, v18, v19
  v_mfma_f32_16x16x32_bf16 v[136:139], v[40:43], v[232:235], v[136:139]
  buffer_load_dwordx4 v6, s[32:35], s26 offen offset:3072 sc1 lds
  v_cvt_pk_bf16_f32 v30, v20, v21
  v_cvt_pk_bf16_f32 v31, v22, v23
  v_mfma_f32_16x16x32_bf16 v[152:155], v[44:47], v[232:235], v[152:155]
  s_add_u32 s26, s26, 1024
  ds_read_b64_tr_b16 v[88:89], v12 offset:41728
  buffer_store_dwordx4 v[28:31], v2, s[40:43], s63 offen offset:1024 sc1
  v_accvgpr_read_b32 v16, a64
  v_mfma_f32_16x16x32_bf16 v[168:171], v[48:51], v[232:235], v[168:171]
  s_mul_i32 s63, s60, 1
  ds_read_b64_tr_b16 v[90:91], v12 offset:42752
  v_accvgpr_read_b32 v17, a65
  v_accvgpr_read_b32 v18, a66
  v_mfma_f32_16x16x32_bf16 v[184:187], v[52:55], v[232:235], v[184:187]
  s_add_u32 s63, s63, s62
  ds_read_b64_tr_b16 v[92:93], v13 offset:41728
  v_accvgpr_read_b32 v19, a67
  v_accvgpr_read_b32 v20, a96
  v_mfma_f32_16x16x32_bf16 v[200:203], v[56:59], v[232:235], v[200:203]
  s_add_u32 m0, s24, 16384
  ds_read_b64_tr_b16 v[94:95], v13 offset:42752
  v_accvgpr_read_b32 v21, a97
  v_accvgpr_read_b32 v22, a98
  v_accvgpr_read_b32 v23, a99
  v_mfma_f32_16x16x32_bf16 v[216:219], v[60:63], v[232:235], v[216:219]
  buffer_load_dwordx4 v10, s[36:39], s27 offen offset:2048 lds
  v_mul_f32 v16, s76, v16
  v_mul_f32 v17, s76, v17
  v_mfma_f32_16x16x32_bf16 v[108:111], v[32:35], v[236:239], v[108:111]
  ds_read_b128 v[248:251], v14 offset:34816
  v_mul_f32 v18, s76, v18
  v_mul_f32 v19, s76, v19
  v_mfma_f32_16x16x32_bf16 v[124:127], v[36:39], v[236:239], v[124:127]
  ds_read_b128 v[252:255], v14 offset:35840
  v_mul_f32 v20, s76, v20
  v_mul_f32 v21, s76, v21
  v_mfma_f32_16x16x32_bf16 v[140:143], v[40:43], v[236:239], v[140:143]
  v_mul_f32 v22, s76, v22
  v_mul_f32 v23, s76, v23
  v_cvt_pk_bf16_f32 v24, v16, v17
  v_mfma_f32_16x16x32_bf16 v[156:159], v[44:47], v[236:239], v[156:159]
  v_xor_b32 v14, 0x10000, v14
  v_cvt_pk_bf16_f32 v25, v18, v19
  v_cvt_pk_bf16_f32 v26, v20, v21
  v_mfma_f32_16x16x32_bf16 v[172:175], v[48:51], v[236:239], v[172:175]
  buffer_load_dwordx4 v11, s[36:39], s27 offen offset:3072 lds
  v_cvt_pk_bf16_f32 v27, v22, v23
  v_mfma_f32_16x16x32_bf16 v[188:191], v[52:55], v[236:239], v[188:191]
  s_add_u32 s27, s27, 524288
  buffer_store_dwordx4 v[24:27], v2, s[40:43], s63 offen offset:0 sc1
  v_xor_b32 v12, 0x10000, v12
  v_mfma_f32_16x16x32_bf16 v[204:207], v[56:59], v[236:239], v[204:207]
  v_xor_b32 v13, 0x10000, v13
  v_mfma_f32_16x16x32_bf16 v[220:223], v[60:63], v[236:239], v[220:223]
  s_waitcnt vmcnt(20) lgkmcnt(0)
  v_mfma_f32_16x16x32_bf16 v[96:99], v[64:67], v[240:243], v[96:99]
  s_barrier
  v_accvgpr_read_b32 v16, a68
  v_accvgpr_read_b32 v17, a69
  v_accvgpr_read_b32 v18, a70
  v_accvgpr_read_b32 v19, a71
  v_mfma_f32_16x16x32_bf16 v[112:115], v[68:71], v[240:243], v[112:115]
  ds_read_b64_tr_b16 v[32:33], v12 offset:0
  v_accvgpr_read_b32 v20, a100
  v_accvgpr_read_b32 v21, a101
  v_mfma_f32_16x16x32_bf16 v[128:131], v[72:75], v[240:243], v[128:131]
  s_add_u32 m0, s24, 98304
  ds_read_b64_tr_b16 v[34:35], v12 offset:1024
  v_accvgpr_read_b32 v22, a102
  v_accvgpr_read_b32 v23, a103
  v_mfma_f32_16x16x32_bf16 v[144:147], v[76:79], v[240:243], v[144:147]
  buffer_load_dwordx4 v3, s[32:35], s26 offen offset:0 sc1 lds
  v_mul_f32 v16, s76, v16
  v_mul_f32 v17, s76, v17
  v_mfma_f32_16x16x32_bf16 v[160:163], v[80:83], v[240:243], v[160:163]
  ds_read_b64_tr_b16 v[36:37], v13 offset:0
  v_mul_f32 v18, s76, v18
  v_mul_f32 v19, s76, v19
  v_mfma_f32_16x16x32_bf16 v[176:179], v[84:87], v[240:243], v[176:179]
  ds_read_b64_tr_b16 v[38:39], v13 offset:1024
  v_mul_f32 v20, s76, v20
  v_mul_f32 v21, s76, v21
  v_mfma_f32_16x16x32_bf16 v[192:195], v[88:91], v[240:243], v[192:195]
  ds_read_b64_tr_b16 v[40:41], v12 offset:256
  v_mul_f32 v22, s76, v22
  v_mul_f32 v23, s76, v23
  v_mfma_f32_16x16x32_bf16 v[208:211], v[92:95], v[240:243], v[208:211]
  ds_read_b64_tr_b16 v[42:43], v12 offset:1280
  v_cvt_pk_bf16_f32 v28, v16, v17
  v_cvt_pk_bf16_f32 v29, v18, v19
  v_mfma_f32_16x16x32_bf16 v[100:103], v[64:67], v[244:247], v[100:103]
  buffer_load_dwordx4 v4, s[32:35], s26 offen offset:1024 sc1 lds
  v_cvt_pk_bf16_f32 v30, v20, v21
  v_cvt_pk_bf16_f32 v31, v22, v23
  v_mfma_f32_16x16x32_bf16 v[116:119], v[68:71], v[244:247], v[116:119]
  ds_read_b64_tr_b16 v[44:45], v13 offset:256
  buffer_store_dwordx4 v[28:31], v2, s[40:43], s63 offen offset:1024 sc1
  v_accvgpr_read_b32 v16, a72
  v_mfma_f32_16x16x32_bf16 v[132:135], v[72:75], v[244:247], v[132:135]
  s_add_u32 s63, s63, s61
  ds_read_b64_tr_b16 v[46:47], v13 offset:1280
  v_accvgpr_read_b32 v17, a73
  v_accvgpr_read_b32 v18, a74
  v_mfma_f32_16x16x32_bf16 v[148:151], v[76:79], v[244:247], v[148:151]
  ds_read_b128 v[224:227], v14 offset:0
  v_accvgpr_read_b32 v19, a75
  v_accvgpr_read_b32 v20, a104
  v_mfma_f32_16x16x32_bf16 v[164:167], v[80:83], v[244:247], v[164:167]
  ds_read_b128 v[228:231], v14 offset:1024
  v_accvgpr_read_b32 v21, a105
  v_accvgpr_read_b32 v22, a106
  v_mfma_f32_16x16x32_bf16 v[180:183], v[84:87], v[244:247], v[180:183]
  buffer_load_dwordx4 v5, s[32:35], s26 offen offset:2048 sc1 lds
  v_accvgpr_read_b32 v23, a107
  v_mul_f32 v16, s76, v16
  v_mfma_f32_16x16x32_bf16 v[196:199], v[88:91], v[244:247], v[196:199]
  ds_read_b64_tr_b16 v[48:49], v12 offset:512
  v_mul_f32 v17, s76, v17
  v_mul_f32 v18, s76, v18
  v_mfma_f32_16x16x32_bf16 v[212:215], v[92:95], v[244:247], v[212:215]
  ds_read_b64_tr_b16 v[50:51], v12 offset:1536
  v_mul_f32 v19, s76, v19
  v_mul_f32 v20, s76, v20
  v_mfma_f32_16x16x32_bf16 v[104:107], v[64:67], v[248:251], v[104:107]
  ds_read_b64_tr_b16 v[52:53], v13 offset:512
  v_mul_f32 v21, s76, v21
  v_mul_f32 v22, s76, v22
  v_mfma_f32_16x16x32_bf16 v[120:123], v[68:71], v[248:251], v[120:123]
  ds_read_b64_tr_b16 v[54:55], v13 offset:1536
  v_mul_f32 v23, s76, v23
  v_cvt_pk_bf16_f32 v24, v16, v17
  v_mfma_f32_16x16x32_bf16 v[136:139], v[72:75], v[248:251], v[136:139]
  buffer_load_dwordx4 v6, s[32:35], s26 offen offset:3072 sc1 lds
  v_cvt_pk_bf16_f32 v25, v18, v19
  v_cvt_pk_bf16_f32 v26, v20, v21
  v_mfma_f32_16x16x32_bf16 v[152:155], v[76:79], v[248:251], v[152:155]
  s_add_u32 s26, s26, 1024
  ds_read_b64_tr_b16 v[56:57], v12 offset:768
  v_cvt_pk_bf16_f32 v27, v22, v23
  v_mfma_f32_16x16x32_bf16 v[168:171], v[80:83], v[248:251], v[168:171]
  ds_read_b64_tr_b16 v[58:59], v12 offset:1792
  buffer_store_dwordx4 v[24:27], v2, s[40:43], s63 offen offset:0 sc1
  v_accvgpr_read_b32 v16, a76
  v_mfma_f32_16x16x32_bf16 v[184:187], v[84:87], v[248:251], v[184:187]
  ds_read_b64_tr_b16 v[60:61], v13 offset:768
  v_accvgpr_read_b32 v17, a77
  v_accvgpr_read_b32 v18, a78
  v_mfma_f32_16x16x32_bf16 v[200:203], v[88:91], v[248:251], v[200:203]
  s_add_u32 m0, s24, 49152
  ds_read_b64_tr_b16 v[62:63], v13 offset:1792
  v_accvgpr_read_b32 v19, a79
  v_accvgpr_read_b32 v20, a108
  v_mfma_f32_16x16x32_bf16 v[216:219], v[92:95], v[248:251], v[216:219]
  buffer_load_dwordx4 v8, s[36:39], s27 offen offset:0 lds
  v_accvgpr_read_b32 v21, a109
  v_accvgpr_read_b32 v22, a110
  v_mfma_f32_16x16x32_bf16 v[108:111], v[64:67], v[252:255], v[108:111]
  ds_read_b128 v[232:235], v14 offset:2048
  v_accvgpr_read_b32 v23, a111
  v_mul_f32 v16, s76, v16
  v_mfma_f32_16x16x32_bf16 v[124:127], v[68:71], v[252:255], v[124:127]
  ds_read_b128 v[236:239], v14 offset:3072
  v_mul_f32 v17, s76, v17
  v_mul_f32 v18, s76, v18
  v_mfma_f32_16x16x32_bf16 v[140:143], v[72:75], v[252:255], v[140:143]
  v_mul_f32 v19, s76, v19
  v_mul_f32 v20, s76, v20
  v_mul_f32 v21, s76, v21
  v_mfma_f32_16x16x32_bf16 v[156:159], v[76:79], v[252:255], v[156:159]
  v_mul_f32 v22, s76, v22
  v_mul_f32 v23, s76, v23
  v_cvt_pk_bf16_f32 v28, v16, v17
  v_mfma_f32_16x16x32_bf16 v[172:175], v[80:83], v[252:255], v[172:175]
  buffer_load_dwordx4 v9, s[36:39], s27 offen offset:1024 lds
  v_cvt_pk_bf16_f32 v29, v18, v19
  v_cvt_pk_bf16_f32 v30, v20, v21
  v_mfma_f32_16x16x32_bf16 v[188:191], v[84:87], v[252:255], v[188:191]
  v_cvt_pk_bf16_f32 v31, v22, v23
  v_mfma_f32_16x16x32_bf16 v[204:207], v[88:91], v[252:255], v[204:207]
  buffer_store_dwordx4 v[28:31], v2, s[40:43], s63 offen offset:1024 sc1
  v_mfma_f32_16x16x32_bf16 v[220:223], v[92:95], v[252:255], v[220:223]
  s_waitcnt vmcnt(22) lgkmcnt(0)
  v_mfma_f32_16x16x32_bf16 v[96:99], v[32:35], v[224:227], v[96:99]
  s_add_u32 s63, s63, s61
  v_accvgpr_read_b32 v16, a80
  v_accvgpr_read_b32 v17, a81
  v_accvgpr_read_b32 v18, a82
  v_accvgpr_read_b32 v19, a83
  v_mfma_f32_16x16x32_bf16 v[112:115], v[36:39], v[224:227], v[112:115]
  ds_read_b64_tr_b16 v[64:65], v12 offset:8192
  v_accvgpr_read_b32 v20, a112
  v_accvgpr_read_b32 v21, a113
  v_mfma_f32_16x16x32_bf16 v[128:131], v[40:43], v[224:227], v[128:131]
  s_add_u32 m0, s24, 0
  ds_read_b64_tr_b16 v[66:67], v12 offset:9216
  v_accvgpr_read_b32 v22, a114
  v_accvgpr_read_b32 v23, a115
  v_mfma_f32_16x16x32_bf16 v[144:147], v[44:47], v[224:227], v[144:147]
  buffer_load_dwordx4 v3, s[32:35], s26 offen offset:0 sc1 lds
  v_mul_f32 v16, s76, v16
  v_mul_f32 v17, s76, v17
  v_mfma_f32_16x16x32_bf16 v[160:163], v[48:51], v[224:227], v[160:163]
  ds_read_b64_tr_b16 v[68:69], v13 offset:8192
  v_mul_f32 v18, s76, v18
  v_mul_f32 v19, s76, v19
  v_mfma_f32_16x16x32_bf16 v[176:179], v[52:55], v[224:227], v[176:179]
  ds_read_b64_tr_b16 v[70:71], v13 offset:9216
  v_mul_f32 v20, s76, v20
  v_mul_f32 v21, s76, v21
  v_mfma_f32_16x16x32_bf16 v[192:195], v[56:59], v[224:227], v[192:195]
  ds_read_b64_tr_b16 v[72:73], v12 offset:8448
  v_mul_f32 v22, s76, v22
  v_mul_f32 v23, s76, v23
  v_mfma_f32_16x16x32_bf16 v[208:211], v[60:63], v[224:227], v[208:211]
  ds_read_b64_tr_b16 v[74:75], v12 offset:9472
  v_cvt_pk_bf16_f32 v24, v16, v17
  v_cvt_pk_bf16_f32 v25, v18, v19
  v_mfma_f32_16x16x32_bf16 v[100:103], v[32:35], v[228:231], v[100:103]
  buffer_load_dwordx4 v4, s[32:35], s26 offen offset:1024 sc1 lds
  v_cvt_pk_bf16_f32 v26, v20, v21
  v_cvt_pk_bf16_f32 v27, v22, v23
  v_mfma_f32_16x16x32_bf16 v[116:119], v[36:39], v[228:231], v[116:119]
  ds_read_b64_tr_b16 v[76:77], v13 offset:8448
  buffer_store_dwordx4 v[24:27], v2, s[40:43], s63 offen offset:0 sc1
  v_accvgpr_read_b32 v16, a84
  v_mfma_f32_16x16x32_bf16 v[132:135], v[40:43], v[228:231], v[132:135]
  ds_read_b64_tr_b16 v[78:79], v13 offset:9472
  v_accvgpr_read_b32 v17, a85
  v_accvgpr_read_b32 v18, a86
  v_mfma_f32_16x16x32_bf16 v[148:151], v[44:47], v[228:231], v[148:151]
  ds_read_b128 v[240:243], v14 offset:32768
  v_accvgpr_read_b32 v19, a87
  v_accvgpr_read_b32 v20, a116
  v_mfma_f32_16x16x32_bf16 v[164:167], v[48:51], v[228:231], v[164:167]
  ds_read_b128 v[244:247], v14 offset:33792
  v_accvgpr_read_b32 v21, a117
  v_accvgpr_read_b32 v22, a118
  v_mfma_f32_16x16x32_bf16 v[180:183], v[52:55], v[228:231], v[180:183]
  buffer_load_dwordx4 v5, s[32:35], s26 offen offset:2048 sc1 lds
  v_accvgpr_read_b32 v23, a119
  v_mul_f32 v16, s76, v16
  v_mfma_f32_16x16x32_bf16 v[196:199], v[56:59], v[228:231], v[196:199]
  ds_read_b64_tr_b16 v[80:81], v12 offset:8704
  v_mul_f32 v17, s76, v17
  v_mul_f32 v18, s76, v18
  v_mfma_f32_16x16x32_bf16 v[212:215], v[60:63], v[228:231], v[212:215]
  ds_read_b64_tr_b16 v[82:83], v12 offset:9728
  v_mul_f32 v19, s76, v19
  v_mul_f32 v20, s76, v20
  v_mul_f32 v21, s76, v21
  v_mfma_f32_16x16x32_bf16 v[104:107], v[32:35], v[232:235], v[104:107]
  ds_read_b64_tr_b16 v[84:85], v13 offset:8704
  v_mul_f32 v22, s76, v22
  v_mul_f32 v23, s76, v23
  v_mfma_f32_16x16x32_bf16 v[120:123], v[36:39], v[232:235], v[120:123]
  ds_read_b64_tr_b16 v[86:87], v13 offset:9728
  v_cvt_pk_bf16_f32 v28, v16, v17
  v_cvt_pk_bf16_f32 v29, v18, v19
  v_mfma_f32_16x16x32_bf16 v[136:139], v[40:43], v[232:235], v[136:139]
  buffer_load_dwordx4 v6, s[32:35], s26 offen offset:3072 sc1 lds
  v_cvt_pk_bf16_f32 v30, v20, v21
  v_cvt_pk_bf16_f32 v31, v22, v23
  v_mfma_f32_16x16x32_bf16 v[152:155], v[44:47], v[232:235], v[152:155]
  s_add_u32 s26, s26, 1024
  ds_read_b64_tr_b16 v[88:89], v12 offset:8960
  buffer_store_dwordx4 v[28:31], v2, s[40:43], s63 offen offset:1024 sc1
  v_accvgpr_read_b32 v16, a88
  v_mfma_f32_16x16x32_bf16 v[168:171], v[48:51], v[232:235], v[168:171]
  s_add_u32 s63, s63, s61
  ds_read_b64_tr_b16 v[90:91], v12 offset:9984
  v_accvgpr_read_b32 v17, a89
  v_accvgpr_read_b32 v18, a90
  v_mfma_f32_16x16x32_bf16 v[184:187], v[52:55], v[232:235], v[184:187]
  ds_read_b64_tr_b16 v[92:93], v13 offset:8960
  v_accvgpr_read_b32 v19, a91
  v_accvgpr_read_b32 v20, a120
  v_mfma_f32_16x16x32_bf16 v[200:203], v[56:59], v[232:235], v[200:203]
  s_add_u32 m0, s24, 49152
  ds_read_b64_tr_b16 v[94:95], v13 offset:9984
  v_accvgpr_read_b32 v21, a121
  v_accvgpr_read_b32 v22, a122
  v_mfma_f32_16x16x32_bf16 v[216:219], v[60:63], v[232:235], v[216:219]
  buffer_load_dwordx4 v10, s[36:39], s27 offen offset:2048 lds
  v_accvgpr_read_b32 v23, a123
  v_mul_f32 v16, s76, v16
  v_mfma_f32_16x16x32_bf16 v[108:111], v[32:35], v[236:239], v[108:111]
  ds_read_b128 v[248:251], v14 offset:34816
  v_mul_f32 v17, s76, v17
  v_mul_f32 v18, s76, v18
  v_mfma_f32_16x16x32_bf16 v[124:127], v[36:39], v[236:239], v[124:127]
  ds_read_b128 v[252:255], v14 offset:35840
  v_mul_f32 v19, s76, v19
  v_mul_f32 v20, s76, v20
  v_mfma_f32_16x16x32_bf16 v[140:143], v[40:43], v[236:239], v[140:143]
  v_mul_f32 v21, s76, v21
  v_mul_f32 v22, s76, v22
  v_mul_f32 v23, s76, v23
  v_mfma_f32_16x16x32_bf16 v[156:159], v[44:47], v[236:239], v[156:159]
  v_xor_b32 v14, 0x10000, v14
  v_cvt_pk_bf16_f32 v24, v16, v17
  v_cvt_pk_bf16_f32 v25, v18, v19
  v_mfma_f32_16x16x32_bf16 v[172:175], v[48:51], v[236:239], v[172:175]
  buffer_load_dwordx4 v11, s[36:39], s27 offen offset:3072 lds
  v_cvt_pk_bf16_f32 v26, v20, v21
  v_cvt_pk_bf16_f32 v27, v22, v23
  v_mfma_f32_16x16x32_bf16 v[188:191], v[52:55], v[236:239], v[188:191]
  s_add_u32 s27, s27, 524288
  buffer_store_dwordx4 v[24:27], v2, s[40:43], s63 offen offset:0 sc1
  v_mfma_f32_16x16x32_bf16 v[204:207], v[56:59], v[236:239], v[204:207]
  v_mfma_f32_16x16x32_bf16 v[220:223], v[60:63], v[236:239], v[220:223]
  s_waitcnt vmcnt(22) lgkmcnt(0)
  v_mfma_f32_16x16x32_bf16 v[96:99], v[64:67], v[240:243], v[96:99]
  s_barrier
  v_accvgpr_read_b32 v16, a92
  v_accvgpr_read_b32 v17, a93
  v_accvgpr_read_b32 v18, a94
  v_accvgpr_read_b32 v19, a95
  v_mfma_f32_16x16x32_bf16 v[112:115], v[68:71], v[240:243], v[112:115]
  ds_read_b64_tr_b16 v[32:33], v12 offset:32768
  v_accvgpr_read_b32 v20, a124
  v_accvgpr_read_b32 v21, a125
  v_mfma_f32_16x16x32_bf16 v[128:131], v[72:75], v[240:243], v[128:131]
  s_add_u32 m0, s24, 32768
  ds_read_b64_tr_b16 v[34:35], v12 offset:33792
  v_accvgpr_read_b32 v22, a126
  v_accvgpr_read_b32 v23, a127
  v_mfma_f32_16x16x32_bf16 v[144:147], v[76:79], v[240:243], v[144:147]
  buffer_load_dwordx4 v3, s[32:35], s26 offen offset:0 sc1 lds
  v_mul_f32 v16, s76, v16
  v_mul_f32 v17, s76, v17
  v_mfma_f32_16x16x32_bf16 v[160:163], v[80:83], v[240:243], v[160:163]
  ds_read_b64_tr_b16 v[36:37], v13 offset:32768
  v_mul_f32 v18, s76, v18
  v_mul_f32 v19, s76, v19
  v_mfma_f32_16x16x32_bf16 v[176:179], v[84:87], v[240:243], v[176:179]
  ds_read_b64_tr_b16 v[38:39], v13 offset:33792
  v_mul_f32 v20, s76, v20
  v_mul_f32 v21, s76, v21
  v_mfma_f32_16x16x32_bf16 v[192:195], v[88:91], v[240:243], v[192:195]
  ds_read_b64_tr_b16 v[40:41], v12 offset:33024
  v_mul_f32 v22, s76, v22
  v_mul_f32 v23, s76, v23
  v_mfma_f32_16x16x32_bf16 v[208:211], v[92:95], v[240:243], v[208:211]
  ds_read_b64_tr_b16 v[42:43], v12 offset:34048
  v_cvt_pk_bf16_f32 v28, v16, v17
  v_cvt_pk_bf16_f32 v29, v18, v19
  v_mfma_f32_16x16x32_bf16 v[100:103], v[64:67], v[244:247], v[100:103]
  buffer_load_dwordx4 v4, s[32:35], s26 offen offset:1024 sc1 lds
  v_cvt_pk_bf16_f32 v30, v20, v21
  v_cvt_pk_bf16_f32 v31, v22, v23
  v_mfma_f32_16x16x32_bf16 v[116:119], v[68:71], v[244:247], v[116:119]
  ds_read_b64_tr_b16 v[44:45], v13 offset:33024
  buffer_store_dwordx4 v[28:31], v2, s[40:43], s63 offen offset:1024 sc1
  v_accvgpr_read_b32 v16, a128
  v_mfma_f32_16x16x32_bf16 v[132:135], v[72:75], v[244:247], v[132:135]
  s_mul_i32 s63, s60, 2
  ds_read_b64_tr_b16 v[46:47], v13 offset:34048
  v_accvgpr_read_b32 v17, a129
  v_accvgpr_read_b32 v18, a130
  v_mfma_f32_16x16x32_bf16 v[148:151], v[76:79], v[244:247], v[148:151]
  s_add_u32 s63, s63, s62
  ds_read_b128 v[224:227], v14 offset:0
  v_accvgpr_read_b32 v19, a131
  v_accvgpr_read_b32 v20, a160
  v_mfma_f32_16x16x32_bf16 v[164:167], v[80:83], v[244:247], v[164:167]
  ds_read_b128 v[228:231], v14 offset:1024
  v_accvgpr_read_b32 v21, a161
  v_accvgpr_read_b32 v22, a162
  v_mfma_f32_16x16x32_bf16 v[180:183], v[84:87], v[244:247], v[180:183]
  buffer_load_dwordx4 v5, s[32:35], s26 offen offset:2048 sc1 lds
  v_accvgpr_read_b32 v23, a163
  v_mul_f32 v16, s76, v16
  v_mfma_f32_16x16x32_bf16 v[196:199], v[88:91], v[244:247], v[196:199]
  ds_read_b64_tr_b16 v[48:49], v12 offset:33280
  v_mul_f32 v17, s76, v17
  v_mul_f32 v18, s76, v18
  v_mfma_f32_16x16x32_bf16 v[212:215], v[92:95], v[244:247], v[212:215]
  ds_read_b64_tr_b16 v[50:51], v12 offset:34304
  v_mul_f32 v19, s76, v19
  v_mul_f32 v20, s76, v20
  v_mfma_f32_16x16x32_bf16 v[104:107], v[64:67], v[248:251], v[104:107]
  ds_read_b64_tr_b16 v[52:53], v13 offset:33280
  v_mul_f32 v21, s76, v21
  v_mul_f32 v22, s76, v22
  v_mfma_f32_16x16x32_bf16 v[120:123], v[68:71], v[248:251], v[120:123]
  ds_read_b64_tr_b16 v[54:55], v13 offset:34304
  v_mul_f32 v23, s76, v23
  v_cvt_pk_bf16_f32 v24, v16, v17
  v_mfma_f32_16x16x32_bf16 v[136:139], v[72:75], v[248:251], v[136:139]
  buffer_load_dwordx4 v6, s[32:35], s26 offen offset:3072 sc1 lds
  v_cvt_pk_bf16_f32 v25, v18, v19
  v_cvt_pk_bf16_f32 v26, v20, v21
  v_mfma_f32_16x16x32_bf16 v[152:155], v[76:79], v[248:251], v[152:155]
  s_add_u32 s26, s26, 1024
  ds_read_b64_tr_b16 v[56:57], v12 offset:33536
  v_cvt_pk_bf16_f32 v27, v22, v23
  v_mfma_f32_16x16x32_bf16 v[168:171], v[80:83], v[248:251], v[168:171]
  ds_read_b64_tr_b16 v[58:59], v12 offset:34560
  buffer_store_dwordx4 v[24:27], v2, s[40:43], s63 offen offset:0 sc1
  v_accvgpr_read_b32 v16, a132
  v_mfma_f32_16x16x32_bf16 v[184:187], v[84:87], v[248:251], v[184:187]
  ds_read_b64_tr_b16 v[60:61], v13 offset:33536
  v_accvgpr_read_b32 v17, a133
  v_accvgpr_read_b32 v18, a134
  v_mfma_f32_16x16x32_bf16 v[200:203], v[88:91], v[248:251], v[200:203]
  s_add_u32 m0, s24, 81920
  ds_read_b64_tr_b16 v[62:63], v13 offset:34560
  v_accvgpr_read_b32 v19, a135
  v_accvgpr_read_b32 v20, a164
  v_mfma_f32_16x16x32_bf16 v[216:219], v[92:95], v[248:251], v[216:219]
  buffer_load_dwordx4 v8, s[36:39], s27 offen offset:0 lds
  v_accvgpr_read_b32 v21, a165
  v_accvgpr_read_b32 v22, a166
  v_mfma_f32_16x16x32_bf16 v[108:111], v[64:67], v[252:255], v[108:111]
  ds_read_b128 v[232:235], v14 offset:2048
  v_accvgpr_read_b32 v23, a167
  v_mul_f32 v16, s76, v16
  v_mfma_f32_16x16x32_bf16 v[124:127], v[68:71], v[252:255], v[124:127]
  ds_read_b128 v[236:239], v14 offset:3072
  v_mul_f32 v17, s76, v17
  v_mul_f32 v18, s76, v18
  v_mfma_f32_16x16x32_bf16 v[140:143], v[72:75], v[252:255], v[140:143]
  v_mul_f32 v19, s76, v19
  v_mul_f32 v20, s76, v20
  v_mul_f32 v21, s76, v21
  v_mfma_f32_16x16x32_bf16 v[156:159], v[76:79], v[252:255], v[156:159]
  v_mul_f32 v22, s76, v22
  v_mul_f32 v23, s76, v23
  v_cvt_pk_bf16_f32 v28, v16, v17
  v_mfma_f32_16x16x32_bf16 v[172:175], v[80:83], v[252:255], v[172:175]
  buffer_load_dwordx4 v9, s[36:39], s27 offen offset:1024 lds
  v_cvt_pk_bf16_f32 v29, v18, v19
  v_cvt_pk_bf16_f32 v30, v20, v21
  v_mfma_f32_16x16x32_bf16 v[188:191], v[84:87], v[252:255], v[188:191]
  v_cvt_pk_bf16_f32 v31, v22, v23
  v_mfma_f32_16x16x32_bf16 v[204:207], v[88:91], v[252:255], v[204:207]
  buffer_store_dwordx4 v[28:31], v2, s[40:43], s63 offen offset:1024 sc1
  v_mfma_f32_16x16x32_bf16 v[220:223], v[92:95], v[252:255], v[220:223]
  s_waitcnt vmcnt(22) lgkmcnt(0)
  v_mfma_f32_16x16x32_bf16 v[96:99], v[32:35], v[224:227], v[96:99]
  s_add_u32 s63, s63, s61
  v_accvgpr_read_b32 v16, a136
  v_accvgpr_read_b32 v17, a137
  v_accvgpr_read_b32 v18, a138
  v_mfma_f32_16x16x32_bf16 v[112:115], v[36:39], v[224:227], v[112:115]
  ds_read_b64_tr_b16 v[64:65], v12 offset:40960
  v_accvgpr_read_b32 v19, a139
  v_mfma_f32_16x16x32_bf16 v[128:131], v[40:43], v[224:227], v[128:131]
  s_add_u32 m0, s24, 65536
  ds_read_b64_tr_b16 v[66:67], v12 offset:41984
  v_accvgpr_read_b32 v20, a168
  v_accvgpr_read_b32 v21, a169
  v_mfma_f32_16x16x32_bf16 v[144:147], v[44:47], v[224:227], v[144:147]
  buffer_load_dwordx4 v3, s[32:35], s26 offen offset:0 sc1 lds
  v_accvgpr_read_b32 v22, a170
  v_mfma_f32_16x16x32_bf16 v[160:163], v[48:51], v[224:227], v[160:163]
  ds_read_b64_tr_b16 v[68:69], v13 offset:40960
  v_accvgpr_read_b32 v23, a171
  v_mfma_f32_16x16x32_bf16 v[176:179], v[52:55], v[224:227], v[176:179]
  ds_read_b64_tr_b16 v[70:71], v13 offset:41984
  v_mul_f32 v16, s76, v16
  v_mul_f32 v17, s76, v17
  v_mfma_f32_16x16x32_bf16 v[192:195], v[56:59], v[224:227], v[192:195]
  ds_read_b64_tr_b16 v[72:73], v12 offset:41216
  v_mul_f32 v18, s76, v18
  v_mfma_f32_16x16x32_bf16 v[208:211], v[60:63], v[224:227], v[208:211]
  ds_read_b64_tr_b16 v[74:75], v12 offset:42240
  v_mul_f32 v19, s76, v19
  v_mul_f32 v20, s76, v20
  v_mfma_f32_16x16x32_bf16 v[100:103], v[32:35], v[228:231], v[100:103]
  buffer_load_dwordx4 v4, s[32:35], s26 offen offset:1024 sc1 lds
  v_mul_f32 v21, s76, v21
  v_mfma_f32_16x16x32_bf16 v[116:119], v[36:39], v[228:231], v[116:119]
  ds_read_b64_tr_b16 v[76:77], v13 offset:41216
  v_mul_f32 v22, s76, v22
  v_mfma_f32_16x16x32_bf16 v[132:135], v[40:43], v[228:231], v[132:135]
  ds_read_b64_tr_b16 v[78:79], v13 offset:42240
  v_mul_f32 v23, s76, v23
  v_cvt_pk_bf16_f32 v24, v16, v17
  v_mfma_f32_16x16x32_bf16 v[148:151], v[44:47], v[228:231], v[148:151]
  ds_read_b128 v[240:243], v14 offset:32768
  v_cvt_pk_bf16_f32 v25, v18, v19
  v_mfma_f32_16x16x32_bf16 v[164:167], v[48:51], v[228:231], v[164:167]
  ds_read_b128 v[244:247], v14 offset:33792
  v_cvt_pk_bf16_f32 v26, v20, v21
  v_cvt_pk_bf16_f32 v27, v22, v23
  v_mfma_f32_16x16x32_bf16 v[180:183], v[52:55], v[228:231], v[180:183]
  buffer_load_dwordx4 v5, s[32:35], s26 offen offset:2048 sc1 lds
  buffer_store_dwordx4 v[24:27], v2, s[40:43], s63 offen offset:0 sc1
  v_mfma_f32_16x16x32_bf16 v[196:199], v[56:59], v[228:231], v[196:199]
  ds_read_b64_tr_b16 v[80:81], v12 offset:41472
  v_accvgpr_read_b32 v16, a140
  v_mfma_f32_16x16x32_bf16 v[212:215], v[60:63], v[228:231], v[212:215]
  ds_read_b64_tr_b16 v[82:83], v12 offset:42496
  v_accvgpr_read_b32 v17, a141
  v_accvgpr_read_b32 v18, a142
  v_mfma_f32_16x16x32_bf16 v[104:107], v[32:35], v[232:235], v[104:107]
  ds_read_b64_tr_b16 v[84:85], v13 offset:41472
  v_accvgpr_read_b32 v19, a143
  v_mfma_f32_16x16x32_bf16 v[120:123], v[36:39], v[232:235], v[120:123]
  ds_read_b64_tr_b16 v[86:87], v13 offset:42496
  v_accvgpr_read_b32 v20, a172
  v_accvgpr_read_b32 v21, a173
  v_mfma_f32_16x16x32_bf16 v[136:139], v[40:43], v[232:235], v[136:139]
  buffer_load_dwordx4 v6, s[32:35], s26 offen offset:3072 sc1 lds
  v_accvgpr_read_b32 v22, a174
  v_mfma_f32_16x16x32_bf16 v[152:155], v[44:47], v[232:235], v[152:155]
  s_add_u32 s26, s26, 1024
  ds_read_b64_tr_b16 v[88:89], v12 offset:41728
  v_accvgpr_read_b32 v23, a175
  v_mfma_f32_16x16x32_bf16 v[168:171], v[48:51], v[232:235], v[168:171]
  ds_read_b64_tr_b16 v[90:91], v12 offset:42752
  v_mul_f32 v16, s76, v16
  v_mul_f32 v17, s76, v17
  v_mfma_f32_16x16x32_bf16 v[184:187], v[52:55], v[232:235], v[184:187]
  ds_read_b64_tr_b16 v[92:93], v13 offset:41728
  v_mul_f32 v18, s76, v18
  v_mfma_f32_16x16x32_bf16 v[200:203], v[56:59], v[232:235], v[200:203]
  s_add_u32 m0, s24, 81920
  ds_read_b64_tr_b16 v[94:95], v13 offset:42752
  v_mul_f32 v19, s76, v19
  v_mul_f32 v20, s76, v20
  v_mfma_f32_16x16x32_bf16 v[216:219], v[60:63], v[232:235], v[216:219]
  buffer_load_dwordx4 v10, s[36:39], s27 offen offset:2048 lds
  v_mul_f32 v21, s76, v21
  v_mfma_f32_16x16x32_bf16 v[108:111], v[32:35], v[236:239], v[108:111]
  ds_read_b128 v[248:251], v14 offset:34816
  v_mul_f32 v22, s76, v22
  v_mfma_f32_16x16x32_bf16 v[124:127], v[36:39], v[236:239], v[124:127]
  ds_read_b128 v[252:255], v14 offset:35840
  v_mul_f32 v23, s76, v23
  v_cvt_pk_bf16_f32 v28, v16, v17
  v_mfma_f32_16x16x32_bf16 v[140:143], v[40:43], v[236:239], v[140:143]
  v_cvt_pk_bf16_f32 v29, v18, v19
  v_cvt_pk_bf16_f32 v30, v20, v21
  v_mfma_f32_16x16x32_bf16 v[156:159], v[44:47], v[236:239], v[156:159]
  v_xor_b32 v14, 0x10000, v14
  v_cvt_pk_bf16_f32 v31, v22, v23
  v_mfma_f32_16x16x32_bf16 v[172:175], v[48:51], v[236:239], v[172:175]
  buffer_load_dwordx4 v11, s[36:39], s27 offen offset:3072 lds
  buffer_store_dwordx4 v[28:31], v2, s[40:43], s63 offen offset:1024 sc1
  v_mfma_f32_16x16x32_bf16 v[188:191], v[52:55], v[236:239], v[188:191]
  s_add_u32 s27, s27, 524288
  v_xor_b32 v12, 0x10000, v12
  v_mfma_f32_16x16x32_bf16 v[204:207], v[56:59], v[236:239], v[204:207]
  v_xor_b32 v13, 0x10000, v13
  v_mfma_f32_16x16x32_bf16 v[220:223], v[60:63], v[236:239], v[220:223]
  s_waitcnt vmcnt(21) lgkmcnt(0)
  v_mfma_f32_16x16x32_bf16 v[96:99], v[64:67], v[240:243], v[96:99]
  s_barrier
  v_accvgpr_read_b32 v16, a144
  v_accvgpr_read_b32 v17, a145
  v_accvgpr_read_b32 v18, a146
  v_mfma_f32_16x16x32_bf16 v[112:115], v[68:71], v[240:243], v[112:115]
  s_add_u32 s63, s63, s61
  ds_read_b64_tr_b16 v[32:33], v12 offset:0
  v_accvgpr_read_b32 v19, a147
  v_mfma_f32_16x16x32_bf16 v[128:131], v[72:75], v[240:243], v[128:131]
  s_add_u32 m0, s24, 98304
  ds_read_b64_tr_b16 v[34:35], v12 offset:1024
  v_accvgpr_read_b32 v20, a176
  v_mfma_f32_16x16x32_bf16 v[144:147], v[76:79], v[240:243], v[144:147]
  buffer_load_dwordx4 v3, s[32:35], s26 offen offset:0 sc1 lds
  v_accvgpr_read_b32 v21, a177
  v_accvgpr_read_b32 v22, a178
  v_mfma_f32_16x16x32_bf16 v[160:163], v[80:83], v[240:243], v[160:163]
  ds_read_b64_tr_b16 v[36:37], v13 offset:0
  v_accvgpr_read_b32 v23, a179
  v_mfma_f32_16x16x32_bf16 v[176:179], v[84:87], v[240:243], v[176:179]
  ds_read_b64_tr_b16 v[38:39], v13 offset:1024
  v_mul_f32 v16, s76, v16
  v_mfma_f32_16x16x32_bf16 v[192:195], v[88:91], v[240:243], v[192:195]
  ds_read_b64_tr_b16 v[40:41], v12 offset:256
  v_mul_f32 v17, s76, v17
  v_mul_f32 v18, s76, v18
  v_mfma_f32_16x16x32_bf16 v[208:211], v[92:95], v[240:243], v[208:211]
  ds_read_b64_tr_b16 v[42:43], v12 offset:1280
  v_mul_f32 v19, s76, v19
  v_mfma_f32_16x16x32_bf16 v[100:103], v[64:67], v[244:247], v[100:103]
  buffer_load_dwordx4 v4, s[32:35], s26 offen offset:1024 sc1 lds
  v_mul_f32 v20, s76, v20
  v_mfma_f32_16x16x32_bf16 v[116:119], v[68:71], v[244:247], v[116:119]
  ds_read_b64_tr_b16 v[44:45], v13 offset:256
  v_mul_f32 v21, s76, v21
  v_mfma_f32_16x16x32_bf16 v[132:135], v[72:75], v[244:247], v[132:135]
  ds_read_b64_tr_b16 v[46:47], v13 offset:1280
  v_mul_f32 v22, s76, v22
  v_mul_f32 v23, s76, v23
  v_mfma_f32_16x16x32_bf16 v[148:151], v[76:79], v[244:247], v[148:151]
  ds_read_b128 v[224:227], v14 offset:0
  v_cvt_pk_bf16_f32 v24, v16, v17
  v_mfma_f32_16x16x32_bf16 v[164:167], v[80:83], v[244:247], v[164:167]
  ds_read_b128 v[228:231], v14 offset:1024
  v_cvt_pk_bf16_f32 v25, v18, v19
  v_mfma_f32_16x16x32_bf16 v[180:183], v[84:87], v[244:247], v[180:183]
  buffer_load_dwordx4 v5, s[32:35], s26 offen offset:2048 sc1 lds
  v_cvt_pk_bf16_f32 v26, v20, v21
  v_cvt_pk_bf16_f32 v27, v22, v23
  v_mfma_f32_16x16x32_bf16 v[196:199], v[88:91], v[244:247], v[196:199]
  ds_read_b64_tr_b16 v[48:49], v12 offset:512
  buffer_store_dwordx4 v[24:27], v2, s[40:43], s63 offen offset:0 sc1
  v_mfma_f32_16x16x32_bf16 v[212:215], v[92:95], v[244:247], v[212:215]
  ds_read_b64_tr_b16 v[50:51], v12 offset:1536
  v_accvgpr_read_b32 v16, a148
  v_mfma_f32_16x16x32_bf16 v[104:107], v[64:67], v[248:251], v[104:107]
  ds_read_b64_tr_b16 v[52:53], v13 offset:512
  v_accvgpr_read_b32 v17, a149
  v_accvgpr_read_b32 v18, a150
  v_mfma_f32_16x16x32_bf16 v[120:123], v[68:71], v[248:251], v[120:123]
  ds_read_b64_tr_b16 v[54:55], v13 offset:1536
  v_accvgpr_read_b32 v19, a151
  v_mfma_f32_16x16x32_bf16 v[136:139], v[72:75], v[248:251], v[136:139]
  buffer_load_dwordx4 v6, s[32:35], s26 offen offset:3072 sc1 lds
  v_accvgpr_read_b32 v20, a180
  v_mfma_f32_16x16x32_bf16 v[152:155], v[76:79], v[248:251], v[152:155]
  s_add_u32 s26, s26, 1024
  ds_read_b64_tr_b16 v[56:57], v12 offset:768
  v_accvgpr_read_b32 v21, a181
  v_mfma_f32_16x16x32_bf16 v[168:171], v[80:83], v[248:251], v[168:171]
  ds_read_b64_tr_b16 v[58:59], v12 offset:1792
  v_accvgpr_read_b32 v22, a182
  v_accvgpr_read_b32 v23, a183
  v_mfma_f32_16x16x32_bf16 v[184:187], v[84:87], v[248:251], v[184:187]
  ds_read_b64_tr_b16 v[60:61], v13 offset:768
  v_mul_f32 v16, s76, v16
  v_mfma_f32_16x16x32_bf16 v[200:203], v[88:91], v[248:251], v[200:203]
  s_add_u32 m0, s24, 114688
  ds_read_b64_tr_b16 v[62:63], v13 offset:1792
  v_mul_f32 v17, s76, v17
  v_mfma_f32_16x16x32_bf16 v[216:219], v[92:95], v[248:251], v[216:219]
  buffer_load_dwordx4 v8, s[36:39], s27 offen offset:0 lds
  v_mul_f32 v18, s76, v18
  v_mul_f32 v19, s76, v19
  v_mfma_f32_16x16x32_bf16 v[108:111], v[64:67], v[252:255], v[108:111]
  ds_read_b128 v[232:235], v14 offset:2048
  v_mul_f32 v20, s76, v20
  v_mfma_f32_16x16x32_bf16 v[124:127], v[68:71], v[252:255], v[124:127]
  ds_read_b128 v[236:239], v14 offset:3072
  v_mul_f32 v21, s76, v21
  v_mfma_f32_16x16x32_bf16 v[140:143], v[72:75], v[252:255], v[140:143]
  v_mul_f32 v22, s76, v22
  v_mul_f32 v23, s76, v23
  v_cvt_pk_bf16_f32 v28, v16, v17
  v_mfma_f32_16x16x32_bf16 v[156:159], v[76:79], v[252:255], v[156:159]
  v_cvt_pk_bf16_f32 v29, v18, v19
  v_cvt_pk_bf16_f32 v30, v20, v21
  v_mfma_f32_16x16x32_bf16 v[172:175], v[80:83], v[252:255], v[172:175]
  buffer_load_dwordx4 v9, s[36:39], s27 offen offset:1024 lds
  v_cvt_pk_bf16_f32 v31, v22, v23
  v_mfma_f32_16x16x32_bf16 v[188:191], v[84:87], v[252:255], v[188:191]
  buffer_store_dwordx4 v[28:31], v2, s[40:43], s63 offen offset:1024 sc1
  v_mfma_f32_16x16x32_bf16 v[204:207], v[88:91], v[252:255], v[204:207]
  v_mfma_f32_16x16x32_bf16 v[220:223], v[92:95], v[252:255], v[220:223]
  s_waitcnt vmcnt(20) lgkmcnt(0)
  v_mfma_f32_16x16x32_bf16 v[96:99], v[32:35], v[224:227], v[96:99]
  s_add_u32 s63, s63, s61
  v_accvgpr_read_b32 v16, a152
  v_accvgpr_read_b32 v17, a153
  v_accvgpr_read_b32 v18, a154
  v_mfma_f32_16x16x32_bf16 v[112:115], v[36:39], v[224:227], v[112:115]
  ds_read_b64_tr_b16 v[64:65], v12 offset:8192
  v_accvgpr_read_b32 v19, a155
  v_mfma_f32_16x16x32_bf16 v[128:131], v[40:43], v[224:227], v[128:131]
  s_add_u32 m0, s24, 0
  ds_read_b64_tr_b16 v[66:67], v12 offset:9216
  v_accvgpr_read_b32 v20, a184
  v_mfma_f32_16x16x32_bf16 v[144:147], v[44:47], v[224:227], v[144:147]
  buffer_load_dwordx4 v3, s[32:35], s26 offen offset:0 sc1 lds
  v_accvgpr_read_b32 v21, a185
  v_accvgpr_read_b32 v22, a186
  v_mfma_f32_16x16x32_bf16 v[160:163], v[48:51], v[224:227], v[160:163]
  ds_read_b64_tr_b16 v[68:69], v13 offset:8192
  v_accvgpr_read_b32 v23, a187
  v_mfma_f32_16x16x32_bf16 v[176:179], v[52:55], v[224:227], v[176:179]
  ds_read_b64_tr_b16 v[70:71], v13 offset:9216
  v_mul_f32 v16, s76, v16
  v_mfma_f32_16x16x32_bf16 v[192:195], v[56:59], v[224:227], v[192:195]
  ds_read_b64_tr_b16 v[72:73], v12 offset:8448
  v_mul_f32 v17, s76, v17
  v_mul_f32 v18, s76, v18
  v_mfma_f32_16x16x32_bf16 v[208:211], v[60:63], v[224:227], v[208:211]
  ds_read_b64_tr_b16 v[74:75], v12 offset:9472
  v_mul_f32 v19, s76, v19
  v_mfma_f32_16x16x32_bf16 v[100:103], v[32:35], v[228:231], v[100:103]
  buffer_load_dwordx4 v4, s[32:35], s26 offen offset:1024 sc1 lds
  v_mul_f32 v20, s76, v20
  v_mfma_f32_16x16x32_bf16 v[116:119], v[36:39], v[228:231], v[116:119]
  ds_read_b64_tr_b16 v[76:77], v13 offset:8448
  v_mul_f32 v21, s76, v21
  v_mul_f32 v22, s76, v22
  v_mfma_f32_16x16x32_bf16 v[132:135], v[40:43], v[228:231], v[132:135]
  ds_read_b64_tr_b16 v[78:79], v13 offset:9472
  v_mul_f32 v23, s76, v23
  v_mfma_f32_16x16x32_bf16 v[148:151], v[44:47], v[228:231], v[148:151]
  ds_read_b128 v[240:243], v14 offset:32768
  v_cvt_pk_bf16_f32 v24, v16, v17
  v_mfma_f32_16x16x32_bf16 v[164:167], v[48:51], v[228:231], v[164:167]
  ds_read_b128 v[244:247], v14 offset:33792
  v_cvt_pk_bf16_f32 v25, v18, v19
  v_cvt_pk_bf16_f32 v26, v20, v21
  v_mfma_f32_16x16x32_bf16 v[180:183], v[52:55], v[228:231], v[180:183]
  buffer_load_dwordx4 v5, s[32:35], s26 offen offset:2048 sc1 lds
  v_cvt_pk_bf16_f32 v27, v22, v23
  v_mfma_f32_16x16x32_bf16 v[196:199], v[56:59], v[228:231], v[196:199]
  ds_read_b64_tr_b16 v[80:81], v12 offset:8704
  buffer_store_dwordx4 v[24:27], v2, s[40:43], s63 offen offset:0 sc1
  v_mfma_f32_16x16x32_bf16 v[212:215], v[60:63], v[228:231], v[212:215]
  ds_read_b64_tr_b16 v[82:83], v12 offset:9728
  v_accvgpr_read_b32 v16, a156
  v_accvgpr_read_b32 v17, a157
  v_mfma_f32_16x16x32_bf16 v[104:107], v[32:35], v[232:235], v[104:107]
  ds_read_b64_tr_b16 v[84:85], v13 offset:8704
  v_accvgpr_read_b32 v18, a158
  v_mfma_f32_16x16x32_bf16 v[120:123], v[36:39], v[232:235], v[120:123]
  ds_read_b64_tr_b16 v[86:87], v13 offset:9728
  v_accvgpr_read_b32 v19, a159
  v_mfma_f32_16x16x32_bf16 v[136:139], v[40:43], v[232:235], v[136:139]
  buffer_load_dwordx4 v6, s[32:35], s26 offen offset:3072 sc1 lds
  v_accvgpr_read_b32 v20, a188
  v_accvgpr_read_b32 v21, a189
  v_mfma_f32_16x16x32_bf16 v[152:155], v[44:47], v[232:235], v[152:155]
  s_add_u32 s26, s26, 1024
  ds_read_b64_tr_b16 v[88:89], v12 offset:8960
  v_accvgpr_read_b32 v22, a190
  v_mfma_f32_16x16x32_bf16 v[168:171], v[48:51], v[232:235], v[168:171]
  ds_read_b64_tr_b16 v[90:91], v12 offset:9984
  v_accvgpr_read_b32 v23, a191
  v_mfma_f32_16x16x32_bf16 v[184:187], v[52:55], v[232:235], v[184:187]
  ds_read_b64_tr_b16 v[92:93], v13 offset:8960
  v_mul_f32 v16, s76, v16
  v_mul_f32 v17, s76, v17
  v_mfma_f32_16x16x32_bf16 v[200:203], v[56:59], v[232:235], v[200:203]
  s_add_u32 m0, s24, 114688
  ds_read_b64_tr_b16 v[94:95], v13 offset:9984
  v_mul_f32 v18, s76, v18
  v_mfma_f32_16x16x32_bf16 v[216:219], v[60:63], v[232:235], v[216:219]
  buffer_load_dwordx4 v10, s[36:39], s27 offen offset:2048 lds
  v_mul_f32 v19, s76, v19
  v_mfma_f32_16x16x32_bf16 v[108:111], v[32:35], v[236:239], v[108:111]
  ds_read_b128 v[248:251], v14 offset:34816
  v_mul_f32 v20, s76, v20
  v_mul_f32 v21, s76, v21
  v_mfma_f32_16x16x32_bf16 v[124:127], v[36:39], v[236:239], v[124:127]
  ds_read_b128 v[252:255], v14 offset:35840
  v_mul_f32 v22, s76, v22
  v_mfma_f32_16x16x32_bf16 v[140:143], v[40:43], v[236:239], v[140:143]
  v_mul_f32 v23, s76, v23
  v_cvt_pk_bf16_f32 v28, v16, v17
  v_mfma_f32_16x16x32_bf16 v[156:159], v[44:47], v[236:239], v[156:159]
  v_xor_b32 v14, 0x10000, v14
  v_cvt_pk_bf16_f32 v29, v18, v19
  v_cvt_pk_bf16_f32 v30, v20, v21
  v_mfma_f32_16x16x32_bf16 v[172:175], v[48:51], v[236:239], v[172:175]
  buffer_load_dwordx4 v11, s[36:39], s27 offen offset:3072 lds
  v_cvt_pk_bf16_f32 v31, v22, v23
  v_mfma_f32_16x16x32_bf16 v[188:191], v[52:55], v[236:239], v[188:191]
  s_add_u32 s27, s27, 524288
  buffer_store_dwordx4 v[28:31], v2, s[40:43], s63 offen offset:1024 sc1
  v_mfma_f32_16x16x32_bf16 v[204:207], v[56:59], v[236:239], v[204:207]
  v_mfma_f32_16x16x32_bf16 v[220:223], v[60:63], v[236:239], v[220:223]
  s_waitcnt vmcnt(19) lgkmcnt(0)
  v_mfma_f32_16x16x32_bf16 v[96:99], v[64:67], v[240:243], v[96:99]
  s_barrier
  v_accvgpr_read_b32 v16, a192
  v_accvgpr_read_b32 v17, a193
  v_accvgpr_read_b32 v18, a194
  v_mfma_f32_16x16x32_bf16 v[112:115], v[68:71], v[240:243], v[112:115]
  s_mul_i32 s63, s60, 3
  ds_read_b64_tr_b16 v[32:33], v12 offset:32768
  v_accvgpr_read_b32 v19, a195
  v_mfma_f32_16x16x32_bf16 v[128:131], v[72:75], v[240:243], v[128:131]
  s_add_u32 m0, s24, 32768
  ds_read_b64_tr_b16 v[34:35], v12 offset:33792
  v_accvgpr_read_b32 v20, a224
  v_mfma_f32_16x16x32_bf16 v[144:147], v[76:79], v[240:243], v[144:147]
  s_add_u32 s63, s63, s62
  buffer_load_dwordx4 v3, s[32:35], s26 offen offset:0 sc1 lds
  v_accvgpr_read_b32 v21, a225
  v_accvgpr_read_b32 v22, a226
  v_mfma_f32_16x16x32_bf16 v[160:163], v[80:83], v[240:243], v[160:163]
  ds_read_b64_tr_b16 v[36:37], v13 offset:32768
  v_accvgpr_read_b32 v23, a227
  v_mfma_f32_16x16x32_bf16 v[176:179], v[84:87], v[240:243], v[176:179]
  ds_read_b64_tr_b16 v[38:39], v13 offset:33792
  v_mul_f32 v16, s76, v16
  v_mfma_f32_16x16x32_bf16 v[192:195], v[88:91], v[240:243], v[192:195]
  ds_read_b64_tr_b16 v[40:41], v12 offset:33024
  v_mul_f32 v17, s76, v17
  v_mul_f32 v18, s76, v18
  v_mfma_f32_16x16x32_bf16 v[208:211], v[92:95], v[240:243], v[208:211]
  ds_read_b64_tr_b16 v[42:43], v12 offset:34048
  v_mul_f32 v19, s76, v19
  v_mfma_f32_16x16x32_bf16 v[100:103], v[64:67], v[244:247], v[100:103]
  buffer_load_dwordx4 v4, s[32:35], s26 offen offset:1024 sc1 lds
  v_mul_f32 v20, s76, v20
  v_mfma_f32_16x16x32_bf16 v[116:119], v[68:71], v[244:247], v[116:119]
  ds_read_b64_tr_b16 v[44:45], v13 offset:33024
  v_mul_f32 v21, s76, v21
  v_mfma_f32_16x16x32_bf16 v[132:135], v[72:75], v[244:247], v[132:135]
  ds_read_b64_tr_b16 v[46:47], v13 offset:34048
  v_mul_f32 v22, s76, v22
  v_mul_f32 v23, s76, v23
  v_mfma_f32_16x16x32_bf16 v[148:151], v[76:79], v[244:247], v[148:151]
  ds_read_b128 v[224:227], v14 offset:0
  v_cvt_pk_bf16_f32 v24, v16, v17
  v_mfma_f32_16x16x32_bf16 v[164:167], v[80:83], v[244:247], v[164:167]
  ds_read_b128 v[228:231], v14 offset:1024
  v_cvt_pk_bf16_f32 v25, v18, v19
  v_mfma_f32_16x16x32_bf16 v[180:183], v[84:87], v[244:247], v[180:183]
  buffer_load_dwordx4 v5, s[32:35], s26 offen offset:2048 sc1 lds
  v_cvt_pk_bf16_f32 v26, v20, v21
  v_cvt_pk_bf16_f32 v27, v22, v23
  v_mfma_f32_16x16x32_bf16 v[196:199], v[88:91], v[244:247], v[196:199]
  ds_read_b64_tr_b16 v[48:49], v12 offset:33280
  buffer_store_dwordx4 v[24:27], v2, s[40:43], s63 offen offset:0 sc1
  v_mfma_f32_16x16x32_bf16 v[212:215], v[92:95], v[244:247], v[212:215]
  ds_read_b64_tr_b16 v[50:51], v12 offset:34304
  v_accvgpr_read_b32 v16, a196
  v_mfma_f32_16x16x32_bf16 v[104:107], v[64:67], v[248:251], v[104:107]
  ds_read_b64_tr_b16 v[52:53], v13 offset:33280
  v_accvgpr_read_b32 v17, a197
  v_accvgpr_read_b32 v18, a198
  v_mfma_f32_16x16x32_bf16 v[120:123], v[68:71], v[248:251], v[120:123]
  ds_read_b64_tr_b16 v[54:55], v13 offset:34304
  v_accvgpr_read_b32 v19, a199
  v_mfma_f32_16x16x32_bf16 v[136:139], v[72:75], v[248:251], v[136:139]
  buffer_load_dwordx4 v6, s[32:35], s26 offen offset:3072 sc1 lds
  v_accvgpr_read_b32 v20, a228
  v_mfma_f32_16x16x32_bf16 v[152:155], v[76:79], v[248:251], v[152:155]
  s_add_u32 s26, s26, 1024
  ds_read_b64_tr_b16 v[56:57], v12 offset:33536
  v_accvgpr_read_b32 v21, a229
  v_mfma_f32_16x16x32_bf16 v[168:171], v[80:83], v[248:251], v[168:171]
  ds_read_b64_tr_b16 v[58:59], v12 offset:34560
  v_accvgpr_read_b32 v22, a230
  v_accvgpr_read_b32 v23, a231
  v_mfma_f32_16x16x32_bf16 v[184:187], v[84:87], v[248:251], v[184:187]
  ds_read_b64_tr_b16 v[60:61], v13 offset:33536
  v_mul_f32 v16, s76, v16
  v_mfma_f32_16x16x32_bf16 v[200:203], v[88:91], v[248:251], v[200:203]
  s_add_u32 m0, s24, 16384
  ds_read_b64_tr_b16 v[62:63], v13 offset:34560
  v_mul_f32 v17, s76, v17
  v_mfma_f32_16x16x32_bf16 v[216:219], v[92:95], v[248:251], v[216:219]
  buffer_load_dwordx4 v8, s[36:39], s27 offen offset:0 lds
  v_mul_f32 v18, s76, v18
  v_mul_f32 v19, s76, v19
  v_mfma_f32_16x16x32_bf16 v[108:111], v[64:67], v[252:255], v[108:111]
  ds_read_b128 v[232:235], v14 offset:2048
  v_mul_f32 v20, s76, v20
  v_mfma_f32_16x16x32_bf16 v[124:127], v[68:71], v[252:255], v[124:127]
  ds_read_b128 v[236:239], v14 offset:3072
  v_mul_f32 v21, s76, v21
  v_mfma_f32_16x16x32_bf16 v[140:143], v[72:75], v[252:255], v[140:143]
  v_mul_f32 v22, s76, v22
  v_mul_f32 v23, s76, v23
  v_cvt_pk_bf16_f32 v28, v16, v17
  v_mfma_f32_16x16x32_bf16 v[156:159], v[76:79], v[252:255], v[156:159]
  v_cvt_pk_bf16_f32 v29, v18, v19
  v_cvt_pk_bf16_f32 v30, v20, v21
  v_mfma_f32_16x16x32_bf16 v[172:175], v[80:83], v[252:255], v[172:175]
  buffer_load_dwordx4 v9, s[36:39], s27 offen offset:1024 lds
  v_cvt_pk_bf16_f32 v31, v22, v23
  v_mfma_f32_16x16x32_bf16 v[188:191], v[84:87], v[252:255], v[188:191]
  buffer_store_dwordx4 v[28:31], v2, s[40:43], s63 offen offset:1024 sc1
  v_mfma_f32_16x16x32_bf16 v[204:207], v[88:91], v[252:255], v[204:207]
  v_mfma_f32_16x16x32_bf16 v[220:223], v[92:95], v[252:255], v[220:223]
  s_waitcnt vmcnt(19) lgkmcnt(0)
  v_mfma_f32_16x16x32_bf16 v[96:99], v[32:35], v[224:227], v[96:99]
  s_add_u32 s63, s63, s61
  v_accvgpr_read_b32 v16, a200
  v_accvgpr_read_b32 v17, a201
  v_accvgpr_read_b32 v18, a202
  v_mfma_f32_16x16x32_bf16 v[112:115], v[36:39], v[224:227], v[112:115]
  ds_read_b64_tr_b16 v[64:65], v12 offset:40960
  v_accvgpr_read_b32 v19, a203
  v_mfma_f32_16x16x32_bf16 v[128:131], v[40:43], v[224:227], v[128:131]
  s_add_u32 m0, s24, 65536
  ds_read_b64_tr_b16 v[66:67], v12 offset:41984
  v_accvgpr_read_b32 v20, a232
  v_accvgpr_read_b32 v21, a233
  v_mfma_f32_16x16x32_bf16 v[144:147], v[44:47], v[224:227], v[144:147]
  buffer_load_dwordx4 v3, s[32:35], s26 offen offset:0 sc1 lds
  v_accvgpr_read_b32 v22, a234
  v_mfma_f32_16x16x32_bf16 v[160:163], v[48:51], v[224:227], v[160:163]
  ds_read_b64_tr_b16 v[68:69], v13 offset:40960
  v_accvgpr_read_b32 v23, a235
  v_mfma_f32_16x16x32_bf16 v[176:179], v[52:55], v[224:227], v[176:179]
  ds_read_b64_tr_b16 v[70:71], v13 offset:41984
  v_mul_f32 v16, s76, v16
  v_mul_f32 v17, s76, v17
  v_mfma_f32_16x16x32_bf16 v[192:195], v[56:59], v[224:227], v[192:195]
  ds_read_b64_tr_b16 v[72:73], v12 offset:41216
  v_mul_f32 v18, s76, v18
  v_mfma_f32_16x16x32_bf16 v[208:211], v[60:63], v[224:227], v[208:211]
  ds_read_b64_tr_b16 v[74:75], v12 offset:42240
  v_mul_f32 v19, s76, v19
  v_mul_f32 v20, s76, v20
  v_mfma_f32_16x16x32_bf16 v[100:103], v[32:35], v[228:231], v[100:103]
  buffer_load_dwordx4 v4, s[32:35], s26 offen offset:1024 sc1 lds
  v_mul_f32 v21, s76, v21
  v_mfma_f32_16x16x32_bf16 v[116:119], v[36:39], v[228:231], v[116:119]
  ds_read_b64_tr_b16 v[76:77], v13 offset:41216
  v_mul_f32 v22, s76, v22
  v_mfma_f32_16x16x32_bf16 v[132:135], v[40:43], v[228:231], v[132:135]
  ds_read_b64_tr_b16 v[78:79], v13 offset:42240
  v_mul_f32 v23, s76, v23
  v_cvt_pk_bf16_f32 v24, v16, v17
  v_mfma_f32_16x16x32_bf16 v[148:151], v[44:47], v[228:231], v[148:151]
  ds_read_b128 v[240:243], v14 offset:32768
  v_cvt_pk_bf16_f32 v25, v18, v19
  v_mfma_f32_16x16x32_bf16 v[164:167], v[48:51], v[228:231], v[164:167]
  ds_read_b128 v[244:247], v14 offset:33792
  v_cvt_pk_bf16_f32 v26, v20, v21
  v_cvt_pk_bf16_f32 v27, v22, v23
  v_mfma_f32_16x16x32_bf16 v[180:183], v[52:55], v[228:231], v[180:183]
  buffer_load_dwordx4 v5, s[32:35], s26 offen offset:2048 sc1 lds
  buffer_store_dwordx4 v[24:27], v2, s[40:43], s63 offen offset:0 sc1
  v_mfma_f32_16x16x32_bf16 v[196:199], v[56:59], v[228:231], v[196:199]
  ds_read_b64_tr_b16 v[80:81], v12 offset:41472
  v_accvgpr_read_b32 v16, a204
  v_mfma_f32_16x16x32_bf16 v[212:215], v[60:63], v[228:231], v[212:215]
  ds_read_b64_tr_b16 v[82:83], v12 offset:42496
  v_accvgpr_read_b32 v17, a205
  v_accvgpr_read_b32 v18, a206
  v_mfma_f32_16x16x32_bf16 v[104:107], v[32:35], v[232:235], v[104:107]
  ds_read_b64_tr_b16 v[84:85], v13 offset:41472
  v_accvgpr_read_b32 v19, a207
  v_mfma_f32_16x16x32_bf16 v[120:123], v[36:39], v[232:235], v[120:123]
  ds_read_b64_tr_b16 v[86:87], v13 offset:42496
  v_accvgpr_read_b32 v20, a236
  v_accvgpr_read_b32 v21, a237
  v_mfma_f32_16x16x32_bf16 v[136:139], v[40:43], v[232:235], v[136:139]
  buffer_load_dwordx4 v6, s[32:35], s26 offen offset:3072 sc1 lds
  v_accvgpr_read_b32 v22, a238
  v_mfma_f32_16x16x32_bf16 v[152:155], v[44:47], v[232:235], v[152:155]
  s_add_u32 s26, s26, 1024
  ds_read_b64_tr_b16 v[88:89], v12 offset:41728
  v_accvgpr_read_b32 v23, a239
  v_mfma_f32_16x16x32_bf16 v[168:171], v[48:51], v[232:235], v[168:171]
  ds_read_b64_tr_b16 v[90:91], v12 offset:42752
  v_mul_f32 v16, s76, v16
  v_mul_f32 v17, s76, v17
  v_mfma_f32_16x16x32_bf16 v[184:187], v[52:55], v[232:235], v[184:187]
  ds_read_b64_tr_b16 v[92:93], v13 offset:41728
  v_mul_f32 v18, s76, v18
  v_mfma_f32_16x16x32_bf16 v[200:203], v[56:59], v[232:235], v[200:203]
  s_add_u32 m0, s24, 16384
  ds_read_b64_tr_b16 v[94:95], v13 offset:42752
  v_mul_f32 v19, s76, v19
  v_mul_f32 v20, s76, v20
  v_mfma_f32_16x16x32_bf16 v[216:219], v[60:63], v[232:235], v[216:219]
  buffer_load_dwordx4 v10, s[36:39], s27 offen offset:2048 lds
  v_mul_f32 v21, s76, v21
  v_mfma_f32_16x16x32_bf16 v[108:111], v[32:35], v[236:239], v[108:111]
  ds_read_b128 v[248:251], v14 offset:34816
  v_mul_f32 v22, s76, v22
  v_mfma_f32_16x16x32_bf16 v[124:127], v[36:39], v[236:239], v[124:127]
  ds_read_b128 v[252:255], v14 offset:35840
  v_mul_f32 v23, s76, v23
  v_cvt_pk_bf16_f32 v28, v16, v17
  v_mfma_f32_16x16x32_bf16 v[140:143], v[40:43], v[236:239], v[140:143]
  v_cvt_pk_bf16_f32 v29, v18, v19
  v_cvt_pk_bf16_f32 v30, v20, v21
  v_mfma_f32_16x16x32_bf16 v[156:159], v[44:47], v[236:239], v[156:159]
  v_xor_b32 v14, 0x10000, v14
  v_cvt_pk_bf16_f32 v31, v22, v23
  v_mfma_f32_16x16x32_bf16 v[172:175], v[48:51], v[236:239], v[172:175]
  buffer_load_dwordx4 v11, s[36:39], s27 offen offset:3072 lds
  buffer_store_dwordx4 v[28:31], v2, s[40:43], s63 offen offset:1024 sc1
  v_mfma_f32_16x16x32_bf16 v[188:191], v[52:55], v[236:239], v[188:191]
  s_add_u32 s27, s27, 524288
  v_xor_b32 v12, 0x10000, v12
  v_mfma_f32_16x16x32_bf16 v[204:207], v[56:59], v[236:239], v[204:207]
  v_xor_b32 v13, 0x10000, v13
  v_mfma_f32_16x16x32_bf16 v[220:223], v[60:63], v[236:239], v[220:223]
  s_waitcnt vmcnt(19) lgkmcnt(0)
  v_mfma_f32_16x16x32_bf16 v[96:99], v[64:67], v[240:243], v[96:99]
  s_barrier
  v_accvgpr_read_b32 v16, a208
  v_accvgpr_read_b32 v17, a209
  v_accvgpr_read_b32 v18, a210
  v_mfma_f32_16x16x32_bf16 v[112:115], v[68:71], v[240:243], v[112:115]
  s_add_u32 s63, s63, s61
  ds_read_b64_tr_b16 v[32:33], v12 offset:0
  v_accvgpr_read_b32 v19, a211
  v_mfma_f32_16x16x32_bf16 v[128:131], v[72:75], v[240:243], v[128:131]
  s_add_u32 m0, s24, 98304
  ds_read_b64_tr_b16 v[34:35], v12 offset:1024
  v_accvgpr_read_b32 v20, a240
  v_mfma_f32_16x16x32_bf16 v[144:147], v[76:79], v[240:243], v[144:147]
  buffer_load_dwordx4 v3, s[32:35], s26 offen offset:0 sc1 lds
  v_accvgpr_read_b32 v21, a241
  v_accvgpr_read_b32 v22, a242
  v_mfma_f32_16x16x32_bf16 v[160:163], v[80:83], v[240:243], v[160:163]
  ds_read_b64_tr_b16 v[36:37], v13 offset:0
  v_accvgpr_read_b32 v23, a243
  v_mfma_f32_16x16x32_bf16 v[176:179], v[84:87], v[240:243], v[176:179]
  ds_read_b64_tr_b16 v[38:39], v13 offset:1024
  v_mul_f32 v16, s76, v16
  v_mfma_f32_16x16x32_bf16 v[192:195], v[88:91], v[240:243], v[192:195]
  ds_read_b64_tr_b16 v[40:41], v12 offset:256
  v_mul_f32 v17, s76, v17
  v_mul_f32 v18, s76, v18
  v_mfma_f32_16x16x32_bf16 v[208:211], v[92:95], v[240:243], v[208:211]
  ds_read_b64_tr_b16 v[42:43], v12 offset:1280
  v_mul_f32 v19, s76, v19
  v_mfma_f32_16x16x32_bf16 v[100:103], v[64:67], v[244:247], v[100:103]
  buffer_load_dwordx4 v4, s[32:35], s26 offen offset:1024 sc1 lds
  v_mul_f32 v20, s76, v20
  v_mfma_f32_16x16x32_bf16 v[116:119], v[68:71], v[244:247], v[116:119]
  ds_read_b64_tr_b16 v[44:45], v13 offset:256
  v_mul_f32 v21, s76, v21
  v_mfma_f32_16x16x32_bf16 v[132:135], v[72:75], v[244:247], v[132:135]
  ds_read_b64_tr_b16 v[46:47], v13 offset:1280
  v_mul_f32 v22, s76, v22
  v_mul_f32 v23, s76, v23
  v_mfma_f32_16x16x32_bf16 v[148:151], v[76:79], v[244:247], v[148:151]
  ds_read_b128 v[224:227], v14 offset:0
  v_cvt_pk_bf16_f32 v24, v16, v17
  v_mfma_f32_16x16x32_bf16 v[164:167], v[80:83], v[244:247], v[164:167]
  ds_read_b128 v[228:231], v14 offset:1024
  v_cvt_pk_bf16_f32 v25, v18, v19
  v_mfma_f32_16x16x32_bf16 v[180:183], v[84:87], v[244:247], v[180:183]
  buffer_load_dwordx4 v5, s[32:35], s26 offen offset:2048 sc1 lds
  v_cvt_pk_bf16_f32 v26, v20, v21
  v_cvt_pk_bf16_f32 v27, v22, v23
  v_mfma_f32_16x16x32_bf16 v[196:199], v[88:91], v[244:247], v[196:199]
  ds_read_b64_tr_b16 v[48:49], v12 offset:512
  buffer_store_dwordx4 v[24:27], v2, s[40:43], s63 offen offset:0 sc1
  v_mfma_f32_16x16x32_bf16 v[212:215], v[92:95], v[244:247], v[212:215]
  ds_read_b64_tr_b16 v[50:51], v12 offset:1536
  v_accvgpr_read_b32 v16, a212
  v_mfma_f32_16x16x32_bf16 v[104:107], v[64:67], v[248:251], v[104:107]
  ds_read_b64_tr_b16 v[52:53], v13 offset:512
  v_accvgpr_read_b32 v17, a213
  v_accvgpr_read_b32 v18, a214
  v_mfma_f32_16x16x32_bf16 v[120:123], v[68:71], v[248:251], v[120:123]
  ds_read_b64_tr_b16 v[54:55], v13 offset:1536
  v_accvgpr_read_b32 v19, a215
  v_mfma_f32_16x16x32_bf16 v[136:139], v[72:75], v[248:251], v[136:139]
  buffer_load_dwordx4 v6, s[32:35], s26 offen offset:3072 sc1 lds
  v_accvgpr_read_b32 v20, a244
  v_mfma_f32_16x16x32_bf16 v[152:155], v[76:79], v[248:251], v[152:155]
  s_add_u32 s26, s26, 1024
  ds_read_b64_tr_b16 v[56:57], v12 offset:768
  v_accvgpr_read_b32 v21, a245
  v_mfma_f32_16x16x32_bf16 v[168:171], v[80:83], v[248:251], v[168:171]
  ds_read_b64_tr_b16 v[58:59], v12 offset:1792
  v_accvgpr_read_b32 v22, a246
  v_accvgpr_read_b32 v23, a247
  v_mfma_f32_16x16x32_bf16 v[184:187], v[84:87], v[248:251], v[184:187]
  ds_read_b64_tr_b16 v[60:61], v13 offset:768
  v_mul_f32 v16, s76, v16
  v_mfma_f32_16x16x32_bf16 v[200:203], v[88:91], v[248:251], v[200:203]
  s_add_u32 m0, s24, 49152
  ds_read_b64_tr_b16 v[62:63], v13 offset:1792
  v_mul_f32 v17, s76, v17
  v_mfma_f32_16x16x32_bf16 v[216:219], v[92:95], v[248:251], v[216:219]
  buffer_load_dwordx4 v8, s[36:39], s27 offen offset:0 lds
  v_mul_f32 v18, s76, v18
  v_mul_f32 v19, s76, v19
  v_mfma_f32_16x16x32_bf16 v[108:111], v[64:67], v[252:255], v[108:111]
  ds_read_b128 v[232:235], v14 offset:2048
  v_mul_f32 v20, s76, v20
  v_mfma_f32_16x16x32_bf16 v[124:127], v[68:71], v[252:255], v[124:127]
  ds_read_b128 v[236:239], v14 offset:3072
  v_mul_f32 v21, s76, v21
  v_mfma_f32_16x16x32_bf16 v[140:143], v[72:75], v[252:255], v[140:143]
  v_mul_f32 v22, s76, v22
  v_mul_f32 v23, s76, v23
  v_cvt_pk_bf16_f32 v28, v16, v17
  v_mfma_f32_16x16x32_bf16 v[156:159], v[76:79], v[252:255], v[156:159]
  v_cvt_pk_bf16_f32 v29, v18, v19
  v_cvt_pk_bf16_f32 v30, v20, v21
  v_mfma_f32_16x16x32_bf16 v[172:175], v[80:83], v[252:255], v[172:175]
  buffer_load_dwordx4 v9, s[36:39], s27 offen offset:1024 lds
  v_cvt_pk_bf16_f32 v31, v22, v23
  v_mfma_f32_16x16x32_bf16 v[188:191], v[84:87], v[252:255], v[188:191]
  buffer_store_dwordx4 v[28:31], v2, s[40:43], s63 offen offset:1024 sc1
  v_mfma_f32_16x16x32_bf16 v[204:207], v[88:91], v[252:255], v[204:207]
  v_mfma_f32_16x16x32_bf16 v[220:223], v[92:95], v[252:255], v[220:223]
  s_waitcnt vmcnt(19) lgkmcnt(0)
  v_mfma_f32_16x16x32_bf16 v[96:99], v[32:35], v[224:227], v[96:99]
  s_add_u32 s63, s63, s61
  v_accvgpr_read_b32 v16, a216
  v_accvgpr_read_b32 v17, a217
  v_accvgpr_read_b32 v18, a218
  v_mfma_f32_16x16x32_bf16 v[112:115], v[36:39], v[224:227], v[112:115]
  ds_read_b64_tr_b16 v[64:65], v12 offset:8192
  v_accvgpr_read_b32 v19, a219
  v_mfma_f32_16x16x32_bf16 v[128:131], v[40:43], v[224:227], v[128:131]
  s_add_u32 m0, s24, 0
  ds_read_b64_tr_b16 v[66:67], v12 offset:9216
  v_accvgpr_read_b32 v20, a248
  v_mfma_f32_16x16x32_bf16 v[144:147], v[44:47], v[224:227], v[144:147]
  buffer_load_dwordx4 v3, s[32:35], s26 offen offset:0 sc1 lds
  v_accvgpr_read_b32 v21, a249
  v_accvgpr_read_b32 v22, a250
  v_mfma_f32_16x16x32_bf16 v[160:163], v[48:51], v[224:227], v[160:163]
  ds_read_b64_tr_b16 v[68:69], v13 offset:8192
  v_accvgpr_read_b32 v23, a251
  v_mfma_f32_16x16x32_bf16 v[176:179], v[52:55], v[224:227], v[176:179]
  ds_read_b64_tr_b16 v[70:71], v13 offset:9216
  v_mul_f32 v16, s76, v16
  v_mfma_f32_16x16x32_bf16 v[192:195], v[56:59], v[224:227], v[192:195]
  ds_read_b64_tr_b16 v[72:73], v12 offset:8448
  v_mul_f32 v17, s76, v17
  v_mul_f32 v18, s76, v18
  v_mfma_f32_16x16x32_bf16 v[208:211], v[60:63], v[224:227], v[208:211]
  ds_read_b64_tr_b16 v[74:75], v12 offset:9472
  v_mul_f32 v19, s76, v19
  v_mfma_f32_16x16x32_bf16 v[100:103], v[32:35], v[228:231], v[100:103]
  buffer_load_dwordx4 v4, s[32:35], s26 offen offset:1024 sc1 lds
  v_mul_f32 v20, s76, v20
  v_mfma_f32_16x16x32_bf16 v[116:119], v[36:39], v[228:231], v[116:119]
  ds_read_b64_tr_b16 v[76:77], v13 offset:8448
  v_mul_f32 v21, s76, v21
  v_mul_f32 v22, s76, v22
  v_mfma_f32_16x16x32_bf16 v[132:135], v[40:43], v[228:231], v[132:135]
  ds_read_b64_tr_b16 v[78:79], v13 offset:9472
  v_mul_f32 v23, s76, v23
  v_mfma_f32_16x16x32_bf16 v[148:151], v[44:47], v[228:231], v[148:151]
  ds_read_b128 v[240:243], v14 offset:32768
  v_cvt_pk_bf16_f32 v24, v16, v17
  v_mfma_f32_16x16x32_bf16 v[164:167], v[48:51], v[228:231], v[164:167]
  ds_read_b128 v[244:247], v14 offset:33792
  v_cvt_pk_bf16_f32 v25, v18, v19
  v_cvt_pk_bf16_f32 v26, v20, v21
  v_mfma_f32_16x16x32_bf16 v[180:183], v[52:55], v[228:231], v[180:183]
  buffer_load_dwordx4 v5, s[32:35], s26 offen offset:2048 sc1 lds
  v_cvt_pk_bf16_f32 v27, v22, v23
  v_mfma_f32_16x16x32_bf16 v[196:199], v[56:59], v[228:231], v[196:199]
  ds_read_b64_tr_b16 v[80:81], v12 offset:8704
  buffer_store_dwordx4 v[24:27], v2, s[40:43], s63 offen offset:0 sc1
  v_mfma_f32_16x16x32_bf16 v[212:215], v[60:63], v[228:231], v[212:215]
  ds_read_b64_tr_b16 v[82:83], v12 offset:9728
  v_accvgpr_read_b32 v16, a220
  v_accvgpr_read_b32 v17, a221
  v_mfma_f32_16x16x32_bf16 v[104:107], v[32:35], v[232:235], v[104:107]
  ds_read_b64_tr_b16 v[84:85], v13 offset:8704
  v_accvgpr_read_b32 v18, a222
  v_mfma_f32_16x16x32_bf16 v[120:123], v[36:39], v[232:235], v[120:123]
  ds_read_b64_tr_b16 v[86:87], v13 offset:9728
  v_accvgpr_read_b32 v19, a223
  v_mfma_f32_16x16x32_bf16 v[136:139], v[40:43], v[232:235], v[136:139]
  buffer_load_dwordx4 v6, s[32:35], s26 offen offset:3072 sc1 lds
  v_accvgpr_read_b32 v20, a252
  v_accvgpr_read_b32 v21, a253
  v_mfma_f32_16x16x32_bf16 v[152:155], v[44:47], v[232:235], v[152:155]
  s_add_u32 s26, s26, 1024
  ds_read_b64_tr_b16 v[88:89], v12 offset:8960
  v_accvgpr_read_b32 v22, a254
  v_mfma_f32_16x16x32_bf16 v[168:171], v[48:51], v[232:235], v[168:171]
  ds_read_b64_tr_b16 v[90:91], v12 offset:9984
  v_accvgpr_read_b32 v23, a255
  v_mfma_f32_16x16x32_bf16 v[184:187], v[52:55], v[232:235], v[184:187]
  ds_read_b64_tr_b16 v[92:93], v13 offset:8960
  v_mul_f32 v16, s76, v16
  v_mul_f32 v17, s76, v17
  v_mfma_f32_16x16x32_bf16 v[200:203], v[56:59], v[232:235], v[200:203]
  s_add_u32 m0, s24, 49152
  ds_read_b64_tr_b16 v[94:95], v13 offset:9984
  v_mul_f32 v18, s76, v18
  v_mfma_f32_16x16x32_bf16 v[216:219], v[60:63], v[232:235], v[216:219]
  buffer_load_dwordx4 v10, s[36:39], s27 offen offset:2048 lds
  v_mul_f32 v19, s76, v19
  v_mfma_f32_16x16x32_bf16 v[108:111], v[32:35], v[236:239], v[108:111]
  ds_read_b128 v[248:251], v14 offset:34816
  v_mul_f32 v20, s76, v20
  v_mul_f32 v21, s76, v21
  v_mfma_f32_16x16x32_bf16 v[124:127], v[36:39], v[236:239], v[124:127]
  ds_read_b128 v[252:255], v14 offset:35840
  v_mul_f32 v22, s76, v22
  v_mfma_f32_16x16x32_bf16 v[140:143], v[40:43], v[236:239], v[140:143]
  v_mul_f32 v23, s76, v23
  v_cvt_pk_bf16_f32 v28, v16, v17
  v_mfma_f32_16x16x32_bf16 v[156:159], v[44:47], v[236:239], v[156:159]
  v_xor_b32 v14, 0x10000, v14
  v_cvt_pk_bf16_f32 v29, v18, v19
  v_cvt_pk_bf16_f32 v30, v20, v21
  v_mfma_f32_16x16x32_bf16 v[172:175], v[48:51], v[236:239], v[172:175]
  buffer_load_dwordx4 v11, s[36:39], s27 offen offset:3072 lds
  v_cvt_pk_bf16_f32 v31, v22, v23
  v_mfma_f32_16x16x32_bf16 v[188:191], v[52:55], v[236:239], v[188:191]
  s_add_u32 s27, s27, 524288
  buffer_store_dwordx4 v[28:31], v2, s[40:43], s63 offen offset:1024 sc1
  v_mfma_f32_16x16x32_bf16 v[204:207], v[56:59], v[236:239], v[204:207]
  v_mfma_f32_16x16x32_bf16 v[220:223], v[60:63], v[236:239], v[220:223]
  s_waitcnt vmcnt(19) lgkmcnt(0)
  v_mfma_f32_16x16x32_bf16 v[96:99], v[64:67], v[240:243], v[96:99]
  s_barrier
  v_and_b32 v11, 15, v1
  v_lshrrev_b32 v10, 4, v1
  v_mfma_f32_16x16x32_bf16 v[112:115], v[68:71], v[240:243], v[112:115]
  ds_read_b64_tr_b16 v[32:33], v12 offset:32768
  v_lshlrev_b32 v10, 2, v10
  v_mfma_f32_16x16x32_bf16 v[128:131], v[72:75], v[240:243], v[128:131]
  s_add_u32 m0, s24, 32768
  ds_read_b64_tr_b16 v[34:35], v12 offset:33792
  v_sub_u32 v11, v11, v10
  v_mfma_f32_16x16x32_bf16 v[144:147], v[76:79], v[240:243], v[144:147]
  buffer_load_dwordx4 v3, s[32:35], s26 offen offset:0 sc1 lds
  v_cmp_le_i32 s[68:69], 0, v11
  v_mfma_f32_16x16x32_bf16 v[160:163], v[80:83], v[240:243], v[160:163]
  ds_read_b64_tr_b16 v[36:37], v13 offset:32768
  v_cmp_le_i32 s[70:71], 1, v11
  v_mfma_f32_16x16x32_bf16 v[176:179], v[84:87], v[240:243], v[176:179]
  ds_read_b64_tr_b16 v[38:39], v13 offset:33792
  v_cmp_le_i32 s[72:73], 2, v11
  v_mfma_f32_16x16x32_bf16 v[192:195], v[88:91], v[240:243], v[192:195]
  ds_read_b64_tr_b16 v[40:41], v12 offset:33024
  v_cmp_le_i32 s[74:75], 3, v11
  v_mfma_f32_16x16x32_bf16 v[208:211], v[92:95], v[240:243], v[208:211]
  ds_read_b64_tr_b16 v[42:43], v12 offset:34048
  v_and_b32 v8, 7, v1
  v_mfma_f32_16x16x32_bf16 v[100:103], v[64:67], v[244:247], v[100:103]
  buffer_load_dwordx4 v4, s[32:35], s26 offen offset:1024 sc1 lds
  v_lshlrev_b32 v8, 2, v8
  v_mfma_f32_16x16x32_bf16 v[116:119], v[68:71], v[244:247], v[116:119]
  ds_read_b64_tr_b16 v[44:45], v13 offset:33024
  v_add_u32 v8, s30, v8
  v_mfma_f32_16x16x32_bf16 v[132:135], v[72:75], v[244:247], v[132:135]
  ds_read_b64_tr_b16 v[46:47], v13 offset:34048
  v_accvgpr_write_b32 a0, 0
  v_mfma_f32_16x16x32_bf16 v[148:151], v[76:79], v[244:247], v[148:151]
  ds_read_b128 v[224:227], v14 offset:0
  v_accvgpr_write_b32 a1, 0
  v_mfma_f32_16x16x32_bf16 v[164:167], v[80:83], v[244:247], v[164:167]
  ds_read_b128 v[228:231], v14 offset:1024
  v_accvgpr_write_b32 a2, 0
  v_mfma_f32_16x16x32_bf16 v[180:183], v[84:87], v[244:247], v[180:183]
  buffer_load_dwordx4 v5, s[32:35], s26 offen offset:2048 sc1 lds
  v_accvgpr_write_b32 a3, 0
  v_mfma_f32_16x16x32_bf16 v[196:199], v[88:91], v[244:247], v[196:199]
  ds_read_b64_tr_b16 v[48:49], v12 offset:33280
  v_accvgpr_write_b32 a32, 0
  v_mfma_f32_16x16x32_bf16 v[212:215], v[92:95], v[244:247], v[212:215]
  ds_read_b64_tr_b16 v[50:51], v12 offset:34304
  v_accvgpr_write_b32 a33, 0
  v_mfma_f32_16x16x32_bf16 v[104:107], v[64:67], v[248:251], v[104:107]
  ds_read_b64_tr_b16 v[52:53], v13 offset:33280
  v_accvgpr_write_b32 a34, 0
  v_mfma_f32_16x16x32_bf16 v[120:123], v[68:71], v[248:251], v[120:123]
  ds_read_b64_tr_b16 v[54:55], v13 offset:34304
  v_accvgpr_write_b32 a35, 0
  v_mfma_f32_16x16x32_bf16 v[136:139], v[72:75], v[248:251], v[136:139]
  buffer_load_dwordx4 v6, s[32:35], s26 offen offset:3072 sc1 lds
  v_accvgpr_write_b32 a4, 0
  v_mfma_f32_16x16x32_bf16 v[152:155], v[76:79], v[248:251], v[152:155]
  s_add_u32 s26, s26, 1024
  ds_read_b64_tr_b16 v[56:57], v12 offset:33536
  v_accvgpr_write_b32 a5, 0
  v_mfma_f32_16x16x32_bf16 v[168:171], v[80:83], v[248:251], v[168:171]
  ds_read_b64_tr_b16 v[58:59], v12 offset:34560
  v_accvgpr_write_b32 a6, 0
  v_mfma_f32_16x16x32_bf16 v[184:187], v[84:87], v[248:251], v[184:187]
  ds_read_b64_tr_b16 v[60:61], v13 offset:33536
  v_accvgpr_write_b32 a7, 0
  v_mfma_f32_16x16x32_bf16 v[200:203], v[88:91], v[248:251], v[200:203]
  ds_read_b64_tr_b16 v[62:63], v13 offset:34560
  v_accvgpr_write_b32 a36, 0
  v_mfma_f32_16x16x32_bf16 v[216:219], v[92:95], v[248:251], v[216:219]
  v_accvgpr_write_b32 a37, 0
  v_accvgpr_write_b32 a38, 0
  v_mfma_f32_16x16x32_bf16 v[108:111], v[64:67], v[252:255], v[108:111]
  ds_read_b128 v[232:235], v14 offset:2048
  v_accvgpr_write_b32 a39, 0
  v_mfma_f32_16x16x32_bf16 v[124:127], v[68:71], v[252:255], v[124:127]
  ds_read_b128 v[236:239], v14 offset:3072
  v_accvgpr_write_b32 a8, 0
  v_mfma_f32_16x16x32_bf16 v[140:143], v[72:75], v[252:255], v[140:143]
  v_accvgpr_write_b32 a9, 0
  v_accvgpr_write_b32 a10, 0
  v_mfma_f32_16x16x32_bf16 v[156:159], v[76:79], v[252:255], v[156:159]
  v_accvgpr_write_b32 a11, 0
  v_accvgpr_write_b32 a40, 0
  v_mfma_f32_16x16x32_bf16 v[172:175], v[80:83], v[252:255], v[172:175]
  v_accvgpr_write_b32 a41, 0
  v_accvgpr_write_b32 a42, 0
  v_mfma_f32_16x16x32_bf16 v[188:191], v[84:87], v[252:255], v[188:191]
  v_accvgpr_write_b32 a43, 0
  v_accvgpr_write_b32 a12, 0
  v_mfma_f32_16x16x32_bf16 v[204:207], v[88:91], v[252:255], v[204:207]
  v_accvgpr_write_b32 a13, 0
  v_mfma_f32_16x16x32_bf16 v[220:223], v[92:95], v[252:255], v[220:223]
  s_waitcnt vmcnt(15) lgkmcnt(0)
  v_mfma_f32_16x16x32_bf16 v[96:99], v[32:35], v[224:227], v[96:99]
  v_accvgpr_write_b32 a14, 0
  v_accvgpr_write_b32 a15, 0
  v_mfma_f32_16x16x32_bf16 v[112:115], v[36:39], v[224:227], v[112:115]
  ds_read_b64_tr_b16 v[64:65], v12 offset:40960
  v_accvgpr_write_b32 a44, 0
  v_mfma_f32_16x16x32_bf16 v[128:131], v[40:43], v[224:227], v[128:131]
  s_add_u32 m0, s24, 65536
  ds_read_b64_tr_b16 v[66:67], v12 offset:41984
  v_accvgpr_write_b32 a45, 0
  v_mfma_f32_16x16x32_bf16 v[144:147], v[44:47], v[224:227], v[144:147]
  buffer_load_dwordx4 v3, s[32:35], s26 offen offset:0 sc1 lds
  v_accvgpr_write_b32 a46, 0
  v_mfma_f32_16x16x32_bf16 v[160:163], v[48:51], v[224:227], v[160:163]
  ds_read_b64_tr_b16 v[68:69], v13 offset:40960
  v_accvgpr_write_b32 a47, 0
  v_mfma_f32_16x16x32_bf16 v[176:179], v[52:55], v[224:227], v[176:179]
  ds_read_b64_tr_b16 v[70:71], v13 offset:41984
  v_accvgpr_write_b32 a16, 0
  v_mfma_f32_16x16x32_bf16 v[192:195], v[56:59], v[224:227], v[192:195]
  ds_read_b64_tr_b16 v[72:73], v12 offset:41216
  v_accvgpr_write_b32 a17, 0
  v_mfma_f32_16x16x32_bf16 v[208:211], v[60:63], v[224:227], v[208:211]
  ds_read_b64_tr_b16 v[74:75], v12 offset:42240
  v_accvgpr_write_b32 a18, 0
  v_mfma_f32_16x16x32_bf16 v[100:103], v[32:35], v[228:231], v[100:103]
  buffer_load_dwordx4 v4, s[32:35], s26 offen offset:1024 sc1 lds
  v_accvgpr_write_b32 a19, 0
  v_mfma_f32_16x16x32_bf16 v[116:119], v[36:39], v[228:231], v[116:119]
  ds_read_b64_tr_b16 v[76:77], v13 offset:41216
  v_accvgpr_write_b32 a48, 0
  v_mfma_f32_16x16x32_bf16 v[132:135], v[40:43], v[228:231], v[132:135]
  ds_read_b64_tr_b16 v[78:79], v13 offset:42240
  v_accvgpr_write_b32 a49, 0
  v_mfma_f32_16x16x32_bf16 v[148:151], v[44:47], v[228:231], v[148:151]
  ds_read_b128 v[240:243], v14 offset:32768
  v_accvgpr_write_b32 a50, 0
  v_mfma_f32_16x16x32_bf16 v[164:167], v[48:51], v[228:231], v[164:167]
  ds_read_b128 v[244:247], v14 offset:33792
  v_accvgpr_write_b32 a51, 0
  v_mfma_f32_16x16x32_bf16 v[180:183], v[52:55], v[228:231], v[180:183]
  buffer_load_dwordx4 v5, s[32:35], s26 offen offset:2048 sc1 lds
  v_accvgpr_write_b32 a20, 0
  v_mfma_f32_16x16x32_bf16 v[196:199], v[56:59], v[228:231], v[196:199]
  ds_read_b64_tr_b16 v[80:81], v12 offset:41472
  v_accvgpr_write_b32 a21, 0
  v_mfma_f32_16x16x32_bf16 v[212:215], v[60:63], v[228:231], v[212:215]
  ds_read_b64_tr_b16 v[82:83], v12 offset:42496
  v_accvgpr_write_b32 a22, 0
  v_mfma_f32_16x16x32_bf16 v[104:107], v[32:35], v[232:235], v[104:107]
  ds_read_b64_tr_b16 v[84:85], v13 offset:41472
  v_accvgpr_write_b32 a23, 0
  v_mfma_f32_16x16x32_bf16 v[120:123], v[36:39], v[232:235], v[120:123]
  ds_read_b64_tr_b16 v[86:87], v13 offset:42496
  v_accvgpr_write_b32 a52, 0
  v_mfma_f32_16x16x32_bf16 v[136:139], v[40:43], v[232:235], v[136:139]
  buffer_load_dwordx4 v6, s[32:35], s26 offen offset:3072 sc1 lds
  v_accvgpr_write_b32 a53, 0
  v_mfma_f32_16x16x32_bf16 v[152:155], v[44:47], v[232:235], v[152:155]
  s_add_u32 s26, s26, 1024
  ds_read_b64_tr_b16 v[88:89], v12 offset:41728
  v_accvgpr_write_b32 a54, 0
  v_mfma_f32_16x16x32_bf16 v[168:171], v[48:51], v[232:235], v[168:171]
  ds_read_b64_tr_b16 v[90:91], v12 offset:42752
  v_accvgpr_write_b32 a55, 0
  v_mfma_f32_16x16x32_bf16 v[184:187], v[52:55], v[232:235], v[184:187]
  ds_read_b64_tr_b16 v[92:93], v13 offset:41728
  v_accvgpr_write_b32 a24, 0
  v_mfma_f32_16x16x32_bf16 v[200:203], v[56:59], v[232:235], v[200:203]
  ds_read_b64_tr_b16 v[94:95], v13 offset:42752
  v_accvgpr_write_b32 a25, 0
  v_mfma_f32_16x16x32_bf16 v[216:219], v[60:63], v[232:235], v[216:219]
  v_accvgpr_write_b32 a26, 0
  v_accvgpr_write_b32 a27, 0
  v_mfma_f32_16x16x32_bf16 v[108:111], v[32:35], v[236:239], v[108:111]
  ds_read_b128 v[248:251], v14 offset:34816
  v_accvgpr_write_b32 a56, 0
  v_mfma_f32_16x16x32_bf16 v[124:127], v[36:39], v[236:239], v[124:127]
  ds_read_b128 v[252:255], v14 offset:35840
  v_accvgpr_write_b32 a57, 0
  v_mfma_f32_16x16x32_bf16 v[140:143], v[40:43], v[236:239], v[140:143]
  v_accvgpr_write_b32 a58, 0
  v_accvgpr_write_b32 a59, 0
  v_mfma_f32_16x16x32_bf16 v[156:159], v[44:47], v[236:239], v[156:159]
  v_xor_b32 v14, 0x10000, v14
  v_accvgpr_write_b32 a28, 0
  v_mfma_f32_16x16x32_bf16 v[172:175], v[48:51], v[236:239], v[172:175]
  v_accvgpr_write_b32 a29, 0
  v_accvgpr_write_b32 a30, 0
  v_mfma_f32_16x16x32_bf16 v[188:191], v[52:55], v[236:239], v[188:191]
  v_xor_b32 v12, 0x10000, v12
  v_accvgpr_write_b32 a31, 0
  v_mfma_f32_16x16x32_bf16 v[204:207], v[56:59], v[236:239], v[204:207]
  v_xor_b32 v13, 0x10000, v13
  v_mfma_f32_16x16x32_bf16 v[220:223], v[60:63], v[236:239], v[220:223]
  s_waitcnt vmcnt(8) lgkmcnt(0)
  v_mfma_f32_16x16x32_bf16 v[96:99], v[64:67], v[240:243], v[96:99]
  s_barrier
  buffer_store_dword v12, off, s[40:43], s29 sc1
  v_accvgpr_write_b32 a60, 0
  v_mfma_f32_16x16x32_bf16 v[112:115], v[68:71], v[240:243], v[112:115]
  ds_read_b64_tr_b16 v[32:33], v12 offset:0
  v_accvgpr_write_b32 a61, 0
  v_mfma_f32_16x16x32_bf16 v[128:131], v[72:75], v[240:243], v[128:131]
  s_add_u32 m0, s24, 98304
  ds_read_b64_tr_b16 v[34:35], v12 offset:1024
  v_accvgpr_write_b32 a62, 0
  v_mfma_f32_16x16x32_bf16 v[144:147], v[76:79], v[240:243], v[144:147]
  buffer_load_dwordx4 v3, s[32:35], s26 offen offset:0 sc1 lds
  v_accvgpr_write_b32 a63, 0
  v_mfma_f32_16x16x32_bf16 v[160:163], v[80:83], v[240:243], v[160:163]
  ds_read_b64_tr_b16 v[36:37], v13 offset:0
  v_accvgpr_write_b32 a64, 0
  v_mfma_f32_16x16x32_bf16 v[176:179], v[84:87], v[240:243], v[176:179]
  ds_read_b64_tr_b16 v[38:39], v13 offset:1024
  v_accvgpr_write_b32 a65, 0
  v_mfma_f32_16x16x32_bf16 v[192:195], v[88:91], v[240:243], v[192:195]
  ds_read_b64_tr_b16 v[40:41], v12 offset:256
  v_accvgpr_write_b32 a66, 0
  v_mfma_f32_16x16x32_bf16 v[208:211], v[92:95], v[240:243], v[208:211]
  ds_read_b64_tr_b16 v[42:43], v12 offset:1280
  v_accvgpr_write_b32 a67, 0
  v_mfma_f32_16x16x32_bf16 v[100:103], v[64:67], v[244:247], v[100:103]
  buffer_load_dwordx4 v4, s[32:35], s26 offen offset:1024 sc1 lds
  v_accvgpr_write_b32 a96, 0
  v_mfma_f32_16x16x32_bf16 v[116:119], v[68:71], v[244:247], v[116:119]
  ds_read_b64_tr_b16 v[44:45], v13 offset:256
  v_accvgpr_write_b32 a97, 0
  v_mfma_f32_16x16x32_bf16 v[132:135], v[72:75], v[244:247], v[132:135]
  ds_read_b64_tr_b16 v[46:47], v13 offset:1280
  v_accvgpr_write_b32 a98, 0
  v_mfma_f32_16x16x32_bf16 v[148:151], v[76:79], v[244:247], v[148:151]
  ds_read_b128 v[224:227], v14 offset:0
  v_accvgpr_write_b32 a99, 0
  v_mfma_f32_16x16x32_bf16 v[164:167], v[80:83], v[244:247], v[164:167]
  ds_read_b128 v[228:231], v14 offset:1024
  v_accvgpr_write_b32 a68, 0
  v_mfma_f32_16x16x32_bf16 v[180:183], v[84:87], v[244:247], v[180:183]
  buffer_load_dwordx4 v5, s[32:35], s26 offen offset:2048 sc1 lds
  v_accvgpr_write_b32 a69, 0
  v_mfma_f32_16x16x32_bf16 v[196:199], v[88:91], v[244:247], v[196:199]
  ds_read_b64_tr_b16 v[48:49], v12 offset:512
  v_accvgpr_write_b32 a70, 0
  v_mfma_f32_16x16x32_bf16 v[212:215], v[92:95], v[244:247], v[212:215]
  ds_read_b64_tr_b16 v[50:51], v12 offset:1536
  v_accvgpr_write_b32 a71, 0
  v_mfma_f32_16x16x32_bf16 v[104:107], v[64:67], v[248:251], v[104:107]
  ds_read_b64_tr_b16 v[52:53], v13 offset:512
  v_accvgpr_write_b32 a100, 0
  v_mfma_f32_16x16x32_bf16 v[120:123], v[68:71], v[248:251], v[120:123]
  ds_read_b64_tr_b16 v[54:55], v13 offset:1536
  v_accvgpr_write_b32 a101, 0
  v_mfma_f32_16x16x32_bf16 v[136:139], v[72:75], v[248:251], v[136:139]
  buffer_load_dwordx4 v6, s[32:35], s26 offen offset:3072 sc1 lds
  v_accvgpr_write_b32 a102, 0
  v_mfma_f32_16x16x32_bf16 v[152:155], v[76:79], v[248:251], v[152:155]
  s_add_u32 s26, s26, 1024
  ds_read_b64_tr_b16 v[56:57], v12 offset:768
  v_accvgpr_write_b32 a103, 0
  v_mfma_f32_16x16x32_bf16 v[168:171], v[80:83], v[248:251], v[168:171]
  ds_read_b64_tr_b16 v[58:59], v12 offset:1792
  v_accvgpr_write_b32 a72, 0
  v_mfma_f32_16x16x32_bf16 v[184:187], v[84:87], v[248:251], v[184:187]
  ds_read_b64_tr_b16 v[60:61], v13 offset:768
  v_accvgpr_write_b32 a73, 0
  v_mfma_f32_16x16x32_bf16 v[200:203], v[88:91], v[248:251], v[200:203]
  ds_read_b64_tr_b16 v[62:63], v13 offset:1792
  v_accvgpr_write_b32 a74, 0
  v_mfma_f32_16x16x32_bf16 v[216:219], v[92:95], v[248:251], v[216:219]
  v_accvgpr_write_b32 a75, 0
  v_accvgpr_write_b32 a104, 0
  v_mfma_f32_16x16x32_bf16 v[108:111], v[64:67], v[252:255], v[108:111]
  ds_read_b128 v[232:235], v14 offset:2048
  v_accvgpr_write_b32 a105, 0
  v_mfma_f32_16x16x32_bf16 v[124:127], v[68:71], v[252:255], v[124:127]
  ds_read_b128 v[236:239], v14 offset:3072
  v_accvgpr_write_b32 a106, 0
  v_mfma_f32_16x16x32_bf16 v[140:143], v[72:75], v[252:255], v[140:143]
  v_accvgpr_write_b32 a107, 0
  v_accvgpr_write_b32 a76, 0
  v_mfma_f32_16x16x32_bf16 v[156:159], v[76:79], v[252:255], v[156:159]
  v_accvgpr_write_b32 a77, 0
  v_accvgpr_write_b32 a78, 0
  v_mfma_f32_16x16x32_bf16 v[172:175], v[80:83], v[252:255], v[172:175]
  v_accvgpr_write_b32 a79, 0
  v_accvgpr_write_b32 a108, 0
  v_mfma_f32_16x16x32_bf16 v[188:191], v[84:87], v[252:255], v[188:191]
  v_accvgpr_write_b32 a109, 0
  v_accvgpr_write_b32 a110, 0
  v_mfma_f32_16x16x32_bf16 v[204:207], v[88:91], v[252:255], v[204:207]
  v_accvgpr_write_b32 a111, 0
  v_mfma_f32_16x16x32_bf16 v[220:223], v[92:95], v[252:255], v[220:223]
  s_waitcnt vmcnt(9) lgkmcnt(0)
  v_mfma_f32_16x16x32_bf16 v[96:99], v[32:35], v[224:227], v[96:99]
  s_and_b32 s62, s2, 1
  v_add_u32 v20, 0, v1
  v_mul_u32_u24 v19, 6554, v20
  v_mfma_f32_16x16x32_bf16 v[112:115], v[36:39], v[224:227], v[112:115]
  s_lshl_b32 s62, s62, 2
  ds_read_b64_tr_b16 v[64:65], v12 offset:8192
  v_lshrrev_b32 v19, 16, v19
  v_mfma_f32_16x16x32_bf16 v[128:131], v[40:43], v[224:227], v[128:131]
  s_add_u32 s62, s62, s20
  ds_read_b64_tr_b16 v[66:67], v12 offset:9216
  v_mul_u32_u24 v19, 1120, v19
  v_mfma_f32_16x16x32_bf16 v[144:147], v[44:47], v[224:227], v[144:147]
  s_lshr_b32 s63, s2, 1
  v_lshl_add_u32 v24, v20, 4, v19
  v_accvgpr_write_b32 a248, v24
  v_mfma_f32_16x16x32_bf16 v[160:163], v[48:51], v[224:227], v[160:163]
  s_mul_i32 s33, s63, 40960
  ds_read_b64_tr_b16 v[68:69], v13 offset:8192
  v_add_u32 v20, 64, v1
  v_mfma_f32_16x16x32_bf16 v[176:179], v[52:55], v[224:227], v[176:179]
  s_mul_i32 s31, s62, 160
  ds_read_b64_tr_b16 v[70:71], v13 offset:9216
  v_mul_u32_u24 v19, 6554, v20
  v_mfma_f32_16x16x32_bf16 v[192:195], v[56:59], v[224:227], v[192:195]
  s_add_u32 s33, s33, s31
  ds_read_b64_tr_b16 v[72:73], v12 offset:8448
  v_lshrrev_b32 v19, 16, v19
  v_mfma_f32_16x16x32_bf16 v[208:211], v[60:63], v[224:227], v[208:211]
  s_mul_i32 s34, s20, 5120
  ds_read_b64_tr_b16 v[74:75], v12 offset:9472
  v_mul_u32_u24 v19, 1120, v19
  v_mfma_f32_16x16x32_bf16 v[100:103], v[32:35], v[228:231], v[100:103]
  s_add_u32 s34, s34, 131072
  v_lshl_add_u32 v25, v20, 4, v19
  v_accvgpr_write_b32 a249, v25
  v_mfma_f32_16x16x32_bf16 v[116:119], v[36:39], v[228:231], v[116:119]
  s_lshl_b32 s30, s62, 7
  ds_read_b64_tr_b16 v[76:77], v13 offset:8448
  v_add_u32 v20, 128, v1
  v_mfma_f32_16x16x32_bf16 v[132:135], v[40:43], v[228:231], v[132:135]
  s_add_u32 s30, s30, s63
  ds_read_b64_tr_b16 v[78:79], v13 offset:9472
  v_mul_u32_u24 v19, 6554, v20
  v_mfma_f32_16x16x32_bf16 v[148:151], v[44:47], v[228:231], v[148:151]
  s_mul_i32 s30, s30, 5120
  ds_read_b128 v[240:243], v14 offset:32768
  v_lshrrev_b32 v19, 16, v19
  v_mfma_f32_16x16x32_bf16 v[164:167], v[48:51], v[228:231], v[164:167]
  s_add_u32 s30, s30, 4194304
  ds_read_b128 v[244:247], v14 offset:33792
  v_mul_u32_u24 v19, 1120, v19
  v_mfma_f32_16x16x32_bf16 v[180:183], v[52:55], v[228:231], v[180:183]
  v_lshl_add_u32 v26, v20, 4, v19
  v_accvgpr_write_b32 a250, v26
  v_mfma_f32_16x16x32_bf16 v[196:199], v[56:59], v[228:231], v[196:199]
  ds_read_b64_tr_b16 v[80:81], v12 offset:8704
  v_add_u32 v20, 192, v1
  v_mfma_f32_16x16x32_bf16 v[212:215], v[60:63], v[228:231], v[212:215]
  ds_read_b64_tr_b16 v[82:83], v12 offset:9728
  v_mul_u32_u24 v19, 6554, v20
  v_mfma_f32_16x16x32_bf16 v[104:107], v[32:35], v[232:235], v[104:107]
  ds_read_b64_tr_b16 v[84:85], v13 offset:8704
  v_lshrrev_b32 v19, 16, v19
  v_mfma_f32_16x16x32_bf16 v[120:123], v[36:39], v[232:235], v[120:123]
  ds_read_b64_tr_b16 v[86:87], v13 offset:9728
  v_mul_u32_u24 v19, 1120, v19
  v_mfma_f32_16x16x32_bf16 v[136:139], v[40:43], v[232:235], v[136:139]
  v_lshl_add_u32 v27, v20, 4, v19
  v_accvgpr_write_b32 a251, v27
  v_mfma_f32_16x16x32_bf16 v[152:155], v[44:47], v[232:235], v[152:155]
  ds_read_b64_tr_b16 v[88:89], v12 offset:8960
  v_add_u32 v20, 256, v1
  v_mfma_f32_16x16x32_bf16 v[168:171], v[48:51], v[232:235], v[168:171]
  ds_read_b64_tr_b16 v[90:91], v12 offset:9984
  v_mul_u32_u24 v19, 6554, v20
  v_mfma_f32_16x16x32_bf16 v[184:187], v[52:55], v[232:235], v[184:187]
  ds_read_b64_tr_b16 v[92:93], v13 offset:8960
  v_lshrrev_b32 v19, 16, v19
  v_mfma_f32_16x16x32_bf16 v[200:203], v[56:59], v[232:235], v[200:203]
  ds_read_b64_tr_b16 v[94:95], v13 offset:9984
  v_mul_u32_u24 v19, 1120, v19
  v_mfma_f32_16x16x32_bf16 v[216:219], v[60:63], v[232:235], v[216:219]
  v_lshl_add_u32 v28, v20, 4, v19
  v_accvgpr_write_b32 a252, v28
  v_mfma_f32_16x16x32_bf16 v[108:111], v[32:35], v[236:239], v[108:111]
  ds_read_b128 v[248:251], v14 offset:34816
  v_accvgpr_write_b32 a80, 0
  v_mfma_f32_16x16x32_bf16 v[124:127], v[36:39], v[236:239], v[124:127]
  ds_read_b128 v[252:255], v14 offset:35840
  v_accvgpr_write_b32 a81, 0
  v_mfma_f32_16x16x32_bf16 v[140:143], v[40:43], v[236:239], v[140:143]
  v_accvgpr_write_b32 a82, 0
  v_accvgpr_write_b32 a83, 0
  v_mfma_f32_16x16x32_bf16 v[156:159], v[44:47], v[236:239], v[156:159]
  v_xor_b32 v14, 0x10000, v14
  v_accvgpr_write_b32 a112, 0
  v_mfma_f32_16x16x32_bf16 v[172:175], v[48:51], v[236:239], v[172:175]
  v_accvgpr_write_b32 a113, 0
  v_accvgpr_write_b32 a114, 0
  v_mfma_f32_16x16x32_bf16 v[188:191], v[52:55], v[236:239], v[188:191]
  v_accvgpr_write_b32 a115, 0
  v_accvgpr_write_b32 a84, 0
  v_mfma_f32_16x16x32_bf16 v[204:207], v[56:59], v[236:239], v[204:207]
  v_accvgpr_write_b32 a85, 0
  v_mfma_f32_16x16x32_bf16 v[220:223], v[60:63], v[236:239], v[220:223]
  s_waitcnt vmcnt(5) lgkmcnt(0)
  v_mfma_f32_16x16x32_bf16 v[96:99], v[64:67], v[240:243], v[96:99]
  s_barrier
  v_lshrrev_b32 v6, 2, v1
  v_mul_u32_u24 v6, 160, v6
  v_mfma_f32_16x16x32_bf16 v[112:115], v[68:71], v[240:243], v[112:115]
  s_and_b32 s23, s20, 1
  ds_read_b64_tr_b16 v[32:33], v12 offset:32768
  v_and_b32 v19, 3, v1
  v_mfma_f32_16x16x32_bf16 v[128:131], v[72:75], v[240:243], v[128:131]
  s_lshl_b32 s23, s23, 12
  ds_read_b64_tr_b16 v[34:35], v12 offset:33792
  v_lshl_add_u32 v6, v19, 3, v6
  v_mfma_f32_16x16x32_bf16 v[144:147], v[76:79], v[240:243], v[144:147]
  s_cmp_lt_u32 s20, 2
  v_add_u32 v6, s34, v6
  v_mov_b32 v3, v2
  v_mfma_f32_16x16x32_bf16 v[160:163], v[80:83], v[240:243], v[160:163]
  s_cselect_b32 s24, 106496, 0
  ds_read_b64_tr_b16 v[36:37], v13 offset:32768
  v_mov_b32 v4, 0xff800000
  v_mfma_f32_16x16x32_bf16 v[176:179], v[84:87], v[240:243], v[176:179]
  s_add_u32 s24, s24, s23
  ds_read_b64_tr_b16 v[38:39], v13 offset:33792
  v_add_u32 v18, 106496, v2
  v_mfma_f32_16x16x32_bf16 v[192:195], v[88:91], v[240:243], v[192:195]
  s_lshl_b32 s26, s20, 12
  ds_read_b64_tr_b16 v[40:41], v12 offset:33024
  v_accvgpr_write_b32 a86, 0
  v_mfma_f32_16x16x32_bf16 v[208:211], v[92:95], v[240:243], v[208:211]
  s_mov_b32 s27, s26
  ds_read_b64_tr_b16 v[42:43], v12 offset:34048
  v_accvgpr_write_b32 a87, 0
  v_mfma_f32_16x16x32_bf16 v[100:103], v[64:67], v[244:247], v[100:103]
  s_add_u32 s25, s27, 49152
  v_accvgpr_write_b32 a116, 0
  v_accvgpr_write_b32 a117, 0
  v_mfma_f32_16x16x32_bf16 v[116:119], v[68:71], v[244:247], v[116:119]
  s_load_dwordx4 s[4:7], s[0:1], 64
  ds_read_b64_tr_b16 v[44:45], v13 offset:33024
  v_accvgpr_write_b32 a118, 0
  v_mfma_f32_16x16x32_bf16 v[132:135], v[72:75], v[244:247], v[132:135]
  s_load_dwordx2 s[8:9], s[0:1], 80
  ds_read_b64_tr_b16 v[46:47], v13 offset:34048
  v_accvgpr_write_b32 a119, 0
  v_mfma_f32_16x16x32_bf16 v[148:151], v[76:79], v[244:247], v[148:151]
  s_add_u32 s23, s20, 1
  ds_read_b128 v[224:227], v14 offset:0
  v_accvgpr_write_b32 a88, 0
  v_mfma_f32_16x16x32_bf16 v[164:167], v[80:83], v[244:247], v[164:167]
  s_lshr_b32 s23, s23, 1
  ds_read_b128 v[228:231], v14 offset:1024
  v_accvgpr_write_b32 a89, 0
  v_mfma_f32_16x16x32_bf16 v[180:183], v[84:87], v[244:247], v[180:183]
  s_lshl_b32 s28, s22, 1
  v_accvgpr_write_b32 a90, 0
  v_accvgpr_write_b32 a91, 0
  v_mfma_f32_16x16x32_bf16 v[196:199], v[88:91], v[244:247], v[196:199]
  s_add_u32 s28, s28, s23
  ds_read_b64_tr_b16 v[48:49], v12 offset:33280
  v_accvgpr_write_b32 a120, 0
  v_mfma_f32_16x16x32_bf16 v[212:215], v[92:95], v[244:247], v[212:215]
  s_lshl_b32 s23, s22, 2
  ds_read_b64_tr_b16 v[50:51], v12 offset:34304
  v_accvgpr_write_b32 a121, 0
  v_mfma_f32_16x16x32_bf16 v[104:107], v[64:67], v[248:251], v[104:107]
  s_sub_u32 s29, 28, s23
  ds_read_b64_tr_b16 v[52:53], v13 offset:33280
  v_accvgpr_write_b32 a122, 0
  v_mfma_f32_16x16x32_bf16 v[120:123], v[68:71], v[248:251], v[120:123]
  s_and_b32 s23, s20, 1
  ds_read_b64_tr_b16 v[54:55], v13 offset:34304
  v_accvgpr_write_b32 a123, 0
  v_mfma_f32_16x16x32_bf16 v[136:139], v[72:75], v[248:251], v[136:139]
  s_add_u32 s29, s29, s23
  v_accvgpr_write_b32 a92, 0
  v_accvgpr_write_b32 a93, 0
  v_mfma_f32_16x16x32_bf16 v[152:155], v[76:79], v[248:251], v[152:155]
  ds_read_b64_tr_b16 v[56:57], v12 offset:33536
  v_accvgpr_write_b32 a94, 0
  v_mfma_f32_16x16x32_bf16 v[168:171], v[80:83], v[248:251], v[168:171]
  ds_read_b64_tr_b16 v[58:59], v12 offset:34560
  v_accvgpr_write_b32 a95, 0
  v_mfma_f32_16x16x32_bf16 v[184:187], v[84:87], v[248:251], v[184:187]
  ds_read_b64_tr_b16 v[60:61], v13 offset:33536
  v_accvgpr_write_b32 a124, 0
  v_mfma_f32_16x16x32_bf16 v[200:203], v[88:91], v[248:251], v[200:203]
  ds_read_b64_tr_b16 v[62:63], v13 offset:34560
  v_accvgpr_write_b32 a125, 0
  v_mfma_f32_16x16x32_bf16 v[216:219], v[92:95], v[248:251], v[216:219]
  v_accvgpr_write_b32 a126, 0
  v_accvgpr_write_b32 a127, 0
  v_mfma_f32_16x16x32_bf16 v[108:111], v[64:67], v[252:255], v[108:111]
  ds_read_b128 v[232:235], v14 offset:2048
  v_mfma_f32_16x16x32_bf16 v[124:127], v[68:71], v[252:255], v[124:127]
  ds_read_b128 v[236:239], v14 offset:3072
  v_mfma_f32_16x16x32_bf16 v[140:143], v[72:75], v[252:255], v[140:143]
  v_mfma_f32_16x16x32_bf16 v[156:159], v[76:79], v[252:255], v[156:159]
  v_mfma_f32_16x16x32_bf16 v[172:175], v[80:83], v[252:255], v[172:175]
  v_mfma_f32_16x16x32_bf16 v[188:191], v[84:87], v[252:255], v[188:191]
  v_mfma_f32_16x16x32_bf16 v[204:207], v[88:91], v[252:255], v[204:207]
  v_mfma_f32_16x16x32_bf16 v[220:223], v[92:95], v[252:255], v[220:223]
  s_waitcnt vmcnt(0) lgkmcnt(0)
  v_mfma_f32_16x16x32_bf16 v[96:99], v[32:35], v[224:227], v[96:99]
  s_cmp_ge_u32 s20, 2
  v_mfma_f32_16x16x32_bf16 v[112:115], v[36:39], v[224:227], v[112:115]
  s_cselect_b32 s4, s6, s4
  ds_read_b64_tr_b16 v[64:65], v12 offset:40960
  v_mfma_f32_16x16x32_bf16 v[128:131], v[40:43], v[224:227], v[128:131]
  s_cselect_b32 s5, s7, s5
  ds_read_b64_tr_b16 v[66:67], v12 offset:41984
  v_mfma_f32_16x16x32_bf16 v[144:147], v[44:47], v[224:227], v[144:147]
  s_mov_b32 s60, s8
  buffer_load_dword v15, v8, s[40:43], 0 offen sc1
  v_mfma_f32_16x16x32_bf16 v[160:163], v[48:51], v[224:227], v[160:163]
  s_mov_b32 s61, s9
  ds_read_b64_tr_b16 v[68:69], v13 offset:40960
  v_mfma_f32_16x16x32_bf16 v[176:179], v[52:55], v[224:227], v[176:179]
  s_mov_b32 s62, 2211840
  ds_read_b64_tr_b16 v[70:71], v13 offset:41984
  v_mfma_f32_16x16x32_bf16 v[192:195], v[56:59], v[224:227], v[192:195]
  s_mov_b32 s63, 0x20000
  ds_read_b64_tr_b16 v[72:73], v12 offset:41216
  v_mfma_f32_16x16x32_bf16 v[208:211], v[60:63], v[224:227], v[208:211]
  s_mov_b64 s[56:57], s[52:53]
  ds_read_b64_tr_b16 v[74:75], v12 offset:42240
  v_mfma_f32_16x16x32_bf16 v[100:103], v[32:35], v[228:231], v[100:103]
  s_mov_b32 s58, s54
  v_mfma_f32_16x16x32_bf16 v[116:119], v[36:39], v[228:231], v[116:119]
  s_mov_b64 s[52:53], s[4:5]
  ds_read_b64_tr_b16 v[76:77], v13 offset:41216
  v_mfma_f32_16x16x32_bf16 v[132:135], v[40:43], v[228:231], v[132:135]
  s_mov_b32 s54, 2211840
  ds_read_b64_tr_b16 v[78:79], v13 offset:42240
  v_mfma_f32_16x16x32_bf16 v[148:151], v[44:47], v[228:231], v[148:151]
  s_and_b32 s32, s21, 3
  ds_read_b128 v[240:243], v14 offset:32768
  v_mfma_f32_16x16x32_bf16 v[164:167], v[48:51], v[228:231], v[164:167]
  s_add_u32 s32, s32, 6
  ds_read_b128 v[244:247], v14 offset:33792
  v_mfma_f32_16x16x32_bf16 v[180:183], v[52:55], v[228:231], v[180:183]
  s_lshl_b32 s32, s32, 14
  v_mfma_f32_16x16x32_bf16 v[196:199], v[56:59], v[228:231], v[196:199]
  s_cmp_lt_u32 s2, 64
  ds_read_b64_tr_b16 v[80:81], v12 offset:41472
  v_mfma_f32_16x16x32_bf16 v[212:215], v[60:63], v[228:231], v[212:215]
  s_cselect_b32 s32, s32, 0
  ds_read_b64_tr_b16 v[82:83], v12 offset:42496
  v_mfma_f32_16x16x32_bf16 v[104:107], v[32:35], v[232:235], v[104:107]
  s_cselect_b32 s9, -1, 0
  ds_read_b64_tr_b16 v[84:85], v13 offset:41472
  v_mfma_f32_16x16x32_bf16 v[120:123], v[36:39], v[232:235], v[120:123]
  s_mov_b32 s8, 0
  ds_read_b64_tr_b16 v[86:87], v13 offset:42496
  v_mfma_f32_16x16x32_bf16 v[136:139], v[40:43], v[232:235], v[136:139]
  s_mov_b32 s66, 0
  v_mfma_f32_16x16x32_bf16 v[152:155], v[44:47], v[232:235], v[152:155]
  s_mov_b32 s11, 0
  ds_read_b64_tr_b16 v[88:89], v12 offset:41728
  v_mfma_f32_16x16x32_bf16 v[168:171], v[48:51], v[232:235], v[168:171]
  s_mov_b32 s12, 0
  ds_read_b64_tr_b16 v[90:91], v12 offset:42752
  v_mfma_f32_16x16x32_bf16 v[184:187], v[52:55], v[232:235], v[184:187]
  s_lshl_b32 s15, s22, 1
  ds_read_b64_tr_b16 v[92:93], v13 offset:41728
  v_mfma_f32_16x16x32_bf16 v[200:203], v[56:59], v[232:235], v[200:203]
  s_add_u32 s23, s15, 6
  ds_read_b64_tr_b16 v[94:95], v13 offset:42752
  v_mfma_f32_16x16x32_bf16 v[216:219], v[60:63], v[232:235], v[216:219]
  s_sub_u32 s15, 24, s15
  v_mfma_f32_16x16x32_bf16 v[108:111], v[32:35], v[236:239], v[108:111]
  s_max_u32 s15, s15, s23
  ds_read_b128 v[248:251], v14 offset:34816
  v_mfma_f32_16x16x32_bf16 v[124:127], v[36:39], v[236:239], v[124:127]
  s_lshl_b32 s15, s15, 14
  ds_read_b128 v[252:255], v14 offset:35840
  v_mfma_f32_16x16x32_bf16 v[140:143], v[40:43], v[236:239], v[140:143]
  s_getpc_b64 s[36:37]
fa_copc:
  v_mfma_f32_16x16x32_bf16 v[156:159], v[44:47], v[236:239], v[156:159]
  s_add_u32 s36, s36, fa_co-fa_copc-4
  v_xor_b32 v14, 0x10000, v14
  v_mfma_f32_16x16x32_bf16 v[172:175], v[48:51], v[236:239], v[172:175]
  s_addc_u32 s37, s37, 0
  v_mfma_f32_16x16x32_bf16 v[188:191], v[52:55], v[236:239], v[188:191]
  v_xor_b32 v12, 0x10000, v12
  v_mfma_f32_16x16x32_bf16 v[204:207], v[56:59], v[236:239], v[204:207]
  v_xor_b32 v13, 0x10000, v13
  v_mfma_f32_16x16x32_bf16 v[220:223], v[60:63], v[236:239], v[220:223]
  s_waitcnt vmcnt(0) lgkmcnt(0)
  v_mfma_f32_16x16x32_bf16 v[96:99], v[64:67], v[240:243], v[96:99]
  s_barrier
  v_cmp_eq_u32 vcc, 0, v15
  v_mfma_f32_16x16x32_bf16 v[112:115], v[68:71], v[240:243], v[112:115]
  s_cbranch_vccnz fa_kv_spin
fa_kv_ok:
  v_mfma_f32_16x16x32_bf16 v[128:131], v[72:75], v[240:243], v[128:131]
  s_mov_b32 m0, s24
  v_mfma_f32_16x16x32_bf16 v[144:147], v[76:79], v[240:243], v[144:147]
  buffer_load_dwordx4 v2, s[44:47], s26 offen offset:0 sc1 lds
  v_mfma_f32_16x16x32_bf16 v[160:163], v[80:83], v[240:243], v[160:163]
  s_add_u32 s24, s24, 32768
  v_mfma_f32_16x16x32_bf16 v[176:179], v[84:87], v[240:243], v[176:179]
  s_and_b32 s24, s24, 0x1ffff
  buffer_load_dwordx4 v2, s[44:47], s26 offen offset:1024 sc1 lds
  v_mfma_f32_16x16x32_bf16 v[192:195], v[88:91], v[240:243], v[192:195]
  v_mfma_f32_16x16x32_bf16 v[208:211], v[92:95], v[240:243], v[208:211]
  buffer_load_dwordx4 v2, s[44:47], s26 offen offset:2048 sc1 lds
  v_mfma_f32_16x16x32_bf16 v[100:103], v[64:67], v[244:247], v[100:103]
  v_mfma_f32_16x16x32_bf16 v[116:119], v[68:71], v[244:247], v[116:119]
  buffer_load_dwordx4 v2, s[44:47], s26 offen offset:3072 sc1 lds
  v_mfma_f32_16x16x32_bf16 v[132:135], v[72:75], v[244:247], v[132:135]
  s_add_u32 s26, s26, 16384
  v_cvt_pk_bf16_f32 v32, v96, v97
  v_cvt_pk_bf16_f32 v33, v98, v99
  v_mfma_f32_16x16x32_bf16 v[148:151], v[76:79], v[244:247], v[148:151]
  v_cvt_pk_bf16_f32 v34, v112, v113
  v_cvt_pk_bf16_f32 v35, v114, v115
  v_mfma_f32_16x16x32_bf16 v[164:167], v[80:83], v[244:247], v[164:167]
  s_mov_b32 m0, s24
  v_cvt_pk_bf16_f32 v40, v128, v129
  v_mfma_f32_16x16x32_bf16 v[180:183], v[84:87], v[244:247], v[180:183]
  buffer_load_dwordx4 v2, s[44:47], s26 offen offset:0 sc1 lds
  v_cvt_pk_bf16_f32 v41, v130, v131
  v_cvt_pk_bf16_f32 v42, v144, v145
  v_mfma_f32_16x16x32_bf16 v[196:199], v[88:91], v[244:247], v[196:199]
  s_add_u32 s24, s24, 32768
  v_cvt_pk_bf16_f32 v43, v146, v147
  v_mfma_f32_16x16x32_bf16 v[212:215], v[92:95], v[244:247], v[212:215]
  s_and_b32 s24, s24, 0x1ffff
  buffer_load_dwordx4 v2, s[44:47], s26 offen offset:1024 sc1 lds
  v_cvt_pk_bf16_f32 v48, v160, v161
  v_cvt_pk_bf16_f32 v49, v162, v163
  v_mfma_f32_16x16x32_bf16 v[104:107], v[64:67], v[248:251], v[104:107]
  v_cvt_pk_bf16_f32 v50, v176, v177
  v_cvt_pk_bf16_f32 v51, v178, v179
  v_mfma_f32_16x16x32_bf16 v[120:123], v[68:71], v[248:251], v[120:123]
  buffer_load_dwordx4 v2, s[44:47], s26 offen offset:2048 sc1 lds
  v_cvt_pk_bf16_f32 v56, v192, v193
  v_mfma_f32_16x16x32_bf16 v[136:139], v[72:75], v[248:251], v[136:139]
  v_cvt_pk_bf16_f32 v57, v194, v195
  v_cvt_pk_bf16_f32 v58, v208, v209
  v_mfma_f32_16x16x32_bf16 v[152:155], v[76:79], v[248:251], v[152:155]
  buffer_load_dwordx4 v2, s[44:47], s26 offen offset:3072 sc1 lds
  v_cvt_pk_bf16_f32 v59, v210, v211
  v_mfma_f32_16x16x32_bf16 v[168:171], v[80:83], v[248:251], v[168:171]
  s_add_u32 s26, s26, 16384
  v_cvt_pk_bf16_f32 v36, v100, v101
  v_cvt_pk_bf16_f32 v37, v102, v103
  v_mfma_f32_16x16x32_bf16 v[184:187], v[84:87], v[248:251], v[184:187]
  v_cvt_pk_bf16_f32 v38, v116, v117
  v_mfma_f32_16x16x32_bf16 v[200:203], v[88:91], v[248:251], v[200:203]
  s_mov_b32 m0, s24
  v_cvt_pk_bf16_f32 v39, v118, v119
  v_cvt_pk_bf16_f32 v44, v132, v133
  v_mfma_f32_16x16x32_bf16 v[216:219], v[92:95], v[248:251], v[216:219]
  buffer_load_dwordx4 v2, s[44:47], s26 offen offset:0 sc1 lds
  v_cvt_pk_bf16_f32 v45, v134, v135
  v_mfma_f32_16x16x32_bf16 v[108:111], v[64:67], v[252:255], v[108:111]
  s_add_u32 s24, s24, 32768
  v_cvt_pk_bf16_f32 v46, v148, v149
  v_cvt_pk_bf16_f32 v47, v150, v151
  v_mfma_f32_16x16x32_bf16 v[124:127], v[68:71], v[252:255], v[124:127]
  s_and_b32 s24, s24, 0x1ffff
  buffer_load_dwordx4 v2, s[44:47], s26 offen offset:1024 sc1 lds
  v_cvt_pk_bf16_f32 v52, v164, v165
  v_mfma_f32_16x16x32_bf16 v[140:143], v[72:75], v[252:255], v[140:143]
  v_cvt_pk_bf16_f32 v53, v166, v167
  v_cvt_pk_bf16_f32 v54, v180, v181
  v_mfma_f32_16x16x32_bf16 v[156:159], v[76:79], v[252:255], v[156:159]
  buffer_load_dwordx4 v2, s[44:47], s26 offen offset:2048 sc1 lds
  v_cvt_pk_bf16_f32 v55, v182, v183
  v_mfma_f32_16x16x32_bf16 v[172:175], v[80:83], v[252:255], v[172:175]
  v_cvt_pk_bf16_f32 v60, v196, v197
  v_cvt_pk_bf16_f32 v61, v198, v199
  v_mfma_f32_16x16x32_bf16 v[188:191], v[84:87], v[252:255], v[188:191]
  buffer_load_dwordx4 v2, s[44:47], s26 offen offset:3072 sc1 lds
  v_cvt_pk_bf16_f32 v62, v212, v213
  v_mfma_f32_16x16x32_bf16 v[204:207], v[88:91], v[252:255], v[204:207]
  s_add_u32 s26, s26, 16384
  v_cvt_pk_bf16_f32 v63, v214, v215
  v_mfma_f32_16x16x32_bf16 v[220:223], v[92:95], v[252:255], v[220:223]
  s_mov_b32 m0, s25
  s_nop 0
  buffer_load_dwordx4 v2, s[48:51], s27 offen offset:0 sc1 lds
  v_cvt_pk_bf16_f32 v64, v104, v105
  v_cvt_pk_bf16_f32 v65, v106, v107
  v_cvt_pk_bf16_f32 v66, v120, v121
  v_cvt_pk_bf16_f32 v67, v122, v123
  v_cvt_pk_bf16_f32 v72, v136, v137
  buffer_load_dwordx4 v2, s[48:51], s27 offen offset:1024 sc1 lds
  v_cvt_pk_bf16_f32 v73, v138, v139
  v_cvt_pk_bf16_f32 v74, v152, v153
  v_cvt_pk_bf16_f32 v75, v154, v155
  v_cvt_pk_bf16_f32 v80, v168, v169
  v_cvt_pk_bf16_f32 v81, v170, v171
  buffer_load_dwordx4 v2, s[48:51], s27 offen offset:2048 sc1 lds
  v_cvt_pk_bf16_f32 v82, v184, v185
  v_cvt_pk_bf16_f32 v83, v186, v187
  v_cvt_pk_bf16_f32 v88, v200, v201
  v_cvt_pk_bf16_f32 v89, v202, v203
  v_cvt_pk_bf16_f32 v90, v216, v217
  buffer_load_dwordx4 v2, s[48:51], s27 offen offset:3072 sc1 lds
  v_cvt_pk_bf16_f32 v91, v218, v219
  v_cvt_pk_bf16_f32 v68, v108, v109
  v_cvt_pk_bf16_f32 v69, v110, v111
  v_cvt_pk_bf16_f32 v70, v124, v125
  v_cvt_pk_bf16_f32 v71, v126, v127
  s_add_u32 s27, s27, 16384
  s_add_u32 s25, s25, 32768
  s_and_b32 s25, s25, 0x1ffff
  s_mov_b32 m0, s25
  s_nop 0
  buffer_load_dwordx4 v2, s[48:51], s27 offen offset:0 sc1 lds
  v_cvt_pk_bf16_f32 v76, v140, v141
  v_cvt_pk_bf16_f32 v77, v142, v143
  v_cvt_pk_bf16_f32 v78, v156, v157
  v_cvt_pk_bf16_f32 v79, v158, v159
  v_cvt_pk_bf16_f32 v84, v172, v173
  buffer_load_dwordx4 v2, s[48:51], s27 offen offset:1024 sc1 lds
  v_cvt_pk_bf16_f32 v85, v174, v175
  v_cvt_pk_bf16_f32 v86, v188, v189
  v_cvt_pk_bf16_f32 v87, v190, v191
  v_cvt_pk_bf16_f32 v92, v204, v205
  v_cvt_pk_bf16_f32 v93, v206, v207
  buffer_load_dwordx4 v2, s[48:51], s27 offen offset:2048 sc1 lds
  v_cvt_pk_bf16_f32 v94, v220, v221
  v_cvt_pk_bf16_f32 v95, v222, v223
  v_mov_b32 v228, 0
  v_mov_b32 v229, 0
  v_mov_b32 v230, 0
  buffer_load_dwordx4 v2, s[48:51], s27 offen offset:3072 sc1 lds
  v_mov_b32 v231, 0
  s_add_u32 s27, s27, 16384
  s_add_u32 s25, s25, 32768
  s_and_b32 s25, s25, 0x1ffff
  s_waitcnt vmcnt(12)
  s_barrier
  ds_read_b128 a[128:131], v18 offset:0
  ds_read_b128 a[132:135], v18 offset:1024
  ds_read_b128 a[136:139], v18 offset:2048
  ds_read_b128 a[140:143], v18 offset:3072
  ds_read_b128 a[144:147], v18 offset:4096
  ds_read_b128 a[148:151], v18 offset:5120
  ds_read_b128 a[152:155], v18 offset:6144
  ds_read_b128 a[156:159], v18 offset:7168
  s_sub_u32 s23, s2, 170
  s_cmp_lt_u32 s23, 54
  s_cbranch_scc1 fa_wo0
fa_wo0b:
  s_cmp_eq_u32 s2, 255
  s_cbranch_scc1 fa_top8
fa_notop:
  s_waitcnt lgkmcnt(4)
  v_mfma_f32_16x16x32_bf16 v[96:99], a[128:131], v[32:35], 0
  v_mfma_f32_16x16x32_bf16 v[104:107], a[128:131], v[36:39], 0
  v_mfma_f32_16x16x32_bf16 v[128:131], a[128:131], v[64:67], 0
  v_mfma_f32_16x16x32_bf16 v[136:139], a[128:131], v[68:71], 0
  s_mov_b32 m0, s24
  ds_read_b128 a[128:131], v3 offset:0
  v_mfma_f32_16x16x32_bf16 v[100:103], a[132:135], v[32:35], 0
  buffer_load_dwordx4 v2, s[44:47], s26 offen offset:0 sc1 lds
  v_mfma_f32_16x16x32_bf16 v[108:111], a[132:135], v[36:39], 0
  v_mfma_f32_16x16x32_bf16 v[132:135], a[132:135], v[64:67], 0
  v_mfma_f32_16x16x32_bf16 v[140:143], a[132:135], v[68:71], 0
  ds_read_b128 a[132:135], v3 offset:1024
  v_mfma_f32_16x16x32_bf16 v[96:99], a[136:139], v[40:43], v[96:99]
  v_mfma_f32_16x16x32_bf16 v[104:107], a[136:139], v[44:47], v[104:107]
  v_mfma_f32_16x16x32_bf16 v[128:131], a[136:139], v[72:75], v[128:131]
  buffer_load_dwordx4 v2, s[44:47], s26 offen offset:1024 sc1 lds
  v_mfma_f32_16x16x32_bf16 v[136:139], a[136:139], v[76:79], v[136:139]
  ds_read_b128 a[136:139], v3 offset:2048
  v_mfma_f32_16x16x32_bf16 v[100:103], a[140:143], v[40:43], v[100:103]
  v_mfma_f32_16x16x32_bf16 v[108:111], a[140:143], v[44:47], v[108:111]
  v_mfma_f32_16x16x32_bf16 v[132:135], a[140:143], v[72:75], v[132:135]
  v_mfma_f32_16x16x32_bf16 v[140:143], a[140:143], v[76:79], v[140:143]
  s_waitcnt lgkmcnt(3)
  ds_read_b128 a[140:143], v3 offset:3072
  v_mfma_f32_16x16x32_bf16 v[96:99], a[144:147], v[48:51], v[96:99]
  v_mfma_f32_16x16x32_bf16 v[104:107], a[144:147], v[52:55], v[104:107]
  v_mfma_f32_16x16x32_bf16 v[128:131], a[144:147], v[80:83], v[128:131]
  buffer_load_dwordx4 v2, s[44:47], s26 offen offset:2048 sc1 lds
  v_mfma_f32_16x16x32_bf16 v[136:139], a[144:147], v[84:87], v[136:139]
  ds_read_b128 a[144:147], v3 offset:4096
  v_mfma_f32_16x16x32_bf16 v[100:103], a[148:151], v[48:51], v[100:103]
  v_mfma_f32_16x16x32_bf16 v[108:111], a[148:151], v[52:55], v[108:111]
  v_mfma_f32_16x16x32_bf16 v[132:135], a[148:151], v[80:83], v[132:135]
  v_mfma_f32_16x16x32_bf16 v[140:143], a[148:151], v[84:87], v[140:143]
  ds_read_b128 a[148:151], v3 offset:5120
  v_mfma_f32_16x16x32_bf16 v[96:99], a[152:155], v[56:59], v[96:99]
  buffer_load_dwordx4 v2, s[44:47], s26 offen offset:3072 sc1 lds
  v_mfma_f32_16x16x32_bf16 v[104:107], a[152:155], v[60:63], v[104:107]
  s_add_u32 s26, s26, 16384
  v_mfma_f32_16x16x32_bf16 v[128:131], a[152:155], v[88:91], v[128:131]
  s_add_u32 s24, s24, 32768
  v_mfma_f32_16x16x32_bf16 v[136:139], a[152:155], v[92:95], v[136:139]
  s_and_b32 s24, s24, 0x1ffff
  ds_read_b128 a[152:155], v3 offset:6144
  v_mfma_f32_16x16x32_bf16 v[100:103], a[156:159], v[56:59], v[100:103]
  v_mfma_f32_16x16x32_bf16 v[108:111], a[156:159], v[60:63], v[108:111]
  v_mfma_f32_16x16x32_bf16 v[132:135], a[156:159], v[88:91], v[132:135]
  v_mfma_f32_16x16x32_bf16 v[140:143], a[156:159], v[92:95], v[140:143]
  s_waitcnt lgkmcnt(3)
  ds_read_b128 a[156:159], v3 offset:7168
  s_nop 7
  s_cmp_lg_u32 s28, 0
  s_cbranch_scc1 fa_nomask0
  v_cndmask_b32 v96, v4, v96, s[68:69]
  v_cndmask_b32 v97, v4, v97, s[70:71]
  v_cndmask_b32 v98, v4, v98, s[72:73]
  v_cndmask_b32 v99, v4, v99, s[74:75]
  v_mov_b32 v100, v4
  v_mov_b32 v101, v4
  v_mov_b32 v102, v4
  v_mov_b32 v103, v4
  v_cndmask_b32 v108, v4, v108, s[68:69]
  v_cndmask_b32 v109, v4, v109, s[70:71]
  v_cndmask_b32 v110, v4, v110, s[72:73]
  v_cndmask_b32 v111, v4, v111, s[74:75]
fa_nomask0:
  v_max3_f32 v16, v96, v97, v98
  v_max3_f32 v16, v16, v99, v100
  v_max3_f32 v16, v16, v101, v102
  v_max_f32 v16, v16, v103
  v_max3_f32 v17, v104, v105, v106
  v_max3_f32 v17, v17, v107, v108
  v_max3_f32 v17, v17, v109, v110
  v_max_f32 v17, v17, v111
  v_max3_f32 v18, v128, v129, v130
  v_max3_f32 v18, v18, v131, v132
  v_max3_f32 v18, v18, v133, v134
  v_max_f32 v18, v18, v135
  v_max3_f32 v19, v136, v137, v138
  v_max3_f32 v19, v19, v139, v140
  v_max3_f32 v19, v19, v141, v142
  v_max_f32 v19, v19, v143
  v_mov_b32 v20, v16
  v_mov_b32 v21, v17
  v_mov_b32 v22, v18
  v_mov_b32 v23, v19
  s_nop 0
  v_permlane16_swap_b32 v16, v20
  v_permlane16_swap_b32 v17, v21
  v_permlane16_swap_b32 v18, v22
  v_permlane16_swap_b32 v19, v23
  v_max_f32 v16, v16, v20
  v_max_f32 v17, v17, v21
  v_max_f32 v18, v18, v22
  v_max_f32 v19, v19, v23
  v_mov_b32 v20, v16
  v_mov_b32 v21, v17
  v_mov_b32 v22, v18
  v_mov_b32 v23, v19
  s_nop 0
  v_permlane32_swap_b32 v16, v20
  v_permlane32_swap_b32 v17, v21
  v_permlane32_swap_b32 v18, v22
  v_permlane32_swap_b32 v19, v23
  v_max_f32 v16, v16, v20
  v_max_f32 v17, v17, v21
  v_max_f32 v18, v18, v22
  v_max_f32 v19, v19, v23
  v_sub_f32 v192, 0, v16
  v_sub_f32 v193, 0, v16
  v_sub_f32 v194, 0, v16
  v_sub_f32 v195, 0, v16
  v_sub_f32 v196, 0, v17
  v_sub_f32 v197, 0, v17
  v_sub_f32 v198, 0, v17
  v_sub_f32 v199, 0, v17
  v_sub_f32 v200, 0, v18
  v_sub_f32 v201, 0, v18
  v_sub_f32 v202, 0, v18
  v_sub_f32 v203, 0, v18
  v_sub_f32 v204, 0, v19
  v_sub_f32 v205, 0, v19
  v_sub_f32 v206, 0, v19
  v_sub_f32 v207, 0, v19
  v_sub_f32 v96, v96, v16
  v_sub_f32 v97, v97, v16
  v_sub_f32 v98, v98, v16
  v_sub_f32 v99, v99, v16
  v_sub_f32 v100, v100, v16
  v_sub_f32 v101, v101, v16
  v_sub_f32 v102, v102, v16
  v_sub_f32 v103, v103, v16
  v_sub_f32 v104, v104, v17
  v_sub_f32 v105, v105, v17
  v_sub_f32 v106, v106, v17
  v_sub_f32 v107, v107, v17
  v_sub_f32 v108, v108, v17
  v_sub_f32 v109, v109, v17
  v_sub_f32 v110, v110, v17
  v_sub_f32 v111, v111, v17
  v_sub_f32 v128, v128, v18
  v_sub_f32 v129, v129, v18
  v_sub_f32 v130, v130, v18
  v_sub_f32 v131, v131, v18
  v_sub_f32 v132, v132, v18
  v_sub_f32 v133, v133, v18
  v_sub_f32 v134, v134, v18
  v_sub_f32 v135, v135, v18
  v_sub_f32 v136, v136, v19
  v_sub_f32 v137, v137, v19
  v_sub_f32 v138, v138, v19
  v_sub_f32 v139, v139, v19
  v_sub_f32 v140, v140, v19
  v_sub_f32 v141, v141, v19
  v_sub_f32 v142, v142, v19
  v_sub_f32 v143, v143, v19
  v_mfma_f32_16x16x32_bf16 v[112:115], a[128:131], v[32:35], v[192:195]
  v_exp_f32 v216, v128
  v_exp_f32 v217, v129
  v_mfma_f32_16x16x32_bf16 v[120:123], a[128:131], v[36:39], v[196:199]
  v_exp_f32 v218, v130
  v_add_f32 v226, v216, v217
  v_cvt_pk_bf16_f32 v176, v216, v217
  v_mfma_f32_16x16x32_bf16 v[144:147], a[128:131], v[64:67], v[200:203]
  s_add_u32 s66, s66, 32768
  v_exp_f32 v219, v131
  v_add_f32 v226, v226, v218
  v_add_f32 v226, v226, v219
  v_mfma_f32_16x16x32_bf16 v[152:155], a[128:131], v[68:71], v[204:207]
  s_mov_b32 m0, s25
  ds_read_b128 a[128:131], v3 offset:8192
  v_exp_f32 v220, v132
  v_cvt_pk_bf16_f32 v177, v218, v219
  v_mfma_f32_16x16x32_bf16 v[116:119], a[132:135], v[32:35], v[192:195]
  s_and_b32 s66, s66, 0x1ffff
  buffer_load_dwordx4 v2, s[48:51], s27 offen offset:0 sc1 lds
  v_exp_f32 v221, v133
  v_add_f32 v226, v226, v220
  v_add_f32 v226, v226, v221
  v_mfma_f32_16x16x32_bf16 v[124:127], a[132:135], v[36:39], v[196:199]
  v_exp_f32 v222, v134
  v_cvt_pk_bf16_f32 v178, v220, v221
  v_exp_f32 v223, v135
  v_mfma_f32_16x16x32_bf16 v[148:151], a[132:135], v[64:67], v[200:203]
  v_exp_f32 v216, v136
  v_add_f32 v226, v226, v222
  v_mfma_f32_16x16x32_bf16 v[156:159], a[132:135], v[68:71], v[204:207]
  ds_read_b128 a[132:135], v3 offset:9216
  v_exp_f32 v217, v137
  v_add_f32 v226, v226, v223
  v_mfma_f32_16x16x32_bf16 v[112:115], a[136:139], v[40:43], v[112:115]
  v_exp_f32 v218, v138
  v_cvt_pk_bf16_f32 v179, v222, v223
  v_add_f32 v227, v216, v217
  v_mfma_f32_16x16x32_bf16 v[120:123], a[136:139], v[44:47], v[120:123]
  v_exp_f32 v219, v139
  v_cvt_pk_bf16_f32 v180, v216, v217
  v_add_f32 v227, v227, v218
  v_add_f32 v227, v227, v219
  v_mfma_f32_16x16x32_bf16 v[144:147], a[136:139], v[72:75], v[144:147]
  buffer_load_dwordx4 v2, s[48:51], s27 offen offset:1024 sc1 lds
  v_exp_f32 v220, v140
  v_cvt_pk_bf16_f32 v181, v218, v219
  v_mfma_f32_16x16x32_bf16 v[152:155], a[136:139], v[76:79], v[152:155]
  ds_read_b128 a[136:139], v3 offset:10240
  v_exp_f32 v221, v141
  v_add_f32 v227, v227, v220
  v_mfma_f32_16x16x32_bf16 v[116:119], a[140:143], v[40:43], v[116:119]
  v_exp_f32 v222, v142
  v_add_f32 v227, v227, v221
  v_cvt_pk_bf16_f32 v182, v220, v221
  v_mfma_f32_16x16x32_bf16 v[124:127], a[140:143], v[44:47], v[124:127]
  v_exp_f32 v223, v143
  v_add_f32 v227, v227, v222
  v_add_f32 v227, v227, v223
  v_exp_f32 v208, v96
  v_mfma_f32_16x16x32_bf16 v[148:151], a[140:143], v[72:75], v[148:151]
  v_exp_f32 v209, v97
  v_cvt_pk_bf16_f32 v183, v222, v223
  v_mfma_f32_16x16x32_bf16 v[156:159], a[140:143], v[76:79], v[156:159]
  s_waitcnt lgkmcnt(3)
  ds_read_b128 a[140:143], v3 offset:11264
  v_exp_f32 v210, v98
  v_add_f32 v224, v208, v209
  v_mfma_f32_16x16x32_bf16 v[112:115], a[144:147], v[48:51], v[112:115]
  v_exp_f32 v211, v99
  v_cvt_pk_bf16_f32 v160, v208, v209
  v_add_f32 v224, v224, v210
  v_mfma_f32_16x16x32_bf16 v[120:123], a[144:147], v[52:55], v[120:123]
  v_exp_f32 v212, v100
  v_add_f32 v224, v224, v211
  v_cvt_pk_bf16_f32 v161, v210, v211
  v_mfma_f32_16x16x32_bf16 v[144:147], a[144:147], v[80:83], v[144:147]
  buffer_load_dwordx4 v2, s[48:51], s27 offen offset:2048 sc1 lds
  v_exp_f32 v213, v101
  v_add_f32 v224, v224, v212
  v_add_f32 v224, v224, v213
  v_mfma_f32_16x16x32_bf16 v[152:155], a[144:147], v[84:87], v[152:155]
  ds_read_b128 a[144:147], v3 offset:12288
  v_exp_f32 v214, v102
  v_cvt_pk_bf16_f32 v162, v212, v213
  v_mfma_f32_16x16x32_bf16 v[116:119], a[148:151], v[48:51], v[116:119]
  v_exp_f32 v215, v103
  v_add_f32 v224, v224, v214
  v_add_f32 v224, v224, v215
  v_mfma_f32_16x16x32_bf16 v[124:127], a[148:151], v[52:55], v[124:127]
  v_exp_f32 v208, v104
  v_exp_f32 v209, v105
  v_mfma_f32_16x16x32_bf16 v[148:151], a[148:151], v[80:83], v[148:151]
  v_exp_f32 v210, v106
  v_cvt_pk_bf16_f32 v163, v214, v215
  v_add_f32 v225, v208, v209
  v_mfma_f32_16x16x32_bf16 v[156:159], a[148:151], v[84:87], v[156:159]
  ds_read_b128 a[148:151], v3 offset:13312
  v_exp_f32 v211, v107
  v_cvt_pk_bf16_f32 v164, v208, v209
  v_add_f32 v225, v225, v210
  v_mfma_f32_16x16x32_bf16 v[112:115], a[152:155], v[56:59], v[112:115]
  buffer_load_dwordx4 v2, s[48:51], s27 offen offset:3072 sc1 lds
  v_exp_f32 v212, v108
  v_add_f32 v225, v225, v211
  v_mfma_f32_16x16x32_bf16 v[120:123], a[152:155], v[60:63], v[120:123]
  s_add_u32 s27, s27, 16384
  v_exp_f32 v213, v109
  v_mfma_f32_16x16x32_bf16 v[144:147], a[152:155], v[88:91], v[144:147]
  s_add_u32 s25, s25, 32768
  v_exp_f32 v214, v110
  v_mfma_f32_16x16x32_bf16 v[152:155], a[152:155], v[92:95], v[152:155]
  s_and_b32 s25, s25, 0x1ffff
  ds_read_b128 a[152:155], v3 offset:14336
  v_cvt_pk_bf16_f32 v165, v210, v211
  v_max3_f32 v5, v226, v227, v224
  v_add_f32 v225, v225, v212
  v_add_f32 v225, v225, v213
  v_cvt_pk_bf16_f32 v166, v212, v213
  v_exp_f32 v215, v111
  v_mfma_f32_16x16x32_bf16 v[116:119], a[156:159], v[56:59], v[116:119]
  v_add_f32 v225, v225, v214
  v_add_f32 v225, v225, v215
  v_max_f32 v5, v5, v225
  v_cmp_lt_f32 vcc, s81, v5
  v_mfma_f32_16x16x32_bf16 v[124:127], a[156:159], v[60:63], v[124:127]
  v_mfma_f32_16x16x32_bf16 v[148:151], a[156:159], v[88:91], v[148:151]
  v_cvt_pk_bf16_f32 v167, v214, v215
  v_mfma_f32_16x16x32_bf16 v[156:159], a[156:159], v[92:95], v[156:159]
  s_waitcnt lgkmcnt(3)
  s_cbranch_vccnz fa_stub0
fa_back0:
  ds_read_b128 a[156:159], v3 offset:15360
  v_add_f32 v228, v228, v224
  v_add_f32 v229, v229, v225
  v_add_f32 v230, v230, v226
  v_add_f32 v231, v231, v227
  s_nop 3
  v_exp_f32 v216, v144
  v_exp_f32 v217, v145
  v_add_u32 v3, s66, v2
  s_cmp_eq_u32 s28, 0
  s_cbranch_scc1 fa_AV
  s_sub_u32 s28, s28, 1
  s_cmp_eq_u32 s28, 0
  s_cbranch_scc1 fa_Aexit
.p2align 6
fa_DD:
  v_mfma_f32_16x16x32_bf16 v[96:99], a[128:131], v[32:35], v[192:195]
  s_waitcnt vmcnt(12)
  v_exp_f32 v218, v146
  v_mfma_f32_16x16x32_bf16 v[104:107], a[128:131], v[36:39], v[196:199]
  s_barrier
  v_exp_f32 v219, v147
  v_mfma_f32_16x16x32_bf16 v[128:131], a[128:131], v[64:67], v[200:203]
  s_cmp_ge_u32 s26, s32
  ds_read_b128 a[160:163], v3 offset:16384
  v_add_f32 v226, v216, v217
  v_mfma_f32_16x16x32_bf16 v[136:139], a[128:131], v[68:71], v[204:207]
  s_cbranch_scc1 fa_hk4
fa_hb4:
  v_exp_f32 v220, v148
  v_mfma_f32_16x16x32_bf16 v[100:103], a[132:135], v[32:35], v[192:195]
  ds_read_b128 a[164:167], v3 offset:17408
  v_cvt_pk_bf16_f32 v184, v216, v217
  v_mfma_f32_16x16x32_bf16 v[108:111], a[132:135], v[36:39], v[196:199]
  s_mov_b32 m0, s24
  v_exp_f32 v221, v149
  v_mfma_f32_16x16x32_bf16 v[132:135], a[132:135], v[64:67], v[200:203]
  buffer_load_dwordx4 v2, s[44:47], s26 offen offset:0 sc1 lds
  v_add_f32 v226, v226, v218
  v_mfma_f32_16x16x32_bf16 v[140:143], a[132:135], v[68:71], v[204:207]
  v_exp_f32 v222, v150
  v_mfma_f32_16x16x32_bf16 v[96:99], a[136:139], v[40:43], v[96:99]
  ds_read_b128 a[168:171], v3 offset:18432
  v_add_f32 v226, v226, v219
  v_mfma_f32_16x16x32_bf16 v[104:107], a[136:139], v[44:47], v[104:107]
  v_exp_f32 v223, v151
  v_mfma_f32_16x16x32_bf16 v[128:131], a[136:139], v[72:75], v[128:131]
  v_cvt_pk_bf16_f32 v185, v218, v219
  v_add_f32 v226, v226, v220
  v_mfma_f32_16x16x32_bf16 v[136:139], a[136:139], v[76:79], v[136:139]
  v_exp_f32 v216, v152
  v_mfma_f32_16x16x32_bf16 v[100:103], a[140:143], v[40:43], v[100:103]
  ds_read_b128 a[172:175], v3 offset:19456
  v_add_f32 v226, v226, v221
  v_mfma_f32_16x16x32_bf16 v[108:111], a[140:143], v[44:47], v[108:111]
  v_exp_f32 v217, v153
  v_mfma_f32_16x16x32_bf16 v[132:135], a[140:143], v[72:75], v[132:135]
  v_cvt_pk_bf16_f32 v186, v220, v221
  v_add_f32 v226, v226, v222
  v_mfma_f32_16x16x32_bf16 v[140:143], a[140:143], v[76:79], v[140:143]
  s_waitcnt lgkmcnt(4)
  v_exp_f32 v218, v154
  v_mfma_f32_16x16x32_bf16 v[96:99], a[144:147], v[48:51], v[96:99]
  ds_read_b128 a[176:179], v3 offset:20480
  v_add_f32 v226, v226, v223
  v_mfma_f32_16x16x32_bf16 v[104:107], a[144:147], v[52:55], v[104:107]
  v_exp_f32 v219, v155
  v_mfma_f32_16x16x32_bf16 v[128:131], a[144:147], v[80:83], v[128:131]
  v_cvt_pk_bf16_f32 v187, v222, v223
  v_add_f32 v227, v216, v217
  v_mfma_f32_16x16x32_bf16 v[136:139], a[144:147], v[84:87], v[136:139]
  v_exp_f32 v220, v156
  v_mfma_f32_16x16x32_bf16 v[100:103], a[148:151], v[48:51], v[100:103]
  ds_read_b128 a[180:183], v3 offset:21504
  v_cvt_pk_bf16_f32 v188, v216, v217
  v_mfma_f32_16x16x32_bf16 v[108:111], a[148:151], v[52:55], v[108:111]
  v_exp_f32 v221, v157
  v_mfma_f32_16x16x32_bf16 v[132:135], a[148:151], v[80:83], v[132:135]
  buffer_load_dwordx4 v2, s[44:47], s26 offen offset:1024 sc1 lds
  v_add_f32 v227, v227, v218
  v_mfma_f32_16x16x32_bf16 v[140:143], a[148:151], v[84:87], v[140:143]
  v_exp_f32 v222, v158
  v_mfma_f32_16x16x32_bf16 v[96:99], a[152:155], v[56:59], v[96:99]
  ds_read_b128 a[184:187], v3 offset:22528
  v_add_f32 v227, v227, v219
  v_mfma_f32_16x16x32_bf16 v[104:107], a[152:155], v[60:63], v[104:107]
  v_exp_f32 v223, v159
  v_mfma_f32_16x16x32_bf16 v[128:131], a[152:155], v[88:91], v[128:131]
  v_cvt_pk_bf16_f32 v189, v218, v219
  v_add_f32 v227, v227, v220
  v_mfma_f32_16x16x32_bf16 v[136:139], a[152:155], v[92:95], v[136:139]
  v_exp_f32 v208, v112
  v_mfma_f32_16x16x32_bf16 v[100:103], a[156:159], v[56:59], v[100:103]
  ds_read_b128 a[188:191], v3 offset:23552
  v_add_f32 v227, v227, v221
  v_mfma_f32_16x16x32_bf16 v[108:111], a[156:159], v[60:63], v[108:111]
  v_exp_f32 v209, v113
  v_mfma_f32_16x16x32_bf16 v[132:135], a[156:159], v[88:91], v[132:135]
  v_cvt_pk_bf16_f32 v190, v220, v221
  v_add_f32 v227, v227, v222
  v_add_f32 v227, v227, v223
  v_mfma_f32_16x16x32_bf16 v[140:143], a[156:159], v[92:95], v[140:143]
  s_waitcnt lgkmcnt(4)
  v_exp_f32 v210, v114
  v_mfma_f32_16x16x32_bf16 a[0:3], a[160:163], v[160:163], a[0:3]
  ds_read_b128 a[128:131], v3 offset:0
  v_cvt_pk_bf16_f32 v191, v222, v223
  v_mfma_f32_16x16x32_bf16 a[4:7], a[160:163], v[164:167], a[4:7]
  v_exp_f32 v211, v115
  v_mfma_f32_16x16x32_bf16 a[64:67], a[160:163], v[176:179], a[64:67]
  v_exp_f32 v212, v116
  v_mfma_f32_16x16x32_bf16 a[68:71], a[160:163], v[180:183], a[68:71]
  v_add_f32 v224, v208, v209
  v_cvt_pk_bf16_f32 v168, v208, v209
  v_mfma_f32_16x16x32_bf16 a[8:11], a[164:167], v[160:163], a[8:11]
  ds_read_b128 a[132:135], v3 offset:1024
  v_add_f32 v224, v224, v210
  v_mfma_f32_16x16x32_bf16 a[12:15], a[164:167], v[164:167], a[12:15]
  v_exp_f32 v213, v117
  v_mfma_f32_16x16x32_bf16 a[72:75], a[164:167], v[176:179], a[72:75]
  buffer_load_dwordx4 v2, s[44:47], s26 offen offset:2048 sc1 lds
  v_add_f32 v224, v224, v211
  v_mfma_f32_16x16x32_bf16 a[76:79], a[164:167], v[180:183], a[76:79]
  v_exp_f32 v214, v118
  v_mfma_f32_16x16x32_bf16 a[16:19], a[168:171], v[160:163], a[16:19]
  ds_read_b128 a[136:139], v3 offset:2048
  v_cvt_pk_bf16_f32 v169, v210, v211
  v_mfma_f32_16x16x32_bf16 a[20:23], a[168:171], v[164:167], a[20:23]
  v_exp_f32 v215, v119
  v_mfma_f32_16x16x32_bf16 a[80:83], a[168:171], v[176:179], a[80:83]
  v_add_f32 v224, v224, v212
  v_add_f32 v224, v224, v213
  v_mfma_f32_16x16x32_bf16 a[84:87], a[168:171], v[180:183], a[84:87]
  v_exp_f32 v208, v120
  v_mfma_f32_16x16x32_bf16 a[24:27], a[172:175], v[160:163], a[24:27]
  ds_read_b128 a[140:143], v3 offset:3072
  v_cvt_pk_bf16_f32 v170, v212, v213
  v_mfma_f32_16x16x32_bf16 a[28:31], a[172:175], v[164:167], a[28:31]
  v_exp_f32 v209, v121
  v_mfma_f32_16x16x32_bf16 a[88:91], a[172:175], v[176:179], a[88:91]
  v_exp_f32 v210, v122
  v_mfma_f32_16x16x32_bf16 a[92:95], a[172:175], v[180:183], a[92:95]
  s_waitcnt lgkmcnt(4)
  v_add_f32 v224, v224, v214
  v_add_f32 v224, v224, v215
  v_mfma_f32_16x16x32_bf16 a[32:35], a[176:179], v[160:163], a[32:35]
  ds_read_b128 a[144:147], v3 offset:4096
  v_cvt_pk_bf16_f32 v171, v214, v215
  v_mfma_f32_16x16x32_bf16 a[36:39], a[176:179], v[164:167], a[36:39]
  v_exp_f32 v211, v123
  v_mfma_f32_16x16x32_bf16 a[96:99], a[176:179], v[176:179], a[96:99]
  v_add_f32 v225, v208, v209
  v_cvt_pk_bf16_f32 v172, v208, v209
  v_mfma_f32_16x16x32_bf16 a[100:103], a[176:179], v[180:183], a[100:103]
  v_exp_f32 v212, v124
  v_mfma_f32_16x16x32_bf16 a[40:43], a[180:183], v[160:163], a[40:43]
  ds_read_b128 a[148:151], v3 offset:5120
  v_add_f32 v225, v225, v210
  v_mfma_f32_16x16x32_bf16 a[44:47], a[180:183], v[164:167], a[44:47]
  v_exp_f32 v213, v125
  v_mfma_f32_16x16x32_bf16 a[104:107], a[180:183], v[176:179], a[104:107]
  buffer_load_dwordx4 v2, s[44:47], s26 offen offset:3072 sc1 lds
  v_add_f32 v225, v225, v211
  v_mfma_f32_16x16x32_bf16 a[108:111], a[180:183], v[180:183], a[108:111]
  s_add_u32 s26, s26, 16384
  v_exp_f32 v214, v126
  v_mfma_f32_16x16x32_bf16 a[48:51], a[184:187], v[160:163], a[48:51]
  s_add_u32 s24, s24, 32768
  ds_read_b128 a[152:155], v3 offset:6144
  v_cvt_pk_bf16_f32 v173, v210, v211
  v_mfma_f32_16x16x32_bf16 a[52:55], a[184:187], v[164:167], a[52:55]
  s_and_b32 s24, s24, 0x1ffff
  v_exp_f32 v215, v127
  v_mfma_f32_16x16x32_bf16 a[112:115], a[184:187], v[176:179], a[112:115]
  v_max3_f32 v5, v226, v227, v224
  v_add_f32 v225, v225, v212
  v_mfma_f32_16x16x32_bf16 a[116:119], a[184:187], v[180:183], a[116:119]
  v_add_f32 v225, v225, v213
  v_cvt_pk_bf16_f32 v174, v212, v213
  v_add_f32 v225, v225, v214
  v_mfma_f32_16x16x32_bf16 a[56:59], a[188:191], v[160:163], a[56:59]
  ds_read_b128 a[156:159], v3 offset:7168
  v_add_f32 v225, v225, v215
  v_max_f32 v5, v5, v225
  v_cmp_lt_f32 vcc, s81, v5
  v_mfma_f32_16x16x32_bf16 a[60:63], a[188:191], v[164:167], a[60:63]
  v_exp_f32 v216, v128
  v_mfma_f32_16x16x32_bf16 a[120:123], a[188:191], v[176:179], a[120:123]
  s_waitcnt lgkmcnt(4)
  v_cvt_pk_bf16_f32 v175, v214, v215
  v_mfma_f32_16x16x32_bf16 a[124:127], a[188:191], v[180:183], a[124:127]
  s_cbranch_vccnz fa_stub1
fa_back1:
  v_exp_f32 v217, v129
  v_add_f32 v228, v228, v224
  v_add_f32 v229, v229, v225
  v_add_f32 v230, v230, v226
  v_add_f32 v231, v231, v227
fa_DDe:
  v_mfma_f32_16x16x32_bf16 v[112:115], a[128:131], v[32:35], v[192:195]
  ds_read_b128 a[160:163], v3 offset:24576
  v_add_f32 v226, v216, v217
  v_mfma_f32_16x16x32_bf16 v[120:123], a[128:131], v[36:39], v[196:199]
  v_exp_f32 v218, v130
  v_mfma_f32_16x16x32_bf16 v[144:147], a[128:131], v[64:67], v[200:203]
  s_cmp_ge_u32 s26, s9
  v_exp_f32 v219, v131
  v_mfma_f32_16x16x32_bf16 v[152:155], a[128:131], v[68:71], v[204:207]
  s_cbranch_scc1 fa_hk5
fa_hb5:
  v_exp_f32 v220, v132
  v_mfma_f32_16x16x32_bf16 v[116:119], a[132:135], v[32:35], v[192:195]
  s_add_u32 s66, s66, 32768
  ds_read_b128 a[164:167], v3 offset:25600
  v_cvt_pk_bf16_f32 v176, v216, v217
  v_mfma_f32_16x16x32_bf16 v[124:127], a[132:135], v[36:39], v[196:199]
  s_mov_b32 m0, s25
  v_exp_f32 v221, v133
  v_mfma_f32_16x16x32_bf16 v[148:151], a[132:135], v[64:67], v[200:203]
  s_and_b32 s66, s66, 0x1ffff
  buffer_load_dwordx4 v2, s[48:51], s27 offen offset:0 sc1 lds
  v_add_f32 v226, v226, v218
  v_mfma_f32_16x16x32_bf16 v[156:159], a[132:135], v[68:71], v[204:207]
  v_exp_f32 v222, v134
  v_mfma_f32_16x16x32_bf16 v[112:115], a[136:139], v[40:43], v[112:115]
  ds_read_b128 a[168:171], v3 offset:26624
  v_add_f32 v226, v226, v219
  v_mfma_f32_16x16x32_bf16 v[120:123], a[136:139], v[44:47], v[120:123]
  v_exp_f32 v223, v135
  v_mfma_f32_16x16x32_bf16 v[144:147], a[136:139], v[72:75], v[144:147]
  v_cvt_pk_bf16_f32 v177, v218, v219
  v_add_f32 v226, v226, v220
  v_mfma_f32_16x16x32_bf16 v[152:155], a[136:139], v[76:79], v[152:155]
  v_exp_f32 v216, v136
  v_mfma_f32_16x16x32_bf16 v[116:119], a[140:143], v[40:43], v[116:119]
  ds_read_b128 a[172:175], v3 offset:27648
  v_add_f32 v226, v226, v221
  v_mfma_f32_16x16x32_bf16 v[124:127], a[140:143], v[44:47], v[124:127]
  v_exp_f32 v217, v137
  v_mfma_f32_16x16x32_bf16 v[148:151], a[140:143], v[72:75], v[148:151]
  v_cvt_pk_bf16_f32 v178, v220, v221
  v_add_f32 v226, v226, v222
  v_mfma_f32_16x16x32_bf16 v[156:159], a[140:143], v[76:79], v[156:159]
  s_waitcnt lgkmcnt(4)
  v_exp_f32 v218, v138
  v_mfma_f32_16x16x32_bf16 v[112:115], a[144:147], v[48:51], v[112:115]
  ds_read_b128 a[176:179], v3 offset:28672
  v_add_f32 v226, v226, v223
  v_mfma_f32_16x16x32_bf16 v[120:123], a[144:147], v[52:55], v[120:123]
  v_exp_f32 v219, v139
  v_mfma_f32_16x16x32_bf16 v[144:147], a[144:147], v[80:83], v[144:147]
  v_cvt_pk_bf16_f32 v179, v222, v223
  v_add_f32 v227, v216, v217
  v_mfma_f32_16x16x32_bf16 v[152:155], a[144:147], v[84:87], v[152:155]
  v_exp_f32 v220, v140
  v_mfma_f32_16x16x32_bf16 v[116:119], a[148:151], v[48:51], v[116:119]
  ds_read_b128 a[180:183], v3 offset:29696
  v_cvt_pk_bf16_f32 v180, v216, v217
  v_mfma_f32_16x16x32_bf16 v[124:127], a[148:151], v[52:55], v[124:127]
  v_exp_f32 v221, v141
  v_mfma_f32_16x16x32_bf16 v[148:151], a[148:151], v[80:83], v[148:151]
  buffer_load_dwordx4 v2, s[48:51], s27 offen offset:1024 sc1 lds
  v_add_f32 v227, v227, v218
  v_mfma_f32_16x16x32_bf16 v[156:159], a[148:151], v[84:87], v[156:159]
  v_exp_f32 v222, v142
  v_mfma_f32_16x16x32_bf16 v[112:115], a[152:155], v[56:59], v[112:115]
  ds_read_b128 a[184:187], v3 offset:30720
  v_add_f32 v227, v227, v219
  v_mfma_f32_16x16x32_bf16 v[120:123], a[152:155], v[60:63], v[120:123]
  v_exp_f32 v223, v143
  v_mfma_f32_16x16x32_bf16 v[144:147], a[152:155], v[88:91], v[144:147]
  v_cvt_pk_bf16_f32 v181, v218, v219
  v_add_f32 v227, v227, v220
  v_mfma_f32_16x16x32_bf16 v[152:155], a[152:155], v[92:95], v[152:155]
  v_exp_f32 v208, v96
  v_mfma_f32_16x16x32_bf16 v[116:119], a[156:159], v[56:59], v[116:119]
  ds_read_b128 a[188:191], v3 offset:31744
  v_add_f32 v227, v227, v221
  v_mfma_f32_16x16x32_bf16 v[124:127], a[156:159], v[60:63], v[124:127]
  v_exp_f32 v209, v97
  v_mfma_f32_16x16x32_bf16 v[148:151], a[156:159], v[88:91], v[148:151]
  v_cvt_pk_bf16_f32 v182, v220, v221
  v_add_f32 v227, v227, v222
  v_add_f32 v227, v227, v223
  v_mfma_f32_16x16x32_bf16 v[156:159], a[156:159], v[92:95], v[156:159]
  s_waitcnt lgkmcnt(4)
  v_exp_f32 v210, v98
  v_mfma_f32_16x16x32_bf16 a[0:3], a[160:163], v[168:171], a[0:3]
  ds_read_b128 a[128:131], v3 offset:8192
  v_cvt_pk_bf16_f32 v183, v222, v223
  v_mfma_f32_16x16x32_bf16 a[4:7], a[160:163], v[172:175], a[4:7]
  v_exp_f32 v211, v99
  v_mfma_f32_16x16x32_bf16 a[64:67], a[160:163], v[184:187], a[64:67]
  v_exp_f32 v212, v100
  v_mfma_f32_16x16x32_bf16 a[68:71], a[160:163], v[188:191], a[68:71]
  v_add_f32 v224, v208, v209
  v_cvt_pk_bf16_f32 v160, v208, v209
  v_mfma_f32_16x16x32_bf16 a[8:11], a[164:167], v[168:171], a[8:11]
  ds_read_b128 a[132:135], v3 offset:9216
  v_add_f32 v224, v224, v210
  v_mfma_f32_16x16x32_bf16 a[12:15], a[164:167], v[172:175], a[12:15]
  v_exp_f32 v213, v101
  v_mfma_f32_16x16x32_bf16 a[72:75], a[164:167], v[184:187], a[72:75]
  buffer_load_dwordx4 v2, s[48:51], s27 offen offset:2048 sc1 lds
  v_add_f32 v224, v224, v211
  v_mfma_f32_16x16x32_bf16 a[76:79], a[164:167], v[188:191], a[76:79]
  v_exp_f32 v214, v102
  v_mfma_f32_16x16x32_bf16 a[16:19], a[168:171], v[168:171], a[16:19]
  ds_read_b128 a[136:139], v3 offset:10240
  v_cvt_pk_bf16_f32 v161, v210, v211
  v_mfma_f32_16x16x32_bf16 a[20:23], a[168:171], v[172:175], a[20:23]
  v_exp_f32 v215, v103
  v_mfma_f32_16x16x32_bf16 a[80:83], a[168:171], v[184:187], a[80:83]
  v_add_f32 v224, v224, v212
  v_add_f32 v224, v224, v213
  v_mfma_f32_16x16x32_bf16 a[84:87], a[168:171], v[188:191], a[84:87]
  v_exp_f32 v208, v104
  v_mfma_f32_16x16x32_bf16 a[24:27], a[172:175], v[168:171], a[24:27]
  ds_read_b128 a[140:143], v3 offset:11264
  v_cvt_pk_bf16_f32 v162, v212, v213
  v_mfma_f32_16x16x32_bf16 a[28:31], a[172:175], v[172:175], a[28:31]
  v_exp_f32 v209, v105
  v_mfma_f32_16x16x32_bf16 a[88:91], a[172:175], v[184:187], a[88:91]
  v_exp_f32 v210, v106
  v_mfma_f32_16x16x32_bf16 a[92:95], a[172:175], v[188:191], a[92:95]
  s_waitcnt lgkmcnt(4)
  v_add_f32 v224, v224, v214
  v_add_f32 v224, v224, v215
  v_mfma_f32_16x16x32_bf16 a[32:35], a[176:179], v[168:171], a[32:35]
  ds_read_b128 a[144:147], v3 offset:12288
  v_cvt_pk_bf16_f32 v163, v214, v215
  v_mfma_f32_16x16x32_bf16 a[36:39], a[176:179], v[172:175], a[36:39]
  v_exp_f32 v211, v107
  v_mfma_f32_16x16x32_bf16 a[96:99], a[176:179], v[184:187], a[96:99]
  v_add_f32 v225, v208, v209
  v_cvt_pk_bf16_f32 v164, v208, v209
  v_mfma_f32_16x16x32_bf16 a[100:103], a[176:179], v[188:191], a[100:103]
  v_exp_f32 v212, v108
  v_mfma_f32_16x16x32_bf16 a[40:43], a[180:183], v[168:171], a[40:43]
  ds_read_b128 a[148:151], v3 offset:13312
  v_add_f32 v225, v225, v210
  v_mfma_f32_16x16x32_bf16 a[44:47], a[180:183], v[172:175], a[44:47]
  v_exp_f32 v213, v109
  v_mfma_f32_16x16x32_bf16 a[104:107], a[180:183], v[184:187], a[104:107]
  buffer_load_dwordx4 v2, s[48:51], s27 offen offset:3072 sc1 lds
  v_add_f32 v225, v225, v211
  v_mfma_f32_16x16x32_bf16 a[108:111], a[180:183], v[188:191], a[108:111]
  s_add_u32 s27, s27, 16384
  v_exp_f32 v214, v110
  v_mfma_f32_16x16x32_bf16 a[48:51], a[184:187], v[168:171], a[48:51]
  s_add_u32 s25, s25, 32768
  ds_read_b128 a[152:155], v3 offset:14336
  v_cvt_pk_bf16_f32 v165, v210, v211
  v_mfma_f32_16x16x32_bf16 a[52:55], a[184:187], v[172:175], a[52:55]
  s_and_b32 s25, s25, 0x1ffff
  v_exp_f32 v215, v111
  v_mfma_f32_16x16x32_bf16 a[112:115], a[184:187], v[184:187], a[112:115]
  v_max3_f32 v5, v226, v227, v224
  v_add_f32 v225, v225, v212
  v_mfma_f32_16x16x32_bf16 a[116:119], a[184:187], v[188:191], a[116:119]
  v_add_f32 v225, v225, v213
  v_cvt_pk_bf16_f32 v166, v212, v213
  v_add_f32 v225, v225, v214
  v_mfma_f32_16x16x32_bf16 a[56:59], a[188:191], v[168:171], a[56:59]
  s_sub_u32 s28, s28, 1
  ds_read_b128 a[156:159], v3 offset:15360
  v_add_f32 v225, v225, v215
  v_max_f32 v5, v5, v225
  v_cmp_lt_f32 vcc, s81, v5
  v_mfma_f32_16x16x32_bf16 a[60:63], a[188:191], v[172:175], a[60:63]
  s_cmp_gt_u32 s28, s8
  v_exp_f32 v216, v144
  v_mfma_f32_16x16x32_bf16 a[120:123], a[188:191], v[184:187], a[120:123]
  s_waitcnt lgkmcnt(4)
  v_cvt_pk_bf16_f32 v167, v214, v215
  v_add_u32 v3, s66, v2
  v_mfma_f32_16x16x32_bf16 a[124:127], a[188:191], v[188:191], a[124:127]
  s_cbranch_vccnz fa_stub2
fa_back2:
  v_exp_f32 v217, v145
  v_add_f32 v228, v228, v224
  v_add_f32 v229, v229, v225
  v_add_f32 v230, v230, v226
  v_add_f32 v231, v231, v227
  s_cbranch_scc1 fa_DD
  s_cmp_lg_u32 s8, 0
  s_cbranch_scc1 fa_DDF
fa_Aexit:
  s_bitcmp1_b32 s20, 0
  s_cbranch_scc1 fa_Aodd
  v_mfma_f32_16x16x32_bf16 v[96:99], a[128:131], v[32:35], v[192:195]
  s_waitcnt vmcnt(12)
  v_exp_f32 v218, v146
  v_mfma_f32_16x16x32_bf16 v[104:107], a[128:131], v[36:39], v[196:199]
  s_barrier
  v_exp_f32 v219, v147
  v_mfma_f32_16x16x32_bf16 v[128:131], a[128:131], v[64:67], v[200:203]
  ds_read_b128 a[160:163], v3 offset:16384
  v_add_f32 v226, v216, v217
  v_mfma_f32_16x16x32_bf16 v[136:139], a[128:131], v[68:71], v[204:207]
  v_exp_f32 v220, v148
  v_mfma_f32_16x16x32_bf16 v[100:103], a[132:135], v[32:35], v[192:195]
  ds_read_b128 a[164:167], v3 offset:17408
  v_cvt_pk_bf16_f32 v184, v216, v217
  v_mfma_f32_16x16x32_bf16 v[108:111], a[132:135], v[36:39], v[196:199]
  s_mov_b32 m0, s24
  v_exp_f32 v221, v149
  v_mfma_f32_16x16x32_bf16 v[132:135], a[132:135], v[64:67], v[200:203]
  buffer_load_dwordx4 v2, s[44:47], s26 offen offset:0 sc1 lds
  v_add_f32 v226, v226, v218
  v_mfma_f32_16x16x32_bf16 v[140:143], a[132:135], v[68:71], v[204:207]
  v_exp_f32 v222, v150
  v_mfma_f32_16x16x32_bf16 v[96:99], a[136:139], v[40:43], v[96:99]
  ds_read_b128 a[168:171], v3 offset:18432
  v_add_f32 v226, v226, v219
  v_mfma_f32_16x16x32_bf16 v[104:107], a[136:139], v[44:47], v[104:107]
  v_exp_f32 v223, v151
  v_mfma_f32_16x16x32_bf16 v[128:131], a[136:139], v[72:75], v[128:131]
  v_cvt_pk_bf16_f32 v185, v218, v219
  v_add_f32 v226, v226, v220
  v_mfma_f32_16x16x32_bf16 v[136:139], a[136:139], v[76:79], v[136:139]
  v_exp_f32 v216, v152
  v_mfma_f32_16x16x32_bf16 v[100:103], a[140:143], v[40:43], v[100:103]
  ds_read_b128 a[172:175], v3 offset:19456
  v_add_f32 v226, v226, v221
  v_mfma_f32_16x16x32_bf16 v[108:111], a[140:143], v[44:47], v[108:111]
  v_exp_f32 v217, v153
  v_mfma_f32_16x16x32_bf16 v[132:135], a[140:143], v[72:75], v[132:135]
  v_cvt_pk_bf16_f32 v186, v220, v221
  v_add_f32 v226, v226, v222
  v_mfma_f32_16x16x32_bf16 v[140:143], a[140:143], v[76:79], v[140:143]
  s_waitcnt lgkmcnt(4)
  v_exp_f32 v218, v154
  v_mfma_f32_16x16x32_bf16 v[96:99], a[144:147], v[48:51], v[96:99]
  ds_read_b128 a[176:179], v3 offset:20480
  v_add_f32 v226, v226, v223
  v_mfma_f32_16x16x32_bf16 v[104:107], a[144:147], v[52:55], v[104:107]
  v_exp_f32 v219, v155
  v_mfma_f32_16x16x32_bf16 v[128:131], a[144:147], v[80:83], v[128:131]
  v_cvt_pk_bf16_f32 v187, v222, v223
  v_add_f32 v227, v216, v217
  v_mfma_f32_16x16x32_bf16 v[136:139], a[144:147], v[84:87], v[136:139]
  v_exp_f32 v220, v156
  v_mfma_f32_16x16x32_bf16 v[100:103], a[148:151], v[48:51], v[100:103]
  ds_read_b128 a[180:183], v3 offset:21504
  v_cvt_pk_bf16_f32 v188, v216, v217
  v_mfma_f32_16x16x32_bf16 v[108:111], a[148:151], v[52:55], v[108:111]
  v_exp_f32 v221, v157
  v_mfma_f32_16x16x32_bf16 v[132:135], a[148:151], v[80:83], v[132:135]
  buffer_load_dwordx4 v2, s[44:47], s26 offen offset:1024 sc1 lds
  v_add_f32 v227, v227, v218
  v_mfma_f32_16x16x32_bf16 v[140:143], a[148:151], v[84:87], v[140:143]
  v_exp_f32 v222, v158
  v_mfma_f32_16x16x32_bf16 v[96:99], a[152:155], v[56:59], v[96:99]
  ds_read_b128 a[184:187], v3 offset:22528
  v_add_f32 v227, v227, v219
  v_mfma_f32_16x16x32_bf16 v[104:107], a[152:155], v[60:63], v[104:107]
  v_exp_f32 v223, v159
  v_mfma_f32_16x16x32_bf16 v[128:131], a[152:155], v[88:91], v[128:131]
  v_cvt_pk_bf16_f32 v189, v218, v219
  v_add_f32 v227, v227, v220
  v_mfma_f32_16x16x32_bf16 v[136:139], a[152:155], v[92:95], v[136:139]
  v_exp_f32 v208, v112
  v_mfma_f32_16x16x32_bf16 v[100:103], a[156:159], v[56:59], v[100:103]
  ds_read_b128 a[188:191], v3 offset:23552
  v_add_f32 v227, v227, v221
  v_mfma_f32_16x16x32_bf16 v[108:111], a[156:159], v[60:63], v[108:111]
  v_exp_f32 v209, v113
  v_mfma_f32_16x16x32_bf16 v[132:135], a[156:159], v[88:91], v[132:135]
  v_cvt_pk_bf16_f32 v190, v220, v221
  v_add_f32 v227, v227, v222
  v_add_f32 v227, v227, v223
  v_mfma_f32_16x16x32_bf16 v[140:143], a[156:159], v[92:95], v[140:143]
  s_waitcnt lgkmcnt(4)
  v_exp_f32 v210, v114
  v_mfma_f32_16x16x32_bf16 a[0:3], a[160:163], v[160:163], a[0:3]
  ds_read_b128 a[128:131], v3 offset:0
  v_cvt_pk_bf16_f32 v191, v222, v223
  v_mfma_f32_16x16x32_bf16 a[4:7], a[160:163], v[164:167], a[4:7]
  v_exp_f32 v211, v115
  v_mfma_f32_16x16x32_bf16 a[64:67], a[160:163], v[176:179], a[64:67]
  v_exp_f32 v212, v116
  v_mfma_f32_16x16x32_bf16 a[68:71], a[160:163], v[180:183], a[68:71]
  v_add_f32 v224, v208, v209
  v_cvt_pk_bf16_f32 v168, v208, v209
  v_mfma_f32_16x16x32_bf16 a[8:11], a[164:167], v[160:163], a[8:11]
  ds_read_b128 a[132:135], v3 offset:1024
  v_add_f32 v224, v224, v210
  v_mfma_f32_16x16x32_bf16 a[12:15], a[164:167], v[164:167], a[12:15]
  v_exp_f32 v213, v117
  v_mfma_f32_16x16x32_bf16 a[72:75], a[164:167], v[176:179], a[72:75]
  buffer_load_dwordx4 v2, s[44:47], s26 offen offset:2048 sc1 lds
  v_add_f32 v224, v224, v211
  v_mfma_f32_16x16x32_bf16 a[76:79], a[164:167], v[180:183], a[76:79]
  v_exp_f32 v214, v118
  v_mfma_f32_16x16x32_bf16 a[16:19], a[168:171], v[160:163], a[16:19]
  ds_read_b128 a[136:139], v3 offset:2048
  v_cvt_pk_bf16_f32 v169, v210, v211
  v_mfma_f32_16x16x32_bf16 a[20:23], a[168:171], v[164:167], a[20:23]
  v_exp_f32 v215, v119
  v_mfma_f32_16x16x32_bf16 a[80:83], a[168:171], v[176:179], a[80:83]
  v_add_f32 v224, v224, v212
  v_add_f32 v224, v224, v213
  v_mfma_f32_16x16x32_bf16 a[84:87], a[168:171], v[180:183], a[84:87]
  v_exp_f32 v208, v120
  v_mfma_f32_16x16x32_bf16 a[24:27], a[172:175], v[160:163], a[24:27]
  ds_read_b128 a[140:143], v3 offset:3072
  v_cvt_pk_bf16_f32 v170, v212, v213
  v_mfma_f32_16x16x32_bf16 a[28:31], a[172:175], v[164:167], a[28:31]
  v_exp_f32 v209, v121
  v_mfma_f32_16x16x32_bf16 a[88:91], a[172:175], v[176:179], a[88:91]
  v_exp_f32 v210, v122
  v_mfma_f32_16x16x32_bf16 a[92:95], a[172:175], v[180:183], a[92:95]
  s_waitcnt lgkmcnt(4)
  v_add_f32 v224, v224, v214
  v_add_f32 v224, v224, v215
  v_mfma_f32_16x16x32_bf16 a[32:35], a[176:179], v[160:163], a[32:35]
  ds_read_b128 a[144:147], v3 offset:4096
  v_cvt_pk_bf16_f32 v171, v214, v215
  v_mfma_f32_16x16x32_bf16 a[36:39], a[176:179], v[164:167], a[36:39]
  v_exp_f32 v211, v123
  v_mfma_f32_16x16x32_bf16 a[96:99], a[176:179], v[176:179], a[96:99]
  v_add_f32 v225, v208, v209
  v_cvt_pk_bf16_f32 v172, v208, v209
  v_mfma_f32_16x16x32_bf16 a[100:103], a[176:179], v[180:183], a[100:103]
  v_exp_f32 v212, v124
  v_mfma_f32_16x16x32_bf16 a[40:43], a[180:183], v[160:163], a[40:43]
  ds_read_b128 a[148:151], v3 offset:5120
  v_add_f32 v225, v225, v210
  v_mfma_f32_16x16x32_bf16 a[44:47], a[180:183], v[164:167], a[44:47]
  v_exp_f32 v213, v125
  v_mfma_f32_16x16x32_bf16 a[104:107], a[180:183], v[176:179], a[104:107]
  buffer_load_dwordx4 v2, s[44:47], s26 offen offset:3072 sc1 lds
  v_add_f32 v225, v225, v211
  v_mfma_f32_16x16x32_bf16 a[108:111], a[180:183], v[180:183], a[108:111]
  s_add_u32 s26, s26, 16384
  v_exp_f32 v214, v126
  v_mfma_f32_16x16x32_bf16 a[48:51], a[184:187], v[160:163], a[48:51]
  s_add_u32 s24, s24, 32768
  ds_read_b128 a[152:155], v3 offset:6144
  v_cvt_pk_bf16_f32 v173, v210, v211
  v_mfma_f32_16x16x32_bf16 a[52:55], a[184:187], v[164:167], a[52:55]
  s_and_b32 s24, s24, 0x1ffff
  v_exp_f32 v215, v127
  v_mfma_f32_16x16x32_bf16 a[112:115], a[184:187], v[176:179], a[112:115]
  v_max3_f32 v5, v226, v227, v224
  v_add_f32 v225, v225, v212
  v_mfma_f32_16x16x32_bf16 a[116:119], a[184:187], v[180:183], a[116:119]
  v_add_f32 v225, v225, v213
  v_cvt_pk_bf16_f32 v174, v212, v213
  v_add_f32 v225, v225, v214
  v_mfma_f32_16x16x32_bf16 a[56:59], a[188:191], v[160:163], a[56:59]
  ds_read_b128 a[156:159], v3 offset:7168
  v_add_f32 v225, v225, v215
  v_max_f32 v5, v5, v225
  v_cmp_lt_f32 vcc, s81, v5
  v_mfma_f32_16x16x32_bf16 a[60:63], a[188:191], v[164:167], a[60:63]
  v_exp_f32 v216, v128
  v_mfma_f32_16x16x32_bf16 a[120:123], a[188:191], v[176:179], a[120:123]
  s_waitcnt lgkmcnt(4)
  v_cvt_pk_bf16_f32 v175, v214, v215
  v_mfma_f32_16x16x32_bf16 a[124:127], a[188:191], v[180:183], a[124:127]
  s_cbranch_vccnz fa_stub4
fa_back4:
  v_exp_f32 v217, v129
  v_add_f32 v228, v228, v224
  v_add_f32 v229, v229, v225
  v_add_f32 v230, v230, v226
  v_add_f32 v231, v231, v227
  v_mfma_f32_16x16x32_bf16 v[144:147], a[128:131], v[64:67], v[200:203]
  ds_read_b128 a[160:163], v3 offset:24576
  v_exp_f32 v218, v130
  v_mfma_f32_16x16x32_bf16 v[152:155], a[128:131], v[68:71], v[204:207]
  v_exp_f32 v219, v131
  v_add_f32 v226, v216, v217
  v_mfma_f32_16x16x32_bf16 v[148:151], a[132:135], v[64:67], v[200:203]
  s_add_u32 s66, s66, 32768
  ds_read_b128 a[164:167], v3 offset:25600
  v_exp_f32 v220, v132
  v_mfma_f32_16x16x32_bf16 v[156:159], a[132:135], v[68:71], v[204:207]
  s_and_b32 s66, s66, 0x1ffff
  v_exp_f32 v221, v133
  v_cvt_pk_bf16_f32 v176, v216, v217
  v_mfma_f32_16x16x32_bf16 v[144:147], a[136:139], v[72:75], v[144:147]
  ds_read_b128 a[168:171], v3 offset:26624
  v_add_f32 v226, v226, v218
  v_add_f32 v226, v226, v219
  v_mfma_f32_16x16x32_bf16 v[152:155], a[136:139], v[76:79], v[152:155]
  s_mov_b32 m0, s25
  v_exp_f32 v222, v134
  v_cvt_pk_bf16_f32 v177, v218, v219
  v_mfma_f32_16x16x32_bf16 v[148:151], a[140:143], v[72:75], v[148:151]
  ds_read_b128 a[172:175], v3 offset:27648
  buffer_load_dwordx4 v2, s[48:51], s27 offen offset:0 sc1 lds
  v_add_f32 v226, v226, v220
  v_add_f32 v226, v226, v221
  v_mfma_f32_16x16x32_bf16 v[156:159], a[140:143], v[76:79], v[156:159]
  s_waitcnt lgkmcnt(4)
  v_exp_f32 v223, v135
  v_cvt_pk_bf16_f32 v178, v220, v221
  v_mfma_f32_16x16x32_bf16 v[144:147], a[144:147], v[80:83], v[144:147]
  ds_read_b128 a[176:179], v3 offset:28672
  v_cndmask_b32 v96, v4, v96, s[68:69]
  v_cndmask_b32 v97, v4, v97, s[70:71]
  v_mfma_f32_16x16x32_bf16 v[152:155], a[144:147], v[84:87], v[152:155]
  v_exp_f32 v216, v136
  v_cndmask_b32 v98, v4, v98, s[72:73]
  v_mfma_f32_16x16x32_bf16 v[148:151], a[148:151], v[80:83], v[148:151]
  ds_read_b128 a[180:183], v3 offset:29696
  v_cndmask_b32 v99, v4, v99, s[74:75]
  v_mov_b32 v100, v4
  v_mfma_f32_16x16x32_bf16 v[156:159], a[148:151], v[84:87], v[156:159]
  v_exp_f32 v217, v137
  v_mov_b32 v101, v4
  v_mfma_f32_16x16x32_bf16 v[144:147], a[152:155], v[88:91], v[144:147]
  ds_read_b128 a[184:187], v3 offset:30720
  v_mov_b32 v102, v4
  v_mov_b32 v103, v4
  v_mfma_f32_16x16x32_bf16 v[152:155], a[152:155], v[92:95], v[152:155]
  v_exp_f32 v218, v138
  v_cndmask_b32 v108, v4, v108, s[68:69]
  v_mfma_f32_16x16x32_bf16 v[148:151], a[156:159], v[88:91], v[148:151]
  ds_read_b128 a[188:191], v3 offset:31744
  v_cndmask_b32 v109, v4, v109, s[70:71]
  v_cndmask_b32 v110, v4, v110, s[72:73]
  v_mfma_f32_16x16x32_bf16 v[156:159], a[156:159], v[92:95], v[156:159]
  s_waitcnt lgkmcnt(4)
  v_exp_f32 v219, v139
  v_cndmask_b32 v111, v4, v111, s[74:75]
  v_mfma_f32_16x16x32_bf16 a[0:3], a[160:163], v[168:171], a[0:3]
  ds_read_b128 a[128:131], v3 offset:8192
  v_add_f32 v226, v226, v222
  v_add_f32 v226, v226, v223
  v_mfma_f32_16x16x32_bf16 a[4:7], a[160:163], v[172:175], a[4:7]
  v_exp_f32 v220, v140
  v_cvt_pk_bf16_f32 v179, v222, v223
  v_mfma_f32_16x16x32_bf16 a[64:67], a[160:163], v[184:187], a[64:67]
  buffer_load_dwordx4 v2, s[48:51], s27 offen offset:1024 sc1 lds
  v_add_f32 v227, v216, v217
  v_cvt_pk_bf16_f32 v180, v216, v217
  v_mfma_f32_16x16x32_bf16 a[68:71], a[160:163], v[188:191], a[68:71]
  v_exp_f32 v221, v141
  v_add_f32 v227, v227, v218
  v_mfma_f32_16x16x32_bf16 a[8:11], a[164:167], v[168:171], a[8:11]
  ds_read_b128 a[132:135], v3 offset:9216
  v_exp_f32 v222, v142
  v_mfma_f32_16x16x32_bf16 a[12:15], a[164:167], v[172:175], a[12:15]
  v_exp_f32 v223, v143
  v_mfma_f32_16x16x32_bf16 a[72:75], a[164:167], v[184:187], a[72:75]
  v_exp_f32 v208, v96
  v_mfma_f32_16x16x32_bf16 a[76:79], a[164:167], v[188:191], a[76:79]
  v_exp_f32 v209, v97
  v_mfma_f32_16x16x32_bf16 a[16:19], a[168:171], v[168:171], a[16:19]
  ds_read_b128 a[136:139], v3 offset:10240
  v_add_f32 v227, v227, v219
  v_cvt_pk_bf16_f32 v181, v218, v219
  v_add_f32 v227, v227, v220
  v_add_f32 v227, v227, v221
  v_cvt_pk_bf16_f32 v182, v220, v221
  v_mfma_f32_16x16x32_bf16 a[20:23], a[168:171], v[172:175], a[20:23]
  v_exp_f32 v210, v98
  v_mfma_f32_16x16x32_bf16 a[80:83], a[168:171], v[184:187], a[80:83]
  v_exp_f32 v211, v99
  v_mfma_f32_16x16x32_bf16 a[84:87], a[168:171], v[188:191], a[84:87]
  v_exp_f32 v212, v100
  v_mfma_f32_16x16x32_bf16 a[24:27], a[172:175], v[168:171], a[24:27]
  ds_read_b128 a[140:143], v3 offset:11264
  v_add_f32 v227, v227, v222
  v_add_f32 v227, v227, v223
  v_cvt_pk_bf16_f32 v183, v222, v223
  v_add_f32 v224, v208, v209
  v_cvt_pk_bf16_f32 v160, v208, v209
  v_mfma_f32_16x16x32_bf16 a[28:31], a[172:175], v[172:175], a[28:31]
  v_exp_f32 v213, v101
  v_mfma_f32_16x16x32_bf16 a[88:91], a[172:175], v[184:187], a[88:91]
  buffer_load_dwordx4 v2, s[48:51], s27 offen offset:2048 sc1 lds
  v_add_f32 v224, v224, v210
  v_add_f32 v224, v224, v211
  v_cvt_pk_bf16_f32 v161, v210, v211
  v_mfma_f32_16x16x32_bf16 a[92:95], a[172:175], v[188:191], a[92:95]
  s_waitcnt lgkmcnt(4)
  v_exp_f32 v214, v102
  v_mfma_f32_16x16x32_bf16 a[32:35], a[176:179], v[168:171], a[32:35]
  ds_read_b128 a[144:147], v3 offset:12288
  v_exp_f32 v215, v103
  v_mfma_f32_16x16x32_bf16 a[36:39], a[176:179], v[172:175], a[36:39]
  v_exp_f32 v208, v104
  v_mfma_f32_16x16x32_bf16 a[96:99], a[176:179], v[184:187], a[96:99]
  v_exp_f32 v209, v105
  v_mfma_f32_16x16x32_bf16 a[100:103], a[176:179], v[188:191], a[100:103]
  v_exp_f32 v210, v106
  v_mfma_f32_16x16x32_bf16 a[40:43], a[180:183], v[168:171], a[40:43]
  ds_read_b128 a[148:151], v3 offset:13312
  v_add_f32 v224, v224, v212
  v_add_f32 v224, v224, v213
  v_cvt_pk_bf16_f32 v162, v212, v213
  v_add_f32 v224, v224, v214
  v_add_f32 v224, v224, v215
  v_cvt_pk_bf16_f32 v163, v214, v215
  v_mfma_f32_16x16x32_bf16 a[44:47], a[180:183], v[172:175], a[44:47]
  v_exp_f32 v211, v107
  v_mfma_f32_16x16x32_bf16 a[104:107], a[180:183], v[184:187], a[104:107]
  v_exp_f32 v212, v108
  v_mfma_f32_16x16x32_bf16 a[108:111], a[180:183], v[188:191], a[108:111]
  v_exp_f32 v213, v109
  v_mfma_f32_16x16x32_bf16 a[48:51], a[184:187], v[168:171], a[48:51]
  ds_read_b128 a[152:155], v3 offset:14336
  v_add_f32 v225, v208, v209
  v_cvt_pk_bf16_f32 v164, v208, v209
  v_add_f32 v225, v225, v210
  v_add_f32 v225, v225, v211
  v_cvt_pk_bf16_f32 v165, v210, v211
  v_mfma_f32_16x16x32_bf16 a[52:55], a[184:187], v[172:175], a[52:55]
  v_exp_f32 v214, v110
  v_mfma_f32_16x16x32_bf16 a[112:115], a[184:187], v[184:187], a[112:115]
  buffer_load_dwordx4 v2, s[48:51], s27 offen offset:3072 sc1 lds
  v_max3_f32 v5, v226, v227, v224
  v_add_f32 v225, v225, v212
  v_add_f32 v225, v225, v213
  v_mfma_f32_16x16x32_bf16 a[116:119], a[184:187], v[188:191], a[116:119]
  s_add_u32 s27, s27, 16384
  v_exp_f32 v215, v111
  v_mfma_f32_16x16x32_bf16 a[56:59], a[188:191], v[168:171], a[56:59]
  s_add_u32 s25, s25, 32768
  ds_read_b128 a[156:159], v3 offset:15360
  v_cvt_pk_bf16_f32 v166, v212, v213
  v_add_f32 v225, v225, v214
  v_add_f32 v225, v225, v215
  v_max_f32 v5, v5, v225
  v_cmp_lt_f32 vcc, s81, v5
  v_mfma_f32_16x16x32_bf16 a[60:63], a[188:191], v[172:175], a[60:63]
  s_and_b32 s25, s25, 0x1ffff
  v_exp_f32 v216, v144
  v_mfma_f32_16x16x32_bf16 a[120:123], a[188:191], v[184:187], a[120:123]
  s_waitcnt lgkmcnt(4)
  v_cvt_pk_bf16_f32 v167, v214, v215
  v_add_u32 v3, s66, v2
  v_mfma_f32_16x16x32_bf16 a[124:127], a[188:191], v[188:191], a[124:127]
  s_cbranch_vccnz fa_stub5
fa_back5:
  v_exp_f32 v217, v145
  v_add_f32 v228, v228, v224
  v_add_f32 v229, v229, v225
  v_add_f32 v230, v230, v226
  v_add_f32 v231, v231, v227
fa_AV:
  v_mfma_f32_16x16x32_bf16 v[128:131], a[128:131], v[64:67], v[200:203]
  s_waitcnt vmcnt(12)
  v_exp_f32 v218, v146
  v_mfma_f32_16x16x32_bf16 v[136:139], a[128:131], v[68:71], v[204:207]
  s_barrier
  v_exp_f32 v219, v147
  v_mfma_f32_16x16x32_bf16 v[132:135], a[132:135], v[64:67], v[200:203]
  ds_read_b128 a[160:163], v3 offset:16384
  ds_read_b128 a[164:167], v3 offset:17408
  v_add_f32 v226, v216, v217
  v_mfma_f32_16x16x32_bf16 v[140:143], a[132:135], v[68:71], v[204:207]
  v_exp_f32 v220, v148
  v_mfma_f32_16x16x32_bf16 v[128:131], a[136:139], v[72:75], v[128:131]
  ds_read_b128 a[168:171], v3 offset:18432
  v_cvt_pk_bf16_f32 v184, v216, v217
  v_mfma_f32_16x16x32_bf16 v[136:139], a[136:139], v[76:79], v[136:139]
  s_mov_b32 m0, s24
  v_exp_f32 v221, v149
  v_mfma_f32_16x16x32_bf16 v[132:135], a[140:143], v[72:75], v[132:135]
  ds_read_b128 a[172:175], v3 offset:19456
  buffer_load_dwordx4 v2, s[44:47], s26 offen offset:0 sc1 lds
  v_add_f32 v226, v226, v218
  v_mfma_f32_16x16x32_bf16 v[140:143], a[140:143], v[76:79], v[140:143]
  s_waitcnt lgkmcnt(4)
  v_exp_f32 v222, v150
  v_mfma_f32_16x16x32_bf16 v[128:131], a[144:147], v[80:83], v[128:131]
  ds_read_b128 a[176:179], v3 offset:20480
  v_add_f32 v226, v226, v219
  v_mfma_f32_16x16x32_bf16 v[136:139], a[144:147], v[84:87], v[136:139]
  v_exp_f32 v223, v151
  v_mfma_f32_16x16x32_bf16 v[132:135], a[148:151], v[80:83], v[132:135]
  ds_read_b128 a[180:183], v3 offset:21504
  v_cvt_pk_bf16_f32 v185, v218, v219
  v_mfma_f32_16x16x32_bf16 v[140:143], a[148:151], v[84:87], v[140:143]
  v_add_f32 v226, v226, v220
  v_add_f32 v226, v226, v221
  v_mfma_f32_16x16x32_bf16 v[128:131], a[152:155], v[88:91], v[128:131]
  ds_read_b128 a[184:187], v3 offset:22528
  v_cvt_pk_bf16_f32 v186, v220, v221
  v_mfma_f32_16x16x32_bf16 v[136:139], a[152:155], v[92:95], v[136:139]
  v_exp_f32 v216, v152
  v_mfma_f32_16x16x32_bf16 v[132:135], a[156:159], v[88:91], v[132:135]
  ds_read_b128 a[188:191], v3 offset:23552
  v_add_f32 v226, v226, v222
  v_mfma_f32_16x16x32_bf16 v[140:143], a[156:159], v[92:95], v[140:143]
  s_waitcnt lgkmcnt(4)
  v_exp_f32 v217, v153
  v_mfma_f32_16x16x32_bf16 a[0:3], a[160:163], v[160:163], a[0:3]
  ds_read_b128 a[128:131], v3 offset:0
  v_add_f32 v226, v226, v223
  v_mfma_f32_16x16x32_bf16 a[4:7], a[160:163], v[164:167], a[4:7]
  v_exp_f32 v218, v154
  v_mfma_f32_16x16x32_bf16 a[64:67], a[160:163], v[176:179], a[64:67]
  buffer_load_dwordx4 v2, s[44:47], s26 offen offset:1024 sc1 lds
  v_cvt_pk_bf16_f32 v187, v222, v223
  v_mfma_f32_16x16x32_bf16 a[68:71], a[160:163], v[180:183], a[68:71]
  v_exp_f32 v219, v155
  v_mfma_f32_16x16x32_bf16 a[8:11], a[164:167], v[160:163], a[8:11]
  ds_read_b128 a[132:135], v3 offset:1024
  v_add_f32 v227, v216, v217
  v_mfma_f32_16x16x32_bf16 a[12:15], a[164:167], v[164:167], a[12:15]
  v_exp_f32 v220, v156
  v_mfma_f32_16x16x32_bf16 a[72:75], a[164:167], v[176:179], a[72:75]
  v_exp_f32 v221, v157
  v_mfma_f32_16x16x32_bf16 a[76:79], a[164:167], v[180:183], a[76:79]
  v_cvt_pk_bf16_f32 v188, v216, v217
  v_add_f32 v227, v227, v218
  v_mfma_f32_16x16x32_bf16 a[16:19], a[168:171], v[160:163], a[16:19]
  ds_read_b128 a[136:139], v3 offset:2048
  v_add_f32 v227, v227, v219
  v_mfma_f32_16x16x32_bf16 a[20:23], a[168:171], v[164:167], a[20:23]
  v_exp_f32 v222, v158
  v_mfma_f32_16x16x32_bf16 a[80:83], a[168:171], v[176:179], a[80:83]
  v_exp_f32 v223, v159
  v_mfma_f32_16x16x32_bf16 a[84:87], a[168:171], v[180:183], a[84:87]
  v_cvt_pk_bf16_f32 v189, v218, v219
  v_add_f32 v227, v227, v220
  v_mfma_f32_16x16x32_bf16 a[24:27], a[172:175], v[160:163], a[24:27]
  ds_read_b128 a[140:143], v3 offset:3072
  v_add_f32 v227, v227, v221
  v_mfma_f32_16x16x32_bf16 a[28:31], a[172:175], v[164:167], a[28:31]
  v_cvt_pk_bf16_f32 v190, v220, v221
  v_add_f32 v227, v227, v222
  v_mfma_f32_16x16x32_bf16 a[88:91], a[172:175], v[176:179], a[88:91]
  buffer_load_dwordx4 v2, s[44:47], s26 offen offset:2048 sc1 lds
  v_add_f32 v227, v227, v223
  v_mfma_f32_16x16x32_bf16 a[92:95], a[172:175], v[180:183], a[92:95]
  s_waitcnt lgkmcnt(4)
  v_max_f32 v5, v226, v227
  v_cmp_lt_f32 vcc, s81, v5
  v_mfma_f32_16x16x32_bf16 a[32:35], a[176:179], v[160:163], a[32:35]
  ds_read_b128 a[144:147], v3 offset:4096
  v_mfma_f32_16x16x32_bf16 a[36:39], a[176:179], v[164:167], a[36:39]
  v_mfma_f32_16x16x32_bf16 a[96:99], a[176:179], v[176:179], a[96:99]
  v_mfma_f32_16x16x32_bf16 a[100:103], a[176:179], v[180:183], a[100:103]
  v_mfma_f32_16x16x32_bf16 a[40:43], a[180:183], v[160:163], a[40:43]
  ds_read_b128 a[148:151], v3 offset:5120
  v_mfma_f32_16x16x32_bf16 a[44:47], a[180:183], v[164:167], a[44:47]
  v_mfma_f32_16x16x32_bf16 a[104:107], a[180:183], v[176:179], a[104:107]
  v_mfma_f32_16x16x32_bf16 a[108:111], a[180:183], v[180:183], a[108:111]
  v_mfma_f32_16x16x32_bf16 a[48:51], a[184:187], v[160:163], a[48:51]
  ds_read_b128 a[152:155], v3 offset:6144
  v_mfma_f32_16x16x32_bf16 a[52:55], a[184:187], v[164:167], a[52:55]
  v_mfma_f32_16x16x32_bf16 a[112:115], a[184:187], v[176:179], a[112:115]
  buffer_load_dwordx4 v2, s[44:47], s26 offen offset:3072 sc1 lds
  v_mfma_f32_16x16x32_bf16 a[116:119], a[184:187], v[180:183], a[116:119]
  s_add_u32 s26, s26, 16384
  v_mfma_f32_16x16x32_bf16 a[56:59], a[188:191], v[160:163], a[56:59]
  s_add_u32 s24, s24, 32768
  ds_read_b128 a[156:159], v3 offset:7168
  v_mfma_f32_16x16x32_bf16 a[60:63], a[188:191], v[164:167], a[60:63]
  s_and_b32 s24, s24, 0x1ffff
  v_exp_f32 v216, v128
  v_mfma_f32_16x16x32_bf16 a[120:123], a[188:191], v[176:179], a[120:123]
  s_waitcnt lgkmcnt(4)
  v_cvt_pk_bf16_f32 v191, v222, v223
  v_mfma_f32_16x16x32_bf16 a[124:127], a[188:191], v[180:183], a[124:127]
  s_cbranch_vccnz fa_stub6
fa_back6:
  v_exp_f32 v217, v129
  v_add_f32 v230, v230, v226
  v_add_f32 v231, v231, v227
  v_mfma_f32_16x16x32_bf16 v[144:147], a[128:131], v[64:67], v[200:203]
  ds_read_b128 a[160:163], v3 offset:24576
  v_add_f32 v226, v216, v217
  v_mfma_f32_16x16x32_bf16 v[152:155], a[128:131], v[68:71], v[204:207]
  v_exp_f32 v218, v130
  v_mfma_f32_16x16x32_bf16 v[148:151], a[132:135], v[64:67], v[200:203]
  s_add_u32 s66, s66, 32768
  ds_read_b128 a[164:167], v3 offset:25600
  v_cvt_pk_bf16_f32 v176, v216, v217
  v_mfma_f32_16x16x32_bf16 v[156:159], a[132:135], v[68:71], v[204:207]
  s_mov_b32 m0, s25
  v_exp_f32 v219, v131
  v_mfma_f32_16x16x32_bf16 v[144:147], a[136:139], v[72:75], v[144:147]
  s_and_b32 s66, s66, 0x1ffff
  ds_read_b128 a[168:171], v3 offset:26624
  buffer_load_dwordx4 v2, s[48:51], s27 offen offset:0 sc1 lds
  v_add_f32 v226, v226, v218
  v_add_f32 v226, v226, v219
  v_mfma_f32_16x16x32_bf16 v[152:155], a[136:139], v[76:79], v[152:155]
  v_exp_f32 v220, v132
  v_mfma_f32_16x16x32_bf16 v[148:151], a[140:143], v[72:75], v[148:151]
  ds_read_b128 a[172:175], v3 offset:27648
  v_cvt_pk_bf16_f32 v177, v218, v219
  v_mfma_f32_16x16x32_bf16 v[156:159], a[140:143], v[76:79], v[156:159]
  s_waitcnt lgkmcnt(4)
  v_exp_f32 v221, v133
  v_mfma_f32_16x16x32_bf16 v[144:147], a[144:147], v[80:83], v[144:147]
  ds_read_b128 a[176:179], v3 offset:28672
  v_add_f32 v226, v226, v220
  v_mfma_f32_16x16x32_bf16 v[152:155], a[144:147], v[84:87], v[152:155]
  v_exp_f32 v222, v134
  v_mfma_f32_16x16x32_bf16 v[148:151], a[148:151], v[80:83], v[148:151]
  ds_read_b128 a[180:183], v3 offset:29696
  buffer_load_dwordx4 v2, s[48:51], s27 offen offset:1024 sc1 lds
  v_add_f32 v226, v226, v221
  v_cvt_pk_bf16_f32 v178, v220, v221
  v_mfma_f32_16x16x32_bf16 v[156:159], a[148:151], v[84:87], v[156:159]
  v_exp_f32 v223, v135
  v_mfma_f32_16x16x32_bf16 v[144:147], a[152:155], v[88:91], v[144:147]
  ds_read_b128 a[184:187], v3 offset:30720
  v_add_f32 v226, v226, v222
  v_mfma_f32_16x16x32_bf16 v[152:155], a[152:155], v[92:95], v[152:155]
  v_exp_f32 v216, v136
  v_mfma_f32_16x16x32_bf16 v[148:151], a[156:159], v[88:91], v[148:151]
  ds_read_b128 a[188:191], v3 offset:31744
  v_add_f32 v226, v226, v223
  v_exp_f32 v217, v137
  v_mfma_f32_16x16x32_bf16 v[156:159], a[156:159], v[92:95], v[156:159]
  s_waitcnt lgkmcnt(4)
  v_exp_f32 v218, v138
  v_mfma_f32_16x16x32_bf16 a[64:67], a[160:163], v[184:187], a[64:67]
  ds_read_b128 a[128:131], v3 offset:8192
  v_cvt_pk_bf16_f32 v179, v222, v223
  v_mfma_f32_16x16x32_bf16 a[68:71], a[160:163], v[188:191], a[68:71]
  v_exp_f32 v219, v139
  v_mfma_f32_16x16x32_bf16 a[72:75], a[164:167], v[184:187], a[72:75]
  ds_read_b128 a[132:135], v3 offset:9216
  buffer_load_dwordx4 v2, s[48:51], s27 offen offset:2048 sc1 lds
  v_add_f32 v227, v216, v217
  v_mfma_f32_16x16x32_bf16 a[76:79], a[164:167], v[188:191], a[76:79]
  v_exp_f32 v220, v140
  v_mfma_f32_16x16x32_bf16 a[80:83], a[168:171], v[184:187], a[80:83]
  ds_read_b128 a[136:139], v3 offset:10240
  v_cvt_pk_bf16_f32 v180, v216, v217
  v_mfma_f32_16x16x32_bf16 a[84:87], a[168:171], v[188:191], a[84:87]
  v_exp_f32 v221, v141
  v_mfma_f32_16x16x32_bf16 a[88:91], a[172:175], v[184:187], a[88:91]
  ds_read_b128 a[140:143], v3 offset:11264
  v_add_f32 v227, v227, v218
  v_mfma_f32_16x16x32_bf16 a[92:95], a[172:175], v[188:191], a[92:95]
  s_waitcnt lgkmcnt(4)
  v_exp_f32 v222, v142
  v_mfma_f32_16x16x32_bf16 a[96:99], a[176:179], v[184:187], a[96:99]
  ds_read_b128 a[144:147], v3 offset:12288
  buffer_load_dwordx4 v2, s[48:51], s27 offen offset:3072 sc1 lds
  v_add_f32 v227, v227, v219
  v_cvt_pk_bf16_f32 v181, v218, v219
  v_mfma_f32_16x16x32_bf16 a[100:103], a[176:179], v[188:191], a[100:103]
  s_add_u32 s27, s27, 16384
  v_exp_f32 v223, v143
  v_mfma_f32_16x16x32_bf16 a[104:107], a[180:183], v[184:187], a[104:107]
  s_add_u32 s25, s25, 32768
  ds_read_b128 a[148:151], v3 offset:13312
  v_add_f32 v227, v227, v220
  v_mfma_f32_16x16x32_bf16 a[108:111], a[180:183], v[188:191], a[108:111]
  s_and_b32 s25, s25, 0x1ffff
  v_add_f32 v227, v227, v221
  v_cvt_pk_bf16_f32 v182, v220, v221
  v_add_f32 v227, v227, v222
  v_mfma_f32_16x16x32_bf16 a[112:115], a[184:187], v[184:187], a[112:115]
  ds_read_b128 a[152:155], v3 offset:14336
  v_add_f32 v227, v227, v223
  v_max_f32 v5, v226, v227
  v_cmp_lt_f32 vcc, s81, v5
  v_mfma_f32_16x16x32_bf16 a[116:119], a[184:187], v[188:191], a[116:119]
  v_exp_f32 v216, v144
  v_mfma_f32_16x16x32_bf16 a[120:123], a[188:191], v[184:187], a[120:123]
  s_waitcnt lgkmcnt(3)
  ds_read_b128 a[156:159], v3 offset:15360
  v_cvt_pk_bf16_f32 v183, v222, v223
  v_add_u32 v3, s66, v2
  v_mfma_f32_16x16x32_bf16 a[124:127], a[188:191], v[188:191], a[124:127]
  s_cbranch_vccnz fa_stub7
fa_back7:
  v_exp_f32 v217, v145
  v_add_f32 v230, v230, v226
  v_add_f32 v231, v231, v227
  s_branch fa_SSpre
fa_Aodd:
  v_mfma_f32_16x16x32_bf16 v[128:131], a[128:131], v[64:67], v[200:203]
  s_waitcnt vmcnt(12)
  v_exp_f32 v218, v146
  v_add_f32 v226, v216, v217
  v_mfma_f32_16x16x32_bf16 v[136:139], a[128:131], v[68:71], v[204:207]
  s_barrier
  v_exp_f32 v219, v147
  v_cvt_pk_bf16_f32 v184, v216, v217
  v_mfma_f32_16x16x32_bf16 v[132:135], a[132:135], v[64:67], v[200:203]
  ds_read_b128 a[160:163], v3 offset:16384
  ds_read_b128 a[164:167], v3 offset:17408
  v_exp_f32 v220, v148
  v_mfma_f32_16x16x32_bf16 v[140:143], a[132:135], v[68:71], v[204:207]
  v_exp_f32 v221, v149
  v_add_f32 v226, v226, v218
  v_mfma_f32_16x16x32_bf16 v[128:131], a[136:139], v[72:75], v[128:131]
  ds_read_b128 a[168:171], v3 offset:18432
  v_add_f32 v226, v226, v219
  v_cvt_pk_bf16_f32 v185, v218, v219
  v_mfma_f32_16x16x32_bf16 v[136:139], a[136:139], v[76:79], v[136:139]
  s_mov_b32 m0, s24
  v_exp_f32 v222, v150
  v_add_f32 v226, v226, v220
  v_mfma_f32_16x16x32_bf16 v[132:135], a[140:143], v[72:75], v[132:135]
  ds_read_b128 a[172:175], v3 offset:19456
  buffer_load_dwordx4 v2, s[44:47], s26 offen offset:0 sc1 lds
  v_add_f32 v226, v226, v221
  v_cvt_pk_bf16_f32 v186, v220, v221
  v_mfma_f32_16x16x32_bf16 v[140:143], a[140:143], v[76:79], v[140:143]
  s_waitcnt lgkmcnt(4)
  v_exp_f32 v223, v151
  v_cndmask_b32 v112, v4, v112, s[68:69]
  v_mfma_f32_16x16x32_bf16 v[128:131], a[144:147], v[80:83], v[128:131]
  ds_read_b128 a[176:179], v3 offset:20480
  v_cndmask_b32 v113, v4, v113, s[70:71]
  v_cndmask_b32 v114, v4, v114, s[72:73]
  v_mfma_f32_16x16x32_bf16 v[136:139], a[144:147], v[84:87], v[136:139]
  v_exp_f32 v216, v152
  v_cndmask_b32 v115, v4, v115, s[74:75]
  v_mfma_f32_16x16x32_bf16 v[132:135], a[148:151], v[80:83], v[132:135]
  ds_read_b128 a[180:183], v3 offset:21504
  v_mov_b32 v116, v4
  v_mov_b32 v117, v4
  v_mfma_f32_16x16x32_bf16 v[140:143], a[148:151], v[84:87], v[140:143]
  v_exp_f32 v217, v153
  v_mov_b32 v118, v4
  v_mfma_f32_16x16x32_bf16 v[128:131], a[152:155], v[88:91], v[128:131]
  ds_read_b128 a[184:187], v3 offset:22528
  v_mov_b32 v119, v4
  v_cndmask_b32 v124, v4, v124, s[68:69]
  v_mfma_f32_16x16x32_bf16 v[136:139], a[152:155], v[92:95], v[136:139]
  v_exp_f32 v218, v154
  v_cndmask_b32 v125, v4, v125, s[70:71]
  v_mfma_f32_16x16x32_bf16 v[132:135], a[156:159], v[88:91], v[132:135]
  ds_read_b128 a[188:191], v3 offset:23552
  v_cndmask_b32 v126, v4, v126, s[72:73]
  v_cndmask_b32 v127, v4, v127, s[74:75]
  v_mfma_f32_16x16x32_bf16 v[140:143], a[156:159], v[92:95], v[140:143]
  s_waitcnt lgkmcnt(4)
  v_exp_f32 v219, v155
  v_add_f32 v226, v226, v222
  v_mfma_f32_16x16x32_bf16 a[0:3], a[160:163], v[160:163], a[0:3]
  ds_read_b128 a[128:131], v3 offset:0
  v_add_f32 v226, v226, v223
  v_cvt_pk_bf16_f32 v187, v222, v223
  v_mfma_f32_16x16x32_bf16 a[4:7], a[160:163], v[164:167], a[4:7]
  v_exp_f32 v220, v156
  v_add_f32 v227, v216, v217
  v_mfma_f32_16x16x32_bf16 a[64:67], a[160:163], v[176:179], a[64:67]
  buffer_load_dwordx4 v2, s[44:47], s26 offen offset:1024 sc1 lds
  v_exp_f32 v221, v157
  v_mfma_f32_16x16x32_bf16 a[68:71], a[160:163], v[180:183], a[68:71]
  v_exp_f32 v222, v158
  v_mfma_f32_16x16x32_bf16 a[8:11], a[164:167], v[160:163], a[8:11]
  ds_read_b128 a[132:135], v3 offset:1024
  v_cvt_pk_bf16_f32 v188, v216, v217
  v_add_f32 v227, v227, v218
  v_add_f32 v227, v227, v219
  v_mfma_f32_16x16x32_bf16 a[12:15], a[164:167], v[164:167], a[12:15]
  v_exp_f32 v223, v159
  v_mfma_f32_16x16x32_bf16 a[72:75], a[164:167], v[176:179], a[72:75]
  v_exp_f32 v208, v112
  v_mfma_f32_16x16x32_bf16 a[76:79], a[164:167], v[180:183], a[76:79]
  v_exp_f32 v209, v113
  v_mfma_f32_16x16x32_bf16 a[16:19], a[168:171], v[160:163], a[16:19]
  ds_read_b128 a[136:139], v3 offset:2048
  v_cvt_pk_bf16_f32 v189, v218, v219
  v_add_f32 v227, v227, v220
  v_add_f32 v227, v227, v221
  v_cvt_pk_bf16_f32 v190, v220, v221
  v_add_f32 v227, v227, v222
  v_mfma_f32_16x16x32_bf16 a[20:23], a[168:171], v[164:167], a[20:23]
  v_exp_f32 v210, v114
  v_mfma_f32_16x16x32_bf16 a[80:83], a[168:171], v[176:179], a[80:83]
  v_exp_f32 v211, v115
  v_mfma_f32_16x16x32_bf16 a[84:87], a[168:171], v[180:183], a[84:87]
  v_exp_f32 v212, v116
  v_mfma_f32_16x16x32_bf16 a[24:27], a[172:175], v[160:163], a[24:27]
  ds_read_b128 a[140:143], v3 offset:3072
  v_add_f32 v227, v227, v223
  v_cvt_pk_bf16_f32 v191, v222, v223
  v_add_f32 v224, v208, v209
  v_cvt_pk_bf16_f32 v168, v208, v209
  v_add_f32 v224, v224, v210
  v_mfma_f32_16x16x32_bf16 a[28:31], a[172:175], v[164:167], a[28:31]
  v_exp_f32 v213, v117
  v_mfma_f32_16x16x32_bf16 a[88:91], a[172:175], v[176:179], a[88:91]
  buffer_load_dwordx4 v2, s[44:47], s26 offen offset:2048 sc1 lds
  v_exp_f32 v214, v118
  v_mfma_f32_16x16x32_bf16 a[92:95], a[172:175], v[180:183], a[92:95]
  s_waitcnt lgkmcnt(4)
  v_exp_f32 v215, v119
  v_mfma_f32_16x16x32_bf16 a[32:35], a[176:179], v[160:163], a[32:35]
  ds_read_b128 a[144:147], v3 offset:4096
  v_add_f32 v224, v224, v211
  v_cvt_pk_bf16_f32 v169, v210, v211
  v_add_f32 v224, v224, v212
  v_add_f32 v224, v224, v213
  v_mfma_f32_16x16x32_bf16 a[36:39], a[176:179], v[164:167], a[36:39]
  v_exp_f32 v208, v120
  v_mfma_f32_16x16x32_bf16 a[96:99], a[176:179], v[176:179], a[96:99]
  v_exp_f32 v209, v121
  v_mfma_f32_16x16x32_bf16 a[100:103], a[176:179], v[180:183], a[100:103]
  v_exp_f32 v210, v122
  v_mfma_f32_16x16x32_bf16 a[40:43], a[180:183], v[160:163], a[40:43]
  ds_read_b128 a[148:151], v3 offset:5120
  v_cvt_pk_bf16_f32 v170, v212, v213
  v_add_f32 v224, v224, v214
  v_add_f32 v224, v224, v215
  v_cvt_pk_bf16_f32 v171, v214, v215
  v_add_f32 v225, v208, v209
  v_mfma_f32_16x16x32_bf16 a[44:47], a[180:183], v[164:167], a[44:47]
  v_exp_f32 v211, v123
  v_mfma_f32_16x16x32_bf16 a[104:107], a[180:183], v[176:179], a[104:107]
  v_exp_f32 v212, v124
  v_mfma_f32_16x16x32_bf16 a[108:111], a[180:183], v[180:183], a[108:111]
  v_exp_f32 v213, v125
  v_mfma_f32_16x16x32_bf16 a[48:51], a[184:187], v[160:163], a[48:51]
  ds_read_b128 a[152:155], v3 offset:6144
  v_cvt_pk_bf16_f32 v172, v208, v209
  v_add_f32 v225, v225, v210
  v_add_f32 v225, v225, v211
  v_cvt_pk_bf16_f32 v173, v210, v211
  v_max3_f32 v5, v226, v227, v224
  v_mfma_f32_16x16x32_bf16 a[52:55], a[184:187], v[164:167], a[52:55]
  v_exp_f32 v214, v126
  v_mfma_f32_16x16x32_bf16 a[112:115], a[184:187], v[176:179], a[112:115]
  buffer_load_dwordx4 v2, s[44:47], s26 offen offset:3072 sc1 lds
  v_add_f32 v225, v225, v212
  v_add_f32 v225, v225, v213
  v_cvt_pk_bf16_f32 v174, v212, v213
  v_mfma_f32_16x16x32_bf16 a[116:119], a[184:187], v[180:183], a[116:119]
  s_add_u32 s26, s26, 16384
  v_exp_f32 v215, v127
  v_mfma_f32_16x16x32_bf16 a[56:59], a[188:191], v[160:163], a[56:59]
  s_add_u32 s24, s24, 32768
  ds_read_b128 a[156:159], v3 offset:7168
  v_add_f32 v225, v225, v214
  v_add_f32 v225, v225, v215
  v_max_f32 v5, v5, v225
  v_cmp_lt_f32 vcc, s81, v5
  v_mfma_f32_16x16x32_bf16 a[60:63], a[188:191], v[164:167], a[60:63]
  s_and_b32 s24, s24, 0x1ffff
  v_exp_f32 v216, v128
  v_mfma_f32_16x16x32_bf16 a[120:123], a[188:191], v[176:179], a[120:123]
  s_waitcnt lgkmcnt(4)
  v_cvt_pk_bf16_f32 v175, v214, v215
  v_mfma_f32_16x16x32_bf16 a[124:127], a[188:191], v[180:183], a[124:127]
  s_cbranch_vccnz fa_stub8
fa_back8:
  v_exp_f32 v217, v129
  v_add_f32 v228, v228, v224
  v_add_f32 v229, v229, v225
  v_add_f32 v230, v230, v226
  v_add_f32 v231, v231, v227
  v_mfma_f32_16x16x32_bf16 v[144:147], a[128:131], v[64:67], v[200:203]
  ds_read_b128 a[160:163], v3 offset:24576
  v_add_f32 v226, v216, v217
  v_mfma_f32_16x16x32_bf16 v[152:155], a[128:131], v[68:71], v[204:207]
  v_exp_f32 v218, v130
  v_mfma_f32_16x16x32_bf16 v[148:151], a[132:135], v[64:67], v[200:203]
  s_add_u32 s66, s66, 32768
  ds_read_b128 a[164:167], v3 offset:25600
  v_cvt_pk_bf16_f32 v176, v216, v217
  v_mfma_f32_16x16x32_bf16 v[156:159], a[132:135], v[68:71], v[204:207]
  s_and_b32 s66, s66, 0x1ffff
  v_exp_f32 v219, v131
  v_mfma_f32_16x16x32_bf16 v[144:147], a[136:139], v[72:75], v[144:147]
  ds_read_b128 a[168:171], v3 offset:26624
  v_add_f32 v226, v226, v218
  v_mfma_f32_16x16x32_bf16 v[152:155], a[136:139], v[76:79], v[152:155]
  s_mov_b32 m0, s25
  v_exp_f32 v220, v132
  v_mfma_f32_16x16x32_bf16 v[148:151], a[140:143], v[72:75], v[148:151]
  ds_read_b128 a[172:175], v3 offset:27648
  buffer_load_dwordx4 v2, s[48:51], s27 offen offset:0 sc1 lds
  v_add_f32 v226, v226, v219
  v_mfma_f32_16x16x32_bf16 v[156:159], a[140:143], v[76:79], v[156:159]
  s_waitcnt lgkmcnt(4)
  v_exp_f32 v221, v133
  v_mfma_f32_16x16x32_bf16 v[144:147], a[144:147], v[80:83], v[144:147]
  ds_read_b128 a[176:179], v3 offset:28672
  v_cvt_pk_bf16_f32 v177, v218, v219
  v_mfma_f32_16x16x32_bf16 v[152:155], a[144:147], v[84:87], v[152:155]
  v_exp_f32 v222, v134
  v_mfma_f32_16x16x32_bf16 v[148:151], a[148:151], v[80:83], v[148:151]
  ds_read_b128 a[180:183], v3 offset:29696
  v_add_f32 v226, v226, v220
  v_mfma_f32_16x16x32_bf16 v[156:159], a[148:151], v[84:87], v[156:159]
  v_exp_f32 v223, v135
  v_mfma_f32_16x16x32_bf16 v[144:147], a[152:155], v[88:91], v[144:147]
  ds_read_b128 a[184:187], v3 offset:30720
  v_add_f32 v226, v226, v221
  v_mfma_f32_16x16x32_bf16 v[152:155], a[152:155], v[92:95], v[152:155]
  v_exp_f32 v216, v136
  v_mfma_f32_16x16x32_bf16 v[148:151], a[156:159], v[88:91], v[148:151]
  ds_read_b128 a[188:191], v3 offset:31744
  v_cvt_pk_bf16_f32 v178, v220, v221
  v_mfma_f32_16x16x32_bf16 v[156:159], a[156:159], v[92:95], v[156:159]
  s_waitcnt lgkmcnt(4)
  v_exp_f32 v217, v137
  v_mfma_f32_16x16x32_bf16 a[0:3], a[160:163], v[168:171], a[0:3]
  ds_read_b128 a[128:131], v3 offset:8192
  v_add_f32 v226, v226, v222
  v_mfma_f32_16x16x32_bf16 a[4:7], a[160:163], v[172:175], a[4:7]
  v_exp_f32 v218, v138
  v_mfma_f32_16x16x32_bf16 a[64:67], a[160:163], v[184:187], a[64:67]
  buffer_load_dwordx4 v2, s[48:51], s27 offen offset:1024 sc1 lds
  v_add_f32 v226, v226, v223
  v_mfma_f32_16x16x32_bf16 a[68:71], a[160:163], v[188:191], a[68:71]
  v_exp_f32 v219, v139
  v_mfma_f32_16x16x32_bf16 a[8:11], a[164:167], v[168:171], a[8:11]
  ds_read_b128 a[132:135], v3 offset:9216
  v_cvt_pk_bf16_f32 v179, v222, v223
  v_mfma_f32_16x16x32_bf16 a[12:15], a[164:167], v[172:175], a[12:15]
  v_exp_f32 v220, v140
  v_mfma_f32_16x16x32_bf16 a[72:75], a[164:167], v[184:187], a[72:75]
  v_add_f32 v227, v216, v217
  v_cvt_pk_bf16_f32 v180, v216, v217
  v_mfma_f32_16x16x32_bf16 a[76:79], a[164:167], v[188:191], a[76:79]
  v_exp_f32 v221, v141
  v_mfma_f32_16x16x32_bf16 a[16:19], a[168:171], v[168:171], a[16:19]
  ds_read_b128 a[136:139], v3 offset:10240
  v_add_f32 v227, v227, v218
  v_mfma_f32_16x16x32_bf16 a[20:23], a[168:171], v[172:175], a[20:23]
  v_exp_f32 v222, v142
  v_mfma_f32_16x16x32_bf16 a[80:83], a[168:171], v[184:187], a[80:83]
  v_add_f32 v227, v227, v219
  v_cvt_pk_bf16_f32 v181, v218, v219
  v_mfma_f32_16x16x32_bf16 a[84:87], a[168:171], v[188:191], a[84:87]
  v_exp_f32 v223, v143
  v_mfma_f32_16x16x32_bf16 a[24:27], a[172:175], v[168:171], a[24:27]
  ds_read_b128 a[140:143], v3 offset:11264
  v_add_f32 v227, v227, v220
  v_mfma_f32_16x16x32_bf16 a[28:31], a[172:175], v[172:175], a[28:31]
  v_add_f32 v227, v227, v221
  v_cvt_pk_bf16_f32 v182, v220, v221
  v_mfma_f32_16x16x32_bf16 a[88:91], a[172:175], v[184:187], a[88:91]
  buffer_load_dwordx4 v2, s[48:51], s27 offen offset:2048 sc1 lds
  v_add_f32 v227, v227, v222
  v_mfma_f32_16x16x32_bf16 a[92:95], a[172:175], v[188:191], a[92:95]
  s_waitcnt lgkmcnt(4)
  v_add_f32 v227, v227, v223
  v_max_f32 v5, v226, v227
  v_mfma_f32_16x16x32_bf16 a[32:35], a[176:179], v[168:171], a[32:35]
  ds_read_b128 a[144:147], v3 offset:12288
  v_cmp_lt_f32 vcc, s81, v5
  v_mfma_f32_16x16x32_bf16 a[36:39], a[176:179], v[172:175], a[36:39]
  v_mfma_f32_16x16x32_bf16 a[96:99], a[176:179], v[184:187], a[96:99]
  v_mfma_f32_16x16x32_bf16 a[100:103], a[176:179], v[188:191], a[100:103]
  v_mfma_f32_16x16x32_bf16 a[40:43], a[180:183], v[168:171], a[40:43]
  ds_read_b128 a[148:151], v3 offset:13312
  v_mfma_f32_16x16x32_bf16 a[44:47], a[180:183], v[172:175], a[44:47]
  v_mfma_f32_16x16x32_bf16 a[104:107], a[180:183], v[184:187], a[104:107]
  v_mfma_f32_16x16x32_bf16 a[108:111], a[180:183], v[188:191], a[108:111]
  v_mfma_f32_16x16x32_bf16 a[48:51], a[184:187], v[168:171], a[48:51]
  ds_read_b128 a[152:155], v3 offset:14336
  v_mfma_f32_16x16x32_bf16 a[52:55], a[184:187], v[172:175], a[52:55]
  v_mfma_f32_16x16x32_bf16 a[112:115], a[184:187], v[184:187], a[112:115]
  buffer_load_dwordx4 v2, s[48:51], s27 offen offset:3072 sc1 lds
  v_mfma_f32_16x16x32_bf16 a[116:119], a[184:187], v[188:191], a[116:119]
  s_add_u32 s27, s27, 16384
  v_mfma_f32_16x16x32_bf16 a[56:59], a[188:191], v[168:171], a[56:59]
  s_add_u32 s25, s25, 32768
  ds_read_b128 a[156:159], v3 offset:15360
  v_mfma_f32_16x16x32_bf16 a[60:63], a[188:191], v[172:175], a[60:63]
  s_and_b32 s25, s25, 0x1ffff
  v_exp_f32 v216, v144
  v_mfma_f32_16x16x32_bf16 a[120:123], a[188:191], v[184:187], a[120:123]
  s_waitcnt lgkmcnt(4)
  v_cvt_pk_bf16_f32 v183, v222, v223
  v_add_u32 v3, s66, v2
  v_mfma_f32_16x16x32_bf16 a[124:127], a[188:191], v[188:191], a[124:127]
  s_cbranch_vccnz fa_stub9
fa_back9:
  v_exp_f32 v217, v145
  v_add_f32 v230, v230, v226
  v_add_f32 v231, v231, v227
fa_SSpre:
  s_mov_b32 s11, 1
  s_cmp_lg_u32 s12, 0
  s_cselect_b32 s32, s15, s32
  s_cmp_ge_u32 s20, 2
  s_cselect_b32 s23, 8, 0
  s_cmp_le_u32 s29, s23
  s_cbranch_scc1 fa_chain
.p2align 6
fa_SS:
  v_mfma_f32_16x16x32_bf16 v[128:131], a[128:131], v[64:67], v[200:203]
  s_waitcnt vmcnt(12)
  v_exp_f32 v218, v146
  v_mfma_f32_16x16x32_bf16 v[136:139], a[128:131], v[68:71], v[204:207]
  s_barrier
  v_exp_f32 v219, v147
  v_mfma_f32_16x16x32_bf16 v[132:135], a[132:135], v[64:67], v[200:203]
  s_cmp_ge_u32 s26, s32
  ds_read_b128 a[160:163], v3 offset:16384
  ds_read_b128 a[164:167], v3 offset:17408
  v_add_f32 v226, v216, v217
  v_mfma_f32_16x16x32_bf16 v[140:143], a[132:135], v[68:71], v[204:207]
  s_cbranch_scc1 fa_hk7
fa_hb7:
  v_exp_f32 v220, v148
  v_mfma_f32_16x16x32_bf16 v[128:131], a[136:139], v[72:75], v[128:131]
  ds_read_b128 a[168:171], v3 offset:18432
  v_cvt_pk_bf16_f32 v184, v216, v217
  v_mfma_f32_16x16x32_bf16 v[136:139], a[136:139], v[76:79], v[136:139]
  s_mov_b32 m0, s24
  v_exp_f32 v221, v149
  v_mfma_f32_16x16x32_bf16 v[132:135], a[140:143], v[72:75], v[132:135]
  ds_read_b128 a[172:175], v3 offset:19456
  buffer_load_dwordx4 v2, s[44:47], s26 offen offset:0 sc1 lds
  v_add_f32 v226, v226, v218
  v_add_f32 v226, v226, v219
  v_mfma_f32_16x16x32_bf16 v[140:143], a[140:143], v[76:79], v[140:143]
  s_waitcnt lgkmcnt(4)
  v_exp_f32 v222, v150
  v_mfma_f32_16x16x32_bf16 v[128:131], a[144:147], v[80:83], v[128:131]
  ds_read_b128 a[176:179], v3 offset:20480
  v_cvt_pk_bf16_f32 v185, v218, v219
  v_mfma_f32_16x16x32_bf16 v[136:139], a[144:147], v[84:87], v[136:139]
  v_exp_f32 v223, v151
  v_mfma_f32_16x16x32_bf16 v[132:135], a[148:151], v[80:83], v[132:135]
  ds_read_b128 a[180:183], v3 offset:21504
  v_add_f32 v226, v226, v220
  v_mfma_f32_16x16x32_bf16 v[140:143], a[148:151], v[84:87], v[140:143]
  v_exp_f32 v216, v152
  v_mfma_f32_16x16x32_bf16 v[128:131], a[152:155], v[88:91], v[128:131]
  ds_read_b128 a[184:187], v3 offset:22528
  buffer_load_dwordx4 v2, s[44:47], s26 offen offset:1024 sc1 lds
  v_add_f32 v226, v226, v221
  v_cvt_pk_bf16_f32 v186, v220, v221
  v_mfma_f32_16x16x32_bf16 v[136:139], a[152:155], v[92:95], v[136:139]
  v_exp_f32 v217, v153
  v_mfma_f32_16x16x32_bf16 v[132:135], a[156:159], v[88:91], v[132:135]
  ds_read_b128 a[188:191], v3 offset:23552
  v_add_f32 v226, v226, v222
  v_mfma_f32_16x16x32_bf16 v[140:143], a[156:159], v[92:95], v[140:143]
  s_waitcnt lgkmcnt(4)
  v_exp_f32 v218, v154
  v_mfma_f32_16x16x32_bf16 a[64:67], a[160:163], v[176:179], a[64:67]
  ds_read_b128 a[128:131], v3 offset:0
  v_add_f32 v226, v226, v223
  v_cvt_pk_bf16_f32 v187, v222, v223
  v_mfma_f32_16x16x32_bf16 a[68:71], a[160:163], v[180:183], a[68:71]
  v_exp_f32 v219, v155
  v_mfma_f32_16x16x32_bf16 a[72:75], a[164:167], v[176:179], a[72:75]
  ds_read_b128 a[132:135], v3 offset:1024
  buffer_load_dwordx4 v2, s[44:47], s26 offen offset:2048 sc1 lds
  v_add_f32 v227, v216, v217
  v_mfma_f32_16x16x32_bf16 a[76:79], a[164:167], v[180:183], a[76:79]
  v_exp_f32 v220, v156
  v_mfma_f32_16x16x32_bf16 a[80:83], a[168:171], v[176:179], a[80:83]
  ds_read_b128 a[136:139], v3 offset:2048
  v_cvt_pk_bf16_f32 v188, v216, v217
  v_mfma_f32_16x16x32_bf16 a[84:87], a[168:171], v[180:183], a[84:87]
  v_exp_f32 v221, v157
  v_mfma_f32_16x16x32_bf16 a[88:91], a[172:175], v[176:179], a[88:91]
  ds_read_b128 a[140:143], v3 offset:3072
  v_add_f32 v227, v227, v218
  v_add_f32 v227, v227, v219
  v_mfma_f32_16x16x32_bf16 a[92:95], a[172:175], v[180:183], a[92:95]
  s_waitcnt lgkmcnt(4)
  v_exp_f32 v222, v158
  v_mfma_f32_16x16x32_bf16 a[96:99], a[176:179], v[176:179], a[96:99]
  ds_read_b128 a[144:147], v3 offset:4096
  buffer_load_dwordx4 v2, s[44:47], s26 offen offset:3072 sc1 lds
  v_cvt_pk_bf16_f32 v189, v218, v219
  v_mfma_f32_16x16x32_bf16 a[100:103], a[176:179], v[180:183], a[100:103]
  s_add_u32 s26, s26, 16384
  v_exp_f32 v223, v159
  v_mfma_f32_16x16x32_bf16 a[104:107], a[180:183], v[176:179], a[104:107]
  s_add_u32 s24, s24, 32768
  ds_read_b128 a[148:151], v3 offset:5120
  v_add_f32 v227, v227, v220
  v_mfma_f32_16x16x32_bf16 a[108:111], a[180:183], v[180:183], a[108:111]
  s_and_b32 s24, s24, 0x1ffff
  v_add_f32 v227, v227, v221
  v_cvt_pk_bf16_f32 v190, v220, v221
  v_add_f32 v227, v227, v222
  v_mfma_f32_16x16x32_bf16 a[112:115], a[184:187], v[176:179], a[112:115]
  ds_read_b128 a[152:155], v3 offset:6144
  v_add_f32 v227, v227, v223
  v_max_f32 v5, v226, v227
  v_cmp_lt_f32 vcc, s81, v5
  v_mfma_f32_16x16x32_bf16 a[116:119], a[184:187], v[180:183], a[116:119]
  v_exp_f32 v216, v128
  v_mfma_f32_16x16x32_bf16 a[120:123], a[188:191], v[176:179], a[120:123]
  s_waitcnt lgkmcnt(3)
  ds_read_b128 a[156:159], v3 offset:7168
  v_cvt_pk_bf16_f32 v191, v222, v223
  v_mfma_f32_16x16x32_bf16 a[124:127], a[188:191], v[180:183], a[124:127]
  s_cbranch_vccnz fa_stub10
fa_back10:
  v_exp_f32 v217, v129
  v_add_f32 v230, v230, v226
  v_add_f32 v231, v231, v227
  v_mfma_f32_16x16x32_bf16 v[144:147], a[128:131], v[64:67], v[200:203]
  ds_read_b128 a[160:163], v3 offset:24576
  v_add_f32 v226, v216, v217
  v_mfma_f32_16x16x32_bf16 v[152:155], a[128:131], v[68:71], v[204:207]
  v_exp_f32 v218, v130
  v_mfma_f32_16x16x32_bf16 v[148:151], a[132:135], v[64:67], v[200:203]
  s_add_u32 s66, s66, 32768
  ds_read_b128 a[164:167], v3 offset:25600
  v_cvt_pk_bf16_f32 v176, v216, v217
  v_mfma_f32_16x16x32_bf16 v[156:159], a[132:135], v[68:71], v[204:207]
  s_mov_b32 m0, s25
  v_exp_f32 v219, v131
  v_mfma_f32_16x16x32_bf16 v[144:147], a[136:139], v[72:75], v[144:147]
  s_and_b32 s66, s66, 0x1ffff
  ds_read_b128 a[168:171], v3 offset:26624
  buffer_load_dwordx4 v2, s[48:51], s27 offen offset:0 sc1 lds
  v_add_f32 v226, v226, v218
  v_add_f32 v226, v226, v219
  v_mfma_f32_16x16x32_bf16 v[152:155], a[136:139], v[76:79], v[152:155]
  v_exp_f32 v220, v132
  v_mfma_f32_16x16x32_bf16 v[148:151], a[140:143], v[72:75], v[148:151]
  ds_read_b128 a[172:175], v3 offset:27648
  v_cvt_pk_bf16_f32 v177, v218, v219
  v_mfma_f32_16x16x32_bf16 v[156:159], a[140:143], v[76:79], v[156:159]
  s_waitcnt lgkmcnt(4)
  v_exp_f32 v221, v133
  v_mfma_f32_16x16x32_bf16 v[144:147], a[144:147], v[80:83], v[144:147]
  ds_read_b128 a[176:179], v3 offset:28672
  v_add_f32 v226, v226, v220
  v_mfma_f32_16x16x32_bf16 v[152:155], a[144:147], v[84:87], v[152:155]
  v_exp_f32 v222, v134
  v_mfma_f32_16x16x32_bf16 v[148:151], a[148:151], v[80:83], v[148:151]
  ds_read_b128 a[180:183], v3 offset:29696
  buffer_load_dwordx4 v2, s[48:51], s27 offen offset:1024 sc1 lds
  v_add_f32 v226, v226, v221
  v_cvt_pk_bf16_f32 v178, v220, v221
  v_mfma_f32_16x16x32_bf16 v[156:159], a[148:151], v[84:87], v[156:159]
  v_exp_f32 v223, v135
  v_mfma_f32_16x16x32_bf16 v[144:147], a[152:155], v[88:91], v[144:147]
  ds_read_b128 a[184:187], v3 offset:30720
  v_add_f32 v226, v226, v222
  v_mfma_f32_16x16x32_bf16 v[152:155], a[152:155], v[92:95], v[152:155]
  v_exp_f32 v216, v136
  v_mfma_f32_16x16x32_bf16 v[148:151], a[156:159], v[88:91], v[148:151]
  ds_read_b128 a[188:191], v3 offset:31744
  v_add_f32 v226, v226, v223
  v_exp_f32 v217, v137
  v_mfma_f32_16x16x32_bf16 v[156:159], a[156:159], v[92:95], v[156:159]
  s_waitcnt lgkmcnt(4)
  v_exp_f32 v218, v138
  v_mfma_f32_16x16x32_bf16 a[64:67], a[160:163], v[184:187], a[64:67]
  ds_read_b128 a[128:131], v3 offset:8192
  v_cvt_pk_bf16_f32 v179, v222, v223
  v_mfma_f32_16x16x32_bf16 a[68:71], a[160:163], v[188:191], a[68:71]
  v_exp_f32 v219, v139
  v_mfma_f32_16x16x32_bf16 a[72:75], a[164:167], v[184:187], a[72:75]
  ds_read_b128 a[132:135], v3 offset:9216
  buffer_load_dwordx4 v2, s[48:51], s27 offen offset:2048 sc1 lds
  v_add_f32 v227, v216, v217
  v_mfma_f32_16x16x32_bf16 a[76:79], a[164:167], v[188:191], a[76:79]
  v_exp_f32 v220, v140
  v_mfma_f32_16x16x32_bf16 a[80:83], a[168:171], v[184:187], a[80:83]
  ds_read_b128 a[136:139], v3 offset:10240
  v_cvt_pk_bf16_f32 v180, v216, v217
  v_mfma_f32_16x16x32_bf16 a[84:87], a[168:171], v[188:191], a[84:87]
  v_exp_f32 v221, v141
  v_mfma_f32_16x16x32_bf16 a[88:91], a[172:175], v[184:187], a[88:91]
  ds_read_b128 a[140:143], v3 offset:11264
  v_add_f32 v227, v227, v218
  v_mfma_f32_16x16x32_bf16 a[92:95], a[172:175], v[188:191], a[92:95]
  s_waitcnt lgkmcnt(4)
  v_exp_f32 v222, v142
  v_mfma_f32_16x16x32_bf16 a[96:99], a[176:179], v[184:187], a[96:99]
  ds_read_b128 a[144:147], v3 offset:12288
  buffer_load_dwordx4 v2, s[48:51], s27 offen offset:3072 sc1 lds
  v_add_f32 v227, v227, v219
  v_cvt_pk_bf16_f32 v181, v218, v219
  v_mfma_f32_16x16x32_bf16 a[100:103], a[176:179], v[188:191], a[100:103]
  s_add_u32 s27, s27, 16384
  v_exp_f32 v223, v143
  v_mfma_f32_16x16x32_bf16 a[104:107], a[180:183], v[184:187], a[104:107]
  s_add_u32 s25, s25, 32768
  ds_read_b128 a[148:151], v3 offset:13312
  v_add_f32 v227, v227, v220
  v_mfma_f32_16x16x32_bf16 a[108:111], a[180:183], v[188:191], a[108:111]
  s_and_b32 s25, s25, 0x1ffff
  v_add_f32 v227, v227, v221
  v_cvt_pk_bf16_f32 v182, v220, v221
  v_add_f32 v227, v227, v222
  v_mfma_f32_16x16x32_bf16 a[112:115], a[184:187], v[184:187], a[112:115]
  s_sub_u32 s29, s29, 1
  ds_read_b128 a[152:155], v3 offset:14336
  v_add_f32 v227, v227, v223
  v_max_f32 v5, v226, v227
  v_cmp_lt_f32 vcc, s81, v5
  v_mfma_f32_16x16x32_bf16 a[116:119], a[184:187], v[188:191], a[116:119]
  s_cmp_gt_u32 s29, 8
  v_exp_f32 v216, v144
  v_mfma_f32_16x16x32_bf16 a[120:123], a[188:191], v[184:187], a[120:123]
  s_waitcnt lgkmcnt(3)
  ds_read_b128 a[156:159], v3 offset:15360
  v_cvt_pk_bf16_f32 v183, v222, v223
  v_add_u32 v3, s66, v2
  v_mfma_f32_16x16x32_bf16 a[124:127], a[188:191], v[188:191], a[124:127]
  s_cbranch_vccnz fa_stub11
fa_back11:
  v_exp_f32 v217, v145
  v_add_f32 v230, v230, v226
  v_add_f32 v231, v231, v227
  s_cbranch_scc1 fa_SS
fa_chain:
fa_hb8:
  s_cmp_lt_u32 s12, 2
  s_cbranch_scc1 fa_hk8
  s_cmp_eq_u32 s29, 8
  s_cbranch_scc0 fa_disp
fa_SSW8:
  v_mfma_f32_16x16x32_bf16 v[128:131], a[128:131], v[64:67], v[200:203]
  s_waitcnt vmcnt(12)
  v_exp_f32 v218, v146
  v_mfma_f32_16x16x32_bf16 v[136:139], a[128:131], v[68:71], v[204:207]
  s_barrier
  v_exp_f32 v219, v147
  v_mfma_f32_16x16x32_bf16 v[132:135], a[132:135], v[64:67], v[200:203]
  ds_read_b128 a[160:163], v3 offset:16384
  ds_read_b128 a[164:167], v3 offset:17408
  v_add_f32 v226, v216, v217
  v_mfma_f32_16x16x32_bf16 v[140:143], a[132:135], v[68:71], v[204:207]
  s_mov_b32 m0, s24
  v_exp_f32 v220, v148
  v_mfma_f32_16x16x32_bf16 v[128:131], a[136:139], v[72:75], v[128:131]
  ds_read_b128 a[168:171], v3 offset:18432
  buffer_load_dwordx4 v2, s[44:47], s26 offen offset:0 sc1 lds
  v_cvt_pk_bf16_f32 v184, v216, v217
  v_mfma_f32_16x16x32_bf16 v[136:139], a[136:139], v[76:79], v[136:139]
  v_exp_f32 v221, v149
  v_mfma_f32_16x16x32_bf16 v[132:135], a[140:143], v[72:75], v[132:135]
  ds_read_b128 a[172:175], v3 offset:19456
  v_add_f32 v226, v226, v218
  v_add_f32 v226, v226, v219
  v_mfma_f32_16x16x32_bf16 v[140:143], a[140:143], v[76:79], v[140:143]
  s_waitcnt lgkmcnt(4)
  v_exp_f32 v222, v150
  v_mfma_f32_16x16x32_bf16 v[128:131], a[144:147], v[80:83], v[128:131]
  s_add_u32 s14, s13, 0
  ds_read_b128 a[176:179], v3 offset:20480
  buffer_load_dwordx4 a[0:3], v2, s[40:43], s14 offen offset:0 sc1
  v_cvt_pk_bf16_f32 v185, v218, v219
  v_mfma_f32_16x16x32_bf16 v[136:139], a[144:147], v[84:87], v[136:139]
  v_exp_f32 v223, v151
  v_mfma_f32_16x16x32_bf16 v[132:135], a[148:151], v[80:83], v[132:135]
  ds_read_b128 a[180:183], v3 offset:21504
  buffer_load_dwordx4 v2, s[44:47], s26 offen offset:1024 sc1 lds
  v_add_f32 v226, v226, v220
  v_mfma_f32_16x16x32_bf16 v[140:143], a[148:151], v[84:87], v[140:143]
  v_exp_f32 v216, v152
  v_mfma_f32_16x16x32_bf16 v[128:131], a[152:155], v[88:91], v[128:131]
  ds_read_b128 a[184:187], v3 offset:22528
  v_add_f32 v226, v226, v221
  v_cvt_pk_bf16_f32 v186, v220, v221
  v_mfma_f32_16x16x32_bf16 v[136:139], a[152:155], v[92:95], v[136:139]
  v_exp_f32 v217, v153
  v_mfma_f32_16x16x32_bf16 v[132:135], a[156:159], v[88:91], v[132:135]
  ds_read_b128 a[188:191], v3 offset:23552
  buffer_load_dwordx4 a[4:7], v2, s[40:43], s14 offen offset:1024 sc1
  v_add_f32 v226, v226, v222
  v_mfma_f32_16x16x32_bf16 v[140:143], a[156:159], v[92:95], v[140:143]
  s_waitcnt lgkmcnt(4)
  v_exp_f32 v218, v154
  v_mfma_f32_16x16x32_bf16 a[64:67], a[160:163], v[176:179], a[64:67]
  ds_read_b128 a[128:131], v3 offset:0
  v_add_f32 v226, v226, v223
  v_cvt_pk_bf16_f32 v187, v222, v223
  v_mfma_f32_16x16x32_bf16 a[68:71], a[160:163], v[180:183], a[68:71]
  v_exp_f32 v219, v155
  v_mfma_f32_16x16x32_bf16 a[72:75], a[164:167], v[176:179], a[72:75]
  ds_read_b128 a[132:135], v3 offset:1024
  buffer_load_dwordx4 v2, s[44:47], s26 offen offset:2048 sc1 lds
  v_add_f32 v227, v216, v217
  v_mfma_f32_16x16x32_bf16 a[76:79], a[164:167], v[180:183], a[76:79]
  v_exp_f32 v220, v156
  v_mfma_f32_16x16x32_bf16 a[80:83], a[168:171], v[176:179], a[80:83]
  ds_read_b128 a[136:139], v3 offset:2048
  v_cvt_pk_bf16_f32 v188, v216, v217
  v_mfma_f32_16x16x32_bf16 a[84:87], a[168:171], v[180:183], a[84:87]
  v_exp_f32 v221, v157
  v_mfma_f32_16x16x32_bf16 a[88:91], a[172:175], v[176:179], a[88:91]
  ds_read_b128 a[140:143], v3 offset:3072
  buffer_load_dwordx4 a[8:11], v2, s[40:43], s14 offen offset:2048 sc1
  v_add_f32 v227, v227, v218
  v_add_f32 v227, v227, v219
  v_mfma_f32_16x16x32_bf16 a[92:95], a[172:175], v[180:183], a[92:95]
  s_waitcnt lgkmcnt(4)
  v_exp_f32 v222, v158
  v_mfma_f32_16x16x32_bf16 a[96:99], a[176:179], v[176:179], a[96:99]
  ds_read_b128 a[144:147], v3 offset:4096
  buffer_load_dwordx4 v2, s[44:47], s26 offen offset:3072 sc1 lds
  v_cvt_pk_bf16_f32 v189, v218, v219
  v_mfma_f32_16x16x32_bf16 a[100:103], a[176:179], v[180:183], a[100:103]
  s_add_u32 s26, s26, 16384
  v_exp_f32 v223, v159
  v_mfma_f32_16x16x32_bf16 a[104:107], a[180:183], v[176:179], a[104:107]
  s_add_u32 s24, s24, 32768
  ds_read_b128 a[148:151], v3 offset:5120
  v_add_f32 v227, v227, v220
  v_mfma_f32_16x16x32_bf16 a[108:111], a[180:183], v[180:183], a[108:111]
  s_and_b32 s24, s24, 0x1ffff
  v_add_f32 v227, v227, v221
  v_cvt_pk_bf16_f32 v190, v220, v221
  v_add_f32 v227, v227, v222
  v_mfma_f32_16x16x32_bf16 a[112:115], a[184:187], v[176:179], a[112:115]
  ds_read_b128 a[152:155], v3 offset:6144
  v_add_f32 v227, v227, v223
  v_max_f32 v5, v226, v227
  v_cmp_lt_f32 vcc, s81, v5
  v_mfma_f32_16x16x32_bf16 a[116:119], a[184:187], v[180:183], a[116:119]
  v_exp_f32 v216, v128
  v_mfma_f32_16x16x32_bf16 a[120:123], a[188:191], v[176:179], a[120:123]
  s_waitcnt lgkmcnt(3)
  ds_read_b128 a[156:159], v3 offset:7168
  v_cvt_pk_bf16_f32 v191, v222, v223
  v_mfma_f32_16x16x32_bf16 a[124:127], a[188:191], v[180:183], a[124:127]
  s_cbranch_vccnz fa_stub12
fa_back12:
  v_exp_f32 v217, v129
  v_add_f32 v230, v230, v226
  v_add_f32 v231, v231, v227
  v_mfma_f32_16x16x32_bf16 v[144:147], a[128:131], v[64:67], v[200:203]
  ds_read_b128 a[160:163], v3 offset:24576
  v_add_f32 v226, v216, v217
  v_mfma_f32_16x16x32_bf16 v[152:155], a[128:131], v[68:71], v[204:207]
  v_exp_f32 v218, v130
  v_mfma_f32_16x16x32_bf16 v[148:151], a[132:135], v[64:67], v[200:203]
  s_add_u32 s66, s66, 32768
  ds_read_b128 a[164:167], v3 offset:25600
  v_cvt_pk_bf16_f32 v176, v216, v217
  v_mfma_f32_16x16x32_bf16 v[156:159], a[132:135], v[68:71], v[204:207]
  s_mov_b32 m0, s25
  v_exp_f32 v219, v131
  v_mfma_f32_16x16x32_bf16 v[144:147], a[136:139], v[72:75], v[144:147]
  s_and_b32 s66, s66, 0x1ffff
  ds_read_b128 a[168:171], v3 offset:26624
  buffer_load_dwordx4 v2, s[48:51], s27 offen offset:0 sc1 lds
  v_add_f32 v226, v226, v218
  v_add_f32 v226, v226, v219
  v_mfma_f32_16x16x32_bf16 v[152:155], a[136:139], v[76:79], v[152:155]
  v_exp_f32 v220, v132
  v_mfma_f32_16x16x32_bf16 v[148:151], a[140:143], v[72:75], v[148:151]
  ds_read_b128 a[172:175], v3 offset:27648
  v_cvt_pk_bf16_f32 v177, v218, v219
  v_mfma_f32_16x16x32_bf16 v[156:159], a[140:143], v[76:79], v[156:159]
  s_waitcnt lgkmcnt(4)
  v_exp_f32 v221, v133
  v_mfma_f32_16x16x32_bf16 v[144:147], a[144:147], v[80:83], v[144:147]
  s_add_u32 s14, s13, 0
  ds_read_b128 a[176:179], v3 offset:28672
  buffer_load_dwordx4 a[12:15], v2, s[40:43], s14 offen offset:3072 sc1
  v_add_f32 v226, v226, v220
  v_mfma_f32_16x16x32_bf16 v[152:155], a[144:147], v[84:87], v[152:155]
  v_exp_f32 v222, v134
  v_mfma_f32_16x16x32_bf16 v[148:151], a[148:151], v[80:83], v[148:151]
  ds_read_b128 a[180:183], v3 offset:29696
  buffer_load_dwordx4 v2, s[48:51], s27 offen offset:1024 sc1 lds
  v_add_f32 v226, v226, v221
  v_cvt_pk_bf16_f32 v178, v220, v221
  v_mfma_f32_16x16x32_bf16 v[156:159], a[148:151], v[84:87], v[156:159]
  v_exp_f32 v223, v135
  v_mfma_f32_16x16x32_bf16 v[144:147], a[152:155], v[88:91], v[144:147]
  ds_read_b128 a[184:187], v3 offset:30720
  v_add_f32 v226, v226, v222
  v_mfma_f32_16x16x32_bf16 v[152:155], a[152:155], v[92:95], v[152:155]
  v_exp_f32 v216, v136
  v_mfma_f32_16x16x32_bf16 v[148:151], a[156:159], v[88:91], v[148:151]
  s_add_u32 s14, s13, 4096
  ds_read_b128 a[188:191], v3 offset:31744
  buffer_load_dwordx4 a[16:19], v2, s[40:43], s14 offen offset:0 sc1
  v_add_f32 v226, v226, v223
  v_exp_f32 v217, v137
  v_mfma_f32_16x16x32_bf16 v[156:159], a[156:159], v[92:95], v[156:159]
  s_waitcnt lgkmcnt(4)
  v_exp_f32 v218, v138
  v_mfma_f32_16x16x32_bf16 a[64:67], a[160:163], v[184:187], a[64:67]
  ds_read_b128 a[128:131], v3 offset:8192
  v_cvt_pk_bf16_f32 v179, v222, v223
  v_mfma_f32_16x16x32_bf16 a[68:71], a[160:163], v[188:191], a[68:71]
  v_exp_f32 v219, v139
  v_mfma_f32_16x16x32_bf16 a[72:75], a[164:167], v[184:187], a[72:75]
  ds_read_b128 a[132:135], v3 offset:9216
  buffer_load_dwordx4 v2, s[48:51], s27 offen offset:2048 sc1 lds
  v_add_f32 v227, v216, v217
  v_mfma_f32_16x16x32_bf16 a[76:79], a[164:167], v[188:191], a[76:79]
  v_exp_f32 v220, v140
  v_mfma_f32_16x16x32_bf16 a[80:83], a[168:171], v[184:187], a[80:83]
  ds_read_b128 a[136:139], v3 offset:10240
  v_cvt_pk_bf16_f32 v180, v216, v217
  v_mfma_f32_16x16x32_bf16 a[84:87], a[168:171], v[188:191], a[84:87]
  v_exp_f32 v221, v141
  v_mfma_f32_16x16x32_bf16 a[88:91], a[172:175], v[184:187], a[88:91]
  ds_read_b128 a[140:143], v3 offset:11264
  buffer_load_dwordx4 a[20:23], v2, s[40:43], s14 offen offset:1024 sc1
  v_add_f32 v227, v227, v218
  v_mfma_f32_16x16x32_bf16 a[92:95], a[172:175], v[188:191], a[92:95]
  s_waitcnt lgkmcnt(4)
  v_exp_f32 v222, v142
  v_mfma_f32_16x16x32_bf16 a[96:99], a[176:179], v[184:187], a[96:99]
  ds_read_b128 a[144:147], v3 offset:12288
  buffer_load_dwordx4 v2, s[48:51], s27 offen offset:3072 sc1 lds
  v_add_f32 v227, v227, v219
  v_cvt_pk_bf16_f32 v181, v218, v219
  v_mfma_f32_16x16x32_bf16 a[100:103], a[176:179], v[188:191], a[100:103]
  s_add_u32 s27, s27, 16384
  v_exp_f32 v223, v143
  v_mfma_f32_16x16x32_bf16 a[104:107], a[180:183], v[184:187], a[104:107]
  s_add_u32 s25, s25, 32768
  ds_read_b128 a[148:151], v3 offset:13312
  v_add_f32 v227, v227, v220
  v_mfma_f32_16x16x32_bf16 a[108:111], a[180:183], v[188:191], a[108:111]
  s_and_b32 s25, s25, 0x1ffff
  v_add_f32 v227, v227, v221
  v_cvt_pk_bf16_f32 v182, v220, v221
  v_add_f32 v227, v227, v222
  v_mfma_f32_16x16x32_bf16 a[112:115], a[184:187], v[184:187], a[112:115]
  ds_read_b128 a[152:155], v3 offset:14336
  v_add_f32 v227, v227, v223
  v_max_f32 v5, v226, v227
  v_cmp_lt_f32 vcc, s81, v5
  v_mfma_f32_16x16x32_bf16 a[116:119], a[184:187], v[188:191], a[116:119]
  v_exp_f32 v216, v144
  v_mfma_f32_16x16x32_bf16 a[120:123], a[188:191], v[184:187], a[120:123]
  s_waitcnt lgkmcnt(3)
  ds_read_b128 a[156:159], v3 offset:15360
  v_cvt_pk_bf16_f32 v183, v222, v223
  v_add_u32 v3, s66, v2
  v_mfma_f32_16x16x32_bf16 a[124:127], a[188:191], v[188:191], a[124:127]
  s_cbranch_vccnz fa_stub13
fa_back13:
  v_exp_f32 v217, v145
  v_add_f32 v230, v230, v226
  v_add_f32 v231, v231, v227
fa_SSW7:
  v_mfma_f32_16x16x32_bf16 v[128:131], a[128:131], v[64:67], v[200:203]
  s_waitcnt vmcnt(12)
  v_exp_f32 v218, v146
  v_mfma_f32_16x16x32_bf16 v[136:139], a[128:131], v[68:71], v[204:207]
  s_barrier
  v_exp_f32 v219, v147
  v_mfma_f32_16x16x32_bf16 v[132:135], a[132:135], v[64:67], v[200:203]
  ds_read_b128 a[160:163], v3 offset:16384
  ds_read_b128 a[164:167], v3 offset:17408
  v_add_f32 v226, v216, v217
  v_mfma_f32_16x16x32_bf16 v[140:143], a[132:135], v[68:71], v[204:207]
  s_mov_b32 m0, s24
  v_exp_f32 v220, v148
  v_mfma_f32_16x16x32_bf16 v[128:131], a[136:139], v[72:75], v[128:131]
  ds_read_b128 a[168:171], v3 offset:18432
  buffer_load_dwordx4 v2, s[44:47], s26 offen offset:0 sc1 lds
  v_cvt_pk_bf16_f32 v184, v216, v217
  v_mfma_f32_16x16x32_bf16 v[136:139], a[136:139], v[76:79], v[136:139]
  v_exp_f32 v221, v149
  v_mfma_f32_16x16x32_bf16 v[132:135], a[140:143], v[72:75], v[132:135]
  ds_read_b128 a[172:175], v3 offset:19456
  v_add_f32 v226, v226, v218
  v_add_f32 v226, v226, v219
  v_mfma_f32_16x16x32_bf16 v[140:143], a[140:143], v[76:79], v[140:143]
  s_waitcnt lgkmcnt(4)
  v_exp_f32 v222, v150
  v_mfma_f32_16x16x32_bf16 v[128:131], a[144:147], v[80:83], v[128:131]
  s_add_u32 s14, s13, 4096
  ds_read_b128 a[176:179], v3 offset:20480
  buffer_load_dwordx4 a[24:27], v2, s[40:43], s14 offen offset:2048 sc1
  v_cvt_pk_bf16_f32 v185, v218, v219
  v_mfma_f32_16x16x32_bf16 v[136:139], a[144:147], v[84:87], v[136:139]
  v_exp_f32 v223, v151
  v_mfma_f32_16x16x32_bf16 v[132:135], a[148:151], v[80:83], v[132:135]
  ds_read_b128 a[180:183], v3 offset:21504
  buffer_load_dwordx4 v2, s[44:47], s26 offen offset:1024 sc1 lds
  v_add_f32 v226, v226, v220
  v_mfma_f32_16x16x32_bf16 v[140:143], a[148:151], v[84:87], v[140:143]
  v_exp_f32 v216, v152
  v_mfma_f32_16x16x32_bf16 v[128:131], a[152:155], v[88:91], v[128:131]
  ds_read_b128 a[184:187], v3 offset:22528
  v_add_f32 v226, v226, v221
  v_cvt_pk_bf16_f32 v186, v220, v221
  v_mfma_f32_16x16x32_bf16 v[136:139], a[152:155], v[92:95], v[136:139]
  v_exp_f32 v217, v153
  v_mfma_f32_16x16x32_bf16 v[132:135], a[156:159], v[88:91], v[132:135]
  ds_read_b128 a[188:191], v3 offset:23552
  buffer_load_dwordx4 a[28:31], v2, s[40:43], s14 offen offset:3072 sc1
  v_add_f32 v226, v226, v222
  v_mfma_f32_16x16x32_bf16 v[140:143], a[156:159], v[92:95], v[140:143]
  s_waitcnt lgkmcnt(4)
  v_exp_f32 v218, v154
  v_mfma_f32_16x16x32_bf16 a[64:67], a[160:163], v[176:179], a[64:67]
  ds_read_b128 a[128:131], v3 offset:0
  v_add_f32 v226, v226, v223
  v_cvt_pk_bf16_f32 v187, v222, v223
  v_mfma_f32_16x16x32_bf16 a[68:71], a[160:163], v[180:183], a[68:71]
  v_exp_f32 v219, v155
  v_mfma_f32_16x16x32_bf16 a[72:75], a[164:167], v[176:179], a[72:75]
  ds_read_b128 a[132:135], v3 offset:1024
  buffer_load_dwordx4 v2, s[44:47], s26 offen offset:2048 sc1 lds
  v_add_f32 v227, v216, v217
  v_mfma_f32_16x16x32_bf16 a[76:79], a[164:167], v[180:183], a[76:79]
  v_exp_f32 v220, v156
  v_mfma_f32_16x16x32_bf16 a[80:83], a[168:171], v[176:179], a[80:83]
  ds_read_b128 a[136:139], v3 offset:2048
  v_cvt_pk_bf16_f32 v188, v216, v217
  v_mfma_f32_16x16x32_bf16 a[84:87], a[168:171], v[180:183], a[84:87]
  v_exp_f32 v221, v157
  v_mfma_f32_16x16x32_bf16 a[88:91], a[172:175], v[176:179], a[88:91]
  s_add_u32 s14, s13, 8192
  ds_read_b128 a[140:143], v3 offset:3072
  buffer_load_dwordx4 a[32:35], v2, s[40:43], s14 offen offset:0 sc1
  v_add_f32 v227, v227, v218
  v_add_f32 v227, v227, v219
  v_mfma_f32_16x16x32_bf16 a[92:95], a[172:175], v[180:183], a[92:95]
  s_waitcnt lgkmcnt(4)
  v_exp_f32 v222, v158
  v_mfma_f32_16x16x32_bf16 a[96:99], a[176:179], v[176:179], a[96:99]
  ds_read_b128 a[144:147], v3 offset:4096
  buffer_load_dwordx4 v2, s[44:47], s26 offen offset:3072 sc1 lds
  v_cvt_pk_bf16_f32 v189, v218, v219
  v_mfma_f32_16x16x32_bf16 a[100:103], a[176:179], v[180:183], a[100:103]
  s_add_u32 s26, s26, 16384
  v_exp_f32 v223, v159
  v_mfma_f32_16x16x32_bf16 a[104:107], a[180:183], v[176:179], a[104:107]
  s_add_u32 s24, s24, 32768
  ds_read_b128 a[148:151], v3 offset:5120
  v_add_f32 v227, v227, v220
  v_mfma_f32_16x16x32_bf16 a[108:111], a[180:183], v[180:183], a[108:111]
  s_and_b32 s24, s24, 0x1ffff
  v_add_f32 v227, v227, v221
  v_cvt_pk_bf16_f32 v190, v220, v221
  v_add_f32 v227, v227, v222
  v_mfma_f32_16x16x32_bf16 a[112:115], a[184:187], v[176:179], a[112:115]
  ds_read_b128 a[152:155], v3 offset:6144
  v_add_f32 v227, v227, v223
  v_max_f32 v5, v226, v227
  v_cmp_lt_f32 vcc, s81, v5
  v_mfma_f32_16x16x32_bf16 a[116:119], a[184:187], v[180:183], a[116:119]
  v_exp_f32 v216, v128
  v_mfma_f32_16x16x32_bf16 a[120:123], a[188:191], v[176:179], a[120:123]
  s_waitcnt lgkmcnt(3)
  ds_read_b128 a[156:159], v3 offset:7168
  v_cvt_pk_bf16_f32 v191, v222, v223
  v_mfma_f32_16x16x32_bf16 a[124:127], a[188:191], v[180:183], a[124:127]
  s_cbranch_vccnz fa_stub14
fa_back14:
  v_exp_f32 v217, v129
  v_add_f32 v230, v230, v226
  v_add_f32 v231, v231, v227
  v_mfma_f32_16x16x32_bf16 v[144:147], a[128:131], v[64:67], v[200:203]
  ds_read_b128 a[160:163], v3 offset:24576
  v_add_f32 v226, v216, v217
  v_mfma_f32_16x16x32_bf16 v[152:155], a[128:131], v[68:71], v[204:207]
  v_exp_f32 v218, v130
  v_mfma_f32_16x16x32_bf16 v[148:151], a[132:135], v[64:67], v[200:203]
  s_add_u32 s66, s66, 32768
  ds_read_b128 a[164:167], v3 offset:25600
  v_cvt_pk_bf16_f32 v176, v216, v217
  v_mfma_f32_16x16x32_bf16 v[156:159], a[132:135], v[68:71], v[204:207]
  s_mov_b32 m0, s25
  v_exp_f32 v219, v131
  v_mfma_f32_16x16x32_bf16 v[144:147], a[136:139], v[72:75], v[144:147]
  s_and_b32 s66, s66, 0x1ffff
  ds_read_b128 a[168:171], v3 offset:26624
  buffer_load_dwordx4 v2, s[48:51], s27 offen offset:0 sc1 lds
  v_add_f32 v226, v226, v218
  v_add_f32 v226, v226, v219
  v_mfma_f32_16x16x32_bf16 v[152:155], a[136:139], v[76:79], v[152:155]
  v_exp_f32 v220, v132
  v_mfma_f32_16x16x32_bf16 v[148:151], a[140:143], v[72:75], v[148:151]
  ds_read_b128 a[172:175], v3 offset:27648
  v_cvt_pk_bf16_f32 v177, v218, v219
  v_mfma_f32_16x16x32_bf16 v[156:159], a[140:143], v[76:79], v[156:159]
  s_waitcnt lgkmcnt(4)
  v_exp_f32 v221, v133
  v_mfma_f32_16x16x32_bf16 v[144:147], a[144:147], v[80:83], v[144:147]
  s_add_u32 s14, s13, 8192
  ds_read_b128 a[176:179], v3 offset:28672
  buffer_load_dwordx4 a[36:39], v2, s[40:43], s14 offen offset:1024 sc1
  v_add_f32 v226, v226, v220
  v_mfma_f32_16x16x32_bf16 v[152:155], a[144:147], v[84:87], v[152:155]
  v_exp_f32 v222, v134
  v_mfma_f32_16x16x32_bf16 v[148:151], a[148:151], v[80:83], v[148:151]
  ds_read_b128 a[180:183], v3 offset:29696
  buffer_load_dwordx4 v2, s[48:51], s27 offen offset:1024 sc1 lds
  v_add_f32 v226, v226, v221
  v_cvt_pk_bf16_f32 v178, v220, v221
  v_mfma_f32_16x16x32_bf16 v[156:159], a[148:151], v[84:87], v[156:159]
  v_exp_f32 v223, v135
  v_mfma_f32_16x16x32_bf16 v[144:147], a[152:155], v[88:91], v[144:147]
  ds_read_b128 a[184:187], v3 offset:30720
  v_add_f32 v226, v226, v222
  v_mfma_f32_16x16x32_bf16 v[152:155], a[152:155], v[92:95], v[152:155]
  v_exp_f32 v216, v136
  v_mfma_f32_16x16x32_bf16 v[148:151], a[156:159], v[88:91], v[148:151]
  ds_read_b128 a[188:191], v3 offset:31744
  buffer_load_dwordx4 a[40:43], v2, s[40:43], s14 offen offset:2048 sc1
  v_add_f32 v226, v226, v223
  v_exp_f32 v217, v137
  v_mfma_f32_16x16x32_bf16 v[156:159], a[156:159], v[92:95], v[156:159]
  s_waitcnt lgkmcnt(4)
  v_exp_f32 v218, v138
  v_mfma_f32_16x16x32_bf16 a[64:67], a[160:163], v[184:187], a[64:67]
  ds_read_b128 a[128:131], v3 offset:8192
  v_cvt_pk_bf16_f32 v179, v222, v223
  v_mfma_f32_16x16x32_bf16 a[68:71], a[160:163], v[188:191], a[68:71]
  v_exp_f32 v219, v139
  v_mfma_f32_16x16x32_bf16 a[72:75], a[164:167], v[184:187], a[72:75]
  ds_read_b128 a[132:135], v3 offset:9216
  buffer_load_dwordx4 v2, s[48:51], s27 offen offset:2048 sc1 lds
  v_add_f32 v227, v216, v217
  v_mfma_f32_16x16x32_bf16 a[76:79], a[164:167], v[188:191], a[76:79]
  v_exp_f32 v220, v140
  v_mfma_f32_16x16x32_bf16 a[80:83], a[168:171], v[184:187], a[80:83]
  ds_read_b128 a[136:139], v3 offset:10240
  v_cvt_pk_bf16_f32 v180, v216, v217
  v_mfma_f32_16x16x32_bf16 a[84:87], a[168:171], v[188:191], a[84:87]
  v_exp_f32 v221, v141
  v_mfma_f32_16x16x32_bf16 a[88:91], a[172:175], v[184:187], a[88:91]
  ds_read_b128 a[140:143], v3 offset:11264
  buffer_load_dwordx4 a[44:47], v2, s[40:43], s14 offen offset:3072 sc1
  v_add_f32 v227, v227, v218
  v_mfma_f32_16x16x32_bf16 a[92:95], a[172:175], v[188:191], a[92:95]
  s_waitcnt lgkmcnt(4)
  v_exp_f32 v222, v142
  v_mfma_f32_16x16x32_bf16 a[96:99], a[176:179], v[184:187], a[96:99]
  ds_read_b128 a[144:147], v3 offset:12288
  buffer_load_dwordx4 v2, s[48:51], s27 offen offset:3072 sc1 lds
  v_add_f32 v227, v227, v219
  v_cvt_pk_bf16_f32 v181, v218, v219
  v_mfma_f32_16x16x32_bf16 a[100:103], a[176:179], v[188:191], a[100:103]
  s_add_u32 s27, s27, 16384
  v_exp_f32 v223, v143
  v_mfma_f32_16x16x32_bf16 a[104:107], a[180:183], v[184:187], a[104:107]
  s_add_u32 s25, s25, 32768
  ds_read_b128 a[148:151], v3 offset:13312
  v_add_f32 v227, v227, v220
  v_mfma_f32_16x16x32_bf16 a[108:111], a[180:183], v[188:191], a[108:111]
  s_and_b32 s25, s25, 0x1ffff
  v_add_f32 v227, v227, v221
  v_cvt_pk_bf16_f32 v182, v220, v221
  v_add_f32 v227, v227, v222
  v_mfma_f32_16x16x32_bf16 a[112:115], a[184:187], v[184:187], a[112:115]
  ds_read_b128 a[152:155], v3 offset:14336
  v_add_f32 v227, v227, v223
  v_max_f32 v5, v226, v227
  v_cmp_lt_f32 vcc, s81, v5
  v_mfma_f32_16x16x32_bf16 a[116:119], a[184:187], v[188:191], a[116:119]
  v_exp_f32 v216, v144
  v_mfma_f32_16x16x32_bf16 a[120:123], a[188:191], v[184:187], a[120:123]
  s_waitcnt lgkmcnt(3)
  ds_read_b128 a[156:159], v3 offset:15360
  v_cvt_pk_bf16_f32 v183, v222, v223
  v_add_u32 v3, s66, v2
  v_mfma_f32_16x16x32_bf16 a[124:127], a[188:191], v[188:191], a[124:127]
  s_cbranch_vccnz fa_stub15
fa_back15:
  v_exp_f32 v217, v145
  v_add_f32 v230, v230, v226
  v_add_f32 v231, v231, v227
fa_SSW6:
  v_mfma_f32_16x16x32_bf16 v[128:131], a[128:131], v[64:67], v[200:203]
  s_waitcnt vmcnt(12)
  v_exp_f32 v218, v146
  v_mfma_f32_16x16x32_bf16 v[136:139], a[128:131], v[68:71], v[204:207]
  s_barrier
  v_exp_f32 v219, v147
  v_mfma_f32_16x16x32_bf16 v[132:135], a[132:135], v[64:67], v[200:203]
  ds_read_b128 a[160:163], v3 offset:16384
  ds_read_b128 a[164:167], v3 offset:17408
  v_add_f32 v226, v216, v217
  v_mfma_f32_16x16x32_bf16 v[140:143], a[132:135], v[68:71], v[204:207]
  s_mov_b32 m0, s24
  v_exp_f32 v220, v148
  v_mfma_f32_16x16x32_bf16 v[128:131], a[136:139], v[72:75], v[128:131]
  ds_read_b128 a[168:171], v3 offset:18432
  buffer_load_dwordx4 v2, s[44:47], s26 offen offset:0 sc1 lds
  v_cvt_pk_bf16_f32 v184, v216, v217
  v_mfma_f32_16x16x32_bf16 v[136:139], a[136:139], v[76:79], v[136:139]
  v_exp_f32 v221, v149
  v_mfma_f32_16x16x32_bf16 v[132:135], a[140:143], v[72:75], v[132:135]
  ds_read_b128 a[172:175], v3 offset:19456
  v_add_f32 v226, v226, v218
  v_add_f32 v226, v226, v219
  v_mfma_f32_16x16x32_bf16 v[140:143], a[140:143], v[76:79], v[140:143]
  s_waitcnt lgkmcnt(4)
  v_exp_f32 v222, v150
  v_mfma_f32_16x16x32_bf16 v[128:131], a[144:147], v[80:83], v[128:131]
  s_add_u32 s14, s13, 12288
  ds_read_b128 a[176:179], v3 offset:20480
  buffer_load_dwordx4 a[48:51], v2, s[40:43], s14 offen offset:0 sc1
  v_cvt_pk_bf16_f32 v185, v218, v219
  v_mfma_f32_16x16x32_bf16 v[136:139], a[144:147], v[84:87], v[136:139]
  v_exp_f32 v223, v151
  v_mfma_f32_16x16x32_bf16 v[132:135], a[148:151], v[80:83], v[132:135]
  ds_read_b128 a[180:183], v3 offset:21504
  buffer_load_dwordx4 v2, s[44:47], s26 offen offset:1024 sc1 lds
  v_add_f32 v226, v226, v220
  v_mfma_f32_16x16x32_bf16 v[140:143], a[148:151], v[84:87], v[140:143]
  v_exp_f32 v216, v152
  v_mfma_f32_16x16x32_bf16 v[128:131], a[152:155], v[88:91], v[128:131]
  ds_read_b128 a[184:187], v3 offset:22528
  v_add_f32 v226, v226, v221
  v_cvt_pk_bf16_f32 v186, v220, v221
  v_mfma_f32_16x16x32_bf16 v[136:139], a[152:155], v[92:95], v[136:139]
  v_exp_f32 v217, v153
  v_mfma_f32_16x16x32_bf16 v[132:135], a[156:159], v[88:91], v[132:135]
  ds_read_b128 a[188:191], v3 offset:23552
  buffer_load_dwordx4 a[52:55], v2, s[40:43], s14 offen offset:1024 sc1
  v_add_f32 v226, v226, v222
  v_mfma_f32_16x16x32_bf16 v[140:143], a[156:159], v[92:95], v[140:143]
  s_waitcnt lgkmcnt(4)
  v_exp_f32 v218, v154
  v_mfma_f32_16x16x32_bf16 a[64:67], a[160:163], v[176:179], a[64:67]
  ds_read_b128 a[128:131], v3 offset:0
  v_add_f32 v226, v226, v223
  v_cvt_pk_bf16_f32 v187, v222, v223
  v_mfma_f32_16x16x32_bf16 a[68:71], a[160:163], v[180:183], a[68:71]
  v_exp_f32 v219, v155
  v_mfma_f32_16x16x32_bf16 a[72:75], a[164:167], v[176:179], a[72:75]
  ds_read_b128 a[132:135], v3 offset:1024
  buffer_load_dwordx4 v2, s[44:47], s26 offen offset:2048 sc1 lds
  v_add_f32 v227, v216, v217
  v_mfma_f32_16x16x32_bf16 a[76:79], a[164:167], v[180:183], a[76:79]
  v_exp_f32 v220, v156
  v_mfma_f32_16x16x32_bf16 a[80:83], a[168:171], v[176:179], a[80:83]
  ds_read_b128 a[136:139], v3 offset:2048
  v_cvt_pk_bf16_f32 v188, v216, v217
  v_mfma_f32_16x16x32_bf16 a[84:87], a[168:171], v[180:183], a[84:87]
  v_exp_f32 v221, v157
  v_mfma_f32_16x16x32_bf16 a[88:91], a[172:175], v[176:179], a[88:91]
  ds_read_b128 a[140:143], v3 offset:3072
  buffer_load_dwordx4 a[56:59], v2, s[40:43], s14 offen offset:2048 sc1
  v_add_f32 v227, v227, v218
  v_add_f32 v227, v227, v219
  v_mfma_f32_16x16x32_bf16 a[92:95], a[172:175], v[180:183], a[92:95]
  s_waitcnt lgkmcnt(4)
  v_exp_f32 v222, v158
  v_mfma_f32_16x16x32_bf16 a[96:99], a[176:179], v[176:179], a[96:99]
  ds_read_b128 a[144:147], v3 offset:4096
  buffer_load_dwordx4 v2, s[44:47], s26 offen offset:3072 sc1 lds
  v_cvt_pk_bf16_f32 v189, v218, v219
  v_mfma_f32_16x16x32_bf16 a[100:103], a[176:179], v[180:183], a[100:103]
  s_add_u32 s26, s26, 16384
  v_exp_f32 v223, v159
  v_mfma_f32_16x16x32_bf16 a[104:107], a[180:183], v[176:179], a[104:107]
  s_add_u32 s24, s24, 32768
  ds_read_b128 a[148:151], v3 offset:5120
  v_add_f32 v227, v227, v220
  v_mfma_f32_16x16x32_bf16 a[108:111], a[180:183], v[180:183], a[108:111]
  s_and_b32 s24, s24, 0x1ffff
  v_add_f32 v227, v227, v221
  v_cvt_pk_bf16_f32 v190, v220, v221
  v_add_f32 v227, v227, v222
  v_mfma_f32_16x16x32_bf16 a[112:115], a[184:187], v[176:179], a[112:115]
  ds_read_b128 a[152:155], v3 offset:6144
  v_add_f32 v227, v227, v223
  v_max_f32 v5, v226, v227
  v_cmp_lt_f32 vcc, s81, v5
  v_mfma_f32_16x16x32_bf16 a[116:119], a[184:187], v[180:183], a[116:119]
  v_exp_f32 v216, v128
  v_mfma_f32_16x16x32_bf16 a[120:123], a[188:191], v[176:179], a[120:123]
  s_waitcnt lgkmcnt(3)
  ds_read_b128 a[156:159], v3 offset:7168
  v_cvt_pk_bf16_f32 v191, v222, v223
  v_mfma_f32_16x16x32_bf16 a[124:127], a[188:191], v[180:183], a[124:127]
  s_cbranch_vccnz fa_stub16
fa_back16:
  v_exp_f32 v217, v129
  v_add_f32 v230, v230, v226
  v_add_f32 v231, v231, v227
  v_mfma_f32_16x16x32_bf16 v[144:147], a[128:131], v[64:67], v[200:203]
  ds_read_b128 a[160:163], v3 offset:24576
  v_add_f32 v226, v216, v217
  v_mfma_f32_16x16x32_bf16 v[152:155], a[128:131], v[68:71], v[204:207]
  v_exp_f32 v218, v130
  v_mfma_f32_16x16x32_bf16 v[148:151], a[132:135], v[64:67], v[200:203]
  s_add_u32 s66, s66, 32768
  ds_read_b128 a[164:167], v3 offset:25600
  v_cvt_pk_bf16_f32 v176, v216, v217
  v_mfma_f32_16x16x32_bf16 v[156:159], a[132:135], v[68:71], v[204:207]
  s_mov_b32 m0, s25
  v_exp_f32 v219, v131
  v_mfma_f32_16x16x32_bf16 v[144:147], a[136:139], v[72:75], v[144:147]
  s_and_b32 s66, s66, 0x1ffff
  ds_read_b128 a[168:171], v3 offset:26624
  buffer_load_dwordx4 v2, s[48:51], s27 offen offset:0 sc1 lds
  v_add_f32 v226, v226, v218
  v_add_f32 v226, v226, v219
  v_mfma_f32_16x16x32_bf16 v[152:155], a[136:139], v[76:79], v[152:155]
  v_exp_f32 v220, v132
  v_mfma_f32_16x16x32_bf16 v[148:151], a[140:143], v[72:75], v[148:151]
  ds_read_b128 a[172:175], v3 offset:27648
  v_cvt_pk_bf16_f32 v177, v218, v219
  v_mfma_f32_16x16x32_bf16 v[156:159], a[140:143], v[76:79], v[156:159]
  s_waitcnt lgkmcnt(4)
  v_exp_f32 v221, v133
  v_mfma_f32_16x16x32_bf16 v[144:147], a[144:147], v[80:83], v[144:147]
  s_add_u32 s14, s13, 12288
  ds_read_b128 a[176:179], v3 offset:28672
  buffer_load_dwordx4 a[60:63], v2, s[40:43], s14 offen offset:3072 sc1
  v_add_f32 v226, v226, v220
  v_mfma_f32_16x16x32_bf16 v[152:155], a[144:147], v[84:87], v[152:155]
  v_exp_f32 v222, v134
  v_mfma_f32_16x16x32_bf16 v[148:151], a[148:151], v[80:83], v[148:151]
  ds_read_b128 a[180:183], v3 offset:29696
  buffer_load_dwordx4 v2, s[48:51], s27 offen offset:1024 sc1 lds
  v_add_f32 v226, v226, v221
  v_cvt_pk_bf16_f32 v178, v220, v221
  v_mfma_f32_16x16x32_bf16 v[156:159], a[148:151], v[84:87], v[156:159]
  v_exp_f32 v223, v135
  v_mfma_f32_16x16x32_bf16 v[144:147], a[152:155], v[88:91], v[144:147]
  ds_read_b128 a[184:187], v3 offset:30720
  v_add_f32 v226, v226, v222
  v_mfma_f32_16x16x32_bf16 v[152:155], a[152:155], v[92:95], v[152:155]
  v_exp_f32 v216, v136
  v_mfma_f32_16x16x32_bf16 v[148:151], a[156:159], v[88:91], v[148:151]
  s_add_u32 s14, s13, 16384
  ds_read_b128 a[188:191], v3 offset:31744
  buffer_load_dwordx4 a[192:195], v2, s[40:43], s14 offen offset:0 sc1
  v_add_f32 v226, v226, v223
  v_exp_f32 v217, v137
  v_mfma_f32_16x16x32_bf16 v[156:159], a[156:159], v[92:95], v[156:159]
  s_waitcnt lgkmcnt(4)
  v_exp_f32 v218, v138
  v_mfma_f32_16x16x32_bf16 a[64:67], a[160:163], v[184:187], a[64:67]
  ds_read_b128 a[128:131], v3 offset:8192
  v_cvt_pk_bf16_f32 v179, v222, v223
  v_mfma_f32_16x16x32_bf16 a[68:71], a[160:163], v[188:191], a[68:71]
  v_exp_f32 v219, v139
  v_mfma_f32_16x16x32_bf16 a[72:75], a[164:167], v[184:187], a[72:75]
  ds_read_b128 a[132:135], v3 offset:9216
  buffer_load_dwordx4 v2, s[48:51], s27 offen offset:2048 sc1 lds
  v_add_f32 v227, v216, v217
  v_mfma_f32_16x16x32_bf16 a[76:79], a[164:167], v[188:191], a[76:79]
  v_exp_f32 v220, v140
  v_mfma_f32_16x16x32_bf16 a[80:83], a[168:171], v[184:187], a[80:83]
  ds_read_b128 a[136:139], v3 offset:10240
  v_cvt_pk_bf16_f32 v180, v216, v217
  v_mfma_f32_16x16x32_bf16 a[84:87], a[168:171], v[188:191], a[84:87]
  v_exp_f32 v221, v141
  v_mfma_f32_16x16x32_bf16 a[88:91], a[172:175], v[184:187], a[88:91]
  ds_read_b128 a[140:143], v3 offset:11264
  buffer_load_dwordx4 a[196:199], v2, s[40:43], s14 offen offset:1024 sc1
  v_add_f32 v227, v227, v218
  v_mfma_f32_16x16x32_bf16 a[92:95], a[172:175], v[188:191], a[92:95]
  s_waitcnt lgkmcnt(4)
  v_exp_f32 v222, v142
  v_mfma_f32_16x16x32_bf16 a[96:99], a[176:179], v[184:187], a[96:99]
  ds_read_b128 a[144:147], v3 offset:12288
  buffer_load_dwordx4 v2, s[48:51], s27 offen offset:3072 sc1 lds
  v_add_f32 v227, v227, v219
  v_cvt_pk_bf16_f32 v181, v218, v219
  v_mfma_f32_16x16x32_bf16 a[100:103], a[176:179], v[188:191], a[100:103]
  s_add_u32 s27, s27, 16384
  v_exp_f32 v223, v143
  v_mfma_f32_16x16x32_bf16 a[104:107], a[180:183], v[184:187], a[104:107]
  s_add_u32 s25, s25, 32768
  ds_read_b128 a[148:151], v3 offset:13312
  v_add_f32 v227, v227, v220
  v_mfma_f32_16x16x32_bf16 a[108:111], a[180:183], v[188:191], a[108:111]
  s_and_b32 s25, s25, 0x1ffff
  v_add_f32 v227, v227, v221
  v_cvt_pk_bf16_f32 v182, v220, v221
  v_add_f32 v227, v227, v222
  v_mfma_f32_16x16x32_bf16 a[112:115], a[184:187], v[184:187], a[112:115]
  ds_read_b128 a[152:155], v3 offset:14336
  v_add_f32 v227, v227, v223
  v_max_f32 v5, v226, v227
  v_cmp_lt_f32 vcc, s81, v5
  v_mfma_f32_16x16x32_bf16 a[116:119], a[184:187], v[188:191], a[116:119]
  v_exp_f32 v216, v144
  v_mfma_f32_16x16x32_bf16 a[120:123], a[188:191], v[184:187], a[120:123]
  s_waitcnt lgkmcnt(3)
  ds_read_b128 a[156:159], v3 offset:15360
  v_cvt_pk_bf16_f32 v183, v222, v223
  v_add_u32 v3, s66, v2
  v_mfma_f32_16x16x32_bf16 a[124:127], a[188:191], v[188:191], a[124:127]
  s_cbranch_vccnz fa_stub17
fa_back17:
  v_exp_f32 v217, v145
  v_add_f32 v230, v230, v226
  v_add_f32 v231, v231, v227
fa_SSW5:
  v_mfma_f32_16x16x32_bf16 v[128:131], a[128:131], v[64:67], v[200:203]
  s_waitcnt vmcnt(12)
  v_exp_f32 v218, v146
  v_mfma_f32_16x16x32_bf16 v[136:139], a[128:131], v[68:71], v[204:207]
  s_barrier
  v_exp_f32 v219, v147
  v_mfma_f32_16x16x32_bf16 v[132:135], a[132:135], v[64:67], v[200:203]
  ds_read_b128 a[160:163], v3 offset:16384
  ds_read_b128 a[164:167], v3 offset:17408
  v_add_f32 v226, v216, v217
  v_mfma_f32_16x16x32_bf16 v[140:143], a[132:135], v[68:71], v[204:207]
  s_mov_b32 m0, s24
  v_exp_f32 v220, v148
  v_mfma_f32_16x16x32_bf16 v[128:131], a[136:139], v[72:75], v[128:131]
  ds_read_b128 a[168:171], v3 offset:18432
  buffer_load_dwordx4 v2, s[44:47], s26 offen offset:0 sc1 lds
  v_cvt_pk_bf16_f32 v184, v216, v217
  v_mfma_f32_16x16x32_bf16 v[136:139], a[136:139], v[76:79], v[136:139]
  v_exp_f32 v221, v149
  v_mfma_f32_16x16x32_bf16 v[132:135], a[140:143], v[72:75], v[132:135]
  ds_read_b128 a[172:175], v3 offset:19456
  v_add_f32 v226, v226, v218
  v_add_f32 v226, v226, v219
  v_mfma_f32_16x16x32_bf16 v[140:143], a[140:143], v[76:79], v[140:143]
  s_waitcnt lgkmcnt(4)
  v_exp_f32 v222, v150
  v_mfma_f32_16x16x32_bf16 v[128:131], a[144:147], v[80:83], v[128:131]
  s_add_u32 s14, s13, 16384
  ds_read_b128 a[176:179], v3 offset:20480
  buffer_load_dwordx4 a[200:203], v2, s[40:43], s14 offen offset:2048 sc1
  v_cvt_pk_bf16_f32 v185, v218, v219
  v_mfma_f32_16x16x32_bf16 v[136:139], a[144:147], v[84:87], v[136:139]
  v_exp_f32 v223, v151
  v_mfma_f32_16x16x32_bf16 v[132:135], a[148:151], v[80:83], v[132:135]
  ds_read_b128 a[180:183], v3 offset:21504
  buffer_load_dwordx4 v2, s[44:47], s26 offen offset:1024 sc1 lds
  v_add_f32 v226, v226, v220
  v_mfma_f32_16x16x32_bf16 v[140:143], a[148:151], v[84:87], v[140:143]
  v_exp_f32 v216, v152
  v_mfma_f32_16x16x32_bf16 v[128:131], a[152:155], v[88:91], v[128:131]
  ds_read_b128 a[184:187], v3 offset:22528
  v_add_f32 v226, v226, v221
  v_cvt_pk_bf16_f32 v186, v220, v221
  v_mfma_f32_16x16x32_bf16 v[136:139], a[152:155], v[92:95], v[136:139]
  v_exp_f32 v217, v153
  v_mfma_f32_16x16x32_bf16 v[132:135], a[156:159], v[88:91], v[132:135]
  ds_read_b128 a[188:191], v3 offset:23552
  buffer_load_dwordx4 a[204:207], v2, s[40:43], s14 offen offset:3072 sc1
  v_add_f32 v226, v226, v222
  v_mfma_f32_16x16x32_bf16 v[140:143], a[156:159], v[92:95], v[140:143]
  s_waitcnt lgkmcnt(4)
  v_exp_f32 v218, v154
  v_mfma_f32_16x16x32_bf16 a[64:67], a[160:163], v[176:179], a[64:67]
  ds_read_b128 a[128:131], v3 offset:0
  v_add_f32 v226, v226, v223
  v_cvt_pk_bf16_f32 v187, v222, v223
  v_mfma_f32_16x16x32_bf16 a[68:71], a[160:163], v[180:183], a[68:71]
  v_exp_f32 v219, v155
  v_mfma_f32_16x16x32_bf16 a[72:75], a[164:167], v[176:179], a[72:75]
  ds_read_b128 a[132:135], v3 offset:1024
  buffer_load_dwordx4 v2, s[44:47], s26 offen offset:2048 sc1 lds
  v_add_f32 v227, v216, v217
  v_mfma_f32_16x16x32_bf16 a[76:79], a[164:167], v[180:183], a[76:79]
  v_exp_f32 v220, v156
  v_mfma_f32_16x16x32_bf16 a[80:83], a[168:171], v[176:179], a[80:83]
  ds_read_b128 a[136:139], v3 offset:2048
  v_cvt_pk_bf16_f32 v188, v216, v217
  v_mfma_f32_16x16x32_bf16 a[84:87], a[168:171], v[180:183], a[84:87]
  v_exp_f32 v221, v157
  v_mfma_f32_16x16x32_bf16 a[88:91], a[172:175], v[176:179], a[88:91]
  s_add_u32 s14, s13, 20480
  ds_read_b128 a[140:143], v3 offset:3072
  buffer_load_dwordx4 a[208:211], v2, s[40:43], s14 offen offset:0 sc1
  v_add_f32 v227, v227, v218
  v_add_f32 v227, v227, v219
  v_mfma_f32_16x16x32_bf16 a[92:95], a[172:175], v[180:183], a[92:95]
  s_waitcnt lgkmcnt(4)
  v_exp_f32 v222, v158
  v_mfma_f32_16x16x32_bf16 a[96:99], a[176:179], v[176:179], a[96:99]
  ds_read_b128 a[144:147], v3 offset:4096
  buffer_load_dwordx4 v2, s[44:47], s26 offen offset:3072 sc1 lds
  v_cvt_pk_bf16_f32 v189, v218, v219
  v_mfma_f32_16x16x32_bf16 a[100:103], a[176:179], v[180:183], a[100:103]
  s_add_u32 s26, s26, 16384
  v_exp_f32 v223, v159
  v_mfma_f32_16x16x32_bf16 a[104:107], a[180:183], v[176:179], a[104:107]
  s_add_u32 s24, s24, 32768
  ds_read_b128 a[148:151], v3 offset:5120
  v_add_f32 v227, v227, v220
  v_mfma_f32_16x16x32_bf16 a[108:111], a[180:183], v[180:183], a[108:111]
  s_and_b32 s24, s24, 0x1ffff
  v_add_f32 v227, v227, v221
  v_cvt_pk_bf16_f32 v190, v220, v221
  v_add_f32 v227, v227, v222
  v_mfma_f32_16x16x32_bf16 a[112:115], a[184:187], v[176:179], a[112:115]
  ds_read_b128 a[152:155], v3 offset:6144
  v_add_f32 v227, v227, v223
  v_max_f32 v5, v226, v227
  v_cmp_lt_f32 vcc, s81, v5
  v_mfma_f32_16x16x32_bf16 a[116:119], a[184:187], v[180:183], a[116:119]
  v_exp_f32 v216, v128
  v_mfma_f32_16x16x32_bf16 a[120:123], a[188:191], v[176:179], a[120:123]
  s_waitcnt lgkmcnt(3)
  ds_read_b128 a[156:159], v3 offset:7168
  v_cvt_pk_bf16_f32 v191, v222, v223
  v_mfma_f32_16x16x32_bf16 a[124:127], a[188:191], v[180:183], a[124:127]
  s_cbranch_vccnz fa_stub18
fa_back18:
  v_exp_f32 v217, v129
  v_add_f32 v230, v230, v226
  v_add_f32 v231, v231, v227
  v_mfma_f32_16x16x32_bf16 v[144:147], a[128:131], v[64:67], v[200:203]
  ds_read_b128 a[160:163], v3 offset:24576
  v_add_f32 v226, v216, v217
  v_mfma_f32_16x16x32_bf16 v[152:155], a[128:131], v[68:71], v[204:207]
  v_exp_f32 v218, v130
  v_mfma_f32_16x16x32_bf16 v[148:151], a[132:135], v[64:67], v[200:203]
  s_add_u32 s66, s66, 32768
  ds_read_b128 a[164:167], v3 offset:25600
  v_cvt_pk_bf16_f32 v176, v216, v217
  v_mfma_f32_16x16x32_bf16 v[156:159], a[132:135], v[68:71], v[204:207]
  s_mov_b32 m0, s25
  v_exp_f32 v219, v131
  v_mfma_f32_16x16x32_bf16 v[144:147], a[136:139], v[72:75], v[144:147]
  s_and_b32 s66, s66, 0x1ffff
  ds_read_b128 a[168:171], v3 offset:26624
  buffer_load_dwordx4 v2, s[48:51], s27 offen offset:0 sc1 lds
  v_add_f32 v226, v226, v218
  v_add_f32 v226, v226, v219
  v_mfma_f32_16x16x32_bf16 v[152:155], a[136:139], v[76:79], v[152:155]
  v_exp_f32 v220, v132
  v_mfma_f32_16x16x32_bf16 v[148:151], a[140:143], v[72:75], v[148:151]
  ds_read_b128 a[172:175], v3 offset:27648
  v_cvt_pk_bf16_f32 v177, v218, v219
  v_mfma_f32_16x16x32_bf16 v[156:159], a[140:143], v[76:79], v[156:159]
  s_waitcnt lgkmcnt(4)
  v_exp_f32 v221, v133
  v_mfma_f32_16x16x32_bf16 v[144:147], a[144:147], v[80:83], v[144:147]
  s_add_u32 s14, s13, 20480
  ds_read_b128 a[176:179], v3 offset:28672
  buffer_load_dwordx4 a[212:215], v2, s[40:43], s14 offen offset:1024 sc1
  v_add_f32 v226, v226, v220
  v_mfma_f32_16x16x32_bf16 v[152:155], a[144:147], v[84:87], v[152:155]
  v_exp_f32 v222, v134
  v_mfma_f32_16x16x32_bf16 v[148:151], a[148:151], v[80:83], v[148:151]
  ds_read_b128 a[180:183], v3 offset:29696
  buffer_load_dwordx4 v2, s[48:51], s27 offen offset:1024 sc1 lds
  v_add_f32 v226, v226, v221
  v_cvt_pk_bf16_f32 v178, v220, v221
  v_mfma_f32_16x16x32_bf16 v[156:159], a[148:151], v[84:87], v[156:159]
  v_exp_f32 v223, v135
  v_mfma_f32_16x16x32_bf16 v[144:147], a[152:155], v[88:91], v[144:147]
  ds_read_b128 a[184:187], v3 offset:30720
  v_add_f32 v226, v226, v222
  v_mfma_f32_16x16x32_bf16 v[152:155], a[152:155], v[92:95], v[152:155]
  v_exp_f32 v216, v136
  v_mfma_f32_16x16x32_bf16 v[148:151], a[156:159], v[88:91], v[148:151]
  ds_read_b128 a[188:191], v3 offset:31744
  buffer_load_dwordx4 a[216:219], v2, s[40:43], s14 offen offset:2048 sc1
  v_add_f32 v226, v226, v223
  v_exp_f32 v217, v137
  v_mfma_f32_16x16x32_bf16 v[156:159], a[156:159], v[92:95], v[156:159]
  s_waitcnt lgkmcnt(4)
  v_exp_f32 v218, v138
  v_mfma_f32_16x16x32_bf16 a[64:67], a[160:163], v[184:187], a[64:67]
  ds_read_b128 a[128:131], v3 offset:8192
  v_cvt_pk_bf16_f32 v179, v222, v223
  v_mfma_f32_16x16x32_bf16 a[68:71], a[160:163], v[188:191], a[68:71]
  v_exp_f32 v219, v139
  v_mfma_f32_16x16x32_bf16 a[72:75], a[164:167], v[184:187], a[72:75]
  ds_read_b128 a[132:135], v3 offset:9216
  buffer_load_dwordx4 v2, s[48:51], s27 offen offset:2048 sc1 lds
  v_add_f32 v227, v216, v217
  v_mfma_f32_16x16x32_bf16 a[76:79], a[164:167], v[188:191], a[76:79]
  v_exp_f32 v220, v140
  v_mfma_f32_16x16x32_bf16 a[80:83], a[168:171], v[184:187], a[80:83]
  ds_read_b128 a[136:139], v3 offset:10240
  v_cvt_pk_bf16_f32 v180, v216, v217
  v_mfma_f32_16x16x32_bf16 a[84:87], a[168:171], v[188:191], a[84:87]
  v_exp_f32 v221, v141
  v_mfma_f32_16x16x32_bf16 a[88:91], a[172:175], v[184:187], a[88:91]
  ds_read_b128 a[140:143], v3 offset:11264
  buffer_load_dwordx4 a[220:223], v2, s[40:43], s14 offen offset:3072 sc1
  v_add_f32 v227, v227, v218
  v_mfma_f32_16x16x32_bf16 a[92:95], a[172:175], v[188:191], a[92:95]
  s_waitcnt lgkmcnt(4)
  v_exp_f32 v222, v142
  v_mfma_f32_16x16x32_bf16 a[96:99], a[176:179], v[184:187], a[96:99]
  ds_read_b128 a[144:147], v3 offset:12288
  buffer_load_dwordx4 v2, s[48:51], s27 offen offset:3072 sc1 lds
  v_add_f32 v227, v227, v219
  v_cvt_pk_bf16_f32 v181, v218, v219
  v_mfma_f32_16x16x32_bf16 a[100:103], a[176:179], v[188:191], a[100:103]
  s_add_u32 s27, s27, 16384
  v_exp_f32 v223, v143
  v_mfma_f32_16x16x32_bf16 a[104:107], a[180:183], v[184:187], a[104:107]
  s_add_u32 s25, s25, 32768
  ds_read_b128 a[148:151], v3 offset:13312
  v_add_f32 v227, v227, v220
  v_mfma_f32_16x16x32_bf16 a[108:111], a[180:183], v[188:191], a[108:111]
  s_and_b32 s25, s25, 0x1ffff
  v_add_f32 v227, v227, v221
  v_cvt_pk_bf16_f32 v182, v220, v221
  v_add_f32 v227, v227, v222
  v_mfma_f32_16x16x32_bf16 a[112:115], a[184:187], v[184:187], a[112:115]
  ds_read_b128 a[152:155], v3 offset:14336
  v_add_f32 v227, v227, v223
  v_max_f32 v5, v226, v227
  v_cmp_lt_f32 vcc, s81, v5
  v_mfma_f32_16x16x32_bf16 a[116:119], a[184:187], v[188:191], a[116:119]
  v_exp_f32 v216, v144
  v_mfma_f32_16x16x32_bf16 a[120:123], a[188:191], v[184:187], a[120:123]
  s_waitcnt lgkmcnt(3)
  ds_read_b128 a[156:159], v3 offset:15360
  v_cvt_pk_bf16_f32 v183, v222, v223
  v_add_u32 v3, s66, v2
  v_mfma_f32_16x16x32_bf16 a[124:127], a[188:191], v[188:191], a[124:127]
  s_cbranch_vccnz fa_stub19
fa_back19:
  v_exp_f32 v217, v145
  v_add_f32 v230, v230, v226
  v_add_f32 v231, v231, v227
fa_SSW4:
  v_mfma_f32_16x16x32_bf16 v[128:131], a[128:131], v[64:67], v[200:203]
  s_waitcnt vmcnt(12)
  v_exp_f32 v218, v146
  v_mfma_f32_16x16x32_bf16 v[136:139], a[128:131], v[68:71], v[204:207]
  s_barrier
  v_exp_f32 v219, v147
  v_mfma_f32_16x16x32_bf16 v[132:135], a[132:135], v[64:67], v[200:203]
  ds_read_b128 a[160:163], v3 offset:16384
  ds_read_b128 a[164:167], v3 offset:17408
  v_add_f32 v226, v216, v217
  v_mfma_f32_16x16x32_bf16 v[140:143], a[132:135], v[68:71], v[204:207]
  s_mov_b32 m0, s24
  v_exp_f32 v220, v148
  v_mfma_f32_16x16x32_bf16 v[128:131], a[136:139], v[72:75], v[128:131]
  ds_read_b128 a[168:171], v3 offset:18432
  buffer_load_dwordx4 v2, s[44:47], s26 offen offset:0 sc1 lds
  v_cvt_pk_bf16_f32 v184, v216, v217
  v_mfma_f32_16x16x32_bf16 v[136:139], a[136:139], v[76:79], v[136:139]
  v_exp_f32 v221, v149
  v_mfma_f32_16x16x32_bf16 v[132:135], a[140:143], v[72:75], v[132:135]
  ds_read_b128 a[172:175], v3 offset:19456
  v_add_f32 v226, v226, v218
  v_add_f32 v226, v226, v219
  v_mfma_f32_16x16x32_bf16 v[140:143], a[140:143], v[76:79], v[140:143]
  s_waitcnt lgkmcnt(4)
  v_exp_f32 v222, v150
  v_mfma_f32_16x16x32_bf16 v[128:131], a[144:147], v[80:83], v[128:131]
  s_add_u32 s14, s13, 24576
  ds_read_b128 a[176:179], v3 offset:20480
  buffer_load_dwordx4 a[224:227], v2, s[40:43], s14 offen offset:0 sc1
  v_cvt_pk_bf16_f32 v185, v218, v219
  v_mfma_f32_16x16x32_bf16 v[136:139], a[144:147], v[84:87], v[136:139]
  v_exp_f32 v223, v151
  v_mfma_f32_16x16x32_bf16 v[132:135], a[148:151], v[80:83], v[132:135]
  ds_read_b128 a[180:183], v3 offset:21504
  buffer_load_dwordx4 v2, s[44:47], s26 offen offset:1024 sc1 lds
  v_add_f32 v226, v226, v220
  v_mfma_f32_16x16x32_bf16 v[140:143], a[148:151], v[84:87], v[140:143]
  v_exp_f32 v216, v152
  v_mfma_f32_16x16x32_bf16 v[128:131], a[152:155], v[88:91], v[128:131]
  ds_read_b128 a[184:187], v3 offset:22528
  v_add_f32 v226, v226, v221
  v_cvt_pk_bf16_f32 v186, v220, v221
  v_mfma_f32_16x16x32_bf16 v[136:139], a[152:155], v[92:95], v[136:139]
  v_exp_f32 v217, v153
  v_mfma_f32_16x16x32_bf16 v[132:135], a[156:159], v[88:91], v[132:135]
  ds_read_b128 a[188:191], v3 offset:23552
  buffer_load_dwordx4 a[228:231], v2, s[40:43], s14 offen offset:1024 sc1
  v_add_f32 v226, v226, v222
  v_mfma_f32_16x16x32_bf16 v[140:143], a[156:159], v[92:95], v[140:143]
  s_waitcnt lgkmcnt(4)
  v_exp_f32 v218, v154
  v_mfma_f32_16x16x32_bf16 a[64:67], a[160:163], v[176:179], a[64:67]
  ds_read_b128 a[128:131], v3 offset:0
  v_add_f32 v226, v226, v223
  v_cvt_pk_bf16_f32 v187, v222, v223
  v_mfma_f32_16x16x32_bf16 a[68:71], a[160:163], v[180:183], a[68:71]
  v_exp_f32 v219, v155
  v_mfma_f32_16x16x32_bf16 a[72:75], a[164:167], v[176:179], a[72:75]
  ds_read_b128 a[132:135], v3 offset:1024
  buffer_load_dwordx4 v2, s[44:47], s26 offen offset:2048 sc1 lds
  v_add_f32 v227, v216, v217
  v_mfma_f32_16x16x32_bf16 a[76:79], a[164:167], v[180:183], a[76:79]
  v_exp_f32 v220, v156
  v_mfma_f32_16x16x32_bf16 a[80:83], a[168:171], v[176:179], a[80:83]
  ds_read_b128 a[136:139], v3 offset:2048
  v_cvt_pk_bf16_f32 v188, v216, v217
  v_mfma_f32_16x16x32_bf16 a[84:87], a[168:171], v[180:183], a[84:87]
  v_exp_f32 v221, v157
  v_mfma_f32_16x16x32_bf16 a[88:91], a[172:175], v[176:179], a[88:91]
  ds_read_b128 a[140:143], v3 offset:3072
  buffer_load_dwordx4 a[232:235], v2, s[40:43], s14 offen offset:2048 sc1
  v_add_f32 v227, v227, v218
  v_add_f32 v227, v227, v219
  v_mfma_f32_16x16x32_bf16 a[92:95], a[172:175], v[180:183], a[92:95]
  s_waitcnt lgkmcnt(4)
  v_exp_f32 v222, v158
  v_mfma_f32_16x16x32_bf16 a[96:99], a[176:179], v[176:179], a[96:99]
  ds_read_b128 a[144:147], v3 offset:4096
  buffer_load_dwordx4 v2, s[44:47], s26 offen offset:3072 sc1 lds
  v_cvt_pk_bf16_f32 v189, v218, v219
  v_mfma_f32_16x16x32_bf16 a[100:103], a[176:179], v[180:183], a[100:103]
  s_add_u32 s26, s26, 16384
  v_exp_f32 v223, v159
  v_mfma_f32_16x16x32_bf16 a[104:107], a[180:183], v[176:179], a[104:107]
  s_add_u32 s24, s24, 32768
  ds_read_b128 a[148:151], v3 offset:5120
  v_add_f32 v227, v227, v220
  v_mfma_f32_16x16x32_bf16 a[108:111], a[180:183], v[180:183], a[108:111]
  s_and_b32 s24, s24, 0x1ffff
  v_add_f32 v227, v227, v221
  v_cvt_pk_bf16_f32 v190, v220, v221
  v_add_f32 v227, v227, v222
  v_mfma_f32_16x16x32_bf16 a[112:115], a[184:187], v[176:179], a[112:115]
  ds_read_b128 a[152:155], v3 offset:6144
  v_add_f32 v227, v227, v223
  v_max_f32 v5, v226, v227
  v_cmp_lt_f32 vcc, s81, v5
  v_mfma_f32_16x16x32_bf16 a[116:119], a[184:187], v[180:183], a[116:119]
  v_exp_f32 v216, v128
  v_mfma_f32_16x16x32_bf16 a[120:123], a[188:191], v[176:179], a[120:123]
  s_waitcnt lgkmcnt(3)
  ds_read_b128 a[156:159], v3 offset:7168
  v_cvt_pk_bf16_f32 v191, v222, v223
  v_mfma_f32_16x16x32_bf16 a[124:127], a[188:191], v[180:183], a[124:127]
  s_cbranch_vccnz fa_stub20
fa_back20:
  v_exp_f32 v217, v129
  v_add_f32 v230, v230, v226
  v_add_f32 v231, v231, v227
  v_mfma_f32_16x16x32_bf16 v[144:147], a[128:131], v[64:67], v[200:203]
  ds_read_b128 a[160:163], v3 offset:24576
  v_add_f32 v226, v216, v217
  v_mfma_f32_16x16x32_bf16 v[152:155], a[128:131], v[68:71], v[204:207]
  v_exp_f32 v218, v130
  v_mfma_f32_16x16x32_bf16 v[148:151], a[132:135], v[64:67], v[200:203]
  s_add_u32 s66, s66, 32768
  ds_read_b128 a[164:167], v3 offset:25600
  v_cvt_pk_bf16_f32 v176, v216, v217
  v_mfma_f32_16x16x32_bf16 v[156:159], a[132:135], v[68:71], v[204:207]
  s_mov_b32 m0, s25
  v_exp_f32 v219, v131
  v_mfma_f32_16x16x32_bf16 v[144:147], a[136:139], v[72:75], v[144:147]
  s_and_b32 s66, s66, 0x1ffff
  ds_read_b128 a[168:171], v3 offset:26624
  buffer_load_dwordx4 v2, s[48:51], s27 offen offset:0 sc1 lds
  v_add_f32 v226, v226, v218
  v_add_f32 v226, v226, v219
  v_mfma_f32_16x16x32_bf16 v[152:155], a[136:139], v[76:79], v[152:155]
  v_exp_f32 v220, v132
  v_mfma_f32_16x16x32_bf16 v[148:151], a[140:143], v[72:75], v[148:151]
  ds_read_b128 a[172:175], v3 offset:27648
  v_cvt_pk_bf16_f32 v177, v218, v219
  v_mfma_f32_16x16x32_bf16 v[156:159], a[140:143], v[76:79], v[156:159]
  s_waitcnt lgkmcnt(4)
  v_exp_f32 v221, v133
  v_mfma_f32_16x16x32_bf16 v[144:147], a[144:147], v[80:83], v[144:147]
  s_add_u32 s14, s13, 24576
  ds_read_b128 a[176:179], v3 offset:28672
  buffer_load_dwordx4 a[236:239], v2, s[40:43], s14 offen offset:3072 sc1
  v_add_f32 v226, v226, v220
  v_mfma_f32_16x16x32_bf16 v[152:155], a[144:147], v[84:87], v[152:155]
  v_exp_f32 v222, v134
  v_mfma_f32_16x16x32_bf16 v[148:151], a[148:151], v[80:83], v[148:151]
  ds_read_b128 a[180:183], v3 offset:29696
  buffer_load_dwordx4 v2, s[48:51], s27 offen offset:1024 sc1 lds
  v_add_f32 v226, v226, v221
  v_cvt_pk_bf16_f32 v178, v220, v221
  v_mfma_f32_16x16x32_bf16 v[156:159], a[148:151], v[84:87], v[156:159]
  v_exp_f32 v223, v135
  v_mfma_f32_16x16x32_bf16 v[144:147], a[152:155], v[88:91], v[144:147]
  ds_read_b128 a[184:187], v3 offset:30720
  v_add_f32 v226, v226, v222
  v_mfma_f32_16x16x32_bf16 v[152:155], a[152:155], v[92:95], v[152:155]
  v_exp_f32 v216, v136
  v_mfma_f32_16x16x32_bf16 v[148:151], a[156:159], v[88:91], v[148:151]
  s_add_u32 s14, s13, 28672
  ds_read_b128 a[188:191], v3 offset:31744
  buffer_load_dwordx4 a[240:243], v2, s[40:43], s14 offen offset:0 sc1
  v_add_f32 v226, v226, v223
  v_exp_f32 v217, v137
  v_mfma_f32_16x16x32_bf16 v[156:159], a[156:159], v[92:95], v[156:159]
  s_waitcnt lgkmcnt(4)
  v_exp_f32 v218, v138
  v_mfma_f32_16x16x32_bf16 a[64:67], a[160:163], v[184:187], a[64:67]
  ds_read_b128 a[128:131], v3 offset:8192
  v_cvt_pk_bf16_f32 v179, v222, v223
  v_mfma_f32_16x16x32_bf16 a[68:71], a[160:163], v[188:191], a[68:71]
  v_exp_f32 v219, v139
  v_mfma_f32_16x16x32_bf16 a[72:75], a[164:167], v[184:187], a[72:75]
  ds_read_b128 a[132:135], v3 offset:9216
  buffer_load_dwordx4 v2, s[48:51], s27 offen offset:2048 sc1 lds
  v_add_f32 v227, v216, v217
  v_mfma_f32_16x16x32_bf16 a[76:79], a[164:167], v[188:191], a[76:79]
  v_exp_f32 v220, v140
  v_mfma_f32_16x16x32_bf16 a[80:83], a[168:171], v[184:187], a[80:83]
  ds_read_b128 a[136:139], v3 offset:10240
  v_cvt_pk_bf16_f32 v180, v216, v217
  v_mfma_f32_16x16x32_bf16 a[84:87], a[168:171], v[188:191], a[84:87]
  v_exp_f32 v221, v141
  v_mfma_f32_16x16x32_bf16 a[88:91], a[172:175], v[184:187], a[88:91]
  ds_read_b128 a[140:143], v3 offset:11264
  buffer_load_dwordx4 a[244:247], v2, s[40:43], s14 offen offset:1024 sc1
  v_add_f32 v227, v227, v218
  v_mfma_f32_16x16x32_bf16 a[92:95], a[172:175], v[188:191], a[92:95]
  s_waitcnt lgkmcnt(4)
  v_exp_f32 v222, v142
  v_mfma_f32_16x16x32_bf16 a[96:99], a[176:179], v[184:187], a[96:99]
  ds_read_b128 a[144:147], v3 offset:12288
  buffer_load_dwordx4 v2, s[48:51], s27 offen offset:3072 sc1 lds
  v_add_f32 v227, v227, v219
  v_cvt_pk_bf16_f32 v181, v218, v219
  v_mfma_f32_16x16x32_bf16 a[100:103], a[176:179], v[188:191], a[100:103]
  s_add_u32 s27, s27, 16384
  v_exp_f32 v223, v143
  v_mfma_f32_16x16x32_bf16 a[104:107], a[180:183], v[184:187], a[104:107]
  s_add_u32 s25, s25, 32768
  ds_read_b128 a[148:151], v3 offset:13312
  v_add_f32 v227, v227, v220
  v_mfma_f32_16x16x32_bf16 a[108:111], a[180:183], v[188:191], a[108:111]
  s_and_b32 s25, s25, 0x1ffff
  v_add_f32 v227, v227, v221
  v_cvt_pk_bf16_f32 v182, v220, v221
  v_add_f32 v227, v227, v222
  v_mfma_f32_16x16x32_bf16 a[112:115], a[184:187], v[184:187], a[112:115]
  ds_read_b128 a[152:155], v3 offset:14336
  v_add_f32 v227, v227, v223
  v_max_f32 v5, v226, v227
  v_cmp_lt_f32 vcc, s81, v5
  v_mfma_f32_16x16x32_bf16 a[116:119], a[184:187], v[188:191], a[116:119]
  v_exp_f32 v216, v144
  v_mfma_f32_16x16x32_bf16 a[120:123], a[188:191], v[184:187], a[120:123]
  s_waitcnt lgkmcnt(3)
  ds_read_b128 a[156:159], v3 offset:15360
  v_cvt_pk_bf16_f32 v183, v222, v223
  v_add_u32 v3, s66, v2
  v_mfma_f32_16x16x32_bf16 a[124:127], a[188:191], v[188:191], a[124:127]
  s_cbranch_vccnz fa_stub21
fa_back21:
  v_exp_f32 v217, v145
  v_add_f32 v230, v230, v226
  v_add_f32 v231, v231, v227
fa_SSW3:
  v_mfma_f32_16x16x32_bf16 v[128:131], a[128:131], v[64:67], v[200:203]
  s_waitcnt vmcnt(12)
  v_exp_f32 v218, v146
  v_mfma_f32_16x16x32_bf16 v[136:139], a[128:131], v[68:71], v[204:207]
  s_barrier
  v_exp_f32 v219, v147
  v_mfma_f32_16x16x32_bf16 v[132:135], a[132:135], v[64:67], v[200:203]
  ds_read_b128 a[160:163], v3 offset:16384
  ds_read_b128 a[164:167], v3 offset:17408
  v_add_f32 v226, v216, v217
  v_mfma_f32_16x16x32_bf16 v[140:143], a[132:135], v[68:71], v[204:207]
  s_mov_b32 m0, s24
  v_exp_f32 v220, v148
  v_mfma_f32_16x16x32_bf16 v[128:131], a[136:139], v[72:75], v[128:131]
  ds_read_b128 a[168:171], v3 offset:18432
  buffer_load_dwordx4 v2, s[44:47], s26 offen offset:0 sc1 lds
  v_cvt_pk_bf16_f32 v184, v216, v217
  v_mfma_f32_16x16x32_bf16 v[136:139], a[136:139], v[76:79], v[136:139]
  v_exp_f32 v221, v149
  v_mfma_f32_16x16x32_bf16 v[132:135], a[140:143], v[72:75], v[132:135]
  ds_read_b128 a[172:175], v3 offset:19456
  v_add_f32 v226, v226, v218
  v_add_f32 v226, v226, v219
  v_mfma_f32_16x16x32_bf16 v[140:143], a[140:143], v[76:79], v[140:143]
  s_waitcnt lgkmcnt(4)
  v_exp_f32 v222, v150
  v_mfma_f32_16x16x32_bf16 v[128:131], a[144:147], v[80:83], v[128:131]
  s_add_u32 s14, s13, 28672
  ds_read_b128 a[176:179], v3 offset:20480
  buffer_load_dwordx4 a[248:251], v2, s[40:43], s14 offen offset:2048 sc1
  v_cvt_pk_bf16_f32 v185, v218, v219
  v_mfma_f32_16x16x32_bf16 v[136:139], a[144:147], v[84:87], v[136:139]
  v_exp_f32 v223, v151
  v_mfma_f32_16x16x32_bf16 v[132:135], a[148:151], v[80:83], v[132:135]
  ds_read_b128 a[180:183], v3 offset:21504
  buffer_load_dwordx4 v2, s[44:47], s26 offen offset:1024 sc1 lds
  v_add_f32 v226, v226, v220
  v_mfma_f32_16x16x32_bf16 v[140:143], a[148:151], v[84:87], v[140:143]
  v_exp_f32 v216, v152
  v_mfma_f32_16x16x32_bf16 v[128:131], a[152:155], v[88:91], v[128:131]
  ds_read_b128 a[184:187], v3 offset:22528
  v_add_f32 v226, v226, v221
  v_cvt_pk_bf16_f32 v186, v220, v221
  v_mfma_f32_16x16x32_bf16 v[136:139], a[152:155], v[92:95], v[136:139]
  v_exp_f32 v217, v153
  v_mfma_f32_16x16x32_bf16 v[132:135], a[156:159], v[88:91], v[132:135]
  ds_read_b128 a[188:191], v3 offset:23552
  buffer_load_dwordx4 a[252:255], v2, s[40:43], s14 offen offset:3072 sc1
  v_add_f32 v226, v226, v222
  v_mfma_f32_16x16x32_bf16 v[140:143], a[156:159], v[92:95], v[140:143]
  s_waitcnt lgkmcnt(4)
  v_exp_f32 v218, v154
  v_mfma_f32_16x16x32_bf16 a[64:67], a[160:163], v[176:179], a[64:67]
  ds_read_b128 a[128:131], v3 offset:0
  v_add_f32 v226, v226, v223
  v_cvt_pk_bf16_f32 v187, v222, v223
  v_mfma_f32_16x16x32_bf16 a[68:71], a[160:163], v[180:183], a[68:71]
  v_exp_f32 v219, v155
  v_mfma_f32_16x16x32_bf16 a[72:75], a[164:167], v[176:179], a[72:75]
  ds_read_b128 a[132:135], v3 offset:1024
  buffer_load_dwordx4 v2, s[44:47], s26 offen offset:2048 sc1 lds
  v_add_f32 v227, v216, v217
  v_mfma_f32_16x16x32_bf16 a[76:79], a[164:167], v[180:183], a[76:79]
  v_exp_f32 v220, v156
  v_mfma_f32_16x16x32_bf16 a[80:83], a[168:171], v[176:179], a[80:83]
  ds_read_b128 a[136:139], v3 offset:2048
  v_cvt_pk_bf16_f32 v188, v216, v217
  v_mfma_f32_16x16x32_bf16 a[84:87], a[168:171], v[180:183], a[84:87]
  v_exp_f32 v221, v157
  v_mfma_f32_16x16x32_bf16 a[88:91], a[172:175], v[176:179], a[88:91]
  s_add_u32 s14, s13, 32768
  ds_read_b128 a[140:143], v3 offset:3072
  buffer_load_dwordx4 v[32:35], v2, s[40:43], s14 offen offset:0 sc1
  v_add_f32 v227, v227, v218
  v_add_f32 v227, v227, v219
  v_mfma_f32_16x16x32_bf16 a[92:95], a[172:175], v[180:183], a[92:95]
  s_waitcnt lgkmcnt(4)
  v_exp_f32 v222, v158
  v_mfma_f32_16x16x32_bf16 a[96:99], a[176:179], v[176:179], a[96:99]
  ds_read_b128 a[144:147], v3 offset:4096
  buffer_load_dwordx4 v2, s[44:47], s26 offen offset:3072 sc1 lds
  v_cvt_pk_bf16_f32 v189, v218, v219
  v_mfma_f32_16x16x32_bf16 a[100:103], a[176:179], v[180:183], a[100:103]
  s_add_u32 s26, s26, 16384
  v_exp_f32 v223, v159
  v_mfma_f32_16x16x32_bf16 a[104:107], a[180:183], v[176:179], a[104:107]
  s_add_u32 s24, s24, 32768
  ds_read_b128 a[148:151], v3 offset:5120
  v_add_f32 v227, v227, v220
  v_mfma_f32_16x16x32_bf16 a[108:111], a[180:183], v[180:183], a[108:111]
  s_and_b32 s24, s24, 0x1ffff
  v_add_f32 v227, v227, v221
  v_cvt_pk_bf16_f32 v190, v220, v221
  v_add_f32 v227, v227, v222
  v_mfma_f32_16x16x32_bf16 a[112:115], a[184:187], v[176:179], a[112:115]
  ds_read_b128 a[152:155], v3 offset:6144
  v_add_f32 v227, v227, v223
  v_max_f32 v5, v226, v227
  v_cmp_lt_f32 vcc, s81, v5
  v_mfma_f32_16x16x32_bf16 a[116:119], a[184:187], v[180:183], a[116:119]
  v_exp_f32 v216, v128
  v_mfma_f32_16x16x32_bf16 a[120:123], a[188:191], v[176:179], a[120:123]
  s_waitcnt lgkmcnt(3)
  ds_read_b128 a[156:159], v3 offset:7168
  v_cvt_pk_bf16_f32 v191, v222, v223
  v_mfma_f32_16x16x32_bf16 a[124:127], a[188:191], v[180:183], a[124:127]
  s_cbranch_vccnz fa_stub22
fa_back22:
  v_exp_f32 v217, v129
  v_add_f32 v230, v230, v226
  v_add_f32 v231, v231, v227
  v_mfma_f32_16x16x32_bf16 v[144:147], a[128:131], v[64:67], v[200:203]
  ds_read_b128 a[160:163], v3 offset:24576
  v_add_f32 v226, v216, v217
  v_mfma_f32_16x16x32_bf16 v[152:155], a[128:131], v[68:71], v[204:207]
  v_exp_f32 v218, v130
  v_mfma_f32_16x16x32_bf16 v[148:151], a[132:135], v[64:67], v[200:203]
  s_add_u32 s66, s66, 32768
  ds_read_b128 a[164:167], v3 offset:25600
  v_cvt_pk_bf16_f32 v176, v216, v217
  v_mfma_f32_16x16x32_bf16 v[156:159], a[132:135], v[68:71], v[204:207]
  s_mov_b32 m0, s25
  v_exp_f32 v219, v131
  v_mfma_f32_16x16x32_bf16 v[144:147], a[136:139], v[72:75], v[144:147]
  s_and_b32 s66, s66, 0x1ffff
  ds_read_b128 a[168:171], v3 offset:26624
  buffer_load_dwordx4 v2, s[48:51], s27 offen offset:0 sc1 lds
  v_add_f32 v226, v226, v218
  v_add_f32 v226, v226, v219
  v_mfma_f32_16x16x32_bf16 v[152:155], a[136:139], v[76:79], v[152:155]
  v_exp_f32 v220, v132
  v_mfma_f32_16x16x32_bf16 v[148:151], a[140:143], v[72:75], v[148:151]
  ds_read_b128 a[172:175], v3 offset:27648
  v_cvt_pk_bf16_f32 v177, v218, v219
  v_mfma_f32_16x16x32_bf16 v[156:159], a[140:143], v[76:79], v[156:159]
  s_waitcnt lgkmcnt(4)
  v_exp_f32 v221, v133
  v_mfma_f32_16x16x32_bf16 v[144:147], a[144:147], v[80:83], v[144:147]
  s_add_u32 s14, s13, 32768
  ds_read_b128 a[176:179], v3 offset:28672
  buffer_load_dwordx4 v[36:39], v2, s[40:43], s14 offen offset:1024 sc1
  v_add_f32 v226, v226, v220
  v_mfma_f32_16x16x32_bf16 v[152:155], a[144:147], v[84:87], v[152:155]
  v_exp_f32 v222, v134
  v_mfma_f32_16x16x32_bf16 v[148:151], a[148:151], v[80:83], v[148:151]
  ds_read_b128 a[180:183], v3 offset:29696
  buffer_load_dwordx4 v2, s[48:51], s27 offen offset:1024 sc1 lds
  v_add_f32 v226, v226, v221
  v_cvt_pk_bf16_f32 v178, v220, v221
  v_mfma_f32_16x16x32_bf16 v[156:159], a[148:151], v[84:87], v[156:159]
  v_exp_f32 v223, v135
  v_mfma_f32_16x16x32_bf16 v[144:147], a[152:155], v[88:91], v[144:147]
  ds_read_b128 a[184:187], v3 offset:30720
  v_add_f32 v226, v226, v222
  v_mfma_f32_16x16x32_bf16 v[152:155], a[152:155], v[92:95], v[152:155]
  v_exp_f32 v216, v136
  v_mfma_f32_16x16x32_bf16 v[148:151], a[156:159], v[88:91], v[148:151]
  ds_read_b128 a[188:191], v3 offset:31744
  buffer_load_dwordx4 v[40:43], v2, s[40:43], s14 offen offset:2048 sc1
  v_add_f32 v226, v226, v223
  v_exp_f32 v217, v137
  v_mfma_f32_16x16x32_bf16 v[156:159], a[156:159], v[92:95], v[156:159]
  s_waitcnt lgkmcnt(4)
  v_exp_f32 v218, v138
  v_mfma_f32_16x16x32_bf16 a[64:67], a[160:163], v[184:187], a[64:67]
  ds_read_b128 a[128:131], v3 offset:8192
  v_cvt_pk_bf16_f32 v179, v222, v223
  v_mfma_f32_16x16x32_bf16 a[68:71], a[160:163], v[188:191], a[68:71]
  v_exp_f32 v219, v139
  v_mfma_f32_16x16x32_bf16 a[72:75], a[164:167], v[184:187], a[72:75]
  ds_read_b128 a[132:135], v3 offset:9216
  buffer_load_dwordx4 v2, s[48:51], s27 offen offset:2048 sc1 lds
  v_add_f32 v227, v216, v217
  v_mfma_f32_16x16x32_bf16 a[76:79], a[164:167], v[188:191], a[76:79]
  v_exp_f32 v220, v140
  v_mfma_f32_16x16x32_bf16 a[80:83], a[168:171], v[184:187], a[80:83]
  ds_read_b128 a[136:139], v3 offset:10240
  v_cvt_pk_bf16_f32 v180, v216, v217
  v_mfma_f32_16x16x32_bf16 a[84:87], a[168:171], v[188:191], a[84:87]
  v_exp_f32 v221, v141
  v_mfma_f32_16x16x32_bf16 a[88:91], a[172:175], v[184:187], a[88:91]
  ds_read_b128 a[140:143], v3 offset:11264
  buffer_load_dwordx4 v[44:47], v2, s[40:43], s14 offen offset:3072 sc1
  v_add_f32 v227, v227, v218
  v_mfma_f32_16x16x32_bf16 a[92:95], a[172:175], v[188:191], a[92:95]
  s_waitcnt lgkmcnt(4)
  v_exp_f32 v222, v142
  v_mfma_f32_16x16x32_bf16 a[96:99], a[176:179], v[184:187], a[96:99]
  ds_read_b128 a[144:147], v3 offset:12288
  buffer_load_dwordx4 v2, s[48:51], s27 offen offset:3072 sc1 lds
  v_add_f32 v227, v227, v219
  v_cvt_pk_bf16_f32 v181, v218, v219
  v_mfma_f32_16x16x32_bf16 a[100:103], a[176:179], v[188:191], a[100:103]
  s_add_u32 s27, s27, 16384
  v_exp_f32 v223, v143
  v_mfma_f32_16x16x32_bf16 a[104:107], a[180:183], v[184:187], a[104:107]
  s_add_u32 s25, s25, 32768
  ds_read_b128 a[148:151], v3 offset:13312
  v_add_f32 v227, v227, v220
  v_mfma_f32_16x16x32_bf16 a[108:111], a[180:183], v[188:191], a[108:111]
  s_and_b32 s25, s25, 0x1ffff
  v_add_f32 v227, v227, v221
  v_cvt_pk_bf16_f32 v182, v220, v221
  v_add_f32 v227, v227, v222
  v_mfma_f32_16x16x32_bf16 a[112:115], a[184:187], v[184:187], a[112:115]
  ds_read_b128 a[152:155], v3 offset:14336
  v_add_f32 v227, v227, v223
  v_max_f32 v5, v226, v227
  v_cmp_lt_f32 vcc, s81, v5
  v_mfma_f32_16x16x32_bf16 a[116:119], a[184:187], v[188:191], a[116:119]
  v_exp_f32 v216, v144
  v_mfma_f32_16x16x32_bf16 a[120:123], a[188:191], v[184:187], a[120:123]
  s_waitcnt lgkmcnt(3)
  ds_read_b128 a[156:159], v3 offset:15360
  v_cvt_pk_bf16_f32 v183, v222, v223
  v_add_u32 v3, s66, v2
  v_mfma_f32_16x16x32_bf16 a[124:127], a[188:191], v[188:191], a[124:127]
  s_cbranch_vccnz fa_stub23
fa_back23:
  v_exp_f32 v217, v145
  v_add_f32 v230, v230, v226
  v_add_f32 v231, v231, v227
fa_SSW2:
  v_mfma_f32_16x16x32_bf16 v[128:131], a[128:131], v[64:67], v[200:203]
  s_waitcnt vmcnt(12)
  v_exp_f32 v218, v146
  v_mfma_f32_16x16x32_bf16 v[136:139], a[128:131], v[68:71], v[204:207]
  s_barrier
  v_exp_f32 v219, v147
  v_mfma_f32_16x16x32_bf16 v[132:135], a[132:135], v[64:67], v[200:203]
  ds_read_b128 a[160:163], v3 offset:16384
  ds_read_b128 a[164:167], v3 offset:17408
  v_add_f32 v226, v216, v217
  v_mfma_f32_16x16x32_bf16 v[140:143], a[132:135], v[68:71], v[204:207]
  s_mov_b32 m0, s24
  v_exp_f32 v220, v148
  v_mfma_f32_16x16x32_bf16 v[128:131], a[136:139], v[72:75], v[128:131]
  ds_read_b128 a[168:171], v3 offset:18432
  buffer_load_dwordx4 v2, s[44:47], s26 offen offset:0 sc1 lds
  v_cvt_pk_bf16_f32 v184, v216, v217
  v_mfma_f32_16x16x32_bf16 v[136:139], a[136:139], v[76:79], v[136:139]
  v_exp_f32 v221, v149
  v_mfma_f32_16x16x32_bf16 v[132:135], a[140:143], v[72:75], v[132:135]
  ds_read_b128 a[172:175], v3 offset:19456
  v_add_f32 v226, v226, v218
  v_add_f32 v226, v226, v219
  v_mfma_f32_16x16x32_bf16 v[140:143], a[140:143], v[76:79], v[140:143]
  s_waitcnt lgkmcnt(4)
  v_exp_f32 v222, v150
  v_mfma_f32_16x16x32_bf16 v[128:131], a[144:147], v[80:83], v[128:131]
  s_add_u32 s14, s13, 36864
  ds_read_b128 a[176:179], v3 offset:20480
  buffer_load_dwordx4 v[48:51], v2, s[40:43], s14 offen offset:0 sc1
  v_cvt_pk_bf16_f32 v185, v218, v219
  v_mfma_f32_16x16x32_bf16 v[136:139], a[144:147], v[84:87], v[136:139]
  v_exp_f32 v223, v151
  v_mfma_f32_16x16x32_bf16 v[132:135], a[148:151], v[80:83], v[132:135]
  ds_read_b128 a[180:183], v3 offset:21504
  buffer_load_dwordx4 v2, s[44:47], s26 offen offset:1024 sc1 lds
  v_add_f32 v226, v226, v220
  v_mfma_f32_16x16x32_bf16 v[140:143], a[148:151], v[84:87], v[140:143]
  v_exp_f32 v216, v152
  v_mfma_f32_16x16x32_bf16 v[128:131], a[152:155], v[88:91], v[128:131]
  ds_read_b128 a[184:187], v3 offset:22528
  v_add_f32 v226, v226, v221
  v_cvt_pk_bf16_f32 v186, v220, v221
  v_mfma_f32_16x16x32_bf16 v[136:139], a[152:155], v[92:95], v[136:139]
  v_exp_f32 v217, v153
  v_mfma_f32_16x16x32_bf16 v[132:135], a[156:159], v[88:91], v[132:135]
  ds_read_b128 a[188:191], v3 offset:23552
  buffer_load_dwordx4 v[52:55], v2, s[40:43], s14 offen offset:1024 sc1
  v_add_f32 v226, v226, v222
  v_mfma_f32_16x16x32_bf16 v[140:143], a[156:159], v[92:95], v[140:143]
  s_waitcnt lgkmcnt(4)
  v_exp_f32 v218, v154
  v_mfma_f32_16x16x32_bf16 a[64:67], a[160:163], v[176:179], a[64:67]
  ds_read_b128 a[128:131], v3 offset:0
  v_add_f32 v226, v226, v223
  v_cvt_pk_bf16_f32 v187, v222, v223
  v_mfma_f32_16x16x32_bf16 a[68:71], a[160:163], v[180:183], a[68:71]
  v_exp_f32 v219, v155
  v_mfma_f32_16x16x32_bf16 a[72:75], a[164:167], v[176:179], a[72:75]
  ds_read_b128 a[132:135], v3 offset:1024
  buffer_load_dwordx4 v2, s[44:47], s26 offen offset:2048 sc1 lds
  v_add_f32 v227, v216, v217
  v_mfma_f32_16x16x32_bf16 a[76:79], a[164:167], v[180:183], a[76:79]
  v_exp_f32 v220, v156
  v_mfma_f32_16x16x32_bf16 a[80:83], a[168:171], v[176:179], a[80:83]
  ds_read_b128 a[136:139], v3 offset:2048
  v_cvt_pk_bf16_f32 v188, v216, v217
  v_mfma_f32_16x16x32_bf16 a[84:87], a[168:171], v[180:183], a[84:87]
  v_exp_f32 v221, v157
  v_mfma_f32_16x16x32_bf16 a[88:91], a[172:175], v[176:179], a[88:91]
  ds_read_b128 a[140:143], v3 offset:3072
  buffer_load_dwordx4 v[56:59], v2, s[40:43], s14 offen offset:2048 sc1
  v_add_f32 v227, v227, v218
  v_add_f32 v227, v227, v219
  v_mfma_f32_16x16x32_bf16 a[92:95], a[172:175], v[180:183], a[92:95]
  s_waitcnt lgkmcnt(4)
  v_exp_f32 v222, v158
  v_mfma_f32_16x16x32_bf16 a[96:99], a[176:179], v[176:179], a[96:99]
  ds_read_b128 a[144:147], v3 offset:4096
  buffer_load_dwordx4 v2, s[44:47], s26 offen offset:3072 sc1 lds
  v_cvt_pk_bf16_f32 v189, v218, v219
  v_mfma_f32_16x16x32_bf16 a[100:103], a[176:179], v[180:183], a[100:103]
  s_add_u32 s26, s26, 16384
  v_exp_f32 v223, v159
  v_mfma_f32_16x16x32_bf16 a[104:107], a[180:183], v[176:179], a[104:107]
  s_add_u32 s24, s24, 32768
  ds_read_b128 a[148:151], v3 offset:5120
  v_add_f32 v227, v227, v220
  v_mfma_f32_16x16x32_bf16 a[108:111], a[180:183], v[180:183], a[108:111]
  s_and_b32 s24, s24, 0x1ffff
  v_add_f32 v227, v227, v221
  v_cvt_pk_bf16_f32 v190, v220, v221
  v_add_f32 v227, v227, v222
  v_mfma_f32_16x16x32_bf16 a[112:115], a[184:187], v[176:179], a[112:115]
  ds_read_b128 a[152:155], v3 offset:6144
  v_add_f32 v227, v227, v223
  v_max_f32 v5, v226, v227
  v_cmp_lt_f32 vcc, s81, v5
  v_mfma_f32_16x16x32_bf16 a[116:119], a[184:187], v[180:183], a[116:119]
  v_exp_f32 v216, v128
  v_mfma_f32_16x16x32_bf16 a[120:123], a[188:191], v[176:179], a[120:123]
  s_waitcnt lgkmcnt(3)
  ds_read_b128 a[156:159], v3 offset:7168
  v_cvt_pk_bf16_f32 v191, v222, v223
  v_mfma_f32_16x16x32_bf16 a[124:127], a[188:191], v[180:183], a[124:127]
  s_cbranch_vccnz fa_stub24
fa_back24:
  v_exp_f32 v217, v129
  v_add_f32 v230, v230, v226
  v_add_f32 v231, v231, v227
  v_mfma_f32_16x16x32_bf16 v[144:147], a[128:131], v[64:67], v[200:203]
  ds_read_b128 a[160:163], v3 offset:24576
  v_add_f32 v226, v216, v217
  v_mfma_f32_16x16x32_bf16 v[152:155], a[128:131], v[68:71], v[204:207]
  v_exp_f32 v218, v130
  v_mfma_f32_16x16x32_bf16 v[148:151], a[132:135], v[64:67], v[200:203]
  s_add_u32 s66, s66, 32768
  ds_read_b128 a[164:167], v3 offset:25600
  v_cvt_pk_bf16_f32 v176, v216, v217
  v_mfma_f32_16x16x32_bf16 v[156:159], a[132:135], v[68:71], v[204:207]
  s_mov_b32 m0, s25
  v_exp_f32 v219, v131
  v_mfma_f32_16x16x32_bf16 v[144:147], a[136:139], v[72:75], v[144:147]
  s_and_b32 s66, s66, 0x1ffff
  ds_read_b128 a[168:171], v3 offset:26624
  buffer_load_dwordx4 v2, s[48:51], s27 offen offset:0 sc1 lds
  v_add_f32 v226, v226, v218
  v_add_f32 v226, v226, v219
  v_mfma_f32_16x16x32_bf16 v[152:155], a[136:139], v[76:79], v[152:155]
  v_exp_f32 v220, v132
  v_mfma_f32_16x16x32_bf16 v[148:151], a[140:143], v[72:75], v[148:151]
  ds_read_b128 a[172:175], v3 offset:27648
  v_cvt_pk_bf16_f32 v177, v218, v219
  v_mfma_f32_16x16x32_bf16 v[156:159], a[140:143], v[76:79], v[156:159]
  s_waitcnt lgkmcnt(4)
  v_exp_f32 v221, v133
  v_mfma_f32_16x16x32_bf16 v[144:147], a[144:147], v[80:83], v[144:147]
  s_add_u32 s14, s13, 36864
  ds_read_b128 a[176:179], v3 offset:28672
  buffer_load_dwordx4 v[60:63], v2, s[40:43], s14 offen offset:3072 sc1
  v_add_f32 v226, v226, v220
  v_mfma_f32_16x16x32_bf16 v[152:155], a[144:147], v[84:87], v[152:155]
  v_exp_f32 v222, v134
  v_mfma_f32_16x16x32_bf16 v[148:151], a[148:151], v[80:83], v[148:151]
  ds_read_b128 a[180:183], v3 offset:29696
  buffer_load_dwordx4 v2, s[48:51], s27 offen offset:1024 sc1 lds
  v_add_f32 v226, v226, v221
  v_cvt_pk_bf16_f32 v178, v220, v221
  v_mfma_f32_16x16x32_bf16 v[156:159], a[148:151], v[84:87], v[156:159]
  v_exp_f32 v223, v135
  v_mfma_f32_16x16x32_bf16 v[144:147], a[152:155], v[88:91], v[144:147]
  ds_read_b128 a[184:187], v3 offset:30720
  v_add_f32 v226, v226, v222
  v_mfma_f32_16x16x32_bf16 v[152:155], a[152:155], v[92:95], v[152:155]
  v_exp_f32 v216, v136
  v_mfma_f32_16x16x32_bf16 v[148:151], a[156:159], v[88:91], v[148:151]
  s_add_u32 s14, s13, 40960
  ds_read_b128 a[188:191], v3 offset:31744
  buffer_load_dwordx4 v[96:99], v2, s[40:43], s14 offen offset:0 sc1
  v_add_f32 v226, v226, v223
  v_exp_f32 v217, v137
  v_mfma_f32_16x16x32_bf16 v[156:159], a[156:159], v[92:95], v[156:159]
  s_waitcnt lgkmcnt(4)
  v_exp_f32 v218, v138
  v_mfma_f32_16x16x32_bf16 a[64:67], a[160:163], v[184:187], a[64:67]
  ds_read_b128 a[128:131], v3 offset:8192
  v_cvt_pk_bf16_f32 v179, v222, v223
  v_mfma_f32_16x16x32_bf16 a[68:71], a[160:163], v[188:191], a[68:71]
  v_exp_f32 v219, v139
  v_mfma_f32_16x16x32_bf16 a[72:75], a[164:167], v[184:187], a[72:75]
  ds_read_b128 a[132:135], v3 offset:9216
  buffer_load_dwordx4 v2, s[48:51], s27 offen offset:2048 sc1 lds
  v_add_f32 v227, v216, v217
  v_mfma_f32_16x16x32_bf16 a[76:79], a[164:167], v[188:191], a[76:79]
  v_exp_f32 v220, v140
  v_mfma_f32_16x16x32_bf16 a[80:83], a[168:171], v[184:187], a[80:83]
  ds_read_b128 a[136:139], v3 offset:10240
  v_cvt_pk_bf16_f32 v180, v216, v217
  v_mfma_f32_16x16x32_bf16 a[84:87], a[168:171], v[188:191], a[84:87]
  v_exp_f32 v221, v141
  v_mfma_f32_16x16x32_bf16 a[88:91], a[172:175], v[184:187], a[88:91]
  ds_read_b128 a[140:143], v3 offset:11264
  buffer_load_dwordx4 v[100:103], v2, s[40:43], s14 offen offset:1024 sc1
  v_add_f32 v227, v227, v218
  v_mfma_f32_16x16x32_bf16 a[92:95], a[172:175], v[188:191], a[92:95]
  s_waitcnt lgkmcnt(4)
  v_exp_f32 v222, v142
  v_mfma_f32_16x16x32_bf16 a[96:99], a[176:179], v[184:187], a[96:99]
  ds_read_b128 a[144:147], v3 offset:12288
  buffer_load_dwordx4 v2, s[48:51], s27 offen offset:3072 sc1 lds
  v_add_f32 v227, v227, v219
  v_cvt_pk_bf16_f32 v181, v218, v219
  v_mfma_f32_16x16x32_bf16 a[100:103], a[176:179], v[188:191], a[100:103]
  s_add_u32 s27, s27, 16384
  v_exp_f32 v223, v143
  v_mfma_f32_16x16x32_bf16 a[104:107], a[180:183], v[184:187], a[104:107]
  s_add_u32 s25, s25, 32768
  ds_read_b128 a[148:151], v3 offset:13312
  v_add_f32 v227, v227, v220
  v_mfma_f32_16x16x32_bf16 a[108:111], a[180:183], v[188:191], a[108:111]
  s_and_b32 s25, s25, 0x1ffff
  v_add_f32 v227, v227, v221
  v_cvt_pk_bf16_f32 v182, v220, v221
  v_add_f32 v227, v227, v222
  v_mfma_f32_16x16x32_bf16 a[112:115], a[184:187], v[184:187], a[112:115]
  ds_read_b128 a[152:155], v3 offset:14336
  v_add_f32 v227, v227, v223
  v_max_f32 v5, v226, v227
  v_cmp_lt_f32 vcc, s81, v5
  v_mfma_f32_16x16x32_bf16 a[116:119], a[184:187], v[188:191], a[116:119]
  v_exp_f32 v216, v144
  v_mfma_f32_16x16x32_bf16 a[120:123], a[188:191], v[184:187], a[120:123]
  s_waitcnt lgkmcnt(3)
  ds_read_b128 a[156:159], v3 offset:15360
  v_cvt_pk_bf16_f32 v183, v222, v223
  v_add_u32 v3, s66, v2
  v_mfma_f32_16x16x32_bf16 a[124:127], a[188:191], v[188:191], a[124:127]
  s_cbranch_vccnz fa_stub25
fa_back25:
  v_exp_f32 v217, v145
  v_add_f32 v230, v230, v226
  v_add_f32 v231, v231, v227
fa_SSW1:
  v_mfma_f32_16x16x32_bf16 v[128:131], a[128:131], v[64:67], v[200:203]
  s_waitcnt vmcnt(12)
  v_exp_f32 v218, v146
  v_mfma_f32_16x16x32_bf16 v[136:139], a[128:131], v[68:71], v[204:207]
  s_barrier
  v_exp_f32 v219, v147
  v_mfma_f32_16x16x32_bf16 v[132:135], a[132:135], v[64:67], v[200:203]
  ds_read_b128 a[160:163], v3 offset:16384
  ds_read_b128 a[164:167], v3 offset:17408
  v_add_f32 v226, v216, v217
  v_mfma_f32_16x16x32_bf16 v[140:143], a[132:135], v[68:71], v[204:207]
  s_mov_b32 m0, s24
  v_exp_f32 v220, v148
  v_mfma_f32_16x16x32_bf16 v[128:131], a[136:139], v[72:75], v[128:131]
  ds_read_b128 a[168:171], v3 offset:18432
  buffer_load_dwordx4 v2, s[44:47], s26 offen offset:0 sc1 lds
  v_cvt_pk_bf16_f32 v184, v216, v217
  v_mfma_f32_16x16x32_bf16 v[136:139], a[136:139], v[76:79], v[136:139]
  v_exp_f32 v221, v149
  v_mfma_f32_16x16x32_bf16 v[132:135], a[140:143], v[72:75], v[132:135]
  ds_read_b128 a[172:175], v3 offset:19456
  v_add_f32 v226, v226, v218
  v_add_f32 v226, v226, v219
  v_mfma_f32_16x16x32_bf16 v[140:143], a[140:143], v[76:79], v[140:143]
  s_waitcnt lgkmcnt(4)
  v_exp_f32 v222, v150
  v_mfma_f32_16x16x32_bf16 v[128:131], a[144:147], v[80:83], v[128:131]
  s_add_u32 s14, s13, 40960
  ds_read_b128 a[176:179], v3 offset:20480
  buffer_load_dwordx4 v[104:107], v2, s[40:43], s14 offen offset:2048 sc1
  v_cvt_pk_bf16_f32 v185, v218, v219
  v_mfma_f32_16x16x32_bf16 v[136:139], a[144:147], v[84:87], v[136:139]
  v_exp_f32 v223, v151
  v_mfma_f32_16x16x32_bf16 v[132:135], a[148:151], v[80:83], v[132:135]
  ds_read_b128 a[180:183], v3 offset:21504
  buffer_load_dwordx4 v2, s[44:47], s26 offen offset:1024 sc1 lds
  v_add_f32 v226, v226, v220
  v_mfma_f32_16x16x32_bf16 v[140:143], a[148:151], v[84:87], v[140:143]
  v_exp_f32 v216, v152
  v_mfma_f32_16x16x32_bf16 v[128:131], a[152:155], v[88:91], v[128:131]
  ds_read_b128 a[184:187], v3 offset:22528
  v_add_f32 v226, v226, v221
  v_cvt_pk_bf16_f32 v186, v220, v221
  v_mfma_f32_16x16x32_bf16 v[136:139], a[152:155], v[92:95], v[136:139]
  v_exp_f32 v217, v153
  v_mfma_f32_16x16x32_bf16 v[132:135], a[156:159], v[88:91], v[132:135]
  ds_read_b128 a[188:191], v3 offset:23552
  buffer_load_dwordx4 v[108:111], v2, s[40:43], s14 offen offset:3072 sc1
  v_add_f32 v226, v226, v222
  v_mfma_f32_16x16x32_bf16 v[140:143], a[156:159], v[92:95], v[140:143]
  s_waitcnt lgkmcnt(4)
  v_exp_f32 v218, v154
  v_mfma_f32_16x16x32_bf16 a[64:67], a[160:163], v[176:179], a[64:67]
  ds_read_b128 a[128:131], v3 offset:0
  v_add_f32 v226, v226, v223
  v_cvt_pk_bf16_f32 v187, v222, v223
  v_mfma_f32_16x16x32_bf16 a[68:71], a[160:163], v[180:183], a[68:71]
  v_exp_f32 v219, v155
  v_mfma_f32_16x16x32_bf16 a[72:75], a[164:167], v[176:179], a[72:75]
  ds_read_b128 a[132:135], v3 offset:1024
  buffer_load_dwordx4 v2, s[44:47], s26 offen offset:2048 sc1 lds
  v_add_f32 v227, v216, v217
  v_mfma_f32_16x16x32_bf16 a[76:79], a[164:167], v[180:183], a[76:79]
  v_exp_f32 v220, v156
  v_mfma_f32_16x16x32_bf16 a[80:83], a[168:171], v[176:179], a[80:83]
  ds_read_b128 a[136:139], v3 offset:2048
  v_cvt_pk_bf16_f32 v188, v216, v217
  v_mfma_f32_16x16x32_bf16 a[84:87], a[168:171], v[180:183], a[84:87]
  v_exp_f32 v221, v157
  v_mfma_f32_16x16x32_bf16 a[88:91], a[172:175], v[176:179], a[88:91]
  s_add_u32 s14, s13, 45056
  ds_read_b128 a[140:143], v3 offset:3072
  buffer_load_dwordx4 v[112:115], v2, s[40:43], s14 offen offset:0 sc1
  v_add_f32 v227, v227, v218
  v_add_f32 v227, v227, v219
  v_mfma_f32_16x16x32_bf16 a[92:95], a[172:175], v[180:183], a[92:95]
  s_waitcnt lgkmcnt(4)
  v_exp_f32 v222, v158
  v_mfma_f32_16x16x32_bf16 a[96:99], a[176:179], v[176:179], a[96:99]
  ds_read_b128 a[144:147], v3 offset:4096
  buffer_load_dwordx4 v2, s[44:47], s26 offen offset:3072 sc1 lds
  v_cvt_pk_bf16_f32 v189, v218, v219
  v_mfma_f32_16x16x32_bf16 a[100:103], a[176:179], v[180:183], a[100:103]
  s_add_u32 s26, s26, 16384
  v_exp_f32 v223, v159
  v_mfma_f32_16x16x32_bf16 a[104:107], a[180:183], v[176:179], a[104:107]
  s_add_u32 s24, s24, 32768
  ds_read_b128 a[148:151], v3 offset:5120
  v_add_f32 v227, v227, v220
  v_mfma_f32_16x16x32_bf16 a[108:111], a[180:183], v[180:183], a[108:111]
  s_and_b32 s24, s24, 0x1ffff
  v_add_f32 v227, v227, v221
  v_cvt_pk_bf16_f32 v190, v220, v221
  v_add_f32 v227, v227, v222
  v_mfma_f32_16x16x32_bf16 a[112:115], a[184:187], v[176:179], a[112:115]
  ds_read_b128 a[152:155], v3 offset:6144
  v_add_f32 v227, v227, v223
  v_max_f32 v5, v226, v227
  v_cmp_lt_f32 vcc, s81, v5
  v_mfma_f32_16x16x32_bf16 a[116:119], a[184:187], v[180:183], a[116:119]
  v_exp_f32 v216, v128
  v_mfma_f32_16x16x32_bf16 a[120:123], a[188:191], v[176:179], a[120:123]
  s_waitcnt lgkmcnt(3)
  ds_read_b128 a[156:159], v3 offset:7168
  v_cvt_pk_bf16_f32 v191, v222, v223
  v_mfma_f32_16x16x32_bf16 a[124:127], a[188:191], v[180:183], a[124:127]
  s_cbranch_vccnz fa_stub26
fa_back26:
  v_exp_f32 v217, v129
  v_add_f32 v230, v230, v226
  v_add_f32 v231, v231, v227
  v_mfma_f32_16x16x32_bf16 v[144:147], a[128:131], v[64:67], v[200:203]
  ds_read_b128 a[160:163], v3 offset:24576
  v_add_f32 v226, v216, v217
  v_mfma_f32_16x16x32_bf16 v[152:155], a[128:131], v[68:71], v[204:207]
  v_exp_f32 v218, v130
  v_mfma_f32_16x16x32_bf16 v[148:151], a[132:135], v[64:67], v[200:203]
  s_add_u32 s66, s66, 32768
  ds_read_b128 a[164:167], v3 offset:25600
  v_cvt_pk_bf16_f32 v176, v216, v217
  v_mfma_f32_16x16x32_bf16 v[156:159], a[132:135], v[68:71], v[204:207]
  s_mov_b32 m0, s25
  v_exp_f32 v219, v131
  v_mfma_f32_16x16x32_bf16 v[144:147], a[136:139], v[72:75], v[144:147]
  s_and_b32 s66, s66, 0x1ffff
  ds_read_b128 a[168:171], v3 offset:26624
  buffer_load_dwordx4 v2, s[48:51], s27 offen offset:0 sc1 lds
  v_add_f32 v226, v226, v218
  v_add_f32 v226, v226, v219
  v_mfma_f32_16x16x32_bf16 v[152:155], a[136:139], v[76:79], v[152:155]
  v_exp_f32 v220, v132
  v_mfma_f32_16x16x32_bf16 v[148:151], a[140:143], v[72:75], v[148:151]
  ds_read_b128 a[172:175], v3 offset:27648
  v_cvt_pk_bf16_f32 v177, v218, v219
  v_mfma_f32_16x16x32_bf16 v[156:159], a[140:143], v[76:79], v[156:159]
  s_waitcnt lgkmcnt(4)
  v_exp_f32 v221, v133
  v_mfma_f32_16x16x32_bf16 v[144:147], a[144:147], v[80:83], v[144:147]
  s_add_u32 s14, s13, 45056
  ds_read_b128 a[176:179], v3 offset:28672
  buffer_load_dwordx4 v[116:119], v2, s[40:43], s14 offen offset:1024 sc1
  v_add_f32 v226, v226, v220
  v_mfma_f32_16x16x32_bf16 v[152:155], a[144:147], v[84:87], v[152:155]
  v_exp_f32 v222, v134
  v_mfma_f32_16x16x32_bf16 v[148:151], a[148:151], v[80:83], v[148:151]
  ds_read_b128 a[180:183], v3 offset:29696
  buffer_load_dwordx4 v2, s[48:51], s27 offen offset:1024 sc1 lds
  v_add_f32 v226, v226, v221
  v_cvt_pk_bf16_f32 v178, v220, v221
  v_mfma_f32_16x16x32_bf16 v[156:159], a[148:151], v[84:87], v[156:159]
  v_exp_f32 v223, v135
  v_mfma_f32_16x16x32_bf16 v[144:147], a[152:155], v[88:91], v[144:147]
  ds_read_b128 a[184:187], v3 offset:30720
  v_add_f32 v226, v226, v222
  v_mfma_f32_16x16x32_bf16 v[152:155], a[152:155], v[92:95], v[152:155]
  v_exp_f32 v216, v136
  v_mfma_f32_16x16x32_bf16 v[148:151], a[156:159], v[88:91], v[148:151]
  ds_read_b128 a[188:191], v3 offset:31744
  buffer_load_dwordx4 v[120:123], v2, s[40:43], s14 offen offset:2048 sc1
  v_add_f32 v226, v226, v223
  v_exp_f32 v217, v137
  v_mfma_f32_16x16x32_bf16 v[156:159], a[156:159], v[92:95], v[156:159]
  s_waitcnt lgkmcnt(4)
  v_exp_f32 v218, v138
  v_mfma_f32_16x16x32_bf16 a[64:67], a[160:163], v[184:187], a[64:67]
  ds_read_b128 a[128:131], v3 offset:8192
  v_cvt_pk_bf16_f32 v179, v222, v223
  v_mfma_f32_16x16x32_bf16 a[68:71], a[160:163], v[188:191], a[68:71]
  v_exp_f32 v219, v139
  v_mfma_f32_16x16x32_bf16 a[72:75], a[164:167], v[184:187], a[72:75]
  ds_read_b128 a[132:135], v3 offset:9216
  buffer_load_dwordx4 v2, s[48:51], s27 offen offset:2048 sc1 lds
  v_add_f32 v227, v216, v217
  v_mfma_f32_16x16x32_bf16 a[76:79], a[164:167], v[188:191], a[76:79]
  v_exp_f32 v220, v140
  v_mfma_f32_16x16x32_bf16 a[80:83], a[168:171], v[184:187], a[80:83]
  ds_read_b128 a[136:139], v3 offset:10240
  v_cvt_pk_bf16_f32 v180, v216, v217
  v_mfma_f32_16x16x32_bf16 a[84:87], a[168:171], v[188:191], a[84:87]
  v_exp_f32 v221, v141
  v_mfma_f32_16x16x32_bf16 a[88:91], a[172:175], v[184:187], a[88:91]
  ds_read_b128 a[140:143], v3 offset:11264
  buffer_load_dwordx4 v[124:127], v2, s[40:43], s14 offen offset:3072 sc1
  v_add_f32 v227, v227, v218
  v_mfma_f32_16x16x32_bf16 a[92:95], a[172:175], v[188:191], a[92:95]
  s_waitcnt lgkmcnt(4)
  v_exp_f32 v222, v142
  v_mfma_f32_16x16x32_bf16 a[96:99], a[176:179], v[184:187], a[96:99]
  ds_read_b128 a[144:147], v3 offset:12288
  buffer_load_dwordx4 v2, s[48:51], s27 offen offset:3072 sc1 lds
  v_add_f32 v227, v227, v219
  v_cvt_pk_bf16_f32 v181, v218, v219
  v_mfma_f32_16x16x32_bf16 a[100:103], a[176:179], v[188:191], a[100:103]
  s_add_u32 s27, s27, 16384
  v_exp_f32 v223, v143
  v_mfma_f32_16x16x32_bf16 a[104:107], a[180:183], v[184:187], a[104:107]
  s_add_u32 s25, s25, 32768
  ds_read_b128 a[148:151], v3 offset:13312
  v_add_f32 v227, v227, v220
  v_mfma_f32_16x16x32_bf16 a[108:111], a[180:183], v[188:191], a[108:111]
  s_and_b32 s25, s25, 0x1ffff
  v_add_f32 v227, v227, v221
  v_cvt_pk_bf16_f32 v182, v220, v221
  v_add_f32 v227, v227, v222
  v_mfma_f32_16x16x32_bf16 a[112:115], a[184:187], v[184:187], a[112:115]
  ds_read_b128 a[152:155], v3 offset:14336
  v_add_f32 v227, v227, v223
  v_max_f32 v5, v226, v227
  v_cmp_lt_f32 vcc, s81, v5
  v_mfma_f32_16x16x32_bf16 a[116:119], a[184:187], v[188:191], a[116:119]
  v_exp_f32 v216, v144
  v_mfma_f32_16x16x32_bf16 a[120:123], a[188:191], v[184:187], a[120:123]
  s_waitcnt lgkmcnt(3)
  ds_read_b128 a[156:159], v3 offset:15360
  v_cvt_pk_bf16_f32 v183, v222, v223
  v_add_u32 v3, s66, v2
  v_mfma_f32_16x16x32_bf16 a[124:127], a[188:191], v[188:191], a[124:127]
  s_cbranch_vccnz fa_stub27
fa_back27:
  v_exp_f32 v217, v145
  v_add_f32 v230, v230, v226
  v_add_f32 v231, v231, v227
fa_Bexit:
  s_bitcmp1_b32 s20, 0
  s_cbranch_scc1 fa_Bodd
  v_mfma_f32_16x16x32_bf16 v[128:131], a[128:131], v[64:67], v[200:203]
  s_waitcnt vmcnt(0)
  v_exp_f32 v218, v146
  v_mfma_f32_16x16x32_bf16 v[136:139], a[128:131], v[68:71], v[204:207]
  s_barrier
  v_exp_f32 v219, v147
  v_mfma_f32_16x16x32_bf16 v[132:135], a[132:135], v[64:67], v[200:203]
  ds_read_b128 a[160:163], v3 offset:16384
  ds_read_b128 a[164:167], v3 offset:17408
  v_add_f32 v226, v216, v217
  v_mfma_f32_16x16x32_bf16 v[140:143], a[132:135], v[68:71], v[204:207]
  s_add_u32 s14, s13, 49152
  buffer_load_dwordx4 v[160:163], v2, s[40:43], s14 offen offset:0 sc1
  v_cvt_pk_bf16_f32 v184, v216, v217
  v_mfma_f32_16x16x32_bf16 v[128:131], a[136:139], v[72:75], v[128:131]
  ds_read_b128 a[168:171], v3 offset:18432
  v_add_f32 v226, v226, v218
  v_mfma_f32_16x16x32_bf16 v[136:139], a[136:139], v[76:79], v[136:139]
  v_exp_f32 v220, v148
  v_mfma_f32_16x16x32_bf16 v[132:135], a[140:143], v[72:75], v[132:135]
  ds_read_b128 a[172:175], v3 offset:19456
  v_add_f32 v226, v226, v219
  v_cvt_pk_bf16_f32 v185, v218, v219
  v_mfma_f32_16x16x32_bf16 v[140:143], a[140:143], v[76:79], v[140:143]
  s_waitcnt lgkmcnt(4)
  buffer_load_dwordx4 v[164:167], v2, s[40:43], s14 offen offset:1024 sc1
  v_add_f32 v226, v226, v220
  v_mfma_f32_16x16x32_bf16 v[128:131], a[144:147], v[80:83], v[128:131]
  ds_read_b128 a[176:179], v3 offset:20480
  v_mfma_f32_16x16x32_bf16 v[136:139], a[144:147], v[84:87], v[136:139]
  v_exp_f32 v221, v149
  v_mfma_f32_16x16x32_bf16 v[132:135], a[148:151], v[80:83], v[132:135]
  ds_read_b128 a[180:183], v3 offset:21504
  v_add_f32 v226, v226, v221
  v_mfma_f32_16x16x32_bf16 v[140:143], a[148:151], v[84:87], v[140:143]
  v_exp_f32 v222, v150
  v_mfma_f32_16x16x32_bf16 v[128:131], a[152:155], v[88:91], v[128:131]
  ds_read_b128 a[184:187], v3 offset:22528
  buffer_load_dwordx4 v[168:171], v2, s[40:43], s14 offen offset:2048 sc1
  v_cvt_pk_bf16_f32 v186, v220, v221
  v_mfma_f32_16x16x32_bf16 v[136:139], a[152:155], v[92:95], v[136:139]
  v_exp_f32 v223, v151
  v_mfma_f32_16x16x32_bf16 v[132:135], a[156:159], v[88:91], v[132:135]
  ds_read_b128 a[188:191], v3 offset:23552
  v_add_f32 v226, v226, v222
  v_add_f32 v226, v226, v223
  v_mfma_f32_16x16x32_bf16 v[140:143], a[156:159], v[92:95], v[140:143]
  s_waitcnt lgkmcnt(4)
  v_exp_f32 v216, v152
  v_mfma_f32_16x16x32_bf16 a[64:67], a[160:163], v[176:179], a[64:67]
  v_exp_f32 v217, v153
  v_mfma_f32_16x16x32_bf16 a[68:71], a[160:163], v[180:183], a[68:71]
  buffer_load_dwordx4 v[172:175], v2, s[40:43], s14 offen offset:3072 sc1
  v_cvt_pk_bf16_f32 v187, v222, v223
  v_add_f32 v227, v216, v217
  v_mfma_f32_16x16x32_bf16 a[72:75], a[164:167], v[176:179], a[72:75]
  v_exp_f32 v218, v154
  v_mfma_f32_16x16x32_bf16 a[76:79], a[164:167], v[180:183], a[76:79]
  v_exp_f32 v219, v155
  v_mfma_f32_16x16x32_bf16 a[80:83], a[168:171], v[176:179], a[80:83]
  v_exp_f32 v220, v156
  v_mfma_f32_16x16x32_bf16 a[84:87], a[168:171], v[180:183], a[84:87]
  s_add_u32 s14, s13, 53248
  buffer_load_dwordx4 v[192:195], v2, s[40:43], s14 offen offset:0 sc1
  v_cvt_pk_bf16_f32 v188, v216, v217
  v_add_f32 v227, v227, v218
  v_mfma_f32_16x16x32_bf16 a[88:91], a[172:175], v[176:179], a[88:91]
  v_exp_f32 v221, v157
  v_mfma_f32_16x16x32_bf16 a[92:95], a[172:175], v[180:183], a[92:95]
  s_waitcnt lgkmcnt(0)
  v_exp_f32 v222, v158
  v_mfma_f32_16x16x32_bf16 a[96:99], a[176:179], v[176:179], a[96:99]
  v_add_f32 v227, v227, v219
  v_cvt_pk_bf16_f32 v189, v218, v219
  v_mfma_f32_16x16x32_bf16 a[100:103], a[176:179], v[180:183], a[100:103]
  v_exp_f32 v223, v159
  v_mfma_f32_16x16x32_bf16 a[104:107], a[180:183], v[176:179], a[104:107]
  buffer_load_dwordx4 v[196:199], v2, s[40:43], s14 offen offset:1024 sc1
  v_add_f32 v227, v227, v220
  v_mfma_f32_16x16x32_bf16 a[108:111], a[180:183], v[180:183], a[108:111]
  v_add_f32 v227, v227, v221
  v_cvt_pk_bf16_f32 v190, v220, v221
  v_add_f32 v227, v227, v222
  v_mfma_f32_16x16x32_bf16 a[112:115], a[184:187], v[176:179], a[112:115]
  v_add_f32 v227, v227, v223
  v_max_f32 v5, v226, v227
  v_cmp_lt_f32 vcc, s81, v5
  v_mfma_f32_16x16x32_bf16 a[116:119], a[184:187], v[180:183], a[116:119]
  v_exp_f32 v216, v128
  v_mfma_f32_16x16x32_bf16 a[120:123], a[188:191], v[176:179], a[120:123]
  v_cvt_pk_bf16_f32 v191, v222, v223
  v_mfma_f32_16x16x32_bf16 a[124:127], a[188:191], v[180:183], a[124:127]
  s_cbranch_vccnz fa_stub28
fa_back28:
  v_exp_f32 v217, v129
  v_add_f32 v230, v230, v226
  v_add_f32 v231, v231, v227
  ds_read_b128 a[160:163], v3 offset:24576
  ds_read_b128 a[164:167], v3 offset:25600
  ds_read_b128 a[168:171], v3 offset:26624
  ds_read_b128 a[172:175], v3 offset:27648
  ds_read_b128 a[176:179], v3 offset:28672
  ds_read_b128 a[180:183], v3 offset:29696
  ds_read_b128 a[184:187], v3 offset:30720
  ds_read_b128 a[188:191], v3 offset:31744
  v_cndmask_b32 v128, v4, v128, s[68:69]
  v_cndmask_b32 v129, v4, v129, s[70:71]
  v_cndmask_b32 v130, v4, v130, s[72:73]
  v_cndmask_b32 v131, v4, v131, s[74:75]
  v_mov_b32 v132, v4
  v_mov_b32 v133, v4
  v_mov_b32 v134, v4
  v_mov_b32 v135, v4
  v_cndmask_b32 v140, v4, v140, s[68:69]
  v_cndmask_b32 v141, v4, v141, s[70:71]
  v_cndmask_b32 v142, v4, v142, s[72:73]
  v_cndmask_b32 v143, v4, v143, s[74:75]
  v_exp_f32 v216, v128
  v_exp_f32 v217, v129
  v_exp_f32 v218, v130
  v_add_f32 v226, v216, v217
  v_cvt_pk_bf16_f32 v176, v216, v217
  v_add_f32 v226, v226, v218
  v_exp_f32 v219, v131
  v_exp_f32 v220, v132
  v_add_f32 v226, v226, v219
  v_cvt_pk_bf16_f32 v177, v218, v219
  v_add_f32 v226, v226, v220
  v_exp_f32 v221, v133
  s_waitcnt lgkmcnt(4)
  v_mfma_f32_16x16x32_bf16 a[64:67], a[160:163], v[184:187], a[64:67]
  v_exp_f32 v222, v134
  v_add_f32 v226, v226, v221
  v_mfma_f32_16x16x32_bf16 a[68:71], a[160:163], v[188:191], a[68:71]
  s_add_u32 s14, s13, 53248
  buffer_load_dwordx4 v[208:211], v2, s[40:43], s14 offen offset:2048 sc1
  v_exp_f32 v223, v135
  v_mfma_f32_16x16x32_bf16 a[72:75], a[164:167], v[184:187], a[72:75]
  s_add_u32 s66, s66, 32768
  v_exp_f32 v216, v136
  v_mfma_f32_16x16x32_bf16 a[76:79], a[164:167], v[188:191], a[76:79]
  s_and_b32 s66, s66, 0x1ffff
  v_exp_f32 v217, v137
  v_mfma_f32_16x16x32_bf16 a[80:83], a[168:171], v[184:187], a[80:83]
  buffer_load_dwordx4 v[212:215], v2, s[40:43], s14 offen offset:3072 sc1
  v_cvt_pk_bf16_f32 v178, v220, v221
  v_add_f32 v226, v226, v222
  v_add_f32 v226, v226, v223
  v_cvt_pk_bf16_f32 v179, v222, v223
  v_mfma_f32_16x16x32_bf16 a[84:87], a[168:171], v[188:191], a[84:87]
  v_exp_f32 v218, v138
  v_mfma_f32_16x16x32_bf16 a[88:91], a[172:175], v[184:187], a[88:91]
  v_exp_f32 v219, v139
  v_mfma_f32_16x16x32_bf16 a[92:95], a[172:175], v[188:191], a[92:95]
  s_waitcnt lgkmcnt(0)
  v_exp_f32 v220, v140
  v_mfma_f32_16x16x32_bf16 a[96:99], a[176:179], v[184:187], a[96:99]
  s_add_u32 s14, s13, 57344
  buffer_load_dwordx4 v[232:235], v2, s[40:43], s14 offen offset:0 sc1
  v_add_f32 v227, v216, v217
  v_cvt_pk_bf16_f32 v180, v216, v217
  v_add_f32 v227, v227, v218
  v_add_f32 v227, v227, v219
  v_cvt_pk_bf16_f32 v181, v218, v219
  v_exp_f32 v221, v141
  v_mfma_f32_16x16x32_bf16 a[100:103], a[176:179], v[188:191], a[100:103]
  v_exp_f32 v222, v142
  v_mfma_f32_16x16x32_bf16 a[104:107], a[180:183], v[184:187], a[104:107]
  v_exp_f32 v223, v143
  v_mfma_f32_16x16x32_bf16 a[108:111], a[180:183], v[188:191], a[108:111]
  buffer_load_dwordx4 v[236:239], v2, s[40:43], s14 offen offset:1024 sc1
  v_add_f32 v227, v227, v220
  v_add_f32 v227, v227, v221
  v_cvt_pk_bf16_f32 v182, v220, v221
  v_add_f32 v227, v227, v222
  v_mfma_f32_16x16x32_bf16 a[112:115], a[184:187], v[184:187], a[112:115]
  v_add_f32 v227, v227, v223
  v_max_f32 v5, v226, v227
  v_cmp_lt_f32 vcc, s81, v5
  v_mfma_f32_16x16x32_bf16 a[116:119], a[184:187], v[188:191], a[116:119]
  v_mfma_f32_16x16x32_bf16 a[120:123], a[188:191], v[184:187], a[120:123]
  v_cvt_pk_bf16_f32 v183, v222, v223
  v_add_u32 v3, s66, v2
  v_mfma_f32_16x16x32_bf16 a[124:127], a[188:191], v[188:191], a[124:127]
  s_cbranch_vccnz fa_stub29
fa_back29:
  v_add_f32 v230, v230, v226
  v_add_f32 v231, v231, v227
  s_waitcnt vmcnt(10)
  s_barrier
  ds_read_b128 a[160:163], v3 offset:16384
  ds_read_b128 a[164:167], v3 offset:17408
  ds_read_b128 a[168:171], v3 offset:18432
  ds_read_b128 a[172:175], v3 offset:19456
  ds_read_b128 a[176:179], v3 offset:20480
  ds_read_b128 a[180:183], v3 offset:21504
  ds_read_b128 a[184:187], v3 offset:22528
  ds_read_b128 a[188:191], v3 offset:23552
  s_waitcnt lgkmcnt(4)
  v_mfma_f32_16x16x32_bf16 a[64:67], a[160:163], v[176:179], a[64:67]
  v_mfma_f32_16x16x32_bf16 a[68:71], a[160:163], v[180:183], a[68:71]
  s_add_u32 s14, s13, 57344
  buffer_load_dwordx4 v[240:243], v2, s[40:43], s14 offen offset:2048 sc1
  v_mfma_f32_16x16x32_bf16 a[72:75], a[164:167], v[176:179], a[72:75]
  v_mfma_f32_16x16x32_bf16 a[76:79], a[164:167], v[180:183], a[76:79]
  v_mfma_f32_16x16x32_bf16 a[80:83], a[168:171], v[176:179], a[80:83]
  v_mfma_f32_16x16x32_bf16 a[84:87], a[168:171], v[180:183], a[84:87]
  v_mfma_f32_16x16x32_bf16 a[88:91], a[172:175], v[176:179], a[88:91]
  v_mfma_f32_16x16x32_bf16 a[92:95], a[172:175], v[180:183], a[92:95]
  s_waitcnt lgkmcnt(0)
  v_mfma_f32_16x16x32_bf16 a[96:99], a[176:179], v[176:179], a[96:99]
  buffer_load_dwordx4 v[244:247], v2, s[40:43], s14 offen offset:3072 sc1
  v_mfma_f32_16x16x32_bf16 a[100:103], a[176:179], v[180:183], a[100:103]
  v_mfma_f32_16x16x32_bf16 a[104:107], a[180:183], v[176:179], a[104:107]
  v_mfma_f32_16x16x32_bf16 a[108:111], a[180:183], v[180:183], a[108:111]
  v_mfma_f32_16x16x32_bf16 a[112:115], a[184:187], v[176:179], a[112:115]
  v_mfma_f32_16x16x32_bf16 a[116:119], a[184:187], v[180:183], a[116:119]
  v_mfma_f32_16x16x32_bf16 a[120:123], a[188:191], v[176:179], a[120:123]
  v_mfma_f32_16x16x32_bf16 a[124:127], a[188:191], v[180:183], a[124:127]
  s_branch fa_Bdone
fa_Bodd:
  s_waitcnt vmcnt(0)
  s_barrier
  ds_read_b128 a[160:163], v3 offset:16384
  ds_read_b128 a[164:167], v3 offset:17408
  ds_read_b128 a[168:171], v3 offset:18432
  ds_read_b128 a[172:175], v3 offset:19456
  ds_read_b128 a[176:179], v3 offset:20480
  ds_read_b128 a[180:183], v3 offset:21504
  ds_read_b128 a[184:187], v3 offset:22528
  ds_read_b128 a[188:191], v3 offset:23552
  v_cndmask_b32 v144, v4, v144, s[68:69]
  v_cndmask_b32 v145, v4, v145, s[70:71]
  v_cndmask_b32 v146, v4, v146, s[72:73]
  v_cndmask_b32 v147, v4, v147, s[74:75]
  v_mov_b32 v148, v4
  v_mov_b32 v149, v4
  v_mov_b32 v150, v4
  v_mov_b32 v151, v4
  v_cndmask_b32 v156, v4, v156, s[68:69]
  v_cndmask_b32 v157, v4, v157, s[70:71]
  v_cndmask_b32 v158, v4, v158, s[72:73]
  v_cndmask_b32 v159, v4, v159, s[74:75]
  v_exp_f32 v216, v144
  v_exp_f32 v217, v145
  v_exp_f32 v218, v146
  v_add_f32 v226, v216, v217
  v_cvt_pk_bf16_f32 v184, v216, v217
  v_add_f32 v226, v226, v218
  v_exp_f32 v219, v147
  v_exp_f32 v220, v148
  v_add_f32 v226, v226, v219
  v_cvt_pk_bf16_f32 v185, v218, v219
  v_add_f32 v226, v226, v220
  v_exp_f32 v221, v149
  s_waitcnt lgkmcnt(4)
  v_mfma_f32_16x16x32_bf16 a[64:67], a[160:163], v[176:179], a[64:67]
  v_exp_f32 v222, v150
  v_add_f32 v226, v226, v221
  v_mfma_f32_16x16x32_bf16 a[68:71], a[160:163], v[180:183], a[68:71]
  s_add_u32 s14, s13, 49152
  buffer_load_dwordx4 v[160:163], v2, s[40:43], s14 offen offset:0 sc1
  v_exp_f32 v223, v151
  v_mfma_f32_16x16x32_bf16 a[72:75], a[164:167], v[176:179], a[72:75]
  v_exp_f32 v216, v152
  v_cvt_pk_bf16_f32 v186, v220, v221
  v_add_f32 v226, v226, v222
  v_mfma_f32_16x16x32_bf16 a[76:79], a[164:167], v[180:183], a[76:79]
  buffer_load_dwordx4 v[164:167], v2, s[40:43], s14 offen offset:1024 sc1
  v_exp_f32 v217, v153
  v_mfma_f32_16x16x32_bf16 a[80:83], a[168:171], v[176:179], a[80:83]
  v_exp_f32 v218, v154
  v_add_f32 v226, v226, v223
  v_mfma_f32_16x16x32_bf16 a[84:87], a[168:171], v[180:183], a[84:87]
  buffer_load_dwordx4 v[168:171], v2, s[40:43], s14 offen offset:2048 sc1
  v_exp_f32 v219, v155
  v_cvt_pk_bf16_f32 v187, v222, v223
  v_mfma_f32_16x16x32_bf16 a[88:91], a[172:175], v[176:179], a[88:91]
  v_exp_f32 v220, v156
  v_mfma_f32_16x16x32_bf16 a[92:95], a[172:175], v[180:183], a[92:95]
  s_waitcnt lgkmcnt(0)
  buffer_load_dwordx4 v[172:175], v2, s[40:43], s14 offen offset:3072 sc1
  v_add_f32 v227, v216, v217
  v_cvt_pk_bf16_f32 v188, v216, v217
  v_add_f32 v227, v227, v218
  v_mfma_f32_16x16x32_bf16 a[96:99], a[176:179], v[176:179], a[96:99]
  v_exp_f32 v221, v157
  v_mfma_f32_16x16x32_bf16 a[100:103], a[176:179], v[180:183], a[100:103]
  s_add_u32 s14, s13, 53248
  buffer_load_dwordx4 v[192:195], v2, s[40:43], s14 offen offset:0 sc1
  v_exp_f32 v222, v158
  v_mfma_f32_16x16x32_bf16 a[104:107], a[180:183], v[176:179], a[104:107]
  v_exp_f32 v223, v159
  v_mfma_f32_16x16x32_bf16 a[108:111], a[180:183], v[180:183], a[108:111]
  buffer_load_dwordx4 v[196:199], v2, s[40:43], s14 offen offset:1024 sc1
  v_add_f32 v227, v227, v219
  v_cvt_pk_bf16_f32 v189, v218, v219
  v_add_f32 v227, v227, v220
  v_add_f32 v227, v227, v221
  v_cvt_pk_bf16_f32 v190, v220, v221
  v_add_f32 v227, v227, v222
  v_mfma_f32_16x16x32_bf16 a[112:115], a[184:187], v[176:179], a[112:115]
  v_add_f32 v227, v227, v223
  v_max_f32 v5, v226, v227
  v_cmp_lt_f32 vcc, s81, v5
  v_mfma_f32_16x16x32_bf16 a[116:119], a[184:187], v[180:183], a[116:119]
  buffer_load_dwordx4 v[208:211], v2, s[40:43], s14 offen offset:2048 sc1
  v_mfma_f32_16x16x32_bf16 a[120:123], a[188:191], v[176:179], a[120:123]
  v_cvt_pk_bf16_f32 v191, v222, v223
  v_mfma_f32_16x16x32_bf16 a[124:127], a[188:191], v[180:183], a[124:127]
  s_cbranch_vccnz fa_stub30
fa_back30:
  v_add_f32 v230, v230, v226
  v_add_f32 v231, v231, v227
  ds_read_b128 a[160:163], v3 offset:24576
  ds_read_b128 a[164:167], v3 offset:25600
  ds_read_b128 a[168:171], v3 offset:26624
  ds_read_b128 a[172:175], v3 offset:27648
  ds_read_b128 a[176:179], v3 offset:28672
  ds_read_b128 a[180:183], v3 offset:29696
  ds_read_b128 a[184:187], v3 offset:30720
  ds_read_b128 a[188:191], v3 offset:31744
  s_waitcnt lgkmcnt(4)
  v_mfma_f32_16x16x32_bf16 a[64:67], a[160:163], v[184:187], a[64:67]
  v_mfma_f32_16x16x32_bf16 a[68:71], a[160:163], v[188:191], a[68:71]
  s_add_u32 s14, s13, 53248
  buffer_load_dwordx4 v[212:215], v2, s[40:43], s14 offen offset:3072 sc1
  v_mfma_f32_16x16x32_bf16 a[72:75], a[164:167], v[184:187], a[72:75]
  s_add_u32 s66, s66, 32768
  v_mfma_f32_16x16x32_bf16 a[76:79], a[164:167], v[188:191], a[76:79]
  s_add_u32 s14, s13, 57344
  buffer_load_dwordx4 v[232:235], v2, s[40:43], s14 offen offset:0 sc1
  v_mfma_f32_16x16x32_bf16 a[80:83], a[168:171], v[184:187], a[80:83]
  s_and_b32 s66, s66, 0x1ffff
  v_mfma_f32_16x16x32_bf16 a[84:87], a[168:171], v[188:191], a[84:87]
  v_mfma_f32_16x16x32_bf16 a[88:91], a[172:175], v[184:187], a[88:91]
  buffer_load_dwordx4 v[236:239], v2, s[40:43], s14 offen offset:1024 sc1
  v_mfma_f32_16x16x32_bf16 a[92:95], a[172:175], v[188:191], a[92:95]
  s_waitcnt lgkmcnt(0)
  v_mfma_f32_16x16x32_bf16 a[96:99], a[176:179], v[184:187], a[96:99]
  v_mfma_f32_16x16x32_bf16 a[100:103], a[176:179], v[188:191], a[100:103]
  buffer_load_dwordx4 v[240:243], v2, s[40:43], s14 offen offset:2048 sc1
  v_mfma_f32_16x16x32_bf16 a[104:107], a[180:183], v[184:187], a[104:107]
  v_mfma_f32_16x16x32_bf16 a[108:111], a[180:183], v[188:191], a[108:111]
  v_mfma_f32_16x16x32_bf16 a[112:115], a[184:187], v[184:187], a[112:115]
  buffer_load_dwordx4 v[244:247], v2, s[40:43], s14 offen offset:3072 sc1
  v_mfma_f32_16x16x32_bf16 a[116:119], a[184:187], v[188:191], a[116:119]
  v_mfma_f32_16x16x32_bf16 a[120:123], a[188:191], v[184:187], a[120:123]
  v_add_u32 v3, s66, v2
  v_mfma_f32_16x16x32_bf16 a[124:127], a[188:191], v[188:191], a[124:127]
fa_Bdone:
  s_cmp_ge_u32 s20, 2
  s_cbranch_scc1 fa_epi
  s_barrier
fa_epi:
  v_mov_b32 v20, v230
  v_mov_b32 v21, v231
  s_nop 1
  v_permlane16_swap_b32 v230, v20
  v_permlane16_swap_b32 v231, v21
  v_add_f32 v230, v230, v20
  v_add_f32 v231, v231, v21
  v_mov_b32 v20, v230
  v_mov_b32 v21, v231
  s_nop 1
  v_permlane32_swap_b32 v230, v20
  v_permlane32_swap_b32 v231, v21
  v_add_f32 v230, v230, v20
  v_add_f32 v231, v231, v21
  v_rcp_f32 v16, v230
  v_rcp_f32 v18, v231
  s_sub_u32 s23, 15, s22
  s_lshl_b32 s23, s23, 2
  v_mov_b32 v17, v16
  v_mov_b32 v19, v18
  s_add_u32 s23, s23, s20
  s_lshl_b32 s23, s23, 18
  s_lshl_b32 s31, s21, 12
  s_add_u32 s31, s31, 50331648
  s_add_u32 s64, s23, s31
  s_add_u32 s65, s64, 131072
  v_accvgpr_read_b32 v68, a64
  v_accvgpr_read_b32 v69, a65
  v_accvgpr_read_b32 v70, a66
  v_accvgpr_read_b32 v71, a67
  v_accvgpr_read_b32 v72, a72
  v_accvgpr_read_b32 v73, a73
  v_accvgpr_read_b32 v74, a74
  v_accvgpr_read_b32 v75, a75
  v_pk_mul_f32 v[68:69], v[68:69], v[16:17]
  v_pk_mul_f32 v[70:71], v[70:71], v[16:17]
  v_pk_mul_f32 v[72:73], v[72:73], v[16:17]
  v_pk_mul_f32 v[74:75], v[74:75], v[16:17]
  v_cvt_pk_bf16_f32 v64, v68, v69
  v_cvt_pk_bf16_f32 v65, v70, v71
  v_cvt_pk_bf16_f32 v66, v72, v73
  v_cvt_pk_bf16_f32 v67, v74, v75
  buffer_store_dwordx4 v[64:67], v2, s[40:43], s64 offen offset:0 sc1
  v_accvgpr_read_b32 v80, a80
  v_accvgpr_read_b32 v81, a81
  v_accvgpr_read_b32 v82, a82
  v_accvgpr_read_b32 v83, a83
  v_accvgpr_read_b32 v84, a88
  v_accvgpr_read_b32 v85, a89
  v_accvgpr_read_b32 v86, a90
  v_accvgpr_read_b32 v87, a91
  v_pk_mul_f32 v[80:81], v[80:81], v[16:17]
  v_pk_mul_f32 v[82:83], v[82:83], v[16:17]
  v_pk_mul_f32 v[84:85], v[84:85], v[16:17]
  v_pk_mul_f32 v[86:87], v[86:87], v[16:17]
  v_cvt_pk_bf16_f32 v76, v80, v81
  v_cvt_pk_bf16_f32 v77, v82, v83
  v_cvt_pk_bf16_f32 v78, v84, v85
  v_cvt_pk_bf16_f32 v79, v86, v87
  buffer_store_dwordx4 v[76:79], v2, s[40:43], s64 offen offset:1024 sc1
  v_accvgpr_read_b32 v132, a96
  v_accvgpr_read_b32 v133, a97
  v_accvgpr_read_b32 v134, a98
  v_accvgpr_read_b32 v135, a99
  v_accvgpr_read_b32 v136, a104
  v_accvgpr_read_b32 v137, a105
  v_accvgpr_read_b32 v138, a106
  v_accvgpr_read_b32 v139, a107
  v_pk_mul_f32 v[132:133], v[132:133], v[16:17]
  v_pk_mul_f32 v[134:135], v[134:135], v[16:17]
  v_pk_mul_f32 v[136:137], v[136:137], v[16:17]
  v_pk_mul_f32 v[138:139], v[138:139], v[16:17]
  v_cvt_pk_bf16_f32 v128, v132, v133
  v_cvt_pk_bf16_f32 v129, v134, v135
  v_cvt_pk_bf16_f32 v130, v136, v137
  v_cvt_pk_bf16_f32 v131, v138, v139
  buffer_store_dwordx4 v[128:131], v2, s[40:43], s64 offen offset:2048 sc1
  v_accvgpr_read_b32 v144, a112
  v_accvgpr_read_b32 v145, a113
  v_accvgpr_read_b32 v146, a114
  v_accvgpr_read_b32 v147, a115
  v_accvgpr_read_b32 v148, a120
  v_accvgpr_read_b32 v149, a121
  v_accvgpr_read_b32 v150, a122
  v_accvgpr_read_b32 v151, a123
  v_pk_mul_f32 v[144:145], v[144:145], v[16:17]
  v_pk_mul_f32 v[146:147], v[146:147], v[16:17]
  v_pk_mul_f32 v[148:149], v[148:149], v[16:17]
  v_pk_mul_f32 v[150:151], v[150:151], v[16:17]
  v_cvt_pk_bf16_f32 v140, v144, v145
  v_cvt_pk_bf16_f32 v141, v146, v147
  v_cvt_pk_bf16_f32 v142, v148, v149
  v_cvt_pk_bf16_f32 v143, v150, v151
  buffer_store_dwordx4 v[140:143], v2, s[40:43], s64 offen offset:3072 sc1
  v_accvgpr_read_b32 v68, a68
  v_accvgpr_read_b32 v69, a69
  v_accvgpr_read_b32 v70, a70
  v_accvgpr_read_b32 v71, a71
  v_accvgpr_read_b32 v72, a76
  v_accvgpr_read_b32 v73, a77
  v_accvgpr_read_b32 v74, a78
  v_accvgpr_read_b32 v75, a79
  v_pk_mul_f32 v[68:69], v[68:69], v[18:19]
  v_pk_mul_f32 v[70:71], v[70:71], v[18:19]
  v_pk_mul_f32 v[72:73], v[72:73], v[18:19]
  v_pk_mul_f32 v[74:75], v[74:75], v[18:19]
  v_cvt_pk_bf16_f32 v64, v68, v69
  v_cvt_pk_bf16_f32 v65, v70, v71
  v_cvt_pk_bf16_f32 v66, v72, v73
  v_cvt_pk_bf16_f32 v67, v74, v75
  buffer_store_dwordx4 v[64:67], v2, s[40:43], s65 offen offset:0 sc1
  v_accvgpr_read_b32 v80, a84
  v_accvgpr_read_b32 v81, a85
  v_accvgpr_read_b32 v82, a86
  v_accvgpr_read_b32 v83, a87
  v_accvgpr_read_b32 v84, a92
  v_accvgpr_read_b32 v85, a93
  v_accvgpr_read_b32 v86, a94
  v_accvgpr_read_b32 v87, a95
  v_pk_mul_f32 v[80:81], v[80:81], v[18:19]
  v_pk_mul_f32 v[82:83], v[82:83], v[18:19]
  v_pk_mul_f32 v[84:85], v[84:85], v[18:19]
  v_pk_mul_f32 v[86:87], v[86:87], v[18:19]
  v_cvt_pk_bf16_f32 v76, v80, v81
  v_cvt_pk_bf16_f32 v77, v82, v83
  v_cvt_pk_bf16_f32 v78, v84, v85
  v_cvt_pk_bf16_f32 v79, v86, v87
  buffer_store_dwordx4 v[76:79], v2, s[40:43], s65 offen offset:1024 sc1
  v_accvgpr_read_b32 v132, a100
  v_accvgpr_read_b32 v133, a101
  v_accvgpr_read_b32 v134, a102
  v_accvgpr_read_b32 v135, a103
  v_accvgpr_read_b32 v136, a108
  v_accvgpr_read_b32 v137, a109
  v_accvgpr_read_b32 v138, a110
  v_accvgpr_read_b32 v139, a111
  v_pk_mul_f32 v[132:133], v[132:133], v[18:19]
  v_pk_mul_f32 v[134:135], v[134:135], v[18:19]
  v_pk_mul_f32 v[136:137], v[136:137], v[18:19]
  v_pk_mul_f32 v[138:139], v[138:139], v[18:19]
  v_cvt_pk_bf16_f32 v128, v132, v133
  v_cvt_pk_bf16_f32 v129, v134, v135
  v_cvt_pk_bf16_f32 v130, v136, v137
  v_cvt_pk_bf16_f32 v131, v138, v139
  buffer_store_dwordx4 v[128:131], v2, s[40:43], s65 offen offset:2048 sc1
  v_accvgpr_read_b32 v144, a116
  v_accvgpr_read_b32 v145, a117
  v_accvgpr_read_b32 v146, a118
  v_accvgpr_read_b32 v147, a119
  v_accvgpr_read_b32 v148, a124
  v_accvgpr_read_b32 v149, a125
  v_accvgpr_read_b32 v150, a126
  v_accvgpr_read_b32 v151, a127
  v_pk_mul_f32 v[144:145], v[144:145], v[18:19]
  v_pk_mul_f32 v[146:147], v[146:147], v[18:19]
  v_pk_mul_f32 v[148:149], v[148:149], v[18:19]
  v_pk_mul_f32 v[150:151], v[150:151], v[18:19]
  v_cvt_pk_bf16_f32 v140, v144, v145
  v_cvt_pk_bf16_f32 v141, v146, v147
  v_cvt_pk_bf16_f32 v142, v148, v149
  v_cvt_pk_bf16_f32 v143, v150, v151
  buffer_store_dwordx4 v[140:143], v2, s[40:43], s65 offen offset:3072 sc1
  s_cmp_lt_u32 s12, 3
  s_cbranch_scc1 fa_hk9
fa_hb9:
  s_load_dwordx2 s[4:5], s[0:1], 0
  s_load_dwordx2 s[6:7], s[0:1], 88
  v_mov_b32 v30, 1073741824
  v_mov_b32 v31, 1
  v_writelane_b32 v30, s80, 0
  v_writelane_b32 v30, s3, 1
  s_lshl_b32 s64, s21, 19
  s_lshl_b32 s23, s20, 15
  s_add_u32 s64, s64, s23
  s_add_u32 s64, s64, 50331648
  s_add_u32 s65, s64, 131072
  s_add_u32 s66, s64, 262144
  s_add_u32 s67, s64, 393216
  v_bfe_u32 v12, v1, 3, 1
  v_lshlrev_b32 v12, 7, v12
  v_and_b32 v13, 7, v1
  v_lshl_add_u32 v12, v13, 2, v12
  s_lshl_b32 s23, s21, 8
  s_lshl_b32 s31, s20, 5
  s_add_u32 s23, s23, s31
  s_add_u32 s23, s23, 2641920
  v_add_u32 v12, s23, v12
  s_lshl_b32 s25, s21, 6
  s_mul_i32 s26, s22, 160
  s_mul_i32 s27, s22, 2560
  v_add_u32 v16, 0, v0
  v_mul_u32_u24 v17, 6554, v16
  v_lshrrev_b32 v17, 16, v17
  v_mul_u32_u24 v18, 10, v17
  v_sub_u32 v18, v16, v18
  v_mul_u32_u24 v251, 336, v17
  v_lshl_add_u32 v251, v18, 5, v251
  v_lshlrev_b32 v203, 5, v18
  v_add_u32 v17, s25, v17
  v_add_u32 v24, 1, v17
  v_mul_u32_u24 v248, 1280, v17
  v_lshl_add_u32 v248, v18, 4, v248
  v_add_u32 v248, s26, v248
  v_lshrrev_b32 v19, 4, v17
  v_mul_u32_u24 v19, 20480, v19
  v_and_b32 v17, 15, v17
  v_lshl_add_u32 v19, v17, 4, v19
  v_lshl_add_u32 v200, v18, 8, v19
  v_mov_b32 v27, 8
  v_add_u32 v16, 256, v0
  v_mul_u32_u24 v17, 6554, v16
  v_lshrrev_b32 v17, 16, v17
  v_mul_u32_u24 v18, 10, v17
  v_sub_u32 v18, v16, v18
  v_mul_u32_u24 v252, 336, v17
  v_lshl_add_u32 v252, v18, 5, v252
  v_lshlrev_b32 v204, 5, v18
  v_add_u32 v17, s25, v17
  v_add_u32 v25, 1, v17
  v_mul_u32_u24 v249, 1280, v17
  v_lshl_add_u32 v249, v18, 4, v249
  v_add_u32 v249, s26, v249
  v_lshrrev_b32 v19, 4, v17
  v_mul_u32_u24 v19, 20480, v19
  v_and_b32 v17, 15, v17
  v_lshl_add_u32 v19, v17, 4, v19
  v_lshl_add_u32 v201, v18, 8, v19
  v_mov_b32 v28, 8
  v_add_u32 v16, 512, v0
  v_mul_u32_u24 v17, 6554, v16
  v_lshrrev_b32 v17, 16, v17
  v_mul_u32_u24 v18, 10, v17
  v_sub_u32 v18, v16, v18
  v_mul_u32_u24 v253, 336, v17
  v_lshl_add_u32 v253, v18, 5, v253
  v_lshlrev_b32 v205, 5, v18
  v_add_u32 v17, s25, v17
  v_add_u32 v26, 1, v17
  v_mul_u32_u24 v250, 1280, v17
  v_lshl_add_u32 v250, v18, 4, v250
  v_add_u32 v250, s26, v250
  v_lshrrev_b32 v19, 4, v17
  v_mul_u32_u24 v19, 20480, v19
  v_and_b32 v17, 15, v17
  v_lshl_add_u32 v19, v17, 4, v19
  v_lshl_add_u32 v202, v18, 8, v19
  v_mov_b32 v29, 8
  v_cmp_gt_u32 vcc, 128, v0
  v_mov_b32 v16, 1073741824
  v_mov_b32 v17, 0
  v_cndmask_b32 v250, v16, v250, vcc
  v_cndmask_b32 v202, v16, v202, vcc
  v_cndmask_b32 v253, v17, v253, vcc
  v_mov_b32 v20, 0
  v_mov_b32 v21, 0
  v_mov_b32 v22, 0
  v_mov_b32 v23, 0
  v_add_u32 v16, 158208, v2
  ds_write_b128 v16, v[20:23]
  s_cmp_lt_u32 s12, 3
  s_waitcnt vmcnt(18) lgkmcnt(0)
  s_cbranch_scc1 fa_pub
  s_waitcnt vmcnt(0)
fa_pub:
  buffer_store_dword v31, v30, s[40:43], 0 offen sc1
  s_cmp_lt_u32 s12, 3
  s_cbranch_scc1 fa_hk10
fa_hb10:
  s_cmp_lt_u32 s29, 8
  s_cbranch_scc1 fa_left
fa_leftb:
  s_add_u32 s13, s13, 61440
  buffer_load_dwordx4 v[64:67], v2, s[40:43], s13 offen offset:0 sc1
  buffer_load_dwordx4 v[68:71], v2, s[40:43], s13 offen offset:1024 sc1
  buffer_load_dwordx4 v[72:75], v2, s[40:43], s13 offen offset:2048 sc1
  buffer_load_dwordx4 v[76:79], v2, s[40:43], s13 offen offset:3072 sc1
  s_add_u32 s13, s13, 4096
  buffer_load_dwordx4 v[80:83], v2, s[40:43], s13 offen offset:0 sc1
  buffer_load_dwordx4 v[84:87], v2, s[40:43], s13 offen offset:1024 sc1
  buffer_load_dwordx4 v[88:91], v2, s[40:43], s13 offen offset:2048 sc1
  buffer_load_dwordx4 v[92:95], v2, s[40:43], s13 offen offset:3072 sc1
  s_add_u32 s13, s13, 4096
  buffer_load_dwordx4 v[128:131], v2, s[40:43], s13 offen offset:0 sc1
  buffer_load_dwordx4 v[132:135], v2, s[40:43], s13 offen offset:1024 sc1
  buffer_load_dwordx4 v[136:139], v2, s[40:43], s13 offen offset:2048 sc1
  buffer_load_dwordx4 v[140:143], v2, s[40:43], s13 offen offset:3072 sc1
  s_add_u32 s13, s13, 4096
  buffer_load_dwordx4 v[144:147], v2, s[40:43], s13 offen offset:0 sc1
  buffer_load_dwordx4 v[148:151], v2, s[40:43], s13 offen offset:1024 sc1
  buffer_load_dwordx4 v[152:155], v2, s[40:43], s13 offen offset:2048 sc1
  buffer_load_dwordx4 v[156:159], v2, s[40:43], s13 offen offset:3072 sc1
  s_add_u32 s13, s13, 4096
  buffer_load_dwordx4 v[176:179], v2, s[40:43], s13 offen offset:0 sc1
  buffer_load_dwordx4 v[180:183], v2, s[40:43], s13 offen offset:1024 sc1
  buffer_load_dwordx4 v[184:187], v2, s[40:43], s13 offen offset:2048 sc1
  buffer_load_dwordx4 v[188:191], v2, s[40:43], s13 offen offset:3072 sc1
  s_add_u32 s13, s13, 4096
  s_barrier
  s_add_u32 s14, s13, 45056
  s_mul_i32 s23, s20, 38912
  v_add_u32 v11, s23, v2
  s_add_u32 m0, s23, 0
  s_nop 0
  buffer_load_dwordx4 v2, s[40:43], s14 offen offset:0 sc1 lds
  buffer_load_dwordx4 v2, s[40:43], s14 offen offset:1024 sc1 lds
  buffer_load_dwordx4 v2, s[40:43], s14 offen offset:2048 sc1 lds
  buffer_load_dwordx4 v2, s[40:43], s14 offen offset:3072 sc1 lds
  s_add_u32 s14, s14, 4096
  s_add_u32 m0, s23, 4096
  s_nop 0
  buffer_load_dwordx4 v2, s[40:43], s14 offen offset:0 sc1 lds
  buffer_load_dwordx4 v2, s[40:43], s14 offen offset:1024 sc1 lds
  buffer_load_dwordx4 v2, s[40:43], s14 offen offset:2048 sc1 lds
  buffer_load_dwordx4 v2, s[40:43], s14 offen offset:3072 sc1 lds
  s_add_u32 s14, s14, 4096
  s_add_u32 m0, s23, 8192
  s_nop 0
  buffer_load_dwordx4 v2, s[40:43], s14 offen offset:0 sc1 lds
  buffer_load_dwordx4 v2, s[40:43], s14 offen offset:1024 sc1 lds
  buffer_load_dwordx4 v2, s[40:43], s14 offen offset:2048 sc1 lds
  buffer_load_dwordx4 v2, s[40:43], s14 offen offset:3072 sc1 lds
  s_add_u32 s14, s14, 4096
  s_add_u32 m0, s23, 12288
  s_nop 0
  buffer_load_dwordx4 v2, s[40:43], s14 offen offset:0 sc1 lds
  buffer_load_dwordx4 v2, s[40:43], s14 offen offset:1024 sc1 lds
  buffer_load_dwordx4 v2, s[40:43], s14 offen offset:2048 sc1 lds
  buffer_load_dwordx4 v2, s[40:43], s14 offen offset:3072 sc1 lds
  s_add_u32 s14, s14, 4096
  s_add_u32 m0, s23, 16384
  s_nop 0
  buffer_load_dwordx4 v2, s[40:43], s14 offen offset:0 sc1 lds
  buffer_load_dwordx4 v2, s[40:43], s14 offen offset:1024 sc1 lds
  buffer_load_dwordx4 v2, s[40:43], s14 offen offset:2048 sc1 lds
  buffer_load_dwordx4 v2, s[40:43], s14 offen offset:3072 sc1 lds
  s_add_u32 s14, s14, 4096
  s_add_u32 m0, s23, 20480
  s_nop 0
  buffer_load_dwordx4 v2, s[40:43], s14 offen offset:0 sc1 lds
  buffer_load_dwordx4 v2, s[40:43], s14 offen offset:1024 sc1 lds
  buffer_load_dwordx4 v2, s[40:43], s14 offen offset:2048 sc1 lds
  buffer_load_dwordx4 v2, s[40:43], s14 offen offset:3072 sc1 lds
  s_add_u32 s14, s14, 4096
  buffer_load_dword v13, v12, s[40:43], 0 offen sc1
  s_add_u32 m0, s23, 24576
  s_nop 0
  buffer_load_dwordx4 v2, s[40:43], s14 offen offset:0 sc1 lds
  buffer_load_dwordx4 v2, s[40:43], s14 offen offset:1024 sc1 lds
  buffer_load_dwordx4 v2, s[40:43], s14 offen offset:2048 sc1 lds
  buffer_load_dwordx4 v2, s[40:43], s14 offen offset:3072 sc1 lds
  s_add_u32 s14, s14, 4096
  s_add_u32 m0, s23, 28672
  s_nop 0
  buffer_load_dwordx4 v2, s[40:43], s14 offen offset:0 sc1 lds
  buffer_load_dwordx4 v2, s[40:43], s14 offen offset:1024 sc1 lds
  buffer_load_dwordx4 v2, s[40:43], s14 offen offset:2048 sc1 lds
  buffer_load_dwordx4 v2, s[40:43], s14 offen offset:3072 sc1 lds
  s_add_u32 s14, s14, 4096
  s_add_u32 m0, s23, 32768
  s_nop 0
  buffer_load_dwordx4 v2, s[40:43], s14 offen offset:0 sc1 lds
  buffer_load_dwordx4 v2, s[40:43], s14 offen offset:1024 sc1 lds
  buffer_load_dwordx4 v2, s[40:43], s14 offen offset:2048 sc1 lds
  buffer_load_dwordx4 v2, s[40:43], s14 offen offset:3072 sc1 lds
  s_add_u32 s14, s14, 4096
  s_mov_b32 s44, s4
  s_mov_b32 s45, s5
  s_mov_b32 s46, 2621440
  s_mov_b32 s47, 0x20000
  s_mov_b32 s48, s6
  s_mov_b32 s49, s7
  s_mov_b32 s50, 2621440
  s_mov_b32 s51, 0x20000
  v_readlane_b32 s68, v15, 0
  v_readlane_b32 s69, v15, 1
  v_readlane_b32 s70, v15, 2
  v_readlane_b32 s71, v15, 3
  v_readlane_b32 s72, v15, 4
  v_readlane_b32 s73, v15, 5
  v_readlane_b32 s74, v15, 6
  v_readlane_b32 s75, v15, 7
  v_cmp_eq_u32 s[52:53], s68, v24
  v_cmp_eq_u32 s[54:55], s68, v25
  v_cmp_eq_u32 s[56:57], s68, v26
  v_cndmask_b32 v27, v27, 0, s[52:53]
  v_cndmask_b32 v28, v28, 0, s[54:55]
  v_cndmask_b32 v29, v29, 0, s[56:57]
  v_cmp_eq_u32 s[52:53], s69, v24
  v_cmp_eq_u32 s[54:55], s69, v25
  v_cmp_eq_u32 s[56:57], s69, v26
  v_cndmask_b32 v27, v27, 1, s[52:53]
  v_cndmask_b32 v28, v28, 1, s[54:55]
  v_cndmask_b32 v29, v29, 1, s[56:57]
  v_cmp_eq_u32 s[52:53], s70, v24
  v_cmp_eq_u32 s[54:55], s70, v25
  v_cmp_eq_u32 s[56:57], s70, v26
  v_cndmask_b32 v27, v27, 2, s[52:53]
  v_cndmask_b32 v28, v28, 2, s[54:55]
  v_cndmask_b32 v29, v29, 2, s[56:57]
  v_cmp_eq_u32 s[52:53], s71, v24
  v_cmp_eq_u32 s[54:55], s71, v25
  v_cmp_eq_u32 s[56:57], s71, v26
  v_cndmask_b32 v27, v27, 3, s[52:53]
  v_cndmask_b32 v28, v28, 3, s[54:55]
  v_cndmask_b32 v29, v29, 3, s[56:57]
  v_cmp_eq_u32 s[52:53], s72, v24
  v_cmp_eq_u32 s[54:55], s72, v25
  v_cmp_eq_u32 s[56:57], s72, v26
  v_cndmask_b32 v27, v27, 4, s[52:53]
  v_cndmask_b32 v28, v28, 4, s[54:55]
  v_cndmask_b32 v29, v29, 4, s[56:57]
  v_cmp_eq_u32 s[52:53], s73, v24
  v_cmp_eq_u32 s[54:55], s73, v25
  v_cmp_eq_u32 s[56:57], s73, v26
  v_cndmask_b32 v27, v27, 5, s[52:53]
  v_cndmask_b32 v28, v28, 5, s[54:55]
  v_cndmask_b32 v29, v29, 5, s[56:57]
  v_cmp_eq_u32 s[52:53], s74, v24
  v_cmp_eq_u32 s[54:55], s74, v25
  v_cmp_eq_u32 s[56:57], s74, v26
  v_cndmask_b32 v27, v27, 6, s[52:53]
  v_cndmask_b32 v28, v28, 6, s[54:55]
  v_cndmask_b32 v29, v29, 6, s[56:57]
  v_cmp_eq_u32 s[52:53], s75, v24
  v_cmp_eq_u32 s[54:55], s75, v25
  v_cmp_eq_u32 s[56:57], s75, v26
  v_cndmask_b32 v27, v27, 7, s[52:53]
  v_cndmask_b32 v28, v28, 7, s[54:55]
  v_cndmask_b32 v29, v29, 7, s[56:57]
  v_mul_u32_u24 v27, 320, v27
  v_add_u32 v203, v203, v27
  v_mul_u32_u24 v28, 320, v28
  v_add_u32 v204, v204, v28
  v_mul_u32_u24 v29, 320, v29
  v_add_u32 v205, v205, v29
  v_add_u32 v203, 155648, v203
  v_add_u32 v204, 155648, v204
  v_add_u32 v205, 155648, v205
  s_waitcnt vmcnt(12)
  v_cmp_eq_u32 vcc, 0, v13
  s_cbranch_vccnz fa_ctx_spin
fa_ctx_ok:
  buffer_load_dwordx4 a[144:147], v2, s[40:43], s64 offen offset:0 sc1
  buffer_load_dwordx4 a[148:151], v2, s[40:43], s65 offen offset:0 sc1
  buffer_load_dwordx4 a[152:155], v2, s[40:43], s66 offen offset:0 sc1
  buffer_load_dwordx4 a[156:159], v2, s[40:43], s67 offen offset:0 sc1
  buffer_load_dwordx4 a[160:163], v2, s[40:43], s64 offen offset:1024 sc1
  buffer_load_dwordx4 a[164:167], v2, s[40:43], s65 offen offset:1024 sc1
  buffer_load_dwordx4 a[168:171], v2, s[40:43], s66 offen offset:1024 sc1
  buffer_load_dwordx4 a[172:175], v2, s[40:43], s67 offen offset:1024 sc1
  buffer_load_dwordx4 a[176:179], v2, s[40:43], s64 offen offset:2048 sc1
  buffer_load_dwordx4 a[180:183], v2, s[40:43], s65 offen offset:2048 sc1
  buffer_load_dwordx4 a[184:187], v2, s[40:43], s66 offen offset:2048 sc1
  buffer_load_dwordx4 a[188:191], v2, s[40:43], s67 offen offset:2048 sc1
  buffer_load_dwordx4 v[216:219], v2, s[40:43], s64 offen offset:3072 sc1
  buffer_load_dwordx4 v[220:223], v2, s[40:43], s65 offen offset:3072 sc1
  buffer_load_dwordx4 v[224:227], v2, s[40:43], s66 offen offset:3072 sc1
  buffer_load_dwordx4 v[228:231], v2, s[40:43], s67 offen offset:3072 sc1
  s_add_u32 s64, s64, 4096
  s_add_u32 s65, s65, 4096
  s_add_u32 s66, s66, 4096
  s_add_u32 s67, s67, 4096
  s_waitcnt vmcnt(12)
  v_mfma_f32_16x16x32_bf16 a[64:67], a[0:3], a[144:147], 0
  v_mfma_f32_16x16x32_bf16 a[68:71], a[0:3], a[148:151], 0
  v_mfma_f32_16x16x32_bf16 a[72:75], a[0:3], a[152:155], 0
  v_mfma_f32_16x16x32_bf16 a[76:79], a[0:3], a[156:159], 0
  buffer_load_dwordx4 a[0:3], v2, s[40:43], s13 offen offset:0 sc1
  v_mfma_f32_16x16x32_bf16 a[80:83], a[4:7], a[144:147], 0
  v_mfma_f32_16x16x32_bf16 a[84:87], a[4:7], a[148:151], 0
  v_mfma_f32_16x16x32_bf16 a[88:91], a[4:7], a[152:155], 0
  v_mfma_f32_16x16x32_bf16 a[92:95], a[4:7], a[156:159], 0
  buffer_load_dwordx4 a[4:7], v2, s[40:43], s13 offen offset:1024 sc1
  v_mfma_f32_16x16x32_bf16 a[96:99], a[8:11], a[144:147], 0
  v_mfma_f32_16x16x32_bf16 a[100:103], a[8:11], a[148:151], 0
  v_mfma_f32_16x16x32_bf16 a[104:107], a[8:11], a[152:155], 0
  v_mfma_f32_16x16x32_bf16 a[108:111], a[8:11], a[156:159], 0
  buffer_load_dwordx4 a[8:11], v2, s[40:43], s13 offen offset:2048 sc1
  v_mfma_f32_16x16x32_bf16 a[112:115], a[12:15], a[144:147], 0
  v_mfma_f32_16x16x32_bf16 a[116:119], a[12:15], a[148:151], 0
  v_mfma_f32_16x16x32_bf16 a[120:123], a[12:15], a[152:155], 0
  v_mfma_f32_16x16x32_bf16 a[124:127], a[12:15], a[156:159], 0
  v_mfma_f32_16x16x32_bf16 a[128:131], a[16:19], a[144:147], 0
  buffer_load_dwordx4 a[144:147], v2, s[40:43], s64 offen offset:0 sc1
  v_mfma_f32_16x16x32_bf16 a[132:135], a[16:19], a[148:151], 0
  buffer_load_dwordx4 a[148:151], v2, s[40:43], s65 offen offset:0 sc1
  v_mfma_f32_16x16x32_bf16 a[136:139], a[16:19], a[152:155], 0
  buffer_load_dwordx4 a[152:155], v2, s[40:43], s66 offen offset:0 sc1
  v_mfma_f32_16x16x32_bf16 a[140:143], a[16:19], a[156:159], 0
  buffer_load_dwordx4 a[156:159], v2, s[40:43], s67 offen offset:0 sc1
  s_waitcnt vmcnt(15)
  v_mfma_f32_16x16x32_bf16 a[64:67], a[20:23], a[160:163], a[64:67]
  v_mfma_f32_16x16x32_bf16 a[68:71], a[20:23], a[164:167], a[68:71]
  v_mfma_f32_16x16x32_bf16 a[72:75], a[20:23], a[168:171], a[72:75]
  v_mfma_f32_16x16x32_bf16 a[76:79], a[20:23], a[172:175], a[76:79]
  buffer_load_dwordx4 a[12:15], v2, s[40:43], s13 offen offset:3072 sc1
  v_mfma_f32_16x16x32_bf16 a[80:83], a[24:27], a[160:163], a[80:83]
  s_add_u32 s13, s13, 4096
  v_mfma_f32_16x16x32_bf16 a[84:87], a[24:27], a[164:167], a[84:87]
  v_mfma_f32_16x16x32_bf16 a[88:91], a[24:27], a[168:171], a[88:91]
  v_mfma_f32_16x16x32_bf16 a[92:95], a[24:27], a[172:175], a[92:95]
  buffer_load_dwordx4 a[16:19], v2, s[40:43], s13 offen offset:0 sc1
  v_mfma_f32_16x16x32_bf16 a[96:99], a[28:31], a[160:163], a[96:99]
  v_mfma_f32_16x16x32_bf16 a[100:103], a[28:31], a[164:167], a[100:103]
  v_mfma_f32_16x16x32_bf16 a[104:107], a[28:31], a[168:171], a[104:107]
  v_mfma_f32_16x16x32_bf16 a[108:111], a[28:31], a[172:175], a[108:111]
  v_mfma_f32_16x16x32_bf16 a[112:115], a[32:35], a[160:163], a[112:115]
  v_mfma_f32_16x16x32_bf16 a[116:119], a[32:35], a[164:167], a[116:119]
  v_mfma_f32_16x16x32_bf16 a[120:123], a[32:35], a[168:171], a[120:123]
  v_mfma_f32_16x16x32_bf16 a[124:127], a[32:35], a[172:175], a[124:127]
  v_mfma_f32_16x16x32_bf16 a[128:131], a[36:39], a[160:163], a[128:131]
  buffer_load_dwordx4 a[160:163], v2, s[40:43], s64 offen offset:1024 sc1
  v_mfma_f32_16x16x32_bf16 a[132:135], a[36:39], a[164:167], a[132:135]
  buffer_load_dwordx4 a[164:167], v2, s[40:43], s65 offen offset:1024 sc1
  v_mfma_f32_16x16x32_bf16 a[136:139], a[36:39], a[168:171], a[136:139]
  buffer_load_dwordx4 a[168:171], v2, s[40:43], s66 offen offset:1024 sc1
  v_mfma_f32_16x16x32_bf16 a[140:143], a[36:39], a[172:175], a[140:143]
  buffer_load_dwordx4 a[172:175], v2, s[40:43], s67 offen offset:1024 sc1
  s_waitcnt vmcnt(17)
  v_mfma_f32_16x16x32_bf16 a[64:67], a[40:43], a[176:179], a[64:67]
  v_mfma_f32_16x16x32_bf16 a[68:71], a[40:43], a[180:183], a[68:71]
  v_mfma_f32_16x16x32_bf16 a[72:75], a[40:43], a[184:187], a[72:75]
  v_mfma_f32_16x16x32_bf16 a[76:79], a[40:43], a[188:191], a[76:79]
  buffer_load_dwordx4 a[20:23], v2, s[40:43], s13 offen offset:1024 sc1
  v_mfma_f32_16x16x32_bf16 a[80:83], a[44:47], a[176:179], a[80:83]
  v_mfma_f32_16x16x32_bf16 a[84:87], a[44:47], a[180:183], a[84:87]
  v_mfma_f32_16x16x32_bf16 a[88:91], a[44:47], a[184:187], a[88:91]
  v_mfma_f32_16x16x32_bf16 a[92:95], a[44:47], a[188:191], a[92:95]
  buffer_load_dwordx4 a[24:27], v2, s[40:43], s13 offen offset:2048 sc1
  v_mfma_f32_16x16x32_bf16 a[96:99], a[48:51], a[176:179], a[96:99]
  v_mfma_f32_16x16x32_bf16 a[100:103], a[48:51], a[180:183], a[100:103]
  v_mfma_f32_16x16x32_bf16 a[104:107], a[48:51], a[184:187], a[104:107]
  v_mfma_f32_16x16x32_bf16 a[108:111], a[48:51], a[188:191], a[108:111]
  v_mfma_f32_16x16x32_bf16 a[112:115], a[52:55], a[176:179], a[112:115]
  v_mfma_f32_16x16x32_bf16 a[116:119], a[52:55], a[180:183], a[116:119]
  v_mfma_f32_16x16x32_bf16 a[120:123], a[52:55], a[184:187], a[120:123]
  v_mfma_f32_16x16x32_bf16 a[124:127], a[52:55], a[188:191], a[124:127]
  v_mfma_f32_16x16x32_bf16 a[128:131], a[56:59], a[176:179], a[128:131]
  buffer_load_dwordx4 a[176:179], v2, s[40:43], s64 offen offset:2048 sc1
  v_mfma_f32_16x16x32_bf16 a[132:135], a[56:59], a[180:183], a[132:135]
  buffer_load_dwordx4 a[180:183], v2, s[40:43], s65 offen offset:2048 sc1
  v_mfma_f32_16x16x32_bf16 a[136:139], a[56:59], a[184:187], a[136:139]
  buffer_load_dwordx4 a[184:187], v2, s[40:43], s66 offen offset:2048 sc1
  v_mfma_f32_16x16x32_bf16 a[140:143], a[56:59], a[188:191], a[140:143]
  buffer_load_dwordx4 a[188:191], v2, s[40:43], s67 offen offset:2048 sc1
  s_waitcnt vmcnt(19)
  v_mfma_f32_16x16x32_bf16 a[64:67], a[60:63], v[216:219], a[64:67]
  v_mfma_f32_16x16x32_bf16 a[68:71], a[60:63], v[220:223], a[68:71]
  v_mfma_f32_16x16x32_bf16 a[72:75], a[60:63], v[224:227], a[72:75]
  v_mfma_f32_16x16x32_bf16 a[76:79], a[60:63], v[228:231], a[76:79]
  buffer_load_dwordx4 a[28:31], v2, s[40:43], s13 offen offset:3072 sc1
  v_mfma_f32_16x16x32_bf16 a[80:83], a[192:195], v[216:219], a[80:83]
  s_add_u32 s13, s13, 4096
  v_mfma_f32_16x16x32_bf16 a[84:87], a[192:195], v[220:223], a[84:87]
  v_mfma_f32_16x16x32_bf16 a[88:91], a[192:195], v[224:227], a[88:91]
  v_mfma_f32_16x16x32_bf16 a[92:95], a[192:195], v[228:231], a[92:95]
  buffer_load_dwordx4 a[32:35], v2, s[40:43], s13 offen offset:0 sc1
  v_mfma_f32_16x16x32_bf16 a[96:99], a[196:199], v[216:219], a[96:99]
  v_mfma_f32_16x16x32_bf16 a[100:103], a[196:199], v[220:223], a[100:103]
  v_mfma_f32_16x16x32_bf16 a[104:107], a[196:199], v[224:227], a[104:107]
  v_mfma_f32_16x16x32_bf16 a[108:111], a[196:199], v[228:231], a[108:111]
  v_mfma_f32_16x16x32_bf16 a[112:115], a[200:203], v[216:219], a[112:115]
  v_mfma_f32_16x16x32_bf16 a[116:119], a[200:203], v[220:223], a[116:119]
  v_mfma_f32_16x16x32_bf16 a[120:123], a[200:203], v[224:227], a[120:123]
  v_mfma_f32_16x16x32_bf16 a[124:127], a[200:203], v[228:231], a[124:127]
  v_mfma_f32_16x16x32_bf16 a[128:131], a[204:207], v[216:219], a[128:131]
  buffer_load_dwordx4 v[216:219], v2, s[40:43], s64 offen offset:3072 sc1
  v_mfma_f32_16x16x32_bf16 a[132:135], a[204:207], v[220:223], a[132:135]
  buffer_load_dwordx4 v[220:223], v2, s[40:43], s65 offen offset:3072 sc1
  v_mfma_f32_16x16x32_bf16 a[136:139], a[204:207], v[224:227], a[136:139]
  buffer_load_dwordx4 v[224:227], v2, s[40:43], s66 offen offset:3072 sc1
  v_mfma_f32_16x16x32_bf16 a[140:143], a[204:207], v[228:231], a[140:143]
  buffer_load_dwordx4 v[228:231], v2, s[40:43], s67 offen offset:3072 sc1
  s_waitcnt vmcnt(18)
  v_mfma_f32_16x16x32_bf16 a[64:67], a[208:211], a[144:147], a[64:67]
  s_add_u32 s64, s64, 4096
  v_mfma_f32_16x16x32_bf16 a[68:71], a[208:211], a[148:151], a[68:71]
  s_add_u32 s65, s65, 4096
  v_mfma_f32_16x16x32_bf16 a[72:75], a[208:211], a[152:155], a[72:75]
  s_add_u32 s66, s66, 4096
  v_mfma_f32_16x16x32_bf16 a[76:79], a[208:211], a[156:159], a[76:79]
  buffer_load_dwordx4 a[36:39], v2, s[40:43], s13 offen offset:1024 sc1
  v_mfma_f32_16x16x32_bf16 a[80:83], a[212:215], a[144:147], a[80:83]
  v_mfma_f32_16x16x32_bf16 a[84:87], a[212:215], a[148:151], a[84:87]
  v_mfma_f32_16x16x32_bf16 a[88:91], a[212:215], a[152:155], a[88:91]
  s_add_u32 s67, s67, 4096
  v_mfma_f32_16x16x32_bf16 a[92:95], a[212:215], a[156:159], a[92:95]
  buffer_load_dwordx4 a[40:43], v2, s[40:43], s13 offen offset:2048 sc1
  v_mfma_f32_16x16x32_bf16 a[96:99], a[216:219], a[144:147], a[96:99]
  v_mfma_f32_16x16x32_bf16 a[100:103], a[216:219], a[148:151], a[100:103]
  v_mfma_f32_16x16x32_bf16 a[104:107], a[216:219], a[152:155], a[104:107]
  v_mfma_f32_16x16x32_bf16 a[108:111], a[216:219], a[156:159], a[108:111]
  v_mfma_f32_16x16x32_bf16 a[112:115], a[220:223], a[144:147], a[112:115]
  v_mfma_f32_16x16x32_bf16 a[116:119], a[220:223], a[148:151], a[116:119]
  v_mfma_f32_16x16x32_bf16 a[120:123], a[220:223], a[152:155], a[120:123]
  v_mfma_f32_16x16x32_bf16 a[124:127], a[220:223], a[156:159], a[124:127]
  v_mfma_f32_16x16x32_bf16 a[128:131], a[224:227], a[144:147], a[128:131]
  buffer_load_dwordx4 a[144:147], v2, s[40:43], s64 offen offset:0 sc1
  v_mfma_f32_16x16x32_bf16 a[132:135], a[224:227], a[148:151], a[132:135]
  buffer_load_dwordx4 a[148:151], v2, s[40:43], s65 offen offset:0 sc1
  v_mfma_f32_16x16x32_bf16 a[136:139], a[224:227], a[152:155], a[136:139]
  buffer_load_dwordx4 a[152:155], v2, s[40:43], s66 offen offset:0 sc1
  v_mfma_f32_16x16x32_bf16 a[140:143], a[224:227], a[156:159], a[140:143]
  buffer_load_dwordx4 a[156:159], v2, s[40:43], s67 offen offset:0 sc1
  s_waitcnt vmcnt(18)
  v_mfma_f32_16x16x32_bf16 a[64:67], a[228:231], a[160:163], a[64:67]
  v_mfma_f32_16x16x32_bf16 a[68:71], a[228:231], a[164:167], a[68:71]
  v_mfma_f32_16x16x32_bf16 a[72:75], a[228:231], a[168:171], a[72:75]
  v_mfma_f32_16x16x32_bf16 a[76:79], a[228:231], a[172:175], a[76:79]
  buffer_load_dwordx4 a[44:47], v2, s[40:43], s13 offen offset:3072 sc1
  v_mfma_f32_16x16x32_bf16 a[80:83], a[232:235], a[160:163], a[80:83]
  s_add_u32 s13, s13, 4096
  v_mfma_f32_16x16x32_bf16 a[84:87], a[232:235], a[164:167], a[84:87]
  v_mfma_f32_16x16x32_bf16 a[88:91], a[232:235], a[168:171], a[88:91]
  v_mfma_f32_16x16x32_bf16 a[92:95], a[232:235], a[172:175], a[92:95]
  buffer_load_dwordx4 a[48:51], v2, s[40:43], s13 offen offset:0 sc1
  v_mfma_f32_16x16x32_bf16 a[96:99], a[236:239], a[160:163], a[96:99]
  v_mfma_f32_16x16x32_bf16 a[100:103], a[236:239], a[164:167], a[100:103]
  v_mfma_f32_16x16x32_bf16 a[104:107], a[236:239], a[168:171], a[104:107]
  v_mfma_f32_16x16x32_bf16 a[108:111], a[236:239], a[172:175], a[108:111]
  buffer_load_dwordx4 a[52:55], v2, s[40:43], s13 offen offset:1024 sc1
  v_mfma_f32_16x16x32_bf16 a[112:115], a[240:243], a[160:163], a[112:115]
  v_mfma_f32_16x16x32_bf16 a[116:119], a[240:243], a[164:167], a[116:119]
  v_mfma_f32_16x16x32_bf16 a[120:123], a[240:243], a[168:171], a[120:123]
  v_mfma_f32_16x16x32_bf16 a[124:127], a[240:243], a[172:175], a[124:127]
  v_mfma_f32_16x16x32_bf16 a[128:131], a[244:247], a[160:163], a[128:131]
  buffer_load_dwordx4 a[160:163], v2, s[40:43], s64 offen offset:1024 sc1
  v_mfma_f32_16x16x32_bf16 a[132:135], a[244:247], a[164:167], a[132:135]
  buffer_load_dwordx4 a[164:167], v2, s[40:43], s65 offen offset:1024 sc1
  v_mfma_f32_16x16x32_bf16 a[136:139], a[244:247], a[168:171], a[136:139]
  buffer_load_dwordx4 a[168:171], v2, s[40:43], s66 offen offset:1024 sc1
  v_mfma_f32_16x16x32_bf16 a[140:143], a[244:247], a[172:175], a[140:143]
  buffer_load_dwordx4 a[172:175], v2, s[40:43], s67 offen offset:1024 sc1
  s_waitcnt vmcnt(19)
  v_mfma_f32_16x16x32_bf16 a[64:67], a[248:251], a[176:179], a[64:67]
  v_mfma_f32_16x16x32_bf16 a[68:71], a[248:251], a[180:183], a[68:71]
  v_mfma_f32_16x16x32_bf16 a[72:75], a[248:251], a[184:187], a[72:75]
  v_mfma_f32_16x16x32_bf16 a[76:79], a[248:251], a[188:191], a[76:79]
  buffer_load_dwordx4 a[56:59], v2, s[40:43], s13 offen offset:2048 sc1
  v_mfma_f32_16x16x32_bf16 a[80:83], a[252:255], a[176:179], a[80:83]
  v_mfma_f32_16x16x32_bf16 a[84:87], a[252:255], a[180:183], a[84:87]
  v_mfma_f32_16x16x32_bf16 a[88:91], a[252:255], a[184:187], a[88:91]
  v_mfma_f32_16x16x32_bf16 a[92:95], a[252:255], a[188:191], a[92:95]
  buffer_load_dwordx4 a[60:63], v2, s[40:43], s13 offen offset:3072 sc1
  v_mfma_f32_16x16x32_bf16 a[96:99], v[32:35], a[176:179], a[96:99]
  s_add_u32 s13, s13, 4096
  v_mfma_f32_16x16x32_bf16 a[100:103], v[32:35], a[180:183], a[100:103]
  v_mfma_f32_16x16x32_bf16 a[104:107], v[32:35], a[184:187], a[104:107]
  v_mfma_f32_16x16x32_bf16 a[108:111], v[32:35], a[188:191], a[108:111]
  v_mfma_f32_16x16x32_bf16 a[112:115], v[36:39], a[176:179], a[112:115]
  v_mfma_f32_16x16x32_bf16 a[116:119], v[36:39], a[180:183], a[116:119]
  v_mfma_f32_16x16x32_bf16 a[120:123], v[36:39], a[184:187], a[120:123]
  v_mfma_f32_16x16x32_bf16 a[124:127], v[36:39], a[188:191], a[124:127]
  v_mfma_f32_16x16x32_bf16 a[128:131], v[40:43], a[176:179], a[128:131]
  buffer_load_dwordx4 a[176:179], v2, s[40:43], s64 offen offset:2048 sc1
  v_mfma_f32_16x16x32_bf16 a[132:135], v[40:43], a[180:183], a[132:135]
  buffer_load_dwordx4 a[180:183], v2, s[40:43], s65 offen offset:2048 sc1
  v_mfma_f32_16x16x32_bf16 a[136:139], v[40:43], a[184:187], a[136:139]
  buffer_load_dwordx4 a[184:187], v2, s[40:43], s66 offen offset:2048 sc1
  v_mfma_f32_16x16x32_bf16 a[140:143], v[40:43], a[188:191], a[140:143]
  buffer_load_dwordx4 a[188:191], v2, s[40:43], s67 offen offset:2048 sc1
  s_waitcnt vmcnt(19)
  v_mfma_f32_16x16x32_bf16 a[64:67], v[44:47], v[216:219], a[64:67]
  v_mfma_f32_16x16x32_bf16 a[68:71], v[44:47], v[220:223], a[68:71]
  v_mfma_f32_16x16x32_bf16 a[72:75], v[44:47], v[224:227], a[72:75]
  v_mfma_f32_16x16x32_bf16 a[76:79], v[44:47], v[228:231], a[76:79]
  buffer_load_dwordx4 a[192:195], v2, s[40:43], s13 offen offset:0 sc1
  v_mfma_f32_16x16x32_bf16 a[80:83], v[48:51], v[216:219], a[80:83]
  v_mfma_f32_16x16x32_bf16 a[84:87], v[48:51], v[220:223], a[84:87]
  v_mfma_f32_16x16x32_bf16 a[88:91], v[48:51], v[224:227], a[88:91]
  v_mfma_f32_16x16x32_bf16 a[92:95], v[48:51], v[228:231], a[92:95]
  buffer_load_dwordx4 a[196:199], v2, s[40:43], s13 offen offset:1024 sc1
  v_mfma_f32_16x16x32_bf16 a[96:99], v[52:55], v[216:219], a[96:99]
  v_mfma_f32_16x16x32_bf16 a[100:103], v[52:55], v[220:223], a[100:103]
  v_mfma_f32_16x16x32_bf16 a[104:107], v[52:55], v[224:227], a[104:107]
  v_mfma_f32_16x16x32_bf16 a[108:111], v[52:55], v[228:231], a[108:111]
  v_mfma_f32_16x16x32_bf16 a[112:115], v[56:59], v[216:219], a[112:115]
  v_mfma_f32_16x16x32_bf16 a[116:119], v[56:59], v[220:223], a[116:119]
  v_mfma_f32_16x16x32_bf16 a[120:123], v[56:59], v[224:227], a[120:123]
  v_mfma_f32_16x16x32_bf16 a[124:127], v[56:59], v[228:231], a[124:127]
  v_mfma_f32_16x16x32_bf16 a[128:131], v[60:63], v[216:219], a[128:131]
  buffer_load_dwordx4 v[216:219], v2, s[40:43], s64 offen offset:3072 sc1
  v_mfma_f32_16x16x32_bf16 a[132:135], v[60:63], v[220:223], a[132:135]
  buffer_load_dwordx4 v[220:223], v2, s[40:43], s65 offen offset:3072 sc1
  v_mfma_f32_16x16x32_bf16 a[136:139], v[60:63], v[224:227], a[136:139]
  buffer_load_dwordx4 v[224:227], v2, s[40:43], s66 offen offset:3072 sc1
  v_mfma_f32_16x16x32_bf16 a[140:143], v[60:63], v[228:231], a[140:143]
  buffer_load_dwordx4 v[228:231], v2, s[40:43], s67 offen offset:3072 sc1
  s_waitcnt vmcnt(19)
  v_mfma_f32_16x16x32_bf16 a[64:67], v[96:99], a[144:147], a[64:67]
  s_add_u32 s64, s64, 4096
  v_mfma_f32_16x16x32_bf16 a[68:71], v[96:99], a[148:151], a[68:71]
  s_add_u32 s65, s65, 4096
  v_mfma_f32_16x16x32_bf16 a[72:75], v[96:99], a[152:155], a[72:75]
  s_add_u32 s66, s66, 4096
  v_mfma_f32_16x16x32_bf16 a[76:79], v[96:99], a[156:159], a[76:79]
  buffer_load_dwordx4 a[200:203], v2, s[40:43], s13 offen offset:2048 sc1
  v_mfma_f32_16x16x32_bf16 a[80:83], v[100:103], a[144:147], a[80:83]
  v_mfma_f32_16x16x32_bf16 a[84:87], v[100:103], a[148:151], a[84:87]
  v_mfma_f32_16x16x32_bf16 a[88:91], v[100:103], a[152:155], a[88:91]
  s_add_u32 s67, s67, 4096
  v_mfma_f32_16x16x32_bf16 a[92:95], v[100:103], a[156:159], a[92:95]
  buffer_load_dwordx4 a[204:207], v2, s[40:43], s13 offen offset:3072 sc1
  v_mfma_f32_16x16x32_bf16 a[96:99], v[104:107], a[144:147], a[96:99]
  s_add_u32 s13, s13, 4096
  v_mfma_f32_16x16x32_bf16 a[100:103], v[104:107], a[148:151], a[100:103]
  v_mfma_f32_16x16x32_bf16 a[104:107], v[104:107], a[152:155], a[104:107]
  v_mfma_f32_16x16x32_bf16 a[108:111], v[104:107], a[156:159], a[108:111]
  v_mfma_f32_16x16x32_bf16 a[112:115], v[108:111], a[144:147], a[112:115]
  v_mfma_f32_16x16x32_bf16 a[116:119], v[108:111], a[148:151], a[116:119]
  v_mfma_f32_16x16x32_bf16 a[120:123], v[108:111], a[152:155], a[120:123]
  v_mfma_f32_16x16x32_bf16 a[124:127], v[108:111], a[156:159], a[124:127]
  v_mfma_f32_16x16x32_bf16 a[128:131], v[112:115], a[144:147], a[128:131]
  buffer_load_dwordx4 a[144:147], v2, s[40:43], s64 offen offset:0 sc1
  v_mfma_f32_16x16x32_bf16 a[132:135], v[112:115], a[148:151], a[132:135]
  buffer_load_dwordx4 a[148:151], v2, s[40:43], s65 offen offset:0 sc1
  v_mfma_f32_16x16x32_bf16 a[136:139], v[112:115], a[152:155], a[136:139]
  buffer_load_dwordx4 a[152:155], v2, s[40:43], s66 offen offset:0 sc1
  v_mfma_f32_16x16x32_bf16 a[140:143], v[112:115], a[156:159], a[140:143]
  buffer_load_dwordx4 a[156:159], v2, s[40:43], s67 offen offset:0 sc1
  s_waitcnt vmcnt(18)
  v_mfma_f32_16x16x32_bf16 a[64:67], v[116:119], a[160:163], a[64:67]
  v_mfma_f32_16x16x32_bf16 a[68:71], v[116:119], a[164:167], a[68:71]
  ds_read_b128 v[112:115], v11 offset:0
  v_mfma_f32_16x16x32_bf16 a[72:75], v[116:119], a[168:171], a[72:75]
  v_mfma_f32_16x16x32_bf16 a[76:79], v[116:119], a[172:175], a[76:79]
  buffer_load_dwordx4 a[208:211], v2, s[40:43], s13 offen offset:0 sc1
  v_mfma_f32_16x16x32_bf16 a[80:83], v[120:123], a[160:163], a[80:83]
  v_mfma_f32_16x16x32_bf16 a[84:87], v[120:123], a[164:167], a[84:87]
  v_mfma_f32_16x16x32_bf16 a[88:91], v[120:123], a[168:171], a[88:91]
  v_mfma_f32_16x16x32_bf16 a[92:95], v[120:123], a[172:175], a[92:95]
  buffer_load_dwordx4 a[212:215], v2, s[40:43], s13 offen offset:1024 sc1
  v_mfma_f32_16x16x32_bf16 a[96:99], v[124:127], a[160:163], a[96:99]
  v_mfma_f32_16x16x32_bf16 a[100:103], v[124:127], a[164:167], a[100:103]
  v_mfma_f32_16x16x32_bf16 a[104:107], v[124:127], a[168:171], a[104:107]
  v_mfma_f32_16x16x32_bf16 a[108:111], v[124:127], a[172:175], a[108:111]
  v_mfma_f32_16x16x32_bf16 a[112:115], v[160:163], a[160:163], a[112:115]
  v_mfma_f32_16x16x32_bf16 a[116:119], v[160:163], a[164:167], a[116:119]
  v_mfma_f32_16x16x32_bf16 a[120:123], v[160:163], a[168:171], a[120:123]
  v_mfma_f32_16x16x32_bf16 a[124:127], v[160:163], a[172:175], a[124:127]
  v_mfma_f32_16x16x32_bf16 a[128:131], v[164:167], a[160:163], a[128:131]
  buffer_load_dwordx4 a[160:163], v2, s[40:43], s64 offen offset:1024 sc1
  v_mfma_f32_16x16x32_bf16 a[132:135], v[164:167], a[164:167], a[132:135]
  buffer_load_dwordx4 a[164:167], v2, s[40:43], s65 offen offset:1024 sc1
  v_mfma_f32_16x16x32_bf16 a[136:139], v[164:167], a[168:171], a[136:139]
  buffer_load_dwordx4 a[168:171], v2, s[40:43], s66 offen offset:1024 sc1
  v_mfma_f32_16x16x32_bf16 a[140:143], v[164:167], a[172:175], a[140:143]
  buffer_load_dwordx4 a[172:175], v2, s[40:43], s67 offen offset:1024 sc1
  s_waitcnt vmcnt(18)
  v_mfma_f32_16x16x32_bf16 a[64:67], v[168:171], a[176:179], a[64:67]
  v_mfma_f32_16x16x32_bf16 a[68:71], v[168:171], a[180:183], a[68:71]
  ds_read_b128 v[116:119], v11 offset:1024
  v_mfma_f32_16x16x32_bf16 a[72:75], v[168:171], a[184:187], a[72:75]
  v_mfma_f32_16x16x32_bf16 a[76:79], v[168:171], a[188:191], a[76:79]
  buffer_load_dwordx4 a[216:219], v2, s[40:43], s13 offen offset:2048 sc1
  v_mfma_f32_16x16x32_bf16 a[80:83], v[172:175], a[176:179], a[80:83]
  v_mfma_f32_16x16x32_bf16 a[84:87], v[172:175], a[180:183], a[84:87]
  ds_read_b128 v[120:123], v11 offset:2048
  v_mfma_f32_16x16x32_bf16 a[88:91], v[172:175], a[184:187], a[88:91]
  v_mfma_f32_16x16x32_bf16 a[92:95], v[172:175], a[188:191], a[92:95]
  buffer_load_dwordx4 a[220:223], v2, s[40:43], s13 offen offset:3072 sc1
  v_mfma_f32_16x16x32_bf16 a[96:99], v[192:195], a[176:179], a[96:99]
  s_add_u32 s13, s13, 4096
  v_mfma_f32_16x16x32_bf16 a[100:103], v[192:195], a[180:183], a[100:103]
  ds_read_b128 v[124:127], v11 offset:3072
  v_mfma_f32_16x16x32_bf16 a[104:107], v[192:195], a[184:187], a[104:107]
  v_mfma_f32_16x16x32_bf16 a[108:111], v[192:195], a[188:191], a[108:111]
  buffer_load_dwordx4 a[224:227], v2, s[40:43], s13 offen offset:0 sc1
  v_mfma_f32_16x16x32_bf16 a[112:115], v[196:199], a[176:179], a[112:115]
  v_mfma_f32_16x16x32_bf16 a[116:119], v[196:199], a[180:183], a[116:119]
  ds_read_b128 v[160:163], v11 offset:4096
  v_mfma_f32_16x16x32_bf16 a[120:123], v[196:199], a[184:187], a[120:123]
  v_mfma_f32_16x16x32_bf16 a[124:127], v[196:199], a[188:191], a[124:127]
  v_mfma_f32_16x16x32_bf16 a[128:131], v[208:211], a[176:179], a[128:131]
  buffer_load_dwordx4 a[176:179], v2, s[40:43], s64 offen offset:2048 sc1
  v_mfma_f32_16x16x32_bf16 a[132:135], v[208:211], a[180:183], a[132:135]
  buffer_load_dwordx4 a[180:183], v2, s[40:43], s65 offen offset:2048 sc1
  v_mfma_f32_16x16x32_bf16 a[136:139], v[208:211], a[184:187], a[136:139]
  buffer_load_dwordx4 a[184:187], v2, s[40:43], s66 offen offset:2048 sc1
  v_mfma_f32_16x16x32_bf16 a[140:143], v[208:211], a[188:191], a[140:143]
  buffer_load_dwordx4 a[188:191], v2, s[40:43], s67 offen offset:2048 sc1
  s_waitcnt vmcnt(19)
  v_mfma_f32_16x16x32_bf16 a[64:67], v[212:215], v[216:219], a[64:67]
  v_mfma_f32_16x16x32_bf16 a[68:71], v[212:215], v[220:223], a[68:71]
  ds_read_b128 v[164:167], v11 offset:5120
  v_mfma_f32_16x16x32_bf16 a[72:75], v[212:215], v[224:227], a[72:75]
  v_mfma_f32_16x16x32_bf16 a[76:79], v[212:215], v[228:231], a[76:79]
  buffer_load_dwordx4 a[228:231], v2, s[40:43], s13 offen offset:1024 sc1
  v_mfma_f32_16x16x32_bf16 a[80:83], v[232:235], v[216:219], a[80:83]
  v_mfma_f32_16x16x32_bf16 a[84:87], v[232:235], v[220:223], a[84:87]
  ds_read_b128 v[168:171], v11 offset:6144
  v_mfma_f32_16x16x32_bf16 a[88:91], v[232:235], v[224:227], a[88:91]
  v_mfma_f32_16x16x32_bf16 a[92:95], v[232:235], v[228:231], a[92:95]
  buffer_load_dwordx4 a[232:235], v2, s[40:43], s13 offen offset:2048 sc1
  v_mfma_f32_16x16x32_bf16 a[96:99], v[236:239], v[216:219], a[96:99]
  v_mfma_f32_16x16x32_bf16 a[100:103], v[236:239], v[220:223], a[100:103]
  ds_read_b128 v[172:175], v11 offset:7168
  v_mfma_f32_16x16x32_bf16 a[104:107], v[236:239], v[224:227], a[104:107]
  v_mfma_f32_16x16x32_bf16 a[108:111], v[236:239], v[228:231], a[108:111]
  v_mfma_f32_16x16x32_bf16 a[112:115], v[240:243], v[216:219], a[112:115]
  v_mfma_f32_16x16x32_bf16 a[116:119], v[240:243], v[220:223], a[116:119]
  ds_read_b128 v[192:195], v11 offset:8192
  v_mfma_f32_16x16x32_bf16 a[120:123], v[240:243], v[224:227], a[120:123]
  v_mfma_f32_16x16x32_bf16 a[124:127], v[240:243], v[228:231], a[124:127]
  v_mfma_f32_16x16x32_bf16 a[128:131], v[244:247], v[216:219], a[128:131]
  buffer_load_dwordx4 v[216:219], v2, s[40:43], s64 offen offset:3072 sc1
  v_mfma_f32_16x16x32_bf16 a[132:135], v[244:247], v[220:223], a[132:135]
  buffer_load_dwordx4 v[220:223], v2, s[40:43], s65 offen offset:3072 sc1
  v_mfma_f32_16x16x32_bf16 a[136:139], v[244:247], v[224:227], a[136:139]
  buffer_load_dwordx4 v[224:227], v2, s[40:43], s66 offen offset:3072 sc1
  v_mfma_f32_16x16x32_bf16 a[140:143], v[244:247], v[228:231], a[140:143]
  buffer_load_dwordx4 v[228:231], v2, s[40:43], s67 offen offset:3072 sc1
  s_waitcnt vmcnt(19)
  v_mfma_f32_16x16x32_bf16 a[64:67], v[64:67], a[144:147], a[64:67]
  s_add_u32 s64, s64, 4096
  v_mfma_f32_16x16x32_bf16 a[68:71], v[64:67], a[148:151], a[68:71]
  s_add_u32 s65, s65, 4096
  ds_read_b128 v[196:199], v11 offset:9216
  v_mfma_f32_16x16x32_bf16 a[72:75], v[64:67], a[152:155], a[72:75]
  s_add_u32 s66, s66, 4096
  v_mfma_f32_16x16x32_bf16 a[76:79], v[64:67], a[156:159], a[76:79]
  buffer_load_dwordx4 a[236:239], v2, s[40:43], s13 offen offset:3072 sc1
  v_mfma_f32_16x16x32_bf16 a[80:83], v[68:71], a[144:147], a[80:83]
  s_add_u32 s13, s13, 4096
  v_mfma_f32_16x16x32_bf16 a[84:87], v[68:71], a[148:151], a[84:87]
  ds_read_b128 v[208:211], v11 offset:10240
  v_mfma_f32_16x16x32_bf16 a[88:91], v[68:71], a[152:155], a[88:91]
  s_add_u32 s67, s67, 4096
  v_mfma_f32_16x16x32_bf16 a[92:95], v[68:71], a[156:159], a[92:95]
  buffer_load_dwordx4 a[240:243], v2, s[40:43], s13 offen offset:0 sc1
  v_mfma_f32_16x16x32_bf16 a[96:99], v[72:75], a[144:147], a[96:99]
  v_mfma_f32_16x16x32_bf16 a[100:103], v[72:75], a[148:151], a[100:103]
  ds_read_b128 v[212:215], v11 offset:11264
  v_mfma_f32_16x16x32_bf16 a[104:107], v[72:75], a[152:155], a[104:107]
  v_mfma_f32_16x16x32_bf16 a[108:111], v[72:75], a[156:159], a[108:111]
  v_mfma_f32_16x16x32_bf16 a[112:115], v[76:79], a[144:147], a[112:115]
  v_mfma_f32_16x16x32_bf16 a[116:119], v[76:79], a[148:151], a[116:119]
  ds_read_b128 v[232:235], v11 offset:12288
  v_mfma_f32_16x16x32_bf16 a[120:123], v[76:79], a[152:155], a[120:123]
  v_mfma_f32_16x16x32_bf16 a[124:127], v[76:79], a[156:159], a[124:127]
  v_mfma_f32_16x16x32_bf16 a[128:131], v[80:83], a[144:147], a[128:131]
  buffer_load_dwordx4 a[144:147], v2, s[40:43], s64 offen offset:0 sc1
  v_mfma_f32_16x16x32_bf16 a[132:135], v[80:83], a[148:151], a[132:135]
  buffer_load_dwordx4 a[148:151], v2, s[40:43], s65 offen offset:0 sc1
  v_mfma_f32_16x16x32_bf16 a[136:139], v[80:83], a[152:155], a[136:139]
  buffer_load_dwordx4 a[152:155], v2, s[40:43], s66 offen offset:0 sc1
  v_mfma_f32_16x16x32_bf16 a[140:143], v[80:83], a[156:159], a[140:143]
  buffer_load_dwordx4 a[156:159], v2, s[40:43], s67 offen offset:0 sc1
  s_waitcnt vmcnt(19)
  v_mfma_f32_16x16x32_bf16 a[64:67], v[84:87], a[160:163], a[64:67]
  v_mfma_f32_16x16x32_bf16 a[68:71], v[84:87], a[164:167], a[68:71]
  ds_read_b128 v[236:239], v11 offset:13312
  v_mfma_f32_16x16x32_bf16 a[72:75], v[84:87], a[168:171], a[72:75]
  v_mfma_f32_16x16x32_bf16 a[76:79], v[84:87], a[172:175], a[76:79]
  buffer_load_dwordx4 a[244:247], v2, s[40:43], s13 offen offset:1024 sc1
  v_mfma_f32_16x16x32_bf16 a[80:83], v[88:91], a[160:163], a[80:83]
  v_mfma_f32_16x16x32_bf16 a[84:87], v[88:91], a[164:167], a[84:87]
  ds_read_b128 v[240:243], v11 offset:14336
  v_mfma_f32_16x16x32_bf16 a[88:91], v[88:91], a[168:171], a[88:91]
  v_mfma_f32_16x16x32_bf16 a[92:95], v[88:91], a[172:175], a[92:95]
  buffer_load_dwordx4 a[248:251], v2, s[40:43], s13 offen offset:2048 sc1
  v_mfma_f32_16x16x32_bf16 a[96:99], v[92:95], a[160:163], a[96:99]
  v_mfma_f32_16x16x32_bf16 a[100:103], v[92:95], a[164:167], a[100:103]
  ds_read_b128 v[244:247], v11 offset:15360
  v_mfma_f32_16x16x32_bf16 a[104:107], v[92:95], a[168:171], a[104:107]
  v_mfma_f32_16x16x32_bf16 a[108:111], v[92:95], a[172:175], a[108:111]
  v_mfma_f32_16x16x32_bf16 a[112:115], v[128:131], a[160:163], a[112:115]
  v_mfma_f32_16x16x32_bf16 a[116:119], v[128:131], a[164:167], a[116:119]
  ds_read_b128 v[64:67], v11 offset:16384
  v_mfma_f32_16x16x32_bf16 a[120:123], v[128:131], a[168:171], a[120:123]
  v_mfma_f32_16x16x32_bf16 a[124:127], v[128:131], a[172:175], a[124:127]
  v_mfma_f32_16x16x32_bf16 a[128:131], v[132:135], a[160:163], a[128:131]
  buffer_load_dwordx4 a[160:163], v2, s[40:43], s64 offen offset:1024 sc1
  v_mfma_f32_16x16x32_bf16 a[132:135], v[132:135], a[164:167], a[132:135]
  buffer_load_dwordx4 a[164:167], v2, s[40:43], s65 offen offset:1024 sc1
  v_mfma_f32_16x16x32_bf16 a[136:139], v[132:135], a[168:171], a[136:139]
  buffer_load_dwordx4 a[168:171], v2, s[40:43], s66 offen offset:1024 sc1
  v_mfma_f32_16x16x32_bf16 a[140:143], v[132:135], a[172:175], a[140:143]
  buffer_load_dwordx4 a[172:175], v2, s[40:43], s67 offen offset:1024 sc1
  s_waitcnt vmcnt(18)
  v_mfma_f32_16x16x32_bf16 a[64:67], v[136:139], a[176:179], a[64:67]
  v_mfma_f32_16x16x32_bf16 a[68:71], v[136:139], a[180:183], a[68:71]
  ds_read_b128 v[68:71], v11 offset:17408
  v_mfma_f32_16x16x32_bf16 a[72:75], v[136:139], a[184:187], a[72:75]
  v_mfma_f32_16x16x32_bf16 a[76:79], v[136:139], a[188:191], a[76:79]
  buffer_load_dwordx4 a[252:255], v2, s[40:43], s13 offen offset:3072 sc1
  v_mfma_f32_16x16x32_bf16 a[80:83], v[140:143], a[176:179], a[80:83]
  s_add_u32 s13, s13, 4096
  v_mfma_f32_16x16x32_bf16 a[84:87], v[140:143], a[180:183], a[84:87]
  ds_read_b128 v[72:75], v11 offset:18432
  v_mfma_f32_16x16x32_bf16 a[88:91], v[140:143], a[184:187], a[88:91]
  v_mfma_f32_16x16x32_bf16 a[92:95], v[140:143], a[188:191], a[92:95]
  buffer_load_dwordx4 v[32:35], v2, s[40:43], s13 offen offset:0 sc1
  v_mfma_f32_16x16x32_bf16 a[96:99], v[144:147], a[176:179], a[96:99]
  v_mfma_f32_16x16x32_bf16 a[100:103], v[144:147], a[180:183], a[100:103]
  ds_read_b128 v[76:79], v11 offset:19456
  v_mfma_f32_16x16x32_bf16 a[104:107], v[144:147], a[184:187], a[104:107]
  v_mfma_f32_16x16x32_bf16 a[108:111], v[144:147], a[188:191], a[108:111]
  v_mfma_f32_16x16x32_bf16 a[112:115], v[148:151], a[176:179], a[112:115]
  v_mfma_f32_16x16x32_bf16 a[116:119], v[148:151], a[180:183], a[116:119]
  ds_read_b128 v[80:83], v11 offset:20480
  v_mfma_f32_16x16x32_bf16 a[120:123], v[148:151], a[184:187], a[120:123]
  v_mfma_f32_16x16x32_bf16 a[124:127], v[148:151], a[188:191], a[124:127]
  v_mfma_f32_16x16x32_bf16 a[128:131], v[152:155], a[176:179], a[128:131]
  buffer_load_dwordx4 a[176:179], v2, s[40:43], s64 offen offset:2048 sc1
  v_mfma_f32_16x16x32_bf16 a[132:135], v[152:155], a[180:183], a[132:135]
  buffer_load_dwordx4 a[180:183], v2, s[40:43], s65 offen offset:2048 sc1
  v_mfma_f32_16x16x32_bf16 a[136:139], v[152:155], a[184:187], a[136:139]
  buffer_load_dwordx4 a[184:187], v2, s[40:43], s66 offen offset:2048 sc1
  v_mfma_f32_16x16x32_bf16 a[140:143], v[152:155], a[188:191], a[140:143]
  buffer_load_dwordx4 a[188:191], v2, s[40:43], s67 offen offset:2048 sc1
  s_waitcnt vmcnt(18)
  v_mfma_f32_16x16x32_bf16 a[64:67], v[156:159], v[216:219], a[64:67]
  v_mfma_f32_16x16x32_bf16 a[68:71], v[156:159], v[220:223], a[68:71]
  ds_read_b128 v[84:87], v11 offset:21504
  v_mfma_f32_16x16x32_bf16 a[72:75], v[156:159], v[224:227], a[72:75]
  v_mfma_f32_16x16x32_bf16 a[76:79], v[156:159], v[228:231], a[76:79]
  buffer_load_dwordx4 v[36:39], v2, s[40:43], s13 offen offset:1024 sc1
  v_mfma_f32_16x16x32_bf16 a[80:83], v[176:179], v[216:219], a[80:83]
  v_mfma_f32_16x16x32_bf16 a[84:87], v[176:179], v[220:223], a[84:87]
  ds_read_b128 v[88:91], v11 offset:22528
  v_mfma_f32_16x16x32_bf16 a[88:91], v[176:179], v[224:227], a[88:91]
  v_mfma_f32_16x16x32_bf16 a[92:95], v[176:179], v[228:231], a[92:95]
  buffer_load_dwordx4 v[40:43], v2, s[40:43], s13 offen offset:2048 sc1
  v_mfma_f32_16x16x32_bf16 a[96:99], v[180:183], v[216:219], a[96:99]
  v_mfma_f32_16x16x32_bf16 a[100:103], v[180:183], v[220:223], a[100:103]
  ds_read_b128 v[92:95], v11 offset:23552
  v_mfma_f32_16x16x32_bf16 a[104:107], v[180:183], v[224:227], a[104:107]
  v_mfma_f32_16x16x32_bf16 a[108:111], v[180:183], v[228:231], a[108:111]
  buffer_load_dwordx4 v[44:47], v2, s[40:43], s13 offen offset:3072 sc1
  v_mfma_f32_16x16x32_bf16 a[112:115], v[184:187], v[216:219], a[112:115]
  s_add_u32 s13, s13, 4096
  v_mfma_f32_16x16x32_bf16 a[116:119], v[184:187], v[220:223], a[116:119]
  ds_read_b128 v[128:131], v11 offset:24576
  v_mfma_f32_16x16x32_bf16 a[120:123], v[184:187], v[224:227], a[120:123]
  v_mfma_f32_16x16x32_bf16 a[124:127], v[184:187], v[228:231], a[124:127]
  v_mfma_f32_16x16x32_bf16 a[128:131], v[188:191], v[216:219], a[128:131]
  buffer_load_dwordx4 v[216:219], v2, s[40:43], s64 offen offset:3072 sc1
  v_mfma_f32_16x16x32_bf16 a[132:135], v[188:191], v[220:223], a[132:135]
  buffer_load_dwordx4 v[220:223], v2, s[40:43], s65 offen offset:3072 sc1
  v_mfma_f32_16x16x32_bf16 a[136:139], v[188:191], v[224:227], a[136:139]
  buffer_load_dwordx4 v[224:227], v2, s[40:43], s66 offen offset:3072 sc1
  v_mfma_f32_16x16x32_bf16 a[140:143], v[188:191], v[228:231], a[140:143]
  buffer_load_dwordx4 v[228:231], v2, s[40:43], s67 offen offset:3072 sc1
  s_waitcnt vmcnt(19)
  v_mfma_f32_16x16x32_bf16 a[64:67], a[0:3], a[144:147], a[64:67]
  s_add_u32 s64, s64, 4096
  v_mfma_f32_16x16x32_bf16 a[68:71], a[0:3], a[148:151], a[68:71]
  s_add_u32 s65, s65, 4096
  ds_read_b128 v[132:135], v11 offset:25600
  v_mfma_f32_16x16x32_bf16 a[72:75], a[0:3], a[152:155], a[72:75]
  s_add_u32 s66, s66, 4096
  v_mfma_f32_16x16x32_bf16 a[76:79], a[0:3], a[156:159], a[76:79]
  buffer_load_dwordx4 v[48:51], v2, s[40:43], s13 offen offset:0 sc1
  v_mfma_f32_16x16x32_bf16 a[80:83], a[4:7], a[144:147], a[80:83]
  v_mfma_f32_16x16x32_bf16 a[84:87], a[4:7], a[148:151], a[84:87]
  ds_read_b128 v[136:139], v11 offset:26624
  v_mfma_f32_16x16x32_bf16 a[88:91], a[4:7], a[152:155], a[88:91]
  s_add_u32 s67, s67, 4096
  v_mfma_f32_16x16x32_bf16 a[92:95], a[4:7], a[156:159], a[92:95]
  buffer_load_dwordx4 v[52:55], v2, s[40:43], s13 offen offset:1024 sc1
  v_mfma_f32_16x16x32_bf16 a[96:99], a[8:11], a[144:147], a[96:99]
  v_mfma_f32_16x16x32_bf16 a[100:103], a[8:11], a[148:151], a[100:103]
  ds_read_b128 v[140:143], v11 offset:27648
  v_mfma_f32_16x16x32_bf16 a[104:107], a[8:11], a[152:155], a[104:107]
  v_mfma_f32_16x16x32_bf16 a[108:111], a[8:11], a[156:159], a[108:111]
  v_mfma_f32_16x16x32_bf16 a[112:115], a[12:15], a[144:147], a[112:115]
  v_mfma_f32_16x16x32_bf16 a[116:119], a[12:15], a[148:151], a[116:119]
  ds_read_b128 v[144:147], v11 offset:28672
  v_mfma_f32_16x16x32_bf16 a[120:123], a[12:15], a[152:155], a[120:123]
  v_mfma_f32_16x16x32_bf16 a[124:127], a[12:15], a[156:159], a[124:127]
  v_mfma_f32_16x16x32_bf16 a[128:131], a[16:19], a[144:147], a[128:131]
  buffer_load_dwordx4 a[144:147], v2, s[40:43], s64 offen offset:0 sc1
  v_mfma_f32_16x16x32_bf16 a[132:135], a[16:19], a[148:151], a[132:135]
  buffer_load_dwordx4 a[148:151], v2, s[40:43], s65 offen offset:0 sc1
  v_mfma_f32_16x16x32_bf16 a[136:139], a[16:19], a[152:155], a[136:139]
  buffer_load_dwordx4 a[152:155], v2, s[40:43], s66 offen offset:0 sc1
  v_mfma_f32_16x16x32_bf16 a[140:143], a[16:19], a[156:159], a[140:143]
  buffer_load_dwordx4 a[156:159], v2, s[40:43], s67 offen offset:0 sc1
  s_waitcnt vmcnt(19)
  v_mfma_f32_16x16x32_bf16 a[64:67], a[20:23], a[160:163], a[64:67]
  v_mfma_f32_16x16x32_bf16 a[68:71], a[20:23], a[164:167], a[68:71]
  ds_read_b128 v[148:151], v11 offset:29696
  v_mfma_f32_16x16x32_bf16 a[72:75], a[20:23], a[168:171], a[72:75]
  v_mfma_f32_16x16x32_bf16 a[76:79], a[20:23], a[172:175], a[76:79]
  buffer_load_dwordx4 v[56:59], v2, s[40:43], s13 offen offset:2048 sc1
  v_mfma_f32_16x16x32_bf16 a[80:83], a[24:27], a[160:163], a[80:83]
  v_mfma_f32_16x16x32_bf16 a[84:87], a[24:27], a[164:167], a[84:87]
  ds_read_b128 v[152:155], v11 offset:30720
  v_mfma_f32_16x16x32_bf16 a[88:91], a[24:27], a[168:171], a[88:91]
  v_mfma_f32_16x16x32_bf16 a[92:95], a[24:27], a[172:175], a[92:95]
  buffer_load_dwordx4 v[60:63], v2, s[40:43], s13 offen offset:3072 sc1
  v_mfma_f32_16x16x32_bf16 a[96:99], a[28:31], a[160:163], a[96:99]
  s_add_u32 s13, s13, 4096
  v_mfma_f32_16x16x32_bf16 a[100:103], a[28:31], a[164:167], a[100:103]
  ds_read_b128 v[156:159], v11 offset:31744
  v_mfma_f32_16x16x32_bf16 a[104:107], a[28:31], a[168:171], a[104:107]
  v_mfma_f32_16x16x32_bf16 a[108:111], a[28:31], a[172:175], a[108:111]
  v_mfma_f32_16x16x32_bf16 a[112:115], a[32:35], a[160:163], a[112:115]
  v_mfma_f32_16x16x32_bf16 a[116:119], a[32:35], a[164:167], a[116:119]
  ds_read_b128 v[176:179], v11 offset:32768
  v_mfma_f32_16x16x32_bf16 a[120:123], a[32:35], a[168:171], a[120:123]
  v_mfma_f32_16x16x32_bf16 a[124:127], a[32:35], a[172:175], a[124:127]
  v_mfma_f32_16x16x32_bf16 a[128:131], a[36:39], a[160:163], a[128:131]
  buffer_load_dwordx4 a[160:163], v2, s[40:43], s64 offen offset:1024 sc1
  v_mfma_f32_16x16x32_bf16 a[132:135], a[36:39], a[164:167], a[132:135]
  buffer_load_dwordx4 a[164:167], v2, s[40:43], s65 offen offset:1024 sc1
  v_mfma_f32_16x16x32_bf16 a[136:139], a[36:39], a[168:171], a[136:139]
  buffer_load_dwordx4 a[168:171], v2, s[40:43], s66 offen offset:1024 sc1
  v_mfma_f32_16x16x32_bf16 a[140:143], a[36:39], a[172:175], a[140:143]
  buffer_load_dwordx4 a[172:175], v2, s[40:43], s67 offen offset:1024 sc1
  s_waitcnt vmcnt(19)
  v_mfma_f32_16x16x32_bf16 a[64:67], a[40:43], a[176:179], a[64:67]
  v_mfma_f32_16x16x32_bf16 a[68:71], a[40:43], a[180:183], a[68:71]
  ds_read_b128 v[180:183], v11 offset:33792
  v_mfma_f32_16x16x32_bf16 a[72:75], a[40:43], a[184:187], a[72:75]
  v_mfma_f32_16x16x32_bf16 a[76:79], a[40:43], a[188:191], a[76:79]
  buffer_load_dwordx4 v[96:99], v2, s[40:43], s13 offen offset:0 sc1
  v_mfma_f32_16x16x32_bf16 a[80:83], a[44:47], a[176:179], a[80:83]
  v_mfma_f32_16x16x32_bf16 a[84:87], a[44:47], a[180:183], a[84:87]
  ds_read_b128 v[184:187], v11 offset:34816
  v_mfma_f32_16x16x32_bf16 a[88:91], a[44:47], a[184:187], a[88:91]
  v_mfma_f32_16x16x32_bf16 a[92:95], a[44:47], a[188:191], a[92:95]
  buffer_load_dwordx4 v[100:103], v2, s[40:43], s13 offen offset:1024 sc1
  v_mfma_f32_16x16x32_bf16 a[96:99], a[48:51], a[176:179], a[96:99]
  v_mfma_f32_16x16x32_bf16 a[100:103], a[48:51], a[180:183], a[100:103]
  ds_read_b128 v[188:191], v11 offset:35840
  v_mfma_f32_16x16x32_bf16 a[104:107], a[48:51], a[184:187], a[104:107]
  v_mfma_f32_16x16x32_bf16 a[108:111], a[48:51], a[188:191], a[108:111]
  v_mfma_f32_16x16x32_bf16 a[112:115], a[52:55], a[176:179], a[112:115]
  v_mfma_f32_16x16x32_bf16 a[116:119], a[52:55], a[180:183], a[116:119]
  v_mfma_f32_16x16x32_bf16 a[120:123], a[52:55], a[184:187], a[120:123]
  v_mfma_f32_16x16x32_bf16 a[124:127], a[52:55], a[188:191], a[124:127]
  v_mfma_f32_16x16x32_bf16 a[128:131], a[56:59], a[176:179], a[128:131]
  buffer_load_dwordx4 a[176:179], v2, s[40:43], s64 offen offset:2048 sc1
  v_mfma_f32_16x16x32_bf16 a[132:135], a[56:59], a[180:183], a[132:135]
  buffer_load_dwordx4 a[180:183], v2, s[40:43], s65 offen offset:2048 sc1
  v_mfma_f32_16x16x32_bf16 a[136:139], a[56:59], a[184:187], a[136:139]
  buffer_load_dwordx4 a[184:187], v2, s[40:43], s66 offen offset:2048 sc1
  v_mfma_f32_16x16x32_bf16 a[140:143], a[56:59], a[188:191], a[140:143]
  buffer_load_dwordx4 a[188:191], v2, s[40:43], s67 offen offset:2048 sc1
  s_waitcnt vmcnt(18)
  v_mfma_f32_16x16x32_bf16 a[64:67], a[60:63], v[216:219], a[64:67]
  v_mfma_f32_16x16x32_bf16 a[68:71], a[60:63], v[220:223], a[68:71]
  v_mfma_f32_16x16x32_bf16 a[72:75], a[60:63], v[224:227], a[72:75]
  v_mfma_f32_16x16x32_bf16 a[76:79], a[60:63], v[228:231], a[76:79]
  buffer_load_dwordx4 v[104:107], v2, s[40:43], s13 offen offset:2048 sc1
  v_mfma_f32_16x16x32_bf16 a[80:83], a[192:195], v[216:219], a[80:83]
  v_mfma_f32_16x16x32_bf16 a[84:87], a[192:195], v[220:223], a[84:87]
  v_mfma_f32_16x16x32_bf16 a[88:91], a[192:195], v[224:227], a[88:91]
  v_mfma_f32_16x16x32_bf16 a[92:95], a[192:195], v[228:231], a[92:95]
  buffer_load_dwordx4 v[108:111], v2, s[40:43], s13 offen offset:3072 sc1
  v_mfma_f32_16x16x32_bf16 a[96:99], a[196:199], v[216:219], a[96:99]
  s_add_u32 s13, s13, 4096
  v_mfma_f32_16x16x32_bf16 a[100:103], a[196:199], v[220:223], a[100:103]
  v_mfma_f32_16x16x32_bf16 a[104:107], a[196:199], v[224:227], a[104:107]
  v_mfma_f32_16x16x32_bf16 a[108:111], a[196:199], v[228:231], a[108:111]
  v_mfma_f32_16x16x32_bf16 a[112:115], a[200:203], v[216:219], a[112:115]
  v_mfma_f32_16x16x32_bf16 a[116:119], a[200:203], v[220:223], a[116:119]
  v_mfma_f32_16x16x32_bf16 a[120:123], a[200:203], v[224:227], a[120:123]
  v_mfma_f32_16x16x32_bf16 a[124:127], a[200:203], v[228:231], a[124:127]
  v_mfma_f32_16x16x32_bf16 a[128:131], a[204:207], v[216:219], a[128:131]
  buffer_load_dwordx4 v[216:219], v2, s[40:43], s64 offen offset:3072 sc1
  v_mfma_f32_16x16x32_bf16 a[132:135], a[204:207], v[220:223], a[132:135]
  buffer_load_dwordx4 v[220:223], v2, s[40:43], s65 offen offset:3072 sc1
  v_mfma_f32_16x16x32_bf16 a[136:139], a[204:207], v[224:227], a[136:139]
  buffer_load_dwordx4 v[224:227], v2, s[40:43], s66 offen offset:3072 sc1
  v_mfma_f32_16x16x32_bf16 a[140:143], a[204:207], v[228:231], a[140:143]
  buffer_load_dwordx4 v[228:231], v2, s[40:43], s67 offen offset:3072 sc1
  s_waitcnt vmcnt(18)
  v_mfma_f32_16x16x32_bf16 a[64:67], a[208:211], a[144:147], a[64:67]
  s_add_u32 s64, s64, 4096
  v_mfma_f32_16x16x32_bf16 a[68:71], a[208:211], a[148:151], a[68:71]
  s_add_u32 s65, s65, 4096
  v_mfma_f32_16x16x32_bf16 a[72:75], a[208:211], a[152:155], a[72:75]
  s_add_u32 s66, s66, 4096
  v_mfma_f32_16x16x32_bf16 a[76:79], a[208:211], a[156:159], a[76:79]
  v_mfma_f32_16x16x32_bf16 a[80:83], a[212:215], a[144:147], a[80:83]
  v_mfma_f32_16x16x32_bf16 a[84:87], a[212:215], a[148:151], a[84:87]
  v_mfma_f32_16x16x32_bf16 a[88:91], a[212:215], a[152:155], a[88:91]
  s_add_u32 s67, s67, 4096
  v_mfma_f32_16x16x32_bf16 a[92:95], a[212:215], a[156:159], a[92:95]
  v_mfma_f32_16x16x32_bf16 a[96:99], a[216:219], a[144:147], a[96:99]
  v_mfma_f32_16x16x32_bf16 a[100:103], a[216:219], a[148:151], a[100:103]
  v_mfma_f32_16x16x32_bf16 a[104:107], a[216:219], a[152:155], a[104:107]
  v_mfma_f32_16x16x32_bf16 a[108:111], a[216:219], a[156:159], a[108:111]
  v_mfma_f32_16x16x32_bf16 a[112:115], a[220:223], a[144:147], a[112:115]
  v_mfma_f32_16x16x32_bf16 a[116:119], a[220:223], a[148:151], a[116:119]
  v_mfma_f32_16x16x32_bf16 a[120:123], a[220:223], a[152:155], a[120:123]
  v_mfma_f32_16x16x32_bf16 a[124:127], a[220:223], a[156:159], a[124:127]
  v_mfma_f32_16x16x32_bf16 a[128:131], a[224:227], a[144:147], a[128:131]
  buffer_load_dwordx4 a[144:147], v2, s[40:43], s64 offen offset:0 sc1
  v_mfma_f32_16x16x32_bf16 a[132:135], a[224:227], a[148:151], a[132:135]
  buffer_load_dwordx4 a[148:151], v2, s[40:43], s65 offen offset:0 sc1
  v_mfma_f32_16x16x32_bf16 a[136:139], a[224:227], a[152:155], a[136:139]
  buffer_load_dwordx4 a[152:155], v2, s[40:43], s66 offen offset:0 sc1
  v_mfma_f32_16x16x32_bf16 a[140:143], a[224:227], a[156:159], a[140:143]
  buffer_load_dwordx4 a[156:159], v2, s[40:43], s67 offen offset:0 sc1
  s_waitcnt vmcnt(16)
  v_mfma_f32_16x16x32_bf16 a[64:67], a[228:231], a[160:163], a[64:67]
  v_mfma_f32_16x16x32_bf16 a[68:71], a[228:231], a[164:167], a[68:71]
  v_mfma_f32_16x16x32_bf16 a[72:75], a[228:231], a[168:171], a[72:75]
  v_mfma_f32_16x16x32_bf16 a[76:79], a[228:231], a[172:175], a[76:79]
  v_mfma_f32_16x16x32_bf16 a[80:83], a[232:235], a[160:163], a[80:83]
  v_mfma_f32_16x16x32_bf16 a[84:87], a[232:235], a[164:167], a[84:87]
  v_mfma_f32_16x16x32_bf16 a[88:91], a[232:235], a[168:171], a[88:91]
  v_mfma_f32_16x16x32_bf16 a[92:95], a[232:235], a[172:175], a[92:95]
  v_mfma_f32_16x16x32_bf16 a[96:99], a[236:239], a[160:163], a[96:99]
  v_mfma_f32_16x16x32_bf16 a[100:103], a[236:239], a[164:167], a[100:103]
  v_mfma_f32_16x16x32_bf16 a[104:107], a[236:239], a[168:171], a[104:107]
  v_mfma_f32_16x16x32_bf16 a[108:111], a[236:239], a[172:175], a[108:111]
  v_mfma_f32_16x16x32_bf16 a[112:115], a[240:243], a[160:163], a[112:115]
  v_mfma_f32_16x16x32_bf16 a[116:119], a[240:243], a[164:167], a[116:119]
  v_mfma_f32_16x16x32_bf16 a[120:123], a[240:243], a[168:171], a[120:123]
  v_mfma_f32_16x16x32_bf16 a[124:127], a[240:243], a[172:175], a[124:127]
  v_mfma_f32_16x16x32_bf16 a[128:131], a[244:247], a[160:163], a[128:131]
  buffer_load_dwordx4 a[160:163], v2, s[40:43], s64 offen offset:1024 sc1
  v_mfma_f32_16x16x32_bf16 a[132:135], a[244:247], a[164:167], a[132:135]
  buffer_load_dwordx4 a[164:167], v2, s[40:43], s65 offen offset:1024 sc1
  v_mfma_f32_16x16x32_bf16 a[136:139], a[244:247], a[168:171], a[136:139]
  buffer_load_dwordx4 a[168:171], v2, s[40:43], s66 offen offset:1024 sc1
  v_mfma_f32_16x16x32_bf16 a[140:143], a[244:247], a[172:175], a[140:143]
  buffer_load_dwordx4 a[172:175], v2, s[40:43], s67 offen offset:1024 sc1
  s_waitcnt vmcnt(14)
  v_mfma_f32_16x16x32_bf16 a[64:67], a[248:251], a[176:179], a[64:67]
  v_mfma_f32_16x16x32_bf16 a[68:71], a[248:251], a[180:183], a[68:71]
  v_mfma_f32_16x16x32_bf16 a[72:75], a[248:251], a[184:187], a[72:75]
  v_mfma_f32_16x16x32_bf16 a[76:79], a[248:251], a[188:191], a[76:79]
  v_mfma_f32_16x16x32_bf16 a[80:83], a[252:255], a[176:179], a[80:83]
  v_mfma_f32_16x16x32_bf16 a[84:87], a[252:255], a[180:183], a[84:87]
  v_mfma_f32_16x16x32_bf16 a[88:91], a[252:255], a[184:187], a[88:91]
  v_mfma_f32_16x16x32_bf16 a[92:95], a[252:255], a[188:191], a[92:95]
  v_mfma_f32_16x16x32_bf16 a[96:99], v[32:35], a[176:179], a[96:99]
  v_mfma_f32_16x16x32_bf16 a[100:103], v[32:35], a[180:183], a[100:103]
  v_mfma_f32_16x16x32_bf16 a[104:107], v[32:35], a[184:187], a[104:107]
  v_mfma_f32_16x16x32_bf16 a[108:111], v[32:35], a[188:191], a[108:111]
  v_mfma_f32_16x16x32_bf16 a[112:115], v[36:39], a[176:179], a[112:115]
  v_mfma_f32_16x16x32_bf16 a[116:119], v[36:39], a[180:183], a[116:119]
  v_mfma_f32_16x16x32_bf16 a[120:123], v[36:39], a[184:187], a[120:123]
  v_mfma_f32_16x16x32_bf16 a[124:127], v[36:39], a[188:191], a[124:127]
  v_mfma_f32_16x16x32_bf16 a[128:131], v[40:43], a[176:179], a[128:131]
  buffer_load_dwordx4 a[176:179], v2, s[40:43], s64 offen offset:2048 sc1
  v_mfma_f32_16x16x32_bf16 a[132:135], v[40:43], a[180:183], a[132:135]
  buffer_load_dwordx4 a[180:183], v2, s[40:43], s65 offen offset:2048 sc1
  v_mfma_f32_16x16x32_bf16 a[136:139], v[40:43], a[184:187], a[136:139]
  buffer_load_dwordx4 a[184:187], v2, s[40:43], s66 offen offset:2048 sc1
  v_mfma_f32_16x16x32_bf16 a[140:143], v[40:43], a[188:191], a[140:143]
  buffer_load_dwordx4 a[188:191], v2, s[40:43], s67 offen offset:2048 sc1
  s_waitcnt vmcnt(12)
  v_mfma_f32_16x16x32_bf16 a[64:67], v[44:47], v[216:219], a[64:67]
  v_mfma_f32_16x16x32_bf16 a[68:71], v[44:47], v[220:223], a[68:71]
  v_mfma_f32_16x16x32_bf16 a[72:75], v[44:47], v[224:227], a[72:75]
  v_mfma_f32_16x16x32_bf16 a[76:79], v[44:47], v[228:231], a[76:79]
  v_mfma_f32_16x16x32_bf16 a[80:83], v[48:51], v[216:219], a[80:83]
  v_mfma_f32_16x16x32_bf16 a[84:87], v[48:51], v[220:223], a[84:87]
  v_mfma_f32_16x16x32_bf16 a[88:91], v[48:51], v[224:227], a[88:91]
  v_mfma_f32_16x16x32_bf16 a[92:95], v[48:51], v[228:231], a[92:95]
  v_mfma_f32_16x16x32_bf16 a[96:99], v[52:55], v[216:219], a[96:99]
  v_mfma_f32_16x16x32_bf16 a[100:103], v[52:55], v[220:223], a[100:103]
  v_mfma_f32_16x16x32_bf16 a[104:107], v[52:55], v[224:227], a[104:107]
  v_mfma_f32_16x16x32_bf16 a[108:111], v[52:55], v[228:231], a[108:111]
  v_mfma_f32_16x16x32_bf16 a[112:115], v[56:59], v[216:219], a[112:115]
  v_mfma_f32_16x16x32_bf16 a[116:119], v[56:59], v[220:223], a[116:119]
  v_mfma_f32_16x16x32_bf16 a[120:123], v[56:59], v[224:227], a[120:123]
  v_mfma_f32_16x16x32_bf16 a[124:127], v[56:59], v[228:231], a[124:127]
  v_mfma_f32_16x16x32_bf16 a[128:131], v[60:63], v[216:219], a[128:131]
  buffer_load_dwordx4 v[216:219], v2, s[40:43], s64 offen offset:3072 sc1
  v_mfma_f32_16x16x32_bf16 a[132:135], v[60:63], v[220:223], a[132:135]
  buffer_load_dwordx4 v[220:223], v2, s[40:43], s65 offen offset:3072 sc1
  v_mfma_f32_16x16x32_bf16 a[136:139], v[60:63], v[224:227], a[136:139]
  buffer_load_dwordx4 v[224:227], v2, s[40:43], s66 offen offset:3072 sc1
  v_mfma_f32_16x16x32_bf16 a[140:143], v[60:63], v[228:231], a[140:143]
  buffer_load_dwordx4 v[228:231], v2, s[40:43], s67 offen offset:3072 sc1
  s_waitcnt vmcnt(12) lgkmcnt(0)
  v_mfma_f32_16x16x32_bf16 a[64:67], v[96:99], a[144:147], a[64:67]
  s_add_u32 s64, s64, 4096
  v_mfma_f32_16x16x32_bf16 a[68:71], v[96:99], a[148:151], a[68:71]
  s_add_u32 s65, s65, 4096
  v_mfma_f32_16x16x32_bf16 a[72:75], v[96:99], a[152:155], a[72:75]
  s_add_u32 s66, s66, 4096
  v_mfma_f32_16x16x32_bf16 a[76:79], v[96:99], a[156:159], a[76:79]
  buffer_load_dwordx4 v[32:35], v248, s[44:47], 0 offen
  v_mfma_f32_16x16x32_bf16 a[80:83], v[100:103], a[144:147], a[80:83]
  v_mfma_f32_16x16x32_bf16 a[84:87], v[100:103], a[148:151], a[84:87]
  buffer_load_dwordx4 v[44:47], v200, s[40:43], s27 offen sc1
  v_mfma_f32_16x16x32_bf16 a[88:91], v[100:103], a[152:155], a[88:91]
  s_add_u32 s67, s67, 4096
  v_mfma_f32_16x16x32_bf16 a[92:95], v[100:103], a[156:159], a[92:95]
  buffer_load_dwordx4 v[36:39], v249, s[44:47], 0 offen
  v_mfma_f32_16x16x32_bf16 a[96:99], v[104:107], a[144:147], a[96:99]
  v_mfma_f32_16x16x32_bf16 a[100:103], v[104:107], a[148:151], a[100:103]
  buffer_load_dwordx4 v[48:51], v201, s[40:43], s27 offen sc1
  v_mfma_f32_16x16x32_bf16 a[104:107], v[104:107], a[152:155], a[104:107]
  v_mfma_f32_16x16x32_bf16 a[108:111], v[104:107], a[156:159], a[108:111]
  buffer_load_dwordx4 v[40:43], v250, s[44:47], 0 offen
  v_mfma_f32_16x16x32_bf16 a[112:115], v[108:111], a[144:147], a[112:115]
  v_mfma_f32_16x16x32_bf16 a[116:119], v[108:111], a[148:151], a[116:119]
  buffer_load_dwordx4 v[52:55], v202, s[40:43], s27 offen sc1
  v_mfma_f32_16x16x32_bf16 a[120:123], v[108:111], a[152:155], a[120:123]
  v_mfma_f32_16x16x32_bf16 a[124:127], v[108:111], a[156:159], a[124:127]
  v_mfma_f32_16x16x32_bf16 a[128:131], v[112:115], a[144:147], a[128:131]
  buffer_load_dwordx4 a[144:147], v2, s[40:43], s64 offen offset:0 sc1
  v_mfma_f32_16x16x32_bf16 a[132:135], v[112:115], a[148:151], a[132:135]
  buffer_load_dwordx4 a[148:151], v2, s[40:43], s65 offen offset:0 sc1
  v_mfma_f32_16x16x32_bf16 a[136:139], v[112:115], a[152:155], a[136:139]
  buffer_load_dwordx4 a[152:155], v2, s[40:43], s66 offen offset:0 sc1
  v_mfma_f32_16x16x32_bf16 a[140:143], v[112:115], a[156:159], a[140:143]
  buffer_load_dwordx4 a[156:159], v2, s[40:43], s67 offen offset:0 sc1
  s_waitcnt vmcnt(18)
  v_mfma_f32_16x16x32_bf16 a[64:67], v[116:119], a[160:163], a[64:67]
  v_mfma_f32_16x16x32_bf16 a[68:71], v[116:119], a[164:167], a[68:71]
  v_mfma_f32_16x16x32_bf16 a[72:75], v[116:119], a[168:171], a[72:75]
  v_mfma_f32_16x16x32_bf16 a[76:79], v[116:119], a[172:175], a[76:79]
  v_mfma_f32_16x16x32_bf16 a[80:83], v[120:123], a[160:163], a[80:83]
  v_mfma_f32_16x16x32_bf16 a[84:87], v[120:123], a[164:167], a[84:87]
  v_mfma_f32_16x16x32_bf16 a[88:91], v[120:123], a[168:171], a[88:91]
  v_mfma_f32_16x16x32_bf16 a[92:95], v[120:123], a[172:175], a[92:95]
  v_mfma_f32_16x16x32_bf16 a[96:99], v[124:127], a[160:163], a[96:99]
  v_mfma_f32_16x16x32_bf16 a[100:103], v[124:127], a[164:167], a[100:103]
  v_mfma_f32_16x16x32_bf16 a[104:107], v[124:127], a[168:171], a[104:107]
  v_mfma_f32_16x16x32_bf16 a[108:111], v[124:127], a[172:175], a[108:111]
  v_mfma_f32_16x16x32_bf16 a[112:115], v[160:163], a[160:163], a[112:115]
  v_mfma_f32_16x16x32_bf16 a[116:119], v[160:163], a[164:167], a[116:119]
  v_mfma_f32_16x16x32_bf16 a[120:123], v[160:163], a[168:171], a[120:123]
  v_mfma_f32_16x16x32_bf16 a[124:127], v[160:163], a[172:175], a[124:127]
  v_mfma_f32_16x16x32_bf16 a[128:131], v[164:167], a[160:163], a[128:131]
  buffer_load_dwordx4 a[160:163], v2, s[40:43], s64 offen offset:1024 sc1
  v_mfma_f32_16x16x32_bf16 a[132:135], v[164:167], a[164:167], a[132:135]
  buffer_load_dwordx4 a[164:167], v2, s[40:43], s65 offen offset:1024 sc1
  v_mfma_f32_16x16x32_bf16 a[136:139], v[164:167], a[168:171], a[136:139]
  buffer_load_dwordx4 a[168:171], v2, s[40:43], s66 offen offset:1024 sc1
  v_mfma_f32_16x16x32_bf16 a[140:143], v[164:167], a[172:175], a[140:143]
  buffer_load_dwordx4 a[172:175], v2, s[40:43], s67 offen offset:1024 sc1
  s_waitcnt vmcnt(18)
  v_mfma_f32_16x16x32_bf16 a[64:67], v[168:171], a[176:179], a[64:67]
  v_mfma_f32_16x16x32_bf16 a[68:71], v[168:171], a[180:183], a[68:71]
  v_mfma_f32_16x16x32_bf16 a[72:75], v[168:171], a[184:187], a[72:75]
  v_mfma_f32_16x16x32_bf16 a[76:79], v[168:171], a[188:191], a[76:79]
  v_mfma_f32_16x16x32_bf16 a[80:83], v[172:175], a[176:179], a[80:83]
  v_mfma_f32_16x16x32_bf16 a[84:87], v[172:175], a[180:183], a[84:87]
  v_mfma_f32_16x16x32_bf16 a[88:91], v[172:175], a[184:187], a[88:91]
  v_mfma_f32_16x16x32_bf16 a[92:95], v[172:175], a[188:191], a[92:95]
  v_mfma_f32_16x16x32_bf16 a[96:99], v[192:195], a[176:179], a[96:99]
  v_mfma_f32_16x16x32_bf16 a[100:103], v[192:195], a[180:183], a[100:103]
  v_mfma_f32_16x16x32_bf16 a[104:107], v[192:195], a[184:187], a[104:107]
  v_mfma_f32_16x16x32_bf16 a[108:111], v[192:195], a[188:191], a[108:111]
  v_mfma_f32_16x16x32_bf16 a[112:115], v[196:199], a[176:179], a[112:115]
  v_mfma_f32_16x16x32_bf16 a[116:119], v[196:199], a[180:183], a[116:119]
  v_mfma_f32_16x16x32_bf16 a[120:123], v[196:199], a[184:187], a[120:123]
  v_mfma_f32_16x16x32_bf16 a[124:127], v[196:199], a[188:191], a[124:127]
  v_mfma_f32_16x16x32_bf16 a[128:131], v[208:211], a[176:179], a[128:131]
  buffer_load_dwordx4 a[176:179], v2, s[40:43], s64 offen offset:2048 sc1
  v_mfma_f32_16x16x32_bf16 a[132:135], v[208:211], a[180:183], a[132:135]
  buffer_load_dwordx4 a[180:183], v2, s[40:43], s65 offen offset:2048 sc1
  v_mfma_f32_16x16x32_bf16 a[136:139], v[208:211], a[184:187], a[136:139]
  buffer_load_dwordx4 a[184:187], v2, s[40:43], s66 offen offset:2048 sc1
  v_mfma_f32_16x16x32_bf16 a[140:143], v[208:211], a[188:191], a[140:143]
  buffer_load_dwordx4 a[188:191], v2, s[40:43], s67 offen offset:2048 sc1
  s_waitcnt vmcnt(18)
  v_mfma_f32_16x16x32_bf16 a[64:67], v[212:215], v[216:219], a[64:67]
  v_mfma_f32_16x16x32_bf16 a[68:71], v[212:215], v[220:223], a[68:71]
  ds_read_b128 v[120:123], v203 offset:0
  v_mfma_f32_16x16x32_bf16 a[72:75], v[212:215], v[224:227], a[72:75]
  v_add_u32 v20, 77824, v251
  v_mfma_f32_16x16x32_bf16 a[76:79], v[212:215], v[228:231], a[76:79]
  ds_read_b128 v[124:127], v203 offset:16
  v_mfma_f32_16x16x32_bf16 a[80:83], v[232:235], v[216:219], a[80:83]
  v_mfma_f32_16x16x32_bf16 a[84:87], v[232:235], v[220:223], a[84:87]
  ds_read_b128 v[160:163], v204 offset:0
  v_mfma_f32_16x16x32_bf16 a[88:91], v[232:235], v[224:227], a[88:91]
  v_add_u32 v21, 77824, v252
  v_mfma_f32_16x16x32_bf16 a[92:95], v[232:235], v[228:231], a[92:95]
  ds_read_b128 v[164:167], v204 offset:16
  v_mfma_f32_16x16x32_bf16 a[96:99], v[236:239], v[216:219], a[96:99]
  v_mfma_f32_16x16x32_bf16 a[100:103], v[236:239], v[220:223], a[100:103]
  ds_read_b128 v[168:171], v205 offset:0
  v_mfma_f32_16x16x32_bf16 a[104:107], v[236:239], v[224:227], a[104:107]
  v_add_u32 v22, 77824, v253
  v_mfma_f32_16x16x32_bf16 a[108:111], v[236:239], v[228:231], a[108:111]
  ds_read_b128 v[172:175], v205 offset:16
  v_mfma_f32_16x16x32_bf16 a[112:115], v[240:243], v[216:219], a[112:115]
  v_mfma_f32_16x16x32_bf16 a[116:119], v[240:243], v[220:223], a[116:119]
  v_mfma_f32_16x16x32_bf16 a[120:123], v[240:243], v[224:227], a[120:123]
  s_mul_i32 s23, s20, 38912
  v_and_b32 v16, 15, v1
  v_mul_u32_u24 v16, 336, v16
  v_mfma_f32_16x16x32_bf16 a[124:127], v[240:243], v[228:231], a[124:127]
  v_lshrrev_b32 v17, 4, v1
  v_lshl_add_u32 v16, v17, 4, v16
  v_mfma_f32_16x16x32_bf16 a[128:131], v[244:247], v[216:219], a[128:131]
  buffer_load_dwordx4 v[216:219], v2, s[40:43], s64 offen offset:3072 sc1
  v_add_u32 v16, s23, v16
  v_mfma_f32_16x16x32_bf16 a[132:135], v[244:247], v[220:223], a[132:135]
  buffer_load_dwordx4 v[220:223], v2, s[40:43], s65 offen offset:3072 sc1
  v_mfma_f32_16x16x32_bf16 a[136:139], v[244:247], v[224:227], a[136:139]
  s_waitcnt lgkmcnt(0)
  buffer_load_dwordx4 v[224:227], v2, s[40:43], s66 offen offset:3072 sc1
  v_mfma_f32_16x16x32_bf16 a[140:143], v[244:247], v[228:231], a[140:143]
  buffer_load_dwordx4 v[228:231], v2, s[40:43], s67 offen offset:3072 sc1
  s_waitcnt vmcnt(12)
  v_mfma_f32_16x16x32_bf16 a[64:67], v[64:67], a[144:147], a[64:67]
  v_lshlrev_b32 v18, 16, v44
  v_and_b32 v19, 0xffff0000, v44
  v_mfma_f32_16x16x32_bf16 a[68:71], v[64:67], a[148:151], a[68:71]
  v_add_f32 v120, v120, v18
  v_add_f32 v121, v121, v19
  v_mfma_f32_16x16x32_bf16 a[72:75], v[64:67], a[152:155], a[72:75]
  v_cvt_pk_bf16_f32 v18, v120, v121
  v_lshlrev_b32 v96, 16, v32
  v_mfma_f32_16x16x32_bf16 a[76:79], v[64:67], a[156:159], a[76:79]
  v_and_b32 v97, 0xffff0000, v32
  v_lshlrev_b32 v120, 16, v18
  v_mfma_f32_16x16x32_bf16 a[80:83], v[68:71], a[144:147], a[80:83]
  v_and_b32 v121, 0xffff0000, v18
  v_lshlrev_b32 v18, 16, v45
  v_mfma_f32_16x16x32_bf16 a[84:87], v[68:71], a[148:151], a[84:87]
  v_and_b32 v19, 0xffff0000, v45
  v_add_f32 v122, v122, v18
  v_mfma_f32_16x16x32_bf16 a[88:91], v[68:71], a[152:155], a[88:91]
  v_add_f32 v123, v123, v19
  v_cvt_pk_bf16_f32 v18, v122, v123
  v_mfma_f32_16x16x32_bf16 a[92:95], v[68:71], a[156:159], a[92:95]
  v_lshlrev_b32 v98, 16, v33
  v_and_b32 v99, 0xffff0000, v33
  v_mfma_f32_16x16x32_bf16 a[96:99], v[72:75], a[144:147], a[96:99]
  v_lshlrev_b32 v122, 16, v18
  v_and_b32 v123, 0xffff0000, v18
  v_mfma_f32_16x16x32_bf16 a[100:103], v[72:75], a[148:151], a[100:103]
  v_lshlrev_b32 v18, 16, v46
  v_and_b32 v19, 0xffff0000, v46
  v_mfma_f32_16x16x32_bf16 a[104:107], v[72:75], a[152:155], a[104:107]
  v_add_f32 v124, v124, v18
  v_add_f32 v125, v125, v19
  v_mfma_f32_16x16x32_bf16 a[108:111], v[72:75], a[156:159], a[108:111]
  v_cvt_pk_bf16_f32 v18, v124, v125
  v_lshlrev_b32 v100, 16, v34
  v_mfma_f32_16x16x32_bf16 a[112:115], v[76:79], a[144:147], a[112:115]
  v_and_b32 v101, 0xffff0000, v34
  v_lshlrev_b32 v124, 16, v18
  v_mfma_f32_16x16x32_bf16 a[116:119], v[76:79], a[148:151], a[116:119]
  v_and_b32 v125, 0xffff0000, v18
  v_lshlrev_b32 v18, 16, v47
  v_mfma_f32_16x16x32_bf16 a[120:123], v[76:79], a[152:155], a[120:123]
  v_and_b32 v19, 0xffff0000, v47
  v_add_f32 v126, v126, v18
  v_mfma_f32_16x16x32_bf16 a[124:127], v[76:79], a[156:159], a[124:127]
  v_add_f32 v127, v127, v19
  v_cvt_pk_bf16_f32 v18, v126, v127
  v_mfma_f32_16x16x32_bf16 a[128:131], v[80:83], a[144:147], a[128:131]
  v_lshlrev_b32 v102, 16, v35
  v_and_b32 v103, 0xffff0000, v35
  v_mfma_f32_16x16x32_bf16 a[132:135], v[80:83], a[148:151], a[132:135]
  v_lshlrev_b32 v126, 16, v18
  v_and_b32 v127, 0xffff0000, v18
  v_mfma_f32_16x16x32_bf16 a[136:139], v[80:83], a[152:155], a[136:139]
  v_mfma_f32_16x16x32_bf16 a[140:143], v[80:83], a[156:159], a[140:143]
  s_waitcnt vmcnt(8)
  v_mfma_f32_16x16x32_bf16 a[64:67], v[84:87], a[160:163], a[64:67]
  v_lshlrev_b32 v18, 16, v48
  v_and_b32 v19, 0xffff0000, v48
  v_mfma_f32_16x16x32_bf16 a[68:71], v[84:87], a[164:167], a[68:71]
  v_add_f32 v160, v160, v18
  v_add_f32 v161, v161, v19
  v_mfma_f32_16x16x32_bf16 a[72:75], v[84:87], a[168:171], a[72:75]
  v_cvt_pk_bf16_f32 v18, v160, v161
  v_lshlrev_b32 v104, 16, v36
  v_mfma_f32_16x16x32_bf16 a[76:79], v[84:87], a[172:175], a[76:79]
  v_and_b32 v105, 0xffff0000, v36
  v_lshlrev_b32 v160, 16, v18
  v_mfma_f32_16x16x32_bf16 a[80:83], v[88:91], a[160:163], a[80:83]
  v_and_b32 v161, 0xffff0000, v18
  v_lshlrev_b32 v18, 16, v49
  v_mfma_f32_16x16x32_bf16 a[84:87], v[88:91], a[164:167], a[84:87]
  v_and_b32 v19, 0xffff0000, v49
  v_add_f32 v162, v162, v18
  v_mfma_f32_16x16x32_bf16 a[88:91], v[88:91], a[168:171], a[88:91]
  v_add_f32 v163, v163, v19
  v_cvt_pk_bf16_f32 v18, v162, v163
  v_mfma_f32_16x16x32_bf16 a[92:95], v[88:91], a[172:175], a[92:95]
  v_lshlrev_b32 v106, 16, v37
  v_and_b32 v107, 0xffff0000, v37
  v_mfma_f32_16x16x32_bf16 a[96:99], v[92:95], a[160:163], a[96:99]
  v_lshlrev_b32 v162, 16, v18
  v_and_b32 v163, 0xffff0000, v18
  v_mfma_f32_16x16x32_bf16 a[100:103], v[92:95], a[164:167], a[100:103]
  v_lshlrev_b32 v18, 16, v50
  v_and_b32 v19, 0xffff0000, v50
  v_mfma_f32_16x16x32_bf16 a[104:107], v[92:95], a[168:171], a[104:107]
  v_add_f32 v164, v164, v18
  v_add_f32 v165, v165, v19
  v_mfma_f32_16x16x32_bf16 a[108:111], v[92:95], a[172:175], a[108:111]
  v_cvt_pk_bf16_f32 v18, v164, v165
  v_lshlrev_b32 v108, 16, v38
  v_mfma_f32_16x16x32_bf16 a[112:115], v[128:131], a[160:163], a[112:115]
  v_and_b32 v109, 0xffff0000, v38
  v_lshlrev_b32 v164, 16, v18
  v_mfma_f32_16x16x32_bf16 a[116:119], v[128:131], a[164:167], a[116:119]
  v_and_b32 v165, 0xffff0000, v18
  v_lshlrev_b32 v18, 16, v51
  v_mfma_f32_16x16x32_bf16 a[120:123], v[128:131], a[168:171], a[120:123]
  v_and_b32 v19, 0xffff0000, v51
  v_add_f32 v166, v166, v18
  v_mfma_f32_16x16x32_bf16 a[124:127], v[128:131], a[172:175], a[124:127]
  v_add_f32 v167, v167, v19
  v_cvt_pk_bf16_f32 v18, v166, v167
  v_mfma_f32_16x16x32_bf16 a[128:131], v[132:135], a[160:163], a[128:131]
  v_lshlrev_b32 v110, 16, v39
  v_and_b32 v111, 0xffff0000, v39
  v_mfma_f32_16x16x32_bf16 a[132:135], v[132:135], a[164:167], a[132:135]
  v_lshlrev_b32 v166, 16, v18
  v_and_b32 v167, 0xffff0000, v18
  v_mfma_f32_16x16x32_bf16 a[136:139], v[132:135], a[168:171], a[136:139]
  v_mfma_f32_16x16x32_bf16 a[140:143], v[132:135], a[172:175], a[140:143]
  s_waitcnt vmcnt(4)
  v_mfma_f32_16x16x32_bf16 a[64:67], v[136:139], a[176:179], a[64:67]
  v_lshlrev_b32 v18, 16, v52
  v_and_b32 v19, 0xffff0000, v52
  v_mfma_f32_16x16x32_bf16 a[68:71], v[136:139], a[180:183], a[68:71]
  v_add_f32 v168, v168, v18
  v_add_f32 v169, v169, v19
  v_mfma_f32_16x16x32_bf16 a[72:75], v[136:139], a[184:187], a[72:75]
  v_cvt_pk_bf16_f32 v18, v168, v169
  v_lshlrev_b32 v112, 16, v40
  v_mfma_f32_16x16x32_bf16 a[76:79], v[136:139], a[188:191], a[76:79]
  v_and_b32 v113, 0xffff0000, v40
  v_lshlrev_b32 v168, 16, v18
  v_mfma_f32_16x16x32_bf16 a[80:83], v[140:143], a[176:179], a[80:83]
  v_and_b32 v169, 0xffff0000, v18
  v_lshlrev_b32 v18, 16, v53
  v_mfma_f32_16x16x32_bf16 a[84:87], v[140:143], a[180:183], a[84:87]
  v_and_b32 v19, 0xffff0000, v53
  v_add_f32 v170, v170, v18
  v_mfma_f32_16x16x32_bf16 a[88:91], v[140:143], a[184:187], a[88:91]
  v_add_f32 v171, v171, v19
  v_cvt_pk_bf16_f32 v18, v170, v171
  v_mfma_f32_16x16x32_bf16 a[92:95], v[140:143], a[188:191], a[92:95]
  v_lshlrev_b32 v114, 16, v41
  v_and_b32 v115, 0xffff0000, v41
  v_mfma_f32_16x16x32_bf16 a[96:99], v[144:147], a[176:179], a[96:99]
  v_lshlrev_b32 v170, 16, v18
  v_and_b32 v171, 0xffff0000, v18
  v_mfma_f32_16x16x32_bf16 a[100:103], v[144:147], a[180:183], a[100:103]
  v_lshlrev_b32 v18, 16, v54
  v_and_b32 v19, 0xffff0000, v54
  v_mfma_f32_16x16x32_bf16 a[104:107], v[144:147], a[184:187], a[104:107]
  v_add_f32 v172, v172, v18
  v_add_f32 v173, v173, v19
  v_mfma_f32_16x16x32_bf16 a[108:111], v[144:147], a[188:191], a[108:111]
  v_cvt_pk_bf16_f32 v18, v172, v173
  v_lshlrev_b32 v116, 16, v42
  v_mfma_f32_16x16x32_bf16 a[112:115], v[148:151], a[176:179], a[112:115]
  v_and_b32 v117, 0xffff0000, v42
  v_lshlrev_b32 v172, 16, v18
  v_mfma_f32_16x16x32_bf16 a[116:119], v[148:151], a[180:183], a[116:119]
  v_and_b32 v173, 0xffff0000, v18
  v_lshlrev_b32 v18, 16, v55
  v_mfma_f32_16x16x32_bf16 a[120:123], v[148:151], a[184:187], a[120:123]
  v_and_b32 v19, 0xffff0000, v55
  v_add_f32 v174, v174, v18
  v_mfma_f32_16x16x32_bf16 a[124:127], v[148:151], a[188:191], a[124:127]
  v_add_f32 v175, v175, v19
  v_cvt_pk_bf16_f32 v18, v174, v175
  v_mfma_f32_16x16x32_bf16 a[128:131], v[152:155], a[176:179], a[128:131]
  v_lshlrev_b32 v118, 16, v43
  v_and_b32 v119, 0xffff0000, v43
  v_mfma_f32_16x16x32_bf16 a[132:135], v[152:155], a[180:183], a[132:135]
  v_lshlrev_b32 v174, 16, v18
  v_and_b32 v175, 0xffff0000, v18
  v_mfma_f32_16x16x32_bf16 a[136:139], v[152:155], a[184:187], a[136:139]
  v_mfma_f32_16x16x32_bf16 a[140:143], v[152:155], a[188:191], a[140:143]
  s_waitcnt vmcnt(0)
  v_mfma_f32_16x16x32_bf16 a[64:67], v[156:159], v[216:219], a[64:67]
  v_mfma_f32_16x16x32_bf16 a[68:71], v[156:159], v[220:223], a[68:71]
  v_mfma_f32_16x16x32_bf16 a[72:75], v[156:159], v[224:227], a[72:75]
  v_mfma_f32_16x16x32_bf16 a[76:79], v[156:159], v[228:231], a[76:79]
  v_mfma_f32_16x16x32_bf16 a[80:83], v[176:179], v[216:219], a[80:83]
  v_mfma_f32_16x16x32_bf16 a[84:87], v[176:179], v[220:223], a[84:87]
  v_mfma_f32_16x16x32_bf16 a[88:91], v[176:179], v[224:227], a[88:91]
  v_mfma_f32_16x16x32_bf16 a[92:95], v[176:179], v[228:231], a[92:95]
  v_mfma_f32_16x16x32_bf16 a[96:99], v[180:183], v[216:219], a[96:99]
  v_mfma_f32_16x16x32_bf16 a[100:103], v[180:183], v[220:223], a[100:103]
  ds_write_b128 v16, a[64:67] offset:0
  v_mfma_f32_16x16x32_bf16 a[104:107], v[180:183], v[224:227], a[104:107]
  ds_write_b128 v16, a[68:71] offset:5376
  v_mfma_f32_16x16x32_bf16 a[108:111], v[180:183], v[228:231], a[108:111]
  ds_write_b128 v16, a[72:75] offset:10752
  v_mfma_f32_16x16x32_bf16 a[112:115], v[184:187], v[216:219], a[112:115]
  ds_write_b128 v16, a[76:79] offset:16128
  v_mfma_f32_16x16x32_bf16 a[116:119], v[184:187], v[220:223], a[116:119]
  ds_write_b128 v16, a[80:83] offset:64
  v_mfma_f32_16x16x32_bf16 a[120:123], v[184:187], v[224:227], a[120:123]
  ds_write_b128 v16, a[84:87] offset:5440
  v_mfma_f32_16x16x32_bf16 a[124:127], v[184:187], v[228:231], a[124:127]
  ds_write_b128 v16, a[88:91] offset:10816
  v_mfma_f32_16x16x32_bf16 a[128:131], v[188:191], v[216:219], a[128:131]
  ds_write_b128 v16, a[92:95] offset:16192
  v_mfma_f32_16x16x32_bf16 a[132:135], v[188:191], v[220:223], a[132:135]
  ds_write_b128 v16, a[96:99] offset:128
  v_mfma_f32_16x16x32_bf16 a[136:139], v[188:191], v[224:227], a[136:139]
  ds_write_b128 v16, a[100:103] offset:5504
  v_mfma_f32_16x16x32_bf16 a[140:143], v[188:191], v[228:231], a[140:143]
  ds_write_b128 v16, a[104:107] offset:10880
  ds_write_b128 v16, a[108:111] offset:16256
  ds_write_b128 v16, a[112:115] offset:192
  ds_write_b128 v16, a[116:119] offset:5568
  ds_write_b128 v16, a[120:123] offset:10944
  ds_write_b128 v16, a[124:127] offset:16320
  ds_write_b128 v16, a[128:131] offset:256
  ds_write_b128 v16, a[132:135] offset:5632
  ds_write_b128 v16, a[136:139] offset:11008
  ds_write_b128 v16, a[140:143] offset:16384
  s_waitcnt lgkmcnt(0)
  s_barrier
  ds_read_b128 v[32:35], v251 offset:0
  ds_read_b128 v[36:39], v251 offset:16
  ds_read_b128 v[40:43], v251 offset:38912
  ds_read_b128 v[44:47], v251 offset:38928
  ds_read_b128 v[48:51], v20 offset:0
  ds_read_b128 v[52:55], v20 offset:16
  ds_read_b128 v[56:59], v20 offset:38912
  ds_read_b128 v[60:63], v20 offset:38928
  ds_read_b128 v[64:67], v252 offset:0
  ds_read_b128 v[68:71], v252 offset:16
  ds_read_b128 v[72:75], v252 offset:38912
  ds_read_b128 v[76:79], v252 offset:38928
  ds_read_b128 v[80:83], v21 offset:0
  ds_read_b128 v[84:87], v21 offset:16
  ds_read_b128 v[88:91], v21 offset:38912
  ds_read_b128 v[92:95], v21 offset:38928
  ds_read_b128 v[128:131], v253 offset:0
  ds_read_b128 v[132:135], v253 offset:16
  ds_read_b128 v[136:139], v253 offset:38912
  ds_read_b128 v[140:143], v253 offset:38928
  ds_read_b128 v[144:147], v22 offset:0
  ds_read_b128 v[148:151], v22 offset:16
  ds_read_b128 v[152:155], v22 offset:38912
  ds_read_b128 v[156:159], v22 offset:38928
  s_waitcnt lgkmcnt(15)
  v_pk_add_f32 v[32:33], v[32:33], v[40:41]
  v_pk_add_f32 v[48:49], v[48:49], v[56:57]
  v_pk_add_f32 v[34:35], v[34:35], v[42:43]
  v_pk_add_f32 v[50:51], v[50:51], v[58:59]
  v_pk_add_f32 v[36:37], v[36:37], v[44:45]
  v_pk_add_f32 v[52:53], v[52:53], v[60:61]
  v_pk_add_f32 v[38:39], v[38:39], v[46:47]
  v_pk_add_f32 v[54:55], v[54:55], v[62:63]
  v_pk_add_f32 v[32:33], v[32:33], v[48:49]
  v_pk_add_f32 v[34:35], v[34:35], v[50:51]
  v_pk_add_f32 v[36:37], v[36:37], v[52:53]
  v_pk_add_f32 v[38:39], v[38:39], v[54:55]
  v_cvt_pk_bf16_f32 v40, v32, v33
  v_cvt_pk_bf16_f32 v41, v34, v35
  v_cvt_pk_bf16_f32 v42, v36, v37
  v_cvt_pk_bf16_f32 v43, v38, v39
  v_lshlrev_b32 v32, 16, v40
  v_and_b32 v33, 0xffff0000, v40
  v_lshlrev_b32 v34, 16, v41
  v_and_b32 v35, 0xffff0000, v41
  v_lshlrev_b32 v36, 16, v42
  v_and_b32 v37, 0xffff0000, v42
  v_lshlrev_b32 v38, 16, v43
  v_and_b32 v39, 0xffff0000, v43
  v_pk_add_f32 v[32:33], v[32:33], v[96:97]
  v_pk_add_f32 v[34:35], v[34:35], v[98:99]
  v_pk_add_f32 v[36:37], v[36:37], v[100:101]
  v_pk_add_f32 v[38:39], v[38:39], v[102:103]
  v_cvt_pk_bf16_f32 v40, v32, v33
  v_cvt_pk_bf16_f32 v41, v34, v35
  v_cvt_pk_bf16_f32 v42, v36, v37
  v_cvt_pk_bf16_f32 v43, v38, v39
  v_lshlrev_b32 v32, 16, v40
  v_and_b32 v33, 0xffff0000, v40
  v_lshlrev_b32 v34, 16, v41
  v_and_b32 v35, 0xffff0000, v41
  v_lshlrev_b32 v36, 16, v42
  v_and_b32 v37, 0xffff0000, v42
  v_lshlrev_b32 v38, 16, v43
  v_and_b32 v39, 0xffff0000, v43
  v_pk_add_f32 v[32:33], v[32:33], v[120:121]
  v_pk_add_f32 v[34:35], v[34:35], v[122:123]
  v_pk_add_f32 v[36:37], v[36:37], v[124:125]
  v_pk_add_f32 v[38:39], v[38:39], v[126:127]
  v_cvt_pk_bf16_f32 v44, v32, v33
  v_cvt_pk_bf16_f32 v45, v34, v35
  v_cvt_pk_bf16_f32 v46, v36, v37
  v_cvt_pk_bf16_f32 v47, v38, v39
  buffer_store_dwordx4 v[44:47], v248, s[48:51], 0 offen
  s_waitcnt lgkmcnt(8)
  v_pk_add_f32 v[64:65], v[64:65], v[72:73]
  v_pk_add_f32 v[80:81], v[80:81], v[88:89]
  v_pk_add_f32 v[66:67], v[66:67], v[74:75]
  v_pk_add_f32 v[82:83], v[82:83], v[90:91]
  v_pk_add_f32 v[68:69], v[68:69], v[76:77]
  v_pk_add_f32 v[84:85], v[84:85], v[92:93]
  v_pk_add_f32 v[70:71], v[70:71], v[78:79]
  v_pk_add_f32 v[86:87], v[86:87], v[94:95]
  v_pk_add_f32 v[64:65], v[64:65], v[80:81]
  v_pk_add_f32 v[66:67], v[66:67], v[82:83]
  v_pk_add_f32 v[68:69], v[68:69], v[84:85]
  v_pk_add_f32 v[70:71], v[70:71], v[86:87]
  v_cvt_pk_bf16_f32 v72, v64, v65
  v_cvt_pk_bf16_f32 v73, v66, v67
  v_cvt_pk_bf16_f32 v74, v68, v69
  v_cvt_pk_bf16_f32 v75, v70, v71
  v_lshlrev_b32 v64, 16, v72
  v_and_b32 v65, 0xffff0000, v72
  v_lshlrev_b32 v66, 16, v73
  v_and_b32 v67, 0xffff0000, v73
  v_lshlrev_b32 v68, 16, v74
  v_and_b32 v69, 0xffff0000, v74
  v_lshlrev_b32 v70, 16, v75
  v_and_b32 v71, 0xffff0000, v75
  v_pk_add_f32 v[64:65], v[64:65], v[104:105]
  v_pk_add_f32 v[66:67], v[66:67], v[106:107]
  v_pk_add_f32 v[68:69], v[68:69], v[108:109]
  v_pk_add_f32 v[70:71], v[70:71], v[110:111]
  v_cvt_pk_bf16_f32 v72, v64, v65
  v_cvt_pk_bf16_f32 v73, v66, v67
  v_cvt_pk_bf16_f32 v74, v68, v69
  v_cvt_pk_bf16_f32 v75, v70, v71
  v_lshlrev_b32 v64, 16, v72
  v_and_b32 v65, 0xffff0000, v72
  v_lshlrev_b32 v66, 16, v73
  v_and_b32 v67, 0xffff0000, v73
  v_lshlrev_b32 v68, 16, v74
  v_and_b32 v69, 0xffff0000, v74
  v_lshlrev_b32 v70, 16, v75
  v_and_b32 v71, 0xffff0000, v75
  v_pk_add_f32 v[64:65], v[64:65], v[160:161]
  v_pk_add_f32 v[66:67], v[66:67], v[162:163]
  v_pk_add_f32 v[68:69], v[68:69], v[164:165]
  v_pk_add_f32 v[70:71], v[70:71], v[166:167]
  v_cvt_pk_bf16_f32 v76, v64, v65
  v_cvt_pk_bf16_f32 v77, v66, v67
  v_cvt_pk_bf16_f32 v78, v68, v69
  v_cvt_pk_bf16_f32 v79, v70, v71
  buffer_store_dwordx4 v[76:79], v249, s[48:51], 0 offen
  s_waitcnt lgkmcnt(0)
  v_pk_add_f32 v[128:129], v[128:129], v[136:137]
  v_pk_add_f32 v[144:145], v[144:145], v[152:153]
  v_pk_add_f32 v[130:131], v[130:131], v[138:139]
  v_pk_add_f32 v[146:147], v[146:147], v[154:155]
  v_pk_add_f32 v[132:133], v[132:133], v[140:141]
  v_pk_add_f32 v[148:149], v[148:149], v[156:157]
  v_pk_add_f32 v[134:135], v[134:135], v[142:143]
  v_pk_add_f32 v[150:151], v[150:151], v[158:159]
  v_pk_add_f32 v[128:129], v[128:129], v[144:145]
  v_pk_add_f32 v[130:131], v[130:131], v[146:147]
  v_pk_add_f32 v[132:133], v[132:133], v[148:149]
  v_pk_add_f32 v[134:135], v[134:135], v[150:151]
  v_cvt_pk_bf16_f32 v136, v128, v129
  v_cvt_pk_bf16_f32 v137, v130, v131
  v_cvt_pk_bf16_f32 v138, v132, v133
  v_cvt_pk_bf16_f32 v139, v134, v135
  v_lshlrev_b32 v128, 16, v136
  v_and_b32 v129, 0xffff0000, v136
  v_lshlrev_b32 v130, 16, v137
  v_and_b32 v131, 0xffff0000, v137
  v_lshlrev_b32 v132, 16, v138
  v_and_b32 v133, 0xffff0000, v138
  v_lshlrev_b32 v134, 16, v139
  v_and_b32 v135, 0xffff0000, v139
  v_pk_add_f32 v[128:129], v[128:129], v[112:113]
  v_pk_add_f32 v[130:131], v[130:131], v[114:115]
  v_pk_add_f32 v[132:133], v[132:133], v[116:117]
  v_pk_add_f32 v[134:135], v[134:135], v[118:119]
  v_cvt_pk_bf16_f32 v136, v128, v129
  v_cvt_pk_bf16_f32 v137, v130, v131
  v_cvt_pk_bf16_f32 v138, v132, v133
  v_cvt_pk_bf16_f32 v139, v134, v135
  v_lshlrev_b32 v128, 16, v136
  v_and_b32 v129, 0xffff0000, v136
  v_lshlrev_b32 v130, 16, v137
  v_and_b32 v131, 0xffff0000, v137
  v_lshlrev_b32 v132, 16, v138
  v_and_b32 v133, 0xffff0000, v138
  v_lshlrev_b32 v134, 16, v139
  v_and_b32 v135, 0xffff0000, v139
  v_pk_add_f32 v[128:129], v[128:129], v[168:169]
  v_pk_add_f32 v[130:131], v[130:131], v[170:171]
  v_pk_add_f32 v[132:133], v[132:133], v[172:173]
  v_pk_add_f32 v[134:135], v[134:135], v[174:175]
  v_cvt_pk_bf16_f32 v140, v128, v129
  v_cvt_pk_bf16_f32 v141, v130, v131
  v_cvt_pk_bf16_f32 v142, v132, v133
  v_cvt_pk_bf16_f32 v143, v134, v135
  buffer_store_dwordx4 v[140:143], v250, s[48:51], 0 offen
fa_end:
  s_endpgm
fa_hk0:
  s_getpc_b64 s[10:11]
fa_hp0:
  s_add_u32 s8, s8, 4
  s_addc_u32 s9, s9, 0
  s_sub_u32 s10, s10, fa_hp0-fa_hb0
  s_subb_u32 s11, s11, 0
  s_setpc_b64 s[8:9]
fa_hk1:
  s_getpc_b64 s[10:11]
fa_hp1:
  s_add_u32 s8, s8, 4
  s_addc_u32 s9, s9, 0
  s_sub_u32 s10, s10, fa_hp1-fa_hb1
  s_subb_u32 s11, s11, 0
  s_setpc_b64 s[8:9]
fa_hk2:
  s_getpc_b64 s[10:11]
fa_hp2:
  s_add_u32 s8, s8, 4
  s_addc_u32 s9, s9, 0
  s_sub_u32 s10, s10, fa_hp2-fa_hb2
  s_subb_u32 s11, s11, 0
  s_setpc_b64 s[8:9]
fa_hk3:
  s_getpc_b64 s[10:11]
fa_hp3:
  s_add_u32 s8, s8, 4
  s_addc_u32 s9, s9, 0
  s_sub_u32 s10, s10, fa_hp3-fa_hb3
  s_subb_u32 s11, s11, 0
  s_setpc_b64 s[8:9]
fa_ln_spin:
  s_mov_b32 s83, 200000
fa_ln_spin2:
  buffer_load_dword v15, v229, s[56:59], 0 offen sc1
  s_waitcnt vmcnt(0)
  v_cmp_ne_u32 vcc, 0x01010101, v15
  s_cbranch_vccz fa_ln_ok
  s_sleep 8
  s_sub_u32 s83, s83, 1
  s_cmp_lg_u32 s83, 0
  s_cbranch_scc1 fa_ln_spin2
  s_branch fa_ln_ok
fa_co1:
  buffer_load_dword v232, v234, s[32:35], s29 offen
  buffer_store_dword v229, v225, s[40:43], 0 offen sc1
  ds_read_b128 v[160:163], v221 offset:0
  ds_read_b128 v[164:167], v221 offset:4096
  ds_read_b128 v[168:171], v221 offset:8192
  buffer_store_dword v218, v222, s[40:43], 0 offen sc1
  s_waitcnt lgkmcnt(0)
  buffer_store_dwordx4 v[160:163], v223, s[40:43], s66 offen sc1
  buffer_store_dwordx4 v[164:167], v223, s[40:43], s67 offen sc1
  buffer_store_dwordx4 v[168:171], v224, s[40:43], s78 offen sc1
  s_getpc_b64 s[8:9]
  s_setpc_b64 s[10:11]
  s_mov_b32 s48, s60
  s_mov_b32 s49, s61
  s_mov_b32 s50, s75
  s_lshl_b32 s74, s22, 2
  s_add_u32 s74, s74, s20
  s_lshl_b32 s74, s74, 16
  s_mov_b32 s73, 2097152
  v_mov_b32 v213, 1073741824
  v_mov_b32 v214, 1
  v_writelane_b32 v213, s77, 0
  v_lshlrev_b32 v229, 2, v1
  s_and_b32 s23, s21, 3
  s_cbranch_scc0 fa_arr
  s_getpc_b64 s[8:9]
  s_setpc_b64 s[10:11]
fa_arr:
  buffer_store_byte v214, v213, s[56:59], 0 offen sc1
  s_getpc_b64 s[8:9]
  s_setpc_b64 s[10:11]
  buffer_load_dword v15, v229, s[56:59], 0 offen sc1
  s_getpc_b64 s[8:9]
  s_setpc_b64 s[10:11]
  s_mov_b32 s36, s60
  s_mov_b32 s37, s61
  s_mov_b32 s38, s75
  s_lshr_b32 s27, s20, 1
  s_lshl_b32 s27, s27, 18
  s_mov_b32 s25, 524288
  s_mov_b32 s32, s18
  s_mov_b32 s33, s19
  s_mov_b32 s34, 2621440
  s_mov_b32 s26, 0
  s_movk_i32 s79, 1024
  s_lshl_b32 s23, s22, 2
  s_add_u32 s23, s23, s20
  s_mul_i32 s23, s23, 40960
  v_add_u32 v3, s23, v2
  s_sub_u32 s23, 15, s22
  s_lshl_b32 s23, s23, 2
  s_add_u32 s23, s23, s20
  s_mul_i32 s23, s23, 40960
  s_sub_u32 s23, s23, 2048
  v_add_u32 v5, s23, v2
  v_add_u32 v4, 19456, v3
  v_add_u32 v6, 19456, v5
  s_waitcnt vmcnt(8)
  v_cmp_ne_u32 vcc, 0x01010101, v15
  s_cbranch_vccnz fa_ln_spin
fa_ln_ok:
  s_setpc_b64 s[10:11]
fa_kv_spin:
  s_mov_b32 s83, 200000
fa_kv_spin2:
  buffer_load_dword v15, v8, s[40:43], 0 offen sc1
  s_waitcnt vmcnt(0)
  v_cmp_eq_u32 vcc, 0, v15
  s_cbranch_vccz fa_kv_ok
  s_sleep 8
  s_sub_u32 s83, s83, 1
  s_cmp_lg_u32 s83, 0
  s_cbranch_scc1 fa_kv_spin2
  s_branch fa_kv_ok
fa_wo0:
  s_add_u32 m0, s34, 0
  s_nop 0
  buffer_load_dwordx4 v24, s[56:59], s33 offen lds
  s_add_u32 m0, s34, 1024
  s_nop 0
  buffer_load_dwordx4 v25, s[56:59], s33 offen lds
  s_add_u32 m0, s34, 2048
  s_nop 0
  buffer_load_dwordx4 v26, s[56:59], s33 offen lds
  s_add_u32 m0, s34, 3072
  s_nop 0
  buffer_load_dwordx4 v27, s[56:59], s33 offen lds
  s_add_u32 m0, s34, 4096
  s_nop 0
  buffer_load_dwordx4 v28, s[56:59], s33 offen lds
  s_branch fa_wo0b
fa_top8:
  s_cmp_lg_u32 s20, 0
  s_cbranch_scc1 fa_notop
  s_mov_b32 s23, 2621440
  s_mov_b32 s31, 2625536
  buffer_load_dwordx4 v[96:99], v2, s[40:43], s23 offen offset:0 sc1
  buffer_load_dwordx4 v[100:103], v2, s[40:43], s23 offen offset:1024 sc1
  buffer_load_dwordx4 v[104:107], v2, s[40:43], s23 offen offset:2048 sc1
  buffer_load_dwordx4 v[108:111], v2, s[40:43], s23 offen offset:3072 sc1
  buffer_load_dwordx4 v[112:115], v2, s[40:43], s31 offen offset:0 sc1
  buffer_load_dwordx4 v[116:119], v2, s[40:43], s31 offen offset:1024 sc1
  buffer_load_dwordx4 v[120:123], v2, s[40:43], s31 offen offset:2048 sc1
  buffer_load_dwordx4 v[124:127], v2, s[40:43], s31 offen offset:3072 sc1
  v_mov_b32 v21, 0
  v_mov_b32 v22, 0
  v_and_b32 v23, 7, v1
  s_mov_b32 s23, 0
  s_waitcnt vmcnt(0)
fa_top:
  v_max3_u32 v20, v96, v97, v98
  v_max3_u32 v24, v99, v100, v101
  v_max3_u32 v20, v20, v102, v103
  v_max3_u32 v24, v24, v104, v105
  v_max3_u32 v20, v20, v106, v107
  v_max3_u32 v24, v24, v108, v109
  v_max3_u32 v20, v20, v110, v111
  v_max3_u32 v24, v24, v112, v113
  v_max3_u32 v20, v20, v114, v115
  v_max3_u32 v24, v24, v116, v117
  v_max3_u32 v20, v20, v118, v119
  v_max3_u32 v24, v24, v120, v121
  v_max3_u32 v20, v20, v122, v123
  v_max3_u32 v24, v24, v124, v125
  v_max3_u32 v20, v20, v126, v127
  v_max_u32 v20, v20, v24
  s_nop 1
  v_max_u32_dpp v20, v20, v20 quad_perm:[1,0,3,2] row_mask:0xf bank_mask:0xf
  s_nop 1
  v_max_u32_dpp v20, v20, v20 quad_perm:[2,3,0,1] row_mask:0xf bank_mask:0xf
  s_nop 1
  v_max_u32_dpp v20, v20, v20 row_half_mirror row_mask:0xf bank_mask:0xf
  s_nop 1
  v_max_u32_dpp v20, v20, v20 row_mirror row_mask:0xf bank_mask:0xf
  v_mov_b32 v24, v20
  s_nop 1
  v_permlane16_swap_b32 v20, v24
  v_max_u32 v20, v20, v24
  v_mov_b32 v24, v20
  s_nop 1
  v_permlane32_swap_b32 v20, v24
  v_max_u32 v20, v20, v24
  v_add_u32 v21, v21, v20
  v_cmp_eq_u32 vcc, s23, v23
  v_sub_u32 v96, v96, v20
  v_sub_u32 v97, v97, v20
  v_sub_u32 v98, v98, v20
  v_sub_u32 v99, v99, v20
  v_sub_u32 v100, v100, v20
  v_sub_u32 v101, v101, v20
  v_sub_u32 v102, v102, v20
  v_sub_u32 v103, v103, v20
  v_sub_u32 v104, v104, v20
  v_sub_u32 v105, v105, v20
  v_sub_u32 v106, v106, v20
  v_sub_u32 v107, v107, v20
  v_sub_u32 v108, v108, v20
  v_sub_u32 v109, v109, v20
  v_sub_u32 v110, v110, v20
  v_sub_u32 v111, v111, v20
  v_sub_u32 v112, v112, v20
  v_sub_u32 v113, v113, v20
  v_sub_u32 v114, v114, v20
  v_sub_u32 v115, v115, v20
  v_sub_u32 v116, v116, v20
  v_sub_u32 v117, v117, v20
  v_sub_u32 v118, v118, v20
  v_sub_u32 v119, v119, v20
  v_sub_u32 v120, v120, v20
  v_sub_u32 v121, v121, v20
  v_sub_u32 v122, v122, v20
  v_sub_u32 v123, v123, v20
  v_sub_u32 v124, v124, v20
  v_sub_u32 v125, v125, v20
  v_sub_u32 v126, v126, v20
  v_sub_u32 v127, v127, v20
  v_cndmask_b32 v22, v22, v21, vcc
  s_add_u32 s23, s23, 1
  s_cmp_lt_u32 s23, 8
  s_cbranch_scc1 fa_top
  v_and_b32 v25, 0xffff, v22
  v_sub_u32 v25, 0xffff, v25
  v_and_b32 v25, 2047, v25
  v_ashrrev_i32 v20, 31, v22
  v_not_b32 v20, v20
  v_or_b32 v20, 0x80000000, v20
  v_xor_b32 v26, v22, v20
  v_and_b32 v26, 0xffff0000, v26
  v_mul_f32 v26, 0xbfb8aa3b, v26
  v_exp_f32 v26, v26
  s_nop 0
  v_add_f32 v26, 1.0, v26
  v_rcp_f32 v26, v26
  s_nop 0
  v_cvt_pk_bf16_f32 v26, v26, v26
  v_and_b32 v26, 0xffff0000, v26
  v_lshlrev_b32 v20, 2, v1
  v_add_u32 v20, 2629632, v20
  v_mov_b32 v21, 1073741824
  v_cmp_gt_u32 vcc, 16, v1
  v_add_u32 v25, 1, v25
  v_or_b32 v26, 1, v26
  v_cndmask_b32 v20, v21, v20, vcc
  v_cmp_gt_u32 vcc, 8, v1
  s_nop 1
  v_cndmask_b32 v26, v26, v25, vcc
  buffer_store_dword v26, v20, s[40:43], 0 offen sc1
  s_branch fa_notop
fa_hk4:
  s_getpc_b64 s[38:39]
fa_hp4:
  s_add_u32 s36, s36, 4
  s_addc_u32 s37, s37, 0
  s_sub_u32 s38, s38, fa_hp4-fa_hb4
  s_subb_u32 s39, s39, 0
  s_setpc_b64 s[36:37]
fa_hk5:
  s_getpc_b64 s[38:39]
fa_hp5:
  s_add_u32 s36, s36, 4
  s_addc_u32 s37, s37, 0
  s_sub_u32 s38, s38, fa_hp5-fa_hb5
  s_subb_u32 s39, s39, 0
  s_setpc_b64 s[36:37]
fa_hk6:
  s_getpc_b64 s[38:39]
fa_hp6:
  s_add_u32 s36, s36, 4
  s_addc_u32 s37, s37, 0
  s_add_u32 s38, s38, fa_hb6-fa_hp6
  s_addc_u32 s39, s39, 0
  s_setpc_b64 s[36:37]
fa_DDF:
  v_mfma_f32_16x16x32_bf16 v[96:99], a[128:131], v[32:35], v[192:195]
  s_waitcnt vmcnt(12)
  v_exp_f32 v218, v146
  v_mfma_f32_16x16x32_bf16 v[104:107], a[128:131], v[36:39], v[196:199]
  s_barrier
  v_exp_f32 v219, v147
  v_mfma_f32_16x16x32_bf16 v[128:131], a[128:131], v[64:67], v[200:203]
  s_cmp_ge_u32 s26, s32
  ds_read_b128 a[160:163], v3 offset:16384
  v_add_f32 v226, v216, v217
  v_mfma_f32_16x16x32_bf16 v[136:139], a[128:131], v[68:71], v[204:207]
  s_cbranch_scc1 fa_hk6
fa_hb6:
  v_exp_f32 v220, v148
  v_mfma_f32_16x16x32_bf16 v[100:103], a[132:135], v[32:35], v[192:195]
  ds_read_b128 a[164:167], v3 offset:17408
  v_cvt_pk_bf16_f32 v184, v216, v217
  v_mfma_f32_16x16x32_bf16 v[108:111], a[132:135], v[36:39], v[196:199]
  s_mov_b32 m0, s24
  v_exp_f32 v221, v149
  v_mfma_f32_16x16x32_bf16 v[132:135], a[132:135], v[64:67], v[200:203]
  buffer_load_dwordx4 v2, s[44:47], s26 offen offset:0 sc1 lds
  v_add_f32 v226, v226, v218
  v_mfma_f32_16x16x32_bf16 v[140:143], a[132:135], v[68:71], v[204:207]
  v_exp_f32 v222, v150
  v_mfma_f32_16x16x32_bf16 v[96:99], a[136:139], v[40:43], v[96:99]
  ds_read_b128 a[168:171], v3 offset:18432
  v_add_f32 v226, v226, v219
  v_cvt_pk_bf16_f32 v185, v218, v219
  v_mfma_f32_16x16x32_bf16 v[104:107], a[136:139], v[44:47], v[104:107]
  v_exp_f32 v223, v151
  v_mfma_f32_16x16x32_bf16 v[128:131], a[136:139], v[72:75], v[128:131]
  v_add_f32 v226, v226, v220
  v_add_f32 v226, v226, v221
  v_mfma_f32_16x16x32_bf16 v[136:139], a[136:139], v[76:79], v[136:139]
  v_exp_f32 v216, v152
  v_mfma_f32_16x16x32_bf16 v[100:103], a[140:143], v[40:43], v[100:103]
  ds_read_b128 a[172:175], v3 offset:19456
  v_cvt_pk_bf16_f32 v186, v220, v221
  v_mfma_f32_16x16x32_bf16 v[108:111], a[140:143], v[44:47], v[108:111]
  buffer_load_dwordx4 v2, s[44:47], s26 offen offset:1024 sc1 lds
  v_add_f32 v226, v226, v222
  v_mfma_f32_16x16x32_bf16 v[132:135], a[140:143], v[72:75], v[132:135]
  v_exp_f32 v217, v153
  v_mfma_f32_16x16x32_bf16 v[140:143], a[140:143], v[76:79], v[140:143]
  s_waitcnt lgkmcnt(4)
  v_exp_f32 v218, v154
  v_mfma_f32_16x16x32_bf16 v[96:99], a[144:147], v[48:51], v[96:99]
  ds_read_b128 a[176:179], v3 offset:20480
  v_add_f32 v226, v226, v223
  v_mfma_f32_16x16x32_bf16 v[104:107], a[144:147], v[52:55], v[104:107]
  v_exp_f32 v219, v155
  v_mfma_f32_16x16x32_bf16 v[128:131], a[144:147], v[80:83], v[128:131]
  v_cvt_pk_bf16_f32 v187, v222, v223
  v_add_f32 v227, v216, v217
  v_cvt_pk_bf16_f32 v188, v216, v217
  v_mfma_f32_16x16x32_bf16 v[136:139], a[144:147], v[84:87], v[136:139]
  buffer_load_dwordx4 v2, s[44:47], s26 offen offset:2048 sc1 lds
  v_add_f32 v227, v227, v218
  v_mfma_f32_16x16x32_bf16 v[100:103], a[148:151], v[48:51], v[100:103]
  ds_read_b128 a[180:183], v3 offset:21504
  v_add_f32 v227, v227, v219
  v_mfma_f32_16x16x32_bf16 v[108:111], a[148:151], v[52:55], v[108:111]
  v_exp_f32 v220, v156
  v_mfma_f32_16x16x32_bf16 v[132:135], a[148:151], v[80:83], v[132:135]
  v_exp_f32 v221, v157
  v_mfma_f32_16x16x32_bf16 v[140:143], a[148:151], v[84:87], v[140:143]
  v_exp_f32 v222, v158
  v_mfma_f32_16x16x32_bf16 v[96:99], a[152:155], v[56:59], v[96:99]
  ds_read_b128 a[184:187], v3 offset:22528
  v_cvt_pk_bf16_f32 v189, v218, v219
  v_mfma_f32_16x16x32_bf16 v[104:107], a[152:155], v[60:63], v[104:107]
  buffer_load_dwordx4 v2, s[44:47], s26 offen offset:3072 sc1 lds
  v_add_f32 v227, v227, v220
  v_add_f32 v227, v227, v221
  v_mfma_f32_16x16x32_bf16 v[128:131], a[152:155], v[88:91], v[128:131]
  s_add_u32 s26, s26, 16384
  v_exp_f32 v223, v159
  v_mfma_f32_16x16x32_bf16 v[136:139], a[152:155], v[92:95], v[136:139]
  s_add_u32 s24, s24, 32768
  v_exp_f32 v208, v112
  v_mfma_f32_16x16x32_bf16 v[100:103], a[156:159], v[56:59], v[100:103]
  s_and_b32 s24, s24, 0x1ffff
  ds_read_b128 a[188:191], v3 offset:23552
  v_cvt_pk_bf16_f32 v190, v220, v221
  v_mfma_f32_16x16x32_bf16 v[108:111], a[156:159], v[60:63], v[108:111]
  v_exp_f32 v209, v113
  v_mfma_f32_16x16x32_bf16 v[132:135], a[156:159], v[88:91], v[132:135]
  s_add_u32 m0, s34, 0
  v_exp_f32 v210, v114
  v_mfma_f32_16x16x32_bf16 v[140:143], a[156:159], v[92:95], v[140:143]
  s_waitcnt lgkmcnt(4)
  buffer_load_dwordx4 v8, s[52:55], s33 offen offset:0 lds
  v_add_f32 v227, v227, v222
  v_mfma_f32_16x16x32_bf16 a[0:3], a[160:163], v[160:163], a[0:3]
  ds_read_b128 a[128:131], v3 offset:0
  v_add_f32 v227, v227, v223
  v_mfma_f32_16x16x32_bf16 a[4:7], a[160:163], v[164:167], a[4:7]
  v_exp_f32 v211, v115
  v_mfma_f32_16x16x32_bf16 a[64:67], a[160:163], v[176:179], a[64:67]
  v_cvt_pk_bf16_f32 v191, v222, v223
  v_add_f32 v224, v208, v209
  v_cvt_pk_bf16_f32 v168, v208, v209
  v_mfma_f32_16x16x32_bf16 a[68:71], a[160:163], v[180:183], a[68:71]
  v_exp_f32 v212, v116
  v_mfma_f32_16x16x32_bf16 a[8:11], a[164:167], v[160:163], a[8:11]
  ds_read_b128 a[132:135], v3 offset:1024
  v_add_f32 v224, v224, v210
  v_mfma_f32_16x16x32_bf16 a[12:15], a[164:167], v[164:167], a[12:15]
  buffer_load_dwordx4 v11, s[52:55], s33 offen offset:1024 lds
  v_add_f32 v224, v224, v211
  v_mfma_f32_16x16x32_bf16 a[72:75], a[164:167], v[176:179], a[72:75]
  v_exp_f32 v213, v117
  v_mfma_f32_16x16x32_bf16 a[76:79], a[164:167], v[180:183], a[76:79]
  v_exp_f32 v214, v118
  v_mfma_f32_16x16x32_bf16 a[16:19], a[168:171], v[160:163], a[16:19]
  ds_read_b128 a[136:139], v3 offset:2048
  v_cvt_pk_bf16_f32 v169, v210, v211
  v_mfma_f32_16x16x32_bf16 a[20:23], a[168:171], v[164:167], a[20:23]
  v_exp_f32 v215, v119
  v_mfma_f32_16x16x32_bf16 a[80:83], a[168:171], v[176:179], a[80:83]
  v_add_f32 v224, v224, v212
  v_add_f32 v224, v224, v213
  v_cvt_pk_bf16_f32 v170, v212, v213
  v_mfma_f32_16x16x32_bf16 a[84:87], a[168:171], v[180:183], a[84:87]
  buffer_load_dwordx4 v12, s[52:55], s33 offen offset:2048 lds
  v_add_f32 v224, v224, v214
  v_mfma_f32_16x16x32_bf16 a[24:27], a[172:175], v[160:163], a[24:27]
  ds_read_b128 a[140:143], v3 offset:3072
  v_add_f32 v224, v224, v215
  v_mfma_f32_16x16x32_bf16 a[28:31], a[172:175], v[164:167], a[28:31]
  v_exp_f32 v208, v120
  v_mfma_f32_16x16x32_bf16 a[88:91], a[172:175], v[176:179], a[88:91]
  v_exp_f32 v209, v121
  v_mfma_f32_16x16x32_bf16 a[92:95], a[172:175], v[180:183], a[92:95]
  s_waitcnt lgkmcnt(4)
  v_exp_f32 v210, v122
  v_mfma_f32_16x16x32_bf16 a[32:35], a[176:179], v[160:163], a[32:35]
  ds_read_b128 a[144:147], v3 offset:4096
  v_cvt_pk_bf16_f32 v171, v214, v215
  v_mfma_f32_16x16x32_bf16 a[36:39], a[176:179], v[164:167], a[36:39]
  buffer_load_dwordx4 v13, s[52:55], s33 offen offset:3072 lds
  v_add_f32 v225, v208, v209
  v_mfma_f32_16x16x32_bf16 a[96:99], a[176:179], v[176:179], a[96:99]
  v_exp_f32 v211, v123
  v_mfma_f32_16x16x32_bf16 a[100:103], a[176:179], v[180:183], a[100:103]
  v_exp_f32 v212, v124
  v_mfma_f32_16x16x32_bf16 a[40:43], a[180:183], v[160:163], a[40:43]
  ds_read_b128 a[148:151], v3 offset:5120
  v_cvt_pk_bf16_f32 v172, v208, v209
  v_add_f32 v225, v225, v210
  v_mfma_f32_16x16x32_bf16 a[44:47], a[180:183], v[164:167], a[44:47]
  v_exp_f32 v213, v125
  v_mfma_f32_16x16x32_bf16 a[104:107], a[180:183], v[176:179], a[104:107]
  s_add_u32 m0, s34, 4096
  v_add_f32 v225, v225, v211
  v_cvt_pk_bf16_f32 v173, v210, v211
  v_mfma_f32_16x16x32_bf16 a[108:111], a[180:183], v[180:183], a[108:111]
  buffer_load_dwordx4 v14, s[52:55], s33 offen offset:0 lds
  v_max3_f32 v5, v226, v227, v224
  v_mfma_f32_16x16x32_bf16 a[48:51], a[184:187], v[160:163], a[48:51]
  ds_read_b128 a[152:155], v3 offset:6144
  v_add_f32 v225, v225, v212
  v_mfma_f32_16x16x32_bf16 a[52:55], a[184:187], v[164:167], a[52:55]
  v_exp_f32 v214, v126
  v_mfma_f32_16x16x32_bf16 a[112:115], a[184:187], v[176:179], a[112:115]
  v_exp_f32 v215, v127
  v_mfma_f32_16x16x32_bf16 a[116:119], a[184:187], v[180:183], a[116:119]
  v_add_f32 v225, v225, v213
  v_cvt_pk_bf16_f32 v174, v212, v213
  v_add_f32 v225, v225, v214
  v_mfma_f32_16x16x32_bf16 a[56:59], a[188:191], v[160:163], a[56:59]
  ds_read_b128 a[156:159], v3 offset:7168
  v_add_f32 v225, v225, v215
  v_max_f32 v5, v5, v225
  v_cmp_lt_f32 vcc, s81, v5
  v_mfma_f32_16x16x32_bf16 a[60:63], a[188:191], v[164:167], a[60:63]
  v_exp_f32 v216, v128
  v_mfma_f32_16x16x32_bf16 a[120:123], a[188:191], v[176:179], a[120:123]
  s_waitcnt lgkmcnt(4)
  v_cvt_pk_bf16_f32 v175, v214, v215
  v_mfma_f32_16x16x32_bf16 a[124:127], a[188:191], v[180:183], a[124:127]
  s_cbranch_vccnz fa_stub3
fa_back3:
  v_exp_f32 v217, v129
  v_add_f32 v228, v228, v224
  v_add_f32 v229, v229, v225
  v_add_f32 v230, v230, v226
  v_add_f32 v231, v231, v227
  s_branch fa_DDe
fa_sel_spin:
  s_mov_b32 s83, 200000
fa_sel_spin2:
  buffer_load_dword v15, v252, s[40:43], 0 offen sc1
  s_waitcnt vmcnt(0)
  v_cmp_eq_u32 vcc, 0, v15
  s_cbranch_vccz fa_sel_ok
  s_sleep 8
  s_sub_u32 s83, s83, 1
  s_cmp_lg_u32 s83, 0
  s_cbranch_scc1 fa_sel_spin2
  s_branch fa_sel_ok
fa_wof_spin:
  s_mov_b32 s83, 200000
fa_wof_spin2:
  buffer_load_dword v8, v9, s[40:43], 0 offen sc1
  s_waitcnt vmcnt(0)
  v_cmp_eq_u32 vcc, 0, v8
  s_cbranch_vccz fa_wof_ok
  s_sleep 8
  s_sub_u32 s83, s83, 1
  s_cmp_lg_u32 s83, 0
  s_cbranch_scc1 fa_wof_spin2
  s_branch fa_wof_ok
fa_sel4_spin:
  s_mov_b32 s83, 200000
fa_sel4_spin2:
  buffer_load_dword v15, v10, s[40:43], 0 offen sc1
  s_waitcnt vmcnt(0)
  v_cmp_eq_u32 vcc, 0, v15
  s_cbranch_vccz fa_sel4_ok
  s_sleep 8
  s_sub_u32 s83, s83, 1
  s_cmp_lg_u32 s83, 0
  s_cbranch_scc1 fa_sel4_spin2
  s_branch fa_sel4_ok
fa_yf_spin:
  s_mov_b32 s83, 200000
fa_yf_spin2:
  buffer_load_dword v14, v11, s[40:43], 0 offen sc1
  s_waitcnt vmcnt(0)
  v_cmp_eq_u32 vcc, 0, v14
  s_cbranch_vccz fa_yf_ok
  s_sleep 8
  s_sub_u32 s83, s83, 1
  s_cmp_lg_u32 s83, 0
  s_cbranch_scc1 fa_yf_spin2
  s_branch fa_yf_ok
fa_co:
  s_sub_u32 s14, s2, 170
  s_cmp_lt_u32 s14, 54
  s_cbranch_scc1 fa_coF
  s_sub_u32 s14, s2, 64
  s_cmp_lt_u32 s14, 96
  s_cbranch_scc1 fa_coT
  s_sub_u32 s14, s2, 128
  s_cmp_ge_u32 s2, 224
  s_cbranch_scc0 fa_coO
fa_coT:
  v_min_u32 v8, 16, v1
  v_lshlrev_b32 v8, 7, v8
  s_lshl_b32 s10, s14, 1
  s_and_b32 s31, s20, 1
  s_add_u32 s10, s10, s31
  s_mul_i32 s10, s10, 2176
  s_lshl_b32 s35, s14, 2
  s_add_u32 s35, s35, s20
  s_mul_i32 s35, s35, 4352
  buffer_load_dword v255, v8, s[52:55], s10 offen
  s_add_u32 s10, s10, 552960
  s_getpc_b64 s[36:37]
  s_setpc_b64 s[38:39]
  buffer_load_dword v255, v8, s[52:55], s10 offen
  s_add_u32 s10, s10, 552960
  s_getpc_b64 s[36:37]
  s_setpc_b64 s[38:39]
  buffer_load_dword v255, v8, s[52:55], s10 offen
  s_add_u32 s10, s10, 552960
  buffer_load_dword v255, v8, s[60:63], s35 offen offset:0
  s_getpc_b64 s[36:37]
  s_setpc_b64 s[38:39]
  buffer_load_dword v255, v8, s[52:55], s10 offen
  s_add_u32 s10, s10, 552960
  buffer_load_dword v255, v8, s[60:63], s35 offen offset:2176
  s_mov_b32 s9, -1
  s_and_b32 s32, s21, 3
  s_add_u32 s32, s32, 7
  s_lshl_b32 s32, s32, 14
  s_getpc_b64 s[36:37]
  s_setpc_b64 s[38:39]
fa_coO:
  s_add_u32 m0, s34, 0
  v_accvgpr_read_b32 v19, a248
  buffer_load_dwordx4 v19, s[56:59], s33 offen lds
  s_add_u32 m0, s34, 1024
  v_accvgpr_read_b32 v19, a249
  buffer_load_dwordx4 v19, s[56:59], s33 offen lds
  s_add_u32 m0, s34, 2048
  v_accvgpr_read_b32 v19, a250
  buffer_load_dwordx4 v19, s[56:59], s33 offen lds
  s_add_u32 m0, s34, 3072
  v_accvgpr_read_b32 v19, a251
  buffer_load_dwordx4 v19, s[56:59], s33 offen lds
  s_add_u32 m0, s34, 4096
  v_accvgpr_read_b32 v19, a252
  buffer_load_dwordx4 v19, s[56:59], s33 offen lds
  s_add_u32 s32, s26, 32768
  s_mov_b32 s9, -1
  s_getpc_b64 s[36:37]
  s_setpc_b64 s[38:39]
  s_waitcnt vmcnt(8)
  ds_read_b64_tr_b16 v[232:233], v6 offset:0
  ds_read_b64_tr_b16 v[234:235], v6 offset:2560
  ds_read_b64_tr_b16 v[236:237], v6 offset:32
  ds_read_b64_tr_b16 v[238:239], v6 offset:2592
  ds_read_b64_tr_b16 v[240:241], v6 offset:64
  ds_read_b64_tr_b16 v[242:243], v6 offset:2624
  ds_read_b64_tr_b16 v[244:245], v6 offset:96
  ds_read_b64_tr_b16 v[246:247], v6 offset:2656
  ds_read_b64_tr_b16 v[248:249], v6 offset:128
  ds_read_b64_tr_b16 v[250:251], v6 offset:2688
  s_waitcnt lgkmcnt(0)
  s_add_u32 s31, s30, 4096
  buffer_store_dwordx4 v[232:235], v2, s[40:43], s30 offen offset:0 sc1
  buffer_store_dwordx4 v[236:239], v2, s[40:43], s30 offen offset:1024 sc1
  buffer_store_dwordx4 v[240:243], v2, s[40:43], s30 offen offset:2048 sc1
  buffer_store_dwordx4 v[244:247], v2, s[40:43], s30 offen offset:3072 sc1
  buffer_store_dwordx4 v[248:251], v2, s[40:43], s31 offen offset:0 sc1
  s_getpc_b64 s[36:37]
  s_setpc_b64 s[38:39]
  s_and_b32 s23, s2, 1
  s_lshl_b32 s23, s23, 2
  s_add_u32 s23, s23, s20
  s_lshl_b32 s23, s23, 7
  s_lshr_b32 s31, s2, 1
  s_add_u32 s23, s23, s31
  s_lshl_b32 s23, s23, 2
  s_add_u32 s23, s23, 2654208
  s_waitcnt vmcnt(8)
  buffer_store_dword v4, off, s[40:43], s23 sc1
  s_branch fa_coW
fa_coF:
  s_waitcnt vmcnt(8)
  ds_read_b64_tr_b16 v[232:233], v6 offset:0
  ds_read_b64_tr_b16 v[234:235], v6 offset:2560
  ds_read_b64_tr_b16 v[236:237], v6 offset:32
  ds_read_b64_tr_b16 v[238:239], v6 offset:2592
  ds_read_b64_tr_b16 v[240:241], v6 offset:64
  ds_read_b64_tr_b16 v[242:243], v6 offset:2624
  ds_read_b64_tr_b16 v[244:245], v6 offset:96
  ds_read_b64_tr_b16 v[246:247], v6 offset:2656
  ds_read_b64_tr_b16 v[248:249], v6 offset:128
  ds_read_b64_tr_b16 v[250:251], v6 offset:2688
  s_getpc_b64 s[36:37]
  s_setpc_b64 s[38:39]
  s_add_u32 s31, s30, 4096
  buffer_store_dwordx4 v[232:235], v2, s[40:43], s30 offen offset:0 sc1
  buffer_store_dwordx4 v[236:239], v2, s[40:43], s30 offen offset:1024 sc1
  buffer_store_dwordx4 v[240:243], v2, s[40:43], s30 offen offset:2048 sc1
  buffer_store_dwordx4 v[244:247], v2, s[40:43], s30 offen offset:3072 sc1
  buffer_store_dwordx4 v[248:251], v2, s[40:43], s31 offen offset:0 sc1
  s_lshl_b32 s33, s14, 6
  s_and_b32 s31, s20, 1
  s_lshl_b32 s31, s31, 5
  s_add_u32 s33, s33, s31
  s_mul_i32 s35, s14, 40960
  s_mul_i32 s31, s20, 320
  s_add_u32 s35, s35, s31
  s_mul_i32 s10, s14, 20480
  s_mul_i32 s31, s20, 640
  s_add_u32 s10, s10, s31
  s_add_u32 s10, s10, 2686976
  s_mov_b32 s9, -1
  s_getpc_b64 s[36:37]
  s_setpc_b64 s[38:39]
  v_and_b32 v16, 7, v1
  v_lshlrev_b32 v252, 2, v16
  v_add_u32 v252, 2629632, v252
  buffer_load_dword v15, v252, s[40:43], 0 offen sc1
  v_lshrrev_b32 v17, 1, v1
  v_mul_u32_u24 v8, 3456, v17
  v_and_b32 v17, 1, v1
  v_lshl_add_u32 v8, v17, 4, v8
  v_add_u32 v11, 109568, v8
  v_add_u32 v12, 219136, v8
  v_add_u32 v13, 328704, v8
  v_add_u32 v14, 442368, v8
  v_lshrrev_b32 v17, 4, v1
  v_lshrrev_b32 v18, 2, v1
  v_lshl_add_u32 v18, v17, 2, v18
  v_lshlrev_b32 v18, 5, v18
  v_and_b32 v19, 3, v1
  v_lshl_add_u32 v9, v19, 3, v18
  v_add_u32 v9, s34, v9
  v_lshlrev_b32 v10, 4, v16
  v_lshl_add_u32 v10, v17, 7, v10
  v_add_u32 v10, 151552, v10
  s_mov_b32 s8, -1
  v_mov_b32 v232, 0
  v_mov_b32 v233, 0
  v_mov_b32 v234, 0
  v_mov_b32 v235, 0
  s_getpc_b64 s[36:37]
  s_setpc_b64 s[38:39]
  s_and_b32 s23, s2, 1
  s_lshl_b32 s23, s23, 2
  s_add_u32 s23, s23, s20
  s_lshl_b32 s23, s23, 7
  s_lshr_b32 s31, s2, 1
  s_add_u32 s23, s23, s31
  s_lshl_b32 s23, s23, 2
  s_add_u32 s23, s23, 2654208
  s_waitcnt vmcnt(8)
  buffer_store_dword v4, off, s[40:43], s23 sc1
  v_cmp_eq_u32 vcc, 0, v15
  s_cbranch_vccnz fa_sel_spin
fa_sel_ok:
  v_add_u32 v18, -1, v15
  v_and_b32 v18, 2047, v18
  v_lshrrev_b32 v19, 4, v18
  v_mul_u32_u24 v19, 20480, v19
  v_and_b32 v18, 15, v18
  v_lshl_add_u32 v19, v18, 4, v19
  v_lshrrev_b32 v18, 3, v1
  v_lshl_add_u32 v19, v18, 8, v19
  s_lshl_b32 s23, s20, 11
  s_lshl_b32 s31, s20, 10
  s_add_u32 s31, s31, 151552
  s_mov_b32 s14, 4
  s_mov_b32 m0, s31
  s_add_u32 s31, s31, 4096
  buffer_load_dwordx4 v19, s[40:43], s23 offen sc1 lds
  s_add_u32 s23, s23, 8192
  s_mov_b32 m0, s31
  s_add_u32 s31, s31, 4096
  buffer_load_dwordx4 v19, s[40:43], s23 offen sc1 lds
  s_add_u32 s23, s23, 8192
  s_mov_b32 m0, s31
  s_add_u32 s31, s31, 4096
  buffer_load_dwordx4 v19, s[40:43], s23 offen sc1 lds
  s_add_u32 s23, s23, 8192
fa_coG:
  s_getpc_b64 s[36:37]
  s_setpc_b64 s[38:39]
  s_waitcnt vmcnt(4)
  ds_read_b64_tr_b16 a[192:193], v9 offset:0
  ds_read_b64_tr_b16 a[194:195], v9 offset:128
  ds_read_b128 a[212:215], v10 offset:0
  ds_read_b64_tr_b16 a[196:197], v9 offset:1024
  ds_read_b64_tr_b16 a[198:199], v9 offset:1152
  ds_read_b128 a[216:219], v10 offset:512
  ds_read_b64_tr_b16 a[200:201], v9 offset:2048
  ds_read_b64_tr_b16 a[202:203], v9 offset:2176
  ds_read_b128 a[220:223], v10 offset:1024
  ds_read_b64_tr_b16 a[204:205], v9 offset:3072
  ds_read_b64_tr_b16 a[206:207], v9 offset:3200
  ds_read_b128 a[224:227], v10 offset:1536
  ds_read_b64_tr_b16 a[208:209], v9 offset:4096
  ds_read_b64_tr_b16 a[210:211], v9 offset:4224
  ds_read_b128 a[228:231], v10 offset:2048
  v_add_u32 v10, 2560, v10
  s_add_u32 s33, s33, 552960
  s_sub_u32 s14, s14, 1
  s_waitcnt lgkmcnt(12)
  v_mfma_f32_16x16x32_bf16 v[232:235], a[192:195], a[212:215], v[232:235]
  s_waitcnt lgkmcnt(9)
  v_mfma_f32_16x16x32_bf16 v[232:235], a[196:199], a[216:219], v[232:235]
  s_waitcnt lgkmcnt(6)
  v_mfma_f32_16x16x32_bf16 v[232:235], a[200:203], a[220:223], v[232:235]
  s_waitcnt lgkmcnt(3)
  v_mfma_f32_16x16x32_bf16 v[232:235], a[204:207], a[224:227], v[232:235]
  s_waitcnt lgkmcnt(0)
  v_mfma_f32_16x16x32_bf16 v[232:235], a[208:211], a[228:231], v[232:235]
  s_cmp_lg_u32 s14, 0
  s_cbranch_scc1 fa_coG
  v_accvgpr_read_b32 v8, a248
  v_accvgpr_read_b32 v11, a249
  v_accvgpr_read_b32 v12, a250
  v_accvgpr_read_b32 v13, a251
  v_accvgpr_read_b32 v14, a252
  v_subrev_u32 v11, 1024, v11
  v_subrev_u32 v12, 2048, v12
  v_subrev_u32 v13, 3072, v13
  s_mov_b32 s52, s60
  s_mov_b32 s53, s61
  s_mov_b32 s33, s35
  s_lshl_b32 s23, s20, 9
  v_add_u32 v16, s23, v10
  ds_write_b128 v16, v[232:235]
  v_and_b32 v17, 7, v1
  v_mul_u32_u24 v9, 2560, v17
  v_lshrrev_b32 v17, 4, v1
  v_lshl_add_u32 v9, v17, 4, v9
  v_and_b32 v17, 8, v1
  v_lshl_add_u32 v9, v17, 27, v9
  s_getpc_b64 s[36:37]
  s_setpc_b64 s[38:39]
  ds_read_b128 v[236:239], v10 offset:0
  ds_read_b128 v[240:243], v10 offset:512
  ds_read_b128 v[244:247], v10 offset:1024
  ds_read_b128 v[248:251], v10 offset:1536
  s_waitcnt vmcnt(4)
  ds_read_b64_tr_b16 a[192:193], v6 offset:0
  ds_read_b64_tr_b16 a[194:195], v6 offset:2560
  ds_read_b64_tr_b16 a[196:197], v6 offset:32
  ds_read_b64_tr_b16 a[198:199], v6 offset:2592
  ds_read_b64_tr_b16 a[200:201], v6 offset:64
  ds_read_b64_tr_b16 a[202:203], v6 offset:2624
  ds_read_b64_tr_b16 a[204:205], v6 offset:96
  ds_read_b64_tr_b16 a[206:207], v6 offset:2656
  ds_read_b64_tr_b16 a[208:209], v6 offset:128
  ds_read_b64_tr_b16 a[210:211], v6 offset:2688
  s_add_u32 s33, s33, 160
  s_mov_b32 s8, 0
  s_waitcnt lgkmcnt(10)
  v_cvt_pk_bf16_f32 v236, v236, v244
  v_cvt_pk_bf16_f32 v237, v237, v245
  v_cvt_pk_bf16_f32 v238, v238, v246
  v_cvt_pk_bf16_f32 v239, v239, v247
  v_cvt_pk_bf16_f32 v240, v240, v248
  v_cvt_pk_bf16_f32 v241, v241, v249
  v_cvt_pk_bf16_f32 v242, v242, v250
  v_cvt_pk_bf16_f32 v243, v243, v251
  v_lshlrev_b32 v244, 16, v236
  v_lshlrev_b32 v245, 16, v237
  v_lshlrev_b32 v246, 16, v238
  v_lshlrev_b32 v247, 16, v239
  v_lshlrev_b32 v248, 16, v240
  v_lshlrev_b32 v249, 16, v241
  v_lshlrev_b32 v250, 16, v242
  v_lshlrev_b32 v251, 16, v243
  v_mul_f32 v16, 0xbfb8aa3b, v244
  v_mul_f32 v17, 0xbfb8aa3b, v245
  v_mul_f32 v18, 0xbfb8aa3b, v246
  v_mul_f32 v19, 0xbfb8aa3b, v247
  v_mul_f32 v20, 0xbfb8aa3b, v248
  v_mul_f32 v21, 0xbfb8aa3b, v249
  v_mul_f32 v22, 0xbfb8aa3b, v250
  v_mul_f32 v23, 0xbfb8aa3b, v251
  v_exp_f32 v16, v16
  v_exp_f32 v17, v17
  v_exp_f32 v18, v18
  v_exp_f32 v19, v19
  v_exp_f32 v20, v20
  v_exp_f32 v21, v21
  v_exp_f32 v22, v22
  v_exp_f32 v23, v23
  v_add_f32 v16, 1.0, v16
  v_add_f32 v17, 1.0, v17
  v_add_f32 v18, 1.0, v18
  v_add_f32 v19, 1.0, v19
  v_add_f32 v20, 1.0, v20
  v_add_f32 v21, 1.0, v21
  v_add_f32 v22, 1.0, v22
  v_add_f32 v23, 1.0, v23
  v_rcp_f32 v16, v16
  v_rcp_f32 v17, v17
  v_rcp_f32 v18, v18
  v_rcp_f32 v19, v19
  v_rcp_f32 v20, v20
  v_rcp_f32 v21, v21
  v_rcp_f32 v22, v22
  v_rcp_f32 v23, v23
  v_mul_f32 v244, v244, v16
  v_mul_f32 v245, v245, v17
  v_mul_f32 v246, v246, v18
  v_mul_f32 v247, v247, v19
  v_mul_f32 v248, v248, v20
  v_mul_f32 v249, v249, v21
  v_mul_f32 v250, v250, v22
  v_mul_f32 v251, v251, v23
  v_cvt_pk_bf16_f32 v16, v244, v245
  v_cvt_pk_bf16_f32 v17, v246, v247
  v_cvt_pk_bf16_f32 v18, v248, v249
  v_cvt_pk_bf16_f32 v19, v250, v251
  v_and_b32 v236, 0xffff0000, v236
  v_and_b32 v237, 0xffff0000, v237
  v_and_b32 v238, 0xffff0000, v238
  v_and_b32 v239, 0xffff0000, v239
  v_and_b32 v240, 0xffff0000, v240
  v_and_b32 v241, 0xffff0000, v241
  v_and_b32 v242, 0xffff0000, v242
  v_and_b32 v243, 0xffff0000, v243
  v_lshlrev_b32 v244, 16, v16
  v_and_b32 v245, 0xffff0000, v16
  v_lshlrev_b32 v246, 16, v17
  v_and_b32 v247, 0xffff0000, v17
  v_lshlrev_b32 v248, 16, v18
  v_and_b32 v249, 0xffff0000, v18
  v_lshlrev_b32 v250, 16, v19
  v_and_b32 v251, 0xffff0000, v19
  v_mul_f32 v236, v236, v244
  v_mul_f32 v237, v237, v245
  v_mul_f32 v238, v238, v246
  v_mul_f32 v239, v239, v247
  v_mul_f32 v240, v240, v248
  v_mul_f32 v241, v241, v249
  v_mul_f32 v242, v242, v250
  v_mul_f32 v243, v243, v251
  v_cvt_pk_bf16_f32 v232, v236, v237
  v_cvt_pk_bf16_f32 v233, v238, v239
  v_cvt_pk_bf16_f32 v234, v240, v241
  v_cvt_pk_bf16_f32 v235, v242, v243
  s_nop 0
  s_waitcnt lgkmcnt(0)
  v_mfma_f32_16x16x32_bf16 v[236:239], a[192:195], v[232:235], 0
  v_mfma_f32_16x16x32_bf16 v[240:243], a[196:199], v[232:235], 0
  v_mfma_f32_16x16x32_bf16 v[244:247], a[200:203], v[232:235], 0
  v_mfma_f32_16x16x32_bf16 v[248:251], a[204:207], v[232:235], 0
  v_mfma_f32_16x16x32_bf16 v[252:255], a[208:211], v[232:235], 0
  s_nop 3
  buffer_store_dwordx4 v[236:239], v9, s[40:43], s10 offen offset:0 sc1
  buffer_store_dwordx4 v[240:243], v9, s[40:43], s10 offen offset:64 sc1
  buffer_store_dwordx4 v[244:247], v9, s[40:43], s10 offen offset:128 sc1
  buffer_store_dwordx4 v[248:251], v9, s[40:43], s10 offen offset:192 sc1
  buffer_store_dwordx4 v[252:255], v9, s[40:43], s10 offen offset:256 sc1
  s_add_u32 s10, s10, 320
  s_getpc_b64 s[36:37]
  s_setpc_b64 s[38:39]
  s_waitcnt vmcnt(4)
  ds_read_b64_tr_b16 a[192:193], v6 offset:0
  ds_read_b64_tr_b16 a[194:195], v6 offset:2560
  ds_read_b64_tr_b16 a[196:197], v6 offset:32
  ds_read_b64_tr_b16 a[198:199], v6 offset:2592
  ds_read_b64_tr_b16 a[200:201], v6 offset:64
  ds_read_b64_tr_b16 a[202:203], v6 offset:2624
  ds_read_b64_tr_b16 a[204:205], v6 offset:96
  ds_read_b64_tr_b16 a[206:207], v6 offset:2656
  ds_read_b64_tr_b16 a[208:209], v6 offset:128
  ds_read_b64_tr_b16 a[210:211], v6 offset:2688
  s_waitcnt lgkmcnt(0)
  v_mfma_f32_16x16x32_bf16 v[236:239], a[192:195], v[232:235], 0
  v_mfma_f32_16x16x32_bf16 v[240:243], a[196:199], v[232:235], 0
  v_mfma_f32_16x16x32_bf16 v[244:247], a[200:203], v[232:235], 0
  v_mfma_f32_16x16x32_bf16 v[248:251], a[204:207], v[232:235], 0
  v_mfma_f32_16x16x32_bf16 v[252:255], a[208:211], v[232:235], 0
  s_nop 3
  buffer_store_dwordx4 v[236:239], v9, s[40:43], s10 offen offset:0 sc1
  buffer_store_dwordx4 v[240:243], v9, s[40:43], s10 offen offset:64 sc1
  buffer_store_dwordx4 v[244:247], v9, s[40:43], s10 offen offset:128 sc1
  buffer_store_dwordx4 v[248:251], v9, s[40:43], s10 offen offset:192 sc1
  buffer_store_dwordx4 v[252:255], v9, s[40:43], s10 offen offset:256 sc1
  s_add_u32 s10, s10, 320
  s_getpc_b64 s[36:37]
  s_setpc_b64 s[38:39]
  s_sub_u32 s23, s2, 170
  s_lshl_b32 s31, s20, 6
  s_add_u32 s23, s23, s31
  s_lshl_b32 s23, s23, 2
  s_add_u32 s23, s23, 2650112
  s_waitcnt vmcnt(8)
  buffer_store_dword v4, off, s[40:43], s23 sc1
fa_coW:
  s_mov_b32 s12, 1
  s_mov_b32 s9, -1
  s_cmp_lg_u32 s11, 0
  s_cselect_b32 s32, s15, -1
  s_getpc_b64 s[36:37]
  s_setpc_b64 s[38:39]
  s_lshl_b32 s23, s22, 2
  s_add_u32 s23, s23, s20
  s_mul_i32 s13, s23, 163840
  s_add_u32 s13, s13, 4194304
  s_lshl_b32 s23, s23, 7
  s_add_u32 s23, s23, 2654208
  v_and_b32 v9, 31, v1
  v_lshl_add_u32 v9, v9, 2, s23
  v_and_b32 v10, 15, v1
  v_lshlrev_b32 v10, 2, v10
  v_add_u32 v10, 2629632, v10
  buffer_load_dword v8, v9, s[40:43], 0 offen sc1
  buffer_load_dword v15, v10, s[40:43], 0 offen sc1
  v_mov_b32 v20, v228
  v_mov_b32 v21, v229
  s_nop 1
  v_permlane16_swap_b32 v228, v20
  v_permlane16_swap_b32 v229, v21
  v_add_f32 v228, v228, v20
  v_add_f32 v229, v229, v21
  v_mov_b32 v20, v228
  v_mov_b32 v21, v229
  s_nop 1
  v_permlane32_swap_b32 v228, v20
  v_permlane32_swap_b32 v229, v21
  v_add_f32 v228, v228, v20
  v_add_f32 v229, v229, v21
  v_rcp_f32 v16, v228
  v_rcp_f32 v18, v229
  s_lshl_b32 s23, s22, 2
  v_mov_b32 v17, v16
  v_mov_b32 v19, v18
  s_add_u32 s23, s23, s20
  s_lshl_b32 s23, s23, 18
  s_lshl_b32 s31, s21, 12
  s_add_u32 s31, s31, 50331648
  s_add_u32 s64, s23, s31
  s_add_u32 s65, s64, 131072
  v_accvgpr_read_b32 v36, a0
  v_accvgpr_read_b32 v37, a1
  v_accvgpr_read_b32 v38, a2
  v_accvgpr_read_b32 v39, a3
  v_accvgpr_read_b32 v40, a8
  v_accvgpr_read_b32 v41, a9
  v_accvgpr_read_b32 v42, a10
  v_accvgpr_read_b32 v43, a11
  v_pk_mul_f32 v[36:37], v[36:37], v[16:17]
  v_pk_mul_f32 v[38:39], v[38:39], v[16:17]
  v_pk_mul_f32 v[40:41], v[40:41], v[16:17]
  v_pk_mul_f32 v[42:43], v[42:43], v[16:17]
  v_cvt_pk_bf16_f32 v32, v36, v37
  v_cvt_pk_bf16_f32 v33, v38, v39
  v_cvt_pk_bf16_f32 v34, v40, v41
  v_cvt_pk_bf16_f32 v35, v42, v43
  buffer_store_dwordx4 v[32:35], v2, s[40:43], s64 offen offset:0 sc1
  v_accvgpr_read_b32 v48, a16
  v_accvgpr_read_b32 v49, a17
  v_accvgpr_read_b32 v50, a18
  v_accvgpr_read_b32 v51, a19
  v_accvgpr_read_b32 v52, a24
  v_accvgpr_read_b32 v53, a25
  v_accvgpr_read_b32 v54, a26
  v_accvgpr_read_b32 v55, a27
  v_pk_mul_f32 v[48:49], v[48:49], v[16:17]
  v_pk_mul_f32 v[50:51], v[50:51], v[16:17]
  v_pk_mul_f32 v[52:53], v[52:53], v[16:17]
  v_pk_mul_f32 v[54:55], v[54:55], v[16:17]
  v_cvt_pk_bf16_f32 v44, v48, v49
  v_cvt_pk_bf16_f32 v45, v50, v51
  v_cvt_pk_bf16_f32 v46, v52, v53
  v_cvt_pk_bf16_f32 v47, v54, v55
  buffer_store_dwordx4 v[44:47], v2, s[40:43], s64 offen offset:1024 sc1
  v_accvgpr_read_b32 v100, a32
  v_accvgpr_read_b32 v101, a33
  v_accvgpr_read_b32 v102, a34
  v_accvgpr_read_b32 v103, a35
  v_accvgpr_read_b32 v104, a40
  v_accvgpr_read_b32 v105, a41
  v_accvgpr_read_b32 v106, a42
  v_accvgpr_read_b32 v107, a43
  v_pk_mul_f32 v[100:101], v[100:101], v[16:17]
  v_pk_mul_f32 v[102:103], v[102:103], v[16:17]
  v_pk_mul_f32 v[104:105], v[104:105], v[16:17]
  v_pk_mul_f32 v[106:107], v[106:107], v[16:17]
  v_cvt_pk_bf16_f32 v96, v100, v101
  v_cvt_pk_bf16_f32 v97, v102, v103
  v_cvt_pk_bf16_f32 v98, v104, v105
  v_cvt_pk_bf16_f32 v99, v106, v107
  buffer_store_dwordx4 v[96:99], v2, s[40:43], s64 offen offset:2048 sc1
  v_accvgpr_read_b32 v112, a48
  v_accvgpr_read_b32 v113, a49
  v_accvgpr_read_b32 v114, a50
  v_accvgpr_read_b32 v115, a51
  v_accvgpr_read_b32 v116, a56
  v_accvgpr_read_b32 v117, a57
  v_accvgpr_read_b32 v118, a58
  v_accvgpr_read_b32 v119, a59
  v_pk_mul_f32 v[112:113], v[112:113], v[16:17]
  v_pk_mul_f32 v[114:115], v[114:115], v[16:17]
  v_pk_mul_f32 v[116:117], v[116:117], v[16:17]
  v_pk_mul_f32 v[118:119], v[118:119], v[16:17]
  v_cvt_pk_bf16_f32 v108, v112, v113
  v_cvt_pk_bf16_f32 v109, v114, v115
  v_cvt_pk_bf16_f32 v110, v116, v117
  v_cvt_pk_bf16_f32 v111, v118, v119
  buffer_store_dwordx4 v[108:111], v2, s[40:43], s64 offen offset:3072 sc1
  v_accvgpr_read_b32 v36, a4
  v_accvgpr_read_b32 v37, a5
  v_accvgpr_read_b32 v38, a6
  v_accvgpr_read_b32 v39, a7
  v_accvgpr_read_b32 v40, a12
  v_accvgpr_read_b32 v41, a13
  v_accvgpr_read_b32 v42, a14
  v_accvgpr_read_b32 v43, a15
  v_pk_mul_f32 v[36:37], v[36:37], v[18:19]
  v_pk_mul_f32 v[38:39], v[38:39], v[18:19]
  v_pk_mul_f32 v[40:41], v[40:41], v[18:19]
  v_pk_mul_f32 v[42:43], v[42:43], v[18:19]
  v_cvt_pk_bf16_f32 v32, v36, v37
  v_cvt_pk_bf16_f32 v33, v38, v39
  v_cvt_pk_bf16_f32 v34, v40, v41
  v_cvt_pk_bf16_f32 v35, v42, v43
  buffer_store_dwordx4 v[32:35], v2, s[40:43], s65 offen offset:0 sc1
  v_accvgpr_read_b32 v48, a20
  v_accvgpr_read_b32 v49, a21
  v_accvgpr_read_b32 v50, a22
  v_accvgpr_read_b32 v51, a23
  v_accvgpr_read_b32 v52, a28
  v_accvgpr_read_b32 v53, a29
  v_accvgpr_read_b32 v54, a30
  v_accvgpr_read_b32 v55, a31
  v_pk_mul_f32 v[48:49], v[48:49], v[18:19]
  v_pk_mul_f32 v[50:51], v[50:51], v[18:19]
  v_pk_mul_f32 v[52:53], v[52:53], v[18:19]
  v_pk_mul_f32 v[54:55], v[54:55], v[18:19]
  v_cvt_pk_bf16_f32 v44, v48, v49
  v_cvt_pk_bf16_f32 v45, v50, v51
  v_cvt_pk_bf16_f32 v46, v52, v53
  v_cvt_pk_bf16_f32 v47, v54, v55
  buffer_store_dwordx4 v[44:47], v2, s[40:43], s65 offen offset:1024 sc1
  v_accvgpr_read_b32 v100, a36
  v_accvgpr_read_b32 v101, a37
  v_accvgpr_read_b32 v102, a38
  v_accvgpr_read_b32 v103, a39
  v_accvgpr_read_b32 v104, a44
  v_accvgpr_read_b32 v105, a45
  v_accvgpr_read_b32 v106, a46
  v_accvgpr_read_b32 v107, a47
  v_pk_mul_f32 v[100:101], v[100:101], v[18:19]
  v_pk_mul_f32 v[102:103], v[102:103], v[18:19]
  v_pk_mul_f32 v[104:105], v[104:105], v[18:19]
  v_pk_mul_f32 v[106:107], v[106:107], v[18:19]
  v_cvt_pk_bf16_f32 v96, v100, v101
  v_cvt_pk_bf16_f32 v97, v102, v103
  v_cvt_pk_bf16_f32 v98, v104, v105
  v_cvt_pk_bf16_f32 v99, v106, v107
  buffer_store_dwordx4 v[96:99], v2, s[40:43], s65 offen offset:2048 sc1
  v_accvgpr_read_b32 v112, a52
  v_accvgpr_read_b32 v113, a53
  v_accvgpr_read_b32 v114, a54
  v_accvgpr_read_b32 v115, a55
  v_accvgpr_read_b32 v116, a60
  v_accvgpr_read_b32 v117, a61
  v_accvgpr_read_b32 v118, a62
  v_accvgpr_read_b32 v119, a63
  v_pk_mul_f32 v[112:113], v[112:113], v[18:19]
  v_pk_mul_f32 v[114:115], v[114:115], v[18:19]
  v_pk_mul_f32 v[116:117], v[116:117], v[18:19]
  v_pk_mul_f32 v[118:119], v[118:119], v[18:19]
  v_cvt_pk_bf16_f32 v108, v112, v113
  v_cvt_pk_bf16_f32 v109, v114, v115
  v_cvt_pk_bf16_f32 v110, v116, v117
  v_cvt_pk_bf16_f32 v111, v118, v119
  buffer_store_dwordx4 v[108:111], v2, s[40:43], s65 offen offset:3072 sc1
  s_waitcnt vmcnt(8)
  v_cmp_eq_u32 vcc, 0, v8
  s_cbranch_vccnz fa_wof_spin
fa_wof_ok:
  v_cmp_eq_u32 vcc, 0, v15
  s_cbranch_vccnz fa_sel4_spin
fa_sel4_ok:
  s_lshl_b32 s23, s20, 1
  s_add_u32 s31, s23, 1
  v_readlane_b32 s33, v15, s23
  v_readlane_b32 s35, v15, s31
  s_lshl_b32 s31, s21, 6
  s_add_u32 s31, s31, 1
  s_sub_u32 s33, s33, s31
  s_sub_u32 s35, s35, s31
  s_cmp_lt_u32 s33, 64
  s_cselect_b32 s10, 1, 0
  s_cmp_lt_u32 s35, 64
  s_cselect_b32 s31, 2, 0
  s_or_b32 s10, s10, s31
  s_cbranch_scc0 fa_coEnd
  v_min_u32 v11, 53, v1
  s_lshr_b32 s23, s22, 1
  s_lshl_b32 s23, s23, 8
  s_add_u32 s23, s23, 2650112
  v_lshl_add_u32 v11, v11, 2, s23
  buffer_load_dword v14, v11, s[40:43], 0 offen sc1
  v_mul_u32_u24 v16, 3277, v1
  v_lshrrev_b32 v16, 16, v16
  v_mul_u32_u24 v8, 20, v16
  v_sub_u32 v8, v1, v8
  v_lshlrev_b32 v8, 4, v8
  v_mul_u32_u24 v9, 368640, v16
  v_add_u32 v9, v9, v8
  v_cmp_gt_u32 vcc, 3, v16
  v_mov_b32 v19, 1073741824
  s_nop 0
  v_cndmask_b32 v9, v19, v9, vcc
  s_mov_b32 s12, 2
  s_mov_b32 s32, -1
  s_mov_b32 s11, 0
  s_getpc_b64 s[36:37]
  s_setpc_b64 s[38:39]
  v_cmp_eq_u32 vcc, 0, v14
  s_cbranch_vccnz fa_yf_spin
fa_yf_ok:
fa_coY:
  s_ff1_i32_b32 s33, s10
  s_bitset0_b32 s10, s33
  s_lshl_b32 s23, s20, 1
  s_add_u32 s33, s33, s23
  s_mul_i32 s14, s33, 2560
  s_mul_i32 s23, s22, 320
  s_add_u32 s14, s14, s23
  s_add_u32 s14, s14, 2686976
  buffer_load_dwordx4 v[64:67], v9, s[40:43], s14 offen sc1
  s_add_u32 s14, s14, 20480
  buffer_load_dwordx4 v[68:71], v9, s[40:43], s14 offen sc1
  s_add_u32 s14, s14, 20480
  buffer_load_dwordx4 v[72:75], v9, s[40:43], s14 offen sc1
  s_add_u32 s14, s14, 20480
  buffer_load_dwordx4 v[76:79], v9, s[40:43], s14 offen sc1
  s_add_u32 s14, s14, 20480
  buffer_load_dwordx4 v[80:83], v9, s[40:43], s14 offen sc1
  s_add_u32 s14, s14, 20480
  buffer_load_dwordx4 v[84:87], v9, s[40:43], s14 offen sc1
  s_add_u32 s14, s14, 20480
  buffer_load_dwordx4 v[88:91], v9, s[40:43], s14 offen sc1
  s_add_u32 s14, s14, 20480
  buffer_load_dwordx4 v[92:95], v9, s[40:43], s14 offen sc1
  s_add_u32 s14, s14, 20480
  buffer_load_dwordx4 v[128:131], v9, s[40:43], s14 offen sc1
  s_add_u32 s14, s14, 20480
  buffer_load_dwordx4 v[132:135], v9, s[40:43], s14 offen sc1
  s_add_u32 s14, s14, 20480
  buffer_load_dwordx4 v[136:139], v9, s[40:43], s14 offen sc1
  s_add_u32 s14, s14, 20480
  buffer_load_dwordx4 v[140:143], v9, s[40:43], s14 offen sc1
  s_add_u32 s14, s14, 20480
  buffer_load_dwordx4 v[144:147], v9, s[40:43], s14 offen sc1
  s_add_u32 s14, s14, 20480
  buffer_load_dwordx4 v[148:151], v9, s[40:43], s14 offen sc1
  s_add_u32 s14, s14, 20480
  buffer_load_dwordx4 v[152:155], v9, s[40:43], s14 offen sc1
  s_add_u32 s14, s14, 20480
  buffer_load_dwordx4 v[156:159], v9, s[40:43], s14 offen sc1
  s_add_u32 s14, s14, 20480
  buffer_load_dwordx4 v[176:179], v9, s[40:43], s14 offen sc1
  s_add_u32 s14, s14, 20480
  buffer_load_dwordx4 v[180:183], v9, s[40:43], s14 offen sc1
  s_add_u32 s14, s14, 20480
  s_cmp_eq_u32 s11, 0
  s_cbranch_scc1 fa_coY1
  s_waitcnt vmcnt(0)
  s_branch fa_coY2
fa_coY1:
  s_mov_b32 s11, 1
  s_getpc_b64 s[36:37]
  s_setpc_b64 s[38:39]
fa_coY2:
  s_lshl_b32 s14, s20, 10
  s_add_u32 s14, s14, 159744
  v_add_u32 v19, s14, v2
  s_add_u32 s23, s33, 8
  v_readlane_b32 s35, v15, s23
  s_waitcnt vmcnt(1)
  v_pk_add_f32 v[64:65], v[64:65], v[68:69]
  v_pk_add_f32 v[66:67], v[66:67], v[70:71]
  v_pk_add_f32 v[64:65], v[64:65], v[72:73]
  v_pk_add_f32 v[66:67], v[66:67], v[74:75]
  v_pk_add_f32 v[64:65], v[64:65], v[76:77]
  v_pk_add_f32 v[66:67], v[66:67], v[78:79]
  v_pk_add_f32 v[64:65], v[64:65], v[80:81]
  v_pk_add_f32 v[66:67], v[66:67], v[82:83]
  v_pk_add_f32 v[64:65], v[64:65], v[84:85]
  v_pk_add_f32 v[66:67], v[66:67], v[86:87]
  v_pk_add_f32 v[64:65], v[64:65], v[88:89]
  v_pk_add_f32 v[66:67], v[66:67], v[90:91]
  v_pk_add_f32 v[64:65], v[64:65], v[92:93]
  v_pk_add_f32 v[66:67], v[66:67], v[94:95]
  v_pk_add_f32 v[64:65], v[64:65], v[128:129]
  v_pk_add_f32 v[66:67], v[66:67], v[130:131]
  v_pk_add_f32 v[64:65], v[64:65], v[132:133]
  v_pk_add_f32 v[66:67], v[66:67], v[134:135]
  v_pk_add_f32 v[64:65], v[64:65], v[136:137]
  v_pk_add_f32 v[66:67], v[66:67], v[138:139]
  v_pk_add_f32 v[64:65], v[64:65], v[140:141]
  v_pk_add_f32 v[66:67], v[66:67], v[142:143]
  v_pk_add_f32 v[64:65], v[64:65], v[144:145]
  v_pk_add_f32 v[66:67], v[66:67], v[146:147]
  v_pk_add_f32 v[64:65], v[64:65], v[148:149]
  v_pk_add_f32 v[66:67], v[66:67], v[150:151]
  v_pk_add_f32 v[64:65], v[64:65], v[152:153]
  v_pk_add_f32 v[66:67], v[66:67], v[154:155]
  v_pk_add_f32 v[64:65], v[64:65], v[156:157]
  v_pk_add_f32 v[66:67], v[66:67], v[158:159]
  v_pk_add_f32 v[64:65], v[64:65], v[176:177]
  v_pk_add_f32 v[66:67], v[66:67], v[178:179]
  v_pk_add_f32 v[64:65], v[64:65], v[180:181]
  v_pk_add_f32 v[66:67], v[66:67], v[182:183]
  ds_write_b128 v19, v[64:67]
  v_add_u32 v19, s14, v8
  s_and_b32 s35, s35, 0xffff0000
  s_waitcnt lgkmcnt(0)
  ds_read_b128 v[64:67], v19
  ds_read_b128 v[68:71], v19 offset:320
  ds_read_b128 v[72:75], v19 offset:640
  s_mul_i32 s14, s33, 320
  s_add_u32 s14, s14, 155648
  v_add_u32 v19, s14, v8
  s_waitcnt lgkmcnt(0)
  v_add_f32 v64, v64, v68
  v_add_f32 v64, v64, v72
  v_cvt_pk_bf16_f32 v64, v64, v64
  v_and_b32 v64, 0xffff0000, v64
  v_mul_f32 v64, s35, v64
  v_cvt_pk_bf16_f32 v64, v64, v64
  v_and_b32 v64, 0xffff0000, v64
  v_add_f32 v65, v65, v69
  v_add_f32 v65, v65, v73
  v_cvt_pk_bf16_f32 v65, v65, v65
  v_and_b32 v65, 0xffff0000, v65
  v_mul_f32 v65, s35, v65
  v_cvt_pk_bf16_f32 v65, v65, v65
  v_and_b32 v65, 0xffff0000, v65
  v_add_f32 v66, v66, v70
  v_add_f32 v66, v66, v74
  v_cvt_pk_bf16_f32 v66, v66, v66
  v_and_b32 v66, 0xffff0000, v66
  v_mul_f32 v66, s35, v66
  v_cvt_pk_bf16_f32 v66, v66, v66
  v_and_b32 v66, 0xffff0000, v66
  v_add_f32 v67, v67, v71
  v_add_f32 v67, v67, v75
  v_cvt_pk_bf16_f32 v67, v67, v67
  v_and_b32 v67, 0xffff0000, v67
  v_mul_f32 v67, s35, v67
  v_cvt_pk_bf16_f32 v67, v67, v67
  v_and_b32 v67, 0xffff0000, v67
  ds_write_b128 v19, v[64:67]
  s_waitcnt lgkmcnt(0)
  s_cmp_lg_u32 s10, 0
  s_cbranch_scc1 fa_coY
fa_coEnd:
  s_mov_b32 s12, 3
  s_mov_b32 s32, -1
  s_setpc_b64 s[38:39]
fa_hk7:
  s_getpc_b64 s[38:39]
fa_hp7:
  s_add_u32 s36, s36, 4
  s_addc_u32 s37, s37, 0
  s_sub_u32 s38, s38, fa_hp7-fa_hb7
  s_subb_u32 s39, s39, 0
  s_setpc_b64 s[36:37]
fa_hk8:
  s_getpc_b64 s[38:39]
fa_hp8:
  s_add_u32 s36, s36, 4
  s_addc_u32 s37, s37, 0
  s_sub_u32 s38, s38, fa_hp8-fa_hb8
  s_subb_u32 s39, s39, 0
  s_setpc_b64 s[36:37]
fa_disp:
  s_cmp_eq_u32 s29, 7
  s_cbranch_scc1 fa_SSW7
  s_cmp_eq_u32 s29, 6
  s_cbranch_scc1 fa_SSW6
  s_cmp_eq_u32 s29, 5
  s_cbranch_scc1 fa_SSW5
  s_cmp_eq_u32 s29, 4
  s_cbranch_scc1 fa_SSW4
  s_cmp_eq_u32 s29, 3
  s_cbranch_scc1 fa_SSW3
  s_cmp_eq_u32 s29, 2
  s_cbranch_scc1 fa_SSW2
  s_cmp_eq_u32 s29, 1
  s_cbranch_scc1 fa_SSW1
  s_branch fa_Bexit
fa_hk9:
  s_getpc_b64 s[38:39]
fa_hp9:
  s_add_u32 s36, s36, 4
  s_addc_u32 s37, s37, 0
  s_sub_u32 s38, s38, fa_hp9-fa_hb9
  s_subb_u32 s39, s39, 0
  s_setpc_b64 s[36:37]
fa_hk10:
  s_getpc_b64 s[38:39]
fa_hp10:
  s_add_u32 s36, s36, 4
  s_addc_u32 s37, s37, 0
  s_sub_u32 s38, s38, fa_hp10-fa_hb10
  s_subb_u32 s39, s39, 0
  s_setpc_b64 s[36:37]
fa_left:
  s_add_u32 s14, s13, 0
  buffer_load_dwordx4 a[0:3], v2, s[40:43], s14 offen offset:0 sc1
  buffer_load_dwordx4 a[4:7], v2, s[40:43], s14 offen offset:1024 sc1
  buffer_load_dwordx4 a[8:11], v2, s[40:43], s14 offen offset:2048 sc1
  buffer_load_dwordx4 a[12:15], v2, s[40:43], s14 offen offset:3072 sc1
  s_add_u32 s14, s13, 4096
  buffer_load_dwordx4 a[16:19], v2, s[40:43], s14 offen offset:0 sc1
  buffer_load_dwordx4 a[20:23], v2, s[40:43], s14 offen offset:1024 sc1
  s_cmp_ge_u32 s29, 7
  s_cbranch_scc1 fa_leftb
  s_add_u32 s14, s13, 4096
  buffer_load_dwordx4 a[24:27], v2, s[40:43], s14 offen offset:2048 sc1
  buffer_load_dwordx4 a[28:31], v2, s[40:43], s14 offen offset:3072 sc1
  s_add_u32 s14, s13, 8192
  buffer_load_dwordx4 a[32:35], v2, s[40:43], s14 offen offset:0 sc1
  buffer_load_dwordx4 a[36:39], v2, s[40:43], s14 offen offset:1024 sc1
  buffer_load_dwordx4 a[40:43], v2, s[40:43], s14 offen offset:2048 sc1
  buffer_load_dwordx4 a[44:47], v2, s[40:43], s14 offen offset:3072 sc1
  s_cmp_ge_u32 s29, 6
  s_cbranch_scc1 fa_leftb
  s_add_u32 s14, s13, 12288
  buffer_load_dwordx4 a[48:51], v2, s[40:43], s14 offen offset:0 sc1
  buffer_load_dwordx4 a[52:55], v2, s[40:43], s14 offen offset:1024 sc1
  buffer_load_dwordx4 a[56:59], v2, s[40:43], s14 offen offset:2048 sc1
  buffer_load_dwordx4 a[60:63], v2, s[40:43], s14 offen offset:3072 sc1
  s_add_u32 s14, s13, 16384
  buffer_load_dwordx4 a[192:195], v2, s[40:43], s14 offen offset:0 sc1
  buffer_load_dwordx4 a[196:199], v2, s[40:43], s14 offen offset:1024 sc1
  s_cmp_ge_u32 s29, 5
  s_cbranch_scc1 fa_leftb
  s_add_u32 s14, s13, 16384
  buffer_load_dwordx4 a[200:203], v2, s[40:43], s14 offen offset:2048 sc1
  buffer_load_dwordx4 a[204:207], v2, s[40:43], s14 offen offset:3072 sc1
  s_add_u32 s14, s13, 20480
  buffer_load_dwordx4 a[208:211], v2, s[40:43], s14 offen offset:0 sc1
  buffer_load_dwordx4 a[212:215], v2, s[40:43], s14 offen offset:1024 sc1
  buffer_load_dwordx4 a[216:219], v2, s[40:43], s14 offen offset:2048 sc1
  buffer_load_dwordx4 a[220:223], v2, s[40:43], s14 offen offset:3072 sc1
  s_cmp_ge_u32 s29, 4
  s_cbranch_scc1 fa_leftb
  s_add_u32 s14, s13, 24576
  buffer_load_dwordx4 a[224:227], v2, s[40:43], s14 offen offset:0 sc1
  buffer_load_dwordx4 a[228:231], v2, s[40:43], s14 offen offset:1024 sc1
  buffer_load_dwordx4 a[232:235], v2, s[40:43], s14 offen offset:2048 sc1
  buffer_load_dwordx4 a[236:239], v2, s[40:43], s14 offen offset:3072 sc1
  s_add_u32 s14, s13, 28672
  buffer_load_dwordx4 a[240:243], v2, s[40:43], s14 offen offset:0 sc1
  buffer_load_dwordx4 a[244:247], v2, s[40:43], s14 offen offset:1024 sc1
  s_cmp_ge_u32 s29, 3
  s_cbranch_scc1 fa_leftb
  s_add_u32 s14, s13, 28672
  buffer_load_dwordx4 a[248:251], v2, s[40:43], s14 offen offset:2048 sc1
  buffer_load_dwordx4 a[252:255], v2, s[40:43], s14 offen offset:3072 sc1
  s_add_u32 s14, s13, 32768
  buffer_load_dwordx4 v[32:35], v2, s[40:43], s14 offen offset:0 sc1
  buffer_load_dwordx4 v[36:39], v2, s[40:43], s14 offen offset:1024 sc1
  buffer_load_dwordx4 v[40:43], v2, s[40:43], s14 offen offset:2048 sc1
  buffer_load_dwordx4 v[44:47], v2, s[40:43], s14 offen offset:3072 sc1
  s_cmp_ge_u32 s29, 2
  s_cbranch_scc1 fa_leftb
  s_add_u32 s14, s13, 36864
  buffer_load_dwordx4 v[48:51], v2, s[40:43], s14 offen offset:0 sc1
  buffer_load_dwordx4 v[52:55], v2, s[40:43], s14 offen offset:1024 sc1
  buffer_load_dwordx4 v[56:59], v2, s[40:43], s14 offen offset:2048 sc1
  buffer_load_dwordx4 v[60:63], v2, s[40:43], s14 offen offset:3072 sc1
  s_add_u32 s14, s13, 40960
  buffer_load_dwordx4 v[96:99], v2, s[40:43], s14 offen offset:0 sc1
  buffer_load_dwordx4 v[100:103], v2, s[40:43], s14 offen offset:1024 sc1
  s_cmp_ge_u32 s29, 1
  s_cbranch_scc1 fa_leftb
  s_add_u32 s14, s13, 40960
  buffer_load_dwordx4 v[104:107], v2, s[40:43], s14 offen offset:2048 sc1
  buffer_load_dwordx4 v[108:111], v2, s[40:43], s14 offen offset:3072 sc1
  s_add_u32 s14, s13, 45056
  buffer_load_dwordx4 v[112:115], v2, s[40:43], s14 offen offset:0 sc1
  buffer_load_dwordx4 v[116:119], v2, s[40:43], s14 offen offset:1024 sc1
  buffer_load_dwordx4 v[120:123], v2, s[40:43], s14 offen offset:2048 sc1
  buffer_load_dwordx4 v[124:127], v2, s[40:43], s14 offen offset:3072 sc1
  s_branch fa_leftb
fa_ctx_spin:
  s_mov_b32 s83, 200000
fa_ctx_spin2:
  buffer_load_dword v13, v12, s[40:43], 0 offen sc1
  s_waitcnt vmcnt(0)
  v_cmp_eq_u32 vcc, 0, v13
  s_cbranch_vccz fa_ctx_ok
  s_sleep 8
  s_sub_u32 s83, s83, 1
  s_cmp_lg_u32 s83, 0
  s_cbranch_scc1 fa_ctx_spin2
  s_branch fa_ctx_ok
fa_stub0:
  s_call_b64 s[76:77], fa_rare00
  s_call_b64 s[76:77], fa_rare10
  s_branch fa_back0
fa_stub1:
  s_call_b64 s[76:77], fa_rare01
  s_call_b64 s[76:77], fa_rare11
  s_branch fa_back1
fa_stub2:
  s_call_b64 s[76:77], fa_rare00
  s_call_b64 s[76:77], fa_rare10
  s_branch fa_back2
fa_stub3:
  s_call_b64 s[76:77], fa_rare01
  s_call_b64 s[76:77], fa_rare11
  s_branch fa_back3
fa_stub4:
  s_call_b64 s[76:77], fa_rare01
  s_call_b64 s[76:77], fa_rare11
  s_branch fa_back4
fa_stub5:
  s_call_b64 s[76:77], fa_rare00
  s_call_b64 s[76:77], fa_rare10
  s_branch fa_back5
fa_stub6:
  s_call_b64 s[76:77], fa_rare11
  s_branch fa_back6
fa_stub7:
  s_call_b64 s[76:77], fa_rare10
  s_branch fa_back7
fa_stub8:
  s_call_b64 s[76:77], fa_rare01
  s_call_b64 s[76:77], fa_rare11
  s_branch fa_back8
fa_stub9:
  s_call_b64 s[76:77], fa_rare10
  s_branch fa_back9
fa_stub10:
  s_call_b64 s[76:77], fa_rare11
  s_branch fa_back10
fa_stub11:
  s_call_b64 s[76:77], fa_rare10
  s_branch fa_back11
fa_stub12:
  s_call_b64 s[76:77], fa_rare11
  s_branch fa_back12
fa_stub13:
  s_call_b64 s[76:77], fa_rare10
  s_branch fa_back13
fa_stub14:
  s_call_b64 s[76:77], fa_rare11
  s_branch fa_back14
fa_stub15:
  s_call_b64 s[76:77], fa_rare10
  s_branch fa_back15
fa_stub16:
  s_call_b64 s[76:77], fa_rare11
  s_branch fa_back16
fa_stub17:
  s_call_b64 s[76:77], fa_rare10
  s_branch fa_back17
fa_stub18:
  s_call_b64 s[76:77], fa_rare11
  s_branch fa_back18
fa_stub19:
  s_call_b64 s[76:77], fa_rare10
  s_branch fa_back19
fa_stub20:
  s_call_b64 s[76:77], fa_rare11
  s_branch fa_back20
fa_stub21:
  s_call_b64 s[76:77], fa_rare10
  s_branch fa_back21
fa_stub22:
  s_call_b64 s[76:77], fa_rare11
  s_branch fa_back22
fa_stub23:
  s_call_b64 s[76:77], fa_rare10
  s_branch fa_back23
fa_stub24:
  s_call_b64 s[76:77], fa_rare11
  s_branch fa_back24
fa_stub25:
  s_call_b64 s[76:77], fa_rare10
  s_branch fa_back25
fa_stub26:
  s_call_b64 s[76:77], fa_rare11
  s_branch fa_back26
fa_stub27:
  s_call_b64 s[76:77], fa_rare10
  s_branch fa_back27
fa_stub28:
  s_call_b64 s[76:77], fa_rare11
  s_branch fa_back28
fa_stub29:
  s_call_b64 s[76:77], fa_rare10
  s_branch fa_back29
fa_stub30:
  s_call_b64 s[76:77], fa_rare11
  s_branch fa_back30
fa_codeend:
fa_rare00:
  s_nop 7
  v_max3_f32 v16, v96, v97, v98
  v_max3_f32 v16, v16, v99, v100
  v_max3_f32 v16, v16, v101, v102
  v_max3_f32 v16, v16, v103, 0
  v_mov_b32 v18, v16
  s_nop 1
  v_permlane16_swap_b32 v16, v18
  v_max_f32 v16, v16, v18
  v_mov_b32 v18, v16
  s_nop 1
  v_permlane32_swap_b32 v16, v18
  v_max_f32 v16, v16, v18
  v_sub_f32 v96, v96, v16
  v_sub_f32 v112, v112, v16
  v_sub_f32 v97, v97, v16
  v_sub_f32 v113, v113, v16
  v_sub_f32 v98, v98, v16
  v_sub_f32 v114, v114, v16
  v_sub_f32 v99, v99, v16
  v_sub_f32 v115, v115, v16
  v_sub_f32 v100, v100, v16
  v_sub_f32 v116, v116, v16
  v_sub_f32 v101, v101, v16
  v_sub_f32 v117, v117, v16
  v_sub_f32 v102, v102, v16
  v_sub_f32 v118, v118, v16
  v_sub_f32 v103, v103, v16
  v_sub_f32 v119, v119, v16
  v_max3_f32 v17, v104, v105, v106
  v_max3_f32 v17, v17, v107, v108
  v_max3_f32 v17, v17, v109, v110
  v_max3_f32 v17, v17, v111, 0
  v_mov_b32 v18, v17
  s_nop 1
  v_permlane16_swap_b32 v17, v18
  v_max_f32 v17, v17, v18
  v_mov_b32 v18, v17
  s_nop 1
  v_permlane32_swap_b32 v17, v18
  v_max_f32 v17, v17, v18
  v_sub_f32 v104, v104, v17
  v_sub_f32 v120, v120, v17
  v_sub_f32 v105, v105, v17
  v_sub_f32 v121, v121, v17
  v_sub_f32 v106, v106, v17
  v_sub_f32 v122, v122, v17
  v_sub_f32 v107, v107, v17
  v_sub_f32 v123, v123, v17
  v_sub_f32 v108, v108, v17
  v_sub_f32 v124, v124, v17
  v_sub_f32 v109, v109, v17
  v_sub_f32 v125, v125, v17
  v_sub_f32 v110, v110, v17
  v_sub_f32 v126, v126, v17
  v_sub_f32 v111, v111, v17
  v_sub_f32 v127, v127, v17
  s_call_b64 s[78:79], fa_resc0
  v_exp_f32 v208, v96
  v_exp_f32 v209, v97
  v_exp_f32 v210, v98
  v_add_f32 v224, v208, v209
  v_cvt_pk_bf16_f32 v160, v208, v209
  v_exp_f32 v211, v99
  v_add_f32 v224, v224, v210
  v_exp_f32 v212, v100
  v_add_f32 v224, v224, v211
  v_cvt_pk_bf16_f32 v161, v210, v211
  v_exp_f32 v213, v101
  v_add_f32 v224, v224, v212
  v_exp_f32 v214, v102
  v_add_f32 v224, v224, v213
  v_cvt_pk_bf16_f32 v162, v212, v213
  v_exp_f32 v215, v103
  v_add_f32 v224, v224, v214
  v_exp_f32 v208, v104
  v_add_f32 v224, v224, v215
  v_cvt_pk_bf16_f32 v163, v214, v215
  v_exp_f32 v209, v105
  v_exp_f32 v210, v106
  v_add_f32 v225, v208, v209
  v_cvt_pk_bf16_f32 v164, v208, v209
  v_exp_f32 v211, v107
  v_add_f32 v225, v225, v210
  v_exp_f32 v212, v108
  v_add_f32 v225, v225, v211
  v_cvt_pk_bf16_f32 v165, v210, v211
  v_exp_f32 v213, v109
  v_add_f32 v225, v225, v212
  v_exp_f32 v214, v110
  v_add_f32 v225, v225, v213
  v_cvt_pk_bf16_f32 v166, v212, v213
  v_exp_f32 v215, v111
  v_add_f32 v225, v225, v214
  s_nop 0
  v_add_f32 v225, v225, v215
  v_cvt_pk_bf16_f32 v167, v214, v215
  s_nop 1
  s_setpc_b64 s[76:77]
fa_rare01:
  s_nop 7
  v_max3_f32 v16, v112, v113, v114
  v_max3_f32 v16, v16, v115, v116
  v_max3_f32 v16, v16, v117, v118
  v_max3_f32 v16, v16, v119, 0
  v_mov_b32 v18, v16
  s_nop 1
  v_permlane16_swap_b32 v16, v18
  v_max_f32 v16, v16, v18
  v_mov_b32 v18, v16
  s_nop 1
  v_permlane32_swap_b32 v16, v18
  v_max_f32 v16, v16, v18
  v_sub_f32 v112, v112, v16
  v_sub_f32 v96, v96, v16
  v_sub_f32 v113, v113, v16
  v_sub_f32 v97, v97, v16
  v_sub_f32 v114, v114, v16
  v_sub_f32 v98, v98, v16
  v_sub_f32 v115, v115, v16
  v_sub_f32 v99, v99, v16
  v_sub_f32 v116, v116, v16
  v_sub_f32 v100, v100, v16
  v_sub_f32 v117, v117, v16
  v_sub_f32 v101, v101, v16
  v_sub_f32 v118, v118, v16
  v_sub_f32 v102, v102, v16
  v_sub_f32 v119, v119, v16
  v_sub_f32 v103, v103, v16
  v_max3_f32 v17, v120, v121, v122
  v_max3_f32 v17, v17, v123, v124
  v_max3_f32 v17, v17, v125, v126
  v_max3_f32 v17, v17, v127, 0
  v_mov_b32 v18, v17
  s_nop 1
  v_permlane16_swap_b32 v17, v18
  v_max_f32 v17, v17, v18
  v_mov_b32 v18, v17
  s_nop 1
  v_permlane32_swap_b32 v17, v18
  v_max_f32 v17, v17, v18
  v_sub_f32 v120, v120, v17
  v_sub_f32 v104, v104, v17
  v_sub_f32 v121, v121, v17
  v_sub_f32 v105, v105, v17
  v_sub_f32 v122, v122, v17
  v_sub_f32 v106, v106, v17
  v_sub_f32 v123, v123, v17
  v_sub_f32 v107, v107, v17
  v_sub_f32 v124, v124, v17
  v_sub_f32 v108, v108, v17
  v_sub_f32 v125, v125, v17
  v_sub_f32 v109, v109, v17
  v_sub_f32 v126, v126, v17
  v_sub_f32 v110, v110, v17
  v_sub_f32 v127, v127, v17
  v_sub_f32 v111, v111, v17
  s_call_b64 s[78:79], fa_resc0
  v_exp_f32 v208, v112
  v_exp_f32 v209, v113
  v_exp_f32 v210, v114
  v_add_f32 v224, v208, v209
  v_cvt_pk_bf16_f32 v168, v208, v209
  v_exp_f32 v211, v115
  v_add_f32 v224, v224, v210
  v_exp_f32 v212, v116
  v_add_f32 v224, v224, v211
  v_cvt_pk_bf16_f32 v169, v210, v211
  v_exp_f32 v213, v117
  v_add_f32 v224, v224, v212
  v_exp_f32 v214, v118
  v_add_f32 v224, v224, v213
  v_cvt_pk_bf16_f32 v170, v212, v213
  v_exp_f32 v215, v119
  v_add_f32 v224, v224, v214
  v_exp_f32 v208, v120
  v_add_f32 v224, v224, v215
  v_cvt_pk_bf16_f32 v171, v214, v215
  v_exp_f32 v209, v121
  v_exp_f32 v210, v122
  v_add_f32 v225, v208, v209
  v_cvt_pk_bf16_f32 v172, v208, v209
  v_exp_f32 v211, v123
  v_add_f32 v225, v225, v210
  v_exp_f32 v212, v124
  v_add_f32 v225, v225, v211
  v_cvt_pk_bf16_f32 v173, v210, v211
  v_exp_f32 v213, v125
  v_add_f32 v225, v225, v212
  v_exp_f32 v214, v126
  v_add_f32 v225, v225, v213
  v_cvt_pk_bf16_f32 v174, v212, v213
  v_exp_f32 v215, v127
  v_add_f32 v225, v225, v214
  s_nop 0
  v_add_f32 v225, v225, v215
  v_cvt_pk_bf16_f32 v175, v214, v215
  s_nop 1
  s_setpc_b64 s[76:77]
fa_resc0:
  v_sub_f32 v192, v192, v16
  v_sub_f32 v193, v193, v16
  v_sub_f32 v194, v194, v16
  v_sub_f32 v195, v195, v16
  v_exp_f32 v18, -v16
  v_sub_f32 v196, v196, v17
  v_sub_f32 v197, v197, v17
  v_sub_f32 v198, v198, v17
  v_sub_f32 v199, v199, v17
  v_exp_f32 v19, -v17
  s_nop 0
  v_mul_f32 v228, v228, v18
  v_mul_f32 v229, v229, v19
  v_accvgpr_read_b32 v20, a0
  v_accvgpr_read_b32 v21, a1
  v_accvgpr_read_b32 v22, a2
  v_accvgpr_read_b32 v23, a3
  v_mul_f32 v20, v20, v18
  v_mul_f32 v21, v21, v18
  v_mul_f32 v22, v22, v18
  v_mul_f32 v23, v23, v18
  v_accvgpr_write_b32 a0, v20
  v_accvgpr_write_b32 a1, v21
  v_accvgpr_write_b32 a2, v22
  v_accvgpr_write_b32 a3, v23
  v_accvgpr_read_b32 v20, a4
  v_accvgpr_read_b32 v21, a5
  v_accvgpr_read_b32 v22, a6
  v_accvgpr_read_b32 v23, a7
  v_mul_f32 v20, v20, v19
  v_mul_f32 v21, v21, v19
  v_mul_f32 v22, v22, v19
  v_mul_f32 v23, v23, v19
  v_accvgpr_write_b32 a4, v20
  v_accvgpr_write_b32 a5, v21
  v_accvgpr_write_b32 a6, v22
  v_accvgpr_write_b32 a7, v23
  v_accvgpr_read_b32 v20, a8
  v_accvgpr_read_b32 v21, a9
  v_accvgpr_read_b32 v22, a10
  v_accvgpr_read_b32 v23, a11
  v_mul_f32 v20, v20, v18
  v_mul_f32 v21, v21, v18
  v_mul_f32 v22, v22, v18
  v_mul_f32 v23, v23, v18
  v_accvgpr_write_b32 a8, v20
  v_accvgpr_write_b32 a9, v21
  v_accvgpr_write_b32 a10, v22
  v_accvgpr_write_b32 a11, v23
  v_accvgpr_read_b32 v20, a12
  v_accvgpr_read_b32 v21, a13
  v_accvgpr_read_b32 v22, a14
  v_accvgpr_read_b32 v23, a15
  v_mul_f32 v20, v20, v19
  v_mul_f32 v21, v21, v19
  v_mul_f32 v22, v22, v19
  v_mul_f32 v23, v23, v19
  v_accvgpr_write_b32 a12, v20
  v_accvgpr_write_b32 a13, v21
  v_accvgpr_write_b32 a14, v22
  v_accvgpr_write_b32 a15, v23
  v_accvgpr_read_b32 v20, a16
  v_accvgpr_read_b32 v21, a17
  v_accvgpr_read_b32 v22, a18
  v_accvgpr_read_b32 v23, a19
  v_mul_f32 v20, v20, v18
  v_mul_f32 v21, v21, v18
  v_mul_f32 v22, v22, v18
  v_mul_f32 v23, v23, v18
  v_accvgpr_write_b32 a16, v20
  v_accvgpr_write_b32 a17, v21
  v_accvgpr_write_b32 a18, v22
  v_accvgpr_write_b32 a19, v23
  v_accvgpr_read_b32 v20, a20
  v_accvgpr_read_b32 v21, a21
  v_accvgpr_read_b32 v22, a22
  v_accvgpr_read_b32 v23, a23
  v_mul_f32 v20, v20, v19
  v_mul_f32 v21, v21, v19
  v_mul_f32 v22, v22, v19
  v_mul_f32 v23, v23, v19
  v_accvgpr_write_b32 a20, v20
  v_accvgpr_write_b32 a21, v21
  v_accvgpr_write_b32 a22, v22
  v_accvgpr_write_b32 a23, v23
  v_accvgpr_read_b32 v20, a24
  v_accvgpr_read_b32 v21, a25
  v_accvgpr_read_b32 v22, a26
  v_accvgpr_read_b32 v23, a27
  v_mul_f32 v20, v20, v18
  v_mul_f32 v21, v21, v18
  v_mul_f32 v22, v22, v18
  v_mul_f32 v23, v23, v18
  v_accvgpr_write_b32 a24, v20
  v_accvgpr_write_b32 a25, v21
  v_accvgpr_write_b32 a26, v22
  v_accvgpr_write_b32 a27, v23
  v_accvgpr_read_b32 v20, a28
  v_accvgpr_read_b32 v21, a29
  v_accvgpr_read_b32 v22, a30
  v_accvgpr_read_b32 v23, a31
  v_mul_f32 v20, v20, v19
  v_mul_f32 v21, v21, v19
  v_mul_f32 v22, v22, v19
  v_mul_f32 v23, v23, v19
  v_accvgpr_write_b32 a28, v20
  v_accvgpr_write_b32 a29, v21
  v_accvgpr_write_b32 a30, v22
  v_accvgpr_write_b32 a31, v23
  v_accvgpr_read_b32 v20, a32
  v_accvgpr_read_b32 v21, a33
  v_accvgpr_read_b32 v22, a34
  v_accvgpr_read_b32 v23, a35
  v_mul_f32 v20, v20, v18
  v_mul_f32 v21, v21, v18
  v_mul_f32 v22, v22, v18
  v_mul_f32 v23, v23, v18
  v_accvgpr_write_b32 a32, v20
  v_accvgpr_write_b32 a33, v21
  v_accvgpr_write_b32 a34, v22
  v_accvgpr_write_b32 a35, v23
  v_accvgpr_read_b32 v20, a36
  v_accvgpr_read_b32 v21, a37
  v_accvgpr_read_b32 v22, a38
  v_accvgpr_read_b32 v23, a39
  v_mul_f32 v20, v20, v19
  v_mul_f32 v21, v21, v19
  v_mul_f32 v22, v22, v19
  v_mul_f32 v23, v23, v19
  v_accvgpr_write_b32 a36, v20
  v_accvgpr_write_b32 a37, v21
  v_accvgpr_write_b32 a38, v22
  v_accvgpr_write_b32 a39, v23
  v_accvgpr_read_b32 v20, a40
  v_accvgpr_read_b32 v21, a41
  v_accvgpr_read_b32 v22, a42
  v_accvgpr_read_b32 v23, a43
  v_mul_f32 v20, v20, v18
  v_mul_f32 v21, v21, v18
  v_mul_f32 v22, v22, v18
  v_mul_f32 v23, v23, v18
  v_accvgpr_write_b32 a40, v20
  v_accvgpr_write_b32 a41, v21
  v_accvgpr_write_b32 a42, v22
  v_accvgpr_write_b32 a43, v23
  v_accvgpr_read_b32 v20, a44
  v_accvgpr_read_b32 v21, a45
  v_accvgpr_read_b32 v22, a46
  v_accvgpr_read_b32 v23, a47
  v_mul_f32 v20, v20, v19
  v_mul_f32 v21, v21, v19
  v_mul_f32 v22, v22, v19
  v_mul_f32 v23, v23, v19
  v_accvgpr_write_b32 a44, v20
  v_accvgpr_write_b32 a45, v21
  v_accvgpr_write_b32 a46, v22
  v_accvgpr_write_b32 a47, v23
  v_accvgpr_read_b32 v20, a48
  v_accvgpr_read_b32 v21, a49
  v_accvgpr_read_b32 v22, a50
  v_accvgpr_read_b32 v23, a51
  v_mul_f32 v20, v20, v18
  v_mul_f32 v21, v21, v18
  v_mul_f32 v22, v22, v18
  v_mul_f32 v23, v23, v18
  v_accvgpr_write_b32 a48, v20
  v_accvgpr_write_b32 a49, v21
  v_accvgpr_write_b32 a50, v22
  v_accvgpr_write_b32 a51, v23
  v_accvgpr_read_b32 v20, a52
  v_accvgpr_read_b32 v21, a53
  v_accvgpr_read_b32 v22, a54
  v_accvgpr_read_b32 v23, a55
  v_mul_f32 v20, v20, v19
  v_mul_f32 v21, v21, v19
  v_mul_f32 v22, v22, v19
  v_mul_f32 v23, v23, v19
  v_accvgpr_write_b32 a52, v20
  v_accvgpr_write_b32 a53, v21
  v_accvgpr_write_b32 a54, v22
  v_accvgpr_write_b32 a55, v23
  v_accvgpr_read_b32 v20, a56
  v_accvgpr_read_b32 v21, a57
  v_accvgpr_read_b32 v22, a58
  v_accvgpr_read_b32 v23, a59
  v_mul_f32 v20, v20, v18
  v_mul_f32 v21, v21, v18
  v_mul_f32 v22, v22, v18
  v_mul_f32 v23, v23, v18
  v_accvgpr_write_b32 a56, v20
  v_accvgpr_write_b32 a57, v21
  v_accvgpr_write_b32 a58, v22
  v_accvgpr_write_b32 a59, v23
  v_accvgpr_read_b32 v20, a60
  v_accvgpr_read_b32 v21, a61
  v_accvgpr_read_b32 v22, a62
  v_accvgpr_read_b32 v23, a63
  v_mul_f32 v20, v20, v19
  v_mul_f32 v21, v21, v19
  v_mul_f32 v22, v22, v19
  v_mul_f32 v23, v23, v19
  v_accvgpr_write_b32 a60, v20
  v_accvgpr_write_b32 a61, v21
  v_accvgpr_write_b32 a62, v22
  v_accvgpr_write_b32 a63, v23
  s_setpc_b64 s[78:79]
fa_rare10:
  s_nop 7
  v_max3_f32 v16, v128, v129, v130
  v_max3_f32 v16, v16, v131, v132
  v_max3_f32 v16, v16, v133, v134
  v_max3_f32 v16, v16, v135, 0
  v_mov_b32 v18, v16
  s_nop 1
  v_permlane16_swap_b32 v16, v18
  v_max_f32 v16, v16, v18
  v_mov_b32 v18, v16
  s_nop 1
  v_permlane32_swap_b32 v16, v18
  v_max_f32 v16, v16, v18
  v_sub_f32 v128, v128, v16
  v_sub_f32 v144, v144, v16
  v_sub_f32 v129, v129, v16
  v_sub_f32 v145, v145, v16
  v_sub_f32 v130, v130, v16
  v_sub_f32 v146, v146, v16
  v_sub_f32 v131, v131, v16
  v_sub_f32 v147, v147, v16
  v_sub_f32 v132, v132, v16
  v_sub_f32 v148, v148, v16
  v_sub_f32 v133, v133, v16
  v_sub_f32 v149, v149, v16
  v_sub_f32 v134, v134, v16
  v_sub_f32 v150, v150, v16
  v_sub_f32 v135, v135, v16
  v_sub_f32 v151, v151, v16
  v_max3_f32 v17, v136, v137, v138
  v_max3_f32 v17, v17, v139, v140
  v_max3_f32 v17, v17, v141, v142
  v_max3_f32 v17, v17, v143, 0
  v_mov_b32 v18, v17
  s_nop 1
  v_permlane16_swap_b32 v17, v18
  v_max_f32 v17, v17, v18
  v_mov_b32 v18, v17
  s_nop 1
  v_permlane32_swap_b32 v17, v18
  v_max_f32 v17, v17, v18
  v_sub_f32 v136, v136, v17
  v_sub_f32 v152, v152, v17
  v_sub_f32 v137, v137, v17
  v_sub_f32 v153, v153, v17
  v_sub_f32 v138, v138, v17
  v_sub_f32 v154, v154, v17
  v_sub_f32 v139, v139, v17
  v_sub_f32 v155, v155, v17
  v_sub_f32 v140, v140, v17
  v_sub_f32 v156, v156, v17
  v_sub_f32 v141, v141, v17
  v_sub_f32 v157, v157, v17
  v_sub_f32 v142, v142, v17
  v_sub_f32 v158, v158, v17
  v_sub_f32 v143, v143, v17
  v_sub_f32 v159, v159, v17
  s_call_b64 s[78:79], fa_resc1
  v_exp_f32 v216, v128
  v_exp_f32 v217, v129
  v_exp_f32 v218, v130
  v_add_f32 v226, v216, v217
  v_cvt_pk_bf16_f32 v176, v216, v217
  v_exp_f32 v219, v131
  v_add_f32 v226, v226, v218
  v_exp_f32 v220, v132
  v_add_f32 v226, v226, v219
  v_cvt_pk_bf16_f32 v177, v218, v219
  v_exp_f32 v221, v133
  v_add_f32 v226, v226, v220
  v_exp_f32 v222, v134
  v_add_f32 v226, v226, v221
  v_cvt_pk_bf16_f32 v178, v220, v221
  v_exp_f32 v223, v135
  v_add_f32 v226, v226, v222
  v_exp_f32 v216, v136
  v_add_f32 v226, v226, v223
  v_cvt_pk_bf16_f32 v179, v222, v223
  v_exp_f32 v217, v137
  v_exp_f32 v218, v138
  v_add_f32 v227, v216, v217
  v_cvt_pk_bf16_f32 v180, v216, v217
  v_exp_f32 v219, v139
  v_add_f32 v227, v227, v218
  v_exp_f32 v220, v140
  v_add_f32 v227, v227, v219
  v_cvt_pk_bf16_f32 v181, v218, v219
  v_exp_f32 v221, v141
  v_add_f32 v227, v227, v220
  v_exp_f32 v222, v142
  v_add_f32 v227, v227, v221
  v_cvt_pk_bf16_f32 v182, v220, v221
  v_exp_f32 v223, v143
  v_add_f32 v227, v227, v222
  s_nop 0
  v_add_f32 v227, v227, v223
  v_cvt_pk_bf16_f32 v183, v222, v223
  v_exp_f32 v216, v144
  s_nop 1
  s_setpc_b64 s[76:77]
fa_rare11:
  s_nop 7
  v_max3_f32 v16, v144, v145, v146
  v_max3_f32 v16, v16, v147, v148
  v_max3_f32 v16, v16, v149, v150
  v_max3_f32 v16, v16, v151, 0
  v_mov_b32 v18, v16
  s_nop 1
  v_permlane16_swap_b32 v16, v18
  v_max_f32 v16, v16, v18
  v_mov_b32 v18, v16
  s_nop 1
  v_permlane32_swap_b32 v16, v18
  v_max_f32 v16, v16, v18
  v_sub_f32 v144, v144, v16
  v_sub_f32 v128, v128, v16
  v_sub_f32 v145, v145, v16
  v_sub_f32 v129, v129, v16
  v_sub_f32 v146, v146, v16
  v_sub_f32 v130, v130, v16
  v_sub_f32 v147, v147, v16
  v_sub_f32 v131, v131, v16
  v_sub_f32 v148, v148, v16
  v_sub_f32 v132, v132, v16
  v_sub_f32 v149, v149, v16
  v_sub_f32 v133, v133, v16
  v_sub_f32 v150, v150, v16
  v_sub_f32 v134, v134, v16
  v_sub_f32 v151, v151, v16
  v_sub_f32 v135, v135, v16
  v_max3_f32 v17, v152, v153, v154
  v_max3_f32 v17, v17, v155, v156
  v_max3_f32 v17, v17, v157, v158
  v_max3_f32 v17, v17, v159, 0
  v_mov_b32 v18, v17
  s_nop 1
  v_permlane16_swap_b32 v17, v18
  v_max_f32 v17, v17, v18
  v_mov_b32 v18, v17
  s_nop 1
  v_permlane32_swap_b32 v17, v18
  v_max_f32 v17, v17, v18
  v_sub_f32 v152, v152, v17
  v_sub_f32 v136, v136, v17
  v_sub_f32 v153, v153, v17
  v_sub_f32 v137, v137, v17
  v_sub_f32 v154, v154, v17
  v_sub_f32 v138, v138, v17
  v_sub_f32 v155, v155, v17
  v_sub_f32 v139, v139, v17
  v_sub_f32 v156, v156, v17
  v_sub_f32 v140, v140, v17
  v_sub_f32 v157, v157, v17
  v_sub_f32 v141, v141, v17
  v_sub_f32 v158, v158, v17
  v_sub_f32 v142, v142, v17
  v_sub_f32 v159, v159, v17
  v_sub_f32 v143, v143, v17
  s_call_b64 s[78:79], fa_resc1
  v_exp_f32 v216, v144
  v_exp_f32 v217, v145
  v_exp_f32 v218, v146
  v_add_f32 v226, v216, v217
  v_cvt_pk_bf16_f32 v184, v216, v217
  v_exp_f32 v219, v147
  v_add_f32 v226, v226, v218
  v_exp_f32 v220, v148
  v_add_f32 v226, v226, v219
  v_cvt_pk_bf16_f32 v185, v218, v219
  v_exp_f32 v221, v149
  v_add_f32 v226, v226, v220
  v_exp_f32 v222, v150
  v_add_f32 v226, v226, v221
  v_cvt_pk_bf16_f32 v186, v220, v221
  v_exp_f32 v223, v151
  v_add_f32 v226, v226, v222
  v_exp_f32 v216, v152
  v_add_f32 v226, v226, v223
  v_cvt_pk_bf16_f32 v187, v222, v223
  v_exp_f32 v217, v153
  v_exp_f32 v218, v154
  v_add_f32 v227, v216, v217
  v_cvt_pk_bf16_f32 v188, v216, v217
  v_exp_f32 v219, v155
  v_add_f32 v227, v227, v218
  v_exp_f32 v220, v156
  v_add_f32 v227, v227, v219
  v_cvt_pk_bf16_f32 v189, v218, v219
  v_exp_f32 v221, v157
  v_add_f32 v227, v227, v220
  v_exp_f32 v222, v158
  v_add_f32 v227, v227, v221
  v_cvt_pk_bf16_f32 v190, v220, v221
  v_exp_f32 v223, v159
  v_add_f32 v227, v227, v222
  s_nop 0
  v_add_f32 v227, v227, v223
  v_cvt_pk_bf16_f32 v191, v222, v223
  v_exp_f32 v216, v128
  s_nop 1
  s_setpc_b64 s[76:77]
fa_resc1:
  v_sub_f32 v200, v200, v16
  v_sub_f32 v201, v201, v16
  v_sub_f32 v202, v202, v16
  v_sub_f32 v203, v203, v16
  v_exp_f32 v18, -v16
  v_sub_f32 v204, v204, v17
  v_sub_f32 v205, v205, v17
  v_sub_f32 v206, v206, v17
  v_sub_f32 v207, v207, v17
  v_exp_f32 v19, -v17
  s_nop 0
  v_mul_f32 v230, v230, v18
  v_mul_f32 v231, v231, v19
  v_accvgpr_read_b32 v20, a64
  v_accvgpr_read_b32 v21, a65
  v_accvgpr_read_b32 v22, a66
  v_accvgpr_read_b32 v23, a67
  v_mul_f32 v20, v20, v18
  v_mul_f32 v21, v21, v18
  v_mul_f32 v22, v22, v18
  v_mul_f32 v23, v23, v18
  v_accvgpr_write_b32 a64, v20
  v_accvgpr_write_b32 a65, v21
  v_accvgpr_write_b32 a66, v22
  v_accvgpr_write_b32 a67, v23
  v_accvgpr_read_b32 v20, a68
  v_accvgpr_read_b32 v21, a69
  v_accvgpr_read_b32 v22, a70
  v_accvgpr_read_b32 v23, a71
  v_mul_f32 v20, v20, v19
  v_mul_f32 v21, v21, v19
  v_mul_f32 v22, v22, v19
  v_mul_f32 v23, v23, v19
  v_accvgpr_write_b32 a68, v20
  v_accvgpr_write_b32 a69, v21
  v_accvgpr_write_b32 a70, v22
  v_accvgpr_write_b32 a71, v23
  v_accvgpr_read_b32 v20, a72
  v_accvgpr_read_b32 v21, a73
  v_accvgpr_read_b32 v22, a74
  v_accvgpr_read_b32 v23, a75
  v_mul_f32 v20, v20, v18
  v_mul_f32 v21, v21, v18
  v_mul_f32 v22, v22, v18
  v_mul_f32 v23, v23, v18
  v_accvgpr_write_b32 a72, v20
  v_accvgpr_write_b32 a73, v21
  v_accvgpr_write_b32 a74, v22
  v_accvgpr_write_b32 a75, v23
  v_accvgpr_read_b32 v20, a76
  v_accvgpr_read_b32 v21, a77
  v_accvgpr_read_b32 v22, a78
  v_accvgpr_read_b32 v23, a79
  v_mul_f32 v20, v20, v19
  v_mul_f32 v21, v21, v19
  v_mul_f32 v22, v22, v19
  v_mul_f32 v23, v23, v19
  v_accvgpr_write_b32 a76, v20
  v_accvgpr_write_b32 a77, v21
  v_accvgpr_write_b32 a78, v22
  v_accvgpr_write_b32 a79, v23
  v_accvgpr_read_b32 v20, a80
  v_accvgpr_read_b32 v21, a81
  v_accvgpr_read_b32 v22, a82
  v_accvgpr_read_b32 v23, a83
  v_mul_f32 v20, v20, v18
  v_mul_f32 v21, v21, v18
  v_mul_f32 v22, v22, v18
  v_mul_f32 v23, v23, v18
  v_accvgpr_write_b32 a80, v20
  v_accvgpr_write_b32 a81, v21
  v_accvgpr_write_b32 a82, v22
  v_accvgpr_write_b32 a83, v23
  v_accvgpr_read_b32 v20, a84
  v_accvgpr_read_b32 v21, a85
  v_accvgpr_read_b32 v22, a86
  v_accvgpr_read_b32 v23, a87
  v_mul_f32 v20, v20, v19
  v_mul_f32 v21, v21, v19
  v_mul_f32 v22, v22, v19
  v_mul_f32 v23, v23, v19
  v_accvgpr_write_b32 a84, v20
  v_accvgpr_write_b32 a85, v21
  v_accvgpr_write_b32 a86, v22
  v_accvgpr_write_b32 a87, v23
  v_accvgpr_read_b32 v20, a88
  v_accvgpr_read_b32 v21, a89
  v_accvgpr_read_b32 v22, a90
  v_accvgpr_read_b32 v23, a91
  v_mul_f32 v20, v20, v18
  v_mul_f32 v21, v21, v18
  v_mul_f32 v22, v22, v18
  v_mul_f32 v23, v23, v18
  v_accvgpr_write_b32 a88, v20
  v_accvgpr_write_b32 a89, v21
  v_accvgpr_write_b32 a90, v22
  v_accvgpr_write_b32 a91, v23
  v_accvgpr_read_b32 v20, a92
  v_accvgpr_read_b32 v21, a93
  v_accvgpr_read_b32 v22, a94
  v_accvgpr_read_b32 v23, a95
  v_mul_f32 v20, v20, v19
  v_mul_f32 v21, v21, v19
  v_mul_f32 v22, v22, v19
  v_mul_f32 v23, v23, v19
  v_accvgpr_write_b32 a92, v20
  v_accvgpr_write_b32 a93, v21
  v_accvgpr_write_b32 a94, v22
  v_accvgpr_write_b32 a95, v23
  v_accvgpr_read_b32 v20, a96
  v_accvgpr_read_b32 v21, a97
  v_accvgpr_read_b32 v22, a98
  v_accvgpr_read_b32 v23, a99
  v_mul_f32 v20, v20, v18
  v_mul_f32 v21, v21, v18
  v_mul_f32 v22, v22, v18
  v_mul_f32 v23, v23, v18
  v_accvgpr_write_b32 a96, v20
  v_accvgpr_write_b32 a97, v21
  v_accvgpr_write_b32 a98, v22
  v_accvgpr_write_b32 a99, v23
  v_accvgpr_read_b32 v20, a100
  v_accvgpr_read_b32 v21, a101
  v_accvgpr_read_b32 v22, a102
  v_accvgpr_read_b32 v23, a103
  v_mul_f32 v20, v20, v19
  v_mul_f32 v21, v21, v19
  v_mul_f32 v22, v22, v19
  v_mul_f32 v23, v23, v19
  v_accvgpr_write_b32 a100, v20
  v_accvgpr_write_b32 a101, v21
  v_accvgpr_write_b32 a102, v22
  v_accvgpr_write_b32 a103, v23
  v_accvgpr_read_b32 v20, a104
  v_accvgpr_read_b32 v21, a105
  v_accvgpr_read_b32 v22, a106
  v_accvgpr_read_b32 v23, a107
  v_mul_f32 v20, v20, v18
  v_mul_f32 v21, v21, v18
  v_mul_f32 v22, v22, v18
  v_mul_f32 v23, v23, v18
  v_accvgpr_write_b32 a104, v20
  v_accvgpr_write_b32 a105, v21
  v_accvgpr_write_b32 a106, v22
  v_accvgpr_write_b32 a107, v23
  v_accvgpr_read_b32 v20, a108
  v_accvgpr_read_b32 v21, a109
  v_accvgpr_read_b32 v22, a110
  v_accvgpr_read_b32 v23, a111
  v_mul_f32 v20, v20, v19
  v_mul_f32 v21, v21, v19
  v_mul_f32 v22, v22, v19
  v_mul_f32 v23, v23, v19
  v_accvgpr_write_b32 a108, v20
  v_accvgpr_write_b32 a109, v21
  v_accvgpr_write_b32 a110, v22
  v_accvgpr_write_b32 a111, v23
  v_accvgpr_read_b32 v20, a112
  v_accvgpr_read_b32 v21, a113
  v_accvgpr_read_b32 v22, a114
  v_accvgpr_read_b32 v23, a115
  v_mul_f32 v20, v20, v18
  v_mul_f32 v21, v21, v18
  v_mul_f32 v22, v22, v18
  v_mul_f32 v23, v23, v18
  v_accvgpr_write_b32 a112, v20
  v_accvgpr_write_b32 a113, v21
  v_accvgpr_write_b32 a114, v22
  v_accvgpr_write_b32 a115, v23
  v_accvgpr_read_b32 v20, a116
  v_accvgpr_read_b32 v21, a117
  v_accvgpr_read_b32 v22, a118
  v_accvgpr_read_b32 v23, a119
  v_mul_f32 v20, v20, v19
  v_mul_f32 v21, v21, v19
  v_mul_f32 v22, v22, v19
  v_mul_f32 v23, v23, v19
  v_accvgpr_write_b32 a116, v20
  v_accvgpr_write_b32 a117, v21
  v_accvgpr_write_b32 a118, v22
  v_accvgpr_write_b32 a119, v23
  v_accvgpr_read_b32 v20, a120
  v_accvgpr_read_b32 v21, a121
  v_accvgpr_read_b32 v22, a122
  v_accvgpr_read_b32 v23, a123
  v_mul_f32 v20, v20, v18
  v_mul_f32 v21, v21, v18
  v_mul_f32 v22, v22, v18
  v_mul_f32 v23, v23, v18
  v_accvgpr_write_b32 a120, v20
  v_accvgpr_write_b32 a121, v21
  v_accvgpr_write_b32 a122, v22
  v_accvgpr_write_b32 a123, v23
  v_accvgpr_read_b32 v20, a124
  v_accvgpr_read_b32 v21, a125
  v_accvgpr_read_b32 v22, a126
  v_accvgpr_read_b32 v23, a127
  v_mul_f32 v20, v20, v19
  v_mul_f32 v21, v21, v19
  v_mul_f32 v22, v22, v19
  v_mul_f32 v23, v23, v19
  v_accvgpr_write_b32 a124, v20
  v_accvgpr_write_b32 a125, v21
  v_accvgpr_write_b32 a126, v22
  v_accvgpr_write_b32 a127, v23
  s_setpc_b64 s[78:79]
.section .rodata,"a"
.p2align 6
.amdhsa_kernel fa_kernel
  .amdhsa_next_free_vgpr 512
  .amdhsa_next_free_sgpr 102
  .amdhsa_accum_offset 256
  .amdhsa_group_segment_fixed_size 0
  .amdhsa_kernarg_size 112
  .amdhsa_user_sgpr_count 2
  .amdhsa_user_sgpr_kernarg_segment_ptr 1
  .amdhsa_system_sgpr_workgroup_id_x 1
  .amdhsa_float_denorm_mode_32 3
.end_amdhsa_kernel
.text
```

```asm
; @launch kernel=fa_kernel grid=(256,1,1) block=(256,1,1) lds=163840
.amdgcn_target "amdgcn-amd-amdhsa--gfx950"
.text
.globl fa_kernel
.p2align 8
.type fa_kernel,@function
fa_kernel:
  s_cmp_ge_u32 s2, 256
  s_cbranch_scc1 fa_end
  s_getpc_b64 s[62:63]
  v_and_b32 v230, 127, v0
  v_lshlrev_b32 v230, 7, v230
  global_load_dword v231, v230, s[62:63]
  s_load_dwordx4 s[4:7], s[0:1], 0
  s_load_dwordx4 s[8:11], s[0:1], 24
  s_load_dwordx2 s[14:15], s[0:1], 56
  s_load_dwordx2 s[12:13], s[0:1], 40
  s_load_dwordx4 s[16:19], s[0:1], 96
  s_load_dwordx2 s[60:61], s[0:1], 16
  v_lshrrev_b32 v16, 6, v0
  v_and_b32 v1, 63, v0
  v_readfirstlane_b32 s20, v16
  s_and_b32 s21, s2, 7
  s_lshl_b32 s21, s21, 2
  s_lshr_b32 s23, s2, 3
  s_and_b32 s23, s23, 3
  s_add_u32 s21, s21, s23
  s_lshr_b32 s22, s2, 5
  v_and_b32 v208, 31, v1
  v_lshrrev_b32 v209, 5, v1
  s_lshl_b32 s31, s2, 2
  s_add_u32 s31, s31, s20
  s_lshl_b32 s31, s31, 1
  v_add_u32 v209, s31, v209
  v_lshlrev_b32 v212, 4, v208
  v_mul_u32_u24 v210, 1280, v209
  v_add_u32 v210, v210, v212
  v_cmp_gt_u32 s[64:65], 16, v208
  v_mov_b32 v19, 1073741824
  v_and_b32 v220, 7, v209
  v_cndmask_b32 v211, v19, v210, s[64:65]
  v_bfe_u32 v17, v1, 1, 3
  v_lshlrev_b32 v17, 13, v17
  v_and_b32 v18, 1, v1
  v_lshl_add_u32 v235, v18, 7, v17
  s_lshl_b32 s74, s22, 1
  s_and_b32 s31, s20, 1
  s_add_u32 s74, s74, s31
  s_lshl_b32 s74, s74, 16
  s_mov_b32 s73, 1048576
  v_and_b32 v16, 15, v1
  v_lshlrev_b32 v17, 10, v16
  v_and_b32 v18, 16, v1
  v_lshl_add_u32 v233, v18, 3, v17
  s_lshl_b32 s30, s23, 2
  s_add_u32 s30, s30, s20
  s_lshl_b32 s30, s30, 14
  s_lshl_b32 s29, s22, 18
  s_lshl_b32 s23, s21, 8
  s_cmp_ge_u32 s20, 2
  s_waitcnt lgkmcnt(0)
  s_mov_b32 s44, s4
  s_mov_b32 s45, s5
  s_mov_b32 s46, 2621440
  s_mov_b32 s47, 0x20000
  s_mov_b32 s68, s14
  s_mov_b32 s69, s15
  s_mov_b32 s70, 1280
  s_mov_b32 s71, 0x20000
  buffer_load_dwordx4 v[160:163], v210, s[44:47], 0 offen
  buffer_load_dwordx4 v[164:167], v210, s[44:47], 0 offen offset:512
  buffer_load_dwordx4 v[168:171], v211, s[44:47], 0 offen offset:1024
  buffer_load_dwordx4 v[172:175], v212, s[68:71], 0 offen offset:0
  buffer_load_dwordx4 v[176:179], v212, s[68:71], 0 offen offset:512
  buffer_load_dwordx4 v[180:183], v212, s[68:71], 0 offen offset:1024
  s_cselect_b32 s62, s10, s8
  s_cselect_b32 s63, s11, s9
  s_add_u32 s62, s62, s23
  s_addc_u32 s63, s63, 0
  s_mov_b32 s36, s62
  s_mov_b32 s37, s63
  s_mov_b32 s38, 0
  s_mov_b32 s39, 0x20000
  s_sub_u32 s38, 4194304, s23
  buffer_load_dword v231, v235, s[36:39], s74 offen
  s_add_u32 s6, s6, s29
  s_addc_u32 s7, s7, 0
  s_mov_b32 s32, s6
  s_mov_b32 s33, s7
  s_mov_b32 s34, 262144
  s_mov_b32 s35, 0x20000
  buffer_load_dword v232, v233, s[32:35], s30 offen
  s_add_u32 s74, s74, s73
  buffer_load_dword v231, v235, s[36:39], s74 offen
  buffer_load_dword v232, v233, s[32:35], s30 offen offset:256
  s_getpc_b64 s[8:9]
fa_pc:
  s_lshr_b32 s31, s2, 3
  s_and_b32 s31, s31, 15
  s_lshl_b32 s31, s31, 2
  s_add_u32 s31, s31, s20
  s_lshl_b32 s31, s31, 11
  s_min_u32 s31, s31, fa_codeend-fa_pc-2048
  v_lshlrev_b32 v234, 7, v16
  v_add_u32 v230, s31, v234
  global_load_dword v231, v230, s[8:9]
  s_add_u32 s8, s8, fa_co1-fa_pc-4
  s_addc_u32 s9, s9, 0
  s_add_u32 s60, s60, s23
  s_addc_u32 s61, s61, 0
  s_sub_u32 s75, 5242880, s23
  s_mov_b32 s48, s62
  s_mov_b32 s49, s63
  s_mov_b32 s50, s38
  s_mov_b32 s51, 0x20000
  v_lshlrev_b32 v2, 4, v1
  v_lshrrev_b32 v19, 2, v1
  v_lshrrev_b32 v17, 5, v1
  v_mul_u32_u24 v17, 3, v17
  v_and_b32 v18, 3, v1
  v_xor_b32 v17, v17, v18
  v_lshlrev_b32 v17, 4, v17
  v_lshl_add_u32 v3, v19, 10, v17
  s_lshl_b32 s23, s20, 16
  v_add_u32 v3, s23, v3
  v_add_u32 v4, 15360, v3
  v_add_u32 v5, 30720, v3
  v_add_u32 v6, 46080, v3
  v_and_b32 v19, 3, v19
  v_lshrrev_b32 v17, 4, v1
  v_lshlrev_b32 v17, 6, v17
  v_lshl_add_u32 v19, v19, 13, v17
  s_and_b32 s23, s20, 1
  s_lshl_b32 s23, s23, 17
  v_add_u32 v19, s23, v19
  v_lshl_add_u32 v8, v18, 4, v19
  v_xor_b32 v18, 2, v18
  v_lshl_add_u32 v10, v18, 4, v19
  v_add_u32 v9, 31744, v8
  v_add_u32 v11, 95232, v10
  v_add_u32 v10, 63488, v10
  s_lshl_b32 s24, s20, 12
  s_mov_b32 s26, 0
  s_mov_b32 s27, 0
  s_mov_b32 s25, 262144
  s_mov_b32 s79, 64
  s_mov_b32 s40, s18
  s_mov_b32 s41, s19
  s_mov_b32 s42, 67108864
  s_mov_b32 s43, 0x20000
  s_mov_b32 s52, s12
  s_mov_b32 s53, s13
  s_mov_b32 s54, 5242880
  s_mov_b32 s55, 0x20000
  s_mov_b32 s56, s16
  s_mov_b32 s57, s17
  s_mov_b32 s58, 256
  s_mov_b32 s59, 0x20000
  s_and_b32 s29, s2, 31
  s_lshl_b32 s29, s29, 2
  s_add_u32 s29, s29, s20
  s_lshl_b32 s29, s29, 11
  s_lshl_b32 s23, s20, 5
  s_add_u32 s23, s23, s21
  s_lshl_b32 s23, s23, 2
  s_add_u32 s23, s23, 2641920
  s_lshl_b32 s31, s22, 9
  s_add_u32 s80, s23, s31
  s_sub_u32 s31, 7680, s31
  s_add_u32 s3, s23, s31
  s_lshl_b32 s23, s21, 7
  s_lshl_b32 s31, s22, 2
  s_add_u32 s23, s23, s31
  s_add_u32 s82, s23, 2637824
  s_sub_u32 s62, s2, 170
  s_lshl_b32 s31, s20, 6
  s_add_u32 s62, s62, s31
  s_lshl_b32 s62, s62, 2
  s_add_u32 s62, s62, 2650112
  s_sub_u32 s23, s2, 170
  s_cmp_lt_u32 s23, 54
  s_cselect_b32 s62, s62, 1073741824
  s_cmp_eq_u32 s20, 0
  s_cselect_b32 s31, s82, 1073741824
  s_cselect_b32 s77, s2, 1073741824
  s_cmp_eq_u32 s2, 255
  s_cselect_b32 s23, 2629632, 1073741824
  v_lshl_add_u32 v225, v16, 2, s23
  v_mov_b32 v229, 0
  v_writelane_b32 v225, s80, 0
  v_writelane_b32 v225, s3, 1
  v_writelane_b32 v225, s31, 2
  s_and_b32 s23, s2, 1
  s_lshl_b32 s23, s23, 2
  s_add_u32 s23, s23, s20
  s_lshl_b32 s23, s23, 7
  s_lshr_b32 s31, s2, 1
  s_add_u32 s23, s23, s31
  s_lshl_b32 s23, s23, 2
  s_add_u32 s23, s23, 2654208
  v_writelane_b32 v225, s23, 3
  v_writelane_b32 v225, s62, 4
  s_and_b32 s23, s21, 3
  s_lshr_b32 s31, s23, 1
  s_lshl_b32 s31, 4, s31
  s_bitcmp1_b32 s23, 0
  s_cselect_b32 s76, s31, 0
  s_cselect_b32 s72, 0, s31
  s_or_b32 s76, s76, 0x20
  s_or_b32 s72, s72, 0x25
  v_mov_b32 v20, 0
  v_mov_b32 v21, 0
  v_mov_b32 v22, 0
  v_mov_b32 v23, 0
  v_lshrrev_b32 v17, 4, v1
  v_lshrrev_b32 v18, 3, v16
  v_mul_u32_u24 v18, 3, v18
  v_xor_b32 v18, v18, v17
  v_lshlrev_b32 v18, 4, v18
  v_lshl_add_u32 v14, v16, 6, v18
  s_and_b32 s23, s20, 1
  s_lshl_b32 s23, s23, 13
  v_add_u32 v14, s23, v14
  v_mfma_f32_32x32x16_bf16 a[0:15], v[20:23], v[20:23], 0
  v_lshrrev_b32 v18, 2, v16
  v_lshlrev_b32 v18, 6, v18
  v_lshl_add_u32 v18, v17, 11, v18
  v_and_b32 v19, 1, v1
  v_mfma_f32_32x32x16_bf16 a[16:31], v[20:23], v[20:23], 0
  v_lshl_add_u32 v18, v19, 3, v18
  v_bfe_u32 v19, v1, 1, 1
  v_and_b32 v17, 1, v17
  v_lshl_or_b32 v19, v17, 1, v19
  v_mfma_f32_32x32x16_bf16 a[32:47], v[20:23], v[20:23], 0
  s_lshr_b32 s23, s20, 1
  s_lshl_b32 s23, s23, 13
  s_add_u32 s23, s23, 16384
  v_add_u32 v18, s23, v18
  v_mfma_f32_32x32x16_bf16 a[48:63], v[20:23], v[20:23], 0
  v_lshl_add_u32 v12, v19, 4, v18
  v_xor_b32 v13, 32, v12
  v_mov_b32 v19, 1073741824
  v_lshlrev_b32 v220, 4, v220
  v_mfma_f32_32x32x16_bf16 a[64:79], v[20:23], v[20:23], 0
  v_lshl_add_u32 v220, v208, 7, v220
  v_add_u32 v220, 131072, v220
  v_lshlrev_b32 v222, 2, v209
  v_cmp_eq_u32 vcc, 0, v208
  v_mfma_f32_32x32x16_bf16 a[80:95], v[20:23], v[20:23], 0
  v_add_u32 v222, 2621440, v222
  v_lshlrev_b32 v221, 4, v0
  v_cndmask_b32 v222, v19, v222, vcc
  v_add_u32 v221, 131072, v221
  v_mfma_f32_32x32x16_bf16 a[96:111], v[20:23], v[20:23], 0
  v_sub_u32 v209, 0xffff, v209
  v_lshrrev_b32 v223, 3, v0
  v_and_b32 v18, 7, v0
  v_lshlrev_b32 v18, 4, v18
  v_mfma_f32_32x32x16_bf16 a[112:127], v[20:23], v[20:23], 0
  v_cmp_gt_u32 vcc, 128, v0
  v_lshl_add_u32 v223, v223, 8, v18
  s_lshr_b32 s66, s2, 1
  s_mul_i32 s66, s66, 20480
  v_mfma_f32_32x32x16_bf16 a[128:143], v[20:23], v[20:23], 0
  s_and_b32 s31, s2, 1
  s_lshl_b32 s31, s31, 7
  s_add_u32 s66, s66, s31
  v_cndmask_b32 v224, v19, v223, vcc
  v_mfma_f32_32x32x16_bf16 a[144:159], v[20:23], v[20:23], 0
  s_add_u32 s67, s66, 8192
  s_add_u32 s78, s66, 16384
  s_mov_b32 s28, 0
  v_mfma_f32_32x32x16_bf16 a[160:175], v[20:23], v[20:23], 0
  v_mfma_f32_32x32x16_bf16 a[176:191], v[20:23], v[20:23], 0
  v_mfma_f32_32x32x16_bf16 a[192:207], v[20:23], v[20:23], 0
  v_mfma_f32_32x32x16_bf16 a[208:223], v[20:23], v[20:23], 0
  v_mfma_f32_32x32x16_bf16 a[224:239], v[20:23], v[20:23], 0
  v_mfma_f32_32x32x16_bf16 a[240:255], v[20:23], v[20:23], 0
  s_waitcnt vmcnt(5)
  v_lshlrev_b32 v184, 16, v160
  v_and_b32 v185, 0xffff0000, v160
  v_lshlrev_b32 v186, 16, v161
  v_and_b32 v187, 0xffff0000, v161
  v_lshlrev_b32 v188, 16, v162
  v_and_b32 v189, 0xffff0000, v162
  v_lshlrev_b32 v190, 16, v163
  v_and_b32 v191, 0xffff0000, v163
  v_lshlrev_b32 v192, 16, v164
  v_and_b32 v193, 0xffff0000, v164
  v_lshlrev_b32 v194, 16, v165
  v_and_b32 v195, 0xffff0000, v165
  v_lshlrev_b32 v196, 16, v166
  v_and_b32 v197, 0xffff0000, v166
  v_lshlrev_b32 v198, 16, v167
  v_and_b32 v199, 0xffff0000, v167
  v_lshlrev_b32 v200, 16, v168
  v_and_b32 v201, 0xffff0000, v168
  v_lshlrev_b32 v202, 16, v169
  v_and_b32 v203, 0xffff0000, v169
  v_lshlrev_b32 v204, 16, v170
  v_and_b32 v205, 0xffff0000, v170
  v_lshlrev_b32 v206, 16, v171
  v_and_b32 v207, 0xffff0000, v171
  v_pk_add_f32 v[16:17], v[184:185], v[186:187]
  v_pk_add_f32 v[18:19], v[188:189], v[190:191]
  v_pk_add_f32 v[16:17], v[16:17], v[192:193]
  v_pk_add_f32 v[18:19], v[18:19], v[194:195]
  v_pk_add_f32 v[16:17], v[16:17], v[196:197]
  v_pk_add_f32 v[18:19], v[18:19], v[198:199]
  v_pk_add_f32 v[16:17], v[16:17], v[200:201]
  v_pk_add_f32 v[18:19], v[18:19], v[202:203]
  v_pk_add_f32 v[16:17], v[16:17], v[204:205]
  v_pk_add_f32 v[18:19], v[18:19], v[206:207]
  v_pk_add_f32 v[16:17], v[16:17], v[18:19]
  v_add_f32 v213, v16, v17
  s_nop 1
  v_add_f32_dpp v213, v213, v213 quad_perm:[1,0,3,2] row_mask:0xf bank_mask:0xf
  s_nop 1
  v_add_f32_dpp v213, v213, v213 quad_perm:[2,3,0,1] row_mask:0xf bank_mask:0xf
  s_nop 1
  v_add_f32_dpp v213, v213, v213 row_half_mirror row_mask:0xf bank_mask:0xf
  s_nop 1
  v_add_f32_dpp v213, v213, v213 row_mirror row_mask:0xf bank_mask:0xf
  v_mov_b32 v214, v213
  s_nop 1
  v_permlane16_swap_b32 v213, v214
  v_add_f32 v213, v213, v214
  v_mul_f32 v216, 0xbacccccd, v213
  v_mul_f32 v217, 0xbacccccd, v213
  v_pk_add_f32 v[20:21], v[184:185], v[216:217]
  v_pk_mul_f32 v[16:17], v[20:21], v[20:21]
  v_pk_add_f32 v[22:23], v[186:187], v[216:217]
  v_pk_fma_f32 v[16:17], v[22:23], v[22:23], v[16:17]
  v_pk_add_f32 v[24:25], v[188:189], v[216:217]
  v_pk_fma_f32 v[16:17], v[24:25], v[24:25], v[16:17]
  v_pk_add_f32 v[26:27], v[190:191], v[216:217]
  v_pk_fma_f32 v[16:17], v[26:27], v[26:27], v[16:17]
  v_pk_add_f32 v[20:21], v[192:193], v[216:217]
  v_pk_fma_f32 v[16:17], v[20:21], v[20:21], v[16:17]
  v_pk_add_f32 v[22:23], v[194:195], v[216:217]
  v_pk_fma_f32 v[16:17], v[22:23], v[22:23], v[16:17]
  v_pk_add_f32 v[24:25], v[196:197], v[216:217]
  v_pk_fma_f32 v[16:17], v[24:25], v[24:25], v[16:17]
  v_pk_add_f32 v[26:27], v[198:199], v[216:217]
  v_pk_fma_f32 v[16:17], v[26:27], v[26:27], v[16:17]
  v_pk_add_f32 v[20:21], v[200:201], v[216:217]
  v_pk_mul_f32 v[18:19], v[20:21], v[20:21]
  v_pk_add_f32 v[22:23], v[202:203], v[216:217]
  v_pk_fma_f32 v[18:19], v[22:23], v[22:23], v[18:19]
  v_pk_add_f32 v[24:25], v[204:205], v[216:217]
  v_pk_fma_f32 v[18:19], v[24:25], v[24:25], v[18:19]
  v_pk_add_f32 v[26:27], v[206:207], v[216:217]
  v_pk_fma_f32 v[18:19], v[26:27], v[26:27], v[18:19]
  v_add_f32 v18, v18, v19
  v_add_f32 v213, v16, v17
  v_cndmask_b32 v18, 0, v18, s[64:65]
  v_add_f32 v213, v213, v18
  s_nop 1
  v_add_f32_dpp v213, v213, v213 quad_perm:[1,0,3,2] row_mask:0xf bank_mask:0xf
  s_nop 1
  v_add_f32_dpp v213, v213, v213 quad_perm:[2,3,0,1] row_mask:0xf bank_mask:0xf
  s_nop 1
  v_add_f32_dpp v213, v213, v213 row_half_mirror row_mask:0xf bank_mask:0xf
  s_nop 1
  v_add_f32_dpp v213, v213, v213 row_mirror row_mask:0xf bank_mask:0xf
  v_mov_b32 v214, v213
  s_nop 1
  v_permlane16_swap_b32 v213, v214
  v_add_f32 v213, v213, v214
  v_mul_f32 v213, 0x3acccccd, v213
  v_cvt_pk_bf16_f32 v213, v213, v213
  v_and_b32 v213, 0xffff0000, v213
  v_add_f32 v213, 0x3727c5ac, v213
  v_cvt_pk_bf16_f32 v213, v213, v213
  v_and_b32 v213, 0xffff0000, v213
  v_sqrt_f32 v213, v213
  v_cvt_pk_bf16_f32 v216, v216, v216
  v_and_b32 v216, 0xffff0000, v216
  v_cvt_pk_bf16_f32 v213, v213, v213
  v_and_b32 v213, 0xffff0000, v213
  v_rcp_f32 v28, v213
  v_mov_b32 v217, v216
  v_mov_b32 v29, v28
  v_pk_add_f32 v[184:185], v[184:185], v[216:217]
  v_lshlrev_b32 v16, 16, v172
  v_cvt_pk_bf16_f32 v185, v184, v185
  v_and_b32 v17, 0xffff0000, v172
  v_lshlrev_b32 v184, 16, v185
  v_and_b32 v185, 0xffff0000, v185
  v_pk_mul_f32 v[184:185], v[184:185], v[28:29]
  v_cvt_pk_bf16_f32 v160, v184, v185
  v_lshlrev_b32 v184, 16, v160
  v_and_b32 v185, 0xffff0000, v160
  v_pk_mul_f32 v[218:219], v[184:185], v[16:17]
  v_pk_add_f32 v[186:187], v[186:187], v[216:217]
  v_lshlrev_b32 v18, 16, v173
  v_cvt_pk_bf16_f32 v187, v186, v187
  v_and_b32 v19, 0xffff0000, v173
  v_lshlrev_b32 v186, 16, v187
  v_and_b32 v187, 0xffff0000, v187
  v_pk_mul_f32 v[186:187], v[186:187], v[28:29]
  v_cvt_pk_bf16_f32 v161, v186, v187
  v_lshlrev_b32 v186, 16, v161
  v_and_b32 v187, 0xffff0000, v161
  v_pk_fma_f32 v[218:219], v[186:187], v[18:19], v[218:219]
  v_pk_add_f32 v[188:189], v[188:189], v[216:217]
  v_lshlrev_b32 v16, 16, v174
  v_cvt_pk_bf16_f32 v189, v188, v189
  v_and_b32 v17, 0xffff0000, v174
  v_lshlrev_b32 v188, 16, v189
  v_and_b32 v189, 0xffff0000, v189
  v_pk_mul_f32 v[188:189], v[188:189], v[28:29]
  v_cvt_pk_bf16_f32 v162, v188, v189
  v_lshlrev_b32 v188, 16, v162
  v_and_b32 v189, 0xffff0000, v162
  v_pk_fma_f32 v[218:219], v[188:189], v[16:17], v[218:219]
  v_pk_add_f32 v[190:191], v[190:191], v[216:217]
  v_lshlrev_b32 v18, 16, v175
  v_cvt_pk_bf16_f32 v191, v190, v191
  v_and_b32 v19, 0xffff0000, v175
  v_lshlrev_b32 v190, 16, v191
  v_and_b32 v191, 0xffff0000, v191
  v_pk_mul_f32 v[190:191], v[190:191], v[28:29]
  v_cvt_pk_bf16_f32 v163, v190, v191
  v_lshlrev_b32 v190, 16, v163
  v_and_b32 v191, 0xffff0000, v163
  v_pk_fma_f32 v[218:219], v[190:191], v[18:19], v[218:219]
  ds_write_b128 v220, v[160:163] offset:0
  v_pk_add_f32 v[192:193], v[192:193], v[216:217]
  v_lshlrev_b32 v16, 16, v176
  v_cvt_pk_bf16_f32 v193, v192, v193
  v_and_b32 v17, 0xffff0000, v176
  v_lshlrev_b32 v192, 16, v193
  v_and_b32 v193, 0xffff0000, v193
  v_pk_mul_f32 v[192:193], v[192:193], v[28:29]
  v_cvt_pk_bf16_f32 v164, v192, v193
  v_lshlrev_b32 v192, 16, v164
  v_and_b32 v193, 0xffff0000, v164
  v_pk_fma_f32 v[218:219], v[192:193], v[16:17], v[218:219]
  v_pk_add_f32 v[194:195], v[194:195], v[216:217]
  v_lshlrev_b32 v18, 16, v177
  v_cvt_pk_bf16_f32 v195, v194, v195
  v_and_b32 v19, 0xffff0000, v177
  v_lshlrev_b32 v194, 16, v195
  v_and_b32 v195, 0xffff0000, v195
  v_pk_mul_f32 v[194:195], v[194:195], v[28:29]
  v_cvt_pk_bf16_f32 v165, v194, v195
  v_lshlrev_b32 v194, 16, v165
  v_and_b32 v195, 0xffff0000, v165
  v_pk_fma_f32 v[218:219], v[194:195], v[18:19], v[218:219]
  v_pk_add_f32 v[196:197], v[196:197], v[216:217]
  v_lshlrev_b32 v16, 16, v178
  v_cvt_pk_bf16_f32 v197, v196, v197
  v_and_b32 v17, 0xffff0000, v178
  v_lshlrev_b32 v196, 16, v197
  v_and_b32 v197, 0xffff0000, v197
  v_pk_mul_f32 v[196:197], v[196:197], v[28:29]
  v_cvt_pk_bf16_f32 v166, v196, v197
  v_lshlrev_b32 v196, 16, v166
  v_and_b32 v197, 0xffff0000, v166
  v_pk_fma_f32 v[218:219], v[196:197], v[16:17], v[218:219]
  v_pk_add_f32 v[198:199], v[198:199], v[216:217]
  v_lshlrev_b32 v18, 16, v179
  v_cvt_pk_bf16_f32 v199, v198, v199
  v_and_b32 v19, 0xffff0000, v179
  v_lshlrev_b32 v198, 16, v199
  v_and_b32 v199, 0xffff0000, v199
  v_pk_mul_f32 v[198:199], v[198:199], v[28:29]
  v_cvt_pk_bf16_f32 v167, v198, v199
  v_lshlrev_b32 v198, 16, v167
  v_and_b32 v199, 0xffff0000, v167
  v_pk_fma_f32 v[218:219], v[198:199], v[18:19], v[218:219]
  ds_write_b128 v220, v[164:167] offset:4096
  v_pk_add_f32 v[200:201], v[200:201], v[216:217]
  v_lshlrev_b32 v16, 16, v180
  v_cvt_pk_bf16_f32 v201, v200, v201
  v_and_b32 v17, 0xffff0000, v180
  v_lshlrev_b32 v200, 16, v201
  v_and_b32 v201, 0xffff0000, v201
  v_pk_mul_f32 v[200:201], v[200:201], v[28:29]
  v_cvt_pk_bf16_f32 v168, v200, v201
  v_lshlrev_b32 v200, 16, v168
  v_and_b32 v201, 0xffff0000, v168
  v_pk_fma_f32 v[218:219], v[200:201], v[16:17], v[218:219]
  v_pk_add_f32 v[202:203], v[202:203], v[216:217]
  v_lshlrev_b32 v18, 16, v181
  v_cvt_pk_bf16_f32 v203, v202, v203
  v_and_b32 v19, 0xffff0000, v181
  v_lshlrev_b32 v202, 16, v203
  v_and_b32 v203, 0xffff0000, v203
  v_pk_mul_f32 v[202:203], v[202:203], v[28:29]
  v_cvt_pk_bf16_f32 v169, v202, v203
  v_lshlrev_b32 v202, 16, v169
  v_and_b32 v203, 0xffff0000, v169
  v_pk_fma_f32 v[218:219], v[202:203], v[18:19], v[218:219]
  v_pk_add_f32 v[204:205], v[204:205], v[216:217]
  v_lshlrev_b32 v16, 16, v182
  v_cvt_pk_bf16_f32 v205, v204, v205
  v_and_b32 v17, 0xffff0000, v182
  v_lshlrev_b32 v204, 16, v205
  v_and_b32 v205, 0xffff0000, v205
  v_pk_mul_f32 v[204:205], v[204:205], v[28:29]
  v_cvt_pk_bf16_f32 v170, v204, v205
  v_lshlrev_b32 v204, 16, v170
  v_and_b32 v205, 0xffff0000, v170
  v_pk_fma_f32 v[218:219], v[204:205], v[16:17], v[218:219]
  v_pk_add_f32 v[206:207], v[206:207], v[216:217]
  v_lshlrev_b32 v18, 16, v183
  v_cvt_pk_bf16_f32 v207, v206, v207
  v_and_b32 v19, 0xffff0000, v183
  v_lshlrev_b32 v206, 16, v207
  v_and_b32 v207, 0xffff0000, v207
  v_pk_mul_f32 v[206:207], v[206:207], v[28:29]
  v_cvt_pk_bf16_f32 v171, v206, v207
  v_lshlrev_b32 v206, 16, v171
  v_and_b32 v207, 0xffff0000, v171
  v_pk_fma_f32 v[218:219], v[206:207], v[18:19], v[218:219]
  ds_write_b128 v220, v[168:171] offset:8192
  v_add_f32 v218, v218, v219
  s_nop 1
  v_add_f32_dpp v218, v218, v218 quad_perm:[1,0,3,2] row_mask:0xf bank_mask:0xf
  s_nop 1
  v_add_f32_dpp v218, v218, v218 quad_perm:[2,3,0,1] row_mask:0xf bank_mask:0xf
  s_nop 1
  v_add_f32_dpp v218, v218, v218 row_half_mirror row_mask:0xf bank_mask:0xf
  s_nop 1
  v_add_f32_dpp v218, v218, v218 row_mirror row_mask:0xf bank_mask:0xf
  v_mov_b32 v214, v218
  s_nop 1
  v_permlane16_swap_b32 v218, v214
  v_add_f32 v218, v218, v214
  v_cvt_pk_bf16_f32 v218, v218, v218
  v_and_b32 v218, 0xffff0000, v218
  v_ashrrev_i32 v214, 31, v218
  v_or_b32 v214, 0x80000000, v214
  v_xor_b32 v218, v218, v214
  v_and_b32 v218, 0xffff0000, v218
  v_or_b32 v218, v218, v209
  v_mov_b32 v19, 1073741824
  s_mov_b32 m0, s24
  s_nop 0
  buffer_load_dwordx4 v3, s[32:35], s26 offen offset:0 sc1 lds
  buffer_load_dwordx4 v4, s[32:35], s26 offen offset:1024 sc1 lds
  buffer_load_dwordx4 v5, s[32:35], s26 offen offset:2048 sc1 lds
  buffer_load_dwordx4 v6, s[32:35], s26 offen offset:3072 sc1 lds
  s_add_u32 m0, s24, 16384
  s_nop 0
  buffer_load_dwordx4 v8, s[36:39], s27 offen offset:0 lds
  buffer_load_dwordx4 v9, s[36:39], s27 offen offset:1024 lds
  buffer_load_dwordx4 v10, s[36:39], s27 offen offset:2048 lds
  buffer_load_dwordx4 v11, s[36:39], s27 offen offset:3072 lds
  s_add_u32 s26, s26, s79
  s_add_u32 s27, s27, s25
  s_add_u32 s24, s24, 32768
  s_and_b32 s24, s24, 0x1ffff
  s_mov_b32 m0, s24
  s_nop 0
  buffer_load_dwordx4 v3, s[32:35], s26 offen offset:0 sc1 lds
  buffer_load_dwordx4 v4, s[32:35], s26 offen offset:1024 sc1 lds
  buffer_load_dwordx4 v5, s[32:35], s26 offen offset:2048 sc1 lds
  buffer_load_dwordx4 v6, s[32:35], s26 offen offset:3072 sc1 lds
  s_add_u32 m0, s24, 16384
  s_nop 0
  buffer_load_dwordx4 v8, s[36:39], s27 offen offset:0 lds
  buffer_load_dwordx4 v9, s[36:39], s27 offen offset:1024 lds
  buffer_load_dwordx4 v10, s[36:39], s27 offen offset:2048 lds
  buffer_load_dwordx4 v11, s[36:39], s27 offen offset:3072 lds
  s_add_u32 s26, s26, s79
  s_add_u32 s27, s27, s25
  s_add_u32 s24, s24, 32768
  s_and_b32 s24, s24, 0x1ffff
  s_mov_b32 m0, s24
  s_nop 0
  buffer_load_dwordx4 v3, s[32:35], s26 offen offset:0 sc1 lds
  buffer_load_dwordx4 v4, s[32:35], s26 offen offset:1024 sc1 lds
  buffer_load_dwordx4 v5, s[32:35], s26 offen offset:2048 sc1 lds
  buffer_load_dwordx4 v6, s[32:35], s26 offen offset:3072 sc1 lds
  s_add_u32 m0, s24, 16384
  s_nop 0
  buffer_load_dwordx4 v8, s[36:39], s27 offen offset:0 lds
  buffer_load_dwordx4 v9, s[36:39], s27 offen offset:1024 lds
  buffer_load_dwordx4 v10, s[36:39], s27 offen offset:2048 lds
  buffer_load_dwordx4 v11, s[36:39], s27 offen offset:3072 lds
  s_add_u32 s26, s26, s79
  s_add_u32 s27, s27, s25
  s_add_u32 s24, s24, 32768
  s_and_b32 s24, s24, 0x1ffff
  buffer_load_dword v231, v19, s[32:35], 0 offen
  s_mov_b32 m0, s24
  s_nop 0
  buffer_load_dwordx4 v3, s[32:35], s26 offen offset:0 sc1 lds
  buffer_load_dwordx4 v4, s[32:35], s26 offen offset:1024 sc1 lds
  buffer_load_dwordx4 v5, s[32:35], s26 offen offset:2048 sc1 lds
  buffer_load_dwordx4 v6, s[32:35], s26 offen offset:3072 sc1 lds
  s_add_u32 m0, s24, 16384
  s_nop 0
  buffer_load_dwordx4 v8, s[36:39], s27 offen offset:0 lds
  buffer_load_dwordx4 v9, s[36:39], s27 offen offset:1024 lds
  buffer_load_dwordx4 v10, s[36:39], s27 offen offset:2048 lds
  buffer_load_dwordx4 v11, s[36:39], s27 offen offset:3072 lds
  s_add_u32 s26, s26, s79
  s_add_u32 s27, s27, s25
  s_add_u32 s24, s24, 32768
  s_and_b32 s24, s24, 0x1ffff
  s_waitcnt vmcnt(25) lgkmcnt(0)
  s_barrier
  s_cmp_ge_u32 s20, 2
  s_cbranch_scc1 fa_roleV
  ds_read_b128 v[96:99], v14 offset:0
  ds_read_b128 v[100:103], v14 offset:1024
  ds_read_b128 v[104:107], v14 offset:2048
  ds_read_b128 v[108:111], v14 offset:3072
  ds_read_b128 v[112:115], v14 offset:4096
  ds_read_b128 v[116:119], v14 offset:5120
  ds_read_b128 v[120:123], v14 offset:6144
  ds_read_b128 v[124:127], v14 offset:7168
  ds_read_b64_tr_b16 v[32:33], v12 offset:0
  ds_read_b64_tr_b16 v[34:35], v12 offset:1024
  ds_read_b64_tr_b16 v[36:37], v13 offset:0
  ds_read_b64_tr_b16 v[38:39], v13 offset:1024
  ds_read_b64_tr_b16 v[40:41], v12 offset:256
  ds_read_b64_tr_b16 v[42:43], v12 offset:1280
  ds_read_b64_tr_b16 v[44:45], v13 offset:256
  ds_read_b64_tr_b16 v[46:47], v13 offset:1280
  ds_read_b64_tr_b16 v[48:49], v12 offset:512
  ds_read_b64_tr_b16 v[50:51], v12 offset:1536
  ds_read_b64_tr_b16 v[52:53], v13 offset:512
  ds_read_b64_tr_b16 v[54:55], v13 offset:1536
  ds_read_b64_tr_b16 v[56:57], v12 offset:768
  ds_read_b64_tr_b16 v[58:59], v12 offset:1792
  ds_read_b64_tr_b16 v[60:61], v13 offset:768
  ds_read_b64_tr_b16 v[62:63], v13 offset:1792
  s_waitcnt lgkmcnt(0)
.p2align 6
fa_loopK:
  v_mfma_f32_16x16x32_bf16 a[0:3], v[32:35], v[96:99], a[0:3]
  s_waitcnt vmcnt(17)
  v_mfma_f32_16x16x32_bf16 a[4:7], v[32:35], v[100:103], a[4:7]
  s_barrier
  v_mfma_f32_16x16x32_bf16 a[8:11], v[32:35], v[104:107], a[8:11]
  ds_read_b64_tr_b16 v[64:65], v12 offset:32768
  v_mfma_f32_16x16x32_bf16 a[12:15], v[32:35], v[108:111], a[12:15]
  v_mfma_f32_16x16x32_bf16 a[16:19], v[32:35], v[112:115], a[16:19]
  s_mov_b32 m0, s24
  ds_read_b64_tr_b16 v[66:67], v12 offset:33792
  v_mfma_f32_16x16x32_bf16 a[20:23], v[32:35], v[116:119], a[20:23]
  buffer_load_dwordx4 v3, s[32:35], s26 offen offset:0 sc1 lds
  v_mfma_f32_16x16x32_bf16 a[24:27], v[32:35], v[120:123], a[24:27]
  ds_read_b128 v[128:131], v14 offset:32768
  v_mfma_f32_16x16x32_bf16 a[28:31], v[32:35], v[124:127], a[28:31]
  buffer_load_dwordx4 v4, s[32:35], s26 offen offset:1024 sc1 lds
  v_mfma_f32_16x16x32_bf16 a[32:35], v[36:39], v[96:99], a[32:35]
  ds_read_b64_tr_b16 v[68:69], v13 offset:32768
  v_mfma_f32_16x16x32_bf16 a[36:39], v[36:39], v[100:103], a[36:39]
  buffer_load_dwordx4 v5, s[32:35], s26 offen offset:2048 sc1 lds
  v_mfma_f32_16x16x32_bf16 a[40:43], v[36:39], v[104:107], a[40:43]
  ds_read_b64_tr_b16 v[70:71], v13 offset:33792
  v_mfma_f32_16x16x32_bf16 a[44:47], v[36:39], v[108:111], a[44:47]
  buffer_load_dwordx4 v6, s[32:35], s26 offen offset:3072 sc1 lds
  v_mfma_f32_16x16x32_bf16 a[48:51], v[36:39], v[112:115], a[48:51]
  s_add_u32 m0, s24, 16384
  ds_read_b128 v[132:135], v14 offset:33792
  v_mfma_f32_16x16x32_bf16 a[52:55], v[36:39], v[116:119], a[52:55]
  buffer_load_dwordx4 v8, s[36:39], s27 offen offset:0 lds
  v_mfma_f32_16x16x32_bf16 a[56:59], v[36:39], v[120:123], a[56:59]
  ds_read_b64_tr_b16 v[72:73], v12 offset:33024
  v_mfma_f32_16x16x32_bf16 a[60:63], v[36:39], v[124:127], a[60:63]
  buffer_load_dwordx4 v9, s[36:39], s27 offen offset:1024 lds
  v_mfma_f32_16x16x32_bf16 a[64:67], v[40:43], v[96:99], a[64:67]
  ds_read_b64_tr_b16 v[74:75], v12 offset:34048
  v_mfma_f32_16x16x32_bf16 a[68:71], v[40:43], v[100:103], a[68:71]
  buffer_load_dwordx4 v10, s[36:39], s27 offen offset:2048 lds
  v_mfma_f32_16x16x32_bf16 a[72:75], v[40:43], v[104:107], a[72:75]
  ds_read_b128 v[136:139], v14 offset:34816
  v_mfma_f32_16x16x32_bf16 a[76:79], v[40:43], v[108:111], a[76:79]
  buffer_load_dwordx4 v11, s[36:39], s27 offen offset:3072 lds
  v_mfma_f32_16x16x32_bf16 a[80:83], v[40:43], v[112:115], a[80:83]
  ds_read_b64_tr_b16 v[76:77], v13 offset:33024
  v_mfma_f32_16x16x32_bf16 a[84:87], v[40:43], v[116:119], a[84:87]
  buffer_load_dword v231, v235, s[48:51], s74 offen sc1
  v_mfma_f32_16x16x32_bf16 a[88:91], v[40:43], v[120:123], a[88:91]
  s_add_u32 s74, s74, s73
  ds_read_b64_tr_b16 v[78:79], v13 offset:34048
  v_mfma_f32_16x16x32_bf16 a[92:95], v[40:43], v[124:127], a[92:95]
  s_bitcmp1_b32 s72, s28
  v_mfma_f32_16x16x32_bf16 a[96:99], v[44:47], v[96:99], a[96:99]
  s_cbranch_scc1 fa_hk0
fa_hb0:
  ds_read_b128 v[140:143], v14 offset:35840
  v_mfma_f32_16x16x32_bf16 a[100:103], v[44:47], v[100:103], a[100:103]
  v_mfma_f32_16x16x32_bf16 a[104:107], v[44:47], v[104:107], a[104:107]
  ds_read_b64_tr_b16 v[80:81], v12 offset:33280
  v_mfma_f32_16x16x32_bf16 a[108:111], v[44:47], v[108:111], a[108:111]
  v_mfma_f32_16x16x32_bf16 a[112:115], v[44:47], v[112:115], a[112:115]
  ds_read_b64_tr_b16 v[82:83], v12 offset:34304
  v_mfma_f32_16x16x32_bf16 a[116:119], v[44:47], v[116:119], a[116:119]
  v_mfma_f32_16x16x32_bf16 a[120:123], v[44:47], v[120:123], a[120:123]
  ds_read_b128 v[144:147], v14 offset:36864
  v_mfma_f32_16x16x32_bf16 a[124:127], v[44:47], v[124:127], a[124:127]
  v_mfma_f32_16x16x32_bf16 a[128:131], v[48:51], v[96:99], a[128:131]
  ds_read_b64_tr_b16 v[84:85], v13 offset:33280
  v_mfma_f32_16x16x32_bf16 a[132:135], v[48:51], v[100:103], a[132:135]
  v_mfma_f32_16x16x32_bf16 a[136:139], v[48:51], v[104:107], a[136:139]
  ds_read_b64_tr_b16 v[86:87], v13 offset:34304
  v_mfma_f32_16x16x32_bf16 a[140:143], v[48:51], v[108:111], a[140:143]
  v_mfma_f32_16x16x32_bf16 a[144:147], v[48:51], v[112:115], a[144:147]
  ds_read_b128 v[148:151], v14 offset:37888
  v_mfma_f32_16x16x32_bf16 a[148:151], v[48:51], v[116:119], a[148:151]
  v_mfma_f32_16x16x32_bf16 a[152:155], v[48:51], v[120:123], a[152:155]
  ds_read_b64_tr_b16 v[88:89], v12 offset:33536
  v_mfma_f32_16x16x32_bf16 a[156:159], v[48:51], v[124:127], a[156:159]
  v_mfma_f32_16x16x32_bf16 a[160:163], v[52:55], v[96:99], a[160:163]
  ds_read_b64_tr_b16 v[90:91], v12 offset:34560
  v_mfma_f32_16x16x32_bf16 a[164:167], v[52:55], v[100:103], a[164:167]
  v_mfma_f32_16x16x32_bf16 a[168:171], v[52:55], v[104:107], a[168:171]
  ds_read_b128 v[152:155], v14 offset:38912
  v_mfma_f32_16x16x32_bf16 a[172:175], v[52:55], v[108:111], a[172:175]
  v_mfma_f32_16x16x32_bf16 a[176:179], v[52:55], v[112:115], a[176:179]
  ds_read_b64_tr_b16 v[92:93], v13 offset:33536
  v_mfma_f32_16x16x32_bf16 a[180:183], v[52:55], v[116:119], a[180:183]
  v_mfma_f32_16x16x32_bf16 a[184:187], v[52:55], v[120:123], a[184:187]
  ds_read_b64_tr_b16 v[94:95], v13 offset:34560
  v_mfma_f32_16x16x32_bf16 a[188:191], v[52:55], v[124:127], a[188:191]
  v_mfma_f32_16x16x32_bf16 a[192:195], v[56:59], v[96:99], a[192:195]
  s_add_u32 s26, s26, s79
  ds_read_b128 v[156:159], v14 offset:39936
  v_mfma_f32_16x16x32_bf16 a[196:199], v[56:59], v[100:103], a[196:199]
  s_add_u32 s27, s27, s25
  v_mfma_f32_16x16x32_bf16 a[200:203], v[56:59], v[104:107], a[200:203]
  s_add_u32 s24, s24, 32768
  v_mfma_f32_16x16x32_bf16 a[204:207], v[56:59], v[108:111], a[204:207]
  s_and_b32 s24, s24, 0x1ffff
  v_mfma_f32_16x16x32_bf16 a[208:211], v[56:59], v[112:115], a[208:211]
  v_xor_b32 v14, 0x10000, v14
  v_mfma_f32_16x16x32_bf16 a[212:215], v[56:59], v[116:119], a[212:215]
  v_xor_b32 v12, 0x10000, v12
  v_mfma_f32_16x16x32_bf16 a[216:219], v[56:59], v[120:123], a[216:219]
  v_xor_b32 v13, 0x10000, v13
  v_mfma_f32_16x16x32_bf16 a[220:223], v[56:59], v[124:127], a[220:223]
  v_mfma_f32_16x16x32_bf16 a[224:227], v[60:63], v[96:99], a[224:227]
  v_mfma_f32_16x16x32_bf16 a[228:231], v[60:63], v[100:103], a[228:231]
  v_mfma_f32_16x16x32_bf16 a[232:235], v[60:63], v[104:107], a[232:235]
  v_mfma_f32_16x16x32_bf16 a[236:239], v[60:63], v[108:111], a[236:239]
  v_mfma_f32_16x16x32_bf16 a[240:243], v[60:63], v[112:115], a[240:243]
  v_mfma_f32_16x16x32_bf16 a[244:247], v[60:63], v[116:119], a[244:247]
  v_mfma_f32_16x16x32_bf16 a[248:251], v[60:63], v[120:123], a[248:251]
  v_mfma_f32_16x16x32_bf16 a[252:255], v[60:63], v[124:127], a[252:255]
  s_waitcnt lgkmcnt(0)
  v_mfma_f32_16x16x32_bf16 a[0:3], v[64:67], v[128:131], a[0:3]
  s_waitcnt vmcnt(18)
  v_mfma_f32_16x16x32_bf16 a[4:7], v[64:67], v[132:135], a[4:7]
  s_barrier
  v_mfma_f32_16x16x32_bf16 a[8:11], v[64:67], v[136:139], a[8:11]
  ds_read_b64_tr_b16 v[32:33], v12 offset:0
  v_mfma_f32_16x16x32_bf16 a[12:15], v[64:67], v[140:143], a[12:15]
  v_mfma_f32_16x16x32_bf16 a[16:19], v[64:67], v[144:147], a[16:19]
  s_mov_b32 m0, s24
  ds_read_b64_tr_b16 v[34:35], v12 offset:1024
  v_mfma_f32_16x16x32_bf16 a[20:23], v[64:67], v[148:151], a[20:23]
  buffer_load_dwordx4 v3, s[32:35], s26 offen offset:0 sc1 lds
  v_mfma_f32_16x16x32_bf16 a[24:27], v[64:67], v[152:155], a[24:27]
  ds_read_b128 v[96:99], v14 offset:0
  v_mfma_f32_16x16x32_bf16 a[28:31], v[64:67], v[156:159], a[28:31]
  v_mfma_f32_16x16x32_bf16 a[32:35], v[68:71], v[128:131], a[32:35]
  ds_read_b64_tr_b16 v[36:37], v13 offset:0
  v_mfma_f32_16x16x32_bf16 a[36:39], v[68:71], v[132:135], a[36:39]
  v_mfma_f32_16x16x32_bf16 a[40:43], v[68:71], v[136:139], a[40:43]
  ds_read_b64_tr_b16 v[38:39], v13 offset:1024
  v_mfma_f32_16x16x32_bf16 a[44:47], v[68:71], v[140:143], a[44:47]
  buffer_load_dwordx4 v4, s[32:35], s26 offen offset:1024 sc1 lds
  v_mfma_f32_16x16x32_bf16 a[48:51], v[68:71], v[144:147], a[48:51]
  ds_read_b128 v[100:103], v14 offset:1024
  v_mfma_f32_16x16x32_bf16 a[52:55], v[68:71], v[148:151], a[52:55]
  v_mfma_f32_16x16x32_bf16 a[56:59], v[68:71], v[152:155], a[56:59]
  ds_read_b64_tr_b16 v[40:41], v12 offset:256
  v_mfma_f32_16x16x32_bf16 a[60:63], v[68:71], v[156:159], a[60:63]
  v_mfma_f32_16x16x32_bf16 a[64:67], v[72:75], v[128:131], a[64:67]
  ds_read_b64_tr_b16 v[42:43], v12 offset:1280
  v_mfma_f32_16x16x32_bf16 a[68:71], v[72:75], v[132:135], a[68:71]
  buffer_load_dwordx4 v5, s[32:35], s26 offen offset:2048 sc1 lds
  v_mfma_f32_16x16x32_bf16 a[72:75], v[72:75], v[136:139], a[72:75]
  ds_read_b128 v[104:107], v14 offset:2048
  v_mfma_f32_16x16x32_bf16 a[76:79], v[72:75], v[140:143], a[76:79]
  v_mfma_f32_16x16x32_bf16 a[80:83], v[72:75], v[144:147], a[80:83]
  ds_read_b64_tr_b16 v[44:45], v13 offset:256
  v_mfma_f32_16x16x32_bf16 a[84:87], v[72:75], v[148:151], a[84:87]
  v_mfma_f32_16x16x32_bf16 a[88:91], v[72:75], v[152:155], a[88:91]
  ds_read_b64_tr_b16 v[46:47], v13 offset:1280
  v_mfma_f32_16x16x32_bf16 a[92:95], v[72:75], v[156:159], a[92:95]
  buffer_load_dwordx4 v6, s[32:35], s26 offen offset:3072 sc1 lds
  v_mfma_f32_16x16x32_bf16 a[96:99], v[76:79], v[128:131], a[96:99]
  ds_read_b128 v[108:111], v14 offset:3072
  v_mfma_f32_16x16x32_bf16 a[100:103], v[76:79], v[132:135], a[100:103]
  v_mfma_f32_16x16x32_bf16 a[104:107], v[76:79], v[136:139], a[104:107]
  ds_read_b64_tr_b16 v[48:49], v12 offset:512
  v_mfma_f32_16x16x32_bf16 a[108:111], v[76:79], v[140:143], a[108:111]
  v_mfma_f32_16x16x32_bf16 a[112:115], v[76:79], v[144:147], a[112:115]
  s_add_u32 m0, s24, 16384
  ds_read_b64_tr_b16 v[50:51], v12 offset:1536
  v_mfma_f32_16x16x32_bf16 a[116:119], v[76:79], v[148:151], a[116:119]
  buffer_load_dwordx4 v8, s[36:39], s27 offen offset:0 lds
  v_mfma_f32_16x16x32_bf16 a[120:123], v[76:79], v[152:155], a[120:123]
  ds_read_b128 v[112:115], v14 offset:4096
  v_mfma_f32_16x16x32_bf16 a[124:127], v[76:79], v[156:159], a[124:127]
  v_mfma_f32_16x16x32_bf16 a[128:131], v[80:83], v[128:131], a[128:131]
  ds_read_b64_tr_b16 v[52:53], v13 offset:512
  v_mfma_f32_16x16x32_bf16 a[132:135], v[80:83], v[132:135], a[132:135]
  v_mfma_f32_16x16x32_bf16 a[136:139], v[80:83], v[136:139], a[136:139]
  ds_read_b64_tr_b16 v[54:55], v13 offset:1536
  v_mfma_f32_16x16x32_bf16 a[140:143], v[80:83], v[140:143], a[140:143]
  buffer_load_dwordx4 v9, s[36:39], s27 offen offset:1024 lds
  v_mfma_f32_16x16x32_bf16 a[144:147], v[80:83], v[144:147], a[144:147]
  ds_read_b128 v[116:119], v14 offset:5120
  v_mfma_f32_16x16x32_bf16 a[148:151], v[80:83], v[148:151], a[148:151]
  v_mfma_f32_16x16x32_bf16 a[152:155], v[80:83], v[152:155], a[152:155]
  ds_read_b64_tr_b16 v[56:57], v12 offset:768
  v_mfma_f32_16x16x32_bf16 a[156:159], v[80:83], v[156:159], a[156:159]
  v_mfma_f32_16x16x32_bf16 a[160:163], v[84:87], v[128:131], a[160:163]
  ds_read_b64_tr_b16 v[58:59], v12 offset:1792
  v_mfma_f32_16x16x32_bf16 a[164:167], v[84:87], v[132:135], a[164:167]
  buffer_load_dwordx4 v10, s[36:39], s27 offen offset:2048 lds
  v_mfma_f32_16x16x32_bf16 a[168:171], v[84:87], v[136:139], a[168:171]
  ds_read_b128 v[120:123], v14 offset:6144
  v_mfma_f32_16x16x32_bf16 a[172:175], v[84:87], v[140:143], a[172:175]
  v_mfma_f32_16x16x32_bf16 a[176:179], v[84:87], v[144:147], a[176:179]
  ds_read_b64_tr_b16 v[60:61], v13 offset:768
  v_mfma_f32_16x16x32_bf16 a[180:183], v[84:87], v[148:151], a[180:183]
  v_mfma_f32_16x16x32_bf16 a[184:187], v[84:87], v[152:155], a[184:187]
  ds_read_b64_tr_b16 v[62:63], v13 offset:1792
  v_mfma_f32_16x16x32_bf16 a[188:191], v[84:87], v[156:159], a[188:191]
  buffer_load_dwordx4 v11, s[36:39], s27 offen offset:3072 lds
  v_mfma_f32_16x16x32_bf16 a[192:195], v[88:91], v[128:131], a[192:195]
  s_add_u32 s26, s26, s79
  ds_read_b128 v[124:127], v14 offset:7168
  v_mfma_f32_16x16x32_bf16 a[196:199], v[88:91], v[132:135], a[196:199]
  s_add_u32 s27, s27, s25
  v_mfma_f32_16x16x32_bf16 a[200:203], v[88:91], v[136:139], a[200:203]
  s_add_u32 s24, s24, 32768
  v_mfma_f32_16x16x32_bf16 a[204:207], v[88:91], v[140:143], a[204:207]
  s_and_b32 s24, s24, 0x1ffff
  v_mfma_f32_16x16x32_bf16 a[208:211], v[88:91], v[144:147], a[208:211]
  v_mfma_f32_16x16x32_bf16 a[212:215], v[88:91], v[148:151], a[212:215]
  s_bitcmp1_b32 s76, s28
  v_mfma_f32_16x16x32_bf16 a[216:219], v[88:91], v[152:155], a[216:219]
  s_cbranch_scc1 fa_hk1
fa_hb1:
  v_mfma_f32_16x16x32_bf16 a[220:223], v[88:91], v[156:159], a[220:223]
  v_mfma_f32_16x16x32_bf16 a[224:227], v[92:95], v[128:131], a[224:227]
  v_mfma_f32_16x16x32_bf16 a[228:231], v[92:95], v[132:135], a[228:231]
  s_add_u32 s28, s28, 1
  v_mfma_f32_16x16x32_bf16 a[232:235], v[92:95], v[136:139], a[232:235]
  v_mfma_f32_16x16x32_bf16 a[236:239], v[92:95], v[140:143], a[236:239]
  v_mfma_f32_16x16x32_bf16 a[240:243], v[92:95], v[144:147], a[240:243]
  v_mfma_f32_16x16x32_bf16 a[244:247], v[92:95], v[148:151], a[244:247]
  s_cmp_lt_u32 s28, 8
  v_mfma_f32_16x16x32_bf16 a[248:251], v[92:95], v[152:155], a[248:251]
  s_waitcnt lgkmcnt(0)
  v_mfma_f32_16x16x32_bf16 a[252:255], v[92:95], v[156:159], a[252:255]
  s_cbranch_scc1 fa_loopK
  s_mov_b32 s60, 2048
  s_mov_b32 s61, 8192
  s_mov_b32 s62, 16777216
  s_mov_b32 s76, 0x3e0293ee
  s_branch fa_p1epi
fa_roleV:
  ds_read_b128 v[32:35], v14 offset:0
  ds_read_b128 v[36:39], v14 offset:1024
  ds_read_b128 v[40:43], v14 offset:2048
  ds_read_b128 v[44:47], v14 offset:3072
  ds_read_b128 v[48:51], v14 offset:4096
  ds_read_b128 v[52:55], v14 offset:5120
  ds_read_b128 v[56:59], v14 offset:6144
  ds_read_b128 v[60:63], v14 offset:7168
  ds_read_b64_tr_b16 v[96:97], v12 offset:0
  ds_read_b64_tr_b16 v[98:99], v12 offset:1024
  ds_read_b64_tr_b16 v[100:101], v13 offset:0
  ds_read_b64_tr_b16 v[102:103], v13 offset:1024
  ds_read_b64_tr_b16 v[104:105], v12 offset:256
  ds_read_b64_tr_b16 v[106:107], v12 offset:1280
  ds_read_b64_tr_b16 v[108:109], v13 offset:256
  ds_read_b64_tr_b16 v[110:111], v13 offset:1280
  ds_read_b64_tr_b16 v[112:113], v12 offset:512
  ds_read_b64_tr_b16 v[114:115], v12 offset:1536
  ds_read_b64_tr_b16 v[116:117], v13 offset:512
  ds_read_b64_tr_b16 v[118:119], v13 offset:1536
  ds_read_b64_tr_b16 v[120:121], v12 offset:768
  ds_read_b64_tr_b16 v[122:123], v12 offset:1792
  ds_read_b64_tr_b16 v[124:125], v13 offset:768
  ds_read_b64_tr_b16 v[126:127], v13 offset:1792
  s_waitcnt lgkmcnt(0)
.p2align 6
fa_loopV:
  v_mfma_f32_16x16x32_bf16 a[0:3], v[32:35], v[96:99], a[0:3]
  s_waitcnt vmcnt(17)
  v_mfma_f32_16x16x32_bf16 a[4:7], v[32:35], v[100:103], a[4:7]
  s_barrier
  v_mfma_f32_16x16x32_bf16 a[8:11], v[32:35], v[104:107], a[8:11]
  ds_read_b64_tr_b16 v[128:129], v12 offset:32768
  v_mfma_f32_16x16x32_bf16 a[12:15], v[32:35], v[108:111], a[12:15]
  v_mfma_f32_16x16x32_bf16 a[16:19], v[32:35], v[112:115], a[16:19]
  s_mov_b32 m0, s24
  ds_read_b64_tr_b16 v[130:131], v12 offset:33792
  v_mfma_f32_16x16x32_bf16 a[20:23], v[32:35], v[116:119], a[20:23]
  buffer_load_dwordx4 v3, s[32:35], s26 offen offset:0 sc1 lds
  v_mfma_f32_16x16x32_bf16 a[24:27], v[32:35], v[120:123], a[24:27]
  ds_read_b128 v[64:67], v14 offset:32768
  v_mfma_f32_16x16x32_bf16 a[28:31], v[32:35], v[124:127], a[28:31]
  buffer_load_dwordx4 v4, s[32:35], s26 offen offset:1024 sc1 lds
  v_mfma_f32_16x16x32_bf16 a[32:35], v[36:39], v[96:99], a[32:35]
  ds_read_b64_tr_b16 v[132:133], v13 offset:32768
  v_mfma_f32_16x16x32_bf16 a[36:39], v[36:39], v[100:103], a[36:39]
  buffer_load_dwordx4 v5, s[32:35], s26 offen offset:2048 sc1 lds
  v_mfma_f32_16x16x32_bf16 a[40:43], v[36:39], v[104:107], a[40:43]
  ds_read_b64_tr_b16 v[134:135], v13 offset:33792
  v_mfma_f32_16x16x32_bf16 a[44:47], v[36:39], v[108:111], a[44:47]
  buffer_load_dwordx4 v6, s[32:35], s26 offen offset:3072 sc1 lds
  v_mfma_f32_16x16x32_bf16 a[48:51], v[36:39], v[112:115], a[48:51]
  s_add_u32 m0, s24, 16384
  ds_read_b128 v[68:71], v14 offset:33792
  v_mfma_f32_16x16x32_bf16 a[52:55], v[36:39], v[116:119], a[52:55]
  buffer_load_dwordx4 v8, s[36:39], s27 offen offset:0 lds
  v_mfma_f32_16x16x32_bf16 a[56:59], v[36:39], v[120:123], a[56:59]
  ds_read_b64_tr_b16 v[136:137], v12 offset:33024
  v_mfma_f32_16x16x32_bf16 a[60:63], v[36:39], v[124:127], a[60:63]
  buffer_load_dwordx4 v9, s[36:39], s27 offen offset:1024 lds
  v_mfma_f32_16x16x32_bf16 a[64:67], v[40:43], v[96:99], a[64:67]
  ds_read_b64_tr_b16 v[138:139], v12 offset:34048
  v_mfma_f32_16x16x32_bf16 a[68:71], v[40:43], v[100:103], a[68:71]
  buffer_load_dwordx4 v10, s[36:39], s27 offen offset:2048 lds
  v_mfma_f32_16x16x32_bf16 a[72:75], v[40:43], v[104:107], a[72:75]
  ds_read_b128 v[72:75], v14 offset:34816
  v_mfma_f32_16x16x32_bf16 a[76:79], v[40:43], v[108:111], a[76:79]
  buffer_load_dwordx4 v11, s[36:39], s27 offen offset:3072 lds
  v_mfma_f32_16x16x32_bf16 a[80:83], v[40:43], v[112:115], a[80:83]
  ds_read_b64_tr_b16 v[140:141], v13 offset:33024
  v_mfma_f32_16x16x32_bf16 a[84:87], v[40:43], v[116:119], a[84:87]
  buffer_load_dword v231, v235, s[48:51], s74 offen sc1
  v_mfma_f32_16x16x32_bf16 a[88:91], v[40:43], v[120:123], a[88:91]
  s_add_u32 s74, s74, s73
  ds_read_b64_tr_b16 v[142:143], v13 offset:34048
  v_mfma_f32_16x16x32_bf16 a[92:95], v[40:43], v[124:127], a[92:95]
  s_bitcmp1_b32 s72, s28
  v_mfma_f32_16x16x32_bf16 a[96:99], v[44:47], v[96:99], a[96:99]
  s_cbranch_scc1 fa_hk2
fa_hb2:
  ds_read_b128 v[76:79], v14 offset:35840
  v_mfma_f32_16x16x32_bf16 a[100:103], v[44:47], v[100:103], a[100:103]
  v_mfma_f32_16x16x32_bf16 a[104:107], v[44:47], v[104:107], a[104:107]
  ds_read_b64_tr_b16 v[144:145], v12 offset:33280
  v_mfma_f32_16x16x32_bf16 a[108:111], v[44:47], v[108:111], a[108:111]
  v_mfma_f32_16x16x32_bf16 a[112:115], v[44:47], v[112:115], a[112:115]
  ds_read_b64_tr_b16 v[146:147], v12 offset:34304
  v_mfma_f32_16x16x32_bf16 a[116:119], v[44:47], v[116:119], a[116:119]
  v_mfma_f32_16x16x32_bf16 a[120:123], v[44:47], v[120:123], a[120:123]
  ds_read_b128 v[80:83], v14 offset:36864
  v_mfma_f32_16x16x32_bf16 a[124:127], v[44:47], v[124:127], a[124:127]
  v_mfma_f32_16x16x32_bf16 a[128:131], v[48:51], v[96:99], a[128:131]
  ds_read_b64_tr_b16 v[148:149], v13 offset:33280
  v_mfma_f32_16x16x32_bf16 a[132:135], v[48:51], v[100:103], a[132:135]
  v_mfma_f32_16x16x32_bf16 a[136:139], v[48:51], v[104:107], a[136:139]
  ds_read_b64_tr_b16 v[150:151], v13 offset:34304
  v_mfma_f32_16x16x32_bf16 a[140:143], v[48:51], v[108:111], a[140:143]
  v_mfma_f32_16x16x32_bf16 a[144:147], v[48:51], v[112:115], a[144:147]
  ds_read_b128 v[84:87], v14 offset:37888
  v_mfma_f32_16x16x32_bf16 a[148:151], v[48:51], v[116:119], a[148:151]
  v_mfma_f32_16x16x32_bf16 a[152:155], v[48:51], v[120:123], a[152:155]
  ds_read_b64_tr_b16 v[152:153], v12 offset:33536
  v_mfma_f32_16x16x32_bf16 a[156:159], v[48:51], v[124:127], a[156:159]
  v_mfma_f32_16x16x32_bf16 a[160:163], v[52:55], v[96:99], a[160:163]
  ds_read_b64_tr_b16 v[154:155], v12 offset:34560
  v_mfma_f32_16x16x32_bf16 a[164:167], v[52:55], v[100:103], a[164:167]
  v_mfma_f32_16x16x32_bf16 a[168:171], v[52:55], v[104:107], a[168:171]
  ds_read_b128 v[88:91], v14 offset:38912
  v_mfma_f32_16x16x32_bf16 a[172:175], v[52:55], v[108:111], a[172:175]
  v_mfma_f32_16x16x32_bf16 a[176:179], v[52:55], v[112:115], a[176:179]
  ds_read_b64_tr_b16 v[156:157], v13 offset:33536
  v_mfma_f32_16x16x32_bf16 a[180:183], v[52:55], v[116:119], a[180:183]
  v_mfma_f32_16x16x32_bf16 a[184:187], v[52:55], v[120:123], a[184:187]
  ds_read_b64_tr_b16 v[158:159], v13 offset:34560
  v_mfma_f32_16x16x32_bf16 a[188:191], v[52:55], v[124:127], a[188:191]
  v_mfma_f32_16x16x32_bf16 a[192:195], v[56:59], v[96:99], a[192:195]
  s_add_u32 s26, s26, s79
  ds_read_b128 v[92:95], v14 offset:39936
  v_mfma_f32_16x16x32_bf16 a[196:199], v[56:59], v[100:103], a[196:199]
  s_add_u32 s27, s27, s25
  v_mfma_f32_16x16x32_bf16 a[200:203], v[56:59], v[104:107], a[200:203]
  s_add_u32 s24, s24, 32768
  v_mfma_f32_16x16x32_bf16 a[204:207], v[56:59], v[108:111], a[204:207]
  s_and_b32 s24, s24, 0x1ffff
  v_mfma_f32_16x16x32_bf16 a[208:211], v[56:59], v[112:115], a[208:211]
  v_xor_b32 v14, 0x10000, v14
  v_mfma_f32_16x16x32_bf16 a[212:215], v[56:59], v[116:119], a[212:215]
  v_xor_b32 v12, 0x10000, v12
  v_mfma_f32_16x16x32_bf16 a[216:219], v[56:59], v[120:123], a[216:219]
  v_xor_b32 v13, 0x10000, v13
  v_mfma_f32_16x16x32_bf16 a[220:223], v[56:59], v[124:127], a[220:223]
  v_mfma_f32_16x16x32_bf16 a[224:227], v[60:63], v[96:99], a[224:227]
  v_mfma_f32_16x16x32_bf16 a[228:231], v[60:63], v[100:103], a[228:231]
  v_mfma_f32_16x16x32_bf16 a[232:235], v[60:63], v[104:107], a[232:235]
  v_mfma_f32_16x16x32_bf16 a[236:239], v[60:63], v[108:111], a[236:239]
  v_mfma_f32_16x16x32_bf16 a[240:243], v[60:63], v[112:115], a[240:243]
  v_mfma_f32_16x16x32_bf16 a[244:247], v[60:63], v[116:119], a[244:247]
  v_mfma_f32_16x16x32_bf16 a[248:251], v[60:63], v[120:123], a[248:251]
  v_mfma_f32_16x16x32_bf16 a[252:255], v[60:63], v[124:127], a[252:255]
  s_waitcnt lgkmcnt(0)
  v_mfma_f32_16x16x32_bf16 a[0:3], v[64:67], v[128:131], a[0:3]
  s_waitcnt vmcnt(18)
  v_mfma_f32_16x16x32_bf16 a[4:7], v[64:67], v[132:135], a[4:7]
  s_barrier
  v_mfma_f32_16x16x32_bf16 a[8:11], v[64:67], v[136:139], a[8:11]
  ds_read_b64_tr_b16 v[96:97], v12 offset:0
  v_mfma_f32_16x16x32_bf16 a[12:15], v[64:67], v[140:143], a[12:15]
  v_mfma_f32_16x16x32_bf16 a[16:19], v[64:67], v[144:147], a[16:19]
  s_mov_b32 m0, s24
  ds_read_b64_tr_b16 v[98:99], v12 offset:1024
  v_mfma_f32_16x16x32_bf16 a[20:23], v[64:67], v[148:151], a[20:23]
  buffer_load_dwordx4 v3, s[32:35], s26 offen offset:0 sc1 lds
  v_mfma_f32_16x16x32_bf16 a[24:27], v[64:67], v[152:155], a[24:27]
  ds_read_b128 v[32:35], v14 offset:0
  v_mfma_f32_16x16x32_bf16 a[28:31], v[64:67], v[156:159], a[28:31]
  v_mfma_f32_16x16x32_bf16 a[32:35], v[68:71], v[128:131], a[32:35]
  ds_read_b64_tr_b16 v[100:101], v13 offset:0
  v_mfma_f32_16x16x32_bf16 a[36:39], v[68:71], v[132:135], a[36:39]
  v_mfma_f32_16x16x32_bf16 a[40:43], v[68:71], v[136:139], a[40:43]
  ds_read_b64_tr_b16 v[102:103], v13 offset:1024
  v_mfma_f32_16x16x32_bf16 a[44:47], v[68:71], v[140:143], a[44:47]
  buffer_load_dwordx4 v4, s[32:35], s26 offen offset:1024 sc1 lds
  v_mfma_f32_16x16x32_bf16 a[48:51], v[68:71], v[144:147], a[48:51]
  ds_read_b128 v[36:39], v14 offset:1024
  v_mfma_f32_16x16x32_bf16 a[52:55], v[68:71], v[148:151], a[52:55]
  v_mfma_f32_16x16x32_bf16 a[56:59], v[68:71], v[152:155], a[56:59]
  ds_read_b64_tr_b16 v[104:105], v12 offset:256
  v_mfma_f32_16x16x32_bf16 a[60:63], v[68:71], v[156:159], a[60:63]
  v_mfma_f32_16x16x32_bf16 a[64:67], v[72:75], v[128:131], a[64:67]
  ds_read_b64_tr_b16 v[106:107], v12 offset:1280
  v_mfma_f32_16x16x32_bf16 a[68:71], v[72:75], v[132:135], a[68:71]
  buffer_load_dwordx4 v5, s[32:35], s26 offen offset:2048 sc1 lds
  v_mfma_f32_16x16x32_bf16 a[72:75], v[72:75], v[136:139], a[72:75]
  ds_read_b128 v[40:43], v14 offset:2048
  v_mfma_f32_16x16x32_bf16 a[76:79], v[72:75], v[140:143], a[76:79]
  v_mfma_f32_16x16x32_bf16 a[80:83], v[72:75], v[144:147], a[80:83]
  ds_read_b64_tr_b16 v[108:109], v13 offset:256
  v_mfma_f32_16x16x32_bf16 a[84:87], v[72:75], v[148:151], a[84:87]
  v_mfma_f32_16x16x32_bf16 a[88:91], v[72:75], v[152:155], a[88:91]
  ds_read_b64_tr_b16 v[110:111], v13 offset:1280
  v_mfma_f32_16x16x32_bf16 a[92:95], v[72:75], v[156:159], a[92:95]
  buffer_load_dwordx4 v6, s[32:35], s26 offen offset:3072 sc1 lds
  v_mfma_f32_16x16x32_bf16 a[96:99], v[76:79], v[128:131], a[96:99]
  ds_read_b128 v[44:47], v14 offset:3072
  v_mfma_f32_16x16x32_bf16 a[100:103], v[76:79], v[132:135], a[100:103]
  v_mfma_f32_16x16x32_bf16 a[104:107], v[76:79], v[136:139], a[104:107]
  ds_read_b64_tr_b16 v[112:113], v12 offset:512
  v_mfma_f32_16x16x32_bf16 a[108:111], v[76:79], v[140:143], a[108:111]
  v_mfma_f32_16x16x32_bf16 a[112:115], v[76:79], v[144:147], a[112:115]
  s_add_u32 m0, s24, 16384
  ds_read_b64_tr_b16 v[114:115], v12 offset:1536
  v_mfma_f32_16x16x32_bf16 a[116:119], v[76:79], v[148:151], a[116:119]
  buffer_load_dwordx4 v8, s[36:39], s27 offen offset:0 lds
  v_mfma_f32_16x16x32_bf16 a[120:123], v[76:79], v[152:155], a[120:123]
  ds_read_b128 v[48:51], v14 offset:4096
  v_mfma_f32_16x16x32_bf16 a[124:127], v[76:79], v[156:159], a[124:127]
  v_mfma_f32_16x16x32_bf16 a[128:131], v[80:83], v[128:131], a[128:131]
  ds_read_b64_tr_b16 v[116:117], v13 offset:512
  v_mfma_f32_16x16x32_bf16 a[132:135], v[80:83], v[132:135], a[132:135]
  v_mfma_f32_16x16x32_bf16 a[136:139], v[80:83], v[136:139], a[136:139]
  ds_read_b64_tr_b16 v[118:119], v13 offset:1536
  v_mfma_f32_16x16x32_bf16 a[140:143], v[80:83], v[140:143], a[140:143]
  buffer_load_dwordx4 v9, s[36:39], s27 offen offset:1024 lds
  v_mfma_f32_16x16x32_bf16 a[144:147], v[80:83], v[144:147], a[144:147]
  ds_read_b128 v[52:55], v14 offset:5120
  v_mfma_f32_16x16x32_bf16 a[148:151], v[80:83], v[148:151], a[148:151]
  v_mfma_f32_16x16x32_bf16 a[152:155], v[80:83], v[152:155], a[152:155]
  ds_read_b64_tr_b16 v[120:121], v12 offset:768
  v_mfma_f32_16x16x32_bf16 a[156:159], v[80:83], v[156:159], a[156:159]
  v_mfma_f32_16x16x32_bf16 a[160:163], v[84:87], v[128:131], a[160:163]
  ds_read_b64_tr_b16 v[122:123], v12 offset:1792
  v_mfma_f32_16x16x32_bf16 a[164:167], v[84:87], v[132:135], a[164:167]
  buffer_load_dwordx4 v10, s[36:39], s27 offen offset:2048 lds
  v_mfma_f32_16x16x32_bf16 a[168:171], v[84:87], v[136:139], a[168:171]
  ds_read_b128 v[56:59], v14 offset:6144
  v_mfma_f32_16x16x32_bf16 a[172:175], v[84:87], v[140:143], a[172:175]
  v_mfma_f32_16x16x32_bf16 a[176:179], v[84:87], v[144:147], a[176:179]
  ds_read_b64_tr_b16 v[124:125], v13 offset:768
  v_mfma_f32_16x16x32_bf16 a[180:183], v[84:87], v[148:151], a[180:183]
  v_mfma_f32_16x16x32_bf16 a[184:187], v[84:87], v[152:155], a[184:187]
  ds_read_b64_tr_b16 v[126:127], v13 offset:1792
  v_mfma_f32_16x16x32_bf16 a[188:191], v[84:87], v[156:159], a[188:191]
  buffer_load_dwordx4 v11, s[36:39], s27 offen offset:3072 lds
  v_mfma_f32_16x16x32_bf16 a[192:195], v[88:91], v[128:131], a[192:195]
  s_add_u32 s26, s26, s79
  ds_read_b128 v[60:63], v14 offset:7168
  v_mfma_f32_16x16x32_bf16 a[196:199], v[88:91], v[132:135], a[196:199]
  s_add_u32 s27, s27, s25
  v_mfma_f32_16x16x32_bf16 a[200:203], v[88:91], v[136:139], a[200:203]
  s_add_u32 s24, s24, 32768
  v_mfma_f32_16x16x32_bf16 a[204:207], v[88:91], v[140:143], a[204:207]
  s_and_b32 s24, s24, 0x1ffff
  v_mfma_f32_16x16x32_bf16 a[208:211], v[88:91], v[144:147], a[208:211]
  v_mfma_f32_16x16x32_bf16 a[212:215], v[88:91], v[148:151], a[212:215]
  s_bitcmp1_b32 s76, s28
  v_mfma_f32_16x16x32_bf16 a[216:219], v[88:91], v[152:155], a[216:219]
  s_cbranch_scc1 fa_hk3
fa_hb3:
  v_mfma_f32_16x16x32_bf16 a[220:223], v[88:91], v[156:159], a[220:223]
  v_mfma_f32_16x16x32_bf16 a[224:227], v[92:95], v[128:131], a[224:227]
  v_mfma_f32_16x16x32_bf16 a[228:231], v[92:95], v[132:135], a[228:231]
  s_add_u32 s28, s28, 1
  v_mfma_f32_16x16x32_bf16 a[232:235], v[92:95], v[136:139], a[232:235]
  v_mfma_f32_16x16x32_bf16 a[236:239], v[92:95], v[140:143], a[236:239]
  v_mfma_f32_16x16x32_bf16 a[240:243], v[92:95], v[144:147], a[240:243]
  v_mfma_f32_16x16x32_bf16 a[244:247], v[92:95], v[148:151], a[244:247]
  s_cmp_lt_u32 s28, 8
  v_mfma_f32_16x16x32_bf16 a[248:251], v[92:95], v[152:155], a[248:251]
  s_waitcnt lgkmcnt(0)
  v_mfma_f32_16x16x32_bf16 a[252:255], v[92:95], v[156:159], a[252:255]
  s_cbranch_scc1 fa_loopV
  s_mov_b32 s60, 8192
  s_mov_b32 s61, 2048
  s_mov_b32 s62, 33554432
  s_mov_b32 s76, 1.0
fa_p1epi:
  s_lshr_b32 s23, s20, 1
  s_lshl_b32 s23, s23, 13
  v_subrev_u32 v12, s23, v12
  v_subrev_u32 v13, s23, v13
  s_lshl_b32 s24, s20, 12
  v_add_u32 v14, s24, v2
  ds_read_b64_tr_b16 v[32:33], v12 offset:0
  ds_read_b64_tr_b16 v[34:35], v12 offset:1024
  ds_read_b64_tr_b16 v[36:37], v13 offset:0
  ds_read_b64_tr_b16 v[38:39], v13 offset:1024
  ds_read_b64_tr_b16 v[40:41], v12 offset:256
  ds_read_b64_tr_b16 v[42:43], v12 offset:1280
  ds_read_b64_tr_b16 v[44:45], v13 offset:256
  ds_read_b64_tr_b16 v[46:47], v13 offset:1280
  ds_read_b64_tr_b16 v[48:49], v12 offset:512
  ds_read_b64_tr_b16 v[50:51], v12 offset:1536
  ds_read_b64_tr_b16 v[52:53], v13 offset:512
  ds_read_b64_tr_b16 v[54:55], v13 offset:1536
  ds_read_b64_tr_b16 v[56:57], v12 offset:768
  ds_read_b64_tr_b16 v[58:59], v12 offset:1792
  ds_read_b64_tr_b16 v[60:61], v13 offset:768
  ds_read_b64_tr_b16 v[62:63], v13 offset:1792
  s_waitcnt vmcnt(8)
  ds_read_b128 v[224:227], v14 offset:0
  ds_read_b128 v[228:231], v14 offset:1024
  ds_read_b128 v[232:235], v14 offset:2048
  ds_read_b128 v[236:239], v14 offset:3072
  s_lshl_b32 s23, s21, 19
  s_add_u32 s62, s62, s23
  s_lshl_b32 s23, s22, 16
  s_add_u32 s62, s62, s23
  s_and_b32 s23, s20, 1
  s_lshl_b32 s23, s23, 15
  s_add_u32 s62, s62, s23
  s_lshl_b32 s23, s21, 19
  s_add_u32 s23, s23, 16777216
  s_add_u32 s6, s18, s23
  s_addc_u32 s7, s19, 0
  s_add_u32 s8, s6, 16777216
  s_addc_u32 s9, s7, 0
  s_sub_u32 s23, 16, s22
  s_lshl_b32 s23, s23, 15
  s_mov_b32 s44, s6
  s_mov_b32 s45, s7
  s_mov_b32 s46, s23
  s_mov_b32 s47, 0x20000
  s_mov_b32 s48, s8
  s_mov_b32 s49, s9
  s_mov_b32 s50, s23
  s_mov_b32 s51, 0x20000
  s_lshl_b32 s30, s21, 7
  s_add_u32 s30, s30, 2637824
  s_mov_b32 s81, 0x47800000
  s_cmp_eq_u32 s20, 0
  s_cselect_b32 s29, s82, 1073741824
  s_waitcnt vmcnt(21) lgkmcnt(0)
  v_mfma_f32_16x16x32_bf16 v[96:99], v[32:35], v[224:227], 0
  s_mul_i32 s63, s60, 0
  v_accvgpr_read_b32 v16, a0
  v_accvgpr_read_b32 v17, a1
  v_accvgpr_read_b32 v18, a2
  v_mfma_f32_16x16x32_bf16 v[112:115], v[36:39], v[224:227], 0
  s_add_u32 s63, s63, s62
  ds_read_b64_tr_b16 v[64:65], v12 offset:8192
  v_accvgpr_read_b32 v19, a3
  v_accvgpr_read_b32 v20, a32
  v_mfma_f32_16x16x32_bf16 v[128:131], v[40:43], v[224:227], 0
  s_add_u32 m0, s24, 0
  ds_read_b64_tr_b16 v[66:67], v12 offset:9216
  v_accvgpr_read_b32 v21, a33
  v_accvgpr_read_b32 v22, a34
  v_mfma_f32_16x16x32_bf16 v[144:147], v[44:47], v[224:227], 0
  buffer_load_dwordx4 v3, s[32:35], s26 offen offset:0 sc1 lds
  v_accvgpr_read_b32 v23, a35
  v_mul_f32 v16, s76, v16
  v_mfma_f32_16x16x32_bf16 v[160:163], v[48:51], v[224:227], 0
  ds_read_b64_tr_b16 v[68:69], v13 offset:8192
  v_mul_f32 v17, s76, v17
  v_mul_f32 v18, s76, v18
  v_mfma_f32_16x16x32_bf16 v[176:179], v[52:55], v[224:227], 0
  ds_read_b64_tr_b16 v[70:71], v13 offset:9216
  v_mul_f32 v19, s76, v19
  v_mul_f32 v20, s76, v20
  v_mfma_f32_16x16x32_bf16 v[192:195], v[56:59], v[224:227], 0
  ds_read_b64_tr_b16 v[72:73], v12 offset:8448
  v_mul_f32 v21, s76, v21
  v_mul_f32 v22, s76, v22
  v_mfma_f32_16x16x32_bf16 v[208:211], v[60:63], v[224:227], 0
  ds_read_b64_tr_b16 v[74:75], v12 offset:9472
  v_mul_f32 v23, s76, v23
  v_cvt_pk_bf16_f32 v24, v16, v17
  v_mfma_f32_16x16x32_bf16 v[100:103], v[32:35], v[228:231], 0
  buffer_load_dwordx4 v4, s[32:35], s26 offen offset:1024 sc1 lds
  v_cvt_pk_bf16_f32 v25, v18, v19
  v_cvt_pk_bf16_f32 v26, v20, v21
  v_mfma_f32_16x16x32_bf16 v[116:119], v[36:39], v[228:231], 0
  ds_read_b64_tr_b16 v[76:77], v13 offset:8448
  v_cvt_pk_bf16_f32 v27, v22, v23
  v_mfma_f32_16x16x32_bf16 v[132:135], v[40:43], v[228:231], 0
  ds_read_b64_tr_b16 v[78:79], v13 offset:9472
  buffer_store_dwordx4 v[24:27], v2, s[40:43], s63 offen offset:0 sc1
  v_accvgpr_read_b32 v16, a4
  v_mfma_f32_16x16x32_bf16 v[148:151], v[44:47], v[228:231], 0
  ds_read_b128 v[240:243], v14 offset:32768
  v_accvgpr_read_b32 v17, a5
  v_accvgpr_read_b32 v18, a6
  v_mfma_f32_16x16x32_bf16 v[164:167], v[48:51], v[228:231], 0
  ds_read_b128 v[244:247], v14 offset:33792
  v_accvgpr_read_b32 v19, a7
  v_accvgpr_read_b32 v20, a36
  v_mfma_f32_16x16x32_bf16 v[180:183], v[52:55], v[228:231], 0
  buffer_load_dwordx4 v5, s[32:35], s26 offen offset:2048 sc1 lds
  v_accvgpr_read_b32 v21, a37
  v_accvgpr_read_b32 v22, a38
  v_mfma_f32_16x16x32_bf16 v[196:199], v[56:59], v[228:231], 0
  ds_read_b64_tr_b16 v[80:81], v12 offset:8704
  v_accvgpr_read_b32 v23, a39
  v_mul_f32 v16, s76, v16
  v_mfma_f32_16x16x32_bf16 v[212:215], v[60:63], v[228:231], 0
  ds_read_b64_tr_b16 v[82:83], v12 offset:9728
  v_mul_f32 v17, s76, v17
  v_mul_f32 v18, s76, v18
  v_mfma_f32_16x16x32_bf16 v[104:107], v[32:35], v[232:235], 0
  ds_read_b64_tr_b16 v[84:85], v13 offset:8704
  v_mul_f32 v19, s76, v19
  v_mul_f32 v20, s76, v20
  v_mfma_f32_16x16x32_bf16 v[120:123], v[36:39], v[232:235], 0
  ds_read_b64_tr_b16 v[86:87], v13 offset:9728
  v_mul_f32 v21, s76, v21
  v_mul_f32 v22, s76, v22
  v_mfma_f32_16x16x32_bf16 v[136:139], v[40:43], v[232:235], 0
  buffer_load_dwordx4 v6, s[32:35], s26 offen offset:3072 sc1 lds
  v_mul_f32 v23, s76, v23
  v_cvt_pk_bf16_f32 v28, v16, v17
  v_mfma_f32_16x16x32_bf16 v[152:155], v[44:47], v[232:235], 0
  s_add_u32 s26, s26, 1024
  ds_read_b64_tr_b16 v[88:89], v12 offset:8960
  v_cvt_pk_bf16_f32 v29, v18, v19
  v_cvt_pk_bf16_f32 v30, v20, v21
  v_mfma_f32_16x16x32_bf16 v[168:171], v[48:51], v[232:235], 0
  ds_read_b64_tr_b16 v[90:91], v12 offset:9984
  v_cvt_pk_bf16_f32 v31, v22, v23
  v_mfma_f32_16x16x32_bf16 v[184:187], v[52:55], v[232:235], 0
  ds_read_b64_tr_b16 v[92:93], v13 offset:8960
  buffer_store_dwordx4 v[28:31], v2, s[40:43], s63 offen offset:1024 sc1
  v_accvgpr_read_b32 v16, a8
  v_mfma_f32_16x16x32_bf16 v[200:203], v[56:59], v[232:235], 0
  s_add_u32 s63, s63, s61
  ds_read_b64_tr_b16 v[94:95], v13 offset:9984
  v_accvgpr_read_b32 v17, a9
  v_accvgpr_read_b32 v18, a10
  v_mfma_f32_16x16x32_bf16 v[216:219], v[60:63], v[232:235], 0
  v_accvgpr_read_b32 v19, a11
  v_accvgpr_read_b32 v20, a40
  v_accvgpr_read_b32 v21, a41
  v_mfma_f32_16x16x32_bf16 v[108:111], v[32:35], v[236:239], 0
  ds_read_b128 v[248:251], v14 offset:34816
  v_accvgpr_read_b32 v22, a42
  v_accvgpr_read_b32 v23, a43
  v_mfma_f32_16x16x32_bf16 v[124:127], v[36:39], v[236:239], 0
  ds_read_b128 v[252:255], v14 offset:35840
  v_mul_f32 v16, s76, v16
  v_mul_f32 v17, s76, v17
  v_mfma_f32_16x16x32_bf16 v[140:143], v[40:43], v[236:239], 0
  v_mul_f32 v18, s76, v18
  v_mul_f32 v19, s76, v19
  v_mul_f32 v20, s76, v20
  v_mfma_f32_16x16x32_bf16 v[156:159], v[44:47], v[236:239], 0
  v_xor_b32 v14, 0x10000, v14
  v_mul_f32 v21, s76, v21
  v_mul_f32 v22, s76, v22
  v_mfma_f32_16x16x32_bf16 v[172:175], v[48:51], v[236:239], 0
  v_mul_f32 v23, s76, v23
  v_cvt_pk_bf16_f32 v24, v16, v17
  v_cvt_pk_bf16_f32 v25, v18, v19
  v_mfma_f32_16x16x32_bf16 v[188:191], v[52:55], v[236:239], 0
  v_cvt_pk_bf16_f32 v26, v20, v21
  v_cvt_pk_bf16_f32 v27, v22, v23
  v_mfma_f32_16x16x32_bf16 v[204:207], v[56:59], v[236:239], 0
  buffer_store_dwordx4 v[24:27], v2, s[40:43], s63 offen offset:0 sc1
  v_mfma_f32_16x16x32_bf16 v[220:223], v[60:63], v[236:239], 0
  s_waitcnt vmcnt(20) lgkmcnt(0)
  v_mfma_f32_16x16x32_bf16 v[96:99], v[64:67], v[240:243], v[96:99]
  s_barrier
  v_accvgpr_read_b32 v16, a12
  v_accvgpr_read_b32 v17, a13
  v_accvgpr_read_b32 v18, a14
  v_accvgpr_read_b32 v19, a15
  v_mfma_f32_16x16x32_bf16 v[112:115], v[68:71], v[240:243], v[112:115]
  ds_read_b64_tr_b16 v[32:33], v12 offset:32768
  v_accvgpr_read_b32 v20, a44
  v_accvgpr_read_b32 v21, a45
  v_mfma_f32_16x16x32_bf16 v[128:131], v[72:75], v[240:243], v[128:131]
  s_add_u32 m0, s24, 32768
  ds_read_b64_tr_b16 v[34:35], v12 offset:33792
  v_accvgpr_read_b32 v22, a46
  v_accvgpr_read_b32 v23, a47
  v_mfma_f32_16x16x32_bf16 v[144:147], v[76:79], v[240:243], v[144:147]
  buffer_load_dwordx4 v3, s[32:35], s26 offen offset:0 sc1 lds
  v_mul_f32 v16, s76, v16
  v_mul_f32 v17, s76, v17
  v_mfma_f32_16x16x32_bf16 v[160:163], v[80:83], v[240:243], v[160:163]
  ds_read_b64_tr_b16 v[36:37], v13 offset:32768
  v_mul_f32 v18, s76, v18
  v_mul_f32 v19, s76, v19
  v_mfma_f32_16x16x32_bf16 v[176:179], v[84:87], v[240:243], v[176:179]
  ds_read_b64_tr_b16 v[38:39], v13 offset:33792
  v_mul_f32 v20, s76, v20
  v_mul_f32 v21, s76, v21
  v_mfma_f32_16x16x32_bf16 v[192:195], v[88:91], v[240:243], v[192:195]
  ds_read_b64_tr_b16 v[40:41], v12 offset:33024
  v_mul_f32 v22, s76, v22
  v_mul_f32 v23, s76, v23
  v_mfma_f32_16x16x32_bf16 v[208:211], v[92:95], v[240:243], v[208:211]
  ds_read_b64_tr_b16 v[42:43], v12 offset:34048
  v_cvt_pk_bf16_f32 v28, v16, v17
  v_cvt_pk_bf16_f32 v29, v18, v19
  v_mfma_f32_16x16x32_bf16 v[100:103], v[64:67], v[244:247], v[100:103]
  buffer_load_dwordx4 v4, s[32:35], s26 offen offset:1024 sc1 lds
  v_cvt_pk_bf16_f32 v30, v20, v21
  v_cvt_pk_bf16_f32 v31, v22, v23
  v_mfma_f32_16x16x32_bf16 v[116:119], v[68:71], v[244:247], v[116:119]
  ds_read_b64_tr_b16 v[44:45], v13 offset:33024
  buffer_store_dwordx4 v[28:31], v2, s[40:43], s63 offen offset:1024 sc1
  v_accvgpr_read_b32 v16, a16
  v_mfma_f32_16x16x32_bf16 v[132:135], v[72:75], v[244:247], v[132:135]
  s_add_u32 s63, s63, s61
  ds_read_b64_tr_b16 v[46:47], v13 offset:34048
  v_accvgpr_read_b32 v17, a17
  v_accvgpr_read_b32 v18, a18
  v_mfma_f32_16x16x32_bf16 v[148:151], v[76:79], v[244:247], v[148:151]
  ds_read_b128 v[224:227], v14 offset:0
  v_accvgpr_read_b32 v19, a19
  v_accvgpr_read_b32 v20, a48
  v_mfma_f32_16x16x32_bf16 v[164:167], v[80:83], v[244:247], v[164:167]
  ds_read_b128 v[228:231], v14 offset:1024
  v_accvgpr_read_b32 v21, a49
  v_accvgpr_read_b32 v22, a50
  v_mfma_f32_16x16x32_bf16 v[180:183], v[84:87], v[244:247], v[180:183]
  buffer_load_dwordx4 v5, s[32:35], s26 offen offset:2048 sc1 lds
  v_accvgpr_read_b32 v23, a51
  v_mul_f32 v16, s76, v16
  v_mfma_f32_16x16x32_bf16 v[196:199], v[88:91], v[244:247], v[196:199]
  ds_read_b64_tr_b16 v[48:49], v12 offset:33280
  v_mul_f32 v17, s76, v17
  v_mul_f32 v18, s76, v18
  v_mfma_f32_16x16x32_bf16 v[212:215], v[92:95], v[244:247], v[212:215]
  ds_read_b64_tr_b16 v[50:51], v12 offset:34304
  v_mul_f32 v19, s76, v19
  v_mul_f32 v20, s76, v20
  v_mfma_f32_16x16x32_bf16 v[104:107], v[64:67], v[248:251], v[104:107]
  ds_read_b64_tr_b16 v[52:53], v13 offset:33280
  v_mul_f32 v21, s76, v21
  v_mul_f32 v22, s76, v22
  v_mfma_f32_16x16x32_bf16 v[120:123], v[68:71], v[248:251], v[120:123]
  ds_read_b64_tr_b16 v[54:55], v13 offset:34304
  v_mul_f32 v23, s76, v23
  v_cvt_pk_bf16_f32 v24, v16, v17
  v_mfma_f32_16x16x32_bf16 v[136:139], v[72:75], v[248:251], v[136:139]
  buffer_load_dwordx4 v6, s[32:35], s26 offen offset:3072 sc1 lds
  v_cvt_pk_bf16_f32 v25, v18, v19
  v_cvt_pk_bf16_f32 v26, v20, v21
  v_mfma_f32_16x16x32_bf16 v[152:155], v[76:79], v[248:251], v[152:155]
  s_add_u32 s26, s26, 1024
  ds_read_b64_tr_b16 v[56:57], v12 offset:33536
  v_cvt_pk_bf16_f32 v27, v22, v23
  v_mfma_f32_16x16x32_bf16 v[168:171], v[80:83], v[248:251], v[168:171]
  ds_read_b64_tr_b16 v[58:59], v12 offset:34560
  buffer_store_dwordx4 v[24:27], v2, s[40:43], s63 offen offset:0 sc1
  v_accvgpr_read_b32 v16, a20
  v_mfma_f32_16x16x32_bf16 v[184:187], v[84:87], v[248:251], v[184:187]
  ds_read_b64_tr_b16 v[60:61], v13 offset:33536
  v_accvgpr_read_b32 v17, a21
  v_accvgpr_read_b32 v18, a22
  v_mfma_f32_16x16x32_bf16 v[200:203], v[88:91], v[248:251], v[200:203]
  s_add_u32 m0, s24, 16384
  ds_read_b64_tr_b16 v[62:63], v13 offset:34560
  v_accvgpr_read_b32 v19, a23
  v_accvgpr_read_b32 v20, a52
  v_mfma_f32_16x16x32_bf16 v[216:219], v[92:95], v[248:251], v[216:219]
  buffer_load_dwordx4 v8, s[36:39], s27 offen offset:0 lds
  v_accvgpr_read_b32 v21, a53
  v_accvgpr_read_b32 v22, a54
  v_mfma_f32_16x16x32_bf16 v[108:111], v[64:67], v[252:255], v[108:111]
  ds_read_b128 v[232:235], v14 offset:2048
  v_accvgpr_read_b32 v23, a55
  v_mul_f32 v16, s76, v16
  v_mfma_f32_16x16x32_bf16 v[124:127], v[68:71], v[252:255], v[124:127]
  ds_read_b128 v[236:239], v14 offset:3072
  v_mul_f32 v17, s76, v17
  v_mul_f32 v18, s76, v18
  v_mfma_f32_16x16x32_bf16 v[140:143], v[72:75], v[252:255], v[140:143]
  v_mul_f32 v19, s76, v19
  v_mul_f32 v20, s76, v20
  v_mul_f32 v21, s76, v21
  v_mfma_f32_16x16x32_bf16 v[156:159], v[76:79], v[252:255], v[156:159]
  v_mul_f32 v22, s76, v22
  v_mul_f32 v23, s76, v23
  v_cvt_pk_bf16_f32 v28, v16, v17
  v_mfma_f32_16x16x32_bf16 v[172:175], v[80:83], v[252:255], v[172:175]
  buffer_load_dwordx4 v9, s[36:39], s27 offen offset:1024 lds
  v_cvt_pk_bf16_f32 v29, v18, v19
  v_cvt_pk_bf16_f32 v30, v20, v21
  v_mfma_f32_16x16x32_bf16 v[188:191], v[84:87], v[252:255], v[188:191]
  v_cvt_pk_bf16_f32 v31, v22, v23
  v_mfma_f32_16x16x32_bf16 v[204:207], v[88:91], v[252:255], v[204:207]
  buffer_store_dwordx4 v[28:31], v2, s[40:43], s63 offen offset:1024 sc1
  v_mfma_f32_16x16x32_bf16 v[220:223], v[92:95], v[252:255], v[220:223]
  s_waitcnt vmcnt(20) lgkmcnt(0)
  v_mfma_f32_16x16x32_bf16 v[96:99], v[32:35], v[224:227], v[96:99]
  s_add_u32 s63, s63, s61
  v_accvgpr_read_b32 v16, a24
  v_accvgpr_read_b32 v17, a25
  v_accvgpr_read_b32 v18, a26
  v_accvgpr_read_b32 v19, a27
  v_mfma_f32_16x16x32_bf16 v[112:115], v[36:39], v[224:227], v[112:115]
  ds_read_b64_tr_b16 v[64:65], v12 offset:40960
  v_accvgpr_read_b32 v20, a56
  v_accvgpr_read_b32 v21, a57
  v_mfma_f32_16x16x32_bf16 v[128:131], v[40:43], v[224:227], v[128:131]
  s_add_u32 m0, s24, 65536
  ds_read_b64_tr_b16 v[66:67], v12 offset:41984
  v_accvgpr_read_b32 v22, a58
  v_accvgpr_read_b32 v23, a59
  v_mfma_f32_16x16x32_bf16 v[144:147], v[44:47], v[224:227], v[144:147]
  buffer_load_dwordx4 v3, s[32:35], s26 offen offset:0 sc1 lds
  v_mul_f32 v16, s76, v16
  v_mul_f32 v17, s76, v17
  v_mfma_f32_16x16x32_bf16 v[160:163], v[48:51], v[224:227], v[160:163]
  ds_read_b64_tr_b16 v[68:69], v13 offset:40960
  v_mul_f32 v18, s76, v18
  v_mul_f32 v19, s76, v19
  v_mfma_f32_16x16x32_bf16 v[176:179], v[52:55], v[224:227], v[176:179]
  ds_read_b64_tr_b16 v[70:71], v13 offset:41984
  v_mul_f32 v20, s76, v20
  v_mul_f32 v21, s76, v21
  v_mfma_f32_16x16x32_bf16 v[192:195], v[56:59], v[224:227], v[192:195]
  ds_read_b64_tr_b16 v[72:73], v12 offset:41216
  v_mul_f32 v22, s76, v22
  v_mul_f32 v23, s76, v23
  v_mfma_f32_16x16x32_bf16 v[208:211], v[60:63], v[224:227], v[208:211]
  ds_read_b64_tr_b16 v[74:75], v12 offset:42240
  v_cvt_pk_bf16_f32 v24, v16, v17
  v_cvt_pk_bf16_f32 v25, v18, v19
  v_cvt_pk_bf16_f32 v26, v20, v21
  v_mfma_f32_16x16x32_bf16 v[100:103], v[32:35], v[228:231], v[100:103]
  buffer_load_dwordx4 v4, s[32:35], s26 offen offset:1024 sc1 lds
  v_cvt_pk_bf16_f32 v27, v22, v23
  v_mfma_f32_16x16x32_bf16 v[116:119], v[36:39], v[228:231], v[116:119]
  ds_read_b64_tr_b16 v[76:77], v13 offset:41216
  buffer_store_dwordx4 v[24:27], v2, s[40:43], s63 offen offset:0 sc1
  v_accvgpr_read_b32 v16, a28
  v_mfma_f32_16x16x32_bf16 v[132:135], v[40:43], v[228:231], v[132:135]
  ds_read_b64_tr_b16 v[78:79], v13 offset:42240
  v_accvgpr_read_b32 v17, a29
  v_accvgpr_read_b32 v18, a30
  v_mfma_f32_16x16x32_bf16 v[148:151], v[44:47], v[228:231], v[148:151]
  ds_read_b128 v[240:243], v14 offset:32768
  v_accvgpr_read_b32 v19, a31
  v_accvgpr_read_b32 v20, a60
  v_mfma_f32_16x16x32_bf16 v[164:167], v[48:51], v[228:231], v[164:167]
  ds_read_b128 v[244:247], v14 offset:33792
  v_accvgpr_read_b32 v21, a61
  v_accvgpr_read_b32 v22, a62
  v_mfma_f32_16x16x32_bf16 v[180:183], v[52:55], v[228:231], v[180:183]
  buffer_load_dwordx4 v5, s[32:35], s26 offen offset:2048 sc1 lds
  v_accvgpr_read_b32 v23, a63
  v_mul_f32 v16, s76, v16
  v_mfma_f32_16x16x32_bf16 v[196:199], v[56:59], v[228:231], v[196:199]
  ds_read_b64_tr_b16 v[80:81], v12 offset:41472
  v_mul_f32 v17, s76, v17
  v_mul_f32 v18, s76, v18
  v_mfma_f32_16x16x32_bf16 v[212:215], v[60:63], v[228:231], v[212:215]
  ds_read_b64_tr_b16 v[82:83], v12 offset:42496
  v_mul_f32 v19, s76, v19
  v_mul_f32 v20, s76, v20
  v_mul_f32 v21, s76, v21
  v_mfma_f32_16x16x32_bf16 v[104:107], v[32:35], v[232:235], v[104:107]
  ds_read_b64_tr_b16 v[84:85], v13 offset:41472
  v_mul_f32 v22, s76, v22
  v_mul_f32 v23, s76, v23
  v_mfma_f32_16x16x32_bf16 v[120:123], v[36:39], v[232:235], v[120:123]
  ds_read_b64_tr_b16 v[86:87], v13 offset:42496
  v_cvt_pk_bf16_f32 v28, v16, v17
  v_cvt_pk_bf16_f32 v29, v18, v19
  v_mfma_f32_16x16x32_bf16 v[136:139], v[40:43], v[232:235], v[136:139]
  buffer_load_dwordx4 v6, s[32:35], s26 offen offset:3072 sc1 lds
  v_cvt_pk_bf16_f32 v30, v20, v21
  v_cvt_pk_bf16_f32 v31, v22, v23
  v_mfma_f32_16x16x32_bf16 v[152:155], v[44:47], v[232:235], v[152:155]
  s_add_u32 s26, s26, 1024
  ds_read_b64_tr_b16 v[88:89], v12 offset:41728
  buffer_store_dwordx4 v[28:31], v2, s[40:43], s63 offen offset:1024 sc1
  v_accvgpr_read_b32 v16, a64
  v_mfma_f32_16x16x32_bf16 v[168:171], v[48:51], v[232:235], v[168:171]
  s_mul_i32 s63, s60, 1
  ds_read_b64_tr_b16 v[90:91], v12 offset:42752
  v_accvgpr_read_b32 v17, a65
  v_accvgpr_read_b32 v18, a66
  v_mfma_f32_16x16x32_bf16 v[184:187], v[52:55], v[232:235], v[184:187]
  s_add_u32 s63, s63, s62
  ds_read_b64_tr_b16 v[92:93], v13 offset:41728
  v_accvgpr_read_b32 v19, a67
  v_accvgpr_read_b32 v20, a96
  v_mfma_f32_16x16x32_bf16 v[200:203], v[56:59], v[232:235], v[200:203]
  s_add_u32 m0, s24, 16384
  ds_read_b64_tr_b16 v[94:95], v13 offset:42752
  v_accvgpr_read_b32 v21, a97
  v_accvgpr_read_b32 v22, a98
  v_accvgpr_read_b32 v23, a99
  v_mfma_f32_16x16x32_bf16 v[216:219], v[60:63], v[232:235], v[216:219]
  buffer_load_dwordx4 v10, s[36:39], s27 offen offset:2048 lds
  v_mul_f32 v16, s76, v16
  v_mul_f32 v17, s76, v17
  v_mfma_f32_16x16x32_bf16 v[108:111], v[32:35], v[236:239], v[108:111]
  ds_read_b128 v[248:251], v14 offset:34816
  v_mul_f32 v18, s76, v18
  v_mul_f32 v19, s76, v19
  v_mfma_f32_16x16x32_bf16 v[124:127], v[36:39], v[236:239], v[124:127]
  ds_read_b128 v[252:255], v14 offset:35840
  v_mul_f32 v20, s76, v20
  v_mul_f32 v21, s76, v21
  v_mfma_f32_16x16x32_bf16 v[140:143], v[40:43], v[236:239], v[140:143]
  v_mul_f32 v22, s76, v22
  v_mul_f32 v23, s76, v23
  v_cvt_pk_bf16_f32 v24, v16, v17
  v_mfma_f32_16x16x32_bf16 v[156:159], v[44:47], v[236:239], v[156:159]
  v_xor_b32 v14, 0x10000, v14
  v_cvt_pk_bf16_f32 v25, v18, v19
  v_cvt_pk_bf16_f32 v26, v20, v21
  v_mfma_f32_16x16x32_bf16 v[172:175], v[48:51], v[236:239], v[172:175]
  buffer_load_dwordx4 v11, s[36:39], s27 offen offset:3072 lds
  v_cvt_pk_bf16_f32 v27, v22, v23
  v_mfma_f32_16x16x32_bf16 v[188:191], v[52:55], v[236:239], v[188:191]
  s_add_u32 s27, s27, 524288
  buffer_store_dwordx4 v[24:27], v2, s[40:43], s63 offen offset:0 sc1
  v_xor_b32 v12, 0x10000, v12
  v_mfma_f32_16x16x32_bf16 v[204:207], v[56:59], v[236:239], v[204:207]
  v_xor_b32 v13, 0x10000, v13
  v_mfma_f32_16x16x32_bf16 v[220:223], v[60:63], v[236:239], v[220:223]
  s_waitcnt vmcnt(20) lgkmcnt(0)
  v_mfma_f32_16x16x32_bf16 v[96:99], v[64:67], v[240:243], v[96:99]
  s_barrier
  v_accvgpr_read_b32 v16, a68
  v_accvgpr_read_b32 v17, a69
  v_accvgpr_read_b32 v18, a70
  v_accvgpr_read_b32 v19, a71
  v_mfma_f32_16x16x32_bf16 v[112:115], v[68:71], v[240:243], v[112:115]
  ds_read_b64_tr_b16 v[32:33], v12 offset:0
  v_accvgpr_read_b32 v20, a100
  v_accvgpr_read_b32 v21, a101
  v_mfma_f32_16x16x32_bf16 v[128:131], v[72:75], v[240:243], v[128:131]
  s_add_u32 m0, s24, 98304
  ds_read_b64_tr_b16 v[34:35], v12 offset:1024
  v_accvgpr_read_b32 v22, a102
  v_accvgpr_read_b32 v23, a103
  v_mfma_f32_16x16x32_bf16 v[144:147], v[76:79], v[240:243], v[144:147]
  buffer_load_dwordx4 v3, s[32:35], s26 offen offset:0 sc1 lds
  v_mul_f32 v16, s76, v16
  v_mul_f32 v17, s76, v17
  v_mfma_f32_16x16x32_bf16 v[160:163], v[80:83], v[240:243], v[160:163]
  ds_read_b64_tr_b16 v[36:37], v13 offset:0
  v_mul_f32 v18, s76, v18
  v_mul_f32 v19, s76, v19
  v_mfma_f32_16x16x32_bf16 v[176:179], v[84:87], v[240:243], v[176:179]
  ds_read_b64_tr_b16 v[38:39], v13 offset:1024
  v_mul_f32 v20, s76, v20
  v_mul_f32 v21, s76, v21
  v_mfma_f32_16x16x32_bf16 v[192:195], v[88:91], v[240:243], v[192:195]
  ds_read_b64_tr_b16 v[40:41], v12 offset:256
  v_mul_f32 v22, s76, v22
  v_mul_f32 v23, s76, v23
  v_mfma_f32_16x16x32_bf16 v[208:211], v[92:95], v[240:243], v[208:211]
  ds_read_b64_tr_b16 v[42:43], v12 offset:1280
  v_cvt_pk_bf16_f32 v28, v16, v17
  v_cvt_pk_bf16_f32 v29, v18, v19
  v_mfma_f32_16x16x32_bf16 v[100:103], v[64:67], v[244:247], v[100:103]
  buffer_load_dwordx4 v4, s[32:35], s26 offen offset:1024 sc1 lds
  v_cvt_pk_bf16_f32 v30, v20, v21
  v_cvt_pk_bf16_f32 v31, v22, v23
  v_mfma_f32_16x16x32_bf16 v[116:119], v[68:71], v[244:247], v[116:119]
  ds_read_b64_tr_b16 v[44:45], v13 offset:256
  buffer_store_dwordx4 v[28:31], v2, s[40:43], s63 offen offset:1024 sc1
  v_accvgpr_read_b32 v16, a72
  v_mfma_f32_16x16x32_bf16 v[132:135], v[72:75], v[244:247], v[132:135]
  s_add_u32 s63, s63, s61
  ds_read_b64_tr_b16 v[46:47], v13 offset:1280
  v_accvgpr_read_b32 v17, a73
  v_accvgpr_read_b32 v18, a74
  v_mfma_f32_16x16x32_bf16 v[148:151], v[76:79], v[244:247], v[148:151]
  ds_read_b128 v[224:227], v14 offset:0
  v_accvgpr_read_b32 v19, a75
  v_accvgpr_read_b32 v20, a104
  v_mfma_f32_16x16x32_bf16 v[164:167], v[80:83], v[244:247], v[164:167]
  ds_read_b128 v[228:231], v14 offset:1024
  v_accvgpr_read_b32 v21, a105
  v_accvgpr_read_b32 v22, a106
  v_mfma_f32_16x16x32_bf16 v[180:183], v[84:87], v[244:247], v[180:183]
  buffer_load_dwordx4 v5, s[32:35], s26 offen offset:2048 sc1 lds
  v_accvgpr_read_b32 v23, a107
  v_mul_f32 v16, s76, v16
  v_mfma_f32_16x16x32_bf16 v[196:199], v[88:91], v[244:247], v[196:199]
  ds_read_b64_tr_b16 v[48:49], v12 offset:512
  v_mul_f32 v17, s76, v17
  v_mul_f32 v18, s76, v18
  v_mfma_f32_16x16x32_bf16 v[212:215], v[92:95], v[244:247], v[212:215]
  ds_read_b64_tr_b16 v[50:51], v12 offset:1536
  v_mul_f32 v19, s76, v19
  v_mul_f32 v20, s76, v20
  v_mfma_f32_16x16x32_bf16 v[104:107], v[64:67], v[248:251], v[104:107]
  ds_read_b64_tr_b16 v[52:53], v13 offset:512
  v_mul_f32 v21, s76, v21
  v_mul_f32 v22, s76, v22
  v_mfma_f32_16x16x32_bf16 v[120:123], v[68:71], v[248:251], v[120:123]
  ds_read_b64_tr_b16 v[54:55], v13 offset:1536
  v_mul_f32 v23, s76, v23
  v_cvt_pk_bf16_f32 v24, v16, v17
  v_mfma_f32_16x16x32_bf16 v[136:139], v[72:75], v[248:251], v[136:139]
  buffer_load_dwordx4 v6, s[32:35], s26 offen offset:3072 sc1 lds
  v_cvt_pk_bf16_f32 v25, v18, v19
  v_cvt_pk_bf16_f32 v26, v20, v21
  v_mfma_f32_16x16x32_bf16 v[152:155], v[76:79], v[248:251], v[152:155]
  s_add_u32 s26, s26, 1024
  ds_read_b64_tr_b16 v[56:57], v12 offset:768
  v_cvt_pk_bf16_f32 v27, v22, v23
  v_mfma_f32_16x16x32_bf16 v[168:171], v[80:83], v[248:251], v[168:171]
  ds_read_b64_tr_b16 v[58:59], v12 offset:1792
  buffer_store_dwordx4 v[24:27], v2, s[40:43], s63 offen offset:0 sc1
  v_accvgpr_read_b32 v16, a76
  v_mfma_f32_16x16x32_bf16 v[184:187], v[84:87], v[248:251], v[184:187]
  ds_read_b64_tr_b16 v[60:61], v13 offset:768
  v_accvgpr_read_b32 v17, a77
  v_accvgpr_read_b32 v18, a78
  v_mfma_f32_16x16x32_bf16 v[200:203], v[88:91], v[248:251], v[200:203]
  s_add_u32 m0, s24, 49152
  ds_read_b64_tr_b16 v[62:63], v13 offset:1792
  v_accvgpr_read_b32 v19, a79
  v_accvgpr_read_b32 v20, a108
  v_mfma_f32_16x16x32_bf16 v[216:219], v[92:95], v[248:251], v[216:219]
  buffer_load_dwordx4 v8, s[36:39], s27 offen offset:0 lds
  v_accvgpr_read_b32 v21, a109
  v_accvgpr_read_b32 v22, a110
  v_mfma_f32_16x16x32_bf16 v[108:111], v[64:67], v[252:255], v[108:111]
  ds_read_b128 v[232:235], v14 offset:2048
  v_accvgpr_read_b32 v23, a111
  v_mul_f32 v16, s76, v16
  v_mfma_f32_16x16x32_bf16 v[124:127], v[68:71], v[252:255], v[124:127]
  ds_read_b128 v[236:239], v14 offset:3072
  v_mul_f32 v17, s76, v17
  v_mul_f32 v18, s76, v18
  v_mfma_f32_16x16x32_bf16 v[140:143], v[72:75], v[252:255], v[140:143]
  v_mul_f32 v19, s76, v19
  v_mul_f32 v20, s76, v20
  v_mul_f32 v21, s76, v21
  v_mfma_f32_16x16x32_bf16 v[156:159], v[76:79], v[252:255], v[156:159]
  v_mul_f32 v22, s76, v22
  v_mul_f32 v23, s76, v23
  v_cvt_pk_bf16_f32 v28, v16, v17
  v_mfma_f32_16x16x32_bf16 v[172:175], v[80:83], v[252:255], v[172:175]
  buffer_load_dwordx4 v9, s[36:39], s27 offen offset:1024 lds
  v_cvt_pk_bf16_f32 v29, v18, v19
  v_cvt_pk_bf16_f32 v30, v20, v21
  v_mfma_f32_16x16x32_bf16 v[188:191], v[84:87], v[252:255], v[188:191]
  v_cvt_pk_bf16_f32 v31, v22, v23
  v_mfma_f32_16x16x32_bf16 v[204:207], v[88:91], v[252:255], v[204:207]
  buffer_store_dwordx4 v[28:31], v2, s[40:43], s63 offen offset:1024 sc1
  v_mfma_f32_16x16x32_bf16 v[220:223], v[92:95], v[252:255], v[220:223]
  s_waitcnt vmcnt(22) lgkmcnt(0)
  v_mfma_f32_16x16x32_bf16 v[96:99], v[32:35], v[224:227], v[96:99]
  s_add_u32 s63, s63, s61
  v_accvgpr_read_b32 v16, a80
  v_accvgpr_read_b32 v17, a81
  v_accvgpr_read_b32 v18, a82
  v_accvgpr_read_b32 v19, a83
  v_mfma_f32_16x16x32_bf16 v[112:115], v[36:39], v[224:227], v[112:115]
  ds_read_b64_tr_b16 v[64:65], v12 offset:8192
  v_accvgpr_read_b32 v20, a112
  v_accvgpr_read_b32 v21, a113
  v_mfma_f32_16x16x32_bf16 v[128:131], v[40:43], v[224:227], v[128:131]
  s_add_u32 m0, s24, 0
  ds_read_b64_tr_b16 v[66:67], v12 offset:9216
  v_accvgpr_read_b32 v22, a114
  v_accvgpr_read_b32 v23, a115
  v_mfma_f32_16x16x32_bf16 v[144:147], v[44:47], v[224:227], v[144:147]
  buffer_load_dwordx4 v3, s[32:35], s26 offen offset:0 sc1 lds
  v_mul_f32 v16, s76, v16
  v_mul_f32 v17, s76, v17
  v_mfma_f32_16x16x32_bf16 v[160:163], v[48:51], v[224:227], v[160:163]
  ds_read_b64_tr_b16 v[68:69], v13 offset:8192
  v_mul_f32 v18, s76, v18
  v_mul_f32 v19, s76, v19
  v_mfma_f32_16x16x32_bf16 v[176:179], v[52:55], v[224:227], v[176:179]
  ds_read_b64_tr_b16 v[70:71], v13 offset:9216
  v_mul_f32 v20, s76, v20
  v_mul_f32 v21, s76, v21
  v_mfma_f32_16x16x32_bf16 v[192:195], v[56:59], v[224:227], v[192:195]
  ds_read_b64_tr_b16 v[72:73], v12 offset:8448
  v_mul_f32 v22, s76, v22
  v_mul_f32 v23, s76, v23
  v_mfma_f32_16x16x32_bf16 v[208:211], v[60:63], v[224:227], v[208:211]
  ds_read_b64_tr_b16 v[74:75], v12 offset:9472
  v_cvt_pk_bf16_f32 v24, v16, v17
  v_cvt_pk_bf16_f32 v25, v18, v19
  v_mfma_f32_16x16x32_bf16 v[100:103], v[32:35], v[228:231], v[100:103]
  buffer_load_dwordx4 v4, s[32:35], s26 offen offset:1024 sc1 lds
  v_cvt_pk_bf16_f32 v26, v20, v21
  v_cvt_pk_bf16_f32 v27, v22, v23
  v_mfma_f32_16x16x32_bf16 v[116:119], v[36:39], v[228:231], v[116:119]
  ds_read_b64_tr_b16 v[76:77], v13 offset:8448
  buffer_store_dwordx4 v[24:27], v2, s[40:43], s63 offen offset:0 sc1
  v_accvgpr_read_b32 v16, a84
  v_mfma_f32_16x16x32_bf16 v[132:135], v[40:43], v[228:231], v[132:135]
  ds_read_b64_tr_b16 v[78:79], v13 offset:9472
  v_accvgpr_read_b32 v17, a85
  v_accvgpr_read_b32 v18, a86
  v_mfma_f32_16x16x32_bf16 v[148:151], v[44:47], v[228:231], v[148:151]
  ds_read_b128 v[240:243], v14 offset:32768
  v_accvgpr_read_b32 v19, a87
  v_accvgpr_read_b32 v20, a116
  v_mfma_f32_16x16x32_bf16 v[164:167], v[48:51], v[228:231], v[164:167]
  ds_read_b128 v[244:247], v14 offset:33792
  v_accvgpr_read_b32 v21, a117
  v_accvgpr_read_b32 v22, a118
  v_mfma_f32_16x16x32_bf16 v[180:183], v[52:55], v[228:231], v[180:183]
  buffer_load_dwordx4 v5, s[32:35], s26 offen offset:2048 sc1 lds
  v_accvgpr_read_b32 v23, a119
  v_mul_f32 v16, s76, v16
  v_mfma_f32_16x16x32_bf16 v[196:199], v[56:59], v[228:231], v[196:199]
  ds_read_b64_tr_b16 v[80:81], v12 offset:8704
  v_mul_f32 v17, s76, v17
  v_mul_f32 v18, s76, v18
  v_mfma_f32_16x16x32_bf16 v[212:215], v[60:63], v[228:231], v[212:215]
  ds_read_b64_tr_b16 v[82:83], v12 offset:9728
  v_mul_f32 v19, s76, v19
  v_mul_f32 v20, s76, v20
  v_mul_f32 v21, s76, v21
  v_mfma_f32_16x16x32_bf16 v[104:107], v[32:35], v[232:235], v[104:107]
  ds_read_b64_tr_b16 v[84:85], v13 offset:8704
  v_mul_f32 v22, s76, v22
  v_mul_f32 v23, s76, v23
  v_mfma_f32_16x16x32_bf16 v[120:123], v[36:39], v[232:235], v[120:123]
  ds_read_b64_tr_b16 v[86:87], v13 offset:9728
  v_cvt_pk_bf16_f32 v28, v16, v17
  v_cvt_pk_bf16_f32 v29, v18, v19
  v_mfma_f32_16x16x32_bf16 v[136:139], v[40:43], v[232:235], v[136:139]
  buffer_load_dwordx4 v6, s[32:35], s26 offen offset:3072 sc1 lds
  v_cvt_pk_bf16_f32 v30, v20, v21
  v_cvt_pk_bf16_f32 v31, v22, v23
  v_mfma_f32_16x16x32_bf16 v[152:155], v[44:47], v[232:235], v[152:155]
  s_add_u32 s26, s26, 1024
  ds_read_b64_tr_b16 v[88:89], v12 offset:8960
  buffer_store_dwordx4 v[28:31], v2, s[40:43], s63 offen offset:1024 sc1
  v_accvgpr_read_b32 v16, a88
  v_mfma_f32_16x16x32_bf16 v[168:171], v[48:51], v[232:235], v[168:171]
  s_add_u32 s63, s63, s61
  ds_read_b64_tr_b16 v[90:91], v12 offset:9984
  v_accvgpr_read_b32 v17, a89
  v_accvgpr_read_b32 v18, a90
  v_mfma_f32_16x16x32_bf16 v[184:187], v[52:55], v[232:235], v[184:187]
  ds_read_b64_tr_b16 v[92:93], v13 offset:8960
  v_accvgpr_read_b32 v19, a91
  v_accvgpr_read_b32 v20, a120
  v_mfma_f32_16x16x32_bf16 v[200:203], v[56:59], v[232:235], v[200:203]
  s_add_u32 m0, s24, 49152
  ds_read_b64_tr_b16 v[94:95], v13 offset:9984
  v_accvgpr_read_b32 v21, a121
  v_accvgpr_read_b32 v22, a122
  v_mfma_f32_16x16x32_bf16 v[216:219], v[60:63], v[232:235], v[216:219]
  buffer_load_dwordx4 v10, s[36:39], s27 offen offset:2048 lds
  v_accvgpr_read_b32 v23, a123
  v_mul_f32 v16, s76, v16
  v_mfma_f32_16x16x32_bf16 v[108:111], v[32:35], v[236:239], v[108:111]
  ds_read_b128 v[248:251], v14 offset:34816
  v_mul_f32 v17, s76, v17
  v_mul_f32 v18, s76, v18
  v_mfma_f32_16x16x32_bf16 v[124:127], v[36:39], v[236:239], v[124:127]
  ds_read_b128 v[252:255], v14 offset:35840
  v_mul_f32 v19, s76, v19
  v_mul_f32 v20, s76, v20
  v_mfma_f32_16x16x32_bf16 v[140:143], v[40:43], v[236:239], v[140:143]
  v_mul_f32 v21, s76, v21
  v_mul_f32 v22, s76, v22
  v_mul_f32 v23, s76, v23
  v_mfma_f32_16x16x32_bf16 v[156:159], v[44:47], v[236:239], v[156:159]
  v_xor_b32 v14, 0x10000, v14
  v_cvt_pk_bf16_f32 v24, v16, v17
  v_cvt_pk_bf16_f32 v25, v18, v19
  v_mfma_f32_16x16x32_bf16 v[172:175], v[48:51], v[236:239], v[172:175]
  buffer_load_dwordx4 v11, s[36:39], s27 offen offset:3072 lds
  v_cvt_pk_bf16_f32 v26, v20, v21
  v_cvt_pk_bf16_f32 v27, v22, v23
  v_mfma_f32_16x16x32_bf16 v[188:191], v[52:55], v[236:239], v[188:191]
  s_add_u32 s27, s27, 524288
  buffer_store_dwordx4 v[24:27], v2, s[40:43], s63 offen offset:0 sc1
  v_mfma_f32_16x16x32_bf16 v[204:207], v[56:59], v[236:239], v[204:207]
  v_mfma_f32_16x16x32_bf16 v[220:223], v[60:63], v[236:239], v[220:223]
  s_waitcnt vmcnt(22) lgkmcnt(0)
  v_mfma_f32_16x16x32_bf16 v[96:99], v[64:67], v[240:243], v[96:99]
  s_barrier
  v_accvgpr_read_b32 v16, a92
  v_accvgpr_read_b32 v17, a93
  v_accvgpr_read_b32 v18, a94
  v_accvgpr_read_b32 v19, a95
  v_mfma_f32_16x16x32_bf16 v[112:115], v[68:71], v[240:243], v[112:115]
  ds_read_b64_tr_b16 v[32:33], v12 offset:32768
  v_accvgpr_read_b32 v20, a124
  v_accvgpr_read_b32 v21, a125
  v_mfma_f32_16x16x32_bf16 v[128:131], v[72:75], v[240:243], v[128:131]
  s_add_u32 m0, s24, 32768
  ds_read_b64_tr_b16 v[34:35], v12 offset:33792
  v_accvgpr_read_b32 v22, a126
  v_accvgpr_read_b32 v23, a127
  v_mfma_f32_16x16x32_bf16 v[144:147], v[76:79], v[240:243], v[144:147]
  buffer_load_dwordx4 v3, s[32:35], s26 offen offset:0 sc1 lds
  v_mul_f32 v16, s76, v16
  v_mul_f32 v17, s76, v17
  v_mfma_f32_16x16x32_bf16 v[160:163], v[80:83], v[240:243], v[160:163]
  ds_read_b64_tr_b16 v[36:37], v13 offset:32768
  v_mul_f32 v18, s76, v18
  v_mul_f32 v19, s76, v19
  v_mfma_f32_16x16x32_bf16 v[176:179], v[84:87], v[240:243], v[176:179]
  ds_read_b64_tr_b16 v[38:39], v13 offset:33792
  v_mul_f32 v20, s76, v20
  v_mul_f32 v21, s76, v21
  v_mfma_f32_16x16x32_bf16 v[192:195], v[88:91], v[240:243], v[192:195]
  ds_read_b64_tr_b16 v[40:41], v12 offset:33024
  v_mul_f32 v22, s76, v22
  v_mul_f32 v23, s76, v23
  v_mfma_f32_16x16x32_bf16 v[208:211], v[92:95], v[240:243], v[208:211]
  ds_read_b64_tr_b16 v[42:43], v12 offset:34048
  v_cvt_pk_bf16_f32 v28, v16, v17
  v_cvt_pk_bf16_f32 v29, v18, v19
  v_mfma_f32_16x16x32_bf16 v[100:103], v[64:67], v[244:247], v[100:103]
  buffer_load_dwordx4 v4, s[32:35], s26 offen offset:1024 sc1 lds
  v_cvt_pk_bf16_f32 v30, v20, v21
  v_cvt_pk_bf16_f32 v31, v22, v23
  v_mfma_f32_16x16x32_bf16 v[116:119], v[68:71], v[244:247], v[116:119]
  ds_read_b64_tr_b16 v[44:45], v13 offset:33024
  buffer_store_dwordx4 v[28:31], v2, s[40:43], s63 offen offset:1024 sc1
  v_accvgpr_read_b32 v16, a128
  v_mfma_f32_16x16x32_bf16 v[132:135], v[72:75], v[244:247], v[132:135]
  s_mul_i32 s63, s60, 2
  ds_read_b64_tr_b16 v[46:47], v13 offset:34048
  v_accvgpr_read_b32 v17, a129
  v_accvgpr_read_b32 v18, a130
  v_mfma_f32_16x16x32_bf16 v[148:151], v[76:79], v[244:247], v[148:151]
  s_add_u32 s63, s63, s62
  ds_read_b128 v[224:227], v14 offset:0
  v_accvgpr_read_b32 v19, a131
  v_accvgpr_read_b32 v20, a160
  v_mfma_f32_16x16x32_bf16 v[164:167], v[80:83], v[244:247], v[164:167]
  ds_read_b128 v[228:231], v14 offset:1024
  v_accvgpr_read_b32 v21, a161
  v_accvgpr_read_b32 v22, a162
  v_mfma_f32_16x16x32_bf16 v[180:183], v[84:87], v[244:247], v[180:183]
  buffer_load_dwordx4 v5, s[32:35], s26 offen offset:2048 sc1 lds
  v_accvgpr_read_b32 v23, a163
  v_mul_f32 v16, s76, v16
  v_mfma_f32_16x16x32_bf16 v[196:199], v[88:91], v[244:247], v[196:199]
  ds_read_b64_tr_b16 v[48:49], v12 offset:33280
  v_mul_f32 v17, s76, v17
  v_mul_f32 v18, s76, v18
  v_mfma_f32_16x16x32_bf16 v[212:215], v[92:95], v[244:247], v[212:215]
  ds_read_b64_tr_b16 v[50:51], v12 offset:34304
  v_mul_f32 v19, s76, v19
  v_mul_f32 v20, s76, v20
  v_mfma_f32_16x16x32_bf16 v[104:107], v[64:67], v[248:251], v[104:107]
  ds_read_b64_tr_b16 v[52:53], v13 offset:33280
  v_mul_f32 v21, s76, v21
  v_mul_f32 v22, s76, v22
  v_mfma_f32_16x16x32_bf16 v[120:123], v[68:71], v[248:251], v[120:123]
  ds_read_b64_tr_b16 v[54:55], v13 offset:34304
  v_mul_f32 v23, s76, v23
  v_cvt_pk_bf16_f32 v24, v16, v17
  v_mfma_f32_16x16x32_bf16 v[136:139], v[72:75], v[248:251], v[136:139]
  buffer_load_dwordx4 v6, s[32:35], s26 offen offset:3072 sc1 lds
  v_cvt_pk_bf16_f32 v25, v18, v19
  v_cvt_pk_bf16_f32 v26, v20, v21
  v_mfma_f32_16x16x32_bf16 v[152:155], v[76:79], v[248:251], v[152:155]
  s_add_u32 s26, s26, 1024
  ds_read_b64_tr_b16 v[56:57], v12 offset:33536
  v_cvt_pk_bf16_f32 v27, v22, v23
  v_mfma_f32_16x16x32_bf16 v[168:171], v[80:83], v[248:251], v[168:171]
  ds_read_b64_tr_b16 v[58:59], v12 offset:34560
  buffer_store_dwordx4 v[24:27], v2, s[40:43], s63 offen offset:0 sc1
  v_accvgpr_read_b32 v16, a132
  v_mfma_f32_16x16x32_bf16 v[184:187], v[84:87], v[248:251], v[184:187]
  ds_read_b64_tr_b16 v[60:61], v13 offset:33536
  v_accvgpr_read_b32 v17, a133
  v_accvgpr_read_b32 v18, a134
  v_mfma_f32_16x16x32_bf16 v[200:203], v[88:91], v[248:251], v[200:203]
  s_add_u32 m0, s24, 81920
  ds_read_b64_tr_b16 v[62:63], v13 offset:34560
  v_accvgpr_read_b32 v19, a135
  v_accvgpr_read_b32 v20, a164
  v_mfma_f32_16x16x32_bf16 v[216:219], v[92:95], v[248:251], v[216:219]
  buffer_load_dwordx4 v8, s[36:39], s27 offen offset:0 lds
  v_accvgpr_read_b32 v21, a165
  v_accvgpr_read_b32 v22, a166
  v_mfma_f32_16x16x32_bf16 v[108:111], v[64:67], v[252:255], v[108:111]
  ds_read_b128 v[232:235], v14 offset:2048
  v_accvgpr_read_b32 v23, a167
  v_mul_f32 v16, s76, v16
  v_mfma_f32_16x16x32_bf16 v[124:127], v[68:71], v[252:255], v[124:127]
  ds_read_b128 v[236:239], v14 offset:3072
  v_mul_f32 v17, s76, v17
  v_mul_f32 v18, s76, v18
  v_mfma_f32_16x16x32_bf16 v[140:143], v[72:75], v[252:255], v[140:143]
  v_mul_f32 v19, s76, v19
  v_mul_f32 v20, s76, v20
  v_mul_f32 v21, s76, v21
  v_mfma_f32_16x16x32_bf16 v[156:159], v[76:79], v[252:255], v[156:159]
  v_mul_f32 v22, s76, v22
  v_mul_f32 v23, s76, v23
  v_cvt_pk_bf16_f32 v28, v16, v17
  v_mfma_f32_16x16x32_bf16 v[172:175], v[80:83], v[252:255], v[172:175]
  buffer_load_dwordx4 v9, s[36:39], s27 offen offset:1024 lds
  v_cvt_pk_bf16_f32 v29, v18, v19
  v_cvt_pk_bf16_f32 v30, v20, v21
  v_mfma_f32_16x16x32_bf16 v[188:191], v[84:87], v[252:255], v[188:191]
  v_cvt_pk_bf16_f32 v31, v22, v23
  v_mfma_f32_16x16x32_bf16 v[204:207], v[88:91], v[252:255], v[204:207]
  buffer_store_dwordx4 v[28:31], v2, s[40:43], s63 offen offset:1024 sc1
  v_mfma_f32_16x16x32_bf16 v[220:223], v[92:95], v[252:255], v[220:223]
  s_waitcnt vmcnt(22) lgkmcnt(0)
  v_mfma_f32_16x16x32_bf16 v[96:99], v[32:35], v[224:227], v[96:99]
  s_add_u32 s63, s63, s61
  v_accvgpr_read_b32 v16, a136
  v_accvgpr_read_b32 v17, a137
  v_accvgpr_read_b32 v18, a138
  v_mfma_f32_16x16x32_bf16 v[112:115], v[36:39], v[224:227], v[112:115]
  ds_read_b64_tr_b16 v[64:65], v12 offset:40960
  v_accvgpr_read_b32 v19, a139
  v_mfma_f32_16x16x32_bf16 v[128:131], v[40:43], v[224:227], v[128:131]
  s_add_u32 m0, s24, 65536
  ds_read_b64_tr_b16 v[66:67], v12 offset:41984
  v_accvgpr_read_b32 v20, a168
  v_accvgpr_read_b32 v21, a169
  v_mfma_f32_16x16x32_bf16 v[144:147], v[44:47], v[224:227], v[144:147]
  buffer_load_dwordx4 v3, s[32:35], s26 offen offset:0 sc1 lds
  v_accvgpr_read_b32 v22, a170
  v_mfma_f32_16x16x32_bf16 v[160:163], v[48:51], v[224:227], v[160:163]
  ds_read_b64_tr_b16 v[68:69], v13 offset:40960
  v_accvgpr_read_b32 v23, a171
  v_mfma_f32_16x16x32_bf16 v[176:179], v[52:55], v[224:227], v[176:179]
  ds_read_b64_tr_b16 v[70:71], v13 offset:41984
  v_mul_f32 v16, s76, v16
  v_mul_f32 v17, s76, v17
  v_mfma_f32_16x16x32_bf16 v[192:195], v[56:59], v[224:227], v[192:195]
  ds_read_b64_tr_b16 v[72:73], v12 offset:41216
  v_mul_f32 v18, s76, v18
  v_mfma_f32_16x16x32_bf16 v[208:211], v[60:63], v[224:227], v[208:211]
  ds_read_b64_tr_b16 v[74:75], v12 offset:42240
  v_mul_f32 v19, s76, v19
  v_mul_f32 v20, s76, v20
  v_mfma_f32_16x16x32_bf16 v[100:103], v[32:35], v[228:231], v[100:103]
  buffer_load_dwordx4 v4, s[32:35], s26 offen offset:1024 sc1 lds
  v_mul_f32 v21, s76, v21
  v_mfma_f32_16x16x32_bf16 v[116:119], v[36:39], v[228:231], v[116:119]
  ds_read_b64_tr_b16 v[76:77], v13 offset:41216
  v_mul_f32 v22, s76, v22
  v_mfma_f32_16x16x32_bf16 v[132:135], v[40:43], v[228:231], v[132:135]
  ds_read_b64_tr_b16 v[78:79], v13 offset:42240
  v_mul_f32 v23, s76, v23
  v_cvt_pk_bf16_f32 v24, v16, v17
  v_mfma_f32_16x16x32_bf16 v[148:151], v[44:47], v[228:231], v[148:151]
  ds_read_b128 v[240:243], v14 offset:32768
  v_cvt_pk_bf16_f32 v25, v18, v19
  v_mfma_f32_16x16x32_bf16 v[164:167], v[48:51], v[228:231], v[164:167]
  ds_read_b128 v[244:247], v14 offset:33792
  v_cvt_pk_bf16_f32 v26, v20, v21
  v_cvt_pk_bf16_f32 v27, v22, v23
  v_mfma_f32_16x16x32_bf16 v[180:183], v[52:55], v[228:231], v[180:183]
  buffer_load_dwordx4 v5, s[32:35], s26 offen offset:2048 sc1 lds
  buffer_store_dwordx4 v[24:27], v2, s[40:43], s63 offen offset:0 sc1
  v_mfma_f32_16x16x32_bf16 v[196:199], v[56:59], v[228:231], v[196:199]
  ds_read_b64_tr_b16 v[80:81], v12 offset:41472
  v_accvgpr_read_b32 v16, a140
  v_mfma_f32_16x16x32_bf16 v[212:215], v[60:63], v[228:231], v[212:215]
  ds_read_b64_tr_b16 v[82:83], v12 offset:42496
  v_accvgpr_read_b32 v17, a141
  v_accvgpr_read_b32 v18, a142
  v_mfma_f32_16x16x32_bf16 v[104:107], v[32:35], v[232:235], v[104:107]
  ds_read_b64_tr_b16 v[84:85], v13 offset:41472
  v_accvgpr_read_b32 v19, a143
  v_mfma_f32_16x16x32_bf16 v[120:123], v[36:39], v[232:235], v[120:123]
  ds_read_b64_tr_b16 v[86:87], v13 offset:42496
  v_accvgpr_read_b32 v20, a172
  v_accvgpr_read_b32 v21, a173
  v_mfma_f32_16x16x32_bf16 v[136:139], v[40:43], v[232:235], v[136:139]
  buffer_load_dwordx4 v6, s[32:35], s26 offen offset:3072 sc1 lds
  v_accvgpr_read_b32 v22, a174
  v_mfma_f32_16x16x32_bf16 v[152:155], v[44:47], v[232:235], v[152:155]
  s_add_u32 s26, s26, 1024
  ds_read_b64_tr_b16 v[88:89], v12 offset:41728
  v_accvgpr_read_b32 v23, a175
  v_mfma_f32_16x16x32_bf16 v[168:171], v[48:51], v[232:235], v[168:171]
  ds_read_b64_tr_b16 v[90:91], v12 offset:42752
  v_mul_f32 v16, s76, v16
  v_mul_f32 v17, s76, v17
  v_mfma_f32_16x16x32_bf16 v[184:187], v[52:55], v[232:235], v[184:187]
  ds_read_b64_tr_b16 v[92:93], v13 offset:41728
  v_mul_f32 v18, s76, v18
  v_mfma_f32_16x16x32_bf16 v[200:203], v[56:59], v[232:235], v[200:203]
  s_add_u32 m0, s24, 81920
  ds_read_b64_tr_b16 v[94:95], v13 offset:42752
  v_mul_f32 v19, s76, v19
  v_mul_f32 v20, s76, v20
  v_mfma_f32_16x16x32_bf16 v[216:219], v[60:63], v[232:235], v[216:219]
  buffer_load_dwordx4 v10, s[36:39], s27 offen offset:2048 lds
  v_mul_f32 v21, s76, v21
  v_mfma_f32_16x16x32_bf16 v[108:111], v[32:35], v[236:239], v[108:111]
  ds_read_b128 v[248:251], v14 offset:34816
  v_mul_f32 v22, s76, v22
  v_mfma_f32_16x16x32_bf16 v[124:127], v[36:39], v[236:239], v[124:127]
  ds_read_b128 v[252:255], v14 offset:35840
  v_mul_f32 v23, s76, v23
  v_cvt_pk_bf16_f32 v28, v16, v17
  v_mfma_f32_16x16x32_bf16 v[140:143], v[40:43], v[236:239], v[140:143]
  v_cvt_pk_bf16_f32 v29, v18, v19
  v_cvt_pk_bf16_f32 v30, v20, v21
  v_mfma_f32_16x16x32_bf16 v[156:159], v[44:47], v[236:239], v[156:159]
  v_xor_b32 v14, 0x10000, v14
  v_cvt_pk_bf16_f32 v31, v22, v23
  v_mfma_f32_16x16x32_bf16 v[172:175], v[48:51], v[236:239], v[172:175]
  buffer_load_dwordx4 v11, s[36:39], s27 offen offset:3072 lds
  buffer_store_dwordx4 v[28:31], v2, s[40:43], s63 offen offset:1024 sc1
  v_mfma_f32_16x16x32_bf16 v[188:191], v[52:55], v[236:239], v[188:191]
  s_add_u32 s27, s27, 524288
  v_xor_b32 v12, 0x10000, v12
  v_mfma_f32_16x16x32_bf16 v[204:207], v[56:59], v[236:239], v[204:207]
  v_xor_b32 v13, 0x10000, v13
  v_mfma_f32_16x16x32_bf16 v[220:223], v[60:63], v[236:239], v[220:223]
  s_waitcnt vmcnt(21) lgkmcnt(0)
  v_mfma_f32_16x16x32_bf16 v[96:99], v[64:67], v[240:243], v[96:99]
  s_barrier
  v_accvgpr_read_b32 v16, a144
  v_accvgpr_read_b32 v17, a145
  v_accvgpr_read_b32 v18, a146
  v_mfma_f32_16x16x32_bf16 v[112:115], v[68:71], v[240:243], v[112:115]
  s_add_u32 s63, s63, s61
  ds_read_b64_tr_b16 v[32:33], v12 offset:0
  v_accvgpr_read_b32 v19, a147
  v_mfma_f32_16x16x32_bf16 v[128:131], v[72:75], v[240:243], v[128:131]
  s_add_u32 m0, s24, 98304
  ds_read_b64_tr_b16 v[34:35], v12 offset:1024
  v_accvgpr_read_b32 v20, a176
  v_mfma_f32_16x16x32_bf16 v[144:147], v[76:79], v[240:243], v[144:147]
  buffer_load_dwordx4 v3, s[32:35], s26 offen offset:0 sc1 lds
  v_accvgpr_read_b32 v21, a177
  v_accvgpr_read_b32 v22, a178
  v_mfma_f32_16x16x32_bf16 v[160:163], v[80:83], v[240:243], v[160:163]
  ds_read_b64_tr_b16 v[36:37], v13 offset:0
  v_accvgpr_read_b32 v23, a179
  v_mfma_f32_16x16x32_bf16 v[176:179], v[84:87], v[240:243], v[176:179]
  ds_read_b64_tr_b16 v[38:39], v13 offset:1024
  v_mul_f32 v16, s76, v16
  v_mfma_f32_16x16x32_bf16 v[192:195], v[88:91], v[240:243], v[192:195]
  ds_read_b64_tr_b16 v[40:41], v12 offset:256
  v_mul_f32 v17, s76, v17
  v_mul_f32 v18, s76, v18
  v_mfma_f32_16x16x32_bf16 v[208:211], v[92:95], v[240:243], v[208:211]
  ds_read_b64_tr_b16 v[42:43], v12 offset:1280
  v_mul_f32 v19, s76, v19
  v_mfma_f32_16x16x32_bf16 v[100:103], v[64:67], v[244:247], v[100:103]
  buffer_load_dwordx4 v4, s[32:35], s26 offen offset:1024 sc1 lds
  v_mul_f32 v20, s76, v20
  v_mfma_f32_16x16x32_bf16 v[116:119], v[68:71], v[244:247], v[116:119]
  ds_read_b64_tr_b16 v[44:45], v13 offset:256
  v_mul_f32 v21, s76, v21
  v_mfma_f32_16x16x32_bf16 v[132:135], v[72:75], v[244:247], v[132:135]
  ds_read_b64_tr_b16 v[46:47], v13 offset:1280
  v_mul_f32 v22, s76, v22
  v_mul_f32 v23, s76, v23
  v_mfma_f32_16x16x32_bf16 v[148:151], v[76:79], v[244:247], v[148:151]
  ds_read_b128 v[224:227], v14 offset:0
  v_cvt_pk_bf16_f32 v24, v16, v17
  v_mfma_f32_16x16x32_bf16 v[164:167], v[80:83], v[244:247], v[164:167]
  ds_read_b128 v[228:231], v14 offset:1024
  v_cvt_pk_bf16_f32 v25, v18, v19
  v_mfma_f32_16x16x32_bf16 v[180:183], v[84:87], v[244:247], v[180:183]
  buffer_load_dwordx4 v5, s[32:35], s26 offen offset:2048 sc1 lds
  v_cvt_pk_bf16_f32 v26, v20, v21
  v_cvt_pk_bf16_f32 v27, v22, v23
  v_mfma_f32_16x16x32_bf16 v[196:199], v[88:91], v[244:247], v[196:199]
  ds_read_b64_tr_b16 v[48:49], v12 offset:512
  buffer_store_dwordx4 v[24:27], v2, s[40:43], s63 offen offset:0 sc1
  v_mfma_f32_16x16x32_bf16 v[212:215], v[92:95], v[244:247], v[212:215]
  ds_read_b64_tr_b16 v[50:51], v12 offset:1536
  v_accvgpr_read_b32 v16, a148
  v_mfma_f32_16x16x32_bf16 v[104:107], v[64:67], v[248:251], v[104:107]
  ds_read_b64_tr_b16 v[52:53], v13 offset:512
  v_accvgpr_read_b32 v17, a149
  v_accvgpr_read_b32 v18, a150
  v_mfma_f32_16x16x32_bf16 v[120:123], v[68:71], v[248:251], v[120:123]
  ds_read_b64_tr_b16 v[54:55], v13 offset:1536
  v_accvgpr_read_b32 v19, a151
  v_mfma_f32_16x16x32_bf16 v[136:139], v[72:75], v[248:251], v[136:139]
  buffer_load_dwordx4 v6, s[32:35], s26 offen offset:3072 sc1 lds
  v_accvgpr_read_b32 v20, a180
  v_mfma_f32_16x16x32_bf16 v[152:155], v[76:79], v[248:251], v[152:155]
  s_add_u32 s26, s26, 1024
  ds_read_b64_tr_b16 v[56:57], v12 offset:768
  v_accvgpr_read_b32 v21, a181
  v_mfma_f32_16x16x32_bf16 v[168:171], v[80:83], v[248:251], v[168:171]
  ds_read_b64_tr_b16 v[58:59], v12 offset:1792
  v_accvgpr_read_b32 v22, a182
  v_accvgpr_read_b32 v23, a183
  v_mfma_f32_16x16x32_bf16 v[184:187], v[84:87], v[248:251], v[184:187]
  ds_read_b64_tr_b16 v[60:61], v13 offset:768
  v_mul_f32 v16, s76, v16
  v_mfma_f32_16x16x32_bf16 v[200:203], v[88:91], v[248:251], v[200:203]
  s_add_u32 m0, s24, 114688
  ds_read_b64_tr_b16 v[62:63], v13 offset:1792
  v_mul_f32 v17, s76, v17
  v_mfma_f32_16x16x32_bf16 v[216:219], v[92:95], v[248:251], v[216:219]
  buffer_load_dwordx4 v8, s[36:39], s27 offen offset:0 lds
  v_mul_f32 v18, s76, v18
  v_mul_f32 v19, s76, v19
  v_mfma_f32_16x16x32_bf16 v[108:111], v[64:67], v[252:255], v[108:111]
  ds_read_b128 v[232:235], v14 offset:2048
  v_mul_f32 v20, s76, v20
  v_mfma_f32_16x16x32_bf16 v[124:127], v[68:71], v[252:255], v[124:127]
  ds_read_b128 v[236:239], v14 offset:3072
  v_mul_f32 v21, s76, v21
  v_mfma_f32_16x16x32_bf16 v[140:143], v[72:75], v[252:255], v[140:143]
  v_mul_f32 v22, s76, v22
  v_mul_f32 v23, s76, v23
  v_cvt_pk_bf16_f32 v28, v16, v17
  v_mfma_f32_16x16x32_bf16 v[156:159], v[76:79], v[252:255], v[156:159]
  v_cvt_pk_bf16_f32 v29, v18, v19
  v_cvt_pk_bf16_f32 v30, v20, v21
  v_mfma_f32_16x16x32_bf16 v[172:175], v[80:83], v[252:255], v[172:175]
  buffer_load_dwordx4 v9, s[36:39], s27 offen offset:1024 lds
  v_cvt_pk_bf16_f32 v31, v22, v23
  v_mfma_f32_16x16x32_bf16 v[188:191], v[84:87], v[252:255], v[188:191]
  buffer_store_dwordx4 v[28:31], v2, s[40:43], s63 offen offset:1024 sc1
  v_mfma_f32_16x16x32_bf16 v[204:207], v[88:91], v[252:255], v[204:207]
  v_mfma_f32_16x16x32_bf16 v[220:223], v[92:95], v[252:255], v[220:223]
  s_waitcnt vmcnt(20) lgkmcnt(0)
  v_mfma_f32_16x16x32_bf16 v[96:99], v[32:35], v[224:227], v[96:99]
  s_add_u32 s63, s63, s61
  v_accvgpr_read_b32 v16, a152
  v_accvgpr_read_b32 v17, a153
  v_accvgpr_read_b32 v18, a154
  v_mfma_f32_16x16x32_bf16 v[112:115], v[36:39], v[224:227], v[112:115]
  ds_read_b64_tr_b16 v[64:65], v12 offset:8192
  v_accvgpr_read_b32 v19, a155
  v_mfma_f32_16x16x32_bf16 v[128:131], v[40:43], v[224:227], v[128:131]
  s_add_u32 m0, s24, 0
  ds_read_b64_tr_b16 v[66:67], v12 offset:9216
  v_accvgpr_read_b32 v20, a184
  v_mfma_f32_16x16x32_bf16 v[144:147], v[44:47], v[224:227], v[144:147]
  buffer_load_dwordx4 v3, s[32:35], s26 offen offset:0 sc1 lds
  v_accvgpr_read_b32 v21, a185
  v_accvgpr_read_b32 v22, a186
  v_mfma_f32_16x16x32_bf16 v[160:163], v[48:51], v[224:227], v[160:163]
  ds_read_b64_tr_b16 v[68:69], v13 offset:8192
  v_accvgpr_read_b32 v23, a187
  v_mfma_f32_16x16x32_bf16 v[176:179], v[52:55], v[224:227], v[176:179]
  ds_read_b64_tr_b16 v[70:71], v13 offset:9216
  v_mul_f32 v16, s76, v16
  v_mfma_f32_16x16x32_bf16 v[192:195], v[56:59], v[224:227], v[192:195]
  ds_read_b64_tr_b16 v[72:73], v12 offset:8448
  v_mul_f32 v17, s76, v17
  v_mul_f32 v18, s76, v18
  v_mfma_f32_16x16x32_bf16 v[208:211], v[60:63], v[224:227], v[208:211]
  ds_read_b64_tr_b16 v[74:75], v12 offset:9472
  v_mul_f32 v19, s76, v19
  v_mfma_f32_16x16x32_bf16 v[100:103], v[32:35], v[228:231], v[100:103]
  buffer_load_dwordx4 v4, s[32:35], s26 offen offset:1024 sc1 lds
  v_mul_f32 v20, s76, v20
  v_mfma_f32_16x16x32_bf16 v[116:119], v[36:39], v[228:231], v[116:119]
  ds_read_b64_tr_b16 v[76:77], v13 offset:8448
  v_mul_f32 v21, s76, v21
  v_mul_f32 v22, s76, v22
  v_mfma_f32_16x16x32_bf16 v[132:135], v[40:43], v[228:231], v[132:135]
  ds_read_b64_tr_b16 v[78:79], v13 offset:9472
  v_mul_f32 v23, s76, v23
  v_mfma_f32_16x16x32_bf16 v[148:151], v[44:47], v[228:231], v[148:151]
  ds_read_b128 v[240:243], v14 offset:32768
  v_cvt_pk_bf16_f32 v24, v16, v17
  v_mfma_f32_16x16x32_bf16 v[164:167], v[48:51], v[228:231], v[164:167]
  ds_read_b128 v[244:247], v14 offset:33792
  v_cvt_pk_bf16_f32 v25, v18, v19
  v_cvt_pk_bf16_f32 v26, v20, v21
  v_mfma_f32_16x16x32_bf16 v[180:183], v[52:55], v[228:231], v[180:183]
  buffer_load_dwordx4 v5, s[32:35], s26 offen offset:2048 sc1 lds
  v_cvt_pk_bf16_f32 v27, v22, v23
  v_mfma_f32_16x16x32_bf16 v[196:199], v[56:59], v[228:231], v[196:199]
  ds_read_b64_tr_b16 v[80:81], v12 offset:8704
  buffer_store_dwordx4 v[24:27], v2, s[40:43], s63 offen offset:0 sc1
  v_mfma_f32_16x16x32_bf16 v[212:215], v[60:63], v[228:231], v[212:215]
  ds_read_b64_tr_b16 v[82:83], v12 offset:9728
  v_accvgpr_read_b32 v16, a156
  v_accvgpr_read_b32 v17, a157
  v_mfma_f32_16x16x32_bf16 v[104:107], v[32:35], v[232:235], v[104:107]
  ds_read_b64_tr_b16 v[84:85], v13 offset:8704
  v_accvgpr_read_b32 v18, a158
  v_mfma_f32_16x16x32_bf16 v[120:123], v[36:39], v[232:235], v[120:123]
  ds_read_b64_tr_b16 v[86:87], v13 offset:9728
  v_accvgpr_read_b32 v19, a159
  v_mfma_f32_16x16x32_bf16 v[136:139], v[40:43], v[232:235], v[136:139]
  buffer_load_dwordx4 v6, s[32:35], s26 offen offset:3072 sc1 lds
  v_accvgpr_read_b32 v20, a188
  v_accvgpr_read_b32 v21, a189
  v_mfma_f32_16x16x32_bf16 v[152:155], v[44:47], v[232:235], v[152:155]
  s_add_u32 s26, s26, 1024
  ds_read_b64_tr_b16 v[88:89], v12 offset:8960
  v_accvgpr_read_b32 v22, a190
  v_mfma_f32_16x16x32_bf16 v[168:171], v[48:51], v[232:235], v[168:171]
  ds_read_b64_tr_b16 v[90:91], v12 offset:9984
  v_accvgpr_read_b32 v23, a191
  v_mfma_f32_16x16x32_bf16 v[184:187], v[52:55], v[232:235], v[184:187]
  ds_read_b64_tr_b16 v[92:93], v13 offset:8960
  v_mul_f32 v16, s76, v16
  v_mul_f32 v17, s76, v17
  v_mfma_f32_16x16x32_bf16 v[200:203], v[56:59], v[232:235], v[200:203]
  s_add_u32 m0, s24, 114688
  ds_read_b64_tr_b16 v[94:95], v13 offset:9984
  v_mul_f32 v18, s76, v18
  v_mfma_f32_16x16x32_bf16 v[216:219], v[60:63], v[232:235], v[216:219]
  buffer_load_dwordx4 v10, s[36:39], s27 offen offset:2048 lds
  v_mul_f32 v19, s76, v19
  v_mfma_f32_16x16x32_bf16 v[108:111], v[32:35], v[236:239], v[108:111]
  ds_read_b128 v[248:251], v14 offset:34816
  v_mul_f32 v20, s76, v20
  v_mul_f32 v21, s76, v21
  v_mfma_f32_16x16x32_bf16 v[124:127], v[36:39], v[236:239], v[124:127]
  ds_read_b128 v[252:255], v14 offset:35840
  v_mul_f32 v22, s76, v22
  v_mfma_f32_16x16x32_bf16 v[140:143], v[40:43], v[236:239], v[140:143]
  v_mul_f32 v23, s76, v23
  v_cvt_pk_bf16_f32 v28, v16, v17
  v_mfma_f32_16x16x32_bf16 v[156:159], v[44:47], v[236:239], v[156:159]
  v_xor_b32 v14, 0x10000, v14
  v_cvt_pk_bf16_f32 v29, v18, v19
  v_cvt_pk_bf16_f32 v30, v20, v21
  v_mfma_f32_16x16x32_bf16 v[172:175], v[48:51], v[236:239], v[172:175]
  buffer_load_dwordx4 v11, s[36:39], s27 offen offset:3072 lds
  v_cvt_pk_bf16_f32 v31, v22, v23
  v_mfma_f32_16x16x32_bf16 v[188:191], v[52:55], v[236:239], v[188:191]
  s_add_u32 s27, s27, 524288
  buffer_store_dwordx4 v[28:31], v2, s[40:43], s63 offen offset:1024 sc1
  v_mfma_f32_16x16x32_bf16 v[204:207], v[56:59], v[236:239], v[204:207]
  v_mfma_f32_16x16x32_bf16 v[220:223], v[60:63], v[236:239], v[220:223]
  s_waitcnt vmcnt(19) lgkmcnt(0)
  v_mfma_f32_16x16x32_bf16 v[96:99], v[64:67], v[240:243], v[96:99]
  s_barrier
  v_accvgpr_read_b32 v16, a192
  v_accvgpr_read_b32 v17, a193
  v_accvgpr_read_b32 v18, a194
  v_mfma_f32_16x16x32_bf16 v[112:115], v[68:71], v[240:243], v[112:115]
  s_mul_i32 s63, s60, 3
  ds_read_b64_tr_b16 v[32:33], v12 offset:32768
  v_accvgpr_read_b32 v19, a195
  v_mfma_f32_16x16x32_bf16 v[128:131], v[72:75], v[240:243], v[128:131]
  s_add_u32 m0, s24, 32768
  ds_read_b64_tr_b16 v[34:35], v12 offset:33792
  v_accvgpr_read_b32 v20, a224
  v_mfma_f32_16x16x32_bf16 v[144:147], v[76:79], v[240:243], v[144:147]
  s_add_u32 s63, s63, s62
  buffer_load_dwordx4 v3, s[32:35], s26 offen offset:0 sc1 lds
  v_accvgpr_read_b32 v21, a225
  v_accvgpr_read_b32 v22, a226
  v_mfma_f32_16x16x32_bf16 v[160:163], v[80:83], v[240:243], v[160:163]
  ds_read_b64_tr_b16 v[36:37], v13 offset:32768
  v_accvgpr_read_b32 v23, a227
  v_mfma_f32_16x16x32_bf16 v[176:179], v[84:87], v[240:243], v[176:179]
  ds_read_b64_tr_b16 v[38:39], v13 offset:33792
  v_mul_f32 v16, s76, v16
  v_mfma_f32_16x16x32_bf16 v[192:195], v[88:91], v[240:243], v[192:195]
  ds_read_b64_tr_b16 v[40:41], v12 offset:33024
  v_mul_f32 v17, s76, v17
  v_mul_f32 v18, s76, v18
  v_mfma_f32_16x16x32_bf16 v[208:211], v[92:95], v[240:243], v[208:211]
  ds_read_b64_tr_b16 v[42:43], v12 offset:34048
  v_mul_f32 v19, s76, v19
  v_mfma_f32_16x16x32_bf16 v[100:103], v[64:67], v[244:247], v[100:103]
  buffer_load_dwordx4 v4, s[32:35], s26 offen offset:1024 sc1 lds
  v_mul_f32 v20, s76, v20
  v_mfma_f32_16x16x32_bf16 v[116:119], v[68:71], v[244:247], v[116:119]
  ds_read_b64_tr_b16 v[44:45], v13 offset:33024
  v_mul_f32 v21, s76, v21
  v_mfma_f32_16x16x32_bf16 v[132:135], v[72:75], v[244:247], v[132:135]
  ds_read_b64_tr_b16 v[46:47], v13 offset:34048
  v_mul_f32 v22, s76, v22
  v_mul_f32 v23, s76, v23
  v_mfma_f32_16x16x32_bf16 v[148:151], v[76:79], v[244:247], v[148:151]
  ds_read_b128 v[224:227], v14 offset:0
  v_cvt_pk_bf16_f32 v24, v16, v17
  v_mfma_f32_16x16x32_bf16 v[164:167], v[80:83], v[244:247], v[164:167]
  ds_read_b128 v[228:231], v14 offset:1024
  v_cvt_pk_bf16_f32 v25, v18, v19
  v_mfma_f32_16x16x32_bf16 v[180:183], v[84:87], v[244:247], v[180:183]
  buffer_load_dwordx4 v5, s[32:35], s26 offen offset:2048 sc1 lds
  v_cvt_pk_bf16_f32 v26, v20, v21
  v_cvt_pk_bf16_f32 v27, v22, v23
  v_mfma_f32_16x16x32_bf16 v[196:199], v[88:91], v[244:247], v[196:199]
  ds_read_b64_tr_b16 v[48:49], v12 offset:33280
  buffer_store_dwordx4 v[24:27], v2, s[40:43], s63 offen offset:0 sc1
  v_mfma_f32_16x16x32_bf16 v[212:215], v[92:95], v[244:247], v[212:215]
  ds_read_b64_tr_b16 v[50:51], v12 offset:34304
  v_accvgpr_read_b32 v16, a196
  v_mfma_f32_16x16x32_bf16 v[104:107], v[64:67], v[248:251], v[104:107]
  ds_read_b64_tr_b16 v[52:53], v13 offset:33280
  v_accvgpr_read_b32 v17, a197
  v_accvgpr_read_b32 v18, a198
  v_mfma_f32_16x16x32_bf16 v[120:123], v[68:71], v[248:251], v[120:123]
  ds_read_b64_tr_b16 v[54:55], v13 offset:34304
  v_accvgpr_read_b32 v19, a199
  v_mfma_f32_16x16x32_bf16 v[136:139], v[72:75], v[248:251], v[136:139]
  buffer_load_dwordx4 v6, s[32:35], s26 offen offset:3072 sc1 lds
  v_accvgpr_read_b32 v20, a228
  v_mfma_f32_16x16x32_bf16 v[152:155], v[76:79], v[248:251], v[152:155]
  s_add_u32 s26, s26, 1024
  ds_read_b64_tr_b16 v[56:57], v12 offset:33536
  v_accvgpr_read_b32 v21, a229
  v_mfma_f32_16x16x32_bf16 v[168:171], v[80:83], v[248:251], v[168:171]
  ds_read_b64_tr_b16 v[58:59], v12 offset:34560
  v_accvgpr_read_b32 v22, a230
  v_accvgpr_read_b32 v23, a231
  v_mfma_f32_16x16x32_bf16 v[184:187], v[84:87], v[248:251], v[184:187]
  ds_read_b64_tr_b16 v[60:61], v13 offset:33536
  v_mul_f32 v16, s76, v16
  v_mfma_f32_16x16x32_bf16 v[200:203], v[88:91], v[248:251], v[200:203]
  s_add_u32 m0, s24, 16384
  ds_read_b64_tr_b16 v[62:63], v13 offset:34560
  v_mul_f32 v17, s76, v17
  v_mfma_f32_16x16x32_bf16 v[216:219], v[92:95], v[248:251], v[216:219]
  buffer_load_dwordx4 v8, s[36:39], s27 offen offset:0 lds
  v_mul_f32 v18, s76, v18
  v_mul_f32 v19, s76, v19
  v_mfma_f32_16x16x32_bf16 v[108:111], v[64:67], v[252:255], v[108:111]
  ds_read_b128 v[232:235], v14 offset:2048
  v_mul_f32 v20, s76, v20
  v_mfma_f32_16x16x32_bf16 v[124:127], v[68:71], v[252:255], v[124:127]
  ds_read_b128 v[236:239], v14 offset:3072
  v_mul_f32 v21, s76, v21
  v_mfma_f32_16x16x32_bf16 v[140:143], v[72:75], v[252:255], v[140:143]
  v_mul_f32 v22, s76, v22
  v_mul_f32 v23, s76, v23
  v_cvt_pk_bf16_f32 v28, v16, v17
  v_mfma_f32_16x16x32_bf16 v[156:159], v[76:79], v[252:255], v[156:159]
  v_cvt_pk_bf16_f32 v29, v18, v19
  v_cvt_pk_bf16_f32 v30, v20, v21
  v_mfma_f32_16x16x32_bf16 v[172:175], v[80:83], v[252:255], v[172:175]
  buffer_load_dwordx4 v9, s[36:39], s27 offen offset:1024 lds
  v_cvt_pk_bf16_f32 v31, v22, v23
  v_mfma_f32_16x16x32_bf16 v[188:191], v[84:87], v[252:255], v[188:191]
  buffer_store_dwordx4 v[28:31], v2, s[40:43], s63 offen offset:1024 sc1
  v_mfma_f32_16x16x32_bf16 v[204:207], v[88:91], v[252:255], v[204:207]
  v_mfma_f32_16x16x32_bf16 v[220:223], v[92:95], v[252:255], v[220:223]
  s_waitcnt vmcnt(19) lgkmcnt(0)
  v_mfma_f32_16x16x32_bf16 v[96:99], v[32:35], v[224:227], v[96:99]
  s_add_u32 s63, s63, s61
  v_accvgpr_read_b32 v16, a200
  v_accvgpr_read_b32 v17, a201
  v_accvgpr_read_b32 v18, a202
  v_mfma_f32_16x16x32_bf16 v[112:115], v[36:39], v[224:227], v[112:115]
  ds_read_b64_tr_b16 v[64:65], v12 offset:40960
  v_accvgpr_read_b32 v19, a203
  v_mfma_f32_16x16x32_bf16 v[128:131], v[40:43], v[224:227], v[128:131]
  s_add_u32 m0, s24, 65536
  ds_read_b64_tr_b16 v[66:67], v12 offset:41984
  v_accvgpr_read_b32 v20, a232
  v_accvgpr_read_b32 v21, a233
  v_mfma_f32_16x16x32_bf16 v[144:147], v[44:47], v[224:227], v[144:147]
  buffer_load_dwordx4 v3, s[32:35], s26 offen offset:0 sc1 lds
  v_accvgpr_read_b32 v22, a234
  v_mfma_f32_16x16x32_bf16 v[160:163], v[48:51], v[224:227], v[160:163]
  ds_read_b64_tr_b16 v[68:69], v13 offset:40960
  v_accvgpr_read_b32 v23, a235
  v_mfma_f32_16x16x32_bf16 v[176:179], v[52:55], v[224:227], v[176:179]
  ds_read_b64_tr_b16 v[70:71], v13 offset:41984
  v_mul_f32 v16, s76, v16
  v_mul_f32 v17, s76, v17
  v_mfma_f32_16x16x32_bf16 v[192:195], v[56:59], v[224:227], v[192:195]
  ds_read_b64_tr_b16 v[72:73], v12 offset:41216
  v_mul_f32 v18, s76, v18
  v_mfma_f32_16x16x32_bf16 v[208:211], v[60:63], v[224:227], v[208:211]
  ds_read_b64_tr_b16 v[74:75], v12 offset:42240
  v_mul_f32 v19, s76, v19
  v_mul_f32 v20, s76, v20
  v_mfma_f32_16x16x32_bf16 v[100:103], v[32:35], v[228:231], v[100:103]
  buffer_load_dwordx4 v4, s[32:35], s26 offen offset:1024 sc1 lds
  v_mul_f32 v21, s76, v21
  v_mfma_f32_16x16x32_bf16 v[116:119], v[36:39], v[228:231], v[116:119]
  ds_read_b64_tr_b16 v[76:77], v13 offset:41216
  v_mul_f32 v22, s76, v22
  v_mfma_f32_16x16x32_bf16 v[132:135], v[40:43], v[228:231], v[132:135]
  ds_read_b64_tr_b16 v[78:79], v13 offset:42240
  v_mul_f32 v23, s76, v23
  v_cvt_pk_bf16_f32 v24, v16, v17
  v_mfma_f32_16x16x32_bf16 v[148:151], v[44:47], v[228:231], v[148:151]
  ds_read_b128 v[240:243], v14 offset:32768
  v_cvt_pk_bf16_f32 v25, v18, v19
  v_mfma_f32_16x16x32_bf16 v[164:167], v[48:51], v[228:231], v[164:167]
  ds_read_b128 v[244:247], v14 offset:33792
  v_cvt_pk_bf16_f32 v26, v20, v21
  v_cvt_pk_bf16_f32 v27, v22, v23
  v_mfma_f32_16x16x32_bf16 v[180:183], v[52:55], v[228:231], v[180:183]
  buffer_load_dwordx4 v5, s[32:35], s26 offen offset:2048 sc1 lds
  buffer_store_dwordx4 v[24:27], v2, s[40:43], s63 offen offset:0 sc1
  v_mfma_f32_16x16x32_bf16 v[196:199], v[56:59], v[228:231], v[196:199]
  ds_read_b64_tr_b16 v[80:81], v12 offset:41472
  v_accvgpr_read_b32 v16, a204
  v_mfma_f32_16x16x32_bf16 v[212:215], v[60:63], v[228:231], v[212:215]
  ds_read_b64_tr_b16 v[82:83], v12 offset:42496
  v_accvgpr_read_b32 v17, a205
  v_accvgpr_read_b32 v18, a206
  v_mfma_f32_16x16x32_bf16 v[104:107], v[32:35], v[232:235], v[104:107]
  ds_read_b64_tr_b16 v[84:85], v13 offset:41472
  v_accvgpr_read_b32 v19, a207
  v_mfma_f32_16x16x32_bf16 v[120:123], v[36:39], v[232:235], v[120:123]
  ds_read_b64_tr_b16 v[86:87], v13 offset:42496
  v_accvgpr_read_b32 v20, a236
  v_accvgpr_read_b32 v21, a237
  v_mfma_f32_16x16x32_bf16 v[136:139], v[40:43], v[232:235], v[136:139]
  buffer_load_dwordx4 v6, s[32:35], s26 offen offset:3072 sc1 lds
  v_accvgpr_read_b32 v22, a238
  v_mfma_f32_16x16x32_bf16 v[152:155], v[44:47], v[232:235], v[152:155]
  s_add_u32 s26, s26, 1024
  ds_read_b64_tr_b16 v[88:89], v12 offset:41728
  v_accvgpr_read_b32 v23, a239
  v_mfma_f32_16x16x32_bf16 v[168:171], v[48:51], v[232:235], v[168:171]
  ds_read_b64_tr_b16 v[90:91], v12 offset:42752
  v_mul_f32 v16, s76, v16
  v_mul_f32 v17, s76, v17
  v_mfma_f32_16x16x32_bf16 v[184:187], v[52:55], v[232:235], v[184:187]
  ds_read_b64_tr_b16 v[92:93], v13 offset:41728
  v_mul_f32 v18, s76, v18
  v_mfma_f32_16x16x32_bf16 v[200:203], v[56:59], v[232:235], v[200:203]
  s_add_u32 m0, s24, 16384
  ds_read_b64_tr_b16 v[94:95], v13 offset:42752
  v_mul_f32 v19, s76, v19
  v_mul_f32 v20, s76, v20
  v_mfma_f32_16x16x32_bf16 v[216:219], v[60:63], v[232:235], v[216:219]
  buffer_load_dwordx4 v10, s[36:39], s27 offen offset:2048 lds
  v_mul_f32 v21, s76, v21
  v_mfma_f32_16x16x32_bf16 v[108:111], v[32:35], v[236:239], v[108:111]
  ds_read_b128 v[248:251], v14 offset:34816
  v_mul_f32 v22, s76, v22
  v_mfma_f32_16x16x32_bf16 v[124:127], v[36:39], v[236:239], v[124:127]
  ds_read_b128 v[252:255], v14 offset:35840
  v_mul_f32 v23, s76, v23
  v_cvt_pk_bf16_f32 v28, v16, v17
  v_mfma_f32_16x16x32_bf16 v[140:143], v[40:43], v[236:239], v[140:143]
  v_cvt_pk_bf16_f32 v29, v18, v19
  v_cvt_pk_bf16_f32 v30, v20, v21
  v_mfma_f32_16x16x32_bf16 v[156:159], v[44:47], v[236:239], v[156:159]
  v_xor_b32 v14, 0x10000, v14
  v_cvt_pk_bf16_f32 v31, v22, v23
  v_mfma_f32_16x16x32_bf16 v[172:175], v[48:51], v[236:239], v[172:175]
  buffer_load_dwordx4 v11, s[36:39], s27 offen offset:3072 lds
  buffer_store_dwordx4 v[28:31], v2, s[40:43], s63 offen offset:1024 sc1
  v_mfma_f32_16x16x32_bf16 v[188:191], v[52:55], v[236:239], v[188:191]
  s_add_u32 s27, s27, 524288
  v_xor_b32 v12, 0x10000, v12
  v_mfma_f32_16x16x32_bf16 v[204:207], v[56:59], v[236:239], v[204:207]
  v_xor_b32 v13, 0x10000, v13
  v_mfma_f32_16x16x32_bf16 v[220:223], v[60:63], v[236:239], v[220:223]
  s_waitcnt vmcnt(19) lgkmcnt(0)
  v_mfma_f32_16x16x32_bf16 v[96:99], v[64:67], v[240:243], v[96:99]
  s_barrier
  v_accvgpr_read_b32 v16, a208
  v_accvgpr_read_b32 v17, a209
  v_accvgpr_read_b32 v18, a210
  v_mfma_f32_16x16x32_bf16 v[112:115], v[68:71], v[240:243], v[112:115]
  s_add_u32 s63, s63, s61
  ds_read_b64_tr_b16 v[32:33], v12 offset:0
  v_accvgpr_read_b32 v19, a211
  v_mfma_f32_16x16x32_bf16 v[128:131], v[72:75], v[240:243], v[128:131]
  s_add_u32 m0, s24, 98304
  ds_read_b64_tr_b16 v[34:35], v12 offset:1024
  v_accvgpr_read_b32 v20, a240
  v_mfma_f32_16x16x32_bf16 v[144:147], v[76:79], v[240:243], v[144:147]
  buffer_load_dwordx4 v3, s[32:35], s26 offen offset:0 sc1 lds
  v_accvgpr_read_b32 v21, a241
  v_accvgpr_read_b32 v22, a242
  v_mfma_f32_16x16x32_bf16 v[160:163], v[80:83], v[240:243], v[160:163]
  ds_read_b64_tr_b16 v[36:37], v13 offset:0
  v_accvgpr_read_b32 v23, a243
  v_mfma_f32_16x16x32_bf16 v[176:179], v[84:87], v[240:243], v[176:179]
  ds_read_b64_tr_b16 v[38:39], v13 offset:1024
  v_mul_f32 v16, s76, v16
  v_mfma_f32_16x16x32_bf16 v[192:195], v[88:91], v[240:243], v[192:195]
  ds_read_b64_tr_b16 v[40:41], v12 offset:256
  v_mul_f32 v17, s76, v17
  v_mul_f32 v18, s76, v18
  v_mfma_f32_16x16x32_bf16 v[208:211], v[92:95], v[240:243], v[208:211]
  ds_read_b64_tr_b16 v[42:43], v12 offset:1280
  v_mul_f32 v19, s76, v19
  v_mfma_f32_16x16x32_bf16 v[100:103], v[64:67], v[244:247], v[100:103]
  buffer_load_dwordx4 v4, s[32:35], s26 offen offset:1024 sc1 lds
  v_mul_f32 v20, s76, v20
  v_mfma_f32_16x16x32_bf16 v[116:119], v[68:71], v[244:247], v[116:119]
  ds_read_b64_tr_b16 v[44:45], v13 offset:256
  v_mul_f32 v21, s76, v21
  v_mfma_f32_16x16x32_bf16 v[132:135], v[72:75], v[244:247], v[132:135]
  ds_read_b64_tr_b16 v[46:47], v13 offset:1280
  v_mul_f32 v22, s76, v22
  v_mul_f32 v23, s76, v23
  v_mfma_f32_16x16x32_bf16 v[148:151], v[76:79], v[244:247], v[148:151]
  ds_read_b128 v[224:227], v14 offset:0
  v_cvt_pk_bf16_f32 v24, v16, v17
  v_mfma_f32_16x16x32_bf16 v[164:167], v[80:83], v[244:247], v[164:167]
  ds_read_b128 v[228:231], v14 offset:1024
  v_cvt_pk_bf16_f32 v25, v18, v19
  v_mfma_f32_16x16x32_bf16 v[180:183], v[84:87], v[244:247], v[180:183]
  buffer_load_dwordx4 v5, s[32:35], s26 offen offset:2048 sc1 lds
  v_cvt_pk_bf16_f32 v26, v20, v21
  v_cvt_pk_bf16_f32 v27, v22, v23
  v_mfma_f32_16x16x32_bf16 v[196:199], v[88:91], v[244:247], v[196:199]
  ds_read_b64_tr_b16 v[48:49], v12 offset:512
  buffer_store_dwordx4 v[24:27], v2, s[40:43], s63 offen offset:0 sc1
  v_mfma_f32_16x16x32_bf16 v[212:215], v[92:95], v[244:247], v[212:215]
  ds_read_b64_tr_b16 v[50:51], v12 offset:1536
  v_accvgpr_read_b32 v16, a212
  v_mfma_f32_16x16x32_bf16 v[104:107], v[64:67], v[248:251], v[104:107]
  ds_read_b64_tr_b16 v[52:53], v13 offset:512
  v_accvgpr_read_b32 v17, a213
  v_accvgpr_read_b32 v18, a214
  v_mfma_f32_16x16x32_bf16 v[120:123], v[68:71], v[248:251], v[120:123]
  ds_read_b64_tr_b16 v[54:55], v13 offset:1536
  v_accvgpr_read_b32 v19, a215
  v_mfma_f32_16x16x32_bf16 v[136:139], v[72:75], v[248:251], v[136:139]
  buffer_load_dwordx4 v6, s[32:35], s26 offen offset:3072 sc1 lds
  v_accvgpr_read_b32 v20, a244
  v_mfma_f32_16x16x32_bf16 v[152:155], v[76:79], v[248:251], v[152:155]
  s_add_u32 s26, s26, 1024
  ds_read_b64_tr_b16 v[56:57], v12 offset:768
  v_accvgpr_read_b32 v21, a245
  v_mfma_f32_16x16x32_bf16 v[168:171], v[80:83], v[248:251], v[168:171]
  ds_read_b64_tr_b16 v[58:59], v12 offset:1792
  v_accvgpr_read_b32 v22, a246
  v_accvgpr_read_b32 v23, a247
  v_mfma_f32_16x16x32_bf16 v[184:187], v[84:87], v[248:251], v[184:187]
  ds_read_b64_tr_b16 v[60:61], v13 offset:768
  v_mul_f32 v16, s76, v16
  v_mfma_f32_16x16x32_bf16 v[200:203], v[88:91], v[248:251], v[200:203]
  s_add_u32 m0, s24, 49152
  ds_read_b64_tr_b16 v[62:63], v13 offset:1792
  v_mul_f32 v17, s76, v17
  v_mfma_f32_16x16x32_bf16 v[216:219], v[92:95], v[248:251], v[216:219]
  buffer_load_dwordx4 v8, s[36:39], s27 offen offset:0 lds
  v_mul_f32 v18, s76, v18
  v_mul_f32 v19, s76, v19
  v_mfma_f32_16x16x32_bf16 v[108:111], v[64:67], v[252:255], v[108:111]
  ds_read_b128 v[232:235], v14 offset:2048
  v_mul_f32 v20, s76, v20
  v_mfma_f32_16x16x32_bf16 v[124:127], v[68:71], v[252:255], v[124:127]
  ds_read_b128 v[236:239], v14 offset:3072
  v_mul_f32 v21, s76, v21
  v_mfma_f32_16x16x32_bf16 v[140:143], v[72:75], v[252:255], v[140:143]
  v_mul_f32 v22, s76, v22
  v_mul_f32 v23, s76, v23
  v_cvt_pk_bf16_f32 v28, v16, v17
  v_mfma_f32_16x16x32_bf16 v[156:159], v[76:79], v[252:255], v[156:159]
  v_cvt_pk_bf16_f32 v29, v18, v19
  v_cvt_pk_bf16_f32 v30, v20, v21
  v_mfma_f32_16x16x32_bf16 v[172:175], v[80:83], v[252:255], v[172:175]
  buffer_load_dwordx4 v9, s[36:39], s27 offen offset:1024 lds
  v_cvt_pk_bf16_f32 v31, v22, v23
  v_mfma_f32_16x16x32_bf16 v[188:191], v[84:87], v[252:255], v[188:191]
  buffer_store_dwordx4 v[28:31], v2, s[40:43], s63 offen offset:1024 sc1
  v_mfma_f32_16x16x32_bf16 v[204:207], v[88:91], v[252:255], v[204:207]
  v_mfma_f32_16x16x32_bf16 v[220:223], v[92:95], v[252:255], v[220:223]
  s_waitcnt vmcnt(19) lgkmcnt(0)
  v_mfma_f32_16x16x32_bf16 v[96:99], v[32:35], v[224:227], v[96:99]
  s_add_u32 s63, s63, s61
  v_accvgpr_read_b32 v16, a216
  v_accvgpr_read_b32 v17, a217
  v_accvgpr_read_b32 v18, a218
  v_mfma_f32_16x16x32_bf16 v[112:115], v[36:39], v[224:227], v[112:115]
  ds_read_b64_tr_b16 v[64:65], v12 offset:8192
  v_accvgpr_read_b32 v19, a219
  v_mfma_f32_16x16x32_bf16 v[128:131], v[40:43], v[224:227], v[128:131]
  s_add_u32 m0, s24, 0
  ds_read_b64_tr_b16 v[66:67], v12 offset:9216
  v_accvgpr_read_b32 v20, a248
  v_mfma_f32_16x16x32_bf16 v[144:147], v[44:47], v[224:227], v[144:147]
  buffer_load_dwordx4 v3, s[32:35], s26 offen offset:0 sc1 lds
  v_accvgpr_read_b32 v21, a249
  v_accvgpr_read_b32 v22, a250
  v_mfma_f32_16x16x32_bf16 v[160:163], v[48:51], v[224:227], v[160:163]
  ds_read_b64_tr_b16 v[68:69], v13 offset:8192
  v_accvgpr_read_b32 v23, a251
  v_mfma_f32_16x16x32_bf16 v[176:179], v[52:55], v[224:227], v[176:179]
  ds_read_b64_tr_b16 v[70:71], v13 offset:9216
  v_mul_f32 v16, s76, v16
  v_mfma_f32_16x16x32_bf16 v[192:195], v[56:59], v[224:227], v[192:195]
  ds_read_b64_tr_b16 v[72:73], v12 offset:8448
  v_mul_f32 v17, s76, v17
  v_mul_f32 v18, s76, v18
  v_mfma_f32_16x16x32_bf16 v[208:211], v[60:63], v[224:227], v[208:211]
  ds_read_b64_tr_b16 v[74:75], v12 offset:9472
  v_mul_f32 v19, s76, v19
  v_mfma_f32_16x16x32_bf16 v[100:103], v[32:35], v[228:231], v[100:103]
  buffer_load_dwordx4 v4, s[32:35], s26 offen offset:1024 sc1 lds
  v_mul_f32 v20, s76, v20
  v_mfma_f32_16x16x32_bf16 v[116:119], v[36:39], v[228:231], v[116:119]
  ds_read_b64_tr_b16 v[76:77], v13 offset:8448
  v_mul_f32 v21, s76, v21
  v_mul_f32 v22, s76, v22
  v_mfma_f32_16x16x32_bf16 v[132:135], v[40:43], v[228:231], v[132:135]
  ds_read_b64_tr_b16 v[78:79], v13 offset:9472
  v_mul_f32 v23, s76, v23
  v_mfma_f32_16x16x32_bf16 v[148:151], v[44:47], v[228:231], v[148:151]
  ds_read_b128 v[240:243], v14 offset:32768
  v_cvt_pk_bf16_f32 v24, v16, v17
  v_mfma_f32_16x16x32_bf16 v[164:167], v[48:51], v[228:231], v[164:167]
  ds_read_b128 v[244:247], v14 offset:33792
  v_cvt_pk_bf16_f32 v25, v18, v19
  v_cvt_pk_bf16_f32 v26, v20, v21
  v_mfma_f32_16x16x32_bf16 v[180:183], v[52:55], v[228:231], v[180:183]
  buffer_load_dwordx4 v5, s[32:35], s26 offen offset:2048 sc1 lds
  v_cvt_pk_bf16_f32 v27, v22, v23
  v_mfma_f32_16x16x32_bf16 v[196:199], v[56:59], v[228:231], v[196:199]
  ds_read_b64_tr_b16 v[80:81], v12 offset:8704
  buffer_store_dwordx4 v[24:27], v2, s[40:43], s63 offen offset:0 sc1
  v_mfma_f32_16x16x32_bf16 v[212:215], v[60:63], v[228:231], v[212:215]
  ds_read_b64_tr_b16 v[82:83], v12 offset:9728
  v_accvgpr_read_b32 v16, a220
  v_accvgpr_read_b32 v17, a221
  v_mfma_f32_16x16x32_bf16 v[104:107], v[32:35], v[232:235], v[104:107]
  ds_read_b64_tr_b16 v[84:85], v13 offset:8704
  v_accvgpr_read_b32 v18, a222
  v_mfma_f32_16x16x32_bf16 v[120:123], v[36:39], v[232:235], v[120:123]
  ds_read_b64_tr_b16 v[86:87], v13 offset:9728
  v_accvgpr_read_b32 v19, a223
  v_mfma_f32_16x16x32_bf16 v[136:139], v[40:43], v[232:235], v[136:139]
  buffer_load_dwordx4 v6, s[32:35], s26 offen offset:3072 sc1 lds
  v_accvgpr_read_b32 v20, a252
  v_accvgpr_read_b32 v21, a253
  v_mfma_f32_16x16x32_bf16 v[152:155], v[44:47], v[232:235], v[152:155]
  s_add_u32 s26, s26, 1024
  ds_read_b64_tr_b16 v[88:89], v12 offset:8960
  v_accvgpr_read_b32 v22, a254
  v_mfma_f32_16x16x32_bf16 v[168:171], v[48:51], v[232:235], v[168:171]
  ds_read_b64_tr_b16 v[90:91], v12 offset:9984
  v_accvgpr_read_b32 v23, a255
  v_mfma_f32_16x16x32_bf16 v[184:187], v[52:55], v[232:235], v[184:187]
  ds_read_b64_tr_b16 v[92:93], v13 offset:8960
  v_mul_f32 v16, s76, v16
  v_mul_f32 v17, s76, v17
  v_mfma_f32_16x16x32_bf16 v[200:203], v[56:59], v[232:235], v[200:203]
  s_add_u32 m0, s24, 49152
  ds_read_b64_tr_b16 v[94:95], v13 offset:9984
  v_mul_f32 v18, s76, v18
  v_mfma_f32_16x16x32_bf16 v[216:219], v[60:63], v[232:235], v[216:219]
  buffer_load_dwordx4 v10, s[36:39], s27 offen offset:2048 lds
  v_mul_f32 v19, s76, v19
  v_mfma_f32_16x16x32_bf16 v[108:111], v[32:35], v[236:239], v[108:111]
  ds_read_b128 v[248:251], v14 offset:34816
  v_mul_f32 v20, s76, v20
  v_mul_f32 v21, s76, v21
  v_mfma_f32_16x16x32_bf16 v[124:127], v[36:39], v[236:239], v[124:127]
  ds_read_b128 v[252:255], v14 offset:35840
  v_mul_f32 v22, s76, v22
  v_mfma_f32_16x16x32_bf16 v[140:143], v[40:43], v[236:239], v[140:143]
  v_mul_f32 v23, s76, v23
  v_cvt_pk_bf16_f32 v28, v16, v17
  v_mfma_f32_16x16x32_bf16 v[156:159], v[44:47], v[236:239], v[156:159]
  v_xor_b32 v14, 0x10000, v14
  v_cvt_pk_bf16_f32 v29, v18, v19
  v_cvt_pk_bf16_f32 v30, v20, v21
  v_mfma_f32_16x16x32_bf16 v[172:175], v[48:51], v[236:239], v[172:175]
  buffer_load_dwordx4 v11, s[36:39], s27 offen offset:3072 lds
  v_cvt_pk_bf16_f32 v31, v22, v23
  v_mfma_f32_16x16x32_bf16 v[188:191], v[52:55], v[236:239], v[188:191]
  s_add_u32 s27, s27, 524288
  buffer_store_dwordx4 v[28:31], v2, s[40:43], s63 offen offset:1024 sc1
  v_mfma_f32_16x16x32_bf16 v[204:207], v[56:59], v[236:239], v[204:207]
  v_mfma_f32_16x16x32_bf16 v[220:223], v[60:63], v[236:239], v[220:223]
  s_waitcnt vmcnt(19) lgkmcnt(0)
  v_mfma_f32_16x16x32_bf16 v[96:99], v[64:67], v[240:243], v[96:99]
  s_barrier
  v_and_b32 v11, 15, v1
  v_lshrrev_b32 v10, 4, v1
  v_mfma_f32_16x16x32_bf16 v[112:115], v[68:71], v[240:243], v[112:115]
  ds_read_b64_tr_b16 v[32:33], v12 offset:32768
  v_lshlrev_b32 v10, 2, v10
  v_mfma_f32_16x16x32_bf16 v[128:131], v[72:75], v[240:243], v[128:131]
  s_add_u32 m0, s24, 32768
  ds_read_b64_tr_b16 v[34:35], v12 offset:33792
  v_sub_u32 v11, v11, v10
  v_mfma_f32_16x16x32_bf16 v[144:147], v[76:79], v[240:243], v[144:147]
  buffer_load_dwordx4 v3, s[32:35], s26 offen offset:0 sc1 lds
  v_cmp_le_i32 s[68:69], 0, v11
  v_mfma_f32_16x16x32_bf16 v[160:163], v[80:83], v[240:243], v[160:163]
  ds_read_b64_tr_b16 v[36:37], v13 offset:32768
  v_cmp_le_i32 s[70:71], 1, v11
  v_mfma_f32_16x16x32_bf16 v[176:179], v[84:87], v[240:243], v[176:179]
  ds_read_b64_tr_b16 v[38:39], v13 offset:33792
  v_cmp_le_i32 s[72:73], 2, v11
  v_mfma_f32_16x16x32_bf16 v[192:195], v[88:91], v[240:243], v[192:195]
  ds_read_b64_tr_b16 v[40:41], v12 offset:33024
  v_cmp_le_i32 s[74:75], 3, v11
  v_mfma_f32_16x16x32_bf16 v[208:211], v[92:95], v[240:243], v[208:211]
  ds_read_b64_tr_b16 v[42:43], v12 offset:34048
  v_and_b32 v8, 7, v1
  v_mfma_f32_16x16x32_bf16 v[100:103], v[64:67], v[244:247], v[100:103]
  buffer_load_dwordx4 v4, s[32:35], s26 offen offset:1024 sc1 lds
  v_lshlrev_b32 v8, 2, v8
  v_mfma_f32_16x16x32_bf16 v[116:119], v[68:71], v[244:247], v[116:119]
  ds_read_b64_tr_b16 v[44:45], v13 offset:33024
  v_add_u32 v8, s30, v8
  v_mfma_f32_16x16x32_bf16 v[132:135], v[72:75], v[244:247], v[132:135]
  ds_read_b64_tr_b16 v[46:47], v13 offset:34048
  v_accvgpr_write_b32 a0, 0
  v_mfma_f32_16x16x32_bf16 v[148:151], v[76:79], v[244:247], v[148:151]
  ds_read_b128 v[224:227], v14 offset:0
  v_accvgpr_write_b32 a1, 0
  v_mfma_f32_16x16x32_bf16 v[164:167], v[80:83], v[244:247], v[164:167]
  ds_read_b128 v[228:231], v14 offset:1024
  v_accvgpr_write_b32 a2, 0
  v_mfma_f32_16x16x32_bf16 v[180:183], v[84:87], v[244:247], v[180:183]
  buffer_load_dwordx4 v5, s[32:35], s26 offen offset:2048 sc1 lds
  v_accvgpr_write_b32 a3, 0
  v_mfma_f32_16x16x32_bf16 v[196:199], v[88:91], v[244:247], v[196:199]
  ds_read_b64_tr_b16 v[48:49], v12 offset:33280
  v_accvgpr_write_b32 a32, 0
  v_mfma_f32_16x16x32_bf16 v[212:215], v[92:95], v[244:247], v[212:215]
  ds_read_b64_tr_b16 v[50:51], v12 offset:34304
  v_accvgpr_write_b32 a33, 0
  v_mfma_f32_16x16x32_bf16 v[104:107], v[64:67], v[248:251], v[104:107]
  ds_read_b64_tr_b16 v[52:53], v13 offset:33280
  v_accvgpr_write_b32 a34, 0
  v_mfma_f32_16x16x32_bf16 v[120:123], v[68:71], v[248:251], v[120:123]
  ds_read_b64_tr_b16 v[54:55], v13 offset:34304
  v_accvgpr_write_b32 a35, 0
  v_mfma_f32_16x16x32_bf16 v[136:139], v[72:75], v[248:251], v[136:139]
  buffer_load_dwordx4 v6, s[32:35], s26 offen offset:3072 sc1 lds
  v_accvgpr_write_b32 a4, 0
  v_mfma_f32_16x16x32_bf16 v[152:155], v[76:79], v[248:251], v[152:155]
  s_add_u32 s26, s26, 1024
  ds_read_b64_tr_b16 v[56:57], v12 offset:33536
  v_accvgpr_write_b32 a5, 0
  v_mfma_f32_16x16x32_bf16 v[168:171], v[80:83], v[248:251], v[168:171]
  ds_read_b64_tr_b16 v[58:59], v12 offset:34560
  v_accvgpr_write_b32 a6, 0
  v_mfma_f32_16x16x32_bf16 v[184:187], v[84:87], v[248:251], v[184:187]
  ds_read_b64_tr_b16 v[60:61], v13 offset:33536
  v_accvgpr_write_b32 a7, 0
  v_mfma_f32_16x16x32_bf16 v[200:203], v[88:91], v[248:251], v[200:203]
  ds_read_b64_tr_b16 v[62:63], v13 offset:34560
  v_accvgpr_write_b32 a36, 0
  v_mfma_f32_16x16x32_bf16 v[216:219], v[92:95], v[248:251], v[216:219]
  v_accvgpr_write_b32 a37, 0
  v_accvgpr_write_b32 a38, 0
  v_mfma_f32_16x16x32_bf16 v[108:111], v[64:67], v[252:255], v[108:111]
  ds_read_b128 v[232:235], v14 offset:2048
  v_accvgpr_write_b32 a39, 0
  v_mfma_f32_16x16x32_bf16 v[124:127], v[68:71], v[252:255], v[124:127]
  ds_read_b128 v[236:239], v14 offset:3072
  v_accvgpr_write_b32 a8, 0
  v_mfma_f32_16x16x32_bf16 v[140:143], v[72:75], v[252:255], v[140:143]
  v_accvgpr_write_b32 a9, 0
  v_accvgpr_write_b32 a10, 0
  v_mfma_f32_16x16x32_bf16 v[156:159], v[76:79], v[252:255], v[156:159]
  v_accvgpr_write_b32 a11, 0
  v_accvgpr_write_b32 a40, 0
  v_mfma_f32_16x16x32_bf16 v[172:175], v[80:83], v[252:255], v[172:175]
  v_accvgpr_write_b32 a41, 0
  v_accvgpr_write_b32 a42, 0
  v_mfma_f32_16x16x32_bf16 v[188:191], v[84:87], v[252:255], v[188:191]
  v_accvgpr_write_b32 a43, 0
  v_accvgpr_write_b32 a12, 0
  v_mfma_f32_16x16x32_bf16 v[204:207], v[88:91], v[252:255], v[204:207]
  v_accvgpr_write_b32 a13, 0
  v_mfma_f32_16x16x32_bf16 v[220:223], v[92:95], v[252:255], v[220:223]
  s_waitcnt vmcnt(15) lgkmcnt(0)
  v_mfma_f32_16x16x32_bf16 v[96:99], v[32:35], v[224:227], v[96:99]
  v_accvgpr_write_b32 a14, 0
  v_accvgpr_write_b32 a15, 0
  v_mfma_f32_16x16x32_bf16 v[112:115], v[36:39], v[224:227], v[112:115]
  ds_read_b64_tr_b16 v[64:65], v12 offset:40960
  v_accvgpr_write_b32 a44, 0
  v_mfma_f32_16x16x32_bf16 v[128:131], v[40:43], v[224:227], v[128:131]
  s_add_u32 m0, s24, 65536
  ds_read_b64_tr_b16 v[66:67], v12 offset:41984
  v_accvgpr_write_b32 a45, 0
  v_mfma_f32_16x16x32_bf16 v[144:147], v[44:47], v[224:227], v[144:147]
  buffer_load_dwordx4 v3, s[32:35], s26 offen offset:0 sc1 lds
  v_accvgpr_write_b32 a46, 0
  v_mfma_f32_16x16x32_bf16 v[160:163], v[48:51], v[224:227], v[160:163]
  ds_read_b64_tr_b16 v[68:69], v13 offset:40960
  v_accvgpr_write_b32 a47, 0
  v_mfma_f32_16x16x32_bf16 v[176:179], v[52:55], v[224:227], v[176:179]
  ds_read_b64_tr_b16 v[70:71], v13 offset:41984
  v_accvgpr_write_b32 a16, 0
  v_mfma_f32_16x16x32_bf16 v[192:195], v[56:59], v[224:227], v[192:195]
  ds_read_b64_tr_b16 v[72:73], v12 offset:41216
  v_accvgpr_write_b32 a17, 0
  v_mfma_f32_16x16x32_bf16 v[208:211], v[60:63], v[224:227], v[208:211]
  ds_read_b64_tr_b16 v[74:75], v12 offset:42240
  v_accvgpr_write_b32 a18, 0
  v_mfma_f32_16x16x32_bf16 v[100:103], v[32:35], v[228:231], v[100:103]
  buffer_load_dwordx4 v4, s[32:35], s26 offen offset:1024 sc1 lds
  v_accvgpr_write_b32 a19, 0
  v_mfma_f32_16x16x32_bf16 v[116:119], v[36:39], v[228:231], v[116:119]
  ds_read_b64_tr_b16 v[76:77], v13 offset:41216
  v_accvgpr_write_b32 a48, 0
  v_mfma_f32_16x16x32_bf16 v[132:135], v[40:43], v[228:231], v[132:135]
  ds_read_b64_tr_b16 v[78:79], v13 offset:42240
  v_accvgpr_write_b32 a49, 0
  v_mfma_f32_16x16x32_bf16 v[148:151], v[44:47], v[228:231], v[148:151]
  ds_read_b128 v[240:243], v14 offset:32768
  v_accvgpr_write_b32 a50, 0
  v_mfma_f32_16x16x32_bf16 v[164:167], v[48:51], v[228:231], v[164:167]
  ds_read_b128 v[244:247], v14 offset:33792
  v_accvgpr_write_b32 a51, 0
  v_mfma_f32_16x16x32_bf16 v[180:183], v[52:55], v[228:231], v[180:183]
  buffer_load_dwordx4 v5, s[32:35], s26 offen offset:2048 sc1 lds
  v_accvgpr_write_b32 a20, 0
  v_mfma_f32_16x16x32_bf16 v[196:199], v[56:59], v[228:231], v[196:199]
  ds_read_b64_tr_b16 v[80:81], v12 offset:41472
  v_accvgpr_write_b32 a21, 0
  v_mfma_f32_16x16x32_bf16 v[212:215], v[60:63], v[228:231], v[212:215]
  ds_read_b64_tr_b16 v[82:83], v12 offset:42496
  v_accvgpr_write_b32 a22, 0
  v_mfma_f32_16x16x32_bf16 v[104:107], v[32:35], v[232:235], v[104:107]
  ds_read_b64_tr_b16 v[84:85], v13 offset:41472
  v_accvgpr_write_b32 a23, 0
  v_mfma_f32_16x16x32_bf16 v[120:123], v[36:39], v[232:235], v[120:123]
  ds_read_b64_tr_b16 v[86:87], v13 offset:42496
  v_accvgpr_write_b32 a52, 0
  v_mfma_f32_16x16x32_bf16 v[136:139], v[40:43], v[232:235], v[136:139]
  buffer_load_dwordx4 v6, s[32:35], s26 offen offset:3072 sc1 lds
  v_accvgpr_write_b32 a53, 0
  v_mfma_f32_16x16x32_bf16 v[152:155], v[44:47], v[232:235], v[152:155]
  s_add_u32 s26, s26, 1024
  ds_read_b64_tr_b16 v[88:89], v12 offset:41728
  v_accvgpr_write_b32 a54, 0
  v_mfma_f32_16x16x32_bf16 v[168:171], v[48:51], v[232:235], v[168:171]
  ds_read_b64_tr_b16 v[90:91], v12 offset:42752
  v_accvgpr_write_b32 a55, 0
  v_mfma_f32_16x16x32_bf16 v[184:187], v[52:55], v[232:235], v[184:187]
  ds_read_b64_tr_b16 v[92:93], v13 offset:41728
  v_accvgpr_write_b32 a24, 0
  v_mfma_f32_16x16x32_bf16 v[200:203], v[56:59], v[232:235], v[200:203]
  ds_read_b64_tr_b16 v[94:95], v13 offset:42752
  v_accvgpr_write_b32 a25, 0
  v_mfma_f32_16x16x32_bf16 v[216:219], v[60:63], v[232:235], v[216:219]
  v_accvgpr_write_b32 a26, 0
  v_accvgpr_write_b32 a27, 0
  v_mfma_f32_16x16x32_bf16 v[108:111], v[32:35], v[236:239], v[108:111]
  ds_read_b128 v[248:251], v14 offset:34816
  v_accvgpr_write_b32 a56, 0
  v_mfma_f32_16x16x32_bf16 v[124:127], v[36:39], v[236:239], v[124:127]
  ds_read_b128 v[252:255], v14 offset:35840
  v_accvgpr_write_b32 a57, 0
  v_mfma_f32_16x16x32_bf16 v[140:143], v[40:43], v[236:239], v[140:143]
  v_accvgpr_write_b32 a58, 0
  v_accvgpr_write_b32 a59, 0
  v_mfma_f32_16x16x32_bf16 v[156:159], v[44:47], v[236:239], v[156:159]
  v_xor_b32 v14, 0x10000, v14
  v_accvgpr_write_b32 a28, 0
  v_mfma_f32_16x16x32_bf16 v[172:175], v[48:51], v[236:239], v[172:175]
  v_accvgpr_write_b32 a29, 0
  v_accvgpr_write_b32 a30, 0
  v_mfma_f32_16x16x32_bf16 v[188:191], v[52:55], v[236:239], v[188:191]
  v_xor_b32 v12, 0x10000, v12
  v_accvgpr_write_b32 a31, 0
  v_mfma_f32_16x16x32_bf16 v[204:207], v[56:59], v[236:239], v[204:207]
  v_xor_b32 v13, 0x10000, v13
  v_mfma_f32_16x16x32_bf16 v[220:223], v[60:63], v[236:239], v[220:223]
  s_waitcnt vmcnt(8) lgkmcnt(0)
  v_mfma_f32_16x16x32_bf16 v[96:99], v[64:67], v[240:243], v[96:99]
  s_barrier
  buffer_store_dword v12, off, s[40:43], s29 sc1
  v_accvgpr_write_b32 a60, 0
  v_mfma_f32_16x16x32_bf16 v[112:115], v[68:71], v[240:243], v[112:115]
  ds_read_b64_tr_b16 v[32:33], v12 offset:0
  v_accvgpr_write_b32 a61, 0
  v_mfma_f32_16x16x32_bf16 v[128:131], v[72:75], v[240:243], v[128:131]
  s_add_u32 m0, s24, 98304
  ds_read_b64_tr_b16 v[34:35], v12 offset:1024
  v_accvgpr_write_b32 a62, 0
  v_mfma_f32_16x16x32_bf16 v[144:147], v[76:79], v[240:243], v[144:147]
  buffer_load_dwordx4 v3, s[32:35], s26 offen offset:0 sc1 lds
  v_accvgpr_write_b32 a63, 0
  v_mfma_f32_16x16x32_bf16 v[160:163], v[80:83], v[240:243], v[160:163]
  ds_read_b64_tr_b16 v[36:37], v13 offset:0
  v_accvgpr_write_b32 a64, 0
  v_mfma_f32_16x16x32_bf16 v[176:179], v[84:87], v[240:243], v[176:179]
  ds_read_b64_tr_b16 v[38:39], v13 offset:1024
  v_accvgpr_write_b32 a65, 0
  v_mfma_f32_16x16x32_bf16 v[192:195], v[88:91], v[240:243], v[192:195]
  ds_read_b64_tr_b16 v[40:41], v12 offset:256
  v_accvgpr_write_b32 a66, 0
  v_mfma_f32_16x16x32_bf16 v[208:211], v[92:95], v[240:243], v[208:211]
  ds_read_b64_tr_b16 v[42:43], v12 offset:1280
  v_accvgpr_write_b32 a67, 0
  v_mfma_f32_16x16x32_bf16 v[100:103], v[64:67], v[244:247], v[100:103]
  buffer_load_dwordx4 v4, s[32:35], s26 offen offset:1024 sc1 lds
  v_accvgpr_write_b32 a96, 0
  v_mfma_f32_16x16x32_bf16 v[116:119], v[68:71], v[244:247], v[116:119]
  ds_read_b64_tr_b16 v[44:45], v13 offset:256
  v_accvgpr_write_b32 a97, 0
  v_mfma_f32_16x16x32_bf16 v[132:135], v[72:75], v[244:247], v[132:135]
  ds_read_b64_tr_b16 v[46:47], v13 offset:1280
  v_accvgpr_write_b32 a98, 0
  v_mfma_f32_16x16x32_bf16 v[148:151], v[76:79], v[244:247], v[148:151]
  ds_read_b128 v[224:227], v14 offset:0
  v_accvgpr_write_b32 a99, 0
  v_mfma_f32_16x16x32_bf16 v[164:167], v[80:83], v[244:247], v[164:167]
  ds_read_b128 v[228:231], v14 offset:1024
  v_accvgpr_write_b32 a68, 0
  v_mfma_f32_16x16x32_bf16 v[180:183], v[84:87], v[244:247], v[180:183]
  buffer_load_dwordx4 v5, s[32:35], s26 offen offset:2048 sc1 lds
  v_accvgpr_write_b32 a69, 0
  v_mfma_f32_16x16x32_bf16 v[196:199], v[88:91], v[244:247], v[196:199]
  ds_read_b64_tr_b16 v[48:49], v12 offset:512
  v_accvgpr_write_b32 a70, 0
  v_mfma_f32_16x16x32_bf16 v[212:215], v[92:95], v[244:247], v[212:215]
  ds_read_b64_tr_b16 v[50:51], v12 offset:1536
  v_accvgpr_write_b32 a71, 0
  v_mfma_f32_16x16x32_bf16 v[104:107], v[64:67], v[248:251], v[104:107]
  ds_read_b64_tr_b16 v[52:53], v13 offset:512
  v_accvgpr_write_b32 a100, 0
  v_mfma_f32_16x16x32_bf16 v[120:123], v[68:71], v[248:251], v[120:123]
  ds_read_b64_tr_b16 v[54:55], v13 offset:1536
  v_accvgpr_write_b32 a101, 0
  v_mfma_f32_16x16x32_bf16 v[136:139], v[72:75], v[248:251], v[136:139]
  buffer_load_dwordx4 v6, s[32:35], s26 offen offset:3072 sc1 lds
  v_accvgpr_write_b32 a102, 0
  v_mfma_f32_16x16x32_bf16 v[152:155], v[76:79], v[248:251], v[152:155]
  s_add_u32 s26, s26, 1024
  ds_read_b64_tr_b16 v[56:57], v12 offset:768
  v_accvgpr_write_b32 a103, 0
  v_mfma_f32_16x16x32_bf16 v[168:171], v[80:83], v[248:251], v[168:171]
  ds_read_b64_tr_b16 v[58:59], v12 offset:1792
  v_accvgpr_write_b32 a72, 0
  v_mfma_f32_16x16x32_bf16 v[184:187], v[84:87], v[248:251], v[184:187]
  ds_read_b64_tr_b16 v[60:61], v13 offset:768
  v_accvgpr_write_b32 a73, 0
  v_mfma_f32_16x16x32_bf16 v[200:203], v[88:91], v[248:251], v[200:203]
  ds_read_b64_tr_b16 v[62:63], v13 offset:1792
  v_accvgpr_write_b32 a74, 0
  v_mfma_f32_16x16x32_bf16 v[216:219], v[92:95], v[248:251], v[216:219]
  v_accvgpr_write_b32 a75, 0
  v_accvgpr_write_b32 a104, 0
  v_mfma_f32_16x16x32_bf16 v[108:111], v[64:67], v[252:255], v[108:111]
  ds_read_b128 v[232:235], v14 offset:2048
  v_accvgpr_write_b32 a105, 0
  v_mfma_f32_16x16x32_bf16 v[124:127], v[68:71], v[252:255], v[124:127]
  ds_read_b128 v[236:239], v14 offset:3072
  v_accvgpr_write_b32 a106, 0
  v_mfma_f32_16x16x32_bf16 v[140:143], v[72:75], v[252:255], v[140:143]
  v_accvgpr_write_b32 a107, 0
  v_accvgpr_write_b32 a76, 0
  v_mfma_f32_16x16x32_bf16 v[156:159], v[76:79], v[252:255], v[156:159]
  v_accvgpr_write_b32 a77, 0
  v_accvgpr_write_b32 a78, 0
  v_mfma_f32_16x16x32_bf16 v[172:175], v[80:83], v[252:255], v[172:175]
  v_accvgpr_write_b32 a79, 0
  v_accvgpr_write_b32 a108, 0
  v_mfma_f32_16x16x32_bf16 v[188:191], v[84:87], v[252:255], v[188:191]
  v_accvgpr_write_b32 a109, 0
  v_accvgpr_write_b32 a110, 0
  v_mfma_f32_16x16x32_bf16 v[204:207], v[88:91], v[252:255], v[204:207]
  v_accvgpr_write_b32 a111, 0
  v_mfma_f32_16x16x32_bf16 v[220:223], v[92:95], v[252:255], v[220:223]
  s_waitcnt vmcnt(9) lgkmcnt(0)
  v_mfma_f32_16x16x32_bf16 v[96:99], v[32:35], v[224:227], v[96:99]
  s_mul_i32 s34, s20, 5120
  v_add_u32 v20, 0, v1
  v_mul_u32_u24 v19, 6554, v20
  v_mfma_f32_16x16x32_bf16 v[112:115], v[36:39], v[224:227], v[112:115]
  s_add_u32 s34, s34, 131072
  ds_read_b64_tr_b16 v[64:65], v12 offset:8192
  v_lshrrev_b32 v19, 16, v19
  v_mfma_f32_16x16x32_bf16 v[128:131], v[40:43], v[224:227], v[128:131]
  s_and_b32 s32, s21, 3
  ds_read_b64_tr_b16 v[66:67], v12 offset:9216
  v_mul_u32_u24 v19, 1120, v19
  v_mfma_f32_16x16x32_bf16 v[144:147], v[44:47], v[224:227], v[144:147]
  s_add_u32 s32, s32, 6
  v_lshl_add_u32 v24, v20, 4, v19
  v_accvgpr_write_b32 a248, v24
  v_mfma_f32_16x16x32_bf16 v[160:163], v[48:51], v[224:227], v[160:163]
  s_lshl_b32 s32, s32, 14
  ds_read_b64_tr_b16 v[68:69], v13 offset:8192
  v_add_u32 v20, 64, v1
  v_mfma_f32_16x16x32_bf16 v[176:179], v[52:55], v[224:227], v[176:179]
  s_cmp_lt_u32 s2, 64
  ds_read_b64_tr_b16 v[70:71], v13 offset:9216
  v_mul_u32_u24 v19, 6554, v20
  v_mfma_f32_16x16x32_bf16 v[192:195], v[56:59], v[224:227], v[192:195]
  s_cselect_b32 s32, s32, 0
  ds_read_b64_tr_b16 v[72:73], v12 offset:8448
  v_lshrrev_b32 v19, 16, v19
  v_mfma_f32_16x16x32_bf16 v[208:211], v[60:63], v[224:227], v[208:211]
  s_cselect_b32 s9, -1, 0
  ds_read_b64_tr_b16 v[74:75], v12 offset:9472
  v_mul_u32_u24 v19, 1120, v19
  v_mfma_f32_16x16x32_bf16 v[100:103], v[32:35], v[228:231], v[100:103]
  s_sub_u32 s23, s2, 170
  v_lshl_add_u32 v25, v20, 4, v19
  v_accvgpr_write_b32 a249, v25
  v_mfma_f32_16x16x32_bf16 v[116:119], v[36:39], v[228:231], v[116:119]
  s_cmp_lt_u32 s23, 54
  ds_read_b64_tr_b16 v[76:77], v13 offset:8448
  v_add_u32 v20, 128, v1
  v_mfma_f32_16x16x32_bf16 v[132:135], v[40:43], v[228:231], v[132:135]
  s_cselect_b32 s32, 98304, s32
  ds_read_b64_tr_b16 v[78:79], v13 offset:9472
  v_mul_u32_u24 v19, 6554, v20
  v_mfma_f32_16x16x32_bf16 v[148:151], v[44:47], v[228:231], v[148:151]
  s_cselect_b32 s9, -1, s9
  ds_read_b128 v[240:243], v14 offset:32768
  v_lshrrev_b32 v19, 16, v19
  v_mfma_f32_16x16x32_bf16 v[164:167], v[48:51], v[228:231], v[164:167]
  s_mov_b32 s67, s2
  ds_read_b128 v[244:247], v14 offset:33792
  v_mul_u32_u24 v19, 1120, v19
  v_mfma_f32_16x16x32_bf16 v[180:183], v[52:55], v[228:231], v[180:183]
  s_mov_b32 s8, 0
  v_lshl_add_u32 v26, v20, 4, v19
  v_accvgpr_write_b32 a250, v26
  v_mfma_f32_16x16x32_bf16 v[196:199], v[56:59], v[228:231], v[196:199]
  s_mov_b32 s66, 0
  ds_read_b64_tr_b16 v[80:81], v12 offset:8704
  v_add_u32 v20, 192, v1
  v_mfma_f32_16x16x32_bf16 v[212:215], v[60:63], v[228:231], v[212:215]
  s_mov_b32 s11, 0
  ds_read_b64_tr_b16 v[82:83], v12 offset:9728
  v_mul_u32_u24 v19, 6554, v20
  v_mfma_f32_16x16x32_bf16 v[104:107], v[32:35], v[232:235], v[104:107]
  s_mov_b32 s12, 0
  ds_read_b64_tr_b16 v[84:85], v13 offset:8704
  v_lshrrev_b32 v19, 16, v19
  v_mfma_f32_16x16x32_bf16 v[120:123], v[36:39], v[232:235], v[120:123]
  s_lshl_b32 s15, s22, 1
  ds_read_b64_tr_b16 v[86:87], v13 offset:9728
  v_mul_u32_u24 v19, 1120, v19
  v_mfma_f32_16x16x32_bf16 v[136:139], v[40:43], v[232:235], v[136:139]
  s_add_u32 s23, s15, 6
  v_lshl_add_u32 v27, v20, 4, v19
  v_accvgpr_write_b32 a251, v27
  v_mfma_f32_16x16x32_bf16 v[152:155], v[44:47], v[232:235], v[152:155]
  s_sub_u32 s15, 24, s15
  ds_read_b64_tr_b16 v[88:89], v12 offset:8960
  v_add_u32 v20, 256, v1
  v_mfma_f32_16x16x32_bf16 v[168:171], v[48:51], v[232:235], v[168:171]
  s_max_u32 s15, s15, s23
  ds_read_b64_tr_b16 v[90:91], v12 offset:9984
  v_mul_u32_u24 v19, 6554, v20
  v_mfma_f32_16x16x32_bf16 v[184:187], v[52:55], v[232:235], v[184:187]
  s_lshl_b32 s15, s15, 14
  ds_read_b64_tr_b16 v[92:93], v13 offset:8960
  v_lshrrev_b32 v19, 16, v19
  v_mfma_f32_16x16x32_bf16 v[200:203], v[56:59], v[232:235], v[200:203]
  ds_read_b64_tr_b16 v[94:95], v13 offset:9984
  v_mul_u32_u24 v19, 1120, v19
  v_mfma_f32_16x16x32_bf16 v[216:219], v[60:63], v[232:235], v[216:219]
  v_lshl_add_u32 v28, v20, 4, v19
  v_accvgpr_write_b32 a252, v28
  v_mfma_f32_16x16x32_bf16 v[108:111], v[32:35], v[236:239], v[108:111]
  ds_read_b128 v[248:251], v14 offset:34816
  v_accvgpr_write_b32 a80, 0
  v_mfma_f32_16x16x32_bf16 v[124:127], v[36:39], v[236:239], v[124:127]
  ds_read_b128 v[252:255], v14 offset:35840
  v_accvgpr_write_b32 a81, 0
  v_mfma_f32_16x16x32_bf16 v[140:143], v[40:43], v[236:239], v[140:143]
  v_accvgpr_write_b32 a82, 0
  v_accvgpr_write_b32 a83, 0
  v_mfma_f32_16x16x32_bf16 v[156:159], v[44:47], v[236:239], v[156:159]
  v_xor_b32 v14, 0x10000, v14
  v_accvgpr_write_b32 a112, 0
  v_mfma_f32_16x16x32_bf16 v[172:175], v[48:51], v[236:239], v[172:175]
  v_accvgpr_write_b32 a113, 0
  v_accvgpr_write_b32 a114, 0
  v_mfma_f32_16x16x32_bf16 v[188:191], v[52:55], v[236:239], v[188:191]
  v_accvgpr_write_b32 a115, 0
  v_accvgpr_write_b32 a84, 0
  v_mfma_f32_16x16x32_bf16 v[204:207], v[56:59], v[236:239], v[204:207]
  v_accvgpr_write_b32 a85, 0
  v_mfma_f32_16x16x32_bf16 v[220:223], v[60:63], v[236:239], v[220:223]
  s_waitcnt vmcnt(5) lgkmcnt(0)
  v_mfma_f32_16x16x32_bf16 v[96:99], v[64:67], v[240:243], v[96:99]
  s_barrier
  v_lshrrev_b32 v6, 2, v1
  v_mul_u32_u24 v6, 160, v6
  v_mfma_f32_16x16x32_bf16 v[112:115], v[68:71], v[240:243], v[112:115]
  s_and_b32 s23, s20, 1
  ds_read_b64_tr_b16 v[32:33], v12 offset:32768
  v_and_b32 v19, 3, v1
  v_mfma_f32_16x16x32_bf16 v[128:131], v[72:75], v[240:243], v[128:131]
  s_lshl_b32 s23, s23, 12
  ds_read_b64_tr_b16 v[34:35], v12 offset:33792
  v_lshl_add_u32 v6, v19, 3, v6
  v_mfma_f32_16x16x32_bf16 v[144:147], v[76:79], v[240:243], v[144:147]
  s_cmp_lt_u32 s20, 2
  v_add_u32 v6, s34, v6
  v_mov_b32 v3, v2
  v_mfma_f32_16x16x32_bf16 v[160:163], v[80:83], v[240:243], v[160:163]
  s_cselect_b32 s24, 106496, 0
  ds_read_b64_tr_b16 v[36:37], v13 offset:32768
  v_mov_b32 v4, 0xff800000
  v_mfma_f32_16x16x32_bf16 v[176:179], v[84:87], v[240:243], v[176:179]
  s_add_u32 s24, s24, s23
  ds_read_b64_tr_b16 v[38:39], v13 offset:33792
  v_add_u32 v18, 106496, v2
  v_mfma_f32_16x16x32_bf16 v[192:195], v[88:91], v[240:243], v[192:195]
  s_lshl_b32 s26, s20, 12
  ds_read_b64_tr_b16 v[40:41], v12 offset:33024
  v_accvgpr_write_b32 a86, 0
  v_mfma_f32_16x16x32_bf16 v[208:211], v[92:95], v[240:243], v[208:211]
  s_mov_b32 s27, s26
  ds_read_b64_tr_b16 v[42:43], v12 offset:34048
  v_accvgpr_write_b32 a87, 0
  v_mfma_f32_16x16x32_bf16 v[100:103], v[64:67], v[244:247], v[100:103]
  s_add_u32 s25, s27, 49152
  v_accvgpr_write_b32 a116, 0
  v_accvgpr_write_b32 a117, 0
  v_mfma_f32_16x16x32_bf16 v[116:119], v[68:71], v[244:247], v[116:119]
  s_load_dwordx4 s[4:7], s[0:1], 64
  ds_read_b64_tr_b16 v[44:45], v13 offset:33024
  v_accvgpr_write_b32 a118, 0
  v_mfma_f32_16x16x32_bf16 v[132:135], v[72:75], v[244:247], v[132:135]
  s_load_dwordx2 s[60:61], s[0:1], 80
  ds_read_b64_tr_b16 v[46:47], v13 offset:34048
  v_accvgpr_write_b32 a119, 0
  v_mfma_f32_16x16x32_bf16 v[148:151], v[76:79], v[244:247], v[148:151]
  s_add_u32 s23, s20, 1
  ds_read_b128 v[224:227], v14 offset:0
  v_accvgpr_write_b32 a88, 0
  v_mfma_f32_16x16x32_bf16 v[164:167], v[80:83], v[244:247], v[164:167]
  s_lshr_b32 s23, s23, 1
  ds_read_b128 v[228:231], v14 offset:1024
  v_accvgpr_write_b32 a89, 0
  v_mfma_f32_16x16x32_bf16 v[180:183], v[84:87], v[244:247], v[180:183]
  s_lshl_b32 s28, s22, 1
  v_accvgpr_write_b32 a90, 0
  v_accvgpr_write_b32 a91, 0
  v_mfma_f32_16x16x32_bf16 v[196:199], v[88:91], v[244:247], v[196:199]
  s_add_u32 s28, s28, s23
  ds_read_b64_tr_b16 v[48:49], v12 offset:33280
  v_accvgpr_write_b32 a120, 0
  v_mfma_f32_16x16x32_bf16 v[212:215], v[92:95], v[244:247], v[212:215]
  s_lshl_b32 s23, s22, 2
  ds_read_b64_tr_b16 v[50:51], v12 offset:34304
  v_accvgpr_write_b32 a121, 0
  v_mfma_f32_16x16x32_bf16 v[104:107], v[64:67], v[248:251], v[104:107]
  s_sub_u32 s29, 28, s23
  ds_read_b64_tr_b16 v[52:53], v13 offset:33280
  v_accvgpr_write_b32 a122, 0
  v_mfma_f32_16x16x32_bf16 v[120:123], v[68:71], v[248:251], v[120:123]
  s_and_b32 s23, s20, 1
  ds_read_b64_tr_b16 v[54:55], v13 offset:34304
  v_accvgpr_write_b32 a123, 0
  v_mfma_f32_16x16x32_bf16 v[136:139], v[72:75], v[248:251], v[136:139]
  s_add_u32 s29, s29, s23
  v_accvgpr_write_b32 a92, 0
  v_accvgpr_write_b32 a93, 0
  v_mfma_f32_16x16x32_bf16 v[152:155], v[76:79], v[248:251], v[152:155]
  ds_read_b64_tr_b16 v[56:57], v12 offset:33536
  v_accvgpr_write_b32 a94, 0
  v_mfma_f32_16x16x32_bf16 v[168:171], v[80:83], v[248:251], v[168:171]
  ds_read_b64_tr_b16 v[58:59], v12 offset:34560
  v_accvgpr_write_b32 a95, 0
  v_mfma_f32_16x16x32_bf16 v[184:187], v[84:87], v[248:251], v[184:187]
  ds_read_b64_tr_b16 v[60:61], v13 offset:33536
  v_accvgpr_write_b32 a124, 0
  v_mfma_f32_16x16x32_bf16 v[200:203], v[88:91], v[248:251], v[200:203]
  ds_read_b64_tr_b16 v[62:63], v13 offset:34560
  v_accvgpr_write_b32 a125, 0
  v_mfma_f32_16x16x32_bf16 v[216:219], v[92:95], v[248:251], v[216:219]
  v_accvgpr_write_b32 a126, 0
  v_accvgpr_write_b32 a127, 0
  v_mfma_f32_16x16x32_bf16 v[108:111], v[64:67], v[252:255], v[108:111]
  ds_read_b128 v[232:235], v14 offset:2048
  v_mfma_f32_16x16x32_bf16 v[124:127], v[68:71], v[252:255], v[124:127]
  ds_read_b128 v[236:239], v14 offset:3072
  v_mfma_f32_16x16x32_bf16 v[140:143], v[72:75], v[252:255], v[140:143]
  v_mfma_f32_16x16x32_bf16 v[156:159], v[76:79], v[252:255], v[156:159]
  v_mfma_f32_16x16x32_bf16 v[172:175], v[80:83], v[252:255], v[172:175]
  v_mfma_f32_16x16x32_bf16 v[188:191], v[84:87], v[252:255], v[188:191]
  v_mfma_f32_16x16x32_bf16 v[204:207], v[88:91], v[252:255], v[204:207]
  v_mfma_f32_16x16x32_bf16 v[220:223], v[92:95], v[252:255], v[220:223]
  s_waitcnt vmcnt(0) lgkmcnt(0)
  v_mfma_f32_16x16x32_bf16 v[96:99], v[32:35], v[224:227], v[96:99]
  s_cmp_ge_u32 s20, 2
  v_mfma_f32_16x16x32_bf16 v[112:115], v[36:39], v[224:227], v[112:115]
  s_cselect_b32 s4, s6, s4
  ds_read_b64_tr_b16 v[64:65], v12 offset:40960
  v_mfma_f32_16x16x32_bf16 v[128:131], v[40:43], v[224:227], v[128:131]
  s_cselect_b32 s5, s7, s5
  ds_read_b64_tr_b16 v[66:67], v12 offset:41984
  v_mfma_f32_16x16x32_bf16 v[144:147], v[44:47], v[224:227], v[144:147]
  s_mov_b32 s62, 2211840
  buffer_load_dword v15, v8, s[40:43], 0 offen sc1
  v_mfma_f32_16x16x32_bf16 v[160:163], v[48:51], v[224:227], v[160:163]
  s_mov_b32 s63, 0x20000
  ds_read_b64_tr_b16 v[68:69], v13 offset:40960
  v_mfma_f32_16x16x32_bf16 v[176:179], v[52:55], v[224:227], v[176:179]
  s_mov_b64 s[56:57], s[52:53]
  ds_read_b64_tr_b16 v[70:71], v13 offset:41984
  v_mfma_f32_16x16x32_bf16 v[192:195], v[56:59], v[224:227], v[192:195]
  s_mov_b32 s58, s54
  ds_read_b64_tr_b16 v[72:73], v12 offset:41216
  v_mfma_f32_16x16x32_bf16 v[208:211], v[60:63], v[224:227], v[208:211]
  s_mov_b64 s[52:53], s[4:5]
  ds_read_b64_tr_b16 v[74:75], v12 offset:42240
  v_mfma_f32_16x16x32_bf16 v[100:103], v[32:35], v[228:231], v[100:103]
  s_mov_b32 s54, 2211840
  v_mfma_f32_16x16x32_bf16 v[116:119], v[36:39], v[228:231], v[116:119]
  s_getpc_b64 s[36:37]
fa_copc:
  ds_read_b64_tr_b16 v[76:77], v13 offset:41216
  v_mfma_f32_16x16x32_bf16 v[132:135], v[40:43], v[228:231], v[132:135]
  s_add_u32 s36, s36, fa_co-fa_copc-4
  ds_read_b64_tr_b16 v[78:79], v13 offset:42240
  v_mfma_f32_16x16x32_bf16 v[148:151], v[44:47], v[228:231], v[148:151]
  s_addc_u32 s37, s37, 0
  ds_read_b128 v[240:243], v14 offset:32768
  v_mfma_f32_16x16x32_bf16 v[164:167], v[48:51], v[228:231], v[164:167]
  ds_read_b128 v[244:247], v14 offset:33792
  v_mfma_f32_16x16x32_bf16 v[180:183], v[52:55], v[228:231], v[180:183]
  v_mfma_f32_16x16x32_bf16 v[196:199], v[56:59], v[228:231], v[196:199]
  ds_read_b64_tr_b16 v[80:81], v12 offset:41472
  v_mfma_f32_16x16x32_bf16 v[212:215], v[60:63], v[228:231], v[212:215]
  ds_read_b64_tr_b16 v[82:83], v12 offset:42496
  v_mfma_f32_16x16x32_bf16 v[104:107], v[32:35], v[232:235], v[104:107]
  ds_read_b64_tr_b16 v[84:85], v13 offset:41472
  v_mfma_f32_16x16x32_bf16 v[120:123], v[36:39], v[232:235], v[120:123]
  ds_read_b64_tr_b16 v[86:87], v13 offset:42496
  v_mfma_f32_16x16x32_bf16 v[136:139], v[40:43], v[232:235], v[136:139]
  v_mfma_f32_16x16x32_bf16 v[152:155], v[44:47], v[232:235], v[152:155]
  ds_read_b64_tr_b16 v[88:89], v12 offset:41728
  v_mfma_f32_16x16x32_bf16 v[168:171], v[48:51], v[232:235], v[168:171]
  ds_read_b64_tr_b16 v[90:91], v12 offset:42752
  v_mfma_f32_16x16x32_bf16 v[184:187], v[52:55], v[232:235], v[184:187]
  ds_read_b64_tr_b16 v[92:93], v13 offset:41728
  v_mfma_f32_16x16x32_bf16 v[200:203], v[56:59], v[232:235], v[200:203]
  ds_read_b64_tr_b16 v[94:95], v13 offset:42752
  v_mfma_f32_16x16x32_bf16 v[216:219], v[60:63], v[232:235], v[216:219]
  v_mfma_f32_16x16x32_bf16 v[108:111], v[32:35], v[236:239], v[108:111]
  ds_read_b128 v[248:251], v14 offset:34816
  v_mfma_f32_16x16x32_bf16 v[124:127], v[36:39], v[236:239], v[124:127]
  ds_read_b128 v[252:255], v14 offset:35840
  v_mfma_f32_16x16x32_bf16 v[140:143], v[40:43], v[236:239], v[140:143]
  v_mfma_f32_16x16x32_bf16 v[156:159], v[44:47], v[236:239], v[156:159]
  v_xor_b32 v14, 0x10000, v14
  v_mfma_f32_16x16x32_bf16 v[172:175], v[48:51], v[236:239], v[172:175]
  v_mfma_f32_16x16x32_bf16 v[188:191], v[52:55], v[236:239], v[188:191]
  v_xor_b32 v12, 0x10000, v12
  v_mfma_f32_16x16x32_bf16 v[204:207], v[56:59], v[236:239], v[204:207]
  v_xor_b32 v13, 0x10000, v13
  v_mfma_f32_16x16x32_bf16 v[220:223], v[60:63], v[236:239], v[220:223]
  s_waitcnt vmcnt(0) lgkmcnt(0)
  v_mfma_f32_16x16x32_bf16 v[96:99], v[64:67], v[240:243], v[96:99]
  s_barrier
  v_cmp_eq_u32 vcc, 0, v15
  v_mfma_f32_16x16x32_bf16 v[112:115], v[68:71], v[240:243], v[112:115]
  s_cbranch_vccnz fa_kv_spin
fa_kv_ok:
  v_mfma_f32_16x16x32_bf16 v[128:131], v[72:75], v[240:243], v[128:131]
  s_mov_b32 m0, s24
  v_mfma_f32_16x16x32_bf16 v[144:147], v[76:79], v[240:243], v[144:147]
  buffer_load_dwordx4 v2, s[44:47], s26 offen offset:0 sc1 lds
  v_mfma_f32_16x16x32_bf16 v[160:163], v[80:83], v[240:243], v[160:163]
  s_add_u32 s24, s24, 32768
  v_mfma_f32_16x16x32_bf16 v[176:179], v[84:87], v[240:243], v[176:179]
  s_and_b32 s24, s24, 0x1ffff
  buffer_load_dwordx4 v2, s[44:47], s26 offen offset:1024 sc1 lds
  v_mfma_f32_16x16x32_bf16 v[192:195], v[88:91], v[240:243], v[192:195]
  v_mfma_f32_16x16x32_bf16 v[208:211], v[92:95], v[240:243], v[208:211]
  buffer_load_dwordx4 v2, s[44:47], s26 offen offset:2048 sc1 lds
  v_mfma_f32_16x16x32_bf16 v[100:103], v[64:67], v[244:247], v[100:103]
  v_mfma_f32_16x16x32_bf16 v[116:119], v[68:71], v[244:247], v[116:119]
  buffer_load_dwordx4 v2, s[44:47], s26 offen offset:3072 sc1 lds
  v_mfma_f32_16x16x32_bf16 v[132:135], v[72:75], v[244:247], v[132:135]
  s_add_u32 s26, s26, 16384
  v_cvt_pk_bf16_f32 v32, v96, v97
  v_cvt_pk_bf16_f32 v33, v98, v99
  v_mfma_f32_16x16x32_bf16 v[148:151], v[76:79], v[244:247], v[148:151]
  v_cvt_pk_bf16_f32 v34, v112, v113
  v_cvt_pk_bf16_f32 v35, v114, v115
  v_mfma_f32_16x16x32_bf16 v[164:167], v[80:83], v[244:247], v[164:167]
  s_mov_b32 m0, s24
  v_cvt_pk_bf16_f32 v40, v128, v129
  v_mfma_f32_16x16x32_bf16 v[180:183], v[84:87], v[244:247], v[180:183]
  buffer_load_dwordx4 v2, s[44:47], s26 offen offset:0 sc1 lds
  v_cvt_pk_bf16_f32 v41, v130, v131
  v_cvt_pk_bf16_f32 v42, v144, v145
  v_mfma_f32_16x16x32_bf16 v[196:199], v[88:91], v[244:247], v[196:199]
  s_add_u32 s24, s24, 32768
  v_cvt_pk_bf16_f32 v43, v146, v147
  v_mfma_f32_16x16x32_bf16 v[212:215], v[92:95], v[244:247], v[212:215]
  s_and_b32 s24, s24, 0x1ffff
  buffer_load_dwordx4 v2, s[44:47], s26 offen offset:1024 sc1 lds
  v_cvt_pk_bf16_f32 v48, v160, v161
  v_cvt_pk_bf16_f32 v49, v162, v163
  v_mfma_f32_16x16x32_bf16 v[104:107], v[64:67], v[248:251], v[104:107]
  v_cvt_pk_bf16_f32 v50, v176, v177
  v_cvt_pk_bf16_f32 v51, v178, v179
  v_mfma_f32_16x16x32_bf16 v[120:123], v[68:71], v[248:251], v[120:123]
  buffer_load_dwordx4 v2, s[44:47], s26 offen offset:2048 sc1 lds
  v_cvt_pk_bf16_f32 v56, v192, v193
  v_mfma_f32_16x16x32_bf16 v[136:139], v[72:75], v[248:251], v[136:139]
  v_cvt_pk_bf16_f32 v57, v194, v195
  v_cvt_pk_bf16_f32 v58, v208, v209
  v_mfma_f32_16x16x32_bf16 v[152:155], v[76:79], v[248:251], v[152:155]
  buffer_load_dwordx4 v2, s[44:47], s26 offen offset:3072 sc1 lds
  v_cvt_pk_bf16_f32 v59, v210, v211
  v_mfma_f32_16x16x32_bf16 v[168:171], v[80:83], v[248:251], v[168:171]
  s_add_u32 s26, s26, 16384
  v_cvt_pk_bf16_f32 v36, v100, v101
  v_cvt_pk_bf16_f32 v37, v102, v103
  v_mfma_f32_16x16x32_bf16 v[184:187], v[84:87], v[248:251], v[184:187]
  v_cvt_pk_bf16_f32 v38, v116, v117
  v_mfma_f32_16x16x32_bf16 v[200:203], v[88:91], v[248:251], v[200:203]
  s_mov_b32 m0, s24
  v_cvt_pk_bf16_f32 v39, v118, v119
  v_cvt_pk_bf16_f32 v44, v132, v133
  v_mfma_f32_16x16x32_bf16 v[216:219], v[92:95], v[248:251], v[216:219]
  buffer_load_dwordx4 v2, s[44:47], s26 offen offset:0 sc1 lds
  v_cvt_pk_bf16_f32 v45, v134, v135
  v_mfma_f32_16x16x32_bf16 v[108:111], v[64:67], v[252:255], v[108:111]
  s_add_u32 s24, s24, 32768
  v_cvt_pk_bf16_f32 v46, v148, v149
  v_cvt_pk_bf16_f32 v47, v150, v151
  v_mfma_f32_16x16x32_bf16 v[124:127], v[68:71], v[252:255], v[124:127]
  s_and_b32 s24, s24, 0x1ffff
  buffer_load_dwordx4 v2, s[44:47], s26 offen offset:1024 sc1 lds
  v_cvt_pk_bf16_f32 v52, v164, v165
  v_mfma_f32_16x16x32_bf16 v[140:143], v[72:75], v[252:255], v[140:143]
  v_cvt_pk_bf16_f32 v53, v166, v167
  v_cvt_pk_bf16_f32 v54, v180, v181
  v_mfma_f32_16x16x32_bf16 v[156:159], v[76:79], v[252:255], v[156:159]
  buffer_load_dwordx4 v2, s[44:47], s26 offen offset:2048 sc1 lds
  v_cvt_pk_bf16_f32 v55, v182, v183
  v_mfma_f32_16x16x32_bf16 v[172:175], v[80:83], v[252:255], v[172:175]
  v_cvt_pk_bf16_f32 v60, v196, v197
  v_cvt_pk_bf16_f32 v61, v198, v199
  v_mfma_f32_16x16x32_bf16 v[188:191], v[84:87], v[252:255], v[188:191]
  buffer_load_dwordx4 v2, s[44:47], s26 offen offset:3072 sc1 lds
  v_cvt_pk_bf16_f32 v62, v212, v213
  v_mfma_f32_16x16x32_bf16 v[204:207], v[88:91], v[252:255], v[204:207]
  s_add_u32 s26, s26, 16384
  v_cvt_pk_bf16_f32 v63, v214, v215
  v_mfma_f32_16x16x32_bf16 v[220:223], v[92:95], v[252:255], v[220:223]
  s_mov_b32 m0, s25
  s_nop 0
  buffer_load_dwordx4 v2, s[48:51], s27 offen offset:0 sc1 lds
  v_cvt_pk_bf16_f32 v64, v104, v105
  v_cvt_pk_bf16_f32 v65, v106, v107
  v_cvt_pk_bf16_f32 v66, v120, v121
  v_cvt_pk_bf16_f32 v67, v122, v123
  v_cvt_pk_bf16_f32 v72, v136, v137
  buffer_load_dwordx4 v2, s[48:51], s27 offen offset:1024 sc1 lds
  v_cvt_pk_bf16_f32 v73, v138, v139
  v_cvt_pk_bf16_f32 v74, v152, v153
  v_cvt_pk_bf16_f32 v75, v154, v155
  v_cvt_pk_bf16_f32 v80, v168, v169
  v_cvt_pk_bf16_f32 v81, v170, v171
  buffer_load_dwordx4 v2, s[48:51], s27 offen offset:2048 sc1 lds
  v_cvt_pk_bf16_f32 v82, v184, v185
  v_cvt_pk_bf16_f32 v83, v186, v187
  v_cvt_pk_bf16_f32 v88, v200, v201
  v_cvt_pk_bf16_f32 v89, v202, v203
  v_cvt_pk_bf16_f32 v90, v216, v217
  buffer_load_dwordx4 v2, s[48:51], s27 offen offset:3072 sc1 lds
  v_cvt_pk_bf16_f32 v91, v218, v219
  v_cvt_pk_bf16_f32 v68, v108, v109
  v_cvt_pk_bf16_f32 v69, v110, v111
  v_cvt_pk_bf16_f32 v70, v124, v125
  v_cvt_pk_bf16_f32 v71, v126, v127
  s_add_u32 s27, s27, 16384
  s_add_u32 s25, s25, 32768
  s_and_b32 s25, s25, 0x1ffff
  s_mov_b32 m0, s25
  s_nop 0
  buffer_load_dwordx4 v2, s[48:51], s27 offen offset:0 sc1 lds
  v_cvt_pk_bf16_f32 v76, v140, v141
  v_cvt_pk_bf16_f32 v77, v142, v143
  v_cvt_pk_bf16_f32 v78, v156, v157
  v_cvt_pk_bf16_f32 v79, v158, v159
  v_cvt_pk_bf16_f32 v84, v172, v173
  buffer_load_dwordx4 v2, s[48:51], s27 offen offset:1024 sc1 lds
  v_cvt_pk_bf16_f32 v85, v174, v175
  v_cvt_pk_bf16_f32 v86, v188, v189
  v_cvt_pk_bf16_f32 v87, v190, v191
  v_cvt_pk_bf16_f32 v92, v204, v205
  v_cvt_pk_bf16_f32 v93, v206, v207
  buffer_load_dwordx4 v2, s[48:51], s27 offen offset:2048 sc1 lds
  v_cvt_pk_bf16_f32 v94, v220, v221
  v_cvt_pk_bf16_f32 v95, v222, v223
  v_mov_b32 v228, 0
  v_mov_b32 v229, 0
  v_mov_b32 v230, 0
  buffer_load_dwordx4 v2, s[48:51], s27 offen offset:3072 sc1 lds
  v_mov_b32 v231, 0
  s_add_u32 s27, s27, 16384
  s_add_u32 s25, s25, 32768
  s_and_b32 s25, s25, 0x1ffff
  s_waitcnt vmcnt(12)
  s_barrier
  ds_read_b128 a[128:131], v18 offset:0
  ds_read_b128 a[132:135], v18 offset:1024
  ds_read_b128 a[136:139], v18 offset:2048
  ds_read_b128 a[140:143], v18 offset:3072
  ds_read_b128 a[144:147], v18 offset:4096
  ds_read_b128 a[148:151], v18 offset:5120
  ds_read_b128 a[152:155], v18 offset:6144
  ds_read_b128 a[156:159], v18 offset:7168
  s_cmp_eq_u32 s2, 255
  s_cbranch_scc1 fa_top8
fa_notop:
  s_waitcnt lgkmcnt(4)
  v_mfma_f32_16x16x32_bf16 v[96:99], a[128:131], v[32:35], 0
  v_mfma_f32_16x16x32_bf16 v[104:107], a[128:131], v[36:39], 0
  v_mfma_f32_16x16x32_bf16 v[128:131], a[128:131], v[64:67], 0
  v_mfma_f32_16x16x32_bf16 v[136:139], a[128:131], v[68:71], 0
  s_mov_b32 m0, s24
  ds_read_b128 a[128:131], v3 offset:0
  v_mfma_f32_16x16x32_bf16 v[100:103], a[132:135], v[32:35], 0
  buffer_load_dwordx4 v2, s[44:47], s26 offen offset:0 sc1 lds
  v_mfma_f32_16x16x32_bf16 v[108:111], a[132:135], v[36:39], 0
  v_mfma_f32_16x16x32_bf16 v[132:135], a[132:135], v[64:67], 0
  v_mfma_f32_16x16x32_bf16 v[140:143], a[132:135], v[68:71], 0
  ds_read_b128 a[132:135], v3 offset:1024
  v_mfma_f32_16x16x32_bf16 v[96:99], a[136:139], v[40:43], v[96:99]
  v_mfma_f32_16x16x32_bf16 v[104:107], a[136:139], v[44:47], v[104:107]
  v_mfma_f32_16x16x32_bf16 v[128:131], a[136:139], v[72:75], v[128:131]
  buffer_load_dwordx4 v2, s[44:47], s26 offen offset:1024 sc1 lds
  v_mfma_f32_16x16x32_bf16 v[136:139], a[136:139], v[76:79], v[136:139]
  ds_read_b128 a[136:139], v3 offset:2048
  v_mfma_f32_16x16x32_bf16 v[100:103], a[140:143], v[40:43], v[100:103]
  v_mfma_f32_16x16x32_bf16 v[108:111], a[140:143], v[44:47], v[108:111]
  v_mfma_f32_16x16x32_bf16 v[132:135], a[140:143], v[72:75], v[132:135]
  v_mfma_f32_16x16x32_bf16 v[140:143], a[140:143], v[76:79], v[140:143]
  s_waitcnt lgkmcnt(3)
  ds_read_b128 a[140:143], v3 offset:3072
  v_mfma_f32_16x16x32_bf16 v[96:99], a[144:147], v[48:51], v[96:99]
  v_mfma_f32_16x16x32_bf16 v[104:107], a[144:147], v[52:55], v[104:107]
  v_mfma_f32_16x16x32_bf16 v[128:131], a[144:147], v[80:83], v[128:131]
  buffer_load_dwordx4 v2, s[44:47], s26 offen offset:2048 sc1 lds
  v_mfma_f32_16x16x32_bf16 v[136:139], a[144:147], v[84:87], v[136:139]
  ds_read_b128 a[144:147], v3 offset:4096
  v_mfma_f32_16x16x32_bf16 v[100:103], a[148:151], v[48:51], v[100:103]
  v_mfma_f32_16x16x32_bf16 v[108:111], a[148:151], v[52:55], v[108:111]
  v_mfma_f32_16x16x32_bf16 v[132:135], a[148:151], v[80:83], v[132:135]
  v_mfma_f32_16x16x32_bf16 v[140:143], a[148:151], v[84:87], v[140:143]
  ds_read_b128 a[148:151], v3 offset:5120
  v_mfma_f32_16x16x32_bf16 v[96:99], a[152:155], v[56:59], v[96:99]
  buffer_load_dwordx4 v2, s[44:47], s26 offen offset:3072 sc1 lds
  v_mfma_f32_16x16x32_bf16 v[104:107], a[152:155], v[60:63], v[104:107]
  s_add_u32 s26, s26, 16384
  v_mfma_f32_16x16x32_bf16 v[128:131], a[152:155], v[88:91], v[128:131]
  s_add_u32 s24, s24, 32768
  v_mfma_f32_16x16x32_bf16 v[136:139], a[152:155], v[92:95], v[136:139]
  s_and_b32 s24, s24, 0x1ffff
  ds_read_b128 a[152:155], v3 offset:6144
  v_mfma_f32_16x16x32_bf16 v[100:103], a[156:159], v[56:59], v[100:103]
  v_mfma_f32_16x16x32_bf16 v[108:111], a[156:159], v[60:63], v[108:111]
  v_mfma_f32_16x16x32_bf16 v[132:135], a[156:159], v[88:91], v[132:135]
  v_mfma_f32_16x16x32_bf16 v[140:143], a[156:159], v[92:95], v[140:143]
  s_waitcnt lgkmcnt(3)
  ds_read_b128 a[156:159], v3 offset:7168
  s_nop 7
  s_cmp_lg_u32 s28, 0
  s_cbranch_scc1 fa_nomask0
  v_cndmask_b32 v96, v4, v96, s[68:69]
  v_cndmask_b32 v97, v4, v97, s[70:71]
  v_cndmask_b32 v98, v4, v98, s[72:73]
  v_cndmask_b32 v99, v4, v99, s[74:75]
  v_mov_b32 v100, v4
  v_mov_b32 v101, v4
  v_mov_b32 v102, v4
  v_mov_b32 v103, v4
  v_cndmask_b32 v108, v4, v108, s[68:69]
  v_cndmask_b32 v109, v4, v109, s[70:71]
  v_cndmask_b32 v110, v4, v110, s[72:73]
  v_cndmask_b32 v111, v4, v111, s[74:75]
fa_nomask0:
  v_max3_f32 v16, v96, v97, v98
  v_max3_f32 v16, v16, v99, v100
  v_max3_f32 v16, v16, v101, v102
  v_max_f32 v16, v16, v103
  v_max3_f32 v17, v104, v105, v106
  v_max3_f32 v17, v17, v107, v108
  v_max3_f32 v17, v17, v109, v110
  v_max_f32 v17, v17, v111
  v_max3_f32 v18, v128, v129, v130
  v_max3_f32 v18, v18, v131, v132
  v_max3_f32 v18, v18, v133, v134
  v_max_f32 v18, v18, v135
  v_max3_f32 v19, v136, v137, v138
  v_max3_f32 v19, v19, v139, v140
  v_max3_f32 v19, v19, v141, v142
  v_max_f32 v19, v19, v143
  v_mov_b32 v20, v16
  v_mov_b32 v21, v17
  v_mov_b32 v22, v18
  v_mov_b32 v23, v19
  s_nop 0
  v_permlane16_swap_b32 v16, v20
  v_permlane16_swap_b32 v17, v21
  v_permlane16_swap_b32 v18, v22
  v_permlane16_swap_b32 v19, v23
  v_max_f32 v16, v16, v20
  v_max_f32 v17, v17, v21
  v_max_f32 v18, v18, v22
  v_max_f32 v19, v19, v23
  v_mov_b32 v20, v16
  v_mov_b32 v21, v17
  v_mov_b32 v22, v18
  v_mov_b32 v23, v19
  s_nop 0
  v_permlane32_swap_b32 v16, v20
  v_permlane32_swap_b32 v17, v21
  v_permlane32_swap_b32 v18, v22
  v_permlane32_swap_b32 v19, v23
  v_max_f32 v16, v16, v20
  v_max_f32 v17, v17, v21
  v_max_f32 v18, v18, v22
  v_max_f32 v19, v19, v23
  v_sub_f32 v192, 0, v16
  v_sub_f32 v193, 0, v16
  v_sub_f32 v194, 0, v16
  v_sub_f32 v195, 0, v16
  v_sub_f32 v196, 0, v17
  v_sub_f32 v197, 0, v17
  v_sub_f32 v198, 0, v17
  v_sub_f32 v199, 0, v17
  v_sub_f32 v200, 0, v18
  v_sub_f32 v201, 0, v18
  v_sub_f32 v202, 0, v18
  v_sub_f32 v203, 0, v18
  v_sub_f32 v204, 0, v19
  v_sub_f32 v205, 0, v19
  v_sub_f32 v206, 0, v19
  v_sub_f32 v207, 0, v19
  v_sub_f32 v96, v96, v16
  v_sub_f32 v97, v97, v16
  v_sub_f32 v98, v98, v16
  v_sub_f32 v99, v99, v16
  v_sub_f32 v100, v100, v16
  v_sub_f32 v101, v101, v16
  v_sub_f32 v102, v102, v16
  v_sub_f32 v103, v103, v16
  v_sub_f32 v104, v104, v17
  v_sub_f32 v105, v105, v17
  v_sub_f32 v106, v106, v17
  v_sub_f32 v107, v107, v17
  v_sub_f32 v108, v108, v17
  v_sub_f32 v109, v109, v17
  v_sub_f32 v110, v110, v17
  v_sub_f32 v111, v111, v17
  v_sub_f32 v128, v128, v18
  v_sub_f32 v129, v129, v18
  v_sub_f32 v130, v130, v18
  v_sub_f32 v131, v131, v18
  v_sub_f32 v132, v132, v18
  v_sub_f32 v133, v133, v18
  v_sub_f32 v134, v134, v18
  v_sub_f32 v135, v135, v18
  v_sub_f32 v136, v136, v19
  v_sub_f32 v137, v137, v19
  v_sub_f32 v138, v138, v19
  v_sub_f32 v139, v139, v19
  v_sub_f32 v140, v140, v19
  v_sub_f32 v141, v141, v19
  v_sub_f32 v142, v142, v19
  v_sub_f32 v143, v143, v19
  v_mfma_f32_16x16x32_bf16 v[112:115], a[128:131], v[32:35], v[192:195]
  v_exp_f32 v216, v128
  v_exp_f32 v217, v129
  v_mfma_f32_16x16x32_bf16 v[120:123], a[128:131], v[36:39], v[196:199]
  v_exp_f32 v218, v130
  v_add_f32 v226, v216, v217
  v_cvt_pk_bf16_f32 v176, v216, v217
  v_mfma_f32_16x16x32_bf16 v[144:147], a[128:131], v[64:67], v[200:203]
  s_add_u32 s66, s66, 32768
  v_exp_f32 v219, v131
  v_add_f32 v226, v226, v218
  v_add_f32 v226, v226, v219
  v_mfma_f32_16x16x32_bf16 v[152:155], a[128:131], v[68:71], v[204:207]
  s_mov_b32 m0, s25
  ds_read_b128 a[128:131], v3 offset:8192
  v_exp_f32 v220, v132
  v_cvt_pk_bf16_f32 v177, v218, v219
  v_mfma_f32_16x16x32_bf16 v[116:119], a[132:135], v[32:35], v[192:195]
  s_and_b32 s66, s66, 0x1ffff
  buffer_load_dwordx4 v2, s[48:51], s27 offen offset:0 sc1 lds
  v_exp_f32 v221, v133
  v_add_f32 v226, v226, v220
  v_add_f32 v226, v226, v221
  v_mfma_f32_16x16x32_bf16 v[124:127], a[132:135], v[36:39], v[196:199]
  v_exp_f32 v222, v134
  v_cvt_pk_bf16_f32 v178, v220, v221
  v_exp_f32 v223, v135
  v_mfma_f32_16x16x32_bf16 v[148:151], a[132:135], v[64:67], v[200:203]
  v_exp_f32 v216, v136
  v_add_f32 v226, v226, v222
  v_mfma_f32_16x16x32_bf16 v[156:159], a[132:135], v[68:71], v[204:207]
  ds_read_b128 a[132:135], v3 offset:9216
  v_exp_f32 v217, v137
  v_add_f32 v226, v226, v223
  v_mfma_f32_16x16x32_bf16 v[112:115], a[136:139], v[40:43], v[112:115]
  v_exp_f32 v218, v138
  v_cvt_pk_bf16_f32 v179, v222, v223
  v_add_f32 v227, v216, v217
  v_mfma_f32_16x16x32_bf16 v[120:123], a[136:139], v[44:47], v[120:123]
  v_exp_f32 v219, v139
  v_cvt_pk_bf16_f32 v180, v216, v217
  v_add_f32 v227, v227, v218
  v_add_f32 v227, v227, v219
  v_mfma_f32_16x16x32_bf16 v[144:147], a[136:139], v[72:75], v[144:147]
  buffer_load_dwordx4 v2, s[48:51], s27 offen offset:1024 sc1 lds
  v_exp_f32 v220, v140
  v_cvt_pk_bf16_f32 v181, v218, v219
  v_mfma_f32_16x16x32_bf16 v[152:155], a[136:139], v[76:79], v[152:155]
  ds_read_b128 a[136:139], v3 offset:10240
  v_exp_f32 v221, v141
  v_add_f32 v227, v227, v220
  v_mfma_f32_16x16x32_bf16 v[116:119], a[140:143], v[40:43], v[116:119]
  v_exp_f32 v222, v142
  v_add_f32 v227, v227, v221
  v_cvt_pk_bf16_f32 v182, v220, v221
  v_mfma_f32_16x16x32_bf16 v[124:127], a[140:143], v[44:47], v[124:127]
  v_exp_f32 v223, v143
  v_add_f32 v227, v227, v222
  v_add_f32 v227, v227, v223
  v_exp_f32 v208, v96
  v_mfma_f32_16x16x32_bf16 v[148:151], a[140:143], v[72:75], v[148:151]
  v_exp_f32 v209, v97
  v_cvt_pk_bf16_f32 v183, v222, v223
  v_mfma_f32_16x16x32_bf16 v[156:159], a[140:143], v[76:79], v[156:159]
  s_waitcnt lgkmcnt(3)
  ds_read_b128 a[140:143], v3 offset:11264
  v_exp_f32 v210, v98
  v_add_f32 v224, v208, v209
  v_mfma_f32_16x16x32_bf16 v[112:115], a[144:147], v[48:51], v[112:115]
  v_exp_f32 v211, v99
  v_cvt_pk_bf16_f32 v160, v208, v209
  v_add_f32 v224, v224, v210
  v_mfma_f32_16x16x32_bf16 v[120:123], a[144:147], v[52:55], v[120:123]
  v_exp_f32 v212, v100
  v_add_f32 v224, v224, v211
  v_cvt_pk_bf16_f32 v161, v210, v211
  v_mfma_f32_16x16x32_bf16 v[144:147], a[144:147], v[80:83], v[144:147]
  buffer_load_dwordx4 v2, s[48:51], s27 offen offset:2048 sc1 lds
  v_exp_f32 v213, v101
  v_add_f32 v224, v224, v212
  v_add_f32 v224, v224, v213
  v_mfma_f32_16x16x32_bf16 v[152:155], a[144:147], v[84:87], v[152:155]
  ds_read_b128 a[144:147], v3 offset:12288
  v_exp_f32 v214, v102
  v_cvt_pk_bf16_f32 v162, v212, v213
  v_mfma_f32_16x16x32_bf16 v[116:119], a[148:151], v[48:51], v[116:119]
  v_exp_f32 v215, v103
  v_add_f32 v224, v224, v214
  v_add_f32 v224, v224, v215
  v_mfma_f32_16x16x32_bf16 v[124:127], a[148:151], v[52:55], v[124:127]
  v_exp_f32 v208, v104
  v_exp_f32 v209, v105
  v_mfma_f32_16x16x32_bf16 v[148:151], a[148:151], v[80:83], v[148:151]
  v_exp_f32 v210, v106
  v_cvt_pk_bf16_f32 v163, v214, v215
  v_add_f32 v225, v208, v209
  v_mfma_f32_16x16x32_bf16 v[156:159], a[148:151], v[84:87], v[156:159]
  ds_read_b128 a[148:151], v3 offset:13312
  v_exp_f32 v211, v107
  v_cvt_pk_bf16_f32 v164, v208, v209
  v_add_f32 v225, v225, v210
  v_mfma_f32_16x16x32_bf16 v[112:115], a[152:155], v[56:59], v[112:115]
  buffer_load_dwordx4 v2, s[48:51], s27 offen offset:3072 sc1 lds
  v_exp_f32 v212, v108
  v_add_f32 v225, v225, v211
  v_mfma_f32_16x16x32_bf16 v[120:123], a[152:155], v[60:63], v[120:123]
  s_add_u32 s27, s27, 16384
  v_exp_f32 v213, v109
  v_mfma_f32_16x16x32_bf16 v[144:147], a[152:155], v[88:91], v[144:147]
  s_add_u32 s25, s25, 32768
  v_exp_f32 v214, v110
  v_mfma_f32_16x16x32_bf16 v[152:155], a[152:155], v[92:95], v[152:155]
  s_and_b32 s25, s25, 0x1ffff
  ds_read_b128 a[152:155], v3 offset:14336
  v_cvt_pk_bf16_f32 v165, v210, v211
  v_max3_f32 v5, v226, v227, v224
  v_add_f32 v225, v225, v212
  v_add_f32 v225, v225, v213
  v_cvt_pk_bf16_f32 v166, v212, v213
  v_exp_f32 v215, v111
  v_mfma_f32_16x16x32_bf16 v[116:119], a[156:159], v[56:59], v[116:119]
  v_add_f32 v225, v225, v214
  v_add_f32 v225, v225, v215
  v_max_f32 v5, v5, v225
  v_cmp_lt_f32 vcc, s81, v5
  v_mfma_f32_16x16x32_bf16 v[124:127], a[156:159], v[60:63], v[124:127]
  v_mfma_f32_16x16x32_bf16 v[148:151], a[156:159], v[88:91], v[148:151]
  v_cvt_pk_bf16_f32 v167, v214, v215
  v_mfma_f32_16x16x32_bf16 v[156:159], a[156:159], v[92:95], v[156:159]
  s_waitcnt lgkmcnt(3)
  s_cbranch_vccnz fa_stub0
fa_back0:
  ds_read_b128 a[156:159], v3 offset:15360
  v_add_f32 v228, v228, v224
  v_add_f32 v229, v229, v225
  v_add_f32 v230, v230, v226
  v_add_f32 v231, v231, v227
  s_nop 3
  v_exp_f32 v216, v144
  v_exp_f32 v217, v145
  v_add_u32 v3, s66, v2
  s_cmp_eq_u32 s28, 0
  s_cbranch_scc1 fa_AV
  s_sub_u32 s28, s28, 1
  s_cmp_eq_u32 s28, 0
  s_cbranch_scc1 fa_Aexit
.p2align 6
fa_DD:
  v_mfma_f32_16x16x32_bf16 v[96:99], a[128:131], v[32:35], v[192:195]
  s_waitcnt vmcnt(12)
  v_exp_f32 v218, v146
  v_mfma_f32_16x16x32_bf16 v[104:107], a[128:131], v[36:39], v[196:199]
  s_barrier
  v_exp_f32 v219, v147
  v_mfma_f32_16x16x32_bf16 v[128:131], a[128:131], v[64:67], v[200:203]
  s_cmp_ge_u32 s26, s32
  ds_read_b128 a[160:163], v3 offset:16384
  v_add_f32 v226, v216, v217
  v_mfma_f32_16x16x32_bf16 v[136:139], a[128:131], v[68:71], v[204:207]
  s_cbranch_scc1 fa_hk4
fa_hb4:
  v_exp_f32 v220, v148
  v_mfma_f32_16x16x32_bf16 v[100:103], a[132:135], v[32:35], v[192:195]
  ds_read_b128 a[164:167], v3 offset:17408
  v_cvt_pk_bf16_f32 v184, v216, v217
  v_mfma_f32_16x16x32_bf16 v[108:111], a[132:135], v[36:39], v[196:199]
  s_mov_b32 m0, s24
  v_exp_f32 v221, v149
  v_mfma_f32_16x16x32_bf16 v[132:135], a[132:135], v[64:67], v[200:203]
  buffer_load_dwordx4 v2, s[44:47], s26 offen offset:0 sc1 lds
  v_add_f32 v226, v226, v218
  v_mfma_f32_16x16x32_bf16 v[140:143], a[132:135], v[68:71], v[204:207]
  v_exp_f32 v222, v150
  v_mfma_f32_16x16x32_bf16 v[96:99], a[136:139], v[40:43], v[96:99]
  ds_read_b128 a[168:171], v3 offset:18432
  v_add_f32 v226, v226, v219
  v_mfma_f32_16x16x32_bf16 v[104:107], a[136:139], v[44:47], v[104:107]
  v_exp_f32 v223, v151
  v_mfma_f32_16x16x32_bf16 v[128:131], a[136:139], v[72:75], v[128:131]
  v_cvt_pk_bf16_f32 v185, v218, v219
  v_add_f32 v226, v226, v220
  v_mfma_f32_16x16x32_bf16 v[136:139], a[136:139], v[76:79], v[136:139]
  v_exp_f32 v216, v152
  v_mfma_f32_16x16x32_bf16 v[100:103], a[140:143], v[40:43], v[100:103]
  ds_read_b128 a[172:175], v3 offset:19456
  v_add_f32 v226, v226, v221
  v_mfma_f32_16x16x32_bf16 v[108:111], a[140:143], v[44:47], v[108:111]
  v_exp_f32 v217, v153
  v_mfma_f32_16x16x32_bf16 v[132:135], a[140:143], v[72:75], v[132:135]
  v_cvt_pk_bf16_f32 v186, v220, v221
  v_add_f32 v226, v226, v222
  v_mfma_f32_16x16x32_bf16 v[140:143], a[140:143], v[76:79], v[140:143]
  s_waitcnt lgkmcnt(4)
  v_exp_f32 v218, v154
  v_mfma_f32_16x16x32_bf16 v[96:99], a[144:147], v[48:51], v[96:99]
  ds_read_b128 a[176:179], v3 offset:20480
  v_add_f32 v226, v226, v223
  v_mfma_f32_16x16x32_bf16 v[104:107], a[144:147], v[52:55], v[104:107]
  v_exp_f32 v219, v155
  v_mfma_f32_16x16x32_bf16 v[128:131], a[144:147], v[80:83], v[128:131]
  v_cvt_pk_bf16_f32 v187, v222, v223
  v_add_f32 v227, v216, v217
  v_mfma_f32_16x16x32_bf16 v[136:139], a[144:147], v[84:87], v[136:139]
  v_exp_f32 v220, v156
  v_mfma_f32_16x16x32_bf16 v[100:103], a[148:151], v[48:51], v[100:103]
  ds_read_b128 a[180:183], v3 offset:21504
  v_cvt_pk_bf16_f32 v188, v216, v217
  v_mfma_f32_16x16x32_bf16 v[108:111], a[148:151], v[52:55], v[108:111]
  v_exp_f32 v221, v157
  v_mfma_f32_16x16x32_bf16 v[132:135], a[148:151], v[80:83], v[132:135]
  buffer_load_dwordx4 v2, s[44:47], s26 offen offset:1024 sc1 lds
  v_add_f32 v227, v227, v218
  v_mfma_f32_16x16x32_bf16 v[140:143], a[148:151], v[84:87], v[140:143]
  v_exp_f32 v222, v158
  v_mfma_f32_16x16x32_bf16 v[96:99], a[152:155], v[56:59], v[96:99]
  ds_read_b128 a[184:187], v3 offset:22528
  v_add_f32 v227, v227, v219
  v_mfma_f32_16x16x32_bf16 v[104:107], a[152:155], v[60:63], v[104:107]
  v_exp_f32 v223, v159
  v_mfma_f32_16x16x32_bf16 v[128:131], a[152:155], v[88:91], v[128:131]
  v_cvt_pk_bf16_f32 v189, v218, v219
  v_add_f32 v227, v227, v220
  v_mfma_f32_16x16x32_bf16 v[136:139], a[152:155], v[92:95], v[136:139]
  v_exp_f32 v208, v112
  v_mfma_f32_16x16x32_bf16 v[100:103], a[156:159], v[56:59], v[100:103]
  ds_read_b128 a[188:191], v3 offset:23552
  v_add_f32 v227, v227, v221
  v_mfma_f32_16x16x32_bf16 v[108:111], a[156:159], v[60:63], v[108:111]
  v_exp_f32 v209, v113
  v_mfma_f32_16x16x32_bf16 v[132:135], a[156:159], v[88:91], v[132:135]
  v_cvt_pk_bf16_f32 v190, v220, v221
  v_add_f32 v227, v227, v222
  v_add_f32 v227, v227, v223
  v_mfma_f32_16x16x32_bf16 v[140:143], a[156:159], v[92:95], v[140:143]
  s_waitcnt lgkmcnt(4)
  v_exp_f32 v210, v114
  v_mfma_f32_16x16x32_bf16 a[0:3], a[160:163], v[160:163], a[0:3]
  ds_read_b128 a[128:131], v3 offset:0
  v_cvt_pk_bf16_f32 v191, v222, v223
  v_mfma_f32_16x16x32_bf16 a[4:7], a[160:163], v[164:167], a[4:7]
  v_exp_f32 v211, v115
  v_mfma_f32_16x16x32_bf16 a[64:67], a[160:163], v[176:179], a[64:67]
  v_exp_f32 v212, v116
  v_mfma_f32_16x16x32_bf16 a[68:71], a[160:163], v[180:183], a[68:71]
  v_add_f32 v224, v208, v209
  v_cvt_pk_bf16_f32 v168, v208, v209
  v_mfma_f32_16x16x32_bf16 a[8:11], a[164:167], v[160:163], a[8:11]
  ds_read_b128 a[132:135], v3 offset:1024
  v_add_f32 v224, v224, v210
  v_mfma_f32_16x16x32_bf16 a[12:15], a[164:167], v[164:167], a[12:15]
  v_exp_f32 v213, v117
  v_mfma_f32_16x16x32_bf16 a[72:75], a[164:167], v[176:179], a[72:75]
  buffer_load_dwordx4 v2, s[44:47], s26 offen offset:2048 sc1 lds
  v_add_f32 v224, v224, v211
  v_mfma_f32_16x16x32_bf16 a[76:79], a[164:167], v[180:183], a[76:79]
  v_exp_f32 v214, v118
  v_mfma_f32_16x16x32_bf16 a[16:19], a[168:171], v[160:163], a[16:19]
  ds_read_b128 a[136:139], v3 offset:2048
  v_cvt_pk_bf16_f32 v169, v210, v211
  v_mfma_f32_16x16x32_bf16 a[20:23], a[168:171], v[164:167], a[20:23]
  v_exp_f32 v215, v119
  v_mfma_f32_16x16x32_bf16 a[80:83], a[168:171], v[176:179], a[80:83]
  v_add_f32 v224, v224, v212
  v_add_f32 v224, v224, v213
  v_mfma_f32_16x16x32_bf16 a[84:87], a[168:171], v[180:183], a[84:87]
  v_exp_f32 v208, v120
  v_mfma_f32_16x16x32_bf16 a[24:27], a[172:175], v[160:163], a[24:27]
  ds_read_b128 a[140:143], v3 offset:3072
  v_cvt_pk_bf16_f32 v170, v212, v213
  v_mfma_f32_16x16x32_bf16 a[28:31], a[172:175], v[164:167], a[28:31]
  v_exp_f32 v209, v121
  v_mfma_f32_16x16x32_bf16 a[88:91], a[172:175], v[176:179], a[88:91]
  v_exp_f32 v210, v122
  v_mfma_f32_16x16x32_bf16 a[92:95], a[172:175], v[180:183], a[92:95]
  s_waitcnt lgkmcnt(4)
  v_add_f32 v224, v224, v214
  v_add_f32 v224, v224, v215
  v_mfma_f32_16x16x32_bf16 a[32:35], a[176:179], v[160:163], a[32:35]
  ds_read_b128 a[144:147], v3 offset:4096
  v_cvt_pk_bf16_f32 v171, v214, v215
  v_mfma_f32_16x16x32_bf16 a[36:39], a[176:179], v[164:167], a[36:39]
  v_exp_f32 v211, v123
  v_mfma_f32_16x16x32_bf16 a[96:99], a[176:179], v[176:179], a[96:99]
  v_add_f32 v225, v208, v209
  v_cvt_pk_bf16_f32 v172, v208, v209
  v_mfma_f32_16x16x32_bf16 a[100:103], a[176:179], v[180:183], a[100:103]
  v_exp_f32 v212, v124
  v_mfma_f32_16x16x32_bf16 a[40:43], a[180:183], v[160:163], a[40:43]
  ds_read_b128 a[148:151], v3 offset:5120
  v_add_f32 v225, v225, v210
  v_mfma_f32_16x16x32_bf16 a[44:47], a[180:183], v[164:167], a[44:47]
  v_exp_f32 v213, v125
  v_mfma_f32_16x16x32_bf16 a[104:107], a[180:183], v[176:179], a[104:107]
  buffer_load_dwordx4 v2, s[44:47], s26 offen offset:3072 sc1 lds
  v_add_f32 v225, v225, v211
  v_mfma_f32_16x16x32_bf16 a[108:111], a[180:183], v[180:183], a[108:111]
  s_add_u32 s26, s26, 16384
  v_exp_f32 v214, v126
  v_mfma_f32_16x16x32_bf16 a[48:51], a[184:187], v[160:163], a[48:51]
  s_add_u32 s24, s24, 32768
  ds_read_b128 a[152:155], v3 offset:6144
  v_cvt_pk_bf16_f32 v173, v210, v211
  v_mfma_f32_16x16x32_bf16 a[52:55], a[184:187], v[164:167], a[52:55]
  s_and_b32 s24, s24, 0x1ffff
  v_exp_f32 v215, v127
  v_mfma_f32_16x16x32_bf16 a[112:115], a[184:187], v[176:179], a[112:115]
  v_max3_f32 v5, v226, v227, v224
  v_add_f32 v225, v225, v212
  v_mfma_f32_16x16x32_bf16 a[116:119], a[184:187], v[180:183], a[116:119]
  v_add_f32 v225, v225, v213
  v_cvt_pk_bf16_f32 v174, v212, v213
  v_add_f32 v225, v225, v214
  v_mfma_f32_16x16x32_bf16 a[56:59], a[188:191], v[160:163], a[56:59]
  ds_read_b128 a[156:159], v3 offset:7168
  v_add_f32 v225, v225, v215
  v_max_f32 v5, v5, v225
  v_cmp_lt_f32 vcc, s81, v5
  v_mfma_f32_16x16x32_bf16 a[60:63], a[188:191], v[164:167], a[60:63]
  v_exp_f32 v216, v128
  v_mfma_f32_16x16x32_bf16 a[120:123], a[188:191], v[176:179], a[120:123]
  s_waitcnt lgkmcnt(4)
  v_cvt_pk_bf16_f32 v175, v214, v215
  v_mfma_f32_16x16x32_bf16 a[124:127], a[188:191], v[180:183], a[124:127]
  s_cbranch_vccnz fa_stub1
fa_back1:
  v_exp_f32 v217, v129
  v_add_f32 v228, v228, v224
  v_add_f32 v229, v229, v225
  v_add_f32 v230, v230, v226
  v_add_f32 v231, v231, v227
fa_DDe:
  v_mfma_f32_16x16x32_bf16 v[112:115], a[128:131], v[32:35], v[192:195]
  ds_read_b128 a[160:163], v3 offset:24576
  v_add_f32 v226, v216, v217
  v_mfma_f32_16x16x32_bf16 v[120:123], a[128:131], v[36:39], v[196:199]
  v_exp_f32 v218, v130
  v_mfma_f32_16x16x32_bf16 v[144:147], a[128:131], v[64:67], v[200:203]
  s_cmp_ge_u32 s26, s9
  v_exp_f32 v219, v131
  v_mfma_f32_16x16x32_bf16 v[152:155], a[128:131], v[68:71], v[204:207]
  s_cbranch_scc1 fa_hk5
fa_hb5:
  v_exp_f32 v220, v132
  v_mfma_f32_16x16x32_bf16 v[116:119], a[132:135], v[32:35], v[192:195]
  s_add_u32 s66, s66, 32768
  ds_read_b128 a[164:167], v3 offset:25600
  v_cvt_pk_bf16_f32 v176, v216, v217
  v_mfma_f32_16x16x32_bf16 v[124:127], a[132:135], v[36:39], v[196:199]
  s_mov_b32 m0, s25
  v_exp_f32 v221, v133
  v_mfma_f32_16x16x32_bf16 v[148:151], a[132:135], v[64:67], v[200:203]
  s_and_b32 s66, s66, 0x1ffff
  buffer_load_dwordx4 v2, s[48:51], s27 offen offset:0 sc1 lds
  v_add_f32 v226, v226, v218
  v_mfma_f32_16x16x32_bf16 v[156:159], a[132:135], v[68:71], v[204:207]
  v_exp_f32 v222, v134
  v_mfma_f32_16x16x32_bf16 v[112:115], a[136:139], v[40:43], v[112:115]
  ds_read_b128 a[168:171], v3 offset:26624
  v_add_f32 v226, v226, v219
  v_mfma_f32_16x16x32_bf16 v[120:123], a[136:139], v[44:47], v[120:123]
  v_exp_f32 v223, v135
  v_mfma_f32_16x16x32_bf16 v[144:147], a[136:139], v[72:75], v[144:147]
  v_cvt_pk_bf16_f32 v177, v218, v219
  v_add_f32 v226, v226, v220
  v_mfma_f32_16x16x32_bf16 v[152:155], a[136:139], v[76:79], v[152:155]
  v_exp_f32 v216, v136
  v_mfma_f32_16x16x32_bf16 v[116:119], a[140:143], v[40:43], v[116:119]
  ds_read_b128 a[172:175], v3 offset:27648
  v_add_f32 v226, v226, v221
  v_mfma_f32_16x16x32_bf16 v[124:127], a[140:143], v[44:47], v[124:127]
  v_exp_f32 v217, v137
  v_mfma_f32_16x16x32_bf16 v[148:151], a[140:143], v[72:75], v[148:151]
  v_cvt_pk_bf16_f32 v178, v220, v221
  v_add_f32 v226, v226, v222
  v_mfma_f32_16x16x32_bf16 v[156:159], a[140:143], v[76:79], v[156:159]
  s_waitcnt lgkmcnt(4)
  v_exp_f32 v218, v138
  v_mfma_f32_16x16x32_bf16 v[112:115], a[144:147], v[48:51], v[112:115]
  ds_read_b128 a[176:179], v3 offset:28672
  v_add_f32 v226, v226, v223
  v_mfma_f32_16x16x32_bf16 v[120:123], a[144:147], v[52:55], v[120:123]
  v_exp_f32 v219, v139
  v_mfma_f32_16x16x32_bf16 v[144:147], a[144:147], v[80:83], v[144:147]
  v_cvt_pk_bf16_f32 v179, v222, v223
  v_add_f32 v227, v216, v217
  v_mfma_f32_16x16x32_bf16 v[152:155], a[144:147], v[84:87], v[152:155]
  v_exp_f32 v220, v140
  v_mfma_f32_16x16x32_bf16 v[116:119], a[148:151], v[48:51], v[116:119]
  ds_read_b128 a[180:183], v3 offset:29696
  v_cvt_pk_bf16_f32 v180, v216, v217
  v_mfma_f32_16x16x32_bf16 v[124:127], a[148:151], v[52:55], v[124:127]
  v_exp_f32 v221, v141
  v_mfma_f32_16x16x32_bf16 v[148:151], a[148:151], v[80:83], v[148:151]
  buffer_load_dwordx4 v2, s[48:51], s27 offen offset:1024 sc1 lds
  v_add_f32 v227, v227, v218
  v_mfma_f32_16x16x32_bf16 v[156:159], a[148:151], v[84:87], v[156:159]
  v_exp_f32 v222, v142
  v_mfma_f32_16x16x32_bf16 v[112:115], a[152:155], v[56:59], v[112:115]
  ds_read_b128 a[184:187], v3 offset:30720
  v_add_f32 v227, v227, v219
  v_mfma_f32_16x16x32_bf16 v[120:123], a[152:155], v[60:63], v[120:123]
  v_exp_f32 v223, v143
  v_mfma_f32_16x16x32_bf16 v[144:147], a[152:155], v[88:91], v[144:147]
  v_cvt_pk_bf16_f32 v181, v218, v219
  v_add_f32 v227, v227, v220
  v_mfma_f32_16x16x32_bf16 v[152:155], a[152:155], v[92:95], v[152:155]
  v_exp_f32 v208, v96
  v_mfma_f32_16x16x32_bf16 v[116:119], a[156:159], v[56:59], v[116:119]
  ds_read_b128 a[188:191], v3 offset:31744
  v_add_f32 v227, v227, v221
  v_mfma_f32_16x16x32_bf16 v[124:127], a[156:159], v[60:63], v[124:127]
  v_exp_f32 v209, v97
  v_mfma_f32_16x16x32_bf16 v[148:151], a[156:159], v[88:91], v[148:151]
  v_cvt_pk_bf16_f32 v182, v220, v221
  v_add_f32 v227, v227, v222
  v_add_f32 v227, v227, v223
  v_mfma_f32_16x16x32_bf16 v[156:159], a[156:159], v[92:95], v[156:159]
  s_waitcnt lgkmcnt(4)
  v_exp_f32 v210, v98
  v_mfma_f32_16x16x32_bf16 a[0:3], a[160:163], v[168:171], a[0:3]
  ds_read_b128 a[128:131], v3 offset:8192
  v_cvt_pk_bf16_f32 v183, v222, v223
  v_mfma_f32_16x16x32_bf16 a[4:7], a[160:163], v[172:175], a[4:7]
  v_exp_f32 v211, v99
  v_mfma_f32_16x16x32_bf16 a[64:67], a[160:163], v[184:187], a[64:67]
  v_exp_f32 v212, v100
  v_mfma_f32_16x16x32_bf16 a[68:71], a[160:163], v[188:191], a[68:71]
  v_add_f32 v224, v208, v209
  v_cvt_pk_bf16_f32 v160, v208, v209
  v_mfma_f32_16x16x32_bf16 a[8:11], a[164:167], v[168:171], a[8:11]
  ds_read_b128 a[132:135], v3 offset:9216
  v_add_f32 v224, v224, v210
  v_mfma_f32_16x16x32_bf16 a[12:15], a[164:167], v[172:175], a[12:15]
  v_exp_f32 v213, v101
  v_mfma_f32_16x16x32_bf16 a[72:75], a[164:167], v[184:187], a[72:75]
  buffer_load_dwordx4 v2, s[48:51], s27 offen offset:2048 sc1 lds
  v_add_f32 v224, v224, v211
  v_mfma_f32_16x16x32_bf16 a[76:79], a[164:167], v[188:191], a[76:79]
  v_exp_f32 v214, v102
  v_mfma_f32_16x16x32_bf16 a[16:19], a[168:171], v[168:171], a[16:19]
  ds_read_b128 a[136:139], v3 offset:10240
  v_cvt_pk_bf16_f32 v161, v210, v211
  v_mfma_f32_16x16x32_bf16 a[20:23], a[168:171], v[172:175], a[20:23]
  v_exp_f32 v215, v103
  v_mfma_f32_16x16x32_bf16 a[80:83], a[168:171], v[184:187], a[80:83]
  v_add_f32 v224, v224, v212
  v_add_f32 v224, v224, v213
  v_mfma_f32_16x16x32_bf16 a[84:87], a[168:171], v[188:191], a[84:87]
  v_exp_f32 v208, v104
  v_mfma_f32_16x16x32_bf16 a[24:27], a[172:175], v[168:171], a[24:27]
  ds_read_b128 a[140:143], v3 offset:11264
  v_cvt_pk_bf16_f32 v162, v212, v213
  v_mfma_f32_16x16x32_bf16 a[28:31], a[172:175], v[172:175], a[28:31]
  v_exp_f32 v209, v105
  v_mfma_f32_16x16x32_bf16 a[88:91], a[172:175], v[184:187], a[88:91]
  v_exp_f32 v210, v106
  v_mfma_f32_16x16x32_bf16 a[92:95], a[172:175], v[188:191], a[92:95]
  s_waitcnt lgkmcnt(4)
  v_add_f32 v224, v224, v214
  v_add_f32 v224, v224, v215
  v_mfma_f32_16x16x32_bf16 a[32:35], a[176:179], v[168:171], a[32:35]
  ds_read_b128 a[144:147], v3 offset:12288
  v_cvt_pk_bf16_f32 v163, v214, v215
  v_mfma_f32_16x16x32_bf16 a[36:39], a[176:179], v[172:175], a[36:39]
  v_exp_f32 v211, v107
  v_mfma_f32_16x16x32_bf16 a[96:99], a[176:179], v[184:187], a[96:99]
  v_add_f32 v225, v208, v209
  v_cvt_pk_bf16_f32 v164, v208, v209
  v_mfma_f32_16x16x32_bf16 a[100:103], a[176:179], v[188:191], a[100:103]
  v_exp_f32 v212, v108
  v_mfma_f32_16x16x32_bf16 a[40:43], a[180:183], v[168:171], a[40:43]
  ds_read_b128 a[148:151], v3 offset:13312
  v_add_f32 v225, v225, v210
  v_mfma_f32_16x16x32_bf16 a[44:47], a[180:183], v[172:175], a[44:47]
  v_exp_f32 v213, v109
  v_mfma_f32_16x16x32_bf16 a[104:107], a[180:183], v[184:187], a[104:107]
  buffer_load_dwordx4 v2, s[48:51], s27 offen offset:3072 sc1 lds
  v_add_f32 v225, v225, v211
  v_mfma_f32_16x16x32_bf16 a[108:111], a[180:183], v[188:191], a[108:111]
  s_add_u32 s27, s27, 16384
  v_exp_f32 v214, v110
  v_mfma_f32_16x16x32_bf16 a[48:51], a[184:187], v[168:171], a[48:51]
  s_add_u32 s25, s25, 32768
  ds_read_b128 a[152:155], v3 offset:14336
  v_cvt_pk_bf16_f32 v165, v210, v211
  v_mfma_f32_16x16x32_bf16 a[52:55], a[184:187], v[172:175], a[52:55]
  s_and_b32 s25, s25, 0x1ffff
  v_exp_f32 v215, v111
  v_mfma_f32_16x16x32_bf16 a[112:115], a[184:187], v[184:187], a[112:115]
  v_max3_f32 v5, v226, v227, v224
  v_add_f32 v225, v225, v212
  v_mfma_f32_16x16x32_bf16 a[116:119], a[184:187], v[188:191], a[116:119]
  v_add_f32 v225, v225, v213
  v_cvt_pk_bf16_f32 v166, v212, v213
  v_add_f32 v225, v225, v214
  v_mfma_f32_16x16x32_bf16 a[56:59], a[188:191], v[168:171], a[56:59]
  s_sub_u32 s28, s28, 1
  ds_read_b128 a[156:159], v3 offset:15360
  v_add_f32 v225, v225, v215
  v_max_f32 v5, v5, v225
  v_cmp_lt_f32 vcc, s81, v5
  v_mfma_f32_16x16x32_bf16 a[60:63], a[188:191], v[172:175], a[60:63]
  s_cmp_gt_u32 s28, s8
  v_exp_f32 v216, v144
  v_mfma_f32_16x16x32_bf16 a[120:123], a[188:191], v[184:187], a[120:123]
  s_waitcnt lgkmcnt(4)
  v_cvt_pk_bf16_f32 v167, v214, v215
  v_add_u32 v3, s66, v2
  v_mfma_f32_16x16x32_bf16 a[124:127], a[188:191], v[188:191], a[124:127]
  s_cbranch_vccnz fa_stub2
fa_back2:
  v_exp_f32 v217, v145
  v_add_f32 v228, v228, v224
  v_add_f32 v229, v229, v225
  v_add_f32 v230, v230, v226
  v_add_f32 v231, v231, v227
  s_cbranch_scc1 fa_DD
  s_cmp_lg_u32 s8, 0
  s_cbranch_scc1 fa_DDF
fa_Aexit:
  s_bitcmp1_b32 s20, 0
  s_cbranch_scc1 fa_Aodd
  v_mfma_f32_16x16x32_bf16 v[96:99], a[128:131], v[32:35], v[192:195]
  s_waitcnt vmcnt(12)
  v_exp_f32 v218, v146
  v_mfma_f32_16x16x32_bf16 v[104:107], a[128:131], v[36:39], v[196:199]
  s_barrier
  v_exp_f32 v219, v147
  v_mfma_f32_16x16x32_bf16 v[128:131], a[128:131], v[64:67], v[200:203]
  ds_read_b128 a[160:163], v3 offset:16384
  v_add_f32 v226, v216, v217
  v_mfma_f32_16x16x32_bf16 v[136:139], a[128:131], v[68:71], v[204:207]
  v_exp_f32 v220, v148
  v_mfma_f32_16x16x32_bf16 v[100:103], a[132:135], v[32:35], v[192:195]
  ds_read_b128 a[164:167], v3 offset:17408
  v_cvt_pk_bf16_f32 v184, v216, v217
  v_mfma_f32_16x16x32_bf16 v[108:111], a[132:135], v[36:39], v[196:199]
  s_mov_b32 m0, s24
  v_exp_f32 v221, v149
  v_mfma_f32_16x16x32_bf16 v[132:135], a[132:135], v[64:67], v[200:203]
  buffer_load_dwordx4 v2, s[44:47], s26 offen offset:0 sc1 lds
  v_add_f32 v226, v226, v218
  v_mfma_f32_16x16x32_bf16 v[140:143], a[132:135], v[68:71], v[204:207]
  v_exp_f32 v222, v150
  v_mfma_f32_16x16x32_bf16 v[96:99], a[136:139], v[40:43], v[96:99]
  ds_read_b128 a[168:171], v3 offset:18432
  v_add_f32 v226, v226, v219
  v_mfma_f32_16x16x32_bf16 v[104:107], a[136:139], v[44:47], v[104:107]
  v_exp_f32 v223, v151
  v_mfma_f32_16x16x32_bf16 v[128:131], a[136:139], v[72:75], v[128:131]
  v_cvt_pk_bf16_f32 v185, v218, v219
  v_add_f32 v226, v226, v220
  v_mfma_f32_16x16x32_bf16 v[136:139], a[136:139], v[76:79], v[136:139]
  v_exp_f32 v216, v152
  v_mfma_f32_16x16x32_bf16 v[100:103], a[140:143], v[40:43], v[100:103]
  ds_read_b128 a[172:175], v3 offset:19456
  v_add_f32 v226, v226, v221
  v_mfma_f32_16x16x32_bf16 v[108:111], a[140:143], v[44:47], v[108:111]
  v_exp_f32 v217, v153
  v_mfma_f32_16x16x32_bf16 v[132:135], a[140:143], v[72:75], v[132:135]
  v_cvt_pk_bf16_f32 v186, v220, v221
  v_add_f32 v226, v226, v222
  v_mfma_f32_16x16x32_bf16 v[140:143], a[140:143], v[76:79], v[140:143]
  s_waitcnt lgkmcnt(4)
  v_exp_f32 v218, v154
  v_mfma_f32_16x16x32_bf16 v[96:99], a[144:147], v[48:51], v[96:99]
  ds_read_b128 a[176:179], v3 offset:20480
  v_add_f32 v226, v226, v223
  v_mfma_f32_16x16x32_bf16 v[104:107], a[144:147], v[52:55], v[104:107]
  v_exp_f32 v219, v155
  v_mfma_f32_16x16x32_bf16 v[128:131], a[144:147], v[80:83], v[128:131]
  v_cvt_pk_bf16_f32 v187, v222, v223
  v_add_f32 v227, v216, v217
  v_mfma_f32_16x16x32_bf16 v[136:139], a[144:147], v[84:87], v[136:139]
  v_exp_f32 v220, v156
  v_mfma_f32_16x16x32_bf16 v[100:103], a[148:151], v[48:51], v[100:103]
  ds_read_b128 a[180:183], v3 offset:21504
  v_cvt_pk_bf16_f32 v188, v216, v217
  v_mfma_f32_16x16x32_bf16 v[108:111], a[148:151], v[52:55], v[108:111]
  v_exp_f32 v221, v157
  v_mfma_f32_16x16x32_bf16 v[132:135], a[148:151], v[80:83], v[132:135]
  buffer_load_dwordx4 v2, s[44:47], s26 offen offset:1024 sc1 lds
  v_add_f32 v227, v227, v218
  v_mfma_f32_16x16x32_bf16 v[140:143], a[148:151], v[84:87], v[140:143]
  v_exp_f32 v222, v158
  v_mfma_f32_16x16x32_bf16 v[96:99], a[152:155], v[56:59], v[96:99]
  ds_read_b128 a[184:187], v3 offset:22528
  v_add_f32 v227, v227, v219
  v_mfma_f32_16x16x32_bf16 v[104:107], a[152:155], v[60:63], v[104:107]
  v_exp_f32 v223, v159
  v_mfma_f32_16x16x32_bf16 v[128:131], a[152:155], v[88:91], v[128:131]
  v_cvt_pk_bf16_f32 v189, v218, v219
  v_add_f32 v227, v227, v220
  v_mfma_f32_16x16x32_bf16 v[136:139], a[152:155], v[92:95], v[136:139]
  v_exp_f32 v208, v112
  v_mfma_f32_16x16x32_bf16 v[100:103], a[156:159], v[56:59], v[100:103]
  ds_read_b128 a[188:191], v3 offset:23552
  v_add_f32 v227, v227, v221
  v_mfma_f32_16x16x32_bf16 v[108:111], a[156:159], v[60:63], v[108:111]
  v_exp_f32 v209, v113
  v_mfma_f32_16x16x32_bf16 v[132:135], a[156:159], v[88:91], v[132:135]
  v_cvt_pk_bf16_f32 v190, v220, v221
  v_add_f32 v227, v227, v222
  v_add_f32 v227, v227, v223
  v_mfma_f32_16x16x32_bf16 v[140:143], a[156:159], v[92:95], v[140:143]
  s_waitcnt lgkmcnt(4)
  v_exp_f32 v210, v114
  v_mfma_f32_16x16x32_bf16 a[0:3], a[160:163], v[160:163], a[0:3]
  ds_read_b128 a[128:131], v3 offset:0
  v_cvt_pk_bf16_f32 v191, v222, v223
  v_mfma_f32_16x16x32_bf16 a[4:7], a[160:163], v[164:167], a[4:7]
  v_exp_f32 v211, v115
  v_mfma_f32_16x16x32_bf16 a[64:67], a[160:163], v[176:179], a[64:67]
  v_exp_f32 v212, v116
  v_mfma_f32_16x16x32_bf16 a[68:71], a[160:163], v[180:183], a[68:71]
  v_add_f32 v224, v208, v209
  v_cvt_pk_bf16_f32 v168, v208, v209
  v_mfma_f32_16x16x32_bf16 a[8:11], a[164:167], v[160:163], a[8:11]
  ds_read_b128 a[132:135], v3 offset:1024
  v_add_f32 v224, v224, v210
  v_mfma_f32_16x16x32_bf16 a[12:15], a[164:167], v[164:167], a[12:15]
  v_exp_f32 v213, v117
  v_mfma_f32_16x16x32_bf16 a[72:75], a[164:167], v[176:179], a[72:75]
  buffer_load_dwordx4 v2, s[44:47], s26 offen offset:2048 sc1 lds
  v_add_f32 v224, v224, v211
  v_mfma_f32_16x16x32_bf16 a[76:79], a[164:167], v[180:183], a[76:79]
  v_exp_f32 v214, v118
  v_mfma_f32_16x16x32_bf16 a[16:19], a[168:171], v[160:163], a[16:19]
  ds_read_b128 a[136:139], v3 offset:2048
  v_cvt_pk_bf16_f32 v169, v210, v211
  v_mfma_f32_16x16x32_bf16 a[20:23], a[168:171], v[164:167], a[20:23]
  v_exp_f32 v215, v119
  v_mfma_f32_16x16x32_bf16 a[80:83], a[168:171], v[176:179], a[80:83]
  v_add_f32 v224, v224, v212
  v_add_f32 v224, v224, v213
  v_mfma_f32_16x16x32_bf16 a[84:87], a[168:171], v[180:183], a[84:87]
  v_exp_f32 v208, v120
  v_mfma_f32_16x16x32_bf16 a[24:27], a[172:175], v[160:163], a[24:27]
  ds_read_b128 a[140:143], v3 offset:3072
  v_cvt_pk_bf16_f32 v170, v212, v213
  v_mfma_f32_16x16x32_bf16 a[28:31], a[172:175], v[164:167], a[28:31]
  v_exp_f32 v209, v121
  v_mfma_f32_16x16x32_bf16 a[88:91], a[172:175], v[176:179], a[88:91]
  v_exp_f32 v210, v122
  v_mfma_f32_16x16x32_bf16 a[92:95], a[172:175], v[180:183], a[92:95]
  s_waitcnt lgkmcnt(4)
  v_add_f32 v224, v224, v214
  v_add_f32 v224, v224, v215
  v_mfma_f32_16x16x32_bf16 a[32:35], a[176:179], v[160:163], a[32:35]
  ds_read_b128 a[144:147], v3 offset:4096
  v_cvt_pk_bf16_f32 v171, v214, v215
  v_mfma_f32_16x16x32_bf16 a[36:39], a[176:179], v[164:167], a[36:39]
  v_exp_f32 v211, v123
  v_mfma_f32_16x16x32_bf16 a[96:99], a[176:179], v[176:179], a[96:99]
  v_add_f32 v225, v208, v209
  v_cvt_pk_bf16_f32 v172, v208, v209
  v_mfma_f32_16x16x32_bf16 a[100:103], a[176:179], v[180:183], a[100:103]
  v_exp_f32 v212, v124
  v_mfma_f32_16x16x32_bf16 a[40:43], a[180:183], v[160:163], a[40:43]
  ds_read_b128 a[148:151], v3 offset:5120
  v_add_f32 v225, v225, v210
  v_mfma_f32_16x16x32_bf16 a[44:47], a[180:183], v[164:167], a[44:47]
  v_exp_f32 v213, v125
  v_mfma_f32_16x16x32_bf16 a[104:107], a[180:183], v[176:179], a[104:107]
  buffer_load_dwordx4 v2, s[44:47], s26 offen offset:3072 sc1 lds
  v_add_f32 v225, v225, v211
  v_mfma_f32_16x16x32_bf16 a[108:111], a[180:183], v[180:183], a[108:111]
  s_add_u32 s26, s26, 16384
  v_exp_f32 v214, v126
  v_mfma_f32_16x16x32_bf16 a[48:51], a[184:187], v[160:163], a[48:51]
  s_add_u32 s24, s24, 32768
  ds_read_b128 a[152:155], v3 offset:6144
  v_cvt_pk_bf16_f32 v173, v210, v211
  v_mfma_f32_16x16x32_bf16 a[52:55], a[184:187], v[164:167], a[52:55]
  s_and_b32 s24, s24, 0x1ffff
  v_exp_f32 v215, v127
  v_mfma_f32_16x16x32_bf16 a[112:115], a[184:187], v[176:179], a[112:115]
  v_max3_f32 v5, v226, v227, v224
  v_add_f32 v225, v225, v212
  v_mfma_f32_16x16x32_bf16 a[116:119], a[184:187], v[180:183], a[116:119]
  v_add_f32 v225, v225, v213
  v_cvt_pk_bf16_f32 v174, v212, v213
  v_add_f32 v225, v225, v214
  v_mfma_f32_16x16x32_bf16 a[56:59], a[188:191], v[160:163], a[56:59]
  ds_read_b128 a[156:159], v3 offset:7168
  v_add_f32 v225, v225, v215
  v_max_f32 v5, v5, v225
  v_cmp_lt_f32 vcc, s81, v5
  v_mfma_f32_16x16x32_bf16 a[60:63], a[188:191], v[164:167], a[60:63]
  v_exp_f32 v216, v128
  v_mfma_f32_16x16x32_bf16 a[120:123], a[188:191], v[176:179], a[120:123]
  s_waitcnt lgkmcnt(4)
  v_cvt_pk_bf16_f32 v175, v214, v215
  v_mfma_f32_16x16x32_bf16 a[124:127], a[188:191], v[180:183], a[124:127]
  s_cbranch_vccnz fa_stub4
fa_back4:
  v_exp_f32 v217, v129
  v_add_f32 v228, v228, v224
  v_add_f32 v229, v229, v225
  v_add_f32 v230, v230, v226
  v_add_f32 v231, v231, v227
  v_mfma_f32_16x16x32_bf16 v[144:147], a[128:131], v[64:67], v[200:203]
  ds_read_b128 a[160:163], v3 offset:24576
  v_exp_f32 v218, v130
  v_mfma_f32_16x16x32_bf16 v[152:155], a[128:131], v[68:71], v[204:207]
  v_exp_f32 v219, v131
  v_add_f32 v226, v216, v217
  v_mfma_f32_16x16x32_bf16 v[148:151], a[132:135], v[64:67], v[200:203]
  s_add_u32 s66, s66, 32768
  ds_read_b128 a[164:167], v3 offset:25600
  v_exp_f32 v220, v132
  v_mfma_f32_16x16x32_bf16 v[156:159], a[132:135], v[68:71], v[204:207]
  s_and_b32 s66, s66, 0x1ffff
  v_exp_f32 v221, v133
  v_cvt_pk_bf16_f32 v176, v216, v217
  v_mfma_f32_16x16x32_bf16 v[144:147], a[136:139], v[72:75], v[144:147]
  ds_read_b128 a[168:171], v3 offset:26624
  v_add_f32 v226, v226, v218
  v_add_f32 v226, v226, v219
  v_mfma_f32_16x16x32_bf16 v[152:155], a[136:139], v[76:79], v[152:155]
  s_mov_b32 m0, s25
  v_exp_f32 v222, v134
  v_cvt_pk_bf16_f32 v177, v218, v219
  v_mfma_f32_16x16x32_bf16 v[148:151], a[140:143], v[72:75], v[148:151]
  ds_read_b128 a[172:175], v3 offset:27648
  buffer_load_dwordx4 v2, s[48:51], s27 offen offset:0 sc1 lds
  v_add_f32 v226, v226, v220
  v_add_f32 v226, v226, v221
  v_mfma_f32_16x16x32_bf16 v[156:159], a[140:143], v[76:79], v[156:159]
  s_waitcnt lgkmcnt(4)
  v_exp_f32 v223, v135
  v_cvt_pk_bf16_f32 v178, v220, v221
  v_mfma_f32_16x16x32_bf16 v[144:147], a[144:147], v[80:83], v[144:147]
  ds_read_b128 a[176:179], v3 offset:28672
  v_cndmask_b32 v96, v4, v96, s[68:69]
  v_cndmask_b32 v97, v4, v97, s[70:71]
  v_mfma_f32_16x16x32_bf16 v[152:155], a[144:147], v[84:87], v[152:155]
  v_exp_f32 v216, v136
  v_cndmask_b32 v98, v4, v98, s[72:73]
  v_mfma_f32_16x16x32_bf16 v[148:151], a[148:151], v[80:83], v[148:151]
  ds_read_b128 a[180:183], v3 offset:29696
  v_cndmask_b32 v99, v4, v99, s[74:75]
  v_mov_b32 v100, v4
  v_mfma_f32_16x16x32_bf16 v[156:159], a[148:151], v[84:87], v[156:159]
  v_exp_f32 v217, v137
  v_mov_b32 v101, v4
  v_mfma_f32_16x16x32_bf16 v[144:147], a[152:155], v[88:91], v[144:147]
  ds_read_b128 a[184:187], v3 offset:30720
  v_mov_b32 v102, v4
  v_mov_b32 v103, v4
  v_mfma_f32_16x16x32_bf16 v[152:155], a[152:155], v[92:95], v[152:155]
  v_exp_f32 v218, v138
  v_cndmask_b32 v108, v4, v108, s[68:69]
  v_mfma_f32_16x16x32_bf16 v[148:151], a[156:159], v[88:91], v[148:151]
  ds_read_b128 a[188:191], v3 offset:31744
  v_cndmask_b32 v109, v4, v109, s[70:71]
  v_cndmask_b32 v110, v4, v110, s[72:73]
  v_mfma_f32_16x16x32_bf16 v[156:159], a[156:159], v[92:95], v[156:159]
  s_waitcnt lgkmcnt(4)
  v_exp_f32 v219, v139
  v_cndmask_b32 v111, v4, v111, s[74:75]
  v_mfma_f32_16x16x32_bf16 a[0:3], a[160:163], v[168:171], a[0:3]
  ds_read_b128 a[128:131], v3 offset:8192
  v_add_f32 v226, v226, v222
  v_add_f32 v226, v226, v223
  v_mfma_f32_16x16x32_bf16 a[4:7], a[160:163], v[172:175], a[4:7]
  v_exp_f32 v220, v140
  v_cvt_pk_bf16_f32 v179, v222, v223
  v_mfma_f32_16x16x32_bf16 a[64:67], a[160:163], v[184:187], a[64:67]
  buffer_load_dwordx4 v2, s[48:51], s27 offen offset:1024 sc1 lds
  v_add_f32 v227, v216, v217
  v_cvt_pk_bf16_f32 v180, v216, v217
  v_mfma_f32_16x16x32_bf16 a[68:71], a[160:163], v[188:191], a[68:71]
  v_exp_f32 v221, v141
  v_add_f32 v227, v227, v218
  v_mfma_f32_16x16x32_bf16 a[8:11], a[164:167], v[168:171], a[8:11]
  ds_read_b128 a[132:135], v3 offset:9216
  v_exp_f32 v222, v142
  v_mfma_f32_16x16x32_bf16 a[12:15], a[164:167], v[172:175], a[12:15]
  v_exp_f32 v223, v143
  v_mfma_f32_16x16x32_bf16 a[72:75], a[164:167], v[184:187], a[72:75]
  v_exp_f32 v208, v96
  v_mfma_f32_16x16x32_bf16 a[76:79], a[164:167], v[188:191], a[76:79]
  v_exp_f32 v209, v97
  v_mfma_f32_16x16x32_bf16 a[16:19], a[168:171], v[168:171], a[16:19]
  ds_read_b128 a[136:139], v3 offset:10240
  v_add_f32 v227, v227, v219
  v_cvt_pk_bf16_f32 v181, v218, v219
  v_add_f32 v227, v227, v220
  v_add_f32 v227, v227, v221
  v_cvt_pk_bf16_f32 v182, v220, v221
  v_mfma_f32_16x16x32_bf16 a[20:23], a[168:171], v[172:175], a[20:23]
  v_exp_f32 v210, v98
  v_mfma_f32_16x16x32_bf16 a[80:83], a[168:171], v[184:187], a[80:83]
  v_exp_f32 v211, v99
  v_mfma_f32_16x16x32_bf16 a[84:87], a[168:171], v[188:191], a[84:87]
  v_exp_f32 v212, v100
  v_mfma_f32_16x16x32_bf16 a[24:27], a[172:175], v[168:171], a[24:27]
  ds_read_b128 a[140:143], v3 offset:11264
  v_add_f32 v227, v227, v222
  v_add_f32 v227, v227, v223
  v_cvt_pk_bf16_f32 v183, v222, v223
  v_add_f32 v224, v208, v209
  v_cvt_pk_bf16_f32 v160, v208, v209
  v_mfma_f32_16x16x32_bf16 a[28:31], a[172:175], v[172:175], a[28:31]
  v_exp_f32 v213, v101
  v_mfma_f32_16x16x32_bf16 a[88:91], a[172:175], v[184:187], a[88:91]
  buffer_load_dwordx4 v2, s[48:51], s27 offen offset:2048 sc1 lds
  v_add_f32 v224, v224, v210
  v_add_f32 v224, v224, v211
  v_cvt_pk_bf16_f32 v161, v210, v211
  v_mfma_f32_16x16x32_bf16 a[92:95], a[172:175], v[188:191], a[92:95]
  s_waitcnt lgkmcnt(4)
  v_exp_f32 v214, v102
  v_mfma_f32_16x16x32_bf16 a[32:35], a[176:179], v[168:171], a[32:35]
  ds_read_b128 a[144:147], v3 offset:12288
  v_exp_f32 v215, v103
  v_mfma_f32_16x16x32_bf16 a[36:39], a[176:179], v[172:175], a[36:39]
  v_exp_f32 v208, v104
  v_mfma_f32_16x16x32_bf16 a[96:99], a[176:179], v[184:187], a[96:99]
  v_exp_f32 v209, v105
  v_mfma_f32_16x16x32_bf16 a[100:103], a[176:179], v[188:191], a[100:103]
  v_exp_f32 v210, v106
  v_mfma_f32_16x16x32_bf16 a[40:43], a[180:183], v[168:171], a[40:43]
  ds_read_b128 a[148:151], v3 offset:13312
  v_add_f32 v224, v224, v212
  v_add_f32 v224, v224, v213
  v_cvt_pk_bf16_f32 v162, v212, v213
  v_add_f32 v224, v224, v214
  v_add_f32 v224, v224, v215
  v_cvt_pk_bf16_f32 v163, v214, v215
  v_mfma_f32_16x16x32_bf16 a[44:47], a[180:183], v[172:175], a[44:47]
  v_exp_f32 v211, v107
  v_mfma_f32_16x16x32_bf16 a[104:107], a[180:183], v[184:187], a[104:107]
  v_exp_f32 v212, v108
  v_mfma_f32_16x16x32_bf16 a[108:111], a[180:183], v[188:191], a[108:111]
  v_exp_f32 v213, v109
  v_mfma_f32_16x16x32_bf16 a[48:51], a[184:187], v[168:171], a[48:51]
  ds_read_b128 a[152:155], v3 offset:14336
  v_add_f32 v225, v208, v209
  v_cvt_pk_bf16_f32 v164, v208, v209
  v_add_f32 v225, v225, v210
  v_add_f32 v225, v225, v211
  v_cvt_pk_bf16_f32 v165, v210, v211
  v_mfma_f32_16x16x32_bf16 a[52:55], a[184:187], v[172:175], a[52:55]
  v_exp_f32 v214, v110
  v_mfma_f32_16x16x32_bf16 a[112:115], a[184:187], v[184:187], a[112:115]
  buffer_load_dwordx4 v2, s[48:51], s27 offen offset:3072 sc1 lds
  v_max3_f32 v5, v226, v227, v224
  v_add_f32 v225, v225, v212
  v_add_f32 v225, v225, v213
  v_mfma_f32_16x16x32_bf16 a[116:119], a[184:187], v[188:191], a[116:119]
  s_add_u32 s27, s27, 16384
  v_exp_f32 v215, v111
  v_mfma_f32_16x16x32_bf16 a[56:59], a[188:191], v[168:171], a[56:59]
  s_add_u32 s25, s25, 32768
  ds_read_b128 a[156:159], v3 offset:15360
  v_cvt_pk_bf16_f32 v166, v212, v213
  v_add_f32 v225, v225, v214
  v_add_f32 v225, v225, v215
  v_max_f32 v5, v5, v225
  v_cmp_lt_f32 vcc, s81, v5
  v_mfma_f32_16x16x32_bf16 a[60:63], a[188:191], v[172:175], a[60:63]
  s_and_b32 s25, s25, 0x1ffff
  v_exp_f32 v216, v144
  v_mfma_f32_16x16x32_bf16 a[120:123], a[188:191], v[184:187], a[120:123]
  s_waitcnt lgkmcnt(4)
  v_cvt_pk_bf16_f32 v167, v214, v215
  v_add_u32 v3, s66, v2
  v_mfma_f32_16x16x32_bf16 a[124:127], a[188:191], v[188:191], a[124:127]
  s_cbranch_vccnz fa_stub5
fa_back5:
  v_exp_f32 v217, v145
  v_add_f32 v228, v228, v224
  v_add_f32 v229, v229, v225
  v_add_f32 v230, v230, v226
  v_add_f32 v231, v231, v227
fa_AV:
  v_mfma_f32_16x16x32_bf16 v[128:131], a[128:131], v[64:67], v[200:203]
  s_waitcnt vmcnt(12)
  v_exp_f32 v218, v146
  v_mfma_f32_16x16x32_bf16 v[136:139], a[128:131], v[68:71], v[204:207]
  s_barrier
  v_exp_f32 v219, v147
  v_mfma_f32_16x16x32_bf16 v[132:135], a[132:135], v[64:67], v[200:203]
  ds_read_b128 a[160:163], v3 offset:16384
  ds_read_b128 a[164:167], v3 offset:17408
  v_add_f32 v226, v216, v217
  v_mfma_f32_16x16x32_bf16 v[140:143], a[132:135], v[68:71], v[204:207]
  v_exp_f32 v220, v148
  v_mfma_f32_16x16x32_bf16 v[128:131], a[136:139], v[72:75], v[128:131]
  ds_read_b128 a[168:171], v3 offset:18432
  v_cvt_pk_bf16_f32 v184, v216, v217
  v_mfma_f32_16x16x32_bf16 v[136:139], a[136:139], v[76:79], v[136:139]
  s_mov_b32 m0, s24
  v_exp_f32 v221, v149
  v_mfma_f32_16x16x32_bf16 v[132:135], a[140:143], v[72:75], v[132:135]
  ds_read_b128 a[172:175], v3 offset:19456
  buffer_load_dwordx4 v2, s[44:47], s26 offen offset:0 sc1 lds
  v_add_f32 v226, v226, v218
  v_mfma_f32_16x16x32_bf16 v[140:143], a[140:143], v[76:79], v[140:143]
  s_waitcnt lgkmcnt(4)
  v_exp_f32 v222, v150
  v_mfma_f32_16x16x32_bf16 v[128:131], a[144:147], v[80:83], v[128:131]
  ds_read_b128 a[176:179], v3 offset:20480
  v_add_f32 v226, v226, v219
  v_mfma_f32_16x16x32_bf16 v[136:139], a[144:147], v[84:87], v[136:139]
  v_exp_f32 v223, v151
  v_mfma_f32_16x16x32_bf16 v[132:135], a[148:151], v[80:83], v[132:135]
  ds_read_b128 a[180:183], v3 offset:21504
  v_cvt_pk_bf16_f32 v185, v218, v219
  v_mfma_f32_16x16x32_bf16 v[140:143], a[148:151], v[84:87], v[140:143]
  v_add_f32 v226, v226, v220
  v_add_f32 v226, v226, v221
  v_mfma_f32_16x16x32_bf16 v[128:131], a[152:155], v[88:91], v[128:131]
  ds_read_b128 a[184:187], v3 offset:22528
  v_cvt_pk_bf16_f32 v186, v220, v221
  v_mfma_f32_16x16x32_bf16 v[136:139], a[152:155], v[92:95], v[136:139]
  v_exp_f32 v216, v152
  v_mfma_f32_16x16x32_bf16 v[132:135], a[156:159], v[88:91], v[132:135]
  ds_read_b128 a[188:191], v3 offset:23552
  v_add_f32 v226, v226, v222
  v_mfma_f32_16x16x32_bf16 v[140:143], a[156:159], v[92:95], v[140:143]
  s_waitcnt lgkmcnt(4)
  v_exp_f32 v217, v153
  v_mfma_f32_16x16x32_bf16 a[0:3], a[160:163], v[160:163], a[0:3]
  ds_read_b128 a[128:131], v3 offset:0
  v_add_f32 v226, v226, v223
  v_mfma_f32_16x16x32_bf16 a[4:7], a[160:163], v[164:167], a[4:7]
  v_exp_f32 v218, v154
  v_mfma_f32_16x16x32_bf16 a[64:67], a[160:163], v[176:179], a[64:67]
  buffer_load_dwordx4 v2, s[44:47], s26 offen offset:1024 sc1 lds
  v_cvt_pk_bf16_f32 v187, v222, v223
  v_mfma_f32_16x16x32_bf16 a[68:71], a[160:163], v[180:183], a[68:71]
  v_exp_f32 v219, v155
  v_mfma_f32_16x16x32_bf16 a[8:11], a[164:167], v[160:163], a[8:11]
  ds_read_b128 a[132:135], v3 offset:1024
  v_add_f32 v227, v216, v217
  v_mfma_f32_16x16x32_bf16 a[12:15], a[164:167], v[164:167], a[12:15]
  v_exp_f32 v220, v156
  v_mfma_f32_16x16x32_bf16 a[72:75], a[164:167], v[176:179], a[72:75]
  v_exp_f32 v221, v157
  v_mfma_f32_16x16x32_bf16 a[76:79], a[164:167], v[180:183], a[76:79]
  v_cvt_pk_bf16_f32 v188, v216, v217
  v_add_f32 v227, v227, v218
  v_mfma_f32_16x16x32_bf16 a[16:19], a[168:171], v[160:163], a[16:19]
  ds_read_b128 a[136:139], v3 offset:2048
  v_add_f32 v227, v227, v219
  v_mfma_f32_16x16x32_bf16 a[20:23], a[168:171], v[164:167], a[20:23]
  v_exp_f32 v222, v158
  v_mfma_f32_16x16x32_bf16 a[80:83], a[168:171], v[176:179], a[80:83]
  v_exp_f32 v223, v159
  v_mfma_f32_16x16x32_bf16 a[84:87], a[168:171], v[180:183], a[84:87]
  v_cvt_pk_bf16_f32 v189, v218, v219
  v_add_f32 v227, v227, v220
  v_mfma_f32_16x16x32_bf16 a[24:27], a[172:175], v[160:163], a[24:27]
  ds_read_b128 a[140:143], v3 offset:3072
  v_add_f32 v227, v227, v221
  v_mfma_f32_16x16x32_bf16 a[28:31], a[172:175], v[164:167], a[28:31]
  v_cvt_pk_bf16_f32 v190, v220, v221
  v_add_f32 v227, v227, v222
  v_mfma_f32_16x16x32_bf16 a[88:91], a[172:175], v[176:179], a[88:91]
  buffer_load_dwordx4 v2, s[44:47], s26 offen offset:2048 sc1 lds
  v_add_f32 v227, v227, v223
  v_mfma_f32_16x16x32_bf16 a[92:95], a[172:175], v[180:183], a[92:95]
  s_waitcnt lgkmcnt(4)
  v_max_f32 v5, v226, v227
  v_cmp_lt_f32 vcc, s81, v5
  v_mfma_f32_16x16x32_bf16 a[32:35], a[176:179], v[160:163], a[32:35]
  ds_read_b128 a[144:147], v3 offset:4096
  v_mfma_f32_16x16x32_bf16 a[36:39], a[176:179], v[164:167], a[36:39]
  v_mfma_f32_16x16x32_bf16 a[96:99], a[176:179], v[176:179], a[96:99]
  v_mfma_f32_16x16x32_bf16 a[100:103], a[176:179], v[180:183], a[100:103]
  v_mfma_f32_16x16x32_bf16 a[40:43], a[180:183], v[160:163], a[40:43]
  ds_read_b128 a[148:151], v3 offset:5120
  v_mfma_f32_16x16x32_bf16 a[44:47], a[180:183], v[164:167], a[44:47]
  v_mfma_f32_16x16x32_bf16 a[104:107], a[180:183], v[176:179], a[104:107]
  v_mfma_f32_16x16x32_bf16 a[108:111], a[180:183], v[180:183], a[108:111]
  v_mfma_f32_16x16x32_bf16 a[48:51], a[184:187], v[160:163], a[48:51]
  ds_read_b128 a[152:155], v3 offset:6144
  v_mfma_f32_16x16x32_bf16 a[52:55], a[184:187], v[164:167], a[52:55]
  v_mfma_f32_16x16x32_bf16 a[112:115], a[184:187], v[176:179], a[112:115]
  buffer_load_dwordx4 v2, s[44:47], s26 offen offset:3072 sc1 lds
  v_mfma_f32_16x16x32_bf16 a[116:119], a[184:187], v[180:183], a[116:119]
  s_add_u32 s26, s26, 16384
  v_mfma_f32_16x16x32_bf16 a[56:59], a[188:191], v[160:163], a[56:59]
  s_add_u32 s24, s24, 32768
  ds_read_b128 a[156:159], v3 offset:7168
  v_mfma_f32_16x16x32_bf16 a[60:63], a[188:191], v[164:167], a[60:63]
  s_and_b32 s24, s24, 0x1ffff
  v_exp_f32 v216, v128
  v_mfma_f32_16x16x32_bf16 a[120:123], a[188:191], v[176:179], a[120:123]
  s_waitcnt lgkmcnt(4)
  v_cvt_pk_bf16_f32 v191, v222, v223
  v_mfma_f32_16x16x32_bf16 a[124:127], a[188:191], v[180:183], a[124:127]
  s_cbranch_vccnz fa_stub6
fa_back6:
  v_exp_f32 v217, v129
  v_add_f32 v230, v230, v226
  v_add_f32 v231, v231, v227
  v_mfma_f32_16x16x32_bf16 v[144:147], a[128:131], v[64:67], v[200:203]
  ds_read_b128 a[160:163], v3 offset:24576
  v_add_f32 v226, v216, v217
  v_mfma_f32_16x16x32_bf16 v[152:155], a[128:131], v[68:71], v[204:207]
  v_exp_f32 v218, v130
  v_mfma_f32_16x16x32_bf16 v[148:151], a[132:135], v[64:67], v[200:203]
  s_add_u32 s66, s66, 32768
  ds_read_b128 a[164:167], v3 offset:25600
  v_cvt_pk_bf16_f32 v176, v216, v217
  v_mfma_f32_16x16x32_bf16 v[156:159], a[132:135], v[68:71], v[204:207]
  s_mov_b32 m0, s25
  v_exp_f32 v219, v131
  v_mfma_f32_16x16x32_bf16 v[144:147], a[136:139], v[72:75], v[144:147]
  s_and_b32 s66, s66, 0x1ffff
  ds_read_b128 a[168:171], v3 offset:26624
  buffer_load_dwordx4 v2, s[48:51], s27 offen offset:0 sc1 lds
  v_add_f32 v226, v226, v218
  v_add_f32 v226, v226, v219
  v_mfma_f32_16x16x32_bf16 v[152:155], a[136:139], v[76:79], v[152:155]
  v_exp_f32 v220, v132
  v_mfma_f32_16x16x32_bf16 v[148:151], a[140:143], v[72:75], v[148:151]
  ds_read_b128 a[172:175], v3 offset:27648
  v_cvt_pk_bf16_f32 v177, v218, v219
  v_mfma_f32_16x16x32_bf16 v[156:159], a[140:143], v[76:79], v[156:159]
  s_waitcnt lgkmcnt(4)
  v_exp_f32 v221, v133
  v_mfma_f32_16x16x32_bf16 v[144:147], a[144:147], v[80:83], v[144:147]
  ds_read_b128 a[176:179], v3 offset:28672
  v_add_f32 v226, v226, v220
  v_mfma_f32_16x16x32_bf16 v[152:155], a[144:147], v[84:87], v[152:155]
  v_exp_f32 v222, v134
  v_mfma_f32_16x16x32_bf16 v[148:151], a[148:151], v[80:83], v[148:151]
  ds_read_b128 a[180:183], v3 offset:29696
  buffer_load_dwordx4 v2, s[48:51], s27 offen offset:1024 sc1 lds
  v_add_f32 v226, v226, v221
  v_cvt_pk_bf16_f32 v178, v220, v221
  v_mfma_f32_16x16x32_bf16 v[156:159], a[148:151], v[84:87], v[156:159]
  v_exp_f32 v223, v135
  v_mfma_f32_16x16x32_bf16 v[144:147], a[152:155], v[88:91], v[144:147]
  ds_read_b128 a[184:187], v3 offset:30720
  v_add_f32 v226, v226, v222
  v_mfma_f32_16x16x32_bf16 v[152:155], a[152:155], v[92:95], v[152:155]
  v_exp_f32 v216, v136
  v_mfma_f32_16x16x32_bf16 v[148:151], a[156:159], v[88:91], v[148:151]
  ds_read_b128 a[188:191], v3 offset:31744
  v_add_f32 v226, v226, v223
  v_exp_f32 v217, v137
  v_mfma_f32_16x16x32_bf16 v[156:159], a[156:159], v[92:95], v[156:159]
  s_waitcnt lgkmcnt(4)
  v_exp_f32 v218, v138
  v_mfma_f32_16x16x32_bf16 a[64:67], a[160:163], v[184:187], a[64:67]
  ds_read_b128 a[128:131], v3 offset:8192
  v_cvt_pk_bf16_f32 v179, v222, v223
  v_mfma_f32_16x16x32_bf16 a[68:71], a[160:163], v[188:191], a[68:71]
  v_exp_f32 v219, v139
  v_mfma_f32_16x16x32_bf16 a[72:75], a[164:167], v[184:187], a[72:75]
  ds_read_b128 a[132:135], v3 offset:9216
  buffer_load_dwordx4 v2, s[48:51], s27 offen offset:2048 sc1 lds
  v_add_f32 v227, v216, v217
  v_mfma_f32_16x16x32_bf16 a[76:79], a[164:167], v[188:191], a[76:79]
  v_exp_f32 v220, v140
  v_mfma_f32_16x16x32_bf16 a[80:83], a[168:171], v[184:187], a[80:83]
  ds_read_b128 a[136:139], v3 offset:10240
  v_cvt_pk_bf16_f32 v180, v216, v217
  v_mfma_f32_16x16x32_bf16 a[84:87], a[168:171], v[188:191], a[84:87]
  v_exp_f32 v221, v141
  v_mfma_f32_16x16x32_bf16 a[88:91], a[172:175], v[184:187], a[88:91]
  ds_read_b128 a[140:143], v3 offset:11264
  v_add_f32 v227, v227, v218
  v_mfma_f32_16x16x32_bf16 a[92:95], a[172:175], v[188:191], a[92:95]
  s_waitcnt lgkmcnt(4)
  v_exp_f32 v222, v142
  v_mfma_f32_16x16x32_bf16 a[96:99], a[176:179], v[184:187], a[96:99]
  ds_read_b128 a[144:147], v3 offset:12288
  buffer_load_dwordx4 v2, s[48:51], s27 offen offset:3072 sc1 lds
  v_add_f32 v227, v227, v219
  v_cvt_pk_bf16_f32 v181, v218, v219
  v_mfma_f32_16x16x32_bf16 a[100:103], a[176:179], v[188:191], a[100:103]
  s_add_u32 s27, s27, 16384
  v_exp_f32 v223, v143
  v_mfma_f32_16x16x32_bf16 a[104:107], a[180:183], v[184:187], a[104:107]
  s_add_u32 s25, s25, 32768
  ds_read_b128 a[148:151], v3 offset:13312
  v_add_f32 v227, v227, v220
  v_mfma_f32_16x16x32_bf16 a[108:111], a[180:183], v[188:191], a[108:111]
  s_and_b32 s25, s25, 0x1ffff
  v_add_f32 v227, v227, v221
  v_cvt_pk_bf16_f32 v182, v220, v221
  v_add_f32 v227, v227, v222
  v_mfma_f32_16x16x32_bf16 a[112:115], a[184:187], v[184:187], a[112:115]
  ds_read_b128 a[152:155], v3 offset:14336
  v_add_f32 v227, v227, v223
  v_max_f32 v5, v226, v227
  v_cmp_lt_f32 vcc, s81, v5
  v_mfma_f32_16x16x32_bf16 a[116:119], a[184:187], v[188:191], a[116:119]
  v_exp_f32 v216, v144
  v_mfma_f32_16x16x32_bf16 a[120:123], a[188:191], v[184:187], a[120:123]
  s_waitcnt lgkmcnt(3)
  ds_read_b128 a[156:159], v3 offset:15360
  v_cvt_pk_bf16_f32 v183, v222, v223
  v_add_u32 v3, s66, v2
  v_mfma_f32_16x16x32_bf16 a[124:127], a[188:191], v[188:191], a[124:127]
  s_cbranch_vccnz fa_stub7
fa_back7:
  v_exp_f32 v217, v145
  v_add_f32 v230, v230, v226
  v_add_f32 v231, v231, v227
  s_branch fa_SSpre
fa_Aodd:
  v_mfma_f32_16x16x32_bf16 v[128:131], a[128:131], v[64:67], v[200:203]
  s_waitcnt vmcnt(12)
  v_exp_f32 v218, v146
  v_add_f32 v226, v216, v217
  v_mfma_f32_16x16x32_bf16 v[136:139], a[128:131], v[68:71], v[204:207]
  s_barrier
  v_exp_f32 v219, v147
  v_cvt_pk_bf16_f32 v184, v216, v217
  v_mfma_f32_16x16x32_bf16 v[132:135], a[132:135], v[64:67], v[200:203]
  ds_read_b128 a[160:163], v3 offset:16384
  ds_read_b128 a[164:167], v3 offset:17408
  v_exp_f32 v220, v148
  v_mfma_f32_16x16x32_bf16 v[140:143], a[132:135], v[68:71], v[204:207]
  v_exp_f32 v221, v149
  v_add_f32 v226, v226, v218
  v_mfma_f32_16x16x32_bf16 v[128:131], a[136:139], v[72:75], v[128:131]
  ds_read_b128 a[168:171], v3 offset:18432
  v_add_f32 v226, v226, v219
  v_cvt_pk_bf16_f32 v185, v218, v219
  v_mfma_f32_16x16x32_bf16 v[136:139], a[136:139], v[76:79], v[136:139]
  s_mov_b32 m0, s24
  v_exp_f32 v222, v150
  v_add_f32 v226, v226, v220
  v_mfma_f32_16x16x32_bf16 v[132:135], a[140:143], v[72:75], v[132:135]
  ds_read_b128 a[172:175], v3 offset:19456
  buffer_load_dwordx4 v2, s[44:47], s26 offen offset:0 sc1 lds
  v_add_f32 v226, v226, v221
  v_cvt_pk_bf16_f32 v186, v220, v221
  v_mfma_f32_16x16x32_bf16 v[140:143], a[140:143], v[76:79], v[140:143]
  s_waitcnt lgkmcnt(4)
  v_exp_f32 v223, v151
  v_cndmask_b32 v112, v4, v112, s[68:69]
  v_mfma_f32_16x16x32_bf16 v[128:131], a[144:147], v[80:83], v[128:131]
  ds_read_b128 a[176:179], v3 offset:20480
  v_cndmask_b32 v113, v4, v113, s[70:71]
  v_cndmask_b32 v114, v4, v114, s[72:73]
  v_mfma_f32_16x16x32_bf16 v[136:139], a[144:147], v[84:87], v[136:139]
  v_exp_f32 v216, v152
  v_cndmask_b32 v115, v4, v115, s[74:75]
  v_mfma_f32_16x16x32_bf16 v[132:135], a[148:151], v[80:83], v[132:135]
  ds_read_b128 a[180:183], v3 offset:21504
  v_mov_b32 v116, v4
  v_mov_b32 v117, v4
  v_mfma_f32_16x16x32_bf16 v[140:143], a[148:151], v[84:87], v[140:143]
  v_exp_f32 v217, v153
  v_mov_b32 v118, v4
  v_mfma_f32_16x16x32_bf16 v[128:131], a[152:155], v[88:91], v[128:131]
  ds_read_b128 a[184:187], v3 offset:22528
  v_mov_b32 v119, v4
  v_cndmask_b32 v124, v4, v124, s[68:69]
  v_mfma_f32_16x16x32_bf16 v[136:139], a[152:155], v[92:95], v[136:139]
  v_exp_f32 v218, v154
  v_cndmask_b32 v125, v4, v125, s[70:71]
  v_mfma_f32_16x16x32_bf16 v[132:135], a[156:159], v[88:91], v[132:135]
  ds_read_b128 a[188:191], v3 offset:23552
  v_cndmask_b32 v126, v4, v126, s[72:73]
  v_cndmask_b32 v127, v4, v127, s[74:75]
  v_mfma_f32_16x16x32_bf16 v[140:143], a[156:159], v[92:95], v[140:143]
  s_waitcnt lgkmcnt(4)
  v_exp_f32 v219, v155
  v_add_f32 v226, v226, v222
  v_mfma_f32_16x16x32_bf16 a[0:3], a[160:163], v[160:163], a[0:3]
  ds_read_b128 a[128:131], v3 offset:0
  v_add_f32 v226, v226, v223
  v_cvt_pk_bf16_f32 v187, v222, v223
  v_mfma_f32_16x16x32_bf16 a[4:7], a[160:163], v[164:167], a[4:7]
  v_exp_f32 v220, v156
  v_add_f32 v227, v216, v217
  v_mfma_f32_16x16x32_bf16 a[64:67], a[160:163], v[176:179], a[64:67]
  buffer_load_dwordx4 v2, s[44:47], s26 offen offset:1024 sc1 lds
  v_exp_f32 v221, v157
  v_mfma_f32_16x16x32_bf16 a[68:71], a[160:163], v[180:183], a[68:71]
  v_exp_f32 v222, v158
  v_mfma_f32_16x16x32_bf16 a[8:11], a[164:167], v[160:163], a[8:11]
  ds_read_b128 a[132:135], v3 offset:1024
  v_cvt_pk_bf16_f32 v188, v216, v217
  v_add_f32 v227, v227, v218
  v_add_f32 v227, v227, v219
  v_mfma_f32_16x16x32_bf16 a[12:15], a[164:167], v[164:167], a[12:15]
  v_exp_f32 v223, v159
  v_mfma_f32_16x16x32_bf16 a[72:75], a[164:167], v[176:179], a[72:75]
  v_exp_f32 v208, v112
  v_mfma_f32_16x16x32_bf16 a[76:79], a[164:167], v[180:183], a[76:79]
  v_exp_f32 v209, v113
  v_mfma_f32_16x16x32_bf16 a[16:19], a[168:171], v[160:163], a[16:19]
  ds_read_b128 a[136:139], v3 offset:2048
  v_cvt_pk_bf16_f32 v189, v218, v219
  v_add_f32 v227, v227, v220
  v_add_f32 v227, v227, v221
  v_cvt_pk_bf16_f32 v190, v220, v221
  v_add_f32 v227, v227, v222
  v_mfma_f32_16x16x32_bf16 a[20:23], a[168:171], v[164:167], a[20:23]
  v_exp_f32 v210, v114
  v_mfma_f32_16x16x32_bf16 a[80:83], a[168:171], v[176:179], a[80:83]
  v_exp_f32 v211, v115
  v_mfma_f32_16x16x32_bf16 a[84:87], a[168:171], v[180:183], a[84:87]
  v_exp_f32 v212, v116
  v_mfma_f32_16x16x32_bf16 a[24:27], a[172:175], v[160:163], a[24:27]
  ds_read_b128 a[140:143], v3 offset:3072
  v_add_f32 v227, v227, v223
  v_cvt_pk_bf16_f32 v191, v222, v223
  v_add_f32 v224, v208, v209
  v_cvt_pk_bf16_f32 v168, v208, v209
  v_add_f32 v224, v224, v210
  v_mfma_f32_16x16x32_bf16 a[28:31], a[172:175], v[164:167], a[28:31]
  v_exp_f32 v213, v117
  v_mfma_f32_16x16x32_bf16 a[88:91], a[172:175], v[176:179], a[88:91]
  buffer_load_dwordx4 v2, s[44:47], s26 offen offset:2048 sc1 lds
  v_exp_f32 v214, v118
  v_mfma_f32_16x16x32_bf16 a[92:95], a[172:175], v[180:183], a[92:95]
  s_waitcnt lgkmcnt(4)
  v_exp_f32 v215, v119
  v_mfma_f32_16x16x32_bf16 a[32:35], a[176:179], v[160:163], a[32:35]
  ds_read_b128 a[144:147], v3 offset:4096
  v_add_f32 v224, v224, v211
  v_cvt_pk_bf16_f32 v169, v210, v211
  v_add_f32 v224, v224, v212
  v_add_f32 v224, v224, v213
  v_mfma_f32_16x16x32_bf16 a[36:39], a[176:179], v[164:167], a[36:39]
  v_exp_f32 v208, v120
  v_mfma_f32_16x16x32_bf16 a[96:99], a[176:179], v[176:179], a[96:99]
  v_exp_f32 v209, v121
  v_mfma_f32_16x16x32_bf16 a[100:103], a[176:179], v[180:183], a[100:103]
  v_exp_f32 v210, v122
  v_mfma_f32_16x16x32_bf16 a[40:43], a[180:183], v[160:163], a[40:43]
  ds_read_b128 a[148:151], v3 offset:5120
  v_cvt_pk_bf16_f32 v170, v212, v213
  v_add_f32 v224, v224, v214
  v_add_f32 v224, v224, v215
  v_cvt_pk_bf16_f32 v171, v214, v215
  v_add_f32 v225, v208, v209
  v_mfma_f32_16x16x32_bf16 a[44:47], a[180:183], v[164:167], a[44:47]
  v_exp_f32 v211, v123
  v_mfma_f32_16x16x32_bf16 a[104:107], a[180:183], v[176:179], a[104:107]
  v_exp_f32 v212, v124
  v_mfma_f32_16x16x32_bf16 a[108:111], a[180:183], v[180:183], a[108:111]
  v_exp_f32 v213, v125
  v_mfma_f32_16x16x32_bf16 a[48:51], a[184:187], v[160:163], a[48:51]
  ds_read_b128 a[152:155], v3 offset:6144
  v_cvt_pk_bf16_f32 v172, v208, v209
  v_add_f32 v225, v225, v210
  v_add_f32 v225, v225, v211
  v_cvt_pk_bf16_f32 v173, v210, v211
  v_max3_f32 v5, v226, v227, v224
  v_mfma_f32_16x16x32_bf16 a[52:55], a[184:187], v[164:167], a[52:55]
  v_exp_f32 v214, v126
  v_mfma_f32_16x16x32_bf16 a[112:115], a[184:187], v[176:179], a[112:115]
  buffer_load_dwordx4 v2, s[44:47], s26 offen offset:3072 sc1 lds
  v_add_f32 v225, v225, v212
  v_add_f32 v225, v225, v213
  v_cvt_pk_bf16_f32 v174, v212, v213
  v_mfma_f32_16x16x32_bf16 a[116:119], a[184:187], v[180:183], a[116:119]
  s_add_u32 s26, s26, 16384
  v_exp_f32 v215, v127
  v_mfma_f32_16x16x32_bf16 a[56:59], a[188:191], v[160:163], a[56:59]
  s_add_u32 s24, s24, 32768
  ds_read_b128 a[156:159], v3 offset:7168
  v_add_f32 v225, v225, v214
  v_add_f32 v225, v225, v215
  v_max_f32 v5, v5, v225
  v_cmp_lt_f32 vcc, s81, v5
  v_mfma_f32_16x16x32_bf16 a[60:63], a[188:191], v[164:167], a[60:63]
  s_and_b32 s24, s24, 0x1ffff
  v_exp_f32 v216, v128
  v_mfma_f32_16x16x32_bf16 a[120:123], a[188:191], v[176:179], a[120:123]
  s_waitcnt lgkmcnt(4)
  v_cvt_pk_bf16_f32 v175, v214, v215
  v_mfma_f32_16x16x32_bf16 a[124:127], a[188:191], v[180:183], a[124:127]
  s_cbranch_vccnz fa_stub8
fa_back8:
  v_exp_f32 v217, v129
  v_add_f32 v228, v228, v224
  v_add_f32 v229, v229, v225
  v_add_f32 v230, v230, v226
  v_add_f32 v231, v231, v227
  v_mfma_f32_16x16x32_bf16 v[144:147], a[128:131], v[64:67], v[200:203]
  ds_read_b128 a[160:163], v3 offset:24576
  v_add_f32 v226, v216, v217
  v_mfma_f32_16x16x32_bf16 v[152:155], a[128:131], v[68:71], v[204:207]
  v_exp_f32 v218, v130
  v_mfma_f32_16x16x32_bf16 v[148:151], a[132:135], v[64:67], v[200:203]
  s_add_u32 s66, s66, 32768
  ds_read_b128 a[164:167], v3 offset:25600
  v_cvt_pk_bf16_f32 v176, v216, v217
  v_mfma_f32_16x16x32_bf16 v[156:159], a[132:135], v[68:71], v[204:207]
  s_and_b32 s66, s66, 0x1ffff
  v_exp_f32 v219, v131
  v_mfma_f32_16x16x32_bf16 v[144:147], a[136:139], v[72:75], v[144:147]
  ds_read_b128 a[168:171], v3 offset:26624
  v_add_f32 v226, v226, v218
  v_mfma_f32_16x16x32_bf16 v[152:155], a[136:139], v[76:79], v[152:155]
  s_mov_b32 m0, s25
  v_exp_f32 v220, v132
  v_mfma_f32_16x16x32_bf16 v[148:151], a[140:143], v[72:75], v[148:151]
  ds_read_b128 a[172:175], v3 offset:27648
  buffer_load_dwordx4 v2, s[48:51], s27 offen offset:0 sc1 lds
  v_add_f32 v226, v226, v219
  v_mfma_f32_16x16x32_bf16 v[156:159], a[140:143], v[76:79], v[156:159]
  s_waitcnt lgkmcnt(4)
  v_exp_f32 v221, v133
  v_mfma_f32_16x16x32_bf16 v[144:147], a[144:147], v[80:83], v[144:147]
  ds_read_b128 a[176:179], v3 offset:28672
  v_cvt_pk_bf16_f32 v177, v218, v219
  v_mfma_f32_16x16x32_bf16 v[152:155], a[144:147], v[84:87], v[152:155]
  v_exp_f32 v222, v134
  v_mfma_f32_16x16x32_bf16 v[148:151], a[148:151], v[80:83], v[148:151]
  ds_read_b128 a[180:183], v3 offset:29696
  v_add_f32 v226, v226, v220
  v_mfma_f32_16x16x32_bf16 v[156:159], a[148:151], v[84:87], v[156:159]
  v_exp_f32 v223, v135
  v_mfma_f32_16x16x32_bf16 v[144:147], a[152:155], v[88:91], v[144:147]
  ds_read_b128 a[184:187], v3 offset:30720
  v_add_f32 v226, v226, v221
  v_mfma_f32_16x16x32_bf16 v[152:155], a[152:155], v[92:95], v[152:155]
  v_exp_f32 v216, v136
  v_mfma_f32_16x16x32_bf16 v[148:151], a[156:159], v[88:91], v[148:151]
  ds_read_b128 a[188:191], v3 offset:31744
  v_cvt_pk_bf16_f32 v178, v220, v221
  v_mfma_f32_16x16x32_bf16 v[156:159], a[156:159], v[92:95], v[156:159]
  s_waitcnt lgkmcnt(4)
  v_exp_f32 v217, v137
  v_mfma_f32_16x16x32_bf16 a[0:3], a[160:163], v[168:171], a[0:3]
  ds_read_b128 a[128:131], v3 offset:8192
  v_add_f32 v226, v226, v222
  v_mfma_f32_16x16x32_bf16 a[4:7], a[160:163], v[172:175], a[4:7]
  v_exp_f32 v218, v138
  v_mfma_f32_16x16x32_bf16 a[64:67], a[160:163], v[184:187], a[64:67]
  buffer_load_dwordx4 v2, s[48:51], s27 offen offset:1024 sc1 lds
  v_add_f32 v226, v226, v223
  v_mfma_f32_16x16x32_bf16 a[68:71], a[160:163], v[188:191], a[68:71]
  v_exp_f32 v219, v139
  v_mfma_f32_16x16x32_bf16 a[8:11], a[164:167], v[168:171], a[8:11]
  ds_read_b128 a[132:135], v3 offset:9216
  v_cvt_pk_bf16_f32 v179, v222, v223
  v_mfma_f32_16x16x32_bf16 a[12:15], a[164:167], v[172:175], a[12:15]
  v_exp_f32 v220, v140
  v_mfma_f32_16x16x32_bf16 a[72:75], a[164:167], v[184:187], a[72:75]
  v_add_f32 v227, v216, v217
  v_cvt_pk_bf16_f32 v180, v216, v217
  v_mfma_f32_16x16x32_bf16 a[76:79], a[164:167], v[188:191], a[76:79]
  v_exp_f32 v221, v141
  v_mfma_f32_16x16x32_bf16 a[16:19], a[168:171], v[168:171], a[16:19]
  ds_read_b128 a[136:139], v3 offset:10240
  v_add_f32 v227, v227, v218
  v_mfma_f32_16x16x32_bf16 a[20:23], a[168:171], v[172:175], a[20:23]
  v_exp_f32 v222, v142
  v_mfma_f32_16x16x32_bf16 a[80:83], a[168:171], v[184:187], a[80:83]
  v_add_f32 v227, v227, v219
  v_cvt_pk_bf16_f32 v181, v218, v219
  v_mfma_f32_16x16x32_bf16 a[84:87], a[168:171], v[188:191], a[84:87]
  v_exp_f32 v223, v143
  v_mfma_f32_16x16x32_bf16 a[24:27], a[172:175], v[168:171], a[24:27]
  ds_read_b128 a[140:143], v3 offset:11264
  v_add_f32 v227, v227, v220
  v_mfma_f32_16x16x32_bf16 a[28:31], a[172:175], v[172:175], a[28:31]
  v_add_f32 v227, v227, v221
  v_cvt_pk_bf16_f32 v182, v220, v221
  v_mfma_f32_16x16x32_bf16 a[88:91], a[172:175], v[184:187], a[88:91]
  buffer_load_dwordx4 v2, s[48:51], s27 offen offset:2048 sc1 lds
  v_add_f32 v227, v227, v222
  v_mfma_f32_16x16x32_bf16 a[92:95], a[172:175], v[188:191], a[92:95]
  s_waitcnt lgkmcnt(4)
  v_add_f32 v227, v227, v223
  v_max_f32 v5, v226, v227
  v_mfma_f32_16x16x32_bf16 a[32:35], a[176:179], v[168:171], a[32:35]
  ds_read_b128 a[144:147], v3 offset:12288
  v_cmp_lt_f32 vcc, s81, v5
  v_mfma_f32_16x16x32_bf16 a[36:39], a[176:179], v[172:175], a[36:39]
  v_mfma_f32_16x16x32_bf16 a[96:99], a[176:179], v[184:187], a[96:99]
  v_mfma_f32_16x16x32_bf16 a[100:103], a[176:179], v[188:191], a[100:103]
  v_mfma_f32_16x16x32_bf16 a[40:43], a[180:183], v[168:171], a[40:43]
  ds_read_b128 a[148:151], v3 offset:13312
  v_mfma_f32_16x16x32_bf16 a[44:47], a[180:183], v[172:175], a[44:47]
  v_mfma_f32_16x16x32_bf16 a[104:107], a[180:183], v[184:187], a[104:107]
  v_mfma_f32_16x16x32_bf16 a[108:111], a[180:183], v[188:191], a[108:111]
  v_mfma_f32_16x16x32_bf16 a[48:51], a[184:187], v[168:171], a[48:51]
  ds_read_b128 a[152:155], v3 offset:14336
  v_mfma_f32_16x16x32_bf16 a[52:55], a[184:187], v[172:175], a[52:55]
  v_mfma_f32_16x16x32_bf16 a[112:115], a[184:187], v[184:187], a[112:115]
  buffer_load_dwordx4 v2, s[48:51], s27 offen offset:3072 sc1 lds
  v_mfma_f32_16x16x32_bf16 a[116:119], a[184:187], v[188:191], a[116:119]
  s_add_u32 s27, s27, 16384
  v_mfma_f32_16x16x32_bf16 a[56:59], a[188:191], v[168:171], a[56:59]
  s_add_u32 s25, s25, 32768
  ds_read_b128 a[156:159], v3 offset:15360
  v_mfma_f32_16x16x32_bf16 a[60:63], a[188:191], v[172:175], a[60:63]
  s_and_b32 s25, s25, 0x1ffff
  v_exp_f32 v216, v144
  v_mfma_f32_16x16x32_bf16 a[120:123], a[188:191], v[184:187], a[120:123]
  s_waitcnt lgkmcnt(4)
  v_cvt_pk_bf16_f32 v183, v222, v223
  v_add_u32 v3, s66, v2
  v_mfma_f32_16x16x32_bf16 a[124:127], a[188:191], v[188:191], a[124:127]
  s_cbranch_vccnz fa_stub9
fa_back9:
  v_exp_f32 v217, v145
  v_add_f32 v230, v230, v226
  v_add_f32 v231, v231, v227
fa_SSpre:
  s_mov_b32 s11, 1
  s_cmp_lg_u32 s12, 0
  s_cselect_b32 s32, s15, s32
  s_cmp_ge_u32 s20, 2
  s_cselect_b32 s23, 8, 0
  s_cmp_le_u32 s29, s23
  s_cbranch_scc1 fa_chain
.p2align 6
fa_SS:
  v_mfma_f32_16x16x32_bf16 v[128:131], a[128:131], v[64:67], v[200:203]
  s_waitcnt vmcnt(12)
  v_exp_f32 v218, v146
  v_mfma_f32_16x16x32_bf16 v[136:139], a[128:131], v[68:71], v[204:207]
  s_barrier
  v_exp_f32 v219, v147
  v_mfma_f32_16x16x32_bf16 v[132:135], a[132:135], v[64:67], v[200:203]
  s_cmp_ge_u32 s26, s32
  ds_read_b128 a[160:163], v3 offset:16384
  ds_read_b128 a[164:167], v3 offset:17408
  v_add_f32 v226, v216, v217
  v_mfma_f32_16x16x32_bf16 v[140:143], a[132:135], v[68:71], v[204:207]
  s_cbranch_scc1 fa_hk7
fa_hb7:
  v_exp_f32 v220, v148
  v_mfma_f32_16x16x32_bf16 v[128:131], a[136:139], v[72:75], v[128:131]
  ds_read_b128 a[168:171], v3 offset:18432
  v_cvt_pk_bf16_f32 v184, v216, v217
  v_mfma_f32_16x16x32_bf16 v[136:139], a[136:139], v[76:79], v[136:139]
  s_mov_b32 m0, s24
  v_exp_f32 v221, v149
  v_mfma_f32_16x16x32_bf16 v[132:135], a[140:143], v[72:75], v[132:135]
  ds_read_b128 a[172:175], v3 offset:19456
  buffer_load_dwordx4 v2, s[44:47], s26 offen offset:0 sc1 lds
  v_add_f32 v226, v226, v218
  v_add_f32 v226, v226, v219
  v_mfma_f32_16x16x32_bf16 v[140:143], a[140:143], v[76:79], v[140:143]
  s_waitcnt lgkmcnt(4)
  v_exp_f32 v222, v150
  v_mfma_f32_16x16x32_bf16 v[128:131], a[144:147], v[80:83], v[128:131]
  ds_read_b128 a[176:179], v3 offset:20480
  v_cvt_pk_bf16_f32 v185, v218, v219
  v_mfma_f32_16x16x32_bf16 v[136:139], a[144:147], v[84:87], v[136:139]
  v_exp_f32 v223, v151
  v_mfma_f32_16x16x32_bf16 v[132:135], a[148:151], v[80:83], v[132:135]
  ds_read_b128 a[180:183], v3 offset:21504
  v_add_f32 v226, v226, v220
  v_mfma_f32_16x16x32_bf16 v[140:143], a[148:151], v[84:87], v[140:143]
  v_exp_f32 v216, v152
  v_mfma_f32_16x16x32_bf16 v[128:131], a[152:155], v[88:91], v[128:131]
  ds_read_b128 a[184:187], v3 offset:22528
  buffer_load_dwordx4 v2, s[44:47], s26 offen offset:1024 sc1 lds
  v_add_f32 v226, v226, v221
  v_cvt_pk_bf16_f32 v186, v220, v221
  v_mfma_f32_16x16x32_bf16 v[136:139], a[152:155], v[92:95], v[136:139]
  v_exp_f32 v217, v153
  v_mfma_f32_16x16x32_bf16 v[132:135], a[156:159], v[88:91], v[132:135]
  ds_read_b128 a[188:191], v3 offset:23552
  v_add_f32 v226, v226, v222
  v_mfma_f32_16x16x32_bf16 v[140:143], a[156:159], v[92:95], v[140:143]
  s_waitcnt lgkmcnt(4)
  v_exp_f32 v218, v154
  v_mfma_f32_16x16x32_bf16 a[64:67], a[160:163], v[176:179], a[64:67]
  ds_read_b128 a[128:131], v3 offset:0
  v_add_f32 v226, v226, v223
  v_cvt_pk_bf16_f32 v187, v222, v223
  v_mfma_f32_16x16x32_bf16 a[68:71], a[160:163], v[180:183], a[68:71]
  v_exp_f32 v219, v155
  v_mfma_f32_16x16x32_bf16 a[72:75], a[164:167], v[176:179], a[72:75]
  ds_read_b128 a[132:135], v3 offset:1024
  buffer_load_dwordx4 v2, s[44:47], s26 offen offset:2048 sc1 lds
  v_add_f32 v227, v216, v217
  v_mfma_f32_16x16x32_bf16 a[76:79], a[164:167], v[180:183], a[76:79]
  v_exp_f32 v220, v156
  v_mfma_f32_16x16x32_bf16 a[80:83], a[168:171], v[176:179], a[80:83]
  ds_read_b128 a[136:139], v3 offset:2048
  v_cvt_pk_bf16_f32 v188, v216, v217
  v_mfma_f32_16x16x32_bf16 a[84:87], a[168:171], v[180:183], a[84:87]
  v_exp_f32 v221, v157
  v_mfma_f32_16x16x32_bf16 a[88:91], a[172:175], v[176:179], a[88:91]
  ds_read_b128 a[140:143], v3 offset:3072
  v_add_f32 v227, v227, v218
  v_add_f32 v227, v227, v219
  v_mfma_f32_16x16x32_bf16 a[92:95], a[172:175], v[180:183], a[92:95]
  s_waitcnt lgkmcnt(4)
  v_exp_f32 v222, v158
  v_mfma_f32_16x16x32_bf16 a[96:99], a[176:179], v[176:179], a[96:99]
  ds_read_b128 a[144:147], v3 offset:4096
  buffer_load_dwordx4 v2, s[44:47], s26 offen offset:3072 sc1 lds
  v_cvt_pk_bf16_f32 v189, v218, v219
  v_mfma_f32_16x16x32_bf16 a[100:103], a[176:179], v[180:183], a[100:103]
  s_add_u32 s26, s26, 16384
  v_exp_f32 v223, v159
  v_mfma_f32_16x16x32_bf16 a[104:107], a[180:183], v[176:179], a[104:107]
  s_add_u32 s24, s24, 32768
  ds_read_b128 a[148:151], v3 offset:5120
  v_add_f32 v227, v227, v220
  v_mfma_f32_16x16x32_bf16 a[108:111], a[180:183], v[180:183], a[108:111]
  s_and_b32 s24, s24, 0x1ffff
  v_add_f32 v227, v227, v221
  v_cvt_pk_bf16_f32 v190, v220, v221
  v_add_f32 v227, v227, v222
  v_mfma_f32_16x16x32_bf16 a[112:115], a[184:187], v[176:179], a[112:115]
  ds_read_b128 a[152:155], v3 offset:6144
  v_add_f32 v227, v227, v223
  v_max_f32 v5, v226, v227
  v_cmp_lt_f32 vcc, s81, v5
  v_mfma_f32_16x16x32_bf16 a[116:119], a[184:187], v[180:183], a[116:119]
  v_exp_f32 v216, v128
  v_mfma_f32_16x16x32_bf16 a[120:123], a[188:191], v[176:179], a[120:123]
  s_waitcnt lgkmcnt(3)
  ds_read_b128 a[156:159], v3 offset:7168
  v_cvt_pk_bf16_f32 v191, v222, v223
  v_mfma_f32_16x16x32_bf16 a[124:127], a[188:191], v[180:183], a[124:127]
  s_cbranch_vccnz fa_stub10
fa_back10:
  v_exp_f32 v217, v129
  v_add_f32 v230, v230, v226
  v_add_f32 v231, v231, v227
  v_mfma_f32_16x16x32_bf16 v[144:147], a[128:131], v[64:67], v[200:203]
  ds_read_b128 a[160:163], v3 offset:24576
  v_add_f32 v226, v216, v217
  v_mfma_f32_16x16x32_bf16 v[152:155], a[128:131], v[68:71], v[204:207]
  v_exp_f32 v218, v130
  v_mfma_f32_16x16x32_bf16 v[148:151], a[132:135], v[64:67], v[200:203]
  s_add_u32 s66, s66, 32768
  ds_read_b128 a[164:167], v3 offset:25600
  v_cvt_pk_bf16_f32 v176, v216, v217
  v_mfma_f32_16x16x32_bf16 v[156:159], a[132:135], v[68:71], v[204:207]
  s_mov_b32 m0, s25
  v_exp_f32 v219, v131
  v_mfma_f32_16x16x32_bf16 v[144:147], a[136:139], v[72:75], v[144:147]
  s_and_b32 s66, s66, 0x1ffff
  ds_read_b128 a[168:171], v3 offset:26624
  buffer_load_dwordx4 v2, s[48:51], s27 offen offset:0 sc1 lds
  v_add_f32 v226, v226, v218
  v_add_f32 v226, v226, v219
  v_mfma_f32_16x16x32_bf16 v[152:155], a[136:139], v[76:79], v[152:155]
  v_exp_f32 v220, v132
  v_mfma_f32_16x16x32_bf16 v[148:151], a[140:143], v[72:75], v[148:151]
  ds_read_b128 a[172:175], v3 offset:27648
  v_cvt_pk_bf16_f32 v177, v218, v219
  v_mfma_f32_16x16x32_bf16 v[156:159], a[140:143], v[76:79], v[156:159]
  s_waitcnt lgkmcnt(4)
  v_exp_f32 v221, v133
  v_mfma_f32_16x16x32_bf16 v[144:147], a[144:147], v[80:83], v[144:147]
  ds_read_b128 a[176:179], v3 offset:28672
  v_add_f32 v226, v226, v220
  v_mfma_f32_16x16x32_bf16 v[152:155], a[144:147], v[84:87], v[152:155]
  v_exp_f32 v222, v134
  v_mfma_f32_16x16x32_bf16 v[148:151], a[148:151], v[80:83], v[148:151]
  ds_read_b128 a[180:183], v3 offset:29696
  buffer_load_dwordx4 v2, s[48:51], s27 offen offset:1024 sc1 lds
  v_add_f32 v226, v226, v221
  v_cvt_pk_bf16_f32 v178, v220, v221
  v_mfma_f32_16x16x32_bf16 v[156:159], a[148:151], v[84:87], v[156:159]
  v_exp_f32 v223, v135
  v_mfma_f32_16x16x32_bf16 v[144:147], a[152:155], v[88:91], v[144:147]
  ds_read_b128 a[184:187], v3 offset:30720
  v_add_f32 v226, v226, v222
  v_mfma_f32_16x16x32_bf16 v[152:155], a[152:155], v[92:95], v[152:155]
  v_exp_f32 v216, v136
  v_mfma_f32_16x16x32_bf16 v[148:151], a[156:159], v[88:91], v[148:151]
  ds_read_b128 a[188:191], v3 offset:31744
  v_add_f32 v226, v226, v223
  v_exp_f32 v217, v137
  v_mfma_f32_16x16x32_bf16 v[156:159], a[156:159], v[92:95], v[156:159]
  s_waitcnt lgkmcnt(4)
  v_exp_f32 v218, v138
  v_mfma_f32_16x16x32_bf16 a[64:67], a[160:163], v[184:187], a[64:67]
  ds_read_b128 a[128:131], v3 offset:8192
  v_cvt_pk_bf16_f32 v179, v222, v223
  v_mfma_f32_16x16x32_bf16 a[68:71], a[160:163], v[188:191], a[68:71]
  v_exp_f32 v219, v139
  v_mfma_f32_16x16x32_bf16 a[72:75], a[164:167], v[184:187], a[72:75]
  ds_read_b128 a[132:135], v3 offset:9216
  buffer_load_dwordx4 v2, s[48:51], s27 offen offset:2048 sc1 lds
  v_add_f32 v227, v216, v217
  v_mfma_f32_16x16x32_bf16 a[76:79], a[164:167], v[188:191], a[76:79]
  v_exp_f32 v220, v140
  v_mfma_f32_16x16x32_bf16 a[80:83], a[168:171], v[184:187], a[80:83]
  ds_read_b128 a[136:139], v3 offset:10240
  v_cvt_pk_bf16_f32 v180, v216, v217
  v_mfma_f32_16x16x32_bf16 a[84:87], a[168:171], v[188:191], a[84:87]
  v_exp_f32 v221, v141
  v_mfma_f32_16x16x32_bf16 a[88:91], a[172:175], v[184:187], a[88:91]
  ds_read_b128 a[140:143], v3 offset:11264
  v_add_f32 v227, v227, v218
  v_mfma_f32_16x16x32_bf16 a[92:95], a[172:175], v[188:191], a[92:95]
  s_waitcnt lgkmcnt(4)
  v_exp_f32 v222, v142
  v_mfma_f32_16x16x32_bf16 a[96:99], a[176:179], v[184:187], a[96:99]
  ds_read_b128 a[144:147], v3 offset:12288
  buffer_load_dwordx4 v2, s[48:51], s27 offen offset:3072 sc1 lds
  v_add_f32 v227, v227, v219
  v_cvt_pk_bf16_f32 v181, v218, v219
  v_mfma_f32_16x16x32_bf16 a[100:103], a[176:179], v[188:191], a[100:103]
  s_add_u32 s27, s27, 16384
  v_exp_f32 v223, v143
  v_mfma_f32_16x16x32_bf16 a[104:107], a[180:183], v[184:187], a[104:107]
  s_add_u32 s25, s25, 32768
  ds_read_b128 a[148:151], v3 offset:13312
  v_add_f32 v227, v227, v220
  v_mfma_f32_16x16x32_bf16 a[108:111], a[180:183], v[188:191], a[108:111]
  s_and_b32 s25, s25, 0x1ffff
  v_add_f32 v227, v227, v221
  v_cvt_pk_bf16_f32 v182, v220, v221
  v_add_f32 v227, v227, v222
  v_mfma_f32_16x16x32_bf16 a[112:115], a[184:187], v[184:187], a[112:115]
  s_sub_u32 s29, s29, 1
  ds_read_b128 a[152:155], v3 offset:14336
  v_add_f32 v227, v227, v223
  v_max_f32 v5, v226, v227
  v_cmp_lt_f32 vcc, s81, v5
  v_mfma_f32_16x16x32_bf16 a[116:119], a[184:187], v[188:191], a[116:119]
  s_cmp_gt_u32 s29, 8
  v_exp_f32 v216, v144
  v_mfma_f32_16x16x32_bf16 a[120:123], a[188:191], v[184:187], a[120:123]
  s_waitcnt lgkmcnt(3)
  ds_read_b128 a[156:159], v3 offset:15360
  v_cvt_pk_bf16_f32 v183, v222, v223
  v_add_u32 v3, s66, v2
  v_mfma_f32_16x16x32_bf16 a[124:127], a[188:191], v[188:191], a[124:127]
  s_cbranch_vccnz fa_stub11
fa_back11:
  v_exp_f32 v217, v145
  v_add_f32 v230, v230, v226
  v_add_f32 v231, v231, v227
  s_cbranch_scc1 fa_SS
fa_chain:
fa_hb8:
  s_cmp_lt_u32 s12, 2
  s_cbranch_scc1 fa_hk8
  s_cmp_eq_u32 s29, 8
  s_cbranch_scc0 fa_disp
fa_SSW8:
  v_mfma_f32_16x16x32_bf16 v[128:131], a[128:131], v[64:67], v[200:203]
  s_waitcnt vmcnt(12)
  v_exp_f32 v218, v146
  v_mfma_f32_16x16x32_bf16 v[136:139], a[128:131], v[68:71], v[204:207]
  s_barrier
  v_exp_f32 v219, v147
  v_mfma_f32_16x16x32_bf16 v[132:135], a[132:135], v[64:67], v[200:203]
  ds_read_b128 a[160:163], v3 offset:16384
  ds_read_b128 a[164:167], v3 offset:17408
  v_add_f32 v226, v216, v217
  v_mfma_f32_16x16x32_bf16 v[140:143], a[132:135], v[68:71], v[204:207]
  s_mov_b32 m0, s24
  v_exp_f32 v220, v148
  v_mfma_f32_16x16x32_bf16 v[128:131], a[136:139], v[72:75], v[128:131]
  ds_read_b128 a[168:171], v3 offset:18432
  buffer_load_dwordx4 v2, s[44:47], s26 offen offset:0 sc1 lds
  v_cvt_pk_bf16_f32 v184, v216, v217
  v_mfma_f32_16x16x32_bf16 v[136:139], a[136:139], v[76:79], v[136:139]
  v_exp_f32 v221, v149
  v_mfma_f32_16x16x32_bf16 v[132:135], a[140:143], v[72:75], v[132:135]
  ds_read_b128 a[172:175], v3 offset:19456
  v_add_f32 v226, v226, v218
  v_add_f32 v226, v226, v219
  v_mfma_f32_16x16x32_bf16 v[140:143], a[140:143], v[76:79], v[140:143]
  s_waitcnt lgkmcnt(4)
  v_exp_f32 v222, v150
  v_mfma_f32_16x16x32_bf16 v[128:131], a[144:147], v[80:83], v[128:131]
  s_add_u32 s14, s13, 0
  ds_read_b128 a[176:179], v3 offset:20480
  buffer_load_dwordx4 a[0:3], v2, s[40:43], s14 offen offset:0 sc1
  v_cvt_pk_bf16_f32 v185, v218, v219
  v_mfma_f32_16x16x32_bf16 v[136:139], a[144:147], v[84:87], v[136:139]
  v_exp_f32 v223, v151
  v_mfma_f32_16x16x32_bf16 v[132:135], a[148:151], v[80:83], v[132:135]
  ds_read_b128 a[180:183], v3 offset:21504
  buffer_load_dwordx4 v2, s[44:47], s26 offen offset:1024 sc1 lds
  v_add_f32 v226, v226, v220
  v_mfma_f32_16x16x32_bf16 v[140:143], a[148:151], v[84:87], v[140:143]
  v_exp_f32 v216, v152
  v_mfma_f32_16x16x32_bf16 v[128:131], a[152:155], v[88:91], v[128:131]
  ds_read_b128 a[184:187], v3 offset:22528
  v_add_f32 v226, v226, v221
  v_cvt_pk_bf16_f32 v186, v220, v221
  v_mfma_f32_16x16x32_bf16 v[136:139], a[152:155], v[92:95], v[136:139]
  v_exp_f32 v217, v153
  v_mfma_f32_16x16x32_bf16 v[132:135], a[156:159], v[88:91], v[132:135]
  ds_read_b128 a[188:191], v3 offset:23552
  buffer_load_dwordx4 a[4:7], v2, s[40:43], s14 offen offset:1024 sc1
  v_add_f32 v226, v226, v222
  v_mfma_f32_16x16x32_bf16 v[140:143], a[156:159], v[92:95], v[140:143]
  s_waitcnt lgkmcnt(4)
  v_exp_f32 v218, v154
  v_mfma_f32_16x16x32_bf16 a[64:67], a[160:163], v[176:179], a[64:67]
  ds_read_b128 a[128:131], v3 offset:0
  v_add_f32 v226, v226, v223
  v_cvt_pk_bf16_f32 v187, v222, v223
  v_mfma_f32_16x16x32_bf16 a[68:71], a[160:163], v[180:183], a[68:71]
  v_exp_f32 v219, v155
  v_mfma_f32_16x16x32_bf16 a[72:75], a[164:167], v[176:179], a[72:75]
  ds_read_b128 a[132:135], v3 offset:1024
  buffer_load_dwordx4 v2, s[44:47], s26 offen offset:2048 sc1 lds
  v_add_f32 v227, v216, v217
  v_mfma_f32_16x16x32_bf16 a[76:79], a[164:167], v[180:183], a[76:79]
  v_exp_f32 v220, v156
  v_mfma_f32_16x16x32_bf16 a[80:83], a[168:171], v[176:179], a[80:83]
  ds_read_b128 a[136:139], v3 offset:2048
  v_cvt_pk_bf16_f32 v188, v216, v217
  v_mfma_f32_16x16x32_bf16 a[84:87], a[168:171], v[180:183], a[84:87]
  v_exp_f32 v221, v157
  v_mfma_f32_16x16x32_bf16 a[88:91], a[172:175], v[176:179], a[88:91]
  ds_read_b128 a[140:143], v3 offset:3072
  buffer_load_dwordx4 a[8:11], v2, s[40:43], s14 offen offset:2048 sc1
  v_add_f32 v227, v227, v218
  v_add_f32 v227, v227, v219
  v_mfma_f32_16x16x32_bf16 a[92:95], a[172:175], v[180:183], a[92:95]
  s_waitcnt lgkmcnt(4)
  v_exp_f32 v222, v158
  v_mfma_f32_16x16x32_bf16 a[96:99], a[176:179], v[176:179], a[96:99]
  ds_read_b128 a[144:147], v3 offset:4096
  buffer_load_dwordx4 v2, s[44:47], s26 offen offset:3072 sc1 lds
  v_cvt_pk_bf16_f32 v189, v218, v219
  v_mfma_f32_16x16x32_bf16 a[100:103], a[176:179], v[180:183], a[100:103]
  s_add_u32 s26, s26, 16384
  v_exp_f32 v223, v159
  v_mfma_f32_16x16x32_bf16 a[104:107], a[180:183], v[176:179], a[104:107]
  s_add_u32 s24, s24, 32768
  ds_read_b128 a[148:151], v3 offset:5120
  v_add_f32 v227, v227, v220
  v_mfma_f32_16x16x32_bf16 a[108:111], a[180:183], v[180:183], a[108:111]
  s_and_b32 s24, s24, 0x1ffff
  v_add_f32 v227, v227, v221
  v_cvt_pk_bf16_f32 v190, v220, v221
  v_add_f32 v227, v227, v222
  v_mfma_f32_16x16x32_bf16 a[112:115], a[184:187], v[176:179], a[112:115]
  ds_read_b128 a[152:155], v3 offset:6144
  v_add_f32 v227, v227, v223
  v_max_f32 v5, v226, v227
  v_cmp_lt_f32 vcc, s81, v5
  v_mfma_f32_16x16x32_bf16 a[116:119], a[184:187], v[180:183], a[116:119]
  v_exp_f32 v216, v128
  v_mfma_f32_16x16x32_bf16 a[120:123], a[188:191], v[176:179], a[120:123]
  s_waitcnt lgkmcnt(3)
  ds_read_b128 a[156:159], v3 offset:7168
  v_cvt_pk_bf16_f32 v191, v222, v223
  v_mfma_f32_16x16x32_bf16 a[124:127], a[188:191], v[180:183], a[124:127]
  s_cbranch_vccnz fa_stub12
fa_back12:
  v_exp_f32 v217, v129
  v_add_f32 v230, v230, v226
  v_add_f32 v231, v231, v227
  v_mfma_f32_16x16x32_bf16 v[144:147], a[128:131], v[64:67], v[200:203]
  ds_read_b128 a[160:163], v3 offset:24576
  v_add_f32 v226, v216, v217
  v_mfma_f32_16x16x32_bf16 v[152:155], a[128:131], v[68:71], v[204:207]
  v_exp_f32 v218, v130
  v_mfma_f32_16x16x32_bf16 v[148:151], a[132:135], v[64:67], v[200:203]
  s_add_u32 s66, s66, 32768
  ds_read_b128 a[164:167], v3 offset:25600
  v_cvt_pk_bf16_f32 v176, v216, v217
  v_mfma_f32_16x16x32_bf16 v[156:159], a[132:135], v[68:71], v[204:207]
  s_mov_b32 m0, s25
  v_exp_f32 v219, v131
  v_mfma_f32_16x16x32_bf16 v[144:147], a[136:139], v[72:75], v[144:147]
  s_and_b32 s66, s66, 0x1ffff
  ds_read_b128 a[168:171], v3 offset:26624
  buffer_load_dwordx4 v2, s[48:51], s27 offen offset:0 sc1 lds
  v_add_f32 v226, v226, v218
  v_add_f32 v226, v226, v219
  v_mfma_f32_16x16x32_bf16 v[152:155], a[136:139], v[76:79], v[152:155]
  v_exp_f32 v220, v132
  v_mfma_f32_16x16x32_bf16 v[148:151], a[140:143], v[72:75], v[148:151]
  ds_read_b128 a[172:175], v3 offset:27648
  v_cvt_pk_bf16_f32 v177, v218, v219
  v_mfma_f32_16x16x32_bf16 v[156:159], a[140:143], v[76:79], v[156:159]
  s_waitcnt lgkmcnt(4)
  v_exp_f32 v221, v133
  v_mfma_f32_16x16x32_bf16 v[144:147], a[144:147], v[80:83], v[144:147]
  s_add_u32 s14, s13, 0
  ds_read_b128 a[176:179], v3 offset:28672
  buffer_load_dwordx4 a[12:15], v2, s[40:43], s14 offen offset:3072 sc1
  v_add_f32 v226, v226, v220
  v_mfma_f32_16x16x32_bf16 v[152:155], a[144:147], v[84:87], v[152:155]
  v_exp_f32 v222, v134
  v_mfma_f32_16x16x32_bf16 v[148:151], a[148:151], v[80:83], v[148:151]
  ds_read_b128 a[180:183], v3 offset:29696
  buffer_load_dwordx4 v2, s[48:51], s27 offen offset:1024 sc1 lds
  v_add_f32 v226, v226, v221
  v_cvt_pk_bf16_f32 v178, v220, v221
  v_mfma_f32_16x16x32_bf16 v[156:159], a[148:151], v[84:87], v[156:159]
  v_exp_f32 v223, v135
  v_mfma_f32_16x16x32_bf16 v[144:147], a[152:155], v[88:91], v[144:147]
  ds_read_b128 a[184:187], v3 offset:30720
  v_add_f32 v226, v226, v222
  v_mfma_f32_16x16x32_bf16 v[152:155], a[152:155], v[92:95], v[152:155]
  v_exp_f32 v216, v136
  v_mfma_f32_16x16x32_bf16 v[148:151], a[156:159], v[88:91], v[148:151]
  s_add_u32 s14, s13, 4096
  ds_read_b128 a[188:191], v3 offset:31744
  buffer_load_dwordx4 a[16:19], v2, s[40:43], s14 offen offset:0 sc1
  v_add_f32 v226, v226, v223
  v_exp_f32 v217, v137
  v_mfma_f32_16x16x32_bf16 v[156:159], a[156:159], v[92:95], v[156:159]
  s_waitcnt lgkmcnt(4)
  v_exp_f32 v218, v138
  v_mfma_f32_16x16x32_bf16 a[64:67], a[160:163], v[184:187], a[64:67]
  ds_read_b128 a[128:131], v3 offset:8192
  v_cvt_pk_bf16_f32 v179, v222, v223
  v_mfma_f32_16x16x32_bf16 a[68:71], a[160:163], v[188:191], a[68:71]
  v_exp_f32 v219, v139
  v_mfma_f32_16x16x32_bf16 a[72:75], a[164:167], v[184:187], a[72:75]
  ds_read_b128 a[132:135], v3 offset:9216
  buffer_load_dwordx4 v2, s[48:51], s27 offen offset:2048 sc1 lds
  v_add_f32 v227, v216, v217
  v_mfma_f32_16x16x32_bf16 a[76:79], a[164:167], v[188:191], a[76:79]
  v_exp_f32 v220, v140
  v_mfma_f32_16x16x32_bf16 a[80:83], a[168:171], v[184:187], a[80:83]
  ds_read_b128 a[136:139], v3 offset:10240
  v_cvt_pk_bf16_f32 v180, v216, v217
  v_mfma_f32_16x16x32_bf16 a[84:87], a[168:171], v[188:191], a[84:87]
  v_exp_f32 v221, v141
  v_mfma_f32_16x16x32_bf16 a[88:91], a[172:175], v[184:187], a[88:91]
  ds_read_b128 a[140:143], v3 offset:11264
  buffer_load_dwordx4 a[20:23], v2, s[40:43], s14 offen offset:1024 sc1
  v_add_f32 v227, v227, v218
  v_mfma_f32_16x16x32_bf16 a[92:95], a[172:175], v[188:191], a[92:95]
  s_waitcnt lgkmcnt(4)
  v_exp_f32 v222, v142
  v_mfma_f32_16x16x32_bf16 a[96:99], a[176:179], v[184:187], a[96:99]
  ds_read_b128 a[144:147], v3 offset:12288
  buffer_load_dwordx4 v2, s[48:51], s27 offen offset:3072 sc1 lds
  v_add_f32 v227, v227, v219
  v_cvt_pk_bf16_f32 v181, v218, v219
  v_mfma_f32_16x16x32_bf16 a[100:103], a[176:179], v[188:191], a[100:103]
  s_add_u32 s27, s27, 16384
  v_exp_f32 v223, v143
  v_mfma_f32_16x16x32_bf16 a[104:107], a[180:183], v[184:187], a[104:107]
  s_add_u32 s25, s25, 32768
  ds_read_b128 a[148:151], v3 offset:13312
  v_add_f32 v227, v227, v220
  v_mfma_f32_16x16x32_bf16 a[108:111], a[180:183], v[188:191], a[108:111]
  s_and_b32 s25, s25, 0x1ffff
  v_add_f32 v227, v227, v221
  v_cvt_pk_bf16_f32 v182, v220, v221
  v_add_f32 v227, v227, v222
  v_mfma_f32_16x16x32_bf16 a[112:115], a[184:187], v[184:187], a[112:115]
  ds_read_b128 a[152:155], v3 offset:14336
  v_add_f32 v227, v227, v223
  v_max_f32 v5, v226, v227
  v_cmp_lt_f32 vcc, s81, v5
  v_mfma_f32_16x16x32_bf16 a[116:119], a[184:187], v[188:191], a[116:119]
  v_exp_f32 v216, v144
  v_mfma_f32_16x16x32_bf16 a[120:123], a[188:191], v[184:187], a[120:123]
  s_waitcnt lgkmcnt(3)
  ds_read_b128 a[156:159], v3 offset:15360
  v_cvt_pk_bf16_f32 v183, v222, v223
  v_add_u32 v3, s66, v2
  v_mfma_f32_16x16x32_bf16 a[124:127], a[188:191], v[188:191], a[124:127]
  s_cbranch_vccnz fa_stub13
fa_back13:
  v_exp_f32 v217, v145
  v_add_f32 v230, v230, v226
  v_add_f32 v231, v231, v227
fa_SSW7:
  v_mfma_f32_16x16x32_bf16 v[128:131], a[128:131], v[64:67], v[200:203]
  s_waitcnt vmcnt(12)
  v_exp_f32 v218, v146
  v_mfma_f32_16x16x32_bf16 v[136:139], a[128:131], v[68:71], v[204:207]
  s_barrier
  v_exp_f32 v219, v147
  v_mfma_f32_16x16x32_bf16 v[132:135], a[132:135], v[64:67], v[200:203]
  ds_read_b128 a[160:163], v3 offset:16384
  ds_read_b128 a[164:167], v3 offset:17408
  v_add_f32 v226, v216, v217
  v_mfma_f32_16x16x32_bf16 v[140:143], a[132:135], v[68:71], v[204:207]
  s_mov_b32 m0, s24
  v_exp_f32 v220, v148
  v_mfma_f32_16x16x32_bf16 v[128:131], a[136:139], v[72:75], v[128:131]
  ds_read_b128 a[168:171], v3 offset:18432
  buffer_load_dwordx4 v2, s[44:47], s26 offen offset:0 sc1 lds
  v_cvt_pk_bf16_f32 v184, v216, v217
  v_mfma_f32_16x16x32_bf16 v[136:139], a[136:139], v[76:79], v[136:139]
  v_exp_f32 v221, v149
  v_mfma_f32_16x16x32_bf16 v[132:135], a[140:143], v[72:75], v[132:135]
  ds_read_b128 a[172:175], v3 offset:19456
  v_add_f32 v226, v226, v218
  v_add_f32 v226, v226, v219
  v_mfma_f32_16x16x32_bf16 v[140:143], a[140:143], v[76:79], v[140:143]
  s_waitcnt lgkmcnt(4)
  v_exp_f32 v222, v150
  v_mfma_f32_16x16x32_bf16 v[128:131], a[144:147], v[80:83], v[128:131]
  s_add_u32 s14, s13, 4096
  ds_read_b128 a[176:179], v3 offset:20480
  buffer_load_dwordx4 a[24:27], v2, s[40:43], s14 offen offset:2048 sc1
  v_cvt_pk_bf16_f32 v185, v218, v219
  v_mfma_f32_16x16x32_bf16 v[136:139], a[144:147], v[84:87], v[136:139]
  v_exp_f32 v223, v151
  v_mfma_f32_16x16x32_bf16 v[132:135], a[148:151], v[80:83], v[132:135]
  ds_read_b128 a[180:183], v3 offset:21504
  buffer_load_dwordx4 v2, s[44:47], s26 offen offset:1024 sc1 lds
  v_add_f32 v226, v226, v220
  v_mfma_f32_16x16x32_bf16 v[140:143], a[148:151], v[84:87], v[140:143]
  v_exp_f32 v216, v152
  v_mfma_f32_16x16x32_bf16 v[128:131], a[152:155], v[88:91], v[128:131]
  ds_read_b128 a[184:187], v3 offset:22528
  v_add_f32 v226, v226, v221
  v_cvt_pk_bf16_f32 v186, v220, v221
  v_mfma_f32_16x16x32_bf16 v[136:139], a[152:155], v[92:95], v[136:139]
  v_exp_f32 v217, v153
  v_mfma_f32_16x16x32_bf16 v[132:135], a[156:159], v[88:91], v[132:135]
  ds_read_b128 a[188:191], v3 offset:23552
  buffer_load_dwordx4 a[28:31], v2, s[40:43], s14 offen offset:3072 sc1
  v_add_f32 v226, v226, v222
  v_mfma_f32_16x16x32_bf16 v[140:143], a[156:159], v[92:95], v[140:143]
  s_waitcnt lgkmcnt(4)
  v_exp_f32 v218, v154
  v_mfma_f32_16x16x32_bf16 a[64:67], a[160:163], v[176:179], a[64:67]
  ds_read_b128 a[128:131], v3 offset:0
  v_add_f32 v226, v226, v223
  v_cvt_pk_bf16_f32 v187, v222, v223
  v_mfma_f32_16x16x32_bf16 a[68:71], a[160:163], v[180:183], a[68:71]
  v_exp_f32 v219, v155
  v_mfma_f32_16x16x32_bf16 a[72:75], a[164:167], v[176:179], a[72:75]
  ds_read_b128 a[132:135], v3 offset:1024
  buffer_load_dwordx4 v2, s[44:47], s26 offen offset:2048 sc1 lds
  v_add_f32 v227, v216, v217
  v_mfma_f32_16x16x32_bf16 a[76:79], a[164:167], v[180:183], a[76:79]
  v_exp_f32 v220, v156
  v_mfma_f32_16x16x32_bf16 a[80:83], a[168:171], v[176:179], a[80:83]
  ds_read_b128 a[136:139], v3 offset:2048
  v_cvt_pk_bf16_f32 v188, v216, v217
  v_mfma_f32_16x16x32_bf16 a[84:87], a[168:171], v[180:183], a[84:87]
  v_exp_f32 v221, v157
  v_mfma_f32_16x16x32_bf16 a[88:91], a[172:175], v[176:179], a[88:91]
  s_add_u32 s14, s13, 8192
  ds_read_b128 a[140:143], v3 offset:3072
  buffer_load_dwordx4 a[32:35], v2, s[40:43], s14 offen offset:0 sc1
  v_add_f32 v227, v227, v218
  v_add_f32 v227, v227, v219
  v_mfma_f32_16x16x32_bf16 a[92:95], a[172:175], v[180:183], a[92:95]
  s_waitcnt lgkmcnt(4)
  v_exp_f32 v222, v158
  v_mfma_f32_16x16x32_bf16 a[96:99], a[176:179], v[176:179], a[96:99]
  ds_read_b128 a[144:147], v3 offset:4096
  buffer_load_dwordx4 v2, s[44:47], s26 offen offset:3072 sc1 lds
  v_cvt_pk_bf16_f32 v189, v218, v219
  v_mfma_f32_16x16x32_bf16 a[100:103], a[176:179], v[180:183], a[100:103]
  s_add_u32 s26, s26, 16384
  v_exp_f32 v223, v159
  v_mfma_f32_16x16x32_bf16 a[104:107], a[180:183], v[176:179], a[104:107]
  s_add_u32 s24, s24, 32768
  ds_read_b128 a[148:151], v3 offset:5120
  v_add_f32 v227, v227, v220
  v_mfma_f32_16x16x32_bf16 a[108:111], a[180:183], v[180:183], a[108:111]
  s_and_b32 s24, s24, 0x1ffff
  v_add_f32 v227, v227, v221
  v_cvt_pk_bf16_f32 v190, v220, v221
  v_add_f32 v227, v227, v222
  v_mfma_f32_16x16x32_bf16 a[112:115], a[184:187], v[176:179], a[112:115]
  ds_read_b128 a[152:155], v3 offset:6144
  v_add_f32 v227, v227, v223
  v_max_f32 v5, v226, v227
  v_cmp_lt_f32 vcc, s81, v5
  v_mfma_f32_16x16x32_bf16 a[116:119], a[184:187], v[180:183], a[116:119]
  v_exp_f32 v216, v128
  v_mfma_f32_16x16x32_bf16 a[120:123], a[188:191], v[176:179], a[120:123]
  s_waitcnt lgkmcnt(3)
  ds_read_b128 a[156:159], v3 offset:7168
  v_cvt_pk_bf16_f32 v191, v222, v223
  v_mfma_f32_16x16x32_bf16 a[124:127], a[188:191], v[180:183], a[124:127]
  s_cbranch_vccnz fa_stub14
fa_back14:
  v_exp_f32 v217, v129
  v_add_f32 v230, v230, v226
  v_add_f32 v231, v231, v227
  v_mfma_f32_16x16x32_bf16 v[144:147], a[128:131], v[64:67], v[200:203]
  ds_read_b128 a[160:163], v3 offset:24576
  v_add_f32 v226, v216, v217
  v_mfma_f32_16x16x32_bf16 v[152:155], a[128:131], v[68:71], v[204:207]
  v_exp_f32 v218, v130
  v_mfma_f32_16x16x32_bf16 v[148:151], a[132:135], v[64:67], v[200:203]
  s_add_u32 s66, s66, 32768
  ds_read_b128 a[164:167], v3 offset:25600
  v_cvt_pk_bf16_f32 v176, v216, v217
  v_mfma_f32_16x16x32_bf16 v[156:159], a[132:135], v[68:71], v[204:207]
  s_mov_b32 m0, s25
  v_exp_f32 v219, v131
  v_mfma_f32_16x16x32_bf16 v[144:147], a[136:139], v[72:75], v[144:147]
  s_and_b32 s66, s66, 0x1ffff
  ds_read_b128 a[168:171], v3 offset:26624
  buffer_load_dwordx4 v2, s[48:51], s27 offen offset:0 sc1 lds
  v_add_f32 v226, v226, v218
  v_add_f32 v226, v226, v219
  v_mfma_f32_16x16x32_bf16 v[152:155], a[136:139], v[76:79], v[152:155]
  v_exp_f32 v220, v132
  v_mfma_f32_16x16x32_bf16 v[148:151], a[140:143], v[72:75], v[148:151]
  ds_read_b128 a[172:175], v3 offset:27648
  v_cvt_pk_bf16_f32 v177, v218, v219
  v_mfma_f32_16x16x32_bf16 v[156:159], a[140:143], v[76:79], v[156:159]
  s_waitcnt lgkmcnt(4)
  v_exp_f32 v221, v133
  v_mfma_f32_16x16x32_bf16 v[144:147], a[144:147], v[80:83], v[144:147]
  s_add_u32 s14, s13, 8192
  ds_read_b128 a[176:179], v3 offset:28672
  buffer_load_dwordx4 a[36:39], v2, s[40:43], s14 offen offset:1024 sc1
  v_add_f32 v226, v226, v220
  v_mfma_f32_16x16x32_bf16 v[152:155], a[144:147], v[84:87], v[152:155]
  v_exp_f32 v222, v134
  v_mfma_f32_16x16x32_bf16 v[148:151], a[148:151], v[80:83], v[148:151]
  ds_read_b128 a[180:183], v3 offset:29696
  buffer_load_dwordx4 v2, s[48:51], s27 offen offset:1024 sc1 lds
  v_add_f32 v226, v226, v221
  v_cvt_pk_bf16_f32 v178, v220, v221
  v_mfma_f32_16x16x32_bf16 v[156:159], a[148:151], v[84:87], v[156:159]
  v_exp_f32 v223, v135
  v_mfma_f32_16x16x32_bf16 v[144:147], a[152:155], v[88:91], v[144:147]
  ds_read_b128 a[184:187], v3 offset:30720
  v_add_f32 v226, v226, v222
  v_mfma_f32_16x16x32_bf16 v[152:155], a[152:155], v[92:95], v[152:155]
  v_exp_f32 v216, v136
  v_mfma_f32_16x16x32_bf16 v[148:151], a[156:159], v[88:91], v[148:151]
  ds_read_b128 a[188:191], v3 offset:31744
  buffer_load_dwordx4 a[40:43], v2, s[40:43], s14 offen offset:2048 sc1
  v_add_f32 v226, v226, v223
  v_exp_f32 v217, v137
  v_mfma_f32_16x16x32_bf16 v[156:159], a[156:159], v[92:95], v[156:159]
  s_waitcnt lgkmcnt(4)
  v_exp_f32 v218, v138
  v_mfma_f32_16x16x32_bf16 a[64:67], a[160:163], v[184:187], a[64:67]
  ds_read_b128 a[128:131], v3 offset:8192
  v_cvt_pk_bf16_f32 v179, v222, v223
  v_mfma_f32_16x16x32_bf16 a[68:71], a[160:163], v[188:191], a[68:71]
  v_exp_f32 v219, v139
  v_mfma_f32_16x16x32_bf16 a[72:75], a[164:167], v[184:187], a[72:75]
  ds_read_b128 a[132:135], v3 offset:9216
  buffer_load_dwordx4 v2, s[48:51], s27 offen offset:2048 sc1 lds
  v_add_f32 v227, v216, v217
  v_mfma_f32_16x16x32_bf16 a[76:79], a[164:167], v[188:191], a[76:79]
  v_exp_f32 v220, v140
  v_mfma_f32_16x16x32_bf16 a[80:83], a[168:171], v[184:187], a[80:83]
  ds_read_b128 a[136:139], v3 offset:10240
  v_cvt_pk_bf16_f32 v180, v216, v217
  v_mfma_f32_16x16x32_bf16 a[84:87], a[168:171], v[188:191], a[84:87]
  v_exp_f32 v221, v141
  v_mfma_f32_16x16x32_bf16 a[88:91], a[172:175], v[184:187], a[88:91]
  ds_read_b128 a[140:143], v3 offset:11264
  buffer_load_dwordx4 a[44:47], v2, s[40:43], s14 offen offset:3072 sc1
  v_add_f32 v227, v227, v218
  v_mfma_f32_16x16x32_bf16 a[92:95], a[172:175], v[188:191], a[92:95]
  s_waitcnt lgkmcnt(4)
  v_exp_f32 v222, v142
  v_mfma_f32_16x16x32_bf16 a[96:99], a[176:179], v[184:187], a[96:99]
  ds_read_b128 a[144:147], v3 offset:12288
  buffer_load_dwordx4 v2, s[48:51], s27 offen offset:3072 sc1 lds
  v_add_f32 v227, v227, v219
  v_cvt_pk_bf16_f32 v181, v218, v219
  v_mfma_f32_16x16x32_bf16 a[100:103], a[176:179], v[188:191], a[100:103]
  s_add_u32 s27, s27, 16384
  v_exp_f32 v223, v143
  v_mfma_f32_16x16x32_bf16 a[104:107], a[180:183], v[184:187], a[104:107]
  s_add_u32 s25, s25, 32768
  ds_read_b128 a[148:151], v3 offset:13312
  v_add_f32 v227, v227, v220
  v_mfma_f32_16x16x32_bf16 a[108:111], a[180:183], v[188:191], a[108:111]
  s_and_b32 s25, s25, 0x1ffff
  v_add_f32 v227, v227, v221
  v_cvt_pk_bf16_f32 v182, v220, v221
  v_add_f32 v227, v227, v222
  v_mfma_f32_16x16x32_bf16 a[112:115], a[184:187], v[184:187], a[112:115]
  ds_read_b128 a[152:155], v3 offset:14336
  v_add_f32 v227, v227, v223
  v_max_f32 v5, v226, v227
  v_cmp_lt_f32 vcc, s81, v5
  v_mfma_f32_16x16x32_bf16 a[116:119], a[184:187], v[188:191], a[116:119]
  v_exp_f32 v216, v144
  v_mfma_f32_16x16x32_bf16 a[120:123], a[188:191], v[184:187], a[120:123]
  s_waitcnt lgkmcnt(3)
  ds_read_b128 a[156:159], v3 offset:15360
  v_cvt_pk_bf16_f32 v183, v222, v223
  v_add_u32 v3, s66, v2
  v_mfma_f32_16x16x32_bf16 a[124:127], a[188:191], v[188:191], a[124:127]
  s_cbranch_vccnz fa_stub15
fa_back15:
  v_exp_f32 v217, v145
  v_add_f32 v230, v230, v226
  v_add_f32 v231, v231, v227
fa_SSW6:
  v_mfma_f32_16x16x32_bf16 v[128:131], a[128:131], v[64:67], v[200:203]
  s_waitcnt vmcnt(12)
  v_exp_f32 v218, v146
  v_mfma_f32_16x16x32_bf16 v[136:139], a[128:131], v[68:71], v[204:207]
  s_barrier
  v_exp_f32 v219, v147
  v_mfma_f32_16x16x32_bf16 v[132:135], a[132:135], v[64:67], v[200:203]
  ds_read_b128 a[160:163], v3 offset:16384
  ds_read_b128 a[164:167], v3 offset:17408
  v_add_f32 v226, v216, v217
  v_mfma_f32_16x16x32_bf16 v[140:143], a[132:135], v[68:71], v[204:207]
  s_mov_b32 m0, s24
  v_exp_f32 v220, v148
  v_mfma_f32_16x16x32_bf16 v[128:131], a[136:139], v[72:75], v[128:131]
  ds_read_b128 a[168:171], v3 offset:18432
  buffer_load_dwordx4 v2, s[44:47], s26 offen offset:0 sc1 lds
  v_cvt_pk_bf16_f32 v184, v216, v217
  v_mfma_f32_16x16x32_bf16 v[136:139], a[136:139], v[76:79], v[136:139]
  v_exp_f32 v221, v149
  v_mfma_f32_16x16x32_bf16 v[132:135], a[140:143], v[72:75], v[132:135]
  ds_read_b128 a[172:175], v3 offset:19456
  v_add_f32 v226, v226, v218
  v_add_f32 v226, v226, v219
  v_mfma_f32_16x16x32_bf16 v[140:143], a[140:143], v[76:79], v[140:143]
  s_waitcnt lgkmcnt(4)
  v_exp_f32 v222, v150
  v_mfma_f32_16x16x32_bf16 v[128:131], a[144:147], v[80:83], v[128:131]
  s_add_u32 s14, s13, 12288
  ds_read_b128 a[176:179], v3 offset:20480
  buffer_load_dwordx4 a[48:51], v2, s[40:43], s14 offen offset:0 sc1
  v_cvt_pk_bf16_f32 v185, v218, v219
  v_mfma_f32_16x16x32_bf16 v[136:139], a[144:147], v[84:87], v[136:139]
  v_exp_f32 v223, v151
  v_mfma_f32_16x16x32_bf16 v[132:135], a[148:151], v[80:83], v[132:135]
  ds_read_b128 a[180:183], v3 offset:21504
  buffer_load_dwordx4 v2, s[44:47], s26 offen offset:1024 sc1 lds
  v_add_f32 v226, v226, v220
  v_mfma_f32_16x16x32_bf16 v[140:143], a[148:151], v[84:87], v[140:143]
  v_exp_f32 v216, v152
  v_mfma_f32_16x16x32_bf16 v[128:131], a[152:155], v[88:91], v[128:131]
  ds_read_b128 a[184:187], v3 offset:22528
  v_add_f32 v226, v226, v221
  v_cvt_pk_bf16_f32 v186, v220, v221
  v_mfma_f32_16x16x32_bf16 v[136:139], a[152:155], v[92:95], v[136:139]
  v_exp_f32 v217, v153
  v_mfma_f32_16x16x32_bf16 v[132:135], a[156:159], v[88:91], v[132:135]
  ds_read_b128 a[188:191], v3 offset:23552
  buffer_load_dwordx4 a[52:55], v2, s[40:43], s14 offen offset:1024 sc1
  v_add_f32 v226, v226, v222
  v_mfma_f32_16x16x32_bf16 v[140:143], a[156:159], v[92:95], v[140:143]
  s_waitcnt lgkmcnt(4)
  v_exp_f32 v218, v154
  v_mfma_f32_16x16x32_bf16 a[64:67], a[160:163], v[176:179], a[64:67]
  ds_read_b128 a[128:131], v3 offset:0
  v_add_f32 v226, v226, v223
  v_cvt_pk_bf16_f32 v187, v222, v223
  v_mfma_f32_16x16x32_bf16 a[68:71], a[160:163], v[180:183], a[68:71]
  v_exp_f32 v219, v155
  v_mfma_f32_16x16x32_bf16 a[72:75], a[164:167], v[176:179], a[72:75]
  ds_read_b128 a[132:135], v3 offset:1024
  buffer_load_dwordx4 v2, s[44:47], s26 offen offset:2048 sc1 lds
  v_add_f32 v227, v216, v217
  v_mfma_f32_16x16x32_bf16 a[76:79], a[164:167], v[180:183], a[76:79]
  v_exp_f32 v220, v156
  v_mfma_f32_16x16x32_bf16 a[80:83], a[168:171], v[176:179], a[80:83]
  ds_read_b128 a[136:139], v3 offset:2048
  v_cvt_pk_bf16_f32 v188, v216, v217
  v_mfma_f32_16x16x32_bf16 a[84:87], a[168:171], v[180:183], a[84:87]
  v_exp_f32 v221, v157
  v_mfma_f32_16x16x32_bf16 a[88:91], a[172:175], v[176:179], a[88:91]
  ds_read_b128 a[140:143], v3 offset:3072
  buffer_load_dwordx4 a[56:59], v2, s[40:43], s14 offen offset:2048 sc1
  v_add_f32 v227, v227, v218
  v_add_f32 v227, v227, v219
  v_mfma_f32_16x16x32_bf16 a[92:95], a[172:175], v[180:183], a[92:95]
  s_waitcnt lgkmcnt(4)
  v_exp_f32 v222, v158
  v_mfma_f32_16x16x32_bf16 a[96:99], a[176:179], v[176:179], a[96:99]
  ds_read_b128 a[144:147], v3 offset:4096
  buffer_load_dwordx4 v2, s[44:47], s26 offen offset:3072 sc1 lds
  v_cvt_pk_bf16_f32 v189, v218, v219
  v_mfma_f32_16x16x32_bf16 a[100:103], a[176:179], v[180:183], a[100:103]
  s_add_u32 s26, s26, 16384
  v_exp_f32 v223, v159
  v_mfma_f32_16x16x32_bf16 a[104:107], a[180:183], v[176:179], a[104:107]
  s_add_u32 s24, s24, 32768
  ds_read_b128 a[148:151], v3 offset:5120
  v_add_f32 v227, v227, v220
  v_mfma_f32_16x16x32_bf16 a[108:111], a[180:183], v[180:183], a[108:111]
  s_and_b32 s24, s24, 0x1ffff
  v_add_f32 v227, v227, v221
  v_cvt_pk_bf16_f32 v190, v220, v221
  v_add_f32 v227, v227, v222
  v_mfma_f32_16x16x32_bf16 a[112:115], a[184:187], v[176:179], a[112:115]
  ds_read_b128 a[152:155], v3 offset:6144
  v_add_f32 v227, v227, v223
  v_max_f32 v5, v226, v227
  v_cmp_lt_f32 vcc, s81, v5
  v_mfma_f32_16x16x32_bf16 a[116:119], a[184:187], v[180:183], a[116:119]
  v_exp_f32 v216, v128
  v_mfma_f32_16x16x32_bf16 a[120:123], a[188:191], v[176:179], a[120:123]
  s_waitcnt lgkmcnt(3)
  ds_read_b128 a[156:159], v3 offset:7168
  v_cvt_pk_bf16_f32 v191, v222, v223
  v_mfma_f32_16x16x32_bf16 a[124:127], a[188:191], v[180:183], a[124:127]
  s_cbranch_vccnz fa_stub16
fa_back16:
  v_exp_f32 v217, v129
  v_add_f32 v230, v230, v226
  v_add_f32 v231, v231, v227
  v_mfma_f32_16x16x32_bf16 v[144:147], a[128:131], v[64:67], v[200:203]
  ds_read_b128 a[160:163], v3 offset:24576
  v_add_f32 v226, v216, v217
  v_mfma_f32_16x16x32_bf16 v[152:155], a[128:131], v[68:71], v[204:207]
  v_exp_f32 v218, v130
  v_mfma_f32_16x16x32_bf16 v[148:151], a[132:135], v[64:67], v[200:203]
  s_add_u32 s66, s66, 32768
  ds_read_b128 a[164:167], v3 offset:25600
  v_cvt_pk_bf16_f32 v176, v216, v217
  v_mfma_f32_16x16x32_bf16 v[156:159], a[132:135], v[68:71], v[204:207]
  s_mov_b32 m0, s25
  v_exp_f32 v219, v131
  v_mfma_f32_16x16x32_bf16 v[144:147], a[136:139], v[72:75], v[144:147]
  s_and_b32 s66, s66, 0x1ffff
  ds_read_b128 a[168:171], v3 offset:26624
  buffer_load_dwordx4 v2, s[48:51], s27 offen offset:0 sc1 lds
  v_add_f32 v226, v226, v218
  v_add_f32 v226, v226, v219
  v_mfma_f32_16x16x32_bf16 v[152:155], a[136:139], v[76:79], v[152:155]
  v_exp_f32 v220, v132
  v_mfma_f32_16x16x32_bf16 v[148:151], a[140:143], v[72:75], v[148:151]
  ds_read_b128 a[172:175], v3 offset:27648
  v_cvt_pk_bf16_f32 v177, v218, v219
  v_mfma_f32_16x16x32_bf16 v[156:159], a[140:143], v[76:79], v[156:159]
  s_waitcnt lgkmcnt(4)
  v_exp_f32 v221, v133
  v_mfma_f32_16x16x32_bf16 v[144:147], a[144:147], v[80:83], v[144:147]
  s_add_u32 s14, s13, 12288
  ds_read_b128 a[176:179], v3 offset:28672
  buffer_load_dwordx4 a[60:63], v2, s[40:43], s14 offen offset:3072 sc1
  v_add_f32 v226, v226, v220
  v_mfma_f32_16x16x32_bf16 v[152:155], a[144:147], v[84:87], v[152:155]
  v_exp_f32 v222, v134
  v_mfma_f32_16x16x32_bf16 v[148:151], a[148:151], v[80:83], v[148:151]
  ds_read_b128 a[180:183], v3 offset:29696
  buffer_load_dwordx4 v2, s[48:51], s27 offen offset:1024 sc1 lds
  v_add_f32 v226, v226, v221
  v_cvt_pk_bf16_f32 v178, v220, v221
  v_mfma_f32_16x16x32_bf16 v[156:159], a[148:151], v[84:87], v[156:159]
  v_exp_f32 v223, v135
  v_mfma_f32_16x16x32_bf16 v[144:147], a[152:155], v[88:91], v[144:147]
  ds_read_b128 a[184:187], v3 offset:30720
  v_add_f32 v226, v226, v222
  v_mfma_f32_16x16x32_bf16 v[152:155], a[152:155], v[92:95], v[152:155]
  v_exp_f32 v216, v136
  v_mfma_f32_16x16x32_bf16 v[148:151], a[156:159], v[88:91], v[148:151]
  s_add_u32 s14, s13, 16384
  ds_read_b128 a[188:191], v3 offset:31744
  buffer_load_dwordx4 a[192:195], v2, s[40:43], s14 offen offset:0 sc1
  v_add_f32 v226, v226, v223
  v_exp_f32 v217, v137
  v_mfma_f32_16x16x32_bf16 v[156:159], a[156:159], v[92:95], v[156:159]
  s_waitcnt lgkmcnt(4)
  v_exp_f32 v218, v138
  v_mfma_f32_16x16x32_bf16 a[64:67], a[160:163], v[184:187], a[64:67]
  ds_read_b128 a[128:131], v3 offset:8192
  v_cvt_pk_bf16_f32 v179, v222, v223
  v_mfma_f32_16x16x32_bf16 a[68:71], a[160:163], v[188:191], a[68:71]
  v_exp_f32 v219, v139
  v_mfma_f32_16x16x32_bf16 a[72:75], a[164:167], v[184:187], a[72:75]
  ds_read_b128 a[132:135], v3 offset:9216
  buffer_load_dwordx4 v2, s[48:51], s27 offen offset:2048 sc1 lds
  v_add_f32 v227, v216, v217
  v_mfma_f32_16x16x32_bf16 a[76:79], a[164:167], v[188:191], a[76:79]
  v_exp_f32 v220, v140
  v_mfma_f32_16x16x32_bf16 a[80:83], a[168:171], v[184:187], a[80:83]
  ds_read_b128 a[136:139], v3 offset:10240
  v_cvt_pk_bf16_f32 v180, v216, v217
  v_mfma_f32_16x16x32_bf16 a[84:87], a[168:171], v[188:191], a[84:87]
  v_exp_f32 v221, v141
  v_mfma_f32_16x16x32_bf16 a[88:91], a[172:175], v[184:187], a[88:91]
  ds_read_b128 a[140:143], v3 offset:11264
  buffer_load_dwordx4 a[196:199], v2, s[40:43], s14 offen offset:1024 sc1
  v_add_f32 v227, v227, v218
  v_mfma_f32_16x16x32_bf16 a[92:95], a[172:175], v[188:191], a[92:95]
  s_waitcnt lgkmcnt(4)
  v_exp_f32 v222, v142
  v_mfma_f32_16x16x32_bf16 a[96:99], a[176:179], v[184:187], a[96:99]
  ds_read_b128 a[144:147], v3 offset:12288
  buffer_load_dwordx4 v2, s[48:51], s27 offen offset:3072 sc1 lds
  v_add_f32 v227, v227, v219
  v_cvt_pk_bf16_f32 v181, v218, v219
  v_mfma_f32_16x16x32_bf16 a[100:103], a[176:179], v[188:191], a[100:103]
  s_add_u32 s27, s27, 16384
  v_exp_f32 v223, v143
  v_mfma_f32_16x16x32_bf16 a[104:107], a[180:183], v[184:187], a[104:107]
  s_add_u32 s25, s25, 32768
  ds_read_b128 a[148:151], v3 offset:13312
  v_add_f32 v227, v227, v220
  v_mfma_f32_16x16x32_bf16 a[108:111], a[180:183], v[188:191], a[108:111]
  s_and_b32 s25, s25, 0x1ffff
  v_add_f32 v227, v227, v221
  v_cvt_pk_bf16_f32 v182, v220, v221
  v_add_f32 v227, v227, v222
  v_mfma_f32_16x16x32_bf16 a[112:115], a[184:187], v[184:187], a[112:115]
  ds_read_b128 a[152:155], v3 offset:14336
  v_add_f32 v227, v227, v223
  v_max_f32 v5, v226, v227
  v_cmp_lt_f32 vcc, s81, v5
  v_mfma_f32_16x16x32_bf16 a[116:119], a[184:187], v[188:191], a[116:119]
  v_exp_f32 v216, v144
  v_mfma_f32_16x16x32_bf16 a[120:123], a[188:191], v[184:187], a[120:123]
  s_waitcnt lgkmcnt(3)
  ds_read_b128 a[156:159], v3 offset:15360
  v_cvt_pk_bf16_f32 v183, v222, v223
  v_add_u32 v3, s66, v2
  v_mfma_f32_16x16x32_bf16 a[124:127], a[188:191], v[188:191], a[124:127]
  s_cbranch_vccnz fa_stub17
fa_back17:
  v_exp_f32 v217, v145
  v_add_f32 v230, v230, v226
  v_add_f32 v231, v231, v227
fa_SSW5:
  v_mfma_f32_16x16x32_bf16 v[128:131], a[128:131], v[64:67], v[200:203]
  s_waitcnt vmcnt(12)
  v_exp_f32 v218, v146
  v_mfma_f32_16x16x32_bf16 v[136:139], a[128:131], v[68:71], v[204:207]
  s_barrier
  v_exp_f32 v219, v147
  v_mfma_f32_16x16x32_bf16 v[132:135], a[132:135], v[64:67], v[200:203]
  ds_read_b128 a[160:163], v3 offset:16384
  ds_read_b128 a[164:167], v3 offset:17408
  v_add_f32 v226, v216, v217
  v_mfma_f32_16x16x32_bf16 v[140:143], a[132:135], v[68:71], v[204:207]
  s_mov_b32 m0, s24
  v_exp_f32 v220, v148
  v_mfma_f32_16x16x32_bf16 v[128:131], a[136:139], v[72:75], v[128:131]
  ds_read_b128 a[168:171], v3 offset:18432
  buffer_load_dwordx4 v2, s[44:47], s26 offen offset:0 sc1 lds
  v_cvt_pk_bf16_f32 v184, v216, v217
  v_mfma_f32_16x16x32_bf16 v[136:139], a[136:139], v[76:79], v[136:139]
  v_exp_f32 v221, v149
  v_mfma_f32_16x16x32_bf16 v[132:135], a[140:143], v[72:75], v[132:135]
  ds_read_b128 a[172:175], v3 offset:19456
  v_add_f32 v226, v226, v218
  v_add_f32 v226, v226, v219
  v_mfma_f32_16x16x32_bf16 v[140:143], a[140:143], v[76:79], v[140:143]
  s_waitcnt lgkmcnt(4)
  v_exp_f32 v222, v150
  v_mfma_f32_16x16x32_bf16 v[128:131], a[144:147], v[80:83], v[128:131]
  s_add_u32 s14, s13, 16384
  ds_read_b128 a[176:179], v3 offset:20480
  buffer_load_dwordx4 a[200:203], v2, s[40:43], s14 offen offset:2048 sc1
  v_cvt_pk_bf16_f32 v185, v218, v219
  v_mfma_f32_16x16x32_bf16 v[136:139], a[144:147], v[84:87], v[136:139]
  v_exp_f32 v223, v151
  v_mfma_f32_16x16x32_bf16 v[132:135], a[148:151], v[80:83], v[132:135]
  ds_read_b128 a[180:183], v3 offset:21504
  buffer_load_dwordx4 v2, s[44:47], s26 offen offset:1024 sc1 lds
  v_add_f32 v226, v226, v220
  v_mfma_f32_16x16x32_bf16 v[140:143], a[148:151], v[84:87], v[140:143]
  v_exp_f32 v216, v152
  v_mfma_f32_16x16x32_bf16 v[128:131], a[152:155], v[88:91], v[128:131]
  ds_read_b128 a[184:187], v3 offset:22528
  v_add_f32 v226, v226, v221
  v_cvt_pk_bf16_f32 v186, v220, v221
  v_mfma_f32_16x16x32_bf16 v[136:139], a[152:155], v[92:95], v[136:139]
  v_exp_f32 v217, v153
  v_mfma_f32_16x16x32_bf16 v[132:135], a[156:159], v[88:91], v[132:135]
  ds_read_b128 a[188:191], v3 offset:23552
  buffer_load_dwordx4 a[204:207], v2, s[40:43], s14 offen offset:3072 sc1
  v_add_f32 v226, v226, v222
  v_mfma_f32_16x16x32_bf16 v[140:143], a[156:159], v[92:95], v[140:143]
  s_waitcnt lgkmcnt(4)
  v_exp_f32 v218, v154
  v_mfma_f32_16x16x32_bf16 a[64:67], a[160:163], v[176:179], a[64:67]
  ds_read_b128 a[128:131], v3 offset:0
  v_add_f32 v226, v226, v223
  v_cvt_pk_bf16_f32 v187, v222, v223
  v_mfma_f32_16x16x32_bf16 a[68:71], a[160:163], v[180:183], a[68:71]
  v_exp_f32 v219, v155
  v_mfma_f32_16x16x32_bf16 a[72:75], a[164:167], v[176:179], a[72:75]
  ds_read_b128 a[132:135], v3 offset:1024
  buffer_load_dwordx4 v2, s[44:47], s26 offen offset:2048 sc1 lds
  v_add_f32 v227, v216, v217
  v_mfma_f32_16x16x32_bf16 a[76:79], a[164:167], v[180:183], a[76:79]
  v_exp_f32 v220, v156
  v_mfma_f32_16x16x32_bf16 a[80:83], a[168:171], v[176:179], a[80:83]
  ds_read_b128 a[136:139], v3 offset:2048
  v_cvt_pk_bf16_f32 v188, v216, v217
  v_mfma_f32_16x16x32_bf16 a[84:87], a[168:171], v[180:183], a[84:87]
  v_exp_f32 v221, v157
  v_mfma_f32_16x16x32_bf16 a[88:91], a[172:175], v[176:179], a[88:91]
  s_add_u32 s14, s13, 20480
  ds_read_b128 a[140:143], v3 offset:3072
  buffer_load_dwordx4 a[208:211], v2, s[40:43], s14 offen offset:0 sc1
  v_add_f32 v227, v227, v218
  v_add_f32 v227, v227, v219
  v_mfma_f32_16x16x32_bf16 a[92:95], a[172:175], v[180:183], a[92:95]
  s_waitcnt lgkmcnt(4)
  v_exp_f32 v222, v158
  v_mfma_f32_16x16x32_bf16 a[96:99], a[176:179], v[176:179], a[96:99]
  ds_read_b128 a[144:147], v3 offset:4096
  buffer_load_dwordx4 v2, s[44:47], s26 offen offset:3072 sc1 lds
  v_cvt_pk_bf16_f32 v189, v218, v219
  v_mfma_f32_16x16x32_bf16 a[100:103], a[176:179], v[180:183], a[100:103]
  s_add_u32 s26, s26, 16384
  v_exp_f32 v223, v159
  v_mfma_f32_16x16x32_bf16 a[104:107], a[180:183], v[176:179], a[104:107]
  s_add_u32 s24, s24, 32768
  ds_read_b128 a[148:151], v3 offset:5120
  v_add_f32 v227, v227, v220
  v_mfma_f32_16x16x32_bf16 a[108:111], a[180:183], v[180:183], a[108:111]
  s_and_b32 s24, s24, 0x1ffff
  v_add_f32 v227, v227, v221
  v_cvt_pk_bf16_f32 v190, v220, v221
  v_add_f32 v227, v227, v222
  v_mfma_f32_16x16x32_bf16 a[112:115], a[184:187], v[176:179], a[112:115]
  ds_read_b128 a[152:155], v3 offset:6144
  v_add_f32 v227, v227, v223
  v_max_f32 v5, v226, v227
  v_cmp_lt_f32 vcc, s81, v5
  v_mfma_f32_16x16x32_bf16 a[116:119], a[184:187], v[180:183], a[116:119]
  v_exp_f32 v216, v128
  v_mfma_f32_16x16x32_bf16 a[120:123], a[188:191], v[176:179], a[120:123]
  s_waitcnt lgkmcnt(3)
  ds_read_b128 a[156:159], v3 offset:7168
  v_cvt_pk_bf16_f32 v191, v222, v223
  v_mfma_f32_16x16x32_bf16 a[124:127], a[188:191], v[180:183], a[124:127]
  s_cbranch_vccnz fa_stub18
fa_back18:
  v_exp_f32 v217, v129
  v_add_f32 v230, v230, v226
  v_add_f32 v231, v231, v227
  v_mfma_f32_16x16x32_bf16 v[144:147], a[128:131], v[64:67], v[200:203]
  ds_read_b128 a[160:163], v3 offset:24576
  v_add_f32 v226, v216, v217
  v_mfma_f32_16x16x32_bf16 v[152:155], a[128:131], v[68:71], v[204:207]
  v_exp_f32 v218, v130
  v_mfma_f32_16x16x32_bf16 v[148:151], a[132:135], v[64:67], v[200:203]
  s_add_u32 s66, s66, 32768
  ds_read_b128 a[164:167], v3 offset:25600
  v_cvt_pk_bf16_f32 v176, v216, v217
  v_mfma_f32_16x16x32_bf16 v[156:159], a[132:135], v[68:71], v[204:207]
  s_mov_b32 m0, s25
  v_exp_f32 v219, v131
  v_mfma_f32_16x16x32_bf16 v[144:147], a[136:139], v[72:75], v[144:147]
  s_and_b32 s66, s66, 0x1ffff
  ds_read_b128 a[168:171], v3 offset:26624
  buffer_load_dwordx4 v2, s[48:51], s27 offen offset:0 sc1 lds
  v_add_f32 v226, v226, v218
  v_add_f32 v226, v226, v219
  v_mfma_f32_16x16x32_bf16 v[152:155], a[136:139], v[76:79], v[152:155]
  v_exp_f32 v220, v132
  v_mfma_f32_16x16x32_bf16 v[148:151], a[140:143], v[72:75], v[148:151]
  ds_read_b128 a[172:175], v3 offset:27648
  v_cvt_pk_bf16_f32 v177, v218, v219
  v_mfma_f32_16x16x32_bf16 v[156:159], a[140:143], v[76:79], v[156:159]
  s_waitcnt lgkmcnt(4)
  v_exp_f32 v221, v133
  v_mfma_f32_16x16x32_bf16 v[144:147], a[144:147], v[80:83], v[144:147]
  s_add_u32 s14, s13, 20480
  ds_read_b128 a[176:179], v3 offset:28672
  buffer_load_dwordx4 a[212:215], v2, s[40:43], s14 offen offset:1024 sc1
  v_add_f32 v226, v226, v220
  v_mfma_f32_16x16x32_bf16 v[152:155], a[144:147], v[84:87], v[152:155]
  v_exp_f32 v222, v134
  v_mfma_f32_16x16x32_bf16 v[148:151], a[148:151], v[80:83], v[148:151]
  ds_read_b128 a[180:183], v3 offset:29696
  buffer_load_dwordx4 v2, s[48:51], s27 offen offset:1024 sc1 lds
  v_add_f32 v226, v226, v221
  v_cvt_pk_bf16_f32 v178, v220, v221
  v_mfma_f32_16x16x32_bf16 v[156:159], a[148:151], v[84:87], v[156:159]
  v_exp_f32 v223, v135
  v_mfma_f32_16x16x32_bf16 v[144:147], a[152:155], v[88:91], v[144:147]
  ds_read_b128 a[184:187], v3 offset:30720
  v_add_f32 v226, v226, v222
  v_mfma_f32_16x16x32_bf16 v[152:155], a[152:155], v[92:95], v[152:155]
  v_exp_f32 v216, v136
  v_mfma_f32_16x16x32_bf16 v[148:151], a[156:159], v[88:91], v[148:151]
  ds_read_b128 a[188:191], v3 offset:31744
  buffer_load_dwordx4 a[216:219], v2, s[40:43], s14 offen offset:2048 sc1
  v_add_f32 v226, v226, v223
  v_exp_f32 v217, v137
  v_mfma_f32_16x16x32_bf16 v[156:159], a[156:159], v[92:95], v[156:159]
  s_waitcnt lgkmcnt(4)
  v_exp_f32 v218, v138
  v_mfma_f32_16x16x32_bf16 a[64:67], a[160:163], v[184:187], a[64:67]
  ds_read_b128 a[128:131], v3 offset:8192
  v_cvt_pk_bf16_f32 v179, v222, v223
  v_mfma_f32_16x16x32_bf16 a[68:71], a[160:163], v[188:191], a[68:71]
  v_exp_f32 v219, v139
  v_mfma_f32_16x16x32_bf16 a[72:75], a[164:167], v[184:187], a[72:75]
  ds_read_b128 a[132:135], v3 offset:9216
  buffer_load_dwordx4 v2, s[48:51], s27 offen offset:2048 sc1 lds
  v_add_f32 v227, v216, v217
  v_mfma_f32_16x16x32_bf16 a[76:79], a[164:167], v[188:191], a[76:79]
  v_exp_f32 v220, v140
  v_mfma_f32_16x16x32_bf16 a[80:83], a[168:171], v[184:187], a[80:83]
  ds_read_b128 a[136:139], v3 offset:10240
  v_cvt_pk_bf16_f32 v180, v216, v217
  v_mfma_f32_16x16x32_bf16 a[84:87], a[168:171], v[188:191], a[84:87]
  v_exp_f32 v221, v141
  v_mfma_f32_16x16x32_bf16 a[88:91], a[172:175], v[184:187], a[88:91]
  ds_read_b128 a[140:143], v3 offset:11264
  buffer_load_dwordx4 a[220:223], v2, s[40:43], s14 offen offset:3072 sc1
  v_add_f32 v227, v227, v218
  v_mfma_f32_16x16x32_bf16 a[92:95], a[172:175], v[188:191], a[92:95]
  s_waitcnt lgkmcnt(4)
  v_exp_f32 v222, v142
  v_mfma_f32_16x16x32_bf16 a[96:99], a[176:179], v[184:187], a[96:99]
  ds_read_b128 a[144:147], v3 offset:12288
  buffer_load_dwordx4 v2, s[48:51], s27 offen offset:3072 sc1 lds
  v_add_f32 v227, v227, v219
  v_cvt_pk_bf16_f32 v181, v218, v219
  v_mfma_f32_16x16x32_bf16 a[100:103], a[176:179], v[188:191], a[100:103]
  s_add_u32 s27, s27, 16384
  v_exp_f32 v223, v143
  v_mfma_f32_16x16x32_bf16 a[104:107], a[180:183], v[184:187], a[104:107]
  s_add_u32 s25, s25, 32768
  ds_read_b128 a[148:151], v3 offset:13312
  v_add_f32 v227, v227, v220
  v_mfma_f32_16x16x32_bf16 a[108:111], a[180:183], v[188:191], a[108:111]
  s_and_b32 s25, s25, 0x1ffff
  v_add_f32 v227, v227, v221
  v_cvt_pk_bf16_f32 v182, v220, v221
  v_add_f32 v227, v227, v222
  v_mfma_f32_16x16x32_bf16 a[112:115], a[184:187], v[184:187], a[112:115]
  ds_read_b128 a[152:155], v3 offset:14336
  v_add_f32 v227, v227, v223
  v_max_f32 v5, v226, v227
  v_cmp_lt_f32 vcc, s81, v5
  v_mfma_f32_16x16x32_bf16 a[116:119], a[184:187], v[188:191], a[116:119]
  v_exp_f32 v216, v144
  v_mfma_f32_16x16x32_bf16 a[120:123], a[188:191], v[184:187], a[120:123]
  s_waitcnt lgkmcnt(3)
  ds_read_b128 a[156:159], v3 offset:15360
  v_cvt_pk_bf16_f32 v183, v222, v223
  v_add_u32 v3, s66, v2
  v_mfma_f32_16x16x32_bf16 a[124:127], a[188:191], v[188:191], a[124:127]
  s_cbranch_vccnz fa_stub19
fa_back19:
  v_exp_f32 v217, v145
  v_add_f32 v230, v230, v226
  v_add_f32 v231, v231, v227
fa_SSW4:
  v_mfma_f32_16x16x32_bf16 v[128:131], a[128:131], v[64:67], v[200:203]
  s_waitcnt vmcnt(12)
  v_exp_f32 v218, v146
  v_mfma_f32_16x16x32_bf16 v[136:139], a[128:131], v[68:71], v[204:207]
  s_barrier
  v_exp_f32 v219, v147
  v_mfma_f32_16x16x32_bf16 v[132:135], a[132:135], v[64:67], v[200:203]
  ds_read_b128 a[160:163], v3 offset:16384
  ds_read_b128 a[164:167], v3 offset:17408
  v_add_f32 v226, v216, v217
  v_mfma_f32_16x16x32_bf16 v[140:143], a[132:135], v[68:71], v[204:207]
  s_mov_b32 m0, s24
  v_exp_f32 v220, v148
  v_mfma_f32_16x16x32_bf16 v[128:131], a[136:139], v[72:75], v[128:131]
  ds_read_b128 a[168:171], v3 offset:18432
  buffer_load_dwordx4 v2, s[44:47], s26 offen offset:0 sc1 lds
  v_cvt_pk_bf16_f32 v184, v216, v217
  v_mfma_f32_16x16x32_bf16 v[136:139], a[136:139], v[76:79], v[136:139]
  v_exp_f32 v221, v149
  v_mfma_f32_16x16x32_bf16 v[132:135], a[140:143], v[72:75], v[132:135]
  ds_read_b128 a[172:175], v3 offset:19456
  v_add_f32 v226, v226, v218
  v_add_f32 v226, v226, v219
  v_mfma_f32_16x16x32_bf16 v[140:143], a[140:143], v[76:79], v[140:143]
  s_waitcnt lgkmcnt(4)
  v_exp_f32 v222, v150
  v_mfma_f32_16x16x32_bf16 v[128:131], a[144:147], v[80:83], v[128:131]
  s_add_u32 s14, s13, 24576
  ds_read_b128 a[176:179], v3 offset:20480
  buffer_load_dwordx4 a[224:227], v2, s[40:43], s14 offen offset:0 sc1
  v_cvt_pk_bf16_f32 v185, v218, v219
  v_mfma_f32_16x16x32_bf16 v[136:139], a[144:147], v[84:87], v[136:139]
  v_exp_f32 v223, v151
  v_mfma_f32_16x16x32_bf16 v[132:135], a[148:151], v[80:83], v[132:135]
  ds_read_b128 a[180:183], v3 offset:21504
  buffer_load_dwordx4 v2, s[44:47], s26 offen offset:1024 sc1 lds
  v_add_f32 v226, v226, v220
  v_mfma_f32_16x16x32_bf16 v[140:143], a[148:151], v[84:87], v[140:143]
  v_exp_f32 v216, v152
  v_mfma_f32_16x16x32_bf16 v[128:131], a[152:155], v[88:91], v[128:131]
  ds_read_b128 a[184:187], v3 offset:22528
  v_add_f32 v226, v226, v221
  v_cvt_pk_bf16_f32 v186, v220, v221
  v_mfma_f32_16x16x32_bf16 v[136:139], a[152:155], v[92:95], v[136:139]
  v_exp_f32 v217, v153
  v_mfma_f32_16x16x32_bf16 v[132:135], a[156:159], v[88:91], v[132:135]
  ds_read_b128 a[188:191], v3 offset:23552
  buffer_load_dwordx4 a[228:231], v2, s[40:43], s14 offen offset:1024 sc1
  v_add_f32 v226, v226, v222
  v_mfma_f32_16x16x32_bf16 v[140:143], a[156:159], v[92:95], v[140:143]
  s_waitcnt lgkmcnt(4)
  v_exp_f32 v218, v154
  v_mfma_f32_16x16x32_bf16 a[64:67], a[160:163], v[176:179], a[64:67]
  ds_read_b128 a[128:131], v3 offset:0
  v_add_f32 v226, v226, v223
  v_cvt_pk_bf16_f32 v187, v222, v223
  v_mfma_f32_16x16x32_bf16 a[68:71], a[160:163], v[180:183], a[68:71]
  v_exp_f32 v219, v155
  v_mfma_f32_16x16x32_bf16 a[72:75], a[164:167], v[176:179], a[72:75]
  ds_read_b128 a[132:135], v3 offset:1024
  buffer_load_dwordx4 v2, s[44:47], s26 offen offset:2048 sc1 lds
  v_add_f32 v227, v216, v217
  v_mfma_f32_16x16x32_bf16 a[76:79], a[164:167], v[180:183], a[76:79]
  v_exp_f32 v220, v156
  v_mfma_f32_16x16x32_bf16 a[80:83], a[168:171], v[176:179], a[80:83]
  ds_read_b128 a[136:139], v3 offset:2048
  v_cvt_pk_bf16_f32 v188, v216, v217
  v_mfma_f32_16x16x32_bf16 a[84:87], a[168:171], v[180:183], a[84:87]
  v_exp_f32 v221, v157
  v_mfma_f32_16x16x32_bf16 a[88:91], a[172:175], v[176:179], a[88:91]
  ds_read_b128 a[140:143], v3 offset:3072
  buffer_load_dwordx4 a[232:235], v2, s[40:43], s14 offen offset:2048 sc1
  v_add_f32 v227, v227, v218
  v_add_f32 v227, v227, v219
  v_mfma_f32_16x16x32_bf16 a[92:95], a[172:175], v[180:183], a[92:95]
  s_waitcnt lgkmcnt(4)
  v_exp_f32 v222, v158
  v_mfma_f32_16x16x32_bf16 a[96:99], a[176:179], v[176:179], a[96:99]
  ds_read_b128 a[144:147], v3 offset:4096
  buffer_load_dwordx4 v2, s[44:47], s26 offen offset:3072 sc1 lds
  v_cvt_pk_bf16_f32 v189, v218, v219
  v_mfma_f32_16x16x32_bf16 a[100:103], a[176:179], v[180:183], a[100:103]
  s_add_u32 s26, s26, 16384
  v_exp_f32 v223, v159
  v_mfma_f32_16x16x32_bf16 a[104:107], a[180:183], v[176:179], a[104:107]
  s_add_u32 s24, s24, 32768
  ds_read_b128 a[148:151], v3 offset:5120
  v_add_f32 v227, v227, v220
  v_mfma_f32_16x16x32_bf16 a[108:111], a[180:183], v[180:183], a[108:111]
  s_and_b32 s24, s24, 0x1ffff
  v_add_f32 v227, v227, v221
  v_cvt_pk_bf16_f32 v190, v220, v221
  v_add_f32 v227, v227, v222
  v_mfma_f32_16x16x32_bf16 a[112:115], a[184:187], v[176:179], a[112:115]
  ds_read_b128 a[152:155], v3 offset:6144
  v_add_f32 v227, v227, v223
  v_max_f32 v5, v226, v227
  v_cmp_lt_f32 vcc, s81, v5
  v_mfma_f32_16x16x32_bf16 a[116:119], a[184:187], v[180:183], a[116:119]
  v_exp_f32 v216, v128
  v_mfma_f32_16x16x32_bf16 a[120:123], a[188:191], v[176:179], a[120:123]
  s_waitcnt lgkmcnt(3)
  ds_read_b128 a[156:159], v3 offset:7168
  v_cvt_pk_bf16_f32 v191, v222, v223
  v_mfma_f32_16x16x32_bf16 a[124:127], a[188:191], v[180:183], a[124:127]
  s_cbranch_vccnz fa_stub20
fa_back20:
  v_exp_f32 v217, v129
  v_add_f32 v230, v230, v226
  v_add_f32 v231, v231, v227
  v_mfma_f32_16x16x32_bf16 v[144:147], a[128:131], v[64:67], v[200:203]
  ds_read_b128 a[160:163], v3 offset:24576
  v_add_f32 v226, v216, v217
  v_mfma_f32_16x16x32_bf16 v[152:155], a[128:131], v[68:71], v[204:207]
  v_exp_f32 v218, v130
  v_mfma_f32_16x16x32_bf16 v[148:151], a[132:135], v[64:67], v[200:203]
  s_add_u32 s66, s66, 32768
  ds_read_b128 a[164:167], v3 offset:25600
  v_cvt_pk_bf16_f32 v176, v216, v217
  v_mfma_f32_16x16x32_bf16 v[156:159], a[132:135], v[68:71], v[204:207]
  s_mov_b32 m0, s25
  v_exp_f32 v219, v131
  v_mfma_f32_16x16x32_bf16 v[144:147], a[136:139], v[72:75], v[144:147]
  s_and_b32 s66, s66, 0x1ffff
  ds_read_b128 a[168:171], v3 offset:26624
  buffer_load_dwordx4 v2, s[48:51], s27 offen offset:0 sc1 lds
  v_add_f32 v226, v226, v218
  v_add_f32 v226, v226, v219
  v_mfma_f32_16x16x32_bf16 v[152:155], a[136:139], v[76:79], v[152:155]
  v_exp_f32 v220, v132
  v_mfma_f32_16x16x32_bf16 v[148:151], a[140:143], v[72:75], v[148:151]
  ds_read_b128 a[172:175], v3 offset:27648
  v_cvt_pk_bf16_f32 v177, v218, v219
  v_mfma_f32_16x16x32_bf16 v[156:159], a[140:143], v[76:79], v[156:159]
  s_waitcnt lgkmcnt(4)
  v_exp_f32 v221, v133
  v_mfma_f32_16x16x32_bf16 v[144:147], a[144:147], v[80:83], v[144:147]
  s_add_u32 s14, s13, 24576
  ds_read_b128 a[176:179], v3 offset:28672
  buffer_load_dwordx4 a[236:239], v2, s[40:43], s14 offen offset:3072 sc1
  v_add_f32 v226, v226, v220
  v_mfma_f32_16x16x32_bf16 v[152:155], a[144:147], v[84:87], v[152:155]
  v_exp_f32 v222, v134
  v_mfma_f32_16x16x32_bf16 v[148:151], a[148:151], v[80:83], v[148:151]
  ds_read_b128 a[180:183], v3 offset:29696
  buffer_load_dwordx4 v2, s[48:51], s27 offen offset:1024 sc1 lds
  v_add_f32 v226, v226, v221
  v_cvt_pk_bf16_f32 v178, v220, v221
  v_mfma_f32_16x16x32_bf16 v[156:159], a[148:151], v[84:87], v[156:159]
  v_exp_f32 v223, v135
  v_mfma_f32_16x16x32_bf16 v[144:147], a[152:155], v[88:91], v[144:147]
  ds_read_b128 a[184:187], v3 offset:30720
  v_add_f32 v226, v226, v222
  v_mfma_f32_16x16x32_bf16 v[152:155], a[152:155], v[92:95], v[152:155]
  v_exp_f32 v216, v136
  v_mfma_f32_16x16x32_bf16 v[148:151], a[156:159], v[88:91], v[148:151]
  s_add_u32 s14, s13, 28672
  ds_read_b128 a[188:191], v3 offset:31744
  buffer_load_dwordx4 a[240:243], v2, s[40:43], s14 offen offset:0 sc1
  v_add_f32 v226, v226, v223
  v_exp_f32 v217, v137
  v_mfma_f32_16x16x32_bf16 v[156:159], a[156:159], v[92:95], v[156:159]
  s_waitcnt lgkmcnt(4)
  v_exp_f32 v218, v138
  v_mfma_f32_16x16x32_bf16 a[64:67], a[160:163], v[184:187], a[64:67]
  ds_read_b128 a[128:131], v3 offset:8192
  v_cvt_pk_bf16_f32 v179, v222, v223
  v_mfma_f32_16x16x32_bf16 a[68:71], a[160:163], v[188:191], a[68:71]
  v_exp_f32 v219, v139
  v_mfma_f32_16x16x32_bf16 a[72:75], a[164:167], v[184:187], a[72:75]
  ds_read_b128 a[132:135], v3 offset:9216
  buffer_load_dwordx4 v2, s[48:51], s27 offen offset:2048 sc1 lds
  v_add_f32 v227, v216, v217
  v_mfma_f32_16x16x32_bf16 a[76:79], a[164:167], v[188:191], a[76:79]
  v_exp_f32 v220, v140
  v_mfma_f32_16x16x32_bf16 a[80:83], a[168:171], v[184:187], a[80:83]
  ds_read_b128 a[136:139], v3 offset:10240
  v_cvt_pk_bf16_f32 v180, v216, v217
  v_mfma_f32_16x16x32_bf16 a[84:87], a[168:171], v[188:191], a[84:87]
  v_exp_f32 v221, v141
  v_mfma_f32_16x16x32_bf16 a[88:91], a[172:175], v[184:187], a[88:91]
  ds_read_b128 a[140:143], v3 offset:11264
  buffer_load_dwordx4 a[244:247], v2, s[40:43], s14 offen offset:1024 sc1
  v_add_f32 v227, v227, v218
  v_mfma_f32_16x16x32_bf16 a[92:95], a[172:175], v[188:191], a[92:95]
  s_waitcnt lgkmcnt(4)
  v_exp_f32 v222, v142
  v_mfma_f32_16x16x32_bf16 a[96:99], a[176:179], v[184:187], a[96:99]
  ds_read_b128 a[144:147], v3 offset:12288
  buffer_load_dwordx4 v2, s[48:51], s27 offen offset:3072 sc1 lds
  v_add_f32 v227, v227, v219
  v_cvt_pk_bf16_f32 v181, v218, v219
  v_mfma_f32_16x16x32_bf16 a[100:103], a[176:179], v[188:191], a[100:103]
  s_add_u32 s27, s27, 16384
  v_exp_f32 v223, v143
  v_mfma_f32_16x16x32_bf16 a[104:107], a[180:183], v[184:187], a[104:107]
  s_add_u32 s25, s25, 32768
  ds_read_b128 a[148:151], v3 offset:13312
  v_add_f32 v227, v227, v220
  v_mfma_f32_16x16x32_bf16 a[108:111], a[180:183], v[188:191], a[108:111]
  s_and_b32 s25, s25, 0x1ffff
  v_add_f32 v227, v227, v221
  v_cvt_pk_bf16_f32 v182, v220, v221
  v_add_f32 v227, v227, v222
  v_mfma_f32_16x16x32_bf16 a[112:115], a[184:187], v[184:187], a[112:115]
  ds_read_b128 a[152:155], v3 offset:14336
  v_add_f32 v227, v227, v223
  v_max_f32 v5, v226, v227
  v_cmp_lt_f32 vcc, s81, v5
  v_mfma_f32_16x16x32_bf16 a[116:119], a[184:187], v[188:191], a[116:119]
  v_exp_f32 v216, v144
  v_mfma_f32_16x16x32_bf16 a[120:123], a[188:191], v[184:187], a[120:123]
  s_waitcnt lgkmcnt(3)
  ds_read_b128 a[156:159], v3 offset:15360
  v_cvt_pk_bf16_f32 v183, v222, v223
  v_add_u32 v3, s66, v2
  v_mfma_f32_16x16x32_bf16 a[124:127], a[188:191], v[188:191], a[124:127]
  s_cbranch_vccnz fa_stub21
fa_back21:
  v_exp_f32 v217, v145
  v_add_f32 v230, v230, v226
  v_add_f32 v231, v231, v227
fa_SSW3:
  v_mfma_f32_16x16x32_bf16 v[128:131], a[128:131], v[64:67], v[200:203]
  s_waitcnt vmcnt(12)
  v_exp_f32 v218, v146
  v_mfma_f32_16x16x32_bf16 v[136:139], a[128:131], v[68:71], v[204:207]
  s_barrier
  v_exp_f32 v219, v147
  v_mfma_f32_16x16x32_bf16 v[132:135], a[132:135], v[64:67], v[200:203]
  ds_read_b128 a[160:163], v3 offset:16384
  ds_read_b128 a[164:167], v3 offset:17408
  v_add_f32 v226, v216, v217
  v_mfma_f32_16x16x32_bf16 v[140:143], a[132:135], v[68:71], v[204:207]
  s_mov_b32 m0, s24
  v_exp_f32 v220, v148
  v_mfma_f32_16x16x32_bf16 v[128:131], a[136:139], v[72:75], v[128:131]
  ds_read_b128 a[168:171], v3 offset:18432
  buffer_load_dwordx4 v2, s[44:47], s26 offen offset:0 sc1 lds
  v_cvt_pk_bf16_f32 v184, v216, v217
  v_mfma_f32_16x16x32_bf16 v[136:139], a[136:139], v[76:79], v[136:139]
  v_exp_f32 v221, v149
  v_mfma_f32_16x16x32_bf16 v[132:135], a[140:143], v[72:75], v[132:135]
  ds_read_b128 a[172:175], v3 offset:19456
  v_add_f32 v226, v226, v218
  v_add_f32 v226, v226, v219
  v_mfma_f32_16x16x32_bf16 v[140:143], a[140:143], v[76:79], v[140:143]
  s_waitcnt lgkmcnt(4)
  v_exp_f32 v222, v150
  v_mfma_f32_16x16x32_bf16 v[128:131], a[144:147], v[80:83], v[128:131]
  s_add_u32 s14, s13, 28672
  ds_read_b128 a[176:179], v3 offset:20480
  buffer_load_dwordx4 a[248:251], v2, s[40:43], s14 offen offset:2048 sc1
  v_cvt_pk_bf16_f32 v185, v218, v219
  v_mfma_f32_16x16x32_bf16 v[136:139], a[144:147], v[84:87], v[136:139]
  v_exp_f32 v223, v151
  v_mfma_f32_16x16x32_bf16 v[132:135], a[148:151], v[80:83], v[132:135]
  ds_read_b128 a[180:183], v3 offset:21504
  buffer_load_dwordx4 v2, s[44:47], s26 offen offset:1024 sc1 lds
  v_add_f32 v226, v226, v220
  v_mfma_f32_16x16x32_bf16 v[140:143], a[148:151], v[84:87], v[140:143]
  v_exp_f32 v216, v152
  v_mfma_f32_16x16x32_bf16 v[128:131], a[152:155], v[88:91], v[128:131]
  ds_read_b128 a[184:187], v3 offset:22528
  v_add_f32 v226, v226, v221
  v_cvt_pk_bf16_f32 v186, v220, v221
  v_mfma_f32_16x16x32_bf16 v[136:139], a[152:155], v[92:95], v[136:139]
  v_exp_f32 v217, v153
  v_mfma_f32_16x16x32_bf16 v[132:135], a[156:159], v[88:91], v[132:135]
  ds_read_b128 a[188:191], v3 offset:23552
  buffer_load_dwordx4 a[252:255], v2, s[40:43], s14 offen offset:3072 sc1
  v_add_f32 v226, v226, v222
  v_mfma_f32_16x16x32_bf16 v[140:143], a[156:159], v[92:95], v[140:143]
  s_waitcnt lgkmcnt(4)
  v_exp_f32 v218, v154
  v_mfma_f32_16x16x32_bf16 a[64:67], a[160:163], v[176:179], a[64:67]
  ds_read_b128 a[128:131], v3 offset:0
  v_add_f32 v226, v226, v223
  v_cvt_pk_bf16_f32 v187, v222, v223
  v_mfma_f32_16x16x32_bf16 a[68:71], a[160:163], v[180:183], a[68:71]
  v_exp_f32 v219, v155
  v_mfma_f32_16x16x32_bf16 a[72:75], a[164:167], v[176:179], a[72:75]
  ds_read_b128 a[132:135], v3 offset:1024
  buffer_load_dwordx4 v2, s[44:47], s26 offen offset:2048 sc1 lds
  v_add_f32 v227, v216, v217
  v_mfma_f32_16x16x32_bf16 a[76:79], a[164:167], v[180:183], a[76:79]
  v_exp_f32 v220, v156
  v_mfma_f32_16x16x32_bf16 a[80:83], a[168:171], v[176:179], a[80:83]
  ds_read_b128 a[136:139], v3 offset:2048
  v_cvt_pk_bf16_f32 v188, v216, v217
  v_mfma_f32_16x16x32_bf16 a[84:87], a[168:171], v[180:183], a[84:87]
  v_exp_f32 v221, v157
  v_mfma_f32_16x16x32_bf16 a[88:91], a[172:175], v[176:179], a[88:91]
  s_add_u32 s14, s13, 32768
  ds_read_b128 a[140:143], v3 offset:3072
  buffer_load_dwordx4 v[32:35], v2, s[40:43], s14 offen offset:0 sc1
  v_add_f32 v227, v227, v218
  v_add_f32 v227, v227, v219
  v_mfma_f32_16x16x32_bf16 a[92:95], a[172:175], v[180:183], a[92:95]
  s_waitcnt lgkmcnt(4)
  v_exp_f32 v222, v158
  v_mfma_f32_16x16x32_bf16 a[96:99], a[176:179], v[176:179], a[96:99]
  ds_read_b128 a[144:147], v3 offset:4096
  buffer_load_dwordx4 v2, s[44:47], s26 offen offset:3072 sc1 lds
  v_cvt_pk_bf16_f32 v189, v218, v219
  v_mfma_f32_16x16x32_bf16 a[100:103], a[176:179], v[180:183], a[100:103]
  s_add_u32 s26, s26, 16384
  v_exp_f32 v223, v159
  v_mfma_f32_16x16x32_bf16 a[104:107], a[180:183], v[176:179], a[104:107]
  s_add_u32 s24, s24, 32768
  ds_read_b128 a[148:151], v3 offset:5120
  v_add_f32 v227, v227, v220
  v_mfma_f32_16x16x32_bf16 a[108:111], a[180:183], v[180:183], a[108:111]
  s_and_b32 s24, s24, 0x1ffff
  v_add_f32 v227, v227, v221
  v_cvt_pk_bf16_f32 v190, v220, v221
  v_add_f32 v227, v227, v222
  v_mfma_f32_16x16x32_bf16 a[112:115], a[184:187], v[176:179], a[112:115]
  ds_read_b128 a[152:155], v3 offset:6144
  v_add_f32 v227, v227, v223
  v_max_f32 v5, v226, v227
  v_cmp_lt_f32 vcc, s81, v5
  v_mfma_f32_16x16x32_bf16 a[116:119], a[184:187], v[180:183], a[116:119]
  v_exp_f32 v216, v128
  v_mfma_f32_16x16x32_bf16 a[120:123], a[188:191], v[176:179], a[120:123]
  s_waitcnt lgkmcnt(3)
  ds_read_b128 a[156:159], v3 offset:7168
  v_cvt_pk_bf16_f32 v191, v222, v223
  v_mfma_f32_16x16x32_bf16 a[124:127], a[188:191], v[180:183], a[124:127]
  s_cbranch_vccnz fa_stub22
fa_back22:
  v_exp_f32 v217, v129
  v_add_f32 v230, v230, v226
  v_add_f32 v231, v231, v227
  v_mfma_f32_16x16x32_bf16 v[144:147], a[128:131], v[64:67], v[200:203]
  ds_read_b128 a[160:163], v3 offset:24576
  v_add_f32 v226, v216, v217
  v_mfma_f32_16x16x32_bf16 v[152:155], a[128:131], v[68:71], v[204:207]
  v_exp_f32 v218, v130
  v_mfma_f32_16x16x32_bf16 v[148:151], a[132:135], v[64:67], v[200:203]
  s_add_u32 s66, s66, 32768
  ds_read_b128 a[164:167], v3 offset:25600
  v_cvt_pk_bf16_f32 v176, v216, v217
  v_mfma_f32_16x16x32_bf16 v[156:159], a[132:135], v[68:71], v[204:207]
  s_mov_b32 m0, s25
  v_exp_f32 v219, v131
  v_mfma_f32_16x16x32_bf16 v[144:147], a[136:139], v[72:75], v[144:147]
  s_and_b32 s66, s66, 0x1ffff
  ds_read_b128 a[168:171], v3 offset:26624
  buffer_load_dwordx4 v2, s[48:51], s27 offen offset:0 sc1 lds
  v_add_f32 v226, v226, v218
  v_add_f32 v226, v226, v219
  v_mfma_f32_16x16x32_bf16 v[152:155], a[136:139], v[76:79], v[152:155]
  v_exp_f32 v220, v132
  v_mfma_f32_16x16x32_bf16 v[148:151], a[140:143], v[72:75], v[148:151]
  ds_read_b128 a[172:175], v3 offset:27648
  v_cvt_pk_bf16_f32 v177, v218, v219
  v_mfma_f32_16x16x32_bf16 v[156:159], a[140:143], v[76:79], v[156:159]
  s_waitcnt lgkmcnt(4)
  v_exp_f32 v221, v133
  v_mfma_f32_16x16x32_bf16 v[144:147], a[144:147], v[80:83], v[144:147]
  s_add_u32 s14, s13, 32768
  ds_read_b128 a[176:179], v3 offset:28672
  buffer_load_dwordx4 v[36:39], v2, s[40:43], s14 offen offset:1024 sc1
  v_add_f32 v226, v226, v220
  v_mfma_f32_16x16x32_bf16 v[152:155], a[144:147], v[84:87], v[152:155]
  v_exp_f32 v222, v134
  v_mfma_f32_16x16x32_bf16 v[148:151], a[148:151], v[80:83], v[148:151]
  ds_read_b128 a[180:183], v3 offset:29696
  buffer_load_dwordx4 v2, s[48:51], s27 offen offset:1024 sc1 lds
  v_add_f32 v226, v226, v221
  v_cvt_pk_bf16_f32 v178, v220, v221
  v_mfma_f32_16x16x32_bf16 v[156:159], a[148:151], v[84:87], v[156:159]
  v_exp_f32 v223, v135
  v_mfma_f32_16x16x32_bf16 v[144:147], a[152:155], v[88:91], v[144:147]
  ds_read_b128 a[184:187], v3 offset:30720
  v_add_f32 v226, v226, v222
  v_mfma_f32_16x16x32_bf16 v[152:155], a[152:155], v[92:95], v[152:155]
  v_exp_f32 v216, v136
  v_mfma_f32_16x16x32_bf16 v[148:151], a[156:159], v[88:91], v[148:151]
  ds_read_b128 a[188:191], v3 offset:31744
  buffer_load_dwordx4 v[40:43], v2, s[40:43], s14 offen offset:2048 sc1
  v_add_f32 v226, v226, v223
  v_exp_f32 v217, v137
  v_mfma_f32_16x16x32_bf16 v[156:159], a[156:159], v[92:95], v[156:159]
  s_waitcnt lgkmcnt(4)
  v_exp_f32 v218, v138
  v_mfma_f32_16x16x32_bf16 a[64:67], a[160:163], v[184:187], a[64:67]
  ds_read_b128 a[128:131], v3 offset:8192
  v_cvt_pk_bf16_f32 v179, v222, v223
  v_mfma_f32_16x16x32_bf16 a[68:71], a[160:163], v[188:191], a[68:71]
  v_exp_f32 v219, v139
  v_mfma_f32_16x16x32_bf16 a[72:75], a[164:167], v[184:187], a[72:75]
  ds_read_b128 a[132:135], v3 offset:9216
  buffer_load_dwordx4 v2, s[48:51], s27 offen offset:2048 sc1 lds
  v_add_f32 v227, v216, v217
  v_mfma_f32_16x16x32_bf16 a[76:79], a[164:167], v[188:191], a[76:79]
  v_exp_f32 v220, v140
  v_mfma_f32_16x16x32_bf16 a[80:83], a[168:171], v[184:187], a[80:83]
  ds_read_b128 a[136:139], v3 offset:10240
  v_cvt_pk_bf16_f32 v180, v216, v217
  v_mfma_f32_16x16x32_bf16 a[84:87], a[168:171], v[188:191], a[84:87]
  v_exp_f32 v221, v141
  v_mfma_f32_16x16x32_bf16 a[88:91], a[172:175], v[184:187], a[88:91]
  ds_read_b128 a[140:143], v3 offset:11264
  buffer_load_dwordx4 v[44:47], v2, s[40:43], s14 offen offset:3072 sc1
  v_add_f32 v227, v227, v218
  v_mfma_f32_16x16x32_bf16 a[92:95], a[172:175], v[188:191], a[92:95]
  s_waitcnt lgkmcnt(4)
  v_exp_f32 v222, v142
  v_mfma_f32_16x16x32_bf16 a[96:99], a[176:179], v[184:187], a[96:99]
  ds_read_b128 a[144:147], v3 offset:12288
  buffer_load_dwordx4 v2, s[48:51], s27 offen offset:3072 sc1 lds
  v_add_f32 v227, v227, v219
  v_cvt_pk_bf16_f32 v181, v218, v219
  v_mfma_f32_16x16x32_bf16 a[100:103], a[176:179], v[188:191], a[100:103]
  s_add_u32 s27, s27, 16384
  v_exp_f32 v223, v143
  v_mfma_f32_16x16x32_bf16 a[104:107], a[180:183], v[184:187], a[104:107]
  s_add_u32 s25, s25, 32768
  ds_read_b128 a[148:151], v3 offset:13312
  v_add_f32 v227, v227, v220
  v_mfma_f32_16x16x32_bf16 a[108:111], a[180:183], v[188:191], a[108:111]
  s_and_b32 s25, s25, 0x1ffff
  v_add_f32 v227, v227, v221
  v_cvt_pk_bf16_f32 v182, v220, v221
  v_add_f32 v227, v227, v222
  v_mfma_f32_16x16x32_bf16 a[112:115], a[184:187], v[184:187], a[112:115]
  ds_read_b128 a[152:155], v3 offset:14336
  v_add_f32 v227, v227, v223
  v_max_f32 v5, v226, v227
  v_cmp_lt_f32 vcc, s81, v5
  v_mfma_f32_16x16x32_bf16 a[116:119], a[184:187], v[188:191], a[116:119]
  v_exp_f32 v216, v144
  v_mfma_f32_16x16x32_bf16 a[120:123], a[188:191], v[184:187], a[120:123]
  s_waitcnt lgkmcnt(3)
  ds_read_b128 a[156:159], v3 offset:15360
  v_cvt_pk_bf16_f32 v183, v222, v223
  v_add_u32 v3, s66, v2
  v_mfma_f32_16x16x32_bf16 a[124:127], a[188:191], v[188:191], a[124:127]
  s_cbranch_vccnz fa_stub23
fa_back23:
  v_exp_f32 v217, v145
  v_add_f32 v230, v230, v226
  v_add_f32 v231, v231, v227
fa_SSW2:
  v_mfma_f32_16x16x32_bf16 v[128:131], a[128:131], v[64:67], v[200:203]
  s_waitcnt vmcnt(12)
  v_exp_f32 v218, v146
  v_mfma_f32_16x16x32_bf16 v[136:139], a[128:131], v[68:71], v[204:207]
  s_barrier
  v_exp_f32 v219, v147
  v_mfma_f32_16x16x32_bf16 v[132:135], a[132:135], v[64:67], v[200:203]
  ds_read_b128 a[160:163], v3 offset:16384
  ds_read_b128 a[164:167], v3 offset:17408
  v_add_f32 v226, v216, v217
  v_mfma_f32_16x16x32_bf16 v[140:143], a[132:135], v[68:71], v[204:207]
  s_mov_b32 m0, s24
  v_exp_f32 v220, v148
  v_mfma_f32_16x16x32_bf16 v[128:131], a[136:139], v[72:75], v[128:131]
  ds_read_b128 a[168:171], v3 offset:18432
  buffer_load_dwordx4 v2, s[44:47], s26 offen offset:0 sc1 lds
  v_cvt_pk_bf16_f32 v184, v216, v217
  v_mfma_f32_16x16x32_bf16 v[136:139], a[136:139], v[76:79], v[136:139]
  v_exp_f32 v221, v149
  v_mfma_f32_16x16x32_bf16 v[132:135], a[140:143], v[72:75], v[132:135]
  ds_read_b128 a[172:175], v3 offset:19456
  v_add_f32 v226, v226, v218
  v_add_f32 v226, v226, v219
  v_mfma_f32_16x16x32_bf16 v[140:143], a[140:143], v[76:79], v[140:143]
  s_waitcnt lgkmcnt(4)
  v_exp_f32 v222, v150
  v_mfma_f32_16x16x32_bf16 v[128:131], a[144:147], v[80:83], v[128:131]
  s_add_u32 s14, s13, 36864
  ds_read_b128 a[176:179], v3 offset:20480
  buffer_load_dwordx4 v[48:51], v2, s[40:43], s14 offen offset:0 sc1
  v_cvt_pk_bf16_f32 v185, v218, v219
  v_mfma_f32_16x16x32_bf16 v[136:139], a[144:147], v[84:87], v[136:139]
  v_exp_f32 v223, v151
  v_mfma_f32_16x16x32_bf16 v[132:135], a[148:151], v[80:83], v[132:135]
  ds_read_b128 a[180:183], v3 offset:21504
  buffer_load_dwordx4 v2, s[44:47], s26 offen offset:1024 sc1 lds
  v_add_f32 v226, v226, v220
  v_mfma_f32_16x16x32_bf16 v[140:143], a[148:151], v[84:87], v[140:143]
  v_exp_f32 v216, v152
  v_mfma_f32_16x16x32_bf16 v[128:131], a[152:155], v[88:91], v[128:131]
  ds_read_b128 a[184:187], v3 offset:22528
  v_add_f32 v226, v226, v221
  v_cvt_pk_bf16_f32 v186, v220, v221
  v_mfma_f32_16x16x32_bf16 v[136:139], a[152:155], v[92:95], v[136:139]
  v_exp_f32 v217, v153
  v_mfma_f32_16x16x32_bf16 v[132:135], a[156:159], v[88:91], v[132:135]
  ds_read_b128 a[188:191], v3 offset:23552
  buffer_load_dwordx4 v[52:55], v2, s[40:43], s14 offen offset:1024 sc1
  v_add_f32 v226, v226, v222
  v_mfma_f32_16x16x32_bf16 v[140:143], a[156:159], v[92:95], v[140:143]
  s_waitcnt lgkmcnt(4)
  v_exp_f32 v218, v154
  v_mfma_f32_16x16x32_bf16 a[64:67], a[160:163], v[176:179], a[64:67]
  ds_read_b128 a[128:131], v3 offset:0
  v_add_f32 v226, v226, v223
  v_cvt_pk_bf16_f32 v187, v222, v223
  v_mfma_f32_16x16x32_bf16 a[68:71], a[160:163], v[180:183], a[68:71]
  v_exp_f32 v219, v155
  v_mfma_f32_16x16x32_bf16 a[72:75], a[164:167], v[176:179], a[72:75]
  ds_read_b128 a[132:135], v3 offset:1024
  buffer_load_dwordx4 v2, s[44:47], s26 offen offset:2048 sc1 lds
  v_add_f32 v227, v216, v217
  v_mfma_f32_16x16x32_bf16 a[76:79], a[164:167], v[180:183], a[76:79]
  v_exp_f32 v220, v156
  v_mfma_f32_16x16x32_bf16 a[80:83], a[168:171], v[176:179], a[80:83]
  ds_read_b128 a[136:139], v3 offset:2048
  v_cvt_pk_bf16_f32 v188, v216, v217
  v_mfma_f32_16x16x32_bf16 a[84:87], a[168:171], v[180:183], a[84:87]
  v_exp_f32 v221, v157
  v_mfma_f32_16x16x32_bf16 a[88:91], a[172:175], v[176:179], a[88:91]
  ds_read_b128 a[140:143], v3 offset:3072
  buffer_load_dwordx4 v[56:59], v2, s[40:43], s14 offen offset:2048 sc1
  v_add_f32 v227, v227, v218
  v_add_f32 v227, v227, v219
  v_mfma_f32_16x16x32_bf16 a[92:95], a[172:175], v[180:183], a[92:95]
  s_waitcnt lgkmcnt(4)
  v_exp_f32 v222, v158
  v_mfma_f32_16x16x32_bf16 a[96:99], a[176:179], v[176:179], a[96:99]
  ds_read_b128 a[144:147], v3 offset:4096
  buffer_load_dwordx4 v2, s[44:47], s26 offen offset:3072 sc1 lds
  v_cvt_pk_bf16_f32 v189, v218, v219
  v_mfma_f32_16x16x32_bf16 a[100:103], a[176:179], v[180:183], a[100:103]
  s_add_u32 s26, s26, 16384
  v_exp_f32 v223, v159
  v_mfma_f32_16x16x32_bf16 a[104:107], a[180:183], v[176:179], a[104:107]
  s_add_u32 s24, s24, 32768
  ds_read_b128 a[148:151], v3 offset:5120
  v_add_f32 v227, v227, v220
  v_mfma_f32_16x16x32_bf16 a[108:111], a[180:183], v[180:183], a[108:111]
  s_and_b32 s24, s24, 0x1ffff
  v_add_f32 v227, v227, v221
  v_cvt_pk_bf16_f32 v190, v220, v221
  v_add_f32 v227, v227, v222
  v_mfma_f32_16x16x32_bf16 a[112:115], a[184:187], v[176:179], a[112:115]
  ds_read_b128 a[152:155], v3 offset:6144
  v_add_f32 v227, v227, v223
  v_max_f32 v5, v226, v227
  v_cmp_lt_f32 vcc, s81, v5
  v_mfma_f32_16x16x32_bf16 a[116:119], a[184:187], v[180:183], a[116:119]
  v_exp_f32 v216, v128
  v_mfma_f32_16x16x32_bf16 a[120:123], a[188:191], v[176:179], a[120:123]
  s_waitcnt lgkmcnt(3)
  ds_read_b128 a[156:159], v3 offset:7168
  v_cvt_pk_bf16_f32 v191, v222, v223
  v_mfma_f32_16x16x32_bf16 a[124:127], a[188:191], v[180:183], a[124:127]
  s_cbranch_vccnz fa_stub24
fa_back24:
  v_exp_f32 v217, v129
  v_add_f32 v230, v230, v226
  v_add_f32 v231, v231, v227
  v_mfma_f32_16x16x32_bf16 v[144:147], a[128:131], v[64:67], v[200:203]
  ds_read_b128 a[160:163], v3 offset:24576
  v_add_f32 v226, v216, v217
  v_mfma_f32_16x16x32_bf16 v[152:155], a[128:131], v[68:71], v[204:207]
  v_exp_f32 v218, v130
  v_mfma_f32_16x16x32_bf16 v[148:151], a[132:135], v[64:67], v[200:203]
  s_add_u32 s66, s66, 32768
  ds_read_b128 a[164:167], v3 offset:25600
  v_cvt_pk_bf16_f32 v176, v216, v217
  v_mfma_f32_16x16x32_bf16 v[156:159], a[132:135], v[68:71], v[204:207]
  s_mov_b32 m0, s25
  v_exp_f32 v219, v131
  v_mfma_f32_16x16x32_bf16 v[144:147], a[136:139], v[72:75], v[144:147]
  s_and_b32 s66, s66, 0x1ffff
  ds_read_b128 a[168:171], v3 offset:26624
  buffer_load_dwordx4 v2, s[48:51], s27 offen offset:0 sc1 lds
  v_add_f32 v226, v226, v218
  v_add_f32 v226, v226, v219
  v_mfma_f32_16x16x32_bf16 v[152:155], a[136:139], v[76:79], v[152:155]
  v_exp_f32 v220, v132
  v_mfma_f32_16x16x32_bf16 v[148:151], a[140:143], v[72:75], v[148:151]
  ds_read_b128 a[172:175], v3 offset:27648
  v_cvt_pk_bf16_f32 v177, v218, v219
  v_mfma_f32_16x16x32_bf16 v[156:159], a[140:143], v[76:79], v[156:159]
  s_waitcnt lgkmcnt(4)
  v_exp_f32 v221, v133
  v_mfma_f32_16x16x32_bf16 v[144:147], a[144:147], v[80:83], v[144:147]
  s_add_u32 s14, s13, 36864
  ds_read_b128 a[176:179], v3 offset:28672
  buffer_load_dwordx4 v[60:63], v2, s[40:43], s14 offen offset:3072 sc1
  v_add_f32 v226, v226, v220
  v_mfma_f32_16x16x32_bf16 v[152:155], a[144:147], v[84:87], v[152:155]
  v_exp_f32 v222, v134
  v_mfma_f32_16x16x32_bf16 v[148:151], a[148:151], v[80:83], v[148:151]
  ds_read_b128 a[180:183], v3 offset:29696
  buffer_load_dwordx4 v2, s[48:51], s27 offen offset:1024 sc1 lds
  v_add_f32 v226, v226, v221
  v_cvt_pk_bf16_f32 v178, v220, v221
  v_mfma_f32_16x16x32_bf16 v[156:159], a[148:151], v[84:87], v[156:159]
  v_exp_f32 v223, v135
  v_mfma_f32_16x16x32_bf16 v[144:147], a[152:155], v[88:91], v[144:147]
  ds_read_b128 a[184:187], v3 offset:30720
  v_add_f32 v226, v226, v222
  v_mfma_f32_16x16x32_bf16 v[152:155], a[152:155], v[92:95], v[152:155]
  v_exp_f32 v216, v136
  v_mfma_f32_16x16x32_bf16 v[148:151], a[156:159], v[88:91], v[148:151]
  s_add_u32 s14, s13, 40960
  ds_read_b128 a[188:191], v3 offset:31744
  buffer_load_dwordx4 v[96:99], v2, s[40:43], s14 offen offset:0 sc1
  v_add_f32 v226, v226, v223
  v_exp_f32 v217, v137
  v_mfma_f32_16x16x32_bf16 v[156:159], a[156:159], v[92:95], v[156:159]
  s_waitcnt lgkmcnt(4)
  v_exp_f32 v218, v138
  v_mfma_f32_16x16x32_bf16 a[64:67], a[160:163], v[184:187], a[64:67]
  ds_read_b128 a[128:131], v3 offset:8192
  v_cvt_pk_bf16_f32 v179, v222, v223
  v_mfma_f32_16x16x32_bf16 a[68:71], a[160:163], v[188:191], a[68:71]
  v_exp_f32 v219, v139
  v_mfma_f32_16x16x32_bf16 a[72:75], a[164:167], v[184:187], a[72:75]
  ds_read_b128 a[132:135], v3 offset:9216
  buffer_load_dwordx4 v2, s[48:51], s27 offen offset:2048 sc1 lds
  v_add_f32 v227, v216, v217
  v_mfma_f32_16x16x32_bf16 a[76:79], a[164:167], v[188:191], a[76:79]
  v_exp_f32 v220, v140
  v_mfma_f32_16x16x32_bf16 a[80:83], a[168:171], v[184:187], a[80:83]
  ds_read_b128 a[136:139], v3 offset:10240
  v_cvt_pk_bf16_f32 v180, v216, v217
  v_mfma_f32_16x16x32_bf16 a[84:87], a[168:171], v[188:191], a[84:87]
  v_exp_f32 v221, v141
  v_mfma_f32_16x16x32_bf16 a[88:91], a[172:175], v[184:187], a[88:91]
  ds_read_b128 a[140:143], v3 offset:11264
  buffer_load_dwordx4 v[100:103], v2, s[40:43], s14 offen offset:1024 sc1
  v_add_f32 v227, v227, v218
  v_mfma_f32_16x16x32_bf16 a[92:95], a[172:175], v[188:191], a[92:95]
  s_waitcnt lgkmcnt(4)
  v_exp_f32 v222, v142
  v_mfma_f32_16x16x32_bf16 a[96:99], a[176:179], v[184:187], a[96:99]
  ds_read_b128 a[144:147], v3 offset:12288
  buffer_load_dwordx4 v2, s[48:51], s27 offen offset:3072 sc1 lds
  v_add_f32 v227, v227, v219
  v_cvt_pk_bf16_f32 v181, v218, v219
  v_mfma_f32_16x16x32_bf16 a[100:103], a[176:179], v[188:191], a[100:103]
  s_add_u32 s27, s27, 16384
  v_exp_f32 v223, v143
  v_mfma_f32_16x16x32_bf16 a[104:107], a[180:183], v[184:187], a[104:107]
  s_add_u32 s25, s25, 32768
  ds_read_b128 a[148:151], v3 offset:13312
  v_add_f32 v227, v227, v220
  v_mfma_f32_16x16x32_bf16 a[108:111], a[180:183], v[188:191], a[108:111]
  s_and_b32 s25, s25, 0x1ffff
  v_add_f32 v227, v227, v221
  v_cvt_pk_bf16_f32 v182, v220, v221
  v_add_f32 v227, v227, v222
  v_mfma_f32_16x16x32_bf16 a[112:115], a[184:187], v[184:187], a[112:115]
  ds_read_b128 a[152:155], v3 offset:14336
  v_add_f32 v227, v227, v223
  v_max_f32 v5, v226, v227
  v_cmp_lt_f32 vcc, s81, v5
  v_mfma_f32_16x16x32_bf16 a[116:119], a[184:187], v[188:191], a[116:119]
  v_exp_f32 v216, v144
  v_mfma_f32_16x16x32_bf16 a[120:123], a[188:191], v[184:187], a[120:123]
  s_waitcnt lgkmcnt(3)
  ds_read_b128 a[156:159], v3 offset:15360
  v_cvt_pk_bf16_f32 v183, v222, v223
  v_add_u32 v3, s66, v2
  v_mfma_f32_16x16x32_bf16 a[124:127], a[188:191], v[188:191], a[124:127]
  s_cbranch_vccnz fa_stub25
fa_back25:
  v_exp_f32 v217, v145
  v_add_f32 v230, v230, v226
  v_add_f32 v231, v231, v227
fa_SSW1:
  v_mfma_f32_16x16x32_bf16 v[128:131], a[128:131], v[64:67], v[200:203]
  s_waitcnt vmcnt(12)
  v_exp_f32 v218, v146
  v_mfma_f32_16x16x32_bf16 v[136:139], a[128:131], v[68:71], v[204:207]
  s_barrier
  v_exp_f32 v219, v147
  v_mfma_f32_16x16x32_bf16 v[132:135], a[132:135], v[64:67], v[200:203]
  ds_read_b128 a[160:163], v3 offset:16384
  ds_read_b128 a[164:167], v3 offset:17408
  v_add_f32 v226, v216, v217
  v_mfma_f32_16x16x32_bf16 v[140:143], a[132:135], v[68:71], v[204:207]
  s_mov_b32 m0, s24
  v_exp_f32 v220, v148
  v_mfma_f32_16x16x32_bf16 v[128:131], a[136:139], v[72:75], v[128:131]
  ds_read_b128 a[168:171], v3 offset:18432
  buffer_load_dwordx4 v2, s[44:47], s26 offen offset:0 sc1 lds
  v_cvt_pk_bf16_f32 v184, v216, v217
  v_mfma_f32_16x16x32_bf16 v[136:139], a[136:139], v[76:79], v[136:139]
  v_exp_f32 v221, v149
  v_mfma_f32_16x16x32_bf16 v[132:135], a[140:143], v[72:75], v[132:135]
  ds_read_b128 a[172:175], v3 offset:19456
  v_add_f32 v226, v226, v218
  v_add_f32 v226, v226, v219
  v_mfma_f32_16x16x32_bf16 v[140:143], a[140:143], v[76:79], v[140:143]
  s_waitcnt lgkmcnt(4)
  v_exp_f32 v222, v150
  v_mfma_f32_16x16x32_bf16 v[128:131], a[144:147], v[80:83], v[128:131]
  s_add_u32 s14, s13, 40960
  ds_read_b128 a[176:179], v3 offset:20480
  buffer_load_dwordx4 v[104:107], v2, s[40:43], s14 offen offset:2048 sc1
  v_cvt_pk_bf16_f32 v185, v218, v219
  v_mfma_f32_16x16x32_bf16 v[136:139], a[144:147], v[84:87], v[136:139]
  v_exp_f32 v223, v151
  v_mfma_f32_16x16x32_bf16 v[132:135], a[148:151], v[80:83], v[132:135]
  ds_read_b128 a[180:183], v3 offset:21504
  buffer_load_dwordx4 v2, s[44:47], s26 offen offset:1024 sc1 lds
  v_add_f32 v226, v226, v220
  v_mfma_f32_16x16x32_bf16 v[140:143], a[148:151], v[84:87], v[140:143]
  v_exp_f32 v216, v152
  v_mfma_f32_16x16x32_bf16 v[128:131], a[152:155], v[88:91], v[128:131]
  ds_read_b128 a[184:187], v3 offset:22528
  v_add_f32 v226, v226, v221
  v_cvt_pk_bf16_f32 v186, v220, v221
  v_mfma_f32_16x16x32_bf16 v[136:139], a[152:155], v[92:95], v[136:139]
  v_exp_f32 v217, v153
  v_mfma_f32_16x16x32_bf16 v[132:135], a[156:159], v[88:91], v[132:135]
  ds_read_b128 a[188:191], v3 offset:23552
  buffer_load_dwordx4 v[108:111], v2, s[40:43], s14 offen offset:3072 sc1
  v_add_f32 v226, v226, v222
  v_mfma_f32_16x16x32_bf16 v[140:143], a[156:159], v[92:95], v[140:143]
  s_waitcnt lgkmcnt(4)
  v_exp_f32 v218, v154
  v_mfma_f32_16x16x32_bf16 a[64:67], a[160:163], v[176:179], a[64:67]
  ds_read_b128 a[128:131], v3 offset:0
  v_add_f32 v226, v226, v223
  v_cvt_pk_bf16_f32 v187, v222, v223
  v_mfma_f32_16x16x32_bf16 a[68:71], a[160:163], v[180:183], a[68:71]
  v_exp_f32 v219, v155
  v_mfma_f32_16x16x32_bf16 a[72:75], a[164:167], v[176:179], a[72:75]
  ds_read_b128 a[132:135], v3 offset:1024
  buffer_load_dwordx4 v2, s[44:47], s26 offen offset:2048 sc1 lds
  v_add_f32 v227, v216, v217
  v_mfma_f32_16x16x32_bf16 a[76:79], a[164:167], v[180:183], a[76:79]
  v_exp_f32 v220, v156
  v_mfma_f32_16x16x32_bf16 a[80:83], a[168:171], v[176:179], a[80:83]
  ds_read_b128 a[136:139], v3 offset:2048
  v_cvt_pk_bf16_f32 v188, v216, v217
  v_mfma_f32_16x16x32_bf16 a[84:87], a[168:171], v[180:183], a[84:87]
  v_exp_f32 v221, v157
  v_mfma_f32_16x16x32_bf16 a[88:91], a[172:175], v[176:179], a[88:91]
  s_add_u32 s14, s13, 45056
  ds_read_b128 a[140:143], v3 offset:3072
  buffer_load_dwordx4 v[112:115], v2, s[40:43], s14 offen offset:0 sc1
  v_add_f32 v227, v227, v218
  v_add_f32 v227, v227, v219
  v_mfma_f32_16x16x32_bf16 a[92:95], a[172:175], v[180:183], a[92:95]
  s_waitcnt lgkmcnt(4)
  v_exp_f32 v222, v158
  v_mfma_f32_16x16x32_bf16 a[96:99], a[176:179], v[176:179], a[96:99]
  ds_read_b128 a[144:147], v3 offset:4096
  buffer_load_dwordx4 v2, s[44:47], s26 offen offset:3072 sc1 lds
  v_cvt_pk_bf16_f32 v189, v218, v219
  v_mfma_f32_16x16x32_bf16 a[100:103], a[176:179], v[180:183], a[100:103]
  s_add_u32 s26, s26, 16384
  v_exp_f32 v223, v159
  v_mfma_f32_16x16x32_bf16 a[104:107], a[180:183], v[176:179], a[104:107]
  s_add_u32 s24, s24, 32768
  ds_read_b128 a[148:151], v3 offset:5120
  v_add_f32 v227, v227, v220
  v_mfma_f32_16x16x32_bf16 a[108:111], a[180:183], v[180:183], a[108:111]
  s_and_b32 s24, s24, 0x1ffff
  v_add_f32 v227, v227, v221
  v_cvt_pk_bf16_f32 v190, v220, v221
  v_add_f32 v227, v227, v222
  v_mfma_f32_16x16x32_bf16 a[112:115], a[184:187], v[176:179], a[112:115]
  ds_read_b128 a[152:155], v3 offset:6144
  v_add_f32 v227, v227, v223
  v_max_f32 v5, v226, v227
  v_cmp_lt_f32 vcc, s81, v5
  v_mfma_f32_16x16x32_bf16 a[116:119], a[184:187], v[180:183], a[116:119]
  v_exp_f32 v216, v128
  v_mfma_f32_16x16x32_bf16 a[120:123], a[188:191], v[176:179], a[120:123]
  s_waitcnt lgkmcnt(3)
  ds_read_b128 a[156:159], v3 offset:7168
  v_cvt_pk_bf16_f32 v191, v222, v223
  v_mfma_f32_16x16x32_bf16 a[124:127], a[188:191], v[180:183], a[124:127]
  s_cbranch_vccnz fa_stub26
fa_back26:
  v_exp_f32 v217, v129
  v_add_f32 v230, v230, v226
  v_add_f32 v231, v231, v227
  v_mfma_f32_16x16x32_bf16 v[144:147], a[128:131], v[64:67], v[200:203]
  ds_read_b128 a[160:163], v3 offset:24576
  v_add_f32 v226, v216, v217
  v_mfma_f32_16x16x32_bf16 v[152:155], a[128:131], v[68:71], v[204:207]
  v_exp_f32 v218, v130
  v_mfma_f32_16x16x32_bf16 v[148:151], a[132:135], v[64:67], v[200:203]
  s_add_u32 s66, s66, 32768
  ds_read_b128 a[164:167], v3 offset:25600
  v_cvt_pk_bf16_f32 v176, v216, v217
  v_mfma_f32_16x16x32_bf16 v[156:159], a[132:135], v[68:71], v[204:207]
  s_mov_b32 m0, s25
  v_exp_f32 v219, v131
  v_mfma_f32_16x16x32_bf16 v[144:147], a[136:139], v[72:75], v[144:147]
  s_and_b32 s66, s66, 0x1ffff
  ds_read_b128 a[168:171], v3 offset:26624
  buffer_load_dwordx4 v2, s[48:51], s27 offen offset:0 sc1 lds
  v_add_f32 v226, v226, v218
  v_add_f32 v226, v226, v219
  v_mfma_f32_16x16x32_bf16 v[152:155], a[136:139], v[76:79], v[152:155]
  v_exp_f32 v220, v132
  v_mfma_f32_16x16x32_bf16 v[148:151], a[140:143], v[72:75], v[148:151]
  ds_read_b128 a[172:175], v3 offset:27648
  v_cvt_pk_bf16_f32 v177, v218, v219
  v_mfma_f32_16x16x32_bf16 v[156:159], a[140:143], v[76:79], v[156:159]
  s_waitcnt lgkmcnt(4)
  v_exp_f32 v221, v133
  v_mfma_f32_16x16x32_bf16 v[144:147], a[144:147], v[80:83], v[144:147]
  s_add_u32 s14, s13, 45056
  ds_read_b128 a[176:179], v3 offset:28672
  buffer_load_dwordx4 v[116:119], v2, s[40:43], s14 offen offset:1024 sc1
  v_add_f32 v226, v226, v220
  v_mfma_f32_16x16x32_bf16 v[152:155], a[144:147], v[84:87], v[152:155]
  v_exp_f32 v222, v134
  v_mfma_f32_16x16x32_bf16 v[148:151], a[148:151], v[80:83], v[148:151]
  ds_read_b128 a[180:183], v3 offset:29696
  buffer_load_dwordx4 v2, s[48:51], s27 offen offset:1024 sc1 lds
  v_add_f32 v226, v226, v221
  v_cvt_pk_bf16_f32 v178, v220, v221
  v_mfma_f32_16x16x32_bf16 v[156:159], a[148:151], v[84:87], v[156:159]
  v_exp_f32 v223, v135
  v_mfma_f32_16x16x32_bf16 v[144:147], a[152:155], v[88:91], v[144:147]
  ds_read_b128 a[184:187], v3 offset:30720
  v_add_f32 v226, v226, v222
  v_mfma_f32_16x16x32_bf16 v[152:155], a[152:155], v[92:95], v[152:155]
  v_exp_f32 v216, v136
  v_mfma_f32_16x16x32_bf16 v[148:151], a[156:159], v[88:91], v[148:151]
  ds_read_b128 a[188:191], v3 offset:31744
  buffer_load_dwordx4 v[120:123], v2, s[40:43], s14 offen offset:2048 sc1
  v_add_f32 v226, v226, v223
  v_exp_f32 v217, v137
  v_mfma_f32_16x16x32_bf16 v[156:159], a[156:159], v[92:95], v[156:159]
  s_waitcnt lgkmcnt(4)
  v_exp_f32 v218, v138
  v_mfma_f32_16x16x32_bf16 a[64:67], a[160:163], v[184:187], a[64:67]
  ds_read_b128 a[128:131], v3 offset:8192
  v_cvt_pk_bf16_f32 v179, v222, v223
  v_mfma_f32_16x16x32_bf16 a[68:71], a[160:163], v[188:191], a[68:71]
  v_exp_f32 v219, v139
  v_mfma_f32_16x16x32_bf16 a[72:75], a[164:167], v[184:187], a[72:75]
  ds_read_b128 a[132:135], v3 offset:9216
  buffer_load_dwordx4 v2, s[48:51], s27 offen offset:2048 sc1 lds
  v_add_f32 v227, v216, v217
  v_mfma_f32_16x16x32_bf16 a[76:79], a[164:167], v[188:191], a[76:79]
  v_exp_f32 v220, v140
  v_mfma_f32_16x16x32_bf16 a[80:83], a[168:171], v[184:187], a[80:83]
  ds_read_b128 a[136:139], v3 offset:10240
  v_cvt_pk_bf16_f32 v180, v216, v217
  v_mfma_f32_16x16x32_bf16 a[84:87], a[168:171], v[188:191], a[84:87]
  v_exp_f32 v221, v141
  v_mfma_f32_16x16x32_bf16 a[88:91], a[172:175], v[184:187], a[88:91]
  ds_read_b128 a[140:143], v3 offset:11264
  buffer_load_dwordx4 v[124:127], v2, s[40:43], s14 offen offset:3072 sc1
  v_add_f32 v227, v227, v218
  v_mfma_f32_16x16x32_bf16 a[92:95], a[172:175], v[188:191], a[92:95]
  s_waitcnt lgkmcnt(4)
  v_exp_f32 v222, v142
  v_mfma_f32_16x16x32_bf16 a[96:99], a[176:179], v[184:187], a[96:99]
  ds_read_b128 a[144:147], v3 offset:12288
  buffer_load_dwordx4 v2, s[48:51], s27 offen offset:3072 sc1 lds
  v_add_f32 v227, v227, v219
  v_cvt_pk_bf16_f32 v181, v218, v219
  v_mfma_f32_16x16x32_bf16 a[100:103], a[176:179], v[188:191], a[100:103]
  s_add_u32 s27, s27, 16384
  v_exp_f32 v223, v143
  v_mfma_f32_16x16x32_bf16 a[104:107], a[180:183], v[184:187], a[104:107]
  s_add_u32 s25, s25, 32768
  ds_read_b128 a[148:151], v3 offset:13312
  v_add_f32 v227, v227, v220
  v_mfma_f32_16x16x32_bf16 a[108:111], a[180:183], v[188:191], a[108:111]
  s_and_b32 s25, s25, 0x1ffff
  v_add_f32 v227, v227, v221
  v_cvt_pk_bf16_f32 v182, v220, v221
  v_add_f32 v227, v227, v222
  v_mfma_f32_16x16x32_bf16 a[112:115], a[184:187], v[184:187], a[112:115]
  ds_read_b128 a[152:155], v3 offset:14336
  v_add_f32 v227, v227, v223
  v_max_f32 v5, v226, v227
  v_cmp_lt_f32 vcc, s81, v5
  v_mfma_f32_16x16x32_bf16 a[116:119], a[184:187], v[188:191], a[116:119]
  v_exp_f32 v216, v144
  v_mfma_f32_16x16x32_bf16 a[120:123], a[188:191], v[184:187], a[120:123]
  s_waitcnt lgkmcnt(3)
  ds_read_b128 a[156:159], v3 offset:15360
  v_cvt_pk_bf16_f32 v183, v222, v223
  v_add_u32 v3, s66, v2
  v_mfma_f32_16x16x32_bf16 a[124:127], a[188:191], v[188:191], a[124:127]
  s_cbranch_vccnz fa_stub27
fa_back27:
  v_exp_f32 v217, v145
  v_add_f32 v230, v230, v226
  v_add_f32 v231, v231, v227
fa_Bexit:
  s_bitcmp1_b32 s20, 0
  s_cbranch_scc1 fa_Bodd
  v_mfma_f32_16x16x32_bf16 v[128:131], a[128:131], v[64:67], v[200:203]
  s_waitcnt vmcnt(0)
  v_exp_f32 v218, v146
  v_mfma_f32_16x16x32_bf16 v[136:139], a[128:131], v[68:71], v[204:207]
  s_barrier
  v_exp_f32 v219, v147
  v_mfma_f32_16x16x32_bf16 v[132:135], a[132:135], v[64:67], v[200:203]
  ds_read_b128 a[160:163], v3 offset:16384
  ds_read_b128 a[164:167], v3 offset:17408
  v_add_f32 v226, v216, v217
  v_mfma_f32_16x16x32_bf16 v[140:143], a[132:135], v[68:71], v[204:207]
  s_add_u32 s14, s13, 49152
  buffer_load_dwordx4 v[160:163], v2, s[40:43], s14 offen offset:0 sc1
  v_cvt_pk_bf16_f32 v184, v216, v217
  v_mfma_f32_16x16x32_bf16 v[128:131], a[136:139], v[72:75], v[128:131]
  ds_read_b128 a[168:171], v3 offset:18432
  v_add_f32 v226, v226, v218
  v_mfma_f32_16x16x32_bf16 v[136:139], a[136:139], v[76:79], v[136:139]
  v_exp_f32 v220, v148
  v_mfma_f32_16x16x32_bf16 v[132:135], a[140:143], v[72:75], v[132:135]
  ds_read_b128 a[172:175], v3 offset:19456
  v_add_f32 v226, v226, v219
  v_cvt_pk_bf16_f32 v185, v218, v219
  v_mfma_f32_16x16x32_bf16 v[140:143], a[140:143], v[76:79], v[140:143]
  s_waitcnt lgkmcnt(4)
  buffer_load_dwordx4 v[164:167], v2, s[40:43], s14 offen offset:1024 sc1
  v_add_f32 v226, v226, v220
  v_mfma_f32_16x16x32_bf16 v[128:131], a[144:147], v[80:83], v[128:131]
  ds_read_b128 a[176:179], v3 offset:20480
  v_mfma_f32_16x16x32_bf16 v[136:139], a[144:147], v[84:87], v[136:139]
  v_exp_f32 v221, v149
  v_mfma_f32_16x16x32_bf16 v[132:135], a[148:151], v[80:83], v[132:135]
  ds_read_b128 a[180:183], v3 offset:21504
  v_add_f32 v226, v226, v221
  v_mfma_f32_16x16x32_bf16 v[140:143], a[148:151], v[84:87], v[140:143]
  v_exp_f32 v222, v150
  v_mfma_f32_16x16x32_bf16 v[128:131], a[152:155], v[88:91], v[128:131]
  ds_read_b128 a[184:187], v3 offset:22528
  buffer_load_dwordx4 v[168:171], v2, s[40:43], s14 offen offset:2048 sc1
  v_cvt_pk_bf16_f32 v186, v220, v221
  v_mfma_f32_16x16x32_bf16 v[136:139], a[152:155], v[92:95], v[136:139]
  v_exp_f32 v223, v151
  v_mfma_f32_16x16x32_bf16 v[132:135], a[156:159], v[88:91], v[132:135]
  ds_read_b128 a[188:191], v3 offset:23552
  v_add_f32 v226, v226, v222
  v_add_f32 v226, v226, v223
  v_mfma_f32_16x16x32_bf16 v[140:143], a[156:159], v[92:95], v[140:143]
  s_waitcnt lgkmcnt(4)
  v_exp_f32 v216, v152
  v_mfma_f32_16x16x32_bf16 a[64:67], a[160:163], v[176:179], a[64:67]
  v_exp_f32 v217, v153
  v_mfma_f32_16x16x32_bf16 a[68:71], a[160:163], v[180:183], a[68:71]
  buffer_load_dwordx4 v[172:175], v2, s[40:43], s14 offen offset:3072 sc1
  v_cvt_pk_bf16_f32 v187, v222, v223
  v_add_f32 v227, v216, v217
  v_mfma_f32_16x16x32_bf16 a[72:75], a[164:167], v[176:179], a[72:75]
  v_exp_f32 v218, v154
  v_mfma_f32_16x16x32_bf16 a[76:79], a[164:167], v[180:183], a[76:79]
  v_exp_f32 v219, v155
  v_mfma_f32_16x16x32_bf16 a[80:83], a[168:171], v[176:179], a[80:83]
  v_exp_f32 v220, v156
  v_mfma_f32_16x16x32_bf16 a[84:87], a[168:171], v[180:183], a[84:87]
  s_add_u32 s14, s13, 53248
  buffer_load_dwordx4 v[192:195], v2, s[40:43], s14 offen offset:0 sc1
  v_cvt_pk_bf16_f32 v188, v216, v217
  v_add_f32 v227, v227, v218
  v_mfma_f32_16x16x32_bf16 a[88:91], a[172:175], v[176:179], a[88:91]
  v_exp_f32 v221, v157
  v_mfma_f32_16x16x32_bf16 a[92:95], a[172:175], v[180:183], a[92:95]
  s_waitcnt lgkmcnt(0)
  v_exp_f32 v222, v158
  v_mfma_f32_16x16x32_bf16 a[96:99], a[176:179], v[176:179], a[96:99]
  v_add_f32 v227, v227, v219
  v_cvt_pk_bf16_f32 v189, v218, v219
  v_mfma_f32_16x16x32_bf16 a[100:103], a[176:179], v[180:183], a[100:103]
  v_exp_f32 v223, v159
  v_mfma_f32_16x16x32_bf16 a[104:107], a[180:183], v[176:179], a[104:107]
  buffer_load_dwordx4 v[196:199], v2, s[40:43], s14 offen offset:1024 sc1
  v_add_f32 v227, v227, v220
  v_mfma_f32_16x16x32_bf16 a[108:111], a[180:183], v[180:183], a[108:111]
  v_add_f32 v227, v227, v221
  v_cvt_pk_bf16_f32 v190, v220, v221
  v_add_f32 v227, v227, v222
  v_mfma_f32_16x16x32_bf16 a[112:115], a[184:187], v[176:179], a[112:115]
  v_add_f32 v227, v227, v223
  v_max_f32 v5, v226, v227
  v_cmp_lt_f32 vcc, s81, v5
  v_mfma_f32_16x16x32_bf16 a[116:119], a[184:187], v[180:183], a[116:119]
  v_exp_f32 v216, v128
  v_mfma_f32_16x16x32_bf16 a[120:123], a[188:191], v[176:179], a[120:123]
  v_cvt_pk_bf16_f32 v191, v222, v223
  v_mfma_f32_16x16x32_bf16 a[124:127], a[188:191], v[180:183], a[124:127]
  s_cbranch_vccnz fa_stub28
fa_back28:
  v_exp_f32 v217, v129
  v_add_f32 v230, v230, v226
  v_add_f32 v231, v231, v227
  ds_read_b128 a[160:163], v3 offset:24576
  ds_read_b128 a[164:167], v3 offset:25600
  ds_read_b128 a[168:171], v3 offset:26624
  ds_read_b128 a[172:175], v3 offset:27648
  ds_read_b128 a[176:179], v3 offset:28672
  ds_read_b128 a[180:183], v3 offset:29696
  ds_read_b128 a[184:187], v3 offset:30720
  ds_read_b128 a[188:191], v3 offset:31744
  v_cndmask_b32 v128, v4, v128, s[68:69]
  v_cndmask_b32 v129, v4, v129, s[70:71]
  v_cndmask_b32 v130, v4, v130, s[72:73]
  v_cndmask_b32 v131, v4, v131, s[74:75]
  v_mov_b32 v132, v4
  v_mov_b32 v133, v4
  v_mov_b32 v134, v4
  v_mov_b32 v135, v4
  v_cndmask_b32 v140, v4, v140, s[68:69]
  v_cndmask_b32 v141, v4, v141, s[70:71]
  v_cndmask_b32 v142, v4, v142, s[72:73]
  v_cndmask_b32 v143, v4, v143, s[74:75]
  v_exp_f32 v216, v128
  v_exp_f32 v217, v129
  v_exp_f32 v218, v130
  v_add_f32 v226, v216, v217
  v_cvt_pk_bf16_f32 v176, v216, v217
  v_add_f32 v226, v226, v218
  v_exp_f32 v219, v131
  v_exp_f32 v220, v132
  v_add_f32 v226, v226, v219
  v_cvt_pk_bf16_f32 v177, v218, v219
  v_add_f32 v226, v226, v220
  v_exp_f32 v221, v133
  s_waitcnt lgkmcnt(4)
  v_mfma_f32_16x16x32_bf16 a[64:67], a[160:163], v[184:187], a[64:67]
  v_exp_f32 v222, v134
  v_add_f32 v226, v226, v221
  v_mfma_f32_16x16x32_bf16 a[68:71], a[160:163], v[188:191], a[68:71]
  s_add_u32 s14, s13, 53248
  buffer_load_dwordx4 v[208:211], v2, s[40:43], s14 offen offset:2048 sc1
  v_exp_f32 v223, v135
  v_mfma_f32_16x16x32_bf16 a[72:75], a[164:167], v[184:187], a[72:75]
  s_add_u32 s66, s66, 32768
  v_exp_f32 v216, v136
  v_mfma_f32_16x16x32_bf16 a[76:79], a[164:167], v[188:191], a[76:79]
  s_and_b32 s66, s66, 0x1ffff
  v_exp_f32 v217, v137
  v_mfma_f32_16x16x32_bf16 a[80:83], a[168:171], v[184:187], a[80:83]
  buffer_load_dwordx4 v[212:215], v2, s[40:43], s14 offen offset:3072 sc1
  v_cvt_pk_bf16_f32 v178, v220, v221
  v_add_f32 v226, v226, v222
  v_add_f32 v226, v226, v223
  v_cvt_pk_bf16_f32 v179, v222, v223
  v_mfma_f32_16x16x32_bf16 a[84:87], a[168:171], v[188:191], a[84:87]
  v_exp_f32 v218, v138
  v_mfma_f32_16x16x32_bf16 a[88:91], a[172:175], v[184:187], a[88:91]
  v_exp_f32 v219, v139
  v_mfma_f32_16x16x32_bf16 a[92:95], a[172:175], v[188:191], a[92:95]
  s_waitcnt lgkmcnt(0)
  v_exp_f32 v220, v140
  v_mfma_f32_16x16x32_bf16 a[96:99], a[176:179], v[184:187], a[96:99]
  s_add_u32 s14, s13, 57344
  buffer_load_dwordx4 v[232:235], v2, s[40:43], s14 offen offset:0 sc1
  v_add_f32 v227, v216, v217
  v_cvt_pk_bf16_f32 v180, v216, v217
  v_add_f32 v227, v227, v218
  v_add_f32 v227, v227, v219
  v_cvt_pk_bf16_f32 v181, v218, v219
  v_exp_f32 v221, v141
  v_mfma_f32_16x16x32_bf16 a[100:103], a[176:179], v[188:191], a[100:103]
  v_exp_f32 v222, v142
  v_mfma_f32_16x16x32_bf16 a[104:107], a[180:183], v[184:187], a[104:107]
  v_exp_f32 v223, v143
  v_mfma_f32_16x16x32_bf16 a[108:111], a[180:183], v[188:191], a[108:111]
  buffer_load_dwordx4 v[236:239], v2, s[40:43], s14 offen offset:1024 sc1
  v_add_f32 v227, v227, v220
  v_add_f32 v227, v227, v221
  v_cvt_pk_bf16_f32 v182, v220, v221
  v_add_f32 v227, v227, v222
  v_mfma_f32_16x16x32_bf16 a[112:115], a[184:187], v[184:187], a[112:115]
  v_add_f32 v227, v227, v223
  v_max_f32 v5, v226, v227
  v_cmp_lt_f32 vcc, s81, v5
  v_mfma_f32_16x16x32_bf16 a[116:119], a[184:187], v[188:191], a[116:119]
  v_mfma_f32_16x16x32_bf16 a[120:123], a[188:191], v[184:187], a[120:123]
  v_cvt_pk_bf16_f32 v183, v222, v223
  v_add_u32 v3, s66, v2
  v_mfma_f32_16x16x32_bf16 a[124:127], a[188:191], v[188:191], a[124:127]
  s_cbranch_vccnz fa_stub29
fa_back29:
  v_add_f32 v230, v230, v226
  v_add_f32 v231, v231, v227
  s_waitcnt vmcnt(10)
  s_barrier
  ds_read_b128 a[160:163], v3 offset:16384
  ds_read_b128 a[164:167], v3 offset:17408
  ds_read_b128 a[168:171], v3 offset:18432
  ds_read_b128 a[172:175], v3 offset:19456
  ds_read_b128 a[176:179], v3 offset:20480
  ds_read_b128 a[180:183], v3 offset:21504
  ds_read_b128 a[184:187], v3 offset:22528
  ds_read_b128 a[188:191], v3 offset:23552
  s_waitcnt lgkmcnt(4)
  v_mfma_f32_16x16x32_bf16 a[64:67], a[160:163], v[176:179], a[64:67]
  v_mfma_f32_16x16x32_bf16 a[68:71], a[160:163], v[180:183], a[68:71]
  s_add_u32 s14, s13, 57344
  buffer_load_dwordx4 v[240:243], v2, s[40:43], s14 offen offset:2048 sc1
  v_mfma_f32_16x16x32_bf16 a[72:75], a[164:167], v[176:179], a[72:75]
  v_mfma_f32_16x16x32_bf16 a[76:79], a[164:167], v[180:183], a[76:79]
  v_mfma_f32_16x16x32_bf16 a[80:83], a[168:171], v[176:179], a[80:83]
  v_mfma_f32_16x16x32_bf16 a[84:87], a[168:171], v[180:183], a[84:87]
  v_mfma_f32_16x16x32_bf16 a[88:91], a[172:175], v[176:179], a[88:91]
  v_mfma_f32_16x16x32_bf16 a[92:95], a[172:175], v[180:183], a[92:95]
  s_waitcnt lgkmcnt(0)
  v_mfma_f32_16x16x32_bf16 a[96:99], a[176:179], v[176:179], a[96:99]
  buffer_load_dwordx4 v[244:247], v2, s[40:43], s14 offen offset:3072 sc1
  v_mfma_f32_16x16x32_bf16 a[100:103], a[176:179], v[180:183], a[100:103]
  v_mfma_f32_16x16x32_bf16 a[104:107], a[180:183], v[176:179], a[104:107]
  v_mfma_f32_16x16x32_bf16 a[108:111], a[180:183], v[180:183], a[108:111]
  v_mfma_f32_16x16x32_bf16 a[112:115], a[184:187], v[176:179], a[112:115]
  v_mfma_f32_16x16x32_bf16 a[116:119], a[184:187], v[180:183], a[116:119]
  v_mfma_f32_16x16x32_bf16 a[120:123], a[188:191], v[176:179], a[120:123]
  v_mfma_f32_16x16x32_bf16 a[124:127], a[188:191], v[180:183], a[124:127]
  s_branch fa_Bdone
fa_Bodd:
  s_waitcnt vmcnt(0)
  s_barrier
  ds_read_b128 a[160:163], v3 offset:16384
  ds_read_b128 a[164:167], v3 offset:17408
  ds_read_b128 a[168:171], v3 offset:18432
  ds_read_b128 a[172:175], v3 offset:19456
  ds_read_b128 a[176:179], v3 offset:20480
  ds_read_b128 a[180:183], v3 offset:21504
  ds_read_b128 a[184:187], v3 offset:22528
  ds_read_b128 a[188:191], v3 offset:23552
  v_cndmask_b32 v144, v4, v144, s[68:69]
  v_cndmask_b32 v145, v4, v145, s[70:71]
  v_cndmask_b32 v146, v4, v146, s[72:73]
  v_cndmask_b32 v147, v4, v147, s[74:75]
  v_mov_b32 v148, v4
  v_mov_b32 v149, v4
  v_mov_b32 v150, v4
  v_mov_b32 v151, v4
  v_cndmask_b32 v156, v4, v156, s[68:69]
  v_cndmask_b32 v157, v4, v157, s[70:71]
  v_cndmask_b32 v158, v4, v158, s[72:73]
  v_cndmask_b32 v159, v4, v159, s[74:75]
  v_exp_f32 v216, v144
  v_exp_f32 v217, v145
  v_exp_f32 v218, v146
  v_add_f32 v226, v216, v217
  v_cvt_pk_bf16_f32 v184, v216, v217
  v_add_f32 v226, v226, v218
  v_exp_f32 v219, v147
  v_exp_f32 v220, v148
  v_add_f32 v226, v226, v219
  v_cvt_pk_bf16_f32 v185, v218, v219
  v_add_f32 v226, v226, v220
  v_exp_f32 v221, v149
  s_waitcnt lgkmcnt(4)
  v_mfma_f32_16x16x32_bf16 a[64:67], a[160:163], v[176:179], a[64:67]
  v_exp_f32 v222, v150
  v_add_f32 v226, v226, v221
  v_mfma_f32_16x16x32_bf16 a[68:71], a[160:163], v[180:183], a[68:71]
  s_add_u32 s14, s13, 49152
  buffer_load_dwordx4 v[160:163], v2, s[40:43], s14 offen offset:0 sc1
  v_exp_f32 v223, v151
  v_mfma_f32_16x16x32_bf16 a[72:75], a[164:167], v[176:179], a[72:75]
  v_exp_f32 v216, v152
  v_cvt_pk_bf16_f32 v186, v220, v221
  v_add_f32 v226, v226, v222
  v_mfma_f32_16x16x32_bf16 a[76:79], a[164:167], v[180:183], a[76:79]
  buffer_load_dwordx4 v[164:167], v2, s[40:43], s14 offen offset:1024 sc1
  v_exp_f32 v217, v153
  v_mfma_f32_16x16x32_bf16 a[80:83], a[168:171], v[176:179], a[80:83]
  v_exp_f32 v218, v154
  v_add_f32 v226, v226, v223
  v_mfma_f32_16x16x32_bf16 a[84:87], a[168:171], v[180:183], a[84:87]
  buffer_load_dwordx4 v[168:171], v2, s[40:43], s14 offen offset:2048 sc1
  v_exp_f32 v219, v155
  v_cvt_pk_bf16_f32 v187, v222, v223
  v_mfma_f32_16x16x32_bf16 a[88:91], a[172:175], v[176:179], a[88:91]
  v_exp_f32 v220, v156
  v_mfma_f32_16x16x32_bf16 a[92:95], a[172:175], v[180:183], a[92:95]
  s_waitcnt lgkmcnt(0)
  buffer_load_dwordx4 v[172:175], v2, s[40:43], s14 offen offset:3072 sc1
  v_add_f32 v227, v216, v217
  v_cvt_pk_bf16_f32 v188, v216, v217
  v_add_f32 v227, v227, v218
  v_mfma_f32_16x16x32_bf16 a[96:99], a[176:179], v[176:179], a[96:99]
  v_exp_f32 v221, v157
  v_mfma_f32_16x16x32_bf16 a[100:103], a[176:179], v[180:183], a[100:103]
  s_add_u32 s14, s13, 53248
  buffer_load_dwordx4 v[192:195], v2, s[40:43], s14 offen offset:0 sc1
  v_exp_f32 v222, v158
  v_mfma_f32_16x16x32_bf16 a[104:107], a[180:183], v[176:179], a[104:107]
  v_exp_f32 v223, v159
  v_mfma_f32_16x16x32_bf16 a[108:111], a[180:183], v[180:183], a[108:111]
  buffer_load_dwordx4 v[196:199], v2, s[40:43], s14 offen offset:1024 sc1
  v_add_f32 v227, v227, v219
  v_cvt_pk_bf16_f32 v189, v218, v219
  v_add_f32 v227, v227, v220
  v_add_f32 v227, v227, v221
  v_cvt_pk_bf16_f32 v190, v220, v221
  v_add_f32 v227, v227, v222
  v_mfma_f32_16x16x32_bf16 a[112:115], a[184:187], v[176:179], a[112:115]
  v_add_f32 v227, v227, v223
  v_max_f32 v5, v226, v227
  v_cmp_lt_f32 vcc, s81, v5
  v_mfma_f32_16x16x32_bf16 a[116:119], a[184:187], v[180:183], a[116:119]
  buffer_load_dwordx4 v[208:211], v2, s[40:43], s14 offen offset:2048 sc1
  v_mfma_f32_16x16x32_bf16 a[120:123], a[188:191], v[176:179], a[120:123]
  v_cvt_pk_bf16_f32 v191, v222, v223
  v_mfma_f32_16x16x32_bf16 a[124:127], a[188:191], v[180:183], a[124:127]
  s_cbranch_vccnz fa_stub30
fa_back30:
  v_add_f32 v230, v230, v226
  v_add_f32 v231, v231, v227
  ds_read_b128 a[160:163], v3 offset:24576
  ds_read_b128 a[164:167], v3 offset:25600
  ds_read_b128 a[168:171], v3 offset:26624
  ds_read_b128 a[172:175], v3 offset:27648
  ds_read_b128 a[176:179], v3 offset:28672
  ds_read_b128 a[180:183], v3 offset:29696
  ds_read_b128 a[184:187], v3 offset:30720
  ds_read_b128 a[188:191], v3 offset:31744
  s_waitcnt lgkmcnt(4)
  v_mfma_f32_16x16x32_bf16 a[64:67], a[160:163], v[184:187], a[64:67]
  v_mfma_f32_16x16x32_bf16 a[68:71], a[160:163], v[188:191], a[68:71]
  s_add_u32 s14, s13, 53248
  buffer_load_dwordx4 v[212:215], v2, s[40:43], s14 offen offset:3072 sc1
  v_mfma_f32_16x16x32_bf16 a[72:75], a[164:167], v[184:187], a[72:75]
  s_add_u32 s66, s66, 32768
  v_mfma_f32_16x16x32_bf16 a[76:79], a[164:167], v[188:191], a[76:79]
  s_add_u32 s14, s13, 57344
  buffer_load_dwordx4 v[232:235], v2, s[40:43], s14 offen offset:0 sc1
  v_mfma_f32_16x16x32_bf16 a[80:83], a[168:171], v[184:187], a[80:83]
  s_and_b32 s66, s66, 0x1ffff
  v_mfma_f32_16x16x32_bf16 a[84:87], a[168:171], v[188:191], a[84:87]
  v_mfma_f32_16x16x32_bf16 a[88:91], a[172:175], v[184:187], a[88:91]
  buffer_load_dwordx4 v[236:239], v2, s[40:43], s14 offen offset:1024 sc1
  v_mfma_f32_16x16x32_bf16 a[92:95], a[172:175], v[188:191], a[92:95]
  s_waitcnt lgkmcnt(0)
  v_mfma_f32_16x16x32_bf16 a[96:99], a[176:179], v[184:187], a[96:99]
  v_mfma_f32_16x16x32_bf16 a[100:103], a[176:179], v[188:191], a[100:103]
  buffer_load_dwordx4 v[240:243], v2, s[40:43], s14 offen offset:2048 sc1
  v_mfma_f32_16x16x32_bf16 a[104:107], a[180:183], v[184:187], a[104:107]
  v_mfma_f32_16x16x32_bf16 a[108:111], a[180:183], v[188:191], a[108:111]
  v_mfma_f32_16x16x32_bf16 a[112:115], a[184:187], v[184:187], a[112:115]
  buffer_load_dwordx4 v[244:247], v2, s[40:43], s14 offen offset:3072 sc1
  v_mfma_f32_16x16x32_bf16 a[116:119], a[184:187], v[188:191], a[116:119]
  v_mfma_f32_16x16x32_bf16 a[120:123], a[188:191], v[184:187], a[120:123]
  v_add_u32 v3, s66, v2
  v_mfma_f32_16x16x32_bf16 a[124:127], a[188:191], v[188:191], a[124:127]
fa_Bdone:
  s_cmp_ge_u32 s20, 2
  s_cbranch_scc1 fa_epi
  s_barrier
fa_epi:
  v_mov_b32 v20, v230
  v_mov_b32 v21, v231
  s_nop 1
  v_permlane16_swap_b32 v230, v20
  v_permlane16_swap_b32 v231, v21
  v_add_f32 v230, v230, v20
  v_add_f32 v231, v231, v21
  v_mov_b32 v20, v230
  v_mov_b32 v21, v231
  s_nop 1
  v_permlane32_swap_b32 v230, v20
  v_permlane32_swap_b32 v231, v21
  v_add_f32 v230, v230, v20
  v_add_f32 v231, v231, v21
  v_rcp_f32 v16, v230
  v_rcp_f32 v18, v231
  s_sub_u32 s23, 15, s22
  s_lshl_b32 s23, s23, 2
  v_mov_b32 v17, v16
  v_mov_b32 v19, v18
  s_add_u32 s23, s23, s20
  s_lshl_b32 s23, s23, 18
  s_lshl_b32 s31, s21, 12
  s_add_u32 s31, s31, 50331648
  s_add_u32 s64, s23, s31
  s_add_u32 s65, s64, 131072
  v_accvgpr_read_b32 v68, a64
  v_accvgpr_read_b32 v69, a65
  v_accvgpr_read_b32 v70, a66
  v_accvgpr_read_b32 v71, a67
  v_accvgpr_read_b32 v72, a72
  v_accvgpr_read_b32 v73, a73
  v_accvgpr_read_b32 v74, a74
  v_accvgpr_read_b32 v75, a75
  v_pk_mul_f32 v[68:69], v[68:69], v[16:17]
  v_pk_mul_f32 v[70:71], v[70:71], v[16:17]
  v_pk_mul_f32 v[72:73], v[72:73], v[16:17]
  v_pk_mul_f32 v[74:75], v[74:75], v[16:17]
  v_cvt_pk_bf16_f32 v64, v68, v69
  v_cvt_pk_bf16_f32 v65, v70, v71
  v_cvt_pk_bf16_f32 v66, v72, v73
  v_cvt_pk_bf16_f32 v67, v74, v75
  buffer_store_dwordx4 v[64:67], v2, s[40:43], s64 offen offset:0 sc1
  v_accvgpr_read_b32 v80, a80
  v_accvgpr_read_b32 v81, a81
  v_accvgpr_read_b32 v82, a82
  v_accvgpr_read_b32 v83, a83
  v_accvgpr_read_b32 v84, a88
  v_accvgpr_read_b32 v85, a89
  v_accvgpr_read_b32 v86, a90
  v_accvgpr_read_b32 v87, a91
  v_pk_mul_f32 v[80:81], v[80:81], v[16:17]
  v_pk_mul_f32 v[82:83], v[82:83], v[16:17]
  v_pk_mul_f32 v[84:85], v[84:85], v[16:17]
  v_pk_mul_f32 v[86:87], v[86:87], v[16:17]
  v_cvt_pk_bf16_f32 v76, v80, v81
  v_cvt_pk_bf16_f32 v77, v82, v83
  v_cvt_pk_bf16_f32 v78, v84, v85
  v_cvt_pk_bf16_f32 v79, v86, v87
  buffer_store_dwordx4 v[76:79], v2, s[40:43], s64 offen offset:1024 sc1
  v_accvgpr_read_b32 v132, a96
  v_accvgpr_read_b32 v133, a97
  v_accvgpr_read_b32 v134, a98
  v_accvgpr_read_b32 v135, a99
  v_accvgpr_read_b32 v136, a104
  v_accvgpr_read_b32 v137, a105
  v_accvgpr_read_b32 v138, a106
  v_accvgpr_read_b32 v139, a107
  v_pk_mul_f32 v[132:133], v[132:133], v[16:17]
  v_pk_mul_f32 v[134:135], v[134:135], v[16:17]
  v_pk_mul_f32 v[136:137], v[136:137], v[16:17]
  v_pk_mul_f32 v[138:139], v[138:139], v[16:17]
  v_cvt_pk_bf16_f32 v128, v132, v133
  v_cvt_pk_bf16_f32 v129, v134, v135
  v_cvt_pk_bf16_f32 v130, v136, v137
  v_cvt_pk_bf16_f32 v131, v138, v139
  buffer_store_dwordx4 v[128:131], v2, s[40:43], s64 offen offset:2048 sc1
  v_accvgpr_read_b32 v144, a112
  v_accvgpr_read_b32 v145, a113
  v_accvgpr_read_b32 v146, a114
  v_accvgpr_read_b32 v147, a115
  v_accvgpr_read_b32 v148, a120
  v_accvgpr_read_b32 v149, a121
  v_accvgpr_read_b32 v150, a122
  v_accvgpr_read_b32 v151, a123
  v_pk_mul_f32 v[144:145], v[144:145], v[16:17]
  v_pk_mul_f32 v[146:147], v[146:147], v[16:17]
  v_pk_mul_f32 v[148:149], v[148:149], v[16:17]
  v_pk_mul_f32 v[150:151], v[150:151], v[16:17]
  v_cvt_pk_bf16_f32 v140, v144, v145
  v_cvt_pk_bf16_f32 v141, v146, v147
  v_cvt_pk_bf16_f32 v142, v148, v149
  v_cvt_pk_bf16_f32 v143, v150, v151
  buffer_store_dwordx4 v[140:143], v2, s[40:43], s64 offen offset:3072 sc1
  v_accvgpr_read_b32 v68, a68
  v_accvgpr_read_b32 v69, a69
  v_accvgpr_read_b32 v70, a70
  v_accvgpr_read_b32 v71, a71
  v_accvgpr_read_b32 v72, a76
  v_accvgpr_read_b32 v73, a77
  v_accvgpr_read_b32 v74, a78
  v_accvgpr_read_b32 v75, a79
  v_pk_mul_f32 v[68:69], v[68:69], v[18:19]
  v_pk_mul_f32 v[70:71], v[70:71], v[18:19]
  v_pk_mul_f32 v[72:73], v[72:73], v[18:19]
  v_pk_mul_f32 v[74:75], v[74:75], v[18:19]
  v_cvt_pk_bf16_f32 v64, v68, v69
  v_cvt_pk_bf16_f32 v65, v70, v71
  v_cvt_pk_bf16_f32 v66, v72, v73
  v_cvt_pk_bf16_f32 v67, v74, v75
  buffer_store_dwordx4 v[64:67], v2, s[40:43], s65 offen offset:0 sc1
  v_accvgpr_read_b32 v80, a84
  v_accvgpr_read_b32 v81, a85
  v_accvgpr_read_b32 v82, a86
  v_accvgpr_read_b32 v83, a87
  v_accvgpr_read_b32 v84, a92
  v_accvgpr_read_b32 v85, a93
  v_accvgpr_read_b32 v86, a94
  v_accvgpr_read_b32 v87, a95
  v_pk_mul_f32 v[80:81], v[80:81], v[18:19]
  v_pk_mul_f32 v[82:83], v[82:83], v[18:19]
  v_pk_mul_f32 v[84:85], v[84:85], v[18:19]
  v_pk_mul_f32 v[86:87], v[86:87], v[18:19]
  v_cvt_pk_bf16_f32 v76, v80, v81
  v_cvt_pk_bf16_f32 v77, v82, v83
  v_cvt_pk_bf16_f32 v78, v84, v85
  v_cvt_pk_bf16_f32 v79, v86, v87
  buffer_store_dwordx4 v[76:79], v2, s[40:43], s65 offen offset:1024 sc1
  v_accvgpr_read_b32 v132, a100
  v_accvgpr_read_b32 v133, a101
  v_accvgpr_read_b32 v134, a102
  v_accvgpr_read_b32 v135, a103
  v_accvgpr_read_b32 v136, a108
  v_accvgpr_read_b32 v137, a109
  v_accvgpr_read_b32 v138, a110
  v_accvgpr_read_b32 v139, a111
  v_pk_mul_f32 v[132:133], v[132:133], v[18:19]
  v_pk_mul_f32 v[134:135], v[134:135], v[18:19]
  v_pk_mul_f32 v[136:137], v[136:137], v[18:19]
  v_pk_mul_f32 v[138:139], v[138:139], v[18:19]
  v_cvt_pk_bf16_f32 v128, v132, v133
  v_cvt_pk_bf16_f32 v129, v134, v135
  v_cvt_pk_bf16_f32 v130, v136, v137
  v_cvt_pk_bf16_f32 v131, v138, v139
  buffer_store_dwordx4 v[128:131], v2, s[40:43], s65 offen offset:2048 sc1
  v_accvgpr_read_b32 v144, a116
  v_accvgpr_read_b32 v145, a117
  v_accvgpr_read_b32 v146, a118
  v_accvgpr_read_b32 v147, a119
  v_accvgpr_read_b32 v148, a124
  v_accvgpr_read_b32 v149, a125
  v_accvgpr_read_b32 v150, a126
  v_accvgpr_read_b32 v151, a127
  v_pk_mul_f32 v[144:145], v[144:145], v[18:19]
  v_pk_mul_f32 v[146:147], v[146:147], v[18:19]
  v_pk_mul_f32 v[148:149], v[148:149], v[18:19]
  v_pk_mul_f32 v[150:151], v[150:151], v[18:19]
  v_cvt_pk_bf16_f32 v140, v144, v145
  v_cvt_pk_bf16_f32 v141, v146, v147
  v_cvt_pk_bf16_f32 v142, v148, v149
  v_cvt_pk_bf16_f32 v143, v150, v151
  buffer_store_dwordx4 v[140:143], v2, s[40:43], s65 offen offset:3072 sc1
  s_cmp_lt_u32 s12, 3
  s_cbranch_scc1 fa_hk9
fa_hb9:
  s_load_dwordx2 s[4:5], s[0:1], 0
  s_load_dwordx2 s[6:7], s[0:1], 88
  v_mov_b32 v30, 1073741824
  v_mov_b32 v31, 1
  v_writelane_b32 v30, s80, 0
  v_writelane_b32 v30, s3, 1
  s_lshl_b32 s64, s21, 19
  s_lshl_b32 s23, s20, 15
  s_add_u32 s64, s64, s23
  s_add_u32 s64, s64, 50331648
  s_add_u32 s65, s64, 131072
  s_add_u32 s66, s64, 262144
  s_add_u32 s67, s64, 393216
  v_bfe_u32 v12, v1, 3, 1
  v_lshlrev_b32 v12, 7, v12
  v_and_b32 v13, 7, v1
  v_lshl_add_u32 v12, v13, 2, v12
  s_lshl_b32 s23, s21, 8
  s_lshl_b32 s31, s20, 5
  s_add_u32 s23, s23, s31
  s_add_u32 s23, s23, 2641920
  v_add_u32 v12, s23, v12
  s_lshl_b32 s25, s21, 6
  s_mul_i32 s26, s22, 160
  s_mul_i32 s27, s22, 2560
  v_add_u32 v16, 0, v0
  v_mul_u32_u24 v17, 6554, v16
  v_lshrrev_b32 v17, 16, v17
  v_mul_u32_u24 v18, 10, v17
  v_sub_u32 v18, v16, v18
  v_mul_u32_u24 v251, 336, v17
  v_lshl_add_u32 v251, v18, 5, v251
  v_lshlrev_b32 v203, 5, v18
  v_add_u32 v17, s25, v17
  v_add_u32 v24, 1, v17
  v_mul_u32_u24 v248, 1280, v17
  v_lshl_add_u32 v248, v18, 4, v248
  v_add_u32 v248, s26, v248
  v_lshrrev_b32 v19, 4, v17
  v_mul_u32_u24 v19, 20480, v19
  v_and_b32 v17, 15, v17
  v_lshl_add_u32 v19, v17, 4, v19
  v_lshl_add_u32 v200, v18, 8, v19
  v_mov_b32 v27, 8
  v_add_u32 v16, 256, v0
  v_mul_u32_u24 v17, 6554, v16
  v_lshrrev_b32 v17, 16, v17
  v_mul_u32_u24 v18, 10, v17
  v_sub_u32 v18, v16, v18
  v_mul_u32_u24 v252, 336, v17
  v_lshl_add_u32 v252, v18, 5, v252
  v_lshlrev_b32 v204, 5, v18
  v_add_u32 v17, s25, v17
  v_add_u32 v25, 1, v17
  v_mul_u32_u24 v249, 1280, v17
  v_lshl_add_u32 v249, v18, 4, v249
  v_add_u32 v249, s26, v249
  v_lshrrev_b32 v19, 4, v17
  v_mul_u32_u24 v19, 20480, v19
  v_and_b32 v17, 15, v17
  v_lshl_add_u32 v19, v17, 4, v19
  v_lshl_add_u32 v201, v18, 8, v19
  v_mov_b32 v28, 8
  v_add_u32 v16, 512, v0
  v_mul_u32_u24 v17, 6554, v16
  v_lshrrev_b32 v17, 16, v17
  v_mul_u32_u24 v18, 10, v17
  v_sub_u32 v18, v16, v18
  v_mul_u32_u24 v253, 336, v17
  v_lshl_add_u32 v253, v18, 5, v253
  v_lshlrev_b32 v205, 5, v18
  v_add_u32 v17, s25, v17
  v_add_u32 v26, 1, v17
  v_mul_u32_u24 v250, 1280, v17
  v_lshl_add_u32 v250, v18, 4, v250
  v_add_u32 v250, s26, v250
  v_lshrrev_b32 v19, 4, v17
  v_mul_u32_u24 v19, 20480, v19
  v_and_b32 v17, 15, v17
  v_lshl_add_u32 v19, v17, 4, v19
  v_lshl_add_u32 v202, v18, 8, v19
  v_mov_b32 v29, 8
  v_cmp_gt_u32 vcc, 128, v0
  v_mov_b32 v16, 1073741824
  v_mov_b32 v17, 0
  v_cndmask_b32 v250, v16, v250, vcc
  v_cndmask_b32 v202, v16, v202, vcc
  v_cndmask_b32 v253, v17, v253, vcc
  v_mov_b32 v20, 0
  v_mov_b32 v21, 0
  v_mov_b32 v22, 0
  v_mov_b32 v23, 0
  v_add_u32 v16, 158208, v2
  ds_write_b128 v16, v[20:23]
  s_cmp_lt_u32 s12, 3
  s_waitcnt vmcnt(18) lgkmcnt(0)
  s_cbranch_scc1 fa_pub
  s_waitcnt vmcnt(0)
fa_pub:
  buffer_store_dword v31, v30, s[40:43], 0 offen sc1
  s_cmp_lt_u32 s12, 3
  s_cbranch_scc1 fa_hk10
fa_hb10:
  s_cmp_lt_u32 s29, 8
  s_cbranch_scc1 fa_left
fa_leftb:
  s_add_u32 s13, s13, 61440
  buffer_load_dwordx4 v[64:67], v2, s[40:43], s13 offen offset:0 sc1
  buffer_load_dwordx4 v[68:71], v2, s[40:43], s13 offen offset:1024 sc1
  buffer_load_dwordx4 v[72:75], v2, s[40:43], s13 offen offset:2048 sc1
  buffer_load_dwordx4 v[76:79], v2, s[40:43], s13 offen offset:3072 sc1
  s_add_u32 s13, s13, 4096
  buffer_load_dwordx4 v[80:83], v2, s[40:43], s13 offen offset:0 sc1
  buffer_load_dwordx4 v[84:87], v2, s[40:43], s13 offen offset:1024 sc1
  buffer_load_dwordx4 v[88:91], v2, s[40:43], s13 offen offset:2048 sc1
  buffer_load_dwordx4 v[92:95], v2, s[40:43], s13 offen offset:3072 sc1
  s_add_u32 s13, s13, 4096
  buffer_load_dwordx4 v[128:131], v2, s[40:43], s13 offen offset:0 sc1
  buffer_load_dwordx4 v[132:135], v2, s[40:43], s13 offen offset:1024 sc1
  buffer_load_dwordx4 v[136:139], v2, s[40:43], s13 offen offset:2048 sc1
  buffer_load_dwordx4 v[140:143], v2, s[40:43], s13 offen offset:3072 sc1
  s_add_u32 s13, s13, 4096
  buffer_load_dwordx4 v[144:147], v2, s[40:43], s13 offen offset:0 sc1
  buffer_load_dwordx4 v[148:151], v2, s[40:43], s13 offen offset:1024 sc1
  buffer_load_dwordx4 v[152:155], v2, s[40:43], s13 offen offset:2048 sc1
  buffer_load_dwordx4 v[156:159], v2, s[40:43], s13 offen offset:3072 sc1
  s_add_u32 s13, s13, 4096
  buffer_load_dwordx4 v[176:179], v2, s[40:43], s13 offen offset:0 sc1
  buffer_load_dwordx4 v[180:183], v2, s[40:43], s13 offen offset:1024 sc1
  buffer_load_dwordx4 v[184:187], v2, s[40:43], s13 offen offset:2048 sc1
  buffer_load_dwordx4 v[188:191], v2, s[40:43], s13 offen offset:3072 sc1
  s_add_u32 s13, s13, 4096
  s_barrier
  s_add_u32 s14, s13, 45056
  s_mul_i32 s23, s20, 38912
  v_add_u32 v11, s23, v2
  s_add_u32 m0, s23, 0
  s_nop 0
  buffer_load_dwordx4 v2, s[40:43], s14 offen offset:0 sc1 lds
  buffer_load_dwordx4 v2, s[40:43], s14 offen offset:1024 sc1 lds
  buffer_load_dwordx4 v2, s[40:43], s14 offen offset:2048 sc1 lds
  buffer_load_dwordx4 v2, s[40:43], s14 offen offset:3072 sc1 lds
  s_add_u32 s14, s14, 4096
  s_add_u32 m0, s23, 4096
  s_nop 0
  buffer_load_dwordx4 v2, s[40:43], s14 offen offset:0 sc1 lds
  buffer_load_dwordx4 v2, s[40:43], s14 offen offset:1024 sc1 lds
  buffer_load_dwordx4 v2, s[40:43], s14 offen offset:2048 sc1 lds
  buffer_load_dwordx4 v2, s[40:43], s14 offen offset:3072 sc1 lds
  s_add_u32 s14, s14, 4096
  s_add_u32 m0, s23, 8192
  s_nop 0
  buffer_load_dwordx4 v2, s[40:43], s14 offen offset:0 sc1 lds
  buffer_load_dwordx4 v2, s[40:43], s14 offen offset:1024 sc1 lds
  buffer_load_dwordx4 v2, s[40:43], s14 offen offset:2048 sc1 lds
  buffer_load_dwordx4 v2, s[40:43], s14 offen offset:3072 sc1 lds
  s_add_u32 s14, s14, 4096
  s_add_u32 m0, s23, 12288
  s_nop 0
  buffer_load_dwordx4 v2, s[40:43], s14 offen offset:0 sc1 lds
  buffer_load_dwordx4 v2, s[40:43], s14 offen offset:1024 sc1 lds
  buffer_load_dwordx4 v2, s[40:43], s14 offen offset:2048 sc1 lds
  buffer_load_dwordx4 v2, s[40:43], s14 offen offset:3072 sc1 lds
  s_add_u32 s14, s14, 4096
  s_add_u32 m0, s23, 16384
  s_nop 0
  buffer_load_dwordx4 v2, s[40:43], s14 offen offset:0 sc1 lds
  buffer_load_dwordx4 v2, s[40:43], s14 offen offset:1024 sc1 lds
  buffer_load_dwordx4 v2, s[40:43], s14 offen offset:2048 sc1 lds
  buffer_load_dwordx4 v2, s[40:43], s14 offen offset:3072 sc1 lds
  s_add_u32 s14, s14, 4096
  s_add_u32 m0, s23, 20480
  s_nop 0
  buffer_load_dwordx4 v2, s[40:43], s14 offen offset:0 sc1 lds
  buffer_load_dwordx4 v2, s[40:43], s14 offen offset:1024 sc1 lds
  buffer_load_dwordx4 v2, s[40:43], s14 offen offset:2048 sc1 lds
  buffer_load_dwordx4 v2, s[40:43], s14 offen offset:3072 sc1 lds
  s_add_u32 s14, s14, 4096
  buffer_load_dword v13, v12, s[40:43], 0 offen sc1
  s_add_u32 m0, s23, 24576
  s_nop 0
  buffer_load_dwordx4 v2, s[40:43], s14 offen offset:0 sc1 lds
  buffer_load_dwordx4 v2, s[40:43], s14 offen offset:1024 sc1 lds
  buffer_load_dwordx4 v2, s[40:43], s14 offen offset:2048 sc1 lds
  buffer_load_dwordx4 v2, s[40:43], s14 offen offset:3072 sc1 lds
  s_add_u32 s14, s14, 4096
  s_add_u32 m0, s23, 28672
  s_nop 0
  buffer_load_dwordx4 v2, s[40:43], s14 offen offset:0 sc1 lds
  buffer_load_dwordx4 v2, s[40:43], s14 offen offset:1024 sc1 lds
  buffer_load_dwordx4 v2, s[40:43], s14 offen offset:2048 sc1 lds
  buffer_load_dwordx4 v2, s[40:43], s14 offen offset:3072 sc1 lds
  s_add_u32 s14, s14, 4096
  s_add_u32 m0, s23, 32768
  s_nop 0
  buffer_load_dwordx4 v2, s[40:43], s14 offen offset:0 sc1 lds
  buffer_load_dwordx4 v2, s[40:43], s14 offen offset:1024 sc1 lds
  buffer_load_dwordx4 v2, s[40:43], s14 offen offset:2048 sc1 lds
  buffer_load_dwordx4 v2, s[40:43], s14 offen offset:3072 sc1 lds
  s_add_u32 s14, s14, 4096
  s_mov_b32 s44, s4
  s_mov_b32 s45, s5
  s_mov_b32 s46, 2621440
  s_mov_b32 s47, 0x20000
  s_mov_b32 s48, s6
  s_mov_b32 s49, s7
  s_mov_b32 s50, 2621440
  s_mov_b32 s51, 0x20000
  v_readlane_b32 s68, v15, 0
  v_readlane_b32 s69, v15, 1
  v_readlane_b32 s70, v15, 2
  v_readlane_b32 s71, v15, 3
  v_readlane_b32 s72, v15, 4
  v_readlane_b32 s73, v15, 5
  v_readlane_b32 s74, v15, 6
  v_readlane_b32 s75, v15, 7
  v_cmp_eq_u32 s[52:53], s68, v24
  v_cmp_eq_u32 s[54:55], s68, v25
  v_cmp_eq_u32 s[56:57], s68, v26
  v_cndmask_b32 v27, v27, 0, s[52:53]
  v_cndmask_b32 v28, v28, 0, s[54:55]
  v_cndmask_b32 v29, v29, 0, s[56:57]
  v_cmp_eq_u32 s[52:53], s69, v24
  v_cmp_eq_u32 s[54:55], s69, v25
  v_cmp_eq_u32 s[56:57], s69, v26
  v_cndmask_b32 v27, v27, 1, s[52:53]
  v_cndmask_b32 v28, v28, 1, s[54:55]
  v_cndmask_b32 v29, v29, 1, s[56:57]
  v_cmp_eq_u32 s[52:53], s70, v24
  v_cmp_eq_u32 s[54:55], s70, v25
  v_cmp_eq_u32 s[56:57], s70, v26
  v_cndmask_b32 v27, v27, 2, s[52:53]
  v_cndmask_b32 v28, v28, 2, s[54:55]
  v_cndmask_b32 v29, v29, 2, s[56:57]
  v_cmp_eq_u32 s[52:53], s71, v24
  v_cmp_eq_u32 s[54:55], s71, v25
  v_cmp_eq_u32 s[56:57], s71, v26
  v_cndmask_b32 v27, v27, 3, s[52:53]
  v_cndmask_b32 v28, v28, 3, s[54:55]
  v_cndmask_b32 v29, v29, 3, s[56:57]
  v_cmp_eq_u32 s[52:53], s72, v24
  v_cmp_eq_u32 s[54:55], s72, v25
  v_cmp_eq_u32 s[56:57], s72, v26
  v_cndmask_b32 v27, v27, 4, s[52:53]
  v_cndmask_b32 v28, v28, 4, s[54:55]
  v_cndmask_b32 v29, v29, 4, s[56:57]
  v_cmp_eq_u32 s[52:53], s73, v24
  v_cmp_eq_u32 s[54:55], s73, v25
  v_cmp_eq_u32 s[56:57], s73, v26
  v_cndmask_b32 v27, v27, 5, s[52:53]
  v_cndmask_b32 v28, v28, 5, s[54:55]
  v_cndmask_b32 v29, v29, 5, s[56:57]
  v_cmp_eq_u32 s[52:53], s74, v24
  v_cmp_eq_u32 s[54:55], s74, v25
  v_cmp_eq_u32 s[56:57], s74, v26
  v_cndmask_b32 v27, v27, 6, s[52:53]
  v_cndmask_b32 v28, v28, 6, s[54:55]
  v_cndmask_b32 v29, v29, 6, s[56:57]
  v_cmp_eq_u32 s[52:53], s75, v24
  v_cmp_eq_u32 s[54:55], s75, v25
  v_cmp_eq_u32 s[56:57], s75, v26
  v_cndmask_b32 v27, v27, 7, s[52:53]
  v_cndmask_b32 v28, v28, 7, s[54:55]
  v_cndmask_b32 v29, v29, 7, s[56:57]
  v_mul_u32_u24 v27, 320, v27
  v_add_u32 v203, v203, v27
  v_mul_u32_u24 v28, 320, v28
  v_add_u32 v204, v204, v28
  v_mul_u32_u24 v29, 320, v29
  v_add_u32 v205, v205, v29
  v_add_u32 v203, 155648, v203
  v_add_u32 v204, 155648, v204
  v_add_u32 v205, 155648, v205
  s_waitcnt vmcnt(12)
  v_cmp_eq_u32 vcc, 0, v13
  s_cbranch_vccnz fa_ctx_spin
fa_ctx_ok:
  buffer_load_dwordx4 a[144:147], v2, s[40:43], s64 offen offset:0 sc1
  buffer_load_dwordx4 a[148:151], v2, s[40:43], s65 offen offset:0 sc1
  buffer_load_dwordx4 a[152:155], v2, s[40:43], s66 offen offset:0 sc1
  buffer_load_dwordx4 a[156:159], v2, s[40:43], s67 offen offset:0 sc1
  buffer_load_dwordx4 a[160:163], v2, s[40:43], s64 offen offset:1024 sc1
  buffer_load_dwordx4 a[164:167], v2, s[40:43], s65 offen offset:1024 sc1
  buffer_load_dwordx4 a[168:171], v2, s[40:43], s66 offen offset:1024 sc1
  buffer_load_dwordx4 a[172:175], v2, s[40:43], s67 offen offset:1024 sc1
  buffer_load_dwordx4 a[176:179], v2, s[40:43], s64 offen offset:2048 sc1
  buffer_load_dwordx4 a[180:183], v2, s[40:43], s65 offen offset:2048 sc1
  buffer_load_dwordx4 a[184:187], v2, s[40:43], s66 offen offset:2048 sc1
  buffer_load_dwordx4 a[188:191], v2, s[40:43], s67 offen offset:2048 sc1
  buffer_load_dwordx4 v[216:219], v2, s[40:43], s64 offen offset:3072 sc1
  buffer_load_dwordx4 v[220:223], v2, s[40:43], s65 offen offset:3072 sc1
  buffer_load_dwordx4 v[224:227], v2, s[40:43], s66 offen offset:3072 sc1
  buffer_load_dwordx4 v[228:231], v2, s[40:43], s67 offen offset:3072 sc1
  s_add_u32 s64, s64, 4096
  s_add_u32 s65, s65, 4096
  s_add_u32 s66, s66, 4096
  s_add_u32 s67, s67, 4096
  s_waitcnt vmcnt(12)
  v_mfma_f32_16x16x32_bf16 a[64:67], a[0:3], a[144:147], 0
  v_mfma_f32_16x16x32_bf16 a[68:71], a[0:3], a[148:151], 0
  v_mfma_f32_16x16x32_bf16 a[72:75], a[0:3], a[152:155], 0
  v_mfma_f32_16x16x32_bf16 a[76:79], a[0:3], a[156:159], 0
  buffer_load_dwordx4 a[0:3], v2, s[40:43], s13 offen offset:0 sc1
  v_mfma_f32_16x16x32_bf16 a[80:83], a[4:7], a[144:147], 0
  v_mfma_f32_16x16x32_bf16 a[84:87], a[4:7], a[148:151], 0
  v_mfma_f32_16x16x32_bf16 a[88:91], a[4:7], a[152:155], 0
  v_mfma_f32_16x16x32_bf16 a[92:95], a[4:7], a[156:159], 0
  buffer_load_dwordx4 a[4:7], v2, s[40:43], s13 offen offset:1024 sc1
  v_mfma_f32_16x16x32_bf16 a[96:99], a[8:11], a[144:147], 0
  v_mfma_f32_16x16x32_bf16 a[100:103], a[8:11], a[148:151], 0
  v_mfma_f32_16x16x32_bf16 a[104:107], a[8:11], a[152:155], 0
  v_mfma_f32_16x16x32_bf16 a[108:111], a[8:11], a[156:159], 0
  buffer_load_dwordx4 a[8:11], v2, s[40:43], s13 offen offset:2048 sc1
  v_mfma_f32_16x16x32_bf16 a[112:115], a[12:15], a[144:147], 0
  v_mfma_f32_16x16x32_bf16 a[116:119], a[12:15], a[148:151], 0
  v_mfma_f32_16x16x32_bf16 a[120:123], a[12:15], a[152:155], 0
  v_mfma_f32_16x16x32_bf16 a[124:127], a[12:15], a[156:159], 0
  v_mfma_f32_16x16x32_bf16 a[128:131], a[16:19], a[144:147], 0
  buffer_load_dwordx4 a[144:147], v2, s[40:43], s64 offen offset:0 sc1
  v_mfma_f32_16x16x32_bf16 a[132:135], a[16:19], a[148:151], 0
  buffer_load_dwordx4 a[148:151], v2, s[40:43], s65 offen offset:0 sc1
  v_mfma_f32_16x16x32_bf16 a[136:139], a[16:19], a[152:155], 0
  buffer_load_dwordx4 a[152:155], v2, s[40:43], s66 offen offset:0 sc1
  v_mfma_f32_16x16x32_bf16 a[140:143], a[16:19], a[156:159], 0
  buffer_load_dwordx4 a[156:159], v2, s[40:43], s67 offen offset:0 sc1
  s_waitcnt vmcnt(15)
  v_mfma_f32_16x16x32_bf16 a[64:67], a[20:23], a[160:163], a[64:67]
  v_mfma_f32_16x16x32_bf16 a[68:71], a[20:23], a[164:167], a[68:71]
  v_mfma_f32_16x16x32_bf16 a[72:75], a[20:23], a[168:171], a[72:75]
  v_mfma_f32_16x16x32_bf16 a[76:79], a[20:23], a[172:175], a[76:79]
  buffer_load_dwordx4 a[12:15], v2, s[40:43], s13 offen offset:3072 sc1
  v_mfma_f32_16x16x32_bf16 a[80:83], a[24:27], a[160:163], a[80:83]
  s_add_u32 s13, s13, 4096
  v_mfma_f32_16x16x32_bf16 a[84:87], a[24:27], a[164:167], a[84:87]
  v_mfma_f32_16x16x32_bf16 a[88:91], a[24:27], a[168:171], a[88:91]
  v_mfma_f32_16x16x32_bf16 a[92:95], a[24:27], a[172:175], a[92:95]
  buffer_load_dwordx4 a[16:19], v2, s[40:43], s13 offen offset:0 sc1
  v_mfma_f32_16x16x32_bf16 a[96:99], a[28:31], a[160:163], a[96:99]
  v_mfma_f32_16x16x32_bf16 a[100:103], a[28:31], a[164:167], a[100:103]
  v_mfma_f32_16x16x32_bf16 a[104:107], a[28:31], a[168:171], a[104:107]
  v_mfma_f32_16x16x32_bf16 a[108:111], a[28:31], a[172:175], a[108:111]
  v_mfma_f32_16x16x32_bf16 a[112:115], a[32:35], a[160:163], a[112:115]
  v_mfma_f32_16x16x32_bf16 a[116:119], a[32:35], a[164:167], a[116:119]
  v_mfma_f32_16x16x32_bf16 a[120:123], a[32:35], a[168:171], a[120:123]
  v_mfma_f32_16x16x32_bf16 a[124:127], a[32:35], a[172:175], a[124:127]
  v_mfma_f32_16x16x32_bf16 a[128:131], a[36:39], a[160:163], a[128:131]
  buffer_load_dwordx4 a[160:163], v2, s[40:43], s64 offen offset:1024 sc1
  v_mfma_f32_16x16x32_bf16 a[132:135], a[36:39], a[164:167], a[132:135]
  buffer_load_dwordx4 a[164:167], v2, s[40:43], s65 offen offset:1024 sc1
  v_mfma_f32_16x16x32_bf16 a[136:139], a[36:39], a[168:171], a[136:139]
  buffer_load_dwordx4 a[168:171], v2, s[40:43], s66 offen offset:1024 sc1
  v_mfma_f32_16x16x32_bf16 a[140:143], a[36:39], a[172:175], a[140:143]
  buffer_load_dwordx4 a[172:175], v2, s[40:43], s67 offen offset:1024 sc1
  s_waitcnt vmcnt(17)
  v_mfma_f32_16x16x32_bf16 a[64:67], a[40:43], a[176:179], a[64:67]
  v_mfma_f32_16x16x32_bf16 a[68:71], a[40:43], a[180:183], a[68:71]
  v_mfma_f32_16x16x32_bf16 a[72:75], a[40:43], a[184:187], a[72:75]
  v_mfma_f32_16x16x32_bf16 a[76:79], a[40:43], a[188:191], a[76:79]
  buffer_load_dwordx4 a[20:23], v2, s[40:43], s13 offen offset:1024 sc1
  v_mfma_f32_16x16x32_bf16 a[80:83], a[44:47], a[176:179], a[80:83]
  v_mfma_f32_16x16x32_bf16 a[84:87], a[44:47], a[180:183], a[84:87]
  v_mfma_f32_16x16x32_bf16 a[88:91], a[44:47], a[184:187], a[88:91]
  v_mfma_f32_16x16x32_bf16 a[92:95], a[44:47], a[188:191], a[92:95]
  buffer_load_dwordx4 a[24:27], v2, s[40:43], s13 offen offset:2048 sc1
  v_mfma_f32_16x16x32_bf16 a[96:99], a[48:51], a[176:179], a[96:99]
  v_mfma_f32_16x16x32_bf16 a[100:103], a[48:51], a[180:183], a[100:103]
  v_mfma_f32_16x16x32_bf16 a[104:107], a[48:51], a[184:187], a[104:107]
  v_mfma_f32_16x16x32_bf16 a[108:111], a[48:51], a[188:191], a[108:111]
  v_mfma_f32_16x16x32_bf16 a[112:115], a[52:55], a[176:179], a[112:115]
  v_mfma_f32_16x16x32_bf16 a[116:119], a[52:55], a[180:183], a[116:119]
  v_mfma_f32_16x16x32_bf16 a[120:123], a[52:55], a[184:187], a[120:123]
  v_mfma_f32_16x16x32_bf16 a[124:127], a[52:55], a[188:191], a[124:127]
  v_mfma_f32_16x16x32_bf16 a[128:131], a[56:59], a[176:179], a[128:131]
  buffer_load_dwordx4 a[176:179], v2, s[40:43], s64 offen offset:2048 sc1
  v_mfma_f32_16x16x32_bf16 a[132:135], a[56:59], a[180:183], a[132:135]
  buffer_load_dwordx4 a[180:183], v2, s[40:43], s65 offen offset:2048 sc1
  v_mfma_f32_16x16x32_bf16 a[136:139], a[56:59], a[184:187], a[136:139]
  buffer_load_dwordx4 a[184:187], v2, s[40:43], s66 offen offset:2048 sc1
  v_mfma_f32_16x16x32_bf16 a[140:143], a[56:59], a[188:191], a[140:143]
  buffer_load_dwordx4 a[188:191], v2, s[40:43], s67 offen offset:2048 sc1
  s_waitcnt vmcnt(19)
  v_mfma_f32_16x16x32_bf16 a[64:67], a[60:63], v[216:219], a[64:67]
  v_mfma_f32_16x16x32_bf16 a[68:71], a[60:63], v[220:223], a[68:71]
  v_mfma_f32_16x16x32_bf16 a[72:75], a[60:63], v[224:227], a[72:75]
  v_mfma_f32_16x16x32_bf16 a[76:79], a[60:63], v[228:231], a[76:79]
  buffer_load_dwordx4 a[28:31], v2, s[40:43], s13 offen offset:3072 sc1
  v_mfma_f32_16x16x32_bf16 a[80:83], a[192:195], v[216:219], a[80:83]
  s_add_u32 s13, s13, 4096
  v_mfma_f32_16x16x32_bf16 a[84:87], a[192:195], v[220:223], a[84:87]
  v_mfma_f32_16x16x32_bf16 a[88:91], a[192:195], v[224:227], a[88:91]
  v_mfma_f32_16x16x32_bf16 a[92:95], a[192:195], v[228:231], a[92:95]
  buffer_load_dwordx4 a[32:35], v2, s[40:43], s13 offen offset:0 sc1
  v_mfma_f32_16x16x32_bf16 a[96:99], a[196:199], v[216:219], a[96:99]
  v_mfma_f32_16x16x32_bf16 a[100:103], a[196:199], v[220:223], a[100:103]
  v_mfma_f32_16x16x32_bf16 a[104:107], a[196:199], v[224:227], a[104:107]
  v_mfma_f32_16x16x32_bf16 a[108:111], a[196:199], v[228:231], a[108:111]
  v_mfma_f32_16x16x32_bf16 a[112:115], a[200:203], v[216:219], a[112:115]
  v_mfma_f32_16x16x32_bf16 a[116:119], a[200:203], v[220:223], a[116:119]
  v_mfma_f32_16x16x32_bf16 a[120:123], a[200:203], v[224:227], a[120:123]
  v_mfma_f32_16x16x32_bf16 a[124:127], a[200:203], v[228:231], a[124:127]
  v_mfma_f32_16x16x32_bf16 a[128:131], a[204:207], v[216:219], a[128:131]
  buffer_load_dwordx4 v[216:219], v2, s[40:43], s64 offen offset:3072 sc1
  v_mfma_f32_16x16x32_bf16 a[132:135], a[204:207], v[220:223], a[132:135]
  buffer_load_dwordx4 v[220:223], v2, s[40:43], s65 offen offset:3072 sc1
  v_mfma_f32_16x16x32_bf16 a[136:139], a[204:207], v[224:227], a[136:139]
  buffer_load_dwordx4 v[224:227], v2, s[40:43], s66 offen offset:3072 sc1
  v_mfma_f32_16x16x32_bf16 a[140:143], a[204:207], v[228:231], a[140:143]
  buffer_load_dwordx4 v[228:231], v2, s[40:43], s67 offen offset:3072 sc1
  s_waitcnt vmcnt(18)
  v_mfma_f32_16x16x32_bf16 a[64:67], a[208:211], a[144:147], a[64:67]
  s_add_u32 s64, s64, 4096
  v_mfma_f32_16x16x32_bf16 a[68:71], a[208:211], a[148:151], a[68:71]
  s_add_u32 s65, s65, 4096
  v_mfma_f32_16x16x32_bf16 a[72:75], a[208:211], a[152:155], a[72:75]
  s_add_u32 s66, s66, 4096
  v_mfma_f32_16x16x32_bf16 a[76:79], a[208:211], a[156:159], a[76:79]
  buffer_load_dwordx4 a[36:39], v2, s[40:43], s13 offen offset:1024 sc1
  v_mfma_f32_16x16x32_bf16 a[80:83], a[212:215], a[144:147], a[80:83]
  v_mfma_f32_16x16x32_bf16 a[84:87], a[212:215], a[148:151], a[84:87]
  v_mfma_f32_16x16x32_bf16 a[88:91], a[212:215], a[152:155], a[88:91]
  s_add_u32 s67, s67, 4096
  v_mfma_f32_16x16x32_bf16 a[92:95], a[212:215], a[156:159], a[92:95]
  buffer_load_dwordx4 a[40:43], v2, s[40:43], s13 offen offset:2048 sc1
  v_mfma_f32_16x16x32_bf16 a[96:99], a[216:219], a[144:147], a[96:99]
  v_mfma_f32_16x16x32_bf16 a[100:103], a[216:219], a[148:151], a[100:103]
  v_mfma_f32_16x16x32_bf16 a[104:107], a[216:219], a[152:155], a[104:107]
  v_mfma_f32_16x16x32_bf16 a[108:111], a[216:219], a[156:159], a[108:111]
  v_mfma_f32_16x16x32_bf16 a[112:115], a[220:223], a[144:147], a[112:115]
  v_mfma_f32_16x16x32_bf16 a[116:119], a[220:223], a[148:151], a[116:119]
  v_mfma_f32_16x16x32_bf16 a[120:123], a[220:223], a[152:155], a[120:123]
  v_mfma_f32_16x16x32_bf16 a[124:127], a[220:223], a[156:159], a[124:127]
  v_mfma_f32_16x16x32_bf16 a[128:131], a[224:227], a[144:147], a[128:131]
  buffer_load_dwordx4 a[144:147], v2, s[40:43], s64 offen offset:0 sc1
  v_mfma_f32_16x16x32_bf16 a[132:135], a[224:227], a[148:151], a[132:135]
  buffer_load_dwordx4 a[148:151], v2, s[40:43], s65 offen offset:0 sc1
  v_mfma_f32_16x16x32_bf16 a[136:139], a[224:227], a[152:155], a[136:139]
  buffer_load_dwordx4 a[152:155], v2, s[40:43], s66 offen offset:0 sc1
  v_mfma_f32_16x16x32_bf16 a[140:143], a[224:227], a[156:159], a[140:143]
  buffer_load_dwordx4 a[156:159], v2, s[40:43], s67 offen offset:0 sc1
  s_waitcnt vmcnt(18)
  v_mfma_f32_16x16x32_bf16 a[64:67], a[228:231], a[160:163], a[64:67]
  v_mfma_f32_16x16x32_bf16 a[68:71], a[228:231], a[164:167], a[68:71]
  v_mfma_f32_16x16x32_bf16 a[72:75], a[228:231], a[168:171], a[72:75]
  v_mfma_f32_16x16x32_bf16 a[76:79], a[228:231], a[172:175], a[76:79]
  buffer_load_dwordx4 a[44:47], v2, s[40:43], s13 offen offset:3072 sc1
  v_mfma_f32_16x16x32_bf16 a[80:83], a[232:235], a[160:163], a[80:83]
  s_add_u32 s13, s13, 4096
  v_mfma_f32_16x16x32_bf16 a[84:87], a[232:235], a[164:167], a[84:87]
  v_mfma_f32_16x16x32_bf16 a[88:91], a[232:235], a[168:171], a[88:91]
  v_mfma_f32_16x16x32_bf16 a[92:95], a[232:235], a[172:175], a[92:95]
  buffer_load_dwordx4 a[48:51], v2, s[40:43], s13 offen offset:0 sc1
  v_mfma_f32_16x16x32_bf16 a[96:99], a[236:239], a[160:163], a[96:99]
  v_mfma_f32_16x16x32_bf16 a[100:103], a[236:239], a[164:167], a[100:103]
  v_mfma_f32_16x16x32_bf16 a[104:107], a[236:239], a[168:171], a[104:107]
  v_mfma_f32_16x16x32_bf16 a[108:111], a[236:239], a[172:175], a[108:111]
  buffer_load_dwordx4 a[52:55], v2, s[40:43], s13 offen offset:1024 sc1
  v_mfma_f32_16x16x32_bf16 a[112:115], a[240:243], a[160:163], a[112:115]
  v_mfma_f32_16x16x32_bf16 a[116:119], a[240:243], a[164:167], a[116:119]
  v_mfma_f32_16x16x32_bf16 a[120:123], a[240:243], a[168:171], a[120:123]
  v_mfma_f32_16x16x32_bf16 a[124:127], a[240:243], a[172:175], a[124:127]
  v_mfma_f32_16x16x32_bf16 a[128:131], a[244:247], a[160:163], a[128:131]
  buffer_load_dwordx4 a[160:163], v2, s[40:43], s64 offen offset:1024 sc1
  v_mfma_f32_16x16x32_bf16 a[132:135], a[244:247], a[164:167], a[132:135]
  buffer_load_dwordx4 a[164:167], v2, s[40:43], s65 offen offset:1024 sc1
  v_mfma_f32_16x16x32_bf16 a[136:139], a[244:247], a[168:171], a[136:139]
  buffer_load_dwordx4 a[168:171], v2, s[40:43], s66 offen offset:1024 sc1
  v_mfma_f32_16x16x32_bf16 a[140:143], a[244:247], a[172:175], a[140:143]
  buffer_load_dwordx4 a[172:175], v2, s[40:43], s67 offen offset:1024 sc1
  s_waitcnt vmcnt(19)
  v_mfma_f32_16x16x32_bf16 a[64:67], a[248:251], a[176:179], a[64:67]
  v_mfma_f32_16x16x32_bf16 a[68:71], a[248:251], a[180:183], a[68:71]
  v_mfma_f32_16x16x32_bf16 a[72:75], a[248:251], a[184:187], a[72:75]
  v_mfma_f32_16x16x32_bf16 a[76:79], a[248:251], a[188:191], a[76:79]
  buffer_load_dwordx4 a[56:59], v2, s[40:43], s13 offen offset:2048 sc1
  v_mfma_f32_16x16x32_bf16 a[80:83], a[252:255], a[176:179], a[80:83]
  v_mfma_f32_16x16x32_bf16 a[84:87], a[252:255], a[180:183], a[84:87]
  v_mfma_f32_16x16x32_bf16 a[88:91], a[252:255], a[184:187], a[88:91]
  v_mfma_f32_16x16x32_bf16 a[92:95], a[252:255], a[188:191], a[92:95]
  buffer_load_dwordx4 a[60:63], v2, s[40:43], s13 offen offset:3072 sc1
  v_mfma_f32_16x16x32_bf16 a[96:99], v[32:35], a[176:179], a[96:99]
  s_add_u32 s13, s13, 4096
  v_mfma_f32_16x16x32_bf16 a[100:103], v[32:35], a[180:183], a[100:103]
  v_mfma_f32_16x16x32_bf16 a[104:107], v[32:35], a[184:187], a[104:107]
  v_mfma_f32_16x16x32_bf16 a[108:111], v[32:35], a[188:191], a[108:111]
  v_mfma_f32_16x16x32_bf16 a[112:115], v[36:39], a[176:179], a[112:115]
  v_mfma_f32_16x16x32_bf16 a[116:119], v[36:39], a[180:183], a[116:119]
  v_mfma_f32_16x16x32_bf16 a[120:123], v[36:39], a[184:187], a[120:123]
  v_mfma_f32_16x16x32_bf16 a[124:127], v[36:39], a[188:191], a[124:127]
  v_mfma_f32_16x16x32_bf16 a[128:131], v[40:43], a[176:179], a[128:131]
  buffer_load_dwordx4 a[176:179], v2, s[40:43], s64 offen offset:2048 sc1
  v_mfma_f32_16x16x32_bf16 a[132:135], v[40:43], a[180:183], a[132:135]
  buffer_load_dwordx4 a[180:183], v2, s[40:43], s65 offen offset:2048 sc1
  v_mfma_f32_16x16x32_bf16 a[136:139], v[40:43], a[184:187], a[136:139]
  buffer_load_dwordx4 a[184:187], v2, s[40:43], s66 offen offset:2048 sc1
  v_mfma_f32_16x16x32_bf16 a[140:143], v[40:43], a[188:191], a[140:143]
  buffer_load_dwordx4 a[188:191], v2, s[40:43], s67 offen offset:2048 sc1
  s_waitcnt vmcnt(19)
  v_mfma_f32_16x16x32_bf16 a[64:67], v[44:47], v[216:219], a[64:67]
  v_mfma_f32_16x16x32_bf16 a[68:71], v[44:47], v[220:223], a[68:71]
  v_mfma_f32_16x16x32_bf16 a[72:75], v[44:47], v[224:227], a[72:75]
  v_mfma_f32_16x16x32_bf16 a[76:79], v[44:47], v[228:231], a[76:79]
  buffer_load_dwordx4 a[192:195], v2, s[40:43], s13 offen offset:0 sc1
  v_mfma_f32_16x16x32_bf16 a[80:83], v[48:51], v[216:219], a[80:83]
  v_mfma_f32_16x16x32_bf16 a[84:87], v[48:51], v[220:223], a[84:87]
  v_mfma_f32_16x16x32_bf16 a[88:91], v[48:51], v[224:227], a[88:91]
  v_mfma_f32_16x16x32_bf16 a[92:95], v[48:51], v[228:231], a[92:95]
  buffer_load_dwordx4 a[196:199], v2, s[40:43], s13 offen offset:1024 sc1
  v_mfma_f32_16x16x32_bf16 a[96:99], v[52:55], v[216:219], a[96:99]
  v_mfma_f32_16x16x32_bf16 a[100:103], v[52:55], v[220:223], a[100:103]
  v_mfma_f32_16x16x32_bf16 a[104:107], v[52:55], v[224:227], a[104:107]
  v_mfma_f32_16x16x32_bf16 a[108:111], v[52:55], v[228:231], a[108:111]
  v_mfma_f32_16x16x32_bf16 a[112:115], v[56:59], v[216:219], a[112:115]
  v_mfma_f32_16x16x32_bf16 a[116:119], v[56:59], v[220:223], a[116:119]
  v_mfma_f32_16x16x32_bf16 a[120:123], v[56:59], v[224:227], a[120:123]
  v_mfma_f32_16x16x32_bf16 a[124:127], v[56:59], v[228:231], a[124:127]
  v_mfma_f32_16x16x32_bf16 a[128:131], v[60:63], v[216:219], a[128:131]
  buffer_load_dwordx4 v[216:219], v2, s[40:43], s64 offen offset:3072 sc1
  v_mfma_f32_16x16x32_bf16 a[132:135], v[60:63], v[220:223], a[132:135]
  buffer_load_dwordx4 v[220:223], v2, s[40:43], s65 offen offset:3072 sc1
  v_mfma_f32_16x16x32_bf16 a[136:139], v[60:63], v[224:227], a[136:139]
  buffer_load_dwordx4 v[224:227], v2, s[40:43], s66 offen offset:3072 sc1
  v_mfma_f32_16x16x32_bf16 a[140:143], v[60:63], v[228:231], a[140:143]
  buffer_load_dwordx4 v[228:231], v2, s[40:43], s67 offen offset:3072 sc1
  s_waitcnt vmcnt(19)
  v_mfma_f32_16x16x32_bf16 a[64:67], v[96:99], a[144:147], a[64:67]
  s_add_u32 s64, s64, 4096
  v_mfma_f32_16x16x32_bf16 a[68:71], v[96:99], a[148:151], a[68:71]
  s_add_u32 s65, s65, 4096
  v_mfma_f32_16x16x32_bf16 a[72:75], v[96:99], a[152:155], a[72:75]
  s_add_u32 s66, s66, 4096
  v_mfma_f32_16x16x32_bf16 a[76:79], v[96:99], a[156:159], a[76:79]
  buffer_load_dwordx4 a[200:203], v2, s[40:43], s13 offen offset:2048 sc1
  v_mfma_f32_16x16x32_bf16 a[80:83], v[100:103], a[144:147], a[80:83]
  v_mfma_f32_16x16x32_bf16 a[84:87], v[100:103], a[148:151], a[84:87]
  v_mfma_f32_16x16x32_bf16 a[88:91], v[100:103], a[152:155], a[88:91]
  s_add_u32 s67, s67, 4096
  v_mfma_f32_16x16x32_bf16 a[92:95], v[100:103], a[156:159], a[92:95]
  buffer_load_dwordx4 a[204:207], v2, s[40:43], s13 offen offset:3072 sc1
  v_mfma_f32_16x16x32_bf16 a[96:99], v[104:107], a[144:147], a[96:99]
  s_add_u32 s13, s13, 4096
  v_mfma_f32_16x16x32_bf16 a[100:103], v[104:107], a[148:151], a[100:103]
  v_mfma_f32_16x16x32_bf16 a[104:107], v[104:107], a[152:155], a[104:107]
  v_mfma_f32_16x16x32_bf16 a[108:111], v[104:107], a[156:159], a[108:111]
  v_mfma_f32_16x16x32_bf16 a[112:115], v[108:111], a[144:147], a[112:115]
  v_mfma_f32_16x16x32_bf16 a[116:119], v[108:111], a[148:151], a[116:119]
  v_mfma_f32_16x16x32_bf16 a[120:123], v[108:111], a[152:155], a[120:123]
  v_mfma_f32_16x16x32_bf16 a[124:127], v[108:111], a[156:159], a[124:127]
  v_mfma_f32_16x16x32_bf16 a[128:131], v[112:115], a[144:147], a[128:131]
  buffer_load_dwordx4 a[144:147], v2, s[40:43], s64 offen offset:0 sc1
  v_mfma_f32_16x16x32_bf16 a[132:135], v[112:115], a[148:151], a[132:135]
  buffer_load_dwordx4 a[148:151], v2, s[40:43], s65 offen offset:0 sc1
  v_mfma_f32_16x16x32_bf16 a[136:139], v[112:115], a[152:155], a[136:139]
  buffer_load_dwordx4 a[152:155], v2, s[40:43], s66 offen offset:0 sc1
  v_mfma_f32_16x16x32_bf16 a[140:143], v[112:115], a[156:159], a[140:143]
  buffer_load_dwordx4 a[156:159], v2, s[40:43], s67 offen offset:0 sc1
  s_waitcnt vmcnt(18)
  v_mfma_f32_16x16x32_bf16 a[64:67], v[116:119], a[160:163], a[64:67]
  v_mfma_f32_16x16x32_bf16 a[68:71], v[116:119], a[164:167], a[68:71]
  ds_read_b128 v[112:115], v11 offset:0
  v_mfma_f32_16x16x32_bf16 a[72:75], v[116:119], a[168:171], a[72:75]
  v_mfma_f32_16x16x32_bf16 a[76:79], v[116:119], a[172:175], a[76:79]
  buffer_load_dwordx4 a[208:211], v2, s[40:43], s13 offen offset:0 sc1
  v_mfma_f32_16x16x32_bf16 a[80:83], v[120:123], a[160:163], a[80:83]
  v_mfma_f32_16x16x32_bf16 a[84:87], v[120:123], a[164:167], a[84:87]
  v_mfma_f32_16x16x32_bf16 a[88:91], v[120:123], a[168:171], a[88:91]
  v_mfma_f32_16x16x32_bf16 a[92:95], v[120:123], a[172:175], a[92:95]
  buffer_load_dwordx4 a[212:215], v2, s[40:43], s13 offen offset:1024 sc1
  v_mfma_f32_16x16x32_bf16 a[96:99], v[124:127], a[160:163], a[96:99]
  v_mfma_f32_16x16x32_bf16 a[100:103], v[124:127], a[164:167], a[100:103]
  v_mfma_f32_16x16x32_bf16 a[104:107], v[124:127], a[168:171], a[104:107]
  v_mfma_f32_16x16x32_bf16 a[108:111], v[124:127], a[172:175], a[108:111]
  v_mfma_f32_16x16x32_bf16 a[112:115], v[160:163], a[160:163], a[112:115]
  v_mfma_f32_16x16x32_bf16 a[116:119], v[160:163], a[164:167], a[116:119]
  v_mfma_f32_16x16x32_bf16 a[120:123], v[160:163], a[168:171], a[120:123]
  v_mfma_f32_16x16x32_bf16 a[124:127], v[160:163], a[172:175], a[124:127]
  v_mfma_f32_16x16x32_bf16 a[128:131], v[164:167], a[160:163], a[128:131]
  buffer_load_dwordx4 a[160:163], v2, s[40:43], s64 offen offset:1024 sc1
  v_mfma_f32_16x16x32_bf16 a[132:135], v[164:167], a[164:167], a[132:135]
  buffer_load_dwordx4 a[164:167], v2, s[40:43], s65 offen offset:1024 sc1
  v_mfma_f32_16x16x32_bf16 a[136:139], v[164:167], a[168:171], a[136:139]
  buffer_load_dwordx4 a[168:171], v2, s[40:43], s66 offen offset:1024 sc1
  v_mfma_f32_16x16x32_bf16 a[140:143], v[164:167], a[172:175], a[140:143]
  buffer_load_dwordx4 a[172:175], v2, s[40:43], s67 offen offset:1024 sc1
  s_waitcnt vmcnt(18)
  v_mfma_f32_16x16x32_bf16 a[64:67], v[168:171], a[176:179], a[64:67]
  v_mfma_f32_16x16x32_bf16 a[68:71], v[168:171], a[180:183], a[68:71]
  ds_read_b128 v[116:119], v11 offset:1024
  v_mfma_f32_16x16x32_bf16 a[72:75], v[168:171], a[184:187], a[72:75]
  v_mfma_f32_16x16x32_bf16 a[76:79], v[168:171], a[188:191], a[76:79]
  buffer_load_dwordx4 a[216:219], v2, s[40:43], s13 offen offset:2048 sc1
  v_mfma_f32_16x16x32_bf16 a[80:83], v[172:175], a[176:179], a[80:83]
  v_mfma_f32_16x16x32_bf16 a[84:87], v[172:175], a[180:183], a[84:87]
  ds_read_b128 v[120:123], v11 offset:2048
  v_mfma_f32_16x16x32_bf16 a[88:91], v[172:175], a[184:187], a[88:91]
  v_mfma_f32_16x16x32_bf16 a[92:95], v[172:175], a[188:191], a[92:95]
  buffer_load_dwordx4 a[220:223], v2, s[40:43], s13 offen offset:3072 sc1
  v_mfma_f32_16x16x32_bf16 a[96:99], v[192:195], a[176:179], a[96:99]
  s_add_u32 s13, s13, 4096
  v_mfma_f32_16x16x32_bf16 a[100:103], v[192:195], a[180:183], a[100:103]
  ds_read_b128 v[124:127], v11 offset:3072
  v_mfma_f32_16x16x32_bf16 a[104:107], v[192:195], a[184:187], a[104:107]
  v_mfma_f32_16x16x32_bf16 a[108:111], v[192:195], a[188:191], a[108:111]
  buffer_load_dwordx4 a[224:227], v2, s[40:43], s13 offen offset:0 sc1
  v_mfma_f32_16x16x32_bf16 a[112:115], v[196:199], a[176:179], a[112:115]
  v_mfma_f32_16x16x32_bf16 a[116:119], v[196:199], a[180:183], a[116:119]
  ds_read_b128 v[160:163], v11 offset:4096
  v_mfma_f32_16x16x32_bf16 a[120:123], v[196:199], a[184:187], a[120:123]
  v_mfma_f32_16x16x32_bf16 a[124:127], v[196:199], a[188:191], a[124:127]
  v_mfma_f32_16x16x32_bf16 a[128:131], v[208:211], a[176:179], a[128:131]
  buffer_load_dwordx4 a[176:179], v2, s[40:43], s64 offen offset:2048 sc1
  v_mfma_f32_16x16x32_bf16 a[132:135], v[208:211], a[180:183], a[132:135]
  buffer_load_dwordx4 a[180:183], v2, s[40:43], s65 offen offset:2048 sc1
  v_mfma_f32_16x16x32_bf16 a[136:139], v[208:211], a[184:187], a[136:139]
  buffer_load_dwordx4 a[184:187], v2, s[40:43], s66 offen offset:2048 sc1
  v_mfma_f32_16x16x32_bf16 a[140:143], v[208:211], a[188:191], a[140:143]
  buffer_load_dwordx4 a[188:191], v2, s[40:43], s67 offen offset:2048 sc1
  s_waitcnt vmcnt(19)
  v_mfma_f32_16x16x32_bf16 a[64:67], v[212:215], v[216:219], a[64:67]
  v_mfma_f32_16x16x32_bf16 a[68:71], v[212:215], v[220:223], a[68:71]
  ds_read_b128 v[164:167], v11 offset:5120
  v_mfma_f32_16x16x32_bf16 a[72:75], v[212:215], v[224:227], a[72:75]
  v_mfma_f32_16x16x32_bf16 a[76:79], v[212:215], v[228:231], a[76:79]
  buffer_load_dwordx4 a[228:231], v2, s[40:43], s13 offen offset:1024 sc1
  v_mfma_f32_16x16x32_bf16 a[80:83], v[232:235], v[216:219], a[80:83]
  v_mfma_f32_16x16x32_bf16 a[84:87], v[232:235], v[220:223], a[84:87]
  ds_read_b128 v[168:171], v11 offset:6144
  v_mfma_f32_16x16x32_bf16 a[88:91], v[232:235], v[224:227], a[88:91]
  v_mfma_f32_16x16x32_bf16 a[92:95], v[232:235], v[228:231], a[92:95]
  buffer_load_dwordx4 a[232:235], v2, s[40:43], s13 offen offset:2048 sc1
  v_mfma_f32_16x16x32_bf16 a[96:99], v[236:239], v[216:219], a[96:99]
  v_mfma_f32_16x16x32_bf16 a[100:103], v[236:239], v[220:223], a[100:103]
  ds_read_b128 v[172:175], v11 offset:7168
  v_mfma_f32_16x16x32_bf16 a[104:107], v[236:239], v[224:227], a[104:107]
  v_mfma_f32_16x16x32_bf16 a[108:111], v[236:239], v[228:231], a[108:111]
  v_mfma_f32_16x16x32_bf16 a[112:115], v[240:243], v[216:219], a[112:115]
  v_mfma_f32_16x16x32_bf16 a[116:119], v[240:243], v[220:223], a[116:119]
  ds_read_b128 v[192:195], v11 offset:8192
  v_mfma_f32_16x16x32_bf16 a[120:123], v[240:243], v[224:227], a[120:123]
  v_mfma_f32_16x16x32_bf16 a[124:127], v[240:243], v[228:231], a[124:127]
  v_mfma_f32_16x16x32_bf16 a[128:131], v[244:247], v[216:219], a[128:131]
  buffer_load_dwordx4 v[216:219], v2, s[40:43], s64 offen offset:3072 sc1
  v_mfma_f32_16x16x32_bf16 a[132:135], v[244:247], v[220:223], a[132:135]
  buffer_load_dwordx4 v[220:223], v2, s[40:43], s65 offen offset:3072 sc1
  v_mfma_f32_16x16x32_bf16 a[136:139], v[244:247], v[224:227], a[136:139]
  buffer_load_dwordx4 v[224:227], v2, s[40:43], s66 offen offset:3072 sc1
  v_mfma_f32_16x16x32_bf16 a[140:143], v[244:247], v[228:231], a[140:143]
  buffer_load_dwordx4 v[228:231], v2, s[40:43], s67 offen offset:3072 sc1
  s_waitcnt vmcnt(19)
  v_mfma_f32_16x16x32_bf16 a[64:67], v[64:67], a[144:147], a[64:67]
  s_add_u32 s64, s64, 4096
  v_mfma_f32_16x16x32_bf16 a[68:71], v[64:67], a[148:151], a[68:71]
  s_add_u32 s65, s65, 4096
  ds_read_b128 v[196:199], v11 offset:9216
  v_mfma_f32_16x16x32_bf16 a[72:75], v[64:67], a[152:155], a[72:75]
  s_add_u32 s66, s66, 4096
  v_mfma_f32_16x16x32_bf16 a[76:79], v[64:67], a[156:159], a[76:79]
  buffer_load_dwordx4 a[236:239], v2, s[40:43], s13 offen offset:3072 sc1
  v_mfma_f32_16x16x32_bf16 a[80:83], v[68:71], a[144:147], a[80:83]
  s_add_u32 s13, s13, 4096
  v_mfma_f32_16x16x32_bf16 a[84:87], v[68:71], a[148:151], a[84:87]
  ds_read_b128 v[208:211], v11 offset:10240
  v_mfma_f32_16x16x32_bf16 a[88:91], v[68:71], a[152:155], a[88:91]
  s_add_u32 s67, s67, 4096
  v_mfma_f32_16x16x32_bf16 a[92:95], v[68:71], a[156:159], a[92:95]
  buffer_load_dwordx4 a[240:243], v2, s[40:43], s13 offen offset:0 sc1
  v_mfma_f32_16x16x32_bf16 a[96:99], v[72:75], a[144:147], a[96:99]
  v_mfma_f32_16x16x32_bf16 a[100:103], v[72:75], a[148:151], a[100:103]
  ds_read_b128 v[212:215], v11 offset:11264
  v_mfma_f32_16x16x32_bf16 a[104:107], v[72:75], a[152:155], a[104:107]
  v_mfma_f32_16x16x32_bf16 a[108:111], v[72:75], a[156:159], a[108:111]
  v_mfma_f32_16x16x32_bf16 a[112:115], v[76:79], a[144:147], a[112:115]
  v_mfma_f32_16x16x32_bf16 a[116:119], v[76:79], a[148:151], a[116:119]
  ds_read_b128 v[232:235], v11 offset:12288
  v_mfma_f32_16x16x32_bf16 a[120:123], v[76:79], a[152:155], a[120:123]
  v_mfma_f32_16x16x32_bf16 a[124:127], v[76:79], a[156:159], a[124:127]
  v_mfma_f32_16x16x32_bf16 a[128:131], v[80:83], a[144:147], a[128:131]
  buffer_load_dwordx4 a[144:147], v2, s[40:43], s64 offen offset:0 sc1
  v_mfma_f32_16x16x32_bf16 a[132:135], v[80:83], a[148:151], a[132:135]
  buffer_load_dwordx4 a[148:151], v2, s[40:43], s65 offen offset:0 sc1
  v_mfma_f32_16x16x32_bf16 a[136:139], v[80:83], a[152:155], a[136:139]
  buffer_load_dwordx4 a[152:155], v2, s[40:43], s66 offen offset:0 sc1
  v_mfma_f32_16x16x32_bf16 a[140:143], v[80:83], a[156:159], a[140:143]
  buffer_load_dwordx4 a[156:159], v2, s[40:43], s67 offen offset:0 sc1
  s_waitcnt vmcnt(19)
  v_mfma_f32_16x16x32_bf16 a[64:67], v[84:87], a[160:163], a[64:67]
  v_mfma_f32_16x16x32_bf16 a[68:71], v[84:87], a[164:167], a[68:71]
  ds_read_b128 v[236:239], v11 offset:13312
  v_mfma_f32_16x16x32_bf16 a[72:75], v[84:87], a[168:171], a[72:75]
  v_mfma_f32_16x16x32_bf16 a[76:79], v[84:87], a[172:175], a[76:79]
  buffer_load_dwordx4 a[244:247], v2, s[40:43], s13 offen offset:1024 sc1
  v_mfma_f32_16x16x32_bf16 a[80:83], v[88:91], a[160:163], a[80:83]
  v_mfma_f32_16x16x32_bf16 a[84:87], v[88:91], a[164:167], a[84:87]
  ds_read_b128 v[240:243], v11 offset:14336
  v_mfma_f32_16x16x32_bf16 a[88:91], v[88:91], a[168:171], a[88:91]
  v_mfma_f32_16x16x32_bf16 a[92:95], v[88:91], a[172:175], a[92:95]
  buffer_load_dwordx4 a[248:251], v2, s[40:43], s13 offen offset:2048 sc1
  v_mfma_f32_16x16x32_bf16 a[96:99], v[92:95], a[160:163], a[96:99]
  v_mfma_f32_16x16x32_bf16 a[100:103], v[92:95], a[164:167], a[100:103]
  ds_read_b128 v[244:247], v11 offset:15360
  v_mfma_f32_16x16x32_bf16 a[104:107], v[92:95], a[168:171], a[104:107]
  v_mfma_f32_16x16x32_bf16 a[108:111], v[92:95], a[172:175], a[108:111]
  v_mfma_f32_16x16x32_bf16 a[112:115], v[128:131], a[160:163], a[112:115]
  v_mfma_f32_16x16x32_bf16 a[116:119], v[128:131], a[164:167], a[116:119]
  ds_read_b128 v[64:67], v11 offset:16384
  v_mfma_f32_16x16x32_bf16 a[120:123], v[128:131], a[168:171], a[120:123]
  v_mfma_f32_16x16x32_bf16 a[124:127], v[128:131], a[172:175], a[124:127]
  v_mfma_f32_16x16x32_bf16 a[128:131], v[132:135], a[160:163], a[128:131]
  buffer_load_dwordx4 a[160:163], v2, s[40:43], s64 offen offset:1024 sc1
  v_mfma_f32_16x16x32_bf16 a[132:135], v[132:135], a[164:167], a[132:135]
  buffer_load_dwordx4 a[164:167], v2, s[40:43], s65 offen offset:1024 sc1
  v_mfma_f32_16x16x32_bf16 a[136:139], v[132:135], a[168:171], a[136:139]
  buffer_load_dwordx4 a[168:171], v2, s[40:43], s66 offen offset:1024 sc1
  v_mfma_f32_16x16x32_bf16 a[140:143], v[132:135], a[172:175], a[140:143]
  buffer_load_dwordx4 a[172:175], v2, s[40:43], s67 offen offset:1024 sc1
  s_waitcnt vmcnt(18)
  v_mfma_f32_16x16x32_bf16 a[64:67], v[136:139], a[176:179], a[64:67]
  v_mfma_f32_16x16x32_bf16 a[68:71], v[136:139], a[180:183], a[68:71]
  ds_read_b128 v[68:71], v11 offset:17408
  v_mfma_f32_16x16x32_bf16 a[72:75], v[136:139], a[184:187], a[72:75]
  v_mfma_f32_16x16x32_bf16 a[76:79], v[136:139], a[188:191], a[76:79]
  buffer_load_dwordx4 a[252:255], v2, s[40:43], s13 offen offset:3072 sc1
  v_mfma_f32_16x16x32_bf16 a[80:83], v[140:143], a[176:179], a[80:83]
  s_add_u32 s13, s13, 4096
  v_mfma_f32_16x16x32_bf16 a[84:87], v[140:143], a[180:183], a[84:87]
  ds_read_b128 v[72:75], v11 offset:18432
  v_mfma_f32_16x16x32_bf16 a[88:91], v[140:143], a[184:187], a[88:91]
  v_mfma_f32_16x16x32_bf16 a[92:95], v[140:143], a[188:191], a[92:95]
  buffer_load_dwordx4 v[32:35], v2, s[40:43], s13 offen offset:0 sc1
  v_mfma_f32_16x16x32_bf16 a[96:99], v[144:147], a[176:179], a[96:99]
  v_mfma_f32_16x16x32_bf16 a[100:103], v[144:147], a[180:183], a[100:103]
  ds_read_b128 v[76:79], v11 offset:19456
  v_mfma_f32_16x16x32_bf16 a[104:107], v[144:147], a[184:187], a[104:107]
  v_mfma_f32_16x16x32_bf16 a[108:111], v[144:147], a[188:191], a[108:111]
  v_mfma_f32_16x16x32_bf16 a[112:115], v[148:151], a[176:179], a[112:115]
  v_mfma_f32_16x16x32_bf16 a[116:119], v[148:151], a[180:183], a[116:119]
  ds_read_b128 v[80:83], v11 offset:20480
  v_mfma_f32_16x16x32_bf16 a[120:123], v[148:151], a[184:187], a[120:123]
  v_mfma_f32_16x16x32_bf16 a[124:127], v[148:151], a[188:191], a[124:127]
  v_mfma_f32_16x16x32_bf16 a[128:131], v[152:155], a[176:179], a[128:131]
  buffer_load_dwordx4 a[176:179], v2, s[40:43], s64 offen offset:2048 sc1
  v_mfma_f32_16x16x32_bf16 a[132:135], v[152:155], a[180:183], a[132:135]
  buffer_load_dwordx4 a[180:183], v2, s[40:43], s65 offen offset:2048 sc1
  v_mfma_f32_16x16x32_bf16 a[136:139], v[152:155], a[184:187], a[136:139]
  buffer_load_dwordx4 a[184:187], v2, s[40:43], s66 offen offset:2048 sc1
  v_mfma_f32_16x16x32_bf16 a[140:143], v[152:155], a[188:191], a[140:143]
  buffer_load_dwordx4 a[188:191], v2, s[40:43], s67 offen offset:2048 sc1
  s_waitcnt vmcnt(18)
  v_mfma_f32_16x16x32_bf16 a[64:67], v[156:159], v[216:219], a[64:67]
  v_mfma_f32_16x16x32_bf16 a[68:71], v[156:159], v[220:223], a[68:71]
  ds_read_b128 v[84:87], v11 offset:21504
  v_mfma_f32_16x16x32_bf16 a[72:75], v[156:159], v[224:227], a[72:75]
  v_mfma_f32_16x16x32_bf16 a[76:79], v[156:159], v[228:231], a[76:79]
  buffer_load_dwordx4 v[36:39], v2, s[40:43], s13 offen offset:1024 sc1
  v_mfma_f32_16x16x32_bf16 a[80:83], v[176:179], v[216:219], a[80:83]
  v_mfma_f32_16x16x32_bf16 a[84:87], v[176:179], v[220:223], a[84:87]
  ds_read_b128 v[88:91], v11 offset:22528
  v_mfma_f32_16x16x32_bf16 a[88:91], v[176:179], v[224:227], a[88:91]
  v_mfma_f32_16x16x32_bf16 a[92:95], v[176:179], v[228:231], a[92:95]
  buffer_load_dwordx4 v[40:43], v2, s[40:43], s13 offen offset:2048 sc1
  v_mfma_f32_16x16x32_bf16 a[96:99], v[180:183], v[216:219], a[96:99]
  v_mfma_f32_16x16x32_bf16 a[100:103], v[180:183], v[220:223], a[100:103]
  ds_read_b128 v[92:95], v11 offset:23552
  v_mfma_f32_16x16x32_bf16 a[104:107], v[180:183], v[224:227], a[104:107]
  v_mfma_f32_16x16x32_bf16 a[108:111], v[180:183], v[228:231], a[108:111]
  buffer_load_dwordx4 v[44:47], v2, s[40:43], s13 offen offset:3072 sc1
  v_mfma_f32_16x16x32_bf16 a[112:115], v[184:187], v[216:219], a[112:115]
  s_add_u32 s13, s13, 4096
  v_mfma_f32_16x16x32_bf16 a[116:119], v[184:187], v[220:223], a[116:119]
  ds_read_b128 v[128:131], v11 offset:24576
  v_mfma_f32_16x16x32_bf16 a[120:123], v[184:187], v[224:227], a[120:123]
  v_mfma_f32_16x16x32_bf16 a[124:127], v[184:187], v[228:231], a[124:127]
  v_mfma_f32_16x16x32_bf16 a[128:131], v[188:191], v[216:219], a[128:131]
  buffer_load_dwordx4 v[216:219], v2, s[40:43], s64 offen offset:3072 sc1
  v_mfma_f32_16x16x32_bf16 a[132:135], v[188:191], v[220:223], a[132:135]
  buffer_load_dwordx4 v[220:223], v2, s[40:43], s65 offen offset:3072 sc1
  v_mfma_f32_16x16x32_bf16 a[136:139], v[188:191], v[224:227], a[136:139]
  buffer_load_dwordx4 v[224:227], v2, s[40:43], s66 offen offset:3072 sc1
  v_mfma_f32_16x16x32_bf16 a[140:143], v[188:191], v[228:231], a[140:143]
  buffer_load_dwordx4 v[228:231], v2, s[40:43], s67 offen offset:3072 sc1
  s_waitcnt vmcnt(19)
  v_mfma_f32_16x16x32_bf16 a[64:67], a[0:3], a[144:147], a[64:67]
  s_add_u32 s64, s64, 4096
  v_mfma_f32_16x16x32_bf16 a[68:71], a[0:3], a[148:151], a[68:71]
  s_add_u32 s65, s65, 4096
  ds_read_b128 v[132:135], v11 offset:25600
  v_mfma_f32_16x16x32_bf16 a[72:75], a[0:3], a[152:155], a[72:75]
  s_add_u32 s66, s66, 4096
  v_mfma_f32_16x16x32_bf16 a[76:79], a[0:3], a[156:159], a[76:79]
  buffer_load_dwordx4 v[48:51], v2, s[40:43], s13 offen offset:0 sc1
  v_mfma_f32_16x16x32_bf16 a[80:83], a[4:7], a[144:147], a[80:83]
  v_mfma_f32_16x16x32_bf16 a[84:87], a[4:7], a[148:151], a[84:87]
  ds_read_b128 v[136:139], v11 offset:26624
  v_mfma_f32_16x16x32_bf16 a[88:91], a[4:7], a[152:155], a[88:91]
  s_add_u32 s67, s67, 4096
  v_mfma_f32_16x16x32_bf16 a[92:95], a[4:7], a[156:159], a[92:95]
  buffer_load_dwordx4 v[52:55], v2, s[40:43], s13 offen offset:1024 sc1
  v_mfma_f32_16x16x32_bf16 a[96:99], a[8:11], a[144:147], a[96:99]
  v_mfma_f32_16x16x32_bf16 a[100:103], a[8:11], a[148:151], a[100:103]
  ds_read_b128 v[140:143], v11 offset:27648
  v_mfma_f32_16x16x32_bf16 a[104:107], a[8:11], a[152:155], a[104:107]
  v_mfma_f32_16x16x32_bf16 a[108:111], a[8:11], a[156:159], a[108:111]
  v_mfma_f32_16x16x32_bf16 a[112:115], a[12:15], a[144:147], a[112:115]
  v_mfma_f32_16x16x32_bf16 a[116:119], a[12:15], a[148:151], a[116:119]
  ds_read_b128 v[144:147], v11 offset:28672
  v_mfma_f32_16x16x32_bf16 a[120:123], a[12:15], a[152:155], a[120:123]
  v_mfma_f32_16x16x32_bf16 a[124:127], a[12:15], a[156:159], a[124:127]
  v_mfma_f32_16x16x32_bf16 a[128:131], a[16:19], a[144:147], a[128:131]
  buffer_load_dwordx4 a[144:147], v2, s[40:43], s64 offen offset:0 sc1
  v_mfma_f32_16x16x32_bf16 a[132:135], a[16:19], a[148:151], a[132:135]
  buffer_load_dwordx4 a[148:151], v2, s[40:43], s65 offen offset:0 sc1
  v_mfma_f32_16x16x32_bf16 a[136:139], a[16:19], a[152:155], a[136:139]
  buffer_load_dwordx4 a[152:155], v2, s[40:43], s66 offen offset:0 sc1
  v_mfma_f32_16x16x32_bf16 a[140:143], a[16:19], a[156:159], a[140:143]
  buffer_load_dwordx4 a[156:159], v2, s[40:43], s67 offen offset:0 sc1
  s_waitcnt vmcnt(19)
  v_mfma_f32_16x16x32_bf16 a[64:67], a[20:23], a[160:163], a[64:67]
  v_mfma_f32_16x16x32_bf16 a[68:71], a[20:23], a[164:167], a[68:71]
  ds_read_b128 v[148:151], v11 offset:29696
  v_mfma_f32_16x16x32_bf16 a[72:75], a[20:23], a[168:171], a[72:75]
  v_mfma_f32_16x16x32_bf16 a[76:79], a[20:23], a[172:175], a[76:79]
  buffer_load_dwordx4 v[56:59], v2, s[40:43], s13 offen offset:2048 sc1
  v_mfma_f32_16x16x32_bf16 a[80:83], a[24:27], a[160:163], a[80:83]
  v_mfma_f32_16x16x32_bf16 a[84:87], a[24:27], a[164:167], a[84:87]
  ds_read_b128 v[152:155], v11 offset:30720
  v_mfma_f32_16x16x32_bf16 a[88:91], a[24:27], a[168:171], a[88:91]
  v_mfma_f32_16x16x32_bf16 a[92:95], a[24:27], a[172:175], a[92:95]
  buffer_load_dwordx4 v[60:63], v2, s[40:43], s13 offen offset:3072 sc1
  v_mfma_f32_16x16x32_bf16 a[96:99], a[28:31], a[160:163], a[96:99]
  s_add_u32 s13, s13, 4096
  v_mfma_f32_16x16x32_bf16 a[100:103], a[28:31], a[164:167], a[100:103]
  ds_read_b128 v[156:159], v11 offset:31744
  v_mfma_f32_16x16x32_bf16 a[104:107], a[28:31], a[168:171], a[104:107]
  v_mfma_f32_16x16x32_bf16 a[108:111], a[28:31], a[172:175], a[108:111]
  v_mfma_f32_16x16x32_bf16 a[112:115], a[32:35], a[160:163], a[112:115]
  v_mfma_f32_16x16x32_bf16 a[116:119], a[32:35], a[164:167], a[116:119]
  ds_read_b128 v[176:179], v11 offset:32768
  v_mfma_f32_16x16x32_bf16 a[120:123], a[32:35], a[168:171], a[120:123]
  v_mfma_f32_16x16x32_bf16 a[124:127], a[32:35], a[172:175], a[124:127]
  v_mfma_f32_16x16x32_bf16 a[128:131], a[36:39], a[160:163], a[128:131]
  buffer_load_dwordx4 a[160:163], v2, s[40:43], s64 offen offset:1024 sc1
  v_mfma_f32_16x16x32_bf16 a[132:135], a[36:39], a[164:167], a[132:135]
  buffer_load_dwordx4 a[164:167], v2, s[40:43], s65 offen offset:1024 sc1
  v_mfma_f32_16x16x32_bf16 a[136:139], a[36:39], a[168:171], a[136:139]
  buffer_load_dwordx4 a[168:171], v2, s[40:43], s66 offen offset:1024 sc1
  v_mfma_f32_16x16x32_bf16 a[140:143], a[36:39], a[172:175], a[140:143]
  buffer_load_dwordx4 a[172:175], v2, s[40:43], s67 offen offset:1024 sc1
  s_waitcnt vmcnt(19)
  v_mfma_f32_16x16x32_bf16 a[64:67], a[40:43], a[176:179], a[64:67]
  v_mfma_f32_16x16x32_bf16 a[68:71], a[40:43], a[180:183], a[68:71]
  ds_read_b128 v[180:183], v11 offset:33792
  v_mfma_f32_16x16x32_bf16 a[72:75], a[40:43], a[184:187], a[72:75]
  v_mfma_f32_16x16x32_bf16 a[76:79], a[40:43], a[188:191], a[76:79]
  buffer_load_dwordx4 v[96:99], v2, s[40:43], s13 offen offset:0 sc1
  v_mfma_f32_16x16x32_bf16 a[80:83], a[44:47], a[176:179], a[80:83]
  v_mfma_f32_16x16x32_bf16 a[84:87], a[44:47], a[180:183], a[84:87]
  ds_read_b128 v[184:187], v11 offset:34816
  v_mfma_f32_16x16x32_bf16 a[88:91], a[44:47], a[184:187], a[88:91]
  v_mfma_f32_16x16x32_bf16 a[92:95], a[44:47], a[188:191], a[92:95]
  buffer_load_dwordx4 v[100:103], v2, s[40:43], s13 offen offset:1024 sc1
  v_mfma_f32_16x16x32_bf16 a[96:99], a[48:51], a[176:179], a[96:99]
  v_mfma_f32_16x16x32_bf16 a[100:103], a[48:51], a[180:183], a[100:103]
  ds_read_b128 v[188:191], v11 offset:35840
  v_mfma_f32_16x16x32_bf16 a[104:107], a[48:51], a[184:187], a[104:107]
  v_mfma_f32_16x16x32_bf16 a[108:111], a[48:51], a[188:191], a[108:111]
  v_mfma_f32_16x16x32_bf16 a[112:115], a[52:55], a[176:179], a[112:115]
  v_mfma_f32_16x16x32_bf16 a[116:119], a[52:55], a[180:183], a[116:119]
  v_mfma_f32_16x16x32_bf16 a[120:123], a[52:55], a[184:187], a[120:123]
  v_mfma_f32_16x16x32_bf16 a[124:127], a[52:55], a[188:191], a[124:127]
  v_mfma_f32_16x16x32_bf16 a[128:131], a[56:59], a[176:179], a[128:131]
  buffer_load_dwordx4 a[176:179], v2, s[40:43], s64 offen offset:2048 sc1
  v_mfma_f32_16x16x32_bf16 a[132:135], a[56:59], a[180:183], a[132:135]
  buffer_load_dwordx4 a[180:183], v2, s[40:43], s65 offen offset:2048 sc1
  v_mfma_f32_16x16x32_bf16 a[136:139], a[56:59], a[184:187], a[136:139]
  buffer_load_dwordx4 a[184:187], v2, s[40:43], s66 offen offset:2048 sc1
  v_mfma_f32_16x16x32_bf16 a[140:143], a[56:59], a[188:191], a[140:143]
  buffer_load_dwordx4 a[188:191], v2, s[40:43], s67 offen offset:2048 sc1
  s_waitcnt vmcnt(18)
  v_mfma_f32_16x16x32_bf16 a[64:67], a[60:63], v[216:219], a[64:67]
  v_mfma_f32_16x16x32_bf16 a[68:71], a[60:63], v[220:223], a[68:71]
  v_mfma_f32_16x16x32_bf16 a[72:75], a[60:63], v[224:227], a[72:75]
  v_mfma_f32_16x16x32_bf16 a[76:79], a[60:63], v[228:231], a[76:79]
  buffer_load_dwordx4 v[104:107], v2, s[40:43], s13 offen offset:2048 sc1
  v_mfma_f32_16x16x32_bf16 a[80:83], a[192:195], v[216:219], a[80:83]
  v_mfma_f32_16x16x32_bf16 a[84:87], a[192:195], v[220:223], a[84:87]
  v_mfma_f32_16x16x32_bf16 a[88:91], a[192:195], v[224:227], a[88:91]
  v_mfma_f32_16x16x32_bf16 a[92:95], a[192:195], v[228:231], a[92:95]
  buffer_load_dwordx4 v[108:111], v2, s[40:43], s13 offen offset:3072 sc1
  v_mfma_f32_16x16x32_bf16 a[96:99], a[196:199], v[216:219], a[96:99]
  s_add_u32 s13, s13, 4096
  v_mfma_f32_16x16x32_bf16 a[100:103], a[196:199], v[220:223], a[100:103]
  v_mfma_f32_16x16x32_bf16 a[104:107], a[196:199], v[224:227], a[104:107]
  v_mfma_f32_16x16x32_bf16 a[108:111], a[196:199], v[228:231], a[108:111]
  v_mfma_f32_16x16x32_bf16 a[112:115], a[200:203], v[216:219], a[112:115]
  v_mfma_f32_16x16x32_bf16 a[116:119], a[200:203], v[220:223], a[116:119]
  v_mfma_f32_16x16x32_bf16 a[120:123], a[200:203], v[224:227], a[120:123]
  v_mfma_f32_16x16x32_bf16 a[124:127], a[200:203], v[228:231], a[124:127]
  v_mfma_f32_16x16x32_bf16 a[128:131], a[204:207], v[216:219], a[128:131]
  buffer_load_dwordx4 v[216:219], v2, s[40:43], s64 offen offset:3072 sc1
  v_mfma_f32_16x16x32_bf16 a[132:135], a[204:207], v[220:223], a[132:135]
  buffer_load_dwordx4 v[220:223], v2, s[40:43], s65 offen offset:3072 sc1
  v_mfma_f32_16x16x32_bf16 a[136:139], a[204:207], v[224:227], a[136:139]
  buffer_load_dwordx4 v[224:227], v2, s[40:43], s66 offen offset:3072 sc1
  v_mfma_f32_16x16x32_bf16 a[140:143], a[204:207], v[228:231], a[140:143]
  buffer_load_dwordx4 v[228:231], v2, s[40:43], s67 offen offset:3072 sc1
  s_waitcnt vmcnt(18)
  v_mfma_f32_16x16x32_bf16 a[64:67], a[208:211], a[144:147], a[64:67]
  s_add_u32 s64, s64, 4096
  v_mfma_f32_16x16x32_bf16 a[68:71], a[208:211], a[148:151], a[68:71]
  s_add_u32 s65, s65, 4096
  v_mfma_f32_16x16x32_bf16 a[72:75], a[208:211], a[152:155], a[72:75]
  s_add_u32 s66, s66, 4096
  v_mfma_f32_16x16x32_bf16 a[76:79], a[208:211], a[156:159], a[76:79]
  v_mfma_f32_16x16x32_bf16 a[80:83], a[212:215], a[144:147], a[80:83]
  v_mfma_f32_16x16x32_bf16 a[84:87], a[212:215], a[148:151], a[84:87]
  v_mfma_f32_16x16x32_bf16 a[88:91], a[212:215], a[152:155], a[88:91]
  s_add_u32 s67, s67, 4096
  v_mfma_f32_16x16x32_bf16 a[92:95], a[212:215], a[156:159], a[92:95]
  v_mfma_f32_16x16x32_bf16 a[96:99], a[216:219], a[144:147], a[96:99]
  v_mfma_f32_16x16x32_bf16 a[100:103], a[216:219], a[148:151], a[100:103]
  v_mfma_f32_16x16x32_bf16 a[104:107], a[216:219], a[152:155], a[104:107]
  v_mfma_f32_16x16x32_bf16 a[108:111], a[216:219], a[156:159], a[108:111]
  v_mfma_f32_16x16x32_bf16 a[112:115], a[220:223], a[144:147], a[112:115]
  v_mfma_f32_16x16x32_bf16 a[116:119], a[220:223], a[148:151], a[116:119]
  v_mfma_f32_16x16x32_bf16 a[120:123], a[220:223], a[152:155], a[120:123]
  v_mfma_f32_16x16x32_bf16 a[124:127], a[220:223], a[156:159], a[124:127]
  v_mfma_f32_16x16x32_bf16 a[128:131], a[224:227], a[144:147], a[128:131]
  buffer_load_dwordx4 a[144:147], v2, s[40:43], s64 offen offset:0 sc1
  v_mfma_f32_16x16x32_bf16 a[132:135], a[224:227], a[148:151], a[132:135]
  buffer_load_dwordx4 a[148:151], v2, s[40:43], s65 offen offset:0 sc1
  v_mfma_f32_16x16x32_bf16 a[136:139], a[224:227], a[152:155], a[136:139]
  buffer_load_dwordx4 a[152:155], v2, s[40:43], s66 offen offset:0 sc1
  v_mfma_f32_16x16x32_bf16 a[140:143], a[224:227], a[156:159], a[140:143]
  buffer_load_dwordx4 a[156:159], v2, s[40:43], s67 offen offset:0 sc1
  s_waitcnt vmcnt(16)
  v_mfma_f32_16x16x32_bf16 a[64:67], a[228:231], a[160:163], a[64:67]
  v_mfma_f32_16x16x32_bf16 a[68:71], a[228:231], a[164:167], a[68:71]
  v_mfma_f32_16x16x32_bf16 a[72:75], a[228:231], a[168:171], a[72:75]
  v_mfma_f32_16x16x32_bf16 a[76:79], a[228:231], a[172:175], a[76:79]
  v_mfma_f32_16x16x32_bf16 a[80:83], a[232:235], a[160:163], a[80:83]
  v_mfma_f32_16x16x32_bf16 a[84:87], a[232:235], a[164:167], a[84:87]
  v_mfma_f32_16x16x32_bf16 a[88:91], a[232:235], a[168:171], a[88:91]
  v_mfma_f32_16x16x32_bf16 a[92:95], a[232:235], a[172:175], a[92:95]
  v_mfma_f32_16x16x32_bf16 a[96:99], a[236:239], a[160:163], a[96:99]
  v_mfma_f32_16x16x32_bf16 a[100:103], a[236:239], a[164:167], a[100:103]
  v_mfma_f32_16x16x32_bf16 a[104:107], a[236:239], a[168:171], a[104:107]
  v_mfma_f32_16x16x32_bf16 a[108:111], a[236:239], a[172:175], a[108:111]
  v_mfma_f32_16x16x32_bf16 a[112:115], a[240:243], a[160:163], a[112:115]
  v_mfma_f32_16x16x32_bf16 a[116:119], a[240:243], a[164:167], a[116:119]
  v_mfma_f32_16x16x32_bf16 a[120:123], a[240:243], a[168:171], a[120:123]
  v_mfma_f32_16x16x32_bf16 a[124:127], a[240:243], a[172:175], a[124:127]
  v_mfma_f32_16x16x32_bf16 a[128:131], a[244:247], a[160:163], a[128:131]
  buffer_load_dwordx4 a[160:163], v2, s[40:43], s64 offen offset:1024 sc1
  v_mfma_f32_16x16x32_bf16 a[132:135], a[244:247], a[164:167], a[132:135]
  buffer_load_dwordx4 a[164:167], v2, s[40:43], s65 offen offset:1024 sc1
  v_mfma_f32_16x16x32_bf16 a[136:139], a[244:247], a[168:171], a[136:139]
  buffer_load_dwordx4 a[168:171], v2, s[40:43], s66 offen offset:1024 sc1
  v_mfma_f32_16x16x32_bf16 a[140:143], a[244:247], a[172:175], a[140:143]
  buffer_load_dwordx4 a[172:175], v2, s[40:43], s67 offen offset:1024 sc1
  s_waitcnt vmcnt(14)
  v_mfma_f32_16x16x32_bf16 a[64:67], a[248:251], a[176:179], a[64:67]
  v_mfma_f32_16x16x32_bf16 a[68:71], a[248:251], a[180:183], a[68:71]
  v_mfma_f32_16x16x32_bf16 a[72:75], a[248:251], a[184:187], a[72:75]
  v_mfma_f32_16x16x32_bf16 a[76:79], a[248:251], a[188:191], a[76:79]
  v_mfma_f32_16x16x32_bf16 a[80:83], a[252:255], a[176:179], a[80:83]
  v_mfma_f32_16x16x32_bf16 a[84:87], a[252:255], a[180:183], a[84:87]
  v_mfma_f32_16x16x32_bf16 a[88:91], a[252:255], a[184:187], a[88:91]
  v_mfma_f32_16x16x32_bf16 a[92:95], a[252:255], a[188:191], a[92:95]
  v_mfma_f32_16x16x32_bf16 a[96:99], v[32:35], a[176:179], a[96:99]
  v_mfma_f32_16x16x32_bf16 a[100:103], v[32:35], a[180:183], a[100:103]
  v_mfma_f32_16x16x32_bf16 a[104:107], v[32:35], a[184:187], a[104:107]
  v_mfma_f32_16x16x32_bf16 a[108:111], v[32:35], a[188:191], a[108:111]
  v_mfma_f32_16x16x32_bf16 a[112:115], v[36:39], a[176:179], a[112:115]
  v_mfma_f32_16x16x32_bf16 a[116:119], v[36:39], a[180:183], a[116:119]
  v_mfma_f32_16x16x32_bf16 a[120:123], v[36:39], a[184:187], a[120:123]
  v_mfma_f32_16x16x32_bf16 a[124:127], v[36:39], a[188:191], a[124:127]
  v_mfma_f32_16x16x32_bf16 a[128:131], v[40:43], a[176:179], a[128:131]
  buffer_load_dwordx4 a[176:179], v2, s[40:43], s64 offen offset:2048 sc1
  v_mfma_f32_16x16x32_bf16 a[132:135], v[40:43], a[180:183], a[132:135]
  buffer_load_dwordx4 a[180:183], v2, s[40:43], s65 offen offset:2048 sc1
  v_mfma_f32_16x16x32_bf16 a[136:139], v[40:43], a[184:187], a[136:139]
  buffer_load_dwordx4 a[184:187], v2, s[40:43], s66 offen offset:2048 sc1
  v_mfma_f32_16x16x32_bf16 a[140:143], v[40:43], a[188:191], a[140:143]
  buffer_load_dwordx4 a[188:191], v2, s[40:43], s67 offen offset:2048 sc1
  s_waitcnt vmcnt(12)
  v_mfma_f32_16x16x32_bf16 a[64:67], v[44:47], v[216:219], a[64:67]
  v_mfma_f32_16x16x32_bf16 a[68:71], v[44:47], v[220:223], a[68:71]
  v_mfma_f32_16x16x32_bf16 a[72:75], v[44:47], v[224:227], a[72:75]
  v_mfma_f32_16x16x32_bf16 a[76:79], v[44:47], v[228:231], a[76:79]
  v_mfma_f32_16x16x32_bf16 a[80:83], v[48:51], v[216:219], a[80:83]
  v_mfma_f32_16x16x32_bf16 a[84:87], v[48:51], v[220:223], a[84:87]
  v_mfma_f32_16x16x32_bf16 a[88:91], v[48:51], v[224:227], a[88:91]
  v_mfma_f32_16x16x32_bf16 a[92:95], v[48:51], v[228:231], a[92:95]
  v_mfma_f32_16x16x32_bf16 a[96:99], v[52:55], v[216:219], a[96:99]
  v_mfma_f32_16x16x32_bf16 a[100:103], v[52:55], v[220:223], a[100:103]
  v_mfma_f32_16x16x32_bf16 a[104:107], v[52:55], v[224:227], a[104:107]
  v_mfma_f32_16x16x32_bf16 a[108:111], v[52:55], v[228:231], a[108:111]
  v_mfma_f32_16x16x32_bf16 a[112:115], v[56:59], v[216:219], a[112:115]
  v_mfma_f32_16x16x32_bf16 a[116:119], v[56:59], v[220:223], a[116:119]
  v_mfma_f32_16x16x32_bf16 a[120:123], v[56:59], v[224:227], a[120:123]
  v_mfma_f32_16x16x32_bf16 a[124:127], v[56:59], v[228:231], a[124:127]
  v_mfma_f32_16x16x32_bf16 a[128:131], v[60:63], v[216:219], a[128:131]
  buffer_load_dwordx4 v[216:219], v2, s[40:43], s64 offen offset:3072 sc1
  v_mfma_f32_16x16x32_bf16 a[132:135], v[60:63], v[220:223], a[132:135]
  buffer_load_dwordx4 v[220:223], v2, s[40:43], s65 offen offset:3072 sc1
  v_mfma_f32_16x16x32_bf16 a[136:139], v[60:63], v[224:227], a[136:139]
  buffer_load_dwordx4 v[224:227], v2, s[40:43], s66 offen offset:3072 sc1
  v_mfma_f32_16x16x32_bf16 a[140:143], v[60:63], v[228:231], a[140:143]
  buffer_load_dwordx4 v[228:231], v2, s[40:43], s67 offen offset:3072 sc1
  s_waitcnt vmcnt(12) lgkmcnt(0)
  v_mfma_f32_16x16x32_bf16 a[64:67], v[96:99], a[144:147], a[64:67]
  s_add_u32 s64, s64, 4096
  v_mfma_f32_16x16x32_bf16 a[68:71], v[96:99], a[148:151], a[68:71]
  s_add_u32 s65, s65, 4096
  v_mfma_f32_16x16x32_bf16 a[72:75], v[96:99], a[152:155], a[72:75]
  s_add_u32 s66, s66, 4096
  v_mfma_f32_16x16x32_bf16 a[76:79], v[96:99], a[156:159], a[76:79]
  buffer_load_dwordx4 v[32:35], v248, s[44:47], 0 offen
  v_mfma_f32_16x16x32_bf16 a[80:83], v[100:103], a[144:147], a[80:83]
  v_mfma_f32_16x16x32_bf16 a[84:87], v[100:103], a[148:151], a[84:87]
  buffer_load_dwordx4 v[44:47], v200, s[40:43], s27 offen sc1
  v_mfma_f32_16x16x32_bf16 a[88:91], v[100:103], a[152:155], a[88:91]
  s_add_u32 s67, s67, 4096
  v_mfma_f32_16x16x32_bf16 a[92:95], v[100:103], a[156:159], a[92:95]
  buffer_load_dwordx4 v[36:39], v249, s[44:47], 0 offen
  v_mfma_f32_16x16x32_bf16 a[96:99], v[104:107], a[144:147], a[96:99]
  v_mfma_f32_16x16x32_bf16 a[100:103], v[104:107], a[148:151], a[100:103]
  buffer_load_dwordx4 v[48:51], v201, s[40:43], s27 offen sc1
  v_mfma_f32_16x16x32_bf16 a[104:107], v[104:107], a[152:155], a[104:107]
  v_mfma_f32_16x16x32_bf16 a[108:111], v[104:107], a[156:159], a[108:111]
  buffer_load_dwordx4 v[40:43], v250, s[44:47], 0 offen
  v_mfma_f32_16x16x32_bf16 a[112:115], v[108:111], a[144:147], a[112:115]
  v_mfma_f32_16x16x32_bf16 a[116:119], v[108:111], a[148:151], a[116:119]
  buffer_load_dwordx4 v[52:55], v202, s[40:43], s27 offen sc1
  v_mfma_f32_16x16x32_bf16 a[120:123], v[108:111], a[152:155], a[120:123]
  v_mfma_f32_16x16x32_bf16 a[124:127], v[108:111], a[156:159], a[124:127]
  v_mfma_f32_16x16x32_bf16 a[128:131], v[112:115], a[144:147], a[128:131]
  buffer_load_dwordx4 a[144:147], v2, s[40:43], s64 offen offset:0 sc1
  v_mfma_f32_16x16x32_bf16 a[132:135], v[112:115], a[148:151], a[132:135]
  buffer_load_dwordx4 a[148:151], v2, s[40:43], s65 offen offset:0 sc1
  v_mfma_f32_16x16x32_bf16 a[136:139], v[112:115], a[152:155], a[136:139]
  buffer_load_dwordx4 a[152:155], v2, s[40:43], s66 offen offset:0 sc1
  v_mfma_f32_16x16x32_bf16 a[140:143], v[112:115], a[156:159], a[140:143]
  buffer_load_dwordx4 a[156:159], v2, s[40:43], s67 offen offset:0 sc1
  s_waitcnt vmcnt(18)
  v_mfma_f32_16x16x32_bf16 a[64:67], v[116:119], a[160:163], a[64:67]
  v_mfma_f32_16x16x32_bf16 a[68:71], v[116:119], a[164:167], a[68:71]
  v_mfma_f32_16x16x32_bf16 a[72:75], v[116:119], a[168:171], a[72:75]
  v_mfma_f32_16x16x32_bf16 a[76:79], v[116:119], a[172:175], a[76:79]
  v_mfma_f32_16x16x32_bf16 a[80:83], v[120:123], a[160:163], a[80:83]
  v_mfma_f32_16x16x32_bf16 a[84:87], v[120:123], a[164:167], a[84:87]
  v_mfma_f32_16x16x32_bf16 a[88:91], v[120:123], a[168:171], a[88:91]
  v_mfma_f32_16x16x32_bf16 a[92:95], v[120:123], a[172:175], a[92:95]
  v_mfma_f32_16x16x32_bf16 a[96:99], v[124:127], a[160:163], a[96:99]
  v_mfma_f32_16x16x32_bf16 a[100:103], v[124:127], a[164:167], a[100:103]
  v_mfma_f32_16x16x32_bf16 a[104:107], v[124:127], a[168:171], a[104:107]
  v_mfma_f32_16x16x32_bf16 a[108:111], v[124:127], a[172:175], a[108:111]
  v_mfma_f32_16x16x32_bf16 a[112:115], v[160:163], a[160:163], a[112:115]
  v_mfma_f32_16x16x32_bf16 a[116:119], v[160:163], a[164:167], a[116:119]
  v_mfma_f32_16x16x32_bf16 a[120:123], v[160:163], a[168:171], a[120:123]
  v_mfma_f32_16x16x32_bf16 a[124:127], v[160:163], a[172:175], a[124:127]
  v_mfma_f32_16x16x32_bf16 a[128:131], v[164:167], a[160:163], a[128:131]
  buffer_load_dwordx4 a[160:163], v2, s[40:43], s64 offen offset:1024 sc1
  v_mfma_f32_16x16x32_bf16 a[132:135], v[164:167], a[164:167], a[132:135]
  buffer_load_dwordx4 a[164:167], v2, s[40:43], s65 offen offset:1024 sc1
  v_mfma_f32_16x16x32_bf16 a[136:139], v[164:167], a[168:171], a[136:139]
  buffer_load_dwordx4 a[168:171], v2, s[40:43], s66 offen offset:1024 sc1
  v_mfma_f32_16x16x32_bf16 a[140:143], v[164:167], a[172:175], a[140:143]
  buffer_load_dwordx4 a[172:175], v2, s[40:43], s67 offen offset:1024 sc1
  s_waitcnt vmcnt(18)
  v_mfma_f32_16x16x32_bf16 a[64:67], v[168:171], a[176:179], a[64:67]
  v_mfma_f32_16x16x32_bf16 a[68:71], v[168:171], a[180:183], a[68:71]
  v_mfma_f32_16x16x32_bf16 a[72:75], v[168:171], a[184:187], a[72:75]
  v_mfma_f32_16x16x32_bf16 a[76:79], v[168:171], a[188:191], a[76:79]
  v_mfma_f32_16x16x32_bf16 a[80:83], v[172:175], a[176:179], a[80:83]
  v_mfma_f32_16x16x32_bf16 a[84:87], v[172:175], a[180:183], a[84:87]
  v_mfma_f32_16x16x32_bf16 a[88:91], v[172:175], a[184:187], a[88:91]
  v_mfma_f32_16x16x32_bf16 a[92:95], v[172:175], a[188:191], a[92:95]
  v_mfma_f32_16x16x32_bf16 a[96:99], v[192:195], a[176:179], a[96:99]
  v_mfma_f32_16x16x32_bf16 a[100:103], v[192:195], a[180:183], a[100:103]
  v_mfma_f32_16x16x32_bf16 a[104:107], v[192:195], a[184:187], a[104:107]
  v_mfma_f32_16x16x32_bf16 a[108:111], v[192:195], a[188:191], a[108:111]
  v_mfma_f32_16x16x32_bf16 a[112:115], v[196:199], a[176:179], a[112:115]
  v_mfma_f32_16x16x32_bf16 a[116:119], v[196:199], a[180:183], a[116:119]
  v_mfma_f32_16x16x32_bf16 a[120:123], v[196:199], a[184:187], a[120:123]
  v_mfma_f32_16x16x32_bf16 a[124:127], v[196:199], a[188:191], a[124:127]
  v_mfma_f32_16x16x32_bf16 a[128:131], v[208:211], a[176:179], a[128:131]
  buffer_load_dwordx4 a[176:179], v2, s[40:43], s64 offen offset:2048 sc1
  v_mfma_f32_16x16x32_bf16 a[132:135], v[208:211], a[180:183], a[132:135]
  buffer_load_dwordx4 a[180:183], v2, s[40:43], s65 offen offset:2048 sc1
  v_mfma_f32_16x16x32_bf16 a[136:139], v[208:211], a[184:187], a[136:139]
  buffer_load_dwordx4 a[184:187], v2, s[40:43], s66 offen offset:2048 sc1
  v_mfma_f32_16x16x32_bf16 a[140:143], v[208:211], a[188:191], a[140:143]
  buffer_load_dwordx4 a[188:191], v2, s[40:43], s67 offen offset:2048 sc1
  s_waitcnt vmcnt(18)
  v_mfma_f32_16x16x32_bf16 a[64:67], v[212:215], v[216:219], a[64:67]
  v_mfma_f32_16x16x32_bf16 a[68:71], v[212:215], v[220:223], a[68:71]
  ds_read_b128 v[120:123], v203 offset:0
  v_mfma_f32_16x16x32_bf16 a[72:75], v[212:215], v[224:227], a[72:75]
  v_add_u32 v20, 77824, v251
  v_mfma_f32_16x16x32_bf16 a[76:79], v[212:215], v[228:231], a[76:79]
  ds_read_b128 v[124:127], v203 offset:16
  v_mfma_f32_16x16x32_bf16 a[80:83], v[232:235], v[216:219], a[80:83]
  v_mfma_f32_16x16x32_bf16 a[84:87], v[232:235], v[220:223], a[84:87]
  ds_read_b128 v[160:163], v204 offset:0
  v_mfma_f32_16x16x32_bf16 a[88:91], v[232:235], v[224:227], a[88:91]
  v_add_u32 v21, 77824, v252
  v_mfma_f32_16x16x32_bf16 a[92:95], v[232:235], v[228:231], a[92:95]
  ds_read_b128 v[164:167], v204 offset:16
  v_mfma_f32_16x16x32_bf16 a[96:99], v[236:239], v[216:219], a[96:99]
  v_mfma_f32_16x16x32_bf16 a[100:103], v[236:239], v[220:223], a[100:103]
  ds_read_b128 v[168:171], v205 offset:0
  v_mfma_f32_16x16x32_bf16 a[104:107], v[236:239], v[224:227], a[104:107]
  v_add_u32 v22, 77824, v253
  v_mfma_f32_16x16x32_bf16 a[108:111], v[236:239], v[228:231], a[108:111]
  ds_read_b128 v[172:175], v205 offset:16
  v_mfma_f32_16x16x32_bf16 a[112:115], v[240:243], v[216:219], a[112:115]
  v_mfma_f32_16x16x32_bf16 a[116:119], v[240:243], v[220:223], a[116:119]
  v_mfma_f32_16x16x32_bf16 a[120:123], v[240:243], v[224:227], a[120:123]
  s_mul_i32 s23, s20, 38912
  v_and_b32 v16, 15, v1
  v_mul_u32_u24 v16, 336, v16
  v_mfma_f32_16x16x32_bf16 a[124:127], v[240:243], v[228:231], a[124:127]
  v_lshrrev_b32 v17, 4, v1
  v_lshl_add_u32 v16, v17, 4, v16
  v_mfma_f32_16x16x32_bf16 a[128:131], v[244:247], v[216:219], a[128:131]
  buffer_load_dwordx4 v[216:219], v2, s[40:43], s64 offen offset:3072 sc1
  v_add_u32 v16, s23, v16
  v_mfma_f32_16x16x32_bf16 a[132:135], v[244:247], v[220:223], a[132:135]
  buffer_load_dwordx4 v[220:223], v2, s[40:43], s65 offen offset:3072 sc1
  v_mfma_f32_16x16x32_bf16 a[136:139], v[244:247], v[224:227], a[136:139]
  s_waitcnt lgkmcnt(0)
  buffer_load_dwordx4 v[224:227], v2, s[40:43], s66 offen offset:3072 sc1
  v_mfma_f32_16x16x32_bf16 a[140:143], v[244:247], v[228:231], a[140:143]
  buffer_load_dwordx4 v[228:231], v2, s[40:43], s67 offen offset:3072 sc1
  s_waitcnt vmcnt(12)
  v_mfma_f32_16x16x32_bf16 a[64:67], v[64:67], a[144:147], a[64:67]
  v_lshlrev_b32 v18, 16, v44
  v_and_b32 v19, 0xffff0000, v44
  v_mfma_f32_16x16x32_bf16 a[68:71], v[64:67], a[148:151], a[68:71]
  v_add_f32 v120, v120, v18
  v_add_f32 v121, v121, v19
  v_mfma_f32_16x16x32_bf16 a[72:75], v[64:67], a[152:155], a[72:75]
  v_cvt_pk_bf16_f32 v18, v120, v121
  v_lshlrev_b32 v96, 16, v32
  v_mfma_f32_16x16x32_bf16 a[76:79], v[64:67], a[156:159], a[76:79]
  v_and_b32 v97, 0xffff0000, v32
  v_lshlrev_b32 v120, 16, v18
  v_mfma_f32_16x16x32_bf16 a[80:83], v[68:71], a[144:147], a[80:83]
  v_and_b32 v121, 0xffff0000, v18
  v_lshlrev_b32 v18, 16, v45
  v_mfma_f32_16x16x32_bf16 a[84:87], v[68:71], a[148:151], a[84:87]
  v_and_b32 v19, 0xffff0000, v45
  v_add_f32 v122, v122, v18
  v_mfma_f32_16x16x32_bf16 a[88:91], v[68:71], a[152:155], a[88:91]
  v_add_f32 v123, v123, v19
  v_cvt_pk_bf16_f32 v18, v122, v123
  v_mfma_f32_16x16x32_bf16 a[92:95], v[68:71], a[156:159], a[92:95]
  v_lshlrev_b32 v98, 16, v33
  v_and_b32 v99, 0xffff0000, v33
  v_mfma_f32_16x16x32_bf16 a[96:99], v[72:75], a[144:147], a[96:99]
  v_lshlrev_b32 v122, 16, v18
  v_and_b32 v123, 0xffff0000, v18
  v_mfma_f32_16x16x32_bf16 a[100:103], v[72:75], a[148:151], a[100:103]
  v_lshlrev_b32 v18, 16, v46
  v_and_b32 v19, 0xffff0000, v46
  v_mfma_f32_16x16x32_bf16 a[104:107], v[72:75], a[152:155], a[104:107]
  v_add_f32 v124, v124, v18
  v_add_f32 v125, v125, v19
  v_mfma_f32_16x16x32_bf16 a[108:111], v[72:75], a[156:159], a[108:111]
  v_cvt_pk_bf16_f32 v18, v124, v125
  v_lshlrev_b32 v100, 16, v34
  v_mfma_f32_16x16x32_bf16 a[112:115], v[76:79], a[144:147], a[112:115]
  v_and_b32 v101, 0xffff0000, v34
  v_lshlrev_b32 v124, 16, v18
  v_mfma_f32_16x16x32_bf16 a[116:119], v[76:79], a[148:151], a[116:119]
  v_and_b32 v125, 0xffff0000, v18
  v_lshlrev_b32 v18, 16, v47
  v_mfma_f32_16x16x32_bf16 a[120:123], v[76:79], a[152:155], a[120:123]
  v_and_b32 v19, 0xffff0000, v47
  v_add_f32 v126, v126, v18
  v_mfma_f32_16x16x32_bf16 a[124:127], v[76:79], a[156:159], a[124:127]
  v_add_f32 v127, v127, v19
  v_cvt_pk_bf16_f32 v18, v126, v127
  v_mfma_f32_16x16x32_bf16 a[128:131], v[80:83], a[144:147], a[128:131]
  v_lshlrev_b32 v102, 16, v35
  v_and_b32 v103, 0xffff0000, v35
  v_mfma_f32_16x16x32_bf16 a[132:135], v[80:83], a[148:151], a[132:135]
  v_lshlrev_b32 v126, 16, v18
  v_and_b32 v127, 0xffff0000, v18
  v_mfma_f32_16x16x32_bf16 a[136:139], v[80:83], a[152:155], a[136:139]
  v_mfma_f32_16x16x32_bf16 a[140:143], v[80:83], a[156:159], a[140:143]
  s_waitcnt vmcnt(8)
  v_mfma_f32_16x16x32_bf16 a[64:67], v[84:87], a[160:163], a[64:67]
  v_lshlrev_b32 v18, 16, v48
  v_and_b32 v19, 0xffff0000, v48
  v_mfma_f32_16x16x32_bf16 a[68:71], v[84:87], a[164:167], a[68:71]
  v_add_f32 v160, v160, v18
  v_add_f32 v161, v161, v19
  v_mfma_f32_16x16x32_bf16 a[72:75], v[84:87], a[168:171], a[72:75]
  v_cvt_pk_bf16_f32 v18, v160, v161
  v_lshlrev_b32 v104, 16, v36
  v_mfma_f32_16x16x32_bf16 a[76:79], v[84:87], a[172:175], a[76:79]
  v_and_b32 v105, 0xffff0000, v36
  v_lshlrev_b32 v160, 16, v18
  v_mfma_f32_16x16x32_bf16 a[80:83], v[88:91], a[160:163], a[80:83]
  v_and_b32 v161, 0xffff0000, v18
  v_lshlrev_b32 v18, 16, v49
  v_mfma_f32_16x16x32_bf16 a[84:87], v[88:91], a[164:167], a[84:87]
  v_and_b32 v19, 0xffff0000, v49
  v_add_f32 v162, v162, v18
  v_mfma_f32_16x16x32_bf16 a[88:91], v[88:91], a[168:171], a[88:91]
  v_add_f32 v163, v163, v19
  v_cvt_pk_bf16_f32 v18, v162, v163
  v_mfma_f32_16x16x32_bf16 a[92:95], v[88:91], a[172:175], a[92:95]
  v_lshlrev_b32 v106, 16, v37
  v_and_b32 v107, 0xffff0000, v37
  v_mfma_f32_16x16x32_bf16 a[96:99], v[92:95], a[160:163], a[96:99]
  v_lshlrev_b32 v162, 16, v18
  v_and_b32 v163, 0xffff0000, v18
  v_mfma_f32_16x16x32_bf16 a[100:103], v[92:95], a[164:167], a[100:103]
  v_lshlrev_b32 v18, 16, v50
  v_and_b32 v19, 0xffff0000, v50
  v_mfma_f32_16x16x32_bf16 a[104:107], v[92:95], a[168:171], a[104:107]
  v_add_f32 v164, v164, v18
  v_add_f32 v165, v165, v19
  v_mfma_f32_16x16x32_bf16 a[108:111], v[92:95], a[172:175], a[108:111]
  v_cvt_pk_bf16_f32 v18, v164, v165
  v_lshlrev_b32 v108, 16, v38
  v_mfma_f32_16x16x32_bf16 a[112:115], v[128:131], a[160:163], a[112:115]
  v_and_b32 v109, 0xffff0000, v38
  v_lshlrev_b32 v164, 16, v18
  v_mfma_f32_16x16x32_bf16 a[116:119], v[128:131], a[164:167], a[116:119]
  v_and_b32 v165, 0xffff0000, v18
  v_lshlrev_b32 v18, 16, v51
  v_mfma_f32_16x16x32_bf16 a[120:123], v[128:131], a[168:171], a[120:123]
  v_and_b32 v19, 0xffff0000, v51
  v_add_f32 v166, v166, v18
  v_mfma_f32_16x16x32_bf16 a[124:127], v[128:131], a[172:175], a[124:127]
  v_add_f32 v167, v167, v19
  v_cvt_pk_bf16_f32 v18, v166, v167
  v_mfma_f32_16x16x32_bf16 a[128:131], v[132:135], a[160:163], a[128:131]
  v_lshlrev_b32 v110, 16, v39
  v_and_b32 v111, 0xffff0000, v39
  v_mfma_f32_16x16x32_bf16 a[132:135], v[132:135], a[164:167], a[132:135]
  v_lshlrev_b32 v166, 16, v18
  v_and_b32 v167, 0xffff0000, v18
  v_mfma_f32_16x16x32_bf16 a[136:139], v[132:135], a[168:171], a[136:139]
  v_mfma_f32_16x16x32_bf16 a[140:143], v[132:135], a[172:175], a[140:143]
  s_waitcnt vmcnt(4)
  v_mfma_f32_16x16x32_bf16 a[64:67], v[136:139], a[176:179], a[64:67]
  v_lshlrev_b32 v18, 16, v52
  v_and_b32 v19, 0xffff0000, v52
  v_mfma_f32_16x16x32_bf16 a[68:71], v[136:139], a[180:183], a[68:71]
  v_add_f32 v168, v168, v18
  v_add_f32 v169, v169, v19
  v_mfma_f32_16x16x32_bf16 a[72:75], v[136:139], a[184:187], a[72:75]
  v_cvt_pk_bf16_f32 v18, v168, v169
  v_lshlrev_b32 v112, 16, v40
  v_mfma_f32_16x16x32_bf16 a[76:79], v[136:139], a[188:191], a[76:79]
  v_and_b32 v113, 0xffff0000, v40
  v_lshlrev_b32 v168, 16, v18
  v_mfma_f32_16x16x32_bf16 a[80:83], v[140:143], a[176:179], a[80:83]
  v_and_b32 v169, 0xffff0000, v18
  v_lshlrev_b32 v18, 16, v53
  v_mfma_f32_16x16x32_bf16 a[84:87], v[140:143], a[180:183], a[84:87]
  v_and_b32 v19, 0xffff0000, v53
  v_add_f32 v170, v170, v18
  v_mfma_f32_16x16x32_bf16 a[88:91], v[140:143], a[184:187], a[88:91]
  v_add_f32 v171, v171, v19
  v_cvt_pk_bf16_f32 v18, v170, v171
  v_mfma_f32_16x16x32_bf16 a[92:95], v[140:143], a[188:191], a[92:95]
  v_lshlrev_b32 v114, 16, v41
  v_and_b32 v115, 0xffff0000, v41
  v_mfma_f32_16x16x32_bf16 a[96:99], v[144:147], a[176:179], a[96:99]
  v_lshlrev_b32 v170, 16, v18
  v_and_b32 v171, 0xffff0000, v18
  v_mfma_f32_16x16x32_bf16 a[100:103], v[144:147], a[180:183], a[100:103]
  v_lshlrev_b32 v18, 16, v54
  v_and_b32 v19, 0xffff0000, v54
  v_mfma_f32_16x16x32_bf16 a[104:107], v[144:147], a[184:187], a[104:107]
  v_add_f32 v172, v172, v18
  v_add_f32 v173, v173, v19
  v_mfma_f32_16x16x32_bf16 a[108:111], v[144:147], a[188:191], a[108:111]
  v_cvt_pk_bf16_f32 v18, v172, v173
  v_lshlrev_b32 v116, 16, v42
  v_mfma_f32_16x16x32_bf16 a[112:115], v[148:151], a[176:179], a[112:115]
  v_and_b32 v117, 0xffff0000, v42
  v_lshlrev_b32 v172, 16, v18
  v_mfma_f32_16x16x32_bf16 a[116:119], v[148:151], a[180:183], a[116:119]
  v_and_b32 v173, 0xffff0000, v18
  v_lshlrev_b32 v18, 16, v55
  v_mfma_f32_16x16x32_bf16 a[120:123], v[148:151], a[184:187], a[120:123]
  v_and_b32 v19, 0xffff0000, v55
  v_add_f32 v174, v174, v18
  v_mfma_f32_16x16x32_bf16 a[124:127], v[148:151], a[188:191], a[124:127]
  v_add_f32 v175, v175, v19
  v_cvt_pk_bf16_f32 v18, v174, v175
  v_mfma_f32_16x16x32_bf16 a[128:131], v[152:155], a[176:179], a[128:131]
  v_lshlrev_b32 v118, 16, v43
  v_and_b32 v119, 0xffff0000, v43
  v_mfma_f32_16x16x32_bf16 a[132:135], v[152:155], a[180:183], a[132:135]
  v_lshlrev_b32 v174, 16, v18
  v_and_b32 v175, 0xffff0000, v18
  v_mfma_f32_16x16x32_bf16 a[136:139], v[152:155], a[184:187], a[136:139]
  v_mfma_f32_16x16x32_bf16 a[140:143], v[152:155], a[188:191], a[140:143]
  s_waitcnt vmcnt(0)
  v_mfma_f32_16x16x32_bf16 a[64:67], v[156:159], v[216:219], a[64:67]
  v_mfma_f32_16x16x32_bf16 a[68:71], v[156:159], v[220:223], a[68:71]
  v_mfma_f32_16x16x32_bf16 a[72:75], v[156:159], v[224:227], a[72:75]
  v_mfma_f32_16x16x32_bf16 a[76:79], v[156:159], v[228:231], a[76:79]
  v_mfma_f32_16x16x32_bf16 a[80:83], v[176:179], v[216:219], a[80:83]
  v_mfma_f32_16x16x32_bf16 a[84:87], v[176:179], v[220:223], a[84:87]
  v_mfma_f32_16x16x32_bf16 a[88:91], v[176:179], v[224:227], a[88:91]
  v_mfma_f32_16x16x32_bf16 a[92:95], v[176:179], v[228:231], a[92:95]
  v_mfma_f32_16x16x32_bf16 a[96:99], v[180:183], v[216:219], a[96:99]
  v_mfma_f32_16x16x32_bf16 a[100:103], v[180:183], v[220:223], a[100:103]
  ds_write_b128 v16, a[64:67] offset:0
  v_mfma_f32_16x16x32_bf16 a[104:107], v[180:183], v[224:227], a[104:107]
  ds_write_b128 v16, a[68:71] offset:5376
  v_mfma_f32_16x16x32_bf16 a[108:111], v[180:183], v[228:231], a[108:111]
  ds_write_b128 v16, a[72:75] offset:10752
  v_mfma_f32_16x16x32_bf16 a[112:115], v[184:187], v[216:219], a[112:115]
  ds_write_b128 v16, a[76:79] offset:16128
  v_mfma_f32_16x16x32_bf16 a[116:119], v[184:187], v[220:223], a[116:119]
  ds_write_b128 v16, a[80:83] offset:64
  v_mfma_f32_16x16x32_bf16 a[120:123], v[184:187], v[224:227], a[120:123]
  ds_write_b128 v16, a[84:87] offset:5440
  v_mfma_f32_16x16x32_bf16 a[124:127], v[184:187], v[228:231], a[124:127]
  ds_write_b128 v16, a[88:91] offset:10816
  v_mfma_f32_16x16x32_bf16 a[128:131], v[188:191], v[216:219], a[128:131]
  ds_write_b128 v16, a[92:95] offset:16192
  v_mfma_f32_16x16x32_bf16 a[132:135], v[188:191], v[220:223], a[132:135]
  ds_write_b128 v16, a[96:99] offset:128
  v_mfma_f32_16x16x32_bf16 a[136:139], v[188:191], v[224:227], a[136:139]
  ds_write_b128 v16, a[100:103] offset:5504
  v_mfma_f32_16x16x32_bf16 a[140:143], v[188:191], v[228:231], a[140:143]
  ds_write_b128 v16, a[104:107] offset:10880
  ds_write_b128 v16, a[108:111] offset:16256
  ds_write_b128 v16, a[112:115] offset:192
  ds_write_b128 v16, a[116:119] offset:5568
  ds_write_b128 v16, a[120:123] offset:10944
  ds_write_b128 v16, a[124:127] offset:16320
  ds_write_b128 v16, a[128:131] offset:256
  ds_write_b128 v16, a[132:135] offset:5632
  ds_write_b128 v16, a[136:139] offset:11008
  ds_write_b128 v16, a[140:143] offset:16384
  s_waitcnt lgkmcnt(0)
  s_barrier
  ds_read_b128 v[32:35], v251 offset:0
  ds_read_b128 v[36:39], v251 offset:16
  ds_read_b128 v[40:43], v251 offset:38912
  ds_read_b128 v[44:47], v251 offset:38928
  ds_read_b128 v[48:51], v20 offset:0
  ds_read_b128 v[52:55], v20 offset:16
  ds_read_b128 v[56:59], v20 offset:38912
  ds_read_b128 v[60:63], v20 offset:38928
  ds_read_b128 v[64:67], v252 offset:0
  ds_read_b128 v[68:71], v252 offset:16
  ds_read_b128 v[72:75], v252 offset:38912
  ds_read_b128 v[76:79], v252 offset:38928
  ds_read_b128 v[80:83], v21 offset:0
  ds_read_b128 v[84:87], v21 offset:16
  ds_read_b128 v[88:91], v21 offset:38912
  ds_read_b128 v[92:95], v21 offset:38928
  ds_read_b128 v[128:131], v253 offset:0
  ds_read_b128 v[132:135], v253 offset:16
  ds_read_b128 v[136:139], v253 offset:38912
  ds_read_b128 v[140:143], v253 offset:38928
  ds_read_b128 v[144:147], v22 offset:0
  ds_read_b128 v[148:151], v22 offset:16
  ds_read_b128 v[152:155], v22 offset:38912
  ds_read_b128 v[156:159], v22 offset:38928
  s_waitcnt lgkmcnt(15)
  v_pk_add_f32 v[32:33], v[32:33], v[40:41]
  v_pk_add_f32 v[48:49], v[48:49], v[56:57]
  v_pk_add_f32 v[34:35], v[34:35], v[42:43]
  v_pk_add_f32 v[50:51], v[50:51], v[58:59]
  v_pk_add_f32 v[36:37], v[36:37], v[44:45]
  v_pk_add_f32 v[52:53], v[52:53], v[60:61]
  v_pk_add_f32 v[38:39], v[38:39], v[46:47]
  v_pk_add_f32 v[54:55], v[54:55], v[62:63]
  v_pk_add_f32 v[32:33], v[32:33], v[48:49]
  v_pk_add_f32 v[34:35], v[34:35], v[50:51]
  v_pk_add_f32 v[36:37], v[36:37], v[52:53]
  v_pk_add_f32 v[38:39], v[38:39], v[54:55]
  v_cvt_pk_bf16_f32 v40, v32, v33
  v_cvt_pk_bf16_f32 v41, v34, v35
  v_cvt_pk_bf16_f32 v42, v36, v37
  v_cvt_pk_bf16_f32 v43, v38, v39
  v_lshlrev_b32 v32, 16, v40
  v_and_b32 v33, 0xffff0000, v40
  v_lshlrev_b32 v34, 16, v41
  v_and_b32 v35, 0xffff0000, v41
  v_lshlrev_b32 v36, 16, v42
  v_and_b32 v37, 0xffff0000, v42
  v_lshlrev_b32 v38, 16, v43
  v_and_b32 v39, 0xffff0000, v43
  v_pk_add_f32 v[32:33], v[32:33], v[96:97]
  v_pk_add_f32 v[34:35], v[34:35], v[98:99]
  v_pk_add_f32 v[36:37], v[36:37], v[100:101]
  v_pk_add_f32 v[38:39], v[38:39], v[102:103]
  v_cvt_pk_bf16_f32 v40, v32, v33
  v_cvt_pk_bf16_f32 v41, v34, v35
  v_cvt_pk_bf16_f32 v42, v36, v37
  v_cvt_pk_bf16_f32 v43, v38, v39
  v_lshlrev_b32 v32, 16, v40
  v_and_b32 v33, 0xffff0000, v40
  v_lshlrev_b32 v34, 16, v41
  v_and_b32 v35, 0xffff0000, v41
  v_lshlrev_b32 v36, 16, v42
  v_and_b32 v37, 0xffff0000, v42
  v_lshlrev_b32 v38, 16, v43
  v_and_b32 v39, 0xffff0000, v43
  v_pk_add_f32 v[32:33], v[32:33], v[120:121]
  v_pk_add_f32 v[34:35], v[34:35], v[122:123]
  v_pk_add_f32 v[36:37], v[36:37], v[124:125]
  v_pk_add_f32 v[38:39], v[38:39], v[126:127]
  v_cvt_pk_bf16_f32 v44, v32, v33
  v_cvt_pk_bf16_f32 v45, v34, v35
  v_cvt_pk_bf16_f32 v46, v36, v37
  v_cvt_pk_bf16_f32 v47, v38, v39
  buffer_store_dwordx4 v[44:47], v248, s[48:51], 0 offen
  s_waitcnt lgkmcnt(8)
  v_pk_add_f32 v[64:65], v[64:65], v[72:73]
  v_pk_add_f32 v[80:81], v[80:81], v[88:89]
  v_pk_add_f32 v[66:67], v[66:67], v[74:75]
  v_pk_add_f32 v[82:83], v[82:83], v[90:91]
  v_pk_add_f32 v[68:69], v[68:69], v[76:77]
  v_pk_add_f32 v[84:85], v[84:85], v[92:93]
  v_pk_add_f32 v[70:71], v[70:71], v[78:79]
  v_pk_add_f32 v[86:87], v[86:87], v[94:95]
  v_pk_add_f32 v[64:65], v[64:65], v[80:81]
  v_pk_add_f32 v[66:67], v[66:67], v[82:83]
  v_pk_add_f32 v[68:69], v[68:69], v[84:85]
  v_pk_add_f32 v[70:71], v[70:71], v[86:87]
  v_cvt_pk_bf16_f32 v72, v64, v65
  v_cvt_pk_bf16_f32 v73, v66, v67
  v_cvt_pk_bf16_f32 v74, v68, v69
  v_cvt_pk_bf16_f32 v75, v70, v71
  v_lshlrev_b32 v64, 16, v72
  v_and_b32 v65, 0xffff0000, v72
  v_lshlrev_b32 v66, 16, v73
  v_and_b32 v67, 0xffff0000, v73
  v_lshlrev_b32 v68, 16, v74
  v_and_b32 v69, 0xffff0000, v74
  v_lshlrev_b32 v70, 16, v75
  v_and_b32 v71, 0xffff0000, v75
  v_pk_add_f32 v[64:65], v[64:65], v[104:105]
  v_pk_add_f32 v[66:67], v[66:67], v[106:107]
  v_pk_add_f32 v[68:69], v[68:69], v[108:109]
  v_pk_add_f32 v[70:71], v[70:71], v[110:111]
  v_cvt_pk_bf16_f32 v72, v64, v65
  v_cvt_pk_bf16_f32 v73, v66, v67
  v_cvt_pk_bf16_f32 v74, v68, v69
  v_cvt_pk_bf16_f32 v75, v70, v71
  v_lshlrev_b32 v64, 16, v72
  v_and_b32 v65, 0xffff0000, v72
  v_lshlrev_b32 v66, 16, v73
  v_and_b32 v67, 0xffff0000, v73
  v_lshlrev_b32 v68, 16, v74
  v_and_b32 v69, 0xffff0000, v74
  v_lshlrev_b32 v70, 16, v75
  v_and_b32 v71, 0xffff0000, v75
  v_pk_add_f32 v[64:65], v[64:65], v[160:161]
  v_pk_add_f32 v[66:67], v[66:67], v[162:163]
  v_pk_add_f32 v[68:69], v[68:69], v[164:165]
  v_pk_add_f32 v[70:71], v[70:71], v[166:167]
  v_cvt_pk_bf16_f32 v76, v64, v65
  v_cvt_pk_bf16_f32 v77, v66, v67
  v_cvt_pk_bf16_f32 v78, v68, v69
  v_cvt_pk_bf16_f32 v79, v70, v71
  buffer_store_dwordx4 v[76:79], v249, s[48:51], 0 offen
  s_waitcnt lgkmcnt(0)
  v_pk_add_f32 v[128:129], v[128:129], v[136:137]
  v_pk_add_f32 v[144:145], v[144:145], v[152:153]
  v_pk_add_f32 v[130:131], v[130:131], v[138:139]
  v_pk_add_f32 v[146:147], v[146:147], v[154:155]
  v_pk_add_f32 v[132:133], v[132:133], v[140:141]
  v_pk_add_f32 v[148:149], v[148:149], v[156:157]
  v_pk_add_f32 v[134:135], v[134:135], v[142:143]
  v_pk_add_f32 v[150:151], v[150:151], v[158:159]
  v_pk_add_f32 v[128:129], v[128:129], v[144:145]
  v_pk_add_f32 v[130:131], v[130:131], v[146:147]
  v_pk_add_f32 v[132:133], v[132:133], v[148:149]
  v_pk_add_f32 v[134:135], v[134:135], v[150:151]
  v_cvt_pk_bf16_f32 v136, v128, v129
  v_cvt_pk_bf16_f32 v137, v130, v131
  v_cvt_pk_bf16_f32 v138, v132, v133
  v_cvt_pk_bf16_f32 v139, v134, v135
  v_lshlrev_b32 v128, 16, v136
  v_and_b32 v129, 0xffff0000, v136
  v_lshlrev_b32 v130, 16, v137
  v_and_b32 v131, 0xffff0000, v137
  v_lshlrev_b32 v132, 16, v138
  v_and_b32 v133, 0xffff0000, v138
  v_lshlrev_b32 v134, 16, v139
  v_and_b32 v135, 0xffff0000, v139
  v_pk_add_f32 v[128:129], v[128:129], v[112:113]
  v_pk_add_f32 v[130:131], v[130:131], v[114:115]
  v_pk_add_f32 v[132:133], v[132:133], v[116:117]
  v_pk_add_f32 v[134:135], v[134:135], v[118:119]
  v_cvt_pk_bf16_f32 v136, v128, v129
  v_cvt_pk_bf16_f32 v137, v130, v131
  v_cvt_pk_bf16_f32 v138, v132, v133
  v_cvt_pk_bf16_f32 v139, v134, v135
  v_lshlrev_b32 v128, 16, v136
  v_and_b32 v129, 0xffff0000, v136
  v_lshlrev_b32 v130, 16, v137
  v_and_b32 v131, 0xffff0000, v137
  v_lshlrev_b32 v132, 16, v138
  v_and_b32 v133, 0xffff0000, v138
  v_lshlrev_b32 v134, 16, v139
  v_and_b32 v135, 0xffff0000, v139
  v_pk_add_f32 v[128:129], v[128:129], v[168:169]
  v_pk_add_f32 v[130:131], v[130:131], v[170:171]
  v_pk_add_f32 v[132:133], v[132:133], v[172:173]
  v_pk_add_f32 v[134:135], v[134:135], v[174:175]
  v_cvt_pk_bf16_f32 v140, v128, v129
  v_cvt_pk_bf16_f32 v141, v130, v131
  v_cvt_pk_bf16_f32 v142, v132, v133
  v_cvt_pk_bf16_f32 v143, v134, v135
  buffer_store_dwordx4 v[140:143], v250, s[48:51], 0 offen
fa_end:
  s_endpgm
fa_hk0:
  s_getpc_b64 s[10:11]
fa_hp0:
  s_add_u32 s8, s8, 4
  s_addc_u32 s9, s9, 0
  s_sub_u32 s10, s10, fa_hp0-fa_hb0
  s_subb_u32 s11, s11, 0
  s_setpc_b64 s[8:9]
fa_hk1:
  s_getpc_b64 s[10:11]
fa_hp1:
  s_add_u32 s8, s8, 4
  s_addc_u32 s9, s9, 0
  s_sub_u32 s10, s10, fa_hp1-fa_hb1
  s_subb_u32 s11, s11, 0
  s_setpc_b64 s[8:9]
fa_hk2:
  s_getpc_b64 s[10:11]
fa_hp2:
  s_add_u32 s8, s8, 4
  s_addc_u32 s9, s9, 0
  s_sub_u32 s10, s10, fa_hp2-fa_hb2
  s_subb_u32 s11, s11, 0
  s_setpc_b64 s[8:9]
fa_hk3:
  s_getpc_b64 s[10:11]
fa_hp3:
  s_add_u32 s8, s8, 4
  s_addc_u32 s9, s9, 0
  s_sub_u32 s10, s10, fa_hp3-fa_hb3
  s_subb_u32 s11, s11, 0
  s_setpc_b64 s[8:9]
fa_ln_spin:
  s_mov_b32 s83, 200000
fa_ln_spin2:
  buffer_load_dword v15, v229, s[56:59], 0 offen sc1
  s_waitcnt vmcnt(0)
  v_cmp_ne_u32 vcc, 0x01010101, v15
  s_cbranch_vccz fa_ln_ok
  s_sleep 8
  s_sub_u32 s83, s83, 1
  s_cmp_lg_u32 s83, 0
  s_cbranch_scc1 fa_ln_spin2
  s_branch fa_ln_ok
fa_co1:
  buffer_load_dword v232, v234, s[32:35], s29 offen
  buffer_store_dword v229, v225, s[40:43], 0 offen sc1
  ds_read_b128 v[160:163], v221 offset:0
  ds_read_b128 v[164:167], v221 offset:4096
  ds_read_b128 v[168:171], v221 offset:8192
  buffer_store_dword v218, v222, s[40:43], 0 offen sc1
  s_waitcnt lgkmcnt(0)
  buffer_store_dwordx4 v[160:163], v223, s[40:43], s66 offen sc1
  buffer_store_dwordx4 v[164:167], v223, s[40:43], s67 offen sc1
  buffer_store_dwordx4 v[168:171], v224, s[40:43], s78 offen sc1
  s_getpc_b64 s[8:9]
  s_setpc_b64 s[10:11]
  s_mov_b32 s48, s60
  s_mov_b32 s49, s61
  s_mov_b32 s50, s75
  s_lshl_b32 s74, s22, 2
  s_add_u32 s74, s74, s20
  s_lshl_b32 s74, s74, 16
  s_mov_b32 s73, 2097152
  v_mov_b32 v213, 1073741824
  v_mov_b32 v214, 1
  v_writelane_b32 v213, s77, 0
  v_lshlrev_b32 v229, 2, v1
  s_and_b32 s23, s21, 3
  s_cbranch_scc0 fa_arr
  s_getpc_b64 s[8:9]
  s_setpc_b64 s[10:11]
fa_arr:
  buffer_store_byte v214, v213, s[56:59], 0 offen sc1
  s_getpc_b64 s[8:9]
  s_setpc_b64 s[10:11]
  buffer_load_dword v15, v229, s[56:59], 0 offen sc1
  s_getpc_b64 s[8:9]
  s_setpc_b64 s[10:11]
  s_mov_b32 s36, s60
  s_mov_b32 s37, s61
  s_mov_b32 s38, s75
  s_lshr_b32 s27, s20, 1
  s_lshl_b32 s27, s27, 18
  s_mov_b32 s25, 524288
  s_mov_b32 s32, s18
  s_mov_b32 s33, s19
  s_mov_b32 s34, 2621440
  s_mov_b32 s26, 0
  s_movk_i32 s79, 1024
  s_lshl_b32 s23, s22, 2
  s_add_u32 s23, s23, s20
  s_mul_i32 s23, s23, 40960
  v_add_u32 v3, s23, v2
  s_sub_u32 s23, 15, s22
  s_lshl_b32 s23, s23, 2
  s_add_u32 s23, s23, s20
  s_mul_i32 s23, s23, 40960
  s_sub_u32 s23, s23, 2048
  v_add_u32 v5, s23, v2
  v_add_u32 v4, 19456, v3
  v_add_u32 v6, 19456, v5
  s_waitcnt vmcnt(8)
  v_cmp_ne_u32 vcc, 0x01010101, v15
  s_cbranch_vccnz fa_ln_spin
fa_ln_ok:
  s_setpc_b64 s[10:11]
fa_kv_spin:
  s_mov_b32 s83, 200000
fa_kv_spin2:
  buffer_load_dword v15, v8, s[40:43], 0 offen sc1
  s_waitcnt vmcnt(0)
  v_cmp_eq_u32 vcc, 0, v15
  s_cbranch_vccz fa_kv_ok
  s_sleep 8
  s_sub_u32 s83, s83, 1
  s_cmp_lg_u32 s83, 0
  s_cbranch_scc1 fa_kv_spin2
  s_branch fa_kv_ok
fa_top8:
  s_cmp_lg_u32 s20, 0
  s_cbranch_scc1 fa_notop
  s_mov_b32 s23, 2621440
  s_mov_b32 s31, 2625536
  buffer_load_dwordx4 v[96:99], v2, s[40:43], s23 offen offset:0 sc1
  buffer_load_dwordx4 v[100:103], v2, s[40:43], s23 offen offset:1024 sc1
  buffer_load_dwordx4 v[104:107], v2, s[40:43], s23 offen offset:2048 sc1
  buffer_load_dwordx4 v[108:111], v2, s[40:43], s23 offen offset:3072 sc1
  buffer_load_dwordx4 v[112:115], v2, s[40:43], s31 offen offset:0 sc1
  buffer_load_dwordx4 v[116:119], v2, s[40:43], s31 offen offset:1024 sc1
  buffer_load_dwordx4 v[120:123], v2, s[40:43], s31 offen offset:2048 sc1
  buffer_load_dwordx4 v[124:127], v2, s[40:43], s31 offen offset:3072 sc1
  v_mov_b32 v21, 0
  v_mov_b32 v22, 0
  v_and_b32 v23, 7, v1
  s_mov_b32 s23, 0
  s_waitcnt vmcnt(0)
fa_top:
  v_max3_u32 v20, v96, v97, v98
  v_max3_u32 v24, v99, v100, v101
  v_max3_u32 v20, v20, v102, v103
  v_max3_u32 v24, v24, v104, v105
  v_max3_u32 v20, v20, v106, v107
  v_max3_u32 v24, v24, v108, v109
  v_max3_u32 v20, v20, v110, v111
  v_max3_u32 v24, v24, v112, v113
  v_max3_u32 v20, v20, v114, v115
  v_max3_u32 v24, v24, v116, v117
  v_max3_u32 v20, v20, v118, v119
  v_max3_u32 v24, v24, v120, v121
  v_max3_u32 v20, v20, v122, v123
  v_max3_u32 v24, v24, v124, v125
  v_max3_u32 v20, v20, v126, v127
  v_max_u32 v20, v20, v24
  s_nop 1
  v_max_u32_dpp v20, v20, v20 quad_perm:[1,0,3,2] row_mask:0xf bank_mask:0xf
  s_nop 1
  v_max_u32_dpp v20, v20, v20 quad_perm:[2,3,0,1] row_mask:0xf bank_mask:0xf
  s_nop 1
  v_max_u32_dpp v20, v20, v20 row_half_mirror row_mask:0xf bank_mask:0xf
  s_nop 1
  v_max_u32_dpp v20, v20, v20 row_mirror row_mask:0xf bank_mask:0xf
  v_mov_b32 v24, v20
  s_nop 1
  v_permlane16_swap_b32 v20, v24
  v_max_u32 v20, v20, v24
  v_mov_b32 v24, v20
  s_nop 1
  v_permlane32_swap_b32 v20, v24
  v_max_u32 v20, v20, v24
  v_add_u32 v21, v21, v20
  v_cmp_eq_u32 vcc, s23, v23
  v_sub_u32 v96, v96, v20
  v_sub_u32 v97, v97, v20
  v_sub_u32 v98, v98, v20
  v_sub_u32 v99, v99, v20
  v_sub_u32 v100, v100, v20
  v_sub_u32 v101, v101, v20
  v_sub_u32 v102, v102, v20
  v_sub_u32 v103, v103, v20
  v_sub_u32 v104, v104, v20
  v_sub_u32 v105, v105, v20
  v_sub_u32 v106, v106, v20
  v_sub_u32 v107, v107, v20
  v_sub_u32 v108, v108, v20
  v_sub_u32 v109, v109, v20
  v_sub_u32 v110, v110, v20
  v_sub_u32 v111, v111, v20
  v_sub_u32 v112, v112, v20
  v_sub_u32 v113, v113, v20
  v_sub_u32 v114, v114, v20
  v_sub_u32 v115, v115, v20
  v_sub_u32 v116, v116, v20
  v_sub_u32 v117, v117, v20
  v_sub_u32 v118, v118, v20
  v_sub_u32 v119, v119, v20
  v_sub_u32 v120, v120, v20
  v_sub_u32 v121, v121, v20
  v_sub_u32 v122, v122, v20
  v_sub_u32 v123, v123, v20
  v_sub_u32 v124, v124, v20
  v_sub_u32 v125, v125, v20
  v_sub_u32 v126, v126, v20
  v_sub_u32 v127, v127, v20
  v_cndmask_b32 v22, v22, v21, vcc
  s_add_u32 s23, s23, 1
  s_cmp_lt_u32 s23, 8
  s_cbranch_scc1 fa_top
  v_and_b32 v25, 0xffff, v22
  v_sub_u32 v25, 0xffff, v25
  v_and_b32 v25, 2047, v25
  v_ashrrev_i32 v20, 31, v22
  v_not_b32 v20, v20
  v_or_b32 v20, 0x80000000, v20
  v_xor_b32 v26, v22, v20
  v_and_b32 v26, 0xffff0000, v26
  v_mul_f32 v26, 0xbfb8aa3b, v26
  v_exp_f32 v26, v26
  s_nop 0
  v_add_f32 v26, 1.0, v26
  v_rcp_f32 v26, v26
  s_nop 0
  v_cvt_pk_bf16_f32 v26, v26, v26
  v_and_b32 v26, 0xffff0000, v26
  v_lshlrev_b32 v20, 2, v1
  v_add_u32 v20, 2629632, v20
  v_mov_b32 v21, 1073741824
  v_cmp_gt_u32 vcc, 16, v1
  v_add_u32 v25, 1, v25
  v_or_b32 v26, 1, v26
  v_cndmask_b32 v20, v21, v20, vcc
  v_cmp_gt_u32 vcc, 8, v1
  s_nop 1
  v_cndmask_b32 v26, v26, v25, vcc
  buffer_store_dword v26, v20, s[40:43], 0 offen sc1
  s_branch fa_notop
fa_hk4:
  s_getpc_b64 s[38:39]
fa_hp4:
  s_add_u32 s36, s36, 4
  s_addc_u32 s37, s37, 0
  s_sub_u32 s38, s38, fa_hp4-fa_hb4
  s_subb_u32 s39, s39, 0
  s_setpc_b64 s[36:37]
fa_hk5:
  s_getpc_b64 s[38:39]
fa_hp5:
  s_add_u32 s36, s36, 4
  s_addc_u32 s37, s37, 0
  s_sub_u32 s38, s38, fa_hp5-fa_hb5
  s_subb_u32 s39, s39, 0
  s_setpc_b64 s[36:37]
fa_hk6:
  s_getpc_b64 s[38:39]
fa_hp6:
  s_add_u32 s36, s36, 4
  s_addc_u32 s37, s37, 0
  s_add_u32 s38, s38, fa_hb6-fa_hp6
  s_addc_u32 s39, s39, 0
  s_setpc_b64 s[36:37]
fa_DDF:
  v_mfma_f32_16x16x32_bf16 v[96:99], a[128:131], v[32:35], v[192:195]
  s_waitcnt vmcnt(12)
  v_exp_f32 v218, v146
  v_mfma_f32_16x16x32_bf16 v[104:107], a[128:131], v[36:39], v[196:199]
  s_barrier
  v_exp_f32 v219, v147
  v_mfma_f32_16x16x32_bf16 v[128:131], a[128:131], v[64:67], v[200:203]
  s_cmp_ge_u32 s26, s32
  ds_read_b128 a[160:163], v3 offset:16384
  v_add_f32 v226, v216, v217
  v_mfma_f32_16x16x32_bf16 v[136:139], a[128:131], v[68:71], v[204:207]
  s_cbranch_scc1 fa_hk6
fa_hb6:
  v_exp_f32 v220, v148
  v_mfma_f32_16x16x32_bf16 v[100:103], a[132:135], v[32:35], v[192:195]
  ds_read_b128 a[164:167], v3 offset:17408
  v_cvt_pk_bf16_f32 v184, v216, v217
  v_mfma_f32_16x16x32_bf16 v[108:111], a[132:135], v[36:39], v[196:199]
  s_mov_b32 m0, s24
  v_exp_f32 v221, v149
  v_mfma_f32_16x16x32_bf16 v[132:135], a[132:135], v[64:67], v[200:203]
  buffer_load_dwordx4 v2, s[44:47], s26 offen offset:0 sc1 lds
  v_add_f32 v226, v226, v218
  v_mfma_f32_16x16x32_bf16 v[140:143], a[132:135], v[68:71], v[204:207]
  v_exp_f32 v222, v150
  v_mfma_f32_16x16x32_bf16 v[96:99], a[136:139], v[40:43], v[96:99]
  ds_read_b128 a[168:171], v3 offset:18432
  v_add_f32 v226, v226, v219
  v_cvt_pk_bf16_f32 v185, v218, v219
  v_mfma_f32_16x16x32_bf16 v[104:107], a[136:139], v[44:47], v[104:107]
  v_exp_f32 v223, v151
  v_mfma_f32_16x16x32_bf16 v[128:131], a[136:139], v[72:75], v[128:131]
  v_add_f32 v226, v226, v220
  v_add_f32 v226, v226, v221
  v_mfma_f32_16x16x32_bf16 v[136:139], a[136:139], v[76:79], v[136:139]
  v_exp_f32 v216, v152
  v_mfma_f32_16x16x32_bf16 v[100:103], a[140:143], v[40:43], v[100:103]
  ds_read_b128 a[172:175], v3 offset:19456
  v_cvt_pk_bf16_f32 v186, v220, v221
  v_mfma_f32_16x16x32_bf16 v[108:111], a[140:143], v[44:47], v[108:111]
  buffer_load_dwordx4 v2, s[44:47], s26 offen offset:1024 sc1 lds
  v_add_f32 v226, v226, v222
  v_mfma_f32_16x16x32_bf16 v[132:135], a[140:143], v[72:75], v[132:135]
  v_exp_f32 v217, v153
  v_mfma_f32_16x16x32_bf16 v[140:143], a[140:143], v[76:79], v[140:143]
  s_waitcnt lgkmcnt(4)
  v_exp_f32 v218, v154
  v_mfma_f32_16x16x32_bf16 v[96:99], a[144:147], v[48:51], v[96:99]
  ds_read_b128 a[176:179], v3 offset:20480
  v_add_f32 v226, v226, v223
  v_mfma_f32_16x16x32_bf16 v[104:107], a[144:147], v[52:55], v[104:107]
  v_exp_f32 v219, v155
  v_mfma_f32_16x16x32_bf16 v[128:131], a[144:147], v[80:83], v[128:131]
  v_cvt_pk_bf16_f32 v187, v222, v223
  v_add_f32 v227, v216, v217
  v_cvt_pk_bf16_f32 v188, v216, v217
  v_mfma_f32_16x16x32_bf16 v[136:139], a[144:147], v[84:87], v[136:139]
  buffer_load_dwordx4 v2, s[44:47], s26 offen offset:2048 sc1 lds
  v_add_f32 v227, v227, v218
  v_mfma_f32_16x16x32_bf16 v[100:103], a[148:151], v[48:51], v[100:103]
  ds_read_b128 a[180:183], v3 offset:21504
  v_add_f32 v227, v227, v219
  v_mfma_f32_16x16x32_bf16 v[108:111], a[148:151], v[52:55], v[108:111]
  v_exp_f32 v220, v156
  v_mfma_f32_16x16x32_bf16 v[132:135], a[148:151], v[80:83], v[132:135]
  v_exp_f32 v221, v157
  v_mfma_f32_16x16x32_bf16 v[140:143], a[148:151], v[84:87], v[140:143]
  v_exp_f32 v222, v158
  v_mfma_f32_16x16x32_bf16 v[96:99], a[152:155], v[56:59], v[96:99]
  ds_read_b128 a[184:187], v3 offset:22528
  v_cvt_pk_bf16_f32 v189, v218, v219
  v_mfma_f32_16x16x32_bf16 v[104:107], a[152:155], v[60:63], v[104:107]
  buffer_load_dwordx4 v2, s[44:47], s26 offen offset:3072 sc1 lds
  v_add_f32 v227, v227, v220
  v_add_f32 v227, v227, v221
  v_mfma_f32_16x16x32_bf16 v[128:131], a[152:155], v[88:91], v[128:131]
  s_add_u32 s26, s26, 16384
  v_exp_f32 v223, v159
  v_mfma_f32_16x16x32_bf16 v[136:139], a[152:155], v[92:95], v[136:139]
  s_add_u32 s24, s24, 32768
  v_exp_f32 v208, v112
  v_mfma_f32_16x16x32_bf16 v[100:103], a[156:159], v[56:59], v[100:103]
  s_and_b32 s24, s24, 0x1ffff
  ds_read_b128 a[188:191], v3 offset:23552
  v_cvt_pk_bf16_f32 v190, v220, v221
  v_mfma_f32_16x16x32_bf16 v[108:111], a[156:159], v[60:63], v[108:111]
  v_exp_f32 v209, v113
  v_mfma_f32_16x16x32_bf16 v[132:135], a[156:159], v[88:91], v[132:135]
  s_add_u32 m0, s34, 0
  v_exp_f32 v210, v114
  v_mfma_f32_16x16x32_bf16 v[140:143], a[156:159], v[92:95], v[140:143]
  s_waitcnt lgkmcnt(4)
  buffer_load_dwordx4 v8, s[52:55], s33 offen offset:0 lds
  v_add_f32 v227, v227, v222
  v_mfma_f32_16x16x32_bf16 a[0:3], a[160:163], v[160:163], a[0:3]
  ds_read_b128 a[128:131], v3 offset:0
  v_add_f32 v227, v227, v223
  v_mfma_f32_16x16x32_bf16 a[4:7], a[160:163], v[164:167], a[4:7]
  v_exp_f32 v211, v115
  v_mfma_f32_16x16x32_bf16 a[64:67], a[160:163], v[176:179], a[64:67]
  v_cvt_pk_bf16_f32 v191, v222, v223
  v_add_f32 v224, v208, v209
  v_cvt_pk_bf16_f32 v168, v208, v209
  v_mfma_f32_16x16x32_bf16 a[68:71], a[160:163], v[180:183], a[68:71]
  v_exp_f32 v212, v116
  v_mfma_f32_16x16x32_bf16 a[8:11], a[164:167], v[160:163], a[8:11]
  ds_read_b128 a[132:135], v3 offset:1024
  v_add_f32 v224, v224, v210
  v_mfma_f32_16x16x32_bf16 a[12:15], a[164:167], v[164:167], a[12:15]
  buffer_load_dwordx4 v11, s[52:55], s33 offen offset:1024 lds
  v_add_f32 v224, v224, v211
  v_mfma_f32_16x16x32_bf16 a[72:75], a[164:167], v[176:179], a[72:75]
  v_exp_f32 v213, v117
  v_mfma_f32_16x16x32_bf16 a[76:79], a[164:167], v[180:183], a[76:79]
  v_exp_f32 v214, v118
  v_mfma_f32_16x16x32_bf16 a[16:19], a[168:171], v[160:163], a[16:19]
  ds_read_b128 a[136:139], v3 offset:2048
  v_cvt_pk_bf16_f32 v169, v210, v211
  v_mfma_f32_16x16x32_bf16 a[20:23], a[168:171], v[164:167], a[20:23]
  v_exp_f32 v215, v119
  v_mfma_f32_16x16x32_bf16 a[80:83], a[168:171], v[176:179], a[80:83]
  v_add_f32 v224, v224, v212
  v_add_f32 v224, v224, v213
  v_cvt_pk_bf16_f32 v170, v212, v213
  v_mfma_f32_16x16x32_bf16 a[84:87], a[168:171], v[180:183], a[84:87]
  buffer_load_dwordx4 v12, s[52:55], s33 offen offset:2048 lds
  v_add_f32 v224, v224, v214
  v_mfma_f32_16x16x32_bf16 a[24:27], a[172:175], v[160:163], a[24:27]
  ds_read_b128 a[140:143], v3 offset:3072
  v_add_f32 v224, v224, v215
  v_mfma_f32_16x16x32_bf16 a[28:31], a[172:175], v[164:167], a[28:31]
  v_exp_f32 v208, v120
  v_mfma_f32_16x16x32_bf16 a[88:91], a[172:175], v[176:179], a[88:91]
  v_exp_f32 v209, v121
  v_mfma_f32_16x16x32_bf16 a[92:95], a[172:175], v[180:183], a[92:95]
  s_waitcnt lgkmcnt(4)
  v_exp_f32 v210, v122
  v_mfma_f32_16x16x32_bf16 a[32:35], a[176:179], v[160:163], a[32:35]
  ds_read_b128 a[144:147], v3 offset:4096
  v_cvt_pk_bf16_f32 v171, v214, v215
  v_mfma_f32_16x16x32_bf16 a[36:39], a[176:179], v[164:167], a[36:39]
  buffer_load_dwordx4 v13, s[52:55], s33 offen offset:3072 lds
  v_add_f32 v225, v208, v209
  v_mfma_f32_16x16x32_bf16 a[96:99], a[176:179], v[176:179], a[96:99]
  v_exp_f32 v211, v123
  v_mfma_f32_16x16x32_bf16 a[100:103], a[176:179], v[180:183], a[100:103]
  v_exp_f32 v212, v124
  v_mfma_f32_16x16x32_bf16 a[40:43], a[180:183], v[160:163], a[40:43]
  ds_read_b128 a[148:151], v3 offset:5120
  v_cvt_pk_bf16_f32 v172, v208, v209
  v_add_f32 v225, v225, v210
  v_mfma_f32_16x16x32_bf16 a[44:47], a[180:183], v[164:167], a[44:47]
  v_exp_f32 v213, v125
  v_mfma_f32_16x16x32_bf16 a[104:107], a[180:183], v[176:179], a[104:107]
  s_add_u32 m0, s34, 4096
  v_add_f32 v225, v225, v211
  v_cvt_pk_bf16_f32 v173, v210, v211
  v_mfma_f32_16x16x32_bf16 a[108:111], a[180:183], v[180:183], a[108:111]
  buffer_load_dwordx4 v14, s[52:55], s33 offen offset:0 lds
  v_max3_f32 v5, v226, v227, v224
  v_mfma_f32_16x16x32_bf16 a[48:51], a[184:187], v[160:163], a[48:51]
  ds_read_b128 a[152:155], v3 offset:6144
  v_add_f32 v225, v225, v212
  v_mfma_f32_16x16x32_bf16 a[52:55], a[184:187], v[164:167], a[52:55]
  v_exp_f32 v214, v126
  v_mfma_f32_16x16x32_bf16 a[112:115], a[184:187], v[176:179], a[112:115]
  v_exp_f32 v215, v127
  v_mfma_f32_16x16x32_bf16 a[116:119], a[184:187], v[180:183], a[116:119]
  v_add_f32 v225, v225, v213
  v_cvt_pk_bf16_f32 v174, v212, v213
  v_add_f32 v225, v225, v214
  v_mfma_f32_16x16x32_bf16 a[56:59], a[188:191], v[160:163], a[56:59]
  ds_read_b128 a[156:159], v3 offset:7168
  v_add_f32 v225, v225, v215
  v_max_f32 v5, v5, v225
  v_cmp_lt_f32 vcc, s81, v5
  v_mfma_f32_16x16x32_bf16 a[60:63], a[188:191], v[164:167], a[60:63]
  v_exp_f32 v216, v128
  v_mfma_f32_16x16x32_bf16 a[120:123], a[188:191], v[176:179], a[120:123]
  s_waitcnt lgkmcnt(4)
  v_cvt_pk_bf16_f32 v175, v214, v215
  v_mfma_f32_16x16x32_bf16 a[124:127], a[188:191], v[180:183], a[124:127]
  s_cbranch_vccnz fa_stub3
fa_back3:
  v_exp_f32 v217, v129
  v_add_f32 v228, v228, v224
  v_add_f32 v229, v229, v225
  v_add_f32 v230, v230, v226
  v_add_f32 v231, v231, v227
  s_branch fa_DDe
fa_sel_spin:
  s_mov_b32 s83, 200000
fa_sel_spin2:
  buffer_load_dword v15, v252, s[40:43], 0 offen sc1
  s_waitcnt vmcnt(0)
  v_cmp_eq_u32 vcc, 0, v15
  s_cbranch_vccz fa_sel_ok
  s_sleep 8
  s_sub_u32 s83, s83, 1
  s_cmp_lg_u32 s83, 0
  s_cbranch_scc1 fa_sel_spin2
  s_branch fa_sel_ok
fa_wof_spin:
  s_mov_b32 s83, 200000
fa_wof_spin2:
  buffer_load_dword v8, v9, s[40:43], 0 offen sc1
  s_waitcnt vmcnt(0)
  v_cmp_eq_u32 vcc, 0, v8
  s_cbranch_vccz fa_wof_ok
  s_sleep 8
  s_sub_u32 s83, s83, 1
  s_cmp_lg_u32 s83, 0
  s_cbranch_scc1 fa_wof_spin2
  s_branch fa_wof_ok
fa_sel4_spin:
  s_mov_b32 s83, 200000
fa_sel4_spin2:
  buffer_load_dword v15, v10, s[40:43], 0 offen sc1
  s_waitcnt vmcnt(0)
  v_cmp_eq_u32 vcc, 0, v15
  s_cbranch_vccz fa_sel4_ok
  s_sleep 8
  s_sub_u32 s83, s83, 1
  s_cmp_lg_u32 s83, 0
  s_cbranch_scc1 fa_sel4_spin2
  s_branch fa_sel4_ok
fa_yf_spin:
  s_mov_b32 s83, 200000
fa_yf_spin2:
  buffer_load_dword v14, v11, s[40:43], 0 offen sc1
  s_waitcnt vmcnt(0)
  v_cmp_eq_u32 vcc, 0, v14
  s_cbranch_vccz fa_yf_ok
  s_sleep 8
  s_sub_u32 s83, s83, 1
  s_cmp_lg_u32 s83, 0
  s_cbranch_scc1 fa_yf_spin2
  s_branch fa_yf_ok
fa_co:
  s_sub_u32 s14, s2, 170
  s_cmp_lt_u32 s14, 54
  s_cbranch_scc1 fa_coF
  s_sub_u32 s14, s2, 64
  s_cmp_lt_u32 s14, 96
  s_cbranch_scc1 fa_coT
  s_cmp_eq_u32 s2, 255
  s_cbranch_scc1 fa_coW
  s_sub_u32 s14, s2, 128
  s_cmp_ge_u32 s2, 224
  s_cbranch_scc0 fa_coO
fa_coT:
  v_min_u32 v8, 16, v1
  v_lshlrev_b32 v8, 7, v8
  s_lshl_b32 s10, s14, 1
  s_and_b32 s31, s20, 1
  s_add_u32 s10, s10, s31
  s_mul_i32 s10, s10, 2176
  s_lshl_b32 s35, s14, 2
  s_add_u32 s35, s35, s20
  s_mul_i32 s35, s35, 4352
  buffer_load_dword v255, v8, s[52:55], s10 offen
  s_add_u32 s10, s10, 552960
  s_getpc_b64 s[36:37]
  s_setpc_b64 s[38:39]
  buffer_load_dword v255, v8, s[52:55], s10 offen
  s_add_u32 s10, s10, 552960
  s_getpc_b64 s[36:37]
  s_setpc_b64 s[38:39]
  buffer_load_dword v255, v8, s[52:55], s10 offen
  s_add_u32 s10, s10, 552960
  buffer_load_dword v255, v8, s[60:63], s35 offen offset:0
  s_getpc_b64 s[36:37]
  s_setpc_b64 s[38:39]
  buffer_load_dword v255, v8, s[52:55], s10 offen
  s_add_u32 s10, s10, 552960
  buffer_load_dword v255, v8, s[60:63], s35 offen offset:2176
  s_mov_b32 s9, -1
  s_and_b32 s32, s21, 3
  s_lshr_b32 s32, s32, 1
  s_add_u32 s32, s32, 6
  s_lshl_b32 s32, s32, 14
  s_getpc_b64 s[36:37]
  s_setpc_b64 s[38:39]
fa_coO:
  s_and_b32 s23, s67, 1
  s_lshl_b32 s23, s23, 2
  s_add_u32 s23, s23, s20
  s_lshr_b32 s31, s67, 1
  s_lshl_b32 s30, s23, 7
  s_add_u32 s30, s30, s31
  s_mul_i32 s33, s31, 40960
  s_mul_i32 s23, s23, 160
  s_add_u32 s33, s33, s23
  s_add_u32 m0, s34, 0
  v_accvgpr_read_b32 v19, a248
  buffer_load_dwordx4 v19, s[56:59], s33 offen lds
  s_add_u32 m0, s34, 1024
  v_accvgpr_read_b32 v19, a249
  buffer_load_dwordx4 v19, s[56:59], s33 offen lds
  s_add_u32 m0, s34, 2048
  v_accvgpr_read_b32 v19, a250
  buffer_load_dwordx4 v19, s[56:59], s33 offen lds
  s_add_u32 m0, s34, 3072
  v_accvgpr_read_b32 v19, a251
  buffer_load_dwordx4 v19, s[56:59], s33 offen lds
  s_add_u32 m0, s34, 4096
  v_accvgpr_read_b32 v19, a252
  buffer_load_dwordx4 v19, s[56:59], s33 offen lds
  s_add_u32 s32, s26, 32768
  s_mov_b32 s9, -1
  s_lshl_b32 s10, s30, 2
  s_mul_i32 s30, s30, 5120
  s_add_u32 s30, s30, 4194304
  s_getpc_b64 s[36:37]
  s_setpc_b64 s[38:39]
  s_waitcnt vmcnt(8)
  ds_read_b64_tr_b16 v[232:233], v6 offset:0
  ds_read_b64_tr_b16 v[234:235], v6 offset:2560
  ds_read_b64_tr_b16 v[236:237], v6 offset:32
  ds_read_b64_tr_b16 v[238:239], v6 offset:2592
  ds_read_b64_tr_b16 v[240:241], v6 offset:64
  ds_read_b64_tr_b16 v[242:243], v6 offset:2624
  ds_read_b64_tr_b16 v[244:245], v6 offset:96
  ds_read_b64_tr_b16 v[246:247], v6 offset:2656
  ds_read_b64_tr_b16 v[248:249], v6 offset:128
  ds_read_b64_tr_b16 v[250:251], v6 offset:2688
  s_waitcnt lgkmcnt(0)
  s_add_u32 s31, s30, 4096
  buffer_store_dwordx4 v[232:235], v2, s[40:43], s30 offen offset:0 sc1
  buffer_store_dwordx4 v[236:239], v2, s[40:43], s30 offen offset:1024 sc1
  buffer_store_dwordx4 v[240:243], v2, s[40:43], s30 offen offset:2048 sc1
  buffer_store_dwordx4 v[244:247], v2, s[40:43], s30 offen offset:3072 sc1
  buffer_store_dwordx4 v[248:251], v2, s[40:43], s31 offen offset:0 sc1
  s_getpc_b64 s[36:37]
  s_setpc_b64 s[38:39]
  s_add_u32 s23, s10, 2654208
  s_waitcnt vmcnt(8)
  buffer_store_dword v4, off, s[40:43], s23 sc1
  s_sub_u32 s23, s67, 96
  s_cmp_gt_u32 s23, 54
  s_cbranch_scc1 fa_coW
  s_add_u32 s67, s23, 170
  s_cmp_eq_u32 s67, 224
  s_cselect_b32 s67, 255, s67
  s_branch fa_coO
fa_coF:
  v_and_b32 v16, 7, v1
  v_lshlrev_b32 v252, 2, v16
  v_add_u32 v252, 2629632, v252
  buffer_load_dword v15, v252, s[40:43], 0 offen sc1
  s_lshl_b32 s33, s14, 6
  s_and_b32 s31, s20, 1
  s_lshl_b32 s31, s31, 5
  s_add_u32 s33, s33, s31
  s_mul_i32 s35, s14, 40960
  s_mul_i32 s31, s20, 320
  s_add_u32 s35, s35, s31
  s_mul_i32 s10, s14, 20480
  s_mul_i32 s31, s20, 5120
  s_add_u32 s10, s10, s31
  s_add_u32 s10, s10, 2686976
  v_lshrrev_b32 v17, 1, v1
  v_mul_u32_u24 v8, 3456, v17
  v_and_b32 v17, 1, v1
  v_lshl_add_u32 v8, v17, 4, v8
  v_add_u32 v11, 109568, v8
  v_add_u32 v12, 219136, v8
  v_add_u32 v13, 328704, v8
  v_add_u32 v14, 442368, v8
  v_lshrrev_b32 v17, 4, v1
  v_lshrrev_b32 v18, 2, v1
  v_lshl_add_u32 v18, v17, 2, v18
  v_lshlrev_b32 v18, 5, v18
  v_and_b32 v19, 3, v1
  v_lshl_add_u32 v9, v19, 3, v18
  v_add_u32 v9, s34, v9
  v_lshlrev_b32 v10, 4, v16
  v_lshl_add_u32 v10, v17, 7, v10
  v_add_u32 v10, 151552, v10
  s_mov_b32 s8, -1
  v_mov_b32 v232, 0
  v_mov_b32 v233, 0
  v_mov_b32 v234, 0
  v_mov_b32 v235, 0
  s_getpc_b64 s[36:37]
  s_setpc_b64 s[38:39]
  s_waitcnt vmcnt(8)
  v_cmp_eq_u32 vcc, 0, v15
  s_cbranch_vccnz fa_sel_spin
fa_sel_ok:
  v_add_u32 v18, -1, v15
  v_and_b32 v18, 2047, v18
  v_lshrrev_b32 v19, 4, v18
  v_mul_u32_u24 v19, 20480, v19
  v_and_b32 v18, 15, v18
  v_lshl_add_u32 v19, v18, 4, v19
  v_lshrrev_b32 v18, 3, v1
  v_lshl_add_u32 v19, v18, 8, v19
  s_lshl_b32 s23, s20, 11
  s_lshl_b32 s31, s20, 10
  s_add_u32 s31, s31, 151552
  s_mov_b32 s14, 4
  s_mov_b32 m0, s31
  s_add_u32 s31, s31, 4096
  buffer_load_dwordx4 v19, s[40:43], s23 offen sc1 lds
  s_add_u32 s23, s23, 8192
  s_mov_b32 m0, s31
  s_add_u32 s31, s31, 4096
  buffer_load_dwordx4 v19, s[40:43], s23 offen sc1 lds
  s_add_u32 s23, s23, 8192
  s_mov_b32 m0, s31
  s_add_u32 s31, s31, 4096
  buffer_load_dwordx4 v19, s[40:43], s23 offen sc1 lds
  s_add_u32 s23, s23, 8192
  s_getpc_b64 s[36:37]
  s_setpc_b64 s[38:39]
  s_branch fa_coG1
fa_coG:
  s_getpc_b64 s[36:37]
  s_setpc_b64 s[38:39]
  v_mfma_f32_16x16x32_bf16 v[232:235], a[192:195], a[212:215], v[232:235]
  v_mfma_f32_16x16x32_bf16 v[232:235], a[196:199], a[216:219], v[232:235]
  v_mfma_f32_16x16x32_bf16 v[232:235], a[200:203], a[220:223], v[232:235]
  v_mfma_f32_16x16x32_bf16 v[232:235], a[204:207], a[224:227], v[232:235]
  v_mfma_f32_16x16x32_bf16 v[232:235], a[208:211], a[228:231], v[232:235]
fa_coG1:
  s_waitcnt vmcnt(4)
  ds_read_b64_tr_b16 a[192:193], v9 offset:0
  ds_read_b64_tr_b16 a[194:195], v9 offset:128
  ds_read_b128 a[212:215], v10 offset:0
  ds_read_b64_tr_b16 a[196:197], v9 offset:1024
  ds_read_b64_tr_b16 a[198:199], v9 offset:1152
  ds_read_b128 a[216:219], v10 offset:512
  ds_read_b64_tr_b16 a[200:201], v9 offset:2048
  ds_read_b64_tr_b16 a[202:203], v9 offset:2176
  ds_read_b128 a[220:223], v10 offset:1024
  ds_read_b64_tr_b16 a[204:205], v9 offset:3072
  ds_read_b64_tr_b16 a[206:207], v9 offset:3200
  ds_read_b128 a[224:227], v10 offset:1536
  ds_read_b64_tr_b16 a[208:209], v9 offset:4096
  ds_read_b64_tr_b16 a[210:211], v9 offset:4224
  ds_read_b128 a[228:231], v10 offset:2048
  v_add_u32 v10, 2560, v10
  s_add_u32 s33, s33, 552960
  s_sub_u32 s14, s14, 1
  s_cmp_lg_u32 s14, 0
  s_cbranch_scc1 fa_coG
  v_accvgpr_read_b32 v8, a248
  v_accvgpr_read_b32 v11, a249
  v_accvgpr_read_b32 v12, a250
  v_accvgpr_read_b32 v13, a251
  v_accvgpr_read_b32 v14, a252
  v_subrev_u32 v11, 1024, v11
  v_subrev_u32 v12, 2048, v12
  v_subrev_u32 v13, 3072, v13
  s_mov_b32 s52, s60
  s_mov_b32 s53, s61
  s_mov_b32 s33, s35
  s_lshl_b32 s23, s20, 9
  v_add_u32 v16, s23, v10
  v_subrev_u32 v9, 161792, v10
  v_and_b32 v17, 8, v1
  v_lshl_add_u32 v9, v17, 27, v9
  s_waitcnt lgkmcnt(0)
  v_mfma_f32_16x16x32_bf16 v[232:235], a[192:195], a[212:215], v[232:235]
  v_mfma_f32_16x16x32_bf16 v[232:235], a[196:199], a[216:219], v[232:235]
  v_mfma_f32_16x16x32_bf16 v[232:235], a[200:203], a[220:223], v[232:235]
  v_mfma_f32_16x16x32_bf16 v[232:235], a[204:207], a[224:227], v[232:235]
  v_mfma_f32_16x16x32_bf16 v[232:235], a[208:211], a[228:231], v[232:235]
  s_nop 7
  ds_write_b128 v16, v[232:235]
  s_getpc_b64 s[36:37]
  s_setpc_b64 s[38:39]
  ds_read_b128 v[236:239], v10 offset:0
  ds_read_b128 v[240:243], v10 offset:512
  ds_read_b128 v[244:247], v10 offset:1024
  ds_read_b128 v[248:251], v10 offset:1536
  s_waitcnt vmcnt(4)
  ds_read_b64_tr_b16 a[192:193], v6 offset:0
  ds_read_b64_tr_b16 a[194:195], v6 offset:2560
  ds_read_b64_tr_b16 a[196:197], v6 offset:32
  ds_read_b64_tr_b16 a[198:199], v6 offset:2592
  ds_read_b64_tr_b16 a[200:201], v6 offset:64
  ds_read_b64_tr_b16 a[202:203], v6 offset:2624
  ds_read_b64_tr_b16 a[204:205], v6 offset:96
  ds_read_b64_tr_b16 a[206:207], v6 offset:2656
  ds_read_b64_tr_b16 a[208:209], v6 offset:128
  ds_read_b64_tr_b16 a[210:211], v6 offset:2688
  s_add_u32 s33, s33, 160
  s_mov_b32 s8, 0
  s_waitcnt lgkmcnt(10)
  v_cvt_pk_bf16_f32 v236, v236, v244
  v_cvt_pk_bf16_f32 v237, v237, v245
  v_cvt_pk_bf16_f32 v238, v238, v246
  v_cvt_pk_bf16_f32 v239, v239, v247
  v_cvt_pk_bf16_f32 v240, v240, v248
  v_cvt_pk_bf16_f32 v241, v241, v249
  v_cvt_pk_bf16_f32 v242, v242, v250
  v_cvt_pk_bf16_f32 v243, v243, v251
  v_lshlrev_b32 v244, 16, v236
  v_lshlrev_b32 v245, 16, v237
  v_lshlrev_b32 v246, 16, v238
  v_lshlrev_b32 v247, 16, v239
  v_lshlrev_b32 v248, 16, v240
  v_lshlrev_b32 v249, 16, v241
  v_lshlrev_b32 v250, 16, v242
  v_lshlrev_b32 v251, 16, v243
  v_mul_f32 v16, 0xbfb8aa3b, v244
  v_mul_f32 v17, 0xbfb8aa3b, v245
  v_mul_f32 v18, 0xbfb8aa3b, v246
  v_mul_f32 v19, 0xbfb8aa3b, v247
  v_mul_f32 v20, 0xbfb8aa3b, v248
  v_mul_f32 v21, 0xbfb8aa3b, v249
  v_mul_f32 v22, 0xbfb8aa3b, v250
  v_mul_f32 v23, 0xbfb8aa3b, v251
  v_exp_f32 v16, v16
  v_exp_f32 v17, v17
  v_exp_f32 v18, v18
  v_exp_f32 v19, v19
  v_exp_f32 v20, v20
  v_exp_f32 v21, v21
  v_exp_f32 v22, v22
  v_exp_f32 v23, v23
  v_add_f32 v16, 1.0, v16
  v_add_f32 v17, 1.0, v17
  v_add_f32 v18, 1.0, v18
  v_add_f32 v19, 1.0, v19
  v_add_f32 v20, 1.0, v20
  v_add_f32 v21, 1.0, v21
  v_add_f32 v22, 1.0, v22
  v_add_f32 v23, 1.0, v23
  v_rcp_f32 v16, v16
  v_rcp_f32 v17, v17
  v_rcp_f32 v18, v18
  v_rcp_f32 v19, v19
  v_rcp_f32 v20, v20
  v_rcp_f32 v21, v21
  v_rcp_f32 v22, v22
  v_rcp_f32 v23, v23
  v_and_b32 v236, 0xffff0000, v236
  v_and_b32 v237, 0xffff0000, v237
  v_and_b32 v238, 0xffff0000, v238
  v_and_b32 v239, 0xffff0000, v239
  v_and_b32 v240, 0xffff0000, v240
  v_and_b32 v241, 0xffff0000, v241
  v_and_b32 v242, 0xffff0000, v242
  v_and_b32 v243, 0xffff0000, v243
  v_pk_mul_f32 v[244:245], v[244:245], v[16:17]
  v_pk_mul_f32 v[246:247], v[246:247], v[18:19]
  v_pk_mul_f32 v[248:249], v[248:249], v[20:21]
  v_pk_mul_f32 v[250:251], v[250:251], v[22:23]
  v_cvt_pk_bf16_f32 v16, v244, v245
  v_cvt_pk_bf16_f32 v17, v246, v247
  v_cvt_pk_bf16_f32 v18, v248, v249
  v_cvt_pk_bf16_f32 v19, v250, v251
  v_lshlrev_b32 v244, 16, v16
  v_and_b32 v245, 0xffff0000, v16
  v_lshlrev_b32 v246, 16, v17
  v_and_b32 v247, 0xffff0000, v17
  v_lshlrev_b32 v248, 16, v18
  v_and_b32 v249, 0xffff0000, v18
  v_lshlrev_b32 v250, 16, v19
  v_and_b32 v251, 0xffff0000, v19
  v_pk_mul_f32 v[236:237], v[236:237], v[244:245]
  v_pk_mul_f32 v[238:239], v[238:239], v[246:247]
  v_pk_mul_f32 v[240:241], v[240:241], v[248:249]
  v_pk_mul_f32 v[242:243], v[242:243], v[250:251]
  v_cvt_pk_bf16_f32 v232, v236, v237
  v_cvt_pk_bf16_f32 v233, v238, v239
  v_cvt_pk_bf16_f32 v234, v240, v241
  v_cvt_pk_bf16_f32 v235, v242, v243
  s_nop 0
  s_waitcnt lgkmcnt(0)
  v_mfma_f32_16x16x32_bf16 v[236:239], a[192:195], v[232:235], 0
  v_mfma_f32_16x16x32_bf16 v[240:243], a[196:199], v[232:235], 0
  v_mfma_f32_16x16x32_bf16 v[244:247], a[200:203], v[232:235], 0
  v_mfma_f32_16x16x32_bf16 v[248:251], a[204:207], v[232:235], 0
  v_mfma_f32_16x16x32_bf16 v[252:255], a[208:211], v[232:235], 0
  s_nop 3
  buffer_store_dwordx4 v[236:239], v9, s[40:43], s10 offen offset:0 sc1
  buffer_store_dwordx4 v[240:243], v9, s[40:43], s10 offen offset:512 sc1
  buffer_store_dwordx4 v[244:247], v9, s[40:43], s10 offen offset:1024 sc1
  buffer_store_dwordx4 v[248:251], v9, s[40:43], s10 offen offset:1536 sc1
  buffer_store_dwordx4 v[252:255], v9, s[40:43], s10 offen offset:2048 sc1
  s_add_u32 s10, s10, 2560
  s_getpc_b64 s[36:37]
  s_setpc_b64 s[38:39]
  s_waitcnt vmcnt(4)
  ds_read_b64_tr_b16 a[192:193], v6 offset:0
  ds_read_b64_tr_b16 a[194:195], v6 offset:2560
  ds_read_b64_tr_b16 a[196:197], v6 offset:32
  ds_read_b64_tr_b16 a[198:199], v6 offset:2592
  ds_read_b64_tr_b16 a[200:201], v6 offset:64
  ds_read_b64_tr_b16 a[202:203], v6 offset:2624
  ds_read_b64_tr_b16 a[204:205], v6 offset:96
  ds_read_b64_tr_b16 a[206:207], v6 offset:2656
  ds_read_b64_tr_b16 a[208:209], v6 offset:128
  ds_read_b64_tr_b16 a[210:211], v6 offset:2688
  s_waitcnt lgkmcnt(0)
  v_mfma_f32_16x16x32_bf16 v[236:239], a[192:195], v[232:235], 0
  v_mfma_f32_16x16x32_bf16 v[240:243], a[196:199], v[232:235], 0
  v_mfma_f32_16x16x32_bf16 v[244:247], a[200:203], v[232:235], 0
  v_mfma_f32_16x16x32_bf16 v[248:251], a[204:207], v[232:235], 0
  v_mfma_f32_16x16x32_bf16 v[252:255], a[208:211], v[232:235], 0
  s_nop 3
  buffer_store_dwordx4 v[236:239], v9, s[40:43], s10 offen offset:0 sc1
  buffer_store_dwordx4 v[240:243], v9, s[40:43], s10 offen offset:512 sc1
  buffer_store_dwordx4 v[244:247], v9, s[40:43], s10 offen offset:1024 sc1
  buffer_store_dwordx4 v[248:251], v9, s[40:43], s10 offen offset:1536 sc1
  buffer_store_dwordx4 v[252:255], v9, s[40:43], s10 offen offset:2048 sc1
  s_add_u32 s10, s10, 2560
  s_getpc_b64 s[36:37]
  s_setpc_b64 s[38:39]
  s_sub_u32 s23, s2, 170
  s_lshl_b32 s31, s20, 6
  s_add_u32 s23, s23, s31
  s_lshl_b32 s23, s23, 2
  s_add_u32 s23, s23, 2650112
  s_waitcnt vmcnt(8)
  buffer_store_dword v4, off, s[40:43], s23 sc1
fa_coW:
  s_mov_b32 s12, 1
  s_mov_b32 s9, -1
  s_cmp_lg_u32 s11, 0
  s_cselect_b32 s32, s15, -1
  s_getpc_b64 s[36:37]
  s_setpc_b64 s[38:39]
  s_lshl_b32 s23, s22, 2
  s_add_u32 s23, s23, s20
  s_mul_i32 s13, s23, 163840
  s_add_u32 s13, s13, 4194304
  s_lshl_b32 s23, s23, 7
  s_add_u32 s23, s23, 2654208
  v_and_b32 v9, 31, v1
  v_lshl_add_u32 v9, v9, 2, s23
  v_and_b32 v10, 15, v1
  v_lshlrev_b32 v10, 2, v10
  v_add_u32 v10, 2629632, v10
  buffer_load_dword v8, v9, s[40:43], 0 offen sc1
  buffer_load_dword v15, v10, s[40:43], 0 offen sc1
  v_mov_b32 v20, v228
  v_mov_b32 v21, v229
  s_nop 1
  v_permlane16_swap_b32 v228, v20
  v_permlane16_swap_b32 v229, v21
  v_add_f32 v228, v228, v20
  v_add_f32 v229, v229, v21
  v_mov_b32 v20, v228
  v_mov_b32 v21, v229
  s_nop 1
  v_permlane32_swap_b32 v228, v20
  v_permlane32_swap_b32 v229, v21
  v_add_f32 v228, v228, v20
  v_add_f32 v229, v229, v21
  v_rcp_f32 v16, v228
  v_rcp_f32 v18, v229
  s_lshl_b32 s23, s22, 2
  v_mov_b32 v17, v16
  v_mov_b32 v19, v18
  s_add_u32 s23, s23, s20
  s_lshl_b32 s23, s23, 18
  s_lshl_b32 s31, s21, 12
  s_add_u32 s31, s31, 50331648
  s_add_u32 s64, s23, s31
  s_add_u32 s65, s64, 131072
  v_accvgpr_read_b32 v36, a0
  v_accvgpr_read_b32 v37, a1
  v_accvgpr_read_b32 v38, a2
  v_accvgpr_read_b32 v39, a3
  v_accvgpr_read_b32 v40, a8
  v_accvgpr_read_b32 v41, a9
  v_accvgpr_read_b32 v42, a10
  v_accvgpr_read_b32 v43, a11
  v_pk_mul_f32 v[36:37], v[36:37], v[16:17]
  v_pk_mul_f32 v[38:39], v[38:39], v[16:17]
  v_pk_mul_f32 v[40:41], v[40:41], v[16:17]
  v_pk_mul_f32 v[42:43], v[42:43], v[16:17]
  v_cvt_pk_bf16_f32 v32, v36, v37
  v_cvt_pk_bf16_f32 v33, v38, v39
  v_cvt_pk_bf16_f32 v34, v40, v41
  v_cvt_pk_bf16_f32 v35, v42, v43
  buffer_store_dwordx4 v[32:35], v2, s[40:43], s64 offen offset:0 sc1
  v_accvgpr_read_b32 v48, a16
  v_accvgpr_read_b32 v49, a17
  v_accvgpr_read_b32 v50, a18
  v_accvgpr_read_b32 v51, a19
  v_accvgpr_read_b32 v52, a24
  v_accvgpr_read_b32 v53, a25
  v_accvgpr_read_b32 v54, a26
  v_accvgpr_read_b32 v55, a27
  v_pk_mul_f32 v[48:49], v[48:49], v[16:17]
  v_pk_mul_f32 v[50:51], v[50:51], v[16:17]
  v_pk_mul_f32 v[52:53], v[52:53], v[16:17]
  v_pk_mul_f32 v[54:55], v[54:55], v[16:17]
  v_cvt_pk_bf16_f32 v44, v48, v49
  v_cvt_pk_bf16_f32 v45, v50, v51
  v_cvt_pk_bf16_f32 v46, v52, v53
  v_cvt_pk_bf16_f32 v47, v54, v55
  buffer_store_dwordx4 v[44:47], v2, s[40:43], s64 offen offset:1024 sc1
  v_accvgpr_read_b32 v100, a32
  v_accvgpr_read_b32 v101, a33
  v_accvgpr_read_b32 v102, a34
  v_accvgpr_read_b32 v103, a35
  v_accvgpr_read_b32 v104, a40
  v_accvgpr_read_b32 v105, a41
  v_accvgpr_read_b32 v106, a42
  v_accvgpr_read_b32 v107, a43
  v_pk_mul_f32 v[100:101], v[100:101], v[16:17]
  v_pk_mul_f32 v[102:103], v[102:103], v[16:17]
  v_pk_mul_f32 v[104:105], v[104:105], v[16:17]
  v_pk_mul_f32 v[106:107], v[106:107], v[16:17]
  v_cvt_pk_bf16_f32 v96, v100, v101
  v_cvt_pk_bf16_f32 v97, v102, v103
  v_cvt_pk_bf16_f32 v98, v104, v105
  v_cvt_pk_bf16_f32 v99, v106, v107
  buffer_store_dwordx4 v[96:99], v2, s[40:43], s64 offen offset:2048 sc1
  v_accvgpr_read_b32 v112, a48
  v_accvgpr_read_b32 v113, a49
  v_accvgpr_read_b32 v114, a50
  v_accvgpr_read_b32 v115, a51
  v_accvgpr_read_b32 v116, a56
  v_accvgpr_read_b32 v117, a57
  v_accvgpr_read_b32 v118, a58
  v_accvgpr_read_b32 v119, a59
  v_pk_mul_f32 v[112:113], v[112:113], v[16:17]
  v_pk_mul_f32 v[114:115], v[114:115], v[16:17]
  v_pk_mul_f32 v[116:117], v[116:117], v[16:17]
  v_pk_mul_f32 v[118:119], v[118:119], v[16:17]
  v_cvt_pk_bf16_f32 v108, v112, v113
  v_cvt_pk_bf16_f32 v109, v114, v115
  v_cvt_pk_bf16_f32 v110, v116, v117
  v_cvt_pk_bf16_f32 v111, v118, v119
  buffer_store_dwordx4 v[108:111], v2, s[40:43], s64 offen offset:3072 sc1
  v_accvgpr_read_b32 v36, a4
  v_accvgpr_read_b32 v37, a5
  v_accvgpr_read_b32 v38, a6
  v_accvgpr_read_b32 v39, a7
  v_accvgpr_read_b32 v40, a12
  v_accvgpr_read_b32 v41, a13
  v_accvgpr_read_b32 v42, a14
  v_accvgpr_read_b32 v43, a15
  v_pk_mul_f32 v[36:37], v[36:37], v[18:19]
  v_pk_mul_f32 v[38:39], v[38:39], v[18:19]
  v_pk_mul_f32 v[40:41], v[40:41], v[18:19]
  v_pk_mul_f32 v[42:43], v[42:43], v[18:19]
  v_cvt_pk_bf16_f32 v32, v36, v37
  v_cvt_pk_bf16_f32 v33, v38, v39
  v_cvt_pk_bf16_f32 v34, v40, v41
  v_cvt_pk_bf16_f32 v35, v42, v43
  buffer_store_dwordx4 v[32:35], v2, s[40:43], s65 offen offset:0 sc1
  v_accvgpr_read_b32 v48, a20
  v_accvgpr_read_b32 v49, a21
  v_accvgpr_read_b32 v50, a22
  v_accvgpr_read_b32 v51, a23
  v_accvgpr_read_b32 v52, a28
  v_accvgpr_read_b32 v53, a29
  v_accvgpr_read_b32 v54, a30
  v_accvgpr_read_b32 v55, a31
  v_pk_mul_f32 v[48:49], v[48:49], v[18:19]
  v_pk_mul_f32 v[50:51], v[50:51], v[18:19]
  v_pk_mul_f32 v[52:53], v[52:53], v[18:19]
  v_pk_mul_f32 v[54:55], v[54:55], v[18:19]
  v_cvt_pk_bf16_f32 v44, v48, v49
  v_cvt_pk_bf16_f32 v45, v50, v51
  v_cvt_pk_bf16_f32 v46, v52, v53
  v_cvt_pk_bf16_f32 v47, v54, v55
  buffer_store_dwordx4 v[44:47], v2, s[40:43], s65 offen offset:1024 sc1
  v_accvgpr_read_b32 v100, a36
  v_accvgpr_read_b32 v101, a37
  v_accvgpr_read_b32 v102, a38
  v_accvgpr_read_b32 v103, a39
  v_accvgpr_read_b32 v104, a44
  v_accvgpr_read_b32 v105, a45
  v_accvgpr_read_b32 v106, a46
  v_accvgpr_read_b32 v107, a47
  v_pk_mul_f32 v[100:101], v[100:101], v[18:19]
  v_pk_mul_f32 v[102:103], v[102:103], v[18:19]
  v_pk_mul_f32 v[104:105], v[104:105], v[18:19]
  v_pk_mul_f32 v[106:107], v[106:107], v[18:19]
  v_cvt_pk_bf16_f32 v96, v100, v101
  v_cvt_pk_bf16_f32 v97, v102, v103
  v_cvt_pk_bf16_f32 v98, v104, v105
  v_cvt_pk_bf16_f32 v99, v106, v107
  buffer_store_dwordx4 v[96:99], v2, s[40:43], s65 offen offset:2048 sc1
  v_accvgpr_read_b32 v112, a52
  v_accvgpr_read_b32 v113, a53
  v_accvgpr_read_b32 v114, a54
  v_accvgpr_read_b32 v115, a55
  v_accvgpr_read_b32 v116, a60
  v_accvgpr_read_b32 v117, a61
  v_accvgpr_read_b32 v118, a62
  v_accvgpr_read_b32 v119, a63
  v_pk_mul_f32 v[112:113], v[112:113], v[18:19]
  v_pk_mul_f32 v[114:115], v[114:115], v[18:19]
  v_pk_mul_f32 v[116:117], v[116:117], v[18:19]
  v_pk_mul_f32 v[118:119], v[118:119], v[18:19]
  v_cvt_pk_bf16_f32 v108, v112, v113
  v_cvt_pk_bf16_f32 v109, v114, v115
  v_cvt_pk_bf16_f32 v110, v116, v117
  v_cvt_pk_bf16_f32 v111, v118, v119
  buffer_store_dwordx4 v[108:111], v2, s[40:43], s65 offen offset:3072 sc1
  s_waitcnt vmcnt(8)
  v_cmp_eq_u32 vcc, 0, v8
  s_cbranch_vccnz fa_wof_spin
fa_wof_ok:
  v_cmp_eq_u32 vcc, 0, v15
  s_cbranch_vccnz fa_sel4_spin
fa_sel4_ok:
  s_lshl_b32 s23, s20, 1
  s_add_u32 s31, s23, 1
  v_readlane_b32 s33, v15, s23
  v_readlane_b32 s35, v15, s31
  s_lshl_b32 s31, s21, 6
  s_add_u32 s31, s31, 1
  s_sub_u32 s33, s33, s31
  s_sub_u32 s35, s35, s31
  s_cmp_lt_u32 s33, 64
  s_cselect_b32 s10, 1, 0
  s_cmp_lt_u32 s35, 64
  s_cselect_b32 s31, 2, 0
  s_or_b32 s10, s10, s31
  s_cbranch_scc0 fa_coEnd
  v_min_u32 v11, 53, v1
  s_lshr_b32 s23, s22, 1
  s_lshl_b32 s23, s23, 8
  s_add_u32 s23, s23, 2650112
  v_lshl_add_u32 v11, v11, 2, s23
  buffer_load_dword v14, v11, s[40:43], 0 offen sc1
  v_mul_u32_u24 v16, 3277, v1
  v_lshrrev_b32 v16, 16, v16
  v_mul_u32_u24 v8, 20, v16
  v_sub_u32 v8, v1, v8
  v_lshlrev_b32 v8, 4, v8
  v_mul_u32_u24 v9, 368640, v16
  v_lshl_add_u32 v9, v8, 3, v9
  v_cmp_gt_u32 vcc, 3, v16
  v_mov_b32 v19, 1073741824
  s_nop 0
  v_cndmask_b32 v9, v19, v9, vcc
  s_mov_b32 s12, 2
  s_mov_b32 s32, -1
  s_mov_b32 s11, 0
  s_getpc_b64 s[36:37]
  s_setpc_b64 s[38:39]
  v_cmp_eq_u32 vcc, 0, v14
  s_cbranch_vccnz fa_yf_spin
fa_yf_ok:
fa_coY:
  s_ff1_i32_b32 s33, s10
  s_bitset0_b32 s10, s33
  s_lshl_b32 s23, s20, 1
  s_add_u32 s33, s33, s23
  s_lshl_b32 s14, s33, 4
  s_mul_i32 s23, s22, 2560
  s_add_u32 s14, s14, s23
  s_add_u32 s14, s14, 2686976
  buffer_load_dwordx4 v[64:67], v9, s[40:43], s14 offen sc1
  s_add_u32 s14, s14, 20480
  buffer_load_dwordx4 v[68:71], v9, s[40:43], s14 offen sc1
  s_add_u32 s14, s14, 20480
  buffer_load_dwordx4 v[72:75], v9, s[40:43], s14 offen sc1
  s_add_u32 s14, s14, 20480
  buffer_load_dwordx4 v[76:79], v9, s[40:43], s14 offen sc1
  s_add_u32 s14, s14, 20480
  buffer_load_dwordx4 v[80:83], v9, s[40:43], s14 offen sc1
  s_add_u32 s14, s14, 20480
  buffer_load_dwordx4 v[84:87], v9, s[40:43], s14 offen sc1
  s_add_u32 s14, s14, 20480
  buffer_load_dwordx4 v[88:91], v9, s[40:43], s14 offen sc1
  s_add_u32 s14, s14, 20480
  buffer_load_dwordx4 v[92:95], v9, s[40:43], s14 offen sc1
  s_add_u32 s14, s14, 20480
  buffer_load_dwordx4 v[128:131], v9, s[40:43], s14 offen sc1
  s_add_u32 s14, s14, 20480
  buffer_load_dwordx4 v[132:135], v9, s[40:43], s14 offen sc1
  s_add_u32 s14, s14, 20480
  buffer_load_dwordx4 v[136:139], v9, s[40:43], s14 offen sc1
  s_add_u32 s14, s14, 20480
  buffer_load_dwordx4 v[140:143], v9, s[40:43], s14 offen sc1
  s_add_u32 s14, s14, 20480
  buffer_load_dwordx4 v[144:147], v9, s[40:43], s14 offen sc1
  s_add_u32 s14, s14, 20480
  buffer_load_dwordx4 v[148:151], v9, s[40:43], s14 offen sc1
  s_add_u32 s14, s14, 20480
  buffer_load_dwordx4 v[152:155], v9, s[40:43], s14 offen sc1
  s_add_u32 s14, s14, 20480
  buffer_load_dwordx4 v[156:159], v9, s[40:43], s14 offen sc1
  s_add_u32 s14, s14, 20480
  buffer_load_dwordx4 v[176:179], v9, s[40:43], s14 offen sc1
  s_add_u32 s14, s14, 20480
  buffer_load_dwordx4 v[180:183], v9, s[40:43], s14 offen sc1
  s_add_u32 s14, s14, 20480
  s_cmp_eq_u32 s11, 0
  s_cbranch_scc1 fa_coY1
  s_waitcnt vmcnt(0)
  s_branch fa_coY2
fa_coY1:
  s_mov_b32 s11, 1
  s_getpc_b64 s[36:37]
  s_setpc_b64 s[38:39]
fa_coY2:
  s_lshl_b32 s14, s20, 10
  s_add_u32 s14, s14, 159744
  v_add_u32 v19, s14, v2
  s_add_u32 s23, s33, 8
  v_readlane_b32 s35, v15, s23
  s_waitcnt vmcnt(1)
  v_pk_add_f32 v[64:65], v[64:65], v[68:69]
  v_pk_add_f32 v[66:67], v[66:67], v[70:71]
  v_pk_add_f32 v[64:65], v[64:65], v[72:73]
  v_pk_add_f32 v[66:67], v[66:67], v[74:75]
  v_pk_add_f32 v[64:65], v[64:65], v[76:77]
  v_pk_add_f32 v[66:67], v[66:67], v[78:79]
  v_pk_add_f32 v[64:65], v[64:65], v[80:81]
  v_pk_add_f32 v[66:67], v[66:67], v[82:83]
  v_pk_add_f32 v[64:65], v[64:65], v[84:85]
  v_pk_add_f32 v[66:67], v[66:67], v[86:87]
  v_pk_add_f32 v[64:65], v[64:65], v[88:89]
  v_pk_add_f32 v[66:67], v[66:67], v[90:91]
  v_pk_add_f32 v[64:65], v[64:65], v[92:93]
  v_pk_add_f32 v[66:67], v[66:67], v[94:95]
  v_pk_add_f32 v[64:65], v[64:65], v[128:129]
  v_pk_add_f32 v[66:67], v[66:67], v[130:131]
  v_pk_add_f32 v[64:65], v[64:65], v[132:133]
  v_pk_add_f32 v[66:67], v[66:67], v[134:135]
  v_pk_add_f32 v[64:65], v[64:65], v[136:137]
  v_pk_add_f32 v[66:67], v[66:67], v[138:139]
  v_pk_add_f32 v[64:65], v[64:65], v[140:141]
  v_pk_add_f32 v[66:67], v[66:67], v[142:143]
  v_pk_add_f32 v[64:65], v[64:65], v[144:145]
  v_pk_add_f32 v[66:67], v[66:67], v[146:147]
  v_pk_add_f32 v[64:65], v[64:65], v[148:149]
  v_pk_add_f32 v[66:67], v[66:67], v[150:151]
  v_pk_add_f32 v[64:65], v[64:65], v[152:153]
  v_pk_add_f32 v[66:67], v[66:67], v[154:155]
  v_pk_add_f32 v[64:65], v[64:65], v[156:157]
  v_pk_add_f32 v[66:67], v[66:67], v[158:159]
  v_pk_add_f32 v[64:65], v[64:65], v[176:177]
  v_pk_add_f32 v[66:67], v[66:67], v[178:179]
  v_pk_add_f32 v[64:65], v[64:65], v[180:181]
  v_pk_add_f32 v[66:67], v[66:67], v[182:183]
  ds_write_b128 v19, v[64:67]
  v_add_u32 v19, s14, v8
  s_and_b32 s35, s35, 0xffff0000
  s_waitcnt lgkmcnt(0)
  ds_read_b128 v[64:67], v19
  ds_read_b128 v[68:71], v19 offset:320
  ds_read_b128 v[72:75], v19 offset:640
  s_mul_i32 s14, s33, 320
  s_add_u32 s14, s14, 155648
  v_add_u32 v19, s14, v8
  s_waitcnt lgkmcnt(0)
  v_add_f32 v64, v64, v68
  v_add_f32 v64, v64, v72
  v_cvt_pk_bf16_f32 v64, v64, v64
  v_and_b32 v64, 0xffff0000, v64
  v_mul_f32 v64, s35, v64
  v_cvt_pk_bf16_f32 v64, v64, v64
  v_and_b32 v64, 0xffff0000, v64
  v_add_f32 v65, v65, v69
  v_add_f32 v65, v65, v73
  v_cvt_pk_bf16_f32 v65, v65, v65
  v_and_b32 v65, 0xffff0000, v65
  v_mul_f32 v65, s35, v65
  v_cvt_pk_bf16_f32 v65, v65, v65
  v_and_b32 v65, 0xffff0000, v65
  v_add_f32 v66, v66, v70
  v_add_f32 v66, v66, v74
  v_cvt_pk_bf16_f32 v66, v66, v66
  v_and_b32 v66, 0xffff0000, v66
  v_mul_f32 v66, s35, v66
  v_cvt_pk_bf16_f32 v66, v66, v66
  v_and_b32 v66, 0xffff0000, v66
  v_add_f32 v67, v67, v71
  v_add_f32 v67, v67, v75
  v_cvt_pk_bf16_f32 v67, v67, v67
  v_and_b32 v67, 0xffff0000, v67
  v_mul_f32 v67, s35, v67
  v_cvt_pk_bf16_f32 v67, v67, v67
  v_and_b32 v67, 0xffff0000, v67
  ds_write_b128 v19, v[64:67]
  s_waitcnt lgkmcnt(0)
  s_cmp_lg_u32 s10, 0
  s_cbranch_scc1 fa_coY
fa_coEnd:
  s_mov_b32 s12, 3
  s_mov_b32 s32, -1
  s_setpc_b64 s[38:39]
fa_hk7:
  s_getpc_b64 s[38:39]
fa_hp7:
  s_add_u32 s36, s36, 4
  s_addc_u32 s37, s37, 0
  s_sub_u32 s38, s38, fa_hp7-fa_hb7
  s_subb_u32 s39, s39, 0
  s_setpc_b64 s[36:37]
fa_hk8:
  s_getpc_b64 s[38:39]
fa_hp8:
  s_add_u32 s36, s36, 4
  s_addc_u32 s37, s37, 0
  s_sub_u32 s38, s38, fa_hp8-fa_hb8
  s_subb_u32 s39, s39, 0
  s_setpc_b64 s[36:37]
fa_disp:
  s_cmp_eq_u32 s29, 7
  s_cbranch_scc1 fa_SSW7
  s_cmp_eq_u32 s29, 6
  s_cbranch_scc1 fa_SSW6
  s_cmp_eq_u32 s29, 5
  s_cbranch_scc1 fa_SSW5
  s_cmp_eq_u32 s29, 4
  s_cbranch_scc1 fa_SSW4
  s_cmp_eq_u32 s29, 3
  s_cbranch_scc1 fa_SSW3
  s_cmp_eq_u32 s29, 2
  s_cbranch_scc1 fa_SSW2
  s_cmp_eq_u32 s29, 1
  s_cbranch_scc1 fa_SSW1
  s_branch fa_Bexit
fa_hk9:
  s_getpc_b64 s[38:39]
fa_hp9:
  s_add_u32 s36, s36, 4
  s_addc_u32 s37, s37, 0
  s_sub_u32 s38, s38, fa_hp9-fa_hb9
  s_subb_u32 s39, s39, 0
  s_setpc_b64 s[36:37]
fa_hk10:
  s_getpc_b64 s[38:39]
fa_hp10:
  s_add_u32 s36, s36, 4
  s_addc_u32 s37, s37, 0
  s_sub_u32 s38, s38, fa_hp10-fa_hb10
  s_subb_u32 s39, s39, 0
  s_setpc_b64 s[36:37]
fa_left:
  s_add_u32 s14, s13, 0
  buffer_load_dwordx4 a[0:3], v2, s[40:43], s14 offen offset:0 sc1
  buffer_load_dwordx4 a[4:7], v2, s[40:43], s14 offen offset:1024 sc1
  buffer_load_dwordx4 a[8:11], v2, s[40:43], s14 offen offset:2048 sc1
  buffer_load_dwordx4 a[12:15], v2, s[40:43], s14 offen offset:3072 sc1
  s_add_u32 s14, s13, 4096
  buffer_load_dwordx4 a[16:19], v2, s[40:43], s14 offen offset:0 sc1
  buffer_load_dwordx4 a[20:23], v2, s[40:43], s14 offen offset:1024 sc1
  s_cmp_ge_u32 s29, 7
  s_cbranch_scc1 fa_leftb
  s_add_u32 s14, s13, 4096
  buffer_load_dwordx4 a[24:27], v2, s[40:43], s14 offen offset:2048 sc1
  buffer_load_dwordx4 a[28:31], v2, s[40:43], s14 offen offset:3072 sc1
  s_add_u32 s14, s13, 8192
  buffer_load_dwordx4 a[32:35], v2, s[40:43], s14 offen offset:0 sc1
  buffer_load_dwordx4 a[36:39], v2, s[40:43], s14 offen offset:1024 sc1
  buffer_load_dwordx4 a[40:43], v2, s[40:43], s14 offen offset:2048 sc1
  buffer_load_dwordx4 a[44:47], v2, s[40:43], s14 offen offset:3072 sc1
  s_cmp_ge_u32 s29, 6
  s_cbranch_scc1 fa_leftb
  s_add_u32 s14, s13, 12288
  buffer_load_dwordx4 a[48:51], v2, s[40:43], s14 offen offset:0 sc1
  buffer_load_dwordx4 a[52:55], v2, s[40:43], s14 offen offset:1024 sc1
  buffer_load_dwordx4 a[56:59], v2, s[40:43], s14 offen offset:2048 sc1
  buffer_load_dwordx4 a[60:63], v2, s[40:43], s14 offen offset:3072 sc1
  s_add_u32 s14, s13, 16384
  buffer_load_dwordx4 a[192:195], v2, s[40:43], s14 offen offset:0 sc1
  buffer_load_dwordx4 a[196:199], v2, s[40:43], s14 offen offset:1024 sc1
  s_cmp_ge_u32 s29, 5
  s_cbranch_scc1 fa_leftb
  s_add_u32 s14, s13, 16384
  buffer_load_dwordx4 a[200:203], v2, s[40:43], s14 offen offset:2048 sc1
  buffer_load_dwordx4 a[204:207], v2, s[40:43], s14 offen offset:3072 sc1
  s_add_u32 s14, s13, 20480
  buffer_load_dwordx4 a[208:211], v2, s[40:43], s14 offen offset:0 sc1
  buffer_load_dwordx4 a[212:215], v2, s[40:43], s14 offen offset:1024 sc1
  buffer_load_dwordx4 a[216:219], v2, s[40:43], s14 offen offset:2048 sc1
  buffer_load_dwordx4 a[220:223], v2, s[40:43], s14 offen offset:3072 sc1
  s_cmp_ge_u32 s29, 4
  s_cbranch_scc1 fa_leftb
  s_add_u32 s14, s13, 24576
  buffer_load_dwordx4 a[224:227], v2, s[40:43], s14 offen offset:0 sc1
  buffer_load_dwordx4 a[228:231], v2, s[40:43], s14 offen offset:1024 sc1
  buffer_load_dwordx4 a[232:235], v2, s[40:43], s14 offen offset:2048 sc1
  buffer_load_dwordx4 a[236:239], v2, s[40:43], s14 offen offset:3072 sc1
  s_add_u32 s14, s13, 28672
  buffer_load_dwordx4 a[240:243], v2, s[40:43], s14 offen offset:0 sc1
  buffer_load_dwordx4 a[244:247], v2, s[40:43], s14 offen offset:1024 sc1
  s_cmp_ge_u32 s29, 3
  s_cbranch_scc1 fa_leftb
  s_add_u32 s14, s13, 28672
  buffer_load_dwordx4 a[248:251], v2, s[40:43], s14 offen offset:2048 sc1
  buffer_load_dwordx4 a[252:255], v2, s[40:43], s14 offen offset:3072 sc1
  s_add_u32 s14, s13, 32768
  buffer_load_dwordx4 v[32:35], v2, s[40:43], s14 offen offset:0 sc1
  buffer_load_dwordx4 v[36:39], v2, s[40:43], s14 offen offset:1024 sc1
  buffer_load_dwordx4 v[40:43], v2, s[40:43], s14 offen offset:2048 sc1
  buffer_load_dwordx4 v[44:47], v2, s[40:43], s14 offen offset:3072 sc1
  s_cmp_ge_u32 s29, 2
  s_cbranch_scc1 fa_leftb
  s_add_u32 s14, s13, 36864
  buffer_load_dwordx4 v[48:51], v2, s[40:43], s14 offen offset:0 sc1
  buffer_load_dwordx4 v[52:55], v2, s[40:43], s14 offen offset:1024 sc1
  buffer_load_dwordx4 v[56:59], v2, s[40:43], s14 offen offset:2048 sc1
  buffer_load_dwordx4 v[60:63], v2, s[40:43], s14 offen offset:3072 sc1
  s_add_u32 s14, s13, 40960
  buffer_load_dwordx4 v[96:99], v2, s[40:43], s14 offen offset:0 sc1
  buffer_load_dwordx4 v[100:103], v2, s[40:43], s14 offen offset:1024 sc1
  s_cmp_ge_u32 s29, 1
  s_cbranch_scc1 fa_leftb
  s_add_u32 s14, s13, 40960
  buffer_load_dwordx4 v[104:107], v2, s[40:43], s14 offen offset:2048 sc1
  buffer_load_dwordx4 v[108:111], v2, s[40:43], s14 offen offset:3072 sc1
  s_add_u32 s14, s13, 45056
  buffer_load_dwordx4 v[112:115], v2, s[40:43], s14 offen offset:0 sc1
  buffer_load_dwordx4 v[116:119], v2, s[40:43], s14 offen offset:1024 sc1
  buffer_load_dwordx4 v[120:123], v2, s[40:43], s14 offen offset:2048 sc1
  buffer_load_dwordx4 v[124:127], v2, s[40:43], s14 offen offset:3072 sc1
  s_branch fa_leftb
fa_ctx_spin:
  s_mov_b32 s83, 200000
fa_ctx_spin2:
  buffer_load_dword v13, v12, s[40:43], 0 offen sc1
  s_waitcnt vmcnt(0)
  v_cmp_eq_u32 vcc, 0, v13
  s_cbranch_vccz fa_ctx_ok
  s_sleep 8
  s_sub_u32 s83, s83, 1
  s_cmp_lg_u32 s83, 0
  s_cbranch_scc1 fa_ctx_spin2
  s_branch fa_ctx_ok
fa_stub0:
  s_call_b64 s[76:77], fa_rare00
  s_call_b64 s[76:77], fa_rare10
  s_branch fa_back0
fa_stub1:
  s_call_b64 s[76:77], fa_rare01
  s_call_b64 s[76:77], fa_rare11
  s_branch fa_back1
fa_stub2:
  s_call_b64 s[76:77], fa_rare00
  s_call_b64 s[76:77], fa_rare10
  s_branch fa_back2
fa_stub3:
  s_call_b64 s[76:77], fa_rare01
  s_call_b64 s[76:77], fa_rare11
  s_branch fa_back3
fa_stub4:
  s_call_b64 s[76:77], fa_rare01
  s_call_b64 s[76:77], fa_rare11
  s_branch fa_back4
fa_stub5:
  s_call_b64 s[76:77], fa_rare00
  s_call_b64 s[76:77], fa_rare10
  s_branch fa_back5
fa_stub6:
  s_call_b64 s[76:77], fa_rare11
  s_branch fa_back6
fa_stub7:
  s_call_b64 s[76:77], fa_rare10
  s_branch fa_back7
fa_stub8:
  s_call_b64 s[76:77], fa_rare01
  s_call_b64 s[76:77], fa_rare11
  s_branch fa_back8
fa_stub9:
  s_call_b64 s[76:77], fa_rare10
  s_branch fa_back9
fa_stub10:
  s_call_b64 s[76:77], fa_rare11
  s_branch fa_back10
fa_stub11:
  s_call_b64 s[76:77], fa_rare10
  s_branch fa_back11
fa_stub12:
  s_call_b64 s[76:77], fa_rare11
  s_branch fa_back12
fa_stub13:
  s_call_b64 s[76:77], fa_rare10
  s_branch fa_back13
fa_stub14:
  s_call_b64 s[76:77], fa_rare11
  s_branch fa_back14
fa_stub15:
  s_call_b64 s[76:77], fa_rare10
  s_branch fa_back15
fa_stub16:
  s_call_b64 s[76:77], fa_rare11
  s_branch fa_back16
fa_stub17:
  s_call_b64 s[76:77], fa_rare10
  s_branch fa_back17
fa_stub18:
  s_call_b64 s[76:77], fa_rare11
  s_branch fa_back18
fa_stub19:
  s_call_b64 s[76:77], fa_rare10
  s_branch fa_back19
fa_stub20:
  s_call_b64 s[76:77], fa_rare11
  s_branch fa_back20
fa_stub21:
  s_call_b64 s[76:77], fa_rare10
  s_branch fa_back21
fa_stub22:
  s_call_b64 s[76:77], fa_rare11
  s_branch fa_back22
fa_stub23:
  s_call_b64 s[76:77], fa_rare10
  s_branch fa_back23
fa_stub24:
  s_call_b64 s[76:77], fa_rare11
  s_branch fa_back24
fa_stub25:
  s_call_b64 s[76:77], fa_rare10
  s_branch fa_back25
fa_stub26:
  s_call_b64 s[76:77], fa_rare11
  s_branch fa_back26
fa_stub27:
  s_call_b64 s[76:77], fa_rare10
  s_branch fa_back27
fa_stub28:
  s_call_b64 s[76:77], fa_rare11
  s_branch fa_back28
fa_stub29:
  s_call_b64 s[76:77], fa_rare10
  s_branch fa_back29
fa_stub30:
  s_call_b64 s[76:77], fa_rare11
  s_branch fa_back30
fa_codeend:
fa_rare00:
  s_nop 7
  v_max3_f32 v16, v96, v97, v98
  v_max3_f32 v16, v16, v99, v100
  v_max3_f32 v16, v16, v101, v102
  v_max3_f32 v16, v16, v103, 0
  v_mov_b32 v18, v16
  s_nop 1
  v_permlane16_swap_b32 v16, v18
  v_max_f32 v16, v16, v18
  v_mov_b32 v18, v16
  s_nop 1
  v_permlane32_swap_b32 v16, v18
  v_max_f32 v16, v16, v18
  v_sub_f32 v96, v96, v16
  v_sub_f32 v112, v112, v16
  v_sub_f32 v97, v97, v16
  v_sub_f32 v113, v113, v16
  v_sub_f32 v98, v98, v16
  v_sub_f32 v114, v114, v16
  v_sub_f32 v99, v99, v16
  v_sub_f32 v115, v115, v16
  v_sub_f32 v100, v100, v16
  v_sub_f32 v116, v116, v16
  v_sub_f32 v101, v101, v16
  v_sub_f32 v117, v117, v16
  v_sub_f32 v102, v102, v16
  v_sub_f32 v118, v118, v16
  v_sub_f32 v103, v103, v16
  v_sub_f32 v119, v119, v16
  v_max3_f32 v17, v104, v105, v106
  v_max3_f32 v17, v17, v107, v108
  v_max3_f32 v17, v17, v109, v110
  v_max3_f32 v17, v17, v111, 0
  v_mov_b32 v18, v17
  s_nop 1
  v_permlane16_swap_b32 v17, v18
  v_max_f32 v17, v17, v18
  v_mov_b32 v18, v17
  s_nop 1
  v_permlane32_swap_b32 v17, v18
  v_max_f32 v17, v17, v18
  v_sub_f32 v104, v104, v17
  v_sub_f32 v120, v120, v17
  v_sub_f32 v105, v105, v17
  v_sub_f32 v121, v121, v17
  v_sub_f32 v106, v106, v17
  v_sub_f32 v122, v122, v17
  v_sub_f32 v107, v107, v17
  v_sub_f32 v123, v123, v17
  v_sub_f32 v108, v108, v17
  v_sub_f32 v124, v124, v17
  v_sub_f32 v109, v109, v17
  v_sub_f32 v125, v125, v17
  v_sub_f32 v110, v110, v17
  v_sub_f32 v126, v126, v17
  v_sub_f32 v111, v111, v17
  v_sub_f32 v127, v127, v17
  s_call_b64 s[78:79], fa_resc0
  v_exp_f32 v208, v96
  v_exp_f32 v209, v97
  v_exp_f32 v210, v98
  v_add_f32 v224, v208, v209
  v_cvt_pk_bf16_f32 v160, v208, v209
  v_exp_f32 v211, v99
  v_add_f32 v224, v224, v210
  v_exp_f32 v212, v100
  v_add_f32 v224, v224, v211
  v_cvt_pk_bf16_f32 v161, v210, v211
  v_exp_f32 v213, v101
  v_add_f32 v224, v224, v212
  v_exp_f32 v214, v102
  v_add_f32 v224, v224, v213
  v_cvt_pk_bf16_f32 v162, v212, v213
  v_exp_f32 v215, v103
  v_add_f32 v224, v224, v214
  v_exp_f32 v208, v104
  v_add_f32 v224, v224, v215
  v_cvt_pk_bf16_f32 v163, v214, v215
  v_exp_f32 v209, v105
  v_exp_f32 v210, v106
  v_add_f32 v225, v208, v209
  v_cvt_pk_bf16_f32 v164, v208, v209
  v_exp_f32 v211, v107
  v_add_f32 v225, v225, v210
  v_exp_f32 v212, v108
  v_add_f32 v225, v225, v211
  v_cvt_pk_bf16_f32 v165, v210, v211
  v_exp_f32 v213, v109
  v_add_f32 v225, v225, v212
  v_exp_f32 v214, v110
  v_add_f32 v225, v225, v213
  v_cvt_pk_bf16_f32 v166, v212, v213
  v_exp_f32 v215, v111
  v_add_f32 v225, v225, v214
  s_nop 0
  v_add_f32 v225, v225, v215
  v_cvt_pk_bf16_f32 v167, v214, v215
  s_nop 1
  s_setpc_b64 s[76:77]
fa_rare01:
  s_nop 7
  v_max3_f32 v16, v112, v113, v114
  v_max3_f32 v16, v16, v115, v116
  v_max3_f32 v16, v16, v117, v118
  v_max3_f32 v16, v16, v119, 0
  v_mov_b32 v18, v16
  s_nop 1
  v_permlane16_swap_b32 v16, v18
  v_max_f32 v16, v16, v18
  v_mov_b32 v18, v16
  s_nop 1
  v_permlane32_swap_b32 v16, v18
  v_max_f32 v16, v16, v18
  v_sub_f32 v112, v112, v16
  v_sub_f32 v96, v96, v16
  v_sub_f32 v113, v113, v16
  v_sub_f32 v97, v97, v16
  v_sub_f32 v114, v114, v16
  v_sub_f32 v98, v98, v16
  v_sub_f32 v115, v115, v16
  v_sub_f32 v99, v99, v16
  v_sub_f32 v116, v116, v16
  v_sub_f32 v100, v100, v16
  v_sub_f32 v117, v117, v16
  v_sub_f32 v101, v101, v16
  v_sub_f32 v118, v118, v16
  v_sub_f32 v102, v102, v16
  v_sub_f32 v119, v119, v16
  v_sub_f32 v103, v103, v16
  v_max3_f32 v17, v120, v121, v122
  v_max3_f32 v17, v17, v123, v124
  v_max3_f32 v17, v17, v125, v126
  v_max3_f32 v17, v17, v127, 0
  v_mov_b32 v18, v17
  s_nop 1
  v_permlane16_swap_b32 v17, v18
  v_max_f32 v17, v17, v18
  v_mov_b32 v18, v17
  s_nop 1
  v_permlane32_swap_b32 v17, v18
  v_max_f32 v17, v17, v18
  v_sub_f32 v120, v120, v17
  v_sub_f32 v104, v104, v17
  v_sub_f32 v121, v121, v17
  v_sub_f32 v105, v105, v17
  v_sub_f32 v122, v122, v17
  v_sub_f32 v106, v106, v17
  v_sub_f32 v123, v123, v17
  v_sub_f32 v107, v107, v17
  v_sub_f32 v124, v124, v17
  v_sub_f32 v108, v108, v17
  v_sub_f32 v125, v125, v17
  v_sub_f32 v109, v109, v17
  v_sub_f32 v126, v126, v17
  v_sub_f32 v110, v110, v17
  v_sub_f32 v127, v127, v17
  v_sub_f32 v111, v111, v17
  s_call_b64 s[78:79], fa_resc0
  v_exp_f32 v208, v112
  v_exp_f32 v209, v113
  v_exp_f32 v210, v114
  v_add_f32 v224, v208, v209
  v_cvt_pk_bf16_f32 v168, v208, v209
  v_exp_f32 v211, v115
  v_add_f32 v224, v224, v210
  v_exp_f32 v212, v116
  v_add_f32 v224, v224, v211
  v_cvt_pk_bf16_f32 v169, v210, v211
  v_exp_f32 v213, v117
  v_add_f32 v224, v224, v212
  v_exp_f32 v214, v118
  v_add_f32 v224, v224, v213
  v_cvt_pk_bf16_f32 v170, v212, v213
  v_exp_f32 v215, v119
  v_add_f32 v224, v224, v214
  v_exp_f32 v208, v120
  v_add_f32 v224, v224, v215
  v_cvt_pk_bf16_f32 v171, v214, v215
  v_exp_f32 v209, v121
  v_exp_f32 v210, v122
  v_add_f32 v225, v208, v209
  v_cvt_pk_bf16_f32 v172, v208, v209
  v_exp_f32 v211, v123
  v_add_f32 v225, v225, v210
  v_exp_f32 v212, v124
  v_add_f32 v225, v225, v211
  v_cvt_pk_bf16_f32 v173, v210, v211
  v_exp_f32 v213, v125
  v_add_f32 v225, v225, v212
  v_exp_f32 v214, v126
  v_add_f32 v225, v225, v213
  v_cvt_pk_bf16_f32 v174, v212, v213
  v_exp_f32 v215, v127
  v_add_f32 v225, v225, v214
  s_nop 0
  v_add_f32 v225, v225, v215
  v_cvt_pk_bf16_f32 v175, v214, v215
  s_nop 1
  s_setpc_b64 s[76:77]
fa_resc0:
  v_sub_f32 v192, v192, v16
  v_sub_f32 v193, v193, v16
  v_sub_f32 v194, v194, v16
  v_sub_f32 v195, v195, v16
  v_exp_f32 v18, -v16
  v_sub_f32 v196, v196, v17
  v_sub_f32 v197, v197, v17
  v_sub_f32 v198, v198, v17
  v_sub_f32 v199, v199, v17
  v_exp_f32 v19, -v17
  s_nop 0
  v_mul_f32 v228, v228, v18
  v_mul_f32 v229, v229, v19
  v_accvgpr_read_b32 v20, a0
  v_accvgpr_read_b32 v21, a1
  v_accvgpr_read_b32 v22, a2
  v_accvgpr_read_b32 v23, a3
  v_mul_f32 v20, v20, v18
  v_mul_f32 v21, v21, v18
  v_mul_f32 v22, v22, v18
  v_mul_f32 v23, v23, v18
  v_accvgpr_write_b32 a0, v20
  v_accvgpr_write_b32 a1, v21
  v_accvgpr_write_b32 a2, v22
  v_accvgpr_write_b32 a3, v23
  v_accvgpr_read_b32 v20, a4
  v_accvgpr_read_b32 v21, a5
  v_accvgpr_read_b32 v22, a6
  v_accvgpr_read_b32 v23, a7
  v_mul_f32 v20, v20, v19
  v_mul_f32 v21, v21, v19
  v_mul_f32 v22, v22, v19
  v_mul_f32 v23, v23, v19
  v_accvgpr_write_b32 a4, v20
  v_accvgpr_write_b32 a5, v21
  v_accvgpr_write_b32 a6, v22
  v_accvgpr_write_b32 a7, v23
  v_accvgpr_read_b32 v20, a8
  v_accvgpr_read_b32 v21, a9
  v_accvgpr_read_b32 v22, a10
  v_accvgpr_read_b32 v23, a11
  v_mul_f32 v20, v20, v18
  v_mul_f32 v21, v21, v18
  v_mul_f32 v22, v22, v18
  v_mul_f32 v23, v23, v18
  v_accvgpr_write_b32 a8, v20
  v_accvgpr_write_b32 a9, v21
  v_accvgpr_write_b32 a10, v22
  v_accvgpr_write_b32 a11, v23
  v_accvgpr_read_b32 v20, a12
  v_accvgpr_read_b32 v21, a13
  v_accvgpr_read_b32 v22, a14
  v_accvgpr_read_b32 v23, a15
  v_mul_f32 v20, v20, v19
  v_mul_f32 v21, v21, v19
  v_mul_f32 v22, v22, v19
  v_mul_f32 v23, v23, v19
  v_accvgpr_write_b32 a12, v20
  v_accvgpr_write_b32 a13, v21
  v_accvgpr_write_b32 a14, v22
  v_accvgpr_write_b32 a15, v23
  v_accvgpr_read_b32 v20, a16
  v_accvgpr_read_b32 v21, a17
  v_accvgpr_read_b32 v22, a18
  v_accvgpr_read_b32 v23, a19
  v_mul_f32 v20, v20, v18
  v_mul_f32 v21, v21, v18
  v_mul_f32 v22, v22, v18
  v_mul_f32 v23, v23, v18
  v_accvgpr_write_b32 a16, v20
  v_accvgpr_write_b32 a17, v21
  v_accvgpr_write_b32 a18, v22
  v_accvgpr_write_b32 a19, v23
  v_accvgpr_read_b32 v20, a20
  v_accvgpr_read_b32 v21, a21
  v_accvgpr_read_b32 v22, a22
  v_accvgpr_read_b32 v23, a23
  v_mul_f32 v20, v20, v19
  v_mul_f32 v21, v21, v19
  v_mul_f32 v22, v22, v19
  v_mul_f32 v23, v23, v19
  v_accvgpr_write_b32 a20, v20
  v_accvgpr_write_b32 a21, v21
  v_accvgpr_write_b32 a22, v22
  v_accvgpr_write_b32 a23, v23
  v_accvgpr_read_b32 v20, a24
  v_accvgpr_read_b32 v21, a25
  v_accvgpr_read_b32 v22, a26
  v_accvgpr_read_b32 v23, a27
  v_mul_f32 v20, v20, v18
  v_mul_f32 v21, v21, v18
  v_mul_f32 v22, v22, v18
  v_mul_f32 v23, v23, v18
  v_accvgpr_write_b32 a24, v20
  v_accvgpr_write_b32 a25, v21
  v_accvgpr_write_b32 a26, v22
  v_accvgpr_write_b32 a27, v23
  v_accvgpr_read_b32 v20, a28
  v_accvgpr_read_b32 v21, a29
  v_accvgpr_read_b32 v22, a30
  v_accvgpr_read_b32 v23, a31
  v_mul_f32 v20, v20, v19
  v_mul_f32 v21, v21, v19
  v_mul_f32 v22, v22, v19
  v_mul_f32 v23, v23, v19
  v_accvgpr_write_b32 a28, v20
  v_accvgpr_write_b32 a29, v21
  v_accvgpr_write_b32 a30, v22
  v_accvgpr_write_b32 a31, v23
  v_accvgpr_read_b32 v20, a32
  v_accvgpr_read_b32 v21, a33
  v_accvgpr_read_b32 v22, a34
  v_accvgpr_read_b32 v23, a35
  v_mul_f32 v20, v20, v18
  v_mul_f32 v21, v21, v18
  v_mul_f32 v22, v22, v18
  v_mul_f32 v23, v23, v18
  v_accvgpr_write_b32 a32, v20
  v_accvgpr_write_b32 a33, v21
  v_accvgpr_write_b32 a34, v22
  v_accvgpr_write_b32 a35, v23
  v_accvgpr_read_b32 v20, a36
  v_accvgpr_read_b32 v21, a37
  v_accvgpr_read_b32 v22, a38
  v_accvgpr_read_b32 v23, a39
  v_mul_f32 v20, v20, v19
  v_mul_f32 v21, v21, v19
  v_mul_f32 v22, v22, v19
  v_mul_f32 v23, v23, v19
  v_accvgpr_write_b32 a36, v20
  v_accvgpr_write_b32 a37, v21
  v_accvgpr_write_b32 a38, v22
  v_accvgpr_write_b32 a39, v23
  v_accvgpr_read_b32 v20, a40
  v_accvgpr_read_b32 v21, a41
  v_accvgpr_read_b32 v22, a42
  v_accvgpr_read_b32 v23, a43
  v_mul_f32 v20, v20, v18
  v_mul_f32 v21, v21, v18
  v_mul_f32 v22, v22, v18
  v_mul_f32 v23, v23, v18
  v_accvgpr_write_b32 a40, v20
  v_accvgpr_write_b32 a41, v21
  v_accvgpr_write_b32 a42, v22
  v_accvgpr_write_b32 a43, v23
  v_accvgpr_read_b32 v20, a44
  v_accvgpr_read_b32 v21, a45
  v_accvgpr_read_b32 v22, a46
  v_accvgpr_read_b32 v23, a47
  v_mul_f32 v20, v20, v19
  v_mul_f32 v21, v21, v19
  v_mul_f32 v22, v22, v19
  v_mul_f32 v23, v23, v19
  v_accvgpr_write_b32 a44, v20
  v_accvgpr_write_b32 a45, v21
  v_accvgpr_write_b32 a46, v22
  v_accvgpr_write_b32 a47, v23
  v_accvgpr_read_b32 v20, a48
  v_accvgpr_read_b32 v21, a49
  v_accvgpr_read_b32 v22, a50
  v_accvgpr_read_b32 v23, a51
  v_mul_f32 v20, v20, v18
  v_mul_f32 v21, v21, v18
  v_mul_f32 v22, v22, v18
  v_mul_f32 v23, v23, v18
  v_accvgpr_write_b32 a48, v20
  v_accvgpr_write_b32 a49, v21
  v_accvgpr_write_b32 a50, v22
  v_accvgpr_write_b32 a51, v23
  v_accvgpr_read_b32 v20, a52
  v_accvgpr_read_b32 v21, a53
  v_accvgpr_read_b32 v22, a54
  v_accvgpr_read_b32 v23, a55
  v_mul_f32 v20, v20, v19
  v_mul_f32 v21, v21, v19
  v_mul_f32 v22, v22, v19
  v_mul_f32 v23, v23, v19
  v_accvgpr_write_b32 a52, v20
  v_accvgpr_write_b32 a53, v21
  v_accvgpr_write_b32 a54, v22
  v_accvgpr_write_b32 a55, v23
  v_accvgpr_read_b32 v20, a56
  v_accvgpr_read_b32 v21, a57
  v_accvgpr_read_b32 v22, a58
  v_accvgpr_read_b32 v23, a59
  v_mul_f32 v20, v20, v18
  v_mul_f32 v21, v21, v18
  v_mul_f32 v22, v22, v18
  v_mul_f32 v23, v23, v18
  v_accvgpr_write_b32 a56, v20
  v_accvgpr_write_b32 a57, v21
  v_accvgpr_write_b32 a58, v22
  v_accvgpr_write_b32 a59, v23
  v_accvgpr_read_b32 v20, a60
  v_accvgpr_read_b32 v21, a61
  v_accvgpr_read_b32 v22, a62
  v_accvgpr_read_b32 v23, a63
  v_mul_f32 v20, v20, v19
  v_mul_f32 v21, v21, v19
  v_mul_f32 v22, v22, v19
  v_mul_f32 v23, v23, v19
  v_accvgpr_write_b32 a60, v20
  v_accvgpr_write_b32 a61, v21
  v_accvgpr_write_b32 a62, v22
  v_accvgpr_write_b32 a63, v23
  s_setpc_b64 s[78:79]
fa_rare10:
  s_nop 7
  v_max3_f32 v16, v128, v129, v130
  v_max3_f32 v16, v16, v131, v132
  v_max3_f32 v16, v16, v133, v134
  v_max3_f32 v16, v16, v135, 0
  v_mov_b32 v18, v16
  s_nop 1
  v_permlane16_swap_b32 v16, v18
  v_max_f32 v16, v16, v18
  v_mov_b32 v18, v16
  s_nop 1
  v_permlane32_swap_b32 v16, v18
  v_max_f32 v16, v16, v18
  v_sub_f32 v128, v128, v16
  v_sub_f32 v144, v144, v16
  v_sub_f32 v129, v129, v16
  v_sub_f32 v145, v145, v16
  v_sub_f32 v130, v130, v16
  v_sub_f32 v146, v146, v16
  v_sub_f32 v131, v131, v16
  v_sub_f32 v147, v147, v16
  v_sub_f32 v132, v132, v16
  v_sub_f32 v148, v148, v16
  v_sub_f32 v133, v133, v16
  v_sub_f32 v149, v149, v16
  v_sub_f32 v134, v134, v16
  v_sub_f32 v150, v150, v16
  v_sub_f32 v135, v135, v16
  v_sub_f32 v151, v151, v16
  v_max3_f32 v17, v136, v137, v138
  v_max3_f32 v17, v17, v139, v140
  v_max3_f32 v17, v17, v141, v142
  v_max3_f32 v17, v17, v143, 0
  v_mov_b32 v18, v17
  s_nop 1
  v_permlane16_swap_b32 v17, v18
  v_max_f32 v17, v17, v18
  v_mov_b32 v18, v17
  s_nop 1
  v_permlane32_swap_b32 v17, v18
  v_max_f32 v17, v17, v18
  v_sub_f32 v136, v136, v17
  v_sub_f32 v152, v152, v17
  v_sub_f32 v137, v137, v17
  v_sub_f32 v153, v153, v17
  v_sub_f32 v138, v138, v17
  v_sub_f32 v154, v154, v17
  v_sub_f32 v139, v139, v17
  v_sub_f32 v155, v155, v17
  v_sub_f32 v140, v140, v17
  v_sub_f32 v156, v156, v17
  v_sub_f32 v141, v141, v17
  v_sub_f32 v157, v157, v17
  v_sub_f32 v142, v142, v17
  v_sub_f32 v158, v158, v17
  v_sub_f32 v143, v143, v17
  v_sub_f32 v159, v159, v17
  s_call_b64 s[78:79], fa_resc1
  v_exp_f32 v216, v128
  v_exp_f32 v217, v129
  v_exp_f32 v218, v130
  v_add_f32 v226, v216, v217
  v_cvt_pk_bf16_f32 v176, v216, v217
  v_exp_f32 v219, v131
  v_add_f32 v226, v226, v218
  v_exp_f32 v220, v132
  v_add_f32 v226, v226, v219
  v_cvt_pk_bf16_f32 v177, v218, v219
  v_exp_f32 v221, v133
  v_add_f32 v226, v226, v220
  v_exp_f32 v222, v134
  v_add_f32 v226, v226, v221
  v_cvt_pk_bf16_f32 v178, v220, v221
  v_exp_f32 v223, v135
  v_add_f32 v226, v226, v222
  v_exp_f32 v216, v136
  v_add_f32 v226, v226, v223
  v_cvt_pk_bf16_f32 v179, v222, v223
  v_exp_f32 v217, v137
  v_exp_f32 v218, v138
  v_add_f32 v227, v216, v217
  v_cvt_pk_bf16_f32 v180, v216, v217
  v_exp_f32 v219, v139
  v_add_f32 v227, v227, v218
  v_exp_f32 v220, v140
  v_add_f32 v227, v227, v219
  v_cvt_pk_bf16_f32 v181, v218, v219
  v_exp_f32 v221, v141
  v_add_f32 v227, v227, v220
  v_exp_f32 v222, v142
  v_add_f32 v227, v227, v221
  v_cvt_pk_bf16_f32 v182, v220, v221
  v_exp_f32 v223, v143
  v_add_f32 v227, v227, v222
  s_nop 0
  v_add_f32 v227, v227, v223
  v_cvt_pk_bf16_f32 v183, v222, v223
  v_exp_f32 v216, v144
  s_nop 1
  s_setpc_b64 s[76:77]
fa_rare11:
  s_nop 7
  v_max3_f32 v16, v144, v145, v146
  v_max3_f32 v16, v16, v147, v148
  v_max3_f32 v16, v16, v149, v150
  v_max3_f32 v16, v16, v151, 0
  v_mov_b32 v18, v16
  s_nop 1
  v_permlane16_swap_b32 v16, v18
  v_max_f32 v16, v16, v18
  v_mov_b32 v18, v16
  s_nop 1
  v_permlane32_swap_b32 v16, v18
  v_max_f32 v16, v16, v18
  v_sub_f32 v144, v144, v16
  v_sub_f32 v128, v128, v16
  v_sub_f32 v145, v145, v16
  v_sub_f32 v129, v129, v16
  v_sub_f32 v146, v146, v16
  v_sub_f32 v130, v130, v16
  v_sub_f32 v147, v147, v16
  v_sub_f32 v131, v131, v16
  v_sub_f32 v148, v148, v16
  v_sub_f32 v132, v132, v16
  v_sub_f32 v149, v149, v16
  v_sub_f32 v133, v133, v16
  v_sub_f32 v150, v150, v16
  v_sub_f32 v134, v134, v16
  v_sub_f32 v151, v151, v16
  v_sub_f32 v135, v135, v16
  v_max3_f32 v17, v152, v153, v154
  v_max3_f32 v17, v17, v155, v156
  v_max3_f32 v17, v17, v157, v158
  v_max3_f32 v17, v17, v159, 0
  v_mov_b32 v18, v17
  s_nop 1
  v_permlane16_swap_b32 v17, v18
  v_max_f32 v17, v17, v18
  v_mov_b32 v18, v17
  s_nop 1
  v_permlane32_swap_b32 v17, v18
  v_max_f32 v17, v17, v18
  v_sub_f32 v152, v152, v17
  v_sub_f32 v136, v136, v17
  v_sub_f32 v153, v153, v17
  v_sub_f32 v137, v137, v17
  v_sub_f32 v154, v154, v17
  v_sub_f32 v138, v138, v17
  v_sub_f32 v155, v155, v17
  v_sub_f32 v139, v139, v17
  v_sub_f32 v156, v156, v17
  v_sub_f32 v140, v140, v17
  v_sub_f32 v157, v157, v17
  v_sub_f32 v141, v141, v17
  v_sub_f32 v158, v158, v17
  v_sub_f32 v142, v142, v17
  v_sub_f32 v159, v159, v17
  v_sub_f32 v143, v143, v17
  s_call_b64 s[78:79], fa_resc1
  v_exp_f32 v216, v144
  v_exp_f32 v217, v145
  v_exp_f32 v218, v146
  v_add_f32 v226, v216, v217
  v_cvt_pk_bf16_f32 v184, v216, v217
  v_exp_f32 v219, v147
  v_add_f32 v226, v226, v218
  v_exp_f32 v220, v148
  v_add_f32 v226, v226, v219
  v_cvt_pk_bf16_f32 v185, v218, v219
  v_exp_f32 v221, v149
  v_add_f32 v226, v226, v220
  v_exp_f32 v222, v150
  v_add_f32 v226, v226, v221
  v_cvt_pk_bf16_f32 v186, v220, v221
  v_exp_f32 v223, v151
  v_add_f32 v226, v226, v222
  v_exp_f32 v216, v152
  v_add_f32 v226, v226, v223
  v_cvt_pk_bf16_f32 v187, v222, v223
  v_exp_f32 v217, v153
  v_exp_f32 v218, v154
  v_add_f32 v227, v216, v217
  v_cvt_pk_bf16_f32 v188, v216, v217
  v_exp_f32 v219, v155
  v_add_f32 v227, v227, v218
  v_exp_f32 v220, v156
  v_add_f32 v227, v227, v219
  v_cvt_pk_bf16_f32 v189, v218, v219
  v_exp_f32 v221, v157
  v_add_f32 v227, v227, v220
  v_exp_f32 v222, v158
  v_add_f32 v227, v227, v221
  v_cvt_pk_bf16_f32 v190, v220, v221
  v_exp_f32 v223, v159
  v_add_f32 v227, v227, v222
  s_nop 0
  v_add_f32 v227, v227, v223
  v_cvt_pk_bf16_f32 v191, v222, v223
  v_exp_f32 v216, v128
  s_nop 1
  s_setpc_b64 s[76:77]
fa_resc1:
  v_sub_f32 v200, v200, v16
  v_sub_f32 v201, v201, v16
  v_sub_f32 v202, v202, v16
  v_sub_f32 v203, v203, v16
  v_exp_f32 v18, -v16
  v_sub_f32 v204, v204, v17
  v_sub_f32 v205, v205, v17
  v_sub_f32 v206, v206, v17
  v_sub_f32 v207, v207, v17
  v_exp_f32 v19, -v17
  s_nop 0
  v_mul_f32 v230, v230, v18
  v_mul_f32 v231, v231, v19
  v_accvgpr_read_b32 v20, a64
  v_accvgpr_read_b32 v21, a65
  v_accvgpr_read_b32 v22, a66
  v_accvgpr_read_b32 v23, a67
  v_mul_f32 v20, v20, v18
  v_mul_f32 v21, v21, v18
  v_mul_f32 v22, v22, v18
  v_mul_f32 v23, v23, v18
  v_accvgpr_write_b32 a64, v20
  v_accvgpr_write_b32 a65, v21
  v_accvgpr_write_b32 a66, v22
  v_accvgpr_write_b32 a67, v23
  v_accvgpr_read_b32 v20, a68
  v_accvgpr_read_b32 v21, a69
  v_accvgpr_read_b32 v22, a70
  v_accvgpr_read_b32 v23, a71
  v_mul_f32 v20, v20, v19
  v_mul_f32 v21, v21, v19
  v_mul_f32 v22, v22, v19
  v_mul_f32 v23, v23, v19
  v_accvgpr_write_b32 a68, v20
  v_accvgpr_write_b32 a69, v21
  v_accvgpr_write_b32 a70, v22
  v_accvgpr_write_b32 a71, v23
  v_accvgpr_read_b32 v20, a72
  v_accvgpr_read_b32 v21, a73
  v_accvgpr_read_b32 v22, a74
  v_accvgpr_read_b32 v23, a75
  v_mul_f32 v20, v20, v18
  v_mul_f32 v21, v21, v18
  v_mul_f32 v22, v22, v18
  v_mul_f32 v23, v23, v18
  v_accvgpr_write_b32 a72, v20
  v_accvgpr_write_b32 a73, v21
  v_accvgpr_write_b32 a74, v22
  v_accvgpr_write_b32 a75, v23
  v_accvgpr_read_b32 v20, a76
  v_accvgpr_read_b32 v21, a77
  v_accvgpr_read_b32 v22, a78
  v_accvgpr_read_b32 v23, a79
  v_mul_f32 v20, v20, v19
  v_mul_f32 v21, v21, v19
  v_mul_f32 v22, v22, v19
  v_mul_f32 v23, v23, v19
  v_accvgpr_write_b32 a76, v20
  v_accvgpr_write_b32 a77, v21
  v_accvgpr_write_b32 a78, v22
  v_accvgpr_write_b32 a79, v23
  v_accvgpr_read_b32 v20, a80
  v_accvgpr_read_b32 v21, a81
  v_accvgpr_read_b32 v22, a82
  v_accvgpr_read_b32 v23, a83
  v_mul_f32 v20, v20, v18
  v_mul_f32 v21, v21, v18
  v_mul_f32 v22, v22, v18
  v_mul_f32 v23, v23, v18
  v_accvgpr_write_b32 a80, v20
  v_accvgpr_write_b32 a81, v21
  v_accvgpr_write_b32 a82, v22
  v_accvgpr_write_b32 a83, v23
  v_accvgpr_read_b32 v20, a84
  v_accvgpr_read_b32 v21, a85
  v_accvgpr_read_b32 v22, a86
  v_accvgpr_read_b32 v23, a87
  v_mul_f32 v20, v20, v19
  v_mul_f32 v21, v21, v19
  v_mul_f32 v22, v22, v19
  v_mul_f32 v23, v23, v19
  v_accvgpr_write_b32 a84, v20
  v_accvgpr_write_b32 a85, v21
  v_accvgpr_write_b32 a86, v22
  v_accvgpr_write_b32 a87, v23
  v_accvgpr_read_b32 v20, a88
  v_accvgpr_read_b32 v21, a89
  v_accvgpr_read_b32 v22, a90
  v_accvgpr_read_b32 v23, a91
  v_mul_f32 v20, v20, v18
  v_mul_f32 v21, v21, v18
  v_mul_f32 v22, v22, v18
  v_mul_f32 v23, v23, v18
  v_accvgpr_write_b32 a88, v20
  v_accvgpr_write_b32 a89, v21
  v_accvgpr_write_b32 a90, v22
  v_accvgpr_write_b32 a91, v23
  v_accvgpr_read_b32 v20, a92
  v_accvgpr_read_b32 v21, a93
  v_accvgpr_read_b32 v22, a94
  v_accvgpr_read_b32 v23, a95
  v_mul_f32 v20, v20, v19
  v_mul_f32 v21, v21, v19
  v_mul_f32 v22, v22, v19
  v_mul_f32 v23, v23, v19
  v_accvgpr_write_b32 a92, v20
  v_accvgpr_write_b32 a93, v21
  v_accvgpr_write_b32 a94, v22
  v_accvgpr_write_b32 a95, v23
  v_accvgpr_read_b32 v20, a96
  v_accvgpr_read_b32 v21, a97
  v_accvgpr_read_b32 v22, a98
  v_accvgpr_read_b32 v23, a99
  v_mul_f32 v20, v20, v18
  v_mul_f32 v21, v21, v18
  v_mul_f32 v22, v22, v18
  v_mul_f32 v23, v23, v18
  v_accvgpr_write_b32 a96, v20
  v_accvgpr_write_b32 a97, v21
  v_accvgpr_write_b32 a98, v22
  v_accvgpr_write_b32 a99, v23
  v_accvgpr_read_b32 v20, a100
  v_accvgpr_read_b32 v21, a101
  v_accvgpr_read_b32 v22, a102
  v_accvgpr_read_b32 v23, a103
  v_mul_f32 v20, v20, v19
  v_mul_f32 v21, v21, v19
  v_mul_f32 v22, v22, v19
  v_mul_f32 v23, v23, v19
  v_accvgpr_write_b32 a100, v20
  v_accvgpr_write_b32 a101, v21
  v_accvgpr_write_b32 a102, v22
  v_accvgpr_write_b32 a103, v23
  v_accvgpr_read_b32 v20, a104
  v_accvgpr_read_b32 v21, a105
  v_accvgpr_read_b32 v22, a106
  v_accvgpr_read_b32 v23, a107
  v_mul_f32 v20, v20, v18
  v_mul_f32 v21, v21, v18
  v_mul_f32 v22, v22, v18
  v_mul_f32 v23, v23, v18
  v_accvgpr_write_b32 a104, v20
  v_accvgpr_write_b32 a105, v21
  v_accvgpr_write_b32 a106, v22
  v_accvgpr_write_b32 a107, v23
  v_accvgpr_read_b32 v20, a108
  v_accvgpr_read_b32 v21, a109
  v_accvgpr_read_b32 v22, a110
  v_accvgpr_read_b32 v23, a111
  v_mul_f32 v20, v20, v19
  v_mul_f32 v21, v21, v19
  v_mul_f32 v22, v22, v19
  v_mul_f32 v23, v23, v19
  v_accvgpr_write_b32 a108, v20
  v_accvgpr_write_b32 a109, v21
  v_accvgpr_write_b32 a110, v22
  v_accvgpr_write_b32 a111, v23
  v_accvgpr_read_b32 v20, a112
  v_accvgpr_read_b32 v21, a113
  v_accvgpr_read_b32 v22, a114
  v_accvgpr_read_b32 v23, a115
  v_mul_f32 v20, v20, v18
  v_mul_f32 v21, v21, v18
  v_mul_f32 v22, v22, v18
  v_mul_f32 v23, v23, v18
  v_accvgpr_write_b32 a112, v20
  v_accvgpr_write_b32 a113, v21
  v_accvgpr_write_b32 a114, v22
  v_accvgpr_write_b32 a115, v23
  v_accvgpr_read_b32 v20, a116
  v_accvgpr_read_b32 v21, a117
  v_accvgpr_read_b32 v22, a118
  v_accvgpr_read_b32 v23, a119
  v_mul_f32 v20, v20, v19
  v_mul_f32 v21, v21, v19
  v_mul_f32 v22, v22, v19
  v_mul_f32 v23, v23, v19
  v_accvgpr_write_b32 a116, v20
  v_accvgpr_write_b32 a117, v21
  v_accvgpr_write_b32 a118, v22
  v_accvgpr_write_b32 a119, v23
  v_accvgpr_read_b32 v20, a120
  v_accvgpr_read_b32 v21, a121
  v_accvgpr_read_b32 v22, a122
  v_accvgpr_read_b32 v23, a123
  v_mul_f32 v20, v20, v18
  v_mul_f32 v21, v21, v18
  v_mul_f32 v22, v22, v18
  v_mul_f32 v23, v23, v18
  v_accvgpr_write_b32 a120, v20
  v_accvgpr_write_b32 a121, v21
  v_accvgpr_write_b32 a122, v22
  v_accvgpr_write_b32 a123, v23
  v_accvgpr_read_b32 v20, a124
  v_accvgpr_read_b32 v21, a125
  v_accvgpr_read_b32 v22, a126
  v_accvgpr_read_b32 v23, a127
  v_mul_f32 v20, v20, v19
  v_mul_f32 v21, v21, v19
  v_mul_f32 v22, v22, v19
  v_mul_f32 v23, v23, v19
  v_accvgpr_write_b32 a124, v20
  v_accvgpr_write_b32 a125, v21
  v_accvgpr_write_b32 a126, v22
  v_accvgpr_write_b32 a127, v23
  s_setpc_b64 s[78:79]
.section .rodata,"a"
.p2align 6
.amdhsa_kernel fa_kernel
  .amdhsa_next_free_vgpr 512
  .amdhsa_next_free_sgpr 102
  .amdhsa_accum_offset 256
  .amdhsa_group_segment_fixed_size 0
  .amdhsa_kernarg_size 112
  .amdhsa_user_sgpr_count 2
  .amdhsa_user_sgpr_kernarg_segment_ptr 1
  .amdhsa_system_sgpr_workgroup_id_x 1
  .amdhsa_float_denorm_mode_32 3
.end_amdhsa_kernel
.text
```

```asm
; @launch kernel=fa_kernel grid=(256,1,1) block=(256,1,1) lds=163840
.amdgcn_target "amdgcn-amd-amdhsa--gfx950"
.text
.globl fa_kernel
.p2align 8
.type fa_kernel,@function
fa_kernel:
  s_cmp_ge_u32 s2, 256
  s_cbranch_scc1 fa_end
  s_getpc_b64 s[62:63]
  v_and_b32 v230, 127, v0
  v_lshlrev_b32 v230, 7, v230
  global_load_dword v231, v230, s[62:63]
  s_load_dwordx4 s[4:7], s[0:1], 0
  s_load_dwordx4 s[8:11], s[0:1], 24
  s_load_dwordx2 s[14:15], s[0:1], 56
  s_load_dwordx2 s[12:13], s[0:1], 40
  s_load_dwordx4 s[16:19], s[0:1], 96
  s_load_dwordx2 s[60:61], s[0:1], 16
  v_lshrrev_b32 v16, 6, v0
  v_and_b32 v1, 63, v0
  v_readfirstlane_b32 s20, v16
  s_and_b32 s21, s2, 7
  s_lshl_b32 s21, s21, 2
  s_lshr_b32 s23, s2, 3
  s_and_b32 s23, s23, 3
  s_add_u32 s21, s21, s23
  s_lshr_b32 s22, s2, 5
  v_and_b32 v208, 31, v1
  v_lshrrev_b32 v209, 5, v1
  s_lshl_b32 s31, s2, 2
  s_add_u32 s31, s31, s20
  s_lshl_b32 s31, s31, 1
  v_add_u32 v209, s31, v209
  v_lshlrev_b32 v212, 4, v208
  v_mul_u32_u24 v210, 1280, v209
  v_add_u32 v210, v210, v212
  v_cmp_gt_u32 s[64:65], 16, v208
  v_mov_b32 v19, 1073741824
  v_and_b32 v220, 7, v209
  v_cndmask_b32 v211, v19, v210, s[64:65]
  v_bfe_u32 v17, v1, 1, 3
  v_lshlrev_b32 v17, 13, v17
  v_and_b32 v18, 1, v1
  v_lshl_add_u32 v235, v18, 7, v17
  s_lshl_b32 s74, s22, 1
  s_and_b32 s31, s20, 1
  s_add_u32 s74, s74, s31
  s_lshl_b32 s74, s74, 16
  s_mov_b32 s73, 1048576
  v_and_b32 v16, 15, v1
  v_lshlrev_b32 v17, 10, v16
  v_and_b32 v18, 16, v1
  v_lshl_add_u32 v233, v18, 3, v17
  s_lshl_b32 s30, s23, 2
  s_add_u32 s30, s30, s20
  s_lshl_b32 s30, s30, 14
  s_lshl_b32 s29, s22, 18
  s_lshl_b32 s23, s21, 8
  s_cmp_ge_u32 s20, 2
  s_waitcnt lgkmcnt(0)
  s_mov_b32 s44, s4
  s_mov_b32 s45, s5
  s_mov_b32 s46, 2621440
  s_mov_b32 s47, 0x20000
  s_mov_b32 s68, s14
  s_mov_b32 s69, s15
  s_mov_b32 s70, 1280
  s_mov_b32 s71, 0x20000
  buffer_load_dwordx4 v[160:163], v210, s[44:47], 0 offen
  buffer_load_dwordx4 v[164:167], v210, s[44:47], 0 offen offset:512
  buffer_load_dwordx4 v[168:171], v211, s[44:47], 0 offen offset:1024
  buffer_load_dwordx4 v[172:175], v212, s[68:71], 0 offen offset:0
  buffer_load_dwordx4 v[176:179], v212, s[68:71], 0 offen offset:512
  buffer_load_dwordx4 v[180:183], v212, s[68:71], 0 offen offset:1024
  s_cselect_b32 s62, s10, s8
  s_cselect_b32 s63, s11, s9
  s_add_u32 s62, s62, s23
  s_addc_u32 s63, s63, 0
  s_mov_b32 s36, s62
  s_mov_b32 s37, s63
  s_mov_b32 s38, 0
  s_mov_b32 s39, 0x20000
  s_sub_u32 s38, 4194304, s23
  buffer_load_dword v231, v235, s[36:39], s74 offen
  s_add_u32 s6, s6, s29
  s_addc_u32 s7, s7, 0
  s_mov_b32 s32, s6
  s_mov_b32 s33, s7
  s_mov_b32 s34, 262144
  s_mov_b32 s35, 0x20000
  buffer_load_dword v232, v233, s[32:35], s30 offen
  s_add_u32 s74, s74, s73
  buffer_load_dword v231, v235, s[36:39], s74 offen
  buffer_load_dword v232, v233, s[32:35], s30 offen offset:256
  s_getpc_b64 s[8:9]
fa_pc:
  s_lshr_b32 s31, s2, 3
  s_and_b32 s31, s31, 15
  s_lshl_b32 s31, s31, 2
  s_add_u32 s31, s31, s20
  s_lshl_b32 s31, s31, 11
  s_min_u32 s31, s31, fa_codeend-fa_pc-2048
  v_lshlrev_b32 v234, 7, v16
  v_add_u32 v230, s31, v234
  global_load_dword v231, v230, s[8:9]
  s_add_u32 s8, s8, fa_co1-fa_pc-4
  s_addc_u32 s9, s9, 0
  s_add_u32 s60, s60, s23
  s_addc_u32 s61, s61, 0
  s_sub_u32 s75, 5242880, s23
  s_mov_b32 s48, s62
  s_mov_b32 s49, s63
  s_mov_b32 s50, s38
  s_mov_b32 s51, 0x20000
  v_lshlrev_b32 v2, 4, v1
  v_lshrrev_b32 v19, 2, v1
  v_lshrrev_b32 v17, 5, v1
  v_mul_u32_u24 v17, 3, v17
  v_and_b32 v18, 3, v1
  v_xor_b32 v17, v17, v18
  v_lshlrev_b32 v17, 4, v17
  v_lshl_add_u32 v3, v19, 10, v17
  s_lshl_b32 s23, s20, 16
  v_add_u32 v3, s23, v3
  v_add_u32 v4, 15360, v3
  v_add_u32 v5, 30720, v3
  v_add_u32 v6, 46080, v3
  v_and_b32 v19, 3, v19
  v_lshrrev_b32 v17, 4, v1
  v_lshlrev_b32 v17, 6, v17
  v_lshl_add_u32 v19, v19, 13, v17
  s_and_b32 s23, s20, 1
  s_lshl_b32 s23, s23, 17
  v_add_u32 v19, s23, v19
  v_lshl_add_u32 v8, v18, 4, v19
  v_xor_b32 v18, 2, v18
  v_lshl_add_u32 v10, v18, 4, v19
  v_add_u32 v9, 31744, v8
  v_add_u32 v11, 95232, v10
  v_add_u32 v10, 63488, v10
  s_lshl_b32 s24, s20, 12
  s_mov_b32 s26, 0
  s_mov_b32 s27, 0
  s_mov_b32 s25, 262144
  s_mov_b32 s79, 64
  s_mov_b32 s40, s18
  s_mov_b32 s41, s19
  s_mov_b32 s42, 67108864
  s_mov_b32 s43, 0x20000
  s_mov_b32 s52, s12
  s_mov_b32 s53, s13
  s_mov_b32 s54, 5242880
  s_mov_b32 s55, 0x20000
  s_mov_b32 s56, s16
  s_mov_b32 s57, s17
  s_mov_b32 s58, 256
  s_mov_b32 s59, 0x20000
  s_and_b32 s29, s2, 31
  s_lshl_b32 s29, s29, 2
  s_add_u32 s29, s29, s20
  s_lshl_b32 s29, s29, 11
  s_lshl_b32 s23, s20, 5
  s_add_u32 s23, s23, s21
  s_lshl_b32 s23, s23, 2
  s_add_u32 s23, s23, 2641920
  s_lshl_b32 s31, s22, 9
  s_add_u32 s80, s23, s31
  s_sub_u32 s31, 7680, s31
  s_add_u32 s3, s23, s31
  s_lshl_b32 s23, s21, 7
  s_lshl_b32 s31, s22, 2
  s_add_u32 s23, s23, s31
  s_add_u32 s82, s23, 2637824
  s_sub_u32 s62, s2, 170
  s_lshl_b32 s31, s20, 6
  s_add_u32 s62, s62, s31
  s_lshl_b32 s62, s62, 2
  s_add_u32 s62, s62, 2650112
  s_sub_u32 s23, s2, 170
  s_cmp_lt_u32 s23, 54
  s_cselect_b32 s62, s62, 1073741824
  s_cmp_eq_u32 s20, 0
  s_cselect_b32 s31, s82, 1073741824
  s_cselect_b32 s77, s2, 1073741824
  s_cmp_eq_u32 s2, 255
  s_cselect_b32 s23, 2629632, 1073741824
  v_lshl_add_u32 v225, v16, 2, s23
  v_mov_b32 v229, 0
  v_writelane_b32 v225, s80, 0
  v_writelane_b32 v225, s3, 1
  v_writelane_b32 v225, s31, 2
  s_and_b32 s23, s2, 1
  s_lshl_b32 s23, s23, 2
  s_add_u32 s23, s23, s20
  s_lshl_b32 s23, s23, 7
  s_lshr_b32 s31, s2, 1
  s_add_u32 s23, s23, s31
  s_lshl_b32 s23, s23, 2
  s_add_u32 s23, s23, 2654208
  v_writelane_b32 v225, s23, 3
  v_writelane_b32 v225, s62, 4
  s_and_b32 s23, s21, 3
  s_lshr_b32 s31, s23, 1
  s_lshl_b32 s31, 4, s31
  s_bitcmp1_b32 s23, 0
  s_cselect_b32 s76, s31, 0
  s_cselect_b32 s72, 0, s31
  s_or_b32 s76, s76, 0x20
  s_or_b32 s72, s72, 0x25
  v_mov_b32 v20, 0
  v_mov_b32 v21, 0
  v_mov_b32 v22, 0
  v_mov_b32 v23, 0
  v_lshrrev_b32 v17, 4, v1
  v_lshrrev_b32 v18, 3, v16
  v_mul_u32_u24 v18, 3, v18
  v_xor_b32 v18, v18, v17
  v_lshlrev_b32 v18, 4, v18
  v_lshl_add_u32 v14, v16, 6, v18
  s_and_b32 s23, s20, 1
  s_lshl_b32 s23, s23, 13
  v_add_u32 v14, s23, v14
  v_mfma_f32_32x32x16_bf16 a[0:15], v[20:23], v[20:23], 0
  v_lshrrev_b32 v18, 2, v16
  v_lshlrev_b32 v18, 6, v18
  v_lshl_add_u32 v18, v17, 11, v18
  v_and_b32 v19, 1, v1
  v_mfma_f32_32x32x16_bf16 a[16:31], v[20:23], v[20:23], 0
  v_lshl_add_u32 v18, v19, 3, v18
  v_bfe_u32 v19, v1, 1, 1
  v_and_b32 v17, 1, v17
  v_lshl_or_b32 v19, v17, 1, v19
  v_mfma_f32_32x32x16_bf16 a[32:47], v[20:23], v[20:23], 0
  s_lshr_b32 s23, s20, 1
  s_lshl_b32 s23, s23, 13
  s_add_u32 s23, s23, 16384
  v_add_u32 v18, s23, v18
  v_mfma_f32_32x32x16_bf16 a[48:63], v[20:23], v[20:23], 0
  v_lshl_add_u32 v12, v19, 4, v18
  v_xor_b32 v13, 32, v12
  v_mov_b32 v19, 1073741824
  v_lshlrev_b32 v220, 4, v220
  v_mfma_f32_32x32x16_bf16 a[64:79], v[20:23], v[20:23], 0
  v_lshl_add_u32 v220, v208, 7, v220
  v_add_u32 v220, 131072, v220
  v_lshlrev_b32 v222, 2, v209
  v_cmp_eq_u32 vcc, 0, v208
  v_mfma_f32_32x32x16_bf16 a[80:95], v[20:23], v[20:23], 0
  v_add_u32 v222, 2621440, v222
  v_lshlrev_b32 v221, 4, v0
  v_cndmask_b32 v222, v19, v222, vcc
  v_add_u32 v221, 131072, v221
  v_mfma_f32_32x32x16_bf16 a[96:111], v[20:23], v[20:23], 0
  v_sub_u32 v209, 0xffff, v209
  v_lshrrev_b32 v223, 3, v0
  v_and_b32 v18, 7, v0
  v_lshlrev_b32 v18, 4, v18
  v_mfma_f32_32x32x16_bf16 a[112:127], v[20:23], v[20:23], 0
  v_cmp_gt_u32 vcc, 128, v0
  v_lshl_add_u32 v223, v223, 8, v18
  s_lshr_b32 s66, s2, 1
  s_mul_i32 s66, s66, 20480
  v_mfma_f32_32x32x16_bf16 a[128:143], v[20:23], v[20:23], 0
  s_and_b32 s31, s2, 1
  s_lshl_b32 s31, s31, 7
  s_add_u32 s66, s66, s31
  v_cndmask_b32 v224, v19, v223, vcc
  v_mfma_f32_32x32x16_bf16 a[144:159], v[20:23], v[20:23], 0
  s_add_u32 s67, s66, 8192
  s_add_u32 s78, s66, 16384
  s_mov_b32 s28, 0
  v_mfma_f32_32x32x16_bf16 a[160:175], v[20:23], v[20:23], 0
  v_mfma_f32_32x32x16_bf16 a[176:191], v[20:23], v[20:23], 0
  v_mfma_f32_32x32x16_bf16 a[192:207], v[20:23], v[20:23], 0
  v_mfma_f32_32x32x16_bf16 a[208:223], v[20:23], v[20:23], 0
  v_mfma_f32_32x32x16_bf16 a[224:239], v[20:23], v[20:23], 0
  v_mfma_f32_32x32x16_bf16 a[240:255], v[20:23], v[20:23], 0
  s_waitcnt vmcnt(5)
  v_lshlrev_b32 v184, 16, v160
  v_and_b32 v185, 0xffff0000, v160
  v_lshlrev_b32 v186, 16, v161
  v_and_b32 v187, 0xffff0000, v161
  v_lshlrev_b32 v188, 16, v162
  v_and_b32 v189, 0xffff0000, v162
  v_lshlrev_b32 v190, 16, v163
  v_and_b32 v191, 0xffff0000, v163
  v_lshlrev_b32 v192, 16, v164
  v_and_b32 v193, 0xffff0000, v164
  v_lshlrev_b32 v194, 16, v165
  v_and_b32 v195, 0xffff0000, v165
  v_lshlrev_b32 v196, 16, v166
  v_and_b32 v197, 0xffff0000, v166
  v_lshlrev_b32 v198, 16, v167
  v_and_b32 v199, 0xffff0000, v167
  v_lshlrev_b32 v200, 16, v168
  v_and_b32 v201, 0xffff0000, v168
  v_lshlrev_b32 v202, 16, v169
  v_and_b32 v203, 0xffff0000, v169
  v_lshlrev_b32 v204, 16, v170
  v_and_b32 v205, 0xffff0000, v170
  v_lshlrev_b32 v206, 16, v171
  v_and_b32 v207, 0xffff0000, v171
  v_pk_add_f32 v[16:17], v[184:185], v[186:187]
  v_pk_add_f32 v[18:19], v[188:189], v[190:191]
  v_pk_add_f32 v[16:17], v[16:17], v[192:193]
  v_pk_add_f32 v[18:19], v[18:19], v[194:195]
  v_pk_add_f32 v[16:17], v[16:17], v[196:197]
  v_pk_add_f32 v[18:19], v[18:19], v[198:199]
  v_pk_add_f32 v[16:17], v[16:17], v[200:201]
  v_pk_add_f32 v[18:19], v[18:19], v[202:203]
  v_pk_add_f32 v[16:17], v[16:17], v[204:205]
  v_pk_add_f32 v[18:19], v[18:19], v[206:207]
  v_pk_add_f32 v[16:17], v[16:17], v[18:19]
  v_add_f32 v213, v16, v17
  s_nop 1
  v_add_f32_dpp v213, v213, v213 quad_perm:[1,0,3,2] row_mask:0xf bank_mask:0xf
  s_nop 1
  v_add_f32_dpp v213, v213, v213 quad_perm:[2,3,0,1] row_mask:0xf bank_mask:0xf
  s_nop 1
  v_add_f32_dpp v213, v213, v213 row_half_mirror row_mask:0xf bank_mask:0xf
  s_nop 1
  v_add_f32_dpp v213, v213, v213 row_mirror row_mask:0xf bank_mask:0xf
  v_mov_b32 v214, v213
  s_nop 1
  v_permlane16_swap_b32 v213, v214
  v_add_f32 v213, v213, v214
  v_mul_f32 v216, 0xbacccccd, v213
  v_mul_f32 v217, 0xbacccccd, v213
  v_pk_add_f32 v[20:21], v[184:185], v[216:217]
  v_pk_mul_f32 v[16:17], v[20:21], v[20:21]
  v_pk_add_f32 v[22:23], v[186:187], v[216:217]
  v_pk_fma_f32 v[16:17], v[22:23], v[22:23], v[16:17]
  v_pk_add_f32 v[24:25], v[188:189], v[216:217]
  v_pk_fma_f32 v[16:17], v[24:25], v[24:25], v[16:17]
  v_pk_add_f32 v[26:27], v[190:191], v[216:217]
  v_pk_fma_f32 v[16:17], v[26:27], v[26:27], v[16:17]
  v_pk_add_f32 v[20:21], v[192:193], v[216:217]
  v_pk_fma_f32 v[16:17], v[20:21], v[20:21], v[16:17]
  v_pk_add_f32 v[22:23], v[194:195], v[216:217]
  v_pk_fma_f32 v[16:17], v[22:23], v[22:23], v[16:17]
  v_pk_add_f32 v[24:25], v[196:197], v[216:217]
  v_pk_fma_f32 v[16:17], v[24:25], v[24:25], v[16:17]
  v_pk_add_f32 v[26:27], v[198:199], v[216:217]
  v_pk_fma_f32 v[16:17], v[26:27], v[26:27], v[16:17]
  v_pk_add_f32 v[20:21], v[200:201], v[216:217]
  v_pk_mul_f32 v[18:19], v[20:21], v[20:21]
  v_pk_add_f32 v[22:23], v[202:203], v[216:217]
  v_pk_fma_f32 v[18:19], v[22:23], v[22:23], v[18:19]
  v_pk_add_f32 v[24:25], v[204:205], v[216:217]
  v_pk_fma_f32 v[18:19], v[24:25], v[24:25], v[18:19]
  v_pk_add_f32 v[26:27], v[206:207], v[216:217]
  v_pk_fma_f32 v[18:19], v[26:27], v[26:27], v[18:19]
  v_add_f32 v18, v18, v19
  v_add_f32 v213, v16, v17
  v_cndmask_b32 v18, 0, v18, s[64:65]
  v_add_f32 v213, v213, v18
  s_nop 1
  v_add_f32_dpp v213, v213, v213 quad_perm:[1,0,3,2] row_mask:0xf bank_mask:0xf
  s_nop 1
  v_add_f32_dpp v213, v213, v213 quad_perm:[2,3,0,1] row_mask:0xf bank_mask:0xf
  s_nop 1
  v_add_f32_dpp v213, v213, v213 row_half_mirror row_mask:0xf bank_mask:0xf
  s_nop 1
  v_add_f32_dpp v213, v213, v213 row_mirror row_mask:0xf bank_mask:0xf
  v_mov_b32 v214, v213
  s_nop 1
  v_permlane16_swap_b32 v213, v214
  v_add_f32 v213, v213, v214
  v_mul_f32 v213, 0x3acccccd, v213
  v_cvt_pk_bf16_f32 v213, v213, v213
  v_and_b32 v213, 0xffff0000, v213
  v_add_f32 v213, 0x3727c5ac, v213
  v_cvt_pk_bf16_f32 v213, v213, v213
  v_and_b32 v213, 0xffff0000, v213
  v_sqrt_f32 v213, v213
  v_cvt_pk_bf16_f32 v216, v216, v216
  v_and_b32 v216, 0xffff0000, v216
  v_cvt_pk_bf16_f32 v213, v213, v213
  v_and_b32 v213, 0xffff0000, v213
  v_rcp_f32 v28, v213
  v_mov_b32 v217, v216
  v_mov_b32 v29, v28
  v_pk_add_f32 v[184:185], v[184:185], v[216:217]
  v_lshlrev_b32 v16, 16, v172
  v_cvt_pk_bf16_f32 v185, v184, v185
  v_and_b32 v17, 0xffff0000, v172
  v_lshlrev_b32 v184, 16, v185
  v_and_b32 v185, 0xffff0000, v185
  v_pk_mul_f32 v[184:185], v[184:185], v[28:29]
  v_cvt_pk_bf16_f32 v160, v184, v185
  v_lshlrev_b32 v184, 16, v160
  v_and_b32 v185, 0xffff0000, v160
  v_pk_mul_f32 v[218:219], v[184:185], v[16:17]
  v_pk_add_f32 v[186:187], v[186:187], v[216:217]
  v_lshlrev_b32 v18, 16, v173
  v_cvt_pk_bf16_f32 v187, v186, v187
  v_and_b32 v19, 0xffff0000, v173
  v_lshlrev_b32 v186, 16, v187
  v_and_b32 v187, 0xffff0000, v187
  v_pk_mul_f32 v[186:187], v[186:187], v[28:29]
  v_cvt_pk_bf16_f32 v161, v186, v187
  v_lshlrev_b32 v186, 16, v161
  v_and_b32 v187, 0xffff0000, v161
  v_pk_fma_f32 v[218:219], v[186:187], v[18:19], v[218:219]
  v_pk_add_f32 v[188:189], v[188:189], v[216:217]
  v_lshlrev_b32 v16, 16, v174
  v_cvt_pk_bf16_f32 v189, v188, v189
  v_and_b32 v17, 0xffff0000, v174
  v_lshlrev_b32 v188, 16, v189
  v_and_b32 v189, 0xffff0000, v189
  v_pk_mul_f32 v[188:189], v[188:189], v[28:29]
  v_cvt_pk_bf16_f32 v162, v188, v189
  v_lshlrev_b32 v188, 16, v162
  v_and_b32 v189, 0xffff0000, v162
  v_pk_fma_f32 v[218:219], v[188:189], v[16:17], v[218:219]
  v_pk_add_f32 v[190:191], v[190:191], v[216:217]
  v_lshlrev_b32 v18, 16, v175
  v_cvt_pk_bf16_f32 v191, v190, v191
  v_and_b32 v19, 0xffff0000, v175
  v_lshlrev_b32 v190, 16, v191
  v_and_b32 v191, 0xffff0000, v191
  v_pk_mul_f32 v[190:191], v[190:191], v[28:29]
  v_cvt_pk_bf16_f32 v163, v190, v191
  v_lshlrev_b32 v190, 16, v163
  v_and_b32 v191, 0xffff0000, v163
  v_pk_fma_f32 v[218:219], v[190:191], v[18:19], v[218:219]
  ds_write_b128 v220, v[160:163] offset:0
  v_pk_add_f32 v[192:193], v[192:193], v[216:217]
  v_lshlrev_b32 v16, 16, v176
  v_cvt_pk_bf16_f32 v193, v192, v193
  v_and_b32 v17, 0xffff0000, v176
  v_lshlrev_b32 v192, 16, v193
  v_and_b32 v193, 0xffff0000, v193
  v_pk_mul_f32 v[192:193], v[192:193], v[28:29]
  v_cvt_pk_bf16_f32 v164, v192, v193
  v_lshlrev_b32 v192, 16, v164
  v_and_b32 v193, 0xffff0000, v164
  v_pk_fma_f32 v[218:219], v[192:193], v[16:17], v[218:219]
  v_pk_add_f32 v[194:195], v[194:195], v[216:217]
  v_lshlrev_b32 v18, 16, v177
  v_cvt_pk_bf16_f32 v195, v194, v195
  v_and_b32 v19, 0xffff0000, v177
  v_lshlrev_b32 v194, 16, v195
  v_and_b32 v195, 0xffff0000, v195
  v_pk_mul_f32 v[194:195], v[194:195], v[28:29]
  v_cvt_pk_bf16_f32 v165, v194, v195
  v_lshlrev_b32 v194, 16, v165
  v_and_b32 v195, 0xffff0000, v165
  v_pk_fma_f32 v[218:219], v[194:195], v[18:19], v[218:219]
  v_pk_add_f32 v[196:197], v[196:197], v[216:217]
  v_lshlrev_b32 v16, 16, v178
  v_cvt_pk_bf16_f32 v197, v196, v197
  v_and_b32 v17, 0xffff0000, v178
  v_lshlrev_b32 v196, 16, v197
  v_and_b32 v197, 0xffff0000, v197
  v_pk_mul_f32 v[196:197], v[196:197], v[28:29]
  v_cvt_pk_bf16_f32 v166, v196, v197
  v_lshlrev_b32 v196, 16, v166
  v_and_b32 v197, 0xffff0000, v166
  v_pk_fma_f32 v[218:219], v[196:197], v[16:17], v[218:219]
  v_pk_add_f32 v[198:199], v[198:199], v[216:217]
  v_lshlrev_b32 v18, 16, v179
  v_cvt_pk_bf16_f32 v199, v198, v199
  v_and_b32 v19, 0xffff0000, v179
  v_lshlrev_b32 v198, 16, v199
  v_and_b32 v199, 0xffff0000, v199
  v_pk_mul_f32 v[198:199], v[198:199], v[28:29]
  v_cvt_pk_bf16_f32 v167, v198, v199
  v_lshlrev_b32 v198, 16, v167
  v_and_b32 v199, 0xffff0000, v167
  v_pk_fma_f32 v[218:219], v[198:199], v[18:19], v[218:219]
  ds_write_b128 v220, v[164:167] offset:4096
  v_pk_add_f32 v[200:201], v[200:201], v[216:217]
  v_lshlrev_b32 v16, 16, v180
  v_cvt_pk_bf16_f32 v201, v200, v201
  v_and_b32 v17, 0xffff0000, v180
  v_lshlrev_b32 v200, 16, v201
  v_and_b32 v201, 0xffff0000, v201
  v_pk_mul_f32 v[200:201], v[200:201], v[28:29]
  v_cvt_pk_bf16_f32 v168, v200, v201
  v_lshlrev_b32 v200, 16, v168
  v_and_b32 v201, 0xffff0000, v168
  v_pk_fma_f32 v[218:219], v[200:201], v[16:17], v[218:219]
  v_pk_add_f32 v[202:203], v[202:203], v[216:217]
  v_lshlrev_b32 v18, 16, v181
  v_cvt_pk_bf16_f32 v203, v202, v203
  v_and_b32 v19, 0xffff0000, v181
  v_lshlrev_b32 v202, 16, v203
  v_and_b32 v203, 0xffff0000, v203
  v_pk_mul_f32 v[202:203], v[202:203], v[28:29]
  v_cvt_pk_bf16_f32 v169, v202, v203
  v_lshlrev_b32 v202, 16, v169
  v_and_b32 v203, 0xffff0000, v169
  v_pk_fma_f32 v[218:219], v[202:203], v[18:19], v[218:219]
  v_pk_add_f32 v[204:205], v[204:205], v[216:217]
  v_lshlrev_b32 v16, 16, v182
  v_cvt_pk_bf16_f32 v205, v204, v205
  v_and_b32 v17, 0xffff0000, v182
  v_lshlrev_b32 v204, 16, v205
  v_and_b32 v205, 0xffff0000, v205
  v_pk_mul_f32 v[204:205], v[204:205], v[28:29]
  v_cvt_pk_bf16_f32 v170, v204, v205
  v_lshlrev_b32 v204, 16, v170
  v_and_b32 v205, 0xffff0000, v170
  v_pk_fma_f32 v[218:219], v[204:205], v[16:17], v[218:219]
  v_pk_add_f32 v[206:207], v[206:207], v[216:217]
  v_lshlrev_b32 v18, 16, v183
  v_cvt_pk_bf16_f32 v207, v206, v207
  v_and_b32 v19, 0xffff0000, v183
  v_lshlrev_b32 v206, 16, v207
  v_and_b32 v207, 0xffff0000, v207
  v_pk_mul_f32 v[206:207], v[206:207], v[28:29]
  v_cvt_pk_bf16_f32 v171, v206, v207
  v_lshlrev_b32 v206, 16, v171
  v_and_b32 v207, 0xffff0000, v171
  v_pk_fma_f32 v[218:219], v[206:207], v[18:19], v[218:219]
  ds_write_b128 v220, v[168:171] offset:8192
  v_add_f32 v218, v218, v219
  s_nop 1
  v_add_f32_dpp v218, v218, v218 quad_perm:[1,0,3,2] row_mask:0xf bank_mask:0xf
  s_nop 1
  v_add_f32_dpp v218, v218, v218 quad_perm:[2,3,0,1] row_mask:0xf bank_mask:0xf
  s_nop 1
  v_add_f32_dpp v218, v218, v218 row_half_mirror row_mask:0xf bank_mask:0xf
  s_nop 1
  v_add_f32_dpp v218, v218, v218 row_mirror row_mask:0xf bank_mask:0xf
  v_mov_b32 v214, v218
  s_nop 1
  v_permlane16_swap_b32 v218, v214
  v_add_f32 v218, v218, v214
  v_cvt_pk_bf16_f32 v218, v218, v218
  v_and_b32 v218, 0xffff0000, v218
  v_ashrrev_i32 v214, 31, v218
  v_or_b32 v214, 0x80000000, v214
  v_xor_b32 v218, v218, v214
  v_and_b32 v218, 0xffff0000, v218
  v_or_b32 v218, v218, v209
  v_mov_b32 v19, 1073741824
  s_mov_b32 m0, s24
  s_nop 0
  buffer_load_dwordx4 v3, s[32:35], s26 offen offset:0 sc1 lds
  buffer_load_dwordx4 v4, s[32:35], s26 offen offset:1024 sc1 lds
  buffer_load_dwordx4 v5, s[32:35], s26 offen offset:2048 sc1 lds
  buffer_load_dwordx4 v6, s[32:35], s26 offen offset:3072 sc1 lds
  s_add_u32 m0, s24, 16384
  s_nop 0
  buffer_load_dwordx4 v8, s[36:39], s27 offen offset:0 lds
  buffer_load_dwordx4 v9, s[36:39], s27 offen offset:1024 lds
  buffer_load_dwordx4 v10, s[36:39], s27 offen offset:2048 lds
  buffer_load_dwordx4 v11, s[36:39], s27 offen offset:3072 lds
  s_add_u32 s26, s26, s79
  s_add_u32 s27, s27, s25
  s_add_u32 s24, s24, 32768
  s_and_b32 s24, s24, 0x1ffff
  s_mov_b32 m0, s24
  s_nop 0
  buffer_load_dwordx4 v3, s[32:35], s26 offen offset:0 sc1 lds
  buffer_load_dwordx4 v4, s[32:35], s26 offen offset:1024 sc1 lds
  buffer_load_dwordx4 v5, s[32:35], s26 offen offset:2048 sc1 lds
  buffer_load_dwordx4 v6, s[32:35], s26 offen offset:3072 sc1 lds
  s_add_u32 m0, s24, 16384
  s_nop 0
  buffer_load_dwordx4 v8, s[36:39], s27 offen offset:0 lds
  buffer_load_dwordx4 v9, s[36:39], s27 offen offset:1024 lds
  buffer_load_dwordx4 v10, s[36:39], s27 offen offset:2048 lds
  buffer_load_dwordx4 v11, s[36:39], s27 offen offset:3072 lds
  s_add_u32 s26, s26, s79
  s_add_u32 s27, s27, s25
  s_add_u32 s24, s24, 32768
  s_and_b32 s24, s24, 0x1ffff
  s_mov_b32 m0, s24
  s_nop 0
  buffer_load_dwordx4 v3, s[32:35], s26 offen offset:0 sc1 lds
  buffer_load_dwordx4 v4, s[32:35], s26 offen offset:1024 sc1 lds
  buffer_load_dwordx4 v5, s[32:35], s26 offen offset:2048 sc1 lds
  buffer_load_dwordx4 v6, s[32:35], s26 offen offset:3072 sc1 lds
  s_add_u32 m0, s24, 16384
  s_nop 0
  buffer_load_dwordx4 v8, s[36:39], s27 offen offset:0 lds
  buffer_load_dwordx4 v9, s[36:39], s27 offen offset:1024 lds
  buffer_load_dwordx4 v10, s[36:39], s27 offen offset:2048 lds
  buffer_load_dwordx4 v11, s[36:39], s27 offen offset:3072 lds
  s_add_u32 s26, s26, s79
  s_add_u32 s27, s27, s25
  s_add_u32 s24, s24, 32768
  s_and_b32 s24, s24, 0x1ffff
  buffer_load_dword v231, v19, s[32:35], 0 offen
  s_mov_b32 m0, s24
  s_nop 0
  buffer_load_dwordx4 v3, s[32:35], s26 offen offset:0 sc1 lds
  buffer_load_dwordx4 v4, s[32:35], s26 offen offset:1024 sc1 lds
  buffer_load_dwordx4 v5, s[32:35], s26 offen offset:2048 sc1 lds
  buffer_load_dwordx4 v6, s[32:35], s26 offen offset:3072 sc1 lds
  s_add_u32 m0, s24, 16384
  s_nop 0
  buffer_load_dwordx4 v8, s[36:39], s27 offen offset:0 lds
  buffer_load_dwordx4 v9, s[36:39], s27 offen offset:1024 lds
  buffer_load_dwordx4 v10, s[36:39], s27 offen offset:2048 lds
  buffer_load_dwordx4 v11, s[36:39], s27 offen offset:3072 lds
  s_add_u32 s26, s26, s79
  s_add_u32 s27, s27, s25
  s_add_u32 s24, s24, 32768
  s_and_b32 s24, s24, 0x1ffff
  s_waitcnt vmcnt(25) lgkmcnt(0)
  s_barrier
  s_cmp_ge_u32 s20, 2
  s_cbranch_scc1 fa_roleV
  ds_read_b128 v[96:99], v14 offset:0
  ds_read_b128 v[100:103], v14 offset:1024
  ds_read_b128 v[104:107], v14 offset:2048
  ds_read_b128 v[108:111], v14 offset:3072
  ds_read_b128 v[112:115], v14 offset:4096
  ds_read_b128 v[116:119], v14 offset:5120
  ds_read_b128 v[120:123], v14 offset:6144
  ds_read_b128 v[124:127], v14 offset:7168
  ds_read_b64_tr_b16 v[32:33], v12 offset:0
  ds_read_b64_tr_b16 v[34:35], v12 offset:1024
  ds_read_b64_tr_b16 v[36:37], v13 offset:0
  ds_read_b64_tr_b16 v[38:39], v13 offset:1024
  ds_read_b64_tr_b16 v[40:41], v12 offset:256
  ds_read_b64_tr_b16 v[42:43], v12 offset:1280
  ds_read_b64_tr_b16 v[44:45], v13 offset:256
  ds_read_b64_tr_b16 v[46:47], v13 offset:1280
  ds_read_b64_tr_b16 v[48:49], v12 offset:512
  ds_read_b64_tr_b16 v[50:51], v12 offset:1536
  ds_read_b64_tr_b16 v[52:53], v13 offset:512
  ds_read_b64_tr_b16 v[54:55], v13 offset:1536
  ds_read_b64_tr_b16 v[56:57], v12 offset:768
  ds_read_b64_tr_b16 v[58:59], v12 offset:1792
  ds_read_b64_tr_b16 v[60:61], v13 offset:768
  ds_read_b64_tr_b16 v[62:63], v13 offset:1792
  s_waitcnt lgkmcnt(0)
.p2align 6
fa_loopK:
  v_mfma_f32_16x16x32_bf16 a[0:3], v[32:35], v[96:99], a[0:3]
  s_waitcnt vmcnt(17)
  v_mfma_f32_16x16x32_bf16 a[4:7], v[32:35], v[100:103], a[4:7]
  s_barrier
  v_mfma_f32_16x16x32_bf16 a[8:11], v[32:35], v[104:107], a[8:11]
  ds_read_b64_tr_b16 v[64:65], v12 offset:32768
  v_mfma_f32_16x16x32_bf16 a[12:15], v[32:35], v[108:111], a[12:15]
  v_mfma_f32_16x16x32_bf16 a[16:19], v[32:35], v[112:115], a[16:19]
  s_mov_b32 m0, s24
  ds_read_b64_tr_b16 v[66:67], v12 offset:33792
  v_mfma_f32_16x16x32_bf16 a[20:23], v[32:35], v[116:119], a[20:23]
  buffer_load_dwordx4 v3, s[32:35], s26 offen offset:0 sc1 lds
  v_mfma_f32_16x16x32_bf16 a[24:27], v[32:35], v[120:123], a[24:27]
  ds_read_b128 v[128:131], v14 offset:32768
  v_mfma_f32_16x16x32_bf16 a[28:31], v[32:35], v[124:127], a[28:31]
  buffer_load_dwordx4 v4, s[32:35], s26 offen offset:1024 sc1 lds
  v_mfma_f32_16x16x32_bf16 a[32:35], v[36:39], v[96:99], a[32:35]
  ds_read_b64_tr_b16 v[68:69], v13 offset:32768
  v_mfma_f32_16x16x32_bf16 a[36:39], v[36:39], v[100:103], a[36:39]
  buffer_load_dwordx4 v5, s[32:35], s26 offen offset:2048 sc1 lds
  v_mfma_f32_16x16x32_bf16 a[40:43], v[36:39], v[104:107], a[40:43]
  ds_read_b64_tr_b16 v[70:71], v13 offset:33792
  v_mfma_f32_16x16x32_bf16 a[44:47], v[36:39], v[108:111], a[44:47]
  buffer_load_dwordx4 v6, s[32:35], s26 offen offset:3072 sc1 lds
  v_mfma_f32_16x16x32_bf16 a[48:51], v[36:39], v[112:115], a[48:51]
  s_add_u32 m0, s24, 16384
  ds_read_b128 v[132:135], v14 offset:33792
  v_mfma_f32_16x16x32_bf16 a[52:55], v[36:39], v[116:119], a[52:55]
  buffer_load_dwordx4 v8, s[36:39], s27 offen offset:0 lds
  v_mfma_f32_16x16x32_bf16 a[56:59], v[36:39], v[120:123], a[56:59]
  ds_read_b64_tr_b16 v[72:73], v12 offset:33024
  v_mfma_f32_16x16x32_bf16 a[60:63], v[36:39], v[124:127], a[60:63]
  buffer_load_dwordx4 v9, s[36:39], s27 offen offset:1024 lds
  v_mfma_f32_16x16x32_bf16 a[64:67], v[40:43], v[96:99], a[64:67]
  ds_read_b64_tr_b16 v[74:75], v12 offset:34048
  v_mfma_f32_16x16x32_bf16 a[68:71], v[40:43], v[100:103], a[68:71]
  buffer_load_dwordx4 v10, s[36:39], s27 offen offset:2048 lds
  v_mfma_f32_16x16x32_bf16 a[72:75], v[40:43], v[104:107], a[72:75]
  ds_read_b128 v[136:139], v14 offset:34816
  v_mfma_f32_16x16x32_bf16 a[76:79], v[40:43], v[108:111], a[76:79]
  buffer_load_dwordx4 v11, s[36:39], s27 offen offset:3072 lds
  v_mfma_f32_16x16x32_bf16 a[80:83], v[40:43], v[112:115], a[80:83]
  ds_read_b64_tr_b16 v[76:77], v13 offset:33024
  v_mfma_f32_16x16x32_bf16 a[84:87], v[40:43], v[116:119], a[84:87]
  buffer_load_dword v231, v235, s[48:51], s74 offen sc1
  v_mfma_f32_16x16x32_bf16 a[88:91], v[40:43], v[120:123], a[88:91]
  s_add_u32 s74, s74, s73
  ds_read_b64_tr_b16 v[78:79], v13 offset:34048
  v_mfma_f32_16x16x32_bf16 a[92:95], v[40:43], v[124:127], a[92:95]
  s_bitcmp1_b32 s72, s28
  v_mfma_f32_16x16x32_bf16 a[96:99], v[44:47], v[96:99], a[96:99]
  s_cbranch_scc1 fa_hk0
fa_hb0:
  ds_read_b128 v[140:143], v14 offset:35840
  v_mfma_f32_16x16x32_bf16 a[100:103], v[44:47], v[100:103], a[100:103]
  v_mfma_f32_16x16x32_bf16 a[104:107], v[44:47], v[104:107], a[104:107]
  ds_read_b64_tr_b16 v[80:81], v12 offset:33280
  v_mfma_f32_16x16x32_bf16 a[108:111], v[44:47], v[108:111], a[108:111]
  v_mfma_f32_16x16x32_bf16 a[112:115], v[44:47], v[112:115], a[112:115]
  ds_read_b64_tr_b16 v[82:83], v12 offset:34304
  v_mfma_f32_16x16x32_bf16 a[116:119], v[44:47], v[116:119], a[116:119]
  v_mfma_f32_16x16x32_bf16 a[120:123], v[44:47], v[120:123], a[120:123]
  ds_read_b128 v[144:147], v14 offset:36864
  v_mfma_f32_16x16x32_bf16 a[124:127], v[44:47], v[124:127], a[124:127]
  v_mfma_f32_16x16x32_bf16 a[128:131], v[48:51], v[96:99], a[128:131]
  ds_read_b64_tr_b16 v[84:85], v13 offset:33280
  v_mfma_f32_16x16x32_bf16 a[132:135], v[48:51], v[100:103], a[132:135]
  v_mfma_f32_16x16x32_bf16 a[136:139], v[48:51], v[104:107], a[136:139]
  ds_read_b64_tr_b16 v[86:87], v13 offset:34304
  v_mfma_f32_16x16x32_bf16 a[140:143], v[48:51], v[108:111], a[140:143]
  v_mfma_f32_16x16x32_bf16 a[144:147], v[48:51], v[112:115], a[144:147]
  ds_read_b128 v[148:151], v14 offset:37888
  v_mfma_f32_16x16x32_bf16 a[148:151], v[48:51], v[116:119], a[148:151]
  v_mfma_f32_16x16x32_bf16 a[152:155], v[48:51], v[120:123], a[152:155]
  ds_read_b64_tr_b16 v[88:89], v12 offset:33536
  v_mfma_f32_16x16x32_bf16 a[156:159], v[48:51], v[124:127], a[156:159]
  v_mfma_f32_16x16x32_bf16 a[160:163], v[52:55], v[96:99], a[160:163]
  ds_read_b64_tr_b16 v[90:91], v12 offset:34560
  v_mfma_f32_16x16x32_bf16 a[164:167], v[52:55], v[100:103], a[164:167]
  v_mfma_f32_16x16x32_bf16 a[168:171], v[52:55], v[104:107], a[168:171]
  ds_read_b128 v[152:155], v14 offset:38912
  v_mfma_f32_16x16x32_bf16 a[172:175], v[52:55], v[108:111], a[172:175]
  v_mfma_f32_16x16x32_bf16 a[176:179], v[52:55], v[112:115], a[176:179]
  ds_read_b64_tr_b16 v[92:93], v13 offset:33536
  v_mfma_f32_16x16x32_bf16 a[180:183], v[52:55], v[116:119], a[180:183]
  v_mfma_f32_16x16x32_bf16 a[184:187], v[52:55], v[120:123], a[184:187]
  ds_read_b64_tr_b16 v[94:95], v13 offset:34560
  v_mfma_f32_16x16x32_bf16 a[188:191], v[52:55], v[124:127], a[188:191]
  v_mfma_f32_16x16x32_bf16 a[192:195], v[56:59], v[96:99], a[192:195]
  s_add_u32 s26, s26, s79
  ds_read_b128 v[156:159], v14 offset:39936
  v_mfma_f32_16x16x32_bf16 a[196:199], v[56:59], v[100:103], a[196:199]
  s_add_u32 s27, s27, s25
  v_mfma_f32_16x16x32_bf16 a[200:203], v[56:59], v[104:107], a[200:203]
  s_add_u32 s24, s24, 32768
  v_mfma_f32_16x16x32_bf16 a[204:207], v[56:59], v[108:111], a[204:207]
  s_and_b32 s24, s24, 0x1ffff
  v_mfma_f32_16x16x32_bf16 a[208:211], v[56:59], v[112:115], a[208:211]
  v_xor_b32 v14, 0x10000, v14
  v_mfma_f32_16x16x32_bf16 a[212:215], v[56:59], v[116:119], a[212:215]
  v_xor_b32 v12, 0x10000, v12
  v_mfma_f32_16x16x32_bf16 a[216:219], v[56:59], v[120:123], a[216:219]
  v_xor_b32 v13, 0x10000, v13
  v_mfma_f32_16x16x32_bf16 a[220:223], v[56:59], v[124:127], a[220:223]
  v_mfma_f32_16x16x32_bf16 a[224:227], v[60:63], v[96:99], a[224:227]
  v_mfma_f32_16x16x32_bf16 a[228:231], v[60:63], v[100:103], a[228:231]
  v_mfma_f32_16x16x32_bf16 a[232:235], v[60:63], v[104:107], a[232:235]
  v_mfma_f32_16x16x32_bf16 a[236:239], v[60:63], v[108:111], a[236:239]
  v_mfma_f32_16x16x32_bf16 a[240:243], v[60:63], v[112:115], a[240:243]
  v_mfma_f32_16x16x32_bf16 a[244:247], v[60:63], v[116:119], a[244:247]
  v_mfma_f32_16x16x32_bf16 a[248:251], v[60:63], v[120:123], a[248:251]
  v_mfma_f32_16x16x32_bf16 a[252:255], v[60:63], v[124:127], a[252:255]
  s_waitcnt lgkmcnt(0)
  v_mfma_f32_16x16x32_bf16 a[0:3], v[64:67], v[128:131], a[0:3]
  s_waitcnt vmcnt(18)
  v_mfma_f32_16x16x32_bf16 a[4:7], v[64:67], v[132:135], a[4:7]
  s_barrier
  v_mfma_f32_16x16x32_bf16 a[8:11], v[64:67], v[136:139], a[8:11]
  ds_read_b64_tr_b16 v[32:33], v12 offset:0
  v_mfma_f32_16x16x32_bf16 a[12:15], v[64:67], v[140:143], a[12:15]
  v_mfma_f32_16x16x32_bf16 a[16:19], v[64:67], v[144:147], a[16:19]
  s_mov_b32 m0, s24
  ds_read_b64_tr_b16 v[34:35], v12 offset:1024
  v_mfma_f32_16x16x32_bf16 a[20:23], v[64:67], v[148:151], a[20:23]
  buffer_load_dwordx4 v3, s[32:35], s26 offen offset:0 sc1 lds
  v_mfma_f32_16x16x32_bf16 a[24:27], v[64:67], v[152:155], a[24:27]
  ds_read_b128 v[96:99], v14 offset:0
  v_mfma_f32_16x16x32_bf16 a[28:31], v[64:67], v[156:159], a[28:31]
  v_mfma_f32_16x16x32_bf16 a[32:35], v[68:71], v[128:131], a[32:35]
  ds_read_b64_tr_b16 v[36:37], v13 offset:0
  v_mfma_f32_16x16x32_bf16 a[36:39], v[68:71], v[132:135], a[36:39]
  v_mfma_f32_16x16x32_bf16 a[40:43], v[68:71], v[136:139], a[40:43]
  ds_read_b64_tr_b16 v[38:39], v13 offset:1024
  v_mfma_f32_16x16x32_bf16 a[44:47], v[68:71], v[140:143], a[44:47]
  buffer_load_dwordx4 v4, s[32:35], s26 offen offset:1024 sc1 lds
  v_mfma_f32_16x16x32_bf16 a[48:51], v[68:71], v[144:147], a[48:51]
  ds_read_b128 v[100:103], v14 offset:1024
  v_mfma_f32_16x16x32_bf16 a[52:55], v[68:71], v[148:151], a[52:55]
  v_mfma_f32_16x16x32_bf16 a[56:59], v[68:71], v[152:155], a[56:59]
  ds_read_b64_tr_b16 v[40:41], v12 offset:256
  v_mfma_f32_16x16x32_bf16 a[60:63], v[68:71], v[156:159], a[60:63]
  v_mfma_f32_16x16x32_bf16 a[64:67], v[72:75], v[128:131], a[64:67]
  ds_read_b64_tr_b16 v[42:43], v12 offset:1280
  v_mfma_f32_16x16x32_bf16 a[68:71], v[72:75], v[132:135], a[68:71]
  buffer_load_dwordx4 v5, s[32:35], s26 offen offset:2048 sc1 lds
  v_mfma_f32_16x16x32_bf16 a[72:75], v[72:75], v[136:139], a[72:75]
  ds_read_b128 v[104:107], v14 offset:2048
  v_mfma_f32_16x16x32_bf16 a[76:79], v[72:75], v[140:143], a[76:79]
  v_mfma_f32_16x16x32_bf16 a[80:83], v[72:75], v[144:147], a[80:83]
  ds_read_b64_tr_b16 v[44:45], v13 offset:256
  v_mfma_f32_16x16x32_bf16 a[84:87], v[72:75], v[148:151], a[84:87]
  v_mfma_f32_16x16x32_bf16 a[88:91], v[72:75], v[152:155], a[88:91]
  ds_read_b64_tr_b16 v[46:47], v13 offset:1280
  v_mfma_f32_16x16x32_bf16 a[92:95], v[72:75], v[156:159], a[92:95]
  buffer_load_dwordx4 v6, s[32:35], s26 offen offset:3072 sc1 lds
  v_mfma_f32_16x16x32_bf16 a[96:99], v[76:79], v[128:131], a[96:99]
  ds_read_b128 v[108:111], v14 offset:3072
  v_mfma_f32_16x16x32_bf16 a[100:103], v[76:79], v[132:135], a[100:103]
  v_mfma_f32_16x16x32_bf16 a[104:107], v[76:79], v[136:139], a[104:107]
  ds_read_b64_tr_b16 v[48:49], v12 offset:512
  v_mfma_f32_16x16x32_bf16 a[108:111], v[76:79], v[140:143], a[108:111]
  v_mfma_f32_16x16x32_bf16 a[112:115], v[76:79], v[144:147], a[112:115]
  s_add_u32 m0, s24, 16384
  ds_read_b64_tr_b16 v[50:51], v12 offset:1536
  v_mfma_f32_16x16x32_bf16 a[116:119], v[76:79], v[148:151], a[116:119]
  buffer_load_dwordx4 v8, s[36:39], s27 offen offset:0 lds
  v_mfma_f32_16x16x32_bf16 a[120:123], v[76:79], v[152:155], a[120:123]
  ds_read_b128 v[112:115], v14 offset:4096
  v_mfma_f32_16x16x32_bf16 a[124:127], v[76:79], v[156:159], a[124:127]
  v_mfma_f32_16x16x32_bf16 a[128:131], v[80:83], v[128:131], a[128:131]
  ds_read_b64_tr_b16 v[52:53], v13 offset:512
  v_mfma_f32_16x16x32_bf16 a[132:135], v[80:83], v[132:135], a[132:135]
  v_mfma_f32_16x16x32_bf16 a[136:139], v[80:83], v[136:139], a[136:139]
  ds_read_b64_tr_b16 v[54:55], v13 offset:1536
  v_mfma_f32_16x16x32_bf16 a[140:143], v[80:83], v[140:143], a[140:143]
  buffer_load_dwordx4 v9, s[36:39], s27 offen offset:1024 lds
  v_mfma_f32_16x16x32_bf16 a[144:147], v[80:83], v[144:147], a[144:147]
  ds_read_b128 v[116:119], v14 offset:5120
  v_mfma_f32_16x16x32_bf16 a[148:151], v[80:83], v[148:151], a[148:151]
  v_mfma_f32_16x16x32_bf16 a[152:155], v[80:83], v[152:155], a[152:155]
  ds_read_b64_tr_b16 v[56:57], v12 offset:768
  v_mfma_f32_16x16x32_bf16 a[156:159], v[80:83], v[156:159], a[156:159]
  v_mfma_f32_16x16x32_bf16 a[160:163], v[84:87], v[128:131], a[160:163]
  ds_read_b64_tr_b16 v[58:59], v12 offset:1792
  v_mfma_f32_16x16x32_bf16 a[164:167], v[84:87], v[132:135], a[164:167]
  buffer_load_dwordx4 v10, s[36:39], s27 offen offset:2048 lds
  v_mfma_f32_16x16x32_bf16 a[168:171], v[84:87], v[136:139], a[168:171]
  ds_read_b128 v[120:123], v14 offset:6144
  v_mfma_f32_16x16x32_bf16 a[172:175], v[84:87], v[140:143], a[172:175]
  v_mfma_f32_16x16x32_bf16 a[176:179], v[84:87], v[144:147], a[176:179]
  ds_read_b64_tr_b16 v[60:61], v13 offset:768
  v_mfma_f32_16x16x32_bf16 a[180:183], v[84:87], v[148:151], a[180:183]
  v_mfma_f32_16x16x32_bf16 a[184:187], v[84:87], v[152:155], a[184:187]
  ds_read_b64_tr_b16 v[62:63], v13 offset:1792
  v_mfma_f32_16x16x32_bf16 a[188:191], v[84:87], v[156:159], a[188:191]
  buffer_load_dwordx4 v11, s[36:39], s27 offen offset:3072 lds
  v_mfma_f32_16x16x32_bf16 a[192:195], v[88:91], v[128:131], a[192:195]
  s_add_u32 s26, s26, s79
  ds_read_b128 v[124:127], v14 offset:7168
  v_mfma_f32_16x16x32_bf16 a[196:199], v[88:91], v[132:135], a[196:199]
  s_add_u32 s27, s27, s25
  v_mfma_f32_16x16x32_bf16 a[200:203], v[88:91], v[136:139], a[200:203]
  s_add_u32 s24, s24, 32768
  v_mfma_f32_16x16x32_bf16 a[204:207], v[88:91], v[140:143], a[204:207]
  s_and_b32 s24, s24, 0x1ffff
  v_mfma_f32_16x16x32_bf16 a[208:211], v[88:91], v[144:147], a[208:211]
  v_mfma_f32_16x16x32_bf16 a[212:215], v[88:91], v[148:151], a[212:215]
  s_bitcmp1_b32 s76, s28
  v_mfma_f32_16x16x32_bf16 a[216:219], v[88:91], v[152:155], a[216:219]
  s_cbranch_scc1 fa_hk1
fa_hb1:
  v_mfma_f32_16x16x32_bf16 a[220:223], v[88:91], v[156:159], a[220:223]
  v_mfma_f32_16x16x32_bf16 a[224:227], v[92:95], v[128:131], a[224:227]
  v_mfma_f32_16x16x32_bf16 a[228:231], v[92:95], v[132:135], a[228:231]
  s_add_u32 s28, s28, 1
  v_mfma_f32_16x16x32_bf16 a[232:235], v[92:95], v[136:139], a[232:235]
  v_mfma_f32_16x16x32_bf16 a[236:239], v[92:95], v[140:143], a[236:239]
  v_mfma_f32_16x16x32_bf16 a[240:243], v[92:95], v[144:147], a[240:243]
  v_mfma_f32_16x16x32_bf16 a[244:247], v[92:95], v[148:151], a[244:247]
  s_cmp_lt_u32 s28, 8
  v_mfma_f32_16x16x32_bf16 a[248:251], v[92:95], v[152:155], a[248:251]
  s_waitcnt lgkmcnt(0)
  v_mfma_f32_16x16x32_bf16 a[252:255], v[92:95], v[156:159], a[252:255]
  s_cbranch_scc1 fa_loopK
  s_mov_b32 s60, 2048
  s_mov_b32 s61, 8192
  s_mov_b32 s62, 16777216
  s_mov_b32 s76, 0x3e0293ee
  s_branch fa_p1epi
fa_roleV:
  ds_read_b128 v[32:35], v14 offset:0
  ds_read_b128 v[36:39], v14 offset:1024
  ds_read_b128 v[40:43], v14 offset:2048
  ds_read_b128 v[44:47], v14 offset:3072
  ds_read_b128 v[48:51], v14 offset:4096
  ds_read_b128 v[52:55], v14 offset:5120
  ds_read_b128 v[56:59], v14 offset:6144
  ds_read_b128 v[60:63], v14 offset:7168
  ds_read_b64_tr_b16 v[96:97], v12 offset:0
  ds_read_b64_tr_b16 v[98:99], v12 offset:1024
  ds_read_b64_tr_b16 v[100:101], v13 offset:0
  ds_read_b64_tr_b16 v[102:103], v13 offset:1024
  ds_read_b64_tr_b16 v[104:105], v12 offset:256
  ds_read_b64_tr_b16 v[106:107], v12 offset:1280
  ds_read_b64_tr_b16 v[108:109], v13 offset:256
  ds_read_b64_tr_b16 v[110:111], v13 offset:1280
  ds_read_b64_tr_b16 v[112:113], v12 offset:512
  ds_read_b64_tr_b16 v[114:115], v12 offset:1536
  ds_read_b64_tr_b16 v[116:117], v13 offset:512
  ds_read_b64_tr_b16 v[118:119], v13 offset:1536
  ds_read_b64_tr_b16 v[120:121], v12 offset:768
  ds_read_b64_tr_b16 v[122:123], v12 offset:1792
  ds_read_b64_tr_b16 v[124:125], v13 offset:768
  ds_read_b64_tr_b16 v[126:127], v13 offset:1792
  s_waitcnt lgkmcnt(0)
.p2align 6
fa_loopV:
  v_mfma_f32_16x16x32_bf16 a[0:3], v[32:35], v[96:99], a[0:3]
  s_waitcnt vmcnt(17)
  v_mfma_f32_16x16x32_bf16 a[4:7], v[32:35], v[100:103], a[4:7]
  s_barrier
  v_mfma_f32_16x16x32_bf16 a[8:11], v[32:35], v[104:107], a[8:11]
  ds_read_b64_tr_b16 v[128:129], v12 offset:32768
  v_mfma_f32_16x16x32_bf16 a[12:15], v[32:35], v[108:111], a[12:15]
  v_mfma_f32_16x16x32_bf16 a[16:19], v[32:35], v[112:115], a[16:19]
  s_mov_b32 m0, s24
  ds_read_b64_tr_b16 v[130:131], v12 offset:33792
  v_mfma_f32_16x16x32_bf16 a[20:23], v[32:35], v[116:119], a[20:23]
  buffer_load_dwordx4 v3, s[32:35], s26 offen offset:0 sc1 lds
  v_mfma_f32_16x16x32_bf16 a[24:27], v[32:35], v[120:123], a[24:27]
  ds_read_b128 v[64:67], v14 offset:32768
  v_mfma_f32_16x16x32_bf16 a[28:31], v[32:35], v[124:127], a[28:31]
  buffer_load_dwordx4 v4, s[32:35], s26 offen offset:1024 sc1 lds
  v_mfma_f32_16x16x32_bf16 a[32:35], v[36:39], v[96:99], a[32:35]
  ds_read_b64_tr_b16 v[132:133], v13 offset:32768
  v_mfma_f32_16x16x32_bf16 a[36:39], v[36:39], v[100:103], a[36:39]
  buffer_load_dwordx4 v5, s[32:35], s26 offen offset:2048 sc1 lds
  v_mfma_f32_16x16x32_bf16 a[40:43], v[36:39], v[104:107], a[40:43]
  ds_read_b64_tr_b16 v[134:135], v13 offset:33792
  v_mfma_f32_16x16x32_bf16 a[44:47], v[36:39], v[108:111], a[44:47]
  buffer_load_dwordx4 v6, s[32:35], s26 offen offset:3072 sc1 lds
  v_mfma_f32_16x16x32_bf16 a[48:51], v[36:39], v[112:115], a[48:51]
  s_add_u32 m0, s24, 16384
  ds_read_b128 v[68:71], v14 offset:33792
  v_mfma_f32_16x16x32_bf16 a[52:55], v[36:39], v[116:119], a[52:55]
  buffer_load_dwordx4 v8, s[36:39], s27 offen offset:0 lds
  v_mfma_f32_16x16x32_bf16 a[56:59], v[36:39], v[120:123], a[56:59]
  ds_read_b64_tr_b16 v[136:137], v12 offset:33024
  v_mfma_f32_16x16x32_bf16 a[60:63], v[36:39], v[124:127], a[60:63]
  buffer_load_dwordx4 v9, s[36:39], s27 offen offset:1024 lds
  v_mfma_f32_16x16x32_bf16 a[64:67], v[40:43], v[96:99], a[64:67]
  ds_read_b64_tr_b16 v[138:139], v12 offset:34048
  v_mfma_f32_16x16x32_bf16 a[68:71], v[40:43], v[100:103], a[68:71]
  buffer_load_dwordx4 v10, s[36:39], s27 offen offset:2048 lds
  v_mfma_f32_16x16x32_bf16 a[72:75], v[40:43], v[104:107], a[72:75]
  ds_read_b128 v[72:75], v14 offset:34816
  v_mfma_f32_16x16x32_bf16 a[76:79], v[40:43], v[108:111], a[76:79]
  buffer_load_dwordx4 v11, s[36:39], s27 offen offset:3072 lds
  v_mfma_f32_16x16x32_bf16 a[80:83], v[40:43], v[112:115], a[80:83]
  ds_read_b64_tr_b16 v[140:141], v13 offset:33024
  v_mfma_f32_16x16x32_bf16 a[84:87], v[40:43], v[116:119], a[84:87]
  buffer_load_dword v231, v235, s[48:51], s74 offen sc1
  v_mfma_f32_16x16x32_bf16 a[88:91], v[40:43], v[120:123], a[88:91]
  s_add_u32 s74, s74, s73
  ds_read_b64_tr_b16 v[142:143], v13 offset:34048
  v_mfma_f32_16x16x32_bf16 a[92:95], v[40:43], v[124:127], a[92:95]
  s_bitcmp1_b32 s72, s28
  v_mfma_f32_16x16x32_bf16 a[96:99], v[44:47], v[96:99], a[96:99]
  s_cbranch_scc1 fa_hk2
fa_hb2:
  ds_read_b128 v[76:79], v14 offset:35840
  v_mfma_f32_16x16x32_bf16 a[100:103], v[44:47], v[100:103], a[100:103]
  v_mfma_f32_16x16x32_bf16 a[104:107], v[44:47], v[104:107], a[104:107]
  ds_read_b64_tr_b16 v[144:145], v12 offset:33280
  v_mfma_f32_16x16x32_bf16 a[108:111], v[44:47], v[108:111], a[108:111]
  v_mfma_f32_16x16x32_bf16 a[112:115], v[44:47], v[112:115], a[112:115]
  ds_read_b64_tr_b16 v[146:147], v12 offset:34304
  v_mfma_f32_16x16x32_bf16 a[116:119], v[44:47], v[116:119], a[116:119]
  v_mfma_f32_16x16x32_bf16 a[120:123], v[44:47], v[120:123], a[120:123]
  ds_read_b128 v[80:83], v14 offset:36864
  v_mfma_f32_16x16x32_bf16 a[124:127], v[44:47], v[124:127], a[124:127]
  v_mfma_f32_16x16x32_bf16 a[128:131], v[48:51], v[96:99], a[128:131]
  ds_read_b64_tr_b16 v[148:149], v13 offset:33280
  v_mfma_f32_16x16x32_bf16 a[132:135], v[48:51], v[100:103], a[132:135]
  v_mfma_f32_16x16x32_bf16 a[136:139], v[48:51], v[104:107], a[136:139]
  ds_read_b64_tr_b16 v[150:151], v13 offset:34304
  v_mfma_f32_16x16x32_bf16 a[140:143], v[48:51], v[108:111], a[140:143]
  v_mfma_f32_16x16x32_bf16 a[144:147], v[48:51], v[112:115], a[144:147]
  ds_read_b128 v[84:87], v14 offset:37888
  v_mfma_f32_16x16x32_bf16 a[148:151], v[48:51], v[116:119], a[148:151]
  v_mfma_f32_16x16x32_bf16 a[152:155], v[48:51], v[120:123], a[152:155]
  ds_read_b64_tr_b16 v[152:153], v12 offset:33536
  v_mfma_f32_16x16x32_bf16 a[156:159], v[48:51], v[124:127], a[156:159]
  v_mfma_f32_16x16x32_bf16 a[160:163], v[52:55], v[96:99], a[160:163]
  ds_read_b64_tr_b16 v[154:155], v12 offset:34560
  v_mfma_f32_16x16x32_bf16 a[164:167], v[52:55], v[100:103], a[164:167]
  v_mfma_f32_16x16x32_bf16 a[168:171], v[52:55], v[104:107], a[168:171]
  ds_read_b128 v[88:91], v14 offset:38912
  v_mfma_f32_16x16x32_bf16 a[172:175], v[52:55], v[108:111], a[172:175]
  v_mfma_f32_16x16x32_bf16 a[176:179], v[52:55], v[112:115], a[176:179]
  ds_read_b64_tr_b16 v[156:157], v13 offset:33536
  v_mfma_f32_16x16x32_bf16 a[180:183], v[52:55], v[116:119], a[180:183]
  v_mfma_f32_16x16x32_bf16 a[184:187], v[52:55], v[120:123], a[184:187]
  ds_read_b64_tr_b16 v[158:159], v13 offset:34560
  v_mfma_f32_16x16x32_bf16 a[188:191], v[52:55], v[124:127], a[188:191]
  v_mfma_f32_16x16x32_bf16 a[192:195], v[56:59], v[96:99], a[192:195]
  s_add_u32 s26, s26, s79
  ds_read_b128 v[92:95], v14 offset:39936
  v_mfma_f32_16x16x32_bf16 a[196:199], v[56:59], v[100:103], a[196:199]
  s_add_u32 s27, s27, s25
  v_mfma_f32_16x16x32_bf16 a[200:203], v[56:59], v[104:107], a[200:203]
  s_add_u32 s24, s24, 32768
  v_mfma_f32_16x16x32_bf16 a[204:207], v[56:59], v[108:111], a[204:207]
  s_and_b32 s24, s24, 0x1ffff
  v_mfma_f32_16x16x32_bf16 a[208:211], v[56:59], v[112:115], a[208:211]
  v_xor_b32 v14, 0x10000, v14
  v_mfma_f32_16x16x32_bf16 a[212:215], v[56:59], v[116:119], a[212:215]
  v_xor_b32 v12, 0x10000, v12
  v_mfma_f32_16x16x32_bf16 a[216:219], v[56:59], v[120:123], a[216:219]
  v_xor_b32 v13, 0x10000, v13
  v_mfma_f32_16x16x32_bf16 a[220:223], v[56:59], v[124:127], a[220:223]
  v_mfma_f32_16x16x32_bf16 a[224:227], v[60:63], v[96:99], a[224:227]
  v_mfma_f32_16x16x32_bf16 a[228:231], v[60:63], v[100:103], a[228:231]
  v_mfma_f32_16x16x32_bf16 a[232:235], v[60:63], v[104:107], a[232:235]
  v_mfma_f32_16x16x32_bf16 a[236:239], v[60:63], v[108:111], a[236:239]
  v_mfma_f32_16x16x32_bf16 a[240:243], v[60:63], v[112:115], a[240:243]
  v_mfma_f32_16x16x32_bf16 a[244:247], v[60:63], v[116:119], a[244:247]
  v_mfma_f32_16x16x32_bf16 a[248:251], v[60:63], v[120:123], a[248:251]
  v_mfma_f32_16x16x32_bf16 a[252:255], v[60:63], v[124:127], a[252:255]
  s_waitcnt lgkmcnt(0)
  v_mfma_f32_16x16x32_bf16 a[0:3], v[64:67], v[128:131], a[0:3]
  s_waitcnt vmcnt(18)
  v_mfma_f32_16x16x32_bf16 a[4:7], v[64:67], v[132:135], a[4:7]
  s_barrier
  v_mfma_f32_16x16x32_bf16 a[8:11], v[64:67], v[136:139], a[8:11]
  ds_read_b64_tr_b16 v[96:97], v12 offset:0
  v_mfma_f32_16x16x32_bf16 a[12:15], v[64:67], v[140:143], a[12:15]
  v_mfma_f32_16x16x32_bf16 a[16:19], v[64:67], v[144:147], a[16:19]
  s_mov_b32 m0, s24
  ds_read_b64_tr_b16 v[98:99], v12 offset:1024
  v_mfma_f32_16x16x32_bf16 a[20:23], v[64:67], v[148:151], a[20:23]
  buffer_load_dwordx4 v3, s[32:35], s26 offen offset:0 sc1 lds
  v_mfma_f32_16x16x32_bf16 a[24:27], v[64:67], v[152:155], a[24:27]
  ds_read_b128 v[32:35], v14 offset:0
  v_mfma_f32_16x16x32_bf16 a[28:31], v[64:67], v[156:159], a[28:31]
  v_mfma_f32_16x16x32_bf16 a[32:35], v[68:71], v[128:131], a[32:35]
  ds_read_b64_tr_b16 v[100:101], v13 offset:0
  v_mfma_f32_16x16x32_bf16 a[36:39], v[68:71], v[132:135], a[36:39]
  v_mfma_f32_16x16x32_bf16 a[40:43], v[68:71], v[136:139], a[40:43]
  ds_read_b64_tr_b16 v[102:103], v13 offset:1024
  v_mfma_f32_16x16x32_bf16 a[44:47], v[68:71], v[140:143], a[44:47]
  buffer_load_dwordx4 v4, s[32:35], s26 offen offset:1024 sc1 lds
  v_mfma_f32_16x16x32_bf16 a[48:51], v[68:71], v[144:147], a[48:51]
  ds_read_b128 v[36:39], v14 offset:1024
  v_mfma_f32_16x16x32_bf16 a[52:55], v[68:71], v[148:151], a[52:55]
  v_mfma_f32_16x16x32_bf16 a[56:59], v[68:71], v[152:155], a[56:59]
  ds_read_b64_tr_b16 v[104:105], v12 offset:256
  v_mfma_f32_16x16x32_bf16 a[60:63], v[68:71], v[156:159], a[60:63]
  v_mfma_f32_16x16x32_bf16 a[64:67], v[72:75], v[128:131], a[64:67]
  ds_read_b64_tr_b16 v[106:107], v12 offset:1280
  v_mfma_f32_16x16x32_bf16 a[68:71], v[72:75], v[132:135], a[68:71]
  buffer_load_dwordx4 v5, s[32:35], s26 offen offset:2048 sc1 lds
  v_mfma_f32_16x16x32_bf16 a[72:75], v[72:75], v[136:139], a[72:75]
  ds_read_b128 v[40:43], v14 offset:2048
  v_mfma_f32_16x16x32_bf16 a[76:79], v[72:75], v[140:143], a[76:79]
  v_mfma_f32_16x16x32_bf16 a[80:83], v[72:75], v[144:147], a[80:83]
  ds_read_b64_tr_b16 v[108:109], v13 offset:256
  v_mfma_f32_16x16x32_bf16 a[84:87], v[72:75], v[148:151], a[84:87]
  v_mfma_f32_16x16x32_bf16 a[88:91], v[72:75], v[152:155], a[88:91]
  ds_read_b64_tr_b16 v[110:111], v13 offset:1280
  v_mfma_f32_16x16x32_bf16 a[92:95], v[72:75], v[156:159], a[92:95]
  buffer_load_dwordx4 v6, s[32:35], s26 offen offset:3072 sc1 lds
  v_mfma_f32_16x16x32_bf16 a[96:99], v[76:79], v[128:131], a[96:99]
  ds_read_b128 v[44:47], v14 offset:3072
  v_mfma_f32_16x16x32_bf16 a[100:103], v[76:79], v[132:135], a[100:103]
  v_mfma_f32_16x16x32_bf16 a[104:107], v[76:79], v[136:139], a[104:107]
  ds_read_b64_tr_b16 v[112:113], v12 offset:512
  v_mfma_f32_16x16x32_bf16 a[108:111], v[76:79], v[140:143], a[108:111]
  v_mfma_f32_16x16x32_bf16 a[112:115], v[76:79], v[144:147], a[112:115]
  s_add_u32 m0, s24, 16384
  ds_read_b64_tr_b16 v[114:115], v12 offset:1536
  v_mfma_f32_16x16x32_bf16 a[116:119], v[76:79], v[148:151], a[116:119]
  buffer_load_dwordx4 v8, s[36:39], s27 offen offset:0 lds
  v_mfma_f32_16x16x32_bf16 a[120:123], v[76:79], v[152:155], a[120:123]
  ds_read_b128 v[48:51], v14 offset:4096
  v_mfma_f32_16x16x32_bf16 a[124:127], v[76:79], v[156:159], a[124:127]
  v_mfma_f32_16x16x32_bf16 a[128:131], v[80:83], v[128:131], a[128:131]
  ds_read_b64_tr_b16 v[116:117], v13 offset:512
  v_mfma_f32_16x16x32_bf16 a[132:135], v[80:83], v[132:135], a[132:135]
  v_mfma_f32_16x16x32_bf16 a[136:139], v[80:83], v[136:139], a[136:139]
  ds_read_b64_tr_b16 v[118:119], v13 offset:1536
  v_mfma_f32_16x16x32_bf16 a[140:143], v[80:83], v[140:143], a[140:143]
  buffer_load_dwordx4 v9, s[36:39], s27 offen offset:1024 lds
  v_mfma_f32_16x16x32_bf16 a[144:147], v[80:83], v[144:147], a[144:147]
  ds_read_b128 v[52:55], v14 offset:5120
  v_mfma_f32_16x16x32_bf16 a[148:151], v[80:83], v[148:151], a[148:151]
  v_mfma_f32_16x16x32_bf16 a[152:155], v[80:83], v[152:155], a[152:155]
  ds_read_b64_tr_b16 v[120:121], v12 offset:768
  v_mfma_f32_16x16x32_bf16 a[156:159], v[80:83], v[156:159], a[156:159]
  v_mfma_f32_16x16x32_bf16 a[160:163], v[84:87], v[128:131], a[160:163]
  ds_read_b64_tr_b16 v[122:123], v12 offset:1792
  v_mfma_f32_16x16x32_bf16 a[164:167], v[84:87], v[132:135], a[164:167]
  buffer_load_dwordx4 v10, s[36:39], s27 offen offset:2048 lds
  v_mfma_f32_16x16x32_bf16 a[168:171], v[84:87], v[136:139], a[168:171]
  ds_read_b128 v[56:59], v14 offset:6144
  v_mfma_f32_16x16x32_bf16 a[172:175], v[84:87], v[140:143], a[172:175]
  v_mfma_f32_16x16x32_bf16 a[176:179], v[84:87], v[144:147], a[176:179]
  ds_read_b64_tr_b16 v[124:125], v13 offset:768
  v_mfma_f32_16x16x32_bf16 a[180:183], v[84:87], v[148:151], a[180:183]
  v_mfma_f32_16x16x32_bf16 a[184:187], v[84:87], v[152:155], a[184:187]
  ds_read_b64_tr_b16 v[126:127], v13 offset:1792
  v_mfma_f32_16x16x32_bf16 a[188:191], v[84:87], v[156:159], a[188:191]
  buffer_load_dwordx4 v11, s[36:39], s27 offen offset:3072 lds
  v_mfma_f32_16x16x32_bf16 a[192:195], v[88:91], v[128:131], a[192:195]
  s_add_u32 s26, s26, s79
  ds_read_b128 v[60:63], v14 offset:7168
  v_mfma_f32_16x16x32_bf16 a[196:199], v[88:91], v[132:135], a[196:199]
  s_add_u32 s27, s27, s25
  v_mfma_f32_16x16x32_bf16 a[200:203], v[88:91], v[136:139], a[200:203]
  s_add_u32 s24, s24, 32768
  v_mfma_f32_16x16x32_bf16 a[204:207], v[88:91], v[140:143], a[204:207]
  s_and_b32 s24, s24, 0x1ffff
  v_mfma_f32_16x16x32_bf16 a[208:211], v[88:91], v[144:147], a[208:211]
  v_mfma_f32_16x16x32_bf16 a[212:215], v[88:91], v[148:151], a[212:215]
  s_bitcmp1_b32 s76, s28
  v_mfma_f32_16x16x32_bf16 a[216:219], v[88:91], v[152:155], a[216:219]
  s_cbranch_scc1 fa_hk3
fa_hb3:
  v_mfma_f32_16x16x32_bf16 a[220:223], v[88:91], v[156:159], a[220:223]
  v_mfma_f32_16x16x32_bf16 a[224:227], v[92:95], v[128:131], a[224:227]
  v_mfma_f32_16x16x32_bf16 a[228:231], v[92:95], v[132:135], a[228:231]
  s_add_u32 s28, s28, 1
  v_mfma_f32_16x16x32_bf16 a[232:235], v[92:95], v[136:139], a[232:235]
  v_mfma_f32_16x16x32_bf16 a[236:239], v[92:95], v[140:143], a[236:239]
  v_mfma_f32_16x16x32_bf16 a[240:243], v[92:95], v[144:147], a[240:243]
  v_mfma_f32_16x16x32_bf16 a[244:247], v[92:95], v[148:151], a[244:247]
  s_cmp_lt_u32 s28, 8
  v_mfma_f32_16x16x32_bf16 a[248:251], v[92:95], v[152:155], a[248:251]
  s_waitcnt lgkmcnt(0)
  v_mfma_f32_16x16x32_bf16 a[252:255], v[92:95], v[156:159], a[252:255]
  s_cbranch_scc1 fa_loopV
  s_mov_b32 s60, 8192
  s_mov_b32 s61, 2048
  s_mov_b32 s62, 33554432
  s_mov_b32 s76, 1.0
fa_p1epi:
  s_lshr_b32 s23, s20, 1
  s_lshl_b32 s23, s23, 13
  v_subrev_u32 v12, s23, v12
  v_subrev_u32 v13, s23, v13
  s_lshl_b32 s24, s20, 12
  v_add_u32 v14, s24, v2
  ds_read_b64_tr_b16 v[32:33], v12 offset:0
  ds_read_b64_tr_b16 v[34:35], v12 offset:1024
  ds_read_b64_tr_b16 v[36:37], v13 offset:0
  ds_read_b64_tr_b16 v[38:39], v13 offset:1024
  ds_read_b64_tr_b16 v[40:41], v12 offset:256
  ds_read_b64_tr_b16 v[42:43], v12 offset:1280
  ds_read_b64_tr_b16 v[44:45], v13 offset:256
  ds_read_b64_tr_b16 v[46:47], v13 offset:1280
  ds_read_b64_tr_b16 v[48:49], v12 offset:512
  ds_read_b64_tr_b16 v[50:51], v12 offset:1536
  ds_read_b64_tr_b16 v[52:53], v13 offset:512
  ds_read_b64_tr_b16 v[54:55], v13 offset:1536
  ds_read_b64_tr_b16 v[56:57], v12 offset:768
  ds_read_b64_tr_b16 v[58:59], v12 offset:1792
  ds_read_b64_tr_b16 v[60:61], v13 offset:768
  ds_read_b64_tr_b16 v[62:63], v13 offset:1792
  s_waitcnt vmcnt(8)
  ds_read_b128 v[224:227], v14 offset:0
  ds_read_b128 v[228:231], v14 offset:1024
  ds_read_b128 v[232:235], v14 offset:2048
  ds_read_b128 v[236:239], v14 offset:3072
  s_lshl_b32 s23, s21, 19
  s_add_u32 s62, s62, s23
  s_lshl_b32 s23, s22, 16
  s_add_u32 s62, s62, s23
  s_and_b32 s23, s20, 1
  s_lshl_b32 s23, s23, 15
  s_add_u32 s62, s62, s23
  s_lshl_b32 s23, s21, 19
  s_add_u32 s23, s23, 16777216
  s_add_u32 s6, s18, s23
  s_addc_u32 s7, s19, 0
  s_add_u32 s8, s6, 16777216
  s_addc_u32 s9, s7, 0
  s_sub_u32 s23, 16, s22
  s_lshl_b32 s23, s23, 15
  s_mov_b32 s44, s6
  s_mov_b32 s45, s7
  s_mov_b32 s46, s23
  s_mov_b32 s47, 0x20000
  s_mov_b32 s48, s8
  s_mov_b32 s49, s9
  s_mov_b32 s50, s23
  s_mov_b32 s51, 0x20000
  s_lshl_b32 s30, s21, 7
  s_add_u32 s30, s30, 2637824
  s_mov_b32 s81, 0x47800000
  s_cmp_eq_u32 s20, 0
  s_cselect_b32 s29, s82, 1073741824
  s_waitcnt vmcnt(21) lgkmcnt(0)
  v_mfma_f32_16x16x32_bf16 v[96:99], v[32:35], v[224:227], 0
  s_mul_i32 s63, s60, 0
  v_accvgpr_read_b32 v16, a0
  v_accvgpr_read_b32 v17, a1
  v_accvgpr_read_b32 v18, a2
  v_mfma_f32_16x16x32_bf16 v[112:115], v[36:39], v[224:227], 0
  s_add_u32 s63, s63, s62
  ds_read_b64_tr_b16 v[64:65], v12 offset:8192
  v_accvgpr_read_b32 v19, a3
  v_accvgpr_read_b32 v20, a32
  v_mfma_f32_16x16x32_bf16 v[128:131], v[40:43], v[224:227], 0
  s_add_u32 m0, s24, 0
  ds_read_b64_tr_b16 v[66:67], v12 offset:9216
  v_accvgpr_read_b32 v21, a33
  v_accvgpr_read_b32 v22, a34
  v_mfma_f32_16x16x32_bf16 v[144:147], v[44:47], v[224:227], 0
  buffer_load_dwordx4 v3, s[32:35], s26 offen offset:0 sc1 lds
  v_accvgpr_read_b32 v23, a35
  v_mul_f32 v16, s76, v16
  v_mfma_f32_16x16x32_bf16 v[160:163], v[48:51], v[224:227], 0
  ds_read_b64_tr_b16 v[68:69], v13 offset:8192
  v_mul_f32 v17, s76, v17
  v_mul_f32 v18, s76, v18
  v_mfma_f32_16x16x32_bf16 v[176:179], v[52:55], v[224:227], 0
  ds_read_b64_tr_b16 v[70:71], v13 offset:9216
  v_mul_f32 v19, s76, v19
  v_mul_f32 v20, s76, v20
  v_mfma_f32_16x16x32_bf16 v[192:195], v[56:59], v[224:227], 0
  ds_read_b64_tr_b16 v[72:73], v12 offset:8448
  v_mul_f32 v21, s76, v21
  v_mul_f32 v22, s76, v22
  v_mfma_f32_16x16x32_bf16 v[208:211], v[60:63], v[224:227], 0
  ds_read_b64_tr_b16 v[74:75], v12 offset:9472
  v_mul_f32 v23, s76, v23
  v_cvt_pk_bf16_f32 v24, v16, v17
  v_mfma_f32_16x16x32_bf16 v[100:103], v[32:35], v[228:231], 0
  buffer_load_dwordx4 v4, s[32:35], s26 offen offset:1024 sc1 lds
  v_cvt_pk_bf16_f32 v25, v18, v19
  v_cvt_pk_bf16_f32 v26, v20, v21
  v_mfma_f32_16x16x32_bf16 v[116:119], v[36:39], v[228:231], 0
  ds_read_b64_tr_b16 v[76:77], v13 offset:8448
  v_cvt_pk_bf16_f32 v27, v22, v23
  v_mfma_f32_16x16x32_bf16 v[132:135], v[40:43], v[228:231], 0
  ds_read_b64_tr_b16 v[78:79], v13 offset:9472
  buffer_store_dwordx4 v[24:27], v2, s[40:43], s63 offen offset:0 sc1
  v_accvgpr_read_b32 v16, a4
  v_mfma_f32_16x16x32_bf16 v[148:151], v[44:47], v[228:231], 0
  ds_read_b128 v[240:243], v14 offset:32768
  v_accvgpr_read_b32 v17, a5
  v_accvgpr_read_b32 v18, a6
  v_mfma_f32_16x16x32_bf16 v[164:167], v[48:51], v[228:231], 0
  ds_read_b128 v[244:247], v14 offset:33792
  v_accvgpr_read_b32 v19, a7
  v_accvgpr_read_b32 v20, a36
  v_mfma_f32_16x16x32_bf16 v[180:183], v[52:55], v[228:231], 0
  buffer_load_dwordx4 v5, s[32:35], s26 offen offset:2048 sc1 lds
  v_accvgpr_read_b32 v21, a37
  v_accvgpr_read_b32 v22, a38
  v_mfma_f32_16x16x32_bf16 v[196:199], v[56:59], v[228:231], 0
  ds_read_b64_tr_b16 v[80:81], v12 offset:8704
  v_accvgpr_read_b32 v23, a39
  v_mul_f32 v16, s76, v16
  v_mfma_f32_16x16x32_bf16 v[212:215], v[60:63], v[228:231], 0
  ds_read_b64_tr_b16 v[82:83], v12 offset:9728
  v_mul_f32 v17, s76, v17
  v_mul_f32 v18, s76, v18
  v_mfma_f32_16x16x32_bf16 v[104:107], v[32:35], v[232:235], 0
  ds_read_b64_tr_b16 v[84:85], v13 offset:8704
  v_mul_f32 v19, s76, v19
  v_mul_f32 v20, s76, v20
  v_mfma_f32_16x16x32_bf16 v[120:123], v[36:39], v[232:235], 0
  ds_read_b64_tr_b16 v[86:87], v13 offset:9728
  v_mul_f32 v21, s76, v21
  v_mul_f32 v22, s76, v22
  v_mfma_f32_16x16x32_bf16 v[136:139], v[40:43], v[232:235], 0
  buffer_load_dwordx4 v6, s[32:35], s26 offen offset:3072 sc1 lds
  v_mul_f32 v23, s76, v23
  v_cvt_pk_bf16_f32 v28, v16, v17
  v_mfma_f32_16x16x32_bf16 v[152:155], v[44:47], v[232:235], 0
  s_add_u32 s26, s26, 1024
  ds_read_b64_tr_b16 v[88:89], v12 offset:8960
  v_cvt_pk_bf16_f32 v29, v18, v19
  v_cvt_pk_bf16_f32 v30, v20, v21
  v_mfma_f32_16x16x32_bf16 v[168:171], v[48:51], v[232:235], 0
  ds_read_b64_tr_b16 v[90:91], v12 offset:9984
  v_cvt_pk_bf16_f32 v31, v22, v23
  v_mfma_f32_16x16x32_bf16 v[184:187], v[52:55], v[232:235], 0
  ds_read_b64_tr_b16 v[92:93], v13 offset:8960
  buffer_store_dwordx4 v[28:31], v2, s[40:43], s63 offen offset:1024 sc1
  v_accvgpr_read_b32 v16, a8
  v_mfma_f32_16x16x32_bf16 v[200:203], v[56:59], v[232:235], 0
  s_add_u32 s63, s63, s61
  ds_read_b64_tr_b16 v[94:95], v13 offset:9984
  v_accvgpr_read_b32 v17, a9
  v_accvgpr_read_b32 v18, a10
  v_mfma_f32_16x16x32_bf16 v[216:219], v[60:63], v[232:235], 0
  v_accvgpr_read_b32 v19, a11
  v_accvgpr_read_b32 v20, a40
  v_accvgpr_read_b32 v21, a41
  v_mfma_f32_16x16x32_bf16 v[108:111], v[32:35], v[236:239], 0
  ds_read_b128 v[248:251], v14 offset:34816
  v_accvgpr_read_b32 v22, a42
  v_accvgpr_read_b32 v23, a43
  v_mfma_f32_16x16x32_bf16 v[124:127], v[36:39], v[236:239], 0
  ds_read_b128 v[252:255], v14 offset:35840
  v_mul_f32 v16, s76, v16
  v_mul_f32 v17, s76, v17
  v_mfma_f32_16x16x32_bf16 v[140:143], v[40:43], v[236:239], 0
  v_mul_f32 v18, s76, v18
  v_mul_f32 v19, s76, v19
  v_mul_f32 v20, s76, v20
  v_mfma_f32_16x16x32_bf16 v[156:159], v[44:47], v[236:239], 0
  v_xor_b32 v14, 0x10000, v14
  v_mul_f32 v21, s76, v21
  v_mul_f32 v22, s76, v22
  v_mfma_f32_16x16x32_bf16 v[172:175], v[48:51], v[236:239], 0
  v_mul_f32 v23, s76, v23
  v_cvt_pk_bf16_f32 v24, v16, v17
  v_cvt_pk_bf16_f32 v25, v18, v19
  v_mfma_f32_16x16x32_bf16 v[188:191], v[52:55], v[236:239], 0
  v_cvt_pk_bf16_f32 v26, v20, v21
  v_cvt_pk_bf16_f32 v27, v22, v23
  v_mfma_f32_16x16x32_bf16 v[204:207], v[56:59], v[236:239], 0
  buffer_store_dwordx4 v[24:27], v2, s[40:43], s63 offen offset:0 sc1
  v_mfma_f32_16x16x32_bf16 v[220:223], v[60:63], v[236:239], 0
  s_waitcnt vmcnt(20) lgkmcnt(0)
  v_mfma_f32_16x16x32_bf16 v[96:99], v[64:67], v[240:243], v[96:99]
  s_barrier
  v_accvgpr_read_b32 v16, a12
  v_accvgpr_read_b32 v17, a13
  v_accvgpr_read_b32 v18, a14
  v_accvgpr_read_b32 v19, a15
  v_mfma_f32_16x16x32_bf16 v[112:115], v[68:71], v[240:243], v[112:115]
  ds_read_b64_tr_b16 v[32:33], v12 offset:32768
  v_accvgpr_read_b32 v20, a44
  v_accvgpr_read_b32 v21, a45
  v_mfma_f32_16x16x32_bf16 v[128:131], v[72:75], v[240:243], v[128:131]
  s_add_u32 m0, s24, 32768
  ds_read_b64_tr_b16 v[34:35], v12 offset:33792
  v_accvgpr_read_b32 v22, a46
  v_accvgpr_read_b32 v23, a47
  v_mfma_f32_16x16x32_bf16 v[144:147], v[76:79], v[240:243], v[144:147]
  buffer_load_dwordx4 v3, s[32:35], s26 offen offset:0 sc1 lds
  v_mul_f32 v16, s76, v16
  v_mul_f32 v17, s76, v17
  v_mfma_f32_16x16x32_bf16 v[160:163], v[80:83], v[240:243], v[160:163]
  ds_read_b64_tr_b16 v[36:37], v13 offset:32768
  v_mul_f32 v18, s76, v18
  v_mul_f32 v19, s76, v19
  v_mfma_f32_16x16x32_bf16 v[176:179], v[84:87], v[240:243], v[176:179]
  ds_read_b64_tr_b16 v[38:39], v13 offset:33792
  v_mul_f32 v20, s76, v20
  v_mul_f32 v21, s76, v21
  v_mfma_f32_16x16x32_bf16 v[192:195], v[88:91], v[240:243], v[192:195]
  ds_read_b64_tr_b16 v[40:41], v12 offset:33024
  v_mul_f32 v22, s76, v22
  v_mul_f32 v23, s76, v23
  v_mfma_f32_16x16x32_bf16 v[208:211], v[92:95], v[240:243], v[208:211]
  ds_read_b64_tr_b16 v[42:43], v12 offset:34048
  v_cvt_pk_bf16_f32 v28, v16, v17
  v_cvt_pk_bf16_f32 v29, v18, v19
  v_mfma_f32_16x16x32_bf16 v[100:103], v[64:67], v[244:247], v[100:103]
  buffer_load_dwordx4 v4, s[32:35], s26 offen offset:1024 sc1 lds
  v_cvt_pk_bf16_f32 v30, v20, v21
  v_cvt_pk_bf16_f32 v31, v22, v23
  v_mfma_f32_16x16x32_bf16 v[116:119], v[68:71], v[244:247], v[116:119]
  ds_read_b64_tr_b16 v[44:45], v13 offset:33024
  buffer_store_dwordx4 v[28:31], v2, s[40:43], s63 offen offset:1024 sc1
  v_accvgpr_read_b32 v16, a16
  v_mfma_f32_16x16x32_bf16 v[132:135], v[72:75], v[244:247], v[132:135]
  s_add_u32 s63, s63, s61
  ds_read_b64_tr_b16 v[46:47], v13 offset:34048
  v_accvgpr_read_b32 v17, a17
  v_accvgpr_read_b32 v18, a18
  v_mfma_f32_16x16x32_bf16 v[148:151], v[76:79], v[244:247], v[148:151]
  ds_read_b128 v[224:227], v14 offset:0
  v_accvgpr_read_b32 v19, a19
  v_accvgpr_read_b32 v20, a48
  v_mfma_f32_16x16x32_bf16 v[164:167], v[80:83], v[244:247], v[164:167]
  ds_read_b128 v[228:231], v14 offset:1024
  v_accvgpr_read_b32 v21, a49
  v_accvgpr_read_b32 v22, a50
  v_mfma_f32_16x16x32_bf16 v[180:183], v[84:87], v[244:247], v[180:183]
  buffer_load_dwordx4 v5, s[32:35], s26 offen offset:2048 sc1 lds
  v_accvgpr_read_b32 v23, a51
  v_mul_f32 v16, s76, v16
  v_mfma_f32_16x16x32_bf16 v[196:199], v[88:91], v[244:247], v[196:199]
  ds_read_b64_tr_b16 v[48:49], v12 offset:33280
  v_mul_f32 v17, s76, v17
  v_mul_f32 v18, s76, v18
  v_mfma_f32_16x16x32_bf16 v[212:215], v[92:95], v[244:247], v[212:215]
  ds_read_b64_tr_b16 v[50:51], v12 offset:34304
  v_mul_f32 v19, s76, v19
  v_mul_f32 v20, s76, v20
  v_mfma_f32_16x16x32_bf16 v[104:107], v[64:67], v[248:251], v[104:107]
  ds_read_b64_tr_b16 v[52:53], v13 offset:33280
  v_mul_f32 v21, s76, v21
  v_mul_f32 v22, s76, v22
  v_mfma_f32_16x16x32_bf16 v[120:123], v[68:71], v[248:251], v[120:123]
  ds_read_b64_tr_b16 v[54:55], v13 offset:34304
  v_mul_f32 v23, s76, v23
  v_cvt_pk_bf16_f32 v24, v16, v17
  v_mfma_f32_16x16x32_bf16 v[136:139], v[72:75], v[248:251], v[136:139]
  buffer_load_dwordx4 v6, s[32:35], s26 offen offset:3072 sc1 lds
  v_cvt_pk_bf16_f32 v25, v18, v19
  v_cvt_pk_bf16_f32 v26, v20, v21
  v_mfma_f32_16x16x32_bf16 v[152:155], v[76:79], v[248:251], v[152:155]
  s_add_u32 s26, s26, 1024
  ds_read_b64_tr_b16 v[56:57], v12 offset:33536
  v_cvt_pk_bf16_f32 v27, v22, v23
  v_mfma_f32_16x16x32_bf16 v[168:171], v[80:83], v[248:251], v[168:171]
  ds_read_b64_tr_b16 v[58:59], v12 offset:34560
  buffer_store_dwordx4 v[24:27], v2, s[40:43], s63 offen offset:0 sc1
  v_accvgpr_read_b32 v16, a20
  v_mfma_f32_16x16x32_bf16 v[184:187], v[84:87], v[248:251], v[184:187]
  ds_read_b64_tr_b16 v[60:61], v13 offset:33536
  v_accvgpr_read_b32 v17, a21
  v_accvgpr_read_b32 v18, a22
  v_mfma_f32_16x16x32_bf16 v[200:203], v[88:91], v[248:251], v[200:203]
  s_add_u32 m0, s24, 16384
  ds_read_b64_tr_b16 v[62:63], v13 offset:34560
  v_accvgpr_read_b32 v19, a23
  v_accvgpr_read_b32 v20, a52
  v_mfma_f32_16x16x32_bf16 v[216:219], v[92:95], v[248:251], v[216:219]
  buffer_load_dwordx4 v8, s[36:39], s27 offen offset:0 lds
  v_accvgpr_read_b32 v21, a53
  v_accvgpr_read_b32 v22, a54
  v_mfma_f32_16x16x32_bf16 v[108:111], v[64:67], v[252:255], v[108:111]
  ds_read_b128 v[232:235], v14 offset:2048
  v_accvgpr_read_b32 v23, a55
  v_mul_f32 v16, s76, v16
  v_mfma_f32_16x16x32_bf16 v[124:127], v[68:71], v[252:255], v[124:127]
  ds_read_b128 v[236:239], v14 offset:3072
  v_mul_f32 v17, s76, v17
  v_mul_f32 v18, s76, v18
  v_mfma_f32_16x16x32_bf16 v[140:143], v[72:75], v[252:255], v[140:143]
  v_mul_f32 v19, s76, v19
  v_mul_f32 v20, s76, v20
  v_mul_f32 v21, s76, v21
  v_mfma_f32_16x16x32_bf16 v[156:159], v[76:79], v[252:255], v[156:159]
  v_mul_f32 v22, s76, v22
  v_mul_f32 v23, s76, v23
  v_cvt_pk_bf16_f32 v28, v16, v17
  v_mfma_f32_16x16x32_bf16 v[172:175], v[80:83], v[252:255], v[172:175]
  buffer_load_dwordx4 v9, s[36:39], s27 offen offset:1024 lds
  v_cvt_pk_bf16_f32 v29, v18, v19
  v_cvt_pk_bf16_f32 v30, v20, v21
  v_mfma_f32_16x16x32_bf16 v[188:191], v[84:87], v[252:255], v[188:191]
  v_cvt_pk_bf16_f32 v31, v22, v23
  v_mfma_f32_16x16x32_bf16 v[204:207], v[88:91], v[252:255], v[204:207]
  buffer_store_dwordx4 v[28:31], v2, s[40:43], s63 offen offset:1024 sc1
  v_mfma_f32_16x16x32_bf16 v[220:223], v[92:95], v[252:255], v[220:223]
  s_waitcnt vmcnt(20) lgkmcnt(0)
  v_mfma_f32_16x16x32_bf16 v[96:99], v[32:35], v[224:227], v[96:99]
  s_add_u32 s63, s63, s61
  v_accvgpr_read_b32 v16, a24
  v_accvgpr_read_b32 v17, a25
  v_accvgpr_read_b32 v18, a26
  v_accvgpr_read_b32 v19, a27
  v_mfma_f32_16x16x32_bf16 v[112:115], v[36:39], v[224:227], v[112:115]
  ds_read_b64_tr_b16 v[64:65], v12 offset:40960
  v_accvgpr_read_b32 v20, a56
  v_accvgpr_read_b32 v21, a57
  v_mfma_f32_16x16x32_bf16 v[128:131], v[40:43], v[224:227], v[128:131]
  s_add_u32 m0, s24, 65536
  ds_read_b64_tr_b16 v[66:67], v12 offset:41984
  v_accvgpr_read_b32 v22, a58
  v_accvgpr_read_b32 v23, a59
  v_mfma_f32_16x16x32_bf16 v[144:147], v[44:47], v[224:227], v[144:147]
  buffer_load_dwordx4 v3, s[32:35], s26 offen offset:0 sc1 lds
  v_mul_f32 v16, s76, v16
  v_mul_f32 v17, s76, v17
  v_mfma_f32_16x16x32_bf16 v[160:163], v[48:51], v[224:227], v[160:163]
  ds_read_b64_tr_b16 v[68:69], v13 offset:40960
  v_mul_f32 v18, s76, v18
  v_mul_f32 v19, s76, v19
  v_mfma_f32_16x16x32_bf16 v[176:179], v[52:55], v[224:227], v[176:179]
  ds_read_b64_tr_b16 v[70:71], v13 offset:41984
  v_mul_f32 v20, s76, v20
  v_mul_f32 v21, s76, v21
  v_mfma_f32_16x16x32_bf16 v[192:195], v[56:59], v[224:227], v[192:195]
  ds_read_b64_tr_b16 v[72:73], v12 offset:41216
  v_mul_f32 v22, s76, v22
  v_mul_f32 v23, s76, v23
  v_mfma_f32_16x16x32_bf16 v[208:211], v[60:63], v[224:227], v[208:211]
  ds_read_b64_tr_b16 v[74:75], v12 offset:42240
  v_cvt_pk_bf16_f32 v24, v16, v17
  v_cvt_pk_bf16_f32 v25, v18, v19
  v_cvt_pk_bf16_f32 v26, v20, v21
  v_mfma_f32_16x16x32_bf16 v[100:103], v[32:35], v[228:231], v[100:103]
  buffer_load_dwordx4 v4, s[32:35], s26 offen offset:1024 sc1 lds
  v_cvt_pk_bf16_f32 v27, v22, v23
  v_mfma_f32_16x16x32_bf16 v[116:119], v[36:39], v[228:231], v[116:119]
  ds_read_b64_tr_b16 v[76:77], v13 offset:41216
  buffer_store_dwordx4 v[24:27], v2, s[40:43], s63 offen offset:0 sc1
  v_accvgpr_read_b32 v16, a28
  v_mfma_f32_16x16x32_bf16 v[132:135], v[40:43], v[228:231], v[132:135]
  ds_read_b64_tr_b16 v[78:79], v13 offset:42240
  v_accvgpr_read_b32 v17, a29
  v_accvgpr_read_b32 v18, a30
  v_mfma_f32_16x16x32_bf16 v[148:151], v[44:47], v[228:231], v[148:151]
  ds_read_b128 v[240:243], v14 offset:32768
  v_accvgpr_read_b32 v19, a31
  v_accvgpr_read_b32 v20, a60
  v_mfma_f32_16x16x32_bf16 v[164:167], v[48:51], v[228:231], v[164:167]
  ds_read_b128 v[244:247], v14 offset:33792
  v_accvgpr_read_b32 v21, a61
  v_accvgpr_read_b32 v22, a62
  v_mfma_f32_16x16x32_bf16 v[180:183], v[52:55], v[228:231], v[180:183]
  buffer_load_dwordx4 v5, s[32:35], s26 offen offset:2048 sc1 lds
  v_accvgpr_read_b32 v23, a63
  v_mul_f32 v16, s76, v16
  v_mfma_f32_16x16x32_bf16 v[196:199], v[56:59], v[228:231], v[196:199]
  ds_read_b64_tr_b16 v[80:81], v12 offset:41472
  v_mul_f32 v17, s76, v17
  v_mul_f32 v18, s76, v18
  v_mfma_f32_16x16x32_bf16 v[212:215], v[60:63], v[228:231], v[212:215]
  ds_read_b64_tr_b16 v[82:83], v12 offset:42496
  v_mul_f32 v19, s76, v19
  v_mul_f32 v20, s76, v20
  v_mul_f32 v21, s76, v21
  v_mfma_f32_16x16x32_bf16 v[104:107], v[32:35], v[232:235], v[104:107]
  ds_read_b64_tr_b16 v[84:85], v13 offset:41472
  v_mul_f32 v22, s76, v22
  v_mul_f32 v23, s76, v23
  v_mfma_f32_16x16x32_bf16 v[120:123], v[36:39], v[232:235], v[120:123]
  ds_read_b64_tr_b16 v[86:87], v13 offset:42496
  v_cvt_pk_bf16_f32 v28, v16, v17
  v_cvt_pk_bf16_f32 v29, v18, v19
  v_mfma_f32_16x16x32_bf16 v[136:139], v[40:43], v[232:235], v[136:139]
  buffer_load_dwordx4 v6, s[32:35], s26 offen offset:3072 sc1 lds
  v_cvt_pk_bf16_f32 v30, v20, v21
  v_cvt_pk_bf16_f32 v31, v22, v23
  v_mfma_f32_16x16x32_bf16 v[152:155], v[44:47], v[232:235], v[152:155]
  s_add_u32 s26, s26, 1024
  ds_read_b64_tr_b16 v[88:89], v12 offset:41728
  buffer_store_dwordx4 v[28:31], v2, s[40:43], s63 offen offset:1024 sc1
  v_accvgpr_read_b32 v16, a64
  v_mfma_f32_16x16x32_bf16 v[168:171], v[48:51], v[232:235], v[168:171]
  s_mul_i32 s63, s60, 1
  ds_read_b64_tr_b16 v[90:91], v12 offset:42752
  v_accvgpr_read_b32 v17, a65
  v_accvgpr_read_b32 v18, a66
  v_mfma_f32_16x16x32_bf16 v[184:187], v[52:55], v[232:235], v[184:187]
  s_add_u32 s63, s63, s62
  ds_read_b64_tr_b16 v[92:93], v13 offset:41728
  v_accvgpr_read_b32 v19, a67
  v_accvgpr_read_b32 v20, a96
  v_mfma_f32_16x16x32_bf16 v[200:203], v[56:59], v[232:235], v[200:203]
  s_add_u32 m0, s24, 16384
  ds_read_b64_tr_b16 v[94:95], v13 offset:42752
  v_accvgpr_read_b32 v21, a97
  v_accvgpr_read_b32 v22, a98
  v_accvgpr_read_b32 v23, a99
  v_mfma_f32_16x16x32_bf16 v[216:219], v[60:63], v[232:235], v[216:219]
  buffer_load_dwordx4 v10, s[36:39], s27 offen offset:2048 lds
  v_mul_f32 v16, s76, v16
  v_mul_f32 v17, s76, v17
  v_mfma_f32_16x16x32_bf16 v[108:111], v[32:35], v[236:239], v[108:111]
  ds_read_b128 v[248:251], v14 offset:34816
  v_mul_f32 v18, s76, v18
  v_mul_f32 v19, s76, v19
  v_mfma_f32_16x16x32_bf16 v[124:127], v[36:39], v[236:239], v[124:127]
  ds_read_b128 v[252:255], v14 offset:35840
  v_mul_f32 v20, s76, v20
  v_mul_f32 v21, s76, v21
  v_mfma_f32_16x16x32_bf16 v[140:143], v[40:43], v[236:239], v[140:143]
  v_mul_f32 v22, s76, v22
  v_mul_f32 v23, s76, v23
  v_cvt_pk_bf16_f32 v24, v16, v17
  v_mfma_f32_16x16x32_bf16 v[156:159], v[44:47], v[236:239], v[156:159]
  v_xor_b32 v14, 0x10000, v14
  v_cvt_pk_bf16_f32 v25, v18, v19
  v_cvt_pk_bf16_f32 v26, v20, v21
  v_mfma_f32_16x16x32_bf16 v[172:175], v[48:51], v[236:239], v[172:175]
  buffer_load_dwordx4 v11, s[36:39], s27 offen offset:3072 lds
  v_cvt_pk_bf16_f32 v27, v22, v23
  v_mfma_f32_16x16x32_bf16 v[188:191], v[52:55], v[236:239], v[188:191]
  s_add_u32 s27, s27, 524288
  buffer_store_dwordx4 v[24:27], v2, s[40:43], s63 offen offset:0 sc1
  v_xor_b32 v12, 0x10000, v12
  v_mfma_f32_16x16x32_bf16 v[204:207], v[56:59], v[236:239], v[204:207]
  v_xor_b32 v13, 0x10000, v13
  v_mfma_f32_16x16x32_bf16 v[220:223], v[60:63], v[236:239], v[220:223]
  s_waitcnt vmcnt(20) lgkmcnt(0)
  v_mfma_f32_16x16x32_bf16 v[96:99], v[64:67], v[240:243], v[96:99]
  s_barrier
  v_accvgpr_read_b32 v16, a68
  v_accvgpr_read_b32 v17, a69
  v_accvgpr_read_b32 v18, a70
  v_accvgpr_read_b32 v19, a71
  v_mfma_f32_16x16x32_bf16 v[112:115], v[68:71], v[240:243], v[112:115]
  ds_read_b64_tr_b16 v[32:33], v12 offset:0
  v_accvgpr_read_b32 v20, a100
  v_accvgpr_read_b32 v21, a101
  v_mfma_f32_16x16x32_bf16 v[128:131], v[72:75], v[240:243], v[128:131]
  s_add_u32 m0, s24, 98304
  ds_read_b64_tr_b16 v[34:35], v12 offset:1024
  v_accvgpr_read_b32 v22, a102
  v_accvgpr_read_b32 v23, a103
  v_mfma_f32_16x16x32_bf16 v[144:147], v[76:79], v[240:243], v[144:147]
  buffer_load_dwordx4 v3, s[32:35], s26 offen offset:0 sc1 lds
  v_mul_f32 v16, s76, v16
  v_mul_f32 v17, s76, v17
  v_mfma_f32_16x16x32_bf16 v[160:163], v[80:83], v[240:243], v[160:163]
  ds_read_b64_tr_b16 v[36:37], v13 offset:0
  v_mul_f32 v18, s76, v18
  v_mul_f32 v19, s76, v19
  v_mfma_f32_16x16x32_bf16 v[176:179], v[84:87], v[240:243], v[176:179]
  ds_read_b64_tr_b16 v[38:39], v13 offset:1024
  v_mul_f32 v20, s76, v20
  v_mul_f32 v21, s76, v21
  v_mfma_f32_16x16x32_bf16 v[192:195], v[88:91], v[240:243], v[192:195]
  ds_read_b64_tr_b16 v[40:41], v12 offset:256
  v_mul_f32 v22, s76, v22
  v_mul_f32 v23, s76, v23
  v_mfma_f32_16x16x32_bf16 v[208:211], v[92:95], v[240:243], v[208:211]
  ds_read_b64_tr_b16 v[42:43], v12 offset:1280
  v_cvt_pk_bf16_f32 v28, v16, v17
  v_cvt_pk_bf16_f32 v29, v18, v19
  v_mfma_f32_16x16x32_bf16 v[100:103], v[64:67], v[244:247], v[100:103]
  buffer_load_dwordx4 v4, s[32:35], s26 offen offset:1024 sc1 lds
  v_cvt_pk_bf16_f32 v30, v20, v21
  v_cvt_pk_bf16_f32 v31, v22, v23
  v_mfma_f32_16x16x32_bf16 v[116:119], v[68:71], v[244:247], v[116:119]
  ds_read_b64_tr_b16 v[44:45], v13 offset:256
  buffer_store_dwordx4 v[28:31], v2, s[40:43], s63 offen offset:1024 sc1
  v_accvgpr_read_b32 v16, a72
  v_mfma_f32_16x16x32_bf16 v[132:135], v[72:75], v[244:247], v[132:135]
  s_add_u32 s63, s63, s61
  ds_read_b64_tr_b16 v[46:47], v13 offset:1280
  v_accvgpr_read_b32 v17, a73
  v_accvgpr_read_b32 v18, a74
  v_mfma_f32_16x16x32_bf16 v[148:151], v[76:79], v[244:247], v[148:151]
  ds_read_b128 v[224:227], v14 offset:0
  v_accvgpr_read_b32 v19, a75
  v_accvgpr_read_b32 v20, a104
  v_mfma_f32_16x16x32_bf16 v[164:167], v[80:83], v[244:247], v[164:167]
  ds_read_b128 v[228:231], v14 offset:1024
  v_accvgpr_read_b32 v21, a105
  v_accvgpr_read_b32 v22, a106
  v_mfma_f32_16x16x32_bf16 v[180:183], v[84:87], v[244:247], v[180:183]
  buffer_load_dwordx4 v5, s[32:35], s26 offen offset:2048 sc1 lds
  v_accvgpr_read_b32 v23, a107
  v_mul_f32 v16, s76, v16
  v_mfma_f32_16x16x32_bf16 v[196:199], v[88:91], v[244:247], v[196:199]
  ds_read_b64_tr_b16 v[48:49], v12 offset:512
  v_mul_f32 v17, s76, v17
  v_mul_f32 v18, s76, v18
  v_mfma_f32_16x16x32_bf16 v[212:215], v[92:95], v[244:247], v[212:215]
  ds_read_b64_tr_b16 v[50:51], v12 offset:1536
  v_mul_f32 v19, s76, v19
  v_mul_f32 v20, s76, v20
  v_mfma_f32_16x16x32_bf16 v[104:107], v[64:67], v[248:251], v[104:107]
  ds_read_b64_tr_b16 v[52:53], v13 offset:512
  v_mul_f32 v21, s76, v21
  v_mul_f32 v22, s76, v22
  v_mfma_f32_16x16x32_bf16 v[120:123], v[68:71], v[248:251], v[120:123]
  ds_read_b64_tr_b16 v[54:55], v13 offset:1536
  v_mul_f32 v23, s76, v23
  v_cvt_pk_bf16_f32 v24, v16, v17
  v_mfma_f32_16x16x32_bf16 v[136:139], v[72:75], v[248:251], v[136:139]
  buffer_load_dwordx4 v6, s[32:35], s26 offen offset:3072 sc1 lds
  v_cvt_pk_bf16_f32 v25, v18, v19
  v_cvt_pk_bf16_f32 v26, v20, v21
  v_mfma_f32_16x16x32_bf16 v[152:155], v[76:79], v[248:251], v[152:155]
  s_add_u32 s26, s26, 1024
  ds_read_b64_tr_b16 v[56:57], v12 offset:768
  v_cvt_pk_bf16_f32 v27, v22, v23
  v_mfma_f32_16x16x32_bf16 v[168:171], v[80:83], v[248:251], v[168:171]
  ds_read_b64_tr_b16 v[58:59], v12 offset:1792
  buffer_store_dwordx4 v[24:27], v2, s[40:43], s63 offen offset:0 sc1
  v_accvgpr_read_b32 v16, a76
  v_mfma_f32_16x16x32_bf16 v[184:187], v[84:87], v[248:251], v[184:187]
  ds_read_b64_tr_b16 v[60:61], v13 offset:768
  v_accvgpr_read_b32 v17, a77
  v_accvgpr_read_b32 v18, a78
  v_mfma_f32_16x16x32_bf16 v[200:203], v[88:91], v[248:251], v[200:203]
  s_add_u32 m0, s24, 49152
  ds_read_b64_tr_b16 v[62:63], v13 offset:1792
  v_accvgpr_read_b32 v19, a79
  v_accvgpr_read_b32 v20, a108
  v_mfma_f32_16x16x32_bf16 v[216:219], v[92:95], v[248:251], v[216:219]
  buffer_load_dwordx4 v8, s[36:39], s27 offen offset:0 lds
  v_accvgpr_read_b32 v21, a109
  v_accvgpr_read_b32 v22, a110
  v_mfma_f32_16x16x32_bf16 v[108:111], v[64:67], v[252:255], v[108:111]
  ds_read_b128 v[232:235], v14 offset:2048
  v_accvgpr_read_b32 v23, a111
  v_mul_f32 v16, s76, v16
  v_mfma_f32_16x16x32_bf16 v[124:127], v[68:71], v[252:255], v[124:127]
  ds_read_b128 v[236:239], v14 offset:3072
  v_mul_f32 v17, s76, v17
  v_mul_f32 v18, s76, v18
  v_mfma_f32_16x16x32_bf16 v[140:143], v[72:75], v[252:255], v[140:143]
  v_mul_f32 v19, s76, v19
  v_mul_f32 v20, s76, v20
  v_mul_f32 v21, s76, v21
  v_mfma_f32_16x16x32_bf16 v[156:159], v[76:79], v[252:255], v[156:159]
  v_mul_f32 v22, s76, v22
  v_mul_f32 v23, s76, v23
  v_cvt_pk_bf16_f32 v28, v16, v17
  v_mfma_f32_16x16x32_bf16 v[172:175], v[80:83], v[252:255], v[172:175]
  buffer_load_dwordx4 v9, s[36:39], s27 offen offset:1024 lds
  v_cvt_pk_bf16_f32 v29, v18, v19
  v_cvt_pk_bf16_f32 v30, v20, v21
  v_mfma_f32_16x16x32_bf16 v[188:191], v[84:87], v[252:255], v[188:191]
  v_cvt_pk_bf16_f32 v31, v22, v23
  v_mfma_f32_16x16x32_bf16 v[204:207], v[88:91], v[252:255], v[204:207]
  buffer_store_dwordx4 v[28:31], v2, s[40:43], s63 offen offset:1024 sc1
  v_mfma_f32_16x16x32_bf16 v[220:223], v[92:95], v[252:255], v[220:223]
  s_waitcnt vmcnt(22) lgkmcnt(0)
  v_mfma_f32_16x16x32_bf16 v[96:99], v[32:35], v[224:227], v[96:99]
  s_add_u32 s63, s63, s61
  v_accvgpr_read_b32 v16, a80
  v_accvgpr_read_b32 v17, a81
  v_accvgpr_read_b32 v18, a82
  v_accvgpr_read_b32 v19, a83
  v_mfma_f32_16x16x32_bf16 v[112:115], v[36:39], v[224:227], v[112:115]
  ds_read_b64_tr_b16 v[64:65], v12 offset:8192
  v_accvgpr_read_b32 v20, a112
  v_accvgpr_read_b32 v21, a113
  v_mfma_f32_16x16x32_bf16 v[128:131], v[40:43], v[224:227], v[128:131]
  s_add_u32 m0, s24, 0
  ds_read_b64_tr_b16 v[66:67], v12 offset:9216
  v_accvgpr_read_b32 v22, a114
  v_accvgpr_read_b32 v23, a115
  v_mfma_f32_16x16x32_bf16 v[144:147], v[44:47], v[224:227], v[144:147]
  buffer_load_dwordx4 v3, s[32:35], s26 offen offset:0 sc1 lds
  v_mul_f32 v16, s76, v16
  v_mul_f32 v17, s76, v17
  v_mfma_f32_16x16x32_bf16 v[160:163], v[48:51], v[224:227], v[160:163]
  ds_read_b64_tr_b16 v[68:69], v13 offset:8192
  v_mul_f32 v18, s76, v18
  v_mul_f32 v19, s76, v19
  v_mfma_f32_16x16x32_bf16 v[176:179], v[52:55], v[224:227], v[176:179]
  ds_read_b64_tr_b16 v[70:71], v13 offset:9216
  v_mul_f32 v20, s76, v20
  v_mul_f32 v21, s76, v21
  v_mfma_f32_16x16x32_bf16 v[192:195], v[56:59], v[224:227], v[192:195]
  ds_read_b64_tr_b16 v[72:73], v12 offset:8448
  v_mul_f32 v22, s76, v22
  v_mul_f32 v23, s76, v23
  v_mfma_f32_16x16x32_bf16 v[208:211], v[60:63], v[224:227], v[208:211]
  ds_read_b64_tr_b16 v[74:75], v12 offset:9472
  v_cvt_pk_bf16_f32 v24, v16, v17
  v_cvt_pk_bf16_f32 v25, v18, v19
  v_mfma_f32_16x16x32_bf16 v[100:103], v[32:35], v[228:231], v[100:103]
  buffer_load_dwordx4 v4, s[32:35], s26 offen offset:1024 sc1 lds
  v_cvt_pk_bf16_f32 v26, v20, v21
  v_cvt_pk_bf16_f32 v27, v22, v23
  v_mfma_f32_16x16x32_bf16 v[116:119], v[36:39], v[228:231], v[116:119]
  ds_read_b64_tr_b16 v[76:77], v13 offset:8448
  buffer_store_dwordx4 v[24:27], v2, s[40:43], s63 offen offset:0 sc1
  v_accvgpr_read_b32 v16, a84
  v_mfma_f32_16x16x32_bf16 v[132:135], v[40:43], v[228:231], v[132:135]
  ds_read_b64_tr_b16 v[78:79], v13 offset:9472
  v_accvgpr_read_b32 v17, a85
  v_accvgpr_read_b32 v18, a86
  v_mfma_f32_16x16x32_bf16 v[148:151], v[44:47], v[228:231], v[148:151]
  ds_read_b128 v[240:243], v14 offset:32768
  v_accvgpr_read_b32 v19, a87
  v_accvgpr_read_b32 v20, a116
  v_mfma_f32_16x16x32_bf16 v[164:167], v[48:51], v[228:231], v[164:167]
  ds_read_b128 v[244:247], v14 offset:33792
  v_accvgpr_read_b32 v21, a117
  v_accvgpr_read_b32 v22, a118
  v_mfma_f32_16x16x32_bf16 v[180:183], v[52:55], v[228:231], v[180:183]
  buffer_load_dwordx4 v5, s[32:35], s26 offen offset:2048 sc1 lds
  v_accvgpr_read_b32 v23, a119
  v_mul_f32 v16, s76, v16
  v_mfma_f32_16x16x32_bf16 v[196:199], v[56:59], v[228:231], v[196:199]
  ds_read_b64_tr_b16 v[80:81], v12 offset:8704
  v_mul_f32 v17, s76, v17
  v_mul_f32 v18, s76, v18
  v_mfma_f32_16x16x32_bf16 v[212:215], v[60:63], v[228:231], v[212:215]
  ds_read_b64_tr_b16 v[82:83], v12 offset:9728
  v_mul_f32 v19, s76, v19
  v_mul_f32 v20, s76, v20
  v_mul_f32 v21, s76, v21
  v_mfma_f32_16x16x32_bf16 v[104:107], v[32:35], v[232:235], v[104:107]
  ds_read_b64_tr_b16 v[84:85], v13 offset:8704
  v_mul_f32 v22, s76, v22
  v_mul_f32 v23, s76, v23
  v_mfma_f32_16x16x32_bf16 v[120:123], v[36:39], v[232:235], v[120:123]
  ds_read_b64_tr_b16 v[86:87], v13 offset:9728
  v_cvt_pk_bf16_f32 v28, v16, v17
  v_cvt_pk_bf16_f32 v29, v18, v19
  v_mfma_f32_16x16x32_bf16 v[136:139], v[40:43], v[232:235], v[136:139]
  buffer_load_dwordx4 v6, s[32:35], s26 offen offset:3072 sc1 lds
  v_cvt_pk_bf16_f32 v30, v20, v21
  v_cvt_pk_bf16_f32 v31, v22, v23
  v_mfma_f32_16x16x32_bf16 v[152:155], v[44:47], v[232:235], v[152:155]
  s_add_u32 s26, s26, 1024
  ds_read_b64_tr_b16 v[88:89], v12 offset:8960
  buffer_store_dwordx4 v[28:31], v2, s[40:43], s63 offen offset:1024 sc1
  v_accvgpr_read_b32 v16, a88
  v_mfma_f32_16x16x32_bf16 v[168:171], v[48:51], v[232:235], v[168:171]
  s_add_u32 s63, s63, s61
  ds_read_b64_tr_b16 v[90:91], v12 offset:9984
  v_accvgpr_read_b32 v17, a89
  v_accvgpr_read_b32 v18, a90
  v_mfma_f32_16x16x32_bf16 v[184:187], v[52:55], v[232:235], v[184:187]
  ds_read_b64_tr_b16 v[92:93], v13 offset:8960
  v_accvgpr_read_b32 v19, a91
  v_accvgpr_read_b32 v20, a120
  v_mfma_f32_16x16x32_bf16 v[200:203], v[56:59], v[232:235], v[200:203]
  s_add_u32 m0, s24, 49152
  ds_read_b64_tr_b16 v[94:95], v13 offset:9984
  v_accvgpr_read_b32 v21, a121
  v_accvgpr_read_b32 v22, a122
  v_mfma_f32_16x16x32_bf16 v[216:219], v[60:63], v[232:235], v[216:219]
  buffer_load_dwordx4 v10, s[36:39], s27 offen offset:2048 lds
  v_accvgpr_read_b32 v23, a123
  v_mul_f32 v16, s76, v16
  v_mfma_f32_16x16x32_bf16 v[108:111], v[32:35], v[236:239], v[108:111]
  ds_read_b128 v[248:251], v14 offset:34816
  v_mul_f32 v17, s76, v17
  v_mul_f32 v18, s76, v18
  v_mfma_f32_16x16x32_bf16 v[124:127], v[36:39], v[236:239], v[124:127]
  ds_read_b128 v[252:255], v14 offset:35840
  v_mul_f32 v19, s76, v19
  v_mul_f32 v20, s76, v20
  v_mfma_f32_16x16x32_bf16 v[140:143], v[40:43], v[236:239], v[140:143]
  v_mul_f32 v21, s76, v21
  v_mul_f32 v22, s76, v22
  v_mul_f32 v23, s76, v23
  v_mfma_f32_16x16x32_bf16 v[156:159], v[44:47], v[236:239], v[156:159]
  v_xor_b32 v14, 0x10000, v14
  v_cvt_pk_bf16_f32 v24, v16, v17
  v_cvt_pk_bf16_f32 v25, v18, v19
  v_mfma_f32_16x16x32_bf16 v[172:175], v[48:51], v[236:239], v[172:175]
  buffer_load_dwordx4 v11, s[36:39], s27 offen offset:3072 lds
  v_cvt_pk_bf16_f32 v26, v20, v21
  v_cvt_pk_bf16_f32 v27, v22, v23
  v_mfma_f32_16x16x32_bf16 v[188:191], v[52:55], v[236:239], v[188:191]
  s_add_u32 s27, s27, 524288
  buffer_store_dwordx4 v[24:27], v2, s[40:43], s63 offen offset:0 sc1
  v_mfma_f32_16x16x32_bf16 v[204:207], v[56:59], v[236:239], v[204:207]
  v_mfma_f32_16x16x32_bf16 v[220:223], v[60:63], v[236:239], v[220:223]
  s_waitcnt vmcnt(22) lgkmcnt(0)
  v_mfma_f32_16x16x32_bf16 v[96:99], v[64:67], v[240:243], v[96:99]
  s_barrier
  v_accvgpr_read_b32 v16, a92
  v_accvgpr_read_b32 v17, a93
  v_accvgpr_read_b32 v18, a94
  v_accvgpr_read_b32 v19, a95
  v_mfma_f32_16x16x32_bf16 v[112:115], v[68:71], v[240:243], v[112:115]
  ds_read_b64_tr_b16 v[32:33], v12 offset:32768
  v_accvgpr_read_b32 v20, a124
  v_accvgpr_read_b32 v21, a125
  v_mfma_f32_16x16x32_bf16 v[128:131], v[72:75], v[240:243], v[128:131]
  s_add_u32 m0, s24, 32768
  ds_read_b64_tr_b16 v[34:35], v12 offset:33792
  v_accvgpr_read_b32 v22, a126
  v_accvgpr_read_b32 v23, a127
  v_mfma_f32_16x16x32_bf16 v[144:147], v[76:79], v[240:243], v[144:147]
  buffer_load_dwordx4 v3, s[32:35], s26 offen offset:0 sc1 lds
  v_mul_f32 v16, s76, v16
  v_mul_f32 v17, s76, v17
  v_mfma_f32_16x16x32_bf16 v[160:163], v[80:83], v[240:243], v[160:163]
  ds_read_b64_tr_b16 v[36:37], v13 offset:32768
  v_mul_f32 v18, s76, v18
  v_mul_f32 v19, s76, v19
  v_mfma_f32_16x16x32_bf16 v[176:179], v[84:87], v[240:243], v[176:179]
  ds_read_b64_tr_b16 v[38:39], v13 offset:33792
  v_mul_f32 v20, s76, v20
  v_mul_f32 v21, s76, v21
  v_mfma_f32_16x16x32_bf16 v[192:195], v[88:91], v[240:243], v[192:195]
  ds_read_b64_tr_b16 v[40:41], v12 offset:33024
  v_mul_f32 v22, s76, v22
  v_mul_f32 v23, s76, v23
  v_mfma_f32_16x16x32_bf16 v[208:211], v[92:95], v[240:243], v[208:211]
  ds_read_b64_tr_b16 v[42:43], v12 offset:34048
  v_cvt_pk_bf16_f32 v28, v16, v17
  v_cvt_pk_bf16_f32 v29, v18, v19
  v_mfma_f32_16x16x32_bf16 v[100:103], v[64:67], v[244:247], v[100:103]
  buffer_load_dwordx4 v4, s[32:35], s26 offen offset:1024 sc1 lds
  v_cvt_pk_bf16_f32 v30, v20, v21
  v_cvt_pk_bf16_f32 v31, v22, v23
  v_mfma_f32_16x16x32_bf16 v[116:119], v[68:71], v[244:247], v[116:119]
  ds_read_b64_tr_b16 v[44:45], v13 offset:33024
  buffer_store_dwordx4 v[28:31], v2, s[40:43], s63 offen offset:1024 sc1
  v_accvgpr_read_b32 v16, a128
  v_mfma_f32_16x16x32_bf16 v[132:135], v[72:75], v[244:247], v[132:135]
  s_mul_i32 s63, s60, 2
  ds_read_b64_tr_b16 v[46:47], v13 offset:34048
  v_accvgpr_read_b32 v17, a129
  v_accvgpr_read_b32 v18, a130
  v_mfma_f32_16x16x32_bf16 v[148:151], v[76:79], v[244:247], v[148:151]
  s_add_u32 s63, s63, s62
  ds_read_b128 v[224:227], v14 offset:0
  v_accvgpr_read_b32 v19, a131
  v_accvgpr_read_b32 v20, a160
  v_mfma_f32_16x16x32_bf16 v[164:167], v[80:83], v[244:247], v[164:167]
  ds_read_b128 v[228:231], v14 offset:1024
  v_accvgpr_read_b32 v21, a161
  v_accvgpr_read_b32 v22, a162
  v_mfma_f32_16x16x32_bf16 v[180:183], v[84:87], v[244:247], v[180:183]
  buffer_load_dwordx4 v5, s[32:35], s26 offen offset:2048 sc1 lds
  v_accvgpr_read_b32 v23, a163
  v_mul_f32 v16, s76, v16
  v_mfma_f32_16x16x32_bf16 v[196:199], v[88:91], v[244:247], v[196:199]
  ds_read_b64_tr_b16 v[48:49], v12 offset:33280
  v_mul_f32 v17, s76, v17
  v_mul_f32 v18, s76, v18
  v_mfma_f32_16x16x32_bf16 v[212:215], v[92:95], v[244:247], v[212:215]
  ds_read_b64_tr_b16 v[50:51], v12 offset:34304
  v_mul_f32 v19, s76, v19
  v_mul_f32 v20, s76, v20
  v_mfma_f32_16x16x32_bf16 v[104:107], v[64:67], v[248:251], v[104:107]
  ds_read_b64_tr_b16 v[52:53], v13 offset:33280
  v_mul_f32 v21, s76, v21
  v_mul_f32 v22, s76, v22
  v_mfma_f32_16x16x32_bf16 v[120:123], v[68:71], v[248:251], v[120:123]
  ds_read_b64_tr_b16 v[54:55], v13 offset:34304
  v_mul_f32 v23, s76, v23
  v_cvt_pk_bf16_f32 v24, v16, v17
  v_mfma_f32_16x16x32_bf16 v[136:139], v[72:75], v[248:251], v[136:139]
  buffer_load_dwordx4 v6, s[32:35], s26 offen offset:3072 sc1 lds
  v_cvt_pk_bf16_f32 v25, v18, v19
  v_cvt_pk_bf16_f32 v26, v20, v21
  v_mfma_f32_16x16x32_bf16 v[152:155], v[76:79], v[248:251], v[152:155]
  s_add_u32 s26, s26, 1024
  ds_read_b64_tr_b16 v[56:57], v12 offset:33536
  v_cvt_pk_bf16_f32 v27, v22, v23
  v_mfma_f32_16x16x32_bf16 v[168:171], v[80:83], v[248:251], v[168:171]
  ds_read_b64_tr_b16 v[58:59], v12 offset:34560
  buffer_store_dwordx4 v[24:27], v2, s[40:43], s63 offen offset:0 sc1
  v_accvgpr_read_b32 v16, a132
  v_mfma_f32_16x16x32_bf16 v[184:187], v[84:87], v[248:251], v[184:187]
  ds_read_b64_tr_b16 v[60:61], v13 offset:33536
  v_accvgpr_read_b32 v17, a133
  v_accvgpr_read_b32 v18, a134
  v_mfma_f32_16x16x32_bf16 v[200:203], v[88:91], v[248:251], v[200:203]
  s_add_u32 m0, s24, 81920
  ds_read_b64_tr_b16 v[62:63], v13 offset:34560
  v_accvgpr_read_b32 v19, a135
  v_accvgpr_read_b32 v20, a164
  v_mfma_f32_16x16x32_bf16 v[216:219], v[92:95], v[248:251], v[216:219]
  buffer_load_dwordx4 v8, s[36:39], s27 offen offset:0 lds
  v_accvgpr_read_b32 v21, a165
  v_accvgpr_read_b32 v22, a166
  v_mfma_f32_16x16x32_bf16 v[108:111], v[64:67], v[252:255], v[108:111]
  ds_read_b128 v[232:235], v14 offset:2048
  v_accvgpr_read_b32 v23, a167
  v_mul_f32 v16, s76, v16
  v_mfma_f32_16x16x32_bf16 v[124:127], v[68:71], v[252:255], v[124:127]
  ds_read_b128 v[236:239], v14 offset:3072
  v_mul_f32 v17, s76, v17
  v_mul_f32 v18, s76, v18
  v_mfma_f32_16x16x32_bf16 v[140:143], v[72:75], v[252:255], v[140:143]
  v_mul_f32 v19, s76, v19
  v_mul_f32 v20, s76, v20
  v_mul_f32 v21, s76, v21
  v_mfma_f32_16x16x32_bf16 v[156:159], v[76:79], v[252:255], v[156:159]
  v_mul_f32 v22, s76, v22
  v_mul_f32 v23, s76, v23
  v_cvt_pk_bf16_f32 v28, v16, v17
  v_mfma_f32_16x16x32_bf16 v[172:175], v[80:83], v[252:255], v[172:175]
  buffer_load_dwordx4 v9, s[36:39], s27 offen offset:1024 lds
  v_cvt_pk_bf16_f32 v29, v18, v19
  v_cvt_pk_bf16_f32 v30, v20, v21
  v_mfma_f32_16x16x32_bf16 v[188:191], v[84:87], v[252:255], v[188:191]
  v_cvt_pk_bf16_f32 v31, v22, v23
  v_mfma_f32_16x16x32_bf16 v[204:207], v[88:91], v[252:255], v[204:207]
  buffer_store_dwordx4 v[28:31], v2, s[40:43], s63 offen offset:1024 sc1
  v_mfma_f32_16x16x32_bf16 v[220:223], v[92:95], v[252:255], v[220:223]
  s_waitcnt vmcnt(22) lgkmcnt(0)
  v_mfma_f32_16x16x32_bf16 v[96:99], v[32:35], v[224:227], v[96:99]
  s_add_u32 s63, s63, s61
  v_accvgpr_read_b32 v16, a136
  v_accvgpr_read_b32 v17, a137
  v_accvgpr_read_b32 v18, a138
  v_mfma_f32_16x16x32_bf16 v[112:115], v[36:39], v[224:227], v[112:115]
  ds_read_b64_tr_b16 v[64:65], v12 offset:40960
  v_accvgpr_read_b32 v19, a139
  v_mfma_f32_16x16x32_bf16 v[128:131], v[40:43], v[224:227], v[128:131]
  s_add_u32 m0, s24, 65536
  ds_read_b64_tr_b16 v[66:67], v12 offset:41984
  v_accvgpr_read_b32 v20, a168
  v_accvgpr_read_b32 v21, a169
  v_mfma_f32_16x16x32_bf16 v[144:147], v[44:47], v[224:227], v[144:147]
  buffer_load_dwordx4 v3, s[32:35], s26 offen offset:0 sc1 lds
  v_accvgpr_read_b32 v22, a170
  v_mfma_f32_16x16x32_bf16 v[160:163], v[48:51], v[224:227], v[160:163]
  ds_read_b64_tr_b16 v[68:69], v13 offset:40960
  v_accvgpr_read_b32 v23, a171
  v_mfma_f32_16x16x32_bf16 v[176:179], v[52:55], v[224:227], v[176:179]
  ds_read_b64_tr_b16 v[70:71], v13 offset:41984
  v_mul_f32 v16, s76, v16
  v_mul_f32 v17, s76, v17
  v_mfma_f32_16x16x32_bf16 v[192:195], v[56:59], v[224:227], v[192:195]
  ds_read_b64_tr_b16 v[72:73], v12 offset:41216
  v_mul_f32 v18, s76, v18
  v_mfma_f32_16x16x32_bf16 v[208:211], v[60:63], v[224:227], v[208:211]
  ds_read_b64_tr_b16 v[74:75], v12 offset:42240
  v_mul_f32 v19, s76, v19
  v_mul_f32 v20, s76, v20
  v_mfma_f32_16x16x32_bf16 v[100:103], v[32:35], v[228:231], v[100:103]
  buffer_load_dwordx4 v4, s[32:35], s26 offen offset:1024 sc1 lds
  v_mul_f32 v21, s76, v21
  v_mfma_f32_16x16x32_bf16 v[116:119], v[36:39], v[228:231], v[116:119]
  ds_read_b64_tr_b16 v[76:77], v13 offset:41216
  v_mul_f32 v22, s76, v22
  v_mfma_f32_16x16x32_bf16 v[132:135], v[40:43], v[228:231], v[132:135]
  ds_read_b64_tr_b16 v[78:79], v13 offset:42240
  v_mul_f32 v23, s76, v23
  v_cvt_pk_bf16_f32 v24, v16, v17
  v_mfma_f32_16x16x32_bf16 v[148:151], v[44:47], v[228:231], v[148:151]
  ds_read_b128 v[240:243], v14 offset:32768
  v_cvt_pk_bf16_f32 v25, v18, v19
  v_mfma_f32_16x16x32_bf16 v[164:167], v[48:51], v[228:231], v[164:167]
  ds_read_b128 v[244:247], v14 offset:33792
  v_cvt_pk_bf16_f32 v26, v20, v21
  v_cvt_pk_bf16_f32 v27, v22, v23
  v_mfma_f32_16x16x32_bf16 v[180:183], v[52:55], v[228:231], v[180:183]
  buffer_load_dwordx4 v5, s[32:35], s26 offen offset:2048 sc1 lds
  buffer_store_dwordx4 v[24:27], v2, s[40:43], s63 offen offset:0 sc1
  v_mfma_f32_16x16x32_bf16 v[196:199], v[56:59], v[228:231], v[196:199]
  ds_read_b64_tr_b16 v[80:81], v12 offset:41472
  v_accvgpr_read_b32 v16, a140
  v_mfma_f32_16x16x32_bf16 v[212:215], v[60:63], v[228:231], v[212:215]
  ds_read_b64_tr_b16 v[82:83], v12 offset:42496
  v_accvgpr_read_b32 v17, a141
  v_accvgpr_read_b32 v18, a142
  v_mfma_f32_16x16x32_bf16 v[104:107], v[32:35], v[232:235], v[104:107]
  ds_read_b64_tr_b16 v[84:85], v13 offset:41472
  v_accvgpr_read_b32 v19, a143
  v_mfma_f32_16x16x32_bf16 v[120:123], v[36:39], v[232:235], v[120:123]
  ds_read_b64_tr_b16 v[86:87], v13 offset:42496
  v_accvgpr_read_b32 v20, a172
  v_accvgpr_read_b32 v21, a173
  v_mfma_f32_16x16x32_bf16 v[136:139], v[40:43], v[232:235], v[136:139]
  buffer_load_dwordx4 v6, s[32:35], s26 offen offset:3072 sc1 lds
  v_accvgpr_read_b32 v22, a174
  v_mfma_f32_16x16x32_bf16 v[152:155], v[44:47], v[232:235], v[152:155]
  s_add_u32 s26, s26, 1024
  ds_read_b64_tr_b16 v[88:89], v12 offset:41728
  v_accvgpr_read_b32 v23, a175
  v_mfma_f32_16x16x32_bf16 v[168:171], v[48:51], v[232:235], v[168:171]
  ds_read_b64_tr_b16 v[90:91], v12 offset:42752
  v_mul_f32 v16, s76, v16
  v_mul_f32 v17, s76, v17
  v_mfma_f32_16x16x32_bf16 v[184:187], v[52:55], v[232:235], v[184:187]
  ds_read_b64_tr_b16 v[92:93], v13 offset:41728
  v_mul_f32 v18, s76, v18
  v_mfma_f32_16x16x32_bf16 v[200:203], v[56:59], v[232:235], v[200:203]
  s_add_u32 m0, s24, 81920
  ds_read_b64_tr_b16 v[94:95], v13 offset:42752
  v_mul_f32 v19, s76, v19
  v_mul_f32 v20, s76, v20
  v_mfma_f32_16x16x32_bf16 v[216:219], v[60:63], v[232:235], v[216:219]
  buffer_load_dwordx4 v10, s[36:39], s27 offen offset:2048 lds
  v_mul_f32 v21, s76, v21
  v_mfma_f32_16x16x32_bf16 v[108:111], v[32:35], v[236:239], v[108:111]
  ds_read_b128 v[248:251], v14 offset:34816
  v_mul_f32 v22, s76, v22
  v_mfma_f32_16x16x32_bf16 v[124:127], v[36:39], v[236:239], v[124:127]
  ds_read_b128 v[252:255], v14 offset:35840
  v_mul_f32 v23, s76, v23
  v_cvt_pk_bf16_f32 v28, v16, v17
  v_mfma_f32_16x16x32_bf16 v[140:143], v[40:43], v[236:239], v[140:143]
  v_cvt_pk_bf16_f32 v29, v18, v19
  v_cvt_pk_bf16_f32 v30, v20, v21
  v_mfma_f32_16x16x32_bf16 v[156:159], v[44:47], v[236:239], v[156:159]
  v_xor_b32 v14, 0x10000, v14
  v_cvt_pk_bf16_f32 v31, v22, v23
  v_mfma_f32_16x16x32_bf16 v[172:175], v[48:51], v[236:239], v[172:175]
  buffer_load_dwordx4 v11, s[36:39], s27 offen offset:3072 lds
  buffer_store_dwordx4 v[28:31], v2, s[40:43], s63 offen offset:1024 sc1
  v_mfma_f32_16x16x32_bf16 v[188:191], v[52:55], v[236:239], v[188:191]
  s_add_u32 s27, s27, 524288
  v_xor_b32 v12, 0x10000, v12
  v_mfma_f32_16x16x32_bf16 v[204:207], v[56:59], v[236:239], v[204:207]
  v_xor_b32 v13, 0x10000, v13
  v_mfma_f32_16x16x32_bf16 v[220:223], v[60:63], v[236:239], v[220:223]
  s_waitcnt vmcnt(21) lgkmcnt(0)
  v_mfma_f32_16x16x32_bf16 v[96:99], v[64:67], v[240:243], v[96:99]
  s_barrier
  v_accvgpr_read_b32 v16, a144
  v_accvgpr_read_b32 v17, a145
  v_accvgpr_read_b32 v18, a146
  v_mfma_f32_16x16x32_bf16 v[112:115], v[68:71], v[240:243], v[112:115]
  s_add_u32 s63, s63, s61
  ds_read_b64_tr_b16 v[32:33], v12 offset:0
  v_accvgpr_read_b32 v19, a147
  v_mfma_f32_16x16x32_bf16 v[128:131], v[72:75], v[240:243], v[128:131]
  s_add_u32 m0, s24, 98304
  ds_read_b64_tr_b16 v[34:35], v12 offset:1024
  v_accvgpr_read_b32 v20, a176
  v_mfma_f32_16x16x32_bf16 v[144:147], v[76:79], v[240:243], v[144:147]
  buffer_load_dwordx4 v3, s[32:35], s26 offen offset:0 sc1 lds
  v_accvgpr_read_b32 v21, a177
  v_accvgpr_read_b32 v22, a178
  v_mfma_f32_16x16x32_bf16 v[160:163], v[80:83], v[240:243], v[160:163]
  ds_read_b64_tr_b16 v[36:37], v13 offset:0
  v_accvgpr_read_b32 v23, a179
  v_mfma_f32_16x16x32_bf16 v[176:179], v[84:87], v[240:243], v[176:179]
  ds_read_b64_tr_b16 v[38:39], v13 offset:1024
  v_mul_f32 v16, s76, v16
  v_mfma_f32_16x16x32_bf16 v[192:195], v[88:91], v[240:243], v[192:195]
  ds_read_b64_tr_b16 v[40:41], v12 offset:256
  v_mul_f32 v17, s76, v17
  v_mul_f32 v18, s76, v18
  v_mfma_f32_16x16x32_bf16 v[208:211], v[92:95], v[240:243], v[208:211]
  ds_read_b64_tr_b16 v[42:43], v12 offset:1280
  v_mul_f32 v19, s76, v19
  v_mfma_f32_16x16x32_bf16 v[100:103], v[64:67], v[244:247], v[100:103]
  buffer_load_dwordx4 v4, s[32:35], s26 offen offset:1024 sc1 lds
  v_mul_f32 v20, s76, v20
  v_mfma_f32_16x16x32_bf16 v[116:119], v[68:71], v[244:247], v[116:119]
  ds_read_b64_tr_b16 v[44:45], v13 offset:256
  v_mul_f32 v21, s76, v21
  v_mfma_f32_16x16x32_bf16 v[132:135], v[72:75], v[244:247], v[132:135]
  ds_read_b64_tr_b16 v[46:47], v13 offset:1280
  v_mul_f32 v22, s76, v22
  v_mul_f32 v23, s76, v23
  v_mfma_f32_16x16x32_bf16 v[148:151], v[76:79], v[244:247], v[148:151]
  ds_read_b128 v[224:227], v14 offset:0
  v_cvt_pk_bf16_f32 v24, v16, v17
  v_mfma_f32_16x16x32_bf16 v[164:167], v[80:83], v[244:247], v[164:167]
  ds_read_b128 v[228:231], v14 offset:1024
  v_cvt_pk_bf16_f32 v25, v18, v19
  v_mfma_f32_16x16x32_bf16 v[180:183], v[84:87], v[244:247], v[180:183]
  buffer_load_dwordx4 v5, s[32:35], s26 offen offset:2048 sc1 lds
  v_cvt_pk_bf16_f32 v26, v20, v21
  v_cvt_pk_bf16_f32 v27, v22, v23
  v_mfma_f32_16x16x32_bf16 v[196:199], v[88:91], v[244:247], v[196:199]
  ds_read_b64_tr_b16 v[48:49], v12 offset:512
  buffer_store_dwordx4 v[24:27], v2, s[40:43], s63 offen offset:0 sc1
  v_mfma_f32_16x16x32_bf16 v[212:215], v[92:95], v[244:247], v[212:215]
  ds_read_b64_tr_b16 v[50:51], v12 offset:1536
  v_accvgpr_read_b32 v16, a148
  v_mfma_f32_16x16x32_bf16 v[104:107], v[64:67], v[248:251], v[104:107]
  ds_read_b64_tr_b16 v[52:53], v13 offset:512
  v_accvgpr_read_b32 v17, a149
  v_accvgpr_read_b32 v18, a150
  v_mfma_f32_16x16x32_bf16 v[120:123], v[68:71], v[248:251], v[120:123]
  ds_read_b64_tr_b16 v[54:55], v13 offset:1536
  v_accvgpr_read_b32 v19, a151
  v_mfma_f32_16x16x32_bf16 v[136:139], v[72:75], v[248:251], v[136:139]
  buffer_load_dwordx4 v6, s[32:35], s26 offen offset:3072 sc1 lds
  v_accvgpr_read_b32 v20, a180
  v_mfma_f32_16x16x32_bf16 v[152:155], v[76:79], v[248:251], v[152:155]
  s_add_u32 s26, s26, 1024
  ds_read_b64_tr_b16 v[56:57], v12 offset:768
  v_accvgpr_read_b32 v21, a181
  v_mfma_f32_16x16x32_bf16 v[168:171], v[80:83], v[248:251], v[168:171]
  ds_read_b64_tr_b16 v[58:59], v12 offset:1792
  v_accvgpr_read_b32 v22, a182
  v_accvgpr_read_b32 v23, a183
  v_mfma_f32_16x16x32_bf16 v[184:187], v[84:87], v[248:251], v[184:187]
  ds_read_b64_tr_b16 v[60:61], v13 offset:768
  v_mul_f32 v16, s76, v16
  v_mfma_f32_16x16x32_bf16 v[200:203], v[88:91], v[248:251], v[200:203]
  s_add_u32 m0, s24, 114688
  ds_read_b64_tr_b16 v[62:63], v13 offset:1792
  v_mul_f32 v17, s76, v17
  v_mfma_f32_16x16x32_bf16 v[216:219], v[92:95], v[248:251], v[216:219]
  buffer_load_dwordx4 v8, s[36:39], s27 offen offset:0 lds
  v_mul_f32 v18, s76, v18
  v_mul_f32 v19, s76, v19
  v_mfma_f32_16x16x32_bf16 v[108:111], v[64:67], v[252:255], v[108:111]
  ds_read_b128 v[232:235], v14 offset:2048
  v_mul_f32 v20, s76, v20
  v_mfma_f32_16x16x32_bf16 v[124:127], v[68:71], v[252:255], v[124:127]
  ds_read_b128 v[236:239], v14 offset:3072
  v_mul_f32 v21, s76, v21
  v_mfma_f32_16x16x32_bf16 v[140:143], v[72:75], v[252:255], v[140:143]
  v_mul_f32 v22, s76, v22
  v_mul_f32 v23, s76, v23
  v_cvt_pk_bf16_f32 v28, v16, v17
  v_mfma_f32_16x16x32_bf16 v[156:159], v[76:79], v[252:255], v[156:159]
  v_cvt_pk_bf16_f32 v29, v18, v19
  v_cvt_pk_bf16_f32 v30, v20, v21
  v_mfma_f32_16x16x32_bf16 v[172:175], v[80:83], v[252:255], v[172:175]
  buffer_load_dwordx4 v9, s[36:39], s27 offen offset:1024 lds
  v_cvt_pk_bf16_f32 v31, v22, v23
  v_mfma_f32_16x16x32_bf16 v[188:191], v[84:87], v[252:255], v[188:191]
  buffer_store_dwordx4 v[28:31], v2, s[40:43], s63 offen offset:1024 sc1
  v_mfma_f32_16x16x32_bf16 v[204:207], v[88:91], v[252:255], v[204:207]
  v_mfma_f32_16x16x32_bf16 v[220:223], v[92:95], v[252:255], v[220:223]
  s_waitcnt vmcnt(20) lgkmcnt(0)
  v_mfma_f32_16x16x32_bf16 v[96:99], v[32:35], v[224:227], v[96:99]
  s_add_u32 s63, s63, s61
  v_accvgpr_read_b32 v16, a152
  v_accvgpr_read_b32 v17, a153
  v_accvgpr_read_b32 v18, a154
  v_mfma_f32_16x16x32_bf16 v[112:115], v[36:39], v[224:227], v[112:115]
  ds_read_b64_tr_b16 v[64:65], v12 offset:8192
  v_accvgpr_read_b32 v19, a155
  v_mfma_f32_16x16x32_bf16 v[128:131], v[40:43], v[224:227], v[128:131]
  s_add_u32 m0, s24, 0
  ds_read_b64_tr_b16 v[66:67], v12 offset:9216
  v_accvgpr_read_b32 v20, a184
  v_mfma_f32_16x16x32_bf16 v[144:147], v[44:47], v[224:227], v[144:147]
  buffer_load_dwordx4 v3, s[32:35], s26 offen offset:0 sc1 lds
  v_accvgpr_read_b32 v21, a185
  v_accvgpr_read_b32 v22, a186
  v_mfma_f32_16x16x32_bf16 v[160:163], v[48:51], v[224:227], v[160:163]
  ds_read_b64_tr_b16 v[68:69], v13 offset:8192
  v_accvgpr_read_b32 v23, a187
  v_mfma_f32_16x16x32_bf16 v[176:179], v[52:55], v[224:227], v[176:179]
  ds_read_b64_tr_b16 v[70:71], v13 offset:9216
  v_mul_f32 v16, s76, v16
  v_mfma_f32_16x16x32_bf16 v[192:195], v[56:59], v[224:227], v[192:195]
  ds_read_b64_tr_b16 v[72:73], v12 offset:8448
  v_mul_f32 v17, s76, v17
  v_mul_f32 v18, s76, v18
  v_mfma_f32_16x16x32_bf16 v[208:211], v[60:63], v[224:227], v[208:211]
  ds_read_b64_tr_b16 v[74:75], v12 offset:9472
  v_mul_f32 v19, s76, v19
  v_mfma_f32_16x16x32_bf16 v[100:103], v[32:35], v[228:231], v[100:103]
  buffer_load_dwordx4 v4, s[32:35], s26 offen offset:1024 sc1 lds
  v_mul_f32 v20, s76, v20
  v_mfma_f32_16x16x32_bf16 v[116:119], v[36:39], v[228:231], v[116:119]
  ds_read_b64_tr_b16 v[76:77], v13 offset:8448
  v_mul_f32 v21, s76, v21
  v_mul_f32 v22, s76, v22
  v_mfma_f32_16x16x32_bf16 v[132:135], v[40:43], v[228:231], v[132:135]
  ds_read_b64_tr_b16 v[78:79], v13 offset:9472
  v_mul_f32 v23, s76, v23
  v_mfma_f32_16x16x32_bf16 v[148:151], v[44:47], v[228:231], v[148:151]
  ds_read_b128 v[240:243], v14 offset:32768
  v_cvt_pk_bf16_f32 v24, v16, v17
  v_mfma_f32_16x16x32_bf16 v[164:167], v[48:51], v[228:231], v[164:167]
  ds_read_b128 v[244:247], v14 offset:33792
  v_cvt_pk_bf16_f32 v25, v18, v19
  v_cvt_pk_bf16_f32 v26, v20, v21
  v_mfma_f32_16x16x32_bf16 v[180:183], v[52:55], v[228:231], v[180:183]
  buffer_load_dwordx4 v5, s[32:35], s26 offen offset:2048 sc1 lds
  v_cvt_pk_bf16_f32 v27, v22, v23
  v_mfma_f32_16x16x32_bf16 v[196:199], v[56:59], v[228:231], v[196:199]
  ds_read_b64_tr_b16 v[80:81], v12 offset:8704
  buffer_store_dwordx4 v[24:27], v2, s[40:43], s63 offen offset:0 sc1
  v_mfma_f32_16x16x32_bf16 v[212:215], v[60:63], v[228:231], v[212:215]
  ds_read_b64_tr_b16 v[82:83], v12 offset:9728
  v_accvgpr_read_b32 v16, a156
  v_accvgpr_read_b32 v17, a157
  v_mfma_f32_16x16x32_bf16 v[104:107], v[32:35], v[232:235], v[104:107]
  ds_read_b64_tr_b16 v[84:85], v13 offset:8704
  v_accvgpr_read_b32 v18, a158
  v_mfma_f32_16x16x32_bf16 v[120:123], v[36:39], v[232:235], v[120:123]
  ds_read_b64_tr_b16 v[86:87], v13 offset:9728
  v_accvgpr_read_b32 v19, a159
  v_mfma_f32_16x16x32_bf16 v[136:139], v[40:43], v[232:235], v[136:139]
  buffer_load_dwordx4 v6, s[32:35], s26 offen offset:3072 sc1 lds
  v_accvgpr_read_b32 v20, a188
  v_accvgpr_read_b32 v21, a189
  v_mfma_f32_16x16x32_bf16 v[152:155], v[44:47], v[232:235], v[152:155]
  s_add_u32 s26, s26, 1024
  ds_read_b64_tr_b16 v[88:89], v12 offset:8960
  v_accvgpr_read_b32 v22, a190
  v_mfma_f32_16x16x32_bf16 v[168:171], v[48:51], v[232:235], v[168:171]
  ds_read_b64_tr_b16 v[90:91], v12 offset:9984
  v_accvgpr_read_b32 v23, a191
  v_mfma_f32_16x16x32_bf16 v[184:187], v[52:55], v[232:235], v[184:187]
  ds_read_b64_tr_b16 v[92:93], v13 offset:8960
  v_mul_f32 v16, s76, v16
  v_mul_f32 v17, s76, v17
  v_mfma_f32_16x16x32_bf16 v[200:203], v[56:59], v[232:235], v[200:203]
  s_add_u32 m0, s24, 114688
  ds_read_b64_tr_b16 v[94:95], v13 offset:9984
  v_mul_f32 v18, s76, v18
  v_mfma_f32_16x16x32_bf16 v[216:219], v[60:63], v[232:235], v[216:219]
  buffer_load_dwordx4 v10, s[36:39], s27 offen offset:2048 lds
  v_mul_f32 v19, s76, v19
  v_mfma_f32_16x16x32_bf16 v[108:111], v[32:35], v[236:239], v[108:111]
  ds_read_b128 v[248:251], v14 offset:34816
  v_mul_f32 v20, s76, v20
  v_mul_f32 v21, s76, v21
  v_mfma_f32_16x16x32_bf16 v[124:127], v[36:39], v[236:239], v[124:127]
  ds_read_b128 v[252:255], v14 offset:35840
  v_mul_f32 v22, s76, v22
  v_mfma_f32_16x16x32_bf16 v[140:143], v[40:43], v[236:239], v[140:143]
  v_mul_f32 v23, s76, v23
  v_cvt_pk_bf16_f32 v28, v16, v17
  v_mfma_f32_16x16x32_bf16 v[156:159], v[44:47], v[236:239], v[156:159]
  v_xor_b32 v14, 0x10000, v14
  v_cvt_pk_bf16_f32 v29, v18, v19
  v_cvt_pk_bf16_f32 v30, v20, v21
  v_mfma_f32_16x16x32_bf16 v[172:175], v[48:51], v[236:239], v[172:175]
  buffer_load_dwordx4 v11, s[36:39], s27 offen offset:3072 lds
  v_cvt_pk_bf16_f32 v31, v22, v23
  v_mfma_f32_16x16x32_bf16 v[188:191], v[52:55], v[236:239], v[188:191]
  s_add_u32 s27, s27, 524288
  buffer_store_dwordx4 v[28:31], v2, s[40:43], s63 offen offset:1024 sc1
  v_mfma_f32_16x16x32_bf16 v[204:207], v[56:59], v[236:239], v[204:207]
  v_mfma_f32_16x16x32_bf16 v[220:223], v[60:63], v[236:239], v[220:223]
  s_waitcnt vmcnt(19) lgkmcnt(0)
  v_mfma_f32_16x16x32_bf16 v[96:99], v[64:67], v[240:243], v[96:99]
  s_barrier
  v_accvgpr_read_b32 v16, a192
  v_accvgpr_read_b32 v17, a193
  v_accvgpr_read_b32 v18, a194
  v_mfma_f32_16x16x32_bf16 v[112:115], v[68:71], v[240:243], v[112:115]
  s_mul_i32 s63, s60, 3
  ds_read_b64_tr_b16 v[32:33], v12 offset:32768
  v_accvgpr_read_b32 v19, a195
  v_mfma_f32_16x16x32_bf16 v[128:131], v[72:75], v[240:243], v[128:131]
  s_add_u32 m0, s24, 32768
  ds_read_b64_tr_b16 v[34:35], v12 offset:33792
  v_accvgpr_read_b32 v20, a224
  v_mfma_f32_16x16x32_bf16 v[144:147], v[76:79], v[240:243], v[144:147]
  s_add_u32 s63, s63, s62
  buffer_load_dwordx4 v3, s[32:35], s26 offen offset:0 sc1 lds
  v_accvgpr_read_b32 v21, a225
  v_accvgpr_read_b32 v22, a226
  v_mfma_f32_16x16x32_bf16 v[160:163], v[80:83], v[240:243], v[160:163]
  ds_read_b64_tr_b16 v[36:37], v13 offset:32768
  v_accvgpr_read_b32 v23, a227
  v_mfma_f32_16x16x32_bf16 v[176:179], v[84:87], v[240:243], v[176:179]
  ds_read_b64_tr_b16 v[38:39], v13 offset:33792
  v_mul_f32 v16, s76, v16
  v_mfma_f32_16x16x32_bf16 v[192:195], v[88:91], v[240:243], v[192:195]
  ds_read_b64_tr_b16 v[40:41], v12 offset:33024
  v_mul_f32 v17, s76, v17
  v_mul_f32 v18, s76, v18
  v_mfma_f32_16x16x32_bf16 v[208:211], v[92:95], v[240:243], v[208:211]
  ds_read_b64_tr_b16 v[42:43], v12 offset:34048
  v_mul_f32 v19, s76, v19
  v_mfma_f32_16x16x32_bf16 v[100:103], v[64:67], v[244:247], v[100:103]
  buffer_load_dwordx4 v4, s[32:35], s26 offen offset:1024 sc1 lds
  v_mul_f32 v20, s76, v20
  v_mfma_f32_16x16x32_bf16 v[116:119], v[68:71], v[244:247], v[116:119]
  ds_read_b64_tr_b16 v[44:45], v13 offset:33024
  v_mul_f32 v21, s76, v21
  v_mfma_f32_16x16x32_bf16 v[132:135], v[72:75], v[244:247], v[132:135]
  ds_read_b64_tr_b16 v[46:47], v13 offset:34048
  v_mul_f32 v22, s76, v22
  v_mul_f32 v23, s76, v23
  v_mfma_f32_16x16x32_bf16 v[148:151], v[76:79], v[244:247], v[148:151]
  ds_read_b128 v[224:227], v14 offset:0
  v_cvt_pk_bf16_f32 v24, v16, v17
  v_mfma_f32_16x16x32_bf16 v[164:167], v[80:83], v[244:247], v[164:167]
  ds_read_b128 v[228:231], v14 offset:1024
  v_cvt_pk_bf16_f32 v25, v18, v19
  v_mfma_f32_16x16x32_bf16 v[180:183], v[84:87], v[244:247], v[180:183]
  buffer_load_dwordx4 v5, s[32:35], s26 offen offset:2048 sc1 lds
  v_cvt_pk_bf16_f32 v26, v20, v21
  v_cvt_pk_bf16_f32 v27, v22, v23
  v_mfma_f32_16x16x32_bf16 v[196:199], v[88:91], v[244:247], v[196:199]
  ds_read_b64_tr_b16 v[48:49], v12 offset:33280
  buffer_store_dwordx4 v[24:27], v2, s[40:43], s63 offen offset:0 sc1
  v_mfma_f32_16x16x32_bf16 v[212:215], v[92:95], v[244:247], v[212:215]
  ds_read_b64_tr_b16 v[50:51], v12 offset:34304
  v_accvgpr_read_b32 v16, a196
  v_mfma_f32_16x16x32_bf16 v[104:107], v[64:67], v[248:251], v[104:107]
  ds_read_b64_tr_b16 v[52:53], v13 offset:33280
  v_accvgpr_read_b32 v17, a197
  v_accvgpr_read_b32 v18, a198
  v_mfma_f32_16x16x32_bf16 v[120:123], v[68:71], v[248:251], v[120:123]
  ds_read_b64_tr_b16 v[54:55], v13 offset:34304
  v_accvgpr_read_b32 v19, a199
  v_mfma_f32_16x16x32_bf16 v[136:139], v[72:75], v[248:251], v[136:139]
  buffer_load_dwordx4 v6, s[32:35], s26 offen offset:3072 sc1 lds
  v_accvgpr_read_b32 v20, a228
  v_mfma_f32_16x16x32_bf16 v[152:155], v[76:79], v[248:251], v[152:155]
  s_add_u32 s26, s26, 1024
  ds_read_b64_tr_b16 v[56:57], v12 offset:33536
  v_accvgpr_read_b32 v21, a229
  v_mfma_f32_16x16x32_bf16 v[168:171], v[80:83], v[248:251], v[168:171]
  ds_read_b64_tr_b16 v[58:59], v12 offset:34560
  v_accvgpr_read_b32 v22, a230
  v_accvgpr_read_b32 v23, a231
  v_mfma_f32_16x16x32_bf16 v[184:187], v[84:87], v[248:251], v[184:187]
  ds_read_b64_tr_b16 v[60:61], v13 offset:33536
  v_mul_f32 v16, s76, v16
  v_mfma_f32_16x16x32_bf16 v[200:203], v[88:91], v[248:251], v[200:203]
  s_add_u32 m0, s24, 16384
  ds_read_b64_tr_b16 v[62:63], v13 offset:34560
  v_mul_f32 v17, s76, v17
  v_mfma_f32_16x16x32_bf16 v[216:219], v[92:95], v[248:251], v[216:219]
  buffer_load_dwordx4 v8, s[36:39], s27 offen offset:0 lds
  v_mul_f32 v18, s76, v18
  v_mul_f32 v19, s76, v19
  v_mfma_f32_16x16x32_bf16 v[108:111], v[64:67], v[252:255], v[108:111]
  ds_read_b128 v[232:235], v14 offset:2048
  v_mul_f32 v20, s76, v20
  v_mfma_f32_16x16x32_bf16 v[124:127], v[68:71], v[252:255], v[124:127]
  ds_read_b128 v[236:239], v14 offset:3072
  v_mul_f32 v21, s76, v21
  v_mfma_f32_16x16x32_bf16 v[140:143], v[72:75], v[252:255], v[140:143]
  v_mul_f32 v22, s76, v22
  v_mul_f32 v23, s76, v23
  v_cvt_pk_bf16_f32 v28, v16, v17
  v_mfma_f32_16x16x32_bf16 v[156:159], v[76:79], v[252:255], v[156:159]
  v_cvt_pk_bf16_f32 v29, v18, v19
  v_cvt_pk_bf16_f32 v30, v20, v21
  v_mfma_f32_16x16x32_bf16 v[172:175], v[80:83], v[252:255], v[172:175]
  buffer_load_dwordx4 v9, s[36:39], s27 offen offset:1024 lds
  v_cvt_pk_bf16_f32 v31, v22, v23
  v_mfma_f32_16x16x32_bf16 v[188:191], v[84:87], v[252:255], v[188:191]
  buffer_store_dwordx4 v[28:31], v2, s[40:43], s63 offen offset:1024 sc1
  v_mfma_f32_16x16x32_bf16 v[204:207], v[88:91], v[252:255], v[204:207]
  v_mfma_f32_16x16x32_bf16 v[220:223], v[92:95], v[252:255], v[220:223]
  s_waitcnt vmcnt(19) lgkmcnt(0)
  v_mfma_f32_16x16x32_bf16 v[96:99], v[32:35], v[224:227], v[96:99]
  s_add_u32 s63, s63, s61
  v_accvgpr_read_b32 v16, a200
  v_accvgpr_read_b32 v17, a201
  v_accvgpr_read_b32 v18, a202
  v_mfma_f32_16x16x32_bf16 v[112:115], v[36:39], v[224:227], v[112:115]
  ds_read_b64_tr_b16 v[64:65], v12 offset:40960
  v_accvgpr_read_b32 v19, a203
  v_mfma_f32_16x16x32_bf16 v[128:131], v[40:43], v[224:227], v[128:131]
  s_add_u32 m0, s24, 65536
  ds_read_b64_tr_b16 v[66:67], v12 offset:41984
  v_accvgpr_read_b32 v20, a232
  v_accvgpr_read_b32 v21, a233
  v_mfma_f32_16x16x32_bf16 v[144:147], v[44:47], v[224:227], v[144:147]
  buffer_load_dwordx4 v3, s[32:35], s26 offen offset:0 sc1 lds
  v_accvgpr_read_b32 v22, a234
  v_mfma_f32_16x16x32_bf16 v[160:163], v[48:51], v[224:227], v[160:163]
  ds_read_b64_tr_b16 v[68:69], v13 offset:40960
  v_accvgpr_read_b32 v23, a235
  v_mfma_f32_16x16x32_bf16 v[176:179], v[52:55], v[224:227], v[176:179]
  ds_read_b64_tr_b16 v[70:71], v13 offset:41984
  v_mul_f32 v16, s76, v16
  v_mul_f32 v17, s76, v17
  v_mfma_f32_16x16x32_bf16 v[192:195], v[56:59], v[224:227], v[192:195]
  ds_read_b64_tr_b16 v[72:73], v12 offset:41216
  v_mul_f32 v18, s76, v18
  v_mfma_f32_16x16x32_bf16 v[208:211], v[60:63], v[224:227], v[208:211]
  ds_read_b64_tr_b16 v[74:75], v12 offset:42240
  v_mul_f32 v19, s76, v19
  v_mul_f32 v20, s76, v20
  v_mfma_f32_16x16x32_bf16 v[100:103], v[32:35], v[228:231], v[100:103]
  buffer_load_dwordx4 v4, s[32:35], s26 offen offset:1024 sc1 lds
  v_mul_f32 v21, s76, v21
  v_mfma_f32_16x16x32_bf16 v[116:119], v[36:39], v[228:231], v[116:119]
  ds_read_b64_tr_b16 v[76:77], v13 offset:41216
  v_mul_f32 v22, s76, v22
  v_mfma_f32_16x16x32_bf16 v[132:135], v[40:43], v[228:231], v[132:135]
  ds_read_b64_tr_b16 v[78:79], v13 offset:42240
  v_mul_f32 v23, s76, v23
  v_cvt_pk_bf16_f32 v24, v16, v17
  v_mfma_f32_16x16x32_bf16 v[148:151], v[44:47], v[228:231], v[148:151]
  ds_read_b128 v[240:243], v14 offset:32768
  v_cvt_pk_bf16_f32 v25, v18, v19
  v_mfma_f32_16x16x32_bf16 v[164:167], v[48:51], v[228:231], v[164:167]
  ds_read_b128 v[244:247], v14 offset:33792
  v_cvt_pk_bf16_f32 v26, v20, v21
  v_cvt_pk_bf16_f32 v27, v22, v23
  v_mfma_f32_16x16x32_bf16 v[180:183], v[52:55], v[228:231], v[180:183]
  buffer_load_dwordx4 v5, s[32:35], s26 offen offset:2048 sc1 lds
  buffer_store_dwordx4 v[24:27], v2, s[40:43], s63 offen offset:0 sc1
  v_mfma_f32_16x16x32_bf16 v[196:199], v[56:59], v[228:231], v[196:199]
  ds_read_b64_tr_b16 v[80:81], v12 offset:41472
  v_accvgpr_read_b32 v16, a204
  v_mfma_f32_16x16x32_bf16 v[212:215], v[60:63], v[228:231], v[212:215]
  ds_read_b64_tr_b16 v[82:83], v12 offset:42496
  v_accvgpr_read_b32 v17, a205
  v_accvgpr_read_b32 v18, a206
  v_mfma_f32_16x16x32_bf16 v[104:107], v[32:35], v[232:235], v[104:107]
  ds_read_b64_tr_b16 v[84:85], v13 offset:41472
  v_accvgpr_read_b32 v19, a207
  v_mfma_f32_16x16x32_bf16 v[120:123], v[36:39], v[232:235], v[120:123]
  ds_read_b64_tr_b16 v[86:87], v13 offset:42496
  v_accvgpr_read_b32 v20, a236
  v_accvgpr_read_b32 v21, a237
  v_mfma_f32_16x16x32_bf16 v[136:139], v[40:43], v[232:235], v[136:139]
  buffer_load_dwordx4 v6, s[32:35], s26 offen offset:3072 sc1 lds
  v_accvgpr_read_b32 v22, a238
  v_mfma_f32_16x16x32_bf16 v[152:155], v[44:47], v[232:235], v[152:155]
  s_add_u32 s26, s26, 1024
  ds_read_b64_tr_b16 v[88:89], v12 offset:41728
  v_accvgpr_read_b32 v23, a239
  v_mfma_f32_16x16x32_bf16 v[168:171], v[48:51], v[232:235], v[168:171]
  ds_read_b64_tr_b16 v[90:91], v12 offset:42752
  v_mul_f32 v16, s76, v16
  v_mul_f32 v17, s76, v17
  v_mfma_f32_16x16x32_bf16 v[184:187], v[52:55], v[232:235], v[184:187]
  ds_read_b64_tr_b16 v[92:93], v13 offset:41728
  v_mul_f32 v18, s76, v18
  v_mfma_f32_16x16x32_bf16 v[200:203], v[56:59], v[232:235], v[200:203]
  s_add_u32 m0, s24, 16384
  ds_read_b64_tr_b16 v[94:95], v13 offset:42752
  v_mul_f32 v19, s76, v19
  v_mul_f32 v20, s76, v20
  v_mfma_f32_16x16x32_bf16 v[216:219], v[60:63], v[232:235], v[216:219]
  buffer_load_dwordx4 v10, s[36:39], s27 offen offset:2048 lds
  v_mul_f32 v21, s76, v21
  v_mfma_f32_16x16x32_bf16 v[108:111], v[32:35], v[236:239], v[108:111]
  ds_read_b128 v[248:251], v14 offset:34816
  v_mul_f32 v22, s76, v22
  v_mfma_f32_16x16x32_bf16 v[124:127], v[36:39], v[236:239], v[124:127]
  ds_read_b128 v[252:255], v14 offset:35840
  v_mul_f32 v23, s76, v23
  v_cvt_pk_bf16_f32 v28, v16, v17
  v_mfma_f32_16x16x32_bf16 v[140:143], v[40:43], v[236:239], v[140:143]
  v_cvt_pk_bf16_f32 v29, v18, v19
  v_cvt_pk_bf16_f32 v30, v20, v21
  v_mfma_f32_16x16x32_bf16 v[156:159], v[44:47], v[236:239], v[156:159]
  v_xor_b32 v14, 0x10000, v14
  v_cvt_pk_bf16_f32 v31, v22, v23
  v_mfma_f32_16x16x32_bf16 v[172:175], v[48:51], v[236:239], v[172:175]
  buffer_load_dwordx4 v11, s[36:39], s27 offen offset:3072 lds
  buffer_store_dwordx4 v[28:31], v2, s[40:43], s63 offen offset:1024 sc1
  v_mfma_f32_16x16x32_bf16 v[188:191], v[52:55], v[236:239], v[188:191]
  s_add_u32 s27, s27, 524288
  v_xor_b32 v12, 0x10000, v12
  v_mfma_f32_16x16x32_bf16 v[204:207], v[56:59], v[236:239], v[204:207]
  v_xor_b32 v13, 0x10000, v13
  v_mfma_f32_16x16x32_bf16 v[220:223], v[60:63], v[236:239], v[220:223]
  s_waitcnt vmcnt(19) lgkmcnt(0)
  v_mfma_f32_16x16x32_bf16 v[96:99], v[64:67], v[240:243], v[96:99]
  s_barrier
  v_accvgpr_read_b32 v16, a208
  v_accvgpr_read_b32 v17, a209
  v_accvgpr_read_b32 v18, a210
  v_mfma_f32_16x16x32_bf16 v[112:115], v[68:71], v[240:243], v[112:115]
  s_add_u32 s63, s63, s61
  ds_read_b64_tr_b16 v[32:33], v12 offset:0
  v_accvgpr_read_b32 v19, a211
  v_mfma_f32_16x16x32_bf16 v[128:131], v[72:75], v[240:243], v[128:131]
  s_add_u32 m0, s24, 98304
  ds_read_b64_tr_b16 v[34:35], v12 offset:1024
  v_accvgpr_read_b32 v20, a240
  v_mfma_f32_16x16x32_bf16 v[144:147], v[76:79], v[240:243], v[144:147]
  buffer_load_dwordx4 v3, s[32:35], s26 offen offset:0 sc1 lds
  v_accvgpr_read_b32 v21, a241
  v_accvgpr_read_b32 v22, a242
  v_mfma_f32_16x16x32_bf16 v[160:163], v[80:83], v[240:243], v[160:163]
  ds_read_b64_tr_b16 v[36:37], v13 offset:0
  v_accvgpr_read_b32 v23, a243
  v_mfma_f32_16x16x32_bf16 v[176:179], v[84:87], v[240:243], v[176:179]
  ds_read_b64_tr_b16 v[38:39], v13 offset:1024
  v_mul_f32 v16, s76, v16
  v_mfma_f32_16x16x32_bf16 v[192:195], v[88:91], v[240:243], v[192:195]
  ds_read_b64_tr_b16 v[40:41], v12 offset:256
  v_mul_f32 v17, s76, v17
  v_mul_f32 v18, s76, v18
  v_mfma_f32_16x16x32_bf16 v[208:211], v[92:95], v[240:243], v[208:211]
  ds_read_b64_tr_b16 v[42:43], v12 offset:1280
  v_mul_f32 v19, s76, v19
  v_mfma_f32_16x16x32_bf16 v[100:103], v[64:67], v[244:247], v[100:103]
  buffer_load_dwordx4 v4, s[32:35], s26 offen offset:1024 sc1 lds
  v_mul_f32 v20, s76, v20
  v_mfma_f32_16x16x32_bf16 v[116:119], v[68:71], v[244:247], v[116:119]
  ds_read_b64_tr_b16 v[44:45], v13 offset:256
  v_mul_f32 v21, s76, v21
  v_mfma_f32_16x16x32_bf16 v[132:135], v[72:75], v[244:247], v[132:135]
  ds_read_b64_tr_b16 v[46:47], v13 offset:1280
  v_mul_f32 v22, s76, v22
  v_mul_f32 v23, s76, v23
  v_mfma_f32_16x16x32_bf16 v[148:151], v[76:79], v[244:247], v[148:151]
  ds_read_b128 v[224:227], v14 offset:0
  v_cvt_pk_bf16_f32 v24, v16, v17
  v_mfma_f32_16x16x32_bf16 v[164:167], v[80:83], v[244:247], v[164:167]
  ds_read_b128 v[228:231], v14 offset:1024
  v_cvt_pk_bf16_f32 v25, v18, v19
  v_mfma_f32_16x16x32_bf16 v[180:183], v[84:87], v[244:247], v[180:183]
  buffer_load_dwordx4 v5, s[32:35], s26 offen offset:2048 sc1 lds
  v_cvt_pk_bf16_f32 v26, v20, v21
  v_cvt_pk_bf16_f32 v27, v22, v23
  v_mfma_f32_16x16x32_bf16 v[196:199], v[88:91], v[244:247], v[196:199]
  ds_read_b64_tr_b16 v[48:49], v12 offset:512
  buffer_store_dwordx4 v[24:27], v2, s[40:43], s63 offen offset:0 sc1
  v_mfma_f32_16x16x32_bf16 v[212:215], v[92:95], v[244:247], v[212:215]
  ds_read_b64_tr_b16 v[50:51], v12 offset:1536
  v_accvgpr_read_b32 v16, a212
  v_mfma_f32_16x16x32_bf16 v[104:107], v[64:67], v[248:251], v[104:107]
  ds_read_b64_tr_b16 v[52:53], v13 offset:512
  v_accvgpr_read_b32 v17, a213
  v_accvgpr_read_b32 v18, a214
  v_mfma_f32_16x16x32_bf16 v[120:123], v[68:71], v[248:251], v[120:123]
  ds_read_b64_tr_b16 v[54:55], v13 offset:1536
  v_accvgpr_read_b32 v19, a215
  v_mfma_f32_16x16x32_bf16 v[136:139], v[72:75], v[248:251], v[136:139]
  buffer_load_dwordx4 v6, s[32:35], s26 offen offset:3072 sc1 lds
  v_accvgpr_read_b32 v20, a244
  v_mfma_f32_16x16x32_bf16 v[152:155], v[76:79], v[248:251], v[152:155]
  s_add_u32 s26, s26, 1024
  ds_read_b64_tr_b16 v[56:57], v12 offset:768
  v_accvgpr_read_b32 v21, a245
  v_mfma_f32_16x16x32_bf16 v[168:171], v[80:83], v[248:251], v[168:171]
  ds_read_b64_tr_b16 v[58:59], v12 offset:1792
  v_accvgpr_read_b32 v22, a246
  v_accvgpr_read_b32 v23, a247
  v_mfma_f32_16x16x32_bf16 v[184:187], v[84:87], v[248:251], v[184:187]
  ds_read_b64_tr_b16 v[60:61], v13 offset:768
  v_mul_f32 v16, s76, v16
  v_mfma_f32_16x16x32_bf16 v[200:203], v[88:91], v[248:251], v[200:203]
  s_add_u32 m0, s24, 49152
  ds_read_b64_tr_b16 v[62:63], v13 offset:1792
  v_mul_f32 v17, s76, v17
  v_mfma_f32_16x16x32_bf16 v[216:219], v[92:95], v[248:251], v[216:219]
  buffer_load_dwordx4 v8, s[36:39], s27 offen offset:0 lds
  v_mul_f32 v18, s76, v18
  v_mul_f32 v19, s76, v19
  v_mfma_f32_16x16x32_bf16 v[108:111], v[64:67], v[252:255], v[108:111]
  ds_read_b128 v[232:235], v14 offset:2048
  v_mul_f32 v20, s76, v20
  v_mfma_f32_16x16x32_bf16 v[124:127], v[68:71], v[252:255], v[124:127]
  ds_read_b128 v[236:239], v14 offset:3072
  v_mul_f32 v21, s76, v21
  v_mfma_f32_16x16x32_bf16 v[140:143], v[72:75], v[252:255], v[140:143]
  v_mul_f32 v22, s76, v22
  v_mul_f32 v23, s76, v23
  v_cvt_pk_bf16_f32 v28, v16, v17
  v_mfma_f32_16x16x32_bf16 v[156:159], v[76:79], v[252:255], v[156:159]
  v_cvt_pk_bf16_f32 v29, v18, v19
  v_cvt_pk_bf16_f32 v30, v20, v21
  v_mfma_f32_16x16x32_bf16 v[172:175], v[80:83], v[252:255], v[172:175]
  buffer_load_dwordx4 v9, s[36:39], s27 offen offset:1024 lds
  v_cvt_pk_bf16_f32 v31, v22, v23
  v_mfma_f32_16x16x32_bf16 v[188:191], v[84:87], v[252:255], v[188:191]
  buffer_store_dwordx4 v[28:31], v2, s[40:43], s63 offen offset:1024 sc1
  v_mfma_f32_16x16x32_bf16 v[204:207], v[88:91], v[252:255], v[204:207]
  v_mfma_f32_16x16x32_bf16 v[220:223], v[92:95], v[252:255], v[220:223]
  s_waitcnt vmcnt(19) lgkmcnt(0)
  v_mfma_f32_16x16x32_bf16 v[96:99], v[32:35], v[224:227], v[96:99]
  s_add_u32 s63, s63, s61
  v_accvgpr_read_b32 v16, a216
  v_accvgpr_read_b32 v17, a217
  v_accvgpr_read_b32 v18, a218
  v_mfma_f32_16x16x32_bf16 v[112:115], v[36:39], v[224:227], v[112:115]
  ds_read_b64_tr_b16 v[64:65], v12 offset:8192
  v_accvgpr_read_b32 v19, a219
  v_mfma_f32_16x16x32_bf16 v[128:131], v[40:43], v[224:227], v[128:131]
  s_add_u32 m0, s24, 0
  ds_read_b64_tr_b16 v[66:67], v12 offset:9216
  v_accvgpr_read_b32 v20, a248
  v_mfma_f32_16x16x32_bf16 v[144:147], v[44:47], v[224:227], v[144:147]
  buffer_load_dwordx4 v3, s[32:35], s26 offen offset:0 sc1 lds
  v_accvgpr_read_b32 v21, a249
  v_accvgpr_read_b32 v22, a250
  v_mfma_f32_16x16x32_bf16 v[160:163], v[48:51], v[224:227], v[160:163]
  ds_read_b64_tr_b16 v[68:69], v13 offset:8192
  v_accvgpr_read_b32 v23, a251
  v_mfma_f32_16x16x32_bf16 v[176:179], v[52:55], v[224:227], v[176:179]
  ds_read_b64_tr_b16 v[70:71], v13 offset:9216
  v_mul_f32 v16, s76, v16
  v_mfma_f32_16x16x32_bf16 v[192:195], v[56:59], v[224:227], v[192:195]
  ds_read_b64_tr_b16 v[72:73], v12 offset:8448
  v_mul_f32 v17, s76, v17
  v_mul_f32 v18, s76, v18
  v_mfma_f32_16x16x32_bf16 v[208:211], v[60:63], v[224:227], v[208:211]
  ds_read_b64_tr_b16 v[74:75], v12 offset:9472
  v_mul_f32 v19, s76, v19
  v_mfma_f32_16x16x32_bf16 v[100:103], v[32:35], v[228:231], v[100:103]
  buffer_load_dwordx4 v4, s[32:35], s26 offen offset:1024 sc1 lds
  v_mul_f32 v20, s76, v20
  v_mfma_f32_16x16x32_bf16 v[116:119], v[36:39], v[228:231], v[116:119]
  ds_read_b64_tr_b16 v[76:77], v13 offset:8448
  v_mul_f32 v21, s76, v21
  v_mul_f32 v22, s76, v22
  v_mfma_f32_16x16x32_bf16 v[132:135], v[40:43], v[228:231], v[132:135]
  ds_read_b64_tr_b16 v[78:79], v13 offset:9472
  v_mul_f32 v23, s76, v23
  v_mfma_f32_16x16x32_bf16 v[148:151], v[44:47], v[228:231], v[148:151]
  ds_read_b128 v[240:243], v14 offset:32768
  v_cvt_pk_bf16_f32 v24, v16, v17
  v_mfma_f32_16x16x32_bf16 v[164:167], v[48:51], v[228:231], v[164:167]
  ds_read_b128 v[244:247], v14 offset:33792
  v_cvt_pk_bf16_f32 v25, v18, v19
  v_cvt_pk_bf16_f32 v26, v20, v21
  v_mfma_f32_16x16x32_bf16 v[180:183], v[52:55], v[228:231], v[180:183]
  buffer_load_dwordx4 v5, s[32:35], s26 offen offset:2048 sc1 lds
  v_cvt_pk_bf16_f32 v27, v22, v23
  v_mfma_f32_16x16x32_bf16 v[196:199], v[56:59], v[228:231], v[196:199]
  ds_read_b64_tr_b16 v[80:81], v12 offset:8704
  buffer_store_dwordx4 v[24:27], v2, s[40:43], s63 offen offset:0 sc1
  v_mfma_f32_16x16x32_bf16 v[212:215], v[60:63], v[228:231], v[212:215]
  ds_read_b64_tr_b16 v[82:83], v12 offset:9728
  v_accvgpr_read_b32 v16, a220
  v_accvgpr_read_b32 v17, a221
  v_mfma_f32_16x16x32_bf16 v[104:107], v[32:35], v[232:235], v[104:107]
  ds_read_b64_tr_b16 v[84:85], v13 offset:8704
  v_accvgpr_read_b32 v18, a222
  v_mfma_f32_16x16x32_bf16 v[120:123], v[36:39], v[232:235], v[120:123]
  ds_read_b64_tr_b16 v[86:87], v13 offset:9728
  v_accvgpr_read_b32 v19, a223
  v_mfma_f32_16x16x32_bf16 v[136:139], v[40:43], v[232:235], v[136:139]
  buffer_load_dwordx4 v6, s[32:35], s26 offen offset:3072 sc1 lds
  v_accvgpr_read_b32 v20, a252
  v_accvgpr_read_b32 v21, a253
  v_mfma_f32_16x16x32_bf16 v[152:155], v[44:47], v[232:235], v[152:155]
  s_add_u32 s26, s26, 1024
  ds_read_b64_tr_b16 v[88:89], v12 offset:8960
  v_accvgpr_read_b32 v22, a254
  v_mfma_f32_16x16x32_bf16 v[168:171], v[48:51], v[232:235], v[168:171]
  ds_read_b64_tr_b16 v[90:91], v12 offset:9984
  v_accvgpr_read_b32 v23, a255
  v_mfma_f32_16x16x32_bf16 v[184:187], v[52:55], v[232:235], v[184:187]
  ds_read_b64_tr_b16 v[92:93], v13 offset:8960
  v_mul_f32 v16, s76, v16
  v_mul_f32 v17, s76, v17
  v_mfma_f32_16x16x32_bf16 v[200:203], v[56:59], v[232:235], v[200:203]
  s_add_u32 m0, s24, 49152
  ds_read_b64_tr_b16 v[94:95], v13 offset:9984
  v_mul_f32 v18, s76, v18
  v_mfma_f32_16x16x32_bf16 v[216:219], v[60:63], v[232:235], v[216:219]
  buffer_load_dwordx4 v10, s[36:39], s27 offen offset:2048 lds
  v_mul_f32 v19, s76, v19
  v_mfma_f32_16x16x32_bf16 v[108:111], v[32:35], v[236:239], v[108:111]
  ds_read_b128 v[248:251], v14 offset:34816
  v_mul_f32 v20, s76, v20
  v_mul_f32 v21, s76, v21
  v_mfma_f32_16x16x32_bf16 v[124:127], v[36:39], v[236:239], v[124:127]
  ds_read_b128 v[252:255], v14 offset:35840
  v_mul_f32 v22, s76, v22
  v_mfma_f32_16x16x32_bf16 v[140:143], v[40:43], v[236:239], v[140:143]
  v_mul_f32 v23, s76, v23
  v_cvt_pk_bf16_f32 v28, v16, v17
  v_mfma_f32_16x16x32_bf16 v[156:159], v[44:47], v[236:239], v[156:159]
  v_xor_b32 v14, 0x10000, v14
  v_cvt_pk_bf16_f32 v29, v18, v19
  v_cvt_pk_bf16_f32 v30, v20, v21
  v_mfma_f32_16x16x32_bf16 v[172:175], v[48:51], v[236:239], v[172:175]
  buffer_load_dwordx4 v11, s[36:39], s27 offen offset:3072 lds
  v_cvt_pk_bf16_f32 v31, v22, v23
  v_mfma_f32_16x16x32_bf16 v[188:191], v[52:55], v[236:239], v[188:191]
  s_add_u32 s27, s27, 524288
  buffer_store_dwordx4 v[28:31], v2, s[40:43], s63 offen offset:1024 sc1
  v_mfma_f32_16x16x32_bf16 v[204:207], v[56:59], v[236:239], v[204:207]
  v_mfma_f32_16x16x32_bf16 v[220:223], v[60:63], v[236:239], v[220:223]
  s_waitcnt vmcnt(19) lgkmcnt(0)
  v_mfma_f32_16x16x32_bf16 v[96:99], v[64:67], v[240:243], v[96:99]
  s_barrier
  v_and_b32 v11, 15, v1
  v_lshrrev_b32 v10, 4, v1
  v_mfma_f32_16x16x32_bf16 v[112:115], v[68:71], v[240:243], v[112:115]
  ds_read_b64_tr_b16 v[32:33], v12 offset:32768
  v_lshlrev_b32 v10, 2, v10
  v_mfma_f32_16x16x32_bf16 v[128:131], v[72:75], v[240:243], v[128:131]
  s_add_u32 m0, s24, 32768
  ds_read_b64_tr_b16 v[34:35], v12 offset:33792
  v_sub_u32 v11, v11, v10
  v_mfma_f32_16x16x32_bf16 v[144:147], v[76:79], v[240:243], v[144:147]
  buffer_load_dwordx4 v3, s[32:35], s26 offen offset:0 sc1 lds
  v_cmp_le_i32 s[68:69], 0, v11
  v_mfma_f32_16x16x32_bf16 v[160:163], v[80:83], v[240:243], v[160:163]
  ds_read_b64_tr_b16 v[36:37], v13 offset:32768
  v_cmp_le_i32 s[70:71], 1, v11
  v_mfma_f32_16x16x32_bf16 v[176:179], v[84:87], v[240:243], v[176:179]
  ds_read_b64_tr_b16 v[38:39], v13 offset:33792
  v_cmp_le_i32 s[72:73], 2, v11
  v_mfma_f32_16x16x32_bf16 v[192:195], v[88:91], v[240:243], v[192:195]
  ds_read_b64_tr_b16 v[40:41], v12 offset:33024
  v_cmp_le_i32 s[74:75], 3, v11
  v_mfma_f32_16x16x32_bf16 v[208:211], v[92:95], v[240:243], v[208:211]
  ds_read_b64_tr_b16 v[42:43], v12 offset:34048
  v_and_b32 v8, 7, v1
  v_mfma_f32_16x16x32_bf16 v[100:103], v[64:67], v[244:247], v[100:103]
  buffer_load_dwordx4 v4, s[32:35], s26 offen offset:1024 sc1 lds
  v_lshlrev_b32 v8, 2, v8
  v_mfma_f32_16x16x32_bf16 v[116:119], v[68:71], v[244:247], v[116:119]
  ds_read_b64_tr_b16 v[44:45], v13 offset:33024
  v_add_u32 v8, s30, v8
  v_mfma_f32_16x16x32_bf16 v[132:135], v[72:75], v[244:247], v[132:135]
  ds_read_b64_tr_b16 v[46:47], v13 offset:34048
  v_accvgpr_write_b32 a0, 0
  v_mfma_f32_16x16x32_bf16 v[148:151], v[76:79], v[244:247], v[148:151]
  ds_read_b128 v[224:227], v14 offset:0
  v_accvgpr_write_b32 a1, 0
  v_mfma_f32_16x16x32_bf16 v[164:167], v[80:83], v[244:247], v[164:167]
  ds_read_b128 v[228:231], v14 offset:1024
  v_accvgpr_write_b32 a2, 0
  v_mfma_f32_16x16x32_bf16 v[180:183], v[84:87], v[244:247], v[180:183]
  buffer_load_dwordx4 v5, s[32:35], s26 offen offset:2048 sc1 lds
  v_accvgpr_write_b32 a3, 0
  v_mfma_f32_16x16x32_bf16 v[196:199], v[88:91], v[244:247], v[196:199]
  ds_read_b64_tr_b16 v[48:49], v12 offset:33280
  v_accvgpr_write_b32 a32, 0
  v_mfma_f32_16x16x32_bf16 v[212:215], v[92:95], v[244:247], v[212:215]
  ds_read_b64_tr_b16 v[50:51], v12 offset:34304
  v_accvgpr_write_b32 a33, 0
  v_mfma_f32_16x16x32_bf16 v[104:107], v[64:67], v[248:251], v[104:107]
  ds_read_b64_tr_b16 v[52:53], v13 offset:33280
  v_accvgpr_write_b32 a34, 0
  v_mfma_f32_16x16x32_bf16 v[120:123], v[68:71], v[248:251], v[120:123]
  ds_read_b64_tr_b16 v[54:55], v13 offset:34304
  v_accvgpr_write_b32 a35, 0
  v_mfma_f32_16x16x32_bf16 v[136:139], v[72:75], v[248:251], v[136:139]
  buffer_load_dwordx4 v6, s[32:35], s26 offen offset:3072 sc1 lds
  v_accvgpr_write_b32 a4, 0
  v_mfma_f32_16x16x32_bf16 v[152:155], v[76:79], v[248:251], v[152:155]
  s_add_u32 s26, s26, 1024
  ds_read_b64_tr_b16 v[56:57], v12 offset:33536
  v_accvgpr_write_b32 a5, 0
  v_mfma_f32_16x16x32_bf16 v[168:171], v[80:83], v[248:251], v[168:171]
  ds_read_b64_tr_b16 v[58:59], v12 offset:34560
  v_accvgpr_write_b32 a6, 0
  v_mfma_f32_16x16x32_bf16 v[184:187], v[84:87], v[248:251], v[184:187]
  ds_read_b64_tr_b16 v[60:61], v13 offset:33536
  v_accvgpr_write_b32 a7, 0
  v_mfma_f32_16x16x32_bf16 v[200:203], v[88:91], v[248:251], v[200:203]
  ds_read_b64_tr_b16 v[62:63], v13 offset:34560
  v_accvgpr_write_b32 a36, 0
  v_mfma_f32_16x16x32_bf16 v[216:219], v[92:95], v[248:251], v[216:219]
  v_accvgpr_write_b32 a37, 0
  v_accvgpr_write_b32 a38, 0
  v_mfma_f32_16x16x32_bf16 v[108:111], v[64:67], v[252:255], v[108:111]
  ds_read_b128 v[232:235], v14 offset:2048
  v_accvgpr_write_b32 a39, 0
  v_mfma_f32_16x16x32_bf16 v[124:127], v[68:71], v[252:255], v[124:127]
  ds_read_b128 v[236:239], v14 offset:3072
  v_accvgpr_write_b32 a8, 0
  v_mfma_f32_16x16x32_bf16 v[140:143], v[72:75], v[252:255], v[140:143]
  v_accvgpr_write_b32 a9, 0
  v_accvgpr_write_b32 a10, 0
  v_mfma_f32_16x16x32_bf16 v[156:159], v[76:79], v[252:255], v[156:159]
  v_accvgpr_write_b32 a11, 0
  v_accvgpr_write_b32 a40, 0
  v_mfma_f32_16x16x32_bf16 v[172:175], v[80:83], v[252:255], v[172:175]
  v_accvgpr_write_b32 a41, 0
  v_accvgpr_write_b32 a42, 0
  v_mfma_f32_16x16x32_bf16 v[188:191], v[84:87], v[252:255], v[188:191]
  v_accvgpr_write_b32 a43, 0
  v_accvgpr_write_b32 a12, 0
  v_mfma_f32_16x16x32_bf16 v[204:207], v[88:91], v[252:255], v[204:207]
  v_accvgpr_write_b32 a13, 0
  v_mfma_f32_16x16x32_bf16 v[220:223], v[92:95], v[252:255], v[220:223]
  s_waitcnt vmcnt(15) lgkmcnt(0)
  v_mfma_f32_16x16x32_bf16 v[96:99], v[32:35], v[224:227], v[96:99]
  v_accvgpr_write_b32 a14, 0
  v_accvgpr_write_b32 a15, 0
  v_mfma_f32_16x16x32_bf16 v[112:115], v[36:39], v[224:227], v[112:115]
  ds_read_b64_tr_b16 v[64:65], v12 offset:40960
  v_accvgpr_write_b32 a44, 0
  v_mfma_f32_16x16x32_bf16 v[128:131], v[40:43], v[224:227], v[128:131]
  s_add_u32 m0, s24, 65536
  ds_read_b64_tr_b16 v[66:67], v12 offset:41984
  v_accvgpr_write_b32 a45, 0
  v_mfma_f32_16x16x32_bf16 v[144:147], v[44:47], v[224:227], v[144:147]
  buffer_load_dwordx4 v3, s[32:35], s26 offen offset:0 sc1 lds
  v_accvgpr_write_b32 a46, 0
  v_mfma_f32_16x16x32_bf16 v[160:163], v[48:51], v[224:227], v[160:163]
  ds_read_b64_tr_b16 v[68:69], v13 offset:40960
  v_accvgpr_write_b32 a47, 0
  v_mfma_f32_16x16x32_bf16 v[176:179], v[52:55], v[224:227], v[176:179]
  ds_read_b64_tr_b16 v[70:71], v13 offset:41984
  v_accvgpr_write_b32 a16, 0
  v_mfma_f32_16x16x32_bf16 v[192:195], v[56:59], v[224:227], v[192:195]
  ds_read_b64_tr_b16 v[72:73], v12 offset:41216
  v_accvgpr_write_b32 a17, 0
  v_mfma_f32_16x16x32_bf16 v[208:211], v[60:63], v[224:227], v[208:211]
  ds_read_b64_tr_b16 v[74:75], v12 offset:42240
  v_accvgpr_write_b32 a18, 0
  v_mfma_f32_16x16x32_bf16 v[100:103], v[32:35], v[228:231], v[100:103]
  buffer_load_dwordx4 v4, s[32:35], s26 offen offset:1024 sc1 lds
  v_accvgpr_write_b32 a19, 0
  v_mfma_f32_16x16x32_bf16 v[116:119], v[36:39], v[228:231], v[116:119]
  ds_read_b64_tr_b16 v[76:77], v13 offset:41216
  v_accvgpr_write_b32 a48, 0
  v_mfma_f32_16x16x32_bf16 v[132:135], v[40:43], v[228:231], v[132:135]
  ds_read_b64_tr_b16 v[78:79], v13 offset:42240
  v_accvgpr_write_b32 a49, 0
  v_mfma_f32_16x16x32_bf16 v[148:151], v[44:47], v[228:231], v[148:151]
  ds_read_b128 v[240:243], v14 offset:32768
  v_accvgpr_write_b32 a50, 0
  v_mfma_f32_16x16x32_bf16 v[164:167], v[48:51], v[228:231], v[164:167]
  ds_read_b128 v[244:247], v14 offset:33792
  v_accvgpr_write_b32 a51, 0
  v_mfma_f32_16x16x32_bf16 v[180:183], v[52:55], v[228:231], v[180:183]
  buffer_load_dwordx4 v5, s[32:35], s26 offen offset:2048 sc1 lds
  v_accvgpr_write_b32 a20, 0
  v_mfma_f32_16x16x32_bf16 v[196:199], v[56:59], v[228:231], v[196:199]
  ds_read_b64_tr_b16 v[80:81], v12 offset:41472
  v_accvgpr_write_b32 a21, 0
  v_mfma_f32_16x16x32_bf16 v[212:215], v[60:63], v[228:231], v[212:215]
  ds_read_b64_tr_b16 v[82:83], v12 offset:42496
  v_accvgpr_write_b32 a22, 0
  v_mfma_f32_16x16x32_bf16 v[104:107], v[32:35], v[232:235], v[104:107]
  ds_read_b64_tr_b16 v[84:85], v13 offset:41472
  v_accvgpr_write_b32 a23, 0
  v_mfma_f32_16x16x32_bf16 v[120:123], v[36:39], v[232:235], v[120:123]
  ds_read_b64_tr_b16 v[86:87], v13 offset:42496
  v_accvgpr_write_b32 a52, 0
  v_mfma_f32_16x16x32_bf16 v[136:139], v[40:43], v[232:235], v[136:139]
  buffer_load_dwordx4 v6, s[32:35], s26 offen offset:3072 sc1 lds
  v_accvgpr_write_b32 a53, 0
  v_mfma_f32_16x16x32_bf16 v[152:155], v[44:47], v[232:235], v[152:155]
  s_add_u32 s26, s26, 1024
  ds_read_b64_tr_b16 v[88:89], v12 offset:41728
  v_accvgpr_write_b32 a54, 0
  v_mfma_f32_16x16x32_bf16 v[168:171], v[48:51], v[232:235], v[168:171]
  ds_read_b64_tr_b16 v[90:91], v12 offset:42752
  v_accvgpr_write_b32 a55, 0
  v_mfma_f32_16x16x32_bf16 v[184:187], v[52:55], v[232:235], v[184:187]
  ds_read_b64_tr_b16 v[92:93], v13 offset:41728
  v_accvgpr_write_b32 a24, 0
  v_mfma_f32_16x16x32_bf16 v[200:203], v[56:59], v[232:235], v[200:203]
  ds_read_b64_tr_b16 v[94:95], v13 offset:42752
  v_accvgpr_write_b32 a25, 0
  v_mfma_f32_16x16x32_bf16 v[216:219], v[60:63], v[232:235], v[216:219]
  v_accvgpr_write_b32 a26, 0
  v_accvgpr_write_b32 a27, 0
  v_mfma_f32_16x16x32_bf16 v[108:111], v[32:35], v[236:239], v[108:111]
  ds_read_b128 v[248:251], v14 offset:34816
  v_accvgpr_write_b32 a56, 0
  v_mfma_f32_16x16x32_bf16 v[124:127], v[36:39], v[236:239], v[124:127]
  ds_read_b128 v[252:255], v14 offset:35840
  v_accvgpr_write_b32 a57, 0
  v_mfma_f32_16x16x32_bf16 v[140:143], v[40:43], v[236:239], v[140:143]
  v_accvgpr_write_b32 a58, 0
  v_accvgpr_write_b32 a59, 0
  v_mfma_f32_16x16x32_bf16 v[156:159], v[44:47], v[236:239], v[156:159]
  v_xor_b32 v14, 0x10000, v14
  v_accvgpr_write_b32 a28, 0
  v_mfma_f32_16x16x32_bf16 v[172:175], v[48:51], v[236:239], v[172:175]
  v_accvgpr_write_b32 a29, 0
  v_accvgpr_write_b32 a30, 0
  v_mfma_f32_16x16x32_bf16 v[188:191], v[52:55], v[236:239], v[188:191]
  v_xor_b32 v12, 0x10000, v12
  v_accvgpr_write_b32 a31, 0
  v_mfma_f32_16x16x32_bf16 v[204:207], v[56:59], v[236:239], v[204:207]
  v_xor_b32 v13, 0x10000, v13
  v_mfma_f32_16x16x32_bf16 v[220:223], v[60:63], v[236:239], v[220:223]
  s_waitcnt vmcnt(8) lgkmcnt(0)
  v_mfma_f32_16x16x32_bf16 v[96:99], v[64:67], v[240:243], v[96:99]
  s_barrier
  buffer_store_dword v12, off, s[40:43], s29 sc1
  v_accvgpr_write_b32 a60, 0
  v_mfma_f32_16x16x32_bf16 v[112:115], v[68:71], v[240:243], v[112:115]
  ds_read_b64_tr_b16 v[32:33], v12 offset:0
  v_accvgpr_write_b32 a61, 0
  v_mfma_f32_16x16x32_bf16 v[128:131], v[72:75], v[240:243], v[128:131]
  s_add_u32 m0, s24, 98304
  ds_read_b64_tr_b16 v[34:35], v12 offset:1024
  v_accvgpr_write_b32 a62, 0
  v_mfma_f32_16x16x32_bf16 v[144:147], v[76:79], v[240:243], v[144:147]
  buffer_load_dwordx4 v3, s[32:35], s26 offen offset:0 sc1 lds
  v_accvgpr_write_b32 a63, 0
  v_mfma_f32_16x16x32_bf16 v[160:163], v[80:83], v[240:243], v[160:163]
  ds_read_b64_tr_b16 v[36:37], v13 offset:0
  v_accvgpr_write_b32 a64, 0
  v_mfma_f32_16x16x32_bf16 v[176:179], v[84:87], v[240:243], v[176:179]
  ds_read_b64_tr_b16 v[38:39], v13 offset:1024
  v_accvgpr_write_b32 a65, 0
  v_mfma_f32_16x16x32_bf16 v[192:195], v[88:91], v[240:243], v[192:195]
  ds_read_b64_tr_b16 v[40:41], v12 offset:256
  v_accvgpr_write_b32 a66, 0
  v_mfma_f32_16x16x32_bf16 v[208:211], v[92:95], v[240:243], v[208:211]
  ds_read_b64_tr_b16 v[42:43], v12 offset:1280
  v_accvgpr_write_b32 a67, 0
  v_mfma_f32_16x16x32_bf16 v[100:103], v[64:67], v[244:247], v[100:103]
  buffer_load_dwordx4 v4, s[32:35], s26 offen offset:1024 sc1 lds
  v_accvgpr_write_b32 a96, 0
  v_mfma_f32_16x16x32_bf16 v[116:119], v[68:71], v[244:247], v[116:119]
  ds_read_b64_tr_b16 v[44:45], v13 offset:256
  v_accvgpr_write_b32 a97, 0
  v_mfma_f32_16x16x32_bf16 v[132:135], v[72:75], v[244:247], v[132:135]
  ds_read_b64_tr_b16 v[46:47], v13 offset:1280
  v_accvgpr_write_b32 a98, 0
  v_mfma_f32_16x16x32_bf16 v[148:151], v[76:79], v[244:247], v[148:151]
  ds_read_b128 v[224:227], v14 offset:0
  v_accvgpr_write_b32 a99, 0
  v_mfma_f32_16x16x32_bf16 v[164:167], v[80:83], v[244:247], v[164:167]
  ds_read_b128 v[228:231], v14 offset:1024
  v_accvgpr_write_b32 a68, 0
  v_mfma_f32_16x16x32_bf16 v[180:183], v[84:87], v[244:247], v[180:183]
  buffer_load_dwordx4 v5, s[32:35], s26 offen offset:2048 sc1 lds
  v_accvgpr_write_b32 a69, 0
  v_mfma_f32_16x16x32_bf16 v[196:199], v[88:91], v[244:247], v[196:199]
  ds_read_b64_tr_b16 v[48:49], v12 offset:512
  v_accvgpr_write_b32 a70, 0
  v_mfma_f32_16x16x32_bf16 v[212:215], v[92:95], v[244:247], v[212:215]
  ds_read_b64_tr_b16 v[50:51], v12 offset:1536
  v_accvgpr_write_b32 a71, 0
  v_mfma_f32_16x16x32_bf16 v[104:107], v[64:67], v[248:251], v[104:107]
  ds_read_b64_tr_b16 v[52:53], v13 offset:512
  v_accvgpr_write_b32 a100, 0
  v_mfma_f32_16x16x32_bf16 v[120:123], v[68:71], v[248:251], v[120:123]
  ds_read_b64_tr_b16 v[54:55], v13 offset:1536
  v_accvgpr_write_b32 a101, 0
  v_mfma_f32_16x16x32_bf16 v[136:139], v[72:75], v[248:251], v[136:139]
  buffer_load_dwordx4 v6, s[32:35], s26 offen offset:3072 sc1 lds
  v_accvgpr_write_b32 a102, 0
  v_mfma_f32_16x16x32_bf16 v[152:155], v[76:79], v[248:251], v[152:155]
  s_add_u32 s26, s26, 1024
  ds_read_b64_tr_b16 v[56:57], v12 offset:768
  v_accvgpr_write_b32 a103, 0
  v_mfma_f32_16x16x32_bf16 v[168:171], v[80:83], v[248:251], v[168:171]
  ds_read_b64_tr_b16 v[58:59], v12 offset:1792
  v_accvgpr_write_b32 a72, 0
  v_mfma_f32_16x16x32_bf16 v[184:187], v[84:87], v[248:251], v[184:187]
  ds_read_b64_tr_b16 v[60:61], v13 offset:768
  v_accvgpr_write_b32 a73, 0
  v_mfma_f32_16x16x32_bf16 v[200:203], v[88:91], v[248:251], v[200:203]
  ds_read_b64_tr_b16 v[62:63], v13 offset:1792
  v_accvgpr_write_b32 a74, 0
  v_mfma_f32_16x16x32_bf16 v[216:219], v[92:95], v[248:251], v[216:219]
  v_accvgpr_write_b32 a75, 0
  v_accvgpr_write_b32 a104, 0
  v_mfma_f32_16x16x32_bf16 v[108:111], v[64:67], v[252:255], v[108:111]
  ds_read_b128 v[232:235], v14 offset:2048
  v_accvgpr_write_b32 a105, 0
  v_mfma_f32_16x16x32_bf16 v[124:127], v[68:71], v[252:255], v[124:127]
  ds_read_b128 v[236:239], v14 offset:3072
  v_accvgpr_write_b32 a106, 0
  v_mfma_f32_16x16x32_bf16 v[140:143], v[72:75], v[252:255], v[140:143]
  v_accvgpr_write_b32 a107, 0
  v_accvgpr_write_b32 a76, 0
  v_mfma_f32_16x16x32_bf16 v[156:159], v[76:79], v[252:255], v[156:159]
  v_accvgpr_write_b32 a77, 0
  v_accvgpr_write_b32 a78, 0
  v_mfma_f32_16x16x32_bf16 v[172:175], v[80:83], v[252:255], v[172:175]
  v_accvgpr_write_b32 a79, 0
  v_accvgpr_write_b32 a108, 0
  v_mfma_f32_16x16x32_bf16 v[188:191], v[84:87], v[252:255], v[188:191]
  v_accvgpr_write_b32 a109, 0
  v_accvgpr_write_b32 a110, 0
  v_mfma_f32_16x16x32_bf16 v[204:207], v[88:91], v[252:255], v[204:207]
  v_accvgpr_write_b32 a111, 0
  v_mfma_f32_16x16x32_bf16 v[220:223], v[92:95], v[252:255], v[220:223]
  s_waitcnt vmcnt(9) lgkmcnt(0)
  v_mfma_f32_16x16x32_bf16 v[96:99], v[32:35], v[224:227], v[96:99]
  s_mul_i32 s34, s20, 5120
  v_add_u32 v20, 0, v1
  v_mul_u32_u24 v19, 6554, v20
  v_mfma_f32_16x16x32_bf16 v[112:115], v[36:39], v[224:227], v[112:115]
  s_add_u32 s34, s34, 131072
  ds_read_b64_tr_b16 v[64:65], v12 offset:8192
  v_lshrrev_b32 v19, 16, v19
  v_mfma_f32_16x16x32_bf16 v[128:131], v[40:43], v[224:227], v[128:131]
  s_and_b32 s32, s21, 3
  ds_read_b64_tr_b16 v[66:67], v12 offset:9216
  v_mul_u32_u24 v19, 1120, v19
  v_mfma_f32_16x16x32_bf16 v[144:147], v[44:47], v[224:227], v[144:147]
  s_add_u32 s32, s32, 6
  v_lshl_add_u32 v24, v20, 4, v19
  v_accvgpr_write_b32 a248, v24
  v_mfma_f32_16x16x32_bf16 v[160:163], v[48:51], v[224:227], v[160:163]
  s_lshl_b32 s32, s32, 14
  ds_read_b64_tr_b16 v[68:69], v13 offset:8192
  v_add_u32 v20, 64, v1
  v_mfma_f32_16x16x32_bf16 v[176:179], v[52:55], v[224:227], v[176:179]
  s_cmp_lt_u32 s2, 64
  ds_read_b64_tr_b16 v[70:71], v13 offset:9216
  v_mul_u32_u24 v19, 6554, v20
  v_mfma_f32_16x16x32_bf16 v[192:195], v[56:59], v[224:227], v[192:195]
  s_cselect_b32 s32, s32, 0
  ds_read_b64_tr_b16 v[72:73], v12 offset:8448
  v_lshrrev_b32 v19, 16, v19
  v_mfma_f32_16x16x32_bf16 v[208:211], v[60:63], v[224:227], v[208:211]
  s_cselect_b32 s9, -1, 0
  ds_read_b64_tr_b16 v[74:75], v12 offset:9472
  v_mul_u32_u24 v19, 1120, v19
  v_mfma_f32_16x16x32_bf16 v[100:103], v[32:35], v[228:231], v[100:103]
  s_sub_u32 s23, s2, 170
  v_lshl_add_u32 v25, v20, 4, v19
  v_accvgpr_write_b32 a249, v25
  v_mfma_f32_16x16x32_bf16 v[116:119], v[36:39], v[228:231], v[116:119]
  s_cmp_lt_u32 s23, 54
  ds_read_b64_tr_b16 v[76:77], v13 offset:8448
  v_add_u32 v20, 128, v1
  v_mfma_f32_16x16x32_bf16 v[132:135], v[40:43], v[228:231], v[132:135]
  s_cselect_b32 s32, 98304, s32
  ds_read_b64_tr_b16 v[78:79], v13 offset:9472
  v_mul_u32_u24 v19, 6554, v20
  v_mfma_f32_16x16x32_bf16 v[148:151], v[44:47], v[228:231], v[148:151]
  s_cselect_b32 s9, -1, s9
  ds_read_b128 v[240:243], v14 offset:32768
  v_lshrrev_b32 v19, 16, v19
  v_mfma_f32_16x16x32_bf16 v[164:167], v[48:51], v[228:231], v[164:167]
  s_mov_b32 s67, s2
  ds_read_b128 v[244:247], v14 offset:33792
  v_mul_u32_u24 v19, 1120, v19
  v_mfma_f32_16x16x32_bf16 v[180:183], v[52:55], v[228:231], v[180:183]
  s_mov_b32 s8, 0
  v_lshl_add_u32 v26, v20, 4, v19
  v_accvgpr_write_b32 a250, v26
  v_mfma_f32_16x16x32_bf16 v[196:199], v[56:59], v[228:231], v[196:199]
  s_mov_b32 s66, 0
  ds_read_b64_tr_b16 v[80:81], v12 offset:8704
  v_add_u32 v20, 192, v1
  v_mfma_f32_16x16x32_bf16 v[212:215], v[60:63], v[228:231], v[212:215]
  s_mov_b32 s11, 0
  ds_read_b64_tr_b16 v[82:83], v12 offset:9728
  v_mul_u32_u24 v19, 6554, v20
  v_mfma_f32_16x16x32_bf16 v[104:107], v[32:35], v[232:235], v[104:107]
  s_mov_b32 s12, 0
  ds_read_b64_tr_b16 v[84:85], v13 offset:8704
  v_lshrrev_b32 v19, 16, v19
  v_mfma_f32_16x16x32_bf16 v[120:123], v[36:39], v[232:235], v[120:123]
  s_lshl_b32 s15, s22, 1
  ds_read_b64_tr_b16 v[86:87], v13 offset:9728
  v_mul_u32_u24 v19, 1120, v19
  v_mfma_f32_16x16x32_bf16 v[136:139], v[40:43], v[232:235], v[136:139]
  s_add_u32 s23, s15, 6
  v_lshl_add_u32 v27, v20, 4, v19
  v_accvgpr_write_b32 a251, v27
  v_mfma_f32_16x16x32_bf16 v[152:155], v[44:47], v[232:235], v[152:155]
  s_sub_u32 s15, 24, s15
  ds_read_b64_tr_b16 v[88:89], v12 offset:8960
  v_add_u32 v20, 256, v1
  v_mfma_f32_16x16x32_bf16 v[168:171], v[48:51], v[232:235], v[168:171]
  s_max_u32 s15, s15, s23
  ds_read_b64_tr_b16 v[90:91], v12 offset:9984
  v_mul_u32_u24 v19, 6554, v20
  v_mfma_f32_16x16x32_bf16 v[184:187], v[52:55], v[232:235], v[184:187]
  s_lshl_b32 s15, s15, 14
  ds_read_b64_tr_b16 v[92:93], v13 offset:8960
  v_lshrrev_b32 v19, 16, v19
  v_mfma_f32_16x16x32_bf16 v[200:203], v[56:59], v[232:235], v[200:203]
  ds_read_b64_tr_b16 v[94:95], v13 offset:9984
  v_mul_u32_u24 v19, 1120, v19
  v_mfma_f32_16x16x32_bf16 v[216:219], v[60:63], v[232:235], v[216:219]
  v_lshl_add_u32 v28, v20, 4, v19
  v_accvgpr_write_b32 a252, v28
  v_mfma_f32_16x16x32_bf16 v[108:111], v[32:35], v[236:239], v[108:111]
  ds_read_b128 v[248:251], v14 offset:34816
  v_accvgpr_write_b32 a80, 0
  v_mfma_f32_16x16x32_bf16 v[124:127], v[36:39], v[236:239], v[124:127]
  ds_read_b128 v[252:255], v14 offset:35840
  v_accvgpr_write_b32 a81, 0
  v_mfma_f32_16x16x32_bf16 v[140:143], v[40:43], v[236:239], v[140:143]
  v_accvgpr_write_b32 a82, 0
  v_accvgpr_write_b32 a83, 0
  v_mfma_f32_16x16x32_bf16 v[156:159], v[44:47], v[236:239], v[156:159]
  v_xor_b32 v14, 0x10000, v14
  v_accvgpr_write_b32 a112, 0
  v_mfma_f32_16x16x32_bf16 v[172:175], v[48:51], v[236:239], v[172:175]
  v_accvgpr_write_b32 a113, 0
  v_accvgpr_write_b32 a114, 0
  v_mfma_f32_16x16x32_bf16 v[188:191], v[52:55], v[236:239], v[188:191]
  v_accvgpr_write_b32 a115, 0
  v_accvgpr_write_b32 a84, 0
  v_mfma_f32_16x16x32_bf16 v[204:207], v[56:59], v[236:239], v[204:207]
  v_accvgpr_write_b32 a85, 0
  v_mfma_f32_16x16x32_bf16 v[220:223], v[60:63], v[236:239], v[220:223]
  s_waitcnt vmcnt(5) lgkmcnt(0)
  v_mfma_f32_16x16x32_bf16 v[96:99], v[64:67], v[240:243], v[96:99]
  s_barrier
  v_lshrrev_b32 v6, 2, v1
  v_mul_u32_u24 v6, 160, v6
  v_mfma_f32_16x16x32_bf16 v[112:115], v[68:71], v[240:243], v[112:115]
  s_and_b32 s23, s20, 1
  ds_read_b64_tr_b16 v[32:33], v12 offset:32768
  v_and_b32 v19, 3, v1
  v_mfma_f32_16x16x32_bf16 v[128:131], v[72:75], v[240:243], v[128:131]
  s_lshl_b32 s23, s23, 12
  ds_read_b64_tr_b16 v[34:35], v12 offset:33792
  v_lshl_add_u32 v6, v19, 3, v6
  v_mfma_f32_16x16x32_bf16 v[144:147], v[76:79], v[240:243], v[144:147]
  s_cmp_lt_u32 s20, 2
  v_add_u32 v6, s34, v6
  v_mov_b32 v3, v2
  v_mfma_f32_16x16x32_bf16 v[160:163], v[80:83], v[240:243], v[160:163]
  s_cselect_b32 s24, 106496, 0
  ds_read_b64_tr_b16 v[36:37], v13 offset:32768
  v_mov_b32 v4, 0xff800000
  v_mfma_f32_16x16x32_bf16 v[176:179], v[84:87], v[240:243], v[176:179]
  s_add_u32 s24, s24, s23
  ds_read_b64_tr_b16 v[38:39], v13 offset:33792
  v_add_u32 v18, 106496, v2
  v_mfma_f32_16x16x32_bf16 v[192:195], v[88:91], v[240:243], v[192:195]
  s_lshl_b32 s26, s20, 12
  ds_read_b64_tr_b16 v[40:41], v12 offset:33024
  v_accvgpr_write_b32 a86, 0
  v_mfma_f32_16x16x32_bf16 v[208:211], v[92:95], v[240:243], v[208:211]
  s_mov_b32 s27, s26
  ds_read_b64_tr_b16 v[42:43], v12 offset:34048
  v_accvgpr_write_b32 a87, 0
  v_mfma_f32_16x16x32_bf16 v[100:103], v[64:67], v[244:247], v[100:103]
  s_add_u32 s25, s27, 49152
  v_accvgpr_write_b32 a116, 0
  v_accvgpr_write_b32 a117, 0
  v_mfma_f32_16x16x32_bf16 v[116:119], v[68:71], v[244:247], v[116:119]
  s_load_dwordx4 s[4:7], s[0:1], 64
  ds_read_b64_tr_b16 v[44:45], v13 offset:33024
  v_accvgpr_write_b32 a118, 0
  v_mfma_f32_16x16x32_bf16 v[132:135], v[72:75], v[244:247], v[132:135]
  s_load_dwordx2 s[60:61], s[0:1], 80
  ds_read_b64_tr_b16 v[46:47], v13 offset:34048
  v_accvgpr_write_b32 a119, 0
  v_mfma_f32_16x16x32_bf16 v[148:151], v[76:79], v[244:247], v[148:151]
  s_add_u32 s23, s20, 1
  ds_read_b128 v[224:227], v14 offset:0
  v_accvgpr_write_b32 a88, 0
  v_mfma_f32_16x16x32_bf16 v[164:167], v[80:83], v[244:247], v[164:167]
  s_lshr_b32 s23, s23, 1
  ds_read_b128 v[228:231], v14 offset:1024
  v_accvgpr_write_b32 a89, 0
  v_mfma_f32_16x16x32_bf16 v[180:183], v[84:87], v[244:247], v[180:183]
  s_lshl_b32 s28, s22, 1
  v_accvgpr_write_b32 a90, 0
  v_accvgpr_write_b32 a91, 0
  v_mfma_f32_16x16x32_bf16 v[196:199], v[88:91], v[244:247], v[196:199]
  s_add_u32 s28, s28, s23
  ds_read_b64_tr_b16 v[48:49], v12 offset:33280
  v_accvgpr_write_b32 a120, 0
  v_mfma_f32_16x16x32_bf16 v[212:215], v[92:95], v[244:247], v[212:215]
  s_lshl_b32 s23, s22, 2
  ds_read_b64_tr_b16 v[50:51], v12 offset:34304
  v_accvgpr_write_b32 a121, 0
  v_mfma_f32_16x16x32_bf16 v[104:107], v[64:67], v[248:251], v[104:107]
  s_sub_u32 s29, 28, s23
  ds_read_b64_tr_b16 v[52:53], v13 offset:33280
  v_accvgpr_write_b32 a122, 0
  v_mfma_f32_16x16x32_bf16 v[120:123], v[68:71], v[248:251], v[120:123]
  s_and_b32 s23, s20, 1
  ds_read_b64_tr_b16 v[54:55], v13 offset:34304
  v_accvgpr_write_b32 a123, 0
  v_mfma_f32_16x16x32_bf16 v[136:139], v[72:75], v[248:251], v[136:139]
  s_add_u32 s29, s29, s23
  v_accvgpr_write_b32 a92, 0
  v_accvgpr_write_b32 a93, 0
  v_mfma_f32_16x16x32_bf16 v[152:155], v[76:79], v[248:251], v[152:155]
  ds_read_b64_tr_b16 v[56:57], v12 offset:33536
  v_accvgpr_write_b32 a94, 0
  v_mfma_f32_16x16x32_bf16 v[168:171], v[80:83], v[248:251], v[168:171]
  ds_read_b64_tr_b16 v[58:59], v12 offset:34560
  v_accvgpr_write_b32 a95, 0
  v_mfma_f32_16x16x32_bf16 v[184:187], v[84:87], v[248:251], v[184:187]
  ds_read_b64_tr_b16 v[60:61], v13 offset:33536
  v_accvgpr_write_b32 a124, 0
  v_mfma_f32_16x16x32_bf16 v[200:203], v[88:91], v[248:251], v[200:203]
  ds_read_b64_tr_b16 v[62:63], v13 offset:34560
  v_accvgpr_write_b32 a125, 0
  v_mfma_f32_16x16x32_bf16 v[216:219], v[92:95], v[248:251], v[216:219]
  v_accvgpr_write_b32 a126, 0
  v_accvgpr_write_b32 a127, 0
  v_mfma_f32_16x16x32_bf16 v[108:111], v[64:67], v[252:255], v[108:111]
  ds_read_b128 v[232:235], v14 offset:2048
  v_mfma_f32_16x16x32_bf16 v[124:127], v[68:71], v[252:255], v[124:127]
  ds_read_b128 v[236:239], v14 offset:3072
  v_mfma_f32_16x16x32_bf16 v[140:143], v[72:75], v[252:255], v[140:143]
  v_mfma_f32_16x16x32_bf16 v[156:159], v[76:79], v[252:255], v[156:159]
  v_mfma_f32_16x16x32_bf16 v[172:175], v[80:83], v[252:255], v[172:175]
  v_mfma_f32_16x16x32_bf16 v[188:191], v[84:87], v[252:255], v[188:191]
  v_mfma_f32_16x16x32_bf16 v[204:207], v[88:91], v[252:255], v[204:207]
  v_mfma_f32_16x16x32_bf16 v[220:223], v[92:95], v[252:255], v[220:223]
  s_waitcnt vmcnt(0) lgkmcnt(0)
  v_mfma_f32_16x16x32_bf16 v[96:99], v[32:35], v[224:227], v[96:99]
  s_cmp_ge_u32 s20, 2
  v_mfma_f32_16x16x32_bf16 v[112:115], v[36:39], v[224:227], v[112:115]
  s_cselect_b32 s4, s6, s4
  ds_read_b64_tr_b16 v[64:65], v12 offset:40960
  v_mfma_f32_16x16x32_bf16 v[128:131], v[40:43], v[224:227], v[128:131]
  s_cselect_b32 s5, s7, s5
  ds_read_b64_tr_b16 v[66:67], v12 offset:41984
  v_mfma_f32_16x16x32_bf16 v[144:147], v[44:47], v[224:227], v[144:147]
  s_mov_b32 s62, 2211840
  buffer_load_dword v15, v8, s[40:43], 0 offen sc1
  v_mfma_f32_16x16x32_bf16 v[160:163], v[48:51], v[224:227], v[160:163]
  s_mov_b32 s63, 0x20000
  ds_read_b64_tr_b16 v[68:69], v13 offset:40960
  v_mfma_f32_16x16x32_bf16 v[176:179], v[52:55], v[224:227], v[176:179]
  s_mov_b64 s[56:57], s[52:53]
  ds_read_b64_tr_b16 v[70:71], v13 offset:41984
  v_mfma_f32_16x16x32_bf16 v[192:195], v[56:59], v[224:227], v[192:195]
  s_mov_b32 s58, s54
  ds_read_b64_tr_b16 v[72:73], v12 offset:41216
  v_mfma_f32_16x16x32_bf16 v[208:211], v[60:63], v[224:227], v[208:211]
  s_mov_b64 s[52:53], s[4:5]
  ds_read_b64_tr_b16 v[74:75], v12 offset:42240
  v_mfma_f32_16x16x32_bf16 v[100:103], v[32:35], v[228:231], v[100:103]
  s_mov_b32 s54, 2211840
  v_mfma_f32_16x16x32_bf16 v[116:119], v[36:39], v[228:231], v[116:119]
  s_getpc_b64 s[36:37]
fa_copc:
  ds_read_b64_tr_b16 v[76:77], v13 offset:41216
  v_mfma_f32_16x16x32_bf16 v[132:135], v[40:43], v[228:231], v[132:135]
  s_add_u32 s36, s36, fa_co-fa_copc-4
  ds_read_b64_tr_b16 v[78:79], v13 offset:42240
  v_mfma_f32_16x16x32_bf16 v[148:151], v[44:47], v[228:231], v[148:151]
  s_addc_u32 s37, s37, 0
  ds_read_b128 v[240:243], v14 offset:32768
  v_mfma_f32_16x16x32_bf16 v[164:167], v[48:51], v[228:231], v[164:167]
  ds_read_b128 v[244:247], v14 offset:33792
  v_mfma_f32_16x16x32_bf16 v[180:183], v[52:55], v[228:231], v[180:183]
  v_mfma_f32_16x16x32_bf16 v[196:199], v[56:59], v[228:231], v[196:199]
  ds_read_b64_tr_b16 v[80:81], v12 offset:41472
  v_mfma_f32_16x16x32_bf16 v[212:215], v[60:63], v[228:231], v[212:215]
  ds_read_b64_tr_b16 v[82:83], v12 offset:42496
  v_mfma_f32_16x16x32_bf16 v[104:107], v[32:35], v[232:235], v[104:107]
  ds_read_b64_tr_b16 v[84:85], v13 offset:41472
  v_mfma_f32_16x16x32_bf16 v[120:123], v[36:39], v[232:235], v[120:123]
  ds_read_b64_tr_b16 v[86:87], v13 offset:42496
  v_mfma_f32_16x16x32_bf16 v[136:139], v[40:43], v[232:235], v[136:139]
  v_mfma_f32_16x16x32_bf16 v[152:155], v[44:47], v[232:235], v[152:155]
  ds_read_b64_tr_b16 v[88:89], v12 offset:41728
  v_mfma_f32_16x16x32_bf16 v[168:171], v[48:51], v[232:235], v[168:171]
  ds_read_b64_tr_b16 v[90:91], v12 offset:42752
  v_mfma_f32_16x16x32_bf16 v[184:187], v[52:55], v[232:235], v[184:187]
  ds_read_b64_tr_b16 v[92:93], v13 offset:41728
  v_mfma_f32_16x16x32_bf16 v[200:203], v[56:59], v[232:235], v[200:203]
  ds_read_b64_tr_b16 v[94:95], v13 offset:42752
  v_mfma_f32_16x16x32_bf16 v[216:219], v[60:63], v[232:235], v[216:219]
  v_mfma_f32_16x16x32_bf16 v[108:111], v[32:35], v[236:239], v[108:111]
  ds_read_b128 v[248:251], v14 offset:34816
  v_mfma_f32_16x16x32_bf16 v[124:127], v[36:39], v[236:239], v[124:127]
  ds_read_b128 v[252:255], v14 offset:35840
  v_mfma_f32_16x16x32_bf16 v[140:143], v[40:43], v[236:239], v[140:143]
  v_mfma_f32_16x16x32_bf16 v[156:159], v[44:47], v[236:239], v[156:159]
  v_xor_b32 v14, 0x10000, v14
  v_mfma_f32_16x16x32_bf16 v[172:175], v[48:51], v[236:239], v[172:175]
  v_mfma_f32_16x16x32_bf16 v[188:191], v[52:55], v[236:239], v[188:191]
  v_xor_b32 v12, 0x10000, v12
  v_mfma_f32_16x16x32_bf16 v[204:207], v[56:59], v[236:239], v[204:207]
  v_xor_b32 v13, 0x10000, v13
  v_mfma_f32_16x16x32_bf16 v[220:223], v[60:63], v[236:239], v[220:223]
  s_waitcnt vmcnt(0) lgkmcnt(0)
  v_mfma_f32_16x16x32_bf16 v[96:99], v[64:67], v[240:243], v[96:99]
  s_barrier
  v_cmp_eq_u32 vcc, 0, v15
  v_mfma_f32_16x16x32_bf16 v[112:115], v[68:71], v[240:243], v[112:115]
  s_cbranch_vccnz fa_kv_spin
fa_kv_ok:
  v_mfma_f32_16x16x32_bf16 v[128:131], v[72:75], v[240:243], v[128:131]
  s_mov_b32 m0, s24
  v_mfma_f32_16x16x32_bf16 v[144:147], v[76:79], v[240:243], v[144:147]
  buffer_load_dwordx4 v2, s[44:47], s26 offen offset:0 sc1 lds
  v_mfma_f32_16x16x32_bf16 v[160:163], v[80:83], v[240:243], v[160:163]
  s_add_u32 s24, s24, 32768
  v_mfma_f32_16x16x32_bf16 v[176:179], v[84:87], v[240:243], v[176:179]
  s_and_b32 s24, s24, 0x1ffff
  buffer_load_dwordx4 v2, s[44:47], s26 offen offset:1024 sc1 lds
  v_mfma_f32_16x16x32_bf16 v[192:195], v[88:91], v[240:243], v[192:195]
  v_mfma_f32_16x16x32_bf16 v[208:211], v[92:95], v[240:243], v[208:211]
  buffer_load_dwordx4 v2, s[44:47], s26 offen offset:2048 sc1 lds
  v_mfma_f32_16x16x32_bf16 v[100:103], v[64:67], v[244:247], v[100:103]
  v_mfma_f32_16x16x32_bf16 v[116:119], v[68:71], v[244:247], v[116:119]
  buffer_load_dwordx4 v2, s[44:47], s26 offen offset:3072 sc1 lds
  v_mfma_f32_16x16x32_bf16 v[132:135], v[72:75], v[244:247], v[132:135]
  s_add_u32 s26, s26, 16384
  v_cvt_pk_bf16_f32 v32, v96, v97
  v_cvt_pk_bf16_f32 v33, v98, v99
  v_mfma_f32_16x16x32_bf16 v[148:151], v[76:79], v[244:247], v[148:151]
  v_cvt_pk_bf16_f32 v34, v112, v113
  v_cvt_pk_bf16_f32 v35, v114, v115
  v_mfma_f32_16x16x32_bf16 v[164:167], v[80:83], v[244:247], v[164:167]
  s_mov_b32 m0, s24
  v_cvt_pk_bf16_f32 v40, v128, v129
  v_mfma_f32_16x16x32_bf16 v[180:183], v[84:87], v[244:247], v[180:183]
  buffer_load_dwordx4 v2, s[44:47], s26 offen offset:0 sc1 lds
  v_cvt_pk_bf16_f32 v41, v130, v131
  v_cvt_pk_bf16_f32 v42, v144, v145
  v_mfma_f32_16x16x32_bf16 v[196:199], v[88:91], v[244:247], v[196:199]
  s_add_u32 s24, s24, 32768
  v_cvt_pk_bf16_f32 v43, v146, v147
  v_mfma_f32_16x16x32_bf16 v[212:215], v[92:95], v[244:247], v[212:215]
  s_and_b32 s24, s24, 0x1ffff
  buffer_load_dwordx4 v2, s[44:47], s26 offen offset:1024 sc1 lds
  v_cvt_pk_bf16_f32 v48, v160, v161
  v_cvt_pk_bf16_f32 v49, v162, v163
  v_mfma_f32_16x16x32_bf16 v[104:107], v[64:67], v[248:251], v[104:107]
  v_cvt_pk_bf16_f32 v50, v176, v177
  v_cvt_pk_bf16_f32 v51, v178, v179
  v_mfma_f32_16x16x32_bf16 v[120:123], v[68:71], v[248:251], v[120:123]
  buffer_load_dwordx4 v2, s[44:47], s26 offen offset:2048 sc1 lds
  v_cvt_pk_bf16_f32 v56, v192, v193
  v_mfma_f32_16x16x32_bf16 v[136:139], v[72:75], v[248:251], v[136:139]
  v_cvt_pk_bf16_f32 v57, v194, v195
  v_cvt_pk_bf16_f32 v58, v208, v209
  v_mfma_f32_16x16x32_bf16 v[152:155], v[76:79], v[248:251], v[152:155]
  buffer_load_dwordx4 v2, s[44:47], s26 offen offset:3072 sc1 lds
  v_cvt_pk_bf16_f32 v59, v210, v211
  v_mfma_f32_16x16x32_bf16 v[168:171], v[80:83], v[248:251], v[168:171]
  s_add_u32 s26, s26, 16384
  v_cvt_pk_bf16_f32 v36, v100, v101
  v_cvt_pk_bf16_f32 v37, v102, v103
  v_mfma_f32_16x16x32_bf16 v[184:187], v[84:87], v[248:251], v[184:187]
  v_cvt_pk_bf16_f32 v38, v116, v117
  v_mfma_f32_16x16x32_bf16 v[200:203], v[88:91], v[248:251], v[200:203]
  s_mov_b32 m0, s24
  v_cvt_pk_bf16_f32 v39, v118, v119
  v_cvt_pk_bf16_f32 v44, v132, v133
  v_mfma_f32_16x16x32_bf16 v[216:219], v[92:95], v[248:251], v[216:219]
  buffer_load_dwordx4 v2, s[44:47], s26 offen offset:0 sc1 lds
  v_cvt_pk_bf16_f32 v45, v134, v135
  v_mfma_f32_16x16x32_bf16 v[108:111], v[64:67], v[252:255], v[108:111]
  s_add_u32 s24, s24, 32768
  v_cvt_pk_bf16_f32 v46, v148, v149
  v_cvt_pk_bf16_f32 v47, v150, v151
  v_mfma_f32_16x16x32_bf16 v[124:127], v[68:71], v[252:255], v[124:127]
  s_and_b32 s24, s24, 0x1ffff
  buffer_load_dwordx4 v2, s[44:47], s26 offen offset:1024 sc1 lds
  v_cvt_pk_bf16_f32 v52, v164, v165
  v_mfma_f32_16x16x32_bf16 v[140:143], v[72:75], v[252:255], v[140:143]
  v_cvt_pk_bf16_f32 v53, v166, v167
  v_cvt_pk_bf16_f32 v54, v180, v181
  v_mfma_f32_16x16x32_bf16 v[156:159], v[76:79], v[252:255], v[156:159]
  buffer_load_dwordx4 v2, s[44:47], s26 offen offset:2048 sc1 lds
  v_cvt_pk_bf16_f32 v55, v182, v183
  v_mfma_f32_16x16x32_bf16 v[172:175], v[80:83], v[252:255], v[172:175]
  v_cvt_pk_bf16_f32 v60, v196, v197
  v_cvt_pk_bf16_f32 v61, v198, v199
  v_mfma_f32_16x16x32_bf16 v[188:191], v[84:87], v[252:255], v[188:191]
  buffer_load_dwordx4 v2, s[44:47], s26 offen offset:3072 sc1 lds
  v_cvt_pk_bf16_f32 v62, v212, v213
  v_mfma_f32_16x16x32_bf16 v[204:207], v[88:91], v[252:255], v[204:207]
  s_add_u32 s26, s26, 16384
  v_cvt_pk_bf16_f32 v63, v214, v215
  v_mfma_f32_16x16x32_bf16 v[220:223], v[92:95], v[252:255], v[220:223]
  s_mov_b32 m0, s25
  s_nop 0
  buffer_load_dwordx4 v2, s[48:51], s27 offen offset:0 sc1 lds
  v_cvt_pk_bf16_f32 v64, v104, v105
  v_cvt_pk_bf16_f32 v65, v106, v107
  v_cvt_pk_bf16_f32 v66, v120, v121
  v_cvt_pk_bf16_f32 v67, v122, v123
  v_cvt_pk_bf16_f32 v72, v136, v137
  buffer_load_dwordx4 v2, s[48:51], s27 offen offset:1024 sc1 lds
  v_cvt_pk_bf16_f32 v73, v138, v139
  v_cvt_pk_bf16_f32 v74, v152, v153
  v_cvt_pk_bf16_f32 v75, v154, v155
  v_cvt_pk_bf16_f32 v80, v168, v169
  v_cvt_pk_bf16_f32 v81, v170, v171
  buffer_load_dwordx4 v2, s[48:51], s27 offen offset:2048 sc1 lds
  v_cvt_pk_bf16_f32 v82, v184, v185
  v_cvt_pk_bf16_f32 v83, v186, v187
  v_cvt_pk_bf16_f32 v88, v200, v201
  v_cvt_pk_bf16_f32 v89, v202, v203
  v_cvt_pk_bf16_f32 v90, v216, v217
  buffer_load_dwordx4 v2, s[48:51], s27 offen offset:3072 sc1 lds
  v_cvt_pk_bf16_f32 v91, v218, v219
  v_cvt_pk_bf16_f32 v68, v108, v109
  v_cvt_pk_bf16_f32 v69, v110, v111
  v_cvt_pk_bf16_f32 v70, v124, v125
  v_cvt_pk_bf16_f32 v71, v126, v127
  s_add_u32 s27, s27, 16384
  s_add_u32 s25, s25, 32768
  s_and_b32 s25, s25, 0x1ffff
  s_mov_b32 m0, s25
  s_nop 0
  buffer_load_dwordx4 v2, s[48:51], s27 offen offset:0 sc1 lds
  v_cvt_pk_bf16_f32 v76, v140, v141
  v_cvt_pk_bf16_f32 v77, v142, v143
  v_cvt_pk_bf16_f32 v78, v156, v157
  v_cvt_pk_bf16_f32 v79, v158, v159
  v_cvt_pk_bf16_f32 v84, v172, v173
  buffer_load_dwordx4 v2, s[48:51], s27 offen offset:1024 sc1 lds
  v_cvt_pk_bf16_f32 v85, v174, v175
  v_cvt_pk_bf16_f32 v86, v188, v189
  v_cvt_pk_bf16_f32 v87, v190, v191
  v_cvt_pk_bf16_f32 v92, v204, v205
  v_cvt_pk_bf16_f32 v93, v206, v207
  buffer_load_dwordx4 v2, s[48:51], s27 offen offset:2048 sc1 lds
  v_cvt_pk_bf16_f32 v94, v220, v221
  v_cvt_pk_bf16_f32 v95, v222, v223
  v_mov_b32 v228, 0
  v_mov_b32 v229, 0
  v_mov_b32 v230, 0
  buffer_load_dwordx4 v2, s[48:51], s27 offen offset:3072 sc1 lds
  v_mov_b32 v231, 0
  s_add_u32 s27, s27, 16384
  s_add_u32 s25, s25, 32768
  s_and_b32 s25, s25, 0x1ffff
  s_waitcnt vmcnt(12)
  s_barrier
  ds_read_b128 a[128:131], v18 offset:0
  ds_read_b128 a[132:135], v18 offset:1024
  ds_read_b128 a[136:139], v18 offset:2048
  ds_read_b128 a[140:143], v18 offset:3072
  ds_read_b128 a[144:147], v18 offset:4096
  ds_read_b128 a[148:151], v18 offset:5120
  ds_read_b128 a[152:155], v18 offset:6144
  ds_read_b128 a[156:159], v18 offset:7168
  s_cmp_eq_u32 s2, 255
  s_cbranch_scc1 fa_top8
fa_notop:
  s_waitcnt lgkmcnt(4)
  v_mfma_f32_16x16x32_bf16 v[96:99], a[128:131], v[32:35], 0
  v_mfma_f32_16x16x32_bf16 v[104:107], a[128:131], v[36:39], 0
  v_mfma_f32_16x16x32_bf16 v[128:131], a[128:131], v[64:67], 0
  v_mfma_f32_16x16x32_bf16 v[136:139], a[128:131], v[68:71], 0
  s_mov_b32 m0, s24
  ds_read_b128 a[128:131], v3 offset:0
  v_mfma_f32_16x16x32_bf16 v[100:103], a[132:135], v[32:35], 0
  buffer_load_dwordx4 v2, s[44:47], s26 offen offset:0 sc1 lds
  v_mfma_f32_16x16x32_bf16 v[108:111], a[132:135], v[36:39], 0
  v_mfma_f32_16x16x32_bf16 v[132:135], a[132:135], v[64:67], 0
  v_mfma_f32_16x16x32_bf16 v[140:143], a[132:135], v[68:71], 0
  ds_read_b128 a[132:135], v3 offset:1024
  v_mfma_f32_16x16x32_bf16 v[96:99], a[136:139], v[40:43], v[96:99]
  v_mfma_f32_16x16x32_bf16 v[104:107], a[136:139], v[44:47], v[104:107]
  v_mfma_f32_16x16x32_bf16 v[128:131], a[136:139], v[72:75], v[128:131]
  buffer_load_dwordx4 v2, s[44:47], s26 offen offset:1024 sc1 lds
  v_mfma_f32_16x16x32_bf16 v[136:139], a[136:139], v[76:79], v[136:139]
  ds_read_b128 a[136:139], v3 offset:2048
  v_mfma_f32_16x16x32_bf16 v[100:103], a[140:143], v[40:43], v[100:103]
  v_mfma_f32_16x16x32_bf16 v[108:111], a[140:143], v[44:47], v[108:111]
  v_mfma_f32_16x16x32_bf16 v[132:135], a[140:143], v[72:75], v[132:135]
  v_mfma_f32_16x16x32_bf16 v[140:143], a[140:143], v[76:79], v[140:143]
  s_waitcnt lgkmcnt(3)
  ds_read_b128 a[140:143], v3 offset:3072
  v_mfma_f32_16x16x32_bf16 v[96:99], a[144:147], v[48:51], v[96:99]
  v_mfma_f32_16x16x32_bf16 v[104:107], a[144:147], v[52:55], v[104:107]
  v_mfma_f32_16x16x32_bf16 v[128:131], a[144:147], v[80:83], v[128:131]
  buffer_load_dwordx4 v2, s[44:47], s26 offen offset:2048 sc1 lds
  v_mfma_f32_16x16x32_bf16 v[136:139], a[144:147], v[84:87], v[136:139]
  ds_read_b128 a[144:147], v3 offset:4096
  v_mfma_f32_16x16x32_bf16 v[100:103], a[148:151], v[48:51], v[100:103]
  v_mfma_f32_16x16x32_bf16 v[108:111], a[148:151], v[52:55], v[108:111]
  v_mfma_f32_16x16x32_bf16 v[132:135], a[148:151], v[80:83], v[132:135]
  v_mfma_f32_16x16x32_bf16 v[140:143], a[148:151], v[84:87], v[140:143]
  ds_read_b128 a[148:151], v3 offset:5120
  v_mfma_f32_16x16x32_bf16 v[96:99], a[152:155], v[56:59], v[96:99]
  buffer_load_dwordx4 v2, s[44:47], s26 offen offset:3072 sc1 lds
  v_mfma_f32_16x16x32_bf16 v[104:107], a[152:155], v[60:63], v[104:107]
  s_add_u32 s26, s26, 16384
  v_mfma_f32_16x16x32_bf16 v[128:131], a[152:155], v[88:91], v[128:131]
  s_add_u32 s24, s24, 32768
  v_mfma_f32_16x16x32_bf16 v[136:139], a[152:155], v[92:95], v[136:139]
  s_and_b32 s24, s24, 0x1ffff
  ds_read_b128 a[152:155], v3 offset:6144
  v_mfma_f32_16x16x32_bf16 v[100:103], a[156:159], v[56:59], v[100:103]
  v_mfma_f32_16x16x32_bf16 v[108:111], a[156:159], v[60:63], v[108:111]
  v_mfma_f32_16x16x32_bf16 v[132:135], a[156:159], v[88:91], v[132:135]
  v_mfma_f32_16x16x32_bf16 v[140:143], a[156:159], v[92:95], v[140:143]
  s_waitcnt lgkmcnt(3)
  ds_read_b128 a[156:159], v3 offset:7168
  s_nop 7
  s_cmp_lg_u32 s28, 0
  s_cbranch_scc1 fa_nomask0
  v_cndmask_b32 v96, v4, v96, s[68:69]
  v_cndmask_b32 v97, v4, v97, s[70:71]
  v_cndmask_b32 v98, v4, v98, s[72:73]
  v_cndmask_b32 v99, v4, v99, s[74:75]
  v_mov_b32 v100, v4
  v_mov_b32 v101, v4
  v_mov_b32 v102, v4
  v_mov_b32 v103, v4
  v_cndmask_b32 v108, v4, v108, s[68:69]
  v_cndmask_b32 v109, v4, v109, s[70:71]
  v_cndmask_b32 v110, v4, v110, s[72:73]
  v_cndmask_b32 v111, v4, v111, s[74:75]
fa_nomask0:
  v_max3_f32 v16, v96, v97, v98
  v_max3_f32 v16, v16, v99, v100
  v_max3_f32 v16, v16, v101, v102
  v_max_f32 v16, v16, v103
  v_max3_f32 v17, v104, v105, v106
  v_max3_f32 v17, v17, v107, v108
  v_max3_f32 v17, v17, v109, v110
  v_max_f32 v17, v17, v111
  v_max3_f32 v18, v128, v129, v130
  v_max3_f32 v18, v18, v131, v132
  v_max3_f32 v18, v18, v133, v134
  v_max_f32 v18, v18, v135
  v_max3_f32 v19, v136, v137, v138
  v_max3_f32 v19, v19, v139, v140
  v_max3_f32 v19, v19, v141, v142
  v_max_f32 v19, v19, v143
  v_mov_b32 v20, v16
  v_mov_b32 v21, v17
  v_mov_b32 v22, v18
  v_mov_b32 v23, v19
  s_nop 0
  v_permlane16_swap_b32 v16, v20
  v_permlane16_swap_b32 v17, v21
  v_permlane16_swap_b32 v18, v22
  v_permlane16_swap_b32 v19, v23
  v_max_f32 v16, v16, v20
  v_max_f32 v17, v17, v21
  v_max_f32 v18, v18, v22
  v_max_f32 v19, v19, v23
  v_mov_b32 v20, v16
  v_mov_b32 v21, v17
  v_mov_b32 v22, v18
  v_mov_b32 v23, v19
  s_nop 0
  v_permlane32_swap_b32 v16, v20
  v_permlane32_swap_b32 v17, v21
  v_permlane32_swap_b32 v18, v22
  v_permlane32_swap_b32 v19, v23
  v_max_f32 v16, v16, v20
  v_max_f32 v17, v17, v21
  v_max_f32 v18, v18, v22
  v_max_f32 v19, v19, v23
  v_sub_f32 v192, 0, v16
  v_sub_f32 v193, 0, v16
  v_sub_f32 v194, 0, v16
  v_sub_f32 v195, 0, v16
  v_sub_f32 v196, 0, v17
  v_sub_f32 v197, 0, v17
  v_sub_f32 v198, 0, v17
  v_sub_f32 v199, 0, v17
  v_sub_f32 v200, 0, v18
  v_sub_f32 v201, 0, v18
  v_sub_f32 v202, 0, v18
  v_sub_f32 v203, 0, v18
  v_sub_f32 v204, 0, v19
  v_sub_f32 v205, 0, v19
  v_sub_f32 v206, 0, v19
  v_sub_f32 v207, 0, v19
  v_sub_f32 v96, v96, v16
  v_sub_f32 v97, v97, v16
  v_sub_f32 v98, v98, v16
  v_sub_f32 v99, v99, v16
  v_sub_f32 v100, v100, v16
  v_sub_f32 v101, v101, v16
  v_sub_f32 v102, v102, v16
  v_sub_f32 v103, v103, v16
  v_sub_f32 v104, v104, v17
  v_sub_f32 v105, v105, v17
  v_sub_f32 v106, v106, v17
  v_sub_f32 v107, v107, v17
  v_sub_f32 v108, v108, v17
  v_sub_f32 v109, v109, v17
  v_sub_f32 v110, v110, v17
  v_sub_f32 v111, v111, v17
  v_sub_f32 v128, v128, v18
  v_sub_f32 v129, v129, v18
  v_sub_f32 v130, v130, v18
  v_sub_f32 v131, v131, v18
  v_sub_f32 v132, v132, v18
  v_sub_f32 v133, v133, v18
  v_sub_f32 v134, v134, v18
  v_sub_f32 v135, v135, v18
  v_sub_f32 v136, v136, v19
  v_sub_f32 v137, v137, v19
  v_sub_f32 v138, v138, v19
  v_sub_f32 v139, v139, v19
  v_sub_f32 v140, v140, v19
  v_sub_f32 v141, v141, v19
  v_sub_f32 v142, v142, v19
  v_sub_f32 v143, v143, v19
  v_mfma_f32_16x16x32_bf16 v[112:115], a[128:131], v[32:35], v[192:195]
  v_exp_f32 v216, v128
  v_exp_f32 v217, v129
  v_mfma_f32_16x16x32_bf16 v[120:123], a[128:131], v[36:39], v[196:199]
  v_exp_f32 v218, v130
  v_add_f32 v226, v216, v217
  v_cvt_pk_bf16_f32 v176, v216, v217
  v_mfma_f32_16x16x32_bf16 v[144:147], a[128:131], v[64:67], v[200:203]
  s_add_u32 s66, s66, 32768
  v_exp_f32 v219, v131
  v_add_f32 v226, v226, v218
  v_add_f32 v226, v226, v219
  v_mfma_f32_16x16x32_bf16 v[152:155], a[128:131], v[68:71], v[204:207]
  s_mov_b32 m0, s25
  ds_read_b128 a[128:131], v3 offset:8192
  v_exp_f32 v220, v132
  v_cvt_pk_bf16_f32 v177, v218, v219
  v_mfma_f32_16x16x32_bf16 v[116:119], a[132:135], v[32:35], v[192:195]
  s_and_b32 s66, s66, 0x1ffff
  buffer_load_dwordx4 v2, s[48:51], s27 offen offset:0 sc1 lds
  v_exp_f32 v221, v133
  v_add_f32 v226, v226, v220
  v_add_f32 v226, v226, v221
  v_mfma_f32_16x16x32_bf16 v[124:127], a[132:135], v[36:39], v[196:199]
  v_exp_f32 v222, v134
  v_cvt_pk_bf16_f32 v178, v220, v221
  v_exp_f32 v223, v135
  v_mfma_f32_16x16x32_bf16 v[148:151], a[132:135], v[64:67], v[200:203]
  v_exp_f32 v216, v136
  v_add_f32 v226, v226, v222
  v_mfma_f32_16x16x32_bf16 v[156:159], a[132:135], v[68:71], v[204:207]
  ds_read_b128 a[132:135], v3 offset:9216
  v_exp_f32 v217, v137
  v_add_f32 v226, v226, v223
  v_mfma_f32_16x16x32_bf16 v[112:115], a[136:139], v[40:43], v[112:115]
  v_exp_f32 v218, v138
  v_cvt_pk_bf16_f32 v179, v222, v223
  v_add_f32 v227, v216, v217
  v_mfma_f32_16x16x32_bf16 v[120:123], a[136:139], v[44:47], v[120:123]
  v_exp_f32 v219, v139
  v_cvt_pk_bf16_f32 v180, v216, v217
  v_add_f32 v227, v227, v218
  v_add_f32 v227, v227, v219
  v_mfma_f32_16x16x32_bf16 v[144:147], a[136:139], v[72:75], v[144:147]
  buffer_load_dwordx4 v2, s[48:51], s27 offen offset:1024 sc1 lds
  v_exp_f32 v220, v140
  v_cvt_pk_bf16_f32 v181, v218, v219
  v_mfma_f32_16x16x32_bf16 v[152:155], a[136:139], v[76:79], v[152:155]
  ds_read_b128 a[136:139], v3 offset:10240
  v_exp_f32 v221, v141
  v_add_f32 v227, v227, v220
  v_mfma_f32_16x16x32_bf16 v[116:119], a[140:143], v[40:43], v[116:119]
  v_exp_f32 v222, v142
  v_add_f32 v227, v227, v221
  v_cvt_pk_bf16_f32 v182, v220, v221
  v_mfma_f32_16x16x32_bf16 v[124:127], a[140:143], v[44:47], v[124:127]
  v_exp_f32 v223, v143
  v_add_f32 v227, v227, v222
  v_add_f32 v227, v227, v223
  v_exp_f32 v208, v96
  v_mfma_f32_16x16x32_bf16 v[148:151], a[140:143], v[72:75], v[148:151]
  v_exp_f32 v209, v97
  v_cvt_pk_bf16_f32 v183, v222, v223
  v_mfma_f32_16x16x32_bf16 v[156:159], a[140:143], v[76:79], v[156:159]
  s_waitcnt lgkmcnt(3)
  ds_read_b128 a[140:143], v3 offset:11264
  v_exp_f32 v210, v98
  v_add_f32 v224, v208, v209
  v_mfma_f32_16x16x32_bf16 v[112:115], a[144:147], v[48:51], v[112:115]
  v_exp_f32 v211, v99
  v_cvt_pk_bf16_f32 v160, v208, v209
  v_add_f32 v224, v224, v210
  v_mfma_f32_16x16x32_bf16 v[120:123], a[144:147], v[52:55], v[120:123]
  v_exp_f32 v212, v100
  v_add_f32 v224, v224, v211
  v_cvt_pk_bf16_f32 v161, v210, v211
  v_mfma_f32_16x16x32_bf16 v[144:147], a[144:147], v[80:83], v[144:147]
  buffer_load_dwordx4 v2, s[48:51], s27 offen offset:2048 sc1 lds
  v_exp_f32 v213, v101
  v_add_f32 v224, v224, v212
  v_add_f32 v224, v224, v213
  v_mfma_f32_16x16x32_bf16 v[152:155], a[144:147], v[84:87], v[152:155]
  ds_read_b128 a[144:147], v3 offset:12288
  v_exp_f32 v214, v102
  v_cvt_pk_bf16_f32 v162, v212, v213
  v_mfma_f32_16x16x32_bf16 v[116:119], a[148:151], v[48:51], v[116:119]
  v_exp_f32 v215, v103
  v_add_f32 v224, v224, v214
  v_add_f32 v224, v224, v215
  v_mfma_f32_16x16x32_bf16 v[124:127], a[148:151], v[52:55], v[124:127]
  v_exp_f32 v208, v104
  v_exp_f32 v209, v105
  v_mfma_f32_16x16x32_bf16 v[148:151], a[148:151], v[80:83], v[148:151]
  v_exp_f32 v210, v106
  v_cvt_pk_bf16_f32 v163, v214, v215
  v_add_f32 v225, v208, v209
  v_mfma_f32_16x16x32_bf16 v[156:159], a[148:151], v[84:87], v[156:159]
  ds_read_b128 a[148:151], v3 offset:13312
  v_exp_f32 v211, v107
  v_cvt_pk_bf16_f32 v164, v208, v209
  v_add_f32 v225, v225, v210
  v_mfma_f32_16x16x32_bf16 v[112:115], a[152:155], v[56:59], v[112:115]
  buffer_load_dwordx4 v2, s[48:51], s27 offen offset:3072 sc1 lds
  v_exp_f32 v212, v108
  v_add_f32 v225, v225, v211
  v_mfma_f32_16x16x32_bf16 v[120:123], a[152:155], v[60:63], v[120:123]
  s_add_u32 s27, s27, 16384
  v_exp_f32 v213, v109
  v_mfma_f32_16x16x32_bf16 v[144:147], a[152:155], v[88:91], v[144:147]
  s_add_u32 s25, s25, 32768
  v_exp_f32 v214, v110
  v_mfma_f32_16x16x32_bf16 v[152:155], a[152:155], v[92:95], v[152:155]
  s_and_b32 s25, s25, 0x1ffff
  ds_read_b128 a[152:155], v3 offset:14336
  v_cvt_pk_bf16_f32 v165, v210, v211
  v_max3_f32 v5, v226, v227, v224
  v_add_f32 v225, v225, v212
  v_add_f32 v225, v225, v213
  v_cvt_pk_bf16_f32 v166, v212, v213
  v_exp_f32 v215, v111
  v_mfma_f32_16x16x32_bf16 v[116:119], a[156:159], v[56:59], v[116:119]
  v_add_f32 v225, v225, v214
  v_add_f32 v225, v225, v215
  v_max_f32 v5, v5, v225
  v_cmp_lt_f32 vcc, s81, v5
  v_mfma_f32_16x16x32_bf16 v[124:127], a[156:159], v[60:63], v[124:127]
  v_mfma_f32_16x16x32_bf16 v[148:151], a[156:159], v[88:91], v[148:151]
  v_cvt_pk_bf16_f32 v167, v214, v215
  v_mfma_f32_16x16x32_bf16 v[156:159], a[156:159], v[92:95], v[156:159]
  s_waitcnt lgkmcnt(3)
  s_cbranch_vccnz fa_stub0
fa_back0:
  ds_read_b128 a[156:159], v3 offset:15360
  v_add_f32 v228, v228, v224
  v_add_f32 v229, v229, v225
  v_add_f32 v230, v230, v226
  v_add_f32 v231, v231, v227
  s_nop 3
  v_exp_f32 v216, v144
  v_exp_f32 v217, v145
  v_add_u32 v3, s66, v2
  s_cmp_eq_u32 s28, 0
  s_cbranch_scc1 fa_AV
  s_sub_u32 s28, s28, 1
  s_cmp_eq_u32 s28, 0
  s_cbranch_scc1 fa_Aexit
.p2align 6
fa_DD:
  v_mfma_f32_16x16x32_bf16 v[96:99], a[128:131], v[32:35], v[192:195]
  s_waitcnt vmcnt(12)
  v_exp_f32 v218, v146
  v_mfma_f32_16x16x32_bf16 v[104:107], a[128:131], v[36:39], v[196:199]
  s_barrier
  v_exp_f32 v219, v147
  v_mfma_f32_16x16x32_bf16 v[128:131], a[128:131], v[64:67], v[200:203]
  s_cmp_ge_u32 s26, s32
  ds_read_b128 a[160:163], v3 offset:16384
  v_add_f32 v226, v216, v217
  v_mfma_f32_16x16x32_bf16 v[136:139], a[128:131], v[68:71], v[204:207]
  s_cbranch_scc1 fa_hk4
fa_hb4:
  v_exp_f32 v220, v148
  v_mfma_f32_16x16x32_bf16 v[100:103], a[132:135], v[32:35], v[192:195]
  ds_read_b128 a[164:167], v3 offset:17408
  v_cvt_pk_bf16_f32 v184, v216, v217
  v_mfma_f32_16x16x32_bf16 v[108:111], a[132:135], v[36:39], v[196:199]
  s_mov_b32 m0, s24
  v_exp_f32 v221, v149
  v_mfma_f32_16x16x32_bf16 v[132:135], a[132:135], v[64:67], v[200:203]
  buffer_load_dwordx4 v2, s[44:47], s26 offen offset:0 sc1 lds
  v_add_f32 v226, v226, v218
  v_mfma_f32_16x16x32_bf16 v[140:143], a[132:135], v[68:71], v[204:207]
  v_exp_f32 v222, v150
  v_mfma_f32_16x16x32_bf16 v[96:99], a[136:139], v[40:43], v[96:99]
  ds_read_b128 a[168:171], v3 offset:18432
  v_add_f32 v226, v226, v219
  v_mfma_f32_16x16x32_bf16 v[104:107], a[136:139], v[44:47], v[104:107]
  v_exp_f32 v223, v151
  v_mfma_f32_16x16x32_bf16 v[128:131], a[136:139], v[72:75], v[128:131]
  v_cvt_pk_bf16_f32 v185, v218, v219
  v_add_f32 v226, v226, v220
  v_mfma_f32_16x16x32_bf16 v[136:139], a[136:139], v[76:79], v[136:139]
  v_exp_f32 v216, v152
  v_mfma_f32_16x16x32_bf16 v[100:103], a[140:143], v[40:43], v[100:103]
  ds_read_b128 a[172:175], v3 offset:19456
  v_add_f32 v226, v226, v221
  v_mfma_f32_16x16x32_bf16 v[108:111], a[140:143], v[44:47], v[108:111]
  v_exp_f32 v217, v153
  v_mfma_f32_16x16x32_bf16 v[132:135], a[140:143], v[72:75], v[132:135]
  v_cvt_pk_bf16_f32 v186, v220, v221
  v_add_f32 v226, v226, v222
  v_mfma_f32_16x16x32_bf16 v[140:143], a[140:143], v[76:79], v[140:143]
  s_waitcnt lgkmcnt(4)
  v_exp_f32 v218, v154
  v_mfma_f32_16x16x32_bf16 v[96:99], a[144:147], v[48:51], v[96:99]
  ds_read_b128 a[176:179], v3 offset:20480
  v_add_f32 v226, v226, v223
  v_mfma_f32_16x16x32_bf16 v[104:107], a[144:147], v[52:55], v[104:107]
  v_exp_f32 v219, v155
  v_mfma_f32_16x16x32_bf16 v[128:131], a[144:147], v[80:83], v[128:131]
  v_cvt_pk_bf16_f32 v187, v222, v223
  v_add_f32 v227, v216, v217
  v_mfma_f32_16x16x32_bf16 v[136:139], a[144:147], v[84:87], v[136:139]
  v_exp_f32 v220, v156
  v_mfma_f32_16x16x32_bf16 v[100:103], a[148:151], v[48:51], v[100:103]
  ds_read_b128 a[180:183], v3 offset:21504
  v_cvt_pk_bf16_f32 v188, v216, v217
  v_mfma_f32_16x16x32_bf16 v[108:111], a[148:151], v[52:55], v[108:111]
  v_exp_f32 v221, v157
  v_mfma_f32_16x16x32_bf16 v[132:135], a[148:151], v[80:83], v[132:135]
  buffer_load_dwordx4 v2, s[44:47], s26 offen offset:1024 sc1 lds
  v_add_f32 v227, v227, v218
  v_mfma_f32_16x16x32_bf16 v[140:143], a[148:151], v[84:87], v[140:143]
  v_exp_f32 v222, v158
  v_mfma_f32_16x16x32_bf16 v[96:99], a[152:155], v[56:59], v[96:99]
  ds_read_b128 a[184:187], v3 offset:22528
  v_add_f32 v227, v227, v219
  v_mfma_f32_16x16x32_bf16 v[104:107], a[152:155], v[60:63], v[104:107]
  v_exp_f32 v223, v159
  v_mfma_f32_16x16x32_bf16 v[128:131], a[152:155], v[88:91], v[128:131]
  v_cvt_pk_bf16_f32 v189, v218, v219
  v_add_f32 v227, v227, v220
  v_mfma_f32_16x16x32_bf16 v[136:139], a[152:155], v[92:95], v[136:139]
  v_exp_f32 v208, v112
  v_mfma_f32_16x16x32_bf16 v[100:103], a[156:159], v[56:59], v[100:103]
  ds_read_b128 a[188:191], v3 offset:23552
  v_add_f32 v227, v227, v221
  v_mfma_f32_16x16x32_bf16 v[108:111], a[156:159], v[60:63], v[108:111]
  v_exp_f32 v209, v113
  v_mfma_f32_16x16x32_bf16 v[132:135], a[156:159], v[88:91], v[132:135]
  v_cvt_pk_bf16_f32 v190, v220, v221
  v_add_f32 v227, v227, v222
  v_add_f32 v227, v227, v223
  v_mfma_f32_16x16x32_bf16 v[140:143], a[156:159], v[92:95], v[140:143]
  s_waitcnt lgkmcnt(4)
  v_exp_f32 v210, v114
  v_mfma_f32_16x16x32_bf16 a[0:3], a[160:163], v[160:163], a[0:3]
  ds_read_b128 a[128:131], v3 offset:0
  v_cvt_pk_bf16_f32 v191, v222, v223
  v_mfma_f32_16x16x32_bf16 a[4:7], a[160:163], v[164:167], a[4:7]
  v_exp_f32 v211, v115
  v_mfma_f32_16x16x32_bf16 a[64:67], a[160:163], v[176:179], a[64:67]
  v_exp_f32 v212, v116
  v_mfma_f32_16x16x32_bf16 a[68:71], a[160:163], v[180:183], a[68:71]
  v_add_f32 v224, v208, v209
  v_cvt_pk_bf16_f32 v168, v208, v209
  v_mfma_f32_16x16x32_bf16 a[8:11], a[164:167], v[160:163], a[8:11]
  ds_read_b128 a[132:135], v3 offset:1024
  v_add_f32 v224, v224, v210
  v_mfma_f32_16x16x32_bf16 a[12:15], a[164:167], v[164:167], a[12:15]
  v_exp_f32 v213, v117
  v_mfma_f32_16x16x32_bf16 a[72:75], a[164:167], v[176:179], a[72:75]
  buffer_load_dwordx4 v2, s[44:47], s26 offen offset:2048 sc1 lds
  v_add_f32 v224, v224, v211
  v_mfma_f32_16x16x32_bf16 a[76:79], a[164:167], v[180:183], a[76:79]
  v_exp_f32 v214, v118
  v_mfma_f32_16x16x32_bf16 a[16:19], a[168:171], v[160:163], a[16:19]
  ds_read_b128 a[136:139], v3 offset:2048
  v_cvt_pk_bf16_f32 v169, v210, v211
  v_mfma_f32_16x16x32_bf16 a[20:23], a[168:171], v[164:167], a[20:23]
  v_exp_f32 v215, v119
  v_mfma_f32_16x16x32_bf16 a[80:83], a[168:171], v[176:179], a[80:83]
  v_add_f32 v224, v224, v212
  v_add_f32 v224, v224, v213
  v_mfma_f32_16x16x32_bf16 a[84:87], a[168:171], v[180:183], a[84:87]
  v_exp_f32 v208, v120
  v_mfma_f32_16x16x32_bf16 a[24:27], a[172:175], v[160:163], a[24:27]
  ds_read_b128 a[140:143], v3 offset:3072
  v_cvt_pk_bf16_f32 v170, v212, v213
  v_mfma_f32_16x16x32_bf16 a[28:31], a[172:175], v[164:167], a[28:31]
  v_exp_f32 v209, v121
  v_mfma_f32_16x16x32_bf16 a[88:91], a[172:175], v[176:179], a[88:91]
  v_exp_f32 v210, v122
  v_mfma_f32_16x16x32_bf16 a[92:95], a[172:175], v[180:183], a[92:95]
  s_waitcnt lgkmcnt(4)
  v_add_f32 v224, v224, v214
  v_add_f32 v224, v224, v215
  v_mfma_f32_16x16x32_bf16 a[32:35], a[176:179], v[160:163], a[32:35]
  ds_read_b128 a[144:147], v3 offset:4096
  v_cvt_pk_bf16_f32 v171, v214, v215
  v_mfma_f32_16x16x32_bf16 a[36:39], a[176:179], v[164:167], a[36:39]
  v_exp_f32 v211, v123
  v_mfma_f32_16x16x32_bf16 a[96:99], a[176:179], v[176:179], a[96:99]
  v_add_f32 v225, v208, v209
  v_cvt_pk_bf16_f32 v172, v208, v209
  v_mfma_f32_16x16x32_bf16 a[100:103], a[176:179], v[180:183], a[100:103]
  v_exp_f32 v212, v124
  v_mfma_f32_16x16x32_bf16 a[40:43], a[180:183], v[160:163], a[40:43]
  ds_read_b128 a[148:151], v3 offset:5120
  v_add_f32 v225, v225, v210
  v_mfma_f32_16x16x32_bf16 a[44:47], a[180:183], v[164:167], a[44:47]
  v_exp_f32 v213, v125
  v_mfma_f32_16x16x32_bf16 a[104:107], a[180:183], v[176:179], a[104:107]
  buffer_load_dwordx4 v2, s[44:47], s26 offen offset:3072 sc1 lds
  v_add_f32 v225, v225, v211
  v_mfma_f32_16x16x32_bf16 a[108:111], a[180:183], v[180:183], a[108:111]
  s_add_u32 s26, s26, 16384
  v_exp_f32 v214, v126
  v_mfma_f32_16x16x32_bf16 a[48:51], a[184:187], v[160:163], a[48:51]
  s_add_u32 s24, s24, 32768
  ds_read_b128 a[152:155], v3 offset:6144
  v_cvt_pk_bf16_f32 v173, v210, v211
  v_mfma_f32_16x16x32_bf16 a[52:55], a[184:187], v[164:167], a[52:55]
  s_and_b32 s24, s24, 0x1ffff
  v_exp_f32 v215, v127
  v_mfma_f32_16x16x32_bf16 a[112:115], a[184:187], v[176:179], a[112:115]
  v_max3_f32 v5, v226, v227, v224
  v_add_f32 v225, v225, v212
  v_mfma_f32_16x16x32_bf16 a[116:119], a[184:187], v[180:183], a[116:119]
  v_add_f32 v225, v225, v213
  v_cvt_pk_bf16_f32 v174, v212, v213
  v_add_f32 v225, v225, v214
  v_mfma_f32_16x16x32_bf16 a[56:59], a[188:191], v[160:163], a[56:59]
  ds_read_b128 a[156:159], v3 offset:7168
  v_add_f32 v225, v225, v215
  v_max_f32 v5, v5, v225
  v_cmp_lt_f32 vcc, s81, v5
  v_mfma_f32_16x16x32_bf16 a[60:63], a[188:191], v[164:167], a[60:63]
  v_exp_f32 v216, v128
  v_mfma_f32_16x16x32_bf16 a[120:123], a[188:191], v[176:179], a[120:123]
  s_waitcnt lgkmcnt(4)
  v_cvt_pk_bf16_f32 v175, v214, v215
  v_mfma_f32_16x16x32_bf16 a[124:127], a[188:191], v[180:183], a[124:127]
  s_cbranch_vccnz fa_stub1
fa_back1:
  v_exp_f32 v217, v129
  v_add_f32 v228, v228, v224
  v_add_f32 v229, v229, v225
  v_add_f32 v230, v230, v226
  v_add_f32 v231, v231, v227
fa_DDe:
  v_mfma_f32_16x16x32_bf16 v[112:115], a[128:131], v[32:35], v[192:195]
  ds_read_b128 a[160:163], v3 offset:24576
  v_add_f32 v226, v216, v217
  v_mfma_f32_16x16x32_bf16 v[120:123], a[128:131], v[36:39], v[196:199]
  v_exp_f32 v218, v130
  v_mfma_f32_16x16x32_bf16 v[144:147], a[128:131], v[64:67], v[200:203]
  s_cmp_ge_u32 s26, s9
  v_exp_f32 v219, v131
  v_mfma_f32_16x16x32_bf16 v[152:155], a[128:131], v[68:71], v[204:207]
  s_cbranch_scc1 fa_hk5
fa_hb5:
  v_exp_f32 v220, v132
  v_mfma_f32_16x16x32_bf16 v[116:119], a[132:135], v[32:35], v[192:195]
  s_add_u32 s66, s66, 32768
  ds_read_b128 a[164:167], v3 offset:25600
  v_cvt_pk_bf16_f32 v176, v216, v217
  v_mfma_f32_16x16x32_bf16 v[124:127], a[132:135], v[36:39], v[196:199]
  s_mov_b32 m0, s25
  v_exp_f32 v221, v133
  v_mfma_f32_16x16x32_bf16 v[148:151], a[132:135], v[64:67], v[200:203]
  s_and_b32 s66, s66, 0x1ffff
  buffer_load_dwordx4 v2, s[48:51], s27 offen offset:0 sc1 lds
  v_add_f32 v226, v226, v218
  v_mfma_f32_16x16x32_bf16 v[156:159], a[132:135], v[68:71], v[204:207]
  v_exp_f32 v222, v134
  v_mfma_f32_16x16x32_bf16 v[112:115], a[136:139], v[40:43], v[112:115]
  ds_read_b128 a[168:171], v3 offset:26624
  v_add_f32 v226, v226, v219
  v_mfma_f32_16x16x32_bf16 v[120:123], a[136:139], v[44:47], v[120:123]
  v_exp_f32 v223, v135
  v_mfma_f32_16x16x32_bf16 v[144:147], a[136:139], v[72:75], v[144:147]
  v_cvt_pk_bf16_f32 v177, v218, v219
  v_add_f32 v226, v226, v220
  v_mfma_f32_16x16x32_bf16 v[152:155], a[136:139], v[76:79], v[152:155]
  v_exp_f32 v216, v136
  v_mfma_f32_16x16x32_bf16 v[116:119], a[140:143], v[40:43], v[116:119]
  ds_read_b128 a[172:175], v3 offset:27648
  v_add_f32 v226, v226, v221
  v_mfma_f32_16x16x32_bf16 v[124:127], a[140:143], v[44:47], v[124:127]
  v_exp_f32 v217, v137
  v_mfma_f32_16x16x32_bf16 v[148:151], a[140:143], v[72:75], v[148:151]
  v_cvt_pk_bf16_f32 v178, v220, v221
  v_add_f32 v226, v226, v222
  v_mfma_f32_16x16x32_bf16 v[156:159], a[140:143], v[76:79], v[156:159]
  s_waitcnt lgkmcnt(4)
  v_exp_f32 v218, v138
  v_mfma_f32_16x16x32_bf16 v[112:115], a[144:147], v[48:51], v[112:115]
  ds_read_b128 a[176:179], v3 offset:28672
  v_add_f32 v226, v226, v223
  v_mfma_f32_16x16x32_bf16 v[120:123], a[144:147], v[52:55], v[120:123]
  v_exp_f32 v219, v139
  v_mfma_f32_16x16x32_bf16 v[144:147], a[144:147], v[80:83], v[144:147]
  v_cvt_pk_bf16_f32 v179, v222, v223
  v_add_f32 v227, v216, v217
  v_mfma_f32_16x16x32_bf16 v[152:155], a[144:147], v[84:87], v[152:155]
  v_exp_f32 v220, v140
  v_mfma_f32_16x16x32_bf16 v[116:119], a[148:151], v[48:51], v[116:119]
  ds_read_b128 a[180:183], v3 offset:29696
  v_cvt_pk_bf16_f32 v180, v216, v217
  v_mfma_f32_16x16x32_bf16 v[124:127], a[148:151], v[52:55], v[124:127]
  v_exp_f32 v221, v141
  v_mfma_f32_16x16x32_bf16 v[148:151], a[148:151], v[80:83], v[148:151]
  buffer_load_dwordx4 v2, s[48:51], s27 offen offset:1024 sc1 lds
  v_add_f32 v227, v227, v218
  v_mfma_f32_16x16x32_bf16 v[156:159], a[148:151], v[84:87], v[156:159]
  v_exp_f32 v222, v142
  v_mfma_f32_16x16x32_bf16 v[112:115], a[152:155], v[56:59], v[112:115]
  ds_read_b128 a[184:187], v3 offset:30720
  v_add_f32 v227, v227, v219
  v_mfma_f32_16x16x32_bf16 v[120:123], a[152:155], v[60:63], v[120:123]
  v_exp_f32 v223, v143
  v_mfma_f32_16x16x32_bf16 v[144:147], a[152:155], v[88:91], v[144:147]
  v_cvt_pk_bf16_f32 v181, v218, v219
  v_add_f32 v227, v227, v220
  v_mfma_f32_16x16x32_bf16 v[152:155], a[152:155], v[92:95], v[152:155]
  v_exp_f32 v208, v96
  v_mfma_f32_16x16x32_bf16 v[116:119], a[156:159], v[56:59], v[116:119]
  ds_read_b128 a[188:191], v3 offset:31744
  v_add_f32 v227, v227, v221
  v_mfma_f32_16x16x32_bf16 v[124:127], a[156:159], v[60:63], v[124:127]
  v_exp_f32 v209, v97
  v_mfma_f32_16x16x32_bf16 v[148:151], a[156:159], v[88:91], v[148:151]
  v_cvt_pk_bf16_f32 v182, v220, v221
  v_add_f32 v227, v227, v222
  v_add_f32 v227, v227, v223
  v_mfma_f32_16x16x32_bf16 v[156:159], a[156:159], v[92:95], v[156:159]
  s_waitcnt lgkmcnt(4)
  v_exp_f32 v210, v98
  v_mfma_f32_16x16x32_bf16 a[0:3], a[160:163], v[168:171], a[0:3]
  ds_read_b128 a[128:131], v3 offset:8192
  v_cvt_pk_bf16_f32 v183, v222, v223
  v_mfma_f32_16x16x32_bf16 a[4:7], a[160:163], v[172:175], a[4:7]
  v_exp_f32 v211, v99
  v_mfma_f32_16x16x32_bf16 a[64:67], a[160:163], v[184:187], a[64:67]
  v_exp_f32 v212, v100
  v_mfma_f32_16x16x32_bf16 a[68:71], a[160:163], v[188:191], a[68:71]
  v_add_f32 v224, v208, v209
  v_cvt_pk_bf16_f32 v160, v208, v209
  v_mfma_f32_16x16x32_bf16 a[8:11], a[164:167], v[168:171], a[8:11]
  ds_read_b128 a[132:135], v3 offset:9216
  v_add_f32 v224, v224, v210
  v_mfma_f32_16x16x32_bf16 a[12:15], a[164:167], v[172:175], a[12:15]
  v_exp_f32 v213, v101
  v_mfma_f32_16x16x32_bf16 a[72:75], a[164:167], v[184:187], a[72:75]
  buffer_load_dwordx4 v2, s[48:51], s27 offen offset:2048 sc1 lds
  v_add_f32 v224, v224, v211
  v_mfma_f32_16x16x32_bf16 a[76:79], a[164:167], v[188:191], a[76:79]
  v_exp_f32 v214, v102
  v_mfma_f32_16x16x32_bf16 a[16:19], a[168:171], v[168:171], a[16:19]
  ds_read_b128 a[136:139], v3 offset:10240
  v_cvt_pk_bf16_f32 v161, v210, v211
  v_mfma_f32_16x16x32_bf16 a[20:23], a[168:171], v[172:175], a[20:23]
  v_exp_f32 v215, v103
  v_mfma_f32_16x16x32_bf16 a[80:83], a[168:171], v[184:187], a[80:83]
  v_add_f32 v224, v224, v212
  v_add_f32 v224, v224, v213
  v_mfma_f32_16x16x32_bf16 a[84:87], a[168:171], v[188:191], a[84:87]
  v_exp_f32 v208, v104
  v_mfma_f32_16x16x32_bf16 a[24:27], a[172:175], v[168:171], a[24:27]
  ds_read_b128 a[140:143], v3 offset:11264
  v_cvt_pk_bf16_f32 v162, v212, v213
  v_mfma_f32_16x16x32_bf16 a[28:31], a[172:175], v[172:175], a[28:31]
  v_exp_f32 v209, v105
  v_mfma_f32_16x16x32_bf16 a[88:91], a[172:175], v[184:187], a[88:91]
  v_exp_f32 v210, v106
  v_mfma_f32_16x16x32_bf16 a[92:95], a[172:175], v[188:191], a[92:95]
  s_waitcnt lgkmcnt(4)
  v_add_f32 v224, v224, v214
  v_add_f32 v224, v224, v215
  v_mfma_f32_16x16x32_bf16 a[32:35], a[176:179], v[168:171], a[32:35]
  ds_read_b128 a[144:147], v3 offset:12288
  v_cvt_pk_bf16_f32 v163, v214, v215
  v_mfma_f32_16x16x32_bf16 a[36:39], a[176:179], v[172:175], a[36:39]
  v_exp_f32 v211, v107
  v_mfma_f32_16x16x32_bf16 a[96:99], a[176:179], v[184:187], a[96:99]
  v_add_f32 v225, v208, v209
  v_cvt_pk_bf16_f32 v164, v208, v209
  v_mfma_f32_16x16x32_bf16 a[100:103], a[176:179], v[188:191], a[100:103]
  v_exp_f32 v212, v108
  v_mfma_f32_16x16x32_bf16 a[40:43], a[180:183], v[168:171], a[40:43]
  ds_read_b128 a[148:151], v3 offset:13312
  v_add_f32 v225, v225, v210
  v_mfma_f32_16x16x32_bf16 a[44:47], a[180:183], v[172:175], a[44:47]
  v_exp_f32 v213, v109
  v_mfma_f32_16x16x32_bf16 a[104:107], a[180:183], v[184:187], a[104:107]
  buffer_load_dwordx4 v2, s[48:51], s27 offen offset:3072 sc1 lds
  v_add_f32 v225, v225, v211
  v_mfma_f32_16x16x32_bf16 a[108:111], a[180:183], v[188:191], a[108:111]
  s_add_u32 s27, s27, 16384
  v_exp_f32 v214, v110
  v_mfma_f32_16x16x32_bf16 a[48:51], a[184:187], v[168:171], a[48:51]
  s_add_u32 s25, s25, 32768
  ds_read_b128 a[152:155], v3 offset:14336
  v_cvt_pk_bf16_f32 v165, v210, v211
  v_mfma_f32_16x16x32_bf16 a[52:55], a[184:187], v[172:175], a[52:55]
  s_and_b32 s25, s25, 0x1ffff
  v_exp_f32 v215, v111
  v_mfma_f32_16x16x32_bf16 a[112:115], a[184:187], v[184:187], a[112:115]
  v_max3_f32 v5, v226, v227, v224
  v_add_f32 v225, v225, v212
  v_mfma_f32_16x16x32_bf16 a[116:119], a[184:187], v[188:191], a[116:119]
  v_add_f32 v225, v225, v213
  v_cvt_pk_bf16_f32 v166, v212, v213
  v_add_f32 v225, v225, v214
  v_mfma_f32_16x16x32_bf16 a[56:59], a[188:191], v[168:171], a[56:59]
  s_sub_u32 s28, s28, 1
  ds_read_b128 a[156:159], v3 offset:15360
  v_add_f32 v225, v225, v215
  v_max_f32 v5, v5, v225
  v_cmp_lt_f32 vcc, s81, v5
  v_mfma_f32_16x16x32_bf16 a[60:63], a[188:191], v[172:175], a[60:63]
  s_cmp_gt_u32 s28, s8
  v_exp_f32 v216, v144
  v_mfma_f32_16x16x32_bf16 a[120:123], a[188:191], v[184:187], a[120:123]
  s_waitcnt lgkmcnt(4)
  v_cvt_pk_bf16_f32 v167, v214, v215
  v_add_u32 v3, s66, v2
  v_mfma_f32_16x16x32_bf16 a[124:127], a[188:191], v[188:191], a[124:127]
  s_cbranch_vccnz fa_stub2
fa_back2:
  v_exp_f32 v217, v145
  v_add_f32 v228, v228, v224
  v_add_f32 v229, v229, v225
  v_add_f32 v230, v230, v226
  v_add_f32 v231, v231, v227
  s_cbranch_scc1 fa_DD
  s_cmp_lg_u32 s8, 0
  s_cbranch_scc1 fa_DDF
fa_Aexit:
  s_bitcmp1_b32 s20, 0
  s_cbranch_scc1 fa_Aodd
  v_mfma_f32_16x16x32_bf16 v[96:99], a[128:131], v[32:35], v[192:195]
  s_waitcnt vmcnt(12)
  v_exp_f32 v218, v146
  v_mfma_f32_16x16x32_bf16 v[104:107], a[128:131], v[36:39], v[196:199]
  s_barrier
  v_exp_f32 v219, v147
  v_mfma_f32_16x16x32_bf16 v[128:131], a[128:131], v[64:67], v[200:203]
  ds_read_b128 a[160:163], v3 offset:16384
  v_add_f32 v226, v216, v217
  v_mfma_f32_16x16x32_bf16 v[136:139], a[128:131], v[68:71], v[204:207]
  v_exp_f32 v220, v148
  v_mfma_f32_16x16x32_bf16 v[100:103], a[132:135], v[32:35], v[192:195]
  ds_read_b128 a[164:167], v3 offset:17408
  v_cvt_pk_bf16_f32 v184, v216, v217
  v_mfma_f32_16x16x32_bf16 v[108:111], a[132:135], v[36:39], v[196:199]
  s_mov_b32 m0, s24
  v_exp_f32 v221, v149
  v_mfma_f32_16x16x32_bf16 v[132:135], a[132:135], v[64:67], v[200:203]
  buffer_load_dwordx4 v2, s[44:47], s26 offen offset:0 sc1 lds
  v_add_f32 v226, v226, v218
  v_mfma_f32_16x16x32_bf16 v[140:143], a[132:135], v[68:71], v[204:207]
  v_exp_f32 v222, v150
  v_mfma_f32_16x16x32_bf16 v[96:99], a[136:139], v[40:43], v[96:99]
  ds_read_b128 a[168:171], v3 offset:18432
  v_add_f32 v226, v226, v219
  v_mfma_f32_16x16x32_bf16 v[104:107], a[136:139], v[44:47], v[104:107]
  v_exp_f32 v223, v151
  v_mfma_f32_16x16x32_bf16 v[128:131], a[136:139], v[72:75], v[128:131]
  v_cvt_pk_bf16_f32 v185, v218, v219
  v_add_f32 v226, v226, v220
  v_mfma_f32_16x16x32_bf16 v[136:139], a[136:139], v[76:79], v[136:139]
  v_exp_f32 v216, v152
  v_mfma_f32_16x16x32_bf16 v[100:103], a[140:143], v[40:43], v[100:103]
  ds_read_b128 a[172:175], v3 offset:19456
  v_add_f32 v226, v226, v221
  v_mfma_f32_16x16x32_bf16 v[108:111], a[140:143], v[44:47], v[108:111]
  v_exp_f32 v217, v153
  v_mfma_f32_16x16x32_bf16 v[132:135], a[140:143], v[72:75], v[132:135]
  v_cvt_pk_bf16_f32 v186, v220, v221
  v_add_f32 v226, v226, v222
  v_mfma_f32_16x16x32_bf16 v[140:143], a[140:143], v[76:79], v[140:143]
  s_waitcnt lgkmcnt(4)
  v_exp_f32 v218, v154
  v_mfma_f32_16x16x32_bf16 v[96:99], a[144:147], v[48:51], v[96:99]
  ds_read_b128 a[176:179], v3 offset:20480
  v_add_f32 v226, v226, v223
  v_mfma_f32_16x16x32_bf16 v[104:107], a[144:147], v[52:55], v[104:107]
  v_exp_f32 v219, v155
  v_mfma_f32_16x16x32_bf16 v[128:131], a[144:147], v[80:83], v[128:131]
  v_cvt_pk_bf16_f32 v187, v222, v223
  v_add_f32 v227, v216, v217
  v_mfma_f32_16x16x32_bf16 v[136:139], a[144:147], v[84:87], v[136:139]
  v_exp_f32 v220, v156
  v_mfma_f32_16x16x32_bf16 v[100:103], a[148:151], v[48:51], v[100:103]
  ds_read_b128 a[180:183], v3 offset:21504
  v_cvt_pk_bf16_f32 v188, v216, v217
  v_mfma_f32_16x16x32_bf16 v[108:111], a[148:151], v[52:55], v[108:111]
  v_exp_f32 v221, v157
  v_mfma_f32_16x16x32_bf16 v[132:135], a[148:151], v[80:83], v[132:135]
  buffer_load_dwordx4 v2, s[44:47], s26 offen offset:1024 sc1 lds
  v_add_f32 v227, v227, v218
  v_mfma_f32_16x16x32_bf16 v[140:143], a[148:151], v[84:87], v[140:143]
  v_exp_f32 v222, v158
  v_mfma_f32_16x16x32_bf16 v[96:99], a[152:155], v[56:59], v[96:99]
  ds_read_b128 a[184:187], v3 offset:22528
  v_add_f32 v227, v227, v219
  v_mfma_f32_16x16x32_bf16 v[104:107], a[152:155], v[60:63], v[104:107]
  v_exp_f32 v223, v159
  v_mfma_f32_16x16x32_bf16 v[128:131], a[152:155], v[88:91], v[128:131]
  v_cvt_pk_bf16_f32 v189, v218, v219
  v_add_f32 v227, v227, v220
  v_mfma_f32_16x16x32_bf16 v[136:139], a[152:155], v[92:95], v[136:139]
  v_exp_f32 v208, v112
  v_mfma_f32_16x16x32_bf16 v[100:103], a[156:159], v[56:59], v[100:103]
  ds_read_b128 a[188:191], v3 offset:23552
  v_add_f32 v227, v227, v221
  v_mfma_f32_16x16x32_bf16 v[108:111], a[156:159], v[60:63], v[108:111]
  v_exp_f32 v209, v113
  v_mfma_f32_16x16x32_bf16 v[132:135], a[156:159], v[88:91], v[132:135]
  v_cvt_pk_bf16_f32 v190, v220, v221
  v_add_f32 v227, v227, v222
  v_add_f32 v227, v227, v223
  v_mfma_f32_16x16x32_bf16 v[140:143], a[156:159], v[92:95], v[140:143]
  s_waitcnt lgkmcnt(4)
  v_exp_f32 v210, v114
  v_mfma_f32_16x16x32_bf16 a[0:3], a[160:163], v[160:163], a[0:3]
  ds_read_b128 a[128:131], v3 offset:0
  v_cvt_pk_bf16_f32 v191, v222, v223
  v_mfma_f32_16x16x32_bf16 a[4:7], a[160:163], v[164:167], a[4:7]
  v_exp_f32 v211, v115
  v_mfma_f32_16x16x32_bf16 a[64:67], a[160:163], v[176:179], a[64:67]
  v_exp_f32 v212, v116
  v_mfma_f32_16x16x32_bf16 a[68:71], a[160:163], v[180:183], a[68:71]
  v_add_f32 v224, v208, v209
  v_cvt_pk_bf16_f32 v168, v208, v209
  v_mfma_f32_16x16x32_bf16 a[8:11], a[164:167], v[160:163], a[8:11]
  ds_read_b128 a[132:135], v3 offset:1024
  v_add_f32 v224, v224, v210
  v_mfma_f32_16x16x32_bf16 a[12:15], a[164:167], v[164:167], a[12:15]
  v_exp_f32 v213, v117
  v_mfma_f32_16x16x32_bf16 a[72:75], a[164:167], v[176:179], a[72:75]
  buffer_load_dwordx4 v2, s[44:47], s26 offen offset:2048 sc1 lds
  v_add_f32 v224, v224, v211
  v_mfma_f32_16x16x32_bf16 a[76:79], a[164:167], v[180:183], a[76:79]
  v_exp_f32 v214, v118
  v_mfma_f32_16x16x32_bf16 a[16:19], a[168:171], v[160:163], a[16:19]
  ds_read_b128 a[136:139], v3 offset:2048
  v_cvt_pk_bf16_f32 v169, v210, v211
  v_mfma_f32_16x16x32_bf16 a[20:23], a[168:171], v[164:167], a[20:23]
  v_exp_f32 v215, v119
  v_mfma_f32_16x16x32_bf16 a[80:83], a[168:171], v[176:179], a[80:83]
  v_add_f32 v224, v224, v212
  v_add_f32 v224, v224, v213
  v_mfma_f32_16x16x32_bf16 a[84:87], a[168:171], v[180:183], a[84:87]
  v_exp_f32 v208, v120
  v_mfma_f32_16x16x32_bf16 a[24:27], a[172:175], v[160:163], a[24:27]
  ds_read_b128 a[140:143], v3 offset:3072
  v_cvt_pk_bf16_f32 v170, v212, v213
  v_mfma_f32_16x16x32_bf16 a[28:31], a[172:175], v[164:167], a[28:31]
  v_exp_f32 v209, v121
  v_mfma_f32_16x16x32_bf16 a[88:91], a[172:175], v[176:179], a[88:91]
  v_exp_f32 v210, v122
  v_mfma_f32_16x16x32_bf16 a[92:95], a[172:175], v[180:183], a[92:95]
  s_waitcnt lgkmcnt(4)
  v_add_f32 v224, v224, v214
  v_add_f32 v224, v224, v215
  v_mfma_f32_16x16x32_bf16 a[32:35], a[176:179], v[160:163], a[32:35]
  ds_read_b128 a[144:147], v3 offset:4096
  v_cvt_pk_bf16_f32 v171, v214, v215
  v_mfma_f32_16x16x32_bf16 a[36:39], a[176:179], v[164:167], a[36:39]
  v_exp_f32 v211, v123
  v_mfma_f32_16x16x32_bf16 a[96:99], a[176:179], v[176:179], a[96:99]
  v_add_f32 v225, v208, v209
  v_cvt_pk_bf16_f32 v172, v208, v209
  v_mfma_f32_16x16x32_bf16 a[100:103], a[176:179], v[180:183], a[100:103]
  v_exp_f32 v212, v124
  v_mfma_f32_16x16x32_bf16 a[40:43], a[180:183], v[160:163], a[40:43]
  ds_read_b128 a[148:151], v3 offset:5120
  v_add_f32 v225, v225, v210
  v_mfma_f32_16x16x32_bf16 a[44:47], a[180:183], v[164:167], a[44:47]
  v_exp_f32 v213, v125
  v_mfma_f32_16x16x32_bf16 a[104:107], a[180:183], v[176:179], a[104:107]
  buffer_load_dwordx4 v2, s[44:47], s26 offen offset:3072 sc1 lds
  v_add_f32 v225, v225, v211
  v_mfma_f32_16x16x32_bf16 a[108:111], a[180:183], v[180:183], a[108:111]
  s_add_u32 s26, s26, 16384
  v_exp_f32 v214, v126
  v_mfma_f32_16x16x32_bf16 a[48:51], a[184:187], v[160:163], a[48:51]
  s_add_u32 s24, s24, 32768
  ds_read_b128 a[152:155], v3 offset:6144
  v_cvt_pk_bf16_f32 v173, v210, v211
  v_mfma_f32_16x16x32_bf16 a[52:55], a[184:187], v[164:167], a[52:55]
  s_and_b32 s24, s24, 0x1ffff
  v_exp_f32 v215, v127
  v_mfma_f32_16x16x32_bf16 a[112:115], a[184:187], v[176:179], a[112:115]
  v_max3_f32 v5, v226, v227, v224
  v_add_f32 v225, v225, v212
  v_mfma_f32_16x16x32_bf16 a[116:119], a[184:187], v[180:183], a[116:119]
  v_add_f32 v225, v225, v213
  v_cvt_pk_bf16_f32 v174, v212, v213
  v_add_f32 v225, v225, v214
  v_mfma_f32_16x16x32_bf16 a[56:59], a[188:191], v[160:163], a[56:59]
  ds_read_b128 a[156:159], v3 offset:7168
  v_add_f32 v225, v225, v215
  v_max_f32 v5, v5, v225
  v_cmp_lt_f32 vcc, s81, v5
  v_mfma_f32_16x16x32_bf16 a[60:63], a[188:191], v[164:167], a[60:63]
  v_exp_f32 v216, v128
  v_mfma_f32_16x16x32_bf16 a[120:123], a[188:191], v[176:179], a[120:123]
  s_waitcnt lgkmcnt(4)
  v_cvt_pk_bf16_f32 v175, v214, v215
  v_mfma_f32_16x16x32_bf16 a[124:127], a[188:191], v[180:183], a[124:127]
  s_cbranch_vccnz fa_stub4
fa_back4:
  v_exp_f32 v217, v129
  v_add_f32 v228, v228, v224
  v_add_f32 v229, v229, v225
  v_add_f32 v230, v230, v226
  v_add_f32 v231, v231, v227
  v_mfma_f32_16x16x32_bf16 v[144:147], a[128:131], v[64:67], v[200:203]
  ds_read_b128 a[160:163], v3 offset:24576
  v_exp_f32 v218, v130
  v_mfma_f32_16x16x32_bf16 v[152:155], a[128:131], v[68:71], v[204:207]
  v_exp_f32 v219, v131
  v_add_f32 v226, v216, v217
  v_mfma_f32_16x16x32_bf16 v[148:151], a[132:135], v[64:67], v[200:203]
  s_add_u32 s66, s66, 32768
  ds_read_b128 a[164:167], v3 offset:25600
  v_exp_f32 v220, v132
  v_mfma_f32_16x16x32_bf16 v[156:159], a[132:135], v[68:71], v[204:207]
  s_and_b32 s66, s66, 0x1ffff
  v_exp_f32 v221, v133
  v_cvt_pk_bf16_f32 v176, v216, v217
  v_mfma_f32_16x16x32_bf16 v[144:147], a[136:139], v[72:75], v[144:147]
  ds_read_b128 a[168:171], v3 offset:26624
  v_add_f32 v226, v226, v218
  v_add_f32 v226, v226, v219
  v_mfma_f32_16x16x32_bf16 v[152:155], a[136:139], v[76:79], v[152:155]
  s_mov_b32 m0, s25
  v_exp_f32 v222, v134
  v_cvt_pk_bf16_f32 v177, v218, v219
  v_mfma_f32_16x16x32_bf16 v[148:151], a[140:143], v[72:75], v[148:151]
  ds_read_b128 a[172:175], v3 offset:27648
  buffer_load_dwordx4 v2, s[48:51], s27 offen offset:0 sc1 lds
  v_add_f32 v226, v226, v220
  v_add_f32 v226, v226, v221
  v_mfma_f32_16x16x32_bf16 v[156:159], a[140:143], v[76:79], v[156:159]
  s_waitcnt lgkmcnt(4)
  v_exp_f32 v223, v135
  v_cvt_pk_bf16_f32 v178, v220, v221
  v_mfma_f32_16x16x32_bf16 v[144:147], a[144:147], v[80:83], v[144:147]
  ds_read_b128 a[176:179], v3 offset:28672
  v_cndmask_b32 v96, v4, v96, s[68:69]
  v_cndmask_b32 v97, v4, v97, s[70:71]
  v_mfma_f32_16x16x32_bf16 v[152:155], a[144:147], v[84:87], v[152:155]
  v_exp_f32 v216, v136
  v_cndmask_b32 v98, v4, v98, s[72:73]
  v_mfma_f32_16x16x32_bf16 v[148:151], a[148:151], v[80:83], v[148:151]
  ds_read_b128 a[180:183], v3 offset:29696
  v_cndmask_b32 v99, v4, v99, s[74:75]
  v_mov_b32 v100, v4
  v_mfma_f32_16x16x32_bf16 v[156:159], a[148:151], v[84:87], v[156:159]
  v_exp_f32 v217, v137
  v_mov_b32 v101, v4
  v_mfma_f32_16x16x32_bf16 v[144:147], a[152:155], v[88:91], v[144:147]
  ds_read_b128 a[184:187], v3 offset:30720
  v_mov_b32 v102, v4
  v_mov_b32 v103, v4
  v_mfma_f32_16x16x32_bf16 v[152:155], a[152:155], v[92:95], v[152:155]
  v_exp_f32 v218, v138
  v_cndmask_b32 v108, v4, v108, s[68:69]
  v_mfma_f32_16x16x32_bf16 v[148:151], a[156:159], v[88:91], v[148:151]
  ds_read_b128 a[188:191], v3 offset:31744
  v_cndmask_b32 v109, v4, v109, s[70:71]
  v_cndmask_b32 v110, v4, v110, s[72:73]
  v_mfma_f32_16x16x32_bf16 v[156:159], a[156:159], v[92:95], v[156:159]
  s_waitcnt lgkmcnt(4)
  v_exp_f32 v219, v139
  v_cndmask_b32 v111, v4, v111, s[74:75]
  v_mfma_f32_16x16x32_bf16 a[0:3], a[160:163], v[168:171], a[0:3]
  ds_read_b128 a[128:131], v3 offset:8192
  v_add_f32 v226, v226, v222
  v_add_f32 v226, v226, v223
  v_mfma_f32_16x16x32_bf16 a[4:7], a[160:163], v[172:175], a[4:7]
  v_exp_f32 v220, v140
  v_cvt_pk_bf16_f32 v179, v222, v223
  v_mfma_f32_16x16x32_bf16 a[64:67], a[160:163], v[184:187], a[64:67]
  buffer_load_dwordx4 v2, s[48:51], s27 offen offset:1024 sc1 lds
  v_add_f32 v227, v216, v217
  v_cvt_pk_bf16_f32 v180, v216, v217
  v_mfma_f32_16x16x32_bf16 a[68:71], a[160:163], v[188:191], a[68:71]
  v_exp_f32 v221, v141
  v_add_f32 v227, v227, v218
  v_mfma_f32_16x16x32_bf16 a[8:11], a[164:167], v[168:171], a[8:11]
  ds_read_b128 a[132:135], v3 offset:9216
  v_exp_f32 v222, v142
  v_mfma_f32_16x16x32_bf16 a[12:15], a[164:167], v[172:175], a[12:15]
  v_exp_f32 v223, v143
  v_mfma_f32_16x16x32_bf16 a[72:75], a[164:167], v[184:187], a[72:75]
  v_exp_f32 v208, v96
  v_mfma_f32_16x16x32_bf16 a[76:79], a[164:167], v[188:191], a[76:79]
  v_exp_f32 v209, v97
  v_mfma_f32_16x16x32_bf16 a[16:19], a[168:171], v[168:171], a[16:19]
  ds_read_b128 a[136:139], v3 offset:10240
  v_add_f32 v227, v227, v219
  v_cvt_pk_bf16_f32 v181, v218, v219
  v_add_f32 v227, v227, v220
  v_add_f32 v227, v227, v221
  v_cvt_pk_bf16_f32 v182, v220, v221
  v_mfma_f32_16x16x32_bf16 a[20:23], a[168:171], v[172:175], a[20:23]
  v_exp_f32 v210, v98
  v_mfma_f32_16x16x32_bf16 a[80:83], a[168:171], v[184:187], a[80:83]
  v_exp_f32 v211, v99
  v_mfma_f32_16x16x32_bf16 a[84:87], a[168:171], v[188:191], a[84:87]
  v_exp_f32 v212, v100
  v_mfma_f32_16x16x32_bf16 a[24:27], a[172:175], v[168:171], a[24:27]
  ds_read_b128 a[140:143], v3 offset:11264
  v_add_f32 v227, v227, v222
  v_add_f32 v227, v227, v223
  v_cvt_pk_bf16_f32 v183, v222, v223
  v_add_f32 v224, v208, v209
  v_cvt_pk_bf16_f32 v160, v208, v209
  v_mfma_f32_16x16x32_bf16 a[28:31], a[172:175], v[172:175], a[28:31]
  v_exp_f32 v213, v101
  v_mfma_f32_16x16x32_bf16 a[88:91], a[172:175], v[184:187], a[88:91]
  buffer_load_dwordx4 v2, s[48:51], s27 offen offset:2048 sc1 lds
  v_add_f32 v224, v224, v210
  v_add_f32 v224, v224, v211
  v_cvt_pk_bf16_f32 v161, v210, v211
  v_mfma_f32_16x16x32_bf16 a[92:95], a[172:175], v[188:191], a[92:95]
  s_waitcnt lgkmcnt(4)
  v_exp_f32 v214, v102
  v_mfma_f32_16x16x32_bf16 a[32:35], a[176:179], v[168:171], a[32:35]
  ds_read_b128 a[144:147], v3 offset:12288
  v_exp_f32 v215, v103
  v_mfma_f32_16x16x32_bf16 a[36:39], a[176:179], v[172:175], a[36:39]
  v_exp_f32 v208, v104
  v_mfma_f32_16x16x32_bf16 a[96:99], a[176:179], v[184:187], a[96:99]
  v_exp_f32 v209, v105
  v_mfma_f32_16x16x32_bf16 a[100:103], a[176:179], v[188:191], a[100:103]
  v_exp_f32 v210, v106
  v_mfma_f32_16x16x32_bf16 a[40:43], a[180:183], v[168:171], a[40:43]
  ds_read_b128 a[148:151], v3 offset:13312
  v_add_f32 v224, v224, v212
  v_add_f32 v224, v224, v213
  v_cvt_pk_bf16_f32 v162, v212, v213
  v_add_f32 v224, v224, v214
  v_add_f32 v224, v224, v215
  v_cvt_pk_bf16_f32 v163, v214, v215
  v_mfma_f32_16x16x32_bf16 a[44:47], a[180:183], v[172:175], a[44:47]
  v_exp_f32 v211, v107
  v_mfma_f32_16x16x32_bf16 a[104:107], a[180:183], v[184:187], a[104:107]
  v_exp_f32 v212, v108
  v_mfma_f32_16x16x32_bf16 a[108:111], a[180:183], v[188:191], a[108:111]
  v_exp_f32 v213, v109
  v_mfma_f32_16x16x32_bf16 a[48:51], a[184:187], v[168:171], a[48:51]
  ds_read_b128 a[152:155], v3 offset:14336
  v_add_f32 v225, v208, v209
  v_cvt_pk_bf16_f32 v164, v208, v209
  v_add_f32 v225, v225, v210
  v_add_f32 v225, v225, v211
  v_cvt_pk_bf16_f32 v165, v210, v211
  v_mfma_f32_16x16x32_bf16 a[52:55], a[184:187], v[172:175], a[52:55]
  v_exp_f32 v214, v110
  v_mfma_f32_16x16x32_bf16 a[112:115], a[184:187], v[184:187], a[112:115]
  buffer_load_dwordx4 v2, s[48:51], s27 offen offset:3072 sc1 lds
  v_max3_f32 v5, v226, v227, v224
  v_add_f32 v225, v225, v212
  v_add_f32 v225, v225, v213
  v_mfma_f32_16x16x32_bf16 a[116:119], a[184:187], v[188:191], a[116:119]
  s_add_u32 s27, s27, 16384
  v_exp_f32 v215, v111
  v_mfma_f32_16x16x32_bf16 a[56:59], a[188:191], v[168:171], a[56:59]
  s_add_u32 s25, s25, 32768
  ds_read_b128 a[156:159], v3 offset:15360
  v_cvt_pk_bf16_f32 v166, v212, v213
  v_add_f32 v225, v225, v214
  v_add_f32 v225, v225, v215
  v_max_f32 v5, v5, v225
  v_cmp_lt_f32 vcc, s81, v5
  v_mfma_f32_16x16x32_bf16 a[60:63], a[188:191], v[172:175], a[60:63]
  s_and_b32 s25, s25, 0x1ffff
  v_exp_f32 v216, v144
  v_mfma_f32_16x16x32_bf16 a[120:123], a[188:191], v[184:187], a[120:123]
  s_waitcnt lgkmcnt(4)
  v_cvt_pk_bf16_f32 v167, v214, v215
  v_add_u32 v3, s66, v2
  v_mfma_f32_16x16x32_bf16 a[124:127], a[188:191], v[188:191], a[124:127]
  s_cbranch_vccnz fa_stub5
fa_back5:
  v_exp_f32 v217, v145
  v_add_f32 v228, v228, v224
  v_add_f32 v229, v229, v225
  v_add_f32 v230, v230, v226
  v_add_f32 v231, v231, v227
fa_AV:
  v_mfma_f32_16x16x32_bf16 v[128:131], a[128:131], v[64:67], v[200:203]
  s_waitcnt vmcnt(12)
  v_exp_f32 v218, v146
  v_mfma_f32_16x16x32_bf16 v[136:139], a[128:131], v[68:71], v[204:207]
  s_barrier
  v_exp_f32 v219, v147
  v_mfma_f32_16x16x32_bf16 v[132:135], a[132:135], v[64:67], v[200:203]
  ds_read_b128 a[160:163], v3 offset:16384
  ds_read_b128 a[164:167], v3 offset:17408
  v_add_f32 v226, v216, v217
  v_mfma_f32_16x16x32_bf16 v[140:143], a[132:135], v[68:71], v[204:207]
  v_exp_f32 v220, v148
  v_mfma_f32_16x16x32_bf16 v[128:131], a[136:139], v[72:75], v[128:131]
  ds_read_b128 a[168:171], v3 offset:18432
  v_cvt_pk_bf16_f32 v184, v216, v217
  v_mfma_f32_16x16x32_bf16 v[136:139], a[136:139], v[76:79], v[136:139]
  s_mov_b32 m0, s24
  v_exp_f32 v221, v149
  v_mfma_f32_16x16x32_bf16 v[132:135], a[140:143], v[72:75], v[132:135]
  ds_read_b128 a[172:175], v3 offset:19456
  buffer_load_dwordx4 v2, s[44:47], s26 offen offset:0 sc1 lds
  v_add_f32 v226, v226, v218
  v_mfma_f32_16x16x32_bf16 v[140:143], a[140:143], v[76:79], v[140:143]
  s_waitcnt lgkmcnt(4)
  v_exp_f32 v222, v150
  v_mfma_f32_16x16x32_bf16 v[128:131], a[144:147], v[80:83], v[128:131]
  ds_read_b128 a[176:179], v3 offset:20480
  v_add_f32 v226, v226, v219
  v_mfma_f32_16x16x32_bf16 v[136:139], a[144:147], v[84:87], v[136:139]
  v_exp_f32 v223, v151
  v_mfma_f32_16x16x32_bf16 v[132:135], a[148:151], v[80:83], v[132:135]
  ds_read_b128 a[180:183], v3 offset:21504
  v_cvt_pk_bf16_f32 v185, v218, v219
  v_mfma_f32_16x16x32_bf16 v[140:143], a[148:151], v[84:87], v[140:143]
  v_add_f32 v226, v226, v220
  v_add_f32 v226, v226, v221
  v_mfma_f32_16x16x32_bf16 v[128:131], a[152:155], v[88:91], v[128:131]
  ds_read_b128 a[184:187], v3 offset:22528
  v_cvt_pk_bf16_f32 v186, v220, v221
  v_mfma_f32_16x16x32_bf16 v[136:139], a[152:155], v[92:95], v[136:139]
  v_exp_f32 v216, v152
  v_mfma_f32_16x16x32_bf16 v[132:135], a[156:159], v[88:91], v[132:135]
  ds_read_b128 a[188:191], v3 offset:23552
  v_add_f32 v226, v226, v222
  v_mfma_f32_16x16x32_bf16 v[140:143], a[156:159], v[92:95], v[140:143]
  s_waitcnt lgkmcnt(4)
  v_exp_f32 v217, v153
  v_mfma_f32_16x16x32_bf16 a[0:3], a[160:163], v[160:163], a[0:3]
  ds_read_b128 a[128:131], v3 offset:0
  v_add_f32 v226, v226, v223
  v_mfma_f32_16x16x32_bf16 a[4:7], a[160:163], v[164:167], a[4:7]
  v_exp_f32 v218, v154
  v_mfma_f32_16x16x32_bf16 a[64:67], a[160:163], v[176:179], a[64:67]
  buffer_load_dwordx4 v2, s[44:47], s26 offen offset:1024 sc1 lds
  v_cvt_pk_bf16_f32 v187, v222, v223
  v_mfma_f32_16x16x32_bf16 a[68:71], a[160:163], v[180:183], a[68:71]
  v_exp_f32 v219, v155
  v_mfma_f32_16x16x32_bf16 a[8:11], a[164:167], v[160:163], a[8:11]
  ds_read_b128 a[132:135], v3 offset:1024
  v_add_f32 v227, v216, v217
  v_mfma_f32_16x16x32_bf16 a[12:15], a[164:167], v[164:167], a[12:15]
  v_exp_f32 v220, v156
  v_mfma_f32_16x16x32_bf16 a[72:75], a[164:167], v[176:179], a[72:75]
  v_exp_f32 v221, v157
  v_mfma_f32_16x16x32_bf16 a[76:79], a[164:167], v[180:183], a[76:79]
  v_cvt_pk_bf16_f32 v188, v216, v217
  v_add_f32 v227, v227, v218
  v_mfma_f32_16x16x32_bf16 a[16:19], a[168:171], v[160:163], a[16:19]
  ds_read_b128 a[136:139], v3 offset:2048
  v_add_f32 v227, v227, v219
  v_mfma_f32_16x16x32_bf16 a[20:23], a[168:171], v[164:167], a[20:23]
  v_exp_f32 v222, v158
  v_mfma_f32_16x16x32_bf16 a[80:83], a[168:171], v[176:179], a[80:83]
  v_exp_f32 v223, v159
  v_mfma_f32_16x16x32_bf16 a[84:87], a[168:171], v[180:183], a[84:87]
  v_cvt_pk_bf16_f32 v189, v218, v219
  v_add_f32 v227, v227, v220
  v_mfma_f32_16x16x32_bf16 a[24:27], a[172:175], v[160:163], a[24:27]
  ds_read_b128 a[140:143], v3 offset:3072
  v_add_f32 v227, v227, v221
  v_mfma_f32_16x16x32_bf16 a[28:31], a[172:175], v[164:167], a[28:31]
  v_cvt_pk_bf16_f32 v190, v220, v221
  v_add_f32 v227, v227, v222
  v_mfma_f32_16x16x32_bf16 a[88:91], a[172:175], v[176:179], a[88:91]
  buffer_load_dwordx4 v2, s[44:47], s26 offen offset:2048 sc1 lds
  v_add_f32 v227, v227, v223
  v_mfma_f32_16x16x32_bf16 a[92:95], a[172:175], v[180:183], a[92:95]
  s_waitcnt lgkmcnt(4)
  v_max_f32 v5, v226, v227
  v_cmp_lt_f32 vcc, s81, v5
  v_mfma_f32_16x16x32_bf16 a[32:35], a[176:179], v[160:163], a[32:35]
  ds_read_b128 a[144:147], v3 offset:4096
  v_mfma_f32_16x16x32_bf16 a[36:39], a[176:179], v[164:167], a[36:39]
  v_mfma_f32_16x16x32_bf16 a[96:99], a[176:179], v[176:179], a[96:99]
  v_mfma_f32_16x16x32_bf16 a[100:103], a[176:179], v[180:183], a[100:103]
  v_mfma_f32_16x16x32_bf16 a[40:43], a[180:183], v[160:163], a[40:43]
  ds_read_b128 a[148:151], v3 offset:5120
  v_mfma_f32_16x16x32_bf16 a[44:47], a[180:183], v[164:167], a[44:47]
  v_mfma_f32_16x16x32_bf16 a[104:107], a[180:183], v[176:179], a[104:107]
  v_mfma_f32_16x16x32_bf16 a[108:111], a[180:183], v[180:183], a[108:111]
  v_mfma_f32_16x16x32_bf16 a[48:51], a[184:187], v[160:163], a[48:51]
  ds_read_b128 a[152:155], v3 offset:6144
  v_mfma_f32_16x16x32_bf16 a[52:55], a[184:187], v[164:167], a[52:55]
  v_mfma_f32_16x16x32_bf16 a[112:115], a[184:187], v[176:179], a[112:115]
  buffer_load_dwordx4 v2, s[44:47], s26 offen offset:3072 sc1 lds
  v_mfma_f32_16x16x32_bf16 a[116:119], a[184:187], v[180:183], a[116:119]
  s_add_u32 s26, s26, 16384
  v_mfma_f32_16x16x32_bf16 a[56:59], a[188:191], v[160:163], a[56:59]
  s_add_u32 s24, s24, 32768
  ds_read_b128 a[156:159], v3 offset:7168
  v_mfma_f32_16x16x32_bf16 a[60:63], a[188:191], v[164:167], a[60:63]
  s_and_b32 s24, s24, 0x1ffff
  v_exp_f32 v216, v128
  v_mfma_f32_16x16x32_bf16 a[120:123], a[188:191], v[176:179], a[120:123]
  s_waitcnt lgkmcnt(4)
  v_cvt_pk_bf16_f32 v191, v222, v223
  v_mfma_f32_16x16x32_bf16 a[124:127], a[188:191], v[180:183], a[124:127]
  s_cbranch_vccnz fa_stub6
fa_back6:
  v_exp_f32 v217, v129
  v_add_f32 v230, v230, v226
  v_add_f32 v231, v231, v227
  v_mfma_f32_16x16x32_bf16 v[144:147], a[128:131], v[64:67], v[200:203]
  ds_read_b128 a[160:163], v3 offset:24576
  v_add_f32 v226, v216, v217
  v_mfma_f32_16x16x32_bf16 v[152:155], a[128:131], v[68:71], v[204:207]
  v_exp_f32 v218, v130
  v_mfma_f32_16x16x32_bf16 v[148:151], a[132:135], v[64:67], v[200:203]
  s_add_u32 s66, s66, 32768
  ds_read_b128 a[164:167], v3 offset:25600
  v_cvt_pk_bf16_f32 v176, v216, v217
  v_mfma_f32_16x16x32_bf16 v[156:159], a[132:135], v[68:71], v[204:207]
  s_mov_b32 m0, s25
  v_exp_f32 v219, v131
  v_mfma_f32_16x16x32_bf16 v[144:147], a[136:139], v[72:75], v[144:147]
  s_and_b32 s66, s66, 0x1ffff
  ds_read_b128 a[168:171], v3 offset:26624
  buffer_load_dwordx4 v2, s[48:51], s27 offen offset:0 sc1 lds
  v_add_f32 v226, v226, v218
  v_add_f32 v226, v226, v219
  v_mfma_f32_16x16x32_bf16 v[152:155], a[136:139], v[76:79], v[152:155]
  v_exp_f32 v220, v132
  v_mfma_f32_16x16x32_bf16 v[148:151], a[140:143], v[72:75], v[148:151]
  ds_read_b128 a[172:175], v3 offset:27648
  v_cvt_pk_bf16_f32 v177, v218, v219
  v_mfma_f32_16x16x32_bf16 v[156:159], a[140:143], v[76:79], v[156:159]
  s_waitcnt lgkmcnt(4)
  v_exp_f32 v221, v133
  v_mfma_f32_16x16x32_bf16 v[144:147], a[144:147], v[80:83], v[144:147]
  ds_read_b128 a[176:179], v3 offset:28672
  v_add_f32 v226, v226, v220
  v_mfma_f32_16x16x32_bf16 v[152:155], a[144:147], v[84:87], v[152:155]
  v_exp_f32 v222, v134
  v_mfma_f32_16x16x32_bf16 v[148:151], a[148:151], v[80:83], v[148:151]
  ds_read_b128 a[180:183], v3 offset:29696
  buffer_load_dwordx4 v2, s[48:51], s27 offen offset:1024 sc1 lds
  v_add_f32 v226, v226, v221
  v_cvt_pk_bf16_f32 v178, v220, v221
  v_mfma_f32_16x16x32_bf16 v[156:159], a[148:151], v[84:87], v[156:159]
  v_exp_f32 v223, v135
  v_mfma_f32_16x16x32_bf16 v[144:147], a[152:155], v[88:91], v[144:147]
  ds_read_b128 a[184:187], v3 offset:30720
  v_add_f32 v226, v226, v222
  v_mfma_f32_16x16x32_bf16 v[152:155], a[152:155], v[92:95], v[152:155]
  v_exp_f32 v216, v136
  v_mfma_f32_16x16x32_bf16 v[148:151], a[156:159], v[88:91], v[148:151]
  ds_read_b128 a[188:191], v3 offset:31744
  v_add_f32 v226, v226, v223
  v_exp_f32 v217, v137
  v_mfma_f32_16x16x32_bf16 v[156:159], a[156:159], v[92:95], v[156:159]
  s_waitcnt lgkmcnt(4)
  v_exp_f32 v218, v138
  v_mfma_f32_16x16x32_bf16 a[64:67], a[160:163], v[184:187], a[64:67]
  ds_read_b128 a[128:131], v3 offset:8192
  v_cvt_pk_bf16_f32 v179, v222, v223
  v_mfma_f32_16x16x32_bf16 a[68:71], a[160:163], v[188:191], a[68:71]
  v_exp_f32 v219, v139
  v_mfma_f32_16x16x32_bf16 a[72:75], a[164:167], v[184:187], a[72:75]
  ds_read_b128 a[132:135], v3 offset:9216
  buffer_load_dwordx4 v2, s[48:51], s27 offen offset:2048 sc1 lds
  v_add_f32 v227, v216, v217
  v_mfma_f32_16x16x32_bf16 a[76:79], a[164:167], v[188:191], a[76:79]
  v_exp_f32 v220, v140
  v_mfma_f32_16x16x32_bf16 a[80:83], a[168:171], v[184:187], a[80:83]
  ds_read_b128 a[136:139], v3 offset:10240
  v_cvt_pk_bf16_f32 v180, v216, v217
  v_mfma_f32_16x16x32_bf16 a[84:87], a[168:171], v[188:191], a[84:87]
  v_exp_f32 v221, v141
  v_mfma_f32_16x16x32_bf16 a[88:91], a[172:175], v[184:187], a[88:91]
  ds_read_b128 a[140:143], v3 offset:11264
  v_add_f32 v227, v227, v218
  v_mfma_f32_16x16x32_bf16 a[92:95], a[172:175], v[188:191], a[92:95]
  s_waitcnt lgkmcnt(4)
  v_exp_f32 v222, v142
  v_mfma_f32_16x16x32_bf16 a[96:99], a[176:179], v[184:187], a[96:99]
  ds_read_b128 a[144:147], v3 offset:12288
  buffer_load_dwordx4 v2, s[48:51], s27 offen offset:3072 sc1 lds
  v_add_f32 v227, v227, v219
  v_cvt_pk_bf16_f32 v181, v218, v219
  v_mfma_f32_16x16x32_bf16 a[100:103], a[176:179], v[188:191], a[100:103]
  s_add_u32 s27, s27, 16384
  v_exp_f32 v223, v143
  v_mfma_f32_16x16x32_bf16 a[104:107], a[180:183], v[184:187], a[104:107]
  s_add_u32 s25, s25, 32768
  ds_read_b128 a[148:151], v3 offset:13312
  v_add_f32 v227, v227, v220
  v_mfma_f32_16x16x32_bf16 a[108:111], a[180:183], v[188:191], a[108:111]
  s_and_b32 s25, s25, 0x1ffff
  v_add_f32 v227, v227, v221
  v_cvt_pk_bf16_f32 v182, v220, v221
  v_add_f32 v227, v227, v222
  v_mfma_f32_16x16x32_bf16 a[112:115], a[184:187], v[184:187], a[112:115]
  ds_read_b128 a[152:155], v3 offset:14336
  v_add_f32 v227, v227, v223
  v_max_f32 v5, v226, v227
  v_cmp_lt_f32 vcc, s81, v5
  v_mfma_f32_16x16x32_bf16 a[116:119], a[184:187], v[188:191], a[116:119]
  v_exp_f32 v216, v144
  v_mfma_f32_16x16x32_bf16 a[120:123], a[188:191], v[184:187], a[120:123]
  s_waitcnt lgkmcnt(3)
  ds_read_b128 a[156:159], v3 offset:15360
  v_cvt_pk_bf16_f32 v183, v222, v223
  v_add_u32 v3, s66, v2
  v_mfma_f32_16x16x32_bf16 a[124:127], a[188:191], v[188:191], a[124:127]
  s_cbranch_vccnz fa_stub7
fa_back7:
  v_exp_f32 v217, v145
  v_add_f32 v230, v230, v226
  v_add_f32 v231, v231, v227
  s_branch fa_SSpre
fa_Aodd:
  v_mfma_f32_16x16x32_bf16 v[128:131], a[128:131], v[64:67], v[200:203]
  s_waitcnt vmcnt(12)
  v_exp_f32 v218, v146
  v_add_f32 v226, v216, v217
  v_mfma_f32_16x16x32_bf16 v[136:139], a[128:131], v[68:71], v[204:207]
  s_barrier
  v_exp_f32 v219, v147
  v_cvt_pk_bf16_f32 v184, v216, v217
  v_mfma_f32_16x16x32_bf16 v[132:135], a[132:135], v[64:67], v[200:203]
  ds_read_b128 a[160:163], v3 offset:16384
  ds_read_b128 a[164:167], v3 offset:17408
  v_exp_f32 v220, v148
  v_mfma_f32_16x16x32_bf16 v[140:143], a[132:135], v[68:71], v[204:207]
  v_exp_f32 v221, v149
  v_add_f32 v226, v226, v218
  v_mfma_f32_16x16x32_bf16 v[128:131], a[136:139], v[72:75], v[128:131]
  ds_read_b128 a[168:171], v3 offset:18432
  v_add_f32 v226, v226, v219
  v_cvt_pk_bf16_f32 v185, v218, v219
  v_mfma_f32_16x16x32_bf16 v[136:139], a[136:139], v[76:79], v[136:139]
  s_mov_b32 m0, s24
  v_exp_f32 v222, v150
  v_add_f32 v226, v226, v220
  v_mfma_f32_16x16x32_bf16 v[132:135], a[140:143], v[72:75], v[132:135]
  ds_read_b128 a[172:175], v3 offset:19456
  buffer_load_dwordx4 v2, s[44:47], s26 offen offset:0 sc1 lds
  v_add_f32 v226, v226, v221
  v_cvt_pk_bf16_f32 v186, v220, v221
  v_mfma_f32_16x16x32_bf16 v[140:143], a[140:143], v[76:79], v[140:143]
  s_waitcnt lgkmcnt(4)
  v_exp_f32 v223, v151
  v_cndmask_b32 v112, v4, v112, s[68:69]
  v_mfma_f32_16x16x32_bf16 v[128:131], a[144:147], v[80:83], v[128:131]
  ds_read_b128 a[176:179], v3 offset:20480
  v_cndmask_b32 v113, v4, v113, s[70:71]
  v_cndmask_b32 v114, v4, v114, s[72:73]
  v_mfma_f32_16x16x32_bf16 v[136:139], a[144:147], v[84:87], v[136:139]
  v_exp_f32 v216, v152
  v_cndmask_b32 v115, v4, v115, s[74:75]
  v_mfma_f32_16x16x32_bf16 v[132:135], a[148:151], v[80:83], v[132:135]
  ds_read_b128 a[180:183], v3 offset:21504
  v_mov_b32 v116, v4
  v_mov_b32 v117, v4
  v_mfma_f32_16x16x32_bf16 v[140:143], a[148:151], v[84:87], v[140:143]
  v_exp_f32 v217, v153
  v_mov_b32 v118, v4
  v_mfma_f32_16x16x32_bf16 v[128:131], a[152:155], v[88:91], v[128:131]
  ds_read_b128 a[184:187], v3 offset:22528
  v_mov_b32 v119, v4
  v_cndmask_b32 v124, v4, v124, s[68:69]
  v_mfma_f32_16x16x32_bf16 v[136:139], a[152:155], v[92:95], v[136:139]
  v_exp_f32 v218, v154
  v_cndmask_b32 v125, v4, v125, s[70:71]
  v_mfma_f32_16x16x32_bf16 v[132:135], a[156:159], v[88:91], v[132:135]
  ds_read_b128 a[188:191], v3 offset:23552
  v_cndmask_b32 v126, v4, v126, s[72:73]
  v_cndmask_b32 v127, v4, v127, s[74:75]
  v_mfma_f32_16x16x32_bf16 v[140:143], a[156:159], v[92:95], v[140:143]
  s_waitcnt lgkmcnt(4)
  v_exp_f32 v219, v155
  v_add_f32 v226, v226, v222
  v_mfma_f32_16x16x32_bf16 a[0:3], a[160:163], v[160:163], a[0:3]
  ds_read_b128 a[128:131], v3 offset:0
  v_add_f32 v226, v226, v223
  v_cvt_pk_bf16_f32 v187, v222, v223
  v_mfma_f32_16x16x32_bf16 a[4:7], a[160:163], v[164:167], a[4:7]
  v_exp_f32 v220, v156
  v_add_f32 v227, v216, v217
  v_mfma_f32_16x16x32_bf16 a[64:67], a[160:163], v[176:179], a[64:67]
  buffer_load_dwordx4 v2, s[44:47], s26 offen offset:1024 sc1 lds
  v_exp_f32 v221, v157
  v_mfma_f32_16x16x32_bf16 a[68:71], a[160:163], v[180:183], a[68:71]
  v_exp_f32 v222, v158
  v_mfma_f32_16x16x32_bf16 a[8:11], a[164:167], v[160:163], a[8:11]
  ds_read_b128 a[132:135], v3 offset:1024
  v_cvt_pk_bf16_f32 v188, v216, v217
  v_add_f32 v227, v227, v218
  v_add_f32 v227, v227, v219
  v_mfma_f32_16x16x32_bf16 a[12:15], a[164:167], v[164:167], a[12:15]
  v_exp_f32 v223, v159
  v_mfma_f32_16x16x32_bf16 a[72:75], a[164:167], v[176:179], a[72:75]
  v_exp_f32 v208, v112
  v_mfma_f32_16x16x32_bf16 a[76:79], a[164:167], v[180:183], a[76:79]
  v_exp_f32 v209, v113
  v_mfma_f32_16x16x32_bf16 a[16:19], a[168:171], v[160:163], a[16:19]
  ds_read_b128 a[136:139], v3 offset:2048
  v_cvt_pk_bf16_f32 v189, v218, v219
  v_add_f32 v227, v227, v220
  v_add_f32 v227, v227, v221
  v_cvt_pk_bf16_f32 v190, v220, v221
  v_add_f32 v227, v227, v222
  v_mfma_f32_16x16x32_bf16 a[20:23], a[168:171], v[164:167], a[20:23]
  v_exp_f32 v210, v114
  v_mfma_f32_16x16x32_bf16 a[80:83], a[168:171], v[176:179], a[80:83]
  v_exp_f32 v211, v115
  v_mfma_f32_16x16x32_bf16 a[84:87], a[168:171], v[180:183], a[84:87]
  v_exp_f32 v212, v116
  v_mfma_f32_16x16x32_bf16 a[24:27], a[172:175], v[160:163], a[24:27]
  ds_read_b128 a[140:143], v3 offset:3072
  v_add_f32 v227, v227, v223
  v_cvt_pk_bf16_f32 v191, v222, v223
  v_add_f32 v224, v208, v209
  v_cvt_pk_bf16_f32 v168, v208, v209
  v_add_f32 v224, v224, v210
  v_mfma_f32_16x16x32_bf16 a[28:31], a[172:175], v[164:167], a[28:31]
  v_exp_f32 v213, v117
  v_mfma_f32_16x16x32_bf16 a[88:91], a[172:175], v[176:179], a[88:91]
  buffer_load_dwordx4 v2, s[44:47], s26 offen offset:2048 sc1 lds
  v_exp_f32 v214, v118
  v_mfma_f32_16x16x32_bf16 a[92:95], a[172:175], v[180:183], a[92:95]
  s_waitcnt lgkmcnt(4)
  v_exp_f32 v215, v119
  v_mfma_f32_16x16x32_bf16 a[32:35], a[176:179], v[160:163], a[32:35]
  ds_read_b128 a[144:147], v3 offset:4096
  v_add_f32 v224, v224, v211
  v_cvt_pk_bf16_f32 v169, v210, v211
  v_add_f32 v224, v224, v212
  v_add_f32 v224, v224, v213
  v_mfma_f32_16x16x32_bf16 a[36:39], a[176:179], v[164:167], a[36:39]
  v_exp_f32 v208, v120
  v_mfma_f32_16x16x32_bf16 a[96:99], a[176:179], v[176:179], a[96:99]
  v_exp_f32 v209, v121
  v_mfma_f32_16x16x32_bf16 a[100:103], a[176:179], v[180:183], a[100:103]
  v_exp_f32 v210, v122
  v_mfma_f32_16x16x32_bf16 a[40:43], a[180:183], v[160:163], a[40:43]
  ds_read_b128 a[148:151], v3 offset:5120
  v_cvt_pk_bf16_f32 v170, v212, v213
  v_add_f32 v224, v224, v214
  v_add_f32 v224, v224, v215
  v_cvt_pk_bf16_f32 v171, v214, v215
  v_add_f32 v225, v208, v209
  v_mfma_f32_16x16x32_bf16 a[44:47], a[180:183], v[164:167], a[44:47]
  v_exp_f32 v211, v123
  v_mfma_f32_16x16x32_bf16 a[104:107], a[180:183], v[176:179], a[104:107]
  v_exp_f32 v212, v124
  v_mfma_f32_16x16x32_bf16 a[108:111], a[180:183], v[180:183], a[108:111]
  v_exp_f32 v213, v125
  v_mfma_f32_16x16x32_bf16 a[48:51], a[184:187], v[160:163], a[48:51]
  ds_read_b128 a[152:155], v3 offset:6144
  v_cvt_pk_bf16_f32 v172, v208, v209
  v_add_f32 v225, v225, v210
  v_add_f32 v225, v225, v211
  v_cvt_pk_bf16_f32 v173, v210, v211
  v_max3_f32 v5, v226, v227, v224
  v_mfma_f32_16x16x32_bf16 a[52:55], a[184:187], v[164:167], a[52:55]
  v_exp_f32 v214, v126
  v_mfma_f32_16x16x32_bf16 a[112:115], a[184:187], v[176:179], a[112:115]
  buffer_load_dwordx4 v2, s[44:47], s26 offen offset:3072 sc1 lds
  v_add_f32 v225, v225, v212
  v_add_f32 v225, v225, v213
  v_cvt_pk_bf16_f32 v174, v212, v213
  v_mfma_f32_16x16x32_bf16 a[116:119], a[184:187], v[180:183], a[116:119]
  s_add_u32 s26, s26, 16384
  v_exp_f32 v215, v127
  v_mfma_f32_16x16x32_bf16 a[56:59], a[188:191], v[160:163], a[56:59]
  s_add_u32 s24, s24, 32768
  ds_read_b128 a[156:159], v3 offset:7168
  v_add_f32 v225, v225, v214
  v_add_f32 v225, v225, v215
  v_max_f32 v5, v5, v225
  v_cmp_lt_f32 vcc, s81, v5
  v_mfma_f32_16x16x32_bf16 a[60:63], a[188:191], v[164:167], a[60:63]
  s_and_b32 s24, s24, 0x1ffff
  v_exp_f32 v216, v128
  v_mfma_f32_16x16x32_bf16 a[120:123], a[188:191], v[176:179], a[120:123]
  s_waitcnt lgkmcnt(4)
  v_cvt_pk_bf16_f32 v175, v214, v215
  v_mfma_f32_16x16x32_bf16 a[124:127], a[188:191], v[180:183], a[124:127]
  s_cbranch_vccnz fa_stub8
fa_back8:
  v_exp_f32 v217, v129
  v_add_f32 v228, v228, v224
  v_add_f32 v229, v229, v225
  v_add_f32 v230, v230, v226
  v_add_f32 v231, v231, v227
  v_mfma_f32_16x16x32_bf16 v[144:147], a[128:131], v[64:67], v[200:203]
  ds_read_b128 a[160:163], v3 offset:24576
  v_add_f32 v226, v216, v217
  v_mfma_f32_16x16x32_bf16 v[152:155], a[128:131], v[68:71], v[204:207]
  v_exp_f32 v218, v130
  v_mfma_f32_16x16x32_bf16 v[148:151], a[132:135], v[64:67], v[200:203]
  s_add_u32 s66, s66, 32768
  ds_read_b128 a[164:167], v3 offset:25600
  v_cvt_pk_bf16_f32 v176, v216, v217
  v_mfma_f32_16x16x32_bf16 v[156:159], a[132:135], v[68:71], v[204:207]
  s_and_b32 s66, s66, 0x1ffff
  v_exp_f32 v219, v131
  v_mfma_f32_16x16x32_bf16 v[144:147], a[136:139], v[72:75], v[144:147]
  ds_read_b128 a[168:171], v3 offset:26624
  v_add_f32 v226, v226, v218
  v_mfma_f32_16x16x32_bf16 v[152:155], a[136:139], v[76:79], v[152:155]
  s_mov_b32 m0, s25
  v_exp_f32 v220, v132
  v_mfma_f32_16x16x32_bf16 v[148:151], a[140:143], v[72:75], v[148:151]
  ds_read_b128 a[172:175], v3 offset:27648
  buffer_load_dwordx4 v2, s[48:51], s27 offen offset:0 sc1 lds
  v_add_f32 v226, v226, v219
  v_mfma_f32_16x16x32_bf16 v[156:159], a[140:143], v[76:79], v[156:159]
  s_waitcnt lgkmcnt(4)
  v_exp_f32 v221, v133
  v_mfma_f32_16x16x32_bf16 v[144:147], a[144:147], v[80:83], v[144:147]
  ds_read_b128 a[176:179], v3 offset:28672
  v_cvt_pk_bf16_f32 v177, v218, v219
  v_mfma_f32_16x16x32_bf16 v[152:155], a[144:147], v[84:87], v[152:155]
  v_exp_f32 v222, v134
  v_mfma_f32_16x16x32_bf16 v[148:151], a[148:151], v[80:83], v[148:151]
  ds_read_b128 a[180:183], v3 offset:29696
  v_add_f32 v226, v226, v220
  v_mfma_f32_16x16x32_bf16 v[156:159], a[148:151], v[84:87], v[156:159]
  v_exp_f32 v223, v135
  v_mfma_f32_16x16x32_bf16 v[144:147], a[152:155], v[88:91], v[144:147]
  ds_read_b128 a[184:187], v3 offset:30720
  v_add_f32 v226, v226, v221
  v_mfma_f32_16x16x32_bf16 v[152:155], a[152:155], v[92:95], v[152:155]
  v_exp_f32 v216, v136
  v_mfma_f32_16x16x32_bf16 v[148:151], a[156:159], v[88:91], v[148:151]
  ds_read_b128 a[188:191], v3 offset:31744
  v_cvt_pk_bf16_f32 v178, v220, v221
  v_mfma_f32_16x16x32_bf16 v[156:159], a[156:159], v[92:95], v[156:159]
  s_waitcnt lgkmcnt(4)
  v_exp_f32 v217, v137
  v_mfma_f32_16x16x32_bf16 a[0:3], a[160:163], v[168:171], a[0:3]
  ds_read_b128 a[128:131], v3 offset:8192
  v_add_f32 v226, v226, v222
  v_mfma_f32_16x16x32_bf16 a[4:7], a[160:163], v[172:175], a[4:7]
  v_exp_f32 v218, v138
  v_mfma_f32_16x16x32_bf16 a[64:67], a[160:163], v[184:187], a[64:67]
  buffer_load_dwordx4 v2, s[48:51], s27 offen offset:1024 sc1 lds
  v_add_f32 v226, v226, v223
  v_mfma_f32_16x16x32_bf16 a[68:71], a[160:163], v[188:191], a[68:71]
  v_exp_f32 v219, v139
  v_mfma_f32_16x16x32_bf16 a[8:11], a[164:167], v[168:171], a[8:11]
  ds_read_b128 a[132:135], v3 offset:9216
  v_cvt_pk_bf16_f32 v179, v222, v223
  v_mfma_f32_16x16x32_bf16 a[12:15], a[164:167], v[172:175], a[12:15]
  v_exp_f32 v220, v140
  v_mfma_f32_16x16x32_bf16 a[72:75], a[164:167], v[184:187], a[72:75]
  v_add_f32 v227, v216, v217
  v_cvt_pk_bf16_f32 v180, v216, v217
  v_mfma_f32_16x16x32_bf16 a[76:79], a[164:167], v[188:191], a[76:79]
  v_exp_f32 v221, v141
  v_mfma_f32_16x16x32_bf16 a[16:19], a[168:171], v[168:171], a[16:19]
  ds_read_b128 a[136:139], v3 offset:10240
  v_add_f32 v227, v227, v218
  v_mfma_f32_16x16x32_bf16 a[20:23], a[168:171], v[172:175], a[20:23]
  v_exp_f32 v222, v142
  v_mfma_f32_16x16x32_bf16 a[80:83], a[168:171], v[184:187], a[80:83]
  v_add_f32 v227, v227, v219
  v_cvt_pk_bf16_f32 v181, v218, v219
  v_mfma_f32_16x16x32_bf16 a[84:87], a[168:171], v[188:191], a[84:87]
  v_exp_f32 v223, v143
  v_mfma_f32_16x16x32_bf16 a[24:27], a[172:175], v[168:171], a[24:27]
  ds_read_b128 a[140:143], v3 offset:11264
  v_add_f32 v227, v227, v220
  v_mfma_f32_16x16x32_bf16 a[28:31], a[172:175], v[172:175], a[28:31]
  v_add_f32 v227, v227, v221
  v_cvt_pk_bf16_f32 v182, v220, v221
  v_mfma_f32_16x16x32_bf16 a[88:91], a[172:175], v[184:187], a[88:91]
  buffer_load_dwordx4 v2, s[48:51], s27 offen offset:2048 sc1 lds
  v_add_f32 v227, v227, v222
  v_mfma_f32_16x16x32_bf16 a[92:95], a[172:175], v[188:191], a[92:95]
  s_waitcnt lgkmcnt(4)
  v_add_f32 v227, v227, v223
  v_max_f32 v5, v226, v227
  v_mfma_f32_16x16x32_bf16 a[32:35], a[176:179], v[168:171], a[32:35]
  ds_read_b128 a[144:147], v3 offset:12288
  v_cmp_lt_f32 vcc, s81, v5
  v_mfma_f32_16x16x32_bf16 a[36:39], a[176:179], v[172:175], a[36:39]
  v_mfma_f32_16x16x32_bf16 a[96:99], a[176:179], v[184:187], a[96:99]
  v_mfma_f32_16x16x32_bf16 a[100:103], a[176:179], v[188:191], a[100:103]
  v_mfma_f32_16x16x32_bf16 a[40:43], a[180:183], v[168:171], a[40:43]
  ds_read_b128 a[148:151], v3 offset:13312
  v_mfma_f32_16x16x32_bf16 a[44:47], a[180:183], v[172:175], a[44:47]
  v_mfma_f32_16x16x32_bf16 a[104:107], a[180:183], v[184:187], a[104:107]
  v_mfma_f32_16x16x32_bf16 a[108:111], a[180:183], v[188:191], a[108:111]
  v_mfma_f32_16x16x32_bf16 a[48:51], a[184:187], v[168:171], a[48:51]
  ds_read_b128 a[152:155], v3 offset:14336
  v_mfma_f32_16x16x32_bf16 a[52:55], a[184:187], v[172:175], a[52:55]
  v_mfma_f32_16x16x32_bf16 a[112:115], a[184:187], v[184:187], a[112:115]
  buffer_load_dwordx4 v2, s[48:51], s27 offen offset:3072 sc1 lds
  v_mfma_f32_16x16x32_bf16 a[116:119], a[184:187], v[188:191], a[116:119]
  s_add_u32 s27, s27, 16384
  v_mfma_f32_16x16x32_bf16 a[56:59], a[188:191], v[168:171], a[56:59]
  s_add_u32 s25, s25, 32768
  ds_read_b128 a[156:159], v3 offset:15360
  v_mfma_f32_16x16x32_bf16 a[60:63], a[188:191], v[172:175], a[60:63]
  s_and_b32 s25, s25, 0x1ffff
  v_exp_f32 v216, v144
  v_mfma_f32_16x16x32_bf16 a[120:123], a[188:191], v[184:187], a[120:123]
  s_waitcnt lgkmcnt(4)
  v_cvt_pk_bf16_f32 v183, v222, v223
  v_add_u32 v3, s66, v2
  v_mfma_f32_16x16x32_bf16 a[124:127], a[188:191], v[188:191], a[124:127]
  s_cbranch_vccnz fa_stub9
fa_back9:
  v_exp_f32 v217, v145
  v_add_f32 v230, v230, v226
  v_add_f32 v231, v231, v227
fa_SSpre:
  s_mov_b32 s11, 1
  s_cmp_lg_u32 s12, 0
  s_cselect_b32 s32, s15, s32
  s_cmp_ge_u32 s20, 2
  s_cselect_b32 s23, 8, 0
  s_cmp_le_u32 s29, s23
  s_cbranch_scc1 fa_chain
.p2align 6
fa_SS:
  v_mfma_f32_16x16x32_bf16 v[128:131], a[128:131], v[64:67], v[200:203]
  s_waitcnt vmcnt(12)
  v_exp_f32 v218, v146
  v_mfma_f32_16x16x32_bf16 v[136:139], a[128:131], v[68:71], v[204:207]
  s_barrier
  v_exp_f32 v219, v147
  v_mfma_f32_16x16x32_bf16 v[132:135], a[132:135], v[64:67], v[200:203]
  s_cmp_ge_u32 s26, s32
  ds_read_b128 a[160:163], v3 offset:16384
  ds_read_b128 a[164:167], v3 offset:17408
  v_add_f32 v226, v216, v217
  v_mfma_f32_16x16x32_bf16 v[140:143], a[132:135], v[68:71], v[204:207]
  s_cbranch_scc1 fa_hk7
fa_hb7:
  v_exp_f32 v220, v148
  v_mfma_f32_16x16x32_bf16 v[128:131], a[136:139], v[72:75], v[128:131]
  ds_read_b128 a[168:171], v3 offset:18432
  v_cvt_pk_bf16_f32 v184, v216, v217
  v_mfma_f32_16x16x32_bf16 v[136:139], a[136:139], v[76:79], v[136:139]
  s_mov_b32 m0, s24
  v_exp_f32 v221, v149
  v_mfma_f32_16x16x32_bf16 v[132:135], a[140:143], v[72:75], v[132:135]
  ds_read_b128 a[172:175], v3 offset:19456
  buffer_load_dwordx4 v2, s[44:47], s26 offen offset:0 sc1 lds
  v_add_f32 v226, v226, v218
  v_add_f32 v226, v226, v219
  v_mfma_f32_16x16x32_bf16 v[140:143], a[140:143], v[76:79], v[140:143]
  s_waitcnt lgkmcnt(4)
  v_exp_f32 v222, v150
  v_mfma_f32_16x16x32_bf16 v[128:131], a[144:147], v[80:83], v[128:131]
  ds_read_b128 a[176:179], v3 offset:20480
  v_cvt_pk_bf16_f32 v185, v218, v219
  v_mfma_f32_16x16x32_bf16 v[136:139], a[144:147], v[84:87], v[136:139]
  v_exp_f32 v223, v151
  v_mfma_f32_16x16x32_bf16 v[132:135], a[148:151], v[80:83], v[132:135]
  ds_read_b128 a[180:183], v3 offset:21504
  v_add_f32 v226, v226, v220
  v_mfma_f32_16x16x32_bf16 v[140:143], a[148:151], v[84:87], v[140:143]
  v_exp_f32 v216, v152
  v_mfma_f32_16x16x32_bf16 v[128:131], a[152:155], v[88:91], v[128:131]
  ds_read_b128 a[184:187], v3 offset:22528
  buffer_load_dwordx4 v2, s[44:47], s26 offen offset:1024 sc1 lds
  v_add_f32 v226, v226, v221
  v_cvt_pk_bf16_f32 v186, v220, v221
  v_mfma_f32_16x16x32_bf16 v[136:139], a[152:155], v[92:95], v[136:139]
  v_exp_f32 v217, v153
  v_mfma_f32_16x16x32_bf16 v[132:135], a[156:159], v[88:91], v[132:135]
  ds_read_b128 a[188:191], v3 offset:23552
  v_add_f32 v226, v226, v222
  v_mfma_f32_16x16x32_bf16 v[140:143], a[156:159], v[92:95], v[140:143]
  s_waitcnt lgkmcnt(4)
  v_exp_f32 v218, v154
  v_mfma_f32_16x16x32_bf16 a[64:67], a[160:163], v[176:179], a[64:67]
  ds_read_b128 a[128:131], v3 offset:0
  v_add_f32 v226, v226, v223
  v_cvt_pk_bf16_f32 v187, v222, v223
  v_mfma_f32_16x16x32_bf16 a[68:71], a[160:163], v[180:183], a[68:71]
  v_exp_f32 v219, v155
  v_mfma_f32_16x16x32_bf16 a[72:75], a[164:167], v[176:179], a[72:75]
  ds_read_b128 a[132:135], v3 offset:1024
  buffer_load_dwordx4 v2, s[44:47], s26 offen offset:2048 sc1 lds
  v_add_f32 v227, v216, v217
  v_mfma_f32_16x16x32_bf16 a[76:79], a[164:167], v[180:183], a[76:79]
  v_exp_f32 v220, v156
  v_mfma_f32_16x16x32_bf16 a[80:83], a[168:171], v[176:179], a[80:83]
  ds_read_b128 a[136:139], v3 offset:2048
  v_cvt_pk_bf16_f32 v188, v216, v217
  v_mfma_f32_16x16x32_bf16 a[84:87], a[168:171], v[180:183], a[84:87]
  v_exp_f32 v221, v157
  v_mfma_f32_16x16x32_bf16 a[88:91], a[172:175], v[176:179], a[88:91]
  ds_read_b128 a[140:143], v3 offset:3072
  v_add_f32 v227, v227, v218
  v_add_f32 v227, v227, v219
  v_mfma_f32_16x16x32_bf16 a[92:95], a[172:175], v[180:183], a[92:95]
  s_waitcnt lgkmcnt(4)
  v_exp_f32 v222, v158
  v_mfma_f32_16x16x32_bf16 a[96:99], a[176:179], v[176:179], a[96:99]
  ds_read_b128 a[144:147], v3 offset:4096
  buffer_load_dwordx4 v2, s[44:47], s26 offen offset:3072 sc1 lds
  v_cvt_pk_bf16_f32 v189, v218, v219
  v_mfma_f32_16x16x32_bf16 a[100:103], a[176:179], v[180:183], a[100:103]
  s_add_u32 s26, s26, 16384
  v_exp_f32 v223, v159
  v_mfma_f32_16x16x32_bf16 a[104:107], a[180:183], v[176:179], a[104:107]
  s_add_u32 s24, s24, 32768
  ds_read_b128 a[148:151], v3 offset:5120
  v_add_f32 v227, v227, v220
  v_mfma_f32_16x16x32_bf16 a[108:111], a[180:183], v[180:183], a[108:111]
  s_and_b32 s24, s24, 0x1ffff
  v_add_f32 v227, v227, v221
  v_cvt_pk_bf16_f32 v190, v220, v221
  v_add_f32 v227, v227, v222
  v_mfma_f32_16x16x32_bf16 a[112:115], a[184:187], v[176:179], a[112:115]
  ds_read_b128 a[152:155], v3 offset:6144
  v_add_f32 v227, v227, v223
  v_max_f32 v5, v226, v227
  v_cmp_lt_f32 vcc, s81, v5
  v_mfma_f32_16x16x32_bf16 a[116:119], a[184:187], v[180:183], a[116:119]
  v_exp_f32 v216, v128
  v_mfma_f32_16x16x32_bf16 a[120:123], a[188:191], v[176:179], a[120:123]
  s_waitcnt lgkmcnt(3)
  ds_read_b128 a[156:159], v3 offset:7168
  v_cvt_pk_bf16_f32 v191, v222, v223
  v_mfma_f32_16x16x32_bf16 a[124:127], a[188:191], v[180:183], a[124:127]
  s_cbranch_vccnz fa_stub10
fa_back10:
  v_exp_f32 v217, v129
  v_add_f32 v230, v230, v226
  v_add_f32 v231, v231, v227
  v_mfma_f32_16x16x32_bf16 v[144:147], a[128:131], v[64:67], v[200:203]
  ds_read_b128 a[160:163], v3 offset:24576
  v_add_f32 v226, v216, v217
  v_mfma_f32_16x16x32_bf16 v[152:155], a[128:131], v[68:71], v[204:207]
  v_exp_f32 v218, v130
  v_mfma_f32_16x16x32_bf16 v[148:151], a[132:135], v[64:67], v[200:203]
  s_add_u32 s66, s66, 32768
  ds_read_b128 a[164:167], v3 offset:25600
  v_cvt_pk_bf16_f32 v176, v216, v217
  v_mfma_f32_16x16x32_bf16 v[156:159], a[132:135], v[68:71], v[204:207]
  s_mov_b32 m0, s25
  v_exp_f32 v219, v131
  v_mfma_f32_16x16x32_bf16 v[144:147], a[136:139], v[72:75], v[144:147]
  s_and_b32 s66, s66, 0x1ffff
  ds_read_b128 a[168:171], v3 offset:26624
  buffer_load_dwordx4 v2, s[48:51], s27 offen offset:0 sc1 lds
  v_add_f32 v226, v226, v218
  v_add_f32 v226, v226, v219
  v_mfma_f32_16x16x32_bf16 v[152:155], a[136:139], v[76:79], v[152:155]
  v_exp_f32 v220, v132
  v_mfma_f32_16x16x32_bf16 v[148:151], a[140:143], v[72:75], v[148:151]
  ds_read_b128 a[172:175], v3 offset:27648
  v_cvt_pk_bf16_f32 v177, v218, v219
  v_mfma_f32_16x16x32_bf16 v[156:159], a[140:143], v[76:79], v[156:159]
  s_waitcnt lgkmcnt(4)
  v_exp_f32 v221, v133
  v_mfma_f32_16x16x32_bf16 v[144:147], a[144:147], v[80:83], v[144:147]
  ds_read_b128 a[176:179], v3 offset:28672
  v_add_f32 v226, v226, v220
  v_mfma_f32_16x16x32_bf16 v[152:155], a[144:147], v[84:87], v[152:155]
  v_exp_f32 v222, v134
  v_mfma_f32_16x16x32_bf16 v[148:151], a[148:151], v[80:83], v[148:151]
  ds_read_b128 a[180:183], v3 offset:29696
  buffer_load_dwordx4 v2, s[48:51], s27 offen offset:1024 sc1 lds
  v_add_f32 v226, v226, v221
  v_cvt_pk_bf16_f32 v178, v220, v221
  v_mfma_f32_16x16x32_bf16 v[156:159], a[148:151], v[84:87], v[156:159]
  v_exp_f32 v223, v135
  v_mfma_f32_16x16x32_bf16 v[144:147], a[152:155], v[88:91], v[144:147]
  ds_read_b128 a[184:187], v3 offset:30720
  v_add_f32 v226, v226, v222
  v_mfma_f32_16x16x32_bf16 v[152:155], a[152:155], v[92:95], v[152:155]
  v_exp_f32 v216, v136
  v_mfma_f32_16x16x32_bf16 v[148:151], a[156:159], v[88:91], v[148:151]
  ds_read_b128 a[188:191], v3 offset:31744
  v_add_f32 v226, v226, v223
  v_exp_f32 v217, v137
  v_mfma_f32_16x16x32_bf16 v[156:159], a[156:159], v[92:95], v[156:159]
  s_waitcnt lgkmcnt(4)
  v_exp_f32 v218, v138
  v_mfma_f32_16x16x32_bf16 a[64:67], a[160:163], v[184:187], a[64:67]
  ds_read_b128 a[128:131], v3 offset:8192
  v_cvt_pk_bf16_f32 v179, v222, v223
  v_mfma_f32_16x16x32_bf16 a[68:71], a[160:163], v[188:191], a[68:71]
  v_exp_f32 v219, v139
  v_mfma_f32_16x16x32_bf16 a[72:75], a[164:167], v[184:187], a[72:75]
  ds_read_b128 a[132:135], v3 offset:9216
  buffer_load_dwordx4 v2, s[48:51], s27 offen offset:2048 sc1 lds
  v_add_f32 v227, v216, v217
  v_mfma_f32_16x16x32_bf16 a[76:79], a[164:167], v[188:191], a[76:79]
  v_exp_f32 v220, v140
  v_mfma_f32_16x16x32_bf16 a[80:83], a[168:171], v[184:187], a[80:83]
  ds_read_b128 a[136:139], v3 offset:10240
  v_cvt_pk_bf16_f32 v180, v216, v217
  v_mfma_f32_16x16x32_bf16 a[84:87], a[168:171], v[188:191], a[84:87]
  v_exp_f32 v221, v141
  v_mfma_f32_16x16x32_bf16 a[88:91], a[172:175], v[184:187], a[88:91]
  ds_read_b128 a[140:143], v3 offset:11264
  v_add_f32 v227, v227, v218
  v_mfma_f32_16x16x32_bf16 a[92:95], a[172:175], v[188:191], a[92:95]
  s_waitcnt lgkmcnt(4)
  v_exp_f32 v222, v142
  v_mfma_f32_16x16x32_bf16 a[96:99], a[176:179], v[184:187], a[96:99]
  ds_read_b128 a[144:147], v3 offset:12288
  buffer_load_dwordx4 v2, s[48:51], s27 offen offset:3072 sc1 lds
  v_add_f32 v227, v227, v219
  v_cvt_pk_bf16_f32 v181, v218, v219
  v_mfma_f32_16x16x32_bf16 a[100:103], a[176:179], v[188:191], a[100:103]
  s_add_u32 s27, s27, 16384
  v_exp_f32 v223, v143
  v_mfma_f32_16x16x32_bf16 a[104:107], a[180:183], v[184:187], a[104:107]
  s_add_u32 s25, s25, 32768
  ds_read_b128 a[148:151], v3 offset:13312
  v_add_f32 v227, v227, v220
  v_mfma_f32_16x16x32_bf16 a[108:111], a[180:183], v[188:191], a[108:111]
  s_and_b32 s25, s25, 0x1ffff
  v_add_f32 v227, v227, v221
  v_cvt_pk_bf16_f32 v182, v220, v221
  v_add_f32 v227, v227, v222
  v_mfma_f32_16x16x32_bf16 a[112:115], a[184:187], v[184:187], a[112:115]
  s_sub_u32 s29, s29, 1
  ds_read_b128 a[152:155], v3 offset:14336
  v_add_f32 v227, v227, v223
  v_max_f32 v5, v226, v227
  v_cmp_lt_f32 vcc, s81, v5
  v_mfma_f32_16x16x32_bf16 a[116:119], a[184:187], v[188:191], a[116:119]
  s_cmp_gt_u32 s29, 8
  v_exp_f32 v216, v144
  v_mfma_f32_16x16x32_bf16 a[120:123], a[188:191], v[184:187], a[120:123]
  s_waitcnt lgkmcnt(3)
  ds_read_b128 a[156:159], v3 offset:15360
  v_cvt_pk_bf16_f32 v183, v222, v223
  v_add_u32 v3, s66, v2
  v_mfma_f32_16x16x32_bf16 a[124:127], a[188:191], v[188:191], a[124:127]
  s_cbranch_vccnz fa_stub11
fa_back11:
  v_exp_f32 v217, v145
  v_add_f32 v230, v230, v226
  v_add_f32 v231, v231, v227
  s_cbranch_scc1 fa_SS
fa_chain:
fa_hb8:
  s_cmp_lt_u32 s12, 2
  s_cbranch_scc1 fa_hk8
  s_cmp_eq_u32 s29, 8
  s_cbranch_scc0 fa_disp
fa_SSW8:
  v_mfma_f32_16x16x32_bf16 v[128:131], a[128:131], v[64:67], v[200:203]
  s_waitcnt vmcnt(12)
  v_exp_f32 v218, v146
  v_mfma_f32_16x16x32_bf16 v[136:139], a[128:131], v[68:71], v[204:207]
  s_barrier
  v_exp_f32 v219, v147
  v_mfma_f32_16x16x32_bf16 v[132:135], a[132:135], v[64:67], v[200:203]
  ds_read_b128 a[160:163], v3 offset:16384
  ds_read_b128 a[164:167], v3 offset:17408
  v_add_f32 v226, v216, v217
  v_mfma_f32_16x16x32_bf16 v[140:143], a[132:135], v[68:71], v[204:207]
  s_mov_b32 m0, s24
  v_exp_f32 v220, v148
  v_mfma_f32_16x16x32_bf16 v[128:131], a[136:139], v[72:75], v[128:131]
  ds_read_b128 a[168:171], v3 offset:18432
  buffer_load_dwordx4 v2, s[44:47], s26 offen offset:0 sc1 lds
  v_cvt_pk_bf16_f32 v184, v216, v217
  v_mfma_f32_16x16x32_bf16 v[136:139], a[136:139], v[76:79], v[136:139]
  v_exp_f32 v221, v149
  v_mfma_f32_16x16x32_bf16 v[132:135], a[140:143], v[72:75], v[132:135]
  ds_read_b128 a[172:175], v3 offset:19456
  v_add_f32 v226, v226, v218
  v_add_f32 v226, v226, v219
  v_mfma_f32_16x16x32_bf16 v[140:143], a[140:143], v[76:79], v[140:143]
  s_waitcnt lgkmcnt(4)
  v_exp_f32 v222, v150
  v_mfma_f32_16x16x32_bf16 v[128:131], a[144:147], v[80:83], v[128:131]
  s_add_u32 s14, s13, 0
  ds_read_b128 a[176:179], v3 offset:20480
  buffer_load_dwordx4 a[0:3], v2, s[40:43], s14 offen offset:0 sc1
  v_cvt_pk_bf16_f32 v185, v218, v219
  v_mfma_f32_16x16x32_bf16 v[136:139], a[144:147], v[84:87], v[136:139]
  v_exp_f32 v223, v151
  v_mfma_f32_16x16x32_bf16 v[132:135], a[148:151], v[80:83], v[132:135]
  ds_read_b128 a[180:183], v3 offset:21504
  buffer_load_dwordx4 v2, s[44:47], s26 offen offset:1024 sc1 lds
  v_add_f32 v226, v226, v220
  v_mfma_f32_16x16x32_bf16 v[140:143], a[148:151], v[84:87], v[140:143]
  v_exp_f32 v216, v152
  v_mfma_f32_16x16x32_bf16 v[128:131], a[152:155], v[88:91], v[128:131]
  ds_read_b128 a[184:187], v3 offset:22528
  v_add_f32 v226, v226, v221
  v_cvt_pk_bf16_f32 v186, v220, v221
  v_mfma_f32_16x16x32_bf16 v[136:139], a[152:155], v[92:95], v[136:139]
  v_exp_f32 v217, v153
  v_mfma_f32_16x16x32_bf16 v[132:135], a[156:159], v[88:91], v[132:135]
  ds_read_b128 a[188:191], v3 offset:23552
  buffer_load_dwordx4 a[4:7], v2, s[40:43], s14 offen offset:1024 sc1
  v_add_f32 v226, v226, v222
  v_mfma_f32_16x16x32_bf16 v[140:143], a[156:159], v[92:95], v[140:143]
  s_waitcnt lgkmcnt(4)
  v_exp_f32 v218, v154
  v_mfma_f32_16x16x32_bf16 a[64:67], a[160:163], v[176:179], a[64:67]
  ds_read_b128 a[128:131], v3 offset:0
  v_add_f32 v226, v226, v223
  v_cvt_pk_bf16_f32 v187, v222, v223
  v_mfma_f32_16x16x32_bf16 a[68:71], a[160:163], v[180:183], a[68:71]
  v_exp_f32 v219, v155
  v_mfma_f32_16x16x32_bf16 a[72:75], a[164:167], v[176:179], a[72:75]
  ds_read_b128 a[132:135], v3 offset:1024
  buffer_load_dwordx4 v2, s[44:47], s26 offen offset:2048 sc1 lds
  v_add_f32 v227, v216, v217
  v_mfma_f32_16x16x32_bf16 a[76:79], a[164:167], v[180:183], a[76:79]
  v_exp_f32 v220, v156
  v_mfma_f32_16x16x32_bf16 a[80:83], a[168:171], v[176:179], a[80:83]
  ds_read_b128 a[136:139], v3 offset:2048
  v_cvt_pk_bf16_f32 v188, v216, v217
  v_mfma_f32_16x16x32_bf16 a[84:87], a[168:171], v[180:183], a[84:87]
  v_exp_f32 v221, v157
  v_mfma_f32_16x16x32_bf16 a[88:91], a[172:175], v[176:179], a[88:91]
  ds_read_b128 a[140:143], v3 offset:3072
  buffer_load_dwordx4 a[8:11], v2, s[40:43], s14 offen offset:2048 sc1
  v_add_f32 v227, v227, v218
  v_add_f32 v227, v227, v219
  v_mfma_f32_16x16x32_bf16 a[92:95], a[172:175], v[180:183], a[92:95]
  s_waitcnt lgkmcnt(4)
  v_exp_f32 v222, v158
  v_mfma_f32_16x16x32_bf16 a[96:99], a[176:179], v[176:179], a[96:99]
  ds_read_b128 a[144:147], v3 offset:4096
  buffer_load_dwordx4 v2, s[44:47], s26 offen offset:3072 sc1 lds
  v_cvt_pk_bf16_f32 v189, v218, v219
  v_mfma_f32_16x16x32_bf16 a[100:103], a[176:179], v[180:183], a[100:103]
  s_add_u32 s26, s26, 16384
  v_exp_f32 v223, v159
  v_mfma_f32_16x16x32_bf16 a[104:107], a[180:183], v[176:179], a[104:107]
  s_add_u32 s24, s24, 32768
  ds_read_b128 a[148:151], v3 offset:5120
  v_add_f32 v227, v227, v220
  v_mfma_f32_16x16x32_bf16 a[108:111], a[180:183], v[180:183], a[108:111]
  s_and_b32 s24, s24, 0x1ffff
  v_add_f32 v227, v227, v221
  v_cvt_pk_bf16_f32 v190, v220, v221
  v_add_f32 v227, v227, v222
  v_mfma_f32_16x16x32_bf16 a[112:115], a[184:187], v[176:179], a[112:115]
  ds_read_b128 a[152:155], v3 offset:6144
  v_add_f32 v227, v227, v223
  v_max_f32 v5, v226, v227
  v_cmp_lt_f32 vcc, s81, v5
  v_mfma_f32_16x16x32_bf16 a[116:119], a[184:187], v[180:183], a[116:119]
  v_exp_f32 v216, v128
  v_mfma_f32_16x16x32_bf16 a[120:123], a[188:191], v[176:179], a[120:123]
  s_waitcnt lgkmcnt(3)
  ds_read_b128 a[156:159], v3 offset:7168
  v_cvt_pk_bf16_f32 v191, v222, v223
  v_mfma_f32_16x16x32_bf16 a[124:127], a[188:191], v[180:183], a[124:127]
  s_cbranch_vccnz fa_stub12
fa_back12:
  v_exp_f32 v217, v129
  v_add_f32 v230, v230, v226
  v_add_f32 v231, v231, v227
  v_mfma_f32_16x16x32_bf16 v[144:147], a[128:131], v[64:67], v[200:203]
  ds_read_b128 a[160:163], v3 offset:24576
  v_add_f32 v226, v216, v217
  v_mfma_f32_16x16x32_bf16 v[152:155], a[128:131], v[68:71], v[204:207]
  v_exp_f32 v218, v130
  v_mfma_f32_16x16x32_bf16 v[148:151], a[132:135], v[64:67], v[200:203]
  s_add_u32 s66, s66, 32768
  ds_read_b128 a[164:167], v3 offset:25600
  v_cvt_pk_bf16_f32 v176, v216, v217
  v_mfma_f32_16x16x32_bf16 v[156:159], a[132:135], v[68:71], v[204:207]
  s_mov_b32 m0, s25
  v_exp_f32 v219, v131
  v_mfma_f32_16x16x32_bf16 v[144:147], a[136:139], v[72:75], v[144:147]
  s_and_b32 s66, s66, 0x1ffff
  ds_read_b128 a[168:171], v3 offset:26624
  buffer_load_dwordx4 v2, s[48:51], s27 offen offset:0 sc1 lds
  v_add_f32 v226, v226, v218
  v_add_f32 v226, v226, v219
  v_mfma_f32_16x16x32_bf16 v[152:155], a[136:139], v[76:79], v[152:155]
  v_exp_f32 v220, v132
  v_mfma_f32_16x16x32_bf16 v[148:151], a[140:143], v[72:75], v[148:151]
  ds_read_b128 a[172:175], v3 offset:27648
  v_cvt_pk_bf16_f32 v177, v218, v219
  v_mfma_f32_16x16x32_bf16 v[156:159], a[140:143], v[76:79], v[156:159]
  s_waitcnt lgkmcnt(4)
  v_exp_f32 v221, v133
  v_mfma_f32_16x16x32_bf16 v[144:147], a[144:147], v[80:83], v[144:147]
  s_add_u32 s14, s13, 0
  ds_read_b128 a[176:179], v3 offset:28672
  buffer_load_dwordx4 a[12:15], v2, s[40:43], s14 offen offset:3072 sc1
  v_add_f32 v226, v226, v220
  v_mfma_f32_16x16x32_bf16 v[152:155], a[144:147], v[84:87], v[152:155]
  v_exp_f32 v222, v134
  v_mfma_f32_16x16x32_bf16 v[148:151], a[148:151], v[80:83], v[148:151]
  ds_read_b128 a[180:183], v3 offset:29696
  buffer_load_dwordx4 v2, s[48:51], s27 offen offset:1024 sc1 lds
  v_add_f32 v226, v226, v221
  v_cvt_pk_bf16_f32 v178, v220, v221
  v_mfma_f32_16x16x32_bf16 v[156:159], a[148:151], v[84:87], v[156:159]
  v_exp_f32 v223, v135
  v_mfma_f32_16x16x32_bf16 v[144:147], a[152:155], v[88:91], v[144:147]
  ds_read_b128 a[184:187], v3 offset:30720
  v_add_f32 v226, v226, v222
  v_mfma_f32_16x16x32_bf16 v[152:155], a[152:155], v[92:95], v[152:155]
  v_exp_f32 v216, v136
  v_mfma_f32_16x16x32_bf16 v[148:151], a[156:159], v[88:91], v[148:151]
  s_add_u32 s14, s13, 4096
  ds_read_b128 a[188:191], v3 offset:31744
  buffer_load_dwordx4 a[16:19], v2, s[40:43], s14 offen offset:0 sc1
  v_add_f32 v226, v226, v223
  v_exp_f32 v217, v137
  v_mfma_f32_16x16x32_bf16 v[156:159], a[156:159], v[92:95], v[156:159]
  s_waitcnt lgkmcnt(4)
  v_exp_f32 v218, v138
  v_mfma_f32_16x16x32_bf16 a[64:67], a[160:163], v[184:187], a[64:67]
  ds_read_b128 a[128:131], v3 offset:8192
  v_cvt_pk_bf16_f32 v179, v222, v223
  v_mfma_f32_16x16x32_bf16 a[68:71], a[160:163], v[188:191], a[68:71]
  v_exp_f32 v219, v139
  v_mfma_f32_16x16x32_bf16 a[72:75], a[164:167], v[184:187], a[72:75]
  ds_read_b128 a[132:135], v3 offset:9216
  buffer_load_dwordx4 v2, s[48:51], s27 offen offset:2048 sc1 lds
  v_add_f32 v227, v216, v217
  v_mfma_f32_16x16x32_bf16 a[76:79], a[164:167], v[188:191], a[76:79]
  v_exp_f32 v220, v140
  v_mfma_f32_16x16x32_bf16 a[80:83], a[168:171], v[184:187], a[80:83]
  ds_read_b128 a[136:139], v3 offset:10240
  v_cvt_pk_bf16_f32 v180, v216, v217
  v_mfma_f32_16x16x32_bf16 a[84:87], a[168:171], v[188:191], a[84:87]
  v_exp_f32 v221, v141
  v_mfma_f32_16x16x32_bf16 a[88:91], a[172:175], v[184:187], a[88:91]
  ds_read_b128 a[140:143], v3 offset:11264
  buffer_load_dwordx4 a[20:23], v2, s[40:43], s14 offen offset:1024 sc1
  v_add_f32 v227, v227, v218
  v_mfma_f32_16x16x32_bf16 a[92:95], a[172:175], v[188:191], a[92:95]
  s_waitcnt lgkmcnt(4)
  v_exp_f32 v222, v142
  v_mfma_f32_16x16x32_bf16 a[96:99], a[176:179], v[184:187], a[96:99]
  ds_read_b128 a[144:147], v3 offset:12288
  buffer_load_dwordx4 v2, s[48:51], s27 offen offset:3072 sc1 lds
  v_add_f32 v227, v227, v219
  v_cvt_pk_bf16_f32 v181, v218, v219
  v_mfma_f32_16x16x32_bf16 a[100:103], a[176:179], v[188:191], a[100:103]
  s_add_u32 s27, s27, 16384
  v_exp_f32 v223, v143
  v_mfma_f32_16x16x32_bf16 a[104:107], a[180:183], v[184:187], a[104:107]
  s_add_u32 s25, s25, 32768
  ds_read_b128 a[148:151], v3 offset:13312
  v_add_f32 v227, v227, v220
  v_mfma_f32_16x16x32_bf16 a[108:111], a[180:183], v[188:191], a[108:111]
  s_and_b32 s25, s25, 0x1ffff
  v_add_f32 v227, v227, v221
  v_cvt_pk_bf16_f32 v182, v220, v221
  v_add_f32 v227, v227, v222
  v_mfma_f32_16x16x32_bf16 a[112:115], a[184:187], v[184:187], a[112:115]
  ds_read_b128 a[152:155], v3 offset:14336
  v_add_f32 v227, v227, v223
  v_max_f32 v5, v226, v227
  v_cmp_lt_f32 vcc, s81, v5
  v_mfma_f32_16x16x32_bf16 a[116:119], a[184:187], v[188:191], a[116:119]
  v_exp_f32 v216, v144
  v_mfma_f32_16x16x32_bf16 a[120:123], a[188:191], v[184:187], a[120:123]
  s_waitcnt lgkmcnt(3)
  ds_read_b128 a[156:159], v3 offset:15360
  v_cvt_pk_bf16_f32 v183, v222, v223
  v_add_u32 v3, s66, v2
  v_mfma_f32_16x16x32_bf16 a[124:127], a[188:191], v[188:191], a[124:127]
  s_cbranch_vccnz fa_stub13
fa_back13:
  v_exp_f32 v217, v145
  v_add_f32 v230, v230, v226
  v_add_f32 v231, v231, v227
fa_SSW7:
  v_mfma_f32_16x16x32_bf16 v[128:131], a[128:131], v[64:67], v[200:203]
  s_waitcnt vmcnt(12)
  v_exp_f32 v218, v146
  v_mfma_f32_16x16x32_bf16 v[136:139], a[128:131], v[68:71], v[204:207]
  s_barrier
  v_exp_f32 v219, v147
  v_mfma_f32_16x16x32_bf16 v[132:135], a[132:135], v[64:67], v[200:203]
  ds_read_b128 a[160:163], v3 offset:16384
  ds_read_b128 a[164:167], v3 offset:17408
  v_add_f32 v226, v216, v217
  v_mfma_f32_16x16x32_bf16 v[140:143], a[132:135], v[68:71], v[204:207]
  s_mov_b32 m0, s24
  v_exp_f32 v220, v148
  v_mfma_f32_16x16x32_bf16 v[128:131], a[136:139], v[72:75], v[128:131]
  ds_read_b128 a[168:171], v3 offset:18432
  buffer_load_dwordx4 v2, s[44:47], s26 offen offset:0 sc1 lds
  v_cvt_pk_bf16_f32 v184, v216, v217
  v_mfma_f32_16x16x32_bf16 v[136:139], a[136:139], v[76:79], v[136:139]
  v_exp_f32 v221, v149
  v_mfma_f32_16x16x32_bf16 v[132:135], a[140:143], v[72:75], v[132:135]
  ds_read_b128 a[172:175], v3 offset:19456
  v_add_f32 v226, v226, v218
  v_add_f32 v226, v226, v219
  v_mfma_f32_16x16x32_bf16 v[140:143], a[140:143], v[76:79], v[140:143]
  s_waitcnt lgkmcnt(4)
  v_exp_f32 v222, v150
  v_mfma_f32_16x16x32_bf16 v[128:131], a[144:147], v[80:83], v[128:131]
  s_add_u32 s14, s13, 4096
  ds_read_b128 a[176:179], v3 offset:20480
  buffer_load_dwordx4 a[24:27], v2, s[40:43], s14 offen offset:2048 sc1
  v_cvt_pk_bf16_f32 v185, v218, v219
  v_mfma_f32_16x16x32_bf16 v[136:139], a[144:147], v[84:87], v[136:139]
  v_exp_f32 v223, v151
  v_mfma_f32_16x16x32_bf16 v[132:135], a[148:151], v[80:83], v[132:135]
  ds_read_b128 a[180:183], v3 offset:21504
  buffer_load_dwordx4 v2, s[44:47], s26 offen offset:1024 sc1 lds
  v_add_f32 v226, v226, v220
  v_mfma_f32_16x16x32_bf16 v[140:143], a[148:151], v[84:87], v[140:143]
  v_exp_f32 v216, v152
  v_mfma_f32_16x16x32_bf16 v[128:131], a[152:155], v[88:91], v[128:131]
  ds_read_b128 a[184:187], v3 offset:22528
  v_add_f32 v226, v226, v221
  v_cvt_pk_bf16_f32 v186, v220, v221
  v_mfma_f32_16x16x32_bf16 v[136:139], a[152:155], v[92:95], v[136:139]
  v_exp_f32 v217, v153
  v_mfma_f32_16x16x32_bf16 v[132:135], a[156:159], v[88:91], v[132:135]
  ds_read_b128 a[188:191], v3 offset:23552
  buffer_load_dwordx4 a[28:31], v2, s[40:43], s14 offen offset:3072 sc1
  v_add_f32 v226, v226, v222
  v_mfma_f32_16x16x32_bf16 v[140:143], a[156:159], v[92:95], v[140:143]
  s_waitcnt lgkmcnt(4)
  v_exp_f32 v218, v154
  v_mfma_f32_16x16x32_bf16 a[64:67], a[160:163], v[176:179], a[64:67]
  ds_read_b128 a[128:131], v3 offset:0
  v_add_f32 v226, v226, v223
  v_cvt_pk_bf16_f32 v187, v222, v223
  v_mfma_f32_16x16x32_bf16 a[68:71], a[160:163], v[180:183], a[68:71]
  v_exp_f32 v219, v155
  v_mfma_f32_16x16x32_bf16 a[72:75], a[164:167], v[176:179], a[72:75]
  ds_read_b128 a[132:135], v3 offset:1024
  buffer_load_dwordx4 v2, s[44:47], s26 offen offset:2048 sc1 lds
  v_add_f32 v227, v216, v217
  v_mfma_f32_16x16x32_bf16 a[76:79], a[164:167], v[180:183], a[76:79]
  v_exp_f32 v220, v156
  v_mfma_f32_16x16x32_bf16 a[80:83], a[168:171], v[176:179], a[80:83]
  ds_read_b128 a[136:139], v3 offset:2048
  v_cvt_pk_bf16_f32 v188, v216, v217
  v_mfma_f32_16x16x32_bf16 a[84:87], a[168:171], v[180:183], a[84:87]
  v_exp_f32 v221, v157
  v_mfma_f32_16x16x32_bf16 a[88:91], a[172:175], v[176:179], a[88:91]
  s_add_u32 s14, s13, 8192
  ds_read_b128 a[140:143], v3 offset:3072
  buffer_load_dwordx4 a[32:35], v2, s[40:43], s14 offen offset:0 sc1
  v_add_f32 v227, v227, v218
  v_add_f32 v227, v227, v219
  v_mfma_f32_16x16x32_bf16 a[92:95], a[172:175], v[180:183], a[92:95]
  s_waitcnt lgkmcnt(4)
  v_exp_f32 v222, v158
  v_mfma_f32_16x16x32_bf16 a[96:99], a[176:179], v[176:179], a[96:99]
  ds_read_b128 a[144:147], v3 offset:4096
  buffer_load_dwordx4 v2, s[44:47], s26 offen offset:3072 sc1 lds
  v_cvt_pk_bf16_f32 v189, v218, v219
  v_mfma_f32_16x16x32_bf16 a[100:103], a[176:179], v[180:183], a[100:103]
  s_add_u32 s26, s26, 16384
  v_exp_f32 v223, v159
  v_mfma_f32_16x16x32_bf16 a[104:107], a[180:183], v[176:179], a[104:107]
  s_add_u32 s24, s24, 32768
  ds_read_b128 a[148:151], v3 offset:5120
  v_add_f32 v227, v227, v220
  v_mfma_f32_16x16x32_bf16 a[108:111], a[180:183], v[180:183], a[108:111]
  s_and_b32 s24, s24, 0x1ffff
  v_add_f32 v227, v227, v221
  v_cvt_pk_bf16_f32 v190, v220, v221
  v_add_f32 v227, v227, v222
  v_mfma_f32_16x16x32_bf16 a[112:115], a[184:187], v[176:179], a[112:115]
  ds_read_b128 a[152:155], v3 offset:6144
  v_add_f32 v227, v227, v223
  v_max_f32 v5, v226, v227
  v_cmp_lt_f32 vcc, s81, v5
  v_mfma_f32_16x16x32_bf16 a[116:119], a[184:187], v[180:183], a[116:119]
  v_exp_f32 v216, v128
  v_mfma_f32_16x16x32_bf16 a[120:123], a[188:191], v[176:179], a[120:123]
  s_waitcnt lgkmcnt(3)
  ds_read_b128 a[156:159], v3 offset:7168
  v_cvt_pk_bf16_f32 v191, v222, v223
  v_mfma_f32_16x16x32_bf16 a[124:127], a[188:191], v[180:183], a[124:127]
  s_cbranch_vccnz fa_stub14
fa_back14:
  v_exp_f32 v217, v129
  v_add_f32 v230, v230, v226
  v_add_f32 v231, v231, v227
  v_mfma_f32_16x16x32_bf16 v[144:147], a[128:131], v[64:67], v[200:203]
  ds_read_b128 a[160:163], v3 offset:24576
  v_add_f32 v226, v216, v217
  v_mfma_f32_16x16x32_bf16 v[152:155], a[128:131], v[68:71], v[204:207]
  v_exp_f32 v218, v130
  v_mfma_f32_16x16x32_bf16 v[148:151], a[132:135], v[64:67], v[200:203]
  s_add_u32 s66, s66, 32768
  ds_read_b128 a[164:167], v3 offset:25600
  v_cvt_pk_bf16_f32 v176, v216, v217
  v_mfma_f32_16x16x32_bf16 v[156:159], a[132:135], v[68:71], v[204:207]
  s_mov_b32 m0, s25
  v_exp_f32 v219, v131
  v_mfma_f32_16x16x32_bf16 v[144:147], a[136:139], v[72:75], v[144:147]
  s_and_b32 s66, s66, 0x1ffff
  ds_read_b128 a[168:171], v3 offset:26624
  buffer_load_dwordx4 v2, s[48:51], s27 offen offset:0 sc1 lds
  v_add_f32 v226, v226, v218
  v_add_f32 v226, v226, v219
  v_mfma_f32_16x16x32_bf16 v[152:155], a[136:139], v[76:79], v[152:155]
  v_exp_f32 v220, v132
  v_mfma_f32_16x16x32_bf16 v[148:151], a[140:143], v[72:75], v[148:151]
  ds_read_b128 a[172:175], v3 offset:27648
  v_cvt_pk_bf16_f32 v177, v218, v219
  v_mfma_f32_16x16x32_bf16 v[156:159], a[140:143], v[76:79], v[156:159]
  s_waitcnt lgkmcnt(4)
  v_exp_f32 v221, v133
  v_mfma_f32_16x16x32_bf16 v[144:147], a[144:147], v[80:83], v[144:147]
  s_add_u32 s14, s13, 8192
  ds_read_b128 a[176:179], v3 offset:28672
  buffer_load_dwordx4 a[36:39], v2, s[40:43], s14 offen offset:1024 sc1
  v_add_f32 v226, v226, v220
  v_mfma_f32_16x16x32_bf16 v[152:155], a[144:147], v[84:87], v[152:155]
  v_exp_f32 v222, v134
  v_mfma_f32_16x16x32_bf16 v[148:151], a[148:151], v[80:83], v[148:151]
  ds_read_b128 a[180:183], v3 offset:29696
  buffer_load_dwordx4 v2, s[48:51], s27 offen offset:1024 sc1 lds
  v_add_f32 v226, v226, v221
  v_cvt_pk_bf16_f32 v178, v220, v221
  v_mfma_f32_16x16x32_bf16 v[156:159], a[148:151], v[84:87], v[156:159]
  v_exp_f32 v223, v135
  v_mfma_f32_16x16x32_bf16 v[144:147], a[152:155], v[88:91], v[144:147]
  ds_read_b128 a[184:187], v3 offset:30720
  v_add_f32 v226, v226, v222
  v_mfma_f32_16x16x32_bf16 v[152:155], a[152:155], v[92:95], v[152:155]
  v_exp_f32 v216, v136
  v_mfma_f32_16x16x32_bf16 v[148:151], a[156:159], v[88:91], v[148:151]
  ds_read_b128 a[188:191], v3 offset:31744
  buffer_load_dwordx4 a[40:43], v2, s[40:43], s14 offen offset:2048 sc1
  v_add_f32 v226, v226, v223
  v_exp_f32 v217, v137
  v_mfma_f32_16x16x32_bf16 v[156:159], a[156:159], v[92:95], v[156:159]
  s_waitcnt lgkmcnt(4)
  v_exp_f32 v218, v138
  v_mfma_f32_16x16x32_bf16 a[64:67], a[160:163], v[184:187], a[64:67]
  ds_read_b128 a[128:131], v3 offset:8192
  v_cvt_pk_bf16_f32 v179, v222, v223
  v_mfma_f32_16x16x32_bf16 a[68:71], a[160:163], v[188:191], a[68:71]
  v_exp_f32 v219, v139
  v_mfma_f32_16x16x32_bf16 a[72:75], a[164:167], v[184:187], a[72:75]
  ds_read_b128 a[132:135], v3 offset:9216
  buffer_load_dwordx4 v2, s[48:51], s27 offen offset:2048 sc1 lds
  v_add_f32 v227, v216, v217
  v_mfma_f32_16x16x32_bf16 a[76:79], a[164:167], v[188:191], a[76:79]
  v_exp_f32 v220, v140
  v_mfma_f32_16x16x32_bf16 a[80:83], a[168:171], v[184:187], a[80:83]
  ds_read_b128 a[136:139], v3 offset:10240
  v_cvt_pk_bf16_f32 v180, v216, v217
  v_mfma_f32_16x16x32_bf16 a[84:87], a[168:171], v[188:191], a[84:87]
  v_exp_f32 v221, v141
  v_mfma_f32_16x16x32_bf16 a[88:91], a[172:175], v[184:187], a[88:91]
  ds_read_b128 a[140:143], v3 offset:11264
  buffer_load_dwordx4 a[44:47], v2, s[40:43], s14 offen offset:3072 sc1
  v_add_f32 v227, v227, v218
  v_mfma_f32_16x16x32_bf16 a[92:95], a[172:175], v[188:191], a[92:95]
  s_waitcnt lgkmcnt(4)
  v_exp_f32 v222, v142
  v_mfma_f32_16x16x32_bf16 a[96:99], a[176:179], v[184:187], a[96:99]
  ds_read_b128 a[144:147], v3 offset:12288
  buffer_load_dwordx4 v2, s[48:51], s27 offen offset:3072 sc1 lds
  v_add_f32 v227, v227, v219
  v_cvt_pk_bf16_f32 v181, v218, v219
  v_mfma_f32_16x16x32_bf16 a[100:103], a[176:179], v[188:191], a[100:103]
  s_add_u32 s27, s27, 16384
  v_exp_f32 v223, v143
  v_mfma_f32_16x16x32_bf16 a[104:107], a[180:183], v[184:187], a[104:107]
  s_add_u32 s25, s25, 32768
  ds_read_b128 a[148:151], v3 offset:13312
  v_add_f32 v227, v227, v220
  v_mfma_f32_16x16x32_bf16 a[108:111], a[180:183], v[188:191], a[108:111]
  s_and_b32 s25, s25, 0x1ffff
  v_add_f32 v227, v227, v221
  v_cvt_pk_bf16_f32 v182, v220, v221
  v_add_f32 v227, v227, v222
  v_mfma_f32_16x16x32_bf16 a[112:115], a[184:187], v[184:187], a[112:115]
  ds_read_b128 a[152:155], v3 offset:14336
  v_add_f32 v227, v227, v223
  v_max_f32 v5, v226, v227
  v_cmp_lt_f32 vcc, s81, v5
  v_mfma_f32_16x16x32_bf16 a[116:119], a[184:187], v[188:191], a[116:119]
  v_exp_f32 v216, v144
  v_mfma_f32_16x16x32_bf16 a[120:123], a[188:191], v[184:187], a[120:123]
  s_waitcnt lgkmcnt(3)
  ds_read_b128 a[156:159], v3 offset:15360
  v_cvt_pk_bf16_f32 v183, v222, v223
  v_add_u32 v3, s66, v2
  v_mfma_f32_16x16x32_bf16 a[124:127], a[188:191], v[188:191], a[124:127]
  s_cbranch_vccnz fa_stub15
fa_back15:
  v_exp_f32 v217, v145
  v_add_f32 v230, v230, v226
  v_add_f32 v231, v231, v227
fa_SSW6:
  v_mfma_f32_16x16x32_bf16 v[128:131], a[128:131], v[64:67], v[200:203]
  s_waitcnt vmcnt(12)
  v_exp_f32 v218, v146
  v_mfma_f32_16x16x32_bf16 v[136:139], a[128:131], v[68:71], v[204:207]
  s_barrier
  v_exp_f32 v219, v147
  v_mfma_f32_16x16x32_bf16 v[132:135], a[132:135], v[64:67], v[200:203]
  ds_read_b128 a[160:163], v3 offset:16384
  ds_read_b128 a[164:167], v3 offset:17408
  v_add_f32 v226, v216, v217
  v_mfma_f32_16x16x32_bf16 v[140:143], a[132:135], v[68:71], v[204:207]
  s_mov_b32 m0, s24
  v_exp_f32 v220, v148
  v_mfma_f32_16x16x32_bf16 v[128:131], a[136:139], v[72:75], v[128:131]
  ds_read_b128 a[168:171], v3 offset:18432
  buffer_load_dwordx4 v2, s[44:47], s26 offen offset:0 sc1 lds
  v_cvt_pk_bf16_f32 v184, v216, v217
  v_mfma_f32_16x16x32_bf16 v[136:139], a[136:139], v[76:79], v[136:139]
  v_exp_f32 v221, v149
  v_mfma_f32_16x16x32_bf16 v[132:135], a[140:143], v[72:75], v[132:135]
  ds_read_b128 a[172:175], v3 offset:19456
  v_add_f32 v226, v226, v218
  v_add_f32 v226, v226, v219
  v_mfma_f32_16x16x32_bf16 v[140:143], a[140:143], v[76:79], v[140:143]
  s_waitcnt lgkmcnt(4)
  v_exp_f32 v222, v150
  v_mfma_f32_16x16x32_bf16 v[128:131], a[144:147], v[80:83], v[128:131]
  s_add_u32 s14, s13, 12288
  ds_read_b128 a[176:179], v3 offset:20480
  buffer_load_dwordx4 a[48:51], v2, s[40:43], s14 offen offset:0 sc1
  v_cvt_pk_bf16_f32 v185, v218, v219
  v_mfma_f32_16x16x32_bf16 v[136:139], a[144:147], v[84:87], v[136:139]
  v_exp_f32 v223, v151
  v_mfma_f32_16x16x32_bf16 v[132:135], a[148:151], v[80:83], v[132:135]
  ds_read_b128 a[180:183], v3 offset:21504
  buffer_load_dwordx4 v2, s[44:47], s26 offen offset:1024 sc1 lds
  v_add_f32 v226, v226, v220
  v_mfma_f32_16x16x32_bf16 v[140:143], a[148:151], v[84:87], v[140:143]
  v_exp_f32 v216, v152
  v_mfma_f32_16x16x32_bf16 v[128:131], a[152:155], v[88:91], v[128:131]
  ds_read_b128 a[184:187], v3 offset:22528
  v_add_f32 v226, v226, v221
  v_cvt_pk_bf16_f32 v186, v220, v221
  v_mfma_f32_16x16x32_bf16 v[136:139], a[152:155], v[92:95], v[136:139]
  v_exp_f32 v217, v153
  v_mfma_f32_16x16x32_bf16 v[132:135], a[156:159], v[88:91], v[132:135]
  ds_read_b128 a[188:191], v3 offset:23552
  buffer_load_dwordx4 a[52:55], v2, s[40:43], s14 offen offset:1024 sc1
  v_add_f32 v226, v226, v222
  v_mfma_f32_16x16x32_bf16 v[140:143], a[156:159], v[92:95], v[140:143]
  s_waitcnt lgkmcnt(4)
  v_exp_f32 v218, v154
  v_mfma_f32_16x16x32_bf16 a[64:67], a[160:163], v[176:179], a[64:67]
  ds_read_b128 a[128:131], v3 offset:0
  v_add_f32 v226, v226, v223
  v_cvt_pk_bf16_f32 v187, v222, v223
  v_mfma_f32_16x16x32_bf16 a[68:71], a[160:163], v[180:183], a[68:71]
  v_exp_f32 v219, v155
  v_mfma_f32_16x16x32_bf16 a[72:75], a[164:167], v[176:179], a[72:75]
  ds_read_b128 a[132:135], v3 offset:1024
  buffer_load_dwordx4 v2, s[44:47], s26 offen offset:2048 sc1 lds
  v_add_f32 v227, v216, v217
  v_mfma_f32_16x16x32_bf16 a[76:79], a[164:167], v[180:183], a[76:79]
  v_exp_f32 v220, v156
  v_mfma_f32_16x16x32_bf16 a[80:83], a[168:171], v[176:179], a[80:83]
  ds_read_b128 a[136:139], v3 offset:2048
  v_cvt_pk_bf16_f32 v188, v216, v217
  v_mfma_f32_16x16x32_bf16 a[84:87], a[168:171], v[180:183], a[84:87]
  v_exp_f32 v221, v157
  v_mfma_f32_16x16x32_bf16 a[88:91], a[172:175], v[176:179], a[88:91]
  ds_read_b128 a[140:143], v3 offset:3072
  buffer_load_dwordx4 a[56:59], v2, s[40:43], s14 offen offset:2048 sc1
  v_add_f32 v227, v227, v218
  v_add_f32 v227, v227, v219
  v_mfma_f32_16x16x32_bf16 a[92:95], a[172:175], v[180:183], a[92:95]
  s_waitcnt lgkmcnt(4)
  v_exp_f32 v222, v158
  v_mfma_f32_16x16x32_bf16 a[96:99], a[176:179], v[176:179], a[96:99]
  ds_read_b128 a[144:147], v3 offset:4096
  buffer_load_dwordx4 v2, s[44:47], s26 offen offset:3072 sc1 lds
  v_cvt_pk_bf16_f32 v189, v218, v219
  v_mfma_f32_16x16x32_bf16 a[100:103], a[176:179], v[180:183], a[100:103]
  s_add_u32 s26, s26, 16384
  v_exp_f32 v223, v159
  v_mfma_f32_16x16x32_bf16 a[104:107], a[180:183], v[176:179], a[104:107]
  s_add_u32 s24, s24, 32768
  ds_read_b128 a[148:151], v3 offset:5120
  v_add_f32 v227, v227, v220
  v_mfma_f32_16x16x32_bf16 a[108:111], a[180:183], v[180:183], a[108:111]
  s_and_b32 s24, s24, 0x1ffff
  v_add_f32 v227, v227, v221
  v_cvt_pk_bf16_f32 v190, v220, v221
  v_add_f32 v227, v227, v222
  v_mfma_f32_16x16x32_bf16 a[112:115], a[184:187], v[176:179], a[112:115]
  ds_read_b128 a[152:155], v3 offset:6144
  v_add_f32 v227, v227, v223
  v_max_f32 v5, v226, v227
  v_cmp_lt_f32 vcc, s81, v5
  v_mfma_f32_16x16x32_bf16 a[116:119], a[184:187], v[180:183], a[116:119]
  v_exp_f32 v216, v128
  v_mfma_f32_16x16x32_bf16 a[120:123], a[188:191], v[176:179], a[120:123]
  s_waitcnt lgkmcnt(3)
  ds_read_b128 a[156:159], v3 offset:7168
  v_cvt_pk_bf16_f32 v191, v222, v223
  v_mfma_f32_16x16x32_bf16 a[124:127], a[188:191], v[180:183], a[124:127]
  s_cbranch_vccnz fa_stub16
fa_back16:
  v_exp_f32 v217, v129
  v_add_f32 v230, v230, v226
  v_add_f32 v231, v231, v227
  v_mfma_f32_16x16x32_bf16 v[144:147], a[128:131], v[64:67], v[200:203]
  ds_read_b128 a[160:163], v3 offset:24576
  v_add_f32 v226, v216, v217
  v_mfma_f32_16x16x32_bf16 v[152:155], a[128:131], v[68:71], v[204:207]
  v_exp_f32 v218, v130
  v_mfma_f32_16x16x32_bf16 v[148:151], a[132:135], v[64:67], v[200:203]
  s_add_u32 s66, s66, 32768
  ds_read_b128 a[164:167], v3 offset:25600
  v_cvt_pk_bf16_f32 v176, v216, v217
  v_mfma_f32_16x16x32_bf16 v[156:159], a[132:135], v[68:71], v[204:207]
  s_mov_b32 m0, s25
  v_exp_f32 v219, v131
  v_mfma_f32_16x16x32_bf16 v[144:147], a[136:139], v[72:75], v[144:147]
  s_and_b32 s66, s66, 0x1ffff
  ds_read_b128 a[168:171], v3 offset:26624
  buffer_load_dwordx4 v2, s[48:51], s27 offen offset:0 sc1 lds
  v_add_f32 v226, v226, v218
  v_add_f32 v226, v226, v219
  v_mfma_f32_16x16x32_bf16 v[152:155], a[136:139], v[76:79], v[152:155]
  v_exp_f32 v220, v132
  v_mfma_f32_16x16x32_bf16 v[148:151], a[140:143], v[72:75], v[148:151]
  ds_read_b128 a[172:175], v3 offset:27648
  v_cvt_pk_bf16_f32 v177, v218, v219
  v_mfma_f32_16x16x32_bf16 v[156:159], a[140:143], v[76:79], v[156:159]
  s_waitcnt lgkmcnt(4)
  v_exp_f32 v221, v133
  v_mfma_f32_16x16x32_bf16 v[144:147], a[144:147], v[80:83], v[144:147]
  s_add_u32 s14, s13, 12288
  ds_read_b128 a[176:179], v3 offset:28672
  buffer_load_dwordx4 a[60:63], v2, s[40:43], s14 offen offset:3072 sc1
  v_add_f32 v226, v226, v220
  v_mfma_f32_16x16x32_bf16 v[152:155], a[144:147], v[84:87], v[152:155]
  v_exp_f32 v222, v134
  v_mfma_f32_16x16x32_bf16 v[148:151], a[148:151], v[80:83], v[148:151]
  ds_read_b128 a[180:183], v3 offset:29696
  buffer_load_dwordx4 v2, s[48:51], s27 offen offset:1024 sc1 lds
  v_add_f32 v226, v226, v221
  v_cvt_pk_bf16_f32 v178, v220, v221
  v_mfma_f32_16x16x32_bf16 v[156:159], a[148:151], v[84:87], v[156:159]
  v_exp_f32 v223, v135
  v_mfma_f32_16x16x32_bf16 v[144:147], a[152:155], v[88:91], v[144:147]
  ds_read_b128 a[184:187], v3 offset:30720
  v_add_f32 v226, v226, v222
  v_mfma_f32_16x16x32_bf16 v[152:155], a[152:155], v[92:95], v[152:155]
  v_exp_f32 v216, v136
  v_mfma_f32_16x16x32_bf16 v[148:151], a[156:159], v[88:91], v[148:151]
  s_add_u32 s14, s13, 16384
  ds_read_b128 a[188:191], v3 offset:31744
  buffer_load_dwordx4 a[192:195], v2, s[40:43], s14 offen offset:0 sc1
  v_add_f32 v226, v226, v223
  v_exp_f32 v217, v137
  v_mfma_f32_16x16x32_bf16 v[156:159], a[156:159], v[92:95], v[156:159]
  s_waitcnt lgkmcnt(4)
  v_exp_f32 v218, v138
  v_mfma_f32_16x16x32_bf16 a[64:67], a[160:163], v[184:187], a[64:67]
  ds_read_b128 a[128:131], v3 offset:8192
  v_cvt_pk_bf16_f32 v179, v222, v223
  v_mfma_f32_16x16x32_bf16 a[68:71], a[160:163], v[188:191], a[68:71]
  v_exp_f32 v219, v139
  v_mfma_f32_16x16x32_bf16 a[72:75], a[164:167], v[184:187], a[72:75]
  ds_read_b128 a[132:135], v3 offset:9216
  buffer_load_dwordx4 v2, s[48:51], s27 offen offset:2048 sc1 lds
  v_add_f32 v227, v216, v217
  v_mfma_f32_16x16x32_bf16 a[76:79], a[164:167], v[188:191], a[76:79]
  v_exp_f32 v220, v140
  v_mfma_f32_16x16x32_bf16 a[80:83], a[168:171], v[184:187], a[80:83]
  ds_read_b128 a[136:139], v3 offset:10240
  v_cvt_pk_bf16_f32 v180, v216, v217
  v_mfma_f32_16x16x32_bf16 a[84:87], a[168:171], v[188:191], a[84:87]
  v_exp_f32 v221, v141
  v_mfma_f32_16x16x32_bf16 a[88:91], a[172:175], v[184:187], a[88:91]
  ds_read_b128 a[140:143], v3 offset:11264
  buffer_load_dwordx4 a[196:199], v2, s[40:43], s14 offen offset:1024 sc1
  v_add_f32 v227, v227, v218
  v_mfma_f32_16x16x32_bf16 a[92:95], a[172:175], v[188:191], a[92:95]
  s_waitcnt lgkmcnt(4)
  v_exp_f32 v222, v142
  v_mfma_f32_16x16x32_bf16 a[96:99], a[176:179], v[184:187], a[96:99]
  ds_read_b128 a[144:147], v3 offset:12288
  buffer_load_dwordx4 v2, s[48:51], s27 offen offset:3072 sc1 lds
  v_add_f32 v227, v227, v219
  v_cvt_pk_bf16_f32 v181, v218, v219
  v_mfma_f32_16x16x32_bf16 a[100:103], a[176:179], v[188:191], a[100:103]
  s_add_u32 s27, s27, 16384
  v_exp_f32 v223, v143
  v_mfma_f32_16x16x32_bf16 a[104:107], a[180:183], v[184:187], a[104:107]
  s_add_u32 s25, s25, 32768
  ds_read_b128 a[148:151], v3 offset:13312
  v_add_f32 v227, v227, v220
  v_mfma_f32_16x16x32_bf16 a[108:111], a[180:183], v[188:191], a[108:111]
  s_and_b32 s25, s25, 0x1ffff
  v_add_f32 v227, v227, v221
  v_cvt_pk_bf16_f32 v182, v220, v221
  v_add_f32 v227, v227, v222
  v_mfma_f32_16x16x32_bf16 a[112:115], a[184:187], v[184:187], a[112:115]
  ds_read_b128 a[152:155], v3 offset:14336
  v_add_f32 v227, v227, v223
  v_max_f32 v5, v226, v227
  v_cmp_lt_f32 vcc, s81, v5
  v_mfma_f32_16x16x32_bf16 a[116:119], a[184:187], v[188:191], a[116:119]
  v_exp_f32 v216, v144
  v_mfma_f32_16x16x32_bf16 a[120:123], a[188:191], v[184:187], a[120:123]
  s_waitcnt lgkmcnt(3)
  ds_read_b128 a[156:159], v3 offset:15360
  v_cvt_pk_bf16_f32 v183, v222, v223
  v_add_u32 v3, s66, v2
  v_mfma_f32_16x16x32_bf16 a[124:127], a[188:191], v[188:191], a[124:127]
  s_cbranch_vccnz fa_stub17
fa_back17:
  v_exp_f32 v217, v145
  v_add_f32 v230, v230, v226
  v_add_f32 v231, v231, v227
fa_SSW5:
  v_mfma_f32_16x16x32_bf16 v[128:131], a[128:131], v[64:67], v[200:203]
  s_waitcnt vmcnt(12)
  v_exp_f32 v218, v146
  v_mfma_f32_16x16x32_bf16 v[136:139], a[128:131], v[68:71], v[204:207]
  s_barrier
  v_exp_f32 v219, v147
  v_mfma_f32_16x16x32_bf16 v[132:135], a[132:135], v[64:67], v[200:203]
  ds_read_b128 a[160:163], v3 offset:16384
  ds_read_b128 a[164:167], v3 offset:17408
  v_add_f32 v226, v216, v217
  v_mfma_f32_16x16x32_bf16 v[140:143], a[132:135], v[68:71], v[204:207]
  s_mov_b32 m0, s24
  v_exp_f32 v220, v148
  v_mfma_f32_16x16x32_bf16 v[128:131], a[136:139], v[72:75], v[128:131]
  ds_read_b128 a[168:171], v3 offset:18432
  buffer_load_dwordx4 v2, s[44:47], s26 offen offset:0 sc1 lds
  v_cvt_pk_bf16_f32 v184, v216, v217
  v_mfma_f32_16x16x32_bf16 v[136:139], a[136:139], v[76:79], v[136:139]
  v_exp_f32 v221, v149
  v_mfma_f32_16x16x32_bf16 v[132:135], a[140:143], v[72:75], v[132:135]
  ds_read_b128 a[172:175], v3 offset:19456
  v_add_f32 v226, v226, v218
  v_add_f32 v226, v226, v219
  v_mfma_f32_16x16x32_bf16 v[140:143], a[140:143], v[76:79], v[140:143]
  s_waitcnt lgkmcnt(4)
  v_exp_f32 v222, v150
  v_mfma_f32_16x16x32_bf16 v[128:131], a[144:147], v[80:83], v[128:131]
  s_add_u32 s14, s13, 16384
  ds_read_b128 a[176:179], v3 offset:20480
  buffer_load_dwordx4 a[200:203], v2, s[40:43], s14 offen offset:2048 sc1
  v_cvt_pk_bf16_f32 v185, v218, v219
  v_mfma_f32_16x16x32_bf16 v[136:139], a[144:147], v[84:87], v[136:139]
  v_exp_f32 v223, v151
  v_mfma_f32_16x16x32_bf16 v[132:135], a[148:151], v[80:83], v[132:135]
  ds_read_b128 a[180:183], v3 offset:21504
  buffer_load_dwordx4 v2, s[44:47], s26 offen offset:1024 sc1 lds
  v_add_f32 v226, v226, v220
  v_mfma_f32_16x16x32_bf16 v[140:143], a[148:151], v[84:87], v[140:143]
  v_exp_f32 v216, v152
  v_mfma_f32_16x16x32_bf16 v[128:131], a[152:155], v[88:91], v[128:131]
  ds_read_b128 a[184:187], v3 offset:22528
  v_add_f32 v226, v226, v221
  v_cvt_pk_bf16_f32 v186, v220, v221
  v_mfma_f32_16x16x32_bf16 v[136:139], a[152:155], v[92:95], v[136:139]
  v_exp_f32 v217, v153
  v_mfma_f32_16x16x32_bf16 v[132:135], a[156:159], v[88:91], v[132:135]
  ds_read_b128 a[188:191], v3 offset:23552
  buffer_load_dwordx4 a[204:207], v2, s[40:43], s14 offen offset:3072 sc1
  v_add_f32 v226, v226, v222
  v_mfma_f32_16x16x32_bf16 v[140:143], a[156:159], v[92:95], v[140:143]
  s_waitcnt lgkmcnt(4)
  v_exp_f32 v218, v154
  v_mfma_f32_16x16x32_bf16 a[64:67], a[160:163], v[176:179], a[64:67]
  ds_read_b128 a[128:131], v3 offset:0
  v_add_f32 v226, v226, v223
  v_cvt_pk_bf16_f32 v187, v222, v223
  v_mfma_f32_16x16x32_bf16 a[68:71], a[160:163], v[180:183], a[68:71]
  v_exp_f32 v219, v155
  v_mfma_f32_16x16x32_bf16 a[72:75], a[164:167], v[176:179], a[72:75]
  ds_read_b128 a[132:135], v3 offset:1024
  buffer_load_dwordx4 v2, s[44:47], s26 offen offset:2048 sc1 lds
  v_add_f32 v227, v216, v217
  v_mfma_f32_16x16x32_bf16 a[76:79], a[164:167], v[180:183], a[76:79]
  v_exp_f32 v220, v156
  v_mfma_f32_16x16x32_bf16 a[80:83], a[168:171], v[176:179], a[80:83]
  ds_read_b128 a[136:139], v3 offset:2048
  v_cvt_pk_bf16_f32 v188, v216, v217
  v_mfma_f32_16x16x32_bf16 a[84:87], a[168:171], v[180:183], a[84:87]
  v_exp_f32 v221, v157
  v_mfma_f32_16x16x32_bf16 a[88:91], a[172:175], v[176:179], a[88:91]
  s_add_u32 s14, s13, 20480
  ds_read_b128 a[140:143], v3 offset:3072
  buffer_load_dwordx4 a[208:211], v2, s[40:43], s14 offen offset:0 sc1
  v_add_f32 v227, v227, v218
  v_add_f32 v227, v227, v219
  v_mfma_f32_16x16x32_bf16 a[92:95], a[172:175], v[180:183], a[92:95]
  s_waitcnt lgkmcnt(4)
  v_exp_f32 v222, v158
  v_mfma_f32_16x16x32_bf16 a[96:99], a[176:179], v[176:179], a[96:99]
  ds_read_b128 a[144:147], v3 offset:4096
  buffer_load_dwordx4 v2, s[44:47], s26 offen offset:3072 sc1 lds
  v_cvt_pk_bf16_f32 v189, v218, v219
  v_mfma_f32_16x16x32_bf16 a[100:103], a[176:179], v[180:183], a[100:103]
  s_add_u32 s26, s26, 16384
  v_exp_f32 v223, v159
  v_mfma_f32_16x16x32_bf16 a[104:107], a[180:183], v[176:179], a[104:107]
  s_add_u32 s24, s24, 32768
  ds_read_b128 a[148:151], v3 offset:5120
  v_add_f32 v227, v227, v220
  v_mfma_f32_16x16x32_bf16 a[108:111], a[180:183], v[180:183], a[108:111]
  s_and_b32 s24, s24, 0x1ffff
  v_add_f32 v227, v227, v221
  v_cvt_pk_bf16_f32 v190, v220, v221
  v_add_f32 v227, v227, v222
  v_mfma_f32_16x16x32_bf16 a[112:115], a[184:187], v[176:179], a[112:115]
  ds_read_b128 a[152:155], v3 offset:6144
  v_add_f32 v227, v227, v223
  v_max_f32 v5, v226, v227
  v_cmp_lt_f32 vcc, s81, v5
  v_mfma_f32_16x16x32_bf16 a[116:119], a[184:187], v[180:183], a[116:119]
  v_exp_f32 v216, v128
  v_mfma_f32_16x16x32_bf16 a[120:123], a[188:191], v[176:179], a[120:123]
  s_waitcnt lgkmcnt(3)
  ds_read_b128 a[156:159], v3 offset:7168
  v_cvt_pk_bf16_f32 v191, v222, v223
  v_mfma_f32_16x16x32_bf16 a[124:127], a[188:191], v[180:183], a[124:127]
  s_cbranch_vccnz fa_stub18
fa_back18:
  v_exp_f32 v217, v129
  v_add_f32 v230, v230, v226
  v_add_f32 v231, v231, v227
  v_mfma_f32_16x16x32_bf16 v[144:147], a[128:131], v[64:67], v[200:203]
  ds_read_b128 a[160:163], v3 offset:24576
  v_add_f32 v226, v216, v217
  v_mfma_f32_16x16x32_bf16 v[152:155], a[128:131], v[68:71], v[204:207]
  v_exp_f32 v218, v130
  v_mfma_f32_16x16x32_bf16 v[148:151], a[132:135], v[64:67], v[200:203]
  s_add_u32 s66, s66, 32768
  ds_read_b128 a[164:167], v3 offset:25600
  v_cvt_pk_bf16_f32 v176, v216, v217
  v_mfma_f32_16x16x32_bf16 v[156:159], a[132:135], v[68:71], v[204:207]
  s_mov_b32 m0, s25
  v_exp_f32 v219, v131
  v_mfma_f32_16x16x32_bf16 v[144:147], a[136:139], v[72:75], v[144:147]
  s_and_b32 s66, s66, 0x1ffff
  ds_read_b128 a[168:171], v3 offset:26624
  buffer_load_dwordx4 v2, s[48:51], s27 offen offset:0 sc1 lds
  v_add_f32 v226, v226, v218
  v_add_f32 v226, v226, v219
  v_mfma_f32_16x16x32_bf16 v[152:155], a[136:139], v[76:79], v[152:155]
  v_exp_f32 v220, v132
  v_mfma_f32_16x16x32_bf16 v[148:151], a[140:143], v[72:75], v[148:151]
  ds_read_b128 a[172:175], v3 offset:27648
  v_cvt_pk_bf16_f32 v177, v218, v219
  v_mfma_f32_16x16x32_bf16 v[156:159], a[140:143], v[76:79], v[156:159]
  s_waitcnt lgkmcnt(4)
  v_exp_f32 v221, v133
  v_mfma_f32_16x16x32_bf16 v[144:147], a[144:147], v[80:83], v[144:147]
  s_add_u32 s14, s13, 20480
  ds_read_b128 a[176:179], v3 offset:28672
  buffer_load_dwordx4 a[212:215], v2, s[40:43], s14 offen offset:1024 sc1
  v_add_f32 v226, v226, v220
  v_mfma_f32_16x16x32_bf16 v[152:155], a[144:147], v[84:87], v[152:155]
  v_exp_f32 v222, v134
  v_mfma_f32_16x16x32_bf16 v[148:151], a[148:151], v[80:83], v[148:151]
  ds_read_b128 a[180:183], v3 offset:29696
  buffer_load_dwordx4 v2, s[48:51], s27 offen offset:1024 sc1 lds
  v_add_f32 v226, v226, v221
  v_cvt_pk_bf16_f32 v178, v220, v221
  v_mfma_f32_16x16x32_bf16 v[156:159], a[148:151], v[84:87], v[156:159]
  v_exp_f32 v223, v135
  v_mfma_f32_16x16x32_bf16 v[144:147], a[152:155], v[88:91], v[144:147]
  ds_read_b128 a[184:187], v3 offset:30720
  v_add_f32 v226, v226, v222
  v_mfma_f32_16x16x32_bf16 v[152:155], a[152:155], v[92:95], v[152:155]
  v_exp_f32 v216, v136
  v_mfma_f32_16x16x32_bf16 v[148:151], a[156:159], v[88:91], v[148:151]
  ds_read_b128 a[188:191], v3 offset:31744
  buffer_load_dwordx4 a[216:219], v2, s[40:43], s14 offen offset:2048 sc1
  v_add_f32 v226, v226, v223
  v_exp_f32 v217, v137
  v_mfma_f32_16x16x32_bf16 v[156:159], a[156:159], v[92:95], v[156:159]
  s_waitcnt lgkmcnt(4)
  v_exp_f32 v218, v138
  v_mfma_f32_16x16x32_bf16 a[64:67], a[160:163], v[184:187], a[64:67]
  ds_read_b128 a[128:131], v3 offset:8192
  v_cvt_pk_bf16_f32 v179, v222, v223
  v_mfma_f32_16x16x32_bf16 a[68:71], a[160:163], v[188:191], a[68:71]
  v_exp_f32 v219, v139
  v_mfma_f32_16x16x32_bf16 a[72:75], a[164:167], v[184:187], a[72:75]
  ds_read_b128 a[132:135], v3 offset:9216
  buffer_load_dwordx4 v2, s[48:51], s27 offen offset:2048 sc1 lds
  v_add_f32 v227, v216, v217
  v_mfma_f32_16x16x32_bf16 a[76:79], a[164:167], v[188:191], a[76:79]
  v_exp_f32 v220, v140
  v_mfma_f32_16x16x32_bf16 a[80:83], a[168:171], v[184:187], a[80:83]
  ds_read_b128 a[136:139], v3 offset:10240
  v_cvt_pk_bf16_f32 v180, v216, v217
  v_mfma_f32_16x16x32_bf16 a[84:87], a[168:171], v[188:191], a[84:87]
  v_exp_f32 v221, v141
  v_mfma_f32_16x16x32_bf16 a[88:91], a[172:175], v[184:187], a[88:91]
  ds_read_b128 a[140:143], v3 offset:11264
  buffer_load_dwordx4 a[220:223], v2, s[40:43], s14 offen offset:3072 sc1
  v_add_f32 v227, v227, v218
  v_mfma_f32_16x16x32_bf16 a[92:95], a[172:175], v[188:191], a[92:95]
  s_waitcnt lgkmcnt(4)
  v_exp_f32 v222, v142
  v_mfma_f32_16x16x32_bf16 a[96:99], a[176:179], v[184:187], a[96:99]
  ds_read_b128 a[144:147], v3 offset:12288
  buffer_load_dwordx4 v2, s[48:51], s27 offen offset:3072 sc1 lds
  v_add_f32 v227, v227, v219
  v_cvt_pk_bf16_f32 v181, v218, v219
  v_mfma_f32_16x16x32_bf16 a[100:103], a[176:179], v[188:191], a[100:103]
  s_add_u32 s27, s27, 16384
  v_exp_f32 v223, v143
  v_mfma_f32_16x16x32_bf16 a[104:107], a[180:183], v[184:187], a[104:107]
  s_add_u32 s25, s25, 32768
  ds_read_b128 a[148:151], v3 offset:13312
  v_add_f32 v227, v227, v220
  v_mfma_f32_16x16x32_bf16 a[108:111], a[180:183], v[188:191], a[108:111]
  s_and_b32 s25, s25, 0x1ffff
  v_add_f32 v227, v227, v221
  v_cvt_pk_bf16_f32 v182, v220, v221
  v_add_f32 v227, v227, v222
  v_mfma_f32_16x16x32_bf16 a[112:115], a[184:187], v[184:187], a[112:115]
  ds_read_b128 a[152:155], v3 offset:14336
  v_add_f32 v227, v227, v223
  v_max_f32 v5, v226, v227
  v_cmp_lt_f32 vcc, s81, v5
  v_mfma_f32_16x16x32_bf16 a[116:119], a[184:187], v[188:191], a[116:119]
  v_exp_f32 v216, v144
  v_mfma_f32_16x16x32_bf16 a[120:123], a[188:191], v[184:187], a[120:123]
  s_waitcnt lgkmcnt(3)
  ds_read_b128 a[156:159], v3 offset:15360
  v_cvt_pk_bf16_f32 v183, v222, v223
  v_add_u32 v3, s66, v2
  v_mfma_f32_16x16x32_bf16 a[124:127], a[188:191], v[188:191], a[124:127]
  s_cbranch_vccnz fa_stub19
fa_back19:
  v_exp_f32 v217, v145
  v_add_f32 v230, v230, v226
  v_add_f32 v231, v231, v227
fa_SSW4:
  v_mfma_f32_16x16x32_bf16 v[128:131], a[128:131], v[64:67], v[200:203]
  s_waitcnt vmcnt(12)
  v_exp_f32 v218, v146
  v_mfma_f32_16x16x32_bf16 v[136:139], a[128:131], v[68:71], v[204:207]
  s_barrier
  v_exp_f32 v219, v147
  v_mfma_f32_16x16x32_bf16 v[132:135], a[132:135], v[64:67], v[200:203]
  ds_read_b128 a[160:163], v3 offset:16384
  ds_read_b128 a[164:167], v3 offset:17408
  v_add_f32 v226, v216, v217
  v_mfma_f32_16x16x32_bf16 v[140:143], a[132:135], v[68:71], v[204:207]
  s_mov_b32 m0, s24
  v_exp_f32 v220, v148
  v_mfma_f32_16x16x32_bf16 v[128:131], a[136:139], v[72:75], v[128:131]
  ds_read_b128 a[168:171], v3 offset:18432
  buffer_load_dwordx4 v2, s[44:47], s26 offen offset:0 sc1 lds
  v_cvt_pk_bf16_f32 v184, v216, v217
  v_mfma_f32_16x16x32_bf16 v[136:139], a[136:139], v[76:79], v[136:139]
  v_exp_f32 v221, v149
  v_mfma_f32_16x16x32_bf16 v[132:135], a[140:143], v[72:75], v[132:135]
  ds_read_b128 a[172:175], v3 offset:19456
  v_add_f32 v226, v226, v218
  v_add_f32 v226, v226, v219
  v_mfma_f32_16x16x32_bf16 v[140:143], a[140:143], v[76:79], v[140:143]
  s_waitcnt lgkmcnt(4)
  v_exp_f32 v222, v150
  v_mfma_f32_16x16x32_bf16 v[128:131], a[144:147], v[80:83], v[128:131]
  s_add_u32 s14, s13, 24576
  ds_read_b128 a[176:179], v3 offset:20480
  buffer_load_dwordx4 a[224:227], v2, s[40:43], s14 offen offset:0 sc1
  v_cvt_pk_bf16_f32 v185, v218, v219
  v_mfma_f32_16x16x32_bf16 v[136:139], a[144:147], v[84:87], v[136:139]
  v_exp_f32 v223, v151
  v_mfma_f32_16x16x32_bf16 v[132:135], a[148:151], v[80:83], v[132:135]
  ds_read_b128 a[180:183], v3 offset:21504
  buffer_load_dwordx4 v2, s[44:47], s26 offen offset:1024 sc1 lds
  v_add_f32 v226, v226, v220
  v_mfma_f32_16x16x32_bf16 v[140:143], a[148:151], v[84:87], v[140:143]
  v_exp_f32 v216, v152
  v_mfma_f32_16x16x32_bf16 v[128:131], a[152:155], v[88:91], v[128:131]
  ds_read_b128 a[184:187], v3 offset:22528
  v_add_f32 v226, v226, v221
  v_cvt_pk_bf16_f32 v186, v220, v221
  v_mfma_f32_16x16x32_bf16 v[136:139], a[152:155], v[92:95], v[136:139]
  v_exp_f32 v217, v153
  v_mfma_f32_16x16x32_bf16 v[132:135], a[156:159], v[88:91], v[132:135]
  ds_read_b128 a[188:191], v3 offset:23552
  buffer_load_dwordx4 a[228:231], v2, s[40:43], s14 offen offset:1024 sc1
  v_add_f32 v226, v226, v222
  v_mfma_f32_16x16x32_bf16 v[140:143], a[156:159], v[92:95], v[140:143]
  s_waitcnt lgkmcnt(4)
  v_exp_f32 v218, v154
  v_mfma_f32_16x16x32_bf16 a[64:67], a[160:163], v[176:179], a[64:67]
  ds_read_b128 a[128:131], v3 offset:0
  v_add_f32 v226, v226, v223
  v_cvt_pk_bf16_f32 v187, v222, v223
  v_mfma_f32_16x16x32_bf16 a[68:71], a[160:163], v[180:183], a[68:71]
  v_exp_f32 v219, v155
  v_mfma_f32_16x16x32_bf16 a[72:75], a[164:167], v[176:179], a[72:75]
  ds_read_b128 a[132:135], v3 offset:1024
  buffer_load_dwordx4 v2, s[44:47], s26 offen offset:2048 sc1 lds
  v_add_f32 v227, v216, v217
  v_mfma_f32_16x16x32_bf16 a[76:79], a[164:167], v[180:183], a[76:79]
  v_exp_f32 v220, v156
  v_mfma_f32_16x16x32_bf16 a[80:83], a[168:171], v[176:179], a[80:83]
  ds_read_b128 a[136:139], v3 offset:2048
  v_cvt_pk_bf16_f32 v188, v216, v217
  v_mfma_f32_16x16x32_bf16 a[84:87], a[168:171], v[180:183], a[84:87]
  v_exp_f32 v221, v157
  v_mfma_f32_16x16x32_bf16 a[88:91], a[172:175], v[176:179], a[88:91]
  ds_read_b128 a[140:143], v3 offset:3072
  buffer_load_dwordx4 a[232:235], v2, s[40:43], s14 offen offset:2048 sc1
  v_add_f32 v227, v227, v218
  v_add_f32 v227, v227, v219
  v_mfma_f32_16x16x32_bf16 a[92:95], a[172:175], v[180:183], a[92:95]
  s_waitcnt lgkmcnt(4)
  v_exp_f32 v222, v158
  v_mfma_f32_16x16x32_bf16 a[96:99], a[176:179], v[176:179], a[96:99]
  ds_read_b128 a[144:147], v3 offset:4096
  buffer_load_dwordx4 v2, s[44:47], s26 offen offset:3072 sc1 lds
  v_cvt_pk_bf16_f32 v189, v218, v219
  v_mfma_f32_16x16x32_bf16 a[100:103], a[176:179], v[180:183], a[100:103]
  s_add_u32 s26, s26, 16384
  v_exp_f32 v223, v159
  v_mfma_f32_16x16x32_bf16 a[104:107], a[180:183], v[176:179], a[104:107]
  s_add_u32 s24, s24, 32768
  ds_read_b128 a[148:151], v3 offset:5120
  v_add_f32 v227, v227, v220
  v_mfma_f32_16x16x32_bf16 a[108:111], a[180:183], v[180:183], a[108:111]
  s_and_b32 s24, s24, 0x1ffff
  v_add_f32 v227, v227, v221
  v_cvt_pk_bf16_f32 v190, v220, v221
  v_add_f32 v227, v227, v222
  v_mfma_f32_16x16x32_bf16 a[112:115], a[184:187], v[176:179], a[112:115]
  ds_read_b128 a[152:155], v3 offset:6144
  v_add_f32 v227, v227, v223
  v_max_f32 v5, v226, v227
  v_cmp_lt_f32 vcc, s81, v5
  v_mfma_f32_16x16x32_bf16 a[116:119], a[184:187], v[180:183], a[116:119]
  v_exp_f32 v216, v128
  v_mfma_f32_16x16x32_bf16 a[120:123], a[188:191], v[176:179], a[120:123]
  s_waitcnt lgkmcnt(3)
  ds_read_b128 a[156:159], v3 offset:7168
  v_cvt_pk_bf16_f32 v191, v222, v223
  v_mfma_f32_16x16x32_bf16 a[124:127], a[188:191], v[180:183], a[124:127]
  s_cbranch_vccnz fa_stub20
fa_back20:
  v_exp_f32 v217, v129
  v_add_f32 v230, v230, v226
  v_add_f32 v231, v231, v227
  v_mfma_f32_16x16x32_bf16 v[144:147], a[128:131], v[64:67], v[200:203]
  ds_read_b128 a[160:163], v3 offset:24576
  v_add_f32 v226, v216, v217
  v_mfma_f32_16x16x32_bf16 v[152:155], a[128:131], v[68:71], v[204:207]
  v_exp_f32 v218, v130
  v_mfma_f32_16x16x32_bf16 v[148:151], a[132:135], v[64:67], v[200:203]
  s_add_u32 s66, s66, 32768
  ds_read_b128 a[164:167], v3 offset:25600
  v_cvt_pk_bf16_f32 v176, v216, v217
  v_mfma_f32_16x16x32_bf16 v[156:159], a[132:135], v[68:71], v[204:207]
  s_mov_b32 m0, s25
  v_exp_f32 v219, v131
  v_mfma_f32_16x16x32_bf16 v[144:147], a[136:139], v[72:75], v[144:147]
  s_and_b32 s66, s66, 0x1ffff
  ds_read_b128 a[168:171], v3 offset:26624
  buffer_load_dwordx4 v2, s[48:51], s27 offen offset:0 sc1 lds
  v_add_f32 v226, v226, v218
  v_add_f32 v226, v226, v219
  v_mfma_f32_16x16x32_bf16 v[152:155], a[136:139], v[76:79], v[152:155]
  v_exp_f32 v220, v132
  v_mfma_f32_16x16x32_bf16 v[148:151], a[140:143], v[72:75], v[148:151]
  ds_read_b128 a[172:175], v3 offset:27648
  v_cvt_pk_bf16_f32 v177, v218, v219
  v_mfma_f32_16x16x32_bf16 v[156:159], a[140:143], v[76:79], v[156:159]
  s_waitcnt lgkmcnt(4)
  v_exp_f32 v221, v133
  v_mfma_f32_16x16x32_bf16 v[144:147], a[144:147], v[80:83], v[144:147]
  s_add_u32 s14, s13, 24576
  ds_read_b128 a[176:179], v3 offset:28672
  buffer_load_dwordx4 a[236:239], v2, s[40:43], s14 offen offset:3072 sc1
  v_add_f32 v226, v226, v220
  v_mfma_f32_16x16x32_bf16 v[152:155], a[144:147], v[84:87], v[152:155]
  v_exp_f32 v222, v134
  v_mfma_f32_16x16x32_bf16 v[148:151], a[148:151], v[80:83], v[148:151]
  ds_read_b128 a[180:183], v3 offset:29696
  buffer_load_dwordx4 v2, s[48:51], s27 offen offset:1024 sc1 lds
  v_add_f32 v226, v226, v221
  v_cvt_pk_bf16_f32 v178, v220, v221
  v_mfma_f32_16x16x32_bf16 v[156:159], a[148:151], v[84:87], v[156:159]
  v_exp_f32 v223, v135
  v_mfma_f32_16x16x32_bf16 v[144:147], a[152:155], v[88:91], v[144:147]
  ds_read_b128 a[184:187], v3 offset:30720
  v_add_f32 v226, v226, v222
  v_mfma_f32_16x16x32_bf16 v[152:155], a[152:155], v[92:95], v[152:155]
  v_exp_f32 v216, v136
  v_mfma_f32_16x16x32_bf16 v[148:151], a[156:159], v[88:91], v[148:151]
  s_add_u32 s14, s13, 28672
  ds_read_b128 a[188:191], v3 offset:31744
  buffer_load_dwordx4 a[240:243], v2, s[40:43], s14 offen offset:0 sc1
  v_add_f32 v226, v226, v223
  v_exp_f32 v217, v137
  v_mfma_f32_16x16x32_bf16 v[156:159], a[156:159], v[92:95], v[156:159]
  s_waitcnt lgkmcnt(4)
  v_exp_f32 v218, v138
  v_mfma_f32_16x16x32_bf16 a[64:67], a[160:163], v[184:187], a[64:67]
  ds_read_b128 a[128:131], v3 offset:8192
  v_cvt_pk_bf16_f32 v179, v222, v223
  v_mfma_f32_16x16x32_bf16 a[68:71], a[160:163], v[188:191], a[68:71]
  v_exp_f32 v219, v139
  v_mfma_f32_16x16x32_bf16 a[72:75], a[164:167], v[184:187], a[72:75]
  ds_read_b128 a[132:135], v3 offset:9216
  buffer_load_dwordx4 v2, s[48:51], s27 offen offset:2048 sc1 lds
  v_add_f32 v227, v216, v217
  v_mfma_f32_16x16x32_bf16 a[76:79], a[164:167], v[188:191], a[76:79]
  v_exp_f32 v220, v140
  v_mfma_f32_16x16x32_bf16 a[80:83], a[168:171], v[184:187], a[80:83]
  ds_read_b128 a[136:139], v3 offset:10240
  v_cvt_pk_bf16_f32 v180, v216, v217
  v_mfma_f32_16x16x32_bf16 a[84:87], a[168:171], v[188:191], a[84:87]
  v_exp_f32 v221, v141
  v_mfma_f32_16x16x32_bf16 a[88:91], a[172:175], v[184:187], a[88:91]
  ds_read_b128 a[140:143], v3 offset:11264
  buffer_load_dwordx4 a[244:247], v2, s[40:43], s14 offen offset:1024 sc1
  v_add_f32 v227, v227, v218
  v_mfma_f32_16x16x32_bf16 a[92:95], a[172:175], v[188:191], a[92:95]
  s_waitcnt lgkmcnt(4)
  v_exp_f32 v222, v142
  v_mfma_f32_16x16x32_bf16 a[96:99], a[176:179], v[184:187], a[96:99]
  ds_read_b128 a[144:147], v3 offset:12288
  buffer_load_dwordx4 v2, s[48:51], s27 offen offset:3072 sc1 lds
  v_add_f32 v227, v227, v219
  v_cvt_pk_bf16_f32 v181, v218, v219
  v_mfma_f32_16x16x32_bf16 a[100:103], a[176:179], v[188:191], a[100:103]
  s_add_u32 s27, s27, 16384
  v_exp_f32 v223, v143
  v_mfma_f32_16x16x32_bf16 a[104:107], a[180:183], v[184:187], a[104:107]
  s_add_u32 s25, s25, 32768
  ds_read_b128 a[148:151], v3 offset:13312
  v_add_f32 v227, v227, v220
  v_mfma_f32_16x16x32_bf16 a[108:111], a[180:183], v[188:191], a[108:111]
  s_and_b32 s25, s25, 0x1ffff
  v_add_f32 v227, v227, v221
  v_cvt_pk_bf16_f32 v182, v220, v221
  v_add_f32 v227, v227, v222
  v_mfma_f32_16x16x32_bf16 a[112:115], a[184:187], v[184:187], a[112:115]
  ds_read_b128 a[152:155], v3 offset:14336
  v_add_f32 v227, v227, v223
  v_max_f32 v5, v226, v227
  v_cmp_lt_f32 vcc, s81, v5
  v_mfma_f32_16x16x32_bf16 a[116:119], a[184:187], v[188:191], a[116:119]
  v_exp_f32 v216, v144
  v_mfma_f32_16x16x32_bf16 a[120:123], a[188:191], v[184:187], a[120:123]
  s_waitcnt lgkmcnt(3)
  ds_read_b128 a[156:159], v3 offset:15360
  v_cvt_pk_bf16_f32 v183, v222, v223
  v_add_u32 v3, s66, v2
  v_mfma_f32_16x16x32_bf16 a[124:127], a[188:191], v[188:191], a[124:127]
  s_cbranch_vccnz fa_stub21
fa_back21:
  v_exp_f32 v217, v145
  v_add_f32 v230, v230, v226
  v_add_f32 v231, v231, v227
fa_SSW3:
  v_mfma_f32_16x16x32_bf16 v[128:131], a[128:131], v[64:67], v[200:203]
  s_waitcnt vmcnt(12)
  v_exp_f32 v218, v146
  v_mfma_f32_16x16x32_bf16 v[136:139], a[128:131], v[68:71], v[204:207]
  s_barrier
  v_exp_f32 v219, v147
  v_mfma_f32_16x16x32_bf16 v[132:135], a[132:135], v[64:67], v[200:203]
  ds_read_b128 a[160:163], v3 offset:16384
  ds_read_b128 a[164:167], v3 offset:17408
  v_add_f32 v226, v216, v217
  v_mfma_f32_16x16x32_bf16 v[140:143], a[132:135], v[68:71], v[204:207]
  s_mov_b32 m0, s24
  v_exp_f32 v220, v148
  v_mfma_f32_16x16x32_bf16 v[128:131], a[136:139], v[72:75], v[128:131]
  ds_read_b128 a[168:171], v3 offset:18432
  buffer_load_dwordx4 v2, s[44:47], s26 offen offset:0 sc1 lds
  v_cvt_pk_bf16_f32 v184, v216, v217
  v_mfma_f32_16x16x32_bf16 v[136:139], a[136:139], v[76:79], v[136:139]
  v_exp_f32 v221, v149
  v_mfma_f32_16x16x32_bf16 v[132:135], a[140:143], v[72:75], v[132:135]
  ds_read_b128 a[172:175], v3 offset:19456
  v_add_f32 v226, v226, v218
  v_add_f32 v226, v226, v219
  v_mfma_f32_16x16x32_bf16 v[140:143], a[140:143], v[76:79], v[140:143]
  s_waitcnt lgkmcnt(4)
  v_exp_f32 v222, v150
  v_mfma_f32_16x16x32_bf16 v[128:131], a[144:147], v[80:83], v[128:131]
  s_add_u32 s14, s13, 28672
  ds_read_b128 a[176:179], v3 offset:20480
  buffer_load_dwordx4 a[248:251], v2, s[40:43], s14 offen offset:2048 sc1
  v_cvt_pk_bf16_f32 v185, v218, v219
  v_mfma_f32_16x16x32_bf16 v[136:139], a[144:147], v[84:87], v[136:139]
  v_exp_f32 v223, v151
  v_mfma_f32_16x16x32_bf16 v[132:135], a[148:151], v[80:83], v[132:135]
  ds_read_b128 a[180:183], v3 offset:21504
  buffer_load_dwordx4 v2, s[44:47], s26 offen offset:1024 sc1 lds
  v_add_f32 v226, v226, v220
  v_mfma_f32_16x16x32_bf16 v[140:143], a[148:151], v[84:87], v[140:143]
  v_exp_f32 v216, v152
  v_mfma_f32_16x16x32_bf16 v[128:131], a[152:155], v[88:91], v[128:131]
  ds_read_b128 a[184:187], v3 offset:22528
  v_add_f32 v226, v226, v221
  v_cvt_pk_bf16_f32 v186, v220, v221
  v_mfma_f32_16x16x32_bf16 v[136:139], a[152:155], v[92:95], v[136:139]
  v_exp_f32 v217, v153
  v_mfma_f32_16x16x32_bf16 v[132:135], a[156:159], v[88:91], v[132:135]
  ds_read_b128 a[188:191], v3 offset:23552
  buffer_load_dwordx4 a[252:255], v2, s[40:43], s14 offen offset:3072 sc1
  v_add_f32 v226, v226, v222
  v_mfma_f32_16x16x32_bf16 v[140:143], a[156:159], v[92:95], v[140:143]
  s_waitcnt lgkmcnt(4)
  v_exp_f32 v218, v154
  v_mfma_f32_16x16x32_bf16 a[64:67], a[160:163], v[176:179], a[64:67]
  ds_read_b128 a[128:131], v3 offset:0
  v_add_f32 v226, v226, v223
  v_cvt_pk_bf16_f32 v187, v222, v223
  v_mfma_f32_16x16x32_bf16 a[68:71], a[160:163], v[180:183], a[68:71]
  v_exp_f32 v219, v155
  v_mfma_f32_16x16x32_bf16 a[72:75], a[164:167], v[176:179], a[72:75]
  ds_read_b128 a[132:135], v3 offset:1024
  buffer_load_dwordx4 v2, s[44:47], s26 offen offset:2048 sc1 lds
  v_add_f32 v227, v216, v217
  v_mfma_f32_16x16x32_bf16 a[76:79], a[164:167], v[180:183], a[76:79]
  v_exp_f32 v220, v156
  v_mfma_f32_16x16x32_bf16 a[80:83], a[168:171], v[176:179], a[80:83]
  ds_read_b128 a[136:139], v3 offset:2048
  v_cvt_pk_bf16_f32 v188, v216, v217
  v_mfma_f32_16x16x32_bf16 a[84:87], a[168:171], v[180:183], a[84:87]
  v_exp_f32 v221, v157
  v_mfma_f32_16x16x32_bf16 a[88:91], a[172:175], v[176:179], a[88:91]
  s_add_u32 s14, s13, 32768
  ds_read_b128 a[140:143], v3 offset:3072
  buffer_load_dwordx4 v[32:35], v2, s[40:43], s14 offen offset:0 sc1
  v_add_f32 v227, v227, v218
  v_add_f32 v227, v227, v219
  v_mfma_f32_16x16x32_bf16 a[92:95], a[172:175], v[180:183], a[92:95]
  s_waitcnt lgkmcnt(4)
  v_exp_f32 v222, v158
  v_mfma_f32_16x16x32_bf16 a[96:99], a[176:179], v[176:179], a[96:99]
  ds_read_b128 a[144:147], v3 offset:4096
  buffer_load_dwordx4 v2, s[44:47], s26 offen offset:3072 sc1 lds
  v_cvt_pk_bf16_f32 v189, v218, v219
  v_mfma_f32_16x16x32_bf16 a[100:103], a[176:179], v[180:183], a[100:103]
  s_add_u32 s26, s26, 16384
  v_exp_f32 v223, v159
  v_mfma_f32_16x16x32_bf16 a[104:107], a[180:183], v[176:179], a[104:107]
  s_add_u32 s24, s24, 32768
  ds_read_b128 a[148:151], v3 offset:5120
  v_add_f32 v227, v227, v220
  v_mfma_f32_16x16x32_bf16 a[108:111], a[180:183], v[180:183], a[108:111]
  s_and_b32 s24, s24, 0x1ffff
  v_add_f32 v227, v227, v221
  v_cvt_pk_bf16_f32 v190, v220, v221
  v_add_f32 v227, v227, v222
  v_mfma_f32_16x16x32_bf16 a[112:115], a[184:187], v[176:179], a[112:115]
  ds_read_b128 a[152:155], v3 offset:6144
  v_add_f32 v227, v227, v223
  v_max_f32 v5, v226, v227
  v_cmp_lt_f32 vcc, s81, v5
  v_mfma_f32_16x16x32_bf16 a[116:119], a[184:187], v[180:183], a[116:119]
  v_exp_f32 v216, v128
  v_mfma_f32_16x16x32_bf16 a[120:123], a[188:191], v[176:179], a[120:123]
  s_waitcnt lgkmcnt(3)
  ds_read_b128 a[156:159], v3 offset:7168
  v_cvt_pk_bf16_f32 v191, v222, v223
  v_mfma_f32_16x16x32_bf16 a[124:127], a[188:191], v[180:183], a[124:127]
  s_cbranch_vccnz fa_stub22
fa_back22:
  v_exp_f32 v217, v129
  v_add_f32 v230, v230, v226
  v_add_f32 v231, v231, v227
  v_mfma_f32_16x16x32_bf16 v[144:147], a[128:131], v[64:67], v[200:203]
  ds_read_b128 a[160:163], v3 offset:24576
  v_add_f32 v226, v216, v217
  v_mfma_f32_16x16x32_bf16 v[152:155], a[128:131], v[68:71], v[204:207]
  v_exp_f32 v218, v130
  v_mfma_f32_16x16x32_bf16 v[148:151], a[132:135], v[64:67], v[200:203]
  s_add_u32 s66, s66, 32768
  ds_read_b128 a[164:167], v3 offset:25600
  v_cvt_pk_bf16_f32 v176, v216, v217
  v_mfma_f32_16x16x32_bf16 v[156:159], a[132:135], v[68:71], v[204:207]
  s_mov_b32 m0, s25
  v_exp_f32 v219, v131
  v_mfma_f32_16x16x32_bf16 v[144:147], a[136:139], v[72:75], v[144:147]
  s_and_b32 s66, s66, 0x1ffff
  ds_read_b128 a[168:171], v3 offset:26624
  buffer_load_dwordx4 v2, s[48:51], s27 offen offset:0 sc1 lds
  v_add_f32 v226, v226, v218
  v_add_f32 v226, v226, v219
  v_mfma_f32_16x16x32_bf16 v[152:155], a[136:139], v[76:79], v[152:155]
  v_exp_f32 v220, v132
  v_mfma_f32_16x16x32_bf16 v[148:151], a[140:143], v[72:75], v[148:151]
  ds_read_b128 a[172:175], v3 offset:27648
  v_cvt_pk_bf16_f32 v177, v218, v219
  v_mfma_f32_16x16x32_bf16 v[156:159], a[140:143], v[76:79], v[156:159]
  s_waitcnt lgkmcnt(4)
  v_exp_f32 v221, v133
  v_mfma_f32_16x16x32_bf16 v[144:147], a[144:147], v[80:83], v[144:147]
  s_add_u32 s14, s13, 32768
  ds_read_b128 a[176:179], v3 offset:28672
  buffer_load_dwordx4 v[36:39], v2, s[40:43], s14 offen offset:1024 sc1
  v_add_f32 v226, v226, v220
  v_mfma_f32_16x16x32_bf16 v[152:155], a[144:147], v[84:87], v[152:155]
  v_exp_f32 v222, v134
  v_mfma_f32_16x16x32_bf16 v[148:151], a[148:151], v[80:83], v[148:151]
  ds_read_b128 a[180:183], v3 offset:29696
  buffer_load_dwordx4 v2, s[48:51], s27 offen offset:1024 sc1 lds
  v_add_f32 v226, v226, v221
  v_cvt_pk_bf16_f32 v178, v220, v221
  v_mfma_f32_16x16x32_bf16 v[156:159], a[148:151], v[84:87], v[156:159]
  v_exp_f32 v223, v135
  v_mfma_f32_16x16x32_bf16 v[144:147], a[152:155], v[88:91], v[144:147]
  ds_read_b128 a[184:187], v3 offset:30720
  v_add_f32 v226, v226, v222
  v_mfma_f32_16x16x32_bf16 v[152:155], a[152:155], v[92:95], v[152:155]
  v_exp_f32 v216, v136
  v_mfma_f32_16x16x32_bf16 v[148:151], a[156:159], v[88:91], v[148:151]
  ds_read_b128 a[188:191], v3 offset:31744
  buffer_load_dwordx4 v[40:43], v2, s[40:43], s14 offen offset:2048 sc1
  v_add_f32 v226, v226, v223
  v_exp_f32 v217, v137
  v_mfma_f32_16x16x32_bf16 v[156:159], a[156:159], v[92:95], v[156:159]
  s_waitcnt lgkmcnt(4)
  v_exp_f32 v218, v138
  v_mfma_f32_16x16x32_bf16 a[64:67], a[160:163], v[184:187], a[64:67]
  ds_read_b128 a[128:131], v3 offset:8192
  v_cvt_pk_bf16_f32 v179, v222, v223
  v_mfma_f32_16x16x32_bf16 a[68:71], a[160:163], v[188:191], a[68:71]
  v_exp_f32 v219, v139
  v_mfma_f32_16x16x32_bf16 a[72:75], a[164:167], v[184:187], a[72:75]
  ds_read_b128 a[132:135], v3 offset:9216
  buffer_load_dwordx4 v2, s[48:51], s27 offen offset:2048 sc1 lds
  v_add_f32 v227, v216, v217
  v_mfma_f32_16x16x32_bf16 a[76:79], a[164:167], v[188:191], a[76:79]
  v_exp_f32 v220, v140
  v_mfma_f32_16x16x32_bf16 a[80:83], a[168:171], v[184:187], a[80:83]
  ds_read_b128 a[136:139], v3 offset:10240
  v_cvt_pk_bf16_f32 v180, v216, v217
  v_mfma_f32_16x16x32_bf16 a[84:87], a[168:171], v[188:191], a[84:87]
  v_exp_f32 v221, v141
  v_mfma_f32_16x16x32_bf16 a[88:91], a[172:175], v[184:187], a[88:91]
  ds_read_b128 a[140:143], v3 offset:11264
  buffer_load_dwordx4 v[44:47], v2, s[40:43], s14 offen offset:3072 sc1
  v_add_f32 v227, v227, v218
  v_mfma_f32_16x16x32_bf16 a[92:95], a[172:175], v[188:191], a[92:95]
  s_waitcnt lgkmcnt(4)
  v_exp_f32 v222, v142
  v_mfma_f32_16x16x32_bf16 a[96:99], a[176:179], v[184:187], a[96:99]
  ds_read_b128 a[144:147], v3 offset:12288
  buffer_load_dwordx4 v2, s[48:51], s27 offen offset:3072 sc1 lds
  v_add_f32 v227, v227, v219
  v_cvt_pk_bf16_f32 v181, v218, v219
  v_mfma_f32_16x16x32_bf16 a[100:103], a[176:179], v[188:191], a[100:103]
  s_add_u32 s27, s27, 16384
  v_exp_f32 v223, v143
  v_mfma_f32_16x16x32_bf16 a[104:107], a[180:183], v[184:187], a[104:107]
  s_add_u32 s25, s25, 32768
  ds_read_b128 a[148:151], v3 offset:13312
  v_add_f32 v227, v227, v220
  v_mfma_f32_16x16x32_bf16 a[108:111], a[180:183], v[188:191], a[108:111]
  s_and_b32 s25, s25, 0x1ffff
  v_add_f32 v227, v227, v221
  v_cvt_pk_bf16_f32 v182, v220, v221
  v_add_f32 v227, v227, v222
  v_mfma_f32_16x16x32_bf16 a[112:115], a[184:187], v[184:187], a[112:115]
  ds_read_b128 a[152:155], v3 offset:14336
  v_add_f32 v227, v227, v223
  v_max_f32 v5, v226, v227
  v_cmp_lt_f32 vcc, s81, v5
  v_mfma_f32_16x16x32_bf16 a[116:119], a[184:187], v[188:191], a[116:119]
  v_exp_f32 v216, v144
  v_mfma_f32_16x16x32_bf16 a[120:123], a[188:191], v[184:187], a[120:123]
  s_waitcnt lgkmcnt(3)
  ds_read_b128 a[156:159], v3 offset:15360
  v_cvt_pk_bf16_f32 v183, v222, v223
  v_add_u32 v3, s66, v2
  v_mfma_f32_16x16x32_bf16 a[124:127], a[188:191], v[188:191], a[124:127]
  s_cbranch_vccnz fa_stub23
fa_back23:
  v_exp_f32 v217, v145
  v_add_f32 v230, v230, v226
  v_add_f32 v231, v231, v227
fa_SSW2:
  v_mfma_f32_16x16x32_bf16 v[128:131], a[128:131], v[64:67], v[200:203]
  s_waitcnt vmcnt(12)
  v_exp_f32 v218, v146
  v_mfma_f32_16x16x32_bf16 v[136:139], a[128:131], v[68:71], v[204:207]
  s_barrier
  v_exp_f32 v219, v147
  v_mfma_f32_16x16x32_bf16 v[132:135], a[132:135], v[64:67], v[200:203]
  ds_read_b128 a[160:163], v3 offset:16384
  ds_read_b128 a[164:167], v3 offset:17408
  v_add_f32 v226, v216, v217
  v_mfma_f32_16x16x32_bf16 v[140:143], a[132:135], v[68:71], v[204:207]
  s_mov_b32 m0, s24
  v_exp_f32 v220, v148
  v_mfma_f32_16x16x32_bf16 v[128:131], a[136:139], v[72:75], v[128:131]
  ds_read_b128 a[168:171], v3 offset:18432
  buffer_load_dwordx4 v2, s[44:47], s26 offen offset:0 sc1 lds
  v_cvt_pk_bf16_f32 v184, v216, v217
  v_mfma_f32_16x16x32_bf16 v[136:139], a[136:139], v[76:79], v[136:139]
  v_exp_f32 v221, v149
  v_mfma_f32_16x16x32_bf16 v[132:135], a[140:143], v[72:75], v[132:135]
  ds_read_b128 a[172:175], v3 offset:19456
  v_add_f32 v226, v226, v218
  v_add_f32 v226, v226, v219
  v_mfma_f32_16x16x32_bf16 v[140:143], a[140:143], v[76:79], v[140:143]
  s_waitcnt lgkmcnt(4)
  v_exp_f32 v222, v150
  v_mfma_f32_16x16x32_bf16 v[128:131], a[144:147], v[80:83], v[128:131]
  s_add_u32 s14, s13, 36864
  ds_read_b128 a[176:179], v3 offset:20480
  buffer_load_dwordx4 v[48:51], v2, s[40:43], s14 offen offset:0 sc1
  v_cvt_pk_bf16_f32 v185, v218, v219
  v_mfma_f32_16x16x32_bf16 v[136:139], a[144:147], v[84:87], v[136:139]
  v_exp_f32 v223, v151
  v_mfma_f32_16x16x32_bf16 v[132:135], a[148:151], v[80:83], v[132:135]
  ds_read_b128 a[180:183], v3 offset:21504
  buffer_load_dwordx4 v2, s[44:47], s26 offen offset:1024 sc1 lds
  v_add_f32 v226, v226, v220
  v_mfma_f32_16x16x32_bf16 v[140:143], a[148:151], v[84:87], v[140:143]
  v_exp_f32 v216, v152
  v_mfma_f32_16x16x32_bf16 v[128:131], a[152:155], v[88:91], v[128:131]
  ds_read_b128 a[184:187], v3 offset:22528
  v_add_f32 v226, v226, v221
  v_cvt_pk_bf16_f32 v186, v220, v221
  v_mfma_f32_16x16x32_bf16 v[136:139], a[152:155], v[92:95], v[136:139]
  v_exp_f32 v217, v153
  v_mfma_f32_16x16x32_bf16 v[132:135], a[156:159], v[88:91], v[132:135]
  ds_read_b128 a[188:191], v3 offset:23552
  buffer_load_dwordx4 v[52:55], v2, s[40:43], s14 offen offset:1024 sc1
  v_add_f32 v226, v226, v222
  v_mfma_f32_16x16x32_bf16 v[140:143], a[156:159], v[92:95], v[140:143]
  s_waitcnt lgkmcnt(4)
  v_exp_f32 v218, v154
  v_mfma_f32_16x16x32_bf16 a[64:67], a[160:163], v[176:179], a[64:67]
  ds_read_b128 a[128:131], v3 offset:0
  v_add_f32 v226, v226, v223
  v_cvt_pk_bf16_f32 v187, v222, v223
  v_mfma_f32_16x16x32_bf16 a[68:71], a[160:163], v[180:183], a[68:71]
  v_exp_f32 v219, v155
  v_mfma_f32_16x16x32_bf16 a[72:75], a[164:167], v[176:179], a[72:75]
  ds_read_b128 a[132:135], v3 offset:1024
  buffer_load_dwordx4 v2, s[44:47], s26 offen offset:2048 sc1 lds
  v_add_f32 v227, v216, v217
  v_mfma_f32_16x16x32_bf16 a[76:79], a[164:167], v[180:183], a[76:79]
  v_exp_f32 v220, v156
  v_mfma_f32_16x16x32_bf16 a[80:83], a[168:171], v[176:179], a[80:83]
  ds_read_b128 a[136:139], v3 offset:2048
  v_cvt_pk_bf16_f32 v188, v216, v217
  v_mfma_f32_16x16x32_bf16 a[84:87], a[168:171], v[180:183], a[84:87]
  v_exp_f32 v221, v157
  v_mfma_f32_16x16x32_bf16 a[88:91], a[172:175], v[176:179], a[88:91]
  ds_read_b128 a[140:143], v3 offset:3072
  buffer_load_dwordx4 v[56:59], v2, s[40:43], s14 offen offset:2048 sc1
  v_add_f32 v227, v227, v218
  v_add_f32 v227, v227, v219
  v_mfma_f32_16x16x32_bf16 a[92:95], a[172:175], v[180:183], a[92:95]
  s_waitcnt lgkmcnt(4)
  v_exp_f32 v222, v158
  v_mfma_f32_16x16x32_bf16 a[96:99], a[176:179], v[176:179], a[96:99]
  ds_read_b128 a[144:147], v3 offset:4096
  buffer_load_dwordx4 v2, s[44:47], s26 offen offset:3072 sc1 lds
  v_cvt_pk_bf16_f32 v189, v218, v219
  v_mfma_f32_16x16x32_bf16 a[100:103], a[176:179], v[180:183], a[100:103]
  s_add_u32 s26, s26, 16384
  v_exp_f32 v223, v159
  v_mfma_f32_16x16x32_bf16 a[104:107], a[180:183], v[176:179], a[104:107]
  s_add_u32 s24, s24, 32768
  ds_read_b128 a[148:151], v3 offset:5120
  v_add_f32 v227, v227, v220
  v_mfma_f32_16x16x32_bf16 a[108:111], a[180:183], v[180:183], a[108:111]
  s_and_b32 s24, s24, 0x1ffff
  v_add_f32 v227, v227, v221
  v_cvt_pk_bf16_f32 v190, v220, v221
  v_add_f32 v227, v227, v222
  v_mfma_f32_16x16x32_bf16 a[112:115], a[184:187], v[176:179], a[112:115]
  ds_read_b128 a[152:155], v3 offset:6144
  v_add_f32 v227, v227, v223
  v_max_f32 v5, v226, v227
  v_cmp_lt_f32 vcc, s81, v5
  v_mfma_f32_16x16x32_bf16 a[116:119], a[184:187], v[180:183], a[116:119]
  v_exp_f32 v216, v128
  v_mfma_f32_16x16x32_bf16 a[120:123], a[188:191], v[176:179], a[120:123]
  s_waitcnt lgkmcnt(3)
  ds_read_b128 a[156:159], v3 offset:7168
  v_cvt_pk_bf16_f32 v191, v222, v223
  v_mfma_f32_16x16x32_bf16 a[124:127], a[188:191], v[180:183], a[124:127]
  s_cbranch_vccnz fa_stub24
fa_back24:
  v_exp_f32 v217, v129
  v_add_f32 v230, v230, v226
  v_add_f32 v231, v231, v227
  v_mfma_f32_16x16x32_bf16 v[144:147], a[128:131], v[64:67], v[200:203]
  ds_read_b128 a[160:163], v3 offset:24576
  v_add_f32 v226, v216, v217
  v_mfma_f32_16x16x32_bf16 v[152:155], a[128:131], v[68:71], v[204:207]
  v_exp_f32 v218, v130
  v_mfma_f32_16x16x32_bf16 v[148:151], a[132:135], v[64:67], v[200:203]
  s_add_u32 s66, s66, 32768
  ds_read_b128 a[164:167], v3 offset:25600
  v_cvt_pk_bf16_f32 v176, v216, v217
  v_mfma_f32_16x16x32_bf16 v[156:159], a[132:135], v[68:71], v[204:207]
  s_mov_b32 m0, s25
  v_exp_f32 v219, v131
  v_mfma_f32_16x16x32_bf16 v[144:147], a[136:139], v[72:75], v[144:147]
  s_and_b32 s66, s66, 0x1ffff
  ds_read_b128 a[168:171], v3 offset:26624
  buffer_load_dwordx4 v2, s[48:51], s27 offen offset:0 sc1 lds
  v_add_f32 v226, v226, v218
  v_add_f32 v226, v226, v219
  v_mfma_f32_16x16x32_bf16 v[152:155], a[136:139], v[76:79], v[152:155]
  v_exp_f32 v220, v132
  v_mfma_f32_16x16x32_bf16 v[148:151], a[140:143], v[72:75], v[148:151]
  ds_read_b128 a[172:175], v3 offset:27648
  v_cvt_pk_bf16_f32 v177, v218, v219
  v_mfma_f32_16x16x32_bf16 v[156:159], a[140:143], v[76:79], v[156:159]
  s_waitcnt lgkmcnt(4)
  v_exp_f32 v221, v133
  v_mfma_f32_16x16x32_bf16 v[144:147], a[144:147], v[80:83], v[144:147]
  s_add_u32 s14, s13, 36864
  ds_read_b128 a[176:179], v3 offset:28672
  buffer_load_dwordx4 v[60:63], v2, s[40:43], s14 offen offset:3072 sc1
  v_add_f32 v226, v226, v220
  v_mfma_f32_16x16x32_bf16 v[152:155], a[144:147], v[84:87], v[152:155]
  v_exp_f32 v222, v134
  v_mfma_f32_16x16x32_bf16 v[148:151], a[148:151], v[80:83], v[148:151]
  ds_read_b128 a[180:183], v3 offset:29696
  buffer_load_dwordx4 v2, s[48:51], s27 offen offset:1024 sc1 lds
  v_add_f32 v226, v226, v221
  v_cvt_pk_bf16_f32 v178, v220, v221
  v_mfma_f32_16x16x32_bf16 v[156:159], a[148:151], v[84:87], v[156:159]
  v_exp_f32 v223, v135
  v_mfma_f32_16x16x32_bf16 v[144:147], a[152:155], v[88:91], v[144:147]
  ds_read_b128 a[184:187], v3 offset:30720
  v_add_f32 v226, v226, v222
  v_mfma_f32_16x16x32_bf16 v[152:155], a[152:155], v[92:95], v[152:155]
  v_exp_f32 v216, v136
  v_mfma_f32_16x16x32_bf16 v[148:151], a[156:159], v[88:91], v[148:151]
  s_add_u32 s14, s13, 40960
  ds_read_b128 a[188:191], v3 offset:31744
  buffer_load_dwordx4 v[96:99], v2, s[40:43], s14 offen offset:0 sc1
  v_add_f32 v226, v226, v223
  v_exp_f32 v217, v137
  v_mfma_f32_16x16x32_bf16 v[156:159], a[156:159], v[92:95], v[156:159]
  s_waitcnt lgkmcnt(4)
  v_exp_f32 v218, v138
  v_mfma_f32_16x16x32_bf16 a[64:67], a[160:163], v[184:187], a[64:67]
  ds_read_b128 a[128:131], v3 offset:8192
  v_cvt_pk_bf16_f32 v179, v222, v223
  v_mfma_f32_16x16x32_bf16 a[68:71], a[160:163], v[188:191], a[68:71]
  v_exp_f32 v219, v139
  v_mfma_f32_16x16x32_bf16 a[72:75], a[164:167], v[184:187], a[72:75]
  ds_read_b128 a[132:135], v3 offset:9216
  buffer_load_dwordx4 v2, s[48:51], s27 offen offset:2048 sc1 lds
  v_add_f32 v227, v216, v217
  v_mfma_f32_16x16x32_bf16 a[76:79], a[164:167], v[188:191], a[76:79]
  v_exp_f32 v220, v140
  v_mfma_f32_16x16x32_bf16 a[80:83], a[168:171], v[184:187], a[80:83]
  ds_read_b128 a[136:139], v3 offset:10240
  v_cvt_pk_bf16_f32 v180, v216, v217
  v_mfma_f32_16x16x32_bf16 a[84:87], a[168:171], v[188:191], a[84:87]
  v_exp_f32 v221, v141
  v_mfma_f32_16x16x32_bf16 a[88:91], a[172:175], v[184:187], a[88:91]
  ds_read_b128 a[140:143], v3 offset:11264
  buffer_load_dwordx4 v[100:103], v2, s[40:43], s14 offen offset:1024 sc1
  v_add_f32 v227, v227, v218
  v_mfma_f32_16x16x32_bf16 a[92:95], a[172:175], v[188:191], a[92:95]
  s_waitcnt lgkmcnt(4)
  v_exp_f32 v222, v142
  v_mfma_f32_16x16x32_bf16 a[96:99], a[176:179], v[184:187], a[96:99]
  ds_read_b128 a[144:147], v3 offset:12288
  buffer_load_dwordx4 v2, s[48:51], s27 offen offset:3072 sc1 lds
  v_add_f32 v227, v227, v219
  v_cvt_pk_bf16_f32 v181, v218, v219
  v_mfma_f32_16x16x32_bf16 a[100:103], a[176:179], v[188:191], a[100:103]
  s_add_u32 s27, s27, 16384
  v_exp_f32 v223, v143
  v_mfma_f32_16x16x32_bf16 a[104:107], a[180:183], v[184:187], a[104:107]
  s_add_u32 s25, s25, 32768
  ds_read_b128 a[148:151], v3 offset:13312
  v_add_f32 v227, v227, v220
  v_mfma_f32_16x16x32_bf16 a[108:111], a[180:183], v[188:191], a[108:111]
  s_and_b32 s25, s25, 0x1ffff
  v_add_f32 v227, v227, v221
  v_cvt_pk_bf16_f32 v182, v220, v221
  v_add_f32 v227, v227, v222
  v_mfma_f32_16x16x32_bf16 a[112:115], a[184:187], v[184:187], a[112:115]
  ds_read_b128 a[152:155], v3 offset:14336
  v_add_f32 v227, v227, v223
  v_max_f32 v5, v226, v227
  v_cmp_lt_f32 vcc, s81, v5
  v_mfma_f32_16x16x32_bf16 a[116:119], a[184:187], v[188:191], a[116:119]
  v_exp_f32 v216, v144
  v_mfma_f32_16x16x32_bf16 a[120:123], a[188:191], v[184:187], a[120:123]
  s_waitcnt lgkmcnt(3)
  ds_read_b128 a[156:159], v3 offset:15360
  v_cvt_pk_bf16_f32 v183, v222, v223
  v_add_u32 v3, s66, v2
  v_mfma_f32_16x16x32_bf16 a[124:127], a[188:191], v[188:191], a[124:127]
  s_cbranch_vccnz fa_stub25
fa_back25:
  v_exp_f32 v217, v145
  v_add_f32 v230, v230, v226
  v_add_f32 v231, v231, v227
fa_SSW1:
  v_mfma_f32_16x16x32_bf16 v[128:131], a[128:131], v[64:67], v[200:203]
  s_waitcnt vmcnt(12)
  v_exp_f32 v218, v146
  v_mfma_f32_16x16x32_bf16 v[136:139], a[128:131], v[68:71], v[204:207]
  s_barrier
  v_exp_f32 v219, v147
  v_mfma_f32_16x16x32_bf16 v[132:135], a[132:135], v[64:67], v[200:203]
  ds_read_b128 a[160:163], v3 offset:16384
  ds_read_b128 a[164:167], v3 offset:17408
  v_add_f32 v226, v216, v217
  v_mfma_f32_16x16x32_bf16 v[140:143], a[132:135], v[68:71], v[204:207]
  s_mov_b32 m0, s24
  v_exp_f32 v220, v148
  v_mfma_f32_16x16x32_bf16 v[128:131], a[136:139], v[72:75], v[128:131]
  ds_read_b128 a[168:171], v3 offset:18432
  buffer_load_dwordx4 v2, s[44:47], s26 offen offset:0 sc1 lds
  v_cvt_pk_bf16_f32 v184, v216, v217
  v_mfma_f32_16x16x32_bf16 v[136:139], a[136:139], v[76:79], v[136:139]
  v_exp_f32 v221, v149
  v_mfma_f32_16x16x32_bf16 v[132:135], a[140:143], v[72:75], v[132:135]
  ds_read_b128 a[172:175], v3 offset:19456
  v_add_f32 v226, v226, v218
  v_add_f32 v226, v226, v219
  v_mfma_f32_16x16x32_bf16 v[140:143], a[140:143], v[76:79], v[140:143]
  s_waitcnt lgkmcnt(4)
  v_exp_f32 v222, v150
  v_mfma_f32_16x16x32_bf16 v[128:131], a[144:147], v[80:83], v[128:131]
  s_add_u32 s14, s13, 40960
  ds_read_b128 a[176:179], v3 offset:20480
  buffer_load_dwordx4 v[104:107], v2, s[40:43], s14 offen offset:2048 sc1
  v_cvt_pk_bf16_f32 v185, v218, v219
  v_mfma_f32_16x16x32_bf16 v[136:139], a[144:147], v[84:87], v[136:139]
  v_exp_f32 v223, v151
  v_mfma_f32_16x16x32_bf16 v[132:135], a[148:151], v[80:83], v[132:135]
  ds_read_b128 a[180:183], v3 offset:21504
  buffer_load_dwordx4 v2, s[44:47], s26 offen offset:1024 sc1 lds
  v_add_f32 v226, v226, v220
  v_mfma_f32_16x16x32_bf16 v[140:143], a[148:151], v[84:87], v[140:143]
  v_exp_f32 v216, v152
  v_mfma_f32_16x16x32_bf16 v[128:131], a[152:155], v[88:91], v[128:131]
  ds_read_b128 a[184:187], v3 offset:22528
  v_add_f32 v226, v226, v221
  v_cvt_pk_bf16_f32 v186, v220, v221
  v_mfma_f32_16x16x32_bf16 v[136:139], a[152:155], v[92:95], v[136:139]
  v_exp_f32 v217, v153
  v_mfma_f32_16x16x32_bf16 v[132:135], a[156:159], v[88:91], v[132:135]
  ds_read_b128 a[188:191], v3 offset:23552
  buffer_load_dwordx4 v[108:111], v2, s[40:43], s14 offen offset:3072 sc1
  v_add_f32 v226, v226, v222
  v_mfma_f32_16x16x32_bf16 v[140:143], a[156:159], v[92:95], v[140:143]
  s_waitcnt lgkmcnt(4)
  v_exp_f32 v218, v154
  v_mfma_f32_16x16x32_bf16 a[64:67], a[160:163], v[176:179], a[64:67]
  ds_read_b128 a[128:131], v3 offset:0
  v_add_f32 v226, v226, v223
  v_cvt_pk_bf16_f32 v187, v222, v223
  v_mfma_f32_16x16x32_bf16 a[68:71], a[160:163], v[180:183], a[68:71]
  v_exp_f32 v219, v155
  v_mfma_f32_16x16x32_bf16 a[72:75], a[164:167], v[176:179], a[72:75]
  ds_read_b128 a[132:135], v3 offset:1024
  buffer_load_dwordx4 v2, s[44:47], s26 offen offset:2048 sc1 lds
  v_add_f32 v227, v216, v217
  v_mfma_f32_16x16x32_bf16 a[76:79], a[164:167], v[180:183], a[76:79]
  v_exp_f32 v220, v156
  v_mfma_f32_16x16x32_bf16 a[80:83], a[168:171], v[176:179], a[80:83]
  ds_read_b128 a[136:139], v3 offset:2048
  v_cvt_pk_bf16_f32 v188, v216, v217
  v_mfma_f32_16x16x32_bf16 a[84:87], a[168:171], v[180:183], a[84:87]
  v_exp_f32 v221, v157
  v_mfma_f32_16x16x32_bf16 a[88:91], a[172:175], v[176:179], a[88:91]
  s_add_u32 s14, s13, 45056
  ds_read_b128 a[140:143], v3 offset:3072
  buffer_load_dwordx4 v[112:115], v2, s[40:43], s14 offen offset:0 sc1
  v_add_f32 v227, v227, v218
  v_add_f32 v227, v227, v219
  v_mfma_f32_16x16x32_bf16 a[92:95], a[172:175], v[180:183], a[92:95]
  s_waitcnt lgkmcnt(4)
  v_exp_f32 v222, v158
  v_mfma_f32_16x16x32_bf16 a[96:99], a[176:179], v[176:179], a[96:99]
  ds_read_b128 a[144:147], v3 offset:4096
  buffer_load_dwordx4 v2, s[44:47], s26 offen offset:3072 sc1 lds
  v_cvt_pk_bf16_f32 v189, v218, v219
  v_mfma_f32_16x16x32_bf16 a[100:103], a[176:179], v[180:183], a[100:103]
  s_add_u32 s26, s26, 16384
  v_exp_f32 v223, v159
  v_mfma_f32_16x16x32_bf16 a[104:107], a[180:183], v[176:179], a[104:107]
  s_add_u32 s24, s24, 32768
  ds_read_b128 a[148:151], v3 offset:5120
  v_add_f32 v227, v227, v220
  v_mfma_f32_16x16x32_bf16 a[108:111], a[180:183], v[180:183], a[108:111]
  s_and_b32 s24, s24, 0x1ffff
  v_add_f32 v227, v227, v221
  v_cvt_pk_bf16_f32 v190, v220, v221
  v_add_f32 v227, v227, v222
  v_mfma_f32_16x16x32_bf16 a[112:115], a[184:187], v[176:179], a[112:115]
  ds_read_b128 a[152:155], v3 offset:6144
  v_add_f32 v227, v227, v223
  v_max_f32 v5, v226, v227
  v_cmp_lt_f32 vcc, s81, v5
  v_mfma_f32_16x16x32_bf16 a[116:119], a[184:187], v[180:183], a[116:119]
  v_exp_f32 v216, v128
  v_mfma_f32_16x16x32_bf16 a[120:123], a[188:191], v[176:179], a[120:123]
  s_waitcnt lgkmcnt(3)
  ds_read_b128 a[156:159], v3 offset:7168
  v_cvt_pk_bf16_f32 v191, v222, v223
  v_mfma_f32_16x16x32_bf16 a[124:127], a[188:191], v[180:183], a[124:127]
  s_cbranch_vccnz fa_stub26
fa_back26:
  v_exp_f32 v217, v129
  v_add_f32 v230, v230, v226
  v_add_f32 v231, v231, v227
  v_mfma_f32_16x16x32_bf16 v[144:147], a[128:131], v[64:67], v[200:203]
  ds_read_b128 a[160:163], v3 offset:24576
  v_add_f32 v226, v216, v217
  v_mfma_f32_16x16x32_bf16 v[152:155], a[128:131], v[68:71], v[204:207]
  v_exp_f32 v218, v130
  v_mfma_f32_16x16x32_bf16 v[148:151], a[132:135], v[64:67], v[200:203]
  s_add_u32 s66, s66, 32768
  ds_read_b128 a[164:167], v3 offset:25600
  v_cvt_pk_bf16_f32 v176, v216, v217
  v_mfma_f32_16x16x32_bf16 v[156:159], a[132:135], v[68:71], v[204:207]
  s_mov_b32 m0, s25
  v_exp_f32 v219, v131
  v_mfma_f32_16x16x32_bf16 v[144:147], a[136:139], v[72:75], v[144:147]
  s_and_b32 s66, s66, 0x1ffff
  ds_read_b128 a[168:171], v3 offset:26624
  buffer_load_dwordx4 v2, s[48:51], s27 offen offset:0 sc1 lds
  v_add_f32 v226, v226, v218
  v_add_f32 v226, v226, v219
  v_mfma_f32_16x16x32_bf16 v[152:155], a[136:139], v[76:79], v[152:155]
  v_exp_f32 v220, v132
  v_mfma_f32_16x16x32_bf16 v[148:151], a[140:143], v[72:75], v[148:151]
  ds_read_b128 a[172:175], v3 offset:27648
  v_cvt_pk_bf16_f32 v177, v218, v219
  v_mfma_f32_16x16x32_bf16 v[156:159], a[140:143], v[76:79], v[156:159]
  s_waitcnt lgkmcnt(4)
  v_exp_f32 v221, v133
  v_mfma_f32_16x16x32_bf16 v[144:147], a[144:147], v[80:83], v[144:147]
  s_add_u32 s14, s13, 45056
  ds_read_b128 a[176:179], v3 offset:28672
  buffer_load_dwordx4 v[116:119], v2, s[40:43], s14 offen offset:1024 sc1
  v_add_f32 v226, v226, v220
  v_mfma_f32_16x16x32_bf16 v[152:155], a[144:147], v[84:87], v[152:155]
  v_exp_f32 v222, v134
  v_mfma_f32_16x16x32_bf16 v[148:151], a[148:151], v[80:83], v[148:151]
  ds_read_b128 a[180:183], v3 offset:29696
  buffer_load_dwordx4 v2, s[48:51], s27 offen offset:1024 sc1 lds
  v_add_f32 v226, v226, v221
  v_cvt_pk_bf16_f32 v178, v220, v221
  v_mfma_f32_16x16x32_bf16 v[156:159], a[148:151], v[84:87], v[156:159]
  v_exp_f32 v223, v135
  v_mfma_f32_16x16x32_bf16 v[144:147], a[152:155], v[88:91], v[144:147]
  ds_read_b128 a[184:187], v3 offset:30720
  v_add_f32 v226, v226, v222
  v_mfma_f32_16x16x32_bf16 v[152:155], a[152:155], v[92:95], v[152:155]
  v_exp_f32 v216, v136
  v_mfma_f32_16x16x32_bf16 v[148:151], a[156:159], v[88:91], v[148:151]
  ds_read_b128 a[188:191], v3 offset:31744
  buffer_load_dwordx4 v[120:123], v2, s[40:43], s14 offen offset:2048 sc1
  v_add_f32 v226, v226, v223
  v_exp_f32 v217, v137
  v_mfma_f32_16x16x32_bf16 v[156:159], a[156:159], v[92:95], v[156:159]
  s_waitcnt lgkmcnt(4)
  v_exp_f32 v218, v138
  v_mfma_f32_16x16x32_bf16 a[64:67], a[160:163], v[184:187], a[64:67]
  ds_read_b128 a[128:131], v3 offset:8192
  v_cvt_pk_bf16_f32 v179, v222, v223
  v_mfma_f32_16x16x32_bf16 a[68:71], a[160:163], v[188:191], a[68:71]
  v_exp_f32 v219, v139
  v_mfma_f32_16x16x32_bf16 a[72:75], a[164:167], v[184:187], a[72:75]
  ds_read_b128 a[132:135], v3 offset:9216
  buffer_load_dwordx4 v2, s[48:51], s27 offen offset:2048 sc1 lds
  v_add_f32 v227, v216, v217
  v_mfma_f32_16x16x32_bf16 a[76:79], a[164:167], v[188:191], a[76:79]
  v_exp_f32 v220, v140
  v_mfma_f32_16x16x32_bf16 a[80:83], a[168:171], v[184:187], a[80:83]
  ds_read_b128 a[136:139], v3 offset:10240
  v_cvt_pk_bf16_f32 v180, v216, v217
  v_mfma_f32_16x16x32_bf16 a[84:87], a[168:171], v[188:191], a[84:87]
  v_exp_f32 v221, v141
  v_mfma_f32_16x16x32_bf16 a[88:91], a[172:175], v[184:187], a[88:91]
  ds_read_b128 a[140:143], v3 offset:11264
  buffer_load_dwordx4 v[124:127], v2, s[40:43], s14 offen offset:3072 sc1
  v_add_f32 v227, v227, v218
  v_mfma_f32_16x16x32_bf16 a[92:95], a[172:175], v[188:191], a[92:95]
  s_waitcnt lgkmcnt(4)
  v_exp_f32 v222, v142
  v_mfma_f32_16x16x32_bf16 a[96:99], a[176:179], v[184:187], a[96:99]
  ds_read_b128 a[144:147], v3 offset:12288
  buffer_load_dwordx4 v2, s[48:51], s27 offen offset:3072 sc1 lds
  v_add_f32 v227, v227, v219
  v_cvt_pk_bf16_f32 v181, v218, v219
  v_mfma_f32_16x16x32_bf16 a[100:103], a[176:179], v[188:191], a[100:103]
  s_add_u32 s27, s27, 16384
  v_exp_f32 v223, v143
  v_mfma_f32_16x16x32_bf16 a[104:107], a[180:183], v[184:187], a[104:107]
  s_add_u32 s25, s25, 32768
  ds_read_b128 a[148:151], v3 offset:13312
  v_add_f32 v227, v227, v220
  v_mfma_f32_16x16x32_bf16 a[108:111], a[180:183], v[188:191], a[108:111]
  s_and_b32 s25, s25, 0x1ffff
  v_add_f32 v227, v227, v221
  v_cvt_pk_bf16_f32 v182, v220, v221
  v_add_f32 v227, v227, v222
  v_mfma_f32_16x16x32_bf16 a[112:115], a[184:187], v[184:187], a[112:115]
  ds_read_b128 a[152:155], v3 offset:14336
  v_add_f32 v227, v227, v223
  v_max_f32 v5, v226, v227
  v_cmp_lt_f32 vcc, s81, v5
  v_mfma_f32_16x16x32_bf16 a[116:119], a[184:187], v[188:191], a[116:119]
  v_exp_f32 v216, v144
  v_mfma_f32_16x16x32_bf16 a[120:123], a[188:191], v[184:187], a[120:123]
  s_waitcnt lgkmcnt(3)
  ds_read_b128 a[156:159], v3 offset:15360
  v_cvt_pk_bf16_f32 v183, v222, v223
  v_add_u32 v3, s66, v2
  v_mfma_f32_16x16x32_bf16 a[124:127], a[188:191], v[188:191], a[124:127]
  s_cbranch_vccnz fa_stub27
fa_back27:
  v_exp_f32 v217, v145
  v_add_f32 v230, v230, v226
  v_add_f32 v231, v231, v227
fa_Bexit:
  s_bitcmp1_b32 s20, 0
  s_cbranch_scc1 fa_Bodd
  v_mfma_f32_16x16x32_bf16 v[128:131], a[128:131], v[64:67], v[200:203]
  s_waitcnt vmcnt(0)
  v_exp_f32 v218, v146
  v_mfma_f32_16x16x32_bf16 v[136:139], a[128:131], v[68:71], v[204:207]
  s_barrier
  v_exp_f32 v219, v147
  v_mfma_f32_16x16x32_bf16 v[132:135], a[132:135], v[64:67], v[200:203]
  ds_read_b128 a[160:163], v3 offset:16384
  ds_read_b128 a[164:167], v3 offset:17408
  v_add_f32 v226, v216, v217
  v_mfma_f32_16x16x32_bf16 v[140:143], a[132:135], v[68:71], v[204:207]
  s_add_u32 s14, s13, 49152
  buffer_load_dwordx4 v[160:163], v2, s[40:43], s14 offen offset:0 sc1
  v_cvt_pk_bf16_f32 v184, v216, v217
  v_mfma_f32_16x16x32_bf16 v[128:131], a[136:139], v[72:75], v[128:131]
  ds_read_b128 a[168:171], v3 offset:18432
  v_add_f32 v226, v226, v218
  v_mfma_f32_16x16x32_bf16 v[136:139], a[136:139], v[76:79], v[136:139]
  v_exp_f32 v220, v148
  v_mfma_f32_16x16x32_bf16 v[132:135], a[140:143], v[72:75], v[132:135]
  ds_read_b128 a[172:175], v3 offset:19456
  v_add_f32 v226, v226, v219
  v_cvt_pk_bf16_f32 v185, v218, v219
  v_mfma_f32_16x16x32_bf16 v[140:143], a[140:143], v[76:79], v[140:143]
  s_waitcnt lgkmcnt(4)
  buffer_load_dwordx4 v[164:167], v2, s[40:43], s14 offen offset:1024 sc1
  v_add_f32 v226, v226, v220
  v_mfma_f32_16x16x32_bf16 v[128:131], a[144:147], v[80:83], v[128:131]
  ds_read_b128 a[176:179], v3 offset:20480
  v_mfma_f32_16x16x32_bf16 v[136:139], a[144:147], v[84:87], v[136:139]
  v_exp_f32 v221, v149
  v_mfma_f32_16x16x32_bf16 v[132:135], a[148:151], v[80:83], v[132:135]
  ds_read_b128 a[180:183], v3 offset:21504
  v_add_f32 v226, v226, v221
  v_mfma_f32_16x16x32_bf16 v[140:143], a[148:151], v[84:87], v[140:143]
  v_exp_f32 v222, v150
  v_mfma_f32_16x16x32_bf16 v[128:131], a[152:155], v[88:91], v[128:131]
  ds_read_b128 a[184:187], v3 offset:22528
  buffer_load_dwordx4 v[168:171], v2, s[40:43], s14 offen offset:2048 sc1
  v_cvt_pk_bf16_f32 v186, v220, v221
  v_mfma_f32_16x16x32_bf16 v[136:139], a[152:155], v[92:95], v[136:139]
  v_exp_f32 v223, v151
  v_mfma_f32_16x16x32_bf16 v[132:135], a[156:159], v[88:91], v[132:135]
  ds_read_b128 a[188:191], v3 offset:23552
  v_add_f32 v226, v226, v222
  v_add_f32 v226, v226, v223
  v_mfma_f32_16x16x32_bf16 v[140:143], a[156:159], v[92:95], v[140:143]
  s_waitcnt lgkmcnt(4)
  v_exp_f32 v216, v152
  v_mfma_f32_16x16x32_bf16 a[64:67], a[160:163], v[176:179], a[64:67]
  v_exp_f32 v217, v153
  v_mfma_f32_16x16x32_bf16 a[68:71], a[160:163], v[180:183], a[68:71]
  buffer_load_dwordx4 v[172:175], v2, s[40:43], s14 offen offset:3072 sc1
  v_cvt_pk_bf16_f32 v187, v222, v223
  v_add_f32 v227, v216, v217
  v_mfma_f32_16x16x32_bf16 a[72:75], a[164:167], v[176:179], a[72:75]
  v_exp_f32 v218, v154
  v_mfma_f32_16x16x32_bf16 a[76:79], a[164:167], v[180:183], a[76:79]
  v_exp_f32 v219, v155
  v_mfma_f32_16x16x32_bf16 a[80:83], a[168:171], v[176:179], a[80:83]
  v_exp_f32 v220, v156
  v_mfma_f32_16x16x32_bf16 a[84:87], a[168:171], v[180:183], a[84:87]
  s_add_u32 s14, s13, 53248
  buffer_load_dwordx4 v[192:195], v2, s[40:43], s14 offen offset:0 sc1
  v_cvt_pk_bf16_f32 v188, v216, v217
  v_add_f32 v227, v227, v218
  v_mfma_f32_16x16x32_bf16 a[88:91], a[172:175], v[176:179], a[88:91]
  v_exp_f32 v221, v157
  v_mfma_f32_16x16x32_bf16 a[92:95], a[172:175], v[180:183], a[92:95]
  s_waitcnt lgkmcnt(0)
  v_exp_f32 v222, v158
  v_mfma_f32_16x16x32_bf16 a[96:99], a[176:179], v[176:179], a[96:99]
  v_add_f32 v227, v227, v219
  v_cvt_pk_bf16_f32 v189, v218, v219
  v_mfma_f32_16x16x32_bf16 a[100:103], a[176:179], v[180:183], a[100:103]
  v_exp_f32 v223, v159
  v_mfma_f32_16x16x32_bf16 a[104:107], a[180:183], v[176:179], a[104:107]
  buffer_load_dwordx4 v[196:199], v2, s[40:43], s14 offen offset:1024 sc1
  v_add_f32 v227, v227, v220
  v_mfma_f32_16x16x32_bf16 a[108:111], a[180:183], v[180:183], a[108:111]
  v_add_f32 v227, v227, v221
  v_cvt_pk_bf16_f32 v190, v220, v221
  v_add_f32 v227, v227, v222
  v_mfma_f32_16x16x32_bf16 a[112:115], a[184:187], v[176:179], a[112:115]
  v_add_f32 v227, v227, v223
  v_max_f32 v5, v226, v227
  v_cmp_lt_f32 vcc, s81, v5
  v_mfma_f32_16x16x32_bf16 a[116:119], a[184:187], v[180:183], a[116:119]
  v_exp_f32 v216, v128
  v_mfma_f32_16x16x32_bf16 a[120:123], a[188:191], v[176:179], a[120:123]
  v_cvt_pk_bf16_f32 v191, v222, v223
  v_mfma_f32_16x16x32_bf16 a[124:127], a[188:191], v[180:183], a[124:127]
  s_cbranch_vccnz fa_stub28
fa_back28:
  v_exp_f32 v217, v129
  v_add_f32 v230, v230, v226
  v_add_f32 v231, v231, v227
  ds_read_b128 a[160:163], v3 offset:24576
  ds_read_b128 a[164:167], v3 offset:25600
  ds_read_b128 a[168:171], v3 offset:26624
  ds_read_b128 a[172:175], v3 offset:27648
  ds_read_b128 a[176:179], v3 offset:28672
  ds_read_b128 a[180:183], v3 offset:29696
  ds_read_b128 a[184:187], v3 offset:30720
  ds_read_b128 a[188:191], v3 offset:31744
  v_cndmask_b32 v128, v4, v128, s[68:69]
  v_cndmask_b32 v129, v4, v129, s[70:71]
  v_cndmask_b32 v130, v4, v130, s[72:73]
  v_cndmask_b32 v131, v4, v131, s[74:75]
  v_mov_b32 v132, v4
  v_mov_b32 v133, v4
  v_mov_b32 v134, v4
  v_mov_b32 v135, v4
  v_cndmask_b32 v140, v4, v140, s[68:69]
  v_cndmask_b32 v141, v4, v141, s[70:71]
  v_cndmask_b32 v142, v4, v142, s[72:73]
  v_cndmask_b32 v143, v4, v143, s[74:75]
  v_exp_f32 v216, v128
  v_exp_f32 v217, v129
  v_exp_f32 v218, v130
  v_add_f32 v226, v216, v217
  v_cvt_pk_bf16_f32 v176, v216, v217
  v_add_f32 v226, v226, v218
  v_exp_f32 v219, v131
  v_exp_f32 v220, v132
  v_add_f32 v226, v226, v219
  v_cvt_pk_bf16_f32 v177, v218, v219
  v_add_f32 v226, v226, v220
  v_exp_f32 v221, v133
  s_waitcnt lgkmcnt(4)
  v_mfma_f32_16x16x32_bf16 a[64:67], a[160:163], v[184:187], a[64:67]
  v_exp_f32 v222, v134
  v_add_f32 v226, v226, v221
  v_mfma_f32_16x16x32_bf16 a[68:71], a[160:163], v[188:191], a[68:71]
  s_add_u32 s14, s13, 53248
  buffer_load_dwordx4 v[208:211], v2, s[40:43], s14 offen offset:2048 sc1
  v_exp_f32 v223, v135
  v_mfma_f32_16x16x32_bf16 a[72:75], a[164:167], v[184:187], a[72:75]
  s_add_u32 s66, s66, 32768
  v_exp_f32 v216, v136
  v_mfma_f32_16x16x32_bf16 a[76:79], a[164:167], v[188:191], a[76:79]
  s_and_b32 s66, s66, 0x1ffff
  v_exp_f32 v217, v137
  v_mfma_f32_16x16x32_bf16 a[80:83], a[168:171], v[184:187], a[80:83]
  buffer_load_dwordx4 v[212:215], v2, s[40:43], s14 offen offset:3072 sc1
  v_cvt_pk_bf16_f32 v178, v220, v221
  v_add_f32 v226, v226, v222
  v_add_f32 v226, v226, v223
  v_cvt_pk_bf16_f32 v179, v222, v223
  v_mfma_f32_16x16x32_bf16 a[84:87], a[168:171], v[188:191], a[84:87]
  v_exp_f32 v218, v138
  v_mfma_f32_16x16x32_bf16 a[88:91], a[172:175], v[184:187], a[88:91]
  v_exp_f32 v219, v139
  v_mfma_f32_16x16x32_bf16 a[92:95], a[172:175], v[188:191], a[92:95]
  s_waitcnt lgkmcnt(0)
  v_exp_f32 v220, v140
  v_mfma_f32_16x16x32_bf16 a[96:99], a[176:179], v[184:187], a[96:99]
  s_add_u32 s14, s13, 57344
  buffer_load_dwordx4 v[232:235], v2, s[40:43], s14 offen offset:0 sc1
  v_add_f32 v227, v216, v217
  v_cvt_pk_bf16_f32 v180, v216, v217
  v_add_f32 v227, v227, v218
  v_add_f32 v227, v227, v219
  v_cvt_pk_bf16_f32 v181, v218, v219
  v_exp_f32 v221, v141
  v_mfma_f32_16x16x32_bf16 a[100:103], a[176:179], v[188:191], a[100:103]
  v_exp_f32 v222, v142
  v_mfma_f32_16x16x32_bf16 a[104:107], a[180:183], v[184:187], a[104:107]
  v_exp_f32 v223, v143
  v_mfma_f32_16x16x32_bf16 a[108:111], a[180:183], v[188:191], a[108:111]
  buffer_load_dwordx4 v[236:239], v2, s[40:43], s14 offen offset:1024 sc1
  v_add_f32 v227, v227, v220
  v_add_f32 v227, v227, v221
  v_cvt_pk_bf16_f32 v182, v220, v221
  v_add_f32 v227, v227, v222
  v_mfma_f32_16x16x32_bf16 a[112:115], a[184:187], v[184:187], a[112:115]
  v_add_f32 v227, v227, v223
  v_max_f32 v5, v226, v227
  v_cmp_lt_f32 vcc, s81, v5
  v_mfma_f32_16x16x32_bf16 a[116:119], a[184:187], v[188:191], a[116:119]
  v_mfma_f32_16x16x32_bf16 a[120:123], a[188:191], v[184:187], a[120:123]
  v_cvt_pk_bf16_f32 v183, v222, v223
  v_add_u32 v3, s66, v2
  v_mfma_f32_16x16x32_bf16 a[124:127], a[188:191], v[188:191], a[124:127]
  s_cbranch_vccnz fa_stub29
fa_back29:
  v_add_f32 v230, v230, v226
  v_add_f32 v231, v231, v227
  s_waitcnt vmcnt(10)
  s_barrier
  ds_read_b128 a[160:163], v3 offset:16384
  ds_read_b128 a[164:167], v3 offset:17408
  ds_read_b128 a[168:171], v3 offset:18432
  ds_read_b128 a[172:175], v3 offset:19456
  ds_read_b128 a[176:179], v3 offset:20480
  ds_read_b128 a[180:183], v3 offset:21504
  ds_read_b128 a[184:187], v3 offset:22528
  ds_read_b128 a[188:191], v3 offset:23552
  s_waitcnt lgkmcnt(4)
  v_mfma_f32_16x16x32_bf16 a[64:67], a[160:163], v[176:179], a[64:67]
  v_mfma_f32_16x16x32_bf16 a[68:71], a[160:163], v[180:183], a[68:71]
  s_add_u32 s14, s13, 57344
  buffer_load_dwordx4 v[240:243], v2, s[40:43], s14 offen offset:2048 sc1
  v_mfma_f32_16x16x32_bf16 a[72:75], a[164:167], v[176:179], a[72:75]
  v_mfma_f32_16x16x32_bf16 a[76:79], a[164:167], v[180:183], a[76:79]
  v_mfma_f32_16x16x32_bf16 a[80:83], a[168:171], v[176:179], a[80:83]
  v_mfma_f32_16x16x32_bf16 a[84:87], a[168:171], v[180:183], a[84:87]
  v_mfma_f32_16x16x32_bf16 a[88:91], a[172:175], v[176:179], a[88:91]
  v_mfma_f32_16x16x32_bf16 a[92:95], a[172:175], v[180:183], a[92:95]
  s_waitcnt lgkmcnt(0)
  v_mfma_f32_16x16x32_bf16 a[96:99], a[176:179], v[176:179], a[96:99]
  buffer_load_dwordx4 v[244:247], v2, s[40:43], s14 offen offset:3072 sc1
  v_mfma_f32_16x16x32_bf16 a[100:103], a[176:179], v[180:183], a[100:103]
  v_mfma_f32_16x16x32_bf16 a[104:107], a[180:183], v[176:179], a[104:107]
  v_mfma_f32_16x16x32_bf16 a[108:111], a[180:183], v[180:183], a[108:111]
  v_mfma_f32_16x16x32_bf16 a[112:115], a[184:187], v[176:179], a[112:115]
  v_mfma_f32_16x16x32_bf16 a[116:119], a[184:187], v[180:183], a[116:119]
  v_mfma_f32_16x16x32_bf16 a[120:123], a[188:191], v[176:179], a[120:123]
  v_mfma_f32_16x16x32_bf16 a[124:127], a[188:191], v[180:183], a[124:127]
  s_branch fa_Bdone
fa_Bodd:
  s_waitcnt vmcnt(0)
  s_barrier
  ds_read_b128 a[160:163], v3 offset:16384
  ds_read_b128 a[164:167], v3 offset:17408
  ds_read_b128 a[168:171], v3 offset:18432
  ds_read_b128 a[172:175], v3 offset:19456
  ds_read_b128 a[176:179], v3 offset:20480
  ds_read_b128 a[180:183], v3 offset:21504
  ds_read_b128 a[184:187], v3 offset:22528
  ds_read_b128 a[188:191], v3 offset:23552
  v_cndmask_b32 v144, v4, v144, s[68:69]
  v_cndmask_b32 v145, v4, v145, s[70:71]
  v_cndmask_b32 v146, v4, v146, s[72:73]
  v_cndmask_b32 v147, v4, v147, s[74:75]
  v_mov_b32 v148, v4
  v_mov_b32 v149, v4
  v_mov_b32 v150, v4
  v_mov_b32 v151, v4
  v_cndmask_b32 v156, v4, v156, s[68:69]
  v_cndmask_b32 v157, v4, v157, s[70:71]
  v_cndmask_b32 v158, v4, v158, s[72:73]
  v_cndmask_b32 v159, v4, v159, s[74:75]
  v_exp_f32 v216, v144
  v_exp_f32 v217, v145
  v_exp_f32 v218, v146
  v_add_f32 v226, v216, v217
  v_cvt_pk_bf16_f32 v184, v216, v217
  v_add_f32 v226, v226, v218
  v_exp_f32 v219, v147
  v_exp_f32 v220, v148
  v_add_f32 v226, v226, v219
  v_cvt_pk_bf16_f32 v185, v218, v219
  v_add_f32 v226, v226, v220
  v_exp_f32 v221, v149
  s_waitcnt lgkmcnt(4)
  v_mfma_f32_16x16x32_bf16 a[64:67], a[160:163], v[176:179], a[64:67]
  v_exp_f32 v222, v150
  v_add_f32 v226, v226, v221
  v_mfma_f32_16x16x32_bf16 a[68:71], a[160:163], v[180:183], a[68:71]
  s_add_u32 s14, s13, 49152
  buffer_load_dwordx4 v[160:163], v2, s[40:43], s14 offen offset:0 sc1
  v_exp_f32 v223, v151
  v_mfma_f32_16x16x32_bf16 a[72:75], a[164:167], v[176:179], a[72:75]
  v_exp_f32 v216, v152
  v_cvt_pk_bf16_f32 v186, v220, v221
  v_add_f32 v226, v226, v222
  v_mfma_f32_16x16x32_bf16 a[76:79], a[164:167], v[180:183], a[76:79]
  buffer_load_dwordx4 v[164:167], v2, s[40:43], s14 offen offset:1024 sc1
  v_exp_f32 v217, v153
  v_mfma_f32_16x16x32_bf16 a[80:83], a[168:171], v[176:179], a[80:83]
  v_exp_f32 v218, v154
  v_add_f32 v226, v226, v223
  v_mfma_f32_16x16x32_bf16 a[84:87], a[168:171], v[180:183], a[84:87]
  buffer_load_dwordx4 v[168:171], v2, s[40:43], s14 offen offset:2048 sc1
  v_exp_f32 v219, v155
  v_cvt_pk_bf16_f32 v187, v222, v223
  v_mfma_f32_16x16x32_bf16 a[88:91], a[172:175], v[176:179], a[88:91]
  v_exp_f32 v220, v156
  v_mfma_f32_16x16x32_bf16 a[92:95], a[172:175], v[180:183], a[92:95]
  s_waitcnt lgkmcnt(0)
  buffer_load_dwordx4 v[172:175], v2, s[40:43], s14 offen offset:3072 sc1
  v_add_f32 v227, v216, v217
  v_cvt_pk_bf16_f32 v188, v216, v217
  v_add_f32 v227, v227, v218
  v_mfma_f32_16x16x32_bf16 a[96:99], a[176:179], v[176:179], a[96:99]
  v_exp_f32 v221, v157
  v_mfma_f32_16x16x32_bf16 a[100:103], a[176:179], v[180:183], a[100:103]
  s_add_u32 s14, s13, 53248
  buffer_load_dwordx4 v[192:195], v2, s[40:43], s14 offen offset:0 sc1
  v_exp_f32 v222, v158
  v_mfma_f32_16x16x32_bf16 a[104:107], a[180:183], v[176:179], a[104:107]
  v_exp_f32 v223, v159
  v_mfma_f32_16x16x32_bf16 a[108:111], a[180:183], v[180:183], a[108:111]
  buffer_load_dwordx4 v[196:199], v2, s[40:43], s14 offen offset:1024 sc1
  v_add_f32 v227, v227, v219
  v_cvt_pk_bf16_f32 v189, v218, v219
  v_add_f32 v227, v227, v220
  v_add_f32 v227, v227, v221
  v_cvt_pk_bf16_f32 v190, v220, v221
  v_add_f32 v227, v227, v222
  v_mfma_f32_16x16x32_bf16 a[112:115], a[184:187], v[176:179], a[112:115]
  v_add_f32 v227, v227, v223
  v_max_f32 v5, v226, v227
  v_cmp_lt_f32 vcc, s81, v5
  v_mfma_f32_16x16x32_bf16 a[116:119], a[184:187], v[180:183], a[116:119]
  buffer_load_dwordx4 v[208:211], v2, s[40:43], s14 offen offset:2048 sc1
  v_mfma_f32_16x16x32_bf16 a[120:123], a[188:191], v[176:179], a[120:123]
  v_cvt_pk_bf16_f32 v191, v222, v223
  v_mfma_f32_16x16x32_bf16 a[124:127], a[188:191], v[180:183], a[124:127]
  s_cbranch_vccnz fa_stub30
fa_back30:
  v_add_f32 v230, v230, v226
  v_add_f32 v231, v231, v227
  ds_read_b128 a[160:163], v3 offset:24576
  ds_read_b128 a[164:167], v3 offset:25600
  ds_read_b128 a[168:171], v3 offset:26624
  ds_read_b128 a[172:175], v3 offset:27648
  ds_read_b128 a[176:179], v3 offset:28672
  ds_read_b128 a[180:183], v3 offset:29696
  ds_read_b128 a[184:187], v3 offset:30720
  ds_read_b128 a[188:191], v3 offset:31744
  s_waitcnt lgkmcnt(4)
  v_mfma_f32_16x16x32_bf16 a[64:67], a[160:163], v[184:187], a[64:67]
  v_mfma_f32_16x16x32_bf16 a[68:71], a[160:163], v[188:191], a[68:71]
  s_add_u32 s14, s13, 53248
  buffer_load_dwordx4 v[212:215], v2, s[40:43], s14 offen offset:3072 sc1
  v_mfma_f32_16x16x32_bf16 a[72:75], a[164:167], v[184:187], a[72:75]
  s_add_u32 s66, s66, 32768
  v_mfma_f32_16x16x32_bf16 a[76:79], a[164:167], v[188:191], a[76:79]
  s_add_u32 s14, s13, 57344
  buffer_load_dwordx4 v[232:235], v2, s[40:43], s14 offen offset:0 sc1
  v_mfma_f32_16x16x32_bf16 a[80:83], a[168:171], v[184:187], a[80:83]
  s_and_b32 s66, s66, 0x1ffff
  v_mfma_f32_16x16x32_bf16 a[84:87], a[168:171], v[188:191], a[84:87]
  v_mfma_f32_16x16x32_bf16 a[88:91], a[172:175], v[184:187], a[88:91]
  buffer_load_dwordx4 v[236:239], v2, s[40:43], s14 offen offset:1024 sc1
  v_mfma_f32_16x16x32_bf16 a[92:95], a[172:175], v[188:191], a[92:95]
  s_waitcnt lgkmcnt(0)
  v_mfma_f32_16x16x32_bf16 a[96:99], a[176:179], v[184:187], a[96:99]
  v_mfma_f32_16x16x32_bf16 a[100:103], a[176:179], v[188:191], a[100:103]
  buffer_load_dwordx4 v[240:243], v2, s[40:43], s14 offen offset:2048 sc1
  v_mfma_f32_16x16x32_bf16 a[104:107], a[180:183], v[184:187], a[104:107]
  v_mfma_f32_16x16x32_bf16 a[108:111], a[180:183], v[188:191], a[108:111]
  v_mfma_f32_16x16x32_bf16 a[112:115], a[184:187], v[184:187], a[112:115]
  buffer_load_dwordx4 v[244:247], v2, s[40:43], s14 offen offset:3072 sc1
  v_mfma_f32_16x16x32_bf16 a[116:119], a[184:187], v[188:191], a[116:119]
  v_mfma_f32_16x16x32_bf16 a[120:123], a[188:191], v[184:187], a[120:123]
  v_add_u32 v3, s66, v2
  v_mfma_f32_16x16x32_bf16 a[124:127], a[188:191], v[188:191], a[124:127]
fa_Bdone:
  s_cmp_ge_u32 s20, 2
  s_cbranch_scc1 fa_epi
  s_barrier
fa_epi:
  v_mov_b32 v20, v230
  v_mov_b32 v21, v231
  s_nop 1
  v_permlane16_swap_b32 v230, v20
  v_permlane16_swap_b32 v231, v21
  v_add_f32 v230, v230, v20
  v_add_f32 v231, v231, v21
  v_mov_b32 v20, v230
  v_mov_b32 v21, v231
  s_nop 1
  v_permlane32_swap_b32 v230, v20
  v_permlane32_swap_b32 v231, v21
  v_add_f32 v230, v230, v20
  v_add_f32 v231, v231, v21
  v_rcp_f32 v16, v230
  v_rcp_f32 v18, v231
  s_sub_u32 s23, 15, s22
  s_lshl_b32 s23, s23, 2
  v_mov_b32 v17, v16
  v_mov_b32 v19, v18
  s_add_u32 s23, s23, s20
  s_lshl_b32 s23, s23, 18
  s_lshl_b32 s31, s21, 12
  s_add_u32 s31, s31, 50331648
  s_add_u32 s64, s23, s31
  s_add_u32 s65, s64, 131072
  v_accvgpr_read_b32 v68, a64
  v_accvgpr_read_b32 v69, a65
  v_accvgpr_read_b32 v70, a66
  v_accvgpr_read_b32 v71, a67
  v_accvgpr_read_b32 v72, a72
  v_accvgpr_read_b32 v73, a73
  v_accvgpr_read_b32 v74, a74
  v_accvgpr_read_b32 v75, a75
  v_pk_mul_f32 v[68:69], v[68:69], v[16:17]
  v_pk_mul_f32 v[70:71], v[70:71], v[16:17]
  v_pk_mul_f32 v[72:73], v[72:73], v[16:17]
  v_pk_mul_f32 v[74:75], v[74:75], v[16:17]
  v_cvt_pk_bf16_f32 v64, v68, v69
  v_cvt_pk_bf16_f32 v65, v70, v71
  v_cvt_pk_bf16_f32 v66, v72, v73
  v_cvt_pk_bf16_f32 v67, v74, v75
  buffer_store_dwordx4 v[64:67], v2, s[40:43], s64 offen offset:0 sc1
  v_accvgpr_read_b32 v80, a80
  v_accvgpr_read_b32 v81, a81
  v_accvgpr_read_b32 v82, a82
  v_accvgpr_read_b32 v83, a83
  v_accvgpr_read_b32 v84, a88
  v_accvgpr_read_b32 v85, a89
  v_accvgpr_read_b32 v86, a90
  v_accvgpr_read_b32 v87, a91
  v_pk_mul_f32 v[80:81], v[80:81], v[16:17]
  v_pk_mul_f32 v[82:83], v[82:83], v[16:17]
  v_pk_mul_f32 v[84:85], v[84:85], v[16:17]
  v_pk_mul_f32 v[86:87], v[86:87], v[16:17]
  v_cvt_pk_bf16_f32 v76, v80, v81
  v_cvt_pk_bf16_f32 v77, v82, v83
  v_cvt_pk_bf16_f32 v78, v84, v85
  v_cvt_pk_bf16_f32 v79, v86, v87
  buffer_store_dwordx4 v[76:79], v2, s[40:43], s64 offen offset:1024 sc1
  v_accvgpr_read_b32 v132, a96
  v_accvgpr_read_b32 v133, a97
  v_accvgpr_read_b32 v134, a98
  v_accvgpr_read_b32 v135, a99
  v_accvgpr_read_b32 v136, a104
  v_accvgpr_read_b32 v137, a105
  v_accvgpr_read_b32 v138, a106
  v_accvgpr_read_b32 v139, a107
  v_pk_mul_f32 v[132:133], v[132:133], v[16:17]
  v_pk_mul_f32 v[134:135], v[134:135], v[16:17]
  v_pk_mul_f32 v[136:137], v[136:137], v[16:17]
  v_pk_mul_f32 v[138:139], v[138:139], v[16:17]
  v_cvt_pk_bf16_f32 v128, v132, v133
  v_cvt_pk_bf16_f32 v129, v134, v135
  v_cvt_pk_bf16_f32 v130, v136, v137
  v_cvt_pk_bf16_f32 v131, v138, v139
  buffer_store_dwordx4 v[128:131], v2, s[40:43], s64 offen offset:2048 sc1
  v_accvgpr_read_b32 v144, a112
  v_accvgpr_read_b32 v145, a113
  v_accvgpr_read_b32 v146, a114
  v_accvgpr_read_b32 v147, a115
  v_accvgpr_read_b32 v148, a120
  v_accvgpr_read_b32 v149, a121
  v_accvgpr_read_b32 v150, a122
  v_accvgpr_read_b32 v151, a123
  v_pk_mul_f32 v[144:145], v[144:145], v[16:17]
  v_pk_mul_f32 v[146:147], v[146:147], v[16:17]
  v_pk_mul_f32 v[148:149], v[148:149], v[16:17]
  v_pk_mul_f32 v[150:151], v[150:151], v[16:17]
  v_cvt_pk_bf16_f32 v140, v144, v145
  v_cvt_pk_bf16_f32 v141, v146, v147
  v_cvt_pk_bf16_f32 v142, v148, v149
  v_cvt_pk_bf16_f32 v143, v150, v151
  buffer_store_dwordx4 v[140:143], v2, s[40:43], s64 offen offset:3072 sc1
  v_accvgpr_read_b32 v68, a68
  v_accvgpr_read_b32 v69, a69
  v_accvgpr_read_b32 v70, a70
  v_accvgpr_read_b32 v71, a71
  v_accvgpr_read_b32 v72, a76
  v_accvgpr_read_b32 v73, a77
  v_accvgpr_read_b32 v74, a78
  v_accvgpr_read_b32 v75, a79
  v_pk_mul_f32 v[68:69], v[68:69], v[18:19]
  v_pk_mul_f32 v[70:71], v[70:71], v[18:19]
  v_pk_mul_f32 v[72:73], v[72:73], v[18:19]
  v_pk_mul_f32 v[74:75], v[74:75], v[18:19]
  v_cvt_pk_bf16_f32 v64, v68, v69
  v_cvt_pk_bf16_f32 v65, v70, v71
  v_cvt_pk_bf16_f32 v66, v72, v73
  v_cvt_pk_bf16_f32 v67, v74, v75
  buffer_store_dwordx4 v[64:67], v2, s[40:43], s65 offen offset:0 sc1
  v_accvgpr_read_b32 v80, a84
  v_accvgpr_read_b32 v81, a85
  v_accvgpr_read_b32 v82, a86
  v_accvgpr_read_b32 v83, a87
  v_accvgpr_read_b32 v84, a92
  v_accvgpr_read_b32 v85, a93
  v_accvgpr_read_b32 v86, a94
  v_accvgpr_read_b32 v87, a95
  v_pk_mul_f32 v[80:81], v[80:81], v[18:19]
  v_pk_mul_f32 v[82:83], v[82:83], v[18:19]
  v_pk_mul_f32 v[84:85], v[84:85], v[18:19]
  v_pk_mul_f32 v[86:87], v[86:87], v[18:19]
  v_cvt_pk_bf16_f32 v76, v80, v81
  v_cvt_pk_bf16_f32 v77, v82, v83
  v_cvt_pk_bf16_f32 v78, v84, v85
  v_cvt_pk_bf16_f32 v79, v86, v87
  buffer_store_dwordx4 v[76:79], v2, s[40:43], s65 offen offset:1024 sc1
  v_accvgpr_read_b32 v132, a100
  v_accvgpr_read_b32 v133, a101
  v_accvgpr_read_b32 v134, a102
  v_accvgpr_read_b32 v135, a103
  v_accvgpr_read_b32 v136, a108
  v_accvgpr_read_b32 v137, a109
  v_accvgpr_read_b32 v138, a110
  v_accvgpr_read_b32 v139, a111
  v_pk_mul_f32 v[132:133], v[132:133], v[18:19]
  v_pk_mul_f32 v[134:135], v[134:135], v[18:19]
  v_pk_mul_f32 v[136:137], v[136:137], v[18:19]
  v_pk_mul_f32 v[138:139], v[138:139], v[18:19]
  v_cvt_pk_bf16_f32 v128, v132, v133
  v_cvt_pk_bf16_f32 v129, v134, v135
  v_cvt_pk_bf16_f32 v130, v136, v137
  v_cvt_pk_bf16_f32 v131, v138, v139
  buffer_store_dwordx4 v[128:131], v2, s[40:43], s65 offen offset:2048 sc1
  v_accvgpr_read_b32 v144, a116
  v_accvgpr_read_b32 v145, a117
  v_accvgpr_read_b32 v146, a118
  v_accvgpr_read_b32 v147, a119
  v_accvgpr_read_b32 v148, a124
  v_accvgpr_read_b32 v149, a125
  v_accvgpr_read_b32 v150, a126
  v_accvgpr_read_b32 v151, a127
  v_pk_mul_f32 v[144:145], v[144:145], v[18:19]
  v_pk_mul_f32 v[146:147], v[146:147], v[18:19]
  v_pk_mul_f32 v[148:149], v[148:149], v[18:19]
  v_pk_mul_f32 v[150:151], v[150:151], v[18:19]
  v_cvt_pk_bf16_f32 v140, v144, v145
  v_cvt_pk_bf16_f32 v141, v146, v147
  v_cvt_pk_bf16_f32 v142, v148, v149
  v_cvt_pk_bf16_f32 v143, v150, v151
  buffer_store_dwordx4 v[140:143], v2, s[40:43], s65 offen offset:3072 sc1
  s_load_dwordx2 s[4:5], s[0:1], 0
  s_load_dwordx2 s[6:7], s[0:1], 88
  v_mov_b32 v30, 1073741824
  v_writelane_b32 v30, s80, 0
  v_writelane_b32 v30, s3, 1
  s_cmp_lt_u32 s12, 3
  s_cbranch_scc1 fa_puby
  s_add_u32 s14, s13, 61440
  buffer_load_dwordx4 v[64:67], v2, s[40:43], s14 offen offset:0 sc1
  buffer_load_dwordx4 v[68:71], v2, s[40:43], s14 offen offset:1024 sc1
  buffer_load_dwordx4 v[72:75], v2, s[40:43], s14 offen offset:2048 sc1
  buffer_load_dwordx4 v[76:79], v2, s[40:43], s14 offen offset:3072 sc1
  s_add_u32 s14, s13, 65536
  buffer_load_dwordx4 v[80:83], v2, s[40:43], s14 offen offset:0 sc1
  buffer_load_dwordx4 v[84:87], v2, s[40:43], s14 offen offset:1024 sc1
  buffer_load_dwordx4 v[88:91], v2, s[40:43], s14 offen offset:2048 sc1
  buffer_load_dwordx4 v[92:95], v2, s[40:43], s14 offen offset:3072 sc1
  s_waitcnt vmcnt(8)
  buffer_store_dword v4, v30, s[40:43], 0 offen sc1
fa_pubb:
  s_cmp_lt_u32 s29, 8
  s_cbranch_scc1 fa_left
fa_leftb:
  s_add_u32 s14, s13, 69632
  buffer_load_dwordx4 v[128:131], v2, s[40:43], s14 offen offset:0 sc1
  buffer_load_dwordx4 v[132:135], v2, s[40:43], s14 offen offset:1024 sc1
  buffer_load_dwordx4 v[136:139], v2, s[40:43], s14 offen offset:2048 sc1
  buffer_load_dwordx4 v[140:143], v2, s[40:43], s14 offen offset:3072 sc1
  s_add_u32 s14, s13, 73728
  buffer_load_dwordx4 v[144:147], v2, s[40:43], s14 offen offset:0 sc1
  buffer_load_dwordx4 v[148:151], v2, s[40:43], s14 offen offset:1024 sc1
  s_lshl_b32 s64, s21, 19
  s_lshl_b32 s23, s20, 15
  s_add_u32 s64, s64, s23
  s_add_u32 s64, s64, 50331648
  s_add_u32 s65, s64, 131072
  s_add_u32 s66, s64, 262144
  s_add_u32 s67, s64, 393216
  v_bfe_u32 v12, v1, 3, 1
  v_lshlrev_b32 v12, 7, v12
  v_and_b32 v13, 7, v1
  v_lshl_add_u32 v12, v13, 2, v12
  s_lshl_b32 s23, s21, 8
  s_lshl_b32 s31, s20, 5
  s_add_u32 s23, s23, s31
  s_add_u32 s23, s23, 2641920
  v_add_u32 v12, s23, v12
  s_lshl_b32 s25, s21, 6
  s_mul_i32 s26, s22, 160
  s_mul_i32 s27, s22, 2560
  v_mov_b32 v20, 0
  v_mov_b32 v21, 0
  v_mov_b32 v22, 0
  v_mov_b32 v23, 0
  v_add_u32 v16, 158208, v2
  ds_write_b128 v16, v[20:23]
  s_add_u32 s33, s13, 126976
  s_mul_i32 s34, s20, 38912
  v_add_u32 v11, s34, v2
  s_add_u32 s35, s34, 36864
  buffer_load_dwordx4 v[152:155], v2, s[40:43], s14 offen offset:2048 sc1
  buffer_load_dwordx4 v[156:159], v2, s[40:43], s14 offen offset:3072 sc1
  s_add_u32 s14, s13, 77824
  buffer_load_dwordx4 v[176:179], v2, s[40:43], s14 offen offset:0 sc1
  buffer_load_dwordx4 v[180:183], v2, s[40:43], s14 offen offset:1024 sc1
  buffer_load_dwordx4 v[184:187], v2, s[40:43], s14 offen offset:2048 sc1
  buffer_load_dwordx4 v[188:191], v2, s[40:43], s14 offen offset:3072 sc1
  s_add_u32 s13, s13, 81920
  s_waitcnt lgkmcnt(0)
  s_barrier
  s_mov_b32 s44, s4
  s_mov_b32 s45, s5
  s_mov_b32 s46, 2621440
  s_mov_b32 s47, 0x20000
  s_mov_b32 s48, s6
  s_mov_b32 s49, s7
  s_mov_b32 s50, 2621440
  s_mov_b32 s51, 0x20000
  s_mov_b32 m0, s34
  s_add_u32 s34, s34, 4096
  buffer_load_dwordx4 v2, s[40:43], s33 offen offset:0 sc1 lds
  buffer_load_dwordx4 v2, s[40:43], s33 offen offset:1024 sc1 lds
  buffer_load_dwordx4 v2, s[40:43], s33 offen offset:2048 sc1 lds
  buffer_load_dwordx4 v2, s[40:43], s33 offen offset:3072 sc1 lds
  s_add_u32 s33, s33, 4096
  s_mov_b32 m0, s34
  s_add_u32 s34, s34, 4096
  buffer_load_dwordx4 v2, s[40:43], s33 offen offset:0 sc1 lds
  buffer_load_dwordx4 v2, s[40:43], s33 offen offset:1024 sc1 lds
  buffer_load_dwordx4 v2, s[40:43], s33 offen offset:2048 sc1 lds
  buffer_load_dwordx4 v2, s[40:43], s33 offen offset:3072 sc1 lds
  s_add_u32 s33, s33, 4096
  s_mov_b32 m0, s34
  s_add_u32 s34, s34, 4096
  buffer_load_dwordx4 v2, s[40:43], s33 offen offset:0 sc1 lds
  buffer_load_dwordx4 v2, s[40:43], s33 offen offset:1024 sc1 lds
  buffer_load_dwordx4 v2, s[40:43], s33 offen offset:2048 sc1 lds
  buffer_load_dwordx4 v2, s[40:43], s33 offen offset:3072 sc1 lds
  s_add_u32 s33, s33, 4096
  s_mov_b32 m0, s34
  s_add_u32 s34, s34, 4096
  buffer_load_dwordx4 v2, s[40:43], s33 offen offset:0 sc1 lds
  buffer_load_dwordx4 v2, s[40:43], s33 offen offset:1024 sc1 lds
  buffer_load_dwordx4 v2, s[40:43], s33 offen offset:2048 sc1 lds
  buffer_load_dwordx4 v2, s[40:43], s33 offen offset:3072 sc1 lds
  s_add_u32 s33, s33, 4096
  s_mov_b32 m0, s34
  s_add_u32 s34, s34, 4096
  buffer_load_dwordx4 v2, s[40:43], s33 offen offset:0 sc1 lds
  buffer_load_dwordx4 v2, s[40:43], s33 offen offset:1024 sc1 lds
  buffer_load_dwordx4 v2, s[40:43], s33 offen offset:2048 sc1 lds
  buffer_load_dwordx4 v2, s[40:43], s33 offen offset:3072 sc1 lds
  s_add_u32 s33, s33, 4096
  s_mov_b32 m0, s34
  s_add_u32 s34, s34, 4096
  buffer_load_dwordx4 v2, s[40:43], s33 offen offset:0 sc1 lds
  buffer_load_dwordx4 v2, s[40:43], s33 offen offset:1024 sc1 lds
  buffer_load_dwordx4 v2, s[40:43], s33 offen offset:2048 sc1 lds
  buffer_load_dwordx4 v2, s[40:43], s33 offen offset:3072 sc1 lds
  s_add_u32 s33, s33, 4096
  s_mov_b32 m0, s34
  s_add_u32 s34, s34, 4096
  buffer_load_dwordx4 v2, s[40:43], s33 offen offset:0 sc1 lds
  buffer_load_dwordx4 v2, s[40:43], s33 offen offset:1024 sc1 lds
  buffer_load_dwordx4 v2, s[40:43], s33 offen offset:2048 sc1 lds
  buffer_load_dwordx4 v2, s[40:43], s33 offen offset:3072 sc1 lds
  s_add_u32 s33, s33, 4096
  buffer_load_dword v13, v12, s[40:43], 0 offen sc1
  s_mov_b32 m0, s34
  s_add_u32 s34, s34, 4096
  buffer_load_dwordx4 v2, s[40:43], s33 offen offset:0 sc1 lds
  buffer_load_dwordx4 v2, s[40:43], s33 offen offset:1024 sc1 lds
  buffer_load_dwordx4 v2, s[40:43], s33 offen offset:2048 sc1 lds
  buffer_load_dwordx4 v2, s[40:43], s33 offen offset:3072 sc1 lds
  s_add_u32 s33, s33, 4096
  s_mov_b32 m0, s34
  s_add_u32 s34, s34, 4096
  buffer_load_dwordx4 v2, s[40:43], s33 offen offset:0 sc1 lds
  buffer_load_dwordx4 v2, s[40:43], s33 offen offset:1024 sc1 lds
  buffer_load_dwordx4 v2, s[40:43], s33 offen offset:2048 sc1 lds
  buffer_load_dwordx4 v2, s[40:43], s33 offen offset:3072 sc1 lds
  s_add_u32 s33, s33, 4096
  s_waitcnt vmcnt(8)
  v_cmp_eq_u32 vcc, 0, v13
  s_cbranch_vccnz fa_ctx_spin
fa_ctx_ok:
  buffer_load_dwordx4 a[144:147], v2, s[40:43], s64 offen offset:0 sc1
  buffer_load_dwordx4 a[148:151], v2, s[40:43], s65 offen offset:0 sc1
  buffer_load_dwordx4 a[152:155], v2, s[40:43], s66 offen offset:0 sc1
  buffer_load_dwordx4 a[156:159], v2, s[40:43], s67 offen offset:0 sc1
  buffer_load_dwordx4 a[160:163], v2, s[40:43], s64 offen offset:1024 sc1
  buffer_load_dwordx4 a[164:167], v2, s[40:43], s65 offen offset:1024 sc1
  buffer_load_dwordx4 a[168:171], v2, s[40:43], s66 offen offset:1024 sc1
  buffer_load_dwordx4 a[172:175], v2, s[40:43], s67 offen offset:1024 sc1
  buffer_load_dwordx4 a[176:179], v2, s[40:43], s64 offen offset:2048 sc1
  buffer_load_dwordx4 a[180:183], v2, s[40:43], s65 offen offset:2048 sc1
  buffer_load_dwordx4 a[184:187], v2, s[40:43], s66 offen offset:2048 sc1
  buffer_load_dwordx4 a[188:191], v2, s[40:43], s67 offen offset:2048 sc1
  buffer_load_dwordx4 v[216:219], v2, s[40:43], s64 offen offset:3072 sc1
  buffer_load_dwordx4 v[220:223], v2, s[40:43], s65 offen offset:3072 sc1
  buffer_load_dwordx4 v[224:227], v2, s[40:43], s66 offen offset:3072 sc1
  buffer_load_dwordx4 v[228:231], v2, s[40:43], s67 offen offset:3072 sc1
  s_add_u32 s64, s64, 4096
  s_add_u32 s65, s65, 4096
  s_add_u32 s66, s66, 4096
  s_add_u32 s67, s67, 4096
  s_waitcnt vmcnt(12)
  v_mfma_f32_16x16x32_bf16 a[64:67], a[0:3], a[144:147], 0
  v_mfma_f32_16x16x32_bf16 a[68:71], a[0:3], a[148:151], 0
  v_mfma_f32_16x16x32_bf16 a[72:75], a[0:3], a[152:155], 0
  v_mfma_f32_16x16x32_bf16 a[76:79], a[0:3], a[156:159], 0
  buffer_load_dwordx4 a[0:3], v2, s[40:43], s13 offen offset:0 sc1
  v_mfma_f32_16x16x32_bf16 a[80:83], a[4:7], a[144:147], 0
  v_mfma_f32_16x16x32_bf16 a[84:87], a[4:7], a[148:151], 0
  v_mfma_f32_16x16x32_bf16 a[88:91], a[4:7], a[152:155], 0
  v_mfma_f32_16x16x32_bf16 a[92:95], a[4:7], a[156:159], 0
  buffer_load_dwordx4 a[4:7], v2, s[40:43], s13 offen offset:1024 sc1
  v_mfma_f32_16x16x32_bf16 a[96:99], a[8:11], a[144:147], 0
  v_mfma_f32_16x16x32_bf16 a[100:103], a[8:11], a[148:151], 0
  v_mfma_f32_16x16x32_bf16 a[104:107], a[8:11], a[152:155], 0
  v_mfma_f32_16x16x32_bf16 a[108:111], a[8:11], a[156:159], 0
  buffer_load_dwordx4 a[8:11], v2, s[40:43], s13 offen offset:2048 sc1
  v_mfma_f32_16x16x32_bf16 a[112:115], a[12:15], a[144:147], 0
  v_mfma_f32_16x16x32_bf16 a[116:119], a[12:15], a[148:151], 0
  v_mfma_f32_16x16x32_bf16 a[120:123], a[12:15], a[152:155], 0
  v_mfma_f32_16x16x32_bf16 a[124:127], a[12:15], a[156:159], 0
  v_mfma_f32_16x16x32_bf16 a[128:131], a[16:19], a[144:147], 0
  buffer_load_dwordx4 a[144:147], v2, s[40:43], s64 offen offset:0 sc1
  v_mfma_f32_16x16x32_bf16 a[132:135], a[16:19], a[148:151], 0
  buffer_load_dwordx4 a[148:151], v2, s[40:43], s65 offen offset:0 sc1
  v_mfma_f32_16x16x32_bf16 a[136:139], a[16:19], a[152:155], 0
  buffer_load_dwordx4 a[152:155], v2, s[40:43], s66 offen offset:0 sc1
  v_mfma_f32_16x16x32_bf16 a[140:143], a[16:19], a[156:159], 0
  buffer_load_dwordx4 a[156:159], v2, s[40:43], s67 offen offset:0 sc1
  s_waitcnt vmcnt(15)
  v_mfma_f32_16x16x32_bf16 a[64:67], a[20:23], a[160:163], a[64:67]
  v_add_u32 v16, 0, v0
  v_mfma_f32_16x16x32_bf16 a[68:71], a[20:23], a[164:167], a[68:71]
  v_mfma_f32_16x16x32_bf16 a[72:75], a[20:23], a[168:171], a[72:75]
  v_mul_u32_u24 v17, 6554, v16
  v_mfma_f32_16x16x32_bf16 a[76:79], a[20:23], a[172:175], a[76:79]
  buffer_load_dwordx4 a[12:15], v2, s[40:43], s13 offen offset:3072 sc1
  v_mfma_f32_16x16x32_bf16 a[80:83], a[24:27], a[160:163], a[80:83]
  s_add_u32 s13, s13, 4096
  v_mfma_f32_16x16x32_bf16 a[84:87], a[24:27], a[164:167], a[84:87]
  v_lshrrev_b32 v17, 16, v17
  v_mfma_f32_16x16x32_bf16 a[88:91], a[24:27], a[168:171], a[88:91]
  v_mul_u32_u24 v18, 10, v17
  v_mfma_f32_16x16x32_bf16 a[92:95], a[24:27], a[172:175], a[92:95]
  buffer_load_dwordx4 a[16:19], v2, s[40:43], s13 offen offset:0 sc1
  v_mfma_f32_16x16x32_bf16 a[96:99], a[28:31], a[160:163], a[96:99]
  v_mfma_f32_16x16x32_bf16 a[100:103], a[28:31], a[164:167], a[100:103]
  v_sub_u32 v18, v16, v18
  v_mfma_f32_16x16x32_bf16 a[104:107], a[28:31], a[168:171], a[104:107]
  v_mfma_f32_16x16x32_bf16 a[108:111], a[28:31], a[172:175], a[108:111]
  v_mfma_f32_16x16x32_bf16 a[112:115], a[32:35], a[160:163], a[112:115]
  v_mfma_f32_16x16x32_bf16 a[116:119], a[32:35], a[164:167], a[116:119]
  v_mul_u32_u24 v251, 336, v17
  v_mfma_f32_16x16x32_bf16 a[120:123], a[32:35], a[168:171], a[120:123]
  v_lshl_add_u32 v251, v18, 5, v251
  v_mfma_f32_16x16x32_bf16 a[124:127], a[32:35], a[172:175], a[124:127]
  v_mfma_f32_16x16x32_bf16 a[128:131], a[36:39], a[160:163], a[128:131]
  buffer_load_dwordx4 a[160:163], v2, s[40:43], s64 offen offset:1024 sc1
  v_mfma_f32_16x16x32_bf16 a[132:135], a[36:39], a[164:167], a[132:135]
  buffer_load_dwordx4 a[164:167], v2, s[40:43], s65 offen offset:1024 sc1
  v_mfma_f32_16x16x32_bf16 a[136:139], a[36:39], a[168:171], a[136:139]
  buffer_load_dwordx4 a[168:171], v2, s[40:43], s66 offen offset:1024 sc1
  v_mfma_f32_16x16x32_bf16 a[140:143], a[36:39], a[172:175], a[140:143]
  buffer_load_dwordx4 a[172:175], v2, s[40:43], s67 offen offset:1024 sc1
  s_waitcnt vmcnt(17)
  v_mfma_f32_16x16x32_bf16 a[64:67], a[40:43], a[176:179], a[64:67]
  v_lshlrev_b32 v203, 5, v18
  v_mfma_f32_16x16x32_bf16 a[68:71], a[40:43], a[180:183], a[68:71]
  v_mfma_f32_16x16x32_bf16 a[72:75], a[40:43], a[184:187], a[72:75]
  v_add_u32 v17, s25, v17
  v_mfma_f32_16x16x32_bf16 a[76:79], a[40:43], a[188:191], a[76:79]
  buffer_load_dwordx4 a[20:23], v2, s[40:43], s13 offen offset:1024 sc1
  v_mfma_f32_16x16x32_bf16 a[80:83], a[44:47], a[176:179], a[80:83]
  v_mfma_f32_16x16x32_bf16 a[84:87], a[44:47], a[180:183], a[84:87]
  v_add_u32 v24, 1, v17
  v_mfma_f32_16x16x32_bf16 a[88:91], a[44:47], a[184:187], a[88:91]
  v_mul_u32_u24 v248, 1280, v17
  v_mfma_f32_16x16x32_bf16 a[92:95], a[44:47], a[188:191], a[92:95]
  buffer_load_dwordx4 a[24:27], v2, s[40:43], s13 offen offset:2048 sc1
  v_mfma_f32_16x16x32_bf16 a[96:99], a[48:51], a[176:179], a[96:99]
  v_mfma_f32_16x16x32_bf16 a[100:103], a[48:51], a[180:183], a[100:103]
  v_lshl_add_u32 v248, v18, 4, v248
  v_mfma_f32_16x16x32_bf16 a[104:107], a[48:51], a[184:187], a[104:107]
  v_mfma_f32_16x16x32_bf16 a[108:111], a[48:51], a[188:191], a[108:111]
  v_mfma_f32_16x16x32_bf16 a[112:115], a[52:55], a[176:179], a[112:115]
  v_mfma_f32_16x16x32_bf16 a[116:119], a[52:55], a[180:183], a[116:119]
  v_add_u32 v248, s26, v248
  v_mfma_f32_16x16x32_bf16 a[120:123], a[52:55], a[184:187], a[120:123]
  v_lshrrev_b32 v19, 4, v17
  v_mfma_f32_16x16x32_bf16 a[124:127], a[52:55], a[188:191], a[124:127]
  v_mfma_f32_16x16x32_bf16 a[128:131], a[56:59], a[176:179], a[128:131]
  buffer_load_dwordx4 a[176:179], v2, s[40:43], s64 offen offset:2048 sc1
  v_mfma_f32_16x16x32_bf16 a[132:135], a[56:59], a[180:183], a[132:135]
  buffer_load_dwordx4 a[180:183], v2, s[40:43], s65 offen offset:2048 sc1
  v_mfma_f32_16x16x32_bf16 a[136:139], a[56:59], a[184:187], a[136:139]
  buffer_load_dwordx4 a[184:187], v2, s[40:43], s66 offen offset:2048 sc1
  v_mfma_f32_16x16x32_bf16 a[140:143], a[56:59], a[188:191], a[140:143]
  buffer_load_dwordx4 a[188:191], v2, s[40:43], s67 offen offset:2048 sc1
  s_waitcnt vmcnt(19)
  v_mfma_f32_16x16x32_bf16 a[64:67], a[60:63], v[216:219], a[64:67]
  v_mul_u32_u24 v19, 20480, v19
  v_mfma_f32_16x16x32_bf16 a[68:71], a[60:63], v[220:223], a[68:71]
  v_mfma_f32_16x16x32_bf16 a[72:75], a[60:63], v[224:227], a[72:75]
  v_and_b32 v17, 15, v17
  v_mfma_f32_16x16x32_bf16 a[76:79], a[60:63], v[228:231], a[76:79]
  buffer_load_dwordx4 a[28:31], v2, s[40:43], s13 offen offset:3072 sc1
  v_mfma_f32_16x16x32_bf16 a[80:83], a[192:195], v[216:219], a[80:83]
  s_add_u32 s13, s13, 4096
  v_mfma_f32_16x16x32_bf16 a[84:87], a[192:195], v[220:223], a[84:87]
  v_lshl_add_u32 v19, v17, 4, v19
  v_mfma_f32_16x16x32_bf16 a[88:91], a[192:195], v[224:227], a[88:91]
  v_lshl_add_u32 v200, v18, 8, v19
  v_mfma_f32_16x16x32_bf16 a[92:95], a[192:195], v[228:231], a[92:95]
  buffer_load_dwordx4 a[32:35], v2, s[40:43], s13 offen offset:0 sc1
  v_mfma_f32_16x16x32_bf16 a[96:99], a[196:199], v[216:219], a[96:99]
  v_mfma_f32_16x16x32_bf16 a[100:103], a[196:199], v[220:223], a[100:103]
  v_mov_b32 v27, 8
  v_mfma_f32_16x16x32_bf16 a[104:107], a[196:199], v[224:227], a[104:107]
  v_mfma_f32_16x16x32_bf16 a[108:111], a[196:199], v[228:231], a[108:111]
  v_mfma_f32_16x16x32_bf16 a[112:115], a[200:203], v[216:219], a[112:115]
  v_mfma_f32_16x16x32_bf16 a[116:119], a[200:203], v[220:223], a[116:119]
  v_add_u32 v16, 256, v0
  v_mfma_f32_16x16x32_bf16 a[120:123], a[200:203], v[224:227], a[120:123]
  v_mul_u32_u24 v17, 6554, v16
  v_mfma_f32_16x16x32_bf16 a[124:127], a[200:203], v[228:231], a[124:127]
  v_mfma_f32_16x16x32_bf16 a[128:131], a[204:207], v[216:219], a[128:131]
  buffer_load_dwordx4 v[216:219], v2, s[40:43], s64 offen offset:3072 sc1
  v_mfma_f32_16x16x32_bf16 a[132:135], a[204:207], v[220:223], a[132:135]
  buffer_load_dwordx4 v[220:223], v2, s[40:43], s65 offen offset:3072 sc1
  v_mfma_f32_16x16x32_bf16 a[136:139], a[204:207], v[224:227], a[136:139]
  buffer_load_dwordx4 v[224:227], v2, s[40:43], s66 offen offset:3072 sc1
  v_mfma_f32_16x16x32_bf16 a[140:143], a[204:207], v[228:231], a[140:143]
  buffer_load_dwordx4 v[228:231], v2, s[40:43], s67 offen offset:3072 sc1
  s_waitcnt vmcnt(18)
  v_mfma_f32_16x16x32_bf16 a[64:67], a[208:211], a[144:147], a[64:67]
  s_add_u32 s64, s64, 4096
  v_lshrrev_b32 v17, 16, v17
  v_mfma_f32_16x16x32_bf16 a[68:71], a[208:211], a[148:151], a[68:71]
  s_add_u32 s65, s65, 4096
  v_mfma_f32_16x16x32_bf16 a[72:75], a[208:211], a[152:155], a[72:75]
  s_add_u32 s66, s66, 4096
  v_mul_u32_u24 v18, 10, v17
  v_mfma_f32_16x16x32_bf16 a[76:79], a[208:211], a[156:159], a[76:79]
  buffer_load_dwordx4 a[36:39], v2, s[40:43], s13 offen offset:1024 sc1
  v_mfma_f32_16x16x32_bf16 a[80:83], a[212:215], a[144:147], a[80:83]
  v_mfma_f32_16x16x32_bf16 a[84:87], a[212:215], a[148:151], a[84:87]
  v_sub_u32 v18, v16, v18
  v_mfma_f32_16x16x32_bf16 a[88:91], a[212:215], a[152:155], a[88:91]
  s_add_u32 s67, s67, 4096
  v_mul_u32_u24 v252, 336, v17
  v_mfma_f32_16x16x32_bf16 a[92:95], a[212:215], a[156:159], a[92:95]
  buffer_load_dwordx4 a[40:43], v2, s[40:43], s13 offen offset:2048 sc1
  v_mfma_f32_16x16x32_bf16 a[96:99], a[216:219], a[144:147], a[96:99]
  v_mfma_f32_16x16x32_bf16 a[100:103], a[216:219], a[148:151], a[100:103]
  v_lshl_add_u32 v252, v18, 5, v252
  v_mfma_f32_16x16x32_bf16 a[104:107], a[216:219], a[152:155], a[104:107]
  v_mfma_f32_16x16x32_bf16 a[108:111], a[216:219], a[156:159], a[108:111]
  v_mfma_f32_16x16x32_bf16 a[112:115], a[220:223], a[144:147], a[112:115]
  v_mfma_f32_16x16x32_bf16 a[116:119], a[220:223], a[148:151], a[116:119]
  v_lshlrev_b32 v204, 5, v18
  v_mfma_f32_16x16x32_bf16 a[120:123], a[220:223], a[152:155], a[120:123]
  v_add_u32 v17, s25, v17
  v_mfma_f32_16x16x32_bf16 a[124:127], a[220:223], a[156:159], a[124:127]
  v_mfma_f32_16x16x32_bf16 a[128:131], a[224:227], a[144:147], a[128:131]
  buffer_load_dwordx4 a[144:147], v2, s[40:43], s64 offen offset:0 sc1
  v_mfma_f32_16x16x32_bf16 a[132:135], a[224:227], a[148:151], a[132:135]
  buffer_load_dwordx4 a[148:151], v2, s[40:43], s65 offen offset:0 sc1
  v_mfma_f32_16x16x32_bf16 a[136:139], a[224:227], a[152:155], a[136:139]
  buffer_load_dwordx4 a[152:155], v2, s[40:43], s66 offen offset:0 sc1
  v_mfma_f32_16x16x32_bf16 a[140:143], a[224:227], a[156:159], a[140:143]
  buffer_load_dwordx4 a[156:159], v2, s[40:43], s67 offen offset:0 sc1
  s_waitcnt vmcnt(18)
  v_mfma_f32_16x16x32_bf16 a[64:67], a[228:231], a[160:163], a[64:67]
  v_add_u32 v25, 1, v17
  v_mfma_f32_16x16x32_bf16 a[68:71], a[228:231], a[164:167], a[68:71]
  v_mfma_f32_16x16x32_bf16 a[72:75], a[228:231], a[168:171], a[72:75]
  v_mul_u32_u24 v249, 1280, v17
  v_mfma_f32_16x16x32_bf16 a[76:79], a[228:231], a[172:175], a[76:79]
  buffer_load_dwordx4 a[44:47], v2, s[40:43], s13 offen offset:3072 sc1
  v_mfma_f32_16x16x32_bf16 a[80:83], a[232:235], a[160:163], a[80:83]
  s_add_u32 s13, s13, 4096
  v_mfma_f32_16x16x32_bf16 a[84:87], a[232:235], a[164:167], a[84:87]
  v_lshl_add_u32 v249, v18, 4, v249
  v_mfma_f32_16x16x32_bf16 a[88:91], a[232:235], a[168:171], a[88:91]
  v_add_u32 v249, s26, v249
  v_mfma_f32_16x16x32_bf16 a[92:95], a[232:235], a[172:175], a[92:95]
  buffer_load_dwordx4 a[48:51], v2, s[40:43], s13 offen offset:0 sc1
  v_mfma_f32_16x16x32_bf16 a[96:99], a[236:239], a[160:163], a[96:99]
  v_mfma_f32_16x16x32_bf16 a[100:103], a[236:239], a[164:167], a[100:103]
  v_lshrrev_b32 v19, 4, v17
  v_mfma_f32_16x16x32_bf16 a[104:107], a[236:239], a[168:171], a[104:107]
  v_mfma_f32_16x16x32_bf16 a[108:111], a[236:239], a[172:175], a[108:111]
  v_mfma_f32_16x16x32_bf16 a[112:115], a[240:243], a[160:163], a[112:115]
  v_mfma_f32_16x16x32_bf16 a[116:119], a[240:243], a[164:167], a[116:119]
  v_mul_u32_u24 v19, 20480, v19
  v_mfma_f32_16x16x32_bf16 a[120:123], a[240:243], a[168:171], a[120:123]
  v_and_b32 v17, 15, v17
  v_mfma_f32_16x16x32_bf16 a[124:127], a[240:243], a[172:175], a[124:127]
  v_mfma_f32_16x16x32_bf16 a[128:131], a[244:247], a[160:163], a[128:131]
  buffer_load_dwordx4 a[160:163], v2, s[40:43], s64 offen offset:1024 sc1
  v_mfma_f32_16x16x32_bf16 a[132:135], a[244:247], a[164:167], a[132:135]
  buffer_load_dwordx4 a[164:167], v2, s[40:43], s65 offen offset:1024 sc1
  v_mfma_f32_16x16x32_bf16 a[136:139], a[244:247], a[168:171], a[136:139]
  buffer_load_dwordx4 a[168:171], v2, s[40:43], s66 offen offset:1024 sc1
  v_mfma_f32_16x16x32_bf16 a[140:143], a[244:247], a[172:175], a[140:143]
  buffer_load_dwordx4 a[172:175], v2, s[40:43], s67 offen offset:1024 sc1
  s_waitcnt vmcnt(18)
  v_mfma_f32_16x16x32_bf16 a[64:67], a[248:251], a[176:179], a[64:67]
  v_lshl_add_u32 v19, v17, 4, v19
  v_mfma_f32_16x16x32_bf16 a[68:71], a[248:251], a[180:183], a[68:71]
  v_mfma_f32_16x16x32_bf16 a[72:75], a[248:251], a[184:187], a[72:75]
  v_lshl_add_u32 v201, v18, 8, v19
  v_mfma_f32_16x16x32_bf16 a[76:79], a[248:251], a[188:191], a[76:79]
  buffer_load_dwordx4 a[52:55], v2, s[40:43], s13 offen offset:1024 sc1
  v_mfma_f32_16x16x32_bf16 a[80:83], a[252:255], a[176:179], a[80:83]
  v_mfma_f32_16x16x32_bf16 a[84:87], a[252:255], a[180:183], a[84:87]
  v_mov_b32 v28, 8
  v_mfma_f32_16x16x32_bf16 a[88:91], a[252:255], a[184:187], a[88:91]
  v_add_u32 v16, 512, v0
  v_mfma_f32_16x16x32_bf16 a[92:95], a[252:255], a[188:191], a[92:95]
  buffer_load_dwordx4 a[56:59], v2, s[40:43], s13 offen offset:2048 sc1
  v_mfma_f32_16x16x32_bf16 a[96:99], v[32:35], a[176:179], a[96:99]
  v_mfma_f32_16x16x32_bf16 a[100:103], v[32:35], a[180:183], a[100:103]
  v_mul_u32_u24 v17, 6554, v16
  v_mfma_f32_16x16x32_bf16 a[104:107], v[32:35], a[184:187], a[104:107]
  v_mfma_f32_16x16x32_bf16 a[108:111], v[32:35], a[188:191], a[108:111]
  v_mfma_f32_16x16x32_bf16 a[112:115], v[36:39], a[176:179], a[112:115]
  v_mfma_f32_16x16x32_bf16 a[116:119], v[36:39], a[180:183], a[116:119]
  v_lshrrev_b32 v17, 16, v17
  v_mfma_f32_16x16x32_bf16 a[120:123], v[36:39], a[184:187], a[120:123]
  v_mul_u32_u24 v18, 10, v17
  v_mfma_f32_16x16x32_bf16 a[124:127], v[36:39], a[188:191], a[124:127]
  v_mfma_f32_16x16x32_bf16 a[128:131], v[40:43], a[176:179], a[128:131]
  buffer_load_dwordx4 a[176:179], v2, s[40:43], s64 offen offset:2048 sc1
  v_mfma_f32_16x16x32_bf16 a[132:135], v[40:43], a[180:183], a[132:135]
  buffer_load_dwordx4 a[180:183], v2, s[40:43], s65 offen offset:2048 sc1
  v_mfma_f32_16x16x32_bf16 a[136:139], v[40:43], a[184:187], a[136:139]
  buffer_load_dwordx4 a[184:187], v2, s[40:43], s66 offen offset:2048 sc1
  v_mfma_f32_16x16x32_bf16 a[140:143], v[40:43], a[188:191], a[140:143]
  buffer_load_dwordx4 a[188:191], v2, s[40:43], s67 offen offset:2048 sc1
  s_waitcnt vmcnt(18)
  v_mfma_f32_16x16x32_bf16 a[64:67], v[44:47], v[216:219], a[64:67]
  v_sub_u32 v18, v16, v18
  v_mfma_f32_16x16x32_bf16 a[68:71], v[44:47], v[220:223], a[68:71]
  v_mfma_f32_16x16x32_bf16 a[72:75], v[44:47], v[224:227], a[72:75]
  v_mul_u32_u24 v253, 336, v17
  v_mfma_f32_16x16x32_bf16 a[76:79], v[44:47], v[228:231], a[76:79]
  buffer_load_dwordx4 a[60:63], v2, s[40:43], s13 offen offset:3072 sc1
  v_mfma_f32_16x16x32_bf16 a[80:83], v[48:51], v[216:219], a[80:83]
  s_add_u32 s13, s13, 4096
  v_mfma_f32_16x16x32_bf16 a[84:87], v[48:51], v[220:223], a[84:87]
  v_lshl_add_u32 v253, v18, 5, v253
  v_mfma_f32_16x16x32_bf16 a[88:91], v[48:51], v[224:227], a[88:91]
  v_lshlrev_b32 v205, 5, v18
  v_mfma_f32_16x16x32_bf16 a[92:95], v[48:51], v[228:231], a[92:95]
  buffer_load_dwordx4 a[192:195], v2, s[40:43], s13 offen offset:0 sc1
  v_mfma_f32_16x16x32_bf16 a[96:99], v[52:55], v[216:219], a[96:99]
  v_mfma_f32_16x16x32_bf16 a[100:103], v[52:55], v[220:223], a[100:103]
  v_add_u32 v17, s25, v17
  v_mfma_f32_16x16x32_bf16 a[104:107], v[52:55], v[224:227], a[104:107]
  v_mfma_f32_16x16x32_bf16 a[108:111], v[52:55], v[228:231], a[108:111]
  v_mfma_f32_16x16x32_bf16 a[112:115], v[56:59], v[216:219], a[112:115]
  v_mfma_f32_16x16x32_bf16 a[116:119], v[56:59], v[220:223], a[116:119]
  v_add_u32 v26, 1, v17
  v_mfma_f32_16x16x32_bf16 a[120:123], v[56:59], v[224:227], a[120:123]
  v_mul_u32_u24 v250, 1280, v17
  v_mfma_f32_16x16x32_bf16 a[124:127], v[56:59], v[228:231], a[124:127]
  v_mfma_f32_16x16x32_bf16 a[128:131], v[60:63], v[216:219], a[128:131]
  buffer_load_dwordx4 v[216:219], v2, s[40:43], s64 offen offset:3072 sc1
  v_mfma_f32_16x16x32_bf16 a[132:135], v[60:63], v[220:223], a[132:135]
  buffer_load_dwordx4 v[220:223], v2, s[40:43], s65 offen offset:3072 sc1
  v_mfma_f32_16x16x32_bf16 a[136:139], v[60:63], v[224:227], a[136:139]
  buffer_load_dwordx4 v[224:227], v2, s[40:43], s66 offen offset:3072 sc1
  v_mfma_f32_16x16x32_bf16 a[140:143], v[60:63], v[228:231], a[140:143]
  buffer_load_dwordx4 v[228:231], v2, s[40:43], s67 offen offset:3072 sc1
  s_waitcnt vmcnt(18)
  v_mfma_f32_16x16x32_bf16 a[64:67], v[96:99], a[144:147], a[64:67]
  s_add_u32 s64, s64, 4096
  v_lshl_add_u32 v250, v18, 4, v250
  v_mfma_f32_16x16x32_bf16 a[68:71], v[96:99], a[148:151], a[68:71]
  s_add_u32 s65, s65, 4096
  v_mfma_f32_16x16x32_bf16 a[72:75], v[96:99], a[152:155], a[72:75]
  s_add_u32 s66, s66, 4096
  v_add_u32 v250, s26, v250
  v_mfma_f32_16x16x32_bf16 a[76:79], v[96:99], a[156:159], a[76:79]
  buffer_load_dwordx4 a[196:199], v2, s[40:43], s13 offen offset:1024 sc1
  v_mfma_f32_16x16x32_bf16 a[80:83], v[100:103], a[144:147], a[80:83]
  v_mfma_f32_16x16x32_bf16 a[84:87], v[100:103], a[148:151], a[84:87]
  v_lshrrev_b32 v19, 4, v17
  v_mfma_f32_16x16x32_bf16 a[88:91], v[100:103], a[152:155], a[88:91]
  s_add_u32 s67, s67, 4096
  v_mul_u32_u24 v19, 20480, v19
  v_mfma_f32_16x16x32_bf16 a[92:95], v[100:103], a[156:159], a[92:95]
  buffer_load_dwordx4 a[200:203], v2, s[40:43], s13 offen offset:2048 sc1
  v_mfma_f32_16x16x32_bf16 a[96:99], v[104:107], a[144:147], a[96:99]
  v_mfma_f32_16x16x32_bf16 a[100:103], v[104:107], a[148:151], a[100:103]
  v_and_b32 v17, 15, v17
  v_mfma_f32_16x16x32_bf16 a[104:107], v[104:107], a[152:155], a[104:107]
  v_mfma_f32_16x16x32_bf16 a[108:111], v[104:107], a[156:159], a[108:111]
  v_mfma_f32_16x16x32_bf16 a[112:115], v[108:111], a[144:147], a[112:115]
  v_mfma_f32_16x16x32_bf16 a[116:119], v[108:111], a[148:151], a[116:119]
  v_lshl_add_u32 v19, v17, 4, v19
  v_mfma_f32_16x16x32_bf16 a[120:123], v[108:111], a[152:155], a[120:123]
  v_lshl_add_u32 v202, v18, 8, v19
  v_mfma_f32_16x16x32_bf16 a[124:127], v[108:111], a[156:159], a[124:127]
  v_mfma_f32_16x16x32_bf16 a[128:131], v[112:115], a[144:147], a[128:131]
  buffer_load_dwordx4 a[144:147], v2, s[40:43], s64 offen offset:0 sc1
  v_mfma_f32_16x16x32_bf16 a[132:135], v[112:115], a[148:151], a[132:135]
  buffer_load_dwordx4 a[148:151], v2, s[40:43], s65 offen offset:0 sc1
  v_mfma_f32_16x16x32_bf16 a[136:139], v[112:115], a[152:155], a[136:139]
  buffer_load_dwordx4 a[152:155], v2, s[40:43], s66 offen offset:0 sc1
  v_mfma_f32_16x16x32_bf16 a[140:143], v[112:115], a[156:159], a[140:143]
  buffer_load_dwordx4 a[156:159], v2, s[40:43], s67 offen offset:0 sc1
  s_waitcnt vmcnt(18)
  v_mfma_f32_16x16x32_bf16 a[64:67], v[116:119], a[160:163], a[64:67]
  v_mov_b32 v29, 8
  v_mfma_f32_16x16x32_bf16 a[68:71], v[116:119], a[164:167], a[68:71]
  v_mfma_f32_16x16x32_bf16 a[72:75], v[116:119], a[168:171], a[72:75]
  v_cmp_gt_u32 vcc, 128, v0
  v_mfma_f32_16x16x32_bf16 a[76:79], v[116:119], a[172:175], a[76:79]
  buffer_load_dwordx4 a[204:207], v2, s[40:43], s13 offen offset:3072 sc1
  v_mfma_f32_16x16x32_bf16 a[80:83], v[120:123], a[160:163], a[80:83]
  s_add_u32 s13, s13, 4096
  v_mfma_f32_16x16x32_bf16 a[84:87], v[120:123], a[164:167], a[84:87]
  v_mov_b32 v16, 1073741824
  v_mfma_f32_16x16x32_bf16 a[88:91], v[120:123], a[168:171], a[88:91]
  v_mov_b32 v17, 0
  v_mfma_f32_16x16x32_bf16 a[92:95], v[120:123], a[172:175], a[92:95]
  buffer_load_dwordx4 a[208:211], v2, s[40:43], s13 offen offset:0 sc1
  v_mfma_f32_16x16x32_bf16 a[96:99], v[124:127], a[160:163], a[96:99]
  v_mfma_f32_16x16x32_bf16 a[100:103], v[124:127], a[164:167], a[100:103]
  v_cndmask_b32 v250, v16, v250, vcc
  v_mfma_f32_16x16x32_bf16 a[104:107], v[124:127], a[168:171], a[104:107]
  v_mfma_f32_16x16x32_bf16 a[108:111], v[124:127], a[172:175], a[108:111]
  v_mfma_f32_16x16x32_bf16 a[112:115], v[160:163], a[160:163], a[112:115]
  v_mfma_f32_16x16x32_bf16 a[116:119], v[160:163], a[164:167], a[116:119]
  v_cndmask_b32 v202, v16, v202, vcc
  v_mfma_f32_16x16x32_bf16 a[120:123], v[160:163], a[168:171], a[120:123]
  v_cndmask_b32 v253, v17, v253, vcc
  v_mfma_f32_16x16x32_bf16 a[124:127], v[160:163], a[172:175], a[124:127]
  v_mfma_f32_16x16x32_bf16 a[128:131], v[164:167], a[160:163], a[128:131]
  buffer_load_dwordx4 a[160:163], v2, s[40:43], s64 offen offset:1024 sc1
  v_mfma_f32_16x16x32_bf16 a[132:135], v[164:167], a[164:167], a[132:135]
  buffer_load_dwordx4 a[164:167], v2, s[40:43], s65 offen offset:1024 sc1
  v_mfma_f32_16x16x32_bf16 a[136:139], v[164:167], a[168:171], a[136:139]
  buffer_load_dwordx4 a[168:171], v2, s[40:43], s66 offen offset:1024 sc1
  v_mfma_f32_16x16x32_bf16 a[140:143], v[164:167], a[172:175], a[140:143]
  buffer_load_dwordx4 a[172:175], v2, s[40:43], s67 offen offset:1024 sc1
  s_waitcnt vmcnt(18)
  v_mfma_f32_16x16x32_bf16 a[64:67], v[168:171], a[176:179], a[64:67]
  v_readlane_b32 s68, v15, 0
  v_mfma_f32_16x16x32_bf16 a[68:71], v[168:171], a[180:183], a[68:71]
  v_mfma_f32_16x16x32_bf16 a[72:75], v[168:171], a[184:187], a[72:75]
  v_readlane_b32 s69, v15, 1
  v_mfma_f32_16x16x32_bf16 a[76:79], v[168:171], a[188:191], a[76:79]
  buffer_load_dwordx4 a[212:215], v2, s[40:43], s13 offen offset:1024 sc1
  v_mfma_f32_16x16x32_bf16 a[80:83], v[172:175], a[176:179], a[80:83]
  v_mfma_f32_16x16x32_bf16 a[84:87], v[172:175], a[180:183], a[84:87]
  v_readlane_b32 s70, v15, 2
  v_mfma_f32_16x16x32_bf16 a[88:91], v[172:175], a[184:187], a[88:91]
  v_readlane_b32 s71, v15, 3
  v_mfma_f32_16x16x32_bf16 a[92:95], v[172:175], a[188:191], a[92:95]
  buffer_load_dwordx4 a[216:219], v2, s[40:43], s13 offen offset:2048 sc1
  v_mfma_f32_16x16x32_bf16 a[96:99], v[192:195], a[176:179], a[96:99]
  v_mfma_f32_16x16x32_bf16 a[100:103], v[192:195], a[180:183], a[100:103]
  v_readlane_b32 s72, v15, 4
  v_mfma_f32_16x16x32_bf16 a[104:107], v[192:195], a[184:187], a[104:107]
  v_mfma_f32_16x16x32_bf16 a[108:111], v[192:195], a[188:191], a[108:111]
  buffer_load_dwordx4 a[220:223], v2, s[40:43], s13 offen offset:3072 sc1
  v_mfma_f32_16x16x32_bf16 a[112:115], v[196:199], a[176:179], a[112:115]
  s_add_u32 s13, s13, 4096
  v_mfma_f32_16x16x32_bf16 a[116:119], v[196:199], a[180:183], a[116:119]
  v_readlane_b32 s73, v15, 5
  v_mfma_f32_16x16x32_bf16 a[120:123], v[196:199], a[184:187], a[120:123]
  v_readlane_b32 s74, v15, 6
  v_mfma_f32_16x16x32_bf16 a[124:127], v[196:199], a[188:191], a[124:127]
  v_mfma_f32_16x16x32_bf16 a[128:131], v[208:211], a[176:179], a[128:131]
  buffer_load_dwordx4 a[176:179], v2, s[40:43], s64 offen offset:2048 sc1
  v_mfma_f32_16x16x32_bf16 a[132:135], v[208:211], a[180:183], a[132:135]
  buffer_load_dwordx4 a[180:183], v2, s[40:43], s65 offen offset:2048 sc1
  v_mfma_f32_16x16x32_bf16 a[136:139], v[208:211], a[184:187], a[136:139]
  buffer_load_dwordx4 a[184:187], v2, s[40:43], s66 offen offset:2048 sc1
  v_mfma_f32_16x16x32_bf16 a[140:143], v[208:211], a[188:191], a[140:143]
  buffer_load_dwordx4 a[188:191], v2, s[40:43], s67 offen offset:2048 sc1
  s_waitcnt vmcnt(19)
  v_mfma_f32_16x16x32_bf16 a[64:67], v[212:215], v[216:219], a[64:67]
  v_readlane_b32 s75, v15, 7
  v_mfma_f32_16x16x32_bf16 a[68:71], v[212:215], v[220:223], a[68:71]
  v_mfma_f32_16x16x32_bf16 a[72:75], v[212:215], v[224:227], a[72:75]
  v_cmp_eq_u32 s[52:53], s68, v24
  v_mfma_f32_16x16x32_bf16 a[76:79], v[212:215], v[228:231], a[76:79]
  buffer_load_dwordx4 a[224:227], v2, s[40:43], s13 offen offset:0 sc1
  v_mfma_f32_16x16x32_bf16 a[80:83], v[232:235], v[216:219], a[80:83]
  v_mfma_f32_16x16x32_bf16 a[84:87], v[232:235], v[220:223], a[84:87]
  v_cmp_eq_u32 s[54:55], s68, v25
  v_mfma_f32_16x16x32_bf16 a[88:91], v[232:235], v[224:227], a[88:91]
  v_cmp_eq_u32 s[56:57], s68, v26
  v_mfma_f32_16x16x32_bf16 a[92:95], v[232:235], v[228:231], a[92:95]
  buffer_load_dwordx4 a[228:231], v2, s[40:43], s13 offen offset:1024 sc1
  v_mfma_f32_16x16x32_bf16 a[96:99], v[236:239], v[216:219], a[96:99]
  v_mfma_f32_16x16x32_bf16 a[100:103], v[236:239], v[220:223], a[100:103]
  v_cndmask_b32 v27, v27, 0, s[52:53]
  v_mfma_f32_16x16x32_bf16 a[104:107], v[236:239], v[224:227], a[104:107]
  v_mfma_f32_16x16x32_bf16 a[108:111], v[236:239], v[228:231], a[108:111]
  v_mfma_f32_16x16x32_bf16 a[112:115], v[240:243], v[216:219], a[112:115]
  v_mfma_f32_16x16x32_bf16 a[116:119], v[240:243], v[220:223], a[116:119]
  v_cndmask_b32 v28, v28, 0, s[54:55]
  v_mfma_f32_16x16x32_bf16 a[120:123], v[240:243], v[224:227], a[120:123]
  v_cndmask_b32 v29, v29, 0, s[56:57]
  v_mfma_f32_16x16x32_bf16 a[124:127], v[240:243], v[228:231], a[124:127]
  v_mfma_f32_16x16x32_bf16 a[128:131], v[244:247], v[216:219], a[128:131]
  buffer_load_dwordx4 v[216:219], v2, s[40:43], s64 offen offset:3072 sc1
  v_mfma_f32_16x16x32_bf16 a[132:135], v[244:247], v[220:223], a[132:135]
  buffer_load_dwordx4 v[220:223], v2, s[40:43], s65 offen offset:3072 sc1
  v_mfma_f32_16x16x32_bf16 a[136:139], v[244:247], v[224:227], a[136:139]
  buffer_load_dwordx4 v[224:227], v2, s[40:43], s66 offen offset:3072 sc1
  v_mfma_f32_16x16x32_bf16 a[140:143], v[244:247], v[228:231], a[140:143]
  buffer_load_dwordx4 v[228:231], v2, s[40:43], s67 offen offset:3072 sc1
  s_waitcnt vmcnt(19)
  v_mfma_f32_16x16x32_bf16 a[64:67], v[64:67], a[144:147], a[64:67]
  s_add_u32 s64, s64, 4096
  v_cmp_eq_u32 s[52:53], s69, v24
  v_mfma_f32_16x16x32_bf16 a[68:71], v[64:67], a[148:151], a[68:71]
  s_add_u32 s65, s65, 4096
  v_mfma_f32_16x16x32_bf16 a[72:75], v[64:67], a[152:155], a[72:75]
  s_add_u32 s66, s66, 4096
  v_cmp_eq_u32 s[54:55], s69, v25
  v_mfma_f32_16x16x32_bf16 a[76:79], v[64:67], a[156:159], a[76:79]
  buffer_load_dwordx4 a[232:235], v2, s[40:43], s13 offen offset:2048 sc1
  v_mfma_f32_16x16x32_bf16 a[80:83], v[68:71], a[144:147], a[80:83]
  v_mfma_f32_16x16x32_bf16 a[84:87], v[68:71], a[148:151], a[84:87]
  v_cmp_eq_u32 s[56:57], s69, v26
  v_mfma_f32_16x16x32_bf16 a[88:91], v[68:71], a[152:155], a[88:91]
  s_add_u32 s67, s67, 4096
  v_cndmask_b32 v27, v27, 1, s[52:53]
  v_mfma_f32_16x16x32_bf16 a[92:95], v[68:71], a[156:159], a[92:95]
  buffer_load_dwordx4 a[236:239], v2, s[40:43], s13 offen offset:3072 sc1
  v_mfma_f32_16x16x32_bf16 a[96:99], v[72:75], a[144:147], a[96:99]
  s_add_u32 s13, s13, 4096
  v_mfma_f32_16x16x32_bf16 a[100:103], v[72:75], a[148:151], a[100:103]
  v_cndmask_b32 v28, v28, 1, s[54:55]
  v_mfma_f32_16x16x32_bf16 a[104:107], v[72:75], a[152:155], a[104:107]
  v_mfma_f32_16x16x32_bf16 a[108:111], v[72:75], a[156:159], a[108:111]
  v_mfma_f32_16x16x32_bf16 a[112:115], v[76:79], a[144:147], a[112:115]
  v_mfma_f32_16x16x32_bf16 a[116:119], v[76:79], a[148:151], a[116:119]
  v_cndmask_b32 v29, v29, 1, s[56:57]
  v_mfma_f32_16x16x32_bf16 a[120:123], v[76:79], a[152:155], a[120:123]
  v_cmp_eq_u32 s[52:53], s70, v24
  v_mfma_f32_16x16x32_bf16 a[124:127], v[76:79], a[156:159], a[124:127]
  v_mfma_f32_16x16x32_bf16 a[128:131], v[80:83], a[144:147], a[128:131]
  buffer_load_dwordx4 a[144:147], v2, s[40:43], s64 offen offset:0 sc1
  v_mfma_f32_16x16x32_bf16 a[132:135], v[80:83], a[148:151], a[132:135]
  buffer_load_dwordx4 a[148:151], v2, s[40:43], s65 offen offset:0 sc1
  v_mfma_f32_16x16x32_bf16 a[136:139], v[80:83], a[152:155], a[136:139]
  buffer_load_dwordx4 a[152:155], v2, s[40:43], s66 offen offset:0 sc1
  v_mfma_f32_16x16x32_bf16 a[140:143], v[80:83], a[156:159], a[140:143]
  buffer_load_dwordx4 a[156:159], v2, s[40:43], s67 offen offset:0 sc1
  s_waitcnt vmcnt(19)
  v_mfma_f32_16x16x32_bf16 a[64:67], v[84:87], a[160:163], a[64:67]
  v_cmp_eq_u32 s[54:55], s70, v25
  v_mfma_f32_16x16x32_bf16 a[68:71], v[84:87], a[164:167], a[68:71]
  v_mfma_f32_16x16x32_bf16 a[72:75], v[84:87], a[168:171], a[72:75]
  v_cmp_eq_u32 s[56:57], s70, v26
  v_mfma_f32_16x16x32_bf16 a[76:79], v[84:87], a[172:175], a[76:79]
  buffer_load_dwordx4 a[240:243], v2, s[40:43], s13 offen offset:0 sc1
  v_mfma_f32_16x16x32_bf16 a[80:83], v[88:91], a[160:163], a[80:83]
  v_mfma_f32_16x16x32_bf16 a[84:87], v[88:91], a[164:167], a[84:87]
  v_cndmask_b32 v27, v27, 2, s[52:53]
  v_mfma_f32_16x16x32_bf16 a[88:91], v[88:91], a[168:171], a[88:91]
  v_cndmask_b32 v28, v28, 2, s[54:55]
  v_mfma_f32_16x16x32_bf16 a[92:95], v[88:91], a[172:175], a[92:95]
  buffer_load_dwordx4 a[244:247], v2, s[40:43], s13 offen offset:1024 sc1
  v_mfma_f32_16x16x32_bf16 a[96:99], v[92:95], a[160:163], a[96:99]
  v_mfma_f32_16x16x32_bf16 a[100:103], v[92:95], a[164:167], a[100:103]
  v_cndmask_b32 v29, v29, 2, s[56:57]
  v_mfma_f32_16x16x32_bf16 a[104:107], v[92:95], a[168:171], a[104:107]
  v_mfma_f32_16x16x32_bf16 a[108:111], v[92:95], a[172:175], a[108:111]
  v_mfma_f32_16x16x32_bf16 a[112:115], v[128:131], a[160:163], a[112:115]
  v_mfma_f32_16x16x32_bf16 a[116:119], v[128:131], a[164:167], a[116:119]
  v_cmp_eq_u32 s[52:53], s71, v24
  v_mfma_f32_16x16x32_bf16 a[120:123], v[128:131], a[168:171], a[120:123]
  v_cmp_eq_u32 s[54:55], s71, v25
  v_mfma_f32_16x16x32_bf16 a[124:127], v[128:131], a[172:175], a[124:127]
  v_mfma_f32_16x16x32_bf16 a[128:131], v[132:135], a[160:163], a[128:131]
  buffer_load_dwordx4 a[160:163], v2, s[40:43], s64 offen offset:1024 sc1
  v_mfma_f32_16x16x32_bf16 a[132:135], v[132:135], a[164:167], a[132:135]
  buffer_load_dwordx4 a[164:167], v2, s[40:43], s65 offen offset:1024 sc1
  v_mfma_f32_16x16x32_bf16 a[136:139], v[132:135], a[168:171], a[136:139]
  buffer_load_dwordx4 a[168:171], v2, s[40:43], s66 offen offset:1024 sc1
  v_mfma_f32_16x16x32_bf16 a[140:143], v[132:135], a[172:175], a[140:143]
  buffer_load_dwordx4 a[172:175], v2, s[40:43], s67 offen offset:1024 sc1
  s_waitcnt vmcnt(18)
  v_mfma_f32_16x16x32_bf16 a[64:67], v[136:139], a[176:179], a[64:67]
  v_cmp_eq_u32 s[56:57], s71, v26
  v_mfma_f32_16x16x32_bf16 a[68:71], v[136:139], a[180:183], a[68:71]
  v_mfma_f32_16x16x32_bf16 a[72:75], v[136:139], a[184:187], a[72:75]
  v_cndmask_b32 v27, v27, 3, s[52:53]
  v_mfma_f32_16x16x32_bf16 a[76:79], v[136:139], a[188:191], a[76:79]
  buffer_load_dwordx4 a[248:251], v2, s[40:43], s13 offen offset:2048 sc1
  v_mfma_f32_16x16x32_bf16 a[80:83], v[140:143], a[176:179], a[80:83]
  v_mfma_f32_16x16x32_bf16 a[84:87], v[140:143], a[180:183], a[84:87]
  v_cndmask_b32 v28, v28, 3, s[54:55]
  v_mfma_f32_16x16x32_bf16 a[88:91], v[140:143], a[184:187], a[88:91]
  v_cndmask_b32 v29, v29, 3, s[56:57]
  v_mfma_f32_16x16x32_bf16 a[92:95], v[140:143], a[188:191], a[92:95]
  buffer_load_dwordx4 a[252:255], v2, s[40:43], s13 offen offset:3072 sc1
  v_mfma_f32_16x16x32_bf16 a[96:99], v[144:147], a[176:179], a[96:99]
  s_add_u32 s13, s13, 4096
  v_mfma_f32_16x16x32_bf16 a[100:103], v[144:147], a[180:183], a[100:103]
  v_cmp_eq_u32 s[52:53], s72, v24
  v_mfma_f32_16x16x32_bf16 a[104:107], v[144:147], a[184:187], a[104:107]
  v_mfma_f32_16x16x32_bf16 a[108:111], v[144:147], a[188:191], a[108:111]
  v_mfma_f32_16x16x32_bf16 a[112:115], v[148:151], a[176:179], a[112:115]
  v_mfma_f32_16x16x32_bf16 a[116:119], v[148:151], a[180:183], a[116:119]
  v_cmp_eq_u32 s[54:55], s72, v25
  v_mfma_f32_16x16x32_bf16 a[120:123], v[148:151], a[184:187], a[120:123]
  v_cmp_eq_u32 s[56:57], s72, v26
  v_mfma_f32_16x16x32_bf16 a[124:127], v[148:151], a[188:191], a[124:127]
  v_mfma_f32_16x16x32_bf16 a[128:131], v[152:155], a[176:179], a[128:131]
  buffer_load_dwordx4 a[176:179], v2, s[40:43], s64 offen offset:2048 sc1
  v_mfma_f32_16x16x32_bf16 a[132:135], v[152:155], a[180:183], a[132:135]
  buffer_load_dwordx4 a[180:183], v2, s[40:43], s65 offen offset:2048 sc1
  v_mfma_f32_16x16x32_bf16 a[136:139], v[152:155], a[184:187], a[136:139]
  buffer_load_dwordx4 a[184:187], v2, s[40:43], s66 offen offset:2048 sc1
  v_mfma_f32_16x16x32_bf16 a[140:143], v[152:155], a[188:191], a[140:143]
  buffer_load_dwordx4 a[188:191], v2, s[40:43], s67 offen offset:2048 sc1
  s_waitcnt vmcnt(18)
  v_mfma_f32_16x16x32_bf16 a[64:67], v[156:159], v[216:219], a[64:67]
  v_cndmask_b32 v27, v27, 4, s[52:53]
  v_mfma_f32_16x16x32_bf16 a[68:71], v[156:159], v[220:223], a[68:71]
  v_mfma_f32_16x16x32_bf16 a[72:75], v[156:159], v[224:227], a[72:75]
  v_cndmask_b32 v28, v28, 4, s[54:55]
  v_mfma_f32_16x16x32_bf16 a[76:79], v[156:159], v[228:231], a[76:79]
  buffer_load_dwordx4 v[32:35], v2, s[40:43], s13 offen offset:0 sc1
  v_mfma_f32_16x16x32_bf16 a[80:83], v[176:179], v[216:219], a[80:83]
  v_mfma_f32_16x16x32_bf16 a[84:87], v[176:179], v[220:223], a[84:87]
  v_cndmask_b32 v29, v29, 4, s[56:57]
  v_mfma_f32_16x16x32_bf16 a[88:91], v[176:179], v[224:227], a[88:91]
  v_cmp_eq_u32 s[52:53], s73, v24
  v_mfma_f32_16x16x32_bf16 a[92:95], v[176:179], v[228:231], a[92:95]
  buffer_load_dwordx4 v[36:39], v2, s[40:43], s13 offen offset:1024 sc1
  v_mfma_f32_16x16x32_bf16 a[96:99], v[180:183], v[216:219], a[96:99]
  v_mfma_f32_16x16x32_bf16 a[100:103], v[180:183], v[220:223], a[100:103]
  v_cmp_eq_u32 s[54:55], s73, v25
  v_mfma_f32_16x16x32_bf16 a[104:107], v[180:183], v[224:227], a[104:107]
  v_mfma_f32_16x16x32_bf16 a[108:111], v[180:183], v[228:231], a[108:111]
  v_mfma_f32_16x16x32_bf16 a[112:115], v[184:187], v[216:219], a[112:115]
  v_mfma_f32_16x16x32_bf16 a[116:119], v[184:187], v[220:223], a[116:119]
  v_cmp_eq_u32 s[56:57], s73, v26
  v_mfma_f32_16x16x32_bf16 a[120:123], v[184:187], v[224:227], a[120:123]
  v_cndmask_b32 v27, v27, 5, s[52:53]
  v_mfma_f32_16x16x32_bf16 a[124:127], v[184:187], v[228:231], a[124:127]
  v_mfma_f32_16x16x32_bf16 a[128:131], v[188:191], v[216:219], a[128:131]
  buffer_load_dwordx4 v[216:219], v2, s[40:43], s64 offen offset:3072 sc1
  v_mfma_f32_16x16x32_bf16 a[132:135], v[188:191], v[220:223], a[132:135]
  buffer_load_dwordx4 v[220:223], v2, s[40:43], s65 offen offset:3072 sc1
  v_mfma_f32_16x16x32_bf16 a[136:139], v[188:191], v[224:227], a[136:139]
  buffer_load_dwordx4 v[224:227], v2, s[40:43], s66 offen offset:3072 sc1
  v_mfma_f32_16x16x32_bf16 a[140:143], v[188:191], v[228:231], a[140:143]
  buffer_load_dwordx4 v[228:231], v2, s[40:43], s67 offen offset:3072 sc1
  s_waitcnt vmcnt(18)
  v_mfma_f32_16x16x32_bf16 a[64:67], a[0:3], a[144:147], a[64:67]
  s_add_u32 s64, s64, 4096
  v_cndmask_b32 v28, v28, 5, s[54:55]
  v_mfma_f32_16x16x32_bf16 a[68:71], a[0:3], a[148:151], a[68:71]
  s_add_u32 s65, s65, 4096
  v_mfma_f32_16x16x32_bf16 a[72:75], a[0:3], a[152:155], a[72:75]
  s_add_u32 s66, s66, 4096
  v_cndmask_b32 v29, v29, 5, s[56:57]
  v_mfma_f32_16x16x32_bf16 a[76:79], a[0:3], a[156:159], a[76:79]
  buffer_load_dwordx4 v[40:43], v2, s[40:43], s13 offen offset:2048 sc1
  v_mfma_f32_16x16x32_bf16 a[80:83], a[4:7], a[144:147], a[80:83]
  v_mfma_f32_16x16x32_bf16 a[84:87], a[4:7], a[148:151], a[84:87]
  v_cmp_eq_u32 s[52:53], s74, v24
  v_mfma_f32_16x16x32_bf16 a[88:91], a[4:7], a[152:155], a[88:91]
  s_add_u32 s67, s67, 4096
  v_cmp_eq_u32 s[54:55], s74, v25
  v_mfma_f32_16x16x32_bf16 a[92:95], a[4:7], a[156:159], a[92:95]
  buffer_load_dwordx4 v[44:47], v2, s[40:43], s13 offen offset:3072 sc1
  v_mfma_f32_16x16x32_bf16 a[96:99], a[8:11], a[144:147], a[96:99]
  s_add_u32 s13, s13, 4096
  v_mfma_f32_16x16x32_bf16 a[100:103], a[8:11], a[148:151], a[100:103]
  v_cmp_eq_u32 s[56:57], s74, v26
  v_mfma_f32_16x16x32_bf16 a[104:107], a[8:11], a[152:155], a[104:107]
  v_mfma_f32_16x16x32_bf16 a[108:111], a[8:11], a[156:159], a[108:111]
  v_mfma_f32_16x16x32_bf16 a[112:115], a[12:15], a[144:147], a[112:115]
  v_mfma_f32_16x16x32_bf16 a[116:119], a[12:15], a[148:151], a[116:119]
  v_cndmask_b32 v27, v27, 6, s[52:53]
  v_mfma_f32_16x16x32_bf16 a[120:123], a[12:15], a[152:155], a[120:123]
  v_cndmask_b32 v28, v28, 6, s[54:55]
  v_mfma_f32_16x16x32_bf16 a[124:127], a[12:15], a[156:159], a[124:127]
  v_mfma_f32_16x16x32_bf16 a[128:131], a[16:19], a[144:147], a[128:131]
  buffer_load_dwordx4 a[144:147], v2, s[40:43], s64 offen offset:0 sc1
  v_mfma_f32_16x16x32_bf16 a[132:135], a[16:19], a[148:151], a[132:135]
  buffer_load_dwordx4 a[148:151], v2, s[40:43], s65 offen offset:0 sc1
  v_mfma_f32_16x16x32_bf16 a[136:139], a[16:19], a[152:155], a[136:139]
  buffer_load_dwordx4 a[152:155], v2, s[40:43], s66 offen offset:0 sc1
  v_mfma_f32_16x16x32_bf16 a[140:143], a[16:19], a[156:159], a[140:143]
  buffer_load_dwordx4 a[156:159], v2, s[40:43], s67 offen offset:0 sc1
  s_waitcnt vmcnt(18)
  v_mfma_f32_16x16x32_bf16 a[64:67], a[20:23], a[160:163], a[64:67]
  v_cndmask_b32 v29, v29, 6, s[56:57]
  v_mfma_f32_16x16x32_bf16 a[68:71], a[20:23], a[164:167], a[68:71]
  v_mfma_f32_16x16x32_bf16 a[72:75], a[20:23], a[168:171], a[72:75]
  v_cmp_eq_u32 s[52:53], s75, v24
  v_mfma_f32_16x16x32_bf16 a[76:79], a[20:23], a[172:175], a[76:79]
  buffer_load_dwordx4 v[48:51], v2, s[40:43], s13 offen offset:0 sc1
  v_mfma_f32_16x16x32_bf16 a[80:83], a[24:27], a[160:163], a[80:83]
  v_mfma_f32_16x16x32_bf16 a[84:87], a[24:27], a[164:167], a[84:87]
  v_cmp_eq_u32 s[54:55], s75, v25
  v_mfma_f32_16x16x32_bf16 a[88:91], a[24:27], a[168:171], a[88:91]
  v_cmp_eq_u32 s[56:57], s75, v26
  v_mfma_f32_16x16x32_bf16 a[92:95], a[24:27], a[172:175], a[92:95]
  buffer_load_dwordx4 v[52:55], v2, s[40:43], s13 offen offset:1024 sc1
  v_mfma_f32_16x16x32_bf16 a[96:99], a[28:31], a[160:163], a[96:99]
  v_mfma_f32_16x16x32_bf16 a[100:103], a[28:31], a[164:167], a[100:103]
  v_cndmask_b32 v27, v27, 7, s[52:53]
  v_mfma_f32_16x16x32_bf16 a[104:107], a[28:31], a[168:171], a[104:107]
  v_mfma_f32_16x16x32_bf16 a[108:111], a[28:31], a[172:175], a[108:111]
  v_mfma_f32_16x16x32_bf16 a[112:115], a[32:35], a[160:163], a[112:115]
  v_mfma_f32_16x16x32_bf16 a[116:119], a[32:35], a[164:167], a[116:119]
  v_cndmask_b32 v28, v28, 7, s[54:55]
  v_mfma_f32_16x16x32_bf16 a[120:123], a[32:35], a[168:171], a[120:123]
  v_cndmask_b32 v29, v29, 7, s[56:57]
  v_mfma_f32_16x16x32_bf16 a[124:127], a[32:35], a[172:175], a[124:127]
  v_mfma_f32_16x16x32_bf16 a[128:131], a[36:39], a[160:163], a[128:131]
  buffer_load_dwordx4 a[160:163], v2, s[40:43], s64 offen offset:1024 sc1
  v_mfma_f32_16x16x32_bf16 a[132:135], a[36:39], a[164:167], a[132:135]
  buffer_load_dwordx4 a[164:167], v2, s[40:43], s65 offen offset:1024 sc1
  v_mfma_f32_16x16x32_bf16 a[136:139], a[36:39], a[168:171], a[136:139]
  buffer_load_dwordx4 a[168:171], v2, s[40:43], s66 offen offset:1024 sc1
  v_mfma_f32_16x16x32_bf16 a[140:143], a[36:39], a[172:175], a[140:143]
  buffer_load_dwordx4 a[172:175], v2, s[40:43], s67 offen offset:1024 sc1
  s_waitcnt vmcnt(18)
  v_mfma_f32_16x16x32_bf16 a[64:67], a[40:43], a[176:179], a[64:67]
  v_mul_u32_u24 v27, 320, v27
  v_mfma_f32_16x16x32_bf16 a[68:71], a[40:43], a[180:183], a[68:71]
  v_mfma_f32_16x16x32_bf16 a[72:75], a[40:43], a[184:187], a[72:75]
  v_add_u32 v203, v203, v27
  v_mfma_f32_16x16x32_bf16 a[76:79], a[40:43], a[188:191], a[76:79]
  buffer_load_dwordx4 v[56:59], v2, s[40:43], s13 offen offset:2048 sc1
  v_mfma_f32_16x16x32_bf16 a[80:83], a[44:47], a[176:179], a[80:83]
  v_mfma_f32_16x16x32_bf16 a[84:87], a[44:47], a[180:183], a[84:87]
  v_add_u32 v203, 155648, v203
  v_mfma_f32_16x16x32_bf16 a[88:91], a[44:47], a[184:187], a[88:91]
  v_mul_u32_u24 v28, 320, v28
  v_mfma_f32_16x16x32_bf16 a[92:95], a[44:47], a[188:191], a[92:95]
  buffer_load_dwordx4 v[60:63], v2, s[40:43], s13 offen offset:3072 sc1
  v_mfma_f32_16x16x32_bf16 a[96:99], a[48:51], a[176:179], a[96:99]
  s_add_u32 s13, s13, 4096
  v_mfma_f32_16x16x32_bf16 a[100:103], a[48:51], a[180:183], a[100:103]
  v_add_u32 v204, v204, v28
  v_mfma_f32_16x16x32_bf16 a[104:107], a[48:51], a[184:187], a[104:107]
  v_mfma_f32_16x16x32_bf16 a[108:111], a[48:51], a[188:191], a[108:111]
  v_mfma_f32_16x16x32_bf16 a[112:115], a[52:55], a[176:179], a[112:115]
  v_mfma_f32_16x16x32_bf16 a[116:119], a[52:55], a[180:183], a[116:119]
  v_add_u32 v204, 155648, v204
  v_mfma_f32_16x16x32_bf16 a[120:123], a[52:55], a[184:187], a[120:123]
  v_mul_u32_u24 v29, 320, v29
  v_mfma_f32_16x16x32_bf16 a[124:127], a[52:55], a[188:191], a[124:127]
  v_mfma_f32_16x16x32_bf16 a[128:131], a[56:59], a[176:179], a[128:131]
  buffer_load_dwordx4 a[176:179], v2, s[40:43], s64 offen offset:2048 sc1
  v_mfma_f32_16x16x32_bf16 a[132:135], a[56:59], a[180:183], a[132:135]
  buffer_load_dwordx4 a[180:183], v2, s[40:43], s65 offen offset:2048 sc1
  v_mfma_f32_16x16x32_bf16 a[136:139], a[56:59], a[184:187], a[136:139]
  buffer_load_dwordx4 a[184:187], v2, s[40:43], s66 offen offset:2048 sc1
  v_mfma_f32_16x16x32_bf16 a[140:143], a[56:59], a[188:191], a[140:143]
  buffer_load_dwordx4 a[188:191], v2, s[40:43], s67 offen offset:2048 sc1
  s_waitcnt vmcnt(18)
  v_mfma_f32_16x16x32_bf16 a[64:67], a[60:63], v[216:219], a[64:67]
  v_add_u32 v205, v205, v29
  v_mfma_f32_16x16x32_bf16 a[68:71], a[60:63], v[220:223], a[68:71]
  v_mfma_f32_16x16x32_bf16 a[72:75], a[60:63], v[224:227], a[72:75]
  v_add_u32 v205, 155648, v205
  v_mfma_f32_16x16x32_bf16 a[76:79], a[60:63], v[228:231], a[76:79]
  buffer_load_dwordx4 v[96:99], v2, s[40:43], s13 offen offset:0 sc1
  v_mfma_f32_16x16x32_bf16 a[80:83], a[192:195], v[216:219], a[80:83]
  v_mfma_f32_16x16x32_bf16 a[84:87], a[192:195], v[220:223], a[84:87]
  v_mfma_f32_16x16x32_bf16 a[88:91], a[192:195], v[224:227], a[88:91]
  v_mfma_f32_16x16x32_bf16 a[92:95], a[192:195], v[228:231], a[92:95]
  buffer_load_dwordx4 v[100:103], v2, s[40:43], s13 offen offset:1024 sc1
  v_mfma_f32_16x16x32_bf16 a[96:99], a[196:199], v[216:219], a[96:99]
  v_mfma_f32_16x16x32_bf16 a[100:103], a[196:199], v[220:223], a[100:103]
  v_mfma_f32_16x16x32_bf16 a[104:107], a[196:199], v[224:227], a[104:107]
  v_mfma_f32_16x16x32_bf16 a[108:111], a[196:199], v[228:231], a[108:111]
  v_mfma_f32_16x16x32_bf16 a[112:115], a[200:203], v[216:219], a[112:115]
  v_mfma_f32_16x16x32_bf16 a[116:119], a[200:203], v[220:223], a[116:119]
  v_mfma_f32_16x16x32_bf16 a[120:123], a[200:203], v[224:227], a[120:123]
  v_mfma_f32_16x16x32_bf16 a[124:127], a[200:203], v[228:231], a[124:127]
  v_mfma_f32_16x16x32_bf16 a[128:131], a[204:207], v[216:219], a[128:131]
  buffer_load_dwordx4 v[216:219], v2, s[40:43], s64 offen offset:3072 sc1
  v_mfma_f32_16x16x32_bf16 a[132:135], a[204:207], v[220:223], a[132:135]
  buffer_load_dwordx4 v[220:223], v2, s[40:43], s65 offen offset:3072 sc1
  v_mfma_f32_16x16x32_bf16 a[136:139], a[204:207], v[224:227], a[136:139]
  buffer_load_dwordx4 v[224:227], v2, s[40:43], s66 offen offset:3072 sc1
  v_mfma_f32_16x16x32_bf16 a[140:143], a[204:207], v[228:231], a[140:143]
  buffer_load_dwordx4 v[228:231], v2, s[40:43], s67 offen offset:3072 sc1
  s_waitcnt vmcnt(18)
  v_mfma_f32_16x16x32_bf16 a[64:67], a[208:211], a[144:147], a[64:67]
  s_add_u32 s64, s64, 4096
  v_mfma_f32_16x16x32_bf16 a[68:71], a[208:211], a[148:151], a[68:71]
  s_add_u32 s65, s65, 4096
  v_mfma_f32_16x16x32_bf16 a[72:75], a[208:211], a[152:155], a[72:75]
  s_add_u32 s66, s66, 4096
  v_mfma_f32_16x16x32_bf16 a[76:79], a[208:211], a[156:159], a[76:79]
  buffer_load_dwordx4 v[104:107], v2, s[40:43], s13 offen offset:2048 sc1
  v_mfma_f32_16x16x32_bf16 a[80:83], a[212:215], a[144:147], a[80:83]
  v_mfma_f32_16x16x32_bf16 a[84:87], a[212:215], a[148:151], a[84:87]
  v_mfma_f32_16x16x32_bf16 a[88:91], a[212:215], a[152:155], a[88:91]
  s_add_u32 s67, s67, 4096
  v_mfma_f32_16x16x32_bf16 a[92:95], a[212:215], a[156:159], a[92:95]
  buffer_load_dwordx4 v[108:111], v2, s[40:43], s13 offen offset:3072 sc1
  v_mfma_f32_16x16x32_bf16 a[96:99], a[216:219], a[144:147], a[96:99]
  s_add_u32 s13, s13, 4096
  v_mfma_f32_16x16x32_bf16 a[100:103], a[216:219], a[148:151], a[100:103]
  v_mfma_f32_16x16x32_bf16 a[104:107], a[216:219], a[152:155], a[104:107]
  v_mfma_f32_16x16x32_bf16 a[108:111], a[216:219], a[156:159], a[108:111]
  v_mfma_f32_16x16x32_bf16 a[112:115], a[220:223], a[144:147], a[112:115]
  v_mfma_f32_16x16x32_bf16 a[116:119], a[220:223], a[148:151], a[116:119]
  v_mfma_f32_16x16x32_bf16 a[120:123], a[220:223], a[152:155], a[120:123]
  v_mfma_f32_16x16x32_bf16 a[124:127], a[220:223], a[156:159], a[124:127]
  v_mfma_f32_16x16x32_bf16 a[128:131], a[224:227], a[144:147], a[128:131]
  buffer_load_dwordx4 a[144:147], v2, s[40:43], s64 offen offset:0 sc1
  v_mfma_f32_16x16x32_bf16 a[132:135], a[224:227], a[148:151], a[132:135]
  buffer_load_dwordx4 a[148:151], v2, s[40:43], s65 offen offset:0 sc1
  v_mfma_f32_16x16x32_bf16 a[136:139], a[224:227], a[152:155], a[136:139]
  buffer_load_dwordx4 a[152:155], v2, s[40:43], s66 offen offset:0 sc1
  v_mfma_f32_16x16x32_bf16 a[140:143], a[224:227], a[156:159], a[140:143]
  buffer_load_dwordx4 a[156:159], v2, s[40:43], s67 offen offset:0 sc1
  s_waitcnt vmcnt(18)
  v_mfma_f32_16x16x32_bf16 a[64:67], a[228:231], a[160:163], a[64:67]
  v_mfma_f32_16x16x32_bf16 a[68:71], a[228:231], a[164:167], a[68:71]
  v_mfma_f32_16x16x32_bf16 a[72:75], a[228:231], a[168:171], a[72:75]
  v_mfma_f32_16x16x32_bf16 a[76:79], a[228:231], a[172:175], a[76:79]
  v_mfma_f32_16x16x32_bf16 a[80:83], a[232:235], a[160:163], a[80:83]
  v_mfma_f32_16x16x32_bf16 a[84:87], a[232:235], a[164:167], a[84:87]
  v_mfma_f32_16x16x32_bf16 a[88:91], a[232:235], a[168:171], a[88:91]
  v_mfma_f32_16x16x32_bf16 a[92:95], a[232:235], a[172:175], a[92:95]
  v_mfma_f32_16x16x32_bf16 a[96:99], a[236:239], a[160:163], a[96:99]
  v_mfma_f32_16x16x32_bf16 a[100:103], a[236:239], a[164:167], a[100:103]
  v_mfma_f32_16x16x32_bf16 a[104:107], a[236:239], a[168:171], a[104:107]
  v_mfma_f32_16x16x32_bf16 a[108:111], a[236:239], a[172:175], a[108:111]
  v_mfma_f32_16x16x32_bf16 a[112:115], a[240:243], a[160:163], a[112:115]
  v_mfma_f32_16x16x32_bf16 a[116:119], a[240:243], a[164:167], a[116:119]
  v_mfma_f32_16x16x32_bf16 a[120:123], a[240:243], a[168:171], a[120:123]
  v_mfma_f32_16x16x32_bf16 a[124:127], a[240:243], a[172:175], a[124:127]
  v_mfma_f32_16x16x32_bf16 a[128:131], a[244:247], a[160:163], a[128:131]
  buffer_load_dwordx4 a[160:163], v2, s[40:43], s64 offen offset:1024 sc1
  v_mfma_f32_16x16x32_bf16 a[132:135], a[244:247], a[164:167], a[132:135]
  buffer_load_dwordx4 a[164:167], v2, s[40:43], s65 offen offset:1024 sc1
  v_mfma_f32_16x16x32_bf16 a[136:139], a[244:247], a[168:171], a[136:139]
  buffer_load_dwordx4 a[168:171], v2, s[40:43], s66 offen offset:1024 sc1
  v_mfma_f32_16x16x32_bf16 a[140:143], a[244:247], a[172:175], a[140:143]
  buffer_load_dwordx4 a[172:175], v2, s[40:43], s67 offen offset:1024 sc1
  s_waitcnt vmcnt(16)
  v_mfma_f32_16x16x32_bf16 a[64:67], a[248:251], a[176:179], a[64:67]
  v_mfma_f32_16x16x32_bf16 a[68:71], a[248:251], a[180:183], a[68:71]
  v_mfma_f32_16x16x32_bf16 a[72:75], a[248:251], a[184:187], a[72:75]
  v_mfma_f32_16x16x32_bf16 a[76:79], a[248:251], a[188:191], a[76:79]
  v_mfma_f32_16x16x32_bf16 a[80:83], a[252:255], a[176:179], a[80:83]
  v_mfma_f32_16x16x32_bf16 a[84:87], a[252:255], a[180:183], a[84:87]
  v_mfma_f32_16x16x32_bf16 a[88:91], a[252:255], a[184:187], a[88:91]
  v_mfma_f32_16x16x32_bf16 a[92:95], a[252:255], a[188:191], a[92:95]
  v_mfma_f32_16x16x32_bf16 a[96:99], v[32:35], a[176:179], a[96:99]
  v_mfma_f32_16x16x32_bf16 a[100:103], v[32:35], a[180:183], a[100:103]
  v_mfma_f32_16x16x32_bf16 a[104:107], v[32:35], a[184:187], a[104:107]
  v_mfma_f32_16x16x32_bf16 a[108:111], v[32:35], a[188:191], a[108:111]
  v_mfma_f32_16x16x32_bf16 a[112:115], v[36:39], a[176:179], a[112:115]
  v_mfma_f32_16x16x32_bf16 a[116:119], v[36:39], a[180:183], a[116:119]
  v_mfma_f32_16x16x32_bf16 a[120:123], v[36:39], a[184:187], a[120:123]
  v_mfma_f32_16x16x32_bf16 a[124:127], v[36:39], a[188:191], a[124:127]
  v_mfma_f32_16x16x32_bf16 a[128:131], v[40:43], a[176:179], a[128:131]
  buffer_load_dwordx4 a[176:179], v2, s[40:43], s64 offen offset:2048 sc1
  v_mfma_f32_16x16x32_bf16 a[132:135], v[40:43], a[180:183], a[132:135]
  buffer_load_dwordx4 a[180:183], v2, s[40:43], s65 offen offset:2048 sc1
  v_mfma_f32_16x16x32_bf16 a[136:139], v[40:43], a[184:187], a[136:139]
  buffer_load_dwordx4 a[184:187], v2, s[40:43], s66 offen offset:2048 sc1
  v_mfma_f32_16x16x32_bf16 a[140:143], v[40:43], a[188:191], a[140:143]
  buffer_load_dwordx4 a[188:191], v2, s[40:43], s67 offen offset:2048 sc1
  s_waitcnt vmcnt(14)
  v_mfma_f32_16x16x32_bf16 a[64:67], v[44:47], v[216:219], a[64:67]
  ds_read_b128 v[112:115], v11 offset:0
  v_mfma_f32_16x16x32_bf16 a[68:71], v[44:47], v[220:223], a[68:71]
  v_mfma_f32_16x16x32_bf16 a[72:75], v[44:47], v[224:227], a[72:75]
  v_mfma_f32_16x16x32_bf16 a[76:79], v[44:47], v[228:231], a[76:79]
  v_mfma_f32_16x16x32_bf16 a[80:83], v[48:51], v[216:219], a[80:83]
  v_mfma_f32_16x16x32_bf16 a[84:87], v[48:51], v[220:223], a[84:87]
  v_mfma_f32_16x16x32_bf16 a[88:91], v[48:51], v[224:227], a[88:91]
  v_mfma_f32_16x16x32_bf16 a[92:95], v[48:51], v[228:231], a[92:95]
  v_mfma_f32_16x16x32_bf16 a[96:99], v[52:55], v[216:219], a[96:99]
  v_mfma_f32_16x16x32_bf16 a[100:103], v[52:55], v[220:223], a[100:103]
  v_mfma_f32_16x16x32_bf16 a[104:107], v[52:55], v[224:227], a[104:107]
  v_mfma_f32_16x16x32_bf16 a[108:111], v[52:55], v[228:231], a[108:111]
  v_mfma_f32_16x16x32_bf16 a[112:115], v[56:59], v[216:219], a[112:115]
  v_mfma_f32_16x16x32_bf16 a[116:119], v[56:59], v[220:223], a[116:119]
  v_mfma_f32_16x16x32_bf16 a[120:123], v[56:59], v[224:227], a[120:123]
  v_mfma_f32_16x16x32_bf16 a[124:127], v[56:59], v[228:231], a[124:127]
  v_mfma_f32_16x16x32_bf16 a[128:131], v[60:63], v[216:219], a[128:131]
  buffer_load_dwordx4 v[216:219], v2, s[40:43], s64 offen offset:3072 sc1
  v_mfma_f32_16x16x32_bf16 a[132:135], v[60:63], v[220:223], a[132:135]
  buffer_load_dwordx4 v[220:223], v2, s[40:43], s65 offen offset:3072 sc1
  v_mfma_f32_16x16x32_bf16 a[136:139], v[60:63], v[224:227], a[136:139]
  buffer_load_dwordx4 v[224:227], v2, s[40:43], s66 offen offset:3072 sc1
  v_mfma_f32_16x16x32_bf16 a[140:143], v[60:63], v[228:231], a[140:143]
  buffer_load_dwordx4 v[228:231], v2, s[40:43], s67 offen offset:3072 sc1
  s_waitcnt vmcnt(12) lgkmcnt(0)
  v_mfma_f32_16x16x32_bf16 a[64:67], v[96:99], a[144:147], a[64:67]
  s_add_u32 s64, s64, 4096
  ds_read_b128 v[116:119], v11 offset:1024
  v_mfma_f32_16x16x32_bf16 a[68:71], v[96:99], a[148:151], a[68:71]
  s_add_u32 s65, s65, 4096
  v_mfma_f32_16x16x32_bf16 a[72:75], v[96:99], a[152:155], a[72:75]
  s_add_u32 s66, s66, 4096
  ds_read_b128 v[120:123], v11 offset:2048
  v_mfma_f32_16x16x32_bf16 a[76:79], v[96:99], a[156:159], a[76:79]
  buffer_load_dwordx4 v[32:35], v248, s[44:47], 0 offen
  v_mfma_f32_16x16x32_bf16 a[80:83], v[100:103], a[144:147], a[80:83]
  ds_read_b128 v[124:127], v11 offset:3072
  v_mfma_f32_16x16x32_bf16 a[84:87], v[100:103], a[148:151], a[84:87]
  buffer_load_dwordx4 v[44:47], v200, s[40:43], s27 offen sc1
  v_mfma_f32_16x16x32_bf16 a[88:91], v[100:103], a[152:155], a[88:91]
  s_add_u32 s67, s67, 4096
  ds_read_b128 v[160:163], v11 offset:4096
  v_mfma_f32_16x16x32_bf16 a[92:95], v[100:103], a[156:159], a[92:95]
  buffer_load_dwordx4 v[36:39], v249, s[44:47], 0 offen
  v_mfma_f32_16x16x32_bf16 a[96:99], v[104:107], a[144:147], a[96:99]
  ds_read_b128 v[164:167], v11 offset:5120
  v_mfma_f32_16x16x32_bf16 a[100:103], v[104:107], a[148:151], a[100:103]
  buffer_load_dwordx4 v[48:51], v201, s[40:43], s27 offen sc1
  v_mfma_f32_16x16x32_bf16 a[104:107], v[104:107], a[152:155], a[104:107]
  v_mfma_f32_16x16x32_bf16 a[108:111], v[104:107], a[156:159], a[108:111]
  buffer_load_dwordx4 v[40:43], v250, s[44:47], 0 offen
  v_mfma_f32_16x16x32_bf16 a[112:115], v[108:111], a[144:147], a[112:115]
  v_mfma_f32_16x16x32_bf16 a[116:119], v[108:111], a[148:151], a[116:119]
  buffer_load_dwordx4 v[52:55], v202, s[40:43], s27 offen sc1
  v_mfma_f32_16x16x32_bf16 a[120:123], v[108:111], a[152:155], a[120:123]
  v_mfma_f32_16x16x32_bf16 a[124:127], v[108:111], a[156:159], a[124:127]
  v_mfma_f32_16x16x32_bf16 a[128:131], v[112:115], a[144:147], a[128:131]
  buffer_load_dwordx4 a[144:147], v2, s[40:43], s64 offen offset:0 sc1
  v_mfma_f32_16x16x32_bf16 a[132:135], v[112:115], a[148:151], a[132:135]
  buffer_load_dwordx4 a[148:151], v2, s[40:43], s65 offen offset:0 sc1
  v_mfma_f32_16x16x32_bf16 a[136:139], v[112:115], a[152:155], a[136:139]
  buffer_load_dwordx4 a[152:155], v2, s[40:43], s66 offen offset:0 sc1
  v_mfma_f32_16x16x32_bf16 a[140:143], v[112:115], a[156:159], a[140:143]
  buffer_load_dwordx4 a[156:159], v2, s[40:43], s67 offen offset:0 sc1
  s_waitcnt vmcnt(18) lgkmcnt(0)
  v_mfma_f32_16x16x32_bf16 a[64:67], v[116:119], a[160:163], a[64:67]
  ds_read_b128 v[168:171], v11 offset:6144
  v_mfma_f32_16x16x32_bf16 a[68:71], v[116:119], a[164:167], a[68:71]
  v_mfma_f32_16x16x32_bf16 a[72:75], v[116:119], a[168:171], a[72:75]
  ds_read_b128 v[172:175], v11 offset:7168
  v_mfma_f32_16x16x32_bf16 a[76:79], v[116:119], a[172:175], a[76:79]
  v_mfma_f32_16x16x32_bf16 a[80:83], v[120:123], a[160:163], a[80:83]
  ds_read_b128 v[192:195], v11 offset:8192
  v_mfma_f32_16x16x32_bf16 a[84:87], v[120:123], a[164:167], a[84:87]
  v_mfma_f32_16x16x32_bf16 a[88:91], v[120:123], a[168:171], a[88:91]
  ds_read_b128 v[196:199], v11 offset:9216
  v_mfma_f32_16x16x32_bf16 a[92:95], v[120:123], a[172:175], a[92:95]
  v_mfma_f32_16x16x32_bf16 a[96:99], v[124:127], a[160:163], a[96:99]
  ds_read_b128 v[208:211], v11 offset:10240
  v_mfma_f32_16x16x32_bf16 a[100:103], v[124:127], a[164:167], a[100:103]
  v_mfma_f32_16x16x32_bf16 a[104:107], v[124:127], a[168:171], a[104:107]
  v_mfma_f32_16x16x32_bf16 a[108:111], v[124:127], a[172:175], a[108:111]
  v_mfma_f32_16x16x32_bf16 a[112:115], v[160:163], a[160:163], a[112:115]
  v_mfma_f32_16x16x32_bf16 a[116:119], v[160:163], a[164:167], a[116:119]
  v_mfma_f32_16x16x32_bf16 a[120:123], v[160:163], a[168:171], a[120:123]
  v_mfma_f32_16x16x32_bf16 a[124:127], v[160:163], a[172:175], a[124:127]
  v_mfma_f32_16x16x32_bf16 a[128:131], v[164:167], a[160:163], a[128:131]
  buffer_load_dwordx4 a[160:163], v2, s[40:43], s64 offen offset:1024 sc1
  v_mfma_f32_16x16x32_bf16 a[132:135], v[164:167], a[164:167], a[132:135]
  buffer_load_dwordx4 a[164:167], v2, s[40:43], s65 offen offset:1024 sc1
  v_mfma_f32_16x16x32_bf16 a[136:139], v[164:167], a[168:171], a[136:139]
  buffer_load_dwordx4 a[168:171], v2, s[40:43], s66 offen offset:1024 sc1
  v_mfma_f32_16x16x32_bf16 a[140:143], v[164:167], a[172:175], a[140:143]
  buffer_load_dwordx4 a[172:175], v2, s[40:43], s67 offen offset:1024 sc1
  s_waitcnt vmcnt(18) lgkmcnt(0)
  v_mfma_f32_16x16x32_bf16 a[64:67], v[168:171], a[176:179], a[64:67]
  ds_read_b128 v[212:215], v11 offset:11264
  v_mfma_f32_16x16x32_bf16 a[68:71], v[168:171], a[180:183], a[68:71]
  v_mfma_f32_16x16x32_bf16 a[72:75], v[168:171], a[184:187], a[72:75]
  ds_read_b128 v[232:235], v11 offset:12288
  v_mfma_f32_16x16x32_bf16 a[76:79], v[168:171], a[188:191], a[76:79]
  v_mfma_f32_16x16x32_bf16 a[80:83], v[172:175], a[176:179], a[80:83]
  ds_read_b128 v[236:239], v11 offset:13312
  v_mfma_f32_16x16x32_bf16 a[84:87], v[172:175], a[180:183], a[84:87]
  v_mfma_f32_16x16x32_bf16 a[88:91], v[172:175], a[184:187], a[88:91]
  ds_read_b128 v[240:243], v11 offset:14336
  v_mfma_f32_16x16x32_bf16 a[92:95], v[172:175], a[188:191], a[92:95]
  v_mfma_f32_16x16x32_bf16 a[96:99], v[192:195], a[176:179], a[96:99]
  ds_read_b128 v[244:247], v11 offset:15360
  v_mfma_f32_16x16x32_bf16 a[100:103], v[192:195], a[180:183], a[100:103]
  v_mfma_f32_16x16x32_bf16 a[104:107], v[192:195], a[184:187], a[104:107]
  v_mfma_f32_16x16x32_bf16 a[108:111], v[192:195], a[188:191], a[108:111]
  v_mfma_f32_16x16x32_bf16 a[112:115], v[196:199], a[176:179], a[112:115]
  v_mfma_f32_16x16x32_bf16 a[116:119], v[196:199], a[180:183], a[116:119]
  v_mfma_f32_16x16x32_bf16 a[120:123], v[196:199], a[184:187], a[120:123]
  v_mfma_f32_16x16x32_bf16 a[124:127], v[196:199], a[188:191], a[124:127]
  v_mfma_f32_16x16x32_bf16 a[128:131], v[208:211], a[176:179], a[128:131]
  buffer_load_dwordx4 a[176:179], v2, s[40:43], s64 offen offset:2048 sc1
  v_mfma_f32_16x16x32_bf16 a[132:135], v[208:211], a[180:183], a[132:135]
  buffer_load_dwordx4 a[180:183], v2, s[40:43], s65 offen offset:2048 sc1
  v_mfma_f32_16x16x32_bf16 a[136:139], v[208:211], a[184:187], a[136:139]
  buffer_load_dwordx4 a[184:187], v2, s[40:43], s66 offen offset:2048 sc1
  v_mfma_f32_16x16x32_bf16 a[140:143], v[208:211], a[188:191], a[140:143]
  buffer_load_dwordx4 a[188:191], v2, s[40:43], s67 offen offset:2048 sc1
  s_waitcnt vmcnt(18) lgkmcnt(0)
  v_mfma_f32_16x16x32_bf16 a[64:67], v[212:215], v[216:219], a[64:67]
  ds_read_b128 v[64:67], v11 offset:16384
  v_mfma_f32_16x16x32_bf16 a[68:71], v[212:215], v[220:223], a[68:71]
  ds_read_b128 v[120:123], v203 offset:0
  v_mfma_f32_16x16x32_bf16 a[72:75], v[212:215], v[224:227], a[72:75]
  ds_read_b128 v[68:71], v11 offset:17408
  v_add_u32 v20, 77824, v251
  v_mfma_f32_16x16x32_bf16 a[76:79], v[212:215], v[228:231], a[76:79]
  ds_read_b128 v[124:127], v203 offset:16
  v_mfma_f32_16x16x32_bf16 a[80:83], v[232:235], v[216:219], a[80:83]
  ds_read_b128 v[72:75], v11 offset:18432
  v_mfma_f32_16x16x32_bf16 a[84:87], v[232:235], v[220:223], a[84:87]
  ds_read_b128 v[160:163], v204 offset:0
  v_mfma_f32_16x16x32_bf16 a[88:91], v[232:235], v[224:227], a[88:91]
  ds_read_b128 v[76:79], v11 offset:19456
  v_add_u32 v21, 77824, v252
  v_mfma_f32_16x16x32_bf16 a[92:95], v[232:235], v[228:231], a[92:95]
  ds_read_b128 v[164:167], v204 offset:16
  v_mfma_f32_16x16x32_bf16 a[96:99], v[236:239], v[216:219], a[96:99]
  ds_read_b128 v[80:83], v11 offset:20480
  v_mfma_f32_16x16x32_bf16 a[100:103], v[236:239], v[220:223], a[100:103]
  ds_read_b128 v[168:171], v205 offset:0
  v_mfma_f32_16x16x32_bf16 a[104:107], v[236:239], v[224:227], a[104:107]
  v_add_u32 v22, 77824, v253
  v_mfma_f32_16x16x32_bf16 a[108:111], v[236:239], v[228:231], a[108:111]
  ds_read_b128 v[172:175], v205 offset:16
  v_mfma_f32_16x16x32_bf16 a[112:115], v[240:243], v[216:219], a[112:115]
  v_mfma_f32_16x16x32_bf16 a[116:119], v[240:243], v[220:223], a[116:119]
  v_mfma_f32_16x16x32_bf16 a[120:123], v[240:243], v[224:227], a[120:123]
  s_mul_i32 s23, s20, 38912
  v_and_b32 v16, 15, v1
  v_mul_u32_u24 v16, 336, v16
  v_mfma_f32_16x16x32_bf16 a[124:127], v[240:243], v[228:231], a[124:127]
  v_lshrrev_b32 v17, 4, v1
  v_lshl_add_u32 v16, v17, 4, v16
  v_mfma_f32_16x16x32_bf16 a[128:131], v[244:247], v[216:219], a[128:131]
  buffer_load_dwordx4 v[216:219], v2, s[40:43], s64 offen offset:3072 sc1
  v_add_u32 v16, s23, v16
  v_mfma_f32_16x16x32_bf16 a[132:135], v[244:247], v[220:223], a[132:135]
  buffer_load_dwordx4 v[220:223], v2, s[40:43], s65 offen offset:3072 sc1
  v_mfma_f32_16x16x32_bf16 a[136:139], v[244:247], v[224:227], a[136:139]
  s_waitcnt lgkmcnt(0)
  buffer_load_dwordx4 v[224:227], v2, s[40:43], s66 offen offset:3072 sc1
  v_mfma_f32_16x16x32_bf16 a[140:143], v[244:247], v[228:231], a[140:143]
  buffer_load_dwordx4 v[228:231], v2, s[40:43], s67 offen offset:3072 sc1
  s_waitcnt vmcnt(12) lgkmcnt(0)
  v_mfma_f32_16x16x32_bf16 a[64:67], v[64:67], a[144:147], a[64:67]
  ds_read_b128 v[84:87], v11 offset:21504
  v_lshlrev_b32 v18, 16, v44
  v_and_b32 v19, 0xffff0000, v44
  v_mfma_f32_16x16x32_bf16 a[68:71], v[64:67], a[148:151], a[68:71]
  v_add_f32 v120, v120, v18
  v_add_f32 v121, v121, v19
  v_mfma_f32_16x16x32_bf16 a[72:75], v[64:67], a[152:155], a[72:75]
  ds_read_b128 v[88:91], v11 offset:22528
  v_cvt_pk_bf16_f32 v18, v120, v121
  v_lshlrev_b32 v96, 16, v32
  v_mfma_f32_16x16x32_bf16 a[76:79], v[64:67], a[156:159], a[76:79]
  v_and_b32 v97, 0xffff0000, v32
  v_lshlrev_b32 v120, 16, v18
  v_mfma_f32_16x16x32_bf16 a[80:83], v[68:71], a[144:147], a[80:83]
  ds_read_b128 v[92:95], v11 offset:23552
  v_and_b32 v121, 0xffff0000, v18
  v_lshlrev_b32 v18, 16, v45
  v_mfma_f32_16x16x32_bf16 a[84:87], v[68:71], a[148:151], a[84:87]
  v_and_b32 v19, 0xffff0000, v45
  v_add_f32 v122, v122, v18
  v_mfma_f32_16x16x32_bf16 a[88:91], v[68:71], a[152:155], a[88:91]
  ds_read_b128 v[128:131], v11 offset:24576
  v_add_f32 v123, v123, v19
  v_cvt_pk_bf16_f32 v18, v122, v123
  v_mfma_f32_16x16x32_bf16 a[92:95], v[68:71], a[156:159], a[92:95]
  v_lshlrev_b32 v98, 16, v33
  v_and_b32 v99, 0xffff0000, v33
  v_mfma_f32_16x16x32_bf16 a[96:99], v[72:75], a[144:147], a[96:99]
  ds_read_b128 v[132:135], v11 offset:25600
  v_lshlrev_b32 v122, 16, v18
  v_and_b32 v123, 0xffff0000, v18
  v_mfma_f32_16x16x32_bf16 a[100:103], v[72:75], a[148:151], a[100:103]
  v_lshlrev_b32 v18, 16, v46
  v_and_b32 v19, 0xffff0000, v46
  v_mfma_f32_16x16x32_bf16 a[104:107], v[72:75], a[152:155], a[104:107]
  v_add_f32 v124, v124, v18
  v_add_f32 v125, v125, v19
  v_mfma_f32_16x16x32_bf16 a[108:111], v[72:75], a[156:159], a[108:111]
  v_cvt_pk_bf16_f32 v18, v124, v125
  v_lshlrev_b32 v100, 16, v34
  v_mfma_f32_16x16x32_bf16 a[112:115], v[76:79], a[144:147], a[112:115]
  v_and_b32 v101, 0xffff0000, v34
  v_lshlrev_b32 v124, 16, v18
  v_mfma_f32_16x16x32_bf16 a[116:119], v[76:79], a[148:151], a[116:119]
  v_and_b32 v125, 0xffff0000, v18
  v_lshlrev_b32 v18, 16, v47
  v_mfma_f32_16x16x32_bf16 a[120:123], v[76:79], a[152:155], a[120:123]
  v_and_b32 v19, 0xffff0000, v47
  v_add_f32 v126, v126, v18
  v_mfma_f32_16x16x32_bf16 a[124:127], v[76:79], a[156:159], a[124:127]
  v_add_f32 v127, v127, v19
  v_cvt_pk_bf16_f32 v18, v126, v127
  v_mfma_f32_16x16x32_bf16 a[128:131], v[80:83], a[144:147], a[128:131]
  v_lshlrev_b32 v102, 16, v35
  v_and_b32 v103, 0xffff0000, v35
  v_mfma_f32_16x16x32_bf16 a[132:135], v[80:83], a[148:151], a[132:135]
  v_lshlrev_b32 v126, 16, v18
  v_and_b32 v127, 0xffff0000, v18
  v_mfma_f32_16x16x32_bf16 a[136:139], v[80:83], a[152:155], a[136:139]
  v_mfma_f32_16x16x32_bf16 a[140:143], v[80:83], a[156:159], a[140:143]
  s_waitcnt vmcnt(8) lgkmcnt(0)
  v_mfma_f32_16x16x32_bf16 a[64:67], v[84:87], a[160:163], a[64:67]
  ds_read_b128 v[136:139], v11 offset:26624
  v_lshlrev_b32 v18, 16, v48
  v_and_b32 v19, 0xffff0000, v48
  v_mfma_f32_16x16x32_bf16 a[68:71], v[84:87], a[164:167], a[68:71]
  v_add_f32 v160, v160, v18
  v_add_f32 v161, v161, v19
  v_mfma_f32_16x16x32_bf16 a[72:75], v[84:87], a[168:171], a[72:75]
  ds_read_b128 v[140:143], v11 offset:27648
  v_cvt_pk_bf16_f32 v18, v160, v161
  v_lshlrev_b32 v104, 16, v36
  v_mfma_f32_16x16x32_bf16 a[76:79], v[84:87], a[172:175], a[76:79]
  v_and_b32 v105, 0xffff0000, v36
  v_lshlrev_b32 v160, 16, v18
  v_mfma_f32_16x16x32_bf16 a[80:83], v[88:91], a[160:163], a[80:83]
  ds_read_b128 v[144:147], v11 offset:28672
  v_and_b32 v161, 0xffff0000, v18
  v_lshlrev_b32 v18, 16, v49
  v_mfma_f32_16x16x32_bf16 a[84:87], v[88:91], a[164:167], a[84:87]
  v_and_b32 v19, 0xffff0000, v49
  v_add_f32 v162, v162, v18
  v_mfma_f32_16x16x32_bf16 a[88:91], v[88:91], a[168:171], a[88:91]
  ds_read_b128 v[148:151], v11 offset:29696
  v_add_f32 v163, v163, v19
  v_cvt_pk_bf16_f32 v18, v162, v163
  v_mfma_f32_16x16x32_bf16 a[92:95], v[88:91], a[172:175], a[92:95]
  v_lshlrev_b32 v106, 16, v37
  v_and_b32 v107, 0xffff0000, v37
  v_mfma_f32_16x16x32_bf16 a[96:99], v[92:95], a[160:163], a[96:99]
  ds_read_b128 v[152:155], v11 offset:30720
  v_lshlrev_b32 v162, 16, v18
  v_and_b32 v163, 0xffff0000, v18
  v_mfma_f32_16x16x32_bf16 a[100:103], v[92:95], a[164:167], a[100:103]
  v_lshlrev_b32 v18, 16, v50
  v_and_b32 v19, 0xffff0000, v50
  v_mfma_f32_16x16x32_bf16 a[104:107], v[92:95], a[168:171], a[104:107]
  v_add_f32 v164, v164, v18
  v_add_f32 v165, v165, v19
  v_mfma_f32_16x16x32_bf16 a[108:111], v[92:95], a[172:175], a[108:111]
  v_cvt_pk_bf16_f32 v18, v164, v165
  v_lshlrev_b32 v108, 16, v38
  v_mfma_f32_16x16x32_bf16 a[112:115], v[128:131], a[160:163], a[112:115]
  v_and_b32 v109, 0xffff0000, v38
  v_lshlrev_b32 v164, 16, v18
  v_mfma_f32_16x16x32_bf16 a[116:119], v[128:131], a[164:167], a[116:119]
  v_and_b32 v165, 0xffff0000, v18
  v_lshlrev_b32 v18, 16, v51
  v_mfma_f32_16x16x32_bf16 a[120:123], v[128:131], a[168:171], a[120:123]
  v_and_b32 v19, 0xffff0000, v51
  v_add_f32 v166, v166, v18
  v_mfma_f32_16x16x32_bf16 a[124:127], v[128:131], a[172:175], a[124:127]
  v_add_f32 v167, v167, v19
  v_cvt_pk_bf16_f32 v18, v166, v167
  v_mfma_f32_16x16x32_bf16 a[128:131], v[132:135], a[160:163], a[128:131]
  v_lshlrev_b32 v110, 16, v39
  v_and_b32 v111, 0xffff0000, v39
  v_mfma_f32_16x16x32_bf16 a[132:135], v[132:135], a[164:167], a[132:135]
  v_lshlrev_b32 v166, 16, v18
  v_and_b32 v167, 0xffff0000, v18
  v_mfma_f32_16x16x32_bf16 a[136:139], v[132:135], a[168:171], a[136:139]
  v_mfma_f32_16x16x32_bf16 a[140:143], v[132:135], a[172:175], a[140:143]
  s_waitcnt vmcnt(4) lgkmcnt(0)
  v_mfma_f32_16x16x32_bf16 a[64:67], v[136:139], a[176:179], a[64:67]
  ds_read_b128 v[156:159], v11 offset:31744
  v_lshlrev_b32 v18, 16, v52
  v_and_b32 v19, 0xffff0000, v52
  v_mfma_f32_16x16x32_bf16 a[68:71], v[136:139], a[180:183], a[68:71]
  v_add_f32 v168, v168, v18
  v_add_f32 v169, v169, v19
  v_mfma_f32_16x16x32_bf16 a[72:75], v[136:139], a[184:187], a[72:75]
  ds_read_b128 v[176:179], v11 offset:32768
  v_cvt_pk_bf16_f32 v18, v168, v169
  v_lshlrev_b32 v112, 16, v40
  v_mfma_f32_16x16x32_bf16 a[76:79], v[136:139], a[188:191], a[76:79]
  v_and_b32 v113, 0xffff0000, v40
  v_lshlrev_b32 v168, 16, v18
  v_mfma_f32_16x16x32_bf16 a[80:83], v[140:143], a[176:179], a[80:83]
  ds_read_b128 v[180:183], v11 offset:33792
  v_and_b32 v169, 0xffff0000, v18
  v_lshlrev_b32 v18, 16, v53
  v_mfma_f32_16x16x32_bf16 a[84:87], v[140:143], a[180:183], a[84:87]
  v_and_b32 v19, 0xffff0000, v53
  v_add_f32 v170, v170, v18
  v_mfma_f32_16x16x32_bf16 a[88:91], v[140:143], a[184:187], a[88:91]
  ds_read_b128 v[184:187], v11 offset:34816
  v_add_f32 v171, v171, v19
  v_cvt_pk_bf16_f32 v18, v170, v171
  v_mfma_f32_16x16x32_bf16 a[92:95], v[140:143], a[188:191], a[92:95]
  v_lshlrev_b32 v114, 16, v41
  v_and_b32 v115, 0xffff0000, v41
  v_mfma_f32_16x16x32_bf16 a[96:99], v[144:147], a[176:179], a[96:99]
  ds_read_b128 v[188:191], v11 offset:35840
  v_lshlrev_b32 v170, 16, v18
  v_and_b32 v171, 0xffff0000, v18
  v_mfma_f32_16x16x32_bf16 a[100:103], v[144:147], a[180:183], a[100:103]
  v_lshlrev_b32 v18, 16, v54
  v_and_b32 v19, 0xffff0000, v54
  v_mfma_f32_16x16x32_bf16 a[104:107], v[144:147], a[184:187], a[104:107]
  v_add_f32 v172, v172, v18
  v_add_f32 v173, v173, v19
  v_mfma_f32_16x16x32_bf16 a[108:111], v[144:147], a[188:191], a[108:111]
  v_cvt_pk_bf16_f32 v18, v172, v173
  v_lshlrev_b32 v116, 16, v42
  v_mfma_f32_16x16x32_bf16 a[112:115], v[148:151], a[176:179], a[112:115]
  v_and_b32 v117, 0xffff0000, v42
  v_lshlrev_b32 v172, 16, v18
  v_mfma_f32_16x16x32_bf16 a[116:119], v[148:151], a[180:183], a[116:119]
  v_and_b32 v173, 0xffff0000, v18
  v_lshlrev_b32 v18, 16, v55
  v_mfma_f32_16x16x32_bf16 a[120:123], v[148:151], a[184:187], a[120:123]
  v_and_b32 v19, 0xffff0000, v55
  v_add_f32 v174, v174, v18
  v_mfma_f32_16x16x32_bf16 a[124:127], v[148:151], a[188:191], a[124:127]
  v_add_f32 v175, v175, v19
  v_cvt_pk_bf16_f32 v18, v174, v175
  v_mfma_f32_16x16x32_bf16 a[128:131], v[152:155], a[176:179], a[128:131]
  v_lshlrev_b32 v118, 16, v43
  v_and_b32 v119, 0xffff0000, v43
  v_mfma_f32_16x16x32_bf16 a[132:135], v[152:155], a[180:183], a[132:135]
  v_lshlrev_b32 v174, 16, v18
  v_and_b32 v175, 0xffff0000, v18
  v_mfma_f32_16x16x32_bf16 a[136:139], v[152:155], a[184:187], a[136:139]
  v_mfma_f32_16x16x32_bf16 a[140:143], v[152:155], a[188:191], a[140:143]
  s_waitcnt vmcnt(0) lgkmcnt(0)
  v_mfma_f32_16x16x32_bf16 a[64:67], v[156:159], v[216:219], a[64:67]
  v_mfma_f32_16x16x32_bf16 a[68:71], v[156:159], v[220:223], a[68:71]
  v_mfma_f32_16x16x32_bf16 a[72:75], v[156:159], v[224:227], a[72:75]
  v_mfma_f32_16x16x32_bf16 a[76:79], v[156:159], v[228:231], a[76:79]
  v_mfma_f32_16x16x32_bf16 a[80:83], v[176:179], v[216:219], a[80:83]
  v_mfma_f32_16x16x32_bf16 a[84:87], v[176:179], v[220:223], a[84:87]
  v_mfma_f32_16x16x32_bf16 a[88:91], v[176:179], v[224:227], a[88:91]
  v_mfma_f32_16x16x32_bf16 a[92:95], v[176:179], v[228:231], a[92:95]
  v_mfma_f32_16x16x32_bf16 a[96:99], v[180:183], v[216:219], a[96:99]
  v_mfma_f32_16x16x32_bf16 a[100:103], v[180:183], v[220:223], a[100:103]
  ds_write_b128 v16, a[64:67] offset:0
  v_mfma_f32_16x16x32_bf16 a[104:107], v[180:183], v[224:227], a[104:107]
  ds_write_b128 v16, a[68:71] offset:5376
  v_mfma_f32_16x16x32_bf16 a[108:111], v[180:183], v[228:231], a[108:111]
  ds_write_b128 v16, a[72:75] offset:10752
  v_mfma_f32_16x16x32_bf16 a[112:115], v[184:187], v[216:219], a[112:115]
  ds_write_b128 v16, a[76:79] offset:16128
  v_mfma_f32_16x16x32_bf16 a[116:119], v[184:187], v[220:223], a[116:119]
  ds_write_b128 v16, a[80:83] offset:64
  v_mfma_f32_16x16x32_bf16 a[120:123], v[184:187], v[224:227], a[120:123]
  ds_write_b128 v16, a[84:87] offset:5440
  v_mfma_f32_16x16x32_bf16 a[124:127], v[184:187], v[228:231], a[124:127]
  ds_write_b128 v16, a[88:91] offset:10816
  v_mfma_f32_16x16x32_bf16 a[128:131], v[188:191], v[216:219], a[128:131]
  ds_write_b128 v16, a[92:95] offset:16192
  v_mfma_f32_16x16x32_bf16 a[132:135], v[188:191], v[220:223], a[132:135]
  ds_write_b128 v16, a[96:99] offset:128
  v_mfma_f32_16x16x32_bf16 a[136:139], v[188:191], v[224:227], a[136:139]
  ds_write_b128 v16, a[100:103] offset:5504
  v_mfma_f32_16x16x32_bf16 a[140:143], v[188:191], v[228:231], a[140:143]
  ds_write_b128 v16, a[104:107] offset:10880
  ds_write_b128 v16, a[108:111] offset:16256
  ds_write_b128 v16, a[112:115] offset:192
  ds_write_b128 v16, a[116:119] offset:5568
  ds_write_b128 v16, a[120:123] offset:10944
  ds_write_b128 v16, a[124:127] offset:16320
  ds_write_b128 v16, a[128:131] offset:256
  ds_write_b128 v16, a[132:135] offset:5632
  ds_write_b128 v16, a[136:139] offset:11008
  ds_write_b128 v16, a[140:143] offset:16384
  s_waitcnt lgkmcnt(0)
  s_barrier
  ds_read_b128 v[32:35], v251 offset:0
  ds_read_b128 v[36:39], v251 offset:16
  ds_read_b128 v[40:43], v251 offset:38912
  ds_read_b128 v[44:47], v251 offset:38928
  ds_read_b128 v[48:51], v20 offset:0
  ds_read_b128 v[52:55], v20 offset:16
  ds_read_b128 v[56:59], v20 offset:38912
  ds_read_b128 v[60:63], v20 offset:38928
  ds_read_b128 v[64:67], v252 offset:0
  ds_read_b128 v[68:71], v252 offset:16
  ds_read_b128 v[72:75], v252 offset:38912
  ds_read_b128 v[76:79], v252 offset:38928
  ds_read_b128 v[80:83], v21 offset:0
  ds_read_b128 v[84:87], v21 offset:16
  ds_read_b128 v[88:91], v21 offset:38912
  ds_read_b128 v[92:95], v21 offset:38928
  ds_read_b128 v[128:131], v253 offset:0
  ds_read_b128 v[132:135], v253 offset:16
  ds_read_b128 v[136:139], v253 offset:38912
  ds_read_b128 v[140:143], v253 offset:38928
  ds_read_b128 v[144:147], v22 offset:0
  ds_read_b128 v[148:151], v22 offset:16
  ds_read_b128 v[152:155], v22 offset:38912
  ds_read_b128 v[156:159], v22 offset:38928
  s_waitcnt lgkmcnt(15)
  v_pk_add_f32 v[32:33], v[32:33], v[40:41]
  v_pk_add_f32 v[48:49], v[48:49], v[56:57]
  v_pk_add_f32 v[34:35], v[34:35], v[42:43]
  v_pk_add_f32 v[50:51], v[50:51], v[58:59]
  v_pk_add_f32 v[36:37], v[36:37], v[44:45]
  v_pk_add_f32 v[52:53], v[52:53], v[60:61]
  v_pk_add_f32 v[38:39], v[38:39], v[46:47]
  v_pk_add_f32 v[54:55], v[54:55], v[62:63]
  v_pk_add_f32 v[32:33], v[32:33], v[48:49]
  v_pk_add_f32 v[34:35], v[34:35], v[50:51]
  v_pk_add_f32 v[36:37], v[36:37], v[52:53]
  v_pk_add_f32 v[38:39], v[38:39], v[54:55]
  v_cvt_pk_bf16_f32 v40, v32, v33
  v_cvt_pk_bf16_f32 v41, v34, v35
  v_cvt_pk_bf16_f32 v42, v36, v37
  v_cvt_pk_bf16_f32 v43, v38, v39
  v_lshlrev_b32 v32, 16, v40
  v_and_b32 v33, 0xffff0000, v40
  v_lshlrev_b32 v34, 16, v41
  v_and_b32 v35, 0xffff0000, v41
  v_lshlrev_b32 v36, 16, v42
  v_and_b32 v37, 0xffff0000, v42
  v_lshlrev_b32 v38, 16, v43
  v_and_b32 v39, 0xffff0000, v43
  v_pk_add_f32 v[32:33], v[32:33], v[96:97]
  v_pk_add_f32 v[34:35], v[34:35], v[98:99]
  v_pk_add_f32 v[36:37], v[36:37], v[100:101]
  v_pk_add_f32 v[38:39], v[38:39], v[102:103]
  v_cvt_pk_bf16_f32 v40, v32, v33
  v_cvt_pk_bf16_f32 v41, v34, v35
  v_cvt_pk_bf16_f32 v42, v36, v37
  v_cvt_pk_bf16_f32 v43, v38, v39
  v_lshlrev_b32 v32, 16, v40
  v_and_b32 v33, 0xffff0000, v40
  v_lshlrev_b32 v34, 16, v41
  v_and_b32 v35, 0xffff0000, v41
  v_lshlrev_b32 v36, 16, v42
  v_and_b32 v37, 0xffff0000, v42
  v_lshlrev_b32 v38, 16, v43
  v_and_b32 v39, 0xffff0000, v43
  v_pk_add_f32 v[32:33], v[32:33], v[120:121]
  v_pk_add_f32 v[34:35], v[34:35], v[122:123]
  v_pk_add_f32 v[36:37], v[36:37], v[124:125]
  v_pk_add_f32 v[38:39], v[38:39], v[126:127]
  v_cvt_pk_bf16_f32 v44, v32, v33
  v_cvt_pk_bf16_f32 v45, v34, v35
  v_cvt_pk_bf16_f32 v46, v36, v37
  v_cvt_pk_bf16_f32 v47, v38, v39
  buffer_store_dwordx4 v[44:47], v248, s[48:51], 0 offen
  s_waitcnt lgkmcnt(8)
  v_pk_add_f32 v[64:65], v[64:65], v[72:73]
  v_pk_add_f32 v[80:81], v[80:81], v[88:89]
  v_pk_add_f32 v[66:67], v[66:67], v[74:75]
  v_pk_add_f32 v[82:83], v[82:83], v[90:91]
  v_pk_add_f32 v[68:69], v[68:69], v[76:77]
  v_pk_add_f32 v[84:85], v[84:85], v[92:93]
  v_pk_add_f32 v[70:71], v[70:71], v[78:79]
  v_pk_add_f32 v[86:87], v[86:87], v[94:95]
  v_pk_add_f32 v[64:65], v[64:65], v[80:81]
  v_pk_add_f32 v[66:67], v[66:67], v[82:83]
  v_pk_add_f32 v[68:69], v[68:69], v[84:85]
  v_pk_add_f32 v[70:71], v[70:71], v[86:87]
  v_cvt_pk_bf16_f32 v72, v64, v65
  v_cvt_pk_bf16_f32 v73, v66, v67
  v_cvt_pk_bf16_f32 v74, v68, v69
  v_cvt_pk_bf16_f32 v75, v70, v71
  v_lshlrev_b32 v64, 16, v72
  v_and_b32 v65, 0xffff0000, v72
  v_lshlrev_b32 v66, 16, v73
  v_and_b32 v67, 0xffff0000, v73
  v_lshlrev_b32 v68, 16, v74
  v_and_b32 v69, 0xffff0000, v74
  v_lshlrev_b32 v70, 16, v75
  v_and_b32 v71, 0xffff0000, v75
  v_pk_add_f32 v[64:65], v[64:65], v[104:105]
  v_pk_add_f32 v[66:67], v[66:67], v[106:107]
  v_pk_add_f32 v[68:69], v[68:69], v[108:109]
  v_pk_add_f32 v[70:71], v[70:71], v[110:111]
  v_cvt_pk_bf16_f32 v72, v64, v65
  v_cvt_pk_bf16_f32 v73, v66, v67
  v_cvt_pk_bf16_f32 v74, v68, v69
  v_cvt_pk_bf16_f32 v75, v70, v71
  v_lshlrev_b32 v64, 16, v72
  v_and_b32 v65, 0xffff0000, v72
  v_lshlrev_b32 v66, 16, v73
  v_and_b32 v67, 0xffff0000, v73
  v_lshlrev_b32 v68, 16, v74
  v_and_b32 v69, 0xffff0000, v74
  v_lshlrev_b32 v70, 16, v75
  v_and_b32 v71, 0xffff0000, v75
  v_pk_add_f32 v[64:65], v[64:65], v[160:161]
  v_pk_add_f32 v[66:67], v[66:67], v[162:163]
  v_pk_add_f32 v[68:69], v[68:69], v[164:165]
  v_pk_add_f32 v[70:71], v[70:71], v[166:167]
  v_cvt_pk_bf16_f32 v76, v64, v65
  v_cvt_pk_bf16_f32 v77, v66, v67
  v_cvt_pk_bf16_f32 v78, v68, v69
  v_cvt_pk_bf16_f32 v79, v70, v71
  buffer_store_dwordx4 v[76:79], v249, s[48:51], 0 offen
  s_waitcnt lgkmcnt(0)
  v_pk_add_f32 v[128:129], v[128:129], v[136:137]
  v_pk_add_f32 v[144:145], v[144:145], v[152:153]
  v_pk_add_f32 v[130:131], v[130:131], v[138:139]
  v_pk_add_f32 v[146:147], v[146:147], v[154:155]
  v_pk_add_f32 v[132:133], v[132:133], v[140:141]
  v_pk_add_f32 v[148:149], v[148:149], v[156:157]
  v_pk_add_f32 v[134:135], v[134:135], v[142:143]
  v_pk_add_f32 v[150:151], v[150:151], v[158:159]
  v_pk_add_f32 v[128:129], v[128:129], v[144:145]
  v_pk_add_f32 v[130:131], v[130:131], v[146:147]
  v_pk_add_f32 v[132:133], v[132:133], v[148:149]
  v_pk_add_f32 v[134:135], v[134:135], v[150:151]
  v_cvt_pk_bf16_f32 v136, v128, v129
  v_cvt_pk_bf16_f32 v137, v130, v131
  v_cvt_pk_bf16_f32 v138, v132, v133
  v_cvt_pk_bf16_f32 v139, v134, v135
  v_lshlrev_b32 v128, 16, v136
  v_and_b32 v129, 0xffff0000, v136
  v_lshlrev_b32 v130, 16, v137
  v_and_b32 v131, 0xffff0000, v137
  v_lshlrev_b32 v132, 16, v138
  v_and_b32 v133, 0xffff0000, v138
  v_lshlrev_b32 v134, 16, v139
  v_and_b32 v135, 0xffff0000, v139
  v_pk_add_f32 v[128:129], v[128:129], v[112:113]
  v_pk_add_f32 v[130:131], v[130:131], v[114:115]
  v_pk_add_f32 v[132:133], v[132:133], v[116:117]
  v_pk_add_f32 v[134:135], v[134:135], v[118:119]
  v_cvt_pk_bf16_f32 v136, v128, v129
  v_cvt_pk_bf16_f32 v137, v130, v131
  v_cvt_pk_bf16_f32 v138, v132, v133
  v_cvt_pk_bf16_f32 v139, v134, v135
  v_lshlrev_b32 v128, 16, v136
  v_and_b32 v129, 0xffff0000, v136
  v_lshlrev_b32 v130, 16, v137
  v_and_b32 v131, 0xffff0000, v137
  v_lshlrev_b32 v132, 16, v138
  v_and_b32 v133, 0xffff0000, v138
  v_lshlrev_b32 v134, 16, v139
  v_and_b32 v135, 0xffff0000, v139
  v_pk_add_f32 v[128:129], v[128:129], v[168:169]
  v_pk_add_f32 v[130:131], v[130:131], v[170:171]
  v_pk_add_f32 v[132:133], v[132:133], v[172:173]
  v_pk_add_f32 v[134:135], v[134:135], v[174:175]
  v_cvt_pk_bf16_f32 v140, v128, v129
  v_cvt_pk_bf16_f32 v141, v130, v131
  v_cvt_pk_bf16_f32 v142, v132, v133
  v_cvt_pk_bf16_f32 v143, v134, v135
  buffer_store_dwordx4 v[140:143], v250, s[48:51], 0 offen
fa_end:
  s_endpgm
fa_hk0:
  s_getpc_b64 s[10:11]
fa_hp0:
  s_add_u32 s8, s8, 4
  s_addc_u32 s9, s9, 0
  s_sub_u32 s10, s10, fa_hp0-fa_hb0
  s_subb_u32 s11, s11, 0
  s_setpc_b64 s[8:9]
fa_hk1:
  s_getpc_b64 s[10:11]
fa_hp1:
  s_add_u32 s8, s8, 4
  s_addc_u32 s9, s9, 0
  s_sub_u32 s10, s10, fa_hp1-fa_hb1
  s_subb_u32 s11, s11, 0
  s_setpc_b64 s[8:9]
fa_hk2:
  s_getpc_b64 s[10:11]
fa_hp2:
  s_add_u32 s8, s8, 4
  s_addc_u32 s9, s9, 0
  s_sub_u32 s10, s10, fa_hp2-fa_hb2
  s_subb_u32 s11, s11, 0
  s_setpc_b64 s[8:9]
fa_hk3:
  s_getpc_b64 s[10:11]
fa_hp3:
  s_add_u32 s8, s8, 4
  s_addc_u32 s9, s9, 0
  s_sub_u32 s10, s10, fa_hp3-fa_hb3
  s_subb_u32 s11, s11, 0
  s_setpc_b64 s[8:9]
fa_ln_spin:
  s_mov_b32 s83, 200000
fa_ln_spin2:
  buffer_load_dword v15, v229, s[56:59], 0 offen sc1
  s_waitcnt vmcnt(0)
  v_cmp_ne_u32 vcc, 0x01010101, v15
  s_cbranch_vccz fa_ln_ok
  s_sleep 8
  s_sub_u32 s83, s83, 1
  s_cmp_lg_u32 s83, 0
  s_cbranch_scc1 fa_ln_spin2
  s_branch fa_ln_ok
fa_co1:
  buffer_load_dword v232, v234, s[32:35], s29 offen
  buffer_store_dword v229, v225, s[40:43], 0 offen sc1
  ds_read_b128 v[160:163], v221 offset:0
  ds_read_b128 v[164:167], v221 offset:4096
  ds_read_b128 v[168:171], v221 offset:8192
  buffer_store_dword v218, v222, s[40:43], 0 offen sc1
  s_waitcnt lgkmcnt(0)
  buffer_store_dwordx4 v[160:163], v223, s[40:43], s66 offen sc1
  buffer_store_dwordx4 v[164:167], v223, s[40:43], s67 offen sc1
  buffer_store_dwordx4 v[168:171], v224, s[40:43], s78 offen sc1
  s_getpc_b64 s[8:9]
  s_setpc_b64 s[10:11]
  s_mov_b32 s48, s60
  s_mov_b32 s49, s61
  s_mov_b32 s50, s75
  s_lshl_b32 s74, s22, 2
  s_add_u32 s74, s74, s20
  s_lshl_b32 s74, s74, 16
  s_mov_b32 s73, 2097152
  v_mov_b32 v213, 1073741824
  v_mov_b32 v214, 1
  v_writelane_b32 v213, s77, 0
  v_lshlrev_b32 v229, 2, v1
  s_and_b32 s23, s21, 3
  s_cbranch_scc0 fa_arr
  s_getpc_b64 s[8:9]
  s_setpc_b64 s[10:11]
fa_arr:
  buffer_store_byte v214, v213, s[56:59], 0 offen sc1
  s_getpc_b64 s[8:9]
  s_setpc_b64 s[10:11]
  buffer_load_dword v15, v229, s[56:59], 0 offen sc1
  s_getpc_b64 s[8:9]
  s_setpc_b64 s[10:11]
  s_mov_b32 s36, s60
  s_mov_b32 s37, s61
  s_mov_b32 s38, s75
  s_lshr_b32 s27, s20, 1
  s_lshl_b32 s27, s27, 18
  s_mov_b32 s25, 524288
  s_mov_b32 s32, s18
  s_mov_b32 s33, s19
  s_mov_b32 s34, 2621440
  s_mov_b32 s26, 0
  s_movk_i32 s79, 1024
  s_lshl_b32 s23, s22, 2
  s_add_u32 s23, s23, s20
  s_mul_i32 s23, s23, 40960
  v_add_u32 v3, s23, v2
  s_sub_u32 s23, 15, s22
  s_lshl_b32 s23, s23, 2
  s_add_u32 s23, s23, s20
  s_mul_i32 s23, s23, 40960
  s_sub_u32 s23, s23, 2048
  v_add_u32 v5, s23, v2
  v_add_u32 v4, 19456, v3
  v_add_u32 v6, 19456, v5
  s_waitcnt vmcnt(8)
  v_cmp_ne_u32 vcc, 0x01010101, v15
  s_cbranch_vccnz fa_ln_spin
fa_ln_ok:
  s_setpc_b64 s[10:11]
fa_kv_spin:
  s_mov_b32 s83, 200000
fa_kv_spin2:
  buffer_load_dword v15, v8, s[40:43], 0 offen sc1
  s_waitcnt vmcnt(0)
  v_cmp_eq_u32 vcc, 0, v15
  s_cbranch_vccz fa_kv_ok
  s_sleep 8
  s_sub_u32 s83, s83, 1
  s_cmp_lg_u32 s83, 0
  s_cbranch_scc1 fa_kv_spin2
  s_branch fa_kv_ok
fa_top8:
  s_cmp_lg_u32 s20, 0
  s_cbranch_scc1 fa_notop
  s_mov_b32 s23, 2621440
  s_mov_b32 s31, 2625536
  buffer_load_dwordx4 v[96:99], v2, s[40:43], s23 offen offset:0 sc1
  buffer_load_dwordx4 v[100:103], v2, s[40:43], s23 offen offset:1024 sc1
  buffer_load_dwordx4 v[104:107], v2, s[40:43], s23 offen offset:2048 sc1
  buffer_load_dwordx4 v[108:111], v2, s[40:43], s23 offen offset:3072 sc1
  buffer_load_dwordx4 v[112:115], v2, s[40:43], s31 offen offset:0 sc1
  buffer_load_dwordx4 v[116:119], v2, s[40:43], s31 offen offset:1024 sc1
  buffer_load_dwordx4 v[120:123], v2, s[40:43], s31 offen offset:2048 sc1
  buffer_load_dwordx4 v[124:127], v2, s[40:43], s31 offen offset:3072 sc1
  v_mov_b32 v21, 0
  v_mov_b32 v22, 0
  v_and_b32 v23, 7, v1
  s_mov_b32 s23, 0
  s_waitcnt vmcnt(0)
fa_top:
  v_max3_u32 v20, v96, v97, v98
  v_max3_u32 v24, v99, v100, v101
  v_max3_u32 v20, v20, v102, v103
  v_max3_u32 v24, v24, v104, v105
  v_max3_u32 v20, v20, v106, v107
  v_max3_u32 v24, v24, v108, v109
  v_max3_u32 v20, v20, v110, v111
  v_max3_u32 v24, v24, v112, v113
  v_max3_u32 v20, v20, v114, v115
  v_max3_u32 v24, v24, v116, v117
  v_max3_u32 v20, v20, v118, v119
  v_max3_u32 v24, v24, v120, v121
  v_max3_u32 v20, v20, v122, v123
  v_max3_u32 v24, v24, v124, v125
  v_max3_u32 v20, v20, v126, v127
  v_max_u32 v20, v20, v24
  s_nop 1
  v_max_u32_dpp v20, v20, v20 quad_perm:[1,0,3,2] row_mask:0xf bank_mask:0xf
  s_nop 1
  v_max_u32_dpp v20, v20, v20 quad_perm:[2,3,0,1] row_mask:0xf bank_mask:0xf
  s_nop 1
  v_max_u32_dpp v20, v20, v20 row_half_mirror row_mask:0xf bank_mask:0xf
  s_nop 1
  v_max_u32_dpp v20, v20, v20 row_mirror row_mask:0xf bank_mask:0xf
  v_mov_b32 v24, v20
  s_nop 1
  v_permlane16_swap_b32 v20, v24
  v_max_u32 v20, v20, v24
  v_mov_b32 v24, v20
  s_nop 1
  v_permlane32_swap_b32 v20, v24
  v_max_u32 v20, v20, v24
  v_add_u32 v21, v21, v20
  v_cmp_eq_u32 vcc, s23, v23
  v_sub_u32 v96, v96, v20
  v_sub_u32 v97, v97, v20
  v_sub_u32 v98, v98, v20
  v_sub_u32 v99, v99, v20
  v_sub_u32 v100, v100, v20
  v_sub_u32 v101, v101, v20
  v_sub_u32 v102, v102, v20
  v_sub_u32 v103, v103, v20
  v_sub_u32 v104, v104, v20
  v_sub_u32 v105, v105, v20
  v_sub_u32 v106, v106, v20
  v_sub_u32 v107, v107, v20
  v_sub_u32 v108, v108, v20
  v_sub_u32 v109, v109, v20
  v_sub_u32 v110, v110, v20
  v_sub_u32 v111, v111, v20
  v_sub_u32 v112, v112, v20
  v_sub_u32 v113, v113, v20
  v_sub_u32 v114, v114, v20
  v_sub_u32 v115, v115, v20
  v_sub_u32 v116, v116, v20
  v_sub_u32 v117, v117, v20
  v_sub_u32 v118, v118, v20
  v_sub_u32 v119, v119, v20
  v_sub_u32 v120, v120, v20
  v_sub_u32 v121, v121, v20
  v_sub_u32 v122, v122, v20
  v_sub_u32 v123, v123, v20
  v_sub_u32 v124, v124, v20
  v_sub_u32 v125, v125, v20
  v_sub_u32 v126, v126, v20
  v_sub_u32 v127, v127, v20
  v_cndmask_b32 v22, v22, v21, vcc
  s_add_u32 s23, s23, 1
  s_cmp_lt_u32 s23, 8
  s_cbranch_scc1 fa_top
  v_and_b32 v25, 0xffff, v22
  v_sub_u32 v25, 0xffff, v25
  v_and_b32 v25, 2047, v25
  v_ashrrev_i32 v20, 31, v22
  v_not_b32 v20, v20
  v_or_b32 v20, 0x80000000, v20
  v_xor_b32 v26, v22, v20
  v_and_b32 v26, 0xffff0000, v26
  v_mul_f32 v26, 0xbfb8aa3b, v26
  v_exp_f32 v26, v26
  s_nop 0
  v_add_f32 v26, 1.0, v26
  v_rcp_f32 v26, v26
  s_nop 0
  v_cvt_pk_bf16_f32 v26, v26, v26
  v_and_b32 v26, 0xffff0000, v26
  v_lshlrev_b32 v20, 2, v1
  v_add_u32 v20, 2629632, v20
  v_mov_b32 v21, 1073741824
  v_cmp_gt_u32 vcc, 16, v1
  v_add_u32 v25, 1, v25
  v_or_b32 v26, 1, v26
  v_cndmask_b32 v20, v21, v20, vcc
  v_cmp_gt_u32 vcc, 8, v1
  s_nop 1
  v_cndmask_b32 v26, v26, v25, vcc
  buffer_store_dword v26, v20, s[40:43], 0 offen sc1
  s_branch fa_notop
fa_hk4:
  s_getpc_b64 s[38:39]
fa_hp4:
  s_add_u32 s36, s36, 4
  s_addc_u32 s37, s37, 0
  s_sub_u32 s38, s38, fa_hp4-fa_hb4
  s_subb_u32 s39, s39, 0
  s_setpc_b64 s[36:37]
fa_hk5:
  s_getpc_b64 s[38:39]
fa_hp5:
  s_add_u32 s36, s36, 4
  s_addc_u32 s37, s37, 0
  s_sub_u32 s38, s38, fa_hp5-fa_hb5
  s_subb_u32 s39, s39, 0
  s_setpc_b64 s[36:37]
fa_hk6:
  s_getpc_b64 s[38:39]
fa_hp6:
  s_add_u32 s36, s36, 4
  s_addc_u32 s37, s37, 0
  s_add_u32 s38, s38, fa_hb6-fa_hp6
  s_addc_u32 s39, s39, 0
  s_setpc_b64 s[36:37]
fa_DDF:
  v_mfma_f32_16x16x32_bf16 v[96:99], a[128:131], v[32:35], v[192:195]
  s_waitcnt vmcnt(12)
  v_exp_f32 v218, v146
  v_mfma_f32_16x16x32_bf16 v[104:107], a[128:131], v[36:39], v[196:199]
  s_barrier
  v_exp_f32 v219, v147
  v_mfma_f32_16x16x32_bf16 v[128:131], a[128:131], v[64:67], v[200:203]
  s_cmp_ge_u32 s26, s32
  ds_read_b128 a[160:163], v3 offset:16384
  v_add_f32 v226, v216, v217
  v_mfma_f32_16x16x32_bf16 v[136:139], a[128:131], v[68:71], v[204:207]
  s_cbranch_scc1 fa_hk6
fa_hb6:
  v_exp_f32 v220, v148
  v_mfma_f32_16x16x32_bf16 v[100:103], a[132:135], v[32:35], v[192:195]
  ds_read_b128 a[164:167], v3 offset:17408
  v_cvt_pk_bf16_f32 v184, v216, v217
  v_mfma_f32_16x16x32_bf16 v[108:111], a[132:135], v[36:39], v[196:199]
  s_mov_b32 m0, s24
  v_exp_f32 v221, v149
  v_mfma_f32_16x16x32_bf16 v[132:135], a[132:135], v[64:67], v[200:203]
  buffer_load_dwordx4 v2, s[44:47], s26 offen offset:0 sc1 lds
  v_add_f32 v226, v226, v218
  v_mfma_f32_16x16x32_bf16 v[140:143], a[132:135], v[68:71], v[204:207]
  v_exp_f32 v222, v150
  v_mfma_f32_16x16x32_bf16 v[96:99], a[136:139], v[40:43], v[96:99]
  ds_read_b128 a[168:171], v3 offset:18432
  v_add_f32 v226, v226, v219
  v_cvt_pk_bf16_f32 v185, v218, v219
  v_mfma_f32_16x16x32_bf16 v[104:107], a[136:139], v[44:47], v[104:107]
  v_exp_f32 v223, v151
  v_mfma_f32_16x16x32_bf16 v[128:131], a[136:139], v[72:75], v[128:131]
  v_add_f32 v226, v226, v220
  v_add_f32 v226, v226, v221
  v_mfma_f32_16x16x32_bf16 v[136:139], a[136:139], v[76:79], v[136:139]
  v_exp_f32 v216, v152
  v_mfma_f32_16x16x32_bf16 v[100:103], a[140:143], v[40:43], v[100:103]
  ds_read_b128 a[172:175], v3 offset:19456
  v_cvt_pk_bf16_f32 v186, v220, v221
  v_mfma_f32_16x16x32_bf16 v[108:111], a[140:143], v[44:47], v[108:111]
  buffer_load_dwordx4 v2, s[44:47], s26 offen offset:1024 sc1 lds
  v_add_f32 v226, v226, v222
  v_mfma_f32_16x16x32_bf16 v[132:135], a[140:143], v[72:75], v[132:135]
  v_exp_f32 v217, v153
  v_mfma_f32_16x16x32_bf16 v[140:143], a[140:143], v[76:79], v[140:143]
  s_waitcnt lgkmcnt(4)
  v_exp_f32 v218, v154
  v_mfma_f32_16x16x32_bf16 v[96:99], a[144:147], v[48:51], v[96:99]
  ds_read_b128 a[176:179], v3 offset:20480
  v_add_f32 v226, v226, v223
  v_mfma_f32_16x16x32_bf16 v[104:107], a[144:147], v[52:55], v[104:107]
  v_exp_f32 v219, v155
  v_mfma_f32_16x16x32_bf16 v[128:131], a[144:147], v[80:83], v[128:131]
  v_cvt_pk_bf16_f32 v187, v222, v223
  v_add_f32 v227, v216, v217
  v_cvt_pk_bf16_f32 v188, v216, v217
  v_mfma_f32_16x16x32_bf16 v[136:139], a[144:147], v[84:87], v[136:139]
  buffer_load_dwordx4 v2, s[44:47], s26 offen offset:2048 sc1 lds
  v_add_f32 v227, v227, v218
  v_mfma_f32_16x16x32_bf16 v[100:103], a[148:151], v[48:51], v[100:103]
  ds_read_b128 a[180:183], v3 offset:21504
  v_add_f32 v227, v227, v219
  v_mfma_f32_16x16x32_bf16 v[108:111], a[148:151], v[52:55], v[108:111]
  v_exp_f32 v220, v156
  v_mfma_f32_16x16x32_bf16 v[132:135], a[148:151], v[80:83], v[132:135]
  v_exp_f32 v221, v157
  v_mfma_f32_16x16x32_bf16 v[140:143], a[148:151], v[84:87], v[140:143]
  v_exp_f32 v222, v158
  v_mfma_f32_16x16x32_bf16 v[96:99], a[152:155], v[56:59], v[96:99]
  ds_read_b128 a[184:187], v3 offset:22528
  v_cvt_pk_bf16_f32 v189, v218, v219
  v_mfma_f32_16x16x32_bf16 v[104:107], a[152:155], v[60:63], v[104:107]
  buffer_load_dwordx4 v2, s[44:47], s26 offen offset:3072 sc1 lds
  v_add_f32 v227, v227, v220
  v_add_f32 v227, v227, v221
  v_mfma_f32_16x16x32_bf16 v[128:131], a[152:155], v[88:91], v[128:131]
  s_add_u32 s26, s26, 16384
  v_exp_f32 v223, v159
  v_mfma_f32_16x16x32_bf16 v[136:139], a[152:155], v[92:95], v[136:139]
  s_add_u32 s24, s24, 32768
  v_exp_f32 v208, v112
  v_mfma_f32_16x16x32_bf16 v[100:103], a[156:159], v[56:59], v[100:103]
  s_and_b32 s24, s24, 0x1ffff
  ds_read_b128 a[188:191], v3 offset:23552
  v_cvt_pk_bf16_f32 v190, v220, v221
  v_mfma_f32_16x16x32_bf16 v[108:111], a[156:159], v[60:63], v[108:111]
  v_exp_f32 v209, v113
  v_mfma_f32_16x16x32_bf16 v[132:135], a[156:159], v[88:91], v[132:135]
  s_add_u32 m0, s34, 0
  v_exp_f32 v210, v114
  v_mfma_f32_16x16x32_bf16 v[140:143], a[156:159], v[92:95], v[140:143]
  s_waitcnt lgkmcnt(4)
  buffer_load_dwordx4 v8, s[52:55], s33 offen offset:0 lds
  v_add_f32 v227, v227, v222
  v_mfma_f32_16x16x32_bf16 a[0:3], a[160:163], v[160:163], a[0:3]
  ds_read_b128 a[128:131], v3 offset:0
  v_add_f32 v227, v227, v223
  v_mfma_f32_16x16x32_bf16 a[4:7], a[160:163], v[164:167], a[4:7]
  v_exp_f32 v211, v115
  v_mfma_f32_16x16x32_bf16 a[64:67], a[160:163], v[176:179], a[64:67]
  v_cvt_pk_bf16_f32 v191, v222, v223
  v_add_f32 v224, v208, v209
  v_cvt_pk_bf16_f32 v168, v208, v209
  v_mfma_f32_16x16x32_bf16 a[68:71], a[160:163], v[180:183], a[68:71]
  v_exp_f32 v212, v116
  v_mfma_f32_16x16x32_bf16 a[8:11], a[164:167], v[160:163], a[8:11]
  ds_read_b128 a[132:135], v3 offset:1024
  v_add_f32 v224, v224, v210
  v_mfma_f32_16x16x32_bf16 a[12:15], a[164:167], v[164:167], a[12:15]
  buffer_load_dwordx4 v11, s[52:55], s33 offen offset:1024 lds
  v_add_f32 v224, v224, v211
  v_mfma_f32_16x16x32_bf16 a[72:75], a[164:167], v[176:179], a[72:75]
  v_exp_f32 v213, v117
  v_mfma_f32_16x16x32_bf16 a[76:79], a[164:167], v[180:183], a[76:79]
  v_exp_f32 v214, v118
  v_mfma_f32_16x16x32_bf16 a[16:19], a[168:171], v[160:163], a[16:19]
  ds_read_b128 a[136:139], v3 offset:2048
  v_cvt_pk_bf16_f32 v169, v210, v211
  v_mfma_f32_16x16x32_bf16 a[20:23], a[168:171], v[164:167], a[20:23]
  v_exp_f32 v215, v119
  v_mfma_f32_16x16x32_bf16 a[80:83], a[168:171], v[176:179], a[80:83]
  v_add_f32 v224, v224, v212
  v_add_f32 v224, v224, v213
  v_cvt_pk_bf16_f32 v170, v212, v213
  v_mfma_f32_16x16x32_bf16 a[84:87], a[168:171], v[180:183], a[84:87]
  buffer_load_dwordx4 v12, s[52:55], s33 offen offset:2048 lds
  v_add_f32 v224, v224, v214
  v_mfma_f32_16x16x32_bf16 a[24:27], a[172:175], v[160:163], a[24:27]
  ds_read_b128 a[140:143], v3 offset:3072
  v_add_f32 v224, v224, v215
  v_mfma_f32_16x16x32_bf16 a[28:31], a[172:175], v[164:167], a[28:31]
  v_exp_f32 v208, v120
  v_mfma_f32_16x16x32_bf16 a[88:91], a[172:175], v[176:179], a[88:91]
  v_exp_f32 v209, v121
  v_mfma_f32_16x16x32_bf16 a[92:95], a[172:175], v[180:183], a[92:95]
  s_waitcnt lgkmcnt(4)
  v_exp_f32 v210, v122
  v_mfma_f32_16x16x32_bf16 a[32:35], a[176:179], v[160:163], a[32:35]
  ds_read_b128 a[144:147], v3 offset:4096
  v_cvt_pk_bf16_f32 v171, v214, v215
  v_mfma_f32_16x16x32_bf16 a[36:39], a[176:179], v[164:167], a[36:39]
  buffer_load_dwordx4 v13, s[52:55], s33 offen offset:3072 lds
  v_add_f32 v225, v208, v209
  v_mfma_f32_16x16x32_bf16 a[96:99], a[176:179], v[176:179], a[96:99]
  v_exp_f32 v211, v123
  v_mfma_f32_16x16x32_bf16 a[100:103], a[176:179], v[180:183], a[100:103]
  v_exp_f32 v212, v124
  v_mfma_f32_16x16x32_bf16 a[40:43], a[180:183], v[160:163], a[40:43]
  ds_read_b128 a[148:151], v3 offset:5120
  v_cvt_pk_bf16_f32 v172, v208, v209
  v_add_f32 v225, v225, v210
  v_mfma_f32_16x16x32_bf16 a[44:47], a[180:183], v[164:167], a[44:47]
  v_exp_f32 v213, v125
  v_mfma_f32_16x16x32_bf16 a[104:107], a[180:183], v[176:179], a[104:107]
  s_add_u32 m0, s34, 4096
  v_add_f32 v225, v225, v211
  v_cvt_pk_bf16_f32 v173, v210, v211
  v_mfma_f32_16x16x32_bf16 a[108:111], a[180:183], v[180:183], a[108:111]
  buffer_load_dwordx4 v14, s[52:55], s33 offen offset:0 lds
  v_max3_f32 v5, v226, v227, v224
  v_mfma_f32_16x16x32_bf16 a[48:51], a[184:187], v[160:163], a[48:51]
  ds_read_b128 a[152:155], v3 offset:6144
  v_add_f32 v225, v225, v212
  v_mfma_f32_16x16x32_bf16 a[52:55], a[184:187], v[164:167], a[52:55]
  v_exp_f32 v214, v126
  v_mfma_f32_16x16x32_bf16 a[112:115], a[184:187], v[176:179], a[112:115]
  v_exp_f32 v215, v127
  v_mfma_f32_16x16x32_bf16 a[116:119], a[184:187], v[180:183], a[116:119]
  v_add_f32 v225, v225, v213
  v_cvt_pk_bf16_f32 v174, v212, v213
  v_add_f32 v225, v225, v214
  v_mfma_f32_16x16x32_bf16 a[56:59], a[188:191], v[160:163], a[56:59]
  ds_read_b128 a[156:159], v3 offset:7168
  v_add_f32 v225, v225, v215
  v_max_f32 v5, v5, v225
  v_cmp_lt_f32 vcc, s81, v5
  v_mfma_f32_16x16x32_bf16 a[60:63], a[188:191], v[164:167], a[60:63]
  v_exp_f32 v216, v128
  v_mfma_f32_16x16x32_bf16 a[120:123], a[188:191], v[176:179], a[120:123]
  s_waitcnt lgkmcnt(4)
  v_cvt_pk_bf16_f32 v175, v214, v215
  v_mfma_f32_16x16x32_bf16 a[124:127], a[188:191], v[180:183], a[124:127]
  s_cbranch_vccnz fa_stub3
fa_back3:
  v_exp_f32 v217, v129
  v_add_f32 v228, v228, v224
  v_add_f32 v229, v229, v225
  v_add_f32 v230, v230, v226
  v_add_f32 v231, v231, v227
  s_branch fa_DDe
fa_sel_spin:
  s_mov_b32 s83, 200000
fa_sel_spin2:
  buffer_load_dword v15, v252, s[40:43], 0 offen sc1
  s_waitcnt vmcnt(0)
  v_cmp_eq_u32 vcc, 0, v15
  s_cbranch_vccz fa_sel_ok
  s_sleep 8
  s_sub_u32 s83, s83, 1
  s_cmp_lg_u32 s83, 0
  s_cbranch_scc1 fa_sel_spin2
  s_branch fa_sel_ok
fa_wof_spin:
  s_mov_b32 s83, 200000
fa_wof_spin2:
  buffer_load_dword v8, v9, s[40:43], 0 offen sc1
  s_waitcnt vmcnt(0)
  v_cmp_eq_u32 vcc, 0, v8
  s_cbranch_vccz fa_wof_ok
  s_sleep 8
  s_sub_u32 s83, s83, 1
  s_cmp_lg_u32 s83, 0
  s_cbranch_scc1 fa_wof_spin2
  s_branch fa_wof_ok
fa_sel4_spin:
  s_mov_b32 s83, 200000
fa_sel4_spin2:
  buffer_load_dword v15, v10, s[40:43], 0 offen sc1
  s_waitcnt vmcnt(0)
  v_cmp_eq_u32 vcc, 0, v15
  s_cbranch_vccz fa_sel4_ok
  s_sleep 8
  s_sub_u32 s83, s83, 1
  s_cmp_lg_u32 s83, 0
  s_cbranch_scc1 fa_sel4_spin2
  s_branch fa_sel4_ok
fa_yf_spin:
  s_mov_b32 s83, 200000
fa_yf_spin2:
  buffer_load_dword v14, v11, s[40:43], 0 offen sc1
  s_waitcnt vmcnt(0)
  v_cmp_eq_u32 vcc, 0, v14
  s_cbranch_vccz fa_yf_ok
  s_sleep 8
  s_sub_u32 s83, s83, 1
  s_cmp_lg_u32 s83, 0
  s_cbranch_scc1 fa_yf_spin2
  s_branch fa_yf_ok
fa_co:
  s_sub_u32 s14, s2, 170
  s_cmp_lt_u32 s14, 54
  s_cbranch_scc1 fa_coF
  s_sub_u32 s14, s2, 64
  s_cmp_lt_u32 s14, 96
  s_cbranch_scc1 fa_coT
  s_cmp_eq_u32 s2, 255
  s_cbranch_scc1 fa_coW
  s_sub_u32 s14, s2, 128
  s_cmp_ge_u32 s2, 224
  s_cbranch_scc0 fa_coO
fa_coT:
  v_min_u32 v8, 16, v1
  v_lshlrev_b32 v8, 7, v8
  s_lshl_b32 s10, s14, 1
  s_and_b32 s31, s20, 1
  s_add_u32 s10, s10, s31
  s_mul_i32 s10, s10, 2176
  s_lshl_b32 s35, s14, 2
  s_add_u32 s35, s35, s20
  s_mul_i32 s35, s35, 4352
  buffer_load_dword v255, v8, s[52:55], s10 offen
  s_add_u32 s10, s10, 552960
  s_getpc_b64 s[36:37]
  s_setpc_b64 s[38:39]
  buffer_load_dword v255, v8, s[52:55], s10 offen
  s_add_u32 s10, s10, 552960
  s_getpc_b64 s[36:37]
  s_setpc_b64 s[38:39]
  buffer_load_dword v255, v8, s[52:55], s10 offen
  s_add_u32 s10, s10, 552960
  buffer_load_dword v255, v8, s[60:63], s35 offen offset:0
  s_getpc_b64 s[36:37]
  s_setpc_b64 s[38:39]
  buffer_load_dword v255, v8, s[52:55], s10 offen
  s_add_u32 s10, s10, 552960
  buffer_load_dword v255, v8, s[60:63], s35 offen offset:2176
  s_mov_b32 s9, -1
  s_and_b32 s32, s21, 3
  s_lshr_b32 s32, s32, 1
  s_add_u32 s32, s32, 6
  s_lshl_b32 s32, s32, 14
  s_getpc_b64 s[36:37]
  s_setpc_b64 s[38:39]
fa_coO:
  s_and_b32 s23, s67, 1
  s_lshl_b32 s23, s23, 2
  s_add_u32 s23, s23, s20
  s_lshr_b32 s31, s67, 1
  s_lshl_b32 s30, s23, 7
  s_add_u32 s30, s30, s31
  s_mul_i32 s33, s31, 40960
  s_mul_i32 s23, s23, 160
  s_add_u32 s33, s33, s23
  s_add_u32 m0, s34, 0
  v_accvgpr_read_b32 v19, a248
  buffer_load_dwordx4 v19, s[56:59], s33 offen lds
  s_add_u32 m0, s34, 1024
  v_accvgpr_read_b32 v19, a249
  buffer_load_dwordx4 v19, s[56:59], s33 offen lds
  s_add_u32 m0, s34, 2048
  v_accvgpr_read_b32 v19, a250
  buffer_load_dwordx4 v19, s[56:59], s33 offen lds
  s_add_u32 m0, s34, 3072
  v_accvgpr_read_b32 v19, a251
  buffer_load_dwordx4 v19, s[56:59], s33 offen lds
  s_add_u32 m0, s34, 4096
  v_accvgpr_read_b32 v19, a252
  buffer_load_dwordx4 v19, s[56:59], s33 offen lds
  s_add_u32 s32, s26, 32768
  s_mov_b32 s9, -1
  s_lshl_b32 s10, s30, 2
  s_mul_i32 s30, s30, 5120
  s_add_u32 s30, s30, 4194304
  s_getpc_b64 s[36:37]
  s_setpc_b64 s[38:39]
  s_waitcnt vmcnt(8)
  ds_read_b64_tr_b16 v[232:233], v6 offset:0
  ds_read_b64_tr_b16 v[234:235], v6 offset:2560
  ds_read_b64_tr_b16 v[236:237], v6 offset:32
  ds_read_b64_tr_b16 v[238:239], v6 offset:2592
  ds_read_b64_tr_b16 v[240:241], v6 offset:64
  ds_read_b64_tr_b16 v[242:243], v6 offset:2624
  ds_read_b64_tr_b16 v[244:245], v6 offset:96
  ds_read_b64_tr_b16 v[246:247], v6 offset:2656
  ds_read_b64_tr_b16 v[248:249], v6 offset:128
  ds_read_b64_tr_b16 v[250:251], v6 offset:2688
  s_waitcnt lgkmcnt(0)
  s_add_u32 s31, s30, 4096
  buffer_store_dwordx4 v[232:235], v2, s[40:43], s30 offen offset:0 sc1
  buffer_store_dwordx4 v[236:239], v2, s[40:43], s30 offen offset:1024 sc1
  buffer_store_dwordx4 v[240:243], v2, s[40:43], s30 offen offset:2048 sc1
  buffer_store_dwordx4 v[244:247], v2, s[40:43], s30 offen offset:3072 sc1
  buffer_store_dwordx4 v[248:251], v2, s[40:43], s31 offen offset:0 sc1
  s_getpc_b64 s[36:37]
  s_setpc_b64 s[38:39]
  s_add_u32 s23, s10, 2654208
  s_waitcnt vmcnt(8)
  buffer_store_dword v4, off, s[40:43], s23 sc1
  s_sub_u32 s23, s67, 96
  s_cmp_gt_u32 s23, 54
  s_cbranch_scc1 fa_coW
  s_add_u32 s67, s23, 170
  s_cmp_eq_u32 s67, 224
  s_cselect_b32 s67, 255, s67
  s_branch fa_coO
fa_coF:
  v_and_b32 v16, 7, v1
  v_lshlrev_b32 v252, 2, v16
  v_add_u32 v252, 2629632, v252
  buffer_load_dword v15, v252, s[40:43], 0 offen sc1
  s_lshl_b32 s33, s14, 6
  s_and_b32 s31, s20, 1
  s_lshl_b32 s31, s31, 5
  s_add_u32 s33, s33, s31
  s_mul_i32 s35, s14, 40960
  s_mul_i32 s31, s20, 320
  s_add_u32 s35, s35, s31
  s_mul_i32 s10, s14, 20480
  s_mul_i32 s31, s20, 640
  s_add_u32 s10, s10, s31
  s_add_u32 s10, s10, 2686976
  v_lshrrev_b32 v17, 1, v1
  v_mul_u32_u24 v8, 3456, v17
  v_and_b32 v17, 1, v1
  v_lshl_add_u32 v8, v17, 4, v8
  v_add_u32 v11, 109568, v8
  v_add_u32 v12, 219136, v8
  v_add_u32 v13, 328704, v8
  v_add_u32 v14, 442368, v8
  v_lshrrev_b32 v17, 4, v1
  v_lshrrev_b32 v18, 2, v1
  v_lshl_add_u32 v18, v17, 2, v18
  v_lshlrev_b32 v18, 5, v18
  v_and_b32 v19, 3, v1
  v_lshl_add_u32 v9, v19, 3, v18
  v_add_u32 v9, s34, v9
  v_lshlrev_b32 v10, 4, v16
  v_lshl_add_u32 v10, v17, 7, v10
  v_add_u32 v10, 151552, v10
  s_mov_b32 s8, -1
  v_mov_b32 v232, 0
  v_mov_b32 v233, 0
  v_mov_b32 v234, 0
  v_mov_b32 v235, 0
  s_getpc_b64 s[36:37]
  s_setpc_b64 s[38:39]
  s_waitcnt vmcnt(8)
  v_cmp_eq_u32 vcc, 0, v15
  s_cbranch_vccnz fa_sel_spin
fa_sel_ok:
  v_add_u32 v18, -1, v15
  v_and_b32 v18, 2047, v18
  v_lshrrev_b32 v19, 4, v18
  v_mul_u32_u24 v19, 20480, v19
  v_and_b32 v18, 15, v18
  v_lshl_add_u32 v19, v18, 4, v19
  v_lshrrev_b32 v18, 3, v1
  v_lshl_add_u32 v19, v18, 8, v19
  s_lshl_b32 s23, s20, 11
  s_lshl_b32 s31, s20, 10
  s_add_u32 s31, s31, 151552
  s_mov_b32 s14, 4
  s_mov_b32 m0, s31
  s_add_u32 s31, s31, 4096
  buffer_load_dwordx4 v19, s[40:43], s23 offen sc1 lds
  s_add_u32 s23, s23, 8192
  s_mov_b32 m0, s31
  s_add_u32 s31, s31, 4096
  buffer_load_dwordx4 v19, s[40:43], s23 offen sc1 lds
  s_add_u32 s23, s23, 8192
  s_mov_b32 m0, s31
  s_add_u32 s31, s31, 4096
  buffer_load_dwordx4 v19, s[40:43], s23 offen sc1 lds
  s_add_u32 s23, s23, 8192
  s_getpc_b64 s[36:37]
  s_setpc_b64 s[38:39]
  s_branch fa_coG1
fa_coG:
  s_getpc_b64 s[36:37]
  s_setpc_b64 s[38:39]
  v_mfma_f32_16x16x32_bf16 v[232:235], a[192:195], a[212:215], v[232:235]
  v_mfma_f32_16x16x32_bf16 v[232:235], a[196:199], a[216:219], v[232:235]
  v_mfma_f32_16x16x32_bf16 v[232:235], a[200:203], a[220:223], v[232:235]
  v_mfma_f32_16x16x32_bf16 v[232:235], a[204:207], a[224:227], v[232:235]
  v_mfma_f32_16x16x32_bf16 v[232:235], a[208:211], a[228:231], v[232:235]
fa_coG1:
  s_waitcnt vmcnt(4)
  ds_read_b64_tr_b16 a[192:193], v9 offset:0
  ds_read_b64_tr_b16 a[194:195], v9 offset:128
  ds_read_b128 a[212:215], v10 offset:0
  ds_read_b64_tr_b16 a[196:197], v9 offset:1024
  ds_read_b64_tr_b16 a[198:199], v9 offset:1152
  ds_read_b128 a[216:219], v10 offset:512
  ds_read_b64_tr_b16 a[200:201], v9 offset:2048
  ds_read_b64_tr_b16 a[202:203], v9 offset:2176
  ds_read_b128 a[220:223], v10 offset:1024
  ds_read_b64_tr_b16 a[204:205], v9 offset:3072
  ds_read_b64_tr_b16 a[206:207], v9 offset:3200
  ds_read_b128 a[224:227], v10 offset:1536
  ds_read_b64_tr_b16 a[208:209], v9 offset:4096
  ds_read_b64_tr_b16 a[210:211], v9 offset:4224
  ds_read_b128 a[228:231], v10 offset:2048
  v_add_u32 v10, 2560, v10
  s_add_u32 s33, s33, 552960
  s_sub_u32 s14, s14, 1
  s_cmp_lg_u32 s14, 0
  s_cbranch_scc1 fa_coG
  v_accvgpr_read_b32 v8, a248
  v_accvgpr_read_b32 v11, a249
  v_accvgpr_read_b32 v12, a250
  v_accvgpr_read_b32 v13, a251
  v_accvgpr_read_b32 v14, a252
  v_subrev_u32 v11, 1024, v11
  v_subrev_u32 v12, 2048, v12
  v_subrev_u32 v13, 3072, v13
  s_mov_b32 s52, s60
  s_mov_b32 s53, s61
  s_mov_b32 s33, s35
  s_lshl_b32 s23, s20, 9
  v_add_u32 v16, s23, v10
  v_and_b32 v17, 7, v1
  v_mul_u32_u24 v9, 2560, v17
  v_lshrrev_b32 v17, 4, v1
  v_lshl_add_u32 v9, v17, 4, v9
  v_and_b32 v17, 8, v1
  v_lshl_add_u32 v9, v17, 27, v9
  s_waitcnt lgkmcnt(0)
  v_mfma_f32_16x16x32_bf16 v[232:235], a[192:195], a[212:215], v[232:235]
  v_mfma_f32_16x16x32_bf16 v[232:235], a[196:199], a[216:219], v[232:235]
  v_mfma_f32_16x16x32_bf16 v[232:235], a[200:203], a[220:223], v[232:235]
  v_mfma_f32_16x16x32_bf16 v[232:235], a[204:207], a[224:227], v[232:235]
  v_mfma_f32_16x16x32_bf16 v[232:235], a[208:211], a[228:231], v[232:235]
  s_nop 7
  ds_write_b128 v16, v[232:235]
  s_getpc_b64 s[36:37]
  s_setpc_b64 s[38:39]
  ds_read_b128 v[236:239], v10 offset:0
  ds_read_b128 v[240:243], v10 offset:512
  ds_read_b128 v[244:247], v10 offset:1024
  ds_read_b128 v[248:251], v10 offset:1536
  s_waitcnt vmcnt(4)
  ds_read_b64_tr_b16 a[192:193], v6 offset:0
  ds_read_b64_tr_b16 a[194:195], v6 offset:2560
  ds_read_b64_tr_b16 a[196:197], v6 offset:32
  ds_read_b64_tr_b16 a[198:199], v6 offset:2592
  ds_read_b64_tr_b16 a[200:201], v6 offset:64
  ds_read_b64_tr_b16 a[202:203], v6 offset:2624
  ds_read_b64_tr_b16 a[204:205], v6 offset:96
  ds_read_b64_tr_b16 a[206:207], v6 offset:2656
  ds_read_b64_tr_b16 a[208:209], v6 offset:128
  ds_read_b64_tr_b16 a[210:211], v6 offset:2688
  s_add_u32 s33, s33, 160
  s_mov_b32 s8, 0
  s_waitcnt lgkmcnt(10)
  v_cvt_pk_bf16_f32 v236, v236, v244
  v_cvt_pk_bf16_f32 v237, v237, v245
  v_cvt_pk_bf16_f32 v238, v238, v246
  v_cvt_pk_bf16_f32 v239, v239, v247
  v_cvt_pk_bf16_f32 v240, v240, v248
  v_cvt_pk_bf16_f32 v241, v241, v249
  v_cvt_pk_bf16_f32 v242, v242, v250
  v_cvt_pk_bf16_f32 v243, v243, v251
  v_lshlrev_b32 v244, 16, v236
  v_lshlrev_b32 v245, 16, v237
  v_lshlrev_b32 v246, 16, v238
  v_lshlrev_b32 v247, 16, v239
  v_lshlrev_b32 v248, 16, v240
  v_lshlrev_b32 v249, 16, v241
  v_lshlrev_b32 v250, 16, v242
  v_lshlrev_b32 v251, 16, v243
  v_mul_f32 v16, 0xbfb8aa3b, v244
  v_mul_f32 v17, 0xbfb8aa3b, v245
  v_mul_f32 v18, 0xbfb8aa3b, v246
  v_mul_f32 v19, 0xbfb8aa3b, v247
  v_mul_f32 v20, 0xbfb8aa3b, v248
  v_mul_f32 v21, 0xbfb8aa3b, v249
  v_mul_f32 v22, 0xbfb8aa3b, v250
  v_mul_f32 v23, 0xbfb8aa3b, v251
  v_exp_f32 v16, v16
  v_exp_f32 v17, v17
  v_exp_f32 v18, v18
  v_exp_f32 v19, v19
  v_exp_f32 v20, v20
  v_exp_f32 v21, v21
  v_exp_f32 v22, v22
  v_exp_f32 v23, v23
  v_add_f32 v16, 1.0, v16
  v_add_f32 v17, 1.0, v17
  v_add_f32 v18, 1.0, v18
  v_add_f32 v19, 1.0, v19
  v_add_f32 v20, 1.0, v20
  v_add_f32 v21, 1.0, v21
  v_add_f32 v22, 1.0, v22
  v_add_f32 v23, 1.0, v23
  v_rcp_f32 v16, v16
  v_rcp_f32 v17, v17
  v_rcp_f32 v18, v18
  v_rcp_f32 v19, v19
  v_rcp_f32 v20, v20
  v_rcp_f32 v21, v21
  v_rcp_f32 v22, v22
  v_rcp_f32 v23, v23
  v_and_b32 v236, 0xffff0000, v236
  v_and_b32 v237, 0xffff0000, v237
  v_and_b32 v238, 0xffff0000, v238
  v_and_b32 v239, 0xffff0000, v239
  v_and_b32 v240, 0xffff0000, v240
  v_and_b32 v241, 0xffff0000, v241
  v_and_b32 v242, 0xffff0000, v242
  v_and_b32 v243, 0xffff0000, v243
  v_pk_mul_f32 v[244:245], v[244:245], v[16:17]
  v_pk_mul_f32 v[246:247], v[246:247], v[18:19]
  v_pk_mul_f32 v[248:249], v[248:249], v[20:21]
  v_pk_mul_f32 v[250:251], v[250:251], v[22:23]
  v_cvt_pk_bf16_f32 v16, v244, v245
  v_cvt_pk_bf16_f32 v17, v246, v247
  v_cvt_pk_bf16_f32 v18, v248, v249
  v_cvt_pk_bf16_f32 v19, v250, v251
  v_lshlrev_b32 v244, 16, v16
  v_and_b32 v245, 0xffff0000, v16
  v_lshlrev_b32 v246, 16, v17
  v_and_b32 v247, 0xffff0000, v17
  v_lshlrev_b32 v248, 16, v18
  v_and_b32 v249, 0xffff0000, v18
  v_lshlrev_b32 v250, 16, v19
  v_and_b32 v251, 0xffff0000, v19
  v_pk_mul_f32 v[236:237], v[236:237], v[244:245]
  v_pk_mul_f32 v[238:239], v[238:239], v[246:247]
  v_pk_mul_f32 v[240:241], v[240:241], v[248:249]
  v_pk_mul_f32 v[242:243], v[242:243], v[250:251]
  v_cvt_pk_bf16_f32 v232, v236, v237
  v_cvt_pk_bf16_f32 v233, v238, v239
  v_cvt_pk_bf16_f32 v234, v240, v241
  v_cvt_pk_bf16_f32 v235, v242, v243
  s_nop 0
  s_waitcnt lgkmcnt(0)
  v_mfma_f32_16x16x32_bf16 v[236:239], a[192:195], v[232:235], 0
  v_mfma_f32_16x16x32_bf16 v[240:243], a[196:199], v[232:235], 0
  v_mfma_f32_16x16x32_bf16 v[244:247], a[200:203], v[232:235], 0
  v_mfma_f32_16x16x32_bf16 v[248:251], a[204:207], v[232:235], 0
  v_mfma_f32_16x16x32_bf16 v[252:255], a[208:211], v[232:235], 0
  s_nop 3
  buffer_store_dwordx4 v[236:239], v9, s[40:43], s10 offen offset:0 sc1
  buffer_store_dwordx4 v[240:243], v9, s[40:43], s10 offen offset:64 sc1
  buffer_store_dwordx4 v[244:247], v9, s[40:43], s10 offen offset:128 sc1
  buffer_store_dwordx4 v[248:251], v9, s[40:43], s10 offen offset:192 sc1
  buffer_store_dwordx4 v[252:255], v9, s[40:43], s10 offen offset:256 sc1
  s_add_u32 s10, s10, 320
  s_getpc_b64 s[36:37]
  s_setpc_b64 s[38:39]
  s_waitcnt vmcnt(4)
  ds_read_b64_tr_b16 a[192:193], v6 offset:0
  ds_read_b64_tr_b16 a[194:195], v6 offset:2560
  ds_read_b64_tr_b16 a[196:197], v6 offset:32
  ds_read_b64_tr_b16 a[198:199], v6 offset:2592
  ds_read_b64_tr_b16 a[200:201], v6 offset:64
  ds_read_b64_tr_b16 a[202:203], v6 offset:2624
  ds_read_b64_tr_b16 a[204:205], v6 offset:96
  ds_read_b64_tr_b16 a[206:207], v6 offset:2656
  ds_read_b64_tr_b16 a[208:209], v6 offset:128
  ds_read_b64_tr_b16 a[210:211], v6 offset:2688
  s_waitcnt lgkmcnt(0)
  v_mfma_f32_16x16x32_bf16 v[236:239], a[192:195], v[232:235], 0
  v_mfma_f32_16x16x32_bf16 v[240:243], a[196:199], v[232:235], 0
  v_mfma_f32_16x16x32_bf16 v[244:247], a[200:203], v[232:235], 0
  v_mfma_f32_16x16x32_bf16 v[248:251], a[204:207], v[232:235], 0
  v_mfma_f32_16x16x32_bf16 v[252:255], a[208:211], v[232:235], 0
  s_nop 3
  buffer_store_dwordx4 v[236:239], v9, s[40:43], s10 offen offset:0 sc1
  buffer_store_dwordx4 v[240:243], v9, s[40:43], s10 offen offset:64 sc1
  buffer_store_dwordx4 v[244:247], v9, s[40:43], s10 offen offset:128 sc1
  buffer_store_dwordx4 v[248:251], v9, s[40:43], s10 offen offset:192 sc1
  buffer_store_dwordx4 v[252:255], v9, s[40:43], s10 offen offset:256 sc1
  s_add_u32 s10, s10, 320
  s_getpc_b64 s[36:37]
  s_setpc_b64 s[38:39]
  s_sub_u32 s23, s2, 170
  s_lshl_b32 s31, s20, 6
  s_add_u32 s23, s23, s31
  s_lshl_b32 s23, s23, 2
  s_add_u32 s23, s23, 2650112
  s_waitcnt vmcnt(8)
  buffer_store_dword v4, off, s[40:43], s23 sc1
fa_coW:
  s_mov_b32 s12, 1
  s_mov_b32 s9, -1
  s_cmp_lg_u32 s11, 0
  s_cselect_b32 s32, s15, -1
  s_getpc_b64 s[36:37]
  s_setpc_b64 s[38:39]
  s_lshl_b32 s23, s22, 2
  s_add_u32 s23, s23, s20
  s_mul_i32 s13, s23, 163840
  s_add_u32 s13, s13, 4194304
  s_lshl_b32 s23, s23, 7
  s_add_u32 s23, s23, 2654208
  v_and_b32 v9, 31, v1
  v_lshl_add_u32 v9, v9, 2, s23
  v_and_b32 v10, 15, v1
  v_lshlrev_b32 v10, 2, v10
  v_add_u32 v10, 2629632, v10
  buffer_load_dword v8, v9, s[40:43], 0 offen sc1
  buffer_load_dword v15, v10, s[40:43], 0 offen sc1
  v_mov_b32 v20, v228
  v_mov_b32 v21, v229
  s_nop 1
  v_permlane16_swap_b32 v228, v20
  v_permlane16_swap_b32 v229, v21
  v_add_f32 v228, v228, v20
  v_add_f32 v229, v229, v21
  v_mov_b32 v20, v228
  v_mov_b32 v21, v229
  s_nop 1
  v_permlane32_swap_b32 v228, v20
  v_permlane32_swap_b32 v229, v21
  v_add_f32 v228, v228, v20
  v_add_f32 v229, v229, v21
  v_rcp_f32 v16, v228
  v_rcp_f32 v18, v229
  s_lshl_b32 s23, s22, 2
  v_mov_b32 v17, v16
  v_mov_b32 v19, v18
  s_add_u32 s23, s23, s20
  s_lshl_b32 s23, s23, 18
  s_lshl_b32 s31, s21, 12
  s_add_u32 s31, s31, 50331648
  s_add_u32 s64, s23, s31
  s_add_u32 s65, s64, 131072
  v_accvgpr_read_b32 v36, a0
  v_accvgpr_read_b32 v37, a1
  v_accvgpr_read_b32 v38, a2
  v_accvgpr_read_b32 v39, a3
  v_accvgpr_read_b32 v40, a8
  v_accvgpr_read_b32 v41, a9
  v_accvgpr_read_b32 v42, a10
  v_accvgpr_read_b32 v43, a11
  v_pk_mul_f32 v[36:37], v[36:37], v[16:17]
  v_pk_mul_f32 v[38:39], v[38:39], v[16:17]
  v_pk_mul_f32 v[40:41], v[40:41], v[16:17]
  v_pk_mul_f32 v[42:43], v[42:43], v[16:17]
  v_cvt_pk_bf16_f32 v32, v36, v37
  v_cvt_pk_bf16_f32 v33, v38, v39
  v_cvt_pk_bf16_f32 v34, v40, v41
  v_cvt_pk_bf16_f32 v35, v42, v43
  buffer_store_dwordx4 v[32:35], v2, s[40:43], s64 offen offset:0 sc1
  v_accvgpr_read_b32 v48, a16
  v_accvgpr_read_b32 v49, a17
  v_accvgpr_read_b32 v50, a18
  v_accvgpr_read_b32 v51, a19
  v_accvgpr_read_b32 v52, a24
  v_accvgpr_read_b32 v53, a25
  v_accvgpr_read_b32 v54, a26
  v_accvgpr_read_b32 v55, a27
  v_pk_mul_f32 v[48:49], v[48:49], v[16:17]
  v_pk_mul_f32 v[50:51], v[50:51], v[16:17]
  v_pk_mul_f32 v[52:53], v[52:53], v[16:17]
  v_pk_mul_f32 v[54:55], v[54:55], v[16:17]
  v_cvt_pk_bf16_f32 v44, v48, v49
  v_cvt_pk_bf16_f32 v45, v50, v51
  v_cvt_pk_bf16_f32 v46, v52, v53
  v_cvt_pk_bf16_f32 v47, v54, v55
  buffer_store_dwordx4 v[44:47], v2, s[40:43], s64 offen offset:1024 sc1
  v_accvgpr_read_b32 v100, a32
  v_accvgpr_read_b32 v101, a33
  v_accvgpr_read_b32 v102, a34
  v_accvgpr_read_b32 v103, a35
  v_accvgpr_read_b32 v104, a40
  v_accvgpr_read_b32 v105, a41
  v_accvgpr_read_b32 v106, a42
  v_accvgpr_read_b32 v107, a43
  v_pk_mul_f32 v[100:101], v[100:101], v[16:17]
  v_pk_mul_f32 v[102:103], v[102:103], v[16:17]
  v_pk_mul_f32 v[104:105], v[104:105], v[16:17]
  v_pk_mul_f32 v[106:107], v[106:107], v[16:17]
  v_cvt_pk_bf16_f32 v96, v100, v101
  v_cvt_pk_bf16_f32 v97, v102, v103
  v_cvt_pk_bf16_f32 v98, v104, v105
  v_cvt_pk_bf16_f32 v99, v106, v107
  buffer_store_dwordx4 v[96:99], v2, s[40:43], s64 offen offset:2048 sc1
  v_accvgpr_read_b32 v112, a48
  v_accvgpr_read_b32 v113, a49
  v_accvgpr_read_b32 v114, a50
  v_accvgpr_read_b32 v115, a51
  v_accvgpr_read_b32 v116, a56
  v_accvgpr_read_b32 v117, a57
  v_accvgpr_read_b32 v118, a58
  v_accvgpr_read_b32 v119, a59
  v_pk_mul_f32 v[112:113], v[112:113], v[16:17]
  v_pk_mul_f32 v[114:115], v[114:115], v[16:17]
  v_pk_mul_f32 v[116:117], v[116:117], v[16:17]
  v_pk_mul_f32 v[118:119], v[118:119], v[16:17]
  v_cvt_pk_bf16_f32 v108, v112, v113
  v_cvt_pk_bf16_f32 v109, v114, v115
  v_cvt_pk_bf16_f32 v110, v116, v117
  v_cvt_pk_bf16_f32 v111, v118, v119
  buffer_store_dwordx4 v[108:111], v2, s[40:43], s64 offen offset:3072 sc1
  v_accvgpr_read_b32 v36, a4
  v_accvgpr_read_b32 v37, a5
  v_accvgpr_read_b32 v38, a6
  v_accvgpr_read_b32 v39, a7
  v_accvgpr_read_b32 v40, a12
  v_accvgpr_read_b32 v41, a13
  v_accvgpr_read_b32 v42, a14
  v_accvgpr_read_b32 v43, a15
  v_pk_mul_f32 v[36:37], v[36:37], v[18:19]
  v_pk_mul_f32 v[38:39], v[38:39], v[18:19]
  v_pk_mul_f32 v[40:41], v[40:41], v[18:19]
  v_pk_mul_f32 v[42:43], v[42:43], v[18:19]
  v_cvt_pk_bf16_f32 v32, v36, v37
  v_cvt_pk_bf16_f32 v33, v38, v39
  v_cvt_pk_bf16_f32 v34, v40, v41
  v_cvt_pk_bf16_f32 v35, v42, v43
  buffer_store_dwordx4 v[32:35], v2, s[40:43], s65 offen offset:0 sc1
  v_accvgpr_read_b32 v48, a20
  v_accvgpr_read_b32 v49, a21
  v_accvgpr_read_b32 v50, a22
  v_accvgpr_read_b32 v51, a23
  v_accvgpr_read_b32 v52, a28
  v_accvgpr_read_b32 v53, a29
  v_accvgpr_read_b32 v54, a30
  v_accvgpr_read_b32 v55, a31
  v_pk_mul_f32 v[48:49], v[48:49], v[18:19]
  v_pk_mul_f32 v[50:51], v[50:51], v[18:19]
  v_pk_mul_f32 v[52:53], v[52:53], v[18:19]
  v_pk_mul_f32 v[54:55], v[54:55], v[18:19]
  v_cvt_pk_bf16_f32 v44, v48, v49
  v_cvt_pk_bf16_f32 v45, v50, v51
  v_cvt_pk_bf16_f32 v46, v52, v53
  v_cvt_pk_bf16_f32 v47, v54, v55
  buffer_store_dwordx4 v[44:47], v2, s[40:43], s65 offen offset:1024 sc1
  v_accvgpr_read_b32 v100, a36
  v_accvgpr_read_b32 v101, a37
  v_accvgpr_read_b32 v102, a38
  v_accvgpr_read_b32 v103, a39
  v_accvgpr_read_b32 v104, a44
  v_accvgpr_read_b32 v105, a45
  v_accvgpr_read_b32 v106, a46
  v_accvgpr_read_b32 v107, a47
  v_pk_mul_f32 v[100:101], v[100:101], v[18:19]
  v_pk_mul_f32 v[102:103], v[102:103], v[18:19]
  v_pk_mul_f32 v[104:105], v[104:105], v[18:19]
  v_pk_mul_f32 v[106:107], v[106:107], v[18:19]
  v_cvt_pk_bf16_f32 v96, v100, v101
  v_cvt_pk_bf16_f32 v97, v102, v103
  v_cvt_pk_bf16_f32 v98, v104, v105
  v_cvt_pk_bf16_f32 v99, v106, v107
  buffer_store_dwordx4 v[96:99], v2, s[40:43], s65 offen offset:2048 sc1
  v_accvgpr_read_b32 v112, a52
  v_accvgpr_read_b32 v113, a53
  v_accvgpr_read_b32 v114, a54
  v_accvgpr_read_b32 v115, a55
  v_accvgpr_read_b32 v116, a60
  v_accvgpr_read_b32 v117, a61
  v_accvgpr_read_b32 v118, a62
  v_accvgpr_read_b32 v119, a63
  v_pk_mul_f32 v[112:113], v[112:113], v[18:19]
  v_pk_mul_f32 v[114:115], v[114:115], v[18:19]
  v_pk_mul_f32 v[116:117], v[116:117], v[18:19]
  v_pk_mul_f32 v[118:119], v[118:119], v[18:19]
  v_cvt_pk_bf16_f32 v108, v112, v113
  v_cvt_pk_bf16_f32 v109, v114, v115
  v_cvt_pk_bf16_f32 v110, v116, v117
  v_cvt_pk_bf16_f32 v111, v118, v119
  buffer_store_dwordx4 v[108:111], v2, s[40:43], s65 offen offset:3072 sc1
  s_waitcnt vmcnt(8)
  v_cmp_eq_u32 vcc, 0, v8
  s_cbranch_vccnz fa_wof_spin
fa_wof_ok:
  v_cmp_eq_u32 vcc, 0, v15
  s_cbranch_vccnz fa_sel4_spin
fa_sel4_ok:
  s_lshl_b32 s31, s21, 6
  s_add_u32 s31, s31, 1
  v_subrev_u32 v16, s31, v15
  v_cmp_gt_u32 vcc, 64, v16
  s_cmp_lt_u32 s20, 2
  s_cselect_b32 s23, 0xff, 0
  s_and_b32 s10, vcc_lo, s23
  s_sub_u32 s23, s10, 1
  s_and_b32 s23, s23, s10
  s_cmp_eq_u32 s20, 1
  s_cselect_b32 s10, s23, s10
  s_cmp_eq_u32 s10, 0
  s_cbranch_scc1 fa_coEnd
  v_min_u32 v11, 53, v1
  s_lshr_b32 s23, s22, 1
  s_lshl_b32 s23, s23, 8
  s_add_u32 s23, s23, 2650112
  v_lshl_add_u32 v11, v11, 2, s23
  buffer_load_dword v14, v11, s[40:43], 0 offen sc1
  v_mul_u32_u24 v16, 3277, v1
  v_lshrrev_b32 v16, 16, v16
  v_mul_u32_u24 v8, 20, v16
  v_sub_u32 v8, v1, v8
  v_lshlrev_b32 v8, 4, v8
  v_mul_u32_u24 v9, 368640, v16
  v_add_u32 v9, v9, v8
  v_cmp_gt_u32 vcc, 3, v16
  v_mov_b32 v19, 1073741824
  s_nop 0
  v_cndmask_b32 v9, v19, v9, vcc
  s_mov_b32 s12, 2
  s_mov_b32 s32, -1
  s_mov_b32 s11, 0
  s_getpc_b64 s[36:37]
  s_setpc_b64 s[38:39]
  v_cmp_eq_u32 vcc, 0, v14
  s_cbranch_vccnz fa_yf_spin
fa_yf_ok:
fa_coY:
  s_ff1_i32_b32 s33, s10
  s_bitset0_b32 s10, s33
  s_sub_u32 s23, s10, 1
  s_and_b32 s10, s10, s23
  s_mul_i32 s14, s33, 2560
  s_mul_i32 s23, s22, 320
  s_add_u32 s14, s14, s23
  s_add_u32 s14, s14, 2686976
  buffer_load_dwordx4 v[64:67], v9, s[40:43], s14 offen sc1
  s_add_u32 s14, s14, 20480
  buffer_load_dwordx4 v[68:71], v9, s[40:43], s14 offen sc1
  s_add_u32 s14, s14, 20480
  buffer_load_dwordx4 v[72:75], v9, s[40:43], s14 offen sc1
  s_add_u32 s14, s14, 20480
  buffer_load_dwordx4 v[76:79], v9, s[40:43], s14 offen sc1
  s_add_u32 s14, s14, 20480
  buffer_load_dwordx4 v[80:83], v9, s[40:43], s14 offen sc1
  s_add_u32 s14, s14, 20480
  buffer_load_dwordx4 v[84:87], v9, s[40:43], s14 offen sc1
  s_add_u32 s14, s14, 20480
  buffer_load_dwordx4 v[88:91], v9, s[40:43], s14 offen sc1
  s_add_u32 s14, s14, 20480
  buffer_load_dwordx4 v[92:95], v9, s[40:43], s14 offen sc1
  s_add_u32 s14, s14, 20480
  buffer_load_dwordx4 v[128:131], v9, s[40:43], s14 offen sc1
  s_add_u32 s14, s14, 20480
  buffer_load_dwordx4 v[132:135], v9, s[40:43], s14 offen sc1
  s_add_u32 s14, s14, 20480
  buffer_load_dwordx4 v[136:139], v9, s[40:43], s14 offen sc1
  s_add_u32 s14, s14, 20480
  buffer_load_dwordx4 v[140:143], v9, s[40:43], s14 offen sc1
  s_add_u32 s14, s14, 20480
  buffer_load_dwordx4 v[144:147], v9, s[40:43], s14 offen sc1
  s_add_u32 s14, s14, 20480
  buffer_load_dwordx4 v[148:151], v9, s[40:43], s14 offen sc1
  s_add_u32 s14, s14, 20480
  buffer_load_dwordx4 v[152:155], v9, s[40:43], s14 offen sc1
  s_add_u32 s14, s14, 20480
  buffer_load_dwordx4 v[156:159], v9, s[40:43], s14 offen sc1
  s_add_u32 s14, s14, 20480
  buffer_load_dwordx4 v[176:179], v9, s[40:43], s14 offen sc1
  s_add_u32 s14, s14, 20480
  buffer_load_dwordx4 v[180:183], v9, s[40:43], s14 offen sc1
  s_add_u32 s14, s14, 20480
  s_lshl_b32 s14, s20, 10
  s_add_u32 s14, s14, 159744
  v_add_u32 v19, s14, v2
  s_add_u32 s23, s33, 8
  v_readlane_b32 s35, v15, s23
  s_waitcnt vmcnt(0)
  v_pk_add_f32 v[64:65], v[64:65], v[68:69]
  v_pk_add_f32 v[66:67], v[66:67], v[70:71]
  v_pk_add_f32 v[64:65], v[64:65], v[72:73]
  v_pk_add_f32 v[66:67], v[66:67], v[74:75]
  v_pk_add_f32 v[64:65], v[64:65], v[76:77]
  v_pk_add_f32 v[66:67], v[66:67], v[78:79]
  v_pk_add_f32 v[64:65], v[64:65], v[80:81]
  v_pk_add_f32 v[66:67], v[66:67], v[82:83]
  v_pk_add_f32 v[64:65], v[64:65], v[84:85]
  v_pk_add_f32 v[66:67], v[66:67], v[86:87]
  v_pk_add_f32 v[64:65], v[64:65], v[88:89]
  v_pk_add_f32 v[66:67], v[66:67], v[90:91]
  v_pk_add_f32 v[64:65], v[64:65], v[92:93]
  v_pk_add_f32 v[66:67], v[66:67], v[94:95]
  v_pk_add_f32 v[64:65], v[64:65], v[128:129]
  v_pk_add_f32 v[66:67], v[66:67], v[130:131]
  v_pk_add_f32 v[64:65], v[64:65], v[132:133]
  v_pk_add_f32 v[66:67], v[66:67], v[134:135]
  v_pk_add_f32 v[64:65], v[64:65], v[136:137]
  v_pk_add_f32 v[66:67], v[66:67], v[138:139]
  v_pk_add_f32 v[64:65], v[64:65], v[140:141]
  v_pk_add_f32 v[66:67], v[66:67], v[142:143]
  v_pk_add_f32 v[64:65], v[64:65], v[144:145]
  v_pk_add_f32 v[66:67], v[66:67], v[146:147]
  v_pk_add_f32 v[64:65], v[64:65], v[148:149]
  v_pk_add_f32 v[66:67], v[66:67], v[150:151]
  v_pk_add_f32 v[64:65], v[64:65], v[152:153]
  v_pk_add_f32 v[66:67], v[66:67], v[154:155]
  v_pk_add_f32 v[64:65], v[64:65], v[156:157]
  v_pk_add_f32 v[66:67], v[66:67], v[158:159]
  v_pk_add_f32 v[64:65], v[64:65], v[176:177]
  v_pk_add_f32 v[66:67], v[66:67], v[178:179]
  v_pk_add_f32 v[64:65], v[64:65], v[180:181]
  v_pk_add_f32 v[66:67], v[66:67], v[182:183]
  ds_write_b128 v19, v[64:67]
  v_add_u32 v19, s14, v8
  s_and_b32 s35, s35, 0xffff0000
  s_waitcnt lgkmcnt(0)
  ds_read_b128 v[64:67], v19
  ds_read_b128 v[68:71], v19 offset:320
  ds_read_b128 v[72:75], v19 offset:640
  s_mul_i32 s14, s33, 320
  s_add_u32 s14, s14, 155648
  v_add_u32 v19, s14, v8
  s_waitcnt lgkmcnt(0)
  v_add_f32 v64, v64, v68
  v_add_f32 v64, v64, v72
  v_cvt_pk_bf16_f32 v64, v64, v64
  v_and_b32 v64, 0xffff0000, v64
  v_mul_f32 v64, s35, v64
  v_cvt_pk_bf16_f32 v64, v64, v64
  v_and_b32 v64, 0xffff0000, v64
  v_add_f32 v65, v65, v69
  v_add_f32 v65, v65, v73
  v_cvt_pk_bf16_f32 v65, v65, v65
  v_and_b32 v65, 0xffff0000, v65
  v_mul_f32 v65, s35, v65
  v_cvt_pk_bf16_f32 v65, v65, v65
  v_and_b32 v65, 0xffff0000, v65
  v_add_f32 v66, v66, v70
  v_add_f32 v66, v66, v74
  v_cvt_pk_bf16_f32 v66, v66, v66
  v_and_b32 v66, 0xffff0000, v66
  v_mul_f32 v66, s35, v66
  v_cvt_pk_bf16_f32 v66, v66, v66
  v_and_b32 v66, 0xffff0000, v66
  v_add_f32 v67, v67, v71
  v_add_f32 v67, v67, v75
  v_cvt_pk_bf16_f32 v67, v67, v67
  v_and_b32 v67, 0xffff0000, v67
  v_mul_f32 v67, s35, v67
  v_cvt_pk_bf16_f32 v67, v67, v67
  v_and_b32 v67, 0xffff0000, v67
  ds_write_b128 v19, v[64:67]
  s_waitcnt lgkmcnt(0)
  s_cmp_lg_u32 s10, 0
  s_cbranch_scc1 fa_coY
fa_coEnd:
  s_mov_b32 s12, 3
  s_mov_b32 s32, -1
  s_setpc_b64 s[38:39]
fa_hk7:
  s_getpc_b64 s[38:39]
fa_hp7:
  s_add_u32 s36, s36, 4
  s_addc_u32 s37, s37, 0
  s_sub_u32 s38, s38, fa_hp7-fa_hb7
  s_subb_u32 s39, s39, 0
  s_setpc_b64 s[36:37]
fa_hk8:
  s_getpc_b64 s[38:39]
fa_hp8:
  s_add_u32 s36, s36, 4
  s_addc_u32 s37, s37, 0
  s_sub_u32 s38, s38, fa_hp8-fa_hb8
  s_subb_u32 s39, s39, 0
  s_setpc_b64 s[36:37]
fa_disp:
  s_cmp_eq_u32 s29, 7
  s_cbranch_scc1 fa_SSW7
  s_cmp_eq_u32 s29, 6
  s_cbranch_scc1 fa_SSW6
  s_cmp_eq_u32 s29, 5
  s_cbranch_scc1 fa_SSW5
  s_cmp_eq_u32 s29, 4
  s_cbranch_scc1 fa_SSW4
  s_cmp_eq_u32 s29, 3
  s_cbranch_scc1 fa_SSW3
  s_cmp_eq_u32 s29, 2
  s_cbranch_scc1 fa_SSW2
  s_cmp_eq_u32 s29, 1
  s_cbranch_scc1 fa_SSW1
  s_branch fa_Bexit
fa_hk9:
  s_getpc_b64 s[38:39]
fa_hp9:
  s_add_u32 s36, s36, 4
  s_addc_u32 s37, s37, 0
  s_add_u32 s38, s38, fa_hb9-fa_hp9
  s_addc_u32 s39, s39, 0
  s_setpc_b64 s[36:37]
fa_puby:
  s_waitcnt vmcnt(0)
  buffer_store_dword v4, v30, s[40:43], 0 offen sc1
  s_cmp_lt_u32 s12, 3
  s_cbranch_scc1 fa_hk9
fa_hb9:
  s_add_u32 s14, s13, 61440
  buffer_load_dwordx4 v[64:67], v2, s[40:43], s14 offen offset:0 sc1
  buffer_load_dwordx4 v[68:71], v2, s[40:43], s14 offen offset:1024 sc1
  buffer_load_dwordx4 v[72:75], v2, s[40:43], s14 offen offset:2048 sc1
  buffer_load_dwordx4 v[76:79], v2, s[40:43], s14 offen offset:3072 sc1
  s_add_u32 s14, s13, 65536
  buffer_load_dwordx4 v[80:83], v2, s[40:43], s14 offen offset:0 sc1
  buffer_load_dwordx4 v[84:87], v2, s[40:43], s14 offen offset:1024 sc1
  buffer_load_dwordx4 v[88:91], v2, s[40:43], s14 offen offset:2048 sc1
  buffer_load_dwordx4 v[92:95], v2, s[40:43], s14 offen offset:3072 sc1
  s_branch fa_pubb
fa_left:
  s_add_u32 s14, s13, 0
  buffer_load_dwordx4 a[0:3], v2, s[40:43], s14 offen offset:0 sc1
  buffer_load_dwordx4 a[4:7], v2, s[40:43], s14 offen offset:1024 sc1
  buffer_load_dwordx4 a[8:11], v2, s[40:43], s14 offen offset:2048 sc1
  buffer_load_dwordx4 a[12:15], v2, s[40:43], s14 offen offset:3072 sc1
  s_add_u32 s14, s13, 4096
  buffer_load_dwordx4 a[16:19], v2, s[40:43], s14 offen offset:0 sc1
  buffer_load_dwordx4 a[20:23], v2, s[40:43], s14 offen offset:1024 sc1
  s_cmp_ge_u32 s29, 7
  s_cbranch_scc1 fa_leftb
  s_add_u32 s14, s13, 4096
  buffer_load_dwordx4 a[24:27], v2, s[40:43], s14 offen offset:2048 sc1
  buffer_load_dwordx4 a[28:31], v2, s[40:43], s14 offen offset:3072 sc1
  s_add_u32 s14, s13, 8192
  buffer_load_dwordx4 a[32:35], v2, s[40:43], s14 offen offset:0 sc1
  buffer_load_dwordx4 a[36:39], v2, s[40:43], s14 offen offset:1024 sc1
  buffer_load_dwordx4 a[40:43], v2, s[40:43], s14 offen offset:2048 sc1
  buffer_load_dwordx4 a[44:47], v2, s[40:43], s14 offen offset:3072 sc1
  s_cmp_ge_u32 s29, 6
  s_cbranch_scc1 fa_leftb
  s_add_u32 s14, s13, 12288
  buffer_load_dwordx4 a[48:51], v2, s[40:43], s14 offen offset:0 sc1
  buffer_load_dwordx4 a[52:55], v2, s[40:43], s14 offen offset:1024 sc1
  buffer_load_dwordx4 a[56:59], v2, s[40:43], s14 offen offset:2048 sc1
  buffer_load_dwordx4 a[60:63], v2, s[40:43], s14 offen offset:3072 sc1
  s_add_u32 s14, s13, 16384
  buffer_load_dwordx4 a[192:195], v2, s[40:43], s14 offen offset:0 sc1
  buffer_load_dwordx4 a[196:199], v2, s[40:43], s14 offen offset:1024 sc1
  s_cmp_ge_u32 s29, 5
  s_cbranch_scc1 fa_leftb
  s_add_u32 s14, s13, 16384
  buffer_load_dwordx4 a[200:203], v2, s[40:43], s14 offen offset:2048 sc1
  buffer_load_dwordx4 a[204:207], v2, s[40:43], s14 offen offset:3072 sc1
  s_add_u32 s14, s13, 20480
  buffer_load_dwordx4 a[208:211], v2, s[40:43], s14 offen offset:0 sc1
  buffer_load_dwordx4 a[212:215], v2, s[40:43], s14 offen offset:1024 sc1
  buffer_load_dwordx4 a[216:219], v2, s[40:43], s14 offen offset:2048 sc1
  buffer_load_dwordx4 a[220:223], v2, s[40:43], s14 offen offset:3072 sc1
  s_cmp_ge_u32 s29, 4
  s_cbranch_scc1 fa_leftb
  s_add_u32 s14, s13, 24576
  buffer_load_dwordx4 a[224:227], v2, s[40:43], s14 offen offset:0 sc1
  buffer_load_dwordx4 a[228:231], v2, s[40:43], s14 offen offset:1024 sc1
  buffer_load_dwordx4 a[232:235], v2, s[40:43], s14 offen offset:2048 sc1
  buffer_load_dwordx4 a[236:239], v2, s[40:43], s14 offen offset:3072 sc1
  s_add_u32 s14, s13, 28672
  buffer_load_dwordx4 a[240:243], v2, s[40:43], s14 offen offset:0 sc1
  buffer_load_dwordx4 a[244:247], v2, s[40:43], s14 offen offset:1024 sc1
  s_cmp_ge_u32 s29, 3
  s_cbranch_scc1 fa_leftb
  s_add_u32 s14, s13, 28672
  buffer_load_dwordx4 a[248:251], v2, s[40:43], s14 offen offset:2048 sc1
  buffer_load_dwordx4 a[252:255], v2, s[40:43], s14 offen offset:3072 sc1
  s_add_u32 s14, s13, 32768
  buffer_load_dwordx4 v[32:35], v2, s[40:43], s14 offen offset:0 sc1
  buffer_load_dwordx4 v[36:39], v2, s[40:43], s14 offen offset:1024 sc1
  buffer_load_dwordx4 v[40:43], v2, s[40:43], s14 offen offset:2048 sc1
  buffer_load_dwordx4 v[44:47], v2, s[40:43], s14 offen offset:3072 sc1
  s_cmp_ge_u32 s29, 2
  s_cbranch_scc1 fa_leftb
  s_add_u32 s14, s13, 36864
  buffer_load_dwordx4 v[48:51], v2, s[40:43], s14 offen offset:0 sc1
  buffer_load_dwordx4 v[52:55], v2, s[40:43], s14 offen offset:1024 sc1
  buffer_load_dwordx4 v[56:59], v2, s[40:43], s14 offen offset:2048 sc1
  buffer_load_dwordx4 v[60:63], v2, s[40:43], s14 offen offset:3072 sc1
  s_add_u32 s14, s13, 40960
  buffer_load_dwordx4 v[96:99], v2, s[40:43], s14 offen offset:0 sc1
  buffer_load_dwordx4 v[100:103], v2, s[40:43], s14 offen offset:1024 sc1
  s_cmp_ge_u32 s29, 1
  s_cbranch_scc1 fa_leftb
  s_add_u32 s14, s13, 40960
  buffer_load_dwordx4 v[104:107], v2, s[40:43], s14 offen offset:2048 sc1
  buffer_load_dwordx4 v[108:111], v2, s[40:43], s14 offen offset:3072 sc1
  s_add_u32 s14, s13, 45056
  buffer_load_dwordx4 v[112:115], v2, s[40:43], s14 offen offset:0 sc1
  buffer_load_dwordx4 v[116:119], v2, s[40:43], s14 offen offset:1024 sc1
  buffer_load_dwordx4 v[120:123], v2, s[40:43], s14 offen offset:2048 sc1
  buffer_load_dwordx4 v[124:127], v2, s[40:43], s14 offen offset:3072 sc1
  s_branch fa_leftb
fa_ctx_spin:
  s_mov_b32 s83, 200000
fa_ctx_spin2:
  buffer_load_dword v13, v12, s[40:43], 0 offen sc1
  s_waitcnt vmcnt(0)
  v_cmp_eq_u32 vcc, 0, v13
  s_cbranch_vccz fa_ctx_ok
  s_sleep 8
  s_sub_u32 s83, s83, 1
  s_cmp_lg_u32 s83, 0
  s_cbranch_scc1 fa_ctx_spin2
  s_branch fa_ctx_ok
fa_stub0:
  s_call_b64 s[76:77], fa_rare00
  s_call_b64 s[76:77], fa_rare10
  s_branch fa_back0
fa_stub1:
  s_call_b64 s[76:77], fa_rare01
  s_call_b64 s[76:77], fa_rare11
  s_branch fa_back1
fa_stub2:
  s_call_b64 s[76:77], fa_rare00
  s_call_b64 s[76:77], fa_rare10
  s_branch fa_back2
fa_stub3:
  s_call_b64 s[76:77], fa_rare01
  s_call_b64 s[76:77], fa_rare11
  s_branch fa_back3
fa_stub4:
  s_call_b64 s[76:77], fa_rare01
  s_call_b64 s[76:77], fa_rare11
  s_branch fa_back4
fa_stub5:
  s_call_b64 s[76:77], fa_rare00
  s_call_b64 s[76:77], fa_rare10
  s_branch fa_back5
fa_stub6:
  s_call_b64 s[76:77], fa_rare11
  s_branch fa_back6
fa_stub7:
  s_call_b64 s[76:77], fa_rare10
  s_branch fa_back7
fa_stub8:
  s_call_b64 s[76:77], fa_rare01
  s_call_b64 s[76:77], fa_rare11
  s_branch fa_back8
fa_stub9:
  s_call_b64 s[76:77], fa_rare10
  s_branch fa_back9
fa_stub10:
  s_call_b64 s[76:77], fa_rare11
  s_branch fa_back10
fa_stub11:
  s_call_b64 s[76:77], fa_rare10
  s_branch fa_back11
fa_stub12:
  s_call_b64 s[76:77], fa_rare11
  s_branch fa_back12
fa_stub13:
  s_call_b64 s[76:77], fa_rare10
  s_branch fa_back13
fa_stub14:
  s_call_b64 s[76:77], fa_rare11
  s_branch fa_back14
fa_stub15:
  s_call_b64 s[76:77], fa_rare10
  s_branch fa_back15
fa_stub16:
  s_call_b64 s[76:77], fa_rare11
  s_branch fa_back16
fa_stub17:
  s_call_b64 s[76:77], fa_rare10
  s_branch fa_back17
fa_stub18:
  s_call_b64 s[76:77], fa_rare11
  s_branch fa_back18
fa_stub19:
  s_call_b64 s[76:77], fa_rare10
  s_branch fa_back19
fa_stub20:
  s_call_b64 s[76:77], fa_rare11
  s_branch fa_back20
fa_stub21:
  s_call_b64 s[76:77], fa_rare10
  s_branch fa_back21
fa_stub22:
  s_call_b64 s[76:77], fa_rare11
  s_branch fa_back22
fa_stub23:
  s_call_b64 s[76:77], fa_rare10
  s_branch fa_back23
fa_stub24:
  s_call_b64 s[76:77], fa_rare11
  s_branch fa_back24
fa_stub25:
  s_call_b64 s[76:77], fa_rare10
  s_branch fa_back25
fa_stub26:
  s_call_b64 s[76:77], fa_rare11
  s_branch fa_back26
fa_stub27:
  s_call_b64 s[76:77], fa_rare10
  s_branch fa_back27
fa_stub28:
  s_call_b64 s[76:77], fa_rare11
  s_branch fa_back28
fa_stub29:
  s_call_b64 s[76:77], fa_rare10
  s_branch fa_back29
fa_stub30:
  s_call_b64 s[76:77], fa_rare11
  s_branch fa_back30
fa_codeend:
fa_rare00:
  s_nop 7
  v_max3_f32 v16, v96, v97, v98
  v_max3_f32 v16, v16, v99, v100
  v_max3_f32 v16, v16, v101, v102
  v_max3_f32 v16, v16, v103, 0
  v_mov_b32 v18, v16
  s_nop 1
  v_permlane16_swap_b32 v16, v18
  v_max_f32 v16, v16, v18
  v_mov_b32 v18, v16
  s_nop 1
  v_permlane32_swap_b32 v16, v18
  v_max_f32 v16, v16, v18
  v_sub_f32 v96, v96, v16
  v_sub_f32 v112, v112, v16
  v_sub_f32 v97, v97, v16
  v_sub_f32 v113, v113, v16
  v_sub_f32 v98, v98, v16
  v_sub_f32 v114, v114, v16
  v_sub_f32 v99, v99, v16
  v_sub_f32 v115, v115, v16
  v_sub_f32 v100, v100, v16
  v_sub_f32 v116, v116, v16
  v_sub_f32 v101, v101, v16
  v_sub_f32 v117, v117, v16
  v_sub_f32 v102, v102, v16
  v_sub_f32 v118, v118, v16
  v_sub_f32 v103, v103, v16
  v_sub_f32 v119, v119, v16
  v_max3_f32 v17, v104, v105, v106
  v_max3_f32 v17, v17, v107, v108
  v_max3_f32 v17, v17, v109, v110
  v_max3_f32 v17, v17, v111, 0
  v_mov_b32 v18, v17
  s_nop 1
  v_permlane16_swap_b32 v17, v18
  v_max_f32 v17, v17, v18
  v_mov_b32 v18, v17
  s_nop 1
  v_permlane32_swap_b32 v17, v18
  v_max_f32 v17, v17, v18
  v_sub_f32 v104, v104, v17
  v_sub_f32 v120, v120, v17
  v_sub_f32 v105, v105, v17
  v_sub_f32 v121, v121, v17
  v_sub_f32 v106, v106, v17
  v_sub_f32 v122, v122, v17
  v_sub_f32 v107, v107, v17
  v_sub_f32 v123, v123, v17
  v_sub_f32 v108, v108, v17
  v_sub_f32 v124, v124, v17
  v_sub_f32 v109, v109, v17
  v_sub_f32 v125, v125, v17
  v_sub_f32 v110, v110, v17
  v_sub_f32 v126, v126, v17
  v_sub_f32 v111, v111, v17
  v_sub_f32 v127, v127, v17
  s_call_b64 s[78:79], fa_resc0
  v_exp_f32 v208, v96
  v_exp_f32 v209, v97
  v_exp_f32 v210, v98
  v_add_f32 v224, v208, v209
  v_cvt_pk_bf16_f32 v160, v208, v209
  v_exp_f32 v211, v99
  v_add_f32 v224, v224, v210
  v_exp_f32 v212, v100
  v_add_f32 v224, v224, v211
  v_cvt_pk_bf16_f32 v161, v210, v211
  v_exp_f32 v213, v101
  v_add_f32 v224, v224, v212
  v_exp_f32 v214, v102
  v_add_f32 v224, v224, v213
  v_cvt_pk_bf16_f32 v162, v212, v213
  v_exp_f32 v215, v103
  v_add_f32 v224, v224, v214
  v_exp_f32 v208, v104
  v_add_f32 v224, v224, v215
  v_cvt_pk_bf16_f32 v163, v214, v215
  v_exp_f32 v209, v105
  v_exp_f32 v210, v106
  v_add_f32 v225, v208, v209
  v_cvt_pk_bf16_f32 v164, v208, v209
  v_exp_f32 v211, v107
  v_add_f32 v225, v225, v210
  v_exp_f32 v212, v108
  v_add_f32 v225, v225, v211
  v_cvt_pk_bf16_f32 v165, v210, v211
  v_exp_f32 v213, v109
  v_add_f32 v225, v225, v212
  v_exp_f32 v214, v110
  v_add_f32 v225, v225, v213
  v_cvt_pk_bf16_f32 v166, v212, v213
  v_exp_f32 v215, v111
  v_add_f32 v225, v225, v214
  s_nop 0
  v_add_f32 v225, v225, v215
  v_cvt_pk_bf16_f32 v167, v214, v215
  s_nop 1
  s_setpc_b64 s[76:77]
fa_rare01:
  s_nop 7
  v_max3_f32 v16, v112, v113, v114
  v_max3_f32 v16, v16, v115, v116
  v_max3_f32 v16, v16, v117, v118
  v_max3_f32 v16, v16, v119, 0
  v_mov_b32 v18, v16
  s_nop 1
  v_permlane16_swap_b32 v16, v18
  v_max_f32 v16, v16, v18
  v_mov_b32 v18, v16
  s_nop 1
  v_permlane32_swap_b32 v16, v18
  v_max_f32 v16, v16, v18
  v_sub_f32 v112, v112, v16
  v_sub_f32 v96, v96, v16
  v_sub_f32 v113, v113, v16
  v_sub_f32 v97, v97, v16
  v_sub_f32 v114, v114, v16
  v_sub_f32 v98, v98, v16
  v_sub_f32 v115, v115, v16
  v_sub_f32 v99, v99, v16
  v_sub_f32 v116, v116, v16
  v_sub_f32 v100, v100, v16
  v_sub_f32 v117, v117, v16
  v_sub_f32 v101, v101, v16
  v_sub_f32 v118, v118, v16
  v_sub_f32 v102, v102, v16
  v_sub_f32 v119, v119, v16
  v_sub_f32 v103, v103, v16
  v_max3_f32 v17, v120, v121, v122
  v_max3_f32 v17, v17, v123, v124
  v_max3_f32 v17, v17, v125, v126
  v_max3_f32 v17, v17, v127, 0
  v_mov_b32 v18, v17
  s_nop 1
  v_permlane16_swap_b32 v17, v18
  v_max_f32 v17, v17, v18
  v_mov_b32 v18, v17
  s_nop 1
  v_permlane32_swap_b32 v17, v18
  v_max_f32 v17, v17, v18
  v_sub_f32 v120, v120, v17
  v_sub_f32 v104, v104, v17
  v_sub_f32 v121, v121, v17
  v_sub_f32 v105, v105, v17
  v_sub_f32 v122, v122, v17
  v_sub_f32 v106, v106, v17
  v_sub_f32 v123, v123, v17
  v_sub_f32 v107, v107, v17
  v_sub_f32 v124, v124, v17
  v_sub_f32 v108, v108, v17
  v_sub_f32 v125, v125, v17
  v_sub_f32 v109, v109, v17
  v_sub_f32 v126, v126, v17
  v_sub_f32 v110, v110, v17
  v_sub_f32 v127, v127, v17
  v_sub_f32 v111, v111, v17
  s_call_b64 s[78:79], fa_resc0
  v_exp_f32 v208, v112
  v_exp_f32 v209, v113
  v_exp_f32 v210, v114
  v_add_f32 v224, v208, v209
  v_cvt_pk_bf16_f32 v168, v208, v209
  v_exp_f32 v211, v115
  v_add_f32 v224, v224, v210
  v_exp_f32 v212, v116
  v_add_f32 v224, v224, v211
  v_cvt_pk_bf16_f32 v169, v210, v211
  v_exp_f32 v213, v117
  v_add_f32 v224, v224, v212
  v_exp_f32 v214, v118
  v_add_f32 v224, v224, v213
  v_cvt_pk_bf16_f32 v170, v212, v213
  v_exp_f32 v215, v119
  v_add_f32 v224, v224, v214
  v_exp_f32 v208, v120
  v_add_f32 v224, v224, v215
  v_cvt_pk_bf16_f32 v171, v214, v215
  v_exp_f32 v209, v121
  v_exp_f32 v210, v122
  v_add_f32 v225, v208, v209
  v_cvt_pk_bf16_f32 v172, v208, v209
  v_exp_f32 v211, v123
  v_add_f32 v225, v225, v210
  v_exp_f32 v212, v124
  v_add_f32 v225, v225, v211
  v_cvt_pk_bf16_f32 v173, v210, v211
  v_exp_f32 v213, v125
  v_add_f32 v225, v225, v212
  v_exp_f32 v214, v126
  v_add_f32 v225, v225, v213
  v_cvt_pk_bf16_f32 v174, v212, v213
  v_exp_f32 v215, v127
  v_add_f32 v225, v225, v214
  s_nop 0
  v_add_f32 v225, v225, v215
  v_cvt_pk_bf16_f32 v175, v214, v215
  s_nop 1
  s_setpc_b64 s[76:77]
fa_resc0:
  v_sub_f32 v192, v192, v16
  v_sub_f32 v193, v193, v16
  v_sub_f32 v194, v194, v16
  v_sub_f32 v195, v195, v16
  v_exp_f32 v18, -v16
  v_sub_f32 v196, v196, v17
  v_sub_f32 v197, v197, v17
  v_sub_f32 v198, v198, v17
  v_sub_f32 v199, v199, v17
  v_exp_f32 v19, -v17
  s_nop 0
  v_mul_f32 v228, v228, v18
  v_mul_f32 v229, v229, v19
  v_accvgpr_read_b32 v20, a0
  v_accvgpr_read_b32 v21, a1
  v_accvgpr_read_b32 v22, a2
  v_accvgpr_read_b32 v23, a3
  v_mul_f32 v20, v20, v18
  v_mul_f32 v21, v21, v18
  v_mul_f32 v22, v22, v18
  v_mul_f32 v23, v23, v18
  v_accvgpr_write_b32 a0, v20
  v_accvgpr_write_b32 a1, v21
  v_accvgpr_write_b32 a2, v22
  v_accvgpr_write_b32 a3, v23
  v_accvgpr_read_b32 v20, a4
  v_accvgpr_read_b32 v21, a5
  v_accvgpr_read_b32 v22, a6
  v_accvgpr_read_b32 v23, a7
  v_mul_f32 v20, v20, v19
  v_mul_f32 v21, v21, v19
  v_mul_f32 v22, v22, v19
  v_mul_f32 v23, v23, v19
  v_accvgpr_write_b32 a4, v20
  v_accvgpr_write_b32 a5, v21
  v_accvgpr_write_b32 a6, v22
  v_accvgpr_write_b32 a7, v23
  v_accvgpr_read_b32 v20, a8
  v_accvgpr_read_b32 v21, a9
  v_accvgpr_read_b32 v22, a10
  v_accvgpr_read_b32 v23, a11
  v_mul_f32 v20, v20, v18
  v_mul_f32 v21, v21, v18
  v_mul_f32 v22, v22, v18
  v_mul_f32 v23, v23, v18
  v_accvgpr_write_b32 a8, v20
  v_accvgpr_write_b32 a9, v21
  v_accvgpr_write_b32 a10, v22
  v_accvgpr_write_b32 a11, v23
  v_accvgpr_read_b32 v20, a12
  v_accvgpr_read_b32 v21, a13
  v_accvgpr_read_b32 v22, a14
  v_accvgpr_read_b32 v23, a15
  v_mul_f32 v20, v20, v19
  v_mul_f32 v21, v21, v19
  v_mul_f32 v22, v22, v19
  v_mul_f32 v23, v23, v19
  v_accvgpr_write_b32 a12, v20
  v_accvgpr_write_b32 a13, v21
  v_accvgpr_write_b32 a14, v22
  v_accvgpr_write_b32 a15, v23
  v_accvgpr_read_b32 v20, a16
  v_accvgpr_read_b32 v21, a17
  v_accvgpr_read_b32 v22, a18
  v_accvgpr_read_b32 v23, a19
  v_mul_f32 v20, v20, v18
  v_mul_f32 v21, v21, v18
  v_mul_f32 v22, v22, v18
  v_mul_f32 v23, v23, v18
  v_accvgpr_write_b32 a16, v20
  v_accvgpr_write_b32 a17, v21
  v_accvgpr_write_b32 a18, v22
  v_accvgpr_write_b32 a19, v23
  v_accvgpr_read_b32 v20, a20
  v_accvgpr_read_b32 v21, a21
  v_accvgpr_read_b32 v22, a22
  v_accvgpr_read_b32 v23, a23
  v_mul_f32 v20, v20, v19
  v_mul_f32 v21, v21, v19
  v_mul_f32 v22, v22, v19
  v_mul_f32 v23, v23, v19
  v_accvgpr_write_b32 a20, v20
  v_accvgpr_write_b32 a21, v21
  v_accvgpr_write_b32 a22, v22
  v_accvgpr_write_b32 a23, v23
  v_accvgpr_read_b32 v20, a24
  v_accvgpr_read_b32 v21, a25
  v_accvgpr_read_b32 v22, a26
  v_accvgpr_read_b32 v23, a27
  v_mul_f32 v20, v20, v18
  v_mul_f32 v21, v21, v18
  v_mul_f32 v22, v22, v18
  v_mul_f32 v23, v23, v18
  v_accvgpr_write_b32 a24, v20
  v_accvgpr_write_b32 a25, v21
  v_accvgpr_write_b32 a26, v22
  v_accvgpr_write_b32 a27, v23
  v_accvgpr_read_b32 v20, a28
  v_accvgpr_read_b32 v21, a29
  v_accvgpr_read_b32 v22, a30
  v_accvgpr_read_b32 v23, a31
  v_mul_f32 v20, v20, v19
  v_mul_f32 v21, v21, v19
  v_mul_f32 v22, v22, v19
  v_mul_f32 v23, v23, v19
  v_accvgpr_write_b32 a28, v20
  v_accvgpr_write_b32 a29, v21
  v_accvgpr_write_b32 a30, v22
  v_accvgpr_write_b32 a31, v23
  v_accvgpr_read_b32 v20, a32
  v_accvgpr_read_b32 v21, a33
  v_accvgpr_read_b32 v22, a34
  v_accvgpr_read_b32 v23, a35
  v_mul_f32 v20, v20, v18
  v_mul_f32 v21, v21, v18
  v_mul_f32 v22, v22, v18
  v_mul_f32 v23, v23, v18
  v_accvgpr_write_b32 a32, v20
  v_accvgpr_write_b32 a33, v21
  v_accvgpr_write_b32 a34, v22
  v_accvgpr_write_b32 a35, v23
  v_accvgpr_read_b32 v20, a36
  v_accvgpr_read_b32 v21, a37
  v_accvgpr_read_b32 v22, a38
  v_accvgpr_read_b32 v23, a39
  v_mul_f32 v20, v20, v19
  v_mul_f32 v21, v21, v19
  v_mul_f32 v22, v22, v19
  v_mul_f32 v23, v23, v19
  v_accvgpr_write_b32 a36, v20
  v_accvgpr_write_b32 a37, v21
  v_accvgpr_write_b32 a38, v22
  v_accvgpr_write_b32 a39, v23
  v_accvgpr_read_b32 v20, a40
  v_accvgpr_read_b32 v21, a41
  v_accvgpr_read_b32 v22, a42
  v_accvgpr_read_b32 v23, a43
  v_mul_f32 v20, v20, v18
  v_mul_f32 v21, v21, v18
  v_mul_f32 v22, v22, v18
  v_mul_f32 v23, v23, v18
  v_accvgpr_write_b32 a40, v20
  v_accvgpr_write_b32 a41, v21
  v_accvgpr_write_b32 a42, v22
  v_accvgpr_write_b32 a43, v23
  v_accvgpr_read_b32 v20, a44
  v_accvgpr_read_b32 v21, a45
  v_accvgpr_read_b32 v22, a46
  v_accvgpr_read_b32 v23, a47
  v_mul_f32 v20, v20, v19
  v_mul_f32 v21, v21, v19
  v_mul_f32 v22, v22, v19
  v_mul_f32 v23, v23, v19
  v_accvgpr_write_b32 a44, v20
  v_accvgpr_write_b32 a45, v21
  v_accvgpr_write_b32 a46, v22
  v_accvgpr_write_b32 a47, v23
  v_accvgpr_read_b32 v20, a48
  v_accvgpr_read_b32 v21, a49
  v_accvgpr_read_b32 v22, a50
  v_accvgpr_read_b32 v23, a51
  v_mul_f32 v20, v20, v18
  v_mul_f32 v21, v21, v18
  v_mul_f32 v22, v22, v18
  v_mul_f32 v23, v23, v18
  v_accvgpr_write_b32 a48, v20
  v_accvgpr_write_b32 a49, v21
  v_accvgpr_write_b32 a50, v22
  v_accvgpr_write_b32 a51, v23
  v_accvgpr_read_b32 v20, a52
  v_accvgpr_read_b32 v21, a53
  v_accvgpr_read_b32 v22, a54
  v_accvgpr_read_b32 v23, a55
  v_mul_f32 v20, v20, v19
  v_mul_f32 v21, v21, v19
  v_mul_f32 v22, v22, v19
  v_mul_f32 v23, v23, v19
  v_accvgpr_write_b32 a52, v20
  v_accvgpr_write_b32 a53, v21
  v_accvgpr_write_b32 a54, v22
  v_accvgpr_write_b32 a55, v23
  v_accvgpr_read_b32 v20, a56
  v_accvgpr_read_b32 v21, a57
  v_accvgpr_read_b32 v22, a58
  v_accvgpr_read_b32 v23, a59
  v_mul_f32 v20, v20, v18
  v_mul_f32 v21, v21, v18
  v_mul_f32 v22, v22, v18
  v_mul_f32 v23, v23, v18
  v_accvgpr_write_b32 a56, v20
  v_accvgpr_write_b32 a57, v21
  v_accvgpr_write_b32 a58, v22
  v_accvgpr_write_b32 a59, v23
  v_accvgpr_read_b32 v20, a60
  v_accvgpr_read_b32 v21, a61
  v_accvgpr_read_b32 v22, a62
  v_accvgpr_read_b32 v23, a63
  v_mul_f32 v20, v20, v19
  v_mul_f32 v21, v21, v19
  v_mul_f32 v22, v22, v19
  v_mul_f32 v23, v23, v19
  v_accvgpr_write_b32 a60, v20
  v_accvgpr_write_b32 a61, v21
  v_accvgpr_write_b32 a62, v22
  v_accvgpr_write_b32 a63, v23
  s_setpc_b64 s[78:79]
fa_rare10:
  s_nop 7
  v_max3_f32 v16, v128, v129, v130
  v_max3_f32 v16, v16, v131, v132
  v_max3_f32 v16, v16, v133, v134
  v_max3_f32 v16, v16, v135, 0
  v_mov_b32 v18, v16
  s_nop 1
  v_permlane16_swap_b32 v16, v18
  v_max_f32 v16, v16, v18
  v_mov_b32 v18, v16
  s_nop 1
  v_permlane32_swap_b32 v16, v18
  v_max_f32 v16, v16, v18
  v_sub_f32 v128, v128, v16
  v_sub_f32 v144, v144, v16
  v_sub_f32 v129, v129, v16
  v_sub_f32 v145, v145, v16
  v_sub_f32 v130, v130, v16
  v_sub_f32 v146, v146, v16
  v_sub_f32 v131, v131, v16
  v_sub_f32 v147, v147, v16
  v_sub_f32 v132, v132, v16
  v_sub_f32 v148, v148, v16
  v_sub_f32 v133, v133, v16
  v_sub_f32 v149, v149, v16
  v_sub_f32 v134, v134, v16
  v_sub_f32 v150, v150, v16
  v_sub_f32 v135, v135, v16
  v_sub_f32 v151, v151, v16
  v_max3_f32 v17, v136, v137, v138
  v_max3_f32 v17, v17, v139, v140
  v_max3_f32 v17, v17, v141, v142
  v_max3_f32 v17, v17, v143, 0
  v_mov_b32 v18, v17
  s_nop 1
  v_permlane16_swap_b32 v17, v18
  v_max_f32 v17, v17, v18
  v_mov_b32 v18, v17
  s_nop 1
  v_permlane32_swap_b32 v17, v18
  v_max_f32 v17, v17, v18
  v_sub_f32 v136, v136, v17
  v_sub_f32 v152, v152, v17
  v_sub_f32 v137, v137, v17
  v_sub_f32 v153, v153, v17
  v_sub_f32 v138, v138, v17
  v_sub_f32 v154, v154, v17
  v_sub_f32 v139, v139, v17
  v_sub_f32 v155, v155, v17
  v_sub_f32 v140, v140, v17
  v_sub_f32 v156, v156, v17
  v_sub_f32 v141, v141, v17
  v_sub_f32 v157, v157, v17
  v_sub_f32 v142, v142, v17
  v_sub_f32 v158, v158, v17
  v_sub_f32 v143, v143, v17
  v_sub_f32 v159, v159, v17
  s_call_b64 s[78:79], fa_resc1
  v_exp_f32 v216, v128
  v_exp_f32 v217, v129
  v_exp_f32 v218, v130
  v_add_f32 v226, v216, v217
  v_cvt_pk_bf16_f32 v176, v216, v217
  v_exp_f32 v219, v131
  v_add_f32 v226, v226, v218
  v_exp_f32 v220, v132
  v_add_f32 v226, v226, v219
  v_cvt_pk_bf16_f32 v177, v218, v219
  v_exp_f32 v221, v133
  v_add_f32 v226, v226, v220
  v_exp_f32 v222, v134
  v_add_f32 v226, v226, v221
  v_cvt_pk_bf16_f32 v178, v220, v221
  v_exp_f32 v223, v135
  v_add_f32 v226, v226, v222
  v_exp_f32 v216, v136
  v_add_f32 v226, v226, v223
  v_cvt_pk_bf16_f32 v179, v222, v223
  v_exp_f32 v217, v137
  v_exp_f32 v218, v138
  v_add_f32 v227, v216, v217
  v_cvt_pk_bf16_f32 v180, v216, v217
  v_exp_f32 v219, v139
  v_add_f32 v227, v227, v218
  v_exp_f32 v220, v140
  v_add_f32 v227, v227, v219
  v_cvt_pk_bf16_f32 v181, v218, v219
  v_exp_f32 v221, v141
  v_add_f32 v227, v227, v220
  v_exp_f32 v222, v142
  v_add_f32 v227, v227, v221
  v_cvt_pk_bf16_f32 v182, v220, v221
  v_exp_f32 v223, v143
  v_add_f32 v227, v227, v222
  s_nop 0
  v_add_f32 v227, v227, v223
  v_cvt_pk_bf16_f32 v183, v222, v223
  v_exp_f32 v216, v144
  s_nop 1
  s_setpc_b64 s[76:77]
fa_rare11:
  s_nop 7
  v_max3_f32 v16, v144, v145, v146
  v_max3_f32 v16, v16, v147, v148
  v_max3_f32 v16, v16, v149, v150
  v_max3_f32 v16, v16, v151, 0
  v_mov_b32 v18, v16
  s_nop 1
  v_permlane16_swap_b32 v16, v18
  v_max_f32 v16, v16, v18
  v_mov_b32 v18, v16
  s_nop 1
  v_permlane32_swap_b32 v16, v18
  v_max_f32 v16, v16, v18
  v_sub_f32 v144, v144, v16
  v_sub_f32 v128, v128, v16
  v_sub_f32 v145, v145, v16
  v_sub_f32 v129, v129, v16
  v_sub_f32 v146, v146, v16
  v_sub_f32 v130, v130, v16
  v_sub_f32 v147, v147, v16
  v_sub_f32 v131, v131, v16
  v_sub_f32 v148, v148, v16
  v_sub_f32 v132, v132, v16
  v_sub_f32 v149, v149, v16
  v_sub_f32 v133, v133, v16
  v_sub_f32 v150, v150, v16
  v_sub_f32 v134, v134, v16
  v_sub_f32 v151, v151, v16
  v_sub_f32 v135, v135, v16
  v_max3_f32 v17, v152, v153, v154
  v_max3_f32 v17, v17, v155, v156
  v_max3_f32 v17, v17, v157, v158
  v_max3_f32 v17, v17, v159, 0
  v_mov_b32 v18, v17
  s_nop 1
  v_permlane16_swap_b32 v17, v18
  v_max_f32 v17, v17, v18
  v_mov_b32 v18, v17
  s_nop 1
  v_permlane32_swap_b32 v17, v18
  v_max_f32 v17, v17, v18
  v_sub_f32 v152, v152, v17
  v_sub_f32 v136, v136, v17
  v_sub_f32 v153, v153, v17
  v_sub_f32 v137, v137, v17
  v_sub_f32 v154, v154, v17
  v_sub_f32 v138, v138, v17
  v_sub_f32 v155, v155, v17
  v_sub_f32 v139, v139, v17
  v_sub_f32 v156, v156, v17
  v_sub_f32 v140, v140, v17
  v_sub_f32 v157, v157, v17
  v_sub_f32 v141, v141, v17
  v_sub_f32 v158, v158, v17
  v_sub_f32 v142, v142, v17
  v_sub_f32 v159, v159, v17
  v_sub_f32 v143, v143, v17
  s_call_b64 s[78:79], fa_resc1
  v_exp_f32 v216, v144
  v_exp_f32 v217, v145
  v_exp_f32 v218, v146
  v_add_f32 v226, v216, v217
  v_cvt_pk_bf16_f32 v184, v216, v217
  v_exp_f32 v219, v147
  v_add_f32 v226, v226, v218
  v_exp_f32 v220, v148
  v_add_f32 v226, v226, v219
  v_cvt_pk_bf16_f32 v185, v218, v219
  v_exp_f32 v221, v149
  v_add_f32 v226, v226, v220
  v_exp_f32 v222, v150
  v_add_f32 v226, v226, v221
  v_cvt_pk_bf16_f32 v186, v220, v221
  v_exp_f32 v223, v151
  v_add_f32 v226, v226, v222
  v_exp_f32 v216, v152
  v_add_f32 v226, v226, v223
  v_cvt_pk_bf16_f32 v187, v222, v223
  v_exp_f32 v217, v153
  v_exp_f32 v218, v154
  v_add_f32 v227, v216, v217
  v_cvt_pk_bf16_f32 v188, v216, v217
  v_exp_f32 v219, v155
  v_add_f32 v227, v227, v218
  v_exp_f32 v220, v156
  v_add_f32 v227, v227, v219
  v_cvt_pk_bf16_f32 v189, v218, v219
  v_exp_f32 v221, v157
  v_add_f32 v227, v227, v220
  v_exp_f32 v222, v158
  v_add_f32 v227, v227, v221
  v_cvt_pk_bf16_f32 v190, v220, v221
  v_exp_f32 v223, v159
  v_add_f32 v227, v227, v222
  s_nop 0
  v_add_f32 v227, v227, v223
  v_cvt_pk_bf16_f32 v191, v222, v223
  v_exp_f32 v216, v128
  s_nop 1
  s_setpc_b64 s[76:77]
fa_resc1:
  v_sub_f32 v200, v200, v16
  v_sub_f32 v201, v201, v16
  v_sub_f32 v202, v202, v16
  v_sub_f32 v203, v203, v16
  v_exp_f32 v18, -v16
  v_sub_f32 v204, v204, v17
  v_sub_f32 v205, v205, v17
  v_sub_f32 v206, v206, v17
  v_sub_f32 v207, v207, v17
  v_exp_f32 v19, -v17
  s_nop 0
  v_mul_f32 v230, v230, v18
  v_mul_f32 v231, v231, v19
  v_accvgpr_read_b32 v20, a64
  v_accvgpr_read_b32 v21, a65
  v_accvgpr_read_b32 v22, a66
  v_accvgpr_read_b32 v23, a67
  v_mul_f32 v20, v20, v18
  v_mul_f32 v21, v21, v18
  v_mul_f32 v22, v22, v18
  v_mul_f32 v23, v23, v18
  v_accvgpr_write_b32 a64, v20
  v_accvgpr_write_b32 a65, v21
  v_accvgpr_write_b32 a66, v22
  v_accvgpr_write_b32 a67, v23
  v_accvgpr_read_b32 v20, a68
  v_accvgpr_read_b32 v21, a69
  v_accvgpr_read_b32 v22, a70
  v_accvgpr_read_b32 v23, a71
  v_mul_f32 v20, v20, v19
  v_mul_f32 v21, v21, v19
  v_mul_f32 v22, v22, v19
  v_mul_f32 v23, v23, v19
  v_accvgpr_write_b32 a68, v20
  v_accvgpr_write_b32 a69, v21
  v_accvgpr_write_b32 a70, v22
  v_accvgpr_write_b32 a71, v23
  v_accvgpr_read_b32 v20, a72
  v_accvgpr_read_b32 v21, a73
  v_accvgpr_read_b32 v22, a74
  v_accvgpr_read_b32 v23, a75
  v_mul_f32 v20, v20, v18
  v_mul_f32 v21, v21, v18
  v_mul_f32 v22, v22, v18
  v_mul_f32 v23, v23, v18
  v_accvgpr_write_b32 a72, v20
  v_accvgpr_write_b32 a73, v21
  v_accvgpr_write_b32 a74, v22
  v_accvgpr_write_b32 a75, v23
  v_accvgpr_read_b32 v20, a76
  v_accvgpr_read_b32 v21, a77
  v_accvgpr_read_b32 v22, a78
  v_accvgpr_read_b32 v23, a79
  v_mul_f32 v20, v20, v19
  v_mul_f32 v21, v21, v19
  v_mul_f32 v22, v22, v19
  v_mul_f32 v23, v23, v19
  v_accvgpr_write_b32 a76, v20
  v_accvgpr_write_b32 a77, v21
  v_accvgpr_write_b32 a78, v22
  v_accvgpr_write_b32 a79, v23
  v_accvgpr_read_b32 v20, a80
  v_accvgpr_read_b32 v21, a81
  v_accvgpr_read_b32 v22, a82
  v_accvgpr_read_b32 v23, a83
  v_mul_f32 v20, v20, v18
  v_mul_f32 v21, v21, v18
  v_mul_f32 v22, v22, v18
  v_mul_f32 v23, v23, v18
  v_accvgpr_write_b32 a80, v20
  v_accvgpr_write_b32 a81, v21
  v_accvgpr_write_b32 a82, v22
  v_accvgpr_write_b32 a83, v23
  v_accvgpr_read_b32 v20, a84
  v_accvgpr_read_b32 v21, a85
  v_accvgpr_read_b32 v22, a86
  v_accvgpr_read_b32 v23, a87
  v_mul_f32 v20, v20, v19
  v_mul_f32 v21, v21, v19
  v_mul_f32 v22, v22, v19
  v_mul_f32 v23, v23, v19
  v_accvgpr_write_b32 a84, v20
  v_accvgpr_write_b32 a85, v21
  v_accvgpr_write_b32 a86, v22
  v_accvgpr_write_b32 a87, v23
  v_accvgpr_read_b32 v20, a88
  v_accvgpr_read_b32 v21, a89
  v_accvgpr_read_b32 v22, a90
  v_accvgpr_read_b32 v23, a91
  v_mul_f32 v20, v20, v18
  v_mul_f32 v21, v21, v18
  v_mul_f32 v22, v22, v18
  v_mul_f32 v23, v23, v18
  v_accvgpr_write_b32 a88, v20
  v_accvgpr_write_b32 a89, v21
  v_accvgpr_write_b32 a90, v22
  v_accvgpr_write_b32 a91, v23
  v_accvgpr_read_b32 v20, a92
  v_accvgpr_read_b32 v21, a93
  v_accvgpr_read_b32 v22, a94
  v_accvgpr_read_b32 v23, a95
  v_mul_f32 v20, v20, v19
  v_mul_f32 v21, v21, v19
  v_mul_f32 v22, v22, v19
  v_mul_f32 v23, v23, v19
  v_accvgpr_write_b32 a92, v20
  v_accvgpr_write_b32 a93, v21
  v_accvgpr_write_b32 a94, v22
  v_accvgpr_write_b32 a95, v23
  v_accvgpr_read_b32 v20, a96
  v_accvgpr_read_b32 v21, a97
  v_accvgpr_read_b32 v22, a98
  v_accvgpr_read_b32 v23, a99
  v_mul_f32 v20, v20, v18
  v_mul_f32 v21, v21, v18
  v_mul_f32 v22, v22, v18
  v_mul_f32 v23, v23, v18
  v_accvgpr_write_b32 a96, v20
  v_accvgpr_write_b32 a97, v21
  v_accvgpr_write_b32 a98, v22
  v_accvgpr_write_b32 a99, v23
  v_accvgpr_read_b32 v20, a100
  v_accvgpr_read_b32 v21, a101
  v_accvgpr_read_b32 v22, a102
  v_accvgpr_read_b32 v23, a103
  v_mul_f32 v20, v20, v19
  v_mul_f32 v21, v21, v19
  v_mul_f32 v22, v22, v19
  v_mul_f32 v23, v23, v19
  v_accvgpr_write_b32 a100, v20
  v_accvgpr_write_b32 a101, v21
  v_accvgpr_write_b32 a102, v22
  v_accvgpr_write_b32 a103, v23
  v_accvgpr_read_b32 v20, a104
  v_accvgpr_read_b32 v21, a105
  v_accvgpr_read_b32 v22, a106
  v_accvgpr_read_b32 v23, a107
  v_mul_f32 v20, v20, v18
  v_mul_f32 v21, v21, v18
  v_mul_f32 v22, v22, v18
  v_mul_f32 v23, v23, v18
  v_accvgpr_write_b32 a104, v20
  v_accvgpr_write_b32 a105, v21
  v_accvgpr_write_b32 a106, v22
  v_accvgpr_write_b32 a107, v23
  v_accvgpr_read_b32 v20, a108
  v_accvgpr_read_b32 v21, a109
  v_accvgpr_read_b32 v22, a110
  v_accvgpr_read_b32 v23, a111
  v_mul_f32 v20, v20, v19
  v_mul_f32 v21, v21, v19
  v_mul_f32 v22, v22, v19
  v_mul_f32 v23, v23, v19
  v_accvgpr_write_b32 a108, v20
  v_accvgpr_write_b32 a109, v21
  v_accvgpr_write_b32 a110, v22
  v_accvgpr_write_b32 a111, v23
  v_accvgpr_read_b32 v20, a112
  v_accvgpr_read_b32 v21, a113
  v_accvgpr_read_b32 v22, a114
  v_accvgpr_read_b32 v23, a115
  v_mul_f32 v20, v20, v18
  v_mul_f32 v21, v21, v18
  v_mul_f32 v22, v22, v18
  v_mul_f32 v23, v23, v18
  v_accvgpr_write_b32 a112, v20
  v_accvgpr_write_b32 a113, v21
  v_accvgpr_write_b32 a114, v22
  v_accvgpr_write_b32 a115, v23
  v_accvgpr_read_b32 v20, a116
  v_accvgpr_read_b32 v21, a117
  v_accvgpr_read_b32 v22, a118
  v_accvgpr_read_b32 v23, a119
  v_mul_f32 v20, v20, v19
  v_mul_f32 v21, v21, v19
  v_mul_f32 v22, v22, v19
  v_mul_f32 v23, v23, v19
  v_accvgpr_write_b32 a116, v20
  v_accvgpr_write_b32 a117, v21
  v_accvgpr_write_b32 a118, v22
  v_accvgpr_write_b32 a119, v23
  v_accvgpr_read_b32 v20, a120
  v_accvgpr_read_b32 v21, a121
  v_accvgpr_read_b32 v22, a122
  v_accvgpr_read_b32 v23, a123
  v_mul_f32 v20, v20, v18
  v_mul_f32 v21, v21, v18
  v_mul_f32 v22, v22, v18
  v_mul_f32 v23, v23, v18
  v_accvgpr_write_b32 a120, v20
  v_accvgpr_write_b32 a121, v21
  v_accvgpr_write_b32 a122, v22
  v_accvgpr_write_b32 a123, v23
  v_accvgpr_read_b32 v20, a124
  v_accvgpr_read_b32 v21, a125
  v_accvgpr_read_b32 v22, a126
  v_accvgpr_read_b32 v23, a127
  v_mul_f32 v20, v20, v19
  v_mul_f32 v21, v21, v19
  v_mul_f32 v22, v22, v19
  v_mul_f32 v23, v23, v19
  v_accvgpr_write_b32 a124, v20
  v_accvgpr_write_b32 a125, v21
  v_accvgpr_write_b32 a126, v22
  v_accvgpr_write_b32 a127, v23
  s_setpc_b64 s[78:79]
.section .rodata,"a"
.p2align 6
.amdhsa_kernel fa_kernel
  .amdhsa_next_free_vgpr 512
  .amdhsa_next_free_sgpr 102
  .amdhsa_accum_offset 256
  .amdhsa_group_segment_fixed_size 0
  .amdhsa_kernarg_size 112
  .amdhsa_user_sgpr_count 2
  .amdhsa_user_sgpr_kernarg_segment_ptr 1
  .amdhsa_system_sgpr_workgroup_id_x 1
  .amdhsa_float_denorm_mode_32 3
.end_amdhsa_kernel
.text
```

```asm
; @launch kernel=fa_kernel grid=(256,1,1) block=(256,1,1) lds=163840
.amdgcn_target "amdgcn-amd-amdhsa--gfx950"
.text
.globl fa_kernel
.p2align 8
.type fa_kernel,@function
fa_kernel:
  s_cmp_ge_u32 s2, 256
  s_cbranch_scc1 fa_end
  s_getpc_b64 s[62:63]
  v_and_b32 v230, 127, v0
  v_lshlrev_b32 v230, 7, v230
  global_load_dword v231, v230, s[62:63]
  s_load_dwordx4 s[4:7], s[0:1], 0
  s_load_dwordx4 s[8:11], s[0:1], 24
  s_load_dwordx2 s[14:15], s[0:1], 56
  s_load_dwordx2 s[12:13], s[0:1], 40
  s_load_dwordx4 s[16:19], s[0:1], 96
  s_load_dwordx2 s[60:61], s[0:1], 16
  v_lshrrev_b32 v16, 6, v0
  v_and_b32 v1, 63, v0
  v_readfirstlane_b32 s20, v16
  s_and_b32 s21, s2, 7
  s_lshl_b32 s21, s21, 2
  s_lshr_b32 s23, s2, 3
  s_and_b32 s23, s23, 3
  s_add_u32 s21, s21, s23
  s_lshr_b32 s22, s2, 5
  v_and_b32 v208, 31, v1
  v_lshrrev_b32 v209, 5, v1
  s_lshl_b32 s31, s2, 2
  s_add_u32 s31, s31, s20
  s_lshl_b32 s31, s31, 1
  v_add_u32 v209, s31, v209
  v_lshlrev_b32 v212, 4, v208
  v_mul_u32_u24 v210, 1280, v209
  v_add_u32 v210, v210, v212
  v_cmp_gt_u32 s[64:65], 16, v208
  v_mov_b32 v19, 1073741824
  v_and_b32 v220, 7, v209
  v_cndmask_b32 v211, v19, v210, s[64:65]
  v_bfe_u32 v17, v1, 1, 3
  v_lshlrev_b32 v17, 13, v17
  v_and_b32 v18, 1, v1
  v_lshl_add_u32 v235, v18, 7, v17
  s_lshl_b32 s74, s22, 1
  s_and_b32 s31, s20, 1
  s_add_u32 s74, s74, s31
  s_lshl_b32 s74, s74, 16
  s_mov_b32 s73, 1048576
  v_and_b32 v16, 15, v1
  v_lshlrev_b32 v17, 10, v16
  v_and_b32 v18, 16, v1
  v_lshl_add_u32 v233, v18, 3, v17
  s_lshl_b32 s30, s23, 5
  s_add_u32 s30, s30, s20
  s_lshl_b32 s30, s30, 14
  s_lshl_b32 s29, s22, 16
  s_lshl_b32 s23, s21, 8
  s_cmp_ge_u32 s20, 2
  s_waitcnt lgkmcnt(0)
  s_mov_b32 s44, s4
  s_mov_b32 s45, s5
  s_mov_b32 s46, 2621440
  s_mov_b32 s47, 0x20000
  s_mov_b32 s68, s14
  s_mov_b32 s69, s15
  s_mov_b32 s70, 1280
  s_mov_b32 s71, 0x20000
  buffer_load_dwordx4 v[160:163], v210, s[44:47], 0 offen
  buffer_load_dwordx4 v[164:167], v210, s[44:47], 0 offen offset:512
  buffer_load_dwordx4 v[168:171], v211, s[44:47], 0 offen offset:1024
  buffer_load_dwordx4 v[172:175], v212, s[68:71], 0 offen offset:0
  buffer_load_dwordx4 v[176:179], v212, s[68:71], 0 offen offset:512
  buffer_load_dwordx4 v[180:183], v212, s[68:71], 0 offen offset:1024
  s_cselect_b32 s62, s10, s8
  s_cselect_b32 s63, s11, s9
  s_add_u32 s62, s62, s23
  s_addc_u32 s63, s63, 0
  s_mov_b32 s36, s62
  s_mov_b32 s37, s63
  s_mov_b32 s38, 0
  s_mov_b32 s39, 0x20000
  s_sub_u32 s38, 4194304, s23
  buffer_load_dword v231, v235, s[36:39], s74 offen
  s_add_u32 s6, s6, s29
  s_addc_u32 s7, s7, 0
  s_mov_b32 s32, s6
  s_mov_b32 s33, s7
  s_mov_b32 s34, 0
  s_mov_b32 s35, 0x20000
  s_sub_u32 s34, 2097152, s29
  buffer_load_dword v232, v233, s[32:35], s30 offen
  s_add_u32 s74, s74, s73
  buffer_load_dword v231, v235, s[36:39], s74 offen
  buffer_load_dword v232, v233, s[32:35], s30 offen offset:256
  s_getpc_b64 s[8:9]
fa_pc:
  s_lshr_b32 s31, s2, 3
  s_and_b32 s31, s31, 15
  s_lshl_b32 s31, s31, 2
  s_add_u32 s31, s31, s20
  s_lshl_b32 s31, s31, 11
  s_min_u32 s31, s31, fa_codeend-fa_pc-2048
  v_lshlrev_b32 v234, 7, v16
  v_add_u32 v230, s31, v234
  global_load_dword v231, v230, s[8:9]
  s_add_u32 s8, s8, fa_co1-fa_pc-4
  s_addc_u32 s9, s9, 0
  s_add_u32 s60, s60, s23
  s_addc_u32 s61, s61, 0
  s_sub_u32 s75, 5242880, s23
  s_mov_b32 s48, s62
  s_mov_b32 s49, s63
  s_mov_b32 s50, s38
  s_mov_b32 s51, 0x20000
  v_lshlrev_b32 v2, 4, v1
  v_lshrrev_b32 v19, 2, v1
  v_lshrrev_b32 v17, 5, v1
  v_mul_u32_u24 v17, 3, v17
  v_and_b32 v18, 3, v1
  v_xor_b32 v17, v17, v18
  v_lshlrev_b32 v17, 4, v17
  v_lshl_add_u32 v3, v19, 10, v17
  s_lshl_b32 s23, s20, 19
  v_add_u32 v3, s23, v3
  v_add_u32 v4, 15360, v3
  v_add_u32 v5, 30720, v3
  v_add_u32 v6, 46080, v3
  v_and_b32 v19, 3, v19
  v_lshrrev_b32 v17, 4, v1
  v_lshlrev_b32 v17, 6, v17
  v_lshl_add_u32 v19, v19, 13, v17
  s_and_b32 s23, s20, 1
  s_lshl_b32 s23, s23, 17
  v_add_u32 v19, s23, v19
  v_lshl_add_u32 v8, v18, 4, v19
  v_xor_b32 v18, 2, v18
  v_lshl_add_u32 v10, v18, 4, v19
  v_add_u32 v9, 31744, v8
  v_add_u32 v11, 95232, v10
  v_add_u32 v10, 63488, v10
  s_lshl_b32 s24, s20, 12
  s_mov_b32 s26, 0
  s_mov_b32 s27, 0
  s_mov_b32 s25, 262144
  s_mov_b32 s79, 64
  s_mov_b32 s40, s18
  s_mov_b32 s41, s19
  s_mov_b32 s42, 67108864
  s_mov_b32 s43, 0x20000
  s_mov_b32 s52, s12
  s_mov_b32 s53, s13
  s_mov_b32 s54, 5242880
  s_mov_b32 s55, 0x20000
  s_mov_b32 s56, s16
  s_mov_b32 s57, s17
  s_mov_b32 s58, 256
  s_mov_b32 s59, 0x20000
  s_and_b32 s29, s2, 7
  s_lshl_b32 s29, s29, 2
  s_add_u32 s29, s29, s20
  s_lshl_b32 s29, s29, 11
  s_and_b32 s23, s21, 3
  s_lshl_b32 s23, s23, 19
  s_add_u32 s29, s29, s23
  s_lshl_b32 s23, s20, 5
  s_add_u32 s23, s23, s21
  s_lshl_b32 s23, s23, 2
  s_add_u32 s23, s23, 2641920
  s_lshl_b32 s31, s22, 9
  s_add_u32 s80, s23, s31
  s_sub_u32 s31, 7680, s31
  s_add_u32 s3, s23, s31
  s_lshl_b32 s23, s21, 7
  s_lshl_b32 s31, s22, 2
  s_add_u32 s23, s23, s31
  s_add_u32 s82, s23, 2637824
  s_sub_u32 s62, s2, 170
  s_lshl_b32 s31, s20, 6
  s_add_u32 s62, s62, s31
  s_lshl_b32 s62, s62, 2
  s_add_u32 s62, s62, 2650112
  s_sub_u32 s23, s2, 170
  s_cmp_lt_u32 s23, 54
  s_cselect_b32 s62, s62, 1073741824
  s_cmp_eq_u32 s20, 0
  s_cselect_b32 s31, s82, 1073741824
  s_cselect_b32 s77, s2, 1073741824
  s_cmp_eq_u32 s2, 255
  s_cselect_b32 s23, 2629632, 1073741824
  v_lshl_add_u32 v225, v16, 2, s23
  v_mov_b32 v229, 0
  v_writelane_b32 v225, s80, 0
  v_writelane_b32 v225, s3, 1
  v_writelane_b32 v225, s31, 2
  s_add_u32 s31, s31, 32
  v_writelane_b32 v225, s31, 5
  s_and_b32 s23, s2, 1
  s_lshl_b32 s23, s23, 2
  s_add_u32 s23, s23, s20
  s_lshl_b32 s23, s23, 7
  s_lshr_b32 s31, s2, 1
  s_add_u32 s23, s23, s31
  s_lshl_b32 s23, s23, 2
  s_add_u32 s23, s23, 2654208
  v_writelane_b32 v225, s23, 3
  v_writelane_b32 v225, s62, 4
  s_and_b32 s23, s21, 3
  s_lshr_b32 s31, s23, 1
  s_lshl_b32 s31, 4, s31
  s_bitcmp1_b32 s23, 0
  s_cselect_b32 s76, s31, 0
  s_cselect_b32 s72, 0, s31
  s_or_b32 s76, s76, 0x20
  s_or_b32 s72, s72, 0x25
  v_mov_b32 v20, 0
  v_mov_b32 v21, 0
  v_mov_b32 v22, 0
  v_mov_b32 v23, 0
  v_lshrrev_b32 v17, 4, v1
  v_lshrrev_b32 v18, 3, v16
  v_mul_u32_u24 v18, 3, v18
  v_xor_b32 v18, v18, v17
  v_lshlrev_b32 v18, 4, v18
  v_lshl_add_u32 v14, v16, 6, v18
  s_and_b32 s23, s20, 1
  s_lshl_b32 s23, s23, 11
  v_add_u32 v14, s23, v14
  v_mfma_f32_32x32x16_bf16 a[0:15], v[20:23], v[20:23], 0
  v_lshrrev_b32 v18, 2, v16
  v_lshlrev_b32 v18, 6, v18
  v_lshl_add_u32 v18, v17, 11, v18
  v_and_b32 v19, 1, v1
  v_mfma_f32_32x32x16_bf16 a[16:31], v[20:23], v[20:23], 0
  v_lshl_add_u32 v18, v19, 3, v18
  v_bfe_u32 v19, v1, 1, 1
  v_and_b32 v17, 1, v17
  v_lshl_or_b32 v19, v17, 1, v19
  v_mfma_f32_32x32x16_bf16 a[32:47], v[20:23], v[20:23], 0
  s_lshr_b32 s23, s20, 1
  s_lshl_b32 s23, s23, 13
  s_add_u32 s23, s23, 16384
  v_add_u32 v18, s23, v18
  v_mfma_f32_32x32x16_bf16 a[48:63], v[20:23], v[20:23], 0
  v_lshl_add_u32 v12, v19, 4, v18
  v_xor_b32 v13, 32, v12
  v_mov_b32 v19, 1073741824
  v_lshlrev_b32 v220, 4, v220
  v_mfma_f32_32x32x16_bf16 a[64:79], v[20:23], v[20:23], 0
  v_lshl_add_u32 v220, v208, 7, v220
  v_add_u32 v220, 131072, v220
  v_lshlrev_b32 v222, 2, v209
  v_cmp_eq_u32 vcc, 0, v208
  v_mfma_f32_32x32x16_bf16 a[80:95], v[20:23], v[20:23], 0
  v_add_u32 v222, 2621440, v222
  v_lshlrev_b32 v221, 4, v0
  v_cndmask_b32 v222, v19, v222, vcc
  v_add_u32 v221, 131072, v221
  v_mfma_f32_32x32x16_bf16 a[96:111], v[20:23], v[20:23], 0
  v_sub_u32 v209, 0xffff, v209
  v_lshrrev_b32 v223, 3, v0
  v_and_b32 v18, 7, v0
  v_lshlrev_b32 v18, 4, v18
  v_mfma_f32_32x32x16_bf16 a[112:127], v[20:23], v[20:23], 0
  v_cmp_gt_u32 vcc, 128, v0
  v_lshl_add_u32 v223, v223, 8, v18
  s_lshr_b32 s66, s2, 1
  s_mul_i32 s66, s66, 20480
  v_mfma_f32_32x32x16_bf16 a[128:143], v[20:23], v[20:23], 0
  s_and_b32 s31, s2, 1
  s_lshl_b32 s31, s31, 7
  s_add_u32 s66, s66, s31
  v_cndmask_b32 v224, v19, v223, vcc
  v_mfma_f32_32x32x16_bf16 a[144:159], v[20:23], v[20:23], 0
  s_add_u32 s67, s66, 8192
  s_add_u32 s78, s66, 16384
  s_mov_b32 s28, 0
  v_mfma_f32_32x32x16_bf16 a[160:175], v[20:23], v[20:23], 0
  v_mfma_f32_32x32x16_bf16 a[176:191], v[20:23], v[20:23], 0
  v_mfma_f32_32x32x16_bf16 a[192:207], v[20:23], v[20:23], 0
  v_mfma_f32_32x32x16_bf16 a[208:223], v[20:23], v[20:23], 0
  v_mfma_f32_32x32x16_bf16 a[224:239], v[20:23], v[20:23], 0
  v_mfma_f32_32x32x16_bf16 a[240:255], v[20:23], v[20:23], 0
  s_waitcnt vmcnt(5)
  v_lshlrev_b32 v184, 16, v160
  v_and_b32 v185, 0xffff0000, v160
  v_lshlrev_b32 v186, 16, v161
  v_and_b32 v187, 0xffff0000, v161
  v_lshlrev_b32 v188, 16, v162
  v_and_b32 v189, 0xffff0000, v162
  v_lshlrev_b32 v190, 16, v163
  v_and_b32 v191, 0xffff0000, v163
  v_lshlrev_b32 v192, 16, v164
  v_and_b32 v193, 0xffff0000, v164
  v_lshlrev_b32 v194, 16, v165
  v_and_b32 v195, 0xffff0000, v165
  v_lshlrev_b32 v196, 16, v166
  v_and_b32 v197, 0xffff0000, v166
  v_lshlrev_b32 v198, 16, v167
  v_and_b32 v199, 0xffff0000, v167
  v_lshlrev_b32 v200, 16, v168
  v_and_b32 v201, 0xffff0000, v168
  v_lshlrev_b32 v202, 16, v169
  v_and_b32 v203, 0xffff0000, v169
  v_lshlrev_b32 v204, 16, v170
  v_and_b32 v205, 0xffff0000, v170
  v_lshlrev_b32 v206, 16, v171
  v_and_b32 v207, 0xffff0000, v171
  v_pk_add_f32 v[16:17], v[184:185], v[186:187]
  v_pk_add_f32 v[18:19], v[188:189], v[190:191]
  v_pk_add_f32 v[16:17], v[16:17], v[192:193]
  v_pk_add_f32 v[18:19], v[18:19], v[194:195]
  v_pk_add_f32 v[16:17], v[16:17], v[196:197]
  v_pk_add_f32 v[18:19], v[18:19], v[198:199]
  v_pk_add_f32 v[16:17], v[16:17], v[200:201]
  v_pk_add_f32 v[18:19], v[18:19], v[202:203]
  v_pk_add_f32 v[16:17], v[16:17], v[204:205]
  v_pk_add_f32 v[18:19], v[18:19], v[206:207]
  v_pk_add_f32 v[16:17], v[16:17], v[18:19]
  v_add_f32 v213, v16, v17
  s_nop 1
  v_add_f32_dpp v213, v213, v213 quad_perm:[1,0,3,2] row_mask:0xf bank_mask:0xf
  s_nop 1
  v_add_f32_dpp v213, v213, v213 quad_perm:[2,3,0,1] row_mask:0xf bank_mask:0xf
  s_nop 1
  v_add_f32_dpp v213, v213, v213 row_half_mirror row_mask:0xf bank_mask:0xf
  s_nop 1
  v_add_f32_dpp v213, v213, v213 row_mirror row_mask:0xf bank_mask:0xf
  v_mov_b32 v214, v213
  s_nop 1
  v_permlane16_swap_b32 v213, v214
  v_add_f32 v213, v213, v214
  v_mul_f32 v216, 0xbacccccd, v213
  v_mul_f32 v217, 0xbacccccd, v213
  v_pk_add_f32 v[20:21], v[184:185], v[216:217]
  v_pk_mul_f32 v[16:17], v[20:21], v[20:21]
  v_pk_add_f32 v[22:23], v[186:187], v[216:217]
  v_pk_fma_f32 v[16:17], v[22:23], v[22:23], v[16:17]
  v_pk_add_f32 v[24:25], v[188:189], v[216:217]
  v_pk_fma_f32 v[16:17], v[24:25], v[24:25], v[16:17]
  v_pk_add_f32 v[26:27], v[190:191], v[216:217]
  v_pk_fma_f32 v[16:17], v[26:27], v[26:27], v[16:17]
  v_pk_add_f32 v[20:21], v[192:193], v[216:217]
  v_pk_fma_f32 v[16:17], v[20:21], v[20:21], v[16:17]
  v_pk_add_f32 v[22:23], v[194:195], v[216:217]
  v_pk_fma_f32 v[16:17], v[22:23], v[22:23], v[16:17]
  v_pk_add_f32 v[24:25], v[196:197], v[216:217]
  v_pk_fma_f32 v[16:17], v[24:25], v[24:25], v[16:17]
  v_pk_add_f32 v[26:27], v[198:199], v[216:217]
  v_pk_fma_f32 v[16:17], v[26:27], v[26:27], v[16:17]
  v_pk_add_f32 v[20:21], v[200:201], v[216:217]
  v_pk_mul_f32 v[18:19], v[20:21], v[20:21]
  v_pk_add_f32 v[22:23], v[202:203], v[216:217]
  v_pk_fma_f32 v[18:19], v[22:23], v[22:23], v[18:19]
  v_pk_add_f32 v[24:25], v[204:205], v[216:217]
  v_pk_fma_f32 v[18:19], v[24:25], v[24:25], v[18:19]
  v_pk_add_f32 v[26:27], v[206:207], v[216:217]
  v_pk_fma_f32 v[18:19], v[26:27], v[26:27], v[18:19]
  v_add_f32 v18, v18, v19
  v_add_f32 v213, v16, v17
  v_cndmask_b32 v18, 0, v18, s[64:65]
  v_add_f32 v213, v213, v18
  s_nop 1
  v_add_f32_dpp v213, v213, v213 quad_perm:[1,0,3,2] row_mask:0xf bank_mask:0xf
  s_nop 1
  v_add_f32_dpp v213, v213, v213 quad_perm:[2,3,0,1] row_mask:0xf bank_mask:0xf
  s_nop 1
  v_add_f32_dpp v213, v213, v213 row_half_mirror row_mask:0xf bank_mask:0xf
  s_nop 1
  v_add_f32_dpp v213, v213, v213 row_mirror row_mask:0xf bank_mask:0xf
  v_mov_b32 v214, v213
  s_nop 1
  v_permlane16_swap_b32 v213, v214
  v_add_f32 v213, v213, v214
  v_mul_f32 v213, 0x3acccccd, v213
  v_cvt_pk_bf16_f32 v213, v213, v213
  v_and_b32 v213, 0xffff0000, v213
  v_add_f32 v213, 0x3727c5ac, v213
  v_cvt_pk_bf16_f32 v213, v213, v213
  v_and_b32 v213, 0xffff0000, v213
  v_sqrt_f32 v213, v213
  v_cvt_pk_bf16_f32 v216, v216, v216
  v_and_b32 v216, 0xffff0000, v216
  v_cvt_pk_bf16_f32 v213, v213, v213
  v_and_b32 v213, 0xffff0000, v213
  v_rcp_f32 v28, v213
  v_mov_b32 v217, v216
  v_mov_b32 v29, v28
  v_pk_add_f32 v[184:185], v[184:185], v[216:217]
  v_lshlrev_b32 v16, 16, v172
  v_cvt_pk_bf16_f32 v185, v184, v185
  v_and_b32 v17, 0xffff0000, v172
  v_lshlrev_b32 v184, 16, v185
  v_and_b32 v185, 0xffff0000, v185
  v_pk_mul_f32 v[184:185], v[184:185], v[28:29]
  v_cvt_pk_bf16_f32 v160, v184, v185
  v_lshlrev_b32 v184, 16, v160
  v_and_b32 v185, 0xffff0000, v160
  v_pk_mul_f32 v[218:219], v[184:185], v[16:17]
  v_pk_add_f32 v[186:187], v[186:187], v[216:217]
  v_lshlrev_b32 v18, 16, v173
  v_cvt_pk_bf16_f32 v187, v186, v187
  v_and_b32 v19, 0xffff0000, v173
  v_lshlrev_b32 v186, 16, v187
  v_and_b32 v187, 0xffff0000, v187
  v_pk_mul_f32 v[186:187], v[186:187], v[28:29]
  v_cvt_pk_bf16_f32 v161, v186, v187
  v_lshlrev_b32 v186, 16, v161
  v_and_b32 v187, 0xffff0000, v161
  v_pk_fma_f32 v[218:219], v[186:187], v[18:19], v[218:219]
  v_pk_add_f32 v[188:189], v[188:189], v[216:217]
  v_lshlrev_b32 v16, 16, v174
  v_cvt_pk_bf16_f32 v189, v188, v189
  v_and_b32 v17, 0xffff0000, v174
  v_lshlrev_b32 v188, 16, v189
  v_and_b32 v189, 0xffff0000, v189
  v_pk_mul_f32 v[188:189], v[188:189], v[28:29]
  v_cvt_pk_bf16_f32 v162, v188, v189
  v_lshlrev_b32 v188, 16, v162
  v_and_b32 v189, 0xffff0000, v162
  v_pk_fma_f32 v[218:219], v[188:189], v[16:17], v[218:219]
  v_pk_add_f32 v[190:191], v[190:191], v[216:217]
  v_lshlrev_b32 v18, 16, v175
  v_cvt_pk_bf16_f32 v191, v190, v191
  v_and_b32 v19, 0xffff0000, v175
  v_lshlrev_b32 v190, 16, v191
  v_and_b32 v191, 0xffff0000, v191
  v_pk_mul_f32 v[190:191], v[190:191], v[28:29]
  v_cvt_pk_bf16_f32 v163, v190, v191
  v_lshlrev_b32 v190, 16, v163
  v_and_b32 v191, 0xffff0000, v163
  v_pk_fma_f32 v[218:219], v[190:191], v[18:19], v[218:219]
  ds_write_b128 v220, v[160:163] offset:0
  v_pk_add_f32 v[192:193], v[192:193], v[216:217]
  v_lshlrev_b32 v16, 16, v176
  v_cvt_pk_bf16_f32 v193, v192, v193
  v_and_b32 v17, 0xffff0000, v176
  v_lshlrev_b32 v192, 16, v193
  v_and_b32 v193, 0xffff0000, v193
  v_pk_mul_f32 v[192:193], v[192:193], v[28:29]
  v_cvt_pk_bf16_f32 v164, v192, v193
  v_lshlrev_b32 v192, 16, v164
  v_and_b32 v193, 0xffff0000, v164
  v_pk_fma_f32 v[218:219], v[192:193], v[16:17], v[218:219]
  v_pk_add_f32 v[194:195], v[194:195], v[216:217]
  v_lshlrev_b32 v18, 16, v177
  v_cvt_pk_bf16_f32 v195, v194, v195
  v_and_b32 v19, 0xffff0000, v177
  v_lshlrev_b32 v194, 16, v195
  v_and_b32 v195, 0xffff0000, v195
  v_pk_mul_f32 v[194:195], v[194:195], v[28:29]
  v_cvt_pk_bf16_f32 v165, v194, v195
  v_lshlrev_b32 v194, 16, v165
  v_and_b32 v195, 0xffff0000, v165
  v_pk_fma_f32 v[218:219], v[194:195], v[18:19], v[218:219]
  v_pk_add_f32 v[196:197], v[196:197], v[216:217]
  v_lshlrev_b32 v16, 16, v178
  v_cvt_pk_bf16_f32 v197, v196, v197
  v_and_b32 v17, 0xffff0000, v178
  v_lshlrev_b32 v196, 16, v197
  v_and_b32 v197, 0xffff0000, v197
  v_pk_mul_f32 v[196:197], v[196:197], v[28:29]
  v_cvt_pk_bf16_f32 v166, v196, v197
  v_lshlrev_b32 v196, 16, v166
  v_and_b32 v197, 0xffff0000, v166
  v_pk_fma_f32 v[218:219], v[196:197], v[16:17], v[218:219]
  v_pk_add_f32 v[198:199], v[198:199], v[216:217]
  v_lshlrev_b32 v18, 16, v179
  v_cvt_pk_bf16_f32 v199, v198, v199
  v_and_b32 v19, 0xffff0000, v179
  v_lshlrev_b32 v198, 16, v199
  v_and_b32 v199, 0xffff0000, v199
  v_pk_mul_f32 v[198:199], v[198:199], v[28:29]
  v_cvt_pk_bf16_f32 v167, v198, v199
  v_lshlrev_b32 v198, 16, v167
  v_and_b32 v199, 0xffff0000, v167
  v_pk_fma_f32 v[218:219], v[198:199], v[18:19], v[218:219]
  ds_write_b128 v220, v[164:167] offset:4096
  v_pk_add_f32 v[200:201], v[200:201], v[216:217]
  v_lshlrev_b32 v16, 16, v180
  v_cvt_pk_bf16_f32 v201, v200, v201
  v_and_b32 v17, 0xffff0000, v180
  v_lshlrev_b32 v200, 16, v201
  v_and_b32 v201, 0xffff0000, v201
  v_pk_mul_f32 v[200:201], v[200:201], v[28:29]
  v_cvt_pk_bf16_f32 v168, v200, v201
  v_lshlrev_b32 v200, 16, v168
  v_and_b32 v201, 0xffff0000, v168
  v_pk_fma_f32 v[218:219], v[200:201], v[16:17], v[218:219]
  v_pk_add_f32 v[202:203], v[202:203], v[216:217]
  v_lshlrev_b32 v18, 16, v181
  v_cvt_pk_bf16_f32 v203, v202, v203
  v_and_b32 v19, 0xffff0000, v181
  v_lshlrev_b32 v202, 16, v203
  v_and_b32 v203, 0xffff0000, v203
  v_pk_mul_f32 v[202:203], v[202:203], v[28:29]
  v_cvt_pk_bf16_f32 v169, v202, v203
  v_lshlrev_b32 v202, 16, v169
  v_and_b32 v203, 0xffff0000, v169
  v_pk_fma_f32 v[218:219], v[202:203], v[18:19], v[218:219]
  v_pk_add_f32 v[204:205], v[204:205], v[216:217]
  v_lshlrev_b32 v16, 16, v182
  v_cvt_pk_bf16_f32 v205, v204, v205
  v_and_b32 v17, 0xffff0000, v182
  v_lshlrev_b32 v204, 16, v205
  v_and_b32 v205, 0xffff0000, v205
  v_pk_mul_f32 v[204:205], v[204:205], v[28:29]
  v_cvt_pk_bf16_f32 v170, v204, v205
  v_lshlrev_b32 v204, 16, v170
  v_and_b32 v205, 0xffff0000, v170
  v_pk_fma_f32 v[218:219], v[204:205], v[16:17], v[218:219]
  v_pk_add_f32 v[206:207], v[206:207], v[216:217]
  v_lshlrev_b32 v18, 16, v183
  v_cvt_pk_bf16_f32 v207, v206, v207
  v_and_b32 v19, 0xffff0000, v183
  v_lshlrev_b32 v206, 16, v207
  v_and_b32 v207, 0xffff0000, v207
  v_pk_mul_f32 v[206:207], v[206:207], v[28:29]
  v_cvt_pk_bf16_f32 v171, v206, v207
  v_lshlrev_b32 v206, 16, v171
  v_and_b32 v207, 0xffff0000, v171
  v_pk_fma_f32 v[218:219], v[206:207], v[18:19], v[218:219]
  ds_write_b128 v220, v[168:171] offset:8192
  v_add_f32 v218, v218, v219
  s_nop 1
  v_add_f32_dpp v218, v218, v218 quad_perm:[1,0,3,2] row_mask:0xf bank_mask:0xf
  s_nop 1
  v_add_f32_dpp v218, v218, v218 quad_perm:[2,3,0,1] row_mask:0xf bank_mask:0xf
  s_nop 1
  v_add_f32_dpp v218, v218, v218 row_half_mirror row_mask:0xf bank_mask:0xf
  s_nop 1
  v_add_f32_dpp v218, v218, v218 row_mirror row_mask:0xf bank_mask:0xf
  v_mov_b32 v214, v218
  s_nop 1
  v_permlane16_swap_b32 v218, v214
  v_add_f32 v218, v218, v214
  v_cvt_pk_bf16_f32 v218, v218, v218
  v_and_b32 v218, 0xffff0000, v218
  v_ashrrev_i32 v214, 31, v218
  v_or_b32 v214, 0x80000000, v214
  v_xor_b32 v218, v218, v214
  v_and_b32 v218, 0xffff0000, v218
  v_or_b32 v218, v218, v209
  v_mov_b32 v19, 1073741824
  s_mov_b32 m0, s24
  s_nop 0
  buffer_load_dwordx4 v3, s[32:35], s26 offen offset:0 sc1 lds
  buffer_load_dwordx4 v4, s[32:35], s26 offen offset:1024 sc1 lds
  buffer_load_dwordx4 v5, s[32:35], s26 offen offset:2048 sc1 lds
  buffer_load_dwordx4 v6, s[32:35], s26 offen offset:3072 sc1 lds
  s_add_u32 m0, s24, 16384
  s_nop 0
  buffer_load_dwordx4 v8, s[36:39], s27 offen offset:0 lds
  buffer_load_dwordx4 v9, s[36:39], s27 offen offset:1024 lds
  buffer_load_dwordx4 v10, s[36:39], s27 offen offset:2048 lds
  buffer_load_dwordx4 v11, s[36:39], s27 offen offset:3072 lds
  s_add_u32 s26, s26, s79
  s_add_u32 s27, s27, s25
  s_add_u32 s24, s24, 32768
  s_and_b32 s24, s24, 0x1ffff
  s_mov_b32 m0, s24
  s_nop 0
  buffer_load_dwordx4 v3, s[32:35], s26 offen offset:0 sc1 lds
  buffer_load_dwordx4 v4, s[32:35], s26 offen offset:1024 sc1 lds
  buffer_load_dwordx4 v5, s[32:35], s26 offen offset:2048 sc1 lds
  buffer_load_dwordx4 v6, s[32:35], s26 offen offset:3072 sc1 lds
  s_add_u32 m0, s24, 16384
  s_nop 0
  buffer_load_dwordx4 v8, s[36:39], s27 offen offset:0 lds
  buffer_load_dwordx4 v9, s[36:39], s27 offen offset:1024 lds
  buffer_load_dwordx4 v10, s[36:39], s27 offen offset:2048 lds
  buffer_load_dwordx4 v11, s[36:39], s27 offen offset:3072 lds
  s_add_u32 s26, s26, s79
  s_add_u32 s27, s27, s25
  s_add_u32 s24, s24, 32768
  s_and_b32 s24, s24, 0x1ffff
  s_mov_b32 m0, s24
  s_nop 0
  buffer_load_dwordx4 v3, s[32:35], s26 offen offset:0 sc1 lds
  buffer_load_dwordx4 v4, s[32:35], s26 offen offset:1024 sc1 lds
  buffer_load_dwordx4 v5, s[32:35], s26 offen offset:2048 sc1 lds
  buffer_load_dwordx4 v6, s[32:35], s26 offen offset:3072 sc1 lds
  s_add_u32 m0, s24, 16384
  s_nop 0
  buffer_load_dwordx4 v8, s[36:39], s27 offen offset:0 lds
  buffer_load_dwordx4 v9, s[36:39], s27 offen offset:1024 lds
  buffer_load_dwordx4 v10, s[36:39], s27 offen offset:2048 lds
  buffer_load_dwordx4 v11, s[36:39], s27 offen offset:3072 lds
  s_add_u32 s26, s26, s79
  s_add_u32 s27, s27, s25
  s_add_u32 s24, s24, 32768
  s_and_b32 s24, s24, 0x1ffff
  buffer_load_dword v231, v19, s[32:35], 0 offen
  s_mov_b32 m0, s24
  s_nop 0
  buffer_load_dwordx4 v3, s[32:35], s26 offen offset:0 sc1 lds
  buffer_load_dwordx4 v4, s[32:35], s26 offen offset:1024 sc1 lds
  buffer_load_dwordx4 v5, s[32:35], s26 offen offset:2048 sc1 lds
  buffer_load_dwordx4 v6, s[32:35], s26 offen offset:3072 sc1 lds
  s_add_u32 m0, s24, 16384
  s_nop 0
  buffer_load_dwordx4 v8, s[36:39], s27 offen offset:0 lds
  buffer_load_dwordx4 v9, s[36:39], s27 offen offset:1024 lds
  buffer_load_dwordx4 v10, s[36:39], s27 offen offset:2048 lds
  buffer_load_dwordx4 v11, s[36:39], s27 offen offset:3072 lds
  s_add_u32 s26, s26, s79
  s_add_u32 s27, s27, s25
  s_add_u32 s24, s24, 32768
  s_and_b32 s24, s24, 0x1ffff
  s_waitcnt vmcnt(25) lgkmcnt(0)
  s_barrier
  s_cmp_ge_u32 s20, 2
  s_cbranch_scc1 fa_roleV
  ds_read_b128 v[96:99], v14 offset:0
  ds_read_b128 v[100:103], v14 offset:1024
  ds_read_b128 v[104:107], v14 offset:4096
  ds_read_b128 v[108:111], v14 offset:5120
  ds_read_b128 v[112:115], v14 offset:8192
  ds_read_b128 v[116:119], v14 offset:9216
  ds_read_b128 v[120:123], v14 offset:12288
  ds_read_b128 v[124:127], v14 offset:13312
  ds_read_b64_tr_b16 v[32:33], v12 offset:0
  ds_read_b64_tr_b16 v[34:35], v12 offset:1024
  ds_read_b64_tr_b16 v[36:37], v13 offset:0
  ds_read_b64_tr_b16 v[38:39], v13 offset:1024
  ds_read_b64_tr_b16 v[40:41], v12 offset:256
  ds_read_b64_tr_b16 v[42:43], v12 offset:1280
  ds_read_b64_tr_b16 v[44:45], v13 offset:256
  ds_read_b64_tr_b16 v[46:47], v13 offset:1280
  ds_read_b64_tr_b16 v[48:49], v12 offset:512
  ds_read_b64_tr_b16 v[50:51], v12 offset:1536
  ds_read_b64_tr_b16 v[52:53], v13 offset:512
  ds_read_b64_tr_b16 v[54:55], v13 offset:1536
  ds_read_b64_tr_b16 v[56:57], v12 offset:768
  ds_read_b64_tr_b16 v[58:59], v12 offset:1792
  ds_read_b64_tr_b16 v[60:61], v13 offset:768
  ds_read_b64_tr_b16 v[62:63], v13 offset:1792
  s_waitcnt lgkmcnt(0)
.p2align 6
fa_loopK:
  v_mfma_f32_16x16x32_bf16 a[192:195], v[32:35], v[96:99], a[192:195]
  s_waitcnt vmcnt(17)
  v_mfma_f32_16x16x32_bf16 a[200:203], v[32:35], v[100:103], a[200:203]
  s_barrier
  v_mfma_f32_16x16x32_bf16 a[0:3], v[32:35], v[104:107], a[0:3]
  ds_read_b64_tr_b16 v[64:65], v12 offset:32768
  v_mfma_f32_16x16x32_bf16 a[8:11], v[32:35], v[108:111], a[8:11]
  v_mfma_f32_16x16x32_bf16 a[64:67], v[32:35], v[112:115], a[64:67]
  s_mov_b32 m0, s24
  ds_read_b64_tr_b16 v[66:67], v12 offset:33792
  v_mfma_f32_16x16x32_bf16 a[72:75], v[32:35], v[116:119], a[72:75]
  buffer_load_dwordx4 v3, s[32:35], s26 offen offset:0 sc1 lds
  v_mfma_f32_16x16x32_bf16 a[128:131], v[32:35], v[120:123], a[128:131]
  ds_read_b128 v[128:131], v14 offset:32768
  v_mfma_f32_16x16x32_bf16 a[136:139], v[32:35], v[124:127], a[136:139]
  buffer_load_dwordx4 v4, s[32:35], s26 offen offset:1024 sc1 lds
  v_mfma_f32_16x16x32_bf16 a[196:199], v[36:39], v[96:99], a[196:199]
  ds_read_b64_tr_b16 v[68:69], v13 offset:32768
  v_mfma_f32_16x16x32_bf16 a[204:207], v[36:39], v[100:103], a[204:207]
  buffer_load_dwordx4 v5, s[32:35], s26 offen offset:2048 sc1 lds
  v_mfma_f32_16x16x32_bf16 a[4:7], v[36:39], v[104:107], a[4:7]
  ds_read_b64_tr_b16 v[70:71], v13 offset:33792
  v_mfma_f32_16x16x32_bf16 a[12:15], v[36:39], v[108:111], a[12:15]
  buffer_load_dwordx4 v6, s[32:35], s26 offen offset:3072 sc1 lds
  v_mfma_f32_16x16x32_bf16 a[68:71], v[36:39], v[112:115], a[68:71]
  s_add_u32 m0, s24, 16384
  ds_read_b128 v[132:135], v14 offset:33792
  v_mfma_f32_16x16x32_bf16 a[76:79], v[36:39], v[116:119], a[76:79]
  buffer_load_dwordx4 v8, s[36:39], s27 offen offset:0 lds
  v_mfma_f32_16x16x32_bf16 a[132:135], v[36:39], v[120:123], a[132:135]
  ds_read_b64_tr_b16 v[72:73], v12 offset:33024
  v_mfma_f32_16x16x32_bf16 a[140:143], v[36:39], v[124:127], a[140:143]
  buffer_load_dwordx4 v9, s[36:39], s27 offen offset:1024 lds
  v_mfma_f32_16x16x32_bf16 a[208:211], v[40:43], v[96:99], a[208:211]
  ds_read_b64_tr_b16 v[74:75], v12 offset:34048
  v_mfma_f32_16x16x32_bf16 a[216:219], v[40:43], v[100:103], a[216:219]
  buffer_load_dwordx4 v10, s[36:39], s27 offen offset:2048 lds
  v_mfma_f32_16x16x32_bf16 a[16:19], v[40:43], v[104:107], a[16:19]
  ds_read_b128 v[136:139], v14 offset:36864
  v_mfma_f32_16x16x32_bf16 a[24:27], v[40:43], v[108:111], a[24:27]
  buffer_load_dwordx4 v11, s[36:39], s27 offen offset:3072 lds
  v_mfma_f32_16x16x32_bf16 a[80:83], v[40:43], v[112:115], a[80:83]
  ds_read_b64_tr_b16 v[76:77], v13 offset:33024
  v_mfma_f32_16x16x32_bf16 a[88:91], v[40:43], v[116:119], a[88:91]
  buffer_load_dword v231, v235, s[48:51], s74 offen sc1
  v_mfma_f32_16x16x32_bf16 a[144:147], v[40:43], v[120:123], a[144:147]
  s_add_u32 s74, s74, s73
  ds_read_b64_tr_b16 v[78:79], v13 offset:34048
  v_mfma_f32_16x16x32_bf16 a[152:155], v[40:43], v[124:127], a[152:155]
  s_bitcmp1_b32 s72, s28
  v_mfma_f32_16x16x32_bf16 a[212:215], v[44:47], v[96:99], a[212:215]
  s_cbranch_scc1 fa_hk0
fa_hb0:
  ds_read_b128 v[140:143], v14 offset:37888
  v_mfma_f32_16x16x32_bf16 a[220:223], v[44:47], v[100:103], a[220:223]
  v_mfma_f32_16x16x32_bf16 a[20:23], v[44:47], v[104:107], a[20:23]
  ds_read_b64_tr_b16 v[80:81], v12 offset:33280
  v_mfma_f32_16x16x32_bf16 a[28:31], v[44:47], v[108:111], a[28:31]
  v_mfma_f32_16x16x32_bf16 a[84:87], v[44:47], v[112:115], a[84:87]
  ds_read_b64_tr_b16 v[82:83], v12 offset:34304
  v_mfma_f32_16x16x32_bf16 a[92:95], v[44:47], v[116:119], a[92:95]
  v_mfma_f32_16x16x32_bf16 a[148:151], v[44:47], v[120:123], a[148:151]
  ds_read_b128 v[144:147], v14 offset:40960
  v_mfma_f32_16x16x32_bf16 a[156:159], v[44:47], v[124:127], a[156:159]
  v_mfma_f32_16x16x32_bf16 a[224:227], v[48:51], v[96:99], a[224:227]
  ds_read_b64_tr_b16 v[84:85], v13 offset:33280
  v_mfma_f32_16x16x32_bf16 a[232:235], v[48:51], v[100:103], a[232:235]
  v_mfma_f32_16x16x32_bf16 a[32:35], v[48:51], v[104:107], a[32:35]
  ds_read_b64_tr_b16 v[86:87], v13 offset:34304
  v_mfma_f32_16x16x32_bf16 a[40:43], v[48:51], v[108:111], a[40:43]
  v_mfma_f32_16x16x32_bf16 a[96:99], v[48:51], v[112:115], a[96:99]
  ds_read_b128 v[148:151], v14 offset:41984
  v_mfma_f32_16x16x32_bf16 a[104:107], v[48:51], v[116:119], a[104:107]
  v_mfma_f32_16x16x32_bf16 a[160:163], v[48:51], v[120:123], a[160:163]
  ds_read_b64_tr_b16 v[88:89], v12 offset:33536
  v_mfma_f32_16x16x32_bf16 a[168:171], v[48:51], v[124:127], a[168:171]
  v_mfma_f32_16x16x32_bf16 a[228:231], v[52:55], v[96:99], a[228:231]
  ds_read_b64_tr_b16 v[90:91], v12 offset:34560
  v_mfma_f32_16x16x32_bf16 a[236:239], v[52:55], v[100:103], a[236:239]
  v_mfma_f32_16x16x32_bf16 a[36:39], v[52:55], v[104:107], a[36:39]
  ds_read_b128 v[152:155], v14 offset:45056
  v_mfma_f32_16x16x32_bf16 a[44:47], v[52:55], v[108:111], a[44:47]
  v_mfma_f32_16x16x32_bf16 a[100:103], v[52:55], v[112:115], a[100:103]
  ds_read_b64_tr_b16 v[92:93], v13 offset:33536
  v_mfma_f32_16x16x32_bf16 a[108:111], v[52:55], v[116:119], a[108:111]
  v_mfma_f32_16x16x32_bf16 a[164:167], v[52:55], v[120:123], a[164:167]
  ds_read_b64_tr_b16 v[94:95], v13 offset:34560
  v_mfma_f32_16x16x32_bf16 a[172:175], v[52:55], v[124:127], a[172:175]
  v_mfma_f32_16x16x32_bf16 a[240:243], v[56:59], v[96:99], a[240:243]
  s_add_u32 s26, s26, s79
  ds_read_b128 v[156:159], v14 offset:46080
  v_mfma_f32_16x16x32_bf16 a[248:251], v[56:59], v[100:103], a[248:251]
  s_add_u32 s27, s27, s25
  v_mfma_f32_16x16x32_bf16 a[48:51], v[56:59], v[104:107], a[48:51]
  s_add_u32 s24, s24, 32768
  v_mfma_f32_16x16x32_bf16 a[56:59], v[56:59], v[108:111], a[56:59]
  s_and_b32 s24, s24, 0x1ffff
  v_mfma_f32_16x16x32_bf16 a[112:115], v[56:59], v[112:115], a[112:115]
  v_xor_b32 v14, 0x10000, v14
  v_mfma_f32_16x16x32_bf16 a[120:123], v[56:59], v[116:119], a[120:123]
  v_xor_b32 v12, 0x10000, v12
  v_mfma_f32_16x16x32_bf16 a[176:179], v[56:59], v[120:123], a[176:179]
  v_xor_b32 v13, 0x10000, v13
  v_mfma_f32_16x16x32_bf16 a[184:187], v[56:59], v[124:127], a[184:187]
  v_mfma_f32_16x16x32_bf16 a[244:247], v[60:63], v[96:99], a[244:247]
  v_mfma_f32_16x16x32_bf16 a[252:255], v[60:63], v[100:103], a[252:255]
  v_mfma_f32_16x16x32_bf16 a[52:55], v[60:63], v[104:107], a[52:55]
  v_mfma_f32_16x16x32_bf16 a[60:63], v[60:63], v[108:111], a[60:63]
  v_mfma_f32_16x16x32_bf16 a[116:119], v[60:63], v[112:115], a[116:119]
  v_mfma_f32_16x16x32_bf16 a[124:127], v[60:63], v[116:119], a[124:127]
  v_mfma_f32_16x16x32_bf16 a[180:183], v[60:63], v[120:123], a[180:183]
  v_mfma_f32_16x16x32_bf16 a[188:191], v[60:63], v[124:127], a[188:191]
  s_waitcnt lgkmcnt(0)
  v_mfma_f32_16x16x32_bf16 a[192:195], v[64:67], v[128:131], a[192:195]
  s_waitcnt vmcnt(18)
  v_mfma_f32_16x16x32_bf16 a[200:203], v[64:67], v[132:135], a[200:203]
  s_barrier
  v_mfma_f32_16x16x32_bf16 a[0:3], v[64:67], v[136:139], a[0:3]
  ds_read_b64_tr_b16 v[32:33], v12 offset:0
  v_mfma_f32_16x16x32_bf16 a[8:11], v[64:67], v[140:143], a[8:11]
  v_mfma_f32_16x16x32_bf16 a[64:67], v[64:67], v[144:147], a[64:67]
  s_mov_b32 m0, s24
  ds_read_b64_tr_b16 v[34:35], v12 offset:1024
  v_mfma_f32_16x16x32_bf16 a[72:75], v[64:67], v[148:151], a[72:75]
  buffer_load_dwordx4 v3, s[32:35], s26 offen offset:0 sc1 lds
  v_mfma_f32_16x16x32_bf16 a[128:131], v[64:67], v[152:155], a[128:131]
  ds_read_b128 v[96:99], v14 offset:0
  v_mfma_f32_16x16x32_bf16 a[136:139], v[64:67], v[156:159], a[136:139]
  v_mfma_f32_16x16x32_bf16 a[196:199], v[68:71], v[128:131], a[196:199]
  ds_read_b64_tr_b16 v[36:37], v13 offset:0
  v_mfma_f32_16x16x32_bf16 a[204:207], v[68:71], v[132:135], a[204:207]
  v_mfma_f32_16x16x32_bf16 a[4:7], v[68:71], v[136:139], a[4:7]
  ds_read_b64_tr_b16 v[38:39], v13 offset:1024
  v_mfma_f32_16x16x32_bf16 a[12:15], v[68:71], v[140:143], a[12:15]
  buffer_load_dwordx4 v4, s[32:35], s26 offen offset:1024 sc1 lds
  v_mfma_f32_16x16x32_bf16 a[68:71], v[68:71], v[144:147], a[68:71]
  ds_read_b128 v[100:103], v14 offset:1024
  v_mfma_f32_16x16x32_bf16 a[76:79], v[68:71], v[148:151], a[76:79]
  v_mfma_f32_16x16x32_bf16 a[132:135], v[68:71], v[152:155], a[132:135]
  ds_read_b64_tr_b16 v[40:41], v12 offset:256
  v_mfma_f32_16x16x32_bf16 a[140:143], v[68:71], v[156:159], a[140:143]
  v_mfma_f32_16x16x32_bf16 a[208:211], v[72:75], v[128:131], a[208:211]
  ds_read_b64_tr_b16 v[42:43], v12 offset:1280
  v_mfma_f32_16x16x32_bf16 a[216:219], v[72:75], v[132:135], a[216:219]
  buffer_load_dwordx4 v5, s[32:35], s26 offen offset:2048 sc1 lds
  v_mfma_f32_16x16x32_bf16 a[16:19], v[72:75], v[136:139], a[16:19]
  ds_read_b128 v[104:107], v14 offset:4096
  v_mfma_f32_16x16x32_bf16 a[24:27], v[72:75], v[140:143], a[24:27]
  v_mfma_f32_16x16x32_bf16 a[80:83], v[72:75], v[144:147], a[80:83]
  ds_read_b64_tr_b16 v[44:45], v13 offset:256
  v_mfma_f32_16x16x32_bf16 a[88:91], v[72:75], v[148:151], a[88:91]
  v_mfma_f32_16x16x32_bf16 a[144:147], v[72:75], v[152:155], a[144:147]
  ds_read_b64_tr_b16 v[46:47], v13 offset:1280
  v_mfma_f32_16x16x32_bf16 a[152:155], v[72:75], v[156:159], a[152:155]
  buffer_load_dwordx4 v6, s[32:35], s26 offen offset:3072 sc1 lds
  v_mfma_f32_16x16x32_bf16 a[212:215], v[76:79], v[128:131], a[212:215]
  ds_read_b128 v[108:111], v14 offset:5120
  v_mfma_f32_16x16x32_bf16 a[220:223], v[76:79], v[132:135], a[220:223]
  v_mfma_f32_16x16x32_bf16 a[20:23], v[76:79], v[136:139], a[20:23]
  ds_read_b64_tr_b16 v[48:49], v12 offset:512
  v_mfma_f32_16x16x32_bf16 a[28:31], v[76:79], v[140:143], a[28:31]
  v_mfma_f32_16x16x32_bf16 a[84:87], v[76:79], v[144:147], a[84:87]
  s_add_u32 m0, s24, 16384
  ds_read_b64_tr_b16 v[50:51], v12 offset:1536
  v_mfma_f32_16x16x32_bf16 a[92:95], v[76:79], v[148:151], a[92:95]
  buffer_load_dwordx4 v8, s[36:39], s27 offen offset:0 lds
  v_mfma_f32_16x16x32_bf16 a[148:151], v[76:79], v[152:155], a[148:151]
  ds_read_b128 v[112:115], v14 offset:8192
  v_mfma_f32_16x16x32_bf16 a[156:159], v[76:79], v[156:159], a[156:159]
  v_mfma_f32_16x16x32_bf16 a[224:227], v[80:83], v[128:131], a[224:227]
  ds_read_b64_tr_b16 v[52:53], v13 offset:512
  v_mfma_f32_16x16x32_bf16 a[232:235], v[80:83], v[132:135], a[232:235]
  v_mfma_f32_16x16x32_bf16 a[32:35], v[80:83], v[136:139], a[32:35]
  ds_read_b64_tr_b16 v[54:55], v13 offset:1536
  v_mfma_f32_16x16x32_bf16 a[40:43], v[80:83], v[140:143], a[40:43]
  buffer_load_dwordx4 v9, s[36:39], s27 offen offset:1024 lds
  v_mfma_f32_16x16x32_bf16 a[96:99], v[80:83], v[144:147], a[96:99]
  ds_read_b128 v[116:119], v14 offset:9216
  v_mfma_f32_16x16x32_bf16 a[104:107], v[80:83], v[148:151], a[104:107]
  v_mfma_f32_16x16x32_bf16 a[160:163], v[80:83], v[152:155], a[160:163]
  ds_read_b64_tr_b16 v[56:57], v12 offset:768
  v_mfma_f32_16x16x32_bf16 a[168:171], v[80:83], v[156:159], a[168:171]
  v_mfma_f32_16x16x32_bf16 a[228:231], v[84:87], v[128:131], a[228:231]
  ds_read_b64_tr_b16 v[58:59], v12 offset:1792
  v_mfma_f32_16x16x32_bf16 a[236:239], v[84:87], v[132:135], a[236:239]
  buffer_load_dwordx4 v10, s[36:39], s27 offen offset:2048 lds
  v_mfma_f32_16x16x32_bf16 a[36:39], v[84:87], v[136:139], a[36:39]
  ds_read_b128 v[120:123], v14 offset:12288
  v_mfma_f32_16x16x32_bf16 a[44:47], v[84:87], v[140:143], a[44:47]
  v_mfma_f32_16x16x32_bf16 a[100:103], v[84:87], v[144:147], a[100:103]
  ds_read_b64_tr_b16 v[60:61], v13 offset:768
  v_mfma_f32_16x16x32_bf16 a[108:111], v[84:87], v[148:151], a[108:111]
  v_mfma_f32_16x16x32_bf16 a[164:167], v[84:87], v[152:155], a[164:167]
  ds_read_b64_tr_b16 v[62:63], v13 offset:1792
  v_mfma_f32_16x16x32_bf16 a[172:175], v[84:87], v[156:159], a[172:175]
  buffer_load_dwordx4 v11, s[36:39], s27 offen offset:3072 lds
  v_mfma_f32_16x16x32_bf16 a[240:243], v[88:91], v[128:131], a[240:243]
  s_add_u32 s26, s26, s79
  ds_read_b128 v[124:127], v14 offset:13312
  v_mfma_f32_16x16x32_bf16 a[248:251], v[88:91], v[132:135], a[248:251]
  s_add_u32 s27, s27, s25
  v_mfma_f32_16x16x32_bf16 a[48:51], v[88:91], v[136:139], a[48:51]
  s_add_u32 s24, s24, 32768
  v_mfma_f32_16x16x32_bf16 a[56:59], v[88:91], v[140:143], a[56:59]
  s_and_b32 s24, s24, 0x1ffff
  v_mfma_f32_16x16x32_bf16 a[112:115], v[88:91], v[144:147], a[112:115]
  v_mfma_f32_16x16x32_bf16 a[120:123], v[88:91], v[148:151], a[120:123]
  s_bitcmp1_b32 s76, s28
  v_mfma_f32_16x16x32_bf16 a[176:179], v[88:91], v[152:155], a[176:179]
  s_cbranch_scc1 fa_hk1
fa_hb1:
  v_mfma_f32_16x16x32_bf16 a[184:187], v[88:91], v[156:159], a[184:187]
  v_mfma_f32_16x16x32_bf16 a[244:247], v[92:95], v[128:131], a[244:247]
  v_mfma_f32_16x16x32_bf16 a[252:255], v[92:95], v[132:135], a[252:255]
  s_add_u32 s28, s28, 1
  v_mfma_f32_16x16x32_bf16 a[52:55], v[92:95], v[136:139], a[52:55]
  v_mfma_f32_16x16x32_bf16 a[60:63], v[92:95], v[140:143], a[60:63]
  v_mfma_f32_16x16x32_bf16 a[116:119], v[92:95], v[144:147], a[116:119]
  v_mfma_f32_16x16x32_bf16 a[124:127], v[92:95], v[148:151], a[124:127]
  s_cmp_lt_u32 s28, 8
  v_mfma_f32_16x16x32_bf16 a[180:183], v[92:95], v[152:155], a[180:183]
  s_waitcnt lgkmcnt(0)
  v_mfma_f32_16x16x32_bf16 a[188:191], v[92:95], v[156:159], a[188:191]
  s_cbranch_scc1 fa_loopK
  s_mov_b32 s64, 16777216
  s_mov_b32 s76, 0x3e0293ee
  s_branch fa_p1epi
fa_roleV:
  ds_read_b128 v[32:35], v14 offset:0
  ds_read_b128 v[36:39], v14 offset:1024
  ds_read_b128 v[40:43], v14 offset:4096
  ds_read_b128 v[44:47], v14 offset:5120
  ds_read_b128 v[48:51], v14 offset:8192
  ds_read_b128 v[52:55], v14 offset:9216
  ds_read_b128 v[56:59], v14 offset:12288
  ds_read_b128 v[60:63], v14 offset:13312
  ds_read_b64_tr_b16 v[96:97], v12 offset:0
  ds_read_b64_tr_b16 v[98:99], v12 offset:1024
  ds_read_b64_tr_b16 v[100:101], v13 offset:0
  ds_read_b64_tr_b16 v[102:103], v13 offset:1024
  ds_read_b64_tr_b16 v[104:105], v12 offset:256
  ds_read_b64_tr_b16 v[106:107], v12 offset:1280
  ds_read_b64_tr_b16 v[108:109], v13 offset:256
  ds_read_b64_tr_b16 v[110:111], v13 offset:1280
  ds_read_b64_tr_b16 v[112:113], v12 offset:512
  ds_read_b64_tr_b16 v[114:115], v12 offset:1536
  ds_read_b64_tr_b16 v[116:117], v13 offset:512
  ds_read_b64_tr_b16 v[118:119], v13 offset:1536
  ds_read_b64_tr_b16 v[120:121], v12 offset:768
  ds_read_b64_tr_b16 v[122:123], v12 offset:1792
  ds_read_b64_tr_b16 v[124:125], v13 offset:768
  ds_read_b64_tr_b16 v[126:127], v13 offset:1792
  s_waitcnt lgkmcnt(0)
.p2align 6
fa_loopV:
  v_mfma_f32_16x16x32_bf16 a[192:195], v[32:35], v[96:99], a[192:195]
  s_waitcnt vmcnt(17)
  v_mfma_f32_16x16x32_bf16 a[200:203], v[32:35], v[100:103], a[200:203]
  s_barrier
  v_mfma_f32_16x16x32_bf16 a[208:211], v[32:35], v[104:107], a[208:211]
  ds_read_b64_tr_b16 v[128:129], v12 offset:32768
  v_mfma_f32_16x16x32_bf16 a[216:219], v[32:35], v[108:111], a[216:219]
  v_mfma_f32_16x16x32_bf16 a[224:227], v[32:35], v[112:115], a[224:227]
  s_mov_b32 m0, s24
  ds_read_b64_tr_b16 v[130:131], v12 offset:33792
  v_mfma_f32_16x16x32_bf16 a[232:235], v[32:35], v[116:119], a[232:235]
  buffer_load_dwordx4 v3, s[32:35], s26 offen offset:0 sc1 lds
  v_mfma_f32_16x16x32_bf16 a[240:243], v[32:35], v[120:123], a[240:243]
  ds_read_b128 v[64:67], v14 offset:32768
  v_mfma_f32_16x16x32_bf16 a[248:251], v[32:35], v[124:127], a[248:251]
  buffer_load_dwordx4 v4, s[32:35], s26 offen offset:1024 sc1 lds
  v_mfma_f32_16x16x32_bf16 a[196:199], v[36:39], v[96:99], a[196:199]
  ds_read_b64_tr_b16 v[132:133], v13 offset:32768
  v_mfma_f32_16x16x32_bf16 a[204:207], v[36:39], v[100:103], a[204:207]
  buffer_load_dwordx4 v5, s[32:35], s26 offen offset:2048 sc1 lds
  v_mfma_f32_16x16x32_bf16 a[212:215], v[36:39], v[104:107], a[212:215]
  ds_read_b64_tr_b16 v[134:135], v13 offset:33792
  v_mfma_f32_16x16x32_bf16 a[220:223], v[36:39], v[108:111], a[220:223]
  buffer_load_dwordx4 v6, s[32:35], s26 offen offset:3072 sc1 lds
  v_mfma_f32_16x16x32_bf16 a[228:231], v[36:39], v[112:115], a[228:231]
  s_add_u32 m0, s24, 16384
  ds_read_b128 v[68:71], v14 offset:33792
  v_mfma_f32_16x16x32_bf16 a[236:239], v[36:39], v[116:119], a[236:239]
  buffer_load_dwordx4 v8, s[36:39], s27 offen offset:0 lds
  v_mfma_f32_16x16x32_bf16 a[244:247], v[36:39], v[120:123], a[244:247]
  ds_read_b64_tr_b16 v[136:137], v12 offset:33024
  v_mfma_f32_16x16x32_bf16 a[252:255], v[36:39], v[124:127], a[252:255]
  buffer_load_dwordx4 v9, s[36:39], s27 offen offset:1024 lds
  v_mfma_f32_16x16x32_bf16 a[0:3], v[40:43], v[96:99], a[0:3]
  ds_read_b64_tr_b16 v[138:139], v12 offset:34048
  v_mfma_f32_16x16x32_bf16 a[8:11], v[40:43], v[100:103], a[8:11]
  buffer_load_dwordx4 v10, s[36:39], s27 offen offset:2048 lds
  v_mfma_f32_16x16x32_bf16 a[16:19], v[40:43], v[104:107], a[16:19]
  ds_read_b128 v[72:75], v14 offset:36864
  v_mfma_f32_16x16x32_bf16 a[24:27], v[40:43], v[108:111], a[24:27]
  buffer_load_dwordx4 v11, s[36:39], s27 offen offset:3072 lds
  v_mfma_f32_16x16x32_bf16 a[32:35], v[40:43], v[112:115], a[32:35]
  ds_read_b64_tr_b16 v[140:141], v13 offset:33024
  v_mfma_f32_16x16x32_bf16 a[40:43], v[40:43], v[116:119], a[40:43]
  buffer_load_dword v231, v235, s[48:51], s74 offen sc1
  v_mfma_f32_16x16x32_bf16 a[48:51], v[40:43], v[120:123], a[48:51]
  s_add_u32 s74, s74, s73
  ds_read_b64_tr_b16 v[142:143], v13 offset:34048
  v_mfma_f32_16x16x32_bf16 a[56:59], v[40:43], v[124:127], a[56:59]
  s_bitcmp1_b32 s72, s28
  v_mfma_f32_16x16x32_bf16 a[4:7], v[44:47], v[96:99], a[4:7]
  s_cbranch_scc1 fa_hk2
fa_hb2:
  ds_read_b128 v[76:79], v14 offset:37888
  v_mfma_f32_16x16x32_bf16 a[12:15], v[44:47], v[100:103], a[12:15]
  v_mfma_f32_16x16x32_bf16 a[20:23], v[44:47], v[104:107], a[20:23]
  ds_read_b64_tr_b16 v[144:145], v12 offset:33280
  v_mfma_f32_16x16x32_bf16 a[28:31], v[44:47], v[108:111], a[28:31]
  v_mfma_f32_16x16x32_bf16 a[36:39], v[44:47], v[112:115], a[36:39]
  ds_read_b64_tr_b16 v[146:147], v12 offset:34304
  v_mfma_f32_16x16x32_bf16 a[44:47], v[44:47], v[116:119], a[44:47]
  v_mfma_f32_16x16x32_bf16 a[52:55], v[44:47], v[120:123], a[52:55]
  ds_read_b128 v[80:83], v14 offset:40960
  v_mfma_f32_16x16x32_bf16 a[60:63], v[44:47], v[124:127], a[60:63]
  v_mfma_f32_16x16x32_bf16 a[64:67], v[48:51], v[96:99], a[64:67]
  ds_read_b64_tr_b16 v[148:149], v13 offset:33280
  v_mfma_f32_16x16x32_bf16 a[72:75], v[48:51], v[100:103], a[72:75]
  v_mfma_f32_16x16x32_bf16 a[80:83], v[48:51], v[104:107], a[80:83]
  ds_read_b64_tr_b16 v[150:151], v13 offset:34304
  v_mfma_f32_16x16x32_bf16 a[88:91], v[48:51], v[108:111], a[88:91]
  v_mfma_f32_16x16x32_bf16 a[96:99], v[48:51], v[112:115], a[96:99]
  ds_read_b128 v[84:87], v14 offset:41984
  v_mfma_f32_16x16x32_bf16 a[104:107], v[48:51], v[116:119], a[104:107]
  v_mfma_f32_16x16x32_bf16 a[112:115], v[48:51], v[120:123], a[112:115]
  ds_read_b64_tr_b16 v[152:153], v12 offset:33536
  v_mfma_f32_16x16x32_bf16 a[120:123], v[48:51], v[124:127], a[120:123]
  v_mfma_f32_16x16x32_bf16 a[68:71], v[52:55], v[96:99], a[68:71]
  ds_read_b64_tr_b16 v[154:155], v12 offset:34560
  v_mfma_f32_16x16x32_bf16 a[76:79], v[52:55], v[100:103], a[76:79]
  v_mfma_f32_16x16x32_bf16 a[84:87], v[52:55], v[104:107], a[84:87]
  ds_read_b128 v[88:91], v14 offset:45056
  v_mfma_f32_16x16x32_bf16 a[92:95], v[52:55], v[108:111], a[92:95]
  v_mfma_f32_16x16x32_bf16 a[100:103], v[52:55], v[112:115], a[100:103]
  ds_read_b64_tr_b16 v[156:157], v13 offset:33536
  v_mfma_f32_16x16x32_bf16 a[108:111], v[52:55], v[116:119], a[108:111]
  v_mfma_f32_16x16x32_bf16 a[116:119], v[52:55], v[120:123], a[116:119]
  ds_read_b64_tr_b16 v[158:159], v13 offset:34560
  v_mfma_f32_16x16x32_bf16 a[124:127], v[52:55], v[124:127], a[124:127]
  v_mfma_f32_16x16x32_bf16 a[128:131], v[56:59], v[96:99], a[128:131]
  s_add_u32 s26, s26, s79
  ds_read_b128 v[92:95], v14 offset:46080
  v_mfma_f32_16x16x32_bf16 a[136:139], v[56:59], v[100:103], a[136:139]
  s_add_u32 s27, s27, s25
  v_mfma_f32_16x16x32_bf16 a[144:147], v[56:59], v[104:107], a[144:147]
  s_add_u32 s24, s24, 32768
  v_mfma_f32_16x16x32_bf16 a[152:155], v[56:59], v[108:111], a[152:155]
  s_and_b32 s24, s24, 0x1ffff
  v_mfma_f32_16x16x32_bf16 a[160:163], v[56:59], v[112:115], a[160:163]
  v_xor_b32 v14, 0x10000, v14
  v_mfma_f32_16x16x32_bf16 a[168:171], v[56:59], v[116:119], a[168:171]
  v_xor_b32 v12, 0x10000, v12
  v_mfma_f32_16x16x32_bf16 a[176:179], v[56:59], v[120:123], a[176:179]
  v_xor_b32 v13, 0x10000, v13
  v_mfma_f32_16x16x32_bf16 a[184:187], v[56:59], v[124:127], a[184:187]
  v_mfma_f32_16x16x32_bf16 a[132:135], v[60:63], v[96:99], a[132:135]
  v_mfma_f32_16x16x32_bf16 a[140:143], v[60:63], v[100:103], a[140:143]
  v_mfma_f32_16x16x32_bf16 a[148:151], v[60:63], v[104:107], a[148:151]
  v_mfma_f32_16x16x32_bf16 a[156:159], v[60:63], v[108:111], a[156:159]
  v_mfma_f32_16x16x32_bf16 a[164:167], v[60:63], v[112:115], a[164:167]
  v_mfma_f32_16x16x32_bf16 a[172:175], v[60:63], v[116:119], a[172:175]
  v_mfma_f32_16x16x32_bf16 a[180:183], v[60:63], v[120:123], a[180:183]
  v_mfma_f32_16x16x32_bf16 a[188:191], v[60:63], v[124:127], a[188:191]
  s_waitcnt lgkmcnt(0)
  v_mfma_f32_16x16x32_bf16 a[192:195], v[64:67], v[128:131], a[192:195]
  s_waitcnt vmcnt(18)
  v_mfma_f32_16x16x32_bf16 a[200:203], v[64:67], v[132:135], a[200:203]
  s_barrier
  v_mfma_f32_16x16x32_bf16 a[208:211], v[64:67], v[136:139], a[208:211]
  ds_read_b64_tr_b16 v[96:97], v12 offset:0
  v_mfma_f32_16x16x32_bf16 a[216:219], v[64:67], v[140:143], a[216:219]
  v_mfma_f32_16x16x32_bf16 a[224:227], v[64:67], v[144:147], a[224:227]
  s_mov_b32 m0, s24
  ds_read_b64_tr_b16 v[98:99], v12 offset:1024
  v_mfma_f32_16x16x32_bf16 a[232:235], v[64:67], v[148:151], a[232:235]
  buffer_load_dwordx4 v3, s[32:35], s26 offen offset:0 sc1 lds
  v_mfma_f32_16x16x32_bf16 a[240:243], v[64:67], v[152:155], a[240:243]
  ds_read_b128 v[32:35], v14 offset:0
  v_mfma_f32_16x16x32_bf16 a[248:251], v[64:67], v[156:159], a[248:251]
  v_mfma_f32_16x16x32_bf16 a[196:199], v[68:71], v[128:131], a[196:199]
  ds_read_b64_tr_b16 v[100:101], v13 offset:0
  v_mfma_f32_16x16x32_bf16 a[204:207], v[68:71], v[132:135], a[204:207]
  v_mfma_f32_16x16x32_bf16 a[212:215], v[68:71], v[136:139], a[212:215]
  ds_read_b64_tr_b16 v[102:103], v13 offset:1024
  v_mfma_f32_16x16x32_bf16 a[220:223], v[68:71], v[140:143], a[220:223]
  buffer_load_dwordx4 v4, s[32:35], s26 offen offset:1024 sc1 lds
  v_mfma_f32_16x16x32_bf16 a[228:231], v[68:71], v[144:147], a[228:231]
  ds_read_b128 v[36:39], v14 offset:1024
  v_mfma_f32_16x16x32_bf16 a[236:239], v[68:71], v[148:151], a[236:239]
  v_mfma_f32_16x16x32_bf16 a[244:247], v[68:71], v[152:155], a[244:247]
  ds_read_b64_tr_b16 v[104:105], v12 offset:256
  v_mfma_f32_16x16x32_bf16 a[252:255], v[68:71], v[156:159], a[252:255]
  v_mfma_f32_16x16x32_bf16 a[0:3], v[72:75], v[128:131], a[0:3]
  ds_read_b64_tr_b16 v[106:107], v12 offset:1280
  v_mfma_f32_16x16x32_bf16 a[8:11], v[72:75], v[132:135], a[8:11]
  buffer_load_dwordx4 v5, s[32:35], s26 offen offset:2048 sc1 lds
  v_mfma_f32_16x16x32_bf16 a[16:19], v[72:75], v[136:139], a[16:19]
  ds_read_b128 v[40:43], v14 offset:4096
  v_mfma_f32_16x16x32_bf16 a[24:27], v[72:75], v[140:143], a[24:27]
  v_mfma_f32_16x16x32_bf16 a[32:35], v[72:75], v[144:147], a[32:35]
  ds_read_b64_tr_b16 v[108:109], v13 offset:256
  v_mfma_f32_16x16x32_bf16 a[40:43], v[72:75], v[148:151], a[40:43]
  v_mfma_f32_16x16x32_bf16 a[48:51], v[72:75], v[152:155], a[48:51]
  ds_read_b64_tr_b16 v[110:111], v13 offset:1280
  v_mfma_f32_16x16x32_bf16 a[56:59], v[72:75], v[156:159], a[56:59]
  buffer_load_dwordx4 v6, s[32:35], s26 offen offset:3072 sc1 lds
  v_mfma_f32_16x16x32_bf16 a[4:7], v[76:79], v[128:131], a[4:7]
  ds_read_b128 v[44:47], v14 offset:5120
  v_mfma_f32_16x16x32_bf16 a[12:15], v[76:79], v[132:135], a[12:15]
  v_mfma_f32_16x16x32_bf16 a[20:23], v[76:79], v[136:139], a[20:23]
  ds_read_b64_tr_b16 v[112:113], v12 offset:512
  v_mfma_f32_16x16x32_bf16 a[28:31], v[76:79], v[140:143], a[28:31]
  v_mfma_f32_16x16x32_bf16 a[36:39], v[76:79], v[144:147], a[36:39]
  s_add_u32 m0, s24, 16384
  ds_read_b64_tr_b16 v[114:115], v12 offset:1536
  v_mfma_f32_16x16x32_bf16 a[44:47], v[76:79], v[148:151], a[44:47]
  buffer_load_dwordx4 v8, s[36:39], s27 offen offset:0 lds
  v_mfma_f32_16x16x32_bf16 a[52:55], v[76:79], v[152:155], a[52:55]
  ds_read_b128 v[48:51], v14 offset:8192
  v_mfma_f32_16x16x32_bf16 a[60:63], v[76:79], v[156:159], a[60:63]
  v_mfma_f32_16x16x32_bf16 a[64:67], v[80:83], v[128:131], a[64:67]
  ds_read_b64_tr_b16 v[116:117], v13 offset:512
  v_mfma_f32_16x16x32_bf16 a[72:75], v[80:83], v[132:135], a[72:75]
  v_mfma_f32_16x16x32_bf16 a[80:83], v[80:83], v[136:139], a[80:83]
  ds_read_b64_tr_b16 v[118:119], v13 offset:1536
  v_mfma_f32_16x16x32_bf16 a[88:91], v[80:83], v[140:143], a[88:91]
  buffer_load_dwordx4 v9, s[36:39], s27 offen offset:1024 lds
  v_mfma_f32_16x16x32_bf16 a[96:99], v[80:83], v[144:147], a[96:99]
  ds_read_b128 v[52:55], v14 offset:9216
  v_mfma_f32_16x16x32_bf16 a[104:107], v[80:83], v[148:151], a[104:107]
  v_mfma_f32_16x16x32_bf16 a[112:115], v[80:83], v[152:155], a[112:115]
  ds_read_b64_tr_b16 v[120:121], v12 offset:768
  v_mfma_f32_16x16x32_bf16 a[120:123], v[80:83], v[156:159], a[120:123]
  v_mfma_f32_16x16x32_bf16 a[68:71], v[84:87], v[128:131], a[68:71]
  ds_read_b64_tr_b16 v[122:123], v12 offset:1792
  v_mfma_f32_16x16x32_bf16 a[76:79], v[84:87], v[132:135], a[76:79]
  buffer_load_dwordx4 v10, s[36:39], s27 offen offset:2048 lds
  v_mfma_f32_16x16x32_bf16 a[84:87], v[84:87], v[136:139], a[84:87]
  ds_read_b128 v[56:59], v14 offset:12288
  v_mfma_f32_16x16x32_bf16 a[92:95], v[84:87], v[140:143], a[92:95]
  v_mfma_f32_16x16x32_bf16 a[100:103], v[84:87], v[144:147], a[100:103]
  ds_read_b64_tr_b16 v[124:125], v13 offset:768
  v_mfma_f32_16x16x32_bf16 a[108:111], v[84:87], v[148:151], a[108:111]
  v_mfma_f32_16x16x32_bf16 a[116:119], v[84:87], v[152:155], a[116:119]
  ds_read_b64_tr_b16 v[126:127], v13 offset:1792
  v_mfma_f32_16x16x32_bf16 a[124:127], v[84:87], v[156:159], a[124:127]
  buffer_load_dwordx4 v11, s[36:39], s27 offen offset:3072 lds
  v_mfma_f32_16x16x32_bf16 a[128:131], v[88:91], v[128:131], a[128:131]
  s_add_u32 s26, s26, s79
  ds_read_b128 v[60:63], v14 offset:13312
  v_mfma_f32_16x16x32_bf16 a[136:139], v[88:91], v[132:135], a[136:139]
  s_add_u32 s27, s27, s25
  v_mfma_f32_16x16x32_bf16 a[144:147], v[88:91], v[136:139], a[144:147]
  s_add_u32 s24, s24, 32768
  v_mfma_f32_16x16x32_bf16 a[152:155], v[88:91], v[140:143], a[152:155]
  s_and_b32 s24, s24, 0x1ffff
  v_mfma_f32_16x16x32_bf16 a[160:163], v[88:91], v[144:147], a[160:163]
  v_mfma_f32_16x16x32_bf16 a[168:171], v[88:91], v[148:151], a[168:171]
  s_bitcmp1_b32 s76, s28
  v_mfma_f32_16x16x32_bf16 a[176:179], v[88:91], v[152:155], a[176:179]
  s_cbranch_scc1 fa_hk3
fa_hb3:
  v_mfma_f32_16x16x32_bf16 a[184:187], v[88:91], v[156:159], a[184:187]
  v_mfma_f32_16x16x32_bf16 a[132:135], v[92:95], v[128:131], a[132:135]
  v_mfma_f32_16x16x32_bf16 a[140:143], v[92:95], v[132:135], a[140:143]
  s_add_u32 s28, s28, 1
  v_mfma_f32_16x16x32_bf16 a[148:151], v[92:95], v[136:139], a[148:151]
  v_mfma_f32_16x16x32_bf16 a[156:159], v[92:95], v[140:143], a[156:159]
  v_mfma_f32_16x16x32_bf16 a[164:167], v[92:95], v[144:147], a[164:167]
  v_mfma_f32_16x16x32_bf16 a[172:175], v[92:95], v[148:151], a[172:175]
  s_cmp_lt_u32 s28, 8
  v_mfma_f32_16x16x32_bf16 a[180:183], v[92:95], v[152:155], a[180:183]
  s_waitcnt lgkmcnt(0)
  v_mfma_f32_16x16x32_bf16 a[188:191], v[92:95], v[156:159], a[188:191]
  s_cbranch_scc1 fa_loopV
  s_mov_b32 s64, 33554432
  s_mov_b32 s76, 1.0
fa_p1epi:
  s_lshr_b32 s23, s20, 1
  s_lshl_b32 s23, s23, 13
  v_subrev_u32 v12, s23, v12
  v_subrev_u32 v13, s23, v13
  s_lshl_b32 s24, s20, 12
  v_add_u32 v14, s24, v2
  ds_read_b64_tr_b16 v[32:33], v12 offset:0
  ds_read_b64_tr_b16 v[34:35], v12 offset:1024
  ds_read_b64_tr_b16 v[36:37], v13 offset:0
  ds_read_b64_tr_b16 v[38:39], v13 offset:1024
  ds_read_b64_tr_b16 v[40:41], v12 offset:256
  ds_read_b64_tr_b16 v[42:43], v12 offset:1280
  ds_read_b64_tr_b16 v[44:45], v13 offset:256
  ds_read_b64_tr_b16 v[46:47], v13 offset:1280
  ds_read_b64_tr_b16 v[48:49], v12 offset:512
  ds_read_b64_tr_b16 v[50:51], v12 offset:1536
  ds_read_b64_tr_b16 v[52:53], v13 offset:512
  ds_read_b64_tr_b16 v[54:55], v13 offset:1536
  ds_read_b64_tr_b16 v[56:57], v12 offset:768
  ds_read_b64_tr_b16 v[58:59], v12 offset:1792
  ds_read_b64_tr_b16 v[60:61], v13 offset:768
  ds_read_b64_tr_b16 v[62:63], v13 offset:1792
  s_waitcnt vmcnt(8)
  ds_read_b128 v[224:227], v14 offset:0
  ds_read_b128 v[228:231], v14 offset:1024
  ds_read_b128 v[232:235], v14 offset:2048
  ds_read_b128 v[236:239], v14 offset:3072
  s_lshl_b32 s23, s21, 19
  s_add_u32 s64, s64, s23
  s_lshl_b32 s23, s22, 14
  s_add_u32 s64, s64, s23
  s_and_b32 s23, s20, 1
  s_lshl_b32 s23, s23, 13
  s_add_u32 s64, s64, s23
  s_lshl_b32 s23, s21, 19
  s_add_u32 s23, s23, 16777216
  s_add_u32 s6, s18, s23
  s_addc_u32 s7, s19, 0
  s_add_u32 s8, s6, 16777216
  s_addc_u32 s9, s7, 0
  s_sub_u32 s23, 16, s22
  s_lshl_b32 s23, s23, 15
  s_mov_b32 s44, s6
  s_mov_b32 s45, s7
  s_mov_b32 s46, s23
  s_mov_b32 s47, 0x20000
  s_mov_b32 s48, s8
  s_mov_b32 s49, s9
  s_mov_b32 s50, s23
  s_mov_b32 s51, 0x20000
  s_lshl_b32 s30, s21, 7
  s_add_u32 s30, s30, 2637824
  s_mov_b32 s81, 0x47800000
  s_cmp_eq_u32 s20, 0
  s_cselect_b32 s65, s82, 1073741824
  s_waitcnt vmcnt(21) lgkmcnt(0)
  v_mfma_f32_16x16x32_bf16 v[96:99], v[32:35], v[224:227], 0
  v_accvgpr_read_b32 v16, a192
  v_accvgpr_read_b32 v17, a193
  v_accvgpr_read_b32 v18, a194
  v_mfma_f32_16x16x32_bf16 v[112:115], v[36:39], v[224:227], 0
  ds_read_b64_tr_b16 v[64:65], v12 offset:8192
  v_accvgpr_read_b32 v19, a195
  v_mfma_f32_16x16x32_bf16 v[128:131], v[40:43], v[224:227], 0
  s_add_u32 m0, s24, 0
  ds_read_b64_tr_b16 v[66:67], v12 offset:9216
  v_accvgpr_read_b32 v20, a196
  v_mfma_f32_16x16x32_bf16 v[144:147], v[44:47], v[224:227], 0
  buffer_load_dwordx4 v3, s[32:35], s26 offen offset:0 sc1 lds
  v_accvgpr_read_b32 v21, a197
  v_mfma_f32_16x16x32_bf16 v[160:163], v[48:51], v[224:227], 0
  ds_read_b64_tr_b16 v[68:69], v13 offset:8192
  v_accvgpr_read_b32 v22, a198
  v_accvgpr_read_b32 v23, a199
  v_mfma_f32_16x16x32_bf16 v[176:179], v[52:55], v[224:227], 0
  ds_read_b64_tr_b16 v[70:71], v13 offset:9216
  v_mul_f32 v16, s76, v16
  v_mfma_f32_16x16x32_bf16 v[192:195], v[56:59], v[224:227], 0
  ds_read_b64_tr_b16 v[72:73], v12 offset:8448
  v_mul_f32 v17, s76, v17
  v_mfma_f32_16x16x32_bf16 v[208:211], v[60:63], v[224:227], 0
  ds_read_b64_tr_b16 v[74:75], v12 offset:9472
  v_mul_f32 v18, s76, v18
  v_mfma_f32_16x16x32_bf16 v[100:103], v[32:35], v[228:231], 0
  buffer_load_dwordx4 v4, s[32:35], s26 offen offset:1024 sc1 lds
  v_mul_f32 v19, s76, v19
  v_mul_f32 v20, s76, v20
  v_mfma_f32_16x16x32_bf16 v[116:119], v[36:39], v[228:231], 0
  ds_read_b64_tr_b16 v[76:77], v13 offset:8448
  v_mul_f32 v21, s76, v21
  v_mfma_f32_16x16x32_bf16 v[132:135], v[40:43], v[228:231], 0
  ds_read_b64_tr_b16 v[78:79], v13 offset:9472
  v_mul_f32 v22, s76, v22
  v_mfma_f32_16x16x32_bf16 v[148:151], v[44:47], v[228:231], 0
  ds_read_b128 v[240:243], v14 offset:32768
  v_mul_f32 v23, s76, v23
  v_mfma_f32_16x16x32_bf16 v[164:167], v[48:51], v[228:231], 0
  ds_read_b128 v[244:247], v14 offset:33792
  v_cvt_pk_bf16_f32 v24, v16, v17
  v_cvt_pk_bf16_f32 v25, v18, v19
  v_mfma_f32_16x16x32_bf16 v[180:183], v[52:55], v[228:231], 0
  buffer_load_dwordx4 v5, s[32:35], s26 offen offset:2048 sc1 lds
  v_cvt_pk_bf16_f32 v26, v20, v21
  v_mfma_f32_16x16x32_bf16 v[196:199], v[56:59], v[228:231], 0
  ds_read_b64_tr_b16 v[80:81], v12 offset:8704
  v_cvt_pk_bf16_f32 v27, v22, v23
  v_mfma_f32_16x16x32_bf16 v[212:215], v[60:63], v[228:231], 0
  ds_read_b64_tr_b16 v[82:83], v12 offset:9728
  buffer_store_dwordx4 v[24:27], v2, s[40:43], s64 offen offset:0 sc1
  v_mfma_f32_16x16x32_bf16 v[104:107], v[32:35], v[232:235], 0
  ds_read_b64_tr_b16 v[84:85], v13 offset:8704
  v_accvgpr_read_b32 v16, a200
  v_mfma_f32_16x16x32_bf16 v[120:123], v[36:39], v[232:235], 0
  ds_read_b64_tr_b16 v[86:87], v13 offset:9728
  v_accvgpr_read_b32 v17, a201
  v_accvgpr_read_b32 v18, a202
  v_mfma_f32_16x16x32_bf16 v[136:139], v[40:43], v[232:235], 0
  buffer_load_dwordx4 v6, s[32:35], s26 offen offset:3072 sc1 lds
  v_accvgpr_read_b32 v19, a203
  v_mfma_f32_16x16x32_bf16 v[152:155], v[44:47], v[232:235], 0
  s_add_u32 s26, s26, 1024
  ds_read_b64_tr_b16 v[88:89], v12 offset:8960
  v_accvgpr_read_b32 v20, a204
  v_mfma_f32_16x16x32_bf16 v[168:171], v[48:51], v[232:235], 0
  ds_read_b64_tr_b16 v[90:91], v12 offset:9984
  v_accvgpr_read_b32 v21, a205
  v_mfma_f32_16x16x32_bf16 v[184:187], v[52:55], v[232:235], 0
  ds_read_b64_tr_b16 v[92:93], v13 offset:8960
  v_accvgpr_read_b32 v22, a206
  v_accvgpr_read_b32 v23, a207
  v_mfma_f32_16x16x32_bf16 v[200:203], v[56:59], v[232:235], 0
  ds_read_b64_tr_b16 v[94:95], v13 offset:9984
  v_mul_f32 v16, s76, v16
  v_mfma_f32_16x16x32_bf16 v[216:219], v[60:63], v[232:235], 0
  v_mul_f32 v17, s76, v17
  v_mul_f32 v18, s76, v18
  v_mfma_f32_16x16x32_bf16 v[108:111], v[32:35], v[236:239], 0
  ds_read_b128 v[248:251], v14 offset:34816
  v_mul_f32 v19, s76, v19
  v_mfma_f32_16x16x32_bf16 v[124:127], v[36:39], v[236:239], 0
  ds_read_b128 v[252:255], v14 offset:35840
  v_mul_f32 v20, s76, v20
  v_mul_f32 v21, s76, v21
  v_mfma_f32_16x16x32_bf16 v[140:143], v[40:43], v[236:239], 0
  v_mul_f32 v22, s76, v22
  v_mul_f32 v23, s76, v23
  v_mfma_f32_16x16x32_bf16 v[156:159], v[44:47], v[236:239], 0
  v_xor_b32 v14, 0x10000, v14
  v_cvt_pk_bf16_f32 v28, v16, v17
  v_mfma_f32_16x16x32_bf16 v[172:175], v[48:51], v[236:239], 0
  v_cvt_pk_bf16_f32 v29, v18, v19
  v_cvt_pk_bf16_f32 v30, v20, v21
  v_mfma_f32_16x16x32_bf16 v[188:191], v[52:55], v[236:239], 0
  v_cvt_pk_bf16_f32 v31, v22, v23
  v_mfma_f32_16x16x32_bf16 v[204:207], v[56:59], v[236:239], 0
  buffer_store_dwordx4 v[28:31], v2, s[40:43], s64 offen offset:1024 sc1
  v_mfma_f32_16x16x32_bf16 v[220:223], v[60:63], v[236:239], 0
  s_waitcnt vmcnt(19) lgkmcnt(0)
  v_mfma_f32_16x16x32_bf16 v[96:99], v[64:67], v[240:243], v[96:99]
  s_barrier
  v_accvgpr_read_b32 v16, a208
  v_accvgpr_read_b32 v17, a209
  v_accvgpr_read_b32 v18, a210
  v_mfma_f32_16x16x32_bf16 v[112:115], v[68:71], v[240:243], v[112:115]
  ds_read_b64_tr_b16 v[32:33], v12 offset:32768
  v_accvgpr_read_b32 v19, a211
  v_mfma_f32_16x16x32_bf16 v[128:131], v[72:75], v[240:243], v[128:131]
  s_add_u32 m0, s24, 32768
  ds_read_b64_tr_b16 v[34:35], v12 offset:33792
  v_accvgpr_read_b32 v20, a212
  v_mfma_f32_16x16x32_bf16 v[144:147], v[76:79], v[240:243], v[144:147]
  buffer_load_dwordx4 v3, s[32:35], s26 offen offset:0 sc1 lds
  v_accvgpr_read_b32 v21, a213
  v_mfma_f32_16x16x32_bf16 v[160:163], v[80:83], v[240:243], v[160:163]
  ds_read_b64_tr_b16 v[36:37], v13 offset:32768
  v_accvgpr_read_b32 v22, a214
  v_accvgpr_read_b32 v23, a215
  v_mfma_f32_16x16x32_bf16 v[176:179], v[84:87], v[240:243], v[176:179]
  ds_read_b64_tr_b16 v[38:39], v13 offset:33792
  v_mul_f32 v16, s76, v16
  v_mfma_f32_16x16x32_bf16 v[192:195], v[88:91], v[240:243], v[192:195]
  ds_read_b64_tr_b16 v[40:41], v12 offset:33024
  v_mul_f32 v17, s76, v17
  v_mfma_f32_16x16x32_bf16 v[208:211], v[92:95], v[240:243], v[208:211]
  ds_read_b64_tr_b16 v[42:43], v12 offset:34048
  v_mul_f32 v18, s76, v18
  v_mfma_f32_16x16x32_bf16 v[100:103], v[64:67], v[244:247], v[100:103]
  buffer_load_dwordx4 v4, s[32:35], s26 offen offset:1024 sc1 lds
  v_mul_f32 v19, s76, v19
  v_mul_f32 v20, s76, v20
  v_mfma_f32_16x16x32_bf16 v[116:119], v[68:71], v[244:247], v[116:119]
  ds_read_b64_tr_b16 v[44:45], v13 offset:33024
  v_mul_f32 v21, s76, v21
  v_mfma_f32_16x16x32_bf16 v[132:135], v[72:75], v[244:247], v[132:135]
  ds_read_b64_tr_b16 v[46:47], v13 offset:34048
  v_mul_f32 v22, s76, v22
  v_mfma_f32_16x16x32_bf16 v[148:151], v[76:79], v[244:247], v[148:151]
  ds_read_b128 v[224:227], v14 offset:0
  v_mul_f32 v23, s76, v23
  v_mfma_f32_16x16x32_bf16 v[164:167], v[80:83], v[244:247], v[164:167]
  ds_read_b128 v[228:231], v14 offset:1024
  v_cvt_pk_bf16_f32 v24, v16, v17
  v_cvt_pk_bf16_f32 v25, v18, v19
  v_mfma_f32_16x16x32_bf16 v[180:183], v[84:87], v[244:247], v[180:183]
  buffer_load_dwordx4 v5, s[32:35], s26 offen offset:2048 sc1 lds
  v_cvt_pk_bf16_f32 v26, v20, v21
  v_mfma_f32_16x16x32_bf16 v[196:199], v[88:91], v[244:247], v[196:199]
  ds_read_b64_tr_b16 v[48:49], v12 offset:33280
  v_cvt_pk_bf16_f32 v27, v22, v23
  v_mfma_f32_16x16x32_bf16 v[212:215], v[92:95], v[244:247], v[212:215]
  ds_read_b64_tr_b16 v[50:51], v12 offset:34304
  buffer_store_dwordx4 v[24:27], v2, s[40:43], s64 offen offset:2048 sc1
  v_mfma_f32_16x16x32_bf16 v[104:107], v[64:67], v[248:251], v[104:107]
  ds_read_b64_tr_b16 v[52:53], v13 offset:33280
  v_accvgpr_read_b32 v16, a216
  v_mfma_f32_16x16x32_bf16 v[120:123], v[68:71], v[248:251], v[120:123]
  ds_read_b64_tr_b16 v[54:55], v13 offset:34304
  v_accvgpr_read_b32 v17, a217
  v_accvgpr_read_b32 v18, a218
  v_mfma_f32_16x16x32_bf16 v[136:139], v[72:75], v[248:251], v[136:139]
  buffer_load_dwordx4 v6, s[32:35], s26 offen offset:3072 sc1 lds
  v_accvgpr_read_b32 v19, a219
  v_mfma_f32_16x16x32_bf16 v[152:155], v[76:79], v[248:251], v[152:155]
  s_add_u32 s26, s26, 1024
  ds_read_b64_tr_b16 v[56:57], v12 offset:33536
  v_accvgpr_read_b32 v20, a220
  v_mfma_f32_16x16x32_bf16 v[168:171], v[80:83], v[248:251], v[168:171]
  ds_read_b64_tr_b16 v[58:59], v12 offset:34560
  v_accvgpr_read_b32 v21, a221
  v_mfma_f32_16x16x32_bf16 v[184:187], v[84:87], v[248:251], v[184:187]
  ds_read_b64_tr_b16 v[60:61], v13 offset:33536
  v_accvgpr_read_b32 v22, a222
  v_accvgpr_read_b32 v23, a223
  v_mfma_f32_16x16x32_bf16 v[200:203], v[88:91], v[248:251], v[200:203]
  s_add_u32 m0, s24, 16384
  ds_read_b64_tr_b16 v[62:63], v13 offset:34560
  v_mul_f32 v16, s76, v16
  v_mfma_f32_16x16x32_bf16 v[216:219], v[92:95], v[248:251], v[216:219]
  buffer_load_dwordx4 v8, s[36:39], s27 offen offset:0 lds
  v_mul_f32 v17, s76, v17
  v_mfma_f32_16x16x32_bf16 v[108:111], v[64:67], v[252:255], v[108:111]
  ds_read_b128 v[232:235], v14 offset:2048
  v_mul_f32 v18, s76, v18
  v_mfma_f32_16x16x32_bf16 v[124:127], v[68:71], v[252:255], v[124:127]
  ds_read_b128 v[236:239], v14 offset:3072
  v_mul_f32 v19, s76, v19
  v_mul_f32 v20, s76, v20
  v_mfma_f32_16x16x32_bf16 v[140:143], v[72:75], v[252:255], v[140:143]
  v_mul_f32 v21, s76, v21
  v_mul_f32 v22, s76, v22
  v_mfma_f32_16x16x32_bf16 v[156:159], v[76:79], v[252:255], v[156:159]
  v_mul_f32 v23, s76, v23
  v_cvt_pk_bf16_f32 v28, v16, v17
  v_mfma_f32_16x16x32_bf16 v[172:175], v[80:83], v[252:255], v[172:175]
  buffer_load_dwordx4 v9, s[36:39], s27 offen offset:1024 lds
  v_cvt_pk_bf16_f32 v29, v18, v19
  v_mfma_f32_16x16x32_bf16 v[188:191], v[84:87], v[252:255], v[188:191]
  v_cvt_pk_bf16_f32 v30, v20, v21
  v_cvt_pk_bf16_f32 v31, v22, v23
  v_mfma_f32_16x16x32_bf16 v[204:207], v[88:91], v[252:255], v[204:207]
  buffer_store_dwordx4 v[28:31], v2, s[40:43], s64 offen offset:3072 sc1
  v_mfma_f32_16x16x32_bf16 v[220:223], v[92:95], v[252:255], v[220:223]
  s_waitcnt vmcnt(18) lgkmcnt(0)
  v_mfma_f32_16x16x32_bf16 v[96:99], v[32:35], v[224:227], v[96:99]
  s_add_u32 s64, s64, 4096
  v_accvgpr_read_b32 v16, a224
  v_accvgpr_read_b32 v17, a225
  v_mfma_f32_16x16x32_bf16 v[112:115], v[36:39], v[224:227], v[112:115]
  ds_read_b64_tr_b16 v[64:65], v12 offset:40960
  v_accvgpr_read_b32 v18, a226
  v_mfma_f32_16x16x32_bf16 v[128:131], v[40:43], v[224:227], v[128:131]
  s_add_u32 m0, s24, 65536
  ds_read_b64_tr_b16 v[66:67], v12 offset:41984
  v_accvgpr_read_b32 v19, a227
  v_mfma_f32_16x16x32_bf16 v[144:147], v[44:47], v[224:227], v[144:147]
  buffer_load_dwordx4 v3, s[32:35], s26 offen offset:0 sc1 lds
  v_accvgpr_read_b32 v20, a228
  v_mfma_f32_16x16x32_bf16 v[160:163], v[48:51], v[224:227], v[160:163]
  ds_read_b64_tr_b16 v[68:69], v13 offset:40960
  v_accvgpr_read_b32 v21, a229
  v_mfma_f32_16x16x32_bf16 v[176:179], v[52:55], v[224:227], v[176:179]
  ds_read_b64_tr_b16 v[70:71], v13 offset:41984
  v_accvgpr_read_b32 v22, a230
  v_mfma_f32_16x16x32_bf16 v[192:195], v[56:59], v[224:227], v[192:195]
  ds_read_b64_tr_b16 v[72:73], v12 offset:41216
  v_accvgpr_read_b32 v23, a231
  v_mfma_f32_16x16x32_bf16 v[208:211], v[60:63], v[224:227], v[208:211]
  ds_read_b64_tr_b16 v[74:75], v12 offset:42240
  v_mul_f32 v16, s76, v16
  v_mfma_f32_16x16x32_bf16 v[100:103], v[32:35], v[228:231], v[100:103]
  buffer_load_dwordx4 v4, s[32:35], s26 offen offset:1024 sc1 lds
  v_mul_f32 v17, s76, v17
  v_mfma_f32_16x16x32_bf16 v[116:119], v[36:39], v[228:231], v[116:119]
  ds_read_b64_tr_b16 v[76:77], v13 offset:41216
  v_mul_f32 v18, s76, v18
  v_mfma_f32_16x16x32_bf16 v[132:135], v[40:43], v[228:231], v[132:135]
  ds_read_b64_tr_b16 v[78:79], v13 offset:42240
  v_mul_f32 v19, s76, v19
  v_mfma_f32_16x16x32_bf16 v[148:151], v[44:47], v[228:231], v[148:151]
  ds_read_b128 v[240:243], v14 offset:32768
  v_mul_f32 v20, s76, v20
  v_mfma_f32_16x16x32_bf16 v[164:167], v[48:51], v[228:231], v[164:167]
  ds_read_b128 v[244:247], v14 offset:33792
  v_mul_f32 v21, s76, v21
  v_mfma_f32_16x16x32_bf16 v[180:183], v[52:55], v[228:231], v[180:183]
  buffer_load_dwordx4 v5, s[32:35], s26 offen offset:2048 sc1 lds
  v_mul_f32 v22, s76, v22
  v_mfma_f32_16x16x32_bf16 v[196:199], v[56:59], v[228:231], v[196:199]
  ds_read_b64_tr_b16 v[80:81], v12 offset:41472
  v_mul_f32 v23, s76, v23
  v_mfma_f32_16x16x32_bf16 v[212:215], v[60:63], v[228:231], v[212:215]
  ds_read_b64_tr_b16 v[82:83], v12 offset:42496
  v_cvt_pk_bf16_f32 v24, v16, v17
  v_mfma_f32_16x16x32_bf16 v[104:107], v[32:35], v[232:235], v[104:107]
  ds_read_b64_tr_b16 v[84:85], v13 offset:41472
  v_cvt_pk_bf16_f32 v25, v18, v19
  v_mfma_f32_16x16x32_bf16 v[120:123], v[36:39], v[232:235], v[120:123]
  ds_read_b64_tr_b16 v[86:87], v13 offset:42496
  v_cvt_pk_bf16_f32 v26, v20, v21
  v_mfma_f32_16x16x32_bf16 v[136:139], v[40:43], v[232:235], v[136:139]
  buffer_load_dwordx4 v6, s[32:35], s26 offen offset:3072 sc1 lds
  v_cvt_pk_bf16_f32 v27, v22, v23
  v_mfma_f32_16x16x32_bf16 v[152:155], v[44:47], v[232:235], v[152:155]
  s_add_u32 s26, s26, 1024
  ds_read_b64_tr_b16 v[88:89], v12 offset:41728
  buffer_store_dwordx4 v[24:27], v2, s[40:43], s64 offen offset:0 sc1
  v_mfma_f32_16x16x32_bf16 v[168:171], v[48:51], v[232:235], v[168:171]
  ds_read_b64_tr_b16 v[90:91], v12 offset:42752
  v_mfma_f32_16x16x32_bf16 v[184:187], v[52:55], v[232:235], v[184:187]
  ds_read_b64_tr_b16 v[92:93], v13 offset:41728
  v_mfma_f32_16x16x32_bf16 v[200:203], v[56:59], v[232:235], v[200:203]
  s_add_u32 m0, s24, 16384
  ds_read_b64_tr_b16 v[94:95], v13 offset:42752
  v_mfma_f32_16x16x32_bf16 v[216:219], v[60:63], v[232:235], v[216:219]
  buffer_load_dwordx4 v10, s[36:39], s27 offen offset:2048 lds
  v_mfma_f32_16x16x32_bf16 v[108:111], v[32:35], v[236:239], v[108:111]
  ds_read_b128 v[248:251], v14 offset:34816
  v_mfma_f32_16x16x32_bf16 v[124:127], v[36:39], v[236:239], v[124:127]
  ds_read_b128 v[252:255], v14 offset:35840
  v_mfma_f32_16x16x32_bf16 v[140:143], v[40:43], v[236:239], v[140:143]
  v_mfma_f32_16x16x32_bf16 v[156:159], v[44:47], v[236:239], v[156:159]
  v_xor_b32 v14, 0x10000, v14
  v_mfma_f32_16x16x32_bf16 v[172:175], v[48:51], v[236:239], v[172:175]
  buffer_load_dwordx4 v11, s[36:39], s27 offen offset:3072 lds
  v_mfma_f32_16x16x32_bf16 v[188:191], v[52:55], v[236:239], v[188:191]
  s_add_u32 s27, s27, 524288
  v_xor_b32 v12, 0x10000, v12
  v_mfma_f32_16x16x32_bf16 v[204:207], v[56:59], v[236:239], v[204:207]
  v_xor_b32 v13, 0x10000, v13
  v_mfma_f32_16x16x32_bf16 v[220:223], v[60:63], v[236:239], v[220:223]
  s_waitcnt vmcnt(16) lgkmcnt(0)
  v_mfma_f32_16x16x32_bf16 v[96:99], v[64:67], v[240:243], v[96:99]
  s_barrier
  v_accvgpr_read_b32 v16, a232
  v_accvgpr_read_b32 v17, a233
  v_mfma_f32_16x16x32_bf16 v[112:115], v[68:71], v[240:243], v[112:115]
  ds_read_b64_tr_b16 v[32:33], v12 offset:0
  v_accvgpr_read_b32 v18, a234
  v_mfma_f32_16x16x32_bf16 v[128:131], v[72:75], v[240:243], v[128:131]
  s_add_u32 m0, s24, 98304
  ds_read_b64_tr_b16 v[34:35], v12 offset:1024
  v_accvgpr_read_b32 v19, a235
  v_mfma_f32_16x16x32_bf16 v[144:147], v[76:79], v[240:243], v[144:147]
  buffer_load_dwordx4 v3, s[32:35], s26 offen offset:0 sc1 lds
  v_accvgpr_read_b32 v20, a236
  v_mfma_f32_16x16x32_bf16 v[160:163], v[80:83], v[240:243], v[160:163]
  ds_read_b64_tr_b16 v[36:37], v13 offset:0
  v_accvgpr_read_b32 v21, a237
  v_mfma_f32_16x16x32_bf16 v[176:179], v[84:87], v[240:243], v[176:179]
  ds_read_b64_tr_b16 v[38:39], v13 offset:1024
  v_accvgpr_read_b32 v22, a238
  v_mfma_f32_16x16x32_bf16 v[192:195], v[88:91], v[240:243], v[192:195]
  ds_read_b64_tr_b16 v[40:41], v12 offset:256
  v_accvgpr_read_b32 v23, a239
  v_mfma_f32_16x16x32_bf16 v[208:211], v[92:95], v[240:243], v[208:211]
  ds_read_b64_tr_b16 v[42:43], v12 offset:1280
  v_mul_f32 v16, s76, v16
  v_mfma_f32_16x16x32_bf16 v[100:103], v[64:67], v[244:247], v[100:103]
  buffer_load_dwordx4 v4, s[32:35], s26 offen offset:1024 sc1 lds
  v_mul_f32 v17, s76, v17
  v_mfma_f32_16x16x32_bf16 v[116:119], v[68:71], v[244:247], v[116:119]
  ds_read_b64_tr_b16 v[44:45], v13 offset:256
  v_mul_f32 v18, s76, v18
  v_mfma_f32_16x16x32_bf16 v[132:135], v[72:75], v[244:247], v[132:135]
  ds_read_b64_tr_b16 v[46:47], v13 offset:1280
  v_mul_f32 v19, s76, v19
  v_mfma_f32_16x16x32_bf16 v[148:151], v[76:79], v[244:247], v[148:151]
  ds_read_b128 v[224:227], v14 offset:0
  v_mul_f32 v20, s76, v20
  v_mfma_f32_16x16x32_bf16 v[164:167], v[80:83], v[244:247], v[164:167]
  ds_read_b128 v[228:231], v14 offset:1024
  v_mul_f32 v21, s76, v21
  v_mfma_f32_16x16x32_bf16 v[180:183], v[84:87], v[244:247], v[180:183]
  buffer_load_dwordx4 v5, s[32:35], s26 offen offset:2048 sc1 lds
  v_mul_f32 v22, s76, v22
  v_mfma_f32_16x16x32_bf16 v[196:199], v[88:91], v[244:247], v[196:199]
  ds_read_b64_tr_b16 v[48:49], v12 offset:512
  v_mul_f32 v23, s76, v23
  v_mfma_f32_16x16x32_bf16 v[212:215], v[92:95], v[244:247], v[212:215]
  ds_read_b64_tr_b16 v[50:51], v12 offset:1536
  v_cvt_pk_bf16_f32 v28, v16, v17
  v_mfma_f32_16x16x32_bf16 v[104:107], v[64:67], v[248:251], v[104:107]
  ds_read_b64_tr_b16 v[52:53], v13 offset:512
  v_cvt_pk_bf16_f32 v29, v18, v19
  v_mfma_f32_16x16x32_bf16 v[120:123], v[68:71], v[248:251], v[120:123]
  ds_read_b64_tr_b16 v[54:55], v13 offset:1536
  v_cvt_pk_bf16_f32 v30, v20, v21
  v_mfma_f32_16x16x32_bf16 v[136:139], v[72:75], v[248:251], v[136:139]
  buffer_load_dwordx4 v6, s[32:35], s26 offen offset:3072 sc1 lds
  v_cvt_pk_bf16_f32 v31, v22, v23
  v_mfma_f32_16x16x32_bf16 v[152:155], v[76:79], v[248:251], v[152:155]
  s_add_u32 s26, s26, 1024
  ds_read_b64_tr_b16 v[56:57], v12 offset:768
  buffer_store_dwordx4 v[28:31], v2, s[40:43], s64 offen offset:1024 sc1
  v_mfma_f32_16x16x32_bf16 v[168:171], v[80:83], v[248:251], v[168:171]
  ds_read_b64_tr_b16 v[58:59], v12 offset:1792
  v_mfma_f32_16x16x32_bf16 v[184:187], v[84:87], v[248:251], v[184:187]
  ds_read_b64_tr_b16 v[60:61], v13 offset:768
  v_mfma_f32_16x16x32_bf16 v[200:203], v[88:91], v[248:251], v[200:203]
  s_add_u32 m0, s24, 49152
  ds_read_b64_tr_b16 v[62:63], v13 offset:1792
  v_mfma_f32_16x16x32_bf16 v[216:219], v[92:95], v[248:251], v[216:219]
  buffer_load_dwordx4 v8, s[36:39], s27 offen offset:0 lds
  v_mfma_f32_16x16x32_bf16 v[108:111], v[64:67], v[252:255], v[108:111]
  ds_read_b128 v[232:235], v14 offset:2048
  v_mfma_f32_16x16x32_bf16 v[124:127], v[68:71], v[252:255], v[124:127]
  ds_read_b128 v[236:239], v14 offset:3072
  v_mfma_f32_16x16x32_bf16 v[140:143], v[72:75], v[252:255], v[140:143]
  v_mfma_f32_16x16x32_bf16 v[156:159], v[76:79], v[252:255], v[156:159]
  v_mfma_f32_16x16x32_bf16 v[172:175], v[80:83], v[252:255], v[172:175]
  buffer_load_dwordx4 v9, s[36:39], s27 offen offset:1024 lds
  v_mfma_f32_16x16x32_bf16 v[188:191], v[84:87], v[252:255], v[188:191]
  v_mfma_f32_16x16x32_bf16 v[204:207], v[88:91], v[252:255], v[204:207]
  v_mfma_f32_16x16x32_bf16 v[220:223], v[92:95], v[252:255], v[220:223]
  s_waitcnt vmcnt(17) lgkmcnt(0)
  v_mfma_f32_16x16x32_bf16 v[96:99], v[32:35], v[224:227], v[96:99]
  v_accvgpr_read_b32 v16, a240
  v_accvgpr_read_b32 v17, a241
  v_mfma_f32_16x16x32_bf16 v[112:115], v[36:39], v[224:227], v[112:115]
  ds_read_b64_tr_b16 v[64:65], v12 offset:8192
  v_accvgpr_read_b32 v18, a242
  v_mfma_f32_16x16x32_bf16 v[128:131], v[40:43], v[224:227], v[128:131]
  s_add_u32 m0, s24, 0
  ds_read_b64_tr_b16 v[66:67], v12 offset:9216
  v_accvgpr_read_b32 v19, a243
  v_mfma_f32_16x16x32_bf16 v[144:147], v[44:47], v[224:227], v[144:147]
  buffer_load_dwordx4 v3, s[32:35], s26 offen offset:0 sc1 lds
  v_accvgpr_read_b32 v20, a244
  v_mfma_f32_16x16x32_bf16 v[160:163], v[48:51], v[224:227], v[160:163]
  ds_read_b64_tr_b16 v[68:69], v13 offset:8192
  v_accvgpr_read_b32 v21, a245
  v_mfma_f32_16x16x32_bf16 v[176:179], v[52:55], v[224:227], v[176:179]
  ds_read_b64_tr_b16 v[70:71], v13 offset:9216
  v_accvgpr_read_b32 v22, a246
  v_mfma_f32_16x16x32_bf16 v[192:195], v[56:59], v[224:227], v[192:195]
  ds_read_b64_tr_b16 v[72:73], v12 offset:8448
  v_accvgpr_read_b32 v23, a247
  v_mfma_f32_16x16x32_bf16 v[208:211], v[60:63], v[224:227], v[208:211]
  ds_read_b64_tr_b16 v[74:75], v12 offset:9472
  v_mul_f32 v16, s76, v16
  v_mfma_f32_16x16x32_bf16 v[100:103], v[32:35], v[228:231], v[100:103]
  buffer_load_dwordx4 v4, s[32:35], s26 offen offset:1024 sc1 lds
  v_mul_f32 v17, s76, v17
  v_mfma_f32_16x16x32_bf16 v[116:119], v[36:39], v[228:231], v[116:119]
  ds_read_b64_tr_b16 v[76:77], v13 offset:8448
  v_mul_f32 v18, s76, v18
  v_mfma_f32_16x16x32_bf16 v[132:135], v[40:43], v[228:231], v[132:135]
  ds_read_b64_tr_b16 v[78:79], v13 offset:9472
  v_mul_f32 v19, s76, v19
  v_mfma_f32_16x16x32_bf16 v[148:151], v[44:47], v[228:231], v[148:151]
  ds_read_b128 v[240:243], v14 offset:32768
  v_mul_f32 v20, s76, v20
  v_mfma_f32_16x16x32_bf16 v[164:167], v[48:51], v[228:231], v[164:167]
  ds_read_b128 v[244:247], v14 offset:33792
  v_mul_f32 v21, s76, v21
  v_mfma_f32_16x16x32_bf16 v[180:183], v[52:55], v[228:231], v[180:183]
  buffer_load_dwordx4 v5, s[32:35], s26 offen offset:2048 sc1 lds
  v_mul_f32 v22, s76, v22
  v_mfma_f32_16x16x32_bf16 v[196:199], v[56:59], v[228:231], v[196:199]
  ds_read_b64_tr_b16 v[80:81], v12 offset:8704
  v_mul_f32 v23, s76, v23
  v_mfma_f32_16x16x32_bf16 v[212:215], v[60:63], v[228:231], v[212:215]
  ds_read_b64_tr_b16 v[82:83], v12 offset:9728
  v_cvt_pk_bf16_f32 v24, v16, v17
  v_mfma_f32_16x16x32_bf16 v[104:107], v[32:35], v[232:235], v[104:107]
  ds_read_b64_tr_b16 v[84:85], v13 offset:8704
  v_cvt_pk_bf16_f32 v25, v18, v19
  v_mfma_f32_16x16x32_bf16 v[120:123], v[36:39], v[232:235], v[120:123]
  ds_read_b64_tr_b16 v[86:87], v13 offset:9728
  v_cvt_pk_bf16_f32 v26, v20, v21
  v_mfma_f32_16x16x32_bf16 v[136:139], v[40:43], v[232:235], v[136:139]
  buffer_load_dwordx4 v6, s[32:35], s26 offen offset:3072 sc1 lds
  v_cvt_pk_bf16_f32 v27, v22, v23
  v_mfma_f32_16x16x32_bf16 v[152:155], v[44:47], v[232:235], v[152:155]
  s_add_u32 s26, s26, 1024
  ds_read_b64_tr_b16 v[88:89], v12 offset:8960
  buffer_store_dwordx4 v[24:27], v2, s[40:43], s64 offen offset:2048 sc1
  v_mfma_f32_16x16x32_bf16 v[168:171], v[48:51], v[232:235], v[168:171]
  ds_read_b64_tr_b16 v[90:91], v12 offset:9984
  v_mfma_f32_16x16x32_bf16 v[184:187], v[52:55], v[232:235], v[184:187]
  ds_read_b64_tr_b16 v[92:93], v13 offset:8960
  v_mfma_f32_16x16x32_bf16 v[200:203], v[56:59], v[232:235], v[200:203]
  s_add_u32 m0, s24, 49152
  ds_read_b64_tr_b16 v[94:95], v13 offset:9984
  v_mfma_f32_16x16x32_bf16 v[216:219], v[60:63], v[232:235], v[216:219]
  buffer_load_dwordx4 v10, s[36:39], s27 offen offset:2048 lds
  v_mfma_f32_16x16x32_bf16 v[108:111], v[32:35], v[236:239], v[108:111]
  ds_read_b128 v[248:251], v14 offset:34816
  v_mfma_f32_16x16x32_bf16 v[124:127], v[36:39], v[236:239], v[124:127]
  ds_read_b128 v[252:255], v14 offset:35840
  v_mfma_f32_16x16x32_bf16 v[140:143], v[40:43], v[236:239], v[140:143]
  v_mfma_f32_16x16x32_bf16 v[156:159], v[44:47], v[236:239], v[156:159]
  v_xor_b32 v14, 0x10000, v14
  v_mfma_f32_16x16x32_bf16 v[172:175], v[48:51], v[236:239], v[172:175]
  buffer_load_dwordx4 v11, s[36:39], s27 offen offset:3072 lds
  v_mfma_f32_16x16x32_bf16 v[188:191], v[52:55], v[236:239], v[188:191]
  s_add_u32 s27, s27, 524288
  v_mfma_f32_16x16x32_bf16 v[204:207], v[56:59], v[236:239], v[204:207]
  v_mfma_f32_16x16x32_bf16 v[220:223], v[60:63], v[236:239], v[220:223]
  s_waitcnt vmcnt(17) lgkmcnt(0)
  v_mfma_f32_16x16x32_bf16 v[96:99], v[64:67], v[240:243], v[96:99]
  s_barrier
  v_accvgpr_read_b32 v16, a248
  v_accvgpr_read_b32 v17, a249
  v_mfma_f32_16x16x32_bf16 v[112:115], v[68:71], v[240:243], v[112:115]
  ds_read_b64_tr_b16 v[32:33], v12 offset:32768
  v_accvgpr_read_b32 v18, a250
  v_mfma_f32_16x16x32_bf16 v[128:131], v[72:75], v[240:243], v[128:131]
  s_add_u32 m0, s24, 32768
  ds_read_b64_tr_b16 v[34:35], v12 offset:33792
  v_accvgpr_read_b32 v19, a251
  v_mfma_f32_16x16x32_bf16 v[144:147], v[76:79], v[240:243], v[144:147]
  buffer_load_dwordx4 v3, s[32:35], s26 offen offset:0 sc1 lds
  v_accvgpr_read_b32 v20, a252
  v_mfma_f32_16x16x32_bf16 v[160:163], v[80:83], v[240:243], v[160:163]
  ds_read_b64_tr_b16 v[36:37], v13 offset:32768
  v_accvgpr_read_b32 v21, a253
  v_mfma_f32_16x16x32_bf16 v[176:179], v[84:87], v[240:243], v[176:179]
  ds_read_b64_tr_b16 v[38:39], v13 offset:33792
  v_accvgpr_read_b32 v22, a254
  v_mfma_f32_16x16x32_bf16 v[192:195], v[88:91], v[240:243], v[192:195]
  ds_read_b64_tr_b16 v[40:41], v12 offset:33024
  v_accvgpr_read_b32 v23, a255
  v_mfma_f32_16x16x32_bf16 v[208:211], v[92:95], v[240:243], v[208:211]
  ds_read_b64_tr_b16 v[42:43], v12 offset:34048
  v_mul_f32 v16, s76, v16
  v_mfma_f32_16x16x32_bf16 v[100:103], v[64:67], v[244:247], v[100:103]
  buffer_load_dwordx4 v4, s[32:35], s26 offen offset:1024 sc1 lds
  v_mul_f32 v17, s76, v17
  v_mfma_f32_16x16x32_bf16 v[116:119], v[68:71], v[244:247], v[116:119]
  ds_read_b64_tr_b16 v[44:45], v13 offset:33024
  v_mul_f32 v18, s76, v18
  v_mfma_f32_16x16x32_bf16 v[132:135], v[72:75], v[244:247], v[132:135]
  ds_read_b64_tr_b16 v[46:47], v13 offset:34048
  v_mul_f32 v19, s76, v19
  v_mfma_f32_16x16x32_bf16 v[148:151], v[76:79], v[244:247], v[148:151]
  ds_read_b128 v[224:227], v14 offset:0
  v_mul_f32 v20, s76, v20
  v_mfma_f32_16x16x32_bf16 v[164:167], v[80:83], v[244:247], v[164:167]
  ds_read_b128 v[228:231], v14 offset:1024
  v_mul_f32 v21, s76, v21
  v_mfma_f32_16x16x32_bf16 v[180:183], v[84:87], v[244:247], v[180:183]
  buffer_load_dwordx4 v5, s[32:35], s26 offen offset:2048 sc1 lds
  v_mul_f32 v22, s76, v22
  v_mfma_f32_16x16x32_bf16 v[196:199], v[88:91], v[244:247], v[196:199]
  ds_read_b64_tr_b16 v[48:49], v12 offset:33280
  v_mul_f32 v23, s76, v23
  v_mfma_f32_16x16x32_bf16 v[212:215], v[92:95], v[244:247], v[212:215]
  ds_read_b64_tr_b16 v[50:51], v12 offset:34304
  v_cvt_pk_bf16_f32 v28, v16, v17
  v_mfma_f32_16x16x32_bf16 v[104:107], v[64:67], v[248:251], v[104:107]
  ds_read_b64_tr_b16 v[52:53], v13 offset:33280
  v_cvt_pk_bf16_f32 v29, v18, v19
  v_mfma_f32_16x16x32_bf16 v[120:123], v[68:71], v[248:251], v[120:123]
  ds_read_b64_tr_b16 v[54:55], v13 offset:34304
  v_cvt_pk_bf16_f32 v30, v20, v21
  v_mfma_f32_16x16x32_bf16 v[136:139], v[72:75], v[248:251], v[136:139]
  buffer_load_dwordx4 v6, s[32:35], s26 offen offset:3072 sc1 lds
  v_cvt_pk_bf16_f32 v31, v22, v23
  v_mfma_f32_16x16x32_bf16 v[152:155], v[76:79], v[248:251], v[152:155]
  s_add_u32 s26, s26, 1024
  ds_read_b64_tr_b16 v[56:57], v12 offset:33536
  buffer_store_dwordx4 v[28:31], v2, s[40:43], s64 offen offset:3072 sc1
  v_mfma_f32_16x16x32_bf16 v[168:171], v[80:83], v[248:251], v[168:171]
  ds_read_b64_tr_b16 v[58:59], v12 offset:34560
  v_mfma_f32_16x16x32_bf16 v[184:187], v[84:87], v[248:251], v[184:187]
  ds_read_b64_tr_b16 v[60:61], v13 offset:33536
  v_mfma_f32_16x16x32_bf16 v[200:203], v[88:91], v[248:251], v[200:203]
  s_add_u32 m0, s24, 81920
  ds_read_b64_tr_b16 v[62:63], v13 offset:34560
  v_mfma_f32_16x16x32_bf16 v[216:219], v[92:95], v[248:251], v[216:219]
  buffer_load_dwordx4 v8, s[36:39], s27 offen offset:0 lds
  v_mfma_f32_16x16x32_bf16 v[108:111], v[64:67], v[252:255], v[108:111]
  ds_read_b128 v[232:235], v14 offset:2048
  v_mfma_f32_16x16x32_bf16 v[124:127], v[68:71], v[252:255], v[124:127]
  ds_read_b128 v[236:239], v14 offset:3072
  v_mfma_f32_16x16x32_bf16 v[140:143], v[72:75], v[252:255], v[140:143]
  v_mfma_f32_16x16x32_bf16 v[156:159], v[76:79], v[252:255], v[156:159]
  v_mfma_f32_16x16x32_bf16 v[172:175], v[80:83], v[252:255], v[172:175]
  buffer_load_dwordx4 v9, s[36:39], s27 offen offset:1024 lds
  v_mfma_f32_16x16x32_bf16 v[188:191], v[84:87], v[252:255], v[188:191]
  v_mfma_f32_16x16x32_bf16 v[204:207], v[88:91], v[252:255], v[204:207]
  v_mfma_f32_16x16x32_bf16 v[220:223], v[92:95], v[252:255], v[220:223]
  s_waitcnt vmcnt(17) lgkmcnt(0)
  v_mfma_f32_16x16x32_bf16 v[96:99], v[32:35], v[224:227], v[96:99]
  s_add_u32 s64, s64, 126976
  v_accvgpr_read_b32 v16, a0
  v_accvgpr_read_b32 v17, a1
  v_mfma_f32_16x16x32_bf16 v[112:115], v[36:39], v[224:227], v[112:115]
  ds_read_b64_tr_b16 v[64:65], v12 offset:40960
  v_accvgpr_read_b32 v18, a2
  v_mfma_f32_16x16x32_bf16 v[128:131], v[40:43], v[224:227], v[128:131]
  s_add_u32 m0, s24, 65536
  ds_read_b64_tr_b16 v[66:67], v12 offset:41984
  v_accvgpr_read_b32 v19, a3
  v_mfma_f32_16x16x32_bf16 v[144:147], v[44:47], v[224:227], v[144:147]
  buffer_load_dwordx4 v3, s[32:35], s26 offen offset:0 sc1 lds
  v_accvgpr_read_b32 v20, a4
  v_mfma_f32_16x16x32_bf16 v[160:163], v[48:51], v[224:227], v[160:163]
  ds_read_b64_tr_b16 v[68:69], v13 offset:40960
  v_accvgpr_read_b32 v21, a5
  v_mfma_f32_16x16x32_bf16 v[176:179], v[52:55], v[224:227], v[176:179]
  ds_read_b64_tr_b16 v[70:71], v13 offset:41984
  v_accvgpr_read_b32 v22, a6
  v_mfma_f32_16x16x32_bf16 v[192:195], v[56:59], v[224:227], v[192:195]
  ds_read_b64_tr_b16 v[72:73], v12 offset:41216
  v_accvgpr_read_b32 v23, a7
  v_mfma_f32_16x16x32_bf16 v[208:211], v[60:63], v[224:227], v[208:211]
  ds_read_b64_tr_b16 v[74:75], v12 offset:42240
  v_mul_f32 v16, s76, v16
  v_mfma_f32_16x16x32_bf16 v[100:103], v[32:35], v[228:231], v[100:103]
  buffer_load_dwordx4 v4, s[32:35], s26 offen offset:1024 sc1 lds
  v_mul_f32 v17, s76, v17
  v_mfma_f32_16x16x32_bf16 v[116:119], v[36:39], v[228:231], v[116:119]
  ds_read_b64_tr_b16 v[76:77], v13 offset:41216
  v_mul_f32 v18, s76, v18
  v_mfma_f32_16x16x32_bf16 v[132:135], v[40:43], v[228:231], v[132:135]
  ds_read_b64_tr_b16 v[78:79], v13 offset:42240
  v_mul_f32 v19, s76, v19
  v_mfma_f32_16x16x32_bf16 v[148:151], v[44:47], v[228:231], v[148:151]
  ds_read_b128 v[240:243], v14 offset:32768
  v_mul_f32 v20, s76, v20
  v_mfma_f32_16x16x32_bf16 v[164:167], v[48:51], v[228:231], v[164:167]
  ds_read_b128 v[244:247], v14 offset:33792
  v_mul_f32 v21, s76, v21
  v_mfma_f32_16x16x32_bf16 v[180:183], v[52:55], v[228:231], v[180:183]
  buffer_load_dwordx4 v5, s[32:35], s26 offen offset:2048 sc1 lds
  v_mul_f32 v22, s76, v22
  v_mfma_f32_16x16x32_bf16 v[196:199], v[56:59], v[228:231], v[196:199]
  ds_read_b64_tr_b16 v[80:81], v12 offset:41472
  v_mul_f32 v23, s76, v23
  v_mfma_f32_16x16x32_bf16 v[212:215], v[60:63], v[228:231], v[212:215]
  ds_read_b64_tr_b16 v[82:83], v12 offset:42496
  v_cvt_pk_bf16_f32 v24, v16, v17
  v_mfma_f32_16x16x32_bf16 v[104:107], v[32:35], v[232:235], v[104:107]
  ds_read_b64_tr_b16 v[84:85], v13 offset:41472
  v_cvt_pk_bf16_f32 v25, v18, v19
  v_mfma_f32_16x16x32_bf16 v[120:123], v[36:39], v[232:235], v[120:123]
  ds_read_b64_tr_b16 v[86:87], v13 offset:42496
  v_cvt_pk_bf16_f32 v26, v20, v21
  v_mfma_f32_16x16x32_bf16 v[136:139], v[40:43], v[232:235], v[136:139]
  buffer_load_dwordx4 v6, s[32:35], s26 offen offset:3072 sc1 lds
  v_cvt_pk_bf16_f32 v27, v22, v23
  v_mfma_f32_16x16x32_bf16 v[152:155], v[44:47], v[232:235], v[152:155]
  s_add_u32 s26, s26, 1024
  ds_read_b64_tr_b16 v[88:89], v12 offset:41728
  buffer_store_dwordx4 v[24:27], v2, s[40:43], s64 offen offset:0 sc1
  v_mfma_f32_16x16x32_bf16 v[168:171], v[48:51], v[232:235], v[168:171]
  ds_read_b64_tr_b16 v[90:91], v12 offset:42752
  v_accvgpr_write_b32 a0, 0
  v_mfma_f32_16x16x32_bf16 v[184:187], v[52:55], v[232:235], v[184:187]
  ds_read_b64_tr_b16 v[92:93], v13 offset:41728
  v_accvgpr_write_b32 a1, 0
  v_mfma_f32_16x16x32_bf16 v[200:203], v[56:59], v[232:235], v[200:203]
  s_add_u32 m0, s24, 81920
  ds_read_b64_tr_b16 v[94:95], v13 offset:42752
  v_accvgpr_write_b32 a2, 0
  v_mfma_f32_16x16x32_bf16 v[216:219], v[60:63], v[232:235], v[216:219]
  buffer_load_dwordx4 v10, s[36:39], s27 offen offset:2048 lds
  v_accvgpr_write_b32 a3, 0
  v_mfma_f32_16x16x32_bf16 v[108:111], v[32:35], v[236:239], v[108:111]
  ds_read_b128 v[248:251], v14 offset:34816
  v_accvgpr_write_b32 a4, 0
  v_mfma_f32_16x16x32_bf16 v[124:127], v[36:39], v[236:239], v[124:127]
  ds_read_b128 v[252:255], v14 offset:35840
  v_accvgpr_write_b32 a5, 0
  v_mfma_f32_16x16x32_bf16 v[140:143], v[40:43], v[236:239], v[140:143]
  v_accvgpr_write_b32 a6, 0
  v_accvgpr_write_b32 a7, 0
  v_mfma_f32_16x16x32_bf16 v[156:159], v[44:47], v[236:239], v[156:159]
  v_xor_b32 v14, 0x10000, v14
  v_mfma_f32_16x16x32_bf16 v[172:175], v[48:51], v[236:239], v[172:175]
  buffer_load_dwordx4 v11, s[36:39], s27 offen offset:3072 lds
  v_mfma_f32_16x16x32_bf16 v[188:191], v[52:55], v[236:239], v[188:191]
  s_add_u32 s27, s27, 524288
  v_xor_b32 v12, 0x10000, v12
  v_mfma_f32_16x16x32_bf16 v[204:207], v[56:59], v[236:239], v[204:207]
  v_xor_b32 v13, 0x10000, v13
  v_mfma_f32_16x16x32_bf16 v[220:223], v[60:63], v[236:239], v[220:223]
  s_waitcnt vmcnt(9) lgkmcnt(0)
  v_mfma_f32_16x16x32_bf16 v[96:99], v[64:67], v[240:243], v[96:99]
  s_barrier
  buffer_store_dword v12, off, s[40:43], s65 sc1
  v_accvgpr_read_b32 v16, a8
  v_mfma_f32_16x16x32_bf16 v[112:115], v[68:71], v[240:243], v[112:115]
  ds_read_b64_tr_b16 v[32:33], v12 offset:0
  v_accvgpr_read_b32 v17, a9
  v_mfma_f32_16x16x32_bf16 v[128:131], v[72:75], v[240:243], v[128:131]
  s_add_u32 m0, s24, 98304
  ds_read_b64_tr_b16 v[34:35], v12 offset:1024
  v_accvgpr_read_b32 v18, a10
  v_mfma_f32_16x16x32_bf16 v[144:147], v[76:79], v[240:243], v[144:147]
  buffer_load_dwordx4 v3, s[32:35], s26 offen offset:0 sc1 lds
  v_accvgpr_read_b32 v19, a11
  v_mfma_f32_16x16x32_bf16 v[160:163], v[80:83], v[240:243], v[160:163]
  ds_read_b64_tr_b16 v[36:37], v13 offset:0
  v_accvgpr_read_b32 v20, a12
  v_mfma_f32_16x16x32_bf16 v[176:179], v[84:87], v[240:243], v[176:179]
  ds_read_b64_tr_b16 v[38:39], v13 offset:1024
  v_accvgpr_read_b32 v21, a13
  v_mfma_f32_16x16x32_bf16 v[192:195], v[88:91], v[240:243], v[192:195]
  ds_read_b64_tr_b16 v[40:41], v12 offset:256
  v_accvgpr_read_b32 v22, a14
  v_mfma_f32_16x16x32_bf16 v[208:211], v[92:95], v[240:243], v[208:211]
  ds_read_b64_tr_b16 v[42:43], v12 offset:1280
  v_accvgpr_read_b32 v23, a15
  v_mfma_f32_16x16x32_bf16 v[100:103], v[64:67], v[244:247], v[100:103]
  buffer_load_dwordx4 v4, s[32:35], s26 offen offset:1024 sc1 lds
  v_mul_f32 v16, s76, v16
  v_mfma_f32_16x16x32_bf16 v[116:119], v[68:71], v[244:247], v[116:119]
  ds_read_b64_tr_b16 v[44:45], v13 offset:256
  v_mul_f32 v17, s76, v17
  v_mfma_f32_16x16x32_bf16 v[132:135], v[72:75], v[244:247], v[132:135]
  ds_read_b64_tr_b16 v[46:47], v13 offset:1280
  v_mul_f32 v18, s76, v18
  v_mfma_f32_16x16x32_bf16 v[148:151], v[76:79], v[244:247], v[148:151]
  ds_read_b128 v[224:227], v14 offset:0
  v_mul_f32 v19, s76, v19
  v_mfma_f32_16x16x32_bf16 v[164:167], v[80:83], v[244:247], v[164:167]
  ds_read_b128 v[228:231], v14 offset:1024
  v_mul_f32 v20, s76, v20
  v_mfma_f32_16x16x32_bf16 v[180:183], v[84:87], v[244:247], v[180:183]
  buffer_load_dwordx4 v5, s[32:35], s26 offen offset:2048 sc1 lds
  v_mul_f32 v21, s76, v21
  v_mfma_f32_16x16x32_bf16 v[196:199], v[88:91], v[244:247], v[196:199]
  ds_read_b64_tr_b16 v[48:49], v12 offset:512
  v_mul_f32 v22, s76, v22
  v_mfma_f32_16x16x32_bf16 v[212:215], v[92:95], v[244:247], v[212:215]
  ds_read_b64_tr_b16 v[50:51], v12 offset:1536
  v_mul_f32 v23, s76, v23
  v_mfma_f32_16x16x32_bf16 v[104:107], v[64:67], v[248:251], v[104:107]
  ds_read_b64_tr_b16 v[52:53], v13 offset:512
  v_cvt_pk_bf16_f32 v28, v16, v17
  v_mfma_f32_16x16x32_bf16 v[120:123], v[68:71], v[248:251], v[120:123]
  ds_read_b64_tr_b16 v[54:55], v13 offset:1536
  v_cvt_pk_bf16_f32 v29, v18, v19
  v_mfma_f32_16x16x32_bf16 v[136:139], v[72:75], v[248:251], v[136:139]
  buffer_load_dwordx4 v6, s[32:35], s26 offen offset:3072 sc1 lds
  v_cvt_pk_bf16_f32 v30, v20, v21
  v_mfma_f32_16x16x32_bf16 v[152:155], v[76:79], v[248:251], v[152:155]
  s_add_u32 s26, s26, 1024
  ds_read_b64_tr_b16 v[56:57], v12 offset:768
  v_cvt_pk_bf16_f32 v31, v22, v23
  v_mfma_f32_16x16x32_bf16 v[168:171], v[80:83], v[248:251], v[168:171]
  ds_read_b64_tr_b16 v[58:59], v12 offset:1792
  buffer_store_dwordx4 v[28:31], v2, s[40:43], s64 offen offset:1024 sc1
  v_mfma_f32_16x16x32_bf16 v[184:187], v[84:87], v[248:251], v[184:187]
  ds_read_b64_tr_b16 v[60:61], v13 offset:768
  v_accvgpr_write_b32 a8, 0
  v_mfma_f32_16x16x32_bf16 v[200:203], v[88:91], v[248:251], v[200:203]
  s_add_u32 m0, s24, 114688
  ds_read_b64_tr_b16 v[62:63], v13 offset:1792
  v_accvgpr_write_b32 a9, 0
  v_mfma_f32_16x16x32_bf16 v[216:219], v[92:95], v[248:251], v[216:219]
  buffer_load_dwordx4 v8, s[36:39], s27 offen offset:0 lds
  v_accvgpr_write_b32 a10, 0
  v_mfma_f32_16x16x32_bf16 v[108:111], v[64:67], v[252:255], v[108:111]
  ds_read_b128 v[232:235], v14 offset:2048
  v_accvgpr_write_b32 a11, 0
  v_mfma_f32_16x16x32_bf16 v[124:127], v[68:71], v[252:255], v[124:127]
  ds_read_b128 v[236:239], v14 offset:3072
  v_accvgpr_write_b32 a12, 0
  v_mfma_f32_16x16x32_bf16 v[140:143], v[72:75], v[252:255], v[140:143]
  v_accvgpr_write_b32 a13, 0
  v_accvgpr_write_b32 a14, 0
  v_mfma_f32_16x16x32_bf16 v[156:159], v[76:79], v[252:255], v[156:159]
  v_accvgpr_write_b32 a15, 0
  v_mfma_f32_16x16x32_bf16 v[172:175], v[80:83], v[252:255], v[172:175]
  buffer_load_dwordx4 v9, s[36:39], s27 offen offset:1024 lds
  v_mfma_f32_16x16x32_bf16 v[188:191], v[84:87], v[252:255], v[188:191]
  v_mfma_f32_16x16x32_bf16 v[204:207], v[88:91], v[252:255], v[204:207]
  v_mfma_f32_16x16x32_bf16 v[220:223], v[92:95], v[252:255], v[220:223]
  s_waitcnt vmcnt(18) lgkmcnt(0)
  v_mfma_f32_16x16x32_bf16 v[96:99], v[32:35], v[224:227], v[96:99]
  v_accvgpr_read_b32 v16, a16
  v_accvgpr_read_b32 v17, a17
  v_mfma_f32_16x16x32_bf16 v[112:115], v[36:39], v[224:227], v[112:115]
  ds_read_b64_tr_b16 v[64:65], v12 offset:8192
  v_accvgpr_read_b32 v18, a18
  v_mfma_f32_16x16x32_bf16 v[128:131], v[40:43], v[224:227], v[128:131]
  s_add_u32 m0, s24, 0
  ds_read_b64_tr_b16 v[66:67], v12 offset:9216
  v_accvgpr_read_b32 v19, a19
  v_mfma_f32_16x16x32_bf16 v[144:147], v[44:47], v[224:227], v[144:147]
  buffer_load_dwordx4 v3, s[32:35], s26 offen offset:0 sc1 lds
  v_accvgpr_read_b32 v20, a20
  v_mfma_f32_16x16x32_bf16 v[160:163], v[48:51], v[224:227], v[160:163]
  ds_read_b64_tr_b16 v[68:69], v13 offset:8192
  v_accvgpr_read_b32 v21, a21
  v_mfma_f32_16x16x32_bf16 v[176:179], v[52:55], v[224:227], v[176:179]
  ds_read_b64_tr_b16 v[70:71], v13 offset:9216
  v_accvgpr_read_b32 v22, a22
  v_mfma_f32_16x16x32_bf16 v[192:195], v[56:59], v[224:227], v[192:195]
  ds_read_b64_tr_b16 v[72:73], v12 offset:8448
  v_accvgpr_read_b32 v23, a23
  v_mfma_f32_16x16x32_bf16 v[208:211], v[60:63], v[224:227], v[208:211]
  ds_read_b64_tr_b16 v[74:75], v12 offset:9472
  v_mul_f32 v16, s76, v16
  v_mfma_f32_16x16x32_bf16 v[100:103], v[32:35], v[228:231], v[100:103]
  buffer_load_dwordx4 v4, s[32:35], s26 offen offset:1024 sc1 lds
  v_mul_f32 v17, s76, v17
  v_mfma_f32_16x16x32_bf16 v[116:119], v[36:39], v[228:231], v[116:119]
  ds_read_b64_tr_b16 v[76:77], v13 offset:8448
  v_mul_f32 v18, s76, v18
  v_mfma_f32_16x16x32_bf16 v[132:135], v[40:43], v[228:231], v[132:135]
  ds_read_b64_tr_b16 v[78:79], v13 offset:9472
  v_mul_f32 v19, s76, v19
  v_mfma_f32_16x16x32_bf16 v[148:151], v[44:47], v[228:231], v[148:151]
  ds_read_b128 v[240:243], v14 offset:32768
  v_mul_f32 v20, s76, v20
  v_mfma_f32_16x16x32_bf16 v[164:167], v[48:51], v[228:231], v[164:167]
  ds_read_b128 v[244:247], v14 offset:33792
  v_mul_f32 v21, s76, v21
  v_mfma_f32_16x16x32_bf16 v[180:183], v[52:55], v[228:231], v[180:183]
  buffer_load_dwordx4 v5, s[32:35], s26 offen offset:2048 sc1 lds
  v_mul_f32 v22, s76, v22
  v_mfma_f32_16x16x32_bf16 v[196:199], v[56:59], v[228:231], v[196:199]
  ds_read_b64_tr_b16 v[80:81], v12 offset:8704
  v_mul_f32 v23, s76, v23
  v_mfma_f32_16x16x32_bf16 v[212:215], v[60:63], v[228:231], v[212:215]
  ds_read_b64_tr_b16 v[82:83], v12 offset:9728
  v_cvt_pk_bf16_f32 v24, v16, v17
  v_mfma_f32_16x16x32_bf16 v[104:107], v[32:35], v[232:235], v[104:107]
  ds_read_b64_tr_b16 v[84:85], v13 offset:8704
  v_cvt_pk_bf16_f32 v25, v18, v19
  v_mfma_f32_16x16x32_bf16 v[120:123], v[36:39], v[232:235], v[120:123]
  ds_read_b64_tr_b16 v[86:87], v13 offset:9728
  v_cvt_pk_bf16_f32 v26, v20, v21
  v_mfma_f32_16x16x32_bf16 v[136:139], v[40:43], v[232:235], v[136:139]
  buffer_load_dwordx4 v6, s[32:35], s26 offen offset:3072 sc1 lds
  v_cvt_pk_bf16_f32 v27, v22, v23
  v_mfma_f32_16x16x32_bf16 v[152:155], v[44:47], v[232:235], v[152:155]
  s_add_u32 s26, s26, 1024
  ds_read_b64_tr_b16 v[88:89], v12 offset:8960
  buffer_store_dwordx4 v[24:27], v2, s[40:43], s64 offen offset:2048 sc1
  v_mfma_f32_16x16x32_bf16 v[168:171], v[48:51], v[232:235], v[168:171]
  ds_read_b64_tr_b16 v[90:91], v12 offset:9984
  v_accvgpr_write_b32 a16, 0
  v_mfma_f32_16x16x32_bf16 v[184:187], v[52:55], v[232:235], v[184:187]
  ds_read_b64_tr_b16 v[92:93], v13 offset:8960
  v_accvgpr_write_b32 a17, 0
  v_mfma_f32_16x16x32_bf16 v[200:203], v[56:59], v[232:235], v[200:203]
  s_add_u32 m0, s24, 114688
  ds_read_b64_tr_b16 v[94:95], v13 offset:9984
  v_accvgpr_write_b32 a18, 0
  v_mfma_f32_16x16x32_bf16 v[216:219], v[60:63], v[232:235], v[216:219]
  buffer_load_dwordx4 v10, s[36:39], s27 offen offset:2048 lds
  v_accvgpr_write_b32 a19, 0
  v_mfma_f32_16x16x32_bf16 v[108:111], v[32:35], v[236:239], v[108:111]
  ds_read_b128 v[248:251], v14 offset:34816
  v_accvgpr_write_b32 a20, 0
  v_mfma_f32_16x16x32_bf16 v[124:127], v[36:39], v[236:239], v[124:127]
  ds_read_b128 v[252:255], v14 offset:35840
  v_accvgpr_write_b32 a21, 0
  v_mfma_f32_16x16x32_bf16 v[140:143], v[40:43], v[236:239], v[140:143]
  v_accvgpr_write_b32 a22, 0
  v_accvgpr_write_b32 a23, 0
  v_mfma_f32_16x16x32_bf16 v[156:159], v[44:47], v[236:239], v[156:159]
  v_xor_b32 v14, 0x10000, v14
  v_mfma_f32_16x16x32_bf16 v[172:175], v[48:51], v[236:239], v[172:175]
  buffer_load_dwordx4 v11, s[36:39], s27 offen offset:3072 lds
  v_mfma_f32_16x16x32_bf16 v[188:191], v[52:55], v[236:239], v[188:191]
  s_add_u32 s27, s27, 524288
  v_mfma_f32_16x16x32_bf16 v[204:207], v[56:59], v[236:239], v[204:207]
  v_mfma_f32_16x16x32_bf16 v[220:223], v[60:63], v[236:239], v[220:223]
  s_waitcnt vmcnt(18) lgkmcnt(0)
  v_mfma_f32_16x16x32_bf16 v[96:99], v[64:67], v[240:243], v[96:99]
  s_barrier
  v_accvgpr_read_b32 v16, a24
  v_accvgpr_read_b32 v17, a25
  v_mfma_f32_16x16x32_bf16 v[112:115], v[68:71], v[240:243], v[112:115]
  ds_read_b64_tr_b16 v[32:33], v12 offset:32768
  v_accvgpr_read_b32 v18, a26
  v_mfma_f32_16x16x32_bf16 v[128:131], v[72:75], v[240:243], v[128:131]
  s_add_u32 m0, s24, 32768
  ds_read_b64_tr_b16 v[34:35], v12 offset:33792
  v_accvgpr_read_b32 v19, a27
  v_mfma_f32_16x16x32_bf16 v[144:147], v[76:79], v[240:243], v[144:147]
  buffer_load_dwordx4 v3, s[32:35], s26 offen offset:0 sc1 lds
  v_accvgpr_read_b32 v20, a28
  v_mfma_f32_16x16x32_bf16 v[160:163], v[80:83], v[240:243], v[160:163]
  ds_read_b64_tr_b16 v[36:37], v13 offset:32768
  v_accvgpr_read_b32 v21, a29
  v_mfma_f32_16x16x32_bf16 v[176:179], v[84:87], v[240:243], v[176:179]
  ds_read_b64_tr_b16 v[38:39], v13 offset:33792
  v_accvgpr_read_b32 v22, a30
  v_mfma_f32_16x16x32_bf16 v[192:195], v[88:91], v[240:243], v[192:195]
  ds_read_b64_tr_b16 v[40:41], v12 offset:33024
  v_accvgpr_read_b32 v23, a31
  v_mfma_f32_16x16x32_bf16 v[208:211], v[92:95], v[240:243], v[208:211]
  ds_read_b64_tr_b16 v[42:43], v12 offset:34048
  v_mul_f32 v16, s76, v16
  v_mfma_f32_16x16x32_bf16 v[100:103], v[64:67], v[244:247], v[100:103]
  buffer_load_dwordx4 v4, s[32:35], s26 offen offset:1024 sc1 lds
  v_mul_f32 v17, s76, v17
  v_mfma_f32_16x16x32_bf16 v[116:119], v[68:71], v[244:247], v[116:119]
  ds_read_b64_tr_b16 v[44:45], v13 offset:33024
  v_mul_f32 v18, s76, v18
  v_mfma_f32_16x16x32_bf16 v[132:135], v[72:75], v[244:247], v[132:135]
  ds_read_b64_tr_b16 v[46:47], v13 offset:34048
  v_mul_f32 v19, s76, v19
  v_mfma_f32_16x16x32_bf16 v[148:151], v[76:79], v[244:247], v[148:151]
  ds_read_b128 v[224:227], v14 offset:0
  v_mul_f32 v20, s76, v20
  v_mfma_f32_16x16x32_bf16 v[164:167], v[80:83], v[244:247], v[164:167]
  ds_read_b128 v[228:231], v14 offset:1024
  v_mul_f32 v21, s76, v21
  v_mfma_f32_16x16x32_bf16 v[180:183], v[84:87], v[244:247], v[180:183]
  buffer_load_dwordx4 v5, s[32:35], s26 offen offset:2048 sc1 lds
  v_mul_f32 v22, s76, v22
  v_mfma_f32_16x16x32_bf16 v[196:199], v[88:91], v[244:247], v[196:199]
  ds_read_b64_tr_b16 v[48:49], v12 offset:33280
  v_mul_f32 v23, s76, v23
  v_mfma_f32_16x16x32_bf16 v[212:215], v[92:95], v[244:247], v[212:215]
  ds_read_b64_tr_b16 v[50:51], v12 offset:34304
  v_cvt_pk_bf16_f32 v28, v16, v17
  v_mfma_f32_16x16x32_bf16 v[104:107], v[64:67], v[248:251], v[104:107]
  ds_read_b64_tr_b16 v[52:53], v13 offset:33280
  v_cvt_pk_bf16_f32 v29, v18, v19
  v_mfma_f32_16x16x32_bf16 v[120:123], v[68:71], v[248:251], v[120:123]
  ds_read_b64_tr_b16 v[54:55], v13 offset:34304
  v_cvt_pk_bf16_f32 v30, v20, v21
  v_mfma_f32_16x16x32_bf16 v[136:139], v[72:75], v[248:251], v[136:139]
  buffer_load_dwordx4 v6, s[32:35], s26 offen offset:3072 sc1 lds
  v_cvt_pk_bf16_f32 v31, v22, v23
  v_mfma_f32_16x16x32_bf16 v[152:155], v[76:79], v[248:251], v[152:155]
  s_add_u32 s26, s26, 1024
  ds_read_b64_tr_b16 v[56:57], v12 offset:33536
  buffer_store_dwordx4 v[28:31], v2, s[40:43], s64 offen offset:3072 sc1
  v_mfma_f32_16x16x32_bf16 v[168:171], v[80:83], v[248:251], v[168:171]
  ds_read_b64_tr_b16 v[58:59], v12 offset:34560
  v_accvgpr_write_b32 a24, 0
  v_mfma_f32_16x16x32_bf16 v[184:187], v[84:87], v[248:251], v[184:187]
  ds_read_b64_tr_b16 v[60:61], v13 offset:33536
  v_accvgpr_write_b32 a25, 0
  v_mfma_f32_16x16x32_bf16 v[200:203], v[88:91], v[248:251], v[200:203]
  s_add_u32 m0, s24, 16384
  ds_read_b64_tr_b16 v[62:63], v13 offset:34560
  v_accvgpr_write_b32 a26, 0
  v_mfma_f32_16x16x32_bf16 v[216:219], v[92:95], v[248:251], v[216:219]
  buffer_load_dwordx4 v8, s[36:39], s27 offen offset:0 lds
  v_accvgpr_write_b32 a27, 0
  v_mfma_f32_16x16x32_bf16 v[108:111], v[64:67], v[252:255], v[108:111]
  ds_read_b128 v[232:235], v14 offset:2048
  v_accvgpr_write_b32 a28, 0
  v_mfma_f32_16x16x32_bf16 v[124:127], v[68:71], v[252:255], v[124:127]
  ds_read_b128 v[236:239], v14 offset:3072
  v_accvgpr_write_b32 a29, 0
  v_mfma_f32_16x16x32_bf16 v[140:143], v[72:75], v[252:255], v[140:143]
  v_accvgpr_write_b32 a30, 0
  v_accvgpr_write_b32 a31, 0
  v_mfma_f32_16x16x32_bf16 v[156:159], v[76:79], v[252:255], v[156:159]
  v_mfma_f32_16x16x32_bf16 v[172:175], v[80:83], v[252:255], v[172:175]
  buffer_load_dwordx4 v9, s[36:39], s27 offen offset:1024 lds
  v_mfma_f32_16x16x32_bf16 v[188:191], v[84:87], v[252:255], v[188:191]
  v_mfma_f32_16x16x32_bf16 v[204:207], v[88:91], v[252:255], v[204:207]
  v_mfma_f32_16x16x32_bf16 v[220:223], v[92:95], v[252:255], v[220:223]
  s_waitcnt vmcnt(17) lgkmcnt(0)
  v_mfma_f32_16x16x32_bf16 v[96:99], v[32:35], v[224:227], v[96:99]
  s_add_u32 s64, s64, 4096
  v_accvgpr_read_b32 v16, a32
  v_accvgpr_read_b32 v17, a33
  v_mfma_f32_16x16x32_bf16 v[112:115], v[36:39], v[224:227], v[112:115]
  ds_read_b64_tr_b16 v[64:65], v12 offset:40960
  v_accvgpr_read_b32 v18, a34
  v_mfma_f32_16x16x32_bf16 v[128:131], v[40:43], v[224:227], v[128:131]
  s_add_u32 m0, s24, 65536
  ds_read_b64_tr_b16 v[66:67], v12 offset:41984
  v_accvgpr_read_b32 v19, a35
  v_mfma_f32_16x16x32_bf16 v[144:147], v[44:47], v[224:227], v[144:147]
  buffer_load_dwordx4 v3, s[32:35], s26 offen offset:0 sc1 lds
  v_accvgpr_read_b32 v20, a36
  v_mfma_f32_16x16x32_bf16 v[160:163], v[48:51], v[224:227], v[160:163]
  ds_read_b64_tr_b16 v[68:69], v13 offset:40960
  v_accvgpr_read_b32 v21, a37
  v_mfma_f32_16x16x32_bf16 v[176:179], v[52:55], v[224:227], v[176:179]
  ds_read_b64_tr_b16 v[70:71], v13 offset:41984
  v_accvgpr_read_b32 v22, a38
  v_mfma_f32_16x16x32_bf16 v[192:195], v[56:59], v[224:227], v[192:195]
  ds_read_b64_tr_b16 v[72:73], v12 offset:41216
  v_accvgpr_read_b32 v23, a39
  v_mfma_f32_16x16x32_bf16 v[208:211], v[60:63], v[224:227], v[208:211]
  ds_read_b64_tr_b16 v[74:75], v12 offset:42240
  v_mul_f32 v16, s76, v16
  v_mfma_f32_16x16x32_bf16 v[100:103], v[32:35], v[228:231], v[100:103]
  buffer_load_dwordx4 v4, s[32:35], s26 offen offset:1024 sc1 lds
  v_mul_f32 v17, s76, v17
  v_mfma_f32_16x16x32_bf16 v[116:119], v[36:39], v[228:231], v[116:119]
  ds_read_b64_tr_b16 v[76:77], v13 offset:41216
  v_mul_f32 v18, s76, v18
  v_mfma_f32_16x16x32_bf16 v[132:135], v[40:43], v[228:231], v[132:135]
  ds_read_b64_tr_b16 v[78:79], v13 offset:42240
  v_mul_f32 v19, s76, v19
  v_mfma_f32_16x16x32_bf16 v[148:151], v[44:47], v[228:231], v[148:151]
  ds_read_b128 v[240:243], v14 offset:32768
  v_mul_f32 v20, s76, v20
  v_mfma_f32_16x16x32_bf16 v[164:167], v[48:51], v[228:231], v[164:167]
  ds_read_b128 v[244:247], v14 offset:33792
  v_mul_f32 v21, s76, v21
  v_mfma_f32_16x16x32_bf16 v[180:183], v[52:55], v[228:231], v[180:183]
  buffer_load_dwordx4 v5, s[32:35], s26 offen offset:2048 sc1 lds
  v_mul_f32 v22, s76, v22
  v_mfma_f32_16x16x32_bf16 v[196:199], v[56:59], v[228:231], v[196:199]
  ds_read_b64_tr_b16 v[80:81], v12 offset:41472
  v_mul_f32 v23, s76, v23
  v_mfma_f32_16x16x32_bf16 v[212:215], v[60:63], v[228:231], v[212:215]
  ds_read_b64_tr_b16 v[82:83], v12 offset:42496
  v_cvt_pk_bf16_f32 v24, v16, v17
  v_mfma_f32_16x16x32_bf16 v[104:107], v[32:35], v[232:235], v[104:107]
  ds_read_b64_tr_b16 v[84:85], v13 offset:41472
  v_cvt_pk_bf16_f32 v25, v18, v19
  v_mfma_f32_16x16x32_bf16 v[120:123], v[36:39], v[232:235], v[120:123]
  ds_read_b64_tr_b16 v[86:87], v13 offset:42496
  v_cvt_pk_bf16_f32 v26, v20, v21
  v_mfma_f32_16x16x32_bf16 v[136:139], v[40:43], v[232:235], v[136:139]
  buffer_load_dwordx4 v6, s[32:35], s26 offen offset:3072 sc1 lds
  v_cvt_pk_bf16_f32 v27, v22, v23
  v_mfma_f32_16x16x32_bf16 v[152:155], v[44:47], v[232:235], v[152:155]
  s_add_u32 s26, s26, 1024
  ds_read_b64_tr_b16 v[88:89], v12 offset:41728
  buffer_store_dwordx4 v[24:27], v2, s[40:43], s64 offen offset:0 sc1
  v_mfma_f32_16x16x32_bf16 v[168:171], v[48:51], v[232:235], v[168:171]
  ds_read_b64_tr_b16 v[90:91], v12 offset:42752
  v_accvgpr_write_b32 a32, 0
  v_mfma_f32_16x16x32_bf16 v[184:187], v[52:55], v[232:235], v[184:187]
  ds_read_b64_tr_b16 v[92:93], v13 offset:41728
  v_accvgpr_write_b32 a33, 0
  v_mfma_f32_16x16x32_bf16 v[200:203], v[56:59], v[232:235], v[200:203]
  s_add_u32 m0, s24, 16384
  ds_read_b64_tr_b16 v[94:95], v13 offset:42752
  v_accvgpr_write_b32 a34, 0
  v_mfma_f32_16x16x32_bf16 v[216:219], v[60:63], v[232:235], v[216:219]
  buffer_load_dwordx4 v10, s[36:39], s27 offen offset:2048 lds
  v_accvgpr_write_b32 a35, 0
  v_mfma_f32_16x16x32_bf16 v[108:111], v[32:35], v[236:239], v[108:111]
  ds_read_b128 v[248:251], v14 offset:34816
  v_accvgpr_write_b32 a36, 0
  v_mfma_f32_16x16x32_bf16 v[124:127], v[36:39], v[236:239], v[124:127]
  ds_read_b128 v[252:255], v14 offset:35840
  v_accvgpr_write_b32 a37, 0
  v_mfma_f32_16x16x32_bf16 v[140:143], v[40:43], v[236:239], v[140:143]
  v_accvgpr_write_b32 a38, 0
  v_accvgpr_write_b32 a39, 0
  v_mfma_f32_16x16x32_bf16 v[156:159], v[44:47], v[236:239], v[156:159]
  v_xor_b32 v14, 0x10000, v14
  v_mfma_f32_16x16x32_bf16 v[172:175], v[48:51], v[236:239], v[172:175]
  buffer_load_dwordx4 v11, s[36:39], s27 offen offset:3072 lds
  v_mfma_f32_16x16x32_bf16 v[188:191], v[52:55], v[236:239], v[188:191]
  s_add_u32 s27, s27, 524288
  v_xor_b32 v12, 0x10000, v12
  v_mfma_f32_16x16x32_bf16 v[204:207], v[56:59], v[236:239], v[204:207]
  v_xor_b32 v13, 0x10000, v13
  v_mfma_f32_16x16x32_bf16 v[220:223], v[60:63], v[236:239], v[220:223]
  s_waitcnt vmcnt(17) lgkmcnt(0)
  v_mfma_f32_16x16x32_bf16 v[96:99], v[64:67], v[240:243], v[96:99]
  s_barrier
  v_accvgpr_read_b32 v16, a40
  v_accvgpr_read_b32 v17, a41
  v_mfma_f32_16x16x32_bf16 v[112:115], v[68:71], v[240:243], v[112:115]
  ds_read_b64_tr_b16 v[32:33], v12 offset:0
  v_accvgpr_read_b32 v18, a42
  v_mfma_f32_16x16x32_bf16 v[128:131], v[72:75], v[240:243], v[128:131]
  s_add_u32 m0, s24, 98304
  ds_read_b64_tr_b16 v[34:35], v12 offset:1024
  v_accvgpr_read_b32 v19, a43
  v_mfma_f32_16x16x32_bf16 v[144:147], v[76:79], v[240:243], v[144:147]
  buffer_load_dwordx4 v3, s[32:35], s26 offen offset:0 sc1 lds
  v_accvgpr_read_b32 v20, a44
  v_mfma_f32_16x16x32_bf16 v[160:163], v[80:83], v[240:243], v[160:163]
  ds_read_b64_tr_b16 v[36:37], v13 offset:0
  v_accvgpr_read_b32 v21, a45
  v_mfma_f32_16x16x32_bf16 v[176:179], v[84:87], v[240:243], v[176:179]
  ds_read_b64_tr_b16 v[38:39], v13 offset:1024
  v_accvgpr_read_b32 v22, a46
  v_mfma_f32_16x16x32_bf16 v[192:195], v[88:91], v[240:243], v[192:195]
  ds_read_b64_tr_b16 v[40:41], v12 offset:256
  v_accvgpr_read_b32 v23, a47
  v_mfma_f32_16x16x32_bf16 v[208:211], v[92:95], v[240:243], v[208:211]
  ds_read_b64_tr_b16 v[42:43], v12 offset:1280
  v_mul_f32 v16, s76, v16
  v_mfma_f32_16x16x32_bf16 v[100:103], v[64:67], v[244:247], v[100:103]
  buffer_load_dwordx4 v4, s[32:35], s26 offen offset:1024 sc1 lds
  v_mul_f32 v17, s76, v17
  v_mfma_f32_16x16x32_bf16 v[116:119], v[68:71], v[244:247], v[116:119]
  ds_read_b64_tr_b16 v[44:45], v13 offset:256
  v_mul_f32 v18, s76, v18
  v_mfma_f32_16x16x32_bf16 v[132:135], v[72:75], v[244:247], v[132:135]
  ds_read_b64_tr_b16 v[46:47], v13 offset:1280
  v_mul_f32 v19, s76, v19
  v_mfma_f32_16x16x32_bf16 v[148:151], v[76:79], v[244:247], v[148:151]
  ds_read_b128 v[224:227], v14 offset:0
  v_mul_f32 v20, s76, v20
  v_mfma_f32_16x16x32_bf16 v[164:167], v[80:83], v[244:247], v[164:167]
  ds_read_b128 v[228:231], v14 offset:1024
  v_mul_f32 v21, s76, v21
  v_mfma_f32_16x16x32_bf16 v[180:183], v[84:87], v[244:247], v[180:183]
  buffer_load_dwordx4 v5, s[32:35], s26 offen offset:2048 sc1 lds
  v_mul_f32 v22, s76, v22
  v_mfma_f32_16x16x32_bf16 v[196:199], v[88:91], v[244:247], v[196:199]
  ds_read_b64_tr_b16 v[48:49], v12 offset:512
  v_mul_f32 v23, s76, v23
  v_mfma_f32_16x16x32_bf16 v[212:215], v[92:95], v[244:247], v[212:215]
  ds_read_b64_tr_b16 v[50:51], v12 offset:1536
  v_cvt_pk_bf16_f32 v28, v16, v17
  v_mfma_f32_16x16x32_bf16 v[104:107], v[64:67], v[248:251], v[104:107]
  ds_read_b64_tr_b16 v[52:53], v13 offset:512
  v_cvt_pk_bf16_f32 v29, v18, v19
  v_mfma_f32_16x16x32_bf16 v[120:123], v[68:71], v[248:251], v[120:123]
  ds_read_b64_tr_b16 v[54:55], v13 offset:1536
  v_cvt_pk_bf16_f32 v30, v20, v21
  v_mfma_f32_16x16x32_bf16 v[136:139], v[72:75], v[248:251], v[136:139]
  buffer_load_dwordx4 v6, s[32:35], s26 offen offset:3072 sc1 lds
  v_cvt_pk_bf16_f32 v31, v22, v23
  v_mfma_f32_16x16x32_bf16 v[152:155], v[76:79], v[248:251], v[152:155]
  s_add_u32 s26, s26, 1024
  ds_read_b64_tr_b16 v[56:57], v12 offset:768
  buffer_store_dwordx4 v[28:31], v2, s[40:43], s64 offen offset:1024 sc1
  v_mfma_f32_16x16x32_bf16 v[168:171], v[80:83], v[248:251], v[168:171]
  ds_read_b64_tr_b16 v[58:59], v12 offset:1792
  v_accvgpr_write_b32 a40, 0
  v_mfma_f32_16x16x32_bf16 v[184:187], v[84:87], v[248:251], v[184:187]
  ds_read_b64_tr_b16 v[60:61], v13 offset:768
  v_accvgpr_write_b32 a41, 0
  v_mfma_f32_16x16x32_bf16 v[200:203], v[88:91], v[248:251], v[200:203]
  s_add_u32 m0, s24, 49152
  ds_read_b64_tr_b16 v[62:63], v13 offset:1792
  v_accvgpr_write_b32 a42, 0
  v_mfma_f32_16x16x32_bf16 v[216:219], v[92:95], v[248:251], v[216:219]
  buffer_load_dwordx4 v8, s[36:39], s27 offen offset:0 lds
  v_accvgpr_write_b32 a43, 0
  v_mfma_f32_16x16x32_bf16 v[108:111], v[64:67], v[252:255], v[108:111]
  ds_read_b128 v[232:235], v14 offset:2048
  v_accvgpr_write_b32 a44, 0
  v_mfma_f32_16x16x32_bf16 v[124:127], v[68:71], v[252:255], v[124:127]
  ds_read_b128 v[236:239], v14 offset:3072
  v_accvgpr_write_b32 a45, 0
  v_mfma_f32_16x16x32_bf16 v[140:143], v[72:75], v[252:255], v[140:143]
  v_accvgpr_write_b32 a46, 0
  v_accvgpr_write_b32 a47, 0
  v_mfma_f32_16x16x32_bf16 v[156:159], v[76:79], v[252:255], v[156:159]
  v_mfma_f32_16x16x32_bf16 v[172:175], v[80:83], v[252:255], v[172:175]
  buffer_load_dwordx4 v9, s[36:39], s27 offen offset:1024 lds
  v_mfma_f32_16x16x32_bf16 v[188:191], v[84:87], v[252:255], v[188:191]
  v_mfma_f32_16x16x32_bf16 v[204:207], v[88:91], v[252:255], v[204:207]
  v_mfma_f32_16x16x32_bf16 v[220:223], v[92:95], v[252:255], v[220:223]
  s_waitcnt vmcnt(17) lgkmcnt(0)
  v_mfma_f32_16x16x32_bf16 v[96:99], v[32:35], v[224:227], v[96:99]
  v_accvgpr_read_b32 v16, a48
  v_accvgpr_read_b32 v17, a49
  v_accvgpr_read_b32 v18, a50
  v_mfma_f32_16x16x32_bf16 v[112:115], v[36:39], v[224:227], v[112:115]
  ds_read_b64_tr_b16 v[64:65], v12 offset:8192
  v_accvgpr_read_b32 v19, a51
  v_mfma_f32_16x16x32_bf16 v[128:131], v[40:43], v[224:227], v[128:131]
  s_add_u32 m0, s24, 0
  ds_read_b64_tr_b16 v[66:67], v12 offset:9216
  v_accvgpr_read_b32 v20, a52
  v_mfma_f32_16x16x32_bf16 v[144:147], v[44:47], v[224:227], v[144:147]
  buffer_load_dwordx4 v3, s[32:35], s26 offen offset:0 sc1 lds
  v_accvgpr_read_b32 v21, a53
  v_accvgpr_read_b32 v22, a54
  v_mfma_f32_16x16x32_bf16 v[160:163], v[48:51], v[224:227], v[160:163]
  ds_read_b64_tr_b16 v[68:69], v13 offset:8192
  v_accvgpr_read_b32 v23, a55
  v_mfma_f32_16x16x32_bf16 v[176:179], v[52:55], v[224:227], v[176:179]
  ds_read_b64_tr_b16 v[70:71], v13 offset:9216
  v_mul_f32 v16, s76, v16
  v_mfma_f32_16x16x32_bf16 v[192:195], v[56:59], v[224:227], v[192:195]
  ds_read_b64_tr_b16 v[72:73], v12 offset:8448
  v_mul_f32 v17, s76, v17
  v_mfma_f32_16x16x32_bf16 v[208:211], v[60:63], v[224:227], v[208:211]
  ds_read_b64_tr_b16 v[74:75], v12 offset:9472
  v_mul_f32 v18, s76, v18
  v_mul_f32 v19, s76, v19
  v_mfma_f32_16x16x32_bf16 v[100:103], v[32:35], v[228:231], v[100:103]
  buffer_load_dwordx4 v4, s[32:35], s26 offen offset:1024 sc1 lds
  v_mul_f32 v20, s76, v20
  v_mfma_f32_16x16x32_bf16 v[116:119], v[36:39], v[228:231], v[116:119]
  ds_read_b64_tr_b16 v[76:77], v13 offset:8448
  v_mul_f32 v21, s76, v21
  v_mfma_f32_16x16x32_bf16 v[132:135], v[40:43], v[228:231], v[132:135]
  ds_read_b64_tr_b16 v[78:79], v13 offset:9472
  v_mul_f32 v22, s76, v22
  v_mfma_f32_16x16x32_bf16 v[148:151], v[44:47], v[228:231], v[148:151]
  ds_read_b128 v[240:243], v14 offset:32768
  v_mul_f32 v23, s76, v23
  v_cvt_pk_bf16_f32 v24, v16, v17
  v_mfma_f32_16x16x32_bf16 v[164:167], v[48:51], v[228:231], v[164:167]
  ds_read_b128 v[244:247], v14 offset:33792
  v_cvt_pk_bf16_f32 v25, v18, v19
  v_mfma_f32_16x16x32_bf16 v[180:183], v[52:55], v[228:231], v[180:183]
  buffer_load_dwordx4 v5, s[32:35], s26 offen offset:2048 sc1 lds
  v_cvt_pk_bf16_f32 v26, v20, v21
  v_mfma_f32_16x16x32_bf16 v[196:199], v[56:59], v[228:231], v[196:199]
  ds_read_b64_tr_b16 v[80:81], v12 offset:8704
  v_cvt_pk_bf16_f32 v27, v22, v23
  v_mfma_f32_16x16x32_bf16 v[212:215], v[60:63], v[228:231], v[212:215]
  ds_read_b64_tr_b16 v[82:83], v12 offset:9728
  buffer_store_dwordx4 v[24:27], v2, s[40:43], s64 offen offset:2048 sc1
  v_accvgpr_read_b32 v16, a56
  v_mfma_f32_16x16x32_bf16 v[104:107], v[32:35], v[232:235], v[104:107]
  ds_read_b64_tr_b16 v[84:85], v13 offset:8704
  v_accvgpr_read_b32 v17, a57
  v_mfma_f32_16x16x32_bf16 v[120:123], v[36:39], v[232:235], v[120:123]
  ds_read_b64_tr_b16 v[86:87], v13 offset:9728
  v_accvgpr_read_b32 v18, a58
  v_mfma_f32_16x16x32_bf16 v[136:139], v[40:43], v[232:235], v[136:139]
  buffer_load_dwordx4 v6, s[32:35], s26 offen offset:3072 sc1 lds
  v_accvgpr_read_b32 v19, a59
  v_accvgpr_read_b32 v20, a60
  v_mfma_f32_16x16x32_bf16 v[152:155], v[44:47], v[232:235], v[152:155]
  s_add_u32 s26, s26, 1024
  ds_read_b64_tr_b16 v[88:89], v12 offset:8960
  v_accvgpr_read_b32 v21, a61
  v_mfma_f32_16x16x32_bf16 v[168:171], v[48:51], v[232:235], v[168:171]
  ds_read_b64_tr_b16 v[90:91], v12 offset:9984
  v_accvgpr_read_b32 v22, a62
  v_mfma_f32_16x16x32_bf16 v[184:187], v[52:55], v[232:235], v[184:187]
  ds_read_b64_tr_b16 v[92:93], v13 offset:8960
  v_accvgpr_read_b32 v23, a63
  v_mfma_f32_16x16x32_bf16 v[200:203], v[56:59], v[232:235], v[200:203]
  s_add_u32 m0, s24, 49152
  ds_read_b64_tr_b16 v[94:95], v13 offset:9984
  v_mul_f32 v16, s76, v16
  v_mul_f32 v17, s76, v17
  v_mfma_f32_16x16x32_bf16 v[216:219], v[60:63], v[232:235], v[216:219]
  buffer_load_dwordx4 v10, s[36:39], s27 offen offset:2048 lds
  v_mul_f32 v18, s76, v18
  v_mfma_f32_16x16x32_bf16 v[108:111], v[32:35], v[236:239], v[108:111]
  ds_read_b128 v[248:251], v14 offset:34816
  v_mul_f32 v19, s76, v19
  v_mfma_f32_16x16x32_bf16 v[124:127], v[36:39], v[236:239], v[124:127]
  ds_read_b128 v[252:255], v14 offset:35840
  v_mul_f32 v20, s76, v20
  v_mfma_f32_16x16x32_bf16 v[140:143], v[40:43], v[236:239], v[140:143]
  v_mul_f32 v21, s76, v21
  v_mul_f32 v22, s76, v22
  v_mul_f32 v23, s76, v23
  v_mfma_f32_16x16x32_bf16 v[156:159], v[44:47], v[236:239], v[156:159]
  v_xor_b32 v14, 0x10000, v14
  v_cvt_pk_bf16_f32 v28, v16, v17
  v_mfma_f32_16x16x32_bf16 v[172:175], v[48:51], v[236:239], v[172:175]
  buffer_load_dwordx4 v11, s[36:39], s27 offen offset:3072 lds
  v_cvt_pk_bf16_f32 v29, v18, v19
  v_mfma_f32_16x16x32_bf16 v[188:191], v[52:55], v[236:239], v[188:191]
  s_add_u32 s27, s27, 524288
  v_cvt_pk_bf16_f32 v30, v20, v21
  v_cvt_pk_bf16_f32 v31, v22, v23
  v_mfma_f32_16x16x32_bf16 v[204:207], v[56:59], v[236:239], v[204:207]
  buffer_store_dwordx4 v[28:31], v2, s[40:43], s64 offen offset:3072 sc1
  v_mfma_f32_16x16x32_bf16 v[220:223], v[60:63], v[236:239], v[220:223]
  s_waitcnt vmcnt(18) lgkmcnt(0)
  v_mfma_f32_16x16x32_bf16 v[96:99], v[64:67], v[240:243], v[96:99]
  s_barrier
  v_accvgpr_read_b32 v16, a64
  v_accvgpr_read_b32 v17, a65
  v_accvgpr_read_b32 v18, a66
  v_mfma_f32_16x16x32_bf16 v[112:115], v[68:71], v[240:243], v[112:115]
  s_add_u32 s64, s64, 126976
  ds_read_b64_tr_b16 v[32:33], v12 offset:32768
  v_accvgpr_read_b32 v19, a67
  v_accvgpr_read_b32 v20, a68
  v_mfma_f32_16x16x32_bf16 v[128:131], v[72:75], v[240:243], v[128:131]
  s_add_u32 m0, s24, 32768
  ds_read_b64_tr_b16 v[34:35], v12 offset:33792
  v_accvgpr_read_b32 v21, a69
  v_mfma_f32_16x16x32_bf16 v[144:147], v[76:79], v[240:243], v[144:147]
  buffer_load_dwordx4 v3, s[32:35], s26 offen offset:0 sc1 lds
  v_accvgpr_read_b32 v22, a70
  v_accvgpr_read_b32 v23, a71
  v_mfma_f32_16x16x32_bf16 v[160:163], v[80:83], v[240:243], v[160:163]
  ds_read_b64_tr_b16 v[36:37], v13 offset:32768
  v_mul_f32 v16, s76, v16
  v_mfma_f32_16x16x32_bf16 v[176:179], v[84:87], v[240:243], v[176:179]
  ds_read_b64_tr_b16 v[38:39], v13 offset:33792
  v_mul_f32 v17, s76, v17
  v_mul_f32 v18, s76, v18
  v_mfma_f32_16x16x32_bf16 v[192:195], v[88:91], v[240:243], v[192:195]
  ds_read_b64_tr_b16 v[40:41], v12 offset:33024
  v_mul_f32 v19, s76, v19
  v_mfma_f32_16x16x32_bf16 v[208:211], v[92:95], v[240:243], v[208:211]
  ds_read_b64_tr_b16 v[42:43], v12 offset:34048
  v_mul_f32 v20, s76, v20
  v_mul_f32 v21, s76, v21
  v_mfma_f32_16x16x32_bf16 v[100:103], v[64:67], v[244:247], v[100:103]
  buffer_load_dwordx4 v4, s[32:35], s26 offen offset:1024 sc1 lds
  v_mul_f32 v22, s76, v22
  v_mfma_f32_16x16x32_bf16 v[116:119], v[68:71], v[244:247], v[116:119]
  ds_read_b64_tr_b16 v[44:45], v13 offset:33024
  v_mul_f32 v23, s76, v23
  v_cvt_pk_bf16_f32 v24, v16, v17
  v_mfma_f32_16x16x32_bf16 v[132:135], v[72:75], v[244:247], v[132:135]
  ds_read_b64_tr_b16 v[46:47], v13 offset:34048
  v_cvt_pk_bf16_f32 v25, v18, v19
  v_mfma_f32_16x16x32_bf16 v[148:151], v[76:79], v[244:247], v[148:151]
  ds_read_b128 v[224:227], v14 offset:0
  v_cvt_pk_bf16_f32 v26, v20, v21
  v_cvt_pk_bf16_f32 v27, v22, v23
  v_mfma_f32_16x16x32_bf16 v[164:167], v[80:83], v[244:247], v[164:167]
  ds_read_b128 v[228:231], v14 offset:1024
  buffer_store_dwordx4 v[24:27], v2, s[40:43], s64 offen offset:0 sc1
  v_mfma_f32_16x16x32_bf16 v[180:183], v[84:87], v[244:247], v[180:183]
  buffer_load_dwordx4 v5, s[32:35], s26 offen offset:2048 sc1 lds
  v_accvgpr_read_b32 v16, a72
  v_accvgpr_read_b32 v17, a73
  v_mfma_f32_16x16x32_bf16 v[196:199], v[88:91], v[244:247], v[196:199]
  ds_read_b64_tr_b16 v[48:49], v12 offset:33280
  v_accvgpr_read_b32 v18, a74
  v_mfma_f32_16x16x32_bf16 v[212:215], v[92:95], v[244:247], v[212:215]
  ds_read_b64_tr_b16 v[50:51], v12 offset:34304
  v_accvgpr_read_b32 v19, a75
  v_accvgpr_read_b32 v20, a76
  v_mfma_f32_16x16x32_bf16 v[104:107], v[64:67], v[248:251], v[104:107]
  ds_read_b64_tr_b16 v[52:53], v13 offset:33280
  v_accvgpr_read_b32 v21, a77
  v_accvgpr_read_b32 v22, a78
  v_mfma_f32_16x16x32_bf16 v[120:123], v[68:71], v[248:251], v[120:123]
  ds_read_b64_tr_b16 v[54:55], v13 offset:34304
  v_accvgpr_read_b32 v23, a79
  v_mfma_f32_16x16x32_bf16 v[136:139], v[72:75], v[248:251], v[136:139]
  buffer_load_dwordx4 v6, s[32:35], s26 offen offset:3072 sc1 lds
  v_mul_f32 v16, s76, v16
  v_mul_f32 v17, s76, v17
  v_mfma_f32_16x16x32_bf16 v[152:155], v[76:79], v[248:251], v[152:155]
  s_add_u32 s26, s26, 1024
  ds_read_b64_tr_b16 v[56:57], v12 offset:33536
  v_mul_f32 v18, s76, v18
  v_mfma_f32_16x16x32_bf16 v[168:171], v[80:83], v[248:251], v[168:171]
  ds_read_b64_tr_b16 v[58:59], v12 offset:34560
  v_mul_f32 v19, s76, v19
  v_mul_f32 v20, s76, v20
  v_mfma_f32_16x16x32_bf16 v[184:187], v[84:87], v[248:251], v[184:187]
  ds_read_b64_tr_b16 v[60:61], v13 offset:33536
  v_mul_f32 v21, s76, v21
  v_mfma_f32_16x16x32_bf16 v[200:203], v[88:91], v[248:251], v[200:203]
  ds_read_b64_tr_b16 v[62:63], v13 offset:34560
  v_mul_f32 v22, s76, v22
  v_mul_f32 v23, s76, v23
  v_mfma_f32_16x16x32_bf16 v[216:219], v[92:95], v[248:251], v[216:219]
  v_cvt_pk_bf16_f32 v28, v16, v17
  v_cvt_pk_bf16_f32 v29, v18, v19
  v_mfma_f32_16x16x32_bf16 v[108:111], v[64:67], v[252:255], v[108:111]
  ds_read_b128 v[232:235], v14 offset:2048
  v_cvt_pk_bf16_f32 v30, v20, v21
  v_cvt_pk_bf16_f32 v31, v22, v23
  v_mfma_f32_16x16x32_bf16 v[124:127], v[68:71], v[252:255], v[124:127]
  ds_read_b128 v[236:239], v14 offset:3072
  buffer_store_dwordx4 v[28:31], v2, s[40:43], s64 offen offset:1024 sc1
  v_mfma_f32_16x16x32_bf16 v[140:143], v[72:75], v[252:255], v[140:143]
  v_and_b32 v11, 15, v1
  v_lshrrev_b32 v10, 4, v1
  v_lshlrev_b32 v10, 2, v10
  v_mfma_f32_16x16x32_bf16 v[156:159], v[76:79], v[252:255], v[156:159]
  v_sub_u32 v11, v11, v10
  v_cmp_le_i32 s[68:69], 0, v11
  v_mfma_f32_16x16x32_bf16 v[172:175], v[80:83], v[252:255], v[172:175]
  v_cmp_le_i32 s[70:71], 1, v11
  v_cmp_le_i32 s[72:73], 2, v11
  v_cmp_le_i32 s[74:75], 3, v11
  v_mfma_f32_16x16x32_bf16 v[188:191], v[84:87], v[252:255], v[188:191]
  v_and_b32 v8, 7, v1
  v_lshlrev_b32 v8, 2, v8
  v_mfma_f32_16x16x32_bf16 v[204:207], v[88:91], v[252:255], v[204:207]
  v_add_u32 v8, s30, v8
  v_mfma_f32_16x16x32_bf16 v[220:223], v[92:95], v[252:255], v[220:223]
  s_waitcnt vmcnt(17) lgkmcnt(0)
  v_mfma_f32_16x16x32_bf16 v[96:99], v[32:35], v[224:227], v[96:99]
  v_accvgpr_read_b32 v16, a80
  v_accvgpr_read_b32 v17, a81
  v_accvgpr_read_b32 v18, a82
  v_mfma_f32_16x16x32_bf16 v[112:115], v[36:39], v[224:227], v[112:115]
  ds_read_b64_tr_b16 v[64:65], v12 offset:40960
  v_accvgpr_read_b32 v19, a83
  v_accvgpr_read_b32 v20, a84
  v_mfma_f32_16x16x32_bf16 v[128:131], v[40:43], v[224:227], v[128:131]
  s_add_u32 m0, s24, 65536
  ds_read_b64_tr_b16 v[66:67], v12 offset:41984
  v_accvgpr_read_b32 v21, a85
  v_accvgpr_read_b32 v22, a86
  v_mfma_f32_16x16x32_bf16 v[144:147], v[44:47], v[224:227], v[144:147]
  buffer_load_dwordx4 v3, s[32:35], s26 offen offset:0 sc1 lds
  v_accvgpr_read_b32 v23, a87
  v_mul_f32 v16, s76, v16
  v_mfma_f32_16x16x32_bf16 v[160:163], v[48:51], v[224:227], v[160:163]
  ds_read_b64_tr_b16 v[68:69], v13 offset:40960
  v_mul_f32 v17, s76, v17
  v_mul_f32 v18, s76, v18
  v_mfma_f32_16x16x32_bf16 v[176:179], v[52:55], v[224:227], v[176:179]
  ds_read_b64_tr_b16 v[70:71], v13 offset:41984
  v_mul_f32 v19, s76, v19
  v_mul_f32 v20, s76, v20
  v_mfma_f32_16x16x32_bf16 v[192:195], v[56:59], v[224:227], v[192:195]
  ds_read_b64_tr_b16 v[72:73], v12 offset:41216
  v_mul_f32 v21, s76, v21
  v_mul_f32 v22, s76, v22
  v_mfma_f32_16x16x32_bf16 v[208:211], v[60:63], v[224:227], v[208:211]
  ds_read_b64_tr_b16 v[74:75], v12 offset:42240
  v_mul_f32 v23, s76, v23
  v_mfma_f32_16x16x32_bf16 v[100:103], v[32:35], v[228:231], v[100:103]
  buffer_load_dwordx4 v4, s[32:35], s26 offen offset:1024 sc1 lds
  v_cvt_pk_bf16_f32 v24, v16, v17
  v_cvt_pk_bf16_f32 v25, v18, v19
  v_mfma_f32_16x16x32_bf16 v[116:119], v[36:39], v[228:231], v[116:119]
  ds_read_b64_tr_b16 v[76:77], v13 offset:41216
  v_cvt_pk_bf16_f32 v26, v20, v21
  v_cvt_pk_bf16_f32 v27, v22, v23
  v_mfma_f32_16x16x32_bf16 v[132:135], v[40:43], v[228:231], v[132:135]
  ds_read_b64_tr_b16 v[78:79], v13 offset:42240
  buffer_store_dwordx4 v[24:27], v2, s[40:43], s64 offen offset:2048 sc1
  v_accvgpr_read_b32 v16, a88
  v_mfma_f32_16x16x32_bf16 v[148:151], v[44:47], v[228:231], v[148:151]
  ds_read_b128 v[240:243], v14 offset:32768
  v_accvgpr_read_b32 v17, a89
  v_accvgpr_read_b32 v18, a90
  v_mfma_f32_16x16x32_bf16 v[164:167], v[48:51], v[228:231], v[164:167]
  ds_read_b128 v[244:247], v14 offset:33792
  v_accvgpr_read_b32 v19, a91
  v_accvgpr_read_b32 v20, a92
  v_mfma_f32_16x16x32_bf16 v[180:183], v[52:55], v[228:231], v[180:183]
  buffer_load_dwordx4 v5, s[32:35], s26 offen offset:2048 sc1 lds
  v_accvgpr_read_b32 v21, a93
  v_accvgpr_read_b32 v22, a94
  v_mfma_f32_16x16x32_bf16 v[196:199], v[56:59], v[228:231], v[196:199]
  ds_read_b64_tr_b16 v[80:81], v12 offset:41472
  v_accvgpr_read_b32 v23, a95
  v_mfma_f32_16x16x32_bf16 v[212:215], v[60:63], v[228:231], v[212:215]
  ds_read_b64_tr_b16 v[82:83], v12 offset:42496
  v_mul_f32 v16, s76, v16
  v_mul_f32 v17, s76, v17
  v_mfma_f32_16x16x32_bf16 v[104:107], v[32:35], v[232:235], v[104:107]
  ds_read_b64_tr_b16 v[84:85], v13 offset:41472
  v_mul_f32 v18, s76, v18
  v_mul_f32 v19, s76, v19
  v_mfma_f32_16x16x32_bf16 v[120:123], v[36:39], v[232:235], v[120:123]
  ds_read_b64_tr_b16 v[86:87], v13 offset:42496
  v_mul_f32 v20, s76, v20
  v_mul_f32 v21, s76, v21
  v_mfma_f32_16x16x32_bf16 v[136:139], v[40:43], v[232:235], v[136:139]
  buffer_load_dwordx4 v6, s[32:35], s26 offen offset:3072 sc1 lds
  v_mul_f32 v22, s76, v22
  v_mul_f32 v23, s76, v23
  v_mfma_f32_16x16x32_bf16 v[152:155], v[44:47], v[232:235], v[152:155]
  s_add_u32 s26, s26, 1024
  ds_read_b64_tr_b16 v[88:89], v12 offset:41728
  v_cvt_pk_bf16_f32 v28, v16, v17
  v_cvt_pk_bf16_f32 v29, v18, v19
  v_mfma_f32_16x16x32_bf16 v[168:171], v[48:51], v[232:235], v[168:171]
  ds_read_b64_tr_b16 v[90:91], v12 offset:42752
  v_cvt_pk_bf16_f32 v30, v20, v21
  v_cvt_pk_bf16_f32 v31, v22, v23
  v_mfma_f32_16x16x32_bf16 v[184:187], v[52:55], v[232:235], v[184:187]
  ds_read_b64_tr_b16 v[92:93], v13 offset:41728
  buffer_store_dwordx4 v[28:31], v2, s[40:43], s64 offen offset:3072 sc1
  v_add_u32 v9, 0, v1
  v_mfma_f32_16x16x32_bf16 v[200:203], v[56:59], v[232:235], v[200:203]
  ds_read_b64_tr_b16 v[94:95], v13 offset:42752
  v_mul_u32_u24 v10, 6554, v9
  v_mfma_f32_16x16x32_bf16 v[216:219], v[60:63], v[232:235], v[216:219]
  v_lshrrev_b32 v10, 16, v10
  v_mul_u32_u24 v10, 1120, v10
  v_lshl_add_u32 v10, v9, 4, v10
  v_mfma_f32_16x16x32_bf16 v[108:111], v[32:35], v[236:239], v[108:111]
  ds_read_b128 v[248:251], v14 offset:34816
  v_accvgpr_write_b32 a248, v10
  v_add_u32 v9, 64, v1
  v_mfma_f32_16x16x32_bf16 v[124:127], v[36:39], v[236:239], v[124:127]
  ds_read_b128 v[252:255], v14 offset:35840
  v_mul_u32_u24 v10, 6554, v9
  v_lshrrev_b32 v10, 16, v10
  v_mfma_f32_16x16x32_bf16 v[140:143], v[40:43], v[236:239], v[140:143]
  v_mul_u32_u24 v10, 1120, v10
  v_lshl_add_u32 v10, v9, 4, v10
  v_accvgpr_write_b32 a249, v10
  v_mfma_f32_16x16x32_bf16 v[156:159], v[44:47], v[236:239], v[156:159]
  v_xor_b32 v14, 0x10000, v14
  v_add_u32 v9, 128, v1
  v_mul_u32_u24 v10, 6554, v9
  v_mfma_f32_16x16x32_bf16 v[172:175], v[48:51], v[236:239], v[172:175]
  v_lshrrev_b32 v10, 16, v10
  v_mul_u32_u24 v10, 1120, v10
  v_lshl_add_u32 v10, v9, 4, v10
  v_mfma_f32_16x16x32_bf16 v[188:191], v[52:55], v[236:239], v[188:191]
  v_xor_b32 v12, 0x10000, v12
  v_accvgpr_write_b32 a250, v10
  v_mfma_f32_16x16x32_bf16 v[204:207], v[56:59], v[236:239], v[204:207]
  v_xor_b32 v13, 0x10000, v13
  v_mfma_f32_16x16x32_bf16 v[220:223], v[60:63], v[236:239], v[220:223]
  s_waitcnt vmcnt(15) lgkmcnt(0)
  v_mfma_f32_16x16x32_bf16 v[96:99], v[64:67], v[240:243], v[96:99]
  s_barrier
  v_accvgpr_read_b32 v16, a96
  v_accvgpr_read_b32 v17, a97
  v_accvgpr_read_b32 v18, a98
  v_accvgpr_read_b32 v19, a99
  v_mfma_f32_16x16x32_bf16 v[112:115], v[68:71], v[240:243], v[112:115]
  s_add_u32 s64, s64, 4096
  ds_read_b64_tr_b16 v[32:33], v12 offset:0
  v_accvgpr_read_b32 v20, a100
  v_accvgpr_read_b32 v21, a101
  v_mfma_f32_16x16x32_bf16 v[128:131], v[72:75], v[240:243], v[128:131]
  s_add_u32 m0, s24, 98304
  ds_read_b64_tr_b16 v[34:35], v12 offset:1024
  v_accvgpr_read_b32 v22, a102
  v_accvgpr_read_b32 v23, a103
  v_mfma_f32_16x16x32_bf16 v[144:147], v[76:79], v[240:243], v[144:147]
  buffer_load_dwordx4 v3, s[32:35], s26 offen offset:0 sc1 lds
  v_mul_f32 v16, s76, v16
  v_mul_f32 v17, s76, v17
  v_mul_f32 v18, s76, v18
  v_mfma_f32_16x16x32_bf16 v[160:163], v[80:83], v[240:243], v[160:163]
  ds_read_b64_tr_b16 v[36:37], v13 offset:0
  v_mul_f32 v19, s76, v19
  v_mul_f32 v20, s76, v20
  v_mfma_f32_16x16x32_bf16 v[176:179], v[84:87], v[240:243], v[176:179]
  ds_read_b64_tr_b16 v[38:39], v13 offset:1024
  v_mul_f32 v21, s76, v21
  v_mul_f32 v22, s76, v22
  v_mfma_f32_16x16x32_bf16 v[192:195], v[88:91], v[240:243], v[192:195]
  ds_read_b64_tr_b16 v[40:41], v12 offset:256
  v_mul_f32 v23, s76, v23
  v_cvt_pk_bf16_f32 v24, v16, v17
  v_cvt_pk_bf16_f32 v25, v18, v19
  v_mfma_f32_16x16x32_bf16 v[208:211], v[92:95], v[240:243], v[208:211]
  ds_read_b64_tr_b16 v[42:43], v12 offset:1280
  v_cvt_pk_bf16_f32 v26, v20, v21
  v_cvt_pk_bf16_f32 v27, v22, v23
  v_mfma_f32_16x16x32_bf16 v[100:103], v[64:67], v[244:247], v[100:103]
  buffer_load_dwordx4 v4, s[32:35], s26 offen offset:1024 sc1 lds
  buffer_store_dwordx4 v[24:27], v2, s[40:43], s64 offen offset:0 sc1
  v_accvgpr_read_b32 v16, a104
  v_mfma_f32_16x16x32_bf16 v[116:119], v[68:71], v[244:247], v[116:119]
  ds_read_b64_tr_b16 v[44:45], v13 offset:256
  v_accvgpr_read_b32 v17, a105
  v_accvgpr_read_b32 v18, a106
  v_mfma_f32_16x16x32_bf16 v[132:135], v[72:75], v[244:247], v[132:135]
  ds_read_b64_tr_b16 v[46:47], v13 offset:1280
  v_accvgpr_read_b32 v19, a107
  v_accvgpr_read_b32 v20, a108
  v_accvgpr_read_b32 v21, a109
  v_mfma_f32_16x16x32_bf16 v[148:151], v[76:79], v[244:247], v[148:151]
  ds_read_b128 v[224:227], v14 offset:0
  v_accvgpr_read_b32 v22, a110
  v_accvgpr_read_b32 v23, a111
  v_mfma_f32_16x16x32_bf16 v[164:167], v[80:83], v[244:247], v[164:167]
  ds_read_b128 v[228:231], v14 offset:1024
  v_mul_f32 v16, s76, v16
  v_mul_f32 v17, s76, v17
  v_mfma_f32_16x16x32_bf16 v[180:183], v[84:87], v[244:247], v[180:183]
  buffer_load_dwordx4 v5, s[32:35], s26 offen offset:2048 sc1 lds
  v_mul_f32 v18, s76, v18
  v_mul_f32 v19, s76, v19
  v_mul_f32 v20, s76, v20
  v_mfma_f32_16x16x32_bf16 v[196:199], v[88:91], v[244:247], v[196:199]
  ds_read_b64_tr_b16 v[48:49], v12 offset:512
  v_mul_f32 v21, s76, v21
  v_mul_f32 v22, s76, v22
  v_mfma_f32_16x16x32_bf16 v[212:215], v[92:95], v[244:247], v[212:215]
  ds_read_b64_tr_b16 v[50:51], v12 offset:1536
  v_mul_f32 v23, s76, v23
  v_cvt_pk_bf16_f32 v28, v16, v17
  v_mfma_f32_16x16x32_bf16 v[104:107], v[64:67], v[248:251], v[104:107]
  ds_read_b64_tr_b16 v[52:53], v13 offset:512
  v_cvt_pk_bf16_f32 v29, v18, v19
  v_cvt_pk_bf16_f32 v30, v20, v21
  v_cvt_pk_bf16_f32 v31, v22, v23
  v_mfma_f32_16x16x32_bf16 v[120:123], v[68:71], v[248:251], v[120:123]
  ds_read_b64_tr_b16 v[54:55], v13 offset:1536
  buffer_store_dwordx4 v[28:31], v2, s[40:43], s64 offen offset:1024 sc1
  v_accvgpr_read_b32 v16, a112
  v_mfma_f32_16x16x32_bf16 v[136:139], v[72:75], v[248:251], v[136:139]
  buffer_load_dwordx4 v6, s[32:35], s26 offen offset:3072 sc1 lds
  v_accvgpr_read_b32 v17, a113
  v_accvgpr_read_b32 v18, a114
  v_mfma_f32_16x16x32_bf16 v[152:155], v[76:79], v[248:251], v[152:155]
  s_add_u32 s26, s26, 1024
  ds_read_b64_tr_b16 v[56:57], v12 offset:768
  v_accvgpr_read_b32 v19, a115
  v_accvgpr_read_b32 v20, a116
  v_mfma_f32_16x16x32_bf16 v[168:171], v[80:83], v[248:251], v[168:171]
  ds_read_b64_tr_b16 v[58:59], v12 offset:1792
  v_accvgpr_read_b32 v21, a117
  v_accvgpr_read_b32 v22, a118
  v_accvgpr_read_b32 v23, a119
  v_mfma_f32_16x16x32_bf16 v[184:187], v[84:87], v[248:251], v[184:187]
  ds_read_b64_tr_b16 v[60:61], v13 offset:768
  v_mul_f32 v16, s76, v16
  v_mul_f32 v17, s76, v17
  v_mfma_f32_16x16x32_bf16 v[200:203], v[88:91], v[248:251], v[200:203]
  ds_read_b64_tr_b16 v[62:63], v13 offset:1792
  v_mul_f32 v18, s76, v18
  v_mul_f32 v19, s76, v19
  v_mfma_f32_16x16x32_bf16 v[216:219], v[92:95], v[248:251], v[216:219]
  v_mul_f32 v20, s76, v20
  v_mul_f32 v21, s76, v21
  v_mul_f32 v22, s76, v22
  v_mul_f32 v23, s76, v23
  v_mfma_f32_16x16x32_bf16 v[108:111], v[64:67], v[252:255], v[108:111]
  ds_read_b128 v[232:235], v14 offset:2048
  v_cvt_pk_bf16_f32 v24, v16, v17
  v_cvt_pk_bf16_f32 v25, v18, v19
  v_mfma_f32_16x16x32_bf16 v[124:127], v[68:71], v[252:255], v[124:127]
  ds_read_b128 v[236:239], v14 offset:3072
  v_cvt_pk_bf16_f32 v26, v20, v21
  v_cvt_pk_bf16_f32 v27, v22, v23
  v_mfma_f32_16x16x32_bf16 v[140:143], v[72:75], v[252:255], v[140:143]
  buffer_store_dwordx4 v[24:27], v2, s[40:43], s64 offen offset:2048 sc1
  v_add_u32 v9, 192, v1
  v_mul_u32_u24 v10, 6554, v9
  v_lshrrev_b32 v10, 16, v10
  v_mfma_f32_16x16x32_bf16 v[156:159], v[76:79], v[252:255], v[156:159]
  v_mul_u32_u24 v10, 1120, v10
  v_lshl_add_u32 v10, v9, 4, v10
  v_accvgpr_write_b32 a251, v10
  v_mfma_f32_16x16x32_bf16 v[172:175], v[80:83], v[252:255], v[172:175]
  v_add_u32 v9, 256, v1
  v_mul_u32_u24 v10, 6554, v9
  v_lshrrev_b32 v10, 16, v10
  v_mfma_f32_16x16x32_bf16 v[188:191], v[84:87], v[252:255], v[188:191]
  v_mul_u32_u24 v10, 1120, v10
  v_lshl_add_u32 v10, v9, 4, v10
  v_accvgpr_write_b32 a252, v10
  v_mfma_f32_16x16x32_bf16 v[204:207], v[88:91], v[252:255], v[204:207]
  v_mfma_f32_16x16x32_bf16 v[220:223], v[92:95], v[252:255], v[220:223]
  s_waitcnt vmcnt(14) lgkmcnt(0)
  v_mfma_f32_16x16x32_bf16 v[96:99], v[32:35], v[224:227], v[96:99]
  v_accvgpr_read_b32 v16, a120
  v_accvgpr_read_b32 v17, a121
  v_accvgpr_read_b32 v18, a122
  v_mfma_f32_16x16x32_bf16 v[112:115], v[36:39], v[224:227], v[112:115]
  s_mul_i32 s34, s20, 5120
  ds_read_b64_tr_b16 v[64:65], v12 offset:8192
  v_accvgpr_read_b32 v19, a123
  v_accvgpr_read_b32 v20, a124
  v_mfma_f32_16x16x32_bf16 v[128:131], v[40:43], v[224:227], v[128:131]
  s_add_u32 s34, s34, 131072
  ds_read_b64_tr_b16 v[66:67], v12 offset:9216
  v_accvgpr_read_b32 v21, a125
  v_accvgpr_read_b32 v22, a126
  v_mfma_f32_16x16x32_bf16 v[144:147], v[44:47], v[224:227], v[144:147]
  s_and_b32 s32, s21, 3
  buffer_load_dword v15, v8, s[40:43], 0 offen sc1
  v_accvgpr_read_b32 v23, a127
  v_mul_f32 v16, s76, v16
  v_mfma_f32_16x16x32_bf16 v[160:163], v[48:51], v[224:227], v[160:163]
  s_min_u32 s32, s32, 2
  ds_read_b64_tr_b16 v[68:69], v13 offset:8192
  v_mul_f32 v17, s76, v17
  v_mul_f32 v18, s76, v18
  v_mfma_f32_16x16x32_bf16 v[176:179], v[52:55], v[224:227], v[176:179]
  s_add_u32 s32, s32, 5
  ds_read_b64_tr_b16 v[70:71], v13 offset:9216
  v_mul_f32 v19, s76, v19
  v_mul_f32 v20, s76, v20
  v_mfma_f32_16x16x32_bf16 v[192:195], v[56:59], v[224:227], v[192:195]
  s_lshl_b32 s32, s32, 14
  ds_read_b64_tr_b16 v[72:73], v12 offset:8448
  v_mul_f32 v21, s76, v21
  v_mul_f32 v22, s76, v22
  v_mfma_f32_16x16x32_bf16 v[208:211], v[60:63], v[224:227], v[208:211]
  s_mov_b32 s9, -1
  ds_read_b64_tr_b16 v[74:75], v12 offset:9472
  v_mul_f32 v23, s76, v23
  v_mfma_f32_16x16x32_bf16 v[100:103], v[32:35], v[228:231], v[100:103]
  s_sub_u32 s23, s2, 64
  v_cvt_pk_bf16_f32 v28, v16, v17
  v_cvt_pk_bf16_f32 v29, v18, v19
  v_cvt_pk_bf16_f32 v30, v20, v21
  v_mfma_f32_16x16x32_bf16 v[116:119], v[36:39], v[228:231], v[116:119]
  s_cmp_lt_u32 s23, 96
  s_cselect_b32 s9, 0, s9
  ds_read_b64_tr_b16 v[76:77], v13 offset:8448
  v_cvt_pk_bf16_f32 v31, v22, v23
  v_mfma_f32_16x16x32_bf16 v[132:135], v[40:43], v[228:231], v[132:135]
  s_cmp_ge_u32 s2, 224
  s_cselect_b32 s9, 0, s9
  ds_read_b64_tr_b16 v[78:79], v13 offset:9472
  buffer_store_dwordx4 v[28:31], v2, s[40:43], s64 offen offset:3072 sc1
  v_accvgpr_read_b32 v16, a128
  v_mfma_f32_16x16x32_bf16 v[148:151], v[44:47], v[228:231], v[148:151]
  s_and_b32 s32, s32, s9
  ds_read_b128 v[240:243], v14 offset:32768
  v_accvgpr_read_b32 v17, a129
  v_accvgpr_read_b32 v18, a130
  v_mfma_f32_16x16x32_bf16 v[164:167], v[48:51], v[228:231], v[164:167]
  s_sub_u32 s23, s2, 170
  ds_read_b128 v[244:247], v14 offset:33792
  v_accvgpr_read_b32 v19, a131
  v_accvgpr_read_b32 v20, a132
  v_mfma_f32_16x16x32_bf16 v[180:183], v[52:55], v[228:231], v[180:183]
  s_cmp_lt_u32 s23, 54
  s_cselect_b32 s32, 98304, s32
  v_accvgpr_read_b32 v21, a133
  v_accvgpr_read_b32 v22, a134
  v_accvgpr_read_b32 v23, a135
  v_mfma_f32_16x16x32_bf16 v[196:199], v[56:59], v[228:231], v[196:199]
  s_mov_b32 s67, s2
  s_add_u32 s64, s64, 126976
  ds_read_b64_tr_b16 v[80:81], v12 offset:8704
  v_mul_f32 v16, s76, v16
  v_mfma_f32_16x16x32_bf16 v[212:215], v[60:63], v[228:231], v[212:215]
  s_mov_b32 s8, 0
  ds_read_b64_tr_b16 v[82:83], v12 offset:9728
  v_mul_f32 v17, s76, v17
  v_mul_f32 v18, s76, v18
  v_mfma_f32_16x16x32_bf16 v[104:107], v[32:35], v[232:235], v[104:107]
  s_mov_b32 s66, 0
  ds_read_b64_tr_b16 v[84:85], v13 offset:8704
  v_mul_f32 v19, s76, v19
  v_mul_f32 v20, s76, v20
  v_mfma_f32_16x16x32_bf16 v[120:123], v[36:39], v[232:235], v[120:123]
  s_mov_b32 s11, 0
  ds_read_b64_tr_b16 v[86:87], v13 offset:9728
  v_mul_f32 v21, s76, v21
  v_mul_f32 v22, s76, v22
  v_mfma_f32_16x16x32_bf16 v[136:139], v[40:43], v[232:235], v[136:139]
  s_mov_b32 s12, 0
  v_mul_f32 v23, s76, v23
  v_cvt_pk_bf16_f32 v24, v16, v17
  v_cvt_pk_bf16_f32 v25, v18, v19
  v_mfma_f32_16x16x32_bf16 v[152:155], v[44:47], v[232:235], v[152:155]
  s_lshl_b32 s15, s22, 1
  ds_read_b64_tr_b16 v[88:89], v12 offset:8960
  v_cvt_pk_bf16_f32 v26, v20, v21
  v_cvt_pk_bf16_f32 v27, v22, v23
  v_mfma_f32_16x16x32_bf16 v[168:171], v[48:51], v[232:235], v[168:171]
  s_add_u32 s23, s15, 6
  ds_read_b64_tr_b16 v[90:91], v12 offset:9984
  buffer_store_dwordx4 v[24:27], v2, s[40:43], s64 offen offset:0 sc1
  v_accvgpr_read_b32 v16, a136
  v_mfma_f32_16x16x32_bf16 v[184:187], v[52:55], v[232:235], v[184:187]
  s_sub_u32 s15, 24, s15
  ds_read_b64_tr_b16 v[92:93], v13 offset:8960
  v_accvgpr_read_b32 v17, a137
  v_accvgpr_read_b32 v18, a138
  v_mfma_f32_16x16x32_bf16 v[200:203], v[56:59], v[232:235], v[200:203]
  s_max_u32 s15, s15, s23
  ds_read_b64_tr_b16 v[94:95], v13 offset:9984
  v_accvgpr_read_b32 v19, a139
  v_mfma_f32_16x16x32_bf16 v[216:219], v[60:63], v[232:235], v[216:219]
  s_lshl_b32 s15, s15, 14
  v_accvgpr_read_b32 v20, a140
  v_accvgpr_read_b32 v21, a141
  v_accvgpr_read_b32 v22, a142
  v_mfma_f32_16x16x32_bf16 v[108:111], v[32:35], v[236:239], v[108:111]
  ds_read_b128 v[248:251], v14 offset:34816
  v_accvgpr_read_b32 v23, a143
  v_mul_f32 v16, s76, v16
  v_mfma_f32_16x16x32_bf16 v[124:127], v[36:39], v[236:239], v[124:127]
  ds_read_b128 v[252:255], v14 offset:35840
  v_mul_f32 v17, s76, v17
  v_mul_f32 v18, s76, v18
  v_mfma_f32_16x16x32_bf16 v[140:143], v[40:43], v[236:239], v[140:143]
  v_mul_f32 v19, s76, v19
  v_mul_f32 v20, s76, v20
  v_mul_f32 v21, s76, v21
  v_mfma_f32_16x16x32_bf16 v[156:159], v[44:47], v[236:239], v[156:159]
  v_xor_b32 v14, 0x10000, v14
  v_mul_f32 v22, s76, v22
  v_mul_f32 v23, s76, v23
  v_mfma_f32_16x16x32_bf16 v[172:175], v[48:51], v[236:239], v[172:175]
  v_cvt_pk_bf16_f32 v28, v16, v17
  v_cvt_pk_bf16_f32 v29, v18, v19
  v_cvt_pk_bf16_f32 v30, v20, v21
  v_mfma_f32_16x16x32_bf16 v[188:191], v[52:55], v[236:239], v[188:191]
  v_cvt_pk_bf16_f32 v31, v22, v23
  v_mfma_f32_16x16x32_bf16 v[204:207], v[56:59], v[236:239], v[204:207]
  buffer_store_dwordx4 v[28:31], v2, s[40:43], s64 offen offset:1024 sc1
  v_mfma_f32_16x16x32_bf16 v[220:223], v[60:63], v[236:239], v[220:223]
  s_waitcnt vmcnt(12) lgkmcnt(0)
  v_mfma_f32_16x16x32_bf16 v[96:99], v[64:67], v[240:243], v[96:99]
  s_barrier
  v_accvgpr_read_b32 v16, a144
  v_accvgpr_read_b32 v17, a145
  v_accvgpr_read_b32 v18, a146
  v_accvgpr_read_b32 v19, a147
  v_mfma_f32_16x16x32_bf16 v[112:115], v[68:71], v[240:243], v[112:115]
  s_and_b32 s23, s20, 1
  ds_read_b64_tr_b16 v[32:33], v12 offset:32768
  v_accvgpr_read_b32 v20, a148
  v_accvgpr_read_b32 v21, a149
  v_mfma_f32_16x16x32_bf16 v[128:131], v[72:75], v[240:243], v[128:131]
  s_lshl_b32 s23, s23, 12
  ds_read_b64_tr_b16 v[34:35], v12 offset:33792
  v_accvgpr_read_b32 v22, a150
  v_accvgpr_read_b32 v23, a151
  v_mfma_f32_16x16x32_bf16 v[144:147], v[76:79], v[240:243], v[144:147]
  s_cmp_lt_u32 s20, 2
  s_cselect_b32 s24, 106496, 0
  v_mul_f32 v16, s76, v16
  v_mul_f32 v17, s76, v17
  v_mul_f32 v18, s76, v18
  v_mfma_f32_16x16x32_bf16 v[160:163], v[80:83], v[240:243], v[160:163]
  s_add_u32 s24, s24, s23
  ds_read_b64_tr_b16 v[36:37], v13 offset:32768
  v_mul_f32 v19, s76, v19
  v_mul_f32 v20, s76, v20
  v_mfma_f32_16x16x32_bf16 v[176:179], v[84:87], v[240:243], v[176:179]
  s_lshl_b32 s26, s20, 12
  ds_read_b64_tr_b16 v[38:39], v13 offset:33792
  v_mul_f32 v21, s76, v21
  v_mul_f32 v22, s76, v22
  v_mfma_f32_16x16x32_bf16 v[192:195], v[88:91], v[240:243], v[192:195]
  s_mov_b32 s27, s26
  ds_read_b64_tr_b16 v[40:41], v12 offset:33024
  v_mul_f32 v23, s76, v23
  v_cvt_pk_bf16_f32 v24, v16, v17
  v_mfma_f32_16x16x32_bf16 v[208:211], v[92:95], v[240:243], v[208:211]
  s_add_u32 s25, s27, 49152
  ds_read_b64_tr_b16 v[42:43], v12 offset:34048
  v_cvt_pk_bf16_f32 v25, v18, v19
  v_cvt_pk_bf16_f32 v26, v20, v21
  v_cvt_pk_bf16_f32 v27, v22, v23
  v_mfma_f32_16x16x32_bf16 v[100:103], v[64:67], v[244:247], v[100:103]
  s_load_dwordx4 s[4:7], s[0:1], 64
  buffer_store_dwordx4 v[24:27], v2, s[40:43], s64 offen offset:2048 sc1
  v_accvgpr_read_b32 v16, a152
  v_accvgpr_read_b32 v17, a153
  v_mfma_f32_16x16x32_bf16 v[116:119], v[68:71], v[244:247], v[116:119]
  s_load_dwordx2 s[60:61], s[0:1], 80
  ds_read_b64_tr_b16 v[44:45], v13 offset:33024
  v_accvgpr_read_b32 v18, a154
  v_accvgpr_read_b32 v19, a155
  v_mfma_f32_16x16x32_bf16 v[132:135], v[72:75], v[244:247], v[132:135]
  s_add_u32 s23, s20, 1
  ds_read_b64_tr_b16 v[46:47], v13 offset:34048
  v_accvgpr_read_b32 v20, a156
  v_accvgpr_read_b32 v21, a157
  v_mfma_f32_16x16x32_bf16 v[148:151], v[76:79], v[244:247], v[148:151]
  s_lshr_b32 s23, s23, 1
  ds_read_b128 v[224:227], v14 offset:0
  v_accvgpr_read_b32 v22, a158
  v_accvgpr_read_b32 v23, a159
  v_mfma_f32_16x16x32_bf16 v[164:167], v[80:83], v[244:247], v[164:167]
  s_lshl_b32 s28, s22, 1
  ds_read_b128 v[228:231], v14 offset:1024
  v_mul_f32 v16, s76, v16
  v_mul_f32 v17, s76, v17
  v_mfma_f32_16x16x32_bf16 v[180:183], v[84:87], v[244:247], v[180:183]
  s_add_u32 s28, s28, s23
  v_mul_f32 v18, s76, v18
  v_mul_f32 v19, s76, v19
  v_mul_f32 v20, s76, v20
  v_mfma_f32_16x16x32_bf16 v[196:199], v[88:91], v[244:247], v[196:199]
  s_lshl_b32 s23, s22, 2
  ds_read_b64_tr_b16 v[48:49], v12 offset:33280
  v_mul_f32 v21, s76, v21
  v_mul_f32 v22, s76, v22
  v_mfma_f32_16x16x32_bf16 v[212:215], v[92:95], v[244:247], v[212:215]
  s_sub_u32 s29, 28, s23
  ds_read_b64_tr_b16 v[50:51], v12 offset:34304
  v_mul_f32 v23, s76, v23
  v_cvt_pk_bf16_f32 v28, v16, v17
  v_cvt_pk_bf16_f32 v29, v18, v19
  v_mfma_f32_16x16x32_bf16 v[104:107], v[64:67], v[248:251], v[104:107]
  s_and_b32 s23, s20, 1
  ds_read_b64_tr_b16 v[52:53], v13 offset:33280
  v_cvt_pk_bf16_f32 v30, v20, v21
  v_cvt_pk_bf16_f32 v31, v22, v23
  v_mfma_f32_16x16x32_bf16 v[120:123], v[68:71], v[248:251], v[120:123]
  s_add_u32 s29, s29, s23
  ds_read_b64_tr_b16 v[54:55], v13 offset:34304
  buffer_store_dwordx4 v[28:31], v2, s[40:43], s64 offen offset:3072 sc1
  v_accvgpr_read_b32 v16, a160
  v_mfma_f32_16x16x32_bf16 v[136:139], v[72:75], v[248:251], v[136:139]
  s_add_u32 s64, s64, 4096
  v_accvgpr_read_b32 v17, a161
  v_accvgpr_read_b32 v18, a162
  v_accvgpr_read_b32 v19, a163
  v_mfma_f32_16x16x32_bf16 v[152:155], v[76:79], v[248:251], v[152:155]
  ds_read_b64_tr_b16 v[56:57], v12 offset:33536
  v_accvgpr_read_b32 v20, a164
  v_accvgpr_read_b32 v21, a165
  v_mfma_f32_16x16x32_bf16 v[168:171], v[80:83], v[248:251], v[168:171]
  ds_read_b64_tr_b16 v[58:59], v12 offset:34560
  v_accvgpr_read_b32 v22, a166
  v_accvgpr_read_b32 v23, a167
  v_mfma_f32_16x16x32_bf16 v[184:187], v[84:87], v[248:251], v[184:187]
  ds_read_b64_tr_b16 v[60:61], v13 offset:33536
  v_mul_f32 v16, s76, v16
  v_mul_f32 v17, s76, v17
  v_mfma_f32_16x16x32_bf16 v[200:203], v[88:91], v[248:251], v[200:203]
  ds_read_b64_tr_b16 v[62:63], v13 offset:34560
  v_mul_f32 v18, s76, v18
  v_mul_f32 v19, s76, v19
  v_mul_f32 v20, s76, v20
  v_mfma_f32_16x16x32_bf16 v[216:219], v[92:95], v[248:251], v[216:219]
  v_mul_f32 v21, s76, v21
  v_mul_f32 v22, s76, v22
  v_mul_f32 v23, s76, v23
  v_mfma_f32_16x16x32_bf16 v[108:111], v[64:67], v[252:255], v[108:111]
  ds_read_b128 v[232:235], v14 offset:2048
  v_cvt_pk_bf16_f32 v24, v16, v17
  v_cvt_pk_bf16_f32 v25, v18, v19
  v_mfma_f32_16x16x32_bf16 v[124:127], v[68:71], v[252:255], v[124:127]
  ds_read_b128 v[236:239], v14 offset:3072
  v_cvt_pk_bf16_f32 v26, v20, v21
  v_cvt_pk_bf16_f32 v27, v22, v23
  v_mfma_f32_16x16x32_bf16 v[140:143], v[72:75], v[252:255], v[140:143]
  buffer_store_dwordx4 v[24:27], v2, s[40:43], s64 offen offset:0 sc1
  v_lshrrev_b32 v6, 2, v1
  v_mul_u32_u24 v6, 160, v6
  v_mfma_f32_16x16x32_bf16 v[156:159], v[76:79], v[252:255], v[156:159]
  v_and_b32 v9, 3, v1
  v_lshl_add_u32 v6, v9, 3, v6
  v_add_u32 v6, s34, v6
  v_mfma_f32_16x16x32_bf16 v[172:175], v[80:83], v[252:255], v[172:175]
  v_mov_b32 v3, v2
  v_mov_b32 v4, 0xff800000
  v_add_u32 v9, 106496, v2
  v_mfma_f32_16x16x32_bf16 v[188:191], v[84:87], v[252:255], v[188:191]
  v_mfma_f32_16x16x32_bf16 v[204:207], v[88:91], v[252:255], v[204:207]
  v_mfma_f32_16x16x32_bf16 v[220:223], v[92:95], v[252:255], v[220:223]
  s_waitcnt vmcnt(8) lgkmcnt(0)
  v_mfma_f32_16x16x32_bf16 v[96:99], v[32:35], v[224:227], v[96:99]
  v_accvgpr_read_b32 v16, a168
  v_accvgpr_read_b32 v17, a169
  v_accvgpr_read_b32 v18, a170
  v_mfma_f32_16x16x32_bf16 v[112:115], v[36:39], v[224:227], v[112:115]
  s_cmp_ge_u32 s20, 2
  s_cselect_b32 s4, s6, s4
  s_cselect_b32 s5, s7, s5
  ds_read_b64_tr_b16 v[64:65], v12 offset:40960
  v_accvgpr_read_b32 v19, a171
  v_accvgpr_read_b32 v20, a172
  v_mfma_f32_16x16x32_bf16 v[128:131], v[40:43], v[224:227], v[128:131]
  s_mov_b32 s62, 2211840
  ds_read_b64_tr_b16 v[66:67], v12 offset:41984
  v_accvgpr_read_b32 v21, a173
  v_accvgpr_read_b32 v22, a174
  v_mfma_f32_16x16x32_bf16 v[144:147], v[44:47], v[224:227], v[144:147]
  s_mov_b32 s63, 0x20000
  v_accvgpr_read_b32 v23, a175
  v_mul_f32 v16, s76, v16
  v_mul_f32 v17, s76, v17
  v_mfma_f32_16x16x32_bf16 v[160:163], v[48:51], v[224:227], v[160:163]
  s_mov_b64 s[56:57], s[52:53]
  ds_read_b64_tr_b16 v[68:69], v13 offset:40960
  v_mul_f32 v18, s76, v18
  v_mfma_f32_16x16x32_bf16 v[176:179], v[52:55], v[224:227], v[176:179]
  s_mov_b32 s58, s54
  ds_read_b64_tr_b16 v[70:71], v13 offset:41984
  v_mul_f32 v19, s76, v19
  v_mul_f32 v20, s76, v20
  v_mfma_f32_16x16x32_bf16 v[192:195], v[56:59], v[224:227], v[192:195]
  s_mov_b64 s[52:53], s[4:5]
  ds_read_b64_tr_b16 v[72:73], v12 offset:41216
  v_mul_f32 v21, s76, v21
  v_mul_f32 v22, s76, v22
  v_mfma_f32_16x16x32_bf16 v[208:211], v[60:63], v[224:227], v[208:211]
  s_mov_b32 s54, 2211840
  ds_read_b64_tr_b16 v[74:75], v12 offset:42240
  v_mul_f32 v23, s76, v23
  v_cvt_pk_bf16_f32 v28, v16, v17
  v_mfma_f32_16x16x32_bf16 v[100:103], v[32:35], v[228:231], v[100:103]
  s_getpc_b64 s[36:37]
fa_copc:
  v_cvt_pk_bf16_f32 v29, v18, v19
  v_cvt_pk_bf16_f32 v30, v20, v21
  v_cvt_pk_bf16_f32 v31, v22, v23
  v_mfma_f32_16x16x32_bf16 v[116:119], v[36:39], v[228:231], v[116:119]
  s_add_u32 s36, s36, fa_co-fa_copc-4
  s_addc_u32 s37, s37, 0
  ds_read_b64_tr_b16 v[76:77], v13 offset:41216
  buffer_store_dwordx4 v[28:31], v2, s[40:43], s64 offen offset:1024 sc1
  v_mfma_f32_16x16x32_bf16 v[132:135], v[40:43], v[228:231], v[132:135]
  ds_read_b64_tr_b16 v[78:79], v13 offset:42240
  v_accvgpr_read_b32 v16, a176
  v_accvgpr_read_b32 v17, a177
  v_mfma_f32_16x16x32_bf16 v[148:151], v[44:47], v[228:231], v[148:151]
  ds_read_b128 v[240:243], v14 offset:32768
  v_accvgpr_read_b32 v18, a178
  v_accvgpr_read_b32 v19, a179
  v_mfma_f32_16x16x32_bf16 v[164:167], v[48:51], v[228:231], v[164:167]
  ds_read_b128 v[244:247], v14 offset:33792
  v_accvgpr_read_b32 v20, a180
  v_accvgpr_read_b32 v21, a181
  v_mfma_f32_16x16x32_bf16 v[180:183], v[52:55], v[228:231], v[180:183]
  v_accvgpr_read_b32 v22, a182
  v_accvgpr_read_b32 v23, a183
  v_mul_f32 v16, s76, v16
  v_mfma_f32_16x16x32_bf16 v[196:199], v[56:59], v[228:231], v[196:199]
  ds_read_b64_tr_b16 v[80:81], v12 offset:41472
  v_mul_f32 v17, s76, v17
  v_mfma_f32_16x16x32_bf16 v[212:215], v[60:63], v[228:231], v[212:215]
  ds_read_b64_tr_b16 v[82:83], v12 offset:42496
  v_mul_f32 v18, s76, v18
  v_mul_f32 v19, s76, v19
  v_mfma_f32_16x16x32_bf16 v[104:107], v[32:35], v[232:235], v[104:107]
  ds_read_b64_tr_b16 v[84:85], v13 offset:41472
  v_mul_f32 v20, s76, v20
  v_mul_f32 v21, s76, v21
  v_mfma_f32_16x16x32_bf16 v[120:123], v[36:39], v[232:235], v[120:123]
  ds_read_b64_tr_b16 v[86:87], v13 offset:42496
  v_mul_f32 v22, s76, v22
  v_mul_f32 v23, s76, v23
  v_mfma_f32_16x16x32_bf16 v[136:139], v[40:43], v[232:235], v[136:139]
  v_cvt_pk_bf16_f32 v24, v16, v17
  v_cvt_pk_bf16_f32 v25, v18, v19
  v_cvt_pk_bf16_f32 v26, v20, v21
  v_mfma_f32_16x16x32_bf16 v[152:155], v[44:47], v[232:235], v[152:155]
  ds_read_b64_tr_b16 v[88:89], v12 offset:41728
  v_cvt_pk_bf16_f32 v27, v22, v23
  v_mfma_f32_16x16x32_bf16 v[168:171], v[48:51], v[232:235], v[168:171]
  ds_read_b64_tr_b16 v[90:91], v12 offset:42752
  buffer_store_dwordx4 v[24:27], v2, s[40:43], s64 offen offset:2048 sc1
  v_accvgpr_read_b32 v16, a184
  v_mfma_f32_16x16x32_bf16 v[184:187], v[52:55], v[232:235], v[184:187]
  ds_read_b64_tr_b16 v[92:93], v13 offset:41728
  v_accvgpr_read_b32 v17, a185
  v_accvgpr_read_b32 v18, a186
  v_mfma_f32_16x16x32_bf16 v[200:203], v[56:59], v[232:235], v[200:203]
  ds_read_b64_tr_b16 v[94:95], v13 offset:42752
  v_accvgpr_read_b32 v19, a187
  v_accvgpr_read_b32 v20, a188
  v_mfma_f32_16x16x32_bf16 v[216:219], v[60:63], v[232:235], v[216:219]
  v_accvgpr_read_b32 v21, a189
  v_accvgpr_read_b32 v22, a190
  v_accvgpr_read_b32 v23, a191
  v_mfma_f32_16x16x32_bf16 v[108:111], v[32:35], v[236:239], v[108:111]
  ds_read_b128 v[248:251], v14 offset:34816
  v_mul_f32 v16, s76, v16
  v_mfma_f32_16x16x32_bf16 v[124:127], v[36:39], v[236:239], v[124:127]
  ds_read_b128 v[252:255], v14 offset:35840
  v_mul_f32 v17, s76, v17
  v_mul_f32 v18, s76, v18
  v_mfma_f32_16x16x32_bf16 v[140:143], v[40:43], v[236:239], v[140:143]
  v_mul_f32 v19, s76, v19
  v_mul_f32 v20, s76, v20
  v_mul_f32 v21, s76, v21
  v_mfma_f32_16x16x32_bf16 v[156:159], v[44:47], v[236:239], v[156:159]
  v_xor_b32 v14, 0x10000, v14
  v_mul_f32 v22, s76, v22
  v_mul_f32 v23, s76, v23
  v_mfma_f32_16x16x32_bf16 v[172:175], v[48:51], v[236:239], v[172:175]
  v_cvt_pk_bf16_f32 v28, v16, v17
  v_cvt_pk_bf16_f32 v29, v18, v19
  v_cvt_pk_bf16_f32 v30, v20, v21
  v_mfma_f32_16x16x32_bf16 v[188:191], v[52:55], v[236:239], v[188:191]
  v_xor_b32 v12, 0x10000, v12
  v_cvt_pk_bf16_f32 v31, v22, v23
  v_mfma_f32_16x16x32_bf16 v[204:207], v[56:59], v[236:239], v[204:207]
  buffer_store_dwordx4 v[28:31], v2, s[40:43], s64 offen offset:3072 sc1
  v_xor_b32 v13, 0x10000, v13
  v_mfma_f32_16x16x32_bf16 v[220:223], v[60:63], v[236:239], v[220:223]
  s_waitcnt vmcnt(9) lgkmcnt(0)
  v_mfma_f32_16x16x32_bf16 v[96:99], v[64:67], v[240:243], v[96:99]
  s_barrier
  v_cmp_eq_u32 vcc, 0, v15
  v_accvgpr_write_b32 a48, 0
  v_accvgpr_write_b32 a49, 0
  v_accvgpr_write_b32 a50, 0
  v_accvgpr_write_b32 a51, 0
  v_mfma_f32_16x16x32_bf16 v[112:115], v[68:71], v[240:243], v[112:115]
  s_cbranch_vccnz fa_kv_spin
fa_kv_ok:
  v_accvgpr_write_b32 a52, 0
  v_accvgpr_write_b32 a53, 0
  v_accvgpr_write_b32 a54, 0
  v_accvgpr_write_b32 a55, 0
  v_mfma_f32_16x16x32_bf16 v[128:131], v[72:75], v[240:243], v[128:131]
  s_mov_b32 m0, s24
  v_accvgpr_write_b32 a56, 0
  v_accvgpr_write_b32 a57, 0
  v_accvgpr_write_b32 a58, 0
  v_accvgpr_write_b32 a59, 0
  v_mfma_f32_16x16x32_bf16 v[144:147], v[76:79], v[240:243], v[144:147]
  buffer_load_dwordx4 v2, s[44:47], s26 offen offset:0 sc1 lds
  v_accvgpr_write_b32 a60, 0
  v_accvgpr_write_b32 a61, 0
  v_accvgpr_write_b32 a62, 0
  v_mfma_f32_16x16x32_bf16 v[160:163], v[80:83], v[240:243], v[160:163]
  s_add_u32 s24, s24, 32768
  v_accvgpr_write_b32 a63, 0
  v_accvgpr_write_b32 a64, 0
  v_accvgpr_write_b32 a65, 0
  v_accvgpr_write_b32 a66, 0
  v_mfma_f32_16x16x32_bf16 v[176:179], v[84:87], v[240:243], v[176:179]
  s_and_b32 s24, s24, 0x1ffff
  buffer_load_dwordx4 v2, s[44:47], s26 offen offset:1024 sc1 lds
  v_accvgpr_write_b32 a67, 0
  v_accvgpr_write_b32 a68, 0
  v_accvgpr_write_b32 a69, 0
  v_mfma_f32_16x16x32_bf16 v[192:195], v[88:91], v[240:243], v[192:195]
  v_accvgpr_write_b32 a70, 0
  v_accvgpr_write_b32 a71, 0
  v_accvgpr_write_b32 a72, 0
  v_accvgpr_write_b32 a73, 0
  v_mfma_f32_16x16x32_bf16 v[208:211], v[92:95], v[240:243], v[208:211]
  buffer_load_dwordx4 v2, s[44:47], s26 offen offset:2048 sc1 lds
  v_accvgpr_write_b32 a74, 0
  v_accvgpr_write_b32 a75, 0
  v_accvgpr_write_b32 a76, 0
  v_mfma_f32_16x16x32_bf16 v[100:103], v[64:67], v[244:247], v[100:103]
  v_accvgpr_write_b32 a77, 0
  v_accvgpr_write_b32 a78, 0
  v_accvgpr_write_b32 a79, 0
  v_accvgpr_write_b32 a80, 0
  v_mfma_f32_16x16x32_bf16 v[116:119], v[68:71], v[244:247], v[116:119]
  buffer_load_dwordx4 v2, s[44:47], s26 offen offset:3072 sc1 lds
  v_accvgpr_write_b32 a81, 0
  v_accvgpr_write_b32 a82, 0
  v_accvgpr_write_b32 a83, 0
  v_mfma_f32_16x16x32_bf16 v[132:135], v[72:75], v[244:247], v[132:135]
  s_add_u32 s26, s26, 16384
  v_cvt_pk_bf16_f32 v32, v96, v97
  v_cvt_pk_bf16_f32 v33, v98, v99
  v_accvgpr_write_b32 a84, 0
  v_accvgpr_write_b32 a85, 0
  v_mfma_f32_16x16x32_bf16 v[148:151], v[76:79], v[244:247], v[148:151]
  v_cvt_pk_bf16_f32 v34, v112, v113
  v_cvt_pk_bf16_f32 v35, v114, v115
  v_accvgpr_write_b32 a86, 0
  v_accvgpr_write_b32 a87, 0
  v_mfma_f32_16x16x32_bf16 v[164:167], v[80:83], v[244:247], v[164:167]
  s_mov_b32 m0, s24
  v_cvt_pk_bf16_f32 v40, v128, v129
  v_accvgpr_write_b32 a88, 0
  v_accvgpr_write_b32 a89, 0
  v_accvgpr_write_b32 a90, 0
  v_mfma_f32_16x16x32_bf16 v[180:183], v[84:87], v[244:247], v[180:183]
  buffer_load_dwordx4 v2, s[44:47], s26 offen offset:0 sc1 lds
  v_cvt_pk_bf16_f32 v41, v130, v131
  v_cvt_pk_bf16_f32 v42, v144, v145
  v_accvgpr_write_b32 a91, 0
  v_accvgpr_write_b32 a92, 0
  v_mfma_f32_16x16x32_bf16 v[196:199], v[88:91], v[244:247], v[196:199]
  s_add_u32 s24, s24, 32768
  v_cvt_pk_bf16_f32 v43, v146, v147
  v_accvgpr_write_b32 a93, 0
  v_accvgpr_write_b32 a94, 0
  v_accvgpr_write_b32 a95, 0
  v_mfma_f32_16x16x32_bf16 v[212:215], v[92:95], v[244:247], v[212:215]
  s_and_b32 s24, s24, 0x1ffff
  buffer_load_dwordx4 v2, s[44:47], s26 offen offset:1024 sc1 lds
  v_cvt_pk_bf16_f32 v48, v160, v161
  v_cvt_pk_bf16_f32 v49, v162, v163
  v_accvgpr_write_b32 a96, 0
  v_accvgpr_write_b32 a97, 0
  v_mfma_f32_16x16x32_bf16 v[104:107], v[64:67], v[248:251], v[104:107]
  v_cvt_pk_bf16_f32 v50, v176, v177
  v_cvt_pk_bf16_f32 v51, v178, v179
  v_accvgpr_write_b32 a98, 0
  v_accvgpr_write_b32 a99, 0
  v_mfma_f32_16x16x32_bf16 v[120:123], v[68:71], v[248:251], v[120:123]
  buffer_load_dwordx4 v2, s[44:47], s26 offen offset:2048 sc1 lds
  v_cvt_pk_bf16_f32 v56, v192, v193
  v_accvgpr_write_b32 a100, 0
  v_accvgpr_write_b32 a101, 0
  v_mfma_f32_16x16x32_bf16 v[136:139], v[72:75], v[248:251], v[136:139]
  v_cvt_pk_bf16_f32 v57, v194, v195
  v_cvt_pk_bf16_f32 v58, v208, v209
  v_accvgpr_write_b32 a102, 0
  v_accvgpr_write_b32 a103, 0
  v_mfma_f32_16x16x32_bf16 v[152:155], v[76:79], v[248:251], v[152:155]
  buffer_load_dwordx4 v2, s[44:47], s26 offen offset:3072 sc1 lds
  v_cvt_pk_bf16_f32 v59, v210, v211
  v_accvgpr_write_b32 a104, 0
  v_accvgpr_write_b32 a105, 0
  v_mfma_f32_16x16x32_bf16 v[168:171], v[80:83], v[248:251], v[168:171]
  s_add_u32 s26, s26, 16384
  v_cvt_pk_bf16_f32 v36, v100, v101
  v_cvt_pk_bf16_f32 v37, v102, v103
  v_accvgpr_write_b32 a106, 0
  v_accvgpr_write_b32 a107, 0
  v_mfma_f32_16x16x32_bf16 v[184:187], v[84:87], v[248:251], v[184:187]
  v_cvt_pk_bf16_f32 v38, v116, v117
  v_accvgpr_write_b32 a108, 0
  v_accvgpr_write_b32 a109, 0
  v_accvgpr_write_b32 a110, 0
  v_mfma_f32_16x16x32_bf16 v[200:203], v[88:91], v[248:251], v[200:203]
  s_mov_b32 m0, s24
  v_cvt_pk_bf16_f32 v39, v118, v119
  v_cvt_pk_bf16_f32 v44, v132, v133
  v_accvgpr_write_b32 a111, 0
  v_accvgpr_write_b32 a112, 0
  v_mfma_f32_16x16x32_bf16 v[216:219], v[92:95], v[248:251], v[216:219]
  buffer_load_dwordx4 v2, s[44:47], s26 offen offset:0 sc1 lds
  v_cvt_pk_bf16_f32 v45, v134, v135
  v_accvgpr_write_b32 a113, 0
  v_accvgpr_write_b32 a114, 0
  v_mfma_f32_16x16x32_bf16 v[108:111], v[64:67], v[252:255], v[108:111]
  s_add_u32 s24, s24, 32768
  v_cvt_pk_bf16_f32 v46, v148, v149
  v_cvt_pk_bf16_f32 v47, v150, v151
  v_accvgpr_write_b32 a115, 0
  v_accvgpr_write_b32 a116, 0
  v_mfma_f32_16x16x32_bf16 v[124:127], v[68:71], v[252:255], v[124:127]
  s_and_b32 s24, s24, 0x1ffff
  buffer_load_dwordx4 v2, s[44:47], s26 offen offset:1024 sc1 lds
  v_cvt_pk_bf16_f32 v52, v164, v165
  v_accvgpr_write_b32 a117, 0
  v_accvgpr_write_b32 a118, 0
  v_mfma_f32_16x16x32_bf16 v[140:143], v[72:75], v[252:255], v[140:143]
  v_cvt_pk_bf16_f32 v53, v166, v167
  v_cvt_pk_bf16_f32 v54, v180, v181
  v_accvgpr_write_b32 a119, 0
  v_accvgpr_write_b32 a120, 0
  v_mfma_f32_16x16x32_bf16 v[156:159], v[76:79], v[252:255], v[156:159]
  buffer_load_dwordx4 v2, s[44:47], s26 offen offset:2048 sc1 lds
  v_cvt_pk_bf16_f32 v55, v182, v183
  v_accvgpr_write_b32 a121, 0
  v_accvgpr_write_b32 a122, 0
  v_mfma_f32_16x16x32_bf16 v[172:175], v[80:83], v[252:255], v[172:175]
  v_cvt_pk_bf16_f32 v60, v196, v197
  v_cvt_pk_bf16_f32 v61, v198, v199
  v_accvgpr_write_b32 a123, 0
  v_accvgpr_write_b32 a124, 0
  v_mfma_f32_16x16x32_bf16 v[188:191], v[84:87], v[252:255], v[188:191]
  buffer_load_dwordx4 v2, s[44:47], s26 offen offset:3072 sc1 lds
  v_cvt_pk_bf16_f32 v62, v212, v213
  v_accvgpr_write_b32 a125, 0
  v_accvgpr_write_b32 a126, 0
  v_mfma_f32_16x16x32_bf16 v[204:207], v[88:91], v[252:255], v[204:207]
  s_add_u32 s26, s26, 16384
  v_cvt_pk_bf16_f32 v63, v214, v215
  v_accvgpr_write_b32 a127, 0
  v_mfma_f32_16x16x32_bf16 v[220:223], v[92:95], v[252:255], v[220:223]
  s_mov_b32 m0, s25
  s_nop 0
  buffer_load_dwordx4 v2, s[48:51], s27 offen offset:0 sc1 lds
  v_cvt_pk_bf16_f32 v64, v104, v105
  v_cvt_pk_bf16_f32 v65, v106, v107
  v_cvt_pk_bf16_f32 v66, v120, v121
  v_cvt_pk_bf16_f32 v67, v122, v123
  v_cvt_pk_bf16_f32 v72, v136, v137
  buffer_load_dwordx4 v2, s[48:51], s27 offen offset:1024 sc1 lds
  v_cvt_pk_bf16_f32 v73, v138, v139
  v_cvt_pk_bf16_f32 v74, v152, v153
  v_cvt_pk_bf16_f32 v75, v154, v155
  v_cvt_pk_bf16_f32 v80, v168, v169
  v_cvt_pk_bf16_f32 v81, v170, v171
  buffer_load_dwordx4 v2, s[48:51], s27 offen offset:2048 sc1 lds
  v_cvt_pk_bf16_f32 v82, v184, v185
  v_cvt_pk_bf16_f32 v83, v186, v187
  v_cvt_pk_bf16_f32 v88, v200, v201
  v_cvt_pk_bf16_f32 v89, v202, v203
  v_cvt_pk_bf16_f32 v90, v216, v217
  buffer_load_dwordx4 v2, s[48:51], s27 offen offset:3072 sc1 lds
  v_cvt_pk_bf16_f32 v91, v218, v219
  v_cvt_pk_bf16_f32 v68, v108, v109
  v_cvt_pk_bf16_f32 v69, v110, v111
  v_cvt_pk_bf16_f32 v70, v124, v125
  v_cvt_pk_bf16_f32 v71, v126, v127
  s_add_u32 s27, s27, 16384
  s_add_u32 s25, s25, 32768
  s_and_b32 s25, s25, 0x1ffff
  s_mov_b32 m0, s25
  s_nop 0
  buffer_load_dwordx4 v2, s[48:51], s27 offen offset:0 sc1 lds
  v_cvt_pk_bf16_f32 v76, v140, v141
  v_cvt_pk_bf16_f32 v77, v142, v143
  v_cvt_pk_bf16_f32 v78, v156, v157
  v_cvt_pk_bf16_f32 v79, v158, v159
  v_cvt_pk_bf16_f32 v84, v172, v173
  buffer_load_dwordx4 v2, s[48:51], s27 offen offset:1024 sc1 lds
  v_cvt_pk_bf16_f32 v85, v174, v175
  v_cvt_pk_bf16_f32 v86, v188, v189
  v_cvt_pk_bf16_f32 v87, v190, v191
  v_cvt_pk_bf16_f32 v92, v204, v205
  v_cvt_pk_bf16_f32 v93, v206, v207
  buffer_load_dwordx4 v2, s[48:51], s27 offen offset:2048 sc1 lds
  v_cvt_pk_bf16_f32 v94, v220, v221
  v_cvt_pk_bf16_f32 v95, v222, v223
  v_mov_b32 v228, 0
  v_mov_b32 v229, 0
  v_mov_b32 v230, 0
  buffer_load_dwordx4 v2, s[48:51], s27 offen offset:3072 sc1 lds
  v_mov_b32 v231, 0
  s_add_u32 s27, s27, 16384
  s_add_u32 s25, s25, 32768
  s_and_b32 s25, s25, 0x1ffff
  s_waitcnt vmcnt(12)
  s_barrier
  ds_read_b128 a[128:131], v9 offset:0
  ds_read_b128 a[132:135], v9 offset:1024
  ds_read_b128 a[136:139], v9 offset:2048
  ds_read_b128 a[140:143], v9 offset:3072
  ds_read_b128 a[144:147], v9 offset:4096
  ds_read_b128 a[148:151], v9 offset:5120
  ds_read_b128 a[152:155], v9 offset:6144
  ds_read_b128 a[156:159], v9 offset:7168
  buffer_store_dword v4, off, s[40:43], s65 offset:32 sc1
  v_add_u32 v13, 32, v8
  v_mov_b32 v14, 0
  s_cmp_eq_u32 s2, 255
  s_cbranch_scc1 fa_top8
fa_notop:
  s_waitcnt lgkmcnt(4)
  v_mfma_f32_16x16x32_bf16 v[96:99], a[128:131], v[32:35], 0
  v_mfma_f32_16x16x32_bf16 v[104:107], a[128:131], v[36:39], 0
  v_mfma_f32_16x16x32_bf16 v[128:131], a[128:131], v[64:67], 0
  v_mfma_f32_16x16x32_bf16 v[136:139], a[128:131], v[68:71], 0
  s_mov_b32 m0, s24
  ds_read_b128 a[128:131], v3 offset:0
  v_mfma_f32_16x16x32_bf16 v[100:103], a[132:135], v[32:35], 0
  buffer_load_dwordx4 v2, s[44:47], s26 offen offset:0 sc1 lds
  v_mfma_f32_16x16x32_bf16 v[108:111], a[132:135], v[36:39], 0
  v_mfma_f32_16x16x32_bf16 v[132:135], a[132:135], v[64:67], 0
  v_mfma_f32_16x16x32_bf16 v[140:143], a[132:135], v[68:71], 0
  ds_read_b128 a[132:135], v3 offset:1024
  v_mfma_f32_16x16x32_bf16 v[96:99], a[136:139], v[40:43], v[96:99]
  v_mfma_f32_16x16x32_bf16 v[104:107], a[136:139], v[44:47], v[104:107]
  v_mfma_f32_16x16x32_bf16 v[128:131], a[136:139], v[72:75], v[128:131]
  buffer_load_dwordx4 v2, s[44:47], s26 offen offset:1024 sc1 lds
  v_mfma_f32_16x16x32_bf16 v[136:139], a[136:139], v[76:79], v[136:139]
  ds_read_b128 a[136:139], v3 offset:2048
  v_mfma_f32_16x16x32_bf16 v[100:103], a[140:143], v[40:43], v[100:103]
  v_mfma_f32_16x16x32_bf16 v[108:111], a[140:143], v[44:47], v[108:111]
  v_mfma_f32_16x16x32_bf16 v[132:135], a[140:143], v[72:75], v[132:135]
  v_mfma_f32_16x16x32_bf16 v[140:143], a[140:143], v[76:79], v[140:143]
  s_waitcnt lgkmcnt(3)
  ds_read_b128 a[140:143], v3 offset:3072
  v_mfma_f32_16x16x32_bf16 v[96:99], a[144:147], v[48:51], v[96:99]
  v_mfma_f32_16x16x32_bf16 v[104:107], a[144:147], v[52:55], v[104:107]
  v_mfma_f32_16x16x32_bf16 v[128:131], a[144:147], v[80:83], v[128:131]
  buffer_load_dwordx4 v2, s[44:47], s26 offen offset:2048 sc1 lds
  v_mfma_f32_16x16x32_bf16 v[136:139], a[144:147], v[84:87], v[136:139]
  ds_read_b128 a[144:147], v3 offset:4096
  v_mfma_f32_16x16x32_bf16 v[100:103], a[148:151], v[48:51], v[100:103]
  v_mfma_f32_16x16x32_bf16 v[108:111], a[148:151], v[52:55], v[108:111]
  v_mfma_f32_16x16x32_bf16 v[132:135], a[148:151], v[80:83], v[132:135]
  v_mfma_f32_16x16x32_bf16 v[140:143], a[148:151], v[84:87], v[140:143]
  ds_read_b128 a[148:151], v3 offset:5120
  v_mfma_f32_16x16x32_bf16 v[96:99], a[152:155], v[56:59], v[96:99]
  buffer_load_dwordx4 v2, s[44:47], s26 offen offset:3072 sc1 lds
  v_mfma_f32_16x16x32_bf16 v[104:107], a[152:155], v[60:63], v[104:107]
  s_add_u32 s26, s26, 16384
  v_mfma_f32_16x16x32_bf16 v[128:131], a[152:155], v[88:91], v[128:131]
  s_add_u32 s24, s24, 32768
  v_mfma_f32_16x16x32_bf16 v[136:139], a[152:155], v[92:95], v[136:139]
  s_and_b32 s24, s24, 0x1ffff
  ds_read_b128 a[152:155], v3 offset:6144
  v_mfma_f32_16x16x32_bf16 v[100:103], a[156:159], v[56:59], v[100:103]
  v_mfma_f32_16x16x32_bf16 v[108:111], a[156:159], v[60:63], v[108:111]
  v_mfma_f32_16x16x32_bf16 v[132:135], a[156:159], v[88:91], v[132:135]
  v_mfma_f32_16x16x32_bf16 v[140:143], a[156:159], v[92:95], v[140:143]
  s_waitcnt lgkmcnt(3)
  ds_read_b128 a[156:159], v3 offset:7168
  s_nop 7
  s_cmp_lg_u32 s28, 0
  s_cbranch_scc1 fa_nomask0
  v_cndmask_b32 v96, v4, v96, s[68:69]
  v_cndmask_b32 v97, v4, v97, s[70:71]
  v_cndmask_b32 v98, v4, v98, s[72:73]
  v_cndmask_b32 v99, v4, v99, s[74:75]
  v_mov_b32 v100, v4
  v_mov_b32 v101, v4
  v_mov_b32 v102, v4
  v_mov_b32 v103, v4
  v_cndmask_b32 v108, v4, v108, s[68:69]
  v_cndmask_b32 v109, v4, v109, s[70:71]
  v_cndmask_b32 v110, v4, v110, s[72:73]
  v_cndmask_b32 v111, v4, v111, s[74:75]
fa_nomask0:
  v_max3_f32 v16, v96, v97, v98
  v_max3_f32 v16, v16, v99, v100
  v_max3_f32 v16, v16, v101, v102
  v_max_f32 v16, v16, v103
  v_max3_f32 v17, v104, v105, v106
  v_max3_f32 v17, v17, v107, v108
  v_max3_f32 v17, v17, v109, v110
  v_max_f32 v17, v17, v111
  v_max3_f32 v18, v128, v129, v130
  v_max3_f32 v18, v18, v131, v132
  v_max3_f32 v18, v18, v133, v134
  v_max_f32 v18, v18, v135
  v_max3_f32 v19, v136, v137, v138
  v_max3_f32 v19, v19, v139, v140
  v_max3_f32 v19, v19, v141, v142
  v_max_f32 v19, v19, v143
  v_mov_b32 v20, v16
  v_mov_b32 v21, v17
  v_mov_b32 v22, v18
  v_mov_b32 v23, v19
  s_nop 0
  v_permlane16_swap_b32 v16, v20
  v_permlane16_swap_b32 v17, v21
  v_permlane16_swap_b32 v18, v22
  v_permlane16_swap_b32 v19, v23
  v_max_f32 v16, v16, v20
  v_max_f32 v17, v17, v21
  v_max_f32 v18, v18, v22
  v_max_f32 v19, v19, v23
  v_mov_b32 v20, v16
  v_mov_b32 v21, v17
  v_mov_b32 v22, v18
  v_mov_b32 v23, v19
  s_nop 0
  v_permlane32_swap_b32 v16, v20
  v_permlane32_swap_b32 v17, v21
  v_permlane32_swap_b32 v18, v22
  v_permlane32_swap_b32 v19, v23
  v_max_f32 v16, v16, v20
  v_max_f32 v17, v17, v21
  v_max_f32 v18, v18, v22
  v_max_f32 v19, v19, v23
  v_sub_f32 v192, 0, v16
  v_sub_f32 v193, 0, v16
  v_sub_f32 v194, 0, v16
  v_sub_f32 v195, 0, v16
  v_sub_f32 v196, 0, v17
  v_sub_f32 v197, 0, v17
  v_sub_f32 v198, 0, v17
  v_sub_f32 v199, 0, v17
  v_sub_f32 v200, 0, v18
  v_sub_f32 v201, 0, v18
  v_sub_f32 v202, 0, v18
  v_sub_f32 v203, 0, v18
  v_sub_f32 v204, 0, v19
  v_sub_f32 v205, 0, v19
  v_sub_f32 v206, 0, v19
  v_sub_f32 v207, 0, v19
  v_sub_f32 v96, v96, v16
  v_sub_f32 v97, v97, v16
  v_sub_f32 v98, v98, v16
  v_sub_f32 v99, v99, v16
  v_sub_f32 v100, v100, v16
  v_sub_f32 v101, v101, v16
  v_sub_f32 v102, v102, v16
  v_sub_f32 v103, v103, v16
  v_sub_f32 v104, v104, v17
  v_sub_f32 v105, v105, v17
  v_sub_f32 v106, v106, v17
  v_sub_f32 v107, v107, v17
  v_sub_f32 v108, v108, v17
  v_sub_f32 v109, v109, v17
  v_sub_f32 v110, v110, v17
  v_sub_f32 v111, v111, v17
  v_sub_f32 v128, v128, v18
  v_sub_f32 v129, v129, v18
  v_sub_f32 v130, v130, v18
  v_sub_f32 v131, v131, v18
  v_sub_f32 v132, v132, v18
  v_sub_f32 v133, v133, v18
  v_sub_f32 v134, v134, v18
  v_sub_f32 v135, v135, v18
  v_sub_f32 v136, v136, v19
  v_sub_f32 v137, v137, v19
  v_sub_f32 v138, v138, v19
  v_sub_f32 v139, v139, v19
  v_sub_f32 v140, v140, v19
  v_sub_f32 v141, v141, v19
  v_sub_f32 v142, v142, v19
  v_sub_f32 v143, v143, v19
  v_mfma_f32_16x16x32_bf16 v[112:115], a[128:131], v[32:35], v[192:195]
  v_exp_f32 v216, v128
  v_exp_f32 v217, v129
  v_mfma_f32_16x16x32_bf16 v[120:123], a[128:131], v[36:39], v[196:199]
  v_exp_f32 v218, v130
  v_add_f32 v226, v216, v217
  v_cvt_pk_bf16_f32 v176, v216, v217
  v_mfma_f32_16x16x32_bf16 v[144:147], a[128:131], v[64:67], v[200:203]
  s_add_u32 s66, s66, 32768
  v_exp_f32 v219, v131
  v_add_f32 v226, v226, v218
  v_add_f32 v226, v226, v219
  v_mfma_f32_16x16x32_bf16 v[152:155], a[128:131], v[68:71], v[204:207]
  s_mov_b32 m0, s25
  ds_read_b128 a[128:131], v3 offset:8192
  v_exp_f32 v220, v132
  v_cvt_pk_bf16_f32 v177, v218, v219
  v_mfma_f32_16x16x32_bf16 v[116:119], a[132:135], v[32:35], v[192:195]
  s_and_b32 s66, s66, 0x1ffff
  buffer_load_dwordx4 v2, s[48:51], s27 offen offset:0 sc1 lds
  v_exp_f32 v221, v133
  v_add_f32 v226, v226, v220
  v_add_f32 v226, v226, v221
  v_mfma_f32_16x16x32_bf16 v[124:127], a[132:135], v[36:39], v[196:199]
  v_exp_f32 v222, v134
  v_cvt_pk_bf16_f32 v178, v220, v221
  v_exp_f32 v223, v135
  v_mfma_f32_16x16x32_bf16 v[148:151], a[132:135], v[64:67], v[200:203]
  v_exp_f32 v216, v136
  v_add_f32 v226, v226, v222
  v_mfma_f32_16x16x32_bf16 v[156:159], a[132:135], v[68:71], v[204:207]
  ds_read_b128 a[132:135], v3 offset:9216
  v_exp_f32 v217, v137
  v_add_f32 v226, v226, v223
  v_mfma_f32_16x16x32_bf16 v[112:115], a[136:139], v[40:43], v[112:115]
  v_exp_f32 v218, v138
  v_cvt_pk_bf16_f32 v179, v222, v223
  v_add_f32 v227, v216, v217
  v_mfma_f32_16x16x32_bf16 v[120:123], a[136:139], v[44:47], v[120:123]
  v_exp_f32 v219, v139
  v_cvt_pk_bf16_f32 v180, v216, v217
  v_add_f32 v227, v227, v218
  v_add_f32 v227, v227, v219
  v_mfma_f32_16x16x32_bf16 v[144:147], a[136:139], v[72:75], v[144:147]
  buffer_load_dwordx4 v2, s[48:51], s27 offen offset:1024 sc1 lds
  v_exp_f32 v220, v140
  v_cvt_pk_bf16_f32 v181, v218, v219
  v_mfma_f32_16x16x32_bf16 v[152:155], a[136:139], v[76:79], v[152:155]
  ds_read_b128 a[136:139], v3 offset:10240
  v_exp_f32 v221, v141
  v_add_f32 v227, v227, v220
  v_mfma_f32_16x16x32_bf16 v[116:119], a[140:143], v[40:43], v[116:119]
  v_exp_f32 v222, v142
  v_add_f32 v227, v227, v221
  v_cvt_pk_bf16_f32 v182, v220, v221
  v_mfma_f32_16x16x32_bf16 v[124:127], a[140:143], v[44:47], v[124:127]
  v_exp_f32 v223, v143
  v_add_f32 v227, v227, v222
  v_add_f32 v227, v227, v223
  v_exp_f32 v208, v96
  v_mfma_f32_16x16x32_bf16 v[148:151], a[140:143], v[72:75], v[148:151]
  v_exp_f32 v209, v97
  v_cvt_pk_bf16_f32 v183, v222, v223
  v_mfma_f32_16x16x32_bf16 v[156:159], a[140:143], v[76:79], v[156:159]
  s_waitcnt lgkmcnt(3)
  ds_read_b128 a[140:143], v3 offset:11264
  v_exp_f32 v210, v98
  v_add_f32 v224, v208, v209
  v_mfma_f32_16x16x32_bf16 v[112:115], a[144:147], v[48:51], v[112:115]
  v_exp_f32 v211, v99
  v_cvt_pk_bf16_f32 v160, v208, v209
  v_add_f32 v224, v224, v210
  v_mfma_f32_16x16x32_bf16 v[120:123], a[144:147], v[52:55], v[120:123]
  v_exp_f32 v212, v100
  v_add_f32 v224, v224, v211
  v_cvt_pk_bf16_f32 v161, v210, v211
  v_mfma_f32_16x16x32_bf16 v[144:147], a[144:147], v[80:83], v[144:147]
  buffer_load_dwordx4 v2, s[48:51], s27 offen offset:2048 sc1 lds
  v_exp_f32 v213, v101
  v_add_f32 v224, v224, v212
  v_add_f32 v224, v224, v213
  v_mfma_f32_16x16x32_bf16 v[152:155], a[144:147], v[84:87], v[152:155]
  ds_read_b128 a[144:147], v3 offset:12288
  v_exp_f32 v214, v102
  v_cvt_pk_bf16_f32 v162, v212, v213
  v_mfma_f32_16x16x32_bf16 v[116:119], a[148:151], v[48:51], v[116:119]
  v_exp_f32 v215, v103
  v_add_f32 v224, v224, v214
  v_add_f32 v224, v224, v215
  v_mfma_f32_16x16x32_bf16 v[124:127], a[148:151], v[52:55], v[124:127]
  v_exp_f32 v208, v104
  v_exp_f32 v209, v105
  v_mfma_f32_16x16x32_bf16 v[148:151], a[148:151], v[80:83], v[148:151]
  v_exp_f32 v210, v106
  v_cvt_pk_bf16_f32 v163, v214, v215
  v_add_f32 v225, v208, v209
  v_mfma_f32_16x16x32_bf16 v[156:159], a[148:151], v[84:87], v[156:159]
  ds_read_b128 a[148:151], v3 offset:13312
  v_exp_f32 v211, v107
  v_cvt_pk_bf16_f32 v164, v208, v209
  v_add_f32 v225, v225, v210
  v_mfma_f32_16x16x32_bf16 v[112:115], a[152:155], v[56:59], v[112:115]
  buffer_load_dwordx4 v2, s[48:51], s27 offen offset:3072 sc1 lds
  v_exp_f32 v212, v108
  v_add_f32 v225, v225, v211
  v_mfma_f32_16x16x32_bf16 v[120:123], a[152:155], v[60:63], v[120:123]
  s_add_u32 s27, s27, 16384
  v_exp_f32 v213, v109
  v_mfma_f32_16x16x32_bf16 v[144:147], a[152:155], v[88:91], v[144:147]
  s_add_u32 s25, s25, 32768
  v_exp_f32 v214, v110
  v_mfma_f32_16x16x32_bf16 v[152:155], a[152:155], v[92:95], v[152:155]
  s_and_b32 s25, s25, 0x1ffff
  ds_read_b128 a[152:155], v3 offset:14336
  v_cvt_pk_bf16_f32 v165, v210, v211
  v_max3_f32 v5, v226, v227, v224
  v_add_f32 v225, v225, v212
  v_add_f32 v225, v225, v213
  v_cvt_pk_bf16_f32 v166, v212, v213
  v_exp_f32 v215, v111
  v_mfma_f32_16x16x32_bf16 v[116:119], a[156:159], v[56:59], v[116:119]
  v_add_f32 v225, v225, v214
  v_add_f32 v225, v225, v215
  v_max_f32 v5, v5, v225
  v_cmp_lt_f32 vcc, s81, v5
  v_mfma_f32_16x16x32_bf16 v[124:127], a[156:159], v[60:63], v[124:127]
  v_mfma_f32_16x16x32_bf16 v[148:151], a[156:159], v[88:91], v[148:151]
  v_cvt_pk_bf16_f32 v167, v214, v215
  v_mfma_f32_16x16x32_bf16 v[156:159], a[156:159], v[92:95], v[156:159]
  s_waitcnt lgkmcnt(3)
  s_cbranch_vccnz fa_stub0
fa_back0:
  ds_read_b128 a[156:159], v3 offset:15360
  v_add_f32 v228, v228, v224
  v_add_f32 v229, v229, v225
  v_add_f32 v230, v230, v226
  v_add_f32 v231, v231, v227
  s_nop 3
  v_exp_f32 v216, v144
  v_exp_f32 v217, v145
  v_add_u32 v3, s66, v2
  buffer_load_dword v14, v13, s[40:43], 0 offen sc1
  s_cmp_eq_u32 s28, 0
  s_cbranch_scc1 fa_AV
  s_sub_u32 s28, s28, 1
  s_cmp_eq_u32 s28, 0
  s_cbranch_scc1 fa_Aexit
.p2align 6
fa_DD:
  v_mfma_f32_16x16x32_bf16 v[96:99], a[128:131], v[32:35], v[192:195]
  s_waitcnt vmcnt(12)
  v_exp_f32 v218, v146
  v_mfma_f32_16x16x32_bf16 v[104:107], a[128:131], v[36:39], v[196:199]
  s_barrier
  v_exp_f32 v219, v147
  v_mfma_f32_16x16x32_bf16 v[128:131], a[128:131], v[64:67], v[200:203]
  s_cmp_ge_u32 s26, s32
  ds_read_b128 a[160:163], v3 offset:16384
  v_add_f32 v226, v216, v217
  v_mfma_f32_16x16x32_bf16 v[136:139], a[128:131], v[68:71], v[204:207]
  s_cbranch_scc1 fa_hk4
fa_hb4:
  v_exp_f32 v220, v148
  v_mfma_f32_16x16x32_bf16 v[100:103], a[132:135], v[32:35], v[192:195]
  ds_read_b128 a[164:167], v3 offset:17408
  v_cvt_pk_bf16_f32 v184, v216, v217
  v_mfma_f32_16x16x32_bf16 v[108:111], a[132:135], v[36:39], v[196:199]
  s_mov_b32 m0, s24
  v_exp_f32 v221, v149
  v_mfma_f32_16x16x32_bf16 v[132:135], a[132:135], v[64:67], v[200:203]
  buffer_load_dwordx4 v2, s[44:47], s26 offen offset:0 sc1 lds
  v_add_f32 v226, v226, v218
  v_mfma_f32_16x16x32_bf16 v[140:143], a[132:135], v[68:71], v[204:207]
  v_exp_f32 v222, v150
  v_mfma_f32_16x16x32_bf16 v[96:99], a[136:139], v[40:43], v[96:99]
  ds_read_b128 a[168:171], v3 offset:18432
  v_add_f32 v226, v226, v219
  v_mfma_f32_16x16x32_bf16 v[104:107], a[136:139], v[44:47], v[104:107]
  v_exp_f32 v223, v151
  v_mfma_f32_16x16x32_bf16 v[128:131], a[136:139], v[72:75], v[128:131]
  v_cvt_pk_bf16_f32 v185, v218, v219
  v_add_f32 v226, v226, v220
  v_mfma_f32_16x16x32_bf16 v[136:139], a[136:139], v[76:79], v[136:139]
  v_exp_f32 v216, v152
  v_mfma_f32_16x16x32_bf16 v[100:103], a[140:143], v[40:43], v[100:103]
  ds_read_b128 a[172:175], v3 offset:19456
  v_add_f32 v226, v226, v221
  v_mfma_f32_16x16x32_bf16 v[108:111], a[140:143], v[44:47], v[108:111]
  v_exp_f32 v217, v153
  v_mfma_f32_16x16x32_bf16 v[132:135], a[140:143], v[72:75], v[132:135]
  v_cvt_pk_bf16_f32 v186, v220, v221
  v_add_f32 v226, v226, v222
  v_mfma_f32_16x16x32_bf16 v[140:143], a[140:143], v[76:79], v[140:143]
  s_waitcnt lgkmcnt(4)
  v_exp_f32 v218, v154
  v_mfma_f32_16x16x32_bf16 v[96:99], a[144:147], v[48:51], v[96:99]
  ds_read_b128 a[176:179], v3 offset:20480
  v_add_f32 v226, v226, v223
  v_mfma_f32_16x16x32_bf16 v[104:107], a[144:147], v[52:55], v[104:107]
  v_exp_f32 v219, v155
  v_mfma_f32_16x16x32_bf16 v[128:131], a[144:147], v[80:83], v[128:131]
  v_cvt_pk_bf16_f32 v187, v222, v223
  v_add_f32 v227, v216, v217
  v_mfma_f32_16x16x32_bf16 v[136:139], a[144:147], v[84:87], v[136:139]
  v_exp_f32 v220, v156
  v_mfma_f32_16x16x32_bf16 v[100:103], a[148:151], v[48:51], v[100:103]
  ds_read_b128 a[180:183], v3 offset:21504
  v_cvt_pk_bf16_f32 v188, v216, v217
  v_mfma_f32_16x16x32_bf16 v[108:111], a[148:151], v[52:55], v[108:111]
  v_exp_f32 v221, v157
  v_mfma_f32_16x16x32_bf16 v[132:135], a[148:151], v[80:83], v[132:135]
  buffer_load_dwordx4 v2, s[44:47], s26 offen offset:1024 sc1 lds
  v_add_f32 v227, v227, v218
  v_mfma_f32_16x16x32_bf16 v[140:143], a[148:151], v[84:87], v[140:143]
  v_exp_f32 v222, v158
  v_mfma_f32_16x16x32_bf16 v[96:99], a[152:155], v[56:59], v[96:99]
  ds_read_b128 a[184:187], v3 offset:22528
  v_add_f32 v227, v227, v219
  v_mfma_f32_16x16x32_bf16 v[104:107], a[152:155], v[60:63], v[104:107]
  v_exp_f32 v223, v159
  v_mfma_f32_16x16x32_bf16 v[128:131], a[152:155], v[88:91], v[128:131]
  v_cvt_pk_bf16_f32 v189, v218, v219
  v_add_f32 v227, v227, v220
  v_mfma_f32_16x16x32_bf16 v[136:139], a[152:155], v[92:95], v[136:139]
  v_exp_f32 v208, v112
  v_mfma_f32_16x16x32_bf16 v[100:103], a[156:159], v[56:59], v[100:103]
  ds_read_b128 a[188:191], v3 offset:23552
  v_add_f32 v227, v227, v221
  v_mfma_f32_16x16x32_bf16 v[108:111], a[156:159], v[60:63], v[108:111]
  v_exp_f32 v209, v113
  v_mfma_f32_16x16x32_bf16 v[132:135], a[156:159], v[88:91], v[132:135]
  v_cvt_pk_bf16_f32 v190, v220, v221
  v_add_f32 v227, v227, v222
  v_add_f32 v227, v227, v223
  v_mfma_f32_16x16x32_bf16 v[140:143], a[156:159], v[92:95], v[140:143]
  s_waitcnt lgkmcnt(4)
  v_exp_f32 v210, v114
  v_mfma_f32_16x16x32_bf16 a[0:3], a[160:163], v[160:163], a[0:3]
  ds_read_b128 a[128:131], v3 offset:0
  v_cvt_pk_bf16_f32 v191, v222, v223
  v_mfma_f32_16x16x32_bf16 a[4:7], a[160:163], v[164:167], a[4:7]
  v_exp_f32 v211, v115
  v_mfma_f32_16x16x32_bf16 a[64:67], a[160:163], v[176:179], a[64:67]
  v_exp_f32 v212, v116
  v_mfma_f32_16x16x32_bf16 a[68:71], a[160:163], v[180:183], a[68:71]
  v_add_f32 v224, v208, v209
  v_cvt_pk_bf16_f32 v168, v208, v209
  v_mfma_f32_16x16x32_bf16 a[8:11], a[164:167], v[160:163], a[8:11]
  ds_read_b128 a[132:135], v3 offset:1024
  v_add_f32 v224, v224, v210
  v_mfma_f32_16x16x32_bf16 a[12:15], a[164:167], v[164:167], a[12:15]
  v_exp_f32 v213, v117
  v_mfma_f32_16x16x32_bf16 a[72:75], a[164:167], v[176:179], a[72:75]
  buffer_load_dwordx4 v2, s[44:47], s26 offen offset:2048 sc1 lds
  v_add_f32 v224, v224, v211
  v_mfma_f32_16x16x32_bf16 a[76:79], a[164:167], v[180:183], a[76:79]
  v_exp_f32 v214, v118
  v_mfma_f32_16x16x32_bf16 a[16:19], a[168:171], v[160:163], a[16:19]
  ds_read_b128 a[136:139], v3 offset:2048
  v_cvt_pk_bf16_f32 v169, v210, v211
  v_mfma_f32_16x16x32_bf16 a[20:23], a[168:171], v[164:167], a[20:23]
  v_exp_f32 v215, v119
  v_mfma_f32_16x16x32_bf16 a[80:83], a[168:171], v[176:179], a[80:83]
  v_add_f32 v224, v224, v212
  v_add_f32 v224, v224, v213
  v_mfma_f32_16x16x32_bf16 a[84:87], a[168:171], v[180:183], a[84:87]
  v_exp_f32 v208, v120
  v_mfma_f32_16x16x32_bf16 a[24:27], a[172:175], v[160:163], a[24:27]
  ds_read_b128 a[140:143], v3 offset:3072
  v_cvt_pk_bf16_f32 v170, v212, v213
  v_mfma_f32_16x16x32_bf16 a[28:31], a[172:175], v[164:167], a[28:31]
  v_exp_f32 v209, v121
  v_mfma_f32_16x16x32_bf16 a[88:91], a[172:175], v[176:179], a[88:91]
  v_exp_f32 v210, v122
  v_mfma_f32_16x16x32_bf16 a[92:95], a[172:175], v[180:183], a[92:95]
  s_waitcnt lgkmcnt(4)
  v_add_f32 v224, v224, v214
  v_add_f32 v224, v224, v215
  v_mfma_f32_16x16x32_bf16 a[32:35], a[176:179], v[160:163], a[32:35]
  ds_read_b128 a[144:147], v3 offset:4096
  v_cvt_pk_bf16_f32 v171, v214, v215
  v_mfma_f32_16x16x32_bf16 a[36:39], a[176:179], v[164:167], a[36:39]
  v_exp_f32 v211, v123
  v_mfma_f32_16x16x32_bf16 a[96:99], a[176:179], v[176:179], a[96:99]
  v_add_f32 v225, v208, v209
  v_cvt_pk_bf16_f32 v172, v208, v209
  v_mfma_f32_16x16x32_bf16 a[100:103], a[176:179], v[180:183], a[100:103]
  v_exp_f32 v212, v124
  v_mfma_f32_16x16x32_bf16 a[40:43], a[180:183], v[160:163], a[40:43]
  ds_read_b128 a[148:151], v3 offset:5120
  v_add_f32 v225, v225, v210
  v_mfma_f32_16x16x32_bf16 a[44:47], a[180:183], v[164:167], a[44:47]
  v_exp_f32 v213, v125
  v_mfma_f32_16x16x32_bf16 a[104:107], a[180:183], v[176:179], a[104:107]
  buffer_load_dwordx4 v2, s[44:47], s26 offen offset:3072 sc1 lds
  v_add_f32 v225, v225, v211
  v_mfma_f32_16x16x32_bf16 a[108:111], a[180:183], v[180:183], a[108:111]
  s_add_u32 s26, s26, 16384
  v_exp_f32 v214, v126
  v_mfma_f32_16x16x32_bf16 a[48:51], a[184:187], v[160:163], a[48:51]
  s_add_u32 s24, s24, 32768
  ds_read_b128 a[152:155], v3 offset:6144
  v_cvt_pk_bf16_f32 v173, v210, v211
  v_mfma_f32_16x16x32_bf16 a[52:55], a[184:187], v[164:167], a[52:55]
  s_and_b32 s24, s24, 0x1ffff
  v_exp_f32 v215, v127
  v_mfma_f32_16x16x32_bf16 a[112:115], a[184:187], v[176:179], a[112:115]
  v_max3_f32 v5, v226, v227, v224
  v_add_f32 v225, v225, v212
  v_mfma_f32_16x16x32_bf16 a[116:119], a[184:187], v[180:183], a[116:119]
  v_add_f32 v225, v225, v213
  v_cvt_pk_bf16_f32 v174, v212, v213
  v_add_f32 v225, v225, v214
  v_mfma_f32_16x16x32_bf16 a[56:59], a[188:191], v[160:163], a[56:59]
  ds_read_b128 a[156:159], v3 offset:7168
  v_add_f32 v225, v225, v215
  v_max_f32 v5, v5, v225
  v_cmp_lt_f32 vcc, s81, v5
  v_mfma_f32_16x16x32_bf16 a[60:63], a[188:191], v[164:167], a[60:63]
  v_exp_f32 v216, v128
  v_mfma_f32_16x16x32_bf16 a[120:123], a[188:191], v[176:179], a[120:123]
  s_waitcnt lgkmcnt(4)
  v_cvt_pk_bf16_f32 v175, v214, v215
  v_mfma_f32_16x16x32_bf16 a[124:127], a[188:191], v[180:183], a[124:127]
  s_cbranch_vccnz fa_stub1
fa_back1:
  v_exp_f32 v217, v129
  v_add_f32 v228, v228, v224
  v_add_f32 v229, v229, v225
  v_add_f32 v230, v230, v226
  v_add_f32 v231, v231, v227
fa_DDe:
  v_mfma_f32_16x16x32_bf16 v[112:115], a[128:131], v[32:35], v[192:195]
  ds_read_b128 a[160:163], v3 offset:24576
  v_add_f32 v226, v216, v217
  v_mfma_f32_16x16x32_bf16 v[120:123], a[128:131], v[36:39], v[196:199]
  v_exp_f32 v218, v130
  v_mfma_f32_16x16x32_bf16 v[144:147], a[128:131], v[64:67], v[200:203]
  s_cmp_ge_u32 s26, s9
  v_exp_f32 v219, v131
  v_mfma_f32_16x16x32_bf16 v[152:155], a[128:131], v[68:71], v[204:207]
  s_cbranch_scc1 fa_hk5
fa_hb5:
  v_exp_f32 v220, v132
  v_mfma_f32_16x16x32_bf16 v[116:119], a[132:135], v[32:35], v[192:195]
  s_add_u32 s66, s66, 32768
  ds_read_b128 a[164:167], v3 offset:25600
  v_cvt_pk_bf16_f32 v176, v216, v217
  v_mfma_f32_16x16x32_bf16 v[124:127], a[132:135], v[36:39], v[196:199]
  s_mov_b32 m0, s25
  v_exp_f32 v221, v133
  v_mfma_f32_16x16x32_bf16 v[148:151], a[132:135], v[64:67], v[200:203]
  s_and_b32 s66, s66, 0x1ffff
  buffer_load_dwordx4 v2, s[48:51], s27 offen offset:0 sc1 lds
  v_add_f32 v226, v226, v218
  v_mfma_f32_16x16x32_bf16 v[156:159], a[132:135], v[68:71], v[204:207]
  v_exp_f32 v222, v134
  v_mfma_f32_16x16x32_bf16 v[112:115], a[136:139], v[40:43], v[112:115]
  ds_read_b128 a[168:171], v3 offset:26624
  v_add_f32 v226, v226, v219
  v_mfma_f32_16x16x32_bf16 v[120:123], a[136:139], v[44:47], v[120:123]
  v_exp_f32 v223, v135
  v_mfma_f32_16x16x32_bf16 v[144:147], a[136:139], v[72:75], v[144:147]
  v_cvt_pk_bf16_f32 v177, v218, v219
  v_add_f32 v226, v226, v220
  v_mfma_f32_16x16x32_bf16 v[152:155], a[136:139], v[76:79], v[152:155]
  v_exp_f32 v216, v136
  v_mfma_f32_16x16x32_bf16 v[116:119], a[140:143], v[40:43], v[116:119]
  ds_read_b128 a[172:175], v3 offset:27648
  v_add_f32 v226, v226, v221
  v_mfma_f32_16x16x32_bf16 v[124:127], a[140:143], v[44:47], v[124:127]
  v_exp_f32 v217, v137
  v_mfma_f32_16x16x32_bf16 v[148:151], a[140:143], v[72:75], v[148:151]
  v_cvt_pk_bf16_f32 v178, v220, v221
  v_add_f32 v226, v226, v222
  v_mfma_f32_16x16x32_bf16 v[156:159], a[140:143], v[76:79], v[156:159]
  s_waitcnt lgkmcnt(4)
  v_exp_f32 v218, v138
  v_mfma_f32_16x16x32_bf16 v[112:115], a[144:147], v[48:51], v[112:115]
  ds_read_b128 a[176:179], v3 offset:28672
  v_add_f32 v226, v226, v223
  v_mfma_f32_16x16x32_bf16 v[120:123], a[144:147], v[52:55], v[120:123]
  v_exp_f32 v219, v139
  v_mfma_f32_16x16x32_bf16 v[144:147], a[144:147], v[80:83], v[144:147]
  v_cvt_pk_bf16_f32 v179, v222, v223
  v_add_f32 v227, v216, v217
  v_mfma_f32_16x16x32_bf16 v[152:155], a[144:147], v[84:87], v[152:155]
  v_exp_f32 v220, v140
  v_mfma_f32_16x16x32_bf16 v[116:119], a[148:151], v[48:51], v[116:119]
  ds_read_b128 a[180:183], v3 offset:29696
  v_cvt_pk_bf16_f32 v180, v216, v217
  v_mfma_f32_16x16x32_bf16 v[124:127], a[148:151], v[52:55], v[124:127]
  v_exp_f32 v221, v141
  v_mfma_f32_16x16x32_bf16 v[148:151], a[148:151], v[80:83], v[148:151]
  buffer_load_dwordx4 v2, s[48:51], s27 offen offset:1024 sc1 lds
  v_add_f32 v227, v227, v218
  v_mfma_f32_16x16x32_bf16 v[156:159], a[148:151], v[84:87], v[156:159]
  v_exp_f32 v222, v142
  v_mfma_f32_16x16x32_bf16 v[112:115], a[152:155], v[56:59], v[112:115]
  ds_read_b128 a[184:187], v3 offset:30720
  v_add_f32 v227, v227, v219
  v_mfma_f32_16x16x32_bf16 v[120:123], a[152:155], v[60:63], v[120:123]
  v_exp_f32 v223, v143
  v_mfma_f32_16x16x32_bf16 v[144:147], a[152:155], v[88:91], v[144:147]
  v_cvt_pk_bf16_f32 v181, v218, v219
  v_add_f32 v227, v227, v220
  v_mfma_f32_16x16x32_bf16 v[152:155], a[152:155], v[92:95], v[152:155]
  v_exp_f32 v208, v96
  v_mfma_f32_16x16x32_bf16 v[116:119], a[156:159], v[56:59], v[116:119]
  ds_read_b128 a[188:191], v3 offset:31744
  v_add_f32 v227, v227, v221
  v_mfma_f32_16x16x32_bf16 v[124:127], a[156:159], v[60:63], v[124:127]
  v_exp_f32 v209, v97
  v_mfma_f32_16x16x32_bf16 v[148:151], a[156:159], v[88:91], v[148:151]
  v_cvt_pk_bf16_f32 v182, v220, v221
  v_add_f32 v227, v227, v222
  v_add_f32 v227, v227, v223
  v_mfma_f32_16x16x32_bf16 v[156:159], a[156:159], v[92:95], v[156:159]
  s_waitcnt lgkmcnt(4)
  v_exp_f32 v210, v98
  v_mfma_f32_16x16x32_bf16 a[0:3], a[160:163], v[168:171], a[0:3]
  ds_read_b128 a[128:131], v3 offset:8192
  v_cvt_pk_bf16_f32 v183, v222, v223
  v_mfma_f32_16x16x32_bf16 a[4:7], a[160:163], v[172:175], a[4:7]
  v_exp_f32 v211, v99
  v_mfma_f32_16x16x32_bf16 a[64:67], a[160:163], v[184:187], a[64:67]
  v_exp_f32 v212, v100
  v_mfma_f32_16x16x32_bf16 a[68:71], a[160:163], v[188:191], a[68:71]
  v_add_f32 v224, v208, v209
  v_cvt_pk_bf16_f32 v160, v208, v209
  v_mfma_f32_16x16x32_bf16 a[8:11], a[164:167], v[168:171], a[8:11]
  ds_read_b128 a[132:135], v3 offset:9216
  v_add_f32 v224, v224, v210
  v_mfma_f32_16x16x32_bf16 a[12:15], a[164:167], v[172:175], a[12:15]
  v_exp_f32 v213, v101
  v_mfma_f32_16x16x32_bf16 a[72:75], a[164:167], v[184:187], a[72:75]
  buffer_load_dwordx4 v2, s[48:51], s27 offen offset:2048 sc1 lds
  v_add_f32 v224, v224, v211
  v_mfma_f32_16x16x32_bf16 a[76:79], a[164:167], v[188:191], a[76:79]
  v_exp_f32 v214, v102
  v_mfma_f32_16x16x32_bf16 a[16:19], a[168:171], v[168:171], a[16:19]
  ds_read_b128 a[136:139], v3 offset:10240
  v_cvt_pk_bf16_f32 v161, v210, v211
  v_mfma_f32_16x16x32_bf16 a[20:23], a[168:171], v[172:175], a[20:23]
  v_exp_f32 v215, v103
  v_mfma_f32_16x16x32_bf16 a[80:83], a[168:171], v[184:187], a[80:83]
  v_add_f32 v224, v224, v212
  v_add_f32 v224, v224, v213
  v_mfma_f32_16x16x32_bf16 a[84:87], a[168:171], v[188:191], a[84:87]
  v_exp_f32 v208, v104
  v_mfma_f32_16x16x32_bf16 a[24:27], a[172:175], v[168:171], a[24:27]
  ds_read_b128 a[140:143], v3 offset:11264
  v_cvt_pk_bf16_f32 v162, v212, v213
  v_mfma_f32_16x16x32_bf16 a[28:31], a[172:175], v[172:175], a[28:31]
  v_exp_f32 v209, v105
  v_mfma_f32_16x16x32_bf16 a[88:91], a[172:175], v[184:187], a[88:91]
  v_exp_f32 v210, v106
  v_mfma_f32_16x16x32_bf16 a[92:95], a[172:175], v[188:191], a[92:95]
  s_waitcnt lgkmcnt(4)
  v_add_f32 v224, v224, v214
  v_add_f32 v224, v224, v215
  v_mfma_f32_16x16x32_bf16 a[32:35], a[176:179], v[168:171], a[32:35]
  ds_read_b128 a[144:147], v3 offset:12288
  v_cvt_pk_bf16_f32 v163, v214, v215
  v_mfma_f32_16x16x32_bf16 a[36:39], a[176:179], v[172:175], a[36:39]
  v_exp_f32 v211, v107
  v_mfma_f32_16x16x32_bf16 a[96:99], a[176:179], v[184:187], a[96:99]
  v_add_f32 v225, v208, v209
  v_cvt_pk_bf16_f32 v164, v208, v209
  v_mfma_f32_16x16x32_bf16 a[100:103], a[176:179], v[188:191], a[100:103]
  v_exp_f32 v212, v108
  v_mfma_f32_16x16x32_bf16 a[40:43], a[180:183], v[168:171], a[40:43]
  ds_read_b128 a[148:151], v3 offset:13312
  v_add_f32 v225, v225, v210
  v_mfma_f32_16x16x32_bf16 a[44:47], a[180:183], v[172:175], a[44:47]
  v_exp_f32 v213, v109
  v_mfma_f32_16x16x32_bf16 a[104:107], a[180:183], v[184:187], a[104:107]
  buffer_load_dwordx4 v2, s[48:51], s27 offen offset:3072 sc1 lds
  v_add_f32 v225, v225, v211
  v_mfma_f32_16x16x32_bf16 a[108:111], a[180:183], v[188:191], a[108:111]
  s_add_u32 s27, s27, 16384
  v_exp_f32 v214, v110
  v_mfma_f32_16x16x32_bf16 a[48:51], a[184:187], v[168:171], a[48:51]
  s_add_u32 s25, s25, 32768
  ds_read_b128 a[152:155], v3 offset:14336
  v_cvt_pk_bf16_f32 v165, v210, v211
  v_mfma_f32_16x16x32_bf16 a[52:55], a[184:187], v[172:175], a[52:55]
  s_and_b32 s25, s25, 0x1ffff
  v_exp_f32 v215, v111
  v_mfma_f32_16x16x32_bf16 a[112:115], a[184:187], v[184:187], a[112:115]
  v_max3_f32 v5, v226, v227, v224
  v_add_f32 v225, v225, v212
  v_mfma_f32_16x16x32_bf16 a[116:119], a[184:187], v[188:191], a[116:119]
  v_add_f32 v225, v225, v213
  v_cvt_pk_bf16_f32 v166, v212, v213
  v_add_f32 v225, v225, v214
  v_mfma_f32_16x16x32_bf16 a[56:59], a[188:191], v[168:171], a[56:59]
  s_sub_u32 s28, s28, 1
  ds_read_b128 a[156:159], v3 offset:15360
  v_add_f32 v225, v225, v215
  v_max_f32 v5, v5, v225
  v_cmp_lt_f32 vcc, s81, v5
  v_mfma_f32_16x16x32_bf16 a[60:63], a[188:191], v[172:175], a[60:63]
  s_cmp_gt_u32 s28, s8
  v_exp_f32 v216, v144
  v_mfma_f32_16x16x32_bf16 a[120:123], a[188:191], v[184:187], a[120:123]
  s_waitcnt lgkmcnt(4)
  v_cvt_pk_bf16_f32 v167, v214, v215
  v_add_u32 v3, s66, v2
  v_mfma_f32_16x16x32_bf16 a[124:127], a[188:191], v[188:191], a[124:127]
  s_cbranch_vccnz fa_stub2
fa_back2:
  v_exp_f32 v217, v145
  v_add_f32 v228, v228, v224
  v_add_f32 v229, v229, v225
  v_add_f32 v230, v230, v226
  v_add_f32 v231, v231, v227
  s_cbranch_scc1 fa_DD
  s_cmp_lg_u32 s8, 0
  s_cbranch_scc1 fa_DDF
fa_Aexit:
  s_bitcmp1_b32 s20, 0
  s_cbranch_scc1 fa_Aodd
  v_mfma_f32_16x16x32_bf16 v[96:99], a[128:131], v[32:35], v[192:195]
  s_waitcnt vmcnt(12)
  v_exp_f32 v218, v146
  v_mfma_f32_16x16x32_bf16 v[104:107], a[128:131], v[36:39], v[196:199]
  s_barrier
  v_exp_f32 v219, v147
  v_mfma_f32_16x16x32_bf16 v[128:131], a[128:131], v[64:67], v[200:203]
  ds_read_b128 a[160:163], v3 offset:16384
  v_add_f32 v226, v216, v217
  v_mfma_f32_16x16x32_bf16 v[136:139], a[128:131], v[68:71], v[204:207]
  v_exp_f32 v220, v148
  v_mfma_f32_16x16x32_bf16 v[100:103], a[132:135], v[32:35], v[192:195]
  ds_read_b128 a[164:167], v3 offset:17408
  v_cvt_pk_bf16_f32 v184, v216, v217
  v_mfma_f32_16x16x32_bf16 v[108:111], a[132:135], v[36:39], v[196:199]
  s_mov_b32 m0, s24
  v_exp_f32 v221, v149
  v_mfma_f32_16x16x32_bf16 v[132:135], a[132:135], v[64:67], v[200:203]
  buffer_load_dwordx4 v2, s[44:47], s26 offen offset:0 sc1 lds
  v_add_f32 v226, v226, v218
  v_mfma_f32_16x16x32_bf16 v[140:143], a[132:135], v[68:71], v[204:207]
  v_exp_f32 v222, v150
  v_mfma_f32_16x16x32_bf16 v[96:99], a[136:139], v[40:43], v[96:99]
  ds_read_b128 a[168:171], v3 offset:18432
  v_add_f32 v226, v226, v219
  v_mfma_f32_16x16x32_bf16 v[104:107], a[136:139], v[44:47], v[104:107]
  v_exp_f32 v223, v151
  v_mfma_f32_16x16x32_bf16 v[128:131], a[136:139], v[72:75], v[128:131]
  v_cvt_pk_bf16_f32 v185, v218, v219
  v_add_f32 v226, v226, v220
  v_mfma_f32_16x16x32_bf16 v[136:139], a[136:139], v[76:79], v[136:139]
  v_exp_f32 v216, v152
  v_mfma_f32_16x16x32_bf16 v[100:103], a[140:143], v[40:43], v[100:103]
  ds_read_b128 a[172:175], v3 offset:19456
  v_add_f32 v226, v226, v221
  v_mfma_f32_16x16x32_bf16 v[108:111], a[140:143], v[44:47], v[108:111]
  v_exp_f32 v217, v153
  v_mfma_f32_16x16x32_bf16 v[132:135], a[140:143], v[72:75], v[132:135]
  v_cvt_pk_bf16_f32 v186, v220, v221
  v_add_f32 v226, v226, v222
  v_mfma_f32_16x16x32_bf16 v[140:143], a[140:143], v[76:79], v[140:143]
  s_waitcnt lgkmcnt(4)
  v_exp_f32 v218, v154
  v_mfma_f32_16x16x32_bf16 v[96:99], a[144:147], v[48:51], v[96:99]
  ds_read_b128 a[176:179], v3 offset:20480
  v_add_f32 v226, v226, v223
  v_mfma_f32_16x16x32_bf16 v[104:107], a[144:147], v[52:55], v[104:107]
  v_exp_f32 v219, v155
  v_mfma_f32_16x16x32_bf16 v[128:131], a[144:147], v[80:83], v[128:131]
  v_cvt_pk_bf16_f32 v187, v222, v223
  v_add_f32 v227, v216, v217
  v_mfma_f32_16x16x32_bf16 v[136:139], a[144:147], v[84:87], v[136:139]
  v_exp_f32 v220, v156
  v_mfma_f32_16x16x32_bf16 v[100:103], a[148:151], v[48:51], v[100:103]
  ds_read_b128 a[180:183], v3 offset:21504
  v_cvt_pk_bf16_f32 v188, v216, v217
  v_mfma_f32_16x16x32_bf16 v[108:111], a[148:151], v[52:55], v[108:111]
  v_exp_f32 v221, v157
  v_mfma_f32_16x16x32_bf16 v[132:135], a[148:151], v[80:83], v[132:135]
  buffer_load_dwordx4 v2, s[44:47], s26 offen offset:1024 sc1 lds
  v_add_f32 v227, v227, v218
  v_mfma_f32_16x16x32_bf16 v[140:143], a[148:151], v[84:87], v[140:143]
  v_exp_f32 v222, v158
  v_mfma_f32_16x16x32_bf16 v[96:99], a[152:155], v[56:59], v[96:99]
  ds_read_b128 a[184:187], v3 offset:22528
  v_add_f32 v227, v227, v219
  v_mfma_f32_16x16x32_bf16 v[104:107], a[152:155], v[60:63], v[104:107]
  v_exp_f32 v223, v159
  v_mfma_f32_16x16x32_bf16 v[128:131], a[152:155], v[88:91], v[128:131]
  v_cvt_pk_bf16_f32 v189, v218, v219
  v_add_f32 v227, v227, v220
  v_mfma_f32_16x16x32_bf16 v[136:139], a[152:155], v[92:95], v[136:139]
  v_exp_f32 v208, v112
  v_mfma_f32_16x16x32_bf16 v[100:103], a[156:159], v[56:59], v[100:103]
  ds_read_b128 a[188:191], v3 offset:23552
  v_add_f32 v227, v227, v221
  v_mfma_f32_16x16x32_bf16 v[108:111], a[156:159], v[60:63], v[108:111]
  v_exp_f32 v209, v113
  v_mfma_f32_16x16x32_bf16 v[132:135], a[156:159], v[88:91], v[132:135]
  v_cvt_pk_bf16_f32 v190, v220, v221
  v_add_f32 v227, v227, v222
  v_add_f32 v227, v227, v223
  v_mfma_f32_16x16x32_bf16 v[140:143], a[156:159], v[92:95], v[140:143]
  s_waitcnt lgkmcnt(4)
  v_exp_f32 v210, v114
  v_mfma_f32_16x16x32_bf16 a[0:3], a[160:163], v[160:163], a[0:3]
  ds_read_b128 a[128:131], v3 offset:0
  v_cvt_pk_bf16_f32 v191, v222, v223
  v_mfma_f32_16x16x32_bf16 a[4:7], a[160:163], v[164:167], a[4:7]
  v_exp_f32 v211, v115
  v_mfma_f32_16x16x32_bf16 a[64:67], a[160:163], v[176:179], a[64:67]
  v_exp_f32 v212, v116
  v_mfma_f32_16x16x32_bf16 a[68:71], a[160:163], v[180:183], a[68:71]
  v_add_f32 v224, v208, v209
  v_cvt_pk_bf16_f32 v168, v208, v209
  v_mfma_f32_16x16x32_bf16 a[8:11], a[164:167], v[160:163], a[8:11]
  ds_read_b128 a[132:135], v3 offset:1024
  v_add_f32 v224, v224, v210
  v_mfma_f32_16x16x32_bf16 a[12:15], a[164:167], v[164:167], a[12:15]
  v_exp_f32 v213, v117
  v_mfma_f32_16x16x32_bf16 a[72:75], a[164:167], v[176:179], a[72:75]
  buffer_load_dwordx4 v2, s[44:47], s26 offen offset:2048 sc1 lds
  v_add_f32 v224, v224, v211
  v_mfma_f32_16x16x32_bf16 a[76:79], a[164:167], v[180:183], a[76:79]
  v_exp_f32 v214, v118
  v_mfma_f32_16x16x32_bf16 a[16:19], a[168:171], v[160:163], a[16:19]
  ds_read_b128 a[136:139], v3 offset:2048
  v_cvt_pk_bf16_f32 v169, v210, v211
  v_mfma_f32_16x16x32_bf16 a[20:23], a[168:171], v[164:167], a[20:23]
  v_exp_f32 v215, v119
  v_mfma_f32_16x16x32_bf16 a[80:83], a[168:171], v[176:179], a[80:83]
  v_add_f32 v224, v224, v212
  v_add_f32 v224, v224, v213
  v_mfma_f32_16x16x32_bf16 a[84:87], a[168:171], v[180:183], a[84:87]
  v_exp_f32 v208, v120
  v_mfma_f32_16x16x32_bf16 a[24:27], a[172:175], v[160:163], a[24:27]
  ds_read_b128 a[140:143], v3 offset:3072
  v_cvt_pk_bf16_f32 v170, v212, v213
  v_mfma_f32_16x16x32_bf16 a[28:31], a[172:175], v[164:167], a[28:31]
  v_exp_f32 v209, v121
  v_mfma_f32_16x16x32_bf16 a[88:91], a[172:175], v[176:179], a[88:91]
  v_exp_f32 v210, v122
  v_mfma_f32_16x16x32_bf16 a[92:95], a[172:175], v[180:183], a[92:95]
  s_waitcnt lgkmcnt(4)
  v_add_f32 v224, v224, v214
  v_add_f32 v224, v224, v215
  v_mfma_f32_16x16x32_bf16 a[32:35], a[176:179], v[160:163], a[32:35]
  ds_read_b128 a[144:147], v3 offset:4096
  v_cvt_pk_bf16_f32 v171, v214, v215
  v_mfma_f32_16x16x32_bf16 a[36:39], a[176:179], v[164:167], a[36:39]
  v_exp_f32 v211, v123
  v_mfma_f32_16x16x32_bf16 a[96:99], a[176:179], v[176:179], a[96:99]
  v_add_f32 v225, v208, v209
  v_cvt_pk_bf16_f32 v172, v208, v209
  v_mfma_f32_16x16x32_bf16 a[100:103], a[176:179], v[180:183], a[100:103]
  v_exp_f32 v212, v124
  v_mfma_f32_16x16x32_bf16 a[40:43], a[180:183], v[160:163], a[40:43]
  ds_read_b128 a[148:151], v3 offset:5120
  v_add_f32 v225, v225, v210
  v_mfma_f32_16x16x32_bf16 a[44:47], a[180:183], v[164:167], a[44:47]
  v_exp_f32 v213, v125
  v_mfma_f32_16x16x32_bf16 a[104:107], a[180:183], v[176:179], a[104:107]
  buffer_load_dwordx4 v2, s[44:47], s26 offen offset:3072 sc1 lds
  v_add_f32 v225, v225, v211
  v_mfma_f32_16x16x32_bf16 a[108:111], a[180:183], v[180:183], a[108:111]
  s_add_u32 s26, s26, 16384
  v_exp_f32 v214, v126
  v_mfma_f32_16x16x32_bf16 a[48:51], a[184:187], v[160:163], a[48:51]
  s_add_u32 s24, s24, 32768
  ds_read_b128 a[152:155], v3 offset:6144
  v_cvt_pk_bf16_f32 v173, v210, v211
  v_mfma_f32_16x16x32_bf16 a[52:55], a[184:187], v[164:167], a[52:55]
  s_and_b32 s24, s24, 0x1ffff
  v_exp_f32 v215, v127
  v_mfma_f32_16x16x32_bf16 a[112:115], a[184:187], v[176:179], a[112:115]
  v_max3_f32 v5, v226, v227, v224
  v_add_f32 v225, v225, v212
  v_mfma_f32_16x16x32_bf16 a[116:119], a[184:187], v[180:183], a[116:119]
  v_add_f32 v225, v225, v213
  v_cvt_pk_bf16_f32 v174, v212, v213
  v_add_f32 v225, v225, v214
  v_mfma_f32_16x16x32_bf16 a[56:59], a[188:191], v[160:163], a[56:59]
  ds_read_b128 a[156:159], v3 offset:7168
  v_add_f32 v225, v225, v215
  v_max_f32 v5, v5, v225
  v_cmp_lt_f32 vcc, s81, v5
  v_mfma_f32_16x16x32_bf16 a[60:63], a[188:191], v[164:167], a[60:63]
  v_exp_f32 v216, v128
  v_mfma_f32_16x16x32_bf16 a[120:123], a[188:191], v[176:179], a[120:123]
  s_waitcnt lgkmcnt(4)
  v_cvt_pk_bf16_f32 v175, v214, v215
  v_mfma_f32_16x16x32_bf16 a[124:127], a[188:191], v[180:183], a[124:127]
  s_cbranch_vccnz fa_stub4
fa_back4:
  v_exp_f32 v217, v129
  v_add_f32 v228, v228, v224
  v_add_f32 v229, v229, v225
  v_add_f32 v230, v230, v226
  v_add_f32 v231, v231, v227
  v_mfma_f32_16x16x32_bf16 v[144:147], a[128:131], v[64:67], v[200:203]
  ds_read_b128 a[160:163], v3 offset:24576
  v_exp_f32 v218, v130
  v_mfma_f32_16x16x32_bf16 v[152:155], a[128:131], v[68:71], v[204:207]
  v_exp_f32 v219, v131
  v_add_f32 v226, v216, v217
  v_mfma_f32_16x16x32_bf16 v[148:151], a[132:135], v[64:67], v[200:203]
  s_add_u32 s66, s66, 32768
  ds_read_b128 a[164:167], v3 offset:25600
  v_exp_f32 v220, v132
  v_mfma_f32_16x16x32_bf16 v[156:159], a[132:135], v[68:71], v[204:207]
  s_and_b32 s66, s66, 0x1ffff
  v_exp_f32 v221, v133
  v_cvt_pk_bf16_f32 v176, v216, v217
  v_mfma_f32_16x16x32_bf16 v[144:147], a[136:139], v[72:75], v[144:147]
  ds_read_b128 a[168:171], v3 offset:26624
  v_add_f32 v226, v226, v218
  v_add_f32 v226, v226, v219
  v_mfma_f32_16x16x32_bf16 v[152:155], a[136:139], v[76:79], v[152:155]
  s_mov_b32 m0, s25
  v_exp_f32 v222, v134
  v_cvt_pk_bf16_f32 v177, v218, v219
  v_mfma_f32_16x16x32_bf16 v[148:151], a[140:143], v[72:75], v[148:151]
  ds_read_b128 a[172:175], v3 offset:27648
  buffer_load_dwordx4 v2, s[48:51], s27 offen offset:0 sc1 lds
  v_add_f32 v226, v226, v220
  v_add_f32 v226, v226, v221
  v_mfma_f32_16x16x32_bf16 v[156:159], a[140:143], v[76:79], v[156:159]
  s_waitcnt lgkmcnt(4)
  v_exp_f32 v223, v135
  v_cvt_pk_bf16_f32 v178, v220, v221
  v_mfma_f32_16x16x32_bf16 v[144:147], a[144:147], v[80:83], v[144:147]
  ds_read_b128 a[176:179], v3 offset:28672
  v_cndmask_b32 v96, v4, v96, s[68:69]
  v_cndmask_b32 v97, v4, v97, s[70:71]
  v_mfma_f32_16x16x32_bf16 v[152:155], a[144:147], v[84:87], v[152:155]
  v_exp_f32 v216, v136
  v_cndmask_b32 v98, v4, v98, s[72:73]
  v_mfma_f32_16x16x32_bf16 v[148:151], a[148:151], v[80:83], v[148:151]
  ds_read_b128 a[180:183], v3 offset:29696
  v_cndmask_b32 v99, v4, v99, s[74:75]
  v_mov_b32 v100, v4
  v_mfma_f32_16x16x32_bf16 v[156:159], a[148:151], v[84:87], v[156:159]
  v_exp_f32 v217, v137
  v_mov_b32 v101, v4
  v_mfma_f32_16x16x32_bf16 v[144:147], a[152:155], v[88:91], v[144:147]
  ds_read_b128 a[184:187], v3 offset:30720
  v_mov_b32 v102, v4
  v_mov_b32 v103, v4
  v_mfma_f32_16x16x32_bf16 v[152:155], a[152:155], v[92:95], v[152:155]
  v_exp_f32 v218, v138
  v_cndmask_b32 v108, v4, v108, s[68:69]
  v_mfma_f32_16x16x32_bf16 v[148:151], a[156:159], v[88:91], v[148:151]
  ds_read_b128 a[188:191], v3 offset:31744
  v_cndmask_b32 v109, v4, v109, s[70:71]
  v_cndmask_b32 v110, v4, v110, s[72:73]
  v_mfma_f32_16x16x32_bf16 v[156:159], a[156:159], v[92:95], v[156:159]
  s_waitcnt lgkmcnt(4)
  v_exp_f32 v219, v139
  v_cndmask_b32 v111, v4, v111, s[74:75]
  v_mfma_f32_16x16x32_bf16 a[0:3], a[160:163], v[168:171], a[0:3]
  ds_read_b128 a[128:131], v3 offset:8192
  v_add_f32 v226, v226, v222
  v_add_f32 v226, v226, v223
  v_mfma_f32_16x16x32_bf16 a[4:7], a[160:163], v[172:175], a[4:7]
  v_exp_f32 v220, v140
  v_cvt_pk_bf16_f32 v179, v222, v223
  v_mfma_f32_16x16x32_bf16 a[64:67], a[160:163], v[184:187], a[64:67]
  buffer_load_dwordx4 v2, s[48:51], s27 offen offset:1024 sc1 lds
  v_add_f32 v227, v216, v217
  v_cvt_pk_bf16_f32 v180, v216, v217
  v_mfma_f32_16x16x32_bf16 a[68:71], a[160:163], v[188:191], a[68:71]
  v_exp_f32 v221, v141
  v_add_f32 v227, v227, v218
  v_mfma_f32_16x16x32_bf16 a[8:11], a[164:167], v[168:171], a[8:11]
  ds_read_b128 a[132:135], v3 offset:9216
  v_exp_f32 v222, v142
  v_mfma_f32_16x16x32_bf16 a[12:15], a[164:167], v[172:175], a[12:15]
  v_exp_f32 v223, v143
  v_mfma_f32_16x16x32_bf16 a[72:75], a[164:167], v[184:187], a[72:75]
  v_exp_f32 v208, v96
  v_mfma_f32_16x16x32_bf16 a[76:79], a[164:167], v[188:191], a[76:79]
  v_exp_f32 v209, v97
  v_mfma_f32_16x16x32_bf16 a[16:19], a[168:171], v[168:171], a[16:19]
  ds_read_b128 a[136:139], v3 offset:10240
  v_add_f32 v227, v227, v219
  v_cvt_pk_bf16_f32 v181, v218, v219
  v_add_f32 v227, v227, v220
  v_add_f32 v227, v227, v221
  v_cvt_pk_bf16_f32 v182, v220, v221
  v_mfma_f32_16x16x32_bf16 a[20:23], a[168:171], v[172:175], a[20:23]
  v_exp_f32 v210, v98
  v_mfma_f32_16x16x32_bf16 a[80:83], a[168:171], v[184:187], a[80:83]
  v_exp_f32 v211, v99
  v_mfma_f32_16x16x32_bf16 a[84:87], a[168:171], v[188:191], a[84:87]
  v_exp_f32 v212, v100
  v_mfma_f32_16x16x32_bf16 a[24:27], a[172:175], v[168:171], a[24:27]
  ds_read_b128 a[140:143], v3 offset:11264
  v_add_f32 v227, v227, v222
  v_add_f32 v227, v227, v223
  v_cvt_pk_bf16_f32 v183, v222, v223
  v_add_f32 v224, v208, v209
  v_cvt_pk_bf16_f32 v160, v208, v209
  v_mfma_f32_16x16x32_bf16 a[28:31], a[172:175], v[172:175], a[28:31]
  v_exp_f32 v213, v101
  v_mfma_f32_16x16x32_bf16 a[88:91], a[172:175], v[184:187], a[88:91]
  buffer_load_dwordx4 v2, s[48:51], s27 offen offset:2048 sc1 lds
  v_add_f32 v224, v224, v210
  v_add_f32 v224, v224, v211
  v_cvt_pk_bf16_f32 v161, v210, v211
  v_mfma_f32_16x16x32_bf16 a[92:95], a[172:175], v[188:191], a[92:95]
  s_waitcnt lgkmcnt(4)
  v_exp_f32 v214, v102
  v_mfma_f32_16x16x32_bf16 a[32:35], a[176:179], v[168:171], a[32:35]
  ds_read_b128 a[144:147], v3 offset:12288
  v_exp_f32 v215, v103
  v_mfma_f32_16x16x32_bf16 a[36:39], a[176:179], v[172:175], a[36:39]
  v_exp_f32 v208, v104
  v_mfma_f32_16x16x32_bf16 a[96:99], a[176:179], v[184:187], a[96:99]
  v_exp_f32 v209, v105
  v_mfma_f32_16x16x32_bf16 a[100:103], a[176:179], v[188:191], a[100:103]
  v_exp_f32 v210, v106
  v_mfma_f32_16x16x32_bf16 a[40:43], a[180:183], v[168:171], a[40:43]
  ds_read_b128 a[148:151], v3 offset:13312
  v_add_f32 v224, v224, v212
  v_add_f32 v224, v224, v213
  v_cvt_pk_bf16_f32 v162, v212, v213
  v_add_f32 v224, v224, v214
  v_add_f32 v224, v224, v215
  v_cvt_pk_bf16_f32 v163, v214, v215
  v_mfma_f32_16x16x32_bf16 a[44:47], a[180:183], v[172:175], a[44:47]
  v_exp_f32 v211, v107
  v_mfma_f32_16x16x32_bf16 a[104:107], a[180:183], v[184:187], a[104:107]
  v_exp_f32 v212, v108
  v_mfma_f32_16x16x32_bf16 a[108:111], a[180:183], v[188:191], a[108:111]
  v_exp_f32 v213, v109
  v_mfma_f32_16x16x32_bf16 a[48:51], a[184:187], v[168:171], a[48:51]
  ds_read_b128 a[152:155], v3 offset:14336
  v_add_f32 v225, v208, v209
  v_cvt_pk_bf16_f32 v164, v208, v209
  v_add_f32 v225, v225, v210
  v_add_f32 v225, v225, v211
  v_cvt_pk_bf16_f32 v165, v210, v211
  v_mfma_f32_16x16x32_bf16 a[52:55], a[184:187], v[172:175], a[52:55]
  v_exp_f32 v214, v110
  v_mfma_f32_16x16x32_bf16 a[112:115], a[184:187], v[184:187], a[112:115]
  buffer_load_dwordx4 v2, s[48:51], s27 offen offset:3072 sc1 lds
  v_max3_f32 v5, v226, v227, v224
  v_add_f32 v225, v225, v212
  v_add_f32 v225, v225, v213
  v_mfma_f32_16x16x32_bf16 a[116:119], a[184:187], v[188:191], a[116:119]
  s_add_u32 s27, s27, 16384
  v_exp_f32 v215, v111
  v_mfma_f32_16x16x32_bf16 a[56:59], a[188:191], v[168:171], a[56:59]
  s_add_u32 s25, s25, 32768
  ds_read_b128 a[156:159], v3 offset:15360
  v_cvt_pk_bf16_f32 v166, v212, v213
  v_add_f32 v225, v225, v214
  v_add_f32 v225, v225, v215
  v_max_f32 v5, v5, v225
  v_cmp_lt_f32 vcc, s81, v5
  v_mfma_f32_16x16x32_bf16 a[60:63], a[188:191], v[172:175], a[60:63]
  s_and_b32 s25, s25, 0x1ffff
  v_exp_f32 v216, v144
  v_mfma_f32_16x16x32_bf16 a[120:123], a[188:191], v[184:187], a[120:123]
  s_waitcnt lgkmcnt(4)
  v_cvt_pk_bf16_f32 v167, v214, v215
  v_add_u32 v3, s66, v2
  v_mfma_f32_16x16x32_bf16 a[124:127], a[188:191], v[188:191], a[124:127]
  s_cbranch_vccnz fa_stub5
fa_back5:
  v_exp_f32 v217, v145
  v_add_f32 v228, v228, v224
  v_add_f32 v229, v229, v225
  v_add_f32 v230, v230, v226
  v_add_f32 v231, v231, v227
fa_AV:
  v_mfma_f32_16x16x32_bf16 v[128:131], a[128:131], v[64:67], v[200:203]
  s_waitcnt vmcnt(12)
  v_exp_f32 v218, v146
  v_mfma_f32_16x16x32_bf16 v[136:139], a[128:131], v[68:71], v[204:207]
  s_barrier
  v_exp_f32 v219, v147
  v_mfma_f32_16x16x32_bf16 v[132:135], a[132:135], v[64:67], v[200:203]
  ds_read_b128 a[160:163], v3 offset:16384
  ds_read_b128 a[164:167], v3 offset:17408
  v_add_f32 v226, v216, v217
  v_mfma_f32_16x16x32_bf16 v[140:143], a[132:135], v[68:71], v[204:207]
  v_exp_f32 v220, v148
  v_mfma_f32_16x16x32_bf16 v[128:131], a[136:139], v[72:75], v[128:131]
  ds_read_b128 a[168:171], v3 offset:18432
  v_cvt_pk_bf16_f32 v184, v216, v217
  v_mfma_f32_16x16x32_bf16 v[136:139], a[136:139], v[76:79], v[136:139]
  s_mov_b32 m0, s24
  v_exp_f32 v221, v149
  v_mfma_f32_16x16x32_bf16 v[132:135], a[140:143], v[72:75], v[132:135]
  ds_read_b128 a[172:175], v3 offset:19456
  buffer_load_dwordx4 v2, s[44:47], s26 offen offset:0 sc1 lds
  v_add_f32 v226, v226, v218
  v_mfma_f32_16x16x32_bf16 v[140:143], a[140:143], v[76:79], v[140:143]
  s_waitcnt lgkmcnt(4)
  v_exp_f32 v222, v150
  v_mfma_f32_16x16x32_bf16 v[128:131], a[144:147], v[80:83], v[128:131]
  ds_read_b128 a[176:179], v3 offset:20480
  v_add_f32 v226, v226, v219
  v_mfma_f32_16x16x32_bf16 v[136:139], a[144:147], v[84:87], v[136:139]
  v_exp_f32 v223, v151
  v_mfma_f32_16x16x32_bf16 v[132:135], a[148:151], v[80:83], v[132:135]
  ds_read_b128 a[180:183], v3 offset:21504
  v_cvt_pk_bf16_f32 v185, v218, v219
  v_mfma_f32_16x16x32_bf16 v[140:143], a[148:151], v[84:87], v[140:143]
  v_add_f32 v226, v226, v220
  v_add_f32 v226, v226, v221
  v_mfma_f32_16x16x32_bf16 v[128:131], a[152:155], v[88:91], v[128:131]
  ds_read_b128 a[184:187], v3 offset:22528
  v_cvt_pk_bf16_f32 v186, v220, v221
  v_mfma_f32_16x16x32_bf16 v[136:139], a[152:155], v[92:95], v[136:139]
  v_exp_f32 v216, v152
  v_mfma_f32_16x16x32_bf16 v[132:135], a[156:159], v[88:91], v[132:135]
  ds_read_b128 a[188:191], v3 offset:23552
  v_add_f32 v226, v226, v222
  v_mfma_f32_16x16x32_bf16 v[140:143], a[156:159], v[92:95], v[140:143]
  s_waitcnt lgkmcnt(4)
  v_exp_f32 v217, v153
  v_mfma_f32_16x16x32_bf16 a[0:3], a[160:163], v[160:163], a[0:3]
  ds_read_b128 a[128:131], v3 offset:0
  v_add_f32 v226, v226, v223
  v_mfma_f32_16x16x32_bf16 a[4:7], a[160:163], v[164:167], a[4:7]
  v_exp_f32 v218, v154
  v_mfma_f32_16x16x32_bf16 a[64:67], a[160:163], v[176:179], a[64:67]
  buffer_load_dwordx4 v2, s[44:47], s26 offen offset:1024 sc1 lds
  v_cvt_pk_bf16_f32 v187, v222, v223
  v_mfma_f32_16x16x32_bf16 a[68:71], a[160:163], v[180:183], a[68:71]
  v_exp_f32 v219, v155
  v_mfma_f32_16x16x32_bf16 a[8:11], a[164:167], v[160:163], a[8:11]
  ds_read_b128 a[132:135], v3 offset:1024
  v_add_f32 v227, v216, v217
  v_mfma_f32_16x16x32_bf16 a[12:15], a[164:167], v[164:167], a[12:15]
  v_exp_f32 v220, v156
  v_mfma_f32_16x16x32_bf16 a[72:75], a[164:167], v[176:179], a[72:75]
  v_exp_f32 v221, v157
  v_mfma_f32_16x16x32_bf16 a[76:79], a[164:167], v[180:183], a[76:79]
  v_cvt_pk_bf16_f32 v188, v216, v217
  v_add_f32 v227, v227, v218
  v_mfma_f32_16x16x32_bf16 a[16:19], a[168:171], v[160:163], a[16:19]
  ds_read_b128 a[136:139], v3 offset:2048
  v_add_f32 v227, v227, v219
  v_mfma_f32_16x16x32_bf16 a[20:23], a[168:171], v[164:167], a[20:23]
  v_exp_f32 v222, v158
  v_mfma_f32_16x16x32_bf16 a[80:83], a[168:171], v[176:179], a[80:83]
  v_exp_f32 v223, v159
  v_mfma_f32_16x16x32_bf16 a[84:87], a[168:171], v[180:183], a[84:87]
  v_cvt_pk_bf16_f32 v189, v218, v219
  v_add_f32 v227, v227, v220
  v_mfma_f32_16x16x32_bf16 a[24:27], a[172:175], v[160:163], a[24:27]
  ds_read_b128 a[140:143], v3 offset:3072
  v_add_f32 v227, v227, v221
  v_mfma_f32_16x16x32_bf16 a[28:31], a[172:175], v[164:167], a[28:31]
  v_cvt_pk_bf16_f32 v190, v220, v221
  v_add_f32 v227, v227, v222
  v_mfma_f32_16x16x32_bf16 a[88:91], a[172:175], v[176:179], a[88:91]
  buffer_load_dwordx4 v2, s[44:47], s26 offen offset:2048 sc1 lds
  v_add_f32 v227, v227, v223
  v_mfma_f32_16x16x32_bf16 a[92:95], a[172:175], v[180:183], a[92:95]
  s_waitcnt lgkmcnt(4)
  v_max_f32 v5, v226, v227
  v_cmp_lt_f32 vcc, s81, v5
  v_mfma_f32_16x16x32_bf16 a[32:35], a[176:179], v[160:163], a[32:35]
  ds_read_b128 a[144:147], v3 offset:4096
  v_mfma_f32_16x16x32_bf16 a[36:39], a[176:179], v[164:167], a[36:39]
  v_mfma_f32_16x16x32_bf16 a[96:99], a[176:179], v[176:179], a[96:99]
  v_mfma_f32_16x16x32_bf16 a[100:103], a[176:179], v[180:183], a[100:103]
  v_mfma_f32_16x16x32_bf16 a[40:43], a[180:183], v[160:163], a[40:43]
  ds_read_b128 a[148:151], v3 offset:5120
  v_mfma_f32_16x16x32_bf16 a[44:47], a[180:183], v[164:167], a[44:47]
  v_mfma_f32_16x16x32_bf16 a[104:107], a[180:183], v[176:179], a[104:107]
  v_mfma_f32_16x16x32_bf16 a[108:111], a[180:183], v[180:183], a[108:111]
  v_mfma_f32_16x16x32_bf16 a[48:51], a[184:187], v[160:163], a[48:51]
  ds_read_b128 a[152:155], v3 offset:6144
  v_mfma_f32_16x16x32_bf16 a[52:55], a[184:187], v[164:167], a[52:55]
  v_mfma_f32_16x16x32_bf16 a[112:115], a[184:187], v[176:179], a[112:115]
  buffer_load_dwordx4 v2, s[44:47], s26 offen offset:3072 sc1 lds
  v_mfma_f32_16x16x32_bf16 a[116:119], a[184:187], v[180:183], a[116:119]
  s_add_u32 s26, s26, 16384
  v_mfma_f32_16x16x32_bf16 a[56:59], a[188:191], v[160:163], a[56:59]
  s_add_u32 s24, s24, 32768
  ds_read_b128 a[156:159], v3 offset:7168
  v_mfma_f32_16x16x32_bf16 a[60:63], a[188:191], v[164:167], a[60:63]
  s_and_b32 s24, s24, 0x1ffff
  v_exp_f32 v216, v128
  v_mfma_f32_16x16x32_bf16 a[120:123], a[188:191], v[176:179], a[120:123]
  s_waitcnt lgkmcnt(4)
  v_cvt_pk_bf16_f32 v191, v222, v223
  v_mfma_f32_16x16x32_bf16 a[124:127], a[188:191], v[180:183], a[124:127]
  s_cbranch_vccnz fa_stub6
fa_back6:
  v_exp_f32 v217, v129
  v_add_f32 v230, v230, v226
  v_add_f32 v231, v231, v227
  v_mfma_f32_16x16x32_bf16 v[144:147], a[128:131], v[64:67], v[200:203]
  ds_read_b128 a[160:163], v3 offset:24576
  v_add_f32 v226, v216, v217
  v_mfma_f32_16x16x32_bf16 v[152:155], a[128:131], v[68:71], v[204:207]
  v_exp_f32 v218, v130
  v_mfma_f32_16x16x32_bf16 v[148:151], a[132:135], v[64:67], v[200:203]
  s_add_u32 s66, s66, 32768
  ds_read_b128 a[164:167], v3 offset:25600
  v_cvt_pk_bf16_f32 v176, v216, v217
  v_mfma_f32_16x16x32_bf16 v[156:159], a[132:135], v[68:71], v[204:207]
  s_mov_b32 m0, s25
  v_exp_f32 v219, v131
  v_mfma_f32_16x16x32_bf16 v[144:147], a[136:139], v[72:75], v[144:147]
  s_and_b32 s66, s66, 0x1ffff
  ds_read_b128 a[168:171], v3 offset:26624
  buffer_load_dwordx4 v2, s[48:51], s27 offen offset:0 sc1 lds
  v_add_f32 v226, v226, v218
  v_add_f32 v226, v226, v219
  v_mfma_f32_16x16x32_bf16 v[152:155], a[136:139], v[76:79], v[152:155]
  v_exp_f32 v220, v132
  v_mfma_f32_16x16x32_bf16 v[148:151], a[140:143], v[72:75], v[148:151]
  ds_read_b128 a[172:175], v3 offset:27648
  v_cvt_pk_bf16_f32 v177, v218, v219
  v_mfma_f32_16x16x32_bf16 v[156:159], a[140:143], v[76:79], v[156:159]
  s_waitcnt lgkmcnt(4)
  v_exp_f32 v221, v133
  v_mfma_f32_16x16x32_bf16 v[144:147], a[144:147], v[80:83], v[144:147]
  ds_read_b128 a[176:179], v3 offset:28672
  v_add_f32 v226, v226, v220
  v_mfma_f32_16x16x32_bf16 v[152:155], a[144:147], v[84:87], v[152:155]
  v_exp_f32 v222, v134
  v_mfma_f32_16x16x32_bf16 v[148:151], a[148:151], v[80:83], v[148:151]
  ds_read_b128 a[180:183], v3 offset:29696
  buffer_load_dwordx4 v2, s[48:51], s27 offen offset:1024 sc1 lds
  v_add_f32 v226, v226, v221
  v_cvt_pk_bf16_f32 v178, v220, v221
  v_mfma_f32_16x16x32_bf16 v[156:159], a[148:151], v[84:87], v[156:159]
  v_exp_f32 v223, v135
  v_mfma_f32_16x16x32_bf16 v[144:147], a[152:155], v[88:91], v[144:147]
  ds_read_b128 a[184:187], v3 offset:30720
  v_add_f32 v226, v226, v222
  v_mfma_f32_16x16x32_bf16 v[152:155], a[152:155], v[92:95], v[152:155]
  v_exp_f32 v216, v136
  v_mfma_f32_16x16x32_bf16 v[148:151], a[156:159], v[88:91], v[148:151]
  ds_read_b128 a[188:191], v3 offset:31744
  v_add_f32 v226, v226, v223
  v_exp_f32 v217, v137
  v_mfma_f32_16x16x32_bf16 v[156:159], a[156:159], v[92:95], v[156:159]
  s_waitcnt lgkmcnt(4)
  v_exp_f32 v218, v138
  v_mfma_f32_16x16x32_bf16 a[64:67], a[160:163], v[184:187], a[64:67]
  ds_read_b128 a[128:131], v3 offset:8192
  v_cvt_pk_bf16_f32 v179, v222, v223
  v_mfma_f32_16x16x32_bf16 a[68:71], a[160:163], v[188:191], a[68:71]
  v_exp_f32 v219, v139
  v_mfma_f32_16x16x32_bf16 a[72:75], a[164:167], v[184:187], a[72:75]
  ds_read_b128 a[132:135], v3 offset:9216
  buffer_load_dwordx4 v2, s[48:51], s27 offen offset:2048 sc1 lds
  v_add_f32 v227, v216, v217
  v_mfma_f32_16x16x32_bf16 a[76:79], a[164:167], v[188:191], a[76:79]
  v_exp_f32 v220, v140
  v_mfma_f32_16x16x32_bf16 a[80:83], a[168:171], v[184:187], a[80:83]
  ds_read_b128 a[136:139], v3 offset:10240
  v_cvt_pk_bf16_f32 v180, v216, v217
  v_mfma_f32_16x16x32_bf16 a[84:87], a[168:171], v[188:191], a[84:87]
  v_exp_f32 v221, v141
  v_mfma_f32_16x16x32_bf16 a[88:91], a[172:175], v[184:187], a[88:91]
  ds_read_b128 a[140:143], v3 offset:11264
  v_add_f32 v227, v227, v218
  v_mfma_f32_16x16x32_bf16 a[92:95], a[172:175], v[188:191], a[92:95]
  s_waitcnt lgkmcnt(4)
  v_exp_f32 v222, v142
  v_mfma_f32_16x16x32_bf16 a[96:99], a[176:179], v[184:187], a[96:99]
  ds_read_b128 a[144:147], v3 offset:12288
  buffer_load_dwordx4 v2, s[48:51], s27 offen offset:3072 sc1 lds
  v_add_f32 v227, v227, v219
  v_cvt_pk_bf16_f32 v181, v218, v219
  v_mfma_f32_16x16x32_bf16 a[100:103], a[176:179], v[188:191], a[100:103]
  s_add_u32 s27, s27, 16384
  v_exp_f32 v223, v143
  v_mfma_f32_16x16x32_bf16 a[104:107], a[180:183], v[184:187], a[104:107]
  s_add_u32 s25, s25, 32768
  ds_read_b128 a[148:151], v3 offset:13312
  v_add_f32 v227, v227, v220
  v_mfma_f32_16x16x32_bf16 a[108:111], a[180:183], v[188:191], a[108:111]
  s_and_b32 s25, s25, 0x1ffff
  v_add_f32 v227, v227, v221
  v_cvt_pk_bf16_f32 v182, v220, v221
  v_add_f32 v227, v227, v222
  v_mfma_f32_16x16x32_bf16 a[112:115], a[184:187], v[184:187], a[112:115]
  ds_read_b128 a[152:155], v3 offset:14336
  v_add_f32 v227, v227, v223
  v_max_f32 v5, v226, v227
  v_cmp_lt_f32 vcc, s81, v5
  v_mfma_f32_16x16x32_bf16 a[116:119], a[184:187], v[188:191], a[116:119]
  v_exp_f32 v216, v144
  v_mfma_f32_16x16x32_bf16 a[120:123], a[188:191], v[184:187], a[120:123]
  s_waitcnt lgkmcnt(3)
  ds_read_b128 a[156:159], v3 offset:15360
  v_cvt_pk_bf16_f32 v183, v222, v223
  v_add_u32 v3, s66, v2
  v_mfma_f32_16x16x32_bf16 a[124:127], a[188:191], v[188:191], a[124:127]
  s_cbranch_vccnz fa_stub7
fa_back7:
  v_exp_f32 v217, v145
  v_add_f32 v230, v230, v226
  v_add_f32 v231, v231, v227
  s_branch fa_SSpre
fa_Aodd:
  v_mfma_f32_16x16x32_bf16 v[128:131], a[128:131], v[64:67], v[200:203]
  s_waitcnt vmcnt(12)
  v_exp_f32 v218, v146
  v_add_f32 v226, v216, v217
  v_mfma_f32_16x16x32_bf16 v[136:139], a[128:131], v[68:71], v[204:207]
  s_barrier
  v_exp_f32 v219, v147
  v_cvt_pk_bf16_f32 v184, v216, v217
  v_mfma_f32_16x16x32_bf16 v[132:135], a[132:135], v[64:67], v[200:203]
  ds_read_b128 a[160:163], v3 offset:16384
  ds_read_b128 a[164:167], v3 offset:17408
  v_exp_f32 v220, v148
  v_mfma_f32_16x16x32_bf16 v[140:143], a[132:135], v[68:71], v[204:207]
  v_exp_f32 v221, v149
  v_add_f32 v226, v226, v218
  v_mfma_f32_16x16x32_bf16 v[128:131], a[136:139], v[72:75], v[128:131]
  ds_read_b128 a[168:171], v3 offset:18432
  v_add_f32 v226, v226, v219
  v_cvt_pk_bf16_f32 v185, v218, v219
  v_mfma_f32_16x16x32_bf16 v[136:139], a[136:139], v[76:79], v[136:139]
  s_mov_b32 m0, s24
  v_exp_f32 v222, v150
  v_add_f32 v226, v226, v220
  v_mfma_f32_16x16x32_bf16 v[132:135], a[140:143], v[72:75], v[132:135]
  ds_read_b128 a[172:175], v3 offset:19456
  buffer_load_dwordx4 v2, s[44:47], s26 offen offset:0 sc1 lds
  v_add_f32 v226, v226, v221
  v_cvt_pk_bf16_f32 v186, v220, v221
  v_mfma_f32_16x16x32_bf16 v[140:143], a[140:143], v[76:79], v[140:143]
  s_waitcnt lgkmcnt(4)
  v_exp_f32 v223, v151
  v_cndmask_b32 v112, v4, v112, s[68:69]
  v_mfma_f32_16x16x32_bf16 v[128:131], a[144:147], v[80:83], v[128:131]
  ds_read_b128 a[176:179], v3 offset:20480
  v_cndmask_b32 v113, v4, v113, s[70:71]
  v_cndmask_b32 v114, v4, v114, s[72:73]
  v_mfma_f32_16x16x32_bf16 v[136:139], a[144:147], v[84:87], v[136:139]
  v_exp_f32 v216, v152
  v_cndmask_b32 v115, v4, v115, s[74:75]
  v_mfma_f32_16x16x32_bf16 v[132:135], a[148:151], v[80:83], v[132:135]
  ds_read_b128 a[180:183], v3 offset:21504
  v_mov_b32 v116, v4
  v_mov_b32 v117, v4
  v_mfma_f32_16x16x32_bf16 v[140:143], a[148:151], v[84:87], v[140:143]
  v_exp_f32 v217, v153
  v_mov_b32 v118, v4
  v_mfma_f32_16x16x32_bf16 v[128:131], a[152:155], v[88:91], v[128:131]
  ds_read_b128 a[184:187], v3 offset:22528
  v_mov_b32 v119, v4
  v_cndmask_b32 v124, v4, v124, s[68:69]
  v_mfma_f32_16x16x32_bf16 v[136:139], a[152:155], v[92:95], v[136:139]
  v_exp_f32 v218, v154
  v_cndmask_b32 v125, v4, v125, s[70:71]
  v_mfma_f32_16x16x32_bf16 v[132:135], a[156:159], v[88:91], v[132:135]
  ds_read_b128 a[188:191], v3 offset:23552
  v_cndmask_b32 v126, v4, v126, s[72:73]
  v_cndmask_b32 v127, v4, v127, s[74:75]
  v_mfma_f32_16x16x32_bf16 v[140:143], a[156:159], v[92:95], v[140:143]
  s_waitcnt lgkmcnt(4)
  v_exp_f32 v219, v155
  v_add_f32 v226, v226, v222
  v_mfma_f32_16x16x32_bf16 a[0:3], a[160:163], v[160:163], a[0:3]
  ds_read_b128 a[128:131], v3 offset:0
  v_add_f32 v226, v226, v223
  v_cvt_pk_bf16_f32 v187, v222, v223
  v_mfma_f32_16x16x32_bf16 a[4:7], a[160:163], v[164:167], a[4:7]
  v_exp_f32 v220, v156
  v_add_f32 v227, v216, v217
  v_mfma_f32_16x16x32_bf16 a[64:67], a[160:163], v[176:179], a[64:67]
  buffer_load_dwordx4 v2, s[44:47], s26 offen offset:1024 sc1 lds
  v_exp_f32 v221, v157
  v_mfma_f32_16x16x32_bf16 a[68:71], a[160:163], v[180:183], a[68:71]
  v_exp_f32 v222, v158
  v_mfma_f32_16x16x32_bf16 a[8:11], a[164:167], v[160:163], a[8:11]
  ds_read_b128 a[132:135], v3 offset:1024
  v_cvt_pk_bf16_f32 v188, v216, v217
  v_add_f32 v227, v227, v218
  v_add_f32 v227, v227, v219
  v_mfma_f32_16x16x32_bf16 a[12:15], a[164:167], v[164:167], a[12:15]
  v_exp_f32 v223, v159
  v_mfma_f32_16x16x32_bf16 a[72:75], a[164:167], v[176:179], a[72:75]
  v_exp_f32 v208, v112
  v_mfma_f32_16x16x32_bf16 a[76:79], a[164:167], v[180:183], a[76:79]
  v_exp_f32 v209, v113
  v_mfma_f32_16x16x32_bf16 a[16:19], a[168:171], v[160:163], a[16:19]
  ds_read_b128 a[136:139], v3 offset:2048
  v_cvt_pk_bf16_f32 v189, v218, v219
  v_add_f32 v227, v227, v220
  v_add_f32 v227, v227, v221
  v_cvt_pk_bf16_f32 v190, v220, v221
  v_add_f32 v227, v227, v222
  v_mfma_f32_16x16x32_bf16 a[20:23], a[168:171], v[164:167], a[20:23]
  v_exp_f32 v210, v114
  v_mfma_f32_16x16x32_bf16 a[80:83], a[168:171], v[176:179], a[80:83]
  v_exp_f32 v211, v115
  v_mfma_f32_16x16x32_bf16 a[84:87], a[168:171], v[180:183], a[84:87]
  v_exp_f32 v212, v116
  v_mfma_f32_16x16x32_bf16 a[24:27], a[172:175], v[160:163], a[24:27]
  ds_read_b128 a[140:143], v3 offset:3072
  v_add_f32 v227, v227, v223
  v_cvt_pk_bf16_f32 v191, v222, v223
  v_add_f32 v224, v208, v209
  v_cvt_pk_bf16_f32 v168, v208, v209
  v_add_f32 v224, v224, v210
  v_mfma_f32_16x16x32_bf16 a[28:31], a[172:175], v[164:167], a[28:31]
  v_exp_f32 v213, v117
  v_mfma_f32_16x16x32_bf16 a[88:91], a[172:175], v[176:179], a[88:91]
  buffer_load_dwordx4 v2, s[44:47], s26 offen offset:2048 sc1 lds
  v_exp_f32 v214, v118
  v_mfma_f32_16x16x32_bf16 a[92:95], a[172:175], v[180:183], a[92:95]
  s_waitcnt lgkmcnt(4)
  v_exp_f32 v215, v119
  v_mfma_f32_16x16x32_bf16 a[32:35], a[176:179], v[160:163], a[32:35]
  ds_read_b128 a[144:147], v3 offset:4096
  v_add_f32 v224, v224, v211
  v_cvt_pk_bf16_f32 v169, v210, v211
  v_add_f32 v224, v224, v212
  v_add_f32 v224, v224, v213
  v_mfma_f32_16x16x32_bf16 a[36:39], a[176:179], v[164:167], a[36:39]
  v_exp_f32 v208, v120
  v_mfma_f32_16x16x32_bf16 a[96:99], a[176:179], v[176:179], a[96:99]
  v_exp_f32 v209, v121
  v_mfma_f32_16x16x32_bf16 a[100:103], a[176:179], v[180:183], a[100:103]
  v_exp_f32 v210, v122
  v_mfma_f32_16x16x32_bf16 a[40:43], a[180:183], v[160:163], a[40:43]
  ds_read_b128 a[148:151], v3 offset:5120
  v_cvt_pk_bf16_f32 v170, v212, v213
  v_add_f32 v224, v224, v214
  v_add_f32 v224, v224, v215
  v_cvt_pk_bf16_f32 v171, v214, v215
  v_add_f32 v225, v208, v209
  v_mfma_f32_16x16x32_bf16 a[44:47], a[180:183], v[164:167], a[44:47]
  v_exp_f32 v211, v123
  v_mfma_f32_16x16x32_bf16 a[104:107], a[180:183], v[176:179], a[104:107]
  v_exp_f32 v212, v124
  v_mfma_f32_16x16x32_bf16 a[108:111], a[180:183], v[180:183], a[108:111]
  v_exp_f32 v213, v125
  v_mfma_f32_16x16x32_bf16 a[48:51], a[184:187], v[160:163], a[48:51]
  ds_read_b128 a[152:155], v3 offset:6144
  v_cvt_pk_bf16_f32 v172, v208, v209
  v_add_f32 v225, v225, v210
  v_add_f32 v225, v225, v211
  v_cvt_pk_bf16_f32 v173, v210, v211
  v_max3_f32 v5, v226, v227, v224
  v_mfma_f32_16x16x32_bf16 a[52:55], a[184:187], v[164:167], a[52:55]
  v_exp_f32 v214, v126
  v_mfma_f32_16x16x32_bf16 a[112:115], a[184:187], v[176:179], a[112:115]
  buffer_load_dwordx4 v2, s[44:47], s26 offen offset:3072 sc1 lds
  v_add_f32 v225, v225, v212
  v_add_f32 v225, v225, v213
  v_cvt_pk_bf16_f32 v174, v212, v213
  v_mfma_f32_16x16x32_bf16 a[116:119], a[184:187], v[180:183], a[116:119]
  s_add_u32 s26, s26, 16384
  v_exp_f32 v215, v127
  v_mfma_f32_16x16x32_bf16 a[56:59], a[188:191], v[160:163], a[56:59]
  s_add_u32 s24, s24, 32768
  ds_read_b128 a[156:159], v3 offset:7168
  v_add_f32 v225, v225, v214
  v_add_f32 v225, v225, v215
  v_max_f32 v5, v5, v225
  v_cmp_lt_f32 vcc, s81, v5
  v_mfma_f32_16x16x32_bf16 a[60:63], a[188:191], v[164:167], a[60:63]
  s_and_b32 s24, s24, 0x1ffff
  v_exp_f32 v216, v128
  v_mfma_f32_16x16x32_bf16 a[120:123], a[188:191], v[176:179], a[120:123]
  s_waitcnt lgkmcnt(4)
  v_cvt_pk_bf16_f32 v175, v214, v215
  v_mfma_f32_16x16x32_bf16 a[124:127], a[188:191], v[180:183], a[124:127]
  s_cbranch_vccnz fa_stub8
fa_back8:
  v_exp_f32 v217, v129
  v_add_f32 v228, v228, v224
  v_add_f32 v229, v229, v225
  v_add_f32 v230, v230, v226
  v_add_f32 v231, v231, v227
  v_mfma_f32_16x16x32_bf16 v[144:147], a[128:131], v[64:67], v[200:203]
  ds_read_b128 a[160:163], v3 offset:24576
  v_add_f32 v226, v216, v217
  v_mfma_f32_16x16x32_bf16 v[152:155], a[128:131], v[68:71], v[204:207]
  v_exp_f32 v218, v130
  v_mfma_f32_16x16x32_bf16 v[148:151], a[132:135], v[64:67], v[200:203]
  s_add_u32 s66, s66, 32768
  ds_read_b128 a[164:167], v3 offset:25600
  v_cvt_pk_bf16_f32 v176, v216, v217
  v_mfma_f32_16x16x32_bf16 v[156:159], a[132:135], v[68:71], v[204:207]
  s_and_b32 s66, s66, 0x1ffff
  v_exp_f32 v219, v131
  v_mfma_f32_16x16x32_bf16 v[144:147], a[136:139], v[72:75], v[144:147]
  ds_read_b128 a[168:171], v3 offset:26624
  v_add_f32 v226, v226, v218
  v_mfma_f32_16x16x32_bf16 v[152:155], a[136:139], v[76:79], v[152:155]
  s_mov_b32 m0, s25
  v_exp_f32 v220, v132
  v_mfma_f32_16x16x32_bf16 v[148:151], a[140:143], v[72:75], v[148:151]
  ds_read_b128 a[172:175], v3 offset:27648
  buffer_load_dwordx4 v2, s[48:51], s27 offen offset:0 sc1 lds
  v_add_f32 v226, v226, v219
  v_mfma_f32_16x16x32_bf16 v[156:159], a[140:143], v[76:79], v[156:159]
  s_waitcnt lgkmcnt(4)
  v_exp_f32 v221, v133
  v_mfma_f32_16x16x32_bf16 v[144:147], a[144:147], v[80:83], v[144:147]
  ds_read_b128 a[176:179], v3 offset:28672
  v_cvt_pk_bf16_f32 v177, v218, v219
  v_mfma_f32_16x16x32_bf16 v[152:155], a[144:147], v[84:87], v[152:155]
  v_exp_f32 v222, v134
  v_mfma_f32_16x16x32_bf16 v[148:151], a[148:151], v[80:83], v[148:151]
  ds_read_b128 a[180:183], v3 offset:29696
  v_add_f32 v226, v226, v220
  v_mfma_f32_16x16x32_bf16 v[156:159], a[148:151], v[84:87], v[156:159]
  v_exp_f32 v223, v135
  v_mfma_f32_16x16x32_bf16 v[144:147], a[152:155], v[88:91], v[144:147]
  ds_read_b128 a[184:187], v3 offset:30720
  v_add_f32 v226, v226, v221
  v_mfma_f32_16x16x32_bf16 v[152:155], a[152:155], v[92:95], v[152:155]
  v_exp_f32 v216, v136
  v_mfma_f32_16x16x32_bf16 v[148:151], a[156:159], v[88:91], v[148:151]
  ds_read_b128 a[188:191], v3 offset:31744
  v_cvt_pk_bf16_f32 v178, v220, v221
  v_mfma_f32_16x16x32_bf16 v[156:159], a[156:159], v[92:95], v[156:159]
  s_waitcnt lgkmcnt(4)
  v_exp_f32 v217, v137
  v_mfma_f32_16x16x32_bf16 a[0:3], a[160:163], v[168:171], a[0:3]
  ds_read_b128 a[128:131], v3 offset:8192
  v_add_f32 v226, v226, v222
  v_mfma_f32_16x16x32_bf16 a[4:7], a[160:163], v[172:175], a[4:7]
  v_exp_f32 v218, v138
  v_mfma_f32_16x16x32_bf16 a[64:67], a[160:163], v[184:187], a[64:67]
  buffer_load_dwordx4 v2, s[48:51], s27 offen offset:1024 sc1 lds
  v_add_f32 v226, v226, v223
  v_mfma_f32_16x16x32_bf16 a[68:71], a[160:163], v[188:191], a[68:71]
  v_exp_f32 v219, v139
  v_mfma_f32_16x16x32_bf16 a[8:11], a[164:167], v[168:171], a[8:11]
  ds_read_b128 a[132:135], v3 offset:9216
  v_cvt_pk_bf16_f32 v179, v222, v223
  v_mfma_f32_16x16x32_bf16 a[12:15], a[164:167], v[172:175], a[12:15]
  v_exp_f32 v220, v140
  v_mfma_f32_16x16x32_bf16 a[72:75], a[164:167], v[184:187], a[72:75]
  v_add_f32 v227, v216, v217
  v_cvt_pk_bf16_f32 v180, v216, v217
  v_mfma_f32_16x16x32_bf16 a[76:79], a[164:167], v[188:191], a[76:79]
  v_exp_f32 v221, v141
  v_mfma_f32_16x16x32_bf16 a[16:19], a[168:171], v[168:171], a[16:19]
  ds_read_b128 a[136:139], v3 offset:10240
  v_add_f32 v227, v227, v218
  v_mfma_f32_16x16x32_bf16 a[20:23], a[168:171], v[172:175], a[20:23]
  v_exp_f32 v222, v142
  v_mfma_f32_16x16x32_bf16 a[80:83], a[168:171], v[184:187], a[80:83]
  v_add_f32 v227, v227, v219
  v_cvt_pk_bf16_f32 v181, v218, v219
  v_mfma_f32_16x16x32_bf16 a[84:87], a[168:171], v[188:191], a[84:87]
  v_exp_f32 v223, v143
  v_mfma_f32_16x16x32_bf16 a[24:27], a[172:175], v[168:171], a[24:27]
  ds_read_b128 a[140:143], v3 offset:11264
  v_add_f32 v227, v227, v220
  v_mfma_f32_16x16x32_bf16 a[28:31], a[172:175], v[172:175], a[28:31]
  v_add_f32 v227, v227, v221
  v_cvt_pk_bf16_f32 v182, v220, v221
  v_mfma_f32_16x16x32_bf16 a[88:91], a[172:175], v[184:187], a[88:91]
  buffer_load_dwordx4 v2, s[48:51], s27 offen offset:2048 sc1 lds
  v_add_f32 v227, v227, v222
  v_mfma_f32_16x16x32_bf16 a[92:95], a[172:175], v[188:191], a[92:95]
  s_waitcnt lgkmcnt(4)
  v_add_f32 v227, v227, v223
  v_max_f32 v5, v226, v227
  v_mfma_f32_16x16x32_bf16 a[32:35], a[176:179], v[168:171], a[32:35]
  ds_read_b128 a[144:147], v3 offset:12288
  v_cmp_lt_f32 vcc, s81, v5
  v_mfma_f32_16x16x32_bf16 a[36:39], a[176:179], v[172:175], a[36:39]
  v_mfma_f32_16x16x32_bf16 a[96:99], a[176:179], v[184:187], a[96:99]
  v_mfma_f32_16x16x32_bf16 a[100:103], a[176:179], v[188:191], a[100:103]
  v_mfma_f32_16x16x32_bf16 a[40:43], a[180:183], v[168:171], a[40:43]
  ds_read_b128 a[148:151], v3 offset:13312
  v_mfma_f32_16x16x32_bf16 a[44:47], a[180:183], v[172:175], a[44:47]
  v_mfma_f32_16x16x32_bf16 a[104:107], a[180:183], v[184:187], a[104:107]
  v_mfma_f32_16x16x32_bf16 a[108:111], a[180:183], v[188:191], a[108:111]
  v_mfma_f32_16x16x32_bf16 a[48:51], a[184:187], v[168:171], a[48:51]
  ds_read_b128 a[152:155], v3 offset:14336
  v_mfma_f32_16x16x32_bf16 a[52:55], a[184:187], v[172:175], a[52:55]
  v_mfma_f32_16x16x32_bf16 a[112:115], a[184:187], v[184:187], a[112:115]
  buffer_load_dwordx4 v2, s[48:51], s27 offen offset:3072 sc1 lds
  v_mfma_f32_16x16x32_bf16 a[116:119], a[184:187], v[188:191], a[116:119]
  s_add_u32 s27, s27, 16384
  v_mfma_f32_16x16x32_bf16 a[56:59], a[188:191], v[168:171], a[56:59]
  s_add_u32 s25, s25, 32768
  ds_read_b128 a[156:159], v3 offset:15360
  v_mfma_f32_16x16x32_bf16 a[60:63], a[188:191], v[172:175], a[60:63]
  s_and_b32 s25, s25, 0x1ffff
  v_exp_f32 v216, v144
  v_mfma_f32_16x16x32_bf16 a[120:123], a[188:191], v[184:187], a[120:123]
  s_waitcnt lgkmcnt(4)
  v_cvt_pk_bf16_f32 v183, v222, v223
  v_add_u32 v3, s66, v2
  v_mfma_f32_16x16x32_bf16 a[124:127], a[188:191], v[188:191], a[124:127]
  s_cbranch_vccnz fa_stub9
fa_back9:
  v_exp_f32 v217, v145
  v_add_f32 v230, v230, v226
  v_add_f32 v231, v231, v227
fa_SSpre:
  s_mov_b32 s11, 1
  s_cmp_lg_u32 s12, 0
  s_cselect_b32 s32, s15, s32
  s_cmp_ge_u32 s20, 2
  s_cselect_b32 s23, 8, 0
  s_cmp_le_u32 s29, s23
  s_cbranch_scc1 fa_chain
.p2align 6
fa_SS:
  v_mfma_f32_16x16x32_bf16 v[128:131], a[128:131], v[64:67], v[200:203]
  s_waitcnt vmcnt(12)
  v_exp_f32 v218, v146
  v_mfma_f32_16x16x32_bf16 v[136:139], a[128:131], v[68:71], v[204:207]
  s_barrier
  v_exp_f32 v219, v147
  v_mfma_f32_16x16x32_bf16 v[132:135], a[132:135], v[64:67], v[200:203]
  s_cmp_ge_u32 s26, s32
  ds_read_b128 a[160:163], v3 offset:16384
  ds_read_b128 a[164:167], v3 offset:17408
  v_add_f32 v226, v216, v217
  v_mfma_f32_16x16x32_bf16 v[140:143], a[132:135], v[68:71], v[204:207]
  s_cbranch_scc1 fa_hk7
fa_hb7:
  v_exp_f32 v220, v148
  v_mfma_f32_16x16x32_bf16 v[128:131], a[136:139], v[72:75], v[128:131]
  ds_read_b128 a[168:171], v3 offset:18432
  v_cvt_pk_bf16_f32 v184, v216, v217
  v_mfma_f32_16x16x32_bf16 v[136:139], a[136:139], v[76:79], v[136:139]
  s_mov_b32 m0, s24
  v_exp_f32 v221, v149
  v_mfma_f32_16x16x32_bf16 v[132:135], a[140:143], v[72:75], v[132:135]
  ds_read_b128 a[172:175], v3 offset:19456
  buffer_load_dwordx4 v2, s[44:47], s26 offen offset:0 sc1 lds
  v_add_f32 v226, v226, v218
  v_add_f32 v226, v226, v219
  v_mfma_f32_16x16x32_bf16 v[140:143], a[140:143], v[76:79], v[140:143]
  s_waitcnt lgkmcnt(4)
  v_exp_f32 v222, v150
  v_mfma_f32_16x16x32_bf16 v[128:131], a[144:147], v[80:83], v[128:131]
  ds_read_b128 a[176:179], v3 offset:20480
  v_cvt_pk_bf16_f32 v185, v218, v219
  v_mfma_f32_16x16x32_bf16 v[136:139], a[144:147], v[84:87], v[136:139]
  v_exp_f32 v223, v151
  v_mfma_f32_16x16x32_bf16 v[132:135], a[148:151], v[80:83], v[132:135]
  ds_read_b128 a[180:183], v3 offset:21504
  v_add_f32 v226, v226, v220
  v_mfma_f32_16x16x32_bf16 v[140:143], a[148:151], v[84:87], v[140:143]
  v_exp_f32 v216, v152
  v_mfma_f32_16x16x32_bf16 v[128:131], a[152:155], v[88:91], v[128:131]
  ds_read_b128 a[184:187], v3 offset:22528
  buffer_load_dwordx4 v2, s[44:47], s26 offen offset:1024 sc1 lds
  v_add_f32 v226, v226, v221
  v_cvt_pk_bf16_f32 v186, v220, v221
  v_mfma_f32_16x16x32_bf16 v[136:139], a[152:155], v[92:95], v[136:139]
  v_exp_f32 v217, v153
  v_mfma_f32_16x16x32_bf16 v[132:135], a[156:159], v[88:91], v[132:135]
  ds_read_b128 a[188:191], v3 offset:23552
  v_add_f32 v226, v226, v222
  v_mfma_f32_16x16x32_bf16 v[140:143], a[156:159], v[92:95], v[140:143]
  s_waitcnt lgkmcnt(4)
  v_exp_f32 v218, v154
  v_mfma_f32_16x16x32_bf16 a[64:67], a[160:163], v[176:179], a[64:67]
  ds_read_b128 a[128:131], v3 offset:0
  v_add_f32 v226, v226, v223
  v_cvt_pk_bf16_f32 v187, v222, v223
  v_mfma_f32_16x16x32_bf16 a[68:71], a[160:163], v[180:183], a[68:71]
  v_exp_f32 v219, v155
  v_mfma_f32_16x16x32_bf16 a[72:75], a[164:167], v[176:179], a[72:75]
  ds_read_b128 a[132:135], v3 offset:1024
  buffer_load_dwordx4 v2, s[44:47], s26 offen offset:2048 sc1 lds
  v_add_f32 v227, v216, v217
  v_mfma_f32_16x16x32_bf16 a[76:79], a[164:167], v[180:183], a[76:79]
  v_exp_f32 v220, v156
  v_mfma_f32_16x16x32_bf16 a[80:83], a[168:171], v[176:179], a[80:83]
  ds_read_b128 a[136:139], v3 offset:2048
  v_cvt_pk_bf16_f32 v188, v216, v217
  v_mfma_f32_16x16x32_bf16 a[84:87], a[168:171], v[180:183], a[84:87]
  v_exp_f32 v221, v157
  v_mfma_f32_16x16x32_bf16 a[88:91], a[172:175], v[176:179], a[88:91]
  ds_read_b128 a[140:143], v3 offset:3072
  v_add_f32 v227, v227, v218
  v_add_f32 v227, v227, v219
  v_mfma_f32_16x16x32_bf16 a[92:95], a[172:175], v[180:183], a[92:95]
  s_waitcnt lgkmcnt(4)
  v_exp_f32 v222, v158
  v_mfma_f32_16x16x32_bf16 a[96:99], a[176:179], v[176:179], a[96:99]
  ds_read_b128 a[144:147], v3 offset:4096
  buffer_load_dwordx4 v2, s[44:47], s26 offen offset:3072 sc1 lds
  v_cvt_pk_bf16_f32 v189, v218, v219
  v_mfma_f32_16x16x32_bf16 a[100:103], a[176:179], v[180:183], a[100:103]
  s_add_u32 s26, s26, 16384
  v_exp_f32 v223, v159
  v_mfma_f32_16x16x32_bf16 a[104:107], a[180:183], v[176:179], a[104:107]
  s_add_u32 s24, s24, 32768
  ds_read_b128 a[148:151], v3 offset:5120
  v_add_f32 v227, v227, v220
  v_mfma_f32_16x16x32_bf16 a[108:111], a[180:183], v[180:183], a[108:111]
  s_and_b32 s24, s24, 0x1ffff
  v_add_f32 v227, v227, v221
  v_cvt_pk_bf16_f32 v190, v220, v221
  v_add_f32 v227, v227, v222
  v_mfma_f32_16x16x32_bf16 a[112:115], a[184:187], v[176:179], a[112:115]
  ds_read_b128 a[152:155], v3 offset:6144
  v_add_f32 v227, v227, v223
  v_max_f32 v5, v226, v227
  v_cmp_lt_f32 vcc, s81, v5
  v_mfma_f32_16x16x32_bf16 a[116:119], a[184:187], v[180:183], a[116:119]
  v_exp_f32 v216, v128
  v_mfma_f32_16x16x32_bf16 a[120:123], a[188:191], v[176:179], a[120:123]
  s_waitcnt lgkmcnt(3)
  ds_read_b128 a[156:159], v3 offset:7168
  v_cvt_pk_bf16_f32 v191, v222, v223
  v_mfma_f32_16x16x32_bf16 a[124:127], a[188:191], v[180:183], a[124:127]
  s_cbranch_vccnz fa_stub10
fa_back10:
  v_exp_f32 v217, v129
  v_add_f32 v230, v230, v226
  v_add_f32 v231, v231, v227
  v_mfma_f32_16x16x32_bf16 v[144:147], a[128:131], v[64:67], v[200:203]
  ds_read_b128 a[160:163], v3 offset:24576
  v_add_f32 v226, v216, v217
  v_mfma_f32_16x16x32_bf16 v[152:155], a[128:131], v[68:71], v[204:207]
  v_exp_f32 v218, v130
  v_mfma_f32_16x16x32_bf16 v[148:151], a[132:135], v[64:67], v[200:203]
  s_add_u32 s66, s66, 32768
  ds_read_b128 a[164:167], v3 offset:25600
  v_cvt_pk_bf16_f32 v176, v216, v217
  v_mfma_f32_16x16x32_bf16 v[156:159], a[132:135], v[68:71], v[204:207]
  s_mov_b32 m0, s25
  v_exp_f32 v219, v131
  v_mfma_f32_16x16x32_bf16 v[144:147], a[136:139], v[72:75], v[144:147]
  s_and_b32 s66, s66, 0x1ffff
  ds_read_b128 a[168:171], v3 offset:26624
  buffer_load_dwordx4 v2, s[48:51], s27 offen offset:0 sc1 lds
  v_add_f32 v226, v226, v218
  v_add_f32 v226, v226, v219
  v_mfma_f32_16x16x32_bf16 v[152:155], a[136:139], v[76:79], v[152:155]
  v_exp_f32 v220, v132
  v_mfma_f32_16x16x32_bf16 v[148:151], a[140:143], v[72:75], v[148:151]
  ds_read_b128 a[172:175], v3 offset:27648
  v_cvt_pk_bf16_f32 v177, v218, v219
  v_mfma_f32_16x16x32_bf16 v[156:159], a[140:143], v[76:79], v[156:159]
  s_waitcnt lgkmcnt(4)
  v_exp_f32 v221, v133
  v_mfma_f32_16x16x32_bf16 v[144:147], a[144:147], v[80:83], v[144:147]
  ds_read_b128 a[176:179], v3 offset:28672
  v_add_f32 v226, v226, v220
  v_mfma_f32_16x16x32_bf16 v[152:155], a[144:147], v[84:87], v[152:155]
  v_exp_f32 v222, v134
  v_mfma_f32_16x16x32_bf16 v[148:151], a[148:151], v[80:83], v[148:151]
  ds_read_b128 a[180:183], v3 offset:29696
  buffer_load_dwordx4 v2, s[48:51], s27 offen offset:1024 sc1 lds
  v_add_f32 v226, v226, v221
  v_cvt_pk_bf16_f32 v178, v220, v221
  v_mfma_f32_16x16x32_bf16 v[156:159], a[148:151], v[84:87], v[156:159]
  v_exp_f32 v223, v135
  v_mfma_f32_16x16x32_bf16 v[144:147], a[152:155], v[88:91], v[144:147]
  ds_read_b128 a[184:187], v3 offset:30720
  v_add_f32 v226, v226, v222
  v_mfma_f32_16x16x32_bf16 v[152:155], a[152:155], v[92:95], v[152:155]
  v_exp_f32 v216, v136
  v_mfma_f32_16x16x32_bf16 v[148:151], a[156:159], v[88:91], v[148:151]
  ds_read_b128 a[188:191], v3 offset:31744
  v_add_f32 v226, v226, v223
  v_exp_f32 v217, v137
  v_mfma_f32_16x16x32_bf16 v[156:159], a[156:159], v[92:95], v[156:159]
  s_waitcnt lgkmcnt(4)
  v_exp_f32 v218, v138
  v_mfma_f32_16x16x32_bf16 a[64:67], a[160:163], v[184:187], a[64:67]
  ds_read_b128 a[128:131], v3 offset:8192
  v_cvt_pk_bf16_f32 v179, v222, v223
  v_mfma_f32_16x16x32_bf16 a[68:71], a[160:163], v[188:191], a[68:71]
  v_exp_f32 v219, v139
  v_mfma_f32_16x16x32_bf16 a[72:75], a[164:167], v[184:187], a[72:75]
  ds_read_b128 a[132:135], v3 offset:9216
  buffer_load_dwordx4 v2, s[48:51], s27 offen offset:2048 sc1 lds
  v_add_f32 v227, v216, v217
  v_mfma_f32_16x16x32_bf16 a[76:79], a[164:167], v[188:191], a[76:79]
  v_exp_f32 v220, v140
  v_mfma_f32_16x16x32_bf16 a[80:83], a[168:171], v[184:187], a[80:83]
  ds_read_b128 a[136:139], v3 offset:10240
  v_cvt_pk_bf16_f32 v180, v216, v217
  v_mfma_f32_16x16x32_bf16 a[84:87], a[168:171], v[188:191], a[84:87]
  v_exp_f32 v221, v141
  v_mfma_f32_16x16x32_bf16 a[88:91], a[172:175], v[184:187], a[88:91]
  ds_read_b128 a[140:143], v3 offset:11264
  v_add_f32 v227, v227, v218
  v_mfma_f32_16x16x32_bf16 a[92:95], a[172:175], v[188:191], a[92:95]
  s_waitcnt lgkmcnt(4)
  v_exp_f32 v222, v142
  v_mfma_f32_16x16x32_bf16 a[96:99], a[176:179], v[184:187], a[96:99]
  ds_read_b128 a[144:147], v3 offset:12288
  buffer_load_dwordx4 v2, s[48:51], s27 offen offset:3072 sc1 lds
  v_add_f32 v227, v227, v219
  v_cvt_pk_bf16_f32 v181, v218, v219
  v_mfma_f32_16x16x32_bf16 a[100:103], a[176:179], v[188:191], a[100:103]
  s_add_u32 s27, s27, 16384
  v_exp_f32 v223, v143
  v_mfma_f32_16x16x32_bf16 a[104:107], a[180:183], v[184:187], a[104:107]
  s_add_u32 s25, s25, 32768
  ds_read_b128 a[148:151], v3 offset:13312
  v_add_f32 v227, v227, v220
  v_mfma_f32_16x16x32_bf16 a[108:111], a[180:183], v[188:191], a[108:111]
  s_and_b32 s25, s25, 0x1ffff
  v_add_f32 v227, v227, v221
  v_cvt_pk_bf16_f32 v182, v220, v221
  v_add_f32 v227, v227, v222
  v_mfma_f32_16x16x32_bf16 a[112:115], a[184:187], v[184:187], a[112:115]
  s_sub_u32 s29, s29, 1
  ds_read_b128 a[152:155], v3 offset:14336
  v_add_f32 v227, v227, v223
  v_max_f32 v5, v226, v227
  v_cmp_lt_f32 vcc, s81, v5
  v_mfma_f32_16x16x32_bf16 a[116:119], a[184:187], v[188:191], a[116:119]
  s_cmp_gt_u32 s29, 8
  v_exp_f32 v216, v144
  v_mfma_f32_16x16x32_bf16 a[120:123], a[188:191], v[184:187], a[120:123]
  s_waitcnt lgkmcnt(3)
  ds_read_b128 a[156:159], v3 offset:15360
  v_cvt_pk_bf16_f32 v183, v222, v223
  v_add_u32 v3, s66, v2
  v_mfma_f32_16x16x32_bf16 a[124:127], a[188:191], v[188:191], a[124:127]
  s_cbranch_vccnz fa_stub11
fa_back11:
  v_exp_f32 v217, v145
  v_add_f32 v230, v230, v226
  v_add_f32 v231, v231, v227
  s_cbranch_scc1 fa_SS
fa_chain:
fa_hb8:
  s_cmp_lt_u32 s12, 2
  s_cbranch_scc1 fa_hk8
  s_cmp_eq_u32 s29, 8
  s_cbranch_scc0 fa_disp
fa_SSW8:
  v_mfma_f32_16x16x32_bf16 v[128:131], a[128:131], v[64:67], v[200:203]
  s_waitcnt vmcnt(12)
  v_exp_f32 v218, v146
  v_mfma_f32_16x16x32_bf16 v[136:139], a[128:131], v[68:71], v[204:207]
  s_barrier
  v_exp_f32 v219, v147
  v_mfma_f32_16x16x32_bf16 v[132:135], a[132:135], v[64:67], v[200:203]
  ds_read_b128 a[160:163], v3 offset:16384
  ds_read_b128 a[164:167], v3 offset:17408
  v_add_f32 v226, v216, v217
  v_mfma_f32_16x16x32_bf16 v[140:143], a[132:135], v[68:71], v[204:207]
  s_mov_b32 m0, s24
  v_exp_f32 v220, v148
  v_mfma_f32_16x16x32_bf16 v[128:131], a[136:139], v[72:75], v[128:131]
  ds_read_b128 a[168:171], v3 offset:18432
  buffer_load_dwordx4 v2, s[44:47], s26 offen offset:0 sc1 lds
  v_cvt_pk_bf16_f32 v184, v216, v217
  v_mfma_f32_16x16x32_bf16 v[136:139], a[136:139], v[76:79], v[136:139]
  v_exp_f32 v221, v149
  v_mfma_f32_16x16x32_bf16 v[132:135], a[140:143], v[72:75], v[132:135]
  ds_read_b128 a[172:175], v3 offset:19456
  v_add_f32 v226, v226, v218
  v_add_f32 v226, v226, v219
  v_mfma_f32_16x16x32_bf16 v[140:143], a[140:143], v[76:79], v[140:143]
  s_waitcnt lgkmcnt(4)
  v_exp_f32 v222, v150
  v_mfma_f32_16x16x32_bf16 v[128:131], a[144:147], v[80:83], v[128:131]
  s_add_u32 s14, s13, 0
  ds_read_b128 a[176:179], v3 offset:20480
  buffer_load_dwordx4 a[0:3], v2, s[40:43], s14 offen offset:0 sc1
  v_cvt_pk_bf16_f32 v185, v218, v219
  v_mfma_f32_16x16x32_bf16 v[136:139], a[144:147], v[84:87], v[136:139]
  v_exp_f32 v223, v151
  v_mfma_f32_16x16x32_bf16 v[132:135], a[148:151], v[80:83], v[132:135]
  ds_read_b128 a[180:183], v3 offset:21504
  buffer_load_dwordx4 v2, s[44:47], s26 offen offset:1024 sc1 lds
  v_add_f32 v226, v226, v220
  v_mfma_f32_16x16x32_bf16 v[140:143], a[148:151], v[84:87], v[140:143]
  v_exp_f32 v216, v152
  v_mfma_f32_16x16x32_bf16 v[128:131], a[152:155], v[88:91], v[128:131]
  ds_read_b128 a[184:187], v3 offset:22528
  v_add_f32 v226, v226, v221
  v_cvt_pk_bf16_f32 v186, v220, v221
  v_mfma_f32_16x16x32_bf16 v[136:139], a[152:155], v[92:95], v[136:139]
  v_exp_f32 v217, v153
  v_mfma_f32_16x16x32_bf16 v[132:135], a[156:159], v[88:91], v[132:135]
  ds_read_b128 a[188:191], v3 offset:23552
  buffer_load_dwordx4 a[4:7], v2, s[40:43], s14 offen offset:1024 sc1
  v_add_f32 v226, v226, v222
  v_mfma_f32_16x16x32_bf16 v[140:143], a[156:159], v[92:95], v[140:143]
  s_waitcnt lgkmcnt(4)
  v_exp_f32 v218, v154
  v_mfma_f32_16x16x32_bf16 a[64:67], a[160:163], v[176:179], a[64:67]
  ds_read_b128 a[128:131], v3 offset:0
  v_add_f32 v226, v226, v223
  v_cvt_pk_bf16_f32 v187, v222, v223
  v_mfma_f32_16x16x32_bf16 a[68:71], a[160:163], v[180:183], a[68:71]
  v_exp_f32 v219, v155
  v_mfma_f32_16x16x32_bf16 a[72:75], a[164:167], v[176:179], a[72:75]
  ds_read_b128 a[132:135], v3 offset:1024
  buffer_load_dwordx4 v2, s[44:47], s26 offen offset:2048 sc1 lds
  v_add_f32 v227, v216, v217
  v_mfma_f32_16x16x32_bf16 a[76:79], a[164:167], v[180:183], a[76:79]
  v_exp_f32 v220, v156
  v_mfma_f32_16x16x32_bf16 a[80:83], a[168:171], v[176:179], a[80:83]
  ds_read_b128 a[136:139], v3 offset:2048
  v_cvt_pk_bf16_f32 v188, v216, v217
  v_mfma_f32_16x16x32_bf16 a[84:87], a[168:171], v[180:183], a[84:87]
  v_exp_f32 v221, v157
  v_mfma_f32_16x16x32_bf16 a[88:91], a[172:175], v[176:179], a[88:91]
  ds_read_b128 a[140:143], v3 offset:3072
  buffer_load_dwordx4 a[8:11], v2, s[40:43], s14 offen offset:2048 sc1
  v_add_f32 v227, v227, v218
  v_add_f32 v227, v227, v219
  v_mfma_f32_16x16x32_bf16 a[92:95], a[172:175], v[180:183], a[92:95]
  s_waitcnt lgkmcnt(4)
  v_exp_f32 v222, v158
  v_mfma_f32_16x16x32_bf16 a[96:99], a[176:179], v[176:179], a[96:99]
  ds_read_b128 a[144:147], v3 offset:4096
  buffer_load_dwordx4 v2, s[44:47], s26 offen offset:3072 sc1 lds
  v_cvt_pk_bf16_f32 v189, v218, v219
  v_mfma_f32_16x16x32_bf16 a[100:103], a[176:179], v[180:183], a[100:103]
  s_add_u32 s26, s26, 16384
  v_exp_f32 v223, v159
  v_mfma_f32_16x16x32_bf16 a[104:107], a[180:183], v[176:179], a[104:107]
  s_add_u32 s24, s24, 32768
  ds_read_b128 a[148:151], v3 offset:5120
  v_add_f32 v227, v227, v220
  v_mfma_f32_16x16x32_bf16 a[108:111], a[180:183], v[180:183], a[108:111]
  s_and_b32 s24, s24, 0x1ffff
  v_add_f32 v227, v227, v221
  v_cvt_pk_bf16_f32 v190, v220, v221
  v_add_f32 v227, v227, v222
  v_mfma_f32_16x16x32_bf16 a[112:115], a[184:187], v[176:179], a[112:115]
  ds_read_b128 a[152:155], v3 offset:6144
  v_add_f32 v227, v227, v223
  v_max_f32 v5, v226, v227
  v_cmp_lt_f32 vcc, s81, v5
  v_mfma_f32_16x16x32_bf16 a[116:119], a[184:187], v[180:183], a[116:119]
  v_exp_f32 v216, v128
  v_mfma_f32_16x16x32_bf16 a[120:123], a[188:191], v[176:179], a[120:123]
  s_waitcnt lgkmcnt(3)
  ds_read_b128 a[156:159], v3 offset:7168
  v_cvt_pk_bf16_f32 v191, v222, v223
  v_mfma_f32_16x16x32_bf16 a[124:127], a[188:191], v[180:183], a[124:127]
  s_cbranch_vccnz fa_stub12
fa_back12:
  v_exp_f32 v217, v129
  v_add_f32 v230, v230, v226
  v_add_f32 v231, v231, v227
  v_mfma_f32_16x16x32_bf16 v[144:147], a[128:131], v[64:67], v[200:203]
  ds_read_b128 a[160:163], v3 offset:24576
  v_add_f32 v226, v216, v217
  v_mfma_f32_16x16x32_bf16 v[152:155], a[128:131], v[68:71], v[204:207]
  v_exp_f32 v218, v130
  v_mfma_f32_16x16x32_bf16 v[148:151], a[132:135], v[64:67], v[200:203]
  s_add_u32 s66, s66, 32768
  ds_read_b128 a[164:167], v3 offset:25600
  v_cvt_pk_bf16_f32 v176, v216, v217
  v_mfma_f32_16x16x32_bf16 v[156:159], a[132:135], v[68:71], v[204:207]
  s_mov_b32 m0, s25
  v_exp_f32 v219, v131
  v_mfma_f32_16x16x32_bf16 v[144:147], a[136:139], v[72:75], v[144:147]
  s_and_b32 s66, s66, 0x1ffff
  ds_read_b128 a[168:171], v3 offset:26624
  buffer_load_dwordx4 v2, s[48:51], s27 offen offset:0 sc1 lds
  v_add_f32 v226, v226, v218
  v_add_f32 v226, v226, v219
  v_mfma_f32_16x16x32_bf16 v[152:155], a[136:139], v[76:79], v[152:155]
  v_exp_f32 v220, v132
  v_mfma_f32_16x16x32_bf16 v[148:151], a[140:143], v[72:75], v[148:151]
  ds_read_b128 a[172:175], v3 offset:27648
  v_cvt_pk_bf16_f32 v177, v218, v219
  v_mfma_f32_16x16x32_bf16 v[156:159], a[140:143], v[76:79], v[156:159]
  s_waitcnt lgkmcnt(4)
  v_exp_f32 v221, v133
  v_mfma_f32_16x16x32_bf16 v[144:147], a[144:147], v[80:83], v[144:147]
  s_add_u32 s14, s13, 0
  ds_read_b128 a[176:179], v3 offset:28672
  buffer_load_dwordx4 a[12:15], v2, s[40:43], s14 offen offset:3072 sc1
  v_add_f32 v226, v226, v220
  v_mfma_f32_16x16x32_bf16 v[152:155], a[144:147], v[84:87], v[152:155]
  v_exp_f32 v222, v134
  v_mfma_f32_16x16x32_bf16 v[148:151], a[148:151], v[80:83], v[148:151]
  ds_read_b128 a[180:183], v3 offset:29696
  buffer_load_dwordx4 v2, s[48:51], s27 offen offset:1024 sc1 lds
  v_add_f32 v226, v226, v221
  v_cvt_pk_bf16_f32 v178, v220, v221
  v_mfma_f32_16x16x32_bf16 v[156:159], a[148:151], v[84:87], v[156:159]
  v_exp_f32 v223, v135
  v_mfma_f32_16x16x32_bf16 v[144:147], a[152:155], v[88:91], v[144:147]
  ds_read_b128 a[184:187], v3 offset:30720
  v_add_f32 v226, v226, v222
  v_mfma_f32_16x16x32_bf16 v[152:155], a[152:155], v[92:95], v[152:155]
  v_exp_f32 v216, v136
  v_mfma_f32_16x16x32_bf16 v[148:151], a[156:159], v[88:91], v[148:151]
  s_add_u32 s14, s13, 4096
  ds_read_b128 a[188:191], v3 offset:31744
  buffer_load_dwordx4 a[16:19], v2, s[40:43], s14 offen offset:0 sc1
  v_add_f32 v226, v226, v223
  v_exp_f32 v217, v137
  v_mfma_f32_16x16x32_bf16 v[156:159], a[156:159], v[92:95], v[156:159]
  s_waitcnt lgkmcnt(4)
  v_exp_f32 v218, v138
  v_mfma_f32_16x16x32_bf16 a[64:67], a[160:163], v[184:187], a[64:67]
  ds_read_b128 a[128:131], v3 offset:8192
  v_cvt_pk_bf16_f32 v179, v222, v223
  v_mfma_f32_16x16x32_bf16 a[68:71], a[160:163], v[188:191], a[68:71]
  v_exp_f32 v219, v139
  v_mfma_f32_16x16x32_bf16 a[72:75], a[164:167], v[184:187], a[72:75]
  ds_read_b128 a[132:135], v3 offset:9216
  buffer_load_dwordx4 v2, s[48:51], s27 offen offset:2048 sc1 lds
  v_add_f32 v227, v216, v217
  v_mfma_f32_16x16x32_bf16 a[76:79], a[164:167], v[188:191], a[76:79]
  v_exp_f32 v220, v140
  v_mfma_f32_16x16x32_bf16 a[80:83], a[168:171], v[184:187], a[80:83]
  ds_read_b128 a[136:139], v3 offset:10240
  v_cvt_pk_bf16_f32 v180, v216, v217
  v_mfma_f32_16x16x32_bf16 a[84:87], a[168:171], v[188:191], a[84:87]
  v_exp_f32 v221, v141
  v_mfma_f32_16x16x32_bf16 a[88:91], a[172:175], v[184:187], a[88:91]
  ds_read_b128 a[140:143], v3 offset:11264
  buffer_load_dwordx4 a[20:23], v2, s[40:43], s14 offen offset:1024 sc1
  v_add_f32 v227, v227, v218
  v_mfma_f32_16x16x32_bf16 a[92:95], a[172:175], v[188:191], a[92:95]
  s_waitcnt lgkmcnt(4)
  v_exp_f32 v222, v142
  v_mfma_f32_16x16x32_bf16 a[96:99], a[176:179], v[184:187], a[96:99]
  ds_read_b128 a[144:147], v3 offset:12288
  buffer_load_dwordx4 v2, s[48:51], s27 offen offset:3072 sc1 lds
  v_add_f32 v227, v227, v219
  v_cvt_pk_bf16_f32 v181, v218, v219
  v_mfma_f32_16x16x32_bf16 a[100:103], a[176:179], v[188:191], a[100:103]
  s_add_u32 s27, s27, 16384
  v_exp_f32 v223, v143
  v_mfma_f32_16x16x32_bf16 a[104:107], a[180:183], v[184:187], a[104:107]
  s_add_u32 s25, s25, 32768
  ds_read_b128 a[148:151], v3 offset:13312
  v_add_f32 v227, v227, v220
  v_mfma_f32_16x16x32_bf16 a[108:111], a[180:183], v[188:191], a[108:111]
  s_and_b32 s25, s25, 0x1ffff
  v_add_f32 v227, v227, v221
  v_cvt_pk_bf16_f32 v182, v220, v221
  v_add_f32 v227, v227, v222
  v_mfma_f32_16x16x32_bf16 a[112:115], a[184:187], v[184:187], a[112:115]
  ds_read_b128 a[152:155], v3 offset:14336
  v_add_f32 v227, v227, v223
  v_max_f32 v5, v226, v227
  v_cmp_lt_f32 vcc, s81, v5
  v_mfma_f32_16x16x32_bf16 a[116:119], a[184:187], v[188:191], a[116:119]
  v_exp_f32 v216, v144
  v_mfma_f32_16x16x32_bf16 a[120:123], a[188:191], v[184:187], a[120:123]
  s_waitcnt lgkmcnt(3)
  ds_read_b128 a[156:159], v3 offset:15360
  v_cvt_pk_bf16_f32 v183, v222, v223
  v_add_u32 v3, s66, v2
  v_mfma_f32_16x16x32_bf16 a[124:127], a[188:191], v[188:191], a[124:127]
  s_cbranch_vccnz fa_stub13
fa_back13:
  v_exp_f32 v217, v145
  v_add_f32 v230, v230, v226
  v_add_f32 v231, v231, v227
fa_SSW7:
  v_mfma_f32_16x16x32_bf16 v[128:131], a[128:131], v[64:67], v[200:203]
  s_waitcnt vmcnt(12)
  v_exp_f32 v218, v146
  v_mfma_f32_16x16x32_bf16 v[136:139], a[128:131], v[68:71], v[204:207]
  s_barrier
  v_exp_f32 v219, v147
  v_mfma_f32_16x16x32_bf16 v[132:135], a[132:135], v[64:67], v[200:203]
  ds_read_b128 a[160:163], v3 offset:16384
  ds_read_b128 a[164:167], v3 offset:17408
  v_add_f32 v226, v216, v217
  v_mfma_f32_16x16x32_bf16 v[140:143], a[132:135], v[68:71], v[204:207]
  s_mov_b32 m0, s24
  v_exp_f32 v220, v148
  v_mfma_f32_16x16x32_bf16 v[128:131], a[136:139], v[72:75], v[128:131]
  ds_read_b128 a[168:171], v3 offset:18432
  buffer_load_dwordx4 v2, s[44:47], s26 offen offset:0 sc1 lds
  v_cvt_pk_bf16_f32 v184, v216, v217
  v_mfma_f32_16x16x32_bf16 v[136:139], a[136:139], v[76:79], v[136:139]
  v_exp_f32 v221, v149
  v_mfma_f32_16x16x32_bf16 v[132:135], a[140:143], v[72:75], v[132:135]
  ds_read_b128 a[172:175], v3 offset:19456
  v_add_f32 v226, v226, v218
  v_add_f32 v226, v226, v219
  v_mfma_f32_16x16x32_bf16 v[140:143], a[140:143], v[76:79], v[140:143]
  s_waitcnt lgkmcnt(4)
  v_exp_f32 v222, v150
  v_mfma_f32_16x16x32_bf16 v[128:131], a[144:147], v[80:83], v[128:131]
  s_add_u32 s14, s13, 4096
  ds_read_b128 a[176:179], v3 offset:20480
  buffer_load_dwordx4 a[24:27], v2, s[40:43], s14 offen offset:2048 sc1
  v_cvt_pk_bf16_f32 v185, v218, v219
  v_mfma_f32_16x16x32_bf16 v[136:139], a[144:147], v[84:87], v[136:139]
  v_exp_f32 v223, v151
  v_mfma_f32_16x16x32_bf16 v[132:135], a[148:151], v[80:83], v[132:135]
  ds_read_b128 a[180:183], v3 offset:21504
  buffer_load_dwordx4 v2, s[44:47], s26 offen offset:1024 sc1 lds
  v_add_f32 v226, v226, v220
  v_mfma_f32_16x16x32_bf16 v[140:143], a[148:151], v[84:87], v[140:143]
  v_exp_f32 v216, v152
  v_mfma_f32_16x16x32_bf16 v[128:131], a[152:155], v[88:91], v[128:131]
  ds_read_b128 a[184:187], v3 offset:22528
  v_add_f32 v226, v226, v221
  v_cvt_pk_bf16_f32 v186, v220, v221
  v_mfma_f32_16x16x32_bf16 v[136:139], a[152:155], v[92:95], v[136:139]
  v_exp_f32 v217, v153
  v_mfma_f32_16x16x32_bf16 v[132:135], a[156:159], v[88:91], v[132:135]
  ds_read_b128 a[188:191], v3 offset:23552
  buffer_load_dwordx4 a[28:31], v2, s[40:43], s14 offen offset:3072 sc1
  v_add_f32 v226, v226, v222
  v_mfma_f32_16x16x32_bf16 v[140:143], a[156:159], v[92:95], v[140:143]
  s_waitcnt lgkmcnt(4)
  v_exp_f32 v218, v154
  v_mfma_f32_16x16x32_bf16 a[64:67], a[160:163], v[176:179], a[64:67]
  ds_read_b128 a[128:131], v3 offset:0
  v_add_f32 v226, v226, v223
  v_cvt_pk_bf16_f32 v187, v222, v223
  v_mfma_f32_16x16x32_bf16 a[68:71], a[160:163], v[180:183], a[68:71]
  v_exp_f32 v219, v155
  v_mfma_f32_16x16x32_bf16 a[72:75], a[164:167], v[176:179], a[72:75]
  ds_read_b128 a[132:135], v3 offset:1024
  buffer_load_dwordx4 v2, s[44:47], s26 offen offset:2048 sc1 lds
  v_add_f32 v227, v216, v217
  v_mfma_f32_16x16x32_bf16 a[76:79], a[164:167], v[180:183], a[76:79]
  v_exp_f32 v220, v156
  v_mfma_f32_16x16x32_bf16 a[80:83], a[168:171], v[176:179], a[80:83]
  ds_read_b128 a[136:139], v3 offset:2048
  v_cvt_pk_bf16_f32 v188, v216, v217
  v_mfma_f32_16x16x32_bf16 a[84:87], a[168:171], v[180:183], a[84:87]
  v_exp_f32 v221, v157
  v_mfma_f32_16x16x32_bf16 a[88:91], a[172:175], v[176:179], a[88:91]
  s_add_u32 s14, s13, 8192
  ds_read_b128 a[140:143], v3 offset:3072
  buffer_load_dwordx4 a[32:35], v2, s[40:43], s14 offen offset:0 sc1
  v_add_f32 v227, v227, v218
  v_add_f32 v227, v227, v219
  v_mfma_f32_16x16x32_bf16 a[92:95], a[172:175], v[180:183], a[92:95]
  s_waitcnt lgkmcnt(4)
  v_exp_f32 v222, v158
  v_mfma_f32_16x16x32_bf16 a[96:99], a[176:179], v[176:179], a[96:99]
  ds_read_b128 a[144:147], v3 offset:4096
  buffer_load_dwordx4 v2, s[44:47], s26 offen offset:3072 sc1 lds
  v_cvt_pk_bf16_f32 v189, v218, v219
  v_mfma_f32_16x16x32_bf16 a[100:103], a[176:179], v[180:183], a[100:103]
  s_add_u32 s26, s26, 16384
  v_exp_f32 v223, v159
  v_mfma_f32_16x16x32_bf16 a[104:107], a[180:183], v[176:179], a[104:107]
  s_add_u32 s24, s24, 32768
  ds_read_b128 a[148:151], v3 offset:5120
  v_add_f32 v227, v227, v220
  v_mfma_f32_16x16x32_bf16 a[108:111], a[180:183], v[180:183], a[108:111]
  s_and_b32 s24, s24, 0x1ffff
  v_add_f32 v227, v227, v221
  v_cvt_pk_bf16_f32 v190, v220, v221
  v_add_f32 v227, v227, v222
  v_mfma_f32_16x16x32_bf16 a[112:115], a[184:187], v[176:179], a[112:115]
  ds_read_b128 a[152:155], v3 offset:6144
  v_add_f32 v227, v227, v223
  v_max_f32 v5, v226, v227
  v_cmp_lt_f32 vcc, s81, v5
  v_mfma_f32_16x16x32_bf16 a[116:119], a[184:187], v[180:183], a[116:119]
  v_exp_f32 v216, v128
  v_mfma_f32_16x16x32_bf16 a[120:123], a[188:191], v[176:179], a[120:123]
  s_waitcnt lgkmcnt(3)
  ds_read_b128 a[156:159], v3 offset:7168
  v_cvt_pk_bf16_f32 v191, v222, v223
  v_mfma_f32_16x16x32_bf16 a[124:127], a[188:191], v[180:183], a[124:127]
  s_cbranch_vccnz fa_stub14
fa_back14:
  v_exp_f32 v217, v129
  v_add_f32 v230, v230, v226
  v_add_f32 v231, v231, v227
  v_mfma_f32_16x16x32_bf16 v[144:147], a[128:131], v[64:67], v[200:203]
  ds_read_b128 a[160:163], v3 offset:24576
  v_add_f32 v226, v216, v217
  v_mfma_f32_16x16x32_bf16 v[152:155], a[128:131], v[68:71], v[204:207]
  v_exp_f32 v218, v130
  v_mfma_f32_16x16x32_bf16 v[148:151], a[132:135], v[64:67], v[200:203]
  s_add_u32 s66, s66, 32768
  ds_read_b128 a[164:167], v3 offset:25600
  v_cvt_pk_bf16_f32 v176, v216, v217
  v_mfma_f32_16x16x32_bf16 v[156:159], a[132:135], v[68:71], v[204:207]
  s_mov_b32 m0, s25
  v_exp_f32 v219, v131
  v_mfma_f32_16x16x32_bf16 v[144:147], a[136:139], v[72:75], v[144:147]
  s_and_b32 s66, s66, 0x1ffff
  ds_read_b128 a[168:171], v3 offset:26624
  buffer_load_dwordx4 v2, s[48:51], s27 offen offset:0 sc1 lds
  v_add_f32 v226, v226, v218
  v_add_f32 v226, v226, v219
  v_mfma_f32_16x16x32_bf16 v[152:155], a[136:139], v[76:79], v[152:155]
  v_exp_f32 v220, v132
  v_mfma_f32_16x16x32_bf16 v[148:151], a[140:143], v[72:75], v[148:151]
  ds_read_b128 a[172:175], v3 offset:27648
  v_cvt_pk_bf16_f32 v177, v218, v219
  v_mfma_f32_16x16x32_bf16 v[156:159], a[140:143], v[76:79], v[156:159]
  s_waitcnt lgkmcnt(4)
  v_exp_f32 v221, v133
  v_mfma_f32_16x16x32_bf16 v[144:147], a[144:147], v[80:83], v[144:147]
  s_add_u32 s14, s13, 8192
  ds_read_b128 a[176:179], v3 offset:28672
  buffer_load_dwordx4 a[36:39], v2, s[40:43], s14 offen offset:1024 sc1
  v_add_f32 v226, v226, v220
  v_mfma_f32_16x16x32_bf16 v[152:155], a[144:147], v[84:87], v[152:155]
  v_exp_f32 v222, v134
  v_mfma_f32_16x16x32_bf16 v[148:151], a[148:151], v[80:83], v[148:151]
  ds_read_b128 a[180:183], v3 offset:29696
  buffer_load_dwordx4 v2, s[48:51], s27 offen offset:1024 sc1 lds
  v_add_f32 v226, v226, v221
  v_cvt_pk_bf16_f32 v178, v220, v221
  v_mfma_f32_16x16x32_bf16 v[156:159], a[148:151], v[84:87], v[156:159]
  v_exp_f32 v223, v135
  v_mfma_f32_16x16x32_bf16 v[144:147], a[152:155], v[88:91], v[144:147]
  ds_read_b128 a[184:187], v3 offset:30720
  v_add_f32 v226, v226, v222
  v_mfma_f32_16x16x32_bf16 v[152:155], a[152:155], v[92:95], v[152:155]
  v_exp_f32 v216, v136
  v_mfma_f32_16x16x32_bf16 v[148:151], a[156:159], v[88:91], v[148:151]
  ds_read_b128 a[188:191], v3 offset:31744
  buffer_load_dwordx4 a[40:43], v2, s[40:43], s14 offen offset:2048 sc1
  v_add_f32 v226, v226, v223
  v_exp_f32 v217, v137
  v_mfma_f32_16x16x32_bf16 v[156:159], a[156:159], v[92:95], v[156:159]
  s_waitcnt lgkmcnt(4)
  v_exp_f32 v218, v138
  v_mfma_f32_16x16x32_bf16 a[64:67], a[160:163], v[184:187], a[64:67]
  ds_read_b128 a[128:131], v3 offset:8192
  v_cvt_pk_bf16_f32 v179, v222, v223
  v_mfma_f32_16x16x32_bf16 a[68:71], a[160:163], v[188:191], a[68:71]
  v_exp_f32 v219, v139
  v_mfma_f32_16x16x32_bf16 a[72:75], a[164:167], v[184:187], a[72:75]
  ds_read_b128 a[132:135], v3 offset:9216
  buffer_load_dwordx4 v2, s[48:51], s27 offen offset:2048 sc1 lds
  v_add_f32 v227, v216, v217
  v_mfma_f32_16x16x32_bf16 a[76:79], a[164:167], v[188:191], a[76:79]
  v_exp_f32 v220, v140
  v_mfma_f32_16x16x32_bf16 a[80:83], a[168:171], v[184:187], a[80:83]
  ds_read_b128 a[136:139], v3 offset:10240
  v_cvt_pk_bf16_f32 v180, v216, v217
  v_mfma_f32_16x16x32_bf16 a[84:87], a[168:171], v[188:191], a[84:87]
  v_exp_f32 v221, v141
  v_mfma_f32_16x16x32_bf16 a[88:91], a[172:175], v[184:187], a[88:91]
  ds_read_b128 a[140:143], v3 offset:11264
  buffer_load_dwordx4 a[44:47], v2, s[40:43], s14 offen offset:3072 sc1
  v_add_f32 v227, v227, v218
  v_mfma_f32_16x16x32_bf16 a[92:95], a[172:175], v[188:191], a[92:95]
  s_waitcnt lgkmcnt(4)
  v_exp_f32 v222, v142
  v_mfma_f32_16x16x32_bf16 a[96:99], a[176:179], v[184:187], a[96:99]
  ds_read_b128 a[144:147], v3 offset:12288
  buffer_load_dwordx4 v2, s[48:51], s27 offen offset:3072 sc1 lds
  v_add_f32 v227, v227, v219
  v_cvt_pk_bf16_f32 v181, v218, v219
  v_mfma_f32_16x16x32_bf16 a[100:103], a[176:179], v[188:191], a[100:103]
  s_add_u32 s27, s27, 16384
  v_exp_f32 v223, v143
  v_mfma_f32_16x16x32_bf16 a[104:107], a[180:183], v[184:187], a[104:107]
  s_add_u32 s25, s25, 32768
  ds_read_b128 a[148:151], v3 offset:13312
  v_add_f32 v227, v227, v220
  v_mfma_f32_16x16x32_bf16 a[108:111], a[180:183], v[188:191], a[108:111]
  s_and_b32 s25, s25, 0x1ffff
  v_add_f32 v227, v227, v221
  v_cvt_pk_bf16_f32 v182, v220, v221
  v_add_f32 v227, v227, v222
  v_mfma_f32_16x16x32_bf16 a[112:115], a[184:187], v[184:187], a[112:115]
  ds_read_b128 a[152:155], v3 offset:14336
  v_add_f32 v227, v227, v223
  v_max_f32 v5, v226, v227
  v_cmp_lt_f32 vcc, s81, v5
  v_mfma_f32_16x16x32_bf16 a[116:119], a[184:187], v[188:191], a[116:119]
  v_exp_f32 v216, v144
  v_mfma_f32_16x16x32_bf16 a[120:123], a[188:191], v[184:187], a[120:123]
  s_waitcnt lgkmcnt(3)
  ds_read_b128 a[156:159], v3 offset:15360
  v_cvt_pk_bf16_f32 v183, v222, v223
  v_add_u32 v3, s66, v2
  v_mfma_f32_16x16x32_bf16 a[124:127], a[188:191], v[188:191], a[124:127]
  s_cbranch_vccnz fa_stub15
fa_back15:
  v_exp_f32 v217, v145
  v_add_f32 v230, v230, v226
  v_add_f32 v231, v231, v227
fa_SSW6:
  v_mfma_f32_16x16x32_bf16 v[128:131], a[128:131], v[64:67], v[200:203]
  s_waitcnt vmcnt(12)
  v_exp_f32 v218, v146
  v_mfma_f32_16x16x32_bf16 v[136:139], a[128:131], v[68:71], v[204:207]
  s_barrier
  v_exp_f32 v219, v147
  v_mfma_f32_16x16x32_bf16 v[132:135], a[132:135], v[64:67], v[200:203]
  ds_read_b128 a[160:163], v3 offset:16384
  ds_read_b128 a[164:167], v3 offset:17408
  v_add_f32 v226, v216, v217
  v_mfma_f32_16x16x32_bf16 v[140:143], a[132:135], v[68:71], v[204:207]
  s_mov_b32 m0, s24
  v_exp_f32 v220, v148
  v_mfma_f32_16x16x32_bf16 v[128:131], a[136:139], v[72:75], v[128:131]
  ds_read_b128 a[168:171], v3 offset:18432
  buffer_load_dwordx4 v2, s[44:47], s26 offen offset:0 sc1 lds
  v_cvt_pk_bf16_f32 v184, v216, v217
  v_mfma_f32_16x16x32_bf16 v[136:139], a[136:139], v[76:79], v[136:139]
  v_exp_f32 v221, v149
  v_mfma_f32_16x16x32_bf16 v[132:135], a[140:143], v[72:75], v[132:135]
  ds_read_b128 a[172:175], v3 offset:19456
  v_add_f32 v226, v226, v218
  v_add_f32 v226, v226, v219
  v_mfma_f32_16x16x32_bf16 v[140:143], a[140:143], v[76:79], v[140:143]
  s_waitcnt lgkmcnt(4)
  v_exp_f32 v222, v150
  v_mfma_f32_16x16x32_bf16 v[128:131], a[144:147], v[80:83], v[128:131]
  s_add_u32 s14, s13, 12288
  ds_read_b128 a[176:179], v3 offset:20480
  buffer_load_dwordx4 a[48:51], v2, s[40:43], s14 offen offset:0 sc1
  v_cvt_pk_bf16_f32 v185, v218, v219
  v_mfma_f32_16x16x32_bf16 v[136:139], a[144:147], v[84:87], v[136:139]
  v_exp_f32 v223, v151
  v_mfma_f32_16x16x32_bf16 v[132:135], a[148:151], v[80:83], v[132:135]
  ds_read_b128 a[180:183], v3 offset:21504
  buffer_load_dwordx4 v2, s[44:47], s26 offen offset:1024 sc1 lds
  v_add_f32 v226, v226, v220
  v_mfma_f32_16x16x32_bf16 v[140:143], a[148:151], v[84:87], v[140:143]
  v_exp_f32 v216, v152
  v_mfma_f32_16x16x32_bf16 v[128:131], a[152:155], v[88:91], v[128:131]
  ds_read_b128 a[184:187], v3 offset:22528
  v_add_f32 v226, v226, v221
  v_cvt_pk_bf16_f32 v186, v220, v221
  v_mfma_f32_16x16x32_bf16 v[136:139], a[152:155], v[92:95], v[136:139]
  v_exp_f32 v217, v153
  v_mfma_f32_16x16x32_bf16 v[132:135], a[156:159], v[88:91], v[132:135]
  ds_read_b128 a[188:191], v3 offset:23552
  buffer_load_dwordx4 a[52:55], v2, s[40:43], s14 offen offset:1024 sc1
  v_add_f32 v226, v226, v222
  v_mfma_f32_16x16x32_bf16 v[140:143], a[156:159], v[92:95], v[140:143]
  s_waitcnt lgkmcnt(4)
  v_exp_f32 v218, v154
  v_mfma_f32_16x16x32_bf16 a[64:67], a[160:163], v[176:179], a[64:67]
  ds_read_b128 a[128:131], v3 offset:0
  v_add_f32 v226, v226, v223
  v_cvt_pk_bf16_f32 v187, v222, v223
  v_mfma_f32_16x16x32_bf16 a[68:71], a[160:163], v[180:183], a[68:71]
  v_exp_f32 v219, v155
  v_mfma_f32_16x16x32_bf16 a[72:75], a[164:167], v[176:179], a[72:75]
  ds_read_b128 a[132:135], v3 offset:1024
  buffer_load_dwordx4 v2, s[44:47], s26 offen offset:2048 sc1 lds
  v_add_f32 v227, v216, v217
  v_mfma_f32_16x16x32_bf16 a[76:79], a[164:167], v[180:183], a[76:79]
  v_exp_f32 v220, v156
  v_mfma_f32_16x16x32_bf16 a[80:83], a[168:171], v[176:179], a[80:83]
  ds_read_b128 a[136:139], v3 offset:2048
  v_cvt_pk_bf16_f32 v188, v216, v217
  v_mfma_f32_16x16x32_bf16 a[84:87], a[168:171], v[180:183], a[84:87]
  v_exp_f32 v221, v157
  v_mfma_f32_16x16x32_bf16 a[88:91], a[172:175], v[176:179], a[88:91]
  ds_read_b128 a[140:143], v3 offset:3072
  buffer_load_dwordx4 a[56:59], v2, s[40:43], s14 offen offset:2048 sc1
  v_add_f32 v227, v227, v218
  v_add_f32 v227, v227, v219
  v_mfma_f32_16x16x32_bf16 a[92:95], a[172:175], v[180:183], a[92:95]
  s_waitcnt lgkmcnt(4)
  v_exp_f32 v222, v158
  v_mfma_f32_16x16x32_bf16 a[96:99], a[176:179], v[176:179], a[96:99]
  ds_read_b128 a[144:147], v3 offset:4096
  buffer_load_dwordx4 v2, s[44:47], s26 offen offset:3072 sc1 lds
  v_cvt_pk_bf16_f32 v189, v218, v219
  v_mfma_f32_16x16x32_bf16 a[100:103], a[176:179], v[180:183], a[100:103]
  s_add_u32 s26, s26, 16384
  v_exp_f32 v223, v159
  v_mfma_f32_16x16x32_bf16 a[104:107], a[180:183], v[176:179], a[104:107]
  s_add_u32 s24, s24, 32768
  ds_read_b128 a[148:151], v3 offset:5120
  v_add_f32 v227, v227, v220
  v_mfma_f32_16x16x32_bf16 a[108:111], a[180:183], v[180:183], a[108:111]
  s_and_b32 s24, s24, 0x1ffff
  v_add_f32 v227, v227, v221
  v_cvt_pk_bf16_f32 v190, v220, v221
  v_add_f32 v227, v227, v222
  v_mfma_f32_16x16x32_bf16 a[112:115], a[184:187], v[176:179], a[112:115]
  ds_read_b128 a[152:155], v3 offset:6144
  v_add_f32 v227, v227, v223
  v_max_f32 v5, v226, v227
  v_cmp_lt_f32 vcc, s81, v5
  v_mfma_f32_16x16x32_bf16 a[116:119], a[184:187], v[180:183], a[116:119]
  v_exp_f32 v216, v128
  v_mfma_f32_16x16x32_bf16 a[120:123], a[188:191], v[176:179], a[120:123]
  s_waitcnt lgkmcnt(3)
  ds_read_b128 a[156:159], v3 offset:7168
  v_cvt_pk_bf16_f32 v191, v222, v223
  v_mfma_f32_16x16x32_bf16 a[124:127], a[188:191], v[180:183], a[124:127]
  s_cbranch_vccnz fa_stub16
fa_back16:
  v_exp_f32 v217, v129
  v_add_f32 v230, v230, v226
  v_add_f32 v231, v231, v227
  v_mfma_f32_16x16x32_bf16 v[144:147], a[128:131], v[64:67], v[200:203]
  ds_read_b128 a[160:163], v3 offset:24576
  v_add_f32 v226, v216, v217
  v_mfma_f32_16x16x32_bf16 v[152:155], a[128:131], v[68:71], v[204:207]
  v_exp_f32 v218, v130
  v_mfma_f32_16x16x32_bf16 v[148:151], a[132:135], v[64:67], v[200:203]
  s_add_u32 s66, s66, 32768
  ds_read_b128 a[164:167], v3 offset:25600
  v_cvt_pk_bf16_f32 v176, v216, v217
  v_mfma_f32_16x16x32_bf16 v[156:159], a[132:135], v[68:71], v[204:207]
  s_mov_b32 m0, s25
  v_exp_f32 v219, v131
  v_mfma_f32_16x16x32_bf16 v[144:147], a[136:139], v[72:75], v[144:147]
  s_and_b32 s66, s66, 0x1ffff
  ds_read_b128 a[168:171], v3 offset:26624
  buffer_load_dwordx4 v2, s[48:51], s27 offen offset:0 sc1 lds
  v_add_f32 v226, v226, v218
  v_add_f32 v226, v226, v219
  v_mfma_f32_16x16x32_bf16 v[152:155], a[136:139], v[76:79], v[152:155]
  v_exp_f32 v220, v132
  v_mfma_f32_16x16x32_bf16 v[148:151], a[140:143], v[72:75], v[148:151]
  ds_read_b128 a[172:175], v3 offset:27648
  v_cvt_pk_bf16_f32 v177, v218, v219
  v_mfma_f32_16x16x32_bf16 v[156:159], a[140:143], v[76:79], v[156:159]
  s_waitcnt lgkmcnt(4)
  v_exp_f32 v221, v133
  v_mfma_f32_16x16x32_bf16 v[144:147], a[144:147], v[80:83], v[144:147]
  s_add_u32 s14, s13, 12288
  ds_read_b128 a[176:179], v3 offset:28672
  buffer_load_dwordx4 a[60:63], v2, s[40:43], s14 offen offset:3072 sc1
  v_add_f32 v226, v226, v220
  v_mfma_f32_16x16x32_bf16 v[152:155], a[144:147], v[84:87], v[152:155]
  v_exp_f32 v222, v134
  v_mfma_f32_16x16x32_bf16 v[148:151], a[148:151], v[80:83], v[148:151]
  ds_read_b128 a[180:183], v3 offset:29696
  buffer_load_dwordx4 v2, s[48:51], s27 offen offset:1024 sc1 lds
  v_add_f32 v226, v226, v221
  v_cvt_pk_bf16_f32 v178, v220, v221
  v_mfma_f32_16x16x32_bf16 v[156:159], a[148:151], v[84:87], v[156:159]
  v_exp_f32 v223, v135
  v_mfma_f32_16x16x32_bf16 v[144:147], a[152:155], v[88:91], v[144:147]
  ds_read_b128 a[184:187], v3 offset:30720
  v_add_f32 v226, v226, v222
  v_mfma_f32_16x16x32_bf16 v[152:155], a[152:155], v[92:95], v[152:155]
  v_exp_f32 v216, v136
  v_mfma_f32_16x16x32_bf16 v[148:151], a[156:159], v[88:91], v[148:151]
  s_add_u32 s14, s13, 16384
  ds_read_b128 a[188:191], v3 offset:31744
  buffer_load_dwordx4 a[192:195], v2, s[40:43], s14 offen offset:0 sc1
  v_add_f32 v226, v226, v223
  v_exp_f32 v217, v137
  v_mfma_f32_16x16x32_bf16 v[156:159], a[156:159], v[92:95], v[156:159]
  s_waitcnt lgkmcnt(4)
  v_exp_f32 v218, v138
  v_mfma_f32_16x16x32_bf16 a[64:67], a[160:163], v[184:187], a[64:67]
  ds_read_b128 a[128:131], v3 offset:8192
  v_cvt_pk_bf16_f32 v179, v222, v223
  v_mfma_f32_16x16x32_bf16 a[68:71], a[160:163], v[188:191], a[68:71]
  v_exp_f32 v219, v139
  v_mfma_f32_16x16x32_bf16 a[72:75], a[164:167], v[184:187], a[72:75]
  ds_read_b128 a[132:135], v3 offset:9216
  buffer_load_dwordx4 v2, s[48:51], s27 offen offset:2048 sc1 lds
  v_add_f32 v227, v216, v217
  v_mfma_f32_16x16x32_bf16 a[76:79], a[164:167], v[188:191], a[76:79]
  v_exp_f32 v220, v140
  v_mfma_f32_16x16x32_bf16 a[80:83], a[168:171], v[184:187], a[80:83]
  ds_read_b128 a[136:139], v3 offset:10240
  v_cvt_pk_bf16_f32 v180, v216, v217
  v_mfma_f32_16x16x32_bf16 a[84:87], a[168:171], v[188:191], a[84:87]
  v_exp_f32 v221, v141
  v_mfma_f32_16x16x32_bf16 a[88:91], a[172:175], v[184:187], a[88:91]
  ds_read_b128 a[140:143], v3 offset:11264
  buffer_load_dwordx4 a[196:199], v2, s[40:43], s14 offen offset:1024 sc1
  v_add_f32 v227, v227, v218
  v_mfma_f32_16x16x32_bf16 a[92:95], a[172:175], v[188:191], a[92:95]
  s_waitcnt lgkmcnt(4)
  v_exp_f32 v222, v142
  v_mfma_f32_16x16x32_bf16 a[96:99], a[176:179], v[184:187], a[96:99]
  ds_read_b128 a[144:147], v3 offset:12288
  buffer_load_dwordx4 v2, s[48:51], s27 offen offset:3072 sc1 lds
  v_add_f32 v227, v227, v219
  v_cvt_pk_bf16_f32 v181, v218, v219
  v_mfma_f32_16x16x32_bf16 a[100:103], a[176:179], v[188:191], a[100:103]
  s_add_u32 s27, s27, 16384
  v_exp_f32 v223, v143
  v_mfma_f32_16x16x32_bf16 a[104:107], a[180:183], v[184:187], a[104:107]
  s_add_u32 s25, s25, 32768
  ds_read_b128 a[148:151], v3 offset:13312
  v_add_f32 v227, v227, v220
  v_mfma_f32_16x16x32_bf16 a[108:111], a[180:183], v[188:191], a[108:111]
  s_and_b32 s25, s25, 0x1ffff
  v_add_f32 v227, v227, v221
  v_cvt_pk_bf16_f32 v182, v220, v221
  v_add_f32 v227, v227, v222
  v_mfma_f32_16x16x32_bf16 a[112:115], a[184:187], v[184:187], a[112:115]
  ds_read_b128 a[152:155], v3 offset:14336
  v_add_f32 v227, v227, v223
  v_max_f32 v5, v226, v227
  v_cmp_lt_f32 vcc, s81, v5
  v_mfma_f32_16x16x32_bf16 a[116:119], a[184:187], v[188:191], a[116:119]
  v_exp_f32 v216, v144
  v_mfma_f32_16x16x32_bf16 a[120:123], a[188:191], v[184:187], a[120:123]
  s_waitcnt lgkmcnt(3)
  ds_read_b128 a[156:159], v3 offset:15360
  v_cvt_pk_bf16_f32 v183, v222, v223
  v_add_u32 v3, s66, v2
  v_mfma_f32_16x16x32_bf16 a[124:127], a[188:191], v[188:191], a[124:127]
  s_cbranch_vccnz fa_stub17
fa_back17:
  v_exp_f32 v217, v145
  v_add_f32 v230, v230, v226
  v_add_f32 v231, v231, v227
fa_SSW5:
  v_mfma_f32_16x16x32_bf16 v[128:131], a[128:131], v[64:67], v[200:203]
  s_waitcnt vmcnt(12)
  v_exp_f32 v218, v146
  v_mfma_f32_16x16x32_bf16 v[136:139], a[128:131], v[68:71], v[204:207]
  s_barrier
  v_exp_f32 v219, v147
  v_mfma_f32_16x16x32_bf16 v[132:135], a[132:135], v[64:67], v[200:203]
  ds_read_b128 a[160:163], v3 offset:16384
  ds_read_b128 a[164:167], v3 offset:17408
  v_add_f32 v226, v216, v217
  v_mfma_f32_16x16x32_bf16 v[140:143], a[132:135], v[68:71], v[204:207]
  s_mov_b32 m0, s24
  v_exp_f32 v220, v148
  v_mfma_f32_16x16x32_bf16 v[128:131], a[136:139], v[72:75], v[128:131]
  ds_read_b128 a[168:171], v3 offset:18432
  buffer_load_dwordx4 v2, s[44:47], s26 offen offset:0 sc1 lds
  v_cvt_pk_bf16_f32 v184, v216, v217
  v_mfma_f32_16x16x32_bf16 v[136:139], a[136:139], v[76:79], v[136:139]
  v_exp_f32 v221, v149
  v_mfma_f32_16x16x32_bf16 v[132:135], a[140:143], v[72:75], v[132:135]
  ds_read_b128 a[172:175], v3 offset:19456
  v_add_f32 v226, v226, v218
  v_add_f32 v226, v226, v219
  v_mfma_f32_16x16x32_bf16 v[140:143], a[140:143], v[76:79], v[140:143]
  s_waitcnt lgkmcnt(4)
  v_exp_f32 v222, v150
  v_mfma_f32_16x16x32_bf16 v[128:131], a[144:147], v[80:83], v[128:131]
  s_add_u32 s14, s13, 16384
  ds_read_b128 a[176:179], v3 offset:20480
  buffer_load_dwordx4 a[200:203], v2, s[40:43], s14 offen offset:2048 sc1
  v_cvt_pk_bf16_f32 v185, v218, v219
  v_mfma_f32_16x16x32_bf16 v[136:139], a[144:147], v[84:87], v[136:139]
  v_exp_f32 v223, v151
  v_mfma_f32_16x16x32_bf16 v[132:135], a[148:151], v[80:83], v[132:135]
  ds_read_b128 a[180:183], v3 offset:21504
  buffer_load_dwordx4 v2, s[44:47], s26 offen offset:1024 sc1 lds
  v_add_f32 v226, v226, v220
  v_mfma_f32_16x16x32_bf16 v[140:143], a[148:151], v[84:87], v[140:143]
  v_exp_f32 v216, v152
  v_mfma_f32_16x16x32_bf16 v[128:131], a[152:155], v[88:91], v[128:131]
  ds_read_b128 a[184:187], v3 offset:22528
  v_add_f32 v226, v226, v221
  v_cvt_pk_bf16_f32 v186, v220, v221
  v_mfma_f32_16x16x32_bf16 v[136:139], a[152:155], v[92:95], v[136:139]
  v_exp_f32 v217, v153
  v_mfma_f32_16x16x32_bf16 v[132:135], a[156:159], v[88:91], v[132:135]
  ds_read_b128 a[188:191], v3 offset:23552
  buffer_load_dwordx4 a[204:207], v2, s[40:43], s14 offen offset:3072 sc1
  v_add_f32 v226, v226, v222
  v_mfma_f32_16x16x32_bf16 v[140:143], a[156:159], v[92:95], v[140:143]
  s_waitcnt lgkmcnt(4)
  v_exp_f32 v218, v154
  v_mfma_f32_16x16x32_bf16 a[64:67], a[160:163], v[176:179], a[64:67]
  ds_read_b128 a[128:131], v3 offset:0
  v_add_f32 v226, v226, v223
  v_cvt_pk_bf16_f32 v187, v222, v223
  v_mfma_f32_16x16x32_bf16 a[68:71], a[160:163], v[180:183], a[68:71]
  v_exp_f32 v219, v155
  v_mfma_f32_16x16x32_bf16 a[72:75], a[164:167], v[176:179], a[72:75]
  ds_read_b128 a[132:135], v3 offset:1024
  buffer_load_dwordx4 v2, s[44:47], s26 offen offset:2048 sc1 lds
  v_add_f32 v227, v216, v217
  v_mfma_f32_16x16x32_bf16 a[76:79], a[164:167], v[180:183], a[76:79]
  v_exp_f32 v220, v156
  v_mfma_f32_16x16x32_bf16 a[80:83], a[168:171], v[176:179], a[80:83]
  ds_read_b128 a[136:139], v3 offset:2048
  v_cvt_pk_bf16_f32 v188, v216, v217
  v_mfma_f32_16x16x32_bf16 a[84:87], a[168:171], v[180:183], a[84:87]
  v_exp_f32 v221, v157
  v_mfma_f32_16x16x32_bf16 a[88:91], a[172:175], v[176:179], a[88:91]
  s_add_u32 s14, s13, 20480
  ds_read_b128 a[140:143], v3 offset:3072
  buffer_load_dwordx4 a[208:211], v2, s[40:43], s14 offen offset:0 sc1
  v_add_f32 v227, v227, v218
  v_add_f32 v227, v227, v219
  v_mfma_f32_16x16x32_bf16 a[92:95], a[172:175], v[180:183], a[92:95]
  s_waitcnt lgkmcnt(4)
  v_exp_f32 v222, v158
  v_mfma_f32_16x16x32_bf16 a[96:99], a[176:179], v[176:179], a[96:99]
  ds_read_b128 a[144:147], v3 offset:4096
  buffer_load_dwordx4 v2, s[44:47], s26 offen offset:3072 sc1 lds
  v_cvt_pk_bf16_f32 v189, v218, v219
  v_mfma_f32_16x16x32_bf16 a[100:103], a[176:179], v[180:183], a[100:103]
  s_add_u32 s26, s26, 16384
  v_exp_f32 v223, v159
  v_mfma_f32_16x16x32_bf16 a[104:107], a[180:183], v[176:179], a[104:107]
  s_add_u32 s24, s24, 32768
  ds_read_b128 a[148:151], v3 offset:5120
  v_add_f32 v227, v227, v220
  v_mfma_f32_16x16x32_bf16 a[108:111], a[180:183], v[180:183], a[108:111]
  s_and_b32 s24, s24, 0x1ffff
  v_add_f32 v227, v227, v221
  v_cvt_pk_bf16_f32 v190, v220, v221
  v_add_f32 v227, v227, v222
  v_mfma_f32_16x16x32_bf16 a[112:115], a[184:187], v[176:179], a[112:115]
  ds_read_b128 a[152:155], v3 offset:6144
  v_add_f32 v227, v227, v223
  v_max_f32 v5, v226, v227
  v_cmp_lt_f32 vcc, s81, v5
  v_mfma_f32_16x16x32_bf16 a[116:119], a[184:187], v[180:183], a[116:119]
  v_exp_f32 v216, v128
  v_mfma_f32_16x16x32_bf16 a[120:123], a[188:191], v[176:179], a[120:123]
  s_waitcnt lgkmcnt(3)
  ds_read_b128 a[156:159], v3 offset:7168
  v_cvt_pk_bf16_f32 v191, v222, v223
  v_mfma_f32_16x16x32_bf16 a[124:127], a[188:191], v[180:183], a[124:127]
  s_cbranch_vccnz fa_stub18
fa_back18:
  v_exp_f32 v217, v129
  v_add_f32 v230, v230, v226
  v_add_f32 v231, v231, v227
  v_mfma_f32_16x16x32_bf16 v[144:147], a[128:131], v[64:67], v[200:203]
  ds_read_b128 a[160:163], v3 offset:24576
  v_add_f32 v226, v216, v217
  v_mfma_f32_16x16x32_bf16 v[152:155], a[128:131], v[68:71], v[204:207]
  v_exp_f32 v218, v130
  v_mfma_f32_16x16x32_bf16 v[148:151], a[132:135], v[64:67], v[200:203]
  s_add_u32 s66, s66, 32768
  ds_read_b128 a[164:167], v3 offset:25600
  v_cvt_pk_bf16_f32 v176, v216, v217
  v_mfma_f32_16x16x32_bf16 v[156:159], a[132:135], v[68:71], v[204:207]
  s_mov_b32 m0, s25
  v_exp_f32 v219, v131
  v_mfma_f32_16x16x32_bf16 v[144:147], a[136:139], v[72:75], v[144:147]
  s_and_b32 s66, s66, 0x1ffff
  ds_read_b128 a[168:171], v3 offset:26624
  buffer_load_dwordx4 v2, s[48:51], s27 offen offset:0 sc1 lds
  v_add_f32 v226, v226, v218
  v_add_f32 v226, v226, v219
  v_mfma_f32_16x16x32_bf16 v[152:155], a[136:139], v[76:79], v[152:155]
  v_exp_f32 v220, v132
  v_mfma_f32_16x16x32_bf16 v[148:151], a[140:143], v[72:75], v[148:151]
  ds_read_b128 a[172:175], v3 offset:27648
  v_cvt_pk_bf16_f32 v177, v218, v219
  v_mfma_f32_16x16x32_bf16 v[156:159], a[140:143], v[76:79], v[156:159]
  s_waitcnt lgkmcnt(4)
  v_exp_f32 v221, v133
  v_mfma_f32_16x16x32_bf16 v[144:147], a[144:147], v[80:83], v[144:147]
  s_add_u32 s14, s13, 20480
  ds_read_b128 a[176:179], v3 offset:28672
  buffer_load_dwordx4 a[212:215], v2, s[40:43], s14 offen offset:1024 sc1
  v_add_f32 v226, v226, v220
  v_mfma_f32_16x16x32_bf16 v[152:155], a[144:147], v[84:87], v[152:155]
  v_exp_f32 v222, v134
  v_mfma_f32_16x16x32_bf16 v[148:151], a[148:151], v[80:83], v[148:151]
  ds_read_b128 a[180:183], v3 offset:29696
  buffer_load_dwordx4 v2, s[48:51], s27 offen offset:1024 sc1 lds
  v_add_f32 v226, v226, v221
  v_cvt_pk_bf16_f32 v178, v220, v221
  v_mfma_f32_16x16x32_bf16 v[156:159], a[148:151], v[84:87], v[156:159]
  v_exp_f32 v223, v135
  v_mfma_f32_16x16x32_bf16 v[144:147], a[152:155], v[88:91], v[144:147]
  ds_read_b128 a[184:187], v3 offset:30720
  v_add_f32 v226, v226, v222
  v_mfma_f32_16x16x32_bf16 v[152:155], a[152:155], v[92:95], v[152:155]
  v_exp_f32 v216, v136
  v_mfma_f32_16x16x32_bf16 v[148:151], a[156:159], v[88:91], v[148:151]
  ds_read_b128 a[188:191], v3 offset:31744
  buffer_load_dwordx4 a[216:219], v2, s[40:43], s14 offen offset:2048 sc1
  v_add_f32 v226, v226, v223
  v_exp_f32 v217, v137
  v_mfma_f32_16x16x32_bf16 v[156:159], a[156:159], v[92:95], v[156:159]
  s_waitcnt lgkmcnt(4)
  v_exp_f32 v218, v138
  v_mfma_f32_16x16x32_bf16 a[64:67], a[160:163], v[184:187], a[64:67]
  ds_read_b128 a[128:131], v3 offset:8192
  v_cvt_pk_bf16_f32 v179, v222, v223
  v_mfma_f32_16x16x32_bf16 a[68:71], a[160:163], v[188:191], a[68:71]
  v_exp_f32 v219, v139
  v_mfma_f32_16x16x32_bf16 a[72:75], a[164:167], v[184:187], a[72:75]
  ds_read_b128 a[132:135], v3 offset:9216
  buffer_load_dwordx4 v2, s[48:51], s27 offen offset:2048 sc1 lds
  v_add_f32 v227, v216, v217
  v_mfma_f32_16x16x32_bf16 a[76:79], a[164:167], v[188:191], a[76:79]
  v_exp_f32 v220, v140
  v_mfma_f32_16x16x32_bf16 a[80:83], a[168:171], v[184:187], a[80:83]
  ds_read_b128 a[136:139], v3 offset:10240
  v_cvt_pk_bf16_f32 v180, v216, v217
  v_mfma_f32_16x16x32_bf16 a[84:87], a[168:171], v[188:191], a[84:87]
  v_exp_f32 v221, v141
  v_mfma_f32_16x16x32_bf16 a[88:91], a[172:175], v[184:187], a[88:91]
  ds_read_b128 a[140:143], v3 offset:11264
  buffer_load_dwordx4 a[220:223], v2, s[40:43], s14 offen offset:3072 sc1
  v_add_f32 v227, v227, v218
  v_mfma_f32_16x16x32_bf16 a[92:95], a[172:175], v[188:191], a[92:95]
  s_waitcnt lgkmcnt(4)
  v_exp_f32 v222, v142
  v_mfma_f32_16x16x32_bf16 a[96:99], a[176:179], v[184:187], a[96:99]
  ds_read_b128 a[144:147], v3 offset:12288
  buffer_load_dwordx4 v2, s[48:51], s27 offen offset:3072 sc1 lds
  v_add_f32 v227, v227, v219
  v_cvt_pk_bf16_f32 v181, v218, v219
  v_mfma_f32_16x16x32_bf16 a[100:103], a[176:179], v[188:191], a[100:103]
  s_add_u32 s27, s27, 16384
  v_exp_f32 v223, v143
  v_mfma_f32_16x16x32_bf16 a[104:107], a[180:183], v[184:187], a[104:107]
  s_add_u32 s25, s25, 32768
  ds_read_b128 a[148:151], v3 offset:13312
  v_add_f32 v227, v227, v220
  v_mfma_f32_16x16x32_bf16 a[108:111], a[180:183], v[188:191], a[108:111]
  s_and_b32 s25, s25, 0x1ffff
  v_add_f32 v227, v227, v221
  v_cvt_pk_bf16_f32 v182, v220, v221
  v_add_f32 v227, v227, v222
  v_mfma_f32_16x16x32_bf16 a[112:115], a[184:187], v[184:187], a[112:115]
  ds_read_b128 a[152:155], v3 offset:14336
  v_add_f32 v227, v227, v223
  v_max_f32 v5, v226, v227
  v_cmp_lt_f32 vcc, s81, v5
  v_mfma_f32_16x16x32_bf16 a[116:119], a[184:187], v[188:191], a[116:119]
  v_exp_f32 v216, v144
  v_mfma_f32_16x16x32_bf16 a[120:123], a[188:191], v[184:187], a[120:123]
  s_waitcnt lgkmcnt(3)
  ds_read_b128 a[156:159], v3 offset:15360
  v_cvt_pk_bf16_f32 v183, v222, v223
  v_add_u32 v3, s66, v2
  v_mfma_f32_16x16x32_bf16 a[124:127], a[188:191], v[188:191], a[124:127]
  s_cbranch_vccnz fa_stub19
fa_back19:
  v_exp_f32 v217, v145
  v_add_f32 v230, v230, v226
  v_add_f32 v231, v231, v227
fa_SSW4:
  v_mfma_f32_16x16x32_bf16 v[128:131], a[128:131], v[64:67], v[200:203]
  s_waitcnt vmcnt(12)
  v_exp_f32 v218, v146
  v_mfma_f32_16x16x32_bf16 v[136:139], a[128:131], v[68:71], v[204:207]
  s_barrier
  v_exp_f32 v219, v147
  v_mfma_f32_16x16x32_bf16 v[132:135], a[132:135], v[64:67], v[200:203]
  ds_read_b128 a[160:163], v3 offset:16384
  ds_read_b128 a[164:167], v3 offset:17408
  v_add_f32 v226, v216, v217
  v_mfma_f32_16x16x32_bf16 v[140:143], a[132:135], v[68:71], v[204:207]
  s_mov_b32 m0, s24
  v_exp_f32 v220, v148
  v_mfma_f32_16x16x32_bf16 v[128:131], a[136:139], v[72:75], v[128:131]
  ds_read_b128 a[168:171], v3 offset:18432
  buffer_load_dwordx4 v2, s[44:47], s26 offen offset:0 sc1 lds
  v_cvt_pk_bf16_f32 v184, v216, v217
  v_mfma_f32_16x16x32_bf16 v[136:139], a[136:139], v[76:79], v[136:139]
  v_exp_f32 v221, v149
  v_mfma_f32_16x16x32_bf16 v[132:135], a[140:143], v[72:75], v[132:135]
  ds_read_b128 a[172:175], v3 offset:19456
  v_add_f32 v226, v226, v218
  v_add_f32 v226, v226, v219
  v_mfma_f32_16x16x32_bf16 v[140:143], a[140:143], v[76:79], v[140:143]
  s_waitcnt lgkmcnt(4)
  v_exp_f32 v222, v150
  v_mfma_f32_16x16x32_bf16 v[128:131], a[144:147], v[80:83], v[128:131]
  s_add_u32 s14, s13, 24576
  ds_read_b128 a[176:179], v3 offset:20480
  buffer_load_dwordx4 a[224:227], v2, s[40:43], s14 offen offset:0 sc1
  v_cvt_pk_bf16_f32 v185, v218, v219
  v_mfma_f32_16x16x32_bf16 v[136:139], a[144:147], v[84:87], v[136:139]
  v_exp_f32 v223, v151
  v_mfma_f32_16x16x32_bf16 v[132:135], a[148:151], v[80:83], v[132:135]
  ds_read_b128 a[180:183], v3 offset:21504
  buffer_load_dwordx4 v2, s[44:47], s26 offen offset:1024 sc1 lds
  v_add_f32 v226, v226, v220
  v_mfma_f32_16x16x32_bf16 v[140:143], a[148:151], v[84:87], v[140:143]
  v_exp_f32 v216, v152
  v_mfma_f32_16x16x32_bf16 v[128:131], a[152:155], v[88:91], v[128:131]
  ds_read_b128 a[184:187], v3 offset:22528
  v_add_f32 v226, v226, v221
  v_cvt_pk_bf16_f32 v186, v220, v221
  v_mfma_f32_16x16x32_bf16 v[136:139], a[152:155], v[92:95], v[136:139]
  v_exp_f32 v217, v153
  v_mfma_f32_16x16x32_bf16 v[132:135], a[156:159], v[88:91], v[132:135]
  ds_read_b128 a[188:191], v3 offset:23552
  buffer_load_dwordx4 a[228:231], v2, s[40:43], s14 offen offset:1024 sc1
  v_add_f32 v226, v226, v222
  v_mfma_f32_16x16x32_bf16 v[140:143], a[156:159], v[92:95], v[140:143]
  s_waitcnt lgkmcnt(4)
  v_exp_f32 v218, v154
  v_mfma_f32_16x16x32_bf16 a[64:67], a[160:163], v[176:179], a[64:67]
  ds_read_b128 a[128:131], v3 offset:0
  v_add_f32 v226, v226, v223
  v_cvt_pk_bf16_f32 v187, v222, v223
  v_mfma_f32_16x16x32_bf16 a[68:71], a[160:163], v[180:183], a[68:71]
  v_exp_f32 v219, v155
  v_mfma_f32_16x16x32_bf16 a[72:75], a[164:167], v[176:179], a[72:75]
  ds_read_b128 a[132:135], v3 offset:1024
  buffer_load_dwordx4 v2, s[44:47], s26 offen offset:2048 sc1 lds
  v_add_f32 v227, v216, v217
  v_mfma_f32_16x16x32_bf16 a[76:79], a[164:167], v[180:183], a[76:79]
  v_exp_f32 v220, v156
  v_mfma_f32_16x16x32_bf16 a[80:83], a[168:171], v[176:179], a[80:83]
  ds_read_b128 a[136:139], v3 offset:2048
  v_cvt_pk_bf16_f32 v188, v216, v217
  v_mfma_f32_16x16x32_bf16 a[84:87], a[168:171], v[180:183], a[84:87]
  v_exp_f32 v221, v157
  v_mfma_f32_16x16x32_bf16 a[88:91], a[172:175], v[176:179], a[88:91]
  ds_read_b128 a[140:143], v3 offset:3072
  buffer_load_dwordx4 a[232:235], v2, s[40:43], s14 offen offset:2048 sc1
  v_add_f32 v227, v227, v218
  v_add_f32 v227, v227, v219
  v_mfma_f32_16x16x32_bf16 a[92:95], a[172:175], v[180:183], a[92:95]
  s_waitcnt lgkmcnt(4)
  v_exp_f32 v222, v158
  v_mfma_f32_16x16x32_bf16 a[96:99], a[176:179], v[176:179], a[96:99]
  ds_read_b128 a[144:147], v3 offset:4096
  buffer_load_dwordx4 v2, s[44:47], s26 offen offset:3072 sc1 lds
  v_cvt_pk_bf16_f32 v189, v218, v219
  v_mfma_f32_16x16x32_bf16 a[100:103], a[176:179], v[180:183], a[100:103]
  s_add_u32 s26, s26, 16384
  v_exp_f32 v223, v159
  v_mfma_f32_16x16x32_bf16 a[104:107], a[180:183], v[176:179], a[104:107]
  s_add_u32 s24, s24, 32768
  ds_read_b128 a[148:151], v3 offset:5120
  v_add_f32 v227, v227, v220
  v_mfma_f32_16x16x32_bf16 a[108:111], a[180:183], v[180:183], a[108:111]
  s_and_b32 s24, s24, 0x1ffff
  v_add_f32 v227, v227, v221
  v_cvt_pk_bf16_f32 v190, v220, v221
  v_add_f32 v227, v227, v222
  v_mfma_f32_16x16x32_bf16 a[112:115], a[184:187], v[176:179], a[112:115]
  ds_read_b128 a[152:155], v3 offset:6144
  v_add_f32 v227, v227, v223
  v_max_f32 v5, v226, v227
  v_cmp_lt_f32 vcc, s81, v5
  v_mfma_f32_16x16x32_bf16 a[116:119], a[184:187], v[180:183], a[116:119]
  v_exp_f32 v216, v128
  v_mfma_f32_16x16x32_bf16 a[120:123], a[188:191], v[176:179], a[120:123]
  s_waitcnt lgkmcnt(3)
  ds_read_b128 a[156:159], v3 offset:7168
  v_cvt_pk_bf16_f32 v191, v222, v223
  v_mfma_f32_16x16x32_bf16 a[124:127], a[188:191], v[180:183], a[124:127]
  s_cbranch_vccnz fa_stub20
fa_back20:
  v_exp_f32 v217, v129
  v_add_f32 v230, v230, v226
  v_add_f32 v231, v231, v227
  v_mfma_f32_16x16x32_bf16 v[144:147], a[128:131], v[64:67], v[200:203]
  ds_read_b128 a[160:163], v3 offset:24576
  v_add_f32 v226, v216, v217
  v_mfma_f32_16x16x32_bf16 v[152:155], a[128:131], v[68:71], v[204:207]
  v_exp_f32 v218, v130
  v_mfma_f32_16x16x32_bf16 v[148:151], a[132:135], v[64:67], v[200:203]
  s_add_u32 s66, s66, 32768
  ds_read_b128 a[164:167], v3 offset:25600
  v_cvt_pk_bf16_f32 v176, v216, v217
  v_mfma_f32_16x16x32_bf16 v[156:159], a[132:135], v[68:71], v[204:207]
  s_mov_b32 m0, s25
  v_exp_f32 v219, v131
  v_mfma_f32_16x16x32_bf16 v[144:147], a[136:139], v[72:75], v[144:147]
  s_and_b32 s66, s66, 0x1ffff
  ds_read_b128 a[168:171], v3 offset:26624
  buffer_load_dwordx4 v2, s[48:51], s27 offen offset:0 sc1 lds
  v_add_f32 v226, v226, v218
  v_add_f32 v226, v226, v219
  v_mfma_f32_16x16x32_bf16 v[152:155], a[136:139], v[76:79], v[152:155]
  v_exp_f32 v220, v132
  v_mfma_f32_16x16x32_bf16 v[148:151], a[140:143], v[72:75], v[148:151]
  ds_read_b128 a[172:175], v3 offset:27648
  v_cvt_pk_bf16_f32 v177, v218, v219
  v_mfma_f32_16x16x32_bf16 v[156:159], a[140:143], v[76:79], v[156:159]
  s_waitcnt lgkmcnt(4)
  v_exp_f32 v221, v133
  v_mfma_f32_16x16x32_bf16 v[144:147], a[144:147], v[80:83], v[144:147]
  s_add_u32 s14, s13, 24576
  ds_read_b128 a[176:179], v3 offset:28672
  buffer_load_dwordx4 a[236:239], v2, s[40:43], s14 offen offset:3072 sc1
  v_add_f32 v226, v226, v220
  v_mfma_f32_16x16x32_bf16 v[152:155], a[144:147], v[84:87], v[152:155]
  v_exp_f32 v222, v134
  v_mfma_f32_16x16x32_bf16 v[148:151], a[148:151], v[80:83], v[148:151]
  ds_read_b128 a[180:183], v3 offset:29696
  buffer_load_dwordx4 v2, s[48:51], s27 offen offset:1024 sc1 lds
  v_add_f32 v226, v226, v221
  v_cvt_pk_bf16_f32 v178, v220, v221
  v_mfma_f32_16x16x32_bf16 v[156:159], a[148:151], v[84:87], v[156:159]
  v_exp_f32 v223, v135
  v_mfma_f32_16x16x32_bf16 v[144:147], a[152:155], v[88:91], v[144:147]
  ds_read_b128 a[184:187], v3 offset:30720
  v_add_f32 v226, v226, v222
  v_mfma_f32_16x16x32_bf16 v[152:155], a[152:155], v[92:95], v[152:155]
  v_exp_f32 v216, v136
  v_mfma_f32_16x16x32_bf16 v[148:151], a[156:159], v[88:91], v[148:151]
  s_add_u32 s14, s13, 28672
  ds_read_b128 a[188:191], v3 offset:31744
  buffer_load_dwordx4 a[240:243], v2, s[40:43], s14 offen offset:0 sc1
  v_add_f32 v226, v226, v223
  v_exp_f32 v217, v137
  v_mfma_f32_16x16x32_bf16 v[156:159], a[156:159], v[92:95], v[156:159]
  s_waitcnt lgkmcnt(4)
  v_exp_f32 v218, v138
  v_mfma_f32_16x16x32_bf16 a[64:67], a[160:163], v[184:187], a[64:67]
  ds_read_b128 a[128:131], v3 offset:8192
  v_cvt_pk_bf16_f32 v179, v222, v223
  v_mfma_f32_16x16x32_bf16 a[68:71], a[160:163], v[188:191], a[68:71]
  v_exp_f32 v219, v139
  v_mfma_f32_16x16x32_bf16 a[72:75], a[164:167], v[184:187], a[72:75]
  ds_read_b128 a[132:135], v3 offset:9216
  buffer_load_dwordx4 v2, s[48:51], s27 offen offset:2048 sc1 lds
  v_add_f32 v227, v216, v217
  v_mfma_f32_16x16x32_bf16 a[76:79], a[164:167], v[188:191], a[76:79]
  v_exp_f32 v220, v140
  v_mfma_f32_16x16x32_bf16 a[80:83], a[168:171], v[184:187], a[80:83]
  ds_read_b128 a[136:139], v3 offset:10240
  v_cvt_pk_bf16_f32 v180, v216, v217
  v_mfma_f32_16x16x32_bf16 a[84:87], a[168:171], v[188:191], a[84:87]
  v_exp_f32 v221, v141
  v_mfma_f32_16x16x32_bf16 a[88:91], a[172:175], v[184:187], a[88:91]
  ds_read_b128 a[140:143], v3 offset:11264
  buffer_load_dwordx4 a[244:247], v2, s[40:43], s14 offen offset:1024 sc1
  v_add_f32 v227, v227, v218
  v_mfma_f32_16x16x32_bf16 a[92:95], a[172:175], v[188:191], a[92:95]
  s_waitcnt lgkmcnt(4)
  v_exp_f32 v222, v142
  v_mfma_f32_16x16x32_bf16 a[96:99], a[176:179], v[184:187], a[96:99]
  ds_read_b128 a[144:147], v3 offset:12288
  buffer_load_dwordx4 v2, s[48:51], s27 offen offset:3072 sc1 lds
  v_add_f32 v227, v227, v219
  v_cvt_pk_bf16_f32 v181, v218, v219
  v_mfma_f32_16x16x32_bf16 a[100:103], a[176:179], v[188:191], a[100:103]
  s_add_u32 s27, s27, 16384
  v_exp_f32 v223, v143
  v_mfma_f32_16x16x32_bf16 a[104:107], a[180:183], v[184:187], a[104:107]
  s_add_u32 s25, s25, 32768
  ds_read_b128 a[148:151], v3 offset:13312
  v_add_f32 v227, v227, v220
  v_mfma_f32_16x16x32_bf16 a[108:111], a[180:183], v[188:191], a[108:111]
  s_and_b32 s25, s25, 0x1ffff
  v_add_f32 v227, v227, v221
  v_cvt_pk_bf16_f32 v182, v220, v221
  v_add_f32 v227, v227, v222
  v_mfma_f32_16x16x32_bf16 a[112:115], a[184:187], v[184:187], a[112:115]
  ds_read_b128 a[152:155], v3 offset:14336
  v_add_f32 v227, v227, v223
  v_max_f32 v5, v226, v227
  v_cmp_lt_f32 vcc, s81, v5
  v_mfma_f32_16x16x32_bf16 a[116:119], a[184:187], v[188:191], a[116:119]
  v_exp_f32 v216, v144
  v_mfma_f32_16x16x32_bf16 a[120:123], a[188:191], v[184:187], a[120:123]
  s_waitcnt lgkmcnt(3)
  ds_read_b128 a[156:159], v3 offset:15360
  v_cvt_pk_bf16_f32 v183, v222, v223
  v_add_u32 v3, s66, v2
  v_mfma_f32_16x16x32_bf16 a[124:127], a[188:191], v[188:191], a[124:127]
  s_cbranch_vccnz fa_stub21
fa_back21:
  v_exp_f32 v217, v145
  v_add_f32 v230, v230, v226
  v_add_f32 v231, v231, v227
fa_SSW3:
  v_mfma_f32_16x16x32_bf16 v[128:131], a[128:131], v[64:67], v[200:203]
  s_waitcnt vmcnt(12)
  v_exp_f32 v218, v146
  v_mfma_f32_16x16x32_bf16 v[136:139], a[128:131], v[68:71], v[204:207]
  s_barrier
  v_exp_f32 v219, v147
  v_mfma_f32_16x16x32_bf16 v[132:135], a[132:135], v[64:67], v[200:203]
  ds_read_b128 a[160:163], v3 offset:16384
  ds_read_b128 a[164:167], v3 offset:17408
  v_add_f32 v226, v216, v217
  v_mfma_f32_16x16x32_bf16 v[140:143], a[132:135], v[68:71], v[204:207]
  s_mov_b32 m0, s24
  v_exp_f32 v220, v148
  v_mfma_f32_16x16x32_bf16 v[128:131], a[136:139], v[72:75], v[128:131]
  ds_read_b128 a[168:171], v3 offset:18432
  buffer_load_dwordx4 v2, s[44:47], s26 offen offset:0 sc1 lds
  v_cvt_pk_bf16_f32 v184, v216, v217
  v_mfma_f32_16x16x32_bf16 v[136:139], a[136:139], v[76:79], v[136:139]
  v_exp_f32 v221, v149
  v_mfma_f32_16x16x32_bf16 v[132:135], a[140:143], v[72:75], v[132:135]
  ds_read_b128 a[172:175], v3 offset:19456
  v_add_f32 v226, v226, v218
  v_add_f32 v226, v226, v219
  v_mfma_f32_16x16x32_bf16 v[140:143], a[140:143], v[76:79], v[140:143]
  s_waitcnt lgkmcnt(4)
  v_exp_f32 v222, v150
  v_mfma_f32_16x16x32_bf16 v[128:131], a[144:147], v[80:83], v[128:131]
  s_add_u32 s14, s13, 28672
  ds_read_b128 a[176:179], v3 offset:20480
  buffer_load_dwordx4 a[248:251], v2, s[40:43], s14 offen offset:2048 sc1
  v_cvt_pk_bf16_f32 v185, v218, v219
  v_mfma_f32_16x16x32_bf16 v[136:139], a[144:147], v[84:87], v[136:139]
  v_exp_f32 v223, v151
  v_mfma_f32_16x16x32_bf16 v[132:135], a[148:151], v[80:83], v[132:135]
  ds_read_b128 a[180:183], v3 offset:21504
  buffer_load_dwordx4 v2, s[44:47], s26 offen offset:1024 sc1 lds
  v_add_f32 v226, v226, v220
  v_mfma_f32_16x16x32_bf16 v[140:143], a[148:151], v[84:87], v[140:143]
  v_exp_f32 v216, v152
  v_mfma_f32_16x16x32_bf16 v[128:131], a[152:155], v[88:91], v[128:131]
  ds_read_b128 a[184:187], v3 offset:22528
  v_add_f32 v226, v226, v221
  v_cvt_pk_bf16_f32 v186, v220, v221
  v_mfma_f32_16x16x32_bf16 v[136:139], a[152:155], v[92:95], v[136:139]
  v_exp_f32 v217, v153
  v_mfma_f32_16x16x32_bf16 v[132:135], a[156:159], v[88:91], v[132:135]
  ds_read_b128 a[188:191], v3 offset:23552
  buffer_load_dwordx4 a[252:255], v2, s[40:43], s14 offen offset:3072 sc1
  v_add_f32 v226, v226, v222
  v_mfma_f32_16x16x32_bf16 v[140:143], a[156:159], v[92:95], v[140:143]
  s_waitcnt lgkmcnt(4)
  v_exp_f32 v218, v154
  v_mfma_f32_16x16x32_bf16 a[64:67], a[160:163], v[176:179], a[64:67]
  ds_read_b128 a[128:131], v3 offset:0
  v_add_f32 v226, v226, v223
  v_cvt_pk_bf16_f32 v187, v222, v223
  v_mfma_f32_16x16x32_bf16 a[68:71], a[160:163], v[180:183], a[68:71]
  v_exp_f32 v219, v155
  v_mfma_f32_16x16x32_bf16 a[72:75], a[164:167], v[176:179], a[72:75]
  ds_read_b128 a[132:135], v3 offset:1024
  buffer_load_dwordx4 v2, s[44:47], s26 offen offset:2048 sc1 lds
  v_add_f32 v227, v216, v217
  v_mfma_f32_16x16x32_bf16 a[76:79], a[164:167], v[180:183], a[76:79]
  v_exp_f32 v220, v156
  v_mfma_f32_16x16x32_bf16 a[80:83], a[168:171], v[176:179], a[80:83]
  ds_read_b128 a[136:139], v3 offset:2048
  v_cvt_pk_bf16_f32 v188, v216, v217
  v_mfma_f32_16x16x32_bf16 a[84:87], a[168:171], v[180:183], a[84:87]
  v_exp_f32 v221, v157
  v_mfma_f32_16x16x32_bf16 a[88:91], a[172:175], v[176:179], a[88:91]
  s_add_u32 s14, s13, 32768
  ds_read_b128 a[140:143], v3 offset:3072
  buffer_load_dwordx4 v[32:35], v2, s[40:43], s14 offen offset:0 sc1
  v_add_f32 v227, v227, v218
  v_add_f32 v227, v227, v219
  v_mfma_f32_16x16x32_bf16 a[92:95], a[172:175], v[180:183], a[92:95]
  s_waitcnt lgkmcnt(4)
  v_exp_f32 v222, v158
  v_mfma_f32_16x16x32_bf16 a[96:99], a[176:179], v[176:179], a[96:99]
  ds_read_b128 a[144:147], v3 offset:4096
  buffer_load_dwordx4 v2, s[44:47], s26 offen offset:3072 sc1 lds
  v_cvt_pk_bf16_f32 v189, v218, v219
  v_mfma_f32_16x16x32_bf16 a[100:103], a[176:179], v[180:183], a[100:103]
  s_add_u32 s26, s26, 16384
  v_exp_f32 v223, v159
  v_mfma_f32_16x16x32_bf16 a[104:107], a[180:183], v[176:179], a[104:107]
  s_add_u32 s24, s24, 32768
  ds_read_b128 a[148:151], v3 offset:5120
  v_add_f32 v227, v227, v220
  v_mfma_f32_16x16x32_bf16 a[108:111], a[180:183], v[180:183], a[108:111]
  s_and_b32 s24, s24, 0x1ffff
  v_add_f32 v227, v227, v221
  v_cvt_pk_bf16_f32 v190, v220, v221
  v_add_f32 v227, v227, v222
  v_mfma_f32_16x16x32_bf16 a[112:115], a[184:187], v[176:179], a[112:115]
  ds_read_b128 a[152:155], v3 offset:6144
  v_add_f32 v227, v227, v223
  v_max_f32 v5, v226, v227
  v_cmp_lt_f32 vcc, s81, v5
  v_mfma_f32_16x16x32_bf16 a[116:119], a[184:187], v[180:183], a[116:119]
  v_exp_f32 v216, v128
  v_mfma_f32_16x16x32_bf16 a[120:123], a[188:191], v[176:179], a[120:123]
  s_waitcnt lgkmcnt(3)
  ds_read_b128 a[156:159], v3 offset:7168
  v_cvt_pk_bf16_f32 v191, v222, v223
  v_mfma_f32_16x16x32_bf16 a[124:127], a[188:191], v[180:183], a[124:127]
  s_cbranch_vccnz fa_stub22
fa_back22:
  v_exp_f32 v217, v129
  v_add_f32 v230, v230, v226
  v_add_f32 v231, v231, v227
  v_mfma_f32_16x16x32_bf16 v[144:147], a[128:131], v[64:67], v[200:203]
  ds_read_b128 a[160:163], v3 offset:24576
  v_add_f32 v226, v216, v217
  v_mfma_f32_16x16x32_bf16 v[152:155], a[128:131], v[68:71], v[204:207]
  v_exp_f32 v218, v130
  v_mfma_f32_16x16x32_bf16 v[148:151], a[132:135], v[64:67], v[200:203]
  s_add_u32 s66, s66, 32768
  ds_read_b128 a[164:167], v3 offset:25600
  v_cvt_pk_bf16_f32 v176, v216, v217
  v_mfma_f32_16x16x32_bf16 v[156:159], a[132:135], v[68:71], v[204:207]
  s_mov_b32 m0, s25
  v_exp_f32 v219, v131
  v_mfma_f32_16x16x32_bf16 v[144:147], a[136:139], v[72:75], v[144:147]
  s_and_b32 s66, s66, 0x1ffff
  ds_read_b128 a[168:171], v3 offset:26624
  buffer_load_dwordx4 v2, s[48:51], s27 offen offset:0 sc1 lds
  v_add_f32 v226, v226, v218
  v_add_f32 v226, v226, v219
  v_mfma_f32_16x16x32_bf16 v[152:155], a[136:139], v[76:79], v[152:155]
  v_exp_f32 v220, v132
  v_mfma_f32_16x16x32_bf16 v[148:151], a[140:143], v[72:75], v[148:151]
  ds_read_b128 a[172:175], v3 offset:27648
  v_cvt_pk_bf16_f32 v177, v218, v219
  v_mfma_f32_16x16x32_bf16 v[156:159], a[140:143], v[76:79], v[156:159]
  s_waitcnt lgkmcnt(4)
  v_exp_f32 v221, v133
  v_mfma_f32_16x16x32_bf16 v[144:147], a[144:147], v[80:83], v[144:147]
  s_add_u32 s14, s13, 32768
  ds_read_b128 a[176:179], v3 offset:28672
  buffer_load_dwordx4 v[36:39], v2, s[40:43], s14 offen offset:1024 sc1
  v_add_f32 v226, v226, v220
  v_mfma_f32_16x16x32_bf16 v[152:155], a[144:147], v[84:87], v[152:155]
  v_exp_f32 v222, v134
  v_mfma_f32_16x16x32_bf16 v[148:151], a[148:151], v[80:83], v[148:151]
  ds_read_b128 a[180:183], v3 offset:29696
  buffer_load_dwordx4 v2, s[48:51], s27 offen offset:1024 sc1 lds
  v_add_f32 v226, v226, v221
  v_cvt_pk_bf16_f32 v178, v220, v221
  v_mfma_f32_16x16x32_bf16 v[156:159], a[148:151], v[84:87], v[156:159]
  v_exp_f32 v223, v135
  v_mfma_f32_16x16x32_bf16 v[144:147], a[152:155], v[88:91], v[144:147]
  ds_read_b128 a[184:187], v3 offset:30720
  v_add_f32 v226, v226, v222
  v_mfma_f32_16x16x32_bf16 v[152:155], a[152:155], v[92:95], v[152:155]
  v_exp_f32 v216, v136
  v_mfma_f32_16x16x32_bf16 v[148:151], a[156:159], v[88:91], v[148:151]
  ds_read_b128 a[188:191], v3 offset:31744
  buffer_load_dwordx4 v[40:43], v2, s[40:43], s14 offen offset:2048 sc1
  v_add_f32 v226, v226, v223
  v_exp_f32 v217, v137
  v_mfma_f32_16x16x32_bf16 v[156:159], a[156:159], v[92:95], v[156:159]
  s_waitcnt lgkmcnt(4)
  v_exp_f32 v218, v138
  v_mfma_f32_16x16x32_bf16 a[64:67], a[160:163], v[184:187], a[64:67]
  ds_read_b128 a[128:131], v3 offset:8192
  v_cvt_pk_bf16_f32 v179, v222, v223
  v_mfma_f32_16x16x32_bf16 a[68:71], a[160:163], v[188:191], a[68:71]
  v_exp_f32 v219, v139
  v_mfma_f32_16x16x32_bf16 a[72:75], a[164:167], v[184:187], a[72:75]
  ds_read_b128 a[132:135], v3 offset:9216
  buffer_load_dwordx4 v2, s[48:51], s27 offen offset:2048 sc1 lds
  v_add_f32 v227, v216, v217
  v_mfma_f32_16x16x32_bf16 a[76:79], a[164:167], v[188:191], a[76:79]
  v_exp_f32 v220, v140
  v_mfma_f32_16x16x32_bf16 a[80:83], a[168:171], v[184:187], a[80:83]
  ds_read_b128 a[136:139], v3 offset:10240
  v_cvt_pk_bf16_f32 v180, v216, v217
  v_mfma_f32_16x16x32_bf16 a[84:87], a[168:171], v[188:191], a[84:87]
  v_exp_f32 v221, v141
  v_mfma_f32_16x16x32_bf16 a[88:91], a[172:175], v[184:187], a[88:91]
  ds_read_b128 a[140:143], v3 offset:11264
  buffer_load_dwordx4 v[44:47], v2, s[40:43], s14 offen offset:3072 sc1
  v_add_f32 v227, v227, v218
  v_mfma_f32_16x16x32_bf16 a[92:95], a[172:175], v[188:191], a[92:95]
  s_waitcnt lgkmcnt(4)
  v_exp_f32 v222, v142
  v_mfma_f32_16x16x32_bf16 a[96:99], a[176:179], v[184:187], a[96:99]
  ds_read_b128 a[144:147], v3 offset:12288
  buffer_load_dwordx4 v2, s[48:51], s27 offen offset:3072 sc1 lds
  v_add_f32 v227, v227, v219
  v_cvt_pk_bf16_f32 v181, v218, v219
  v_mfma_f32_16x16x32_bf16 a[100:103], a[176:179], v[188:191], a[100:103]
  s_add_u32 s27, s27, 16384
  v_exp_f32 v223, v143
  v_mfma_f32_16x16x32_bf16 a[104:107], a[180:183], v[184:187], a[104:107]
  s_add_u32 s25, s25, 32768
  ds_read_b128 a[148:151], v3 offset:13312
  v_add_f32 v227, v227, v220
  v_mfma_f32_16x16x32_bf16 a[108:111], a[180:183], v[188:191], a[108:111]
  s_and_b32 s25, s25, 0x1ffff
  v_add_f32 v227, v227, v221
  v_cvt_pk_bf16_f32 v182, v220, v221
  v_add_f32 v227, v227, v222
  v_mfma_f32_16x16x32_bf16 a[112:115], a[184:187], v[184:187], a[112:115]
  ds_read_b128 a[152:155], v3 offset:14336
  v_add_f32 v227, v227, v223
  v_max_f32 v5, v226, v227
  v_cmp_lt_f32 vcc, s81, v5
  v_mfma_f32_16x16x32_bf16 a[116:119], a[184:187], v[188:191], a[116:119]
  v_exp_f32 v216, v144
  v_mfma_f32_16x16x32_bf16 a[120:123], a[188:191], v[184:187], a[120:123]
  s_waitcnt lgkmcnt(3)
  ds_read_b128 a[156:159], v3 offset:15360
  v_cvt_pk_bf16_f32 v183, v222, v223
  v_add_u32 v3, s66, v2
  v_mfma_f32_16x16x32_bf16 a[124:127], a[188:191], v[188:191], a[124:127]
  s_cbranch_vccnz fa_stub23
fa_back23:
  v_exp_f32 v217, v145
  v_add_f32 v230, v230, v226
  v_add_f32 v231, v231, v227
fa_SSW2:
  v_mfma_f32_16x16x32_bf16 v[128:131], a[128:131], v[64:67], v[200:203]
  s_waitcnt vmcnt(12)
  v_exp_f32 v218, v146
  v_mfma_f32_16x16x32_bf16 v[136:139], a[128:131], v[68:71], v[204:207]
  s_barrier
  v_exp_f32 v219, v147
  v_mfma_f32_16x16x32_bf16 v[132:135], a[132:135], v[64:67], v[200:203]
  ds_read_b128 a[160:163], v3 offset:16384
  ds_read_b128 a[164:167], v3 offset:17408
  v_add_f32 v226, v216, v217
  v_mfma_f32_16x16x32_bf16 v[140:143], a[132:135], v[68:71], v[204:207]
  s_mov_b32 m0, s24
  v_exp_f32 v220, v148
  v_mfma_f32_16x16x32_bf16 v[128:131], a[136:139], v[72:75], v[128:131]
  ds_read_b128 a[168:171], v3 offset:18432
  buffer_load_dwordx4 v2, s[44:47], s26 offen offset:0 sc1 lds
  v_cvt_pk_bf16_f32 v184, v216, v217
  v_mfma_f32_16x16x32_bf16 v[136:139], a[136:139], v[76:79], v[136:139]
  v_exp_f32 v221, v149
  v_mfma_f32_16x16x32_bf16 v[132:135], a[140:143], v[72:75], v[132:135]
  ds_read_b128 a[172:175], v3 offset:19456
  v_add_f32 v226, v226, v218
  v_add_f32 v226, v226, v219
  v_mfma_f32_16x16x32_bf16 v[140:143], a[140:143], v[76:79], v[140:143]
  s_waitcnt lgkmcnt(4)
  v_exp_f32 v222, v150
  v_mfma_f32_16x16x32_bf16 v[128:131], a[144:147], v[80:83], v[128:131]
  s_add_u32 s14, s13, 36864
  ds_read_b128 a[176:179], v3 offset:20480
  buffer_load_dwordx4 v[48:51], v2, s[40:43], s14 offen offset:0 sc1
  v_cvt_pk_bf16_f32 v185, v218, v219
  v_mfma_f32_16x16x32_bf16 v[136:139], a[144:147], v[84:87], v[136:139]
  v_exp_f32 v223, v151
  v_mfma_f32_16x16x32_bf16 v[132:135], a[148:151], v[80:83], v[132:135]
  ds_read_b128 a[180:183], v3 offset:21504
  buffer_load_dwordx4 v2, s[44:47], s26 offen offset:1024 sc1 lds
  v_add_f32 v226, v226, v220
  v_mfma_f32_16x16x32_bf16 v[140:143], a[148:151], v[84:87], v[140:143]
  v_exp_f32 v216, v152
  v_mfma_f32_16x16x32_bf16 v[128:131], a[152:155], v[88:91], v[128:131]
  ds_read_b128 a[184:187], v3 offset:22528
  v_add_f32 v226, v226, v221
  v_cvt_pk_bf16_f32 v186, v220, v221
  v_mfma_f32_16x16x32_bf16 v[136:139], a[152:155], v[92:95], v[136:139]
  v_exp_f32 v217, v153
  v_mfma_f32_16x16x32_bf16 v[132:135], a[156:159], v[88:91], v[132:135]
  ds_read_b128 a[188:191], v3 offset:23552
  buffer_load_dwordx4 v[52:55], v2, s[40:43], s14 offen offset:1024 sc1
  v_add_f32 v226, v226, v222
  v_mfma_f32_16x16x32_bf16 v[140:143], a[156:159], v[92:95], v[140:143]
  s_waitcnt lgkmcnt(4)
  v_exp_f32 v218, v154
  v_mfma_f32_16x16x32_bf16 a[64:67], a[160:163], v[176:179], a[64:67]
  ds_read_b128 a[128:131], v3 offset:0
  v_add_f32 v226, v226, v223
  v_cvt_pk_bf16_f32 v187, v222, v223
  v_mfma_f32_16x16x32_bf16 a[68:71], a[160:163], v[180:183], a[68:71]
  v_exp_f32 v219, v155
  v_mfma_f32_16x16x32_bf16 a[72:75], a[164:167], v[176:179], a[72:75]
  ds_read_b128 a[132:135], v3 offset:1024
  buffer_load_dwordx4 v2, s[44:47], s26 offen offset:2048 sc1 lds
  v_add_f32 v227, v216, v217
  v_mfma_f32_16x16x32_bf16 a[76:79], a[164:167], v[180:183], a[76:79]
  v_exp_f32 v220, v156
  v_mfma_f32_16x16x32_bf16 a[80:83], a[168:171], v[176:179], a[80:83]
  ds_read_b128 a[136:139], v3 offset:2048
  v_cvt_pk_bf16_f32 v188, v216, v217
  v_mfma_f32_16x16x32_bf16 a[84:87], a[168:171], v[180:183], a[84:87]
  v_exp_f32 v221, v157
  v_mfma_f32_16x16x32_bf16 a[88:91], a[172:175], v[176:179], a[88:91]
  ds_read_b128 a[140:143], v3 offset:3072
  buffer_load_dwordx4 v[56:59], v2, s[40:43], s14 offen offset:2048 sc1
  v_add_f32 v227, v227, v218
  v_add_f32 v227, v227, v219
  v_mfma_f32_16x16x32_bf16 a[92:95], a[172:175], v[180:183], a[92:95]
  s_waitcnt lgkmcnt(4)
  v_exp_f32 v222, v158
  v_mfma_f32_16x16x32_bf16 a[96:99], a[176:179], v[176:179], a[96:99]
  ds_read_b128 a[144:147], v3 offset:4096
  buffer_load_dwordx4 v2, s[44:47], s26 offen offset:3072 sc1 lds
  v_cvt_pk_bf16_f32 v189, v218, v219
  v_mfma_f32_16x16x32_bf16 a[100:103], a[176:179], v[180:183], a[100:103]
  s_add_u32 s26, s26, 16384
  v_exp_f32 v223, v159
  v_mfma_f32_16x16x32_bf16 a[104:107], a[180:183], v[176:179], a[104:107]
  s_add_u32 s24, s24, 32768
  ds_read_b128 a[148:151], v3 offset:5120
  v_add_f32 v227, v227, v220
  v_mfma_f32_16x16x32_bf16 a[108:111], a[180:183], v[180:183], a[108:111]
  s_and_b32 s24, s24, 0x1ffff
  v_add_f32 v227, v227, v221
  v_cvt_pk_bf16_f32 v190, v220, v221
  v_add_f32 v227, v227, v222
  v_mfma_f32_16x16x32_bf16 a[112:115], a[184:187], v[176:179], a[112:115]
  ds_read_b128 a[152:155], v3 offset:6144
  v_add_f32 v227, v227, v223
  v_max_f32 v5, v226, v227
  v_cmp_lt_f32 vcc, s81, v5
  v_mfma_f32_16x16x32_bf16 a[116:119], a[184:187], v[180:183], a[116:119]
  v_exp_f32 v216, v128
  v_mfma_f32_16x16x32_bf16 a[120:123], a[188:191], v[176:179], a[120:123]
  s_waitcnt lgkmcnt(3)
  ds_read_b128 a[156:159], v3 offset:7168
  v_cvt_pk_bf16_f32 v191, v222, v223
  v_mfma_f32_16x16x32_bf16 a[124:127], a[188:191], v[180:183], a[124:127]
  s_cbranch_vccnz fa_stub24
fa_back24:
  v_exp_f32 v217, v129
  v_add_f32 v230, v230, v226
  v_add_f32 v231, v231, v227
  v_mfma_f32_16x16x32_bf16 v[144:147], a[128:131], v[64:67], v[200:203]
  ds_read_b128 a[160:163], v3 offset:24576
  v_add_f32 v226, v216, v217
  v_mfma_f32_16x16x32_bf16 v[152:155], a[128:131], v[68:71], v[204:207]
  v_exp_f32 v218, v130
  v_mfma_f32_16x16x32_bf16 v[148:151], a[132:135], v[64:67], v[200:203]
  s_add_u32 s66, s66, 32768
  ds_read_b128 a[164:167], v3 offset:25600
  v_cvt_pk_bf16_f32 v176, v216, v217
  v_mfma_f32_16x16x32_bf16 v[156:159], a[132:135], v[68:71], v[204:207]
  s_mov_b32 m0, s25
  v_exp_f32 v219, v131
  v_mfma_f32_16x16x32_bf16 v[144:147], a[136:139], v[72:75], v[144:147]
  s_and_b32 s66, s66, 0x1ffff
  ds_read_b128 a[168:171], v3 offset:26624
  buffer_load_dwordx4 v2, s[48:51], s27 offen offset:0 sc1 lds
  v_add_f32 v226, v226, v218
  v_add_f32 v226, v226, v219
  v_mfma_f32_16x16x32_bf16 v[152:155], a[136:139], v[76:79], v[152:155]
  v_exp_f32 v220, v132
  v_mfma_f32_16x16x32_bf16 v[148:151], a[140:143], v[72:75], v[148:151]
  ds_read_b128 a[172:175], v3 offset:27648
  v_cvt_pk_bf16_f32 v177, v218, v219
  v_mfma_f32_16x16x32_bf16 v[156:159], a[140:143], v[76:79], v[156:159]
  s_waitcnt lgkmcnt(4)
  v_exp_f32 v221, v133
  v_mfma_f32_16x16x32_bf16 v[144:147], a[144:147], v[80:83], v[144:147]
  s_add_u32 s14, s13, 36864
  ds_read_b128 a[176:179], v3 offset:28672
  buffer_load_dwordx4 v[60:63], v2, s[40:43], s14 offen offset:3072 sc1
  v_add_f32 v226, v226, v220
  v_mfma_f32_16x16x32_bf16 v[152:155], a[144:147], v[84:87], v[152:155]
  v_exp_f32 v222, v134
  v_mfma_f32_16x16x32_bf16 v[148:151], a[148:151], v[80:83], v[148:151]
  ds_read_b128 a[180:183], v3 offset:29696
  buffer_load_dwordx4 v2, s[48:51], s27 offen offset:1024 sc1 lds
  v_add_f32 v226, v226, v221
  v_cvt_pk_bf16_f32 v178, v220, v221
  v_mfma_f32_16x16x32_bf16 v[156:159], a[148:151], v[84:87], v[156:159]
  v_exp_f32 v223, v135
  v_mfma_f32_16x16x32_bf16 v[144:147], a[152:155], v[88:91], v[144:147]
  ds_read_b128 a[184:187], v3 offset:30720
  v_add_f32 v226, v226, v222
  v_mfma_f32_16x16x32_bf16 v[152:155], a[152:155], v[92:95], v[152:155]
  v_exp_f32 v216, v136
  v_mfma_f32_16x16x32_bf16 v[148:151], a[156:159], v[88:91], v[148:151]
  s_add_u32 s14, s13, 40960
  ds_read_b128 a[188:191], v3 offset:31744
  buffer_load_dwordx4 v[96:99], v2, s[40:43], s14 offen offset:0 sc1
  v_add_f32 v226, v226, v223
  v_exp_f32 v217, v137
  v_mfma_f32_16x16x32_bf16 v[156:159], a[156:159], v[92:95], v[156:159]
  s_waitcnt lgkmcnt(4)
  v_exp_f32 v218, v138
  v_mfma_f32_16x16x32_bf16 a[64:67], a[160:163], v[184:187], a[64:67]
  ds_read_b128 a[128:131], v3 offset:8192
  v_cvt_pk_bf16_f32 v179, v222, v223
  v_mfma_f32_16x16x32_bf16 a[68:71], a[160:163], v[188:191], a[68:71]
  v_exp_f32 v219, v139
  v_mfma_f32_16x16x32_bf16 a[72:75], a[164:167], v[184:187], a[72:75]
  ds_read_b128 a[132:135], v3 offset:9216
  buffer_load_dwordx4 v2, s[48:51], s27 offen offset:2048 sc1 lds
  v_add_f32 v227, v216, v217
  v_mfma_f32_16x16x32_bf16 a[76:79], a[164:167], v[188:191], a[76:79]
  v_exp_f32 v220, v140
  v_mfma_f32_16x16x32_bf16 a[80:83], a[168:171], v[184:187], a[80:83]
  ds_read_b128 a[136:139], v3 offset:10240
  v_cvt_pk_bf16_f32 v180, v216, v217
  v_mfma_f32_16x16x32_bf16 a[84:87], a[168:171], v[188:191], a[84:87]
  v_exp_f32 v221, v141
  v_mfma_f32_16x16x32_bf16 a[88:91], a[172:175], v[184:187], a[88:91]
  ds_read_b128 a[140:143], v3 offset:11264
  buffer_load_dwordx4 v[100:103], v2, s[40:43], s14 offen offset:1024 sc1
  v_add_f32 v227, v227, v218
  v_mfma_f32_16x16x32_bf16 a[92:95], a[172:175], v[188:191], a[92:95]
  s_waitcnt lgkmcnt(4)
  v_exp_f32 v222, v142
  v_mfma_f32_16x16x32_bf16 a[96:99], a[176:179], v[184:187], a[96:99]
  ds_read_b128 a[144:147], v3 offset:12288
  buffer_load_dwordx4 v2, s[48:51], s27 offen offset:3072 sc1 lds
  v_add_f32 v227, v227, v219
  v_cvt_pk_bf16_f32 v181, v218, v219
  v_mfma_f32_16x16x32_bf16 a[100:103], a[176:179], v[188:191], a[100:103]
  s_add_u32 s27, s27, 16384
  v_exp_f32 v223, v143
  v_mfma_f32_16x16x32_bf16 a[104:107], a[180:183], v[184:187], a[104:107]
  s_add_u32 s25, s25, 32768
  ds_read_b128 a[148:151], v3 offset:13312
  v_add_f32 v227, v227, v220
  v_mfma_f32_16x16x32_bf16 a[108:111], a[180:183], v[188:191], a[108:111]
  s_and_b32 s25, s25, 0x1ffff
  v_add_f32 v227, v227, v221
  v_cvt_pk_bf16_f32 v182, v220, v221
  v_add_f32 v227, v227, v222
  v_mfma_f32_16x16x32_bf16 a[112:115], a[184:187], v[184:187], a[112:115]
  ds_read_b128 a[152:155], v3 offset:14336
  v_add_f32 v227, v227, v223
  v_max_f32 v5, v226, v227
  v_cmp_lt_f32 vcc, s81, v5
  v_mfma_f32_16x16x32_bf16 a[116:119], a[184:187], v[188:191], a[116:119]
  v_exp_f32 v216, v144
  v_mfma_f32_16x16x32_bf16 a[120:123], a[188:191], v[184:187], a[120:123]
  s_waitcnt lgkmcnt(3)
  ds_read_b128 a[156:159], v3 offset:15360
  v_cvt_pk_bf16_f32 v183, v222, v223
  v_add_u32 v3, s66, v2
  v_mfma_f32_16x16x32_bf16 a[124:127], a[188:191], v[188:191], a[124:127]
  s_cbranch_vccnz fa_stub25
fa_back25:
  v_exp_f32 v217, v145
  v_add_f32 v230, v230, v226
  v_add_f32 v231, v231, v227
fa_SSW1:
  v_mfma_f32_16x16x32_bf16 v[128:131], a[128:131], v[64:67], v[200:203]
  s_waitcnt vmcnt(12)
  v_exp_f32 v218, v146
  v_mfma_f32_16x16x32_bf16 v[136:139], a[128:131], v[68:71], v[204:207]
  s_barrier
  v_exp_f32 v219, v147
  v_mfma_f32_16x16x32_bf16 v[132:135], a[132:135], v[64:67], v[200:203]
  ds_read_b128 a[160:163], v3 offset:16384
  ds_read_b128 a[164:167], v3 offset:17408
  v_add_f32 v226, v216, v217
  v_mfma_f32_16x16x32_bf16 v[140:143], a[132:135], v[68:71], v[204:207]
  s_mov_b32 m0, s24
  v_exp_f32 v220, v148
  v_mfma_f32_16x16x32_bf16 v[128:131], a[136:139], v[72:75], v[128:131]
  ds_read_b128 a[168:171], v3 offset:18432
  buffer_load_dwordx4 v2, s[44:47], s26 offen offset:0 sc1 lds
  v_cvt_pk_bf16_f32 v184, v216, v217
  v_mfma_f32_16x16x32_bf16 v[136:139], a[136:139], v[76:79], v[136:139]
  v_exp_f32 v221, v149
  v_mfma_f32_16x16x32_bf16 v[132:135], a[140:143], v[72:75], v[132:135]
  ds_read_b128 a[172:175], v3 offset:19456
  v_add_f32 v226, v226, v218
  v_add_f32 v226, v226, v219
  v_mfma_f32_16x16x32_bf16 v[140:143], a[140:143], v[76:79], v[140:143]
  s_waitcnt lgkmcnt(4)
  v_exp_f32 v222, v150
  v_mfma_f32_16x16x32_bf16 v[128:131], a[144:147], v[80:83], v[128:131]
  s_add_u32 s14, s13, 40960
  ds_read_b128 a[176:179], v3 offset:20480
  buffer_load_dwordx4 v[104:107], v2, s[40:43], s14 offen offset:2048 sc1
  v_cvt_pk_bf16_f32 v185, v218, v219
  v_mfma_f32_16x16x32_bf16 v[136:139], a[144:147], v[84:87], v[136:139]
  v_exp_f32 v223, v151
  v_mfma_f32_16x16x32_bf16 v[132:135], a[148:151], v[80:83], v[132:135]
  ds_read_b128 a[180:183], v3 offset:21504
  buffer_load_dwordx4 v2, s[44:47], s26 offen offset:1024 sc1 lds
  v_add_f32 v226, v226, v220
  v_mfma_f32_16x16x32_bf16 v[140:143], a[148:151], v[84:87], v[140:143]
  v_exp_f32 v216, v152
  v_mfma_f32_16x16x32_bf16 v[128:131], a[152:155], v[88:91], v[128:131]
  ds_read_b128 a[184:187], v3 offset:22528
  v_add_f32 v226, v226, v221
  v_cvt_pk_bf16_f32 v186, v220, v221
  v_mfma_f32_16x16x32_bf16 v[136:139], a[152:155], v[92:95], v[136:139]
  v_exp_f32 v217, v153
  v_mfma_f32_16x16x32_bf16 v[132:135], a[156:159], v[88:91], v[132:135]
  ds_read_b128 a[188:191], v3 offset:23552
  buffer_load_dwordx4 v[108:111], v2, s[40:43], s14 offen offset:3072 sc1
  v_add_f32 v226, v226, v222
  v_mfma_f32_16x16x32_bf16 v[140:143], a[156:159], v[92:95], v[140:143]
  s_waitcnt lgkmcnt(4)
  v_exp_f32 v218, v154
  v_mfma_f32_16x16x32_bf16 a[64:67], a[160:163], v[176:179], a[64:67]
  ds_read_b128 a[128:131], v3 offset:0
  v_add_f32 v226, v226, v223
  v_cvt_pk_bf16_f32 v187, v222, v223
  v_mfma_f32_16x16x32_bf16 a[68:71], a[160:163], v[180:183], a[68:71]
  v_exp_f32 v219, v155
  v_mfma_f32_16x16x32_bf16 a[72:75], a[164:167], v[176:179], a[72:75]
  ds_read_b128 a[132:135], v3 offset:1024
  buffer_load_dwordx4 v2, s[44:47], s26 offen offset:2048 sc1 lds
  v_add_f32 v227, v216, v217
  v_mfma_f32_16x16x32_bf16 a[76:79], a[164:167], v[180:183], a[76:79]
  v_exp_f32 v220, v156
  v_mfma_f32_16x16x32_bf16 a[80:83], a[168:171], v[176:179], a[80:83]
  ds_read_b128 a[136:139], v3 offset:2048
  v_cvt_pk_bf16_f32 v188, v216, v217
  v_mfma_f32_16x16x32_bf16 a[84:87], a[168:171], v[180:183], a[84:87]
  v_exp_f32 v221, v157
  v_mfma_f32_16x16x32_bf16 a[88:91], a[172:175], v[176:179], a[88:91]
  s_add_u32 s14, s13, 45056
  ds_read_b128 a[140:143], v3 offset:3072
  buffer_load_dwordx4 v[112:115], v2, s[40:43], s14 offen offset:0 sc1
  v_add_f32 v227, v227, v218
  v_add_f32 v227, v227, v219
  v_mfma_f32_16x16x32_bf16 a[92:95], a[172:175], v[180:183], a[92:95]
  s_waitcnt lgkmcnt(4)
  v_exp_f32 v222, v158
  v_mfma_f32_16x16x32_bf16 a[96:99], a[176:179], v[176:179], a[96:99]
  ds_read_b128 a[144:147], v3 offset:4096
  buffer_load_dwordx4 v2, s[44:47], s26 offen offset:3072 sc1 lds
  v_cvt_pk_bf16_f32 v189, v218, v219
  v_mfma_f32_16x16x32_bf16 a[100:103], a[176:179], v[180:183], a[100:103]
  s_add_u32 s26, s26, 16384
  v_exp_f32 v223, v159
  v_mfma_f32_16x16x32_bf16 a[104:107], a[180:183], v[176:179], a[104:107]
  s_add_u32 s24, s24, 32768
  ds_read_b128 a[148:151], v3 offset:5120
  v_add_f32 v227, v227, v220
  v_mfma_f32_16x16x32_bf16 a[108:111], a[180:183], v[180:183], a[108:111]
  s_and_b32 s24, s24, 0x1ffff
  v_add_f32 v227, v227, v221
  v_cvt_pk_bf16_f32 v190, v220, v221
  v_add_f32 v227, v227, v222
  v_mfma_f32_16x16x32_bf16 a[112:115], a[184:187], v[176:179], a[112:115]
  ds_read_b128 a[152:155], v3 offset:6144
  v_add_f32 v227, v227, v223
  v_max_f32 v5, v226, v227
  v_cmp_lt_f32 vcc, s81, v5
  v_mfma_f32_16x16x32_bf16 a[116:119], a[184:187], v[180:183], a[116:119]
  v_exp_f32 v216, v128
  v_mfma_f32_16x16x32_bf16 a[120:123], a[188:191], v[176:179], a[120:123]
  s_waitcnt lgkmcnt(3)
  ds_read_b128 a[156:159], v3 offset:7168
  v_cvt_pk_bf16_f32 v191, v222, v223
  v_mfma_f32_16x16x32_bf16 a[124:127], a[188:191], v[180:183], a[124:127]
  s_cbranch_vccnz fa_stub26
fa_back26:
  v_exp_f32 v217, v129
  v_add_f32 v230, v230, v226
  v_add_f32 v231, v231, v227
  v_mfma_f32_16x16x32_bf16 v[144:147], a[128:131], v[64:67], v[200:203]
  ds_read_b128 a[160:163], v3 offset:24576
  v_add_f32 v226, v216, v217
  v_mfma_f32_16x16x32_bf16 v[152:155], a[128:131], v[68:71], v[204:207]
  v_exp_f32 v218, v130
  v_mfma_f32_16x16x32_bf16 v[148:151], a[132:135], v[64:67], v[200:203]
  s_add_u32 s66, s66, 32768
  ds_read_b128 a[164:167], v3 offset:25600
  v_cvt_pk_bf16_f32 v176, v216, v217
  v_mfma_f32_16x16x32_bf16 v[156:159], a[132:135], v[68:71], v[204:207]
  s_mov_b32 m0, s25
  v_exp_f32 v219, v131
  v_mfma_f32_16x16x32_bf16 v[144:147], a[136:139], v[72:75], v[144:147]
  s_and_b32 s66, s66, 0x1ffff
  ds_read_b128 a[168:171], v3 offset:26624
  buffer_load_dwordx4 v2, s[48:51], s27 offen offset:0 sc1 lds
  v_add_f32 v226, v226, v218
  v_add_f32 v226, v226, v219
  v_mfma_f32_16x16x32_bf16 v[152:155], a[136:139], v[76:79], v[152:155]
  v_exp_f32 v220, v132
  v_mfma_f32_16x16x32_bf16 v[148:151], a[140:143], v[72:75], v[148:151]
  ds_read_b128 a[172:175], v3 offset:27648
  v_cvt_pk_bf16_f32 v177, v218, v219
  v_mfma_f32_16x16x32_bf16 v[156:159], a[140:143], v[76:79], v[156:159]
  s_waitcnt lgkmcnt(4)
  v_exp_f32 v221, v133
  v_mfma_f32_16x16x32_bf16 v[144:147], a[144:147], v[80:83], v[144:147]
  s_add_u32 s14, s13, 45056
  ds_read_b128 a[176:179], v3 offset:28672
  buffer_load_dwordx4 v[116:119], v2, s[40:43], s14 offen offset:1024 sc1
  v_add_f32 v226, v226, v220
  v_mfma_f32_16x16x32_bf16 v[152:155], a[144:147], v[84:87], v[152:155]
  v_exp_f32 v222, v134
  v_mfma_f32_16x16x32_bf16 v[148:151], a[148:151], v[80:83], v[148:151]
  ds_read_b128 a[180:183], v3 offset:29696
  buffer_load_dwordx4 v2, s[48:51], s27 offen offset:1024 sc1 lds
  v_add_f32 v226, v226, v221
  v_cvt_pk_bf16_f32 v178, v220, v221
  v_mfma_f32_16x16x32_bf16 v[156:159], a[148:151], v[84:87], v[156:159]
  v_exp_f32 v223, v135
  v_mfma_f32_16x16x32_bf16 v[144:147], a[152:155], v[88:91], v[144:147]
  ds_read_b128 a[184:187], v3 offset:30720
  v_add_f32 v226, v226, v222
  v_mfma_f32_16x16x32_bf16 v[152:155], a[152:155], v[92:95], v[152:155]
  v_exp_f32 v216, v136
  v_mfma_f32_16x16x32_bf16 v[148:151], a[156:159], v[88:91], v[148:151]
  ds_read_b128 a[188:191], v3 offset:31744
  buffer_load_dwordx4 v[120:123], v2, s[40:43], s14 offen offset:2048 sc1
  v_add_f32 v226, v226, v223
  v_exp_f32 v217, v137
  v_mfma_f32_16x16x32_bf16 v[156:159], a[156:159], v[92:95], v[156:159]
  s_waitcnt lgkmcnt(4)
  v_exp_f32 v218, v138
  v_mfma_f32_16x16x32_bf16 a[64:67], a[160:163], v[184:187], a[64:67]
  ds_read_b128 a[128:131], v3 offset:8192
  v_cvt_pk_bf16_f32 v179, v222, v223
  v_mfma_f32_16x16x32_bf16 a[68:71], a[160:163], v[188:191], a[68:71]
  v_exp_f32 v219, v139
  v_mfma_f32_16x16x32_bf16 a[72:75], a[164:167], v[184:187], a[72:75]
  ds_read_b128 a[132:135], v3 offset:9216
  buffer_load_dwordx4 v2, s[48:51], s27 offen offset:2048 sc1 lds
  v_add_f32 v227, v216, v217
  v_mfma_f32_16x16x32_bf16 a[76:79], a[164:167], v[188:191], a[76:79]
  v_exp_f32 v220, v140
  v_mfma_f32_16x16x32_bf16 a[80:83], a[168:171], v[184:187], a[80:83]
  ds_read_b128 a[136:139], v3 offset:10240
  v_cvt_pk_bf16_f32 v180, v216, v217
  v_mfma_f32_16x16x32_bf16 a[84:87], a[168:171], v[188:191], a[84:87]
  v_exp_f32 v221, v141
  v_mfma_f32_16x16x32_bf16 a[88:91], a[172:175], v[184:187], a[88:91]
  ds_read_b128 a[140:143], v3 offset:11264
  buffer_load_dwordx4 v[124:127], v2, s[40:43], s14 offen offset:3072 sc1
  v_add_f32 v227, v227, v218
  v_mfma_f32_16x16x32_bf16 a[92:95], a[172:175], v[188:191], a[92:95]
  s_waitcnt lgkmcnt(4)
  v_exp_f32 v222, v142
  v_mfma_f32_16x16x32_bf16 a[96:99], a[176:179], v[184:187], a[96:99]
  ds_read_b128 a[144:147], v3 offset:12288
  buffer_load_dwordx4 v2, s[48:51], s27 offen offset:3072 sc1 lds
  v_add_f32 v227, v227, v219
  v_cvt_pk_bf16_f32 v181, v218, v219
  v_mfma_f32_16x16x32_bf16 a[100:103], a[176:179], v[188:191], a[100:103]
  s_add_u32 s27, s27, 16384
  v_exp_f32 v223, v143
  v_mfma_f32_16x16x32_bf16 a[104:107], a[180:183], v[184:187], a[104:107]
  s_add_u32 s25, s25, 32768
  ds_read_b128 a[148:151], v3 offset:13312
  v_add_f32 v227, v227, v220
  v_mfma_f32_16x16x32_bf16 a[108:111], a[180:183], v[188:191], a[108:111]
  s_and_b32 s25, s25, 0x1ffff
  v_add_f32 v227, v227, v221
  v_cvt_pk_bf16_f32 v182, v220, v221
  v_add_f32 v227, v227, v222
  v_mfma_f32_16x16x32_bf16 a[112:115], a[184:187], v[184:187], a[112:115]
  ds_read_b128 a[152:155], v3 offset:14336
  v_add_f32 v227, v227, v223
  v_max_f32 v5, v226, v227
  v_cmp_lt_f32 vcc, s81, v5
  v_mfma_f32_16x16x32_bf16 a[116:119], a[184:187], v[188:191], a[116:119]
  v_exp_f32 v216, v144
  v_mfma_f32_16x16x32_bf16 a[120:123], a[188:191], v[184:187], a[120:123]
  s_waitcnt lgkmcnt(3)
  ds_read_b128 a[156:159], v3 offset:15360
  v_cvt_pk_bf16_f32 v183, v222, v223
  v_add_u32 v3, s66, v2
  v_mfma_f32_16x16x32_bf16 a[124:127], a[188:191], v[188:191], a[124:127]
  s_cbranch_vccnz fa_stub27
fa_back27:
  v_exp_f32 v217, v145
  v_add_f32 v230, v230, v226
  v_add_f32 v231, v231, v227
fa_Bexit:
  s_bitcmp1_b32 s20, 0
  s_cbranch_scc1 fa_Bodd
  v_mfma_f32_16x16x32_bf16 v[128:131], a[128:131], v[64:67], v[200:203]
  s_waitcnt vmcnt(0)
  v_exp_f32 v218, v146
  v_mfma_f32_16x16x32_bf16 v[136:139], a[128:131], v[68:71], v[204:207]
  s_barrier
  v_exp_f32 v219, v147
  v_mfma_f32_16x16x32_bf16 v[132:135], a[132:135], v[64:67], v[200:203]
  ds_read_b128 a[160:163], v3 offset:16384
  ds_read_b128 a[164:167], v3 offset:17408
  v_add_f32 v226, v216, v217
  v_mfma_f32_16x16x32_bf16 v[140:143], a[132:135], v[68:71], v[204:207]
  s_add_u32 s14, s13, 49152
  buffer_load_dwordx4 v[160:163], v2, s[40:43], s14 offen offset:0 sc1
  v_cvt_pk_bf16_f32 v184, v216, v217
  v_mfma_f32_16x16x32_bf16 v[128:131], a[136:139], v[72:75], v[128:131]
  ds_read_b128 a[168:171], v3 offset:18432
  v_add_f32 v226, v226, v218
  v_mfma_f32_16x16x32_bf16 v[136:139], a[136:139], v[76:79], v[136:139]
  v_exp_f32 v220, v148
  v_mfma_f32_16x16x32_bf16 v[132:135], a[140:143], v[72:75], v[132:135]
  ds_read_b128 a[172:175], v3 offset:19456
  v_add_f32 v226, v226, v219
  v_cvt_pk_bf16_f32 v185, v218, v219
  v_mfma_f32_16x16x32_bf16 v[140:143], a[140:143], v[76:79], v[140:143]
  s_waitcnt lgkmcnt(4)
  buffer_load_dwordx4 v[164:167], v2, s[40:43], s14 offen offset:1024 sc1
  v_add_f32 v226, v226, v220
  v_mfma_f32_16x16x32_bf16 v[128:131], a[144:147], v[80:83], v[128:131]
  ds_read_b128 a[176:179], v3 offset:20480
  v_mfma_f32_16x16x32_bf16 v[136:139], a[144:147], v[84:87], v[136:139]
  v_exp_f32 v221, v149
  v_mfma_f32_16x16x32_bf16 v[132:135], a[148:151], v[80:83], v[132:135]
  ds_read_b128 a[180:183], v3 offset:21504
  v_add_f32 v226, v226, v221
  v_mfma_f32_16x16x32_bf16 v[140:143], a[148:151], v[84:87], v[140:143]
  v_exp_f32 v222, v150
  v_mfma_f32_16x16x32_bf16 v[128:131], a[152:155], v[88:91], v[128:131]
  ds_read_b128 a[184:187], v3 offset:22528
  buffer_load_dwordx4 v[168:171], v2, s[40:43], s14 offen offset:2048 sc1
  v_cvt_pk_bf16_f32 v186, v220, v221
  v_mfma_f32_16x16x32_bf16 v[136:139], a[152:155], v[92:95], v[136:139]
  v_exp_f32 v223, v151
  v_mfma_f32_16x16x32_bf16 v[132:135], a[156:159], v[88:91], v[132:135]
  ds_read_b128 a[188:191], v3 offset:23552
  v_add_f32 v226, v226, v222
  v_add_f32 v226, v226, v223
  v_mfma_f32_16x16x32_bf16 v[140:143], a[156:159], v[92:95], v[140:143]
  s_waitcnt lgkmcnt(4)
  v_exp_f32 v216, v152
  v_mfma_f32_16x16x32_bf16 a[64:67], a[160:163], v[176:179], a[64:67]
  v_exp_f32 v217, v153
  v_mfma_f32_16x16x32_bf16 a[68:71], a[160:163], v[180:183], a[68:71]
  buffer_load_dwordx4 v[172:175], v2, s[40:43], s14 offen offset:3072 sc1
  v_cvt_pk_bf16_f32 v187, v222, v223
  v_add_f32 v227, v216, v217
  v_mfma_f32_16x16x32_bf16 a[72:75], a[164:167], v[176:179], a[72:75]
  v_exp_f32 v218, v154
  v_mfma_f32_16x16x32_bf16 a[76:79], a[164:167], v[180:183], a[76:79]
  v_exp_f32 v219, v155
  v_mfma_f32_16x16x32_bf16 a[80:83], a[168:171], v[176:179], a[80:83]
  v_exp_f32 v220, v156
  v_mfma_f32_16x16x32_bf16 a[84:87], a[168:171], v[180:183], a[84:87]
  s_add_u32 s14, s13, 53248
  buffer_load_dwordx4 v[192:195], v2, s[40:43], s14 offen offset:0 sc1
  v_cvt_pk_bf16_f32 v188, v216, v217
  v_add_f32 v227, v227, v218
  v_mfma_f32_16x16x32_bf16 a[88:91], a[172:175], v[176:179], a[88:91]
  v_exp_f32 v221, v157
  v_mfma_f32_16x16x32_bf16 a[92:95], a[172:175], v[180:183], a[92:95]
  s_waitcnt lgkmcnt(0)
  v_exp_f32 v222, v158
  v_mfma_f32_16x16x32_bf16 a[96:99], a[176:179], v[176:179], a[96:99]
  v_add_f32 v227, v227, v219
  v_cvt_pk_bf16_f32 v189, v218, v219
  v_mfma_f32_16x16x32_bf16 a[100:103], a[176:179], v[180:183], a[100:103]
  v_exp_f32 v223, v159
  v_mfma_f32_16x16x32_bf16 a[104:107], a[180:183], v[176:179], a[104:107]
  buffer_load_dwordx4 v[196:199], v2, s[40:43], s14 offen offset:1024 sc1
  v_add_f32 v227, v227, v220
  v_mfma_f32_16x16x32_bf16 a[108:111], a[180:183], v[180:183], a[108:111]
  v_add_f32 v227, v227, v221
  v_cvt_pk_bf16_f32 v190, v220, v221
  v_add_f32 v227, v227, v222
  v_mfma_f32_16x16x32_bf16 a[112:115], a[184:187], v[176:179], a[112:115]
  v_add_f32 v227, v227, v223
  v_max_f32 v5, v226, v227
  v_cmp_lt_f32 vcc, s81, v5
  v_mfma_f32_16x16x32_bf16 a[116:119], a[184:187], v[180:183], a[116:119]
  v_exp_f32 v216, v128
  v_mfma_f32_16x16x32_bf16 a[120:123], a[188:191], v[176:179], a[120:123]
  v_cvt_pk_bf16_f32 v191, v222, v223
  v_mfma_f32_16x16x32_bf16 a[124:127], a[188:191], v[180:183], a[124:127]
  s_cbranch_vccnz fa_stub28
fa_back28:
  v_exp_f32 v217, v129
  v_add_f32 v230, v230, v226
  v_add_f32 v231, v231, v227
  ds_read_b128 a[160:163], v3 offset:24576
  ds_read_b128 a[164:167], v3 offset:25600
  ds_read_b128 a[168:171], v3 offset:26624
  ds_read_b128 a[172:175], v3 offset:27648
  ds_read_b128 a[176:179], v3 offset:28672
  ds_read_b128 a[180:183], v3 offset:29696
  ds_read_b128 a[184:187], v3 offset:30720
  ds_read_b128 a[188:191], v3 offset:31744
  v_cndmask_b32 v128, v4, v128, s[68:69]
  v_cndmask_b32 v129, v4, v129, s[70:71]
  v_cndmask_b32 v130, v4, v130, s[72:73]
  v_cndmask_b32 v131, v4, v131, s[74:75]
  v_mov_b32 v132, v4
  v_mov_b32 v133, v4
  v_mov_b32 v134, v4
  v_mov_b32 v135, v4
  v_cndmask_b32 v140, v4, v140, s[68:69]
  v_cndmask_b32 v141, v4, v141, s[70:71]
  v_cndmask_b32 v142, v4, v142, s[72:73]
  v_cndmask_b32 v143, v4, v143, s[74:75]
  v_exp_f32 v216, v128
  v_exp_f32 v217, v129
  v_exp_f32 v218, v130
  v_add_f32 v226, v216, v217
  v_cvt_pk_bf16_f32 v176, v216, v217
  v_add_f32 v226, v226, v218
  v_exp_f32 v219, v131
  v_exp_f32 v220, v132
  v_add_f32 v226, v226, v219
  v_cvt_pk_bf16_f32 v177, v218, v219
  v_add_f32 v226, v226, v220
  v_exp_f32 v221, v133
  s_waitcnt lgkmcnt(4)
  v_mfma_f32_16x16x32_bf16 a[64:67], a[160:163], v[184:187], a[64:67]
  v_exp_f32 v222, v134
  v_add_f32 v226, v226, v221
  v_mfma_f32_16x16x32_bf16 a[68:71], a[160:163], v[188:191], a[68:71]
  s_add_u32 s14, s13, 53248
  buffer_load_dwordx4 v[208:211], v2, s[40:43], s14 offen offset:2048 sc1
  v_exp_f32 v223, v135
  v_mfma_f32_16x16x32_bf16 a[72:75], a[164:167], v[184:187], a[72:75]
  s_add_u32 s66, s66, 32768
  v_exp_f32 v216, v136
  v_mfma_f32_16x16x32_bf16 a[76:79], a[164:167], v[188:191], a[76:79]
  s_and_b32 s66, s66, 0x1ffff
  v_exp_f32 v217, v137
  v_mfma_f32_16x16x32_bf16 a[80:83], a[168:171], v[184:187], a[80:83]
  buffer_load_dwordx4 v[212:215], v2, s[40:43], s14 offen offset:3072 sc1
  v_cvt_pk_bf16_f32 v178, v220, v221
  v_add_f32 v226, v226, v222
  v_add_f32 v226, v226, v223
  v_cvt_pk_bf16_f32 v179, v222, v223
  v_mfma_f32_16x16x32_bf16 a[84:87], a[168:171], v[188:191], a[84:87]
  v_exp_f32 v218, v138
  v_mfma_f32_16x16x32_bf16 a[88:91], a[172:175], v[184:187], a[88:91]
  v_exp_f32 v219, v139
  v_mfma_f32_16x16x32_bf16 a[92:95], a[172:175], v[188:191], a[92:95]
  s_waitcnt lgkmcnt(0)
  v_exp_f32 v220, v140
  v_mfma_f32_16x16x32_bf16 a[96:99], a[176:179], v[184:187], a[96:99]
  s_add_u32 s14, s13, 57344
  buffer_load_dwordx4 v[232:235], v2, s[40:43], s14 offen offset:0 sc1
  v_add_f32 v227, v216, v217
  v_cvt_pk_bf16_f32 v180, v216, v217
  v_add_f32 v227, v227, v218
  v_add_f32 v227, v227, v219
  v_cvt_pk_bf16_f32 v181, v218, v219
  v_exp_f32 v221, v141
  v_mfma_f32_16x16x32_bf16 a[100:103], a[176:179], v[188:191], a[100:103]
  v_exp_f32 v222, v142
  v_mfma_f32_16x16x32_bf16 a[104:107], a[180:183], v[184:187], a[104:107]
  v_exp_f32 v223, v143
  v_mfma_f32_16x16x32_bf16 a[108:111], a[180:183], v[188:191], a[108:111]
  buffer_load_dwordx4 v[236:239], v2, s[40:43], s14 offen offset:1024 sc1
  v_add_f32 v227, v227, v220
  v_add_f32 v227, v227, v221
  v_cvt_pk_bf16_f32 v182, v220, v221
  v_add_f32 v227, v227, v222
  v_mfma_f32_16x16x32_bf16 a[112:115], a[184:187], v[184:187], a[112:115]
  v_add_f32 v227, v227, v223
  v_max_f32 v5, v226, v227
  v_cmp_lt_f32 vcc, s81, v5
  v_mfma_f32_16x16x32_bf16 a[116:119], a[184:187], v[188:191], a[116:119]
  v_mfma_f32_16x16x32_bf16 a[120:123], a[188:191], v[184:187], a[120:123]
  v_cvt_pk_bf16_f32 v183, v222, v223
  v_add_u32 v3, s66, v2
  v_mfma_f32_16x16x32_bf16 a[124:127], a[188:191], v[188:191], a[124:127]
  s_cbranch_vccnz fa_stub29
fa_back29:
  v_add_f32 v230, v230, v226
  v_add_f32 v231, v231, v227
  s_waitcnt vmcnt(10)
  s_barrier
  ds_read_b128 a[160:163], v3 offset:16384
  ds_read_b128 a[164:167], v3 offset:17408
  ds_read_b128 a[168:171], v3 offset:18432
  ds_read_b128 a[172:175], v3 offset:19456
  ds_read_b128 a[176:179], v3 offset:20480
  ds_read_b128 a[180:183], v3 offset:21504
  ds_read_b128 a[184:187], v3 offset:22528
  ds_read_b128 a[188:191], v3 offset:23552
  s_waitcnt lgkmcnt(4)
  v_mfma_f32_16x16x32_bf16 a[64:67], a[160:163], v[176:179], a[64:67]
  v_mfma_f32_16x16x32_bf16 a[68:71], a[160:163], v[180:183], a[68:71]
  s_add_u32 s14, s13, 57344
  buffer_load_dwordx4 v[240:243], v2, s[40:43], s14 offen offset:2048 sc1
  v_mfma_f32_16x16x32_bf16 a[72:75], a[164:167], v[176:179], a[72:75]
  v_mfma_f32_16x16x32_bf16 a[76:79], a[164:167], v[180:183], a[76:79]
  v_mfma_f32_16x16x32_bf16 a[80:83], a[168:171], v[176:179], a[80:83]
  v_mfma_f32_16x16x32_bf16 a[84:87], a[168:171], v[180:183], a[84:87]
  v_mfma_f32_16x16x32_bf16 a[88:91], a[172:175], v[176:179], a[88:91]
  v_mfma_f32_16x16x32_bf16 a[92:95], a[172:175], v[180:183], a[92:95]
  s_waitcnt lgkmcnt(0)
  v_mfma_f32_16x16x32_bf16 a[96:99], a[176:179], v[176:179], a[96:99]
  buffer_load_dwordx4 v[244:247], v2, s[40:43], s14 offen offset:3072 sc1
  v_mfma_f32_16x16x32_bf16 a[100:103], a[176:179], v[180:183], a[100:103]
  v_mfma_f32_16x16x32_bf16 a[104:107], a[180:183], v[176:179], a[104:107]
  v_mfma_f32_16x16x32_bf16 a[108:111], a[180:183], v[180:183], a[108:111]
  v_mfma_f32_16x16x32_bf16 a[112:115], a[184:187], v[176:179], a[112:115]
  v_mfma_f32_16x16x32_bf16 a[116:119], a[184:187], v[180:183], a[116:119]
  v_mfma_f32_16x16x32_bf16 a[120:123], a[188:191], v[176:179], a[120:123]
  v_mfma_f32_16x16x32_bf16 a[124:127], a[188:191], v[180:183], a[124:127]
  s_branch fa_Bdone
fa_Bodd:
  s_waitcnt vmcnt(0)
  s_barrier
  ds_read_b128 a[160:163], v3 offset:16384
  ds_read_b128 a[164:167], v3 offset:17408
  ds_read_b128 a[168:171], v3 offset:18432
  ds_read_b128 a[172:175], v3 offset:19456
  ds_read_b128 a[176:179], v3 offset:20480
  ds_read_b128 a[180:183], v3 offset:21504
  ds_read_b128 a[184:187], v3 offset:22528
  ds_read_b128 a[188:191], v3 offset:23552
  v_cndmask_b32 v144, v4, v144, s[68:69]
  v_cndmask_b32 v145, v4, v145, s[70:71]
  v_cndmask_b32 v146, v4, v146, s[72:73]
  v_cndmask_b32 v147, v4, v147, s[74:75]
  v_mov_b32 v148, v4
  v_mov_b32 v149, v4
  v_mov_b32 v150, v4
  v_mov_b32 v151, v4
  v_cndmask_b32 v156, v4, v156, s[68:69]
  v_cndmask_b32 v157, v4, v157, s[70:71]
  v_cndmask_b32 v158, v4, v158, s[72:73]
  v_cndmask_b32 v159, v4, v159, s[74:75]
  v_exp_f32 v216, v144
  v_exp_f32 v217, v145
  v_exp_f32 v218, v146
  v_add_f32 v226, v216, v217
  v_cvt_pk_bf16_f32 v184, v216, v217
  v_add_f32 v226, v226, v218
  v_exp_f32 v219, v147
  v_exp_f32 v220, v148
  v_add_f32 v226, v226, v219
  v_cvt_pk_bf16_f32 v185, v218, v219
  v_add_f32 v226, v226, v220
  v_exp_f32 v221, v149
  s_waitcnt lgkmcnt(4)
  v_mfma_f32_16x16x32_bf16 a[64:67], a[160:163], v[176:179], a[64:67]
  v_exp_f32 v222, v150
  v_add_f32 v226, v226, v221
  v_mfma_f32_16x16x32_bf16 a[68:71], a[160:163], v[180:183], a[68:71]
  s_add_u32 s14, s13, 49152
  buffer_load_dwordx4 v[160:163], v2, s[40:43], s14 offen offset:0 sc1
  v_exp_f32 v223, v151
  v_mfma_f32_16x16x32_bf16 a[72:75], a[164:167], v[176:179], a[72:75]
  v_exp_f32 v216, v152
  v_cvt_pk_bf16_f32 v186, v220, v221
  v_add_f32 v226, v226, v222
  v_mfma_f32_16x16x32_bf16 a[76:79], a[164:167], v[180:183], a[76:79]
  buffer_load_dwordx4 v[164:167], v2, s[40:43], s14 offen offset:1024 sc1
  v_exp_f32 v217, v153
  v_mfma_f32_16x16x32_bf16 a[80:83], a[168:171], v[176:179], a[80:83]
  v_exp_f32 v218, v154
  v_add_f32 v226, v226, v223
  v_mfma_f32_16x16x32_bf16 a[84:87], a[168:171], v[180:183], a[84:87]
  buffer_load_dwordx4 v[168:171], v2, s[40:43], s14 offen offset:2048 sc1
  v_exp_f32 v219, v155
  v_cvt_pk_bf16_f32 v187, v222, v223
  v_mfma_f32_16x16x32_bf16 a[88:91], a[172:175], v[176:179], a[88:91]
  v_exp_f32 v220, v156
  v_mfma_f32_16x16x32_bf16 a[92:95], a[172:175], v[180:183], a[92:95]
  s_waitcnt lgkmcnt(0)
  buffer_load_dwordx4 v[172:175], v2, s[40:43], s14 offen offset:3072 sc1
  v_add_f32 v227, v216, v217
  v_cvt_pk_bf16_f32 v188, v216, v217
  v_add_f32 v227, v227, v218
  v_mfma_f32_16x16x32_bf16 a[96:99], a[176:179], v[176:179], a[96:99]
  v_exp_f32 v221, v157
  v_mfma_f32_16x16x32_bf16 a[100:103], a[176:179], v[180:183], a[100:103]
  s_add_u32 s14, s13, 53248
  buffer_load_dwordx4 v[192:195], v2, s[40:43], s14 offen offset:0 sc1
  v_exp_f32 v222, v158
  v_mfma_f32_16x16x32_bf16 a[104:107], a[180:183], v[176:179], a[104:107]
  v_exp_f32 v223, v159
  v_mfma_f32_16x16x32_bf16 a[108:111], a[180:183], v[180:183], a[108:111]
  buffer_load_dwordx4 v[196:199], v2, s[40:43], s14 offen offset:1024 sc1
  v_add_f32 v227, v227, v219
  v_cvt_pk_bf16_f32 v189, v218, v219
  v_add_f32 v227, v227, v220
  v_add_f32 v227, v227, v221
  v_cvt_pk_bf16_f32 v190, v220, v221
  v_add_f32 v227, v227, v222
  v_mfma_f32_16x16x32_bf16 a[112:115], a[184:187], v[176:179], a[112:115]
  v_add_f32 v227, v227, v223
  v_max_f32 v5, v226, v227
  v_cmp_lt_f32 vcc, s81, v5
  v_mfma_f32_16x16x32_bf16 a[116:119], a[184:187], v[180:183], a[116:119]
  buffer_load_dwordx4 v[208:211], v2, s[40:43], s14 offen offset:2048 sc1
  v_mfma_f32_16x16x32_bf16 a[120:123], a[188:191], v[176:179], a[120:123]
  v_cvt_pk_bf16_f32 v191, v222, v223
  v_mfma_f32_16x16x32_bf16 a[124:127], a[188:191], v[180:183], a[124:127]
  s_cbranch_vccnz fa_stub30
fa_back30:
  v_add_f32 v230, v230, v226
  v_add_f32 v231, v231, v227
  ds_read_b128 a[160:163], v3 offset:24576
  ds_read_b128 a[164:167], v3 offset:25600
  ds_read_b128 a[168:171], v3 offset:26624
  ds_read_b128 a[172:175], v3 offset:27648
  ds_read_b128 a[176:179], v3 offset:28672
  ds_read_b128 a[180:183], v3 offset:29696
  ds_read_b128 a[184:187], v3 offset:30720
  ds_read_b128 a[188:191], v3 offset:31744
  s_waitcnt lgkmcnt(4)
  v_mfma_f32_16x16x32_bf16 a[64:67], a[160:163], v[184:187], a[64:67]
  v_mfma_f32_16x16x32_bf16 a[68:71], a[160:163], v[188:191], a[68:71]
  s_add_u32 s14, s13, 53248
  buffer_load_dwordx4 v[212:215], v2, s[40:43], s14 offen offset:3072 sc1
  v_mfma_f32_16x16x32_bf16 a[72:75], a[164:167], v[184:187], a[72:75]
  s_add_u32 s66, s66, 32768
  v_mfma_f32_16x16x32_bf16 a[76:79], a[164:167], v[188:191], a[76:79]
  s_add_u32 s14, s13, 57344
  buffer_load_dwordx4 v[232:235], v2, s[40:43], s14 offen offset:0 sc1
  v_mfma_f32_16x16x32_bf16 a[80:83], a[168:171], v[184:187], a[80:83]
  s_and_b32 s66, s66, 0x1ffff
  v_mfma_f32_16x16x32_bf16 a[84:87], a[168:171], v[188:191], a[84:87]
  v_mfma_f32_16x16x32_bf16 a[88:91], a[172:175], v[184:187], a[88:91]
  buffer_load_dwordx4 v[236:239], v2, s[40:43], s14 offen offset:1024 sc1
  v_mfma_f32_16x16x32_bf16 a[92:95], a[172:175], v[188:191], a[92:95]
  s_waitcnt lgkmcnt(0)
  v_mfma_f32_16x16x32_bf16 a[96:99], a[176:179], v[184:187], a[96:99]
  v_mfma_f32_16x16x32_bf16 a[100:103], a[176:179], v[188:191], a[100:103]
  buffer_load_dwordx4 v[240:243], v2, s[40:43], s14 offen offset:2048 sc1
  v_mfma_f32_16x16x32_bf16 a[104:107], a[180:183], v[184:187], a[104:107]
  v_mfma_f32_16x16x32_bf16 a[108:111], a[180:183], v[188:191], a[108:111]
  v_mfma_f32_16x16x32_bf16 a[112:115], a[184:187], v[184:187], a[112:115]
  buffer_load_dwordx4 v[244:247], v2, s[40:43], s14 offen offset:3072 sc1
  v_mfma_f32_16x16x32_bf16 a[116:119], a[184:187], v[188:191], a[116:119]
  v_mfma_f32_16x16x32_bf16 a[120:123], a[188:191], v[184:187], a[120:123]
  v_add_u32 v3, s66, v2
  v_mfma_f32_16x16x32_bf16 a[124:127], a[188:191], v[188:191], a[124:127]
fa_Bdone:
  s_cmp_ge_u32 s20, 2
  s_cbranch_scc1 fa_epi
  s_barrier
fa_epi:
  v_mov_b32 v20, v230
  v_mov_b32 v21, v231
  s_nop 1
  v_permlane16_swap_b32 v230, v20
  v_permlane16_swap_b32 v231, v21
  v_add_f32 v230, v230, v20
  v_add_f32 v231, v231, v21
  v_mov_b32 v20, v230
  v_mov_b32 v21, v231
  s_nop 1
  v_permlane32_swap_b32 v230, v20
  v_permlane32_swap_b32 v231, v21
  v_add_f32 v230, v230, v20
  v_add_f32 v231, v231, v21
  v_rcp_f32 v16, v230
  v_rcp_f32 v18, v231
  s_sub_u32 s23, 15, s22
  s_lshl_b32 s23, s23, 2
  v_mov_b32 v17, v16
  v_mov_b32 v19, v18
  s_add_u32 s23, s23, s20
  s_lshl_b32 s23, s23, 18
  s_lshl_b32 s31, s21, 12
  s_add_u32 s31, s31, 50331648
  s_add_u32 s64, s23, s31
  s_add_u32 s65, s64, 131072
  v_accvgpr_read_b32 v68, a64
  v_accvgpr_read_b32 v69, a65
  v_accvgpr_read_b32 v70, a66
  v_accvgpr_read_b32 v71, a67
  v_accvgpr_read_b32 v72, a72
  v_accvgpr_read_b32 v73, a73
  v_accvgpr_read_b32 v74, a74
  v_accvgpr_read_b32 v75, a75
  v_pk_mul_f32 v[68:69], v[68:69], v[16:17]
  v_pk_mul_f32 v[70:71], v[70:71], v[16:17]
  v_pk_mul_f32 v[72:73], v[72:73], v[16:17]
  v_pk_mul_f32 v[74:75], v[74:75], v[16:17]
  v_cvt_pk_bf16_f32 v64, v68, v69
  v_cvt_pk_bf16_f32 v65, v70, v71
  v_cvt_pk_bf16_f32 v66, v72, v73
  v_cvt_pk_bf16_f32 v67, v74, v75
  buffer_store_dwordx4 v[64:67], v2, s[40:43], s64 offen offset:0 sc1
  v_accvgpr_read_b32 v80, a80
  v_accvgpr_read_b32 v81, a81
  v_accvgpr_read_b32 v82, a82
  v_accvgpr_read_b32 v83, a83
  v_accvgpr_read_b32 v84, a88
  v_accvgpr_read_b32 v85, a89
  v_accvgpr_read_b32 v86, a90
  v_accvgpr_read_b32 v87, a91
  v_pk_mul_f32 v[80:81], v[80:81], v[16:17]
  v_pk_mul_f32 v[82:83], v[82:83], v[16:17]
  v_pk_mul_f32 v[84:85], v[84:85], v[16:17]
  v_pk_mul_f32 v[86:87], v[86:87], v[16:17]
  v_cvt_pk_bf16_f32 v76, v80, v81
  v_cvt_pk_bf16_f32 v77, v82, v83
  v_cvt_pk_bf16_f32 v78, v84, v85
  v_cvt_pk_bf16_f32 v79, v86, v87
  buffer_store_dwordx4 v[76:79], v2, s[40:43], s64 offen offset:1024 sc1
  v_accvgpr_read_b32 v132, a96
  v_accvgpr_read_b32 v133, a97
  v_accvgpr_read_b32 v134, a98
  v_accvgpr_read_b32 v135, a99
  v_accvgpr_read_b32 v136, a104
  v_accvgpr_read_b32 v137, a105
  v_accvgpr_read_b32 v138, a106
  v_accvgpr_read_b32 v139, a107
  v_pk_mul_f32 v[132:133], v[132:133], v[16:17]
  v_pk_mul_f32 v[134:135], v[134:135], v[16:17]
  v_pk_mul_f32 v[136:137], v[136:137], v[16:17]
  v_pk_mul_f32 v[138:139], v[138:139], v[16:17]
  v_cvt_pk_bf16_f32 v128, v132, v133
  v_cvt_pk_bf16_f32 v129, v134, v135
  v_cvt_pk_bf16_f32 v130, v136, v137
  v_cvt_pk_bf16_f32 v131, v138, v139
  buffer_store_dwordx4 v[128:131], v2, s[40:43], s64 offen offset:2048 sc1
  v_accvgpr_read_b32 v144, a112
  v_accvgpr_read_b32 v145, a113
  v_accvgpr_read_b32 v146, a114
  v_accvgpr_read_b32 v147, a115
  v_accvgpr_read_b32 v148, a120
  v_accvgpr_read_b32 v149, a121
  v_accvgpr_read_b32 v150, a122
  v_accvgpr_read_b32 v151, a123
  v_pk_mul_f32 v[144:145], v[144:145], v[16:17]
  v_pk_mul_f32 v[146:147], v[146:147], v[16:17]
  v_pk_mul_f32 v[148:149], v[148:149], v[16:17]
  v_pk_mul_f32 v[150:151], v[150:151], v[16:17]
  v_cvt_pk_bf16_f32 v140, v144, v145
  v_cvt_pk_bf16_f32 v141, v146, v147
  v_cvt_pk_bf16_f32 v142, v148, v149
  v_cvt_pk_bf16_f32 v143, v150, v151
  buffer_store_dwordx4 v[140:143], v2, s[40:43], s64 offen offset:3072 sc1
  v_accvgpr_read_b32 v68, a68
  v_accvgpr_read_b32 v69, a69
  v_accvgpr_read_b32 v70, a70
  v_accvgpr_read_b32 v71, a71
  v_accvgpr_read_b32 v72, a76
  v_accvgpr_read_b32 v73, a77
  v_accvgpr_read_b32 v74, a78
  v_accvgpr_read_b32 v75, a79
  v_pk_mul_f32 v[68:69], v[68:69], v[18:19]
  v_pk_mul_f32 v[70:71], v[70:71], v[18:19]
  v_pk_mul_f32 v[72:73], v[72:73], v[18:19]
  v_pk_mul_f32 v[74:75], v[74:75], v[18:19]
  v_cvt_pk_bf16_f32 v64, v68, v69
  v_cvt_pk_bf16_f32 v65, v70, v71
  v_cvt_pk_bf16_f32 v66, v72, v73
  v_cvt_pk_bf16_f32 v67, v74, v75
  buffer_store_dwordx4 v[64:67], v2, s[40:43], s65 offen offset:0 sc1
  v_accvgpr_read_b32 v80, a84
  v_accvgpr_read_b32 v81, a85
  v_accvgpr_read_b32 v82, a86
  v_accvgpr_read_b32 v83, a87
  v_accvgpr_read_b32 v84, a92
  v_accvgpr_read_b32 v85, a93
  v_accvgpr_read_b32 v86, a94
  v_accvgpr_read_b32 v87, a95
  v_pk_mul_f32 v[80:81], v[80:81], v[18:19]
  v_pk_mul_f32 v[82:83], v[82:83], v[18:19]
  v_pk_mul_f32 v[84:85], v[84:85], v[18:19]
  v_pk_mul_f32 v[86:87], v[86:87], v[18:19]
  v_cvt_pk_bf16_f32 v76, v80, v81
  v_cvt_pk_bf16_f32 v77, v82, v83
  v_cvt_pk_bf16_f32 v78, v84, v85
  v_cvt_pk_bf16_f32 v79, v86, v87
  buffer_store_dwordx4 v[76:79], v2, s[40:43], s65 offen offset:1024 sc1
  v_accvgpr_read_b32 v132, a100
  v_accvgpr_read_b32 v133, a101
  v_accvgpr_read_b32 v134, a102
  v_accvgpr_read_b32 v135, a103
  v_accvgpr_read_b32 v136, a108
  v_accvgpr_read_b32 v137, a109
  v_accvgpr_read_b32 v138, a110
  v_accvgpr_read_b32 v139, a111
  v_pk_mul_f32 v[132:133], v[132:133], v[18:19]
  v_pk_mul_f32 v[134:135], v[134:135], v[18:19]
  v_pk_mul_f32 v[136:137], v[136:137], v[18:19]
  v_pk_mul_f32 v[138:139], v[138:139], v[18:19]
  v_cvt_pk_bf16_f32 v128, v132, v133
  v_cvt_pk_bf16_f32 v129, v134, v135
  v_cvt_pk_bf16_f32 v130, v136, v137
  v_cvt_pk_bf16_f32 v131, v138, v139
  buffer_store_dwordx4 v[128:131], v2, s[40:43], s65 offen offset:2048 sc1
  v_accvgpr_read_b32 v144, a116
  v_accvgpr_read_b32 v145, a117
  v_accvgpr_read_b32 v146, a118
  v_accvgpr_read_b32 v147, a119
  v_accvgpr_read_b32 v148, a124
  v_accvgpr_read_b32 v149, a125
  v_accvgpr_read_b32 v150, a126
  v_accvgpr_read_b32 v151, a127
  v_pk_mul_f32 v[144:145], v[144:145], v[18:19]
  v_pk_mul_f32 v[146:147], v[146:147], v[18:19]
  v_pk_mul_f32 v[148:149], v[148:149], v[18:19]
  v_pk_mul_f32 v[150:151], v[150:151], v[18:19]
  v_cvt_pk_bf16_f32 v140, v144, v145
  v_cvt_pk_bf16_f32 v141, v146, v147
  v_cvt_pk_bf16_f32 v142, v148, v149
  v_cvt_pk_bf16_f32 v143, v150, v151
  buffer_store_dwordx4 v[140:143], v2, s[40:43], s65 offen offset:3072 sc1
  s_load_dwordx2 s[4:5], s[0:1], 0
  s_load_dwordx2 s[6:7], s[0:1], 88
  v_mov_b32 v30, 1073741824
  v_writelane_b32 v30, s80, 0
  v_writelane_b32 v30, s3, 1
  s_cmp_lt_u32 s12, 3
  s_cbranch_scc1 fa_puby
  s_add_u32 s14, s13, 61440
  buffer_load_dwordx4 v[64:67], v2, s[40:43], s14 offen offset:0 sc1
  buffer_load_dwordx4 v[68:71], v2, s[40:43], s14 offen offset:1024 sc1
  buffer_load_dwordx4 v[72:75], v2, s[40:43], s14 offen offset:2048 sc1
  buffer_load_dwordx4 v[76:79], v2, s[40:43], s14 offen offset:3072 sc1
  s_add_u32 s14, s13, 65536
  buffer_load_dwordx4 v[80:83], v2, s[40:43], s14 offen offset:0 sc1
  buffer_load_dwordx4 v[84:87], v2, s[40:43], s14 offen offset:1024 sc1
  buffer_load_dwordx4 v[88:91], v2, s[40:43], s14 offen offset:2048 sc1
  buffer_load_dwordx4 v[92:95], v2, s[40:43], s14 offen offset:3072 sc1
  s_waitcnt vmcnt(8)
  buffer_store_dword v4, v30, s[40:43], 0 offen sc1
fa_pubb:
  s_cmp_lt_u32 s29, 8
  s_cbranch_scc1 fa_left
fa_leftb:
  s_add_u32 s14, s13, 69632
  buffer_load_dwordx4 v[128:131], v2, s[40:43], s14 offen offset:0 sc1
  buffer_load_dwordx4 v[132:135], v2, s[40:43], s14 offen offset:1024 sc1
  buffer_load_dwordx4 v[136:139], v2, s[40:43], s14 offen offset:2048 sc1
  buffer_load_dwordx4 v[140:143], v2, s[40:43], s14 offen offset:3072 sc1
  s_add_u32 s14, s13, 73728
  buffer_load_dwordx4 v[144:147], v2, s[40:43], s14 offen offset:0 sc1
  buffer_load_dwordx4 v[148:151], v2, s[40:43], s14 offen offset:1024 sc1
  s_lshl_b32 s64, s21, 19
  s_lshl_b32 s23, s20, 15
  s_add_u32 s64, s64, s23
  s_add_u32 s64, s64, 50331648
  s_add_u32 s65, s64, 131072
  s_add_u32 s66, s64, 262144
  s_add_u32 s67, s64, 393216
  v_bfe_u32 v12, v1, 3, 1
  v_lshlrev_b32 v12, 7, v12
  v_and_b32 v13, 7, v1
  v_lshl_add_u32 v12, v13, 2, v12
  s_lshl_b32 s23, s21, 8
  s_lshl_b32 s31, s20, 5
  s_add_u32 s23, s23, s31
  s_add_u32 s23, s23, 2641920
  v_add_u32 v12, s23, v12
  s_lshl_b32 s25, s21, 6
  s_mul_i32 s26, s22, 160
  s_mul_i32 s27, s22, 2560
  v_mov_b32 v20, 0
  v_mov_b32 v21, 0
  v_mov_b32 v22, 0
  v_mov_b32 v23, 0
  v_add_u32 v16, 158208, v2
  ds_write_b128 v16, v[20:23]
  s_add_u32 s33, s13, 126976
  s_mul_i32 s34, s20, 38912
  v_add_u32 v11, s34, v2
  s_add_u32 s35, s34, 36864
  buffer_load_dwordx4 v[152:155], v2, s[40:43], s14 offen offset:2048 sc1
  buffer_load_dwordx4 v[156:159], v2, s[40:43], s14 offen offset:3072 sc1
  s_add_u32 s14, s13, 77824
  buffer_load_dwordx4 v[176:179], v2, s[40:43], s14 offen offset:0 sc1
  buffer_load_dwordx4 v[180:183], v2, s[40:43], s14 offen offset:1024 sc1
  buffer_load_dwordx4 v[184:187], v2, s[40:43], s14 offen offset:2048 sc1
  buffer_load_dwordx4 v[188:191], v2, s[40:43], s14 offen offset:3072 sc1
  s_add_u32 s13, s13, 81920
  s_waitcnt lgkmcnt(0)
  s_barrier
  s_mov_b32 s44, s4
  s_mov_b32 s45, s5
  s_mov_b32 s46, 2621440
  s_mov_b32 s47, 0x20000
  s_mov_b32 s48, s6
  s_mov_b32 s49, s7
  s_mov_b32 s50, 2621440
  s_mov_b32 s51, 0x20000
  s_mov_b32 m0, s34
  s_add_u32 s34, s34, 4096
  buffer_load_dwordx4 v2, s[40:43], s33 offen offset:0 sc1 lds
  buffer_load_dwordx4 v2, s[40:43], s33 offen offset:1024 sc1 lds
  buffer_load_dwordx4 v2, s[40:43], s33 offen offset:2048 sc1 lds
  buffer_load_dwordx4 v2, s[40:43], s33 offen offset:3072 sc1 lds
  s_add_u32 s33, s33, 4096
  s_mov_b32 m0, s34
  s_add_u32 s34, s34, 4096
  buffer_load_dwordx4 v2, s[40:43], s33 offen offset:0 sc1 lds
  buffer_load_dwordx4 v2, s[40:43], s33 offen offset:1024 sc1 lds
  buffer_load_dwordx4 v2, s[40:43], s33 offen offset:2048 sc1 lds
  buffer_load_dwordx4 v2, s[40:43], s33 offen offset:3072 sc1 lds
  s_add_u32 s33, s33, 4096
  s_mov_b32 m0, s34
  s_add_u32 s34, s34, 4096
  buffer_load_dwordx4 v2, s[40:43], s33 offen offset:0 sc1 lds
  buffer_load_dwordx4 v2, s[40:43], s33 offen offset:1024 sc1 lds
  buffer_load_dwordx4 v2, s[40:43], s33 offen offset:2048 sc1 lds
  buffer_load_dwordx4 v2, s[40:43], s33 offen offset:3072 sc1 lds
  s_add_u32 s33, s33, 4096
  s_mov_b32 m0, s34
  s_add_u32 s34, s34, 4096
  buffer_load_dwordx4 v2, s[40:43], s33 offen offset:0 sc1 lds
  buffer_load_dwordx4 v2, s[40:43], s33 offen offset:1024 sc1 lds
  buffer_load_dwordx4 v2, s[40:43], s33 offen offset:2048 sc1 lds
  buffer_load_dwordx4 v2, s[40:43], s33 offen offset:3072 sc1 lds
  s_add_u32 s33, s33, 4096
  s_mov_b32 m0, s34
  s_add_u32 s34, s34, 4096
  buffer_load_dwordx4 v2, s[40:43], s33 offen offset:0 sc1 lds
  buffer_load_dwordx4 v2, s[40:43], s33 offen offset:1024 sc1 lds
  buffer_load_dwordx4 v2, s[40:43], s33 offen offset:2048 sc1 lds
  buffer_load_dwordx4 v2, s[40:43], s33 offen offset:3072 sc1 lds
  s_add_u32 s33, s33, 4096
  s_mov_b32 m0, s34
  s_add_u32 s34, s34, 4096
  buffer_load_dwordx4 v2, s[40:43], s33 offen offset:0 sc1 lds
  buffer_load_dwordx4 v2, s[40:43], s33 offen offset:1024 sc1 lds
  buffer_load_dwordx4 v2, s[40:43], s33 offen offset:2048 sc1 lds
  buffer_load_dwordx4 v2, s[40:43], s33 offen offset:3072 sc1 lds
  s_add_u32 s33, s33, 4096
  s_mov_b32 m0, s34
  s_add_u32 s34, s34, 4096
  buffer_load_dwordx4 v2, s[40:43], s33 offen offset:0 sc1 lds
  buffer_load_dwordx4 v2, s[40:43], s33 offen offset:1024 sc1 lds
  buffer_load_dwordx4 v2, s[40:43], s33 offen offset:2048 sc1 lds
  buffer_load_dwordx4 v2, s[40:43], s33 offen offset:3072 sc1 lds
  s_add_u32 s33, s33, 4096
  buffer_load_dword v13, v12, s[40:43], 0 offen sc1
  s_mov_b32 m0, s34
  s_add_u32 s34, s34, 4096
  buffer_load_dwordx4 v2, s[40:43], s33 offen offset:0 sc1 lds
  buffer_load_dwordx4 v2, s[40:43], s33 offen offset:1024 sc1 lds
  buffer_load_dwordx4 v2, s[40:43], s33 offen offset:2048 sc1 lds
  buffer_load_dwordx4 v2, s[40:43], s33 offen offset:3072 sc1 lds
  s_add_u32 s33, s33, 4096
  s_mov_b32 m0, s34
  s_add_u32 s34, s34, 4096
  buffer_load_dwordx4 v2, s[40:43], s33 offen offset:0 sc1 lds
  buffer_load_dwordx4 v2, s[40:43], s33 offen offset:1024 sc1 lds
  buffer_load_dwordx4 v2, s[40:43], s33 offen offset:2048 sc1 lds
  buffer_load_dwordx4 v2, s[40:43], s33 offen offset:3072 sc1 lds
  s_add_u32 s33, s33, 4096
  s_waitcnt vmcnt(8)
  v_cmp_eq_u32 vcc, 0, v13
  s_cbranch_vccnz fa_ctx_spin
fa_ctx_ok:
  buffer_load_dwordx4 a[144:147], v2, s[40:43], s64 offen offset:0 sc1
  buffer_load_dwordx4 a[148:151], v2, s[40:43], s65 offen offset:0 sc1
  buffer_load_dwordx4 a[152:155], v2, s[40:43], s66 offen offset:0 sc1
  buffer_load_dwordx4 a[156:159], v2, s[40:43], s67 offen offset:0 sc1
  buffer_load_dwordx4 a[160:163], v2, s[40:43], s64 offen offset:1024 sc1
  buffer_load_dwordx4 a[164:167], v2, s[40:43], s65 offen offset:1024 sc1
  buffer_load_dwordx4 a[168:171], v2, s[40:43], s66 offen offset:1024 sc1
  buffer_load_dwordx4 a[172:175], v2, s[40:43], s67 offen offset:1024 sc1
  buffer_load_dwordx4 a[176:179], v2, s[40:43], s64 offen offset:2048 sc1
  buffer_load_dwordx4 a[180:183], v2, s[40:43], s65 offen offset:2048 sc1
  buffer_load_dwordx4 a[184:187], v2, s[40:43], s66 offen offset:2048 sc1
  buffer_load_dwordx4 a[188:191], v2, s[40:43], s67 offen offset:2048 sc1
  buffer_load_dwordx4 v[216:219], v2, s[40:43], s64 offen offset:3072 sc1
  buffer_load_dwordx4 v[220:223], v2, s[40:43], s65 offen offset:3072 sc1
  buffer_load_dwordx4 v[224:227], v2, s[40:43], s66 offen offset:3072 sc1
  buffer_load_dwordx4 v[228:231], v2, s[40:43], s67 offen offset:3072 sc1
  s_add_u32 s64, s64, 4096
  s_add_u32 s65, s65, 4096
  s_add_u32 s66, s66, 4096
  s_add_u32 s67, s67, 4096
  s_waitcnt vmcnt(12)
  v_mfma_f32_16x16x32_bf16 a[64:67], a[0:3], a[144:147], 0
  v_mfma_f32_16x16x32_bf16 a[68:71], a[0:3], a[148:151], 0
  v_mfma_f32_16x16x32_bf16 a[72:75], a[0:3], a[152:155], 0
  v_mfma_f32_16x16x32_bf16 a[76:79], a[0:3], a[156:159], 0
  buffer_load_dwordx4 a[0:3], v2, s[40:43], s13 offen offset:0 sc1
  v_mfma_f32_16x16x32_bf16 a[80:83], a[4:7], a[144:147], 0
  v_mfma_f32_16x16x32_bf16 a[84:87], a[4:7], a[148:151], 0
  v_mfma_f32_16x16x32_bf16 a[88:91], a[4:7], a[152:155], 0
  v_mfma_f32_16x16x32_bf16 a[92:95], a[4:7], a[156:159], 0
  buffer_load_dwordx4 a[4:7], v2, s[40:43], s13 offen offset:1024 sc1
  v_mfma_f32_16x16x32_bf16 a[96:99], a[8:11], a[144:147], 0
  v_mfma_f32_16x16x32_bf16 a[100:103], a[8:11], a[148:151], 0
  v_mfma_f32_16x16x32_bf16 a[104:107], a[8:11], a[152:155], 0
  v_mfma_f32_16x16x32_bf16 a[108:111], a[8:11], a[156:159], 0
  buffer_load_dwordx4 a[8:11], v2, s[40:43], s13 offen offset:2048 sc1
  v_mfma_f32_16x16x32_bf16 a[112:115], a[12:15], a[144:147], 0
  v_mfma_f32_16x16x32_bf16 a[116:119], a[12:15], a[148:151], 0
  v_mfma_f32_16x16x32_bf16 a[120:123], a[12:15], a[152:155], 0
  v_mfma_f32_16x16x32_bf16 a[124:127], a[12:15], a[156:159], 0
  v_mfma_f32_16x16x32_bf16 a[128:131], a[16:19], a[144:147], 0
  buffer_load_dwordx4 a[144:147], v2, s[40:43], s64 offen offset:0 sc1
  v_mfma_f32_16x16x32_bf16 a[132:135], a[16:19], a[148:151], 0
  buffer_load_dwordx4 a[148:151], v2, s[40:43], s65 offen offset:0 sc1
  v_mfma_f32_16x16x32_bf16 a[136:139], a[16:19], a[152:155], 0
  buffer_load_dwordx4 a[152:155], v2, s[40:43], s66 offen offset:0 sc1
  v_mfma_f32_16x16x32_bf16 a[140:143], a[16:19], a[156:159], 0
  buffer_load_dwordx4 a[156:159], v2, s[40:43], s67 offen offset:0 sc1
  s_waitcnt vmcnt(15)
  v_mfma_f32_16x16x32_bf16 a[64:67], a[20:23], a[160:163], a[64:67]
  v_add_u32 v16, 0, v0
  v_mfma_f32_16x16x32_bf16 a[68:71], a[20:23], a[164:167], a[68:71]
  v_mfma_f32_16x16x32_bf16 a[72:75], a[20:23], a[168:171], a[72:75]
  v_mul_u32_u24 v17, 6554, v16
  v_mfma_f32_16x16x32_bf16 a[76:79], a[20:23], a[172:175], a[76:79]
  buffer_load_dwordx4 a[12:15], v2, s[40:43], s13 offen offset:3072 sc1
  v_mfma_f32_16x16x32_bf16 a[80:83], a[24:27], a[160:163], a[80:83]
  s_add_u32 s13, s13, 4096
  v_mfma_f32_16x16x32_bf16 a[84:87], a[24:27], a[164:167], a[84:87]
  v_lshrrev_b32 v17, 16, v17
  v_mfma_f32_16x16x32_bf16 a[88:91], a[24:27], a[168:171], a[88:91]
  v_mul_u32_u24 v18, 10, v17
  v_mfma_f32_16x16x32_bf16 a[92:95], a[24:27], a[172:175], a[92:95]
  buffer_load_dwordx4 a[16:19], v2, s[40:43], s13 offen offset:0 sc1
  v_mfma_f32_16x16x32_bf16 a[96:99], a[28:31], a[160:163], a[96:99]
  v_mfma_f32_16x16x32_bf16 a[100:103], a[28:31], a[164:167], a[100:103]
  v_sub_u32 v18, v16, v18
  v_mfma_f32_16x16x32_bf16 a[104:107], a[28:31], a[168:171], a[104:107]
  v_mfma_f32_16x16x32_bf16 a[108:111], a[28:31], a[172:175], a[108:111]
  v_mfma_f32_16x16x32_bf16 a[112:115], a[32:35], a[160:163], a[112:115]
  v_mfma_f32_16x16x32_bf16 a[116:119], a[32:35], a[164:167], a[116:119]
  v_mul_u32_u24 v251, 336, v17
  v_mfma_f32_16x16x32_bf16 a[120:123], a[32:35], a[168:171], a[120:123]
  v_lshl_add_u32 v251, v18, 5, v251
  v_mfma_f32_16x16x32_bf16 a[124:127], a[32:35], a[172:175], a[124:127]
  v_mfma_f32_16x16x32_bf16 a[128:131], a[36:39], a[160:163], a[128:131]
  buffer_load_dwordx4 a[160:163], v2, s[40:43], s64 offen offset:1024 sc1
  v_mfma_f32_16x16x32_bf16 a[132:135], a[36:39], a[164:167], a[132:135]
  buffer_load_dwordx4 a[164:167], v2, s[40:43], s65 offen offset:1024 sc1
  v_mfma_f32_16x16x32_bf16 a[136:139], a[36:39], a[168:171], a[136:139]
  buffer_load_dwordx4 a[168:171], v2, s[40:43], s66 offen offset:1024 sc1
  v_mfma_f32_16x16x32_bf16 a[140:143], a[36:39], a[172:175], a[140:143]
  buffer_load_dwordx4 a[172:175], v2, s[40:43], s67 offen offset:1024 sc1
  s_waitcnt vmcnt(17)
  v_mfma_f32_16x16x32_bf16 a[64:67], a[40:43], a[176:179], a[64:67]
  v_lshlrev_b32 v203, 5, v18
  v_mfma_f32_16x16x32_bf16 a[68:71], a[40:43], a[180:183], a[68:71]
  v_mfma_f32_16x16x32_bf16 a[72:75], a[40:43], a[184:187], a[72:75]
  v_add_u32 v17, s25, v17
  v_mfma_f32_16x16x32_bf16 a[76:79], a[40:43], a[188:191], a[76:79]
  buffer_load_dwordx4 a[20:23], v2, s[40:43], s13 offen offset:1024 sc1
  v_mfma_f32_16x16x32_bf16 a[80:83], a[44:47], a[176:179], a[80:83]
  v_mfma_f32_16x16x32_bf16 a[84:87], a[44:47], a[180:183], a[84:87]
  v_add_u32 v24, 1, v17
  v_mfma_f32_16x16x32_bf16 a[88:91], a[44:47], a[184:187], a[88:91]
  v_mul_u32_u24 v248, 1280, v17
  v_mfma_f32_16x16x32_bf16 a[92:95], a[44:47], a[188:191], a[92:95]
  buffer_load_dwordx4 a[24:27], v2, s[40:43], s13 offen offset:2048 sc1
  v_mfma_f32_16x16x32_bf16 a[96:99], a[48:51], a[176:179], a[96:99]
  v_mfma_f32_16x16x32_bf16 a[100:103], a[48:51], a[180:183], a[100:103]
  v_lshl_add_u32 v248, v18, 4, v248
  v_mfma_f32_16x16x32_bf16 a[104:107], a[48:51], a[184:187], a[104:107]
  v_mfma_f32_16x16x32_bf16 a[108:111], a[48:51], a[188:191], a[108:111]
  v_mfma_f32_16x16x32_bf16 a[112:115], a[52:55], a[176:179], a[112:115]
  v_mfma_f32_16x16x32_bf16 a[116:119], a[52:55], a[180:183], a[116:119]
  v_add_u32 v248, s26, v248
  v_mfma_f32_16x16x32_bf16 a[120:123], a[52:55], a[184:187], a[120:123]
  v_lshrrev_b32 v19, 4, v17
  v_mfma_f32_16x16x32_bf16 a[124:127], a[52:55], a[188:191], a[124:127]
  v_mfma_f32_16x16x32_bf16 a[128:131], a[56:59], a[176:179], a[128:131]
  buffer_load_dwordx4 a[176:179], v2, s[40:43], s64 offen offset:2048 sc1
  v_mfma_f32_16x16x32_bf16 a[132:135], a[56:59], a[180:183], a[132:135]
  buffer_load_dwordx4 a[180:183], v2, s[40:43], s65 offen offset:2048 sc1
  v_mfma_f32_16x16x32_bf16 a[136:139], a[56:59], a[184:187], a[136:139]
  buffer_load_dwordx4 a[184:187], v2, s[40:43], s66 offen offset:2048 sc1
  v_mfma_f32_16x16x32_bf16 a[140:143], a[56:59], a[188:191], a[140:143]
  buffer_load_dwordx4 a[188:191], v2, s[40:43], s67 offen offset:2048 sc1
  s_waitcnt vmcnt(19)
  v_mfma_f32_16x16x32_bf16 a[64:67], a[60:63], v[216:219], a[64:67]
  v_mul_u32_u24 v19, 20480, v19
  v_mfma_f32_16x16x32_bf16 a[68:71], a[60:63], v[220:223], a[68:71]
  v_mfma_f32_16x16x32_bf16 a[72:75], a[60:63], v[224:227], a[72:75]
  v_and_b32 v17, 15, v17
  v_mfma_f32_16x16x32_bf16 a[76:79], a[60:63], v[228:231], a[76:79]
  buffer_load_dwordx4 a[28:31], v2, s[40:43], s13 offen offset:3072 sc1
  v_mfma_f32_16x16x32_bf16 a[80:83], a[192:195], v[216:219], a[80:83]
  s_add_u32 s13, s13, 4096
  v_mfma_f32_16x16x32_bf16 a[84:87], a[192:195], v[220:223], a[84:87]
  v_lshl_add_u32 v19, v17, 4, v19
  v_mfma_f32_16x16x32_bf16 a[88:91], a[192:195], v[224:227], a[88:91]
  v_lshl_add_u32 v200, v18, 8, v19
  v_mfma_f32_16x16x32_bf16 a[92:95], a[192:195], v[228:231], a[92:95]
  buffer_load_dwordx4 a[32:35], v2, s[40:43], s13 offen offset:0 sc1
  v_mfma_f32_16x16x32_bf16 a[96:99], a[196:199], v[216:219], a[96:99]
  v_mfma_f32_16x16x32_bf16 a[100:103], a[196:199], v[220:223], a[100:103]
  v_mov_b32 v27, 8
  v_mfma_f32_16x16x32_bf16 a[104:107], a[196:199], v[224:227], a[104:107]
  v_mfma_f32_16x16x32_bf16 a[108:111], a[196:199], v[228:231], a[108:111]
  v_mfma_f32_16x16x32_bf16 a[112:115], a[200:203], v[216:219], a[112:115]
  v_mfma_f32_16x16x32_bf16 a[116:119], a[200:203], v[220:223], a[116:119]
  v_add_u32 v16, 256, v0
  v_mfma_f32_16x16x32_bf16 a[120:123], a[200:203], v[224:227], a[120:123]
  v_mul_u32_u24 v17, 6554, v16
  v_mfma_f32_16x16x32_bf16 a[124:127], a[200:203], v[228:231], a[124:127]
  v_mfma_f32_16x16x32_bf16 a[128:131], a[204:207], v[216:219], a[128:131]
  buffer_load_dwordx4 v[216:219], v2, s[40:43], s64 offen offset:3072 sc1
  v_mfma_f32_16x16x32_bf16 a[132:135], a[204:207], v[220:223], a[132:135]
  buffer_load_dwordx4 v[220:223], v2, s[40:43], s65 offen offset:3072 sc1
  v_mfma_f32_16x16x32_bf16 a[136:139], a[204:207], v[224:227], a[136:139]
  buffer_load_dwordx4 v[224:227], v2, s[40:43], s66 offen offset:3072 sc1
  v_mfma_f32_16x16x32_bf16 a[140:143], a[204:207], v[228:231], a[140:143]
  buffer_load_dwordx4 v[228:231], v2, s[40:43], s67 offen offset:3072 sc1
  s_waitcnt vmcnt(18)
  v_mfma_f32_16x16x32_bf16 a[64:67], a[208:211], a[144:147], a[64:67]
  s_add_u32 s64, s64, 4096
  v_lshrrev_b32 v17, 16, v17
  v_mfma_f32_16x16x32_bf16 a[68:71], a[208:211], a[148:151], a[68:71]
  s_add_u32 s65, s65, 4096
  v_mfma_f32_16x16x32_bf16 a[72:75], a[208:211], a[152:155], a[72:75]
  s_add_u32 s66, s66, 4096
  v_mul_u32_u24 v18, 10, v17
  v_mfma_f32_16x16x32_bf16 a[76:79], a[208:211], a[156:159], a[76:79]
  buffer_load_dwordx4 a[36:39], v2, s[40:43], s13 offen offset:1024 sc1
  v_mfma_f32_16x16x32_bf16 a[80:83], a[212:215], a[144:147], a[80:83]
  v_mfma_f32_16x16x32_bf16 a[84:87], a[212:215], a[148:151], a[84:87]
  v_sub_u32 v18, v16, v18
  v_mfma_f32_16x16x32_bf16 a[88:91], a[212:215], a[152:155], a[88:91]
  s_add_u32 s67, s67, 4096
  v_mul_u32_u24 v252, 336, v17
  v_mfma_f32_16x16x32_bf16 a[92:95], a[212:215], a[156:159], a[92:95]
  buffer_load_dwordx4 a[40:43], v2, s[40:43], s13 offen offset:2048 sc1
  v_mfma_f32_16x16x32_bf16 a[96:99], a[216:219], a[144:147], a[96:99]
  v_mfma_f32_16x16x32_bf16 a[100:103], a[216:219], a[148:151], a[100:103]
  v_lshl_add_u32 v252, v18, 5, v252
  v_mfma_f32_16x16x32_bf16 a[104:107], a[216:219], a[152:155], a[104:107]
  v_mfma_f32_16x16x32_bf16 a[108:111], a[216:219], a[156:159], a[108:111]
  v_mfma_f32_16x16x32_bf16 a[112:115], a[220:223], a[144:147], a[112:115]
  v_mfma_f32_16x16x32_bf16 a[116:119], a[220:223], a[148:151], a[116:119]
  v_lshlrev_b32 v204, 5, v18
  v_mfma_f32_16x16x32_bf16 a[120:123], a[220:223], a[152:155], a[120:123]
  v_add_u32 v17, s25, v17
  v_mfma_f32_16x16x32_bf16 a[124:127], a[220:223], a[156:159], a[124:127]
  v_mfma_f32_16x16x32_bf16 a[128:131], a[224:227], a[144:147], a[128:131]
  buffer_load_dwordx4 a[144:147], v2, s[40:43], s64 offen offset:0 sc1
  v_mfma_f32_16x16x32_bf16 a[132:135], a[224:227], a[148:151], a[132:135]
  buffer_load_dwordx4 a[148:151], v2, s[40:43], s65 offen offset:0 sc1
  v_mfma_f32_16x16x32_bf16 a[136:139], a[224:227], a[152:155], a[136:139]
  buffer_load_dwordx4 a[152:155], v2, s[40:43], s66 offen offset:0 sc1
  v_mfma_f32_16x16x32_bf16 a[140:143], a[224:227], a[156:159], a[140:143]
  buffer_load_dwordx4 a[156:159], v2, s[40:43], s67 offen offset:0 sc1
  s_waitcnt vmcnt(18)
  v_mfma_f32_16x16x32_bf16 a[64:67], a[228:231], a[160:163], a[64:67]
  v_add_u32 v25, 1, v17
  v_mfma_f32_16x16x32_bf16 a[68:71], a[228:231], a[164:167], a[68:71]
  v_mfma_f32_16x16x32_bf16 a[72:75], a[228:231], a[168:171], a[72:75]
  v_mul_u32_u24 v249, 1280, v17
  v_mfma_f32_16x16x32_bf16 a[76:79], a[228:231], a[172:175], a[76:79]
  buffer_load_dwordx4 a[44:47], v2, s[40:43], s13 offen offset:3072 sc1
  v_mfma_f32_16x16x32_bf16 a[80:83], a[232:235], a[160:163], a[80:83]
  s_add_u32 s13, s13, 4096
  v_mfma_f32_16x16x32_bf16 a[84:87], a[232:235], a[164:167], a[84:87]
  v_lshl_add_u32 v249, v18, 4, v249
  v_mfma_f32_16x16x32_bf16 a[88:91], a[232:235], a[168:171], a[88:91]
  v_add_u32 v249, s26, v249
  v_mfma_f32_16x16x32_bf16 a[92:95], a[232:235], a[172:175], a[92:95]
  buffer_load_dwordx4 a[48:51], v2, s[40:43], s13 offen offset:0 sc1
  v_mfma_f32_16x16x32_bf16 a[96:99], a[236:239], a[160:163], a[96:99]
  v_mfma_f32_16x16x32_bf16 a[100:103], a[236:239], a[164:167], a[100:103]
  v_lshrrev_b32 v19, 4, v17
  v_mfma_f32_16x16x32_bf16 a[104:107], a[236:239], a[168:171], a[104:107]
  v_mfma_f32_16x16x32_bf16 a[108:111], a[236:239], a[172:175], a[108:111]
  v_mfma_f32_16x16x32_bf16 a[112:115], a[240:243], a[160:163], a[112:115]
  v_mfma_f32_16x16x32_bf16 a[116:119], a[240:243], a[164:167], a[116:119]
  v_mul_u32_u24 v19, 20480, v19
  v_mfma_f32_16x16x32_bf16 a[120:123], a[240:243], a[168:171], a[120:123]
  v_and_b32 v17, 15, v17
  v_mfma_f32_16x16x32_bf16 a[124:127], a[240:243], a[172:175], a[124:127]
  v_mfma_f32_16x16x32_bf16 a[128:131], a[244:247], a[160:163], a[128:131]
  buffer_load_dwordx4 a[160:163], v2, s[40:43], s64 offen offset:1024 sc1
  v_mfma_f32_16x16x32_bf16 a[132:135], a[244:247], a[164:167], a[132:135]
  buffer_load_dwordx4 a[164:167], v2, s[40:43], s65 offen offset:1024 sc1
  v_mfma_f32_16x16x32_bf16 a[136:139], a[244:247], a[168:171], a[136:139]
  buffer_load_dwordx4 a[168:171], v2, s[40:43], s66 offen offset:1024 sc1
  v_mfma_f32_16x16x32_bf16 a[140:143], a[244:247], a[172:175], a[140:143]
  buffer_load_dwordx4 a[172:175], v2, s[40:43], s67 offen offset:1024 sc1
  s_waitcnt vmcnt(18)
  v_mfma_f32_16x16x32_bf16 a[64:67], a[248:251], a[176:179], a[64:67]
  v_lshl_add_u32 v19, v17, 4, v19
  v_mfma_f32_16x16x32_bf16 a[68:71], a[248:251], a[180:183], a[68:71]
  v_mfma_f32_16x16x32_bf16 a[72:75], a[248:251], a[184:187], a[72:75]
  v_lshl_add_u32 v201, v18, 8, v19
  v_mfma_f32_16x16x32_bf16 a[76:79], a[248:251], a[188:191], a[76:79]
  buffer_load_dwordx4 a[52:55], v2, s[40:43], s13 offen offset:1024 sc1
  v_mfma_f32_16x16x32_bf16 a[80:83], a[252:255], a[176:179], a[80:83]
  v_mfma_f32_16x16x32_bf16 a[84:87], a[252:255], a[180:183], a[84:87]
  v_mov_b32 v28, 8
  v_mfma_f32_16x16x32_bf16 a[88:91], a[252:255], a[184:187], a[88:91]
  v_add_u32 v16, 512, v0
  v_mfma_f32_16x16x32_bf16 a[92:95], a[252:255], a[188:191], a[92:95]
  buffer_load_dwordx4 a[56:59], v2, s[40:43], s13 offen offset:2048 sc1
  v_mfma_f32_16x16x32_bf16 a[96:99], v[32:35], a[176:179], a[96:99]
  v_mfma_f32_16x16x32_bf16 a[100:103], v[32:35], a[180:183], a[100:103]
  v_mul_u32_u24 v17, 6554, v16
  v_mfma_f32_16x16x32_bf16 a[104:107], v[32:35], a[184:187], a[104:107]
  v_mfma_f32_16x16x32_bf16 a[108:111], v[32:35], a[188:191], a[108:111]
  v_mfma_f32_16x16x32_bf16 a[112:115], v[36:39], a[176:179], a[112:115]
  v_mfma_f32_16x16x32_bf16 a[116:119], v[36:39], a[180:183], a[116:119]
  v_lshrrev_b32 v17, 16, v17
  v_mfma_f32_16x16x32_bf16 a[120:123], v[36:39], a[184:187], a[120:123]
  v_mul_u32_u24 v18, 10, v17
  v_mfma_f32_16x16x32_bf16 a[124:127], v[36:39], a[188:191], a[124:127]
  v_mfma_f32_16x16x32_bf16 a[128:131], v[40:43], a[176:179], a[128:131]
  buffer_load_dwordx4 a[176:179], v2, s[40:43], s64 offen offset:2048 sc1
  v_mfma_f32_16x16x32_bf16 a[132:135], v[40:43], a[180:183], a[132:135]
  buffer_load_dwordx4 a[180:183], v2, s[40:43], s65 offen offset:2048 sc1
  v_mfma_f32_16x16x32_bf16 a[136:139], v[40:43], a[184:187], a[136:139]
  buffer_load_dwordx4 a[184:187], v2, s[40:43], s66 offen offset:2048 sc1
  v_mfma_f32_16x16x32_bf16 a[140:143], v[40:43], a[188:191], a[140:143]
  buffer_load_dwordx4 a[188:191], v2, s[40:43], s67 offen offset:2048 sc1
  s_waitcnt vmcnt(18)
  v_mfma_f32_16x16x32_bf16 a[64:67], v[44:47], v[216:219], a[64:67]
  v_sub_u32 v18, v16, v18
  v_mfma_f32_16x16x32_bf16 a[68:71], v[44:47], v[220:223], a[68:71]
  v_mfma_f32_16x16x32_bf16 a[72:75], v[44:47], v[224:227], a[72:75]
  v_mul_u32_u24 v253, 336, v17
  v_mfma_f32_16x16x32_bf16 a[76:79], v[44:47], v[228:231], a[76:79]
  buffer_load_dwordx4 a[60:63], v2, s[40:43], s13 offen offset:3072 sc1
  v_mfma_f32_16x16x32_bf16 a[80:83], v[48:51], v[216:219], a[80:83]
  s_add_u32 s13, s13, 4096
  v_mfma_f32_16x16x32_bf16 a[84:87], v[48:51], v[220:223], a[84:87]
  v_lshl_add_u32 v253, v18, 5, v253
  v_mfma_f32_16x16x32_bf16 a[88:91], v[48:51], v[224:227], a[88:91]
  v_lshlrev_b32 v205, 5, v18
  v_mfma_f32_16x16x32_bf16 a[92:95], v[48:51], v[228:231], a[92:95]
  buffer_load_dwordx4 a[192:195], v2, s[40:43], s13 offen offset:0 sc1
  v_mfma_f32_16x16x32_bf16 a[96:99], v[52:55], v[216:219], a[96:99]
  v_mfma_f32_16x16x32_bf16 a[100:103], v[52:55], v[220:223], a[100:103]
  v_add_u32 v17, s25, v17
  v_mfma_f32_16x16x32_bf16 a[104:107], v[52:55], v[224:227], a[104:107]
  v_mfma_f32_16x16x32_bf16 a[108:111], v[52:55], v[228:231], a[108:111]
  v_mfma_f32_16x16x32_bf16 a[112:115], v[56:59], v[216:219], a[112:115]
  v_mfma_f32_16x16x32_bf16 a[116:119], v[56:59], v[220:223], a[116:119]
  v_add_u32 v26, 1, v17
  v_mfma_f32_16x16x32_bf16 a[120:123], v[56:59], v[224:227], a[120:123]
  v_mul_u32_u24 v250, 1280, v17
  v_mfma_f32_16x16x32_bf16 a[124:127], v[56:59], v[228:231], a[124:127]
  v_mfma_f32_16x16x32_bf16 a[128:131], v[60:63], v[216:219], a[128:131]
  buffer_load_dwordx4 v[216:219], v2, s[40:43], s64 offen offset:3072 sc1
  v_mfma_f32_16x16x32_bf16 a[132:135], v[60:63], v[220:223], a[132:135]
  buffer_load_dwordx4 v[220:223], v2, s[40:43], s65 offen offset:3072 sc1
  v_mfma_f32_16x16x32_bf16 a[136:139], v[60:63], v[224:227], a[136:139]
  buffer_load_dwordx4 v[224:227], v2, s[40:43], s66 offen offset:3072 sc1
  v_mfma_f32_16x16x32_bf16 a[140:143], v[60:63], v[228:231], a[140:143]
  buffer_load_dwordx4 v[228:231], v2, s[40:43], s67 offen offset:3072 sc1
  s_waitcnt vmcnt(18)
  v_mfma_f32_16x16x32_bf16 a[64:67], v[96:99], a[144:147], a[64:67]
  s_add_u32 s64, s64, 4096
  v_lshl_add_u32 v250, v18, 4, v250
  v_mfma_f32_16x16x32_bf16 a[68:71], v[96:99], a[148:151], a[68:71]
  s_add_u32 s65, s65, 4096
  v_mfma_f32_16x16x32_bf16 a[72:75], v[96:99], a[152:155], a[72:75]
  s_add_u32 s66, s66, 4096
  v_add_u32 v250, s26, v250
  v_mfma_f32_16x16x32_bf16 a[76:79], v[96:99], a[156:159], a[76:79]
  buffer_load_dwordx4 a[196:199], v2, s[40:43], s13 offen offset:1024 sc1
  v_mfma_f32_16x16x32_bf16 a[80:83], v[100:103], a[144:147], a[80:83]
  v_mfma_f32_16x16x32_bf16 a[84:87], v[100:103], a[148:151], a[84:87]
  v_lshrrev_b32 v19, 4, v17
  v_mfma_f32_16x16x32_bf16 a[88:91], v[100:103], a[152:155], a[88:91]
  s_add_u32 s67, s67, 4096
  v_mul_u32_u24 v19, 20480, v19
  v_mfma_f32_16x16x32_bf16 a[92:95], v[100:103], a[156:159], a[92:95]
  buffer_load_dwordx4 a[200:203], v2, s[40:43], s13 offen offset:2048 sc1
  v_mfma_f32_16x16x32_bf16 a[96:99], v[104:107], a[144:147], a[96:99]
  v_mfma_f32_16x16x32_bf16 a[100:103], v[104:107], a[148:151], a[100:103]
  v_and_b32 v17, 15, v17
  v_mfma_f32_16x16x32_bf16 a[104:107], v[104:107], a[152:155], a[104:107]
  v_mfma_f32_16x16x32_bf16 a[108:111], v[104:107], a[156:159], a[108:111]
  v_mfma_f32_16x16x32_bf16 a[112:115], v[108:111], a[144:147], a[112:115]
  v_mfma_f32_16x16x32_bf16 a[116:119], v[108:111], a[148:151], a[116:119]
  v_lshl_add_u32 v19, v17, 4, v19
  v_mfma_f32_16x16x32_bf16 a[120:123], v[108:111], a[152:155], a[120:123]
  v_lshl_add_u32 v202, v18, 8, v19
  v_mfma_f32_16x16x32_bf16 a[124:127], v[108:111], a[156:159], a[124:127]
  v_mfma_f32_16x16x32_bf16 a[128:131], v[112:115], a[144:147], a[128:131]
  buffer_load_dwordx4 a[144:147], v2, s[40:43], s64 offen offset:0 sc1
  v_mfma_f32_16x16x32_bf16 a[132:135], v[112:115], a[148:151], a[132:135]
  buffer_load_dwordx4 a[148:151], v2, s[40:43], s65 offen offset:0 sc1
  v_mfma_f32_16x16x32_bf16 a[136:139], v[112:115], a[152:155], a[136:139]
  buffer_load_dwordx4 a[152:155], v2, s[40:43], s66 offen offset:0 sc1
  v_mfma_f32_16x16x32_bf16 a[140:143], v[112:115], a[156:159], a[140:143]
  buffer_load_dwordx4 a[156:159], v2, s[40:43], s67 offen offset:0 sc1
  s_waitcnt vmcnt(18)
  v_mfma_f32_16x16x32_bf16 a[64:67], v[116:119], a[160:163], a[64:67]
  v_mov_b32 v29, 8
  v_mfma_f32_16x16x32_bf16 a[68:71], v[116:119], a[164:167], a[68:71]
  v_mfma_f32_16x16x32_bf16 a[72:75], v[116:119], a[168:171], a[72:75]
  v_cmp_gt_u32 vcc, 128, v0
  v_mfma_f32_16x16x32_bf16 a[76:79], v[116:119], a[172:175], a[76:79]
  buffer_load_dwordx4 a[204:207], v2, s[40:43], s13 offen offset:3072 sc1
  v_mfma_f32_16x16x32_bf16 a[80:83], v[120:123], a[160:163], a[80:83]
  s_add_u32 s13, s13, 4096
  v_mfma_f32_16x16x32_bf16 a[84:87], v[120:123], a[164:167], a[84:87]
  v_mov_b32 v16, 1073741824
  v_mfma_f32_16x16x32_bf16 a[88:91], v[120:123], a[168:171], a[88:91]
  v_mov_b32 v17, 0
  v_mfma_f32_16x16x32_bf16 a[92:95], v[120:123], a[172:175], a[92:95]
  buffer_load_dwordx4 a[208:211], v2, s[40:43], s13 offen offset:0 sc1
  v_mfma_f32_16x16x32_bf16 a[96:99], v[124:127], a[160:163], a[96:99]
  v_mfma_f32_16x16x32_bf16 a[100:103], v[124:127], a[164:167], a[100:103]
  v_cndmask_b32 v250, v16, v250, vcc
  v_mfma_f32_16x16x32_bf16 a[104:107], v[124:127], a[168:171], a[104:107]
  v_mfma_f32_16x16x32_bf16 a[108:111], v[124:127], a[172:175], a[108:111]
  v_mfma_f32_16x16x32_bf16 a[112:115], v[160:163], a[160:163], a[112:115]
  v_mfma_f32_16x16x32_bf16 a[116:119], v[160:163], a[164:167], a[116:119]
  v_cndmask_b32 v202, v16, v202, vcc
  v_mfma_f32_16x16x32_bf16 a[120:123], v[160:163], a[168:171], a[120:123]
  v_cndmask_b32 v253, v17, v253, vcc
  v_mfma_f32_16x16x32_bf16 a[124:127], v[160:163], a[172:175], a[124:127]
  v_mfma_f32_16x16x32_bf16 a[128:131], v[164:167], a[160:163], a[128:131]
  buffer_load_dwordx4 a[160:163], v2, s[40:43], s64 offen offset:1024 sc1
  v_mfma_f32_16x16x32_bf16 a[132:135], v[164:167], a[164:167], a[132:135]
  buffer_load_dwordx4 a[164:167], v2, s[40:43], s65 offen offset:1024 sc1
  v_mfma_f32_16x16x32_bf16 a[136:139], v[164:167], a[168:171], a[136:139]
  buffer_load_dwordx4 a[168:171], v2, s[40:43], s66 offen offset:1024 sc1
  v_mfma_f32_16x16x32_bf16 a[140:143], v[164:167], a[172:175], a[140:143]
  buffer_load_dwordx4 a[172:175], v2, s[40:43], s67 offen offset:1024 sc1
  s_waitcnt vmcnt(18)
  v_mfma_f32_16x16x32_bf16 a[64:67], v[168:171], a[176:179], a[64:67]
  v_readlane_b32 s68, v15, 0
  v_mfma_f32_16x16x32_bf16 a[68:71], v[168:171], a[180:183], a[68:71]
  v_mfma_f32_16x16x32_bf16 a[72:75], v[168:171], a[184:187], a[72:75]
  v_readlane_b32 s69, v15, 1
  v_mfma_f32_16x16x32_bf16 a[76:79], v[168:171], a[188:191], a[76:79]
  buffer_load_dwordx4 a[212:215], v2, s[40:43], s13 offen offset:1024 sc1
  v_mfma_f32_16x16x32_bf16 a[80:83], v[172:175], a[176:179], a[80:83]
  v_mfma_f32_16x16x32_bf16 a[84:87], v[172:175], a[180:183], a[84:87]
  v_readlane_b32 s70, v15, 2
  v_mfma_f32_16x16x32_bf16 a[88:91], v[172:175], a[184:187], a[88:91]
  v_readlane_b32 s71, v15, 3
  v_mfma_f32_16x16x32_bf16 a[92:95], v[172:175], a[188:191], a[92:95]
  buffer_load_dwordx4 a[216:219], v2, s[40:43], s13 offen offset:2048 sc1
  v_mfma_f32_16x16x32_bf16 a[96:99], v[192:195], a[176:179], a[96:99]
  v_mfma_f32_16x16x32_bf16 a[100:103], v[192:195], a[180:183], a[100:103]
  v_readlane_b32 s72, v15, 4
  v_mfma_f32_16x16x32_bf16 a[104:107], v[192:195], a[184:187], a[104:107]
  v_mfma_f32_16x16x32_bf16 a[108:111], v[192:195], a[188:191], a[108:111]
  buffer_load_dwordx4 a[220:223], v2, s[40:43], s13 offen offset:3072 sc1
  v_mfma_f32_16x16x32_bf16 a[112:115], v[196:199], a[176:179], a[112:115]
  s_add_u32 s13, s13, 4096
  v_mfma_f32_16x16x32_bf16 a[116:119], v[196:199], a[180:183], a[116:119]
  v_readlane_b32 s73, v15, 5
  v_mfma_f32_16x16x32_bf16 a[120:123], v[196:199], a[184:187], a[120:123]
  v_readlane_b32 s74, v15, 6
  v_mfma_f32_16x16x32_bf16 a[124:127], v[196:199], a[188:191], a[124:127]
  v_mfma_f32_16x16x32_bf16 a[128:131], v[208:211], a[176:179], a[128:131]
  buffer_load_dwordx4 a[176:179], v2, s[40:43], s64 offen offset:2048 sc1
  v_mfma_f32_16x16x32_bf16 a[132:135], v[208:211], a[180:183], a[132:135]
  buffer_load_dwordx4 a[180:183], v2, s[40:43], s65 offen offset:2048 sc1
  v_mfma_f32_16x16x32_bf16 a[136:139], v[208:211], a[184:187], a[136:139]
  buffer_load_dwordx4 a[184:187], v2, s[40:43], s66 offen offset:2048 sc1
  v_mfma_f32_16x16x32_bf16 a[140:143], v[208:211], a[188:191], a[140:143]
  buffer_load_dwordx4 a[188:191], v2, s[40:43], s67 offen offset:2048 sc1
  s_waitcnt vmcnt(19)
  v_mfma_f32_16x16x32_bf16 a[64:67], v[212:215], v[216:219], a[64:67]
  v_readlane_b32 s75, v15, 7
  v_mfma_f32_16x16x32_bf16 a[68:71], v[212:215], v[220:223], a[68:71]
  v_mfma_f32_16x16x32_bf16 a[72:75], v[212:215], v[224:227], a[72:75]
  v_cmp_eq_u32 s[52:53], s68, v24
  v_mfma_f32_16x16x32_bf16 a[76:79], v[212:215], v[228:231], a[76:79]
  buffer_load_dwordx4 a[224:227], v2, s[40:43], s13 offen offset:0 sc1
  v_mfma_f32_16x16x32_bf16 a[80:83], v[232:235], v[216:219], a[80:83]
  v_mfma_f32_16x16x32_bf16 a[84:87], v[232:235], v[220:223], a[84:87]
  v_cmp_eq_u32 s[54:55], s68, v25
  v_mfma_f32_16x16x32_bf16 a[88:91], v[232:235], v[224:227], a[88:91]
  v_cmp_eq_u32 s[56:57], s68, v26
  v_mfma_f32_16x16x32_bf16 a[92:95], v[232:235], v[228:231], a[92:95]
  buffer_load_dwordx4 a[228:231], v2, s[40:43], s13 offen offset:1024 sc1
  v_mfma_f32_16x16x32_bf16 a[96:99], v[236:239], v[216:219], a[96:99]
  v_mfma_f32_16x16x32_bf16 a[100:103], v[236:239], v[220:223], a[100:103]
  v_cndmask_b32 v27, v27, 0, s[52:53]
  v_mfma_f32_16x16x32_bf16 a[104:107], v[236:239], v[224:227], a[104:107]
  v_mfma_f32_16x16x32_bf16 a[108:111], v[236:239], v[228:231], a[108:111]
  v_mfma_f32_16x16x32_bf16 a[112:115], v[240:243], v[216:219], a[112:115]
  v_mfma_f32_16x16x32_bf16 a[116:119], v[240:243], v[220:223], a[116:119]
  v_cndmask_b32 v28, v28, 0, s[54:55]
  v_mfma_f32_16x16x32_bf16 a[120:123], v[240:243], v[224:227], a[120:123]
  v_cndmask_b32 v29, v29, 0, s[56:57]
  v_mfma_f32_16x16x32_bf16 a[124:127], v[240:243], v[228:231], a[124:127]
  v_mfma_f32_16x16x32_bf16 a[128:131], v[244:247], v[216:219], a[128:131]
  buffer_load_dwordx4 v[216:219], v2, s[40:43], s64 offen offset:3072 sc1
  v_mfma_f32_16x16x32_bf16 a[132:135], v[244:247], v[220:223], a[132:135]
  buffer_load_dwordx4 v[220:223], v2, s[40:43], s65 offen offset:3072 sc1
  v_mfma_f32_16x16x32_bf16 a[136:139], v[244:247], v[224:227], a[136:139]
  buffer_load_dwordx4 v[224:227], v2, s[40:43], s66 offen offset:3072 sc1
  v_mfma_f32_16x16x32_bf16 a[140:143], v[244:247], v[228:231], a[140:143]
  buffer_load_dwordx4 v[228:231], v2, s[40:43], s67 offen offset:3072 sc1
  s_waitcnt vmcnt(19)
  v_mfma_f32_16x16x32_bf16 a[64:67], v[64:67], a[144:147], a[64:67]
  s_add_u32 s64, s64, 4096
  v_cmp_eq_u32 s[52:53], s69, v24
  v_mfma_f32_16x16x32_bf16 a[68:71], v[64:67], a[148:151], a[68:71]
  s_add_u32 s65, s65, 4096
  v_mfma_f32_16x16x32_bf16 a[72:75], v[64:67], a[152:155], a[72:75]
  s_add_u32 s66, s66, 4096
  v_cmp_eq_u32 s[54:55], s69, v25
  v_mfma_f32_16x16x32_bf16 a[76:79], v[64:67], a[156:159], a[76:79]
  buffer_load_dwordx4 a[232:235], v2, s[40:43], s13 offen offset:2048 sc1
  v_mfma_f32_16x16x32_bf16 a[80:83], v[68:71], a[144:147], a[80:83]
  v_mfma_f32_16x16x32_bf16 a[84:87], v[68:71], a[148:151], a[84:87]
  v_cmp_eq_u32 s[56:57], s69, v26
  v_mfma_f32_16x16x32_bf16 a[88:91], v[68:71], a[152:155], a[88:91]
  s_add_u32 s67, s67, 4096
  v_cndmask_b32 v27, v27, 1, s[52:53]
  v_mfma_f32_16x16x32_bf16 a[92:95], v[68:71], a[156:159], a[92:95]
  buffer_load_dwordx4 a[236:239], v2, s[40:43], s13 offen offset:3072 sc1
  v_mfma_f32_16x16x32_bf16 a[96:99], v[72:75], a[144:147], a[96:99]
  s_add_u32 s13, s13, 4096
  v_mfma_f32_16x16x32_bf16 a[100:103], v[72:75], a[148:151], a[100:103]
  v_cndmask_b32 v28, v28, 1, s[54:55]
  v_mfma_f32_16x16x32_bf16 a[104:107], v[72:75], a[152:155], a[104:107]
  v_mfma_f32_16x16x32_bf16 a[108:111], v[72:75], a[156:159], a[108:111]
  v_mfma_f32_16x16x32_bf16 a[112:115], v[76:79], a[144:147], a[112:115]
  v_mfma_f32_16x16x32_bf16 a[116:119], v[76:79], a[148:151], a[116:119]
  v_cndmask_b32 v29, v29, 1, s[56:57]
  v_mfma_f32_16x16x32_bf16 a[120:123], v[76:79], a[152:155], a[120:123]
  v_cmp_eq_u32 s[52:53], s70, v24
  v_mfma_f32_16x16x32_bf16 a[124:127], v[76:79], a[156:159], a[124:127]
  v_mfma_f32_16x16x32_bf16 a[128:131], v[80:83], a[144:147], a[128:131]
  buffer_load_dwordx4 a[144:147], v2, s[40:43], s64 offen offset:0 sc1
  v_mfma_f32_16x16x32_bf16 a[132:135], v[80:83], a[148:151], a[132:135]
  buffer_load_dwordx4 a[148:151], v2, s[40:43], s65 offen offset:0 sc1
  v_mfma_f32_16x16x32_bf16 a[136:139], v[80:83], a[152:155], a[136:139]
  buffer_load_dwordx4 a[152:155], v2, s[40:43], s66 offen offset:0 sc1
  v_mfma_f32_16x16x32_bf16 a[140:143], v[80:83], a[156:159], a[140:143]
  buffer_load_dwordx4 a[156:159], v2, s[40:43], s67 offen offset:0 sc1
  s_waitcnt vmcnt(19)
  v_mfma_f32_16x16x32_bf16 a[64:67], v[84:87], a[160:163], a[64:67]
  v_cmp_eq_u32 s[54:55], s70, v25
  v_mfma_f32_16x16x32_bf16 a[68:71], v[84:87], a[164:167], a[68:71]
  v_mfma_f32_16x16x32_bf16 a[72:75], v[84:87], a[168:171], a[72:75]
  v_cmp_eq_u32 s[56:57], s70, v26
  v_mfma_f32_16x16x32_bf16 a[76:79], v[84:87], a[172:175], a[76:79]
  buffer_load_dwordx4 a[240:243], v2, s[40:43], s13 offen offset:0 sc1
  v_mfma_f32_16x16x32_bf16 a[80:83], v[88:91], a[160:163], a[80:83]
  v_mfma_f32_16x16x32_bf16 a[84:87], v[88:91], a[164:167], a[84:87]
  v_cndmask_b32 v27, v27, 2, s[52:53]
  v_mfma_f32_16x16x32_bf16 a[88:91], v[88:91], a[168:171], a[88:91]
  v_cndmask_b32 v28, v28, 2, s[54:55]
  v_mfma_f32_16x16x32_bf16 a[92:95], v[88:91], a[172:175], a[92:95]
  buffer_load_dwordx4 a[244:247], v2, s[40:43], s13 offen offset:1024 sc1
  v_mfma_f32_16x16x32_bf16 a[96:99], v[92:95], a[160:163], a[96:99]
  v_mfma_f32_16x16x32_bf16 a[100:103], v[92:95], a[164:167], a[100:103]
  v_cndmask_b32 v29, v29, 2, s[56:57]
  v_mfma_f32_16x16x32_bf16 a[104:107], v[92:95], a[168:171], a[104:107]
  v_mfma_f32_16x16x32_bf16 a[108:111], v[92:95], a[172:175], a[108:111]
  v_mfma_f32_16x16x32_bf16 a[112:115], v[128:131], a[160:163], a[112:115]
  v_mfma_f32_16x16x32_bf16 a[116:119], v[128:131], a[164:167], a[116:119]
  v_cmp_eq_u32 s[52:53], s71, v24
  v_mfma_f32_16x16x32_bf16 a[120:123], v[128:131], a[168:171], a[120:123]
  v_cmp_eq_u32 s[54:55], s71, v25
  v_mfma_f32_16x16x32_bf16 a[124:127], v[128:131], a[172:175], a[124:127]
  v_mfma_f32_16x16x32_bf16 a[128:131], v[132:135], a[160:163], a[128:131]
  buffer_load_dwordx4 a[160:163], v2, s[40:43], s64 offen offset:1024 sc1
  v_mfma_f32_16x16x32_bf16 a[132:135], v[132:135], a[164:167], a[132:135]
  buffer_load_dwordx4 a[164:167], v2, s[40:43], s65 offen offset:1024 sc1
  v_mfma_f32_16x16x32_bf16 a[136:139], v[132:135], a[168:171], a[136:139]
  buffer_load_dwordx4 a[168:171], v2, s[40:43], s66 offen offset:1024 sc1
  v_mfma_f32_16x16x32_bf16 a[140:143], v[132:135], a[172:175], a[140:143]
  buffer_load_dwordx4 a[172:175], v2, s[40:43], s67 offen offset:1024 sc1
  s_waitcnt vmcnt(18)
  v_mfma_f32_16x16x32_bf16 a[64:67], v[136:139], a[176:179], a[64:67]
  v_cmp_eq_u32 s[56:57], s71, v26
  v_mfma_f32_16x16x32_bf16 a[68:71], v[136:139], a[180:183], a[68:71]
  v_mfma_f32_16x16x32_bf16 a[72:75], v[136:139], a[184:187], a[72:75]
  v_cndmask_b32 v27, v27, 3, s[52:53]
  v_mfma_f32_16x16x32_bf16 a[76:79], v[136:139], a[188:191], a[76:79]
  buffer_load_dwordx4 a[248:251], v2, s[40:43], s13 offen offset:2048 sc1
  v_mfma_f32_16x16x32_bf16 a[80:83], v[140:143], a[176:179], a[80:83]
  v_mfma_f32_16x16x32_bf16 a[84:87], v[140:143], a[180:183], a[84:87]
  v_cndmask_b32 v28, v28, 3, s[54:55]
  v_mfma_f32_16x16x32_bf16 a[88:91], v[140:143], a[184:187], a[88:91]
  v_cndmask_b32 v29, v29, 3, s[56:57]
  v_mfma_f32_16x16x32_bf16 a[92:95], v[140:143], a[188:191], a[92:95]
  buffer_load_dwordx4 a[252:255], v2, s[40:43], s13 offen offset:3072 sc1
  v_mfma_f32_16x16x32_bf16 a[96:99], v[144:147], a[176:179], a[96:99]
  s_add_u32 s13, s13, 4096
  v_mfma_f32_16x16x32_bf16 a[100:103], v[144:147], a[180:183], a[100:103]
  v_cmp_eq_u32 s[52:53], s72, v24
  v_mfma_f32_16x16x32_bf16 a[104:107], v[144:147], a[184:187], a[104:107]
  v_mfma_f32_16x16x32_bf16 a[108:111], v[144:147], a[188:191], a[108:111]
  v_mfma_f32_16x16x32_bf16 a[112:115], v[148:151], a[176:179], a[112:115]
  v_mfma_f32_16x16x32_bf16 a[116:119], v[148:151], a[180:183], a[116:119]
  v_cmp_eq_u32 s[54:55], s72, v25
  v_mfma_f32_16x16x32_bf16 a[120:123], v[148:151], a[184:187], a[120:123]
  v_cmp_eq_u32 s[56:57], s72, v26
  v_mfma_f32_16x16x32_bf16 a[124:127], v[148:151], a[188:191], a[124:127]
  v_mfma_f32_16x16x32_bf16 a[128:131], v[152:155], a[176:179], a[128:131]
  buffer_load_dwordx4 a[176:179], v2, s[40:43], s64 offen offset:2048 sc1
  v_mfma_f32_16x16x32_bf16 a[132:135], v[152:155], a[180:183], a[132:135]
  buffer_load_dwordx4 a[180:183], v2, s[40:43], s65 offen offset:2048 sc1
  v_mfma_f32_16x16x32_bf16 a[136:139], v[152:155], a[184:187], a[136:139]
  buffer_load_dwordx4 a[184:187], v2, s[40:43], s66 offen offset:2048 sc1
  v_mfma_f32_16x16x32_bf16 a[140:143], v[152:155], a[188:191], a[140:143]
  buffer_load_dwordx4 a[188:191], v2, s[40:43], s67 offen offset:2048 sc1
  s_waitcnt vmcnt(18)
  v_mfma_f32_16x16x32_bf16 a[64:67], v[156:159], v[216:219], a[64:67]
  v_cndmask_b32 v27, v27, 4, s[52:53]
  v_mfma_f32_16x16x32_bf16 a[68:71], v[156:159], v[220:223], a[68:71]
  v_mfma_f32_16x16x32_bf16 a[72:75], v[156:159], v[224:227], a[72:75]
  v_cndmask_b32 v28, v28, 4, s[54:55]
  v_mfma_f32_16x16x32_bf16 a[76:79], v[156:159], v[228:231], a[76:79]
  buffer_load_dwordx4 v[32:35], v2, s[40:43], s13 offen offset:0 sc1
  v_mfma_f32_16x16x32_bf16 a[80:83], v[176:179], v[216:219], a[80:83]
  v_mfma_f32_16x16x32_bf16 a[84:87], v[176:179], v[220:223], a[84:87]
  v_cndmask_b32 v29, v29, 4, s[56:57]
  v_mfma_f32_16x16x32_bf16 a[88:91], v[176:179], v[224:227], a[88:91]
  v_cmp_eq_u32 s[52:53], s73, v24
  v_mfma_f32_16x16x32_bf16 a[92:95], v[176:179], v[228:231], a[92:95]
  buffer_load_dwordx4 v[36:39], v2, s[40:43], s13 offen offset:1024 sc1
  v_mfma_f32_16x16x32_bf16 a[96:99], v[180:183], v[216:219], a[96:99]
  v_mfma_f32_16x16x32_bf16 a[100:103], v[180:183], v[220:223], a[100:103]
  v_cmp_eq_u32 s[54:55], s73, v25
  v_mfma_f32_16x16x32_bf16 a[104:107], v[180:183], v[224:227], a[104:107]
  v_mfma_f32_16x16x32_bf16 a[108:111], v[180:183], v[228:231], a[108:111]
  v_mfma_f32_16x16x32_bf16 a[112:115], v[184:187], v[216:219], a[112:115]
  v_mfma_f32_16x16x32_bf16 a[116:119], v[184:187], v[220:223], a[116:119]
  v_cmp_eq_u32 s[56:57], s73, v26
  v_mfma_f32_16x16x32_bf16 a[120:123], v[184:187], v[224:227], a[120:123]
  v_cndmask_b32 v27, v27, 5, s[52:53]
  v_mfma_f32_16x16x32_bf16 a[124:127], v[184:187], v[228:231], a[124:127]
  v_mfma_f32_16x16x32_bf16 a[128:131], v[188:191], v[216:219], a[128:131]
  buffer_load_dwordx4 v[216:219], v2, s[40:43], s64 offen offset:3072 sc1
  v_mfma_f32_16x16x32_bf16 a[132:135], v[188:191], v[220:223], a[132:135]
  buffer_load_dwordx4 v[220:223], v2, s[40:43], s65 offen offset:3072 sc1
  v_mfma_f32_16x16x32_bf16 a[136:139], v[188:191], v[224:227], a[136:139]
  buffer_load_dwordx4 v[224:227], v2, s[40:43], s66 offen offset:3072 sc1
  v_mfma_f32_16x16x32_bf16 a[140:143], v[188:191], v[228:231], a[140:143]
  buffer_load_dwordx4 v[228:231], v2, s[40:43], s67 offen offset:3072 sc1
  s_waitcnt vmcnt(18)
  v_mfma_f32_16x16x32_bf16 a[64:67], a[0:3], a[144:147], a[64:67]
  s_add_u32 s64, s64, 4096
  v_cndmask_b32 v28, v28, 5, s[54:55]
  v_mfma_f32_16x16x32_bf16 a[68:71], a[0:3], a[148:151], a[68:71]
  s_add_u32 s65, s65, 4096
  v_mfma_f32_16x16x32_bf16 a[72:75], a[0:3], a[152:155], a[72:75]
  s_add_u32 s66, s66, 4096
  v_cndmask_b32 v29, v29, 5, s[56:57]
  v_mfma_f32_16x16x32_bf16 a[76:79], a[0:3], a[156:159], a[76:79]
  buffer_load_dwordx4 v[40:43], v2, s[40:43], s13 offen offset:2048 sc1
  v_mfma_f32_16x16x32_bf16 a[80:83], a[4:7], a[144:147], a[80:83]
  v_mfma_f32_16x16x32_bf16 a[84:87], a[4:7], a[148:151], a[84:87]
  v_cmp_eq_u32 s[52:53], s74, v24
  v_mfma_f32_16x16x32_bf16 a[88:91], a[4:7], a[152:155], a[88:91]
  s_add_u32 s67, s67, 4096
  v_cmp_eq_u32 s[54:55], s74, v25
  v_mfma_f32_16x16x32_bf16 a[92:95], a[4:7], a[156:159], a[92:95]
  buffer_load_dwordx4 v[44:47], v2, s[40:43], s13 offen offset:3072 sc1
  v_mfma_f32_16x16x32_bf16 a[96:99], a[8:11], a[144:147], a[96:99]
  s_add_u32 s13, s13, 4096
  v_mfma_f32_16x16x32_bf16 a[100:103], a[8:11], a[148:151], a[100:103]
  v_cmp_eq_u32 s[56:57], s74, v26
  v_mfma_f32_16x16x32_bf16 a[104:107], a[8:11], a[152:155], a[104:107]
  v_mfma_f32_16x16x32_bf16 a[108:111], a[8:11], a[156:159], a[108:111]
  v_mfma_f32_16x16x32_bf16 a[112:115], a[12:15], a[144:147], a[112:115]
  v_mfma_f32_16x16x32_bf16 a[116:119], a[12:15], a[148:151], a[116:119]
  v_cndmask_b32 v27, v27, 6, s[52:53]
  v_mfma_f32_16x16x32_bf16 a[120:123], a[12:15], a[152:155], a[120:123]
  v_cndmask_b32 v28, v28, 6, s[54:55]
  v_mfma_f32_16x16x32_bf16 a[124:127], a[12:15], a[156:159], a[124:127]
  v_mfma_f32_16x16x32_bf16 a[128:131], a[16:19], a[144:147], a[128:131]
  buffer_load_dwordx4 a[144:147], v2, s[40:43], s64 offen offset:0 sc1
  v_mfma_f32_16x16x32_bf16 a[132:135], a[16:19], a[148:151], a[132:135]
  buffer_load_dwordx4 a[148:151], v2, s[40:43], s65 offen offset:0 sc1
  v_mfma_f32_16x16x32_bf16 a[136:139], a[16:19], a[152:155], a[136:139]
  buffer_load_dwordx4 a[152:155], v2, s[40:43], s66 offen offset:0 sc1
  v_mfma_f32_16x16x32_bf16 a[140:143], a[16:19], a[156:159], a[140:143]
  buffer_load_dwordx4 a[156:159], v2, s[40:43], s67 offen offset:0 sc1
  s_waitcnt vmcnt(18)
  v_mfma_f32_16x16x32_bf16 a[64:67], a[20:23], a[160:163], a[64:67]
  v_cndmask_b32 v29, v29, 6, s[56:57]
  v_mfma_f32_16x16x32_bf16 a[68:71], a[20:23], a[164:167], a[68:71]
  v_mfma_f32_16x16x32_bf16 a[72:75], a[20:23], a[168:171], a[72:75]
  v_cmp_eq_u32 s[52:53], s75, v24
  v_mfma_f32_16x16x32_bf16 a[76:79], a[20:23], a[172:175], a[76:79]
  buffer_load_dwordx4 v[48:51], v2, s[40:43], s13 offen offset:0 sc1
  v_mfma_f32_16x16x32_bf16 a[80:83], a[24:27], a[160:163], a[80:83]
  v_mfma_f32_16x16x32_bf16 a[84:87], a[24:27], a[164:167], a[84:87]
  v_cmp_eq_u32 s[54:55], s75, v25
  v_mfma_f32_16x16x32_bf16 a[88:91], a[24:27], a[168:171], a[88:91]
  v_cmp_eq_u32 s[56:57], s75, v26
  v_mfma_f32_16x16x32_bf16 a[92:95], a[24:27], a[172:175], a[92:95]
  buffer_load_dwordx4 v[52:55], v2, s[40:43], s13 offen offset:1024 sc1
  v_mfma_f32_16x16x32_bf16 a[96:99], a[28:31], a[160:163], a[96:99]
  v_mfma_f32_16x16x32_bf16 a[100:103], a[28:31], a[164:167], a[100:103]
  v_cndmask_b32 v27, v27, 7, s[52:53]
  v_mfma_f32_16x16x32_bf16 a[104:107], a[28:31], a[168:171], a[104:107]
  v_mfma_f32_16x16x32_bf16 a[108:111], a[28:31], a[172:175], a[108:111]
  v_mfma_f32_16x16x32_bf16 a[112:115], a[32:35], a[160:163], a[112:115]
  v_mfma_f32_16x16x32_bf16 a[116:119], a[32:35], a[164:167], a[116:119]
  v_cndmask_b32 v28, v28, 7, s[54:55]
  v_mfma_f32_16x16x32_bf16 a[120:123], a[32:35], a[168:171], a[120:123]
  v_cndmask_b32 v29, v29, 7, s[56:57]
  v_mfma_f32_16x16x32_bf16 a[124:127], a[32:35], a[172:175], a[124:127]
  v_mfma_f32_16x16x32_bf16 a[128:131], a[36:39], a[160:163], a[128:131]
  buffer_load_dwordx4 a[160:163], v2, s[40:43], s64 offen offset:1024 sc1
  v_mfma_f32_16x16x32_bf16 a[132:135], a[36:39], a[164:167], a[132:135]
  buffer_load_dwordx4 a[164:167], v2, s[40:43], s65 offen offset:1024 sc1
  v_mfma_f32_16x16x32_bf16 a[136:139], a[36:39], a[168:171], a[136:139]
  buffer_load_dwordx4 a[168:171], v2, s[40:43], s66 offen offset:1024 sc1
  v_mfma_f32_16x16x32_bf16 a[140:143], a[36:39], a[172:175], a[140:143]
  buffer_load_dwordx4 a[172:175], v2, s[40:43], s67 offen offset:1024 sc1
  s_waitcnt vmcnt(18)
  v_mfma_f32_16x16x32_bf16 a[64:67], a[40:43], a[176:179], a[64:67]
  v_mul_u32_u24 v27, 320, v27
  v_mfma_f32_16x16x32_bf16 a[68:71], a[40:43], a[180:183], a[68:71]
  v_mfma_f32_16x16x32_bf16 a[72:75], a[40:43], a[184:187], a[72:75]
  v_add_u32 v203, v203, v27
  v_mfma_f32_16x16x32_bf16 a[76:79], a[40:43], a[188:191], a[76:79]
  buffer_load_dwordx4 v[56:59], v2, s[40:43], s13 offen offset:2048 sc1
  v_mfma_f32_16x16x32_bf16 a[80:83], a[44:47], a[176:179], a[80:83]
  v_mfma_f32_16x16x32_bf16 a[84:87], a[44:47], a[180:183], a[84:87]
  v_add_u32 v203, 155648, v203
  v_mfma_f32_16x16x32_bf16 a[88:91], a[44:47], a[184:187], a[88:91]
  v_mul_u32_u24 v28, 320, v28
  v_mfma_f32_16x16x32_bf16 a[92:95], a[44:47], a[188:191], a[92:95]
  buffer_load_dwordx4 v[60:63], v2, s[40:43], s13 offen offset:3072 sc1
  v_mfma_f32_16x16x32_bf16 a[96:99], a[48:51], a[176:179], a[96:99]
  s_add_u32 s13, s13, 4096
  v_mfma_f32_16x16x32_bf16 a[100:103], a[48:51], a[180:183], a[100:103]
  v_add_u32 v204, v204, v28
  v_mfma_f32_16x16x32_bf16 a[104:107], a[48:51], a[184:187], a[104:107]
  v_mfma_f32_16x16x32_bf16 a[108:111], a[48:51], a[188:191], a[108:111]
  v_mfma_f32_16x16x32_bf16 a[112:115], a[52:55], a[176:179], a[112:115]
  v_mfma_f32_16x16x32_bf16 a[116:119], a[52:55], a[180:183], a[116:119]
  v_add_u32 v204, 155648, v204
  v_mfma_f32_16x16x32_bf16 a[120:123], a[52:55], a[184:187], a[120:123]
  v_mul_u32_u24 v29, 320, v29
  v_mfma_f32_16x16x32_bf16 a[124:127], a[52:55], a[188:191], a[124:127]
  v_mfma_f32_16x16x32_bf16 a[128:131], a[56:59], a[176:179], a[128:131]
  buffer_load_dwordx4 a[176:179], v2, s[40:43], s64 offen offset:2048 sc1
  v_mfma_f32_16x16x32_bf16 a[132:135], a[56:59], a[180:183], a[132:135]
  buffer_load_dwordx4 a[180:183], v2, s[40:43], s65 offen offset:2048 sc1
  v_mfma_f32_16x16x32_bf16 a[136:139], a[56:59], a[184:187], a[136:139]
  buffer_load_dwordx4 a[184:187], v2, s[40:43], s66 offen offset:2048 sc1
  v_mfma_f32_16x16x32_bf16 a[140:143], a[56:59], a[188:191], a[140:143]
  buffer_load_dwordx4 a[188:191], v2, s[40:43], s67 offen offset:2048 sc1
  s_waitcnt vmcnt(18)
  v_mfma_f32_16x16x32_bf16 a[64:67], a[60:63], v[216:219], a[64:67]
  v_add_u32 v205, v205, v29
  v_mfma_f32_16x16x32_bf16 a[68:71], a[60:63], v[220:223], a[68:71]
  v_mfma_f32_16x16x32_bf16 a[72:75], a[60:63], v[224:227], a[72:75]
  v_add_u32 v205, 155648, v205
  v_mfma_f32_16x16x32_bf16 a[76:79], a[60:63], v[228:231], a[76:79]
  buffer_load_dwordx4 v[96:99], v2, s[40:43], s13 offen offset:0 sc1
  v_mfma_f32_16x16x32_bf16 a[80:83], a[192:195], v[216:219], a[80:83]
  v_mfma_f32_16x16x32_bf16 a[84:87], a[192:195], v[220:223], a[84:87]
  v_mfma_f32_16x16x32_bf16 a[88:91], a[192:195], v[224:227], a[88:91]
  v_mfma_f32_16x16x32_bf16 a[92:95], a[192:195], v[228:231], a[92:95]
  buffer_load_dwordx4 v[100:103], v2, s[40:43], s13 offen offset:1024 sc1
  v_mfma_f32_16x16x32_bf16 a[96:99], a[196:199], v[216:219], a[96:99]
  v_mfma_f32_16x16x32_bf16 a[100:103], a[196:199], v[220:223], a[100:103]
  v_mfma_f32_16x16x32_bf16 a[104:107], a[196:199], v[224:227], a[104:107]
  v_mfma_f32_16x16x32_bf16 a[108:111], a[196:199], v[228:231], a[108:111]
  v_mfma_f32_16x16x32_bf16 a[112:115], a[200:203], v[216:219], a[112:115]
  v_mfma_f32_16x16x32_bf16 a[116:119], a[200:203], v[220:223], a[116:119]
  v_mfma_f32_16x16x32_bf16 a[120:123], a[200:203], v[224:227], a[120:123]
  v_mfma_f32_16x16x32_bf16 a[124:127], a[200:203], v[228:231], a[124:127]
  v_mfma_f32_16x16x32_bf16 a[128:131], a[204:207], v[216:219], a[128:131]
  buffer_load_dwordx4 v[216:219], v2, s[40:43], s64 offen offset:3072 sc1
  v_mfma_f32_16x16x32_bf16 a[132:135], a[204:207], v[220:223], a[132:135]
  buffer_load_dwordx4 v[220:223], v2, s[40:43], s65 offen offset:3072 sc1
  v_mfma_f32_16x16x32_bf16 a[136:139], a[204:207], v[224:227], a[136:139]
  buffer_load_dwordx4 v[224:227], v2, s[40:43], s66 offen offset:3072 sc1
  v_mfma_f32_16x16x32_bf16 a[140:143], a[204:207], v[228:231], a[140:143]
  buffer_load_dwordx4 v[228:231], v2, s[40:43], s67 offen offset:3072 sc1
  s_waitcnt vmcnt(18)
  v_mfma_f32_16x16x32_bf16 a[64:67], a[208:211], a[144:147], a[64:67]
  s_add_u32 s64, s64, 4096
  v_mfma_f32_16x16x32_bf16 a[68:71], a[208:211], a[148:151], a[68:71]
  s_add_u32 s65, s65, 4096
  v_mfma_f32_16x16x32_bf16 a[72:75], a[208:211], a[152:155], a[72:75]
  s_add_u32 s66, s66, 4096
  v_mfma_f32_16x16x32_bf16 a[76:79], a[208:211], a[156:159], a[76:79]
  buffer_load_dwordx4 v[104:107], v2, s[40:43], s13 offen offset:2048 sc1
  v_mfma_f32_16x16x32_bf16 a[80:83], a[212:215], a[144:147], a[80:83]
  v_mfma_f32_16x16x32_bf16 a[84:87], a[212:215], a[148:151], a[84:87]
  v_mfma_f32_16x16x32_bf16 a[88:91], a[212:215], a[152:155], a[88:91]
  s_add_u32 s67, s67, 4096
  v_mfma_f32_16x16x32_bf16 a[92:95], a[212:215], a[156:159], a[92:95]
  buffer_load_dwordx4 v[108:111], v2, s[40:43], s13 offen offset:3072 sc1
  v_mfma_f32_16x16x32_bf16 a[96:99], a[216:219], a[144:147], a[96:99]
  s_add_u32 s13, s13, 4096
  v_mfma_f32_16x16x32_bf16 a[100:103], a[216:219], a[148:151], a[100:103]
  v_mfma_f32_16x16x32_bf16 a[104:107], a[216:219], a[152:155], a[104:107]
  v_mfma_f32_16x16x32_bf16 a[108:111], a[216:219], a[156:159], a[108:111]
  v_mfma_f32_16x16x32_bf16 a[112:115], a[220:223], a[144:147], a[112:115]
  v_mfma_f32_16x16x32_bf16 a[116:119], a[220:223], a[148:151], a[116:119]
  v_mfma_f32_16x16x32_bf16 a[120:123], a[220:223], a[152:155], a[120:123]
  v_mfma_f32_16x16x32_bf16 a[124:127], a[220:223], a[156:159], a[124:127]
  v_mfma_f32_16x16x32_bf16 a[128:131], a[224:227], a[144:147], a[128:131]
  buffer_load_dwordx4 a[144:147], v2, s[40:43], s64 offen offset:0 sc1
  v_mfma_f32_16x16x32_bf16 a[132:135], a[224:227], a[148:151], a[132:135]
  buffer_load_dwordx4 a[148:151], v2, s[40:43], s65 offen offset:0 sc1
  v_mfma_f32_16x16x32_bf16 a[136:139], a[224:227], a[152:155], a[136:139]
  buffer_load_dwordx4 a[152:155], v2, s[40:43], s66 offen offset:0 sc1
  v_mfma_f32_16x16x32_bf16 a[140:143], a[224:227], a[156:159], a[140:143]
  buffer_load_dwordx4 a[156:159], v2, s[40:43], s67 offen offset:0 sc1
  s_waitcnt vmcnt(18)
  v_mfma_f32_16x16x32_bf16 a[64:67], a[228:231], a[160:163], a[64:67]
  v_mfma_f32_16x16x32_bf16 a[68:71], a[228:231], a[164:167], a[68:71]
  v_mfma_f32_16x16x32_bf16 a[72:75], a[228:231], a[168:171], a[72:75]
  v_mfma_f32_16x16x32_bf16 a[76:79], a[228:231], a[172:175], a[76:79]
  v_mfma_f32_16x16x32_bf16 a[80:83], a[232:235], a[160:163], a[80:83]
  v_mfma_f32_16x16x32_bf16 a[84:87], a[232:235], a[164:167], a[84:87]
  v_mfma_f32_16x16x32_bf16 a[88:91], a[232:235], a[168:171], a[88:91]
  v_mfma_f32_16x16x32_bf16 a[92:95], a[232:235], a[172:175], a[92:95]
  v_mfma_f32_16x16x32_bf16 a[96:99], a[236:239], a[160:163], a[96:99]
  v_mfma_f32_16x16x32_bf16 a[100:103], a[236:239], a[164:167], a[100:103]
  v_mfma_f32_16x16x32_bf16 a[104:107], a[236:239], a[168:171], a[104:107]
  v_mfma_f32_16x16x32_bf16 a[108:111], a[236:239], a[172:175], a[108:111]
  v_mfma_f32_16x16x32_bf16 a[112:115], a[240:243], a[160:163], a[112:115]
  v_mfma_f32_16x16x32_bf16 a[116:119], a[240:243], a[164:167], a[116:119]
  v_mfma_f32_16x16x32_bf16 a[120:123], a[240:243], a[168:171], a[120:123]
  v_mfma_f32_16x16x32_bf16 a[124:127], a[240:243], a[172:175], a[124:127]
  v_mfma_f32_16x16x32_bf16 a[128:131], a[244:247], a[160:163], a[128:131]
  buffer_load_dwordx4 a[160:163], v2, s[40:43], s64 offen offset:1024 sc1
  v_mfma_f32_16x16x32_bf16 a[132:135], a[244:247], a[164:167], a[132:135]
  buffer_load_dwordx4 a[164:167], v2, s[40:43], s65 offen offset:1024 sc1
  v_mfma_f32_16x16x32_bf16 a[136:139], a[244:247], a[168:171], a[136:139]
  buffer_load_dwordx4 a[168:171], v2, s[40:43], s66 offen offset:1024 sc1
  v_mfma_f32_16x16x32_bf16 a[140:143], a[244:247], a[172:175], a[140:143]
  buffer_load_dwordx4 a[172:175], v2, s[40:43], s67 offen offset:1024 sc1
  s_waitcnt vmcnt(16)
  v_mfma_f32_16x16x32_bf16 a[64:67], a[248:251], a[176:179], a[64:67]
  v_mfma_f32_16x16x32_bf16 a[68:71], a[248:251], a[180:183], a[68:71]
  v_mfma_f32_16x16x32_bf16 a[72:75], a[248:251], a[184:187], a[72:75]
  v_mfma_f32_16x16x32_bf16 a[76:79], a[248:251], a[188:191], a[76:79]
  v_mfma_f32_16x16x32_bf16 a[80:83], a[252:255], a[176:179], a[80:83]
  v_mfma_f32_16x16x32_bf16 a[84:87], a[252:255], a[180:183], a[84:87]
  v_mfma_f32_16x16x32_bf16 a[88:91], a[252:255], a[184:187], a[88:91]
  v_mfma_f32_16x16x32_bf16 a[92:95], a[252:255], a[188:191], a[92:95]
  v_mfma_f32_16x16x32_bf16 a[96:99], v[32:35], a[176:179], a[96:99]
  v_mfma_f32_16x16x32_bf16 a[100:103], v[32:35], a[180:183], a[100:103]
  v_mfma_f32_16x16x32_bf16 a[104:107], v[32:35], a[184:187], a[104:107]
  v_mfma_f32_16x16x32_bf16 a[108:111], v[32:35], a[188:191], a[108:111]
  v_mfma_f32_16x16x32_bf16 a[112:115], v[36:39], a[176:179], a[112:115]
  v_mfma_f32_16x16x32_bf16 a[116:119], v[36:39], a[180:183], a[116:119]
  v_mfma_f32_16x16x32_bf16 a[120:123], v[36:39], a[184:187], a[120:123]
  v_mfma_f32_16x16x32_bf16 a[124:127], v[36:39], a[188:191], a[124:127]
  v_mfma_f32_16x16x32_bf16 a[128:131], v[40:43], a[176:179], a[128:131]
  buffer_load_dwordx4 a[176:179], v2, s[40:43], s64 offen offset:2048 sc1
  v_mfma_f32_16x16x32_bf16 a[132:135], v[40:43], a[180:183], a[132:135]
  buffer_load_dwordx4 a[180:183], v2, s[40:43], s65 offen offset:2048 sc1
  v_mfma_f32_16x16x32_bf16 a[136:139], v[40:43], a[184:187], a[136:139]
  buffer_load_dwordx4 a[184:187], v2, s[40:43], s66 offen offset:2048 sc1
  v_mfma_f32_16x16x32_bf16 a[140:143], v[40:43], a[188:191], a[140:143]
  buffer_load_dwordx4 a[188:191], v2, s[40:43], s67 offen offset:2048 sc1
  s_waitcnt vmcnt(14)
  v_mfma_f32_16x16x32_bf16 a[64:67], v[44:47], v[216:219], a[64:67]
  ds_read_b128 v[112:115], v11 offset:0
  v_mfma_f32_16x16x32_bf16 a[68:71], v[44:47], v[220:223], a[68:71]
  v_mfma_f32_16x16x32_bf16 a[72:75], v[44:47], v[224:227], a[72:75]
  v_mfma_f32_16x16x32_bf16 a[76:79], v[44:47], v[228:231], a[76:79]
  v_mfma_f32_16x16x32_bf16 a[80:83], v[48:51], v[216:219], a[80:83]
  v_mfma_f32_16x16x32_bf16 a[84:87], v[48:51], v[220:223], a[84:87]
  v_mfma_f32_16x16x32_bf16 a[88:91], v[48:51], v[224:227], a[88:91]
  v_mfma_f32_16x16x32_bf16 a[92:95], v[48:51], v[228:231], a[92:95]
  v_mfma_f32_16x16x32_bf16 a[96:99], v[52:55], v[216:219], a[96:99]
  v_mfma_f32_16x16x32_bf16 a[100:103], v[52:55], v[220:223], a[100:103]
  v_mfma_f32_16x16x32_bf16 a[104:107], v[52:55], v[224:227], a[104:107]
  v_mfma_f32_16x16x32_bf16 a[108:111], v[52:55], v[228:231], a[108:111]
  v_mfma_f32_16x16x32_bf16 a[112:115], v[56:59], v[216:219], a[112:115]
  v_mfma_f32_16x16x32_bf16 a[116:119], v[56:59], v[220:223], a[116:119]
  v_mfma_f32_16x16x32_bf16 a[120:123], v[56:59], v[224:227], a[120:123]
  v_mfma_f32_16x16x32_bf16 a[124:127], v[56:59], v[228:231], a[124:127]
  v_mfma_f32_16x16x32_bf16 a[128:131], v[60:63], v[216:219], a[128:131]
  buffer_load_dwordx4 v[216:219], v2, s[40:43], s64 offen offset:3072 sc1
  v_mfma_f32_16x16x32_bf16 a[132:135], v[60:63], v[220:223], a[132:135]
  buffer_load_dwordx4 v[220:223], v2, s[40:43], s65 offen offset:3072 sc1
  v_mfma_f32_16x16x32_bf16 a[136:139], v[60:63], v[224:227], a[136:139]
  buffer_load_dwordx4 v[224:227], v2, s[40:43], s66 offen offset:3072 sc1
  v_mfma_f32_16x16x32_bf16 a[140:143], v[60:63], v[228:231], a[140:143]
  buffer_load_dwordx4 v[228:231], v2, s[40:43], s67 offen offset:3072 sc1
  s_waitcnt vmcnt(12) lgkmcnt(0)
  v_mfma_f32_16x16x32_bf16 a[64:67], v[96:99], a[144:147], a[64:67]
  s_add_u32 s64, s64, 4096
  ds_read_b128 v[116:119], v11 offset:1024
  v_mfma_f32_16x16x32_bf16 a[68:71], v[96:99], a[148:151], a[68:71]
  s_add_u32 s65, s65, 4096
  v_mfma_f32_16x16x32_bf16 a[72:75], v[96:99], a[152:155], a[72:75]
  s_add_u32 s66, s66, 4096
  ds_read_b128 v[120:123], v11 offset:2048
  v_mfma_f32_16x16x32_bf16 a[76:79], v[96:99], a[156:159], a[76:79]
  buffer_load_dwordx4 v[32:35], v248, s[44:47], 0 offen
  v_mfma_f32_16x16x32_bf16 a[80:83], v[100:103], a[144:147], a[80:83]
  ds_read_b128 v[124:127], v11 offset:3072
  v_mfma_f32_16x16x32_bf16 a[84:87], v[100:103], a[148:151], a[84:87]
  buffer_load_dwordx4 v[44:47], v200, s[40:43], s27 offen sc1
  v_mfma_f32_16x16x32_bf16 a[88:91], v[100:103], a[152:155], a[88:91]
  s_add_u32 s67, s67, 4096
  ds_read_b128 v[160:163], v11 offset:4096
  v_mfma_f32_16x16x32_bf16 a[92:95], v[100:103], a[156:159], a[92:95]
  buffer_load_dwordx4 v[36:39], v249, s[44:47], 0 offen
  v_mfma_f32_16x16x32_bf16 a[96:99], v[104:107], a[144:147], a[96:99]
  ds_read_b128 v[164:167], v11 offset:5120
  v_mfma_f32_16x16x32_bf16 a[100:103], v[104:107], a[148:151], a[100:103]
  buffer_load_dwordx4 v[48:51], v201, s[40:43], s27 offen sc1
  v_mfma_f32_16x16x32_bf16 a[104:107], v[104:107], a[152:155], a[104:107]
  v_mfma_f32_16x16x32_bf16 a[108:111], v[104:107], a[156:159], a[108:111]
  buffer_load_dwordx4 v[40:43], v250, s[44:47], 0 offen
  v_mfma_f32_16x16x32_bf16 a[112:115], v[108:111], a[144:147], a[112:115]
  v_mfma_f32_16x16x32_bf16 a[116:119], v[108:111], a[148:151], a[116:119]
  buffer_load_dwordx4 v[52:55], v202, s[40:43], s27 offen sc1
  v_mfma_f32_16x16x32_bf16 a[120:123], v[108:111], a[152:155], a[120:123]
  v_mfma_f32_16x16x32_bf16 a[124:127], v[108:111], a[156:159], a[124:127]
  v_mfma_f32_16x16x32_bf16 a[128:131], v[112:115], a[144:147], a[128:131]
  buffer_load_dwordx4 a[144:147], v2, s[40:43], s64 offen offset:0 sc1
  v_mfma_f32_16x16x32_bf16 a[132:135], v[112:115], a[148:151], a[132:135]
  buffer_load_dwordx4 a[148:151], v2, s[40:43], s65 offen offset:0 sc1
  v_mfma_f32_16x16x32_bf16 a[136:139], v[112:115], a[152:155], a[136:139]
  buffer_load_dwordx4 a[152:155], v2, s[40:43], s66 offen offset:0 sc1
  v_mfma_f32_16x16x32_bf16 a[140:143], v[112:115], a[156:159], a[140:143]
  buffer_load_dwordx4 a[156:159], v2, s[40:43], s67 offen offset:0 sc1
  s_waitcnt vmcnt(18) lgkmcnt(0)
  v_mfma_f32_16x16x32_bf16 a[64:67], v[116:119], a[160:163], a[64:67]
  ds_read_b128 v[168:171], v11 offset:6144
  v_mfma_f32_16x16x32_bf16 a[68:71], v[116:119], a[164:167], a[68:71]
  v_mfma_f32_16x16x32_bf16 a[72:75], v[116:119], a[168:171], a[72:75]
  ds_read_b128 v[172:175], v11 offset:7168
  v_mfma_f32_16x16x32_bf16 a[76:79], v[116:119], a[172:175], a[76:79]
  v_mfma_f32_16x16x32_bf16 a[80:83], v[120:123], a[160:163], a[80:83]
  ds_read_b128 v[192:195], v11 offset:8192
  v_mfma_f32_16x16x32_bf16 a[84:87], v[120:123], a[164:167], a[84:87]
  v_mfma_f32_16x16x32_bf16 a[88:91], v[120:123], a[168:171], a[88:91]
  ds_read_b128 v[196:199], v11 offset:9216
  v_mfma_f32_16x16x32_bf16 a[92:95], v[120:123], a[172:175], a[92:95]
  v_mfma_f32_16x16x32_bf16 a[96:99], v[124:127], a[160:163], a[96:99]
  ds_read_b128 v[208:211], v11 offset:10240
  v_mfma_f32_16x16x32_bf16 a[100:103], v[124:127], a[164:167], a[100:103]
  v_mfma_f32_16x16x32_bf16 a[104:107], v[124:127], a[168:171], a[104:107]
  v_mfma_f32_16x16x32_bf16 a[108:111], v[124:127], a[172:175], a[108:111]
  v_mfma_f32_16x16x32_bf16 a[112:115], v[160:163], a[160:163], a[112:115]
  v_mfma_f32_16x16x32_bf16 a[116:119], v[160:163], a[164:167], a[116:119]
  v_mfma_f32_16x16x32_bf16 a[120:123], v[160:163], a[168:171], a[120:123]
  v_mfma_f32_16x16x32_bf16 a[124:127], v[160:163], a[172:175], a[124:127]
  v_mfma_f32_16x16x32_bf16 a[128:131], v[164:167], a[160:163], a[128:131]
  buffer_load_dwordx4 a[160:163], v2, s[40:43], s64 offen offset:1024 sc1
  v_mfma_f32_16x16x32_bf16 a[132:135], v[164:167], a[164:167], a[132:135]
  buffer_load_dwordx4 a[164:167], v2, s[40:43], s65 offen offset:1024 sc1
  v_mfma_f32_16x16x32_bf16 a[136:139], v[164:167], a[168:171], a[136:139]
  buffer_load_dwordx4 a[168:171], v2, s[40:43], s66 offen offset:1024 sc1
  v_mfma_f32_16x16x32_bf16 a[140:143], v[164:167], a[172:175], a[140:143]
  buffer_load_dwordx4 a[172:175], v2, s[40:43], s67 offen offset:1024 sc1
  s_waitcnt vmcnt(18) lgkmcnt(0)
  v_mfma_f32_16x16x32_bf16 a[64:67], v[168:171], a[176:179], a[64:67]
  ds_read_b128 v[212:215], v11 offset:11264
  v_mfma_f32_16x16x32_bf16 a[68:71], v[168:171], a[180:183], a[68:71]
  v_mfma_f32_16x16x32_bf16 a[72:75], v[168:171], a[184:187], a[72:75]
  ds_read_b128 v[232:235], v11 offset:12288
  v_mfma_f32_16x16x32_bf16 a[76:79], v[168:171], a[188:191], a[76:79]
  v_mfma_f32_16x16x32_bf16 a[80:83], v[172:175], a[176:179], a[80:83]
  ds_read_b128 v[236:239], v11 offset:13312
  v_mfma_f32_16x16x32_bf16 a[84:87], v[172:175], a[180:183], a[84:87]
  v_mfma_f32_16x16x32_bf16 a[88:91], v[172:175], a[184:187], a[88:91]
  ds_read_b128 v[240:243], v11 offset:14336
  v_mfma_f32_16x16x32_bf16 a[92:95], v[172:175], a[188:191], a[92:95]
  v_mfma_f32_16x16x32_bf16 a[96:99], v[192:195], a[176:179], a[96:99]
  ds_read_b128 v[244:247], v11 offset:15360
  v_mfma_f32_16x16x32_bf16 a[100:103], v[192:195], a[180:183], a[100:103]
  v_mfma_f32_16x16x32_bf16 a[104:107], v[192:195], a[184:187], a[104:107]
  v_mfma_f32_16x16x32_bf16 a[108:111], v[192:195], a[188:191], a[108:111]
  v_mfma_f32_16x16x32_bf16 a[112:115], v[196:199], a[176:179], a[112:115]
  v_mfma_f32_16x16x32_bf16 a[116:119], v[196:199], a[180:183], a[116:119]
  v_mfma_f32_16x16x32_bf16 a[120:123], v[196:199], a[184:187], a[120:123]
  v_mfma_f32_16x16x32_bf16 a[124:127], v[196:199], a[188:191], a[124:127]
  v_mfma_f32_16x16x32_bf16 a[128:131], v[208:211], a[176:179], a[128:131]
  buffer_load_dwordx4 a[176:179], v2, s[40:43], s64 offen offset:2048 sc1
  v_mfma_f32_16x16x32_bf16 a[132:135], v[208:211], a[180:183], a[132:135]
  buffer_load_dwordx4 a[180:183], v2, s[40:43], s65 offen offset:2048 sc1
  v_mfma_f32_16x16x32_bf16 a[136:139], v[208:211], a[184:187], a[136:139]
  buffer_load_dwordx4 a[184:187], v2, s[40:43], s66 offen offset:2048 sc1
  v_mfma_f32_16x16x32_bf16 a[140:143], v[208:211], a[188:191], a[140:143]
  buffer_load_dwordx4 a[188:191], v2, s[40:43], s67 offen offset:2048 sc1
  s_waitcnt vmcnt(18) lgkmcnt(0)
  v_mfma_f32_16x16x32_bf16 a[64:67], v[212:215], v[216:219], a[64:67]
  ds_read_b128 v[64:67], v11 offset:16384
  v_mfma_f32_16x16x32_bf16 a[68:71], v[212:215], v[220:223], a[68:71]
  ds_read_b128 v[120:123], v203 offset:0
  v_mfma_f32_16x16x32_bf16 a[72:75], v[212:215], v[224:227], a[72:75]
  ds_read_b128 v[68:71], v11 offset:17408
  v_add_u32 v20, 77824, v251
  v_mfma_f32_16x16x32_bf16 a[76:79], v[212:215], v[228:231], a[76:79]
  ds_read_b128 v[124:127], v203 offset:16
  v_mfma_f32_16x16x32_bf16 a[80:83], v[232:235], v[216:219], a[80:83]
  ds_read_b128 v[72:75], v11 offset:18432
  v_mfma_f32_16x16x32_bf16 a[84:87], v[232:235], v[220:223], a[84:87]
  ds_read_b128 v[160:163], v204 offset:0
  v_mfma_f32_16x16x32_bf16 a[88:91], v[232:235], v[224:227], a[88:91]
  ds_read_b128 v[76:79], v11 offset:19456
  v_add_u32 v21, 77824, v252
  v_mfma_f32_16x16x32_bf16 a[92:95], v[232:235], v[228:231], a[92:95]
  ds_read_b128 v[164:167], v204 offset:16
  v_mfma_f32_16x16x32_bf16 a[96:99], v[236:239], v[216:219], a[96:99]
  ds_read_b128 v[80:83], v11 offset:20480
  v_mfma_f32_16x16x32_bf16 a[100:103], v[236:239], v[220:223], a[100:103]
  ds_read_b128 v[168:171], v205 offset:0
  v_mfma_f32_16x16x32_bf16 a[104:107], v[236:239], v[224:227], a[104:107]
  v_add_u32 v22, 77824, v253
  v_mfma_f32_16x16x32_bf16 a[108:111], v[236:239], v[228:231], a[108:111]
  ds_read_b128 v[172:175], v205 offset:16
  v_mfma_f32_16x16x32_bf16 a[112:115], v[240:243], v[216:219], a[112:115]
  v_mfma_f32_16x16x32_bf16 a[116:119], v[240:243], v[220:223], a[116:119]
  v_mfma_f32_16x16x32_bf16 a[120:123], v[240:243], v[224:227], a[120:123]
  s_mul_i32 s23, s20, 38912
  v_and_b32 v16, 15, v1
  v_mul_u32_u24 v16, 336, v16
  v_mfma_f32_16x16x32_bf16 a[124:127], v[240:243], v[228:231], a[124:127]
  v_lshrrev_b32 v17, 4, v1
  v_lshl_add_u32 v16, v17, 4, v16
  v_mfma_f32_16x16x32_bf16 a[128:131], v[244:247], v[216:219], a[128:131]
  buffer_load_dwordx4 v[216:219], v2, s[40:43], s64 offen offset:3072 sc1
  v_add_u32 v16, s23, v16
  v_mfma_f32_16x16x32_bf16 a[132:135], v[244:247], v[220:223], a[132:135]
  buffer_load_dwordx4 v[220:223], v2, s[40:43], s65 offen offset:3072 sc1
  v_mfma_f32_16x16x32_bf16 a[136:139], v[244:247], v[224:227], a[136:139]
  s_waitcnt lgkmcnt(0)
  buffer_load_dwordx4 v[224:227], v2, s[40:43], s66 offen offset:3072 sc1
  v_mfma_f32_16x16x32_bf16 a[140:143], v[244:247], v[228:231], a[140:143]
  buffer_load_dwordx4 v[228:231], v2, s[40:43], s67 offen offset:3072 sc1
  s_waitcnt vmcnt(12) lgkmcnt(0)
  v_mfma_f32_16x16x32_bf16 a[64:67], v[64:67], a[144:147], a[64:67]
  ds_read_b128 v[84:87], v11 offset:21504
  v_lshlrev_b32 v18, 16, v44
  v_and_b32 v19, 0xffff0000, v44
  v_mfma_f32_16x16x32_bf16 a[68:71], v[64:67], a[148:151], a[68:71]
  v_add_f32 v120, v120, v18
  v_add_f32 v121, v121, v19
  v_mfma_f32_16x16x32_bf16 a[72:75], v[64:67], a[152:155], a[72:75]
  ds_read_b128 v[88:91], v11 offset:22528
  v_cvt_pk_bf16_f32 v18, v120, v121
  v_lshlrev_b32 v96, 16, v32
  v_mfma_f32_16x16x32_bf16 a[76:79], v[64:67], a[156:159], a[76:79]
  v_and_b32 v97, 0xffff0000, v32
  v_lshlrev_b32 v120, 16, v18
  v_mfma_f32_16x16x32_bf16 a[80:83], v[68:71], a[144:147], a[80:83]
  ds_read_b128 v[92:95], v11 offset:23552
  v_and_b32 v121, 0xffff0000, v18
  v_lshlrev_b32 v18, 16, v45
  v_mfma_f32_16x16x32_bf16 a[84:87], v[68:71], a[148:151], a[84:87]
  v_and_b32 v19, 0xffff0000, v45
  v_add_f32 v122, v122, v18
  v_mfma_f32_16x16x32_bf16 a[88:91], v[68:71], a[152:155], a[88:91]
  ds_read_b128 v[128:131], v11 offset:24576
  v_add_f32 v123, v123, v19
  v_cvt_pk_bf16_f32 v18, v122, v123
  v_mfma_f32_16x16x32_bf16 a[92:95], v[68:71], a[156:159], a[92:95]
  v_lshlrev_b32 v98, 16, v33
  v_and_b32 v99, 0xffff0000, v33
  v_mfma_f32_16x16x32_bf16 a[96:99], v[72:75], a[144:147], a[96:99]
  ds_read_b128 v[132:135], v11 offset:25600
  v_lshlrev_b32 v122, 16, v18
  v_and_b32 v123, 0xffff0000, v18
  v_mfma_f32_16x16x32_bf16 a[100:103], v[72:75], a[148:151], a[100:103]
  v_lshlrev_b32 v18, 16, v46
  v_and_b32 v19, 0xffff0000, v46
  v_mfma_f32_16x16x32_bf16 a[104:107], v[72:75], a[152:155], a[104:107]
  v_add_f32 v124, v124, v18
  v_add_f32 v125, v125, v19
  v_mfma_f32_16x16x32_bf16 a[108:111], v[72:75], a[156:159], a[108:111]
  v_cvt_pk_bf16_f32 v18, v124, v125
  v_lshlrev_b32 v100, 16, v34
  v_mfma_f32_16x16x32_bf16 a[112:115], v[76:79], a[144:147], a[112:115]
  v_and_b32 v101, 0xffff0000, v34
  v_lshlrev_b32 v124, 16, v18
  v_mfma_f32_16x16x32_bf16 a[116:119], v[76:79], a[148:151], a[116:119]
  v_and_b32 v125, 0xffff0000, v18
  v_lshlrev_b32 v18, 16, v47
  v_mfma_f32_16x16x32_bf16 a[120:123], v[76:79], a[152:155], a[120:123]
  v_and_b32 v19, 0xffff0000, v47
  v_add_f32 v126, v126, v18
  v_mfma_f32_16x16x32_bf16 a[124:127], v[76:79], a[156:159], a[124:127]
  v_add_f32 v127, v127, v19
  v_cvt_pk_bf16_f32 v18, v126, v127
  v_mfma_f32_16x16x32_bf16 a[128:131], v[80:83], a[144:147], a[128:131]
  v_lshlrev_b32 v102, 16, v35
  v_and_b32 v103, 0xffff0000, v35
  v_mfma_f32_16x16x32_bf16 a[132:135], v[80:83], a[148:151], a[132:135]
  v_lshlrev_b32 v126, 16, v18
  v_and_b32 v127, 0xffff0000, v18
  v_mfma_f32_16x16x32_bf16 a[136:139], v[80:83], a[152:155], a[136:139]
  v_mfma_f32_16x16x32_bf16 a[140:143], v[80:83], a[156:159], a[140:143]
  s_waitcnt vmcnt(8) lgkmcnt(0)
  v_mfma_f32_16x16x32_bf16 a[64:67], v[84:87], a[160:163], a[64:67]
  ds_read_b128 v[136:139], v11 offset:26624
  v_lshlrev_b32 v18, 16, v48
  v_and_b32 v19, 0xffff0000, v48
  v_mfma_f32_16x16x32_bf16 a[68:71], v[84:87], a[164:167], a[68:71]
  v_add_f32 v160, v160, v18
  v_add_f32 v161, v161, v19
  v_mfma_f32_16x16x32_bf16 a[72:75], v[84:87], a[168:171], a[72:75]
  ds_read_b128 v[140:143], v11 offset:27648
  v_cvt_pk_bf16_f32 v18, v160, v161
  v_lshlrev_b32 v104, 16, v36
  v_mfma_f32_16x16x32_bf16 a[76:79], v[84:87], a[172:175], a[76:79]
  v_and_b32 v105, 0xffff0000, v36
  v_lshlrev_b32 v160, 16, v18
  v_mfma_f32_16x16x32_bf16 a[80:83], v[88:91], a[160:163], a[80:83]
  ds_read_b128 v[144:147], v11 offset:28672
  v_and_b32 v161, 0xffff0000, v18
  v_lshlrev_b32 v18, 16, v49
  v_mfma_f32_16x16x32_bf16 a[84:87], v[88:91], a[164:167], a[84:87]
  v_and_b32 v19, 0xffff0000, v49
  v_add_f32 v162, v162, v18
  v_mfma_f32_16x16x32_bf16 a[88:91], v[88:91], a[168:171], a[88:91]
  ds_read_b128 v[148:151], v11 offset:29696
  v_add_f32 v163, v163, v19
  v_cvt_pk_bf16_f32 v18, v162, v163
  v_mfma_f32_16x16x32_bf16 a[92:95], v[88:91], a[172:175], a[92:95]
  v_lshlrev_b32 v106, 16, v37
  v_and_b32 v107, 0xffff0000, v37
  v_mfma_f32_16x16x32_bf16 a[96:99], v[92:95], a[160:163], a[96:99]
  ds_read_b128 v[152:155], v11 offset:30720
  v_lshlrev_b32 v162, 16, v18
  v_and_b32 v163, 0xffff0000, v18
  v_mfma_f32_16x16x32_bf16 a[100:103], v[92:95], a[164:167], a[100:103]
  v_lshlrev_b32 v18, 16, v50
  v_and_b32 v19, 0xffff0000, v50
  v_mfma_f32_16x16x32_bf16 a[104:107], v[92:95], a[168:171], a[104:107]
  v_add_f32 v164, v164, v18
  v_add_f32 v165, v165, v19
  v_mfma_f32_16x16x32_bf16 a[108:111], v[92:95], a[172:175], a[108:111]
  v_cvt_pk_bf16_f32 v18, v164, v165
  v_lshlrev_b32 v108, 16, v38
  v_mfma_f32_16x16x32_bf16 a[112:115], v[128:131], a[160:163], a[112:115]
  v_and_b32 v109, 0xffff0000, v38
  v_lshlrev_b32 v164, 16, v18
  v_mfma_f32_16x16x32_bf16 a[116:119], v[128:131], a[164:167], a[116:119]
  v_and_b32 v165, 0xffff0000, v18
  v_lshlrev_b32 v18, 16, v51
  v_mfma_f32_16x16x32_bf16 a[120:123], v[128:131], a[168:171], a[120:123]
  v_and_b32 v19, 0xffff0000, v51
  v_add_f32 v166, v166, v18
  v_mfma_f32_16x16x32_bf16 a[124:127], v[128:131], a[172:175], a[124:127]
  v_add_f32 v167, v167, v19
  v_cvt_pk_bf16_f32 v18, v166, v167
  v_mfma_f32_16x16x32_bf16 a[128:131], v[132:135], a[160:163], a[128:131]
  v_lshlrev_b32 v110, 16, v39
  v_and_b32 v111, 0xffff0000, v39
  v_mfma_f32_16x16x32_bf16 a[132:135], v[132:135], a[164:167], a[132:135]
  v_lshlrev_b32 v166, 16, v18
  v_and_b32 v167, 0xffff0000, v18
  v_mfma_f32_16x16x32_bf16 a[136:139], v[132:135], a[168:171], a[136:139]
  v_mfma_f32_16x16x32_bf16 a[140:143], v[132:135], a[172:175], a[140:143]
  s_waitcnt vmcnt(4) lgkmcnt(0)
  v_mfma_f32_16x16x32_bf16 a[64:67], v[136:139], a[176:179], a[64:67]
  ds_read_b128 v[156:159], v11 offset:31744
  v_lshlrev_b32 v18, 16, v52
  v_and_b32 v19, 0xffff0000, v52
  v_mfma_f32_16x16x32_bf16 a[68:71], v[136:139], a[180:183], a[68:71]
  v_add_f32 v168, v168, v18
  v_add_f32 v169, v169, v19
  v_mfma_f32_16x16x32_bf16 a[72:75], v[136:139], a[184:187], a[72:75]
  ds_read_b128 v[176:179], v11 offset:32768
  v_cvt_pk_bf16_f32 v18, v168, v169
  v_lshlrev_b32 v112, 16, v40
  v_mfma_f32_16x16x32_bf16 a[76:79], v[136:139], a[188:191], a[76:79]
  v_and_b32 v113, 0xffff0000, v40
  v_lshlrev_b32 v168, 16, v18
  v_mfma_f32_16x16x32_bf16 a[80:83], v[140:143], a[176:179], a[80:83]
  ds_read_b128 v[180:183], v11 offset:33792
  v_and_b32 v169, 0xffff0000, v18
  v_lshlrev_b32 v18, 16, v53
  v_mfma_f32_16x16x32_bf16 a[84:87], v[140:143], a[180:183], a[84:87]
  v_and_b32 v19, 0xffff0000, v53
  v_add_f32 v170, v170, v18
  v_mfma_f32_16x16x32_bf16 a[88:91], v[140:143], a[184:187], a[88:91]
  ds_read_b128 v[184:187], v11 offset:34816
  v_add_f32 v171, v171, v19
  v_cvt_pk_bf16_f32 v18, v170, v171
  v_mfma_f32_16x16x32_bf16 a[92:95], v[140:143], a[188:191], a[92:95]
  v_lshlrev_b32 v114, 16, v41
  v_and_b32 v115, 0xffff0000, v41
  v_mfma_f32_16x16x32_bf16 a[96:99], v[144:147], a[176:179], a[96:99]
  ds_read_b128 v[188:191], v11 offset:35840
  v_lshlrev_b32 v170, 16, v18
  v_and_b32 v171, 0xffff0000, v18
  v_mfma_f32_16x16x32_bf16 a[100:103], v[144:147], a[180:183], a[100:103]
  v_lshlrev_b32 v18, 16, v54
  v_and_b32 v19, 0xffff0000, v54
  v_mfma_f32_16x16x32_bf16 a[104:107], v[144:147], a[184:187], a[104:107]
  v_add_f32 v172, v172, v18
  v_add_f32 v173, v173, v19
  v_mfma_f32_16x16x32_bf16 a[108:111], v[144:147], a[188:191], a[108:111]
  v_cvt_pk_bf16_f32 v18, v172, v173
  v_lshlrev_b32 v116, 16, v42
  v_mfma_f32_16x16x32_bf16 a[112:115], v[148:151], a[176:179], a[112:115]
  v_and_b32 v117, 0xffff0000, v42
  v_lshlrev_b32 v172, 16, v18
  v_mfma_f32_16x16x32_bf16 a[116:119], v[148:151], a[180:183], a[116:119]
  v_and_b32 v173, 0xffff0000, v18
  v_lshlrev_b32 v18, 16, v55
  v_mfma_f32_16x16x32_bf16 a[120:123], v[148:151], a[184:187], a[120:123]
  v_and_b32 v19, 0xffff0000, v55
  v_add_f32 v174, v174, v18
  v_mfma_f32_16x16x32_bf16 a[124:127], v[148:151], a[188:191], a[124:127]
  v_add_f32 v175, v175, v19
  v_cvt_pk_bf16_f32 v18, v174, v175
  v_mfma_f32_16x16x32_bf16 a[128:131], v[152:155], a[176:179], a[128:131]
  v_lshlrev_b32 v118, 16, v43
  v_and_b32 v119, 0xffff0000, v43
  v_mfma_f32_16x16x32_bf16 a[132:135], v[152:155], a[180:183], a[132:135]
  v_lshlrev_b32 v174, 16, v18
  v_and_b32 v175, 0xffff0000, v18
  v_mfma_f32_16x16x32_bf16 a[136:139], v[152:155], a[184:187], a[136:139]
  v_mfma_f32_16x16x32_bf16 a[140:143], v[152:155], a[188:191], a[140:143]
  s_waitcnt vmcnt(0) lgkmcnt(0)
  v_mfma_f32_16x16x32_bf16 a[64:67], v[156:159], v[216:219], a[64:67]
  v_mfma_f32_16x16x32_bf16 a[68:71], v[156:159], v[220:223], a[68:71]
  v_mfma_f32_16x16x32_bf16 a[72:75], v[156:159], v[224:227], a[72:75]
  v_mfma_f32_16x16x32_bf16 a[76:79], v[156:159], v[228:231], a[76:79]
  v_mfma_f32_16x16x32_bf16 a[80:83], v[176:179], v[216:219], a[80:83]
  v_mfma_f32_16x16x32_bf16 a[84:87], v[176:179], v[220:223], a[84:87]
  v_mfma_f32_16x16x32_bf16 a[88:91], v[176:179], v[224:227], a[88:91]
  v_mfma_f32_16x16x32_bf16 a[92:95], v[176:179], v[228:231], a[92:95]
  v_mfma_f32_16x16x32_bf16 a[96:99], v[180:183], v[216:219], a[96:99]
  v_mfma_f32_16x16x32_bf16 a[100:103], v[180:183], v[220:223], a[100:103]
  ds_write_b128 v16, a[64:67] offset:0
  v_mfma_f32_16x16x32_bf16 a[104:107], v[180:183], v[224:227], a[104:107]
  ds_write_b128 v16, a[68:71] offset:5376
  v_mfma_f32_16x16x32_bf16 a[108:111], v[180:183], v[228:231], a[108:111]
  ds_write_b128 v16, a[72:75] offset:10752
  v_mfma_f32_16x16x32_bf16 a[112:115], v[184:187], v[216:219], a[112:115]
  ds_write_b128 v16, a[76:79] offset:16128
  v_mfma_f32_16x16x32_bf16 a[116:119], v[184:187], v[220:223], a[116:119]
  ds_write_b128 v16, a[80:83] offset:64
  v_mfma_f32_16x16x32_bf16 a[120:123], v[184:187], v[224:227], a[120:123]
  ds_write_b128 v16, a[84:87] offset:5440
  v_mfma_f32_16x16x32_bf16 a[124:127], v[184:187], v[228:231], a[124:127]
  ds_write_b128 v16, a[88:91] offset:10816
  v_mfma_f32_16x16x32_bf16 a[128:131], v[188:191], v[216:219], a[128:131]
  ds_write_b128 v16, a[92:95] offset:16192
  v_mfma_f32_16x16x32_bf16 a[132:135], v[188:191], v[220:223], a[132:135]
  ds_write_b128 v16, a[96:99] offset:128
  v_mfma_f32_16x16x32_bf16 a[136:139], v[188:191], v[224:227], a[136:139]
  ds_write_b128 v16, a[100:103] offset:5504
  v_mfma_f32_16x16x32_bf16 a[140:143], v[188:191], v[228:231], a[140:143]
  ds_write_b128 v16, a[104:107] offset:10880
  ds_write_b128 v16, a[108:111] offset:16256
  ds_write_b128 v16, a[112:115] offset:192
  ds_write_b128 v16, a[116:119] offset:5568
  ds_write_b128 v16, a[120:123] offset:10944
  ds_write_b128 v16, a[124:127] offset:16320
  ds_write_b128 v16, a[128:131] offset:256
  ds_write_b128 v16, a[132:135] offset:5632
  ds_write_b128 v16, a[136:139] offset:11008
  ds_write_b128 v16, a[140:143] offset:16384
  s_waitcnt lgkmcnt(0)
  s_barrier
  ds_read_b128 v[32:35], v251 offset:0
  ds_read_b128 v[36:39], v251 offset:16
  ds_read_b128 v[40:43], v251 offset:38912
  ds_read_b128 v[44:47], v251 offset:38928
  ds_read_b128 v[48:51], v20 offset:0
  ds_read_b128 v[52:55], v20 offset:16
  ds_read_b128 v[56:59], v20 offset:38912
  ds_read_b128 v[60:63], v20 offset:38928
  ds_read_b128 v[64:67], v252 offset:0
  ds_read_b128 v[68:71], v252 offset:16
  ds_read_b128 v[72:75], v252 offset:38912
  ds_read_b128 v[76:79], v252 offset:38928
  ds_read_b128 v[80:83], v21 offset:0
  ds_read_b128 v[84:87], v21 offset:16
  ds_read_b128 v[88:91], v21 offset:38912
  ds_read_b128 v[92:95], v21 offset:38928
  ds_read_b128 v[128:131], v253 offset:0
  ds_read_b128 v[132:135], v253 offset:16
  ds_read_b128 v[136:139], v253 offset:38912
  ds_read_b128 v[140:143], v253 offset:38928
  ds_read_b128 v[144:147], v22 offset:0
  ds_read_b128 v[148:151], v22 offset:16
  ds_read_b128 v[152:155], v22 offset:38912
  ds_read_b128 v[156:159], v22 offset:38928
  s_waitcnt lgkmcnt(15)
  v_pk_add_f32 v[32:33], v[32:33], v[40:41]
  v_pk_add_f32 v[48:49], v[48:49], v[56:57]
  v_pk_add_f32 v[34:35], v[34:35], v[42:43]
  v_pk_add_f32 v[50:51], v[50:51], v[58:59]
  v_pk_add_f32 v[36:37], v[36:37], v[44:45]
  v_pk_add_f32 v[52:53], v[52:53], v[60:61]
  v_pk_add_f32 v[38:39], v[38:39], v[46:47]
  v_pk_add_f32 v[54:55], v[54:55], v[62:63]
  v_pk_add_f32 v[32:33], v[32:33], v[48:49]
  v_pk_add_f32 v[34:35], v[34:35], v[50:51]
  v_pk_add_f32 v[36:37], v[36:37], v[52:53]
  v_pk_add_f32 v[38:39], v[38:39], v[54:55]
  v_cvt_pk_bf16_f32 v40, v32, v33
  v_cvt_pk_bf16_f32 v41, v34, v35
  v_cvt_pk_bf16_f32 v42, v36, v37
  v_cvt_pk_bf16_f32 v43, v38, v39
  v_lshlrev_b32 v32, 16, v40
  v_and_b32 v33, 0xffff0000, v40
  v_lshlrev_b32 v34, 16, v41
  v_and_b32 v35, 0xffff0000, v41
  v_lshlrev_b32 v36, 16, v42
  v_and_b32 v37, 0xffff0000, v42
  v_lshlrev_b32 v38, 16, v43
  v_and_b32 v39, 0xffff0000, v43
  v_pk_add_f32 v[32:33], v[32:33], v[96:97]
  v_pk_add_f32 v[34:35], v[34:35], v[98:99]
  v_pk_add_f32 v[36:37], v[36:37], v[100:101]
  v_pk_add_f32 v[38:39], v[38:39], v[102:103]
  v_cvt_pk_bf16_f32 v40, v32, v33
  v_cvt_pk_bf16_f32 v41, v34, v35
  v_cvt_pk_bf16_f32 v42, v36, v37
  v_cvt_pk_bf16_f32 v43, v38, v39
  v_lshlrev_b32 v32, 16, v40
  v_and_b32 v33, 0xffff0000, v40
  v_lshlrev_b32 v34, 16, v41
  v_and_b32 v35, 0xffff0000, v41
  v_lshlrev_b32 v36, 16, v42
  v_and_b32 v37, 0xffff0000, v42
  v_lshlrev_b32 v38, 16, v43
  v_and_b32 v39, 0xffff0000, v43
  v_pk_add_f32 v[32:33], v[32:33], v[120:121]
  v_pk_add_f32 v[34:35], v[34:35], v[122:123]
  v_pk_add_f32 v[36:37], v[36:37], v[124:125]
  v_pk_add_f32 v[38:39], v[38:39], v[126:127]
  v_cvt_pk_bf16_f32 v44, v32, v33
  v_cvt_pk_bf16_f32 v45, v34, v35
  v_cvt_pk_bf16_f32 v46, v36, v37
  v_cvt_pk_bf16_f32 v47, v38, v39
  buffer_store_dwordx4 v[44:47], v248, s[48:51], 0 offen
  s_waitcnt lgkmcnt(8)
  v_pk_add_f32 v[64:65], v[64:65], v[72:73]
  v_pk_add_f32 v[80:81], v[80:81], v[88:89]
  v_pk_add_f32 v[66:67], v[66:67], v[74:75]
  v_pk_add_f32 v[82:83], v[82:83], v[90:91]
  v_pk_add_f32 v[68:69], v[68:69], v[76:77]
  v_pk_add_f32 v[84:85], v[84:85], v[92:93]
  v_pk_add_f32 v[70:71], v[70:71], v[78:79]
  v_pk_add_f32 v[86:87], v[86:87], v[94:95]
  v_pk_add_f32 v[64:65], v[64:65], v[80:81]
  v_pk_add_f32 v[66:67], v[66:67], v[82:83]
  v_pk_add_f32 v[68:69], v[68:69], v[84:85]
  v_pk_add_f32 v[70:71], v[70:71], v[86:87]
  v_cvt_pk_bf16_f32 v72, v64, v65
  v_cvt_pk_bf16_f32 v73, v66, v67
  v_cvt_pk_bf16_f32 v74, v68, v69
  v_cvt_pk_bf16_f32 v75, v70, v71
  v_lshlrev_b32 v64, 16, v72
  v_and_b32 v65, 0xffff0000, v72
  v_lshlrev_b32 v66, 16, v73
  v_and_b32 v67, 0xffff0000, v73
  v_lshlrev_b32 v68, 16, v74
  v_and_b32 v69, 0xffff0000, v74
  v_lshlrev_b32 v70, 16, v75
  v_and_b32 v71, 0xffff0000, v75
  v_pk_add_f32 v[64:65], v[64:65], v[104:105]
  v_pk_add_f32 v[66:67], v[66:67], v[106:107]
  v_pk_add_f32 v[68:69], v[68:69], v[108:109]
  v_pk_add_f32 v[70:71], v[70:71], v[110:111]
  v_cvt_pk_bf16_f32 v72, v64, v65
  v_cvt_pk_bf16_f32 v73, v66, v67
  v_cvt_pk_bf16_f32 v74, v68, v69
  v_cvt_pk_bf16_f32 v75, v70, v71
  v_lshlrev_b32 v64, 16, v72
  v_and_b32 v65, 0xffff0000, v72
  v_lshlrev_b32 v66, 16, v73
  v_and_b32 v67, 0xffff0000, v73
  v_lshlrev_b32 v68, 16, v74
  v_and_b32 v69, 0xffff0000, v74
  v_lshlrev_b32 v70, 16, v75
  v_and_b32 v71, 0xffff0000, v75
  v_pk_add_f32 v[64:65], v[64:65], v[160:161]
  v_pk_add_f32 v[66:67], v[66:67], v[162:163]
  v_pk_add_f32 v[68:69], v[68:69], v[164:165]
  v_pk_add_f32 v[70:71], v[70:71], v[166:167]
  v_cvt_pk_bf16_f32 v76, v64, v65
  v_cvt_pk_bf16_f32 v77, v66, v67
  v_cvt_pk_bf16_f32 v78, v68, v69
  v_cvt_pk_bf16_f32 v79, v70, v71
  buffer_store_dwordx4 v[76:79], v249, s[48:51], 0 offen
  s_waitcnt lgkmcnt(0)
  v_pk_add_f32 v[128:129], v[128:129], v[136:137]
  v_pk_add_f32 v[144:145], v[144:145], v[152:153]
  v_pk_add_f32 v[130:131], v[130:131], v[138:139]
  v_pk_add_f32 v[146:147], v[146:147], v[154:155]
  v_pk_add_f32 v[132:133], v[132:133], v[140:141]
  v_pk_add_f32 v[148:149], v[148:149], v[156:157]
  v_pk_add_f32 v[134:135], v[134:135], v[142:143]
  v_pk_add_f32 v[150:151], v[150:151], v[158:159]
  v_pk_add_f32 v[128:129], v[128:129], v[144:145]
  v_pk_add_f32 v[130:131], v[130:131], v[146:147]
  v_pk_add_f32 v[132:133], v[132:133], v[148:149]
  v_pk_add_f32 v[134:135], v[134:135], v[150:151]
  v_cvt_pk_bf16_f32 v136, v128, v129
  v_cvt_pk_bf16_f32 v137, v130, v131
  v_cvt_pk_bf16_f32 v138, v132, v133
  v_cvt_pk_bf16_f32 v139, v134, v135
  v_lshlrev_b32 v128, 16, v136
  v_and_b32 v129, 0xffff0000, v136
  v_lshlrev_b32 v130, 16, v137
  v_and_b32 v131, 0xffff0000, v137
  v_lshlrev_b32 v132, 16, v138
  v_and_b32 v133, 0xffff0000, v138
  v_lshlrev_b32 v134, 16, v139
  v_and_b32 v135, 0xffff0000, v139
  v_pk_add_f32 v[128:129], v[128:129], v[112:113]
  v_pk_add_f32 v[130:131], v[130:131], v[114:115]
  v_pk_add_f32 v[132:133], v[132:133], v[116:117]
  v_pk_add_f32 v[134:135], v[134:135], v[118:119]
  v_cvt_pk_bf16_f32 v136, v128, v129
  v_cvt_pk_bf16_f32 v137, v130, v131
  v_cvt_pk_bf16_f32 v138, v132, v133
  v_cvt_pk_bf16_f32 v139, v134, v135
  v_lshlrev_b32 v128, 16, v136
  v_and_b32 v129, 0xffff0000, v136
  v_lshlrev_b32 v130, 16, v137
  v_and_b32 v131, 0xffff0000, v137
  v_lshlrev_b32 v132, 16, v138
  v_and_b32 v133, 0xffff0000, v138
  v_lshlrev_b32 v134, 16, v139
  v_and_b32 v135, 0xffff0000, v139
  v_pk_add_f32 v[128:129], v[128:129], v[168:169]
  v_pk_add_f32 v[130:131], v[130:131], v[170:171]
  v_pk_add_f32 v[132:133], v[132:133], v[172:173]
  v_pk_add_f32 v[134:135], v[134:135], v[174:175]
  v_cvt_pk_bf16_f32 v140, v128, v129
  v_cvt_pk_bf16_f32 v141, v130, v131
  v_cvt_pk_bf16_f32 v142, v132, v133
  v_cvt_pk_bf16_f32 v143, v134, v135
  buffer_store_dwordx4 v[140:143], v250, s[48:51], 0 offen
fa_end:
  s_endpgm
fa_hk0:
  s_getpc_b64 s[10:11]
fa_hp0:
  s_add_u32 s8, s8, 4
  s_addc_u32 s9, s9, 0
  s_sub_u32 s10, s10, fa_hp0-fa_hb0
  s_subb_u32 s11, s11, 0
  s_setpc_b64 s[8:9]
fa_hk1:
  s_getpc_b64 s[10:11]
fa_hp1:
  s_add_u32 s8, s8, 4
  s_addc_u32 s9, s9, 0
  s_sub_u32 s10, s10, fa_hp1-fa_hb1
  s_subb_u32 s11, s11, 0
  s_setpc_b64 s[8:9]
fa_hk2:
  s_getpc_b64 s[10:11]
fa_hp2:
  s_add_u32 s8, s8, 4
  s_addc_u32 s9, s9, 0
  s_sub_u32 s10, s10, fa_hp2-fa_hb2
  s_subb_u32 s11, s11, 0
  s_setpc_b64 s[8:9]
fa_hk3:
  s_getpc_b64 s[10:11]
fa_hp3:
  s_add_u32 s8, s8, 4
  s_addc_u32 s9, s9, 0
  s_sub_u32 s10, s10, fa_hp3-fa_hb3
  s_subb_u32 s11, s11, 0
  s_setpc_b64 s[8:9]
fa_ln_spin:
  s_mov_b32 s83, 200000
fa_ln_spin2:
  buffer_load_dword v15, v229, s[56:59], 0 offen sc1
  s_waitcnt vmcnt(0)
  v_cmp_ne_u32 vcc, 0x01010101, v15
  s_cbranch_vccz fa_ln_ok
  s_sleep 8
  s_sub_u32 s83, s83, 1
  s_cmp_lg_u32 s83, 0
  s_cbranch_scc1 fa_ln_spin2
  s_branch fa_ln_ok
fa_co1:
  buffer_load_dword v232, v234, s[32:35], s29 offen
  buffer_store_dword v229, v225, s[40:43], 0 offen sc1
  ds_read_b128 v[160:163], v221 offset:0
  ds_read_b128 v[164:167], v221 offset:4096
  ds_read_b128 v[168:171], v221 offset:8192
  buffer_store_dword v218, v222, s[40:43], 0 offen sc1
  s_waitcnt lgkmcnt(0)
  buffer_store_dwordx4 v[160:163], v223, s[40:43], s66 offen sc1
  buffer_store_dwordx4 v[164:167], v223, s[40:43], s67 offen sc1
  buffer_store_dwordx4 v[168:171], v224, s[40:43], s78 offen sc1
  s_getpc_b64 s[8:9]
  s_setpc_b64 s[10:11]
  s_mov_b32 s48, s60
  s_mov_b32 s49, s61
  s_mov_b32 s50, s75
  s_lshl_b32 s74, s22, 2
  s_add_u32 s74, s74, s20
  s_lshl_b32 s74, s74, 16
  s_mov_b32 s73, 2097152
  v_mov_b32 v213, 1073741824
  v_mov_b32 v214, 1
  v_writelane_b32 v213, s77, 0
  v_lshlrev_b32 v229, 2, v1
  s_and_b32 s23, s21, 3
  s_cbranch_scc0 fa_arr
  s_getpc_b64 s[8:9]
  s_setpc_b64 s[10:11]
fa_arr:
  buffer_store_byte v214, v213, s[56:59], 0 offen sc1
  s_getpc_b64 s[8:9]
  s_setpc_b64 s[10:11]
  buffer_load_dword v15, v229, s[56:59], 0 offen sc1
  s_getpc_b64 s[8:9]
  s_setpc_b64 s[10:11]
  s_mov_b32 s36, s60
  s_mov_b32 s37, s61
  s_mov_b32 s38, s75
  s_lshr_b32 s27, s20, 1
  s_lshl_b32 s27, s27, 18
  s_mov_b32 s25, 524288
  s_mov_b32 s32, s18
  s_mov_b32 s33, s19
  s_mov_b32 s34, 2621440
  s_mov_b32 s26, 0
  s_movk_i32 s79, 1024
  s_lshl_b32 s23, s22, 2
  s_add_u32 s23, s23, s20
  s_mul_i32 s23, s23, 40960
  v_add_u32 v3, s23, v2
  s_sub_u32 s23, 15, s22
  s_lshl_b32 s23, s23, 2
  s_add_u32 s23, s23, s20
  s_mul_i32 s23, s23, 40960
  s_sub_u32 s23, s23, 2048
  v_add_u32 v5, s23, v2
  v_add_u32 v4, 19456, v3
  v_add_u32 v6, 19456, v5
  s_waitcnt vmcnt(8)
  v_cmp_ne_u32 vcc, 0x01010101, v15
  s_cbranch_vccnz fa_ln_spin
fa_ln_ok:
  s_setpc_b64 s[10:11]
fa_kv_spin:
  s_mov_b32 s83, 200000
fa_kv_spin2:
  buffer_load_dword v15, v8, s[40:43], 0 offen sc1
  s_waitcnt vmcnt(0)
  v_cmp_eq_u32 vcc, 0, v15
  s_cbranch_vccz fa_kv_ok
  s_sleep 8
  s_sub_u32 s83, s83, 1
  s_cmp_lg_u32 s83, 0
  s_cbranch_scc1 fa_kv_spin2
  s_branch fa_kv_ok
fa_top8:
  s_cmp_lg_u32 s20, 0
  s_cbranch_scc1 fa_notop
  s_mov_b32 s23, 2621440
  s_mov_b32 s31, 2625536
  buffer_load_dwordx4 v[96:99], v2, s[40:43], s23 offen offset:0 sc1
  buffer_load_dwordx4 v[100:103], v2, s[40:43], s23 offen offset:1024 sc1
  buffer_load_dwordx4 v[104:107], v2, s[40:43], s23 offen offset:2048 sc1
  buffer_load_dwordx4 v[108:111], v2, s[40:43], s23 offen offset:3072 sc1
  buffer_load_dwordx4 v[112:115], v2, s[40:43], s31 offen offset:0 sc1
  buffer_load_dwordx4 v[116:119], v2, s[40:43], s31 offen offset:1024 sc1
  buffer_load_dwordx4 v[120:123], v2, s[40:43], s31 offen offset:2048 sc1
  buffer_load_dwordx4 v[124:127], v2, s[40:43], s31 offen offset:3072 sc1
  v_mov_b32 v21, 0
  v_mov_b32 v22, 0
  v_and_b32 v23, 7, v1
  s_mov_b32 s23, 0
  s_waitcnt vmcnt(0)
fa_top:
  v_max3_u32 v20, v96, v97, v98
  v_max3_u32 v24, v99, v100, v101
  v_max3_u32 v20, v20, v102, v103
  v_max3_u32 v24, v24, v104, v105
  v_max3_u32 v20, v20, v106, v107
  v_max3_u32 v24, v24, v108, v109
  v_max3_u32 v20, v20, v110, v111
  v_max3_u32 v24, v24, v112, v113
  v_max3_u32 v20, v20, v114, v115
  v_max3_u32 v24, v24, v116, v117
  v_max3_u32 v20, v20, v118, v119
  v_max3_u32 v24, v24, v120, v121
  v_max3_u32 v20, v20, v122, v123
  v_max3_u32 v24, v24, v124, v125
  v_max3_u32 v20, v20, v126, v127
  v_max_u32 v20, v20, v24
  s_nop 1
  v_max_u32_dpp v20, v20, v20 quad_perm:[1,0,3,2] row_mask:0xf bank_mask:0xf
  s_nop 1
  v_max_u32_dpp v20, v20, v20 quad_perm:[2,3,0,1] row_mask:0xf bank_mask:0xf
  s_nop 1
  v_max_u32_dpp v20, v20, v20 row_half_mirror row_mask:0xf bank_mask:0xf
  s_nop 1
  v_max_u32_dpp v20, v20, v20 row_mirror row_mask:0xf bank_mask:0xf
  v_mov_b32 v24, v20
  s_nop 1
  v_permlane16_swap_b32 v20, v24
  v_max_u32 v20, v20, v24
  v_mov_b32 v24, v20
  s_nop 1
  v_permlane32_swap_b32 v20, v24
  v_max_u32 v20, v20, v24
  v_add_u32 v21, v21, v20
  v_cmp_eq_u32 vcc, s23, v23
  v_sub_u32 v96, v96, v20
  v_sub_u32 v97, v97, v20
  v_sub_u32 v98, v98, v20
  v_sub_u32 v99, v99, v20
  v_sub_u32 v100, v100, v20
  v_sub_u32 v101, v101, v20
  v_sub_u32 v102, v102, v20
  v_sub_u32 v103, v103, v20
  v_sub_u32 v104, v104, v20
  v_sub_u32 v105, v105, v20
  v_sub_u32 v106, v106, v20
  v_sub_u32 v107, v107, v20
  v_sub_u32 v108, v108, v20
  v_sub_u32 v109, v109, v20
  v_sub_u32 v110, v110, v20
  v_sub_u32 v111, v111, v20
  v_sub_u32 v112, v112, v20
  v_sub_u32 v113, v113, v20
  v_sub_u32 v114, v114, v20
  v_sub_u32 v115, v115, v20
  v_sub_u32 v116, v116, v20
  v_sub_u32 v117, v117, v20
  v_sub_u32 v118, v118, v20
  v_sub_u32 v119, v119, v20
  v_sub_u32 v120, v120, v20
  v_sub_u32 v121, v121, v20
  v_sub_u32 v122, v122, v20
  v_sub_u32 v123, v123, v20
  v_sub_u32 v124, v124, v20
  v_sub_u32 v125, v125, v20
  v_sub_u32 v126, v126, v20
  v_sub_u32 v127, v127, v20
  v_cndmask_b32 v22, v22, v21, vcc
  s_add_u32 s23, s23, 1
  s_cmp_lt_u32 s23, 8
  s_cbranch_scc1 fa_top
  v_and_b32 v25, 0xffff, v22
  v_sub_u32 v25, 0xffff, v25
  v_and_b32 v25, 2047, v25
  v_ashrrev_i32 v20, 31, v22
  v_not_b32 v20, v20
  v_or_b32 v20, 0x80000000, v20
  v_xor_b32 v26, v22, v20
  v_and_b32 v26, 0xffff0000, v26
  v_mul_f32 v26, 0xbfb8aa3b, v26
  v_exp_f32 v26, v26
  s_nop 0
  v_add_f32 v26, 1.0, v26
  v_rcp_f32 v26, v26
  s_nop 0
  v_cvt_pk_bf16_f32 v26, v26, v26
  v_and_b32 v26, 0xffff0000, v26
  v_lshlrev_b32 v20, 2, v1
  v_add_u32 v20, 2629632, v20
  v_mov_b32 v21, 1073741824
  v_cmp_gt_u32 vcc, 16, v1
  v_add_u32 v25, 1, v25
  v_or_b32 v26, 1, v26
  v_cndmask_b32 v20, v21, v20, vcc
  v_cmp_gt_u32 vcc, 8, v1
  s_nop 1
  v_cndmask_b32 v26, v26, v25, vcc
  buffer_store_dword v26, v20, s[40:43], 0 offen sc1
  s_branch fa_notop
fa_hk4:
  s_getpc_b64 s[38:39]
fa_hp4:
  s_add_u32 s36, s36, 4
  s_addc_u32 s37, s37, 0
  s_sub_u32 s38, s38, fa_hp4-fa_hb4
  s_subb_u32 s39, s39, 0
  s_setpc_b64 s[36:37]
fa_hk5:
  s_getpc_b64 s[38:39]
fa_hp5:
  s_add_u32 s36, s36, 4
  s_addc_u32 s37, s37, 0
  s_sub_u32 s38, s38, fa_hp5-fa_hb5
  s_subb_u32 s39, s39, 0
  s_setpc_b64 s[36:37]
fa_hk6:
  s_getpc_b64 s[38:39]
fa_hp6:
  s_add_u32 s36, s36, 4
  s_addc_u32 s37, s37, 0
  s_add_u32 s38, s38, fa_hb6-fa_hp6
  s_addc_u32 s39, s39, 0
  s_setpc_b64 s[36:37]
fa_DDF:
  v_mfma_f32_16x16x32_bf16 v[96:99], a[128:131], v[32:35], v[192:195]
  s_waitcnt vmcnt(12)
  v_exp_f32 v218, v146
  v_mfma_f32_16x16x32_bf16 v[104:107], a[128:131], v[36:39], v[196:199]
  s_barrier
  v_exp_f32 v219, v147
  v_mfma_f32_16x16x32_bf16 v[128:131], a[128:131], v[64:67], v[200:203]
  s_cmp_ge_u32 s26, s32
  ds_read_b128 a[160:163], v3 offset:16384
  v_add_f32 v226, v216, v217
  v_mfma_f32_16x16x32_bf16 v[136:139], a[128:131], v[68:71], v[204:207]
  s_cbranch_scc1 fa_hk6
fa_hb6:
  v_exp_f32 v220, v148
  v_mfma_f32_16x16x32_bf16 v[100:103], a[132:135], v[32:35], v[192:195]
  ds_read_b128 a[164:167], v3 offset:17408
  v_cvt_pk_bf16_f32 v184, v216, v217
  v_mfma_f32_16x16x32_bf16 v[108:111], a[132:135], v[36:39], v[196:199]
  s_mov_b32 m0, s24
  v_exp_f32 v221, v149
  v_mfma_f32_16x16x32_bf16 v[132:135], a[132:135], v[64:67], v[200:203]
  buffer_load_dwordx4 v2, s[44:47], s26 offen offset:0 sc1 lds
  v_add_f32 v226, v226, v218
  v_mfma_f32_16x16x32_bf16 v[140:143], a[132:135], v[68:71], v[204:207]
  v_exp_f32 v222, v150
  v_mfma_f32_16x16x32_bf16 v[96:99], a[136:139], v[40:43], v[96:99]
  ds_read_b128 a[168:171], v3 offset:18432
  v_add_f32 v226, v226, v219
  v_cvt_pk_bf16_f32 v185, v218, v219
  v_mfma_f32_16x16x32_bf16 v[104:107], a[136:139], v[44:47], v[104:107]
  v_exp_f32 v223, v151
  v_mfma_f32_16x16x32_bf16 v[128:131], a[136:139], v[72:75], v[128:131]
  v_add_f32 v226, v226, v220
  v_add_f32 v226, v226, v221
  v_mfma_f32_16x16x32_bf16 v[136:139], a[136:139], v[76:79], v[136:139]
  v_exp_f32 v216, v152
  v_mfma_f32_16x16x32_bf16 v[100:103], a[140:143], v[40:43], v[100:103]
  ds_read_b128 a[172:175], v3 offset:19456
  v_cvt_pk_bf16_f32 v186, v220, v221
  v_mfma_f32_16x16x32_bf16 v[108:111], a[140:143], v[44:47], v[108:111]
  buffer_load_dwordx4 v2, s[44:47], s26 offen offset:1024 sc1 lds
  v_add_f32 v226, v226, v222
  v_mfma_f32_16x16x32_bf16 v[132:135], a[140:143], v[72:75], v[132:135]
  v_exp_f32 v217, v153
  v_mfma_f32_16x16x32_bf16 v[140:143], a[140:143], v[76:79], v[140:143]
  s_waitcnt lgkmcnt(4)
  v_exp_f32 v218, v154
  v_mfma_f32_16x16x32_bf16 v[96:99], a[144:147], v[48:51], v[96:99]
  ds_read_b128 a[176:179], v3 offset:20480
  v_add_f32 v226, v226, v223
  v_mfma_f32_16x16x32_bf16 v[104:107], a[144:147], v[52:55], v[104:107]
  v_exp_f32 v219, v155
  v_mfma_f32_16x16x32_bf16 v[128:131], a[144:147], v[80:83], v[128:131]
  v_cvt_pk_bf16_f32 v187, v222, v223
  v_add_f32 v227, v216, v217
  v_cvt_pk_bf16_f32 v188, v216, v217
  v_mfma_f32_16x16x32_bf16 v[136:139], a[144:147], v[84:87], v[136:139]
  buffer_load_dwordx4 v2, s[44:47], s26 offen offset:2048 sc1 lds
  v_add_f32 v227, v227, v218
  v_mfma_f32_16x16x32_bf16 v[100:103], a[148:151], v[48:51], v[100:103]
  ds_read_b128 a[180:183], v3 offset:21504
  v_add_f32 v227, v227, v219
  v_mfma_f32_16x16x32_bf16 v[108:111], a[148:151], v[52:55], v[108:111]
  v_exp_f32 v220, v156
  v_mfma_f32_16x16x32_bf16 v[132:135], a[148:151], v[80:83], v[132:135]
  v_exp_f32 v221, v157
  v_mfma_f32_16x16x32_bf16 v[140:143], a[148:151], v[84:87], v[140:143]
  v_exp_f32 v222, v158
  v_mfma_f32_16x16x32_bf16 v[96:99], a[152:155], v[56:59], v[96:99]
  ds_read_b128 a[184:187], v3 offset:22528
  v_cvt_pk_bf16_f32 v189, v218, v219
  v_mfma_f32_16x16x32_bf16 v[104:107], a[152:155], v[60:63], v[104:107]
  buffer_load_dwordx4 v2, s[44:47], s26 offen offset:3072 sc1 lds
  v_add_f32 v227, v227, v220
  v_add_f32 v227, v227, v221
  v_mfma_f32_16x16x32_bf16 v[128:131], a[152:155], v[88:91], v[128:131]
  s_add_u32 s26, s26, 16384
  v_exp_f32 v223, v159
  v_mfma_f32_16x16x32_bf16 v[136:139], a[152:155], v[92:95], v[136:139]
  s_add_u32 s24, s24, 32768
  v_exp_f32 v208, v112
  v_mfma_f32_16x16x32_bf16 v[100:103], a[156:159], v[56:59], v[100:103]
  s_and_b32 s24, s24, 0x1ffff
  ds_read_b128 a[188:191], v3 offset:23552
  v_cvt_pk_bf16_f32 v190, v220, v221
  v_mfma_f32_16x16x32_bf16 v[108:111], a[156:159], v[60:63], v[108:111]
  v_exp_f32 v209, v113
  v_mfma_f32_16x16x32_bf16 v[132:135], a[156:159], v[88:91], v[132:135]
  s_add_u32 m0, s34, 0
  v_exp_f32 v210, v114
  v_mfma_f32_16x16x32_bf16 v[140:143], a[156:159], v[92:95], v[140:143]
  s_waitcnt lgkmcnt(4)
  buffer_load_dwordx4 v8, s[52:55], s33 offen offset:0 lds
  v_add_f32 v227, v227, v222
  v_mfma_f32_16x16x32_bf16 a[0:3], a[160:163], v[160:163], a[0:3]
  ds_read_b128 a[128:131], v3 offset:0
  v_add_f32 v227, v227, v223
  v_mfma_f32_16x16x32_bf16 a[4:7], a[160:163], v[164:167], a[4:7]
  v_exp_f32 v211, v115
  v_mfma_f32_16x16x32_bf16 a[64:67], a[160:163], v[176:179], a[64:67]
  v_cvt_pk_bf16_f32 v191, v222, v223
  v_add_f32 v224, v208, v209
  v_cvt_pk_bf16_f32 v168, v208, v209
  v_mfma_f32_16x16x32_bf16 a[68:71], a[160:163], v[180:183], a[68:71]
  v_exp_f32 v212, v116
  v_mfma_f32_16x16x32_bf16 a[8:11], a[164:167], v[160:163], a[8:11]
  ds_read_b128 a[132:135], v3 offset:1024
  v_add_f32 v224, v224, v210
  v_mfma_f32_16x16x32_bf16 a[12:15], a[164:167], v[164:167], a[12:15]
  buffer_load_dwordx4 v11, s[52:55], s33 offen offset:1024 lds
  v_add_f32 v224, v224, v211
  v_mfma_f32_16x16x32_bf16 a[72:75], a[164:167], v[176:179], a[72:75]
  v_exp_f32 v213, v117
  v_mfma_f32_16x16x32_bf16 a[76:79], a[164:167], v[180:183], a[76:79]
  v_exp_f32 v214, v118
  v_mfma_f32_16x16x32_bf16 a[16:19], a[168:171], v[160:163], a[16:19]
  ds_read_b128 a[136:139], v3 offset:2048
  v_cvt_pk_bf16_f32 v169, v210, v211
  v_mfma_f32_16x16x32_bf16 a[20:23], a[168:171], v[164:167], a[20:23]
  v_exp_f32 v215, v119
  v_mfma_f32_16x16x32_bf16 a[80:83], a[168:171], v[176:179], a[80:83]
  v_add_f32 v224, v224, v212
  v_add_f32 v224, v224, v213
  v_cvt_pk_bf16_f32 v170, v212, v213
  v_mfma_f32_16x16x32_bf16 a[84:87], a[168:171], v[180:183], a[84:87]
  buffer_load_dwordx4 v12, s[52:55], s33 offen offset:2048 lds
  v_add_f32 v224, v224, v214
  v_mfma_f32_16x16x32_bf16 a[24:27], a[172:175], v[160:163], a[24:27]
  ds_read_b128 a[140:143], v3 offset:3072
  v_add_f32 v224, v224, v215
  v_mfma_f32_16x16x32_bf16 a[28:31], a[172:175], v[164:167], a[28:31]
  v_exp_f32 v208, v120
  v_mfma_f32_16x16x32_bf16 a[88:91], a[172:175], v[176:179], a[88:91]
  v_exp_f32 v209, v121
  v_mfma_f32_16x16x32_bf16 a[92:95], a[172:175], v[180:183], a[92:95]
  s_waitcnt lgkmcnt(4)
  v_exp_f32 v210, v122
  v_mfma_f32_16x16x32_bf16 a[32:35], a[176:179], v[160:163], a[32:35]
  ds_read_b128 a[144:147], v3 offset:4096
  v_cvt_pk_bf16_f32 v171, v214, v215
  v_mfma_f32_16x16x32_bf16 a[36:39], a[176:179], v[164:167], a[36:39]
  buffer_load_dwordx4 v13, s[52:55], s33 offen offset:3072 lds
  v_add_f32 v225, v208, v209
  v_mfma_f32_16x16x32_bf16 a[96:99], a[176:179], v[176:179], a[96:99]
  v_exp_f32 v211, v123
  v_mfma_f32_16x16x32_bf16 a[100:103], a[176:179], v[180:183], a[100:103]
  v_exp_f32 v212, v124
  v_mfma_f32_16x16x32_bf16 a[40:43], a[180:183], v[160:163], a[40:43]
  ds_read_b128 a[148:151], v3 offset:5120
  v_cvt_pk_bf16_f32 v172, v208, v209
  v_add_f32 v225, v225, v210
  v_mfma_f32_16x16x32_bf16 a[44:47], a[180:183], v[164:167], a[44:47]
  v_exp_f32 v213, v125
  v_mfma_f32_16x16x32_bf16 a[104:107], a[180:183], v[176:179], a[104:107]
  s_add_u32 m0, s34, 4096
  v_add_f32 v225, v225, v211
  v_cvt_pk_bf16_f32 v173, v210, v211
  v_mfma_f32_16x16x32_bf16 a[108:111], a[180:183], v[180:183], a[108:111]
  buffer_load_dwordx4 v14, s[52:55], s33 offen offset:0 lds
  v_max3_f32 v5, v226, v227, v224
  v_mfma_f32_16x16x32_bf16 a[48:51], a[184:187], v[160:163], a[48:51]
  ds_read_b128 a[152:155], v3 offset:6144
  v_add_f32 v225, v225, v212
  v_mfma_f32_16x16x32_bf16 a[52:55], a[184:187], v[164:167], a[52:55]
  v_exp_f32 v214, v126
  v_mfma_f32_16x16x32_bf16 a[112:115], a[184:187], v[176:179], a[112:115]
  v_exp_f32 v215, v127
  v_mfma_f32_16x16x32_bf16 a[116:119], a[184:187], v[180:183], a[116:119]
  v_add_f32 v225, v225, v213
  v_cvt_pk_bf16_f32 v174, v212, v213
  v_add_f32 v225, v225, v214
  v_mfma_f32_16x16x32_bf16 a[56:59], a[188:191], v[160:163], a[56:59]
  ds_read_b128 a[156:159], v3 offset:7168
  v_add_f32 v225, v225, v215
  v_max_f32 v5, v5, v225
  v_cmp_lt_f32 vcc, s81, v5
  v_mfma_f32_16x16x32_bf16 a[60:63], a[188:191], v[164:167], a[60:63]
  v_exp_f32 v216, v128
  v_mfma_f32_16x16x32_bf16 a[120:123], a[188:191], v[176:179], a[120:123]
  s_waitcnt lgkmcnt(4)
  v_cvt_pk_bf16_f32 v175, v214, v215
  v_mfma_f32_16x16x32_bf16 a[124:127], a[188:191], v[180:183], a[124:127]
  s_cbranch_vccnz fa_stub3
fa_back3:
  v_exp_f32 v217, v129
  v_add_f32 v228, v228, v224
  v_add_f32 v229, v229, v225
  v_add_f32 v230, v230, v226
  v_add_f32 v231, v231, v227
  s_branch fa_DDe
fa_kv2_spin:
  s_mov_b32 s83, 200000
fa_kv2_spin2:
  buffer_load_dword v14, v13, s[40:43], 0 offen sc1
  s_waitcnt vmcnt(0)
  v_cmp_eq_u32 vcc, 0, v14
  s_cbranch_vccz fa_kv2_ok
  s_sleep 8
  s_sub_u32 s83, s83, 1
  s_cmp_lg_u32 s83, 0
  s_cbranch_scc1 fa_kv2_spin2
  s_branch fa_kv2_ok
fa_kv3_spin:
  s_mov_b32 s83, 200000
fa_kv3_spin2:
  buffer_load_dword v14, v13, s[40:43], 0 offen sc1
  s_waitcnt vmcnt(0)
  v_cmp_eq_u32 vcc, 0, v14
  s_cbranch_vccz fa_kv3_ok
  s_sleep 8
  s_sub_u32 s83, s83, 1
  s_cmp_lg_u32 s83, 0
  s_cbranch_scc1 fa_kv3_spin2
  s_branch fa_kv3_ok
fa_sel_spin:
  s_mov_b32 s83, 200000
fa_sel_spin2:
  buffer_load_dword v15, v252, s[40:43], 0 offen sc1
  s_waitcnt vmcnt(0)
  v_cmp_eq_u32 vcc, 0, v15
  s_cbranch_vccz fa_sel_ok
  s_sleep 8
  s_sub_u32 s83, s83, 1
  s_cmp_lg_u32 s83, 0
  s_cbranch_scc1 fa_sel_spin2
  s_branch fa_sel_ok
fa_wof_spin:
  s_mov_b32 s83, 200000
fa_wof_spin2:
  buffer_load_dword v8, v9, s[40:43], 0 offen sc1
  s_waitcnt vmcnt(0)
  v_cmp_eq_u32 vcc, 0, v8
  s_cbranch_vccz fa_wof_ok
  s_sleep 8
  s_sub_u32 s83, s83, 1
  s_cmp_lg_u32 s83, 0
  s_cbranch_scc1 fa_wof_spin2
  s_branch fa_wof_ok
fa_sel4_spin:
  s_mov_b32 s83, 200000
fa_sel4_spin2:
  buffer_load_dword v15, v10, s[40:43], 0 offen sc1
  s_waitcnt vmcnt(0)
  v_cmp_eq_u32 vcc, 0, v15
  s_cbranch_vccz fa_sel4_ok
  s_sleep 8
  s_sub_u32 s83, s83, 1
  s_cmp_lg_u32 s83, 0
  s_cbranch_scc1 fa_sel4_spin2
  s_branch fa_sel4_ok
fa_yf_spin:
  s_mov_b32 s83, 200000
fa_yf_spin2:
  buffer_load_dword v14, v11, s[40:43], 0 offen sc1
  s_waitcnt vmcnt(0)
  v_cmp_eq_u32 vcc, 0, v14
  s_cbranch_vccz fa_yf_ok
  s_sleep 8
  s_sub_u32 s83, s83, 1
  s_cmp_lg_u32 s83, 0
  s_cbranch_scc1 fa_yf_spin2
  s_branch fa_yf_ok
fa_co:
  s_sub_u32 s14, s2, 64
  s_cmp_lt_u32 s14, 96
  s_cbranch_scc1 fa_coT
  s_sub_u32 s14, s2, 128
  s_sub_u32 s23, s2, 224
  s_cmp_lt_u32 s23, 31
  s_cbranch_scc1 fa_coT
  v_cmp_eq_u32 vcc, 0, v14
  s_cbranch_vccnz fa_kv2_spin
fa_kv2_ok:
  s_sub_u32 s14, s2, 170
  s_cmp_lt_u32 s14, 54
  s_cbranch_scc1 fa_coF
  s_cmp_eq_u32 s2, 255
  s_cbranch_scc1 fa_coW
  s_branch fa_coO
fa_coT:
  v_min_u32 v8, 16, v1
  v_lshlrev_b32 v8, 7, v8
  s_lshl_b32 s10, s14, 1
  s_and_b32 s31, s20, 1
  s_add_u32 s10, s10, s31
  s_mul_i32 s10, s10, 2176
  s_lshl_b32 s35, s14, 2
  s_add_u32 s35, s35, s20
  s_mul_i32 s35, s35, 4352
  buffer_load_dword v255, v8, s[52:55], s10 offen
  s_add_u32 s10, s10, 552960
  s_getpc_b64 s[36:37]
  s_setpc_b64 s[38:39]
  buffer_load_dword v255, v8, s[52:55], s10 offen
  s_add_u32 s10, s10, 552960
  s_getpc_b64 s[36:37]
  s_setpc_b64 s[38:39]
  v_cmp_eq_u32 vcc, 0, v14
  s_cbranch_vccnz fa_kv3_spin
fa_kv3_ok:
  buffer_load_dword v255, v8, s[52:55], s10 offen
  s_add_u32 s10, s10, 552960
  buffer_load_dword v255, v8, s[60:63], s35 offen offset:0
  s_getpc_b64 s[36:37]
  s_setpc_b64 s[38:39]
  buffer_load_dword v255, v8, s[52:55], s10 offen
  s_add_u32 s10, s10, 552960
  buffer_load_dword v255, v8, s[60:63], s35 offen offset:2176
  s_mov_b32 s9, -1
  s_and_b32 s32, s21, 3
  s_lshr_b32 s32, s32, 1
  s_add_u32 s32, s32, 6
  s_lshl_b32 s32, s32, 14
  s_getpc_b64 s[36:37]
  s_setpc_b64 s[38:39]
fa_coO:
  s_and_b32 s23, s67, 1
  s_lshl_b32 s23, s23, 2
  s_add_u32 s23, s23, s20
  s_lshr_b32 s31, s67, 1
  s_lshl_b32 s30, s23, 7
  s_add_u32 s30, s30, s31
  s_mul_i32 s33, s31, 40960
  s_mul_i32 s23, s23, 160
  s_add_u32 s33, s33, s23
  s_add_u32 m0, s34, 0
  v_accvgpr_read_b32 v19, a248
  buffer_load_dwordx4 v19, s[56:59], s33 offen lds
  s_add_u32 m0, s34, 1024
  v_accvgpr_read_b32 v19, a249
  buffer_load_dwordx4 v19, s[56:59], s33 offen lds
  s_add_u32 m0, s34, 2048
  v_accvgpr_read_b32 v19, a250
  buffer_load_dwordx4 v19, s[56:59], s33 offen lds
  s_add_u32 m0, s34, 3072
  v_accvgpr_read_b32 v19, a251
  buffer_load_dwordx4 v19, s[56:59], s33 offen lds
  s_add_u32 m0, s34, 4096
  v_accvgpr_read_b32 v19, a252
  buffer_load_dwordx4 v19, s[56:59], s33 offen lds
  s_add_u32 s32, s26, 32768
  s_mov_b32 s9, -1
  s_lshl_b32 s10, s30, 2
  s_mul_i32 s30, s30, 5120
  s_add_u32 s30, s30, 4194304
  s_getpc_b64 s[36:37]
  s_setpc_b64 s[38:39]
  s_waitcnt vmcnt(8)
  ds_read_b64_tr_b16 v[232:233], v6 offset:0
  ds_read_b64_tr_b16 v[234:235], v6 offset:2560
  ds_read_b64_tr_b16 v[236:237], v6 offset:32
  ds_read_b64_tr_b16 v[238:239], v6 offset:2592
  ds_read_b64_tr_b16 v[240:241], v6 offset:64
  ds_read_b64_tr_b16 v[242:243], v6 offset:2624
  ds_read_b64_tr_b16 v[244:245], v6 offset:96
  ds_read_b64_tr_b16 v[246:247], v6 offset:2656
  ds_read_b64_tr_b16 v[248:249], v6 offset:128
  ds_read_b64_tr_b16 v[250:251], v6 offset:2688
  s_waitcnt lgkmcnt(0)
  s_add_u32 s31, s30, 4096
  buffer_store_dwordx4 v[232:235], v2, s[40:43], s30 offen offset:0 sc1
  buffer_store_dwordx4 v[236:239], v2, s[40:43], s30 offen offset:1024 sc1
  buffer_store_dwordx4 v[240:243], v2, s[40:43], s30 offen offset:2048 sc1
  buffer_store_dwordx4 v[244:247], v2, s[40:43], s30 offen offset:3072 sc1
  buffer_store_dwordx4 v[248:251], v2, s[40:43], s31 offen offset:0 sc1
  s_getpc_b64 s[36:37]
  s_setpc_b64 s[38:39]
  s_add_u32 s23, s10, 2654208
  s_waitcnt vmcnt(8)
  buffer_store_dword v4, off, s[40:43], s23 sc1
  s_sub_u32 s23, s67, 96
  s_cmp_gt_u32 s23, 54
  s_cbranch_scc1 fa_coW
  s_add_u32 s67, s23, 170
  s_cmp_eq_u32 s67, 224
  s_cselect_b32 s67, 255, s67
  s_branch fa_coO
fa_coF:
  v_and_b32 v16, 7, v1
  v_lshlrev_b32 v252, 2, v16
  v_add_u32 v252, 2629632, v252
  buffer_load_dword v15, v252, s[40:43], 0 offen sc1
  s_lshl_b32 s33, s14, 6
  s_and_b32 s31, s20, 1
  s_lshl_b32 s31, s31, 5
  s_add_u32 s33, s33, s31
  s_mul_i32 s35, s14, 40960
  s_mul_i32 s31, s20, 320
  s_add_u32 s35, s35, s31
  s_mul_i32 s10, s14, 20480
  s_mul_i32 s31, s20, 640
  s_add_u32 s10, s10, s31
  s_add_u32 s10, s10, 2686976
  v_lshrrev_b32 v17, 1, v1
  v_mul_u32_u24 v8, 3456, v17
  v_and_b32 v17, 1, v1
  v_lshl_add_u32 v8, v17, 4, v8
  v_add_u32 v11, 109568, v8
  v_add_u32 v12, 219136, v8
  v_add_u32 v13, 328704, v8
  v_add_u32 v14, 442368, v8
  v_lshrrev_b32 v17, 4, v1
  v_lshrrev_b32 v18, 2, v1
  v_lshl_add_u32 v18, v17, 2, v18
  v_lshlrev_b32 v18, 5, v18
  v_and_b32 v19, 3, v1
  v_lshl_add_u32 v9, v19, 3, v18
  v_add_u32 v9, s34, v9
  v_lshlrev_b32 v10, 4, v16
  v_lshl_add_u32 v10, v17, 7, v10
  v_add_u32 v10, 151552, v10
  s_mov_b32 s8, -1
  v_mov_b32 v232, 0
  v_mov_b32 v233, 0
  v_mov_b32 v234, 0
  v_mov_b32 v235, 0
  s_getpc_b64 s[36:37]
  s_setpc_b64 s[38:39]
  s_waitcnt vmcnt(8)
  v_cmp_eq_u32 vcc, 0, v15
  s_cbranch_vccnz fa_sel_spin
fa_sel_ok:
  v_add_u32 v18, -1, v15
  v_and_b32 v18, 2047, v18
  v_lshrrev_b32 v19, 4, v18
  v_mul_u32_u24 v19, 20480, v19
  v_and_b32 v18, 15, v18
  v_lshl_add_u32 v19, v18, 4, v19
  v_lshrrev_b32 v18, 3, v1
  v_lshl_add_u32 v19, v18, 8, v19
  s_lshl_b32 s23, s20, 11
  s_lshl_b32 s31, s20, 10
  s_add_u32 s31, s31, 151552
  s_mov_b32 s14, 4
  s_mov_b32 m0, s31
  s_add_u32 s31, s31, 4096
  buffer_load_dwordx4 v19, s[40:43], s23 offen sc1 lds
  s_add_u32 s23, s23, 8192
  s_mov_b32 m0, s31
  s_add_u32 s31, s31, 4096
  buffer_load_dwordx4 v19, s[40:43], s23 offen sc1 lds
  s_add_u32 s23, s23, 8192
  s_mov_b32 m0, s31
  s_add_u32 s31, s31, 4096
  buffer_load_dwordx4 v19, s[40:43], s23 offen sc1 lds
  s_add_u32 s23, s23, 8192
  s_getpc_b64 s[36:37]
  s_setpc_b64 s[38:39]
  s_branch fa_coG1
fa_coG:
  s_getpc_b64 s[36:37]
  s_setpc_b64 s[38:39]
  v_mfma_f32_16x16x32_bf16 v[232:235], a[192:195], a[212:215], v[232:235]
  v_mfma_f32_16x16x32_bf16 v[232:235], a[196:199], a[216:219], v[232:235]
  v_mfma_f32_16x16x32_bf16 v[232:235], a[200:203], a[220:223], v[232:235]
  v_mfma_f32_16x16x32_bf16 v[232:235], a[204:207], a[224:227], v[232:235]
  v_mfma_f32_16x16x32_bf16 v[232:235], a[208:211], a[228:231], v[232:235]
fa_coG1:
  s_waitcnt vmcnt(4)
  ds_read_b64_tr_b16 a[192:193], v9 offset:0
  ds_read_b64_tr_b16 a[194:195], v9 offset:128
  ds_read_b128 a[212:215], v10 offset:0
  ds_read_b64_tr_b16 a[196:197], v9 offset:1024
  ds_read_b64_tr_b16 a[198:199], v9 offset:1152
  ds_read_b128 a[216:219], v10 offset:512
  ds_read_b64_tr_b16 a[200:201], v9 offset:2048
  ds_read_b64_tr_b16 a[202:203], v9 offset:2176
  ds_read_b128 a[220:223], v10 offset:1024
  ds_read_b64_tr_b16 a[204:205], v9 offset:3072
  ds_read_b64_tr_b16 a[206:207], v9 offset:3200
  ds_read_b128 a[224:227], v10 offset:1536
  ds_read_b64_tr_b16 a[208:209], v9 offset:4096
  ds_read_b64_tr_b16 a[210:211], v9 offset:4224
  ds_read_b128 a[228:231], v10 offset:2048
  v_add_u32 v10, 2560, v10
  s_add_u32 s33, s33, 552960
  s_sub_u32 s14, s14, 1
  s_cmp_lg_u32 s14, 0
  s_cbranch_scc1 fa_coG
  v_accvgpr_read_b32 v8, a248
  v_accvgpr_read_b32 v11, a249
  v_accvgpr_read_b32 v12, a250
  v_accvgpr_read_b32 v13, a251
  v_accvgpr_read_b32 v14, a252
  v_subrev_u32 v11, 1024, v11
  v_subrev_u32 v12, 2048, v12
  v_subrev_u32 v13, 3072, v13
  s_mov_b32 s52, s60
  s_mov_b32 s53, s61
  s_mov_b32 s33, s35
  s_lshl_b32 s23, s20, 9
  v_add_u32 v16, s23, v10
  v_and_b32 v17, 7, v1
  v_mul_u32_u24 v9, 2560, v17
  v_lshrrev_b32 v17, 4, v1
  v_lshl_add_u32 v9, v17, 4, v9
  v_and_b32 v17, 8, v1
  v_lshl_add_u32 v9, v17, 27, v9
  s_waitcnt lgkmcnt(0)
  v_mfma_f32_16x16x32_bf16 v[232:235], a[192:195], a[212:215], v[232:235]
  v_mfma_f32_16x16x32_bf16 v[232:235], a[196:199], a[216:219], v[232:235]
  v_mfma_f32_16x16x32_bf16 v[232:235], a[200:203], a[220:223], v[232:235]
  v_mfma_f32_16x16x32_bf16 v[232:235], a[204:207], a[224:227], v[232:235]
  v_mfma_f32_16x16x32_bf16 v[232:235], a[208:211], a[228:231], v[232:235]
  s_nop 7
  ds_write_b128 v16, v[232:235]
  s_getpc_b64 s[36:37]
  s_setpc_b64 s[38:39]
  ds_read_b128 v[236:239], v10 offset:0
  ds_read_b128 v[240:243], v10 offset:512
  ds_read_b128 v[244:247], v10 offset:1024
  ds_read_b128 v[248:251], v10 offset:1536
  s_waitcnt vmcnt(4)
  ds_read_b64_tr_b16 a[192:193], v6 offset:0
  ds_read_b64_tr_b16 a[194:195], v6 offset:2560
  ds_read_b64_tr_b16 a[196:197], v6 offset:32
  ds_read_b64_tr_b16 a[198:199], v6 offset:2592
  ds_read_b64_tr_b16 a[200:201], v6 offset:64
  ds_read_b64_tr_b16 a[202:203], v6 offset:2624
  ds_read_b64_tr_b16 a[204:205], v6 offset:96
  ds_read_b64_tr_b16 a[206:207], v6 offset:2656
  ds_read_b64_tr_b16 a[208:209], v6 offset:128
  ds_read_b64_tr_b16 a[210:211], v6 offset:2688
  s_add_u32 s33, s33, 160
  s_mov_b32 s8, 0
  s_waitcnt lgkmcnt(10)
  v_cvt_pk_bf16_f32 v236, v236, v244
  v_cvt_pk_bf16_f32 v237, v237, v245
  v_cvt_pk_bf16_f32 v238, v238, v246
  v_cvt_pk_bf16_f32 v239, v239, v247
  v_cvt_pk_bf16_f32 v240, v240, v248
  v_cvt_pk_bf16_f32 v241, v241, v249
  v_cvt_pk_bf16_f32 v242, v242, v250
  v_cvt_pk_bf16_f32 v243, v243, v251
  v_lshlrev_b32 v244, 16, v236
  v_lshlrev_b32 v245, 16, v237
  v_lshlrev_b32 v246, 16, v238
  v_lshlrev_b32 v247, 16, v239
  v_lshlrev_b32 v248, 16, v240
  v_lshlrev_b32 v249, 16, v241
  v_lshlrev_b32 v250, 16, v242
  v_lshlrev_b32 v251, 16, v243
  v_mul_f32 v16, 0xbfb8aa3b, v244
  v_mul_f32 v17, 0xbfb8aa3b, v245
  v_mul_f32 v18, 0xbfb8aa3b, v246
  v_mul_f32 v19, 0xbfb8aa3b, v247
  v_mul_f32 v20, 0xbfb8aa3b, v248
  v_mul_f32 v21, 0xbfb8aa3b, v249
  v_mul_f32 v22, 0xbfb8aa3b, v250
  v_mul_f32 v23, 0xbfb8aa3b, v251
  v_exp_f32 v16, v16
  v_exp_f32 v17, v17
  v_exp_f32 v18, v18
  v_exp_f32 v19, v19
  v_exp_f32 v20, v20
  v_exp_f32 v21, v21
  v_exp_f32 v22, v22
  v_exp_f32 v23, v23
  v_add_f32 v16, 1.0, v16
  v_add_f32 v17, 1.0, v17
  v_add_f32 v18, 1.0, v18
  v_add_f32 v19, 1.0, v19
  v_add_f32 v20, 1.0, v20
  v_add_f32 v21, 1.0, v21
  v_add_f32 v22, 1.0, v22
  v_add_f32 v23, 1.0, v23
  v_rcp_f32 v16, v16
  v_rcp_f32 v17, v17
  v_rcp_f32 v18, v18
  v_rcp_f32 v19, v19
  v_rcp_f32 v20, v20
  v_rcp_f32 v21, v21
  v_rcp_f32 v22, v22
  v_rcp_f32 v23, v23
  v_and_b32 v236, 0xffff0000, v236
  v_and_b32 v237, 0xffff0000, v237
  v_and_b32 v238, 0xffff0000, v238
  v_and_b32 v239, 0xffff0000, v239
  v_and_b32 v240, 0xffff0000, v240
  v_and_b32 v241, 0xffff0000, v241
  v_and_b32 v242, 0xffff0000, v242
  v_and_b32 v243, 0xffff0000, v243
  v_pk_mul_f32 v[244:245], v[244:245], v[16:17]
  v_pk_mul_f32 v[246:247], v[246:247], v[18:19]
  v_pk_mul_f32 v[248:249], v[248:249], v[20:21]
  v_pk_mul_f32 v[250:251], v[250:251], v[22:23]
  v_cvt_pk_bf16_f32 v16, v244, v245
  v_cvt_pk_bf16_f32 v17, v246, v247
  v_cvt_pk_bf16_f32 v18, v248, v249
  v_cvt_pk_bf16_f32 v19, v250, v251
  v_lshlrev_b32 v244, 16, v16
  v_and_b32 v245, 0xffff0000, v16
  v_lshlrev_b32 v246, 16, v17
  v_and_b32 v247, 0xffff0000, v17
  v_lshlrev_b32 v248, 16, v18
  v_and_b32 v249, 0xffff0000, v18
  v_lshlrev_b32 v250, 16, v19
  v_and_b32 v251, 0xffff0000, v19
  v_pk_mul_f32 v[236:237], v[236:237], v[244:245]
  v_pk_mul_f32 v[238:239], v[238:239], v[246:247]
  v_pk_mul_f32 v[240:241], v[240:241], v[248:249]
  v_pk_mul_f32 v[242:243], v[242:243], v[250:251]
  v_cvt_pk_bf16_f32 v232, v236, v237
  v_cvt_pk_bf16_f32 v233, v238, v239
  v_cvt_pk_bf16_f32 v234, v240, v241
  v_cvt_pk_bf16_f32 v235, v242, v243
  s_nop 0
  s_waitcnt lgkmcnt(0)
  v_mfma_f32_16x16x32_bf16 v[236:239], a[192:195], v[232:235], 0
  v_mfma_f32_16x16x32_bf16 v[240:243], a[196:199], v[232:235], 0
  v_mfma_f32_16x16x32_bf16 v[244:247], a[200:203], v[232:235], 0
  v_mfma_f32_16x16x32_bf16 v[248:251], a[204:207], v[232:235], 0
  v_mfma_f32_16x16x32_bf16 v[252:255], a[208:211], v[232:235], 0
  s_nop 3
  buffer_store_dwordx4 v[236:239], v9, s[40:43], s10 offen offset:0 sc1
  buffer_store_dwordx4 v[240:243], v9, s[40:43], s10 offen offset:64 sc1
  buffer_store_dwordx4 v[244:247], v9, s[40:43], s10 offen offset:128 sc1
  buffer_store_dwordx4 v[248:251], v9, s[40:43], s10 offen offset:192 sc1
  buffer_store_dwordx4 v[252:255], v9, s[40:43], s10 offen offset:256 sc1
  s_add_u32 s10, s10, 320
  s_getpc_b64 s[36:37]
  s_setpc_b64 s[38:39]
  s_waitcnt vmcnt(4)
  ds_read_b64_tr_b16 a[192:193], v6 offset:0
  ds_read_b64_tr_b16 a[194:195], v6 offset:2560
  ds_read_b64_tr_b16 a[196:197], v6 offset:32
  ds_read_b64_tr_b16 a[198:199], v6 offset:2592
  ds_read_b64_tr_b16 a[200:201], v6 offset:64
  ds_read_b64_tr_b16 a[202:203], v6 offset:2624
  ds_read_b64_tr_b16 a[204:205], v6 offset:96
  ds_read_b64_tr_b16 a[206:207], v6 offset:2656
  ds_read_b64_tr_b16 a[208:209], v6 offset:128
  ds_read_b64_tr_b16 a[210:211], v6 offset:2688
  s_waitcnt lgkmcnt(0)
  v_mfma_f32_16x16x32_bf16 v[236:239], a[192:195], v[232:235], 0
  v_mfma_f32_16x16x32_bf16 v[240:243], a[196:199], v[232:235], 0
  v_mfma_f32_16x16x32_bf16 v[244:247], a[200:203], v[232:235], 0
  v_mfma_f32_16x16x32_bf16 v[248:251], a[204:207], v[232:235], 0
  v_mfma_f32_16x16x32_bf16 v[252:255], a[208:211], v[232:235], 0
  s_nop 3
  buffer_store_dwordx4 v[236:239], v9, s[40:43], s10 offen offset:0 sc1
  buffer_store_dwordx4 v[240:243], v9, s[40:43], s10 offen offset:64 sc1
  buffer_store_dwordx4 v[244:247], v9, s[40:43], s10 offen offset:128 sc1
  buffer_store_dwordx4 v[248:251], v9, s[40:43], s10 offen offset:192 sc1
  buffer_store_dwordx4 v[252:255], v9, s[40:43], s10 offen offset:256 sc1
  s_add_u32 s10, s10, 320
  s_getpc_b64 s[36:37]
  s_setpc_b64 s[38:39]
  s_sub_u32 s23, s2, 170
  s_lshl_b32 s31, s20, 6
  s_add_u32 s23, s23, s31
  s_lshl_b32 s23, s23, 2
  s_add_u32 s23, s23, 2650112
  s_waitcnt vmcnt(8)
  buffer_store_dword v4, off, s[40:43], s23 sc1
fa_coW:
  s_mov_b32 s12, 1
  s_mov_b32 s9, -1
  s_cmp_lg_u32 s11, 0
  s_cselect_b32 s32, s15, -1
  s_getpc_b64 s[36:37]
  s_setpc_b64 s[38:39]
  s_lshl_b32 s23, s22, 2
  s_add_u32 s23, s23, s20
  s_mul_i32 s13, s23, 163840
  s_add_u32 s13, s13, 4194304
  s_lshl_b32 s23, s23, 7
  s_add_u32 s23, s23, 2654208
  v_and_b32 v9, 31, v1
  v_lshl_add_u32 v9, v9, 2, s23
  v_and_b32 v10, 15, v1
  v_lshlrev_b32 v10, 2, v10
  v_add_u32 v10, 2629632, v10
  buffer_load_dword v8, v9, s[40:43], 0 offen sc1
  buffer_load_dword v15, v10, s[40:43], 0 offen sc1
  v_mov_b32 v20, v228
  v_mov_b32 v21, v229
  s_nop 1
  v_permlane16_swap_b32 v228, v20
  v_permlane16_swap_b32 v229, v21
  v_add_f32 v228, v228, v20
  v_add_f32 v229, v229, v21
  v_mov_b32 v20, v228
  v_mov_b32 v21, v229
  s_nop 1
  v_permlane32_swap_b32 v228, v20
  v_permlane32_swap_b32 v229, v21
  v_add_f32 v228, v228, v20
  v_add_f32 v229, v229, v21
  v_rcp_f32 v16, v228
  v_rcp_f32 v18, v229
  s_lshl_b32 s23, s22, 2
  v_mov_b32 v17, v16
  v_mov_b32 v19, v18
  s_add_u32 s23, s23, s20
  s_lshl_b32 s23, s23, 18
  s_lshl_b32 s31, s21, 12
  s_add_u32 s31, s31, 50331648
  s_add_u32 s64, s23, s31
  s_add_u32 s65, s64, 131072
  v_accvgpr_read_b32 v36, a0
  v_accvgpr_read_b32 v37, a1
  v_accvgpr_read_b32 v38, a2
  v_accvgpr_read_b32 v39, a3
  v_accvgpr_read_b32 v40, a8
  v_accvgpr_read_b32 v41, a9
  v_accvgpr_read_b32 v42, a10
  v_accvgpr_read_b32 v43, a11
  v_pk_mul_f32 v[36:37], v[36:37], v[16:17]
  v_pk_mul_f32 v[38:39], v[38:39], v[16:17]
  v_pk_mul_f32 v[40:41], v[40:41], v[16:17]
  v_pk_mul_f32 v[42:43], v[42:43], v[16:17]
  v_cvt_pk_bf16_f32 v32, v36, v37
  v_cvt_pk_bf16_f32 v33, v38, v39
  v_cvt_pk_bf16_f32 v34, v40, v41
  v_cvt_pk_bf16_f32 v35, v42, v43
  buffer_store_dwordx4 v[32:35], v2, s[40:43], s64 offen offset:0 sc1
  v_accvgpr_read_b32 v48, a16
  v_accvgpr_read_b32 v49, a17
  v_accvgpr_read_b32 v50, a18
  v_accvgpr_read_b32 v51, a19
  v_accvgpr_read_b32 v52, a24
  v_accvgpr_read_b32 v53, a25
  v_accvgpr_read_b32 v54, a26
  v_accvgpr_read_b32 v55, a27
  v_pk_mul_f32 v[48:49], v[48:49], v[16:17]
  v_pk_mul_f32 v[50:51], v[50:51], v[16:17]
  v_pk_mul_f32 v[52:53], v[52:53], v[16:17]
  v_pk_mul_f32 v[54:55], v[54:55], v[16:17]
  v_cvt_pk_bf16_f32 v44, v48, v49
  v_cvt_pk_bf16_f32 v45, v50, v51
  v_cvt_pk_bf16_f32 v46, v52, v53
  v_cvt_pk_bf16_f32 v47, v54, v55
  buffer_store_dwordx4 v[44:47], v2, s[40:43], s64 offen offset:1024 sc1
  v_accvgpr_read_b32 v100, a32
  v_accvgpr_read_b32 v101, a33
  v_accvgpr_read_b32 v102, a34
  v_accvgpr_read_b32 v103, a35
  v_accvgpr_read_b32 v104, a40
  v_accvgpr_read_b32 v105, a41
  v_accvgpr_read_b32 v106, a42
  v_accvgpr_read_b32 v107, a43
  v_pk_mul_f32 v[100:101], v[100:101], v[16:17]
  v_pk_mul_f32 v[102:103], v[102:103], v[16:17]
  v_pk_mul_f32 v[104:105], v[104:105], v[16:17]
  v_pk_mul_f32 v[106:107], v[106:107], v[16:17]
  v_cvt_pk_bf16_f32 v96, v100, v101
  v_cvt_pk_bf16_f32 v97, v102, v103
  v_cvt_pk_bf16_f32 v98, v104, v105
  v_cvt_pk_bf16_f32 v99, v106, v107
  buffer_store_dwordx4 v[96:99], v2, s[40:43], s64 offen offset:2048 sc1
  v_accvgpr_read_b32 v112, a48
  v_accvgpr_read_b32 v113, a49
  v_accvgpr_read_b32 v114, a50
  v_accvgpr_read_b32 v115, a51
  v_accvgpr_read_b32 v116, a56
  v_accvgpr_read_b32 v117, a57
  v_accvgpr_read_b32 v118, a58
  v_accvgpr_read_b32 v119, a59
  v_pk_mul_f32 v[112:113], v[112:113], v[16:17]
  v_pk_mul_f32 v[114:115], v[114:115], v[16:17]
  v_pk_mul_f32 v[116:117], v[116:117], v[16:17]
  v_pk_mul_f32 v[118:119], v[118:119], v[16:17]
  v_cvt_pk_bf16_f32 v108, v112, v113
  v_cvt_pk_bf16_f32 v109, v114, v115
  v_cvt_pk_bf16_f32 v110, v116, v117
  v_cvt_pk_bf16_f32 v111, v118, v119
  buffer_store_dwordx4 v[108:111], v2, s[40:43], s64 offen offset:3072 sc1
  v_accvgpr_read_b32 v36, a4
  v_accvgpr_read_b32 v37, a5
  v_accvgpr_read_b32 v38, a6
  v_accvgpr_read_b32 v39, a7
  v_accvgpr_read_b32 v40, a12
  v_accvgpr_read_b32 v41, a13
  v_accvgpr_read_b32 v42, a14
  v_accvgpr_read_b32 v43, a15
  v_pk_mul_f32 v[36:37], v[36:37], v[18:19]
  v_pk_mul_f32 v[38:39], v[38:39], v[18:19]
  v_pk_mul_f32 v[40:41], v[40:41], v[18:19]
  v_pk_mul_f32 v[42:43], v[42:43], v[18:19]
  v_cvt_pk_bf16_f32 v32, v36, v37
  v_cvt_pk_bf16_f32 v33, v38, v39
  v_cvt_pk_bf16_f32 v34, v40, v41
  v_cvt_pk_bf16_f32 v35, v42, v43
  buffer_store_dwordx4 v[32:35], v2, s[40:43], s65 offen offset:0 sc1
  v_accvgpr_read_b32 v48, a20
  v_accvgpr_read_b32 v49, a21
  v_accvgpr_read_b32 v50, a22
  v_accvgpr_read_b32 v51, a23
  v_accvgpr_read_b32 v52, a28
  v_accvgpr_read_b32 v53, a29
  v_accvgpr_read_b32 v54, a30
  v_accvgpr_read_b32 v55, a31
  v_pk_mul_f32 v[48:49], v[48:49], v[18:19]
  v_pk_mul_f32 v[50:51], v[50:51], v[18:19]
  v_pk_mul_f32 v[52:53], v[52:53], v[18:19]
  v_pk_mul_f32 v[54:55], v[54:55], v[18:19]
  v_cvt_pk_bf16_f32 v44, v48, v49
  v_cvt_pk_bf16_f32 v45, v50, v51
  v_cvt_pk_bf16_f32 v46, v52, v53
  v_cvt_pk_bf16_f32 v47, v54, v55
  buffer_store_dwordx4 v[44:47], v2, s[40:43], s65 offen offset:1024 sc1
  v_accvgpr_read_b32 v100, a36
  v_accvgpr_read_b32 v101, a37
  v_accvgpr_read_b32 v102, a38
  v_accvgpr_read_b32 v103, a39
  v_accvgpr_read_b32 v104, a44
  v_accvgpr_read_b32 v105, a45
  v_accvgpr_read_b32 v106, a46
  v_accvgpr_read_b32 v107, a47
  v_pk_mul_f32 v[100:101], v[100:101], v[18:19]
  v_pk_mul_f32 v[102:103], v[102:103], v[18:19]
  v_pk_mul_f32 v[104:105], v[104:105], v[18:19]
  v_pk_mul_f32 v[106:107], v[106:107], v[18:19]
  v_cvt_pk_bf16_f32 v96, v100, v101
  v_cvt_pk_bf16_f32 v97, v102, v103
  v_cvt_pk_bf16_f32 v98, v104, v105
  v_cvt_pk_bf16_f32 v99, v106, v107
  buffer_store_dwordx4 v[96:99], v2, s[40:43], s65 offen offset:2048 sc1
  v_accvgpr_read_b32 v112, a52
  v_accvgpr_read_b32 v113, a53
  v_accvgpr_read_b32 v114, a54
  v_accvgpr_read_b32 v115, a55
  v_accvgpr_read_b32 v116, a60
  v_accvgpr_read_b32 v117, a61
  v_accvgpr_read_b32 v118, a62
  v_accvgpr_read_b32 v119, a63
  v_pk_mul_f32 v[112:113], v[112:113], v[18:19]
  v_pk_mul_f32 v[114:115], v[114:115], v[18:19]
  v_pk_mul_f32 v[116:117], v[116:117], v[18:19]
  v_pk_mul_f32 v[118:119], v[118:119], v[18:19]
  v_cvt_pk_bf16_f32 v108, v112, v113
  v_cvt_pk_bf16_f32 v109, v114, v115
  v_cvt_pk_bf16_f32 v110, v116, v117
  v_cvt_pk_bf16_f32 v111, v118, v119
  buffer_store_dwordx4 v[108:111], v2, s[40:43], s65 offen offset:3072 sc1
  s_waitcnt vmcnt(8)
  v_cmp_eq_u32 vcc, 0, v8
  s_cbranch_vccnz fa_wof_spin
fa_wof_ok:
  v_cmp_eq_u32 vcc, 0, v15
  s_cbranch_vccnz fa_sel4_spin
fa_sel4_ok:
  s_lshl_b32 s31, s21, 6
  s_add_u32 s31, s31, 1
  v_subrev_u32 v16, s31, v15
  v_cmp_gt_u32 vcc, 64, v16
  s_cmp_lt_u32 s20, 2
  s_cselect_b32 s23, 0xff, 0
  s_and_b32 s10, vcc_lo, s23
  s_sub_u32 s23, s10, 1
  s_and_b32 s23, s23, s10
  s_cmp_eq_u32 s20, 1
  s_cselect_b32 s10, s23, s10
  s_cmp_eq_u32 s10, 0
  s_cbranch_scc1 fa_coEnd
  v_min_u32 v11, 53, v1
  s_lshr_b32 s23, s22, 1
  s_lshl_b32 s23, s23, 8
  s_add_u32 s23, s23, 2650112
  v_lshl_add_u32 v11, v11, 2, s23
  buffer_load_dword v14, v11, s[40:43], 0 offen sc1
  v_mul_u32_u24 v16, 3277, v1
  v_lshrrev_b32 v16, 16, v16
  v_mul_u32_u24 v8, 20, v16
  v_sub_u32 v8, v1, v8
  v_lshlrev_b32 v8, 4, v8
  v_mul_u32_u24 v9, 368640, v16
  v_add_u32 v9, v9, v8
  v_cmp_gt_u32 vcc, 3, v16
  v_mov_b32 v19, 1073741824
  s_nop 0
  v_cndmask_b32 v9, v19, v9, vcc
  s_mov_b32 s12, 2
  s_mov_b32 s32, -1
  s_mov_b32 s11, 0
  s_getpc_b64 s[36:37]
  s_setpc_b64 s[38:39]
  v_cmp_eq_u32 vcc, 0, v14
  s_cbranch_vccnz fa_yf_spin
fa_yf_ok:
fa_coY:
  s_ff1_i32_b32 s33, s10
  s_bitset0_b32 s10, s33
  s_sub_u32 s23, s10, 1
  s_and_b32 s10, s10, s23
  s_mul_i32 s14, s33, 2560
  s_mul_i32 s23, s22, 320
  s_add_u32 s14, s14, s23
  s_add_u32 s14, s14, 2686976
  buffer_load_dwordx4 v[64:67], v9, s[40:43], s14 offen sc1
  s_add_u32 s14, s14, 20480
  buffer_load_dwordx4 v[68:71], v9, s[40:43], s14 offen sc1
  s_add_u32 s14, s14, 20480
  buffer_load_dwordx4 v[72:75], v9, s[40:43], s14 offen sc1
  s_add_u32 s14, s14, 20480
  buffer_load_dwordx4 v[76:79], v9, s[40:43], s14 offen sc1
  s_add_u32 s14, s14, 20480
  buffer_load_dwordx4 v[80:83], v9, s[40:43], s14 offen sc1
  s_add_u32 s14, s14, 20480
  buffer_load_dwordx4 v[84:87], v9, s[40:43], s14 offen sc1
  s_add_u32 s14, s14, 20480
  buffer_load_dwordx4 v[88:91], v9, s[40:43], s14 offen sc1
  s_add_u32 s14, s14, 20480
  buffer_load_dwordx4 v[92:95], v9, s[40:43], s14 offen sc1
  s_add_u32 s14, s14, 20480
  buffer_load_dwordx4 v[128:131], v9, s[40:43], s14 offen sc1
  s_add_u32 s14, s14, 20480
  buffer_load_dwordx4 v[132:135], v9, s[40:43], s14 offen sc1
  s_add_u32 s14, s14, 20480
  buffer_load_dwordx4 v[136:139], v9, s[40:43], s14 offen sc1
  s_add_u32 s14, s14, 20480
  buffer_load_dwordx4 v[140:143], v9, s[40:43], s14 offen sc1
  s_add_u32 s14, s14, 20480
  buffer_load_dwordx4 v[144:147], v9, s[40:43], s14 offen sc1
  s_add_u32 s14, s14, 20480
  buffer_load_dwordx4 v[148:151], v9, s[40:43], s14 offen sc1
  s_add_u32 s14, s14, 20480
  buffer_load_dwordx4 v[152:155], v9, s[40:43], s14 offen sc1
  s_add_u32 s14, s14, 20480
  buffer_load_dwordx4 v[156:159], v9, s[40:43], s14 offen sc1
  s_add_u32 s14, s14, 20480
  buffer_load_dwordx4 v[176:179], v9, s[40:43], s14 offen sc1
  s_add_u32 s14, s14, 20480
  buffer_load_dwordx4 v[180:183], v9, s[40:43], s14 offen sc1
  s_add_u32 s14, s14, 20480
  s_lshl_b32 s14, s20, 10
  s_add_u32 s14, s14, 159744
  v_add_u32 v19, s14, v2
  s_add_u32 s23, s33, 8
  v_readlane_b32 s35, v15, s23
  s_waitcnt vmcnt(0)
  v_pk_add_f32 v[64:65], v[64:65], v[68:69]
  v_pk_add_f32 v[66:67], v[66:67], v[70:71]
  v_pk_add_f32 v[64:65], v[64:65], v[72:73]
  v_pk_add_f32 v[66:67], v[66:67], v[74:75]
  v_pk_add_f32 v[64:65], v[64:65], v[76:77]
  v_pk_add_f32 v[66:67], v[66:67], v[78:79]
  v_pk_add_f32 v[64:65], v[64:65], v[80:81]
  v_pk_add_f32 v[66:67], v[66:67], v[82:83]
  v_pk_add_f32 v[64:65], v[64:65], v[84:85]
  v_pk_add_f32 v[66:67], v[66:67], v[86:87]
  v_pk_add_f32 v[64:65], v[64:65], v[88:89]
  v_pk_add_f32 v[66:67], v[66:67], v[90:91]
  v_pk_add_f32 v[64:65], v[64:65], v[92:93]
  v_pk_add_f32 v[66:67], v[66:67], v[94:95]
  v_pk_add_f32 v[64:65], v[64:65], v[128:129]
  v_pk_add_f32 v[66:67], v[66:67], v[130:131]
  v_pk_add_f32 v[64:65], v[64:65], v[132:133]
  v_pk_add_f32 v[66:67], v[66:67], v[134:135]
  v_pk_add_f32 v[64:65], v[64:65], v[136:137]
  v_pk_add_f32 v[66:67], v[66:67], v[138:139]
  v_pk_add_f32 v[64:65], v[64:65], v[140:141]
  v_pk_add_f32 v[66:67], v[66:67], v[142:143]
  v_pk_add_f32 v[64:65], v[64:65], v[144:145]
  v_pk_add_f32 v[66:67], v[66:67], v[146:147]
  v_pk_add_f32 v[64:65], v[64:65], v[148:149]
  v_pk_add_f32 v[66:67], v[66:67], v[150:151]
  v_pk_add_f32 v[64:65], v[64:65], v[152:153]
  v_pk_add_f32 v[66:67], v[66:67], v[154:155]
  v_pk_add_f32 v[64:65], v[64:65], v[156:157]
  v_pk_add_f32 v[66:67], v[66:67], v[158:159]
  v_pk_add_f32 v[64:65], v[64:65], v[176:177]
  v_pk_add_f32 v[66:67], v[66:67], v[178:179]
  v_pk_add_f32 v[64:65], v[64:65], v[180:181]
  v_pk_add_f32 v[66:67], v[66:67], v[182:183]
  ds_write_b128 v19, v[64:67]
  v_add_u32 v19, s14, v8
  s_and_b32 s35, s35, 0xffff0000
  s_waitcnt lgkmcnt(0)
  ds_read_b128 v[64:67], v19
  ds_read_b128 v[68:71], v19 offset:320
  ds_read_b128 v[72:75], v19 offset:640
  s_mul_i32 s14, s33, 320
  s_add_u32 s14, s14, 155648
  v_add_u32 v19, s14, v8
  s_waitcnt lgkmcnt(0)
  v_add_f32 v64, v64, v68
  v_add_f32 v64, v64, v72
  v_cvt_pk_bf16_f32 v64, v64, v64
  v_and_b32 v64, 0xffff0000, v64
  v_mul_f32 v64, s35, v64
  v_cvt_pk_bf16_f32 v64, v64, v64
  v_and_b32 v64, 0xffff0000, v64
  v_add_f32 v65, v65, v69
  v_add_f32 v65, v65, v73
  v_cvt_pk_bf16_f32 v65, v65, v65
  v_and_b32 v65, 0xffff0000, v65
  v_mul_f32 v65, s35, v65
  v_cvt_pk_bf16_f32 v65, v65, v65
  v_and_b32 v65, 0xffff0000, v65
  v_add_f32 v66, v66, v70
  v_add_f32 v66, v66, v74
  v_cvt_pk_bf16_f32 v66, v66, v66
  v_and_b32 v66, 0xffff0000, v66
  v_mul_f32 v66, s35, v66
  v_cvt_pk_bf16_f32 v66, v66, v66
  v_and_b32 v66, 0xffff0000, v66
  v_add_f32 v67, v67, v71
  v_add_f32 v67, v67, v75
  v_cvt_pk_bf16_f32 v67, v67, v67
  v_and_b32 v67, 0xffff0000, v67
  v_mul_f32 v67, s35, v67
  v_cvt_pk_bf16_f32 v67, v67, v67
  v_and_b32 v67, 0xffff0000, v67
  ds_write_b128 v19, v[64:67]
  s_waitcnt lgkmcnt(0)
  s_cmp_lg_u32 s10, 0
  s_cbranch_scc1 fa_coY
fa_coEnd:
  s_mov_b32 s12, 3
  s_mov_b32 s32, -1
  s_setpc_b64 s[38:39]
fa_hk7:
  s_getpc_b64 s[38:39]
fa_hp7:
  s_add_u32 s36, s36, 4
  s_addc_u32 s37, s37, 0
  s_sub_u32 s38, s38, fa_hp7-fa_hb7
  s_subb_u32 s39, s39, 0
  s_setpc_b64 s[36:37]
fa_hk8:
  s_getpc_b64 s[38:39]
fa_hp8:
  s_add_u32 s36, s36, 4
  s_addc_u32 s37, s37, 0
  s_sub_u32 s38, s38, fa_hp8-fa_hb8
  s_subb_u32 s39, s39, 0
  s_setpc_b64 s[36:37]
fa_disp:
  s_cmp_eq_u32 s29, 7
  s_cbranch_scc1 fa_SSW7
  s_cmp_eq_u32 s29, 6
  s_cbranch_scc1 fa_SSW6
  s_cmp_eq_u32 s29, 5
  s_cbranch_scc1 fa_SSW5
  s_cmp_eq_u32 s29, 4
  s_cbranch_scc1 fa_SSW4
  s_cmp_eq_u32 s29, 3
  s_cbranch_scc1 fa_SSW3
  s_cmp_eq_u32 s29, 2
  s_cbranch_scc1 fa_SSW2
  s_cmp_eq_u32 s29, 1
  s_cbranch_scc1 fa_SSW1
  s_branch fa_Bexit
fa_hk9:
  s_getpc_b64 s[38:39]
fa_hp9:
  s_add_u32 s36, s36, 4
  s_addc_u32 s37, s37, 0
  s_add_u32 s38, s38, fa_hb9-fa_hp9
  s_addc_u32 s39, s39, 0
  s_setpc_b64 s[36:37]
fa_puby:
  s_waitcnt vmcnt(0)
  buffer_store_dword v4, v30, s[40:43], 0 offen sc1
  s_cmp_lt_u32 s12, 3
  s_cbranch_scc1 fa_hk9
fa_hb9:
  s_add_u32 s14, s13, 61440
  buffer_load_dwordx4 v[64:67], v2, s[40:43], s14 offen offset:0 sc1
  buffer_load_dwordx4 v[68:71], v2, s[40:43], s14 offen offset:1024 sc1
  buffer_load_dwordx4 v[72:75], v2, s[40:43], s14 offen offset:2048 sc1
  buffer_load_dwordx4 v[76:79], v2, s[40:43], s14 offen offset:3072 sc1
  s_add_u32 s14, s13, 65536
  buffer_load_dwordx4 v[80:83], v2, s[40:43], s14 offen offset:0 sc1
  buffer_load_dwordx4 v[84:87], v2, s[40:43], s14 offen offset:1024 sc1
  buffer_load_dwordx4 v[88:91], v2, s[40:43], s14 offen offset:2048 sc1
  buffer_load_dwordx4 v[92:95], v2, s[40:43], s14 offen offset:3072 sc1
  s_branch fa_pubb
fa_left:
  s_add_u32 s14, s13, 0
  buffer_load_dwordx4 a[0:3], v2, s[40:43], s14 offen offset:0 sc1
  buffer_load_dwordx4 a[4:7], v2, s[40:43], s14 offen offset:1024 sc1
  buffer_load_dwordx4 a[8:11], v2, s[40:43], s14 offen offset:2048 sc1
  buffer_load_dwordx4 a[12:15], v2, s[40:43], s14 offen offset:3072 sc1
  s_add_u32 s14, s13, 4096
  buffer_load_dwordx4 a[16:19], v2, s[40:43], s14 offen offset:0 sc1
  buffer_load_dwordx4 a[20:23], v2, s[40:43], s14 offen offset:1024 sc1
  s_cmp_ge_u32 s29, 7
  s_cbranch_scc1 fa_leftb
  s_add_u32 s14, s13, 4096
  buffer_load_dwordx4 a[24:27], v2, s[40:43], s14 offen offset:2048 sc1
  buffer_load_dwordx4 a[28:31], v2, s[40:43], s14 offen offset:3072 sc1
  s_add_u32 s14, s13, 8192
  buffer_load_dwordx4 a[32:35], v2, s[40:43], s14 offen offset:0 sc1
  buffer_load_dwordx4 a[36:39], v2, s[40:43], s14 offen offset:1024 sc1
  buffer_load_dwordx4 a[40:43], v2, s[40:43], s14 offen offset:2048 sc1
  buffer_load_dwordx4 a[44:47], v2, s[40:43], s14 offen offset:3072 sc1
  s_cmp_ge_u32 s29, 6
  s_cbranch_scc1 fa_leftb
  s_add_u32 s14, s13, 12288
  buffer_load_dwordx4 a[48:51], v2, s[40:43], s14 offen offset:0 sc1
  buffer_load_dwordx4 a[52:55], v2, s[40:43], s14 offen offset:1024 sc1
  buffer_load_dwordx4 a[56:59], v2, s[40:43], s14 offen offset:2048 sc1
  buffer_load_dwordx4 a[60:63], v2, s[40:43], s14 offen offset:3072 sc1
  s_add_u32 s14, s13, 16384
  buffer_load_dwordx4 a[192:195], v2, s[40:43], s14 offen offset:0 sc1
  buffer_load_dwordx4 a[196:199], v2, s[40:43], s14 offen offset:1024 sc1
  s_cmp_ge_u32 s29, 5
  s_cbranch_scc1 fa_leftb
  s_add_u32 s14, s13, 16384
  buffer_load_dwordx4 a[200:203], v2, s[40:43], s14 offen offset:2048 sc1
  buffer_load_dwordx4 a[204:207], v2, s[40:43], s14 offen offset:3072 sc1
  s_add_u32 s14, s13, 20480
  buffer_load_dwordx4 a[208:211], v2, s[40:43], s14 offen offset:0 sc1
  buffer_load_dwordx4 a[212:215], v2, s[40:43], s14 offen offset:1024 sc1
  buffer_load_dwordx4 a[216:219], v2, s[40:43], s14 offen offset:2048 sc1
  buffer_load_dwordx4 a[220:223], v2, s[40:43], s14 offen offset:3072 sc1
  s_cmp_ge_u32 s29, 4
  s_cbranch_scc1 fa_leftb
  s_add_u32 s14, s13, 24576
  buffer_load_dwordx4 a[224:227], v2, s[40:43], s14 offen offset:0 sc1
  buffer_load_dwordx4 a[228:231], v2, s[40:43], s14 offen offset:1024 sc1
  buffer_load_dwordx4 a[232:235], v2, s[40:43], s14 offen offset:2048 sc1
  buffer_load_dwordx4 a[236:239], v2, s[40:43], s14 offen offset:3072 sc1
  s_add_u32 s14, s13, 28672
  buffer_load_dwordx4 a[240:243], v2, s[40:43], s14 offen offset:0 sc1
  buffer_load_dwordx4 a[244:247], v2, s[40:43], s14 offen offset:1024 sc1
  s_cmp_ge_u32 s29, 3
  s_cbranch_scc1 fa_leftb
  s_add_u32 s14, s13, 28672
  buffer_load_dwordx4 a[248:251], v2, s[40:43], s14 offen offset:2048 sc1
  buffer_load_dwordx4 a[252:255], v2, s[40:43], s14 offen offset:3072 sc1
  s_add_u32 s14, s13, 32768
  buffer_load_dwordx4 v[32:35], v2, s[40:43], s14 offen offset:0 sc1
  buffer_load_dwordx4 v[36:39], v2, s[40:43], s14 offen offset:1024 sc1
  buffer_load_dwordx4 v[40:43], v2, s[40:43], s14 offen offset:2048 sc1
  buffer_load_dwordx4 v[44:47], v2, s[40:43], s14 offen offset:3072 sc1
  s_cmp_ge_u32 s29, 2
  s_cbranch_scc1 fa_leftb
  s_add_u32 s14, s13, 36864
  buffer_load_dwordx4 v[48:51], v2, s[40:43], s14 offen offset:0 sc1
  buffer_load_dwordx4 v[52:55], v2, s[40:43], s14 offen offset:1024 sc1
  buffer_load_dwordx4 v[56:59], v2, s[40:43], s14 offen offset:2048 sc1
  buffer_load_dwordx4 v[60:63], v2, s[40:43], s14 offen offset:3072 sc1
  s_add_u32 s14, s13, 40960
  buffer_load_dwordx4 v[96:99], v2, s[40:43], s14 offen offset:0 sc1
  buffer_load_dwordx4 v[100:103], v2, s[40:43], s14 offen offset:1024 sc1
  s_cmp_ge_u32 s29, 1
  s_cbranch_scc1 fa_leftb
  s_add_u32 s14, s13, 40960
  buffer_load_dwordx4 v[104:107], v2, s[40:43], s14 offen offset:2048 sc1
  buffer_load_dwordx4 v[108:111], v2, s[40:43], s14 offen offset:3072 sc1
  s_add_u32 s14, s13, 45056
  buffer_load_dwordx4 v[112:115], v2, s[40:43], s14 offen offset:0 sc1
  buffer_load_dwordx4 v[116:119], v2, s[40:43], s14 offen offset:1024 sc1
  buffer_load_dwordx4 v[120:123], v2, s[40:43], s14 offen offset:2048 sc1
  buffer_load_dwordx4 v[124:127], v2, s[40:43], s14 offen offset:3072 sc1
  s_branch fa_leftb
fa_ctx_spin:
  s_mov_b32 s83, 200000
fa_ctx_spin2:
  buffer_load_dword v13, v12, s[40:43], 0 offen sc1
  s_waitcnt vmcnt(0)
  v_cmp_eq_u32 vcc, 0, v13
  s_cbranch_vccz fa_ctx_ok
  s_sleep 8
  s_sub_u32 s83, s83, 1
  s_cmp_lg_u32 s83, 0
  s_cbranch_scc1 fa_ctx_spin2
  s_branch fa_ctx_ok
fa_stub0:
  s_call_b64 s[76:77], fa_rare00
  s_call_b64 s[76:77], fa_rare10
  s_branch fa_back0
fa_stub1:
  s_call_b64 s[76:77], fa_rare01
  s_call_b64 s[76:77], fa_rare11
  s_branch fa_back1
fa_stub2:
  s_call_b64 s[76:77], fa_rare00
  s_call_b64 s[76:77], fa_rare10
  s_branch fa_back2
fa_stub3:
  s_call_b64 s[76:77], fa_rare01
  s_call_b64 s[76:77], fa_rare11
  s_branch fa_back3
fa_stub4:
  s_call_b64 s[76:77], fa_rare01
  s_call_b64 s[76:77], fa_rare11
  s_branch fa_back4
fa_stub5:
  s_call_b64 s[76:77], fa_rare00
  s_call_b64 s[76:77], fa_rare10
  s_branch fa_back5
fa_stub6:
  s_call_b64 s[76:77], fa_rare11
  s_branch fa_back6
fa_stub7:
  s_call_b64 s[76:77], fa_rare10
  s_branch fa_back7
fa_stub8:
  s_call_b64 s[76:77], fa_rare01
  s_call_b64 s[76:77], fa_rare11
  s_branch fa_back8
fa_stub9:
  s_call_b64 s[76:77], fa_rare10
  s_branch fa_back9
fa_stub10:
  s_call_b64 s[76:77], fa_rare11
  s_branch fa_back10
fa_stub11:
  s_call_b64 s[76:77], fa_rare10
  s_branch fa_back11
fa_stub12:
  s_call_b64 s[76:77], fa_rare11
  s_branch fa_back12
fa_stub13:
  s_call_b64 s[76:77], fa_rare10
  s_branch fa_back13
fa_stub14:
  s_call_b64 s[76:77], fa_rare11
  s_branch fa_back14
fa_stub15:
  s_call_b64 s[76:77], fa_rare10
  s_branch fa_back15
fa_stub16:
  s_call_b64 s[76:77], fa_rare11
  s_branch fa_back16
fa_stub17:
  s_call_b64 s[76:77], fa_rare10
  s_branch fa_back17
fa_stub18:
  s_call_b64 s[76:77], fa_rare11
  s_branch fa_back18
fa_stub19:
  s_call_b64 s[76:77], fa_rare10
  s_branch fa_back19
fa_stub20:
  s_call_b64 s[76:77], fa_rare11
  s_branch fa_back20
fa_stub21:
  s_call_b64 s[76:77], fa_rare10
  s_branch fa_back21
fa_stub22:
  s_call_b64 s[76:77], fa_rare11
  s_branch fa_back22
fa_stub23:
  s_call_b64 s[76:77], fa_rare10
  s_branch fa_back23
fa_stub24:
  s_call_b64 s[76:77], fa_rare11
  s_branch fa_back24
fa_stub25:
  s_call_b64 s[76:77], fa_rare10
  s_branch fa_back25
fa_stub26:
  s_call_b64 s[76:77], fa_rare11
  s_branch fa_back26
fa_stub27:
  s_call_b64 s[76:77], fa_rare10
  s_branch fa_back27
fa_stub28:
  s_call_b64 s[76:77], fa_rare11
  s_branch fa_back28
fa_stub29:
  s_call_b64 s[76:77], fa_rare10
  s_branch fa_back29
fa_stub30:
  s_call_b64 s[76:77], fa_rare11
  s_branch fa_back30
fa_codeend:
fa_rare00:
  s_nop 7
  v_max3_f32 v16, v96, v97, v98
  v_max3_f32 v16, v16, v99, v100
  v_max3_f32 v16, v16, v101, v102
  v_max3_f32 v16, v16, v103, 0
  v_mov_b32 v18, v16
  s_nop 1
  v_permlane16_swap_b32 v16, v18
  v_max_f32 v16, v16, v18
  v_mov_b32 v18, v16
  s_nop 1
  v_permlane32_swap_b32 v16, v18
  v_max_f32 v16, v16, v18
  v_sub_f32 v96, v96, v16
  v_sub_f32 v112, v112, v16
  v_sub_f32 v97, v97, v16
  v_sub_f32 v113, v113, v16
  v_sub_f32 v98, v98, v16
  v_sub_f32 v114, v114, v16
  v_sub_f32 v99, v99, v16
  v_sub_f32 v115, v115, v16
  v_sub_f32 v100, v100, v16
  v_sub_f32 v116, v116, v16
  v_sub_f32 v101, v101, v16
  v_sub_f32 v117, v117, v16
  v_sub_f32 v102, v102, v16
  v_sub_f32 v118, v118, v16
  v_sub_f32 v103, v103, v16
  v_sub_f32 v119, v119, v16
  v_max3_f32 v17, v104, v105, v106
  v_max3_f32 v17, v17, v107, v108
  v_max3_f32 v17, v17, v109, v110
  v_max3_f32 v17, v17, v111, 0
  v_mov_b32 v18, v17
  s_nop 1
  v_permlane16_swap_b32 v17, v18
  v_max_f32 v17, v17, v18
  v_mov_b32 v18, v17
  s_nop 1
  v_permlane32_swap_b32 v17, v18
  v_max_f32 v17, v17, v18
  v_sub_f32 v104, v104, v17
  v_sub_f32 v120, v120, v17
  v_sub_f32 v105, v105, v17
  v_sub_f32 v121, v121, v17
  v_sub_f32 v106, v106, v17
  v_sub_f32 v122, v122, v17
  v_sub_f32 v107, v107, v17
  v_sub_f32 v123, v123, v17
  v_sub_f32 v108, v108, v17
  v_sub_f32 v124, v124, v17
  v_sub_f32 v109, v109, v17
  v_sub_f32 v125, v125, v17
  v_sub_f32 v110, v110, v17
  v_sub_f32 v126, v126, v17
  v_sub_f32 v111, v111, v17
  v_sub_f32 v127, v127, v17
  s_call_b64 s[78:79], fa_resc0
  v_exp_f32 v208, v96
  v_exp_f32 v209, v97
  v_exp_f32 v210, v98
  v_add_f32 v224, v208, v209
  v_cvt_pk_bf16_f32 v160, v208, v209
  v_exp_f32 v211, v99
  v_add_f32 v224, v224, v210
  v_exp_f32 v212, v100
  v_add_f32 v224, v224, v211
  v_cvt_pk_bf16_f32 v161, v210, v211
  v_exp_f32 v213, v101
  v_add_f32 v224, v224, v212
  v_exp_f32 v214, v102
  v_add_f32 v224, v224, v213
  v_cvt_pk_bf16_f32 v162, v212, v213
  v_exp_f32 v215, v103
  v_add_f32 v224, v224, v214
  v_exp_f32 v208, v104
  v_add_f32 v224, v224, v215
  v_cvt_pk_bf16_f32 v163, v214, v215
  v_exp_f32 v209, v105
  v_exp_f32 v210, v106
  v_add_f32 v225, v208, v209
  v_cvt_pk_bf16_f32 v164, v208, v209
  v_exp_f32 v211, v107
  v_add_f32 v225, v225, v210
  v_exp_f32 v212, v108
  v_add_f32 v225, v225, v211
  v_cvt_pk_bf16_f32 v165, v210, v211
  v_exp_f32 v213, v109
  v_add_f32 v225, v225, v212
  v_exp_f32 v214, v110
  v_add_f32 v225, v225, v213
  v_cvt_pk_bf16_f32 v166, v212, v213
  v_exp_f32 v215, v111
  v_add_f32 v225, v225, v214
  s_nop 0
  v_add_f32 v225, v225, v215
  v_cvt_pk_bf16_f32 v167, v214, v215
  s_nop 1
  s_setpc_b64 s[76:77]
fa_rare01:
  s_nop 7
  v_max3_f32 v16, v112, v113, v114
  v_max3_f32 v16, v16, v115, v116
  v_max3_f32 v16, v16, v117, v118
  v_max3_f32 v16, v16, v119, 0
  v_mov_b32 v18, v16
  s_nop 1
  v_permlane16_swap_b32 v16, v18
  v_max_f32 v16, v16, v18
  v_mov_b32 v18, v16
  s_nop 1
  v_permlane32_swap_b32 v16, v18
  v_max_f32 v16, v16, v18
  v_sub_f32 v112, v112, v16
  v_sub_f32 v96, v96, v16
  v_sub_f32 v113, v113, v16
  v_sub_f32 v97, v97, v16
  v_sub_f32 v114, v114, v16
  v_sub_f32 v98, v98, v16
  v_sub_f32 v115, v115, v16
  v_sub_f32 v99, v99, v16
  v_sub_f32 v116, v116, v16
  v_sub_f32 v100, v100, v16
  v_sub_f32 v117, v117, v16
  v_sub_f32 v101, v101, v16
  v_sub_f32 v118, v118, v16
  v_sub_f32 v102, v102, v16
  v_sub_f32 v119, v119, v16
  v_sub_f32 v103, v103, v16
  v_max3_f32 v17, v120, v121, v122
  v_max3_f32 v17, v17, v123, v124
  v_max3_f32 v17, v17, v125, v126
  v_max3_f32 v17, v17, v127, 0
  v_mov_b32 v18, v17
  s_nop 1
  v_permlane16_swap_b32 v17, v18
  v_max_f32 v17, v17, v18
  v_mov_b32 v18, v17
  s_nop 1
  v_permlane32_swap_b32 v17, v18
  v_max_f32 v17, v17, v18
  v_sub_f32 v120, v120, v17
  v_sub_f32 v104, v104, v17
  v_sub_f32 v121, v121, v17
  v_sub_f32 v105, v105, v17
  v_sub_f32 v122, v122, v17
  v_sub_f32 v106, v106, v17
  v_sub_f32 v123, v123, v17
  v_sub_f32 v107, v107, v17
  v_sub_f32 v124, v124, v17
  v_sub_f32 v108, v108, v17
  v_sub_f32 v125, v125, v17
  v_sub_f32 v109, v109, v17
  v_sub_f32 v126, v126, v17
  v_sub_f32 v110, v110, v17
  v_sub_f32 v127, v127, v17
  v_sub_f32 v111, v111, v17
  s_call_b64 s[78:79], fa_resc0
  v_exp_f32 v208, v112
  v_exp_f32 v209, v113
  v_exp_f32 v210, v114
  v_add_f32 v224, v208, v209
  v_cvt_pk_bf16_f32 v168, v208, v209
  v_exp_f32 v211, v115
  v_add_f32 v224, v224, v210
  v_exp_f32 v212, v116
  v_add_f32 v224, v224, v211
  v_cvt_pk_bf16_f32 v169, v210, v211
  v_exp_f32 v213, v117
  v_add_f32 v224, v224, v212
  v_exp_f32 v214, v118
  v_add_f32 v224, v224, v213
  v_cvt_pk_bf16_f32 v170, v212, v213
  v_exp_f32 v215, v119
  v_add_f32 v224, v224, v214
  v_exp_f32 v208, v120
  v_add_f32 v224, v224, v215
  v_cvt_pk_bf16_f32 v171, v214, v215
  v_exp_f32 v209, v121
  v_exp_f32 v210, v122
  v_add_f32 v225, v208, v209
  v_cvt_pk_bf16_f32 v172, v208, v209
  v_exp_f32 v211, v123
  v_add_f32 v225, v225, v210
  v_exp_f32 v212, v124
  v_add_f32 v225, v225, v211
  v_cvt_pk_bf16_f32 v173, v210, v211
  v_exp_f32 v213, v125
  v_add_f32 v225, v225, v212
  v_exp_f32 v214, v126
  v_add_f32 v225, v225, v213
  v_cvt_pk_bf16_f32 v174, v212, v213
  v_exp_f32 v215, v127
  v_add_f32 v225, v225, v214
  s_nop 0
  v_add_f32 v225, v225, v215
  v_cvt_pk_bf16_f32 v175, v214, v215
  s_nop 1
  s_setpc_b64 s[76:77]
fa_resc0:
  v_sub_f32 v192, v192, v16
  v_sub_f32 v193, v193, v16
  v_sub_f32 v194, v194, v16
  v_sub_f32 v195, v195, v16
  v_exp_f32 v18, -v16
  v_sub_f32 v196, v196, v17
  v_sub_f32 v197, v197, v17
  v_sub_f32 v198, v198, v17
  v_sub_f32 v199, v199, v17
  v_exp_f32 v19, -v17
  s_nop 0
  v_mul_f32 v228, v228, v18
  v_mul_f32 v229, v229, v19
  v_accvgpr_read_b32 v20, a0
  v_accvgpr_read_b32 v21, a1
  v_accvgpr_read_b32 v22, a2
  v_accvgpr_read_b32 v23, a3
  v_mul_f32 v20, v20, v18
  v_mul_f32 v21, v21, v18
  v_mul_f32 v22, v22, v18
  v_mul_f32 v23, v23, v18
  v_accvgpr_write_b32 a0, v20
  v_accvgpr_write_b32 a1, v21
  v_accvgpr_write_b32 a2, v22
  v_accvgpr_write_b32 a3, v23
  v_accvgpr_read_b32 v20, a4
  v_accvgpr_read_b32 v21, a5
  v_accvgpr_read_b32 v22, a6
  v_accvgpr_read_b32 v23, a7
  v_mul_f32 v20, v20, v19
  v_mul_f32 v21, v21, v19
  v_mul_f32 v22, v22, v19
  v_mul_f32 v23, v23, v19
  v_accvgpr_write_b32 a4, v20
  v_accvgpr_write_b32 a5, v21
  v_accvgpr_write_b32 a6, v22
  v_accvgpr_write_b32 a7, v23
  v_accvgpr_read_b32 v20, a8
  v_accvgpr_read_b32 v21, a9
  v_accvgpr_read_b32 v22, a10
  v_accvgpr_read_b32 v23, a11
  v_mul_f32 v20, v20, v18
  v_mul_f32 v21, v21, v18
  v_mul_f32 v22, v22, v18
  v_mul_f32 v23, v23, v18
  v_accvgpr_write_b32 a8, v20
  v_accvgpr_write_b32 a9, v21
  v_accvgpr_write_b32 a10, v22
  v_accvgpr_write_b32 a11, v23
  v_accvgpr_read_b32 v20, a12
  v_accvgpr_read_b32 v21, a13
  v_accvgpr_read_b32 v22, a14
  v_accvgpr_read_b32 v23, a15
  v_mul_f32 v20, v20, v19
  v_mul_f32 v21, v21, v19
  v_mul_f32 v22, v22, v19
  v_mul_f32 v23, v23, v19
  v_accvgpr_write_b32 a12, v20
  v_accvgpr_write_b32 a13, v21
  v_accvgpr_write_b32 a14, v22
  v_accvgpr_write_b32 a15, v23
  v_accvgpr_read_b32 v20, a16
  v_accvgpr_read_b32 v21, a17
  v_accvgpr_read_b32 v22, a18
  v_accvgpr_read_b32 v23, a19
  v_mul_f32 v20, v20, v18
  v_mul_f32 v21, v21, v18
  v_mul_f32 v22, v22, v18
  v_mul_f32 v23, v23, v18
  v_accvgpr_write_b32 a16, v20
  v_accvgpr_write_b32 a17, v21
  v_accvgpr_write_b32 a18, v22
  v_accvgpr_write_b32 a19, v23
  v_accvgpr_read_b32 v20, a20
  v_accvgpr_read_b32 v21, a21
  v_accvgpr_read_b32 v22, a22
  v_accvgpr_read_b32 v23, a23
  v_mul_f32 v20, v20, v19
  v_mul_f32 v21, v21, v19
  v_mul_f32 v22, v22, v19
  v_mul_f32 v23, v23, v19
  v_accvgpr_write_b32 a20, v20
  v_accvgpr_write_b32 a21, v21
  v_accvgpr_write_b32 a22, v22
  v_accvgpr_write_b32 a23, v23
  v_accvgpr_read_b32 v20, a24
  v_accvgpr_read_b32 v21, a25
  v_accvgpr_read_b32 v22, a26
  v_accvgpr_read_b32 v23, a27
  v_mul_f32 v20, v20, v18
  v_mul_f32 v21, v21, v18
  v_mul_f32 v22, v22, v18
  v_mul_f32 v23, v23, v18
  v_accvgpr_write_b32 a24, v20
  v_accvgpr_write_b32 a25, v21
  v_accvgpr_write_b32 a26, v22
  v_accvgpr_write_b32 a27, v23
  v_accvgpr_read_b32 v20, a28
  v_accvgpr_read_b32 v21, a29
  v_accvgpr_read_b32 v22, a30
  v_accvgpr_read_b32 v23, a31
  v_mul_f32 v20, v20, v19
  v_mul_f32 v21, v21, v19
  v_mul_f32 v22, v22, v19
  v_mul_f32 v23, v23, v19
  v_accvgpr_write_b32 a28, v20
  v_accvgpr_write_b32 a29, v21
  v_accvgpr_write_b32 a30, v22
  v_accvgpr_write_b32 a31, v23
  v_accvgpr_read_b32 v20, a32
  v_accvgpr_read_b32 v21, a33
  v_accvgpr_read_b32 v22, a34
  v_accvgpr_read_b32 v23, a35
  v_mul_f32 v20, v20, v18
  v_mul_f32 v21, v21, v18
  v_mul_f32 v22, v22, v18
  v_mul_f32 v23, v23, v18
  v_accvgpr_write_b32 a32, v20
  v_accvgpr_write_b32 a33, v21
  v_accvgpr_write_b32 a34, v22
  v_accvgpr_write_b32 a35, v23
  v_accvgpr_read_b32 v20, a36
  v_accvgpr_read_b32 v21, a37
  v_accvgpr_read_b32 v22, a38
  v_accvgpr_read_b32 v23, a39
  v_mul_f32 v20, v20, v19
  v_mul_f32 v21, v21, v19
  v_mul_f32 v22, v22, v19
  v_mul_f32 v23, v23, v19
  v_accvgpr_write_b32 a36, v20
  v_accvgpr_write_b32 a37, v21
  v_accvgpr_write_b32 a38, v22
  v_accvgpr_write_b32 a39, v23
  v_accvgpr_read_b32 v20, a40
  v_accvgpr_read_b32 v21, a41
  v_accvgpr_read_b32 v22, a42
  v_accvgpr_read_b32 v23, a43
  v_mul_f32 v20, v20, v18
  v_mul_f32 v21, v21, v18
  v_mul_f32 v22, v22, v18
  v_mul_f32 v23, v23, v18
  v_accvgpr_write_b32 a40, v20
  v_accvgpr_write_b32 a41, v21
  v_accvgpr_write_b32 a42, v22
  v_accvgpr_write_b32 a43, v23
  v_accvgpr_read_b32 v20, a44
  v_accvgpr_read_b32 v21, a45
  v_accvgpr_read_b32 v22, a46
  v_accvgpr_read_b32 v23, a47
  v_mul_f32 v20, v20, v19
  v_mul_f32 v21, v21, v19
  v_mul_f32 v22, v22, v19
  v_mul_f32 v23, v23, v19
  v_accvgpr_write_b32 a44, v20
  v_accvgpr_write_b32 a45, v21
  v_accvgpr_write_b32 a46, v22
  v_accvgpr_write_b32 a47, v23
  v_accvgpr_read_b32 v20, a48
  v_accvgpr_read_b32 v21, a49
  v_accvgpr_read_b32 v22, a50
  v_accvgpr_read_b32 v23, a51
  v_mul_f32 v20, v20, v18
  v_mul_f32 v21, v21, v18
  v_mul_f32 v22, v22, v18
  v_mul_f32 v23, v23, v18
  v_accvgpr_write_b32 a48, v20
  v_accvgpr_write_b32 a49, v21
  v_accvgpr_write_b32 a50, v22
  v_accvgpr_write_b32 a51, v23
  v_accvgpr_read_b32 v20, a52
  v_accvgpr_read_b32 v21, a53
  v_accvgpr_read_b32 v22, a54
  v_accvgpr_read_b32 v23, a55
  v_mul_f32 v20, v20, v19
  v_mul_f32 v21, v21, v19
  v_mul_f32 v22, v22, v19
  v_mul_f32 v23, v23, v19
  v_accvgpr_write_b32 a52, v20
  v_accvgpr_write_b32 a53, v21
  v_accvgpr_write_b32 a54, v22
  v_accvgpr_write_b32 a55, v23
  v_accvgpr_read_b32 v20, a56
  v_accvgpr_read_b32 v21, a57
  v_accvgpr_read_b32 v22, a58
  v_accvgpr_read_b32 v23, a59
  v_mul_f32 v20, v20, v18
  v_mul_f32 v21, v21, v18
  v_mul_f32 v22, v22, v18
  v_mul_f32 v23, v23, v18
  v_accvgpr_write_b32 a56, v20
  v_accvgpr_write_b32 a57, v21
  v_accvgpr_write_b32 a58, v22
  v_accvgpr_write_b32 a59, v23
  v_accvgpr_read_b32 v20, a60
  v_accvgpr_read_b32 v21, a61
  v_accvgpr_read_b32 v22, a62
  v_accvgpr_read_b32 v23, a63
  v_mul_f32 v20, v20, v19
  v_mul_f32 v21, v21, v19
  v_mul_f32 v22, v22, v19
  v_mul_f32 v23, v23, v19
  v_accvgpr_write_b32 a60, v20
  v_accvgpr_write_b32 a61, v21
  v_accvgpr_write_b32 a62, v22
  v_accvgpr_write_b32 a63, v23
  s_setpc_b64 s[78:79]
fa_rare10:
  s_nop 7
  v_max3_f32 v16, v128, v129, v130
  v_max3_f32 v16, v16, v131, v132
  v_max3_f32 v16, v16, v133, v134
  v_max3_f32 v16, v16, v135, 0
  v_mov_b32 v18, v16
  s_nop 1
  v_permlane16_swap_b32 v16, v18
  v_max_f32 v16, v16, v18
  v_mov_b32 v18, v16
  s_nop 1
  v_permlane32_swap_b32 v16, v18
  v_max_f32 v16, v16, v18
  v_sub_f32 v128, v128, v16
  v_sub_f32 v144, v144, v16
  v_sub_f32 v129, v129, v16
  v_sub_f32 v145, v145, v16
  v_sub_f32 v130, v130, v16
  v_sub_f32 v146, v146, v16
  v_sub_f32 v131, v131, v16
  v_sub_f32 v147, v147, v16
  v_sub_f32 v132, v132, v16
  v_sub_f32 v148, v148, v16
  v_sub_f32 v133, v133, v16
  v_sub_f32 v149, v149, v16
  v_sub_f32 v134, v134, v16
  v_sub_f32 v150, v150, v16
  v_sub_f32 v135, v135, v16
  v_sub_f32 v151, v151, v16
  v_max3_f32 v17, v136, v137, v138
  v_max3_f32 v17, v17, v139, v140
  v_max3_f32 v17, v17, v141, v142
  v_max3_f32 v17, v17, v143, 0
  v_mov_b32 v18, v17
  s_nop 1
  v_permlane16_swap_b32 v17, v18
  v_max_f32 v17, v17, v18
  v_mov_b32 v18, v17
  s_nop 1
  v_permlane32_swap_b32 v17, v18
  v_max_f32 v17, v17, v18
  v_sub_f32 v136, v136, v17
  v_sub_f32 v152, v152, v17
  v_sub_f32 v137, v137, v17
  v_sub_f32 v153, v153, v17
  v_sub_f32 v138, v138, v17
  v_sub_f32 v154, v154, v17
  v_sub_f32 v139, v139, v17
  v_sub_f32 v155, v155, v17
  v_sub_f32 v140, v140, v17
  v_sub_f32 v156, v156, v17
  v_sub_f32 v141, v141, v17
  v_sub_f32 v157, v157, v17
  v_sub_f32 v142, v142, v17
  v_sub_f32 v158, v158, v17
  v_sub_f32 v143, v143, v17
  v_sub_f32 v159, v159, v17
  s_call_b64 s[78:79], fa_resc1
  v_exp_f32 v216, v128
  v_exp_f32 v217, v129
  v_exp_f32 v218, v130
  v_add_f32 v226, v216, v217
  v_cvt_pk_bf16_f32 v176, v216, v217
  v_exp_f32 v219, v131
  v_add_f32 v226, v226, v218
  v_exp_f32 v220, v132
  v_add_f32 v226, v226, v219
  v_cvt_pk_bf16_f32 v177, v218, v219
  v_exp_f32 v221, v133
  v_add_f32 v226, v226, v220
  v_exp_f32 v222, v134
  v_add_f32 v226, v226, v221
  v_cvt_pk_bf16_f32 v178, v220, v221
  v_exp_f32 v223, v135
  v_add_f32 v226, v226, v222
  v_exp_f32 v216, v136
  v_add_f32 v226, v226, v223
  v_cvt_pk_bf16_f32 v179, v222, v223
  v_exp_f32 v217, v137
  v_exp_f32 v218, v138
  v_add_f32 v227, v216, v217
  v_cvt_pk_bf16_f32 v180, v216, v217
  v_exp_f32 v219, v139
  v_add_f32 v227, v227, v218
  v_exp_f32 v220, v140
  v_add_f32 v227, v227, v219
  v_cvt_pk_bf16_f32 v181, v218, v219
  v_exp_f32 v221, v141
  v_add_f32 v227, v227, v220
  v_exp_f32 v222, v142
  v_add_f32 v227, v227, v221
  v_cvt_pk_bf16_f32 v182, v220, v221
  v_exp_f32 v223, v143
  v_add_f32 v227, v227, v222
  s_nop 0
  v_add_f32 v227, v227, v223
  v_cvt_pk_bf16_f32 v183, v222, v223
  v_exp_f32 v216, v144
  s_nop 1
  s_setpc_b64 s[76:77]
fa_rare11:
  s_nop 7
  v_max3_f32 v16, v144, v145, v146
  v_max3_f32 v16, v16, v147, v148
  v_max3_f32 v16, v16, v149, v150
  v_max3_f32 v16, v16, v151, 0
  v_mov_b32 v18, v16
  s_nop 1
  v_permlane16_swap_b32 v16, v18
  v_max_f32 v16, v16, v18
  v_mov_b32 v18, v16
  s_nop 1
  v_permlane32_swap_b32 v16, v18
  v_max_f32 v16, v16, v18
  v_sub_f32 v144, v144, v16
  v_sub_f32 v128, v128, v16
  v_sub_f32 v145, v145, v16
  v_sub_f32 v129, v129, v16
  v_sub_f32 v146, v146, v16
  v_sub_f32 v130, v130, v16
  v_sub_f32 v147, v147, v16
  v_sub_f32 v131, v131, v16
  v_sub_f32 v148, v148, v16
  v_sub_f32 v132, v132, v16
  v_sub_f32 v149, v149, v16
  v_sub_f32 v133, v133, v16
  v_sub_f32 v150, v150, v16
  v_sub_f32 v134, v134, v16
  v_sub_f32 v151, v151, v16
  v_sub_f32 v135, v135, v16
  v_max3_f32 v17, v152, v153, v154
  v_max3_f32 v17, v17, v155, v156
  v_max3_f32 v17, v17, v157, v158
  v_max3_f32 v17, v17, v159, 0
  v_mov_b32 v18, v17
  s_nop 1
  v_permlane16_swap_b32 v17, v18
  v_max_f32 v17, v17, v18
  v_mov_b32 v18, v17
  s_nop 1
  v_permlane32_swap_b32 v17, v18
  v_max_f32 v17, v17, v18
  v_sub_f32 v152, v152, v17
  v_sub_f32 v136, v136, v17
  v_sub_f32 v153, v153, v17
  v_sub_f32 v137, v137, v17
  v_sub_f32 v154, v154, v17
  v_sub_f32 v138, v138, v17
  v_sub_f32 v155, v155, v17
  v_sub_f32 v139, v139, v17
  v_sub_f32 v156, v156, v17
  v_sub_f32 v140, v140, v17
  v_sub_f32 v157, v157, v17
  v_sub_f32 v141, v141, v17
  v_sub_f32 v158, v158, v17
  v_sub_f32 v142, v142, v17
  v_sub_f32 v159, v159, v17
  v_sub_f32 v143, v143, v17
  s_call_b64 s[78:79], fa_resc1
  v_exp_f32 v216, v144
  v_exp_f32 v217, v145
  v_exp_f32 v218, v146
  v_add_f32 v226, v216, v217
  v_cvt_pk_bf16_f32 v184, v216, v217
  v_exp_f32 v219, v147
  v_add_f32 v226, v226, v218
  v_exp_f32 v220, v148
  v_add_f32 v226, v226, v219
  v_cvt_pk_bf16_f32 v185, v218, v219
  v_exp_f32 v221, v149
  v_add_f32 v226, v226, v220
  v_exp_f32 v222, v150
  v_add_f32 v226, v226, v221
  v_cvt_pk_bf16_f32 v186, v220, v221
  v_exp_f32 v223, v151
  v_add_f32 v226, v226, v222
  v_exp_f32 v216, v152
  v_add_f32 v226, v226, v223
  v_cvt_pk_bf16_f32 v187, v222, v223
  v_exp_f32 v217, v153
  v_exp_f32 v218, v154
  v_add_f32 v227, v216, v217
  v_cvt_pk_bf16_f32 v188, v216, v217
  v_exp_f32 v219, v155
  v_add_f32 v227, v227, v218
  v_exp_f32 v220, v156
  v_add_f32 v227, v227, v219
  v_cvt_pk_bf16_f32 v189, v218, v219
  v_exp_f32 v221, v157
  v_add_f32 v227, v227, v220
  v_exp_f32 v222, v158
  v_add_f32 v227, v227, v221
  v_cvt_pk_bf16_f32 v190, v220, v221
  v_exp_f32 v223, v159
  v_add_f32 v227, v227, v222
  s_nop 0
  v_add_f32 v227, v227, v223
  v_cvt_pk_bf16_f32 v191, v222, v223
  v_exp_f32 v216, v128
  s_nop 1
  s_setpc_b64 s[76:77]
fa_resc1:
  v_sub_f32 v200, v200, v16
  v_sub_f32 v201, v201, v16
  v_sub_f32 v202, v202, v16
  v_sub_f32 v203, v203, v16
  v_exp_f32 v18, -v16
  v_sub_f32 v204, v204, v17
  v_sub_f32 v205, v205, v17
  v_sub_f32 v206, v206, v17
  v_sub_f32 v207, v207, v17
  v_exp_f32 v19, -v17
  s_nop 0
  v_mul_f32 v230, v230, v18
  v_mul_f32 v231, v231, v19
  v_accvgpr_read_b32 v20, a64
  v_accvgpr_read_b32 v21, a65
  v_accvgpr_read_b32 v22, a66
  v_accvgpr_read_b32 v23, a67
  v_mul_f32 v20, v20, v18
  v_mul_f32 v21, v21, v18
  v_mul_f32 v22, v22, v18
  v_mul_f32 v23, v23, v18
  v_accvgpr_write_b32 a64, v20
  v_accvgpr_write_b32 a65, v21
  v_accvgpr_write_b32 a66, v22
  v_accvgpr_write_b32 a67, v23
  v_accvgpr_read_b32 v20, a68
  v_accvgpr_read_b32 v21, a69
  v_accvgpr_read_b32 v22, a70
  v_accvgpr_read_b32 v23, a71
  v_mul_f32 v20, v20, v19
  v_mul_f32 v21, v21, v19
  v_mul_f32 v22, v22, v19
  v_mul_f32 v23, v23, v19
  v_accvgpr_write_b32 a68, v20
  v_accvgpr_write_b32 a69, v21
  v_accvgpr_write_b32 a70, v22
  v_accvgpr_write_b32 a71, v23
  v_accvgpr_read_b32 v20, a72
  v_accvgpr_read_b32 v21, a73
  v_accvgpr_read_b32 v22, a74
  v_accvgpr_read_b32 v23, a75
  v_mul_f32 v20, v20, v18
  v_mul_f32 v21, v21, v18
  v_mul_f32 v22, v22, v18
  v_mul_f32 v23, v23, v18
  v_accvgpr_write_b32 a72, v20
  v_accvgpr_write_b32 a73, v21
  v_accvgpr_write_b32 a74, v22
  v_accvgpr_write_b32 a75, v23
  v_accvgpr_read_b32 v20, a76
  v_accvgpr_read_b32 v21, a77
  v_accvgpr_read_b32 v22, a78
  v_accvgpr_read_b32 v23, a79
  v_mul_f32 v20, v20, v19
  v_mul_f32 v21, v21, v19
  v_mul_f32 v22, v22, v19
  v_mul_f32 v23, v23, v19
  v_accvgpr_write_b32 a76, v20
  v_accvgpr_write_b32 a77, v21
  v_accvgpr_write_b32 a78, v22
  v_accvgpr_write_b32 a79, v23
  v_accvgpr_read_b32 v20, a80
  v_accvgpr_read_b32 v21, a81
  v_accvgpr_read_b32 v22, a82
  v_accvgpr_read_b32 v23, a83
  v_mul_f32 v20, v20, v18
  v_mul_f32 v21, v21, v18
  v_mul_f32 v22, v22, v18
  v_mul_f32 v23, v23, v18
  v_accvgpr_write_b32 a80, v20
  v_accvgpr_write_b32 a81, v21
  v_accvgpr_write_b32 a82, v22
  v_accvgpr_write_b32 a83, v23
  v_accvgpr_read_b32 v20, a84
  v_accvgpr_read_b32 v21, a85
  v_accvgpr_read_b32 v22, a86
  v_accvgpr_read_b32 v23, a87
  v_mul_f32 v20, v20, v19
  v_mul_f32 v21, v21, v19
  v_mul_f32 v22, v22, v19
  v_mul_f32 v23, v23, v19
  v_accvgpr_write_b32 a84, v20
  v_accvgpr_write_b32 a85, v21
  v_accvgpr_write_b32 a86, v22
  v_accvgpr_write_b32 a87, v23
  v_accvgpr_read_b32 v20, a88
  v_accvgpr_read_b32 v21, a89
  v_accvgpr_read_b32 v22, a90
  v_accvgpr_read_b32 v23, a91
  v_mul_f32 v20, v20, v18
  v_mul_f32 v21, v21, v18
  v_mul_f32 v22, v22, v18
  v_mul_f32 v23, v23, v18
  v_accvgpr_write_b32 a88, v20
  v_accvgpr_write_b32 a89, v21
  v_accvgpr_write_b32 a90, v22
  v_accvgpr_write_b32 a91, v23
  v_accvgpr_read_b32 v20, a92
  v_accvgpr_read_b32 v21, a93
  v_accvgpr_read_b32 v22, a94
  v_accvgpr_read_b32 v23, a95
  v_mul_f32 v20, v20, v19
  v_mul_f32 v21, v21, v19
  v_mul_f32 v22, v22, v19
  v_mul_f32 v23, v23, v19
  v_accvgpr_write_b32 a92, v20
  v_accvgpr_write_b32 a93, v21
  v_accvgpr_write_b32 a94, v22
  v_accvgpr_write_b32 a95, v23
  v_accvgpr_read_b32 v20, a96
  v_accvgpr_read_b32 v21, a97
  v_accvgpr_read_b32 v22, a98
  v_accvgpr_read_b32 v23, a99
  v_mul_f32 v20, v20, v18
  v_mul_f32 v21, v21, v18
  v_mul_f32 v22, v22, v18
  v_mul_f32 v23, v23, v18
  v_accvgpr_write_b32 a96, v20
  v_accvgpr_write_b32 a97, v21
  v_accvgpr_write_b32 a98, v22
  v_accvgpr_write_b32 a99, v23
  v_accvgpr_read_b32 v20, a100
  v_accvgpr_read_b32 v21, a101
  v_accvgpr_read_b32 v22, a102
  v_accvgpr_read_b32 v23, a103
  v_mul_f32 v20, v20, v19
  v_mul_f32 v21, v21, v19
  v_mul_f32 v22, v22, v19
  v_mul_f32 v23, v23, v19
  v_accvgpr_write_b32 a100, v20
  v_accvgpr_write_b32 a101, v21
  v_accvgpr_write_b32 a102, v22
  v_accvgpr_write_b32 a103, v23
  v_accvgpr_read_b32 v20, a104
  v_accvgpr_read_b32 v21, a105
  v_accvgpr_read_b32 v22, a106
  v_accvgpr_read_b32 v23, a107
  v_mul_f32 v20, v20, v18
  v_mul_f32 v21, v21, v18
  v_mul_f32 v22, v22, v18
  v_mul_f32 v23, v23, v18
  v_accvgpr_write_b32 a104, v20
  v_accvgpr_write_b32 a105, v21
  v_accvgpr_write_b32 a106, v22
  v_accvgpr_write_b32 a107, v23
  v_accvgpr_read_b32 v20, a108
  v_accvgpr_read_b32 v21, a109
  v_accvgpr_read_b32 v22, a110
  v_accvgpr_read_b32 v23, a111
  v_mul_f32 v20, v20, v19
  v_mul_f32 v21, v21, v19
  v_mul_f32 v22, v22, v19
  v_mul_f32 v23, v23, v19
  v_accvgpr_write_b32 a108, v20
  v_accvgpr_write_b32 a109, v21
  v_accvgpr_write_b32 a110, v22
  v_accvgpr_write_b32 a111, v23
  v_accvgpr_read_b32 v20, a112
  v_accvgpr_read_b32 v21, a113
  v_accvgpr_read_b32 v22, a114
  v_accvgpr_read_b32 v23, a115
  v_mul_f32 v20, v20, v18
  v_mul_f32 v21, v21, v18
  v_mul_f32 v22, v22, v18
  v_mul_f32 v23, v23, v18
  v_accvgpr_write_b32 a112, v20
  v_accvgpr_write_b32 a113, v21
  v_accvgpr_write_b32 a114, v22
  v_accvgpr_write_b32 a115, v23
  v_accvgpr_read_b32 v20, a116
  v_accvgpr_read_b32 v21, a117
  v_accvgpr_read_b32 v22, a118
  v_accvgpr_read_b32 v23, a119
  v_mul_f32 v20, v20, v19
  v_mul_f32 v21, v21, v19
  v_mul_f32 v22, v22, v19
  v_mul_f32 v23, v23, v19
  v_accvgpr_write_b32 a116, v20
  v_accvgpr_write_b32 a117, v21
  v_accvgpr_write_b32 a118, v22
  v_accvgpr_write_b32 a119, v23
  v_accvgpr_read_b32 v20, a120
  v_accvgpr_read_b32 v21, a121
  v_accvgpr_read_b32 v22, a122
  v_accvgpr_read_b32 v23, a123
  v_mul_f32 v20, v20, v18
  v_mul_f32 v21, v21, v18
  v_mul_f32 v22, v22, v18
  v_mul_f32 v23, v23, v18
  v_accvgpr_write_b32 a120, v20
  v_accvgpr_write_b32 a121, v21
  v_accvgpr_write_b32 a122, v22
  v_accvgpr_write_b32 a123, v23
  v_accvgpr_read_b32 v20, a124
  v_accvgpr_read_b32 v21, a125
  v_accvgpr_read_b32 v22, a126
  v_accvgpr_read_b32 v23, a127
  v_mul_f32 v20, v20, v19
  v_mul_f32 v21, v21, v19
  v_mul_f32 v22, v22, v19
  v_mul_f32 v23, v23, v19
  v_accvgpr_write_b32 a124, v20
  v_accvgpr_write_b32 a125, v21
  v_accvgpr_write_b32 a126, v22
  v_accvgpr_write_b32 a127, v23
  s_setpc_b64 s[78:79]
.section .rodata,"a"
.p2align 6
.amdhsa_kernel fa_kernel
  .amdhsa_next_free_vgpr 512
  .amdhsa_next_free_sgpr 102
  .amdhsa_accum_offset 256
  .amdhsa_group_segment_fixed_size 0
  .amdhsa_kernarg_size 112
  .amdhsa_user_sgpr_count 2
  .amdhsa_user_sgpr_kernarg_segment_ptr 1
  .amdhsa_system_sgpr_workgroup_id_x 1
  .amdhsa_float_denorm_mode_32 3
.end_amdhsa_kernel
.text
```

```asm
; @launch kernel=fa_kernel grid=(256,1,1) block=(256,1,1) lds=163840
.amdgcn_target "amdgcn-amd-amdhsa--gfx950"
.text
.globl fa_kernel
.p2align 8
.type fa_kernel,@function
fa_kernel:
  s_cmp_ge_u32 s2, 256
  s_cbranch_scc1 fa_end
  s_getpc_b64 s[62:63]
  v_and_b32 v230, 127, v0
  v_lshlrev_b32 v230, 7, v230
  global_load_dword v231, v230, s[62:63]
  s_load_dwordx4 s[4:7], s[0:1], 0
  s_load_dwordx4 s[8:11], s[0:1], 24
  s_load_dwordx2 s[14:15], s[0:1], 56
  s_load_dwordx2 s[12:13], s[0:1], 40
  s_load_dwordx4 s[16:19], s[0:1], 96
  s_load_dwordx2 s[60:61], s[0:1], 16
  v_lshrrev_b32 v16, 6, v0
  v_and_b32 v1, 63, v0
  v_readfirstlane_b32 s20, v16
  s_and_b32 s21, s2, 7
  s_lshl_b32 s21, s21, 2
  s_lshr_b32 s23, s2, 3
  s_and_b32 s23, s23, 3
  s_add_u32 s21, s21, s23
  s_lshr_b32 s22, s2, 5
  v_and_b32 v208, 31, v1
  v_lshrrev_b32 v209, 5, v1
  s_lshl_b32 s31, s2, 2
  s_add_u32 s31, s31, s20
  s_lshl_b32 s31, s31, 1
  v_add_u32 v209, s31, v209
  v_lshlrev_b32 v212, 4, v208
  v_mul_u32_u24 v210, 1280, v209
  v_add_u32 v210, v210, v212
  v_cmp_gt_u32 s[64:65], 16, v208
  v_mov_b32 v19, 1073741824
  v_and_b32 v220, 7, v209
  v_cndmask_b32 v211, v19, v210, s[64:65]
  v_bfe_u32 v17, v1, 1, 3
  v_lshlrev_b32 v17, 13, v17
  v_and_b32 v18, 1, v1
  v_lshl_add_u32 v235, v18, 7, v17
  s_lshl_b32 s74, s22, 1
  s_and_b32 s31, s20, 1
  s_add_u32 s74, s74, s31
  s_lshl_b32 s74, s74, 16
  s_mov_b32 s73, 1048576
  v_and_b32 v16, 15, v1
  v_lshlrev_b32 v17, 10, v16
  v_and_b32 v18, 16, v1
  v_lshl_add_u32 v233, v18, 3, v17
  s_lshl_b32 s30, s23, 5
  s_add_u32 s30, s30, s20
  s_lshl_b32 s30, s30, 14
  s_lshl_b32 s29, s22, 16
  s_lshl_b32 s23, s21, 8
  s_cmp_ge_u32 s20, 2
  s_waitcnt lgkmcnt(0)
  s_mov_b32 s44, s4
  s_mov_b32 s45, s5
  s_mov_b32 s46, 2621440
  s_mov_b32 s47, 0x20000
  s_mov_b32 s68, s14
  s_mov_b32 s69, s15
  s_mov_b32 s70, 1280
  s_mov_b32 s71, 0x20000
  buffer_load_dwordx4 v[160:163], v210, s[44:47], 0 offen
  buffer_load_dwordx4 v[164:167], v210, s[44:47], 0 offen offset:512
  buffer_load_dwordx4 v[168:171], v211, s[44:47], 0 offen offset:1024
  buffer_load_dwordx4 v[172:175], v212, s[68:71], 0 offen offset:0
  buffer_load_dwordx4 v[176:179], v212, s[68:71], 0 offen offset:512
  buffer_load_dwordx4 v[180:183], v212, s[68:71], 0 offen offset:1024
  s_cselect_b32 s62, s10, s8
  s_cselect_b32 s63, s11, s9
  s_add_u32 s62, s62, s23
  s_addc_u32 s63, s63, 0
  s_mov_b32 s36, s62
  s_mov_b32 s37, s63
  s_mov_b32 s38, 0
  s_mov_b32 s39, 0x20000
  s_sub_u32 s38, 4194304, s23
  buffer_load_dword v231, v235, s[36:39], s74 offen
  s_add_u32 s6, s6, s29
  s_addc_u32 s7, s7, 0
  s_mov_b32 s32, s6
  s_mov_b32 s33, s7
  s_mov_b32 s34, 0
  s_mov_b32 s35, 0x20000
  s_sub_u32 s34, 2097152, s29
  buffer_load_dword v232, v233, s[32:35], s30 offen
  s_add_u32 s74, s74, s73
  buffer_load_dword v231, v235, s[36:39], s74 offen
  buffer_load_dword v232, v233, s[32:35], s30 offen offset:256
  s_getpc_b64 s[8:9]
fa_pc:
  s_lshr_b32 s31, s2, 3
  s_and_b32 s31, s31, 15
  s_lshl_b32 s31, s31, 2
  s_add_u32 s31, s31, s20
  s_lshl_b32 s31, s31, 11
  s_min_u32 s31, s31, fa_codeend-fa_pc-2048
  v_lshlrev_b32 v234, 7, v16
  v_add_u32 v230, s31, v234
  global_load_dword v231, v230, s[8:9]
  s_add_u32 s8, s8, fa_co1-fa_pc-4
  s_addc_u32 s9, s9, 0
  s_add_u32 s60, s60, s23
  s_addc_u32 s61, s61, 0
  s_sub_u32 s75, 5242880, s23
  s_mov_b32 s48, s62
  s_mov_b32 s49, s63
  s_mov_b32 s50, s38
  s_mov_b32 s51, 0x20000
  v_lshlrev_b32 v2, 4, v1
  v_lshrrev_b32 v19, 2, v1
  v_lshrrev_b32 v17, 5, v1
  v_mul_u32_u24 v17, 3, v17
  v_and_b32 v18, 3, v1
  v_xor_b32 v17, v17, v18
  v_lshlrev_b32 v17, 4, v17
  v_lshl_add_u32 v3, v19, 10, v17
  s_lshl_b32 s23, s20, 19
  v_add_u32 v3, s23, v3
  v_add_u32 v4, 15360, v3
  v_add_u32 v5, 30720, v3
  v_add_u32 v6, 46080, v3
  v_and_b32 v19, 3, v19
  v_lshrrev_b32 v17, 4, v1
  v_lshlrev_b32 v17, 6, v17
  v_lshl_add_u32 v19, v19, 13, v17
  s_and_b32 s23, s20, 1
  s_lshl_b32 s23, s23, 17
  v_add_u32 v19, s23, v19
  v_lshl_add_u32 v8, v18, 4, v19
  v_xor_b32 v18, 2, v18
  v_lshl_add_u32 v10, v18, 4, v19
  v_add_u32 v9, 31744, v8
  v_add_u32 v11, 95232, v10
  v_add_u32 v10, 63488, v10
  s_lshl_b32 s24, s20, 12
  s_mov_b32 s26, 0
  s_mov_b32 s27, 0
  s_mov_b32 s25, 262144
  s_mov_b32 s79, 64
  s_mov_b32 s40, s18
  s_mov_b32 s41, s19
  s_mov_b32 s42, 67108864
  s_mov_b32 s43, 0x20000
  s_mov_b32 s52, s12
  s_mov_b32 s53, s13
  s_mov_b32 s54, 5242880
  s_mov_b32 s55, 0x20000
  s_mov_b32 s56, s16
  s_mov_b32 s57, s17
  s_mov_b32 s58, 256
  s_mov_b32 s59, 0x20000
  s_and_b32 s29, s2, 7
  s_lshl_b32 s29, s29, 2
  s_add_u32 s29, s29, s20
  s_lshl_b32 s29, s29, 11
  s_and_b32 s23, s21, 3
  s_lshl_b32 s23, s23, 19
  s_add_u32 s29, s29, s23
  s_lshl_b32 s23, s20, 5
  s_add_u32 s23, s23, s21
  s_lshl_b32 s23, s23, 2
  s_add_u32 s23, s23, 2641920
  s_lshl_b32 s31, s22, 9
  s_add_u32 s80, s23, s31
  s_sub_u32 s31, 7680, s31
  s_add_u32 s3, s23, s31
  s_lshl_b32 s23, s21, 7
  s_lshl_b32 s31, s22, 2
  s_add_u32 s23, s23, s31
  s_add_u32 s82, s23, 2637824
  s_sub_u32 s62, s2, 170
  s_lshl_b32 s31, s20, 6
  s_add_u32 s62, s62, s31
  s_lshl_b32 s62, s62, 2
  s_add_u32 s62, s62, 2650112
  s_sub_u32 s23, s2, 170
  s_cmp_lt_u32 s23, 54
  s_cselect_b32 s62, s62, 1073741824
  s_cmp_eq_u32 s20, 0
  s_cselect_b32 s31, s82, 1073741824
  s_cselect_b32 s77, s2, 1073741824
  s_cmp_eq_u32 s2, 255
  s_cselect_b32 s23, 2629632, 1073741824
  v_lshl_add_u32 v225, v16, 2, s23
  v_mov_b32 v229, 0
  v_writelane_b32 v225, s80, 0
  v_writelane_b32 v225, s3, 1
  v_writelane_b32 v225, s31, 2
  s_add_u32 s31, s31, 32
  v_writelane_b32 v225, s31, 5
  s_and_b32 s23, s2, 1
  s_lshl_b32 s23, s23, 2
  s_add_u32 s23, s23, s20
  s_lshl_b32 s23, s23, 7
  s_lshr_b32 s31, s2, 1
  s_add_u32 s23, s23, s31
  s_lshl_b32 s23, s23, 2
  s_add_u32 s23, s23, 2654208
  v_writelane_b32 v225, s23, 3
  v_writelane_b32 v225, s62, 4
  s_and_b32 s23, s21, 3
  s_lshr_b32 s31, s23, 1
  s_lshl_b32 s31, 4, s31
  s_bitcmp1_b32 s23, 0
  s_cselect_b32 s76, s31, 0
  s_cselect_b32 s72, 0, s31
  s_or_b32 s76, s76, 0x20
  s_or_b32 s72, s72, 0x25
  v_mov_b32 v20, 0
  v_mov_b32 v21, 0
  v_mov_b32 v22, 0
  v_mov_b32 v23, 0
  v_lshrrev_b32 v17, 4, v1
  v_lshrrev_b32 v18, 3, v16
  v_mul_u32_u24 v18, 3, v18
  v_xor_b32 v18, v18, v17
  v_lshlrev_b32 v18, 4, v18
  v_lshl_add_u32 v14, v16, 6, v18
  s_and_b32 s23, s20, 1
  s_lshl_b32 s23, s23, 11
  v_add_u32 v14, s23, v14
  v_mfma_f32_32x32x16_bf16 a[0:15], v[20:23], v[20:23], 0
  v_lshrrev_b32 v18, 2, v16
  v_lshlrev_b32 v18, 6, v18
  v_lshl_add_u32 v18, v17, 11, v18
  v_and_b32 v19, 1, v1
  v_mfma_f32_32x32x16_bf16 a[16:31], v[20:23], v[20:23], 0
  v_lshl_add_u32 v18, v19, 3, v18
  v_bfe_u32 v19, v1, 1, 1
  v_and_b32 v17, 1, v17
  v_lshl_or_b32 v19, v17, 1, v19
  v_mfma_f32_32x32x16_bf16 a[32:47], v[20:23], v[20:23], 0
  s_lshr_b32 s23, s20, 1
  s_lshl_b32 s23, s23, 13
  s_add_u32 s23, s23, 16384
  v_add_u32 v18, s23, v18
  v_mfma_f32_32x32x16_bf16 a[48:63], v[20:23], v[20:23], 0
  v_lshl_add_u32 v12, v19, 4, v18
  v_xor_b32 v13, 32, v12
  v_mov_b32 v19, 1073741824
  v_lshlrev_b32 v220, 4, v220
  v_mfma_f32_32x32x16_bf16 a[64:79], v[20:23], v[20:23], 0
  v_lshl_add_u32 v220, v208, 7, v220
  v_add_u32 v220, 131072, v220
  v_lshlrev_b32 v222, 2, v209
  v_cmp_eq_u32 vcc, 0, v208
  v_mfma_f32_32x32x16_bf16 a[80:95], v[20:23], v[20:23], 0
  v_add_u32 v222, 2621440, v222
  v_lshlrev_b32 v221, 4, v0
  v_cndmask_b32 v222, v19, v222, vcc
  v_add_u32 v221, 131072, v221
  v_mfma_f32_32x32x16_bf16 a[96:111], v[20:23], v[20:23], 0
  v_sub_u32 v209, 0xffff, v209
  v_lshrrev_b32 v223, 3, v0
  v_and_b32 v18, 7, v0
  v_lshlrev_b32 v18, 4, v18
  v_mfma_f32_32x32x16_bf16 a[112:127], v[20:23], v[20:23], 0
  v_cmp_gt_u32 vcc, 128, v0
  v_lshl_add_u32 v223, v223, 8, v18
  s_lshr_b32 s66, s2, 1
  s_mul_i32 s66, s66, 20480
  v_mfma_f32_32x32x16_bf16 a[128:143], v[20:23], v[20:23], 0
  s_and_b32 s31, s2, 1
  s_lshl_b32 s31, s31, 7
  s_add_u32 s66, s66, s31
  v_cndmask_b32 v224, v19, v223, vcc
  v_mfma_f32_32x32x16_bf16 a[144:159], v[20:23], v[20:23], 0
  s_add_u32 s67, s66, 8192
  s_add_u32 s78, s66, 16384
  s_mov_b32 s28, 0
  v_mfma_f32_32x32x16_bf16 a[160:175], v[20:23], v[20:23], 0
  v_mfma_f32_32x32x16_bf16 a[176:191], v[20:23], v[20:23], 0
  v_mfma_f32_32x32x16_bf16 a[192:207], v[20:23], v[20:23], 0
  v_mfma_f32_32x32x16_bf16 a[208:223], v[20:23], v[20:23], 0
  v_mfma_f32_32x32x16_bf16 a[224:239], v[20:23], v[20:23], 0
  v_mfma_f32_32x32x16_bf16 a[240:255], v[20:23], v[20:23], 0
  s_waitcnt vmcnt(5)
  v_lshlrev_b32 v184, 16, v160
  v_and_b32 v185, 0xffff0000, v160
  v_lshlrev_b32 v186, 16, v161
  v_and_b32 v187, 0xffff0000, v161
  v_lshlrev_b32 v188, 16, v162
  v_and_b32 v189, 0xffff0000, v162
  v_lshlrev_b32 v190, 16, v163
  v_and_b32 v191, 0xffff0000, v163
  v_lshlrev_b32 v192, 16, v164
  v_and_b32 v193, 0xffff0000, v164
  v_lshlrev_b32 v194, 16, v165
  v_and_b32 v195, 0xffff0000, v165
  v_lshlrev_b32 v196, 16, v166
  v_and_b32 v197, 0xffff0000, v166
  v_lshlrev_b32 v198, 16, v167
  v_and_b32 v199, 0xffff0000, v167
  v_lshlrev_b32 v200, 16, v168
  v_and_b32 v201, 0xffff0000, v168
  v_lshlrev_b32 v202, 16, v169
  v_and_b32 v203, 0xffff0000, v169
  v_lshlrev_b32 v204, 16, v170
  v_and_b32 v205, 0xffff0000, v170
  v_lshlrev_b32 v206, 16, v171
  v_and_b32 v207, 0xffff0000, v171
  v_pk_add_f32 v[16:17], v[184:185], v[186:187]
  v_pk_add_f32 v[18:19], v[188:189], v[190:191]
  v_pk_add_f32 v[16:17], v[16:17], v[192:193]
  v_pk_add_f32 v[18:19], v[18:19], v[194:195]
  v_pk_add_f32 v[16:17], v[16:17], v[196:197]
  v_pk_add_f32 v[18:19], v[18:19], v[198:199]
  v_pk_add_f32 v[16:17], v[16:17], v[200:201]
  v_pk_add_f32 v[18:19], v[18:19], v[202:203]
  v_pk_add_f32 v[16:17], v[16:17], v[204:205]
  v_pk_add_f32 v[18:19], v[18:19], v[206:207]
  v_pk_add_f32 v[16:17], v[16:17], v[18:19]
  v_add_f32 v213, v16, v17
  s_nop 1
  v_add_f32_dpp v213, v213, v213 quad_perm:[1,0,3,2] row_mask:0xf bank_mask:0xf
  s_nop 1
  v_add_f32_dpp v213, v213, v213 quad_perm:[2,3,0,1] row_mask:0xf bank_mask:0xf
  s_nop 1
  v_add_f32_dpp v213, v213, v213 row_half_mirror row_mask:0xf bank_mask:0xf
  s_nop 1
  v_add_f32_dpp v213, v213, v213 row_mirror row_mask:0xf bank_mask:0xf
  v_mov_b32 v214, v213
  s_nop 1
  v_permlane16_swap_b32 v213, v214
  v_add_f32 v213, v213, v214
  v_mul_f32 v216, 0xbacccccd, v213
  v_mul_f32 v217, 0xbacccccd, v213
  v_pk_add_f32 v[20:21], v[184:185], v[216:217]
  v_pk_mul_f32 v[16:17], v[20:21], v[20:21]
  v_pk_add_f32 v[22:23], v[186:187], v[216:217]
  v_pk_fma_f32 v[16:17], v[22:23], v[22:23], v[16:17]
  v_pk_add_f32 v[24:25], v[188:189], v[216:217]
  v_pk_fma_f32 v[16:17], v[24:25], v[24:25], v[16:17]
  v_pk_add_f32 v[26:27], v[190:191], v[216:217]
  v_pk_fma_f32 v[16:17], v[26:27], v[26:27], v[16:17]
  v_pk_add_f32 v[20:21], v[192:193], v[216:217]
  v_pk_fma_f32 v[16:17], v[20:21], v[20:21], v[16:17]
  v_pk_add_f32 v[22:23], v[194:195], v[216:217]
  v_pk_fma_f32 v[16:17], v[22:23], v[22:23], v[16:17]
  v_pk_add_f32 v[24:25], v[196:197], v[216:217]
  v_pk_fma_f32 v[16:17], v[24:25], v[24:25], v[16:17]
  v_pk_add_f32 v[26:27], v[198:199], v[216:217]
  v_pk_fma_f32 v[16:17], v[26:27], v[26:27], v[16:17]
  v_pk_add_f32 v[20:21], v[200:201], v[216:217]
  v_pk_mul_f32 v[18:19], v[20:21], v[20:21]
  v_pk_add_f32 v[22:23], v[202:203], v[216:217]
  v_pk_fma_f32 v[18:19], v[22:23], v[22:23], v[18:19]
  v_pk_add_f32 v[24:25], v[204:205], v[216:217]
  v_pk_fma_f32 v[18:19], v[24:25], v[24:25], v[18:19]
  v_pk_add_f32 v[26:27], v[206:207], v[216:217]
  v_pk_fma_f32 v[18:19], v[26:27], v[26:27], v[18:19]
  v_add_f32 v18, v18, v19
  v_add_f32 v213, v16, v17
  v_cndmask_b32 v18, 0, v18, s[64:65]
  v_add_f32 v213, v213, v18
  s_nop 1
  v_add_f32_dpp v213, v213, v213 quad_perm:[1,0,3,2] row_mask:0xf bank_mask:0xf
  s_nop 1
  v_add_f32_dpp v213, v213, v213 quad_perm:[2,3,0,1] row_mask:0xf bank_mask:0xf
  s_nop 1
  v_add_f32_dpp v213, v213, v213 row_half_mirror row_mask:0xf bank_mask:0xf
  s_nop 1
  v_add_f32_dpp v213, v213, v213 row_mirror row_mask:0xf bank_mask:0xf
  v_mov_b32 v214, v213
  s_nop 1
  v_permlane16_swap_b32 v213, v214
  v_add_f32 v213, v213, v214
  v_mul_f32 v213, 0x3acccccd, v213
  v_cvt_pk_bf16_f32 v213, v213, v213
  v_and_b32 v213, 0xffff0000, v213
  v_add_f32 v213, 0x3727c5ac, v213
  v_cvt_pk_bf16_f32 v213, v213, v213
  v_and_b32 v213, 0xffff0000, v213
  v_sqrt_f32 v213, v213
  v_cvt_pk_bf16_f32 v216, v216, v216
  v_and_b32 v216, 0xffff0000, v216
  v_cvt_pk_bf16_f32 v213, v213, v213
  v_and_b32 v213, 0xffff0000, v213
  v_rcp_f32 v28, v213
  v_mov_b32 v217, v216
  v_mov_b32 v29, v28
  v_pk_add_f32 v[184:185], v[184:185], v[216:217]
  v_lshlrev_b32 v16, 16, v172
  v_cvt_pk_bf16_f32 v185, v184, v185
  v_and_b32 v17, 0xffff0000, v172
  v_lshlrev_b32 v184, 16, v185
  v_and_b32 v185, 0xffff0000, v185
  v_pk_mul_f32 v[184:185], v[184:185], v[28:29]
  v_cvt_pk_bf16_f32 v160, v184, v185
  v_lshlrev_b32 v184, 16, v160
  v_and_b32 v185, 0xffff0000, v160
  v_pk_mul_f32 v[218:219], v[184:185], v[16:17]
  v_pk_add_f32 v[186:187], v[186:187], v[216:217]
  v_lshlrev_b32 v18, 16, v173
  v_cvt_pk_bf16_f32 v187, v186, v187
  v_and_b32 v19, 0xffff0000, v173
  v_lshlrev_b32 v186, 16, v187
  v_and_b32 v187, 0xffff0000, v187
  v_pk_mul_f32 v[186:187], v[186:187], v[28:29]
  v_cvt_pk_bf16_f32 v161, v186, v187
  v_lshlrev_b32 v186, 16, v161
  v_and_b32 v187, 0xffff0000, v161
  v_pk_fma_f32 v[218:219], v[186:187], v[18:19], v[218:219]
  v_pk_add_f32 v[188:189], v[188:189], v[216:217]
  v_lshlrev_b32 v16, 16, v174
  v_cvt_pk_bf16_f32 v189, v188, v189
  v_and_b32 v17, 0xffff0000, v174
  v_lshlrev_b32 v188, 16, v189
  v_and_b32 v189, 0xffff0000, v189
  v_pk_mul_f32 v[188:189], v[188:189], v[28:29]
  v_cvt_pk_bf16_f32 v162, v188, v189
  v_lshlrev_b32 v188, 16, v162
  v_and_b32 v189, 0xffff0000, v162
  v_pk_fma_f32 v[218:219], v[188:189], v[16:17], v[218:219]
  v_pk_add_f32 v[190:191], v[190:191], v[216:217]
  v_lshlrev_b32 v18, 16, v175
  v_cvt_pk_bf16_f32 v191, v190, v191
  v_and_b32 v19, 0xffff0000, v175
  v_lshlrev_b32 v190, 16, v191
  v_and_b32 v191, 0xffff0000, v191
  v_pk_mul_f32 v[190:191], v[190:191], v[28:29]
  v_cvt_pk_bf16_f32 v163, v190, v191
  v_lshlrev_b32 v190, 16, v163
  v_and_b32 v191, 0xffff0000, v163
  v_pk_fma_f32 v[218:219], v[190:191], v[18:19], v[218:219]
  ds_write_b128 v220, v[160:163] offset:0
  v_pk_add_f32 v[192:193], v[192:193], v[216:217]
  v_lshlrev_b32 v16, 16, v176
  v_cvt_pk_bf16_f32 v193, v192, v193
  v_and_b32 v17, 0xffff0000, v176
  v_lshlrev_b32 v192, 16, v193
  v_and_b32 v193, 0xffff0000, v193
  v_pk_mul_f32 v[192:193], v[192:193], v[28:29]
  v_cvt_pk_bf16_f32 v164, v192, v193
  v_lshlrev_b32 v192, 16, v164
  v_and_b32 v193, 0xffff0000, v164
  v_pk_fma_f32 v[218:219], v[192:193], v[16:17], v[218:219]
  v_pk_add_f32 v[194:195], v[194:195], v[216:217]
  v_lshlrev_b32 v18, 16, v177
  v_cvt_pk_bf16_f32 v195, v194, v195
  v_and_b32 v19, 0xffff0000, v177
  v_lshlrev_b32 v194, 16, v195
  v_and_b32 v195, 0xffff0000, v195
  v_pk_mul_f32 v[194:195], v[194:195], v[28:29]
  v_cvt_pk_bf16_f32 v165, v194, v195
  v_lshlrev_b32 v194, 16, v165
  v_and_b32 v195, 0xffff0000, v165
  v_pk_fma_f32 v[218:219], v[194:195], v[18:19], v[218:219]
  v_pk_add_f32 v[196:197], v[196:197], v[216:217]
  v_lshlrev_b32 v16, 16, v178
  v_cvt_pk_bf16_f32 v197, v196, v197
  v_and_b32 v17, 0xffff0000, v178
  v_lshlrev_b32 v196, 16, v197
  v_and_b32 v197, 0xffff0000, v197
  v_pk_mul_f32 v[196:197], v[196:197], v[28:29]
  v_cvt_pk_bf16_f32 v166, v196, v197
  v_lshlrev_b32 v196, 16, v166
  v_and_b32 v197, 0xffff0000, v166
  v_pk_fma_f32 v[218:219], v[196:197], v[16:17], v[218:219]
  v_pk_add_f32 v[198:199], v[198:199], v[216:217]
  v_lshlrev_b32 v18, 16, v179
  v_cvt_pk_bf16_f32 v199, v198, v199
  v_and_b32 v19, 0xffff0000, v179
  v_lshlrev_b32 v198, 16, v199
  v_and_b32 v199, 0xffff0000, v199
  v_pk_mul_f32 v[198:199], v[198:199], v[28:29]
  v_cvt_pk_bf16_f32 v167, v198, v199
  v_lshlrev_b32 v198, 16, v167
  v_and_b32 v199, 0xffff0000, v167
  v_pk_fma_f32 v[218:219], v[198:199], v[18:19], v[218:219]
  ds_write_b128 v220, v[164:167] offset:4096
  v_pk_add_f32 v[200:201], v[200:201], v[216:217]
  v_lshlrev_b32 v16, 16, v180
  v_cvt_pk_bf16_f32 v201, v200, v201
  v_and_b32 v17, 0xffff0000, v180
  v_lshlrev_b32 v200, 16, v201
  v_and_b32 v201, 0xffff0000, v201
  v_pk_mul_f32 v[200:201], v[200:201], v[28:29]
  v_cvt_pk_bf16_f32 v168, v200, v201
  v_lshlrev_b32 v200, 16, v168
  v_and_b32 v201, 0xffff0000, v168
  v_pk_fma_f32 v[218:219], v[200:201], v[16:17], v[218:219]
  v_pk_add_f32 v[202:203], v[202:203], v[216:217]
  v_lshlrev_b32 v18, 16, v181
  v_cvt_pk_bf16_f32 v203, v202, v203
  v_and_b32 v19, 0xffff0000, v181
  v_lshlrev_b32 v202, 16, v203
  v_and_b32 v203, 0xffff0000, v203
  v_pk_mul_f32 v[202:203], v[202:203], v[28:29]
  v_cvt_pk_bf16_f32 v169, v202, v203
  v_lshlrev_b32 v202, 16, v169
  v_and_b32 v203, 0xffff0000, v169
  v_pk_fma_f32 v[218:219], v[202:203], v[18:19], v[218:219]
  v_pk_add_f32 v[204:205], v[204:205], v[216:217]
  v_lshlrev_b32 v16, 16, v182
  v_cvt_pk_bf16_f32 v205, v204, v205
  v_and_b32 v17, 0xffff0000, v182
  v_lshlrev_b32 v204, 16, v205
  v_and_b32 v205, 0xffff0000, v205
  v_pk_mul_f32 v[204:205], v[204:205], v[28:29]
  v_cvt_pk_bf16_f32 v170, v204, v205
  v_lshlrev_b32 v204, 16, v170
  v_and_b32 v205, 0xffff0000, v170
  v_pk_fma_f32 v[218:219], v[204:205], v[16:17], v[218:219]
  v_pk_add_f32 v[206:207], v[206:207], v[216:217]
  v_lshlrev_b32 v18, 16, v183
  v_cvt_pk_bf16_f32 v207, v206, v207
  v_and_b32 v19, 0xffff0000, v183
  v_lshlrev_b32 v206, 16, v207
  v_and_b32 v207, 0xffff0000, v207
  v_pk_mul_f32 v[206:207], v[206:207], v[28:29]
  v_cvt_pk_bf16_f32 v171, v206, v207
  v_lshlrev_b32 v206, 16, v171
  v_and_b32 v207, 0xffff0000, v171
  v_pk_fma_f32 v[218:219], v[206:207], v[18:19], v[218:219]
  ds_write_b128 v220, v[168:171] offset:8192
  v_add_f32 v218, v218, v219
  s_nop 1
  v_add_f32_dpp v218, v218, v218 quad_perm:[1,0,3,2] row_mask:0xf bank_mask:0xf
  s_nop 1
  v_add_f32_dpp v218, v218, v218 quad_perm:[2,3,0,1] row_mask:0xf bank_mask:0xf
  s_nop 1
  v_add_f32_dpp v218, v218, v218 row_half_mirror row_mask:0xf bank_mask:0xf
  s_nop 1
  v_add_f32_dpp v218, v218, v218 row_mirror row_mask:0xf bank_mask:0xf
  v_mov_b32 v214, v218
  s_nop 1
  v_permlane16_swap_b32 v218, v214
  v_add_f32 v218, v218, v214
  v_cvt_pk_bf16_f32 v218, v218, v218
  v_and_b32 v218, 0xffff0000, v218
  v_ashrrev_i32 v214, 31, v218
  v_or_b32 v214, 0x80000000, v214
  v_xor_b32 v218, v218, v214
  v_and_b32 v218, 0xffff0000, v218
  v_or_b32 v218, v218, v209
  v_mov_b32 v19, 1073741824
  s_mov_b32 m0, s24
  s_nop 0
  buffer_load_dwordx4 v3, s[32:35], s26 offen offset:0 sc1 lds
  buffer_load_dwordx4 v4, s[32:35], s26 offen offset:1024 sc1 lds
  buffer_load_dwordx4 v5, s[32:35], s26 offen offset:2048 sc1 lds
  buffer_load_dwordx4 v6, s[32:35], s26 offen offset:3072 sc1 lds
  s_add_u32 m0, s24, 16384
  s_nop 0
  buffer_load_dwordx4 v8, s[36:39], s27 offen offset:0 lds
  buffer_load_dwordx4 v9, s[36:39], s27 offen offset:1024 lds
  buffer_load_dwordx4 v10, s[36:39], s27 offen offset:2048 lds
  buffer_load_dwordx4 v11, s[36:39], s27 offen offset:3072 lds
  s_add_u32 s26, s26, s79
  s_add_u32 s27, s27, s25
  s_add_u32 s24, s24, 32768
  s_and_b32 s24, s24, 0x1ffff
  s_mov_b32 m0, s24
  s_nop 0
  buffer_load_dwordx4 v3, s[32:35], s26 offen offset:0 sc1 lds
  buffer_load_dwordx4 v4, s[32:35], s26 offen offset:1024 sc1 lds
  buffer_load_dwordx4 v5, s[32:35], s26 offen offset:2048 sc1 lds
  buffer_load_dwordx4 v6, s[32:35], s26 offen offset:3072 sc1 lds
  s_add_u32 m0, s24, 16384
  s_nop 0
  buffer_load_dwordx4 v8, s[36:39], s27 offen offset:0 lds
  buffer_load_dwordx4 v9, s[36:39], s27 offen offset:1024 lds
  buffer_load_dwordx4 v10, s[36:39], s27 offen offset:2048 lds
  buffer_load_dwordx4 v11, s[36:39], s27 offen offset:3072 lds
  s_add_u32 s26, s26, s79
  s_add_u32 s27, s27, s25
  s_add_u32 s24, s24, 32768
  s_and_b32 s24, s24, 0x1ffff
  s_mov_b32 m0, s24
  s_nop 0
  buffer_load_dwordx4 v3, s[32:35], s26 offen offset:0 sc1 lds
  buffer_load_dwordx4 v4, s[32:35], s26 offen offset:1024 sc1 lds
  buffer_load_dwordx4 v5, s[32:35], s26 offen offset:2048 sc1 lds
  buffer_load_dwordx4 v6, s[32:35], s26 offen offset:3072 sc1 lds
  s_add_u32 m0, s24, 16384
  s_nop 0
  buffer_load_dwordx4 v8, s[36:39], s27 offen offset:0 lds
  buffer_load_dwordx4 v9, s[36:39], s27 offen offset:1024 lds
  buffer_load_dwordx4 v10, s[36:39], s27 offen offset:2048 lds
  buffer_load_dwordx4 v11, s[36:39], s27 offen offset:3072 lds
  s_add_u32 s26, s26, s79
  s_add_u32 s27, s27, s25
  s_add_u32 s24, s24, 32768
  s_and_b32 s24, s24, 0x1ffff
  buffer_load_dword v231, v19, s[32:35], 0 offen
  s_mov_b32 m0, s24
  s_nop 0
  buffer_load_dwordx4 v3, s[32:35], s26 offen offset:0 sc1 lds
  buffer_load_dwordx4 v4, s[32:35], s26 offen offset:1024 sc1 lds
  buffer_load_dwordx4 v5, s[32:35], s26 offen offset:2048 sc1 lds
  buffer_load_dwordx4 v6, s[32:35], s26 offen offset:3072 sc1 lds
  s_add_u32 m0, s24, 16384
  s_nop 0
  buffer_load_dwordx4 v8, s[36:39], s27 offen offset:0 lds
  buffer_load_dwordx4 v9, s[36:39], s27 offen offset:1024 lds
  buffer_load_dwordx4 v10, s[36:39], s27 offen offset:2048 lds
  buffer_load_dwordx4 v11, s[36:39], s27 offen offset:3072 lds
  s_add_u32 s26, s26, s79
  s_add_u32 s27, s27, s25
  s_add_u32 s24, s24, 32768
  s_and_b32 s24, s24, 0x1ffff
  s_waitcnt vmcnt(25) lgkmcnt(0)
  s_barrier
  s_cmp_ge_u32 s20, 2
  s_cbranch_scc1 fa_roleV
  ds_read_b128 v[96:99], v14 offset:0
  ds_read_b128 v[100:103], v14 offset:1024
  ds_read_b128 v[104:107], v14 offset:4096
  ds_read_b128 v[108:111], v14 offset:5120
  ds_read_b128 v[112:115], v14 offset:8192
  ds_read_b128 v[116:119], v14 offset:9216
  ds_read_b128 v[120:123], v14 offset:12288
  ds_read_b128 v[124:127], v14 offset:13312
  ds_read_b64_tr_b16 v[32:33], v12 offset:0
  ds_read_b64_tr_b16 v[34:35], v12 offset:1024
  ds_read_b64_tr_b16 v[36:37], v13 offset:0
  ds_read_b64_tr_b16 v[38:39], v13 offset:1024
  ds_read_b64_tr_b16 v[40:41], v12 offset:256
  ds_read_b64_tr_b16 v[42:43], v12 offset:1280
  ds_read_b64_tr_b16 v[44:45], v13 offset:256
  ds_read_b64_tr_b16 v[46:47], v13 offset:1280
  ds_read_b64_tr_b16 v[48:49], v12 offset:512
  ds_read_b64_tr_b16 v[50:51], v12 offset:1536
  ds_read_b64_tr_b16 v[52:53], v13 offset:512
  ds_read_b64_tr_b16 v[54:55], v13 offset:1536
  ds_read_b64_tr_b16 v[56:57], v12 offset:768
  ds_read_b64_tr_b16 v[58:59], v12 offset:1792
  ds_read_b64_tr_b16 v[60:61], v13 offset:768
  ds_read_b64_tr_b16 v[62:63], v13 offset:1792
  s_waitcnt lgkmcnt(0)
.p2align 6
fa_loopK:
  v_mfma_f32_16x16x32_bf16 a[192:195], v[32:35], v[96:99], a[192:195]
  s_waitcnt vmcnt(17)
  v_mfma_f32_16x16x32_bf16 a[200:203], v[32:35], v[100:103], a[200:203]
  s_barrier
  v_mfma_f32_16x16x32_bf16 a[0:3], v[32:35], v[104:107], a[0:3]
  ds_read_b64_tr_b16 v[64:65], v12 offset:32768
  v_mfma_f32_16x16x32_bf16 a[8:11], v[32:35], v[108:111], a[8:11]
  v_mfma_f32_16x16x32_bf16 a[64:67], v[32:35], v[112:115], a[64:67]
  s_mov_b32 m0, s24
  ds_read_b64_tr_b16 v[66:67], v12 offset:33792
  v_mfma_f32_16x16x32_bf16 a[72:75], v[32:35], v[116:119], a[72:75]
  buffer_load_dwordx4 v3, s[32:35], s26 offen offset:0 sc1 lds
  v_mfma_f32_16x16x32_bf16 a[128:131], v[32:35], v[120:123], a[128:131]
  ds_read_b128 v[128:131], v14 offset:32768
  v_mfma_f32_16x16x32_bf16 a[136:139], v[32:35], v[124:127], a[136:139]
  buffer_load_dwordx4 v4, s[32:35], s26 offen offset:1024 sc1 lds
  v_mfma_f32_16x16x32_bf16 a[196:199], v[36:39], v[96:99], a[196:199]
  ds_read_b64_tr_b16 v[68:69], v13 offset:32768
  v_mfma_f32_16x16x32_bf16 a[204:207], v[36:39], v[100:103], a[204:207]
  buffer_load_dwordx4 v5, s[32:35], s26 offen offset:2048 sc1 lds
  v_mfma_f32_16x16x32_bf16 a[4:7], v[36:39], v[104:107], a[4:7]
  ds_read_b64_tr_b16 v[70:71], v13 offset:33792
  v_mfma_f32_16x16x32_bf16 a[12:15], v[36:39], v[108:111], a[12:15]
  buffer_load_dwordx4 v6, s[32:35], s26 offen offset:3072 sc1 lds
  v_mfma_f32_16x16x32_bf16 a[68:71], v[36:39], v[112:115], a[68:71]
  s_add_u32 m0, s24, 16384
  ds_read_b128 v[132:135], v14 offset:33792
  v_mfma_f32_16x16x32_bf16 a[76:79], v[36:39], v[116:119], a[76:79]
  buffer_load_dwordx4 v8, s[36:39], s27 offen offset:0 lds
  v_mfma_f32_16x16x32_bf16 a[132:135], v[36:39], v[120:123], a[132:135]
  ds_read_b64_tr_b16 v[72:73], v12 offset:33024
  v_mfma_f32_16x16x32_bf16 a[140:143], v[36:39], v[124:127], a[140:143]
  buffer_load_dwordx4 v9, s[36:39], s27 offen offset:1024 lds
  v_mfma_f32_16x16x32_bf16 a[208:211], v[40:43], v[96:99], a[208:211]
  ds_read_b64_tr_b16 v[74:75], v12 offset:34048
  v_mfma_f32_16x16x32_bf16 a[216:219], v[40:43], v[100:103], a[216:219]
  buffer_load_dwordx4 v10, s[36:39], s27 offen offset:2048 lds
  v_mfma_f32_16x16x32_bf16 a[16:19], v[40:43], v[104:107], a[16:19]
  ds_read_b128 v[136:139], v14 offset:36864
  v_mfma_f32_16x16x32_bf16 a[24:27], v[40:43], v[108:111], a[24:27]
  buffer_load_dwordx4 v11, s[36:39], s27 offen offset:3072 lds
  v_mfma_f32_16x16x32_bf16 a[80:83], v[40:43], v[112:115], a[80:83]
  ds_read_b64_tr_b16 v[76:77], v13 offset:33024
  v_mfma_f32_16x16x32_bf16 a[88:91], v[40:43], v[116:119], a[88:91]
  buffer_load_dword v231, v235, s[48:51], s74 offen sc1
  v_mfma_f32_16x16x32_bf16 a[144:147], v[40:43], v[120:123], a[144:147]
  s_add_u32 s74, s74, s73
  ds_read_b64_tr_b16 v[78:79], v13 offset:34048
  v_mfma_f32_16x16x32_bf16 a[152:155], v[40:43], v[124:127], a[152:155]
  s_bitcmp1_b32 s72, s28
  v_mfma_f32_16x16x32_bf16 a[212:215], v[44:47], v[96:99], a[212:215]
  s_cbranch_scc1 fa_hk0
fa_hb0:
  ds_read_b128 v[140:143], v14 offset:37888
  v_mfma_f32_16x16x32_bf16 a[220:223], v[44:47], v[100:103], a[220:223]
  v_mfma_f32_16x16x32_bf16 a[20:23], v[44:47], v[104:107], a[20:23]
  ds_read_b64_tr_b16 v[80:81], v12 offset:33280
  v_mfma_f32_16x16x32_bf16 a[28:31], v[44:47], v[108:111], a[28:31]
  v_mfma_f32_16x16x32_bf16 a[84:87], v[44:47], v[112:115], a[84:87]
  ds_read_b64_tr_b16 v[82:83], v12 offset:34304
  v_mfma_f32_16x16x32_bf16 a[92:95], v[44:47], v[116:119], a[92:95]
  v_mfma_f32_16x16x32_bf16 a[148:151], v[44:47], v[120:123], a[148:151]
  ds_read_b128 v[144:147], v14 offset:40960
  v_mfma_f32_16x16x32_bf16 a[156:159], v[44:47], v[124:127], a[156:159]
  v_mfma_f32_16x16x32_bf16 a[224:227], v[48:51], v[96:99], a[224:227]
  ds_read_b64_tr_b16 v[84:85], v13 offset:33280
  v_mfma_f32_16x16x32_bf16 a[232:235], v[48:51], v[100:103], a[232:235]
  v_mfma_f32_16x16x32_bf16 a[32:35], v[48:51], v[104:107], a[32:35]
  ds_read_b64_tr_b16 v[86:87], v13 offset:34304
  v_mfma_f32_16x16x32_bf16 a[40:43], v[48:51], v[108:111], a[40:43]
  v_mfma_f32_16x16x32_bf16 a[96:99], v[48:51], v[112:115], a[96:99]
  ds_read_b128 v[148:151], v14 offset:41984
  v_mfma_f32_16x16x32_bf16 a[104:107], v[48:51], v[116:119], a[104:107]
  v_mfma_f32_16x16x32_bf16 a[160:163], v[48:51], v[120:123], a[160:163]
  ds_read_b64_tr_b16 v[88:89], v12 offset:33536
  v_mfma_f32_16x16x32_bf16 a[168:171], v[48:51], v[124:127], a[168:171]
  v_mfma_f32_16x16x32_bf16 a[228:231], v[52:55], v[96:99], a[228:231]
  ds_read_b64_tr_b16 v[90:91], v12 offset:34560
  v_mfma_f32_16x16x32_bf16 a[236:239], v[52:55], v[100:103], a[236:239]
  v_mfma_f32_16x16x32_bf16 a[36:39], v[52:55], v[104:107], a[36:39]
  ds_read_b128 v[152:155], v14 offset:45056
  v_mfma_f32_16x16x32_bf16 a[44:47], v[52:55], v[108:111], a[44:47]
  v_mfma_f32_16x16x32_bf16 a[100:103], v[52:55], v[112:115], a[100:103]
  ds_read_b64_tr_b16 v[92:93], v13 offset:33536
  v_mfma_f32_16x16x32_bf16 a[108:111], v[52:55], v[116:119], a[108:111]
  v_mfma_f32_16x16x32_bf16 a[164:167], v[52:55], v[120:123], a[164:167]
  ds_read_b64_tr_b16 v[94:95], v13 offset:34560
  v_mfma_f32_16x16x32_bf16 a[172:175], v[52:55], v[124:127], a[172:175]
  v_mfma_f32_16x16x32_bf16 a[240:243], v[56:59], v[96:99], a[240:243]
  s_add_u32 s26, s26, s79
  ds_read_b128 v[156:159], v14 offset:46080
  v_mfma_f32_16x16x32_bf16 a[248:251], v[56:59], v[100:103], a[248:251]
  s_add_u32 s27, s27, s25
  v_mfma_f32_16x16x32_bf16 a[48:51], v[56:59], v[104:107], a[48:51]
  s_add_u32 s24, s24, 32768
  v_mfma_f32_16x16x32_bf16 a[56:59], v[56:59], v[108:111], a[56:59]
  s_and_b32 s24, s24, 0x1ffff
  v_mfma_f32_16x16x32_bf16 a[112:115], v[56:59], v[112:115], a[112:115]
  v_xor_b32 v14, 0x10000, v14
  v_mfma_f32_16x16x32_bf16 a[120:123], v[56:59], v[116:119], a[120:123]
  v_xor_b32 v12, 0x10000, v12
  v_mfma_f32_16x16x32_bf16 a[176:179], v[56:59], v[120:123], a[176:179]
  v_xor_b32 v13, 0x10000, v13
  v_mfma_f32_16x16x32_bf16 a[184:187], v[56:59], v[124:127], a[184:187]
  v_mfma_f32_16x16x32_bf16 a[244:247], v[60:63], v[96:99], a[244:247]
  v_mfma_f32_16x16x32_bf16 a[252:255], v[60:63], v[100:103], a[252:255]
  v_mfma_f32_16x16x32_bf16 a[52:55], v[60:63], v[104:107], a[52:55]
  v_mfma_f32_16x16x32_bf16 a[60:63], v[60:63], v[108:111], a[60:63]
  v_mfma_f32_16x16x32_bf16 a[116:119], v[60:63], v[112:115], a[116:119]
  v_mfma_f32_16x16x32_bf16 a[124:127], v[60:63], v[116:119], a[124:127]
  v_mfma_f32_16x16x32_bf16 a[180:183], v[60:63], v[120:123], a[180:183]
  v_mfma_f32_16x16x32_bf16 a[188:191], v[60:63], v[124:127], a[188:191]
  s_waitcnt lgkmcnt(0)
  v_mfma_f32_16x16x32_bf16 a[192:195], v[64:67], v[128:131], a[192:195]
  s_waitcnt vmcnt(18)
  v_mfma_f32_16x16x32_bf16 a[200:203], v[64:67], v[132:135], a[200:203]
  s_barrier
  v_mfma_f32_16x16x32_bf16 a[0:3], v[64:67], v[136:139], a[0:3]
  ds_read_b64_tr_b16 v[32:33], v12 offset:0
  v_mfma_f32_16x16x32_bf16 a[8:11], v[64:67], v[140:143], a[8:11]
  v_mfma_f32_16x16x32_bf16 a[64:67], v[64:67], v[144:147], a[64:67]
  s_mov_b32 m0, s24
  ds_read_b64_tr_b16 v[34:35], v12 offset:1024
  v_mfma_f32_16x16x32_bf16 a[72:75], v[64:67], v[148:151], a[72:75]
  buffer_load_dwordx4 v3, s[32:35], s26 offen offset:0 sc1 lds
  v_mfma_f32_16x16x32_bf16 a[128:131], v[64:67], v[152:155], a[128:131]
  ds_read_b128 v[96:99], v14 offset:0
  v_mfma_f32_16x16x32_bf16 a[136:139], v[64:67], v[156:159], a[136:139]
  v_mfma_f32_16x16x32_bf16 a[196:199], v[68:71], v[128:131], a[196:199]
  ds_read_b64_tr_b16 v[36:37], v13 offset:0
  v_mfma_f32_16x16x32_bf16 a[204:207], v[68:71], v[132:135], a[204:207]
  v_mfma_f32_16x16x32_bf16 a[4:7], v[68:71], v[136:139], a[4:7]
  ds_read_b64_tr_b16 v[38:39], v13 offset:1024
  v_mfma_f32_16x16x32_bf16 a[12:15], v[68:71], v[140:143], a[12:15]
  buffer_load_dwordx4 v4, s[32:35], s26 offen offset:1024 sc1 lds
  v_mfma_f32_16x16x32_bf16 a[68:71], v[68:71], v[144:147], a[68:71]
  ds_read_b128 v[100:103], v14 offset:1024
  v_mfma_f32_16x16x32_bf16 a[76:79], v[68:71], v[148:151], a[76:79]
  v_mfma_f32_16x16x32_bf16 a[132:135], v[68:71], v[152:155], a[132:135]
  ds_read_b64_tr_b16 v[40:41], v12 offset:256
  v_mfma_f32_16x16x32_bf16 a[140:143], v[68:71], v[156:159], a[140:143]
  v_mfma_f32_16x16x32_bf16 a[208:211], v[72:75], v[128:131], a[208:211]
  ds_read_b64_tr_b16 v[42:43], v12 offset:1280
  v_mfma_f32_16x16x32_bf16 a[216:219], v[72:75], v[132:135], a[216:219]
  buffer_load_dwordx4 v5, s[32:35], s26 offen offset:2048 sc1 lds
  v_mfma_f32_16x16x32_bf16 a[16:19], v[72:75], v[136:139], a[16:19]
  ds_read_b128 v[104:107], v14 offset:4096
  v_mfma_f32_16x16x32_bf16 a[24:27], v[72:75], v[140:143], a[24:27]
  v_mfma_f32_16x16x32_bf16 a[80:83], v[72:75], v[144:147], a[80:83]
  ds_read_b64_tr_b16 v[44:45], v13 offset:256
  v_mfma_f32_16x16x32_bf16 a[88:91], v[72:75], v[148:151], a[88:91]
  v_mfma_f32_16x16x32_bf16 a[144:147], v[72:75], v[152:155], a[144:147]
  ds_read_b64_tr_b16 v[46:47], v13 offset:1280
  v_mfma_f32_16x16x32_bf16 a[152:155], v[72:75], v[156:159], a[152:155]
  buffer_load_dwordx4 v6, s[32:35], s26 offen offset:3072 sc1 lds
  v_mfma_f32_16x16x32_bf16 a[212:215], v[76:79], v[128:131], a[212:215]
  ds_read_b128 v[108:111], v14 offset:5120
  v_mfma_f32_16x16x32_bf16 a[220:223], v[76:79], v[132:135], a[220:223]
  v_mfma_f32_16x16x32_bf16 a[20:23], v[76:79], v[136:139], a[20:23]
  ds_read_b64_tr_b16 v[48:49], v12 offset:512
  v_mfma_f32_16x16x32_bf16 a[28:31], v[76:79], v[140:143], a[28:31]
  v_mfma_f32_16x16x32_bf16 a[84:87], v[76:79], v[144:147], a[84:87]
  s_add_u32 m0, s24, 16384
  ds_read_b64_tr_b16 v[50:51], v12 offset:1536
  v_mfma_f32_16x16x32_bf16 a[92:95], v[76:79], v[148:151], a[92:95]
  buffer_load_dwordx4 v8, s[36:39], s27 offen offset:0 lds
  v_mfma_f32_16x16x32_bf16 a[148:151], v[76:79], v[152:155], a[148:151]
  ds_read_b128 v[112:115], v14 offset:8192
  v_mfma_f32_16x16x32_bf16 a[156:159], v[76:79], v[156:159], a[156:159]
  v_mfma_f32_16x16x32_bf16 a[224:227], v[80:83], v[128:131], a[224:227]
  ds_read_b64_tr_b16 v[52:53], v13 offset:512
  v_mfma_f32_16x16x32_bf16 a[232:235], v[80:83], v[132:135], a[232:235]
  v_mfma_f32_16x16x32_bf16 a[32:35], v[80:83], v[136:139], a[32:35]
  ds_read_b64_tr_b16 v[54:55], v13 offset:1536
  v_mfma_f32_16x16x32_bf16 a[40:43], v[80:83], v[140:143], a[40:43]
  buffer_load_dwordx4 v9, s[36:39], s27 offen offset:1024 lds
  v_mfma_f32_16x16x32_bf16 a[96:99], v[80:83], v[144:147], a[96:99]
  ds_read_b128 v[116:119], v14 offset:9216
  v_mfma_f32_16x16x32_bf16 a[104:107], v[80:83], v[148:151], a[104:107]
  v_mfma_f32_16x16x32_bf16 a[160:163], v[80:83], v[152:155], a[160:163]
  ds_read_b64_tr_b16 v[56:57], v12 offset:768
  v_mfma_f32_16x16x32_bf16 a[168:171], v[80:83], v[156:159], a[168:171]
  v_mfma_f32_16x16x32_bf16 a[228:231], v[84:87], v[128:131], a[228:231]
  ds_read_b64_tr_b16 v[58:59], v12 offset:1792
  v_mfma_f32_16x16x32_bf16 a[236:239], v[84:87], v[132:135], a[236:239]
  buffer_load_dwordx4 v10, s[36:39], s27 offen offset:2048 lds
  v_mfma_f32_16x16x32_bf16 a[36:39], v[84:87], v[136:139], a[36:39]
  ds_read_b128 v[120:123], v14 offset:12288
  v_mfma_f32_16x16x32_bf16 a[44:47], v[84:87], v[140:143], a[44:47]
  v_mfma_f32_16x16x32_bf16 a[100:103], v[84:87], v[144:147], a[100:103]
  ds_read_b64_tr_b16 v[60:61], v13 offset:768
  v_mfma_f32_16x16x32_bf16 a[108:111], v[84:87], v[148:151], a[108:111]
  v_mfma_f32_16x16x32_bf16 a[164:167], v[84:87], v[152:155], a[164:167]
  ds_read_b64_tr_b16 v[62:63], v13 offset:1792
  v_mfma_f32_16x16x32_bf16 a[172:175], v[84:87], v[156:159], a[172:175]
  buffer_load_dwordx4 v11, s[36:39], s27 offen offset:3072 lds
  v_mfma_f32_16x16x32_bf16 a[240:243], v[88:91], v[128:131], a[240:243]
  s_add_u32 s26, s26, s79
  ds_read_b128 v[124:127], v14 offset:13312
  v_mfma_f32_16x16x32_bf16 a[248:251], v[88:91], v[132:135], a[248:251]
  s_add_u32 s27, s27, s25
  v_mfma_f32_16x16x32_bf16 a[48:51], v[88:91], v[136:139], a[48:51]
  s_add_u32 s24, s24, 32768
  v_mfma_f32_16x16x32_bf16 a[56:59], v[88:91], v[140:143], a[56:59]
  s_and_b32 s24, s24, 0x1ffff
  v_mfma_f32_16x16x32_bf16 a[112:115], v[88:91], v[144:147], a[112:115]
  v_mfma_f32_16x16x32_bf16 a[120:123], v[88:91], v[148:151], a[120:123]
  s_bitcmp1_b32 s76, s28
  v_mfma_f32_16x16x32_bf16 a[176:179], v[88:91], v[152:155], a[176:179]
  s_cbranch_scc1 fa_hk1
fa_hb1:
  v_mfma_f32_16x16x32_bf16 a[184:187], v[88:91], v[156:159], a[184:187]
  v_mfma_f32_16x16x32_bf16 a[244:247], v[92:95], v[128:131], a[244:247]
  v_mfma_f32_16x16x32_bf16 a[252:255], v[92:95], v[132:135], a[252:255]
  s_add_u32 s28, s28, 1
  v_mfma_f32_16x16x32_bf16 a[52:55], v[92:95], v[136:139], a[52:55]
  v_mfma_f32_16x16x32_bf16 a[60:63], v[92:95], v[140:143], a[60:63]
  v_mfma_f32_16x16x32_bf16 a[116:119], v[92:95], v[144:147], a[116:119]
  v_mfma_f32_16x16x32_bf16 a[124:127], v[92:95], v[148:151], a[124:127]
  s_cmp_lt_u32 s28, 8
  v_mfma_f32_16x16x32_bf16 a[180:183], v[92:95], v[152:155], a[180:183]
  s_waitcnt lgkmcnt(0)
  v_mfma_f32_16x16x32_bf16 a[188:191], v[92:95], v[156:159], a[188:191]
  s_cbranch_scc1 fa_loopK
  s_mov_b32 s64, 16777216
  s_mov_b32 s76, 0x3e0293ee
  s_branch fa_p1epi
fa_roleV:
  ds_read_b128 v[32:35], v14 offset:0
  ds_read_b128 v[36:39], v14 offset:1024
  ds_read_b128 v[40:43], v14 offset:4096
  ds_read_b128 v[44:47], v14 offset:5120
  ds_read_b128 v[48:51], v14 offset:8192
  ds_read_b128 v[52:55], v14 offset:9216
  ds_read_b128 v[56:59], v14 offset:12288
  ds_read_b128 v[60:63], v14 offset:13312
  ds_read_b64_tr_b16 v[96:97], v12 offset:0
  ds_read_b64_tr_b16 v[98:99], v12 offset:1024
  ds_read_b64_tr_b16 v[100:101], v13 offset:0
  ds_read_b64_tr_b16 v[102:103], v13 offset:1024
  ds_read_b64_tr_b16 v[104:105], v12 offset:256
  ds_read_b64_tr_b16 v[106:107], v12 offset:1280
  ds_read_b64_tr_b16 v[108:109], v13 offset:256
  ds_read_b64_tr_b16 v[110:111], v13 offset:1280
  ds_read_b64_tr_b16 v[112:113], v12 offset:512
  ds_read_b64_tr_b16 v[114:115], v12 offset:1536
  ds_read_b64_tr_b16 v[116:117], v13 offset:512
  ds_read_b64_tr_b16 v[118:119], v13 offset:1536
  ds_read_b64_tr_b16 v[120:121], v12 offset:768
  ds_read_b64_tr_b16 v[122:123], v12 offset:1792
  ds_read_b64_tr_b16 v[124:125], v13 offset:768
  ds_read_b64_tr_b16 v[126:127], v13 offset:1792
  s_waitcnt lgkmcnt(0)
.p2align 6
fa_loopV:
  v_mfma_f32_16x16x32_bf16 a[192:195], v[32:35], v[96:99], a[192:195]
  s_waitcnt vmcnt(17)
  v_mfma_f32_16x16x32_bf16 a[200:203], v[32:35], v[100:103], a[200:203]
  s_barrier
  v_mfma_f32_16x16x32_bf16 a[208:211], v[32:35], v[104:107], a[208:211]
  ds_read_b64_tr_b16 v[128:129], v12 offset:32768
  v_mfma_f32_16x16x32_bf16 a[216:219], v[32:35], v[108:111], a[216:219]
  v_mfma_f32_16x16x32_bf16 a[224:227], v[32:35], v[112:115], a[224:227]
  s_mov_b32 m0, s24
  ds_read_b64_tr_b16 v[130:131], v12 offset:33792
  v_mfma_f32_16x16x32_bf16 a[232:235], v[32:35], v[116:119], a[232:235]
  buffer_load_dwordx4 v3, s[32:35], s26 offen offset:0 sc1 lds
  v_mfma_f32_16x16x32_bf16 a[240:243], v[32:35], v[120:123], a[240:243]
  ds_read_b128 v[64:67], v14 offset:32768
  v_mfma_f32_16x16x32_bf16 a[248:251], v[32:35], v[124:127], a[248:251]
  buffer_load_dwordx4 v4, s[32:35], s26 offen offset:1024 sc1 lds
  v_mfma_f32_16x16x32_bf16 a[196:199], v[36:39], v[96:99], a[196:199]
  ds_read_b64_tr_b16 v[132:133], v13 offset:32768
  v_mfma_f32_16x16x32_bf16 a[204:207], v[36:39], v[100:103], a[204:207]
  buffer_load_dwordx4 v5, s[32:35], s26 offen offset:2048 sc1 lds
  v_mfma_f32_16x16x32_bf16 a[212:215], v[36:39], v[104:107], a[212:215]
  ds_read_b64_tr_b16 v[134:135], v13 offset:33792
  v_mfma_f32_16x16x32_bf16 a[220:223], v[36:39], v[108:111], a[220:223]
  buffer_load_dwordx4 v6, s[32:35], s26 offen offset:3072 sc1 lds
  v_mfma_f32_16x16x32_bf16 a[228:231], v[36:39], v[112:115], a[228:231]
  s_add_u32 m0, s24, 16384
  ds_read_b128 v[68:71], v14 offset:33792
  v_mfma_f32_16x16x32_bf16 a[236:239], v[36:39], v[116:119], a[236:239]
  buffer_load_dwordx4 v8, s[36:39], s27 offen offset:0 lds
  v_mfma_f32_16x16x32_bf16 a[244:247], v[36:39], v[120:123], a[244:247]
  ds_read_b64_tr_b16 v[136:137], v12 offset:33024
  v_mfma_f32_16x16x32_bf16 a[252:255], v[36:39], v[124:127], a[252:255]
  buffer_load_dwordx4 v9, s[36:39], s27 offen offset:1024 lds
  v_mfma_f32_16x16x32_bf16 a[0:3], v[40:43], v[96:99], a[0:3]
  ds_read_b64_tr_b16 v[138:139], v12 offset:34048
  v_mfma_f32_16x16x32_bf16 a[8:11], v[40:43], v[100:103], a[8:11]
  buffer_load_dwordx4 v10, s[36:39], s27 offen offset:2048 lds
  v_mfma_f32_16x16x32_bf16 a[16:19], v[40:43], v[104:107], a[16:19]
  ds_read_b128 v[72:75], v14 offset:36864
  v_mfma_f32_16x16x32_bf16 a[24:27], v[40:43], v[108:111], a[24:27]
  buffer_load_dwordx4 v11, s[36:39], s27 offen offset:3072 lds
  v_mfma_f32_16x16x32_bf16 a[32:35], v[40:43], v[112:115], a[32:35]
  ds_read_b64_tr_b16 v[140:141], v13 offset:33024
  v_mfma_f32_16x16x32_bf16 a[40:43], v[40:43], v[116:119], a[40:43]
  buffer_load_dword v231, v235, s[48:51], s74 offen sc1
  v_mfma_f32_16x16x32_bf16 a[48:51], v[40:43], v[120:123], a[48:51]
  s_add_u32 s74, s74, s73
  ds_read_b64_tr_b16 v[142:143], v13 offset:34048
  v_mfma_f32_16x16x32_bf16 a[56:59], v[40:43], v[124:127], a[56:59]
  s_bitcmp1_b32 s72, s28
  v_mfma_f32_16x16x32_bf16 a[4:7], v[44:47], v[96:99], a[4:7]
  s_cbranch_scc1 fa_hk2
fa_hb2:
  ds_read_b128 v[76:79], v14 offset:37888
  v_mfma_f32_16x16x32_bf16 a[12:15], v[44:47], v[100:103], a[12:15]
  v_mfma_f32_16x16x32_bf16 a[20:23], v[44:47], v[104:107], a[20:23]
  ds_read_b64_tr_b16 v[144:145], v12 offset:33280
  v_mfma_f32_16x16x32_bf16 a[28:31], v[44:47], v[108:111], a[28:31]
  v_mfma_f32_16x16x32_bf16 a[36:39], v[44:47], v[112:115], a[36:39]
  ds_read_b64_tr_b16 v[146:147], v12 offset:34304
  v_mfma_f32_16x16x32_bf16 a[44:47], v[44:47], v[116:119], a[44:47]
  v_mfma_f32_16x16x32_bf16 a[52:55], v[44:47], v[120:123], a[52:55]
  ds_read_b128 v[80:83], v14 offset:40960
  v_mfma_f32_16x16x32_bf16 a[60:63], v[44:47], v[124:127], a[60:63]
  v_mfma_f32_16x16x32_bf16 a[64:67], v[48:51], v[96:99], a[64:67]
  ds_read_b64_tr_b16 v[148:149], v13 offset:33280
  v_mfma_f32_16x16x32_bf16 a[72:75], v[48:51], v[100:103], a[72:75]
  v_mfma_f32_16x16x32_bf16 a[80:83], v[48:51], v[104:107], a[80:83]
  ds_read_b64_tr_b16 v[150:151], v13 offset:34304
  v_mfma_f32_16x16x32_bf16 a[88:91], v[48:51], v[108:111], a[88:91]
  v_mfma_f32_16x16x32_bf16 a[96:99], v[48:51], v[112:115], a[96:99]
  ds_read_b128 v[84:87], v14 offset:41984
  v_mfma_f32_16x16x32_bf16 a[104:107], v[48:51], v[116:119], a[104:107]
  v_mfma_f32_16x16x32_bf16 a[112:115], v[48:51], v[120:123], a[112:115]
  ds_read_b64_tr_b16 v[152:153], v12 offset:33536
  v_mfma_f32_16x16x32_bf16 a[120:123], v[48:51], v[124:127], a[120:123]
  v_mfma_f32_16x16x32_bf16 a[68:71], v[52:55], v[96:99], a[68:71]
  ds_read_b64_tr_b16 v[154:155], v12 offset:34560
  v_mfma_f32_16x16x32_bf16 a[76:79], v[52:55], v[100:103], a[76:79]
  v_mfma_f32_16x16x32_bf16 a[84:87], v[52:55], v[104:107], a[84:87]
  ds_read_b128 v[88:91], v14 offset:45056
  v_mfma_f32_16x16x32_bf16 a[92:95], v[52:55], v[108:111], a[92:95]
  v_mfma_f32_16x16x32_bf16 a[100:103], v[52:55], v[112:115], a[100:103]
  ds_read_b64_tr_b16 v[156:157], v13 offset:33536
  v_mfma_f32_16x16x32_bf16 a[108:111], v[52:55], v[116:119], a[108:111]
  v_mfma_f32_16x16x32_bf16 a[116:119], v[52:55], v[120:123], a[116:119]
  ds_read_b64_tr_b16 v[158:159], v13 offset:34560
  v_mfma_f32_16x16x32_bf16 a[124:127], v[52:55], v[124:127], a[124:127]
  v_mfma_f32_16x16x32_bf16 a[128:131], v[56:59], v[96:99], a[128:131]
  s_add_u32 s26, s26, s79
  ds_read_b128 v[92:95], v14 offset:46080
  v_mfma_f32_16x16x32_bf16 a[136:139], v[56:59], v[100:103], a[136:139]
  s_add_u32 s27, s27, s25
  v_mfma_f32_16x16x32_bf16 a[144:147], v[56:59], v[104:107], a[144:147]
  s_add_u32 s24, s24, 32768
  v_mfma_f32_16x16x32_bf16 a[152:155], v[56:59], v[108:111], a[152:155]
  s_and_b32 s24, s24, 0x1ffff
  v_mfma_f32_16x16x32_bf16 a[160:163], v[56:59], v[112:115], a[160:163]
  v_xor_b32 v14, 0x10000, v14
  v_mfma_f32_16x16x32_bf16 a[168:171], v[56:59], v[116:119], a[168:171]
  v_xor_b32 v12, 0x10000, v12
  v_mfma_f32_16x16x32_bf16 a[176:179], v[56:59], v[120:123], a[176:179]
  v_xor_b32 v13, 0x10000, v13
  v_mfma_f32_16x16x32_bf16 a[184:187], v[56:59], v[124:127], a[184:187]
  v_mfma_f32_16x16x32_bf16 a[132:135], v[60:63], v[96:99], a[132:135]
  v_mfma_f32_16x16x32_bf16 a[140:143], v[60:63], v[100:103], a[140:143]
  v_mfma_f32_16x16x32_bf16 a[148:151], v[60:63], v[104:107], a[148:151]
  v_mfma_f32_16x16x32_bf16 a[156:159], v[60:63], v[108:111], a[156:159]
  v_mfma_f32_16x16x32_bf16 a[164:167], v[60:63], v[112:115], a[164:167]
  v_mfma_f32_16x16x32_bf16 a[172:175], v[60:63], v[116:119], a[172:175]
  v_mfma_f32_16x16x32_bf16 a[180:183], v[60:63], v[120:123], a[180:183]
  v_mfma_f32_16x16x32_bf16 a[188:191], v[60:63], v[124:127], a[188:191]
  s_waitcnt lgkmcnt(0)
  v_mfma_f32_16x16x32_bf16 a[192:195], v[64:67], v[128:131], a[192:195]
  s_waitcnt vmcnt(18)
  v_mfma_f32_16x16x32_bf16 a[200:203], v[64:67], v[132:135], a[200:203]
  s_barrier
  v_mfma_f32_16x16x32_bf16 a[208:211], v[64:67], v[136:139], a[208:211]
  ds_read_b64_tr_b16 v[96:97], v12 offset:0
  v_mfma_f32_16x16x32_bf16 a[216:219], v[64:67], v[140:143], a[216:219]
  v_mfma_f32_16x16x32_bf16 a[224:227], v[64:67], v[144:147], a[224:227]
  s_mov_b32 m0, s24
  ds_read_b64_tr_b16 v[98:99], v12 offset:1024
  v_mfma_f32_16x16x32_bf16 a[232:235], v[64:67], v[148:151], a[232:235]
  buffer_load_dwordx4 v3, s[32:35], s26 offen offset:0 sc1 lds
  v_mfma_f32_16x16x32_bf16 a[240:243], v[64:67], v[152:155], a[240:243]
  ds_read_b128 v[32:35], v14 offset:0
  v_mfma_f32_16x16x32_bf16 a[248:251], v[64:67], v[156:159], a[248:251]
  v_mfma_f32_16x16x32_bf16 a[196:199], v[68:71], v[128:131], a[196:199]
  ds_read_b64_tr_b16 v[100:101], v13 offset:0
  v_mfma_f32_16x16x32_bf16 a[204:207], v[68:71], v[132:135], a[204:207]
  v_mfma_f32_16x16x32_bf16 a[212:215], v[68:71], v[136:139], a[212:215]
  ds_read_b64_tr_b16 v[102:103], v13 offset:1024
  v_mfma_f32_16x16x32_bf16 a[220:223], v[68:71], v[140:143], a[220:223]
  buffer_load_dwordx4 v4, s[32:35], s26 offen offset:1024 sc1 lds
  v_mfma_f32_16x16x32_bf16 a[228:231], v[68:71], v[144:147], a[228:231]
  ds_read_b128 v[36:39], v14 offset:1024
  v_mfma_f32_16x16x32_bf16 a[236:239], v[68:71], v[148:151], a[236:239]
  v_mfma_f32_16x16x32_bf16 a[244:247], v[68:71], v[152:155], a[244:247]
  ds_read_b64_tr_b16 v[104:105], v12 offset:256
  v_mfma_f32_16x16x32_bf16 a[252:255], v[68:71], v[156:159], a[252:255]
  v_mfma_f32_16x16x32_bf16 a[0:3], v[72:75], v[128:131], a[0:3]
  ds_read_b64_tr_b16 v[106:107], v12 offset:1280
  v_mfma_f32_16x16x32_bf16 a[8:11], v[72:75], v[132:135], a[8:11]
  buffer_load_dwordx4 v5, s[32:35], s26 offen offset:2048 sc1 lds
  v_mfma_f32_16x16x32_bf16 a[16:19], v[72:75], v[136:139], a[16:19]
  ds_read_b128 v[40:43], v14 offset:4096
  v_mfma_f32_16x16x32_bf16 a[24:27], v[72:75], v[140:143], a[24:27]
  v_mfma_f32_16x16x32_bf16 a[32:35], v[72:75], v[144:147], a[32:35]
  ds_read_b64_tr_b16 v[108:109], v13 offset:256
  v_mfma_f32_16x16x32_bf16 a[40:43], v[72:75], v[148:151], a[40:43]
  v_mfma_f32_16x16x32_bf16 a[48:51], v[72:75], v[152:155], a[48:51]
  ds_read_b64_tr_b16 v[110:111], v13 offset:1280
  v_mfma_f32_16x16x32_bf16 a[56:59], v[72:75], v[156:159], a[56:59]
  buffer_load_dwordx4 v6, s[32:35], s26 offen offset:3072 sc1 lds
  v_mfma_f32_16x16x32_bf16 a[4:7], v[76:79], v[128:131], a[4:7]
  ds_read_b128 v[44:47], v14 offset:5120
  v_mfma_f32_16x16x32_bf16 a[12:15], v[76:79], v[132:135], a[12:15]
  v_mfma_f32_16x16x32_bf16 a[20:23], v[76:79], v[136:139], a[20:23]
  ds_read_b64_tr_b16 v[112:113], v12 offset:512
  v_mfma_f32_16x16x32_bf16 a[28:31], v[76:79], v[140:143], a[28:31]
  v_mfma_f32_16x16x32_bf16 a[36:39], v[76:79], v[144:147], a[36:39]
  s_add_u32 m0, s24, 16384
  ds_read_b64_tr_b16 v[114:115], v12 offset:1536
  v_mfma_f32_16x16x32_bf16 a[44:47], v[76:79], v[148:151], a[44:47]
  buffer_load_dwordx4 v8, s[36:39], s27 offen offset:0 lds
  v_mfma_f32_16x16x32_bf16 a[52:55], v[76:79], v[152:155], a[52:55]
  ds_read_b128 v[48:51], v14 offset:8192
  v_mfma_f32_16x16x32_bf16 a[60:63], v[76:79], v[156:159], a[60:63]
  v_mfma_f32_16x16x32_bf16 a[64:67], v[80:83], v[128:131], a[64:67]
  ds_read_b64_tr_b16 v[116:117], v13 offset:512
  v_mfma_f32_16x16x32_bf16 a[72:75], v[80:83], v[132:135], a[72:75]
  v_mfma_f32_16x16x32_bf16 a[80:83], v[80:83], v[136:139], a[80:83]
  ds_read_b64_tr_b16 v[118:119], v13 offset:1536
  v_mfma_f32_16x16x32_bf16 a[88:91], v[80:83], v[140:143], a[88:91]
  buffer_load_dwordx4 v9, s[36:39], s27 offen offset:1024 lds
  v_mfma_f32_16x16x32_bf16 a[96:99], v[80:83], v[144:147], a[96:99]
  ds_read_b128 v[52:55], v14 offset:9216
  v_mfma_f32_16x16x32_bf16 a[104:107], v[80:83], v[148:151], a[104:107]
  v_mfma_f32_16x16x32_bf16 a[112:115], v[80:83], v[152:155], a[112:115]
  ds_read_b64_tr_b16 v[120:121], v12 offset:768
  v_mfma_f32_16x16x32_bf16 a[120:123], v[80:83], v[156:159], a[120:123]
  v_mfma_f32_16x16x32_bf16 a[68:71], v[84:87], v[128:131], a[68:71]
  ds_read_b64_tr_b16 v[122:123], v12 offset:1792
  v_mfma_f32_16x16x32_bf16 a[76:79], v[84:87], v[132:135], a[76:79]
  buffer_load_dwordx4 v10, s[36:39], s27 offen offset:2048 lds
  v_mfma_f32_16x16x32_bf16 a[84:87], v[84:87], v[136:139], a[84:87]
  ds_read_b128 v[56:59], v14 offset:12288
  v_mfma_f32_16x16x32_bf16 a[92:95], v[84:87], v[140:143], a[92:95]
  v_mfma_f32_16x16x32_bf16 a[100:103], v[84:87], v[144:147], a[100:103]
  ds_read_b64_tr_b16 v[124:125], v13 offset:768
  v_mfma_f32_16x16x32_bf16 a[108:111], v[84:87], v[148:151], a[108:111]
  v_mfma_f32_16x16x32_bf16 a[116:119], v[84:87], v[152:155], a[116:119]
  ds_read_b64_tr_b16 v[126:127], v13 offset:1792
  v_mfma_f32_16x16x32_bf16 a[124:127], v[84:87], v[156:159], a[124:127]
  buffer_load_dwordx4 v11, s[36:39], s27 offen offset:3072 lds
  v_mfma_f32_16x16x32_bf16 a[128:131], v[88:91], v[128:131], a[128:131]
  s_add_u32 s26, s26, s79
  ds_read_b128 v[60:63], v14 offset:13312
  v_mfma_f32_16x16x32_bf16 a[136:139], v[88:91], v[132:135], a[136:139]
  s_add_u32 s27, s27, s25
  v_mfma_f32_16x16x32_bf16 a[144:147], v[88:91], v[136:139], a[144:147]
  s_add_u32 s24, s24, 32768
  v_mfma_f32_16x16x32_bf16 a[152:155], v[88:91], v[140:143], a[152:155]
  s_and_b32 s24, s24, 0x1ffff
  v_mfma_f32_16x16x32_bf16 a[160:163], v[88:91], v[144:147], a[160:163]
  v_mfma_f32_16x16x32_bf16 a[168:171], v[88:91], v[148:151], a[168:171]
  s_bitcmp1_b32 s76, s28
  v_mfma_f32_16x16x32_bf16 a[176:179], v[88:91], v[152:155], a[176:179]
  s_cbranch_scc1 fa_hk3
fa_hb3:
  v_mfma_f32_16x16x32_bf16 a[184:187], v[88:91], v[156:159], a[184:187]
  v_mfma_f32_16x16x32_bf16 a[132:135], v[92:95], v[128:131], a[132:135]
  v_mfma_f32_16x16x32_bf16 a[140:143], v[92:95], v[132:135], a[140:143]
  s_add_u32 s28, s28, 1
  v_mfma_f32_16x16x32_bf16 a[148:151], v[92:95], v[136:139], a[148:151]
  v_mfma_f32_16x16x32_bf16 a[156:159], v[92:95], v[140:143], a[156:159]
  v_mfma_f32_16x16x32_bf16 a[164:167], v[92:95], v[144:147], a[164:167]
  v_mfma_f32_16x16x32_bf16 a[172:175], v[92:95], v[148:151], a[172:175]
  s_cmp_lt_u32 s28, 8
  v_mfma_f32_16x16x32_bf16 a[180:183], v[92:95], v[152:155], a[180:183]
  s_waitcnt lgkmcnt(0)
  v_mfma_f32_16x16x32_bf16 a[188:191], v[92:95], v[156:159], a[188:191]
  s_cbranch_scc1 fa_loopV
  s_mov_b32 s64, 33554432
  s_mov_b32 s76, 1.0
fa_p1epi:
  s_lshr_b32 s23, s20, 1
  s_lshl_b32 s23, s23, 13
  v_subrev_u32 v12, s23, v12
  v_subrev_u32 v13, s23, v13
  s_lshl_b32 s24, s20, 12
  v_add_u32 v14, s24, v2
  ds_read_b64_tr_b16 v[32:33], v12 offset:0
  ds_read_b64_tr_b16 v[34:35], v12 offset:1024
  ds_read_b64_tr_b16 v[36:37], v13 offset:0
  ds_read_b64_tr_b16 v[38:39], v13 offset:1024
  ds_read_b64_tr_b16 v[40:41], v12 offset:256
  ds_read_b64_tr_b16 v[42:43], v12 offset:1280
  ds_read_b64_tr_b16 v[44:45], v13 offset:256
  ds_read_b64_tr_b16 v[46:47], v13 offset:1280
  ds_read_b64_tr_b16 v[48:49], v12 offset:512
  ds_read_b64_tr_b16 v[50:51], v12 offset:1536
  ds_read_b64_tr_b16 v[52:53], v13 offset:512
  ds_read_b64_tr_b16 v[54:55], v13 offset:1536
  ds_read_b64_tr_b16 v[56:57], v12 offset:768
  ds_read_b64_tr_b16 v[58:59], v12 offset:1792
  ds_read_b64_tr_b16 v[60:61], v13 offset:768
  ds_read_b64_tr_b16 v[62:63], v13 offset:1792
  s_waitcnt vmcnt(8)
  ds_read_b128 v[224:227], v14 offset:0
  ds_read_b128 v[228:231], v14 offset:1024
  ds_read_b128 v[232:235], v14 offset:2048
  ds_read_b128 v[236:239], v14 offset:3072
  s_lshl_b32 s23, s21, 19
  s_add_u32 s64, s64, s23
  s_lshl_b32 s23, s22, 14
  s_add_u32 s64, s64, s23
  s_and_b32 s23, s20, 1
  s_lshl_b32 s23, s23, 13
  s_add_u32 s64, s64, s23
  s_lshl_b32 s23, s21, 19
  s_add_u32 s23, s23, 16777216
  s_add_u32 s6, s18, s23
  s_addc_u32 s7, s19, 0
  s_add_u32 s8, s6, 16777216
  s_addc_u32 s9, s7, 0
  s_sub_u32 s23, 16, s22
  s_lshl_b32 s23, s23, 15
  s_mov_b32 s44, s6
  s_mov_b32 s45, s7
  s_mov_b32 s46, s23
  s_mov_b32 s47, 0x20000
  s_mov_b32 s48, s8
  s_mov_b32 s49, s9
  s_mov_b32 s50, s23
  s_mov_b32 s51, 0x20000
  s_lshl_b32 s30, s21, 7
  s_add_u32 s30, s30, 2637824
  s_mov_b32 s81, 0x47800000
  s_cmp_eq_u32 s20, 0
  s_cselect_b32 s65, s82, 1073741824
  s_waitcnt vmcnt(21) lgkmcnt(0)
  v_mfma_f32_16x16x32_bf16 v[96:99], v[32:35], v[224:227], 0
  v_accvgpr_read_b32 v16, a192
  v_accvgpr_read_b32 v17, a193
  v_accvgpr_read_b32 v18, a194
  v_mfma_f32_16x16x32_bf16 v[112:115], v[36:39], v[224:227], 0
  ds_read_b64_tr_b16 v[64:65], v12 offset:8192
  v_accvgpr_read_b32 v19, a195
  v_mfma_f32_16x16x32_bf16 v[128:131], v[40:43], v[224:227], 0
  s_add_u32 m0, s24, 0
  ds_read_b64_tr_b16 v[66:67], v12 offset:9216
  v_accvgpr_read_b32 v20, a196
  v_mfma_f32_16x16x32_bf16 v[144:147], v[44:47], v[224:227], 0
  buffer_load_dwordx4 v3, s[32:35], s26 offen offset:0 sc1 lds
  v_accvgpr_read_b32 v21, a197
  v_mfma_f32_16x16x32_bf16 v[160:163], v[48:51], v[224:227], 0
  ds_read_b64_tr_b16 v[68:69], v13 offset:8192
  v_accvgpr_read_b32 v22, a198
  v_accvgpr_read_b32 v23, a199
  v_mfma_f32_16x16x32_bf16 v[176:179], v[52:55], v[224:227], 0
  ds_read_b64_tr_b16 v[70:71], v13 offset:9216
  v_mul_f32 v16, s76, v16
  v_mfma_f32_16x16x32_bf16 v[192:195], v[56:59], v[224:227], 0
  ds_read_b64_tr_b16 v[72:73], v12 offset:8448
  v_mul_f32 v17, s76, v17
  v_mfma_f32_16x16x32_bf16 v[208:211], v[60:63], v[224:227], 0
  ds_read_b64_tr_b16 v[74:75], v12 offset:9472
  v_mul_f32 v18, s76, v18
  v_mfma_f32_16x16x32_bf16 v[100:103], v[32:35], v[228:231], 0
  buffer_load_dwordx4 v4, s[32:35], s26 offen offset:1024 sc1 lds
  v_mul_f32 v19, s76, v19
  v_mul_f32 v20, s76, v20
  v_mfma_f32_16x16x32_bf16 v[116:119], v[36:39], v[228:231], 0
  ds_read_b64_tr_b16 v[76:77], v13 offset:8448
  v_mul_f32 v21, s76, v21
  v_mfma_f32_16x16x32_bf16 v[132:135], v[40:43], v[228:231], 0
  ds_read_b64_tr_b16 v[78:79], v13 offset:9472
  v_mul_f32 v22, s76, v22
  v_mfma_f32_16x16x32_bf16 v[148:151], v[44:47], v[228:231], 0
  ds_read_b128 v[240:243], v14 offset:32768
  v_mul_f32 v23, s76, v23
  v_mfma_f32_16x16x32_bf16 v[164:167], v[48:51], v[228:231], 0
  ds_read_b128 v[244:247], v14 offset:33792
  v_cvt_pk_bf16_f32 v24, v16, v17
  v_cvt_pk_bf16_f32 v25, v18, v19
  v_mfma_f32_16x16x32_bf16 v[180:183], v[52:55], v[228:231], 0
  buffer_load_dwordx4 v5, s[32:35], s26 offen offset:2048 sc1 lds
  v_cvt_pk_bf16_f32 v26, v20, v21
  v_mfma_f32_16x16x32_bf16 v[196:199], v[56:59], v[228:231], 0
  ds_read_b64_tr_b16 v[80:81], v12 offset:8704
  v_cvt_pk_bf16_f32 v27, v22, v23
  v_mfma_f32_16x16x32_bf16 v[212:215], v[60:63], v[228:231], 0
  ds_read_b64_tr_b16 v[82:83], v12 offset:9728
  buffer_store_dwordx4 v[24:27], v2, s[40:43], s64 offen offset:0 sc1
  v_mfma_f32_16x16x32_bf16 v[104:107], v[32:35], v[232:235], 0
  ds_read_b64_tr_b16 v[84:85], v13 offset:8704
  v_accvgpr_read_b32 v16, a200
  v_mfma_f32_16x16x32_bf16 v[120:123], v[36:39], v[232:235], 0
  ds_read_b64_tr_b16 v[86:87], v13 offset:9728
  v_accvgpr_read_b32 v17, a201
  v_accvgpr_read_b32 v18, a202
  v_mfma_f32_16x16x32_bf16 v[136:139], v[40:43], v[232:235], 0
  buffer_load_dwordx4 v6, s[32:35], s26 offen offset:3072 sc1 lds
  v_accvgpr_read_b32 v19, a203
  v_mfma_f32_16x16x32_bf16 v[152:155], v[44:47], v[232:235], 0
  s_add_u32 s26, s26, 1024
  ds_read_b64_tr_b16 v[88:89], v12 offset:8960
  v_accvgpr_read_b32 v20, a204
  v_mfma_f32_16x16x32_bf16 v[168:171], v[48:51], v[232:235], 0
  ds_read_b64_tr_b16 v[90:91], v12 offset:9984
  v_accvgpr_read_b32 v21, a205
  v_mfma_f32_16x16x32_bf16 v[184:187], v[52:55], v[232:235], 0
  ds_read_b64_tr_b16 v[92:93], v13 offset:8960
  v_accvgpr_read_b32 v22, a206
  v_accvgpr_read_b32 v23, a207
  v_mfma_f32_16x16x32_bf16 v[200:203], v[56:59], v[232:235], 0
  ds_read_b64_tr_b16 v[94:95], v13 offset:9984
  v_mul_f32 v16, s76, v16
  v_mfma_f32_16x16x32_bf16 v[216:219], v[60:63], v[232:235], 0
  v_mul_f32 v17, s76, v17
  v_mul_f32 v18, s76, v18
  v_mfma_f32_16x16x32_bf16 v[108:111], v[32:35], v[236:239], 0
  ds_read_b128 v[248:251], v14 offset:34816
  v_mul_f32 v19, s76, v19
  v_mfma_f32_16x16x32_bf16 v[124:127], v[36:39], v[236:239], 0
  ds_read_b128 v[252:255], v14 offset:35840
  v_mul_f32 v20, s76, v20
  v_mul_f32 v21, s76, v21
  v_mfma_f32_16x16x32_bf16 v[140:143], v[40:43], v[236:239], 0
  v_mul_f32 v22, s76, v22
  v_mul_f32 v23, s76, v23
  v_mfma_f32_16x16x32_bf16 v[156:159], v[44:47], v[236:239], 0
  v_xor_b32 v14, 0x10000, v14
  v_cvt_pk_bf16_f32 v28, v16, v17
  v_mfma_f32_16x16x32_bf16 v[172:175], v[48:51], v[236:239], 0
  v_cvt_pk_bf16_f32 v29, v18, v19
  v_cvt_pk_bf16_f32 v30, v20, v21
  v_mfma_f32_16x16x32_bf16 v[188:191], v[52:55], v[236:239], 0
  v_cvt_pk_bf16_f32 v31, v22, v23
  v_mfma_f32_16x16x32_bf16 v[204:207], v[56:59], v[236:239], 0
  buffer_store_dwordx4 v[28:31], v2, s[40:43], s64 offen offset:1024 sc1
  v_mfma_f32_16x16x32_bf16 v[220:223], v[60:63], v[236:239], 0
  s_waitcnt vmcnt(19) lgkmcnt(0)
  v_mfma_f32_16x16x32_bf16 v[96:99], v[64:67], v[240:243], v[96:99]
  s_barrier
  v_accvgpr_read_b32 v16, a208
  v_accvgpr_read_b32 v17, a209
  v_accvgpr_read_b32 v18, a210
  v_mfma_f32_16x16x32_bf16 v[112:115], v[68:71], v[240:243], v[112:115]
  ds_read_b64_tr_b16 v[32:33], v12 offset:32768
  v_accvgpr_read_b32 v19, a211
  v_mfma_f32_16x16x32_bf16 v[128:131], v[72:75], v[240:243], v[128:131]
  s_add_u32 m0, s24, 32768
  ds_read_b64_tr_b16 v[34:35], v12 offset:33792
  v_accvgpr_read_b32 v20, a212
  v_mfma_f32_16x16x32_bf16 v[144:147], v[76:79], v[240:243], v[144:147]
  buffer_load_dwordx4 v3, s[32:35], s26 offen offset:0 sc1 lds
  v_accvgpr_read_b32 v21, a213
  v_mfma_f32_16x16x32_bf16 v[160:163], v[80:83], v[240:243], v[160:163]
  ds_read_b64_tr_b16 v[36:37], v13 offset:32768
  v_accvgpr_read_b32 v22, a214
  v_accvgpr_read_b32 v23, a215
  v_mfma_f32_16x16x32_bf16 v[176:179], v[84:87], v[240:243], v[176:179]
  ds_read_b64_tr_b16 v[38:39], v13 offset:33792
  v_mul_f32 v16, s76, v16
  v_mfma_f32_16x16x32_bf16 v[192:195], v[88:91], v[240:243], v[192:195]
  ds_read_b64_tr_b16 v[40:41], v12 offset:33024
  v_mul_f32 v17, s76, v17
  v_mfma_f32_16x16x32_bf16 v[208:211], v[92:95], v[240:243], v[208:211]
  ds_read_b64_tr_b16 v[42:43], v12 offset:34048
  v_mul_f32 v18, s76, v18
  v_mfma_f32_16x16x32_bf16 v[100:103], v[64:67], v[244:247], v[100:103]
  buffer_load_dwordx4 v4, s[32:35], s26 offen offset:1024 sc1 lds
  v_mul_f32 v19, s76, v19
  v_mul_f32 v20, s76, v20
  v_mfma_f32_16x16x32_bf16 v[116:119], v[68:71], v[244:247], v[116:119]
  ds_read_b64_tr_b16 v[44:45], v13 offset:33024
  v_mul_f32 v21, s76, v21
  v_mfma_f32_16x16x32_bf16 v[132:135], v[72:75], v[244:247], v[132:135]
  ds_read_b64_tr_b16 v[46:47], v13 offset:34048
  v_mul_f32 v22, s76, v22
  v_mfma_f32_16x16x32_bf16 v[148:151], v[76:79], v[244:247], v[148:151]
  ds_read_b128 v[224:227], v14 offset:0
  v_mul_f32 v23, s76, v23
  v_mfma_f32_16x16x32_bf16 v[164:167], v[80:83], v[244:247], v[164:167]
  ds_read_b128 v[228:231], v14 offset:1024
  v_cvt_pk_bf16_f32 v24, v16, v17
  v_cvt_pk_bf16_f32 v25, v18, v19
  v_mfma_f32_16x16x32_bf16 v[180:183], v[84:87], v[244:247], v[180:183]
  buffer_load_dwordx4 v5, s[32:35], s26 offen offset:2048 sc1 lds
  v_cvt_pk_bf16_f32 v26, v20, v21
  v_mfma_f32_16x16x32_bf16 v[196:199], v[88:91], v[244:247], v[196:199]
  ds_read_b64_tr_b16 v[48:49], v12 offset:33280
  v_cvt_pk_bf16_f32 v27, v22, v23
  v_mfma_f32_16x16x32_bf16 v[212:215], v[92:95], v[244:247], v[212:215]
  ds_read_b64_tr_b16 v[50:51], v12 offset:34304
  buffer_store_dwordx4 v[24:27], v2, s[40:43], s64 offen offset:2048 sc1
  v_mfma_f32_16x16x32_bf16 v[104:107], v[64:67], v[248:251], v[104:107]
  ds_read_b64_tr_b16 v[52:53], v13 offset:33280
  v_accvgpr_read_b32 v16, a216
  v_mfma_f32_16x16x32_bf16 v[120:123], v[68:71], v[248:251], v[120:123]
  ds_read_b64_tr_b16 v[54:55], v13 offset:34304
  v_accvgpr_read_b32 v17, a217
  v_accvgpr_read_b32 v18, a218
  v_mfma_f32_16x16x32_bf16 v[136:139], v[72:75], v[248:251], v[136:139]
  buffer_load_dwordx4 v6, s[32:35], s26 offen offset:3072 sc1 lds
  v_accvgpr_read_b32 v19, a219
  v_mfma_f32_16x16x32_bf16 v[152:155], v[76:79], v[248:251], v[152:155]
  s_add_u32 s26, s26, 1024
  ds_read_b64_tr_b16 v[56:57], v12 offset:33536
  v_accvgpr_read_b32 v20, a220
  v_mfma_f32_16x16x32_bf16 v[168:171], v[80:83], v[248:251], v[168:171]
  ds_read_b64_tr_b16 v[58:59], v12 offset:34560
  v_accvgpr_read_b32 v21, a221
  v_mfma_f32_16x16x32_bf16 v[184:187], v[84:87], v[248:251], v[184:187]
  ds_read_b64_tr_b16 v[60:61], v13 offset:33536
  v_accvgpr_read_b32 v22, a222
  v_accvgpr_read_b32 v23, a223
  v_mfma_f32_16x16x32_bf16 v[200:203], v[88:91], v[248:251], v[200:203]
  s_add_u32 m0, s24, 16384
  ds_read_b64_tr_b16 v[62:63], v13 offset:34560
  v_mul_f32 v16, s76, v16
  v_mfma_f32_16x16x32_bf16 v[216:219], v[92:95], v[248:251], v[216:219]
  buffer_load_dwordx4 v8, s[36:39], s27 offen offset:0 lds
  v_mul_f32 v17, s76, v17
  v_mfma_f32_16x16x32_bf16 v[108:111], v[64:67], v[252:255], v[108:111]
  ds_read_b128 v[232:235], v14 offset:2048
  v_mul_f32 v18, s76, v18
  v_mfma_f32_16x16x32_bf16 v[124:127], v[68:71], v[252:255], v[124:127]
  ds_read_b128 v[236:239], v14 offset:3072
  v_mul_f32 v19, s76, v19
  v_mul_f32 v20, s76, v20
  v_mfma_f32_16x16x32_bf16 v[140:143], v[72:75], v[252:255], v[140:143]
  v_mul_f32 v21, s76, v21
  v_mul_f32 v22, s76, v22
  v_mfma_f32_16x16x32_bf16 v[156:159], v[76:79], v[252:255], v[156:159]
  v_mul_f32 v23, s76, v23
  v_cvt_pk_bf16_f32 v28, v16, v17
  v_mfma_f32_16x16x32_bf16 v[172:175], v[80:83], v[252:255], v[172:175]
  buffer_load_dwordx4 v9, s[36:39], s27 offen offset:1024 lds
  v_cvt_pk_bf16_f32 v29, v18, v19
  v_mfma_f32_16x16x32_bf16 v[188:191], v[84:87], v[252:255], v[188:191]
  v_cvt_pk_bf16_f32 v30, v20, v21
  v_cvt_pk_bf16_f32 v31, v22, v23
  v_mfma_f32_16x16x32_bf16 v[204:207], v[88:91], v[252:255], v[204:207]
  buffer_store_dwordx4 v[28:31], v2, s[40:43], s64 offen offset:3072 sc1
  v_mfma_f32_16x16x32_bf16 v[220:223], v[92:95], v[252:255], v[220:223]
  s_waitcnt vmcnt(18) lgkmcnt(0)
  v_mfma_f32_16x16x32_bf16 v[96:99], v[32:35], v[224:227], v[96:99]
  s_add_u32 s64, s64, 4096
  v_accvgpr_read_b32 v16, a224
  v_accvgpr_read_b32 v17, a225
  v_mfma_f32_16x16x32_bf16 v[112:115], v[36:39], v[224:227], v[112:115]
  ds_read_b64_tr_b16 v[64:65], v12 offset:40960
  v_accvgpr_read_b32 v18, a226
  v_mfma_f32_16x16x32_bf16 v[128:131], v[40:43], v[224:227], v[128:131]
  s_add_u32 m0, s24, 65536
  ds_read_b64_tr_b16 v[66:67], v12 offset:41984
  v_accvgpr_read_b32 v19, a227
  v_mfma_f32_16x16x32_bf16 v[144:147], v[44:47], v[224:227], v[144:147]
  buffer_load_dwordx4 v3, s[32:35], s26 offen offset:0 sc1 lds
  v_accvgpr_read_b32 v20, a228
  v_mfma_f32_16x16x32_bf16 v[160:163], v[48:51], v[224:227], v[160:163]
  ds_read_b64_tr_b16 v[68:69], v13 offset:40960
  v_accvgpr_read_b32 v21, a229
  v_mfma_f32_16x16x32_bf16 v[176:179], v[52:55], v[224:227], v[176:179]
  ds_read_b64_tr_b16 v[70:71], v13 offset:41984
  v_accvgpr_read_b32 v22, a230
  v_mfma_f32_16x16x32_bf16 v[192:195], v[56:59], v[224:227], v[192:195]
  ds_read_b64_tr_b16 v[72:73], v12 offset:41216
  v_accvgpr_read_b32 v23, a231
  v_mfma_f32_16x16x32_bf16 v[208:211], v[60:63], v[224:227], v[208:211]
  ds_read_b64_tr_b16 v[74:75], v12 offset:42240
  v_mul_f32 v16, s76, v16
  v_mfma_f32_16x16x32_bf16 v[100:103], v[32:35], v[228:231], v[100:103]
  buffer_load_dwordx4 v4, s[32:35], s26 offen offset:1024 sc1 lds
  v_mul_f32 v17, s76, v17
  v_mfma_f32_16x16x32_bf16 v[116:119], v[36:39], v[228:231], v[116:119]
  ds_read_b64_tr_b16 v[76:77], v13 offset:41216
  v_mul_f32 v18, s76, v18
  v_mfma_f32_16x16x32_bf16 v[132:135], v[40:43], v[228:231], v[132:135]
  ds_read_b64_tr_b16 v[78:79], v13 offset:42240
  v_mul_f32 v19, s76, v19
  v_mfma_f32_16x16x32_bf16 v[148:151], v[44:47], v[228:231], v[148:151]
  ds_read_b128 v[240:243], v14 offset:32768
  v_mul_f32 v20, s76, v20
  v_mfma_f32_16x16x32_bf16 v[164:167], v[48:51], v[228:231], v[164:167]
  ds_read_b128 v[244:247], v14 offset:33792
  v_mul_f32 v21, s76, v21
  v_mfma_f32_16x16x32_bf16 v[180:183], v[52:55], v[228:231], v[180:183]
  buffer_load_dwordx4 v5, s[32:35], s26 offen offset:2048 sc1 lds
  v_mul_f32 v22, s76, v22
  v_mfma_f32_16x16x32_bf16 v[196:199], v[56:59], v[228:231], v[196:199]
  ds_read_b64_tr_b16 v[80:81], v12 offset:41472
  v_mul_f32 v23, s76, v23
  v_mfma_f32_16x16x32_bf16 v[212:215], v[60:63], v[228:231], v[212:215]
  ds_read_b64_tr_b16 v[82:83], v12 offset:42496
  v_cvt_pk_bf16_f32 v24, v16, v17
  v_mfma_f32_16x16x32_bf16 v[104:107], v[32:35], v[232:235], v[104:107]
  ds_read_b64_tr_b16 v[84:85], v13 offset:41472
  v_cvt_pk_bf16_f32 v25, v18, v19
  v_mfma_f32_16x16x32_bf16 v[120:123], v[36:39], v[232:235], v[120:123]
  ds_read_b64_tr_b16 v[86:87], v13 offset:42496
  v_cvt_pk_bf16_f32 v26, v20, v21
  v_mfma_f32_16x16x32_bf16 v[136:139], v[40:43], v[232:235], v[136:139]
  buffer_load_dwordx4 v6, s[32:35], s26 offen offset:3072 sc1 lds
  v_cvt_pk_bf16_f32 v27, v22, v23
  v_mfma_f32_16x16x32_bf16 v[152:155], v[44:47], v[232:235], v[152:155]
  s_add_u32 s26, s26, 1024
  ds_read_b64_tr_b16 v[88:89], v12 offset:41728
  buffer_store_dwordx4 v[24:27], v2, s[40:43], s64 offen offset:0 sc1
  v_mfma_f32_16x16x32_bf16 v[168:171], v[48:51], v[232:235], v[168:171]
  ds_read_b64_tr_b16 v[90:91], v12 offset:42752
  v_mfma_f32_16x16x32_bf16 v[184:187], v[52:55], v[232:235], v[184:187]
  ds_read_b64_tr_b16 v[92:93], v13 offset:41728
  v_mfma_f32_16x16x32_bf16 v[200:203], v[56:59], v[232:235], v[200:203]
  s_add_u32 m0, s24, 16384
  ds_read_b64_tr_b16 v[94:95], v13 offset:42752
  v_mfma_f32_16x16x32_bf16 v[216:219], v[60:63], v[232:235], v[216:219]
  buffer_load_dwordx4 v10, s[36:39], s27 offen offset:2048 lds
  v_mfma_f32_16x16x32_bf16 v[108:111], v[32:35], v[236:239], v[108:111]
  ds_read_b128 v[248:251], v14 offset:34816
  v_mfma_f32_16x16x32_bf16 v[124:127], v[36:39], v[236:239], v[124:127]
  ds_read_b128 v[252:255], v14 offset:35840
  v_mfma_f32_16x16x32_bf16 v[140:143], v[40:43], v[236:239], v[140:143]
  v_mfma_f32_16x16x32_bf16 v[156:159], v[44:47], v[236:239], v[156:159]
  v_xor_b32 v14, 0x10000, v14
  v_mfma_f32_16x16x32_bf16 v[172:175], v[48:51], v[236:239], v[172:175]
  buffer_load_dwordx4 v11, s[36:39], s27 offen offset:3072 lds
  v_mfma_f32_16x16x32_bf16 v[188:191], v[52:55], v[236:239], v[188:191]
  s_add_u32 s27, s27, 524288
  v_xor_b32 v12, 0x10000, v12
  v_mfma_f32_16x16x32_bf16 v[204:207], v[56:59], v[236:239], v[204:207]
  v_xor_b32 v13, 0x10000, v13
  v_mfma_f32_16x16x32_bf16 v[220:223], v[60:63], v[236:239], v[220:223]
  s_waitcnt vmcnt(16) lgkmcnt(0)
  v_mfma_f32_16x16x32_bf16 v[96:99], v[64:67], v[240:243], v[96:99]
  s_barrier
  v_accvgpr_read_b32 v16, a232
  v_accvgpr_read_b32 v17, a233
  v_mfma_f32_16x16x32_bf16 v[112:115], v[68:71], v[240:243], v[112:115]
  ds_read_b64_tr_b16 v[32:33], v12 offset:0
  v_accvgpr_read_b32 v18, a234
  v_mfma_f32_16x16x32_bf16 v[128:131], v[72:75], v[240:243], v[128:131]
  s_add_u32 m0, s24, 98304
  ds_read_b64_tr_b16 v[34:35], v12 offset:1024
  v_accvgpr_read_b32 v19, a235
  v_mfma_f32_16x16x32_bf16 v[144:147], v[76:79], v[240:243], v[144:147]
  buffer_load_dwordx4 v3, s[32:35], s26 offen offset:0 sc1 lds
  v_accvgpr_read_b32 v20, a236
  v_mfma_f32_16x16x32_bf16 v[160:163], v[80:83], v[240:243], v[160:163]
  ds_read_b64_tr_b16 v[36:37], v13 offset:0
  v_accvgpr_read_b32 v21, a237
  v_mfma_f32_16x16x32_bf16 v[176:179], v[84:87], v[240:243], v[176:179]
  ds_read_b64_tr_b16 v[38:39], v13 offset:1024
  v_accvgpr_read_b32 v22, a238
  v_mfma_f32_16x16x32_bf16 v[192:195], v[88:91], v[240:243], v[192:195]
  ds_read_b64_tr_b16 v[40:41], v12 offset:256
  v_accvgpr_read_b32 v23, a239
  v_mfma_f32_16x16x32_bf16 v[208:211], v[92:95], v[240:243], v[208:211]
  ds_read_b64_tr_b16 v[42:43], v12 offset:1280
  v_mul_f32 v16, s76, v16
  v_mfma_f32_16x16x32_bf16 v[100:103], v[64:67], v[244:247], v[100:103]
  buffer_load_dwordx4 v4, s[32:35], s26 offen offset:1024 sc1 lds
  v_mul_f32 v17, s76, v17
  v_mfma_f32_16x16x32_bf16 v[116:119], v[68:71], v[244:247], v[116:119]
  ds_read_b64_tr_b16 v[44:45], v13 offset:256
  v_mul_f32 v18, s76, v18
  v_mfma_f32_16x16x32_bf16 v[132:135], v[72:75], v[244:247], v[132:135]
  ds_read_b64_tr_b16 v[46:47], v13 offset:1280
  v_mul_f32 v19, s76, v19
  v_mfma_f32_16x16x32_bf16 v[148:151], v[76:79], v[244:247], v[148:151]
  ds_read_b128 v[224:227], v14 offset:0
  v_mul_f32 v20, s76, v20
  v_mfma_f32_16x16x32_bf16 v[164:167], v[80:83], v[244:247], v[164:167]
  ds_read_b128 v[228:231], v14 offset:1024
  v_mul_f32 v21, s76, v21
  v_mfma_f32_16x16x32_bf16 v[180:183], v[84:87], v[244:247], v[180:183]
  buffer_load_dwordx4 v5, s[32:35], s26 offen offset:2048 sc1 lds
  v_mul_f32 v22, s76, v22
  v_mfma_f32_16x16x32_bf16 v[196:199], v[88:91], v[244:247], v[196:199]
  ds_read_b64_tr_b16 v[48:49], v12 offset:512
  v_mul_f32 v23, s76, v23
  v_mfma_f32_16x16x32_bf16 v[212:215], v[92:95], v[244:247], v[212:215]
  ds_read_b64_tr_b16 v[50:51], v12 offset:1536
  v_cvt_pk_bf16_f32 v28, v16, v17
  v_mfma_f32_16x16x32_bf16 v[104:107], v[64:67], v[248:251], v[104:107]
  ds_read_b64_tr_b16 v[52:53], v13 offset:512
  v_cvt_pk_bf16_f32 v29, v18, v19
  v_mfma_f32_16x16x32_bf16 v[120:123], v[68:71], v[248:251], v[120:123]
  ds_read_b64_tr_b16 v[54:55], v13 offset:1536
  v_cvt_pk_bf16_f32 v30, v20, v21
  v_mfma_f32_16x16x32_bf16 v[136:139], v[72:75], v[248:251], v[136:139]
  buffer_load_dwordx4 v6, s[32:35], s26 offen offset:3072 sc1 lds
  v_cvt_pk_bf16_f32 v31, v22, v23
  v_mfma_f32_16x16x32_bf16 v[152:155], v[76:79], v[248:251], v[152:155]
  s_add_u32 s26, s26, 1024
  ds_read_b64_tr_b16 v[56:57], v12 offset:768
  buffer_store_dwordx4 v[28:31], v2, s[40:43], s64 offen offset:1024 sc1
  v_mfma_f32_16x16x32_bf16 v[168:171], v[80:83], v[248:251], v[168:171]
  ds_read_b64_tr_b16 v[58:59], v12 offset:1792
  v_mfma_f32_16x16x32_bf16 v[184:187], v[84:87], v[248:251], v[184:187]
  ds_read_b64_tr_b16 v[60:61], v13 offset:768
  v_mfma_f32_16x16x32_bf16 v[200:203], v[88:91], v[248:251], v[200:203]
  s_add_u32 m0, s24, 49152
  ds_read_b64_tr_b16 v[62:63], v13 offset:1792
  v_mfma_f32_16x16x32_bf16 v[216:219], v[92:95], v[248:251], v[216:219]
  buffer_load_dwordx4 v8, s[36:39], s27 offen offset:0 lds
  v_mfma_f32_16x16x32_bf16 v[108:111], v[64:67], v[252:255], v[108:111]
  ds_read_b128 v[232:235], v14 offset:2048
  v_mfma_f32_16x16x32_bf16 v[124:127], v[68:71], v[252:255], v[124:127]
  ds_read_b128 v[236:239], v14 offset:3072
  v_mfma_f32_16x16x32_bf16 v[140:143], v[72:75], v[252:255], v[140:143]
  v_mfma_f32_16x16x32_bf16 v[156:159], v[76:79], v[252:255], v[156:159]
  v_mfma_f32_16x16x32_bf16 v[172:175], v[80:83], v[252:255], v[172:175]
  buffer_load_dwordx4 v9, s[36:39], s27 offen offset:1024 lds
  v_mfma_f32_16x16x32_bf16 v[188:191], v[84:87], v[252:255], v[188:191]
  v_mfma_f32_16x16x32_bf16 v[204:207], v[88:91], v[252:255], v[204:207]
  v_mfma_f32_16x16x32_bf16 v[220:223], v[92:95], v[252:255], v[220:223]
  s_waitcnt vmcnt(17) lgkmcnt(0)
  v_mfma_f32_16x16x32_bf16 v[96:99], v[32:35], v[224:227], v[96:99]
  v_accvgpr_read_b32 v16, a240
  v_accvgpr_read_b32 v17, a241
  v_mfma_f32_16x16x32_bf16 v[112:115], v[36:39], v[224:227], v[112:115]
  ds_read_b64_tr_b16 v[64:65], v12 offset:8192
  v_accvgpr_read_b32 v18, a242
  v_mfma_f32_16x16x32_bf16 v[128:131], v[40:43], v[224:227], v[128:131]
  s_add_u32 m0, s24, 0
  ds_read_b64_tr_b16 v[66:67], v12 offset:9216
  v_accvgpr_read_b32 v19, a243
  v_mfma_f32_16x16x32_bf16 v[144:147], v[44:47], v[224:227], v[144:147]
  buffer_load_dwordx4 v3, s[32:35], s26 offen offset:0 sc1 lds
  v_accvgpr_read_b32 v20, a244
  v_mfma_f32_16x16x32_bf16 v[160:163], v[48:51], v[224:227], v[160:163]
  ds_read_b64_tr_b16 v[68:69], v13 offset:8192
  v_accvgpr_read_b32 v21, a245
  v_mfma_f32_16x16x32_bf16 v[176:179], v[52:55], v[224:227], v[176:179]
  ds_read_b64_tr_b16 v[70:71], v13 offset:9216
  v_accvgpr_read_b32 v22, a246
  v_mfma_f32_16x16x32_bf16 v[192:195], v[56:59], v[224:227], v[192:195]
  ds_read_b64_tr_b16 v[72:73], v12 offset:8448
  v_accvgpr_read_b32 v23, a247
  v_mfma_f32_16x16x32_bf16 v[208:211], v[60:63], v[224:227], v[208:211]
  ds_read_b64_tr_b16 v[74:75], v12 offset:9472
  v_mul_f32 v16, s76, v16
  v_mfma_f32_16x16x32_bf16 v[100:103], v[32:35], v[228:231], v[100:103]
  buffer_load_dwordx4 v4, s[32:35], s26 offen offset:1024 sc1 lds
  v_mul_f32 v17, s76, v17
  v_mfma_f32_16x16x32_bf16 v[116:119], v[36:39], v[228:231], v[116:119]
  ds_read_b64_tr_b16 v[76:77], v13 offset:8448
  v_mul_f32 v18, s76, v18
  v_mfma_f32_16x16x32_bf16 v[132:135], v[40:43], v[228:231], v[132:135]
  ds_read_b64_tr_b16 v[78:79], v13 offset:9472
  v_mul_f32 v19, s76, v19
  v_mfma_f32_16x16x32_bf16 v[148:151], v[44:47], v[228:231], v[148:151]
  ds_read_b128 v[240:243], v14 offset:32768
  v_mul_f32 v20, s76, v20
  v_mfma_f32_16x16x32_bf16 v[164:167], v[48:51], v[228:231], v[164:167]
  ds_read_b128 v[244:247], v14 offset:33792
  v_mul_f32 v21, s76, v21
  v_mfma_f32_16x16x32_bf16 v[180:183], v[52:55], v[228:231], v[180:183]
  buffer_load_dwordx4 v5, s[32:35], s26 offen offset:2048 sc1 lds
  v_mul_f32 v22, s76, v22
  v_mfma_f32_16x16x32_bf16 v[196:199], v[56:59], v[228:231], v[196:199]
  ds_read_b64_tr_b16 v[80:81], v12 offset:8704
  v_mul_f32 v23, s76, v23
  v_mfma_f32_16x16x32_bf16 v[212:215], v[60:63], v[228:231], v[212:215]
  ds_read_b64_tr_b16 v[82:83], v12 offset:9728
  v_cvt_pk_bf16_f32 v24, v16, v17
  v_mfma_f32_16x16x32_bf16 v[104:107], v[32:35], v[232:235], v[104:107]
  ds_read_b64_tr_b16 v[84:85], v13 offset:8704
  v_cvt_pk_bf16_f32 v25, v18, v19
  v_mfma_f32_16x16x32_bf16 v[120:123], v[36:39], v[232:235], v[120:123]
  ds_read_b64_tr_b16 v[86:87], v13 offset:9728
  v_cvt_pk_bf16_f32 v26, v20, v21
  v_mfma_f32_16x16x32_bf16 v[136:139], v[40:43], v[232:235], v[136:139]
  buffer_load_dwordx4 v6, s[32:35], s26 offen offset:3072 sc1 lds
  v_cvt_pk_bf16_f32 v27, v22, v23
  v_mfma_f32_16x16x32_bf16 v[152:155], v[44:47], v[232:235], v[152:155]
  s_add_u32 s26, s26, 1024
  ds_read_b64_tr_b16 v[88:89], v12 offset:8960
  buffer_store_dwordx4 v[24:27], v2, s[40:43], s64 offen offset:2048 sc1
  v_mfma_f32_16x16x32_bf16 v[168:171], v[48:51], v[232:235], v[168:171]
  ds_read_b64_tr_b16 v[90:91], v12 offset:9984
  v_mfma_f32_16x16x32_bf16 v[184:187], v[52:55], v[232:235], v[184:187]
  ds_read_b64_tr_b16 v[92:93], v13 offset:8960
  v_mfma_f32_16x16x32_bf16 v[200:203], v[56:59], v[232:235], v[200:203]
  s_add_u32 m0, s24, 49152
  ds_read_b64_tr_b16 v[94:95], v13 offset:9984
  v_mfma_f32_16x16x32_bf16 v[216:219], v[60:63], v[232:235], v[216:219]
  buffer_load_dwordx4 v10, s[36:39], s27 offen offset:2048 lds
  v_mfma_f32_16x16x32_bf16 v[108:111], v[32:35], v[236:239], v[108:111]
  ds_read_b128 v[248:251], v14 offset:34816
  v_mfma_f32_16x16x32_bf16 v[124:127], v[36:39], v[236:239], v[124:127]
  ds_read_b128 v[252:255], v14 offset:35840
  v_mfma_f32_16x16x32_bf16 v[140:143], v[40:43], v[236:239], v[140:143]
  v_mfma_f32_16x16x32_bf16 v[156:159], v[44:47], v[236:239], v[156:159]
  v_xor_b32 v14, 0x10000, v14
  v_mfma_f32_16x16x32_bf16 v[172:175], v[48:51], v[236:239], v[172:175]
  buffer_load_dwordx4 v11, s[36:39], s27 offen offset:3072 lds
  v_mfma_f32_16x16x32_bf16 v[188:191], v[52:55], v[236:239], v[188:191]
  s_add_u32 s27, s27, 524288
  v_mfma_f32_16x16x32_bf16 v[204:207], v[56:59], v[236:239], v[204:207]
  v_mfma_f32_16x16x32_bf16 v[220:223], v[60:63], v[236:239], v[220:223]
  s_waitcnt vmcnt(17) lgkmcnt(0)
  v_mfma_f32_16x16x32_bf16 v[96:99], v[64:67], v[240:243], v[96:99]
  s_barrier
  v_accvgpr_read_b32 v16, a248
  v_accvgpr_read_b32 v17, a249
  v_mfma_f32_16x16x32_bf16 v[112:115], v[68:71], v[240:243], v[112:115]
  ds_read_b64_tr_b16 v[32:33], v12 offset:32768
  v_accvgpr_read_b32 v18, a250
  v_mfma_f32_16x16x32_bf16 v[128:131], v[72:75], v[240:243], v[128:131]
  s_add_u32 m0, s24, 32768
  ds_read_b64_tr_b16 v[34:35], v12 offset:33792
  v_accvgpr_read_b32 v19, a251
  v_mfma_f32_16x16x32_bf16 v[144:147], v[76:79], v[240:243], v[144:147]
  buffer_load_dwordx4 v3, s[32:35], s26 offen offset:0 sc1 lds
  v_accvgpr_read_b32 v20, a252
  v_mfma_f32_16x16x32_bf16 v[160:163], v[80:83], v[240:243], v[160:163]
  ds_read_b64_tr_b16 v[36:37], v13 offset:32768
  v_accvgpr_read_b32 v21, a253
  v_mfma_f32_16x16x32_bf16 v[176:179], v[84:87], v[240:243], v[176:179]
  ds_read_b64_tr_b16 v[38:39], v13 offset:33792
  v_accvgpr_read_b32 v22, a254
  v_mfma_f32_16x16x32_bf16 v[192:195], v[88:91], v[240:243], v[192:195]
  ds_read_b64_tr_b16 v[40:41], v12 offset:33024
  v_accvgpr_read_b32 v23, a255
  v_mfma_f32_16x16x32_bf16 v[208:211], v[92:95], v[240:243], v[208:211]
  ds_read_b64_tr_b16 v[42:43], v12 offset:34048
  v_mul_f32 v16, s76, v16
  v_mfma_f32_16x16x32_bf16 v[100:103], v[64:67], v[244:247], v[100:103]
  buffer_load_dwordx4 v4, s[32:35], s26 offen offset:1024 sc1 lds
  v_mul_f32 v17, s76, v17
  v_mfma_f32_16x16x32_bf16 v[116:119], v[68:71], v[244:247], v[116:119]
  ds_read_b64_tr_b16 v[44:45], v13 offset:33024
  v_mul_f32 v18, s76, v18
  v_mfma_f32_16x16x32_bf16 v[132:135], v[72:75], v[244:247], v[132:135]
  ds_read_b64_tr_b16 v[46:47], v13 offset:34048
  v_mul_f32 v19, s76, v19
  v_mfma_f32_16x16x32_bf16 v[148:151], v[76:79], v[244:247], v[148:151]
  ds_read_b128 v[224:227], v14 offset:0
  v_mul_f32 v20, s76, v20
  v_mfma_f32_16x16x32_bf16 v[164:167], v[80:83], v[244:247], v[164:167]
  ds_read_b128 v[228:231], v14 offset:1024
  v_mul_f32 v21, s76, v21
  v_mfma_f32_16x16x32_bf16 v[180:183], v[84:87], v[244:247], v[180:183]
  buffer_load_dwordx4 v5, s[32:35], s26 offen offset:2048 sc1 lds
  v_mul_f32 v22, s76, v22
  v_mfma_f32_16x16x32_bf16 v[196:199], v[88:91], v[244:247], v[196:199]
  ds_read_b64_tr_b16 v[48:49], v12 offset:33280
  v_mul_f32 v23, s76, v23
  v_mfma_f32_16x16x32_bf16 v[212:215], v[92:95], v[244:247], v[212:215]
  ds_read_b64_tr_b16 v[50:51], v12 offset:34304
  v_cvt_pk_bf16_f32 v28, v16, v17
  v_mfma_f32_16x16x32_bf16 v[104:107], v[64:67], v[248:251], v[104:107]
  ds_read_b64_tr_b16 v[52:53], v13 offset:33280
  v_cvt_pk_bf16_f32 v29, v18, v19
  v_mfma_f32_16x16x32_bf16 v[120:123], v[68:71], v[248:251], v[120:123]
  ds_read_b64_tr_b16 v[54:55], v13 offset:34304
  v_cvt_pk_bf16_f32 v30, v20, v21
  v_mfma_f32_16x16x32_bf16 v[136:139], v[72:75], v[248:251], v[136:139]
  buffer_load_dwordx4 v6, s[32:35], s26 offen offset:3072 sc1 lds
  v_cvt_pk_bf16_f32 v31, v22, v23
  v_mfma_f32_16x16x32_bf16 v[152:155], v[76:79], v[248:251], v[152:155]
  s_add_u32 s26, s26, 1024
  ds_read_b64_tr_b16 v[56:57], v12 offset:33536
  buffer_store_dwordx4 v[28:31], v2, s[40:43], s64 offen offset:3072 sc1
  v_mfma_f32_16x16x32_bf16 v[168:171], v[80:83], v[248:251], v[168:171]
  ds_read_b64_tr_b16 v[58:59], v12 offset:34560
  v_mfma_f32_16x16x32_bf16 v[184:187], v[84:87], v[248:251], v[184:187]
  ds_read_b64_tr_b16 v[60:61], v13 offset:33536
  v_mfma_f32_16x16x32_bf16 v[200:203], v[88:91], v[248:251], v[200:203]
  s_add_u32 m0, s24, 81920
  ds_read_b64_tr_b16 v[62:63], v13 offset:34560
  v_mfma_f32_16x16x32_bf16 v[216:219], v[92:95], v[248:251], v[216:219]
  buffer_load_dwordx4 v8, s[36:39], s27 offen offset:0 lds
  v_mfma_f32_16x16x32_bf16 v[108:111], v[64:67], v[252:255], v[108:111]
  ds_read_b128 v[232:235], v14 offset:2048
  v_mfma_f32_16x16x32_bf16 v[124:127], v[68:71], v[252:255], v[124:127]
  ds_read_b128 v[236:239], v14 offset:3072
  v_mfma_f32_16x16x32_bf16 v[140:143], v[72:75], v[252:255], v[140:143]
  v_mfma_f32_16x16x32_bf16 v[156:159], v[76:79], v[252:255], v[156:159]
  v_mfma_f32_16x16x32_bf16 v[172:175], v[80:83], v[252:255], v[172:175]
  buffer_load_dwordx4 v9, s[36:39], s27 offen offset:1024 lds
  v_mfma_f32_16x16x32_bf16 v[188:191], v[84:87], v[252:255], v[188:191]
  v_mfma_f32_16x16x32_bf16 v[204:207], v[88:91], v[252:255], v[204:207]
  v_mfma_f32_16x16x32_bf16 v[220:223], v[92:95], v[252:255], v[220:223]
  s_waitcnt vmcnt(17) lgkmcnt(0)
  v_mfma_f32_16x16x32_bf16 v[96:99], v[32:35], v[224:227], v[96:99]
  s_add_u32 s64, s64, 126976
  v_accvgpr_read_b32 v16, a0
  v_accvgpr_read_b32 v17, a1
  v_mfma_f32_16x16x32_bf16 v[112:115], v[36:39], v[224:227], v[112:115]
  ds_read_b64_tr_b16 v[64:65], v12 offset:40960
  v_accvgpr_read_b32 v18, a2
  v_mfma_f32_16x16x32_bf16 v[128:131], v[40:43], v[224:227], v[128:131]
  s_add_u32 m0, s24, 65536
  ds_read_b64_tr_b16 v[66:67], v12 offset:41984
  v_accvgpr_read_b32 v19, a3
  v_mfma_f32_16x16x32_bf16 v[144:147], v[44:47], v[224:227], v[144:147]
  buffer_load_dwordx4 v3, s[32:35], s26 offen offset:0 sc1 lds
  v_accvgpr_read_b32 v20, a4
  v_mfma_f32_16x16x32_bf16 v[160:163], v[48:51], v[224:227], v[160:163]
  ds_read_b64_tr_b16 v[68:69], v13 offset:40960
  v_accvgpr_read_b32 v21, a5
  v_mfma_f32_16x16x32_bf16 v[176:179], v[52:55], v[224:227], v[176:179]
  ds_read_b64_tr_b16 v[70:71], v13 offset:41984
  v_accvgpr_read_b32 v22, a6
  v_mfma_f32_16x16x32_bf16 v[192:195], v[56:59], v[224:227], v[192:195]
  ds_read_b64_tr_b16 v[72:73], v12 offset:41216
  v_accvgpr_read_b32 v23, a7
  v_mfma_f32_16x16x32_bf16 v[208:211], v[60:63], v[224:227], v[208:211]
  ds_read_b64_tr_b16 v[74:75], v12 offset:42240
  v_mul_f32 v16, s76, v16
  v_mfma_f32_16x16x32_bf16 v[100:103], v[32:35], v[228:231], v[100:103]
  buffer_load_dwordx4 v4, s[32:35], s26 offen offset:1024 sc1 lds
  v_mul_f32 v17, s76, v17
  v_mfma_f32_16x16x32_bf16 v[116:119], v[36:39], v[228:231], v[116:119]
  ds_read_b64_tr_b16 v[76:77], v13 offset:41216
  v_mul_f32 v18, s76, v18
  v_mfma_f32_16x16x32_bf16 v[132:135], v[40:43], v[228:231], v[132:135]
  ds_read_b64_tr_b16 v[78:79], v13 offset:42240
  v_mul_f32 v19, s76, v19
  v_mfma_f32_16x16x32_bf16 v[148:151], v[44:47], v[228:231], v[148:151]
  ds_read_b128 v[240:243], v14 offset:32768
  v_mul_f32 v20, s76, v20
  v_mfma_f32_16x16x32_bf16 v[164:167], v[48:51], v[228:231], v[164:167]
  ds_read_b128 v[244:247], v14 offset:33792
  v_mul_f32 v21, s76, v21
  v_mfma_f32_16x16x32_bf16 v[180:183], v[52:55], v[228:231], v[180:183]
  buffer_load_dwordx4 v5, s[32:35], s26 offen offset:2048 sc1 lds
  v_mul_f32 v22, s76, v22
  v_mfma_f32_16x16x32_bf16 v[196:199], v[56:59], v[228:231], v[196:199]
  ds_read_b64_tr_b16 v[80:81], v12 offset:41472
  v_mul_f32 v23, s76, v23
  v_mfma_f32_16x16x32_bf16 v[212:215], v[60:63], v[228:231], v[212:215]
  ds_read_b64_tr_b16 v[82:83], v12 offset:42496
  v_cvt_pk_bf16_f32 v24, v16, v17
  v_mfma_f32_16x16x32_bf16 v[104:107], v[32:35], v[232:235], v[104:107]
  ds_read_b64_tr_b16 v[84:85], v13 offset:41472
  v_cvt_pk_bf16_f32 v25, v18, v19
  v_mfma_f32_16x16x32_bf16 v[120:123], v[36:39], v[232:235], v[120:123]
  ds_read_b64_tr_b16 v[86:87], v13 offset:42496
  v_cvt_pk_bf16_f32 v26, v20, v21
  v_mfma_f32_16x16x32_bf16 v[136:139], v[40:43], v[232:235], v[136:139]
  buffer_load_dwordx4 v6, s[32:35], s26 offen offset:3072 sc1 lds
  v_cvt_pk_bf16_f32 v27, v22, v23
  v_mfma_f32_16x16x32_bf16 v[152:155], v[44:47], v[232:235], v[152:155]
  s_add_u32 s26, s26, 1024
  ds_read_b64_tr_b16 v[88:89], v12 offset:41728
  buffer_store_dwordx4 v[24:27], v2, s[40:43], s64 offen offset:0 sc1
  v_mfma_f32_16x16x32_bf16 v[168:171], v[48:51], v[232:235], v[168:171]
  ds_read_b64_tr_b16 v[90:91], v12 offset:42752
  v_mfma_f32_16x16x32_bf16 v[184:187], v[52:55], v[232:235], v[184:187]
  ds_read_b64_tr_b16 v[92:93], v13 offset:41728
  v_mfma_f32_16x16x32_bf16 v[200:203], v[56:59], v[232:235], v[200:203]
  s_add_u32 m0, s24, 81920
  ds_read_b64_tr_b16 v[94:95], v13 offset:42752
  v_mfma_f32_16x16x32_bf16 v[216:219], v[60:63], v[232:235], v[216:219]
  buffer_load_dwordx4 v10, s[36:39], s27 offen offset:2048 lds
  v_mfma_f32_16x16x32_bf16 v[108:111], v[32:35], v[236:239], v[108:111]
  ds_read_b128 v[248:251], v14 offset:34816
  v_mfma_f32_16x16x32_bf16 v[124:127], v[36:39], v[236:239], v[124:127]
  ds_read_b128 v[252:255], v14 offset:35840
  v_mfma_f32_16x16x32_bf16 v[140:143], v[40:43], v[236:239], v[140:143]
  v_mfma_f32_16x16x32_bf16 v[156:159], v[44:47], v[236:239], v[156:159]
  v_xor_b32 v14, 0x10000, v14
  v_mfma_f32_16x16x32_bf16 v[172:175], v[48:51], v[236:239], v[172:175]
  buffer_load_dwordx4 v11, s[36:39], s27 offen offset:3072 lds
  v_mfma_f32_16x16x32_bf16 v[188:191], v[52:55], v[236:239], v[188:191]
  s_add_u32 s27, s27, 524288
  v_xor_b32 v12, 0x10000, v12
  v_mfma_f32_16x16x32_bf16 v[204:207], v[56:59], v[236:239], v[204:207]
  v_xor_b32 v13, 0x10000, v13
  v_mfma_f32_16x16x32_bf16 v[220:223], v[60:63], v[236:239], v[220:223]
  s_waitcnt vmcnt(9) lgkmcnt(0)
  v_mfma_f32_16x16x32_bf16 v[96:99], v[64:67], v[240:243], v[96:99]
  s_barrier
  buffer_store_dword v12, off, s[40:43], s65 sc1
  v_accvgpr_read_b32 v16, a8
  v_mfma_f32_16x16x32_bf16 v[112:115], v[68:71], v[240:243], v[112:115]
  ds_read_b64_tr_b16 v[32:33], v12 offset:0
  v_accvgpr_read_b32 v17, a9
  v_mfma_f32_16x16x32_bf16 v[128:131], v[72:75], v[240:243], v[128:131]
  s_add_u32 m0, s24, 98304
  ds_read_b64_tr_b16 v[34:35], v12 offset:1024
  v_accvgpr_read_b32 v18, a10
  v_mfma_f32_16x16x32_bf16 v[144:147], v[76:79], v[240:243], v[144:147]
  buffer_load_dwordx4 v3, s[32:35], s26 offen offset:0 sc1 lds
  v_accvgpr_read_b32 v19, a11
  v_mfma_f32_16x16x32_bf16 v[160:163], v[80:83], v[240:243], v[160:163]
  ds_read_b64_tr_b16 v[36:37], v13 offset:0
  v_accvgpr_read_b32 v20, a12
  v_mfma_f32_16x16x32_bf16 v[176:179], v[84:87], v[240:243], v[176:179]
  ds_read_b64_tr_b16 v[38:39], v13 offset:1024
  v_accvgpr_read_b32 v21, a13
  v_mfma_f32_16x16x32_bf16 v[192:195], v[88:91], v[240:243], v[192:195]
  ds_read_b64_tr_b16 v[40:41], v12 offset:256
  v_accvgpr_read_b32 v22, a14
  v_mfma_f32_16x16x32_bf16 v[208:211], v[92:95], v[240:243], v[208:211]
  ds_read_b64_tr_b16 v[42:43], v12 offset:1280
  v_accvgpr_read_b32 v23, a15
  v_mfma_f32_16x16x32_bf16 v[100:103], v[64:67], v[244:247], v[100:103]
  buffer_load_dwordx4 v4, s[32:35], s26 offen offset:1024 sc1 lds
  v_mul_f32 v16, s76, v16
  v_mfma_f32_16x16x32_bf16 v[116:119], v[68:71], v[244:247], v[116:119]
  ds_read_b64_tr_b16 v[44:45], v13 offset:256
  v_mul_f32 v17, s76, v17
  v_mfma_f32_16x16x32_bf16 v[132:135], v[72:75], v[244:247], v[132:135]
  ds_read_b64_tr_b16 v[46:47], v13 offset:1280
  v_mul_f32 v18, s76, v18
  v_mfma_f32_16x16x32_bf16 v[148:151], v[76:79], v[244:247], v[148:151]
  ds_read_b128 v[224:227], v14 offset:0
  v_mul_f32 v19, s76, v19
  v_mfma_f32_16x16x32_bf16 v[164:167], v[80:83], v[244:247], v[164:167]
  ds_read_b128 v[228:231], v14 offset:1024
  v_mul_f32 v20, s76, v20
  v_mfma_f32_16x16x32_bf16 v[180:183], v[84:87], v[244:247], v[180:183]
  buffer_load_dwordx4 v5, s[32:35], s26 offen offset:2048 sc1 lds
  v_mul_f32 v21, s76, v21
  v_mfma_f32_16x16x32_bf16 v[196:199], v[88:91], v[244:247], v[196:199]
  ds_read_b64_tr_b16 v[48:49], v12 offset:512
  v_mul_f32 v22, s76, v22
  v_mfma_f32_16x16x32_bf16 v[212:215], v[92:95], v[244:247], v[212:215]
  ds_read_b64_tr_b16 v[50:51], v12 offset:1536
  v_mul_f32 v23, s76, v23
  v_mfma_f32_16x16x32_bf16 v[104:107], v[64:67], v[248:251], v[104:107]
  ds_read_b64_tr_b16 v[52:53], v13 offset:512
  v_cvt_pk_bf16_f32 v28, v16, v17
  v_mfma_f32_16x16x32_bf16 v[120:123], v[68:71], v[248:251], v[120:123]
  ds_read_b64_tr_b16 v[54:55], v13 offset:1536
  v_cvt_pk_bf16_f32 v29, v18, v19
  v_mfma_f32_16x16x32_bf16 v[136:139], v[72:75], v[248:251], v[136:139]
  buffer_load_dwordx4 v6, s[32:35], s26 offen offset:3072 sc1 lds
  v_cvt_pk_bf16_f32 v30, v20, v21
  v_mfma_f32_16x16x32_bf16 v[152:155], v[76:79], v[248:251], v[152:155]
  s_add_u32 s26, s26, 1024
  ds_read_b64_tr_b16 v[56:57], v12 offset:768
  v_cvt_pk_bf16_f32 v31, v22, v23
  v_mfma_f32_16x16x32_bf16 v[168:171], v[80:83], v[248:251], v[168:171]
  ds_read_b64_tr_b16 v[58:59], v12 offset:1792
  buffer_store_dwordx4 v[28:31], v2, s[40:43], s64 offen offset:1024 sc1
  v_mfma_f32_16x16x32_bf16 v[184:187], v[84:87], v[248:251], v[184:187]
  ds_read_b64_tr_b16 v[60:61], v13 offset:768
  v_mfma_f32_16x16x32_bf16 v[200:203], v[88:91], v[248:251], v[200:203]
  s_add_u32 m0, s24, 114688
  ds_read_b64_tr_b16 v[62:63], v13 offset:1792
  v_mfma_f32_16x16x32_bf16 v[216:219], v[92:95], v[248:251], v[216:219]
  buffer_load_dwordx4 v8, s[36:39], s27 offen offset:0 lds
  v_mfma_f32_16x16x32_bf16 v[108:111], v[64:67], v[252:255], v[108:111]
  ds_read_b128 v[232:235], v14 offset:2048
  v_mfma_f32_16x16x32_bf16 v[124:127], v[68:71], v[252:255], v[124:127]
  ds_read_b128 v[236:239], v14 offset:3072
  v_mfma_f32_16x16x32_bf16 v[140:143], v[72:75], v[252:255], v[140:143]
  v_mfma_f32_16x16x32_bf16 v[156:159], v[76:79], v[252:255], v[156:159]
  v_mfma_f32_16x16x32_bf16 v[172:175], v[80:83], v[252:255], v[172:175]
  buffer_load_dwordx4 v9, s[36:39], s27 offen offset:1024 lds
  v_mfma_f32_16x16x32_bf16 v[188:191], v[84:87], v[252:255], v[188:191]
  v_mfma_f32_16x16x32_bf16 v[204:207], v[88:91], v[252:255], v[204:207]
  v_mfma_f32_16x16x32_bf16 v[220:223], v[92:95], v[252:255], v[220:223]
  s_waitcnt vmcnt(18) lgkmcnt(0)
  v_mfma_f32_16x16x32_bf16 v[96:99], v[32:35], v[224:227], v[96:99]
  v_accvgpr_read_b32 v16, a16
  v_accvgpr_read_b32 v17, a17
  v_mfma_f32_16x16x32_bf16 v[112:115], v[36:39], v[224:227], v[112:115]
  ds_read_b64_tr_b16 v[64:65], v12 offset:8192
  v_accvgpr_read_b32 v18, a18
  v_mfma_f32_16x16x32_bf16 v[128:131], v[40:43], v[224:227], v[128:131]
  s_add_u32 m0, s24, 0
  ds_read_b64_tr_b16 v[66:67], v12 offset:9216
  v_accvgpr_read_b32 v19, a19
  v_mfma_f32_16x16x32_bf16 v[144:147], v[44:47], v[224:227], v[144:147]
  buffer_load_dwordx4 v3, s[32:35], s26 offen offset:0 sc1 lds
  v_accvgpr_read_b32 v20, a20
  v_mfma_f32_16x16x32_bf16 v[160:163], v[48:51], v[224:227], v[160:163]
  ds_read_b64_tr_b16 v[68:69], v13 offset:8192
  v_accvgpr_read_b32 v21, a21
  v_mfma_f32_16x16x32_bf16 v[176:179], v[52:55], v[224:227], v[176:179]
  ds_read_b64_tr_b16 v[70:71], v13 offset:9216
  v_accvgpr_read_b32 v22, a22
  v_mfma_f32_16x16x32_bf16 v[192:195], v[56:59], v[224:227], v[192:195]
  ds_read_b64_tr_b16 v[72:73], v12 offset:8448
  v_accvgpr_read_b32 v23, a23
  v_mfma_f32_16x16x32_bf16 v[208:211], v[60:63], v[224:227], v[208:211]
  ds_read_b64_tr_b16 v[74:75], v12 offset:9472
  v_mul_f32 v16, s76, v16
  v_mfma_f32_16x16x32_bf16 v[100:103], v[32:35], v[228:231], v[100:103]
  buffer_load_dwordx4 v4, s[32:35], s26 offen offset:1024 sc1 lds
  v_mul_f32 v17, s76, v17
  v_mfma_f32_16x16x32_bf16 v[116:119], v[36:39], v[228:231], v[116:119]
  ds_read_b64_tr_b16 v[76:77], v13 offset:8448
  v_mul_f32 v18, s76, v18
  v_mfma_f32_16x16x32_bf16 v[132:135], v[40:43], v[228:231], v[132:135]
  ds_read_b64_tr_b16 v[78:79], v13 offset:9472
  v_mul_f32 v19, s76, v19
  v_mfma_f32_16x16x32_bf16 v[148:151], v[44:47], v[228:231], v[148:151]
  ds_read_b128 v[240:243], v14 offset:32768
  v_mul_f32 v20, s76, v20
  v_mfma_f32_16x16x32_bf16 v[164:167], v[48:51], v[228:231], v[164:167]
  ds_read_b128 v[244:247], v14 offset:33792
  v_mul_f32 v21, s76, v21
  v_mfma_f32_16x16x32_bf16 v[180:183], v[52:55], v[228:231], v[180:183]
  buffer_load_dwordx4 v5, s[32:35], s26 offen offset:2048 sc1 lds
  v_mul_f32 v22, s76, v22
  v_mfma_f32_16x16x32_bf16 v[196:199], v[56:59], v[228:231], v[196:199]
  ds_read_b64_tr_b16 v[80:81], v12 offset:8704
  v_mul_f32 v23, s76, v23
  v_mfma_f32_16x16x32_bf16 v[212:215], v[60:63], v[228:231], v[212:215]
  ds_read_b64_tr_b16 v[82:83], v12 offset:9728
  v_cvt_pk_bf16_f32 v24, v16, v17
  v_mfma_f32_16x16x32_bf16 v[104:107], v[32:35], v[232:235], v[104:107]
  ds_read_b64_tr_b16 v[84:85], v13 offset:8704
  v_cvt_pk_bf16_f32 v25, v18, v19
  v_mfma_f32_16x16x32_bf16 v[120:123], v[36:39], v[232:235], v[120:123]
  ds_read_b64_tr_b16 v[86:87], v13 offset:9728
  v_cvt_pk_bf16_f32 v26, v20, v21
  v_mfma_f32_16x16x32_bf16 v[136:139], v[40:43], v[232:235], v[136:139]
  buffer_load_dwordx4 v6, s[32:35], s26 offen offset:3072 sc1 lds
  v_cvt_pk_bf16_f32 v27, v22, v23
  v_mfma_f32_16x16x32_bf16 v[152:155], v[44:47], v[232:235], v[152:155]
  s_add_u32 s26, s26, 1024
  ds_read_b64_tr_b16 v[88:89], v12 offset:8960
  buffer_store_dwordx4 v[24:27], v2, s[40:43], s64 offen offset:2048 sc1
  v_mfma_f32_16x16x32_bf16 v[168:171], v[48:51], v[232:235], v[168:171]
  ds_read_b64_tr_b16 v[90:91], v12 offset:9984
  v_mfma_f32_16x16x32_bf16 v[184:187], v[52:55], v[232:235], v[184:187]
  ds_read_b64_tr_b16 v[92:93], v13 offset:8960
  v_mfma_f32_16x16x32_bf16 v[200:203], v[56:59], v[232:235], v[200:203]
  s_add_u32 m0, s24, 114688
  ds_read_b64_tr_b16 v[94:95], v13 offset:9984
  v_mfma_f32_16x16x32_bf16 v[216:219], v[60:63], v[232:235], v[216:219]
  buffer_load_dwordx4 v10, s[36:39], s27 offen offset:2048 lds
  v_mfma_f32_16x16x32_bf16 v[108:111], v[32:35], v[236:239], v[108:111]
  ds_read_b128 v[248:251], v14 offset:34816
  v_mfma_f32_16x16x32_bf16 v[124:127], v[36:39], v[236:239], v[124:127]
  ds_read_b128 v[252:255], v14 offset:35840
  v_mfma_f32_16x16x32_bf16 v[140:143], v[40:43], v[236:239], v[140:143]
  v_mfma_f32_16x16x32_bf16 v[156:159], v[44:47], v[236:239], v[156:159]
  v_xor_b32 v14, 0x10000, v14
  v_mfma_f32_16x16x32_bf16 v[172:175], v[48:51], v[236:239], v[172:175]
  buffer_load_dwordx4 v11, s[36:39], s27 offen offset:3072 lds
  v_mfma_f32_16x16x32_bf16 v[188:191], v[52:55], v[236:239], v[188:191]
  s_add_u32 s27, s27, 524288
  v_mfma_f32_16x16x32_bf16 v[204:207], v[56:59], v[236:239], v[204:207]
  v_mfma_f32_16x16x32_bf16 v[220:223], v[60:63], v[236:239], v[220:223]
  s_waitcnt vmcnt(18) lgkmcnt(0)
  v_mfma_f32_16x16x32_bf16 v[96:99], v[64:67], v[240:243], v[96:99]
  s_barrier
  v_accvgpr_read_b32 v16, a24
  v_accvgpr_read_b32 v17, a25
  v_mfma_f32_16x16x32_bf16 v[112:115], v[68:71], v[240:243], v[112:115]
  ds_read_b64_tr_b16 v[32:33], v12 offset:32768
  v_accvgpr_read_b32 v18, a26
  v_mfma_f32_16x16x32_bf16 v[128:131], v[72:75], v[240:243], v[128:131]
  s_add_u32 m0, s24, 32768
  ds_read_b64_tr_b16 v[34:35], v12 offset:33792
  v_accvgpr_read_b32 v19, a27
  v_mfma_f32_16x16x32_bf16 v[144:147], v[76:79], v[240:243], v[144:147]
  buffer_load_dwordx4 v3, s[32:35], s26 offen offset:0 sc1 lds
  v_accvgpr_read_b32 v20, a28
  v_mfma_f32_16x16x32_bf16 v[160:163], v[80:83], v[240:243], v[160:163]
  ds_read_b64_tr_b16 v[36:37], v13 offset:32768
  v_accvgpr_read_b32 v21, a29
  v_mfma_f32_16x16x32_bf16 v[176:179], v[84:87], v[240:243], v[176:179]
  ds_read_b64_tr_b16 v[38:39], v13 offset:33792
  v_accvgpr_read_b32 v22, a30
  v_mfma_f32_16x16x32_bf16 v[192:195], v[88:91], v[240:243], v[192:195]
  ds_read_b64_tr_b16 v[40:41], v12 offset:33024
  v_accvgpr_read_b32 v23, a31
  v_mfma_f32_16x16x32_bf16 v[208:211], v[92:95], v[240:243], v[208:211]
  ds_read_b64_tr_b16 v[42:43], v12 offset:34048
  v_mul_f32 v16, s76, v16
  v_mfma_f32_16x16x32_bf16 v[100:103], v[64:67], v[244:247], v[100:103]
  buffer_load_dwordx4 v4, s[32:35], s26 offen offset:1024 sc1 lds
  v_mul_f32 v17, s76, v17
  v_mfma_f32_16x16x32_bf16 v[116:119], v[68:71], v[244:247], v[116:119]
  ds_read_b64_tr_b16 v[44:45], v13 offset:33024
  v_mul_f32 v18, s76, v18
  v_mfma_f32_16x16x32_bf16 v[132:135], v[72:75], v[244:247], v[132:135]
  ds_read_b64_tr_b16 v[46:47], v13 offset:34048
  v_mul_f32 v19, s76, v19
  v_mfma_f32_16x16x32_bf16 v[148:151], v[76:79], v[244:247], v[148:151]
  ds_read_b128 v[224:227], v14 offset:0
  v_mul_f32 v20, s76, v20
  v_mfma_f32_16x16x32_bf16 v[164:167], v[80:83], v[244:247], v[164:167]
  ds_read_b128 v[228:231], v14 offset:1024
  v_mul_f32 v21, s76, v21
  v_mfma_f32_16x16x32_bf16 v[180:183], v[84:87], v[244:247], v[180:183]
  buffer_load_dwordx4 v5, s[32:35], s26 offen offset:2048 sc1 lds
  v_mul_f32 v22, s76, v22
  v_mfma_f32_16x16x32_bf16 v[196:199], v[88:91], v[244:247], v[196:199]
  ds_read_b64_tr_b16 v[48:49], v12 offset:33280
  v_mul_f32 v23, s76, v23
  v_mfma_f32_16x16x32_bf16 v[212:215], v[92:95], v[244:247], v[212:215]
  ds_read_b64_tr_b16 v[50:51], v12 offset:34304
  v_cvt_pk_bf16_f32 v28, v16, v17
  v_mfma_f32_16x16x32_bf16 v[104:107], v[64:67], v[248:251], v[104:107]
  ds_read_b64_tr_b16 v[52:53], v13 offset:33280
  v_cvt_pk_bf16_f32 v29, v18, v19
  v_mfma_f32_16x16x32_bf16 v[120:123], v[68:71], v[248:251], v[120:123]
  ds_read_b64_tr_b16 v[54:55], v13 offset:34304
  v_cvt_pk_bf16_f32 v30, v20, v21
  v_mfma_f32_16x16x32_bf16 v[136:139], v[72:75], v[248:251], v[136:139]
  buffer_load_dwordx4 v6, s[32:35], s26 offen offset:3072 sc1 lds
  v_cvt_pk_bf16_f32 v31, v22, v23
  v_mfma_f32_16x16x32_bf16 v[152:155], v[76:79], v[248:251], v[152:155]
  s_add_u32 s26, s26, 1024
  ds_read_b64_tr_b16 v[56:57], v12 offset:33536
  buffer_store_dwordx4 v[28:31], v2, s[40:43], s64 offen offset:3072 sc1
  v_mfma_f32_16x16x32_bf16 v[168:171], v[80:83], v[248:251], v[168:171]
  ds_read_b64_tr_b16 v[58:59], v12 offset:34560
  v_mfma_f32_16x16x32_bf16 v[184:187], v[84:87], v[248:251], v[184:187]
  ds_read_b64_tr_b16 v[60:61], v13 offset:33536
  v_mfma_f32_16x16x32_bf16 v[200:203], v[88:91], v[248:251], v[200:203]
  s_add_u32 m0, s24, 16384
  ds_read_b64_tr_b16 v[62:63], v13 offset:34560
  v_mfma_f32_16x16x32_bf16 v[216:219], v[92:95], v[248:251], v[216:219]
  buffer_load_dwordx4 v8, s[36:39], s27 offen offset:0 lds
  v_mfma_f32_16x16x32_bf16 v[108:111], v[64:67], v[252:255], v[108:111]
  ds_read_b128 v[232:235], v14 offset:2048
  v_mfma_f32_16x16x32_bf16 v[124:127], v[68:71], v[252:255], v[124:127]
  ds_read_b128 v[236:239], v14 offset:3072
  v_mfma_f32_16x16x32_bf16 v[140:143], v[72:75], v[252:255], v[140:143]
  v_mfma_f32_16x16x32_bf16 v[156:159], v[76:79], v[252:255], v[156:159]
  v_mfma_f32_16x16x32_bf16 v[172:175], v[80:83], v[252:255], v[172:175]
  buffer_load_dwordx4 v9, s[36:39], s27 offen offset:1024 lds
  v_mfma_f32_16x16x32_bf16 v[188:191], v[84:87], v[252:255], v[188:191]
  v_mfma_f32_16x16x32_bf16 v[204:207], v[88:91], v[252:255], v[204:207]
  v_mfma_f32_16x16x32_bf16 v[220:223], v[92:95], v[252:255], v[220:223]
  s_waitcnt vmcnt(17) lgkmcnt(0)
  v_mfma_f32_16x16x32_bf16 v[96:99], v[32:35], v[224:227], v[96:99]
  s_add_u32 s64, s64, 4096
  v_accvgpr_read_b32 v16, a32
  v_accvgpr_read_b32 v17, a33
  v_mfma_f32_16x16x32_bf16 v[112:115], v[36:39], v[224:227], v[112:115]
  ds_read_b64_tr_b16 v[64:65], v12 offset:40960
  v_accvgpr_read_b32 v18, a34
  v_mfma_f32_16x16x32_bf16 v[128:131], v[40:43], v[224:227], v[128:131]
  s_add_u32 m0, s24, 65536
  ds_read_b64_tr_b16 v[66:67], v12 offset:41984
  v_accvgpr_read_b32 v19, a35
  v_mfma_f32_16x16x32_bf16 v[144:147], v[44:47], v[224:227], v[144:147]
  buffer_load_dwordx4 v3, s[32:35], s26 offen offset:0 sc1 lds
  v_accvgpr_read_b32 v20, a36
  v_mfma_f32_16x16x32_bf16 v[160:163], v[48:51], v[224:227], v[160:163]
  ds_read_b64_tr_b16 v[68:69], v13 offset:40960
  v_accvgpr_read_b32 v21, a37
  v_mfma_f32_16x16x32_bf16 v[176:179], v[52:55], v[224:227], v[176:179]
  ds_read_b64_tr_b16 v[70:71], v13 offset:41984
  v_accvgpr_read_b32 v22, a38
  v_mfma_f32_16x16x32_bf16 v[192:195], v[56:59], v[224:227], v[192:195]
  ds_read_b64_tr_b16 v[72:73], v12 offset:41216
  v_accvgpr_read_b32 v23, a39
  v_mfma_f32_16x16x32_bf16 v[208:211], v[60:63], v[224:227], v[208:211]
  ds_read_b64_tr_b16 v[74:75], v12 offset:42240
  v_mul_f32 v16, s76, v16
  v_mfma_f32_16x16x32_bf16 v[100:103], v[32:35], v[228:231], v[100:103]
  buffer_load_dwordx4 v4, s[32:35], s26 offen offset:1024 sc1 lds
  v_mul_f32 v17, s76, v17
  v_mfma_f32_16x16x32_bf16 v[116:119], v[36:39], v[228:231], v[116:119]
  ds_read_b64_tr_b16 v[76:77], v13 offset:41216
  v_mul_f32 v18, s76, v18
  v_mfma_f32_16x16x32_bf16 v[132:135], v[40:43], v[228:231], v[132:135]
  ds_read_b64_tr_b16 v[78:79], v13 offset:42240
  v_mul_f32 v19, s76, v19
  v_mfma_f32_16x16x32_bf16 v[148:151], v[44:47], v[228:231], v[148:151]
  ds_read_b128 v[240:243], v14 offset:32768
  v_mul_f32 v20, s76, v20
  v_mfma_f32_16x16x32_bf16 v[164:167], v[48:51], v[228:231], v[164:167]
  ds_read_b128 v[244:247], v14 offset:33792
  v_mul_f32 v21, s76, v21
  v_mfma_f32_16x16x32_bf16 v[180:183], v[52:55], v[228:231], v[180:183]
  buffer_load_dwordx4 v5, s[32:35], s26 offen offset:2048 sc1 lds
  v_mul_f32 v22, s76, v22
  v_mfma_f32_16x16x32_bf16 v[196:199], v[56:59], v[228:231], v[196:199]
  ds_read_b64_tr_b16 v[80:81], v12 offset:41472
  v_mul_f32 v23, s76, v23
  v_mfma_f32_16x16x32_bf16 v[212:215], v[60:63], v[228:231], v[212:215]
  ds_read_b64_tr_b16 v[82:83], v12 offset:42496
  v_cvt_pk_bf16_f32 v24, v16, v17
  v_mfma_f32_16x16x32_bf16 v[104:107], v[32:35], v[232:235], v[104:107]
  ds_read_b64_tr_b16 v[84:85], v13 offset:41472
  v_cvt_pk_bf16_f32 v25, v18, v19
  v_mfma_f32_16x16x32_bf16 v[120:123], v[36:39], v[232:235], v[120:123]
  ds_read_b64_tr_b16 v[86:87], v13 offset:42496
  v_cvt_pk_bf16_f32 v26, v20, v21
  v_mfma_f32_16x16x32_bf16 v[136:139], v[40:43], v[232:235], v[136:139]
  buffer_load_dwordx4 v6, s[32:35], s26 offen offset:3072 sc1 lds
  v_cvt_pk_bf16_f32 v27, v22, v23
  v_mfma_f32_16x16x32_bf16 v[152:155], v[44:47], v[232:235], v[152:155]
  s_add_u32 s26, s26, 1024
  ds_read_b64_tr_b16 v[88:89], v12 offset:41728
  buffer_store_dwordx4 v[24:27], v2, s[40:43], s64 offen offset:0 sc1
  v_mfma_f32_16x16x32_bf16 v[168:171], v[48:51], v[232:235], v[168:171]
  ds_read_b64_tr_b16 v[90:91], v12 offset:42752
  v_mfma_f32_16x16x32_bf16 v[184:187], v[52:55], v[232:235], v[184:187]
  ds_read_b64_tr_b16 v[92:93], v13 offset:41728
  v_mfma_f32_16x16x32_bf16 v[200:203], v[56:59], v[232:235], v[200:203]
  s_add_u32 m0, s24, 16384
  ds_read_b64_tr_b16 v[94:95], v13 offset:42752
  v_mfma_f32_16x16x32_bf16 v[216:219], v[60:63], v[232:235], v[216:219]
  buffer_load_dwordx4 v10, s[36:39], s27 offen offset:2048 lds
  v_mfma_f32_16x16x32_bf16 v[108:111], v[32:35], v[236:239], v[108:111]
  ds_read_b128 v[248:251], v14 offset:34816
  v_mfma_f32_16x16x32_bf16 v[124:127], v[36:39], v[236:239], v[124:127]
  ds_read_b128 v[252:255], v14 offset:35840
  v_mfma_f32_16x16x32_bf16 v[140:143], v[40:43], v[236:239], v[140:143]
  v_mfma_f32_16x16x32_bf16 v[156:159], v[44:47], v[236:239], v[156:159]
  v_xor_b32 v14, 0x10000, v14
  v_mfma_f32_16x16x32_bf16 v[172:175], v[48:51], v[236:239], v[172:175]
  buffer_load_dwordx4 v11, s[36:39], s27 offen offset:3072 lds
  v_mfma_f32_16x16x32_bf16 v[188:191], v[52:55], v[236:239], v[188:191]
  s_add_u32 s27, s27, 524288
  v_xor_b32 v12, 0x10000, v12
  v_mfma_f32_16x16x32_bf16 v[204:207], v[56:59], v[236:239], v[204:207]
  v_xor_b32 v13, 0x10000, v13
  v_mfma_f32_16x16x32_bf16 v[220:223], v[60:63], v[236:239], v[220:223]
  s_waitcnt vmcnt(17) lgkmcnt(0)
  v_mfma_f32_16x16x32_bf16 v[96:99], v[64:67], v[240:243], v[96:99]
  s_barrier
  v_accvgpr_read_b32 v16, a40
  v_accvgpr_read_b32 v17, a41
  v_mfma_f32_16x16x32_bf16 v[112:115], v[68:71], v[240:243], v[112:115]
  ds_read_b64_tr_b16 v[32:33], v12 offset:0
  v_accvgpr_read_b32 v18, a42
  v_mfma_f32_16x16x32_bf16 v[128:131], v[72:75], v[240:243], v[128:131]
  s_add_u32 m0, s24, 98304
  ds_read_b64_tr_b16 v[34:35], v12 offset:1024
  v_accvgpr_read_b32 v19, a43
  v_mfma_f32_16x16x32_bf16 v[144:147], v[76:79], v[240:243], v[144:147]
  buffer_load_dwordx4 v3, s[32:35], s26 offen offset:0 sc1 lds
  v_accvgpr_read_b32 v20, a44
  v_mfma_f32_16x16x32_bf16 v[160:163], v[80:83], v[240:243], v[160:163]
  ds_read_b64_tr_b16 v[36:37], v13 offset:0
  v_accvgpr_read_b32 v21, a45
  v_mfma_f32_16x16x32_bf16 v[176:179], v[84:87], v[240:243], v[176:179]
  ds_read_b64_tr_b16 v[38:39], v13 offset:1024
  v_accvgpr_read_b32 v22, a46
  v_mfma_f32_16x16x32_bf16 v[192:195], v[88:91], v[240:243], v[192:195]
  ds_read_b64_tr_b16 v[40:41], v12 offset:256
  v_accvgpr_read_b32 v23, a47
  v_mfma_f32_16x16x32_bf16 v[208:211], v[92:95], v[240:243], v[208:211]
  ds_read_b64_tr_b16 v[42:43], v12 offset:1280
  v_mul_f32 v16, s76, v16
  v_mfma_f32_16x16x32_bf16 v[100:103], v[64:67], v[244:247], v[100:103]
  buffer_load_dwordx4 v4, s[32:35], s26 offen offset:1024 sc1 lds
  v_mul_f32 v17, s76, v17
  v_mfma_f32_16x16x32_bf16 v[116:119], v[68:71], v[244:247], v[116:119]
  ds_read_b64_tr_b16 v[44:45], v13 offset:256
  v_mul_f32 v18, s76, v18
  v_mfma_f32_16x16x32_bf16 v[132:135], v[72:75], v[244:247], v[132:135]
  ds_read_b64_tr_b16 v[46:47], v13 offset:1280
  v_mul_f32 v19, s76, v19
  v_mfma_f32_16x16x32_bf16 v[148:151], v[76:79], v[244:247], v[148:151]
  ds_read_b128 v[224:227], v14 offset:0
  v_mul_f32 v20, s76, v20
  v_mfma_f32_16x16x32_bf16 v[164:167], v[80:83], v[244:247], v[164:167]
  ds_read_b128 v[228:231], v14 offset:1024
  v_mul_f32 v21, s76, v21
  v_mfma_f32_16x16x32_bf16 v[180:183], v[84:87], v[244:247], v[180:183]
  buffer_load_dwordx4 v5, s[32:35], s26 offen offset:2048 sc1 lds
  v_mul_f32 v22, s76, v22
  v_mfma_f32_16x16x32_bf16 v[196:199], v[88:91], v[244:247], v[196:199]
  ds_read_b64_tr_b16 v[48:49], v12 offset:512
  v_mul_f32 v23, s76, v23
  v_mfma_f32_16x16x32_bf16 v[212:215], v[92:95], v[244:247], v[212:215]
  ds_read_b64_tr_b16 v[50:51], v12 offset:1536
  v_cvt_pk_bf16_f32 v28, v16, v17
  v_mfma_f32_16x16x32_bf16 v[104:107], v[64:67], v[248:251], v[104:107]
  ds_read_b64_tr_b16 v[52:53], v13 offset:512
  v_cvt_pk_bf16_f32 v29, v18, v19
  v_mfma_f32_16x16x32_bf16 v[120:123], v[68:71], v[248:251], v[120:123]
  ds_read_b64_tr_b16 v[54:55], v13 offset:1536
  v_cvt_pk_bf16_f32 v30, v20, v21
  v_mfma_f32_16x16x32_bf16 v[136:139], v[72:75], v[248:251], v[136:139]
  buffer_load_dwordx4 v6, s[32:35], s26 offen offset:3072 sc1 lds
  v_cvt_pk_bf16_f32 v31, v22, v23
  v_mfma_f32_16x16x32_bf16 v[152:155], v[76:79], v[248:251], v[152:155]
  s_add_u32 s26, s26, 1024
  ds_read_b64_tr_b16 v[56:57], v12 offset:768
  buffer_store_dwordx4 v[28:31], v2, s[40:43], s64 offen offset:1024 sc1
  v_mfma_f32_16x16x32_bf16 v[168:171], v[80:83], v[248:251], v[168:171]
  ds_read_b64_tr_b16 v[58:59], v12 offset:1792
  v_mfma_f32_16x16x32_bf16 v[184:187], v[84:87], v[248:251], v[184:187]
  ds_read_b64_tr_b16 v[60:61], v13 offset:768
  v_mfma_f32_16x16x32_bf16 v[200:203], v[88:91], v[248:251], v[200:203]
  s_add_u32 m0, s24, 49152
  ds_read_b64_tr_b16 v[62:63], v13 offset:1792
  v_mfma_f32_16x16x32_bf16 v[216:219], v[92:95], v[248:251], v[216:219]
  buffer_load_dwordx4 v8, s[36:39], s27 offen offset:0 lds
  v_mfma_f32_16x16x32_bf16 v[108:111], v[64:67], v[252:255], v[108:111]
  ds_read_b128 v[232:235], v14 offset:2048
  v_mfma_f32_16x16x32_bf16 v[124:127], v[68:71], v[252:255], v[124:127]
  ds_read_b128 v[236:239], v14 offset:3072
  v_mfma_f32_16x16x32_bf16 v[140:143], v[72:75], v[252:255], v[140:143]
  v_mfma_f32_16x16x32_bf16 v[156:159], v[76:79], v[252:255], v[156:159]
  v_mfma_f32_16x16x32_bf16 v[172:175], v[80:83], v[252:255], v[172:175]
  buffer_load_dwordx4 v9, s[36:39], s27 offen offset:1024 lds
  v_mfma_f32_16x16x32_bf16 v[188:191], v[84:87], v[252:255], v[188:191]
  v_mfma_f32_16x16x32_bf16 v[204:207], v[88:91], v[252:255], v[204:207]
  v_mfma_f32_16x16x32_bf16 v[220:223], v[92:95], v[252:255], v[220:223]
  s_waitcnt vmcnt(17) lgkmcnt(0)
  v_mfma_f32_16x16x32_bf16 v[96:99], v[32:35], v[224:227], v[96:99]
  v_accvgpr_read_b32 v16, a48
  v_accvgpr_read_b32 v17, a49
  v_accvgpr_read_b32 v18, a50
  v_mfma_f32_16x16x32_bf16 v[112:115], v[36:39], v[224:227], v[112:115]
  ds_read_b64_tr_b16 v[64:65], v12 offset:8192
  v_accvgpr_read_b32 v19, a51
  v_mfma_f32_16x16x32_bf16 v[128:131], v[40:43], v[224:227], v[128:131]
  s_add_u32 m0, s24, 0
  ds_read_b64_tr_b16 v[66:67], v12 offset:9216
  v_accvgpr_read_b32 v20, a52
  v_mfma_f32_16x16x32_bf16 v[144:147], v[44:47], v[224:227], v[144:147]
  buffer_load_dwordx4 v3, s[32:35], s26 offen offset:0 sc1 lds
  v_accvgpr_read_b32 v21, a53
  v_accvgpr_read_b32 v22, a54
  v_mfma_f32_16x16x32_bf16 v[160:163], v[48:51], v[224:227], v[160:163]
  ds_read_b64_tr_b16 v[68:69], v13 offset:8192
  v_accvgpr_read_b32 v23, a55
  v_mfma_f32_16x16x32_bf16 v[176:179], v[52:55], v[224:227], v[176:179]
  ds_read_b64_tr_b16 v[70:71], v13 offset:9216
  v_mul_f32 v16, s76, v16
  v_mfma_f32_16x16x32_bf16 v[192:195], v[56:59], v[224:227], v[192:195]
  ds_read_b64_tr_b16 v[72:73], v12 offset:8448
  v_mul_f32 v17, s76, v17
  v_mfma_f32_16x16x32_bf16 v[208:211], v[60:63], v[224:227], v[208:211]
  ds_read_b64_tr_b16 v[74:75], v12 offset:9472
  v_mul_f32 v18, s76, v18
  v_mul_f32 v19, s76, v19
  v_mfma_f32_16x16x32_bf16 v[100:103], v[32:35], v[228:231], v[100:103]
  buffer_load_dwordx4 v4, s[32:35], s26 offen offset:1024 sc1 lds
  v_mul_f32 v20, s76, v20
  v_mfma_f32_16x16x32_bf16 v[116:119], v[36:39], v[228:231], v[116:119]
  ds_read_b64_tr_b16 v[76:77], v13 offset:8448
  v_mul_f32 v21, s76, v21
  v_mfma_f32_16x16x32_bf16 v[132:135], v[40:43], v[228:231], v[132:135]
  ds_read_b64_tr_b16 v[78:79], v13 offset:9472
  v_mul_f32 v22, s76, v22
  v_mfma_f32_16x16x32_bf16 v[148:151], v[44:47], v[228:231], v[148:151]
  ds_read_b128 v[240:243], v14 offset:32768
  v_mul_f32 v23, s76, v23
  v_cvt_pk_bf16_f32 v24, v16, v17
  v_mfma_f32_16x16x32_bf16 v[164:167], v[48:51], v[228:231], v[164:167]
  ds_read_b128 v[244:247], v14 offset:33792
  v_cvt_pk_bf16_f32 v25, v18, v19
  v_mfma_f32_16x16x32_bf16 v[180:183], v[52:55], v[228:231], v[180:183]
  buffer_load_dwordx4 v5, s[32:35], s26 offen offset:2048 sc1 lds
  v_cvt_pk_bf16_f32 v26, v20, v21
  v_mfma_f32_16x16x32_bf16 v[196:199], v[56:59], v[228:231], v[196:199]
  ds_read_b64_tr_b16 v[80:81], v12 offset:8704
  v_cvt_pk_bf16_f32 v27, v22, v23
  v_mfma_f32_16x16x32_bf16 v[212:215], v[60:63], v[228:231], v[212:215]
  ds_read_b64_tr_b16 v[82:83], v12 offset:9728
  buffer_store_dwordx4 v[24:27], v2, s[40:43], s64 offen offset:2048 sc1
  v_accvgpr_read_b32 v16, a56
  v_mfma_f32_16x16x32_bf16 v[104:107], v[32:35], v[232:235], v[104:107]
  ds_read_b64_tr_b16 v[84:85], v13 offset:8704
  v_accvgpr_read_b32 v17, a57
  v_mfma_f32_16x16x32_bf16 v[120:123], v[36:39], v[232:235], v[120:123]
  ds_read_b64_tr_b16 v[86:87], v13 offset:9728
  v_accvgpr_read_b32 v18, a58
  v_mfma_f32_16x16x32_bf16 v[136:139], v[40:43], v[232:235], v[136:139]
  buffer_load_dwordx4 v6, s[32:35], s26 offen offset:3072 sc1 lds
  v_accvgpr_read_b32 v19, a59
  v_accvgpr_read_b32 v20, a60
  v_mfma_f32_16x16x32_bf16 v[152:155], v[44:47], v[232:235], v[152:155]
  s_add_u32 s26, s26, 1024
  ds_read_b64_tr_b16 v[88:89], v12 offset:8960
  v_accvgpr_read_b32 v21, a61
  v_mfma_f32_16x16x32_bf16 v[168:171], v[48:51], v[232:235], v[168:171]
  ds_read_b64_tr_b16 v[90:91], v12 offset:9984
  v_accvgpr_read_b32 v22, a62
  v_mfma_f32_16x16x32_bf16 v[184:187], v[52:55], v[232:235], v[184:187]
  ds_read_b64_tr_b16 v[92:93], v13 offset:8960
  v_accvgpr_read_b32 v23, a63
  v_mfma_f32_16x16x32_bf16 v[200:203], v[56:59], v[232:235], v[200:203]
  s_add_u32 m0, s24, 49152
  ds_read_b64_tr_b16 v[94:95], v13 offset:9984
  v_mul_f32 v16, s76, v16
  v_mul_f32 v17, s76, v17
  v_mfma_f32_16x16x32_bf16 v[216:219], v[60:63], v[232:235], v[216:219]
  buffer_load_dwordx4 v10, s[36:39], s27 offen offset:2048 lds
  v_mul_f32 v18, s76, v18
  v_mfma_f32_16x16x32_bf16 v[108:111], v[32:35], v[236:239], v[108:111]
  ds_read_b128 v[248:251], v14 offset:34816
  v_mul_f32 v19, s76, v19
  v_mfma_f32_16x16x32_bf16 v[124:127], v[36:39], v[236:239], v[124:127]
  ds_read_b128 v[252:255], v14 offset:35840
  v_mul_f32 v20, s76, v20
  v_mfma_f32_16x16x32_bf16 v[140:143], v[40:43], v[236:239], v[140:143]
  v_mul_f32 v21, s76, v21
  v_mul_f32 v22, s76, v22
  v_mul_f32 v23, s76, v23
  v_mfma_f32_16x16x32_bf16 v[156:159], v[44:47], v[236:239], v[156:159]
  v_xor_b32 v14, 0x10000, v14
  v_cvt_pk_bf16_f32 v28, v16, v17
  v_mfma_f32_16x16x32_bf16 v[172:175], v[48:51], v[236:239], v[172:175]
  buffer_load_dwordx4 v11, s[36:39], s27 offen offset:3072 lds
  v_cvt_pk_bf16_f32 v29, v18, v19
  v_mfma_f32_16x16x32_bf16 v[188:191], v[52:55], v[236:239], v[188:191]
  s_add_u32 s27, s27, 524288
  v_cvt_pk_bf16_f32 v30, v20, v21
  v_cvt_pk_bf16_f32 v31, v22, v23
  v_mfma_f32_16x16x32_bf16 v[204:207], v[56:59], v[236:239], v[204:207]
  buffer_store_dwordx4 v[28:31], v2, s[40:43], s64 offen offset:3072 sc1
  v_mfma_f32_16x16x32_bf16 v[220:223], v[60:63], v[236:239], v[220:223]
  s_waitcnt vmcnt(18) lgkmcnt(0)
  v_mfma_f32_16x16x32_bf16 v[96:99], v[64:67], v[240:243], v[96:99]
  s_barrier
  v_accvgpr_read_b32 v16, a64
  v_accvgpr_read_b32 v17, a65
  v_accvgpr_read_b32 v18, a66
  v_mfma_f32_16x16x32_bf16 v[112:115], v[68:71], v[240:243], v[112:115]
  s_add_u32 s64, s64, 126976
  ds_read_b64_tr_b16 v[32:33], v12 offset:32768
  v_accvgpr_read_b32 v19, a67
  v_accvgpr_read_b32 v20, a68
  v_mfma_f32_16x16x32_bf16 v[128:131], v[72:75], v[240:243], v[128:131]
  s_add_u32 m0, s24, 32768
  ds_read_b64_tr_b16 v[34:35], v12 offset:33792
  v_accvgpr_read_b32 v21, a69
  v_mfma_f32_16x16x32_bf16 v[144:147], v[76:79], v[240:243], v[144:147]
  buffer_load_dwordx4 v3, s[32:35], s26 offen offset:0 sc1 lds
  v_accvgpr_read_b32 v22, a70
  v_accvgpr_read_b32 v23, a71
  v_mfma_f32_16x16x32_bf16 v[160:163], v[80:83], v[240:243], v[160:163]
  ds_read_b64_tr_b16 v[36:37], v13 offset:32768
  v_mul_f32 v16, s76, v16
  v_mfma_f32_16x16x32_bf16 v[176:179], v[84:87], v[240:243], v[176:179]
  ds_read_b64_tr_b16 v[38:39], v13 offset:33792
  v_mul_f32 v17, s76, v17
  v_mul_f32 v18, s76, v18
  v_mfma_f32_16x16x32_bf16 v[192:195], v[88:91], v[240:243], v[192:195]
  ds_read_b64_tr_b16 v[40:41], v12 offset:33024
  v_mul_f32 v19, s76, v19
  v_mfma_f32_16x16x32_bf16 v[208:211], v[92:95], v[240:243], v[208:211]
  ds_read_b64_tr_b16 v[42:43], v12 offset:34048
  v_mul_f32 v20, s76, v20
  v_mul_f32 v21, s76, v21
  v_mfma_f32_16x16x32_bf16 v[100:103], v[64:67], v[244:247], v[100:103]
  buffer_load_dwordx4 v4, s[32:35], s26 offen offset:1024 sc1 lds
  v_mul_f32 v22, s76, v22
  v_mfma_f32_16x16x32_bf16 v[116:119], v[68:71], v[244:247], v[116:119]
  ds_read_b64_tr_b16 v[44:45], v13 offset:33024
  v_mul_f32 v23, s76, v23
  v_cvt_pk_bf16_f32 v24, v16, v17
  v_mfma_f32_16x16x32_bf16 v[132:135], v[72:75], v[244:247], v[132:135]
  ds_read_b64_tr_b16 v[46:47], v13 offset:34048
  v_cvt_pk_bf16_f32 v25, v18, v19
  v_mfma_f32_16x16x32_bf16 v[148:151], v[76:79], v[244:247], v[148:151]
  ds_read_b128 v[224:227], v14 offset:0
  v_cvt_pk_bf16_f32 v26, v20, v21
  v_cvt_pk_bf16_f32 v27, v22, v23
  v_mfma_f32_16x16x32_bf16 v[164:167], v[80:83], v[244:247], v[164:167]
  ds_read_b128 v[228:231], v14 offset:1024
  buffer_store_dwordx4 v[24:27], v2, s[40:43], s64 offen offset:0 sc1
  v_mfma_f32_16x16x32_bf16 v[180:183], v[84:87], v[244:247], v[180:183]
  buffer_load_dwordx4 v5, s[32:35], s26 offen offset:2048 sc1 lds
  v_accvgpr_read_b32 v16, a72
  v_accvgpr_read_b32 v17, a73
  v_mfma_f32_16x16x32_bf16 v[196:199], v[88:91], v[244:247], v[196:199]
  ds_read_b64_tr_b16 v[48:49], v12 offset:33280
  v_accvgpr_read_b32 v18, a74
  v_mfma_f32_16x16x32_bf16 v[212:215], v[92:95], v[244:247], v[212:215]
  ds_read_b64_tr_b16 v[50:51], v12 offset:34304
  v_accvgpr_read_b32 v19, a75
  v_accvgpr_read_b32 v20, a76
  v_mfma_f32_16x16x32_bf16 v[104:107], v[64:67], v[248:251], v[104:107]
  ds_read_b64_tr_b16 v[52:53], v13 offset:33280
  v_accvgpr_read_b32 v21, a77
  v_accvgpr_read_b32 v22, a78
  v_mfma_f32_16x16x32_bf16 v[120:123], v[68:71], v[248:251], v[120:123]
  ds_read_b64_tr_b16 v[54:55], v13 offset:34304
  v_accvgpr_read_b32 v23, a79
  v_mfma_f32_16x16x32_bf16 v[136:139], v[72:75], v[248:251], v[136:139]
  buffer_load_dwordx4 v6, s[32:35], s26 offen offset:3072 sc1 lds
  v_mul_f32 v16, s76, v16
  v_mul_f32 v17, s76, v17
  v_mfma_f32_16x16x32_bf16 v[152:155], v[76:79], v[248:251], v[152:155]
  s_add_u32 s26, s26, 1024
  ds_read_b64_tr_b16 v[56:57], v12 offset:33536
  v_mul_f32 v18, s76, v18
  v_mfma_f32_16x16x32_bf16 v[168:171], v[80:83], v[248:251], v[168:171]
  ds_read_b64_tr_b16 v[58:59], v12 offset:34560
  v_mul_f32 v19, s76, v19
  v_mul_f32 v20, s76, v20
  v_mfma_f32_16x16x32_bf16 v[184:187], v[84:87], v[248:251], v[184:187]
  ds_read_b64_tr_b16 v[60:61], v13 offset:33536
  v_mul_f32 v21, s76, v21
  v_mfma_f32_16x16x32_bf16 v[200:203], v[88:91], v[248:251], v[200:203]
  ds_read_b64_tr_b16 v[62:63], v13 offset:34560
  v_mul_f32 v22, s76, v22
  v_mul_f32 v23, s76, v23
  v_mfma_f32_16x16x32_bf16 v[216:219], v[92:95], v[248:251], v[216:219]
  v_cvt_pk_bf16_f32 v28, v16, v17
  v_cvt_pk_bf16_f32 v29, v18, v19
  v_mfma_f32_16x16x32_bf16 v[108:111], v[64:67], v[252:255], v[108:111]
  ds_read_b128 v[232:235], v14 offset:2048
  v_cvt_pk_bf16_f32 v30, v20, v21
  v_cvt_pk_bf16_f32 v31, v22, v23
  v_mfma_f32_16x16x32_bf16 v[124:127], v[68:71], v[252:255], v[124:127]
  ds_read_b128 v[236:239], v14 offset:3072
  buffer_store_dwordx4 v[28:31], v2, s[40:43], s64 offen offset:1024 sc1
  v_mfma_f32_16x16x32_bf16 v[140:143], v[72:75], v[252:255], v[140:143]
  v_and_b32 v11, 15, v1
  v_lshrrev_b32 v10, 4, v1
  v_lshlrev_b32 v10, 2, v10
  v_mfma_f32_16x16x32_bf16 v[156:159], v[76:79], v[252:255], v[156:159]
  v_sub_u32 v11, v11, v10
  v_cmp_le_i32 s[68:69], 0, v11
  v_mfma_f32_16x16x32_bf16 v[172:175], v[80:83], v[252:255], v[172:175]
  v_cmp_le_i32 s[70:71], 1, v11
  v_cmp_le_i32 s[72:73], 2, v11
  v_cmp_le_i32 s[74:75], 3, v11
  v_mfma_f32_16x16x32_bf16 v[188:191], v[84:87], v[252:255], v[188:191]
  v_and_b32 v8, 7, v1
  v_lshlrev_b32 v8, 2, v8
  v_mfma_f32_16x16x32_bf16 v[204:207], v[88:91], v[252:255], v[204:207]
  v_add_u32 v8, s30, v8
  v_mfma_f32_16x16x32_bf16 v[220:223], v[92:95], v[252:255], v[220:223]
  s_waitcnt vmcnt(17) lgkmcnt(0)
  v_mfma_f32_16x16x32_bf16 v[96:99], v[32:35], v[224:227], v[96:99]
  v_accvgpr_read_b32 v16, a80
  v_accvgpr_read_b32 v17, a81
  v_accvgpr_read_b32 v18, a82
  v_mfma_f32_16x16x32_bf16 v[112:115], v[36:39], v[224:227], v[112:115]
  ds_read_b64_tr_b16 v[64:65], v12 offset:40960
  v_accvgpr_read_b32 v19, a83
  v_accvgpr_read_b32 v20, a84
  v_mfma_f32_16x16x32_bf16 v[128:131], v[40:43], v[224:227], v[128:131]
  s_add_u32 m0, s24, 65536
  ds_read_b64_tr_b16 v[66:67], v12 offset:41984
  v_accvgpr_read_b32 v21, a85
  v_accvgpr_read_b32 v22, a86
  v_mfma_f32_16x16x32_bf16 v[144:147], v[44:47], v[224:227], v[144:147]
  buffer_load_dwordx4 v3, s[32:35], s26 offen offset:0 sc1 lds
  v_accvgpr_read_b32 v23, a87
  v_mul_f32 v16, s76, v16
  v_mfma_f32_16x16x32_bf16 v[160:163], v[48:51], v[224:227], v[160:163]
  ds_read_b64_tr_b16 v[68:69], v13 offset:40960
  v_mul_f32 v17, s76, v17
  v_mul_f32 v18, s76, v18
  v_mfma_f32_16x16x32_bf16 v[176:179], v[52:55], v[224:227], v[176:179]
  ds_read_b64_tr_b16 v[70:71], v13 offset:41984
  v_mul_f32 v19, s76, v19
  v_mul_f32 v20, s76, v20
  v_mfma_f32_16x16x32_bf16 v[192:195], v[56:59], v[224:227], v[192:195]
  ds_read_b64_tr_b16 v[72:73], v12 offset:41216
  v_mul_f32 v21, s76, v21
  v_mul_f32 v22, s76, v22
  v_mfma_f32_16x16x32_bf16 v[208:211], v[60:63], v[224:227], v[208:211]
  ds_read_b64_tr_b16 v[74:75], v12 offset:42240
  v_mul_f32 v23, s76, v23
  v_mfma_f32_16x16x32_bf16 v[100:103], v[32:35], v[228:231], v[100:103]
  buffer_load_dwordx4 v4, s[32:35], s26 offen offset:1024 sc1 lds
  v_cvt_pk_bf16_f32 v24, v16, v17
  v_cvt_pk_bf16_f32 v25, v18, v19
  v_mfma_f32_16x16x32_bf16 v[116:119], v[36:39], v[228:231], v[116:119]
  ds_read_b64_tr_b16 v[76:77], v13 offset:41216
  v_cvt_pk_bf16_f32 v26, v20, v21
  v_cvt_pk_bf16_f32 v27, v22, v23
  v_mfma_f32_16x16x32_bf16 v[132:135], v[40:43], v[228:231], v[132:135]
  ds_read_b64_tr_b16 v[78:79], v13 offset:42240
  buffer_store_dwordx4 v[24:27], v2, s[40:43], s64 offen offset:2048 sc1
  v_accvgpr_read_b32 v16, a88
  v_mfma_f32_16x16x32_bf16 v[148:151], v[44:47], v[228:231], v[148:151]
  ds_read_b128 v[240:243], v14 offset:32768
  v_accvgpr_read_b32 v17, a89
  v_accvgpr_read_b32 v18, a90
  v_mfma_f32_16x16x32_bf16 v[164:167], v[48:51], v[228:231], v[164:167]
  ds_read_b128 v[244:247], v14 offset:33792
  v_accvgpr_read_b32 v19, a91
  v_accvgpr_read_b32 v20, a92
  v_mfma_f32_16x16x32_bf16 v[180:183], v[52:55], v[228:231], v[180:183]
  buffer_load_dwordx4 v5, s[32:35], s26 offen offset:2048 sc1 lds
  v_accvgpr_read_b32 v21, a93
  v_accvgpr_read_b32 v22, a94
  v_mfma_f32_16x16x32_bf16 v[196:199], v[56:59], v[228:231], v[196:199]
  ds_read_b64_tr_b16 v[80:81], v12 offset:41472
  v_accvgpr_read_b32 v23, a95
  v_mfma_f32_16x16x32_bf16 v[212:215], v[60:63], v[228:231], v[212:215]
  ds_read_b64_tr_b16 v[82:83], v12 offset:42496
  v_mul_f32 v16, s76, v16
  v_mul_f32 v17, s76, v17
  v_mfma_f32_16x16x32_bf16 v[104:107], v[32:35], v[232:235], v[104:107]
  ds_read_b64_tr_b16 v[84:85], v13 offset:41472
  v_mul_f32 v18, s76, v18
  v_mul_f32 v19, s76, v19
  v_mfma_f32_16x16x32_bf16 v[120:123], v[36:39], v[232:235], v[120:123]
  ds_read_b64_tr_b16 v[86:87], v13 offset:42496
  v_mul_f32 v20, s76, v20
  v_mul_f32 v21, s76, v21
  v_mfma_f32_16x16x32_bf16 v[136:139], v[40:43], v[232:235], v[136:139]
  buffer_load_dwordx4 v6, s[32:35], s26 offen offset:3072 sc1 lds
  v_mul_f32 v22, s76, v22
  v_mul_f32 v23, s76, v23
  v_mfma_f32_16x16x32_bf16 v[152:155], v[44:47], v[232:235], v[152:155]
  s_add_u32 s26, s26, 1024
  ds_read_b64_tr_b16 v[88:89], v12 offset:41728
  v_cvt_pk_bf16_f32 v28, v16, v17
  v_cvt_pk_bf16_f32 v29, v18, v19
  v_mfma_f32_16x16x32_bf16 v[168:171], v[48:51], v[232:235], v[168:171]
  ds_read_b64_tr_b16 v[90:91], v12 offset:42752
  v_cvt_pk_bf16_f32 v30, v20, v21
  v_cvt_pk_bf16_f32 v31, v22, v23
  v_mfma_f32_16x16x32_bf16 v[184:187], v[52:55], v[232:235], v[184:187]
  ds_read_b64_tr_b16 v[92:93], v13 offset:41728
  buffer_store_dwordx4 v[28:31], v2, s[40:43], s64 offen offset:3072 sc1
  v_add_u32 v9, 0, v1
  v_mfma_f32_16x16x32_bf16 v[200:203], v[56:59], v[232:235], v[200:203]
  ds_read_b64_tr_b16 v[94:95], v13 offset:42752
  v_mul_u32_u24 v10, 6554, v9
  v_mfma_f32_16x16x32_bf16 v[216:219], v[60:63], v[232:235], v[216:219]
  v_lshrrev_b32 v10, 16, v10
  v_mul_u32_u24 v10, 1120, v10
  v_lshl_add_u32 v10, v9, 4, v10
  v_mfma_f32_16x16x32_bf16 v[108:111], v[32:35], v[236:239], v[108:111]
  ds_read_b128 v[248:251], v14 offset:34816
  v_accvgpr_write_b32 a248, v10
  v_add_u32 v9, 64, v1
  v_mfma_f32_16x16x32_bf16 v[124:127], v[36:39], v[236:239], v[124:127]
  ds_read_b128 v[252:255], v14 offset:35840
  v_mul_u32_u24 v10, 6554, v9
  v_lshrrev_b32 v10, 16, v10
  v_mfma_f32_16x16x32_bf16 v[140:143], v[40:43], v[236:239], v[140:143]
  v_mul_u32_u24 v10, 1120, v10
  v_lshl_add_u32 v10, v9, 4, v10
  v_accvgpr_write_b32 a249, v10
  v_mfma_f32_16x16x32_bf16 v[156:159], v[44:47], v[236:239], v[156:159]
  v_xor_b32 v14, 0x10000, v14
  v_add_u32 v9, 128, v1
  v_mul_u32_u24 v10, 6554, v9
  v_mfma_f32_16x16x32_bf16 v[172:175], v[48:51], v[236:239], v[172:175]
  v_lshrrev_b32 v10, 16, v10
  v_mul_u32_u24 v10, 1120, v10
  v_lshl_add_u32 v10, v9, 4, v10
  v_mfma_f32_16x16x32_bf16 v[188:191], v[52:55], v[236:239], v[188:191]
  v_xor_b32 v12, 0x10000, v12
  v_accvgpr_write_b32 a250, v10
  v_mfma_f32_16x16x32_bf16 v[204:207], v[56:59], v[236:239], v[204:207]
  v_xor_b32 v13, 0x10000, v13
  v_mfma_f32_16x16x32_bf16 v[220:223], v[60:63], v[236:239], v[220:223]
  s_waitcnt vmcnt(15) lgkmcnt(0)
  v_mfma_f32_16x16x32_bf16 v[96:99], v[64:67], v[240:243], v[96:99]
  s_barrier
  v_accvgpr_read_b32 v16, a96
  v_accvgpr_read_b32 v17, a97
  v_accvgpr_read_b32 v18, a98
  v_accvgpr_read_b32 v19, a99
  v_mfma_f32_16x16x32_bf16 v[112:115], v[68:71], v[240:243], v[112:115]
  s_add_u32 s64, s64, 4096
  ds_read_b64_tr_b16 v[32:33], v12 offset:0
  v_accvgpr_read_b32 v20, a100
  v_accvgpr_read_b32 v21, a101
  v_mfma_f32_16x16x32_bf16 v[128:131], v[72:75], v[240:243], v[128:131]
  s_add_u32 m0, s24, 98304
  ds_read_b64_tr_b16 v[34:35], v12 offset:1024
  v_accvgpr_read_b32 v22, a102
  v_accvgpr_read_b32 v23, a103
  v_mfma_f32_16x16x32_bf16 v[144:147], v[76:79], v[240:243], v[144:147]
  buffer_load_dwordx4 v3, s[32:35], s26 offen offset:0 sc1 lds
  v_mul_f32 v16, s76, v16
  v_mul_f32 v17, s76, v17
  v_mul_f32 v18, s76, v18
  v_mfma_f32_16x16x32_bf16 v[160:163], v[80:83], v[240:243], v[160:163]
  ds_read_b64_tr_b16 v[36:37], v13 offset:0
  v_mul_f32 v19, s76, v19
  v_mul_f32 v20, s76, v20
  v_mfma_f32_16x16x32_bf16 v[176:179], v[84:87], v[240:243], v[176:179]
  ds_read_b64_tr_b16 v[38:39], v13 offset:1024
  v_mul_f32 v21, s76, v21
  v_mul_f32 v22, s76, v22
  v_mfma_f32_16x16x32_bf16 v[192:195], v[88:91], v[240:243], v[192:195]
  ds_read_b64_tr_b16 v[40:41], v12 offset:256
  v_mul_f32 v23, s76, v23
  v_cvt_pk_bf16_f32 v24, v16, v17
  v_cvt_pk_bf16_f32 v25, v18, v19
  v_mfma_f32_16x16x32_bf16 v[208:211], v[92:95], v[240:243], v[208:211]
  ds_read_b64_tr_b16 v[42:43], v12 offset:1280
  v_cvt_pk_bf16_f32 v26, v20, v21
  v_cvt_pk_bf16_f32 v27, v22, v23
  v_mfma_f32_16x16x32_bf16 v[100:103], v[64:67], v[244:247], v[100:103]
  buffer_load_dwordx4 v4, s[32:35], s26 offen offset:1024 sc1 lds
  buffer_store_dwordx4 v[24:27], v2, s[40:43], s64 offen offset:0 sc1
  v_accvgpr_read_b32 v16, a104
  v_mfma_f32_16x16x32_bf16 v[116:119], v[68:71], v[244:247], v[116:119]
  ds_read_b64_tr_b16 v[44:45], v13 offset:256
  v_accvgpr_read_b32 v17, a105
  v_accvgpr_read_b32 v18, a106
  v_mfma_f32_16x16x32_bf16 v[132:135], v[72:75], v[244:247], v[132:135]
  ds_read_b64_tr_b16 v[46:47], v13 offset:1280
  v_accvgpr_read_b32 v19, a107
  v_accvgpr_read_b32 v20, a108
  v_accvgpr_read_b32 v21, a109
  v_mfma_f32_16x16x32_bf16 v[148:151], v[76:79], v[244:247], v[148:151]
  ds_read_b128 v[224:227], v14 offset:0
  v_accvgpr_read_b32 v22, a110
  v_accvgpr_read_b32 v23, a111
  v_mfma_f32_16x16x32_bf16 v[164:167], v[80:83], v[244:247], v[164:167]
  ds_read_b128 v[228:231], v14 offset:1024
  v_mul_f32 v16, s76, v16
  v_mul_f32 v17, s76, v17
  v_mfma_f32_16x16x32_bf16 v[180:183], v[84:87], v[244:247], v[180:183]
  buffer_load_dwordx4 v5, s[32:35], s26 offen offset:2048 sc1 lds
  v_mul_f32 v18, s76, v18
  v_mul_f32 v19, s76, v19
  v_mul_f32 v20, s76, v20
  v_mfma_f32_16x16x32_bf16 v[196:199], v[88:91], v[244:247], v[196:199]
  ds_read_b64_tr_b16 v[48:49], v12 offset:512
  v_mul_f32 v21, s76, v21
  v_mul_f32 v22, s76, v22
  v_mfma_f32_16x16x32_bf16 v[212:215], v[92:95], v[244:247], v[212:215]
  ds_read_b64_tr_b16 v[50:51], v12 offset:1536
  v_mul_f32 v23, s76, v23
  v_cvt_pk_bf16_f32 v28, v16, v17
  v_mfma_f32_16x16x32_bf16 v[104:107], v[64:67], v[248:251], v[104:107]
  ds_read_b64_tr_b16 v[52:53], v13 offset:512
  v_cvt_pk_bf16_f32 v29, v18, v19
  v_cvt_pk_bf16_f32 v30, v20, v21
  v_cvt_pk_bf16_f32 v31, v22, v23
  v_mfma_f32_16x16x32_bf16 v[120:123], v[68:71], v[248:251], v[120:123]
  ds_read_b64_tr_b16 v[54:55], v13 offset:1536
  buffer_store_dwordx4 v[28:31], v2, s[40:43], s64 offen offset:1024 sc1
  v_accvgpr_read_b32 v16, a112
  v_mfma_f32_16x16x32_bf16 v[136:139], v[72:75], v[248:251], v[136:139]
  buffer_load_dwordx4 v6, s[32:35], s26 offen offset:3072 sc1 lds
  v_accvgpr_read_b32 v17, a113
  v_accvgpr_read_b32 v18, a114
  v_mfma_f32_16x16x32_bf16 v[152:155], v[76:79], v[248:251], v[152:155]
  s_add_u32 s26, s26, 1024
  ds_read_b64_tr_b16 v[56:57], v12 offset:768
  v_accvgpr_read_b32 v19, a115
  v_accvgpr_read_b32 v20, a116
  v_mfma_f32_16x16x32_bf16 v[168:171], v[80:83], v[248:251], v[168:171]
  ds_read_b64_tr_b16 v[58:59], v12 offset:1792
  v_accvgpr_read_b32 v21, a117
  v_accvgpr_read_b32 v22, a118
  v_accvgpr_read_b32 v23, a119
  v_mfma_f32_16x16x32_bf16 v[184:187], v[84:87], v[248:251], v[184:187]
  ds_read_b64_tr_b16 v[60:61], v13 offset:768
  v_mul_f32 v16, s76, v16
  v_mul_f32 v17, s76, v17
  v_mfma_f32_16x16x32_bf16 v[200:203], v[88:91], v[248:251], v[200:203]
  ds_read_b64_tr_b16 v[62:63], v13 offset:1792
  v_mul_f32 v18, s76, v18
  v_mul_f32 v19, s76, v19
  v_mfma_f32_16x16x32_bf16 v[216:219], v[92:95], v[248:251], v[216:219]
  v_mul_f32 v20, s76, v20
  v_mul_f32 v21, s76, v21
  v_mul_f32 v22, s76, v22
  v_mul_f32 v23, s76, v23
  v_mfma_f32_16x16x32_bf16 v[108:111], v[64:67], v[252:255], v[108:111]
  ds_read_b128 v[232:235], v14 offset:2048
  v_cvt_pk_bf16_f32 v24, v16, v17
  v_cvt_pk_bf16_f32 v25, v18, v19
  v_mfma_f32_16x16x32_bf16 v[124:127], v[68:71], v[252:255], v[124:127]
  ds_read_b128 v[236:239], v14 offset:3072
  v_cvt_pk_bf16_f32 v26, v20, v21
  v_cvt_pk_bf16_f32 v27, v22, v23
  v_mfma_f32_16x16x32_bf16 v[140:143], v[72:75], v[252:255], v[140:143]
  buffer_store_dwordx4 v[24:27], v2, s[40:43], s64 offen offset:2048 sc1
  v_add_u32 v9, 192, v1
  v_mul_u32_u24 v10, 6554, v9
  v_lshrrev_b32 v10, 16, v10
  v_mfma_f32_16x16x32_bf16 v[156:159], v[76:79], v[252:255], v[156:159]
  v_mul_u32_u24 v10, 1120, v10
  v_lshl_add_u32 v10, v9, 4, v10
  v_accvgpr_write_b32 a251, v10
  v_mfma_f32_16x16x32_bf16 v[172:175], v[80:83], v[252:255], v[172:175]
  v_add_u32 v9, 256, v1
  v_mul_u32_u24 v10, 6554, v9
  v_lshrrev_b32 v10, 16, v10
  v_mfma_f32_16x16x32_bf16 v[188:191], v[84:87], v[252:255], v[188:191]
  v_mul_u32_u24 v10, 1120, v10
  v_lshl_add_u32 v10, v9, 4, v10
  v_accvgpr_write_b32 a252, v10
  v_mfma_f32_16x16x32_bf16 v[204:207], v[88:91], v[252:255], v[204:207]
  v_mfma_f32_16x16x32_bf16 v[220:223], v[92:95], v[252:255], v[220:223]
  s_waitcnt vmcnt(14) lgkmcnt(0)
  v_mfma_f32_16x16x32_bf16 v[96:99], v[32:35], v[224:227], v[96:99]
  v_accvgpr_read_b32 v16, a120
  v_accvgpr_read_b32 v17, a121
  v_accvgpr_read_b32 v18, a122
  v_mfma_f32_16x16x32_bf16 v[112:115], v[36:39], v[224:227], v[112:115]
  s_mul_i32 s34, s20, 5120
  ds_read_b64_tr_b16 v[64:65], v12 offset:8192
  v_accvgpr_read_b32 v19, a123
  v_accvgpr_read_b32 v20, a124
  v_mfma_f32_16x16x32_bf16 v[128:131], v[40:43], v[224:227], v[128:131]
  s_add_u32 s34, s34, 131072
  ds_read_b64_tr_b16 v[66:67], v12 offset:9216
  v_accvgpr_read_b32 v21, a125
  v_accvgpr_read_b32 v22, a126
  v_mfma_f32_16x16x32_bf16 v[144:147], v[44:47], v[224:227], v[144:147]
  s_and_b32 s32, s21, 3
  buffer_load_dword v15, v8, s[40:43], 0 offen sc1
  v_accvgpr_read_b32 v23, a127
  v_mul_f32 v16, s76, v16
  v_mfma_f32_16x16x32_bf16 v[160:163], v[48:51], v[224:227], v[160:163]
  s_min_u32 s32, s32, 2
  ds_read_b64_tr_b16 v[68:69], v13 offset:8192
  v_mul_f32 v17, s76, v17
  v_mul_f32 v18, s76, v18
  v_mfma_f32_16x16x32_bf16 v[176:179], v[52:55], v[224:227], v[176:179]
  s_add_u32 s32, s32, 5
  ds_read_b64_tr_b16 v[70:71], v13 offset:9216
  v_mul_f32 v19, s76, v19
  v_mul_f32 v20, s76, v20
  v_mfma_f32_16x16x32_bf16 v[192:195], v[56:59], v[224:227], v[192:195]
  s_lshl_b32 s32, s32, 14
  ds_read_b64_tr_b16 v[72:73], v12 offset:8448
  v_mul_f32 v21, s76, v21
  v_mul_f32 v22, s76, v22
  v_mfma_f32_16x16x32_bf16 v[208:211], v[60:63], v[224:227], v[208:211]
  s_mov_b32 s9, -1
  ds_read_b64_tr_b16 v[74:75], v12 offset:9472
  v_mul_f32 v23, s76, v23
  v_mfma_f32_16x16x32_bf16 v[100:103], v[32:35], v[228:231], v[100:103]
  s_sub_u32 s23, s2, 64
  v_cvt_pk_bf16_f32 v28, v16, v17
  v_cvt_pk_bf16_f32 v29, v18, v19
  v_cvt_pk_bf16_f32 v30, v20, v21
  v_mfma_f32_16x16x32_bf16 v[116:119], v[36:39], v[228:231], v[116:119]
  s_cmp_lt_u32 s23, 96
  s_cselect_b32 s9, 0, s9
  ds_read_b64_tr_b16 v[76:77], v13 offset:8448
  v_cvt_pk_bf16_f32 v31, v22, v23
  v_mfma_f32_16x16x32_bf16 v[132:135], v[40:43], v[228:231], v[132:135]
  s_cmp_ge_u32 s2, 224
  s_cselect_b32 s9, 0, s9
  ds_read_b64_tr_b16 v[78:79], v13 offset:9472
  buffer_store_dwordx4 v[28:31], v2, s[40:43], s64 offen offset:3072 sc1
  v_accvgpr_read_b32 v16, a128
  v_mfma_f32_16x16x32_bf16 v[148:151], v[44:47], v[228:231], v[148:151]
  s_and_b32 s32, s32, s9
  ds_read_b128 v[240:243], v14 offset:32768
  v_accvgpr_read_b32 v17, a129
  v_accvgpr_read_b32 v18, a130
  v_mfma_f32_16x16x32_bf16 v[164:167], v[48:51], v[228:231], v[164:167]
  s_sub_u32 s23, s2, 170
  ds_read_b128 v[244:247], v14 offset:33792
  v_accvgpr_read_b32 v19, a131
  v_accvgpr_read_b32 v20, a132
  v_mfma_f32_16x16x32_bf16 v[180:183], v[52:55], v[228:231], v[180:183]
  s_cmp_lt_u32 s23, 54
  s_cselect_b32 s32, 98304, s32
  v_accvgpr_read_b32 v21, a133
  v_accvgpr_read_b32 v22, a134
  v_accvgpr_read_b32 v23, a135
  v_mfma_f32_16x16x32_bf16 v[196:199], v[56:59], v[228:231], v[196:199]
  s_mov_b32 s67, s2
  s_add_u32 s64, s64, 126976
  ds_read_b64_tr_b16 v[80:81], v12 offset:8704
  v_mul_f32 v16, s76, v16
  v_mfma_f32_16x16x32_bf16 v[212:215], v[60:63], v[228:231], v[212:215]
  s_mov_b32 s8, 0
  ds_read_b64_tr_b16 v[82:83], v12 offset:9728
  v_mul_f32 v17, s76, v17
  v_mul_f32 v18, s76, v18
  v_mfma_f32_16x16x32_bf16 v[104:107], v[32:35], v[232:235], v[104:107]
  s_mov_b32 s66, 0
  ds_read_b64_tr_b16 v[84:85], v13 offset:8704
  v_mul_f32 v19, s76, v19
  v_mul_f32 v20, s76, v20
  v_mfma_f32_16x16x32_bf16 v[120:123], v[36:39], v[232:235], v[120:123]
  s_mov_b32 s11, 0
  ds_read_b64_tr_b16 v[86:87], v13 offset:9728
  v_mul_f32 v21, s76, v21
  v_mul_f32 v22, s76, v22
  v_mfma_f32_16x16x32_bf16 v[136:139], v[40:43], v[232:235], v[136:139]
  s_mov_b32 s12, 0
  v_mul_f32 v23, s76, v23
  v_cvt_pk_bf16_f32 v24, v16, v17
  v_cvt_pk_bf16_f32 v25, v18, v19
  v_mfma_f32_16x16x32_bf16 v[152:155], v[44:47], v[232:235], v[152:155]
  s_lshl_b32 s15, s22, 1
  ds_read_b64_tr_b16 v[88:89], v12 offset:8960
  v_cvt_pk_bf16_f32 v26, v20, v21
  v_cvt_pk_bf16_f32 v27, v22, v23
  v_mfma_f32_16x16x32_bf16 v[168:171], v[48:51], v[232:235], v[168:171]
  s_add_u32 s23, s15, 6
  ds_read_b64_tr_b16 v[90:91], v12 offset:9984
  buffer_store_dwordx4 v[24:27], v2, s[40:43], s64 offen offset:0 sc1
  v_accvgpr_read_b32 v16, a136
  v_mfma_f32_16x16x32_bf16 v[184:187], v[52:55], v[232:235], v[184:187]
  s_sub_u32 s15, 24, s15
  ds_read_b64_tr_b16 v[92:93], v13 offset:8960
  v_accvgpr_read_b32 v17, a137
  v_accvgpr_read_b32 v18, a138
  v_mfma_f32_16x16x32_bf16 v[200:203], v[56:59], v[232:235], v[200:203]
  s_max_u32 s15, s15, s23
  ds_read_b64_tr_b16 v[94:95], v13 offset:9984
  v_accvgpr_read_b32 v19, a139
  v_mfma_f32_16x16x32_bf16 v[216:219], v[60:63], v[232:235], v[216:219]
  s_lshl_b32 s15, s15, 14
  v_accvgpr_read_b32 v20, a140
  v_accvgpr_read_b32 v21, a141
  v_accvgpr_read_b32 v22, a142
  v_mfma_f32_16x16x32_bf16 v[108:111], v[32:35], v[236:239], v[108:111]
  ds_read_b128 v[248:251], v14 offset:34816
  v_accvgpr_read_b32 v23, a143
  v_mul_f32 v16, s76, v16
  v_mfma_f32_16x16x32_bf16 v[124:127], v[36:39], v[236:239], v[124:127]
  ds_read_b128 v[252:255], v14 offset:35840
  v_mul_f32 v17, s76, v17
  v_mul_f32 v18, s76, v18
  v_mfma_f32_16x16x32_bf16 v[140:143], v[40:43], v[236:239], v[140:143]
  v_mul_f32 v19, s76, v19
  v_mul_f32 v20, s76, v20
  v_mul_f32 v21, s76, v21
  v_mfma_f32_16x16x32_bf16 v[156:159], v[44:47], v[236:239], v[156:159]
  v_xor_b32 v14, 0x10000, v14
  v_mul_f32 v22, s76, v22
  v_mul_f32 v23, s76, v23
  v_mfma_f32_16x16x32_bf16 v[172:175], v[48:51], v[236:239], v[172:175]
  v_cvt_pk_bf16_f32 v28, v16, v17
  v_cvt_pk_bf16_f32 v29, v18, v19
  v_cvt_pk_bf16_f32 v30, v20, v21
  v_mfma_f32_16x16x32_bf16 v[188:191], v[52:55], v[236:239], v[188:191]
  v_cvt_pk_bf16_f32 v31, v22, v23
  v_mfma_f32_16x16x32_bf16 v[204:207], v[56:59], v[236:239], v[204:207]
  buffer_store_dwordx4 v[28:31], v2, s[40:43], s64 offen offset:1024 sc1
  v_mfma_f32_16x16x32_bf16 v[220:223], v[60:63], v[236:239], v[220:223]
  s_waitcnt vmcnt(12) lgkmcnt(0)
  v_mfma_f32_16x16x32_bf16 v[96:99], v[64:67], v[240:243], v[96:99]
  s_barrier
  v_accvgpr_read_b32 v16, a144
  v_accvgpr_read_b32 v17, a145
  v_accvgpr_read_b32 v18, a146
  v_accvgpr_read_b32 v19, a147
  v_mfma_f32_16x16x32_bf16 v[112:115], v[68:71], v[240:243], v[112:115]
  s_and_b32 s23, s20, 1
  ds_read_b64_tr_b16 v[32:33], v12 offset:32768
  v_accvgpr_read_b32 v20, a148
  v_accvgpr_read_b32 v21, a149
  v_mfma_f32_16x16x32_bf16 v[128:131], v[72:75], v[240:243], v[128:131]
  s_lshl_b32 s23, s23, 12
  ds_read_b64_tr_b16 v[34:35], v12 offset:33792
  v_accvgpr_read_b32 v22, a150
  v_accvgpr_read_b32 v23, a151
  v_mfma_f32_16x16x32_bf16 v[144:147], v[76:79], v[240:243], v[144:147]
  s_cmp_lt_u32 s20, 2
  s_cselect_b32 s24, 106496, 0
  v_mul_f32 v16, s76, v16
  v_mul_f32 v17, s76, v17
  v_mul_f32 v18, s76, v18
  v_mfma_f32_16x16x32_bf16 v[160:163], v[80:83], v[240:243], v[160:163]
  s_add_u32 s24, s24, s23
  ds_read_b64_tr_b16 v[36:37], v13 offset:32768
  v_mul_f32 v19, s76, v19
  v_mul_f32 v20, s76, v20
  v_mfma_f32_16x16x32_bf16 v[176:179], v[84:87], v[240:243], v[176:179]
  s_lshl_b32 s26, s20, 12
  ds_read_b64_tr_b16 v[38:39], v13 offset:33792
  v_mul_f32 v21, s76, v21
  v_mul_f32 v22, s76, v22
  v_mfma_f32_16x16x32_bf16 v[192:195], v[88:91], v[240:243], v[192:195]
  s_mov_b32 s27, s26
  ds_read_b64_tr_b16 v[40:41], v12 offset:33024
  v_mul_f32 v23, s76, v23
  v_cvt_pk_bf16_f32 v24, v16, v17
  v_mfma_f32_16x16x32_bf16 v[208:211], v[92:95], v[240:243], v[208:211]
  s_add_u32 s25, s27, 49152
  ds_read_b64_tr_b16 v[42:43], v12 offset:34048
  v_cvt_pk_bf16_f32 v25, v18, v19
  v_cvt_pk_bf16_f32 v26, v20, v21
  v_cvt_pk_bf16_f32 v27, v22, v23
  v_mfma_f32_16x16x32_bf16 v[100:103], v[64:67], v[244:247], v[100:103]
  s_load_dwordx4 s[4:7], s[0:1], 64
  buffer_store_dwordx4 v[24:27], v2, s[40:43], s64 offen offset:2048 sc1
  v_accvgpr_read_b32 v16, a152
  v_accvgpr_read_b32 v17, a153
  v_mfma_f32_16x16x32_bf16 v[116:119], v[68:71], v[244:247], v[116:119]
  s_load_dwordx2 s[60:61], s[0:1], 80
  ds_read_b64_tr_b16 v[44:45], v13 offset:33024
  v_accvgpr_read_b32 v18, a154
  v_accvgpr_read_b32 v19, a155
  v_mfma_f32_16x16x32_bf16 v[132:135], v[72:75], v[244:247], v[132:135]
  s_add_u32 s23, s20, 1
  ds_read_b64_tr_b16 v[46:47], v13 offset:34048
  v_accvgpr_read_b32 v20, a156
  v_accvgpr_read_b32 v21, a157
  v_mfma_f32_16x16x32_bf16 v[148:151], v[76:79], v[244:247], v[148:151]
  s_lshr_b32 s23, s23, 1
  ds_read_b128 v[224:227], v14 offset:0
  v_accvgpr_read_b32 v22, a158
  v_accvgpr_read_b32 v23, a159
  v_mfma_f32_16x16x32_bf16 v[164:167], v[80:83], v[244:247], v[164:167]
  s_lshl_b32 s28, s22, 1
  ds_read_b128 v[228:231], v14 offset:1024
  v_mul_f32 v16, s76, v16
  v_mul_f32 v17, s76, v17
  v_mfma_f32_16x16x32_bf16 v[180:183], v[84:87], v[244:247], v[180:183]
  s_add_u32 s28, s28, s23
  v_mul_f32 v18, s76, v18
  v_mul_f32 v19, s76, v19
  v_mul_f32 v20, s76, v20
  v_mfma_f32_16x16x32_bf16 v[196:199], v[88:91], v[244:247], v[196:199]
  s_lshl_b32 s23, s22, 2
  ds_read_b64_tr_b16 v[48:49], v12 offset:33280
  v_mul_f32 v21, s76, v21
  v_mul_f32 v22, s76, v22
  v_mfma_f32_16x16x32_bf16 v[212:215], v[92:95], v[244:247], v[212:215]
  s_sub_u32 s29, 28, s23
  ds_read_b64_tr_b16 v[50:51], v12 offset:34304
  v_mul_f32 v23, s76, v23
  v_cvt_pk_bf16_f32 v28, v16, v17
  v_cvt_pk_bf16_f32 v29, v18, v19
  v_mfma_f32_16x16x32_bf16 v[104:107], v[64:67], v[248:251], v[104:107]
  s_and_b32 s23, s20, 1
  ds_read_b64_tr_b16 v[52:53], v13 offset:33280
  v_cvt_pk_bf16_f32 v30, v20, v21
  v_cvt_pk_bf16_f32 v31, v22, v23
  v_mfma_f32_16x16x32_bf16 v[120:123], v[68:71], v[248:251], v[120:123]
  s_add_u32 s29, s29, s23
  ds_read_b64_tr_b16 v[54:55], v13 offset:34304
  buffer_store_dwordx4 v[28:31], v2, s[40:43], s64 offen offset:3072 sc1
  v_accvgpr_read_b32 v16, a160
  v_mfma_f32_16x16x32_bf16 v[136:139], v[72:75], v[248:251], v[136:139]
  s_add_u32 s64, s64, 4096
  v_accvgpr_read_b32 v17, a161
  v_accvgpr_read_b32 v18, a162
  v_accvgpr_read_b32 v19, a163
  v_mfma_f32_16x16x32_bf16 v[152:155], v[76:79], v[248:251], v[152:155]
  ds_read_b64_tr_b16 v[56:57], v12 offset:33536
  v_accvgpr_read_b32 v20, a164
  v_accvgpr_read_b32 v21, a165
  v_mfma_f32_16x16x32_bf16 v[168:171], v[80:83], v[248:251], v[168:171]
  ds_read_b64_tr_b16 v[58:59], v12 offset:34560
  v_accvgpr_read_b32 v22, a166
  v_accvgpr_read_b32 v23, a167
  v_mfma_f32_16x16x32_bf16 v[184:187], v[84:87], v[248:251], v[184:187]
  ds_read_b64_tr_b16 v[60:61], v13 offset:33536
  v_mul_f32 v16, s76, v16
  v_mul_f32 v17, s76, v17
  v_mfma_f32_16x16x32_bf16 v[200:203], v[88:91], v[248:251], v[200:203]
  ds_read_b64_tr_b16 v[62:63], v13 offset:34560
  v_mul_f32 v18, s76, v18
  v_mul_f32 v19, s76, v19
  v_mul_f32 v20, s76, v20
  v_mfma_f32_16x16x32_bf16 v[216:219], v[92:95], v[248:251], v[216:219]
  v_mul_f32 v21, s76, v21
  v_mul_f32 v22, s76, v22
  v_mul_f32 v23, s76, v23
  v_mfma_f32_16x16x32_bf16 v[108:111], v[64:67], v[252:255], v[108:111]
  ds_read_b128 v[232:235], v14 offset:2048
  v_cvt_pk_bf16_f32 v24, v16, v17
  v_cvt_pk_bf16_f32 v25, v18, v19
  v_mfma_f32_16x16x32_bf16 v[124:127], v[68:71], v[252:255], v[124:127]
  ds_read_b128 v[236:239], v14 offset:3072
  v_cvt_pk_bf16_f32 v26, v20, v21
  v_cvt_pk_bf16_f32 v27, v22, v23
  v_mfma_f32_16x16x32_bf16 v[140:143], v[72:75], v[252:255], v[140:143]
  buffer_store_dwordx4 v[24:27], v2, s[40:43], s64 offen offset:0 sc1
  v_lshrrev_b32 v6, 2, v1
  v_mul_u32_u24 v6, 160, v6
  v_mfma_f32_16x16x32_bf16 v[156:159], v[76:79], v[252:255], v[156:159]
  v_and_b32 v9, 3, v1
  v_lshl_add_u32 v6, v9, 3, v6
  v_add_u32 v6, s34, v6
  v_mfma_f32_16x16x32_bf16 v[172:175], v[80:83], v[252:255], v[172:175]
  v_mov_b32 v3, v2
  v_mov_b32 v4, 0xff800000
  v_add_u32 v9, 106496, v2
  v_mfma_f32_16x16x32_bf16 v[188:191], v[84:87], v[252:255], v[188:191]
  v_mfma_f32_16x16x32_bf16 v[204:207], v[88:91], v[252:255], v[204:207]
  v_mfma_f32_16x16x32_bf16 v[220:223], v[92:95], v[252:255], v[220:223]
  s_waitcnt vmcnt(8) lgkmcnt(0)
  v_mfma_f32_16x16x32_bf16 v[96:99], v[32:35], v[224:227], v[96:99]
  v_accvgpr_read_b32 v16, a168
  v_accvgpr_read_b32 v17, a169
  v_accvgpr_read_b32 v18, a170
  v_mfma_f32_16x16x32_bf16 v[112:115], v[36:39], v[224:227], v[112:115]
  s_cmp_ge_u32 s20, 2
  s_cselect_b32 s4, s6, s4
  s_cselect_b32 s5, s7, s5
  ds_read_b64_tr_b16 v[64:65], v12 offset:40960
  v_accvgpr_read_b32 v19, a171
  v_accvgpr_read_b32 v20, a172
  v_mfma_f32_16x16x32_bf16 v[128:131], v[40:43], v[224:227], v[128:131]
  s_mov_b32 s62, 2211840
  ds_read_b64_tr_b16 v[66:67], v12 offset:41984
  v_accvgpr_read_b32 v21, a173
  v_accvgpr_read_b32 v22, a174
  v_mfma_f32_16x16x32_bf16 v[144:147], v[44:47], v[224:227], v[144:147]
  s_mov_b32 s63, 0x20000
  v_accvgpr_read_b32 v23, a175
  v_mul_f32 v16, s76, v16
  v_mul_f32 v17, s76, v17
  v_mfma_f32_16x16x32_bf16 v[160:163], v[48:51], v[224:227], v[160:163]
  s_mov_b64 s[56:57], s[52:53]
  ds_read_b64_tr_b16 v[68:69], v13 offset:40960
  v_mul_f32 v18, s76, v18
  v_mfma_f32_16x16x32_bf16 v[176:179], v[52:55], v[224:227], v[176:179]
  s_mov_b32 s58, s54
  ds_read_b64_tr_b16 v[70:71], v13 offset:41984
  v_mul_f32 v19, s76, v19
  v_mul_f32 v20, s76, v20
  v_mfma_f32_16x16x32_bf16 v[192:195], v[56:59], v[224:227], v[192:195]
  s_mov_b64 s[52:53], s[4:5]
  ds_read_b64_tr_b16 v[72:73], v12 offset:41216
  v_mul_f32 v21, s76, v21
  v_mul_f32 v22, s76, v22
  v_mfma_f32_16x16x32_bf16 v[208:211], v[60:63], v[224:227], v[208:211]
  s_mov_b32 s54, 2211840
  ds_read_b64_tr_b16 v[74:75], v12 offset:42240
  v_mul_f32 v23, s76, v23
  v_cvt_pk_bf16_f32 v28, v16, v17
  v_mfma_f32_16x16x32_bf16 v[100:103], v[32:35], v[228:231], v[100:103]
  s_getpc_b64 s[36:37]
fa_copc:
  v_cvt_pk_bf16_f32 v29, v18, v19
  v_cvt_pk_bf16_f32 v30, v20, v21
  v_cvt_pk_bf16_f32 v31, v22, v23
  v_mfma_f32_16x16x32_bf16 v[116:119], v[36:39], v[228:231], v[116:119]
  s_add_u32 s36, s36, fa_co-fa_copc-4
  s_addc_u32 s37, s37, 0
  ds_read_b64_tr_b16 v[76:77], v13 offset:41216
  buffer_store_dwordx4 v[28:31], v2, s[40:43], s64 offen offset:1024 sc1
  v_mfma_f32_16x16x32_bf16 v[132:135], v[40:43], v[228:231], v[132:135]
  ds_read_b64_tr_b16 v[78:79], v13 offset:42240
  v_accvgpr_read_b32 v16, a176
  v_accvgpr_read_b32 v17, a177
  v_mfma_f32_16x16x32_bf16 v[148:151], v[44:47], v[228:231], v[148:151]
  ds_read_b128 v[240:243], v14 offset:32768
  v_accvgpr_read_b32 v18, a178
  v_accvgpr_read_b32 v19, a179
  v_mfma_f32_16x16x32_bf16 v[164:167], v[48:51], v[228:231], v[164:167]
  ds_read_b128 v[244:247], v14 offset:33792
  v_accvgpr_read_b32 v20, a180
  v_accvgpr_read_b32 v21, a181
  v_mfma_f32_16x16x32_bf16 v[180:183], v[52:55], v[228:231], v[180:183]
  v_accvgpr_read_b32 v22, a182
  v_accvgpr_read_b32 v23, a183
  v_mul_f32 v16, s76, v16
  v_mfma_f32_16x16x32_bf16 v[196:199], v[56:59], v[228:231], v[196:199]
  ds_read_b64_tr_b16 v[80:81], v12 offset:41472
  v_mul_f32 v17, s76, v17
  v_mfma_f32_16x16x32_bf16 v[212:215], v[60:63], v[228:231], v[212:215]
  ds_read_b64_tr_b16 v[82:83], v12 offset:42496
  v_mul_f32 v18, s76, v18
  v_mul_f32 v19, s76, v19
  v_mfma_f32_16x16x32_bf16 v[104:107], v[32:35], v[232:235], v[104:107]
  ds_read_b64_tr_b16 v[84:85], v13 offset:41472
  v_mul_f32 v20, s76, v20
  v_mul_f32 v21, s76, v21
  v_mfma_f32_16x16x32_bf16 v[120:123], v[36:39], v[232:235], v[120:123]
  ds_read_b64_tr_b16 v[86:87], v13 offset:42496
  v_mul_f32 v22, s76, v22
  v_mul_f32 v23, s76, v23
  v_mfma_f32_16x16x32_bf16 v[136:139], v[40:43], v[232:235], v[136:139]
  v_cvt_pk_bf16_f32 v24, v16, v17
  v_cvt_pk_bf16_f32 v25, v18, v19
  v_cvt_pk_bf16_f32 v26, v20, v21
  v_mfma_f32_16x16x32_bf16 v[152:155], v[44:47], v[232:235], v[152:155]
  ds_read_b64_tr_b16 v[88:89], v12 offset:41728
  v_cvt_pk_bf16_f32 v27, v22, v23
  v_mfma_f32_16x16x32_bf16 v[168:171], v[48:51], v[232:235], v[168:171]
  ds_read_b64_tr_b16 v[90:91], v12 offset:42752
  buffer_store_dwordx4 v[24:27], v2, s[40:43], s64 offen offset:2048 sc1
  v_accvgpr_read_b32 v16, a184
  v_mfma_f32_16x16x32_bf16 v[184:187], v[52:55], v[232:235], v[184:187]
  ds_read_b64_tr_b16 v[92:93], v13 offset:41728
  v_accvgpr_read_b32 v17, a185
  v_accvgpr_read_b32 v18, a186
  v_mfma_f32_16x16x32_bf16 v[200:203], v[56:59], v[232:235], v[200:203]
  ds_read_b64_tr_b16 v[94:95], v13 offset:42752
  v_accvgpr_read_b32 v19, a187
  v_accvgpr_read_b32 v20, a188
  v_mfma_f32_16x16x32_bf16 v[216:219], v[60:63], v[232:235], v[216:219]
  v_accvgpr_read_b32 v21, a189
  v_accvgpr_read_b32 v22, a190
  v_accvgpr_read_b32 v23, a191
  v_mfma_f32_16x16x32_bf16 v[108:111], v[32:35], v[236:239], v[108:111]
  ds_read_b128 v[248:251], v14 offset:34816
  v_mul_f32 v16, s76, v16
  v_mfma_f32_16x16x32_bf16 v[124:127], v[36:39], v[236:239], v[124:127]
  ds_read_b128 v[252:255], v14 offset:35840
  v_mul_f32 v17, s76, v17
  v_mul_f32 v18, s76, v18
  v_mfma_f32_16x16x32_bf16 v[140:143], v[40:43], v[236:239], v[140:143]
  v_mul_f32 v19, s76, v19
  v_mul_f32 v20, s76, v20
  v_mul_f32 v21, s76, v21
  v_mfma_f32_16x16x32_bf16 v[156:159], v[44:47], v[236:239], v[156:159]
  v_xor_b32 v14, 0x10000, v14
  v_mul_f32 v22, s76, v22
  v_mul_f32 v23, s76, v23
  v_mfma_f32_16x16x32_bf16 v[172:175], v[48:51], v[236:239], v[172:175]
  v_cvt_pk_bf16_f32 v28, v16, v17
  v_cvt_pk_bf16_f32 v29, v18, v19
  v_cvt_pk_bf16_f32 v30, v20, v21
  v_mfma_f32_16x16x32_bf16 v[188:191], v[52:55], v[236:239], v[188:191]
  v_xor_b32 v12, 0x10000, v12
  v_cvt_pk_bf16_f32 v31, v22, v23
  v_mfma_f32_16x16x32_bf16 v[204:207], v[56:59], v[236:239], v[204:207]
  buffer_store_dwordx4 v[28:31], v2, s[40:43], s64 offen offset:3072 sc1
  v_xor_b32 v13, 0x10000, v13
  v_mfma_f32_16x16x32_bf16 v[220:223], v[60:63], v[236:239], v[220:223]
  s_waitcnt vmcnt(9) lgkmcnt(0)
  v_mfma_f32_16x16x32_bf16 v[96:99], v[64:67], v[240:243], v[96:99]
  s_barrier
  v_cmp_eq_u32 vcc, 0, v15
  v_mfma_f32_16x16x32_bf16 v[112:115], v[68:71], v[240:243], v[112:115]
  s_cbranch_vccnz fa_kv_spin
fa_kv_ok:
  v_mfma_f32_16x16x32_bf16 v[128:131], v[72:75], v[240:243], v[128:131]
  s_mov_b32 m0, s24
  v_mov_b32 v228, 0
  v_mfma_f32_16x16x32_bf16 v[144:147], v[76:79], v[240:243], v[144:147]
  buffer_load_dwordx4 v2, s[44:47], s26 offen offset:0 sc1 lds
  v_mfma_f32_16x16x32_bf16 v[160:163], v[80:83], v[240:243], v[160:163]
  s_add_u32 s24, s24, 32768
  v_mov_b32 v229, 0
  v_mfma_f32_16x16x32_bf16 v[176:179], v[84:87], v[240:243], v[176:179]
  s_and_b32 s24, s24, 0x1ffff
  buffer_load_dwordx4 v2, s[44:47], s26 offen offset:1024 sc1 lds
  v_mfma_f32_16x16x32_bf16 v[192:195], v[88:91], v[240:243], v[192:195]
  v_mov_b32 v230, 0
  v_mfma_f32_16x16x32_bf16 v[208:211], v[92:95], v[240:243], v[208:211]
  buffer_load_dwordx4 v2, s[44:47], s26 offen offset:2048 sc1 lds
  v_mfma_f32_16x16x32_bf16 v[100:103], v[64:67], v[244:247], v[100:103]
  v_mov_b32 v231, 0
  v_mfma_f32_16x16x32_bf16 v[116:119], v[68:71], v[244:247], v[116:119]
  buffer_load_dwordx4 v2, s[44:47], s26 offen offset:3072 sc1 lds
  v_mfma_f32_16x16x32_bf16 v[132:135], v[72:75], v[244:247], v[132:135]
  s_add_u32 s26, s26, 16384
  v_cvt_pk_bf16_f32 v32, v96, v97
  v_cvt_pk_bf16_f32 v33, v98, v99
  v_mfma_f32_16x16x32_bf16 v[148:151], v[76:79], v[244:247], v[148:151]
  v_cvt_pk_bf16_f32 v34, v112, v113
  v_cvt_pk_bf16_f32 v35, v114, v115
  v_mfma_f32_16x16x32_bf16 v[164:167], v[80:83], v[244:247], v[164:167]
  s_mov_b32 m0, s24
  v_cvt_pk_bf16_f32 v40, v128, v129
  v_mfma_f32_16x16x32_bf16 v[180:183], v[84:87], v[244:247], v[180:183]
  buffer_load_dwordx4 v2, s[44:47], s26 offen offset:0 sc1 lds
  v_cvt_pk_bf16_f32 v41, v130, v131
  v_cvt_pk_bf16_f32 v42, v144, v145
  v_mfma_f32_16x16x32_bf16 v[196:199], v[88:91], v[244:247], v[196:199]
  s_add_u32 s24, s24, 32768
  v_cvt_pk_bf16_f32 v43, v146, v147
  v_mfma_f32_16x16x32_bf16 v[212:215], v[92:95], v[244:247], v[212:215]
  s_and_b32 s24, s24, 0x1ffff
  buffer_load_dwordx4 v2, s[44:47], s26 offen offset:1024 sc1 lds
  v_cvt_pk_bf16_f32 v48, v160, v161
  v_cvt_pk_bf16_f32 v49, v162, v163
  v_mfma_f32_16x16x32_bf16 v[104:107], v[64:67], v[248:251], v[104:107]
  v_cvt_pk_bf16_f32 v50, v176, v177
  v_cvt_pk_bf16_f32 v51, v178, v179
  v_mfma_f32_16x16x32_bf16 v[120:123], v[68:71], v[248:251], v[120:123]
  buffer_load_dwordx4 v2, s[44:47], s26 offen offset:2048 sc1 lds
  v_cvt_pk_bf16_f32 v56, v192, v193
  v_mfma_f32_16x16x32_bf16 v[136:139], v[72:75], v[248:251], v[136:139]
  v_cvt_pk_bf16_f32 v57, v194, v195
  v_cvt_pk_bf16_f32 v58, v208, v209
  v_mfma_f32_16x16x32_bf16 v[152:155], v[76:79], v[248:251], v[152:155]
  buffer_load_dwordx4 v2, s[44:47], s26 offen offset:3072 sc1 lds
  v_cvt_pk_bf16_f32 v59, v210, v211
  v_mfma_f32_16x16x32_bf16 v[168:171], v[80:83], v[248:251], v[168:171]
  s_add_u32 s26, s26, 16384
  v_cvt_pk_bf16_f32 v36, v100, v101
  v_cvt_pk_bf16_f32 v37, v102, v103
  v_mfma_f32_16x16x32_bf16 v[184:187], v[84:87], v[248:251], v[184:187]
  v_cvt_pk_bf16_f32 v38, v116, v117
  v_mfma_f32_16x16x32_bf16 v[200:203], v[88:91], v[248:251], v[200:203]
  s_mov_b32 m0, s24
  v_cvt_pk_bf16_f32 v39, v118, v119
  v_cvt_pk_bf16_f32 v44, v132, v133
  v_mfma_f32_16x16x32_bf16 v[216:219], v[92:95], v[248:251], v[216:219]
  buffer_load_dwordx4 v2, s[44:47], s26 offen offset:0 sc1 lds
  v_cvt_pk_bf16_f32 v45, v134, v135
  v_mfma_f32_16x16x32_bf16 v[108:111], v[64:67], v[252:255], v[108:111]
  s_add_u32 s24, s24, 32768
  v_cvt_pk_bf16_f32 v46, v148, v149
  v_cvt_pk_bf16_f32 v47, v150, v151
  v_mfma_f32_16x16x32_bf16 v[124:127], v[68:71], v[252:255], v[124:127]
  s_and_b32 s24, s24, 0x1ffff
  buffer_load_dwordx4 v2, s[44:47], s26 offen offset:1024 sc1 lds
  v_cvt_pk_bf16_f32 v52, v164, v165
  v_mfma_f32_16x16x32_bf16 v[140:143], v[72:75], v[252:255], v[140:143]
  v_cvt_pk_bf16_f32 v53, v166, v167
  v_cvt_pk_bf16_f32 v54, v180, v181
  v_mfma_f32_16x16x32_bf16 v[156:159], v[76:79], v[252:255], v[156:159]
  buffer_load_dwordx4 v2, s[44:47], s26 offen offset:2048 sc1 lds
  v_cvt_pk_bf16_f32 v55, v182, v183
  v_mfma_f32_16x16x32_bf16 v[172:175], v[80:83], v[252:255], v[172:175]
  v_cvt_pk_bf16_f32 v60, v196, v197
  v_cvt_pk_bf16_f32 v61, v198, v199
  v_mfma_f32_16x16x32_bf16 v[188:191], v[84:87], v[252:255], v[188:191]
  buffer_load_dwordx4 v2, s[44:47], s26 offen offset:3072 sc1 lds
  v_cvt_pk_bf16_f32 v62, v212, v213
  v_mfma_f32_16x16x32_bf16 v[204:207], v[88:91], v[252:255], v[204:207]
  s_add_u32 s26, s26, 16384
  v_cvt_pk_bf16_f32 v63, v214, v215
  v_mfma_f32_16x16x32_bf16 v[220:223], v[92:95], v[252:255], v[220:223]
  s_mov_b32 m0, s25
  s_nop 0
  v_mfma_f32_32x32x16_bf16 a[0:15], v[228:231], v[228:231], 0
  buffer_load_dwordx4 v2, s[48:51], s27 offen offset:0 sc1 lds
  v_cvt_pk_bf16_f32 v64, v104, v105
  v_cvt_pk_bf16_f32 v65, v106, v107
  v_cvt_pk_bf16_f32 v66, v120, v121
  v_cvt_pk_bf16_f32 v67, v122, v123
  v_mfma_f32_32x32x16_bf16 a[16:31], v[228:231], v[228:231], 0
  buffer_load_dwordx4 v2, s[48:51], s27 offen offset:1024 sc1 lds
  v_cvt_pk_bf16_f32 v72, v136, v137
  v_cvt_pk_bf16_f32 v73, v138, v139
  v_cvt_pk_bf16_f32 v74, v152, v153
  v_cvt_pk_bf16_f32 v75, v154, v155
  v_mfma_f32_32x32x16_bf16 a[32:47], v[228:231], v[228:231], 0
  buffer_load_dwordx4 v2, s[48:51], s27 offen offset:2048 sc1 lds
  v_cvt_pk_bf16_f32 v80, v168, v169
  v_cvt_pk_bf16_f32 v81, v170, v171
  v_cvt_pk_bf16_f32 v82, v184, v185
  v_cvt_pk_bf16_f32 v83, v186, v187
  v_mfma_f32_32x32x16_bf16 a[48:63], v[228:231], v[228:231], 0
  buffer_load_dwordx4 v2, s[48:51], s27 offen offset:3072 sc1 lds
  v_cvt_pk_bf16_f32 v88, v200, v201
  v_cvt_pk_bf16_f32 v89, v202, v203
  v_cvt_pk_bf16_f32 v90, v216, v217
  v_cvt_pk_bf16_f32 v91, v218, v219
  s_add_u32 s27, s27, 16384
  s_add_u32 s25, s25, 32768
  s_and_b32 s25, s25, 0x1ffff
  s_mov_b32 m0, s25
  s_nop 0
  v_mfma_f32_32x32x16_bf16 a[64:79], v[228:231], v[228:231], 0
  buffer_load_dwordx4 v2, s[48:51], s27 offen offset:0 sc1 lds
  v_cvt_pk_bf16_f32 v68, v108, v109
  v_cvt_pk_bf16_f32 v69, v110, v111
  v_cvt_pk_bf16_f32 v70, v124, v125
  v_cvt_pk_bf16_f32 v71, v126, v127
  v_mfma_f32_32x32x16_bf16 a[80:95], v[228:231], v[228:231], 0
  buffer_load_dwordx4 v2, s[48:51], s27 offen offset:1024 sc1 lds
  v_cvt_pk_bf16_f32 v76, v140, v141
  v_cvt_pk_bf16_f32 v77, v142, v143
  v_cvt_pk_bf16_f32 v78, v156, v157
  v_cvt_pk_bf16_f32 v79, v158, v159
  v_mfma_f32_32x32x16_bf16 a[96:111], v[228:231], v[228:231], 0
  buffer_load_dwordx4 v2, s[48:51], s27 offen offset:2048 sc1 lds
  v_cvt_pk_bf16_f32 v84, v172, v173
  v_cvt_pk_bf16_f32 v85, v174, v175
  v_cvt_pk_bf16_f32 v86, v188, v189
  v_cvt_pk_bf16_f32 v87, v190, v191
  v_mfma_f32_32x32x16_bf16 a[112:127], v[228:231], v[228:231], 0
  buffer_load_dwordx4 v2, s[48:51], s27 offen offset:3072 sc1 lds
  v_cvt_pk_bf16_f32 v92, v204, v205
  v_cvt_pk_bf16_f32 v93, v206, v207
  v_cvt_pk_bf16_f32 v94, v220, v221
  v_cvt_pk_bf16_f32 v95, v222, v223
  s_add_u32 s27, s27, 16384
  s_add_u32 s25, s25, 32768
  s_and_b32 s25, s25, 0x1ffff
  s_waitcnt vmcnt(12)
  s_barrier
  ds_read_b128 a[128:131], v9 offset:0
  ds_read_b128 a[132:135], v9 offset:1024
  ds_read_b128 a[136:139], v9 offset:2048
  ds_read_b128 a[140:143], v9 offset:3072
  ds_read_b128 a[144:147], v9 offset:4096
  ds_read_b128 a[148:151], v9 offset:5120
  ds_read_b128 a[152:155], v9 offset:6144
  ds_read_b128 a[156:159], v9 offset:7168
  buffer_store_dword v4, off, s[40:43], s65 offset:32 sc1
  v_add_u32 v13, 32, v8
  v_mov_b32 v14, 0
  s_cmp_eq_u32 s2, 255
  s_cbranch_scc1 fa_top8
fa_notop:
  s_waitcnt lgkmcnt(4)
  v_mfma_f32_16x16x32_bf16 v[96:99], a[128:131], v[32:35], 0
  v_mfma_f32_16x16x32_bf16 v[104:107], a[128:131], v[36:39], 0
  v_mfma_f32_16x16x32_bf16 v[128:131], a[128:131], v[64:67], 0
  v_mfma_f32_16x16x32_bf16 v[136:139], a[128:131], v[68:71], 0
  s_mov_b32 m0, s24
  ds_read_b128 a[128:131], v3 offset:0
  v_mfma_f32_16x16x32_bf16 v[100:103], a[132:135], v[32:35], 0
  buffer_load_dwordx4 v2, s[44:47], s26 offen offset:0 sc1 lds
  v_mfma_f32_16x16x32_bf16 v[108:111], a[132:135], v[36:39], 0
  v_mfma_f32_16x16x32_bf16 v[132:135], a[132:135], v[64:67], 0
  v_mfma_f32_16x16x32_bf16 v[140:143], a[132:135], v[68:71], 0
  ds_read_b128 a[132:135], v3 offset:1024
  v_mfma_f32_16x16x32_bf16 v[96:99], a[136:139], v[40:43], v[96:99]
  v_mfma_f32_16x16x32_bf16 v[104:107], a[136:139], v[44:47], v[104:107]
  v_mfma_f32_16x16x32_bf16 v[128:131], a[136:139], v[72:75], v[128:131]
  buffer_load_dwordx4 v2, s[44:47], s26 offen offset:1024 sc1 lds
  v_mfma_f32_16x16x32_bf16 v[136:139], a[136:139], v[76:79], v[136:139]
  ds_read_b128 a[136:139], v3 offset:2048
  v_mfma_f32_16x16x32_bf16 v[100:103], a[140:143], v[40:43], v[100:103]
  v_mfma_f32_16x16x32_bf16 v[108:111], a[140:143], v[44:47], v[108:111]
  v_mfma_f32_16x16x32_bf16 v[132:135], a[140:143], v[72:75], v[132:135]
  v_mfma_f32_16x16x32_bf16 v[140:143], a[140:143], v[76:79], v[140:143]
  s_waitcnt lgkmcnt(3)
  ds_read_b128 a[140:143], v3 offset:3072
  v_mfma_f32_16x16x32_bf16 v[96:99], a[144:147], v[48:51], v[96:99]
  v_mfma_f32_16x16x32_bf16 v[104:107], a[144:147], v[52:55], v[104:107]
  v_mfma_f32_16x16x32_bf16 v[128:131], a[144:147], v[80:83], v[128:131]
  buffer_load_dwordx4 v2, s[44:47], s26 offen offset:2048 sc1 lds
  v_mfma_f32_16x16x32_bf16 v[136:139], a[144:147], v[84:87], v[136:139]
  ds_read_b128 a[144:147], v3 offset:4096
  v_mfma_f32_16x16x32_bf16 v[100:103], a[148:151], v[48:51], v[100:103]
  v_mfma_f32_16x16x32_bf16 v[108:111], a[148:151], v[52:55], v[108:111]
  v_mfma_f32_16x16x32_bf16 v[132:135], a[148:151], v[80:83], v[132:135]
  v_mfma_f32_16x16x32_bf16 v[140:143], a[148:151], v[84:87], v[140:143]
  ds_read_b128 a[148:151], v3 offset:5120
  v_mfma_f32_16x16x32_bf16 v[96:99], a[152:155], v[56:59], v[96:99]
  buffer_load_dwordx4 v2, s[44:47], s26 offen offset:3072 sc1 lds
  v_mfma_f32_16x16x32_bf16 v[104:107], a[152:155], v[60:63], v[104:107]
  s_add_u32 s26, s26, 16384
  v_mfma_f32_16x16x32_bf16 v[128:131], a[152:155], v[88:91], v[128:131]
  s_add_u32 s24, s24, 32768
  v_mfma_f32_16x16x32_bf16 v[136:139], a[152:155], v[92:95], v[136:139]
  s_and_b32 s24, s24, 0x1ffff
  ds_read_b128 a[152:155], v3 offset:6144
  v_mfma_f32_16x16x32_bf16 v[100:103], a[156:159], v[56:59], v[100:103]
  v_mfma_f32_16x16x32_bf16 v[108:111], a[156:159], v[60:63], v[108:111]
  v_mfma_f32_16x16x32_bf16 v[132:135], a[156:159], v[88:91], v[132:135]
  v_mfma_f32_16x16x32_bf16 v[140:143], a[156:159], v[92:95], v[140:143]
  s_waitcnt lgkmcnt(3)
  ds_read_b128 a[156:159], v3 offset:7168
  s_nop 7
  s_cmp_lg_u32 s28, 0
  s_cbranch_scc1 fa_nomask0
  v_cndmask_b32 v96, v4, v96, s[68:69]
  v_cndmask_b32 v97, v4, v97, s[70:71]
  v_cndmask_b32 v98, v4, v98, s[72:73]
  v_cndmask_b32 v99, v4, v99, s[74:75]
  v_mov_b32 v100, v4
  v_mov_b32 v101, v4
  v_mov_b32 v102, v4
  v_mov_b32 v103, v4
  v_cndmask_b32 v108, v4, v108, s[68:69]
  v_cndmask_b32 v109, v4, v109, s[70:71]
  v_cndmask_b32 v110, v4, v110, s[72:73]
  v_cndmask_b32 v111, v4, v111, s[74:75]
fa_nomask0:
  v_max3_f32 v16, v96, v97, v98
  v_max3_f32 v16, v16, v99, v100
  v_max3_f32 v16, v16, v101, v102
  v_max_f32 v16, v16, v103
  v_max3_f32 v17, v104, v105, v106
  v_max3_f32 v17, v17, v107, v108
  v_max3_f32 v17, v17, v109, v110
  v_max_f32 v17, v17, v111
  v_max3_f32 v18, v128, v129, v130
  v_max3_f32 v18, v18, v131, v132
  v_max3_f32 v18, v18, v133, v134
  v_max_f32 v18, v18, v135
  v_max3_f32 v19, v136, v137, v138
  v_max3_f32 v19, v19, v139, v140
  v_max3_f32 v19, v19, v141, v142
  v_max_f32 v19, v19, v143
  v_mov_b32 v20, v16
  v_mov_b32 v21, v17
  v_mov_b32 v22, v18
  v_mov_b32 v23, v19
  s_nop 0
  v_permlane16_swap_b32 v16, v20
  v_permlane16_swap_b32 v17, v21
  v_permlane16_swap_b32 v18, v22
  v_permlane16_swap_b32 v19, v23
  v_max_f32 v16, v16, v20
  v_max_f32 v17, v17, v21
  v_max_f32 v18, v18, v22
  v_max_f32 v19, v19, v23
  v_mov_b32 v20, v16
  v_mov_b32 v21, v17
  v_mov_b32 v22, v18
  v_mov_b32 v23, v19
  s_nop 0
  v_permlane32_swap_b32 v16, v20
  v_permlane32_swap_b32 v17, v21
  v_permlane32_swap_b32 v18, v22
  v_permlane32_swap_b32 v19, v23
  v_max_f32 v16, v16, v20
  v_max_f32 v17, v17, v21
  v_max_f32 v18, v18, v22
  v_max_f32 v19, v19, v23
  v_sub_f32 v192, 0, v16
  v_sub_f32 v193, 0, v16
  v_sub_f32 v194, 0, v16
  v_sub_f32 v195, 0, v16
  v_sub_f32 v196, 0, v17
  v_sub_f32 v197, 0, v17
  v_sub_f32 v198, 0, v17
  v_sub_f32 v199, 0, v17
  v_sub_f32 v200, 0, v18
  v_sub_f32 v201, 0, v18
  v_sub_f32 v202, 0, v18
  v_sub_f32 v203, 0, v18
  v_sub_f32 v204, 0, v19
  v_sub_f32 v205, 0, v19
  v_sub_f32 v206, 0, v19
  v_sub_f32 v207, 0, v19
  v_sub_f32 v96, v96, v16
  v_sub_f32 v97, v97, v16
  v_sub_f32 v98, v98, v16
  v_sub_f32 v99, v99, v16
  v_sub_f32 v100, v100, v16
  v_sub_f32 v101, v101, v16
  v_sub_f32 v102, v102, v16
  v_sub_f32 v103, v103, v16
  v_sub_f32 v104, v104, v17
  v_sub_f32 v105, v105, v17
  v_sub_f32 v106, v106, v17
  v_sub_f32 v107, v107, v17
  v_sub_f32 v108, v108, v17
  v_sub_f32 v109, v109, v17
  v_sub_f32 v110, v110, v17
  v_sub_f32 v111, v111, v17
  v_sub_f32 v128, v128, v18
  v_sub_f32 v129, v129, v18
  v_sub_f32 v130, v130, v18
  v_sub_f32 v131, v131, v18
  v_sub_f32 v132, v132, v18
  v_sub_f32 v133, v133, v18
  v_sub_f32 v134, v134, v18
  v_sub_f32 v135, v135, v18
  v_sub_f32 v136, v136, v19
  v_sub_f32 v137, v137, v19
  v_sub_f32 v138, v138, v19
  v_sub_f32 v139, v139, v19
  v_sub_f32 v140, v140, v19
  v_sub_f32 v141, v141, v19
  v_sub_f32 v142, v142, v19
  v_sub_f32 v143, v143, v19
  v_mfma_f32_16x16x32_bf16 v[112:115], a[128:131], v[32:35], v[192:195]
  v_exp_f32 v216, v128
  v_exp_f32 v217, v129
  v_mfma_f32_16x16x32_bf16 v[120:123], a[128:131], v[36:39], v[196:199]
  v_exp_f32 v218, v130
  v_add_f32 v226, v216, v217
  v_cvt_pk_bf16_f32 v176, v216, v217
  v_mfma_f32_16x16x32_bf16 v[144:147], a[128:131], v[64:67], v[200:203]
  s_add_u32 s66, s66, 32768
  v_exp_f32 v219, v131
  v_add_f32 v226, v226, v218
  v_add_f32 v226, v226, v219
  v_mfma_f32_16x16x32_bf16 v[152:155], a[128:131], v[68:71], v[204:207]
  s_mov_b32 m0, s25
  ds_read_b128 a[128:131], v3 offset:8192
  v_exp_f32 v220, v132
  v_cvt_pk_bf16_f32 v177, v218, v219
  v_mfma_f32_16x16x32_bf16 v[116:119], a[132:135], v[32:35], v[192:195]
  s_and_b32 s66, s66, 0x1ffff
  buffer_load_dwordx4 v2, s[48:51], s27 offen offset:0 sc1 lds
  v_exp_f32 v221, v133
  v_add_f32 v226, v226, v220
  v_add_f32 v226, v226, v221
  v_mfma_f32_16x16x32_bf16 v[124:127], a[132:135], v[36:39], v[196:199]
  v_exp_f32 v222, v134
  v_cvt_pk_bf16_f32 v178, v220, v221
  v_exp_f32 v223, v135
  v_mfma_f32_16x16x32_bf16 v[148:151], a[132:135], v[64:67], v[200:203]
  v_exp_f32 v216, v136
  v_add_f32 v226, v226, v222
  v_mfma_f32_16x16x32_bf16 v[156:159], a[132:135], v[68:71], v[204:207]
  ds_read_b128 a[132:135], v3 offset:9216
  v_exp_f32 v217, v137
  v_add_f32 v226, v226, v223
  v_mfma_f32_16x16x32_bf16 v[112:115], a[136:139], v[40:43], v[112:115]
  v_exp_f32 v218, v138
  v_cvt_pk_bf16_f32 v179, v222, v223
  v_add_f32 v227, v216, v217
  v_mfma_f32_16x16x32_bf16 v[120:123], a[136:139], v[44:47], v[120:123]
  v_exp_f32 v219, v139
  v_cvt_pk_bf16_f32 v180, v216, v217
  v_add_f32 v227, v227, v218
  v_add_f32 v227, v227, v219
  v_mfma_f32_16x16x32_bf16 v[144:147], a[136:139], v[72:75], v[144:147]
  buffer_load_dwordx4 v2, s[48:51], s27 offen offset:1024 sc1 lds
  v_exp_f32 v220, v140
  v_cvt_pk_bf16_f32 v181, v218, v219
  v_mfma_f32_16x16x32_bf16 v[152:155], a[136:139], v[76:79], v[152:155]
  ds_read_b128 a[136:139], v3 offset:10240
  v_exp_f32 v221, v141
  v_add_f32 v227, v227, v220
  v_mfma_f32_16x16x32_bf16 v[116:119], a[140:143], v[40:43], v[116:119]
  v_exp_f32 v222, v142
  v_add_f32 v227, v227, v221
  v_cvt_pk_bf16_f32 v182, v220, v221
  v_mfma_f32_16x16x32_bf16 v[124:127], a[140:143], v[44:47], v[124:127]
  v_exp_f32 v223, v143
  v_add_f32 v227, v227, v222
  v_add_f32 v227, v227, v223
  v_exp_f32 v208, v96
  v_mfma_f32_16x16x32_bf16 v[148:151], a[140:143], v[72:75], v[148:151]
  v_exp_f32 v209, v97
  v_cvt_pk_bf16_f32 v183, v222, v223
  v_mfma_f32_16x16x32_bf16 v[156:159], a[140:143], v[76:79], v[156:159]
  s_waitcnt lgkmcnt(3)
  ds_read_b128 a[140:143], v3 offset:11264
  v_exp_f32 v210, v98
  v_add_f32 v224, v208, v209
  v_mfma_f32_16x16x32_bf16 v[112:115], a[144:147], v[48:51], v[112:115]
  v_exp_f32 v211, v99
  v_cvt_pk_bf16_f32 v160, v208, v209
  v_add_f32 v224, v224, v210
  v_mfma_f32_16x16x32_bf16 v[120:123], a[144:147], v[52:55], v[120:123]
  v_exp_f32 v212, v100
  v_add_f32 v224, v224, v211
  v_cvt_pk_bf16_f32 v161, v210, v211
  v_mfma_f32_16x16x32_bf16 v[144:147], a[144:147], v[80:83], v[144:147]
  buffer_load_dwordx4 v2, s[48:51], s27 offen offset:2048 sc1 lds
  v_exp_f32 v213, v101
  v_add_f32 v224, v224, v212
  v_add_f32 v224, v224, v213
  v_mfma_f32_16x16x32_bf16 v[152:155], a[144:147], v[84:87], v[152:155]
  ds_read_b128 a[144:147], v3 offset:12288
  v_exp_f32 v214, v102
  v_cvt_pk_bf16_f32 v162, v212, v213
  v_mfma_f32_16x16x32_bf16 v[116:119], a[148:151], v[48:51], v[116:119]
  v_exp_f32 v215, v103
  v_add_f32 v224, v224, v214
  v_add_f32 v224, v224, v215
  v_mfma_f32_16x16x32_bf16 v[124:127], a[148:151], v[52:55], v[124:127]
  v_exp_f32 v208, v104
  v_exp_f32 v209, v105
  v_mfma_f32_16x16x32_bf16 v[148:151], a[148:151], v[80:83], v[148:151]
  v_exp_f32 v210, v106
  v_cvt_pk_bf16_f32 v163, v214, v215
  v_add_f32 v225, v208, v209
  v_mfma_f32_16x16x32_bf16 v[156:159], a[148:151], v[84:87], v[156:159]
  ds_read_b128 a[148:151], v3 offset:13312
  v_exp_f32 v211, v107
  v_cvt_pk_bf16_f32 v164, v208, v209
  v_add_f32 v225, v225, v210
  v_mfma_f32_16x16x32_bf16 v[112:115], a[152:155], v[56:59], v[112:115]
  buffer_load_dwordx4 v2, s[48:51], s27 offen offset:3072 sc1 lds
  v_exp_f32 v212, v108
  v_add_f32 v225, v225, v211
  v_mfma_f32_16x16x32_bf16 v[120:123], a[152:155], v[60:63], v[120:123]
  s_add_u32 s27, s27, 16384
  v_exp_f32 v213, v109
  v_mfma_f32_16x16x32_bf16 v[144:147], a[152:155], v[88:91], v[144:147]
  s_add_u32 s25, s25, 32768
  v_exp_f32 v214, v110
  v_mfma_f32_16x16x32_bf16 v[152:155], a[152:155], v[92:95], v[152:155]
  s_and_b32 s25, s25, 0x1ffff
  ds_read_b128 a[152:155], v3 offset:14336
  v_cvt_pk_bf16_f32 v165, v210, v211
  v_max3_f32 v5, v226, v227, v224
  v_add_f32 v225, v225, v212
  v_add_f32 v225, v225, v213
  v_cvt_pk_bf16_f32 v166, v212, v213
  v_exp_f32 v215, v111
  v_mfma_f32_16x16x32_bf16 v[116:119], a[156:159], v[56:59], v[116:119]
  v_add_f32 v225, v225, v214
  v_add_f32 v225, v225, v215
  v_max_f32 v5, v5, v225
  v_cmp_lt_f32 vcc, s81, v5
  v_mfma_f32_16x16x32_bf16 v[124:127], a[156:159], v[60:63], v[124:127]
  v_mfma_f32_16x16x32_bf16 v[148:151], a[156:159], v[88:91], v[148:151]
  v_cvt_pk_bf16_f32 v167, v214, v215
  v_mfma_f32_16x16x32_bf16 v[156:159], a[156:159], v[92:95], v[156:159]
  s_waitcnt lgkmcnt(3)
  s_cbranch_vccnz fa_stub0
fa_back0:
  ds_read_b128 a[156:159], v3 offset:15360
  v_add_f32 v228, v228, v224
  v_add_f32 v229, v229, v225
  v_add_f32 v230, v230, v226
  v_add_f32 v231, v231, v227
  s_nop 3
  v_exp_f32 v216, v144
  v_exp_f32 v217, v145
  v_add_u32 v3, s66, v2
  buffer_load_dword v14, v13, s[40:43], 0 offen sc1
  s_cmp_eq_u32 s28, 0
  s_cbranch_scc1 fa_AV
  s_sub_u32 s28, s28, 1
  s_cmp_eq_u32 s28, 0
  s_cbranch_scc1 fa_Aexit
.p2align 6
fa_DD:
  v_mfma_f32_16x16x32_bf16 v[96:99], a[128:131], v[32:35], v[192:195]
  s_waitcnt vmcnt(12)
  v_exp_f32 v218, v146
  v_mfma_f32_16x16x32_bf16 v[104:107], a[128:131], v[36:39], v[196:199]
  s_barrier
  v_exp_f32 v219, v147
  v_mfma_f32_16x16x32_bf16 v[128:131], a[128:131], v[64:67], v[200:203]
  s_cmp_ge_u32 s26, s32
  ds_read_b128 a[160:163], v3 offset:16384
  v_add_f32 v226, v216, v217
  v_mfma_f32_16x16x32_bf16 v[136:139], a[128:131], v[68:71], v[204:207]
  s_cbranch_scc1 fa_hk4
fa_hb4:
  v_exp_f32 v220, v148
  v_mfma_f32_16x16x32_bf16 v[100:103], a[132:135], v[32:35], v[192:195]
  ds_read_b128 a[164:167], v3 offset:17408
  v_cvt_pk_bf16_f32 v184, v216, v217
  v_mfma_f32_16x16x32_bf16 v[108:111], a[132:135], v[36:39], v[196:199]
  s_mov_b32 m0, s24
  v_exp_f32 v221, v149
  v_mfma_f32_16x16x32_bf16 v[132:135], a[132:135], v[64:67], v[200:203]
  buffer_load_dwordx4 v2, s[44:47], s26 offen offset:0 sc1 lds
  v_add_f32 v226, v226, v218
  v_mfma_f32_16x16x32_bf16 v[140:143], a[132:135], v[68:71], v[204:207]
  v_exp_f32 v222, v150
  v_mfma_f32_16x16x32_bf16 v[96:99], a[136:139], v[40:43], v[96:99]
  ds_read_b128 a[168:171], v3 offset:18432
  v_add_f32 v226, v226, v219
  v_mfma_f32_16x16x32_bf16 v[104:107], a[136:139], v[44:47], v[104:107]
  v_exp_f32 v223, v151
  v_mfma_f32_16x16x32_bf16 v[128:131], a[136:139], v[72:75], v[128:131]
  v_cvt_pk_bf16_f32 v185, v218, v219
  v_add_f32 v226, v226, v220
  v_mfma_f32_16x16x32_bf16 v[136:139], a[136:139], v[76:79], v[136:139]
  v_exp_f32 v216, v152
  v_mfma_f32_16x16x32_bf16 v[100:103], a[140:143], v[40:43], v[100:103]
  ds_read_b128 a[172:175], v3 offset:19456
  v_add_f32 v226, v226, v221
  v_mfma_f32_16x16x32_bf16 v[108:111], a[140:143], v[44:47], v[108:111]
  v_exp_f32 v217, v153
  v_mfma_f32_16x16x32_bf16 v[132:135], a[140:143], v[72:75], v[132:135]
  v_cvt_pk_bf16_f32 v186, v220, v221
  v_add_f32 v226, v226, v222
  v_mfma_f32_16x16x32_bf16 v[140:143], a[140:143], v[76:79], v[140:143]
  s_waitcnt lgkmcnt(4)
  v_exp_f32 v218, v154
  v_mfma_f32_16x16x32_bf16 v[96:99], a[144:147], v[48:51], v[96:99]
  ds_read_b128 a[176:179], v3 offset:20480
  v_add_f32 v226, v226, v223
  v_mfma_f32_16x16x32_bf16 v[104:107], a[144:147], v[52:55], v[104:107]
  v_exp_f32 v219, v155
  v_mfma_f32_16x16x32_bf16 v[128:131], a[144:147], v[80:83], v[128:131]
  v_cvt_pk_bf16_f32 v187, v222, v223
  v_add_f32 v227, v216, v217
  v_mfma_f32_16x16x32_bf16 v[136:139], a[144:147], v[84:87], v[136:139]
  v_exp_f32 v220, v156
  v_mfma_f32_16x16x32_bf16 v[100:103], a[148:151], v[48:51], v[100:103]
  ds_read_b128 a[180:183], v3 offset:21504
  v_cvt_pk_bf16_f32 v188, v216, v217
  v_mfma_f32_16x16x32_bf16 v[108:111], a[148:151], v[52:55], v[108:111]
  v_exp_f32 v221, v157
  v_mfma_f32_16x16x32_bf16 v[132:135], a[148:151], v[80:83], v[132:135]
  buffer_load_dwordx4 v2, s[44:47], s26 offen offset:1024 sc1 lds
  v_add_f32 v227, v227, v218
  v_mfma_f32_16x16x32_bf16 v[140:143], a[148:151], v[84:87], v[140:143]
  v_exp_f32 v222, v158
  v_mfma_f32_16x16x32_bf16 v[96:99], a[152:155], v[56:59], v[96:99]
  ds_read_b128 a[184:187], v3 offset:22528
  v_add_f32 v227, v227, v219
  v_mfma_f32_16x16x32_bf16 v[104:107], a[152:155], v[60:63], v[104:107]
  v_exp_f32 v223, v159
  v_mfma_f32_16x16x32_bf16 v[128:131], a[152:155], v[88:91], v[128:131]
  v_cvt_pk_bf16_f32 v189, v218, v219
  v_add_f32 v227, v227, v220
  v_mfma_f32_16x16x32_bf16 v[136:139], a[152:155], v[92:95], v[136:139]
  v_exp_f32 v208, v112
  v_mfma_f32_16x16x32_bf16 v[100:103], a[156:159], v[56:59], v[100:103]
  ds_read_b128 a[188:191], v3 offset:23552
  v_add_f32 v227, v227, v221
  v_mfma_f32_16x16x32_bf16 v[108:111], a[156:159], v[60:63], v[108:111]
  v_exp_f32 v209, v113
  v_mfma_f32_16x16x32_bf16 v[132:135], a[156:159], v[88:91], v[132:135]
  v_cvt_pk_bf16_f32 v190, v220, v221
  v_add_f32 v227, v227, v222
  v_add_f32 v227, v227, v223
  v_mfma_f32_16x16x32_bf16 v[140:143], a[156:159], v[92:95], v[140:143]
  s_waitcnt lgkmcnt(4)
  v_exp_f32 v210, v114
  v_mfma_f32_16x16x32_bf16 a[0:3], a[160:163], v[160:163], a[0:3]
  ds_read_b128 a[128:131], v3 offset:0
  v_cvt_pk_bf16_f32 v191, v222, v223
  v_mfma_f32_16x16x32_bf16 a[4:7], a[160:163], v[164:167], a[4:7]
  v_exp_f32 v211, v115
  v_mfma_f32_16x16x32_bf16 a[64:67], a[160:163], v[176:179], a[64:67]
  v_exp_f32 v212, v116
  v_mfma_f32_16x16x32_bf16 a[68:71], a[160:163], v[180:183], a[68:71]
  v_add_f32 v224, v208, v209
  v_cvt_pk_bf16_f32 v168, v208, v209
  v_mfma_f32_16x16x32_bf16 a[8:11], a[164:167], v[160:163], a[8:11]
  ds_read_b128 a[132:135], v3 offset:1024
  v_add_f32 v224, v224, v210
  v_mfma_f32_16x16x32_bf16 a[12:15], a[164:167], v[164:167], a[12:15]
  v_exp_f32 v213, v117
  v_mfma_f32_16x16x32_bf16 a[72:75], a[164:167], v[176:179], a[72:75]
  buffer_load_dwordx4 v2, s[44:47], s26 offen offset:2048 sc1 lds
  v_add_f32 v224, v224, v211
  v_mfma_f32_16x16x32_bf16 a[76:79], a[164:167], v[180:183], a[76:79]
  v_exp_f32 v214, v118
  v_mfma_f32_16x16x32_bf16 a[16:19], a[168:171], v[160:163], a[16:19]
  ds_read_b128 a[136:139], v3 offset:2048
  v_cvt_pk_bf16_f32 v169, v210, v211
  v_mfma_f32_16x16x32_bf16 a[20:23], a[168:171], v[164:167], a[20:23]
  v_exp_f32 v215, v119
  v_mfma_f32_16x16x32_bf16 a[80:83], a[168:171], v[176:179], a[80:83]
  v_add_f32 v224, v224, v212
  v_add_f32 v224, v224, v213
  v_mfma_f32_16x16x32_bf16 a[84:87], a[168:171], v[180:183], a[84:87]
  v_exp_f32 v208, v120
  v_mfma_f32_16x16x32_bf16 a[24:27], a[172:175], v[160:163], a[24:27]
  ds_read_b128 a[140:143], v3 offset:3072
  v_cvt_pk_bf16_f32 v170, v212, v213
  v_mfma_f32_16x16x32_bf16 a[28:31], a[172:175], v[164:167], a[28:31]
  v_exp_f32 v209, v121
  v_mfma_f32_16x16x32_bf16 a[88:91], a[172:175], v[176:179], a[88:91]
  v_exp_f32 v210, v122
  v_mfma_f32_16x16x32_bf16 a[92:95], a[172:175], v[180:183], a[92:95]
  s_waitcnt lgkmcnt(4)
  v_add_f32 v224, v224, v214
  v_add_f32 v224, v224, v215
  v_mfma_f32_16x16x32_bf16 a[32:35], a[176:179], v[160:163], a[32:35]
  ds_read_b128 a[144:147], v3 offset:4096
  v_cvt_pk_bf16_f32 v171, v214, v215
  v_mfma_f32_16x16x32_bf16 a[36:39], a[176:179], v[164:167], a[36:39]
  v_exp_f32 v211, v123
  v_mfma_f32_16x16x32_bf16 a[96:99], a[176:179], v[176:179], a[96:99]
  v_add_f32 v225, v208, v209
  v_cvt_pk_bf16_f32 v172, v208, v209
  v_mfma_f32_16x16x32_bf16 a[100:103], a[176:179], v[180:183], a[100:103]
  v_exp_f32 v212, v124
  v_mfma_f32_16x16x32_bf16 a[40:43], a[180:183], v[160:163], a[40:43]
  ds_read_b128 a[148:151], v3 offset:5120
  v_add_f32 v225, v225, v210
  v_mfma_f32_16x16x32_bf16 a[44:47], a[180:183], v[164:167], a[44:47]
  v_exp_f32 v213, v125
  v_mfma_f32_16x16x32_bf16 a[104:107], a[180:183], v[176:179], a[104:107]
  buffer_load_dwordx4 v2, s[44:47], s26 offen offset:3072 sc1 lds
  v_add_f32 v225, v225, v211
  v_mfma_f32_16x16x32_bf16 a[108:111], a[180:183], v[180:183], a[108:111]
  s_add_u32 s26, s26, 16384
  v_exp_f32 v214, v126
  v_mfma_f32_16x16x32_bf16 a[48:51], a[184:187], v[160:163], a[48:51]
  s_add_u32 s24, s24, 32768
  ds_read_b128 a[152:155], v3 offset:6144
  v_cvt_pk_bf16_f32 v173, v210, v211
  v_mfma_f32_16x16x32_bf16 a[52:55], a[184:187], v[164:167], a[52:55]
  s_and_b32 s24, s24, 0x1ffff
  v_exp_f32 v215, v127
  v_mfma_f32_16x16x32_bf16 a[112:115], a[184:187], v[176:179], a[112:115]
  v_max3_f32 v5, v226, v227, v224
  v_add_f32 v225, v225, v212
  v_mfma_f32_16x16x32_bf16 a[116:119], a[184:187], v[180:183], a[116:119]
  v_add_f32 v225, v225, v213
  v_cvt_pk_bf16_f32 v174, v212, v213
  v_add_f32 v225, v225, v214
  v_mfma_f32_16x16x32_bf16 a[56:59], a[188:191], v[160:163], a[56:59]
  ds_read_b128 a[156:159], v3 offset:7168
  v_add_f32 v225, v225, v215
  v_max_f32 v5, v5, v225
  v_cmp_lt_f32 vcc, s81, v5
  v_mfma_f32_16x16x32_bf16 a[60:63], a[188:191], v[164:167], a[60:63]
  v_exp_f32 v216, v128
  v_mfma_f32_16x16x32_bf16 a[120:123], a[188:191], v[176:179], a[120:123]
  s_waitcnt lgkmcnt(4)
  v_cvt_pk_bf16_f32 v175, v214, v215
  v_mfma_f32_16x16x32_bf16 a[124:127], a[188:191], v[180:183], a[124:127]
  s_cbranch_vccnz fa_stub1
fa_back1:
  v_exp_f32 v217, v129
  v_add_f32 v228, v228, v224
  v_add_f32 v229, v229, v225
  v_add_f32 v230, v230, v226
  v_add_f32 v231, v231, v227
fa_DDe:
  v_mfma_f32_16x16x32_bf16 v[112:115], a[128:131], v[32:35], v[192:195]
  ds_read_b128 a[160:163], v3 offset:24576
  v_add_f32 v226, v216, v217
  v_mfma_f32_16x16x32_bf16 v[120:123], a[128:131], v[36:39], v[196:199]
  v_exp_f32 v218, v130
  v_mfma_f32_16x16x32_bf16 v[144:147], a[128:131], v[64:67], v[200:203]
  s_cmp_ge_u32 s26, s9
  v_exp_f32 v219, v131
  v_mfma_f32_16x16x32_bf16 v[152:155], a[128:131], v[68:71], v[204:207]
  s_cbranch_scc1 fa_hk5
fa_hb5:
  v_exp_f32 v220, v132
  v_mfma_f32_16x16x32_bf16 v[116:119], a[132:135], v[32:35], v[192:195]
  s_add_u32 s66, s66, 32768
  ds_read_b128 a[164:167], v3 offset:25600
  v_cvt_pk_bf16_f32 v176, v216, v217
  v_mfma_f32_16x16x32_bf16 v[124:127], a[132:135], v[36:39], v[196:199]
  s_mov_b32 m0, s25
  v_exp_f32 v221, v133
  v_mfma_f32_16x16x32_bf16 v[148:151], a[132:135], v[64:67], v[200:203]
  s_and_b32 s66, s66, 0x1ffff
  buffer_load_dwordx4 v2, s[48:51], s27 offen offset:0 sc1 lds
  v_add_f32 v226, v226, v218
  v_mfma_f32_16x16x32_bf16 v[156:159], a[132:135], v[68:71], v[204:207]
  v_exp_f32 v222, v134
  v_mfma_f32_16x16x32_bf16 v[112:115], a[136:139], v[40:43], v[112:115]
  ds_read_b128 a[168:171], v3 offset:26624
  v_add_f32 v226, v226, v219
  v_mfma_f32_16x16x32_bf16 v[120:123], a[136:139], v[44:47], v[120:123]
  v_exp_f32 v223, v135
  v_mfma_f32_16x16x32_bf16 v[144:147], a[136:139], v[72:75], v[144:147]
  v_cvt_pk_bf16_f32 v177, v218, v219
  v_add_f32 v226, v226, v220
  v_mfma_f32_16x16x32_bf16 v[152:155], a[136:139], v[76:79], v[152:155]
  v_exp_f32 v216, v136
  v_mfma_f32_16x16x32_bf16 v[116:119], a[140:143], v[40:43], v[116:119]
  ds_read_b128 a[172:175], v3 offset:27648
  v_add_f32 v226, v226, v221
  v_mfma_f32_16x16x32_bf16 v[124:127], a[140:143], v[44:47], v[124:127]
  v_exp_f32 v217, v137
  v_mfma_f32_16x16x32_bf16 v[148:151], a[140:143], v[72:75], v[148:151]
  v_cvt_pk_bf16_f32 v178, v220, v221
  v_add_f32 v226, v226, v222
  v_mfma_f32_16x16x32_bf16 v[156:159], a[140:143], v[76:79], v[156:159]
  s_waitcnt lgkmcnt(4)
  v_exp_f32 v218, v138
  v_mfma_f32_16x16x32_bf16 v[112:115], a[144:147], v[48:51], v[112:115]
  ds_read_b128 a[176:179], v3 offset:28672
  v_add_f32 v226, v226, v223
  v_mfma_f32_16x16x32_bf16 v[120:123], a[144:147], v[52:55], v[120:123]
  v_exp_f32 v219, v139
  v_mfma_f32_16x16x32_bf16 v[144:147], a[144:147], v[80:83], v[144:147]
  v_cvt_pk_bf16_f32 v179, v222, v223
  v_add_f32 v227, v216, v217
  v_mfma_f32_16x16x32_bf16 v[152:155], a[144:147], v[84:87], v[152:155]
  v_exp_f32 v220, v140
  v_mfma_f32_16x16x32_bf16 v[116:119], a[148:151], v[48:51], v[116:119]
  ds_read_b128 a[180:183], v3 offset:29696
  v_cvt_pk_bf16_f32 v180, v216, v217
  v_mfma_f32_16x16x32_bf16 v[124:127], a[148:151], v[52:55], v[124:127]
  v_exp_f32 v221, v141
  v_mfma_f32_16x16x32_bf16 v[148:151], a[148:151], v[80:83], v[148:151]
  buffer_load_dwordx4 v2, s[48:51], s27 offen offset:1024 sc1 lds
  v_add_f32 v227, v227, v218
  v_mfma_f32_16x16x32_bf16 v[156:159], a[148:151], v[84:87], v[156:159]
  v_exp_f32 v222, v142
  v_mfma_f32_16x16x32_bf16 v[112:115], a[152:155], v[56:59], v[112:115]
  ds_read_b128 a[184:187], v3 offset:30720
  v_add_f32 v227, v227, v219
  v_mfma_f32_16x16x32_bf16 v[120:123], a[152:155], v[60:63], v[120:123]
  v_exp_f32 v223, v143
  v_mfma_f32_16x16x32_bf16 v[144:147], a[152:155], v[88:91], v[144:147]
  v_cvt_pk_bf16_f32 v181, v218, v219
  v_add_f32 v227, v227, v220
  v_mfma_f32_16x16x32_bf16 v[152:155], a[152:155], v[92:95], v[152:155]
  v_exp_f32 v208, v96
  v_mfma_f32_16x16x32_bf16 v[116:119], a[156:159], v[56:59], v[116:119]
  ds_read_b128 a[188:191], v3 offset:31744
  v_add_f32 v227, v227, v221
  v_mfma_f32_16x16x32_bf16 v[124:127], a[156:159], v[60:63], v[124:127]
  v_exp_f32 v209, v97
  v_mfma_f32_16x16x32_bf16 v[148:151], a[156:159], v[88:91], v[148:151]
  v_cvt_pk_bf16_f32 v182, v220, v221
  v_add_f32 v227, v227, v222
  v_add_f32 v227, v227, v223
  v_mfma_f32_16x16x32_bf16 v[156:159], a[156:159], v[92:95], v[156:159]
  s_waitcnt lgkmcnt(4)
  v_exp_f32 v210, v98
  v_mfma_f32_16x16x32_bf16 a[0:3], a[160:163], v[168:171], a[0:3]
  ds_read_b128 a[128:131], v3 offset:8192
  v_cvt_pk_bf16_f32 v183, v222, v223
  v_mfma_f32_16x16x32_bf16 a[4:7], a[160:163], v[172:175], a[4:7]
  v_exp_f32 v211, v99
  v_mfma_f32_16x16x32_bf16 a[64:67], a[160:163], v[184:187], a[64:67]
  v_exp_f32 v212, v100
  v_mfma_f32_16x16x32_bf16 a[68:71], a[160:163], v[188:191], a[68:71]
  v_add_f32 v224, v208, v209
  v_cvt_pk_bf16_f32 v160, v208, v209
  v_mfma_f32_16x16x32_bf16 a[8:11], a[164:167], v[168:171], a[8:11]
  ds_read_b128 a[132:135], v3 offset:9216
  v_add_f32 v224, v224, v210
  v_mfma_f32_16x16x32_bf16 a[12:15], a[164:167], v[172:175], a[12:15]
  v_exp_f32 v213, v101
  v_mfma_f32_16x16x32_bf16 a[72:75], a[164:167], v[184:187], a[72:75]
  buffer_load_dwordx4 v2, s[48:51], s27 offen offset:2048 sc1 lds
  v_add_f32 v224, v224, v211
  v_mfma_f32_16x16x32_bf16 a[76:79], a[164:167], v[188:191], a[76:79]
  v_exp_f32 v214, v102
  v_mfma_f32_16x16x32_bf16 a[16:19], a[168:171], v[168:171], a[16:19]
  ds_read_b128 a[136:139], v3 offset:10240
  v_cvt_pk_bf16_f32 v161, v210, v211
  v_mfma_f32_16x16x32_bf16 a[20:23], a[168:171], v[172:175], a[20:23]
  v_exp_f32 v215, v103
  v_mfma_f32_16x16x32_bf16 a[80:83], a[168:171], v[184:187], a[80:83]
  v_add_f32 v224, v224, v212
  v_add_f32 v224, v224, v213
  v_mfma_f32_16x16x32_bf16 a[84:87], a[168:171], v[188:191], a[84:87]
  v_exp_f32 v208, v104
  v_mfma_f32_16x16x32_bf16 a[24:27], a[172:175], v[168:171], a[24:27]
  ds_read_b128 a[140:143], v3 offset:11264
  v_cvt_pk_bf16_f32 v162, v212, v213
  v_mfma_f32_16x16x32_bf16 a[28:31], a[172:175], v[172:175], a[28:31]
  v_exp_f32 v209, v105
  v_mfma_f32_16x16x32_bf16 a[88:91], a[172:175], v[184:187], a[88:91]
  v_exp_f32 v210, v106
  v_mfma_f32_16x16x32_bf16 a[92:95], a[172:175], v[188:191], a[92:95]
  s_waitcnt lgkmcnt(4)
  v_add_f32 v224, v224, v214
  v_add_f32 v224, v224, v215
  v_mfma_f32_16x16x32_bf16 a[32:35], a[176:179], v[168:171], a[32:35]
  ds_read_b128 a[144:147], v3 offset:12288
  v_cvt_pk_bf16_f32 v163, v214, v215
  v_mfma_f32_16x16x32_bf16 a[36:39], a[176:179], v[172:175], a[36:39]
  v_exp_f32 v211, v107
  v_mfma_f32_16x16x32_bf16 a[96:99], a[176:179], v[184:187], a[96:99]
  v_add_f32 v225, v208, v209
  v_cvt_pk_bf16_f32 v164, v208, v209
  v_mfma_f32_16x16x32_bf16 a[100:103], a[176:179], v[188:191], a[100:103]
  v_exp_f32 v212, v108
  v_mfma_f32_16x16x32_bf16 a[40:43], a[180:183], v[168:171], a[40:43]
  ds_read_b128 a[148:151], v3 offset:13312
  v_add_f32 v225, v225, v210
  v_mfma_f32_16x16x32_bf16 a[44:47], a[180:183], v[172:175], a[44:47]
  v_exp_f32 v213, v109
  v_mfma_f32_16x16x32_bf16 a[104:107], a[180:183], v[184:187], a[104:107]
  buffer_load_dwordx4 v2, s[48:51], s27 offen offset:3072 sc1 lds
  v_add_f32 v225, v225, v211
  v_mfma_f32_16x16x32_bf16 a[108:111], a[180:183], v[188:191], a[108:111]
  s_add_u32 s27, s27, 16384
  v_exp_f32 v214, v110
  v_mfma_f32_16x16x32_bf16 a[48:51], a[184:187], v[168:171], a[48:51]
  s_add_u32 s25, s25, 32768
  ds_read_b128 a[152:155], v3 offset:14336
  v_cvt_pk_bf16_f32 v165, v210, v211
  v_mfma_f32_16x16x32_bf16 a[52:55], a[184:187], v[172:175], a[52:55]
  s_and_b32 s25, s25, 0x1ffff
  v_exp_f32 v215, v111
  v_mfma_f32_16x16x32_bf16 a[112:115], a[184:187], v[184:187], a[112:115]
  v_max3_f32 v5, v226, v227, v224
  v_add_f32 v225, v225, v212
  v_mfma_f32_16x16x32_bf16 a[116:119], a[184:187], v[188:191], a[116:119]
  v_add_f32 v225, v225, v213
  v_cvt_pk_bf16_f32 v166, v212, v213
  v_add_f32 v225, v225, v214
  v_mfma_f32_16x16x32_bf16 a[56:59], a[188:191], v[168:171], a[56:59]
  s_sub_u32 s28, s28, 1
  ds_read_b128 a[156:159], v3 offset:15360
  v_add_f32 v225, v225, v215
  v_max_f32 v5, v5, v225
  v_cmp_lt_f32 vcc, s81, v5
  v_mfma_f32_16x16x32_bf16 a[60:63], a[188:191], v[172:175], a[60:63]
  s_cmp_gt_u32 s28, s8
  v_exp_f32 v216, v144
  v_mfma_f32_16x16x32_bf16 a[120:123], a[188:191], v[184:187], a[120:123]
  s_waitcnt lgkmcnt(4)
  v_cvt_pk_bf16_f32 v167, v214, v215
  v_add_u32 v3, s66, v2
  v_mfma_f32_16x16x32_bf16 a[124:127], a[188:191], v[188:191], a[124:127]
  s_cbranch_vccnz fa_stub2
fa_back2:
  v_exp_f32 v217, v145
  v_add_f32 v228, v228, v224
  v_add_f32 v229, v229, v225
  v_add_f32 v230, v230, v226
  v_add_f32 v231, v231, v227
  s_cbranch_scc1 fa_DD
  s_cmp_lg_u32 s8, 0
  s_cbranch_scc1 fa_DDF
fa_Aexit:
  s_bitcmp1_b32 s20, 0
  s_cbranch_scc1 fa_Aodd
  v_mfma_f32_16x16x32_bf16 v[96:99], a[128:131], v[32:35], v[192:195]
  s_waitcnt vmcnt(12)
  v_exp_f32 v218, v146
  v_mfma_f32_16x16x32_bf16 v[104:107], a[128:131], v[36:39], v[196:199]
  s_barrier
  v_exp_f32 v219, v147
  v_mfma_f32_16x16x32_bf16 v[128:131], a[128:131], v[64:67], v[200:203]
  ds_read_b128 a[160:163], v3 offset:16384
  v_add_f32 v226, v216, v217
  v_mfma_f32_16x16x32_bf16 v[136:139], a[128:131], v[68:71], v[204:207]
  v_exp_f32 v220, v148
  v_mfma_f32_16x16x32_bf16 v[100:103], a[132:135], v[32:35], v[192:195]
  ds_read_b128 a[164:167], v3 offset:17408
  v_cvt_pk_bf16_f32 v184, v216, v217
  v_mfma_f32_16x16x32_bf16 v[108:111], a[132:135], v[36:39], v[196:199]
  s_mov_b32 m0, s24
  v_exp_f32 v221, v149
  v_mfma_f32_16x16x32_bf16 v[132:135], a[132:135], v[64:67], v[200:203]
  buffer_load_dwordx4 v2, s[44:47], s26 offen offset:0 sc1 lds
  v_add_f32 v226, v226, v218
  v_mfma_f32_16x16x32_bf16 v[140:143], a[132:135], v[68:71], v[204:207]
  v_exp_f32 v222, v150
  v_mfma_f32_16x16x32_bf16 v[96:99], a[136:139], v[40:43], v[96:99]
  ds_read_b128 a[168:171], v3 offset:18432
  v_add_f32 v226, v226, v219
  v_mfma_f32_16x16x32_bf16 v[104:107], a[136:139], v[44:47], v[104:107]
  v_exp_f32 v223, v151
  v_mfma_f32_16x16x32_bf16 v[128:131], a[136:139], v[72:75], v[128:131]
  v_cvt_pk_bf16_f32 v185, v218, v219
  v_add_f32 v226, v226, v220
  v_mfma_f32_16x16x32_bf16 v[136:139], a[136:139], v[76:79], v[136:139]
  v_exp_f32 v216, v152
  v_mfma_f32_16x16x32_bf16 v[100:103], a[140:143], v[40:43], v[100:103]
  ds_read_b128 a[172:175], v3 offset:19456
  v_add_f32 v226, v226, v221
  v_mfma_f32_16x16x32_bf16 v[108:111], a[140:143], v[44:47], v[108:111]
  v_exp_f32 v217, v153
  v_mfma_f32_16x16x32_bf16 v[132:135], a[140:143], v[72:75], v[132:135]
  v_cvt_pk_bf16_f32 v186, v220, v221
  v_add_f32 v226, v226, v222
  v_mfma_f32_16x16x32_bf16 v[140:143], a[140:143], v[76:79], v[140:143]
  s_waitcnt lgkmcnt(4)
  v_exp_f32 v218, v154
  v_mfma_f32_16x16x32_bf16 v[96:99], a[144:147], v[48:51], v[96:99]
  ds_read_b128 a[176:179], v3 offset:20480
  v_add_f32 v226, v226, v223
  v_mfma_f32_16x16x32_bf16 v[104:107], a[144:147], v[52:55], v[104:107]
  v_exp_f32 v219, v155
  v_mfma_f32_16x16x32_bf16 v[128:131], a[144:147], v[80:83], v[128:131]
  v_cvt_pk_bf16_f32 v187, v222, v223
  v_add_f32 v227, v216, v217
  v_mfma_f32_16x16x32_bf16 v[136:139], a[144:147], v[84:87], v[136:139]
  v_exp_f32 v220, v156
  v_mfma_f32_16x16x32_bf16 v[100:103], a[148:151], v[48:51], v[100:103]
  ds_read_b128 a[180:183], v3 offset:21504
  v_cvt_pk_bf16_f32 v188, v216, v217
  v_mfma_f32_16x16x32_bf16 v[108:111], a[148:151], v[52:55], v[108:111]
  v_exp_f32 v221, v157
  v_mfma_f32_16x16x32_bf16 v[132:135], a[148:151], v[80:83], v[132:135]
  buffer_load_dwordx4 v2, s[44:47], s26 offen offset:1024 sc1 lds
  v_add_f32 v227, v227, v218
  v_mfma_f32_16x16x32_bf16 v[140:143], a[148:151], v[84:87], v[140:143]
  v_exp_f32 v222, v158
  v_mfma_f32_16x16x32_bf16 v[96:99], a[152:155], v[56:59], v[96:99]
  ds_read_b128 a[184:187], v3 offset:22528
  v_add_f32 v227, v227, v219
  v_mfma_f32_16x16x32_bf16 v[104:107], a[152:155], v[60:63], v[104:107]
  v_exp_f32 v223, v159
  v_mfma_f32_16x16x32_bf16 v[128:131], a[152:155], v[88:91], v[128:131]
  v_cvt_pk_bf16_f32 v189, v218, v219
  v_add_f32 v227, v227, v220
  v_mfma_f32_16x16x32_bf16 v[136:139], a[152:155], v[92:95], v[136:139]
  v_exp_f32 v208, v112
  v_mfma_f32_16x16x32_bf16 v[100:103], a[156:159], v[56:59], v[100:103]
  ds_read_b128 a[188:191], v3 offset:23552
  v_add_f32 v227, v227, v221
  v_mfma_f32_16x16x32_bf16 v[108:111], a[156:159], v[60:63], v[108:111]
  v_exp_f32 v209, v113
  v_mfma_f32_16x16x32_bf16 v[132:135], a[156:159], v[88:91], v[132:135]
  v_cvt_pk_bf16_f32 v190, v220, v221
  v_add_f32 v227, v227, v222
  v_add_f32 v227, v227, v223
  v_mfma_f32_16x16x32_bf16 v[140:143], a[156:159], v[92:95], v[140:143]
  s_waitcnt lgkmcnt(4)
  v_exp_f32 v210, v114
  v_mfma_f32_16x16x32_bf16 a[0:3], a[160:163], v[160:163], a[0:3]
  ds_read_b128 a[128:131], v3 offset:0
  v_cvt_pk_bf16_f32 v191, v222, v223
  v_mfma_f32_16x16x32_bf16 a[4:7], a[160:163], v[164:167], a[4:7]
  v_exp_f32 v211, v115
  v_mfma_f32_16x16x32_bf16 a[64:67], a[160:163], v[176:179], a[64:67]
  v_exp_f32 v212, v116
  v_mfma_f32_16x16x32_bf16 a[68:71], a[160:163], v[180:183], a[68:71]
  v_add_f32 v224, v208, v209
  v_cvt_pk_bf16_f32 v168, v208, v209
  v_mfma_f32_16x16x32_bf16 a[8:11], a[164:167], v[160:163], a[8:11]
  ds_read_b128 a[132:135], v3 offset:1024
  v_add_f32 v224, v224, v210
  v_mfma_f32_16x16x32_bf16 a[12:15], a[164:167], v[164:167], a[12:15]
  v_exp_f32 v213, v117
  v_mfma_f32_16x16x32_bf16 a[72:75], a[164:167], v[176:179], a[72:75]
  buffer_load_dwordx4 v2, s[44:47], s26 offen offset:2048 sc1 lds
  v_add_f32 v224, v224, v211
  v_mfma_f32_16x16x32_bf16 a[76:79], a[164:167], v[180:183], a[76:79]
  v_exp_f32 v214, v118
  v_mfma_f32_16x16x32_bf16 a[16:19], a[168:171], v[160:163], a[16:19]
  ds_read_b128 a[136:139], v3 offset:2048
  v_cvt_pk_bf16_f32 v169, v210, v211
  v_mfma_f32_16x16x32_bf16 a[20:23], a[168:171], v[164:167], a[20:23]
  v_exp_f32 v215, v119
  v_mfma_f32_16x16x32_bf16 a[80:83], a[168:171], v[176:179], a[80:83]
  v_add_f32 v224, v224, v212
  v_add_f32 v224, v224, v213
  v_mfma_f32_16x16x32_bf16 a[84:87], a[168:171], v[180:183], a[84:87]
  v_exp_f32 v208, v120
  v_mfma_f32_16x16x32_bf16 a[24:27], a[172:175], v[160:163], a[24:27]
  ds_read_b128 a[140:143], v3 offset:3072
  v_cvt_pk_bf16_f32 v170, v212, v213
  v_mfma_f32_16x16x32_bf16 a[28:31], a[172:175], v[164:167], a[28:31]
  v_exp_f32 v209, v121
  v_mfma_f32_16x16x32_bf16 a[88:91], a[172:175], v[176:179], a[88:91]
  v_exp_f32 v210, v122
  v_mfma_f32_16x16x32_bf16 a[92:95], a[172:175], v[180:183], a[92:95]
  s_waitcnt lgkmcnt(4)
  v_add_f32 v224, v224, v214
  v_add_f32 v224, v224, v215
  v_mfma_f32_16x16x32_bf16 a[32:35], a[176:179], v[160:163], a[32:35]
  ds_read_b128 a[144:147], v3 offset:4096
  v_cvt_pk_bf16_f32 v171, v214, v215
  v_mfma_f32_16x16x32_bf16 a[36:39], a[176:179], v[164:167], a[36:39]
  v_exp_f32 v211, v123
  v_mfma_f32_16x16x32_bf16 a[96:99], a[176:179], v[176:179], a[96:99]
  v_add_f32 v225, v208, v209
  v_cvt_pk_bf16_f32 v172, v208, v209
  v_mfma_f32_16x16x32_bf16 a[100:103], a[176:179], v[180:183], a[100:103]
  v_exp_f32 v212, v124
  v_mfma_f32_16x16x32_bf16 a[40:43], a[180:183], v[160:163], a[40:43]
  ds_read_b128 a[148:151], v3 offset:5120
  v_add_f32 v225, v225, v210
  v_mfma_f32_16x16x32_bf16 a[44:47], a[180:183], v[164:167], a[44:47]
  v_exp_f32 v213, v125
  v_mfma_f32_16x16x32_bf16 a[104:107], a[180:183], v[176:179], a[104:107]
  buffer_load_dwordx4 v2, s[44:47], s26 offen offset:3072 sc1 lds
  v_add_f32 v225, v225, v211
  v_mfma_f32_16x16x32_bf16 a[108:111], a[180:183], v[180:183], a[108:111]
  s_add_u32 s26, s26, 16384
  v_exp_f32 v214, v126
  v_mfma_f32_16x16x32_bf16 a[48:51], a[184:187], v[160:163], a[48:51]
  s_add_u32 s24, s24, 32768
  ds_read_b128 a[152:155], v3 offset:6144
  v_cvt_pk_bf16_f32 v173, v210, v211
  v_mfma_f32_16x16x32_bf16 a[52:55], a[184:187], v[164:167], a[52:55]
  s_and_b32 s24, s24, 0x1ffff
  v_exp_f32 v215, v127
  v_mfma_f32_16x16x32_bf16 a[112:115], a[184:187], v[176:179], a[112:115]
  v_max3_f32 v5, v226, v227, v224
  v_add_f32 v225, v225, v212
  v_mfma_f32_16x16x32_bf16 a[116:119], a[184:187], v[180:183], a[116:119]
  v_add_f32 v225, v225, v213
  v_cvt_pk_bf16_f32 v174, v212, v213
  v_add_f32 v225, v225, v214
  v_mfma_f32_16x16x32_bf16 a[56:59], a[188:191], v[160:163], a[56:59]
  ds_read_b128 a[156:159], v3 offset:7168
  v_add_f32 v225, v225, v215
  v_max_f32 v5, v5, v225
  v_cmp_lt_f32 vcc, s81, v5
  v_mfma_f32_16x16x32_bf16 a[60:63], a[188:191], v[164:167], a[60:63]
  v_exp_f32 v216, v128
  v_mfma_f32_16x16x32_bf16 a[120:123], a[188:191], v[176:179], a[120:123]
  s_waitcnt lgkmcnt(4)
  v_cvt_pk_bf16_f32 v175, v214, v215
  v_mfma_f32_16x16x32_bf16 a[124:127], a[188:191], v[180:183], a[124:127]
  s_cbranch_vccnz fa_stub4
fa_back4:
  v_exp_f32 v217, v129
  v_add_f32 v228, v228, v224
  v_add_f32 v229, v229, v225
  v_add_f32 v230, v230, v226
  v_add_f32 v231, v231, v227
  v_mfma_f32_16x16x32_bf16 v[144:147], a[128:131], v[64:67], v[200:203]
  ds_read_b128 a[160:163], v3 offset:24576
  v_exp_f32 v218, v130
  v_mfma_f32_16x16x32_bf16 v[152:155], a[128:131], v[68:71], v[204:207]
  v_exp_f32 v219, v131
  v_add_f32 v226, v216, v217
  v_mfma_f32_16x16x32_bf16 v[148:151], a[132:135], v[64:67], v[200:203]
  s_add_u32 s66, s66, 32768
  ds_read_b128 a[164:167], v3 offset:25600
  v_exp_f32 v220, v132
  v_mfma_f32_16x16x32_bf16 v[156:159], a[132:135], v[68:71], v[204:207]
  s_and_b32 s66, s66, 0x1ffff
  v_exp_f32 v221, v133
  v_cvt_pk_bf16_f32 v176, v216, v217
  v_mfma_f32_16x16x32_bf16 v[144:147], a[136:139], v[72:75], v[144:147]
  ds_read_b128 a[168:171], v3 offset:26624
  v_add_f32 v226, v226, v218
  v_add_f32 v226, v226, v219
  v_mfma_f32_16x16x32_bf16 v[152:155], a[136:139], v[76:79], v[152:155]
  s_mov_b32 m0, s25
  v_exp_f32 v222, v134
  v_cvt_pk_bf16_f32 v177, v218, v219
  v_mfma_f32_16x16x32_bf16 v[148:151], a[140:143], v[72:75], v[148:151]
  ds_read_b128 a[172:175], v3 offset:27648
  buffer_load_dwordx4 v2, s[48:51], s27 offen offset:0 sc1 lds
  v_add_f32 v226, v226, v220
  v_add_f32 v226, v226, v221
  v_mfma_f32_16x16x32_bf16 v[156:159], a[140:143], v[76:79], v[156:159]
  s_waitcnt lgkmcnt(4)
  v_exp_f32 v223, v135
  v_cvt_pk_bf16_f32 v178, v220, v221
  v_mfma_f32_16x16x32_bf16 v[144:147], a[144:147], v[80:83], v[144:147]
  ds_read_b128 a[176:179], v3 offset:28672
  v_cndmask_b32 v96, v4, v96, s[68:69]
  v_cndmask_b32 v97, v4, v97, s[70:71]
  v_mfma_f32_16x16x32_bf16 v[152:155], a[144:147], v[84:87], v[152:155]
  v_exp_f32 v216, v136
  v_cndmask_b32 v98, v4, v98, s[72:73]
  v_mfma_f32_16x16x32_bf16 v[148:151], a[148:151], v[80:83], v[148:151]
  ds_read_b128 a[180:183], v3 offset:29696
  v_cndmask_b32 v99, v4, v99, s[74:75]
  v_mov_b32 v100, v4
  v_mfma_f32_16x16x32_bf16 v[156:159], a[148:151], v[84:87], v[156:159]
  v_exp_f32 v217, v137
  v_mov_b32 v101, v4
  v_mfma_f32_16x16x32_bf16 v[144:147], a[152:155], v[88:91], v[144:147]
  ds_read_b128 a[184:187], v3 offset:30720
  v_mov_b32 v102, v4
  v_mov_b32 v103, v4
  v_mfma_f32_16x16x32_bf16 v[152:155], a[152:155], v[92:95], v[152:155]
  v_exp_f32 v218, v138
  v_cndmask_b32 v108, v4, v108, s[68:69]
  v_mfma_f32_16x16x32_bf16 v[148:151], a[156:159], v[88:91], v[148:151]
  ds_read_b128 a[188:191], v3 offset:31744
  v_cndmask_b32 v109, v4, v109, s[70:71]
  v_cndmask_b32 v110, v4, v110, s[72:73]
  v_mfma_f32_16x16x32_bf16 v[156:159], a[156:159], v[92:95], v[156:159]
  s_waitcnt lgkmcnt(4)
  v_exp_f32 v219, v139
  v_cndmask_b32 v111, v4, v111, s[74:75]
  v_mfma_f32_16x16x32_bf16 a[0:3], a[160:163], v[168:171], a[0:3]
  ds_read_b128 a[128:131], v3 offset:8192
  v_add_f32 v226, v226, v222
  v_add_f32 v226, v226, v223
  v_mfma_f32_16x16x32_bf16 a[4:7], a[160:163], v[172:175], a[4:7]
  v_exp_f32 v220, v140
  v_cvt_pk_bf16_f32 v179, v222, v223
  v_mfma_f32_16x16x32_bf16 a[64:67], a[160:163], v[184:187], a[64:67]
  buffer_load_dwordx4 v2, s[48:51], s27 offen offset:1024 sc1 lds
  v_add_f32 v227, v216, v217
  v_cvt_pk_bf16_f32 v180, v216, v217
  v_mfma_f32_16x16x32_bf16 a[68:71], a[160:163], v[188:191], a[68:71]
  v_exp_f32 v221, v141
  v_add_f32 v227, v227, v218
  v_mfma_f32_16x16x32_bf16 a[8:11], a[164:167], v[168:171], a[8:11]
  ds_read_b128 a[132:135], v3 offset:9216
  v_exp_f32 v222, v142
  v_mfma_f32_16x16x32_bf16 a[12:15], a[164:167], v[172:175], a[12:15]
  v_exp_f32 v223, v143
  v_mfma_f32_16x16x32_bf16 a[72:75], a[164:167], v[184:187], a[72:75]
  v_exp_f32 v208, v96
  v_mfma_f32_16x16x32_bf16 a[76:79], a[164:167], v[188:191], a[76:79]
  v_exp_f32 v209, v97
  v_mfma_f32_16x16x32_bf16 a[16:19], a[168:171], v[168:171], a[16:19]
  ds_read_b128 a[136:139], v3 offset:10240
  v_add_f32 v227, v227, v219
  v_cvt_pk_bf16_f32 v181, v218, v219
  v_add_f32 v227, v227, v220
  v_add_f32 v227, v227, v221
  v_cvt_pk_bf16_f32 v182, v220, v221
  v_mfma_f32_16x16x32_bf16 a[20:23], a[168:171], v[172:175], a[20:23]
  v_exp_f32 v210, v98
  v_mfma_f32_16x16x32_bf16 a[80:83], a[168:171], v[184:187], a[80:83]
  v_exp_f32 v211, v99
  v_mfma_f32_16x16x32_bf16 a[84:87], a[168:171], v[188:191], a[84:87]
  v_exp_f32 v212, v100
  v_mfma_f32_16x16x32_bf16 a[24:27], a[172:175], v[168:171], a[24:27]
  ds_read_b128 a[140:143], v3 offset:11264
  v_add_f32 v227, v227, v222
  v_add_f32 v227, v227, v223
  v_cvt_pk_bf16_f32 v183, v222, v223
  v_add_f32 v224, v208, v209
  v_cvt_pk_bf16_f32 v160, v208, v209
  v_mfma_f32_16x16x32_bf16 a[28:31], a[172:175], v[172:175], a[28:31]
  v_exp_f32 v213, v101
  v_mfma_f32_16x16x32_bf16 a[88:91], a[172:175], v[184:187], a[88:91]
  buffer_load_dwordx4 v2, s[48:51], s27 offen offset:2048 sc1 lds
  v_add_f32 v224, v224, v210
  v_add_f32 v224, v224, v211
  v_cvt_pk_bf16_f32 v161, v210, v211
  v_mfma_f32_16x16x32_bf16 a[92:95], a[172:175], v[188:191], a[92:95]
  s_waitcnt lgkmcnt(4)
  v_exp_f32 v214, v102
  v_mfma_f32_16x16x32_bf16 a[32:35], a[176:179], v[168:171], a[32:35]
  ds_read_b128 a[144:147], v3 offset:12288
  v_exp_f32 v215, v103
  v_mfma_f32_16x16x32_bf16 a[36:39], a[176:179], v[172:175], a[36:39]
  v_exp_f32 v208, v104
  v_mfma_f32_16x16x32_bf16 a[96:99], a[176:179], v[184:187], a[96:99]
  v_exp_f32 v209, v105
  v_mfma_f32_16x16x32_bf16 a[100:103], a[176:179], v[188:191], a[100:103]
  v_exp_f32 v210, v106
  v_mfma_f32_16x16x32_bf16 a[40:43], a[180:183], v[168:171], a[40:43]
  ds_read_b128 a[148:151], v3 offset:13312
  v_add_f32 v224, v224, v212
  v_add_f32 v224, v224, v213
  v_cvt_pk_bf16_f32 v162, v212, v213
  v_add_f32 v224, v224, v214
  v_add_f32 v224, v224, v215
  v_cvt_pk_bf16_f32 v163, v214, v215
  v_mfma_f32_16x16x32_bf16 a[44:47], a[180:183], v[172:175], a[44:47]
  v_exp_f32 v211, v107
  v_mfma_f32_16x16x32_bf16 a[104:107], a[180:183], v[184:187], a[104:107]
  v_exp_f32 v212, v108
  v_mfma_f32_16x16x32_bf16 a[108:111], a[180:183], v[188:191], a[108:111]
  v_exp_f32 v213, v109
  v_mfma_f32_16x16x32_bf16 a[48:51], a[184:187], v[168:171], a[48:51]
  ds_read_b128 a[152:155], v3 offset:14336
  v_add_f32 v225, v208, v209
  v_cvt_pk_bf16_f32 v164, v208, v209
  v_add_f32 v225, v225, v210
  v_add_f32 v225, v225, v211
  v_cvt_pk_bf16_f32 v165, v210, v211
  v_mfma_f32_16x16x32_bf16 a[52:55], a[184:187], v[172:175], a[52:55]
  v_exp_f32 v214, v110
  v_mfma_f32_16x16x32_bf16 a[112:115], a[184:187], v[184:187], a[112:115]
  buffer_load_dwordx4 v2, s[48:51], s27 offen offset:3072 sc1 lds
  v_max3_f32 v5, v226, v227, v224
  v_add_f32 v225, v225, v212
  v_add_f32 v225, v225, v213
  v_mfma_f32_16x16x32_bf16 a[116:119], a[184:187], v[188:191], a[116:119]
  s_add_u32 s27, s27, 16384
  v_exp_f32 v215, v111
  v_mfma_f32_16x16x32_bf16 a[56:59], a[188:191], v[168:171], a[56:59]
  s_add_u32 s25, s25, 32768
  ds_read_b128 a[156:159], v3 offset:15360
  v_cvt_pk_bf16_f32 v166, v212, v213
  v_add_f32 v225, v225, v214
  v_add_f32 v225, v225, v215
  v_max_f32 v5, v5, v225
  v_cmp_lt_f32 vcc, s81, v5
  v_mfma_f32_16x16x32_bf16 a[60:63], a[188:191], v[172:175], a[60:63]
  s_and_b32 s25, s25, 0x1ffff
  v_exp_f32 v216, v144
  v_mfma_f32_16x16x32_bf16 a[120:123], a[188:191], v[184:187], a[120:123]
  s_waitcnt lgkmcnt(4)
  v_cvt_pk_bf16_f32 v167, v214, v215
  v_add_u32 v3, s66, v2
  v_mfma_f32_16x16x32_bf16 a[124:127], a[188:191], v[188:191], a[124:127]
  s_cbranch_vccnz fa_stub5
fa_back5:
  v_exp_f32 v217, v145
  v_add_f32 v228, v228, v224
  v_add_f32 v229, v229, v225
  v_add_f32 v230, v230, v226
  v_add_f32 v231, v231, v227
fa_AV:
  v_mfma_f32_16x16x32_bf16 v[128:131], a[128:131], v[64:67], v[200:203]
  s_waitcnt vmcnt(12)
  v_exp_f32 v218, v146
  v_mfma_f32_16x16x32_bf16 v[136:139], a[128:131], v[68:71], v[204:207]
  s_barrier
  v_exp_f32 v219, v147
  v_mfma_f32_16x16x32_bf16 v[132:135], a[132:135], v[64:67], v[200:203]
  ds_read_b128 a[160:163], v3 offset:16384
  ds_read_b128 a[164:167], v3 offset:17408
  v_add_f32 v226, v216, v217
  v_mfma_f32_16x16x32_bf16 v[140:143], a[132:135], v[68:71], v[204:207]
  v_exp_f32 v220, v148
  v_mfma_f32_16x16x32_bf16 v[128:131], a[136:139], v[72:75], v[128:131]
  ds_read_b128 a[168:171], v3 offset:18432
  v_cvt_pk_bf16_f32 v184, v216, v217
  v_mfma_f32_16x16x32_bf16 v[136:139], a[136:139], v[76:79], v[136:139]
  s_mov_b32 m0, s24
  v_exp_f32 v221, v149
  v_mfma_f32_16x16x32_bf16 v[132:135], a[140:143], v[72:75], v[132:135]
  ds_read_b128 a[172:175], v3 offset:19456
  buffer_load_dwordx4 v2, s[44:47], s26 offen offset:0 sc1 lds
  v_add_f32 v226, v226, v218
  v_mfma_f32_16x16x32_bf16 v[140:143], a[140:143], v[76:79], v[140:143]
  s_waitcnt lgkmcnt(4)
  v_exp_f32 v222, v150
  v_mfma_f32_16x16x32_bf16 v[128:131], a[144:147], v[80:83], v[128:131]
  ds_read_b128 a[176:179], v3 offset:20480
  v_add_f32 v226, v226, v219
  v_mfma_f32_16x16x32_bf16 v[136:139], a[144:147], v[84:87], v[136:139]
  v_exp_f32 v223, v151
  v_mfma_f32_16x16x32_bf16 v[132:135], a[148:151], v[80:83], v[132:135]
  ds_read_b128 a[180:183], v3 offset:21504
  v_cvt_pk_bf16_f32 v185, v218, v219
  v_mfma_f32_16x16x32_bf16 v[140:143], a[148:151], v[84:87], v[140:143]
  v_add_f32 v226, v226, v220
  v_add_f32 v226, v226, v221
  v_mfma_f32_16x16x32_bf16 v[128:131], a[152:155], v[88:91], v[128:131]
  ds_read_b128 a[184:187], v3 offset:22528
  v_cvt_pk_bf16_f32 v186, v220, v221
  v_mfma_f32_16x16x32_bf16 v[136:139], a[152:155], v[92:95], v[136:139]
  v_exp_f32 v216, v152
  v_mfma_f32_16x16x32_bf16 v[132:135], a[156:159], v[88:91], v[132:135]
  ds_read_b128 a[188:191], v3 offset:23552
  v_add_f32 v226, v226, v222
  v_mfma_f32_16x16x32_bf16 v[140:143], a[156:159], v[92:95], v[140:143]
  s_waitcnt lgkmcnt(4)
  v_exp_f32 v217, v153
  v_mfma_f32_16x16x32_bf16 a[0:3], a[160:163], v[160:163], a[0:3]
  ds_read_b128 a[128:131], v3 offset:0
  v_add_f32 v226, v226, v223
  v_mfma_f32_16x16x32_bf16 a[4:7], a[160:163], v[164:167], a[4:7]
  v_exp_f32 v218, v154
  v_mfma_f32_16x16x32_bf16 a[64:67], a[160:163], v[176:179], a[64:67]
  buffer_load_dwordx4 v2, s[44:47], s26 offen offset:1024 sc1 lds
  v_cvt_pk_bf16_f32 v187, v222, v223
  v_mfma_f32_16x16x32_bf16 a[68:71], a[160:163], v[180:183], a[68:71]
  v_exp_f32 v219, v155
  v_mfma_f32_16x16x32_bf16 a[8:11], a[164:167], v[160:163], a[8:11]
  ds_read_b128 a[132:135], v3 offset:1024
  v_add_f32 v227, v216, v217
  v_mfma_f32_16x16x32_bf16 a[12:15], a[164:167], v[164:167], a[12:15]
  v_exp_f32 v220, v156
  v_mfma_f32_16x16x32_bf16 a[72:75], a[164:167], v[176:179], a[72:75]
  v_exp_f32 v221, v157
  v_mfma_f32_16x16x32_bf16 a[76:79], a[164:167], v[180:183], a[76:79]
  v_cvt_pk_bf16_f32 v188, v216, v217
  v_add_f32 v227, v227, v218
  v_mfma_f32_16x16x32_bf16 a[16:19], a[168:171], v[160:163], a[16:19]
  ds_read_b128 a[136:139], v3 offset:2048
  v_add_f32 v227, v227, v219
  v_mfma_f32_16x16x32_bf16 a[20:23], a[168:171], v[164:167], a[20:23]
  v_exp_f32 v222, v158
  v_mfma_f32_16x16x32_bf16 a[80:83], a[168:171], v[176:179], a[80:83]
  v_exp_f32 v223, v159
  v_mfma_f32_16x16x32_bf16 a[84:87], a[168:171], v[180:183], a[84:87]
  v_cvt_pk_bf16_f32 v189, v218, v219
  v_add_f32 v227, v227, v220
  v_mfma_f32_16x16x32_bf16 a[24:27], a[172:175], v[160:163], a[24:27]
  ds_read_b128 a[140:143], v3 offset:3072
  v_add_f32 v227, v227, v221
  v_mfma_f32_16x16x32_bf16 a[28:31], a[172:175], v[164:167], a[28:31]
  v_cvt_pk_bf16_f32 v190, v220, v221
  v_add_f32 v227, v227, v222
  v_mfma_f32_16x16x32_bf16 a[88:91], a[172:175], v[176:179], a[88:91]
  buffer_load_dwordx4 v2, s[44:47], s26 offen offset:2048 sc1 lds
  v_add_f32 v227, v227, v223
  v_mfma_f32_16x16x32_bf16 a[92:95], a[172:175], v[180:183], a[92:95]
  s_waitcnt lgkmcnt(4)
  v_max_f32 v5, v226, v227
  v_cmp_lt_f32 vcc, s81, v5
  v_mfma_f32_16x16x32_bf16 a[32:35], a[176:179], v[160:163], a[32:35]
  ds_read_b128 a[144:147], v3 offset:4096
  v_mfma_f32_16x16x32_bf16 a[36:39], a[176:179], v[164:167], a[36:39]
  v_mfma_f32_16x16x32_bf16 a[96:99], a[176:179], v[176:179], a[96:99]
  v_mfma_f32_16x16x32_bf16 a[100:103], a[176:179], v[180:183], a[100:103]
  v_mfma_f32_16x16x32_bf16 a[40:43], a[180:183], v[160:163], a[40:43]
  ds_read_b128 a[148:151], v3 offset:5120
  v_mfma_f32_16x16x32_bf16 a[44:47], a[180:183], v[164:167], a[44:47]
  v_mfma_f32_16x16x32_bf16 a[104:107], a[180:183], v[176:179], a[104:107]
  v_mfma_f32_16x16x32_bf16 a[108:111], a[180:183], v[180:183], a[108:111]
  v_mfma_f32_16x16x32_bf16 a[48:51], a[184:187], v[160:163], a[48:51]
  ds_read_b128 a[152:155], v3 offset:6144
  v_mfma_f32_16x16x32_bf16 a[52:55], a[184:187], v[164:167], a[52:55]
  v_mfma_f32_16x16x32_bf16 a[112:115], a[184:187], v[176:179], a[112:115]
  buffer_load_dwordx4 v2, s[44:47], s26 offen offset:3072 sc1 lds
  v_mfma_f32_16x16x32_bf16 a[116:119], a[184:187], v[180:183], a[116:119]
  s_add_u32 s26, s26, 16384
  v_mfma_f32_16x16x32_bf16 a[56:59], a[188:191], v[160:163], a[56:59]
  s_add_u32 s24, s24, 32768
  ds_read_b128 a[156:159], v3 offset:7168
  v_mfma_f32_16x16x32_bf16 a[60:63], a[188:191], v[164:167], a[60:63]
  s_and_b32 s24, s24, 0x1ffff
  v_exp_f32 v216, v128
  v_mfma_f32_16x16x32_bf16 a[120:123], a[188:191], v[176:179], a[120:123]
  s_waitcnt lgkmcnt(4)
  v_cvt_pk_bf16_f32 v191, v222, v223
  v_mfma_f32_16x16x32_bf16 a[124:127], a[188:191], v[180:183], a[124:127]
  s_cbranch_vccnz fa_stub6
fa_back6:
  v_exp_f32 v217, v129
  v_add_f32 v230, v230, v226
  v_add_f32 v231, v231, v227
  v_mfma_f32_16x16x32_bf16 v[144:147], a[128:131], v[64:67], v[200:203]
  ds_read_b128 a[160:163], v3 offset:24576
  v_add_f32 v226, v216, v217
  v_mfma_f32_16x16x32_bf16 v[152:155], a[128:131], v[68:71], v[204:207]
  v_exp_f32 v218, v130
  v_mfma_f32_16x16x32_bf16 v[148:151], a[132:135], v[64:67], v[200:203]
  s_add_u32 s66, s66, 32768
  ds_read_b128 a[164:167], v3 offset:25600
  v_cvt_pk_bf16_f32 v176, v216, v217
  v_mfma_f32_16x16x32_bf16 v[156:159], a[132:135], v[68:71], v[204:207]
  s_mov_b32 m0, s25
  v_exp_f32 v219, v131
  v_mfma_f32_16x16x32_bf16 v[144:147], a[136:139], v[72:75], v[144:147]
  s_and_b32 s66, s66, 0x1ffff
  ds_read_b128 a[168:171], v3 offset:26624
  buffer_load_dwordx4 v2, s[48:51], s27 offen offset:0 sc1 lds
  v_add_f32 v226, v226, v218
  v_add_f32 v226, v226, v219
  v_mfma_f32_16x16x32_bf16 v[152:155], a[136:139], v[76:79], v[152:155]
  v_exp_f32 v220, v132
  v_mfma_f32_16x16x32_bf16 v[148:151], a[140:143], v[72:75], v[148:151]
  ds_read_b128 a[172:175], v3 offset:27648
  v_cvt_pk_bf16_f32 v177, v218, v219
  v_mfma_f32_16x16x32_bf16 v[156:159], a[140:143], v[76:79], v[156:159]
  s_waitcnt lgkmcnt(4)
  v_exp_f32 v221, v133
  v_mfma_f32_16x16x32_bf16 v[144:147], a[144:147], v[80:83], v[144:147]
  ds_read_b128 a[176:179], v3 offset:28672
  v_add_f32 v226, v226, v220
  v_mfma_f32_16x16x32_bf16 v[152:155], a[144:147], v[84:87], v[152:155]
  v_exp_f32 v222, v134
  v_mfma_f32_16x16x32_bf16 v[148:151], a[148:151], v[80:83], v[148:151]
  ds_read_b128 a[180:183], v3 offset:29696
  buffer_load_dwordx4 v2, s[48:51], s27 offen offset:1024 sc1 lds
  v_add_f32 v226, v226, v221
  v_cvt_pk_bf16_f32 v178, v220, v221
  v_mfma_f32_16x16x32_bf16 v[156:159], a[148:151], v[84:87], v[156:159]
  v_exp_f32 v223, v135
  v_mfma_f32_16x16x32_bf16 v[144:147], a[152:155], v[88:91], v[144:147]
  ds_read_b128 a[184:187], v3 offset:30720
  v_add_f32 v226, v226, v222
  v_mfma_f32_16x16x32_bf16 v[152:155], a[152:155], v[92:95], v[152:155]
  v_exp_f32 v216, v136
  v_mfma_f32_16x16x32_bf16 v[148:151], a[156:159], v[88:91], v[148:151]
  ds_read_b128 a[188:191], v3 offset:31744
  v_add_f32 v226, v226, v223
  v_exp_f32 v217, v137
  v_mfma_f32_16x16x32_bf16 v[156:159], a[156:159], v[92:95], v[156:159]
  s_waitcnt lgkmcnt(4)
  v_exp_f32 v218, v138
  v_mfma_f32_16x16x32_bf16 a[64:67], a[160:163], v[184:187], a[64:67]
  ds_read_b128 a[128:131], v3 offset:8192
  v_cvt_pk_bf16_f32 v179, v222, v223
  v_mfma_f32_16x16x32_bf16 a[68:71], a[160:163], v[188:191], a[68:71]
  v_exp_f32 v219, v139
  v_mfma_f32_16x16x32_bf16 a[72:75], a[164:167], v[184:187], a[72:75]
  ds_read_b128 a[132:135], v3 offset:9216
  buffer_load_dwordx4 v2, s[48:51], s27 offen offset:2048 sc1 lds
  v_add_f32 v227, v216, v217
  v_mfma_f32_16x16x32_bf16 a[76:79], a[164:167], v[188:191], a[76:79]
  v_exp_f32 v220, v140
  v_mfma_f32_16x16x32_bf16 a[80:83], a[168:171], v[184:187], a[80:83]
  ds_read_b128 a[136:139], v3 offset:10240
  v_cvt_pk_bf16_f32 v180, v216, v217
  v_mfma_f32_16x16x32_bf16 a[84:87], a[168:171], v[188:191], a[84:87]
  v_exp_f32 v221, v141
  v_mfma_f32_16x16x32_bf16 a[88:91], a[172:175], v[184:187], a[88:91]
  ds_read_b128 a[140:143], v3 offset:11264
  v_add_f32 v227, v227, v218
  v_mfma_f32_16x16x32_bf16 a[92:95], a[172:175], v[188:191], a[92:95]
  s_waitcnt lgkmcnt(4)
  v_exp_f32 v222, v142
  v_mfma_f32_16x16x32_bf16 a[96:99], a[176:179], v[184:187], a[96:99]
  ds_read_b128 a[144:147], v3 offset:12288
  buffer_load_dwordx4 v2, s[48:51], s27 offen offset:3072 sc1 lds
  v_add_f32 v227, v227, v219
  v_cvt_pk_bf16_f32 v181, v218, v219
  v_mfma_f32_16x16x32_bf16 a[100:103], a[176:179], v[188:191], a[100:103]
  s_add_u32 s27, s27, 16384
  v_exp_f32 v223, v143
  v_mfma_f32_16x16x32_bf16 a[104:107], a[180:183], v[184:187], a[104:107]
  s_add_u32 s25, s25, 32768
  ds_read_b128 a[148:151], v3 offset:13312
  v_add_f32 v227, v227, v220
  v_mfma_f32_16x16x32_bf16 a[108:111], a[180:183], v[188:191], a[108:111]
  s_and_b32 s25, s25, 0x1ffff
  v_add_f32 v227, v227, v221
  v_cvt_pk_bf16_f32 v182, v220, v221
  v_add_f32 v227, v227, v222
  v_mfma_f32_16x16x32_bf16 a[112:115], a[184:187], v[184:187], a[112:115]
  ds_read_b128 a[152:155], v3 offset:14336
  v_add_f32 v227, v227, v223
  v_max_f32 v5, v226, v227
  v_cmp_lt_f32 vcc, s81, v5
  v_mfma_f32_16x16x32_bf16 a[116:119], a[184:187], v[188:191], a[116:119]
  v_exp_f32 v216, v144
  v_mfma_f32_16x16x32_bf16 a[120:123], a[188:191], v[184:187], a[120:123]
  s_waitcnt lgkmcnt(3)
  ds_read_b128 a[156:159], v3 offset:15360
  v_cvt_pk_bf16_f32 v183, v222, v223
  v_add_u32 v3, s66, v2
  v_mfma_f32_16x16x32_bf16 a[124:127], a[188:191], v[188:191], a[124:127]
  s_cbranch_vccnz fa_stub7
fa_back7:
  v_exp_f32 v217, v145
  v_add_f32 v230, v230, v226
  v_add_f32 v231, v231, v227
  s_branch fa_SSpre
fa_Aodd:
  v_mfma_f32_16x16x32_bf16 v[128:131], a[128:131], v[64:67], v[200:203]
  s_waitcnt vmcnt(12)
  v_exp_f32 v218, v146
  v_add_f32 v226, v216, v217
  v_mfma_f32_16x16x32_bf16 v[136:139], a[128:131], v[68:71], v[204:207]
  s_barrier
  v_exp_f32 v219, v147
  v_cvt_pk_bf16_f32 v184, v216, v217
  v_mfma_f32_16x16x32_bf16 v[132:135], a[132:135], v[64:67], v[200:203]
  ds_read_b128 a[160:163], v3 offset:16384
  ds_read_b128 a[164:167], v3 offset:17408
  v_exp_f32 v220, v148
  v_mfma_f32_16x16x32_bf16 v[140:143], a[132:135], v[68:71], v[204:207]
  v_exp_f32 v221, v149
  v_add_f32 v226, v226, v218
  v_mfma_f32_16x16x32_bf16 v[128:131], a[136:139], v[72:75], v[128:131]
  ds_read_b128 a[168:171], v3 offset:18432
  v_add_f32 v226, v226, v219
  v_cvt_pk_bf16_f32 v185, v218, v219
  v_mfma_f32_16x16x32_bf16 v[136:139], a[136:139], v[76:79], v[136:139]
  s_mov_b32 m0, s24
  v_exp_f32 v222, v150
  v_add_f32 v226, v226, v220
  v_mfma_f32_16x16x32_bf16 v[132:135], a[140:143], v[72:75], v[132:135]
  ds_read_b128 a[172:175], v3 offset:19456
  buffer_load_dwordx4 v2, s[44:47], s26 offen offset:0 sc1 lds
  v_add_f32 v226, v226, v221
  v_cvt_pk_bf16_f32 v186, v220, v221
  v_mfma_f32_16x16x32_bf16 v[140:143], a[140:143], v[76:79], v[140:143]
  s_waitcnt lgkmcnt(4)
  v_exp_f32 v223, v151
  v_cndmask_b32 v112, v4, v112, s[68:69]
  v_mfma_f32_16x16x32_bf16 v[128:131], a[144:147], v[80:83], v[128:131]
  ds_read_b128 a[176:179], v3 offset:20480
  v_cndmask_b32 v113, v4, v113, s[70:71]
  v_cndmask_b32 v114, v4, v114, s[72:73]
  v_mfma_f32_16x16x32_bf16 v[136:139], a[144:147], v[84:87], v[136:139]
  v_exp_f32 v216, v152
  v_cndmask_b32 v115, v4, v115, s[74:75]
  v_mfma_f32_16x16x32_bf16 v[132:135], a[148:151], v[80:83], v[132:135]
  ds_read_b128 a[180:183], v3 offset:21504
  v_mov_b32 v116, v4
  v_mov_b32 v117, v4
  v_mfma_f32_16x16x32_bf16 v[140:143], a[148:151], v[84:87], v[140:143]
  v_exp_f32 v217, v153
  v_mov_b32 v118, v4
  v_mfma_f32_16x16x32_bf16 v[128:131], a[152:155], v[88:91], v[128:131]
  ds_read_b128 a[184:187], v3 offset:22528
  v_mov_b32 v119, v4
  v_cndmask_b32 v124, v4, v124, s[68:69]
  v_mfma_f32_16x16x32_bf16 v[136:139], a[152:155], v[92:95], v[136:139]
  v_exp_f32 v218, v154
  v_cndmask_b32 v125, v4, v125, s[70:71]
  v_mfma_f32_16x16x32_bf16 v[132:135], a[156:159], v[88:91], v[132:135]
  ds_read_b128 a[188:191], v3 offset:23552
  v_cndmask_b32 v126, v4, v126, s[72:73]
  v_cndmask_b32 v127, v4, v127, s[74:75]
  v_mfma_f32_16x16x32_bf16 v[140:143], a[156:159], v[92:95], v[140:143]
  s_waitcnt lgkmcnt(4)
  v_exp_f32 v219, v155
  v_add_f32 v226, v226, v222
  v_mfma_f32_16x16x32_bf16 a[0:3], a[160:163], v[160:163], a[0:3]
  ds_read_b128 a[128:131], v3 offset:0
  v_add_f32 v226, v226, v223
  v_cvt_pk_bf16_f32 v187, v222, v223
  v_mfma_f32_16x16x32_bf16 a[4:7], a[160:163], v[164:167], a[4:7]
  v_exp_f32 v220, v156
  v_add_f32 v227, v216, v217
  v_mfma_f32_16x16x32_bf16 a[64:67], a[160:163], v[176:179], a[64:67]
  buffer_load_dwordx4 v2, s[44:47], s26 offen offset:1024 sc1 lds
  v_exp_f32 v221, v157
  v_mfma_f32_16x16x32_bf16 a[68:71], a[160:163], v[180:183], a[68:71]
  v_exp_f32 v222, v158
  v_mfma_f32_16x16x32_bf16 a[8:11], a[164:167], v[160:163], a[8:11]
  ds_read_b128 a[132:135], v3 offset:1024
  v_cvt_pk_bf16_f32 v188, v216, v217
  v_add_f32 v227, v227, v218
  v_add_f32 v227, v227, v219
  v_mfma_f32_16x16x32_bf16 a[12:15], a[164:167], v[164:167], a[12:15]
  v_exp_f32 v223, v159
  v_mfma_f32_16x16x32_bf16 a[72:75], a[164:167], v[176:179], a[72:75]
  v_exp_f32 v208, v112
  v_mfma_f32_16x16x32_bf16 a[76:79], a[164:167], v[180:183], a[76:79]
  v_exp_f32 v209, v113
  v_mfma_f32_16x16x32_bf16 a[16:19], a[168:171], v[160:163], a[16:19]
  ds_read_b128 a[136:139], v3 offset:2048
  v_cvt_pk_bf16_f32 v189, v218, v219
  v_add_f32 v227, v227, v220
  v_add_f32 v227, v227, v221
  v_cvt_pk_bf16_f32 v190, v220, v221
  v_add_f32 v227, v227, v222
  v_mfma_f32_16x16x32_bf16 a[20:23], a[168:171], v[164:167], a[20:23]
  v_exp_f32 v210, v114
  v_mfma_f32_16x16x32_bf16 a[80:83], a[168:171], v[176:179], a[80:83]
  v_exp_f32 v211, v115
  v_mfma_f32_16x16x32_bf16 a[84:87], a[168:171], v[180:183], a[84:87]
  v_exp_f32 v212, v116
  v_mfma_f32_16x16x32_bf16 a[24:27], a[172:175], v[160:163], a[24:27]
  ds_read_b128 a[140:143], v3 offset:3072
  v_add_f32 v227, v227, v223
  v_cvt_pk_bf16_f32 v191, v222, v223
  v_add_f32 v224, v208, v209
  v_cvt_pk_bf16_f32 v168, v208, v209
  v_add_f32 v224, v224, v210
  v_mfma_f32_16x16x32_bf16 a[28:31], a[172:175], v[164:167], a[28:31]
  v_exp_f32 v213, v117
  v_mfma_f32_16x16x32_bf16 a[88:91], a[172:175], v[176:179], a[88:91]
  buffer_load_dwordx4 v2, s[44:47], s26 offen offset:2048 sc1 lds
  v_exp_f32 v214, v118
  v_mfma_f32_16x16x32_bf16 a[92:95], a[172:175], v[180:183], a[92:95]
  s_waitcnt lgkmcnt(4)
  v_exp_f32 v215, v119
  v_mfma_f32_16x16x32_bf16 a[32:35], a[176:179], v[160:163], a[32:35]
  ds_read_b128 a[144:147], v3 offset:4096
  v_add_f32 v224, v224, v211
  v_cvt_pk_bf16_f32 v169, v210, v211
  v_add_f32 v224, v224, v212
  v_add_f32 v224, v224, v213
  v_mfma_f32_16x16x32_bf16 a[36:39], a[176:179], v[164:167], a[36:39]
  v_exp_f32 v208, v120
  v_mfma_f32_16x16x32_bf16 a[96:99], a[176:179], v[176:179], a[96:99]
  v_exp_f32 v209, v121
  v_mfma_f32_16x16x32_bf16 a[100:103], a[176:179], v[180:183], a[100:103]
  v_exp_f32 v210, v122
  v_mfma_f32_16x16x32_bf16 a[40:43], a[180:183], v[160:163], a[40:43]
  ds_read_b128 a[148:151], v3 offset:5120
  v_cvt_pk_bf16_f32 v170, v212, v213
  v_add_f32 v224, v224, v214
  v_add_f32 v224, v224, v215
  v_cvt_pk_bf16_f32 v171, v214, v215
  v_add_f32 v225, v208, v209
  v_mfma_f32_16x16x32_bf16 a[44:47], a[180:183], v[164:167], a[44:47]
  v_exp_f32 v211, v123
  v_mfma_f32_16x16x32_bf16 a[104:107], a[180:183], v[176:179], a[104:107]
  v_exp_f32 v212, v124
  v_mfma_f32_16x16x32_bf16 a[108:111], a[180:183], v[180:183], a[108:111]
  v_exp_f32 v213, v125
  v_mfma_f32_16x16x32_bf16 a[48:51], a[184:187], v[160:163], a[48:51]
  ds_read_b128 a[152:155], v3 offset:6144
  v_cvt_pk_bf16_f32 v172, v208, v209
  v_add_f32 v225, v225, v210
  v_add_f32 v225, v225, v211
  v_cvt_pk_bf16_f32 v173, v210, v211
  v_max3_f32 v5, v226, v227, v224
  v_mfma_f32_16x16x32_bf16 a[52:55], a[184:187], v[164:167], a[52:55]
  v_exp_f32 v214, v126
  v_mfma_f32_16x16x32_bf16 a[112:115], a[184:187], v[176:179], a[112:115]
  buffer_load_dwordx4 v2, s[44:47], s26 offen offset:3072 sc1 lds
  v_add_f32 v225, v225, v212
  v_add_f32 v225, v225, v213
  v_cvt_pk_bf16_f32 v174, v212, v213
  v_mfma_f32_16x16x32_bf16 a[116:119], a[184:187], v[180:183], a[116:119]
  s_add_u32 s26, s26, 16384
  v_exp_f32 v215, v127
  v_mfma_f32_16x16x32_bf16 a[56:59], a[188:191], v[160:163], a[56:59]
  s_add_u32 s24, s24, 32768
  ds_read_b128 a[156:159], v3 offset:7168
  v_add_f32 v225, v225, v214
  v_add_f32 v225, v225, v215
  v_max_f32 v5, v5, v225
  v_cmp_lt_f32 vcc, s81, v5
  v_mfma_f32_16x16x32_bf16 a[60:63], a[188:191], v[164:167], a[60:63]
  s_and_b32 s24, s24, 0x1ffff
  v_exp_f32 v216, v128
  v_mfma_f32_16x16x32_bf16 a[120:123], a[188:191], v[176:179], a[120:123]
  s_waitcnt lgkmcnt(4)
  v_cvt_pk_bf16_f32 v175, v214, v215
  v_mfma_f32_16x16x32_bf16 a[124:127], a[188:191], v[180:183], a[124:127]
  s_cbranch_vccnz fa_stub8
fa_back8:
  v_exp_f32 v217, v129
  v_add_f32 v228, v228, v224
  v_add_f32 v229, v229, v225
  v_add_f32 v230, v230, v226
  v_add_f32 v231, v231, v227
  v_mfma_f32_16x16x32_bf16 v[144:147], a[128:131], v[64:67], v[200:203]
  ds_read_b128 a[160:163], v3 offset:24576
  v_add_f32 v226, v216, v217
  v_mfma_f32_16x16x32_bf16 v[152:155], a[128:131], v[68:71], v[204:207]
  v_exp_f32 v218, v130
  v_mfma_f32_16x16x32_bf16 v[148:151], a[132:135], v[64:67], v[200:203]
  s_add_u32 s66, s66, 32768
  ds_read_b128 a[164:167], v3 offset:25600
  v_cvt_pk_bf16_f32 v176, v216, v217
  v_mfma_f32_16x16x32_bf16 v[156:159], a[132:135], v[68:71], v[204:207]
  s_and_b32 s66, s66, 0x1ffff
  v_exp_f32 v219, v131
  v_mfma_f32_16x16x32_bf16 v[144:147], a[136:139], v[72:75], v[144:147]
  ds_read_b128 a[168:171], v3 offset:26624
  v_add_f32 v226, v226, v218
  v_mfma_f32_16x16x32_bf16 v[152:155], a[136:139], v[76:79], v[152:155]
  s_mov_b32 m0, s25
  v_exp_f32 v220, v132
  v_mfma_f32_16x16x32_bf16 v[148:151], a[140:143], v[72:75], v[148:151]
  ds_read_b128 a[172:175], v3 offset:27648
  buffer_load_dwordx4 v2, s[48:51], s27 offen offset:0 sc1 lds
  v_add_f32 v226, v226, v219
  v_mfma_f32_16x16x32_bf16 v[156:159], a[140:143], v[76:79], v[156:159]
  s_waitcnt lgkmcnt(4)
  v_exp_f32 v221, v133
  v_mfma_f32_16x16x32_bf16 v[144:147], a[144:147], v[80:83], v[144:147]
  ds_read_b128 a[176:179], v3 offset:28672
  v_cvt_pk_bf16_f32 v177, v218, v219
  v_mfma_f32_16x16x32_bf16 v[152:155], a[144:147], v[84:87], v[152:155]
  v_exp_f32 v222, v134
  v_mfma_f32_16x16x32_bf16 v[148:151], a[148:151], v[80:83], v[148:151]
  ds_read_b128 a[180:183], v3 offset:29696
  v_add_f32 v226, v226, v220
  v_mfma_f32_16x16x32_bf16 v[156:159], a[148:151], v[84:87], v[156:159]
  v_exp_f32 v223, v135
  v_mfma_f32_16x16x32_bf16 v[144:147], a[152:155], v[88:91], v[144:147]
  ds_read_b128 a[184:187], v3 offset:30720
  v_add_f32 v226, v226, v221
  v_mfma_f32_16x16x32_bf16 v[152:155], a[152:155], v[92:95], v[152:155]
  v_exp_f32 v216, v136
  v_mfma_f32_16x16x32_bf16 v[148:151], a[156:159], v[88:91], v[148:151]
  ds_read_b128 a[188:191], v3 offset:31744
  v_cvt_pk_bf16_f32 v178, v220, v221
  v_mfma_f32_16x16x32_bf16 v[156:159], a[156:159], v[92:95], v[156:159]
  s_waitcnt lgkmcnt(4)
  v_exp_f32 v217, v137
  v_mfma_f32_16x16x32_bf16 a[0:3], a[160:163], v[168:171], a[0:3]
  ds_read_b128 a[128:131], v3 offset:8192
  v_add_f32 v226, v226, v222
  v_mfma_f32_16x16x32_bf16 a[4:7], a[160:163], v[172:175], a[4:7]
  v_exp_f32 v218, v138
  v_mfma_f32_16x16x32_bf16 a[64:67], a[160:163], v[184:187], a[64:67]
  buffer_load_dwordx4 v2, s[48:51], s27 offen offset:1024 sc1 lds
  v_add_f32 v226, v226, v223
  v_mfma_f32_16x16x32_bf16 a[68:71], a[160:163], v[188:191], a[68:71]
  v_exp_f32 v219, v139
  v_mfma_f32_16x16x32_bf16 a[8:11], a[164:167], v[168:171], a[8:11]
  ds_read_b128 a[132:135], v3 offset:9216
  v_cvt_pk_bf16_f32 v179, v222, v223
  v_mfma_f32_16x16x32_bf16 a[12:15], a[164:167], v[172:175], a[12:15]
  v_exp_f32 v220, v140
  v_mfma_f32_16x16x32_bf16 a[72:75], a[164:167], v[184:187], a[72:75]
  v_add_f32 v227, v216, v217
  v_cvt_pk_bf16_f32 v180, v216, v217
  v_mfma_f32_16x16x32_bf16 a[76:79], a[164:167], v[188:191], a[76:79]
  v_exp_f32 v221, v141
  v_mfma_f32_16x16x32_bf16 a[16:19], a[168:171], v[168:171], a[16:19]
  ds_read_b128 a[136:139], v3 offset:10240
  v_add_f32 v227, v227, v218
  v_mfma_f32_16x16x32_bf16 a[20:23], a[168:171], v[172:175], a[20:23]
  v_exp_f32 v222, v142
  v_mfma_f32_16x16x32_bf16 a[80:83], a[168:171], v[184:187], a[80:83]
  v_add_f32 v227, v227, v219
  v_cvt_pk_bf16_f32 v181, v218, v219
  v_mfma_f32_16x16x32_bf16 a[84:87], a[168:171], v[188:191], a[84:87]
  v_exp_f32 v223, v143
  v_mfma_f32_16x16x32_bf16 a[24:27], a[172:175], v[168:171], a[24:27]
  ds_read_b128 a[140:143], v3 offset:11264
  v_add_f32 v227, v227, v220
  v_mfma_f32_16x16x32_bf16 a[28:31], a[172:175], v[172:175], a[28:31]
  v_add_f32 v227, v227, v221
  v_cvt_pk_bf16_f32 v182, v220, v221
  v_mfma_f32_16x16x32_bf16 a[88:91], a[172:175], v[184:187], a[88:91]
  buffer_load_dwordx4 v2, s[48:51], s27 offen offset:2048 sc1 lds
  v_add_f32 v227, v227, v222
  v_mfma_f32_16x16x32_bf16 a[92:95], a[172:175], v[188:191], a[92:95]
  s_waitcnt lgkmcnt(4)
  v_add_f32 v227, v227, v223
  v_max_f32 v5, v226, v227
  v_mfma_f32_16x16x32_bf16 a[32:35], a[176:179], v[168:171], a[32:35]
  ds_read_b128 a[144:147], v3 offset:12288
  v_cmp_lt_f32 vcc, s81, v5
  v_mfma_f32_16x16x32_bf16 a[36:39], a[176:179], v[172:175], a[36:39]
  v_mfma_f32_16x16x32_bf16 a[96:99], a[176:179], v[184:187], a[96:99]
  v_mfma_f32_16x16x32_bf16 a[100:103], a[176:179], v[188:191], a[100:103]
  v_mfma_f32_16x16x32_bf16 a[40:43], a[180:183], v[168:171], a[40:43]
  ds_read_b128 a[148:151], v3 offset:13312
  v_mfma_f32_16x16x32_bf16 a[44:47], a[180:183], v[172:175], a[44:47]
  v_mfma_f32_16x16x32_bf16 a[104:107], a[180:183], v[184:187], a[104:107]
  v_mfma_f32_16x16x32_bf16 a[108:111], a[180:183], v[188:191], a[108:111]
  v_mfma_f32_16x16x32_bf16 a[48:51], a[184:187], v[168:171], a[48:51]
  ds_read_b128 a[152:155], v3 offset:14336
  v_mfma_f32_16x16x32_bf16 a[52:55], a[184:187], v[172:175], a[52:55]
  v_mfma_f32_16x16x32_bf16 a[112:115], a[184:187], v[184:187], a[112:115]
  buffer_load_dwordx4 v2, s[48:51], s27 offen offset:3072 sc1 lds
  v_mfma_f32_16x16x32_bf16 a[116:119], a[184:187], v[188:191], a[116:119]
  s_add_u32 s27, s27, 16384
  v_mfma_f32_16x16x32_bf16 a[56:59], a[188:191], v[168:171], a[56:59]
  s_add_u32 s25, s25, 32768
  ds_read_b128 a[156:159], v3 offset:15360
  v_mfma_f32_16x16x32_bf16 a[60:63], a[188:191], v[172:175], a[60:63]
  s_and_b32 s25, s25, 0x1ffff
  v_exp_f32 v216, v144
  v_mfma_f32_16x16x32_bf16 a[120:123], a[188:191], v[184:187], a[120:123]
  s_waitcnt lgkmcnt(4)
  v_cvt_pk_bf16_f32 v183, v222, v223
  v_add_u32 v3, s66, v2
  v_mfma_f32_16x16x32_bf16 a[124:127], a[188:191], v[188:191], a[124:127]
  s_cbranch_vccnz fa_stub9
fa_back9:
  v_exp_f32 v217, v145
  v_add_f32 v230, v230, v226
  v_add_f32 v231, v231, v227
fa_SSpre:
  s_mov_b32 s11, 1
  s_cmp_lg_u32 s12, 0
  s_cselect_b32 s32, s15, s32
  s_cmp_ge_u32 s20, 2
  s_cselect_b32 s23, 8, 0
  s_cmp_le_u32 s29, s23
  s_cbranch_scc1 fa_chain
.p2align 6
fa_SS:
  v_mfma_f32_16x16x32_bf16 v[128:131], a[128:131], v[64:67], v[200:203]
  s_waitcnt vmcnt(12)
  v_exp_f32 v218, v146
  v_mfma_f32_16x16x32_bf16 v[136:139], a[128:131], v[68:71], v[204:207]
  s_barrier
  v_exp_f32 v219, v147
  v_mfma_f32_16x16x32_bf16 v[132:135], a[132:135], v[64:67], v[200:203]
  s_cmp_ge_u32 s26, s32
  ds_read_b128 a[160:163], v3 offset:16384
  ds_read_b128 a[164:167], v3 offset:17408
  v_add_f32 v226, v216, v217
  v_mfma_f32_16x16x32_bf16 v[140:143], a[132:135], v[68:71], v[204:207]
  s_cbranch_scc1 fa_hk7
fa_hb7:
  v_exp_f32 v220, v148
  v_mfma_f32_16x16x32_bf16 v[128:131], a[136:139], v[72:75], v[128:131]
  ds_read_b128 a[168:171], v3 offset:18432
  v_cvt_pk_bf16_f32 v184, v216, v217
  v_mfma_f32_16x16x32_bf16 v[136:139], a[136:139], v[76:79], v[136:139]
  s_mov_b32 m0, s24
  v_exp_f32 v221, v149
  v_mfma_f32_16x16x32_bf16 v[132:135], a[140:143], v[72:75], v[132:135]
  ds_read_b128 a[172:175], v3 offset:19456
  buffer_load_dwordx4 v2, s[44:47], s26 offen offset:0 sc1 lds
  v_add_f32 v226, v226, v218
  v_add_f32 v226, v226, v219
  v_mfma_f32_16x16x32_bf16 v[140:143], a[140:143], v[76:79], v[140:143]
  s_waitcnt lgkmcnt(4)
  v_exp_f32 v222, v150
  v_mfma_f32_16x16x32_bf16 v[128:131], a[144:147], v[80:83], v[128:131]
  ds_read_b128 a[176:179], v3 offset:20480
  v_cvt_pk_bf16_f32 v185, v218, v219
  v_mfma_f32_16x16x32_bf16 v[136:139], a[144:147], v[84:87], v[136:139]
  v_exp_f32 v223, v151
  v_mfma_f32_16x16x32_bf16 v[132:135], a[148:151], v[80:83], v[132:135]
  ds_read_b128 a[180:183], v3 offset:21504
  v_add_f32 v226, v226, v220
  v_mfma_f32_16x16x32_bf16 v[140:143], a[148:151], v[84:87], v[140:143]
  v_exp_f32 v216, v152
  v_mfma_f32_16x16x32_bf16 v[128:131], a[152:155], v[88:91], v[128:131]
  ds_read_b128 a[184:187], v3 offset:22528
  buffer_load_dwordx4 v2, s[44:47], s26 offen offset:1024 sc1 lds
  v_add_f32 v226, v226, v221
  v_cvt_pk_bf16_f32 v186, v220, v221
  v_mfma_f32_16x16x32_bf16 v[136:139], a[152:155], v[92:95], v[136:139]
  v_exp_f32 v217, v153
  v_mfma_f32_16x16x32_bf16 v[132:135], a[156:159], v[88:91], v[132:135]
  ds_read_b128 a[188:191], v3 offset:23552
  v_add_f32 v226, v226, v222
  v_mfma_f32_16x16x32_bf16 v[140:143], a[156:159], v[92:95], v[140:143]
  s_waitcnt lgkmcnt(4)
  v_exp_f32 v218, v154
  v_mfma_f32_16x16x32_bf16 a[64:67], a[160:163], v[176:179], a[64:67]
  ds_read_b128 a[128:131], v3 offset:0
  v_add_f32 v226, v226, v223
  v_cvt_pk_bf16_f32 v187, v222, v223
  v_mfma_f32_16x16x32_bf16 a[68:71], a[160:163], v[180:183], a[68:71]
  v_exp_f32 v219, v155
  v_mfma_f32_16x16x32_bf16 a[72:75], a[164:167], v[176:179], a[72:75]
  ds_read_b128 a[132:135], v3 offset:1024
  buffer_load_dwordx4 v2, s[44:47], s26 offen offset:2048 sc1 lds
  v_add_f32 v227, v216, v217
  v_mfma_f32_16x16x32_bf16 a[76:79], a[164:167], v[180:183], a[76:79]
  v_exp_f32 v220, v156
  v_mfma_f32_16x16x32_bf16 a[80:83], a[168:171], v[176:179], a[80:83]
  ds_read_b128 a[136:139], v3 offset:2048
  v_cvt_pk_bf16_f32 v188, v216, v217
  v_mfma_f32_16x16x32_bf16 a[84:87], a[168:171], v[180:183], a[84:87]
  v_exp_f32 v221, v157
  v_mfma_f32_16x16x32_bf16 a[88:91], a[172:175], v[176:179], a[88:91]
  ds_read_b128 a[140:143], v3 offset:3072
  v_add_f32 v227, v227, v218
  v_add_f32 v227, v227, v219
  v_mfma_f32_16x16x32_bf16 a[92:95], a[172:175], v[180:183], a[92:95]
  s_waitcnt lgkmcnt(4)
  v_exp_f32 v222, v158
  v_mfma_f32_16x16x32_bf16 a[96:99], a[176:179], v[176:179], a[96:99]
  ds_read_b128 a[144:147], v3 offset:4096
  buffer_load_dwordx4 v2, s[44:47], s26 offen offset:3072 sc1 lds
  v_cvt_pk_bf16_f32 v189, v218, v219
  v_mfma_f32_16x16x32_bf16 a[100:103], a[176:179], v[180:183], a[100:103]
  s_add_u32 s26, s26, 16384
  v_exp_f32 v223, v159
  v_mfma_f32_16x16x32_bf16 a[104:107], a[180:183], v[176:179], a[104:107]
  s_add_u32 s24, s24, 32768
  ds_read_b128 a[148:151], v3 offset:5120
  v_add_f32 v227, v227, v220
  v_mfma_f32_16x16x32_bf16 a[108:111], a[180:183], v[180:183], a[108:111]
  s_and_b32 s24, s24, 0x1ffff
  v_add_f32 v227, v227, v221
  v_cvt_pk_bf16_f32 v190, v220, v221
  v_add_f32 v227, v227, v222
  v_mfma_f32_16x16x32_bf16 a[112:115], a[184:187], v[176:179], a[112:115]
  ds_read_b128 a[152:155], v3 offset:6144
  v_add_f32 v227, v227, v223
  v_max_f32 v5, v226, v227
  v_cmp_lt_f32 vcc, s81, v5
  v_mfma_f32_16x16x32_bf16 a[116:119], a[184:187], v[180:183], a[116:119]
  v_exp_f32 v216, v128
  v_mfma_f32_16x16x32_bf16 a[120:123], a[188:191], v[176:179], a[120:123]
  s_waitcnt lgkmcnt(3)
  ds_read_b128 a[156:159], v3 offset:7168
  v_cvt_pk_bf16_f32 v191, v222, v223
  v_mfma_f32_16x16x32_bf16 a[124:127], a[188:191], v[180:183], a[124:127]
  s_cbranch_vccnz fa_stub10
fa_back10:
  v_exp_f32 v217, v129
  v_add_f32 v230, v230, v226
  v_add_f32 v231, v231, v227
  v_mfma_f32_16x16x32_bf16 v[144:147], a[128:131], v[64:67], v[200:203]
  ds_read_b128 a[160:163], v3 offset:24576
  v_add_f32 v226, v216, v217
  v_mfma_f32_16x16x32_bf16 v[152:155], a[128:131], v[68:71], v[204:207]
  v_exp_f32 v218, v130
  v_mfma_f32_16x16x32_bf16 v[148:151], a[132:135], v[64:67], v[200:203]
  s_add_u32 s66, s66, 32768
  ds_read_b128 a[164:167], v3 offset:25600
  v_cvt_pk_bf16_f32 v176, v216, v217
  v_mfma_f32_16x16x32_bf16 v[156:159], a[132:135], v[68:71], v[204:207]
  s_mov_b32 m0, s25
  v_exp_f32 v219, v131
  v_mfma_f32_16x16x32_bf16 v[144:147], a[136:139], v[72:75], v[144:147]
  s_and_b32 s66, s66, 0x1ffff
  ds_read_b128 a[168:171], v3 offset:26624
  buffer_load_dwordx4 v2, s[48:51], s27 offen offset:0 sc1 lds
  v_add_f32 v226, v226, v218
  v_add_f32 v226, v226, v219
  v_mfma_f32_16x16x32_bf16 v[152:155], a[136:139], v[76:79], v[152:155]
  v_exp_f32 v220, v132
  v_mfma_f32_16x16x32_bf16 v[148:151], a[140:143], v[72:75], v[148:151]
  ds_read_b128 a[172:175], v3 offset:27648
  v_cvt_pk_bf16_f32 v177, v218, v219
  v_mfma_f32_16x16x32_bf16 v[156:159], a[140:143], v[76:79], v[156:159]
  s_waitcnt lgkmcnt(4)
  v_exp_f32 v221, v133
  v_mfma_f32_16x16x32_bf16 v[144:147], a[144:147], v[80:83], v[144:147]
  ds_read_b128 a[176:179], v3 offset:28672
  v_add_f32 v226, v226, v220
  v_mfma_f32_16x16x32_bf16 v[152:155], a[144:147], v[84:87], v[152:155]
  v_exp_f32 v222, v134
  v_mfma_f32_16x16x32_bf16 v[148:151], a[148:151], v[80:83], v[148:151]
  ds_read_b128 a[180:183], v3 offset:29696
  buffer_load_dwordx4 v2, s[48:51], s27 offen offset:1024 sc1 lds
  v_add_f32 v226, v226, v221
  v_cvt_pk_bf16_f32 v178, v220, v221
  v_mfma_f32_16x16x32_bf16 v[156:159], a[148:151], v[84:87], v[156:159]
  v_exp_f32 v223, v135
  v_mfma_f32_16x16x32_bf16 v[144:147], a[152:155], v[88:91], v[144:147]
  ds_read_b128 a[184:187], v3 offset:30720
  v_add_f32 v226, v226, v222
  v_mfma_f32_16x16x32_bf16 v[152:155], a[152:155], v[92:95], v[152:155]
  v_exp_f32 v216, v136
  v_mfma_f32_16x16x32_bf16 v[148:151], a[156:159], v[88:91], v[148:151]
  ds_read_b128 a[188:191], v3 offset:31744
  v_add_f32 v226, v226, v223
  v_exp_f32 v217, v137
  v_mfma_f32_16x16x32_bf16 v[156:159], a[156:159], v[92:95], v[156:159]
  s_waitcnt lgkmcnt(4)
  v_exp_f32 v218, v138
  v_mfma_f32_16x16x32_bf16 a[64:67], a[160:163], v[184:187], a[64:67]
  ds_read_b128 a[128:131], v3 offset:8192
  v_cvt_pk_bf16_f32 v179, v222, v223
  v_mfma_f32_16x16x32_bf16 a[68:71], a[160:163], v[188:191], a[68:71]
  v_exp_f32 v219, v139
  v_mfma_f32_16x16x32_bf16 a[72:75], a[164:167], v[184:187], a[72:75]
  ds_read_b128 a[132:135], v3 offset:9216
  buffer_load_dwordx4 v2, s[48:51], s27 offen offset:2048 sc1 lds
  v_add_f32 v227, v216, v217
  v_mfma_f32_16x16x32_bf16 a[76:79], a[164:167], v[188:191], a[76:79]
  v_exp_f32 v220, v140
  v_mfma_f32_16x16x32_bf16 a[80:83], a[168:171], v[184:187], a[80:83]
  ds_read_b128 a[136:139], v3 offset:10240
  v_cvt_pk_bf16_f32 v180, v216, v217
  v_mfma_f32_16x16x32_bf16 a[84:87], a[168:171], v[188:191], a[84:87]
  v_exp_f32 v221, v141
  v_mfma_f32_16x16x32_bf16 a[88:91], a[172:175], v[184:187], a[88:91]
  ds_read_b128 a[140:143], v3 offset:11264
  v_add_f32 v227, v227, v218
  v_mfma_f32_16x16x32_bf16 a[92:95], a[172:175], v[188:191], a[92:95]
  s_waitcnt lgkmcnt(4)
  v_exp_f32 v222, v142
  v_mfma_f32_16x16x32_bf16 a[96:99], a[176:179], v[184:187], a[96:99]
  ds_read_b128 a[144:147], v3 offset:12288
  buffer_load_dwordx4 v2, s[48:51], s27 offen offset:3072 sc1 lds
  v_add_f32 v227, v227, v219
  v_cvt_pk_bf16_f32 v181, v218, v219
  v_mfma_f32_16x16x32_bf16 a[100:103], a[176:179], v[188:191], a[100:103]
  s_add_u32 s27, s27, 16384
  v_exp_f32 v223, v143
  v_mfma_f32_16x16x32_bf16 a[104:107], a[180:183], v[184:187], a[104:107]
  s_add_u32 s25, s25, 32768
  ds_read_b128 a[148:151], v3 offset:13312
  v_add_f32 v227, v227, v220
  v_mfma_f32_16x16x32_bf16 a[108:111], a[180:183], v[188:191], a[108:111]
  s_and_b32 s25, s25, 0x1ffff
  v_add_f32 v227, v227, v221
  v_cvt_pk_bf16_f32 v182, v220, v221
  v_add_f32 v227, v227, v222
  v_mfma_f32_16x16x32_bf16 a[112:115], a[184:187], v[184:187], a[112:115]
  s_sub_u32 s29, s29, 1
  ds_read_b128 a[152:155], v3 offset:14336
  v_add_f32 v227, v227, v223
  v_max_f32 v5, v226, v227
  v_cmp_lt_f32 vcc, s81, v5
  v_mfma_f32_16x16x32_bf16 a[116:119], a[184:187], v[188:191], a[116:119]
  s_cmp_gt_u32 s29, 8
  v_exp_f32 v216, v144
  v_mfma_f32_16x16x32_bf16 a[120:123], a[188:191], v[184:187], a[120:123]
  s_waitcnt lgkmcnt(3)
  ds_read_b128 a[156:159], v3 offset:15360
  v_cvt_pk_bf16_f32 v183, v222, v223
  v_add_u32 v3, s66, v2
  v_mfma_f32_16x16x32_bf16 a[124:127], a[188:191], v[188:191], a[124:127]
  s_cbranch_vccnz fa_stub11
fa_back11:
  v_exp_f32 v217, v145
  v_add_f32 v230, v230, v226
  v_add_f32 v231, v231, v227
  s_cbranch_scc1 fa_SS
fa_chain:
fa_hb8:
  s_cmp_lt_u32 s12, 2
  s_cbranch_scc1 fa_hk8
  s_cmp_eq_u32 s29, 8
  s_cbranch_scc0 fa_disp
fa_SSW8:
  v_mfma_f32_16x16x32_bf16 v[128:131], a[128:131], v[64:67], v[200:203]
  s_waitcnt vmcnt(12)
  v_exp_f32 v218, v146
  v_mfma_f32_16x16x32_bf16 v[136:139], a[128:131], v[68:71], v[204:207]
  s_barrier
  v_exp_f32 v219, v147
  v_mfma_f32_16x16x32_bf16 v[132:135], a[132:135], v[64:67], v[200:203]
  ds_read_b128 a[160:163], v3 offset:16384
  ds_read_b128 a[164:167], v3 offset:17408
  v_add_f32 v226, v216, v217
  v_mfma_f32_16x16x32_bf16 v[140:143], a[132:135], v[68:71], v[204:207]
  s_mov_b32 m0, s24
  v_exp_f32 v220, v148
  v_mfma_f32_16x16x32_bf16 v[128:131], a[136:139], v[72:75], v[128:131]
  ds_read_b128 a[168:171], v3 offset:18432
  buffer_load_dwordx4 v2, s[44:47], s26 offen offset:0 sc1 lds
  v_cvt_pk_bf16_f32 v184, v216, v217
  v_mfma_f32_16x16x32_bf16 v[136:139], a[136:139], v[76:79], v[136:139]
  v_exp_f32 v221, v149
  v_mfma_f32_16x16x32_bf16 v[132:135], a[140:143], v[72:75], v[132:135]
  ds_read_b128 a[172:175], v3 offset:19456
  v_add_f32 v226, v226, v218
  v_add_f32 v226, v226, v219
  v_mfma_f32_16x16x32_bf16 v[140:143], a[140:143], v[76:79], v[140:143]
  s_waitcnt lgkmcnt(4)
  v_exp_f32 v222, v150
  v_mfma_f32_16x16x32_bf16 v[128:131], a[144:147], v[80:83], v[128:131]
  s_add_u32 s14, s13, 0
  ds_read_b128 a[176:179], v3 offset:20480
  buffer_load_dwordx4 a[0:3], v2, s[40:43], s14 offen offset:0 sc1
  v_cvt_pk_bf16_f32 v185, v218, v219
  v_mfma_f32_16x16x32_bf16 v[136:139], a[144:147], v[84:87], v[136:139]
  v_exp_f32 v223, v151
  v_mfma_f32_16x16x32_bf16 v[132:135], a[148:151], v[80:83], v[132:135]
  ds_read_b128 a[180:183], v3 offset:21504
  buffer_load_dwordx4 v2, s[44:47], s26 offen offset:1024 sc1 lds
  v_add_f32 v226, v226, v220
  v_mfma_f32_16x16x32_bf16 v[140:143], a[148:151], v[84:87], v[140:143]
  v_exp_f32 v216, v152
  v_mfma_f32_16x16x32_bf16 v[128:131], a[152:155], v[88:91], v[128:131]
  ds_read_b128 a[184:187], v3 offset:22528
  v_add_f32 v226, v226, v221
  v_cvt_pk_bf16_f32 v186, v220, v221
  v_mfma_f32_16x16x32_bf16 v[136:139], a[152:155], v[92:95], v[136:139]
  v_exp_f32 v217, v153
  v_mfma_f32_16x16x32_bf16 v[132:135], a[156:159], v[88:91], v[132:135]
  ds_read_b128 a[188:191], v3 offset:23552
  buffer_load_dwordx4 a[4:7], v2, s[40:43], s14 offen offset:1024 sc1
  v_add_f32 v226, v226, v222
  v_mfma_f32_16x16x32_bf16 v[140:143], a[156:159], v[92:95], v[140:143]
  s_waitcnt lgkmcnt(4)
  v_exp_f32 v218, v154
  v_mfma_f32_16x16x32_bf16 a[64:67], a[160:163], v[176:179], a[64:67]
  ds_read_b128 a[128:131], v3 offset:0
  v_add_f32 v226, v226, v223
  v_cvt_pk_bf16_f32 v187, v222, v223
  v_mfma_f32_16x16x32_bf16 a[68:71], a[160:163], v[180:183], a[68:71]
  v_exp_f32 v219, v155
  v_mfma_f32_16x16x32_bf16 a[72:75], a[164:167], v[176:179], a[72:75]
  ds_read_b128 a[132:135], v3 offset:1024
  buffer_load_dwordx4 v2, s[44:47], s26 offen offset:2048 sc1 lds
  v_add_f32 v227, v216, v217
  v_mfma_f32_16x16x32_bf16 a[76:79], a[164:167], v[180:183], a[76:79]
  v_exp_f32 v220, v156
  v_mfma_f32_16x16x32_bf16 a[80:83], a[168:171], v[176:179], a[80:83]
  ds_read_b128 a[136:139], v3 offset:2048
  v_cvt_pk_bf16_f32 v188, v216, v217
  v_mfma_f32_16x16x32_bf16 a[84:87], a[168:171], v[180:183], a[84:87]
  v_exp_f32 v221, v157
  v_mfma_f32_16x16x32_bf16 a[88:91], a[172:175], v[176:179], a[88:91]
  ds_read_b128 a[140:143], v3 offset:3072
  buffer_load_dwordx4 a[8:11], v2, s[40:43], s14 offen offset:2048 sc1
  v_add_f32 v227, v227, v218
  v_add_f32 v227, v227, v219
  v_mfma_f32_16x16x32_bf16 a[92:95], a[172:175], v[180:183], a[92:95]
  s_waitcnt lgkmcnt(4)
  v_exp_f32 v222, v158
  v_mfma_f32_16x16x32_bf16 a[96:99], a[176:179], v[176:179], a[96:99]
  ds_read_b128 a[144:147], v3 offset:4096
  buffer_load_dwordx4 v2, s[44:47], s26 offen offset:3072 sc1 lds
  v_cvt_pk_bf16_f32 v189, v218, v219
  v_mfma_f32_16x16x32_bf16 a[100:103], a[176:179], v[180:183], a[100:103]
  s_add_u32 s26, s26, 16384
  v_exp_f32 v223, v159
  v_mfma_f32_16x16x32_bf16 a[104:107], a[180:183], v[176:179], a[104:107]
  s_add_u32 s24, s24, 32768
  ds_read_b128 a[148:151], v3 offset:5120
  v_add_f32 v227, v227, v220
  v_mfma_f32_16x16x32_bf16 a[108:111], a[180:183], v[180:183], a[108:111]
  s_and_b32 s24, s24, 0x1ffff
  v_add_f32 v227, v227, v221
  v_cvt_pk_bf16_f32 v190, v220, v221
  v_add_f32 v227, v227, v222
  v_mfma_f32_16x16x32_bf16 a[112:115], a[184:187], v[176:179], a[112:115]
  ds_read_b128 a[152:155], v3 offset:6144
  v_add_f32 v227, v227, v223
  v_max_f32 v5, v226, v227
  v_cmp_lt_f32 vcc, s81, v5
  v_mfma_f32_16x16x32_bf16 a[116:119], a[184:187], v[180:183], a[116:119]
  v_exp_f32 v216, v128
  v_mfma_f32_16x16x32_bf16 a[120:123], a[188:191], v[176:179], a[120:123]
  s_waitcnt lgkmcnt(3)
  ds_read_b128 a[156:159], v3 offset:7168
  v_cvt_pk_bf16_f32 v191, v222, v223
  v_mfma_f32_16x16x32_bf16 a[124:127], a[188:191], v[180:183], a[124:127]
  s_cbranch_vccnz fa_stub12
fa_back12:
  v_exp_f32 v217, v129
  v_add_f32 v230, v230, v226
  v_add_f32 v231, v231, v227
  v_mfma_f32_16x16x32_bf16 v[144:147], a[128:131], v[64:67], v[200:203]
  ds_read_b128 a[160:163], v3 offset:24576
  v_add_f32 v226, v216, v217
  v_mfma_f32_16x16x32_bf16 v[152:155], a[128:131], v[68:71], v[204:207]
  v_exp_f32 v218, v130
  v_mfma_f32_16x16x32_bf16 v[148:151], a[132:135], v[64:67], v[200:203]
  s_add_u32 s66, s66, 32768
  ds_read_b128 a[164:167], v3 offset:25600
  v_cvt_pk_bf16_f32 v176, v216, v217
  v_mfma_f32_16x16x32_bf16 v[156:159], a[132:135], v[68:71], v[204:207]
  s_mov_b32 m0, s25
  v_exp_f32 v219, v131
  v_mfma_f32_16x16x32_bf16 v[144:147], a[136:139], v[72:75], v[144:147]
  s_and_b32 s66, s66, 0x1ffff
  ds_read_b128 a[168:171], v3 offset:26624
  buffer_load_dwordx4 v2, s[48:51], s27 offen offset:0 sc1 lds
  v_add_f32 v226, v226, v218
  v_add_f32 v226, v226, v219
  v_mfma_f32_16x16x32_bf16 v[152:155], a[136:139], v[76:79], v[152:155]
  v_exp_f32 v220, v132
  v_mfma_f32_16x16x32_bf16 v[148:151], a[140:143], v[72:75], v[148:151]
  ds_read_b128 a[172:175], v3 offset:27648
  v_cvt_pk_bf16_f32 v177, v218, v219
  v_mfma_f32_16x16x32_bf16 v[156:159], a[140:143], v[76:79], v[156:159]
  s_waitcnt lgkmcnt(4)
  v_exp_f32 v221, v133
  v_mfma_f32_16x16x32_bf16 v[144:147], a[144:147], v[80:83], v[144:147]
  s_add_u32 s14, s13, 0
  ds_read_b128 a[176:179], v3 offset:28672
  buffer_load_dwordx4 a[12:15], v2, s[40:43], s14 offen offset:3072 sc1
  v_add_f32 v226, v226, v220
  v_mfma_f32_16x16x32_bf16 v[152:155], a[144:147], v[84:87], v[152:155]
  v_exp_f32 v222, v134
  v_mfma_f32_16x16x32_bf16 v[148:151], a[148:151], v[80:83], v[148:151]
  ds_read_b128 a[180:183], v3 offset:29696
  buffer_load_dwordx4 v2, s[48:51], s27 offen offset:1024 sc1 lds
  v_add_f32 v226, v226, v221
  v_cvt_pk_bf16_f32 v178, v220, v221
  v_mfma_f32_16x16x32_bf16 v[156:159], a[148:151], v[84:87], v[156:159]
  v_exp_f32 v223, v135
  v_mfma_f32_16x16x32_bf16 v[144:147], a[152:155], v[88:91], v[144:147]
  ds_read_b128 a[184:187], v3 offset:30720
  v_add_f32 v226, v226, v222
  v_mfma_f32_16x16x32_bf16 v[152:155], a[152:155], v[92:95], v[152:155]
  v_exp_f32 v216, v136
  v_mfma_f32_16x16x32_bf16 v[148:151], a[156:159], v[88:91], v[148:151]
  s_add_u32 s14, s13, 4096
  ds_read_b128 a[188:191], v3 offset:31744
  buffer_load_dwordx4 a[16:19], v2, s[40:43], s14 offen offset:0 sc1
  v_add_f32 v226, v226, v223
  v_exp_f32 v217, v137
  v_mfma_f32_16x16x32_bf16 v[156:159], a[156:159], v[92:95], v[156:159]
  s_waitcnt lgkmcnt(4)
  v_exp_f32 v218, v138
  v_mfma_f32_16x16x32_bf16 a[64:67], a[160:163], v[184:187], a[64:67]
  ds_read_b128 a[128:131], v3 offset:8192
  v_cvt_pk_bf16_f32 v179, v222, v223
  v_mfma_f32_16x16x32_bf16 a[68:71], a[160:163], v[188:191], a[68:71]
  v_exp_f32 v219, v139
  v_mfma_f32_16x16x32_bf16 a[72:75], a[164:167], v[184:187], a[72:75]
  ds_read_b128 a[132:135], v3 offset:9216
  buffer_load_dwordx4 v2, s[48:51], s27 offen offset:2048 sc1 lds
  v_add_f32 v227, v216, v217
  v_mfma_f32_16x16x32_bf16 a[76:79], a[164:167], v[188:191], a[76:79]
  v_exp_f32 v220, v140
  v_mfma_f32_16x16x32_bf16 a[80:83], a[168:171], v[184:187], a[80:83]
  ds_read_b128 a[136:139], v3 offset:10240
  v_cvt_pk_bf16_f32 v180, v216, v217
  v_mfma_f32_16x16x32_bf16 a[84:87], a[168:171], v[188:191], a[84:87]
  v_exp_f32 v221, v141
  v_mfma_f32_16x16x32_bf16 a[88:91], a[172:175], v[184:187], a[88:91]
  ds_read_b128 a[140:143], v3 offset:11264
  buffer_load_dwordx4 a[20:23], v2, s[40:43], s14 offen offset:1024 sc1
  v_add_f32 v227, v227, v218
  v_mfma_f32_16x16x32_bf16 a[92:95], a[172:175], v[188:191], a[92:95]
  s_waitcnt lgkmcnt(4)
  v_exp_f32 v222, v142
  v_mfma_f32_16x16x32_bf16 a[96:99], a[176:179], v[184:187], a[96:99]
  ds_read_b128 a[144:147], v3 offset:12288
  buffer_load_dwordx4 v2, s[48:51], s27 offen offset:3072 sc1 lds
  v_add_f32 v227, v227, v219
  v_cvt_pk_bf16_f32 v181, v218, v219
  v_mfma_f32_16x16x32_bf16 a[100:103], a[176:179], v[188:191], a[100:103]
  s_add_u32 s27, s27, 16384
  v_exp_f32 v223, v143
  v_mfma_f32_16x16x32_bf16 a[104:107], a[180:183], v[184:187], a[104:107]
  s_add_u32 s25, s25, 32768
  ds_read_b128 a[148:151], v3 offset:13312
  v_add_f32 v227, v227, v220
  v_mfma_f32_16x16x32_bf16 a[108:111], a[180:183], v[188:191], a[108:111]
  s_and_b32 s25, s25, 0x1ffff
  v_add_f32 v227, v227, v221
  v_cvt_pk_bf16_f32 v182, v220, v221
  v_add_f32 v227, v227, v222
  v_mfma_f32_16x16x32_bf16 a[112:115], a[184:187], v[184:187], a[112:115]
  ds_read_b128 a[152:155], v3 offset:14336
  v_add_f32 v227, v227, v223
  v_max_f32 v5, v226, v227
  v_cmp_lt_f32 vcc, s81, v5
  v_mfma_f32_16x16x32_bf16 a[116:119], a[184:187], v[188:191], a[116:119]
  v_exp_f32 v216, v144
  v_mfma_f32_16x16x32_bf16 a[120:123], a[188:191], v[184:187], a[120:123]
  s_waitcnt lgkmcnt(3)
  ds_read_b128 a[156:159], v3 offset:15360
  v_cvt_pk_bf16_f32 v183, v222, v223
  v_add_u32 v3, s66, v2
  v_mfma_f32_16x16x32_bf16 a[124:127], a[188:191], v[188:191], a[124:127]
  s_cbranch_vccnz fa_stub13
fa_back13:
  v_exp_f32 v217, v145
  v_add_f32 v230, v230, v226
  v_add_f32 v231, v231, v227
fa_SSW7:
  v_mfma_f32_16x16x32_bf16 v[128:131], a[128:131], v[64:67], v[200:203]
  s_waitcnt vmcnt(12)
  v_exp_f32 v218, v146
  v_mfma_f32_16x16x32_bf16 v[136:139], a[128:131], v[68:71], v[204:207]
  s_barrier
  v_exp_f32 v219, v147
  v_mfma_f32_16x16x32_bf16 v[132:135], a[132:135], v[64:67], v[200:203]
  ds_read_b128 a[160:163], v3 offset:16384
  ds_read_b128 a[164:167], v3 offset:17408
  v_add_f32 v226, v216, v217
  v_mfma_f32_16x16x32_bf16 v[140:143], a[132:135], v[68:71], v[204:207]
  s_mov_b32 m0, s24
  v_exp_f32 v220, v148
  v_mfma_f32_16x16x32_bf16 v[128:131], a[136:139], v[72:75], v[128:131]
  ds_read_b128 a[168:171], v3 offset:18432
  buffer_load_dwordx4 v2, s[44:47], s26 offen offset:0 sc1 lds
  v_cvt_pk_bf16_f32 v184, v216, v217
  v_mfma_f32_16x16x32_bf16 v[136:139], a[136:139], v[76:79], v[136:139]
  v_exp_f32 v221, v149
  v_mfma_f32_16x16x32_bf16 v[132:135], a[140:143], v[72:75], v[132:135]
  ds_read_b128 a[172:175], v3 offset:19456
  v_add_f32 v226, v226, v218
  v_add_f32 v226, v226, v219
  v_mfma_f32_16x16x32_bf16 v[140:143], a[140:143], v[76:79], v[140:143]
  s_waitcnt lgkmcnt(4)
  v_exp_f32 v222, v150
  v_mfma_f32_16x16x32_bf16 v[128:131], a[144:147], v[80:83], v[128:131]
  s_add_u32 s14, s13, 4096
  ds_read_b128 a[176:179], v3 offset:20480
  buffer_load_dwordx4 a[24:27], v2, s[40:43], s14 offen offset:2048 sc1
  v_cvt_pk_bf16_f32 v185, v218, v219
  v_mfma_f32_16x16x32_bf16 v[136:139], a[144:147], v[84:87], v[136:139]
  v_exp_f32 v223, v151
  v_mfma_f32_16x16x32_bf16 v[132:135], a[148:151], v[80:83], v[132:135]
  ds_read_b128 a[180:183], v3 offset:21504
  buffer_load_dwordx4 v2, s[44:47], s26 offen offset:1024 sc1 lds
  v_add_f32 v226, v226, v220
  v_mfma_f32_16x16x32_bf16 v[140:143], a[148:151], v[84:87], v[140:143]
  v_exp_f32 v216, v152
  v_mfma_f32_16x16x32_bf16 v[128:131], a[152:155], v[88:91], v[128:131]
  ds_read_b128 a[184:187], v3 offset:22528
  v_add_f32 v226, v226, v221
  v_cvt_pk_bf16_f32 v186, v220, v221
  v_mfma_f32_16x16x32_bf16 v[136:139], a[152:155], v[92:95], v[136:139]
  v_exp_f32 v217, v153
  v_mfma_f32_16x16x32_bf16 v[132:135], a[156:159], v[88:91], v[132:135]
  ds_read_b128 a[188:191], v3 offset:23552
  buffer_load_dwordx4 a[28:31], v2, s[40:43], s14 offen offset:3072 sc1
  v_add_f32 v226, v226, v222
  v_mfma_f32_16x16x32_bf16 v[140:143], a[156:159], v[92:95], v[140:143]
  s_waitcnt lgkmcnt(4)
  v_exp_f32 v218, v154
  v_mfma_f32_16x16x32_bf16 a[64:67], a[160:163], v[176:179], a[64:67]
  ds_read_b128 a[128:131], v3 offset:0
  v_add_f32 v226, v226, v223
  v_cvt_pk_bf16_f32 v187, v222, v223
  v_mfma_f32_16x16x32_bf16 a[68:71], a[160:163], v[180:183], a[68:71]
  v_exp_f32 v219, v155
  v_mfma_f32_16x16x32_bf16 a[72:75], a[164:167], v[176:179], a[72:75]
  ds_read_b128 a[132:135], v3 offset:1024
  buffer_load_dwordx4 v2, s[44:47], s26 offen offset:2048 sc1 lds
  v_add_f32 v227, v216, v217
  v_mfma_f32_16x16x32_bf16 a[76:79], a[164:167], v[180:183], a[76:79]
  v_exp_f32 v220, v156
  v_mfma_f32_16x16x32_bf16 a[80:83], a[168:171], v[176:179], a[80:83]
  ds_read_b128 a[136:139], v3 offset:2048
  v_cvt_pk_bf16_f32 v188, v216, v217
  v_mfma_f32_16x16x32_bf16 a[84:87], a[168:171], v[180:183], a[84:87]
  v_exp_f32 v221, v157
  v_mfma_f32_16x16x32_bf16 a[88:91], a[172:175], v[176:179], a[88:91]
  s_add_u32 s14, s13, 8192
  ds_read_b128 a[140:143], v3 offset:3072
  buffer_load_dwordx4 a[32:35], v2, s[40:43], s14 offen offset:0 sc1
  v_add_f32 v227, v227, v218
  v_add_f32 v227, v227, v219
  v_mfma_f32_16x16x32_bf16 a[92:95], a[172:175], v[180:183], a[92:95]
  s_waitcnt lgkmcnt(4)
  v_exp_f32 v222, v158
  v_mfma_f32_16x16x32_bf16 a[96:99], a[176:179], v[176:179], a[96:99]
  ds_read_b128 a[144:147], v3 offset:4096
  buffer_load_dwordx4 v2, s[44:47], s26 offen offset:3072 sc1 lds
  v_cvt_pk_bf16_f32 v189, v218, v219
  v_mfma_f32_16x16x32_bf16 a[100:103], a[176:179], v[180:183], a[100:103]
  s_add_u32 s26, s26, 16384
  v_exp_f32 v223, v159
  v_mfma_f32_16x16x32_bf16 a[104:107], a[180:183], v[176:179], a[104:107]
  s_add_u32 s24, s24, 32768
  ds_read_b128 a[148:151], v3 offset:5120
  v_add_f32 v227, v227, v220
  v_mfma_f32_16x16x32_bf16 a[108:111], a[180:183], v[180:183], a[108:111]
  s_and_b32 s24, s24, 0x1ffff
  v_add_f32 v227, v227, v221
  v_cvt_pk_bf16_f32 v190, v220, v221
  v_add_f32 v227, v227, v222
  v_mfma_f32_16x16x32_bf16 a[112:115], a[184:187], v[176:179], a[112:115]
  ds_read_b128 a[152:155], v3 offset:6144
  v_add_f32 v227, v227, v223
  v_max_f32 v5, v226, v227
  v_cmp_lt_f32 vcc, s81, v5
  v_mfma_f32_16x16x32_bf16 a[116:119], a[184:187], v[180:183], a[116:119]
  v_exp_f32 v216, v128
  v_mfma_f32_16x16x32_bf16 a[120:123], a[188:191], v[176:179], a[120:123]
  s_waitcnt lgkmcnt(3)
  ds_read_b128 a[156:159], v3 offset:7168
  v_cvt_pk_bf16_f32 v191, v222, v223
  v_mfma_f32_16x16x32_bf16 a[124:127], a[188:191], v[180:183], a[124:127]
  s_cbranch_vccnz fa_stub14
fa_back14:
  v_exp_f32 v217, v129
  v_add_f32 v230, v230, v226
  v_add_f32 v231, v231, v227
  v_mfma_f32_16x16x32_bf16 v[144:147], a[128:131], v[64:67], v[200:203]
  ds_read_b128 a[160:163], v3 offset:24576
  v_add_f32 v226, v216, v217
  v_mfma_f32_16x16x32_bf16 v[152:155], a[128:131], v[68:71], v[204:207]
  v_exp_f32 v218, v130
  v_mfma_f32_16x16x32_bf16 v[148:151], a[132:135], v[64:67], v[200:203]
  s_add_u32 s66, s66, 32768
  ds_read_b128 a[164:167], v3 offset:25600
  v_cvt_pk_bf16_f32 v176, v216, v217
  v_mfma_f32_16x16x32_bf16 v[156:159], a[132:135], v[68:71], v[204:207]
  s_mov_b32 m0, s25
  v_exp_f32 v219, v131
  v_mfma_f32_16x16x32_bf16 v[144:147], a[136:139], v[72:75], v[144:147]
  s_and_b32 s66, s66, 0x1ffff
  ds_read_b128 a[168:171], v3 offset:26624
  buffer_load_dwordx4 v2, s[48:51], s27 offen offset:0 sc1 lds
  v_add_f32 v226, v226, v218
  v_add_f32 v226, v226, v219
  v_mfma_f32_16x16x32_bf16 v[152:155], a[136:139], v[76:79], v[152:155]
  v_exp_f32 v220, v132
  v_mfma_f32_16x16x32_bf16 v[148:151], a[140:143], v[72:75], v[148:151]
  ds_read_b128 a[172:175], v3 offset:27648
  v_cvt_pk_bf16_f32 v177, v218, v219
  v_mfma_f32_16x16x32_bf16 v[156:159], a[140:143], v[76:79], v[156:159]
  s_waitcnt lgkmcnt(4)
  v_exp_f32 v221, v133
  v_mfma_f32_16x16x32_bf16 v[144:147], a[144:147], v[80:83], v[144:147]
  s_add_u32 s14, s13, 8192
  ds_read_b128 a[176:179], v3 offset:28672
  buffer_load_dwordx4 a[36:39], v2, s[40:43], s14 offen offset:1024 sc1
  v_add_f32 v226, v226, v220
  v_mfma_f32_16x16x32_bf16 v[152:155], a[144:147], v[84:87], v[152:155]
  v_exp_f32 v222, v134
  v_mfma_f32_16x16x32_bf16 v[148:151], a[148:151], v[80:83], v[148:151]
  ds_read_b128 a[180:183], v3 offset:29696
  buffer_load_dwordx4 v2, s[48:51], s27 offen offset:1024 sc1 lds
  v_add_f32 v226, v226, v221
  v_cvt_pk_bf16_f32 v178, v220, v221
  v_mfma_f32_16x16x32_bf16 v[156:159], a[148:151], v[84:87], v[156:159]
  v_exp_f32 v223, v135
  v_mfma_f32_16x16x32_bf16 v[144:147], a[152:155], v[88:91], v[144:147]
  ds_read_b128 a[184:187], v3 offset:30720
  v_add_f32 v226, v226, v222
  v_mfma_f32_16x16x32_bf16 v[152:155], a[152:155], v[92:95], v[152:155]
  v_exp_f32 v216, v136
  v_mfma_f32_16x16x32_bf16 v[148:151], a[156:159], v[88:91], v[148:151]
  ds_read_b128 a[188:191], v3 offset:31744
  buffer_load_dwordx4 a[40:43], v2, s[40:43], s14 offen offset:2048 sc1
  v_add_f32 v226, v226, v223
  v_exp_f32 v217, v137
  v_mfma_f32_16x16x32_bf16 v[156:159], a[156:159], v[92:95], v[156:159]
  s_waitcnt lgkmcnt(4)
  v_exp_f32 v218, v138
  v_mfma_f32_16x16x32_bf16 a[64:67], a[160:163], v[184:187], a[64:67]
  ds_read_b128 a[128:131], v3 offset:8192
  v_cvt_pk_bf16_f32 v179, v222, v223
  v_mfma_f32_16x16x32_bf16 a[68:71], a[160:163], v[188:191], a[68:71]
  v_exp_f32 v219, v139
  v_mfma_f32_16x16x32_bf16 a[72:75], a[164:167], v[184:187], a[72:75]
  ds_read_b128 a[132:135], v3 offset:9216
  buffer_load_dwordx4 v2, s[48:51], s27 offen offset:2048 sc1 lds
  v_add_f32 v227, v216, v217
  v_mfma_f32_16x16x32_bf16 a[76:79], a[164:167], v[188:191], a[76:79]
  v_exp_f32 v220, v140
  v_mfma_f32_16x16x32_bf16 a[80:83], a[168:171], v[184:187], a[80:83]
  ds_read_b128 a[136:139], v3 offset:10240
  v_cvt_pk_bf16_f32 v180, v216, v217
  v_mfma_f32_16x16x32_bf16 a[84:87], a[168:171], v[188:191], a[84:87]
  v_exp_f32 v221, v141
  v_mfma_f32_16x16x32_bf16 a[88:91], a[172:175], v[184:187], a[88:91]
  ds_read_b128 a[140:143], v3 offset:11264
  buffer_load_dwordx4 a[44:47], v2, s[40:43], s14 offen offset:3072 sc1
  v_add_f32 v227, v227, v218
  v_mfma_f32_16x16x32_bf16 a[92:95], a[172:175], v[188:191], a[92:95]
  s_waitcnt lgkmcnt(4)
  v_exp_f32 v222, v142
  v_mfma_f32_16x16x32_bf16 a[96:99], a[176:179], v[184:187], a[96:99]
  ds_read_b128 a[144:147], v3 offset:12288
  buffer_load_dwordx4 v2, s[48:51], s27 offen offset:3072 sc1 lds
  v_add_f32 v227, v227, v219
  v_cvt_pk_bf16_f32 v181, v218, v219
  v_mfma_f32_16x16x32_bf16 a[100:103], a[176:179], v[188:191], a[100:103]
  s_add_u32 s27, s27, 16384
  v_exp_f32 v223, v143
  v_mfma_f32_16x16x32_bf16 a[104:107], a[180:183], v[184:187], a[104:107]
  s_add_u32 s25, s25, 32768
  ds_read_b128 a[148:151], v3 offset:13312
  v_add_f32 v227, v227, v220
  v_mfma_f32_16x16x32_bf16 a[108:111], a[180:183], v[188:191], a[108:111]
  s_and_b32 s25, s25, 0x1ffff
  v_add_f32 v227, v227, v221
  v_cvt_pk_bf16_f32 v182, v220, v221
  v_add_f32 v227, v227, v222
  v_mfma_f32_16x16x32_bf16 a[112:115], a[184:187], v[184:187], a[112:115]
  ds_read_b128 a[152:155], v3 offset:14336
  v_add_f32 v227, v227, v223
  v_max_f32 v5, v226, v227
  v_cmp_lt_f32 vcc, s81, v5
  v_mfma_f32_16x16x32_bf16 a[116:119], a[184:187], v[188:191], a[116:119]
  v_exp_f32 v216, v144
  v_mfma_f32_16x16x32_bf16 a[120:123], a[188:191], v[184:187], a[120:123]
  s_waitcnt lgkmcnt(3)
  ds_read_b128 a[156:159], v3 offset:15360
  v_cvt_pk_bf16_f32 v183, v222, v223
  v_add_u32 v3, s66, v2
  v_mfma_f32_16x16x32_bf16 a[124:127], a[188:191], v[188:191], a[124:127]
  s_cbranch_vccnz fa_stub15
fa_back15:
  v_exp_f32 v217, v145
  v_add_f32 v230, v230, v226
  v_add_f32 v231, v231, v227
fa_SSW6:
  v_mfma_f32_16x16x32_bf16 v[128:131], a[128:131], v[64:67], v[200:203]
  s_waitcnt vmcnt(12)
  v_exp_f32 v218, v146
  v_mfma_f32_16x16x32_bf16 v[136:139], a[128:131], v[68:71], v[204:207]
  s_barrier
  v_exp_f32 v219, v147
  v_mfma_f32_16x16x32_bf16 v[132:135], a[132:135], v[64:67], v[200:203]
  ds_read_b128 a[160:163], v3 offset:16384
  ds_read_b128 a[164:167], v3 offset:17408
  v_add_f32 v226, v216, v217
  v_mfma_f32_16x16x32_bf16 v[140:143], a[132:135], v[68:71], v[204:207]
  s_mov_b32 m0, s24
  v_exp_f32 v220, v148
  v_mfma_f32_16x16x32_bf16 v[128:131], a[136:139], v[72:75], v[128:131]
  ds_read_b128 a[168:171], v3 offset:18432
  buffer_load_dwordx4 v2, s[44:47], s26 offen offset:0 sc1 lds
  v_cvt_pk_bf16_f32 v184, v216, v217
  v_mfma_f32_16x16x32_bf16 v[136:139], a[136:139], v[76:79], v[136:139]
  v_exp_f32 v221, v149
  v_mfma_f32_16x16x32_bf16 v[132:135], a[140:143], v[72:75], v[132:135]
  ds_read_b128 a[172:175], v3 offset:19456
  v_add_f32 v226, v226, v218
  v_add_f32 v226, v226, v219
  v_mfma_f32_16x16x32_bf16 v[140:143], a[140:143], v[76:79], v[140:143]
  s_waitcnt lgkmcnt(4)
  v_exp_f32 v222, v150
  v_mfma_f32_16x16x32_bf16 v[128:131], a[144:147], v[80:83], v[128:131]
  s_add_u32 s14, s13, 12288
  ds_read_b128 a[176:179], v3 offset:20480
  buffer_load_dwordx4 a[48:51], v2, s[40:43], s14 offen offset:0 sc1
  v_cvt_pk_bf16_f32 v185, v218, v219
  v_mfma_f32_16x16x32_bf16 v[136:139], a[144:147], v[84:87], v[136:139]
  v_exp_f32 v223, v151
  v_mfma_f32_16x16x32_bf16 v[132:135], a[148:151], v[80:83], v[132:135]
  ds_read_b128 a[180:183], v3 offset:21504
  buffer_load_dwordx4 v2, s[44:47], s26 offen offset:1024 sc1 lds
  v_add_f32 v226, v226, v220
  v_mfma_f32_16x16x32_bf16 v[140:143], a[148:151], v[84:87], v[140:143]
  v_exp_f32 v216, v152
  v_mfma_f32_16x16x32_bf16 v[128:131], a[152:155], v[88:91], v[128:131]
  ds_read_b128 a[184:187], v3 offset:22528
  v_add_f32 v226, v226, v221
  v_cvt_pk_bf16_f32 v186, v220, v221
  v_mfma_f32_16x16x32_bf16 v[136:139], a[152:155], v[92:95], v[136:139]
  v_exp_f32 v217, v153
  v_mfma_f32_16x16x32_bf16 v[132:135], a[156:159], v[88:91], v[132:135]
  ds_read_b128 a[188:191], v3 offset:23552
  buffer_load_dwordx4 a[52:55], v2, s[40:43], s14 offen offset:1024 sc1
  v_add_f32 v226, v226, v222
  v_mfma_f32_16x16x32_bf16 v[140:143], a[156:159], v[92:95], v[140:143]
  s_waitcnt lgkmcnt(4)
  v_exp_f32 v218, v154
  v_mfma_f32_16x16x32_bf16 a[64:67], a[160:163], v[176:179], a[64:67]
  ds_read_b128 a[128:131], v3 offset:0
  v_add_f32 v226, v226, v223
  v_cvt_pk_bf16_f32 v187, v222, v223
  v_mfma_f32_16x16x32_bf16 a[68:71], a[160:163], v[180:183], a[68:71]
  v_exp_f32 v219, v155
  v_mfma_f32_16x16x32_bf16 a[72:75], a[164:167], v[176:179], a[72:75]
  ds_read_b128 a[132:135], v3 offset:1024
  buffer_load_dwordx4 v2, s[44:47], s26 offen offset:2048 sc1 lds
  v_add_f32 v227, v216, v217
  v_mfma_f32_16x16x32_bf16 a[76:79], a[164:167], v[180:183], a[76:79]
  v_exp_f32 v220, v156
  v_mfma_f32_16x16x32_bf16 a[80:83], a[168:171], v[176:179], a[80:83]
  ds_read_b128 a[136:139], v3 offset:2048
  v_cvt_pk_bf16_f32 v188, v216, v217
  v_mfma_f32_16x16x32_bf16 a[84:87], a[168:171], v[180:183], a[84:87]
  v_exp_f32 v221, v157
  v_mfma_f32_16x16x32_bf16 a[88:91], a[172:175], v[176:179], a[88:91]
  ds_read_b128 a[140:143], v3 offset:3072
  buffer_load_dwordx4 a[56:59], v2, s[40:43], s14 offen offset:2048 sc1
  v_add_f32 v227, v227, v218
  v_add_f32 v227, v227, v219
  v_mfma_f32_16x16x32_bf16 a[92:95], a[172:175], v[180:183], a[92:95]
  s_waitcnt lgkmcnt(4)
  v_exp_f32 v222, v158
  v_mfma_f32_16x16x32_bf16 a[96:99], a[176:179], v[176:179], a[96:99]
  ds_read_b128 a[144:147], v3 offset:4096
  buffer_load_dwordx4 v2, s[44:47], s26 offen offset:3072 sc1 lds
  v_cvt_pk_bf16_f32 v189, v218, v219
  v_mfma_f32_16x16x32_bf16 a[100:103], a[176:179], v[180:183], a[100:103]
  s_add_u32 s26, s26, 16384
  v_exp_f32 v223, v159
  v_mfma_f32_16x16x32_bf16 a[104:107], a[180:183], v[176:179], a[104:107]
  s_add_u32 s24, s24, 32768
  ds_read_b128 a[148:151], v3 offset:5120
  v_add_f32 v227, v227, v220
  v_mfma_f32_16x16x32_bf16 a[108:111], a[180:183], v[180:183], a[108:111]
  s_and_b32 s24, s24, 0x1ffff
  v_add_f32 v227, v227, v221
  v_cvt_pk_bf16_f32 v190, v220, v221
  v_add_f32 v227, v227, v222
  v_mfma_f32_16x16x32_bf16 a[112:115], a[184:187], v[176:179], a[112:115]
  ds_read_b128 a[152:155], v3 offset:6144
  v_add_f32 v227, v227, v223
  v_max_f32 v5, v226, v227
  v_cmp_lt_f32 vcc, s81, v5
  v_mfma_f32_16x16x32_bf16 a[116:119], a[184:187], v[180:183], a[116:119]
  v_exp_f32 v216, v128
  v_mfma_f32_16x16x32_bf16 a[120:123], a[188:191], v[176:179], a[120:123]
  s_waitcnt lgkmcnt(3)
  ds_read_b128 a[156:159], v3 offset:7168
  v_cvt_pk_bf16_f32 v191, v222, v223
  v_mfma_f32_16x16x32_bf16 a[124:127], a[188:191], v[180:183], a[124:127]
  s_cbranch_vccnz fa_stub16
fa_back16:
  v_exp_f32 v217, v129
  v_add_f32 v230, v230, v226
  v_add_f32 v231, v231, v227
  v_mfma_f32_16x16x32_bf16 v[144:147], a[128:131], v[64:67], v[200:203]
  ds_read_b128 a[160:163], v3 offset:24576
  v_add_f32 v226, v216, v217
  v_mfma_f32_16x16x32_bf16 v[152:155], a[128:131], v[68:71], v[204:207]
  v_exp_f32 v218, v130
  v_mfma_f32_16x16x32_bf16 v[148:151], a[132:135], v[64:67], v[200:203]
  s_add_u32 s66, s66, 32768
  ds_read_b128 a[164:167], v3 offset:25600
  v_cvt_pk_bf16_f32 v176, v216, v217
  v_mfma_f32_16x16x32_bf16 v[156:159], a[132:135], v[68:71], v[204:207]
  s_mov_b32 m0, s25
  v_exp_f32 v219, v131
  v_mfma_f32_16x16x32_bf16 v[144:147], a[136:139], v[72:75], v[144:147]
  s_and_b32 s66, s66, 0x1ffff
  ds_read_b128 a[168:171], v3 offset:26624
  buffer_load_dwordx4 v2, s[48:51], s27 offen offset:0 sc1 lds
  v_add_f32 v226, v226, v218
  v_add_f32 v226, v226, v219
  v_mfma_f32_16x16x32_bf16 v[152:155], a[136:139], v[76:79], v[152:155]
  v_exp_f32 v220, v132
  v_mfma_f32_16x16x32_bf16 v[148:151], a[140:143], v[72:75], v[148:151]
  ds_read_b128 a[172:175], v3 offset:27648
  v_cvt_pk_bf16_f32 v177, v218, v219
  v_mfma_f32_16x16x32_bf16 v[156:159], a[140:143], v[76:79], v[156:159]
  s_waitcnt lgkmcnt(4)
  v_exp_f32 v221, v133
  v_mfma_f32_16x16x32_bf16 v[144:147], a[144:147], v[80:83], v[144:147]
  s_add_u32 s14, s13, 12288
  ds_read_b128 a[176:179], v3 offset:28672
  buffer_load_dwordx4 a[60:63], v2, s[40:43], s14 offen offset:3072 sc1
  v_add_f32 v226, v226, v220
  v_mfma_f32_16x16x32_bf16 v[152:155], a[144:147], v[84:87], v[152:155]
  v_exp_f32 v222, v134
  v_mfma_f32_16x16x32_bf16 v[148:151], a[148:151], v[80:83], v[148:151]
  ds_read_b128 a[180:183], v3 offset:29696
  buffer_load_dwordx4 v2, s[48:51], s27 offen offset:1024 sc1 lds
  v_add_f32 v226, v226, v221
  v_cvt_pk_bf16_f32 v178, v220, v221
  v_mfma_f32_16x16x32_bf16 v[156:159], a[148:151], v[84:87], v[156:159]
  v_exp_f32 v223, v135
  v_mfma_f32_16x16x32_bf16 v[144:147], a[152:155], v[88:91], v[144:147]
  ds_read_b128 a[184:187], v3 offset:30720
  v_add_f32 v226, v226, v222
  v_mfma_f32_16x16x32_bf16 v[152:155], a[152:155], v[92:95], v[152:155]
  v_exp_f32 v216, v136
  v_mfma_f32_16x16x32_bf16 v[148:151], a[156:159], v[88:91], v[148:151]
  s_add_u32 s14, s13, 16384
  ds_read_b128 a[188:191], v3 offset:31744
  buffer_load_dwordx4 a[192:195], v2, s[40:43], s14 offen offset:0 sc1
  v_add_f32 v226, v226, v223
  v_exp_f32 v217, v137
  v_mfma_f32_16x16x32_bf16 v[156:159], a[156:159], v[92:95], v[156:159]
  s_waitcnt lgkmcnt(4)
  v_exp_f32 v218, v138
  v_mfma_f32_16x16x32_bf16 a[64:67], a[160:163], v[184:187], a[64:67]
  ds_read_b128 a[128:131], v3 offset:8192
  v_cvt_pk_bf16_f32 v179, v222, v223
  v_mfma_f32_16x16x32_bf16 a[68:71], a[160:163], v[188:191], a[68:71]
  v_exp_f32 v219, v139
  v_mfma_f32_16x16x32_bf16 a[72:75], a[164:167], v[184:187], a[72:75]
  ds_read_b128 a[132:135], v3 offset:9216
  buffer_load_dwordx4 v2, s[48:51], s27 offen offset:2048 sc1 lds
  v_add_f32 v227, v216, v217
  v_mfma_f32_16x16x32_bf16 a[76:79], a[164:167], v[188:191], a[76:79]
  v_exp_f32 v220, v140
  v_mfma_f32_16x16x32_bf16 a[80:83], a[168:171], v[184:187], a[80:83]
  ds_read_b128 a[136:139], v3 offset:10240
  v_cvt_pk_bf16_f32 v180, v216, v217
  v_mfma_f32_16x16x32_bf16 a[84:87], a[168:171], v[188:191], a[84:87]
  v_exp_f32 v221, v141
  v_mfma_f32_16x16x32_bf16 a[88:91], a[172:175], v[184:187], a[88:91]
  ds_read_b128 a[140:143], v3 offset:11264
  buffer_load_dwordx4 a[196:199], v2, s[40:43], s14 offen offset:1024 sc1
  v_add_f32 v227, v227, v218
  v_mfma_f32_16x16x32_bf16 a[92:95], a[172:175], v[188:191], a[92:95]
  s_waitcnt lgkmcnt(4)
  v_exp_f32 v222, v142
  v_mfma_f32_16x16x32_bf16 a[96:99], a[176:179], v[184:187], a[96:99]
  ds_read_b128 a[144:147], v3 offset:12288
  buffer_load_dwordx4 v2, s[48:51], s27 offen offset:3072 sc1 lds
  v_add_f32 v227, v227, v219
  v_cvt_pk_bf16_f32 v181, v218, v219
  v_mfma_f32_16x16x32_bf16 a[100:103], a[176:179], v[188:191], a[100:103]
  s_add_u32 s27, s27, 16384
  v_exp_f32 v223, v143
  v_mfma_f32_16x16x32_bf16 a[104:107], a[180:183], v[184:187], a[104:107]
  s_add_u32 s25, s25, 32768
  ds_read_b128 a[148:151], v3 offset:13312
  v_add_f32 v227, v227, v220
  v_mfma_f32_16x16x32_bf16 a[108:111], a[180:183], v[188:191], a[108:111]
  s_and_b32 s25, s25, 0x1ffff
  v_add_f32 v227, v227, v221
  v_cvt_pk_bf16_f32 v182, v220, v221
  v_add_f32 v227, v227, v222
  v_mfma_f32_16x16x32_bf16 a[112:115], a[184:187], v[184:187], a[112:115]
  ds_read_b128 a[152:155], v3 offset:14336
  v_add_f32 v227, v227, v223
  v_max_f32 v5, v226, v227
  v_cmp_lt_f32 vcc, s81, v5
  v_mfma_f32_16x16x32_bf16 a[116:119], a[184:187], v[188:191], a[116:119]
  v_exp_f32 v216, v144
  v_mfma_f32_16x16x32_bf16 a[120:123], a[188:191], v[184:187], a[120:123]
  s_waitcnt lgkmcnt(3)
  ds_read_b128 a[156:159], v3 offset:15360
  v_cvt_pk_bf16_f32 v183, v222, v223
  v_add_u32 v3, s66, v2
  v_mfma_f32_16x16x32_bf16 a[124:127], a[188:191], v[188:191], a[124:127]
  s_cbranch_vccnz fa_stub17
fa_back17:
  v_exp_f32 v217, v145
  v_add_f32 v230, v230, v226
  v_add_f32 v231, v231, v227
fa_SSW5:
  v_mfma_f32_16x16x32_bf16 v[128:131], a[128:131], v[64:67], v[200:203]
  s_waitcnt vmcnt(12)
  v_exp_f32 v218, v146
  v_mfma_f32_16x16x32_bf16 v[136:139], a[128:131], v[68:71], v[204:207]
  s_barrier
  v_exp_f32 v219, v147
  v_mfma_f32_16x16x32_bf16 v[132:135], a[132:135], v[64:67], v[200:203]
  ds_read_b128 a[160:163], v3 offset:16384
  ds_read_b128 a[164:167], v3 offset:17408
  v_add_f32 v226, v216, v217
  v_mfma_f32_16x16x32_bf16 v[140:143], a[132:135], v[68:71], v[204:207]
  s_mov_b32 m0, s24
  v_exp_f32 v220, v148
  v_mfma_f32_16x16x32_bf16 v[128:131], a[136:139], v[72:75], v[128:131]
  ds_read_b128 a[168:171], v3 offset:18432
  buffer_load_dwordx4 v2, s[44:47], s26 offen offset:0 sc1 lds
  v_cvt_pk_bf16_f32 v184, v216, v217
  v_mfma_f32_16x16x32_bf16 v[136:139], a[136:139], v[76:79], v[136:139]
  v_exp_f32 v221, v149
  v_mfma_f32_16x16x32_bf16 v[132:135], a[140:143], v[72:75], v[132:135]
  ds_read_b128 a[172:175], v3 offset:19456
  v_add_f32 v226, v226, v218
  v_add_f32 v226, v226, v219
  v_mfma_f32_16x16x32_bf16 v[140:143], a[140:143], v[76:79], v[140:143]
  s_waitcnt lgkmcnt(4)
  v_exp_f32 v222, v150
  v_mfma_f32_16x16x32_bf16 v[128:131], a[144:147], v[80:83], v[128:131]
  s_add_u32 s14, s13, 16384
  ds_read_b128 a[176:179], v3 offset:20480
  buffer_load_dwordx4 a[200:203], v2, s[40:43], s14 offen offset:2048 sc1
  v_cvt_pk_bf16_f32 v185, v218, v219
  v_mfma_f32_16x16x32_bf16 v[136:139], a[144:147], v[84:87], v[136:139]
  v_exp_f32 v223, v151
  v_mfma_f32_16x16x32_bf16 v[132:135], a[148:151], v[80:83], v[132:135]
  ds_read_b128 a[180:183], v3 offset:21504
  buffer_load_dwordx4 v2, s[44:47], s26 offen offset:1024 sc1 lds
  v_add_f32 v226, v226, v220
  v_mfma_f32_16x16x32_bf16 v[140:143], a[148:151], v[84:87], v[140:143]
  v_exp_f32 v216, v152
  v_mfma_f32_16x16x32_bf16 v[128:131], a[152:155], v[88:91], v[128:131]
  ds_read_b128 a[184:187], v3 offset:22528
  v_add_f32 v226, v226, v221
  v_cvt_pk_bf16_f32 v186, v220, v221
  v_mfma_f32_16x16x32_bf16 v[136:139], a[152:155], v[92:95], v[136:139]
  v_exp_f32 v217, v153
  v_mfma_f32_16x16x32_bf16 v[132:135], a[156:159], v[88:91], v[132:135]
  ds_read_b128 a[188:191], v3 offset:23552
  buffer_load_dwordx4 a[204:207], v2, s[40:43], s14 offen offset:3072 sc1
  v_add_f32 v226, v226, v222
  v_mfma_f32_16x16x32_bf16 v[140:143], a[156:159], v[92:95], v[140:143]
  s_waitcnt lgkmcnt(4)
  v_exp_f32 v218, v154
  v_mfma_f32_16x16x32_bf16 a[64:67], a[160:163], v[176:179], a[64:67]
  ds_read_b128 a[128:131], v3 offset:0
  v_add_f32 v226, v226, v223
  v_cvt_pk_bf16_f32 v187, v222, v223
  v_mfma_f32_16x16x32_bf16 a[68:71], a[160:163], v[180:183], a[68:71]
  v_exp_f32 v219, v155
  v_mfma_f32_16x16x32_bf16 a[72:75], a[164:167], v[176:179], a[72:75]
  ds_read_b128 a[132:135], v3 offset:1024
  buffer_load_dwordx4 v2, s[44:47], s26 offen offset:2048 sc1 lds
  v_add_f32 v227, v216, v217
  v_mfma_f32_16x16x32_bf16 a[76:79], a[164:167], v[180:183], a[76:79]
  v_exp_f32 v220, v156
  v_mfma_f32_16x16x32_bf16 a[80:83], a[168:171], v[176:179], a[80:83]
  ds_read_b128 a[136:139], v3 offset:2048
  v_cvt_pk_bf16_f32 v188, v216, v217
  v_mfma_f32_16x16x32_bf16 a[84:87], a[168:171], v[180:183], a[84:87]
  v_exp_f32 v221, v157
  v_mfma_f32_16x16x32_bf16 a[88:91], a[172:175], v[176:179], a[88:91]
  s_add_u32 s14, s13, 20480
  ds_read_b128 a[140:143], v3 offset:3072
  buffer_load_dwordx4 a[208:211], v2, s[40:43], s14 offen offset:0 sc1
  v_add_f32 v227, v227, v218
  v_add_f32 v227, v227, v219
  v_mfma_f32_16x16x32_bf16 a[92:95], a[172:175], v[180:183], a[92:95]
  s_waitcnt lgkmcnt(4)
  v_exp_f32 v222, v158
  v_mfma_f32_16x16x32_bf16 a[96:99], a[176:179], v[176:179], a[96:99]
  ds_read_b128 a[144:147], v3 offset:4096
  buffer_load_dwordx4 v2, s[44:47], s26 offen offset:3072 sc1 lds
  v_cvt_pk_bf16_f32 v189, v218, v219
  v_mfma_f32_16x16x32_bf16 a[100:103], a[176:179], v[180:183], a[100:103]
  s_add_u32 s26, s26, 16384
  v_exp_f32 v223, v159
  v_mfma_f32_16x16x32_bf16 a[104:107], a[180:183], v[176:179], a[104:107]
  s_add_u32 s24, s24, 32768
  ds_read_b128 a[148:151], v3 offset:5120
  v_add_f32 v227, v227, v220
  v_mfma_f32_16x16x32_bf16 a[108:111], a[180:183], v[180:183], a[108:111]
  s_and_b32 s24, s24, 0x1ffff
  v_add_f32 v227, v227, v221
  v_cvt_pk_bf16_f32 v190, v220, v221
  v_add_f32 v227, v227, v222
  v_mfma_f32_16x16x32_bf16 a[112:115], a[184:187], v[176:179], a[112:115]
  ds_read_b128 a[152:155], v3 offset:6144
  v_add_f32 v227, v227, v223
  v_max_f32 v5, v226, v227
  v_cmp_lt_f32 vcc, s81, v5
  v_mfma_f32_16x16x32_bf16 a[116:119], a[184:187], v[180:183], a[116:119]
  v_exp_f32 v216, v128
  v_mfma_f32_16x16x32_bf16 a[120:123], a[188:191], v[176:179], a[120:123]
  s_waitcnt lgkmcnt(3)
  ds_read_b128 a[156:159], v3 offset:7168
  v_cvt_pk_bf16_f32 v191, v222, v223
  v_mfma_f32_16x16x32_bf16 a[124:127], a[188:191], v[180:183], a[124:127]
  s_cbranch_vccnz fa_stub18
fa_back18:
  v_exp_f32 v217, v129
  v_add_f32 v230, v230, v226
  v_add_f32 v231, v231, v227
  v_mfma_f32_16x16x32_bf16 v[144:147], a[128:131], v[64:67], v[200:203]
  ds_read_b128 a[160:163], v3 offset:24576
  v_add_f32 v226, v216, v217
  v_mfma_f32_16x16x32_bf16 v[152:155], a[128:131], v[68:71], v[204:207]
  v_exp_f32 v218, v130
  v_mfma_f32_16x16x32_bf16 v[148:151], a[132:135], v[64:67], v[200:203]
  s_add_u32 s66, s66, 32768
  ds_read_b128 a[164:167], v3 offset:25600
  v_cvt_pk_bf16_f32 v176, v216, v217
  v_mfma_f32_16x16x32_bf16 v[156:159], a[132:135], v[68:71], v[204:207]
  s_mov_b32 m0, s25
  v_exp_f32 v219, v131
  v_mfma_f32_16x16x32_bf16 v[144:147], a[136:139], v[72:75], v[144:147]
  s_and_b32 s66, s66, 0x1ffff
  ds_read_b128 a[168:171], v3 offset:26624
  buffer_load_dwordx4 v2, s[48:51], s27 offen offset:0 sc1 lds
  v_add_f32 v226, v226, v218
  v_add_f32 v226, v226, v219
  v_mfma_f32_16x16x32_bf16 v[152:155], a[136:139], v[76:79], v[152:155]
  v_exp_f32 v220, v132
  v_mfma_f32_16x16x32_bf16 v[148:151], a[140:143], v[72:75], v[148:151]
  ds_read_b128 a[172:175], v3 offset:27648
  v_cvt_pk_bf16_f32 v177, v218, v219
  v_mfma_f32_16x16x32_bf16 v[156:159], a[140:143], v[76:79], v[156:159]
  s_waitcnt lgkmcnt(4)
  v_exp_f32 v221, v133
  v_mfma_f32_16x16x32_bf16 v[144:147], a[144:147], v[80:83], v[144:147]
  s_add_u32 s14, s13, 20480
  ds_read_b128 a[176:179], v3 offset:28672
  buffer_load_dwordx4 a[212:215], v2, s[40:43], s14 offen offset:1024 sc1
  v_add_f32 v226, v226, v220
  v_mfma_f32_16x16x32_bf16 v[152:155], a[144:147], v[84:87], v[152:155]
  v_exp_f32 v222, v134
  v_mfma_f32_16x16x32_bf16 v[148:151], a[148:151], v[80:83], v[148:151]
  ds_read_b128 a[180:183], v3 offset:29696
  buffer_load_dwordx4 v2, s[48:51], s27 offen offset:1024 sc1 lds
  v_add_f32 v226, v226, v221
  v_cvt_pk_bf16_f32 v178, v220, v221
  v_mfma_f32_16x16x32_bf16 v[156:159], a[148:151], v[84:87], v[156:159]
  v_exp_f32 v223, v135
  v_mfma_f32_16x16x32_bf16 v[144:147], a[152:155], v[88:91], v[144:147]
  ds_read_b128 a[184:187], v3 offset:30720
  v_add_f32 v226, v226, v222
  v_mfma_f32_16x16x32_bf16 v[152:155], a[152:155], v[92:95], v[152:155]
  v_exp_f32 v216, v136
  v_mfma_f32_16x16x32_bf16 v[148:151], a[156:159], v[88:91], v[148:151]
  ds_read_b128 a[188:191], v3 offset:31744
  buffer_load_dwordx4 a[216:219], v2, s[40:43], s14 offen offset:2048 sc1
  v_add_f32 v226, v226, v223
  v_exp_f32 v217, v137
  v_mfma_f32_16x16x32_bf16 v[156:159], a[156:159], v[92:95], v[156:159]
  s_waitcnt lgkmcnt(4)
  v_exp_f32 v218, v138
  v_mfma_f32_16x16x32_bf16 a[64:67], a[160:163], v[184:187], a[64:67]
  ds_read_b128 a[128:131], v3 offset:8192
  v_cvt_pk_bf16_f32 v179, v222, v223
  v_mfma_f32_16x16x32_bf16 a[68:71], a[160:163], v[188:191], a[68:71]
  v_exp_f32 v219, v139
  v_mfma_f32_16x16x32_bf16 a[72:75], a[164:167], v[184:187], a[72:75]
  ds_read_b128 a[132:135], v3 offset:9216
  buffer_load_dwordx4 v2, s[48:51], s27 offen offset:2048 sc1 lds
  v_add_f32 v227, v216, v217
  v_mfma_f32_16x16x32_bf16 a[76:79], a[164:167], v[188:191], a[76:79]
  v_exp_f32 v220, v140
  v_mfma_f32_16x16x32_bf16 a[80:83], a[168:171], v[184:187], a[80:83]
  ds_read_b128 a[136:139], v3 offset:10240
  v_cvt_pk_bf16_f32 v180, v216, v217
  v_mfma_f32_16x16x32_bf16 a[84:87], a[168:171], v[188:191], a[84:87]
  v_exp_f32 v221, v141
  v_mfma_f32_16x16x32_bf16 a[88:91], a[172:175], v[184:187], a[88:91]
  ds_read_b128 a[140:143], v3 offset:11264
  buffer_load_dwordx4 a[220:223], v2, s[40:43], s14 offen offset:3072 sc1
  v_add_f32 v227, v227, v218
  v_mfma_f32_16x16x32_bf16 a[92:95], a[172:175], v[188:191], a[92:95]
  s_waitcnt lgkmcnt(4)
  v_exp_f32 v222, v142
  v_mfma_f32_16x16x32_bf16 a[96:99], a[176:179], v[184:187], a[96:99]
  ds_read_b128 a[144:147], v3 offset:12288
  buffer_load_dwordx4 v2, s[48:51], s27 offen offset:3072 sc1 lds
  v_add_f32 v227, v227, v219
  v_cvt_pk_bf16_f32 v181, v218, v219
  v_mfma_f32_16x16x32_bf16 a[100:103], a[176:179], v[188:191], a[100:103]
  s_add_u32 s27, s27, 16384
  v_exp_f32 v223, v143
  v_mfma_f32_16x16x32_bf16 a[104:107], a[180:183], v[184:187], a[104:107]
  s_add_u32 s25, s25, 32768
  ds_read_b128 a[148:151], v3 offset:13312
  v_add_f32 v227, v227, v220
  v_mfma_f32_16x16x32_bf16 a[108:111], a[180:183], v[188:191], a[108:111]
  s_and_b32 s25, s25, 0x1ffff
  v_add_f32 v227, v227, v221
  v_cvt_pk_bf16_f32 v182, v220, v221
  v_add_f32 v227, v227, v222
  v_mfma_f32_16x16x32_bf16 a[112:115], a[184:187], v[184:187], a[112:115]
  ds_read_b128 a[152:155], v3 offset:14336
  v_add_f32 v227, v227, v223
  v_max_f32 v5, v226, v227
  v_cmp_lt_f32 vcc, s81, v5
  v_mfma_f32_16x16x32_bf16 a[116:119], a[184:187], v[188:191], a[116:119]
  v_exp_f32 v216, v144
  v_mfma_f32_16x16x32_bf16 a[120:123], a[188:191], v[184:187], a[120:123]
  s_waitcnt lgkmcnt(3)
  ds_read_b128 a[156:159], v3 offset:15360
  v_cvt_pk_bf16_f32 v183, v222, v223
  v_add_u32 v3, s66, v2
  v_mfma_f32_16x16x32_bf16 a[124:127], a[188:191], v[188:191], a[124:127]
  s_cbranch_vccnz fa_stub19
fa_back19:
  v_exp_f32 v217, v145
  v_add_f32 v230, v230, v226
  v_add_f32 v231, v231, v227
fa_SSW4:
  v_mfma_f32_16x16x32_bf16 v[128:131], a[128:131], v[64:67], v[200:203]
  s_waitcnt vmcnt(12)
  v_exp_f32 v218, v146
  v_mfma_f32_16x16x32_bf16 v[136:139], a[128:131], v[68:71], v[204:207]
  s_barrier
  v_exp_f32 v219, v147
  v_mfma_f32_16x16x32_bf16 v[132:135], a[132:135], v[64:67], v[200:203]
  ds_read_b128 a[160:163], v3 offset:16384
  ds_read_b128 a[164:167], v3 offset:17408
  v_add_f32 v226, v216, v217
  v_mfma_f32_16x16x32_bf16 v[140:143], a[132:135], v[68:71], v[204:207]
  s_mov_b32 m0, s24
  v_exp_f32 v220, v148
  v_mfma_f32_16x16x32_bf16 v[128:131], a[136:139], v[72:75], v[128:131]
  ds_read_b128 a[168:171], v3 offset:18432
  buffer_load_dwordx4 v2, s[44:47], s26 offen offset:0 sc1 lds
  v_cvt_pk_bf16_f32 v184, v216, v217
  v_mfma_f32_16x16x32_bf16 v[136:139], a[136:139], v[76:79], v[136:139]
  v_exp_f32 v221, v149
  v_mfma_f32_16x16x32_bf16 v[132:135], a[140:143], v[72:75], v[132:135]
  ds_read_b128 a[172:175], v3 offset:19456
  v_add_f32 v226, v226, v218
  v_add_f32 v226, v226, v219
  v_mfma_f32_16x16x32_bf16 v[140:143], a[140:143], v[76:79], v[140:143]
  s_waitcnt lgkmcnt(4)
  v_exp_f32 v222, v150
  v_mfma_f32_16x16x32_bf16 v[128:131], a[144:147], v[80:83], v[128:131]
  s_add_u32 s14, s13, 24576
  ds_read_b128 a[176:179], v3 offset:20480
  buffer_load_dwordx4 a[224:227], v2, s[40:43], s14 offen offset:0 sc1
  v_cvt_pk_bf16_f32 v185, v218, v219
  v_mfma_f32_16x16x32_bf16 v[136:139], a[144:147], v[84:87], v[136:139]
  v_exp_f32 v223, v151
  v_mfma_f32_16x16x32_bf16 v[132:135], a[148:151], v[80:83], v[132:135]
  ds_read_b128 a[180:183], v3 offset:21504
  buffer_load_dwordx4 v2, s[44:47], s26 offen offset:1024 sc1 lds
  v_add_f32 v226, v226, v220
  v_mfma_f32_16x16x32_bf16 v[140:143], a[148:151], v[84:87], v[140:143]
  v_exp_f32 v216, v152
  v_mfma_f32_16x16x32_bf16 v[128:131], a[152:155], v[88:91], v[128:131]
  ds_read_b128 a[184:187], v3 offset:22528
  v_add_f32 v226, v226, v221
  v_cvt_pk_bf16_f32 v186, v220, v221
  v_mfma_f32_16x16x32_bf16 v[136:139], a[152:155], v[92:95], v[136:139]
  v_exp_f32 v217, v153
  v_mfma_f32_16x16x32_bf16 v[132:135], a[156:159], v[88:91], v[132:135]
  ds_read_b128 a[188:191], v3 offset:23552
  buffer_load_dwordx4 a[228:231], v2, s[40:43], s14 offen offset:1024 sc1
  v_add_f32 v226, v226, v222
  v_mfma_f32_16x16x32_bf16 v[140:143], a[156:159], v[92:95], v[140:143]
  s_waitcnt lgkmcnt(4)
  v_exp_f32 v218, v154
  v_mfma_f32_16x16x32_bf16 a[64:67], a[160:163], v[176:179], a[64:67]
  ds_read_b128 a[128:131], v3 offset:0
  v_add_f32 v226, v226, v223
  v_cvt_pk_bf16_f32 v187, v222, v223
  v_mfma_f32_16x16x32_bf16 a[68:71], a[160:163], v[180:183], a[68:71]
  v_exp_f32 v219, v155
  v_mfma_f32_16x16x32_bf16 a[72:75], a[164:167], v[176:179], a[72:75]
  ds_read_b128 a[132:135], v3 offset:1024
  buffer_load_dwordx4 v2, s[44:47], s26 offen offset:2048 sc1 lds
  v_add_f32 v227, v216, v217
  v_mfma_f32_16x16x32_bf16 a[76:79], a[164:167], v[180:183], a[76:79]
  v_exp_f32 v220, v156
  v_mfma_f32_16x16x32_bf16 a[80:83], a[168:171], v[176:179], a[80:83]
  ds_read_b128 a[136:139], v3 offset:2048
  v_cvt_pk_bf16_f32 v188, v216, v217
  v_mfma_f32_16x16x32_bf16 a[84:87], a[168:171], v[180:183], a[84:87]
  v_exp_f32 v221, v157
  v_mfma_f32_16x16x32_bf16 a[88:91], a[172:175], v[176:179], a[88:91]
  ds_read_b128 a[140:143], v3 offset:3072
  buffer_load_dwordx4 a[232:235], v2, s[40:43], s14 offen offset:2048 sc1
  v_add_f32 v227, v227, v218
  v_add_f32 v227, v227, v219
  v_mfma_f32_16x16x32_bf16 a[92:95], a[172:175], v[180:183], a[92:95]
  s_waitcnt lgkmcnt(4)
  v_exp_f32 v222, v158
  v_mfma_f32_16x16x32_bf16 a[96:99], a[176:179], v[176:179], a[96:99]
  ds_read_b128 a[144:147], v3 offset:4096
  buffer_load_dwordx4 v2, s[44:47], s26 offen offset:3072 sc1 lds
  v_cvt_pk_bf16_f32 v189, v218, v219
  v_mfma_f32_16x16x32_bf16 a[100:103], a[176:179], v[180:183], a[100:103]
  s_add_u32 s26, s26, 16384
  v_exp_f32 v223, v159
  v_mfma_f32_16x16x32_bf16 a[104:107], a[180:183], v[176:179], a[104:107]
  s_add_u32 s24, s24, 32768
  ds_read_b128 a[148:151], v3 offset:5120
  v_add_f32 v227, v227, v220
  v_mfma_f32_16x16x32_bf16 a[108:111], a[180:183], v[180:183], a[108:111]
  s_and_b32 s24, s24, 0x1ffff
  v_add_f32 v227, v227, v221
  v_cvt_pk_bf16_f32 v190, v220, v221
  v_add_f32 v227, v227, v222
  v_mfma_f32_16x16x32_bf16 a[112:115], a[184:187], v[176:179], a[112:115]
  ds_read_b128 a[152:155], v3 offset:6144
  v_add_f32 v227, v227, v223
  v_max_f32 v5, v226, v227
  v_cmp_lt_f32 vcc, s81, v5
  v_mfma_f32_16x16x32_bf16 a[116:119], a[184:187], v[180:183], a[116:119]
  v_exp_f32 v216, v128
  v_mfma_f32_16x16x32_bf16 a[120:123], a[188:191], v[176:179], a[120:123]
  s_waitcnt lgkmcnt(3)
  ds_read_b128 a[156:159], v3 offset:7168
  v_cvt_pk_bf16_f32 v191, v222, v223
  v_mfma_f32_16x16x32_bf16 a[124:127], a[188:191], v[180:183], a[124:127]
  s_cbranch_vccnz fa_stub20
fa_back20:
  v_exp_f32 v217, v129
  v_add_f32 v230, v230, v226
  v_add_f32 v231, v231, v227
  v_mfma_f32_16x16x32_bf16 v[144:147], a[128:131], v[64:67], v[200:203]
  ds_read_b128 a[160:163], v3 offset:24576
  v_add_f32 v226, v216, v217
  v_mfma_f32_16x16x32_bf16 v[152:155], a[128:131], v[68:71], v[204:207]
  v_exp_f32 v218, v130
  v_mfma_f32_16x16x32_bf16 v[148:151], a[132:135], v[64:67], v[200:203]
  s_add_u32 s66, s66, 32768
  ds_read_b128 a[164:167], v3 offset:25600
  v_cvt_pk_bf16_f32 v176, v216, v217
  v_mfma_f32_16x16x32_bf16 v[156:159], a[132:135], v[68:71], v[204:207]
  s_mov_b32 m0, s25
  v_exp_f32 v219, v131
  v_mfma_f32_16x16x32_bf16 v[144:147], a[136:139], v[72:75], v[144:147]
  s_and_b32 s66, s66, 0x1ffff
  ds_read_b128 a[168:171], v3 offset:26624
  buffer_load_dwordx4 v2, s[48:51], s27 offen offset:0 sc1 lds
  v_add_f32 v226, v226, v218
  v_add_f32 v226, v226, v219
  v_mfma_f32_16x16x32_bf16 v[152:155], a[136:139], v[76:79], v[152:155]
  v_exp_f32 v220, v132
  v_mfma_f32_16x16x32_bf16 v[148:151], a[140:143], v[72:75], v[148:151]
  ds_read_b128 a[172:175], v3 offset:27648
  v_cvt_pk_bf16_f32 v177, v218, v219
  v_mfma_f32_16x16x32_bf16 v[156:159], a[140:143], v[76:79], v[156:159]
  s_waitcnt lgkmcnt(4)
  v_exp_f32 v221, v133
  v_mfma_f32_16x16x32_bf16 v[144:147], a[144:147], v[80:83], v[144:147]
  s_add_u32 s14, s13, 24576
  ds_read_b128 a[176:179], v3 offset:28672
  buffer_load_dwordx4 a[236:239], v2, s[40:43], s14 offen offset:3072 sc1
  v_add_f32 v226, v226, v220
  v_mfma_f32_16x16x32_bf16 v[152:155], a[144:147], v[84:87], v[152:155]
  v_exp_f32 v222, v134
  v_mfma_f32_16x16x32_bf16 v[148:151], a[148:151], v[80:83], v[148:151]
  ds_read_b128 a[180:183], v3 offset:29696
  buffer_load_dwordx4 v2, s[48:51], s27 offen offset:1024 sc1 lds
  v_add_f32 v226, v226, v221
  v_cvt_pk_bf16_f32 v178, v220, v221
  v_mfma_f32_16x16x32_bf16 v[156:159], a[148:151], v[84:87], v[156:159]
  v_exp_f32 v223, v135
  v_mfma_f32_16x16x32_bf16 v[144:147], a[152:155], v[88:91], v[144:147]
  ds_read_b128 a[184:187], v3 offset:30720
  v_add_f32 v226, v226, v222
  v_mfma_f32_16x16x32_bf16 v[152:155], a[152:155], v[92:95], v[152:155]
  v_exp_f32 v216, v136
  v_mfma_f32_16x16x32_bf16 v[148:151], a[156:159], v[88:91], v[148:151]
  s_add_u32 s14, s13, 28672
  ds_read_b128 a[188:191], v3 offset:31744
  buffer_load_dwordx4 a[240:243], v2, s[40:43], s14 offen offset:0 sc1
  v_add_f32 v226, v226, v223
  v_exp_f32 v217, v137
  v_mfma_f32_16x16x32_bf16 v[156:159], a[156:159], v[92:95], v[156:159]
  s_waitcnt lgkmcnt(4)
  v_exp_f32 v218, v138
  v_mfma_f32_16x16x32_bf16 a[64:67], a[160:163], v[184:187], a[64:67]
  ds_read_b128 a[128:131], v3 offset:8192
  v_cvt_pk_bf16_f32 v179, v222, v223
  v_mfma_f32_16x16x32_bf16 a[68:71], a[160:163], v[188:191], a[68:71]
  v_exp_f32 v219, v139
  v_mfma_f32_16x16x32_bf16 a[72:75], a[164:167], v[184:187], a[72:75]
  ds_read_b128 a[132:135], v3 offset:9216
  buffer_load_dwordx4 v2, s[48:51], s27 offen offset:2048 sc1 lds
  v_add_f32 v227, v216, v217
  v_mfma_f32_16x16x32_bf16 a[76:79], a[164:167], v[188:191], a[76:79]
  v_exp_f32 v220, v140
  v_mfma_f32_16x16x32_bf16 a[80:83], a[168:171], v[184:187], a[80:83]
  ds_read_b128 a[136:139], v3 offset:10240
  v_cvt_pk_bf16_f32 v180, v216, v217
  v_mfma_f32_16x16x32_bf16 a[84:87], a[168:171], v[188:191], a[84:87]
  v_exp_f32 v221, v141
  v_mfma_f32_16x16x32_bf16 a[88:91], a[172:175], v[184:187], a[88:91]
  ds_read_b128 a[140:143], v3 offset:11264
  buffer_load_dwordx4 a[244:247], v2, s[40:43], s14 offen offset:1024 sc1
  v_add_f32 v227, v227, v218
  v_mfma_f32_16x16x32_bf16 a[92:95], a[172:175], v[188:191], a[92:95]
  s_waitcnt lgkmcnt(4)
  v_exp_f32 v222, v142
  v_mfma_f32_16x16x32_bf16 a[96:99], a[176:179], v[184:187], a[96:99]
  ds_read_b128 a[144:147], v3 offset:12288
  buffer_load_dwordx4 v2, s[48:51], s27 offen offset:3072 sc1 lds
  v_add_f32 v227, v227, v219
  v_cvt_pk_bf16_f32 v181, v218, v219
  v_mfma_f32_16x16x32_bf16 a[100:103], a[176:179], v[188:191], a[100:103]
  s_add_u32 s27, s27, 16384
  v_exp_f32 v223, v143
  v_mfma_f32_16x16x32_bf16 a[104:107], a[180:183], v[184:187], a[104:107]
  s_add_u32 s25, s25, 32768
  ds_read_b128 a[148:151], v3 offset:13312
  v_add_f32 v227, v227, v220
  v_mfma_f32_16x16x32_bf16 a[108:111], a[180:183], v[188:191], a[108:111]
  s_and_b32 s25, s25, 0x1ffff
  v_add_f32 v227, v227, v221
  v_cvt_pk_bf16_f32 v182, v220, v221
  v_add_f32 v227, v227, v222
  v_mfma_f32_16x16x32_bf16 a[112:115], a[184:187], v[184:187], a[112:115]
  ds_read_b128 a[152:155], v3 offset:14336
  v_add_f32 v227, v227, v223
  v_max_f32 v5, v226, v227
  v_cmp_lt_f32 vcc, s81, v5
  v_mfma_f32_16x16x32_bf16 a[116:119], a[184:187], v[188:191], a[116:119]
  v_exp_f32 v216, v144
  v_mfma_f32_16x16x32_bf16 a[120:123], a[188:191], v[184:187], a[120:123]
  s_waitcnt lgkmcnt(3)
  ds_read_b128 a[156:159], v3 offset:15360
  v_cvt_pk_bf16_f32 v183, v222, v223
  v_add_u32 v3, s66, v2
  v_mfma_f32_16x16x32_bf16 a[124:127], a[188:191], v[188:191], a[124:127]
  s_cbranch_vccnz fa_stub21
fa_back21:
  v_exp_f32 v217, v145
  v_add_f32 v230, v230, v226
  v_add_f32 v231, v231, v227
fa_SSW3:
  v_mfma_f32_16x16x32_bf16 v[128:131], a[128:131], v[64:67], v[200:203]
  s_waitcnt vmcnt(12)
  v_exp_f32 v218, v146
  v_mfma_f32_16x16x32_bf16 v[136:139], a[128:131], v[68:71], v[204:207]
  s_barrier
  v_exp_f32 v219, v147
  v_mfma_f32_16x16x32_bf16 v[132:135], a[132:135], v[64:67], v[200:203]
  ds_read_b128 a[160:163], v3 offset:16384
  ds_read_b128 a[164:167], v3 offset:17408
  v_add_f32 v226, v216, v217
  v_mfma_f32_16x16x32_bf16 v[140:143], a[132:135], v[68:71], v[204:207]
  s_mov_b32 m0, s24
  v_exp_f32 v220, v148
  v_mfma_f32_16x16x32_bf16 v[128:131], a[136:139], v[72:75], v[128:131]
  ds_read_b128 a[168:171], v3 offset:18432
  buffer_load_dwordx4 v2, s[44:47], s26 offen offset:0 sc1 lds
  v_cvt_pk_bf16_f32 v184, v216, v217
  v_mfma_f32_16x16x32_bf16 v[136:139], a[136:139], v[76:79], v[136:139]
  v_exp_f32 v221, v149
  v_mfma_f32_16x16x32_bf16 v[132:135], a[140:143], v[72:75], v[132:135]
  ds_read_b128 a[172:175], v3 offset:19456
  v_add_f32 v226, v226, v218
  v_add_f32 v226, v226, v219
  v_mfma_f32_16x16x32_bf16 v[140:143], a[140:143], v[76:79], v[140:143]
  s_waitcnt lgkmcnt(4)
  v_exp_f32 v222, v150
  v_mfma_f32_16x16x32_bf16 v[128:131], a[144:147], v[80:83], v[128:131]
  s_add_u32 s14, s13, 28672
  ds_read_b128 a[176:179], v3 offset:20480
  buffer_load_dwordx4 a[248:251], v2, s[40:43], s14 offen offset:2048 sc1
  v_cvt_pk_bf16_f32 v185, v218, v219
  v_mfma_f32_16x16x32_bf16 v[136:139], a[144:147], v[84:87], v[136:139]
  v_exp_f32 v223, v151
  v_mfma_f32_16x16x32_bf16 v[132:135], a[148:151], v[80:83], v[132:135]
  ds_read_b128 a[180:183], v3 offset:21504
  buffer_load_dwordx4 v2, s[44:47], s26 offen offset:1024 sc1 lds
  v_add_f32 v226, v226, v220
  v_mfma_f32_16x16x32_bf16 v[140:143], a[148:151], v[84:87], v[140:143]
  v_exp_f32 v216, v152
  v_mfma_f32_16x16x32_bf16 v[128:131], a[152:155], v[88:91], v[128:131]
  ds_read_b128 a[184:187], v3 offset:22528
  v_add_f32 v226, v226, v221
  v_cvt_pk_bf16_f32 v186, v220, v221
  v_mfma_f32_16x16x32_bf16 v[136:139], a[152:155], v[92:95], v[136:139]
  v_exp_f32 v217, v153
  v_mfma_f32_16x16x32_bf16 v[132:135], a[156:159], v[88:91], v[132:135]
  ds_read_b128 a[188:191], v3 offset:23552
  buffer_load_dwordx4 a[252:255], v2, s[40:43], s14 offen offset:3072 sc1
  v_add_f32 v226, v226, v222
  v_mfma_f32_16x16x32_bf16 v[140:143], a[156:159], v[92:95], v[140:143]
  s_waitcnt lgkmcnt(4)
  v_exp_f32 v218, v154
  v_mfma_f32_16x16x32_bf16 a[64:67], a[160:163], v[176:179], a[64:67]
  ds_read_b128 a[128:131], v3 offset:0
  v_add_f32 v226, v226, v223
  v_cvt_pk_bf16_f32 v187, v222, v223
  v_mfma_f32_16x16x32_bf16 a[68:71], a[160:163], v[180:183], a[68:71]
  v_exp_f32 v219, v155
  v_mfma_f32_16x16x32_bf16 a[72:75], a[164:167], v[176:179], a[72:75]
  ds_read_b128 a[132:135], v3 offset:1024
  buffer_load_dwordx4 v2, s[44:47], s26 offen offset:2048 sc1 lds
  v_add_f32 v227, v216, v217
  v_mfma_f32_16x16x32_bf16 a[76:79], a[164:167], v[180:183], a[76:79]
  v_exp_f32 v220, v156
  v_mfma_f32_16x16x32_bf16 a[80:83], a[168:171], v[176:179], a[80:83]
  ds_read_b128 a[136:139], v3 offset:2048
  v_cvt_pk_bf16_f32 v188, v216, v217
  v_mfma_f32_16x16x32_bf16 a[84:87], a[168:171], v[180:183], a[84:87]
  v_exp_f32 v221, v157
  v_mfma_f32_16x16x32_bf16 a[88:91], a[172:175], v[176:179], a[88:91]
  s_add_u32 s14, s13, 32768
  ds_read_b128 a[140:143], v3 offset:3072
  buffer_load_dwordx4 v[32:35], v2, s[40:43], s14 offen offset:0 sc1
  v_add_f32 v227, v227, v218
  v_add_f32 v227, v227, v219
  v_mfma_f32_16x16x32_bf16 a[92:95], a[172:175], v[180:183], a[92:95]
  s_waitcnt lgkmcnt(4)
  v_exp_f32 v222, v158
  v_mfma_f32_16x16x32_bf16 a[96:99], a[176:179], v[176:179], a[96:99]
  ds_read_b128 a[144:147], v3 offset:4096
  buffer_load_dwordx4 v2, s[44:47], s26 offen offset:3072 sc1 lds
  v_cvt_pk_bf16_f32 v189, v218, v219
  v_mfma_f32_16x16x32_bf16 a[100:103], a[176:179], v[180:183], a[100:103]
  s_add_u32 s26, s26, 16384
  v_exp_f32 v223, v159
  v_mfma_f32_16x16x32_bf16 a[104:107], a[180:183], v[176:179], a[104:107]
  s_add_u32 s24, s24, 32768
  ds_read_b128 a[148:151], v3 offset:5120
  v_add_f32 v227, v227, v220
  v_mfma_f32_16x16x32_bf16 a[108:111], a[180:183], v[180:183], a[108:111]
  s_and_b32 s24, s24, 0x1ffff
  v_add_f32 v227, v227, v221
  v_cvt_pk_bf16_f32 v190, v220, v221
  v_add_f32 v227, v227, v222
  v_mfma_f32_16x16x32_bf16 a[112:115], a[184:187], v[176:179], a[112:115]
  ds_read_b128 a[152:155], v3 offset:6144
  v_add_f32 v227, v227, v223
  v_max_f32 v5, v226, v227
  v_cmp_lt_f32 vcc, s81, v5
  v_mfma_f32_16x16x32_bf16 a[116:119], a[184:187], v[180:183], a[116:119]
  v_exp_f32 v216, v128
  v_mfma_f32_16x16x32_bf16 a[120:123], a[188:191], v[176:179], a[120:123]
  s_waitcnt lgkmcnt(3)
  ds_read_b128 a[156:159], v3 offset:7168
  v_cvt_pk_bf16_f32 v191, v222, v223
  v_mfma_f32_16x16x32_bf16 a[124:127], a[188:191], v[180:183], a[124:127]
  s_cbranch_vccnz fa_stub22
fa_back22:
  v_exp_f32 v217, v129
  v_add_f32 v230, v230, v226
  v_add_f32 v231, v231, v227
  v_mfma_f32_16x16x32_bf16 v[144:147], a[128:131], v[64:67], v[200:203]
  ds_read_b128 a[160:163], v3 offset:24576
  v_add_f32 v226, v216, v217
  v_mfma_f32_16x16x32_bf16 v[152:155], a[128:131], v[68:71], v[204:207]
  v_exp_f32 v218, v130
  v_mfma_f32_16x16x32_bf16 v[148:151], a[132:135], v[64:67], v[200:203]
  s_add_u32 s66, s66, 32768
  ds_read_b128 a[164:167], v3 offset:25600
  v_cvt_pk_bf16_f32 v176, v216, v217
  v_mfma_f32_16x16x32_bf16 v[156:159], a[132:135], v[68:71], v[204:207]
  s_mov_b32 m0, s25
  v_exp_f32 v219, v131
  v_mfma_f32_16x16x32_bf16 v[144:147], a[136:139], v[72:75], v[144:147]
  s_and_b32 s66, s66, 0x1ffff
  ds_read_b128 a[168:171], v3 offset:26624
  buffer_load_dwordx4 v2, s[48:51], s27 offen offset:0 sc1 lds
  v_add_f32 v226, v226, v218
  v_add_f32 v226, v226, v219
  v_mfma_f32_16x16x32_bf16 v[152:155], a[136:139], v[76:79], v[152:155]
  v_exp_f32 v220, v132
  v_mfma_f32_16x16x32_bf16 v[148:151], a[140:143], v[72:75], v[148:151]
  ds_read_b128 a[172:175], v3 offset:27648
  v_cvt_pk_bf16_f32 v177, v218, v219
  v_mfma_f32_16x16x32_bf16 v[156:159], a[140:143], v[76:79], v[156:159]
  s_waitcnt lgkmcnt(4)
  v_exp_f32 v221, v133
  v_mfma_f32_16x16x32_bf16 v[144:147], a[144:147], v[80:83], v[144:147]
  s_add_u32 s14, s13, 32768
  ds_read_b128 a[176:179], v3 offset:28672
  buffer_load_dwordx4 v[36:39], v2, s[40:43], s14 offen offset:1024 sc1
  v_add_f32 v226, v226, v220
  v_mfma_f32_16x16x32_bf16 v[152:155], a[144:147], v[84:87], v[152:155]
  v_exp_f32 v222, v134
  v_mfma_f32_16x16x32_bf16 v[148:151], a[148:151], v[80:83], v[148:151]
  ds_read_b128 a[180:183], v3 offset:29696
  buffer_load_dwordx4 v2, s[48:51], s27 offen offset:1024 sc1 lds
  v_add_f32 v226, v226, v221
  v_cvt_pk_bf16_f32 v178, v220, v221
  v_mfma_f32_16x16x32_bf16 v[156:159], a[148:151], v[84:87], v[156:159]
  v_exp_f32 v223, v135
  v_mfma_f32_16x16x32_bf16 v[144:147], a[152:155], v[88:91], v[144:147]
  ds_read_b128 a[184:187], v3 offset:30720
  v_add_f32 v226, v226, v222
  v_mfma_f32_16x16x32_bf16 v[152:155], a[152:155], v[92:95], v[152:155]
  v_exp_f32 v216, v136
  v_mfma_f32_16x16x32_bf16 v[148:151], a[156:159], v[88:91], v[148:151]
  ds_read_b128 a[188:191], v3 offset:31744
  buffer_load_dwordx4 v[40:43], v2, s[40:43], s14 offen offset:2048 sc1
  v_add_f32 v226, v226, v223
  v_exp_f32 v217, v137
  v_mfma_f32_16x16x32_bf16 v[156:159], a[156:159], v[92:95], v[156:159]
  s_waitcnt lgkmcnt(4)
  v_exp_f32 v218, v138
  v_mfma_f32_16x16x32_bf16 a[64:67], a[160:163], v[184:187], a[64:67]
  ds_read_b128 a[128:131], v3 offset:8192
  v_cvt_pk_bf16_f32 v179, v222, v223
  v_mfma_f32_16x16x32_bf16 a[68:71], a[160:163], v[188:191], a[68:71]
  v_exp_f32 v219, v139
  v_mfma_f32_16x16x32_bf16 a[72:75], a[164:167], v[184:187], a[72:75]
  ds_read_b128 a[132:135], v3 offset:9216
  buffer_load_dwordx4 v2, s[48:51], s27 offen offset:2048 sc1 lds
  v_add_f32 v227, v216, v217
  v_mfma_f32_16x16x32_bf16 a[76:79], a[164:167], v[188:191], a[76:79]
  v_exp_f32 v220, v140
  v_mfma_f32_16x16x32_bf16 a[80:83], a[168:171], v[184:187], a[80:83]
  ds_read_b128 a[136:139], v3 offset:10240
  v_cvt_pk_bf16_f32 v180, v216, v217
  v_mfma_f32_16x16x32_bf16 a[84:87], a[168:171], v[188:191], a[84:87]
  v_exp_f32 v221, v141
  v_mfma_f32_16x16x32_bf16 a[88:91], a[172:175], v[184:187], a[88:91]
  ds_read_b128 a[140:143], v3 offset:11264
  buffer_load_dwordx4 v[44:47], v2, s[40:43], s14 offen offset:3072 sc1
  v_add_f32 v227, v227, v218
  v_mfma_f32_16x16x32_bf16 a[92:95], a[172:175], v[188:191], a[92:95]
  s_waitcnt lgkmcnt(4)
  v_exp_f32 v222, v142
  v_mfma_f32_16x16x32_bf16 a[96:99], a[176:179], v[184:187], a[96:99]
  ds_read_b128 a[144:147], v3 offset:12288
  buffer_load_dwordx4 v2, s[48:51], s27 offen offset:3072 sc1 lds
  v_add_f32 v227, v227, v219
  v_cvt_pk_bf16_f32 v181, v218, v219
  v_mfma_f32_16x16x32_bf16 a[100:103], a[176:179], v[188:191], a[100:103]
  s_add_u32 s27, s27, 16384
  v_exp_f32 v223, v143
  v_mfma_f32_16x16x32_bf16 a[104:107], a[180:183], v[184:187], a[104:107]
  s_add_u32 s25, s25, 32768
  ds_read_b128 a[148:151], v3 offset:13312
  v_add_f32 v227, v227, v220
  v_mfma_f32_16x16x32_bf16 a[108:111], a[180:183], v[188:191], a[108:111]
  s_and_b32 s25, s25, 0x1ffff
  v_add_f32 v227, v227, v221
  v_cvt_pk_bf16_f32 v182, v220, v221
  v_add_f32 v227, v227, v222
  v_mfma_f32_16x16x32_bf16 a[112:115], a[184:187], v[184:187], a[112:115]
  ds_read_b128 a[152:155], v3 offset:14336
  v_add_f32 v227, v227, v223
  v_max_f32 v5, v226, v227
  v_cmp_lt_f32 vcc, s81, v5
  v_mfma_f32_16x16x32_bf16 a[116:119], a[184:187], v[188:191], a[116:119]
  v_exp_f32 v216, v144
  v_mfma_f32_16x16x32_bf16 a[120:123], a[188:191], v[184:187], a[120:123]
  s_waitcnt lgkmcnt(3)
  ds_read_b128 a[156:159], v3 offset:15360
  v_cvt_pk_bf16_f32 v183, v222, v223
  v_add_u32 v3, s66, v2
  v_mfma_f32_16x16x32_bf16 a[124:127], a[188:191], v[188:191], a[124:127]
  s_cbranch_vccnz fa_stub23
fa_back23:
  v_exp_f32 v217, v145
  v_add_f32 v230, v230, v226
  v_add_f32 v231, v231, v227
fa_SSW2:
  v_mfma_f32_16x16x32_bf16 v[128:131], a[128:131], v[64:67], v[200:203]
  s_waitcnt vmcnt(12)
  v_exp_f32 v218, v146
  v_mfma_f32_16x16x32_bf16 v[136:139], a[128:131], v[68:71], v[204:207]
  s_barrier
  v_exp_f32 v219, v147
  v_mfma_f32_16x16x32_bf16 v[132:135], a[132:135], v[64:67], v[200:203]
  ds_read_b128 a[160:163], v3 offset:16384
  ds_read_b128 a[164:167], v3 offset:17408
  v_add_f32 v226, v216, v217
  v_mfma_f32_16x16x32_bf16 v[140:143], a[132:135], v[68:71], v[204:207]
  s_mov_b32 m0, s24
  v_exp_f32 v220, v148
  v_mfma_f32_16x16x32_bf16 v[128:131], a[136:139], v[72:75], v[128:131]
  ds_read_b128 a[168:171], v3 offset:18432
  buffer_load_dwordx4 v2, s[44:47], s26 offen offset:0 sc1 lds
  v_cvt_pk_bf16_f32 v184, v216, v217
  v_mfma_f32_16x16x32_bf16 v[136:139], a[136:139], v[76:79], v[136:139]
  v_exp_f32 v221, v149
  v_mfma_f32_16x16x32_bf16 v[132:135], a[140:143], v[72:75], v[132:135]
  ds_read_b128 a[172:175], v3 offset:19456
  v_add_f32 v226, v226, v218
  v_add_f32 v226, v226, v219
  v_mfma_f32_16x16x32_bf16 v[140:143], a[140:143], v[76:79], v[140:143]
  s_waitcnt lgkmcnt(4)
  v_exp_f32 v222, v150
  v_mfma_f32_16x16x32_bf16 v[128:131], a[144:147], v[80:83], v[128:131]
  s_add_u32 s14, s13, 36864
  ds_read_b128 a[176:179], v3 offset:20480
  buffer_load_dwordx4 v[48:51], v2, s[40:43], s14 offen offset:0 sc1
  v_cvt_pk_bf16_f32 v185, v218, v219
  v_mfma_f32_16x16x32_bf16 v[136:139], a[144:147], v[84:87], v[136:139]
  v_exp_f32 v223, v151
  v_mfma_f32_16x16x32_bf16 v[132:135], a[148:151], v[80:83], v[132:135]
  ds_read_b128 a[180:183], v3 offset:21504
  buffer_load_dwordx4 v2, s[44:47], s26 offen offset:1024 sc1 lds
  v_add_f32 v226, v226, v220
  v_mfma_f32_16x16x32_bf16 v[140:143], a[148:151], v[84:87], v[140:143]
  v_exp_f32 v216, v152
  v_mfma_f32_16x16x32_bf16 v[128:131], a[152:155], v[88:91], v[128:131]
  ds_read_b128 a[184:187], v3 offset:22528
  v_add_f32 v226, v226, v221
  v_cvt_pk_bf16_f32 v186, v220, v221
  v_mfma_f32_16x16x32_bf16 v[136:139], a[152:155], v[92:95], v[136:139]
  v_exp_f32 v217, v153
  v_mfma_f32_16x16x32_bf16 v[132:135], a[156:159], v[88:91], v[132:135]
  ds_read_b128 a[188:191], v3 offset:23552
  buffer_load_dwordx4 v[52:55], v2, s[40:43], s14 offen offset:1024 sc1
  v_add_f32 v226, v226, v222
  v_mfma_f32_16x16x32_bf16 v[140:143], a[156:159], v[92:95], v[140:143]
  s_waitcnt lgkmcnt(4)
  v_exp_f32 v218, v154
  v_mfma_f32_16x16x32_bf16 a[64:67], a[160:163], v[176:179], a[64:67]
  ds_read_b128 a[128:131], v3 offset:0
  v_add_f32 v226, v226, v223
  v_cvt_pk_bf16_f32 v187, v222, v223
  v_mfma_f32_16x16x32_bf16 a[68:71], a[160:163], v[180:183], a[68:71]
  v_exp_f32 v219, v155
  v_mfma_f32_16x16x32_bf16 a[72:75], a[164:167], v[176:179], a[72:75]
  ds_read_b128 a[132:135], v3 offset:1024
  buffer_load_dwordx4 v2, s[44:47], s26 offen offset:2048 sc1 lds
  v_add_f32 v227, v216, v217
  v_mfma_f32_16x16x32_bf16 a[76:79], a[164:167], v[180:183], a[76:79]
  v_exp_f32 v220, v156
  v_mfma_f32_16x16x32_bf16 a[80:83], a[168:171], v[176:179], a[80:83]
  ds_read_b128 a[136:139], v3 offset:2048
  v_cvt_pk_bf16_f32 v188, v216, v217
  v_mfma_f32_16x16x32_bf16 a[84:87], a[168:171], v[180:183], a[84:87]
  v_exp_f32 v221, v157
  v_mfma_f32_16x16x32_bf16 a[88:91], a[172:175], v[176:179], a[88:91]
  ds_read_b128 a[140:143], v3 offset:3072
  buffer_load_dwordx4 v[56:59], v2, s[40:43], s14 offen offset:2048 sc1
  v_add_f32 v227, v227, v218
  v_add_f32 v227, v227, v219
  v_mfma_f32_16x16x32_bf16 a[92:95], a[172:175], v[180:183], a[92:95]
  s_waitcnt lgkmcnt(4)
  v_exp_f32 v222, v158
  v_mfma_f32_16x16x32_bf16 a[96:99], a[176:179], v[176:179], a[96:99]
  ds_read_b128 a[144:147], v3 offset:4096
  buffer_load_dwordx4 v2, s[44:47], s26 offen offset:3072 sc1 lds
  v_cvt_pk_bf16_f32 v189, v218, v219
  v_mfma_f32_16x16x32_bf16 a[100:103], a[176:179], v[180:183], a[100:103]
  s_add_u32 s26, s26, 16384
  v_exp_f32 v223, v159
  v_mfma_f32_16x16x32_bf16 a[104:107], a[180:183], v[176:179], a[104:107]
  s_add_u32 s24, s24, 32768
  ds_read_b128 a[148:151], v3 offset:5120
  v_add_f32 v227, v227, v220
  v_mfma_f32_16x16x32_bf16 a[108:111], a[180:183], v[180:183], a[108:111]
  s_and_b32 s24, s24, 0x1ffff
  v_add_f32 v227, v227, v221
  v_cvt_pk_bf16_f32 v190, v220, v221
  v_add_f32 v227, v227, v222
  v_mfma_f32_16x16x32_bf16 a[112:115], a[184:187], v[176:179], a[112:115]
  ds_read_b128 a[152:155], v3 offset:6144
  v_add_f32 v227, v227, v223
  v_max_f32 v5, v226, v227
  v_cmp_lt_f32 vcc, s81, v5
  v_mfma_f32_16x16x32_bf16 a[116:119], a[184:187], v[180:183], a[116:119]
  v_exp_f32 v216, v128
  v_mfma_f32_16x16x32_bf16 a[120:123], a[188:191], v[176:179], a[120:123]
  s_waitcnt lgkmcnt(3)
  ds_read_b128 a[156:159], v3 offset:7168
  v_cvt_pk_bf16_f32 v191, v222, v223
  v_mfma_f32_16x16x32_bf16 a[124:127], a[188:191], v[180:183], a[124:127]
  s_cbranch_vccnz fa_stub24
fa_back24:
  v_exp_f32 v217, v129
  v_add_f32 v230, v230, v226
  v_add_f32 v231, v231, v227
  v_mfma_f32_16x16x32_bf16 v[144:147], a[128:131], v[64:67], v[200:203]
  ds_read_b128 a[160:163], v3 offset:24576
  v_add_f32 v226, v216, v217
  v_mfma_f32_16x16x32_bf16 v[152:155], a[128:131], v[68:71], v[204:207]
  v_exp_f32 v218, v130
  v_mfma_f32_16x16x32_bf16 v[148:151], a[132:135], v[64:67], v[200:203]
  s_add_u32 s66, s66, 32768
  ds_read_b128 a[164:167], v3 offset:25600
  v_cvt_pk_bf16_f32 v176, v216, v217
  v_mfma_f32_16x16x32_bf16 v[156:159], a[132:135], v[68:71], v[204:207]
  s_mov_b32 m0, s25
  v_exp_f32 v219, v131
  v_mfma_f32_16x16x32_bf16 v[144:147], a[136:139], v[72:75], v[144:147]
  s_and_b32 s66, s66, 0x1ffff
  ds_read_b128 a[168:171], v3 offset:26624
  buffer_load_dwordx4 v2, s[48:51], s27 offen offset:0 sc1 lds
  v_add_f32 v226, v226, v218
  v_add_f32 v226, v226, v219
  v_mfma_f32_16x16x32_bf16 v[152:155], a[136:139], v[76:79], v[152:155]
  v_exp_f32 v220, v132
  v_mfma_f32_16x16x32_bf16 v[148:151], a[140:143], v[72:75], v[148:151]
  ds_read_b128 a[172:175], v3 offset:27648
  v_cvt_pk_bf16_f32 v177, v218, v219
  v_mfma_f32_16x16x32_bf16 v[156:159], a[140:143], v[76:79], v[156:159]
  s_waitcnt lgkmcnt(4)
  v_exp_f32 v221, v133
  v_mfma_f32_16x16x32_bf16 v[144:147], a[144:147], v[80:83], v[144:147]
  s_add_u32 s14, s13, 36864
  ds_read_b128 a[176:179], v3 offset:28672
  buffer_load_dwordx4 v[60:63], v2, s[40:43], s14 offen offset:3072 sc1
  v_add_f32 v226, v226, v220
  v_mfma_f32_16x16x32_bf16 v[152:155], a[144:147], v[84:87], v[152:155]
  v_exp_f32 v222, v134
  v_mfma_f32_16x16x32_bf16 v[148:151], a[148:151], v[80:83], v[148:151]
  ds_read_b128 a[180:183], v3 offset:29696
  buffer_load_dwordx4 v2, s[48:51], s27 offen offset:1024 sc1 lds
  v_add_f32 v226, v226, v221
  v_cvt_pk_bf16_f32 v178, v220, v221
  v_mfma_f32_16x16x32_bf16 v[156:159], a[148:151], v[84:87], v[156:159]
  v_exp_f32 v223, v135
  v_mfma_f32_16x16x32_bf16 v[144:147], a[152:155], v[88:91], v[144:147]
  ds_read_b128 a[184:187], v3 offset:30720
  v_add_f32 v226, v226, v222
  v_mfma_f32_16x16x32_bf16 v[152:155], a[152:155], v[92:95], v[152:155]
  v_exp_f32 v216, v136
  v_mfma_f32_16x16x32_bf16 v[148:151], a[156:159], v[88:91], v[148:151]
  s_add_u32 s14, s13, 40960
  ds_read_b128 a[188:191], v3 offset:31744
  buffer_load_dwordx4 v[96:99], v2, s[40:43], s14 offen offset:0 sc1
  v_add_f32 v226, v226, v223
  v_exp_f32 v217, v137
  v_mfma_f32_16x16x32_bf16 v[156:159], a[156:159], v[92:95], v[156:159]
  s_waitcnt lgkmcnt(4)
  v_exp_f32 v218, v138
  v_mfma_f32_16x16x32_bf16 a[64:67], a[160:163], v[184:187], a[64:67]
  ds_read_b128 a[128:131], v3 offset:8192
  v_cvt_pk_bf16_f32 v179, v222, v223
  v_mfma_f32_16x16x32_bf16 a[68:71], a[160:163], v[188:191], a[68:71]
  v_exp_f32 v219, v139
  v_mfma_f32_16x16x32_bf16 a[72:75], a[164:167], v[184:187], a[72:75]
  ds_read_b128 a[132:135], v3 offset:9216
  buffer_load_dwordx4 v2, s[48:51], s27 offen offset:2048 sc1 lds
  v_add_f32 v227, v216, v217
  v_mfma_f32_16x16x32_bf16 a[76:79], a[164:167], v[188:191], a[76:79]
  v_exp_f32 v220, v140
  v_mfma_f32_16x16x32_bf16 a[80:83], a[168:171], v[184:187], a[80:83]
  ds_read_b128 a[136:139], v3 offset:10240
  v_cvt_pk_bf16_f32 v180, v216, v217
  v_mfma_f32_16x16x32_bf16 a[84:87], a[168:171], v[188:191], a[84:87]
  v_exp_f32 v221, v141
  v_mfma_f32_16x16x32_bf16 a[88:91], a[172:175], v[184:187], a[88:91]
  ds_read_b128 a[140:143], v3 offset:11264
  buffer_load_dwordx4 v[100:103], v2, s[40:43], s14 offen offset:1024 sc1
  v_add_f32 v227, v227, v218
  v_mfma_f32_16x16x32_bf16 a[92:95], a[172:175], v[188:191], a[92:95]
  s_waitcnt lgkmcnt(4)
  v_exp_f32 v222, v142
  v_mfma_f32_16x16x32_bf16 a[96:99], a[176:179], v[184:187], a[96:99]
  ds_read_b128 a[144:147], v3 offset:12288
  buffer_load_dwordx4 v2, s[48:51], s27 offen offset:3072 sc1 lds
  v_add_f32 v227, v227, v219
  v_cvt_pk_bf16_f32 v181, v218, v219
  v_mfma_f32_16x16x32_bf16 a[100:103], a[176:179], v[188:191], a[100:103]
  s_add_u32 s27, s27, 16384
  v_exp_f32 v223, v143
  v_mfma_f32_16x16x32_bf16 a[104:107], a[180:183], v[184:187], a[104:107]
  s_add_u32 s25, s25, 32768
  ds_read_b128 a[148:151], v3 offset:13312
  v_add_f32 v227, v227, v220
  v_mfma_f32_16x16x32_bf16 a[108:111], a[180:183], v[188:191], a[108:111]
  s_and_b32 s25, s25, 0x1ffff
  v_add_f32 v227, v227, v221
  v_cvt_pk_bf16_f32 v182, v220, v221
  v_add_f32 v227, v227, v222
  v_mfma_f32_16x16x32_bf16 a[112:115], a[184:187], v[184:187], a[112:115]
  ds_read_b128 a[152:155], v3 offset:14336
  v_add_f32 v227, v227, v223
  v_max_f32 v5, v226, v227
  v_cmp_lt_f32 vcc, s81, v5
  v_mfma_f32_16x16x32_bf16 a[116:119], a[184:187], v[188:191], a[116:119]
  v_exp_f32 v216, v144
  v_mfma_f32_16x16x32_bf16 a[120:123], a[188:191], v[184:187], a[120:123]
  s_waitcnt lgkmcnt(3)
  ds_read_b128 a[156:159], v3 offset:15360
  v_cvt_pk_bf16_f32 v183, v222, v223
  v_add_u32 v3, s66, v2
  v_mfma_f32_16x16x32_bf16 a[124:127], a[188:191], v[188:191], a[124:127]
  s_cbranch_vccnz fa_stub25
fa_back25:
  v_exp_f32 v217, v145
  v_add_f32 v230, v230, v226
  v_add_f32 v231, v231, v227
fa_SSW1:
  v_mfma_f32_16x16x32_bf16 v[128:131], a[128:131], v[64:67], v[200:203]
  s_waitcnt vmcnt(12)
  v_exp_f32 v218, v146
  v_mfma_f32_16x16x32_bf16 v[136:139], a[128:131], v[68:71], v[204:207]
  s_barrier
  v_exp_f32 v219, v147
  v_mfma_f32_16x16x32_bf16 v[132:135], a[132:135], v[64:67], v[200:203]
  ds_read_b128 a[160:163], v3 offset:16384
  ds_read_b128 a[164:167], v3 offset:17408
  v_add_f32 v226, v216, v217
  v_mfma_f32_16x16x32_bf16 v[140:143], a[132:135], v[68:71], v[204:207]
  s_mov_b32 m0, s24
  v_exp_f32 v220, v148
  v_mfma_f32_16x16x32_bf16 v[128:131], a[136:139], v[72:75], v[128:131]
  ds_read_b128 a[168:171], v3 offset:18432
  buffer_load_dwordx4 v2, s[44:47], s26 offen offset:0 sc1 lds
  v_cvt_pk_bf16_f32 v184, v216, v217
  v_mfma_f32_16x16x32_bf16 v[136:139], a[136:139], v[76:79], v[136:139]
  v_exp_f32 v221, v149
  v_mfma_f32_16x16x32_bf16 v[132:135], a[140:143], v[72:75], v[132:135]
  ds_read_b128 a[172:175], v3 offset:19456
  v_add_f32 v226, v226, v218
  v_add_f32 v226, v226, v219
  v_mfma_f32_16x16x32_bf16 v[140:143], a[140:143], v[76:79], v[140:143]
  s_waitcnt lgkmcnt(4)
  v_exp_f32 v222, v150
  v_mfma_f32_16x16x32_bf16 v[128:131], a[144:147], v[80:83], v[128:131]
  s_add_u32 s14, s13, 40960
  ds_read_b128 a[176:179], v3 offset:20480
  buffer_load_dwordx4 v[104:107], v2, s[40:43], s14 offen offset:2048 sc1
  v_cvt_pk_bf16_f32 v185, v218, v219
  v_mfma_f32_16x16x32_bf16 v[136:139], a[144:147], v[84:87], v[136:139]
  v_exp_f32 v223, v151
  v_mfma_f32_16x16x32_bf16 v[132:135], a[148:151], v[80:83], v[132:135]
  ds_read_b128 a[180:183], v3 offset:21504
  buffer_load_dwordx4 v2, s[44:47], s26 offen offset:1024 sc1 lds
  v_add_f32 v226, v226, v220
  v_mfma_f32_16x16x32_bf16 v[140:143], a[148:151], v[84:87], v[140:143]
  v_exp_f32 v216, v152
  v_mfma_f32_16x16x32_bf16 v[128:131], a[152:155], v[88:91], v[128:131]
  ds_read_b128 a[184:187], v3 offset:22528
  v_add_f32 v226, v226, v221
  v_cvt_pk_bf16_f32 v186, v220, v221
  v_mfma_f32_16x16x32_bf16 v[136:139], a[152:155], v[92:95], v[136:139]
  v_exp_f32 v217, v153
  v_mfma_f32_16x16x32_bf16 v[132:135], a[156:159], v[88:91], v[132:135]
  ds_read_b128 a[188:191], v3 offset:23552
  buffer_load_dwordx4 v[108:111], v2, s[40:43], s14 offen offset:3072 sc1
  v_add_f32 v226, v226, v222
  v_mfma_f32_16x16x32_bf16 v[140:143], a[156:159], v[92:95], v[140:143]
  s_waitcnt lgkmcnt(4)
  v_exp_f32 v218, v154
  v_mfma_f32_16x16x32_bf16 a[64:67], a[160:163], v[176:179], a[64:67]
  ds_read_b128 a[128:131], v3 offset:0
  v_add_f32 v226, v226, v223
  v_cvt_pk_bf16_f32 v187, v222, v223
  v_mfma_f32_16x16x32_bf16 a[68:71], a[160:163], v[180:183], a[68:71]
  v_exp_f32 v219, v155
  v_mfma_f32_16x16x32_bf16 a[72:75], a[164:167], v[176:179], a[72:75]
  ds_read_b128 a[132:135], v3 offset:1024
  buffer_load_dwordx4 v2, s[44:47], s26 offen offset:2048 sc1 lds
  v_add_f32 v227, v216, v217
  v_mfma_f32_16x16x32_bf16 a[76:79], a[164:167], v[180:183], a[76:79]
  v_exp_f32 v220, v156
  v_mfma_f32_16x16x32_bf16 a[80:83], a[168:171], v[176:179], a[80:83]
  ds_read_b128 a[136:139], v3 offset:2048
  v_cvt_pk_bf16_f32 v188, v216, v217
  v_mfma_f32_16x16x32_bf16 a[84:87], a[168:171], v[180:183], a[84:87]
  v_exp_f32 v221, v157
  v_mfma_f32_16x16x32_bf16 a[88:91], a[172:175], v[176:179], a[88:91]
  s_add_u32 s14, s13, 45056
  ds_read_b128 a[140:143], v3 offset:3072
  buffer_load_dwordx4 v[112:115], v2, s[40:43], s14 offen offset:0 sc1
  v_add_f32 v227, v227, v218
  v_add_f32 v227, v227, v219
  v_mfma_f32_16x16x32_bf16 a[92:95], a[172:175], v[180:183], a[92:95]
  s_waitcnt lgkmcnt(4)
  v_exp_f32 v222, v158
  v_mfma_f32_16x16x32_bf16 a[96:99], a[176:179], v[176:179], a[96:99]
  ds_read_b128 a[144:147], v3 offset:4096
  buffer_load_dwordx4 v2, s[44:47], s26 offen offset:3072 sc1 lds
  v_cvt_pk_bf16_f32 v189, v218, v219
  v_mfma_f32_16x16x32_bf16 a[100:103], a[176:179], v[180:183], a[100:103]
  s_add_u32 s26, s26, 16384
  v_exp_f32 v223, v159
  v_mfma_f32_16x16x32_bf16 a[104:107], a[180:183], v[176:179], a[104:107]
  s_add_u32 s24, s24, 32768
  ds_read_b128 a[148:151], v3 offset:5120
  v_add_f32 v227, v227, v220
  v_mfma_f32_16x16x32_bf16 a[108:111], a[180:183], v[180:183], a[108:111]
  s_and_b32 s24, s24, 0x1ffff
  v_add_f32 v227, v227, v221
  v_cvt_pk_bf16_f32 v190, v220, v221
  v_add_f32 v227, v227, v222
  v_mfma_f32_16x16x32_bf16 a[112:115], a[184:187], v[176:179], a[112:115]
  ds_read_b128 a[152:155], v3 offset:6144
  v_add_f32 v227, v227, v223
  v_max_f32 v5, v226, v227
  v_cmp_lt_f32 vcc, s81, v5
  v_mfma_f32_16x16x32_bf16 a[116:119], a[184:187], v[180:183], a[116:119]
  v_exp_f32 v216, v128
  v_mfma_f32_16x16x32_bf16 a[120:123], a[188:191], v[176:179], a[120:123]
  s_waitcnt lgkmcnt(3)
  ds_read_b128 a[156:159], v3 offset:7168
  v_cvt_pk_bf16_f32 v191, v222, v223
  v_mfma_f32_16x16x32_bf16 a[124:127], a[188:191], v[180:183], a[124:127]
  s_cbranch_vccnz fa_stub26
fa_back26:
  v_exp_f32 v217, v129
  v_add_f32 v230, v230, v226
  v_add_f32 v231, v231, v227
  v_mfma_f32_16x16x32_bf16 v[144:147], a[128:131], v[64:67], v[200:203]
  ds_read_b128 a[160:163], v3 offset:24576
  v_add_f32 v226, v216, v217
  v_mfma_f32_16x16x32_bf16 v[152:155], a[128:131], v[68:71], v[204:207]
  v_exp_f32 v218, v130
  v_mfma_f32_16x16x32_bf16 v[148:151], a[132:135], v[64:67], v[200:203]
  s_add_u32 s66, s66, 32768
  ds_read_b128 a[164:167], v3 offset:25600
  v_cvt_pk_bf16_f32 v176, v216, v217
  v_mfma_f32_16x16x32_bf16 v[156:159], a[132:135], v[68:71], v[204:207]
  s_mov_b32 m0, s25
  v_exp_f32 v219, v131
  v_mfma_f32_16x16x32_bf16 v[144:147], a[136:139], v[72:75], v[144:147]
  s_and_b32 s66, s66, 0x1ffff
  ds_read_b128 a[168:171], v3 offset:26624
  buffer_load_dwordx4 v2, s[48:51], s27 offen offset:0 sc1 lds
  v_add_f32 v226, v226, v218
  v_add_f32 v226, v226, v219
  v_mfma_f32_16x16x32_bf16 v[152:155], a[136:139], v[76:79], v[152:155]
  v_exp_f32 v220, v132
  v_mfma_f32_16x16x32_bf16 v[148:151], a[140:143], v[72:75], v[148:151]
  ds_read_b128 a[172:175], v3 offset:27648
  v_cvt_pk_bf16_f32 v177, v218, v219
  v_mfma_f32_16x16x32_bf16 v[156:159], a[140:143], v[76:79], v[156:159]
  s_waitcnt lgkmcnt(4)
  v_exp_f32 v221, v133
  v_mfma_f32_16x16x32_bf16 v[144:147], a[144:147], v[80:83], v[144:147]
  s_add_u32 s14, s13, 45056
  ds_read_b128 a[176:179], v3 offset:28672
  buffer_load_dwordx4 v[116:119], v2, s[40:43], s14 offen offset:1024 sc1
  v_add_f32 v226, v226, v220
  v_mfma_f32_16x16x32_bf16 v[152:155], a[144:147], v[84:87], v[152:155]
  v_exp_f32 v222, v134
  v_mfma_f32_16x16x32_bf16 v[148:151], a[148:151], v[80:83], v[148:151]
  ds_read_b128 a[180:183], v3 offset:29696
  buffer_load_dwordx4 v2, s[48:51], s27 offen offset:1024 sc1 lds
  v_add_f32 v226, v226, v221
  v_cvt_pk_bf16_f32 v178, v220, v221
  v_mfma_f32_16x16x32_bf16 v[156:159], a[148:151], v[84:87], v[156:159]
  v_exp_f32 v223, v135
  v_mfma_f32_16x16x32_bf16 v[144:147], a[152:155], v[88:91], v[144:147]
  ds_read_b128 a[184:187], v3 offset:30720
  v_add_f32 v226, v226, v222
  v_mfma_f32_16x16x32_bf16 v[152:155], a[152:155], v[92:95], v[152:155]
  v_exp_f32 v216, v136
  v_mfma_f32_16x16x32_bf16 v[148:151], a[156:159], v[88:91], v[148:151]
  ds_read_b128 a[188:191], v3 offset:31744
  buffer_load_dwordx4 v[120:123], v2, s[40:43], s14 offen offset:2048 sc1
  v_add_f32 v226, v226, v223
  v_exp_f32 v217, v137
  v_mfma_f32_16x16x32_bf16 v[156:159], a[156:159], v[92:95], v[156:159]
  s_waitcnt lgkmcnt(4)
  v_exp_f32 v218, v138
  v_mfma_f32_16x16x32_bf16 a[64:67], a[160:163], v[184:187], a[64:67]
  ds_read_b128 a[128:131], v3 offset:8192
  v_cvt_pk_bf16_f32 v179, v222, v223
  v_mfma_f32_16x16x32_bf16 a[68:71], a[160:163], v[188:191], a[68:71]
  v_exp_f32 v219, v139
  v_mfma_f32_16x16x32_bf16 a[72:75], a[164:167], v[184:187], a[72:75]
  ds_read_b128 a[132:135], v3 offset:9216
  buffer_load_dwordx4 v2, s[48:51], s27 offen offset:2048 sc1 lds
  v_add_f32 v227, v216, v217
  v_mfma_f32_16x16x32_bf16 a[76:79], a[164:167], v[188:191], a[76:79]
  v_exp_f32 v220, v140
  v_mfma_f32_16x16x32_bf16 a[80:83], a[168:171], v[184:187], a[80:83]
  ds_read_b128 a[136:139], v3 offset:10240
  v_cvt_pk_bf16_f32 v180, v216, v217
  v_mfma_f32_16x16x32_bf16 a[84:87], a[168:171], v[188:191], a[84:87]
  v_exp_f32 v221, v141
  v_mfma_f32_16x16x32_bf16 a[88:91], a[172:175], v[184:187], a[88:91]
  ds_read_b128 a[140:143], v3 offset:11264
  buffer_load_dwordx4 v[124:127], v2, s[40:43], s14 offen offset:3072 sc1
  v_add_f32 v227, v227, v218
  v_mfma_f32_16x16x32_bf16 a[92:95], a[172:175], v[188:191], a[92:95]
  s_waitcnt lgkmcnt(4)
  v_exp_f32 v222, v142
  v_mfma_f32_16x16x32_bf16 a[96:99], a[176:179], v[184:187], a[96:99]
  ds_read_b128 a[144:147], v3 offset:12288
  buffer_load_dwordx4 v2, s[48:51], s27 offen offset:3072 sc1 lds
  v_add_f32 v227, v227, v219
  v_cvt_pk_bf16_f32 v181, v218, v219
  v_mfma_f32_16x16x32_bf16 a[100:103], a[176:179], v[188:191], a[100:103]
  s_add_u32 s27, s27, 16384
  v_exp_f32 v223, v143
  v_mfma_f32_16x16x32_bf16 a[104:107], a[180:183], v[184:187], a[104:107]
  s_add_u32 s25, s25, 32768
  ds_read_b128 a[148:151], v3 offset:13312
  v_add_f32 v227, v227, v220
  v_mfma_f32_16x16x32_bf16 a[108:111], a[180:183], v[188:191], a[108:111]
  s_and_b32 s25, s25, 0x1ffff
  v_add_f32 v227, v227, v221
  v_cvt_pk_bf16_f32 v182, v220, v221
  v_add_f32 v227, v227, v222
  v_mfma_f32_16x16x32_bf16 a[112:115], a[184:187], v[184:187], a[112:115]
  ds_read_b128 a[152:155], v3 offset:14336
  v_add_f32 v227, v227, v223
  v_max_f32 v5, v226, v227
  v_cmp_lt_f32 vcc, s81, v5
  v_mfma_f32_16x16x32_bf16 a[116:119], a[184:187], v[188:191], a[116:119]
  v_exp_f32 v216, v144
  v_mfma_f32_16x16x32_bf16 a[120:123], a[188:191], v[184:187], a[120:123]
  s_waitcnt lgkmcnt(3)
  ds_read_b128 a[156:159], v3 offset:15360
  v_cvt_pk_bf16_f32 v183, v222, v223
  v_add_u32 v3, s66, v2
  v_mfma_f32_16x16x32_bf16 a[124:127], a[188:191], v[188:191], a[124:127]
  s_cbranch_vccnz fa_stub27
fa_back27:
  v_exp_f32 v217, v145
  v_add_f32 v230, v230, v226
  v_add_f32 v231, v231, v227
fa_Bexit:
  s_bitcmp1_b32 s20, 0
  s_cbranch_scc1 fa_Bodd
  v_mfma_f32_16x16x32_bf16 v[128:131], a[128:131], v[64:67], v[200:203]
  s_waitcnt vmcnt(0)
  v_exp_f32 v218, v146
  v_mfma_f32_16x16x32_bf16 v[136:139], a[128:131], v[68:71], v[204:207]
  s_barrier
  v_exp_f32 v219, v147
  v_mfma_f32_16x16x32_bf16 v[132:135], a[132:135], v[64:67], v[200:203]
  ds_read_b128 a[160:163], v3 offset:16384
  ds_read_b128 a[164:167], v3 offset:17408
  v_add_f32 v226, v216, v217
  v_mfma_f32_16x16x32_bf16 v[140:143], a[132:135], v[68:71], v[204:207]
  s_add_u32 s14, s13, 49152
  buffer_load_dwordx4 v[160:163], v2, s[40:43], s14 offen offset:0 sc1
  v_cvt_pk_bf16_f32 v184, v216, v217
  v_mfma_f32_16x16x32_bf16 v[128:131], a[136:139], v[72:75], v[128:131]
  ds_read_b128 a[168:171], v3 offset:18432
  v_add_f32 v226, v226, v218
  v_mfma_f32_16x16x32_bf16 v[136:139], a[136:139], v[76:79], v[136:139]
  v_exp_f32 v220, v148
  v_mfma_f32_16x16x32_bf16 v[132:135], a[140:143], v[72:75], v[132:135]
  ds_read_b128 a[172:175], v3 offset:19456
  v_add_f32 v226, v226, v219
  v_cvt_pk_bf16_f32 v185, v218, v219
  v_mfma_f32_16x16x32_bf16 v[140:143], a[140:143], v[76:79], v[140:143]
  s_waitcnt lgkmcnt(4)
  buffer_load_dwordx4 v[164:167], v2, s[40:43], s14 offen offset:1024 sc1
  v_add_f32 v226, v226, v220
  v_mfma_f32_16x16x32_bf16 v[128:131], a[144:147], v[80:83], v[128:131]
  ds_read_b128 a[176:179], v3 offset:20480
  v_mfma_f32_16x16x32_bf16 v[136:139], a[144:147], v[84:87], v[136:139]
  v_exp_f32 v221, v149
  v_mfma_f32_16x16x32_bf16 v[132:135], a[148:151], v[80:83], v[132:135]
  ds_read_b128 a[180:183], v3 offset:21504
  v_add_f32 v226, v226, v221
  v_mfma_f32_16x16x32_bf16 v[140:143], a[148:151], v[84:87], v[140:143]
  v_exp_f32 v222, v150
  v_mfma_f32_16x16x32_bf16 v[128:131], a[152:155], v[88:91], v[128:131]
  ds_read_b128 a[184:187], v3 offset:22528
  buffer_load_dwordx4 v[168:171], v2, s[40:43], s14 offen offset:2048 sc1
  v_cvt_pk_bf16_f32 v186, v220, v221
  v_mfma_f32_16x16x32_bf16 v[136:139], a[152:155], v[92:95], v[136:139]
  v_exp_f32 v223, v151
  v_mfma_f32_16x16x32_bf16 v[132:135], a[156:159], v[88:91], v[132:135]
  ds_read_b128 a[188:191], v3 offset:23552
  v_add_f32 v226, v226, v222
  v_add_f32 v226, v226, v223
  v_mfma_f32_16x16x32_bf16 v[140:143], a[156:159], v[92:95], v[140:143]
  s_waitcnt lgkmcnt(4)
  v_exp_f32 v216, v152
  v_mfma_f32_16x16x32_bf16 a[64:67], a[160:163], v[176:179], a[64:67]
  v_exp_f32 v217, v153
  v_mfma_f32_16x16x32_bf16 a[68:71], a[160:163], v[180:183], a[68:71]
  buffer_load_dwordx4 v[172:175], v2, s[40:43], s14 offen offset:3072 sc1
  v_cvt_pk_bf16_f32 v187, v222, v223
  v_add_f32 v227, v216, v217
  v_mfma_f32_16x16x32_bf16 a[72:75], a[164:167], v[176:179], a[72:75]
  v_exp_f32 v218, v154
  v_mfma_f32_16x16x32_bf16 a[76:79], a[164:167], v[180:183], a[76:79]
  v_exp_f32 v219, v155
  v_mfma_f32_16x16x32_bf16 a[80:83], a[168:171], v[176:179], a[80:83]
  v_exp_f32 v220, v156
  v_mfma_f32_16x16x32_bf16 a[84:87], a[168:171], v[180:183], a[84:87]
  s_add_u32 s14, s13, 53248
  buffer_load_dwordx4 v[192:195], v2, s[40:43], s14 offen offset:0 sc1
  v_cvt_pk_bf16_f32 v188, v216, v217
  v_add_f32 v227, v227, v218
  v_mfma_f32_16x16x32_bf16 a[88:91], a[172:175], v[176:179], a[88:91]
  v_exp_f32 v221, v157
  v_mfma_f32_16x16x32_bf16 a[92:95], a[172:175], v[180:183], a[92:95]
  s_waitcnt lgkmcnt(0)
  v_exp_f32 v222, v158
  v_mfma_f32_16x16x32_bf16 a[96:99], a[176:179], v[176:179], a[96:99]
  v_add_f32 v227, v227, v219
  v_cvt_pk_bf16_f32 v189, v218, v219
  v_mfma_f32_16x16x32_bf16 a[100:103], a[176:179], v[180:183], a[100:103]
  v_exp_f32 v223, v159
  v_mfma_f32_16x16x32_bf16 a[104:107], a[180:183], v[176:179], a[104:107]
  buffer_load_dwordx4 v[196:199], v2, s[40:43], s14 offen offset:1024 sc1
  v_add_f32 v227, v227, v220
  v_mfma_f32_16x16x32_bf16 a[108:111], a[180:183], v[180:183], a[108:111]
  v_add_f32 v227, v227, v221
  v_cvt_pk_bf16_f32 v190, v220, v221
  v_add_f32 v227, v227, v222
  v_mfma_f32_16x16x32_bf16 a[112:115], a[184:187], v[176:179], a[112:115]
  v_add_f32 v227, v227, v223
  v_max_f32 v5, v226, v227
  v_cmp_lt_f32 vcc, s81, v5
  v_mfma_f32_16x16x32_bf16 a[116:119], a[184:187], v[180:183], a[116:119]
  v_exp_f32 v216, v128
  v_mfma_f32_16x16x32_bf16 a[120:123], a[188:191], v[176:179], a[120:123]
  v_cvt_pk_bf16_f32 v191, v222, v223
  v_mfma_f32_16x16x32_bf16 a[124:127], a[188:191], v[180:183], a[124:127]
  s_cbranch_vccnz fa_stub28
fa_back28:
  v_exp_f32 v217, v129
  v_add_f32 v230, v230, v226
  v_add_f32 v231, v231, v227
  ds_read_b128 a[160:163], v3 offset:24576
  ds_read_b128 a[164:167], v3 offset:25600
  ds_read_b128 a[168:171], v3 offset:26624
  ds_read_b128 a[172:175], v3 offset:27648
  ds_read_b128 a[176:179], v3 offset:28672
  ds_read_b128 a[180:183], v3 offset:29696
  ds_read_b128 a[184:187], v3 offset:30720
  ds_read_b128 a[188:191], v3 offset:31744
  v_cndmask_b32 v128, v4, v128, s[68:69]
  v_cndmask_b32 v129, v4, v129, s[70:71]
  v_cndmask_b32 v130, v4, v130, s[72:73]
  v_cndmask_b32 v131, v4, v131, s[74:75]
  v_mov_b32 v132, v4
  v_mov_b32 v133, v4
  v_mov_b32 v134, v4
  v_mov_b32 v135, v4
  v_cndmask_b32 v140, v4, v140, s[68:69]
  v_cndmask_b32 v141, v4, v141, s[70:71]
  v_cndmask_b32 v142, v4, v142, s[72:73]
  v_cndmask_b32 v143, v4, v143, s[74:75]
  v_exp_f32 v216, v128
  v_exp_f32 v217, v129
  v_exp_f32 v218, v130
  v_add_f32 v226, v216, v217
  v_cvt_pk_bf16_f32 v176, v216, v217
  v_add_f32 v226, v226, v218
  v_exp_f32 v219, v131
  v_exp_f32 v220, v132
  v_add_f32 v226, v226, v219
  v_cvt_pk_bf16_f32 v177, v218, v219
  v_add_f32 v226, v226, v220
  v_exp_f32 v221, v133
  s_waitcnt lgkmcnt(4)
  v_mfma_f32_16x16x32_bf16 a[64:67], a[160:163], v[184:187], a[64:67]
  v_exp_f32 v222, v134
  v_add_f32 v226, v226, v221
  v_mfma_f32_16x16x32_bf16 a[68:71], a[160:163], v[188:191], a[68:71]
  s_add_u32 s14, s13, 53248
  buffer_load_dwordx4 v[208:211], v2, s[40:43], s14 offen offset:2048 sc1
  v_exp_f32 v223, v135
  v_mfma_f32_16x16x32_bf16 a[72:75], a[164:167], v[184:187], a[72:75]
  s_add_u32 s66, s66, 32768
  v_exp_f32 v216, v136
  v_mfma_f32_16x16x32_bf16 a[76:79], a[164:167], v[188:191], a[76:79]
  s_and_b32 s66, s66, 0x1ffff
  v_exp_f32 v217, v137
  v_mfma_f32_16x16x32_bf16 a[80:83], a[168:171], v[184:187], a[80:83]
  buffer_load_dwordx4 v[212:215], v2, s[40:43], s14 offen offset:3072 sc1
  v_cvt_pk_bf16_f32 v178, v220, v221
  v_add_f32 v226, v226, v222
  v_add_f32 v226, v226, v223
  v_cvt_pk_bf16_f32 v179, v222, v223
  v_mfma_f32_16x16x32_bf16 a[84:87], a[168:171], v[188:191], a[84:87]
  v_exp_f32 v218, v138
  v_mfma_f32_16x16x32_bf16 a[88:91], a[172:175], v[184:187], a[88:91]
  v_exp_f32 v219, v139
  v_mfma_f32_16x16x32_bf16 a[92:95], a[172:175], v[188:191], a[92:95]
  s_waitcnt lgkmcnt(0)
  v_exp_f32 v220, v140
  v_mfma_f32_16x16x32_bf16 a[96:99], a[176:179], v[184:187], a[96:99]
  s_add_u32 s14, s13, 57344
  buffer_load_dwordx4 v[232:235], v2, s[40:43], s14 offen offset:0 sc1
  v_add_f32 v227, v216, v217
  v_cvt_pk_bf16_f32 v180, v216, v217
  v_add_f32 v227, v227, v218
  v_add_f32 v227, v227, v219
  v_cvt_pk_bf16_f32 v181, v218, v219
  v_exp_f32 v221, v141
  v_mfma_f32_16x16x32_bf16 a[100:103], a[176:179], v[188:191], a[100:103]
  v_exp_f32 v222, v142
  v_mfma_f32_16x16x32_bf16 a[104:107], a[180:183], v[184:187], a[104:107]
  v_exp_f32 v223, v143
  v_mfma_f32_16x16x32_bf16 a[108:111], a[180:183], v[188:191], a[108:111]
  buffer_load_dwordx4 v[236:239], v2, s[40:43], s14 offen offset:1024 sc1
  v_add_f32 v227, v227, v220
  v_add_f32 v227, v227, v221
  v_cvt_pk_bf16_f32 v182, v220, v221
  v_add_f32 v227, v227, v222
  v_mfma_f32_16x16x32_bf16 a[112:115], a[184:187], v[184:187], a[112:115]
  v_add_f32 v227, v227, v223
  v_max_f32 v5, v226, v227
  v_cmp_lt_f32 vcc, s81, v5
  v_mfma_f32_16x16x32_bf16 a[116:119], a[184:187], v[188:191], a[116:119]
  v_mfma_f32_16x16x32_bf16 a[120:123], a[188:191], v[184:187], a[120:123]
  v_cvt_pk_bf16_f32 v183, v222, v223
  v_add_u32 v3, s66, v2
  v_mfma_f32_16x16x32_bf16 a[124:127], a[188:191], v[188:191], a[124:127]
  s_cbranch_vccnz fa_stub29
fa_back29:
  v_add_f32 v230, v230, v226
  v_add_f32 v231, v231, v227
  s_waitcnt vmcnt(10)
  s_barrier
  ds_read_b128 a[160:163], v3 offset:16384
  ds_read_b128 a[164:167], v3 offset:17408
  ds_read_b128 a[168:171], v3 offset:18432
  ds_read_b128 a[172:175], v3 offset:19456
  ds_read_b128 a[176:179], v3 offset:20480
  ds_read_b128 a[180:183], v3 offset:21504
  ds_read_b128 a[184:187], v3 offset:22528
  ds_read_b128 a[188:191], v3 offset:23552
  s_waitcnt lgkmcnt(4)
  v_mfma_f32_16x16x32_bf16 a[64:67], a[160:163], v[176:179], a[64:67]
  v_mfma_f32_16x16x32_bf16 a[68:71], a[160:163], v[180:183], a[68:71]
  s_add_u32 s14, s13, 57344
  buffer_load_dwordx4 v[240:243], v2, s[40:43], s14 offen offset:2048 sc1
  v_mfma_f32_16x16x32_bf16 a[72:75], a[164:167], v[176:179], a[72:75]
  v_mfma_f32_16x16x32_bf16 a[76:79], a[164:167], v[180:183], a[76:79]
  v_mfma_f32_16x16x32_bf16 a[80:83], a[168:171], v[176:179], a[80:83]
  v_mfma_f32_16x16x32_bf16 a[84:87], a[168:171], v[180:183], a[84:87]
  v_mfma_f32_16x16x32_bf16 a[88:91], a[172:175], v[176:179], a[88:91]
  v_mfma_f32_16x16x32_bf16 a[92:95], a[172:175], v[180:183], a[92:95]
  s_waitcnt lgkmcnt(0)
  v_mfma_f32_16x16x32_bf16 a[96:99], a[176:179], v[176:179], a[96:99]
  buffer_load_dwordx4 v[244:247], v2, s[40:43], s14 offen offset:3072 sc1
  v_mfma_f32_16x16x32_bf16 a[100:103], a[176:179], v[180:183], a[100:103]
  v_mfma_f32_16x16x32_bf16 a[104:107], a[180:183], v[176:179], a[104:107]
  v_mfma_f32_16x16x32_bf16 a[108:111], a[180:183], v[180:183], a[108:111]
  v_mfma_f32_16x16x32_bf16 a[112:115], a[184:187], v[176:179], a[112:115]
  v_mfma_f32_16x16x32_bf16 a[116:119], a[184:187], v[180:183], a[116:119]
  v_mfma_f32_16x16x32_bf16 a[120:123], a[188:191], v[176:179], a[120:123]
  v_mfma_f32_16x16x32_bf16 a[124:127], a[188:191], v[180:183], a[124:127]
  s_branch fa_Bdone
fa_Bodd:
  s_waitcnt vmcnt(0)
  s_barrier
  ds_read_b128 a[160:163], v3 offset:16384
  ds_read_b128 a[164:167], v3 offset:17408
  ds_read_b128 a[168:171], v3 offset:18432
  ds_read_b128 a[172:175], v3 offset:19456
  ds_read_b128 a[176:179], v3 offset:20480
  ds_read_b128 a[180:183], v3 offset:21504
  ds_read_b128 a[184:187], v3 offset:22528
  ds_read_b128 a[188:191], v3 offset:23552
  v_cndmask_b32 v144, v4, v144, s[68:69]
  v_cndmask_b32 v145, v4, v145, s[70:71]
  v_cndmask_b32 v146, v4, v146, s[72:73]
  v_cndmask_b32 v147, v4, v147, s[74:75]
  v_mov_b32 v148, v4
  v_mov_b32 v149, v4
  v_mov_b32 v150, v4
  v_mov_b32 v151, v4
  v_cndmask_b32 v156, v4, v156, s[68:69]
  v_cndmask_b32 v157, v4, v157, s[70:71]
  v_cndmask_b32 v158, v4, v158, s[72:73]
  v_cndmask_b32 v159, v4, v159, s[74:75]
  v_exp_f32 v216, v144
  v_exp_f32 v217, v145
  v_exp_f32 v218, v146
  v_add_f32 v226, v216, v217
  v_cvt_pk_bf16_f32 v184, v216, v217
  v_add_f32 v226, v226, v218
  v_exp_f32 v219, v147
  v_exp_f32 v220, v148
  v_add_f32 v226, v226, v219
  v_cvt_pk_bf16_f32 v185, v218, v219
  v_add_f32 v226, v226, v220
  v_exp_f32 v221, v149
  s_waitcnt lgkmcnt(4)
  v_mfma_f32_16x16x32_bf16 a[64:67], a[160:163], v[176:179], a[64:67]
  v_exp_f32 v222, v150
  v_add_f32 v226, v226, v221
  v_mfma_f32_16x16x32_bf16 a[68:71], a[160:163], v[180:183], a[68:71]
  s_add_u32 s14, s13, 49152
  buffer_load_dwordx4 v[160:163], v2, s[40:43], s14 offen offset:0 sc1
  v_exp_f32 v223, v151
  v_mfma_f32_16x16x32_bf16 a[72:75], a[164:167], v[176:179], a[72:75]
  v_exp_f32 v216, v152
  v_cvt_pk_bf16_f32 v186, v220, v221
  v_add_f32 v226, v226, v222
  v_mfma_f32_16x16x32_bf16 a[76:79], a[164:167], v[180:183], a[76:79]
  buffer_load_dwordx4 v[164:167], v2, s[40:43], s14 offen offset:1024 sc1
  v_exp_f32 v217, v153
  v_mfma_f32_16x16x32_bf16 a[80:83], a[168:171], v[176:179], a[80:83]
  v_exp_f32 v218, v154
  v_add_f32 v226, v226, v223
  v_mfma_f32_16x16x32_bf16 a[84:87], a[168:171], v[180:183], a[84:87]
  buffer_load_dwordx4 v[168:171], v2, s[40:43], s14 offen offset:2048 sc1
  v_exp_f32 v219, v155
  v_cvt_pk_bf16_f32 v187, v222, v223
  v_mfma_f32_16x16x32_bf16 a[88:91], a[172:175], v[176:179], a[88:91]
  v_exp_f32 v220, v156
  v_mfma_f32_16x16x32_bf16 a[92:95], a[172:175], v[180:183], a[92:95]
  s_waitcnt lgkmcnt(0)
  buffer_load_dwordx4 v[172:175], v2, s[40:43], s14 offen offset:3072 sc1
  v_add_f32 v227, v216, v217
  v_cvt_pk_bf16_f32 v188, v216, v217
  v_add_f32 v227, v227, v218
  v_mfma_f32_16x16x32_bf16 a[96:99], a[176:179], v[176:179], a[96:99]
  v_exp_f32 v221, v157
  v_mfma_f32_16x16x32_bf16 a[100:103], a[176:179], v[180:183], a[100:103]
  s_add_u32 s14, s13, 53248
  buffer_load_dwordx4 v[192:195], v2, s[40:43], s14 offen offset:0 sc1
  v_exp_f32 v222, v158
  v_mfma_f32_16x16x32_bf16 a[104:107], a[180:183], v[176:179], a[104:107]
  v_exp_f32 v223, v159
  v_mfma_f32_16x16x32_bf16 a[108:111], a[180:183], v[180:183], a[108:111]
  buffer_load_dwordx4 v[196:199], v2, s[40:43], s14 offen offset:1024 sc1
  v_add_f32 v227, v227, v219
  v_cvt_pk_bf16_f32 v189, v218, v219
  v_add_f32 v227, v227, v220
  v_add_f32 v227, v227, v221
  v_cvt_pk_bf16_f32 v190, v220, v221
  v_add_f32 v227, v227, v222
  v_mfma_f32_16x16x32_bf16 a[112:115], a[184:187], v[176:179], a[112:115]
  v_add_f32 v227, v227, v223
  v_max_f32 v5, v226, v227
  v_cmp_lt_f32 vcc, s81, v5
  v_mfma_f32_16x16x32_bf16 a[116:119], a[184:187], v[180:183], a[116:119]
  buffer_load_dwordx4 v[208:211], v2, s[40:43], s14 offen offset:2048 sc1
  v_mfma_f32_16x16x32_bf16 a[120:123], a[188:191], v[176:179], a[120:123]
  v_cvt_pk_bf16_f32 v191, v222, v223
  v_mfma_f32_16x16x32_bf16 a[124:127], a[188:191], v[180:183], a[124:127]
  s_cbranch_vccnz fa_stub30
fa_back30:
  v_add_f32 v230, v230, v226
  v_add_f32 v231, v231, v227
  ds_read_b128 a[160:163], v3 offset:24576
  ds_read_b128 a[164:167], v3 offset:25600
  ds_read_b128 a[168:171], v3 offset:26624
  ds_read_b128 a[172:175], v3 offset:27648
  ds_read_b128 a[176:179], v3 offset:28672
  ds_read_b128 a[180:183], v3 offset:29696
  ds_read_b128 a[184:187], v3 offset:30720
  ds_read_b128 a[188:191], v3 offset:31744
  s_waitcnt lgkmcnt(4)
  v_mfma_f32_16x16x32_bf16 a[64:67], a[160:163], v[184:187], a[64:67]
  v_mfma_f32_16x16x32_bf16 a[68:71], a[160:163], v[188:191], a[68:71]
  s_add_u32 s14, s13, 53248
  buffer_load_dwordx4 v[212:215], v2, s[40:43], s14 offen offset:3072 sc1
  v_mfma_f32_16x16x32_bf16 a[72:75], a[164:167], v[184:187], a[72:75]
  s_add_u32 s66, s66, 32768
  v_mfma_f32_16x16x32_bf16 a[76:79], a[164:167], v[188:191], a[76:79]
  s_add_u32 s14, s13, 57344
  buffer_load_dwordx4 v[232:235], v2, s[40:43], s14 offen offset:0 sc1
  v_mfma_f32_16x16x32_bf16 a[80:83], a[168:171], v[184:187], a[80:83]
  s_and_b32 s66, s66, 0x1ffff
  v_mfma_f32_16x16x32_bf16 a[84:87], a[168:171], v[188:191], a[84:87]
  v_mfma_f32_16x16x32_bf16 a[88:91], a[172:175], v[184:187], a[88:91]
  buffer_load_dwordx4 v[236:239], v2, s[40:43], s14 offen offset:1024 sc1
  v_mfma_f32_16x16x32_bf16 a[92:95], a[172:175], v[188:191], a[92:95]
  s_waitcnt lgkmcnt(0)
  v_mfma_f32_16x16x32_bf16 a[96:99], a[176:179], v[184:187], a[96:99]
  v_mfma_f32_16x16x32_bf16 a[100:103], a[176:179], v[188:191], a[100:103]
  buffer_load_dwordx4 v[240:243], v2, s[40:43], s14 offen offset:2048 sc1
  v_mfma_f32_16x16x32_bf16 a[104:107], a[180:183], v[184:187], a[104:107]
  v_mfma_f32_16x16x32_bf16 a[108:111], a[180:183], v[188:191], a[108:111]
  v_mfma_f32_16x16x32_bf16 a[112:115], a[184:187], v[184:187], a[112:115]
  buffer_load_dwordx4 v[244:247], v2, s[40:43], s14 offen offset:3072 sc1
  v_mfma_f32_16x16x32_bf16 a[116:119], a[184:187], v[188:191], a[116:119]
  v_mfma_f32_16x16x32_bf16 a[120:123], a[188:191], v[184:187], a[120:123]
  v_add_u32 v3, s66, v2
  v_mfma_f32_16x16x32_bf16 a[124:127], a[188:191], v[188:191], a[124:127]
fa_Bdone:
  s_cmp_ge_u32 s20, 2
  s_cbranch_scc1 fa_epi
  s_barrier
fa_epi:
  v_mov_b32 v20, v230
  v_mov_b32 v21, v231
  s_nop 1
  v_permlane16_swap_b32 v230, v20
  v_permlane16_swap_b32 v231, v21
  v_add_f32 v230, v230, v20
  v_add_f32 v231, v231, v21
  v_mov_b32 v20, v230
  v_mov_b32 v21, v231
  s_nop 1
  v_permlane32_swap_b32 v230, v20
  v_permlane32_swap_b32 v231, v21
  v_add_f32 v230, v230, v20
  v_add_f32 v231, v231, v21
  v_rcp_f32 v16, v230
  v_rcp_f32 v18, v231
  s_sub_u32 s23, 15, s22
  s_lshl_b32 s23, s23, 2
  v_mov_b32 v17, v16
  v_mov_b32 v19, v18
  s_add_u32 s23, s23, s20
  s_lshl_b32 s23, s23, 18
  s_lshl_b32 s31, s21, 12
  s_add_u32 s31, s31, 50331648
  s_add_u32 s64, s23, s31
  s_add_u32 s65, s64, 131072
  v_accvgpr_read_b32 v68, a64
  v_accvgpr_read_b32 v69, a65
  v_accvgpr_read_b32 v70, a66
  v_accvgpr_read_b32 v71, a67
  v_accvgpr_read_b32 v72, a72
  v_accvgpr_read_b32 v73, a73
  v_accvgpr_read_b32 v74, a74
  v_accvgpr_read_b32 v75, a75
  v_pk_mul_f32 v[68:69], v[68:69], v[16:17]
  v_pk_mul_f32 v[70:71], v[70:71], v[16:17]
  v_pk_mul_f32 v[72:73], v[72:73], v[16:17]
  v_pk_mul_f32 v[74:75], v[74:75], v[16:17]
  v_cvt_pk_bf16_f32 v64, v68, v69
  v_cvt_pk_bf16_f32 v65, v70, v71
  v_cvt_pk_bf16_f32 v66, v72, v73
  v_cvt_pk_bf16_f32 v67, v74, v75
  buffer_store_dwordx4 v[64:67], v2, s[40:43], s64 offen offset:0 sc1
  v_accvgpr_read_b32 v80, a80
  v_accvgpr_read_b32 v81, a81
  v_accvgpr_read_b32 v82, a82
  v_accvgpr_read_b32 v83, a83
  v_accvgpr_read_b32 v84, a88
  v_accvgpr_read_b32 v85, a89
  v_accvgpr_read_b32 v86, a90
  v_accvgpr_read_b32 v87, a91
  v_pk_mul_f32 v[80:81], v[80:81], v[16:17]
  v_pk_mul_f32 v[82:83], v[82:83], v[16:17]
  v_pk_mul_f32 v[84:85], v[84:85], v[16:17]
  v_pk_mul_f32 v[86:87], v[86:87], v[16:17]
  v_cvt_pk_bf16_f32 v76, v80, v81
  v_cvt_pk_bf16_f32 v77, v82, v83
  v_cvt_pk_bf16_f32 v78, v84, v85
  v_cvt_pk_bf16_f32 v79, v86, v87
  buffer_store_dwordx4 v[76:79], v2, s[40:43], s64 offen offset:1024 sc1
  v_accvgpr_read_b32 v132, a96
  v_accvgpr_read_b32 v133, a97
  v_accvgpr_read_b32 v134, a98
  v_accvgpr_read_b32 v135, a99
  v_accvgpr_read_b32 v136, a104
  v_accvgpr_read_b32 v137, a105
  v_accvgpr_read_b32 v138, a106
  v_accvgpr_read_b32 v139, a107
  v_pk_mul_f32 v[132:133], v[132:133], v[16:17]
  v_pk_mul_f32 v[134:135], v[134:135], v[16:17]
  v_pk_mul_f32 v[136:137], v[136:137], v[16:17]
  v_pk_mul_f32 v[138:139], v[138:139], v[16:17]
  v_cvt_pk_bf16_f32 v128, v132, v133
  v_cvt_pk_bf16_f32 v129, v134, v135
  v_cvt_pk_bf16_f32 v130, v136, v137
  v_cvt_pk_bf16_f32 v131, v138, v139
  buffer_store_dwordx4 v[128:131], v2, s[40:43], s64 offen offset:2048 sc1
  v_accvgpr_read_b32 v144, a112
  v_accvgpr_read_b32 v145, a113
  v_accvgpr_read_b32 v146, a114
  v_accvgpr_read_b32 v147, a115
  v_accvgpr_read_b32 v148, a120
  v_accvgpr_read_b32 v149, a121
  v_accvgpr_read_b32 v150, a122
  v_accvgpr_read_b32 v151, a123
  v_pk_mul_f32 v[144:145], v[144:145], v[16:17]
  v_pk_mul_f32 v[146:147], v[146:147], v[16:17]
  v_pk_mul_f32 v[148:149], v[148:149], v[16:17]
  v_pk_mul_f32 v[150:151], v[150:151], v[16:17]
  v_cvt_pk_bf16_f32 v140, v144, v145
  v_cvt_pk_bf16_f32 v141, v146, v147
  v_cvt_pk_bf16_f32 v142, v148, v149
  v_cvt_pk_bf16_f32 v143, v150, v151
  buffer_store_dwordx4 v[140:143], v2, s[40:43], s64 offen offset:3072 sc1
  v_accvgpr_read_b32 v68, a68
  v_accvgpr_read_b32 v69, a69
  v_accvgpr_read_b32 v70, a70
  v_accvgpr_read_b32 v71, a71
  v_accvgpr_read_b32 v72, a76
  v_accvgpr_read_b32 v73, a77
  v_accvgpr_read_b32 v74, a78
  v_accvgpr_read_b32 v75, a79
  v_pk_mul_f32 v[68:69], v[68:69], v[18:19]
  v_pk_mul_f32 v[70:71], v[70:71], v[18:19]
  v_pk_mul_f32 v[72:73], v[72:73], v[18:19]
  v_pk_mul_f32 v[74:75], v[74:75], v[18:19]
  v_cvt_pk_bf16_f32 v64, v68, v69
  v_cvt_pk_bf16_f32 v65, v70, v71
  v_cvt_pk_bf16_f32 v66, v72, v73
  v_cvt_pk_bf16_f32 v67, v74, v75
  buffer_store_dwordx4 v[64:67], v2, s[40:43], s65 offen offset:0 sc1
  v_accvgpr_read_b32 v80, a84
  v_accvgpr_read_b32 v81, a85
  v_accvgpr_read_b32 v82, a86
  v_accvgpr_read_b32 v83, a87
  v_accvgpr_read_b32 v84, a92
  v_accvgpr_read_b32 v85, a93
  v_accvgpr_read_b32 v86, a94
  v_accvgpr_read_b32 v87, a95
  v_pk_mul_f32 v[80:81], v[80:81], v[18:19]
  v_pk_mul_f32 v[82:83], v[82:83], v[18:19]
  v_pk_mul_f32 v[84:85], v[84:85], v[18:19]
  v_pk_mul_f32 v[86:87], v[86:87], v[18:19]
  v_cvt_pk_bf16_f32 v76, v80, v81
  v_cvt_pk_bf16_f32 v77, v82, v83
  v_cvt_pk_bf16_f32 v78, v84, v85
  v_cvt_pk_bf16_f32 v79, v86, v87
  buffer_store_dwordx4 v[76:79], v2, s[40:43], s65 offen offset:1024 sc1
  v_accvgpr_read_b32 v132, a100
  v_accvgpr_read_b32 v133, a101
  v_accvgpr_read_b32 v134, a102
  v_accvgpr_read_b32 v135, a103
  v_accvgpr_read_b32 v136, a108
  v_accvgpr_read_b32 v137, a109
  v_accvgpr_read_b32 v138, a110
  v_accvgpr_read_b32 v139, a111
  v_pk_mul_f32 v[132:133], v[132:133], v[18:19]
  v_pk_mul_f32 v[134:135], v[134:135], v[18:19]
  v_pk_mul_f32 v[136:137], v[136:137], v[18:19]
  v_pk_mul_f32 v[138:139], v[138:139], v[18:19]
  v_cvt_pk_bf16_f32 v128, v132, v133
  v_cvt_pk_bf16_f32 v129, v134, v135
  v_cvt_pk_bf16_f32 v130, v136, v137
  v_cvt_pk_bf16_f32 v131, v138, v139
  buffer_store_dwordx4 v[128:131], v2, s[40:43], s65 offen offset:2048 sc1
  v_accvgpr_read_b32 v144, a116
  v_accvgpr_read_b32 v145, a117
  v_accvgpr_read_b32 v146, a118
  v_accvgpr_read_b32 v147, a119
  v_accvgpr_read_b32 v148, a124
  v_accvgpr_read_b32 v149, a125
  v_accvgpr_read_b32 v150, a126
  v_accvgpr_read_b32 v151, a127
  v_pk_mul_f32 v[144:145], v[144:145], v[18:19]
  v_pk_mul_f32 v[146:147], v[146:147], v[18:19]
  v_pk_mul_f32 v[148:149], v[148:149], v[18:19]
  v_pk_mul_f32 v[150:151], v[150:151], v[18:19]
  v_cvt_pk_bf16_f32 v140, v144, v145
  v_cvt_pk_bf16_f32 v141, v146, v147
  v_cvt_pk_bf16_f32 v142, v148, v149
  v_cvt_pk_bf16_f32 v143, v150, v151
  buffer_store_dwordx4 v[140:143], v2, s[40:43], s65 offen offset:3072 sc1
  s_load_dwordx2 s[4:5], s[0:1], 0
  s_load_dwordx2 s[6:7], s[0:1], 88
  v_mov_b32 v30, 1073741824
  v_writelane_b32 v30, s80, 0
  v_writelane_b32 v30, s3, 1
  s_cmp_lt_u32 s12, 3
  s_cbranch_scc1 fa_puby
  s_add_u32 s14, s13, 61440
  buffer_load_dwordx4 v[64:67], v2, s[40:43], s14 offen offset:0 sc1
  buffer_load_dwordx4 v[68:71], v2, s[40:43], s14 offen offset:1024 sc1
  buffer_load_dwordx4 v[72:75], v2, s[40:43], s14 offen offset:2048 sc1
  buffer_load_dwordx4 v[76:79], v2, s[40:43], s14 offen offset:3072 sc1
  s_add_u32 s14, s13, 65536
  buffer_load_dwordx4 v[80:83], v2, s[40:43], s14 offen offset:0 sc1
  buffer_load_dwordx4 v[84:87], v2, s[40:43], s14 offen offset:1024 sc1
  buffer_load_dwordx4 v[88:91], v2, s[40:43], s14 offen offset:2048 sc1
  buffer_load_dwordx4 v[92:95], v2, s[40:43], s14 offen offset:3072 sc1
  s_waitcnt vmcnt(8)
  buffer_store_dword v4, v30, s[40:43], 0 offen sc1
fa_pubb:
  s_cmp_lt_u32 s29, 8
  s_cbranch_scc1 fa_left
fa_leftb:
  s_add_u32 s14, s13, 69632
  buffer_load_dwordx4 v[128:131], v2, s[40:43], s14 offen offset:0 sc1
  buffer_load_dwordx4 v[132:135], v2, s[40:43], s14 offen offset:1024 sc1
  buffer_load_dwordx4 v[136:139], v2, s[40:43], s14 offen offset:2048 sc1
  buffer_load_dwordx4 v[140:143], v2, s[40:43], s14 offen offset:3072 sc1
  s_add_u32 s14, s13, 73728
  buffer_load_dwordx4 v[144:147], v2, s[40:43], s14 offen offset:0 sc1
  buffer_load_dwordx4 v[148:151], v2, s[40:43], s14 offen offset:1024 sc1
  s_lshl_b32 s64, s21, 19
  s_lshl_b32 s23, s20, 15
  s_add_u32 s64, s64, s23
  s_add_u32 s64, s64, 50331648
  s_add_u32 s65, s64, 131072
  s_add_u32 s66, s64, 262144
  s_add_u32 s67, s64, 393216
  v_bfe_u32 v12, v1, 3, 1
  v_lshlrev_b32 v12, 7, v12
  v_and_b32 v13, 7, v1
  v_lshl_add_u32 v12, v13, 2, v12
  s_lshl_b32 s23, s21, 8
  s_lshl_b32 s31, s20, 5
  s_add_u32 s23, s23, s31
  s_add_u32 s23, s23, 2641920
  v_add_u32 v12, s23, v12
  s_lshl_b32 s25, s21, 6
  s_mul_i32 s26, s22, 160
  s_mul_i32 s27, s22, 2560
  v_mov_b32 v20, 0
  v_mov_b32 v21, 0
  v_mov_b32 v22, 0
  v_mov_b32 v23, 0
  v_add_u32 v16, 158208, v2
  ds_write_b128 v16, v[20:23]
  s_add_u32 s33, s13, 126976
  s_mul_i32 s34, s20, 38912
  v_add_u32 v11, s34, v2
  s_add_u32 s35, s34, 36864
  buffer_load_dwordx4 v[152:155], v2, s[40:43], s14 offen offset:2048 sc1
  buffer_load_dwordx4 v[156:159], v2, s[40:43], s14 offen offset:3072 sc1
  s_add_u32 s14, s13, 77824
  buffer_load_dwordx4 v[176:179], v2, s[40:43], s14 offen offset:0 sc1
  buffer_load_dwordx4 v[180:183], v2, s[40:43], s14 offen offset:1024 sc1
  buffer_load_dwordx4 v[184:187], v2, s[40:43], s14 offen offset:2048 sc1
  buffer_load_dwordx4 v[188:191], v2, s[40:43], s14 offen offset:3072 sc1
  s_add_u32 s13, s13, 81920
  s_waitcnt lgkmcnt(0)
  s_barrier
  s_mov_b32 s44, s4
  s_mov_b32 s45, s5
  s_mov_b32 s46, 2621440
  s_mov_b32 s47, 0x20000
  s_mov_b32 s48, s6
  s_mov_b32 s49, s7
  s_mov_b32 s50, 2621440
  s_mov_b32 s51, 0x20000
  s_mov_b32 m0, s34
  s_add_u32 s34, s34, 4096
  buffer_load_dwordx4 v2, s[40:43], s33 offen offset:0 sc1 lds
  buffer_load_dwordx4 v2, s[40:43], s33 offen offset:1024 sc1 lds
  buffer_load_dwordx4 v2, s[40:43], s33 offen offset:2048 sc1 lds
  buffer_load_dwordx4 v2, s[40:43], s33 offen offset:3072 sc1 lds
  s_add_u32 s33, s33, 4096
  s_mov_b32 m0, s34
  s_add_u32 s34, s34, 4096
  buffer_load_dwordx4 v2, s[40:43], s33 offen offset:0 sc1 lds
  buffer_load_dwordx4 v2, s[40:43], s33 offen offset:1024 sc1 lds
  buffer_load_dwordx4 v2, s[40:43], s33 offen offset:2048 sc1 lds
  buffer_load_dwordx4 v2, s[40:43], s33 offen offset:3072 sc1 lds
  s_add_u32 s33, s33, 4096
  s_mov_b32 m0, s34
  s_add_u32 s34, s34, 4096
  buffer_load_dwordx4 v2, s[40:43], s33 offen offset:0 sc1 lds
  buffer_load_dwordx4 v2, s[40:43], s33 offen offset:1024 sc1 lds
  buffer_load_dwordx4 v2, s[40:43], s33 offen offset:2048 sc1 lds
  buffer_load_dwordx4 v2, s[40:43], s33 offen offset:3072 sc1 lds
  s_add_u32 s33, s33, 4096
  s_mov_b32 m0, s34
  s_add_u32 s34, s34, 4096
  buffer_load_dwordx4 v2, s[40:43], s33 offen offset:0 sc1 lds
  buffer_load_dwordx4 v2, s[40:43], s33 offen offset:1024 sc1 lds
  buffer_load_dwordx4 v2, s[40:43], s33 offen offset:2048 sc1 lds
  buffer_load_dwordx4 v2, s[40:43], s33 offen offset:3072 sc1 lds
  s_add_u32 s33, s33, 4096
  s_mov_b32 m0, s34
  s_add_u32 s34, s34, 4096
  buffer_load_dwordx4 v2, s[40:43], s33 offen offset:0 sc1 lds
  buffer_load_dwordx4 v2, s[40:43], s33 offen offset:1024 sc1 lds
  buffer_load_dwordx4 v2, s[40:43], s33 offen offset:2048 sc1 lds
  buffer_load_dwordx4 v2, s[40:43], s33 offen offset:3072 sc1 lds
  s_add_u32 s33, s33, 4096
  s_mov_b32 m0, s34
  s_add_u32 s34, s34, 4096
  buffer_load_dwordx4 v2, s[40:43], s33 offen offset:0 sc1 lds
  buffer_load_dwordx4 v2, s[40:43], s33 offen offset:1024 sc1 lds
  buffer_load_dwordx4 v2, s[40:43], s33 offen offset:2048 sc1 lds
  buffer_load_dwordx4 v2, s[40:43], s33 offen offset:3072 sc1 lds
  s_add_u32 s33, s33, 4096
  s_mov_b32 m0, s34
  s_add_u32 s34, s34, 4096
  buffer_load_dwordx4 v2, s[40:43], s33 offen offset:0 sc1 lds
  buffer_load_dwordx4 v2, s[40:43], s33 offen offset:1024 sc1 lds
  buffer_load_dwordx4 v2, s[40:43], s33 offen offset:2048 sc1 lds
  buffer_load_dwordx4 v2, s[40:43], s33 offen offset:3072 sc1 lds
  s_add_u32 s33, s33, 4096
  buffer_load_dword v13, v12, s[40:43], 0 offen sc1
  s_mov_b32 m0, s34
  s_add_u32 s34, s34, 4096
  buffer_load_dwordx4 v2, s[40:43], s33 offen offset:0 sc1 lds
  buffer_load_dwordx4 v2, s[40:43], s33 offen offset:1024 sc1 lds
  buffer_load_dwordx4 v2, s[40:43], s33 offen offset:2048 sc1 lds
  buffer_load_dwordx4 v2, s[40:43], s33 offen offset:3072 sc1 lds
  s_add_u32 s33, s33, 4096
  s_mov_b32 m0, s34
  s_add_u32 s34, s34, 4096
  buffer_load_dwordx4 v2, s[40:43], s33 offen offset:0 sc1 lds
  buffer_load_dwordx4 v2, s[40:43], s33 offen offset:1024 sc1 lds
  buffer_load_dwordx4 v2, s[40:43], s33 offen offset:2048 sc1 lds
  buffer_load_dwordx4 v2, s[40:43], s33 offen offset:3072 sc1 lds
  s_add_u32 s33, s33, 4096
  s_waitcnt vmcnt(8)
  v_cmp_eq_u32 vcc, 0, v13
  s_cbranch_vccnz fa_ctx_spin
fa_ctx_ok:
  buffer_load_dwordx4 a[144:147], v2, s[40:43], s64 offen offset:0 sc1
  buffer_load_dwordx4 a[148:151], v2, s[40:43], s65 offen offset:0 sc1
  buffer_load_dwordx4 a[152:155], v2, s[40:43], s66 offen offset:0 sc1
  buffer_load_dwordx4 a[156:159], v2, s[40:43], s67 offen offset:0 sc1
  buffer_load_dwordx4 a[160:163], v2, s[40:43], s64 offen offset:1024 sc1
  buffer_load_dwordx4 a[164:167], v2, s[40:43], s65 offen offset:1024 sc1
  buffer_load_dwordx4 a[168:171], v2, s[40:43], s66 offen offset:1024 sc1
  buffer_load_dwordx4 a[172:175], v2, s[40:43], s67 offen offset:1024 sc1
  buffer_load_dwordx4 a[176:179], v2, s[40:43], s64 offen offset:2048 sc1
  buffer_load_dwordx4 a[180:183], v2, s[40:43], s65 offen offset:2048 sc1
  buffer_load_dwordx4 a[184:187], v2, s[40:43], s66 offen offset:2048 sc1
  buffer_load_dwordx4 a[188:191], v2, s[40:43], s67 offen offset:2048 sc1
  buffer_load_dwordx4 v[216:219], v2, s[40:43], s64 offen offset:3072 sc1
  buffer_load_dwordx4 v[220:223], v2, s[40:43], s65 offen offset:3072 sc1
  buffer_load_dwordx4 v[224:227], v2, s[40:43], s66 offen offset:3072 sc1
  buffer_load_dwordx4 v[228:231], v2, s[40:43], s67 offen offset:3072 sc1
  s_add_u32 s64, s64, 4096
  s_add_u32 s65, s65, 4096
  s_add_u32 s66, s66, 4096
  s_add_u32 s67, s67, 4096
  s_waitcnt vmcnt(12)
  v_mfma_f32_16x16x32_bf16 a[64:67], a[0:3], a[144:147], 0
  v_mfma_f32_16x16x32_bf16 a[68:71], a[0:3], a[148:151], 0
  v_mfma_f32_16x16x32_bf16 a[72:75], a[0:3], a[152:155], 0
  v_mfma_f32_16x16x32_bf16 a[76:79], a[0:3], a[156:159], 0
  buffer_load_dwordx4 a[0:3], v2, s[40:43], s13 offen offset:0 sc1
  v_mfma_f32_16x16x32_bf16 a[80:83], a[4:7], a[144:147], 0
  v_mfma_f32_16x16x32_bf16 a[84:87], a[4:7], a[148:151], 0
  v_mfma_f32_16x16x32_bf16 a[88:91], a[4:7], a[152:155], 0
  v_mfma_f32_16x16x32_bf16 a[92:95], a[4:7], a[156:159], 0
  buffer_load_dwordx4 a[4:7], v2, s[40:43], s13 offen offset:1024 sc1
  v_mfma_f32_16x16x32_bf16 a[96:99], a[8:11], a[144:147], 0
  v_mfma_f32_16x16x32_bf16 a[100:103], a[8:11], a[148:151], 0
  v_mfma_f32_16x16x32_bf16 a[104:107], a[8:11], a[152:155], 0
  v_mfma_f32_16x16x32_bf16 a[108:111], a[8:11], a[156:159], 0
  buffer_load_dwordx4 a[8:11], v2, s[40:43], s13 offen offset:2048 sc1
  v_mfma_f32_16x16x32_bf16 a[112:115], a[12:15], a[144:147], 0
  v_mfma_f32_16x16x32_bf16 a[116:119], a[12:15], a[148:151], 0
  v_mfma_f32_16x16x32_bf16 a[120:123], a[12:15], a[152:155], 0
  v_mfma_f32_16x16x32_bf16 a[124:127], a[12:15], a[156:159], 0
  v_mfma_f32_16x16x32_bf16 a[128:131], a[16:19], a[144:147], 0
  buffer_load_dwordx4 a[144:147], v2, s[40:43], s64 offen offset:0 sc1
  v_mfma_f32_16x16x32_bf16 a[132:135], a[16:19], a[148:151], 0
  buffer_load_dwordx4 a[148:151], v2, s[40:43], s65 offen offset:0 sc1
  v_mfma_f32_16x16x32_bf16 a[136:139], a[16:19], a[152:155], 0
  buffer_load_dwordx4 a[152:155], v2, s[40:43], s66 offen offset:0 sc1
  v_mfma_f32_16x16x32_bf16 a[140:143], a[16:19], a[156:159], 0
  buffer_load_dwordx4 a[156:159], v2, s[40:43], s67 offen offset:0 sc1
  s_waitcnt vmcnt(15)
  v_mfma_f32_16x16x32_bf16 a[64:67], a[20:23], a[160:163], a[64:67]
  v_add_u32 v16, 0, v0
  v_mfma_f32_16x16x32_bf16 a[68:71], a[20:23], a[164:167], a[68:71]
  v_mfma_f32_16x16x32_bf16 a[72:75], a[20:23], a[168:171], a[72:75]
  v_mul_u32_u24 v17, 6554, v16
  v_mfma_f32_16x16x32_bf16 a[76:79], a[20:23], a[172:175], a[76:79]
  buffer_load_dwordx4 a[12:15], v2, s[40:43], s13 offen offset:3072 sc1
  v_mfma_f32_16x16x32_bf16 a[80:83], a[24:27], a[160:163], a[80:83]
  s_add_u32 s13, s13, 4096
  v_mfma_f32_16x16x32_bf16 a[84:87], a[24:27], a[164:167], a[84:87]
  v_lshrrev_b32 v17, 16, v17
  v_mfma_f32_16x16x32_bf16 a[88:91], a[24:27], a[168:171], a[88:91]
  v_mul_u32_u24 v18, 10, v17
  v_mfma_f32_16x16x32_bf16 a[92:95], a[24:27], a[172:175], a[92:95]
  buffer_load_dwordx4 a[16:19], v2, s[40:43], s13 offen offset:0 sc1
  v_mfma_f32_16x16x32_bf16 a[96:99], a[28:31], a[160:163], a[96:99]
  v_mfma_f32_16x16x32_bf16 a[100:103], a[28:31], a[164:167], a[100:103]
  v_sub_u32 v18, v16, v18
  v_mfma_f32_16x16x32_bf16 a[104:107], a[28:31], a[168:171], a[104:107]
  v_mfma_f32_16x16x32_bf16 a[108:111], a[28:31], a[172:175], a[108:111]
  v_mfma_f32_16x16x32_bf16 a[112:115], a[32:35], a[160:163], a[112:115]
  v_mfma_f32_16x16x32_bf16 a[116:119], a[32:35], a[164:167], a[116:119]
  v_mul_u32_u24 v251, 336, v17
  v_mfma_f32_16x16x32_bf16 a[120:123], a[32:35], a[168:171], a[120:123]
  v_lshl_add_u32 v251, v18, 5, v251
  v_mfma_f32_16x16x32_bf16 a[124:127], a[32:35], a[172:175], a[124:127]
  v_mfma_f32_16x16x32_bf16 a[128:131], a[36:39], a[160:163], a[128:131]
  buffer_load_dwordx4 a[160:163], v2, s[40:43], s64 offen offset:1024 sc1
  v_mfma_f32_16x16x32_bf16 a[132:135], a[36:39], a[164:167], a[132:135]
  buffer_load_dwordx4 a[164:167], v2, s[40:43], s65 offen offset:1024 sc1
  v_mfma_f32_16x16x32_bf16 a[136:139], a[36:39], a[168:171], a[136:139]
  buffer_load_dwordx4 a[168:171], v2, s[40:43], s66 offen offset:1024 sc1
  v_mfma_f32_16x16x32_bf16 a[140:143], a[36:39], a[172:175], a[140:143]
  buffer_load_dwordx4 a[172:175], v2, s[40:43], s67 offen offset:1024 sc1
  s_waitcnt vmcnt(17)
  v_mfma_f32_16x16x32_bf16 a[64:67], a[40:43], a[176:179], a[64:67]
  v_lshlrev_b32 v203, 5, v18
  v_mfma_f32_16x16x32_bf16 a[68:71], a[40:43], a[180:183], a[68:71]
  v_mfma_f32_16x16x32_bf16 a[72:75], a[40:43], a[184:187], a[72:75]
  v_add_u32 v17, s25, v17
  v_mfma_f32_16x16x32_bf16 a[76:79], a[40:43], a[188:191], a[76:79]
  buffer_load_dwordx4 a[20:23], v2, s[40:43], s13 offen offset:1024 sc1
  v_mfma_f32_16x16x32_bf16 a[80:83], a[44:47], a[176:179], a[80:83]
  v_mfma_f32_16x16x32_bf16 a[84:87], a[44:47], a[180:183], a[84:87]
  v_add_u32 v24, 1, v17
  v_mfma_f32_16x16x32_bf16 a[88:91], a[44:47], a[184:187], a[88:91]
  v_mul_u32_u24 v248, 1280, v17
  v_mfma_f32_16x16x32_bf16 a[92:95], a[44:47], a[188:191], a[92:95]
  buffer_load_dwordx4 a[24:27], v2, s[40:43], s13 offen offset:2048 sc1
  v_mfma_f32_16x16x32_bf16 a[96:99], a[48:51], a[176:179], a[96:99]
  v_mfma_f32_16x16x32_bf16 a[100:103], a[48:51], a[180:183], a[100:103]
  v_lshl_add_u32 v248, v18, 4, v248
  v_mfma_f32_16x16x32_bf16 a[104:107], a[48:51], a[184:187], a[104:107]
  v_mfma_f32_16x16x32_bf16 a[108:111], a[48:51], a[188:191], a[108:111]
  v_mfma_f32_16x16x32_bf16 a[112:115], a[52:55], a[176:179], a[112:115]
  v_mfma_f32_16x16x32_bf16 a[116:119], a[52:55], a[180:183], a[116:119]
  v_add_u32 v248, s26, v248
  v_mfma_f32_16x16x32_bf16 a[120:123], a[52:55], a[184:187], a[120:123]
  v_lshrrev_b32 v19, 4, v17
  v_mfma_f32_16x16x32_bf16 a[124:127], a[52:55], a[188:191], a[124:127]
  v_mfma_f32_16x16x32_bf16 a[128:131], a[56:59], a[176:179], a[128:131]
  buffer_load_dwordx4 a[176:179], v2, s[40:43], s64 offen offset:2048 sc1
  v_mfma_f32_16x16x32_bf16 a[132:135], a[56:59], a[180:183], a[132:135]
  buffer_load_dwordx4 a[180:183], v2, s[40:43], s65 offen offset:2048 sc1
  v_mfma_f32_16x16x32_bf16 a[136:139], a[56:59], a[184:187], a[136:139]
  buffer_load_dwordx4 a[184:187], v2, s[40:43], s66 offen offset:2048 sc1
  v_mfma_f32_16x16x32_bf16 a[140:143], a[56:59], a[188:191], a[140:143]
  buffer_load_dwordx4 a[188:191], v2, s[40:43], s67 offen offset:2048 sc1
  s_waitcnt vmcnt(19)
  v_mfma_f32_16x16x32_bf16 a[64:67], a[60:63], v[216:219], a[64:67]
  v_mul_u32_u24 v19, 20480, v19
  v_mfma_f32_16x16x32_bf16 a[68:71], a[60:63], v[220:223], a[68:71]
  v_mfma_f32_16x16x32_bf16 a[72:75], a[60:63], v[224:227], a[72:75]
  v_and_b32 v17, 15, v17
  v_mfma_f32_16x16x32_bf16 a[76:79], a[60:63], v[228:231], a[76:79]
  buffer_load_dwordx4 a[28:31], v2, s[40:43], s13 offen offset:3072 sc1
  v_mfma_f32_16x16x32_bf16 a[80:83], a[192:195], v[216:219], a[80:83]
  s_add_u32 s13, s13, 4096
  v_mfma_f32_16x16x32_bf16 a[84:87], a[192:195], v[220:223], a[84:87]
  v_lshl_add_u32 v19, v17, 4, v19
  v_mfma_f32_16x16x32_bf16 a[88:91], a[192:195], v[224:227], a[88:91]
  v_lshl_add_u32 v200, v18, 8, v19
  v_mfma_f32_16x16x32_bf16 a[92:95], a[192:195], v[228:231], a[92:95]
  buffer_load_dwordx4 a[32:35], v2, s[40:43], s13 offen offset:0 sc1
  v_mfma_f32_16x16x32_bf16 a[96:99], a[196:199], v[216:219], a[96:99]
  v_mfma_f32_16x16x32_bf16 a[100:103], a[196:199], v[220:223], a[100:103]
  v_mov_b32 v27, 8
  v_mfma_f32_16x16x32_bf16 a[104:107], a[196:199], v[224:227], a[104:107]
  v_mfma_f32_16x16x32_bf16 a[108:111], a[196:199], v[228:231], a[108:111]
  v_mfma_f32_16x16x32_bf16 a[112:115], a[200:203], v[216:219], a[112:115]
  v_mfma_f32_16x16x32_bf16 a[116:119], a[200:203], v[220:223], a[116:119]
  v_add_u32 v16, 256, v0
  v_mfma_f32_16x16x32_bf16 a[120:123], a[200:203], v[224:227], a[120:123]
  v_mul_u32_u24 v17, 6554, v16
  v_mfma_f32_16x16x32_bf16 a[124:127], a[200:203], v[228:231], a[124:127]
  v_mfma_f32_16x16x32_bf16 a[128:131], a[204:207], v[216:219], a[128:131]
  buffer_load_dwordx4 v[216:219], v2, s[40:43], s64 offen offset:3072 sc1
  v_mfma_f32_16x16x32_bf16 a[132:135], a[204:207], v[220:223], a[132:135]
  buffer_load_dwordx4 v[220:223], v2, s[40:43], s65 offen offset:3072 sc1
  v_mfma_f32_16x16x32_bf16 a[136:139], a[204:207], v[224:227], a[136:139]
  buffer_load_dwordx4 v[224:227], v2, s[40:43], s66 offen offset:3072 sc1
  v_mfma_f32_16x16x32_bf16 a[140:143], a[204:207], v[228:231], a[140:143]
  buffer_load_dwordx4 v[228:231], v2, s[40:43], s67 offen offset:3072 sc1
  s_waitcnt vmcnt(18)
  v_mfma_f32_16x16x32_bf16 a[64:67], a[208:211], a[144:147], a[64:67]
  s_add_u32 s64, s64, 4096
  v_lshrrev_b32 v17, 16, v17
  v_mfma_f32_16x16x32_bf16 a[68:71], a[208:211], a[148:151], a[68:71]
  s_add_u32 s65, s65, 4096
  v_mfma_f32_16x16x32_bf16 a[72:75], a[208:211], a[152:155], a[72:75]
  s_add_u32 s66, s66, 4096
  v_mul_u32_u24 v18, 10, v17
  v_mfma_f32_16x16x32_bf16 a[76:79], a[208:211], a[156:159], a[76:79]
  buffer_load_dwordx4 a[36:39], v2, s[40:43], s13 offen offset:1024 sc1
  v_mfma_f32_16x16x32_bf16 a[80:83], a[212:215], a[144:147], a[80:83]
  v_mfma_f32_16x16x32_bf16 a[84:87], a[212:215], a[148:151], a[84:87]
  v_sub_u32 v18, v16, v18
  v_mfma_f32_16x16x32_bf16 a[88:91], a[212:215], a[152:155], a[88:91]
  s_add_u32 s67, s67, 4096
  v_mul_u32_u24 v252, 336, v17
  v_mfma_f32_16x16x32_bf16 a[92:95], a[212:215], a[156:159], a[92:95]
  buffer_load_dwordx4 a[40:43], v2, s[40:43], s13 offen offset:2048 sc1
  v_mfma_f32_16x16x32_bf16 a[96:99], a[216:219], a[144:147], a[96:99]
  v_mfma_f32_16x16x32_bf16 a[100:103], a[216:219], a[148:151], a[100:103]
  v_lshl_add_u32 v252, v18, 5, v252
  v_mfma_f32_16x16x32_bf16 a[104:107], a[216:219], a[152:155], a[104:107]
  v_mfma_f32_16x16x32_bf16 a[108:111], a[216:219], a[156:159], a[108:111]
  v_mfma_f32_16x16x32_bf16 a[112:115], a[220:223], a[144:147], a[112:115]
  v_mfma_f32_16x16x32_bf16 a[116:119], a[220:223], a[148:151], a[116:119]
  v_lshlrev_b32 v204, 5, v18
  v_mfma_f32_16x16x32_bf16 a[120:123], a[220:223], a[152:155], a[120:123]
  v_add_u32 v17, s25, v17
  v_mfma_f32_16x16x32_bf16 a[124:127], a[220:223], a[156:159], a[124:127]
  v_mfma_f32_16x16x32_bf16 a[128:131], a[224:227], a[144:147], a[128:131]
  buffer_load_dwordx4 a[144:147], v2, s[40:43], s64 offen offset:0 sc1
  v_mfma_f32_16x16x32_bf16 a[132:135], a[224:227], a[148:151], a[132:135]
  buffer_load_dwordx4 a[148:151], v2, s[40:43], s65 offen offset:0 sc1
  v_mfma_f32_16x16x32_bf16 a[136:139], a[224:227], a[152:155], a[136:139]
  buffer_load_dwordx4 a[152:155], v2, s[40:43], s66 offen offset:0 sc1
  v_mfma_f32_16x16x32_bf16 a[140:143], a[224:227], a[156:159], a[140:143]
  buffer_load_dwordx4 a[156:159], v2, s[40:43], s67 offen offset:0 sc1
  s_waitcnt vmcnt(18)
  v_mfma_f32_16x16x32_bf16 a[64:67], a[228:231], a[160:163], a[64:67]
  v_add_u32 v25, 1, v17
  v_mfma_f32_16x16x32_bf16 a[68:71], a[228:231], a[164:167], a[68:71]
  v_mfma_f32_16x16x32_bf16 a[72:75], a[228:231], a[168:171], a[72:75]
  v_mul_u32_u24 v249, 1280, v17
  v_mfma_f32_16x16x32_bf16 a[76:79], a[228:231], a[172:175], a[76:79]
  buffer_load_dwordx4 a[44:47], v2, s[40:43], s13 offen offset:3072 sc1
  v_mfma_f32_16x16x32_bf16 a[80:83], a[232:235], a[160:163], a[80:83]
  s_add_u32 s13, s13, 4096
  v_mfma_f32_16x16x32_bf16 a[84:87], a[232:235], a[164:167], a[84:87]
  v_lshl_add_u32 v249, v18, 4, v249
  v_mfma_f32_16x16x32_bf16 a[88:91], a[232:235], a[168:171], a[88:91]
  v_add_u32 v249, s26, v249
  v_mfma_f32_16x16x32_bf16 a[92:95], a[232:235], a[172:175], a[92:95]
  buffer_load_dwordx4 a[48:51], v2, s[40:43], s13 offen offset:0 sc1
  v_mfma_f32_16x16x32_bf16 a[96:99], a[236:239], a[160:163], a[96:99]
  v_mfma_f32_16x16x32_bf16 a[100:103], a[236:239], a[164:167], a[100:103]
  v_lshrrev_b32 v19, 4, v17
  v_mfma_f32_16x16x32_bf16 a[104:107], a[236:239], a[168:171], a[104:107]
  v_mfma_f32_16x16x32_bf16 a[108:111], a[236:239], a[172:175], a[108:111]
  v_mfma_f32_16x16x32_bf16 a[112:115], a[240:243], a[160:163], a[112:115]
  v_mfma_f32_16x16x32_bf16 a[116:119], a[240:243], a[164:167], a[116:119]
  v_mul_u32_u24 v19, 20480, v19
  v_mfma_f32_16x16x32_bf16 a[120:123], a[240:243], a[168:171], a[120:123]
  v_and_b32 v17, 15, v17
  v_mfma_f32_16x16x32_bf16 a[124:127], a[240:243], a[172:175], a[124:127]
  v_mfma_f32_16x16x32_bf16 a[128:131], a[244:247], a[160:163], a[128:131]
  buffer_load_dwordx4 a[160:163], v2, s[40:43], s64 offen offset:1024 sc1
  v_mfma_f32_16x16x32_bf16 a[132:135], a[244:247], a[164:167], a[132:135]
  buffer_load_dwordx4 a[164:167], v2, s[40:43], s65 offen offset:1024 sc1
  v_mfma_f32_16x16x32_bf16 a[136:139], a[244:247], a[168:171], a[136:139]
  buffer_load_dwordx4 a[168:171], v2, s[40:43], s66 offen offset:1024 sc1
  v_mfma_f32_16x16x32_bf16 a[140:143], a[244:247], a[172:175], a[140:143]
  buffer_load_dwordx4 a[172:175], v2, s[40:43], s67 offen offset:1024 sc1
  s_waitcnt vmcnt(18)
  v_mfma_f32_16x16x32_bf16 a[64:67], a[248:251], a[176:179], a[64:67]
  v_lshl_add_u32 v19, v17, 4, v19
  v_mfma_f32_16x16x32_bf16 a[68:71], a[248:251], a[180:183], a[68:71]
  v_mfma_f32_16x16x32_bf16 a[72:75], a[248:251], a[184:187], a[72:75]
  v_lshl_add_u32 v201, v18, 8, v19
  v_mfma_f32_16x16x32_bf16 a[76:79], a[248:251], a[188:191], a[76:79]
  buffer_load_dwordx4 a[52:55], v2, s[40:43], s13 offen offset:1024 sc1
  v_mfma_f32_16x16x32_bf16 a[80:83], a[252:255], a[176:179], a[80:83]
  v_mfma_f32_16x16x32_bf16 a[84:87], a[252:255], a[180:183], a[84:87]
  v_mov_b32 v28, 8
  v_mfma_f32_16x16x32_bf16 a[88:91], a[252:255], a[184:187], a[88:91]
  v_add_u32 v16, 512, v0
  v_mfma_f32_16x16x32_bf16 a[92:95], a[252:255], a[188:191], a[92:95]
  buffer_load_dwordx4 a[56:59], v2, s[40:43], s13 offen offset:2048 sc1
  v_mfma_f32_16x16x32_bf16 a[96:99], v[32:35], a[176:179], a[96:99]
  v_mfma_f32_16x16x32_bf16 a[100:103], v[32:35], a[180:183], a[100:103]
  v_mul_u32_u24 v17, 6554, v16
  v_mfma_f32_16x16x32_bf16 a[104:107], v[32:35], a[184:187], a[104:107]
  v_mfma_f32_16x16x32_bf16 a[108:111], v[32:35], a[188:191], a[108:111]
  v_mfma_f32_16x16x32_bf16 a[112:115], v[36:39], a[176:179], a[112:115]
  v_mfma_f32_16x16x32_bf16 a[116:119], v[36:39], a[180:183], a[116:119]
  v_lshrrev_b32 v17, 16, v17
  v_mfma_f32_16x16x32_bf16 a[120:123], v[36:39], a[184:187], a[120:123]
  v_mul_u32_u24 v18, 10, v17
  v_mfma_f32_16x16x32_bf16 a[124:127], v[36:39], a[188:191], a[124:127]
  v_mfma_f32_16x16x32_bf16 a[128:131], v[40:43], a[176:179], a[128:131]
  buffer_load_dwordx4 a[176:179], v2, s[40:43], s64 offen offset:2048 sc1
  v_mfma_f32_16x16x32_bf16 a[132:135], v[40:43], a[180:183], a[132:135]
  buffer_load_dwordx4 a[180:183], v2, s[40:43], s65 offen offset:2048 sc1
  v_mfma_f32_16x16x32_bf16 a[136:139], v[40:43], a[184:187], a[136:139]
  buffer_load_dwordx4 a[184:187], v2, s[40:43], s66 offen offset:2048 sc1
  v_mfma_f32_16x16x32_bf16 a[140:143], v[40:43], a[188:191], a[140:143]
  buffer_load_dwordx4 a[188:191], v2, s[40:43], s67 offen offset:2048 sc1
  s_waitcnt vmcnt(18)
  v_mfma_f32_16x16x32_bf16 a[64:67], v[44:47], v[216:219], a[64:67]
  v_sub_u32 v18, v16, v18
  v_mfma_f32_16x16x32_bf16 a[68:71], v[44:47], v[220:223], a[68:71]
  v_mfma_f32_16x16x32_bf16 a[72:75], v[44:47], v[224:227], a[72:75]
  v_mul_u32_u24 v253, 336, v17
  v_mfma_f32_16x16x32_bf16 a[76:79], v[44:47], v[228:231], a[76:79]
  buffer_load_dwordx4 a[60:63], v2, s[40:43], s13 offen offset:3072 sc1
  v_mfma_f32_16x16x32_bf16 a[80:83], v[48:51], v[216:219], a[80:83]
  s_add_u32 s13, s13, 4096
  v_mfma_f32_16x16x32_bf16 a[84:87], v[48:51], v[220:223], a[84:87]
  v_lshl_add_u32 v253, v18, 5, v253
  v_mfma_f32_16x16x32_bf16 a[88:91], v[48:51], v[224:227], a[88:91]
  v_lshlrev_b32 v205, 5, v18
  v_mfma_f32_16x16x32_bf16 a[92:95], v[48:51], v[228:231], a[92:95]
  buffer_load_dwordx4 a[192:195], v2, s[40:43], s13 offen offset:0 sc1
  v_mfma_f32_16x16x32_bf16 a[96:99], v[52:55], v[216:219], a[96:99]
  v_mfma_f32_16x16x32_bf16 a[100:103], v[52:55], v[220:223], a[100:103]
  v_add_u32 v17, s25, v17
  v_mfma_f32_16x16x32_bf16 a[104:107], v[52:55], v[224:227], a[104:107]
  v_mfma_f32_16x16x32_bf16 a[108:111], v[52:55], v[228:231], a[108:111]
  v_mfma_f32_16x16x32_bf16 a[112:115], v[56:59], v[216:219], a[112:115]
  v_mfma_f32_16x16x32_bf16 a[116:119], v[56:59], v[220:223], a[116:119]
  v_add_u32 v26, 1, v17
  v_mfma_f32_16x16x32_bf16 a[120:123], v[56:59], v[224:227], a[120:123]
  v_mul_u32_u24 v250, 1280, v17
  v_mfma_f32_16x16x32_bf16 a[124:127], v[56:59], v[228:231], a[124:127]
  v_mfma_f32_16x16x32_bf16 a[128:131], v[60:63], v[216:219], a[128:131]
  buffer_load_dwordx4 v[216:219], v2, s[40:43], s64 offen offset:3072 sc1
  v_mfma_f32_16x16x32_bf16 a[132:135], v[60:63], v[220:223], a[132:135]
  buffer_load_dwordx4 v[220:223], v2, s[40:43], s65 offen offset:3072 sc1
  v_mfma_f32_16x16x32_bf16 a[136:139], v[60:63], v[224:227], a[136:139]
  buffer_load_dwordx4 v[224:227], v2, s[40:43], s66 offen offset:3072 sc1
  v_mfma_f32_16x16x32_bf16 a[140:143], v[60:63], v[228:231], a[140:143]
  buffer_load_dwordx4 v[228:231], v2, s[40:43], s67 offen offset:3072 sc1
  s_waitcnt vmcnt(18)
  v_mfma_f32_16x16x32_bf16 a[64:67], v[96:99], a[144:147], a[64:67]
  s_add_u32 s64, s64, 4096
  v_lshl_add_u32 v250, v18, 4, v250
  v_mfma_f32_16x16x32_bf16 a[68:71], v[96:99], a[148:151], a[68:71]
  s_add_u32 s65, s65, 4096
  v_mfma_f32_16x16x32_bf16 a[72:75], v[96:99], a[152:155], a[72:75]
  s_add_u32 s66, s66, 4096
  v_add_u32 v250, s26, v250
  v_mfma_f32_16x16x32_bf16 a[76:79], v[96:99], a[156:159], a[76:79]
  buffer_load_dwordx4 a[196:199], v2, s[40:43], s13 offen offset:1024 sc1
  v_mfma_f32_16x16x32_bf16 a[80:83], v[100:103], a[144:147], a[80:83]
  v_mfma_f32_16x16x32_bf16 a[84:87], v[100:103], a[148:151], a[84:87]
  v_lshrrev_b32 v19, 4, v17
  v_mfma_f32_16x16x32_bf16 a[88:91], v[100:103], a[152:155], a[88:91]
  s_add_u32 s67, s67, 4096
  v_mul_u32_u24 v19, 20480, v19
  v_mfma_f32_16x16x32_bf16 a[92:95], v[100:103], a[156:159], a[92:95]
  buffer_load_dwordx4 a[200:203], v2, s[40:43], s13 offen offset:2048 sc1
  v_mfma_f32_16x16x32_bf16 a[96:99], v[104:107], a[144:147], a[96:99]
  v_mfma_f32_16x16x32_bf16 a[100:103], v[104:107], a[148:151], a[100:103]
  v_and_b32 v17, 15, v17
  v_mfma_f32_16x16x32_bf16 a[104:107], v[104:107], a[152:155], a[104:107]
  v_mfma_f32_16x16x32_bf16 a[108:111], v[104:107], a[156:159], a[108:111]
  v_mfma_f32_16x16x32_bf16 a[112:115], v[108:111], a[144:147], a[112:115]
  v_mfma_f32_16x16x32_bf16 a[116:119], v[108:111], a[148:151], a[116:119]
  v_lshl_add_u32 v19, v17, 4, v19
  v_mfma_f32_16x16x32_bf16 a[120:123], v[108:111], a[152:155], a[120:123]
  v_lshl_add_u32 v202, v18, 8, v19
  v_mfma_f32_16x16x32_bf16 a[124:127], v[108:111], a[156:159], a[124:127]
  v_mfma_f32_16x16x32_bf16 a[128:131], v[112:115], a[144:147], a[128:131]
  buffer_load_dwordx4 a[144:147], v2, s[40:43], s64 offen offset:0 sc1
  v_mfma_f32_16x16x32_bf16 a[132:135], v[112:115], a[148:151], a[132:135]
  buffer_load_dwordx4 a[148:151], v2, s[40:43], s65 offen offset:0 sc1
  v_mfma_f32_16x16x32_bf16 a[136:139], v[112:115], a[152:155], a[136:139]
  buffer_load_dwordx4 a[152:155], v2, s[40:43], s66 offen offset:0 sc1
  v_mfma_f32_16x16x32_bf16 a[140:143], v[112:115], a[156:159], a[140:143]
  buffer_load_dwordx4 a[156:159], v2, s[40:43], s67 offen offset:0 sc1
  s_waitcnt vmcnt(18)
  v_mfma_f32_16x16x32_bf16 a[64:67], v[116:119], a[160:163], a[64:67]
  v_mov_b32 v29, 8
  v_mfma_f32_16x16x32_bf16 a[68:71], v[116:119], a[164:167], a[68:71]
  v_mfma_f32_16x16x32_bf16 a[72:75], v[116:119], a[168:171], a[72:75]
  v_cmp_gt_u32 vcc, 128, v0
  v_mfma_f32_16x16x32_bf16 a[76:79], v[116:119], a[172:175], a[76:79]
  buffer_load_dwordx4 a[204:207], v2, s[40:43], s13 offen offset:3072 sc1
  v_mfma_f32_16x16x32_bf16 a[80:83], v[120:123], a[160:163], a[80:83]
  s_add_u32 s13, s13, 4096
  v_mfma_f32_16x16x32_bf16 a[84:87], v[120:123], a[164:167], a[84:87]
  v_mov_b32 v16, 1073741824
  v_mfma_f32_16x16x32_bf16 a[88:91], v[120:123], a[168:171], a[88:91]
  v_mov_b32 v17, 0
  v_mfma_f32_16x16x32_bf16 a[92:95], v[120:123], a[172:175], a[92:95]
  buffer_load_dwordx4 a[208:211], v2, s[40:43], s13 offen offset:0 sc1
  v_mfma_f32_16x16x32_bf16 a[96:99], v[124:127], a[160:163], a[96:99]
  v_mfma_f32_16x16x32_bf16 a[100:103], v[124:127], a[164:167], a[100:103]
  v_cndmask_b32 v250, v16, v250, vcc
  v_mfma_f32_16x16x32_bf16 a[104:107], v[124:127], a[168:171], a[104:107]
  v_mfma_f32_16x16x32_bf16 a[108:111], v[124:127], a[172:175], a[108:111]
  v_mfma_f32_16x16x32_bf16 a[112:115], v[160:163], a[160:163], a[112:115]
  v_mfma_f32_16x16x32_bf16 a[116:119], v[160:163], a[164:167], a[116:119]
  v_cndmask_b32 v202, v16, v202, vcc
  v_mfma_f32_16x16x32_bf16 a[120:123], v[160:163], a[168:171], a[120:123]
  v_cndmask_b32 v253, v17, v253, vcc
  v_mfma_f32_16x16x32_bf16 a[124:127], v[160:163], a[172:175], a[124:127]
  v_mfma_f32_16x16x32_bf16 a[128:131], v[164:167], a[160:163], a[128:131]
  buffer_load_dwordx4 a[160:163], v2, s[40:43], s64 offen offset:1024 sc1
  v_mfma_f32_16x16x32_bf16 a[132:135], v[164:167], a[164:167], a[132:135]
  buffer_load_dwordx4 a[164:167], v2, s[40:43], s65 offen offset:1024 sc1
  v_mfma_f32_16x16x32_bf16 a[136:139], v[164:167], a[168:171], a[136:139]
  buffer_load_dwordx4 a[168:171], v2, s[40:43], s66 offen offset:1024 sc1
  v_mfma_f32_16x16x32_bf16 a[140:143], v[164:167], a[172:175], a[140:143]
  buffer_load_dwordx4 a[172:175], v2, s[40:43], s67 offen offset:1024 sc1
  s_waitcnt vmcnt(18)
  v_mfma_f32_16x16x32_bf16 a[64:67], v[168:171], a[176:179], a[64:67]
  v_readlane_b32 s68, v15, 0
  v_mfma_f32_16x16x32_bf16 a[68:71], v[168:171], a[180:183], a[68:71]
  v_mfma_f32_16x16x32_bf16 a[72:75], v[168:171], a[184:187], a[72:75]
  v_readlane_b32 s69, v15, 1
  v_mfma_f32_16x16x32_bf16 a[76:79], v[168:171], a[188:191], a[76:79]
  buffer_load_dwordx4 a[212:215], v2, s[40:43], s13 offen offset:1024 sc1
  v_mfma_f32_16x16x32_bf16 a[80:83], v[172:175], a[176:179], a[80:83]
  v_mfma_f32_16x16x32_bf16 a[84:87], v[172:175], a[180:183], a[84:87]
  v_readlane_b32 s70, v15, 2
  v_mfma_f32_16x16x32_bf16 a[88:91], v[172:175], a[184:187], a[88:91]
  v_readlane_b32 s71, v15, 3
  v_mfma_f32_16x16x32_bf16 a[92:95], v[172:175], a[188:191], a[92:95]
  buffer_load_dwordx4 a[216:219], v2, s[40:43], s13 offen offset:2048 sc1
  v_mfma_f32_16x16x32_bf16 a[96:99], v[192:195], a[176:179], a[96:99]
  v_mfma_f32_16x16x32_bf16 a[100:103], v[192:195], a[180:183], a[100:103]
  v_readlane_b32 s72, v15, 4
  v_mfma_f32_16x16x32_bf16 a[104:107], v[192:195], a[184:187], a[104:107]
  v_mfma_f32_16x16x32_bf16 a[108:111], v[192:195], a[188:191], a[108:111]
  buffer_load_dwordx4 a[220:223], v2, s[40:43], s13 offen offset:3072 sc1
  v_mfma_f32_16x16x32_bf16 a[112:115], v[196:199], a[176:179], a[112:115]
  s_add_u32 s13, s13, 4096
  v_mfma_f32_16x16x32_bf16 a[116:119], v[196:199], a[180:183], a[116:119]
  v_readlane_b32 s73, v15, 5
  v_mfma_f32_16x16x32_bf16 a[120:123], v[196:199], a[184:187], a[120:123]
  v_readlane_b32 s74, v15, 6
  v_mfma_f32_16x16x32_bf16 a[124:127], v[196:199], a[188:191], a[124:127]
  v_mfma_f32_16x16x32_bf16 a[128:131], v[208:211], a[176:179], a[128:131]
  buffer_load_dwordx4 a[176:179], v2, s[40:43], s64 offen offset:2048 sc1
  v_mfma_f32_16x16x32_bf16 a[132:135], v[208:211], a[180:183], a[132:135]
  buffer_load_dwordx4 a[180:183], v2, s[40:43], s65 offen offset:2048 sc1
  v_mfma_f32_16x16x32_bf16 a[136:139], v[208:211], a[184:187], a[136:139]
  buffer_load_dwordx4 a[184:187], v2, s[40:43], s66 offen offset:2048 sc1
  v_mfma_f32_16x16x32_bf16 a[140:143], v[208:211], a[188:191], a[140:143]
  buffer_load_dwordx4 a[188:191], v2, s[40:43], s67 offen offset:2048 sc1
  s_waitcnt vmcnt(19)
  v_mfma_f32_16x16x32_bf16 a[64:67], v[212:215], v[216:219], a[64:67]
  v_readlane_b32 s75, v15, 7
  v_mfma_f32_16x16x32_bf16 a[68:71], v[212:215], v[220:223], a[68:71]
  v_mfma_f32_16x16x32_bf16 a[72:75], v[212:215], v[224:227], a[72:75]
  v_cmp_eq_u32 s[52:53], s68, v24
  v_mfma_f32_16x16x32_bf16 a[76:79], v[212:215], v[228:231], a[76:79]
  buffer_load_dwordx4 a[224:227], v2, s[40:43], s13 offen offset:0 sc1
  v_mfma_f32_16x16x32_bf16 a[80:83], v[232:235], v[216:219], a[80:83]
  v_mfma_f32_16x16x32_bf16 a[84:87], v[232:235], v[220:223], a[84:87]
  v_cmp_eq_u32 s[54:55], s68, v25
  v_mfma_f32_16x16x32_bf16 a[88:91], v[232:235], v[224:227], a[88:91]
  v_cmp_eq_u32 s[56:57], s68, v26
  v_mfma_f32_16x16x32_bf16 a[92:95], v[232:235], v[228:231], a[92:95]
  buffer_load_dwordx4 a[228:231], v2, s[40:43], s13 offen offset:1024 sc1
  v_mfma_f32_16x16x32_bf16 a[96:99], v[236:239], v[216:219], a[96:99]
  v_mfma_f32_16x16x32_bf16 a[100:103], v[236:239], v[220:223], a[100:103]
  v_cndmask_b32 v27, v27, 0, s[52:53]
  v_mfma_f32_16x16x32_bf16 a[104:107], v[236:239], v[224:227], a[104:107]
  v_mfma_f32_16x16x32_bf16 a[108:111], v[236:239], v[228:231], a[108:111]
  v_mfma_f32_16x16x32_bf16 a[112:115], v[240:243], v[216:219], a[112:115]
  v_mfma_f32_16x16x32_bf16 a[116:119], v[240:243], v[220:223], a[116:119]
  v_cndmask_b32 v28, v28, 0, s[54:55]
  v_mfma_f32_16x16x32_bf16 a[120:123], v[240:243], v[224:227], a[120:123]
  v_cndmask_b32 v29, v29, 0, s[56:57]
  v_mfma_f32_16x16x32_bf16 a[124:127], v[240:243], v[228:231], a[124:127]
  v_mfma_f32_16x16x32_bf16 a[128:131], v[244:247], v[216:219], a[128:131]
  buffer_load_dwordx4 v[216:219], v2, s[40:43], s64 offen offset:3072 sc1
  v_mfma_f32_16x16x32_bf16 a[132:135], v[244:247], v[220:223], a[132:135]
  buffer_load_dwordx4 v[220:223], v2, s[40:43], s65 offen offset:3072 sc1
  v_mfma_f32_16x16x32_bf16 a[136:139], v[244:247], v[224:227], a[136:139]
  buffer_load_dwordx4 v[224:227], v2, s[40:43], s66 offen offset:3072 sc1
  v_mfma_f32_16x16x32_bf16 a[140:143], v[244:247], v[228:231], a[140:143]
  buffer_load_dwordx4 v[228:231], v2, s[40:43], s67 offen offset:3072 sc1
  s_waitcnt vmcnt(19)
  v_mfma_f32_16x16x32_bf16 a[64:67], v[64:67], a[144:147], a[64:67]
  s_add_u32 s64, s64, 4096
  v_cmp_eq_u32 s[52:53], s69, v24
  v_mfma_f32_16x16x32_bf16 a[68:71], v[64:67], a[148:151], a[68:71]
  s_add_u32 s65, s65, 4096
  v_mfma_f32_16x16x32_bf16 a[72:75], v[64:67], a[152:155], a[72:75]
  s_add_u32 s66, s66, 4096
  v_cmp_eq_u32 s[54:55], s69, v25
  v_mfma_f32_16x16x32_bf16 a[76:79], v[64:67], a[156:159], a[76:79]
  buffer_load_dwordx4 a[232:235], v2, s[40:43], s13 offen offset:2048 sc1
  v_mfma_f32_16x16x32_bf16 a[80:83], v[68:71], a[144:147], a[80:83]
  v_mfma_f32_16x16x32_bf16 a[84:87], v[68:71], a[148:151], a[84:87]
  v_cmp_eq_u32 s[56:57], s69, v26
  v_mfma_f32_16x16x32_bf16 a[88:91], v[68:71], a[152:155], a[88:91]
  s_add_u32 s67, s67, 4096
  v_cndmask_b32 v27, v27, 1, s[52:53]
  v_mfma_f32_16x16x32_bf16 a[92:95], v[68:71], a[156:159], a[92:95]
  buffer_load_dwordx4 a[236:239], v2, s[40:43], s13 offen offset:3072 sc1
  v_mfma_f32_16x16x32_bf16 a[96:99], v[72:75], a[144:147], a[96:99]
  s_add_u32 s13, s13, 4096
  v_mfma_f32_16x16x32_bf16 a[100:103], v[72:75], a[148:151], a[100:103]
  v_cndmask_b32 v28, v28, 1, s[54:55]
  v_mfma_f32_16x16x32_bf16 a[104:107], v[72:75], a[152:155], a[104:107]
  v_mfma_f32_16x16x32_bf16 a[108:111], v[72:75], a[156:159], a[108:111]
  v_mfma_f32_16x16x32_bf16 a[112:115], v[76:79], a[144:147], a[112:115]
  v_mfma_f32_16x16x32_bf16 a[116:119], v[76:79], a[148:151], a[116:119]
  v_cndmask_b32 v29, v29, 1, s[56:57]
  v_mfma_f32_16x16x32_bf16 a[120:123], v[76:79], a[152:155], a[120:123]
  v_cmp_eq_u32 s[52:53], s70, v24
  v_mfma_f32_16x16x32_bf16 a[124:127], v[76:79], a[156:159], a[124:127]
  v_mfma_f32_16x16x32_bf16 a[128:131], v[80:83], a[144:147], a[128:131]
  buffer_load_dwordx4 a[144:147], v2, s[40:43], s64 offen offset:0 sc1
  v_mfma_f32_16x16x32_bf16 a[132:135], v[80:83], a[148:151], a[132:135]
  buffer_load_dwordx4 a[148:151], v2, s[40:43], s65 offen offset:0 sc1
  v_mfma_f32_16x16x32_bf16 a[136:139], v[80:83], a[152:155], a[136:139]
  buffer_load_dwordx4 a[152:155], v2, s[40:43], s66 offen offset:0 sc1
  v_mfma_f32_16x16x32_bf16 a[140:143], v[80:83], a[156:159], a[140:143]
  buffer_load_dwordx4 a[156:159], v2, s[40:43], s67 offen offset:0 sc1
  s_waitcnt vmcnt(19)
  v_mfma_f32_16x16x32_bf16 a[64:67], v[84:87], a[160:163], a[64:67]
  v_cmp_eq_u32 s[54:55], s70, v25
  v_mfma_f32_16x16x32_bf16 a[68:71], v[84:87], a[164:167], a[68:71]
  v_mfma_f32_16x16x32_bf16 a[72:75], v[84:87], a[168:171], a[72:75]
  v_cmp_eq_u32 s[56:57], s70, v26
  v_mfma_f32_16x16x32_bf16 a[76:79], v[84:87], a[172:175], a[76:79]
  buffer_load_dwordx4 a[240:243], v2, s[40:43], s13 offen offset:0 sc1
  v_mfma_f32_16x16x32_bf16 a[80:83], v[88:91], a[160:163], a[80:83]
  v_mfma_f32_16x16x32_bf16 a[84:87], v[88:91], a[164:167], a[84:87]
  v_cndmask_b32 v27, v27, 2, s[52:53]
  v_mfma_f32_16x16x32_bf16 a[88:91], v[88:91], a[168:171], a[88:91]
  v_cndmask_b32 v28, v28, 2, s[54:55]
  v_mfma_f32_16x16x32_bf16 a[92:95], v[88:91], a[172:175], a[92:95]
  buffer_load_dwordx4 a[244:247], v2, s[40:43], s13 offen offset:1024 sc1
  v_mfma_f32_16x16x32_bf16 a[96:99], v[92:95], a[160:163], a[96:99]
  v_mfma_f32_16x16x32_bf16 a[100:103], v[92:95], a[164:167], a[100:103]
  v_cndmask_b32 v29, v29, 2, s[56:57]
  v_mfma_f32_16x16x32_bf16 a[104:107], v[92:95], a[168:171], a[104:107]
  v_mfma_f32_16x16x32_bf16 a[108:111], v[92:95], a[172:175], a[108:111]
  v_mfma_f32_16x16x32_bf16 a[112:115], v[128:131], a[160:163], a[112:115]
  v_mfma_f32_16x16x32_bf16 a[116:119], v[128:131], a[164:167], a[116:119]
  v_cmp_eq_u32 s[52:53], s71, v24
  v_mfma_f32_16x16x32_bf16 a[120:123], v[128:131], a[168:171], a[120:123]
  v_cmp_eq_u32 s[54:55], s71, v25
  v_mfma_f32_16x16x32_bf16 a[124:127], v[128:131], a[172:175], a[124:127]
  v_mfma_f32_16x16x32_bf16 a[128:131], v[132:135], a[160:163], a[128:131]
  buffer_load_dwordx4 a[160:163], v2, s[40:43], s64 offen offset:1024 sc1
  v_mfma_f32_16x16x32_bf16 a[132:135], v[132:135], a[164:167], a[132:135]
  buffer_load_dwordx4 a[164:167], v2, s[40:43], s65 offen offset:1024 sc1
  v_mfma_f32_16x16x32_bf16 a[136:139], v[132:135], a[168:171], a[136:139]
  buffer_load_dwordx4 a[168:171], v2, s[40:43], s66 offen offset:1024 sc1
  v_mfma_f32_16x16x32_bf16 a[140:143], v[132:135], a[172:175], a[140:143]
  buffer_load_dwordx4 a[172:175], v2, s[40:43], s67 offen offset:1024 sc1
  s_waitcnt vmcnt(18)
  v_mfma_f32_16x16x32_bf16 a[64:67], v[136:139], a[176:179], a[64:67]
  v_cmp_eq_u32 s[56:57], s71, v26
  v_mfma_f32_16x16x32_bf16 a[68:71], v[136:139], a[180:183], a[68:71]
  v_mfma_f32_16x16x32_bf16 a[72:75], v[136:139], a[184:187], a[72:75]
  v_cndmask_b32 v27, v27, 3, s[52:53]
  v_mfma_f32_16x16x32_bf16 a[76:79], v[136:139], a[188:191], a[76:79]
  buffer_load_dwordx4 a[248:251], v2, s[40:43], s13 offen offset:2048 sc1
  v_mfma_f32_16x16x32_bf16 a[80:83], v[140:143], a[176:179], a[80:83]
  v_mfma_f32_16x16x32_bf16 a[84:87], v[140:143], a[180:183], a[84:87]
  v_cndmask_b32 v28, v28, 3, s[54:55]
  v_mfma_f32_16x16x32_bf16 a[88:91], v[140:143], a[184:187], a[88:91]
  v_cndmask_b32 v29, v29, 3, s[56:57]
  v_mfma_f32_16x16x32_bf16 a[92:95], v[140:143], a[188:191], a[92:95]
  buffer_load_dwordx4 a[252:255], v2, s[40:43], s13 offen offset:3072 sc1
  v_mfma_f32_16x16x32_bf16 a[96:99], v[144:147], a[176:179], a[96:99]
  s_add_u32 s13, s13, 4096
  v_mfma_f32_16x16x32_bf16 a[100:103], v[144:147], a[180:183], a[100:103]
  v_cmp_eq_u32 s[52:53], s72, v24
  v_mfma_f32_16x16x32_bf16 a[104:107], v[144:147], a[184:187], a[104:107]
  v_mfma_f32_16x16x32_bf16 a[108:111], v[144:147], a[188:191], a[108:111]
  v_mfma_f32_16x16x32_bf16 a[112:115], v[148:151], a[176:179], a[112:115]
  v_mfma_f32_16x16x32_bf16 a[116:119], v[148:151], a[180:183], a[116:119]
  v_cmp_eq_u32 s[54:55], s72, v25
  v_mfma_f32_16x16x32_bf16 a[120:123], v[148:151], a[184:187], a[120:123]
  v_cmp_eq_u32 s[56:57], s72, v26
  v_mfma_f32_16x16x32_bf16 a[124:127], v[148:151], a[188:191], a[124:127]
  v_mfma_f32_16x16x32_bf16 a[128:131], v[152:155], a[176:179], a[128:131]
  buffer_load_dwordx4 a[176:179], v2, s[40:43], s64 offen offset:2048 sc1
  v_mfma_f32_16x16x32_bf16 a[132:135], v[152:155], a[180:183], a[132:135]
  buffer_load_dwordx4 a[180:183], v2, s[40:43], s65 offen offset:2048 sc1
  v_mfma_f32_16x16x32_bf16 a[136:139], v[152:155], a[184:187], a[136:139]
  buffer_load_dwordx4 a[184:187], v2, s[40:43], s66 offen offset:2048 sc1
  v_mfma_f32_16x16x32_bf16 a[140:143], v[152:155], a[188:191], a[140:143]
  buffer_load_dwordx4 a[188:191], v2, s[40:43], s67 offen offset:2048 sc1
  s_waitcnt vmcnt(18)
  v_mfma_f32_16x16x32_bf16 a[64:67], v[156:159], v[216:219], a[64:67]
  v_cndmask_b32 v27, v27, 4, s[52:53]
  v_mfma_f32_16x16x32_bf16 a[68:71], v[156:159], v[220:223], a[68:71]
  v_mfma_f32_16x16x32_bf16 a[72:75], v[156:159], v[224:227], a[72:75]
  v_cndmask_b32 v28, v28, 4, s[54:55]
  v_mfma_f32_16x16x32_bf16 a[76:79], v[156:159], v[228:231], a[76:79]
  buffer_load_dwordx4 v[32:35], v2, s[40:43], s13 offen offset:0 sc1
  v_mfma_f32_16x16x32_bf16 a[80:83], v[176:179], v[216:219], a[80:83]
  v_mfma_f32_16x16x32_bf16 a[84:87], v[176:179], v[220:223], a[84:87]
  v_cndmask_b32 v29, v29, 4, s[56:57]
  v_mfma_f32_16x16x32_bf16 a[88:91], v[176:179], v[224:227], a[88:91]
  v_cmp_eq_u32 s[52:53], s73, v24
  v_mfma_f32_16x16x32_bf16 a[92:95], v[176:179], v[228:231], a[92:95]
  buffer_load_dwordx4 v[36:39], v2, s[40:43], s13 offen offset:1024 sc1
  v_mfma_f32_16x16x32_bf16 a[96:99], v[180:183], v[216:219], a[96:99]
  v_mfma_f32_16x16x32_bf16 a[100:103], v[180:183], v[220:223], a[100:103]
  v_cmp_eq_u32 s[54:55], s73, v25
  v_mfma_f32_16x16x32_bf16 a[104:107], v[180:183], v[224:227], a[104:107]
  v_mfma_f32_16x16x32_bf16 a[108:111], v[180:183], v[228:231], a[108:111]
  v_mfma_f32_16x16x32_bf16 a[112:115], v[184:187], v[216:219], a[112:115]
  v_mfma_f32_16x16x32_bf16 a[116:119], v[184:187], v[220:223], a[116:119]
  v_cmp_eq_u32 s[56:57], s73, v26
  v_mfma_f32_16x16x32_bf16 a[120:123], v[184:187], v[224:227], a[120:123]
  v_cndmask_b32 v27, v27, 5, s[52:53]
  v_mfma_f32_16x16x32_bf16 a[124:127], v[184:187], v[228:231], a[124:127]
  v_mfma_f32_16x16x32_bf16 a[128:131], v[188:191], v[216:219], a[128:131]
  buffer_load_dwordx4 v[216:219], v2, s[40:43], s64 offen offset:3072 sc1
  v_mfma_f32_16x16x32_bf16 a[132:135], v[188:191], v[220:223], a[132:135]
  buffer_load_dwordx4 v[220:223], v2, s[40:43], s65 offen offset:3072 sc1
  v_mfma_f32_16x16x32_bf16 a[136:139], v[188:191], v[224:227], a[136:139]
  buffer_load_dwordx4 v[224:227], v2, s[40:43], s66 offen offset:3072 sc1
  v_mfma_f32_16x16x32_bf16 a[140:143], v[188:191], v[228:231], a[140:143]
  buffer_load_dwordx4 v[228:231], v2, s[40:43], s67 offen offset:3072 sc1
  s_waitcnt vmcnt(18)
  v_mfma_f32_16x16x32_bf16 a[64:67], a[0:3], a[144:147], a[64:67]
  s_add_u32 s64, s64, 4096
  v_cndmask_b32 v28, v28, 5, s[54:55]
  v_mfma_f32_16x16x32_bf16 a[68:71], a[0:3], a[148:151], a[68:71]
  s_add_u32 s65, s65, 4096
  v_mfma_f32_16x16x32_bf16 a[72:75], a[0:3], a[152:155], a[72:75]
  s_add_u32 s66, s66, 4096
  v_cndmask_b32 v29, v29, 5, s[56:57]
  v_mfma_f32_16x16x32_bf16 a[76:79], a[0:3], a[156:159], a[76:79]
  buffer_load_dwordx4 v[40:43], v2, s[40:43], s13 offen offset:2048 sc1
  v_mfma_f32_16x16x32_bf16 a[80:83], a[4:7], a[144:147], a[80:83]
  v_mfma_f32_16x16x32_bf16 a[84:87], a[4:7], a[148:151], a[84:87]
  v_cmp_eq_u32 s[52:53], s74, v24
  v_mfma_f32_16x16x32_bf16 a[88:91], a[4:7], a[152:155], a[88:91]
  s_add_u32 s67, s67, 4096
  v_cmp_eq_u32 s[54:55], s74, v25
  v_mfma_f32_16x16x32_bf16 a[92:95], a[4:7], a[156:159], a[92:95]
  buffer_load_dwordx4 v[44:47], v2, s[40:43], s13 offen offset:3072 sc1
  v_mfma_f32_16x16x32_bf16 a[96:99], a[8:11], a[144:147], a[96:99]
  s_add_u32 s13, s13, 4096
  v_mfma_f32_16x16x32_bf16 a[100:103], a[8:11], a[148:151], a[100:103]
  v_cmp_eq_u32 s[56:57], s74, v26
  v_mfma_f32_16x16x32_bf16 a[104:107], a[8:11], a[152:155], a[104:107]
  v_mfma_f32_16x16x32_bf16 a[108:111], a[8:11], a[156:159], a[108:111]
  v_mfma_f32_16x16x32_bf16 a[112:115], a[12:15], a[144:147], a[112:115]
  v_mfma_f32_16x16x32_bf16 a[116:119], a[12:15], a[148:151], a[116:119]
  v_cndmask_b32 v27, v27, 6, s[52:53]
  v_mfma_f32_16x16x32_bf16 a[120:123], a[12:15], a[152:155], a[120:123]
  v_cndmask_b32 v28, v28, 6, s[54:55]
  v_mfma_f32_16x16x32_bf16 a[124:127], a[12:15], a[156:159], a[124:127]
  v_mfma_f32_16x16x32_bf16 a[128:131], a[16:19], a[144:147], a[128:131]
  buffer_load_dwordx4 a[144:147], v2, s[40:43], s64 offen offset:0 sc1
  v_mfma_f32_16x16x32_bf16 a[132:135], a[16:19], a[148:151], a[132:135]
  buffer_load_dwordx4 a[148:151], v2, s[40:43], s65 offen offset:0 sc1
  v_mfma_f32_16x16x32_bf16 a[136:139], a[16:19], a[152:155], a[136:139]
  buffer_load_dwordx4 a[152:155], v2, s[40:43], s66 offen offset:0 sc1
  v_mfma_f32_16x16x32_bf16 a[140:143], a[16:19], a[156:159], a[140:143]
  buffer_load_dwordx4 a[156:159], v2, s[40:43], s67 offen offset:0 sc1
  s_waitcnt vmcnt(18)
  v_mfma_f32_16x16x32_bf16 a[64:67], a[20:23], a[160:163], a[64:67]
  v_cndmask_b32 v29, v29, 6, s[56:57]
  v_mfma_f32_16x16x32_bf16 a[68:71], a[20:23], a[164:167], a[68:71]
  v_mfma_f32_16x16x32_bf16 a[72:75], a[20:23], a[168:171], a[72:75]
  v_cmp_eq_u32 s[52:53], s75, v24
  v_mfma_f32_16x16x32_bf16 a[76:79], a[20:23], a[172:175], a[76:79]
  buffer_load_dwordx4 v[48:51], v2, s[40:43], s13 offen offset:0 sc1
  v_mfma_f32_16x16x32_bf16 a[80:83], a[24:27], a[160:163], a[80:83]
  v_mfma_f32_16x16x32_bf16 a[84:87], a[24:27], a[164:167], a[84:87]
  v_cmp_eq_u32 s[54:55], s75, v25
  v_mfma_f32_16x16x32_bf16 a[88:91], a[24:27], a[168:171], a[88:91]
  v_cmp_eq_u32 s[56:57], s75, v26
  v_mfma_f32_16x16x32_bf16 a[92:95], a[24:27], a[172:175], a[92:95]
  buffer_load_dwordx4 v[52:55], v2, s[40:43], s13 offen offset:1024 sc1
  v_mfma_f32_16x16x32_bf16 a[96:99], a[28:31], a[160:163], a[96:99]
  v_mfma_f32_16x16x32_bf16 a[100:103], a[28:31], a[164:167], a[100:103]
  v_cndmask_b32 v27, v27, 7, s[52:53]
  v_mfma_f32_16x16x32_bf16 a[104:107], a[28:31], a[168:171], a[104:107]
  v_mfma_f32_16x16x32_bf16 a[108:111], a[28:31], a[172:175], a[108:111]
  v_mfma_f32_16x16x32_bf16 a[112:115], a[32:35], a[160:163], a[112:115]
  v_mfma_f32_16x16x32_bf16 a[116:119], a[32:35], a[164:167], a[116:119]
  v_cndmask_b32 v28, v28, 7, s[54:55]
  v_mfma_f32_16x16x32_bf16 a[120:123], a[32:35], a[168:171], a[120:123]
  v_cndmask_b32 v29, v29, 7, s[56:57]
  v_mfma_f32_16x16x32_bf16 a[124:127], a[32:35], a[172:175], a[124:127]
  v_mfma_f32_16x16x32_bf16 a[128:131], a[36:39], a[160:163], a[128:131]
  buffer_load_dwordx4 a[160:163], v2, s[40:43], s64 offen offset:1024 sc1
  v_mfma_f32_16x16x32_bf16 a[132:135], a[36:39], a[164:167], a[132:135]
  buffer_load_dwordx4 a[164:167], v2, s[40:43], s65 offen offset:1024 sc1
  v_mfma_f32_16x16x32_bf16 a[136:139], a[36:39], a[168:171], a[136:139]
  buffer_load_dwordx4 a[168:171], v2, s[40:43], s66 offen offset:1024 sc1
  v_mfma_f32_16x16x32_bf16 a[140:143], a[36:39], a[172:175], a[140:143]
  buffer_load_dwordx4 a[172:175], v2, s[40:43], s67 offen offset:1024 sc1
  s_waitcnt vmcnt(18)
  v_mfma_f32_16x16x32_bf16 a[64:67], a[40:43], a[176:179], a[64:67]
  v_mul_u32_u24 v27, 320, v27
  v_mfma_f32_16x16x32_bf16 a[68:71], a[40:43], a[180:183], a[68:71]
  v_mfma_f32_16x16x32_bf16 a[72:75], a[40:43], a[184:187], a[72:75]
  v_add_u32 v203, v203, v27
  v_mfma_f32_16x16x32_bf16 a[76:79], a[40:43], a[188:191], a[76:79]
  buffer_load_dwordx4 v[56:59], v2, s[40:43], s13 offen offset:2048 sc1
  v_mfma_f32_16x16x32_bf16 a[80:83], a[44:47], a[176:179], a[80:83]
  v_mfma_f32_16x16x32_bf16 a[84:87], a[44:47], a[180:183], a[84:87]
  v_add_u32 v203, 155648, v203
  v_mfma_f32_16x16x32_bf16 a[88:91], a[44:47], a[184:187], a[88:91]
  v_mul_u32_u24 v28, 320, v28
  v_mfma_f32_16x16x32_bf16 a[92:95], a[44:47], a[188:191], a[92:95]
  buffer_load_dwordx4 v[60:63], v2, s[40:43], s13 offen offset:3072 sc1
  v_mfma_f32_16x16x32_bf16 a[96:99], a[48:51], a[176:179], a[96:99]
  s_add_u32 s13, s13, 4096
  v_mfma_f32_16x16x32_bf16 a[100:103], a[48:51], a[180:183], a[100:103]
  v_add_u32 v204, v204, v28
  v_mfma_f32_16x16x32_bf16 a[104:107], a[48:51], a[184:187], a[104:107]
  v_mfma_f32_16x16x32_bf16 a[108:111], a[48:51], a[188:191], a[108:111]
  v_mfma_f32_16x16x32_bf16 a[112:115], a[52:55], a[176:179], a[112:115]
  v_mfma_f32_16x16x32_bf16 a[116:119], a[52:55], a[180:183], a[116:119]
  v_add_u32 v204, 155648, v204
  v_mfma_f32_16x16x32_bf16 a[120:123], a[52:55], a[184:187], a[120:123]
  v_mul_u32_u24 v29, 320, v29
  v_mfma_f32_16x16x32_bf16 a[124:127], a[52:55], a[188:191], a[124:127]
  v_mfma_f32_16x16x32_bf16 a[128:131], a[56:59], a[176:179], a[128:131]
  buffer_load_dwordx4 a[176:179], v2, s[40:43], s64 offen offset:2048 sc1
  v_mfma_f32_16x16x32_bf16 a[132:135], a[56:59], a[180:183], a[132:135]
  buffer_load_dwordx4 a[180:183], v2, s[40:43], s65 offen offset:2048 sc1
  v_mfma_f32_16x16x32_bf16 a[136:139], a[56:59], a[184:187], a[136:139]
  buffer_load_dwordx4 a[184:187], v2, s[40:43], s66 offen offset:2048 sc1
  v_mfma_f32_16x16x32_bf16 a[140:143], a[56:59], a[188:191], a[140:143]
  buffer_load_dwordx4 a[188:191], v2, s[40:43], s67 offen offset:2048 sc1
  s_waitcnt vmcnt(18)
  v_mfma_f32_16x16x32_bf16 a[64:67], a[60:63], v[216:219], a[64:67]
  v_add_u32 v205, v205, v29
  v_mfma_f32_16x16x32_bf16 a[68:71], a[60:63], v[220:223], a[68:71]
  v_mfma_f32_16x16x32_bf16 a[72:75], a[60:63], v[224:227], a[72:75]
  v_add_u32 v205, 155648, v205
  v_mfma_f32_16x16x32_bf16 a[76:79], a[60:63], v[228:231], a[76:79]
  buffer_load_dwordx4 v[96:99], v2, s[40:43], s13 offen offset:0 sc1
  v_mfma_f32_16x16x32_bf16 a[80:83], a[192:195], v[216:219], a[80:83]
  v_mfma_f32_16x16x32_bf16 a[84:87], a[192:195], v[220:223], a[84:87]
  v_mfma_f32_16x16x32_bf16 a[88:91], a[192:195], v[224:227], a[88:91]
  v_mfma_f32_16x16x32_bf16 a[92:95], a[192:195], v[228:231], a[92:95]
  buffer_load_dwordx4 v[100:103], v2, s[40:43], s13 offen offset:1024 sc1
  v_mfma_f32_16x16x32_bf16 a[96:99], a[196:199], v[216:219], a[96:99]
  v_mfma_f32_16x16x32_bf16 a[100:103], a[196:199], v[220:223], a[100:103]
  v_mfma_f32_16x16x32_bf16 a[104:107], a[196:199], v[224:227], a[104:107]
  v_mfma_f32_16x16x32_bf16 a[108:111], a[196:199], v[228:231], a[108:111]
  v_mfma_f32_16x16x32_bf16 a[112:115], a[200:203], v[216:219], a[112:115]
  v_mfma_f32_16x16x32_bf16 a[116:119], a[200:203], v[220:223], a[116:119]
  v_mfma_f32_16x16x32_bf16 a[120:123], a[200:203], v[224:227], a[120:123]
  v_mfma_f32_16x16x32_bf16 a[124:127], a[200:203], v[228:231], a[124:127]
  v_mfma_f32_16x16x32_bf16 a[128:131], a[204:207], v[216:219], a[128:131]
  buffer_load_dwordx4 v[216:219], v2, s[40:43], s64 offen offset:3072 sc1
  v_mfma_f32_16x16x32_bf16 a[132:135], a[204:207], v[220:223], a[132:135]
  buffer_load_dwordx4 v[220:223], v2, s[40:43], s65 offen offset:3072 sc1
  v_mfma_f32_16x16x32_bf16 a[136:139], a[204:207], v[224:227], a[136:139]
  buffer_load_dwordx4 v[224:227], v2, s[40:43], s66 offen offset:3072 sc1
  v_mfma_f32_16x16x32_bf16 a[140:143], a[204:207], v[228:231], a[140:143]
  buffer_load_dwordx4 v[228:231], v2, s[40:43], s67 offen offset:3072 sc1
  s_waitcnt vmcnt(18)
  v_mfma_f32_16x16x32_bf16 a[64:67], a[208:211], a[144:147], a[64:67]
  s_add_u32 s64, s64, 4096
  v_mfma_f32_16x16x32_bf16 a[68:71], a[208:211], a[148:151], a[68:71]
  s_add_u32 s65, s65, 4096
  v_mfma_f32_16x16x32_bf16 a[72:75], a[208:211], a[152:155], a[72:75]
  s_add_u32 s66, s66, 4096
  v_mfma_f32_16x16x32_bf16 a[76:79], a[208:211], a[156:159], a[76:79]
  buffer_load_dwordx4 v[104:107], v2, s[40:43], s13 offen offset:2048 sc1
  v_mfma_f32_16x16x32_bf16 a[80:83], a[212:215], a[144:147], a[80:83]
  v_mfma_f32_16x16x32_bf16 a[84:87], a[212:215], a[148:151], a[84:87]
  v_mfma_f32_16x16x32_bf16 a[88:91], a[212:215], a[152:155], a[88:91]
  s_add_u32 s67, s67, 4096
  v_mfma_f32_16x16x32_bf16 a[92:95], a[212:215], a[156:159], a[92:95]
  buffer_load_dwordx4 v[108:111], v2, s[40:43], s13 offen offset:3072 sc1
  v_mfma_f32_16x16x32_bf16 a[96:99], a[216:219], a[144:147], a[96:99]
  s_add_u32 s13, s13, 4096
  v_mfma_f32_16x16x32_bf16 a[100:103], a[216:219], a[148:151], a[100:103]
  v_mfma_f32_16x16x32_bf16 a[104:107], a[216:219], a[152:155], a[104:107]
  v_mfma_f32_16x16x32_bf16 a[108:111], a[216:219], a[156:159], a[108:111]
  v_mfma_f32_16x16x32_bf16 a[112:115], a[220:223], a[144:147], a[112:115]
  v_mfma_f32_16x16x32_bf16 a[116:119], a[220:223], a[148:151], a[116:119]
  v_mfma_f32_16x16x32_bf16 a[120:123], a[220:223], a[152:155], a[120:123]
  v_mfma_f32_16x16x32_bf16 a[124:127], a[220:223], a[156:159], a[124:127]
  v_mfma_f32_16x16x32_bf16 a[128:131], a[224:227], a[144:147], a[128:131]
  buffer_load_dwordx4 a[144:147], v2, s[40:43], s64 offen offset:0 sc1
  v_mfma_f32_16x16x32_bf16 a[132:135], a[224:227], a[148:151], a[132:135]
  buffer_load_dwordx4 a[148:151], v2, s[40:43], s65 offen offset:0 sc1
  v_mfma_f32_16x16x32_bf16 a[136:139], a[224:227], a[152:155], a[136:139]
  buffer_load_dwordx4 a[152:155], v2, s[40:43], s66 offen offset:0 sc1
  v_mfma_f32_16x16x32_bf16 a[140:143], a[224:227], a[156:159], a[140:143]
  buffer_load_dwordx4 a[156:159], v2, s[40:43], s67 offen offset:0 sc1
  s_waitcnt vmcnt(18)
  v_mfma_f32_16x16x32_bf16 a[64:67], a[228:231], a[160:163], a[64:67]
  v_mfma_f32_16x16x32_bf16 a[68:71], a[228:231], a[164:167], a[68:71]
  v_mfma_f32_16x16x32_bf16 a[72:75], a[228:231], a[168:171], a[72:75]
  v_mfma_f32_16x16x32_bf16 a[76:79], a[228:231], a[172:175], a[76:79]
  v_mfma_f32_16x16x32_bf16 a[80:83], a[232:235], a[160:163], a[80:83]
  v_mfma_f32_16x16x32_bf16 a[84:87], a[232:235], a[164:167], a[84:87]
  v_mfma_f32_16x16x32_bf16 a[88:91], a[232:235], a[168:171], a[88:91]
  v_mfma_f32_16x16x32_bf16 a[92:95], a[232:235], a[172:175], a[92:95]
  v_mfma_f32_16x16x32_bf16 a[96:99], a[236:239], a[160:163], a[96:99]
  v_mfma_f32_16x16x32_bf16 a[100:103], a[236:239], a[164:167], a[100:103]
  v_mfma_f32_16x16x32_bf16 a[104:107], a[236:239], a[168:171], a[104:107]
  v_mfma_f32_16x16x32_bf16 a[108:111], a[236:239], a[172:175], a[108:111]
  v_mfma_f32_16x16x32_bf16 a[112:115], a[240:243], a[160:163], a[112:115]
  v_mfma_f32_16x16x32_bf16 a[116:119], a[240:243], a[164:167], a[116:119]
  v_mfma_f32_16x16x32_bf16 a[120:123], a[240:243], a[168:171], a[120:123]
  v_mfma_f32_16x16x32_bf16 a[124:127], a[240:243], a[172:175], a[124:127]
  v_mfma_f32_16x16x32_bf16 a[128:131], a[244:247], a[160:163], a[128:131]
  buffer_load_dwordx4 a[160:163], v2, s[40:43], s64 offen offset:1024 sc1
  v_mfma_f32_16x16x32_bf16 a[132:135], a[244:247], a[164:167], a[132:135]
  buffer_load_dwordx4 a[164:167], v2, s[40:43], s65 offen offset:1024 sc1
  v_mfma_f32_16x16x32_bf16 a[136:139], a[244:247], a[168:171], a[136:139]
  buffer_load_dwordx4 a[168:171], v2, s[40:43], s66 offen offset:1024 sc1
  v_mfma_f32_16x16x32_bf16 a[140:143], a[244:247], a[172:175], a[140:143]
  buffer_load_dwordx4 a[172:175], v2, s[40:43], s67 offen offset:1024 sc1
  s_waitcnt vmcnt(16)
  v_mfma_f32_16x16x32_bf16 a[64:67], a[248:251], a[176:179], a[64:67]
  v_mfma_f32_16x16x32_bf16 a[68:71], a[248:251], a[180:183], a[68:71]
  v_mfma_f32_16x16x32_bf16 a[72:75], a[248:251], a[184:187], a[72:75]
  v_mfma_f32_16x16x32_bf16 a[76:79], a[248:251], a[188:191], a[76:79]
  v_mfma_f32_16x16x32_bf16 a[80:83], a[252:255], a[176:179], a[80:83]
  v_mfma_f32_16x16x32_bf16 a[84:87], a[252:255], a[180:183], a[84:87]
  v_mfma_f32_16x16x32_bf16 a[88:91], a[252:255], a[184:187], a[88:91]
  v_mfma_f32_16x16x32_bf16 a[92:95], a[252:255], a[188:191], a[92:95]
  v_mfma_f32_16x16x32_bf16 a[96:99], v[32:35], a[176:179], a[96:99]
  v_mfma_f32_16x16x32_bf16 a[100:103], v[32:35], a[180:183], a[100:103]
  v_mfma_f32_16x16x32_bf16 a[104:107], v[32:35], a[184:187], a[104:107]
  v_mfma_f32_16x16x32_bf16 a[108:111], v[32:35], a[188:191], a[108:111]
  v_mfma_f32_16x16x32_bf16 a[112:115], v[36:39], a[176:179], a[112:115]
  v_mfma_f32_16x16x32_bf16 a[116:119], v[36:39], a[180:183], a[116:119]
  v_mfma_f32_16x16x32_bf16 a[120:123], v[36:39], a[184:187], a[120:123]
  v_mfma_f32_16x16x32_bf16 a[124:127], v[36:39], a[188:191], a[124:127]
  v_mfma_f32_16x16x32_bf16 a[128:131], v[40:43], a[176:179], a[128:131]
  buffer_load_dwordx4 a[176:179], v2, s[40:43], s64 offen offset:2048 sc1
  v_mfma_f32_16x16x32_bf16 a[132:135], v[40:43], a[180:183], a[132:135]
  buffer_load_dwordx4 a[180:183], v2, s[40:43], s65 offen offset:2048 sc1
  v_mfma_f32_16x16x32_bf16 a[136:139], v[40:43], a[184:187], a[136:139]
  buffer_load_dwordx4 a[184:187], v2, s[40:43], s66 offen offset:2048 sc1
  v_mfma_f32_16x16x32_bf16 a[140:143], v[40:43], a[188:191], a[140:143]
  buffer_load_dwordx4 a[188:191], v2, s[40:43], s67 offen offset:2048 sc1
  s_waitcnt vmcnt(14)
  v_mfma_f32_16x16x32_bf16 a[64:67], v[44:47], v[216:219], a[64:67]
  ds_read_b128 v[112:115], v11 offset:0
  v_mfma_f32_16x16x32_bf16 a[68:71], v[44:47], v[220:223], a[68:71]
  v_mfma_f32_16x16x32_bf16 a[72:75], v[44:47], v[224:227], a[72:75]
  v_mfma_f32_16x16x32_bf16 a[76:79], v[44:47], v[228:231], a[76:79]
  v_mfma_f32_16x16x32_bf16 a[80:83], v[48:51], v[216:219], a[80:83]
  v_mfma_f32_16x16x32_bf16 a[84:87], v[48:51], v[220:223], a[84:87]
  v_mfma_f32_16x16x32_bf16 a[88:91], v[48:51], v[224:227], a[88:91]
  v_mfma_f32_16x16x32_bf16 a[92:95], v[48:51], v[228:231], a[92:95]
  v_mfma_f32_16x16x32_bf16 a[96:99], v[52:55], v[216:219], a[96:99]
  v_mfma_f32_16x16x32_bf16 a[100:103], v[52:55], v[220:223], a[100:103]
  v_mfma_f32_16x16x32_bf16 a[104:107], v[52:55], v[224:227], a[104:107]
  v_mfma_f32_16x16x32_bf16 a[108:111], v[52:55], v[228:231], a[108:111]
  v_mfma_f32_16x16x32_bf16 a[112:115], v[56:59], v[216:219], a[112:115]
  v_mfma_f32_16x16x32_bf16 a[116:119], v[56:59], v[220:223], a[116:119]
  v_mfma_f32_16x16x32_bf16 a[120:123], v[56:59], v[224:227], a[120:123]
  v_mfma_f32_16x16x32_bf16 a[124:127], v[56:59], v[228:231], a[124:127]
  v_mfma_f32_16x16x32_bf16 a[128:131], v[60:63], v[216:219], a[128:131]
  buffer_load_dwordx4 v[216:219], v2, s[40:43], s64 offen offset:3072 sc1
  v_mfma_f32_16x16x32_bf16 a[132:135], v[60:63], v[220:223], a[132:135]
  buffer_load_dwordx4 v[220:223], v2, s[40:43], s65 offen offset:3072 sc1
  v_mfma_f32_16x16x32_bf16 a[136:139], v[60:63], v[224:227], a[136:139]
  buffer_load_dwordx4 v[224:227], v2, s[40:43], s66 offen offset:3072 sc1
  v_mfma_f32_16x16x32_bf16 a[140:143], v[60:63], v[228:231], a[140:143]
  buffer_load_dwordx4 v[228:231], v2, s[40:43], s67 offen offset:3072 sc1
  s_waitcnt vmcnt(12) lgkmcnt(0)
  v_mfma_f32_16x16x32_bf16 a[64:67], v[96:99], a[144:147], a[64:67]
  s_add_u32 s64, s64, 4096
  ds_read_b128 v[116:119], v11 offset:1024
  v_mfma_f32_16x16x32_bf16 a[68:71], v[96:99], a[148:151], a[68:71]
  s_add_u32 s65, s65, 4096
  v_mfma_f32_16x16x32_bf16 a[72:75], v[96:99], a[152:155], a[72:75]
  s_add_u32 s66, s66, 4096
  ds_read_b128 v[120:123], v11 offset:2048
  v_mfma_f32_16x16x32_bf16 a[76:79], v[96:99], a[156:159], a[76:79]
  buffer_load_dwordx4 v[32:35], v248, s[44:47], 0 offen
  v_mfma_f32_16x16x32_bf16 a[80:83], v[100:103], a[144:147], a[80:83]
  ds_read_b128 v[124:127], v11 offset:3072
  v_mfma_f32_16x16x32_bf16 a[84:87], v[100:103], a[148:151], a[84:87]
  buffer_load_dwordx4 v[44:47], v200, s[40:43], s27 offen sc1
  v_mfma_f32_16x16x32_bf16 a[88:91], v[100:103], a[152:155], a[88:91]
  s_add_u32 s67, s67, 4096
  ds_read_b128 v[160:163], v11 offset:4096
  v_mfma_f32_16x16x32_bf16 a[92:95], v[100:103], a[156:159], a[92:95]
  buffer_load_dwordx4 v[36:39], v249, s[44:47], 0 offen
  v_mfma_f32_16x16x32_bf16 a[96:99], v[104:107], a[144:147], a[96:99]
  ds_read_b128 v[164:167], v11 offset:5120
  v_mfma_f32_16x16x32_bf16 a[100:103], v[104:107], a[148:151], a[100:103]
  buffer_load_dwordx4 v[48:51], v201, s[40:43], s27 offen sc1
  v_mfma_f32_16x16x32_bf16 a[104:107], v[104:107], a[152:155], a[104:107]
  v_mfma_f32_16x16x32_bf16 a[108:111], v[104:107], a[156:159], a[108:111]
  buffer_load_dwordx4 v[40:43], v250, s[44:47], 0 offen
  v_mfma_f32_16x16x32_bf16 a[112:115], v[108:111], a[144:147], a[112:115]
  v_mfma_f32_16x16x32_bf16 a[116:119], v[108:111], a[148:151], a[116:119]
  buffer_load_dwordx4 v[52:55], v202, s[40:43], s27 offen sc1
  v_mfma_f32_16x16x32_bf16 a[120:123], v[108:111], a[152:155], a[120:123]
  v_mfma_f32_16x16x32_bf16 a[124:127], v[108:111], a[156:159], a[124:127]
  v_mfma_f32_16x16x32_bf16 a[128:131], v[112:115], a[144:147], a[128:131]
  buffer_load_dwordx4 a[144:147], v2, s[40:43], s64 offen offset:0 sc1
  v_mfma_f32_16x16x32_bf16 a[132:135], v[112:115], a[148:151], a[132:135]
  buffer_load_dwordx4 a[148:151], v2, s[40:43], s65 offen offset:0 sc1
  v_mfma_f32_16x16x32_bf16 a[136:139], v[112:115], a[152:155], a[136:139]
  buffer_load_dwordx4 a[152:155], v2, s[40:43], s66 offen offset:0 sc1
  v_mfma_f32_16x16x32_bf16 a[140:143], v[112:115], a[156:159], a[140:143]
  buffer_load_dwordx4 a[156:159], v2, s[40:43], s67 offen offset:0 sc1
  s_waitcnt vmcnt(18) lgkmcnt(0)
  v_mfma_f32_16x16x32_bf16 a[64:67], v[116:119], a[160:163], a[64:67]
  ds_read_b128 v[168:171], v11 offset:6144
  v_mfma_f32_16x16x32_bf16 a[68:71], v[116:119], a[164:167], a[68:71]
  v_mfma_f32_16x16x32_bf16 a[72:75], v[116:119], a[168:171], a[72:75]
  ds_read_b128 v[172:175], v11 offset:7168
  v_mfma_f32_16x16x32_bf16 a[76:79], v[116:119], a[172:175], a[76:79]
  v_mfma_f32_16x16x32_bf16 a[80:83], v[120:123], a[160:163], a[80:83]
  ds_read_b128 v[192:195], v11 offset:8192
  v_mfma_f32_16x16x32_bf16 a[84:87], v[120:123], a[164:167], a[84:87]
  v_mfma_f32_16x16x32_bf16 a[88:91], v[120:123], a[168:171], a[88:91]
  ds_read_b128 v[196:199], v11 offset:9216
  v_mfma_f32_16x16x32_bf16 a[92:95], v[120:123], a[172:175], a[92:95]
  v_mfma_f32_16x16x32_bf16 a[96:99], v[124:127], a[160:163], a[96:99]
  ds_read_b128 v[208:211], v11 offset:10240
  v_mfma_f32_16x16x32_bf16 a[100:103], v[124:127], a[164:167], a[100:103]
  v_mfma_f32_16x16x32_bf16 a[104:107], v[124:127], a[168:171], a[104:107]
  v_mfma_f32_16x16x32_bf16 a[108:111], v[124:127], a[172:175], a[108:111]
  v_mfma_f32_16x16x32_bf16 a[112:115], v[160:163], a[160:163], a[112:115]
  v_mfma_f32_16x16x32_bf16 a[116:119], v[160:163], a[164:167], a[116:119]
  v_mfma_f32_16x16x32_bf16 a[120:123], v[160:163], a[168:171], a[120:123]
  v_mfma_f32_16x16x32_bf16 a[124:127], v[160:163], a[172:175], a[124:127]
  v_mfma_f32_16x16x32_bf16 a[128:131], v[164:167], a[160:163], a[128:131]
  buffer_load_dwordx4 a[160:163], v2, s[40:43], s64 offen offset:1024 sc1
  v_mfma_f32_16x16x32_bf16 a[132:135], v[164:167], a[164:167], a[132:135]
  buffer_load_dwordx4 a[164:167], v2, s[40:43], s65 offen offset:1024 sc1
  v_mfma_f32_16x16x32_bf16 a[136:139], v[164:167], a[168:171], a[136:139]
  buffer_load_dwordx4 a[168:171], v2, s[40:43], s66 offen offset:1024 sc1
  v_mfma_f32_16x16x32_bf16 a[140:143], v[164:167], a[172:175], a[140:143]
  buffer_load_dwordx4 a[172:175], v2, s[40:43], s67 offen offset:1024 sc1
  s_waitcnt vmcnt(18) lgkmcnt(0)
  v_mfma_f32_16x16x32_bf16 a[64:67], v[168:171], a[176:179], a[64:67]
  ds_read_b128 v[212:215], v11 offset:11264
  v_mfma_f32_16x16x32_bf16 a[68:71], v[168:171], a[180:183], a[68:71]
  v_mfma_f32_16x16x32_bf16 a[72:75], v[168:171], a[184:187], a[72:75]
  ds_read_b128 v[232:235], v11 offset:12288
  v_mfma_f32_16x16x32_bf16 a[76:79], v[168:171], a[188:191], a[76:79]
  v_mfma_f32_16x16x32_bf16 a[80:83], v[172:175], a[176:179], a[80:83]
  ds_read_b128 v[236:239], v11 offset:13312
  v_mfma_f32_16x16x32_bf16 a[84:87], v[172:175], a[180:183], a[84:87]
  v_mfma_f32_16x16x32_bf16 a[88:91], v[172:175], a[184:187], a[88:91]
  ds_read_b128 v[240:243], v11 offset:14336
  v_mfma_f32_16x16x32_bf16 a[92:95], v[172:175], a[188:191], a[92:95]
  v_mfma_f32_16x16x32_bf16 a[96:99], v[192:195], a[176:179], a[96:99]
  ds_read_b128 v[244:247], v11 offset:15360
  v_mfma_f32_16x16x32_bf16 a[100:103], v[192:195], a[180:183], a[100:103]
  v_mfma_f32_16x16x32_bf16 a[104:107], v[192:195], a[184:187], a[104:107]
  v_mfma_f32_16x16x32_bf16 a[108:111], v[192:195], a[188:191], a[108:111]
  v_mfma_f32_16x16x32_bf16 a[112:115], v[196:199], a[176:179], a[112:115]
  v_mfma_f32_16x16x32_bf16 a[116:119], v[196:199], a[180:183], a[116:119]
  v_mfma_f32_16x16x32_bf16 a[120:123], v[196:199], a[184:187], a[120:123]
  v_mfma_f32_16x16x32_bf16 a[124:127], v[196:199], a[188:191], a[124:127]
  v_mfma_f32_16x16x32_bf16 a[128:131], v[208:211], a[176:179], a[128:131]
  buffer_load_dwordx4 a[176:179], v2, s[40:43], s64 offen offset:2048 sc1
  v_mfma_f32_16x16x32_bf16 a[132:135], v[208:211], a[180:183], a[132:135]
  buffer_load_dwordx4 a[180:183], v2, s[40:43], s65 offen offset:2048 sc1
  v_mfma_f32_16x16x32_bf16 a[136:139], v[208:211], a[184:187], a[136:139]
  buffer_load_dwordx4 a[184:187], v2, s[40:43], s66 offen offset:2048 sc1
  v_mfma_f32_16x16x32_bf16 a[140:143], v[208:211], a[188:191], a[140:143]
  buffer_load_dwordx4 a[188:191], v2, s[40:43], s67 offen offset:2048 sc1
  s_waitcnt vmcnt(18) lgkmcnt(0)
  v_mfma_f32_16x16x32_bf16 a[64:67], v[212:215], v[216:219], a[64:67]
  ds_read_b128 v[64:67], v11 offset:16384
  v_mfma_f32_16x16x32_bf16 a[68:71], v[212:215], v[220:223], a[68:71]
  ds_read_b128 v[120:123], v203 offset:0
  v_mfma_f32_16x16x32_bf16 a[72:75], v[212:215], v[224:227], a[72:75]
  ds_read_b128 v[68:71], v11 offset:17408
  v_add_u32 v20, 77824, v251
  v_mfma_f32_16x16x32_bf16 a[76:79], v[212:215], v[228:231], a[76:79]
  ds_read_b128 v[124:127], v203 offset:16
  v_mfma_f32_16x16x32_bf16 a[80:83], v[232:235], v[216:219], a[80:83]
  ds_read_b128 v[72:75], v11 offset:18432
  v_mfma_f32_16x16x32_bf16 a[84:87], v[232:235], v[220:223], a[84:87]
  ds_read_b128 v[160:163], v204 offset:0
  v_mfma_f32_16x16x32_bf16 a[88:91], v[232:235], v[224:227], a[88:91]
  ds_read_b128 v[76:79], v11 offset:19456
  v_add_u32 v21, 77824, v252
  v_mfma_f32_16x16x32_bf16 a[92:95], v[232:235], v[228:231], a[92:95]
  ds_read_b128 v[164:167], v204 offset:16
  v_mfma_f32_16x16x32_bf16 a[96:99], v[236:239], v[216:219], a[96:99]
  ds_read_b128 v[80:83], v11 offset:20480
  v_mfma_f32_16x16x32_bf16 a[100:103], v[236:239], v[220:223], a[100:103]
  ds_read_b128 v[168:171], v205 offset:0
  v_mfma_f32_16x16x32_bf16 a[104:107], v[236:239], v[224:227], a[104:107]
  v_add_u32 v22, 77824, v253
  v_mfma_f32_16x16x32_bf16 a[108:111], v[236:239], v[228:231], a[108:111]
  ds_read_b128 v[172:175], v205 offset:16
  v_mfma_f32_16x16x32_bf16 a[112:115], v[240:243], v[216:219], a[112:115]
  v_mfma_f32_16x16x32_bf16 a[116:119], v[240:243], v[220:223], a[116:119]
  v_mfma_f32_16x16x32_bf16 a[120:123], v[240:243], v[224:227], a[120:123]
  s_mul_i32 s23, s20, 38912
  v_and_b32 v16, 15, v1
  v_mul_u32_u24 v16, 336, v16
  v_mfma_f32_16x16x32_bf16 a[124:127], v[240:243], v[228:231], a[124:127]
  v_lshrrev_b32 v17, 4, v1
  v_lshl_add_u32 v16, v17, 4, v16
  v_mfma_f32_16x16x32_bf16 a[128:131], v[244:247], v[216:219], a[128:131]
  buffer_load_dwordx4 v[216:219], v2, s[40:43], s64 offen offset:3072 sc1
  v_add_u32 v16, s23, v16
  v_mfma_f32_16x16x32_bf16 a[132:135], v[244:247], v[220:223], a[132:135]
  buffer_load_dwordx4 v[220:223], v2, s[40:43], s65 offen offset:3072 sc1
  v_mfma_f32_16x16x32_bf16 a[136:139], v[244:247], v[224:227], a[136:139]
  s_waitcnt lgkmcnt(0)
  buffer_load_dwordx4 v[224:227], v2, s[40:43], s66 offen offset:3072 sc1
  v_mfma_f32_16x16x32_bf16 a[140:143], v[244:247], v[228:231], a[140:143]
  buffer_load_dwordx4 v[228:231], v2, s[40:43], s67 offen offset:3072 sc1
  s_waitcnt vmcnt(12) lgkmcnt(0)
  v_mfma_f32_16x16x32_bf16 a[64:67], v[64:67], a[144:147], a[64:67]
  ds_read_b128 v[84:87], v11 offset:21504
  v_lshlrev_b32 v18, 16, v44
  v_and_b32 v19, 0xffff0000, v44
  v_mfma_f32_16x16x32_bf16 a[68:71], v[64:67], a[148:151], a[68:71]
  v_add_f32 v120, v120, v18
  v_add_f32 v121, v121, v19
  v_mfma_f32_16x16x32_bf16 a[72:75], v[64:67], a[152:155], a[72:75]
  ds_read_b128 v[88:91], v11 offset:22528
  v_cvt_pk_bf16_f32 v18, v120, v121
  v_lshlrev_b32 v96, 16, v32
  v_mfma_f32_16x16x32_bf16 a[76:79], v[64:67], a[156:159], a[76:79]
  v_and_b32 v97, 0xffff0000, v32
  v_lshlrev_b32 v120, 16, v18
  v_mfma_f32_16x16x32_bf16 a[80:83], v[68:71], a[144:147], a[80:83]
  ds_read_b128 v[92:95], v11 offset:23552
  v_and_b32 v121, 0xffff0000, v18
  v_lshlrev_b32 v18, 16, v45
  v_mfma_f32_16x16x32_bf16 a[84:87], v[68:71], a[148:151], a[84:87]
  v_and_b32 v19, 0xffff0000, v45
  v_add_f32 v122, v122, v18
  v_mfma_f32_16x16x32_bf16 a[88:91], v[68:71], a[152:155], a[88:91]
  ds_read_b128 v[128:131], v11 offset:24576
  v_add_f32 v123, v123, v19
  v_cvt_pk_bf16_f32 v18, v122, v123
  v_mfma_f32_16x16x32_bf16 a[92:95], v[68:71], a[156:159], a[92:95]
  v_lshlrev_b32 v98, 16, v33
  v_and_b32 v99, 0xffff0000, v33
  v_mfma_f32_16x16x32_bf16 a[96:99], v[72:75], a[144:147], a[96:99]
  ds_read_b128 v[132:135], v11 offset:25600
  v_lshlrev_b32 v122, 16, v18
  v_and_b32 v123, 0xffff0000, v18
  v_mfma_f32_16x16x32_bf16 a[100:103], v[72:75], a[148:151], a[100:103]
  v_lshlrev_b32 v18, 16, v46
  v_and_b32 v19, 0xffff0000, v46
  v_mfma_f32_16x16x32_bf16 a[104:107], v[72:75], a[152:155], a[104:107]
  v_add_f32 v124, v124, v18
  v_add_f32 v125, v125, v19
  v_mfma_f32_16x16x32_bf16 a[108:111], v[72:75], a[156:159], a[108:111]
  v_cvt_pk_bf16_f32 v18, v124, v125
  v_lshlrev_b32 v100, 16, v34
  v_mfma_f32_16x16x32_bf16 a[112:115], v[76:79], a[144:147], a[112:115]
  v_and_b32 v101, 0xffff0000, v34
  v_lshlrev_b32 v124, 16, v18
  v_mfma_f32_16x16x32_bf16 a[116:119], v[76:79], a[148:151], a[116:119]
  v_and_b32 v125, 0xffff0000, v18
  v_lshlrev_b32 v18, 16, v47
  v_mfma_f32_16x16x32_bf16 a[120:123], v[76:79], a[152:155], a[120:123]
  v_and_b32 v19, 0xffff0000, v47
  v_add_f32 v126, v126, v18
  v_mfma_f32_16x16x32_bf16 a[124:127], v[76:79], a[156:159], a[124:127]
  v_add_f32 v127, v127, v19
  v_cvt_pk_bf16_f32 v18, v126, v127
  v_mfma_f32_16x16x32_bf16 a[128:131], v[80:83], a[144:147], a[128:131]
  v_lshlrev_b32 v102, 16, v35
  v_and_b32 v103, 0xffff0000, v35
  v_mfma_f32_16x16x32_bf16 a[132:135], v[80:83], a[148:151], a[132:135]
  v_lshlrev_b32 v126, 16, v18
  v_and_b32 v127, 0xffff0000, v18
  v_mfma_f32_16x16x32_bf16 a[136:139], v[80:83], a[152:155], a[136:139]
  v_mfma_f32_16x16x32_bf16 a[140:143], v[80:83], a[156:159], a[140:143]
  s_waitcnt vmcnt(8) lgkmcnt(0)
  v_mfma_f32_16x16x32_bf16 a[64:67], v[84:87], a[160:163], a[64:67]
  ds_read_b128 v[136:139], v11 offset:26624
  v_lshlrev_b32 v18, 16, v48
  v_and_b32 v19, 0xffff0000, v48
  v_mfma_f32_16x16x32_bf16 a[68:71], v[84:87], a[164:167], a[68:71]
  v_add_f32 v160, v160, v18
  v_add_f32 v161, v161, v19
  v_mfma_f32_16x16x32_bf16 a[72:75], v[84:87], a[168:171], a[72:75]
  ds_read_b128 v[140:143], v11 offset:27648
  v_cvt_pk_bf16_f32 v18, v160, v161
  v_lshlrev_b32 v104, 16, v36
  v_mfma_f32_16x16x32_bf16 a[76:79], v[84:87], a[172:175], a[76:79]
  v_and_b32 v105, 0xffff0000, v36
  v_lshlrev_b32 v160, 16, v18
  v_mfma_f32_16x16x32_bf16 a[80:83], v[88:91], a[160:163], a[80:83]
  ds_read_b128 v[144:147], v11 offset:28672
  v_and_b32 v161, 0xffff0000, v18
  v_lshlrev_b32 v18, 16, v49
  v_mfma_f32_16x16x32_bf16 a[84:87], v[88:91], a[164:167], a[84:87]
  v_and_b32 v19, 0xffff0000, v49
  v_add_f32 v162, v162, v18
  v_mfma_f32_16x16x32_bf16 a[88:91], v[88:91], a[168:171], a[88:91]
  ds_read_b128 v[148:151], v11 offset:29696
  v_add_f32 v163, v163, v19
  v_cvt_pk_bf16_f32 v18, v162, v163
  v_mfma_f32_16x16x32_bf16 a[92:95], v[88:91], a[172:175], a[92:95]
  v_lshlrev_b32 v106, 16, v37
  v_and_b32 v107, 0xffff0000, v37
  v_mfma_f32_16x16x32_bf16 a[96:99], v[92:95], a[160:163], a[96:99]
  ds_read_b128 v[152:155], v11 offset:30720
  v_lshlrev_b32 v162, 16, v18
  v_and_b32 v163, 0xffff0000, v18
  v_mfma_f32_16x16x32_bf16 a[100:103], v[92:95], a[164:167], a[100:103]
  v_lshlrev_b32 v18, 16, v50
  v_and_b32 v19, 0xffff0000, v50
  v_mfma_f32_16x16x32_bf16 a[104:107], v[92:95], a[168:171], a[104:107]
  v_add_f32 v164, v164, v18
  v_add_f32 v165, v165, v19
  v_mfma_f32_16x16x32_bf16 a[108:111], v[92:95], a[172:175], a[108:111]
  v_cvt_pk_bf16_f32 v18, v164, v165
  v_lshlrev_b32 v108, 16, v38
  v_mfma_f32_16x16x32_bf16 a[112:115], v[128:131], a[160:163], a[112:115]
  v_and_b32 v109, 0xffff0000, v38
  v_lshlrev_b32 v164, 16, v18
  v_mfma_f32_16x16x32_bf16 a[116:119], v[128:131], a[164:167], a[116:119]
  v_and_b32 v165, 0xffff0000, v18
  v_lshlrev_b32 v18, 16, v51
  v_mfma_f32_16x16x32_bf16 a[120:123], v[128:131], a[168:171], a[120:123]
  v_and_b32 v19, 0xffff0000, v51
  v_add_f32 v166, v166, v18
  v_mfma_f32_16x16x32_bf16 a[124:127], v[128:131], a[172:175], a[124:127]
  v_add_f32 v167, v167, v19
  v_cvt_pk_bf16_f32 v18, v166, v167
  v_mfma_f32_16x16x32_bf16 a[128:131], v[132:135], a[160:163], a[128:131]
  v_lshlrev_b32 v110, 16, v39
  v_and_b32 v111, 0xffff0000, v39
  v_mfma_f32_16x16x32_bf16 a[132:135], v[132:135], a[164:167], a[132:135]
  v_lshlrev_b32 v166, 16, v18
  v_and_b32 v167, 0xffff0000, v18
  v_mfma_f32_16x16x32_bf16 a[136:139], v[132:135], a[168:171], a[136:139]
  v_mfma_f32_16x16x32_bf16 a[140:143], v[132:135], a[172:175], a[140:143]
  s_waitcnt vmcnt(4) lgkmcnt(0)
  v_mfma_f32_16x16x32_bf16 a[64:67], v[136:139], a[176:179], a[64:67]
  ds_read_b128 v[156:159], v11 offset:31744
  v_lshlrev_b32 v18, 16, v52
  v_and_b32 v19, 0xffff0000, v52
  v_mfma_f32_16x16x32_bf16 a[68:71], v[136:139], a[180:183], a[68:71]
  v_add_f32 v168, v168, v18
  v_add_f32 v169, v169, v19
  v_mfma_f32_16x16x32_bf16 a[72:75], v[136:139], a[184:187], a[72:75]
  ds_read_b128 v[176:179], v11 offset:32768
  v_cvt_pk_bf16_f32 v18, v168, v169
  v_lshlrev_b32 v112, 16, v40
  v_mfma_f32_16x16x32_bf16 a[76:79], v[136:139], a[188:191], a[76:79]
  v_and_b32 v113, 0xffff0000, v40
  v_lshlrev_b32 v168, 16, v18
  v_mfma_f32_16x16x32_bf16 a[80:83], v[140:143], a[176:179], a[80:83]
  ds_read_b128 v[180:183], v11 offset:33792
  v_and_b32 v169, 0xffff0000, v18
  v_lshlrev_b32 v18, 16, v53
  v_mfma_f32_16x16x32_bf16 a[84:87], v[140:143], a[180:183], a[84:87]
  v_and_b32 v19, 0xffff0000, v53
  v_add_f32 v170, v170, v18
  v_mfma_f32_16x16x32_bf16 a[88:91], v[140:143], a[184:187], a[88:91]
  ds_read_b128 v[184:187], v11 offset:34816
  v_add_f32 v171, v171, v19
  v_cvt_pk_bf16_f32 v18, v170, v171
  v_mfma_f32_16x16x32_bf16 a[92:95], v[140:143], a[188:191], a[92:95]
  v_lshlrev_b32 v114, 16, v41
  v_and_b32 v115, 0xffff0000, v41
  v_mfma_f32_16x16x32_bf16 a[96:99], v[144:147], a[176:179], a[96:99]
  ds_read_b128 v[188:191], v11 offset:35840
  v_lshlrev_b32 v170, 16, v18
  v_and_b32 v171, 0xffff0000, v18
  v_mfma_f32_16x16x32_bf16 a[100:103], v[144:147], a[180:183], a[100:103]
  v_lshlrev_b32 v18, 16, v54
  v_and_b32 v19, 0xffff0000, v54
  v_mfma_f32_16x16x32_bf16 a[104:107], v[144:147], a[184:187], a[104:107]
  v_add_f32 v172, v172, v18
  v_add_f32 v173, v173, v19
  v_mfma_f32_16x16x32_bf16 a[108:111], v[144:147], a[188:191], a[108:111]
  v_cvt_pk_bf16_f32 v18, v172, v173
  v_lshlrev_b32 v116, 16, v42
  v_mfma_f32_16x16x32_bf16 a[112:115], v[148:151], a[176:179], a[112:115]
  v_and_b32 v117, 0xffff0000, v42
  v_lshlrev_b32 v172, 16, v18
  v_mfma_f32_16x16x32_bf16 a[116:119], v[148:151], a[180:183], a[116:119]
  v_and_b32 v173, 0xffff0000, v18
  v_lshlrev_b32 v18, 16, v55
  v_mfma_f32_16x16x32_bf16 a[120:123], v[148:151], a[184:187], a[120:123]
  v_and_b32 v19, 0xffff0000, v55
  v_add_f32 v174, v174, v18
  v_mfma_f32_16x16x32_bf16 a[124:127], v[148:151], a[188:191], a[124:127]
  v_add_f32 v175, v175, v19
  v_cvt_pk_bf16_f32 v18, v174, v175
  v_mfma_f32_16x16x32_bf16 a[128:131], v[152:155], a[176:179], a[128:131]
  v_lshlrev_b32 v118, 16, v43
  v_and_b32 v119, 0xffff0000, v43
  v_mfma_f32_16x16x32_bf16 a[132:135], v[152:155], a[180:183], a[132:135]
  v_lshlrev_b32 v174, 16, v18
  v_and_b32 v175, 0xffff0000, v18
  v_mfma_f32_16x16x32_bf16 a[136:139], v[152:155], a[184:187], a[136:139]
  v_mfma_f32_16x16x32_bf16 a[140:143], v[152:155], a[188:191], a[140:143]
  s_waitcnt vmcnt(0) lgkmcnt(0)
  v_mfma_f32_16x16x32_bf16 a[64:67], v[156:159], v[216:219], a[64:67]
  v_mfma_f32_16x16x32_bf16 a[68:71], v[156:159], v[220:223], a[68:71]
  v_mfma_f32_16x16x32_bf16 a[72:75], v[156:159], v[224:227], a[72:75]
  v_mfma_f32_16x16x32_bf16 a[76:79], v[156:159], v[228:231], a[76:79]
  v_mfma_f32_16x16x32_bf16 a[80:83], v[176:179], v[216:219], a[80:83]
  v_mfma_f32_16x16x32_bf16 a[84:87], v[176:179], v[220:223], a[84:87]
  v_mfma_f32_16x16x32_bf16 a[88:91], v[176:179], v[224:227], a[88:91]
  v_mfma_f32_16x16x32_bf16 a[92:95], v[176:179], v[228:231], a[92:95]
  v_mfma_f32_16x16x32_bf16 a[96:99], v[180:183], v[216:219], a[96:99]
  v_mfma_f32_16x16x32_bf16 a[100:103], v[180:183], v[220:223], a[100:103]
  ds_write_b128 v16, a[64:67] offset:0
  v_mfma_f32_16x16x32_bf16 a[104:107], v[180:183], v[224:227], a[104:107]
  ds_write_b128 v16, a[68:71] offset:5376
  v_mfma_f32_16x16x32_bf16 a[108:111], v[180:183], v[228:231], a[108:111]
  ds_write_b128 v16, a[72:75] offset:10752
  v_mfma_f32_16x16x32_bf16 a[112:115], v[184:187], v[216:219], a[112:115]
  ds_write_b128 v16, a[76:79] offset:16128
  v_mfma_f32_16x16x32_bf16 a[116:119], v[184:187], v[220:223], a[116:119]
  ds_write_b128 v16, a[80:83] offset:64
  v_mfma_f32_16x16x32_bf16 a[120:123], v[184:187], v[224:227], a[120:123]
  ds_write_b128 v16, a[84:87] offset:5440
  v_mfma_f32_16x16x32_bf16 a[124:127], v[184:187], v[228:231], a[124:127]
  ds_write_b128 v16, a[88:91] offset:10816
  v_mfma_f32_16x16x32_bf16 a[128:131], v[188:191], v[216:219], a[128:131]
  ds_write_b128 v16, a[92:95] offset:16192
  v_mfma_f32_16x16x32_bf16 a[132:135], v[188:191], v[220:223], a[132:135]
  ds_write_b128 v16, a[96:99] offset:128
  v_mfma_f32_16x16x32_bf16 a[136:139], v[188:191], v[224:227], a[136:139]
  ds_write_b128 v16, a[100:103] offset:5504
  v_mfma_f32_16x16x32_bf16 a[140:143], v[188:191], v[228:231], a[140:143]
  ds_write_b128 v16, a[104:107] offset:10880
  ds_write_b128 v16, a[108:111] offset:16256
  ds_write_b128 v16, a[112:115] offset:192
  ds_write_b128 v16, a[116:119] offset:5568
  ds_write_b128 v16, a[120:123] offset:10944
  ds_write_b128 v16, a[124:127] offset:16320
  ds_write_b128 v16, a[128:131] offset:256
  ds_write_b128 v16, a[132:135] offset:5632
  ds_write_b128 v16, a[136:139] offset:11008
  ds_write_b128 v16, a[140:143] offset:16384
  s_waitcnt lgkmcnt(0)
  s_barrier
  ds_read_b128 v[32:35], v251 offset:0
  ds_read_b128 v[36:39], v251 offset:16
  ds_read_b128 v[40:43], v251 offset:38912
  ds_read_b128 v[44:47], v251 offset:38928
  ds_read_b128 v[48:51], v20 offset:0
  ds_read_b128 v[52:55], v20 offset:16
  ds_read_b128 v[56:59], v20 offset:38912
  ds_read_b128 v[60:63], v20 offset:38928
  ds_read_b128 v[64:67], v252 offset:0
  ds_read_b128 v[68:71], v252 offset:16
  ds_read_b128 v[72:75], v252 offset:38912
  ds_read_b128 v[76:79], v252 offset:38928
  ds_read_b128 v[80:83], v21 offset:0
  ds_read_b128 v[84:87], v21 offset:16
  ds_read_b128 v[88:91], v21 offset:38912
  ds_read_b128 v[92:95], v21 offset:38928
  ds_read_b128 v[128:131], v253 offset:0
  ds_read_b128 v[132:135], v253 offset:16
  ds_read_b128 v[136:139], v253 offset:38912
  ds_read_b128 v[140:143], v253 offset:38928
  ds_read_b128 v[144:147], v22 offset:0
  ds_read_b128 v[148:151], v22 offset:16
  ds_read_b128 v[152:155], v22 offset:38912
  ds_read_b128 v[156:159], v22 offset:38928
  s_waitcnt lgkmcnt(15)
  v_pk_add_f32 v[32:33], v[32:33], v[40:41]
  v_pk_add_f32 v[48:49], v[48:49], v[56:57]
  v_pk_add_f32 v[34:35], v[34:35], v[42:43]
  v_pk_add_f32 v[50:51], v[50:51], v[58:59]
  v_pk_add_f32 v[36:37], v[36:37], v[44:45]
  v_pk_add_f32 v[52:53], v[52:53], v[60:61]
  v_pk_add_f32 v[38:39], v[38:39], v[46:47]
  v_pk_add_f32 v[54:55], v[54:55], v[62:63]
  v_pk_add_f32 v[32:33], v[32:33], v[48:49]
  v_pk_add_f32 v[34:35], v[34:35], v[50:51]
  v_pk_add_f32 v[36:37], v[36:37], v[52:53]
  v_pk_add_f32 v[38:39], v[38:39], v[54:55]
  v_cvt_pk_bf16_f32 v40, v32, v33
  v_cvt_pk_bf16_f32 v41, v34, v35
  v_cvt_pk_bf16_f32 v42, v36, v37
  v_cvt_pk_bf16_f32 v43, v38, v39
  v_lshlrev_b32 v32, 16, v40
  v_and_b32 v33, 0xffff0000, v40
  v_lshlrev_b32 v34, 16, v41
  v_and_b32 v35, 0xffff0000, v41
  v_lshlrev_b32 v36, 16, v42
  v_and_b32 v37, 0xffff0000, v42
  v_lshlrev_b32 v38, 16, v43
  v_and_b32 v39, 0xffff0000, v43
  v_pk_add_f32 v[32:33], v[32:33], v[96:97]
  v_pk_add_f32 v[34:35], v[34:35], v[98:99]
  v_pk_add_f32 v[36:37], v[36:37], v[100:101]
  v_pk_add_f32 v[38:39], v[38:39], v[102:103]
  v_cvt_pk_bf16_f32 v40, v32, v33
  v_cvt_pk_bf16_f32 v41, v34, v35
  v_cvt_pk_bf16_f32 v42, v36, v37
  v_cvt_pk_bf16_f32 v43, v38, v39
  v_lshlrev_b32 v32, 16, v40
  v_and_b32 v33, 0xffff0000, v40
  v_lshlrev_b32 v34, 16, v41
  v_and_b32 v35, 0xffff0000, v41
  v_lshlrev_b32 v36, 16, v42
  v_and_b32 v37, 0xffff0000, v42
  v_lshlrev_b32 v38, 16, v43
  v_and_b32 v39, 0xffff0000, v43
  v_pk_add_f32 v[32:33], v[32:33], v[120:121]
  v_pk_add_f32 v[34:35], v[34:35], v[122:123]
  v_pk_add_f32 v[36:37], v[36:37], v[124:125]
  v_pk_add_f32 v[38:39], v[38:39], v[126:127]
  v_cvt_pk_bf16_f32 v44, v32, v33
  v_cvt_pk_bf16_f32 v45, v34, v35
  v_cvt_pk_bf16_f32 v46, v36, v37
  v_cvt_pk_bf16_f32 v47, v38, v39
  buffer_store_dwordx4 v[44:47], v248, s[48:51], 0 offen
  s_waitcnt lgkmcnt(8)
  v_pk_add_f32 v[64:65], v[64:65], v[72:73]
  v_pk_add_f32 v[80:81], v[80:81], v[88:89]
  v_pk_add_f32 v[66:67], v[66:67], v[74:75]
  v_pk_add_f32 v[82:83], v[82:83], v[90:91]
  v_pk_add_f32 v[68:69], v[68:69], v[76:77]
  v_pk_add_f32 v[84:85], v[84:85], v[92:93]
  v_pk_add_f32 v[70:71], v[70:71], v[78:79]
  v_pk_add_f32 v[86:87], v[86:87], v[94:95]
  v_pk_add_f32 v[64:65], v[64:65], v[80:81]
  v_pk_add_f32 v[66:67], v[66:67], v[82:83]
  v_pk_add_f32 v[68:69], v[68:69], v[84:85]
  v_pk_add_f32 v[70:71], v[70:71], v[86:87]
  v_cvt_pk_bf16_f32 v72, v64, v65
  v_cvt_pk_bf16_f32 v73, v66, v67
  v_cvt_pk_bf16_f32 v74, v68, v69
  v_cvt_pk_bf16_f32 v75, v70, v71
  v_lshlrev_b32 v64, 16, v72
  v_and_b32 v65, 0xffff0000, v72
  v_lshlrev_b32 v66, 16, v73
  v_and_b32 v67, 0xffff0000, v73
  v_lshlrev_b32 v68, 16, v74
  v_and_b32 v69, 0xffff0000, v74
  v_lshlrev_b32 v70, 16, v75
  v_and_b32 v71, 0xffff0000, v75
  v_pk_add_f32 v[64:65], v[64:65], v[104:105]
  v_pk_add_f32 v[66:67], v[66:67], v[106:107]
  v_pk_add_f32 v[68:69], v[68:69], v[108:109]
  v_pk_add_f32 v[70:71], v[70:71], v[110:111]
  v_cvt_pk_bf16_f32 v72, v64, v65
  v_cvt_pk_bf16_f32 v73, v66, v67
  v_cvt_pk_bf16_f32 v74, v68, v69
  v_cvt_pk_bf16_f32 v75, v70, v71
  v_lshlrev_b32 v64, 16, v72
  v_and_b32 v65, 0xffff0000, v72
  v_lshlrev_b32 v66, 16, v73
  v_and_b32 v67, 0xffff0000, v73
  v_lshlrev_b32 v68, 16, v74
  v_and_b32 v69, 0xffff0000, v74
  v_lshlrev_b32 v70, 16, v75
  v_and_b32 v71, 0xffff0000, v75
  v_pk_add_f32 v[64:65], v[64:65], v[160:161]
  v_pk_add_f32 v[66:67], v[66:67], v[162:163]
  v_pk_add_f32 v[68:69], v[68:69], v[164:165]
  v_pk_add_f32 v[70:71], v[70:71], v[166:167]
  v_cvt_pk_bf16_f32 v76, v64, v65
  v_cvt_pk_bf16_f32 v77, v66, v67
  v_cvt_pk_bf16_f32 v78, v68, v69
  v_cvt_pk_bf16_f32 v79, v70, v71
  buffer_store_dwordx4 v[76:79], v249, s[48:51], 0 offen
  s_waitcnt lgkmcnt(0)
  v_pk_add_f32 v[128:129], v[128:129], v[136:137]
  v_pk_add_f32 v[144:145], v[144:145], v[152:153]
  v_pk_add_f32 v[130:131], v[130:131], v[138:139]
  v_pk_add_f32 v[146:147], v[146:147], v[154:155]
  v_pk_add_f32 v[132:133], v[132:133], v[140:141]
  v_pk_add_f32 v[148:149], v[148:149], v[156:157]
  v_pk_add_f32 v[134:135], v[134:135], v[142:143]
  v_pk_add_f32 v[150:151], v[150:151], v[158:159]
  v_pk_add_f32 v[128:129], v[128:129], v[144:145]
  v_pk_add_f32 v[130:131], v[130:131], v[146:147]
  v_pk_add_f32 v[132:133], v[132:133], v[148:149]
  v_pk_add_f32 v[134:135], v[134:135], v[150:151]
  v_cvt_pk_bf16_f32 v136, v128, v129
  v_cvt_pk_bf16_f32 v137, v130, v131
  v_cvt_pk_bf16_f32 v138, v132, v133
  v_cvt_pk_bf16_f32 v139, v134, v135
  v_lshlrev_b32 v128, 16, v136
  v_and_b32 v129, 0xffff0000, v136
  v_lshlrev_b32 v130, 16, v137
  v_and_b32 v131, 0xffff0000, v137
  v_lshlrev_b32 v132, 16, v138
  v_and_b32 v133, 0xffff0000, v138
  v_lshlrev_b32 v134, 16, v139
  v_and_b32 v135, 0xffff0000, v139
  v_pk_add_f32 v[128:129], v[128:129], v[112:113]
  v_pk_add_f32 v[130:131], v[130:131], v[114:115]
  v_pk_add_f32 v[132:133], v[132:133], v[116:117]
  v_pk_add_f32 v[134:135], v[134:135], v[118:119]
  v_cvt_pk_bf16_f32 v136, v128, v129
  v_cvt_pk_bf16_f32 v137, v130, v131
  v_cvt_pk_bf16_f32 v138, v132, v133
  v_cvt_pk_bf16_f32 v139, v134, v135
  v_lshlrev_b32 v128, 16, v136
  v_and_b32 v129, 0xffff0000, v136
  v_lshlrev_b32 v130, 16, v137
  v_and_b32 v131, 0xffff0000, v137
  v_lshlrev_b32 v132, 16, v138
  v_and_b32 v133, 0xffff0000, v138
  v_lshlrev_b32 v134, 16, v139
  v_and_b32 v135, 0xffff0000, v139
  v_pk_add_f32 v[128:129], v[128:129], v[168:169]
  v_pk_add_f32 v[130:131], v[130:131], v[170:171]
  v_pk_add_f32 v[132:133], v[132:133], v[172:173]
  v_pk_add_f32 v[134:135], v[134:135], v[174:175]
  v_cvt_pk_bf16_f32 v140, v128, v129
  v_cvt_pk_bf16_f32 v141, v130, v131
  v_cvt_pk_bf16_f32 v142, v132, v133
  v_cvt_pk_bf16_f32 v143, v134, v135
  buffer_store_dwordx4 v[140:143], v250, s[48:51], 0 offen
fa_end:
  s_endpgm
fa_hk0:
  s_getpc_b64 s[10:11]
fa_hp0:
  s_add_u32 s8, s8, 4
  s_addc_u32 s9, s9, 0
  s_sub_u32 s10, s10, fa_hp0-fa_hb0
  s_subb_u32 s11, s11, 0
  s_setpc_b64 s[8:9]
fa_hk1:
  s_getpc_b64 s[10:11]
fa_hp1:
  s_add_u32 s8, s8, 4
  s_addc_u32 s9, s9, 0
  s_sub_u32 s10, s10, fa_hp1-fa_hb1
  s_subb_u32 s11, s11, 0
  s_setpc_b64 s[8:9]
fa_hk2:
  s_getpc_b64 s[10:11]
fa_hp2:
  s_add_u32 s8, s8, 4
  s_addc_u32 s9, s9, 0
  s_sub_u32 s10, s10, fa_hp2-fa_hb2
  s_subb_u32 s11, s11, 0
  s_setpc_b64 s[8:9]
fa_hk3:
  s_getpc_b64 s[10:11]
fa_hp3:
  s_add_u32 s8, s8, 4
  s_addc_u32 s9, s9, 0
  s_sub_u32 s10, s10, fa_hp3-fa_hb3
  s_subb_u32 s11, s11, 0
  s_setpc_b64 s[8:9]
fa_ln_spin:
  s_mov_b32 s83, 200000
fa_ln_spin2:
  buffer_load_dword v15, v229, s[56:59], 0 offen sc1
  s_waitcnt vmcnt(0)
  v_cmp_ne_u32 vcc, 0x01010101, v15
  s_cbranch_vccz fa_ln_ok
  s_sleep 8
  s_sub_u32 s83, s83, 1
  s_cmp_lg_u32 s83, 0
  s_cbranch_scc1 fa_ln_spin2
  s_branch fa_ln_ok
fa_co1:
  buffer_load_dword v232, v234, s[32:35], s29 offen
  buffer_store_dword v229, v225, s[40:43], 0 offen sc1
  ds_read_b128 v[160:163], v221 offset:0
  ds_read_b128 v[164:167], v221 offset:4096
  ds_read_b128 v[168:171], v221 offset:8192
  buffer_store_dword v218, v222, s[40:43], 0 offen sc1
  s_waitcnt lgkmcnt(0)
  buffer_store_dwordx4 v[160:163], v223, s[40:43], s66 offen sc1
  buffer_store_dwordx4 v[164:167], v223, s[40:43], s67 offen sc1
  buffer_store_dwordx4 v[168:171], v224, s[40:43], s78 offen sc1
  s_getpc_b64 s[8:9]
  s_setpc_b64 s[10:11]
  s_mov_b32 s48, s60
  s_mov_b32 s49, s61
  s_mov_b32 s50, s75
  s_lshl_b32 s74, s22, 2
  s_add_u32 s74, s74, s20
  s_lshl_b32 s74, s74, 16
  s_mov_b32 s73, 2097152
  v_mov_b32 v213, 1073741824
  v_mov_b32 v214, 1
  v_writelane_b32 v213, s77, 0
  v_lshlrev_b32 v229, 2, v1
  s_and_b32 s23, s21, 3
  s_cbranch_scc0 fa_arr
  s_getpc_b64 s[8:9]
  s_setpc_b64 s[10:11]
fa_arr:
  buffer_store_byte v214, v213, s[56:59], 0 offen sc1
  s_getpc_b64 s[8:9]
  s_setpc_b64 s[10:11]
  buffer_load_dword v15, v229, s[56:59], 0 offen sc1
  s_getpc_b64 s[8:9]
  s_setpc_b64 s[10:11]
  s_mov_b32 s36, s60
  s_mov_b32 s37, s61
  s_mov_b32 s38, s75
  s_lshr_b32 s27, s20, 1
  s_lshl_b32 s27, s27, 18
  s_mov_b32 s25, 524288
  s_mov_b32 s32, s18
  s_mov_b32 s33, s19
  s_mov_b32 s34, 2621440
  s_mov_b32 s26, 0
  s_movk_i32 s79, 1024
  s_lshl_b32 s23, s22, 2
  s_add_u32 s23, s23, s20
  s_mul_i32 s23, s23, 40960
  v_add_u32 v3, s23, v2
  s_sub_u32 s23, 15, s22
  s_lshl_b32 s23, s23, 2
  s_add_u32 s23, s23, s20
  s_mul_i32 s23, s23, 40960
  s_sub_u32 s23, s23, 2048
  v_add_u32 v5, s23, v2
  v_add_u32 v4, 19456, v3
  v_add_u32 v6, 19456, v5
  s_waitcnt vmcnt(8)
  v_cmp_ne_u32 vcc, 0x01010101, v15
  s_cbranch_vccnz fa_ln_spin
fa_ln_ok:
  s_setpc_b64 s[10:11]
fa_kv_spin:
  s_mov_b32 s83, 200000
fa_kv_spin2:
  buffer_load_dword v15, v8, s[40:43], 0 offen sc1
  s_waitcnt vmcnt(0)
  v_cmp_eq_u32 vcc, 0, v15
  s_cbranch_vccz fa_kv_ok
  s_sleep 8
  s_sub_u32 s83, s83, 1
  s_cmp_lg_u32 s83, 0
  s_cbranch_scc1 fa_kv_spin2
  s_branch fa_kv_ok
fa_top8:
  s_cmp_lg_u32 s20, 0
  s_cbranch_scc1 fa_notop
  s_mov_b32 s23, 2621440
  s_mov_b32 s31, 2625536
  buffer_load_dwordx4 v[96:99], v2, s[40:43], s23 offen offset:0 sc1
  buffer_load_dwordx4 v[100:103], v2, s[40:43], s23 offen offset:1024 sc1
  buffer_load_dwordx4 v[104:107], v2, s[40:43], s23 offen offset:2048 sc1
  buffer_load_dwordx4 v[108:111], v2, s[40:43], s23 offen offset:3072 sc1
  buffer_load_dwordx4 v[112:115], v2, s[40:43], s31 offen offset:0 sc1
  buffer_load_dwordx4 v[116:119], v2, s[40:43], s31 offen offset:1024 sc1
  buffer_load_dwordx4 v[120:123], v2, s[40:43], s31 offen offset:2048 sc1
  buffer_load_dwordx4 v[124:127], v2, s[40:43], s31 offen offset:3072 sc1
  v_mov_b32 v21, 0
  v_mov_b32 v22, 0
  v_and_b32 v23, 7, v1
  s_mov_b32 s23, 0
  s_waitcnt vmcnt(0)
fa_top:
  v_max3_u32 v20, v96, v97, v98
  v_max3_u32 v24, v99, v100, v101
  v_max3_u32 v20, v20, v102, v103
  v_max3_u32 v24, v24, v104, v105
  v_max3_u32 v20, v20, v106, v107
  v_max3_u32 v24, v24, v108, v109
  v_max3_u32 v20, v20, v110, v111
  v_max3_u32 v24, v24, v112, v113
  v_max3_u32 v20, v20, v114, v115
  v_max3_u32 v24, v24, v116, v117
  v_max3_u32 v20, v20, v118, v119
  v_max3_u32 v24, v24, v120, v121
  v_max3_u32 v20, v20, v122, v123
  v_max3_u32 v24, v24, v124, v125
  v_max3_u32 v20, v20, v126, v127
  v_max_u32 v20, v20, v24
  s_nop 1
  v_max_u32_dpp v20, v20, v20 quad_perm:[1,0,3,2] row_mask:0xf bank_mask:0xf
  s_nop 1
  v_max_u32_dpp v20, v20, v20 quad_perm:[2,3,0,1] row_mask:0xf bank_mask:0xf
  s_nop 1
  v_max_u32_dpp v20, v20, v20 row_half_mirror row_mask:0xf bank_mask:0xf
  s_nop 1
  v_max_u32_dpp v20, v20, v20 row_mirror row_mask:0xf bank_mask:0xf
  v_mov_b32 v24, v20
  s_nop 1
  v_permlane16_swap_b32 v20, v24
  v_max_u32 v20, v20, v24
  v_mov_b32 v24, v20
  s_nop 1
  v_permlane32_swap_b32 v20, v24
  v_max_u32 v20, v20, v24
  v_add_u32 v21, v21, v20
  v_cmp_eq_u32 vcc, s23, v23
  v_sub_u32 v96, v96, v20
  v_sub_u32 v97, v97, v20
  v_sub_u32 v98, v98, v20
  v_sub_u32 v99, v99, v20
  v_sub_u32 v100, v100, v20
  v_sub_u32 v101, v101, v20
  v_sub_u32 v102, v102, v20
  v_sub_u32 v103, v103, v20
  v_sub_u32 v104, v104, v20
  v_sub_u32 v105, v105, v20
  v_sub_u32 v106, v106, v20
  v_sub_u32 v107, v107, v20
  v_sub_u32 v108, v108, v20
  v_sub_u32 v109, v109, v20
  v_sub_u32 v110, v110, v20
  v_sub_u32 v111, v111, v20
  v_sub_u32 v112, v112, v20
  v_sub_u32 v113, v113, v20
  v_sub_u32 v114, v114, v20
  v_sub_u32 v115, v115, v20
  v_sub_u32 v116, v116, v20
  v_sub_u32 v117, v117, v20
  v_sub_u32 v118, v118, v20
  v_sub_u32 v119, v119, v20
  v_sub_u32 v120, v120, v20
  v_sub_u32 v121, v121, v20
  v_sub_u32 v122, v122, v20
  v_sub_u32 v123, v123, v20
  v_sub_u32 v124, v124, v20
  v_sub_u32 v125, v125, v20
  v_sub_u32 v126, v126, v20
  v_sub_u32 v127, v127, v20
  v_cndmask_b32 v22, v22, v21, vcc
  s_add_u32 s23, s23, 1
  s_cmp_lt_u32 s23, 8
  s_cbranch_scc1 fa_top
  v_and_b32 v25, 0xffff, v22
  v_sub_u32 v25, 0xffff, v25
  v_and_b32 v25, 2047, v25
  v_ashrrev_i32 v20, 31, v22
  v_not_b32 v20, v20
  v_or_b32 v20, 0x80000000, v20
  v_xor_b32 v26, v22, v20
  v_and_b32 v26, 0xffff0000, v26
  v_mul_f32 v26, 0xbfb8aa3b, v26
  v_exp_f32 v26, v26
  s_nop 0
  v_add_f32 v26, 1.0, v26
  v_rcp_f32 v26, v26
  s_nop 0
  v_cvt_pk_bf16_f32 v26, v26, v26
  v_and_b32 v26, 0xffff0000, v26
  v_lshlrev_b32 v20, 2, v1
  v_add_u32 v20, 2629632, v20
  v_mov_b32 v21, 1073741824
  v_cmp_gt_u32 vcc, 16, v1
  v_add_u32 v25, 1, v25
  v_or_b32 v26, 1, v26
  v_cndmask_b32 v20, v21, v20, vcc
  v_cmp_gt_u32 vcc, 8, v1
  s_nop 1
  v_cndmask_b32 v26, v26, v25, vcc
  buffer_store_dword v26, v20, s[40:43], 0 offen sc1
  s_branch fa_notop
fa_hk4:
  s_getpc_b64 s[38:39]
fa_hp4:
  s_add_u32 s36, s36, 4
  s_addc_u32 s37, s37, 0
  s_sub_u32 s38, s38, fa_hp4-fa_hb4
  s_subb_u32 s39, s39, 0
  s_setpc_b64 s[36:37]
fa_hk5:
  s_getpc_b64 s[38:39]
fa_hp5:
  s_add_u32 s36, s36, 4
  s_addc_u32 s37, s37, 0
  s_sub_u32 s38, s38, fa_hp5-fa_hb5
  s_subb_u32 s39, s39, 0
  s_setpc_b64 s[36:37]
fa_hk6:
  s_getpc_b64 s[38:39]
fa_hp6:
  s_add_u32 s36, s36, 4
  s_addc_u32 s37, s37, 0
  s_add_u32 s38, s38, fa_hb6-fa_hp6
  s_addc_u32 s39, s39, 0
  s_setpc_b64 s[36:37]
fa_DDF:
  v_mfma_f32_16x16x32_bf16 v[96:99], a[128:131], v[32:35], v[192:195]
  s_waitcnt vmcnt(12)
  v_exp_f32 v218, v146
  v_mfma_f32_16x16x32_bf16 v[104:107], a[128:131], v[36:39], v[196:199]
  s_barrier
  v_exp_f32 v219, v147
  v_mfma_f32_16x16x32_bf16 v[128:131], a[128:131], v[64:67], v[200:203]
  s_cmp_ge_u32 s26, s32
  ds_read_b128 a[160:163], v3 offset:16384
  v_add_f32 v226, v216, v217
  v_mfma_f32_16x16x32_bf16 v[136:139], a[128:131], v[68:71], v[204:207]
  s_cbranch_scc1 fa_hk6
fa_hb6:
  v_exp_f32 v220, v148
  v_mfma_f32_16x16x32_bf16 v[100:103], a[132:135], v[32:35], v[192:195]
  ds_read_b128 a[164:167], v3 offset:17408
  v_cvt_pk_bf16_f32 v184, v216, v217
  v_mfma_f32_16x16x32_bf16 v[108:111], a[132:135], v[36:39], v[196:199]
  s_mov_b32 m0, s24
  v_exp_f32 v221, v149
  v_mfma_f32_16x16x32_bf16 v[132:135], a[132:135], v[64:67], v[200:203]
  buffer_load_dwordx4 v2, s[44:47], s26 offen offset:0 sc1 lds
  v_add_f32 v226, v226, v218
  v_mfma_f32_16x16x32_bf16 v[140:143], a[132:135], v[68:71], v[204:207]
  v_exp_f32 v222, v150
  v_mfma_f32_16x16x32_bf16 v[96:99], a[136:139], v[40:43], v[96:99]
  ds_read_b128 a[168:171], v3 offset:18432
  v_add_f32 v226, v226, v219
  v_cvt_pk_bf16_f32 v185, v218, v219
  v_mfma_f32_16x16x32_bf16 v[104:107], a[136:139], v[44:47], v[104:107]
  v_exp_f32 v223, v151
  v_mfma_f32_16x16x32_bf16 v[128:131], a[136:139], v[72:75], v[128:131]
  v_add_f32 v226, v226, v220
  v_add_f32 v226, v226, v221
  v_mfma_f32_16x16x32_bf16 v[136:139], a[136:139], v[76:79], v[136:139]
  v_exp_f32 v216, v152
  v_mfma_f32_16x16x32_bf16 v[100:103], a[140:143], v[40:43], v[100:103]
  ds_read_b128 a[172:175], v3 offset:19456
  v_cvt_pk_bf16_f32 v186, v220, v221
  v_mfma_f32_16x16x32_bf16 v[108:111], a[140:143], v[44:47], v[108:111]
  buffer_load_dwordx4 v2, s[44:47], s26 offen offset:1024 sc1 lds
  v_add_f32 v226, v226, v222
  v_mfma_f32_16x16x32_bf16 v[132:135], a[140:143], v[72:75], v[132:135]
  v_exp_f32 v217, v153
  v_mfma_f32_16x16x32_bf16 v[140:143], a[140:143], v[76:79], v[140:143]
  s_waitcnt lgkmcnt(4)
  v_exp_f32 v218, v154
  v_mfma_f32_16x16x32_bf16 v[96:99], a[144:147], v[48:51], v[96:99]
  ds_read_b128 a[176:179], v3 offset:20480
  v_add_f32 v226, v226, v223
  v_mfma_f32_16x16x32_bf16 v[104:107], a[144:147], v[52:55], v[104:107]
  v_exp_f32 v219, v155
  v_mfma_f32_16x16x32_bf16 v[128:131], a[144:147], v[80:83], v[128:131]
  v_cvt_pk_bf16_f32 v187, v222, v223
  v_add_f32 v227, v216, v217
  v_cvt_pk_bf16_f32 v188, v216, v217
  v_mfma_f32_16x16x32_bf16 v[136:139], a[144:147], v[84:87], v[136:139]
  buffer_load_dwordx4 v2, s[44:47], s26 offen offset:2048 sc1 lds
  v_add_f32 v227, v227, v218
  v_mfma_f32_16x16x32_bf16 v[100:103], a[148:151], v[48:51], v[100:103]
  ds_read_b128 a[180:183], v3 offset:21504
  v_add_f32 v227, v227, v219
  v_mfma_f32_16x16x32_bf16 v[108:111], a[148:151], v[52:55], v[108:111]
  v_exp_f32 v220, v156
  v_mfma_f32_16x16x32_bf16 v[132:135], a[148:151], v[80:83], v[132:135]
  v_exp_f32 v221, v157
  v_mfma_f32_16x16x32_bf16 v[140:143], a[148:151], v[84:87], v[140:143]
  v_exp_f32 v222, v158
  v_mfma_f32_16x16x32_bf16 v[96:99], a[152:155], v[56:59], v[96:99]
  ds_read_b128 a[184:187], v3 offset:22528
  v_cvt_pk_bf16_f32 v189, v218, v219
  v_mfma_f32_16x16x32_bf16 v[104:107], a[152:155], v[60:63], v[104:107]
  buffer_load_dwordx4 v2, s[44:47], s26 offen offset:3072 sc1 lds
  v_add_f32 v227, v227, v220
  v_add_f32 v227, v227, v221
  v_mfma_f32_16x16x32_bf16 v[128:131], a[152:155], v[88:91], v[128:131]
  s_add_u32 s26, s26, 16384
  v_exp_f32 v223, v159
  v_mfma_f32_16x16x32_bf16 v[136:139], a[152:155], v[92:95], v[136:139]
  s_add_u32 s24, s24, 32768
  v_exp_f32 v208, v112
  v_mfma_f32_16x16x32_bf16 v[100:103], a[156:159], v[56:59], v[100:103]
  s_and_b32 s24, s24, 0x1ffff
  ds_read_b128 a[188:191], v3 offset:23552
  v_cvt_pk_bf16_f32 v190, v220, v221
  v_mfma_f32_16x16x32_bf16 v[108:111], a[156:159], v[60:63], v[108:111]
  v_exp_f32 v209, v113
  v_mfma_f32_16x16x32_bf16 v[132:135], a[156:159], v[88:91], v[132:135]
  s_add_u32 m0, s34, 0
  v_exp_f32 v210, v114
  v_mfma_f32_16x16x32_bf16 v[140:143], a[156:159], v[92:95], v[140:143]
  s_waitcnt lgkmcnt(4)
  buffer_load_dwordx4 v8, s[52:55], s33 offen offset:0 lds
  v_add_f32 v227, v227, v222
  v_mfma_f32_16x16x32_bf16 a[0:3], a[160:163], v[160:163], a[0:3]
  ds_read_b128 a[128:131], v3 offset:0
  v_add_f32 v227, v227, v223
  v_mfma_f32_16x16x32_bf16 a[4:7], a[160:163], v[164:167], a[4:7]
  v_exp_f32 v211, v115
  v_mfma_f32_16x16x32_bf16 a[64:67], a[160:163], v[176:179], a[64:67]
  v_cvt_pk_bf16_f32 v191, v222, v223
  v_add_f32 v224, v208, v209
  v_cvt_pk_bf16_f32 v168, v208, v209
  v_mfma_f32_16x16x32_bf16 a[68:71], a[160:163], v[180:183], a[68:71]
  v_exp_f32 v212, v116
  v_mfma_f32_16x16x32_bf16 a[8:11], a[164:167], v[160:163], a[8:11]
  ds_read_b128 a[132:135], v3 offset:1024
  v_add_f32 v224, v224, v210
  v_mfma_f32_16x16x32_bf16 a[12:15], a[164:167], v[164:167], a[12:15]
  buffer_load_dwordx4 v11, s[52:55], s33 offen offset:1024 lds
  v_add_f32 v224, v224, v211
  v_mfma_f32_16x16x32_bf16 a[72:75], a[164:167], v[176:179], a[72:75]
  v_exp_f32 v213, v117
  v_mfma_f32_16x16x32_bf16 a[76:79], a[164:167], v[180:183], a[76:79]
  v_exp_f32 v214, v118
  v_mfma_f32_16x16x32_bf16 a[16:19], a[168:171], v[160:163], a[16:19]
  ds_read_b128 a[136:139], v3 offset:2048
  v_cvt_pk_bf16_f32 v169, v210, v211
  v_mfma_f32_16x16x32_bf16 a[20:23], a[168:171], v[164:167], a[20:23]
  v_exp_f32 v215, v119
  v_mfma_f32_16x16x32_bf16 a[80:83], a[168:171], v[176:179], a[80:83]
  v_add_f32 v224, v224, v212
  v_add_f32 v224, v224, v213
  v_cvt_pk_bf16_f32 v170, v212, v213
  v_mfma_f32_16x16x32_bf16 a[84:87], a[168:171], v[180:183], a[84:87]
  buffer_load_dwordx4 v12, s[52:55], s33 offen offset:2048 lds
  v_add_f32 v224, v224, v214
  v_mfma_f32_16x16x32_bf16 a[24:27], a[172:175], v[160:163], a[24:27]
  ds_read_b128 a[140:143], v3 offset:3072
  v_add_f32 v224, v224, v215
  v_mfma_f32_16x16x32_bf16 a[28:31], a[172:175], v[164:167], a[28:31]
  v_exp_f32 v208, v120
  v_mfma_f32_16x16x32_bf16 a[88:91], a[172:175], v[176:179], a[88:91]
  v_exp_f32 v209, v121
  v_mfma_f32_16x16x32_bf16 a[92:95], a[172:175], v[180:183], a[92:95]
  s_waitcnt lgkmcnt(4)
  v_exp_f32 v210, v122
  v_mfma_f32_16x16x32_bf16 a[32:35], a[176:179], v[160:163], a[32:35]
  ds_read_b128 a[144:147], v3 offset:4096
  v_cvt_pk_bf16_f32 v171, v214, v215
  v_mfma_f32_16x16x32_bf16 a[36:39], a[176:179], v[164:167], a[36:39]
  buffer_load_dwordx4 v13, s[52:55], s33 offen offset:3072 lds
  v_add_f32 v225, v208, v209
  v_mfma_f32_16x16x32_bf16 a[96:99], a[176:179], v[176:179], a[96:99]
  v_exp_f32 v211, v123
  v_mfma_f32_16x16x32_bf16 a[100:103], a[176:179], v[180:183], a[100:103]
  v_exp_f32 v212, v124
  v_mfma_f32_16x16x32_bf16 a[40:43], a[180:183], v[160:163], a[40:43]
  ds_read_b128 a[148:151], v3 offset:5120
  v_cvt_pk_bf16_f32 v172, v208, v209
  v_add_f32 v225, v225, v210
  v_mfma_f32_16x16x32_bf16 a[44:47], a[180:183], v[164:167], a[44:47]
  v_exp_f32 v213, v125
  v_mfma_f32_16x16x32_bf16 a[104:107], a[180:183], v[176:179], a[104:107]
  s_add_u32 m0, s34, 4096
  v_add_f32 v225, v225, v211
  v_cvt_pk_bf16_f32 v173, v210, v211
  v_mfma_f32_16x16x32_bf16 a[108:111], a[180:183], v[180:183], a[108:111]
  buffer_load_dwordx4 v14, s[52:55], s33 offen offset:0 lds
  v_max3_f32 v5, v226, v227, v224
  v_mfma_f32_16x16x32_bf16 a[48:51], a[184:187], v[160:163], a[48:51]
  ds_read_b128 a[152:155], v3 offset:6144
  v_add_f32 v225, v225, v212
  v_mfma_f32_16x16x32_bf16 a[52:55], a[184:187], v[164:167], a[52:55]
  v_exp_f32 v214, v126
  v_mfma_f32_16x16x32_bf16 a[112:115], a[184:187], v[176:179], a[112:115]
  v_exp_f32 v215, v127
  v_mfma_f32_16x16x32_bf16 a[116:119], a[184:187], v[180:183], a[116:119]
  v_add_f32 v225, v225, v213
  v_cvt_pk_bf16_f32 v174, v212, v213
  v_add_f32 v225, v225, v214
  v_mfma_f32_16x16x32_bf16 a[56:59], a[188:191], v[160:163], a[56:59]
  ds_read_b128 a[156:159], v3 offset:7168
  v_add_f32 v225, v225, v215
  v_max_f32 v5, v5, v225
  v_cmp_lt_f32 vcc, s81, v5
  v_mfma_f32_16x16x32_bf16 a[60:63], a[188:191], v[164:167], a[60:63]
  v_exp_f32 v216, v128
  v_mfma_f32_16x16x32_bf16 a[120:123], a[188:191], v[176:179], a[120:123]
  s_waitcnt lgkmcnt(4)
  v_cvt_pk_bf16_f32 v175, v214, v215
  v_mfma_f32_16x16x32_bf16 a[124:127], a[188:191], v[180:183], a[124:127]
  s_cbranch_vccnz fa_stub3
fa_back3:
  v_exp_f32 v217, v129
  v_add_f32 v228, v228, v224
  v_add_f32 v229, v229, v225
  v_add_f32 v230, v230, v226
  v_add_f32 v231, v231, v227
  s_branch fa_DDe
fa_kv2_spin:
  s_mov_b32 s83, 200000
fa_kv2_spin2:
  buffer_load_dword v14, v13, s[40:43], 0 offen sc1
  s_waitcnt vmcnt(0)
  v_cmp_eq_u32 vcc, 0, v14
  s_cbranch_vccz fa_kv2_ok
  s_sleep 8
  s_sub_u32 s83, s83, 1
  s_cmp_lg_u32 s83, 0
  s_cbranch_scc1 fa_kv2_spin2
  s_branch fa_kv2_ok
fa_kv3_spin:
  s_mov_b32 s83, 200000
fa_kv3_spin2:
  buffer_load_dword v14, v13, s[40:43], 0 offen sc1
  s_waitcnt vmcnt(0)
  v_cmp_eq_u32 vcc, 0, v14
  s_cbranch_vccz fa_kv3_ok
  s_sleep 8
  s_sub_u32 s83, s83, 1
  s_cmp_lg_u32 s83, 0
  s_cbranch_scc1 fa_kv3_spin2
  s_branch fa_kv3_ok
fa_sel_spin:
  s_mov_b32 s83, 200000
fa_sel_spin2:
  buffer_load_dword v15, v252, s[40:43], 0 offen sc1
  s_waitcnt vmcnt(0)
  v_cmp_eq_u32 vcc, 0, v15
  s_cbranch_vccz fa_sel_ok
  s_sleep 8
  s_sub_u32 s83, s83, 1
  s_cmp_lg_u32 s83, 0
  s_cbranch_scc1 fa_sel_spin2
  s_branch fa_sel_ok
fa_wof_spin:
  s_mov_b32 s83, 200000
fa_wof_spin2:
  buffer_load_dword v8, v9, s[40:43], 0 offen sc1
  s_waitcnt vmcnt(0)
  v_cmp_eq_u32 vcc, 0, v8
  s_cbranch_vccz fa_wof_ok
  s_sleep 8
  s_sub_u32 s83, s83, 1
  s_cmp_lg_u32 s83, 0
  s_cbranch_scc1 fa_wof_spin2
  s_branch fa_wof_ok
fa_sel4_spin:
  s_mov_b32 s83, 200000
fa_sel4_spin2:
  buffer_load_dword v15, v10, s[40:43], 0 offen sc1
  s_waitcnt vmcnt(0)
  v_cmp_eq_u32 vcc, 0, v15
  s_cbranch_vccz fa_sel4_ok
  s_sleep 8
  s_sub_u32 s83, s83, 1
  s_cmp_lg_u32 s83, 0
  s_cbranch_scc1 fa_sel4_spin2
  s_branch fa_sel4_ok
fa_yf_spin:
  s_mov_b32 s83, 200000
fa_yf_spin2:
  buffer_load_dword v14, v11, s[40:43], 0 offen sc1
  s_waitcnt vmcnt(0)
  v_cmp_eq_u32 vcc, 0, v14
  s_cbranch_vccz fa_yf_ok
  s_sleep 8
  s_sub_u32 s83, s83, 1
  s_cmp_lg_u32 s83, 0
  s_cbranch_scc1 fa_yf_spin2
  s_branch fa_yf_ok
fa_co:
  s_sub_u32 s14, s2, 64
  s_cmp_lt_u32 s14, 96
  s_cbranch_scc1 fa_coT
  s_sub_u32 s14, s2, 128
  s_sub_u32 s23, s2, 224
  s_cmp_lt_u32 s23, 31
  s_cbranch_scc1 fa_coT
  v_cmp_eq_u32 vcc, 0, v14
  s_cbranch_vccnz fa_kv2_spin
fa_kv2_ok:
  s_sub_u32 s14, s2, 170
  s_cmp_lt_u32 s14, 54
  s_cbranch_scc1 fa_coF
  s_cmp_eq_u32 s2, 255
  s_cbranch_scc1 fa_coW
  s_branch fa_coO
fa_coT:
  v_min_u32 v8, 16, v1
  v_lshlrev_b32 v8, 7, v8
  s_lshl_b32 s10, s14, 1
  s_and_b32 s31, s20, 1
  s_add_u32 s10, s10, s31
  s_mul_i32 s10, s10, 2176
  s_lshl_b32 s35, s14, 2
  s_add_u32 s35, s35, s20
  s_mul_i32 s35, s35, 4352
  buffer_load_dword v255, v8, s[52:55], s10 offen
  s_add_u32 s10, s10, 552960
  s_getpc_b64 s[36:37]
  s_setpc_b64 s[38:39]
  buffer_load_dword v255, v8, s[52:55], s10 offen
  s_add_u32 s10, s10, 552960
  s_getpc_b64 s[36:37]
  s_setpc_b64 s[38:39]
  v_cmp_eq_u32 vcc, 0, v14
  s_cbranch_vccnz fa_kv3_spin
fa_kv3_ok:
  buffer_load_dword v255, v8, s[52:55], s10 offen
  s_add_u32 s10, s10, 552960
  buffer_load_dword v255, v8, s[60:63], s35 offen offset:0
  s_getpc_b64 s[36:37]
  s_setpc_b64 s[38:39]
  buffer_load_dword v255, v8, s[52:55], s10 offen
  s_add_u32 s10, s10, 552960
  buffer_load_dword v255, v8, s[60:63], s35 offen offset:2176
  s_mov_b32 s9, -1
  s_and_b32 s32, s21, 3
  s_lshr_b32 s32, s32, 1
  s_add_u32 s32, s32, 6
  s_lshl_b32 s32, s32, 14
  s_getpc_b64 s[36:37]
  s_setpc_b64 s[38:39]
fa_coO:
  s_and_b32 s23, s67, 1
  s_lshl_b32 s23, s23, 2
  s_add_u32 s23, s23, s20
  s_lshr_b32 s31, s67, 1
  s_lshl_b32 s30, s23, 7
  s_add_u32 s30, s30, s31
  s_mul_i32 s33, s31, 40960
  s_mul_i32 s23, s23, 160
  s_add_u32 s33, s33, s23
  s_add_u32 m0, s34, 0
  v_accvgpr_read_b32 v19, a248
  buffer_load_dwordx4 v19, s[56:59], s33 offen lds
  s_add_u32 m0, s34, 1024
  v_accvgpr_read_b32 v19, a249
  buffer_load_dwordx4 v19, s[56:59], s33 offen lds
  s_add_u32 m0, s34, 2048
  v_accvgpr_read_b32 v19, a250
  buffer_load_dwordx4 v19, s[56:59], s33 offen lds
  s_add_u32 m0, s34, 3072
  v_accvgpr_read_b32 v19, a251
  buffer_load_dwordx4 v19, s[56:59], s33 offen lds
  s_add_u32 m0, s34, 4096
  v_accvgpr_read_b32 v19, a252
  buffer_load_dwordx4 v19, s[56:59], s33 offen lds
  s_add_u32 s32, s26, 32768
  s_mov_b32 s9, -1
  s_lshl_b32 s10, s30, 2
  s_mul_i32 s30, s30, 5120
  s_add_u32 s30, s30, 4194304
  s_getpc_b64 s[36:37]
  s_setpc_b64 s[38:39]
  s_waitcnt vmcnt(8)
  ds_read_b64_tr_b16 v[232:233], v6 offset:0
  ds_read_b64_tr_b16 v[234:235], v6 offset:2560
  ds_read_b64_tr_b16 v[236:237], v6 offset:32
  ds_read_b64_tr_b16 v[238:239], v6 offset:2592
  ds_read_b64_tr_b16 v[240:241], v6 offset:64
  ds_read_b64_tr_b16 v[242:243], v6 offset:2624
  ds_read_b64_tr_b16 v[244:245], v6 offset:96
  ds_read_b64_tr_b16 v[246:247], v6 offset:2656
  ds_read_b64_tr_b16 v[248:249], v6 offset:128
  ds_read_b64_tr_b16 v[250:251], v6 offset:2688
  s_waitcnt lgkmcnt(0)
  s_add_u32 s31, s30, 4096
  buffer_store_dwordx4 v[232:235], v2, s[40:43], s30 offen offset:0 sc1
  buffer_store_dwordx4 v[236:239], v2, s[40:43], s30 offen offset:1024 sc1
  buffer_store_dwordx4 v[240:243], v2, s[40:43], s30 offen offset:2048 sc1
  buffer_store_dwordx4 v[244:247], v2, s[40:43], s30 offen offset:3072 sc1
  buffer_store_dwordx4 v[248:251], v2, s[40:43], s31 offen offset:0 sc1
  s_getpc_b64 s[36:37]
  s_setpc_b64 s[38:39]
  s_add_u32 s23, s10, 2654208
  s_waitcnt vmcnt(8)
  buffer_store_dword v4, off, s[40:43], s23 sc1
  s_sub_u32 s23, s67, 96
  s_cmp_gt_u32 s23, 54
  s_cbranch_scc1 fa_coW
  s_add_u32 s67, s23, 170
  s_cmp_eq_u32 s67, 224
  s_cselect_b32 s67, 255, s67
  s_branch fa_coO
fa_coF:
  v_and_b32 v16, 7, v1
  v_lshlrev_b32 v252, 2, v16
  v_add_u32 v252, 2629632, v252
  buffer_load_dword v15, v252, s[40:43], 0 offen sc1
  s_lshl_b32 s33, s14, 6
  s_and_b32 s31, s20, 1
  s_lshl_b32 s31, s31, 5
  s_add_u32 s33, s33, s31
  s_mul_i32 s35, s14, 40960
  s_mul_i32 s31, s20, 320
  s_add_u32 s35, s35, s31
  s_mul_i32 s10, s14, 20480
  s_mul_i32 s31, s20, 640
  s_add_u32 s10, s10, s31
  s_add_u32 s10, s10, 2686976
  v_lshrrev_b32 v17, 1, v1
  v_mul_u32_u24 v8, 3456, v17
  v_and_b32 v17, 1, v1
  v_lshl_add_u32 v8, v17, 4, v8
  v_add_u32 v11, 109568, v8
  v_add_u32 v12, 219136, v8
  v_add_u32 v13, 328704, v8
  v_add_u32 v14, 442368, v8
  v_lshrrev_b32 v17, 4, v1
  v_lshrrev_b32 v18, 2, v1
  v_lshl_add_u32 v18, v17, 2, v18
  v_lshlrev_b32 v18, 5, v18
  v_and_b32 v19, 3, v1
  v_lshl_add_u32 v9, v19, 3, v18
  v_add_u32 v9, s34, v9
  v_lshlrev_b32 v10, 4, v16
  v_lshl_add_u32 v10, v17, 7, v10
  v_add_u32 v10, 151552, v10
  s_mov_b32 s8, -1
  v_mov_b32 v232, 0
  v_mov_b32 v233, 0
  v_mov_b32 v234, 0
  v_mov_b32 v235, 0
  s_getpc_b64 s[36:37]
  s_setpc_b64 s[38:39]
  s_waitcnt vmcnt(8)
  v_cmp_eq_u32 vcc, 0, v15
  s_cbranch_vccnz fa_sel_spin
fa_sel_ok:
  v_add_u32 v18, -1, v15
  v_and_b32 v18, 2047, v18
  v_lshrrev_b32 v19, 4, v18
  v_mul_u32_u24 v19, 20480, v19
  v_and_b32 v18, 15, v18
  v_lshl_add_u32 v19, v18, 4, v19
  v_lshrrev_b32 v18, 3, v1
  v_lshl_add_u32 v19, v18, 8, v19
  s_lshl_b32 s23, s20, 11
  s_lshl_b32 s31, s20, 10
  s_add_u32 s31, s31, 151552
  s_mov_b32 s14, 4
  s_mov_b32 m0, s31
  s_add_u32 s31, s31, 4096
  buffer_load_dwordx4 v19, s[40:43], s23 offen sc1 lds
  s_add_u32 s23, s23, 8192
  s_mov_b32 m0, s31
  s_add_u32 s31, s31, 4096
  buffer_load_dwordx4 v19, s[40:43], s23 offen sc1 lds
  s_add_u32 s23, s23, 8192
  s_mov_b32 m0, s31
  s_add_u32 s31, s31, 4096
  buffer_load_dwordx4 v19, s[40:43], s23 offen sc1 lds
  s_add_u32 s23, s23, 8192
  s_getpc_b64 s[36:37]
  s_setpc_b64 s[38:39]
  s_branch fa_coG1
fa_coG:
  s_getpc_b64 s[36:37]
  s_setpc_b64 s[38:39]
  v_mfma_f32_16x16x32_bf16 v[232:235], a[192:195], a[212:215], v[232:235]
  v_mfma_f32_16x16x32_bf16 v[232:235], a[196:199], a[216:219], v[232:235]
  v_mfma_f32_16x16x32_bf16 v[232:235], a[200:203], a[220:223], v[232:235]
  v_mfma_f32_16x16x32_bf16 v[232:235], a[204:207], a[224:227], v[232:235]
  v_mfma_f32_16x16x32_bf16 v[232:235], a[208:211], a[228:231], v[232:235]
fa_coG1:
  s_waitcnt vmcnt(4)
  ds_read_b64_tr_b16 a[192:193], v9 offset:0
  ds_read_b64_tr_b16 a[194:195], v9 offset:128
  ds_read_b128 a[212:215], v10 offset:0
  ds_read_b64_tr_b16 a[196:197], v9 offset:1024
  ds_read_b64_tr_b16 a[198:199], v9 offset:1152
  ds_read_b128 a[216:219], v10 offset:512
  ds_read_b64_tr_b16 a[200:201], v9 offset:2048
  ds_read_b64_tr_b16 a[202:203], v9 offset:2176
  ds_read_b128 a[220:223], v10 offset:1024
  ds_read_b64_tr_b16 a[204:205], v9 offset:3072
  ds_read_b64_tr_b16 a[206:207], v9 offset:3200
  ds_read_b128 a[224:227], v10 offset:1536
  ds_read_b64_tr_b16 a[208:209], v9 offset:4096
  ds_read_b64_tr_b16 a[210:211], v9 offset:4224
  ds_read_b128 a[228:231], v10 offset:2048
  v_add_u32 v10, 2560, v10
  s_add_u32 s33, s33, 552960
  s_sub_u32 s14, s14, 1
  s_cmp_lg_u32 s14, 0
  s_cbranch_scc1 fa_coG
  v_accvgpr_read_b32 v8, a248
  v_accvgpr_read_b32 v11, a249
  v_accvgpr_read_b32 v12, a250
  v_accvgpr_read_b32 v13, a251
  v_accvgpr_read_b32 v14, a252
  v_subrev_u32 v11, 1024, v11
  v_subrev_u32 v12, 2048, v12
  v_subrev_u32 v13, 3072, v13
  s_mov_b32 s52, s60
  s_mov_b32 s53, s61
  s_mov_b32 s33, s35
  s_lshl_b32 s23, s20, 9
  v_add_u32 v16, s23, v10
  v_and_b32 v17, 7, v1
  v_mul_u32_u24 v9, 2560, v17
  v_lshrrev_b32 v17, 4, v1
  v_lshl_add_u32 v9, v17, 4, v9
  v_and_b32 v17, 8, v1
  v_lshl_add_u32 v9, v17, 27, v9
  s_waitcnt lgkmcnt(0)
  v_mfma_f32_16x16x32_bf16 v[232:235], a[192:195], a[212:215], v[232:235]
  v_mfma_f32_16x16x32_bf16 v[232:235], a[196:199], a[216:219], v[232:235]
  v_mfma_f32_16x16x32_bf16 v[232:235], a[200:203], a[220:223], v[232:235]
  v_mfma_f32_16x16x32_bf16 v[232:235], a[204:207], a[224:227], v[232:235]
  v_mfma_f32_16x16x32_bf16 v[232:235], a[208:211], a[228:231], v[232:235]
  s_nop 7
  ds_write_b128 v16, v[232:235]
  s_getpc_b64 s[36:37]
  s_setpc_b64 s[38:39]
  ds_read_b128 v[236:239], v10 offset:0
  ds_read_b128 v[240:243], v10 offset:512
  ds_read_b128 v[244:247], v10 offset:1024
  ds_read_b128 v[248:251], v10 offset:1536
  s_waitcnt vmcnt(4)
  ds_read_b64_tr_b16 a[192:193], v6 offset:0
  ds_read_b64_tr_b16 a[194:195], v6 offset:2560
  ds_read_b64_tr_b16 a[196:197], v6 offset:32
  ds_read_b64_tr_b16 a[198:199], v6 offset:2592
  ds_read_b64_tr_b16 a[200:201], v6 offset:64
  ds_read_b64_tr_b16 a[202:203], v6 offset:2624
  ds_read_b64_tr_b16 a[204:205], v6 offset:96
  ds_read_b64_tr_b16 a[206:207], v6 offset:2656
  ds_read_b64_tr_b16 a[208:209], v6 offset:128
  ds_read_b64_tr_b16 a[210:211], v6 offset:2688
  s_add_u32 s33, s33, 160
  s_mov_b32 s8, 0
  s_waitcnt lgkmcnt(10)
  v_cvt_pk_bf16_f32 v236, v236, v244
  v_cvt_pk_bf16_f32 v237, v237, v245
  v_cvt_pk_bf16_f32 v238, v238, v246
  v_cvt_pk_bf16_f32 v239, v239, v247
  v_cvt_pk_bf16_f32 v240, v240, v248
  v_cvt_pk_bf16_f32 v241, v241, v249
  v_cvt_pk_bf16_f32 v242, v242, v250
  v_cvt_pk_bf16_f32 v243, v243, v251
  v_lshlrev_b32 v244, 16, v236
  v_lshlrev_b32 v245, 16, v237
  v_lshlrev_b32 v246, 16, v238
  v_lshlrev_b32 v247, 16, v239
  v_lshlrev_b32 v248, 16, v240
  v_lshlrev_b32 v249, 16, v241
  v_lshlrev_b32 v250, 16, v242
  v_lshlrev_b32 v251, 16, v243
  v_mul_f32 v16, 0xbfb8aa3b, v244
  v_mul_f32 v17, 0xbfb8aa3b, v245
  v_mul_f32 v18, 0xbfb8aa3b, v246
  v_mul_f32 v19, 0xbfb8aa3b, v247
  v_mul_f32 v20, 0xbfb8aa3b, v248
  v_mul_f32 v21, 0xbfb8aa3b, v249
  v_mul_f32 v22, 0xbfb8aa3b, v250
  v_mul_f32 v23, 0xbfb8aa3b, v251
  v_exp_f32 v16, v16
  v_exp_f32 v17, v17
  v_exp_f32 v18, v18
  v_exp_f32 v19, v19
  v_exp_f32 v20, v20
  v_exp_f32 v21, v21
  v_exp_f32 v22, v22
  v_exp_f32 v23, v23
  v_add_f32 v16, 1.0, v16
  v_add_f32 v17, 1.0, v17
  v_add_f32 v18, 1.0, v18
  v_add_f32 v19, 1.0, v19
  v_add_f32 v20, 1.0, v20
  v_add_f32 v21, 1.0, v21
  v_add_f32 v22, 1.0, v22
  v_add_f32 v23, 1.0, v23
  v_rcp_f32 v16, v16
  v_rcp_f32 v17, v17
  v_rcp_f32 v18, v18
  v_rcp_f32 v19, v19
  v_rcp_f32 v20, v20
  v_rcp_f32 v21, v21
  v_rcp_f32 v22, v22
  v_rcp_f32 v23, v23
  v_and_b32 v236, 0xffff0000, v236
  v_and_b32 v237, 0xffff0000, v237
  v_and_b32 v238, 0xffff0000, v238
  v_and_b32 v239, 0xffff0000, v239
  v_and_b32 v240, 0xffff0000, v240
  v_and_b32 v241, 0xffff0000, v241
  v_and_b32 v242, 0xffff0000, v242
  v_and_b32 v243, 0xffff0000, v243
  v_pk_mul_f32 v[244:245], v[244:245], v[16:17]
  v_pk_mul_f32 v[246:247], v[246:247], v[18:19]
  v_pk_mul_f32 v[248:249], v[248:249], v[20:21]
  v_pk_mul_f32 v[250:251], v[250:251], v[22:23]
  v_cvt_pk_bf16_f32 v16, v244, v245
  v_cvt_pk_bf16_f32 v17, v246, v247
  v_cvt_pk_bf16_f32 v18, v248, v249
  v_cvt_pk_bf16_f32 v19, v250, v251
  v_lshlrev_b32 v244, 16, v16
  v_and_b32 v245, 0xffff0000, v16
  v_lshlrev_b32 v246, 16, v17
  v_and_b32 v247, 0xffff0000, v17
  v_lshlrev_b32 v248, 16, v18
  v_and_b32 v249, 0xffff0000, v18
  v_lshlrev_b32 v250, 16, v19
  v_and_b32 v251, 0xffff0000, v19
  v_pk_mul_f32 v[236:237], v[236:237], v[244:245]
  v_pk_mul_f32 v[238:239], v[238:239], v[246:247]
  v_pk_mul_f32 v[240:241], v[240:241], v[248:249]
  v_pk_mul_f32 v[242:243], v[242:243], v[250:251]
  v_cvt_pk_bf16_f32 v232, v236, v237
  v_cvt_pk_bf16_f32 v233, v238, v239
  v_cvt_pk_bf16_f32 v234, v240, v241
  v_cvt_pk_bf16_f32 v235, v242, v243
  s_nop 0
  s_waitcnt lgkmcnt(0)
  v_mfma_f32_16x16x32_bf16 v[236:239], a[192:195], v[232:235], 0
  v_mfma_f32_16x16x32_bf16 v[240:243], a[196:199], v[232:235], 0
  v_mfma_f32_16x16x32_bf16 v[244:247], a[200:203], v[232:235], 0
  v_mfma_f32_16x16x32_bf16 v[248:251], a[204:207], v[232:235], 0
  v_mfma_f32_16x16x32_bf16 v[252:255], a[208:211], v[232:235], 0
  s_nop 3
  buffer_store_dwordx4 v[236:239], v9, s[40:43], s10 offen offset:0 sc1
  buffer_store_dwordx4 v[240:243], v9, s[40:43], s10 offen offset:64 sc1
  buffer_store_dwordx4 v[244:247], v9, s[40:43], s10 offen offset:128 sc1
  buffer_store_dwordx4 v[248:251], v9, s[40:43], s10 offen offset:192 sc1
  buffer_store_dwordx4 v[252:255], v9, s[40:43], s10 offen offset:256 sc1
  s_add_u32 s10, s10, 320
  s_getpc_b64 s[36:37]
  s_setpc_b64 s[38:39]
  s_waitcnt vmcnt(4)
  ds_read_b64_tr_b16 a[192:193], v6 offset:0
  ds_read_b64_tr_b16 a[194:195], v6 offset:2560
  ds_read_b64_tr_b16 a[196:197], v6 offset:32
  ds_read_b64_tr_b16 a[198:199], v6 offset:2592
  ds_read_b64_tr_b16 a[200:201], v6 offset:64
  ds_read_b64_tr_b16 a[202:203], v6 offset:2624
  ds_read_b64_tr_b16 a[204:205], v6 offset:96
  ds_read_b64_tr_b16 a[206:207], v6 offset:2656
  ds_read_b64_tr_b16 a[208:209], v6 offset:128
  ds_read_b64_tr_b16 a[210:211], v6 offset:2688
  s_waitcnt lgkmcnt(0)
  v_mfma_f32_16x16x32_bf16 v[236:239], a[192:195], v[232:235], 0
  v_mfma_f32_16x16x32_bf16 v[240:243], a[196:199], v[232:235], 0
  v_mfma_f32_16x16x32_bf16 v[244:247], a[200:203], v[232:235], 0
  v_mfma_f32_16x16x32_bf16 v[248:251], a[204:207], v[232:235], 0
  v_mfma_f32_16x16x32_bf16 v[252:255], a[208:211], v[232:235], 0
  s_nop 3
  buffer_store_dwordx4 v[236:239], v9, s[40:43], s10 offen offset:0 sc1
  buffer_store_dwordx4 v[240:243], v9, s[40:43], s10 offen offset:64 sc1
  buffer_store_dwordx4 v[244:247], v9, s[40:43], s10 offen offset:128 sc1
  buffer_store_dwordx4 v[248:251], v9, s[40:43], s10 offen offset:192 sc1
  buffer_store_dwordx4 v[252:255], v9, s[40:43], s10 offen offset:256 sc1
  s_add_u32 s10, s10, 320
  s_getpc_b64 s[36:37]
  s_setpc_b64 s[38:39]
  s_sub_u32 s23, s2, 170
  s_lshl_b32 s31, s20, 6
  s_add_u32 s23, s23, s31
  s_lshl_b32 s23, s23, 2
  s_add_u32 s23, s23, 2650112
  s_waitcnt vmcnt(8)
  buffer_store_dword v4, off, s[40:43], s23 sc1
fa_coW:
  s_mov_b32 s12, 1
  s_mov_b32 s9, -1
  s_cmp_lg_u32 s11, 0
  s_cselect_b32 s32, s15, -1
  s_getpc_b64 s[36:37]
  s_setpc_b64 s[38:39]
  s_lshl_b32 s23, s22, 2
  s_add_u32 s23, s23, s20
  s_mul_i32 s13, s23, 163840
  s_add_u32 s13, s13, 4194304
  s_lshl_b32 s23, s23, 7
  s_add_u32 s23, s23, 2654208
  v_and_b32 v9, 31, v1
  v_lshl_add_u32 v9, v9, 2, s23
  v_and_b32 v10, 15, v1
  v_lshlrev_b32 v10, 2, v10
  v_add_u32 v10, 2629632, v10
  buffer_load_dword v8, v9, s[40:43], 0 offen sc1
  buffer_load_dword v15, v10, s[40:43], 0 offen sc1
  v_mov_b32 v20, v228
  v_mov_b32 v21, v229
  s_nop 1
  v_permlane16_swap_b32 v228, v20
  v_permlane16_swap_b32 v229, v21
  v_add_f32 v228, v228, v20
  v_add_f32 v229, v229, v21
  v_mov_b32 v20, v228
  v_mov_b32 v21, v229
  s_nop 1
  v_permlane32_swap_b32 v228, v20
  v_permlane32_swap_b32 v229, v21
  v_add_f32 v228, v228, v20
  v_add_f32 v229, v229, v21
  v_rcp_f32 v16, v228
  v_rcp_f32 v18, v229
  s_lshl_b32 s23, s22, 2
  v_mov_b32 v17, v16
  v_mov_b32 v19, v18
  s_add_u32 s23, s23, s20
  s_lshl_b32 s23, s23, 18
  s_lshl_b32 s31, s21, 12
  s_add_u32 s31, s31, 50331648
  s_add_u32 s64, s23, s31
  s_add_u32 s65, s64, 131072
  v_accvgpr_read_b32 v36, a0
  v_accvgpr_read_b32 v37, a1
  v_accvgpr_read_b32 v38, a2
  v_accvgpr_read_b32 v39, a3
  v_accvgpr_read_b32 v40, a8
  v_accvgpr_read_b32 v41, a9
  v_accvgpr_read_b32 v42, a10
  v_accvgpr_read_b32 v43, a11
  v_pk_mul_f32 v[36:37], v[36:37], v[16:17]
  v_pk_mul_f32 v[38:39], v[38:39], v[16:17]
  v_pk_mul_f32 v[40:41], v[40:41], v[16:17]
  v_pk_mul_f32 v[42:43], v[42:43], v[16:17]
  v_cvt_pk_bf16_f32 v32, v36, v37
  v_cvt_pk_bf16_f32 v33, v38, v39
  v_cvt_pk_bf16_f32 v34, v40, v41
  v_cvt_pk_bf16_f32 v35, v42, v43
  buffer_store_dwordx4 v[32:35], v2, s[40:43], s64 offen offset:0 sc1
  v_accvgpr_read_b32 v48, a16
  v_accvgpr_read_b32 v49, a17
  v_accvgpr_read_b32 v50, a18
  v_accvgpr_read_b32 v51, a19
  v_accvgpr_read_b32 v52, a24
  v_accvgpr_read_b32 v53, a25
  v_accvgpr_read_b32 v54, a26
  v_accvgpr_read_b32 v55, a27
  v_pk_mul_f32 v[48:49], v[48:49], v[16:17]
  v_pk_mul_f32 v[50:51], v[50:51], v[16:17]
  v_pk_mul_f32 v[52:53], v[52:53], v[16:17]
  v_pk_mul_f32 v[54:55], v[54:55], v[16:17]
  v_cvt_pk_bf16_f32 v44, v48, v49
  v_cvt_pk_bf16_f32 v45, v50, v51
  v_cvt_pk_bf16_f32 v46, v52, v53
  v_cvt_pk_bf16_f32 v47, v54, v55
  buffer_store_dwordx4 v[44:47], v2, s[40:43], s64 offen offset:1024 sc1
  v_accvgpr_read_b32 v100, a32
  v_accvgpr_read_b32 v101, a33
  v_accvgpr_read_b32 v102, a34
  v_accvgpr_read_b32 v103, a35
  v_accvgpr_read_b32 v104, a40
  v_accvgpr_read_b32 v105, a41
  v_accvgpr_read_b32 v106, a42
  v_accvgpr_read_b32 v107, a43
  v_pk_mul_f32 v[100:101], v[100:101], v[16:17]
  v_pk_mul_f32 v[102:103], v[102:103], v[16:17]
  v_pk_mul_f32 v[104:105], v[104:105], v[16:17]
  v_pk_mul_f32 v[106:107], v[106:107], v[16:17]
  v_cvt_pk_bf16_f32 v96, v100, v101
  v_cvt_pk_bf16_f32 v97, v102, v103
  v_cvt_pk_bf16_f32 v98, v104, v105
  v_cvt_pk_bf16_f32 v99, v106, v107
  buffer_store_dwordx4 v[96:99], v2, s[40:43], s64 offen offset:2048 sc1
  v_accvgpr_read_b32 v112, a48
  v_accvgpr_read_b32 v113, a49
  v_accvgpr_read_b32 v114, a50
  v_accvgpr_read_b32 v115, a51
  v_accvgpr_read_b32 v116, a56
  v_accvgpr_read_b32 v117, a57
  v_accvgpr_read_b32 v118, a58
  v_accvgpr_read_b32 v119, a59
  v_pk_mul_f32 v[112:113], v[112:113], v[16:17]
  v_pk_mul_f32 v[114:115], v[114:115], v[16:17]
  v_pk_mul_f32 v[116:117], v[116:117], v[16:17]
  v_pk_mul_f32 v[118:119], v[118:119], v[16:17]
  v_cvt_pk_bf16_f32 v108, v112, v113
  v_cvt_pk_bf16_f32 v109, v114, v115
  v_cvt_pk_bf16_f32 v110, v116, v117
  v_cvt_pk_bf16_f32 v111, v118, v119
  buffer_store_dwordx4 v[108:111], v2, s[40:43], s64 offen offset:3072 sc1
  v_accvgpr_read_b32 v36, a4
  v_accvgpr_read_b32 v37, a5
  v_accvgpr_read_b32 v38, a6
  v_accvgpr_read_b32 v39, a7
  v_accvgpr_read_b32 v40, a12
  v_accvgpr_read_b32 v41, a13
  v_accvgpr_read_b32 v42, a14
  v_accvgpr_read_b32 v43, a15
  v_pk_mul_f32 v[36:37], v[36:37], v[18:19]
  v_pk_mul_f32 v[38:39], v[38:39], v[18:19]
  v_pk_mul_f32 v[40:41], v[40:41], v[18:19]
  v_pk_mul_f32 v[42:43], v[42:43], v[18:19]
  v_cvt_pk_bf16_f32 v32, v36, v37
  v_cvt_pk_bf16_f32 v33, v38, v39
  v_cvt_pk_bf16_f32 v34, v40, v41
  v_cvt_pk_bf16_f32 v35, v42, v43
  buffer_store_dwordx4 v[32:35], v2, s[40:43], s65 offen offset:0 sc1
  v_accvgpr_read_b32 v48, a20
  v_accvgpr_read_b32 v49, a21
  v_accvgpr_read_b32 v50, a22
  v_accvgpr_read_b32 v51, a23
  v_accvgpr_read_b32 v52, a28
  v_accvgpr_read_b32 v53, a29
  v_accvgpr_read_b32 v54, a30
  v_accvgpr_read_b32 v55, a31
  v_pk_mul_f32 v[48:49], v[48:49], v[18:19]
  v_pk_mul_f32 v[50:51], v[50:51], v[18:19]
  v_pk_mul_f32 v[52:53], v[52:53], v[18:19]
  v_pk_mul_f32 v[54:55], v[54:55], v[18:19]
  v_cvt_pk_bf16_f32 v44, v48, v49
  v_cvt_pk_bf16_f32 v45, v50, v51
  v_cvt_pk_bf16_f32 v46, v52, v53
  v_cvt_pk_bf16_f32 v47, v54, v55
  buffer_store_dwordx4 v[44:47], v2, s[40:43], s65 offen offset:1024 sc1
  v_accvgpr_read_b32 v100, a36
  v_accvgpr_read_b32 v101, a37
  v_accvgpr_read_b32 v102, a38
  v_accvgpr_read_b32 v103, a39
  v_accvgpr_read_b32 v104, a44
  v_accvgpr_read_b32 v105, a45
  v_accvgpr_read_b32 v106, a46
  v_accvgpr_read_b32 v107, a47
  v_pk_mul_f32 v[100:101], v[100:101], v[18:19]
  v_pk_mul_f32 v[102:103], v[102:103], v[18:19]
  v_pk_mul_f32 v[104:105], v[104:105], v[18:19]
  v_pk_mul_f32 v[106:107], v[106:107], v[18:19]
  v_cvt_pk_bf16_f32 v96, v100, v101
  v_cvt_pk_bf16_f32 v97, v102, v103
  v_cvt_pk_bf16_f32 v98, v104, v105
  v_cvt_pk_bf16_f32 v99, v106, v107
  buffer_store_dwordx4 v[96:99], v2, s[40:43], s65 offen offset:2048 sc1
  v_accvgpr_read_b32 v112, a52
  v_accvgpr_read_b32 v113, a53
  v_accvgpr_read_b32 v114, a54
  v_accvgpr_read_b32 v115, a55
  v_accvgpr_read_b32 v116, a60
  v_accvgpr_read_b32 v117, a61
  v_accvgpr_read_b32 v118, a62
  v_accvgpr_read_b32 v119, a63
  v_pk_mul_f32 v[112:113], v[112:113], v[18:19]
  v_pk_mul_f32 v[114:115], v[114:115], v[18:19]
  v_pk_mul_f32 v[116:117], v[116:117], v[18:19]
  v_pk_mul_f32 v[118:119], v[118:119], v[18:19]
  v_cvt_pk_bf16_f32 v108, v112, v113
  v_cvt_pk_bf16_f32 v109, v114, v115
  v_cvt_pk_bf16_f32 v110, v116, v117
  v_cvt_pk_bf16_f32 v111, v118, v119
  buffer_store_dwordx4 v[108:111], v2, s[40:43], s65 offen offset:3072 sc1
  s_waitcnt vmcnt(8)
  v_cmp_eq_u32 vcc, 0, v8
  s_cbranch_vccnz fa_wof_spin
fa_wof_ok:
  v_cmp_eq_u32 vcc, 0, v15
  s_cbranch_vccnz fa_sel4_spin
fa_sel4_ok:
  s_lshl_b32 s31, s21, 6
  s_add_u32 s31, s31, 1
  v_subrev_u32 v16, s31, v15
  v_cmp_gt_u32 vcc, 64, v16
  s_cmp_lt_u32 s20, 2
  s_cselect_b32 s23, 0xff, 0
  s_and_b32 s10, vcc_lo, s23
  s_sub_u32 s23, s10, 1
  s_and_b32 s23, s23, s10
  s_cmp_eq_u32 s20, 1
  s_cselect_b32 s10, s23, s10
  s_cmp_eq_u32 s10, 0
  s_cbranch_scc1 fa_coEnd
  v_min_u32 v11, 53, v1
  s_lshr_b32 s23, s22, 1
  s_lshl_b32 s23, s23, 8
  s_add_u32 s23, s23, 2650112
  v_lshl_add_u32 v11, v11, 2, s23
  buffer_load_dword v14, v11, s[40:43], 0 offen sc1
  v_mul_u32_u24 v16, 3277, v1
  v_lshrrev_b32 v16, 16, v16
  v_mul_u32_u24 v8, 20, v16
  v_sub_u32 v8, v1, v8
  v_lshlrev_b32 v8, 4, v8
  v_mul_u32_u24 v9, 368640, v16
  v_add_u32 v9, v9, v8
  v_cmp_gt_u32 vcc, 3, v16
  v_mov_b32 v19, 1073741824
  s_nop 0
  v_cndmask_b32 v9, v19, v9, vcc
  s_mov_b32 s12, 2
  s_mov_b32 s32, -1
  s_mov_b32 s11, 0
  s_getpc_b64 s[36:37]
  s_setpc_b64 s[38:39]
  v_cmp_eq_u32 vcc, 0, v14
  s_cbranch_vccnz fa_yf_spin
fa_yf_ok:
fa_coY:
  s_ff1_i32_b32 s33, s10
  s_bitset0_b32 s10, s33
  s_sub_u32 s23, s10, 1
  s_and_b32 s10, s10, s23
  s_mul_i32 s14, s33, 2560
  s_mul_i32 s23, s22, 320
  s_add_u32 s14, s14, s23
  s_add_u32 s14, s14, 2686976
  buffer_load_dwordx4 v[64:67], v9, s[40:43], s14 offen sc1
  s_add_u32 s14, s14, 20480
  buffer_load_dwordx4 v[68:71], v9, s[40:43], s14 offen sc1
  s_add_u32 s14, s14, 20480
  buffer_load_dwordx4 v[72:75], v9, s[40:43], s14 offen sc1
  s_add_u32 s14, s14, 20480
  buffer_load_dwordx4 v[76:79], v9, s[40:43], s14 offen sc1
  s_add_u32 s14, s14, 20480
  buffer_load_dwordx4 v[80:83], v9, s[40:43], s14 offen sc1
  s_add_u32 s14, s14, 20480
  buffer_load_dwordx4 v[84:87], v9, s[40:43], s14 offen sc1
  s_add_u32 s14, s14, 20480
  buffer_load_dwordx4 v[88:91], v9, s[40:43], s14 offen sc1
  s_add_u32 s14, s14, 20480
  buffer_load_dwordx4 v[92:95], v9, s[40:43], s14 offen sc1
  s_add_u32 s14, s14, 20480
  buffer_load_dwordx4 v[128:131], v9, s[40:43], s14 offen sc1
  s_add_u32 s14, s14, 20480
  buffer_load_dwordx4 v[132:135], v9, s[40:43], s14 offen sc1
  s_add_u32 s14, s14, 20480
  buffer_load_dwordx4 v[136:139], v9, s[40:43], s14 offen sc1
  s_add_u32 s14, s14, 20480
  buffer_load_dwordx4 v[140:143], v9, s[40:43], s14 offen sc1
  s_add_u32 s14, s14, 20480
  buffer_load_dwordx4 v[144:147], v9, s[40:43], s14 offen sc1
  s_add_u32 s14, s14, 20480
  buffer_load_dwordx4 v[148:151], v9, s[40:43], s14 offen sc1
  s_add_u32 s14, s14, 20480
  buffer_load_dwordx4 v[152:155], v9, s[40:43], s14 offen sc1
  s_add_u32 s14, s14, 20480
  buffer_load_dwordx4 v[156:159], v9, s[40:43], s14 offen sc1
  s_add_u32 s14, s14, 20480
  buffer_load_dwordx4 v[176:179], v9, s[40:43], s14 offen sc1
  s_add_u32 s14, s14, 20480
  buffer_load_dwordx4 v[180:183], v9, s[40:43], s14 offen sc1
  s_add_u32 s14, s14, 20480
  s_lshl_b32 s14, s20, 10
  s_add_u32 s14, s14, 159744
  v_add_u32 v19, s14, v2
  s_add_u32 s23, s33, 8
  v_readlane_b32 s35, v15, s23
  s_waitcnt vmcnt(0)
  v_pk_add_f32 v[64:65], v[64:65], v[68:69]
  v_pk_add_f32 v[66:67], v[66:67], v[70:71]
  v_pk_add_f32 v[64:65], v[64:65], v[72:73]
  v_pk_add_f32 v[66:67], v[66:67], v[74:75]
  v_pk_add_f32 v[64:65], v[64:65], v[76:77]
  v_pk_add_f32 v[66:67], v[66:67], v[78:79]
  v_pk_add_f32 v[64:65], v[64:65], v[80:81]
  v_pk_add_f32 v[66:67], v[66:67], v[82:83]
  v_pk_add_f32 v[64:65], v[64:65], v[84:85]
  v_pk_add_f32 v[66:67], v[66:67], v[86:87]
  v_pk_add_f32 v[64:65], v[64:65], v[88:89]
  v_pk_add_f32 v[66:67], v[66:67], v[90:91]
  v_pk_add_f32 v[64:65], v[64:65], v[92:93]
  v_pk_add_f32 v[66:67], v[66:67], v[94:95]
  v_pk_add_f32 v[64:65], v[64:65], v[128:129]
  v_pk_add_f32 v[66:67], v[66:67], v[130:131]
  v_pk_add_f32 v[64:65], v[64:65], v[132:133]
  v_pk_add_f32 v[66:67], v[66:67], v[134:135]
  v_pk_add_f32 v[64:65], v[64:65], v[136:137]
  v_pk_add_f32 v[66:67], v[66:67], v[138:139]
  v_pk_add_f32 v[64:65], v[64:65], v[140:141]
  v_pk_add_f32 v[66:67], v[66:67], v[142:143]
  v_pk_add_f32 v[64:65], v[64:65], v[144:145]
  v_pk_add_f32 v[66:67], v[66:67], v[146:147]
  v_pk_add_f32 v[64:65], v[64:65], v[148:149]
  v_pk_add_f32 v[66:67], v[66:67], v[150:151]
  v_pk_add_f32 v[64:65], v[64:65], v[152:153]
  v_pk_add_f32 v[66:67], v[66:67], v[154:155]
  v_pk_add_f32 v[64:65], v[64:65], v[156:157]
  v_pk_add_f32 v[66:67], v[66:67], v[158:159]
  v_pk_add_f32 v[64:65], v[64:65], v[176:177]
  v_pk_add_f32 v[66:67], v[66:67], v[178:179]
  v_pk_add_f32 v[64:65], v[64:65], v[180:181]
  v_pk_add_f32 v[66:67], v[66:67], v[182:183]
  ds_write_b128 v19, v[64:67]
  v_add_u32 v19, s14, v8
  s_and_b32 s35, s35, 0xffff0000
  s_waitcnt lgkmcnt(0)
  ds_read_b128 v[64:67], v19
  ds_read_b128 v[68:71], v19 offset:320
  ds_read_b128 v[72:75], v19 offset:640
  s_mul_i32 s14, s33, 320
  s_add_u32 s14, s14, 155648
  v_add_u32 v19, s14, v8
  s_waitcnt lgkmcnt(0)
  v_add_f32 v64, v64, v68
  v_add_f32 v64, v64, v72
  v_cvt_pk_bf16_f32 v64, v64, v64
  v_and_b32 v64, 0xffff0000, v64
  v_mul_f32 v64, s35, v64
  v_cvt_pk_bf16_f32 v64, v64, v64
  v_and_b32 v64, 0xffff0000, v64
  v_add_f32 v65, v65, v69
  v_add_f32 v65, v65, v73
  v_cvt_pk_bf16_f32 v65, v65, v65
  v_and_b32 v65, 0xffff0000, v65
  v_mul_f32 v65, s35, v65
  v_cvt_pk_bf16_f32 v65, v65, v65
  v_and_b32 v65, 0xffff0000, v65
  v_add_f32 v66, v66, v70
  v_add_f32 v66, v66, v74
  v_cvt_pk_bf16_f32 v66, v66, v66
  v_and_b32 v66, 0xffff0000, v66
  v_mul_f32 v66, s35, v66
  v_cvt_pk_bf16_f32 v66, v66, v66
  v_and_b32 v66, 0xffff0000, v66
  v_add_f32 v67, v67, v71
  v_add_f32 v67, v67, v75
  v_cvt_pk_bf16_f32 v67, v67, v67
  v_and_b32 v67, 0xffff0000, v67
  v_mul_f32 v67, s35, v67
  v_cvt_pk_bf16_f32 v67, v67, v67
  v_and_b32 v67, 0xffff0000, v67
  ds_write_b128 v19, v[64:67]
  s_waitcnt lgkmcnt(0)
  s_cmp_lg_u32 s10, 0
  s_cbranch_scc1 fa_coY
fa_coEnd:
  s_mov_b32 s12, 3
  s_mov_b32 s32, -1
  s_setpc_b64 s[38:39]
fa_hk7:
  s_getpc_b64 s[38:39]
fa_hp7:
  s_add_u32 s36, s36, 4
  s_addc_u32 s37, s37, 0
  s_sub_u32 s38, s38, fa_hp7-fa_hb7
  s_subb_u32 s39, s39, 0
  s_setpc_b64 s[36:37]
fa_hk8:
  s_getpc_b64 s[38:39]
fa_hp8:
  s_add_u32 s36, s36, 4
  s_addc_u32 s37, s37, 0
  s_sub_u32 s38, s38, fa_hp8-fa_hb8
  s_subb_u32 s39, s39, 0
  s_setpc_b64 s[36:37]
fa_disp:
  s_cmp_eq_u32 s29, 7
  s_cbranch_scc1 fa_SSW7
  s_cmp_eq_u32 s29, 6
  s_cbranch_scc1 fa_SSW6
  s_cmp_eq_u32 s29, 5
  s_cbranch_scc1 fa_SSW5
  s_cmp_eq_u32 s29, 4
  s_cbranch_scc1 fa_SSW4
  s_cmp_eq_u32 s29, 3
  s_cbranch_scc1 fa_SSW3
  s_cmp_eq_u32 s29, 2
  s_cbranch_scc1 fa_SSW2
  s_cmp_eq_u32 s29, 1
  s_cbranch_scc1 fa_SSW1
  s_branch fa_Bexit
fa_hk9:
  s_getpc_b64 s[38:39]
fa_hp9:
  s_add_u32 s36, s36, 4
  s_addc_u32 s37, s37, 0
  s_add_u32 s38, s38, fa_hb9-fa_hp9
  s_addc_u32 s39, s39, 0
  s_setpc_b64 s[36:37]
fa_puby:
  s_waitcnt vmcnt(0)
  buffer_store_dword v4, v30, s[40:43], 0 offen sc1
  s_cmp_lt_u32 s12, 3
  s_cbranch_scc1 fa_hk9
fa_hb9:
  s_add_u32 s14, s13, 61440
  buffer_load_dwordx4 v[64:67], v2, s[40:43], s14 offen offset:0 sc1
  buffer_load_dwordx4 v[68:71], v2, s[40:43], s14 offen offset:1024 sc1
  buffer_load_dwordx4 v[72:75], v2, s[40:43], s14 offen offset:2048 sc1
  buffer_load_dwordx4 v[76:79], v2, s[40:43], s14 offen offset:3072 sc1
  s_add_u32 s14, s13, 65536
  buffer_load_dwordx4 v[80:83], v2, s[40:43], s14 offen offset:0 sc1
  buffer_load_dwordx4 v[84:87], v2, s[40:43], s14 offen offset:1024 sc1
  buffer_load_dwordx4 v[88:91], v2, s[40:43], s14 offen offset:2048 sc1
  buffer_load_dwordx4 v[92:95], v2, s[40:43], s14 offen offset:3072 sc1
  s_branch fa_pubb
fa_left:
  s_add_u32 s14, s13, 0
  buffer_load_dwordx4 a[0:3], v2, s[40:43], s14 offen offset:0 sc1
  buffer_load_dwordx4 a[4:7], v2, s[40:43], s14 offen offset:1024 sc1
  buffer_load_dwordx4 a[8:11], v2, s[40:43], s14 offen offset:2048 sc1
  buffer_load_dwordx4 a[12:15], v2, s[40:43], s14 offen offset:3072 sc1
  s_add_u32 s14, s13, 4096
  buffer_load_dwordx4 a[16:19], v2, s[40:43], s14 offen offset:0 sc1
  buffer_load_dwordx4 a[20:23], v2, s[40:43], s14 offen offset:1024 sc1
  s_cmp_ge_u32 s29, 7
  s_cbranch_scc1 fa_leftb
  s_add_u32 s14, s13, 4096
  buffer_load_dwordx4 a[24:27], v2, s[40:43], s14 offen offset:2048 sc1
  buffer_load_dwordx4 a[28:31], v2, s[40:43], s14 offen offset:3072 sc1
  s_add_u32 s14, s13, 8192
  buffer_load_dwordx4 a[32:35], v2, s[40:43], s14 offen offset:0 sc1
  buffer_load_dwordx4 a[36:39], v2, s[40:43], s14 offen offset:1024 sc1
  buffer_load_dwordx4 a[40:43], v2, s[40:43], s14 offen offset:2048 sc1
  buffer_load_dwordx4 a[44:47], v2, s[40:43], s14 offen offset:3072 sc1
  s_cmp_ge_u32 s29, 6
  s_cbranch_scc1 fa_leftb
  s_add_u32 s14, s13, 12288
  buffer_load_dwordx4 a[48:51], v2, s[40:43], s14 offen offset:0 sc1
  buffer_load_dwordx4 a[52:55], v2, s[40:43], s14 offen offset:1024 sc1
  buffer_load_dwordx4 a[56:59], v2, s[40:43], s14 offen offset:2048 sc1
  buffer_load_dwordx4 a[60:63], v2, s[40:43], s14 offen offset:3072 sc1
  s_add_u32 s14, s13, 16384
  buffer_load_dwordx4 a[192:195], v2, s[40:43], s14 offen offset:0 sc1
  buffer_load_dwordx4 a[196:199], v2, s[40:43], s14 offen offset:1024 sc1
  s_cmp_ge_u32 s29, 5
  s_cbranch_scc1 fa_leftb
  s_add_u32 s14, s13, 16384
  buffer_load_dwordx4 a[200:203], v2, s[40:43], s14 offen offset:2048 sc1
  buffer_load_dwordx4 a[204:207], v2, s[40:43], s14 offen offset:3072 sc1
  s_add_u32 s14, s13, 20480
  buffer_load_dwordx4 a[208:211], v2, s[40:43], s14 offen offset:0 sc1
  buffer_load_dwordx4 a[212:215], v2, s[40:43], s14 offen offset:1024 sc1
  buffer_load_dwordx4 a[216:219], v2, s[40:43], s14 offen offset:2048 sc1
  buffer_load_dwordx4 a[220:223], v2, s[40:43], s14 offen offset:3072 sc1
  s_cmp_ge_u32 s29, 4
  s_cbranch_scc1 fa_leftb
  s_add_u32 s14, s13, 24576
  buffer_load_dwordx4 a[224:227], v2, s[40:43], s14 offen offset:0 sc1
  buffer_load_dwordx4 a[228:231], v2, s[40:43], s14 offen offset:1024 sc1
  buffer_load_dwordx4 a[232:235], v2, s[40:43], s14 offen offset:2048 sc1
  buffer_load_dwordx4 a[236:239], v2, s[40:43], s14 offen offset:3072 sc1
  s_add_u32 s14, s13, 28672
  buffer_load_dwordx4 a[240:243], v2, s[40:43], s14 offen offset:0 sc1
  buffer_load_dwordx4 a[244:247], v2, s[40:43], s14 offen offset:1024 sc1
  s_cmp_ge_u32 s29, 3
  s_cbranch_scc1 fa_leftb
  s_add_u32 s14, s13, 28672
  buffer_load_dwordx4 a[248:251], v2, s[40:43], s14 offen offset:2048 sc1
  buffer_load_dwordx4 a[252:255], v2, s[40:43], s14 offen offset:3072 sc1
  s_add_u32 s14, s13, 32768
  buffer_load_dwordx4 v[32:35], v2, s[40:43], s14 offen offset:0 sc1
  buffer_load_dwordx4 v[36:39], v2, s[40:43], s14 offen offset:1024 sc1
  buffer_load_dwordx4 v[40:43], v2, s[40:43], s14 offen offset:2048 sc1
  buffer_load_dwordx4 v[44:47], v2, s[40:43], s14 offen offset:3072 sc1
  s_cmp_ge_u32 s29, 2
  s_cbranch_scc1 fa_leftb
  s_add_u32 s14, s13, 36864
  buffer_load_dwordx4 v[48:51], v2, s[40:43], s14 offen offset:0 sc1
  buffer_load_dwordx4 v[52:55], v2, s[40:43], s14 offen offset:1024 sc1
  buffer_load_dwordx4 v[56:59], v2, s[40:43], s14 offen offset:2048 sc1
  buffer_load_dwordx4 v[60:63], v2, s[40:43], s14 offen offset:3072 sc1
  s_add_u32 s14, s13, 40960
  buffer_load_dwordx4 v[96:99], v2, s[40:43], s14 offen offset:0 sc1
  buffer_load_dwordx4 v[100:103], v2, s[40:43], s14 offen offset:1024 sc1
  s_cmp_ge_u32 s29, 1
  s_cbranch_scc1 fa_leftb
  s_add_u32 s14, s13, 40960
  buffer_load_dwordx4 v[104:107], v2, s[40:43], s14 offen offset:2048 sc1
  buffer_load_dwordx4 v[108:111], v2, s[40:43], s14 offen offset:3072 sc1
  s_add_u32 s14, s13, 45056
  buffer_load_dwordx4 v[112:115], v2, s[40:43], s14 offen offset:0 sc1
  buffer_load_dwordx4 v[116:119], v2, s[40:43], s14 offen offset:1024 sc1
  buffer_load_dwordx4 v[120:123], v2, s[40:43], s14 offen offset:2048 sc1
  buffer_load_dwordx4 v[124:127], v2, s[40:43], s14 offen offset:3072 sc1
  s_branch fa_leftb
fa_ctx_spin:
  s_mov_b32 s83, 200000
fa_ctx_spin2:
  buffer_load_dword v13, v12, s[40:43], 0 offen sc1
  s_waitcnt vmcnt(0)
  v_cmp_eq_u32 vcc, 0, v13
  s_cbranch_vccz fa_ctx_ok
  s_sleep 8
  s_sub_u32 s83, s83, 1
  s_cmp_lg_u32 s83, 0
  s_cbranch_scc1 fa_ctx_spin2
  s_branch fa_ctx_ok
fa_stub0:
  s_call_b64 s[76:77], fa_rare00
  s_call_b64 s[76:77], fa_rare10
  s_branch fa_back0
fa_stub1:
  s_call_b64 s[76:77], fa_rare01
  s_call_b64 s[76:77], fa_rare11
  s_branch fa_back1
fa_stub2:
  s_call_b64 s[76:77], fa_rare00
  s_call_b64 s[76:77], fa_rare10
  s_branch fa_back2
fa_stub3:
  s_call_b64 s[76:77], fa_rare01
  s_call_b64 s[76:77], fa_rare11
  s_branch fa_back3
fa_stub4:
  s_call_b64 s[76:77], fa_rare01
  s_call_b64 s[76:77], fa_rare11
  s_branch fa_back4
fa_stub5:
  s_call_b64 s[76:77], fa_rare00
  s_call_b64 s[76:77], fa_rare10
  s_branch fa_back5
fa_stub6:
  s_call_b64 s[76:77], fa_rare11
  s_branch fa_back6
fa_stub7:
  s_call_b64 s[76:77], fa_rare10
  s_branch fa_back7
fa_stub8:
  s_call_b64 s[76:77], fa_rare01
  s_call_b64 s[76:77], fa_rare11
  s_branch fa_back8
fa_stub9:
  s_call_b64 s[76:77], fa_rare10
  s_branch fa_back9
fa_stub10:
  s_call_b64 s[76:77], fa_rare11
  s_branch fa_back10
fa_stub11:
  s_call_b64 s[76:77], fa_rare10
  s_branch fa_back11
fa_stub12:
  s_call_b64 s[76:77], fa_rare11
  s_branch fa_back12
fa_stub13:
  s_call_b64 s[76:77], fa_rare10
  s_branch fa_back13
fa_stub14:
  s_call_b64 s[76:77], fa_rare11
  s_branch fa_back14
fa_stub15:
  s_call_b64 s[76:77], fa_rare10
  s_branch fa_back15
fa_stub16:
  s_call_b64 s[76:77], fa_rare11
  s_branch fa_back16
fa_stub17:
  s_call_b64 s[76:77], fa_rare10
  s_branch fa_back17
fa_stub18:
  s_call_b64 s[76:77], fa_rare11
  s_branch fa_back18
fa_stub19:
  s_call_b64 s[76:77], fa_rare10
  s_branch fa_back19
fa_stub20:
  s_call_b64 s[76:77], fa_rare11
  s_branch fa_back20
fa_stub21:
  s_call_b64 s[76:77], fa_rare10
  s_branch fa_back21
fa_stub22:
  s_call_b64 s[76:77], fa_rare11
  s_branch fa_back22
fa_stub23:
  s_call_b64 s[76:77], fa_rare10
  s_branch fa_back23
fa_stub24:
  s_call_b64 s[76:77], fa_rare11
  s_branch fa_back24
fa_stub25:
  s_call_b64 s[76:77], fa_rare10
  s_branch fa_back25
fa_stub26:
  s_call_b64 s[76:77], fa_rare11
  s_branch fa_back26
fa_stub27:
  s_call_b64 s[76:77], fa_rare10
  s_branch fa_back27
fa_stub28:
  s_call_b64 s[76:77], fa_rare11
  s_branch fa_back28
fa_stub29:
  s_call_b64 s[76:77], fa_rare10
  s_branch fa_back29
fa_stub30:
  s_call_b64 s[76:77], fa_rare11
  s_branch fa_back30
fa_codeend:
fa_rare00:
  s_nop 7
  v_max3_f32 v16, v96, v97, v98
  v_max3_f32 v16, v16, v99, v100
  v_max3_f32 v16, v16, v101, v102
  v_max3_f32 v16, v16, v103, 0
  v_mov_b32 v18, v16
  s_nop 1
  v_permlane16_swap_b32 v16, v18
  v_max_f32 v16, v16, v18
  v_mov_b32 v18, v16
  s_nop 1
  v_permlane32_swap_b32 v16, v18
  v_max_f32 v16, v16, v18
  v_sub_f32 v96, v96, v16
  v_sub_f32 v112, v112, v16
  v_sub_f32 v97, v97, v16
  v_sub_f32 v113, v113, v16
  v_sub_f32 v98, v98, v16
  v_sub_f32 v114, v114, v16
  v_sub_f32 v99, v99, v16
  v_sub_f32 v115, v115, v16
  v_sub_f32 v100, v100, v16
  v_sub_f32 v116, v116, v16
  v_sub_f32 v101, v101, v16
  v_sub_f32 v117, v117, v16
  v_sub_f32 v102, v102, v16
  v_sub_f32 v118, v118, v16
  v_sub_f32 v103, v103, v16
  v_sub_f32 v119, v119, v16
  v_max3_f32 v17, v104, v105, v106
  v_max3_f32 v17, v17, v107, v108
  v_max3_f32 v17, v17, v109, v110
  v_max3_f32 v17, v17, v111, 0
  v_mov_b32 v18, v17
  s_nop 1
  v_permlane16_swap_b32 v17, v18
  v_max_f32 v17, v17, v18
  v_mov_b32 v18, v17
  s_nop 1
  v_permlane32_swap_b32 v17, v18
  v_max_f32 v17, v17, v18
  v_sub_f32 v104, v104, v17
  v_sub_f32 v120, v120, v17
  v_sub_f32 v105, v105, v17
  v_sub_f32 v121, v121, v17
  v_sub_f32 v106, v106, v17
  v_sub_f32 v122, v122, v17
  v_sub_f32 v107, v107, v17
  v_sub_f32 v123, v123, v17
  v_sub_f32 v108, v108, v17
  v_sub_f32 v124, v124, v17
  v_sub_f32 v109, v109, v17
  v_sub_f32 v125, v125, v17
  v_sub_f32 v110, v110, v17
  v_sub_f32 v126, v126, v17
  v_sub_f32 v111, v111, v17
  v_sub_f32 v127, v127, v17
  s_call_b64 s[78:79], fa_resc0
  v_exp_f32 v208, v96
  v_exp_f32 v209, v97
  v_exp_f32 v210, v98
  v_add_f32 v224, v208, v209
  v_cvt_pk_bf16_f32 v160, v208, v209
  v_exp_f32 v211, v99
  v_add_f32 v224, v224, v210
  v_exp_f32 v212, v100
  v_add_f32 v224, v224, v211
  v_cvt_pk_bf16_f32 v161, v210, v211
  v_exp_f32 v213, v101
  v_add_f32 v224, v224, v212
  v_exp_f32 v214, v102
  v_add_f32 v224, v224, v213
  v_cvt_pk_bf16_f32 v162, v212, v213
  v_exp_f32 v215, v103
  v_add_f32 v224, v224, v214
  v_exp_f32 v208, v104
  v_add_f32 v224, v224, v215
  v_cvt_pk_bf16_f32 v163, v214, v215
  v_exp_f32 v209, v105
  v_exp_f32 v210, v106
  v_add_f32 v225, v208, v209
  v_cvt_pk_bf16_f32 v164, v208, v209
  v_exp_f32 v211, v107
  v_add_f32 v225, v225, v210
  v_exp_f32 v212, v108
  v_add_f32 v225, v225, v211
  v_cvt_pk_bf16_f32 v165, v210, v211
  v_exp_f32 v213, v109
  v_add_f32 v225, v225, v212
  v_exp_f32 v214, v110
  v_add_f32 v225, v225, v213
  v_cvt_pk_bf16_f32 v166, v212, v213
  v_exp_f32 v215, v111
  v_add_f32 v225, v225, v214
  s_nop 0
  v_add_f32 v225, v225, v215
  v_cvt_pk_bf16_f32 v167, v214, v215
  s_nop 1
  s_setpc_b64 s[76:77]
fa_rare01:
  s_nop 7
  v_max3_f32 v16, v112, v113, v114
  v_max3_f32 v16, v16, v115, v116
  v_max3_f32 v16, v16, v117, v118
  v_max3_f32 v16, v16, v119, 0
  v_mov_b32 v18, v16
  s_nop 1
  v_permlane16_swap_b32 v16, v18
  v_max_f32 v16, v16, v18
  v_mov_b32 v18, v16
  s_nop 1
  v_permlane32_swap_b32 v16, v18
  v_max_f32 v16, v16, v18
  v_sub_f32 v112, v112, v16
  v_sub_f32 v96, v96, v16
  v_sub_f32 v113, v113, v16
  v_sub_f32 v97, v97, v16
  v_sub_f32 v114, v114, v16
  v_sub_f32 v98, v98, v16
  v_sub_f32 v115, v115, v16
  v_sub_f32 v99, v99, v16
  v_sub_f32 v116, v116, v16
  v_sub_f32 v100, v100, v16
  v_sub_f32 v117, v117, v16
  v_sub_f32 v101, v101, v16
  v_sub_f32 v118, v118, v16
  v_sub_f32 v102, v102, v16
  v_sub_f32 v119, v119, v16
  v_sub_f32 v103, v103, v16
  v_max3_f32 v17, v120, v121, v122
  v_max3_f32 v17, v17, v123, v124
  v_max3_f32 v17, v17, v125, v126
  v_max3_f32 v17, v17, v127, 0
  v_mov_b32 v18, v17
  s_nop 1
  v_permlane16_swap_b32 v17, v18
  v_max_f32 v17, v17, v18
  v_mov_b32 v18, v17
  s_nop 1
  v_permlane32_swap_b32 v17, v18
  v_max_f32 v17, v17, v18
  v_sub_f32 v120, v120, v17
  v_sub_f32 v104, v104, v17
  v_sub_f32 v121, v121, v17
  v_sub_f32 v105, v105, v17
  v_sub_f32 v122, v122, v17
  v_sub_f32 v106, v106, v17
  v_sub_f32 v123, v123, v17
  v_sub_f32 v107, v107, v17
  v_sub_f32 v124, v124, v17
  v_sub_f32 v108, v108, v17
  v_sub_f32 v125, v125, v17
  v_sub_f32 v109, v109, v17
  v_sub_f32 v126, v126, v17
  v_sub_f32 v110, v110, v17
  v_sub_f32 v127, v127, v17
  v_sub_f32 v111, v111, v17
  s_call_b64 s[78:79], fa_resc0
  v_exp_f32 v208, v112
  v_exp_f32 v209, v113
  v_exp_f32 v210, v114
  v_add_f32 v224, v208, v209
  v_cvt_pk_bf16_f32 v168, v208, v209
  v_exp_f32 v211, v115
  v_add_f32 v224, v224, v210
  v_exp_f32 v212, v116
  v_add_f32 v224, v224, v211
  v_cvt_pk_bf16_f32 v169, v210, v211
  v_exp_f32 v213, v117
  v_add_f32 v224, v224, v212
  v_exp_f32 v214, v118
  v_add_f32 v224, v224, v213
  v_cvt_pk_bf16_f32 v170, v212, v213
  v_exp_f32 v215, v119
  v_add_f32 v224, v224, v214
  v_exp_f32 v208, v120
  v_add_f32 v224, v224, v215
  v_cvt_pk_bf16_f32 v171, v214, v215
  v_exp_f32 v209, v121
  v_exp_f32 v210, v122
  v_add_f32 v225, v208, v209
  v_cvt_pk_bf16_f32 v172, v208, v209
  v_exp_f32 v211, v123
  v_add_f32 v225, v225, v210
  v_exp_f32 v212, v124
  v_add_f32 v225, v225, v211
  v_cvt_pk_bf16_f32 v173, v210, v211
  v_exp_f32 v213, v125
  v_add_f32 v225, v225, v212
  v_exp_f32 v214, v126
  v_add_f32 v225, v225, v213
  v_cvt_pk_bf16_f32 v174, v212, v213
  v_exp_f32 v215, v127
  v_add_f32 v225, v225, v214
  s_nop 0
  v_add_f32 v225, v225, v215
  v_cvt_pk_bf16_f32 v175, v214, v215
  s_nop 1
  s_setpc_b64 s[76:77]
fa_resc0:
  v_sub_f32 v192, v192, v16
  v_sub_f32 v193, v193, v16
  v_sub_f32 v194, v194, v16
  v_sub_f32 v195, v195, v16
  v_exp_f32 v18, -v16
  v_sub_f32 v196, v196, v17
  v_sub_f32 v197, v197, v17
  v_sub_f32 v198, v198, v17
  v_sub_f32 v199, v199, v17
  v_exp_f32 v19, -v17
  s_nop 0
  v_mul_f32 v228, v228, v18
  v_mul_f32 v229, v229, v19
  v_accvgpr_read_b32 v20, a0
  v_accvgpr_read_b32 v21, a1
  v_accvgpr_read_b32 v22, a2
  v_accvgpr_read_b32 v23, a3
  v_mul_f32 v20, v20, v18
  v_mul_f32 v21, v21, v18
  v_mul_f32 v22, v22, v18
  v_mul_f32 v23, v23, v18
  v_accvgpr_write_b32 a0, v20
  v_accvgpr_write_b32 a1, v21
  v_accvgpr_write_b32 a2, v22
  v_accvgpr_write_b32 a3, v23
  v_accvgpr_read_b32 v20, a4
  v_accvgpr_read_b32 v21, a5
  v_accvgpr_read_b32 v22, a6
  v_accvgpr_read_b32 v23, a7
  v_mul_f32 v20, v20, v19
  v_mul_f32 v21, v21, v19
  v_mul_f32 v22, v22, v19
  v_mul_f32 v23, v23, v19
  v_accvgpr_write_b32 a4, v20
  v_accvgpr_write_b32 a5, v21
  v_accvgpr_write_b32 a6, v22
  v_accvgpr_write_b32 a7, v23
  v_accvgpr_read_b32 v20, a8
  v_accvgpr_read_b32 v21, a9
  v_accvgpr_read_b32 v22, a10
  v_accvgpr_read_b32 v23, a11
  v_mul_f32 v20, v20, v18
  v_mul_f32 v21, v21, v18
  v_mul_f32 v22, v22, v18
  v_mul_f32 v23, v23, v18
  v_accvgpr_write_b32 a8, v20
  v_accvgpr_write_b32 a9, v21
  v_accvgpr_write_b32 a10, v22
  v_accvgpr_write_b32 a11, v23
  v_accvgpr_read_b32 v20, a12
  v_accvgpr_read_b32 v21, a13
  v_accvgpr_read_b32 v22, a14
  v_accvgpr_read_b32 v23, a15
  v_mul_f32 v20, v20, v19
  v_mul_f32 v21, v21, v19
  v_mul_f32 v22, v22, v19
  v_mul_f32 v23, v23, v19
  v_accvgpr_write_b32 a12, v20
  v_accvgpr_write_b32 a13, v21
  v_accvgpr_write_b32 a14, v22
  v_accvgpr_write_b32 a15, v23
  v_accvgpr_read_b32 v20, a16
  v_accvgpr_read_b32 v21, a17
  v_accvgpr_read_b32 v22, a18
  v_accvgpr_read_b32 v23, a19
  v_mul_f32 v20, v20, v18
  v_mul_f32 v21, v21, v18
  v_mul_f32 v22, v22, v18
  v_mul_f32 v23, v23, v18
  v_accvgpr_write_b32 a16, v20
  v_accvgpr_write_b32 a17, v21
  v_accvgpr_write_b32 a18, v22
  v_accvgpr_write_b32 a19, v23
  v_accvgpr_read_b32 v20, a20
  v_accvgpr_read_b32 v21, a21
  v_accvgpr_read_b32 v22, a22
  v_accvgpr_read_b32 v23, a23
  v_mul_f32 v20, v20, v19
  v_mul_f32 v21, v21, v19
  v_mul_f32 v22, v22, v19
  v_mul_f32 v23, v23, v19
  v_accvgpr_write_b32 a20, v20
  v_accvgpr_write_b32 a21, v21
  v_accvgpr_write_b32 a22, v22
  v_accvgpr_write_b32 a23, v23
  v_accvgpr_read_b32 v20, a24
  v_accvgpr_read_b32 v21, a25
  v_accvgpr_read_b32 v22, a26
  v_accvgpr_read_b32 v23, a27
  v_mul_f32 v20, v20, v18
  v_mul_f32 v21, v21, v18
  v_mul_f32 v22, v22, v18
  v_mul_f32 v23, v23, v18
  v_accvgpr_write_b32 a24, v20
  v_accvgpr_write_b32 a25, v21
  v_accvgpr_write_b32 a26, v22
  v_accvgpr_write_b32 a27, v23
  v_accvgpr_read_b32 v20, a28
  v_accvgpr_read_b32 v21, a29
  v_accvgpr_read_b32 v22, a30
  v_accvgpr_read_b32 v23, a31
  v_mul_f32 v20, v20, v19
  v_mul_f32 v21, v21, v19
  v_mul_f32 v22, v22, v19
  v_mul_f32 v23, v23, v19
  v_accvgpr_write_b32 a28, v20
  v_accvgpr_write_b32 a29, v21
  v_accvgpr_write_b32 a30, v22
  v_accvgpr_write_b32 a31, v23
  v_accvgpr_read_b32 v20, a32
  v_accvgpr_read_b32 v21, a33
  v_accvgpr_read_b32 v22, a34
  v_accvgpr_read_b32 v23, a35
  v_mul_f32 v20, v20, v18
  v_mul_f32 v21, v21, v18
  v_mul_f32 v22, v22, v18
  v_mul_f32 v23, v23, v18
  v_accvgpr_write_b32 a32, v20
  v_accvgpr_write_b32 a33, v21
  v_accvgpr_write_b32 a34, v22
  v_accvgpr_write_b32 a35, v23
  v_accvgpr_read_b32 v20, a36
  v_accvgpr_read_b32 v21, a37
  v_accvgpr_read_b32 v22, a38
  v_accvgpr_read_b32 v23, a39
  v_mul_f32 v20, v20, v19
  v_mul_f32 v21, v21, v19
  v_mul_f32 v22, v22, v19
  v_mul_f32 v23, v23, v19
  v_accvgpr_write_b32 a36, v20
  v_accvgpr_write_b32 a37, v21
  v_accvgpr_write_b32 a38, v22
  v_accvgpr_write_b32 a39, v23
  v_accvgpr_read_b32 v20, a40
  v_accvgpr_read_b32 v21, a41
  v_accvgpr_read_b32 v22, a42
  v_accvgpr_read_b32 v23, a43
  v_mul_f32 v20, v20, v18
  v_mul_f32 v21, v21, v18
  v_mul_f32 v22, v22, v18
  v_mul_f32 v23, v23, v18
  v_accvgpr_write_b32 a40, v20
  v_accvgpr_write_b32 a41, v21
  v_accvgpr_write_b32 a42, v22
  v_accvgpr_write_b32 a43, v23
  v_accvgpr_read_b32 v20, a44
  v_accvgpr_read_b32 v21, a45
  v_accvgpr_read_b32 v22, a46
  v_accvgpr_read_b32 v23, a47
  v_mul_f32 v20, v20, v19
  v_mul_f32 v21, v21, v19
  v_mul_f32 v22, v22, v19
  v_mul_f32 v23, v23, v19
  v_accvgpr_write_b32 a44, v20
  v_accvgpr_write_b32 a45, v21
  v_accvgpr_write_b32 a46, v22
  v_accvgpr_write_b32 a47, v23
  v_accvgpr_read_b32 v20, a48
  v_accvgpr_read_b32 v21, a49
  v_accvgpr_read_b32 v22, a50
  v_accvgpr_read_b32 v23, a51
  v_mul_f32 v20, v20, v18
  v_mul_f32 v21, v21, v18
  v_mul_f32 v22, v22, v18
  v_mul_f32 v23, v23, v18
  v_accvgpr_write_b32 a48, v20
  v_accvgpr_write_b32 a49, v21
  v_accvgpr_write_b32 a50, v22
  v_accvgpr_write_b32 a51, v23
  v_accvgpr_read_b32 v20, a52
  v_accvgpr_read_b32 v21, a53
  v_accvgpr_read_b32 v22, a54
  v_accvgpr_read_b32 v23, a55
  v_mul_f32 v20, v20, v19
  v_mul_f32 v21, v21, v19
  v_mul_f32 v22, v22, v19
  v_mul_f32 v23, v23, v19
  v_accvgpr_write_b32 a52, v20
  v_accvgpr_write_b32 a53, v21
  v_accvgpr_write_b32 a54, v22
  v_accvgpr_write_b32 a55, v23
  v_accvgpr_read_b32 v20, a56
  v_accvgpr_read_b32 v21, a57
  v_accvgpr_read_b32 v22, a58
  v_accvgpr_read_b32 v23, a59
  v_mul_f32 v20, v20, v18
  v_mul_f32 v21, v21, v18
  v_mul_f32 v22, v22, v18
  v_mul_f32 v23, v23, v18
  v_accvgpr_write_b32 a56, v20
  v_accvgpr_write_b32 a57, v21
  v_accvgpr_write_b32 a58, v22
  v_accvgpr_write_b32 a59, v23
  v_accvgpr_read_b32 v20, a60
  v_accvgpr_read_b32 v21, a61
  v_accvgpr_read_b32 v22, a62
  v_accvgpr_read_b32 v23, a63
  v_mul_f32 v20, v20, v19
  v_mul_f32 v21, v21, v19
  v_mul_f32 v22, v22, v19
  v_mul_f32 v23, v23, v19
  v_accvgpr_write_b32 a60, v20
  v_accvgpr_write_b32 a61, v21
  v_accvgpr_write_b32 a62, v22
  v_accvgpr_write_b32 a63, v23
  s_setpc_b64 s[78:79]
fa_rare10:
  s_nop 7
  v_max3_f32 v16, v128, v129, v130
  v_max3_f32 v16, v16, v131, v132
  v_max3_f32 v16, v16, v133, v134
  v_max3_f32 v16, v16, v135, 0
  v_mov_b32 v18, v16
  s_nop 1
  v_permlane16_swap_b32 v16, v18
  v_max_f32 v16, v16, v18
  v_mov_b32 v18, v16
  s_nop 1
  v_permlane32_swap_b32 v16, v18
  v_max_f32 v16, v16, v18
  v_sub_f32 v128, v128, v16
  v_sub_f32 v144, v144, v16
  v_sub_f32 v129, v129, v16
  v_sub_f32 v145, v145, v16
  v_sub_f32 v130, v130, v16
  v_sub_f32 v146, v146, v16
  v_sub_f32 v131, v131, v16
  v_sub_f32 v147, v147, v16
  v_sub_f32 v132, v132, v16
  v_sub_f32 v148, v148, v16
  v_sub_f32 v133, v133, v16
  v_sub_f32 v149, v149, v16
  v_sub_f32 v134, v134, v16
  v_sub_f32 v150, v150, v16
  v_sub_f32 v135, v135, v16
  v_sub_f32 v151, v151, v16
  v_max3_f32 v17, v136, v137, v138
  v_max3_f32 v17, v17, v139, v140
  v_max3_f32 v17, v17, v141, v142
  v_max3_f32 v17, v17, v143, 0
  v_mov_b32 v18, v17
  s_nop 1
  v_permlane16_swap_b32 v17, v18
  v_max_f32 v17, v17, v18
  v_mov_b32 v18, v17
  s_nop 1
  v_permlane32_swap_b32 v17, v18
  v_max_f32 v17, v17, v18
  v_sub_f32 v136, v136, v17
  v_sub_f32 v152, v152, v17
  v_sub_f32 v137, v137, v17
  v_sub_f32 v153, v153, v17
  v_sub_f32 v138, v138, v17
  v_sub_f32 v154, v154, v17
  v_sub_f32 v139, v139, v17
  v_sub_f32 v155, v155, v17
  v_sub_f32 v140, v140, v17
  v_sub_f32 v156, v156, v17
  v_sub_f32 v141, v141, v17
  v_sub_f32 v157, v157, v17
  v_sub_f32 v142, v142, v17
  v_sub_f32 v158, v158, v17
  v_sub_f32 v143, v143, v17
  v_sub_f32 v159, v159, v17
  s_call_b64 s[78:79], fa_resc1
  v_exp_f32 v216, v128
  v_exp_f32 v217, v129
  v_exp_f32 v218, v130
  v_add_f32 v226, v216, v217
  v_cvt_pk_bf16_f32 v176, v216, v217
  v_exp_f32 v219, v131
  v_add_f32 v226, v226, v218
  v_exp_f32 v220, v132
  v_add_f32 v226, v226, v219
  v_cvt_pk_bf16_f32 v177, v218, v219
  v_exp_f32 v221, v133
  v_add_f32 v226, v226, v220
  v_exp_f32 v222, v134
  v_add_f32 v226, v226, v221
  v_cvt_pk_bf16_f32 v178, v220, v221
  v_exp_f32 v223, v135
  v_add_f32 v226, v226, v222
  v_exp_f32 v216, v136
  v_add_f32 v226, v226, v223
  v_cvt_pk_bf16_f32 v179, v222, v223
  v_exp_f32 v217, v137
  v_exp_f32 v218, v138
  v_add_f32 v227, v216, v217
  v_cvt_pk_bf16_f32 v180, v216, v217
  v_exp_f32 v219, v139
  v_add_f32 v227, v227, v218
  v_exp_f32 v220, v140
  v_add_f32 v227, v227, v219
  v_cvt_pk_bf16_f32 v181, v218, v219
  v_exp_f32 v221, v141
  v_add_f32 v227, v227, v220
  v_exp_f32 v222, v142
  v_add_f32 v227, v227, v221
  v_cvt_pk_bf16_f32 v182, v220, v221
  v_exp_f32 v223, v143
  v_add_f32 v227, v227, v222
  s_nop 0
  v_add_f32 v227, v227, v223
  v_cvt_pk_bf16_f32 v183, v222, v223
  v_exp_f32 v216, v144
  s_nop 1
  s_setpc_b64 s[76:77]
fa_rare11:
  s_nop 7
  v_max3_f32 v16, v144, v145, v146
  v_max3_f32 v16, v16, v147, v148
  v_max3_f32 v16, v16, v149, v150
  v_max3_f32 v16, v16, v151, 0
  v_mov_b32 v18, v16
  s_nop 1
  v_permlane16_swap_b32 v16, v18
  v_max_f32 v16, v16, v18
  v_mov_b32 v18, v16
  s_nop 1
  v_permlane32_swap_b32 v16, v18
  v_max_f32 v16, v16, v18
  v_sub_f32 v144, v144, v16
  v_sub_f32 v128, v128, v16
  v_sub_f32 v145, v145, v16
  v_sub_f32 v129, v129, v16
  v_sub_f32 v146, v146, v16
  v_sub_f32 v130, v130, v16
  v_sub_f32 v147, v147, v16
  v_sub_f32 v131, v131, v16
  v_sub_f32 v148, v148, v16
  v_sub_f32 v132, v132, v16
  v_sub_f32 v149, v149, v16
  v_sub_f32 v133, v133, v16
  v_sub_f32 v150, v150, v16
  v_sub_f32 v134, v134, v16
  v_sub_f32 v151, v151, v16
  v_sub_f32 v135, v135, v16
  v_max3_f32 v17, v152, v153, v154
  v_max3_f32 v17, v17, v155, v156
  v_max3_f32 v17, v17, v157, v158
  v_max3_f32 v17, v17, v159, 0
  v_mov_b32 v18, v17
  s_nop 1
  v_permlane16_swap_b32 v17, v18
  v_max_f32 v17, v17, v18
  v_mov_b32 v18, v17
  s_nop 1
  v_permlane32_swap_b32 v17, v18
  v_max_f32 v17, v17, v18
  v_sub_f32 v152, v152, v17
  v_sub_f32 v136, v136, v17
  v_sub_f32 v153, v153, v17
  v_sub_f32 v137, v137, v17
  v_sub_f32 v154, v154, v17
  v_sub_f32 v138, v138, v17
  v_sub_f32 v155, v155, v17
  v_sub_f32 v139, v139, v17
  v_sub_f32 v156, v156, v17
  v_sub_f32 v140, v140, v17
  v_sub_f32 v157, v157, v17
  v_sub_f32 v141, v141, v17
  v_sub_f32 v158, v158, v17
  v_sub_f32 v142, v142, v17
  v_sub_f32 v159, v159, v17
  v_sub_f32 v143, v143, v17
  s_call_b64 s[78:79], fa_resc1
  v_exp_f32 v216, v144
  v_exp_f32 v217, v145
  v_exp_f32 v218, v146
  v_add_f32 v226, v216, v217
  v_cvt_pk_bf16_f32 v184, v216, v217
  v_exp_f32 v219, v147
  v_add_f32 v226, v226, v218
  v_exp_f32 v220, v148
  v_add_f32 v226, v226, v219
  v_cvt_pk_bf16_f32 v185, v218, v219
  v_exp_f32 v221, v149
  v_add_f32 v226, v226, v220
  v_exp_f32 v222, v150
  v_add_f32 v226, v226, v221
  v_cvt_pk_bf16_f32 v186, v220, v221
  v_exp_f32 v223, v151
  v_add_f32 v226, v226, v222
  v_exp_f32 v216, v152
  v_add_f32 v226, v226, v223
  v_cvt_pk_bf16_f32 v187, v222, v223
  v_exp_f32 v217, v153
  v_exp_f32 v218, v154
  v_add_f32 v227, v216, v217
  v_cvt_pk_bf16_f32 v188, v216, v217
  v_exp_f32 v219, v155
  v_add_f32 v227, v227, v218
  v_exp_f32 v220, v156
  v_add_f32 v227, v227, v219
  v_cvt_pk_bf16_f32 v189, v218, v219
  v_exp_f32 v221, v157
  v_add_f32 v227, v227, v220
  v_exp_f32 v222, v158
  v_add_f32 v227, v227, v221
  v_cvt_pk_bf16_f32 v190, v220, v221
  v_exp_f32 v223, v159
  v_add_f32 v227, v227, v222
  s_nop 0
  v_add_f32 v227, v227, v223
  v_cvt_pk_bf16_f32 v191, v222, v223
  v_exp_f32 v216, v128
  s_nop 1
  s_setpc_b64 s[76:77]
fa_resc1:
  v_sub_f32 v200, v200, v16
  v_sub_f32 v201, v201, v16
  v_sub_f32 v202, v202, v16
  v_sub_f32 v203, v203, v16
  v_exp_f32 v18, -v16
  v_sub_f32 v204, v204, v17
  v_sub_f32 v205, v205, v17
  v_sub_f32 v206, v206, v17
  v_sub_f32 v207, v207, v17
  v_exp_f32 v19, -v17
  s_nop 0
  v_mul_f32 v230, v230, v18
  v_mul_f32 v231, v231, v19
  v_accvgpr_read_b32 v20, a64
  v_accvgpr_read_b32 v21, a65
  v_accvgpr_read_b32 v22, a66
  v_accvgpr_read_b32 v23, a67
  v_mul_f32 v20, v20, v18
  v_mul_f32 v21, v21, v18
  v_mul_f32 v22, v22, v18
  v_mul_f32 v23, v23, v18
  v_accvgpr_write_b32 a64, v20
  v_accvgpr_write_b32 a65, v21
  v_accvgpr_write_b32 a66, v22
  v_accvgpr_write_b32 a67, v23
  v_accvgpr_read_b32 v20, a68
  v_accvgpr_read_b32 v21, a69
  v_accvgpr_read_b32 v22, a70
  v_accvgpr_read_b32 v23, a71
  v_mul_f32 v20, v20, v19
  v_mul_f32 v21, v21, v19
  v_mul_f32 v22, v22, v19
  v_mul_f32 v23, v23, v19
  v_accvgpr_write_b32 a68, v20
  v_accvgpr_write_b32 a69, v21
  v_accvgpr_write_b32 a70, v22
  v_accvgpr_write_b32 a71, v23
  v_accvgpr_read_b32 v20, a72
  v_accvgpr_read_b32 v21, a73
  v_accvgpr_read_b32 v22, a74
  v_accvgpr_read_b32 v23, a75
  v_mul_f32 v20, v20, v18
  v_mul_f32 v21, v21, v18
  v_mul_f32 v22, v22, v18
  v_mul_f32 v23, v23, v18
  v_accvgpr_write_b32 a72, v20
  v_accvgpr_write_b32 a73, v21
  v_accvgpr_write_b32 a74, v22
  v_accvgpr_write_b32 a75, v23
  v_accvgpr_read_b32 v20, a76
  v_accvgpr_read_b32 v21, a77
  v_accvgpr_read_b32 v22, a78
  v_accvgpr_read_b32 v23, a79
  v_mul_f32 v20, v20, v19
  v_mul_f32 v21, v21, v19
  v_mul_f32 v22, v22, v19
  v_mul_f32 v23, v23, v19
  v_accvgpr_write_b32 a76, v20
  v_accvgpr_write_b32 a77, v21
  v_accvgpr_write_b32 a78, v22
  v_accvgpr_write_b32 a79, v23
  v_accvgpr_read_b32 v20, a80
  v_accvgpr_read_b32 v21, a81
  v_accvgpr_read_b32 v22, a82
  v_accvgpr_read_b32 v23, a83
  v_mul_f32 v20, v20, v18
  v_mul_f32 v21, v21, v18
  v_mul_f32 v22, v22, v18
  v_mul_f32 v23, v23, v18
  v_accvgpr_write_b32 a80, v20
  v_accvgpr_write_b32 a81, v21
  v_accvgpr_write_b32 a82, v22
  v_accvgpr_write_b32 a83, v23
  v_accvgpr_read_b32 v20, a84
  v_accvgpr_read_b32 v21, a85
  v_accvgpr_read_b32 v22, a86
  v_accvgpr_read_b32 v23, a87
  v_mul_f32 v20, v20, v19
  v_mul_f32 v21, v21, v19
  v_mul_f32 v22, v22, v19
  v_mul_f32 v23, v23, v19
  v_accvgpr_write_b32 a84, v20
  v_accvgpr_write_b32 a85, v21
  v_accvgpr_write_b32 a86, v22
  v_accvgpr_write_b32 a87, v23
  v_accvgpr_read_b32 v20, a88
  v_accvgpr_read_b32 v21, a89
  v_accvgpr_read_b32 v22, a90
  v_accvgpr_read_b32 v23, a91
  v_mul_f32 v20, v20, v18
  v_mul_f32 v21, v21, v18
  v_mul_f32 v22, v22, v18
  v_mul_f32 v23, v23, v18
  v_accvgpr_write_b32 a88, v20
  v_accvgpr_write_b32 a89, v21
  v_accvgpr_write_b32 a90, v22
  v_accvgpr_write_b32 a91, v23
  v_accvgpr_read_b32 v20, a92
  v_accvgpr_read_b32 v21, a93
  v_accvgpr_read_b32 v22, a94
  v_accvgpr_read_b32 v23, a95
  v_mul_f32 v20, v20, v19
  v_mul_f32 v21, v21, v19
  v_mul_f32 v22, v22, v19
  v_mul_f32 v23, v23, v19
  v_accvgpr_write_b32 a92, v20
  v_accvgpr_write_b32 a93, v21
  v_accvgpr_write_b32 a94, v22
  v_accvgpr_write_b32 a95, v23
  v_accvgpr_read_b32 v20, a96
  v_accvgpr_read_b32 v21, a97
  v_accvgpr_read_b32 v22, a98
  v_accvgpr_read_b32 v23, a99
  v_mul_f32 v20, v20, v18
  v_mul_f32 v21, v21, v18
  v_mul_f32 v22, v22, v18
  v_mul_f32 v23, v23, v18
  v_accvgpr_write_b32 a96, v20
  v_accvgpr_write_b32 a97, v21
  v_accvgpr_write_b32 a98, v22
  v_accvgpr_write_b32 a99, v23
  v_accvgpr_read_b32 v20, a100
  v_accvgpr_read_b32 v21, a101
  v_accvgpr_read_b32 v22, a102
  v_accvgpr_read_b32 v23, a103
  v_mul_f32 v20, v20, v19
  v_mul_f32 v21, v21, v19
  v_mul_f32 v22, v22, v19
  v_mul_f32 v23, v23, v19
  v_accvgpr_write_b32 a100, v20
  v_accvgpr_write_b32 a101, v21
  v_accvgpr_write_b32 a102, v22
  v_accvgpr_write_b32 a103, v23
  v_accvgpr_read_b32 v20, a104
  v_accvgpr_read_b32 v21, a105
  v_accvgpr_read_b32 v22, a106
  v_accvgpr_read_b32 v23, a107
  v_mul_f32 v20, v20, v18
  v_mul_f32 v21, v21, v18
  v_mul_f32 v22, v22, v18
  v_mul_f32 v23, v23, v18
  v_accvgpr_write_b32 a104, v20
  v_accvgpr_write_b32 a105, v21
  v_accvgpr_write_b32 a106, v22
  v_accvgpr_write_b32 a107, v23
  v_accvgpr_read_b32 v20, a108
  v_accvgpr_read_b32 v21, a109
  v_accvgpr_read_b32 v22, a110
  v_accvgpr_read_b32 v23, a111
  v_mul_f32 v20, v20, v19
  v_mul_f32 v21, v21, v19
  v_mul_f32 v22, v22, v19
  v_mul_f32 v23, v23, v19
  v_accvgpr_write_b32 a108, v20
  v_accvgpr_write_b32 a109, v21
  v_accvgpr_write_b32 a110, v22
  v_accvgpr_write_b32 a111, v23
  v_accvgpr_read_b32 v20, a112
  v_accvgpr_read_b32 v21, a113
  v_accvgpr_read_b32 v22, a114
  v_accvgpr_read_b32 v23, a115
  v_mul_f32 v20, v20, v18
  v_mul_f32 v21, v21, v18
  v_mul_f32 v22, v22, v18
  v_mul_f32 v23, v23, v18
  v_accvgpr_write_b32 a112, v20
  v_accvgpr_write_b32 a113, v21
  v_accvgpr_write_b32 a114, v22
  v_accvgpr_write_b32 a115, v23
  v_accvgpr_read_b32 v20, a116
  v_accvgpr_read_b32 v21, a117
  v_accvgpr_read_b32 v22, a118
  v_accvgpr_read_b32 v23, a119
  v_mul_f32 v20, v20, v19
  v_mul_f32 v21, v21, v19
  v_mul_f32 v22, v22, v19
  v_mul_f32 v23, v23, v19
  v_accvgpr_write_b32 a116, v20
  v_accvgpr_write_b32 a117, v21
  v_accvgpr_write_b32 a118, v22
  v_accvgpr_write_b32 a119, v23
  v_accvgpr_read_b32 v20, a120
  v_accvgpr_read_b32 v21, a121
  v_accvgpr_read_b32 v22, a122
  v_accvgpr_read_b32 v23, a123
  v_mul_f32 v20, v20, v18
  v_mul_f32 v21, v21, v18
  v_mul_f32 v22, v22, v18
  v_mul_f32 v23, v23, v18
  v_accvgpr_write_b32 a120, v20
  v_accvgpr_write_b32 a121, v21
  v_accvgpr_write_b32 a122, v22
  v_accvgpr_write_b32 a123, v23
  v_accvgpr_read_b32 v20, a124
  v_accvgpr_read_b32 v21, a125
  v_accvgpr_read_b32 v22, a126
  v_accvgpr_read_b32 v23, a127
  v_mul_f32 v20, v20, v19
  v_mul_f32 v21, v21, v19
  v_mul_f32 v22, v22, v19
  v_mul_f32 v23, v23, v19
  v_accvgpr_write_b32 a124, v20
  v_accvgpr_write_b32 a125, v21
  v_accvgpr_write_b32 a126, v22
  v_accvgpr_write_b32 a127, v23
  s_setpc_b64 s[78:79]
.section .rodata,"a"
.p2align 6
.amdhsa_kernel fa_kernel
  .amdhsa_next_free_vgpr 512
  .amdhsa_next_free_sgpr 102
  .amdhsa_accum_offset 256
  .amdhsa_group_segment_fixed_size 0
  .amdhsa_kernarg_size 112
  .amdhsa_user_sgpr_count 2
  .amdhsa_user_sgpr_kernarg_segment_ptr 1
  .amdhsa_system_sgpr_workgroup_id_x 1
  .amdhsa_float_denorm_mode_32 3
.end_amdhsa_kernel
.text
```

```asm
; @launch kernel=fa_kernel grid=(256,1,1) block=(256,1,1) lds=163840
.amdgcn_target "amdgcn-amd-amdhsa--gfx950"
.text
.globl fa_kernel
.p2align 8
.type fa_kernel,@function
fa_kernel:
  s_cmp_ge_u32 s2, 256
  s_cbranch_scc1 fa_end
  s_getpc_b64 s[62:63]
  v_and_b32 v230, 127, v0
  v_lshlrev_b32 v230, 7, v230
  global_load_dword v231, v230, s[62:63]
  s_load_dwordx4 s[4:7], s[0:1], 0
  s_load_dwordx4 s[8:11], s[0:1], 24
  s_load_dwordx2 s[14:15], s[0:1], 56
  s_load_dwordx2 s[12:13], s[0:1], 40
  s_load_dwordx4 s[16:19], s[0:1], 96
  s_load_dwordx2 s[60:61], s[0:1], 16
  v_lshrrev_b32 v16, 6, v0
  v_and_b32 v1, 63, v0
  v_readfirstlane_b32 s20, v16
  s_and_b32 s21, s2, 7
  s_lshl_b32 s21, s21, 2
  s_lshr_b32 s23, s2, 3
  s_and_b32 s23, s23, 3
  s_add_u32 s21, s21, s23
  s_lshr_b32 s22, s2, 5
  v_and_b32 v208, 31, v1
  v_lshrrev_b32 v209, 5, v1
  s_lshl_b32 s31, s2, 2
  s_add_u32 s31, s31, s20
  s_lshl_b32 s31, s31, 1
  v_add_u32 v209, s31, v209
  v_lshlrev_b32 v212, 4, v208
  v_mul_u32_u24 v210, 1280, v209
  v_add_u32 v210, v210, v212
  v_cmp_gt_u32 s[64:65], 16, v208
  v_mov_b32 v19, 1073741824
  v_and_b32 v220, 7, v209
  v_cndmask_b32 v211, v19, v210, s[64:65]
  v_bfe_u32 v17, v1, 1, 3
  v_lshlrev_b32 v17, 13, v17
  v_and_b32 v18, 1, v1
  v_lshl_add_u32 v235, v18, 7, v17
  s_lshl_b32 s74, s22, 1
  s_and_b32 s31, s20, 1
  s_add_u32 s74, s74, s31
  s_lshl_b32 s74, s74, 16
  s_mov_b32 s73, 1048576
  v_and_b32 v16, 15, v1
  v_lshlrev_b32 v17, 10, v16
  v_and_b32 v18, 16, v1
  v_lshl_add_u32 v233, v18, 3, v17
  s_lshl_b32 s30, s23, 5
  s_add_u32 s30, s30, s20
  s_lshl_b32 s30, s30, 14
  s_lshl_b32 s29, s22, 16
  s_lshl_b32 s23, s21, 8
  s_cmp_ge_u32 s20, 2
  s_waitcnt lgkmcnt(0)
  s_mov_b32 s44, s4
  s_mov_b32 s45, s5
  s_mov_b32 s46, 2621440
  s_mov_b32 s47, 0x20000
  s_mov_b32 s68, s14
  s_mov_b32 s69, s15
  s_mov_b32 s70, 1280
  s_mov_b32 s71, 0x20000
  buffer_load_dwordx4 v[160:163], v210, s[44:47], 0 offen
  buffer_load_dwordx4 v[164:167], v210, s[44:47], 0 offen offset:512
  buffer_load_dwordx4 v[168:171], v211, s[44:47], 0 offen offset:1024
  buffer_load_dwordx4 v[172:175], v212, s[68:71], 0 offen offset:0
  buffer_load_dwordx4 v[176:179], v212, s[68:71], 0 offen offset:512
  buffer_load_dwordx4 v[180:183], v212, s[68:71], 0 offen offset:1024
  s_cselect_b32 s62, s10, s8
  s_cselect_b32 s63, s11, s9
  s_add_u32 s62, s62, s23
  s_addc_u32 s63, s63, 0
  s_mov_b32 s36, s62
  s_mov_b32 s37, s63
  s_mov_b32 s38, 0
  s_mov_b32 s39, 0x20000
  s_sub_u32 s38, 4194304, s23
  buffer_load_dword v231, v235, s[36:39], s74 offen
  s_add_u32 s6, s6, s29
  s_addc_u32 s7, s7, 0
  s_mov_b32 s32, s6
  s_mov_b32 s33, s7
  s_mov_b32 s34, 0
  s_mov_b32 s35, 0x20000
  s_sub_u32 s34, 2097152, s29
  buffer_load_dword v232, v233, s[32:35], s30 offen
  s_add_u32 s74, s74, s73
  buffer_load_dword v231, v235, s[36:39], s74 offen
  buffer_load_dword v232, v233, s[32:35], s30 offen offset:256
  s_getpc_b64 s[8:9]
fa_pc:
  s_lshr_b32 s31, s2, 3
  s_and_b32 s31, s31, 15
  s_lshl_b32 s31, s31, 2
  s_add_u32 s31, s31, s20
  s_lshl_b32 s31, s31, 11
  s_min_u32 s31, s31, fa_codeend-fa_pc-2048
  v_lshlrev_b32 v234, 7, v16
  v_add_u32 v230, s31, v234
  global_load_dword v231, v230, s[8:9]
  s_add_u32 s8, s8, fa_co1-fa_pc-4
  s_addc_u32 s9, s9, 0
  s_add_u32 s60, s60, s23
  s_addc_u32 s61, s61, 0
  s_sub_u32 s75, 5242880, s23
  s_mov_b32 s48, s62
  s_mov_b32 s49, s63
  s_mov_b32 s50, s38
  s_mov_b32 s51, 0x20000
  v_lshlrev_b32 v2, 4, v1
  v_lshrrev_b32 v19, 2, v1
  v_lshrrev_b32 v17, 5, v1
  v_mul_u32_u24 v17, 3, v17
  v_and_b32 v18, 3, v1
  v_xor_b32 v17, v17, v18
  v_lshlrev_b32 v17, 4, v17
  v_lshl_add_u32 v3, v19, 10, v17
  s_lshl_b32 s23, s20, 19
  v_add_u32 v3, s23, v3
  v_add_u32 v4, 15360, v3
  v_add_u32 v5, 30720, v3
  v_add_u32 v6, 46080, v3
  v_and_b32 v19, 3, v19
  v_lshrrev_b32 v17, 4, v1
  v_lshlrev_b32 v17, 6, v17
  v_lshl_add_u32 v19, v19, 13, v17
  s_and_b32 s23, s20, 1
  s_lshl_b32 s23, s23, 17
  v_add_u32 v19, s23, v19
  v_lshl_add_u32 v8, v18, 4, v19
  v_xor_b32 v18, 2, v18
  v_lshl_add_u32 v10, v18, 4, v19
  v_add_u32 v9, 31744, v8
  v_add_u32 v11, 95232, v10
  v_add_u32 v10, 63488, v10
  s_lshl_b32 s24, s20, 12
  s_mov_b32 s26, 0
  s_mov_b32 s27, 0
  s_mov_b32 s25, 262144
  s_mov_b32 s79, 64
  s_mov_b32 s40, s18
  s_mov_b32 s41, s19
  s_mov_b32 s42, 67108864
  s_mov_b32 s43, 0x20000
  s_mov_b32 s52, s12
  s_mov_b32 s53, s13
  s_mov_b32 s54, 5242880
  s_mov_b32 s55, 0x20000
  s_mov_b32 s56, s16
  s_mov_b32 s57, s17
  s_mov_b32 s58, 256
  s_mov_b32 s59, 0x20000
  s_and_b32 s29, s2, 7
  s_lshl_b32 s29, s29, 2
  s_add_u32 s29, s29, s20
  s_lshl_b32 s29, s29, 11
  s_and_b32 s23, s21, 3
  s_lshl_b32 s23, s23, 19
  s_add_u32 s29, s29, s23
  s_lshl_b32 s23, s20, 5
  s_add_u32 s23, s23, s21
  s_lshl_b32 s23, s23, 2
  s_add_u32 s23, s23, 2641920
  s_lshl_b32 s31, s22, 9
  s_add_u32 s80, s23, s31
  s_sub_u32 s31, 7680, s31
  s_add_u32 s3, s23, s31
  s_lshl_b32 s23, s21, 7
  s_lshl_b32 s31, s22, 2
  s_add_u32 s23, s23, s31
  s_add_u32 s82, s23, 2637824
  s_sub_u32 s62, s2, 170
  s_lshl_b32 s31, s20, 6
  s_add_u32 s62, s62, s31
  s_lshl_b32 s62, s62, 2
  s_add_u32 s62, s62, 2650112
  s_sub_u32 s23, s2, 170
  s_cmp_lt_u32 s23, 54
  s_cselect_b32 s62, s62, 1073741824
  s_cmp_eq_u32 s20, 0
  s_cselect_b32 s31, s82, 1073741824
  s_cselect_b32 s77, s2, 1073741824
  s_cmp_eq_u32 s2, 255
  s_cselect_b32 s23, 2629632, 1073741824
  v_lshl_add_u32 v225, v16, 2, s23
  v_mov_b32 v229, 0
  v_writelane_b32 v225, s80, 0
  v_writelane_b32 v225, s3, 1
  v_writelane_b32 v225, s31, 2
  s_add_u32 s31, s31, 32
  v_writelane_b32 v225, s31, 5
  s_and_b32 s23, s2, 1
  s_lshl_b32 s23, s23, 2
  s_add_u32 s23, s23, s20
  s_lshl_b32 s23, s23, 7
  s_lshr_b32 s31, s2, 1
  s_add_u32 s23, s23, s31
  s_lshl_b32 s23, s23, 2
  s_add_u32 s23, s23, 2654208
  v_writelane_b32 v225, s23, 3
  v_writelane_b32 v225, s62, 4
  s_and_b32 s23, s21, 3
  s_lshr_b32 s31, s23, 1
  s_lshl_b32 s31, 4, s31
  s_bitcmp1_b32 s23, 0
  s_cselect_b32 s76, s31, 0
  s_cselect_b32 s72, 0, s31
  s_or_b32 s76, s76, 0x20
  s_or_b32 s72, s72, 0x25
  v_mov_b32 v20, 0
  v_mov_b32 v21, 0
  v_mov_b32 v22, 0
  v_mov_b32 v23, 0
  v_lshrrev_b32 v17, 4, v1
  v_lshrrev_b32 v18, 3, v16
  v_mul_u32_u24 v18, 3, v18
  v_xor_b32 v18, v18, v17
  v_lshlrev_b32 v18, 4, v18
  v_lshl_add_u32 v14, v16, 6, v18
  s_and_b32 s23, s20, 1
  s_lshl_b32 s23, s23, 11
  v_add_u32 v14, s23, v14
  v_mfma_f32_32x32x16_bf16 a[0:15], v[20:23], v[20:23], 0
  v_lshrrev_b32 v18, 2, v16
  v_lshlrev_b32 v18, 6, v18
  v_lshl_add_u32 v18, v17, 11, v18
  v_and_b32 v19, 1, v1
  v_mfma_f32_32x32x16_bf16 a[16:31], v[20:23], v[20:23], 0
  v_lshl_add_u32 v18, v19, 3, v18
  v_bfe_u32 v19, v1, 1, 1
  v_and_b32 v17, 1, v17
  v_lshl_or_b32 v19, v17, 1, v19
  v_mfma_f32_32x32x16_bf16 a[32:47], v[20:23], v[20:23], 0
  s_lshr_b32 s23, s20, 1
  s_lshl_b32 s23, s23, 13
  s_add_u32 s23, s23, 16384
  v_add_u32 v18, s23, v18
  v_mfma_f32_32x32x16_bf16 a[48:63], v[20:23], v[20:23], 0
  v_lshl_add_u32 v12, v19, 4, v18
  v_xor_b32 v13, 32, v12
  v_mov_b32 v19, 1073741824
  v_lshlrev_b32 v220, 4, v220
  v_mfma_f32_32x32x16_bf16 a[64:79], v[20:23], v[20:23], 0
  v_lshl_add_u32 v220, v208, 7, v220
  v_add_u32 v220, 131072, v220
  v_lshlrev_b32 v222, 2, v209
  v_cmp_eq_u32 vcc, 0, v208
  v_mfma_f32_32x32x16_bf16 a[80:95], v[20:23], v[20:23], 0
  v_add_u32 v222, 2621440, v222
  v_lshlrev_b32 v221, 4, v0
  v_cndmask_b32 v222, v19, v222, vcc
  v_add_u32 v221, 131072, v221
  v_mfma_f32_32x32x16_bf16 a[96:111], v[20:23], v[20:23], 0
  v_sub_u32 v209, 0xffff, v209
  v_lshrrev_b32 v223, 3, v0
  v_and_b32 v18, 7, v0
  v_lshlrev_b32 v18, 4, v18
  v_mfma_f32_32x32x16_bf16 a[112:127], v[20:23], v[20:23], 0
  v_cmp_gt_u32 vcc, 128, v0
  v_lshl_add_u32 v223, v223, 8, v18
  s_lshr_b32 s66, s2, 1
  s_mul_i32 s66, s66, 20480
  v_mfma_f32_32x32x16_bf16 a[128:143], v[20:23], v[20:23], 0
  s_and_b32 s31, s2, 1
  s_lshl_b32 s31, s31, 7
  s_add_u32 s66, s66, s31
  v_cndmask_b32 v224, v19, v223, vcc
  v_mfma_f32_32x32x16_bf16 a[144:159], v[20:23], v[20:23], 0
  s_add_u32 s67, s66, 8192
  s_add_u32 s78, s66, 16384
  s_mov_b32 s28, 0
  v_mfma_f32_32x32x16_bf16 a[160:175], v[20:23], v[20:23], 0
  v_mfma_f32_32x32x16_bf16 a[176:191], v[20:23], v[20:23], 0
  v_mfma_f32_32x32x16_bf16 a[192:207], v[20:23], v[20:23], 0
  v_mfma_f32_32x32x16_bf16 a[208:223], v[20:23], v[20:23], 0
  v_mfma_f32_32x32x16_bf16 a[224:239], v[20:23], v[20:23], 0
  v_mfma_f32_32x32x16_bf16 a[240:255], v[20:23], v[20:23], 0
  s_waitcnt vmcnt(5)
  v_lshlrev_b32 v184, 16, v160
  v_and_b32 v185, 0xffff0000, v160
  v_lshlrev_b32 v186, 16, v161
  v_and_b32 v187, 0xffff0000, v161
  v_lshlrev_b32 v188, 16, v162
  v_and_b32 v189, 0xffff0000, v162
  v_lshlrev_b32 v190, 16, v163
  v_and_b32 v191, 0xffff0000, v163
  v_lshlrev_b32 v192, 16, v164
  v_and_b32 v193, 0xffff0000, v164
  v_lshlrev_b32 v194, 16, v165
  v_and_b32 v195, 0xffff0000, v165
  v_lshlrev_b32 v196, 16, v166
  v_and_b32 v197, 0xffff0000, v166
  v_lshlrev_b32 v198, 16, v167
  v_and_b32 v199, 0xffff0000, v167
  v_lshlrev_b32 v200, 16, v168
  v_and_b32 v201, 0xffff0000, v168
  v_lshlrev_b32 v202, 16, v169
  v_and_b32 v203, 0xffff0000, v169
  v_lshlrev_b32 v204, 16, v170
  v_and_b32 v205, 0xffff0000, v170
  v_lshlrev_b32 v206, 16, v171
  v_and_b32 v207, 0xffff0000, v171
  v_pk_add_f32 v[16:17], v[184:185], v[186:187]
  v_pk_add_f32 v[18:19], v[188:189], v[190:191]
  v_pk_add_f32 v[16:17], v[16:17], v[192:193]
  v_pk_add_f32 v[18:19], v[18:19], v[194:195]
  v_pk_add_f32 v[16:17], v[16:17], v[196:197]
  v_pk_add_f32 v[18:19], v[18:19], v[198:199]
  v_pk_add_f32 v[16:17], v[16:17], v[200:201]
  v_pk_add_f32 v[18:19], v[18:19], v[202:203]
  v_pk_add_f32 v[16:17], v[16:17], v[204:205]
  v_pk_add_f32 v[18:19], v[18:19], v[206:207]
  v_pk_add_f32 v[16:17], v[16:17], v[18:19]
  v_add_f32 v213, v16, v17
  s_nop 1
  v_add_f32_dpp v213, v213, v213 quad_perm:[1,0,3,2] row_mask:0xf bank_mask:0xf
  s_nop 1
  v_add_f32_dpp v213, v213, v213 quad_perm:[2,3,0,1] row_mask:0xf bank_mask:0xf
  s_nop 1
  v_add_f32_dpp v213, v213, v213 row_half_mirror row_mask:0xf bank_mask:0xf
  s_nop 1
  v_add_f32_dpp v213, v213, v213 row_mirror row_mask:0xf bank_mask:0xf
  v_mov_b32 v214, v213
  s_nop 1
  v_permlane16_swap_b32 v213, v214
  v_add_f32 v213, v213, v214
  v_mul_f32 v216, 0xbacccccd, v213
  v_mul_f32 v217, 0xbacccccd, v213
  v_pk_add_f32 v[20:21], v[184:185], v[216:217]
  v_pk_mul_f32 v[16:17], v[20:21], v[20:21]
  v_pk_add_f32 v[22:23], v[186:187], v[216:217]
  v_pk_fma_f32 v[16:17], v[22:23], v[22:23], v[16:17]
  v_pk_add_f32 v[24:25], v[188:189], v[216:217]
  v_pk_fma_f32 v[16:17], v[24:25], v[24:25], v[16:17]
  v_pk_add_f32 v[26:27], v[190:191], v[216:217]
  v_pk_fma_f32 v[16:17], v[26:27], v[26:27], v[16:17]
  v_pk_add_f32 v[20:21], v[192:193], v[216:217]
  v_pk_fma_f32 v[16:17], v[20:21], v[20:21], v[16:17]
  v_pk_add_f32 v[22:23], v[194:195], v[216:217]
  v_pk_fma_f32 v[16:17], v[22:23], v[22:23], v[16:17]
  v_pk_add_f32 v[24:25], v[196:197], v[216:217]
  v_pk_fma_f32 v[16:17], v[24:25], v[24:25], v[16:17]
  v_pk_add_f32 v[26:27], v[198:199], v[216:217]
  v_pk_fma_f32 v[16:17], v[26:27], v[26:27], v[16:17]
  v_pk_add_f32 v[20:21], v[200:201], v[216:217]
  v_pk_mul_f32 v[18:19], v[20:21], v[20:21]
  v_pk_add_f32 v[22:23], v[202:203], v[216:217]
  v_pk_fma_f32 v[18:19], v[22:23], v[22:23], v[18:19]
  v_pk_add_f32 v[24:25], v[204:205], v[216:217]
  v_pk_fma_f32 v[18:19], v[24:25], v[24:25], v[18:19]
  v_pk_add_f32 v[26:27], v[206:207], v[216:217]
  v_pk_fma_f32 v[18:19], v[26:27], v[26:27], v[18:19]
  v_add_f32 v18, v18, v19
  v_add_f32 v213, v16, v17
  v_cndmask_b32 v18, 0, v18, s[64:65]
  v_add_f32 v213, v213, v18
  s_nop 1
  v_add_f32_dpp v213, v213, v213 quad_perm:[1,0,3,2] row_mask:0xf bank_mask:0xf
  s_nop 1
  v_add_f32_dpp v213, v213, v213 quad_perm:[2,3,0,1] row_mask:0xf bank_mask:0xf
  s_nop 1
  v_add_f32_dpp v213, v213, v213 row_half_mirror row_mask:0xf bank_mask:0xf
  s_nop 1
  v_add_f32_dpp v213, v213, v213 row_mirror row_mask:0xf bank_mask:0xf
  v_mov_b32 v214, v213
  s_nop 1
  v_permlane16_swap_b32 v213, v214
  v_add_f32 v213, v213, v214
  v_mul_f32 v213, 0x3acccccd, v213
  v_cvt_pk_bf16_f32 v213, v213, v213
  v_and_b32 v213, 0xffff0000, v213
  v_add_f32 v213, 0x3727c5ac, v213
  v_cvt_pk_bf16_f32 v213, v213, v213
  v_and_b32 v213, 0xffff0000, v213
  v_sqrt_f32 v213, v213
  v_cvt_pk_bf16_f32 v216, v216, v216
  v_and_b32 v216, 0xffff0000, v216
  v_cvt_pk_bf16_f32 v213, v213, v213
  v_and_b32 v213, 0xffff0000, v213
  v_rcp_f32 v28, v213
  v_mov_b32 v217, v216
  v_mov_b32 v29, v28
  v_pk_add_f32 v[184:185], v[184:185], v[216:217]
  v_lshlrev_b32 v16, 16, v172
  v_cvt_pk_bf16_f32 v185, v184, v185
  v_and_b32 v17, 0xffff0000, v172
  v_lshlrev_b32 v184, 16, v185
  v_and_b32 v185, 0xffff0000, v185
  v_pk_mul_f32 v[184:185], v[184:185], v[28:29]
  v_cvt_pk_bf16_f32 v160, v184, v185
  v_lshlrev_b32 v184, 16, v160
  v_and_b32 v185, 0xffff0000, v160
  v_pk_mul_f32 v[218:219], v[184:185], v[16:17]
  v_pk_add_f32 v[186:187], v[186:187], v[216:217]
  v_lshlrev_b32 v18, 16, v173
  v_cvt_pk_bf16_f32 v187, v186, v187
  v_and_b32 v19, 0xffff0000, v173
  v_lshlrev_b32 v186, 16, v187
  v_and_b32 v187, 0xffff0000, v187
  v_pk_mul_f32 v[186:187], v[186:187], v[28:29]
  v_cvt_pk_bf16_f32 v161, v186, v187
  v_lshlrev_b32 v186, 16, v161
  v_and_b32 v187, 0xffff0000, v161
  v_pk_fma_f32 v[218:219], v[186:187], v[18:19], v[218:219]
  v_pk_add_f32 v[188:189], v[188:189], v[216:217]
  v_lshlrev_b32 v16, 16, v174
  v_cvt_pk_bf16_f32 v189, v188, v189
  v_and_b32 v17, 0xffff0000, v174
  v_lshlrev_b32 v188, 16, v189
  v_and_b32 v189, 0xffff0000, v189
  v_pk_mul_f32 v[188:189], v[188:189], v[28:29]
  v_cvt_pk_bf16_f32 v162, v188, v189
  v_lshlrev_b32 v188, 16, v162
  v_and_b32 v189, 0xffff0000, v162
  v_pk_fma_f32 v[218:219], v[188:189], v[16:17], v[218:219]
  v_pk_add_f32 v[190:191], v[190:191], v[216:217]
  v_lshlrev_b32 v18, 16, v175
  v_cvt_pk_bf16_f32 v191, v190, v191
  v_and_b32 v19, 0xffff0000, v175
  v_lshlrev_b32 v190, 16, v191
  v_and_b32 v191, 0xffff0000, v191
  v_pk_mul_f32 v[190:191], v[190:191], v[28:29]
  v_cvt_pk_bf16_f32 v163, v190, v191
  v_lshlrev_b32 v190, 16, v163
  v_and_b32 v191, 0xffff0000, v163
  v_pk_fma_f32 v[218:219], v[190:191], v[18:19], v[218:219]
  ds_write_b128 v220, v[160:163] offset:0
  v_pk_add_f32 v[192:193], v[192:193], v[216:217]
  v_lshlrev_b32 v16, 16, v176
  v_cvt_pk_bf16_f32 v193, v192, v193
  v_and_b32 v17, 0xffff0000, v176
  v_lshlrev_b32 v192, 16, v193
  v_and_b32 v193, 0xffff0000, v193
  v_pk_mul_f32 v[192:193], v[192:193], v[28:29]
  v_cvt_pk_bf16_f32 v164, v192, v193
  v_lshlrev_b32 v192, 16, v164
  v_and_b32 v193, 0xffff0000, v164
  v_pk_fma_f32 v[218:219], v[192:193], v[16:17], v[218:219]
  v_pk_add_f32 v[194:195], v[194:195], v[216:217]
  v_lshlrev_b32 v18, 16, v177
  v_cvt_pk_bf16_f32 v195, v194, v195
  v_and_b32 v19, 0xffff0000, v177
  v_lshlrev_b32 v194, 16, v195
  v_and_b32 v195, 0xffff0000, v195
  v_pk_mul_f32 v[194:195], v[194:195], v[28:29]
  v_cvt_pk_bf16_f32 v165, v194, v195
  v_lshlrev_b32 v194, 16, v165
  v_and_b32 v195, 0xffff0000, v165
  v_pk_fma_f32 v[218:219], v[194:195], v[18:19], v[218:219]
  v_pk_add_f32 v[196:197], v[196:197], v[216:217]
  v_lshlrev_b32 v16, 16, v178
  v_cvt_pk_bf16_f32 v197, v196, v197
  v_and_b32 v17, 0xffff0000, v178
  v_lshlrev_b32 v196, 16, v197
  v_and_b32 v197, 0xffff0000, v197
  v_pk_mul_f32 v[196:197], v[196:197], v[28:29]
  v_cvt_pk_bf16_f32 v166, v196, v197
  v_lshlrev_b32 v196, 16, v166
  v_and_b32 v197, 0xffff0000, v166
  v_pk_fma_f32 v[218:219], v[196:197], v[16:17], v[218:219]
  v_pk_add_f32 v[198:199], v[198:199], v[216:217]
  v_lshlrev_b32 v18, 16, v179
  v_cvt_pk_bf16_f32 v199, v198, v199
  v_and_b32 v19, 0xffff0000, v179
  v_lshlrev_b32 v198, 16, v199
  v_and_b32 v199, 0xffff0000, v199
  v_pk_mul_f32 v[198:199], v[198:199], v[28:29]
  v_cvt_pk_bf16_f32 v167, v198, v199
  v_lshlrev_b32 v198, 16, v167
  v_and_b32 v199, 0xffff0000, v167
  v_pk_fma_f32 v[218:219], v[198:199], v[18:19], v[218:219]
  ds_write_b128 v220, v[164:167] offset:4096
  v_pk_add_f32 v[200:201], v[200:201], v[216:217]
  v_lshlrev_b32 v16, 16, v180
  v_cvt_pk_bf16_f32 v201, v200, v201
  v_and_b32 v17, 0xffff0000, v180
  v_lshlrev_b32 v200, 16, v201
  v_and_b32 v201, 0xffff0000, v201
  v_pk_mul_f32 v[200:201], v[200:201], v[28:29]
  v_cvt_pk_bf16_f32 v168, v200, v201
  v_lshlrev_b32 v200, 16, v168
  v_and_b32 v201, 0xffff0000, v168
  v_pk_fma_f32 v[218:219], v[200:201], v[16:17], v[218:219]
  v_pk_add_f32 v[202:203], v[202:203], v[216:217]
  v_lshlrev_b32 v18, 16, v181
  v_cvt_pk_bf16_f32 v203, v202, v203
  v_and_b32 v19, 0xffff0000, v181
  v_lshlrev_b32 v202, 16, v203
  v_and_b32 v203, 0xffff0000, v203
  v_pk_mul_f32 v[202:203], v[202:203], v[28:29]
  v_cvt_pk_bf16_f32 v169, v202, v203
  v_lshlrev_b32 v202, 16, v169
  v_and_b32 v203, 0xffff0000, v169
  v_pk_fma_f32 v[218:219], v[202:203], v[18:19], v[218:219]
  v_pk_add_f32 v[204:205], v[204:205], v[216:217]
  v_lshlrev_b32 v16, 16, v182
  v_cvt_pk_bf16_f32 v205, v204, v205
  v_and_b32 v17, 0xffff0000, v182
  v_lshlrev_b32 v204, 16, v205
  v_and_b32 v205, 0xffff0000, v205
  v_pk_mul_f32 v[204:205], v[204:205], v[28:29]
  v_cvt_pk_bf16_f32 v170, v204, v205
  v_lshlrev_b32 v204, 16, v170
  v_and_b32 v205, 0xffff0000, v170
  v_pk_fma_f32 v[218:219], v[204:205], v[16:17], v[218:219]
  v_pk_add_f32 v[206:207], v[206:207], v[216:217]
  v_lshlrev_b32 v18, 16, v183
  v_cvt_pk_bf16_f32 v207, v206, v207
  v_and_b32 v19, 0xffff0000, v183
  v_lshlrev_b32 v206, 16, v207
  v_and_b32 v207, 0xffff0000, v207
  v_pk_mul_f32 v[206:207], v[206:207], v[28:29]
  v_cvt_pk_bf16_f32 v171, v206, v207
  v_lshlrev_b32 v206, 16, v171
  v_and_b32 v207, 0xffff0000, v171
  v_pk_fma_f32 v[218:219], v[206:207], v[18:19], v[218:219]
  ds_write_b128 v220, v[168:171] offset:8192
  v_add_f32 v218, v218, v219
  s_nop 1
  v_add_f32_dpp v218, v218, v218 quad_perm:[1,0,3,2] row_mask:0xf bank_mask:0xf
  s_nop 1
  v_add_f32_dpp v218, v218, v218 quad_perm:[2,3,0,1] row_mask:0xf bank_mask:0xf
  s_nop 1
  v_add_f32_dpp v218, v218, v218 row_half_mirror row_mask:0xf bank_mask:0xf
  s_nop 1
  v_add_f32_dpp v218, v218, v218 row_mirror row_mask:0xf bank_mask:0xf
  v_mov_b32 v214, v218
  s_nop 1
  v_permlane16_swap_b32 v218, v214
  v_add_f32 v218, v218, v214
  v_cvt_pk_bf16_f32 v218, v218, v218
  v_and_b32 v218, 0xffff0000, v218
  v_ashrrev_i32 v214, 31, v218
  v_or_b32 v214, 0x80000000, v214
  v_xor_b32 v218, v218, v214
  v_and_b32 v218, 0xffff0000, v218
  v_or_b32 v218, v218, v209
  v_mov_b32 v19, 1073741824
  s_mov_b32 m0, s24
  s_nop 0
  buffer_load_dwordx4 v3, s[32:35], s26 offen offset:0 sc1 lds
  buffer_load_dwordx4 v4, s[32:35], s26 offen offset:1024 sc1 lds
  buffer_load_dwordx4 v5, s[32:35], s26 offen offset:2048 sc1 lds
  buffer_load_dwordx4 v6, s[32:35], s26 offen offset:3072 sc1 lds
  s_add_u32 m0, s24, 16384
  s_nop 0
  buffer_load_dwordx4 v8, s[36:39], s27 offen offset:0 lds
  buffer_load_dwordx4 v9, s[36:39], s27 offen offset:1024 lds
  buffer_load_dwordx4 v10, s[36:39], s27 offen offset:2048 lds
  buffer_load_dwordx4 v11, s[36:39], s27 offen offset:3072 lds
  s_add_u32 s26, s26, s79
  s_add_u32 s27, s27, s25
  s_add_u32 s24, s24, 32768
  s_and_b32 s24, s24, 0x1ffff
  s_mov_b32 m0, s24
  s_nop 0
  buffer_load_dwordx4 v3, s[32:35], s26 offen offset:0 sc1 lds
  buffer_load_dwordx4 v4, s[32:35], s26 offen offset:1024 sc1 lds
  buffer_load_dwordx4 v5, s[32:35], s26 offen offset:2048 sc1 lds
  buffer_load_dwordx4 v6, s[32:35], s26 offen offset:3072 sc1 lds
  s_add_u32 m0, s24, 16384
  s_nop 0
  buffer_load_dwordx4 v8, s[36:39], s27 offen offset:0 lds
  buffer_load_dwordx4 v9, s[36:39], s27 offen offset:1024 lds
  buffer_load_dwordx4 v10, s[36:39], s27 offen offset:2048 lds
  buffer_load_dwordx4 v11, s[36:39], s27 offen offset:3072 lds
  s_add_u32 s26, s26, s79
  s_add_u32 s27, s27, s25
  s_add_u32 s24, s24, 32768
  s_and_b32 s24, s24, 0x1ffff
  s_mov_b32 m0, s24
  s_nop 0
  buffer_load_dwordx4 v3, s[32:35], s26 offen offset:0 sc1 lds
  buffer_load_dwordx4 v4, s[32:35], s26 offen offset:1024 sc1 lds
  buffer_load_dwordx4 v5, s[32:35], s26 offen offset:2048 sc1 lds
  buffer_load_dwordx4 v6, s[32:35], s26 offen offset:3072 sc1 lds
  s_add_u32 m0, s24, 16384
  s_nop 0
  buffer_load_dwordx4 v8, s[36:39], s27 offen offset:0 lds
  buffer_load_dwordx4 v9, s[36:39], s27 offen offset:1024 lds
  buffer_load_dwordx4 v10, s[36:39], s27 offen offset:2048 lds
  buffer_load_dwordx4 v11, s[36:39], s27 offen offset:3072 lds
  s_add_u32 s26, s26, s79
  s_add_u32 s27, s27, s25
  s_add_u32 s24, s24, 32768
  s_and_b32 s24, s24, 0x1ffff
  buffer_load_dword v231, v19, s[32:35], 0 offen
  s_mov_b32 m0, s24
  s_nop 0
  buffer_load_dwordx4 v3, s[32:35], s26 offen offset:0 sc1 lds
  buffer_load_dwordx4 v4, s[32:35], s26 offen offset:1024 sc1 lds
  buffer_load_dwordx4 v5, s[32:35], s26 offen offset:2048 sc1 lds
  buffer_load_dwordx4 v6, s[32:35], s26 offen offset:3072 sc1 lds
  s_add_u32 m0, s24, 16384
  s_nop 0
  buffer_load_dwordx4 v8, s[36:39], s27 offen offset:0 lds
  buffer_load_dwordx4 v9, s[36:39], s27 offen offset:1024 lds
  buffer_load_dwordx4 v10, s[36:39], s27 offen offset:2048 lds
  buffer_load_dwordx4 v11, s[36:39], s27 offen offset:3072 lds
  s_add_u32 s26, s26, s79
  s_add_u32 s27, s27, s25
  s_add_u32 s24, s24, 32768
  s_and_b32 s24, s24, 0x1ffff
  s_waitcnt vmcnt(25) lgkmcnt(0)
  s_barrier
  s_cmp_ge_u32 s20, 2
  s_cbranch_scc1 fa_roleV
  ds_read_b128 v[96:99], v14 offset:0
  ds_read_b128 v[100:103], v14 offset:1024
  ds_read_b128 v[104:107], v14 offset:4096
  ds_read_b128 v[108:111], v14 offset:5120
  ds_read_b128 v[112:115], v14 offset:8192
  ds_read_b128 v[116:119], v14 offset:9216
  ds_read_b128 v[120:123], v14 offset:12288
  ds_read_b128 v[124:127], v14 offset:13312
  ds_read_b64_tr_b16 v[32:33], v12 offset:0
  ds_read_b64_tr_b16 v[34:35], v12 offset:1024
  ds_read_b64_tr_b16 v[36:37], v13 offset:0
  ds_read_b64_tr_b16 v[38:39], v13 offset:1024
  ds_read_b64_tr_b16 v[40:41], v12 offset:256
  ds_read_b64_tr_b16 v[42:43], v12 offset:1280
  ds_read_b64_tr_b16 v[44:45], v13 offset:256
  ds_read_b64_tr_b16 v[46:47], v13 offset:1280
  ds_read_b64_tr_b16 v[48:49], v12 offset:512
  ds_read_b64_tr_b16 v[50:51], v12 offset:1536
  ds_read_b64_tr_b16 v[52:53], v13 offset:512
  ds_read_b64_tr_b16 v[54:55], v13 offset:1536
  ds_read_b64_tr_b16 v[56:57], v12 offset:768
  ds_read_b64_tr_b16 v[58:59], v12 offset:1792
  ds_read_b64_tr_b16 v[60:61], v13 offset:768
  ds_read_b64_tr_b16 v[62:63], v13 offset:1792
  s_waitcnt lgkmcnt(0)
.p2align 6
fa_loopK:
  v_mfma_f32_16x16x32_bf16 a[192:195], v[32:35], v[96:99], a[192:195]
  s_waitcnt vmcnt(17)
  v_mfma_f32_16x16x32_bf16 a[200:203], v[32:35], v[100:103], a[200:203]
  s_barrier
  v_mfma_f32_16x16x32_bf16 a[0:3], v[32:35], v[104:107], a[0:3]
  ds_read_b64_tr_b16 v[64:65], v12 offset:32768
  v_mfma_f32_16x16x32_bf16 a[8:11], v[32:35], v[108:111], a[8:11]
  v_mfma_f32_16x16x32_bf16 a[64:67], v[32:35], v[112:115], a[64:67]
  s_mov_b32 m0, s24
  ds_read_b64_tr_b16 v[66:67], v12 offset:33792
  v_mfma_f32_16x16x32_bf16 a[72:75], v[32:35], v[116:119], a[72:75]
  buffer_load_dwordx4 v3, s[32:35], s26 offen offset:0 sc1 lds
  v_mfma_f32_16x16x32_bf16 a[128:131], v[32:35], v[120:123], a[128:131]
  ds_read_b128 v[128:131], v14 offset:32768
  v_mfma_f32_16x16x32_bf16 a[136:139], v[32:35], v[124:127], a[136:139]
  buffer_load_dwordx4 v4, s[32:35], s26 offen offset:1024 sc1 lds
  v_mfma_f32_16x16x32_bf16 a[196:199], v[36:39], v[96:99], a[196:199]
  ds_read_b64_tr_b16 v[68:69], v13 offset:32768
  v_mfma_f32_16x16x32_bf16 a[204:207], v[36:39], v[100:103], a[204:207]
  buffer_load_dwordx4 v5, s[32:35], s26 offen offset:2048 sc1 lds
  v_mfma_f32_16x16x32_bf16 a[4:7], v[36:39], v[104:107], a[4:7]
  ds_read_b64_tr_b16 v[70:71], v13 offset:33792
  v_mfma_f32_16x16x32_bf16 a[12:15], v[36:39], v[108:111], a[12:15]
  buffer_load_dwordx4 v6, s[32:35], s26 offen offset:3072 sc1 lds
  v_mfma_f32_16x16x32_bf16 a[68:71], v[36:39], v[112:115], a[68:71]
  s_add_u32 m0, s24, 16384
  ds_read_b128 v[132:135], v14 offset:33792
  v_mfma_f32_16x16x32_bf16 a[76:79], v[36:39], v[116:119], a[76:79]
  buffer_load_dwordx4 v8, s[36:39], s27 offen offset:0 lds
  v_mfma_f32_16x16x32_bf16 a[132:135], v[36:39], v[120:123], a[132:135]
  ds_read_b64_tr_b16 v[72:73], v12 offset:33024
  v_mfma_f32_16x16x32_bf16 a[140:143], v[36:39], v[124:127], a[140:143]
  buffer_load_dwordx4 v9, s[36:39], s27 offen offset:1024 lds
  v_mfma_f32_16x16x32_bf16 a[208:211], v[40:43], v[96:99], a[208:211]
  ds_read_b64_tr_b16 v[74:75], v12 offset:34048
  v_mfma_f32_16x16x32_bf16 a[216:219], v[40:43], v[100:103], a[216:219]
  buffer_load_dwordx4 v10, s[36:39], s27 offen offset:2048 lds
  v_mfma_f32_16x16x32_bf16 a[16:19], v[40:43], v[104:107], a[16:19]
  ds_read_b128 v[136:139], v14 offset:36864
  v_mfma_f32_16x16x32_bf16 a[24:27], v[40:43], v[108:111], a[24:27]
  buffer_load_dwordx4 v11, s[36:39], s27 offen offset:3072 lds
  v_mfma_f32_16x16x32_bf16 a[80:83], v[40:43], v[112:115], a[80:83]
  ds_read_b64_tr_b16 v[76:77], v13 offset:33024
  v_mfma_f32_16x16x32_bf16 a[88:91], v[40:43], v[116:119], a[88:91]
  buffer_load_dword v231, v235, s[48:51], s74 offen sc1
  v_mfma_f32_16x16x32_bf16 a[144:147], v[40:43], v[120:123], a[144:147]
  s_add_u32 s74, s74, s73
  ds_read_b64_tr_b16 v[78:79], v13 offset:34048
  v_mfma_f32_16x16x32_bf16 a[152:155], v[40:43], v[124:127], a[152:155]
  s_bitcmp1_b32 s72, s28
  v_mfma_f32_16x16x32_bf16 a[212:215], v[44:47], v[96:99], a[212:215]
  s_cbranch_scc1 fa_hk0
fa_hb0:
  ds_read_b128 v[140:143], v14 offset:37888
  v_mfma_f32_16x16x32_bf16 a[220:223], v[44:47], v[100:103], a[220:223]
  v_mfma_f32_16x16x32_bf16 a[20:23], v[44:47], v[104:107], a[20:23]
  ds_read_b64_tr_b16 v[80:81], v12 offset:33280
  v_mfma_f32_16x16x32_bf16 a[28:31], v[44:47], v[108:111], a[28:31]
  v_mfma_f32_16x16x32_bf16 a[84:87], v[44:47], v[112:115], a[84:87]
  ds_read_b64_tr_b16 v[82:83], v12 offset:34304
  v_mfma_f32_16x16x32_bf16 a[92:95], v[44:47], v[116:119], a[92:95]
  v_mfma_f32_16x16x32_bf16 a[148:151], v[44:47], v[120:123], a[148:151]
  ds_read_b128 v[144:147], v14 offset:40960
  v_mfma_f32_16x16x32_bf16 a[156:159], v[44:47], v[124:127], a[156:159]
  v_mfma_f32_16x16x32_bf16 a[224:227], v[48:51], v[96:99], a[224:227]
  ds_read_b64_tr_b16 v[84:85], v13 offset:33280
  v_mfma_f32_16x16x32_bf16 a[232:235], v[48:51], v[100:103], a[232:235]
  v_mfma_f32_16x16x32_bf16 a[32:35], v[48:51], v[104:107], a[32:35]
  ds_read_b64_tr_b16 v[86:87], v13 offset:34304
  v_mfma_f32_16x16x32_bf16 a[40:43], v[48:51], v[108:111], a[40:43]
  v_mfma_f32_16x16x32_bf16 a[96:99], v[48:51], v[112:115], a[96:99]
  ds_read_b128 v[148:151], v14 offset:41984
  v_mfma_f32_16x16x32_bf16 a[104:107], v[48:51], v[116:119], a[104:107]
  v_mfma_f32_16x16x32_bf16 a[160:163], v[48:51], v[120:123], a[160:163]
  ds_read_b64_tr_b16 v[88:89], v12 offset:33536
  v_mfma_f32_16x16x32_bf16 a[168:171], v[48:51], v[124:127], a[168:171]
  v_mfma_f32_16x16x32_bf16 a[228:231], v[52:55], v[96:99], a[228:231]
  ds_read_b64_tr_b16 v[90:91], v12 offset:34560
  v_mfma_f32_16x16x32_bf16 a[236:239], v[52:55], v[100:103], a[236:239]
  v_mfma_f32_16x16x32_bf16 a[36:39], v[52:55], v[104:107], a[36:39]
  ds_read_b128 v[152:155], v14 offset:45056
  v_mfma_f32_16x16x32_bf16 a[44:47], v[52:55], v[108:111], a[44:47]
  v_mfma_f32_16x16x32_bf16 a[100:103], v[52:55], v[112:115], a[100:103]
  ds_read_b64_tr_b16 v[92:93], v13 offset:33536
  v_mfma_f32_16x16x32_bf16 a[108:111], v[52:55], v[116:119], a[108:111]
  v_mfma_f32_16x16x32_bf16 a[164:167], v[52:55], v[120:123], a[164:167]
  ds_read_b64_tr_b16 v[94:95], v13 offset:34560
  v_mfma_f32_16x16x32_bf16 a[172:175], v[52:55], v[124:127], a[172:175]
  v_mfma_f32_16x16x32_bf16 a[240:243], v[56:59], v[96:99], a[240:243]
  s_add_u32 s26, s26, s79
  ds_read_b128 v[156:159], v14 offset:46080
  v_mfma_f32_16x16x32_bf16 a[248:251], v[56:59], v[100:103], a[248:251]
  s_add_u32 s27, s27, s25
  v_mfma_f32_16x16x32_bf16 a[48:51], v[56:59], v[104:107], a[48:51]
  s_add_u32 s24, s24, 32768
  v_mfma_f32_16x16x32_bf16 a[56:59], v[56:59], v[108:111], a[56:59]
  s_and_b32 s24, s24, 0x1ffff
  v_mfma_f32_16x16x32_bf16 a[112:115], v[56:59], v[112:115], a[112:115]
  v_xor_b32 v14, 0x10000, v14
  v_mfma_f32_16x16x32_bf16 a[120:123], v[56:59], v[116:119], a[120:123]
  v_xor_b32 v12, 0x10000, v12
  v_mfma_f32_16x16x32_bf16 a[176:179], v[56:59], v[120:123], a[176:179]
  v_xor_b32 v13, 0x10000, v13
  v_mfma_f32_16x16x32_bf16 a[184:187], v[56:59], v[124:127], a[184:187]
  v_mfma_f32_16x16x32_bf16 a[244:247], v[60:63], v[96:99], a[244:247]
  v_mfma_f32_16x16x32_bf16 a[252:255], v[60:63], v[100:103], a[252:255]
  v_mfma_f32_16x16x32_bf16 a[52:55], v[60:63], v[104:107], a[52:55]
  v_mfma_f32_16x16x32_bf16 a[60:63], v[60:63], v[108:111], a[60:63]
  v_mfma_f32_16x16x32_bf16 a[116:119], v[60:63], v[112:115], a[116:119]
  v_mfma_f32_16x16x32_bf16 a[124:127], v[60:63], v[116:119], a[124:127]
  v_mfma_f32_16x16x32_bf16 a[180:183], v[60:63], v[120:123], a[180:183]
  v_mfma_f32_16x16x32_bf16 a[188:191], v[60:63], v[124:127], a[188:191]
  s_waitcnt lgkmcnt(0)
  v_mfma_f32_16x16x32_bf16 a[192:195], v[64:67], v[128:131], a[192:195]
  s_waitcnt vmcnt(18)
  v_mfma_f32_16x16x32_bf16 a[200:203], v[64:67], v[132:135], a[200:203]
  s_barrier
  v_mfma_f32_16x16x32_bf16 a[0:3], v[64:67], v[136:139], a[0:3]
  ds_read_b64_tr_b16 v[32:33], v12 offset:0
  v_mfma_f32_16x16x32_bf16 a[8:11], v[64:67], v[140:143], a[8:11]
  v_mfma_f32_16x16x32_bf16 a[64:67], v[64:67], v[144:147], a[64:67]
  s_mov_b32 m0, s24
  ds_read_b64_tr_b16 v[34:35], v12 offset:1024
  v_mfma_f32_16x16x32_bf16 a[72:75], v[64:67], v[148:151], a[72:75]
  buffer_load_dwordx4 v3, s[32:35], s26 offen offset:0 sc1 lds
  v_mfma_f32_16x16x32_bf16 a[128:131], v[64:67], v[152:155], a[128:131]
  ds_read_b128 v[96:99], v14 offset:0
  v_mfma_f32_16x16x32_bf16 a[136:139], v[64:67], v[156:159], a[136:139]
  v_mfma_f32_16x16x32_bf16 a[196:199], v[68:71], v[128:131], a[196:199]
  ds_read_b64_tr_b16 v[36:37], v13 offset:0
  v_mfma_f32_16x16x32_bf16 a[204:207], v[68:71], v[132:135], a[204:207]
  v_mfma_f32_16x16x32_bf16 a[4:7], v[68:71], v[136:139], a[4:7]
  ds_read_b64_tr_b16 v[38:39], v13 offset:1024
  v_mfma_f32_16x16x32_bf16 a[12:15], v[68:71], v[140:143], a[12:15]
  buffer_load_dwordx4 v4, s[32:35], s26 offen offset:1024 sc1 lds
  v_mfma_f32_16x16x32_bf16 a[68:71], v[68:71], v[144:147], a[68:71]
  ds_read_b128 v[100:103], v14 offset:1024
  v_mfma_f32_16x16x32_bf16 a[76:79], v[68:71], v[148:151], a[76:79]
  v_mfma_f32_16x16x32_bf16 a[132:135], v[68:71], v[152:155], a[132:135]
  ds_read_b64_tr_b16 v[40:41], v12 offset:256
  v_mfma_f32_16x16x32_bf16 a[140:143], v[68:71], v[156:159], a[140:143]
  v_mfma_f32_16x16x32_bf16 a[208:211], v[72:75], v[128:131], a[208:211]
  ds_read_b64_tr_b16 v[42:43], v12 offset:1280
  v_mfma_f32_16x16x32_bf16 a[216:219], v[72:75], v[132:135], a[216:219]
  buffer_load_dwordx4 v5, s[32:35], s26 offen offset:2048 sc1 lds
  v_mfma_f32_16x16x32_bf16 a[16:19], v[72:75], v[136:139], a[16:19]
  ds_read_b128 v[104:107], v14 offset:4096
  v_mfma_f32_16x16x32_bf16 a[24:27], v[72:75], v[140:143], a[24:27]
  v_mfma_f32_16x16x32_bf16 a[80:83], v[72:75], v[144:147], a[80:83]
  ds_read_b64_tr_b16 v[44:45], v13 offset:256
  v_mfma_f32_16x16x32_bf16 a[88:91], v[72:75], v[148:151], a[88:91]
  v_mfma_f32_16x16x32_bf16 a[144:147], v[72:75], v[152:155], a[144:147]
  ds_read_b64_tr_b16 v[46:47], v13 offset:1280
  v_mfma_f32_16x16x32_bf16 a[152:155], v[72:75], v[156:159], a[152:155]
  buffer_load_dwordx4 v6, s[32:35], s26 offen offset:3072 sc1 lds
  v_mfma_f32_16x16x32_bf16 a[212:215], v[76:79], v[128:131], a[212:215]
  ds_read_b128 v[108:111], v14 offset:5120
  v_mfma_f32_16x16x32_bf16 a[220:223], v[76:79], v[132:135], a[220:223]
  v_mfma_f32_16x16x32_bf16 a[20:23], v[76:79], v[136:139], a[20:23]
  ds_read_b64_tr_b16 v[48:49], v12 offset:512
  v_mfma_f32_16x16x32_bf16 a[28:31], v[76:79], v[140:143], a[28:31]
  v_mfma_f32_16x16x32_bf16 a[84:87], v[76:79], v[144:147], a[84:87]
  s_add_u32 m0, s24, 16384
  ds_read_b64_tr_b16 v[50:51], v12 offset:1536
  v_mfma_f32_16x16x32_bf16 a[92:95], v[76:79], v[148:151], a[92:95]
  buffer_load_dwordx4 v8, s[36:39], s27 offen offset:0 lds
  v_mfma_f32_16x16x32_bf16 a[148:151], v[76:79], v[152:155], a[148:151]
  ds_read_b128 v[112:115], v14 offset:8192
  v_mfma_f32_16x16x32_bf16 a[156:159], v[76:79], v[156:159], a[156:159]
  v_mfma_f32_16x16x32_bf16 a[224:227], v[80:83], v[128:131], a[224:227]
  ds_read_b64_tr_b16 v[52:53], v13 offset:512
  v_mfma_f32_16x16x32_bf16 a[232:235], v[80:83], v[132:135], a[232:235]
  v_mfma_f32_16x16x32_bf16 a[32:35], v[80:83], v[136:139], a[32:35]
  ds_read_b64_tr_b16 v[54:55], v13 offset:1536
  v_mfma_f32_16x16x32_bf16 a[40:43], v[80:83], v[140:143], a[40:43]
  buffer_load_dwordx4 v9, s[36:39], s27 offen offset:1024 lds
  v_mfma_f32_16x16x32_bf16 a[96:99], v[80:83], v[144:147], a[96:99]
  ds_read_b128 v[116:119], v14 offset:9216
  v_mfma_f32_16x16x32_bf16 a[104:107], v[80:83], v[148:151], a[104:107]
  v_mfma_f32_16x16x32_bf16 a[160:163], v[80:83], v[152:155], a[160:163]
  ds_read_b64_tr_b16 v[56:57], v12 offset:768
  v_mfma_f32_16x16x32_bf16 a[168:171], v[80:83], v[156:159], a[168:171]
  v_mfma_f32_16x16x32_bf16 a[228:231], v[84:87], v[128:131], a[228:231]
  ds_read_b64_tr_b16 v[58:59], v12 offset:1792
  v_mfma_f32_16x16x32_bf16 a[236:239], v[84:87], v[132:135], a[236:239]
  buffer_load_dwordx4 v10, s[36:39], s27 offen offset:2048 lds
  v_mfma_f32_16x16x32_bf16 a[36:39], v[84:87], v[136:139], a[36:39]
  ds_read_b128 v[120:123], v14 offset:12288
  v_mfma_f32_16x16x32_bf16 a[44:47], v[84:87], v[140:143], a[44:47]
  v_mfma_f32_16x16x32_bf16 a[100:103], v[84:87], v[144:147], a[100:103]
  ds_read_b64_tr_b16 v[60:61], v13 offset:768
  v_mfma_f32_16x16x32_bf16 a[108:111], v[84:87], v[148:151], a[108:111]
  v_mfma_f32_16x16x32_bf16 a[164:167], v[84:87], v[152:155], a[164:167]
  ds_read_b64_tr_b16 v[62:63], v13 offset:1792
  v_mfma_f32_16x16x32_bf16 a[172:175], v[84:87], v[156:159], a[172:175]
  buffer_load_dwordx4 v11, s[36:39], s27 offen offset:3072 lds
  v_mfma_f32_16x16x32_bf16 a[240:243], v[88:91], v[128:131], a[240:243]
  s_add_u32 s26, s26, s79
  ds_read_b128 v[124:127], v14 offset:13312
  v_mfma_f32_16x16x32_bf16 a[248:251], v[88:91], v[132:135], a[248:251]
  s_add_u32 s27, s27, s25
  v_mfma_f32_16x16x32_bf16 a[48:51], v[88:91], v[136:139], a[48:51]
  s_add_u32 s24, s24, 32768
  v_mfma_f32_16x16x32_bf16 a[56:59], v[88:91], v[140:143], a[56:59]
  s_and_b32 s24, s24, 0x1ffff
  v_mfma_f32_16x16x32_bf16 a[112:115], v[88:91], v[144:147], a[112:115]
  v_mfma_f32_16x16x32_bf16 a[120:123], v[88:91], v[148:151], a[120:123]
  s_bitcmp1_b32 s76, s28
  v_mfma_f32_16x16x32_bf16 a[176:179], v[88:91], v[152:155], a[176:179]
  s_cbranch_scc1 fa_hk1
fa_hb1:
  v_mfma_f32_16x16x32_bf16 a[184:187], v[88:91], v[156:159], a[184:187]
  v_mfma_f32_16x16x32_bf16 a[244:247], v[92:95], v[128:131], a[244:247]
  v_mfma_f32_16x16x32_bf16 a[252:255], v[92:95], v[132:135], a[252:255]
  s_add_u32 s28, s28, 1
  v_mfma_f32_16x16x32_bf16 a[52:55], v[92:95], v[136:139], a[52:55]
  v_mfma_f32_16x16x32_bf16 a[60:63], v[92:95], v[140:143], a[60:63]
  v_mfma_f32_16x16x32_bf16 a[116:119], v[92:95], v[144:147], a[116:119]
  v_mfma_f32_16x16x32_bf16 a[124:127], v[92:95], v[148:151], a[124:127]
  s_cmp_lt_u32 s28, 8
  v_mfma_f32_16x16x32_bf16 a[180:183], v[92:95], v[152:155], a[180:183]
  s_waitcnt lgkmcnt(0)
  v_mfma_f32_16x16x32_bf16 a[188:191], v[92:95], v[156:159], a[188:191]
  s_cbranch_scc1 fa_loopK
  s_mov_b32 s64, 16777216
  s_mov_b32 s76, 0x3e0293ee
  s_branch fa_p1epi
fa_roleV:
  ds_read_b128 v[32:35], v14 offset:0
  ds_read_b128 v[36:39], v14 offset:1024
  ds_read_b128 v[40:43], v14 offset:4096
  ds_read_b128 v[44:47], v14 offset:5120
  ds_read_b128 v[48:51], v14 offset:8192
  ds_read_b128 v[52:55], v14 offset:9216
  ds_read_b128 v[56:59], v14 offset:12288
  ds_read_b128 v[60:63], v14 offset:13312
  ds_read_b64_tr_b16 v[96:97], v12 offset:0
  ds_read_b64_tr_b16 v[98:99], v12 offset:1024
  ds_read_b64_tr_b16 v[100:101], v13 offset:0
  ds_read_b64_tr_b16 v[102:103], v13 offset:1024
  ds_read_b64_tr_b16 v[104:105], v12 offset:256
  ds_read_b64_tr_b16 v[106:107], v12 offset:1280
  ds_read_b64_tr_b16 v[108:109], v13 offset:256
  ds_read_b64_tr_b16 v[110:111], v13 offset:1280
  ds_read_b64_tr_b16 v[112:113], v12 offset:512
  ds_read_b64_tr_b16 v[114:115], v12 offset:1536
  ds_read_b64_tr_b16 v[116:117], v13 offset:512
  ds_read_b64_tr_b16 v[118:119], v13 offset:1536
  ds_read_b64_tr_b16 v[120:121], v12 offset:768
  ds_read_b64_tr_b16 v[122:123], v12 offset:1792
  ds_read_b64_tr_b16 v[124:125], v13 offset:768
  ds_read_b64_tr_b16 v[126:127], v13 offset:1792
  s_waitcnt lgkmcnt(0)
.p2align 6
fa_loopV:
  v_mfma_f32_16x16x32_bf16 a[192:195], v[32:35], v[96:99], a[192:195]
  s_waitcnt vmcnt(17)
  v_mfma_f32_16x16x32_bf16 a[200:203], v[32:35], v[100:103], a[200:203]
  s_barrier
  v_mfma_f32_16x16x32_bf16 a[208:211], v[32:35], v[104:107], a[208:211]
  ds_read_b64_tr_b16 v[128:129], v12 offset:32768
  v_mfma_f32_16x16x32_bf16 a[216:219], v[32:35], v[108:111], a[216:219]
  v_mfma_f32_16x16x32_bf16 a[224:227], v[32:35], v[112:115], a[224:227]
  s_mov_b32 m0, s24
  ds_read_b64_tr_b16 v[130:131], v12 offset:33792
  v_mfma_f32_16x16x32_bf16 a[232:235], v[32:35], v[116:119], a[232:235]
  buffer_load_dwordx4 v3, s[32:35], s26 offen offset:0 sc1 lds
  v_mfma_f32_16x16x32_bf16 a[240:243], v[32:35], v[120:123], a[240:243]
  ds_read_b128 v[64:67], v14 offset:32768
  v_mfma_f32_16x16x32_bf16 a[248:251], v[32:35], v[124:127], a[248:251]
  buffer_load_dwordx4 v4, s[32:35], s26 offen offset:1024 sc1 lds
  v_mfma_f32_16x16x32_bf16 a[196:199], v[36:39], v[96:99], a[196:199]
  ds_read_b64_tr_b16 v[132:133], v13 offset:32768
  v_mfma_f32_16x16x32_bf16 a[204:207], v[36:39], v[100:103], a[204:207]
  buffer_load_dwordx4 v5, s[32:35], s26 offen offset:2048 sc1 lds
  v_mfma_f32_16x16x32_bf16 a[212:215], v[36:39], v[104:107], a[212:215]
  ds_read_b64_tr_b16 v[134:135], v13 offset:33792
  v_mfma_f32_16x16x32_bf16 a[220:223], v[36:39], v[108:111], a[220:223]
  buffer_load_dwordx4 v6, s[32:35], s26 offen offset:3072 sc1 lds
  v_mfma_f32_16x16x32_bf16 a[228:231], v[36:39], v[112:115], a[228:231]
  s_add_u32 m0, s24, 16384
  ds_read_b128 v[68:71], v14 offset:33792
  v_mfma_f32_16x16x32_bf16 a[236:239], v[36:39], v[116:119], a[236:239]
  buffer_load_dwordx4 v8, s[36:39], s27 offen offset:0 lds
  v_mfma_f32_16x16x32_bf16 a[244:247], v[36:39], v[120:123], a[244:247]
  ds_read_b64_tr_b16 v[136:137], v12 offset:33024
  v_mfma_f32_16x16x32_bf16 a[252:255], v[36:39], v[124:127], a[252:255]
  buffer_load_dwordx4 v9, s[36:39], s27 offen offset:1024 lds
  v_mfma_f32_16x16x32_bf16 a[0:3], v[40:43], v[96:99], a[0:3]
  ds_read_b64_tr_b16 v[138:139], v12 offset:34048
  v_mfma_f32_16x16x32_bf16 a[8:11], v[40:43], v[100:103], a[8:11]
  buffer_load_dwordx4 v10, s[36:39], s27 offen offset:2048 lds
  v_mfma_f32_16x16x32_bf16 a[16:19], v[40:43], v[104:107], a[16:19]
  ds_read_b128 v[72:75], v14 offset:36864
  v_mfma_f32_16x16x32_bf16 a[24:27], v[40:43], v[108:111], a[24:27]
  buffer_load_dwordx4 v11, s[36:39], s27 offen offset:3072 lds
  v_mfma_f32_16x16x32_bf16 a[32:35], v[40:43], v[112:115], a[32:35]
  ds_read_b64_tr_b16 v[140:141], v13 offset:33024
  v_mfma_f32_16x16x32_bf16 a[40:43], v[40:43], v[116:119], a[40:43]
  buffer_load_dword v231, v235, s[48:51], s74 offen sc1
  v_mfma_f32_16x16x32_bf16 a[48:51], v[40:43], v[120:123], a[48:51]
  s_add_u32 s74, s74, s73
  ds_read_b64_tr_b16 v[142:143], v13 offset:34048
  v_mfma_f32_16x16x32_bf16 a[56:59], v[40:43], v[124:127], a[56:59]
  s_bitcmp1_b32 s72, s28
  v_mfma_f32_16x16x32_bf16 a[4:7], v[44:47], v[96:99], a[4:7]
  s_cbranch_scc1 fa_hk2
fa_hb2:
  ds_read_b128 v[76:79], v14 offset:37888
  v_mfma_f32_16x16x32_bf16 a[12:15], v[44:47], v[100:103], a[12:15]
  v_mfma_f32_16x16x32_bf16 a[20:23], v[44:47], v[104:107], a[20:23]
  ds_read_b64_tr_b16 v[144:145], v12 offset:33280
  v_mfma_f32_16x16x32_bf16 a[28:31], v[44:47], v[108:111], a[28:31]
  v_mfma_f32_16x16x32_bf16 a[36:39], v[44:47], v[112:115], a[36:39]
  ds_read_b64_tr_b16 v[146:147], v12 offset:34304
  v_mfma_f32_16x16x32_bf16 a[44:47], v[44:47], v[116:119], a[44:47]
  v_mfma_f32_16x16x32_bf16 a[52:55], v[44:47], v[120:123], a[52:55]
  ds_read_b128 v[80:83], v14 offset:40960
  v_mfma_f32_16x16x32_bf16 a[60:63], v[44:47], v[124:127], a[60:63]
  v_mfma_f32_16x16x32_bf16 a[64:67], v[48:51], v[96:99], a[64:67]
  ds_read_b64_tr_b16 v[148:149], v13 offset:33280
  v_mfma_f32_16x16x32_bf16 a[72:75], v[48:51], v[100:103], a[72:75]
  v_mfma_f32_16x16x32_bf16 a[80:83], v[48:51], v[104:107], a[80:83]
  ds_read_b64_tr_b16 v[150:151], v13 offset:34304
  v_mfma_f32_16x16x32_bf16 a[88:91], v[48:51], v[108:111], a[88:91]
  v_mfma_f32_16x16x32_bf16 a[96:99], v[48:51], v[112:115], a[96:99]
  ds_read_b128 v[84:87], v14 offset:41984
  v_mfma_f32_16x16x32_bf16 a[104:107], v[48:51], v[116:119], a[104:107]
  v_mfma_f32_16x16x32_bf16 a[112:115], v[48:51], v[120:123], a[112:115]
  ds_read_b64_tr_b16 v[152:153], v12 offset:33536
  v_mfma_f32_16x16x32_bf16 a[120:123], v[48:51], v[124:127], a[120:123]
  v_mfma_f32_16x16x32_bf16 a[68:71], v[52:55], v[96:99], a[68:71]
  ds_read_b64_tr_b16 v[154:155], v12 offset:34560
  v_mfma_f32_16x16x32_bf16 a[76:79], v[52:55], v[100:103], a[76:79]
  v_mfma_f32_16x16x32_bf16 a[84:87], v[52:55], v[104:107], a[84:87]
  ds_read_b128 v[88:91], v14 offset:45056
  v_mfma_f32_16x16x32_bf16 a[92:95], v[52:55], v[108:111], a[92:95]
  v_mfma_f32_16x16x32_bf16 a[100:103], v[52:55], v[112:115], a[100:103]
  ds_read_b64_tr_b16 v[156:157], v13 offset:33536
  v_mfma_f32_16x16x32_bf16 a[108:111], v[52:55], v[116:119], a[108:111]
  v_mfma_f32_16x16x32_bf16 a[116:119], v[52:55], v[120:123], a[116:119]
  ds_read_b64_tr_b16 v[158:159], v13 offset:34560
  v_mfma_f32_16x16x32_bf16 a[124:127], v[52:55], v[124:127], a[124:127]
  v_mfma_f32_16x16x32_bf16 a[128:131], v[56:59], v[96:99], a[128:131]
  s_add_u32 s26, s26, s79
  ds_read_b128 v[92:95], v14 offset:46080
  v_mfma_f32_16x16x32_bf16 a[136:139], v[56:59], v[100:103], a[136:139]
  s_add_u32 s27, s27, s25
  v_mfma_f32_16x16x32_bf16 a[144:147], v[56:59], v[104:107], a[144:147]
  s_add_u32 s24, s24, 32768
  v_mfma_f32_16x16x32_bf16 a[152:155], v[56:59], v[108:111], a[152:155]
  s_and_b32 s24, s24, 0x1ffff
  v_mfma_f32_16x16x32_bf16 a[160:163], v[56:59], v[112:115], a[160:163]
  v_xor_b32 v14, 0x10000, v14
  v_mfma_f32_16x16x32_bf16 a[168:171], v[56:59], v[116:119], a[168:171]
  v_xor_b32 v12, 0x10000, v12
  v_mfma_f32_16x16x32_bf16 a[176:179], v[56:59], v[120:123], a[176:179]
  v_xor_b32 v13, 0x10000, v13
  v_mfma_f32_16x16x32_bf16 a[184:187], v[56:59], v[124:127], a[184:187]
  v_mfma_f32_16x16x32_bf16 a[132:135], v[60:63], v[96:99], a[132:135]
  v_mfma_f32_16x16x32_bf16 a[140:143], v[60:63], v[100:103], a[140:143]
  v_mfma_f32_16x16x32_bf16 a[148:151], v[60:63], v[104:107], a[148:151]
  v_mfma_f32_16x16x32_bf16 a[156:159], v[60:63], v[108:111], a[156:159]
  v_mfma_f32_16x16x32_bf16 a[164:167], v[60:63], v[112:115], a[164:167]
  v_mfma_f32_16x16x32_bf16 a[172:175], v[60:63], v[116:119], a[172:175]
  v_mfma_f32_16x16x32_bf16 a[180:183], v[60:63], v[120:123], a[180:183]
  v_mfma_f32_16x16x32_bf16 a[188:191], v[60:63], v[124:127], a[188:191]
  s_waitcnt lgkmcnt(0)
  v_mfma_f32_16x16x32_bf16 a[192:195], v[64:67], v[128:131], a[192:195]
  s_waitcnt vmcnt(18)
  v_mfma_f32_16x16x32_bf16 a[200:203], v[64:67], v[132:135], a[200:203]
  s_barrier
  v_mfma_f32_16x16x32_bf16 a[208:211], v[64:67], v[136:139], a[208:211]
  ds_read_b64_tr_b16 v[96:97], v12 offset:0
  v_mfma_f32_16x16x32_bf16 a[216:219], v[64:67], v[140:143], a[216:219]
  v_mfma_f32_16x16x32_bf16 a[224:227], v[64:67], v[144:147], a[224:227]
  s_mov_b32 m0, s24
  ds_read_b64_tr_b16 v[98:99], v12 offset:1024
  v_mfma_f32_16x16x32_bf16 a[232:235], v[64:67], v[148:151], a[232:235]
  buffer_load_dwordx4 v3, s[32:35], s26 offen offset:0 sc1 lds
  v_mfma_f32_16x16x32_bf16 a[240:243], v[64:67], v[152:155], a[240:243]
  ds_read_b128 v[32:35], v14 offset:0
  v_mfma_f32_16x16x32_bf16 a[248:251], v[64:67], v[156:159], a[248:251]
  v_mfma_f32_16x16x32_bf16 a[196:199], v[68:71], v[128:131], a[196:199]
  ds_read_b64_tr_b16 v[100:101], v13 offset:0
  v_mfma_f32_16x16x32_bf16 a[204:207], v[68:71], v[132:135], a[204:207]
  v_mfma_f32_16x16x32_bf16 a[212:215], v[68:71], v[136:139], a[212:215]
  ds_read_b64_tr_b16 v[102:103], v13 offset:1024
  v_mfma_f32_16x16x32_bf16 a[220:223], v[68:71], v[140:143], a[220:223]
  buffer_load_dwordx4 v4, s[32:35], s26 offen offset:1024 sc1 lds
  v_mfma_f32_16x16x32_bf16 a[228:231], v[68:71], v[144:147], a[228:231]
  ds_read_b128 v[36:39], v14 offset:1024
  v_mfma_f32_16x16x32_bf16 a[236:239], v[68:71], v[148:151], a[236:239]
  v_mfma_f32_16x16x32_bf16 a[244:247], v[68:71], v[152:155], a[244:247]
  ds_read_b64_tr_b16 v[104:105], v12 offset:256
  v_mfma_f32_16x16x32_bf16 a[252:255], v[68:71], v[156:159], a[252:255]
  v_mfma_f32_16x16x32_bf16 a[0:3], v[72:75], v[128:131], a[0:3]
  ds_read_b64_tr_b16 v[106:107], v12 offset:1280
  v_mfma_f32_16x16x32_bf16 a[8:11], v[72:75], v[132:135], a[8:11]
  buffer_load_dwordx4 v5, s[32:35], s26 offen offset:2048 sc1 lds
  v_mfma_f32_16x16x32_bf16 a[16:19], v[72:75], v[136:139], a[16:19]
  ds_read_b128 v[40:43], v14 offset:4096
  v_mfma_f32_16x16x32_bf16 a[24:27], v[72:75], v[140:143], a[24:27]
  v_mfma_f32_16x16x32_bf16 a[32:35], v[72:75], v[144:147], a[32:35]
  ds_read_b64_tr_b16 v[108:109], v13 offset:256
  v_mfma_f32_16x16x32_bf16 a[40:43], v[72:75], v[148:151], a[40:43]
  v_mfma_f32_16x16x32_bf16 a[48:51], v[72:75], v[152:155], a[48:51]
  ds_read_b64_tr_b16 v[110:111], v13 offset:1280
  v_mfma_f32_16x16x32_bf16 a[56:59], v[72:75], v[156:159], a[56:59]
  buffer_load_dwordx4 v6, s[32:35], s26 offen offset:3072 sc1 lds
  v_mfma_f32_16x16x32_bf16 a[4:7], v[76:79], v[128:131], a[4:7]
  ds_read_b128 v[44:47], v14 offset:5120
  v_mfma_f32_16x16x32_bf16 a[12:15], v[76:79], v[132:135], a[12:15]
  v_mfma_f32_16x16x32_bf16 a[20:23], v[76:79], v[136:139], a[20:23]
  ds_read_b64_tr_b16 v[112:113], v12 offset:512
  v_mfma_f32_16x16x32_bf16 a[28:31], v[76:79], v[140:143], a[28:31]
  v_mfma_f32_16x16x32_bf16 a[36:39], v[76:79], v[144:147], a[36:39]
  s_add_u32 m0, s24, 16384
  ds_read_b64_tr_b16 v[114:115], v12 offset:1536
  v_mfma_f32_16x16x32_bf16 a[44:47], v[76:79], v[148:151], a[44:47]
  buffer_load_dwordx4 v8, s[36:39], s27 offen offset:0 lds
  v_mfma_f32_16x16x32_bf16 a[52:55], v[76:79], v[152:155], a[52:55]
  ds_read_b128 v[48:51], v14 offset:8192
  v_mfma_f32_16x16x32_bf16 a[60:63], v[76:79], v[156:159], a[60:63]
  v_mfma_f32_16x16x32_bf16 a[64:67], v[80:83], v[128:131], a[64:67]
  ds_read_b64_tr_b16 v[116:117], v13 offset:512
  v_mfma_f32_16x16x32_bf16 a[72:75], v[80:83], v[132:135], a[72:75]
  v_mfma_f32_16x16x32_bf16 a[80:83], v[80:83], v[136:139], a[80:83]
  ds_read_b64_tr_b16 v[118:119], v13 offset:1536
  v_mfma_f32_16x16x32_bf16 a[88:91], v[80:83], v[140:143], a[88:91]
  buffer_load_dwordx4 v9, s[36:39], s27 offen offset:1024 lds
  v_mfma_f32_16x16x32_bf16 a[96:99], v[80:83], v[144:147], a[96:99]
  ds_read_b128 v[52:55], v14 offset:9216
  v_mfma_f32_16x16x32_bf16 a[104:107], v[80:83], v[148:151], a[104:107]
  v_mfma_f32_16x16x32_bf16 a[112:115], v[80:83], v[152:155], a[112:115]
  ds_read_b64_tr_b16 v[120:121], v12 offset:768
  v_mfma_f32_16x16x32_bf16 a[120:123], v[80:83], v[156:159], a[120:123]
  v_mfma_f32_16x16x32_bf16 a[68:71], v[84:87], v[128:131], a[68:71]
  ds_read_b64_tr_b16 v[122:123], v12 offset:1792
  v_mfma_f32_16x16x32_bf16 a[76:79], v[84:87], v[132:135], a[76:79]
  buffer_load_dwordx4 v10, s[36:39], s27 offen offset:2048 lds
  v_mfma_f32_16x16x32_bf16 a[84:87], v[84:87], v[136:139], a[84:87]
  ds_read_b128 v[56:59], v14 offset:12288
  v_mfma_f32_16x16x32_bf16 a[92:95], v[84:87], v[140:143], a[92:95]
  v_mfma_f32_16x16x32_bf16 a[100:103], v[84:87], v[144:147], a[100:103]
  ds_read_b64_tr_b16 v[124:125], v13 offset:768
  v_mfma_f32_16x16x32_bf16 a[108:111], v[84:87], v[148:151], a[108:111]
  v_mfma_f32_16x16x32_bf16 a[116:119], v[84:87], v[152:155], a[116:119]
  ds_read_b64_tr_b16 v[126:127], v13 offset:1792
  v_mfma_f32_16x16x32_bf16 a[124:127], v[84:87], v[156:159], a[124:127]
  buffer_load_dwordx4 v11, s[36:39], s27 offen offset:3072 lds
  v_mfma_f32_16x16x32_bf16 a[128:131], v[88:91], v[128:131], a[128:131]
  s_add_u32 s26, s26, s79
  ds_read_b128 v[60:63], v14 offset:13312
  v_mfma_f32_16x16x32_bf16 a[136:139], v[88:91], v[132:135], a[136:139]
  s_add_u32 s27, s27, s25
  v_mfma_f32_16x16x32_bf16 a[144:147], v[88:91], v[136:139], a[144:147]
  s_add_u32 s24, s24, 32768
  v_mfma_f32_16x16x32_bf16 a[152:155], v[88:91], v[140:143], a[152:155]
  s_and_b32 s24, s24, 0x1ffff
  v_mfma_f32_16x16x32_bf16 a[160:163], v[88:91], v[144:147], a[160:163]
  v_mfma_f32_16x16x32_bf16 a[168:171], v[88:91], v[148:151], a[168:171]
  s_bitcmp1_b32 s76, s28
  v_mfma_f32_16x16x32_bf16 a[176:179], v[88:91], v[152:155], a[176:179]
  s_cbranch_scc1 fa_hk3
fa_hb3:
  v_mfma_f32_16x16x32_bf16 a[184:187], v[88:91], v[156:159], a[184:187]
  v_mfma_f32_16x16x32_bf16 a[132:135], v[92:95], v[128:131], a[132:135]
  v_mfma_f32_16x16x32_bf16 a[140:143], v[92:95], v[132:135], a[140:143]
  s_add_u32 s28, s28, 1
  v_mfma_f32_16x16x32_bf16 a[148:151], v[92:95], v[136:139], a[148:151]
  v_mfma_f32_16x16x32_bf16 a[156:159], v[92:95], v[140:143], a[156:159]
  v_mfma_f32_16x16x32_bf16 a[164:167], v[92:95], v[144:147], a[164:167]
  v_mfma_f32_16x16x32_bf16 a[172:175], v[92:95], v[148:151], a[172:175]
  s_cmp_lt_u32 s28, 8
  v_mfma_f32_16x16x32_bf16 a[180:183], v[92:95], v[152:155], a[180:183]
  s_waitcnt lgkmcnt(0)
  v_mfma_f32_16x16x32_bf16 a[188:191], v[92:95], v[156:159], a[188:191]
  s_cbranch_scc1 fa_loopV
  s_mov_b32 s64, 33554432
  s_mov_b32 s76, 1.0
fa_p1epi:
  s_lshr_b32 s23, s20, 1
  s_lshl_b32 s23, s23, 13
  v_subrev_u32 v12, s23, v12
  v_subrev_u32 v13, s23, v13
  s_lshl_b32 s24, s20, 12
  v_add_u32 v14, s24, v2
  ds_read_b64_tr_b16 v[32:33], v12 offset:0
  ds_read_b64_tr_b16 v[34:35], v12 offset:1024
  ds_read_b64_tr_b16 v[36:37], v13 offset:0
  ds_read_b64_tr_b16 v[38:39], v13 offset:1024
  ds_read_b64_tr_b16 v[40:41], v12 offset:256
  ds_read_b64_tr_b16 v[42:43], v12 offset:1280
  ds_read_b64_tr_b16 v[44:45], v13 offset:256
  ds_read_b64_tr_b16 v[46:47], v13 offset:1280
  ds_read_b64_tr_b16 v[48:49], v12 offset:512
  ds_read_b64_tr_b16 v[50:51], v12 offset:1536
  ds_read_b64_tr_b16 v[52:53], v13 offset:512
  ds_read_b64_tr_b16 v[54:55], v13 offset:1536
  ds_read_b64_tr_b16 v[56:57], v12 offset:768
  ds_read_b64_tr_b16 v[58:59], v12 offset:1792
  ds_read_b64_tr_b16 v[60:61], v13 offset:768
  ds_read_b64_tr_b16 v[62:63], v13 offset:1792
  s_waitcnt vmcnt(8)
  ds_read_b128 v[224:227], v14 offset:0
  ds_read_b128 v[228:231], v14 offset:1024
  ds_read_b128 v[232:235], v14 offset:2048
  ds_read_b128 v[236:239], v14 offset:3072
  s_lshl_b32 s23, s21, 19
  s_add_u32 s64, s64, s23
  s_lshl_b32 s23, s22, 14
  s_add_u32 s64, s64, s23
  s_and_b32 s23, s20, 1
  s_lshl_b32 s23, s23, 13
  s_add_u32 s64, s64, s23
  s_lshl_b32 s23, s21, 19
  s_add_u32 s23, s23, 16777216
  s_add_u32 s6, s18, s23
  s_addc_u32 s7, s19, 0
  s_add_u32 s8, s6, 16777216
  s_addc_u32 s9, s7, 0
  s_sub_u32 s23, 16, s22
  s_lshl_b32 s23, s23, 15
  s_mov_b32 s44, s6
  s_mov_b32 s45, s7
  s_mov_b32 s46, s23
  s_mov_b32 s47, 0x20000
  s_mov_b32 s48, s8
  s_mov_b32 s49, s9
  s_mov_b32 s50, s23
  s_mov_b32 s51, 0x20000
  s_lshl_b32 s30, s21, 7
  s_add_u32 s30, s30, 2637824
  s_mov_b32 s81, 0x47800000
  s_cmp_eq_u32 s20, 0
  s_cselect_b32 s65, s82, 1073741824
  s_waitcnt vmcnt(21) lgkmcnt(0)
  v_mfma_f32_16x16x32_bf16 v[96:99], v[32:35], v[224:227], 0
  v_accvgpr_read_b32 v16, a192
  v_accvgpr_read_b32 v17, a193
  v_accvgpr_read_b32 v18, a194
  v_mfma_f32_16x16x32_bf16 v[112:115], v[36:39], v[224:227], 0
  ds_read_b64_tr_b16 v[64:65], v12 offset:8192
  v_accvgpr_read_b32 v19, a195
  v_mfma_f32_16x16x32_bf16 v[128:131], v[40:43], v[224:227], 0
  s_add_u32 m0, s24, 0
  ds_read_b64_tr_b16 v[66:67], v12 offset:9216
  v_accvgpr_read_b32 v20, a196
  v_mfma_f32_16x16x32_bf16 v[144:147], v[44:47], v[224:227], 0
  buffer_load_dwordx4 v3, s[32:35], s26 offen offset:0 sc1 lds
  v_accvgpr_read_b32 v21, a197
  v_mfma_f32_16x16x32_bf16 v[160:163], v[48:51], v[224:227], 0
  ds_read_b64_tr_b16 v[68:69], v13 offset:8192
  v_accvgpr_read_b32 v22, a198
  v_accvgpr_read_b32 v23, a199
  v_mfma_f32_16x16x32_bf16 v[176:179], v[52:55], v[224:227], 0
  ds_read_b64_tr_b16 v[70:71], v13 offset:9216
  v_mul_f32 v16, s76, v16
  v_mfma_f32_16x16x32_bf16 v[192:195], v[56:59], v[224:227], 0
  ds_read_b64_tr_b16 v[72:73], v12 offset:8448
  v_mul_f32 v17, s76, v17
  v_mfma_f32_16x16x32_bf16 v[208:211], v[60:63], v[224:227], 0
  ds_read_b64_tr_b16 v[74:75], v12 offset:9472
  v_mul_f32 v18, s76, v18
  v_mfma_f32_16x16x32_bf16 v[100:103], v[32:35], v[228:231], 0
  buffer_load_dwordx4 v4, s[32:35], s26 offen offset:1024 sc1 lds
  v_mul_f32 v19, s76, v19
  v_mul_f32 v20, s76, v20
  v_mfma_f32_16x16x32_bf16 v[116:119], v[36:39], v[228:231], 0
  ds_read_b64_tr_b16 v[76:77], v13 offset:8448
  v_mul_f32 v21, s76, v21
  v_mfma_f32_16x16x32_bf16 v[132:135], v[40:43], v[228:231], 0
  ds_read_b64_tr_b16 v[78:79], v13 offset:9472
  v_mul_f32 v22, s76, v22
  v_mfma_f32_16x16x32_bf16 v[148:151], v[44:47], v[228:231], 0
  ds_read_b128 v[240:243], v14 offset:32768
  v_mul_f32 v23, s76, v23
  v_mfma_f32_16x16x32_bf16 v[164:167], v[48:51], v[228:231], 0
  ds_read_b128 v[244:247], v14 offset:33792
  v_cvt_pk_bf16_f32 v24, v16, v17
  v_cvt_pk_bf16_f32 v25, v18, v19
  v_mfma_f32_16x16x32_bf16 v[180:183], v[52:55], v[228:231], 0
  buffer_load_dwordx4 v5, s[32:35], s26 offen offset:2048 sc1 lds
  v_cvt_pk_bf16_f32 v26, v20, v21
  v_mfma_f32_16x16x32_bf16 v[196:199], v[56:59], v[228:231], 0
  ds_read_b64_tr_b16 v[80:81], v12 offset:8704
  v_cvt_pk_bf16_f32 v27, v22, v23
  v_mfma_f32_16x16x32_bf16 v[212:215], v[60:63], v[228:231], 0
  ds_read_b64_tr_b16 v[82:83], v12 offset:9728
  buffer_store_dwordx4 v[24:27], v2, s[40:43], s64 offen offset:0 sc1
  v_mfma_f32_16x16x32_bf16 v[104:107], v[32:35], v[232:235], 0
  ds_read_b64_tr_b16 v[84:85], v13 offset:8704
  v_accvgpr_read_b32 v16, a200
  v_mfma_f32_16x16x32_bf16 v[120:123], v[36:39], v[232:235], 0
  ds_read_b64_tr_b16 v[86:87], v13 offset:9728
  v_accvgpr_read_b32 v17, a201
  v_accvgpr_read_b32 v18, a202
  v_mfma_f32_16x16x32_bf16 v[136:139], v[40:43], v[232:235], 0
  buffer_load_dwordx4 v6, s[32:35], s26 offen offset:3072 sc1 lds
  v_accvgpr_read_b32 v19, a203
  v_mfma_f32_16x16x32_bf16 v[152:155], v[44:47], v[232:235], 0
  s_add_u32 s26, s26, 1024
  ds_read_b64_tr_b16 v[88:89], v12 offset:8960
  v_accvgpr_read_b32 v20, a204
  v_mfma_f32_16x16x32_bf16 v[168:171], v[48:51], v[232:235], 0
  ds_read_b64_tr_b16 v[90:91], v12 offset:9984
  v_accvgpr_read_b32 v21, a205
  v_mfma_f32_16x16x32_bf16 v[184:187], v[52:55], v[232:235], 0
  ds_read_b64_tr_b16 v[92:93], v13 offset:8960
  v_accvgpr_read_b32 v22, a206
  v_accvgpr_read_b32 v23, a207
  v_mfma_f32_16x16x32_bf16 v[200:203], v[56:59], v[232:235], 0
  ds_read_b64_tr_b16 v[94:95], v13 offset:9984
  v_mul_f32 v16, s76, v16
  v_mfma_f32_16x16x32_bf16 v[216:219], v[60:63], v[232:235], 0
  v_mul_f32 v17, s76, v17
  v_mul_f32 v18, s76, v18
  v_mfma_f32_16x16x32_bf16 v[108:111], v[32:35], v[236:239], 0
  ds_read_b128 v[248:251], v14 offset:34816
  v_mul_f32 v19, s76, v19
  v_mfma_f32_16x16x32_bf16 v[124:127], v[36:39], v[236:239], 0
  ds_read_b128 v[252:255], v14 offset:35840
  v_mul_f32 v20, s76, v20
  v_mul_f32 v21, s76, v21
  v_mfma_f32_16x16x32_bf16 v[140:143], v[40:43], v[236:239], 0
  v_mul_f32 v22, s76, v22
  v_mul_f32 v23, s76, v23
  v_mfma_f32_16x16x32_bf16 v[156:159], v[44:47], v[236:239], 0
  v_xor_b32 v14, 0x10000, v14
  v_cvt_pk_bf16_f32 v28, v16, v17
  v_mfma_f32_16x16x32_bf16 v[172:175], v[48:51], v[236:239], 0
  v_cvt_pk_bf16_f32 v29, v18, v19
  v_cvt_pk_bf16_f32 v30, v20, v21
  v_mfma_f32_16x16x32_bf16 v[188:191], v[52:55], v[236:239], 0
  v_cvt_pk_bf16_f32 v31, v22, v23
  v_mfma_f32_16x16x32_bf16 v[204:207], v[56:59], v[236:239], 0
  buffer_store_dwordx4 v[28:31], v2, s[40:43], s64 offen offset:1024 sc1
  v_mfma_f32_16x16x32_bf16 v[220:223], v[60:63], v[236:239], 0
  s_waitcnt vmcnt(19) lgkmcnt(0)
  v_mfma_f32_16x16x32_bf16 v[96:99], v[64:67], v[240:243], v[96:99]
  s_barrier
  v_accvgpr_read_b32 v16, a208
  v_accvgpr_read_b32 v17, a209
  v_accvgpr_read_b32 v18, a210
  v_mfma_f32_16x16x32_bf16 v[112:115], v[68:71], v[240:243], v[112:115]
  ds_read_b64_tr_b16 v[32:33], v12 offset:32768
  v_accvgpr_read_b32 v19, a211
  v_mfma_f32_16x16x32_bf16 v[128:131], v[72:75], v[240:243], v[128:131]
  s_add_u32 m0, s24, 32768
  ds_read_b64_tr_b16 v[34:35], v12 offset:33792
  v_accvgpr_read_b32 v20, a212
  v_mfma_f32_16x16x32_bf16 v[144:147], v[76:79], v[240:243], v[144:147]
  buffer_load_dwordx4 v3, s[32:35], s26 offen offset:0 sc1 lds
  v_accvgpr_read_b32 v21, a213
  v_mfma_f32_16x16x32_bf16 v[160:163], v[80:83], v[240:243], v[160:163]
  ds_read_b64_tr_b16 v[36:37], v13 offset:32768
  v_accvgpr_read_b32 v22, a214
  v_accvgpr_read_b32 v23, a215
  v_mfma_f32_16x16x32_bf16 v[176:179], v[84:87], v[240:243], v[176:179]
  ds_read_b64_tr_b16 v[38:39], v13 offset:33792
  v_mul_f32 v16, s76, v16
  v_mfma_f32_16x16x32_bf16 v[192:195], v[88:91], v[240:243], v[192:195]
  ds_read_b64_tr_b16 v[40:41], v12 offset:33024
  v_mul_f32 v17, s76, v17
  v_mfma_f32_16x16x32_bf16 v[208:211], v[92:95], v[240:243], v[208:211]
  ds_read_b64_tr_b16 v[42:43], v12 offset:34048
  v_mul_f32 v18, s76, v18
  v_mfma_f32_16x16x32_bf16 v[100:103], v[64:67], v[244:247], v[100:103]
  buffer_load_dwordx4 v4, s[32:35], s26 offen offset:1024 sc1 lds
  v_mul_f32 v19, s76, v19
  v_mul_f32 v20, s76, v20
  v_mfma_f32_16x16x32_bf16 v[116:119], v[68:71], v[244:247], v[116:119]
  ds_read_b64_tr_b16 v[44:45], v13 offset:33024
  v_mul_f32 v21, s76, v21
  v_mfma_f32_16x16x32_bf16 v[132:135], v[72:75], v[244:247], v[132:135]
  ds_read_b64_tr_b16 v[46:47], v13 offset:34048
  v_mul_f32 v22, s76, v22
  v_mfma_f32_16x16x32_bf16 v[148:151], v[76:79], v[244:247], v[148:151]
  ds_read_b128 v[224:227], v14 offset:0
  v_mul_f32 v23, s76, v23
  v_mfma_f32_16x16x32_bf16 v[164:167], v[80:83], v[244:247], v[164:167]
  ds_read_b128 v[228:231], v14 offset:1024
  v_cvt_pk_bf16_f32 v24, v16, v17
  v_cvt_pk_bf16_f32 v25, v18, v19
  v_mfma_f32_16x16x32_bf16 v[180:183], v[84:87], v[244:247], v[180:183]
  buffer_load_dwordx4 v5, s[32:35], s26 offen offset:2048 sc1 lds
  v_cvt_pk_bf16_f32 v26, v20, v21
  v_mfma_f32_16x16x32_bf16 v[196:199], v[88:91], v[244:247], v[196:199]
  ds_read_b64_tr_b16 v[48:49], v12 offset:33280
  v_cvt_pk_bf16_f32 v27, v22, v23
  v_mfma_f32_16x16x32_bf16 v[212:215], v[92:95], v[244:247], v[212:215]
  ds_read_b64_tr_b16 v[50:51], v12 offset:34304
  buffer_store_dwordx4 v[24:27], v2, s[40:43], s64 offen offset:2048 sc1
  v_mfma_f32_16x16x32_bf16 v[104:107], v[64:67], v[248:251], v[104:107]
  ds_read_b64_tr_b16 v[52:53], v13 offset:33280
  v_accvgpr_read_b32 v16, a216
  v_mfma_f32_16x16x32_bf16 v[120:123], v[68:71], v[248:251], v[120:123]
  ds_read_b64_tr_b16 v[54:55], v13 offset:34304
  v_accvgpr_read_b32 v17, a217
  v_accvgpr_read_b32 v18, a218
  v_mfma_f32_16x16x32_bf16 v[136:139], v[72:75], v[248:251], v[136:139]
  buffer_load_dwordx4 v6, s[32:35], s26 offen offset:3072 sc1 lds
  v_accvgpr_read_b32 v19, a219
  v_mfma_f32_16x16x32_bf16 v[152:155], v[76:79], v[248:251], v[152:155]
  s_add_u32 s26, s26, 1024
  ds_read_b64_tr_b16 v[56:57], v12 offset:33536
  v_accvgpr_read_b32 v20, a220
  v_mfma_f32_16x16x32_bf16 v[168:171], v[80:83], v[248:251], v[168:171]
  ds_read_b64_tr_b16 v[58:59], v12 offset:34560
  v_accvgpr_read_b32 v21, a221
  v_mfma_f32_16x16x32_bf16 v[184:187], v[84:87], v[248:251], v[184:187]
  ds_read_b64_tr_b16 v[60:61], v13 offset:33536
  v_accvgpr_read_b32 v22, a222
  v_accvgpr_read_b32 v23, a223
  v_mfma_f32_16x16x32_bf16 v[200:203], v[88:91], v[248:251], v[200:203]
  s_add_u32 m0, s24, 16384
  ds_read_b64_tr_b16 v[62:63], v13 offset:34560
  v_mul_f32 v16, s76, v16
  v_mfma_f32_16x16x32_bf16 v[216:219], v[92:95], v[248:251], v[216:219]
  buffer_load_dwordx4 v8, s[36:39], s27 offen offset:0 lds
  v_mul_f32 v17, s76, v17
  v_mfma_f32_16x16x32_bf16 v[108:111], v[64:67], v[252:255], v[108:111]
  ds_read_b128 v[232:235], v14 offset:2048
  v_mul_f32 v18, s76, v18
  v_mfma_f32_16x16x32_bf16 v[124:127], v[68:71], v[252:255], v[124:127]
  ds_read_b128 v[236:239], v14 offset:3072
  v_mul_f32 v19, s76, v19
  v_mul_f32 v20, s76, v20
  v_mfma_f32_16x16x32_bf16 v[140:143], v[72:75], v[252:255], v[140:143]
  v_mul_f32 v21, s76, v21
  v_mul_f32 v22, s76, v22
  v_mfma_f32_16x16x32_bf16 v[156:159], v[76:79], v[252:255], v[156:159]
  v_mul_f32 v23, s76, v23
  v_cvt_pk_bf16_f32 v28, v16, v17
  v_mfma_f32_16x16x32_bf16 v[172:175], v[80:83], v[252:255], v[172:175]
  buffer_load_dwordx4 v9, s[36:39], s27 offen offset:1024 lds
  v_cvt_pk_bf16_f32 v29, v18, v19
  v_mfma_f32_16x16x32_bf16 v[188:191], v[84:87], v[252:255], v[188:191]
  v_cvt_pk_bf16_f32 v30, v20, v21
  v_cvt_pk_bf16_f32 v31, v22, v23
  v_mfma_f32_16x16x32_bf16 v[204:207], v[88:91], v[252:255], v[204:207]
  buffer_store_dwordx4 v[28:31], v2, s[40:43], s64 offen offset:3072 sc1
  v_mfma_f32_16x16x32_bf16 v[220:223], v[92:95], v[252:255], v[220:223]
  s_waitcnt vmcnt(18) lgkmcnt(0)
  v_mfma_f32_16x16x32_bf16 v[96:99], v[32:35], v[224:227], v[96:99]
  s_add_u32 s64, s64, 4096
  v_accvgpr_read_b32 v16, a224
  v_accvgpr_read_b32 v17, a225
  v_mfma_f32_16x16x32_bf16 v[112:115], v[36:39], v[224:227], v[112:115]
  ds_read_b64_tr_b16 v[64:65], v12 offset:40960
  v_accvgpr_read_b32 v18, a226
  v_mfma_f32_16x16x32_bf16 v[128:131], v[40:43], v[224:227], v[128:131]
  s_add_u32 m0, s24, 65536
  ds_read_b64_tr_b16 v[66:67], v12 offset:41984
  v_accvgpr_read_b32 v19, a227
  v_mfma_f32_16x16x32_bf16 v[144:147], v[44:47], v[224:227], v[144:147]
  buffer_load_dwordx4 v3, s[32:35], s26 offen offset:0 sc1 lds
  v_accvgpr_read_b32 v20, a228
  v_mfma_f32_16x16x32_bf16 v[160:163], v[48:51], v[224:227], v[160:163]
  ds_read_b64_tr_b16 v[68:69], v13 offset:40960
  v_accvgpr_read_b32 v21, a229
  v_mfma_f32_16x16x32_bf16 v[176:179], v[52:55], v[224:227], v[176:179]
  ds_read_b64_tr_b16 v[70:71], v13 offset:41984
  v_accvgpr_read_b32 v22, a230
  v_mfma_f32_16x16x32_bf16 v[192:195], v[56:59], v[224:227], v[192:195]
  ds_read_b64_tr_b16 v[72:73], v12 offset:41216
  v_accvgpr_read_b32 v23, a231
  v_mfma_f32_16x16x32_bf16 v[208:211], v[60:63], v[224:227], v[208:211]
  ds_read_b64_tr_b16 v[74:75], v12 offset:42240
  v_mul_f32 v16, s76, v16
  v_mfma_f32_16x16x32_bf16 v[100:103], v[32:35], v[228:231], v[100:103]
  buffer_load_dwordx4 v4, s[32:35], s26 offen offset:1024 sc1 lds
  v_mul_f32 v17, s76, v17
  v_mfma_f32_16x16x32_bf16 v[116:119], v[36:39], v[228:231], v[116:119]
  ds_read_b64_tr_b16 v[76:77], v13 offset:41216
  v_mul_f32 v18, s76, v18
  v_mfma_f32_16x16x32_bf16 v[132:135], v[40:43], v[228:231], v[132:135]
  ds_read_b64_tr_b16 v[78:79], v13 offset:42240
  v_mul_f32 v19, s76, v19
  v_mfma_f32_16x16x32_bf16 v[148:151], v[44:47], v[228:231], v[148:151]
  ds_read_b128 v[240:243], v14 offset:32768
  v_mul_f32 v20, s76, v20
  v_mfma_f32_16x16x32_bf16 v[164:167], v[48:51], v[228:231], v[164:167]
  ds_read_b128 v[244:247], v14 offset:33792
  v_mul_f32 v21, s76, v21
  v_mfma_f32_16x16x32_bf16 v[180:183], v[52:55], v[228:231], v[180:183]
  buffer_load_dwordx4 v5, s[32:35], s26 offen offset:2048 sc1 lds
  v_mul_f32 v22, s76, v22
  v_mfma_f32_16x16x32_bf16 v[196:199], v[56:59], v[228:231], v[196:199]
  ds_read_b64_tr_b16 v[80:81], v12 offset:41472
  v_mul_f32 v23, s76, v23
  v_mfma_f32_16x16x32_bf16 v[212:215], v[60:63], v[228:231], v[212:215]
  ds_read_b64_tr_b16 v[82:83], v12 offset:42496
  v_cvt_pk_bf16_f32 v24, v16, v17
  v_mfma_f32_16x16x32_bf16 v[104:107], v[32:35], v[232:235], v[104:107]
  ds_read_b64_tr_b16 v[84:85], v13 offset:41472
  v_cvt_pk_bf16_f32 v25, v18, v19
  v_mfma_f32_16x16x32_bf16 v[120:123], v[36:39], v[232:235], v[120:123]
  ds_read_b64_tr_b16 v[86:87], v13 offset:42496
  v_cvt_pk_bf16_f32 v26, v20, v21
  v_mfma_f32_16x16x32_bf16 v[136:139], v[40:43], v[232:235], v[136:139]
  buffer_load_dwordx4 v6, s[32:35], s26 offen offset:3072 sc1 lds
  v_cvt_pk_bf16_f32 v27, v22, v23
  v_mfma_f32_16x16x32_bf16 v[152:155], v[44:47], v[232:235], v[152:155]
  s_add_u32 s26, s26, 1024
  ds_read_b64_tr_b16 v[88:89], v12 offset:41728
  buffer_store_dwordx4 v[24:27], v2, s[40:43], s64 offen offset:0 sc1
  v_mfma_f32_16x16x32_bf16 v[168:171], v[48:51], v[232:235], v[168:171]
  ds_read_b64_tr_b16 v[90:91], v12 offset:42752
  v_mfma_f32_16x16x32_bf16 v[184:187], v[52:55], v[232:235], v[184:187]
  ds_read_b64_tr_b16 v[92:93], v13 offset:41728
  v_mfma_f32_16x16x32_bf16 v[200:203], v[56:59], v[232:235], v[200:203]
  s_add_u32 m0, s24, 16384
  ds_read_b64_tr_b16 v[94:95], v13 offset:42752
  v_mfma_f32_16x16x32_bf16 v[216:219], v[60:63], v[232:235], v[216:219]
  buffer_load_dwordx4 v10, s[36:39], s27 offen offset:2048 lds
  v_mfma_f32_16x16x32_bf16 v[108:111], v[32:35], v[236:239], v[108:111]
  ds_read_b128 v[248:251], v14 offset:34816
  v_mfma_f32_16x16x32_bf16 v[124:127], v[36:39], v[236:239], v[124:127]
  ds_read_b128 v[252:255], v14 offset:35840
  v_mfma_f32_16x16x32_bf16 v[140:143], v[40:43], v[236:239], v[140:143]
  v_mfma_f32_16x16x32_bf16 v[156:159], v[44:47], v[236:239], v[156:159]
  v_xor_b32 v14, 0x10000, v14
  v_mfma_f32_16x16x32_bf16 v[172:175], v[48:51], v[236:239], v[172:175]
  buffer_load_dwordx4 v11, s[36:39], s27 offen offset:3072 lds
  v_mfma_f32_16x16x32_bf16 v[188:191], v[52:55], v[236:239], v[188:191]
  s_add_u32 s27, s27, 524288
  v_xor_b32 v12, 0x10000, v12
  v_mfma_f32_16x16x32_bf16 v[204:207], v[56:59], v[236:239], v[204:207]
  v_xor_b32 v13, 0x10000, v13
  v_mfma_f32_16x16x32_bf16 v[220:223], v[60:63], v[236:239], v[220:223]
  s_waitcnt vmcnt(16) lgkmcnt(0)
  v_mfma_f32_16x16x32_bf16 v[96:99], v[64:67], v[240:243], v[96:99]
  s_barrier
  v_accvgpr_read_b32 v16, a232
  v_accvgpr_read_b32 v17, a233
  v_mfma_f32_16x16x32_bf16 v[112:115], v[68:71], v[240:243], v[112:115]
  ds_read_b64_tr_b16 v[32:33], v12 offset:0
  v_accvgpr_read_b32 v18, a234
  v_mfma_f32_16x16x32_bf16 v[128:131], v[72:75], v[240:243], v[128:131]
  s_add_u32 m0, s24, 98304
  ds_read_b64_tr_b16 v[34:35], v12 offset:1024
  v_accvgpr_read_b32 v19, a235
  v_mfma_f32_16x16x32_bf16 v[144:147], v[76:79], v[240:243], v[144:147]
  buffer_load_dwordx4 v3, s[32:35], s26 offen offset:0 sc1 lds
  v_accvgpr_read_b32 v20, a236
  v_mfma_f32_16x16x32_bf16 v[160:163], v[80:83], v[240:243], v[160:163]
  ds_read_b64_tr_b16 v[36:37], v13 offset:0
  v_accvgpr_read_b32 v21, a237
  v_mfma_f32_16x16x32_bf16 v[176:179], v[84:87], v[240:243], v[176:179]
  ds_read_b64_tr_b16 v[38:39], v13 offset:1024
  v_accvgpr_read_b32 v22, a238
  v_mfma_f32_16x16x32_bf16 v[192:195], v[88:91], v[240:243], v[192:195]
  ds_read_b64_tr_b16 v[40:41], v12 offset:256
  v_accvgpr_read_b32 v23, a239
  v_mfma_f32_16x16x32_bf16 v[208:211], v[92:95], v[240:243], v[208:211]
  ds_read_b64_tr_b16 v[42:43], v12 offset:1280
  v_mul_f32 v16, s76, v16
  v_mfma_f32_16x16x32_bf16 v[100:103], v[64:67], v[244:247], v[100:103]
  buffer_load_dwordx4 v4, s[32:35], s26 offen offset:1024 sc1 lds
  v_mul_f32 v17, s76, v17
  v_mfma_f32_16x16x32_bf16 v[116:119], v[68:71], v[244:247], v[116:119]
  ds_read_b64_tr_b16 v[44:45], v13 offset:256
  v_mul_f32 v18, s76, v18
  v_mfma_f32_16x16x32_bf16 v[132:135], v[72:75], v[244:247], v[132:135]
  ds_read_b64_tr_b16 v[46:47], v13 offset:1280
  v_mul_f32 v19, s76, v19
  v_mfma_f32_16x16x32_bf16 v[148:151], v[76:79], v[244:247], v[148:151]
  ds_read_b128 v[224:227], v14 offset:0
  v_mul_f32 v20, s76, v20
  v_mfma_f32_16x16x32_bf16 v[164:167], v[80:83], v[244:247], v[164:167]
  ds_read_b128 v[228:231], v14 offset:1024
  v_mul_f32 v21, s76, v21
  v_mfma_f32_16x16x32_bf16 v[180:183], v[84:87], v[244:247], v[180:183]
  buffer_load_dwordx4 v5, s[32:35], s26 offen offset:2048 sc1 lds
  v_mul_f32 v22, s76, v22
  v_mfma_f32_16x16x32_bf16 v[196:199], v[88:91], v[244:247], v[196:199]
  ds_read_b64_tr_b16 v[48:49], v12 offset:512
  v_mul_f32 v23, s76, v23
  v_mfma_f32_16x16x32_bf16 v[212:215], v[92:95], v[244:247], v[212:215]
  ds_read_b64_tr_b16 v[50:51], v12 offset:1536
  v_cvt_pk_bf16_f32 v28, v16, v17
  v_mfma_f32_16x16x32_bf16 v[104:107], v[64:67], v[248:251], v[104:107]
  ds_read_b64_tr_b16 v[52:53], v13 offset:512
  v_cvt_pk_bf16_f32 v29, v18, v19
  v_mfma_f32_16x16x32_bf16 v[120:123], v[68:71], v[248:251], v[120:123]
  ds_read_b64_tr_b16 v[54:55], v13 offset:1536
  v_cvt_pk_bf16_f32 v30, v20, v21
  v_mfma_f32_16x16x32_bf16 v[136:139], v[72:75], v[248:251], v[136:139]
  buffer_load_dwordx4 v6, s[32:35], s26 offen offset:3072 sc1 lds
  v_cvt_pk_bf16_f32 v31, v22, v23
  v_mfma_f32_16x16x32_bf16 v[152:155], v[76:79], v[248:251], v[152:155]
  s_add_u32 s26, s26, 1024
  ds_read_b64_tr_b16 v[56:57], v12 offset:768
  buffer_store_dwordx4 v[28:31], v2, s[40:43], s64 offen offset:1024 sc1
  v_mfma_f32_16x16x32_bf16 v[168:171], v[80:83], v[248:251], v[168:171]
  ds_read_b64_tr_b16 v[58:59], v12 offset:1792
  v_mfma_f32_16x16x32_bf16 v[184:187], v[84:87], v[248:251], v[184:187]
  ds_read_b64_tr_b16 v[60:61], v13 offset:768
  v_mfma_f32_16x16x32_bf16 v[200:203], v[88:91], v[248:251], v[200:203]
  s_add_u32 m0, s24, 49152
  ds_read_b64_tr_b16 v[62:63], v13 offset:1792
  v_mfma_f32_16x16x32_bf16 v[216:219], v[92:95], v[248:251], v[216:219]
  buffer_load_dwordx4 v8, s[36:39], s27 offen offset:0 lds
  v_mfma_f32_16x16x32_bf16 v[108:111], v[64:67], v[252:255], v[108:111]
  ds_read_b128 v[232:235], v14 offset:2048
  v_mfma_f32_16x16x32_bf16 v[124:127], v[68:71], v[252:255], v[124:127]
  ds_read_b128 v[236:239], v14 offset:3072
  v_mfma_f32_16x16x32_bf16 v[140:143], v[72:75], v[252:255], v[140:143]
  v_mfma_f32_16x16x32_bf16 v[156:159], v[76:79], v[252:255], v[156:159]
  v_mfma_f32_16x16x32_bf16 v[172:175], v[80:83], v[252:255], v[172:175]
  buffer_load_dwordx4 v9, s[36:39], s27 offen offset:1024 lds
  v_mfma_f32_16x16x32_bf16 v[188:191], v[84:87], v[252:255], v[188:191]
  v_mfma_f32_16x16x32_bf16 v[204:207], v[88:91], v[252:255], v[204:207]
  v_mfma_f32_16x16x32_bf16 v[220:223], v[92:95], v[252:255], v[220:223]
  s_waitcnt vmcnt(17) lgkmcnt(0)
  v_mfma_f32_16x16x32_bf16 v[96:99], v[32:35], v[224:227], v[96:99]
  v_accvgpr_read_b32 v16, a240
  v_accvgpr_read_b32 v17, a241
  v_mfma_f32_16x16x32_bf16 v[112:115], v[36:39], v[224:227], v[112:115]
  ds_read_b64_tr_b16 v[64:65], v12 offset:8192
  v_accvgpr_read_b32 v18, a242
  v_mfma_f32_16x16x32_bf16 v[128:131], v[40:43], v[224:227], v[128:131]
  s_add_u32 m0, s24, 0
  ds_read_b64_tr_b16 v[66:67], v12 offset:9216
  v_accvgpr_read_b32 v19, a243
  v_mfma_f32_16x16x32_bf16 v[144:147], v[44:47], v[224:227], v[144:147]
  buffer_load_dwordx4 v3, s[32:35], s26 offen offset:0 sc1 lds
  v_accvgpr_read_b32 v20, a244
  v_mfma_f32_16x16x32_bf16 v[160:163], v[48:51], v[224:227], v[160:163]
  ds_read_b64_tr_b16 v[68:69], v13 offset:8192
  v_accvgpr_read_b32 v21, a245
  v_mfma_f32_16x16x32_bf16 v[176:179], v[52:55], v[224:227], v[176:179]
  ds_read_b64_tr_b16 v[70:71], v13 offset:9216
  v_accvgpr_read_b32 v22, a246
  v_mfma_f32_16x16x32_bf16 v[192:195], v[56:59], v[224:227], v[192:195]
  ds_read_b64_tr_b16 v[72:73], v12 offset:8448
  v_accvgpr_read_b32 v23, a247
  v_mfma_f32_16x16x32_bf16 v[208:211], v[60:63], v[224:227], v[208:211]
  ds_read_b64_tr_b16 v[74:75], v12 offset:9472
  v_mul_f32 v16, s76, v16
  v_mfma_f32_16x16x32_bf16 v[100:103], v[32:35], v[228:231], v[100:103]
  buffer_load_dwordx4 v4, s[32:35], s26 offen offset:1024 sc1 lds
  v_mul_f32 v17, s76, v17
  v_mfma_f32_16x16x32_bf16 v[116:119], v[36:39], v[228:231], v[116:119]
  ds_read_b64_tr_b16 v[76:77], v13 offset:8448
  v_mul_f32 v18, s76, v18
  v_mfma_f32_16x16x32_bf16 v[132:135], v[40:43], v[228:231], v[132:135]
  ds_read_b64_tr_b16 v[78:79], v13 offset:9472
  v_mul_f32 v19, s76, v19
  v_mfma_f32_16x16x32_bf16 v[148:151], v[44:47], v[228:231], v[148:151]
  ds_read_b128 v[240:243], v14 offset:32768
  v_mul_f32 v20, s76, v20
  v_mfma_f32_16x16x32_bf16 v[164:167], v[48:51], v[228:231], v[164:167]
  ds_read_b128 v[244:247], v14 offset:33792
  v_mul_f32 v21, s76, v21
  v_mfma_f32_16x16x32_bf16 v[180:183], v[52:55], v[228:231], v[180:183]
  buffer_load_dwordx4 v5, s[32:35], s26 offen offset:2048 sc1 lds
  v_mul_f32 v22, s76, v22
  v_mfma_f32_16x16x32_bf16 v[196:199], v[56:59], v[228:231], v[196:199]
  ds_read_b64_tr_b16 v[80:81], v12 offset:8704
  v_mul_f32 v23, s76, v23
  v_mfma_f32_16x16x32_bf16 v[212:215], v[60:63], v[228:231], v[212:215]
  ds_read_b64_tr_b16 v[82:83], v12 offset:9728
  v_cvt_pk_bf16_f32 v24, v16, v17
  v_mfma_f32_16x16x32_bf16 v[104:107], v[32:35], v[232:235], v[104:107]
  ds_read_b64_tr_b16 v[84:85], v13 offset:8704
  v_cvt_pk_bf16_f32 v25, v18, v19
  v_mfma_f32_16x16x32_bf16 v[120:123], v[36:39], v[232:235], v[120:123]
  ds_read_b64_tr_b16 v[86:87], v13 offset:9728
  v_cvt_pk_bf16_f32 v26, v20, v21
  v_mfma_f32_16x16x32_bf16 v[136:139], v[40:43], v[232:235], v[136:139]
  buffer_load_dwordx4 v6, s[32:35], s26 offen offset:3072 sc1 lds
  v_cvt_pk_bf16_f32 v27, v22, v23
  v_mfma_f32_16x16x32_bf16 v[152:155], v[44:47], v[232:235], v[152:155]
  s_add_u32 s26, s26, 1024
  ds_read_b64_tr_b16 v[88:89], v12 offset:8960
  buffer_store_dwordx4 v[24:27], v2, s[40:43], s64 offen offset:2048 sc1
  v_mfma_f32_16x16x32_bf16 v[168:171], v[48:51], v[232:235], v[168:171]
  ds_read_b64_tr_b16 v[90:91], v12 offset:9984
  v_mfma_f32_16x16x32_bf16 v[184:187], v[52:55], v[232:235], v[184:187]
  ds_read_b64_tr_b16 v[92:93], v13 offset:8960
  v_mfma_f32_16x16x32_bf16 v[200:203], v[56:59], v[232:235], v[200:203]
  s_add_u32 m0, s24, 49152
  ds_read_b64_tr_b16 v[94:95], v13 offset:9984
  v_mfma_f32_16x16x32_bf16 v[216:219], v[60:63], v[232:235], v[216:219]
  buffer_load_dwordx4 v10, s[36:39], s27 offen offset:2048 lds
  v_mfma_f32_16x16x32_bf16 v[108:111], v[32:35], v[236:239], v[108:111]
  ds_read_b128 v[248:251], v14 offset:34816
  v_mfma_f32_16x16x32_bf16 v[124:127], v[36:39], v[236:239], v[124:127]
  ds_read_b128 v[252:255], v14 offset:35840
  v_mfma_f32_16x16x32_bf16 v[140:143], v[40:43], v[236:239], v[140:143]
  v_mfma_f32_16x16x32_bf16 v[156:159], v[44:47], v[236:239], v[156:159]
  v_xor_b32 v14, 0x10000, v14
  v_mfma_f32_16x16x32_bf16 v[172:175], v[48:51], v[236:239], v[172:175]
  buffer_load_dwordx4 v11, s[36:39], s27 offen offset:3072 lds
  v_mfma_f32_16x16x32_bf16 v[188:191], v[52:55], v[236:239], v[188:191]
  s_add_u32 s27, s27, 524288
  v_mfma_f32_16x16x32_bf16 v[204:207], v[56:59], v[236:239], v[204:207]
  v_mfma_f32_16x16x32_bf16 v[220:223], v[60:63], v[236:239], v[220:223]
  s_waitcnt vmcnt(17) lgkmcnt(0)
  v_mfma_f32_16x16x32_bf16 v[96:99], v[64:67], v[240:243], v[96:99]
  s_barrier
  v_accvgpr_read_b32 v16, a248
  v_accvgpr_read_b32 v17, a249
  v_mfma_f32_16x16x32_bf16 v[112:115], v[68:71], v[240:243], v[112:115]
  ds_read_b64_tr_b16 v[32:33], v12 offset:32768
  v_accvgpr_read_b32 v18, a250
  v_mfma_f32_16x16x32_bf16 v[128:131], v[72:75], v[240:243], v[128:131]
  s_add_u32 m0, s24, 32768
  ds_read_b64_tr_b16 v[34:35], v12 offset:33792
  v_accvgpr_read_b32 v19, a251
  v_mfma_f32_16x16x32_bf16 v[144:147], v[76:79], v[240:243], v[144:147]
  buffer_load_dwordx4 v3, s[32:35], s26 offen offset:0 sc1 lds
  v_accvgpr_read_b32 v20, a252
  v_mfma_f32_16x16x32_bf16 v[160:163], v[80:83], v[240:243], v[160:163]
  ds_read_b64_tr_b16 v[36:37], v13 offset:32768
  v_accvgpr_read_b32 v21, a253
  v_mfma_f32_16x16x32_bf16 v[176:179], v[84:87], v[240:243], v[176:179]
  ds_read_b64_tr_b16 v[38:39], v13 offset:33792
  v_accvgpr_read_b32 v22, a254
  v_mfma_f32_16x16x32_bf16 v[192:195], v[88:91], v[240:243], v[192:195]
  ds_read_b64_tr_b16 v[40:41], v12 offset:33024
  v_accvgpr_read_b32 v23, a255
  v_mfma_f32_16x16x32_bf16 v[208:211], v[92:95], v[240:243], v[208:211]
  ds_read_b64_tr_b16 v[42:43], v12 offset:34048
  v_mul_f32 v16, s76, v16
  v_mfma_f32_16x16x32_bf16 v[100:103], v[64:67], v[244:247], v[100:103]
  buffer_load_dwordx4 v4, s[32:35], s26 offen offset:1024 sc1 lds
  v_mul_f32 v17, s76, v17
  v_mfma_f32_16x16x32_bf16 v[116:119], v[68:71], v[244:247], v[116:119]
  ds_read_b64_tr_b16 v[44:45], v13 offset:33024
  v_mul_f32 v18, s76, v18
  v_mfma_f32_16x16x32_bf16 v[132:135], v[72:75], v[244:247], v[132:135]
  ds_read_b64_tr_b16 v[46:47], v13 offset:34048
  v_mul_f32 v19, s76, v19
  v_mfma_f32_16x16x32_bf16 v[148:151], v[76:79], v[244:247], v[148:151]
  ds_read_b128 v[224:227], v14 offset:0
  v_mul_f32 v20, s76, v20
  v_mfma_f32_16x16x32_bf16 v[164:167], v[80:83], v[244:247], v[164:167]
  ds_read_b128 v[228:231], v14 offset:1024
  v_mul_f32 v21, s76, v21
  v_mfma_f32_16x16x32_bf16 v[180:183], v[84:87], v[244:247], v[180:183]
  buffer_load_dwordx4 v5, s[32:35], s26 offen offset:2048 sc1 lds
  v_mul_f32 v22, s76, v22
  v_mfma_f32_16x16x32_bf16 v[196:199], v[88:91], v[244:247], v[196:199]
  ds_read_b64_tr_b16 v[48:49], v12 offset:33280
  v_mul_f32 v23, s76, v23
  v_mfma_f32_16x16x32_bf16 v[212:215], v[92:95], v[244:247], v[212:215]
  ds_read_b64_tr_b16 v[50:51], v12 offset:34304
  v_cvt_pk_bf16_f32 v28, v16, v17
  v_mfma_f32_16x16x32_bf16 v[104:107], v[64:67], v[248:251], v[104:107]
  ds_read_b64_tr_b16 v[52:53], v13 offset:33280
  v_cvt_pk_bf16_f32 v29, v18, v19
  v_mfma_f32_16x16x32_bf16 v[120:123], v[68:71], v[248:251], v[120:123]
  ds_read_b64_tr_b16 v[54:55], v13 offset:34304
  v_cvt_pk_bf16_f32 v30, v20, v21
  v_mfma_f32_16x16x32_bf16 v[136:139], v[72:75], v[248:251], v[136:139]
  buffer_load_dwordx4 v6, s[32:35], s26 offen offset:3072 sc1 lds
  v_cvt_pk_bf16_f32 v31, v22, v23
  v_mfma_f32_16x16x32_bf16 v[152:155], v[76:79], v[248:251], v[152:155]
  s_add_u32 s26, s26, 1024
  ds_read_b64_tr_b16 v[56:57], v12 offset:33536
  buffer_store_dwordx4 v[28:31], v2, s[40:43], s64 offen offset:3072 sc1
  v_mfma_f32_16x16x32_bf16 v[168:171], v[80:83], v[248:251], v[168:171]
  ds_read_b64_tr_b16 v[58:59], v12 offset:34560
  v_mfma_f32_16x16x32_bf16 v[184:187], v[84:87], v[248:251], v[184:187]
  ds_read_b64_tr_b16 v[60:61], v13 offset:33536
  v_mfma_f32_16x16x32_bf16 v[200:203], v[88:91], v[248:251], v[200:203]
  s_add_u32 m0, s24, 81920
  ds_read_b64_tr_b16 v[62:63], v13 offset:34560
  v_mfma_f32_16x16x32_bf16 v[216:219], v[92:95], v[248:251], v[216:219]
  buffer_load_dwordx4 v8, s[36:39], s27 offen offset:0 lds
  v_mfma_f32_16x16x32_bf16 v[108:111], v[64:67], v[252:255], v[108:111]
  ds_read_b128 v[232:235], v14 offset:2048
  v_mfma_f32_16x16x32_bf16 v[124:127], v[68:71], v[252:255], v[124:127]
  ds_read_b128 v[236:239], v14 offset:3072
  v_mfma_f32_16x16x32_bf16 v[140:143], v[72:75], v[252:255], v[140:143]
  v_mfma_f32_16x16x32_bf16 v[156:159], v[76:79], v[252:255], v[156:159]
  v_mfma_f32_16x16x32_bf16 v[172:175], v[80:83], v[252:255], v[172:175]
  buffer_load_dwordx4 v9, s[36:39], s27 offen offset:1024 lds
  v_mfma_f32_16x16x32_bf16 v[188:191], v[84:87], v[252:255], v[188:191]
  v_mfma_f32_16x16x32_bf16 v[204:207], v[88:91], v[252:255], v[204:207]
  v_mfma_f32_16x16x32_bf16 v[220:223], v[92:95], v[252:255], v[220:223]
  s_waitcnt vmcnt(17) lgkmcnt(0)
  v_mfma_f32_16x16x32_bf16 v[96:99], v[32:35], v[224:227], v[96:99]
  s_add_u32 s64, s64, 126976
  v_accvgpr_read_b32 v16, a0
  v_accvgpr_read_b32 v17, a1
  v_mfma_f32_16x16x32_bf16 v[112:115], v[36:39], v[224:227], v[112:115]
  ds_read_b64_tr_b16 v[64:65], v12 offset:40960
  v_accvgpr_read_b32 v18, a2
  v_mfma_f32_16x16x32_bf16 v[128:131], v[40:43], v[224:227], v[128:131]
  s_add_u32 m0, s24, 65536
  ds_read_b64_tr_b16 v[66:67], v12 offset:41984
  v_accvgpr_read_b32 v19, a3
  v_mfma_f32_16x16x32_bf16 v[144:147], v[44:47], v[224:227], v[144:147]
  buffer_load_dwordx4 v3, s[32:35], s26 offen offset:0 sc1 lds
  v_accvgpr_read_b32 v20, a4
  v_mfma_f32_16x16x32_bf16 v[160:163], v[48:51], v[224:227], v[160:163]
  ds_read_b64_tr_b16 v[68:69], v13 offset:40960
  v_accvgpr_read_b32 v21, a5
  v_mfma_f32_16x16x32_bf16 v[176:179], v[52:55], v[224:227], v[176:179]
  ds_read_b64_tr_b16 v[70:71], v13 offset:41984
  v_accvgpr_read_b32 v22, a6
  v_mfma_f32_16x16x32_bf16 v[192:195], v[56:59], v[224:227], v[192:195]
  ds_read_b64_tr_b16 v[72:73], v12 offset:41216
  v_accvgpr_read_b32 v23, a7
  v_mfma_f32_16x16x32_bf16 v[208:211], v[60:63], v[224:227], v[208:211]
  ds_read_b64_tr_b16 v[74:75], v12 offset:42240
  v_mul_f32 v16, s76, v16
  v_mfma_f32_16x16x32_bf16 v[100:103], v[32:35], v[228:231], v[100:103]
  buffer_load_dwordx4 v4, s[32:35], s26 offen offset:1024 sc1 lds
  v_mul_f32 v17, s76, v17
  v_mfma_f32_16x16x32_bf16 v[116:119], v[36:39], v[228:231], v[116:119]
  ds_read_b64_tr_b16 v[76:77], v13 offset:41216
  v_mul_f32 v18, s76, v18
  v_mfma_f32_16x16x32_bf16 v[132:135], v[40:43], v[228:231], v[132:135]
  ds_read_b64_tr_b16 v[78:79], v13 offset:42240
  v_mul_f32 v19, s76, v19
  v_mfma_f32_16x16x32_bf16 v[148:151], v[44:47], v[228:231], v[148:151]
  ds_read_b128 v[240:243], v14 offset:32768
  v_mul_f32 v20, s76, v20
  v_mfma_f32_16x16x32_bf16 v[164:167], v[48:51], v[228:231], v[164:167]
  ds_read_b128 v[244:247], v14 offset:33792
  v_mul_f32 v21, s76, v21
  v_mfma_f32_16x16x32_bf16 v[180:183], v[52:55], v[228:231], v[180:183]
  buffer_load_dwordx4 v5, s[32:35], s26 offen offset:2048 sc1 lds
  v_mul_f32 v22, s76, v22
  v_mfma_f32_16x16x32_bf16 v[196:199], v[56:59], v[228:231], v[196:199]
  ds_read_b64_tr_b16 v[80:81], v12 offset:41472
  v_mul_f32 v23, s76, v23
  v_mfma_f32_16x16x32_bf16 v[212:215], v[60:63], v[228:231], v[212:215]
  ds_read_b64_tr_b16 v[82:83], v12 offset:42496
  v_cvt_pk_bf16_f32 v24, v16, v17
  v_mfma_f32_16x16x32_bf16 v[104:107], v[32:35], v[232:235], v[104:107]
  ds_read_b64_tr_b16 v[84:85], v13 offset:41472
  v_cvt_pk_bf16_f32 v25, v18, v19
  v_mfma_f32_16x16x32_bf16 v[120:123], v[36:39], v[232:235], v[120:123]
  ds_read_b64_tr_b16 v[86:87], v13 offset:42496
  v_cvt_pk_bf16_f32 v26, v20, v21
  v_mfma_f32_16x16x32_bf16 v[136:139], v[40:43], v[232:235], v[136:139]
  buffer_load_dwordx4 v6, s[32:35], s26 offen offset:3072 sc1 lds
  v_cvt_pk_bf16_f32 v27, v22, v23
  v_mfma_f32_16x16x32_bf16 v[152:155], v[44:47], v[232:235], v[152:155]
  s_add_u32 s26, s26, 1024
  ds_read_b64_tr_b16 v[88:89], v12 offset:41728
  buffer_store_dwordx4 v[24:27], v2, s[40:43], s64 offen offset:0 sc1
  v_mfma_f32_16x16x32_bf16 v[168:171], v[48:51], v[232:235], v[168:171]
  ds_read_b64_tr_b16 v[90:91], v12 offset:42752
  v_mfma_f32_16x16x32_bf16 v[184:187], v[52:55], v[232:235], v[184:187]
  ds_read_b64_tr_b16 v[92:93], v13 offset:41728
  v_mfma_f32_16x16x32_bf16 v[200:203], v[56:59], v[232:235], v[200:203]
  s_add_u32 m0, s24, 81920
  ds_read_b64_tr_b16 v[94:95], v13 offset:42752
  v_mfma_f32_16x16x32_bf16 v[216:219], v[60:63], v[232:235], v[216:219]
  buffer_load_dwordx4 v10, s[36:39], s27 offen offset:2048 lds
  v_mfma_f32_16x16x32_bf16 v[108:111], v[32:35], v[236:239], v[108:111]
  ds_read_b128 v[248:251], v14 offset:34816
  v_mfma_f32_16x16x32_bf16 v[124:127], v[36:39], v[236:239], v[124:127]
  ds_read_b128 v[252:255], v14 offset:35840
  v_mfma_f32_16x16x32_bf16 v[140:143], v[40:43], v[236:239], v[140:143]
  v_mfma_f32_16x16x32_bf16 v[156:159], v[44:47], v[236:239], v[156:159]
  v_xor_b32 v14, 0x10000, v14
  v_mfma_f32_16x16x32_bf16 v[172:175], v[48:51], v[236:239], v[172:175]
  buffer_load_dwordx4 v11, s[36:39], s27 offen offset:3072 lds
  v_mfma_f32_16x16x32_bf16 v[188:191], v[52:55], v[236:239], v[188:191]
  s_add_u32 s27, s27, 524288
  v_xor_b32 v12, 0x10000, v12
  v_mfma_f32_16x16x32_bf16 v[204:207], v[56:59], v[236:239], v[204:207]
  v_xor_b32 v13, 0x10000, v13
  v_mfma_f32_16x16x32_bf16 v[220:223], v[60:63], v[236:239], v[220:223]
  s_waitcnt vmcnt(9) lgkmcnt(0)
  v_mfma_f32_16x16x32_bf16 v[96:99], v[64:67], v[240:243], v[96:99]
  s_barrier
  buffer_store_dword v12, off, s[40:43], s65 sc1
  v_accvgpr_read_b32 v16, a8
  v_mfma_f32_16x16x32_bf16 v[112:115], v[68:71], v[240:243], v[112:115]
  ds_read_b64_tr_b16 v[32:33], v12 offset:0
  v_accvgpr_read_b32 v17, a9
  v_mfma_f32_16x16x32_bf16 v[128:131], v[72:75], v[240:243], v[128:131]
  s_add_u32 m0, s24, 98304
  ds_read_b64_tr_b16 v[34:35], v12 offset:1024
  v_accvgpr_read_b32 v18, a10
  v_mfma_f32_16x16x32_bf16 v[144:147], v[76:79], v[240:243], v[144:147]
  buffer_load_dwordx4 v3, s[32:35], s26 offen offset:0 sc1 lds
  v_accvgpr_read_b32 v19, a11
  v_mfma_f32_16x16x32_bf16 v[160:163], v[80:83], v[240:243], v[160:163]
  ds_read_b64_tr_b16 v[36:37], v13 offset:0
  v_accvgpr_read_b32 v20, a12
  v_mfma_f32_16x16x32_bf16 v[176:179], v[84:87], v[240:243], v[176:179]
  ds_read_b64_tr_b16 v[38:39], v13 offset:1024
  v_accvgpr_read_b32 v21, a13
  v_mfma_f32_16x16x32_bf16 v[192:195], v[88:91], v[240:243], v[192:195]
  ds_read_b64_tr_b16 v[40:41], v12 offset:256
  v_accvgpr_read_b32 v22, a14
  v_mfma_f32_16x16x32_bf16 v[208:211], v[92:95], v[240:243], v[208:211]
  ds_read_b64_tr_b16 v[42:43], v12 offset:1280
  v_accvgpr_read_b32 v23, a15
  v_mfma_f32_16x16x32_bf16 v[100:103], v[64:67], v[244:247], v[100:103]
  buffer_load_dwordx4 v4, s[32:35], s26 offen offset:1024 sc1 lds
  v_mul_f32 v16, s76, v16
  v_mfma_f32_16x16x32_bf16 v[116:119], v[68:71], v[244:247], v[116:119]
  ds_read_b64_tr_b16 v[44:45], v13 offset:256
  v_mul_f32 v17, s76, v17
  v_mfma_f32_16x16x32_bf16 v[132:135], v[72:75], v[244:247], v[132:135]
  ds_read_b64_tr_b16 v[46:47], v13 offset:1280
  v_mul_f32 v18, s76, v18
  v_mfma_f32_16x16x32_bf16 v[148:151], v[76:79], v[244:247], v[148:151]
  ds_read_b128 v[224:227], v14 offset:0
  v_mul_f32 v19, s76, v19
  v_mfma_f32_16x16x32_bf16 v[164:167], v[80:83], v[244:247], v[164:167]
  ds_read_b128 v[228:231], v14 offset:1024
  v_mul_f32 v20, s76, v20
  v_mfma_f32_16x16x32_bf16 v[180:183], v[84:87], v[244:247], v[180:183]
  buffer_load_dwordx4 v5, s[32:35], s26 offen offset:2048 sc1 lds
  v_mul_f32 v21, s76, v21
  v_mfma_f32_16x16x32_bf16 v[196:199], v[88:91], v[244:247], v[196:199]
  ds_read_b64_tr_b16 v[48:49], v12 offset:512
  v_mul_f32 v22, s76, v22
  v_mfma_f32_16x16x32_bf16 v[212:215], v[92:95], v[244:247], v[212:215]
  ds_read_b64_tr_b16 v[50:51], v12 offset:1536
  v_mul_f32 v23, s76, v23
  v_mfma_f32_16x16x32_bf16 v[104:107], v[64:67], v[248:251], v[104:107]
  ds_read_b64_tr_b16 v[52:53], v13 offset:512
  v_cvt_pk_bf16_f32 v28, v16, v17
  v_mfma_f32_16x16x32_bf16 v[120:123], v[68:71], v[248:251], v[120:123]
  ds_read_b64_tr_b16 v[54:55], v13 offset:1536
  v_cvt_pk_bf16_f32 v29, v18, v19
  v_mfma_f32_16x16x32_bf16 v[136:139], v[72:75], v[248:251], v[136:139]
  buffer_load_dwordx4 v6, s[32:35], s26 offen offset:3072 sc1 lds
  v_cvt_pk_bf16_f32 v30, v20, v21
  v_mfma_f32_16x16x32_bf16 v[152:155], v[76:79], v[248:251], v[152:155]
  s_add_u32 s26, s26, 1024
  ds_read_b64_tr_b16 v[56:57], v12 offset:768
  v_cvt_pk_bf16_f32 v31, v22, v23
  v_mfma_f32_16x16x32_bf16 v[168:171], v[80:83], v[248:251], v[168:171]
  ds_read_b64_tr_b16 v[58:59], v12 offset:1792
  buffer_store_dwordx4 v[28:31], v2, s[40:43], s64 offen offset:1024 sc1
  v_mfma_f32_16x16x32_bf16 v[184:187], v[84:87], v[248:251], v[184:187]
  ds_read_b64_tr_b16 v[60:61], v13 offset:768
  v_mfma_f32_16x16x32_bf16 v[200:203], v[88:91], v[248:251], v[200:203]
  s_add_u32 m0, s24, 114688
  ds_read_b64_tr_b16 v[62:63], v13 offset:1792
  v_mfma_f32_16x16x32_bf16 v[216:219], v[92:95], v[248:251], v[216:219]
  buffer_load_dwordx4 v8, s[36:39], s27 offen offset:0 lds
  v_mfma_f32_16x16x32_bf16 v[108:111], v[64:67], v[252:255], v[108:111]
  ds_read_b128 v[232:235], v14 offset:2048
  v_mfma_f32_16x16x32_bf16 v[124:127], v[68:71], v[252:255], v[124:127]
  ds_read_b128 v[236:239], v14 offset:3072
  v_mfma_f32_16x16x32_bf16 v[140:143], v[72:75], v[252:255], v[140:143]
  v_mfma_f32_16x16x32_bf16 v[156:159], v[76:79], v[252:255], v[156:159]
  v_mfma_f32_16x16x32_bf16 v[172:175], v[80:83], v[252:255], v[172:175]
  buffer_load_dwordx4 v9, s[36:39], s27 offen offset:1024 lds
  v_mfma_f32_16x16x32_bf16 v[188:191], v[84:87], v[252:255], v[188:191]
  v_mfma_f32_16x16x32_bf16 v[204:207], v[88:91], v[252:255], v[204:207]
  v_mfma_f32_16x16x32_bf16 v[220:223], v[92:95], v[252:255], v[220:223]
  s_waitcnt vmcnt(18) lgkmcnt(0)
  v_mfma_f32_16x16x32_bf16 v[96:99], v[32:35], v[224:227], v[96:99]
  v_accvgpr_read_b32 v16, a16
  v_accvgpr_read_b32 v17, a17
  v_mfma_f32_16x16x32_bf16 v[112:115], v[36:39], v[224:227], v[112:115]
  ds_read_b64_tr_b16 v[64:65], v12 offset:8192
  v_accvgpr_read_b32 v18, a18
  v_mfma_f32_16x16x32_bf16 v[128:131], v[40:43], v[224:227], v[128:131]
  s_add_u32 m0, s24, 0
  ds_read_b64_tr_b16 v[66:67], v12 offset:9216
  v_accvgpr_read_b32 v19, a19
  v_mfma_f32_16x16x32_bf16 v[144:147], v[44:47], v[224:227], v[144:147]
  buffer_load_dwordx4 v3, s[32:35], s26 offen offset:0 sc1 lds
  v_accvgpr_read_b32 v20, a20
  v_mfma_f32_16x16x32_bf16 v[160:163], v[48:51], v[224:227], v[160:163]
  ds_read_b64_tr_b16 v[68:69], v13 offset:8192
  v_accvgpr_read_b32 v21, a21
  v_mfma_f32_16x16x32_bf16 v[176:179], v[52:55], v[224:227], v[176:179]
  ds_read_b64_tr_b16 v[70:71], v13 offset:9216
  v_accvgpr_read_b32 v22, a22
  v_mfma_f32_16x16x32_bf16 v[192:195], v[56:59], v[224:227], v[192:195]
  ds_read_b64_tr_b16 v[72:73], v12 offset:8448
  v_accvgpr_read_b32 v23, a23
  v_mfma_f32_16x16x32_bf16 v[208:211], v[60:63], v[224:227], v[208:211]
  ds_read_b64_tr_b16 v[74:75], v12 offset:9472
  v_mul_f32 v16, s76, v16
  v_mfma_f32_16x16x32_bf16 v[100:103], v[32:35], v[228:231], v[100:103]
  buffer_load_dwordx4 v4, s[32:35], s26 offen offset:1024 sc1 lds
  v_mul_f32 v17, s76, v17
  v_mfma_f32_16x16x32_bf16 v[116:119], v[36:39], v[228:231], v[116:119]
  ds_read_b64_tr_b16 v[76:77], v13 offset:8448
  v_mul_f32 v18, s76, v18
  v_mfma_f32_16x16x32_bf16 v[132:135], v[40:43], v[228:231], v[132:135]
  ds_read_b64_tr_b16 v[78:79], v13 offset:9472
  v_mul_f32 v19, s76, v19
  v_mfma_f32_16x16x32_bf16 v[148:151], v[44:47], v[228:231], v[148:151]
  ds_read_b128 v[240:243], v14 offset:32768
  v_mul_f32 v20, s76, v20
  v_mfma_f32_16x16x32_bf16 v[164:167], v[48:51], v[228:231], v[164:167]
  ds_read_b128 v[244:247], v14 offset:33792
  v_mul_f32 v21, s76, v21
  v_mfma_f32_16x16x32_bf16 v[180:183], v[52:55], v[228:231], v[180:183]
  buffer_load_dwordx4 v5, s[32:35], s26 offen offset:2048 sc1 lds
  v_mul_f32 v22, s76, v22
  v_mfma_f32_16x16x32_bf16 v[196:199], v[56:59], v[228:231], v[196:199]
  ds_read_b64_tr_b16 v[80:81], v12 offset:8704
  v_mul_f32 v23, s76, v23
  v_mfma_f32_16x16x32_bf16 v[212:215], v[60:63], v[228:231], v[212:215]
  ds_read_b64_tr_b16 v[82:83], v12 offset:9728
  v_cvt_pk_bf16_f32 v24, v16, v17
  v_mfma_f32_16x16x32_bf16 v[104:107], v[32:35], v[232:235], v[104:107]
  ds_read_b64_tr_b16 v[84:85], v13 offset:8704
  v_cvt_pk_bf16_f32 v25, v18, v19
  v_mfma_f32_16x16x32_bf16 v[120:123], v[36:39], v[232:235], v[120:123]
  ds_read_b64_tr_b16 v[86:87], v13 offset:9728
  v_cvt_pk_bf16_f32 v26, v20, v21
  v_mfma_f32_16x16x32_bf16 v[136:139], v[40:43], v[232:235], v[136:139]
  buffer_load_dwordx4 v6, s[32:35], s26 offen offset:3072 sc1 lds
  v_cvt_pk_bf16_f32 v27, v22, v23
  v_mfma_f32_16x16x32_bf16 v[152:155], v[44:47], v[232:235], v[152:155]
  s_add_u32 s26, s26, 1024
  ds_read_b64_tr_b16 v[88:89], v12 offset:8960
  buffer_store_dwordx4 v[24:27], v2, s[40:43], s64 offen offset:2048 sc1
  v_mfma_f32_16x16x32_bf16 v[168:171], v[48:51], v[232:235], v[168:171]
  ds_read_b64_tr_b16 v[90:91], v12 offset:9984
  v_mfma_f32_16x16x32_bf16 v[184:187], v[52:55], v[232:235], v[184:187]
  ds_read_b64_tr_b16 v[92:93], v13 offset:8960
  v_mfma_f32_16x16x32_bf16 v[200:203], v[56:59], v[232:235], v[200:203]
  s_add_u32 m0, s24, 114688
  ds_read_b64_tr_b16 v[94:95], v13 offset:9984
  v_mfma_f32_16x16x32_bf16 v[216:219], v[60:63], v[232:235], v[216:219]
  buffer_load_dwordx4 v10, s[36:39], s27 offen offset:2048 lds
  v_mfma_f32_16x16x32_bf16 v[108:111], v[32:35], v[236:239], v[108:111]
  ds_read_b128 v[248:251], v14 offset:34816
  v_mfma_f32_16x16x32_bf16 v[124:127], v[36:39], v[236:239], v[124:127]
  ds_read_b128 v[252:255], v14 offset:35840
  v_mfma_f32_16x16x32_bf16 v[140:143], v[40:43], v[236:239], v[140:143]
  v_mfma_f32_16x16x32_bf16 v[156:159], v[44:47], v[236:239], v[156:159]
  v_xor_b32 v14, 0x10000, v14
  v_mfma_f32_16x16x32_bf16 v[172:175], v[48:51], v[236:239], v[172:175]
  buffer_load_dwordx4 v11, s[36:39], s27 offen offset:3072 lds
  v_mfma_f32_16x16x32_bf16 v[188:191], v[52:55], v[236:239], v[188:191]
  s_add_u32 s27, s27, 524288
  v_mfma_f32_16x16x32_bf16 v[204:207], v[56:59], v[236:239], v[204:207]
  v_mfma_f32_16x16x32_bf16 v[220:223], v[60:63], v[236:239], v[220:223]
  s_waitcnt vmcnt(18) lgkmcnt(0)
  v_mfma_f32_16x16x32_bf16 v[96:99], v[64:67], v[240:243], v[96:99]
  s_barrier
  v_accvgpr_read_b32 v16, a24
  v_accvgpr_read_b32 v17, a25
  v_mfma_f32_16x16x32_bf16 v[112:115], v[68:71], v[240:243], v[112:115]
  ds_read_b64_tr_b16 v[32:33], v12 offset:32768
  v_accvgpr_read_b32 v18, a26
  v_mfma_f32_16x16x32_bf16 v[128:131], v[72:75], v[240:243], v[128:131]
  s_add_u32 m0, s24, 32768
  ds_read_b64_tr_b16 v[34:35], v12 offset:33792
  v_accvgpr_read_b32 v19, a27
  v_mfma_f32_16x16x32_bf16 v[144:147], v[76:79], v[240:243], v[144:147]
  buffer_load_dwordx4 v3, s[32:35], s26 offen offset:0 sc1 lds
  v_accvgpr_read_b32 v20, a28
  v_mfma_f32_16x16x32_bf16 v[160:163], v[80:83], v[240:243], v[160:163]
  ds_read_b64_tr_b16 v[36:37], v13 offset:32768
  v_accvgpr_read_b32 v21, a29
  v_mfma_f32_16x16x32_bf16 v[176:179], v[84:87], v[240:243], v[176:179]
  ds_read_b64_tr_b16 v[38:39], v13 offset:33792
  v_accvgpr_read_b32 v22, a30
  v_mfma_f32_16x16x32_bf16 v[192:195], v[88:91], v[240:243], v[192:195]
  ds_read_b64_tr_b16 v[40:41], v12 offset:33024
  v_accvgpr_read_b32 v23, a31
  v_mfma_f32_16x16x32_bf16 v[208:211], v[92:95], v[240:243], v[208:211]
  ds_read_b64_tr_b16 v[42:43], v12 offset:34048
  v_mul_f32 v16, s76, v16
  v_mfma_f32_16x16x32_bf16 v[100:103], v[64:67], v[244:247], v[100:103]
  buffer_load_dwordx4 v4, s[32:35], s26 offen offset:1024 sc1 lds
  v_mul_f32 v17, s76, v17
  v_mfma_f32_16x16x32_bf16 v[116:119], v[68:71], v[244:247], v[116:119]
  ds_read_b64_tr_b16 v[44:45], v13 offset:33024
  v_mul_f32 v18, s76, v18
  v_mfma_f32_16x16x32_bf16 v[132:135], v[72:75], v[244:247], v[132:135]
  ds_read_b64_tr_b16 v[46:47], v13 offset:34048
  v_mul_f32 v19, s76, v19
  v_mfma_f32_16x16x32_bf16 v[148:151], v[76:79], v[244:247], v[148:151]
  ds_read_b128 v[224:227], v14 offset:0
  v_mul_f32 v20, s76, v20
  v_mfma_f32_16x16x32_bf16 v[164:167], v[80:83], v[244:247], v[164:167]
  ds_read_b128 v[228:231], v14 offset:1024
  v_mul_f32 v21, s76, v21
  v_mfma_f32_16x16x32_bf16 v[180:183], v[84:87], v[244:247], v[180:183]
  buffer_load_dwordx4 v5, s[32:35], s26 offen offset:2048 sc1 lds
  v_mul_f32 v22, s76, v22
  v_mfma_f32_16x16x32_bf16 v[196:199], v[88:91], v[244:247], v[196:199]
  ds_read_b64_tr_b16 v[48:49], v12 offset:33280
  v_mul_f32 v23, s76, v23
  v_mfma_f32_16x16x32_bf16 v[212:215], v[92:95], v[244:247], v[212:215]
  ds_read_b64_tr_b16 v[50:51], v12 offset:34304
  v_cvt_pk_bf16_f32 v28, v16, v17
  v_mfma_f32_16x16x32_bf16 v[104:107], v[64:67], v[248:251], v[104:107]
  ds_read_b64_tr_b16 v[52:53], v13 offset:33280
  v_cvt_pk_bf16_f32 v29, v18, v19
  v_mfma_f32_16x16x32_bf16 v[120:123], v[68:71], v[248:251], v[120:123]
  ds_read_b64_tr_b16 v[54:55], v13 offset:34304
  v_cvt_pk_bf16_f32 v30, v20, v21
  v_mfma_f32_16x16x32_bf16 v[136:139], v[72:75], v[248:251], v[136:139]
  buffer_load_dwordx4 v6, s[32:35], s26 offen offset:3072 sc1 lds
  v_cvt_pk_bf16_f32 v31, v22, v23
  v_mfma_f32_16x16x32_bf16 v[152:155], v[76:79], v[248:251], v[152:155]
  s_add_u32 s26, s26, 1024
  ds_read_b64_tr_b16 v[56:57], v12 offset:33536
  buffer_store_dwordx4 v[28:31], v2, s[40:43], s64 offen offset:3072 sc1
  v_mfma_f32_16x16x32_bf16 v[168:171], v[80:83], v[248:251], v[168:171]
  ds_read_b64_tr_b16 v[58:59], v12 offset:34560
  v_mfma_f32_16x16x32_bf16 v[184:187], v[84:87], v[248:251], v[184:187]
  ds_read_b64_tr_b16 v[60:61], v13 offset:33536
  v_mfma_f32_16x16x32_bf16 v[200:203], v[88:91], v[248:251], v[200:203]
  s_add_u32 m0, s24, 16384
  ds_read_b64_tr_b16 v[62:63], v13 offset:34560
  v_mfma_f32_16x16x32_bf16 v[216:219], v[92:95], v[248:251], v[216:219]
  buffer_load_dwordx4 v8, s[36:39], s27 offen offset:0 lds
  v_mfma_f32_16x16x32_bf16 v[108:111], v[64:67], v[252:255], v[108:111]
  ds_read_b128 v[232:235], v14 offset:2048
  v_mfma_f32_16x16x32_bf16 v[124:127], v[68:71], v[252:255], v[124:127]
  ds_read_b128 v[236:239], v14 offset:3072
  v_mfma_f32_16x16x32_bf16 v[140:143], v[72:75], v[252:255], v[140:143]
  v_mfma_f32_16x16x32_bf16 v[156:159], v[76:79], v[252:255], v[156:159]
  v_mfma_f32_16x16x32_bf16 v[172:175], v[80:83], v[252:255], v[172:175]
  buffer_load_dwordx4 v9, s[36:39], s27 offen offset:1024 lds
  v_mfma_f32_16x16x32_bf16 v[188:191], v[84:87], v[252:255], v[188:191]
  v_mfma_f32_16x16x32_bf16 v[204:207], v[88:91], v[252:255], v[204:207]
  v_mfma_f32_16x16x32_bf16 v[220:223], v[92:95], v[252:255], v[220:223]
  s_waitcnt vmcnt(17) lgkmcnt(0)
  v_mfma_f32_16x16x32_bf16 v[96:99], v[32:35], v[224:227], v[96:99]
  s_add_u32 s64, s64, 4096
  v_accvgpr_read_b32 v16, a32
  v_accvgpr_read_b32 v17, a33
  v_mfma_f32_16x16x32_bf16 v[112:115], v[36:39], v[224:227], v[112:115]
  ds_read_b64_tr_b16 v[64:65], v12 offset:40960
  v_accvgpr_read_b32 v18, a34
  v_mfma_f32_16x16x32_bf16 v[128:131], v[40:43], v[224:227], v[128:131]
  s_add_u32 m0, s24, 65536
  ds_read_b64_tr_b16 v[66:67], v12 offset:41984
  v_accvgpr_read_b32 v19, a35
  v_mfma_f32_16x16x32_bf16 v[144:147], v[44:47], v[224:227], v[144:147]
  buffer_load_dwordx4 v3, s[32:35], s26 offen offset:0 sc1 lds
  v_accvgpr_read_b32 v20, a36
  v_mfma_f32_16x16x32_bf16 v[160:163], v[48:51], v[224:227], v[160:163]
  ds_read_b64_tr_b16 v[68:69], v13 offset:40960
  v_accvgpr_read_b32 v21, a37
  v_mfma_f32_16x16x32_bf16 v[176:179], v[52:55], v[224:227], v[176:179]
  ds_read_b64_tr_b16 v[70:71], v13 offset:41984
  v_accvgpr_read_b32 v22, a38
  v_mfma_f32_16x16x32_bf16 v[192:195], v[56:59], v[224:227], v[192:195]
  ds_read_b64_tr_b16 v[72:73], v12 offset:41216
  v_accvgpr_read_b32 v23, a39
  v_mfma_f32_16x16x32_bf16 v[208:211], v[60:63], v[224:227], v[208:211]
  ds_read_b64_tr_b16 v[74:75], v12 offset:42240
  v_mul_f32 v16, s76, v16
  v_mfma_f32_16x16x32_bf16 v[100:103], v[32:35], v[228:231], v[100:103]
  buffer_load_dwordx4 v4, s[32:35], s26 offen offset:1024 sc1 lds
  v_mul_f32 v17, s76, v17
  v_mfma_f32_16x16x32_bf16 v[116:119], v[36:39], v[228:231], v[116:119]
  ds_read_b64_tr_b16 v[76:77], v13 offset:41216
  v_mul_f32 v18, s76, v18
  v_mfma_f32_16x16x32_bf16 v[132:135], v[40:43], v[228:231], v[132:135]
  ds_read_b64_tr_b16 v[78:79], v13 offset:42240
  v_mul_f32 v19, s76, v19
  v_mfma_f32_16x16x32_bf16 v[148:151], v[44:47], v[228:231], v[148:151]
  ds_read_b128 v[240:243], v14 offset:32768
  v_mul_f32 v20, s76, v20
  v_mfma_f32_16x16x32_bf16 v[164:167], v[48:51], v[228:231], v[164:167]
  ds_read_b128 v[244:247], v14 offset:33792
  v_mul_f32 v21, s76, v21
  v_mfma_f32_16x16x32_bf16 v[180:183], v[52:55], v[228:231], v[180:183]
  buffer_load_dwordx4 v5, s[32:35], s26 offen offset:2048 sc1 lds
  v_mul_f32 v22, s76, v22
  v_mfma_f32_16x16x32_bf16 v[196:199], v[56:59], v[228:231], v[196:199]
  ds_read_b64_tr_b16 v[80:81], v12 offset:41472
  v_mul_f32 v23, s76, v23
  v_mfma_f32_16x16x32_bf16 v[212:215], v[60:63], v[228:231], v[212:215]
  ds_read_b64_tr_b16 v[82:83], v12 offset:42496
  v_cvt_pk_bf16_f32 v24, v16, v17
  v_mfma_f32_16x16x32_bf16 v[104:107], v[32:35], v[232:235], v[104:107]
  ds_read_b64_tr_b16 v[84:85], v13 offset:41472
  v_cvt_pk_bf16_f32 v25, v18, v19
  v_mfma_f32_16x16x32_bf16 v[120:123], v[36:39], v[232:235], v[120:123]
  ds_read_b64_tr_b16 v[86:87], v13 offset:42496
  v_cvt_pk_bf16_f32 v26, v20, v21
  v_mfma_f32_16x16x32_bf16 v[136:139], v[40:43], v[232:235], v[136:139]
  buffer_load_dwordx4 v6, s[32:35], s26 offen offset:3072 sc1 lds
  v_cvt_pk_bf16_f32 v27, v22, v23
  v_mfma_f32_16x16x32_bf16 v[152:155], v[44:47], v[232:235], v[152:155]
  s_add_u32 s26, s26, 1024
  ds_read_b64_tr_b16 v[88:89], v12 offset:41728
  buffer_store_dwordx4 v[24:27], v2, s[40:43], s64 offen offset:0 sc1
  v_mfma_f32_16x16x32_bf16 v[168:171], v[48:51], v[232:235], v[168:171]
  ds_read_b64_tr_b16 v[90:91], v12 offset:42752
  v_mfma_f32_16x16x32_bf16 v[184:187], v[52:55], v[232:235], v[184:187]
  ds_read_b64_tr_b16 v[92:93], v13 offset:41728
  v_mfma_f32_16x16x32_bf16 v[200:203], v[56:59], v[232:235], v[200:203]
  s_add_u32 m0, s24, 16384
  ds_read_b64_tr_b16 v[94:95], v13 offset:42752
  v_mfma_f32_16x16x32_bf16 v[216:219], v[60:63], v[232:235], v[216:219]
  buffer_load_dwordx4 v10, s[36:39], s27 offen offset:2048 lds
  v_mfma_f32_16x16x32_bf16 v[108:111], v[32:35], v[236:239], v[108:111]
  ds_read_b128 v[248:251], v14 offset:34816
  v_mfma_f32_16x16x32_bf16 v[124:127], v[36:39], v[236:239], v[124:127]
  ds_read_b128 v[252:255], v14 offset:35840
  v_mfma_f32_16x16x32_bf16 v[140:143], v[40:43], v[236:239], v[140:143]
  v_mfma_f32_16x16x32_bf16 v[156:159], v[44:47], v[236:239], v[156:159]
  v_xor_b32 v14, 0x10000, v14
  v_mfma_f32_16x16x32_bf16 v[172:175], v[48:51], v[236:239], v[172:175]
  buffer_load_dwordx4 v11, s[36:39], s27 offen offset:3072 lds
  v_mfma_f32_16x16x32_bf16 v[188:191], v[52:55], v[236:239], v[188:191]
  s_add_u32 s27, s27, 524288
  v_xor_b32 v12, 0x10000, v12
  v_mfma_f32_16x16x32_bf16 v[204:207], v[56:59], v[236:239], v[204:207]
  v_xor_b32 v13, 0x10000, v13
  v_mfma_f32_16x16x32_bf16 v[220:223], v[60:63], v[236:239], v[220:223]
  s_waitcnt vmcnt(17) lgkmcnt(0)
  v_mfma_f32_16x16x32_bf16 v[96:99], v[64:67], v[240:243], v[96:99]
  s_barrier
  v_accvgpr_read_b32 v16, a40
  v_accvgpr_read_b32 v17, a41
  v_mfma_f32_16x16x32_bf16 v[112:115], v[68:71], v[240:243], v[112:115]
  ds_read_b64_tr_b16 v[32:33], v12 offset:0
  v_accvgpr_read_b32 v18, a42
  v_mfma_f32_16x16x32_bf16 v[128:131], v[72:75], v[240:243], v[128:131]
  s_add_u32 m0, s24, 98304
  ds_read_b64_tr_b16 v[34:35], v12 offset:1024
  v_accvgpr_read_b32 v19, a43
  v_mfma_f32_16x16x32_bf16 v[144:147], v[76:79], v[240:243], v[144:147]
  buffer_load_dwordx4 v3, s[32:35], s26 offen offset:0 sc1 lds
  v_accvgpr_read_b32 v20, a44
  v_mfma_f32_16x16x32_bf16 v[160:163], v[80:83], v[240:243], v[160:163]
  ds_read_b64_tr_b16 v[36:37], v13 offset:0
  v_accvgpr_read_b32 v21, a45
  v_mfma_f32_16x16x32_bf16 v[176:179], v[84:87], v[240:243], v[176:179]
  ds_read_b64_tr_b16 v[38:39], v13 offset:1024
  v_accvgpr_read_b32 v22, a46
  v_mfma_f32_16x16x32_bf16 v[192:195], v[88:91], v[240:243], v[192:195]
  ds_read_b64_tr_b16 v[40:41], v12 offset:256
  v_accvgpr_read_b32 v23, a47
  v_mfma_f32_16x16x32_bf16 v[208:211], v[92:95], v[240:243], v[208:211]
  ds_read_b64_tr_b16 v[42:43], v12 offset:1280
  v_mul_f32 v16, s76, v16
  v_mfma_f32_16x16x32_bf16 v[100:103], v[64:67], v[244:247], v[100:103]
  buffer_load_dwordx4 v4, s[32:35], s26 offen offset:1024 sc1 lds
  v_mul_f32 v17, s76, v17
  v_mfma_f32_16x16x32_bf16 v[116:119], v[68:71], v[244:247], v[116:119]
  ds_read_b64_tr_b16 v[44:45], v13 offset:256
  v_mul_f32 v18, s76, v18
  v_mfma_f32_16x16x32_bf16 v[132:135], v[72:75], v[244:247], v[132:135]
  ds_read_b64_tr_b16 v[46:47], v13 offset:1280
  v_mul_f32 v19, s76, v19
  v_mfma_f32_16x16x32_bf16 v[148:151], v[76:79], v[244:247], v[148:151]
  ds_read_b128 v[224:227], v14 offset:0
  v_mul_f32 v20, s76, v20
  v_mfma_f32_16x16x32_bf16 v[164:167], v[80:83], v[244:247], v[164:167]
  ds_read_b128 v[228:231], v14 offset:1024
  v_mul_f32 v21, s76, v21
  v_mfma_f32_16x16x32_bf16 v[180:183], v[84:87], v[244:247], v[180:183]
  buffer_load_dwordx4 v5, s[32:35], s26 offen offset:2048 sc1 lds
  v_mul_f32 v22, s76, v22
  v_mfma_f32_16x16x32_bf16 v[196:199], v[88:91], v[244:247], v[196:199]
  ds_read_b64_tr_b16 v[48:49], v12 offset:512
  v_mul_f32 v23, s76, v23
  v_mfma_f32_16x16x32_bf16 v[212:215], v[92:95], v[244:247], v[212:215]
  ds_read_b64_tr_b16 v[50:51], v12 offset:1536
  v_cvt_pk_bf16_f32 v28, v16, v17
  v_mfma_f32_16x16x32_bf16 v[104:107], v[64:67], v[248:251], v[104:107]
  ds_read_b64_tr_b16 v[52:53], v13 offset:512
  v_cvt_pk_bf16_f32 v29, v18, v19
  v_mfma_f32_16x16x32_bf16 v[120:123], v[68:71], v[248:251], v[120:123]
  ds_read_b64_tr_b16 v[54:55], v13 offset:1536
  v_cvt_pk_bf16_f32 v30, v20, v21
  v_mfma_f32_16x16x32_bf16 v[136:139], v[72:75], v[248:251], v[136:139]
  buffer_load_dwordx4 v6, s[32:35], s26 offen offset:3072 sc1 lds
  v_cvt_pk_bf16_f32 v31, v22, v23
  v_mfma_f32_16x16x32_bf16 v[152:155], v[76:79], v[248:251], v[152:155]
  s_add_u32 s26, s26, 1024
  ds_read_b64_tr_b16 v[56:57], v12 offset:768
  buffer_store_dwordx4 v[28:31], v2, s[40:43], s64 offen offset:1024 sc1
  v_mfma_f32_16x16x32_bf16 v[168:171], v[80:83], v[248:251], v[168:171]
  ds_read_b64_tr_b16 v[58:59], v12 offset:1792
  v_mfma_f32_16x16x32_bf16 v[184:187], v[84:87], v[248:251], v[184:187]
  ds_read_b64_tr_b16 v[60:61], v13 offset:768
  v_mfma_f32_16x16x32_bf16 v[200:203], v[88:91], v[248:251], v[200:203]
  s_add_u32 m0, s24, 49152
  ds_read_b64_tr_b16 v[62:63], v13 offset:1792
  v_mfma_f32_16x16x32_bf16 v[216:219], v[92:95], v[248:251], v[216:219]
  buffer_load_dwordx4 v8, s[36:39], s27 offen offset:0 lds
  v_mfma_f32_16x16x32_bf16 v[108:111], v[64:67], v[252:255], v[108:111]
  ds_read_b128 v[232:235], v14 offset:2048
  v_mfma_f32_16x16x32_bf16 v[124:127], v[68:71], v[252:255], v[124:127]
  ds_read_b128 v[236:239], v14 offset:3072
  v_mfma_f32_16x16x32_bf16 v[140:143], v[72:75], v[252:255], v[140:143]
  v_mfma_f32_16x16x32_bf16 v[156:159], v[76:79], v[252:255], v[156:159]
  v_mfma_f32_16x16x32_bf16 v[172:175], v[80:83], v[252:255], v[172:175]
  buffer_load_dwordx4 v9, s[36:39], s27 offen offset:1024 lds
  v_mfma_f32_16x16x32_bf16 v[188:191], v[84:87], v[252:255], v[188:191]
  v_mfma_f32_16x16x32_bf16 v[204:207], v[88:91], v[252:255], v[204:207]
  v_mfma_f32_16x16x32_bf16 v[220:223], v[92:95], v[252:255], v[220:223]
  s_waitcnt vmcnt(17) lgkmcnt(0)
  v_mfma_f32_16x16x32_bf16 v[96:99], v[32:35], v[224:227], v[96:99]
  v_accvgpr_read_b32 v16, a48
  v_accvgpr_read_b32 v17, a49
  v_accvgpr_read_b32 v18, a50
  v_mfma_f32_16x16x32_bf16 v[112:115], v[36:39], v[224:227], v[112:115]
  ds_read_b64_tr_b16 v[64:65], v12 offset:8192
  v_accvgpr_read_b32 v19, a51
  v_mfma_f32_16x16x32_bf16 v[128:131], v[40:43], v[224:227], v[128:131]
  s_add_u32 m0, s24, 0
  ds_read_b64_tr_b16 v[66:67], v12 offset:9216
  v_accvgpr_read_b32 v20, a52
  v_mfma_f32_16x16x32_bf16 v[144:147], v[44:47], v[224:227], v[144:147]
  buffer_load_dwordx4 v3, s[32:35], s26 offen offset:0 sc1 lds
  v_accvgpr_read_b32 v21, a53
  v_accvgpr_read_b32 v22, a54
  v_mfma_f32_16x16x32_bf16 v[160:163], v[48:51], v[224:227], v[160:163]
  ds_read_b64_tr_b16 v[68:69], v13 offset:8192
  v_accvgpr_read_b32 v23, a55
  v_mfma_f32_16x16x32_bf16 v[176:179], v[52:55], v[224:227], v[176:179]
  ds_read_b64_tr_b16 v[70:71], v13 offset:9216
  v_mul_f32 v16, s76, v16
  v_mfma_f32_16x16x32_bf16 v[192:195], v[56:59], v[224:227], v[192:195]
  ds_read_b64_tr_b16 v[72:73], v12 offset:8448
  v_mul_f32 v17, s76, v17
  v_mfma_f32_16x16x32_bf16 v[208:211], v[60:63], v[224:227], v[208:211]
  ds_read_b64_tr_b16 v[74:75], v12 offset:9472
  v_mul_f32 v18, s76, v18
  v_mul_f32 v19, s76, v19
  v_mfma_f32_16x16x32_bf16 v[100:103], v[32:35], v[228:231], v[100:103]
  buffer_load_dwordx4 v4, s[32:35], s26 offen offset:1024 sc1 lds
  v_mul_f32 v20, s76, v20
  v_mfma_f32_16x16x32_bf16 v[116:119], v[36:39], v[228:231], v[116:119]
  ds_read_b64_tr_b16 v[76:77], v13 offset:8448
  v_mul_f32 v21, s76, v21
  v_mfma_f32_16x16x32_bf16 v[132:135], v[40:43], v[228:231], v[132:135]
  ds_read_b64_tr_b16 v[78:79], v13 offset:9472
  v_mul_f32 v22, s76, v22
  v_mfma_f32_16x16x32_bf16 v[148:151], v[44:47], v[228:231], v[148:151]
  ds_read_b128 v[240:243], v14 offset:32768
  v_mul_f32 v23, s76, v23
  v_cvt_pk_bf16_f32 v24, v16, v17
  v_mfma_f32_16x16x32_bf16 v[164:167], v[48:51], v[228:231], v[164:167]
  ds_read_b128 v[244:247], v14 offset:33792
  v_cvt_pk_bf16_f32 v25, v18, v19
  v_mfma_f32_16x16x32_bf16 v[180:183], v[52:55], v[228:231], v[180:183]
  buffer_load_dwordx4 v5, s[32:35], s26 offen offset:2048 sc1 lds
  v_cvt_pk_bf16_f32 v26, v20, v21
  v_mfma_f32_16x16x32_bf16 v[196:199], v[56:59], v[228:231], v[196:199]
  ds_read_b64_tr_b16 v[80:81], v12 offset:8704
  v_cvt_pk_bf16_f32 v27, v22, v23
  v_mfma_f32_16x16x32_bf16 v[212:215], v[60:63], v[228:231], v[212:215]
  ds_read_b64_tr_b16 v[82:83], v12 offset:9728
  buffer_store_dwordx4 v[24:27], v2, s[40:43], s64 offen offset:2048 sc1
  v_accvgpr_read_b32 v16, a56
  v_mfma_f32_16x16x32_bf16 v[104:107], v[32:35], v[232:235], v[104:107]
  ds_read_b64_tr_b16 v[84:85], v13 offset:8704
  v_accvgpr_read_b32 v17, a57
  v_mfma_f32_16x16x32_bf16 v[120:123], v[36:39], v[232:235], v[120:123]
  ds_read_b64_tr_b16 v[86:87], v13 offset:9728
  v_accvgpr_read_b32 v18, a58
  v_mfma_f32_16x16x32_bf16 v[136:139], v[40:43], v[232:235], v[136:139]
  buffer_load_dwordx4 v6, s[32:35], s26 offen offset:3072 sc1 lds
  v_accvgpr_read_b32 v19, a59
  v_accvgpr_read_b32 v20, a60
  v_mfma_f32_16x16x32_bf16 v[152:155], v[44:47], v[232:235], v[152:155]
  s_add_u32 s26, s26, 1024
  ds_read_b64_tr_b16 v[88:89], v12 offset:8960
  v_accvgpr_read_b32 v21, a61
  v_mfma_f32_16x16x32_bf16 v[168:171], v[48:51], v[232:235], v[168:171]
  ds_read_b64_tr_b16 v[90:91], v12 offset:9984
  v_accvgpr_read_b32 v22, a62
  v_mfma_f32_16x16x32_bf16 v[184:187], v[52:55], v[232:235], v[184:187]
  ds_read_b64_tr_b16 v[92:93], v13 offset:8960
  v_accvgpr_read_b32 v23, a63
  v_mfma_f32_16x16x32_bf16 v[200:203], v[56:59], v[232:235], v[200:203]
  s_add_u32 m0, s24, 49152
  ds_read_b64_tr_b16 v[94:95], v13 offset:9984
  v_mul_f32 v16, s76, v16
  v_mul_f32 v17, s76, v17
  v_mfma_f32_16x16x32_bf16 v[216:219], v[60:63], v[232:235], v[216:219]
  buffer_load_dwordx4 v10, s[36:39], s27 offen offset:2048 lds
  v_mul_f32 v18, s76, v18
  v_mfma_f32_16x16x32_bf16 v[108:111], v[32:35], v[236:239], v[108:111]
  ds_read_b128 v[248:251], v14 offset:34816
  v_mul_f32 v19, s76, v19
  v_mfma_f32_16x16x32_bf16 v[124:127], v[36:39], v[236:239], v[124:127]
  ds_read_b128 v[252:255], v14 offset:35840
  v_mul_f32 v20, s76, v20
  v_mfma_f32_16x16x32_bf16 v[140:143], v[40:43], v[236:239], v[140:143]
  v_mul_f32 v21, s76, v21
  v_mul_f32 v22, s76, v22
  v_mul_f32 v23, s76, v23
  v_mfma_f32_16x16x32_bf16 v[156:159], v[44:47], v[236:239], v[156:159]
  v_xor_b32 v14, 0x10000, v14
  v_cvt_pk_bf16_f32 v28, v16, v17
  v_mfma_f32_16x16x32_bf16 v[172:175], v[48:51], v[236:239], v[172:175]
  buffer_load_dwordx4 v11, s[36:39], s27 offen offset:3072 lds
  v_cvt_pk_bf16_f32 v29, v18, v19
  v_mfma_f32_16x16x32_bf16 v[188:191], v[52:55], v[236:239], v[188:191]
  s_add_u32 s27, s27, 524288
  v_cvt_pk_bf16_f32 v30, v20, v21
  v_cvt_pk_bf16_f32 v31, v22, v23
  v_mfma_f32_16x16x32_bf16 v[204:207], v[56:59], v[236:239], v[204:207]
  buffer_store_dwordx4 v[28:31], v2, s[40:43], s64 offen offset:3072 sc1
  v_mfma_f32_16x16x32_bf16 v[220:223], v[60:63], v[236:239], v[220:223]
  s_waitcnt vmcnt(18) lgkmcnt(0)
  v_mfma_f32_16x16x32_bf16 v[96:99], v[64:67], v[240:243], v[96:99]
  s_barrier
  v_accvgpr_read_b32 v16, a64
  v_accvgpr_read_b32 v17, a65
  v_accvgpr_read_b32 v18, a66
  v_mfma_f32_16x16x32_bf16 v[112:115], v[68:71], v[240:243], v[112:115]
  s_add_u32 s64, s64, 126976
  ds_read_b64_tr_b16 v[32:33], v12 offset:32768
  v_accvgpr_read_b32 v19, a67
  v_accvgpr_read_b32 v20, a68
  v_mfma_f32_16x16x32_bf16 v[128:131], v[72:75], v[240:243], v[128:131]
  s_add_u32 m0, s24, 32768
  ds_read_b64_tr_b16 v[34:35], v12 offset:33792
  v_accvgpr_read_b32 v21, a69
  v_mfma_f32_16x16x32_bf16 v[144:147], v[76:79], v[240:243], v[144:147]
  buffer_load_dwordx4 v3, s[32:35], s26 offen offset:0 sc1 lds
  v_accvgpr_read_b32 v22, a70
  v_accvgpr_read_b32 v23, a71
  v_mfma_f32_16x16x32_bf16 v[160:163], v[80:83], v[240:243], v[160:163]
  ds_read_b64_tr_b16 v[36:37], v13 offset:32768
  v_mul_f32 v16, s76, v16
  v_mfma_f32_16x16x32_bf16 v[176:179], v[84:87], v[240:243], v[176:179]
  ds_read_b64_tr_b16 v[38:39], v13 offset:33792
  v_mul_f32 v17, s76, v17
  v_mul_f32 v18, s76, v18
  v_mfma_f32_16x16x32_bf16 v[192:195], v[88:91], v[240:243], v[192:195]
  ds_read_b64_tr_b16 v[40:41], v12 offset:33024
  v_mul_f32 v19, s76, v19
  v_mfma_f32_16x16x32_bf16 v[208:211], v[92:95], v[240:243], v[208:211]
  ds_read_b64_tr_b16 v[42:43], v12 offset:34048
  v_mul_f32 v20, s76, v20
  v_mul_f32 v21, s76, v21
  v_mfma_f32_16x16x32_bf16 v[100:103], v[64:67], v[244:247], v[100:103]
  buffer_load_dwordx4 v4, s[32:35], s26 offen offset:1024 sc1 lds
  v_mul_f32 v22, s76, v22
  v_mfma_f32_16x16x32_bf16 v[116:119], v[68:71], v[244:247], v[116:119]
  ds_read_b64_tr_b16 v[44:45], v13 offset:33024
  v_mul_f32 v23, s76, v23
  v_cvt_pk_bf16_f32 v24, v16, v17
  v_mfma_f32_16x16x32_bf16 v[132:135], v[72:75], v[244:247], v[132:135]
  ds_read_b64_tr_b16 v[46:47], v13 offset:34048
  v_cvt_pk_bf16_f32 v25, v18, v19
  v_mfma_f32_16x16x32_bf16 v[148:151], v[76:79], v[244:247], v[148:151]
  ds_read_b128 v[224:227], v14 offset:0
  v_cvt_pk_bf16_f32 v26, v20, v21
  v_cvt_pk_bf16_f32 v27, v22, v23
  v_mfma_f32_16x16x32_bf16 v[164:167], v[80:83], v[244:247], v[164:167]
  ds_read_b128 v[228:231], v14 offset:1024
  buffer_store_dwordx4 v[24:27], v2, s[40:43], s64 offen offset:0 sc1
  v_mfma_f32_16x16x32_bf16 v[180:183], v[84:87], v[244:247], v[180:183]
  buffer_load_dwordx4 v5, s[32:35], s26 offen offset:2048 sc1 lds
  v_accvgpr_read_b32 v16, a72
  v_accvgpr_read_b32 v17, a73
  v_mfma_f32_16x16x32_bf16 v[196:199], v[88:91], v[244:247], v[196:199]
  ds_read_b64_tr_b16 v[48:49], v12 offset:33280
  v_accvgpr_read_b32 v18, a74
  v_mfma_f32_16x16x32_bf16 v[212:215], v[92:95], v[244:247], v[212:215]
  ds_read_b64_tr_b16 v[50:51], v12 offset:34304
  v_accvgpr_read_b32 v19, a75
  v_accvgpr_read_b32 v20, a76
  v_mfma_f32_16x16x32_bf16 v[104:107], v[64:67], v[248:251], v[104:107]
  ds_read_b64_tr_b16 v[52:53], v13 offset:33280
  v_accvgpr_read_b32 v21, a77
  v_accvgpr_read_b32 v22, a78
  v_mfma_f32_16x16x32_bf16 v[120:123], v[68:71], v[248:251], v[120:123]
  ds_read_b64_tr_b16 v[54:55], v13 offset:34304
  v_accvgpr_read_b32 v23, a79
  v_mfma_f32_16x16x32_bf16 v[136:139], v[72:75], v[248:251], v[136:139]
  buffer_load_dwordx4 v6, s[32:35], s26 offen offset:3072 sc1 lds
  v_mul_f32 v16, s76, v16
  v_mul_f32 v17, s76, v17
  v_mfma_f32_16x16x32_bf16 v[152:155], v[76:79], v[248:251], v[152:155]
  s_add_u32 s26, s26, 1024
  ds_read_b64_tr_b16 v[56:57], v12 offset:33536
  v_mul_f32 v18, s76, v18
  v_mfma_f32_16x16x32_bf16 v[168:171], v[80:83], v[248:251], v[168:171]
  ds_read_b64_tr_b16 v[58:59], v12 offset:34560
  v_mul_f32 v19, s76, v19
  v_mul_f32 v20, s76, v20
  v_mfma_f32_16x16x32_bf16 v[184:187], v[84:87], v[248:251], v[184:187]
  ds_read_b64_tr_b16 v[60:61], v13 offset:33536
  v_mul_f32 v21, s76, v21
  v_mfma_f32_16x16x32_bf16 v[200:203], v[88:91], v[248:251], v[200:203]
  ds_read_b64_tr_b16 v[62:63], v13 offset:34560
  v_mul_f32 v22, s76, v22
  v_mul_f32 v23, s76, v23
  v_mfma_f32_16x16x32_bf16 v[216:219], v[92:95], v[248:251], v[216:219]
  v_cvt_pk_bf16_f32 v28, v16, v17
  v_cvt_pk_bf16_f32 v29, v18, v19
  v_mfma_f32_16x16x32_bf16 v[108:111], v[64:67], v[252:255], v[108:111]
  ds_read_b128 v[232:235], v14 offset:2048
  v_cvt_pk_bf16_f32 v30, v20, v21
  v_cvt_pk_bf16_f32 v31, v22, v23
  v_mfma_f32_16x16x32_bf16 v[124:127], v[68:71], v[252:255], v[124:127]
  ds_read_b128 v[236:239], v14 offset:3072
  buffer_store_dwordx4 v[28:31], v2, s[40:43], s64 offen offset:1024 sc1
  v_mfma_f32_16x16x32_bf16 v[140:143], v[72:75], v[252:255], v[140:143]
  v_and_b32 v11, 15, v1
  v_lshrrev_b32 v10, 4, v1
  v_lshlrev_b32 v10, 2, v10
  v_mfma_f32_16x16x32_bf16 v[156:159], v[76:79], v[252:255], v[156:159]
  v_sub_u32 v11, v11, v10
  v_cmp_le_i32 s[68:69], 0, v11
  v_mfma_f32_16x16x32_bf16 v[172:175], v[80:83], v[252:255], v[172:175]
  v_cmp_le_i32 s[70:71], 1, v11
  v_cmp_le_i32 s[72:73], 2, v11
  v_cmp_le_i32 s[74:75], 3, v11
  v_mfma_f32_16x16x32_bf16 v[188:191], v[84:87], v[252:255], v[188:191]
  v_and_b32 v8, 7, v1
  v_lshlrev_b32 v8, 2, v8
  v_mfma_f32_16x16x32_bf16 v[204:207], v[88:91], v[252:255], v[204:207]
  v_add_u32 v8, s30, v8
  v_mfma_f32_16x16x32_bf16 v[220:223], v[92:95], v[252:255], v[220:223]
  s_waitcnt vmcnt(17) lgkmcnt(0)
  v_mfma_f32_16x16x32_bf16 v[96:99], v[32:35], v[224:227], v[96:99]
  v_accvgpr_read_b32 v16, a80
  v_accvgpr_read_b32 v17, a81
  v_accvgpr_read_b32 v18, a82
  v_mfma_f32_16x16x32_bf16 v[112:115], v[36:39], v[224:227], v[112:115]
  ds_read_b64_tr_b16 v[64:65], v12 offset:40960
  v_accvgpr_read_b32 v19, a83
  v_accvgpr_read_b32 v20, a84
  v_mfma_f32_16x16x32_bf16 v[128:131], v[40:43], v[224:227], v[128:131]
  s_add_u32 m0, s24, 65536
  ds_read_b64_tr_b16 v[66:67], v12 offset:41984
  v_accvgpr_read_b32 v21, a85
  v_accvgpr_read_b32 v22, a86
  v_mfma_f32_16x16x32_bf16 v[144:147], v[44:47], v[224:227], v[144:147]
  buffer_load_dwordx4 v3, s[32:35], s26 offen offset:0 sc1 lds
  v_accvgpr_read_b32 v23, a87
  v_mul_f32 v16, s76, v16
  v_mfma_f32_16x16x32_bf16 v[160:163], v[48:51], v[224:227], v[160:163]
  ds_read_b64_tr_b16 v[68:69], v13 offset:40960
  v_mul_f32 v17, s76, v17
  v_mul_f32 v18, s76, v18
  v_mfma_f32_16x16x32_bf16 v[176:179], v[52:55], v[224:227], v[176:179]
  ds_read_b64_tr_b16 v[70:71], v13 offset:41984
  v_mul_f32 v19, s76, v19
  v_mul_f32 v20, s76, v20
  v_mfma_f32_16x16x32_bf16 v[192:195], v[56:59], v[224:227], v[192:195]
  ds_read_b64_tr_b16 v[72:73], v12 offset:41216
  v_mul_f32 v21, s76, v21
  v_mul_f32 v22, s76, v22
  v_mfma_f32_16x16x32_bf16 v[208:211], v[60:63], v[224:227], v[208:211]
  ds_read_b64_tr_b16 v[74:75], v12 offset:42240
  v_mul_f32 v23, s76, v23
  v_mfma_f32_16x16x32_bf16 v[100:103], v[32:35], v[228:231], v[100:103]
  buffer_load_dwordx4 v4, s[32:35], s26 offen offset:1024 sc1 lds
  v_cvt_pk_bf16_f32 v24, v16, v17
  v_cvt_pk_bf16_f32 v25, v18, v19
  v_mfma_f32_16x16x32_bf16 v[116:119], v[36:39], v[228:231], v[116:119]
  ds_read_b64_tr_b16 v[76:77], v13 offset:41216
  v_cvt_pk_bf16_f32 v26, v20, v21
  v_cvt_pk_bf16_f32 v27, v22, v23
  v_mfma_f32_16x16x32_bf16 v[132:135], v[40:43], v[228:231], v[132:135]
  ds_read_b64_tr_b16 v[78:79], v13 offset:42240
  buffer_store_dwordx4 v[24:27], v2, s[40:43], s64 offen offset:2048 sc1
  v_accvgpr_read_b32 v16, a88
  v_mfma_f32_16x16x32_bf16 v[148:151], v[44:47], v[228:231], v[148:151]
  ds_read_b128 v[240:243], v14 offset:32768
  v_accvgpr_read_b32 v17, a89
  v_accvgpr_read_b32 v18, a90
  v_mfma_f32_16x16x32_bf16 v[164:167], v[48:51], v[228:231], v[164:167]
  ds_read_b128 v[244:247], v14 offset:33792
  v_accvgpr_read_b32 v19, a91
  v_accvgpr_read_b32 v20, a92
  v_mfma_f32_16x16x32_bf16 v[180:183], v[52:55], v[228:231], v[180:183]
  buffer_load_dwordx4 v5, s[32:35], s26 offen offset:2048 sc1 lds
  v_accvgpr_read_b32 v21, a93
  v_accvgpr_read_b32 v22, a94
  v_mfma_f32_16x16x32_bf16 v[196:199], v[56:59], v[228:231], v[196:199]
  ds_read_b64_tr_b16 v[80:81], v12 offset:41472
  v_accvgpr_read_b32 v23, a95
  v_mfma_f32_16x16x32_bf16 v[212:215], v[60:63], v[228:231], v[212:215]
  ds_read_b64_tr_b16 v[82:83], v12 offset:42496
  v_mul_f32 v16, s76, v16
  v_mul_f32 v17, s76, v17
  v_mfma_f32_16x16x32_bf16 v[104:107], v[32:35], v[232:235], v[104:107]
  ds_read_b64_tr_b16 v[84:85], v13 offset:41472
  v_mul_f32 v18, s76, v18
  v_mul_f32 v19, s76, v19
  v_mfma_f32_16x16x32_bf16 v[120:123], v[36:39], v[232:235], v[120:123]
  ds_read_b64_tr_b16 v[86:87], v13 offset:42496
  v_mul_f32 v20, s76, v20
  v_mul_f32 v21, s76, v21
  v_mfma_f32_16x16x32_bf16 v[136:139], v[40:43], v[232:235], v[136:139]
  buffer_load_dwordx4 v6, s[32:35], s26 offen offset:3072 sc1 lds
  v_mul_f32 v22, s76, v22
  v_mul_f32 v23, s76, v23
  v_mfma_f32_16x16x32_bf16 v[152:155], v[44:47], v[232:235], v[152:155]
  s_add_u32 s26, s26, 1024
  ds_read_b64_tr_b16 v[88:89], v12 offset:41728
  v_cvt_pk_bf16_f32 v28, v16, v17
  v_cvt_pk_bf16_f32 v29, v18, v19
  v_mfma_f32_16x16x32_bf16 v[168:171], v[48:51], v[232:235], v[168:171]
  ds_read_b64_tr_b16 v[90:91], v12 offset:42752
  v_cvt_pk_bf16_f32 v30, v20, v21
  v_cvt_pk_bf16_f32 v31, v22, v23
  v_mfma_f32_16x16x32_bf16 v[184:187], v[52:55], v[232:235], v[184:187]
  ds_read_b64_tr_b16 v[92:93], v13 offset:41728
  buffer_store_dwordx4 v[28:31], v2, s[40:43], s64 offen offset:3072 sc1
  v_add_u32 v9, 0, v1
  v_mfma_f32_16x16x32_bf16 v[200:203], v[56:59], v[232:235], v[200:203]
  ds_read_b64_tr_b16 v[94:95], v13 offset:42752
  v_mul_u32_u24 v10, 6554, v9
  v_mfma_f32_16x16x32_bf16 v[216:219], v[60:63], v[232:235], v[216:219]
  v_lshrrev_b32 v10, 16, v10
  v_mul_u32_u24 v10, 1120, v10
  v_lshl_add_u32 v10, v9, 4, v10
  v_mfma_f32_16x16x32_bf16 v[108:111], v[32:35], v[236:239], v[108:111]
  ds_read_b128 v[248:251], v14 offset:34816
  v_accvgpr_write_b32 a248, v10
  v_add_u32 v9, 64, v1
  v_mfma_f32_16x16x32_bf16 v[124:127], v[36:39], v[236:239], v[124:127]
  ds_read_b128 v[252:255], v14 offset:35840
  v_mul_u32_u24 v10, 6554, v9
  v_lshrrev_b32 v10, 16, v10
  v_mfma_f32_16x16x32_bf16 v[140:143], v[40:43], v[236:239], v[140:143]
  v_mul_u32_u24 v10, 1120, v10
  v_lshl_add_u32 v10, v9, 4, v10
  v_accvgpr_write_b32 a249, v10
  v_mfma_f32_16x16x32_bf16 v[156:159], v[44:47], v[236:239], v[156:159]
  v_xor_b32 v14, 0x10000, v14
  v_add_u32 v9, 128, v1
  v_mul_u32_u24 v10, 6554, v9
  v_mfma_f32_16x16x32_bf16 v[172:175], v[48:51], v[236:239], v[172:175]
  v_lshrrev_b32 v10, 16, v10
  v_mul_u32_u24 v10, 1120, v10
  v_lshl_add_u32 v10, v9, 4, v10
  v_mfma_f32_16x16x32_bf16 v[188:191], v[52:55], v[236:239], v[188:191]
  v_xor_b32 v12, 0x10000, v12
  v_accvgpr_write_b32 a250, v10
  v_mfma_f32_16x16x32_bf16 v[204:207], v[56:59], v[236:239], v[204:207]
  v_xor_b32 v13, 0x10000, v13
  v_mfma_f32_16x16x32_bf16 v[220:223], v[60:63], v[236:239], v[220:223]
  s_waitcnt vmcnt(15) lgkmcnt(0)
  v_mfma_f32_16x16x32_bf16 v[96:99], v[64:67], v[240:243], v[96:99]
  s_barrier
  v_accvgpr_read_b32 v16, a96
  v_accvgpr_read_b32 v17, a97
  v_accvgpr_read_b32 v18, a98
  v_accvgpr_read_b32 v19, a99
  v_mfma_f32_16x16x32_bf16 v[112:115], v[68:71], v[240:243], v[112:115]
  s_add_u32 s64, s64, 4096
  ds_read_b64_tr_b16 v[32:33], v12 offset:0
  v_accvgpr_read_b32 v20, a100
  v_accvgpr_read_b32 v21, a101
  v_mfma_f32_16x16x32_bf16 v[128:131], v[72:75], v[240:243], v[128:131]
  s_add_u32 m0, s24, 98304
  ds_read_b64_tr_b16 v[34:35], v12 offset:1024
  v_accvgpr_read_b32 v22, a102
  v_accvgpr_read_b32 v23, a103
  v_mfma_f32_16x16x32_bf16 v[144:147], v[76:79], v[240:243], v[144:147]
  buffer_load_dwordx4 v3, s[32:35], s26 offen offset:0 sc1 lds
  v_mul_f32 v16, s76, v16
  v_mul_f32 v17, s76, v17
  v_mul_f32 v18, s76, v18
  v_mfma_f32_16x16x32_bf16 v[160:163], v[80:83], v[240:243], v[160:163]
  ds_read_b64_tr_b16 v[36:37], v13 offset:0
  v_mul_f32 v19, s76, v19
  v_mul_f32 v20, s76, v20
  v_mfma_f32_16x16x32_bf16 v[176:179], v[84:87], v[240:243], v[176:179]
  ds_read_b64_tr_b16 v[38:39], v13 offset:1024
  v_mul_f32 v21, s76, v21
  v_mul_f32 v22, s76, v22
  v_mfma_f32_16x16x32_bf16 v[192:195], v[88:91], v[240:243], v[192:195]
  ds_read_b64_tr_b16 v[40:41], v12 offset:256
  v_mul_f32 v23, s76, v23
  v_cvt_pk_bf16_f32 v24, v16, v17
  v_cvt_pk_bf16_f32 v25, v18, v19
  v_mfma_f32_16x16x32_bf16 v[208:211], v[92:95], v[240:243], v[208:211]
  ds_read_b64_tr_b16 v[42:43], v12 offset:1280
  v_cvt_pk_bf16_f32 v26, v20, v21
  v_cvt_pk_bf16_f32 v27, v22, v23
  v_mfma_f32_16x16x32_bf16 v[100:103], v[64:67], v[244:247], v[100:103]
  buffer_load_dwordx4 v4, s[32:35], s26 offen offset:1024 sc1 lds
  buffer_store_dwordx4 v[24:27], v2, s[40:43], s64 offen offset:0 sc1
  v_accvgpr_read_b32 v16, a104
  v_mfma_f32_16x16x32_bf16 v[116:119], v[68:71], v[244:247], v[116:119]
  ds_read_b64_tr_b16 v[44:45], v13 offset:256
  v_accvgpr_read_b32 v17, a105
  v_accvgpr_read_b32 v18, a106
  v_mfma_f32_16x16x32_bf16 v[132:135], v[72:75], v[244:247], v[132:135]
  ds_read_b64_tr_b16 v[46:47], v13 offset:1280
  v_accvgpr_read_b32 v19, a107
  v_accvgpr_read_b32 v20, a108
  v_accvgpr_read_b32 v21, a109
  v_mfma_f32_16x16x32_bf16 v[148:151], v[76:79], v[244:247], v[148:151]
  ds_read_b128 v[224:227], v14 offset:0
  v_accvgpr_read_b32 v22, a110
  v_accvgpr_read_b32 v23, a111
  v_mfma_f32_16x16x32_bf16 v[164:167], v[80:83], v[244:247], v[164:167]
  ds_read_b128 v[228:231], v14 offset:1024
  v_mul_f32 v16, s76, v16
  v_mul_f32 v17, s76, v17
  v_mfma_f32_16x16x32_bf16 v[180:183], v[84:87], v[244:247], v[180:183]
  buffer_load_dwordx4 v5, s[32:35], s26 offen offset:2048 sc1 lds
  v_mul_f32 v18, s76, v18
  v_mul_f32 v19, s76, v19
  v_mul_f32 v20, s76, v20
  v_mfma_f32_16x16x32_bf16 v[196:199], v[88:91], v[244:247], v[196:199]
  ds_read_b64_tr_b16 v[48:49], v12 offset:512
  v_mul_f32 v21, s76, v21
  v_mul_f32 v22, s76, v22
  v_mfma_f32_16x16x32_bf16 v[212:215], v[92:95], v[244:247], v[212:215]
  ds_read_b64_tr_b16 v[50:51], v12 offset:1536
  v_mul_f32 v23, s76, v23
  v_cvt_pk_bf16_f32 v28, v16, v17
  v_mfma_f32_16x16x32_bf16 v[104:107], v[64:67], v[248:251], v[104:107]
  ds_read_b64_tr_b16 v[52:53], v13 offset:512
  v_cvt_pk_bf16_f32 v29, v18, v19
  v_cvt_pk_bf16_f32 v30, v20, v21
  v_cvt_pk_bf16_f32 v31, v22, v23
  v_mfma_f32_16x16x32_bf16 v[120:123], v[68:71], v[248:251], v[120:123]
  ds_read_b64_tr_b16 v[54:55], v13 offset:1536
  buffer_store_dwordx4 v[28:31], v2, s[40:43], s64 offen offset:1024 sc1
  v_accvgpr_read_b32 v16, a112
  v_mfma_f32_16x16x32_bf16 v[136:139], v[72:75], v[248:251], v[136:139]
  buffer_load_dwordx4 v6, s[32:35], s26 offen offset:3072 sc1 lds
  v_accvgpr_read_b32 v17, a113
  v_accvgpr_read_b32 v18, a114
  v_mfma_f32_16x16x32_bf16 v[152:155], v[76:79], v[248:251], v[152:155]
  s_add_u32 s26, s26, 1024
  ds_read_b64_tr_b16 v[56:57], v12 offset:768
  v_accvgpr_read_b32 v19, a115
  v_accvgpr_read_b32 v20, a116
  v_mfma_f32_16x16x32_bf16 v[168:171], v[80:83], v[248:251], v[168:171]
  ds_read_b64_tr_b16 v[58:59], v12 offset:1792
  v_accvgpr_read_b32 v21, a117
  v_accvgpr_read_b32 v22, a118
  v_accvgpr_read_b32 v23, a119
  v_mfma_f32_16x16x32_bf16 v[184:187], v[84:87], v[248:251], v[184:187]
  ds_read_b64_tr_b16 v[60:61], v13 offset:768
  v_mul_f32 v16, s76, v16
  v_mul_f32 v17, s76, v17
  v_mfma_f32_16x16x32_bf16 v[200:203], v[88:91], v[248:251], v[200:203]
  ds_read_b64_tr_b16 v[62:63], v13 offset:1792
  v_mul_f32 v18, s76, v18
  v_mul_f32 v19, s76, v19
  v_mfma_f32_16x16x32_bf16 v[216:219], v[92:95], v[248:251], v[216:219]
  v_mul_f32 v20, s76, v20
  v_mul_f32 v21, s76, v21
  v_mul_f32 v22, s76, v22
  v_mul_f32 v23, s76, v23
  v_mfma_f32_16x16x32_bf16 v[108:111], v[64:67], v[252:255], v[108:111]
  ds_read_b128 v[232:235], v14 offset:2048
  v_cvt_pk_bf16_f32 v24, v16, v17
  v_cvt_pk_bf16_f32 v25, v18, v19
  v_mfma_f32_16x16x32_bf16 v[124:127], v[68:71], v[252:255], v[124:127]
  ds_read_b128 v[236:239], v14 offset:3072
  v_cvt_pk_bf16_f32 v26, v20, v21
  v_cvt_pk_bf16_f32 v27, v22, v23
  v_mfma_f32_16x16x32_bf16 v[140:143], v[72:75], v[252:255], v[140:143]
  buffer_store_dwordx4 v[24:27], v2, s[40:43], s64 offen offset:2048 sc1
  v_add_u32 v9, 192, v1
  v_mul_u32_u24 v10, 6554, v9
  v_lshrrev_b32 v10, 16, v10
  v_mfma_f32_16x16x32_bf16 v[156:159], v[76:79], v[252:255], v[156:159]
  v_mul_u32_u24 v10, 1120, v10
  v_lshl_add_u32 v10, v9, 4, v10
  v_accvgpr_write_b32 a251, v10
  v_mfma_f32_16x16x32_bf16 v[172:175], v[80:83], v[252:255], v[172:175]
  v_add_u32 v9, 256, v1
  v_mul_u32_u24 v10, 6554, v9
  v_lshrrev_b32 v10, 16, v10
  v_mfma_f32_16x16x32_bf16 v[188:191], v[84:87], v[252:255], v[188:191]
  v_mul_u32_u24 v10, 1120, v10
  v_lshl_add_u32 v10, v9, 4, v10
  v_accvgpr_write_b32 a252, v10
  v_mfma_f32_16x16x32_bf16 v[204:207], v[88:91], v[252:255], v[204:207]
  v_mfma_f32_16x16x32_bf16 v[220:223], v[92:95], v[252:255], v[220:223]
  s_waitcnt vmcnt(14) lgkmcnt(0)
  v_mfma_f32_16x16x32_bf16 v[96:99], v[32:35], v[224:227], v[96:99]
  v_accvgpr_read_b32 v16, a120
  v_accvgpr_read_b32 v17, a121
  v_accvgpr_read_b32 v18, a122
  v_mfma_f32_16x16x32_bf16 v[112:115], v[36:39], v[224:227], v[112:115]
  s_mul_i32 s34, s20, 5120
  ds_read_b64_tr_b16 v[64:65], v12 offset:8192
  v_accvgpr_read_b32 v19, a123
  v_accvgpr_read_b32 v20, a124
  v_mfma_f32_16x16x32_bf16 v[128:131], v[40:43], v[224:227], v[128:131]
  s_add_u32 s34, s34, 131072
  ds_read_b64_tr_b16 v[66:67], v12 offset:9216
  v_accvgpr_read_b32 v21, a125
  v_accvgpr_read_b32 v22, a126
  v_mfma_f32_16x16x32_bf16 v[144:147], v[44:47], v[224:227], v[144:147]
  s_and_b32 s32, s21, 3
  buffer_load_dword v15, v8, s[40:43], 0 offen sc1
  v_accvgpr_read_b32 v23, a127
  v_mul_f32 v16, s76, v16
  v_mfma_f32_16x16x32_bf16 v[160:163], v[48:51], v[224:227], v[160:163]
  s_min_u32 s32, s32, 2
  ds_read_b64_tr_b16 v[68:69], v13 offset:8192
  v_mul_f32 v17, s76, v17
  v_mul_f32 v18, s76, v18
  v_mfma_f32_16x16x32_bf16 v[176:179], v[52:55], v[224:227], v[176:179]
  s_add_u32 s32, s32, 5
  ds_read_b64_tr_b16 v[70:71], v13 offset:9216
  v_mul_f32 v19, s76, v19
  v_mul_f32 v20, s76, v20
  v_mfma_f32_16x16x32_bf16 v[192:195], v[56:59], v[224:227], v[192:195]
  s_lshl_b32 s32, s32, 14
  ds_read_b64_tr_b16 v[72:73], v12 offset:8448
  v_mul_f32 v21, s76, v21
  v_mul_f32 v22, s76, v22
  v_mfma_f32_16x16x32_bf16 v[208:211], v[60:63], v[224:227], v[208:211]
  s_mov_b32 s9, -1
  ds_read_b64_tr_b16 v[74:75], v12 offset:9472
  v_mul_f32 v23, s76, v23
  v_mfma_f32_16x16x32_bf16 v[100:103], v[32:35], v[228:231], v[100:103]
  s_sub_u32 s23, s2, 64
  v_cvt_pk_bf16_f32 v28, v16, v17
  v_cvt_pk_bf16_f32 v29, v18, v19
  v_cvt_pk_bf16_f32 v30, v20, v21
  v_mfma_f32_16x16x32_bf16 v[116:119], v[36:39], v[228:231], v[116:119]
  s_cmp_lt_u32 s23, 96
  s_cselect_b32 s9, 0, s9
  ds_read_b64_tr_b16 v[76:77], v13 offset:8448
  v_cvt_pk_bf16_f32 v31, v22, v23
  v_mfma_f32_16x16x32_bf16 v[132:135], v[40:43], v[228:231], v[132:135]
  s_cmp_ge_u32 s2, 224
  s_cselect_b32 s9, 0, s9
  ds_read_b64_tr_b16 v[78:79], v13 offset:9472
  buffer_store_dwordx4 v[28:31], v2, s[40:43], s64 offen offset:3072 sc1
  v_accvgpr_read_b32 v16, a128
  v_mfma_f32_16x16x32_bf16 v[148:151], v[44:47], v[228:231], v[148:151]
  s_and_b32 s32, s32, s9
  ds_read_b128 v[240:243], v14 offset:32768
  v_accvgpr_read_b32 v17, a129
  v_accvgpr_read_b32 v18, a130
  v_mfma_f32_16x16x32_bf16 v[164:167], v[48:51], v[228:231], v[164:167]
  s_sub_u32 s23, s2, 170
  ds_read_b128 v[244:247], v14 offset:33792
  v_accvgpr_read_b32 v19, a131
  v_accvgpr_read_b32 v20, a132
  v_mfma_f32_16x16x32_bf16 v[180:183], v[52:55], v[228:231], v[180:183]
  s_cmp_lt_u32 s23, 54
  s_cselect_b32 s32, 98304, s32
  v_accvgpr_read_b32 v21, a133
  v_accvgpr_read_b32 v22, a134
  v_accvgpr_read_b32 v23, a135
  v_mfma_f32_16x16x32_bf16 v[196:199], v[56:59], v[228:231], v[196:199]
  s_mov_b32 s67, s2
  s_add_u32 s64, s64, 126976
  ds_read_b64_tr_b16 v[80:81], v12 offset:8704
  v_mul_f32 v16, s76, v16
  v_mfma_f32_16x16x32_bf16 v[212:215], v[60:63], v[228:231], v[212:215]
  s_mov_b32 s8, 0
  ds_read_b64_tr_b16 v[82:83], v12 offset:9728
  v_mul_f32 v17, s76, v17
  v_mul_f32 v18, s76, v18
  v_mfma_f32_16x16x32_bf16 v[104:107], v[32:35], v[232:235], v[104:107]
  s_mov_b32 s66, 0
  ds_read_b64_tr_b16 v[84:85], v13 offset:8704
  v_mul_f32 v19, s76, v19
  v_mul_f32 v20, s76, v20
  v_mfma_f32_16x16x32_bf16 v[120:123], v[36:39], v[232:235], v[120:123]
  s_mov_b32 s11, 0
  ds_read_b64_tr_b16 v[86:87], v13 offset:9728
  v_mul_f32 v21, s76, v21
  v_mul_f32 v22, s76, v22
  v_mfma_f32_16x16x32_bf16 v[136:139], v[40:43], v[232:235], v[136:139]
  s_mov_b32 s12, 0
  v_mul_f32 v23, s76, v23
  v_cvt_pk_bf16_f32 v24, v16, v17
  v_cvt_pk_bf16_f32 v25, v18, v19
  v_mfma_f32_16x16x32_bf16 v[152:155], v[44:47], v[232:235], v[152:155]
  s_lshl_b32 s15, s22, 1
  ds_read_b64_tr_b16 v[88:89], v12 offset:8960
  v_cvt_pk_bf16_f32 v26, v20, v21
  v_cvt_pk_bf16_f32 v27, v22, v23
  v_mfma_f32_16x16x32_bf16 v[168:171], v[48:51], v[232:235], v[168:171]
  s_add_u32 s23, s15, 6
  ds_read_b64_tr_b16 v[90:91], v12 offset:9984
  buffer_store_dwordx4 v[24:27], v2, s[40:43], s64 offen offset:0 sc1
  v_accvgpr_read_b32 v16, a136
  v_mfma_f32_16x16x32_bf16 v[184:187], v[52:55], v[232:235], v[184:187]
  s_sub_u32 s15, 24, s15
  ds_read_b64_tr_b16 v[92:93], v13 offset:8960
  v_accvgpr_read_b32 v17, a137
  v_accvgpr_read_b32 v18, a138
  v_mfma_f32_16x16x32_bf16 v[200:203], v[56:59], v[232:235], v[200:203]
  s_max_u32 s15, s15, s23
  ds_read_b64_tr_b16 v[94:95], v13 offset:9984
  v_accvgpr_read_b32 v19, a139
  v_mfma_f32_16x16x32_bf16 v[216:219], v[60:63], v[232:235], v[216:219]
  s_lshl_b32 s15, s15, 14
  v_accvgpr_read_b32 v20, a140
  v_accvgpr_read_b32 v21, a141
  v_accvgpr_read_b32 v22, a142
  v_mfma_f32_16x16x32_bf16 v[108:111], v[32:35], v[236:239], v[108:111]
  ds_read_b128 v[248:251], v14 offset:34816
  v_accvgpr_read_b32 v23, a143
  v_mul_f32 v16, s76, v16
  v_mfma_f32_16x16x32_bf16 v[124:127], v[36:39], v[236:239], v[124:127]
  ds_read_b128 v[252:255], v14 offset:35840
  v_mul_f32 v17, s76, v17
  v_mul_f32 v18, s76, v18
  v_mfma_f32_16x16x32_bf16 v[140:143], v[40:43], v[236:239], v[140:143]
  v_mul_f32 v19, s76, v19
  v_mul_f32 v20, s76, v20
  v_mul_f32 v21, s76, v21
  v_mfma_f32_16x16x32_bf16 v[156:159], v[44:47], v[236:239], v[156:159]
  v_xor_b32 v14, 0x10000, v14
  v_mul_f32 v22, s76, v22
  v_mul_f32 v23, s76, v23
  v_mfma_f32_16x16x32_bf16 v[172:175], v[48:51], v[236:239], v[172:175]
  v_cvt_pk_bf16_f32 v28, v16, v17
  v_cvt_pk_bf16_f32 v29, v18, v19
  v_cvt_pk_bf16_f32 v30, v20, v21
  v_mfma_f32_16x16x32_bf16 v[188:191], v[52:55], v[236:239], v[188:191]
  v_cvt_pk_bf16_f32 v31, v22, v23
  v_mfma_f32_16x16x32_bf16 v[204:207], v[56:59], v[236:239], v[204:207]
  buffer_store_dwordx4 v[28:31], v2, s[40:43], s64 offen offset:1024 sc1
  v_mfma_f32_16x16x32_bf16 v[220:223], v[60:63], v[236:239], v[220:223]
  s_waitcnt vmcnt(12) lgkmcnt(0)
  v_mfma_f32_16x16x32_bf16 v[96:99], v[64:67], v[240:243], v[96:99]
  s_barrier
  v_accvgpr_read_b32 v16, a144
  v_accvgpr_read_b32 v17, a145
  v_accvgpr_read_b32 v18, a146
  v_accvgpr_read_b32 v19, a147
  v_mfma_f32_16x16x32_bf16 v[112:115], v[68:71], v[240:243], v[112:115]
  s_and_b32 s23, s20, 1
  ds_read_b64_tr_b16 v[32:33], v12 offset:32768
  v_accvgpr_read_b32 v20, a148
  v_accvgpr_read_b32 v21, a149
  v_mfma_f32_16x16x32_bf16 v[128:131], v[72:75], v[240:243], v[128:131]
  s_lshl_b32 s23, s23, 12
  ds_read_b64_tr_b16 v[34:35], v12 offset:33792
  v_accvgpr_read_b32 v22, a150
  v_accvgpr_read_b32 v23, a151
  v_mfma_f32_16x16x32_bf16 v[144:147], v[76:79], v[240:243], v[144:147]
  s_cmp_lt_u32 s20, 2
  s_cselect_b32 s24, 106496, 0
  v_mul_f32 v16, s76, v16
  v_mul_f32 v17, s76, v17
  v_mul_f32 v18, s76, v18
  v_mfma_f32_16x16x32_bf16 v[160:163], v[80:83], v[240:243], v[160:163]
  s_add_u32 s24, s24, s23
  ds_read_b64_tr_b16 v[36:37], v13 offset:32768
  v_mul_f32 v19, s76, v19
  v_mul_f32 v20, s76, v20
  v_mfma_f32_16x16x32_bf16 v[176:179], v[84:87], v[240:243], v[176:179]
  s_lshl_b32 s26, s20, 12
  ds_read_b64_tr_b16 v[38:39], v13 offset:33792
  v_mul_f32 v21, s76, v21
  v_mul_f32 v22, s76, v22
  v_mfma_f32_16x16x32_bf16 v[192:195], v[88:91], v[240:243], v[192:195]
  s_mov_b32 s27, s26
  ds_read_b64_tr_b16 v[40:41], v12 offset:33024
  v_mul_f32 v23, s76, v23
  v_cvt_pk_bf16_f32 v24, v16, v17
  v_mfma_f32_16x16x32_bf16 v[208:211], v[92:95], v[240:243], v[208:211]
  s_add_u32 s25, s27, 49152
  ds_read_b64_tr_b16 v[42:43], v12 offset:34048
  v_cvt_pk_bf16_f32 v25, v18, v19
  v_cvt_pk_bf16_f32 v26, v20, v21
  v_cvt_pk_bf16_f32 v27, v22, v23
  v_mfma_f32_16x16x32_bf16 v[100:103], v[64:67], v[244:247], v[100:103]
  s_load_dwordx4 s[4:7], s[0:1], 64
  buffer_store_dwordx4 v[24:27], v2, s[40:43], s64 offen offset:2048 sc1
  v_accvgpr_read_b32 v16, a152
  v_accvgpr_read_b32 v17, a153
  v_mfma_f32_16x16x32_bf16 v[116:119], v[68:71], v[244:247], v[116:119]
  s_load_dwordx2 s[60:61], s[0:1], 80
  ds_read_b64_tr_b16 v[44:45], v13 offset:33024
  v_accvgpr_read_b32 v18, a154
  v_accvgpr_read_b32 v19, a155
  v_mfma_f32_16x16x32_bf16 v[132:135], v[72:75], v[244:247], v[132:135]
  s_add_u32 s23, s20, 1
  ds_read_b64_tr_b16 v[46:47], v13 offset:34048
  v_accvgpr_read_b32 v20, a156
  v_accvgpr_read_b32 v21, a157
  v_mfma_f32_16x16x32_bf16 v[148:151], v[76:79], v[244:247], v[148:151]
  s_lshr_b32 s23, s23, 1
  ds_read_b128 v[224:227], v14 offset:0
  v_accvgpr_read_b32 v22, a158
  v_accvgpr_read_b32 v23, a159
  v_mfma_f32_16x16x32_bf16 v[164:167], v[80:83], v[244:247], v[164:167]
  s_lshl_b32 s28, s22, 1
  ds_read_b128 v[228:231], v14 offset:1024
  v_mul_f32 v16, s76, v16
  v_mul_f32 v17, s76, v17
  v_mfma_f32_16x16x32_bf16 v[180:183], v[84:87], v[244:247], v[180:183]
  s_add_u32 s28, s28, s23
  v_mul_f32 v18, s76, v18
  v_mul_f32 v19, s76, v19
  v_mul_f32 v20, s76, v20
  v_mfma_f32_16x16x32_bf16 v[196:199], v[88:91], v[244:247], v[196:199]
  s_lshl_b32 s23, s22, 2
  ds_read_b64_tr_b16 v[48:49], v12 offset:33280
  v_mul_f32 v21, s76, v21
  v_mul_f32 v22, s76, v22
  v_mfma_f32_16x16x32_bf16 v[212:215], v[92:95], v[244:247], v[212:215]
  s_sub_u32 s29, 28, s23
  ds_read_b64_tr_b16 v[50:51], v12 offset:34304
  v_mul_f32 v23, s76, v23
  v_cvt_pk_bf16_f32 v28, v16, v17
  v_cvt_pk_bf16_f32 v29, v18, v19
  v_mfma_f32_16x16x32_bf16 v[104:107], v[64:67], v[248:251], v[104:107]
  s_and_b32 s23, s20, 1
  ds_read_b64_tr_b16 v[52:53], v13 offset:33280
  v_cvt_pk_bf16_f32 v30, v20, v21
  v_cvt_pk_bf16_f32 v31, v22, v23
  v_mfma_f32_16x16x32_bf16 v[120:123], v[68:71], v[248:251], v[120:123]
  s_add_u32 s29, s29, s23
  ds_read_b64_tr_b16 v[54:55], v13 offset:34304
  buffer_store_dwordx4 v[28:31], v2, s[40:43], s64 offen offset:3072 sc1
  v_accvgpr_read_b32 v16, a160
  v_mfma_f32_16x16x32_bf16 v[136:139], v[72:75], v[248:251], v[136:139]
  s_add_u32 s64, s64, 4096
  v_accvgpr_read_b32 v17, a161
  v_accvgpr_read_b32 v18, a162
  v_accvgpr_read_b32 v19, a163
  v_mfma_f32_16x16x32_bf16 v[152:155], v[76:79], v[248:251], v[152:155]
  ds_read_b64_tr_b16 v[56:57], v12 offset:33536
  v_accvgpr_read_b32 v20, a164
  v_accvgpr_read_b32 v21, a165
  v_mfma_f32_16x16x32_bf16 v[168:171], v[80:83], v[248:251], v[168:171]
  ds_read_b64_tr_b16 v[58:59], v12 offset:34560
  v_accvgpr_read_b32 v22, a166
  v_accvgpr_read_b32 v23, a167
  v_mfma_f32_16x16x32_bf16 v[184:187], v[84:87], v[248:251], v[184:187]
  ds_read_b64_tr_b16 v[60:61], v13 offset:33536
  v_mul_f32 v16, s76, v16
  v_mul_f32 v17, s76, v17
  v_mfma_f32_16x16x32_bf16 v[200:203], v[88:91], v[248:251], v[200:203]
  ds_read_b64_tr_b16 v[62:63], v13 offset:34560
  v_mul_f32 v18, s76, v18
  v_mul_f32 v19, s76, v19
  v_mul_f32 v20, s76, v20
  v_mfma_f32_16x16x32_bf16 v[216:219], v[92:95], v[248:251], v[216:219]
  v_mul_f32 v21, s76, v21
  v_mul_f32 v22, s76, v22
  v_mul_f32 v23, s76, v23
  v_mfma_f32_16x16x32_bf16 v[108:111], v[64:67], v[252:255], v[108:111]
  ds_read_b128 v[232:235], v14 offset:2048
  v_cvt_pk_bf16_f32 v24, v16, v17
  v_cvt_pk_bf16_f32 v25, v18, v19
  v_mfma_f32_16x16x32_bf16 v[124:127], v[68:71], v[252:255], v[124:127]
  ds_read_b128 v[236:239], v14 offset:3072
  v_cvt_pk_bf16_f32 v26, v20, v21
  v_cvt_pk_bf16_f32 v27, v22, v23
  v_mfma_f32_16x16x32_bf16 v[140:143], v[72:75], v[252:255], v[140:143]
  buffer_store_dwordx4 v[24:27], v2, s[40:43], s64 offen offset:0 sc1
  v_lshrrev_b32 v6, 2, v1
  v_mul_u32_u24 v6, 160, v6
  v_mfma_f32_16x16x32_bf16 v[156:159], v[76:79], v[252:255], v[156:159]
  v_and_b32 v9, 3, v1
  v_lshl_add_u32 v6, v9, 3, v6
  v_add_u32 v6, s34, v6
  v_mfma_f32_16x16x32_bf16 v[172:175], v[80:83], v[252:255], v[172:175]
  v_mov_b32 v3, v2
  v_mov_b32 v4, 0xff800000
  v_add_u32 v9, 106496, v2
  v_mfma_f32_16x16x32_bf16 v[188:191], v[84:87], v[252:255], v[188:191]
  v_mfma_f32_16x16x32_bf16 v[204:207], v[88:91], v[252:255], v[204:207]
  v_mfma_f32_16x16x32_bf16 v[220:223], v[92:95], v[252:255], v[220:223]
  s_waitcnt vmcnt(8) lgkmcnt(0)
  v_mfma_f32_16x16x32_bf16 v[96:99], v[32:35], v[224:227], v[96:99]
  v_accvgpr_read_b32 v16, a168
  v_accvgpr_read_b32 v17, a169
  v_accvgpr_read_b32 v18, a170
  v_mfma_f32_16x16x32_bf16 v[112:115], v[36:39], v[224:227], v[112:115]
  s_cmp_ge_u32 s20, 2
  s_cselect_b32 s4, s6, s4
  s_cselect_b32 s5, s7, s5
  ds_read_b64_tr_b16 v[64:65], v12 offset:40960
  v_accvgpr_read_b32 v19, a171
  v_accvgpr_read_b32 v20, a172
  v_mfma_f32_16x16x32_bf16 v[128:131], v[40:43], v[224:227], v[128:131]
  s_mov_b32 s62, 2211840
  ds_read_b64_tr_b16 v[66:67], v12 offset:41984
  v_accvgpr_read_b32 v21, a173
  v_accvgpr_read_b32 v22, a174
  v_mfma_f32_16x16x32_bf16 v[144:147], v[44:47], v[224:227], v[144:147]
  s_mov_b32 s63, 0x20000
  v_accvgpr_read_b32 v23, a175
  v_mul_f32 v16, s76, v16
  v_mul_f32 v17, s76, v17
  v_mfma_f32_16x16x32_bf16 v[160:163], v[48:51], v[224:227], v[160:163]
  s_mov_b64 s[56:57], s[52:53]
  ds_read_b64_tr_b16 v[68:69], v13 offset:40960
  v_mul_f32 v18, s76, v18
  v_mfma_f32_16x16x32_bf16 v[176:179], v[52:55], v[224:227], v[176:179]
  s_mov_b32 s58, s54
  ds_read_b64_tr_b16 v[70:71], v13 offset:41984
  v_mul_f32 v19, s76, v19
  v_mul_f32 v20, s76, v20
  v_mfma_f32_16x16x32_bf16 v[192:195], v[56:59], v[224:227], v[192:195]
  s_mov_b64 s[52:53], s[4:5]
  ds_read_b64_tr_b16 v[72:73], v12 offset:41216
  v_mul_f32 v21, s76, v21
  v_mul_f32 v22, s76, v22
  v_mfma_f32_16x16x32_bf16 v[208:211], v[60:63], v[224:227], v[208:211]
  s_mov_b32 s54, 2211840
  ds_read_b64_tr_b16 v[74:75], v12 offset:42240
  v_mul_f32 v23, s76, v23
  v_cvt_pk_bf16_f32 v28, v16, v17
  v_mfma_f32_16x16x32_bf16 v[100:103], v[32:35], v[228:231], v[100:103]
  s_getpc_b64 s[36:37]
fa_copc:
  v_cvt_pk_bf16_f32 v29, v18, v19
  v_cvt_pk_bf16_f32 v30, v20, v21
  v_cvt_pk_bf16_f32 v31, v22, v23
  v_mfma_f32_16x16x32_bf16 v[116:119], v[36:39], v[228:231], v[116:119]
  s_add_u32 s36, s36, fa_co-fa_copc-4
  s_addc_u32 s37, s37, 0
  ds_read_b64_tr_b16 v[76:77], v13 offset:41216
  buffer_store_dwordx4 v[28:31], v2, s[40:43], s64 offen offset:1024 sc1
  v_mfma_f32_16x16x32_bf16 v[132:135], v[40:43], v[228:231], v[132:135]
  ds_read_b64_tr_b16 v[78:79], v13 offset:42240
  v_accvgpr_read_b32 v16, a176
  v_accvgpr_read_b32 v17, a177
  v_mfma_f32_16x16x32_bf16 v[148:151], v[44:47], v[228:231], v[148:151]
  ds_read_b128 v[240:243], v14 offset:32768
  v_accvgpr_read_b32 v18, a178
  v_accvgpr_read_b32 v19, a179
  v_mfma_f32_16x16x32_bf16 v[164:167], v[48:51], v[228:231], v[164:167]
  ds_read_b128 v[244:247], v14 offset:33792
  v_accvgpr_read_b32 v20, a180
  v_accvgpr_read_b32 v21, a181
  v_mfma_f32_16x16x32_bf16 v[180:183], v[52:55], v[228:231], v[180:183]
  v_accvgpr_read_b32 v22, a182
  v_accvgpr_read_b32 v23, a183
  v_mul_f32 v16, s76, v16
  v_mfma_f32_16x16x32_bf16 v[196:199], v[56:59], v[228:231], v[196:199]
  ds_read_b64_tr_b16 v[80:81], v12 offset:41472
  v_mul_f32 v17, s76, v17
  v_mfma_f32_16x16x32_bf16 v[212:215], v[60:63], v[228:231], v[212:215]
  ds_read_b64_tr_b16 v[82:83], v12 offset:42496
  v_mul_f32 v18, s76, v18
  v_mul_f32 v19, s76, v19
  v_mfma_f32_16x16x32_bf16 v[104:107], v[32:35], v[232:235], v[104:107]
  ds_read_b64_tr_b16 v[84:85], v13 offset:41472
  v_mul_f32 v20, s76, v20
  v_mul_f32 v21, s76, v21
  v_mfma_f32_16x16x32_bf16 v[120:123], v[36:39], v[232:235], v[120:123]
  ds_read_b64_tr_b16 v[86:87], v13 offset:42496
  v_mul_f32 v22, s76, v22
  v_mul_f32 v23, s76, v23
  v_mfma_f32_16x16x32_bf16 v[136:139], v[40:43], v[232:235], v[136:139]
  v_cvt_pk_bf16_f32 v24, v16, v17
  v_cvt_pk_bf16_f32 v25, v18, v19
  v_cvt_pk_bf16_f32 v26, v20, v21
  v_mfma_f32_16x16x32_bf16 v[152:155], v[44:47], v[232:235], v[152:155]
  ds_read_b64_tr_b16 v[88:89], v12 offset:41728
  v_cvt_pk_bf16_f32 v27, v22, v23
  v_mfma_f32_16x16x32_bf16 v[168:171], v[48:51], v[232:235], v[168:171]
  ds_read_b64_tr_b16 v[90:91], v12 offset:42752
  buffer_store_dwordx4 v[24:27], v2, s[40:43], s64 offen offset:2048 sc1
  v_accvgpr_read_b32 v16, a184
  v_mfma_f32_16x16x32_bf16 v[184:187], v[52:55], v[232:235], v[184:187]
  ds_read_b64_tr_b16 v[92:93], v13 offset:41728
  v_accvgpr_read_b32 v17, a185
  v_accvgpr_read_b32 v18, a186
  v_mfma_f32_16x16x32_bf16 v[200:203], v[56:59], v[232:235], v[200:203]
  ds_read_b64_tr_b16 v[94:95], v13 offset:42752
  v_accvgpr_read_b32 v19, a187
  v_accvgpr_read_b32 v20, a188
  v_mfma_f32_16x16x32_bf16 v[216:219], v[60:63], v[232:235], v[216:219]
  v_accvgpr_read_b32 v21, a189
  v_accvgpr_read_b32 v22, a190
  v_accvgpr_read_b32 v23, a191
  v_mfma_f32_16x16x32_bf16 v[108:111], v[32:35], v[236:239], v[108:111]
  ds_read_b128 v[248:251], v14 offset:34816
  v_mul_f32 v16, s76, v16
  v_mfma_f32_16x16x32_bf16 v[124:127], v[36:39], v[236:239], v[124:127]
  ds_read_b128 v[252:255], v14 offset:35840
  v_mul_f32 v17, s76, v17
  v_mul_f32 v18, s76, v18
  v_mfma_f32_16x16x32_bf16 v[140:143], v[40:43], v[236:239], v[140:143]
  v_mul_f32 v19, s76, v19
  v_mul_f32 v20, s76, v20
  v_mul_f32 v21, s76, v21
  v_mfma_f32_16x16x32_bf16 v[156:159], v[44:47], v[236:239], v[156:159]
  v_xor_b32 v14, 0x10000, v14
  v_mul_f32 v22, s76, v22
  v_mul_f32 v23, s76, v23
  v_mfma_f32_16x16x32_bf16 v[172:175], v[48:51], v[236:239], v[172:175]
  v_cvt_pk_bf16_f32 v28, v16, v17
  v_cvt_pk_bf16_f32 v29, v18, v19
  v_cvt_pk_bf16_f32 v30, v20, v21
  v_mfma_f32_16x16x32_bf16 v[188:191], v[52:55], v[236:239], v[188:191]
  v_xor_b32 v12, 0x10000, v12
  v_cvt_pk_bf16_f32 v31, v22, v23
  v_mfma_f32_16x16x32_bf16 v[204:207], v[56:59], v[236:239], v[204:207]
  buffer_store_dwordx4 v[28:31], v2, s[40:43], s64 offen offset:3072 sc1
  v_xor_b32 v13, 0x10000, v13
  v_mfma_f32_16x16x32_bf16 v[220:223], v[60:63], v[236:239], v[220:223]
  s_waitcnt vmcnt(9) lgkmcnt(0)
  v_mfma_f32_16x16x32_bf16 v[96:99], v[64:67], v[240:243], v[96:99]
  s_barrier
  v_cmp_eq_u32 vcc, 0, v15
  v_mfma_f32_16x16x32_bf16 v[112:115], v[68:71], v[240:243], v[112:115]
  s_cbranch_vccnz fa_kv_spin
fa_kv_ok:
  v_mfma_f32_16x16x32_bf16 v[128:131], v[72:75], v[240:243], v[128:131]
  s_mov_b32 m0, s24
  v_mov_b32 v228, 0
  v_mfma_f32_16x16x32_bf16 v[144:147], v[76:79], v[240:243], v[144:147]
  buffer_load_dwordx4 v2, s[44:47], s26 offen offset:0 sc1 lds
  v_mfma_f32_16x16x32_bf16 v[160:163], v[80:83], v[240:243], v[160:163]
  s_add_u32 s24, s24, 32768
  v_mov_b32 v229, 0
  v_mfma_f32_16x16x32_bf16 v[176:179], v[84:87], v[240:243], v[176:179]
  s_and_b32 s24, s24, 0x1ffff
  buffer_load_dwordx4 v2, s[44:47], s26 offen offset:1024 sc1 lds
  v_mfma_f32_16x16x32_bf16 v[192:195], v[88:91], v[240:243], v[192:195]
  v_mov_b32 v230, 0
  v_mfma_f32_16x16x32_bf16 v[208:211], v[92:95], v[240:243], v[208:211]
  buffer_load_dwordx4 v2, s[44:47], s26 offen offset:2048 sc1 lds
  v_mfma_f32_16x16x32_bf16 v[100:103], v[64:67], v[244:247], v[100:103]
  v_mov_b32 v231, 0
  v_mfma_f32_16x16x32_bf16 v[116:119], v[68:71], v[244:247], v[116:119]
  buffer_load_dwordx4 v2, s[44:47], s26 offen offset:3072 sc1 lds
  v_mfma_f32_16x16x32_bf16 v[132:135], v[72:75], v[244:247], v[132:135]
  s_add_u32 s26, s26, 16384
  v_cvt_pk_bf16_f32 v32, v96, v97
  v_cvt_pk_bf16_f32 v33, v98, v99
  v_mfma_f32_16x16x32_bf16 v[148:151], v[76:79], v[244:247], v[148:151]
  v_cvt_pk_bf16_f32 v34, v112, v113
  v_cvt_pk_bf16_f32 v35, v114, v115
  v_mfma_f32_16x16x32_bf16 v[164:167], v[80:83], v[244:247], v[164:167]
  s_mov_b32 m0, s24
  v_cvt_pk_bf16_f32 v40, v128, v129
  v_mfma_f32_16x16x32_bf16 v[180:183], v[84:87], v[244:247], v[180:183]
  buffer_load_dwordx4 v2, s[44:47], s26 offen offset:0 sc1 lds
  v_cvt_pk_bf16_f32 v41, v130, v131
  v_cvt_pk_bf16_f32 v42, v144, v145
  v_mfma_f32_16x16x32_bf16 v[196:199], v[88:91], v[244:247], v[196:199]
  s_add_u32 s24, s24, 32768
  v_cvt_pk_bf16_f32 v43, v146, v147
  v_mfma_f32_16x16x32_bf16 v[212:215], v[92:95], v[244:247], v[212:215]
  s_and_b32 s24, s24, 0x1ffff
  buffer_load_dwordx4 v2, s[44:47], s26 offen offset:1024 sc1 lds
  v_cvt_pk_bf16_f32 v48, v160, v161
  v_cvt_pk_bf16_f32 v49, v162, v163
  v_mfma_f32_16x16x32_bf16 v[104:107], v[64:67], v[248:251], v[104:107]
  v_cvt_pk_bf16_f32 v50, v176, v177
  v_cvt_pk_bf16_f32 v51, v178, v179
  v_mfma_f32_16x16x32_bf16 v[120:123], v[68:71], v[248:251], v[120:123]
  buffer_load_dwordx4 v2, s[44:47], s26 offen offset:2048 sc1 lds
  v_cvt_pk_bf16_f32 v56, v192, v193
  v_mfma_f32_16x16x32_bf16 v[136:139], v[72:75], v[248:251], v[136:139]
  v_cvt_pk_bf16_f32 v57, v194, v195
  v_cvt_pk_bf16_f32 v58, v208, v209
  v_mfma_f32_16x16x32_bf16 v[152:155], v[76:79], v[248:251], v[152:155]
  buffer_load_dwordx4 v2, s[44:47], s26 offen offset:3072 sc1 lds
  v_cvt_pk_bf16_f32 v59, v210, v211
  v_mfma_f32_16x16x32_bf16 v[168:171], v[80:83], v[248:251], v[168:171]
  s_add_u32 s26, s26, 16384
  v_cvt_pk_bf16_f32 v36, v100, v101
  v_cvt_pk_bf16_f32 v37, v102, v103
  v_mfma_f32_16x16x32_bf16 v[184:187], v[84:87], v[248:251], v[184:187]
  v_cvt_pk_bf16_f32 v38, v116, v117
  v_mfma_f32_16x16x32_bf16 v[200:203], v[88:91], v[248:251], v[200:203]
  s_mov_b32 m0, s24
  v_cvt_pk_bf16_f32 v39, v118, v119
  v_cvt_pk_bf16_f32 v44, v132, v133
  v_mfma_f32_16x16x32_bf16 v[216:219], v[92:95], v[248:251], v[216:219]
  buffer_load_dwordx4 v2, s[44:47], s26 offen offset:0 sc1 lds
  v_cvt_pk_bf16_f32 v45, v134, v135
  v_mfma_f32_16x16x32_bf16 v[108:111], v[64:67], v[252:255], v[108:111]
  s_add_u32 s24, s24, 32768
  v_cvt_pk_bf16_f32 v46, v148, v149
  v_cvt_pk_bf16_f32 v47, v150, v151
  v_mfma_f32_16x16x32_bf16 v[124:127], v[68:71], v[252:255], v[124:127]
  s_and_b32 s24, s24, 0x1ffff
  buffer_load_dwordx4 v2, s[44:47], s26 offen offset:1024 sc1 lds
  v_cvt_pk_bf16_f32 v52, v164, v165
  v_mfma_f32_16x16x32_bf16 v[140:143], v[72:75], v[252:255], v[140:143]
  v_cvt_pk_bf16_f32 v53, v166, v167
  v_cvt_pk_bf16_f32 v54, v180, v181
  v_mfma_f32_16x16x32_bf16 v[156:159], v[76:79], v[252:255], v[156:159]
  buffer_load_dwordx4 v2, s[44:47], s26 offen offset:2048 sc1 lds
  v_cvt_pk_bf16_f32 v55, v182, v183
  v_mfma_f32_16x16x32_bf16 v[172:175], v[80:83], v[252:255], v[172:175]
  v_cvt_pk_bf16_f32 v60, v196, v197
  v_cvt_pk_bf16_f32 v61, v198, v199
  v_mfma_f32_16x16x32_bf16 v[188:191], v[84:87], v[252:255], v[188:191]
  buffer_load_dwordx4 v2, s[44:47], s26 offen offset:3072 sc1 lds
  v_cvt_pk_bf16_f32 v62, v212, v213
  v_mfma_f32_16x16x32_bf16 v[204:207], v[88:91], v[252:255], v[204:207]
  s_add_u32 s26, s26, 16384
  v_cvt_pk_bf16_f32 v63, v214, v215
  v_mfma_f32_16x16x32_bf16 v[220:223], v[92:95], v[252:255], v[220:223]
  s_mov_b32 m0, s25
  s_nop 0
  v_mfma_f32_32x32x16_bf16 a[0:15], v[228:231], v[228:231], 0
  buffer_load_dwordx4 v2, s[48:51], s27 offen offset:0 sc1 lds
  v_cvt_pk_bf16_f32 v64, v104, v105
  v_cvt_pk_bf16_f32 v65, v106, v107
  v_cvt_pk_bf16_f32 v66, v120, v121
  v_cvt_pk_bf16_f32 v67, v122, v123
  v_mfma_f32_32x32x16_bf16 a[16:31], v[228:231], v[228:231], 0
  buffer_load_dwordx4 v2, s[48:51], s27 offen offset:1024 sc1 lds
  v_cvt_pk_bf16_f32 v72, v136, v137
  v_cvt_pk_bf16_f32 v73, v138, v139
  v_cvt_pk_bf16_f32 v74, v152, v153
  v_cvt_pk_bf16_f32 v75, v154, v155
  v_mfma_f32_32x32x16_bf16 a[32:47], v[228:231], v[228:231], 0
  buffer_load_dwordx4 v2, s[48:51], s27 offen offset:2048 sc1 lds
  v_cvt_pk_bf16_f32 v80, v168, v169
  v_cvt_pk_bf16_f32 v81, v170, v171
  v_cvt_pk_bf16_f32 v82, v184, v185
  v_cvt_pk_bf16_f32 v83, v186, v187
  v_mfma_f32_32x32x16_bf16 a[48:63], v[228:231], v[228:231], 0
  buffer_load_dwordx4 v2, s[48:51], s27 offen offset:3072 sc1 lds
  v_cvt_pk_bf16_f32 v88, v200, v201
  v_cvt_pk_bf16_f32 v89, v202, v203
  v_cvt_pk_bf16_f32 v90, v216, v217
  v_cvt_pk_bf16_f32 v91, v218, v219
  s_add_u32 s27, s27, 16384
  s_add_u32 s25, s25, 32768
  s_and_b32 s25, s25, 0x1ffff
  s_mov_b32 m0, s25
  s_nop 0
  v_mfma_f32_32x32x16_bf16 a[64:79], v[228:231], v[228:231], 0
  buffer_load_dwordx4 v2, s[48:51], s27 offen offset:0 sc1 lds
  v_cvt_pk_bf16_f32 v68, v108, v109
  v_cvt_pk_bf16_f32 v69, v110, v111
  v_cvt_pk_bf16_f32 v70, v124, v125
  v_cvt_pk_bf16_f32 v71, v126, v127
  v_mfma_f32_32x32x16_bf16 a[80:95], v[228:231], v[228:231], 0
  buffer_load_dwordx4 v2, s[48:51], s27 offen offset:1024 sc1 lds
  v_cvt_pk_bf16_f32 v76, v140, v141
  v_cvt_pk_bf16_f32 v77, v142, v143
  v_cvt_pk_bf16_f32 v78, v156, v157
  v_cvt_pk_bf16_f32 v79, v158, v159
  v_mfma_f32_32x32x16_bf16 a[96:111], v[228:231], v[228:231], 0
  buffer_load_dwordx4 v2, s[48:51], s27 offen offset:2048 sc1 lds
  v_cvt_pk_bf16_f32 v84, v172, v173
  v_cvt_pk_bf16_f32 v85, v174, v175
  v_cvt_pk_bf16_f32 v86, v188, v189
  v_cvt_pk_bf16_f32 v87, v190, v191
  v_mfma_f32_32x32x16_bf16 a[112:127], v[228:231], v[228:231], 0
  buffer_load_dwordx4 v2, s[48:51], s27 offen offset:3072 sc1 lds
  v_cvt_pk_bf16_f32 v92, v204, v205
  v_cvt_pk_bf16_f32 v93, v206, v207
  v_cvt_pk_bf16_f32 v94, v220, v221
  v_cvt_pk_bf16_f32 v95, v222, v223
  s_add_u32 s27, s27, 16384
  s_add_u32 s25, s25, 32768
  s_and_b32 s25, s25, 0x1ffff
  s_waitcnt vmcnt(12)
  s_barrier
  ds_read_b128 a[128:131], v9 offset:0
  ds_read_b128 a[132:135], v9 offset:1024
  ds_read_b128 a[136:139], v9 offset:2048
  ds_read_b128 a[140:143], v9 offset:3072
  ds_read_b128 a[144:147], v9 offset:4096
  ds_read_b128 a[148:151], v9 offset:5120
  ds_read_b128 a[152:155], v9 offset:6144
  ds_read_b128 a[156:159], v9 offset:7168
  buffer_store_dword v4, off, s[40:43], s65 offset:32 sc1
  v_add_u32 v13, 32, v8
  v_mov_b32 v14, 0
  s_cmp_eq_u32 s2, 255
  s_cbranch_scc1 fa_top8
fa_notop:
  s_waitcnt lgkmcnt(4)
  v_mfma_f32_16x16x32_bf16 v[96:99], a[128:131], v[32:35], 0
  v_mfma_f32_16x16x32_bf16 v[104:107], a[128:131], v[36:39], 0
  v_mfma_f32_16x16x32_bf16 v[128:131], a[128:131], v[64:67], 0
  v_mfma_f32_16x16x32_bf16 v[136:139], a[128:131], v[68:71], 0
  s_mov_b32 m0, s24
  ds_read_b128 a[128:131], v3 offset:0
  v_mfma_f32_16x16x32_bf16 v[100:103], a[132:135], v[32:35], 0
  buffer_load_dwordx4 v2, s[44:47], s26 offen offset:0 sc1 lds
  v_mfma_f32_16x16x32_bf16 v[108:111], a[132:135], v[36:39], 0
  v_mfma_f32_16x16x32_bf16 v[132:135], a[132:135], v[64:67], 0
  v_mfma_f32_16x16x32_bf16 v[140:143], a[132:135], v[68:71], 0
  ds_read_b128 a[132:135], v3 offset:1024
  v_mfma_f32_16x16x32_bf16 v[96:99], a[136:139], v[40:43], v[96:99]
  v_mfma_f32_16x16x32_bf16 v[104:107], a[136:139], v[44:47], v[104:107]
  v_mfma_f32_16x16x32_bf16 v[128:131], a[136:139], v[72:75], v[128:131]
  buffer_load_dwordx4 v2, s[44:47], s26 offen offset:1024 sc1 lds
  v_mfma_f32_16x16x32_bf16 v[136:139], a[136:139], v[76:79], v[136:139]
  ds_read_b128 a[136:139], v3 offset:2048
  v_mfma_f32_16x16x32_bf16 v[100:103], a[140:143], v[40:43], v[100:103]
  v_mfma_f32_16x16x32_bf16 v[108:111], a[140:143], v[44:47], v[108:111]
  v_mfma_f32_16x16x32_bf16 v[132:135], a[140:143], v[72:75], v[132:135]
  v_mfma_f32_16x16x32_bf16 v[140:143], a[140:143], v[76:79], v[140:143]
  s_waitcnt lgkmcnt(3)
  ds_read_b128 a[140:143], v3 offset:3072
  v_mfma_f32_16x16x32_bf16 v[96:99], a[144:147], v[48:51], v[96:99]
  v_mfma_f32_16x16x32_bf16 v[104:107], a[144:147], v[52:55], v[104:107]
  v_mfma_f32_16x16x32_bf16 v[128:131], a[144:147], v[80:83], v[128:131]
  buffer_load_dwordx4 v2, s[44:47], s26 offen offset:2048 sc1 lds
  v_mfma_f32_16x16x32_bf16 v[136:139], a[144:147], v[84:87], v[136:139]
  ds_read_b128 a[144:147], v3 offset:4096
  v_mfma_f32_16x16x32_bf16 v[100:103], a[148:151], v[48:51], v[100:103]
  v_mfma_f32_16x16x32_bf16 v[108:111], a[148:151], v[52:55], v[108:111]
  v_mfma_f32_16x16x32_bf16 v[132:135], a[148:151], v[80:83], v[132:135]
  v_mfma_f32_16x16x32_bf16 v[140:143], a[148:151], v[84:87], v[140:143]
  ds_read_b128 a[148:151], v3 offset:5120
  v_mfma_f32_16x16x32_bf16 v[96:99], a[152:155], v[56:59], v[96:99]
  buffer_load_dwordx4 v2, s[44:47], s26 offen offset:3072 sc1 lds
  v_mfma_f32_16x16x32_bf16 v[104:107], a[152:155], v[60:63], v[104:107]
  s_add_u32 s26, s26, 16384
  v_mfma_f32_16x16x32_bf16 v[128:131], a[152:155], v[88:91], v[128:131]
  s_add_u32 s24, s24, 32768
  v_mfma_f32_16x16x32_bf16 v[136:139], a[152:155], v[92:95], v[136:139]
  s_and_b32 s24, s24, 0x1ffff
  ds_read_b128 a[152:155], v3 offset:6144
  v_mfma_f32_16x16x32_bf16 v[100:103], a[156:159], v[56:59], v[100:103]
  v_mfma_f32_16x16x32_bf16 v[108:111], a[156:159], v[60:63], v[108:111]
  v_mfma_f32_16x16x32_bf16 v[132:135], a[156:159], v[88:91], v[132:135]
  v_mfma_f32_16x16x32_bf16 v[140:143], a[156:159], v[92:95], v[140:143]
  s_waitcnt lgkmcnt(3)
  ds_read_b128 a[156:159], v3 offset:7168
  s_nop 7
  s_cmp_lg_u32 s28, 0
  s_cbranch_scc1 fa_nomask0
  v_cndmask_b32 v96, v4, v96, s[68:69]
  v_cndmask_b32 v97, v4, v97, s[70:71]
  v_cndmask_b32 v98, v4, v98, s[72:73]
  v_cndmask_b32 v99, v4, v99, s[74:75]
  v_mov_b32 v100, v4
  v_mov_b32 v101, v4
  v_mov_b32 v102, v4
  v_mov_b32 v103, v4
  v_cndmask_b32 v108, v4, v108, s[68:69]
  v_cndmask_b32 v109, v4, v109, s[70:71]
  v_cndmask_b32 v110, v4, v110, s[72:73]
  v_cndmask_b32 v111, v4, v111, s[74:75]
fa_nomask0:
  v_max3_f32 v16, v96, v97, v98
  v_max3_f32 v16, v16, v99, v100
  v_max3_f32 v16, v16, v101, v102
  v_max_f32 v16, v16, v103
  v_max3_f32 v17, v104, v105, v106
  v_max3_f32 v17, v17, v107, v108
  v_max3_f32 v17, v17, v109, v110
  v_max_f32 v17, v17, v111
  v_max3_f32 v18, v128, v129, v130
  v_max3_f32 v18, v18, v131, v132
  v_max3_f32 v18, v18, v133, v134
  v_max_f32 v18, v18, v135
  v_max3_f32 v19, v136, v137, v138
  v_max3_f32 v19, v19, v139, v140
  v_max3_f32 v19, v19, v141, v142
  v_max_f32 v19, v19, v143
  v_mov_b32 v20, v16
  v_mov_b32 v21, v17
  v_mov_b32 v22, v18
  v_mov_b32 v23, v19
  s_nop 0
  v_permlane16_swap_b32 v16, v20
  v_permlane16_swap_b32 v17, v21
  v_permlane16_swap_b32 v18, v22
  v_permlane16_swap_b32 v19, v23
  v_max_f32 v16, v16, v20
  v_max_f32 v17, v17, v21
  v_max_f32 v18, v18, v22
  v_max_f32 v19, v19, v23
  v_mov_b32 v20, v16
  v_mov_b32 v21, v17
  v_mov_b32 v22, v18
  v_mov_b32 v23, v19
  s_nop 0
  v_permlane32_swap_b32 v16, v20
  v_permlane32_swap_b32 v17, v21
  v_permlane32_swap_b32 v18, v22
  v_permlane32_swap_b32 v19, v23
  v_max_f32 v16, v16, v20
  v_max_f32 v17, v17, v21
  v_max_f32 v18, v18, v22
  v_max_f32 v19, v19, v23
  v_sub_f32 v192, 0, v16
  v_sub_f32 v193, 0, v16
  v_sub_f32 v194, 0, v16
  v_sub_f32 v195, 0, v16
  v_sub_f32 v196, 0, v17
  v_sub_f32 v197, 0, v17
  v_sub_f32 v198, 0, v17
  v_sub_f32 v199, 0, v17
  v_sub_f32 v200, 0, v18
  v_sub_f32 v201, 0, v18
  v_sub_f32 v202, 0, v18
  v_sub_f32 v203, 0, v18
  v_sub_f32 v204, 0, v19
  v_sub_f32 v205, 0, v19
  v_sub_f32 v206, 0, v19
  v_sub_f32 v207, 0, v19
  v_sub_f32 v96, v96, v16
  v_sub_f32 v97, v97, v16
  v_sub_f32 v98, v98, v16
  v_sub_f32 v99, v99, v16
  v_sub_f32 v100, v100, v16
  v_sub_f32 v101, v101, v16
  v_sub_f32 v102, v102, v16
  v_sub_f32 v103, v103, v16
  v_sub_f32 v104, v104, v17
  v_sub_f32 v105, v105, v17
  v_sub_f32 v106, v106, v17
  v_sub_f32 v107, v107, v17
  v_sub_f32 v108, v108, v17
  v_sub_f32 v109, v109, v17
  v_sub_f32 v110, v110, v17
  v_sub_f32 v111, v111, v17
  v_sub_f32 v128, v128, v18
  v_sub_f32 v129, v129, v18
  v_sub_f32 v130, v130, v18
  v_sub_f32 v131, v131, v18
  v_sub_f32 v132, v132, v18
  v_sub_f32 v133, v133, v18
  v_sub_f32 v134, v134, v18
  v_sub_f32 v135, v135, v18
  v_sub_f32 v136, v136, v19
  v_sub_f32 v137, v137, v19
  v_sub_f32 v138, v138, v19
  v_sub_f32 v139, v139, v19
  v_sub_f32 v140, v140, v19
  v_sub_f32 v141, v141, v19
  v_sub_f32 v142, v142, v19
  v_sub_f32 v143, v143, v19
  v_mfma_f32_16x16x32_bf16 v[112:115], a[128:131], v[32:35], v[192:195]
  v_exp_f32 v216, v128
  v_exp_f32 v217, v129
  v_mfma_f32_16x16x32_bf16 v[120:123], a[128:131], v[36:39], v[196:199]
  v_exp_f32 v218, v130
  v_add_f32 v226, v216, v217
  v_cvt_pk_bf16_f32 v176, v216, v217
  v_mfma_f32_16x16x32_bf16 v[144:147], a[128:131], v[64:67], v[200:203]
  s_add_u32 s66, s66, 32768
  v_exp_f32 v219, v131
  v_add_f32 v226, v226, v218
  v_add_f32 v226, v226, v219
  v_mfma_f32_16x16x32_bf16 v[152:155], a[128:131], v[68:71], v[204:207]
  s_mov_b32 m0, s25
  ds_read_b128 a[128:131], v3 offset:8192
  v_exp_f32 v220, v132
  v_cvt_pk_bf16_f32 v177, v218, v219
  v_mfma_f32_16x16x32_bf16 v[116:119], a[132:135], v[32:35], v[192:195]
  s_and_b32 s66, s66, 0x1ffff
  buffer_load_dwordx4 v2, s[48:51], s27 offen offset:0 sc1 lds
  v_exp_f32 v221, v133
  v_add_f32 v226, v226, v220
  v_add_f32 v226, v226, v221
  v_mfma_f32_16x16x32_bf16 v[124:127], a[132:135], v[36:39], v[196:199]
  v_exp_f32 v222, v134
  v_cvt_pk_bf16_f32 v178, v220, v221
  v_exp_f32 v223, v135
  v_mfma_f32_16x16x32_bf16 v[148:151], a[132:135], v[64:67], v[200:203]
  v_exp_f32 v216, v136
  v_add_f32 v226, v226, v222
  v_mfma_f32_16x16x32_bf16 v[156:159], a[132:135], v[68:71], v[204:207]
  ds_read_b128 a[132:135], v3 offset:9216
  v_exp_f32 v217, v137
  v_add_f32 v226, v226, v223
  v_mfma_f32_16x16x32_bf16 v[112:115], a[136:139], v[40:43], v[112:115]
  v_exp_f32 v218, v138
  v_cvt_pk_bf16_f32 v179, v222, v223
  v_add_f32 v227, v216, v217
  v_mfma_f32_16x16x32_bf16 v[120:123], a[136:139], v[44:47], v[120:123]
  v_exp_f32 v219, v139
  v_cvt_pk_bf16_f32 v180, v216, v217
  v_add_f32 v227, v227, v218
  v_add_f32 v227, v227, v219
  v_mfma_f32_16x16x32_bf16 v[144:147], a[136:139], v[72:75], v[144:147]
  buffer_load_dwordx4 v2, s[48:51], s27 offen offset:1024 sc1 lds
  v_exp_f32 v220, v140
  v_cvt_pk_bf16_f32 v181, v218, v219
  v_mfma_f32_16x16x32_bf16 v[152:155], a[136:139], v[76:79], v[152:155]
  ds_read_b128 a[136:139], v3 offset:10240
  v_exp_f32 v221, v141
  v_add_f32 v227, v227, v220
  v_mfma_f32_16x16x32_bf16 v[116:119], a[140:143], v[40:43], v[116:119]
  v_exp_f32 v222, v142
  v_add_f32 v227, v227, v221
  v_cvt_pk_bf16_f32 v182, v220, v221
  v_mfma_f32_16x16x32_bf16 v[124:127], a[140:143], v[44:47], v[124:127]
  v_exp_f32 v223, v143
  v_add_f32 v227, v227, v222
  v_add_f32 v227, v227, v223
  v_exp_f32 v208, v96
  v_mfma_f32_16x16x32_bf16 v[148:151], a[140:143], v[72:75], v[148:151]
  v_exp_f32 v209, v97
  v_cvt_pk_bf16_f32 v183, v222, v223
  v_mfma_f32_16x16x32_bf16 v[156:159], a[140:143], v[76:79], v[156:159]
  s_waitcnt lgkmcnt(3)
  ds_read_b128 a[140:143], v3 offset:11264
  v_exp_f32 v210, v98
  v_add_f32 v224, v208, v209
  v_mfma_f32_16x16x32_bf16 v[112:115], a[144:147], v[48:51], v[112:115]
  v_exp_f32 v211, v99
  v_cvt_pk_bf16_f32 v160, v208, v209
  v_add_f32 v224, v224, v210
  v_mfma_f32_16x16x32_bf16 v[120:123], a[144:147], v[52:55], v[120:123]
  v_exp_f32 v212, v100
  v_add_f32 v224, v224, v211
  v_cvt_pk_bf16_f32 v161, v210, v211
  v_mfma_f32_16x16x32_bf16 v[144:147], a[144:147], v[80:83], v[144:147]
  buffer_load_dwordx4 v2, s[48:51], s27 offen offset:2048 sc1 lds
  v_exp_f32 v213, v101
  v_add_f32 v224, v224, v212
  v_add_f32 v224, v224, v213
  v_mfma_f32_16x16x32_bf16 v[152:155], a[144:147], v[84:87], v[152:155]
  ds_read_b128 a[144:147], v3 offset:12288
  v_exp_f32 v214, v102
  v_cvt_pk_bf16_f32 v162, v212, v213
  v_mfma_f32_16x16x32_bf16 v[116:119], a[148:151], v[48:51], v[116:119]
  v_exp_f32 v215, v103
  v_add_f32 v224, v224, v214
  v_add_f32 v224, v224, v215
  v_mfma_f32_16x16x32_bf16 v[124:127], a[148:151], v[52:55], v[124:127]
  v_exp_f32 v208, v104
  v_exp_f32 v209, v105
  v_mfma_f32_16x16x32_bf16 v[148:151], a[148:151], v[80:83], v[148:151]
  v_exp_f32 v210, v106
  v_cvt_pk_bf16_f32 v163, v214, v215
  v_add_f32 v225, v208, v209
  v_mfma_f32_16x16x32_bf16 v[156:159], a[148:151], v[84:87], v[156:159]
  ds_read_b128 a[148:151], v3 offset:13312
  v_exp_f32 v211, v107
  v_cvt_pk_bf16_f32 v164, v208, v209
  v_add_f32 v225, v225, v210
  v_mfma_f32_16x16x32_bf16 v[112:115], a[152:155], v[56:59], v[112:115]
  buffer_load_dwordx4 v2, s[48:51], s27 offen offset:3072 sc1 lds
  v_exp_f32 v212, v108
  v_add_f32 v225, v225, v211
  v_mfma_f32_16x16x32_bf16 v[120:123], a[152:155], v[60:63], v[120:123]
  s_add_u32 s27, s27, 16384
  v_exp_f32 v213, v109
  v_mfma_f32_16x16x32_bf16 v[144:147], a[152:155], v[88:91], v[144:147]
  s_add_u32 s25, s25, 32768
  v_exp_f32 v214, v110
  v_mfma_f32_16x16x32_bf16 v[152:155], a[152:155], v[92:95], v[152:155]
  s_and_b32 s25, s25, 0x1ffff
  ds_read_b128 a[152:155], v3 offset:14336
  v_cvt_pk_bf16_f32 v165, v210, v211
  v_max3_f32 v5, v226, v227, v224
  v_add_f32 v225, v225, v212
  v_add_f32 v225, v225, v213
  v_cvt_pk_bf16_f32 v166, v212, v213
  v_exp_f32 v215, v111
  v_mfma_f32_16x16x32_bf16 v[116:119], a[156:159], v[56:59], v[116:119]
  v_add_f32 v225, v225, v214
  v_add_f32 v225, v225, v215
  v_max_f32 v5, v5, v225
  v_cmp_lt_f32 vcc, s81, v5
  v_mfma_f32_16x16x32_bf16 v[124:127], a[156:159], v[60:63], v[124:127]
  v_mfma_f32_16x16x32_bf16 v[148:151], a[156:159], v[88:91], v[148:151]
  v_cvt_pk_bf16_f32 v167, v214, v215
  v_mfma_f32_16x16x32_bf16 v[156:159], a[156:159], v[92:95], v[156:159]
  s_waitcnt lgkmcnt(3)
  s_cbranch_vccnz fa_stub0
fa_back0:
  ds_read_b128 a[156:159], v3 offset:15360
  v_add_f32 v228, v228, v224
  v_add_f32 v229, v229, v225
  v_add_f32 v230, v230, v226
  v_add_f32 v231, v231, v227
  s_nop 3
  v_exp_f32 v216, v144
  v_exp_f32 v217, v145
  v_add_u32 v3, s66, v2
  buffer_load_dword v14, v13, s[40:43], 0 offen sc1
  s_cmp_eq_u32 s28, 0
  s_cbranch_scc1 fa_AV
  s_sub_u32 s28, s28, 1
  s_cmp_eq_u32 s28, 0
  s_cbranch_scc1 fa_Aexit
.p2align 6
fa_DD:
  v_mfma_f32_16x16x32_bf16 v[96:99], a[128:131], v[32:35], v[192:195]
  s_waitcnt vmcnt(12)
  v_exp_f32 v218, v146
  v_mfma_f32_16x16x32_bf16 v[104:107], a[128:131], v[36:39], v[196:199]
  s_barrier
  v_exp_f32 v219, v147
  v_mfma_f32_16x16x32_bf16 v[128:131], a[128:131], v[64:67], v[200:203]
  s_cmp_ge_u32 s26, s32
  ds_read_b128 a[160:163], v3 offset:16384
  v_add_f32 v226, v216, v217
  v_mfma_f32_16x16x32_bf16 v[136:139], a[128:131], v[68:71], v[204:207]
  s_cbranch_scc1 fa_hk4
fa_hb4:
  v_exp_f32 v220, v148
  v_mfma_f32_16x16x32_bf16 v[100:103], a[132:135], v[32:35], v[192:195]
  ds_read_b128 a[164:167], v3 offset:17408
  v_cvt_pk_bf16_f32 v184, v216, v217
  v_mfma_f32_16x16x32_bf16 v[108:111], a[132:135], v[36:39], v[196:199]
  s_mov_b32 m0, s24
  v_exp_f32 v221, v149
  v_mfma_f32_16x16x32_bf16 v[132:135], a[132:135], v[64:67], v[200:203]
  buffer_load_dwordx4 v2, s[44:47], s26 offen offset:0 sc1 lds
  v_add_f32 v226, v226, v218
  v_mfma_f32_16x16x32_bf16 v[140:143], a[132:135], v[68:71], v[204:207]
  v_exp_f32 v222, v150
  v_mfma_f32_16x16x32_bf16 v[96:99], a[136:139], v[40:43], v[96:99]
  ds_read_b128 a[168:171], v3 offset:18432
  v_add_f32 v226, v226, v219
  v_mfma_f32_16x16x32_bf16 v[104:107], a[136:139], v[44:47], v[104:107]
  v_exp_f32 v223, v151
  v_mfma_f32_16x16x32_bf16 v[128:131], a[136:139], v[72:75], v[128:131]
  v_cvt_pk_bf16_f32 v185, v218, v219
  v_add_f32 v226, v226, v220
  v_mfma_f32_16x16x32_bf16 v[136:139], a[136:139], v[76:79], v[136:139]
  v_exp_f32 v216, v152
  v_mfma_f32_16x16x32_bf16 v[100:103], a[140:143], v[40:43], v[100:103]
  ds_read_b128 a[172:175], v3 offset:19456
  v_add_f32 v226, v226, v221
  v_mfma_f32_16x16x32_bf16 v[108:111], a[140:143], v[44:47], v[108:111]
  v_exp_f32 v217, v153
  v_mfma_f32_16x16x32_bf16 v[132:135], a[140:143], v[72:75], v[132:135]
  v_cvt_pk_bf16_f32 v186, v220, v221
  v_add_f32 v226, v226, v222
  v_mfma_f32_16x16x32_bf16 v[140:143], a[140:143], v[76:79], v[140:143]
  s_waitcnt lgkmcnt(4)
  v_exp_f32 v218, v154
  v_mfma_f32_16x16x32_bf16 v[96:99], a[144:147], v[48:51], v[96:99]
  ds_read_b128 a[176:179], v3 offset:20480
  v_add_f32 v226, v226, v223
  v_mfma_f32_16x16x32_bf16 v[104:107], a[144:147], v[52:55], v[104:107]
  v_exp_f32 v219, v155
  v_mfma_f32_16x16x32_bf16 v[128:131], a[144:147], v[80:83], v[128:131]
  v_cvt_pk_bf16_f32 v187, v222, v223
  v_add_f32 v227, v216, v217
  v_mfma_f32_16x16x32_bf16 v[136:139], a[144:147], v[84:87], v[136:139]
  v_exp_f32 v220, v156
  v_mfma_f32_16x16x32_bf16 v[100:103], a[148:151], v[48:51], v[100:103]
  ds_read_b128 a[180:183], v3 offset:21504
  v_cvt_pk_bf16_f32 v188, v216, v217
  v_mfma_f32_16x16x32_bf16 v[108:111], a[148:151], v[52:55], v[108:111]
  v_exp_f32 v221, v157
  v_mfma_f32_16x16x32_bf16 v[132:135], a[148:151], v[80:83], v[132:135]
  buffer_load_dwordx4 v2, s[44:47], s26 offen offset:1024 sc1 lds
  v_add_f32 v227, v227, v218
  v_mfma_f32_16x16x32_bf16 v[140:143], a[148:151], v[84:87], v[140:143]
  v_exp_f32 v222, v158
  v_mfma_f32_16x16x32_bf16 v[96:99], a[152:155], v[56:59], v[96:99]
  ds_read_b128 a[184:187], v3 offset:22528
  v_add_f32 v227, v227, v219
  v_mfma_f32_16x16x32_bf16 v[104:107], a[152:155], v[60:63], v[104:107]
  v_exp_f32 v223, v159
  v_mfma_f32_16x16x32_bf16 v[128:131], a[152:155], v[88:91], v[128:131]
  v_cvt_pk_bf16_f32 v189, v218, v219
  v_add_f32 v227, v227, v220
  v_mfma_f32_16x16x32_bf16 v[136:139], a[152:155], v[92:95], v[136:139]
  v_exp_f32 v208, v112
  v_mfma_f32_16x16x32_bf16 v[100:103], a[156:159], v[56:59], v[100:103]
  ds_read_b128 a[188:191], v3 offset:23552
  v_add_f32 v227, v227, v221
  v_mfma_f32_16x16x32_bf16 v[108:111], a[156:159], v[60:63], v[108:111]
  v_exp_f32 v209, v113
  v_mfma_f32_16x16x32_bf16 v[132:135], a[156:159], v[88:91], v[132:135]
  v_cvt_pk_bf16_f32 v190, v220, v221
  v_add_f32 v227, v227, v222
  v_add_f32 v227, v227, v223
  v_mfma_f32_16x16x32_bf16 v[140:143], a[156:159], v[92:95], v[140:143]
  s_waitcnt lgkmcnt(4)
  v_exp_f32 v210, v114
  v_mfma_f32_16x16x32_bf16 a[0:3], a[160:163], v[160:163], a[0:3]
  ds_read_b128 a[128:131], v3 offset:0
  v_cvt_pk_bf16_f32 v191, v222, v223
  v_mfma_f32_16x16x32_bf16 a[4:7], a[160:163], v[164:167], a[4:7]
  v_exp_f32 v211, v115
  v_mfma_f32_16x16x32_bf16 a[64:67], a[160:163], v[176:179], a[64:67]
  v_exp_f32 v212, v116
  v_mfma_f32_16x16x32_bf16 a[68:71], a[160:163], v[180:183], a[68:71]
  v_add_f32 v224, v208, v209
  v_cvt_pk_bf16_f32 v168, v208, v209
  v_mfma_f32_16x16x32_bf16 a[8:11], a[164:167], v[160:163], a[8:11]
  ds_read_b128 a[132:135], v3 offset:1024
  v_add_f32 v224, v224, v210
  v_mfma_f32_16x16x32_bf16 a[12:15], a[164:167], v[164:167], a[12:15]
  v_exp_f32 v213, v117
  v_mfma_f32_16x16x32_bf16 a[72:75], a[164:167], v[176:179], a[72:75]
  buffer_load_dwordx4 v2, s[44:47], s26 offen offset:2048 sc1 lds
  v_add_f32 v224, v224, v211
  v_mfma_f32_16x16x32_bf16 a[76:79], a[164:167], v[180:183], a[76:79]
  v_exp_f32 v214, v118
  v_mfma_f32_16x16x32_bf16 a[16:19], a[168:171], v[160:163], a[16:19]
  ds_read_b128 a[136:139], v3 offset:2048
  v_cvt_pk_bf16_f32 v169, v210, v211
  v_mfma_f32_16x16x32_bf16 a[20:23], a[168:171], v[164:167], a[20:23]
  v_exp_f32 v215, v119
  v_mfma_f32_16x16x32_bf16 a[80:83], a[168:171], v[176:179], a[80:83]
  v_add_f32 v224, v224, v212
  v_add_f32 v224, v224, v213
  v_mfma_f32_16x16x32_bf16 a[84:87], a[168:171], v[180:183], a[84:87]
  v_exp_f32 v208, v120
  v_mfma_f32_16x16x32_bf16 a[24:27], a[172:175], v[160:163], a[24:27]
  ds_read_b128 a[140:143], v3 offset:3072
  v_cvt_pk_bf16_f32 v170, v212, v213
  v_mfma_f32_16x16x32_bf16 a[28:31], a[172:175], v[164:167], a[28:31]
  v_exp_f32 v209, v121
  v_mfma_f32_16x16x32_bf16 a[88:91], a[172:175], v[176:179], a[88:91]
  v_exp_f32 v210, v122
  v_mfma_f32_16x16x32_bf16 a[92:95], a[172:175], v[180:183], a[92:95]
  s_waitcnt lgkmcnt(4)
  v_add_f32 v224, v224, v214
  v_add_f32 v224, v224, v215
  v_mfma_f32_16x16x32_bf16 a[32:35], a[176:179], v[160:163], a[32:35]
  ds_read_b128 a[144:147], v3 offset:4096
  v_cvt_pk_bf16_f32 v171, v214, v215
  v_mfma_f32_16x16x32_bf16 a[36:39], a[176:179], v[164:167], a[36:39]
  v_exp_f32 v211, v123
  v_mfma_f32_16x16x32_bf16 a[96:99], a[176:179], v[176:179], a[96:99]
  v_add_f32 v225, v208, v209
  v_cvt_pk_bf16_f32 v172, v208, v209
  v_mfma_f32_16x16x32_bf16 a[100:103], a[176:179], v[180:183], a[100:103]
  v_exp_f32 v212, v124
  v_mfma_f32_16x16x32_bf16 a[40:43], a[180:183], v[160:163], a[40:43]
  ds_read_b128 a[148:151], v3 offset:5120
  v_add_f32 v225, v225, v210
  v_mfma_f32_16x16x32_bf16 a[44:47], a[180:183], v[164:167], a[44:47]
  v_exp_f32 v213, v125
  v_mfma_f32_16x16x32_bf16 a[104:107], a[180:183], v[176:179], a[104:107]
  buffer_load_dwordx4 v2, s[44:47], s26 offen offset:3072 sc1 lds
  v_add_f32 v225, v225, v211
  v_mfma_f32_16x16x32_bf16 a[108:111], a[180:183], v[180:183], a[108:111]
  s_add_u32 s26, s26, 16384
  v_exp_f32 v214, v126
  v_mfma_f32_16x16x32_bf16 a[48:51], a[184:187], v[160:163], a[48:51]
  s_add_u32 s24, s24, 32768
  ds_read_b128 a[152:155], v3 offset:6144
  v_cvt_pk_bf16_f32 v173, v210, v211
  v_mfma_f32_16x16x32_bf16 a[52:55], a[184:187], v[164:167], a[52:55]
  s_and_b32 s24, s24, 0x1ffff
  v_exp_f32 v215, v127
  v_mfma_f32_16x16x32_bf16 a[112:115], a[184:187], v[176:179], a[112:115]
  v_max3_f32 v5, v226, v227, v224
  v_add_f32 v225, v225, v212
  v_mfma_f32_16x16x32_bf16 a[116:119], a[184:187], v[180:183], a[116:119]
  v_add_f32 v225, v225, v213
  v_cvt_pk_bf16_f32 v174, v212, v213
  v_add_f32 v225, v225, v214
  v_mfma_f32_16x16x32_bf16 a[56:59], a[188:191], v[160:163], a[56:59]
  ds_read_b128 a[156:159], v3 offset:7168
  v_add_f32 v225, v225, v215
  v_max_f32 v5, v5, v225
  v_cmp_lt_f32 vcc, s81, v5
  v_mfma_f32_16x16x32_bf16 a[60:63], a[188:191], v[164:167], a[60:63]
  v_exp_f32 v216, v128
  v_mfma_f32_16x16x32_bf16 a[120:123], a[188:191], v[176:179], a[120:123]
  s_waitcnt lgkmcnt(4)
  v_cvt_pk_bf16_f32 v175, v214, v215
  v_mfma_f32_16x16x32_bf16 a[124:127], a[188:191], v[180:183], a[124:127]
  s_cbranch_vccnz fa_stub1
fa_back1:
  v_exp_f32 v217, v129
  v_add_f32 v228, v228, v224
  v_add_f32 v229, v229, v225
  v_add_f32 v230, v230, v226
  v_add_f32 v231, v231, v227
fa_DDe:
  v_mfma_f32_16x16x32_bf16 v[112:115], a[128:131], v[32:35], v[192:195]
  ds_read_b128 a[160:163], v3 offset:24576
  v_add_f32 v226, v216, v217
  v_mfma_f32_16x16x32_bf16 v[120:123], a[128:131], v[36:39], v[196:199]
  v_exp_f32 v218, v130
  v_mfma_f32_16x16x32_bf16 v[144:147], a[128:131], v[64:67], v[200:203]
  s_cmp_ge_u32 s26, s9
  v_exp_f32 v219, v131
  v_mfma_f32_16x16x32_bf16 v[152:155], a[128:131], v[68:71], v[204:207]
  s_cbranch_scc1 fa_hk5
fa_hb5:
  v_exp_f32 v220, v132
  v_mfma_f32_16x16x32_bf16 v[116:119], a[132:135], v[32:35], v[192:195]
  s_add_u32 s66, s66, 32768
  ds_read_b128 a[164:167], v3 offset:25600
  v_cvt_pk_bf16_f32 v176, v216, v217
  v_mfma_f32_16x16x32_bf16 v[124:127], a[132:135], v[36:39], v[196:199]
  s_mov_b32 m0, s25
  v_exp_f32 v221, v133
  v_mfma_f32_16x16x32_bf16 v[148:151], a[132:135], v[64:67], v[200:203]
  s_and_b32 s66, s66, 0x1ffff
  buffer_load_dwordx4 v2, s[48:51], s27 offen offset:0 sc1 lds
  v_add_f32 v226, v226, v218
  v_mfma_f32_16x16x32_bf16 v[156:159], a[132:135], v[68:71], v[204:207]
  v_exp_f32 v222, v134
  v_mfma_f32_16x16x32_bf16 v[112:115], a[136:139], v[40:43], v[112:115]
  ds_read_b128 a[168:171], v3 offset:26624
  v_add_f32 v226, v226, v219
  v_mfma_f32_16x16x32_bf16 v[120:123], a[136:139], v[44:47], v[120:123]
  v_exp_f32 v223, v135
  v_mfma_f32_16x16x32_bf16 v[144:147], a[136:139], v[72:75], v[144:147]
  v_cvt_pk_bf16_f32 v177, v218, v219
  v_add_f32 v226, v226, v220
  v_mfma_f32_16x16x32_bf16 v[152:155], a[136:139], v[76:79], v[152:155]
  v_exp_f32 v216, v136
  v_mfma_f32_16x16x32_bf16 v[116:119], a[140:143], v[40:43], v[116:119]
  ds_read_b128 a[172:175], v3 offset:27648
  v_add_f32 v226, v226, v221
  v_mfma_f32_16x16x32_bf16 v[124:127], a[140:143], v[44:47], v[124:127]
  v_exp_f32 v217, v137
  v_mfma_f32_16x16x32_bf16 v[148:151], a[140:143], v[72:75], v[148:151]
  v_cvt_pk_bf16_f32 v178, v220, v221
  v_add_f32 v226, v226, v222
  v_mfma_f32_16x16x32_bf16 v[156:159], a[140:143], v[76:79], v[156:159]
  s_waitcnt lgkmcnt(4)
  v_exp_f32 v218, v138
  v_mfma_f32_16x16x32_bf16 v[112:115], a[144:147], v[48:51], v[112:115]
  ds_read_b128 a[176:179], v3 offset:28672
  v_add_f32 v226, v226, v223
  v_mfma_f32_16x16x32_bf16 v[120:123], a[144:147], v[52:55], v[120:123]
  v_exp_f32 v219, v139
  v_mfma_f32_16x16x32_bf16 v[144:147], a[144:147], v[80:83], v[144:147]
  v_cvt_pk_bf16_f32 v179, v222, v223
  v_add_f32 v227, v216, v217
  v_mfma_f32_16x16x32_bf16 v[152:155], a[144:147], v[84:87], v[152:155]
  v_exp_f32 v220, v140
  v_mfma_f32_16x16x32_bf16 v[116:119], a[148:151], v[48:51], v[116:119]
  ds_read_b128 a[180:183], v3 offset:29696
  v_cvt_pk_bf16_f32 v180, v216, v217
  v_mfma_f32_16x16x32_bf16 v[124:127], a[148:151], v[52:55], v[124:127]
  v_exp_f32 v221, v141
  v_mfma_f32_16x16x32_bf16 v[148:151], a[148:151], v[80:83], v[148:151]
  buffer_load_dwordx4 v2, s[48:51], s27 offen offset:1024 sc1 lds
  v_add_f32 v227, v227, v218
  v_mfma_f32_16x16x32_bf16 v[156:159], a[148:151], v[84:87], v[156:159]
  v_exp_f32 v222, v142
  v_mfma_f32_16x16x32_bf16 v[112:115], a[152:155], v[56:59], v[112:115]
  ds_read_b128 a[184:187], v3 offset:30720
  v_add_f32 v227, v227, v219
  v_mfma_f32_16x16x32_bf16 v[120:123], a[152:155], v[60:63], v[120:123]
  v_exp_f32 v223, v143
  v_mfma_f32_16x16x32_bf16 v[144:147], a[152:155], v[88:91], v[144:147]
  v_cvt_pk_bf16_f32 v181, v218, v219
  v_add_f32 v227, v227, v220
  v_mfma_f32_16x16x32_bf16 v[152:155], a[152:155], v[92:95], v[152:155]
  v_exp_f32 v208, v96
  v_mfma_f32_16x16x32_bf16 v[116:119], a[156:159], v[56:59], v[116:119]
  ds_read_b128 a[188:191], v3 offset:31744
  v_add_f32 v227, v227, v221
  v_mfma_f32_16x16x32_bf16 v[124:127], a[156:159], v[60:63], v[124:127]
  v_exp_f32 v209, v97
  v_mfma_f32_16x16x32_bf16 v[148:151], a[156:159], v[88:91], v[148:151]
  v_cvt_pk_bf16_f32 v182, v220, v221
  v_add_f32 v227, v227, v222
  v_add_f32 v227, v227, v223
  v_mfma_f32_16x16x32_bf16 v[156:159], a[156:159], v[92:95], v[156:159]
  s_waitcnt lgkmcnt(4)
  v_exp_f32 v210, v98
  v_mfma_f32_16x16x32_bf16 a[0:3], a[160:163], v[168:171], a[0:3]
  ds_read_b128 a[128:131], v3 offset:8192
  v_cvt_pk_bf16_f32 v183, v222, v223
  v_mfma_f32_16x16x32_bf16 a[4:7], a[160:163], v[172:175], a[4:7]
  v_exp_f32 v211, v99
  v_mfma_f32_16x16x32_bf16 a[64:67], a[160:163], v[184:187], a[64:67]
  v_exp_f32 v212, v100
  v_mfma_f32_16x16x32_bf16 a[68:71], a[160:163], v[188:191], a[68:71]
  v_add_f32 v224, v208, v209
  v_cvt_pk_bf16_f32 v160, v208, v209
  v_mfma_f32_16x16x32_bf16 a[8:11], a[164:167], v[168:171], a[8:11]
  ds_read_b128 a[132:135], v3 offset:9216
  v_add_f32 v224, v224, v210
  v_mfma_f32_16x16x32_bf16 a[12:15], a[164:167], v[172:175], a[12:15]
  v_exp_f32 v213, v101
  v_mfma_f32_16x16x32_bf16 a[72:75], a[164:167], v[184:187], a[72:75]
  buffer_load_dwordx4 v2, s[48:51], s27 offen offset:2048 sc1 lds
  v_add_f32 v224, v224, v211
  v_mfma_f32_16x16x32_bf16 a[76:79], a[164:167], v[188:191], a[76:79]
  v_exp_f32 v214, v102
  v_mfma_f32_16x16x32_bf16 a[16:19], a[168:171], v[168:171], a[16:19]
  ds_read_b128 a[136:139], v3 offset:10240
  v_cvt_pk_bf16_f32 v161, v210, v211
  v_mfma_f32_16x16x32_bf16 a[20:23], a[168:171], v[172:175], a[20:23]
  v_exp_f32 v215, v103
  v_mfma_f32_16x16x32_bf16 a[80:83], a[168:171], v[184:187], a[80:83]
  v_add_f32 v224, v224, v212
  v_add_f32 v224, v224, v213
  v_mfma_f32_16x16x32_bf16 a[84:87], a[168:171], v[188:191], a[84:87]
  v_exp_f32 v208, v104
  v_mfma_f32_16x16x32_bf16 a[24:27], a[172:175], v[168:171], a[24:27]
  ds_read_b128 a[140:143], v3 offset:11264
  v_cvt_pk_bf16_f32 v162, v212, v213
  v_mfma_f32_16x16x32_bf16 a[28:31], a[172:175], v[172:175], a[28:31]
  v_exp_f32 v209, v105
  v_mfma_f32_16x16x32_bf16 a[88:91], a[172:175], v[184:187], a[88:91]
  v_exp_f32 v210, v106
  v_mfma_f32_16x16x32_bf16 a[92:95], a[172:175], v[188:191], a[92:95]
  s_waitcnt lgkmcnt(4)
  v_add_f32 v224, v224, v214
  v_add_f32 v224, v224, v215
  v_mfma_f32_16x16x32_bf16 a[32:35], a[176:179], v[168:171], a[32:35]
  ds_read_b128 a[144:147], v3 offset:12288
  v_cvt_pk_bf16_f32 v163, v214, v215
  v_mfma_f32_16x16x32_bf16 a[36:39], a[176:179], v[172:175], a[36:39]
  v_exp_f32 v211, v107
  v_mfma_f32_16x16x32_bf16 a[96:99], a[176:179], v[184:187], a[96:99]
  v_add_f32 v225, v208, v209
  v_cvt_pk_bf16_f32 v164, v208, v209
  v_mfma_f32_16x16x32_bf16 a[100:103], a[176:179], v[188:191], a[100:103]
  v_exp_f32 v212, v108
  v_mfma_f32_16x16x32_bf16 a[40:43], a[180:183], v[168:171], a[40:43]
  ds_read_b128 a[148:151], v3 offset:13312
  v_add_f32 v225, v225, v210
  v_mfma_f32_16x16x32_bf16 a[44:47], a[180:183], v[172:175], a[44:47]
  v_exp_f32 v213, v109
  v_mfma_f32_16x16x32_bf16 a[104:107], a[180:183], v[184:187], a[104:107]
  buffer_load_dwordx4 v2, s[48:51], s27 offen offset:3072 sc1 lds
  v_add_f32 v225, v225, v211
  v_mfma_f32_16x16x32_bf16 a[108:111], a[180:183], v[188:191], a[108:111]
  s_add_u32 s27, s27, 16384
  v_exp_f32 v214, v110
  v_mfma_f32_16x16x32_bf16 a[48:51], a[184:187], v[168:171], a[48:51]
  s_add_u32 s25, s25, 32768
  ds_read_b128 a[152:155], v3 offset:14336
  v_cvt_pk_bf16_f32 v165, v210, v211
  v_mfma_f32_16x16x32_bf16 a[52:55], a[184:187], v[172:175], a[52:55]
  s_and_b32 s25, s25, 0x1ffff
  v_exp_f32 v215, v111
  v_mfma_f32_16x16x32_bf16 a[112:115], a[184:187], v[184:187], a[112:115]
  v_max3_f32 v5, v226, v227, v224
  v_add_f32 v225, v225, v212
  v_mfma_f32_16x16x32_bf16 a[116:119], a[184:187], v[188:191], a[116:119]
  v_add_f32 v225, v225, v213
  v_cvt_pk_bf16_f32 v166, v212, v213
  v_add_f32 v225, v225, v214
  v_mfma_f32_16x16x32_bf16 a[56:59], a[188:191], v[168:171], a[56:59]
  s_sub_u32 s28, s28, 1
  ds_read_b128 a[156:159], v3 offset:15360
  v_add_f32 v225, v225, v215
  v_max_f32 v5, v5, v225
  v_cmp_lt_f32 vcc, s81, v5
  v_mfma_f32_16x16x32_bf16 a[60:63], a[188:191], v[172:175], a[60:63]
  s_cmp_gt_u32 s28, s8
  v_exp_f32 v216, v144
  v_mfma_f32_16x16x32_bf16 a[120:123], a[188:191], v[184:187], a[120:123]
  s_waitcnt lgkmcnt(4)
  v_cvt_pk_bf16_f32 v167, v214, v215
  v_add_u32 v3, s66, v2
  v_mfma_f32_16x16x32_bf16 a[124:127], a[188:191], v[188:191], a[124:127]
  s_cbranch_vccnz fa_stub2
fa_back2:
  v_exp_f32 v217, v145
  v_add_f32 v228, v228, v224
  v_add_f32 v229, v229, v225
  v_add_f32 v230, v230, v226
  v_add_f32 v231, v231, v227
  s_cbranch_scc1 fa_DD
  s_cmp_lg_u32 s8, 0
  s_cbranch_scc1 fa_DDF
fa_Aexit:
  s_bitcmp1_b32 s20, 0
  s_cbranch_scc1 fa_Aodd
  v_mfma_f32_16x16x32_bf16 v[96:99], a[128:131], v[32:35], v[192:195]
  s_waitcnt vmcnt(12)
  v_exp_f32 v218, v146
  v_mfma_f32_16x16x32_bf16 v[104:107], a[128:131], v[36:39], v[196:199]
  s_barrier
  v_exp_f32 v219, v147
  v_mfma_f32_16x16x32_bf16 v[128:131], a[128:131], v[64:67], v[200:203]
  ds_read_b128 a[160:163], v3 offset:16384
  v_add_f32 v226, v216, v217
  v_mfma_f32_16x16x32_bf16 v[136:139], a[128:131], v[68:71], v[204:207]
  v_exp_f32 v220, v148
  v_mfma_f32_16x16x32_bf16 v[100:103], a[132:135], v[32:35], v[192:195]
  ds_read_b128 a[164:167], v3 offset:17408
  v_cvt_pk_bf16_f32 v184, v216, v217
  v_mfma_f32_16x16x32_bf16 v[108:111], a[132:135], v[36:39], v[196:199]
  s_mov_b32 m0, s24
  v_exp_f32 v221, v149
  v_mfma_f32_16x16x32_bf16 v[132:135], a[132:135], v[64:67], v[200:203]
  buffer_load_dwordx4 v2, s[44:47], s26 offen offset:0 sc1 lds
  v_add_f32 v226, v226, v218
  v_mfma_f32_16x16x32_bf16 v[140:143], a[132:135], v[68:71], v[204:207]
  v_exp_f32 v222, v150
  v_mfma_f32_16x16x32_bf16 v[96:99], a[136:139], v[40:43], v[96:99]
  ds_read_b128 a[168:171], v3 offset:18432
  v_add_f32 v226, v226, v219
  v_mfma_f32_16x16x32_bf16 v[104:107], a[136:139], v[44:47], v[104:107]
  v_exp_f32 v223, v151
  v_mfma_f32_16x16x32_bf16 v[128:131], a[136:139], v[72:75], v[128:131]
  v_cvt_pk_bf16_f32 v185, v218, v219
  v_add_f32 v226, v226, v220
  v_mfma_f32_16x16x32_bf16 v[136:139], a[136:139], v[76:79], v[136:139]
  v_exp_f32 v216, v152
  v_mfma_f32_16x16x32_bf16 v[100:103], a[140:143], v[40:43], v[100:103]
  ds_read_b128 a[172:175], v3 offset:19456
  v_add_f32 v226, v226, v221
  v_mfma_f32_16x16x32_bf16 v[108:111], a[140:143], v[44:47], v[108:111]
  v_exp_f32 v217, v153
  v_mfma_f32_16x16x32_bf16 v[132:135], a[140:143], v[72:75], v[132:135]
  v_cvt_pk_bf16_f32 v186, v220, v221
  v_add_f32 v226, v226, v222
  v_mfma_f32_16x16x32_bf16 v[140:143], a[140:143], v[76:79], v[140:143]
  s_waitcnt lgkmcnt(4)
  v_exp_f32 v218, v154
  v_mfma_f32_16x16x32_bf16 v[96:99], a[144:147], v[48:51], v[96:99]
  ds_read_b128 a[176:179], v3 offset:20480
  v_add_f32 v226, v226, v223
  v_mfma_f32_16x16x32_bf16 v[104:107], a[144:147], v[52:55], v[104:107]
  v_exp_f32 v219, v155
  v_mfma_f32_16x16x32_bf16 v[128:131], a[144:147], v[80:83], v[128:131]
  v_cvt_pk_bf16_f32 v187, v222, v223
  v_add_f32 v227, v216, v217
  v_mfma_f32_16x16x32_bf16 v[136:139], a[144:147], v[84:87], v[136:139]
  v_exp_f32 v220, v156
  v_mfma_f32_16x16x32_bf16 v[100:103], a[148:151], v[48:51], v[100:103]
  ds_read_b128 a[180:183], v3 offset:21504
  v_cvt_pk_bf16_f32 v188, v216, v217
  v_mfma_f32_16x16x32_bf16 v[108:111], a[148:151], v[52:55], v[108:111]
  v_exp_f32 v221, v157
  v_mfma_f32_16x16x32_bf16 v[132:135], a[148:151], v[80:83], v[132:135]
  buffer_load_dwordx4 v2, s[44:47], s26 offen offset:1024 sc1 lds
  v_add_f32 v227, v227, v218
  v_mfma_f32_16x16x32_bf16 v[140:143], a[148:151], v[84:87], v[140:143]
  v_exp_f32 v222, v158
  v_mfma_f32_16x16x32_bf16 v[96:99], a[152:155], v[56:59], v[96:99]
  ds_read_b128 a[184:187], v3 offset:22528
  v_add_f32 v227, v227, v219
  v_mfma_f32_16x16x32_bf16 v[104:107], a[152:155], v[60:63], v[104:107]
  v_exp_f32 v223, v159
  v_mfma_f32_16x16x32_bf16 v[128:131], a[152:155], v[88:91], v[128:131]
  v_cvt_pk_bf16_f32 v189, v218, v219
  v_add_f32 v227, v227, v220
  v_mfma_f32_16x16x32_bf16 v[136:139], a[152:155], v[92:95], v[136:139]
  v_exp_f32 v208, v112
  v_mfma_f32_16x16x32_bf16 v[100:103], a[156:159], v[56:59], v[100:103]
  ds_read_b128 a[188:191], v3 offset:23552
  v_add_f32 v227, v227, v221
  v_mfma_f32_16x16x32_bf16 v[108:111], a[156:159], v[60:63], v[108:111]
  v_exp_f32 v209, v113
  v_mfma_f32_16x16x32_bf16 v[132:135], a[156:159], v[88:91], v[132:135]
  v_cvt_pk_bf16_f32 v190, v220, v221
  v_add_f32 v227, v227, v222
  v_add_f32 v227, v227, v223
  v_mfma_f32_16x16x32_bf16 v[140:143], a[156:159], v[92:95], v[140:143]
  s_waitcnt lgkmcnt(4)
  v_exp_f32 v210, v114
  v_mfma_f32_16x16x32_bf16 a[0:3], a[160:163], v[160:163], a[0:3]
  ds_read_b128 a[128:131], v3 offset:0
  v_cvt_pk_bf16_f32 v191, v222, v223
  v_mfma_f32_16x16x32_bf16 a[4:7], a[160:163], v[164:167], a[4:7]
  v_exp_f32 v211, v115
  v_mfma_f32_16x16x32_bf16 a[64:67], a[160:163], v[176:179], a[64:67]
  v_exp_f32 v212, v116
  v_mfma_f32_16x16x32_bf16 a[68:71], a[160:163], v[180:183], a[68:71]
  v_add_f32 v224, v208, v209
  v_cvt_pk_bf16_f32 v168, v208, v209
  v_mfma_f32_16x16x32_bf16 a[8:11], a[164:167], v[160:163], a[8:11]
  ds_read_b128 a[132:135], v3 offset:1024
  v_add_f32 v224, v224, v210
  v_mfma_f32_16x16x32_bf16 a[12:15], a[164:167], v[164:167], a[12:15]
  v_exp_f32 v213, v117
  v_mfma_f32_16x16x32_bf16 a[72:75], a[164:167], v[176:179], a[72:75]
  buffer_load_dwordx4 v2, s[44:47], s26 offen offset:2048 sc1 lds
  v_add_f32 v224, v224, v211
  v_mfma_f32_16x16x32_bf16 a[76:79], a[164:167], v[180:183], a[76:79]
  v_exp_f32 v214, v118
  v_mfma_f32_16x16x32_bf16 a[16:19], a[168:171], v[160:163], a[16:19]
  ds_read_b128 a[136:139], v3 offset:2048
  v_cvt_pk_bf16_f32 v169, v210, v211
  v_mfma_f32_16x16x32_bf16 a[20:23], a[168:171], v[164:167], a[20:23]
  v_exp_f32 v215, v119
  v_mfma_f32_16x16x32_bf16 a[80:83], a[168:171], v[176:179], a[80:83]
  v_add_f32 v224, v224, v212
  v_add_f32 v224, v224, v213
  v_mfma_f32_16x16x32_bf16 a[84:87], a[168:171], v[180:183], a[84:87]
  v_exp_f32 v208, v120
  v_mfma_f32_16x16x32_bf16 a[24:27], a[172:175], v[160:163], a[24:27]
  ds_read_b128 a[140:143], v3 offset:3072
  v_cvt_pk_bf16_f32 v170, v212, v213
  v_mfma_f32_16x16x32_bf16 a[28:31], a[172:175], v[164:167], a[28:31]
  v_exp_f32 v209, v121
  v_mfma_f32_16x16x32_bf16 a[88:91], a[172:175], v[176:179], a[88:91]
  v_exp_f32 v210, v122
  v_mfma_f32_16x16x32_bf16 a[92:95], a[172:175], v[180:183], a[92:95]
  s_waitcnt lgkmcnt(4)
  v_add_f32 v224, v224, v214
  v_add_f32 v224, v224, v215
  v_mfma_f32_16x16x32_bf16 a[32:35], a[176:179], v[160:163], a[32:35]
  ds_read_b128 a[144:147], v3 offset:4096
  v_cvt_pk_bf16_f32 v171, v214, v215
  v_mfma_f32_16x16x32_bf16 a[36:39], a[176:179], v[164:167], a[36:39]
  v_exp_f32 v211, v123
  v_mfma_f32_16x16x32_bf16 a[96:99], a[176:179], v[176:179], a[96:99]
  v_add_f32 v225, v208, v209
  v_cvt_pk_bf16_f32 v172, v208, v209
  v_mfma_f32_16x16x32_bf16 a[100:103], a[176:179], v[180:183], a[100:103]
  v_exp_f32 v212, v124
  v_mfma_f32_16x16x32_bf16 a[40:43], a[180:183], v[160:163], a[40:43]
  ds_read_b128 a[148:151], v3 offset:5120
  v_add_f32 v225, v225, v210
  v_mfma_f32_16x16x32_bf16 a[44:47], a[180:183], v[164:167], a[44:47]
  v_exp_f32 v213, v125
  v_mfma_f32_16x16x32_bf16 a[104:107], a[180:183], v[176:179], a[104:107]
  buffer_load_dwordx4 v2, s[44:47], s26 offen offset:3072 sc1 lds
  v_add_f32 v225, v225, v211
  v_mfma_f32_16x16x32_bf16 a[108:111], a[180:183], v[180:183], a[108:111]
  s_add_u32 s26, s26, 16384
  v_exp_f32 v214, v126
  v_mfma_f32_16x16x32_bf16 a[48:51], a[184:187], v[160:163], a[48:51]
  s_add_u32 s24, s24, 32768
  ds_read_b128 a[152:155], v3 offset:6144
  v_cvt_pk_bf16_f32 v173, v210, v211
  v_mfma_f32_16x16x32_bf16 a[52:55], a[184:187], v[164:167], a[52:55]
  s_and_b32 s24, s24, 0x1ffff
  v_exp_f32 v215, v127
  v_mfma_f32_16x16x32_bf16 a[112:115], a[184:187], v[176:179], a[112:115]
  v_max3_f32 v5, v226, v227, v224
  v_add_f32 v225, v225, v212
  v_mfma_f32_16x16x32_bf16 a[116:119], a[184:187], v[180:183], a[116:119]
  v_add_f32 v225, v225, v213
  v_cvt_pk_bf16_f32 v174, v212, v213
  v_add_f32 v225, v225, v214
  v_mfma_f32_16x16x32_bf16 a[56:59], a[188:191], v[160:163], a[56:59]
  ds_read_b128 a[156:159], v3 offset:7168
  v_add_f32 v225, v225, v215
  v_max_f32 v5, v5, v225
  v_cmp_lt_f32 vcc, s81, v5
  v_mfma_f32_16x16x32_bf16 a[60:63], a[188:191], v[164:167], a[60:63]
  v_exp_f32 v216, v128
  v_mfma_f32_16x16x32_bf16 a[120:123], a[188:191], v[176:179], a[120:123]
  s_waitcnt lgkmcnt(4)
  v_cvt_pk_bf16_f32 v175, v214, v215
  v_mfma_f32_16x16x32_bf16 a[124:127], a[188:191], v[180:183], a[124:127]
  s_cbranch_vccnz fa_stub4
fa_back4:
  v_exp_f32 v217, v129
  v_add_f32 v228, v228, v224
  v_add_f32 v229, v229, v225
  v_add_f32 v230, v230, v226
  v_add_f32 v231, v231, v227
  v_mfma_f32_16x16x32_bf16 v[144:147], a[128:131], v[64:67], v[200:203]
  ds_read_b128 a[160:163], v3 offset:24576
  v_exp_f32 v218, v130
  v_mfma_f32_16x16x32_bf16 v[152:155], a[128:131], v[68:71], v[204:207]
  v_exp_f32 v219, v131
  v_add_f32 v226, v216, v217
  v_mfma_f32_16x16x32_bf16 v[148:151], a[132:135], v[64:67], v[200:203]
  s_add_u32 s66, s66, 32768
  ds_read_b128 a[164:167], v3 offset:25600
  v_exp_f32 v220, v132
  v_mfma_f32_16x16x32_bf16 v[156:159], a[132:135], v[68:71], v[204:207]
  s_and_b32 s66, s66, 0x1ffff
  v_exp_f32 v221, v133
  v_cvt_pk_bf16_f32 v176, v216, v217
  v_mfma_f32_16x16x32_bf16 v[144:147], a[136:139], v[72:75], v[144:147]
  ds_read_b128 a[168:171], v3 offset:26624
  v_add_f32 v226, v226, v218
  v_add_f32 v226, v226, v219
  v_mfma_f32_16x16x32_bf16 v[152:155], a[136:139], v[76:79], v[152:155]
  s_mov_b32 m0, s25
  v_exp_f32 v222, v134
  v_cvt_pk_bf16_f32 v177, v218, v219
  v_mfma_f32_16x16x32_bf16 v[148:151], a[140:143], v[72:75], v[148:151]
  ds_read_b128 a[172:175], v3 offset:27648
  buffer_load_dwordx4 v2, s[48:51], s27 offen offset:0 sc1 lds
  v_add_f32 v226, v226, v220
  v_add_f32 v226, v226, v221
  v_mfma_f32_16x16x32_bf16 v[156:159], a[140:143], v[76:79], v[156:159]
  s_waitcnt lgkmcnt(4)
  v_exp_f32 v223, v135
  v_cvt_pk_bf16_f32 v178, v220, v221
  v_mfma_f32_16x16x32_bf16 v[144:147], a[144:147], v[80:83], v[144:147]
  ds_read_b128 a[176:179], v3 offset:28672
  v_cndmask_b32 v96, v4, v96, s[68:69]
  v_cndmask_b32 v97, v4, v97, s[70:71]
  v_mfma_f32_16x16x32_bf16 v[152:155], a[144:147], v[84:87], v[152:155]
  v_exp_f32 v216, v136
  v_cndmask_b32 v98, v4, v98, s[72:73]
  v_mfma_f32_16x16x32_bf16 v[148:151], a[148:151], v[80:83], v[148:151]
  ds_read_b128 a[180:183], v3 offset:29696
  v_cndmask_b32 v99, v4, v99, s[74:75]
  v_mov_b32 v100, v4
  v_mfma_f32_16x16x32_bf16 v[156:159], a[148:151], v[84:87], v[156:159]
  v_exp_f32 v217, v137
  v_mov_b32 v101, v4
  v_mfma_f32_16x16x32_bf16 v[144:147], a[152:155], v[88:91], v[144:147]
  ds_read_b128 a[184:187], v3 offset:30720
  v_mov_b32 v102, v4
  v_mov_b32 v103, v4
  v_mfma_f32_16x16x32_bf16 v[152:155], a[152:155], v[92:95], v[152:155]
  v_exp_f32 v218, v138
  v_cndmask_b32 v108, v4, v108, s[68:69]
  v_mfma_f32_16x16x32_bf16 v[148:151], a[156:159], v[88:91], v[148:151]
  ds_read_b128 a[188:191], v3 offset:31744
  v_cndmask_b32 v109, v4, v109, s[70:71]
  v_cndmask_b32 v110, v4, v110, s[72:73]
  v_mfma_f32_16x16x32_bf16 v[156:159], a[156:159], v[92:95], v[156:159]
  s_waitcnt lgkmcnt(4)
  v_exp_f32 v219, v139
  v_cndmask_b32 v111, v4, v111, s[74:75]
  v_mfma_f32_16x16x32_bf16 a[0:3], a[160:163], v[168:171], a[0:3]
  ds_read_b128 a[128:131], v3 offset:8192
  v_add_f32 v226, v226, v222
  v_add_f32 v226, v226, v223
  v_mfma_f32_16x16x32_bf16 a[4:7], a[160:163], v[172:175], a[4:7]
  v_exp_f32 v220, v140
  v_cvt_pk_bf16_f32 v179, v222, v223
  v_mfma_f32_16x16x32_bf16 a[64:67], a[160:163], v[184:187], a[64:67]
  buffer_load_dwordx4 v2, s[48:51], s27 offen offset:1024 sc1 lds
  v_add_f32 v227, v216, v217
  v_cvt_pk_bf16_f32 v180, v216, v217
  v_mfma_f32_16x16x32_bf16 a[68:71], a[160:163], v[188:191], a[68:71]
  v_exp_f32 v221, v141
  v_add_f32 v227, v227, v218
  v_mfma_f32_16x16x32_bf16 a[8:11], a[164:167], v[168:171], a[8:11]
  ds_read_b128 a[132:135], v3 offset:9216
  v_exp_f32 v222, v142
  v_mfma_f32_16x16x32_bf16 a[12:15], a[164:167], v[172:175], a[12:15]
  v_exp_f32 v223, v143
  v_mfma_f32_16x16x32_bf16 a[72:75], a[164:167], v[184:187], a[72:75]
  v_exp_f32 v208, v96
  v_mfma_f32_16x16x32_bf16 a[76:79], a[164:167], v[188:191], a[76:79]
  v_exp_f32 v209, v97
  v_mfma_f32_16x16x32_bf16 a[16:19], a[168:171], v[168:171], a[16:19]
  ds_read_b128 a[136:139], v3 offset:10240
  v_add_f32 v227, v227, v219
  v_cvt_pk_bf16_f32 v181, v218, v219
  v_add_f32 v227, v227, v220
  v_add_f32 v227, v227, v221
  v_cvt_pk_bf16_f32 v182, v220, v221
  v_mfma_f32_16x16x32_bf16 a[20:23], a[168:171], v[172:175], a[20:23]
  v_exp_f32 v210, v98
  v_mfma_f32_16x16x32_bf16 a[80:83], a[168:171], v[184:187], a[80:83]
  v_exp_f32 v211, v99
  v_mfma_f32_16x16x32_bf16 a[84:87], a[168:171], v[188:191], a[84:87]
  v_exp_f32 v212, v100
  v_mfma_f32_16x16x32_bf16 a[24:27], a[172:175], v[168:171], a[24:27]
  ds_read_b128 a[140:143], v3 offset:11264
  v_add_f32 v227, v227, v222
  v_add_f32 v227, v227, v223
  v_cvt_pk_bf16_f32 v183, v222, v223
  v_add_f32 v224, v208, v209
  v_cvt_pk_bf16_f32 v160, v208, v209
  v_mfma_f32_16x16x32_bf16 a[28:31], a[172:175], v[172:175], a[28:31]
  v_exp_f32 v213, v101
  v_mfma_f32_16x16x32_bf16 a[88:91], a[172:175], v[184:187], a[88:91]
  buffer_load_dwordx4 v2, s[48:51], s27 offen offset:2048 sc1 lds
  v_add_f32 v224, v224, v210
  v_add_f32 v224, v224, v211
  v_cvt_pk_bf16_f32 v161, v210, v211
  v_mfma_f32_16x16x32_bf16 a[92:95], a[172:175], v[188:191], a[92:95]
  s_waitcnt lgkmcnt(4)
  v_exp_f32 v214, v102
  v_mfma_f32_16x16x32_bf16 a[32:35], a[176:179], v[168:171], a[32:35]
  ds_read_b128 a[144:147], v3 offset:12288
  v_exp_f32 v215, v103
  v_mfma_f32_16x16x32_bf16 a[36:39], a[176:179], v[172:175], a[36:39]
  v_exp_f32 v208, v104
  v_mfma_f32_16x16x32_bf16 a[96:99], a[176:179], v[184:187], a[96:99]
  v_exp_f32 v209, v105
  v_mfma_f32_16x16x32_bf16 a[100:103], a[176:179], v[188:191], a[100:103]
  v_exp_f32 v210, v106
  v_mfma_f32_16x16x32_bf16 a[40:43], a[180:183], v[168:171], a[40:43]
  ds_read_b128 a[148:151], v3 offset:13312
  v_add_f32 v224, v224, v212
  v_add_f32 v224, v224, v213
  v_cvt_pk_bf16_f32 v162, v212, v213
  v_add_f32 v224, v224, v214
  v_add_f32 v224, v224, v215
  v_cvt_pk_bf16_f32 v163, v214, v215
  v_mfma_f32_16x16x32_bf16 a[44:47], a[180:183], v[172:175], a[44:47]
  v_exp_f32 v211, v107
  v_mfma_f32_16x16x32_bf16 a[104:107], a[180:183], v[184:187], a[104:107]
  v_exp_f32 v212, v108
  v_mfma_f32_16x16x32_bf16 a[108:111], a[180:183], v[188:191], a[108:111]
  v_exp_f32 v213, v109
  v_mfma_f32_16x16x32_bf16 a[48:51], a[184:187], v[168:171], a[48:51]
  ds_read_b128 a[152:155], v3 offset:14336
  v_add_f32 v225, v208, v209
  v_cvt_pk_bf16_f32 v164, v208, v209
  v_add_f32 v225, v225, v210
  v_add_f32 v225, v225, v211
  v_cvt_pk_bf16_f32 v165, v210, v211
  v_mfma_f32_16x16x32_bf16 a[52:55], a[184:187], v[172:175], a[52:55]
  v_exp_f32 v214, v110
  v_mfma_f32_16x16x32_bf16 a[112:115], a[184:187], v[184:187], a[112:115]
  buffer_load_dwordx4 v2, s[48:51], s27 offen offset:3072 sc1 lds
  v_max3_f32 v5, v226, v227, v224
  v_add_f32 v225, v225, v212
  v_add_f32 v225, v225, v213
  v_mfma_f32_16x16x32_bf16 a[116:119], a[184:187], v[188:191], a[116:119]
  s_add_u32 s27, s27, 16384
  v_exp_f32 v215, v111
  v_mfma_f32_16x16x32_bf16 a[56:59], a[188:191], v[168:171], a[56:59]
  s_add_u32 s25, s25, 32768
  ds_read_b128 a[156:159], v3 offset:15360
  v_cvt_pk_bf16_f32 v166, v212, v213
  v_add_f32 v225, v225, v214
  v_add_f32 v225, v225, v215
  v_max_f32 v5, v5, v225
  v_cmp_lt_f32 vcc, s81, v5
  v_mfma_f32_16x16x32_bf16 a[60:63], a[188:191], v[172:175], a[60:63]
  s_and_b32 s25, s25, 0x1ffff
  v_exp_f32 v216, v144
  v_mfma_f32_16x16x32_bf16 a[120:123], a[188:191], v[184:187], a[120:123]
  s_waitcnt lgkmcnt(4)
  v_cvt_pk_bf16_f32 v167, v214, v215
  v_add_u32 v3, s66, v2
  v_mfma_f32_16x16x32_bf16 a[124:127], a[188:191], v[188:191], a[124:127]
  s_cbranch_vccnz fa_stub5
fa_back5:
  v_exp_f32 v217, v145
  v_add_f32 v228, v228, v224
  v_add_f32 v229, v229, v225
  v_add_f32 v230, v230, v226
  v_add_f32 v231, v231, v227
fa_AV:
  v_mfma_f32_16x16x32_bf16 v[128:131], a[128:131], v[64:67], v[200:203]
  s_waitcnt vmcnt(12)
  v_exp_f32 v218, v146
  v_mfma_f32_16x16x32_bf16 v[136:139], a[128:131], v[68:71], v[204:207]
  s_barrier
  v_exp_f32 v219, v147
  v_mfma_f32_16x16x32_bf16 v[132:135], a[132:135], v[64:67], v[200:203]
  ds_read_b128 a[160:163], v3 offset:16384
  ds_read_b128 a[164:167], v3 offset:17408
  v_add_f32 v226, v216, v217
  v_mfma_f32_16x16x32_bf16 v[140:143], a[132:135], v[68:71], v[204:207]
  v_exp_f32 v220, v148
  v_mfma_f32_16x16x32_bf16 v[128:131], a[136:139], v[72:75], v[128:131]
  ds_read_b128 a[168:171], v3 offset:18432
  v_cvt_pk_bf16_f32 v184, v216, v217
  v_mfma_f32_16x16x32_bf16 v[136:139], a[136:139], v[76:79], v[136:139]
  s_mov_b32 m0, s24
  v_exp_f32 v221, v149
  v_mfma_f32_16x16x32_bf16 v[132:135], a[140:143], v[72:75], v[132:135]
  ds_read_b128 a[172:175], v3 offset:19456
  buffer_load_dwordx4 v2, s[44:47], s26 offen offset:0 sc1 lds
  v_add_f32 v226, v226, v218
  v_mfma_f32_16x16x32_bf16 v[140:143], a[140:143], v[76:79], v[140:143]
  s_waitcnt lgkmcnt(4)
  v_exp_f32 v222, v150
  v_mfma_f32_16x16x32_bf16 v[128:131], a[144:147], v[80:83], v[128:131]
  ds_read_b128 a[176:179], v3 offset:20480
  v_add_f32 v226, v226, v219
  v_mfma_f32_16x16x32_bf16 v[136:139], a[144:147], v[84:87], v[136:139]
  v_exp_f32 v223, v151
  v_mfma_f32_16x16x32_bf16 v[132:135], a[148:151], v[80:83], v[132:135]
  ds_read_b128 a[180:183], v3 offset:21504
  v_cvt_pk_bf16_f32 v185, v218, v219
  v_mfma_f32_16x16x32_bf16 v[140:143], a[148:151], v[84:87], v[140:143]
  v_add_f32 v226, v226, v220
  v_add_f32 v226, v226, v221
  v_mfma_f32_16x16x32_bf16 v[128:131], a[152:155], v[88:91], v[128:131]
  ds_read_b128 a[184:187], v3 offset:22528
  v_cvt_pk_bf16_f32 v186, v220, v221
  v_mfma_f32_16x16x32_bf16 v[136:139], a[152:155], v[92:95], v[136:139]
  v_exp_f32 v216, v152
  v_mfma_f32_16x16x32_bf16 v[132:135], a[156:159], v[88:91], v[132:135]
  ds_read_b128 a[188:191], v3 offset:23552
  v_add_f32 v226, v226, v222
  v_mfma_f32_16x16x32_bf16 v[140:143], a[156:159], v[92:95], v[140:143]
  s_waitcnt lgkmcnt(4)
  v_exp_f32 v217, v153
  v_mfma_f32_16x16x32_bf16 a[0:3], a[160:163], v[160:163], a[0:3]
  ds_read_b128 a[128:131], v3 offset:0
  v_add_f32 v226, v226, v223
  v_mfma_f32_16x16x32_bf16 a[4:7], a[160:163], v[164:167], a[4:7]
  v_exp_f32 v218, v154
  v_mfma_f32_16x16x32_bf16 a[64:67], a[160:163], v[176:179], a[64:67]
  buffer_load_dwordx4 v2, s[44:47], s26 offen offset:1024 sc1 lds
  v_cvt_pk_bf16_f32 v187, v222, v223
  v_mfma_f32_16x16x32_bf16 a[68:71], a[160:163], v[180:183], a[68:71]
  v_exp_f32 v219, v155
  v_mfma_f32_16x16x32_bf16 a[8:11], a[164:167], v[160:163], a[8:11]
  ds_read_b128 a[132:135], v3 offset:1024
  v_add_f32 v227, v216, v217
  v_mfma_f32_16x16x32_bf16 a[12:15], a[164:167], v[164:167], a[12:15]
  v_exp_f32 v220, v156
  v_mfma_f32_16x16x32_bf16 a[72:75], a[164:167], v[176:179], a[72:75]
  v_exp_f32 v221, v157
  v_mfma_f32_16x16x32_bf16 a[76:79], a[164:167], v[180:183], a[76:79]
  v_cvt_pk_bf16_f32 v188, v216, v217
  v_add_f32 v227, v227, v218
  v_mfma_f32_16x16x32_bf16 a[16:19], a[168:171], v[160:163], a[16:19]
  ds_read_b128 a[136:139], v3 offset:2048
  v_add_f32 v227, v227, v219
  v_mfma_f32_16x16x32_bf16 a[20:23], a[168:171], v[164:167], a[20:23]
  v_exp_f32 v222, v158
  v_mfma_f32_16x16x32_bf16 a[80:83], a[168:171], v[176:179], a[80:83]
  v_exp_f32 v223, v159
  v_mfma_f32_16x16x32_bf16 a[84:87], a[168:171], v[180:183], a[84:87]
  v_cvt_pk_bf16_f32 v189, v218, v219
  v_add_f32 v227, v227, v220
  v_mfma_f32_16x16x32_bf16 a[24:27], a[172:175], v[160:163], a[24:27]
  ds_read_b128 a[140:143], v3 offset:3072
  v_add_f32 v227, v227, v221
  v_mfma_f32_16x16x32_bf16 a[28:31], a[172:175], v[164:167], a[28:31]
  v_cvt_pk_bf16_f32 v190, v220, v221
  v_add_f32 v227, v227, v222
  v_mfma_f32_16x16x32_bf16 a[88:91], a[172:175], v[176:179], a[88:91]
  buffer_load_dwordx4 v2, s[44:47], s26 offen offset:2048 sc1 lds
  v_add_f32 v227, v227, v223
  v_mfma_f32_16x16x32_bf16 a[92:95], a[172:175], v[180:183], a[92:95]
  s_waitcnt lgkmcnt(4)
  v_max_f32 v5, v226, v227
  v_cmp_lt_f32 vcc, s81, v5
  v_mfma_f32_16x16x32_bf16 a[32:35], a[176:179], v[160:163], a[32:35]
  ds_read_b128 a[144:147], v3 offset:4096
  v_mfma_f32_16x16x32_bf16 a[36:39], a[176:179], v[164:167], a[36:39]
  v_mfma_f32_16x16x32_bf16 a[96:99], a[176:179], v[176:179], a[96:99]
  v_mfma_f32_16x16x32_bf16 a[100:103], a[176:179], v[180:183], a[100:103]
  v_mfma_f32_16x16x32_bf16 a[40:43], a[180:183], v[160:163], a[40:43]
  ds_read_b128 a[148:151], v3 offset:5120
  v_mfma_f32_16x16x32_bf16 a[44:47], a[180:183], v[164:167], a[44:47]
  v_mfma_f32_16x16x32_bf16 a[104:107], a[180:183], v[176:179], a[104:107]
  v_mfma_f32_16x16x32_bf16 a[108:111], a[180:183], v[180:183], a[108:111]
  v_mfma_f32_16x16x32_bf16 a[48:51], a[184:187], v[160:163], a[48:51]
  ds_read_b128 a[152:155], v3 offset:6144
  v_mfma_f32_16x16x32_bf16 a[52:55], a[184:187], v[164:167], a[52:55]
  v_mfma_f32_16x16x32_bf16 a[112:115], a[184:187], v[176:179], a[112:115]
  buffer_load_dwordx4 v2, s[44:47], s26 offen offset:3072 sc1 lds
  v_mfma_f32_16x16x32_bf16 a[116:119], a[184:187], v[180:183], a[116:119]
  s_add_u32 s26, s26, 16384
  v_mfma_f32_16x16x32_bf16 a[56:59], a[188:191], v[160:163], a[56:59]
  s_add_u32 s24, s24, 32768
  ds_read_b128 a[156:159], v3 offset:7168
  v_mfma_f32_16x16x32_bf16 a[60:63], a[188:191], v[164:167], a[60:63]
  s_and_b32 s24, s24, 0x1ffff
  v_exp_f32 v216, v128
  v_mfma_f32_16x16x32_bf16 a[120:123], a[188:191], v[176:179], a[120:123]
  s_waitcnt lgkmcnt(4)
  v_cvt_pk_bf16_f32 v191, v222, v223
  v_mfma_f32_16x16x32_bf16 a[124:127], a[188:191], v[180:183], a[124:127]
  s_cbranch_vccnz fa_stub6
fa_back6:
  v_exp_f32 v217, v129
  v_add_f32 v230, v230, v226
  v_add_f32 v231, v231, v227
  v_mfma_f32_16x16x32_bf16 v[144:147], a[128:131], v[64:67], v[200:203]
  ds_read_b128 a[160:163], v3 offset:24576
  v_add_f32 v226, v216, v217
  v_mfma_f32_16x16x32_bf16 v[152:155], a[128:131], v[68:71], v[204:207]
  v_exp_f32 v218, v130
  v_mfma_f32_16x16x32_bf16 v[148:151], a[132:135], v[64:67], v[200:203]
  s_add_u32 s66, s66, 32768
  ds_read_b128 a[164:167], v3 offset:25600
  v_cvt_pk_bf16_f32 v176, v216, v217
  v_mfma_f32_16x16x32_bf16 v[156:159], a[132:135], v[68:71], v[204:207]
  s_mov_b32 m0, s25
  v_exp_f32 v219, v131
  v_mfma_f32_16x16x32_bf16 v[144:147], a[136:139], v[72:75], v[144:147]
  s_and_b32 s66, s66, 0x1ffff
  ds_read_b128 a[168:171], v3 offset:26624
  buffer_load_dwordx4 v2, s[48:51], s27 offen offset:0 sc1 lds
  v_add_f32 v226, v226, v218
  v_add_f32 v226, v226, v219
  v_mfma_f32_16x16x32_bf16 v[152:155], a[136:139], v[76:79], v[152:155]
  v_exp_f32 v220, v132
  v_mfma_f32_16x16x32_bf16 v[148:151], a[140:143], v[72:75], v[148:151]
  ds_read_b128 a[172:175], v3 offset:27648
  v_cvt_pk_bf16_f32 v177, v218, v219
  v_mfma_f32_16x16x32_bf16 v[156:159], a[140:143], v[76:79], v[156:159]
  s_waitcnt lgkmcnt(4)
  v_exp_f32 v221, v133
  v_mfma_f32_16x16x32_bf16 v[144:147], a[144:147], v[80:83], v[144:147]
  ds_read_b128 a[176:179], v3 offset:28672
  v_add_f32 v226, v226, v220
  v_mfma_f32_16x16x32_bf16 v[152:155], a[144:147], v[84:87], v[152:155]
  v_exp_f32 v222, v134
  v_mfma_f32_16x16x32_bf16 v[148:151], a[148:151], v[80:83], v[148:151]
  ds_read_b128 a[180:183], v3 offset:29696
  buffer_load_dwordx4 v2, s[48:51], s27 offen offset:1024 sc1 lds
  v_add_f32 v226, v226, v221
  v_cvt_pk_bf16_f32 v178, v220, v221
  v_mfma_f32_16x16x32_bf16 v[156:159], a[148:151], v[84:87], v[156:159]
  v_exp_f32 v223, v135
  v_mfma_f32_16x16x32_bf16 v[144:147], a[152:155], v[88:91], v[144:147]
  ds_read_b128 a[184:187], v3 offset:30720
  v_add_f32 v226, v226, v222
  v_mfma_f32_16x16x32_bf16 v[152:155], a[152:155], v[92:95], v[152:155]
  v_exp_f32 v216, v136
  v_mfma_f32_16x16x32_bf16 v[148:151], a[156:159], v[88:91], v[148:151]
  ds_read_b128 a[188:191], v3 offset:31744
  v_add_f32 v226, v226, v223
  v_exp_f32 v217, v137
  v_mfma_f32_16x16x32_bf16 v[156:159], a[156:159], v[92:95], v[156:159]
  s_waitcnt lgkmcnt(4)
  v_exp_f32 v218, v138
  v_mfma_f32_16x16x32_bf16 a[64:67], a[160:163], v[184:187], a[64:67]
  ds_read_b128 a[128:131], v3 offset:8192
  v_cvt_pk_bf16_f32 v179, v222, v223
  v_mfma_f32_16x16x32_bf16 a[68:71], a[160:163], v[188:191], a[68:71]
  v_exp_f32 v219, v139
  v_mfma_f32_16x16x32_bf16 a[72:75], a[164:167], v[184:187], a[72:75]
  ds_read_b128 a[132:135], v3 offset:9216
  buffer_load_dwordx4 v2, s[48:51], s27 offen offset:2048 sc1 lds
  v_add_f32 v227, v216, v217
  v_mfma_f32_16x16x32_bf16 a[76:79], a[164:167], v[188:191], a[76:79]
  v_exp_f32 v220, v140
  v_mfma_f32_16x16x32_bf16 a[80:83], a[168:171], v[184:187], a[80:83]
  ds_read_b128 a[136:139], v3 offset:10240
  v_cvt_pk_bf16_f32 v180, v216, v217
  v_mfma_f32_16x16x32_bf16 a[84:87], a[168:171], v[188:191], a[84:87]
  v_exp_f32 v221, v141
  v_mfma_f32_16x16x32_bf16 a[88:91], a[172:175], v[184:187], a[88:91]
  ds_read_b128 a[140:143], v3 offset:11264
  v_add_f32 v227, v227, v218
  v_mfma_f32_16x16x32_bf16 a[92:95], a[172:175], v[188:191], a[92:95]
  s_waitcnt lgkmcnt(4)
  v_exp_f32 v222, v142
  v_mfma_f32_16x16x32_bf16 a[96:99], a[176:179], v[184:187], a[96:99]
  ds_read_b128 a[144:147], v3 offset:12288
  buffer_load_dwordx4 v2, s[48:51], s27 offen offset:3072 sc1 lds
  v_add_f32 v227, v227, v219
  v_cvt_pk_bf16_f32 v181, v218, v219
  v_mfma_f32_16x16x32_bf16 a[100:103], a[176:179], v[188:191], a[100:103]
  s_add_u32 s27, s27, 16384
  v_exp_f32 v223, v143
  v_mfma_f32_16x16x32_bf16 a[104:107], a[180:183], v[184:187], a[104:107]
  s_add_u32 s25, s25, 32768
  ds_read_b128 a[148:151], v3 offset:13312
  v_add_f32 v227, v227, v220
  v_mfma_f32_16x16x32_bf16 a[108:111], a[180:183], v[188:191], a[108:111]
  s_and_b32 s25, s25, 0x1ffff
  v_add_f32 v227, v227, v221
  v_cvt_pk_bf16_f32 v182, v220, v221
  v_add_f32 v227, v227, v222
  v_mfma_f32_16x16x32_bf16 a[112:115], a[184:187], v[184:187], a[112:115]
  ds_read_b128 a[152:155], v3 offset:14336
  v_add_f32 v227, v227, v223
  v_max_f32 v5, v226, v227
  v_cmp_lt_f32 vcc, s81, v5
  v_mfma_f32_16x16x32_bf16 a[116:119], a[184:187], v[188:191], a[116:119]
  v_exp_f32 v216, v144
  v_mfma_f32_16x16x32_bf16 a[120:123], a[188:191], v[184:187], a[120:123]
  s_waitcnt lgkmcnt(3)
  ds_read_b128 a[156:159], v3 offset:15360
  v_cvt_pk_bf16_f32 v183, v222, v223
  v_add_u32 v3, s66, v2
  v_mfma_f32_16x16x32_bf16 a[124:127], a[188:191], v[188:191], a[124:127]
  s_cbranch_vccnz fa_stub7
fa_back7:
  v_exp_f32 v217, v145
  v_add_f32 v230, v230, v226
  v_add_f32 v231, v231, v227
  s_branch fa_SSpre
fa_Aodd:
  v_mfma_f32_16x16x32_bf16 v[128:131], a[128:131], v[64:67], v[200:203]
  s_waitcnt vmcnt(12)
  v_exp_f32 v218, v146
  v_add_f32 v226, v216, v217
  v_mfma_f32_16x16x32_bf16 v[136:139], a[128:131], v[68:71], v[204:207]
  s_barrier
  v_exp_f32 v219, v147
  v_cvt_pk_bf16_f32 v184, v216, v217
  v_mfma_f32_16x16x32_bf16 v[132:135], a[132:135], v[64:67], v[200:203]
  ds_read_b128 a[160:163], v3 offset:16384
  ds_read_b128 a[164:167], v3 offset:17408
  v_exp_f32 v220, v148
  v_mfma_f32_16x16x32_bf16 v[140:143], a[132:135], v[68:71], v[204:207]
  v_exp_f32 v221, v149
  v_add_f32 v226, v226, v218
  v_mfma_f32_16x16x32_bf16 v[128:131], a[136:139], v[72:75], v[128:131]
  ds_read_b128 a[168:171], v3 offset:18432
  v_add_f32 v226, v226, v219
  v_cvt_pk_bf16_f32 v185, v218, v219
  v_mfma_f32_16x16x32_bf16 v[136:139], a[136:139], v[76:79], v[136:139]
  s_mov_b32 m0, s24
  v_exp_f32 v222, v150
  v_add_f32 v226, v226, v220
  v_mfma_f32_16x16x32_bf16 v[132:135], a[140:143], v[72:75], v[132:135]
  ds_read_b128 a[172:175], v3 offset:19456
  buffer_load_dwordx4 v2, s[44:47], s26 offen offset:0 sc1 lds
  v_add_f32 v226, v226, v221
  v_cvt_pk_bf16_f32 v186, v220, v221
  v_mfma_f32_16x16x32_bf16 v[140:143], a[140:143], v[76:79], v[140:143]
  s_waitcnt lgkmcnt(4)
  v_exp_f32 v223, v151
  v_cndmask_b32 v112, v4, v112, s[68:69]
  v_mfma_f32_16x16x32_bf16 v[128:131], a[144:147], v[80:83], v[128:131]
  ds_read_b128 a[176:179], v3 offset:20480
  v_cndmask_b32 v113, v4, v113, s[70:71]
  v_cndmask_b32 v114, v4, v114, s[72:73]
  v_mfma_f32_16x16x32_bf16 v[136:139], a[144:147], v[84:87], v[136:139]
  v_exp_f32 v216, v152
  v_cndmask_b32 v115, v4, v115, s[74:75]
  v_mfma_f32_16x16x32_bf16 v[132:135], a[148:151], v[80:83], v[132:135]
  ds_read_b128 a[180:183], v3 offset:21504
  v_mov_b32 v116, v4
  v_mov_b32 v117, v4
  v_mfma_f32_16x16x32_bf16 v[140:143], a[148:151], v[84:87], v[140:143]
  v_exp_f32 v217, v153
  v_mov_b32 v118, v4
  v_mfma_f32_16x16x32_bf16 v[128:131], a[152:155], v[88:91], v[128:131]
  ds_read_b128 a[184:187], v3 offset:22528
  v_mov_b32 v119, v4
  v_cndmask_b32 v124, v4, v124, s[68:69]
  v_mfma_f32_16x16x32_bf16 v[136:139], a[152:155], v[92:95], v[136:139]
  v_exp_f32 v218, v154
  v_cndmask_b32 v125, v4, v125, s[70:71]
  v_mfma_f32_16x16x32_bf16 v[132:135], a[156:159], v[88:91], v[132:135]
  ds_read_b128 a[188:191], v3 offset:23552
  v_cndmask_b32 v126, v4, v126, s[72:73]
  v_cndmask_b32 v127, v4, v127, s[74:75]
  v_mfma_f32_16x16x32_bf16 v[140:143], a[156:159], v[92:95], v[140:143]
  s_waitcnt lgkmcnt(4)
  v_exp_f32 v219, v155
  v_add_f32 v226, v226, v222
  v_mfma_f32_16x16x32_bf16 a[0:3], a[160:163], v[160:163], a[0:3]
  ds_read_b128 a[128:131], v3 offset:0
  v_add_f32 v226, v226, v223
  v_cvt_pk_bf16_f32 v187, v222, v223
  v_mfma_f32_16x16x32_bf16 a[4:7], a[160:163], v[164:167], a[4:7]
  v_exp_f32 v220, v156
  v_add_f32 v227, v216, v217
  v_mfma_f32_16x16x32_bf16 a[64:67], a[160:163], v[176:179], a[64:67]
  buffer_load_dwordx4 v2, s[44:47], s26 offen offset:1024 sc1 lds
  v_exp_f32 v221, v157
  v_mfma_f32_16x16x32_bf16 a[68:71], a[160:163], v[180:183], a[68:71]
  v_exp_f32 v222, v158
  v_mfma_f32_16x16x32_bf16 a[8:11], a[164:167], v[160:163], a[8:11]
  ds_read_b128 a[132:135], v3 offset:1024
  v_cvt_pk_bf16_f32 v188, v216, v217
  v_add_f32 v227, v227, v218
  v_add_f32 v227, v227, v219
  v_mfma_f32_16x16x32_bf16 a[12:15], a[164:167], v[164:167], a[12:15]
  v_exp_f32 v223, v159
  v_mfma_f32_16x16x32_bf16 a[72:75], a[164:167], v[176:179], a[72:75]
  v_exp_f32 v208, v112
  v_mfma_f32_16x16x32_bf16 a[76:79], a[164:167], v[180:183], a[76:79]
  v_exp_f32 v209, v113
  v_mfma_f32_16x16x32_bf16 a[16:19], a[168:171], v[160:163], a[16:19]
  ds_read_b128 a[136:139], v3 offset:2048
  v_cvt_pk_bf16_f32 v189, v218, v219
  v_add_f32 v227, v227, v220
  v_add_f32 v227, v227, v221
  v_cvt_pk_bf16_f32 v190, v220, v221
  v_add_f32 v227, v227, v222
  v_mfma_f32_16x16x32_bf16 a[20:23], a[168:171], v[164:167], a[20:23]
  v_exp_f32 v210, v114
  v_mfma_f32_16x16x32_bf16 a[80:83], a[168:171], v[176:179], a[80:83]
  v_exp_f32 v211, v115
  v_mfma_f32_16x16x32_bf16 a[84:87], a[168:171], v[180:183], a[84:87]
  v_exp_f32 v212, v116
  v_mfma_f32_16x16x32_bf16 a[24:27], a[172:175], v[160:163], a[24:27]
  ds_read_b128 a[140:143], v3 offset:3072
  v_add_f32 v227, v227, v223
  v_cvt_pk_bf16_f32 v191, v222, v223
  v_add_f32 v224, v208, v209
  v_cvt_pk_bf16_f32 v168, v208, v209
  v_add_f32 v224, v224, v210
  v_mfma_f32_16x16x32_bf16 a[28:31], a[172:175], v[164:167], a[28:31]
  v_exp_f32 v213, v117
  v_mfma_f32_16x16x32_bf16 a[88:91], a[172:175], v[176:179], a[88:91]
  buffer_load_dwordx4 v2, s[44:47], s26 offen offset:2048 sc1 lds
  v_exp_f32 v214, v118
  v_mfma_f32_16x16x32_bf16 a[92:95], a[172:175], v[180:183], a[92:95]
  s_waitcnt lgkmcnt(4)
  v_exp_f32 v215, v119
  v_mfma_f32_16x16x32_bf16 a[32:35], a[176:179], v[160:163], a[32:35]
  ds_read_b128 a[144:147], v3 offset:4096
  v_add_f32 v224, v224, v211
  v_cvt_pk_bf16_f32 v169, v210, v211
  v_add_f32 v224, v224, v212
  v_add_f32 v224, v224, v213
  v_mfma_f32_16x16x32_bf16 a[36:39], a[176:179], v[164:167], a[36:39]
  v_exp_f32 v208, v120
  v_mfma_f32_16x16x32_bf16 a[96:99], a[176:179], v[176:179], a[96:99]
  v_exp_f32 v209, v121
  v_mfma_f32_16x16x32_bf16 a[100:103], a[176:179], v[180:183], a[100:103]
  v_exp_f32 v210, v122
  v_mfma_f32_16x16x32_bf16 a[40:43], a[180:183], v[160:163], a[40:43]
  ds_read_b128 a[148:151], v3 offset:5120
  v_cvt_pk_bf16_f32 v170, v212, v213
  v_add_f32 v224, v224, v214
  v_add_f32 v224, v224, v215
  v_cvt_pk_bf16_f32 v171, v214, v215
  v_add_f32 v225, v208, v209
  v_mfma_f32_16x16x32_bf16 a[44:47], a[180:183], v[164:167], a[44:47]
  v_exp_f32 v211, v123
  v_mfma_f32_16x16x32_bf16 a[104:107], a[180:183], v[176:179], a[104:107]
  v_exp_f32 v212, v124
  v_mfma_f32_16x16x32_bf16 a[108:111], a[180:183], v[180:183], a[108:111]
  v_exp_f32 v213, v125
  v_mfma_f32_16x16x32_bf16 a[48:51], a[184:187], v[160:163], a[48:51]
  ds_read_b128 a[152:155], v3 offset:6144
  v_cvt_pk_bf16_f32 v172, v208, v209
  v_add_f32 v225, v225, v210
  v_add_f32 v225, v225, v211
  v_cvt_pk_bf16_f32 v173, v210, v211
  v_max3_f32 v5, v226, v227, v224
  v_mfma_f32_16x16x32_bf16 a[52:55], a[184:187], v[164:167], a[52:55]
  v_exp_f32 v214, v126
  v_mfma_f32_16x16x32_bf16 a[112:115], a[184:187], v[176:179], a[112:115]
  buffer_load_dwordx4 v2, s[44:47], s26 offen offset:3072 sc1 lds
  v_add_f32 v225, v225, v212
  v_add_f32 v225, v225, v213
  v_cvt_pk_bf16_f32 v174, v212, v213
  v_mfma_f32_16x16x32_bf16 a[116:119], a[184:187], v[180:183], a[116:119]
  s_add_u32 s26, s26, 16384
  v_exp_f32 v215, v127
  v_mfma_f32_16x16x32_bf16 a[56:59], a[188:191], v[160:163], a[56:59]
  s_add_u32 s24, s24, 32768
  ds_read_b128 a[156:159], v3 offset:7168
  v_add_f32 v225, v225, v214
  v_add_f32 v225, v225, v215
  v_max_f32 v5, v5, v225
  v_cmp_lt_f32 vcc, s81, v5
  v_mfma_f32_16x16x32_bf16 a[60:63], a[188:191], v[164:167], a[60:63]
  s_and_b32 s24, s24, 0x1ffff
  v_exp_f32 v216, v128
  v_mfma_f32_16x16x32_bf16 a[120:123], a[188:191], v[176:179], a[120:123]
  s_waitcnt lgkmcnt(4)
  v_cvt_pk_bf16_f32 v175, v214, v215
  v_mfma_f32_16x16x32_bf16 a[124:127], a[188:191], v[180:183], a[124:127]
  s_cbranch_vccnz fa_stub8
fa_back8:
  v_exp_f32 v217, v129
  v_add_f32 v228, v228, v224
  v_add_f32 v229, v229, v225
  v_add_f32 v230, v230, v226
  v_add_f32 v231, v231, v227
  v_mfma_f32_16x16x32_bf16 v[144:147], a[128:131], v[64:67], v[200:203]
  ds_read_b128 a[160:163], v3 offset:24576
  v_add_f32 v226, v216, v217
  v_mfma_f32_16x16x32_bf16 v[152:155], a[128:131], v[68:71], v[204:207]
  v_exp_f32 v218, v130
  v_mfma_f32_16x16x32_bf16 v[148:151], a[132:135], v[64:67], v[200:203]
  s_add_u32 s66, s66, 32768
  ds_read_b128 a[164:167], v3 offset:25600
  v_cvt_pk_bf16_f32 v176, v216, v217
  v_mfma_f32_16x16x32_bf16 v[156:159], a[132:135], v[68:71], v[204:207]
  s_and_b32 s66, s66, 0x1ffff
  v_exp_f32 v219, v131
  v_mfma_f32_16x16x32_bf16 v[144:147], a[136:139], v[72:75], v[144:147]
  ds_read_b128 a[168:171], v3 offset:26624
  v_add_f32 v226, v226, v218
  v_mfma_f32_16x16x32_bf16 v[152:155], a[136:139], v[76:79], v[152:155]
  s_mov_b32 m0, s25
  v_exp_f32 v220, v132
  v_mfma_f32_16x16x32_bf16 v[148:151], a[140:143], v[72:75], v[148:151]
  ds_read_b128 a[172:175], v3 offset:27648
  buffer_load_dwordx4 v2, s[48:51], s27 offen offset:0 sc1 lds
  v_add_f32 v226, v226, v219
  v_mfma_f32_16x16x32_bf16 v[156:159], a[140:143], v[76:79], v[156:159]
  s_waitcnt lgkmcnt(4)
  v_exp_f32 v221, v133
  v_mfma_f32_16x16x32_bf16 v[144:147], a[144:147], v[80:83], v[144:147]
  ds_read_b128 a[176:179], v3 offset:28672
  v_cvt_pk_bf16_f32 v177, v218, v219
  v_mfma_f32_16x16x32_bf16 v[152:155], a[144:147], v[84:87], v[152:155]
  v_exp_f32 v222, v134
  v_mfma_f32_16x16x32_bf16 v[148:151], a[148:151], v[80:83], v[148:151]
  ds_read_b128 a[180:183], v3 offset:29696
  v_add_f32 v226, v226, v220
  v_mfma_f32_16x16x32_bf16 v[156:159], a[148:151], v[84:87], v[156:159]
  v_exp_f32 v223, v135
  v_mfma_f32_16x16x32_bf16 v[144:147], a[152:155], v[88:91], v[144:147]
  ds_read_b128 a[184:187], v3 offset:30720
  v_add_f32 v226, v226, v221
  v_mfma_f32_16x16x32_bf16 v[152:155], a[152:155], v[92:95], v[152:155]
  v_exp_f32 v216, v136
  v_mfma_f32_16x16x32_bf16 v[148:151], a[156:159], v[88:91], v[148:151]
  ds_read_b128 a[188:191], v3 offset:31744
  v_cvt_pk_bf16_f32 v178, v220, v221
  v_mfma_f32_16x16x32_bf16 v[156:159], a[156:159], v[92:95], v[156:159]
  s_waitcnt lgkmcnt(4)
  v_exp_f32 v217, v137
  v_mfma_f32_16x16x32_bf16 a[0:3], a[160:163], v[168:171], a[0:3]
  ds_read_b128 a[128:131], v3 offset:8192
  v_add_f32 v226, v226, v222
  v_mfma_f32_16x16x32_bf16 a[4:7], a[160:163], v[172:175], a[4:7]
  v_exp_f32 v218, v138
  v_mfma_f32_16x16x32_bf16 a[64:67], a[160:163], v[184:187], a[64:67]
  buffer_load_dwordx4 v2, s[48:51], s27 offen offset:1024 sc1 lds
  v_add_f32 v226, v226, v223
  v_mfma_f32_16x16x32_bf16 a[68:71], a[160:163], v[188:191], a[68:71]
  v_exp_f32 v219, v139
  v_mfma_f32_16x16x32_bf16 a[8:11], a[164:167], v[168:171], a[8:11]
  ds_read_b128 a[132:135], v3 offset:9216
  v_cvt_pk_bf16_f32 v179, v222, v223
  v_mfma_f32_16x16x32_bf16 a[12:15], a[164:167], v[172:175], a[12:15]
  v_exp_f32 v220, v140
  v_mfma_f32_16x16x32_bf16 a[72:75], a[164:167], v[184:187], a[72:75]
  v_add_f32 v227, v216, v217
  v_cvt_pk_bf16_f32 v180, v216, v217
  v_mfma_f32_16x16x32_bf16 a[76:79], a[164:167], v[188:191], a[76:79]
  v_exp_f32 v221, v141
  v_mfma_f32_16x16x32_bf16 a[16:19], a[168:171], v[168:171], a[16:19]
  ds_read_b128 a[136:139], v3 offset:10240
  v_add_f32 v227, v227, v218
  v_mfma_f32_16x16x32_bf16 a[20:23], a[168:171], v[172:175], a[20:23]
  v_exp_f32 v222, v142
  v_mfma_f32_16x16x32_bf16 a[80:83], a[168:171], v[184:187], a[80:83]
  v_add_f32 v227, v227, v219
  v_cvt_pk_bf16_f32 v181, v218, v219
  v_mfma_f32_16x16x32_bf16 a[84:87], a[168:171], v[188:191], a[84:87]
  v_exp_f32 v223, v143
  v_mfma_f32_16x16x32_bf16 a[24:27], a[172:175], v[168:171], a[24:27]
  ds_read_b128 a[140:143], v3 offset:11264
  v_add_f32 v227, v227, v220
  v_mfma_f32_16x16x32_bf16 a[28:31], a[172:175], v[172:175], a[28:31]
  v_add_f32 v227, v227, v221
  v_cvt_pk_bf16_f32 v182, v220, v221
  v_mfma_f32_16x16x32_bf16 a[88:91], a[172:175], v[184:187], a[88:91]
  buffer_load_dwordx4 v2, s[48:51], s27 offen offset:2048 sc1 lds
  v_add_f32 v227, v227, v222
  v_mfma_f32_16x16x32_bf16 a[92:95], a[172:175], v[188:191], a[92:95]
  s_waitcnt lgkmcnt(4)
  v_add_f32 v227, v227, v223
  v_max_f32 v5, v226, v227
  v_mfma_f32_16x16x32_bf16 a[32:35], a[176:179], v[168:171], a[32:35]
  ds_read_b128 a[144:147], v3 offset:12288
  v_cmp_lt_f32 vcc, s81, v5
  v_mfma_f32_16x16x32_bf16 a[36:39], a[176:179], v[172:175], a[36:39]
  v_mfma_f32_16x16x32_bf16 a[96:99], a[176:179], v[184:187], a[96:99]
  v_mfma_f32_16x16x32_bf16 a[100:103], a[176:179], v[188:191], a[100:103]
  v_mfma_f32_16x16x32_bf16 a[40:43], a[180:183], v[168:171], a[40:43]
  ds_read_b128 a[148:151], v3 offset:13312
  v_mfma_f32_16x16x32_bf16 a[44:47], a[180:183], v[172:175], a[44:47]
  v_mfma_f32_16x16x32_bf16 a[104:107], a[180:183], v[184:187], a[104:107]
  v_mfma_f32_16x16x32_bf16 a[108:111], a[180:183], v[188:191], a[108:111]
  v_mfma_f32_16x16x32_bf16 a[48:51], a[184:187], v[168:171], a[48:51]
  ds_read_b128 a[152:155], v3 offset:14336
  v_mfma_f32_16x16x32_bf16 a[52:55], a[184:187], v[172:175], a[52:55]
  v_mfma_f32_16x16x32_bf16 a[112:115], a[184:187], v[184:187], a[112:115]
  buffer_load_dwordx4 v2, s[48:51], s27 offen offset:3072 sc1 lds
  v_mfma_f32_16x16x32_bf16 a[116:119], a[184:187], v[188:191], a[116:119]
  s_add_u32 s27, s27, 16384
  v_mfma_f32_16x16x32_bf16 a[56:59], a[188:191], v[168:171], a[56:59]
  s_add_u32 s25, s25, 32768
  ds_read_b128 a[156:159], v3 offset:15360
  v_mfma_f32_16x16x32_bf16 a[60:63], a[188:191], v[172:175], a[60:63]
  s_and_b32 s25, s25, 0x1ffff
  v_exp_f32 v216, v144
  v_mfma_f32_16x16x32_bf16 a[120:123], a[188:191], v[184:187], a[120:123]
  s_waitcnt lgkmcnt(4)
  v_cvt_pk_bf16_f32 v183, v222, v223
  v_add_u32 v3, s66, v2
  v_mfma_f32_16x16x32_bf16 a[124:127], a[188:191], v[188:191], a[124:127]
  s_cbranch_vccnz fa_stub9
fa_back9:
  v_exp_f32 v217, v145
  v_add_f32 v230, v230, v226
  v_add_f32 v231, v231, v227
fa_SSpre:
  s_mov_b32 s11, 1
  s_cmp_lg_u32 s12, 0
  s_cselect_b32 s32, s15, s32
  s_cmp_ge_u32 s20, 2
  s_cselect_b32 s23, 8, 0
  s_cmp_le_u32 s29, s23
  s_cbranch_scc1 fa_chain
.p2align 6
fa_SS:
  v_mfma_f32_16x16x32_bf16 v[128:131], a[128:131], v[64:67], v[200:203]
  s_waitcnt vmcnt(12)
  v_exp_f32 v218, v146
  v_mfma_f32_16x16x32_bf16 v[136:139], a[128:131], v[68:71], v[204:207]
  s_barrier
  v_exp_f32 v219, v147
  v_mfma_f32_16x16x32_bf16 v[132:135], a[132:135], v[64:67], v[200:203]
  s_cmp_ge_u32 s26, s32
  ds_read_b128 a[160:163], v3 offset:16384
  ds_read_b128 a[164:167], v3 offset:17408
  v_add_f32 v226, v216, v217
  v_mfma_f32_16x16x32_bf16 v[140:143], a[132:135], v[68:71], v[204:207]
  s_cbranch_scc1 fa_hk7
fa_hb7:
  v_exp_f32 v220, v148
  v_mfma_f32_16x16x32_bf16 v[128:131], a[136:139], v[72:75], v[128:131]
  ds_read_b128 a[168:171], v3 offset:18432
  v_cvt_pk_bf16_f32 v184, v216, v217
  v_mfma_f32_16x16x32_bf16 v[136:139], a[136:139], v[76:79], v[136:139]
  s_mov_b32 m0, s24
  v_exp_f32 v221, v149
  v_mfma_f32_16x16x32_bf16 v[132:135], a[140:143], v[72:75], v[132:135]
  ds_read_b128 a[172:175], v3 offset:19456
  buffer_load_dwordx4 v2, s[44:47], s26 offen offset:0 sc1 lds
  v_add_f32 v226, v226, v218
  v_add_f32 v226, v226, v219
  v_mfma_f32_16x16x32_bf16 v[140:143], a[140:143], v[76:79], v[140:143]
  s_waitcnt lgkmcnt(4)
  v_exp_f32 v222, v150
  v_mfma_f32_16x16x32_bf16 v[128:131], a[144:147], v[80:83], v[128:131]
  ds_read_b128 a[176:179], v3 offset:20480
  v_cvt_pk_bf16_f32 v185, v218, v219
  v_mfma_f32_16x16x32_bf16 v[136:139], a[144:147], v[84:87], v[136:139]
  v_exp_f32 v223, v151
  v_mfma_f32_16x16x32_bf16 v[132:135], a[148:151], v[80:83], v[132:135]
  ds_read_b128 a[180:183], v3 offset:21504
  v_add_f32 v226, v226, v220
  v_mfma_f32_16x16x32_bf16 v[140:143], a[148:151], v[84:87], v[140:143]
  v_exp_f32 v216, v152
  v_mfma_f32_16x16x32_bf16 v[128:131], a[152:155], v[88:91], v[128:131]
  ds_read_b128 a[184:187], v3 offset:22528
  buffer_load_dwordx4 v2, s[44:47], s26 offen offset:1024 sc1 lds
  v_add_f32 v226, v226, v221
  v_cvt_pk_bf16_f32 v186, v220, v221
  v_mfma_f32_16x16x32_bf16 v[136:139], a[152:155], v[92:95], v[136:139]
  v_exp_f32 v217, v153
  v_mfma_f32_16x16x32_bf16 v[132:135], a[156:159], v[88:91], v[132:135]
  ds_read_b128 a[188:191], v3 offset:23552
  v_add_f32 v226, v226, v222
  v_mfma_f32_16x16x32_bf16 v[140:143], a[156:159], v[92:95], v[140:143]
  s_waitcnt lgkmcnt(4)
  v_exp_f32 v218, v154
  v_mfma_f32_16x16x32_bf16 a[64:67], a[160:163], v[176:179], a[64:67]
  ds_read_b128 a[128:131], v3 offset:0
  v_add_f32 v226, v226, v223
  v_cvt_pk_bf16_f32 v187, v222, v223
  v_mfma_f32_16x16x32_bf16 a[68:71], a[160:163], v[180:183], a[68:71]
  v_exp_f32 v219, v155
  v_mfma_f32_16x16x32_bf16 a[72:75], a[164:167], v[176:179], a[72:75]
  ds_read_b128 a[132:135], v3 offset:1024
  buffer_load_dwordx4 v2, s[44:47], s26 offen offset:2048 sc1 lds
  v_add_f32 v227, v216, v217
  v_mfma_f32_16x16x32_bf16 a[76:79], a[164:167], v[180:183], a[76:79]
  v_exp_f32 v220, v156
  v_mfma_f32_16x16x32_bf16 a[80:83], a[168:171], v[176:179], a[80:83]
  ds_read_b128 a[136:139], v3 offset:2048
  v_cvt_pk_bf16_f32 v188, v216, v217
  v_mfma_f32_16x16x32_bf16 a[84:87], a[168:171], v[180:183], a[84:87]
  v_exp_f32 v221, v157
  v_mfma_f32_16x16x32_bf16 a[88:91], a[172:175], v[176:179], a[88:91]
  ds_read_b128 a[140:143], v3 offset:3072
  v_add_f32 v227, v227, v218
  v_add_f32 v227, v227, v219
  v_mfma_f32_16x16x32_bf16 a[92:95], a[172:175], v[180:183], a[92:95]
  s_waitcnt lgkmcnt(4)
  v_exp_f32 v222, v158
  v_mfma_f32_16x16x32_bf16 a[96:99], a[176:179], v[176:179], a[96:99]
  ds_read_b128 a[144:147], v3 offset:4096
  buffer_load_dwordx4 v2, s[44:47], s26 offen offset:3072 sc1 lds
  v_cvt_pk_bf16_f32 v189, v218, v219
  v_mfma_f32_16x16x32_bf16 a[100:103], a[176:179], v[180:183], a[100:103]
  s_add_u32 s26, s26, 16384
  v_exp_f32 v223, v159
  v_mfma_f32_16x16x32_bf16 a[104:107], a[180:183], v[176:179], a[104:107]
  s_add_u32 s24, s24, 32768
  ds_read_b128 a[148:151], v3 offset:5120
  v_add_f32 v227, v227, v220
  v_mfma_f32_16x16x32_bf16 a[108:111], a[180:183], v[180:183], a[108:111]
  s_and_b32 s24, s24, 0x1ffff
  v_add_f32 v227, v227, v221
  v_cvt_pk_bf16_f32 v190, v220, v221
  v_add_f32 v227, v227, v222
  v_mfma_f32_16x16x32_bf16 a[112:115], a[184:187], v[176:179], a[112:115]
  ds_read_b128 a[152:155], v3 offset:6144
  v_add_f32 v227, v227, v223
  v_max_f32 v5, v226, v227
  v_cmp_lt_f32 vcc, s81, v5
  v_mfma_f32_16x16x32_bf16 a[116:119], a[184:187], v[180:183], a[116:119]
  v_exp_f32 v216, v128
  v_mfma_f32_16x16x32_bf16 a[120:123], a[188:191], v[176:179], a[120:123]
  s_waitcnt lgkmcnt(3)
  ds_read_b128 a[156:159], v3 offset:7168
  v_cvt_pk_bf16_f32 v191, v222, v223
  v_mfma_f32_16x16x32_bf16 a[124:127], a[188:191], v[180:183], a[124:127]
  s_cbranch_vccnz fa_stub10
fa_back10:
  v_exp_f32 v217, v129
  v_add_f32 v230, v230, v226
  v_add_f32 v231, v231, v227
  v_mfma_f32_16x16x32_bf16 v[144:147], a[128:131], v[64:67], v[200:203]
  ds_read_b128 a[160:163], v3 offset:24576
  v_add_f32 v226, v216, v217
  v_mfma_f32_16x16x32_bf16 v[152:155], a[128:131], v[68:71], v[204:207]
  v_exp_f32 v218, v130
  v_mfma_f32_16x16x32_bf16 v[148:151], a[132:135], v[64:67], v[200:203]
  s_add_u32 s66, s66, 32768
  ds_read_b128 a[164:167], v3 offset:25600
  v_cvt_pk_bf16_f32 v176, v216, v217
  v_mfma_f32_16x16x32_bf16 v[156:159], a[132:135], v[68:71], v[204:207]
  s_mov_b32 m0, s25
  v_exp_f32 v219, v131
  v_mfma_f32_16x16x32_bf16 v[144:147], a[136:139], v[72:75], v[144:147]
  s_and_b32 s66, s66, 0x1ffff
  ds_read_b128 a[168:171], v3 offset:26624
  buffer_load_dwordx4 v2, s[48:51], s27 offen offset:0 sc1 lds
  v_add_f32 v226, v226, v218
  v_add_f32 v226, v226, v219
  v_mfma_f32_16x16x32_bf16 v[152:155], a[136:139], v[76:79], v[152:155]
  v_exp_f32 v220, v132
  v_mfma_f32_16x16x32_bf16 v[148:151], a[140:143], v[72:75], v[148:151]
  ds_read_b128 a[172:175], v3 offset:27648
  v_cvt_pk_bf16_f32 v177, v218, v219
  v_mfma_f32_16x16x32_bf16 v[156:159], a[140:143], v[76:79], v[156:159]
  s_waitcnt lgkmcnt(4)
  v_exp_f32 v221, v133
  v_mfma_f32_16x16x32_bf16 v[144:147], a[144:147], v[80:83], v[144:147]
  ds_read_b128 a[176:179], v3 offset:28672
  v_add_f32 v226, v226, v220
  v_mfma_f32_16x16x32_bf16 v[152:155], a[144:147], v[84:87], v[152:155]
  v_exp_f32 v222, v134
  v_mfma_f32_16x16x32_bf16 v[148:151], a[148:151], v[80:83], v[148:151]
  ds_read_b128 a[180:183], v3 offset:29696
  buffer_load_dwordx4 v2, s[48:51], s27 offen offset:1024 sc1 lds
  v_add_f32 v226, v226, v221
  v_cvt_pk_bf16_f32 v178, v220, v221
  v_mfma_f32_16x16x32_bf16 v[156:159], a[148:151], v[84:87], v[156:159]
  v_exp_f32 v223, v135
  v_mfma_f32_16x16x32_bf16 v[144:147], a[152:155], v[88:91], v[144:147]
  ds_read_b128 a[184:187], v3 offset:30720
  v_add_f32 v226, v226, v222
  v_mfma_f32_16x16x32_bf16 v[152:155], a[152:155], v[92:95], v[152:155]
  v_exp_f32 v216, v136
  v_mfma_f32_16x16x32_bf16 v[148:151], a[156:159], v[88:91], v[148:151]
  ds_read_b128 a[188:191], v3 offset:31744
  v_add_f32 v226, v226, v223
  v_exp_f32 v217, v137
  v_mfma_f32_16x16x32_bf16 v[156:159], a[156:159], v[92:95], v[156:159]
  s_waitcnt lgkmcnt(4)
  v_exp_f32 v218, v138
  v_mfma_f32_16x16x32_bf16 a[64:67], a[160:163], v[184:187], a[64:67]
  ds_read_b128 a[128:131], v3 offset:8192
  v_cvt_pk_bf16_f32 v179, v222, v223
  v_mfma_f32_16x16x32_bf16 a[68:71], a[160:163], v[188:191], a[68:71]
  v_exp_f32 v219, v139
  v_mfma_f32_16x16x32_bf16 a[72:75], a[164:167], v[184:187], a[72:75]
  ds_read_b128 a[132:135], v3 offset:9216
  buffer_load_dwordx4 v2, s[48:51], s27 offen offset:2048 sc1 lds
  v_add_f32 v227, v216, v217
  v_mfma_f32_16x16x32_bf16 a[76:79], a[164:167], v[188:191], a[76:79]
  v_exp_f32 v220, v140
  v_mfma_f32_16x16x32_bf16 a[80:83], a[168:171], v[184:187], a[80:83]
  ds_read_b128 a[136:139], v3 offset:10240
  v_cvt_pk_bf16_f32 v180, v216, v217
  v_mfma_f32_16x16x32_bf16 a[84:87], a[168:171], v[188:191], a[84:87]
  v_exp_f32 v221, v141
  v_mfma_f32_16x16x32_bf16 a[88:91], a[172:175], v[184:187], a[88:91]
  ds_read_b128 a[140:143], v3 offset:11264
  v_add_f32 v227, v227, v218
  v_mfma_f32_16x16x32_bf16 a[92:95], a[172:175], v[188:191], a[92:95]
  s_waitcnt lgkmcnt(4)
  v_exp_f32 v222, v142
  v_mfma_f32_16x16x32_bf16 a[96:99], a[176:179], v[184:187], a[96:99]
  ds_read_b128 a[144:147], v3 offset:12288
  buffer_load_dwordx4 v2, s[48:51], s27 offen offset:3072 sc1 lds
  v_add_f32 v227, v227, v219
  v_cvt_pk_bf16_f32 v181, v218, v219
  v_mfma_f32_16x16x32_bf16 a[100:103], a[176:179], v[188:191], a[100:103]
  s_add_u32 s27, s27, 16384
  v_exp_f32 v223, v143
  v_mfma_f32_16x16x32_bf16 a[104:107], a[180:183], v[184:187], a[104:107]
  s_add_u32 s25, s25, 32768
  ds_read_b128 a[148:151], v3 offset:13312
  v_add_f32 v227, v227, v220
  v_mfma_f32_16x16x32_bf16 a[108:111], a[180:183], v[188:191], a[108:111]
  s_and_b32 s25, s25, 0x1ffff
  v_add_f32 v227, v227, v221
  v_cvt_pk_bf16_f32 v182, v220, v221
  v_add_f32 v227, v227, v222
  v_mfma_f32_16x16x32_bf16 a[112:115], a[184:187], v[184:187], a[112:115]
  s_sub_u32 s29, s29, 1
  ds_read_b128 a[152:155], v3 offset:14336
  v_add_f32 v227, v227, v223
  v_max_f32 v5, v226, v227
  v_cmp_lt_f32 vcc, s81, v5
  v_mfma_f32_16x16x32_bf16 a[116:119], a[184:187], v[188:191], a[116:119]
  s_cmp_gt_u32 s29, 8
  v_exp_f32 v216, v144
  v_mfma_f32_16x16x32_bf16 a[120:123], a[188:191], v[184:187], a[120:123]
  s_waitcnt lgkmcnt(3)
  ds_read_b128 a[156:159], v3 offset:15360
  v_cvt_pk_bf16_f32 v183, v222, v223
  v_add_u32 v3, s66, v2
  v_mfma_f32_16x16x32_bf16 a[124:127], a[188:191], v[188:191], a[124:127]
  s_cbranch_vccnz fa_stub11
fa_back11:
  v_exp_f32 v217, v145
  v_add_f32 v230, v230, v226
  v_add_f32 v231, v231, v227
  s_cbranch_scc1 fa_SS
fa_chain:
fa_hb8:
  s_cmp_lt_u32 s12, 2
  s_cbranch_scc1 fa_hk8
  s_cmp_eq_u32 s29, 8
  s_cbranch_scc0 fa_disp
fa_SSW8:
  v_mfma_f32_16x16x32_bf16 v[128:131], a[128:131], v[64:67], v[200:203]
  s_waitcnt vmcnt(12)
  v_exp_f32 v218, v146
  v_mfma_f32_16x16x32_bf16 v[136:139], a[128:131], v[68:71], v[204:207]
  s_barrier
  v_exp_f32 v219, v147
  v_mfma_f32_16x16x32_bf16 v[132:135], a[132:135], v[64:67], v[200:203]
  ds_read_b128 a[160:163], v3 offset:16384
  ds_read_b128 a[164:167], v3 offset:17408
  v_add_f32 v226, v216, v217
  v_mfma_f32_16x16x32_bf16 v[140:143], a[132:135], v[68:71], v[204:207]
  s_mov_b32 m0, s24
  v_exp_f32 v220, v148
  v_mfma_f32_16x16x32_bf16 v[128:131], a[136:139], v[72:75], v[128:131]
  ds_read_b128 a[168:171], v3 offset:18432
  buffer_load_dwordx4 v2, s[44:47], s26 offen offset:0 sc1 lds
  v_cvt_pk_bf16_f32 v184, v216, v217
  v_mfma_f32_16x16x32_bf16 v[136:139], a[136:139], v[76:79], v[136:139]
  v_exp_f32 v221, v149
  v_mfma_f32_16x16x32_bf16 v[132:135], a[140:143], v[72:75], v[132:135]
  ds_read_b128 a[172:175], v3 offset:19456
  v_add_f32 v226, v226, v218
  v_add_f32 v226, v226, v219
  v_mfma_f32_16x16x32_bf16 v[140:143], a[140:143], v[76:79], v[140:143]
  s_waitcnt lgkmcnt(4)
  v_exp_f32 v222, v150
  v_mfma_f32_16x16x32_bf16 v[128:131], a[144:147], v[80:83], v[128:131]
  s_add_u32 s14, s13, 0
  ds_read_b128 a[176:179], v3 offset:20480
  buffer_load_dwordx4 a[0:3], v2, s[40:43], s14 offen offset:0 sc1
  v_cvt_pk_bf16_f32 v185, v218, v219
  v_mfma_f32_16x16x32_bf16 v[136:139], a[144:147], v[84:87], v[136:139]
  v_exp_f32 v223, v151
  v_mfma_f32_16x16x32_bf16 v[132:135], a[148:151], v[80:83], v[132:135]
  ds_read_b128 a[180:183], v3 offset:21504
  buffer_load_dwordx4 v2, s[44:47], s26 offen offset:1024 sc1 lds
  v_add_f32 v226, v226, v220
  v_mfma_f32_16x16x32_bf16 v[140:143], a[148:151], v[84:87], v[140:143]
  v_exp_f32 v216, v152
  v_mfma_f32_16x16x32_bf16 v[128:131], a[152:155], v[88:91], v[128:131]
  ds_read_b128 a[184:187], v3 offset:22528
  v_add_f32 v226, v226, v221
  v_cvt_pk_bf16_f32 v186, v220, v221
  v_mfma_f32_16x16x32_bf16 v[136:139], a[152:155], v[92:95], v[136:139]
  v_exp_f32 v217, v153
  v_mfma_f32_16x16x32_bf16 v[132:135], a[156:159], v[88:91], v[132:135]
  ds_read_b128 a[188:191], v3 offset:23552
  buffer_load_dwordx4 a[4:7], v2, s[40:43], s14 offen offset:1024 sc1
  v_add_f32 v226, v226, v222
  v_mfma_f32_16x16x32_bf16 v[140:143], a[156:159], v[92:95], v[140:143]
  s_waitcnt lgkmcnt(4)
  v_exp_f32 v218, v154
  v_mfma_f32_16x16x32_bf16 a[64:67], a[160:163], v[176:179], a[64:67]
  ds_read_b128 a[128:131], v3 offset:0
  v_add_f32 v226, v226, v223
  v_cvt_pk_bf16_f32 v187, v222, v223
  v_mfma_f32_16x16x32_bf16 a[68:71], a[160:163], v[180:183], a[68:71]
  v_exp_f32 v219, v155
  v_mfma_f32_16x16x32_bf16 a[72:75], a[164:167], v[176:179], a[72:75]
  ds_read_b128 a[132:135], v3 offset:1024
  buffer_load_dwordx4 v2, s[44:47], s26 offen offset:2048 sc1 lds
  v_add_f32 v227, v216, v217
  v_mfma_f32_16x16x32_bf16 a[76:79], a[164:167], v[180:183], a[76:79]
  v_exp_f32 v220, v156
  v_mfma_f32_16x16x32_bf16 a[80:83], a[168:171], v[176:179], a[80:83]
  ds_read_b128 a[136:139], v3 offset:2048
  v_cvt_pk_bf16_f32 v188, v216, v217
  v_mfma_f32_16x16x32_bf16 a[84:87], a[168:171], v[180:183], a[84:87]
  v_exp_f32 v221, v157
  v_mfma_f32_16x16x32_bf16 a[88:91], a[172:175], v[176:179], a[88:91]
  ds_read_b128 a[140:143], v3 offset:3072
  buffer_load_dwordx4 a[8:11], v2, s[40:43], s14 offen offset:2048 sc1
  v_add_f32 v227, v227, v218
  v_add_f32 v227, v227, v219
  v_mfma_f32_16x16x32_bf16 a[92:95], a[172:175], v[180:183], a[92:95]
  s_waitcnt lgkmcnt(4)
  v_exp_f32 v222, v158
  v_mfma_f32_16x16x32_bf16 a[96:99], a[176:179], v[176:179], a[96:99]
  ds_read_b128 a[144:147], v3 offset:4096
  buffer_load_dwordx4 v2, s[44:47], s26 offen offset:3072 sc1 lds
  v_cvt_pk_bf16_f32 v189, v218, v219
  v_mfma_f32_16x16x32_bf16 a[100:103], a[176:179], v[180:183], a[100:103]
  s_add_u32 s26, s26, 16384
  v_exp_f32 v223, v159
  v_mfma_f32_16x16x32_bf16 a[104:107], a[180:183], v[176:179], a[104:107]
  s_add_u32 s24, s24, 32768
  ds_read_b128 a[148:151], v3 offset:5120
  v_add_f32 v227, v227, v220
  v_mfma_f32_16x16x32_bf16 a[108:111], a[180:183], v[180:183], a[108:111]
  s_and_b32 s24, s24, 0x1ffff
  v_add_f32 v227, v227, v221
  v_cvt_pk_bf16_f32 v190, v220, v221
  v_add_f32 v227, v227, v222
  v_mfma_f32_16x16x32_bf16 a[112:115], a[184:187], v[176:179], a[112:115]
  ds_read_b128 a[152:155], v3 offset:6144
  v_add_f32 v227, v227, v223
  v_max_f32 v5, v226, v227
  v_cmp_lt_f32 vcc, s81, v5
  v_mfma_f32_16x16x32_bf16 a[116:119], a[184:187], v[180:183], a[116:119]
  v_exp_f32 v216, v128
  v_mfma_f32_16x16x32_bf16 a[120:123], a[188:191], v[176:179], a[120:123]
  s_waitcnt lgkmcnt(3)
  ds_read_b128 a[156:159], v3 offset:7168
  v_cvt_pk_bf16_f32 v191, v222, v223
  v_mfma_f32_16x16x32_bf16 a[124:127], a[188:191], v[180:183], a[124:127]
  s_cbranch_vccnz fa_stub12
fa_back12:
  v_exp_f32 v217, v129
  v_add_f32 v230, v230, v226
  v_add_f32 v231, v231, v227
  v_mfma_f32_16x16x32_bf16 v[144:147], a[128:131], v[64:67], v[200:203]
  ds_read_b128 a[160:163], v3 offset:24576
  v_add_f32 v226, v216, v217
  v_mfma_f32_16x16x32_bf16 v[152:155], a[128:131], v[68:71], v[204:207]
  v_exp_f32 v218, v130
  v_mfma_f32_16x16x32_bf16 v[148:151], a[132:135], v[64:67], v[200:203]
  s_add_u32 s66, s66, 32768
  ds_read_b128 a[164:167], v3 offset:25600
  v_cvt_pk_bf16_f32 v176, v216, v217
  v_mfma_f32_16x16x32_bf16 v[156:159], a[132:135], v[68:71], v[204:207]
  s_mov_b32 m0, s25
  v_exp_f32 v219, v131
  v_mfma_f32_16x16x32_bf16 v[144:147], a[136:139], v[72:75], v[144:147]
  s_and_b32 s66, s66, 0x1ffff
  ds_read_b128 a[168:171], v3 offset:26624
  buffer_load_dwordx4 v2, s[48:51], s27 offen offset:0 sc1 lds
  v_add_f32 v226, v226, v218
  v_add_f32 v226, v226, v219
  v_mfma_f32_16x16x32_bf16 v[152:155], a[136:139], v[76:79], v[152:155]
  v_exp_f32 v220, v132
  v_mfma_f32_16x16x32_bf16 v[148:151], a[140:143], v[72:75], v[148:151]
  ds_read_b128 a[172:175], v3 offset:27648
  v_cvt_pk_bf16_f32 v177, v218, v219
  v_mfma_f32_16x16x32_bf16 v[156:159], a[140:143], v[76:79], v[156:159]
  s_waitcnt lgkmcnt(4)
  v_exp_f32 v221, v133
  v_mfma_f32_16x16x32_bf16 v[144:147], a[144:147], v[80:83], v[144:147]
  s_add_u32 s14, s13, 0
  ds_read_b128 a[176:179], v3 offset:28672
  buffer_load_dwordx4 a[12:15], v2, s[40:43], s14 offen offset:3072 sc1
  v_add_f32 v226, v226, v220
  v_mfma_f32_16x16x32_bf16 v[152:155], a[144:147], v[84:87], v[152:155]
  v_exp_f32 v222, v134
  v_mfma_f32_16x16x32_bf16 v[148:151], a[148:151], v[80:83], v[148:151]
  ds_read_b128 a[180:183], v3 offset:29696
  buffer_load_dwordx4 v2, s[48:51], s27 offen offset:1024 sc1 lds
  v_add_f32 v226, v226, v221
  v_cvt_pk_bf16_f32 v178, v220, v221
  v_mfma_f32_16x16x32_bf16 v[156:159], a[148:151], v[84:87], v[156:159]
  v_exp_f32 v223, v135
  v_mfma_f32_16x16x32_bf16 v[144:147], a[152:155], v[88:91], v[144:147]
  ds_read_b128 a[184:187], v3 offset:30720
  v_add_f32 v226, v226, v222
  v_mfma_f32_16x16x32_bf16 v[152:155], a[152:155], v[92:95], v[152:155]
  v_exp_f32 v216, v136
  v_mfma_f32_16x16x32_bf16 v[148:151], a[156:159], v[88:91], v[148:151]
  s_add_u32 s14, s13, 4096
  ds_read_b128 a[188:191], v3 offset:31744
  buffer_load_dwordx4 a[16:19], v2, s[40:43], s14 offen offset:0 sc1
  v_add_f32 v226, v226, v223
  v_exp_f32 v217, v137
  v_mfma_f32_16x16x32_bf16 v[156:159], a[156:159], v[92:95], v[156:159]
  s_waitcnt lgkmcnt(4)
  v_exp_f32 v218, v138
  v_mfma_f32_16x16x32_bf16 a[64:67], a[160:163], v[184:187], a[64:67]
  ds_read_b128 a[128:131], v3 offset:8192
  v_cvt_pk_bf16_f32 v179, v222, v223
  v_mfma_f32_16x16x32_bf16 a[68:71], a[160:163], v[188:191], a[68:71]
  v_exp_f32 v219, v139
  v_mfma_f32_16x16x32_bf16 a[72:75], a[164:167], v[184:187], a[72:75]
  ds_read_b128 a[132:135], v3 offset:9216
  buffer_load_dwordx4 v2, s[48:51], s27 offen offset:2048 sc1 lds
  v_add_f32 v227, v216, v217
  v_mfma_f32_16x16x32_bf16 a[76:79], a[164:167], v[188:191], a[76:79]
  v_exp_f32 v220, v140
  v_mfma_f32_16x16x32_bf16 a[80:83], a[168:171], v[184:187], a[80:83]
  ds_read_b128 a[136:139], v3 offset:10240
  v_cvt_pk_bf16_f32 v180, v216, v217
  v_mfma_f32_16x16x32_bf16 a[84:87], a[168:171], v[188:191], a[84:87]
  v_exp_f32 v221, v141
  v_mfma_f32_16x16x32_bf16 a[88:91], a[172:175], v[184:187], a[88:91]
  ds_read_b128 a[140:143], v3 offset:11264
  buffer_load_dwordx4 a[20:23], v2, s[40:43], s14 offen offset:1024 sc1
  v_add_f32 v227, v227, v218
  v_mfma_f32_16x16x32_bf16 a[92:95], a[172:175], v[188:191], a[92:95]
  s_waitcnt lgkmcnt(4)
  v_exp_f32 v222, v142
  v_mfma_f32_16x16x32_bf16 a[96:99], a[176:179], v[184:187], a[96:99]
  ds_read_b128 a[144:147], v3 offset:12288
  buffer_load_dwordx4 v2, s[48:51], s27 offen offset:3072 sc1 lds
  v_add_f32 v227, v227, v219
  v_cvt_pk_bf16_f32 v181, v218, v219
  v_mfma_f32_16x16x32_bf16 a[100:103], a[176:179], v[188:191], a[100:103]
  s_add_u32 s27, s27, 16384
  v_exp_f32 v223, v143
  v_mfma_f32_16x16x32_bf16 a[104:107], a[180:183], v[184:187], a[104:107]
  s_add_u32 s25, s25, 32768
  ds_read_b128 a[148:151], v3 offset:13312
  v_add_f32 v227, v227, v220
  v_mfma_f32_16x16x32_bf16 a[108:111], a[180:183], v[188:191], a[108:111]
  s_and_b32 s25, s25, 0x1ffff
  v_add_f32 v227, v227, v221
  v_cvt_pk_bf16_f32 v182, v220, v221
  v_add_f32 v227, v227, v222
  v_mfma_f32_16x16x32_bf16 a[112:115], a[184:187], v[184:187], a[112:115]
  ds_read_b128 a[152:155], v3 offset:14336
  v_add_f32 v227, v227, v223
  v_max_f32 v5, v226, v227
  v_cmp_lt_f32 vcc, s81, v5
  v_mfma_f32_16x16x32_bf16 a[116:119], a[184:187], v[188:191], a[116:119]
  v_exp_f32 v216, v144
  v_mfma_f32_16x16x32_bf16 a[120:123], a[188:191], v[184:187], a[120:123]
  s_waitcnt lgkmcnt(3)
  ds_read_b128 a[156:159], v3 offset:15360
  v_cvt_pk_bf16_f32 v183, v222, v223
  v_add_u32 v3, s66, v2
  v_mfma_f32_16x16x32_bf16 a[124:127], a[188:191], v[188:191], a[124:127]
  s_cbranch_vccnz fa_stub13
fa_back13:
  v_exp_f32 v217, v145
  v_add_f32 v230, v230, v226
  v_add_f32 v231, v231, v227
fa_SSW7:
  v_mfma_f32_16x16x32_bf16 v[128:131], a[128:131], v[64:67], v[200:203]
  s_waitcnt vmcnt(12)
  v_exp_f32 v218, v146
  v_mfma_f32_16x16x32_bf16 v[136:139], a[128:131], v[68:71], v[204:207]
  s_barrier
  v_exp_f32 v219, v147
  v_mfma_f32_16x16x32_bf16 v[132:135], a[132:135], v[64:67], v[200:203]
  ds_read_b128 a[160:163], v3 offset:16384
  ds_read_b128 a[164:167], v3 offset:17408
  v_add_f32 v226, v216, v217
  v_mfma_f32_16x16x32_bf16 v[140:143], a[132:135], v[68:71], v[204:207]
  s_mov_b32 m0, s24
  v_exp_f32 v220, v148
  v_mfma_f32_16x16x32_bf16 v[128:131], a[136:139], v[72:75], v[128:131]
  ds_read_b128 a[168:171], v3 offset:18432
  buffer_load_dwordx4 v2, s[44:47], s26 offen offset:0 sc1 lds
  v_cvt_pk_bf16_f32 v184, v216, v217
  v_mfma_f32_16x16x32_bf16 v[136:139], a[136:139], v[76:79], v[136:139]
  v_exp_f32 v221, v149
  v_mfma_f32_16x16x32_bf16 v[132:135], a[140:143], v[72:75], v[132:135]
  ds_read_b128 a[172:175], v3 offset:19456
  v_add_f32 v226, v226, v218
  v_add_f32 v226, v226, v219
  v_mfma_f32_16x16x32_bf16 v[140:143], a[140:143], v[76:79], v[140:143]
  s_waitcnt lgkmcnt(4)
  v_exp_f32 v222, v150
  v_mfma_f32_16x16x32_bf16 v[128:131], a[144:147], v[80:83], v[128:131]
  s_add_u32 s14, s13, 4096
  ds_read_b128 a[176:179], v3 offset:20480
  buffer_load_dwordx4 a[24:27], v2, s[40:43], s14 offen offset:2048 sc1
  v_cvt_pk_bf16_f32 v185, v218, v219
  v_mfma_f32_16x16x32_bf16 v[136:139], a[144:147], v[84:87], v[136:139]
  v_exp_f32 v223, v151
  v_mfma_f32_16x16x32_bf16 v[132:135], a[148:151], v[80:83], v[132:135]
  ds_read_b128 a[180:183], v3 offset:21504
  buffer_load_dwordx4 v2, s[44:47], s26 offen offset:1024 sc1 lds
  v_add_f32 v226, v226, v220
  v_mfma_f32_16x16x32_bf16 v[140:143], a[148:151], v[84:87], v[140:143]
  v_exp_f32 v216, v152
  v_mfma_f32_16x16x32_bf16 v[128:131], a[152:155], v[88:91], v[128:131]
  ds_read_b128 a[184:187], v3 offset:22528
  v_add_f32 v226, v226, v221
  v_cvt_pk_bf16_f32 v186, v220, v221
  v_mfma_f32_16x16x32_bf16 v[136:139], a[152:155], v[92:95], v[136:139]
  v_exp_f32 v217, v153
  v_mfma_f32_16x16x32_bf16 v[132:135], a[156:159], v[88:91], v[132:135]
  ds_read_b128 a[188:191], v3 offset:23552
  buffer_load_dwordx4 a[28:31], v2, s[40:43], s14 offen offset:3072 sc1
  v_add_f32 v226, v226, v222
  v_mfma_f32_16x16x32_bf16 v[140:143], a[156:159], v[92:95], v[140:143]
  s_waitcnt lgkmcnt(4)
  v_exp_f32 v218, v154
  v_mfma_f32_16x16x32_bf16 a[64:67], a[160:163], v[176:179], a[64:67]
  ds_read_b128 a[128:131], v3 offset:0
  v_add_f32 v226, v226, v223
  v_cvt_pk_bf16_f32 v187, v222, v223
  v_mfma_f32_16x16x32_bf16 a[68:71], a[160:163], v[180:183], a[68:71]
  v_exp_f32 v219, v155
  v_mfma_f32_16x16x32_bf16 a[72:75], a[164:167], v[176:179], a[72:75]
  ds_read_b128 a[132:135], v3 offset:1024
  buffer_load_dwordx4 v2, s[44:47], s26 offen offset:2048 sc1 lds
  v_add_f32 v227, v216, v217
  v_mfma_f32_16x16x32_bf16 a[76:79], a[164:167], v[180:183], a[76:79]
  v_exp_f32 v220, v156
  v_mfma_f32_16x16x32_bf16 a[80:83], a[168:171], v[176:179], a[80:83]
  ds_read_b128 a[136:139], v3 offset:2048
  v_cvt_pk_bf16_f32 v188, v216, v217
  v_mfma_f32_16x16x32_bf16 a[84:87], a[168:171], v[180:183], a[84:87]
  v_exp_f32 v221, v157
  v_mfma_f32_16x16x32_bf16 a[88:91], a[172:175], v[176:179], a[88:91]
  s_add_u32 s14, s13, 8192
  ds_read_b128 a[140:143], v3 offset:3072
  buffer_load_dwordx4 a[32:35], v2, s[40:43], s14 offen offset:0 sc1
  v_add_f32 v227, v227, v218
  v_add_f32 v227, v227, v219
  v_mfma_f32_16x16x32_bf16 a[92:95], a[172:175], v[180:183], a[92:95]
  s_waitcnt lgkmcnt(4)
  v_exp_f32 v222, v158
  v_mfma_f32_16x16x32_bf16 a[96:99], a[176:179], v[176:179], a[96:99]
  ds_read_b128 a[144:147], v3 offset:4096
  buffer_load_dwordx4 v2, s[44:47], s26 offen offset:3072 sc1 lds
  v_cvt_pk_bf16_f32 v189, v218, v219
  v_mfma_f32_16x16x32_bf16 a[100:103], a[176:179], v[180:183], a[100:103]
  s_add_u32 s26, s26, 16384
  v_exp_f32 v223, v159
  v_mfma_f32_16x16x32_bf16 a[104:107], a[180:183], v[176:179], a[104:107]
  s_add_u32 s24, s24, 32768
  ds_read_b128 a[148:151], v3 offset:5120
  v_add_f32 v227, v227, v220
  v_mfma_f32_16x16x32_bf16 a[108:111], a[180:183], v[180:183], a[108:111]
  s_and_b32 s24, s24, 0x1ffff
  v_add_f32 v227, v227, v221
  v_cvt_pk_bf16_f32 v190, v220, v221
  v_add_f32 v227, v227, v222
  v_mfma_f32_16x16x32_bf16 a[112:115], a[184:187], v[176:179], a[112:115]
  ds_read_b128 a[152:155], v3 offset:6144
  v_add_f32 v227, v227, v223
  v_max_f32 v5, v226, v227
  v_cmp_lt_f32 vcc, s81, v5
  v_mfma_f32_16x16x32_bf16 a[116:119], a[184:187], v[180:183], a[116:119]
  v_exp_f32 v216, v128
  v_mfma_f32_16x16x32_bf16 a[120:123], a[188:191], v[176:179], a[120:123]
  s_waitcnt lgkmcnt(3)
  ds_read_b128 a[156:159], v3 offset:7168
  v_cvt_pk_bf16_f32 v191, v222, v223
  v_mfma_f32_16x16x32_bf16 a[124:127], a[188:191], v[180:183], a[124:127]
  s_cbranch_vccnz fa_stub14
fa_back14:
  v_exp_f32 v217, v129
  v_add_f32 v230, v230, v226
  v_add_f32 v231, v231, v227
  v_mfma_f32_16x16x32_bf16 v[144:147], a[128:131], v[64:67], v[200:203]
  ds_read_b128 a[160:163], v3 offset:24576
  v_add_f32 v226, v216, v217
  v_mfma_f32_16x16x32_bf16 v[152:155], a[128:131], v[68:71], v[204:207]
  v_exp_f32 v218, v130
  v_mfma_f32_16x16x32_bf16 v[148:151], a[132:135], v[64:67], v[200:203]
  s_add_u32 s66, s66, 32768
  ds_read_b128 a[164:167], v3 offset:25600
  v_cvt_pk_bf16_f32 v176, v216, v217
  v_mfma_f32_16x16x32_bf16 v[156:159], a[132:135], v[68:71], v[204:207]
  s_mov_b32 m0, s25
  v_exp_f32 v219, v131
  v_mfma_f32_16x16x32_bf16 v[144:147], a[136:139], v[72:75], v[144:147]
  s_and_b32 s66, s66, 0x1ffff
  ds_read_b128 a[168:171], v3 offset:26624
  buffer_load_dwordx4 v2, s[48:51], s27 offen offset:0 sc1 lds
  v_add_f32 v226, v226, v218
  v_add_f32 v226, v226, v219
  v_mfma_f32_16x16x32_bf16 v[152:155], a[136:139], v[76:79], v[152:155]
  v_exp_f32 v220, v132
  v_mfma_f32_16x16x32_bf16 v[148:151], a[140:143], v[72:75], v[148:151]
  ds_read_b128 a[172:175], v3 offset:27648
  v_cvt_pk_bf16_f32 v177, v218, v219
  v_mfma_f32_16x16x32_bf16 v[156:159], a[140:143], v[76:79], v[156:159]
  s_waitcnt lgkmcnt(4)
  v_exp_f32 v221, v133
  v_mfma_f32_16x16x32_bf16 v[144:147], a[144:147], v[80:83], v[144:147]
  s_add_u32 s14, s13, 8192
  ds_read_b128 a[176:179], v3 offset:28672
  buffer_load_dwordx4 a[36:39], v2, s[40:43], s14 offen offset:1024 sc1
  v_add_f32 v226, v226, v220
  v_mfma_f32_16x16x32_bf16 v[152:155], a[144:147], v[84:87], v[152:155]
  v_exp_f32 v222, v134
  v_mfma_f32_16x16x32_bf16 v[148:151], a[148:151], v[80:83], v[148:151]
  ds_read_b128 a[180:183], v3 offset:29696
  buffer_load_dwordx4 v2, s[48:51], s27 offen offset:1024 sc1 lds
  v_add_f32 v226, v226, v221
  v_cvt_pk_bf16_f32 v178, v220, v221
  v_mfma_f32_16x16x32_bf16 v[156:159], a[148:151], v[84:87], v[156:159]
  v_exp_f32 v223, v135
  v_mfma_f32_16x16x32_bf16 v[144:147], a[152:155], v[88:91], v[144:147]
  ds_read_b128 a[184:187], v3 offset:30720
  v_add_f32 v226, v226, v222
  v_mfma_f32_16x16x32_bf16 v[152:155], a[152:155], v[92:95], v[152:155]
  v_exp_f32 v216, v136
  v_mfma_f32_16x16x32_bf16 v[148:151], a[156:159], v[88:91], v[148:151]
  ds_read_b128 a[188:191], v3 offset:31744
  buffer_load_dwordx4 a[40:43], v2, s[40:43], s14 offen offset:2048 sc1
  v_add_f32 v226, v226, v223
  v_exp_f32 v217, v137
  v_mfma_f32_16x16x32_bf16 v[156:159], a[156:159], v[92:95], v[156:159]
  s_waitcnt lgkmcnt(4)
  v_exp_f32 v218, v138
  v_mfma_f32_16x16x32_bf16 a[64:67], a[160:163], v[184:187], a[64:67]
  ds_read_b128 a[128:131], v3 offset:8192
  v_cvt_pk_bf16_f32 v179, v222, v223
  v_mfma_f32_16x16x32_bf16 a[68:71], a[160:163], v[188:191], a[68:71]
  v_exp_f32 v219, v139
  v_mfma_f32_16x16x32_bf16 a[72:75], a[164:167], v[184:187], a[72:75]
  ds_read_b128 a[132:135], v3 offset:9216
  buffer_load_dwordx4 v2, s[48:51], s27 offen offset:2048 sc1 lds
  v_add_f32 v227, v216, v217
  v_mfma_f32_16x16x32_bf16 a[76:79], a[164:167], v[188:191], a[76:79]
  v_exp_f32 v220, v140
  v_mfma_f32_16x16x32_bf16 a[80:83], a[168:171], v[184:187], a[80:83]
  ds_read_b128 a[136:139], v3 offset:10240
  v_cvt_pk_bf16_f32 v180, v216, v217
  v_mfma_f32_16x16x32_bf16 a[84:87], a[168:171], v[188:191], a[84:87]
  v_exp_f32 v221, v141
  v_mfma_f32_16x16x32_bf16 a[88:91], a[172:175], v[184:187], a[88:91]
  ds_read_b128 a[140:143], v3 offset:11264
  buffer_load_dwordx4 a[44:47], v2, s[40:43], s14 offen offset:3072 sc1
  v_add_f32 v227, v227, v218
  v_mfma_f32_16x16x32_bf16 a[92:95], a[172:175], v[188:191], a[92:95]
  s_waitcnt lgkmcnt(4)
  v_exp_f32 v222, v142
  v_mfma_f32_16x16x32_bf16 a[96:99], a[176:179], v[184:187], a[96:99]
  ds_read_b128 a[144:147], v3 offset:12288
  buffer_load_dwordx4 v2, s[48:51], s27 offen offset:3072 sc1 lds
  v_add_f32 v227, v227, v219
  v_cvt_pk_bf16_f32 v181, v218, v219
  v_mfma_f32_16x16x32_bf16 a[100:103], a[176:179], v[188:191], a[100:103]
  s_add_u32 s27, s27, 16384
  v_exp_f32 v223, v143
  v_mfma_f32_16x16x32_bf16 a[104:107], a[180:183], v[184:187], a[104:107]
  s_add_u32 s25, s25, 32768
  ds_read_b128 a[148:151], v3 offset:13312
  v_add_f32 v227, v227, v220
  v_mfma_f32_16x16x32_bf16 a[108:111], a[180:183], v[188:191], a[108:111]
  s_and_b32 s25, s25, 0x1ffff
  v_add_f32 v227, v227, v221
  v_cvt_pk_bf16_f32 v182, v220, v221
  v_add_f32 v227, v227, v222
  v_mfma_f32_16x16x32_bf16 a[112:115], a[184:187], v[184:187], a[112:115]
  ds_read_b128 a[152:155], v3 offset:14336
  v_add_f32 v227, v227, v223
  v_max_f32 v5, v226, v227
  v_cmp_lt_f32 vcc, s81, v5
  v_mfma_f32_16x16x32_bf16 a[116:119], a[184:187], v[188:191], a[116:119]
  v_exp_f32 v216, v144
  v_mfma_f32_16x16x32_bf16 a[120:123], a[188:191], v[184:187], a[120:123]
  s_waitcnt lgkmcnt(3)
  ds_read_b128 a[156:159], v3 offset:15360
  v_cvt_pk_bf16_f32 v183, v222, v223
  v_add_u32 v3, s66, v2
  v_mfma_f32_16x16x32_bf16 a[124:127], a[188:191], v[188:191], a[124:127]
  s_cbranch_vccnz fa_stub15
fa_back15:
  v_exp_f32 v217, v145
  v_add_f32 v230, v230, v226
  v_add_f32 v231, v231, v227
fa_SSW6:
  v_mfma_f32_16x16x32_bf16 v[128:131], a[128:131], v[64:67], v[200:203]
  s_waitcnt vmcnt(12)
  v_exp_f32 v218, v146
  v_mfma_f32_16x16x32_bf16 v[136:139], a[128:131], v[68:71], v[204:207]
  s_barrier
  v_exp_f32 v219, v147
  v_mfma_f32_16x16x32_bf16 v[132:135], a[132:135], v[64:67], v[200:203]
  ds_read_b128 a[160:163], v3 offset:16384
  ds_read_b128 a[164:167], v3 offset:17408
  v_add_f32 v226, v216, v217
  v_mfma_f32_16x16x32_bf16 v[140:143], a[132:135], v[68:71], v[204:207]
  s_mov_b32 m0, s24
  v_exp_f32 v220, v148
  v_mfma_f32_16x16x32_bf16 v[128:131], a[136:139], v[72:75], v[128:131]
  ds_read_b128 a[168:171], v3 offset:18432
  buffer_load_dwordx4 v2, s[44:47], s26 offen offset:0 sc1 lds
  v_cvt_pk_bf16_f32 v184, v216, v217
  v_mfma_f32_16x16x32_bf16 v[136:139], a[136:139], v[76:79], v[136:139]
  v_exp_f32 v221, v149
  v_mfma_f32_16x16x32_bf16 v[132:135], a[140:143], v[72:75], v[132:135]
  ds_read_b128 a[172:175], v3 offset:19456
  v_add_f32 v226, v226, v218
  v_add_f32 v226, v226, v219
  v_mfma_f32_16x16x32_bf16 v[140:143], a[140:143], v[76:79], v[140:143]
  s_waitcnt lgkmcnt(4)
  v_exp_f32 v222, v150
  v_mfma_f32_16x16x32_bf16 v[128:131], a[144:147], v[80:83], v[128:131]
  s_add_u32 s14, s13, 12288
  ds_read_b128 a[176:179], v3 offset:20480
  buffer_load_dwordx4 a[48:51], v2, s[40:43], s14 offen offset:0 sc1
  v_cvt_pk_bf16_f32 v185, v218, v219
  v_mfma_f32_16x16x32_bf16 v[136:139], a[144:147], v[84:87], v[136:139]
  v_exp_f32 v223, v151
  v_mfma_f32_16x16x32_bf16 v[132:135], a[148:151], v[80:83], v[132:135]
  ds_read_b128 a[180:183], v3 offset:21504
  buffer_load_dwordx4 v2, s[44:47], s26 offen offset:1024 sc1 lds
  v_add_f32 v226, v226, v220
  v_mfma_f32_16x16x32_bf16 v[140:143], a[148:151], v[84:87], v[140:143]
  v_exp_f32 v216, v152
  v_mfma_f32_16x16x32_bf16 v[128:131], a[152:155], v[88:91], v[128:131]
  ds_read_b128 a[184:187], v3 offset:22528
  v_add_f32 v226, v226, v221
  v_cvt_pk_bf16_f32 v186, v220, v221
  v_mfma_f32_16x16x32_bf16 v[136:139], a[152:155], v[92:95], v[136:139]
  v_exp_f32 v217, v153
  v_mfma_f32_16x16x32_bf16 v[132:135], a[156:159], v[88:91], v[132:135]
  ds_read_b128 a[188:191], v3 offset:23552
  buffer_load_dwordx4 a[52:55], v2, s[40:43], s14 offen offset:1024 sc1
  v_add_f32 v226, v226, v222
  v_mfma_f32_16x16x32_bf16 v[140:143], a[156:159], v[92:95], v[140:143]
  s_waitcnt lgkmcnt(4)
  v_exp_f32 v218, v154
  v_mfma_f32_16x16x32_bf16 a[64:67], a[160:163], v[176:179], a[64:67]
  ds_read_b128 a[128:131], v3 offset:0
  v_add_f32 v226, v226, v223
  v_cvt_pk_bf16_f32 v187, v222, v223
  v_mfma_f32_16x16x32_bf16 a[68:71], a[160:163], v[180:183], a[68:71]
  v_exp_f32 v219, v155
  v_mfma_f32_16x16x32_bf16 a[72:75], a[164:167], v[176:179], a[72:75]
  ds_read_b128 a[132:135], v3 offset:1024
  buffer_load_dwordx4 v2, s[44:47], s26 offen offset:2048 sc1 lds
  v_add_f32 v227, v216, v217
  v_mfma_f32_16x16x32_bf16 a[76:79], a[164:167], v[180:183], a[76:79]
  v_exp_f32 v220, v156
  v_mfma_f32_16x16x32_bf16 a[80:83], a[168:171], v[176:179], a[80:83]
  ds_read_b128 a[136:139], v3 offset:2048
  v_cvt_pk_bf16_f32 v188, v216, v217
  v_mfma_f32_16x16x32_bf16 a[84:87], a[168:171], v[180:183], a[84:87]
  v_exp_f32 v221, v157
  v_mfma_f32_16x16x32_bf16 a[88:91], a[172:175], v[176:179], a[88:91]
  ds_read_b128 a[140:143], v3 offset:3072
  buffer_load_dwordx4 a[56:59], v2, s[40:43], s14 offen offset:2048 sc1
  v_add_f32 v227, v227, v218
  v_add_f32 v227, v227, v219
  v_mfma_f32_16x16x32_bf16 a[92:95], a[172:175], v[180:183], a[92:95]
  s_waitcnt lgkmcnt(4)
  v_exp_f32 v222, v158
  v_mfma_f32_16x16x32_bf16 a[96:99], a[176:179], v[176:179], a[96:99]
  ds_read_b128 a[144:147], v3 offset:4096
  buffer_load_dwordx4 v2, s[44:47], s26 offen offset:3072 sc1 lds
  v_cvt_pk_bf16_f32 v189, v218, v219
  v_mfma_f32_16x16x32_bf16 a[100:103], a[176:179], v[180:183], a[100:103]
  s_add_u32 s26, s26, 16384
  v_exp_f32 v223, v159
  v_mfma_f32_16x16x32_bf16 a[104:107], a[180:183], v[176:179], a[104:107]
  s_add_u32 s24, s24, 32768
  ds_read_b128 a[148:151], v3 offset:5120
  v_add_f32 v227, v227, v220
  v_mfma_f32_16x16x32_bf16 a[108:111], a[180:183], v[180:183], a[108:111]
  s_and_b32 s24, s24, 0x1ffff
  v_add_f32 v227, v227, v221
  v_cvt_pk_bf16_f32 v190, v220, v221
  v_add_f32 v227, v227, v222
  v_mfma_f32_16x16x32_bf16 a[112:115], a[184:187], v[176:179], a[112:115]
  ds_read_b128 a[152:155], v3 offset:6144
  v_add_f32 v227, v227, v223
  v_max_f32 v5, v226, v227
  v_cmp_lt_f32 vcc, s81, v5
  v_mfma_f32_16x16x32_bf16 a[116:119], a[184:187], v[180:183], a[116:119]
  v_exp_f32 v216, v128
  v_mfma_f32_16x16x32_bf16 a[120:123], a[188:191], v[176:179], a[120:123]
  s_waitcnt lgkmcnt(3)
  ds_read_b128 a[156:159], v3 offset:7168
  v_cvt_pk_bf16_f32 v191, v222, v223
  v_mfma_f32_16x16x32_bf16 a[124:127], a[188:191], v[180:183], a[124:127]
  s_cbranch_vccnz fa_stub16
fa_back16:
  v_exp_f32 v217, v129
  v_add_f32 v230, v230, v226
  v_add_f32 v231, v231, v227
  v_mfma_f32_16x16x32_bf16 v[144:147], a[128:131], v[64:67], v[200:203]
  ds_read_b128 a[160:163], v3 offset:24576
  v_add_f32 v226, v216, v217
  v_mfma_f32_16x16x32_bf16 v[152:155], a[128:131], v[68:71], v[204:207]
  v_exp_f32 v218, v130
  v_mfma_f32_16x16x32_bf16 v[148:151], a[132:135], v[64:67], v[200:203]
  s_add_u32 s66, s66, 32768
  ds_read_b128 a[164:167], v3 offset:25600
  v_cvt_pk_bf16_f32 v176, v216, v217
  v_mfma_f32_16x16x32_bf16 v[156:159], a[132:135], v[68:71], v[204:207]
  s_mov_b32 m0, s25
  v_exp_f32 v219, v131
  v_mfma_f32_16x16x32_bf16 v[144:147], a[136:139], v[72:75], v[144:147]
  s_and_b32 s66, s66, 0x1ffff
  ds_read_b128 a[168:171], v3 offset:26624
  buffer_load_dwordx4 v2, s[48:51], s27 offen offset:0 sc1 lds
  v_add_f32 v226, v226, v218
  v_add_f32 v226, v226, v219
  v_mfma_f32_16x16x32_bf16 v[152:155], a[136:139], v[76:79], v[152:155]
  v_exp_f32 v220, v132
  v_mfma_f32_16x16x32_bf16 v[148:151], a[140:143], v[72:75], v[148:151]
  ds_read_b128 a[172:175], v3 offset:27648
  v_cvt_pk_bf16_f32 v177, v218, v219
  v_mfma_f32_16x16x32_bf16 v[156:159], a[140:143], v[76:79], v[156:159]
  s_waitcnt lgkmcnt(4)
  v_exp_f32 v221, v133
  v_mfma_f32_16x16x32_bf16 v[144:147], a[144:147], v[80:83], v[144:147]
  s_add_u32 s14, s13, 12288
  ds_read_b128 a[176:179], v3 offset:28672
  buffer_load_dwordx4 a[60:63], v2, s[40:43], s14 offen offset:3072 sc1
  v_add_f32 v226, v226, v220
  v_mfma_f32_16x16x32_bf16 v[152:155], a[144:147], v[84:87], v[152:155]
  v_exp_f32 v222, v134
  v_mfma_f32_16x16x32_bf16 v[148:151], a[148:151], v[80:83], v[148:151]
  ds_read_b128 a[180:183], v3 offset:29696
  buffer_load_dwordx4 v2, s[48:51], s27 offen offset:1024 sc1 lds
  v_add_f32 v226, v226, v221
  v_cvt_pk_bf16_f32 v178, v220, v221
  v_mfma_f32_16x16x32_bf16 v[156:159], a[148:151], v[84:87], v[156:159]
  v_exp_f32 v223, v135
  v_mfma_f32_16x16x32_bf16 v[144:147], a[152:155], v[88:91], v[144:147]
  ds_read_b128 a[184:187], v3 offset:30720
  v_add_f32 v226, v226, v222
  v_mfma_f32_16x16x32_bf16 v[152:155], a[152:155], v[92:95], v[152:155]
  v_exp_f32 v216, v136
  v_mfma_f32_16x16x32_bf16 v[148:151], a[156:159], v[88:91], v[148:151]
  s_add_u32 s14, s13, 16384
  ds_read_b128 a[188:191], v3 offset:31744
  buffer_load_dwordx4 a[192:195], v2, s[40:43], s14 offen offset:0 sc1
  v_add_f32 v226, v226, v223
  v_exp_f32 v217, v137
  v_mfma_f32_16x16x32_bf16 v[156:159], a[156:159], v[92:95], v[156:159]
  s_waitcnt lgkmcnt(4)
  v_exp_f32 v218, v138
  v_mfma_f32_16x16x32_bf16 a[64:67], a[160:163], v[184:187], a[64:67]
  ds_read_b128 a[128:131], v3 offset:8192
  v_cvt_pk_bf16_f32 v179, v222, v223
  v_mfma_f32_16x16x32_bf16 a[68:71], a[160:163], v[188:191], a[68:71]
  v_exp_f32 v219, v139
  v_mfma_f32_16x16x32_bf16 a[72:75], a[164:167], v[184:187], a[72:75]
  ds_read_b128 a[132:135], v3 offset:9216
  buffer_load_dwordx4 v2, s[48:51], s27 offen offset:2048 sc1 lds
  v_add_f32 v227, v216, v217
  v_mfma_f32_16x16x32_bf16 a[76:79], a[164:167], v[188:191], a[76:79]
  v_exp_f32 v220, v140
  v_mfma_f32_16x16x32_bf16 a[80:83], a[168:171], v[184:187], a[80:83]
  ds_read_b128 a[136:139], v3 offset:10240
  v_cvt_pk_bf16_f32 v180, v216, v217
  v_mfma_f32_16x16x32_bf16 a[84:87], a[168:171], v[188:191], a[84:87]
  v_exp_f32 v221, v141
  v_mfma_f32_16x16x32_bf16 a[88:91], a[172:175], v[184:187], a[88:91]
  ds_read_b128 a[140:143], v3 offset:11264
  buffer_load_dwordx4 a[196:199], v2, s[40:43], s14 offen offset:1024 sc1
  v_add_f32 v227, v227, v218
  v_mfma_f32_16x16x32_bf16 a[92:95], a[172:175], v[188:191], a[92:95]
  s_waitcnt lgkmcnt(4)
  v_exp_f32 v222, v142
  v_mfma_f32_16x16x32_bf16 a[96:99], a[176:179], v[184:187], a[96:99]
  ds_read_b128 a[144:147], v3 offset:12288
  buffer_load_dwordx4 v2, s[48:51], s27 offen offset:3072 sc1 lds
  v_add_f32 v227, v227, v219
  v_cvt_pk_bf16_f32 v181, v218, v219
  v_mfma_f32_16x16x32_bf16 a[100:103], a[176:179], v[188:191], a[100:103]
  s_add_u32 s27, s27, 16384
  v_exp_f32 v223, v143
  v_mfma_f32_16x16x32_bf16 a[104:107], a[180:183], v[184:187], a[104:107]
  s_add_u32 s25, s25, 32768
  ds_read_b128 a[148:151], v3 offset:13312
  v_add_f32 v227, v227, v220
  v_mfma_f32_16x16x32_bf16 a[108:111], a[180:183], v[188:191], a[108:111]
  s_and_b32 s25, s25, 0x1ffff
  v_add_f32 v227, v227, v221
  v_cvt_pk_bf16_f32 v182, v220, v221
  v_add_f32 v227, v227, v222
  v_mfma_f32_16x16x32_bf16 a[112:115], a[184:187], v[184:187], a[112:115]
  ds_read_b128 a[152:155], v3 offset:14336
  v_add_f32 v227, v227, v223
  v_max_f32 v5, v226, v227
  v_cmp_lt_f32 vcc, s81, v5
  v_mfma_f32_16x16x32_bf16 a[116:119], a[184:187], v[188:191], a[116:119]
  v_exp_f32 v216, v144
  v_mfma_f32_16x16x32_bf16 a[120:123], a[188:191], v[184:187], a[120:123]
  s_waitcnt lgkmcnt(3)
  ds_read_b128 a[156:159], v3 offset:15360
  v_cvt_pk_bf16_f32 v183, v222, v223
  v_add_u32 v3, s66, v2
  v_mfma_f32_16x16x32_bf16 a[124:127], a[188:191], v[188:191], a[124:127]
  s_cbranch_vccnz fa_stub17
fa_back17:
  v_exp_f32 v217, v145
  v_add_f32 v230, v230, v226
  v_add_f32 v231, v231, v227
fa_SSW5:
  v_mfma_f32_16x16x32_bf16 v[128:131], a[128:131], v[64:67], v[200:203]
  s_waitcnt vmcnt(12)
  v_exp_f32 v218, v146
  v_mfma_f32_16x16x32_bf16 v[136:139], a[128:131], v[68:71], v[204:207]
  s_barrier
  v_exp_f32 v219, v147
  v_mfma_f32_16x16x32_bf16 v[132:135], a[132:135], v[64:67], v[200:203]
  ds_read_b128 a[160:163], v3 offset:16384
  ds_read_b128 a[164:167], v3 offset:17408
  v_add_f32 v226, v216, v217
  v_mfma_f32_16x16x32_bf16 v[140:143], a[132:135], v[68:71], v[204:207]
  s_mov_b32 m0, s24
  v_exp_f32 v220, v148
  v_mfma_f32_16x16x32_bf16 v[128:131], a[136:139], v[72:75], v[128:131]
  ds_read_b128 a[168:171], v3 offset:18432
  buffer_load_dwordx4 v2, s[44:47], s26 offen offset:0 sc1 lds
  v_cvt_pk_bf16_f32 v184, v216, v217
  v_mfma_f32_16x16x32_bf16 v[136:139], a[136:139], v[76:79], v[136:139]
  v_exp_f32 v221, v149
  v_mfma_f32_16x16x32_bf16 v[132:135], a[140:143], v[72:75], v[132:135]
  ds_read_b128 a[172:175], v3 offset:19456
  v_add_f32 v226, v226, v218
  v_add_f32 v226, v226, v219
  v_mfma_f32_16x16x32_bf16 v[140:143], a[140:143], v[76:79], v[140:143]
  s_waitcnt lgkmcnt(4)
  v_exp_f32 v222, v150
  v_mfma_f32_16x16x32_bf16 v[128:131], a[144:147], v[80:83], v[128:131]
  s_add_u32 s14, s13, 16384
  ds_read_b128 a[176:179], v3 offset:20480
  buffer_load_dwordx4 a[200:203], v2, s[40:43], s14 offen offset:2048 sc1
  v_cvt_pk_bf16_f32 v185, v218, v219
  v_mfma_f32_16x16x32_bf16 v[136:139], a[144:147], v[84:87], v[136:139]
  v_exp_f32 v223, v151
  v_mfma_f32_16x16x32_bf16 v[132:135], a[148:151], v[80:83], v[132:135]
  ds_read_b128 a[180:183], v3 offset:21504
  buffer_load_dwordx4 v2, s[44:47], s26 offen offset:1024 sc1 lds
  v_add_f32 v226, v226, v220
  v_mfma_f32_16x16x32_bf16 v[140:143], a[148:151], v[84:87], v[140:143]
  v_exp_f32 v216, v152
  v_mfma_f32_16x16x32_bf16 v[128:131], a[152:155], v[88:91], v[128:131]
  ds_read_b128 a[184:187], v3 offset:22528
  v_add_f32 v226, v226, v221
  v_cvt_pk_bf16_f32 v186, v220, v221
  v_mfma_f32_16x16x32_bf16 v[136:139], a[152:155], v[92:95], v[136:139]
  v_exp_f32 v217, v153
  v_mfma_f32_16x16x32_bf16 v[132:135], a[156:159], v[88:91], v[132:135]
  ds_read_b128 a[188:191], v3 offset:23552
  buffer_load_dwordx4 a[204:207], v2, s[40:43], s14 offen offset:3072 sc1
  v_add_f32 v226, v226, v222
  v_mfma_f32_16x16x32_bf16 v[140:143], a[156:159], v[92:95], v[140:143]
  s_waitcnt lgkmcnt(4)
  v_exp_f32 v218, v154
  v_mfma_f32_16x16x32_bf16 a[64:67], a[160:163], v[176:179], a[64:67]
  ds_read_b128 a[128:131], v3 offset:0
  v_add_f32 v226, v226, v223
  v_cvt_pk_bf16_f32 v187, v222, v223
  v_mfma_f32_16x16x32_bf16 a[68:71], a[160:163], v[180:183], a[68:71]
  v_exp_f32 v219, v155
  v_mfma_f32_16x16x32_bf16 a[72:75], a[164:167], v[176:179], a[72:75]
  ds_read_b128 a[132:135], v3 offset:1024
  buffer_load_dwordx4 v2, s[44:47], s26 offen offset:2048 sc1 lds
  v_add_f32 v227, v216, v217
  v_mfma_f32_16x16x32_bf16 a[76:79], a[164:167], v[180:183], a[76:79]
  v_exp_f32 v220, v156
  v_mfma_f32_16x16x32_bf16 a[80:83], a[168:171], v[176:179], a[80:83]
  ds_read_b128 a[136:139], v3 offset:2048
  v_cvt_pk_bf16_f32 v188, v216, v217
  v_mfma_f32_16x16x32_bf16 a[84:87], a[168:171], v[180:183], a[84:87]
  v_exp_f32 v221, v157
  v_mfma_f32_16x16x32_bf16 a[88:91], a[172:175], v[176:179], a[88:91]
  s_add_u32 s14, s13, 20480
  ds_read_b128 a[140:143], v3 offset:3072
  buffer_load_dwordx4 a[208:211], v2, s[40:43], s14 offen offset:0 sc1
  v_add_f32 v227, v227, v218
  v_add_f32 v227, v227, v219
  v_mfma_f32_16x16x32_bf16 a[92:95], a[172:175], v[180:183], a[92:95]
  s_waitcnt lgkmcnt(4)
  v_exp_f32 v222, v158
  v_mfma_f32_16x16x32_bf16 a[96:99], a[176:179], v[176:179], a[96:99]
  ds_read_b128 a[144:147], v3 offset:4096
  buffer_load_dwordx4 v2, s[44:47], s26 offen offset:3072 sc1 lds
  v_cvt_pk_bf16_f32 v189, v218, v219
  v_mfma_f32_16x16x32_bf16 a[100:103], a[176:179], v[180:183], a[100:103]
  s_add_u32 s26, s26, 16384
  v_exp_f32 v223, v159
  v_mfma_f32_16x16x32_bf16 a[104:107], a[180:183], v[176:179], a[104:107]
  s_add_u32 s24, s24, 32768
  ds_read_b128 a[148:151], v3 offset:5120
  v_add_f32 v227, v227, v220
  v_mfma_f32_16x16x32_bf16 a[108:111], a[180:183], v[180:183], a[108:111]
  s_and_b32 s24, s24, 0x1ffff
  v_add_f32 v227, v227, v221
  v_cvt_pk_bf16_f32 v190, v220, v221
  v_add_f32 v227, v227, v222
  v_mfma_f32_16x16x32_bf16 a[112:115], a[184:187], v[176:179], a[112:115]
  ds_read_b128 a[152:155], v3 offset:6144
  v_add_f32 v227, v227, v223
  v_max_f32 v5, v226, v227
  v_cmp_lt_f32 vcc, s81, v5
  v_mfma_f32_16x16x32_bf16 a[116:119], a[184:187], v[180:183], a[116:119]
  v_exp_f32 v216, v128
  v_mfma_f32_16x16x32_bf16 a[120:123], a[188:191], v[176:179], a[120:123]
  s_waitcnt lgkmcnt(3)
  ds_read_b128 a[156:159], v3 offset:7168
  v_cvt_pk_bf16_f32 v191, v222, v223
  v_mfma_f32_16x16x32_bf16 a[124:127], a[188:191], v[180:183], a[124:127]
  s_cbranch_vccnz fa_stub18
fa_back18:
  v_exp_f32 v217, v129
  v_add_f32 v230, v230, v226
  v_add_f32 v231, v231, v227
  v_mfma_f32_16x16x32_bf16 v[144:147], a[128:131], v[64:67], v[200:203]
  ds_read_b128 a[160:163], v3 offset:24576
  v_add_f32 v226, v216, v217
  v_mfma_f32_16x16x32_bf16 v[152:155], a[128:131], v[68:71], v[204:207]
  v_exp_f32 v218, v130
  v_mfma_f32_16x16x32_bf16 v[148:151], a[132:135], v[64:67], v[200:203]
  s_add_u32 s66, s66, 32768
  ds_read_b128 a[164:167], v3 offset:25600
  v_cvt_pk_bf16_f32 v176, v216, v217
  v_mfma_f32_16x16x32_bf16 v[156:159], a[132:135], v[68:71], v[204:207]
  s_mov_b32 m0, s25
  v_exp_f32 v219, v131
  v_mfma_f32_16x16x32_bf16 v[144:147], a[136:139], v[72:75], v[144:147]
  s_and_b32 s66, s66, 0x1ffff
  ds_read_b128 a[168:171], v3 offset:26624
  buffer_load_dwordx4 v2, s[48:51], s27 offen offset:0 sc1 lds
  v_add_f32 v226, v226, v218
  v_add_f32 v226, v226, v219
  v_mfma_f32_16x16x32_bf16 v[152:155], a[136:139], v[76:79], v[152:155]
  v_exp_f32 v220, v132
  v_mfma_f32_16x16x32_bf16 v[148:151], a[140:143], v[72:75], v[148:151]
  ds_read_b128 a[172:175], v3 offset:27648
  v_cvt_pk_bf16_f32 v177, v218, v219
  v_mfma_f32_16x16x32_bf16 v[156:159], a[140:143], v[76:79], v[156:159]
  s_waitcnt lgkmcnt(4)
  v_exp_f32 v221, v133
  v_mfma_f32_16x16x32_bf16 v[144:147], a[144:147], v[80:83], v[144:147]
  s_add_u32 s14, s13, 20480
  ds_read_b128 a[176:179], v3 offset:28672
  buffer_load_dwordx4 a[212:215], v2, s[40:43], s14 offen offset:1024 sc1
  v_add_f32 v226, v226, v220
  v_mfma_f32_16x16x32_bf16 v[152:155], a[144:147], v[84:87], v[152:155]
  v_exp_f32 v222, v134
  v_mfma_f32_16x16x32_bf16 v[148:151], a[148:151], v[80:83], v[148:151]
  ds_read_b128 a[180:183], v3 offset:29696
  buffer_load_dwordx4 v2, s[48:51], s27 offen offset:1024 sc1 lds
  v_add_f32 v226, v226, v221
  v_cvt_pk_bf16_f32 v178, v220, v221
  v_mfma_f32_16x16x32_bf16 v[156:159], a[148:151], v[84:87], v[156:159]
  v_exp_f32 v223, v135
  v_mfma_f32_16x16x32_bf16 v[144:147], a[152:155], v[88:91], v[144:147]
  ds_read_b128 a[184:187], v3 offset:30720
  v_add_f32 v226, v226, v222
  v_mfma_f32_16x16x32_bf16 v[152:155], a[152:155], v[92:95], v[152:155]
  v_exp_f32 v216, v136
  v_mfma_f32_16x16x32_bf16 v[148:151], a[156:159], v[88:91], v[148:151]
  ds_read_b128 a[188:191], v3 offset:31744
  buffer_load_dwordx4 a[216:219], v2, s[40:43], s14 offen offset:2048 sc1
  v_add_f32 v226, v226, v223
  v_exp_f32 v217, v137
  v_mfma_f32_16x16x32_bf16 v[156:159], a[156:159], v[92:95], v[156:159]
  s_waitcnt lgkmcnt(4)
  v_exp_f32 v218, v138
  v_mfma_f32_16x16x32_bf16 a[64:67], a[160:163], v[184:187], a[64:67]
  ds_read_b128 a[128:131], v3 offset:8192
  v_cvt_pk_bf16_f32 v179, v222, v223
  v_mfma_f32_16x16x32_bf16 a[68:71], a[160:163], v[188:191], a[68:71]
  v_exp_f32 v219, v139
  v_mfma_f32_16x16x32_bf16 a[72:75], a[164:167], v[184:187], a[72:75]
  ds_read_b128 a[132:135], v3 offset:9216
  buffer_load_dwordx4 v2, s[48:51], s27 offen offset:2048 sc1 lds
  v_add_f32 v227, v216, v217
  v_mfma_f32_16x16x32_bf16 a[76:79], a[164:167], v[188:191], a[76:79]
  v_exp_f32 v220, v140
  v_mfma_f32_16x16x32_bf16 a[80:83], a[168:171], v[184:187], a[80:83]
  ds_read_b128 a[136:139], v3 offset:10240
  v_cvt_pk_bf16_f32 v180, v216, v217
  v_mfma_f32_16x16x32_bf16 a[84:87], a[168:171], v[188:191], a[84:87]
  v_exp_f32 v221, v141
  v_mfma_f32_16x16x32_bf16 a[88:91], a[172:175], v[184:187], a[88:91]
  ds_read_b128 a[140:143], v3 offset:11264
  buffer_load_dwordx4 a[220:223], v2, s[40:43], s14 offen offset:3072 sc1
  v_add_f32 v227, v227, v218
  v_mfma_f32_16x16x32_bf16 a[92:95], a[172:175], v[188:191], a[92:95]
  s_waitcnt lgkmcnt(4)
  v_exp_f32 v222, v142
  v_mfma_f32_16x16x32_bf16 a[96:99], a[176:179], v[184:187], a[96:99]
  ds_read_b128 a[144:147], v3 offset:12288
  buffer_load_dwordx4 v2, s[48:51], s27 offen offset:3072 sc1 lds
  v_add_f32 v227, v227, v219
  v_cvt_pk_bf16_f32 v181, v218, v219
  v_mfma_f32_16x16x32_bf16 a[100:103], a[176:179], v[188:191], a[100:103]
  s_add_u32 s27, s27, 16384
  v_exp_f32 v223, v143
  v_mfma_f32_16x16x32_bf16 a[104:107], a[180:183], v[184:187], a[104:107]
  s_add_u32 s25, s25, 32768
  ds_read_b128 a[148:151], v3 offset:13312
  v_add_f32 v227, v227, v220
  v_mfma_f32_16x16x32_bf16 a[108:111], a[180:183], v[188:191], a[108:111]
  s_and_b32 s25, s25, 0x1ffff
  v_add_f32 v227, v227, v221
  v_cvt_pk_bf16_f32 v182, v220, v221
  v_add_f32 v227, v227, v222
  v_mfma_f32_16x16x32_bf16 a[112:115], a[184:187], v[184:187], a[112:115]
  ds_read_b128 a[152:155], v3 offset:14336
  v_add_f32 v227, v227, v223
  v_max_f32 v5, v226, v227
  v_cmp_lt_f32 vcc, s81, v5
  v_mfma_f32_16x16x32_bf16 a[116:119], a[184:187], v[188:191], a[116:119]
  v_exp_f32 v216, v144
  v_mfma_f32_16x16x32_bf16 a[120:123], a[188:191], v[184:187], a[120:123]
  s_waitcnt lgkmcnt(3)
  ds_read_b128 a[156:159], v3 offset:15360
  v_cvt_pk_bf16_f32 v183, v222, v223
  v_add_u32 v3, s66, v2
  v_mfma_f32_16x16x32_bf16 a[124:127], a[188:191], v[188:191], a[124:127]
  s_cbranch_vccnz fa_stub19
fa_back19:
  v_exp_f32 v217, v145
  v_add_f32 v230, v230, v226
  v_add_f32 v231, v231, v227
fa_SSW4:
  v_mfma_f32_16x16x32_bf16 v[128:131], a[128:131], v[64:67], v[200:203]
  s_waitcnt vmcnt(12)
  v_exp_f32 v218, v146
  v_mfma_f32_16x16x32_bf16 v[136:139], a[128:131], v[68:71], v[204:207]
  s_barrier
  v_exp_f32 v219, v147
  v_mfma_f32_16x16x32_bf16 v[132:135], a[132:135], v[64:67], v[200:203]
  ds_read_b128 a[160:163], v3 offset:16384
  ds_read_b128 a[164:167], v3 offset:17408
  v_add_f32 v226, v216, v217
  v_mfma_f32_16x16x32_bf16 v[140:143], a[132:135], v[68:71], v[204:207]
  s_mov_b32 m0, s24
  v_exp_f32 v220, v148
  v_mfma_f32_16x16x32_bf16 v[128:131], a[136:139], v[72:75], v[128:131]
  ds_read_b128 a[168:171], v3 offset:18432
  buffer_load_dwordx4 v2, s[44:47], s26 offen offset:0 sc1 lds
  v_cvt_pk_bf16_f32 v184, v216, v217
  v_mfma_f32_16x16x32_bf16 v[136:139], a[136:139], v[76:79], v[136:139]
  v_exp_f32 v221, v149
  v_mfma_f32_16x16x32_bf16 v[132:135], a[140:143], v[72:75], v[132:135]
  ds_read_b128 a[172:175], v3 offset:19456
  v_add_f32 v226, v226, v218
  v_add_f32 v226, v226, v219
  v_mfma_f32_16x16x32_bf16 v[140:143], a[140:143], v[76:79], v[140:143]
  s_waitcnt lgkmcnt(4)
  v_exp_f32 v222, v150
  v_mfma_f32_16x16x32_bf16 v[128:131], a[144:147], v[80:83], v[128:131]
  s_add_u32 s14, s13, 24576
  ds_read_b128 a[176:179], v3 offset:20480
  buffer_load_dwordx4 a[224:227], v2, s[40:43], s14 offen offset:0 sc1
  v_cvt_pk_bf16_f32 v185, v218, v219
  v_mfma_f32_16x16x32_bf16 v[136:139], a[144:147], v[84:87], v[136:139]
  v_exp_f32 v223, v151
  v_mfma_f32_16x16x32_bf16 v[132:135], a[148:151], v[80:83], v[132:135]
  ds_read_b128 a[180:183], v3 offset:21504
  buffer_load_dwordx4 v2, s[44:47], s26 offen offset:1024 sc1 lds
  v_add_f32 v226, v226, v220
  v_mfma_f32_16x16x32_bf16 v[140:143], a[148:151], v[84:87], v[140:143]
  v_exp_f32 v216, v152
  v_mfma_f32_16x16x32_bf16 v[128:131], a[152:155], v[88:91], v[128:131]
  ds_read_b128 a[184:187], v3 offset:22528
  v_add_f32 v226, v226, v221
  v_cvt_pk_bf16_f32 v186, v220, v221
  v_mfma_f32_16x16x32_bf16 v[136:139], a[152:155], v[92:95], v[136:139]
  v_exp_f32 v217, v153
  v_mfma_f32_16x16x32_bf16 v[132:135], a[156:159], v[88:91], v[132:135]
  ds_read_b128 a[188:191], v3 offset:23552
  buffer_load_dwordx4 a[228:231], v2, s[40:43], s14 offen offset:1024 sc1
  v_add_f32 v226, v226, v222
  v_mfma_f32_16x16x32_bf16 v[140:143], a[156:159], v[92:95], v[140:143]
  s_waitcnt lgkmcnt(4)
  v_exp_f32 v218, v154
  v_mfma_f32_16x16x32_bf16 a[64:67], a[160:163], v[176:179], a[64:67]
  ds_read_b128 a[128:131], v3 offset:0
  v_add_f32 v226, v226, v223
  v_cvt_pk_bf16_f32 v187, v222, v223
  v_mfma_f32_16x16x32_bf16 a[68:71], a[160:163], v[180:183], a[68:71]
  v_exp_f32 v219, v155
  v_mfma_f32_16x16x32_bf16 a[72:75], a[164:167], v[176:179], a[72:75]
  ds_read_b128 a[132:135], v3 offset:1024
  buffer_load_dwordx4 v2, s[44:47], s26 offen offset:2048 sc1 lds
  v_add_f32 v227, v216, v217
  v_mfma_f32_16x16x32_bf16 a[76:79], a[164:167], v[180:183], a[76:79]
  v_exp_f32 v220, v156
  v_mfma_f32_16x16x32_bf16 a[80:83], a[168:171], v[176:179], a[80:83]
  ds_read_b128 a[136:139], v3 offset:2048
  v_cvt_pk_bf16_f32 v188, v216, v217
  v_mfma_f32_16x16x32_bf16 a[84:87], a[168:171], v[180:183], a[84:87]
  v_exp_f32 v221, v157
  v_mfma_f32_16x16x32_bf16 a[88:91], a[172:175], v[176:179], a[88:91]
  ds_read_b128 a[140:143], v3 offset:3072
  buffer_load_dwordx4 a[232:235], v2, s[40:43], s14 offen offset:2048 sc1
  v_add_f32 v227, v227, v218
  v_add_f32 v227, v227, v219
  v_mfma_f32_16x16x32_bf16 a[92:95], a[172:175], v[180:183], a[92:95]
  s_waitcnt lgkmcnt(4)
  v_exp_f32 v222, v158
  v_mfma_f32_16x16x32_bf16 a[96:99], a[176:179], v[176:179], a[96:99]
  ds_read_b128 a[144:147], v3 offset:4096
  buffer_load_dwordx4 v2, s[44:47], s26 offen offset:3072 sc1 lds
  v_cvt_pk_bf16_f32 v189, v218, v219
  v_mfma_f32_16x16x32_bf16 a[100:103], a[176:179], v[180:183], a[100:103]
  s_add_u32 s26, s26, 16384
  v_exp_f32 v223, v159
  v_mfma_f32_16x16x32_bf16 a[104:107], a[180:183], v[176:179], a[104:107]
  s_add_u32 s24, s24, 32768
  ds_read_b128 a[148:151], v3 offset:5120
  v_add_f32 v227, v227, v220
  v_mfma_f32_16x16x32_bf16 a[108:111], a[180:183], v[180:183], a[108:111]
  s_and_b32 s24, s24, 0x1ffff
  v_add_f32 v227, v227, v221
  v_cvt_pk_bf16_f32 v190, v220, v221
  v_add_f32 v227, v227, v222
  v_mfma_f32_16x16x32_bf16 a[112:115], a[184:187], v[176:179], a[112:115]
  ds_read_b128 a[152:155], v3 offset:6144
  v_add_f32 v227, v227, v223
  v_max_f32 v5, v226, v227
  v_cmp_lt_f32 vcc, s81, v5
  v_mfma_f32_16x16x32_bf16 a[116:119], a[184:187], v[180:183], a[116:119]
  v_exp_f32 v216, v128
  v_mfma_f32_16x16x32_bf16 a[120:123], a[188:191], v[176:179], a[120:123]
  s_waitcnt lgkmcnt(3)
  ds_read_b128 a[156:159], v3 offset:7168
  v_cvt_pk_bf16_f32 v191, v222, v223
  v_mfma_f32_16x16x32_bf16 a[124:127], a[188:191], v[180:183], a[124:127]
  s_cbranch_vccnz fa_stub20
fa_back20:
  v_exp_f32 v217, v129
  v_add_f32 v230, v230, v226
  v_add_f32 v231, v231, v227
  v_mfma_f32_16x16x32_bf16 v[144:147], a[128:131], v[64:67], v[200:203]
  ds_read_b128 a[160:163], v3 offset:24576
  v_add_f32 v226, v216, v217
  v_mfma_f32_16x16x32_bf16 v[152:155], a[128:131], v[68:71], v[204:207]
  v_exp_f32 v218, v130
  v_mfma_f32_16x16x32_bf16 v[148:151], a[132:135], v[64:67], v[200:203]
  s_add_u32 s66, s66, 32768
  ds_read_b128 a[164:167], v3 offset:25600
  v_cvt_pk_bf16_f32 v176, v216, v217
  v_mfma_f32_16x16x32_bf16 v[156:159], a[132:135], v[68:71], v[204:207]
  s_mov_b32 m0, s25
  v_exp_f32 v219, v131
  v_mfma_f32_16x16x32_bf16 v[144:147], a[136:139], v[72:75], v[144:147]
  s_and_b32 s66, s66, 0x1ffff
  ds_read_b128 a[168:171], v3 offset:26624
  buffer_load_dwordx4 v2, s[48:51], s27 offen offset:0 sc1 lds
  v_add_f32 v226, v226, v218
  v_add_f32 v226, v226, v219
  v_mfma_f32_16x16x32_bf16 v[152:155], a[136:139], v[76:79], v[152:155]
  v_exp_f32 v220, v132
  v_mfma_f32_16x16x32_bf16 v[148:151], a[140:143], v[72:75], v[148:151]
  ds_read_b128 a[172:175], v3 offset:27648
  v_cvt_pk_bf16_f32 v177, v218, v219
  v_mfma_f32_16x16x32_bf16 v[156:159], a[140:143], v[76:79], v[156:159]
  s_waitcnt lgkmcnt(4)
  v_exp_f32 v221, v133
  v_mfma_f32_16x16x32_bf16 v[144:147], a[144:147], v[80:83], v[144:147]
  s_add_u32 s14, s13, 24576
  ds_read_b128 a[176:179], v3 offset:28672
  buffer_load_dwordx4 a[236:239], v2, s[40:43], s14 offen offset:3072 sc1
  v_add_f32 v226, v226, v220
  v_mfma_f32_16x16x32_bf16 v[152:155], a[144:147], v[84:87], v[152:155]
  v_exp_f32 v222, v134
  v_mfma_f32_16x16x32_bf16 v[148:151], a[148:151], v[80:83], v[148:151]
  ds_read_b128 a[180:183], v3 offset:29696
  buffer_load_dwordx4 v2, s[48:51], s27 offen offset:1024 sc1 lds
  v_add_f32 v226, v226, v221
  v_cvt_pk_bf16_f32 v178, v220, v221
  v_mfma_f32_16x16x32_bf16 v[156:159], a[148:151], v[84:87], v[156:159]
  v_exp_f32 v223, v135
  v_mfma_f32_16x16x32_bf16 v[144:147], a[152:155], v[88:91], v[144:147]
  ds_read_b128 a[184:187], v3 offset:30720
  v_add_f32 v226, v226, v222
  v_mfma_f32_16x16x32_bf16 v[152:155], a[152:155], v[92:95], v[152:155]
  v_exp_f32 v216, v136
  v_mfma_f32_16x16x32_bf16 v[148:151], a[156:159], v[88:91], v[148:151]
  s_add_u32 s14, s13, 28672
  ds_read_b128 a[188:191], v3 offset:31744
  buffer_load_dwordx4 a[240:243], v2, s[40:43], s14 offen offset:0 sc1
  v_add_f32 v226, v226, v223
  v_exp_f32 v217, v137
  v_mfma_f32_16x16x32_bf16 v[156:159], a[156:159], v[92:95], v[156:159]
  s_waitcnt lgkmcnt(4)
  v_exp_f32 v218, v138
  v_mfma_f32_16x16x32_bf16 a[64:67], a[160:163], v[184:187], a[64:67]
  ds_read_b128 a[128:131], v3 offset:8192
  v_cvt_pk_bf16_f32 v179, v222, v223
  v_mfma_f32_16x16x32_bf16 a[68:71], a[160:163], v[188:191], a[68:71]
  v_exp_f32 v219, v139
  v_mfma_f32_16x16x32_bf16 a[72:75], a[164:167], v[184:187], a[72:75]
  ds_read_b128 a[132:135], v3 offset:9216
  buffer_load_dwordx4 v2, s[48:51], s27 offen offset:2048 sc1 lds
  v_add_f32 v227, v216, v217
  v_mfma_f32_16x16x32_bf16 a[76:79], a[164:167], v[188:191], a[76:79]
  v_exp_f32 v220, v140
  v_mfma_f32_16x16x32_bf16 a[80:83], a[168:171], v[184:187], a[80:83]
  ds_read_b128 a[136:139], v3 offset:10240
  v_cvt_pk_bf16_f32 v180, v216, v217
  v_mfma_f32_16x16x32_bf16 a[84:87], a[168:171], v[188:191], a[84:87]
  v_exp_f32 v221, v141
  v_mfma_f32_16x16x32_bf16 a[88:91], a[172:175], v[184:187], a[88:91]
  ds_read_b128 a[140:143], v3 offset:11264
  buffer_load_dwordx4 a[244:247], v2, s[40:43], s14 offen offset:1024 sc1
  v_add_f32 v227, v227, v218
  v_mfma_f32_16x16x32_bf16 a[92:95], a[172:175], v[188:191], a[92:95]
  s_waitcnt lgkmcnt(4)
  v_exp_f32 v222, v142
  v_mfma_f32_16x16x32_bf16 a[96:99], a[176:179], v[184:187], a[96:99]
  ds_read_b128 a[144:147], v3 offset:12288
  buffer_load_dwordx4 v2, s[48:51], s27 offen offset:3072 sc1 lds
  v_add_f32 v227, v227, v219
  v_cvt_pk_bf16_f32 v181, v218, v219
  v_mfma_f32_16x16x32_bf16 a[100:103], a[176:179], v[188:191], a[100:103]
  s_add_u32 s27, s27, 16384
  v_exp_f32 v223, v143
  v_mfma_f32_16x16x32_bf16 a[104:107], a[180:183], v[184:187], a[104:107]
  s_add_u32 s25, s25, 32768
  ds_read_b128 a[148:151], v3 offset:13312
  v_add_f32 v227, v227, v220
  v_mfma_f32_16x16x32_bf16 a[108:111], a[180:183], v[188:191], a[108:111]
  s_and_b32 s25, s25, 0x1ffff
  v_add_f32 v227, v227, v221
  v_cvt_pk_bf16_f32 v182, v220, v221
  v_add_f32 v227, v227, v222
  v_mfma_f32_16x16x32_bf16 a[112:115], a[184:187], v[184:187], a[112:115]
  ds_read_b128 a[152:155], v3 offset:14336
  v_add_f32 v227, v227, v223
  v_max_f32 v5, v226, v227
  v_cmp_lt_f32 vcc, s81, v5
  v_mfma_f32_16x16x32_bf16 a[116:119], a[184:187], v[188:191], a[116:119]
  v_exp_f32 v216, v144
  v_mfma_f32_16x16x32_bf16 a[120:123], a[188:191], v[184:187], a[120:123]
  s_waitcnt lgkmcnt(3)
  ds_read_b128 a[156:159], v3 offset:15360
  v_cvt_pk_bf16_f32 v183, v222, v223
  v_add_u32 v3, s66, v2
  v_mfma_f32_16x16x32_bf16 a[124:127], a[188:191], v[188:191], a[124:127]
  s_cbranch_vccnz fa_stub21
fa_back21:
  v_exp_f32 v217, v145
  v_add_f32 v230, v230, v226
  v_add_f32 v231, v231, v227
fa_SSW3:
  v_mfma_f32_16x16x32_bf16 v[128:131], a[128:131], v[64:67], v[200:203]
  s_waitcnt vmcnt(12)
  v_exp_f32 v218, v146
  v_mfma_f32_16x16x32_bf16 v[136:139], a[128:131], v[68:71], v[204:207]
  s_barrier
  v_exp_f32 v219, v147
  v_mfma_f32_16x16x32_bf16 v[132:135], a[132:135], v[64:67], v[200:203]
  s_cmp_ge_u32 s26, s46
  s_cselect_b64 s[44:45], s[4:5], s[44:45]
  s_cselect_b32 s46, s30, s46
  ds_read_b128 a[160:163], v3 offset:16384
  ds_read_b128 a[164:167], v3 offset:17408
  v_add_f32 v226, v216, v217
  v_mfma_f32_16x16x32_bf16 v[140:143], a[132:135], v[68:71], v[204:207]
  s_mov_b32 m0, s24
  v_exp_f32 v220, v148
  v_mfma_f32_16x16x32_bf16 v[128:131], a[136:139], v[72:75], v[128:131]
  ds_read_b128 a[168:171], v3 offset:18432
  buffer_load_dwordx4 v2, s[44:47], s26 offen offset:0 sc1 lds
  v_cvt_pk_bf16_f32 v184, v216, v217
  v_mfma_f32_16x16x32_bf16 v[136:139], a[136:139], v[76:79], v[136:139]
  v_exp_f32 v221, v149
  v_mfma_f32_16x16x32_bf16 v[132:135], a[140:143], v[72:75], v[132:135]
  ds_read_b128 a[172:175], v3 offset:19456
  v_add_f32 v226, v226, v218
  v_add_f32 v226, v226, v219
  v_mfma_f32_16x16x32_bf16 v[140:143], a[140:143], v[76:79], v[140:143]
  s_waitcnt lgkmcnt(4)
  v_exp_f32 v222, v150
  v_mfma_f32_16x16x32_bf16 v[128:131], a[144:147], v[80:83], v[128:131]
  s_add_u32 s14, s13, 28672
  ds_read_b128 a[176:179], v3 offset:20480
  buffer_load_dwordx4 a[248:251], v2, s[40:43], s14 offen offset:2048 sc1
  v_cvt_pk_bf16_f32 v185, v218, v219
  v_mfma_f32_16x16x32_bf16 v[136:139], a[144:147], v[84:87], v[136:139]
  v_exp_f32 v223, v151
  v_mfma_f32_16x16x32_bf16 v[132:135], a[148:151], v[80:83], v[132:135]
  ds_read_b128 a[180:183], v3 offset:21504
  buffer_load_dwordx4 v2, s[44:47], s26 offen offset:1024 sc1 lds
  v_add_f32 v226, v226, v220
  v_mfma_f32_16x16x32_bf16 v[140:143], a[148:151], v[84:87], v[140:143]
  v_exp_f32 v216, v152
  v_mfma_f32_16x16x32_bf16 v[128:131], a[152:155], v[88:91], v[128:131]
  ds_read_b128 a[184:187], v3 offset:22528
  v_add_f32 v226, v226, v221
  v_cvt_pk_bf16_f32 v186, v220, v221
  v_mfma_f32_16x16x32_bf16 v[136:139], a[152:155], v[92:95], v[136:139]
  v_exp_f32 v217, v153
  v_mfma_f32_16x16x32_bf16 v[132:135], a[156:159], v[88:91], v[132:135]
  ds_read_b128 a[188:191], v3 offset:23552
  buffer_load_dwordx4 a[252:255], v2, s[40:43], s14 offen offset:3072 sc1
  v_add_f32 v226, v226, v222
  v_mfma_f32_16x16x32_bf16 v[140:143], a[156:159], v[92:95], v[140:143]
  s_waitcnt lgkmcnt(4)
  v_exp_f32 v218, v154
  v_mfma_f32_16x16x32_bf16 a[64:67], a[160:163], v[176:179], a[64:67]
  ds_read_b128 a[128:131], v3 offset:0
  v_add_f32 v226, v226, v223
  v_cvt_pk_bf16_f32 v187, v222, v223
  v_mfma_f32_16x16x32_bf16 a[68:71], a[160:163], v[180:183], a[68:71]
  v_exp_f32 v219, v155
  v_mfma_f32_16x16x32_bf16 a[72:75], a[164:167], v[176:179], a[72:75]
  ds_read_b128 a[132:135], v3 offset:1024
  buffer_load_dwordx4 v2, s[44:47], s26 offen offset:2048 sc1 lds
  v_add_f32 v227, v216, v217
  v_mfma_f32_16x16x32_bf16 a[76:79], a[164:167], v[180:183], a[76:79]
  v_exp_f32 v220, v156
  v_mfma_f32_16x16x32_bf16 a[80:83], a[168:171], v[176:179], a[80:83]
  ds_read_b128 a[136:139], v3 offset:2048
  v_cvt_pk_bf16_f32 v188, v216, v217
  v_mfma_f32_16x16x32_bf16 a[84:87], a[168:171], v[180:183], a[84:87]
  v_exp_f32 v221, v157
  v_mfma_f32_16x16x32_bf16 a[88:91], a[172:175], v[176:179], a[88:91]
  s_add_u32 s14, s13, 32768
  ds_read_b128 a[140:143], v3 offset:3072
  buffer_load_dwordx4 v[32:35], v2, s[40:43], s14 offen offset:0 sc1
  v_add_f32 v227, v227, v218
  v_add_f32 v227, v227, v219
  v_mfma_f32_16x16x32_bf16 a[92:95], a[172:175], v[180:183], a[92:95]
  s_waitcnt lgkmcnt(4)
  v_exp_f32 v222, v158
  v_mfma_f32_16x16x32_bf16 a[96:99], a[176:179], v[176:179], a[96:99]
  ds_read_b128 a[144:147], v3 offset:4096
  buffer_load_dwordx4 v2, s[44:47], s26 offen offset:3072 sc1 lds
  v_cvt_pk_bf16_f32 v189, v218, v219
  v_mfma_f32_16x16x32_bf16 a[100:103], a[176:179], v[180:183], a[100:103]
  s_add_u32 s26, s26, 16384
  v_exp_f32 v223, v159
  v_mfma_f32_16x16x32_bf16 a[104:107], a[180:183], v[176:179], a[104:107]
  s_add_u32 s24, s24, 32768
  ds_read_b128 a[148:151], v3 offset:5120
  v_add_f32 v227, v227, v220
  v_mfma_f32_16x16x32_bf16 a[108:111], a[180:183], v[180:183], a[108:111]
  s_and_b32 s24, s24, 0x1ffff
  v_add_f32 v227, v227, v221
  v_cvt_pk_bf16_f32 v190, v220, v221
  v_add_f32 v227, v227, v222
  v_mfma_f32_16x16x32_bf16 a[112:115], a[184:187], v[176:179], a[112:115]
  ds_read_b128 a[152:155], v3 offset:6144
  v_add_f32 v227, v227, v223
  v_max_f32 v5, v226, v227
  v_cmp_lt_f32 vcc, s81, v5
  v_mfma_f32_16x16x32_bf16 a[116:119], a[184:187], v[180:183], a[116:119]
  v_exp_f32 v216, v128
  v_mfma_f32_16x16x32_bf16 a[120:123], a[188:191], v[176:179], a[120:123]
  s_waitcnt lgkmcnt(3)
  ds_read_b128 a[156:159], v3 offset:7168
  v_cvt_pk_bf16_f32 v191, v222, v223
  v_mfma_f32_16x16x32_bf16 a[124:127], a[188:191], v[180:183], a[124:127]
  s_cbranch_vccnz fa_stub22
fa_back22:
  v_exp_f32 v217, v129
  v_add_f32 v230, v230, v226
  v_add_f32 v231, v231, v227
  v_mfma_f32_16x16x32_bf16 v[144:147], a[128:131], v[64:67], v[200:203]
  ds_read_b128 a[160:163], v3 offset:24576
  v_add_f32 v226, v216, v217
  v_mfma_f32_16x16x32_bf16 v[152:155], a[128:131], v[68:71], v[204:207]
  v_exp_f32 v218, v130
  v_mfma_f32_16x16x32_bf16 v[148:151], a[132:135], v[64:67], v[200:203]
  s_cmp_ge_u32 s27, s50
  s_cselect_b64 s[48:49], s[6:7], s[48:49]
  s_cselect_b32 s50, s30, s50
  ds_read_b128 a[164:167], v3 offset:25600
  v_cvt_pk_bf16_f32 v176, v216, v217
  v_mfma_f32_16x16x32_bf16 v[156:159], a[132:135], v[68:71], v[204:207]
  s_mov_b32 m0, s25
  v_exp_f32 v219, v131
  v_mfma_f32_16x16x32_bf16 v[144:147], a[136:139], v[72:75], v[144:147]
  s_add_u32 s66, s66, 32768
  ds_read_b128 a[168:171], v3 offset:26624
  buffer_load_dwordx4 v2, s[48:51], s27 offen offset:0 sc1 lds
  v_add_f32 v226, v226, v218
  v_add_f32 v226, v226, v219
  v_mfma_f32_16x16x32_bf16 v[152:155], a[136:139], v[76:79], v[152:155]
  s_and_b32 s66, s66, 0x1ffff
  v_exp_f32 v220, v132
  v_mfma_f32_16x16x32_bf16 v[148:151], a[140:143], v[72:75], v[148:151]
  ds_read_b128 a[172:175], v3 offset:27648
  v_cvt_pk_bf16_f32 v177, v218, v219
  v_mfma_f32_16x16x32_bf16 v[156:159], a[140:143], v[76:79], v[156:159]
  s_waitcnt lgkmcnt(4)
  v_exp_f32 v221, v133
  v_mfma_f32_16x16x32_bf16 v[144:147], a[144:147], v[80:83], v[144:147]
  s_add_u32 s14, s13, 32768
  ds_read_b128 a[176:179], v3 offset:28672
  buffer_load_dwordx4 v[36:39], v2, s[40:43], s14 offen offset:1024 sc1
  v_add_f32 v226, v226, v220
  v_mfma_f32_16x16x32_bf16 v[152:155], a[144:147], v[84:87], v[152:155]
  v_exp_f32 v222, v134
  v_mfma_f32_16x16x32_bf16 v[148:151], a[148:151], v[80:83], v[148:151]
  ds_read_b128 a[180:183], v3 offset:29696
  buffer_load_dwordx4 v2, s[48:51], s27 offen offset:1024 sc1 lds
  v_add_f32 v226, v226, v221
  v_cvt_pk_bf16_f32 v178, v220, v221
  v_mfma_f32_16x16x32_bf16 v[156:159], a[148:151], v[84:87], v[156:159]
  v_exp_f32 v223, v135
  v_mfma_f32_16x16x32_bf16 v[144:147], a[152:155], v[88:91], v[144:147]
  ds_read_b128 a[184:187], v3 offset:30720
  v_add_f32 v226, v226, v222
  v_mfma_f32_16x16x32_bf16 v[152:155], a[152:155], v[92:95], v[152:155]
  v_exp_f32 v216, v136
  v_mfma_f32_16x16x32_bf16 v[148:151], a[156:159], v[88:91], v[148:151]
  ds_read_b128 a[188:191], v3 offset:31744
  buffer_load_dwordx4 v[40:43], v2, s[40:43], s14 offen offset:2048 sc1
  v_add_f32 v226, v226, v223
  v_exp_f32 v217, v137
  v_mfma_f32_16x16x32_bf16 v[156:159], a[156:159], v[92:95], v[156:159]
  s_waitcnt lgkmcnt(4)
  v_exp_f32 v218, v138
  v_mfma_f32_16x16x32_bf16 a[64:67], a[160:163], v[184:187], a[64:67]
  ds_read_b128 a[128:131], v3 offset:8192
  v_cvt_pk_bf16_f32 v179, v222, v223
  v_mfma_f32_16x16x32_bf16 a[68:71], a[160:163], v[188:191], a[68:71]
  v_exp_f32 v219, v139
  v_mfma_f32_16x16x32_bf16 a[72:75], a[164:167], v[184:187], a[72:75]
  ds_read_b128 a[132:135], v3 offset:9216
  buffer_load_dwordx4 v2, s[48:51], s27 offen offset:2048 sc1 lds
  v_add_f32 v227, v216, v217
  v_mfma_f32_16x16x32_bf16 a[76:79], a[164:167], v[188:191], a[76:79]
  v_exp_f32 v220, v140
  v_mfma_f32_16x16x32_bf16 a[80:83], a[168:171], v[184:187], a[80:83]
  ds_read_b128 a[136:139], v3 offset:10240
  v_cvt_pk_bf16_f32 v180, v216, v217
  v_mfma_f32_16x16x32_bf16 a[84:87], a[168:171], v[188:191], a[84:87]
  v_exp_f32 v221, v141
  v_mfma_f32_16x16x32_bf16 a[88:91], a[172:175], v[184:187], a[88:91]
  ds_read_b128 a[140:143], v3 offset:11264
  buffer_load_dwordx4 v[44:47], v2, s[40:43], s14 offen offset:3072 sc1
  v_add_f32 v227, v227, v218
  v_mfma_f32_16x16x32_bf16 a[92:95], a[172:175], v[188:191], a[92:95]
  s_waitcnt lgkmcnt(4)
  v_exp_f32 v222, v142
  v_mfma_f32_16x16x32_bf16 a[96:99], a[176:179], v[184:187], a[96:99]
  ds_read_b128 a[144:147], v3 offset:12288
  buffer_load_dwordx4 v2, s[48:51], s27 offen offset:3072 sc1 lds
  v_add_f32 v227, v227, v219
  v_cvt_pk_bf16_f32 v181, v218, v219
  v_mfma_f32_16x16x32_bf16 a[100:103], a[176:179], v[188:191], a[100:103]
  s_add_u32 s27, s27, 16384
  v_exp_f32 v223, v143
  v_mfma_f32_16x16x32_bf16 a[104:107], a[180:183], v[184:187], a[104:107]
  s_add_u32 s25, s25, 32768
  ds_read_b128 a[148:151], v3 offset:13312
  v_add_f32 v227, v227, v220
  v_mfma_f32_16x16x32_bf16 a[108:111], a[180:183], v[188:191], a[108:111]
  s_and_b32 s25, s25, 0x1ffff
  v_add_f32 v227, v227, v221
  v_cvt_pk_bf16_f32 v182, v220, v221
  v_add_f32 v227, v227, v222
  v_mfma_f32_16x16x32_bf16 a[112:115], a[184:187], v[184:187], a[112:115]
  ds_read_b128 a[152:155], v3 offset:14336
  v_add_f32 v227, v227, v223
  v_max_f32 v5, v226, v227
  v_cmp_lt_f32 vcc, s81, v5
  v_mfma_f32_16x16x32_bf16 a[116:119], a[184:187], v[188:191], a[116:119]
  v_exp_f32 v216, v144
  v_mfma_f32_16x16x32_bf16 a[120:123], a[188:191], v[184:187], a[120:123]
  s_waitcnt lgkmcnt(3)
  ds_read_b128 a[156:159], v3 offset:15360
  v_cvt_pk_bf16_f32 v183, v222, v223
  v_add_u32 v3, s66, v2
  v_mfma_f32_16x16x32_bf16 a[124:127], a[188:191], v[188:191], a[124:127]
  s_cbranch_vccnz fa_stub23
fa_back23:
  v_exp_f32 v217, v145
  v_add_f32 v230, v230, v226
  v_add_f32 v231, v231, v227
fa_SSW2:
  v_mfma_f32_16x16x32_bf16 v[128:131], a[128:131], v[64:67], v[200:203]
  s_waitcnt vmcnt(12)
  v_exp_f32 v218, v146
  v_mfma_f32_16x16x32_bf16 v[136:139], a[128:131], v[68:71], v[204:207]
  s_barrier
  v_exp_f32 v219, v147
  v_mfma_f32_16x16x32_bf16 v[132:135], a[132:135], v[64:67], v[200:203]
  s_cmp_ge_u32 s26, s46
  s_cselect_b64 s[44:45], s[4:5], s[44:45]
  s_cselect_b32 s46, s30, s46
  ds_read_b128 a[160:163], v3 offset:16384
  ds_read_b128 a[164:167], v3 offset:17408
  v_add_f32 v226, v216, v217
  v_mfma_f32_16x16x32_bf16 v[140:143], a[132:135], v[68:71], v[204:207]
  s_mov_b32 m0, s24
  v_exp_f32 v220, v148
  v_mfma_f32_16x16x32_bf16 v[128:131], a[136:139], v[72:75], v[128:131]
  ds_read_b128 a[168:171], v3 offset:18432
  buffer_load_dwordx4 v2, s[44:47], s26 offen offset:0 sc1 lds
  v_cvt_pk_bf16_f32 v184, v216, v217
  v_mfma_f32_16x16x32_bf16 v[136:139], a[136:139], v[76:79], v[136:139]
  v_exp_f32 v221, v149
  v_mfma_f32_16x16x32_bf16 v[132:135], a[140:143], v[72:75], v[132:135]
  ds_read_b128 a[172:175], v3 offset:19456
  v_add_f32 v226, v226, v218
  v_add_f32 v226, v226, v219
  v_mfma_f32_16x16x32_bf16 v[140:143], a[140:143], v[76:79], v[140:143]
  s_waitcnt lgkmcnt(4)
  v_exp_f32 v222, v150
  v_mfma_f32_16x16x32_bf16 v[128:131], a[144:147], v[80:83], v[128:131]
  s_add_u32 s14, s13, 36864
  ds_read_b128 a[176:179], v3 offset:20480
  buffer_load_dwordx4 v[48:51], v2, s[40:43], s14 offen offset:0 sc1
  v_cvt_pk_bf16_f32 v185, v218, v219
  v_mfma_f32_16x16x32_bf16 v[136:139], a[144:147], v[84:87], v[136:139]
  v_exp_f32 v223, v151
  v_mfma_f32_16x16x32_bf16 v[132:135], a[148:151], v[80:83], v[132:135]
  ds_read_b128 a[180:183], v3 offset:21504
  buffer_load_dwordx4 v2, s[44:47], s26 offen offset:1024 sc1 lds
  v_add_f32 v226, v226, v220
  v_mfma_f32_16x16x32_bf16 v[140:143], a[148:151], v[84:87], v[140:143]
  v_exp_f32 v216, v152
  v_mfma_f32_16x16x32_bf16 v[128:131], a[152:155], v[88:91], v[128:131]
  ds_read_b128 a[184:187], v3 offset:22528
  v_add_f32 v226, v226, v221
  v_cvt_pk_bf16_f32 v186, v220, v221
  v_mfma_f32_16x16x32_bf16 v[136:139], a[152:155], v[92:95], v[136:139]
  v_exp_f32 v217, v153
  v_mfma_f32_16x16x32_bf16 v[132:135], a[156:159], v[88:91], v[132:135]
  ds_read_b128 a[188:191], v3 offset:23552
  buffer_load_dwordx4 v[52:55], v2, s[40:43], s14 offen offset:1024 sc1
  v_add_f32 v226, v226, v222
  v_mfma_f32_16x16x32_bf16 v[140:143], a[156:159], v[92:95], v[140:143]
  s_waitcnt lgkmcnt(4)
  v_exp_f32 v218, v154
  v_mfma_f32_16x16x32_bf16 a[64:67], a[160:163], v[176:179], a[64:67]
  ds_read_b128 a[128:131], v3 offset:0
  v_add_f32 v226, v226, v223
  v_cvt_pk_bf16_f32 v187, v222, v223
  v_mfma_f32_16x16x32_bf16 a[68:71], a[160:163], v[180:183], a[68:71]
  v_exp_f32 v219, v155
  v_mfma_f32_16x16x32_bf16 a[72:75], a[164:167], v[176:179], a[72:75]
  ds_read_b128 a[132:135], v3 offset:1024
  buffer_load_dwordx4 v2, s[44:47], s26 offen offset:2048 sc1 lds
  v_add_f32 v227, v216, v217
  v_mfma_f32_16x16x32_bf16 a[76:79], a[164:167], v[180:183], a[76:79]
  v_exp_f32 v220, v156
  v_mfma_f32_16x16x32_bf16 a[80:83], a[168:171], v[176:179], a[80:83]
  ds_read_b128 a[136:139], v3 offset:2048
  v_cvt_pk_bf16_f32 v188, v216, v217
  v_mfma_f32_16x16x32_bf16 a[84:87], a[168:171], v[180:183], a[84:87]
  v_exp_f32 v221, v157
  v_mfma_f32_16x16x32_bf16 a[88:91], a[172:175], v[176:179], a[88:91]
  ds_read_b128 a[140:143], v3 offset:3072
  buffer_load_dwordx4 v[56:59], v2, s[40:43], s14 offen offset:2048 sc1
  v_add_f32 v227, v227, v218
  v_add_f32 v227, v227, v219
  v_mfma_f32_16x16x32_bf16 a[92:95], a[172:175], v[180:183], a[92:95]
  s_waitcnt lgkmcnt(4)
  v_exp_f32 v222, v158
  v_mfma_f32_16x16x32_bf16 a[96:99], a[176:179], v[176:179], a[96:99]
  ds_read_b128 a[144:147], v3 offset:4096
  buffer_load_dwordx4 v2, s[44:47], s26 offen offset:3072 sc1 lds
  v_cvt_pk_bf16_f32 v189, v218, v219
  v_mfma_f32_16x16x32_bf16 a[100:103], a[176:179], v[180:183], a[100:103]
  s_add_u32 s26, s26, 16384
  v_exp_f32 v223, v159
  v_mfma_f32_16x16x32_bf16 a[104:107], a[180:183], v[176:179], a[104:107]
  s_add_u32 s24, s24, 32768
  ds_read_b128 a[148:151], v3 offset:5120
  v_add_f32 v227, v227, v220
  v_mfma_f32_16x16x32_bf16 a[108:111], a[180:183], v[180:183], a[108:111]
  s_and_b32 s24, s24, 0x1ffff
  v_add_f32 v227, v227, v221
  v_cvt_pk_bf16_f32 v190, v220, v221
  v_add_f32 v227, v227, v222
  v_mfma_f32_16x16x32_bf16 a[112:115], a[184:187], v[176:179], a[112:115]
  ds_read_b128 a[152:155], v3 offset:6144
  v_add_f32 v227, v227, v223
  v_max_f32 v5, v226, v227
  v_cmp_lt_f32 vcc, s81, v5
  v_mfma_f32_16x16x32_bf16 a[116:119], a[184:187], v[180:183], a[116:119]
  v_exp_f32 v216, v128
  v_mfma_f32_16x16x32_bf16 a[120:123], a[188:191], v[176:179], a[120:123]
  s_waitcnt lgkmcnt(3)
  ds_read_b128 a[156:159], v3 offset:7168
  v_cvt_pk_bf16_f32 v191, v222, v223
  v_mfma_f32_16x16x32_bf16 a[124:127], a[188:191], v[180:183], a[124:127]
  s_cbranch_vccnz fa_stub24
fa_back24:
  v_exp_f32 v217, v129
  v_add_f32 v230, v230, v226
  v_add_f32 v231, v231, v227
  v_mfma_f32_16x16x32_bf16 v[144:147], a[128:131], v[64:67], v[200:203]
  ds_read_b128 a[160:163], v3 offset:24576
  v_add_f32 v226, v216, v217
  v_mfma_f32_16x16x32_bf16 v[152:155], a[128:131], v[68:71], v[204:207]
  v_exp_f32 v218, v130
  v_mfma_f32_16x16x32_bf16 v[148:151], a[132:135], v[64:67], v[200:203]
  s_cmp_ge_u32 s27, s50
  s_cselect_b64 s[48:49], s[6:7], s[48:49]
  s_cselect_b32 s50, s30, s50
  ds_read_b128 a[164:167], v3 offset:25600
  v_cvt_pk_bf16_f32 v176, v216, v217
  v_mfma_f32_16x16x32_bf16 v[156:159], a[132:135], v[68:71], v[204:207]
  s_mov_b32 m0, s25
  v_exp_f32 v219, v131
  v_mfma_f32_16x16x32_bf16 v[144:147], a[136:139], v[72:75], v[144:147]
  s_add_u32 s66, s66, 32768
  ds_read_b128 a[168:171], v3 offset:26624
  buffer_load_dwordx4 v2, s[48:51], s27 offen offset:0 sc1 lds
  v_add_f32 v226, v226, v218
  v_add_f32 v226, v226, v219
  v_mfma_f32_16x16x32_bf16 v[152:155], a[136:139], v[76:79], v[152:155]
  s_and_b32 s66, s66, 0x1ffff
  v_exp_f32 v220, v132
  v_mfma_f32_16x16x32_bf16 v[148:151], a[140:143], v[72:75], v[148:151]
  ds_read_b128 a[172:175], v3 offset:27648
  v_cvt_pk_bf16_f32 v177, v218, v219
  v_mfma_f32_16x16x32_bf16 v[156:159], a[140:143], v[76:79], v[156:159]
  s_waitcnt lgkmcnt(4)
  v_exp_f32 v221, v133
  v_mfma_f32_16x16x32_bf16 v[144:147], a[144:147], v[80:83], v[144:147]
  s_add_u32 s14, s13, 36864
  ds_read_b128 a[176:179], v3 offset:28672
  buffer_load_dwordx4 v[60:63], v2, s[40:43], s14 offen offset:3072 sc1
  v_add_f32 v226, v226, v220
  v_mfma_f32_16x16x32_bf16 v[152:155], a[144:147], v[84:87], v[152:155]
  v_exp_f32 v222, v134
  v_mfma_f32_16x16x32_bf16 v[148:151], a[148:151], v[80:83], v[148:151]
  ds_read_b128 a[180:183], v3 offset:29696
  buffer_load_dwordx4 v2, s[48:51], s27 offen offset:1024 sc1 lds
  v_add_f32 v226, v226, v221
  v_cvt_pk_bf16_f32 v178, v220, v221
  v_mfma_f32_16x16x32_bf16 v[156:159], a[148:151], v[84:87], v[156:159]
  v_exp_f32 v223, v135
  v_mfma_f32_16x16x32_bf16 v[144:147], a[152:155], v[88:91], v[144:147]
  ds_read_b128 a[184:187], v3 offset:30720
  v_add_f32 v226, v226, v222
  v_mfma_f32_16x16x32_bf16 v[152:155], a[152:155], v[92:95], v[152:155]
  v_exp_f32 v216, v136
  v_mfma_f32_16x16x32_bf16 v[148:151], a[156:159], v[88:91], v[148:151]
  s_add_u32 s14, s13, 40960
  ds_read_b128 a[188:191], v3 offset:31744
  buffer_load_dwordx4 v[96:99], v2, s[40:43], s14 offen offset:0 sc1
  v_add_f32 v226, v226, v223
  v_exp_f32 v217, v137
  v_mfma_f32_16x16x32_bf16 v[156:159], a[156:159], v[92:95], v[156:159]
  s_waitcnt lgkmcnt(4)
  v_exp_f32 v218, v138
  v_mfma_f32_16x16x32_bf16 a[64:67], a[160:163], v[184:187], a[64:67]
  ds_read_b128 a[128:131], v3 offset:8192
  v_cvt_pk_bf16_f32 v179, v222, v223
  v_mfma_f32_16x16x32_bf16 a[68:71], a[160:163], v[188:191], a[68:71]
  v_exp_f32 v219, v139
  v_mfma_f32_16x16x32_bf16 a[72:75], a[164:167], v[184:187], a[72:75]
  ds_read_b128 a[132:135], v3 offset:9216
  buffer_load_dwordx4 v2, s[48:51], s27 offen offset:2048 sc1 lds
  v_add_f32 v227, v216, v217
  v_mfma_f32_16x16x32_bf16 a[76:79], a[164:167], v[188:191], a[76:79]
  v_exp_f32 v220, v140
  v_mfma_f32_16x16x32_bf16 a[80:83], a[168:171], v[184:187], a[80:83]
  ds_read_b128 a[136:139], v3 offset:10240
  v_cvt_pk_bf16_f32 v180, v216, v217
  v_mfma_f32_16x16x32_bf16 a[84:87], a[168:171], v[188:191], a[84:87]
  v_exp_f32 v221, v141
  v_mfma_f32_16x16x32_bf16 a[88:91], a[172:175], v[184:187], a[88:91]
  ds_read_b128 a[140:143], v3 offset:11264
  buffer_load_dwordx4 v[100:103], v2, s[40:43], s14 offen offset:1024 sc1
  v_add_f32 v227, v227, v218
  v_mfma_f32_16x16x32_bf16 a[92:95], a[172:175], v[188:191], a[92:95]
  s_waitcnt lgkmcnt(4)
  v_exp_f32 v222, v142
  v_mfma_f32_16x16x32_bf16 a[96:99], a[176:179], v[184:187], a[96:99]
  ds_read_b128 a[144:147], v3 offset:12288
  buffer_load_dwordx4 v2, s[48:51], s27 offen offset:3072 sc1 lds
  v_add_f32 v227, v227, v219
  v_cvt_pk_bf16_f32 v181, v218, v219
  v_mfma_f32_16x16x32_bf16 a[100:103], a[176:179], v[188:191], a[100:103]
  s_add_u32 s27, s27, 16384
  v_exp_f32 v223, v143
  v_mfma_f32_16x16x32_bf16 a[104:107], a[180:183], v[184:187], a[104:107]
  s_add_u32 s25, s25, 32768
  ds_read_b128 a[148:151], v3 offset:13312
  v_add_f32 v227, v227, v220
  v_mfma_f32_16x16x32_bf16 a[108:111], a[180:183], v[188:191], a[108:111]
  s_and_b32 s25, s25, 0x1ffff
  v_add_f32 v227, v227, v221
  v_cvt_pk_bf16_f32 v182, v220, v221
  v_add_f32 v227, v227, v222
  v_mfma_f32_16x16x32_bf16 a[112:115], a[184:187], v[184:187], a[112:115]
  ds_read_b128 a[152:155], v3 offset:14336
  v_add_f32 v227, v227, v223
  v_max_f32 v5, v226, v227
  v_cmp_lt_f32 vcc, s81, v5
  v_mfma_f32_16x16x32_bf16 a[116:119], a[184:187], v[188:191], a[116:119]
  v_exp_f32 v216, v144
  v_mfma_f32_16x16x32_bf16 a[120:123], a[188:191], v[184:187], a[120:123]
  s_waitcnt lgkmcnt(3)
  ds_read_b128 a[156:159], v3 offset:15360
  v_cvt_pk_bf16_f32 v183, v222, v223
  v_add_u32 v3, s66, v2
  v_mfma_f32_16x16x32_bf16 a[124:127], a[188:191], v[188:191], a[124:127]
  s_cbranch_vccnz fa_stub25
fa_back25:
  v_exp_f32 v217, v145
  v_add_f32 v230, v230, v226
  v_add_f32 v231, v231, v227
fa_SSW1:
  v_mfma_f32_16x16x32_bf16 v[128:131], a[128:131], v[64:67], v[200:203]
  s_waitcnt vmcnt(8)
  v_exp_f32 v218, v146
  v_mfma_f32_16x16x32_bf16 v[136:139], a[128:131], v[68:71], v[204:207]
  s_barrier
  v_exp_f32 v219, v147
  v_mfma_f32_16x16x32_bf16 v[132:135], a[132:135], v[64:67], v[200:203]
  s_cmp_ge_u32 s26, s46
  s_cselect_b64 s[44:45], s[4:5], s[44:45]
  s_cselect_b32 s46, s30, s46
  ds_read_b128 a[160:163], v3 offset:16384
  ds_read_b128 a[164:167], v3 offset:17408
  v_add_f32 v226, v216, v217
  v_mfma_f32_16x16x32_bf16 v[140:143], a[132:135], v[68:71], v[204:207]
  s_mov_b32 m0, s24
  v_exp_f32 v220, v148
  v_mfma_f32_16x16x32_bf16 v[128:131], a[136:139], v[72:75], v[128:131]
  ds_read_b128 a[168:171], v3 offset:18432
  buffer_load_dwordx4 v2, s[44:47], s26 offen offset:0 sc1 lds
  v_cvt_pk_bf16_f32 v184, v216, v217
  v_mfma_f32_16x16x32_bf16 v[136:139], a[136:139], v[76:79], v[136:139]
  v_exp_f32 v221, v149
  v_mfma_f32_16x16x32_bf16 v[132:135], a[140:143], v[72:75], v[132:135]
  ds_read_b128 a[172:175], v3 offset:19456
  v_add_f32 v226, v226, v218
  v_add_f32 v226, v226, v219
  v_mfma_f32_16x16x32_bf16 v[140:143], a[140:143], v[76:79], v[140:143]
  s_waitcnt lgkmcnt(4)
  v_exp_f32 v222, v150
  v_mfma_f32_16x16x32_bf16 v[128:131], a[144:147], v[80:83], v[128:131]
  s_add_u32 s14, s13, 40960
  ds_read_b128 a[176:179], v3 offset:20480
  buffer_load_dwordx4 v[104:107], v2, s[40:43], s14 offen offset:2048 sc1
  v_cvt_pk_bf16_f32 v185, v218, v219
  v_mfma_f32_16x16x32_bf16 v[136:139], a[144:147], v[84:87], v[136:139]
  v_exp_f32 v223, v151
  v_mfma_f32_16x16x32_bf16 v[132:135], a[148:151], v[80:83], v[132:135]
  ds_read_b128 a[180:183], v3 offset:21504
  buffer_load_dwordx4 v2, s[44:47], s26 offen offset:1024 sc1 lds
  v_add_f32 v226, v226, v220
  v_mfma_f32_16x16x32_bf16 v[140:143], a[148:151], v[84:87], v[140:143]
  v_exp_f32 v216, v152
  v_mfma_f32_16x16x32_bf16 v[128:131], a[152:155], v[88:91], v[128:131]
  ds_read_b128 a[184:187], v3 offset:22528
  v_add_f32 v226, v226, v221
  v_cvt_pk_bf16_f32 v186, v220, v221
  v_mfma_f32_16x16x32_bf16 v[136:139], a[152:155], v[92:95], v[136:139]
  v_exp_f32 v217, v153
  v_mfma_f32_16x16x32_bf16 v[132:135], a[156:159], v[88:91], v[132:135]
  ds_read_b128 a[188:191], v3 offset:23552
  buffer_load_dwordx4 v[108:111], v2, s[40:43], s14 offen offset:3072 sc1
  v_add_f32 v226, v226, v222
  v_mfma_f32_16x16x32_bf16 v[140:143], a[156:159], v[92:95], v[140:143]
  s_waitcnt lgkmcnt(4)
  v_exp_f32 v218, v154
  v_mfma_f32_16x16x32_bf16 a[64:67], a[160:163], v[176:179], a[64:67]
  ds_read_b128 a[128:131], v3 offset:0
  v_add_f32 v226, v226, v223
  v_cvt_pk_bf16_f32 v187, v222, v223
  v_mfma_f32_16x16x32_bf16 a[68:71], a[160:163], v[180:183], a[68:71]
  v_exp_f32 v219, v155
  v_mfma_f32_16x16x32_bf16 a[72:75], a[164:167], v[176:179], a[72:75]
  ds_read_b128 a[132:135], v3 offset:1024
  buffer_load_dwordx4 v2, s[44:47], s26 offen offset:2048 sc1 lds
  v_add_f32 v227, v216, v217
  v_mfma_f32_16x16x32_bf16 a[76:79], a[164:167], v[180:183], a[76:79]
  v_exp_f32 v220, v156
  v_mfma_f32_16x16x32_bf16 a[80:83], a[168:171], v[176:179], a[80:83]
  ds_read_b128 a[136:139], v3 offset:2048
  v_cvt_pk_bf16_f32 v188, v216, v217
  v_mfma_f32_16x16x32_bf16 a[84:87], a[168:171], v[180:183], a[84:87]
  v_exp_f32 v221, v157
  v_mfma_f32_16x16x32_bf16 a[88:91], a[172:175], v[176:179], a[88:91]
  s_add_u32 s14, s13, 45056
  ds_read_b128 a[140:143], v3 offset:3072
  buffer_load_dwordx4 v[112:115], v2, s[40:43], s14 offen offset:0 sc1
  v_add_f32 v227, v227, v218
  v_add_f32 v227, v227, v219
  v_mfma_f32_16x16x32_bf16 a[92:95], a[172:175], v[180:183], a[92:95]
  s_waitcnt lgkmcnt(4)
  v_exp_f32 v222, v158
  v_mfma_f32_16x16x32_bf16 a[96:99], a[176:179], v[176:179], a[96:99]
  ds_read_b128 a[144:147], v3 offset:4096
  buffer_load_dwordx4 v2, s[44:47], s26 offen offset:3072 sc1 lds
  v_cvt_pk_bf16_f32 v189, v218, v219
  v_mfma_f32_16x16x32_bf16 a[100:103], a[176:179], v[180:183], a[100:103]
  s_add_u32 s26, s26, 16384
  v_exp_f32 v223, v159
  v_mfma_f32_16x16x32_bf16 a[104:107], a[180:183], v[176:179], a[104:107]
  s_add_u32 s24, s24, 32768
  ds_read_b128 a[148:151], v3 offset:5120
  v_add_f32 v227, v227, v220
  v_mfma_f32_16x16x32_bf16 a[108:111], a[180:183], v[180:183], a[108:111]
  s_and_b32 s24, s24, 0x1ffff
  v_add_f32 v227, v227, v221
  v_cvt_pk_bf16_f32 v190, v220, v221
  v_add_f32 v227, v227, v222
  v_mfma_f32_16x16x32_bf16 a[112:115], a[184:187], v[176:179], a[112:115]
  ds_read_b128 a[152:155], v3 offset:6144
  v_add_f32 v227, v227, v223
  v_max_f32 v5, v226, v227
  v_cmp_lt_f32 vcc, s81, v5
  v_mfma_f32_16x16x32_bf16 a[116:119], a[184:187], v[180:183], a[116:119]
  v_exp_f32 v216, v128
  v_mfma_f32_16x16x32_bf16 a[120:123], a[188:191], v[176:179], a[120:123]
  s_waitcnt lgkmcnt(3)
  ds_read_b128 a[156:159], v3 offset:7168
  v_cvt_pk_bf16_f32 v191, v222, v223
  v_mfma_f32_16x16x32_bf16 a[124:127], a[188:191], v[180:183], a[124:127]
  s_cbranch_vccnz fa_stub26
fa_back26:
  v_exp_f32 v217, v129
  v_add_f32 v230, v230, v226
  v_add_f32 v231, v231, v227
  v_mfma_f32_16x16x32_bf16 v[144:147], a[128:131], v[64:67], v[200:203]
  ds_read_b128 a[160:163], v3 offset:24576
  v_add_f32 v226, v216, v217
  v_mfma_f32_16x16x32_bf16 v[152:155], a[128:131], v[68:71], v[204:207]
  v_exp_f32 v218, v130
  v_mfma_f32_16x16x32_bf16 v[148:151], a[132:135], v[64:67], v[200:203]
  s_cmp_ge_u32 s27, s50
  s_cselect_b64 s[48:49], s[6:7], s[48:49]
  s_cselect_b32 s50, s30, s50
  ds_read_b128 a[164:167], v3 offset:25600
  v_cvt_pk_bf16_f32 v176, v216, v217
  v_mfma_f32_16x16x32_bf16 v[156:159], a[132:135], v[68:71], v[204:207]
  s_mov_b32 m0, s25
  v_exp_f32 v219, v131
  v_mfma_f32_16x16x32_bf16 v[144:147], a[136:139], v[72:75], v[144:147]
  s_add_u32 s66, s66, 32768
  ds_read_b128 a[168:171], v3 offset:26624
  buffer_load_dwordx4 v2, s[48:51], s27 offen offset:0 sc1 lds
  v_add_f32 v226, v226, v218
  v_add_f32 v226, v226, v219
  v_mfma_f32_16x16x32_bf16 v[152:155], a[136:139], v[76:79], v[152:155]
  s_and_b32 s66, s66, 0x1ffff
  v_exp_f32 v220, v132
  v_mfma_f32_16x16x32_bf16 v[148:151], a[140:143], v[72:75], v[148:151]
  ds_read_b128 a[172:175], v3 offset:27648
  v_cvt_pk_bf16_f32 v177, v218, v219
  v_mfma_f32_16x16x32_bf16 v[156:159], a[140:143], v[76:79], v[156:159]
  s_waitcnt lgkmcnt(4)
  v_exp_f32 v221, v133
  v_mfma_f32_16x16x32_bf16 v[144:147], a[144:147], v[80:83], v[144:147]
  s_add_u32 s14, s13, 45056
  ds_read_b128 a[176:179], v3 offset:28672
  buffer_load_dwordx4 v[116:119], v2, s[40:43], s14 offen offset:1024 sc1
  v_add_f32 v226, v226, v220
  v_mfma_f32_16x16x32_bf16 v[152:155], a[144:147], v[84:87], v[152:155]
  v_exp_f32 v222, v134
  v_mfma_f32_16x16x32_bf16 v[148:151], a[148:151], v[80:83], v[148:151]
  ds_read_b128 a[180:183], v3 offset:29696
  buffer_load_dwordx4 v2, s[48:51], s27 offen offset:1024 sc1 lds
  v_add_f32 v226, v226, v221
  v_cvt_pk_bf16_f32 v178, v220, v221
  v_mfma_f32_16x16x32_bf16 v[156:159], a[148:151], v[84:87], v[156:159]
  v_exp_f32 v223, v135
  v_mfma_f32_16x16x32_bf16 v[144:147], a[152:155], v[88:91], v[144:147]
  ds_read_b128 a[184:187], v3 offset:30720
  v_add_f32 v226, v226, v222
  v_mfma_f32_16x16x32_bf16 v[152:155], a[152:155], v[92:95], v[152:155]
  v_exp_f32 v216, v136
  v_mfma_f32_16x16x32_bf16 v[148:151], a[156:159], v[88:91], v[148:151]
  ds_read_b128 a[188:191], v3 offset:31744
  buffer_load_dwordx4 v[120:123], v2, s[40:43], s14 offen offset:2048 sc1
  v_add_f32 v226, v226, v223
  v_exp_f32 v217, v137
  v_mfma_f32_16x16x32_bf16 v[156:159], a[156:159], v[92:95], v[156:159]
  s_waitcnt lgkmcnt(4)
  v_exp_f32 v218, v138
  v_mfma_f32_16x16x32_bf16 a[64:67], a[160:163], v[184:187], a[64:67]
  ds_read_b128 a[128:131], v3 offset:8192
  v_cvt_pk_bf16_f32 v179, v222, v223
  v_mfma_f32_16x16x32_bf16 a[68:71], a[160:163], v[188:191], a[68:71]
  v_exp_f32 v219, v139
  v_mfma_f32_16x16x32_bf16 a[72:75], a[164:167], v[184:187], a[72:75]
  ds_read_b128 a[132:135], v3 offset:9216
  buffer_load_dwordx4 v2, s[48:51], s27 offen offset:2048 sc1 lds
  v_add_f32 v227, v216, v217
  v_mfma_f32_16x16x32_bf16 a[76:79], a[164:167], v[188:191], a[76:79]
  v_exp_f32 v220, v140
  v_mfma_f32_16x16x32_bf16 a[80:83], a[168:171], v[184:187], a[80:83]
  ds_read_b128 a[136:139], v3 offset:10240
  v_cvt_pk_bf16_f32 v180, v216, v217
  v_mfma_f32_16x16x32_bf16 a[84:87], a[168:171], v[188:191], a[84:87]
  v_exp_f32 v221, v141
  v_mfma_f32_16x16x32_bf16 a[88:91], a[172:175], v[184:187], a[88:91]
  ds_read_b128 a[140:143], v3 offset:11264
  buffer_load_dwordx4 v[124:127], v2, s[40:43], s14 offen offset:3072 sc1
  v_add_f32 v227, v227, v218
  v_mfma_f32_16x16x32_bf16 a[92:95], a[172:175], v[188:191], a[92:95]
  s_waitcnt lgkmcnt(4)
  v_exp_f32 v222, v142
  v_mfma_f32_16x16x32_bf16 a[96:99], a[176:179], v[184:187], a[96:99]
  ds_read_b128 a[144:147], v3 offset:12288
  buffer_load_dwordx4 v2, s[48:51], s27 offen offset:3072 sc1 lds
  v_add_f32 v227, v227, v219
  v_cvt_pk_bf16_f32 v181, v218, v219
  v_mfma_f32_16x16x32_bf16 a[100:103], a[176:179], v[188:191], a[100:103]
  s_add_u32 s27, s27, 16384
  v_exp_f32 v223, v143
  v_mfma_f32_16x16x32_bf16 a[104:107], a[180:183], v[184:187], a[104:107]
  s_add_u32 s25, s25, 32768
  ds_read_b128 a[148:151], v3 offset:13312
  v_add_f32 v227, v227, v220
  v_mfma_f32_16x16x32_bf16 a[108:111], a[180:183], v[188:191], a[108:111]
  s_and_b32 s25, s25, 0x1ffff
  v_add_f32 v227, v227, v221
  v_cvt_pk_bf16_f32 v182, v220, v221
  v_add_f32 v227, v227, v222
  v_mfma_f32_16x16x32_bf16 a[112:115], a[184:187], v[184:187], a[112:115]
  ds_read_b128 a[152:155], v3 offset:14336
  v_add_f32 v227, v227, v223
  v_max_f32 v5, v226, v227
  v_cmp_lt_f32 vcc, s81, v5
  v_mfma_f32_16x16x32_bf16 a[116:119], a[184:187], v[188:191], a[116:119]
  v_exp_f32 v216, v144
  v_mfma_f32_16x16x32_bf16 a[120:123], a[188:191], v[184:187], a[120:123]
  s_waitcnt lgkmcnt(3)
  ds_read_b128 a[156:159], v3 offset:15360
  v_cvt_pk_bf16_f32 v183, v222, v223
  v_add_u32 v3, s66, v2
  v_mfma_f32_16x16x32_bf16 a[124:127], a[188:191], v[188:191], a[124:127]
  s_cbranch_vccnz fa_stub27
fa_back27:
  v_exp_f32 v217, v145
  v_add_f32 v230, v230, v226
  v_add_f32 v231, v231, v227
fa_Bexit:
  s_bitcmp1_b32 s20, 0
  s_cbranch_scc1 fa_Bodd
  v_mfma_f32_16x16x32_bf16 v[128:131], a[128:131], v[64:67], v[200:203]
  s_waitcnt vmcnt(8)
  v_exp_f32 v218, v146
  v_mfma_f32_16x16x32_bf16 v[136:139], a[128:131], v[68:71], v[204:207]
  s_barrier
  v_exp_f32 v219, v147
  v_mfma_f32_16x16x32_bf16 v[132:135], a[132:135], v[64:67], v[200:203]
  ds_read_b128 a[160:163], v3 offset:16384
  ds_read_b128 a[164:167], v3 offset:17408
  v_add_f32 v226, v216, v217
  v_mfma_f32_16x16x32_bf16 v[140:143], a[132:135], v[68:71], v[204:207]
  s_add_u32 s14, s13, 49152
  buffer_load_dwordx4 v[160:163], v2, s[40:43], s14 offen offset:0 sc1
  v_cvt_pk_bf16_f32 v184, v216, v217
  v_mfma_f32_16x16x32_bf16 v[128:131], a[136:139], v[72:75], v[128:131]
  ds_read_b128 a[168:171], v3 offset:18432
  v_add_f32 v226, v226, v218
  v_mfma_f32_16x16x32_bf16 v[136:139], a[136:139], v[76:79], v[136:139]
  v_exp_f32 v220, v148
  v_mfma_f32_16x16x32_bf16 v[132:135], a[140:143], v[72:75], v[132:135]
  ds_read_b128 a[172:175], v3 offset:19456
  v_add_f32 v226, v226, v219
  v_cvt_pk_bf16_f32 v185, v218, v219
  v_mfma_f32_16x16x32_bf16 v[140:143], a[140:143], v[76:79], v[140:143]
  s_waitcnt lgkmcnt(4)
  buffer_load_dwordx4 v[164:167], v2, s[40:43], s14 offen offset:1024 sc1
  v_add_f32 v226, v226, v220
  v_mfma_f32_16x16x32_bf16 v[128:131], a[144:147], v[80:83], v[128:131]
  ds_read_b128 a[176:179], v3 offset:20480
  v_mfma_f32_16x16x32_bf16 v[136:139], a[144:147], v[84:87], v[136:139]
  v_exp_f32 v221, v149
  v_mfma_f32_16x16x32_bf16 v[132:135], a[148:151], v[80:83], v[132:135]
  ds_read_b128 a[180:183], v3 offset:21504
  v_add_f32 v226, v226, v221
  v_mfma_f32_16x16x32_bf16 v[140:143], a[148:151], v[84:87], v[140:143]
  v_exp_f32 v222, v150
  v_mfma_f32_16x16x32_bf16 v[128:131], a[152:155], v[88:91], v[128:131]
  ds_read_b128 a[184:187], v3 offset:22528
  buffer_load_dwordx4 v[168:171], v2, s[40:43], s14 offen offset:2048 sc1
  v_cvt_pk_bf16_f32 v186, v220, v221
  v_mfma_f32_16x16x32_bf16 v[136:139], a[152:155], v[92:95], v[136:139]
  v_exp_f32 v223, v151
  v_mfma_f32_16x16x32_bf16 v[132:135], a[156:159], v[88:91], v[132:135]
  ds_read_b128 a[188:191], v3 offset:23552
  v_add_f32 v226, v226, v222
  v_add_f32 v226, v226, v223
  v_mfma_f32_16x16x32_bf16 v[140:143], a[156:159], v[92:95], v[140:143]
  s_waitcnt lgkmcnt(4)
  v_exp_f32 v216, v152
  v_mfma_f32_16x16x32_bf16 a[64:67], a[160:163], v[176:179], a[64:67]
  v_exp_f32 v217, v153
  v_mfma_f32_16x16x32_bf16 a[68:71], a[160:163], v[180:183], a[68:71]
  buffer_load_dwordx4 v[172:175], v2, s[40:43], s14 offen offset:3072 sc1
  v_cvt_pk_bf16_f32 v187, v222, v223
  v_add_f32 v227, v216, v217
  v_mfma_f32_16x16x32_bf16 a[72:75], a[164:167], v[176:179], a[72:75]
  v_exp_f32 v218, v154
  v_mfma_f32_16x16x32_bf16 a[76:79], a[164:167], v[180:183], a[76:79]
  v_exp_f32 v219, v155
  v_mfma_f32_16x16x32_bf16 a[80:83], a[168:171], v[176:179], a[80:83]
  v_exp_f32 v220, v156
  v_mfma_f32_16x16x32_bf16 a[84:87], a[168:171], v[180:183], a[84:87]
  s_add_u32 s14, s13, 53248
  buffer_load_dwordx4 v[192:195], v2, s[40:43], s14 offen offset:0 sc1
  v_cvt_pk_bf16_f32 v188, v216, v217
  v_add_f32 v227, v227, v218
  v_mfma_f32_16x16x32_bf16 a[88:91], a[172:175], v[176:179], a[88:91]
  v_exp_f32 v221, v157
  v_mfma_f32_16x16x32_bf16 a[92:95], a[172:175], v[180:183], a[92:95]
  s_waitcnt lgkmcnt(0)
  v_exp_f32 v222, v158
  v_mfma_f32_16x16x32_bf16 a[96:99], a[176:179], v[176:179], a[96:99]
  v_add_f32 v227, v227, v219
  v_cvt_pk_bf16_f32 v189, v218, v219
  v_mfma_f32_16x16x32_bf16 a[100:103], a[176:179], v[180:183], a[100:103]
  v_exp_f32 v223, v159
  v_mfma_f32_16x16x32_bf16 a[104:107], a[180:183], v[176:179], a[104:107]
  buffer_load_dwordx4 v[196:199], v2, s[40:43], s14 offen offset:1024 sc1
  v_add_f32 v227, v227, v220
  v_mfma_f32_16x16x32_bf16 a[108:111], a[180:183], v[180:183], a[108:111]
  v_add_f32 v227, v227, v221
  v_cvt_pk_bf16_f32 v190, v220, v221
  v_add_f32 v227, v227, v222
  v_mfma_f32_16x16x32_bf16 a[112:115], a[184:187], v[176:179], a[112:115]
  v_add_f32 v227, v227, v223
  v_max_f32 v5, v226, v227
  v_cmp_lt_f32 vcc, s81, v5
  v_mfma_f32_16x16x32_bf16 a[116:119], a[184:187], v[180:183], a[116:119]
  v_exp_f32 v216, v128
  v_mfma_f32_16x16x32_bf16 a[120:123], a[188:191], v[176:179], a[120:123]
  v_cvt_pk_bf16_f32 v191, v222, v223
  v_mfma_f32_16x16x32_bf16 a[124:127], a[188:191], v[180:183], a[124:127]
  s_cbranch_vccnz fa_stub28
fa_back28:
  v_exp_f32 v217, v129
  v_add_f32 v230, v230, v226
  v_add_f32 v231, v231, v227
  ds_read_b128 a[160:163], v3 offset:24576
  ds_read_b128 a[164:167], v3 offset:25600
  ds_read_b128 a[168:171], v3 offset:26624
  ds_read_b128 a[172:175], v3 offset:27648
  ds_read_b128 a[176:179], v3 offset:28672
  ds_read_b128 a[180:183], v3 offset:29696
  ds_read_b128 a[184:187], v3 offset:30720
  ds_read_b128 a[188:191], v3 offset:31744
  v_cndmask_b32 v128, v4, v128, s[68:69]
  v_cndmask_b32 v129, v4, v129, s[70:71]
  v_cndmask_b32 v130, v4, v130, s[72:73]
  v_cndmask_b32 v131, v4, v131, s[74:75]
  v_mov_b32 v132, v4
  v_mov_b32 v133, v4
  v_mov_b32 v134, v4
  v_mov_b32 v135, v4
  v_cndmask_b32 v140, v4, v140, s[68:69]
  v_cndmask_b32 v141, v4, v141, s[70:71]
  v_cndmask_b32 v142, v4, v142, s[72:73]
  v_cndmask_b32 v143, v4, v143, s[74:75]
  v_exp_f32 v216, v128
  v_exp_f32 v217, v129
  v_exp_f32 v218, v130
  v_add_f32 v226, v216, v217
  v_cvt_pk_bf16_f32 v176, v216, v217
  v_add_f32 v226, v226, v218
  v_exp_f32 v219, v131
  v_exp_f32 v220, v132
  v_add_f32 v226, v226, v219
  v_cvt_pk_bf16_f32 v177, v218, v219
  v_add_f32 v226, v226, v220
  v_exp_f32 v221, v133
  s_waitcnt lgkmcnt(4)
  v_mfma_f32_16x16x32_bf16 a[64:67], a[160:163], v[184:187], a[64:67]
  v_exp_f32 v222, v134
  v_add_f32 v226, v226, v221
  v_mfma_f32_16x16x32_bf16 a[68:71], a[160:163], v[188:191], a[68:71]
  s_add_u32 s14, s13, 53248
  buffer_load_dwordx4 v[208:211], v2, s[40:43], s14 offen offset:2048 sc1
  v_exp_f32 v223, v135
  v_mfma_f32_16x16x32_bf16 a[72:75], a[164:167], v[184:187], a[72:75]
  s_add_u32 s66, s66, 32768
  v_exp_f32 v216, v136
  v_mfma_f32_16x16x32_bf16 a[76:79], a[164:167], v[188:191], a[76:79]
  s_and_b32 s66, s66, 0x1ffff
  v_exp_f32 v217, v137
  v_mfma_f32_16x16x32_bf16 a[80:83], a[168:171], v[184:187], a[80:83]
  buffer_load_dwordx4 v[212:215], v2, s[40:43], s14 offen offset:3072 sc1
  v_cvt_pk_bf16_f32 v178, v220, v221
  v_add_f32 v226, v226, v222
  v_add_f32 v226, v226, v223
  v_cvt_pk_bf16_f32 v179, v222, v223
  v_mfma_f32_16x16x32_bf16 a[84:87], a[168:171], v[188:191], a[84:87]
  v_exp_f32 v218, v138
  v_mfma_f32_16x16x32_bf16 a[88:91], a[172:175], v[184:187], a[88:91]
  v_exp_f32 v219, v139
  v_mfma_f32_16x16x32_bf16 a[92:95], a[172:175], v[188:191], a[92:95]
  s_waitcnt lgkmcnt(0)
  v_exp_f32 v220, v140
  v_mfma_f32_16x16x32_bf16 a[96:99], a[176:179], v[184:187], a[96:99]
  s_add_u32 s14, s13, 57344
  buffer_load_dwordx4 v[232:235], v2, s[40:43], s14 offen offset:0 sc1
  v_add_f32 v227, v216, v217
  v_cvt_pk_bf16_f32 v180, v216, v217
  v_add_f32 v227, v227, v218
  v_add_f32 v227, v227, v219
  v_cvt_pk_bf16_f32 v181, v218, v219
  v_exp_f32 v221, v141
  v_mfma_f32_16x16x32_bf16 a[100:103], a[176:179], v[188:191], a[100:103]
  v_exp_f32 v222, v142
  v_mfma_f32_16x16x32_bf16 a[104:107], a[180:183], v[184:187], a[104:107]
  v_exp_f32 v223, v143
  v_mfma_f32_16x16x32_bf16 a[108:111], a[180:183], v[188:191], a[108:111]
  buffer_load_dwordx4 v[236:239], v2, s[40:43], s14 offen offset:1024 sc1
  v_add_f32 v227, v227, v220
  v_add_f32 v227, v227, v221
  v_cvt_pk_bf16_f32 v182, v220, v221
  v_add_f32 v227, v227, v222
  v_mfma_f32_16x16x32_bf16 a[112:115], a[184:187], v[184:187], a[112:115]
  v_add_f32 v227, v227, v223
  v_max_f32 v5, v226, v227
  v_cmp_lt_f32 vcc, s81, v5
  v_mfma_f32_16x16x32_bf16 a[116:119], a[184:187], v[188:191], a[116:119]
  v_mfma_f32_16x16x32_bf16 a[120:123], a[188:191], v[184:187], a[120:123]
  v_cvt_pk_bf16_f32 v183, v222, v223
  v_add_u32 v3, s66, v2
  v_mfma_f32_16x16x32_bf16 a[124:127], a[188:191], v[188:191], a[124:127]
  s_cbranch_vccnz fa_stub29
fa_back29:
  v_add_f32 v230, v230, v226
  v_add_f32 v231, v231, v227
  s_cmp_ge_u32 s20, 2
  s_cbranch_scc1 fa_nb0
  s_waitcnt vmcnt(10)
  s_barrier
fa_nb0:
  ds_read_b128 a[160:163], v3 offset:16384
  ds_read_b128 a[164:167], v3 offset:17408
  ds_read_b128 a[168:171], v3 offset:18432
  ds_read_b128 a[172:175], v3 offset:19456
  ds_read_b128 a[176:179], v3 offset:20480
  ds_read_b128 a[180:183], v3 offset:21504
  ds_read_b128 a[184:187], v3 offset:22528
  ds_read_b128 a[188:191], v3 offset:23552
  s_waitcnt lgkmcnt(4)
  v_mfma_f32_16x16x32_bf16 a[64:67], a[160:163], v[176:179], a[64:67]
  v_mfma_f32_16x16x32_bf16 a[68:71], a[160:163], v[180:183], a[68:71]
  s_add_u32 s14, s13, 57344
  buffer_load_dwordx4 v[240:243], v2, s[40:43], s14 offen offset:2048 sc1
  v_mfma_f32_16x16x32_bf16 a[72:75], a[164:167], v[176:179], a[72:75]
  v_mfma_f32_16x16x32_bf16 a[76:79], a[164:167], v[180:183], a[76:79]
  v_mfma_f32_16x16x32_bf16 a[80:83], a[168:171], v[176:179], a[80:83]
  v_mfma_f32_16x16x32_bf16 a[84:87], a[168:171], v[180:183], a[84:87]
  v_mfma_f32_16x16x32_bf16 a[88:91], a[172:175], v[176:179], a[88:91]
  v_mfma_f32_16x16x32_bf16 a[92:95], a[172:175], v[180:183], a[92:95]
  s_waitcnt lgkmcnt(0)
  v_mfma_f32_16x16x32_bf16 a[96:99], a[176:179], v[176:179], a[96:99]
  buffer_load_dwordx4 v[244:247], v2, s[40:43], s14 offen offset:3072 sc1
  v_mfma_f32_16x16x32_bf16 a[100:103], a[176:179], v[180:183], a[100:103]
  v_mfma_f32_16x16x32_bf16 a[104:107], a[180:183], v[176:179], a[104:107]
  v_mfma_f32_16x16x32_bf16 a[108:111], a[180:183], v[180:183], a[108:111]
  v_mfma_f32_16x16x32_bf16 a[112:115], a[184:187], v[176:179], a[112:115]
  v_mfma_f32_16x16x32_bf16 a[116:119], a[184:187], v[180:183], a[116:119]
  v_mfma_f32_16x16x32_bf16 a[120:123], a[188:191], v[176:179], a[120:123]
  v_mfma_f32_16x16x32_bf16 a[124:127], a[188:191], v[180:183], a[124:127]
  s_branch fa_Bdone
fa_Bodd:
  s_cmp_ge_u32 s20, 2
  s_cbranch_scc1 fa_nb1
  s_waitcnt vmcnt(8)
  s_barrier
fa_nb1:
  ds_read_b128 a[160:163], v3 offset:16384
  ds_read_b128 a[164:167], v3 offset:17408
  ds_read_b128 a[168:171], v3 offset:18432
  ds_read_b128 a[172:175], v3 offset:19456
  ds_read_b128 a[176:179], v3 offset:20480
  ds_read_b128 a[180:183], v3 offset:21504
  ds_read_b128 a[184:187], v3 offset:22528
  ds_read_b128 a[188:191], v3 offset:23552
  v_cndmask_b32 v144, v4, v144, s[68:69]
  v_cndmask_b32 v145, v4, v145, s[70:71]
  v_cndmask_b32 v146, v4, v146, s[72:73]
  v_cndmask_b32 v147, v4, v147, s[74:75]
  v_mov_b32 v148, v4
  v_mov_b32 v149, v4
  v_mov_b32 v150, v4
  v_mov_b32 v151, v4
  v_cndmask_b32 v156, v4, v156, s[68:69]
  v_cndmask_b32 v157, v4, v157, s[70:71]
  v_cndmask_b32 v158, v4, v158, s[72:73]
  v_cndmask_b32 v159, v4, v159, s[74:75]
  v_exp_f32 v216, v144
  v_exp_f32 v217, v145
  v_exp_f32 v218, v146
  v_add_f32 v226, v216, v217
  v_cvt_pk_bf16_f32 v184, v216, v217
  v_add_f32 v226, v226, v218
  v_exp_f32 v219, v147
  v_exp_f32 v220, v148
  v_add_f32 v226, v226, v219
  v_cvt_pk_bf16_f32 v185, v218, v219
  v_add_f32 v226, v226, v220
  v_exp_f32 v221, v149
  s_waitcnt lgkmcnt(4)
  v_mfma_f32_16x16x32_bf16 a[64:67], a[160:163], v[176:179], a[64:67]
  v_exp_f32 v222, v150
  v_add_f32 v226, v226, v221
  v_mfma_f32_16x16x32_bf16 a[68:71], a[160:163], v[180:183], a[68:71]
  s_add_u32 s14, s13, 49152
  buffer_load_dwordx4 v[160:163], v2, s[40:43], s14 offen offset:0 sc1
  v_exp_f32 v223, v151
  v_mfma_f32_16x16x32_bf16 a[72:75], a[164:167], v[176:179], a[72:75]
  v_exp_f32 v216, v152
  v_cvt_pk_bf16_f32 v186, v220, v221
  v_add_f32 v226, v226, v222
  v_mfma_f32_16x16x32_bf16 a[76:79], a[164:167], v[180:183], a[76:79]
  buffer_load_dwordx4 v[164:167], v2, s[40:43], s14 offen offset:1024 sc1
  v_exp_f32 v217, v153
  v_mfma_f32_16x16x32_bf16 a[80:83], a[168:171], v[176:179], a[80:83]
  v_exp_f32 v218, v154
  v_add_f32 v226, v226, v223
  v_mfma_f32_16x16x32_bf16 a[84:87], a[168:171], v[180:183], a[84:87]
  buffer_load_dwordx4 v[168:171], v2, s[40:43], s14 offen offset:2048 sc1
  v_exp_f32 v219, v155
  v_cvt_pk_bf16_f32 v187, v222, v223
  v_mfma_f32_16x16x32_bf16 a[88:91], a[172:175], v[176:179], a[88:91]
  v_exp_f32 v220, v156
  v_mfma_f32_16x16x32_bf16 a[92:95], a[172:175], v[180:183], a[92:95]
  s_waitcnt lgkmcnt(0)
  buffer_load_dwordx4 v[172:175], v2, s[40:43], s14 offen offset:3072 sc1
  v_add_f32 v227, v216, v217
  v_cvt_pk_bf16_f32 v188, v216, v217
  v_add_f32 v227, v227, v218
  v_mfma_f32_16x16x32_bf16 a[96:99], a[176:179], v[176:179], a[96:99]
  v_exp_f32 v221, v157
  v_mfma_f32_16x16x32_bf16 a[100:103], a[176:179], v[180:183], a[100:103]
  s_add_u32 s14, s13, 53248
  buffer_load_dwordx4 v[192:195], v2, s[40:43], s14 offen offset:0 sc1
  v_exp_f32 v222, v158
  v_mfma_f32_16x16x32_bf16 a[104:107], a[180:183], v[176:179], a[104:107]
  v_exp_f32 v223, v159
  v_mfma_f32_16x16x32_bf16 a[108:111], a[180:183], v[180:183], a[108:111]
  buffer_load_dwordx4 v[196:199], v2, s[40:43], s14 offen offset:1024 sc1
  v_add_f32 v227, v227, v219
  v_cvt_pk_bf16_f32 v189, v218, v219
  v_add_f32 v227, v227, v220
  v_add_f32 v227, v227, v221
  v_cvt_pk_bf16_f32 v190, v220, v221
  v_add_f32 v227, v227, v222
  v_mfma_f32_16x16x32_bf16 a[112:115], a[184:187], v[176:179], a[112:115]
  v_add_f32 v227, v227, v223
  v_max_f32 v5, v226, v227
  v_cmp_lt_f32 vcc, s81, v5
  v_mfma_f32_16x16x32_bf16 a[116:119], a[184:187], v[180:183], a[116:119]
  buffer_load_dwordx4 v[208:211], v2, s[40:43], s14 offen offset:2048 sc1
  v_mfma_f32_16x16x32_bf16 a[120:123], a[188:191], v[176:179], a[120:123]
  v_cvt_pk_bf16_f32 v191, v222, v223
  v_mfma_f32_16x16x32_bf16 a[124:127], a[188:191], v[180:183], a[124:127]
  s_cbranch_vccnz fa_stub30
fa_back30:
  v_add_f32 v230, v230, v226
  v_add_f32 v231, v231, v227
  ds_read_b128 a[160:163], v3 offset:24576
  ds_read_b128 a[164:167], v3 offset:25600
  ds_read_b128 a[168:171], v3 offset:26624
  ds_read_b128 a[172:175], v3 offset:27648
  ds_read_b128 a[176:179], v3 offset:28672
  ds_read_b128 a[180:183], v3 offset:29696
  ds_read_b128 a[184:187], v3 offset:30720
  ds_read_b128 a[188:191], v3 offset:31744
  s_waitcnt lgkmcnt(4)
  v_mfma_f32_16x16x32_bf16 a[64:67], a[160:163], v[184:187], a[64:67]
  v_mfma_f32_16x16x32_bf16 a[68:71], a[160:163], v[188:191], a[68:71]
  s_add_u32 s14, s13, 53248
  buffer_load_dwordx4 v[212:215], v2, s[40:43], s14 offen offset:3072 sc1
  v_mfma_f32_16x16x32_bf16 a[72:75], a[164:167], v[184:187], a[72:75]
  s_add_u32 s66, s66, 32768
  v_mfma_f32_16x16x32_bf16 a[76:79], a[164:167], v[188:191], a[76:79]
  s_add_u32 s14, s13, 57344
  buffer_load_dwordx4 v[232:235], v2, s[40:43], s14 offen offset:0 sc1
  v_mfma_f32_16x16x32_bf16 a[80:83], a[168:171], v[184:187], a[80:83]
  s_and_b32 s66, s66, 0x1ffff
  v_mfma_f32_16x16x32_bf16 a[84:87], a[168:171], v[188:191], a[84:87]
  v_mfma_f32_16x16x32_bf16 a[88:91], a[172:175], v[184:187], a[88:91]
  buffer_load_dwordx4 v[236:239], v2, s[40:43], s14 offen offset:1024 sc1
  v_mfma_f32_16x16x32_bf16 a[92:95], a[172:175], v[188:191], a[92:95]
  s_waitcnt lgkmcnt(0)
  v_mfma_f32_16x16x32_bf16 a[96:99], a[176:179], v[184:187], a[96:99]
  v_mfma_f32_16x16x32_bf16 a[100:103], a[176:179], v[188:191], a[100:103]
  buffer_load_dwordx4 v[240:243], v2, s[40:43], s14 offen offset:2048 sc1
  v_mfma_f32_16x16x32_bf16 a[104:107], a[180:183], v[184:187], a[104:107]
  v_mfma_f32_16x16x32_bf16 a[108:111], a[180:183], v[188:191], a[108:111]
  v_mfma_f32_16x16x32_bf16 a[112:115], a[184:187], v[184:187], a[112:115]
  buffer_load_dwordx4 v[244:247], v2, s[40:43], s14 offen offset:3072 sc1
  v_mfma_f32_16x16x32_bf16 a[116:119], a[184:187], v[188:191], a[116:119]
  v_mfma_f32_16x16x32_bf16 a[120:123], a[188:191], v[184:187], a[120:123]
  v_add_u32 v3, s66, v2
  v_mfma_f32_16x16x32_bf16 a[124:127], a[188:191], v[188:191], a[124:127]
fa_Bdone:
fa_epi:
  v_mov_b32 v20, v230
  v_mov_b32 v21, v231
  s_nop 1
  v_permlane16_swap_b32 v230, v20
  v_permlane16_swap_b32 v231, v21
  v_add_f32 v230, v230, v20
  v_add_f32 v231, v231, v21
  v_mov_b32 v20, v230
  v_mov_b32 v21, v231
  s_nop 1
  v_permlane32_swap_b32 v230, v20
  v_permlane32_swap_b32 v231, v21
  v_add_f32 v230, v230, v20
  v_add_f32 v231, v231, v21
  v_rcp_f32 v16, v230
  v_rcp_f32 v18, v231
  s_sub_u32 s23, 15, s22
  s_lshl_b32 s23, s23, 2
  v_mov_b32 v17, v16
  v_mov_b32 v19, v18
  s_add_u32 s23, s23, s20
  s_lshl_b32 s23, s23, 18
  s_lshl_b32 s31, s21, 12
  s_add_u32 s31, s31, 50331648
  s_add_u32 s64, s23, s31
  s_add_u32 s65, s64, 131072
  v_accvgpr_read_b32 v68, a64
  v_accvgpr_read_b32 v69, a65
  v_accvgpr_read_b32 v70, a66
  v_accvgpr_read_b32 v71, a67
  v_accvgpr_read_b32 v72, a72
  v_accvgpr_read_b32 v73, a73
  v_accvgpr_read_b32 v74, a74
  v_accvgpr_read_b32 v75, a75
  v_pk_mul_f32 v[68:69], v[68:69], v[16:17]
  v_pk_mul_f32 v[70:71], v[70:71], v[16:17]
  v_pk_mul_f32 v[72:73], v[72:73], v[16:17]
  v_pk_mul_f32 v[74:75], v[74:75], v[16:17]
  v_cvt_pk_bf16_f32 v64, v68, v69
  v_cvt_pk_bf16_f32 v65, v70, v71
  v_cvt_pk_bf16_f32 v66, v72, v73
  v_cvt_pk_bf16_f32 v67, v74, v75
  buffer_store_dwordx4 v[64:67], v2, s[40:43], s64 offen offset:0 sc1
  v_accvgpr_read_b32 v80, a80
  v_accvgpr_read_b32 v81, a81
  v_accvgpr_read_b32 v82, a82
  v_accvgpr_read_b32 v83, a83
  v_accvgpr_read_b32 v84, a88
  v_accvgpr_read_b32 v85, a89
  v_accvgpr_read_b32 v86, a90
  v_accvgpr_read_b32 v87, a91
  v_pk_mul_f32 v[80:81], v[80:81], v[16:17]
  v_pk_mul_f32 v[82:83], v[82:83], v[16:17]
  v_pk_mul_f32 v[84:85], v[84:85], v[16:17]
  v_pk_mul_f32 v[86:87], v[86:87], v[16:17]
  v_cvt_pk_bf16_f32 v76, v80, v81
  v_cvt_pk_bf16_f32 v77, v82, v83
  v_cvt_pk_bf16_f32 v78, v84, v85
  v_cvt_pk_bf16_f32 v79, v86, v87
  buffer_store_dwordx4 v[76:79], v2, s[40:43], s64 offen offset:1024 sc1
  v_accvgpr_read_b32 v132, a96
  v_accvgpr_read_b32 v133, a97
  v_accvgpr_read_b32 v134, a98
  v_accvgpr_read_b32 v135, a99
  v_accvgpr_read_b32 v136, a104
  v_accvgpr_read_b32 v137, a105
  v_accvgpr_read_b32 v138, a106
  v_accvgpr_read_b32 v139, a107
  v_pk_mul_f32 v[132:133], v[132:133], v[16:17]
  v_pk_mul_f32 v[134:135], v[134:135], v[16:17]
  v_pk_mul_f32 v[136:137], v[136:137], v[16:17]
  v_pk_mul_f32 v[138:139], v[138:139], v[16:17]
  v_cvt_pk_bf16_f32 v128, v132, v133
  v_cvt_pk_bf16_f32 v129, v134, v135
  v_cvt_pk_bf16_f32 v130, v136, v137
  v_cvt_pk_bf16_f32 v131, v138, v139
  buffer_store_dwordx4 v[128:131], v2, s[40:43], s64 offen offset:2048 sc1
  v_accvgpr_read_b32 v144, a112
  v_accvgpr_read_b32 v145, a113
  v_accvgpr_read_b32 v146, a114
  v_accvgpr_read_b32 v147, a115
  v_accvgpr_read_b32 v148, a120
  v_accvgpr_read_b32 v149, a121
  v_accvgpr_read_b32 v150, a122
  v_accvgpr_read_b32 v151, a123
  v_pk_mul_f32 v[144:145], v[144:145], v[16:17]
  v_pk_mul_f32 v[146:147], v[146:147], v[16:17]
  v_pk_mul_f32 v[148:149], v[148:149], v[16:17]
  v_pk_mul_f32 v[150:151], v[150:151], v[16:17]
  v_cvt_pk_bf16_f32 v140, v144, v145
  v_cvt_pk_bf16_f32 v141, v146, v147
  v_cvt_pk_bf16_f32 v142, v148, v149
  v_cvt_pk_bf16_f32 v143, v150, v151
  buffer_store_dwordx4 v[140:143], v2, s[40:43], s64 offen offset:3072 sc1
  v_accvgpr_read_b32 v68, a68
  v_accvgpr_read_b32 v69, a69
  v_accvgpr_read_b32 v70, a70
  v_accvgpr_read_b32 v71, a71
  v_accvgpr_read_b32 v72, a76
  v_accvgpr_read_b32 v73, a77
  v_accvgpr_read_b32 v74, a78
  v_accvgpr_read_b32 v75, a79
  v_pk_mul_f32 v[68:69], v[68:69], v[18:19]
  v_pk_mul_f32 v[70:71], v[70:71], v[18:19]
  v_pk_mul_f32 v[72:73], v[72:73], v[18:19]
  v_pk_mul_f32 v[74:75], v[74:75], v[18:19]
  v_cvt_pk_bf16_f32 v64, v68, v69
  v_cvt_pk_bf16_f32 v65, v70, v71
  v_cvt_pk_bf16_f32 v66, v72, v73
  v_cvt_pk_bf16_f32 v67, v74, v75
  buffer_store_dwordx4 v[64:67], v2, s[40:43], s65 offen offset:0 sc1
  v_accvgpr_read_b32 v80, a84
  v_accvgpr_read_b32 v81, a85
  v_accvgpr_read_b32 v82, a86
  v_accvgpr_read_b32 v83, a87
  v_accvgpr_read_b32 v84, a92
  v_accvgpr_read_b32 v85, a93
  v_accvgpr_read_b32 v86, a94
  v_accvgpr_read_b32 v87, a95
  v_pk_mul_f32 v[80:81], v[80:81], v[18:19]
  v_pk_mul_f32 v[82:83], v[82:83], v[18:19]
  v_pk_mul_f32 v[84:85], v[84:85], v[18:19]
  v_pk_mul_f32 v[86:87], v[86:87], v[18:19]
  v_cvt_pk_bf16_f32 v76, v80, v81
  v_cvt_pk_bf16_f32 v77, v82, v83
  v_cvt_pk_bf16_f32 v78, v84, v85
  v_cvt_pk_bf16_f32 v79, v86, v87
  buffer_store_dwordx4 v[76:79], v2, s[40:43], s65 offen offset:1024 sc1
  v_accvgpr_read_b32 v132, a100
  v_accvgpr_read_b32 v133, a101
  v_accvgpr_read_b32 v134, a102
  v_accvgpr_read_b32 v135, a103
  v_accvgpr_read_b32 v136, a108
  v_accvgpr_read_b32 v137, a109
  v_accvgpr_read_b32 v138, a110
  v_accvgpr_read_b32 v139, a111
  v_pk_mul_f32 v[132:133], v[132:133], v[18:19]
  v_pk_mul_f32 v[134:135], v[134:135], v[18:19]
  v_pk_mul_f32 v[136:137], v[136:137], v[18:19]
  v_pk_mul_f32 v[138:139], v[138:139], v[18:19]
  v_cvt_pk_bf16_f32 v128, v132, v133
  v_cvt_pk_bf16_f32 v129, v134, v135
  v_cvt_pk_bf16_f32 v130, v136, v137
  v_cvt_pk_bf16_f32 v131, v138, v139
  buffer_store_dwordx4 v[128:131], v2, s[40:43], s65 offen offset:2048 sc1
  v_accvgpr_read_b32 v144, a116
  v_accvgpr_read_b32 v145, a117
  v_accvgpr_read_b32 v146, a118
  v_accvgpr_read_b32 v147, a119
  v_accvgpr_read_b32 v148, a124
  v_accvgpr_read_b32 v149, a125
  v_accvgpr_read_b32 v150, a126
  v_accvgpr_read_b32 v151, a127
  v_pk_mul_f32 v[144:145], v[144:145], v[18:19]
  v_pk_mul_f32 v[146:147], v[146:147], v[18:19]
  v_pk_mul_f32 v[148:149], v[148:149], v[18:19]
  v_pk_mul_f32 v[150:151], v[150:151], v[18:19]
  v_cvt_pk_bf16_f32 v140, v144, v145
  v_cvt_pk_bf16_f32 v141, v146, v147
  v_cvt_pk_bf16_f32 v142, v148, v149
  v_cvt_pk_bf16_f32 v143, v150, v151
  buffer_store_dwordx4 v[140:143], v2, s[40:43], s65 offen offset:3072 sc1
  s_load_dwordx2 s[8:9], s[0:1], 0
  s_load_dwordx2 s[16:17], s[0:1], 88
  v_mov_b32 v30, 1073741824
  v_writelane_b32 v30, s80, 0
  v_writelane_b32 v30, s3, 1
  s_cmp_lt_u32 s12, 3
  s_cbranch_scc1 fa_puby
  s_add_u32 s14, s13, 61440
  buffer_load_dwordx4 v[64:67], v2, s[40:43], s14 offen offset:0 sc1
  buffer_load_dwordx4 v[68:71], v2, s[40:43], s14 offen offset:1024 sc1
  buffer_load_dwordx4 v[72:75], v2, s[40:43], s14 offen offset:2048 sc1
  buffer_load_dwordx4 v[76:79], v2, s[40:43], s14 offen offset:3072 sc1
  s_add_u32 s14, s13, 65536
  buffer_load_dwordx4 v[80:83], v2, s[40:43], s14 offen offset:0 sc1
  buffer_load_dwordx4 v[84:87], v2, s[40:43], s14 offen offset:1024 sc1
  buffer_load_dwordx4 v[88:91], v2, s[40:43], s14 offen offset:2048 sc1
  buffer_load_dwordx4 v[92:95], v2, s[40:43], s14 offen offset:3072 sc1
  s_waitcnt vmcnt(8)
  buffer_store_dword v4, v30, s[40:43], 0 offen sc1
fa_pubb:
  s_cmp_lt_u32 s29, 8
  s_cbranch_scc1 fa_left
fa_leftb:
  s_add_u32 s14, s13, 69632
  buffer_load_dwordx4 v[128:131], v2, s[40:43], s14 offen offset:0 sc1
  buffer_load_dwordx4 v[132:135], v2, s[40:43], s14 offen offset:1024 sc1
  buffer_load_dwordx4 v[136:139], v2, s[40:43], s14 offen offset:2048 sc1
  buffer_load_dwordx4 v[140:143], v2, s[40:43], s14 offen offset:3072 sc1
  s_add_u32 s14, s13, 73728
  buffer_load_dwordx4 v[144:147], v2, s[40:43], s14 offen offset:0 sc1
  buffer_load_dwordx4 v[148:151], v2, s[40:43], s14 offen offset:1024 sc1
  s_lshl_b32 s63, s21, 19
  s_lshl_b32 s23, s20, 15
  s_add_u32 s63, s63, s23
  s_add_u32 s63, s63, 50331648
  s_mul_i32 s62, s22, 0
  s_and_b32 s62, s62, 0x7fff
  s_add_u32 s64, s63, s62
  s_add_u32 s65, s64, 131072
  s_add_u32 s66, s64, 262144
  s_add_u32 s67, s64, 393216
  v_bfe_u32 v12, v1, 3, 1
  v_lshlrev_b32 v12, 7, v12
  v_and_b32 v13, 7, v1
  v_lshl_add_u32 v12, v13, 2, v12
  s_lshl_b32 s23, s21, 8
  s_lshl_b32 s31, s20, 5
  s_add_u32 s23, s23, s31
  s_add_u32 s23, s23, 2641920
  v_add_u32 v12, s23, v12
  v_mov_b32 v20, 0
  v_mov_b32 v21, 0
  v_mov_b32 v22, 0
  v_mov_b32 v23, 0
  v_add_u32 v16, 158208, v2
  ds_write_b128 v16, v[20:23]
  buffer_load_dwordx4 v[152:155], v2, s[40:43], s14 offen offset:2048 sc1
  buffer_load_dwordx4 v[156:159], v2, s[40:43], s14 offen offset:3072 sc1
  s_add_u32 s14, s13, 77824
  buffer_load_dwordx4 v[176:179], v2, s[40:43], s14 offen offset:0 sc1
  buffer_load_dwordx4 v[180:183], v2, s[40:43], s14 offen offset:1024 sc1
  buffer_load_dwordx4 v[184:187], v2, s[40:43], s14 offen offset:2048 sc1
  buffer_load_dwordx4 v[188:191], v2, s[40:43], s14 offen offset:3072 sc1
  s_lshl_b32 s34, s28, 1
  s_and_b32 s23, s20, 1
  s_lshl_b32 s23, s23, 12
  s_cmp_lt_u32 s20, 2
  s_cselect_b32 s33, 106496, 0
  s_add_u32 s33, s33, s23
  s_add_u32 s33, s33, s34
  s_and_b32 s33, s33, 0x1ffff
  s_lshl_b32 s23, s20, 12
  s_add_u32 s34, s34, 49152
  s_add_u32 s34, s34, s23
  s_and_b32 s34, s34, 0x1ffff
  s_add_u32 s23, s23, s28
  s_cmp_lt_u32 s29, 3
  s_cselect_b32 s26, s23, s26
  s_cselect_b32 s27, s23, s27
  s_cselect_b32 s24, s33, s24
  s_cselect_b32 s25, s34, s25
  s_mov_b64 s[44:45], s[4:5]
  s_mov_b64 s[48:49], s[6:7]
  s_mov_b32 s46, s30
  s_mov_b32 s50, s30
  s_add_u32 s23, s28, 49152
fa_pk:
  s_cmp_ge_u32 s26, s23
  s_cbranch_scc1 fa_pkd
  s_mov_b32 m0, s24
  s_add_u32 s24, s24, 32768
  s_and_b32 s24, s24, 0x1ffff
  buffer_load_dwordx4 v2, s[44:47], s26 offen offset:0 sc1 lds
  buffer_load_dwordx4 v2, s[44:47], s26 offen offset:1024 sc1 lds
  buffer_load_dwordx4 v2, s[44:47], s26 offen offset:2048 sc1 lds
  buffer_load_dwordx4 v2, s[44:47], s26 offen offset:3072 sc1 lds
  s_add_u32 s26, s26, 16384
  s_branch fa_pk
fa_pkd:
  s_add_u32 s23, s28, 32768
fa_pv:
  s_cmp_ge_u32 s27, s23
  s_cbranch_scc1 fa_pvd
  s_mov_b32 m0, s25
  s_add_u32 s25, s25, 32768
  s_and_b32 s25, s25, 0x1ffff
  buffer_load_dwordx4 v2, s[48:51], s27 offen offset:0 sc1 lds
  buffer_load_dwordx4 v2, s[48:51], s27 offen offset:1024 sc1 lds
  buffer_load_dwordx4 v2, s[48:51], s27 offen offset:2048 sc1 lds
  buffer_load_dwordx4 v2, s[48:51], s27 offen offset:3072 sc1 lds
  s_add_u32 s27, s27, 16384
  s_branch fa_pv
fa_pvd:
  s_lshl_b32 s35, s20, 12
  s_add_u32 s35, s35, 131072
  s_mov_b32 m0, s35
  s_add_u32 s14, s13, 155648
  buffer_load_dwordx4 v2, s[40:43], s14 offen offset:0 sc1 lds
  buffer_load_dwordx4 v2, s[40:43], s14 offen offset:1024 sc1 lds
  buffer_load_dwordx4 v2, s[40:43], s14 offen offset:2048 sc1 lds
  buffer_load_dwordx4 v2, s[40:43], s14 offen offset:3072 sc1 lds
  s_waitcnt lgkmcnt(0)
  s_barrier
  s_mov_b32 m0, s24
  s_add_u32 s24, s24, 32768
  s_and_b32 s24, s24, 0x1ffff
  buffer_load_dwordx4 v2, s[44:47], s26 offen offset:0 sc1 lds
  buffer_load_dwordx4 v2, s[44:47], s26 offen offset:1024 sc1 lds
  buffer_load_dwordx4 v2, s[44:47], s26 offen offset:2048 sc1 lds
  buffer_load_dwordx4 v2, s[44:47], s26 offen offset:3072 sc1 lds
  s_add_u32 s26, s26, 16384
  buffer_load_dword v13, v12, s[40:43], 0 offen sc1
  s_mov_b32 m0, s25
  s_add_u32 s25, s25, 32768
  s_and_b32 s25, s25, 0x1ffff
  buffer_load_dwordx4 v2, s[48:51], s27 offen offset:0 sc1 lds
  buffer_load_dwordx4 v2, s[48:51], s27 offen offset:1024 sc1 lds
  buffer_load_dwordx4 v2, s[48:51], s27 offen offset:2048 sc1 lds
  buffer_load_dwordx4 v2, s[48:51], s27 offen offset:3072 sc1 lds
  s_add_u32 s27, s27, 16384
  s_mov_b32 m0, s25
  s_add_u32 s25, s25, 32768
  s_and_b32 s25, s25, 0x1ffff
  buffer_load_dwordx4 v2, s[48:51], s27 offen offset:0 sc1 lds
  buffer_load_dwordx4 v2, s[48:51], s27 offen offset:1024 sc1 lds
  buffer_load_dwordx4 v2, s[48:51], s27 offen offset:2048 sc1 lds
  buffer_load_dwordx4 v2, s[48:51], s27 offen offset:3072 sc1 lds
  s_add_u32 s27, s27, 16384
  s_mov_b32 s44, s8
  s_mov_b32 s45, s9
  s_mov_b32 s46, 2621440
  s_mov_b32 s47, 0x20000
  s_mov_b32 s48, s16
  s_mov_b32 s49, s17
  s_mov_b32 s50, 2621440
  s_mov_b32 s51, 0x20000
  s_lshl_b32 s25, s21, 6
  s_mul_i32 s26, s22, 160
  s_mul_i32 s27, s22, 2560
  s_waitcnt vmcnt(8)
  v_cmp_eq_u32 vcc, 0, v13
  s_cbranch_vccnz fa_ctx_spin
fa_ctx_ok:
  buffer_load_dwordx4 a[144:147], v2, s[40:43], s64 offen offset:0 sc1
  buffer_load_dwordx4 a[148:151], v2, s[40:43], s65 offen offset:0 sc1
  buffer_load_dwordx4 a[152:155], v2, s[40:43], s66 offen offset:0 sc1
  buffer_load_dwordx4 a[156:159], v2, s[40:43], s67 offen offset:0 sc1
  buffer_load_dwordx4 a[160:163], v2, s[40:43], s64 offen offset:1024 sc1
  buffer_load_dwordx4 a[164:167], v2, s[40:43], s65 offen offset:1024 sc1
  buffer_load_dwordx4 a[168:171], v2, s[40:43], s66 offen offset:1024 sc1
  buffer_load_dwordx4 a[172:175], v2, s[40:43], s67 offen offset:1024 sc1
  buffer_load_dwordx4 a[176:179], v2, s[40:43], s64 offen offset:2048 sc1
  buffer_load_dwordx4 a[180:183], v2, s[40:43], s65 offen offset:2048 sc1
  buffer_load_dwordx4 a[184:187], v2, s[40:43], s66 offen offset:2048 sc1
  buffer_load_dwordx4 a[188:191], v2, s[40:43], s67 offen offset:2048 sc1
  buffer_load_dwordx4 v[216:219], v2, s[40:43], s64 offen offset:3072 sc1
  buffer_load_dwordx4 v[220:223], v2, s[40:43], s65 offen offset:3072 sc1
  buffer_load_dwordx4 v[224:227], v2, s[40:43], s66 offen offset:3072 sc1
  buffer_load_dwordx4 v[228:231], v2, s[40:43], s67 offen offset:3072 sc1
  s_add_u32 s62, s62, 4096
  s_and_b32 s62, s62, 0x7fff
  s_add_u32 s64, s63, s62
  s_add_u32 s65, s64, 131072
  s_add_u32 s66, s64, 262144
  s_add_u32 s67, s64, 393216
  s_waitcnt vmcnt(14)
  v_mfma_f32_16x16x32_bf16 a[64:67], a[0:3], a[144:147], 0
  v_mfma_f32_16x16x32_bf16 a[80:83], a[4:7], a[144:147], 0
  v_mfma_f32_16x16x32_bf16 a[96:99], a[8:11], a[144:147], 0
  v_mfma_f32_16x16x32_bf16 a[112:115], a[12:15], a[144:147], 0
  v_mfma_f32_16x16x32_bf16 a[128:131], a[16:19], a[144:147], 0
  buffer_load_dwordx4 a[144:147], v2, s[40:43], s64 offen offset:0 sc1
  v_mfma_f32_16x16x32_bf16 a[68:71], a[0:3], a[148:151], 0
  v_mfma_f32_16x16x32_bf16 a[84:87], a[4:7], a[148:151], 0
  v_mfma_f32_16x16x32_bf16 a[100:103], a[8:11], a[148:151], 0
  v_mfma_f32_16x16x32_bf16 a[116:119], a[12:15], a[148:151], 0
  v_mfma_f32_16x16x32_bf16 a[132:135], a[16:19], a[148:151], 0
  s_waitcnt vmcnt(13)
  buffer_load_dwordx4 a[148:151], v2, s[40:43], s65 offen offset:0 sc1
  v_mfma_f32_16x16x32_bf16 a[72:75], a[0:3], a[152:155], 0
  v_mfma_f32_16x16x32_bf16 a[88:91], a[4:7], a[152:155], 0
  v_mfma_f32_16x16x32_bf16 a[104:107], a[8:11], a[152:155], 0
  v_mfma_f32_16x16x32_bf16 a[120:123], a[12:15], a[152:155], 0
  v_mfma_f32_16x16x32_bf16 a[136:139], a[16:19], a[152:155], 0
  buffer_load_dwordx4 a[152:155], v2, s[40:43], s66 offen offset:0 sc1
  v_mfma_f32_16x16x32_bf16 a[76:79], a[0:3], a[156:159], 0
  v_mfma_f32_16x16x32_bf16 a[92:95], a[4:7], a[156:159], 0
  v_mfma_f32_16x16x32_bf16 a[108:111], a[8:11], a[156:159], 0
  v_mfma_f32_16x16x32_bf16 a[124:127], a[12:15], a[156:159], 0
  v_mfma_f32_16x16x32_bf16 a[140:143], a[16:19], a[156:159], 0
  s_waitcnt vmcnt(13)
  buffer_load_dwordx4 a[156:159], v2, s[40:43], s67 offen offset:0 sc1
  v_mfma_f32_16x16x32_bf16 a[64:67], a[20:23], a[160:163], a[64:67]
  v_add_u32 v16, 0, v0
  v_mfma_f32_16x16x32_bf16 a[80:83], a[24:27], a[160:163], a[80:83]
  v_mfma_f32_16x16x32_bf16 a[96:99], a[28:31], a[160:163], a[96:99]
  s_add_u32 s14, s13, 81920
  buffer_load_dwordx4 a[0:3], v2, s[40:43], s14 offen offset:0 sc1
  v_mul_u32_u24 v17, 6554, v16
  v_mfma_f32_16x16x32_bf16 a[112:115], a[32:35], a[160:163], a[112:115]
  v_mfma_f32_16x16x32_bf16 a[128:131], a[36:39], a[160:163], a[128:131]
  buffer_load_dwordx4 a[160:163], v2, s[40:43], s64 offen offset:1024 sc1
  v_mfma_f32_16x16x32_bf16 a[68:71], a[20:23], a[164:167], a[68:71]
  v_lshrrev_b32 v17, 16, v17
  v_mfma_f32_16x16x32_bf16 a[84:87], a[24:27], a[164:167], a[84:87]
  v_mul_u32_u24 v18, 10, v17
  v_mfma_f32_16x16x32_bf16 a[100:103], a[28:31], a[164:167], a[100:103]
  v_mfma_f32_16x16x32_bf16 a[116:119], a[32:35], a[164:167], a[116:119]
  v_mfma_f32_16x16x32_bf16 a[132:135], a[36:39], a[164:167], a[132:135]
  s_waitcnt vmcnt(14)
  buffer_load_dwordx4 a[164:167], v2, s[40:43], s65 offen offset:1024 sc1
  v_sub_u32 v18, v16, v18
  v_mfma_f32_16x16x32_bf16 a[72:75], a[20:23], a[168:171], a[72:75]
  v_mfma_f32_16x16x32_bf16 a[88:91], a[24:27], a[168:171], a[88:91]
  v_mfma_f32_16x16x32_bf16 a[104:107], a[28:31], a[168:171], a[104:107]
  buffer_load_dwordx4 a[4:7], v2, s[40:43], s14 offen offset:1024 sc1
  v_mfma_f32_16x16x32_bf16 a[120:123], a[32:35], a[168:171], a[120:123]
  v_mul_u32_u24 v251, 336, v17
  v_mfma_f32_16x16x32_bf16 a[136:139], a[36:39], a[168:171], a[136:139]
  buffer_load_dwordx4 a[168:171], v2, s[40:43], s66 offen offset:1024 sc1
  v_lshl_add_u32 v251, v18, 5, v251
  v_mfma_f32_16x16x32_bf16 a[76:79], a[20:23], a[172:175], a[76:79]
  v_mfma_f32_16x16x32_bf16 a[92:95], a[24:27], a[172:175], a[92:95]
  v_mfma_f32_16x16x32_bf16 a[108:111], a[28:31], a[172:175], a[108:111]
  v_mfma_f32_16x16x32_bf16 a[124:127], a[32:35], a[172:175], a[124:127]
  v_mfma_f32_16x16x32_bf16 a[140:143], a[36:39], a[172:175], a[140:143]
  s_waitcnt vmcnt(15)
  buffer_load_dwordx4 a[172:175], v2, s[40:43], s67 offen offset:1024 sc1
  v_mfma_f32_16x16x32_bf16 a[64:67], a[40:43], a[176:179], a[64:67]
  v_lshlrev_b32 v203, 5, v18
  v_mfma_f32_16x16x32_bf16 a[80:83], a[44:47], a[176:179], a[80:83]
  v_mfma_f32_16x16x32_bf16 a[96:99], a[48:51], a[176:179], a[96:99]
  buffer_load_dwordx4 a[8:11], v2, s[40:43], s14 offen offset:2048 sc1
  v_add_u32 v17, s25, v17
  v_mfma_f32_16x16x32_bf16 a[112:115], a[52:55], a[176:179], a[112:115]
  v_mfma_f32_16x16x32_bf16 a[128:131], a[56:59], a[176:179], a[128:131]
  buffer_load_dwordx4 a[176:179], v2, s[40:43], s64 offen offset:2048 sc1
  v_mfma_f32_16x16x32_bf16 a[68:71], a[40:43], a[180:183], a[68:71]
  v_add_u32 v24, 1, v17
  v_mfma_f32_16x16x32_bf16 a[84:87], a[44:47], a[180:183], a[84:87]
  v_mul_u32_u24 v248, 1280, v17
  v_mfma_f32_16x16x32_bf16 a[100:103], a[48:51], a[180:183], a[100:103]
  v_mfma_f32_16x16x32_bf16 a[116:119], a[52:55], a[180:183], a[116:119]
  v_mfma_f32_16x16x32_bf16 a[132:135], a[56:59], a[180:183], a[132:135]
  s_waitcnt vmcnt(16)
  buffer_load_dwordx4 a[180:183], v2, s[40:43], s65 offen offset:2048 sc1
  v_lshl_add_u32 v248, v18, 4, v248
  v_mfma_f32_16x16x32_bf16 a[72:75], a[40:43], a[184:187], a[72:75]
  v_mfma_f32_16x16x32_bf16 a[88:91], a[44:47], a[184:187], a[88:91]
  v_mfma_f32_16x16x32_bf16 a[104:107], a[48:51], a[184:187], a[104:107]
  buffer_load_dwordx4 a[12:15], v2, s[40:43], s14 offen offset:3072 sc1
  v_mfma_f32_16x16x32_bf16 a[120:123], a[52:55], a[184:187], a[120:123]
  v_add_u32 v248, s26, v248
  v_mfma_f32_16x16x32_bf16 a[136:139], a[56:59], a[184:187], a[136:139]
  buffer_load_dwordx4 a[184:187], v2, s[40:43], s66 offen offset:2048 sc1
  v_lshrrev_b32 v19, 4, v17
  v_mfma_f32_16x16x32_bf16 a[76:79], a[40:43], a[188:191], a[76:79]
  v_mfma_f32_16x16x32_bf16 a[92:95], a[44:47], a[188:191], a[92:95]
  v_mfma_f32_16x16x32_bf16 a[108:111], a[48:51], a[188:191], a[108:111]
  v_mfma_f32_16x16x32_bf16 a[124:127], a[52:55], a[188:191], a[124:127]
  v_mfma_f32_16x16x32_bf16 a[140:143], a[56:59], a[188:191], a[140:143]
  s_waitcnt vmcnt(17)
  buffer_load_dwordx4 a[188:191], v2, s[40:43], s67 offen offset:2048 sc1
  v_mfma_f32_16x16x32_bf16 a[64:67], a[60:63], v[216:219], a[64:67]
  v_mul_u32_u24 v19, 20480, v19
  v_mfma_f32_16x16x32_bf16 a[80:83], a[192:195], v[216:219], a[80:83]
  v_mfma_f32_16x16x32_bf16 a[96:99], a[196:199], v[216:219], a[96:99]
  s_add_u32 s14, s13, 86016
  buffer_load_dwordx4 a[16:19], v2, s[40:43], s14 offen offset:0 sc1
  v_and_b32 v17, 15, v17
  v_mfma_f32_16x16x32_bf16 a[112:115], a[200:203], v[216:219], a[112:115]
  v_mfma_f32_16x16x32_bf16 a[128:131], a[204:207], v[216:219], a[128:131]
  buffer_load_dwordx4 v[216:219], v2, s[40:43], s64 offen offset:3072 sc1
  v_mfma_f32_16x16x32_bf16 a[68:71], a[60:63], v[220:223], a[68:71]
  v_lshl_add_u32 v19, v17, 4, v19
  v_mfma_f32_16x16x32_bf16 a[84:87], a[192:195], v[220:223], a[84:87]
  v_lshl_add_u32 v200, v18, 8, v19
  v_mfma_f32_16x16x32_bf16 a[100:103], a[196:199], v[220:223], a[100:103]
  v_mfma_f32_16x16x32_bf16 a[116:119], a[200:203], v[220:223], a[116:119]
  v_mfma_f32_16x16x32_bf16 a[132:135], a[204:207], v[220:223], a[132:135]
  s_waitcnt vmcnt(18)
  buffer_load_dwordx4 v[220:223], v2, s[40:43], s65 offen offset:3072 sc1
  v_mov_b32 v27, 8
  v_mfma_f32_16x16x32_bf16 a[72:75], a[60:63], v[224:227], a[72:75]
  v_mfma_f32_16x16x32_bf16 a[88:91], a[192:195], v[224:227], a[88:91]
  v_mfma_f32_16x16x32_bf16 a[104:107], a[196:199], v[224:227], a[104:107]
  buffer_load_dwordx4 a[20:23], v2, s[40:43], s14 offen offset:1024 sc1
  v_mfma_f32_16x16x32_bf16 a[120:123], a[200:203], v[224:227], a[120:123]
  v_add_u32 v16, 256, v0
  v_mfma_f32_16x16x32_bf16 a[136:139], a[204:207], v[224:227], a[136:139]
  buffer_load_dwordx4 v[224:227], v2, s[40:43], s66 offen offset:3072 sc1
  v_mul_u32_u24 v17, 6554, v16
  v_mfma_f32_16x16x32_bf16 a[76:79], a[60:63], v[228:231], a[76:79]
  v_mfma_f32_16x16x32_bf16 a[92:95], a[192:195], v[228:231], a[92:95]
  v_mfma_f32_16x16x32_bf16 a[108:111], a[196:199], v[228:231], a[108:111]
  v_mfma_f32_16x16x32_bf16 a[124:127], a[200:203], v[228:231], a[124:127]
  v_mfma_f32_16x16x32_bf16 a[140:143], a[204:207], v[228:231], a[140:143]
  s_waitcnt vmcnt(19)
  buffer_load_dwordx4 v[228:231], v2, s[40:43], s67 offen offset:3072 sc1
  v_mfma_f32_16x16x32_bf16 a[64:67], a[208:211], a[144:147], a[64:67]
  s_add_u32 s62, s62, 4096
  v_lshrrev_b32 v17, 16, v17
  v_mfma_f32_16x16x32_bf16 a[80:83], a[212:215], a[144:147], a[80:83]
  s_and_b32 s62, s62, 0x7fff
  v_mfma_f32_16x16x32_bf16 a[96:99], a[216:219], a[144:147], a[96:99]
  buffer_load_dwordx4 a[24:27], v2, s[40:43], s14 offen offset:2048 sc1
  v_mul_u32_u24 v18, 10, v17
  v_mfma_f32_16x16x32_bf16 a[112:115], a[220:223], a[144:147], a[112:115]
  s_add_u32 s64, s63, s62
  v_mfma_f32_16x16x32_bf16 a[128:131], a[224:227], a[144:147], a[128:131]
  buffer_load_dwordx4 a[144:147], v2, s[40:43], s64 offen offset:0 sc1
  v_mfma_f32_16x16x32_bf16 a[68:71], a[208:211], a[148:151], a[68:71]
  s_add_u32 s65, s64, 131072
  v_sub_u32 v18, v16, v18
  v_mfma_f32_16x16x32_bf16 a[84:87], a[212:215], a[148:151], a[84:87]
  s_add_u32 s66, s64, 262144
  v_mul_u32_u24 v252, 336, v17
  v_mfma_f32_16x16x32_bf16 a[100:103], a[216:219], a[148:151], a[100:103]
  v_mfma_f32_16x16x32_bf16 a[116:119], a[220:223], a[148:151], a[116:119]
  v_mfma_f32_16x16x32_bf16 a[132:135], a[224:227], a[148:151], a[132:135]
  s_waitcnt vmcnt(20)
  buffer_load_dwordx4 a[148:151], v2, s[40:43], s65 offen offset:0 sc1
  v_lshl_add_u32 v252, v18, 5, v252
  v_mfma_f32_16x16x32_bf16 a[72:75], a[208:211], a[152:155], a[72:75]
  s_add_u32 s67, s64, 393216
  v_mfma_f32_16x16x32_bf16 a[88:91], a[212:215], a[152:155], a[88:91]
  v_mfma_f32_16x16x32_bf16 a[104:107], a[216:219], a[152:155], a[104:107]
  v_mfma_f32_16x16x32_bf16 a[120:123], a[220:223], a[152:155], a[120:123]
  v_lshlrev_b32 v204, 5, v18
  v_mfma_f32_16x16x32_bf16 a[136:139], a[224:227], a[152:155], a[136:139]
  buffer_load_dwordx4 a[152:155], v2, s[40:43], s66 offen offset:0 sc1
  v_add_u32 v17, s25, v17
  v_mfma_f32_16x16x32_bf16 a[76:79], a[208:211], a[156:159], a[76:79]
  v_mfma_f32_16x16x32_bf16 a[92:95], a[212:215], a[156:159], a[92:95]
  v_mfma_f32_16x16x32_bf16 a[108:111], a[216:219], a[156:159], a[108:111]
  v_mfma_f32_16x16x32_bf16 a[124:127], a[220:223], a[156:159], a[124:127]
  v_mfma_f32_16x16x32_bf16 a[140:143], a[224:227], a[156:159], a[140:143]
  s_waitcnt vmcnt(19)
  buffer_load_dwordx4 a[156:159], v2, s[40:43], s67 offen offset:0 sc1
  v_mfma_f32_16x16x32_bf16 a[64:67], a[228:231], a[160:163], a[64:67]
  v_add_u32 v25, 1, v17
  v_mfma_f32_16x16x32_bf16 a[80:83], a[232:235], a[160:163], a[80:83]
  v_mfma_f32_16x16x32_bf16 a[96:99], a[236:239], a[160:163], a[96:99]
  buffer_load_dwordx4 a[28:31], v2, s[40:43], s14 offen offset:3072 sc1
  v_mul_u32_u24 v249, 1280, v17
  v_mfma_f32_16x16x32_bf16 a[112:115], a[240:243], a[160:163], a[112:115]
  v_mfma_f32_16x16x32_bf16 a[128:131], a[244:247], a[160:163], a[128:131]
  buffer_load_dwordx4 a[160:163], v2, s[40:43], s64 offen offset:1024 sc1
  v_mfma_f32_16x16x32_bf16 a[68:71], a[228:231], a[164:167], a[68:71]
  v_lshl_add_u32 v249, v18, 4, v249
  v_mfma_f32_16x16x32_bf16 a[84:87], a[232:235], a[164:167], a[84:87]
  v_add_u32 v249, s26, v249
  v_mfma_f32_16x16x32_bf16 a[100:103], a[236:239], a[164:167], a[100:103]
  v_mfma_f32_16x16x32_bf16 a[116:119], a[240:243], a[164:167], a[116:119]
  v_mfma_f32_16x16x32_bf16 a[132:135], a[244:247], a[164:167], a[132:135]
  s_waitcnt vmcnt(19)
  buffer_load_dwordx4 a[164:167], v2, s[40:43], s65 offen offset:1024 sc1
  v_lshrrev_b32 v19, 4, v17
  v_mfma_f32_16x16x32_bf16 a[72:75], a[228:231], a[168:171], a[72:75]
  v_mfma_f32_16x16x32_bf16 a[88:91], a[232:235], a[168:171], a[88:91]
  v_mfma_f32_16x16x32_bf16 a[104:107], a[236:239], a[168:171], a[104:107]
  s_add_u32 s14, s13, 90112
  buffer_load_dwordx4 a[32:35], v2, s[40:43], s14 offen offset:0 sc1
  v_mfma_f32_16x16x32_bf16 a[120:123], a[240:243], a[168:171], a[120:123]
  v_mul_u32_u24 v19, 20480, v19
  v_mfma_f32_16x16x32_bf16 a[136:139], a[244:247], a[168:171], a[136:139]
  buffer_load_dwordx4 a[168:171], v2, s[40:43], s66 offen offset:1024 sc1
  v_and_b32 v17, 15, v17
  v_mfma_f32_16x16x32_bf16 a[76:79], a[228:231], a[172:175], a[76:79]
  v_mfma_f32_16x16x32_bf16 a[92:95], a[232:235], a[172:175], a[92:95]
  v_mfma_f32_16x16x32_bf16 a[108:111], a[236:239], a[172:175], a[108:111]
  v_mfma_f32_16x16x32_bf16 a[124:127], a[240:243], a[172:175], a[124:127]
  v_mfma_f32_16x16x32_bf16 a[140:143], a[244:247], a[172:175], a[140:143]
  s_waitcnt vmcnt(19)
  buffer_load_dwordx4 a[172:175], v2, s[40:43], s67 offen offset:1024 sc1
  v_mfma_f32_16x16x32_bf16 a[64:67], a[248:251], a[176:179], a[64:67]
  v_lshl_add_u32 v19, v17, 4, v19
  v_mfma_f32_16x16x32_bf16 a[80:83], a[252:255], a[176:179], a[80:83]
  v_mfma_f32_16x16x32_bf16 a[96:99], v[32:35], a[176:179], a[96:99]
  buffer_load_dwordx4 a[36:39], v2, s[40:43], s14 offen offset:1024 sc1
  v_lshl_add_u32 v201, v18, 8, v19
  v_mfma_f32_16x16x32_bf16 a[112:115], v[36:39], a[176:179], a[112:115]
  v_mfma_f32_16x16x32_bf16 a[128:131], v[40:43], a[176:179], a[128:131]
  buffer_load_dwordx4 a[176:179], v2, s[40:43], s64 offen offset:2048 sc1
  v_mfma_f32_16x16x32_bf16 a[68:71], a[248:251], a[180:183], a[68:71]
  v_mov_b32 v28, 8
  v_mfma_f32_16x16x32_bf16 a[84:87], a[252:255], a[180:183], a[84:87]
  v_add_u32 v16, 512, v0
  v_mfma_f32_16x16x32_bf16 a[100:103], v[32:35], a[180:183], a[100:103]
  v_mfma_f32_16x16x32_bf16 a[116:119], v[36:39], a[180:183], a[116:119]
  v_mfma_f32_16x16x32_bf16 a[132:135], v[40:43], a[180:183], a[132:135]
  s_waitcnt vmcnt(19)
  buffer_load_dwordx4 a[180:183], v2, s[40:43], s65 offen offset:2048 sc1
  v_mul_u32_u24 v17, 6554, v16
  v_mfma_f32_16x16x32_bf16 a[72:75], a[248:251], a[184:187], a[72:75]
  v_mfma_f32_16x16x32_bf16 a[88:91], a[252:255], a[184:187], a[88:91]
  v_mfma_f32_16x16x32_bf16 a[104:107], v[32:35], a[184:187], a[104:107]
  buffer_load_dwordx4 a[40:43], v2, s[40:43], s14 offen offset:2048 sc1
  v_mfma_f32_16x16x32_bf16 a[120:123], v[36:39], a[184:187], a[120:123]
  v_lshrrev_b32 v17, 16, v17
  v_mfma_f32_16x16x32_bf16 a[136:139], v[40:43], a[184:187], a[136:139]
  buffer_load_dwordx4 a[184:187], v2, s[40:43], s66 offen offset:2048 sc1
  v_mul_u32_u24 v18, 10, v17
  v_mfma_f32_16x16x32_bf16 a[76:79], a[248:251], a[188:191], a[76:79]
  v_mfma_f32_16x16x32_bf16 a[92:95], a[252:255], a[188:191], a[92:95]
  v_mfma_f32_16x16x32_bf16 a[108:111], v[32:35], a[188:191], a[108:111]
  v_mfma_f32_16x16x32_bf16 a[124:127], v[36:39], a[188:191], a[124:127]
  v_mfma_f32_16x16x32_bf16 a[140:143], v[40:43], a[188:191], a[140:143]
  s_waitcnt vmcnt(19)
  buffer_load_dwordx4 a[188:191], v2, s[40:43], s67 offen offset:2048 sc1
  v_mfma_f32_16x16x32_bf16 a[64:67], v[44:47], v[216:219], a[64:67]
  v_sub_u32 v18, v16, v18
  v_mfma_f32_16x16x32_bf16 a[80:83], v[48:51], v[216:219], a[80:83]
  v_mfma_f32_16x16x32_bf16 a[96:99], v[52:55], v[216:219], a[96:99]
  buffer_load_dwordx4 a[44:47], v2, s[40:43], s14 offen offset:3072 sc1
  v_mul_u32_u24 v253, 336, v17
  v_mfma_f32_16x16x32_bf16 a[112:115], v[56:59], v[216:219], a[112:115]
  v_mfma_f32_16x16x32_bf16 a[128:131], v[60:63], v[216:219], a[128:131]
  buffer_load_dwordx4 v[216:219], v2, s[40:43], s64 offen offset:3072 sc1
  v_mfma_f32_16x16x32_bf16 a[68:71], v[44:47], v[220:223], a[68:71]
  v_lshl_add_u32 v253, v18, 5, v253
  v_mfma_f32_16x16x32_bf16 a[84:87], v[48:51], v[220:223], a[84:87]
  v_lshlrev_b32 v205, 5, v18
  v_mfma_f32_16x16x32_bf16 a[100:103], v[52:55], v[220:223], a[100:103]
  v_mfma_f32_16x16x32_bf16 a[116:119], v[56:59], v[220:223], a[116:119]
  v_mfma_f32_16x16x32_bf16 a[132:135], v[60:63], v[220:223], a[132:135]
  s_waitcnt vmcnt(19)
  buffer_load_dwordx4 v[220:223], v2, s[40:43], s65 offen offset:3072 sc1
  v_add_u32 v17, s25, v17
  v_mfma_f32_16x16x32_bf16 a[72:75], v[44:47], v[224:227], a[72:75]
  v_mfma_f32_16x16x32_bf16 a[88:91], v[48:51], v[224:227], a[88:91]
  v_mfma_f32_16x16x32_bf16 a[104:107], v[52:55], v[224:227], a[104:107]
  v_mfma_f32_16x16x32_bf16 a[120:123], v[56:59], v[224:227], a[120:123]
  v_add_u32 v26, 1, v17
  v_mfma_f32_16x16x32_bf16 a[136:139], v[60:63], v[224:227], a[136:139]
  buffer_load_dwordx4 v[224:227], v2, s[40:43], s66 offen offset:3072 sc1
  v_mul_u32_u24 v250, 1280, v17
  v_mfma_f32_16x16x32_bf16 a[76:79], v[44:47], v[228:231], a[76:79]
  v_mfma_f32_16x16x32_bf16 a[92:95], v[48:51], v[228:231], a[92:95]
  v_mfma_f32_16x16x32_bf16 a[108:111], v[52:55], v[228:231], a[108:111]
  v_mfma_f32_16x16x32_bf16 a[124:127], v[56:59], v[228:231], a[124:127]
  v_mfma_f32_16x16x32_bf16 a[140:143], v[60:63], v[228:231], a[140:143]
  s_waitcnt vmcnt(18)
  buffer_load_dwordx4 v[228:231], v2, s[40:43], s67 offen offset:3072 sc1
  v_mfma_f32_16x16x32_bf16 a[64:67], v[96:99], a[144:147], a[64:67]
  s_add_u32 s62, s62, 4096
  v_lshl_add_u32 v250, v18, 4, v250
  v_mfma_f32_16x16x32_bf16 a[80:83], v[100:103], a[144:147], a[80:83]
  s_and_b32 s62, s62, 0x7fff
  v_mfma_f32_16x16x32_bf16 a[96:99], v[104:107], a[144:147], a[96:99]
  s_add_u32 s14, s13, 94208
  buffer_load_dwordx4 a[48:51], v2, s[40:43], s14 offen offset:0 sc1
  v_add_u32 v250, s26, v250
  v_mfma_f32_16x16x32_bf16 a[112:115], v[108:111], a[144:147], a[112:115]
  s_add_u32 s64, s63, s62
  v_mfma_f32_16x16x32_bf16 a[128:131], v[112:115], a[144:147], a[128:131]
  buffer_load_dwordx4 a[144:147], v2, s[40:43], s64 offen offset:0 sc1
  v_mfma_f32_16x16x32_bf16 a[68:71], v[96:99], a[148:151], a[68:71]
  s_add_u32 s65, s64, 131072
  v_lshrrev_b32 v19, 4, v17
  v_mfma_f32_16x16x32_bf16 a[84:87], v[100:103], a[148:151], a[84:87]
  s_add_u32 s66, s64, 262144
  v_mul_u32_u24 v19, 20480, v19
  v_mfma_f32_16x16x32_bf16 a[100:103], v[104:107], a[148:151], a[100:103]
  v_mfma_f32_16x16x32_bf16 a[116:119], v[108:111], a[148:151], a[116:119]
  v_mfma_f32_16x16x32_bf16 a[132:135], v[112:115], a[148:151], a[132:135]
  s_waitcnt vmcnt(19)
  buffer_load_dwordx4 a[148:151], v2, s[40:43], s65 offen offset:0 sc1
  v_and_b32 v17, 15, v17
  v_mfma_f32_16x16x32_bf16 a[72:75], v[96:99], a[152:155], a[72:75]
  s_add_u32 s67, s64, 393216
  v_mfma_f32_16x16x32_bf16 a[88:91], v[100:103], a[152:155], a[88:91]
  v_mfma_f32_16x16x32_bf16 a[104:107], v[104:107], a[152:155], a[104:107]
  buffer_load_dwordx4 a[52:55], v2, s[40:43], s14 offen offset:1024 sc1
  v_mfma_f32_16x16x32_bf16 a[120:123], v[108:111], a[152:155], a[120:123]
  v_lshl_add_u32 v19, v17, 4, v19
  v_mfma_f32_16x16x32_bf16 a[136:139], v[112:115], a[152:155], a[136:139]
  buffer_load_dwordx4 a[152:155], v2, s[40:43], s66 offen offset:0 sc1
  v_lshl_add_u32 v202, v18, 8, v19
  v_mfma_f32_16x16x32_bf16 a[76:79], v[96:99], a[156:159], a[76:79]
  v_mfma_f32_16x16x32_bf16 a[92:95], v[100:103], a[156:159], a[92:95]
  v_mfma_f32_16x16x32_bf16 a[108:111], v[104:107], a[156:159], a[108:111]
  v_mfma_f32_16x16x32_bf16 a[124:127], v[108:111], a[156:159], a[124:127]
  v_mfma_f32_16x16x32_bf16 a[140:143], v[112:115], a[156:159], a[140:143]
  s_waitcnt vmcnt(19)
  buffer_load_dwordx4 a[156:159], v2, s[40:43], s67 offen offset:0 sc1
  v_mfma_f32_16x16x32_bf16 a[64:67], v[116:119], a[160:163], a[64:67]
  v_mov_b32 v29, 8
  v_mfma_f32_16x16x32_bf16 a[80:83], v[120:123], a[160:163], a[80:83]
  v_mfma_f32_16x16x32_bf16 a[96:99], v[124:127], a[160:163], a[96:99]
  buffer_load_dwordx4 a[56:59], v2, s[40:43], s14 offen offset:2048 sc1
  v_cmp_gt_u32 vcc, 128, v0
  v_mfma_f32_16x16x32_bf16 a[112:115], v[160:163], a[160:163], a[112:115]
  v_mfma_f32_16x16x32_bf16 a[128:131], v[164:167], a[160:163], a[128:131]
  buffer_load_dwordx4 a[160:163], v2, s[40:43], s64 offen offset:1024 sc1
  v_mfma_f32_16x16x32_bf16 a[68:71], v[116:119], a[164:167], a[68:71]
  v_mov_b32 v16, 1073741824
  v_mfma_f32_16x16x32_bf16 a[84:87], v[120:123], a[164:167], a[84:87]
  v_mov_b32 v17, 0
  v_mfma_f32_16x16x32_bf16 a[100:103], v[124:127], a[164:167], a[100:103]
  v_mfma_f32_16x16x32_bf16 a[116:119], v[160:163], a[164:167], a[116:119]
  v_mfma_f32_16x16x32_bf16 a[132:135], v[164:167], a[164:167], a[132:135]
  s_waitcnt vmcnt(19)
  buffer_load_dwordx4 a[164:167], v2, s[40:43], s65 offen offset:1024 sc1
  v_cndmask_b32 v250, v16, v250, vcc
  v_mfma_f32_16x16x32_bf16 a[72:75], v[116:119], a[168:171], a[72:75]
  v_mfma_f32_16x16x32_bf16 a[88:91], v[120:123], a[168:171], a[88:91]
  v_mfma_f32_16x16x32_bf16 a[104:107], v[124:127], a[168:171], a[104:107]
  buffer_load_dwordx4 a[60:63], v2, s[40:43], s14 offen offset:3072 sc1
  v_mfma_f32_16x16x32_bf16 a[120:123], v[160:163], a[168:171], a[120:123]
  v_cndmask_b32 v202, v16, v202, vcc
  v_mfma_f32_16x16x32_bf16 a[136:139], v[164:167], a[168:171], a[136:139]
  buffer_load_dwordx4 a[168:171], v2, s[40:43], s66 offen offset:1024 sc1
  v_cndmask_b32 v253, v17, v253, vcc
  v_mfma_f32_16x16x32_bf16 a[76:79], v[116:119], a[172:175], a[76:79]
  v_mfma_f32_16x16x32_bf16 a[92:95], v[120:123], a[172:175], a[92:95]
  v_mfma_f32_16x16x32_bf16 a[108:111], v[124:127], a[172:175], a[108:111]
  v_mfma_f32_16x16x32_bf16 a[124:127], v[160:163], a[172:175], a[124:127]
  v_mfma_f32_16x16x32_bf16 a[140:143], v[164:167], a[172:175], a[140:143]
  s_waitcnt vmcnt(19)
  buffer_load_dwordx4 a[172:175], v2, s[40:43], s67 offen offset:1024 sc1
  v_mfma_f32_16x16x32_bf16 a[64:67], v[168:171], a[176:179], a[64:67]
  v_readlane_b32 s68, v15, 0
  v_mfma_f32_16x16x32_bf16 a[80:83], v[172:175], a[176:179], a[80:83]
  v_mfma_f32_16x16x32_bf16 a[96:99], v[192:195], a[176:179], a[96:99]
  s_add_u32 s14, s13, 106496
  buffer_load_dwordx4 a[224:227], v2, s[40:43], s14 offen offset:0 sc1
  v_readlane_b32 s69, v15, 1
  v_mfma_f32_16x16x32_bf16 a[112:115], v[196:199], a[176:179], a[112:115]
  v_mfma_f32_16x16x32_bf16 a[128:131], v[208:211], a[176:179], a[128:131]
  buffer_load_dwordx4 a[176:179], v2, s[40:43], s64 offen offset:2048 sc1
  v_mfma_f32_16x16x32_bf16 a[68:71], v[168:171], a[180:183], a[68:71]
  v_readlane_b32 s70, v15, 2
  v_mfma_f32_16x16x32_bf16 a[84:87], v[172:175], a[180:183], a[84:87]
  v_readlane_b32 s71, v15, 3
  v_mfma_f32_16x16x32_bf16 a[100:103], v[192:195], a[180:183], a[100:103]
  v_mfma_f32_16x16x32_bf16 a[116:119], v[196:199], a[180:183], a[116:119]
  v_mfma_f32_16x16x32_bf16 a[132:135], v[208:211], a[180:183], a[132:135]
  s_waitcnt vmcnt(19)
  buffer_load_dwordx4 a[180:183], v2, s[40:43], s65 offen offset:2048 sc1
  v_readlane_b32 s72, v15, 4
  v_mfma_f32_16x16x32_bf16 a[72:75], v[168:171], a[184:187], a[72:75]
  v_mfma_f32_16x16x32_bf16 a[88:91], v[172:175], a[184:187], a[88:91]
  v_mfma_f32_16x16x32_bf16 a[104:107], v[192:195], a[184:187], a[104:107]
  v_mfma_f32_16x16x32_bf16 a[120:123], v[196:199], a[184:187], a[120:123]
  v_readlane_b32 s73, v15, 5
  v_mfma_f32_16x16x32_bf16 a[136:139], v[208:211], a[184:187], a[136:139]
  buffer_load_dwordx4 a[184:187], v2, s[40:43], s66 offen offset:2048 sc1
  v_readlane_b32 s74, v15, 6
  v_mfma_f32_16x16x32_bf16 a[76:79], v[168:171], a[188:191], a[76:79]
  v_mfma_f32_16x16x32_bf16 a[92:95], v[172:175], a[188:191], a[92:95]
  v_mfma_f32_16x16x32_bf16 a[108:111], v[192:195], a[188:191], a[108:111]
  v_mfma_f32_16x16x32_bf16 a[124:127], v[196:199], a[188:191], a[124:127]
  v_mfma_f32_16x16x32_bf16 a[140:143], v[208:211], a[188:191], a[140:143]
  s_waitcnt vmcnt(18)
  buffer_load_dwordx4 a[188:191], v2, s[40:43], s67 offen offset:2048 sc1
  v_mfma_f32_16x16x32_bf16 a[64:67], v[212:215], v[216:219], a[64:67]
  v_readlane_b32 s75, v15, 7
  v_mfma_f32_16x16x32_bf16 a[80:83], v[232:235], v[216:219], a[80:83]
  v_mfma_f32_16x16x32_bf16 a[96:99], v[236:239], v[216:219], a[96:99]
  buffer_load_dwordx4 a[228:231], v2, s[40:43], s14 offen offset:1024 sc1
  v_cmp_eq_u32 s[52:53], s68, v24
  v_mfma_f32_16x16x32_bf16 a[112:115], v[240:243], v[216:219], a[112:115]
  v_mfma_f32_16x16x32_bf16 a[128:131], v[244:247], v[216:219], a[128:131]
  buffer_load_dwordx4 v[216:219], v2, s[40:43], s64 offen offset:3072 sc1
  v_mfma_f32_16x16x32_bf16 a[68:71], v[212:215], v[220:223], a[68:71]
  v_cmp_eq_u32 s[54:55], s68, v25
  v_mfma_f32_16x16x32_bf16 a[84:87], v[232:235], v[220:223], a[84:87]
  v_cmp_eq_u32 s[56:57], s68, v26
  v_mfma_f32_16x16x32_bf16 a[100:103], v[236:239], v[220:223], a[100:103]
  v_mfma_f32_16x16x32_bf16 a[116:119], v[240:243], v[220:223], a[116:119]
  v_mfma_f32_16x16x32_bf16 a[132:135], v[244:247], v[220:223], a[132:135]
  s_waitcnt vmcnt(19)
  buffer_load_dwordx4 v[220:223], v2, s[40:43], s65 offen offset:3072 sc1
  v_cndmask_b32 v27, v27, 0, s[52:53]
  v_mfma_f32_16x16x32_bf16 a[72:75], v[212:215], v[224:227], a[72:75]
  v_mfma_f32_16x16x32_bf16 a[88:91], v[232:235], v[224:227], a[88:91]
  v_mfma_f32_16x16x32_bf16 a[104:107], v[236:239], v[224:227], a[104:107]
  buffer_load_dwordx4 a[232:235], v2, s[40:43], s14 offen offset:2048 sc1
  v_mfma_f32_16x16x32_bf16 a[120:123], v[240:243], v[224:227], a[120:123]
  v_cndmask_b32 v28, v28, 0, s[54:55]
  v_mfma_f32_16x16x32_bf16 a[136:139], v[244:247], v[224:227], a[136:139]
  buffer_load_dwordx4 v[224:227], v2, s[40:43], s66 offen offset:3072 sc1
  v_cndmask_b32 v29, v29, 0, s[56:57]
  v_mfma_f32_16x16x32_bf16 a[76:79], v[212:215], v[228:231], a[76:79]
  v_mfma_f32_16x16x32_bf16 a[92:95], v[232:235], v[228:231], a[92:95]
  v_mfma_f32_16x16x32_bf16 a[108:111], v[236:239], v[228:231], a[108:111]
  v_mfma_f32_16x16x32_bf16 a[124:127], v[240:243], v[228:231], a[124:127]
  v_mfma_f32_16x16x32_bf16 a[140:143], v[244:247], v[228:231], a[140:143]
  s_waitcnt vmcnt(19)
  buffer_load_dwordx4 v[228:231], v2, s[40:43], s67 offen offset:3072 sc1
  v_mfma_f32_16x16x32_bf16 a[64:67], v[64:67], a[144:147], a[64:67]
  s_add_u32 s62, s62, 4096
  v_cmp_eq_u32 s[52:53], s69, v24
  v_mfma_f32_16x16x32_bf16 a[80:83], v[68:71], a[144:147], a[80:83]
  s_and_b32 s62, s62, 0x7fff
  v_mfma_f32_16x16x32_bf16 a[96:99], v[72:75], a[144:147], a[96:99]
  buffer_load_dwordx4 a[236:239], v2, s[40:43], s14 offen offset:3072 sc1
  v_cmp_eq_u32 s[54:55], s69, v25
  v_mfma_f32_16x16x32_bf16 a[112:115], v[76:79], a[144:147], a[112:115]
  s_add_u32 s64, s63, s62
  v_mfma_f32_16x16x32_bf16 a[128:131], v[80:83], a[144:147], a[128:131]
  buffer_load_dwordx4 a[144:147], v2, s[40:43], s64 offen offset:0 sc1
  v_mfma_f32_16x16x32_bf16 a[68:71], v[64:67], a[148:151], a[68:71]
  s_add_u32 s65, s64, 131072
  v_cmp_eq_u32 s[56:57], s69, v26
  v_mfma_f32_16x16x32_bf16 a[84:87], v[68:71], a[148:151], a[84:87]
  s_add_u32 s66, s64, 262144
  v_cndmask_b32 v27, v27, 1, s[52:53]
  v_mfma_f32_16x16x32_bf16 a[100:103], v[72:75], a[148:151], a[100:103]
  v_mfma_f32_16x16x32_bf16 a[116:119], v[76:79], a[148:151], a[116:119]
  v_mfma_f32_16x16x32_bf16 a[132:135], v[80:83], a[148:151], a[132:135]
  s_waitcnt vmcnt(19)
  buffer_load_dwordx4 a[148:151], v2, s[40:43], s65 offen offset:0 sc1
  v_cndmask_b32 v28, v28, 1, s[54:55]
  v_mfma_f32_16x16x32_bf16 a[72:75], v[64:67], a[152:155], a[72:75]
  s_add_u32 s67, s64, 393216
  v_add_u32 v11, s33, v2
  v_mfma_f32_16x16x32_bf16 a[88:91], v[68:71], a[152:155], a[88:91]
  ds_read_b128 a[192:195], v11 offset:0
  v_mfma_f32_16x16x32_bf16 a[104:107], v[72:75], a[152:155], a[104:107]
  s_add_u32 s14, s13, 110592
  buffer_load_dwordx4 a[240:243], v2, s[40:43], s14 offen offset:0 sc1
  v_mfma_f32_16x16x32_bf16 a[120:123], v[76:79], a[152:155], a[120:123]
  s_add_u32 s33, s33, 32768
  ds_read_b128 a[196:199], v11 offset:1024
  v_cndmask_b32 v29, v29, 1, s[56:57]
  v_mfma_f32_16x16x32_bf16 a[136:139], v[80:83], a[152:155], a[136:139]
  buffer_load_dwordx4 a[152:155], v2, s[40:43], s66 offen offset:0 sc1
  v_cmp_eq_u32 s[52:53], s70, v24
  v_mfma_f32_16x16x32_bf16 a[76:79], v[64:67], a[156:159], a[76:79]
  s_and_b32 s33, s33, 0x1ffff
  v_mfma_f32_16x16x32_bf16 a[92:95], v[68:71], a[156:159], a[92:95]
  ds_read_b128 a[200:203], v11 offset:2048
  v_mfma_f32_16x16x32_bf16 a[108:111], v[72:75], a[156:159], a[108:111]
  ds_read_b128 a[204:207], v11 offset:3072
  v_mfma_f32_16x16x32_bf16 a[124:127], v[76:79], a[156:159], a[124:127]
  v_mfma_f32_16x16x32_bf16 a[140:143], v[80:83], a[156:159], a[140:143]
  s_waitcnt vmcnt(19)
  buffer_load_dwordx4 a[156:159], v2, s[40:43], s67 offen offset:0 sc1
  v_mfma_f32_16x16x32_bf16 a[64:67], v[84:87], a[160:163], a[64:67]
  v_cmp_eq_u32 s[54:55], s70, v25
  v_mfma_f32_16x16x32_bf16 a[80:83], v[88:91], a[160:163], a[80:83]
  v_mfma_f32_16x16x32_bf16 a[96:99], v[92:95], a[160:163], a[96:99]
  buffer_load_dwordx4 a[244:247], v2, s[40:43], s14 offen offset:1024 sc1
  v_cmp_eq_u32 s[56:57], s70, v26
  v_mfma_f32_16x16x32_bf16 a[112:115], v[128:131], a[160:163], a[112:115]
  v_mfma_f32_16x16x32_bf16 a[128:131], v[132:135], a[160:163], a[128:131]
  buffer_load_dwordx4 a[160:163], v2, s[40:43], s64 offen offset:1024 sc1
  v_mfma_f32_16x16x32_bf16 a[68:71], v[84:87], a[164:167], a[68:71]
  v_cndmask_b32 v27, v27, 2, s[52:53]
  v_mfma_f32_16x16x32_bf16 a[84:87], v[88:91], a[164:167], a[84:87]
  v_cndmask_b32 v28, v28, 2, s[54:55]
  v_mfma_f32_16x16x32_bf16 a[100:103], v[92:95], a[164:167], a[100:103]
  v_mfma_f32_16x16x32_bf16 a[116:119], v[128:131], a[164:167], a[116:119]
  s_waitcnt lgkmcnt(0)
  v_mfma_f32_16x16x32_bf16 a[132:135], v[132:135], a[164:167], a[132:135]
  s_waitcnt vmcnt(19)
  buffer_load_dwordx4 a[164:167], v2, s[40:43], s65 offen offset:1024 sc1
  v_cndmask_b32 v29, v29, 2, s[56:57]
  v_mfma_f32_16x16x32_bf16 a[72:75], v[84:87], a[168:171], a[72:75]
  v_add_u32 v11, s34, v2
  v_mfma_f32_16x16x32_bf16 a[88:91], v[88:91], a[168:171], a[88:91]
  ds_read_b128 a[208:211], v11 offset:0
  v_mfma_f32_16x16x32_bf16 a[104:107], v[92:95], a[168:171], a[104:107]
  v_mfma_f32_16x16x32_bf16 a[120:123], v[128:131], a[168:171], a[120:123]
  s_add_u32 s34, s34, 32768
  ds_read_b128 a[212:215], v11 offset:1024
  v_cmp_eq_u32 s[52:53], s71, v24
  v_mfma_f32_16x16x32_bf16 a[136:139], v[132:135], a[168:171], a[136:139]
  buffer_load_dwordx4 a[168:171], v2, s[40:43], s66 offen offset:1024 sc1
  v_cmp_eq_u32 s[54:55], s71, v25
  v_mfma_f32_16x16x32_bf16 a[76:79], v[84:87], a[172:175], a[76:79]
  s_and_b32 s34, s34, 0x1ffff
  v_mfma_f32_16x16x32_bf16 a[92:95], v[88:91], a[172:175], a[92:95]
  ds_read_b128 a[216:219], v11 offset:2048
  v_mfma_f32_16x16x32_bf16 a[108:111], v[92:95], a[172:175], a[108:111]
  ds_read_b128 a[220:223], v11 offset:3072
  v_mfma_f32_16x16x32_bf16 a[124:127], v[128:131], a[172:175], a[124:127]
  v_mfma_f32_16x16x32_bf16 a[140:143], v[132:135], a[172:175], a[140:143]
  s_waitcnt vmcnt(18)
  buffer_load_dwordx4 a[172:175], v2, s[40:43], s67 offen offset:1024 sc1
  v_mfma_f32_16x16x32_bf16 a[64:67], v[136:139], a[176:179], a[64:67]
  v_cmp_eq_u32 s[56:57], s71, v26
  v_mfma_f32_16x16x32_bf16 a[80:83], v[140:143], a[176:179], a[80:83]
  v_mfma_f32_16x16x32_bf16 a[96:99], v[144:147], a[176:179], a[96:99]
  buffer_load_dwordx4 a[248:251], v2, s[40:43], s14 offen offset:2048 sc1
  v_cndmask_b32 v27, v27, 3, s[52:53]
  v_mfma_f32_16x16x32_bf16 a[112:115], v[148:151], a[176:179], a[112:115]
  v_mfma_f32_16x16x32_bf16 a[128:131], v[152:155], a[176:179], a[128:131]
  buffer_load_dwordx4 a[176:179], v2, s[40:43], s64 offen offset:2048 sc1
  v_mfma_f32_16x16x32_bf16 a[68:71], v[136:139], a[180:183], a[68:71]
  v_cndmask_b32 v28, v28, 3, s[54:55]
  v_mfma_f32_16x16x32_bf16 a[84:87], v[140:143], a[180:183], a[84:87]
  v_cndmask_b32 v29, v29, 3, s[56:57]
  v_mfma_f32_16x16x32_bf16 a[100:103], v[144:147], a[180:183], a[100:103]
  v_mfma_f32_16x16x32_bf16 a[116:119], v[148:151], a[180:183], a[116:119]
  s_waitcnt lgkmcnt(0)
  v_mfma_f32_16x16x32_bf16 a[132:135], v[152:155], a[180:183], a[132:135]
  s_waitcnt vmcnt(19)
  buffer_load_dwordx4 a[180:183], v2, s[40:43], s65 offen offset:2048 sc1
  v_cmp_eq_u32 s[52:53], s72, v24
  v_mfma_f32_16x16x32_bf16 a[72:75], v[136:139], a[184:187], a[72:75]
  v_add_u32 v11, s33, v2
  v_mfma_f32_16x16x32_bf16 a[88:91], v[140:143], a[184:187], a[88:91]
  ds_read_b128 v[32:35], v11 offset:0
  v_mfma_f32_16x16x32_bf16 a[104:107], v[144:147], a[184:187], a[104:107]
  buffer_load_dwordx4 a[252:255], v2, s[40:43], s14 offen offset:3072 sc1
  v_mfma_f32_16x16x32_bf16 a[120:123], v[148:151], a[184:187], a[120:123]
  s_add_u32 s33, s33, 32768
  ds_read_b128 v[36:39], v11 offset:1024
  v_cmp_eq_u32 s[54:55], s72, v25
  v_mfma_f32_16x16x32_bf16 a[136:139], v[152:155], a[184:187], a[136:139]
  buffer_load_dwordx4 a[184:187], v2, s[40:43], s66 offen offset:2048 sc1
  v_cmp_eq_u32 s[56:57], s72, v26
  v_mfma_f32_16x16x32_bf16 a[76:79], v[136:139], a[188:191], a[76:79]
  s_and_b32 s33, s33, 0x1ffff
  v_mfma_f32_16x16x32_bf16 a[92:95], v[140:143], a[188:191], a[92:95]
  ds_read_b128 v[40:43], v11 offset:2048
  v_mfma_f32_16x16x32_bf16 a[108:111], v[144:147], a[188:191], a[108:111]
  ds_read_b128 v[44:47], v11 offset:3072
  v_mfma_f32_16x16x32_bf16 a[124:127], v[148:151], a[188:191], a[124:127]
  v_mfma_f32_16x16x32_bf16 a[140:143], v[152:155], a[188:191], a[140:143]
  s_waitcnt vmcnt(19)
  buffer_load_dwordx4 a[188:191], v2, s[40:43], s67 offen offset:2048 sc1
  v_mfma_f32_16x16x32_bf16 a[64:67], v[156:159], v[216:219], a[64:67]
  v_cndmask_b32 v27, v27, 4, s[52:53]
  v_mfma_f32_16x16x32_bf16 a[80:83], v[176:179], v[216:219], a[80:83]
  v_mfma_f32_16x16x32_bf16 a[96:99], v[180:183], v[216:219], a[96:99]
  s_add_u32 s14, s13, 122880
  buffer_load_dwordx4 v[96:99], v2, s[40:43], s14 offen offset:0 sc1
  v_cndmask_b32 v28, v28, 4, s[54:55]
  v_mfma_f32_16x16x32_bf16 a[112:115], v[184:187], v[216:219], a[112:115]
  v_mfma_f32_16x16x32_bf16 a[128:131], v[188:191], v[216:219], a[128:131]
  buffer_load_dwordx4 v[216:219], v2, s[40:43], s64 offen offset:3072 sc1
  v_mfma_f32_16x16x32_bf16 a[68:71], v[156:159], v[220:223], a[68:71]
  v_cndmask_b32 v29, v29, 4, s[56:57]
  v_mfma_f32_16x16x32_bf16 a[84:87], v[176:179], v[220:223], a[84:87]
  v_cmp_eq_u32 s[52:53], s73, v24
  v_mfma_f32_16x16x32_bf16 a[100:103], v[180:183], v[220:223], a[100:103]
  v_mfma_f32_16x16x32_bf16 a[116:119], v[184:187], v[220:223], a[116:119]
  s_waitcnt lgkmcnt(0)
  v_mfma_f32_16x16x32_bf16 a[132:135], v[188:191], v[220:223], a[132:135]
  s_waitcnt vmcnt(19)
  buffer_load_dwordx4 v[220:223], v2, s[40:43], s65 offen offset:3072 sc1
  v_cmp_eq_u32 s[54:55], s73, v25
  v_mfma_f32_16x16x32_bf16 a[72:75], v[156:159], v[224:227], a[72:75]
  v_add_u32 v11, s34, v2
  v_mfma_f32_16x16x32_bf16 a[88:91], v[176:179], v[224:227], a[88:91]
  ds_read_b128 v[48:51], v11 offset:0
  v_mfma_f32_16x16x32_bf16 a[104:107], v[180:183], v[224:227], a[104:107]
  buffer_load_dwordx4 v[100:103], v2, s[40:43], s14 offen offset:1024 sc1
  v_mfma_f32_16x16x32_bf16 a[120:123], v[184:187], v[224:227], a[120:123]
  s_add_u32 s34, s34, 32768
  ds_read_b128 v[52:55], v11 offset:1024
  v_cmp_eq_u32 s[56:57], s73, v26
  v_mfma_f32_16x16x32_bf16 a[136:139], v[188:191], v[224:227], a[136:139]
  buffer_load_dwordx4 v[224:227], v2, s[40:43], s66 offen offset:3072 sc1
  v_cndmask_b32 v27, v27, 5, s[52:53]
  v_mfma_f32_16x16x32_bf16 a[76:79], v[156:159], v[228:231], a[76:79]
  s_and_b32 s34, s34, 0x1ffff
  v_mfma_f32_16x16x32_bf16 a[92:95], v[176:179], v[228:231], a[92:95]
  ds_read_b128 v[56:59], v11 offset:2048
  v_mfma_f32_16x16x32_bf16 a[108:111], v[180:183], v[228:231], a[108:111]
  ds_read_b128 v[60:63], v11 offset:3072
  v_mfma_f32_16x16x32_bf16 a[124:127], v[184:187], v[228:231], a[124:127]
  v_mfma_f32_16x16x32_bf16 a[140:143], v[188:191], v[228:231], a[140:143]
  s_waitcnt vmcnt(19)
  buffer_load_dwordx4 v[228:231], v2, s[40:43], s67 offen offset:3072 sc1
  v_mfma_f32_16x16x32_bf16 a[64:67], a[0:3], a[144:147], a[64:67]
  s_add_u32 s62, s62, 4096
  v_cndmask_b32 v28, v28, 5, s[54:55]
  v_mfma_f32_16x16x32_bf16 a[80:83], a[4:7], a[144:147], a[80:83]
  s_and_b32 s62, s62, 0x7fff
  v_mfma_f32_16x16x32_bf16 a[96:99], a[8:11], a[144:147], a[96:99]
  buffer_load_dwordx4 v[104:107], v2, s[40:43], s14 offen offset:2048 sc1
  v_cndmask_b32 v29, v29, 5, s[56:57]
  v_mfma_f32_16x16x32_bf16 a[112:115], a[12:15], a[144:147], a[112:115]
  s_add_u32 s64, s63, s62
  v_mfma_f32_16x16x32_bf16 a[128:131], a[16:19], a[144:147], a[128:131]
  buffer_load_dwordx4 a[144:147], v2, s[40:43], s64 offen offset:0 sc1
  v_mfma_f32_16x16x32_bf16 a[68:71], a[0:3], a[148:151], a[68:71]
  s_add_u32 s65, s64, 131072
  v_cmp_eq_u32 s[52:53], s74, v24
  v_mfma_f32_16x16x32_bf16 a[84:87], a[4:7], a[148:151], a[84:87]
  s_add_u32 s66, s64, 262144
  v_cmp_eq_u32 s[54:55], s74, v25
  v_mfma_f32_16x16x32_bf16 a[100:103], a[8:11], a[148:151], a[100:103]
  v_mfma_f32_16x16x32_bf16 a[116:119], a[12:15], a[148:151], a[116:119]
  s_waitcnt lgkmcnt(0)
  v_mfma_f32_16x16x32_bf16 a[132:135], a[16:19], a[148:151], a[132:135]
  s_waitcnt vmcnt(19)
  buffer_load_dwordx4 a[148:151], v2, s[40:43], s65 offen offset:0 sc1
  v_cmp_eq_u32 s[56:57], s74, v26
  v_mfma_f32_16x16x32_bf16 a[72:75], a[0:3], a[152:155], a[72:75]
  s_add_u32 s67, s64, 393216
  v_add_u32 v11, s33, v2
  v_mfma_f32_16x16x32_bf16 a[88:91], a[4:7], a[152:155], a[88:91]
  ds_read_b128 v[160:163], v11 offset:0
  v_mfma_f32_16x16x32_bf16 a[104:107], a[8:11], a[152:155], a[104:107]
  buffer_load_dwordx4 v[108:111], v2, s[40:43], s14 offen offset:3072 sc1
  v_mfma_f32_16x16x32_bf16 a[120:123], a[12:15], a[152:155], a[120:123]
  s_add_u32 s33, s33, 32768
  ds_read_b128 v[164:167], v11 offset:1024
  v_cndmask_b32 v27, v27, 6, s[52:53]
  v_mfma_f32_16x16x32_bf16 a[136:139], a[16:19], a[152:155], a[136:139]
  buffer_load_dwordx4 a[152:155], v2, s[40:43], s66 offen offset:0 sc1
  v_cndmask_b32 v28, v28, 6, s[54:55]
  v_mfma_f32_16x16x32_bf16 a[76:79], a[0:3], a[156:159], a[76:79]
  s_and_b32 s33, s33, 0x1ffff
  v_mfma_f32_16x16x32_bf16 a[92:95], a[4:7], a[156:159], a[92:95]
  ds_read_b128 v[168:171], v11 offset:2048
  v_mfma_f32_16x16x32_bf16 a[108:111], a[8:11], a[156:159], a[108:111]
  ds_read_b128 v[172:175], v11 offset:3072
  v_mfma_f32_16x16x32_bf16 a[124:127], a[12:15], a[156:159], a[124:127]
  v_mfma_f32_16x16x32_bf16 a[140:143], a[16:19], a[156:159], a[140:143]
  s_waitcnt vmcnt(19)
  buffer_load_dwordx4 a[156:159], v2, s[40:43], s67 offen offset:0 sc1
  v_mfma_f32_16x16x32_bf16 a[64:67], a[20:23], a[160:163], a[64:67]
  v_cndmask_b32 v29, v29, 6, s[56:57]
  v_mfma_f32_16x16x32_bf16 a[80:83], a[24:27], a[160:163], a[80:83]
  v_mfma_f32_16x16x32_bf16 a[96:99], a[28:31], a[160:163], a[96:99]
  s_add_u32 s14, s13, 126976
  buffer_load_dwordx4 v[112:115], v2, s[40:43], s14 offen offset:0 sc1
  v_cmp_eq_u32 s[52:53], s75, v24
  v_mfma_f32_16x16x32_bf16 a[112:115], a[32:35], a[160:163], a[112:115]
  v_mfma_f32_16x16x32_bf16 a[128:131], a[36:39], a[160:163], a[128:131]
  buffer_load_dwordx4 a[160:163], v2, s[40:43], s64 offen offset:1024 sc1
  v_mfma_f32_16x16x32_bf16 a[68:71], a[20:23], a[164:167], a[68:71]
  v_cmp_eq_u32 s[54:55], s75, v25
  v_mfma_f32_16x16x32_bf16 a[84:87], a[24:27], a[164:167], a[84:87]
  v_cmp_eq_u32 s[56:57], s75, v26
  v_mfma_f32_16x16x32_bf16 a[100:103], a[28:31], a[164:167], a[100:103]
  v_mfma_f32_16x16x32_bf16 a[116:119], a[32:35], a[164:167], a[116:119]
  s_waitcnt lgkmcnt(0)
  v_mfma_f32_16x16x32_bf16 a[132:135], a[36:39], a[164:167], a[132:135]
  s_waitcnt vmcnt(20)
  buffer_load_dwordx4 a[164:167], v2, s[40:43], s65 offen offset:1024 sc1
  v_cndmask_b32 v27, v27, 7, s[52:53]
  v_mfma_f32_16x16x32_bf16 a[72:75], a[20:23], a[168:171], a[72:75]
  v_add_u32 v11, s34, v2
  v_mfma_f32_16x16x32_bf16 a[88:91], a[24:27], a[168:171], a[88:91]
  ds_read_b128 v[192:195], v11 offset:0
  v_mfma_f32_16x16x32_bf16 a[104:107], a[28:31], a[168:171], a[104:107]
  v_mfma_f32_16x16x32_bf16 a[120:123], a[32:35], a[168:171], a[120:123]
  s_add_u32 s34, s34, 32768
  ds_read_b128 v[196:199], v11 offset:1024
  v_cndmask_b32 v28, v28, 7, s[54:55]
  v_mfma_f32_16x16x32_bf16 a[136:139], a[36:39], a[168:171], a[136:139]
  buffer_load_dwordx4 a[168:171], v2, s[40:43], s66 offen offset:1024 sc1
  v_cndmask_b32 v29, v29, 7, s[56:57]
  v_mfma_f32_16x16x32_bf16 a[76:79], a[20:23], a[172:175], a[76:79]
  s_and_b32 s34, s34, 0x1ffff
  v_mfma_f32_16x16x32_bf16 a[92:95], a[24:27], a[172:175], a[92:95]
  ds_read_b128 v[208:211], v11 offset:2048
  v_mfma_f32_16x16x32_bf16 a[108:111], a[28:31], a[172:175], a[108:111]
  ds_read_b128 v[212:215], v11 offset:3072
  v_mfma_f32_16x16x32_bf16 a[124:127], a[32:35], a[172:175], a[124:127]
  v_mfma_f32_16x16x32_bf16 a[140:143], a[36:39], a[172:175], a[140:143]
  s_waitcnt vmcnt(19)
  buffer_load_dwordx4 a[172:175], v2, s[40:43], s67 offen offset:1024 sc1
  v_mfma_f32_16x16x32_bf16 a[64:67], a[40:43], a[176:179], a[64:67]
  v_mul_u32_u24 v27, 320, v27
  v_mfma_f32_16x16x32_bf16 a[80:83], a[44:47], a[176:179], a[80:83]
  v_mfma_f32_16x16x32_bf16 a[96:99], a[48:51], a[176:179], a[96:99]
  buffer_load_dwordx4 v[116:119], v2, s[40:43], s14 offen offset:1024 sc1
  v_add_u32 v203, v203, v27
  v_mfma_f32_16x16x32_bf16 a[112:115], a[52:55], a[176:179], a[112:115]
  v_mfma_f32_16x16x32_bf16 a[128:131], a[56:59], a[176:179], a[128:131]
  buffer_load_dwordx4 a[176:179], v2, s[40:43], s64 offen offset:2048 sc1
  v_mfma_f32_16x16x32_bf16 a[68:71], a[40:43], a[180:183], a[68:71]
  v_add_u32 v203, 155648, v203
  v_mfma_f32_16x16x32_bf16 a[84:87], a[44:47], a[180:183], a[84:87]
  v_mul_u32_u24 v28, 320, v28
  v_mfma_f32_16x16x32_bf16 a[100:103], a[48:51], a[180:183], a[100:103]
  v_mfma_f32_16x16x32_bf16 a[116:119], a[52:55], a[180:183], a[116:119]
  s_waitcnt lgkmcnt(0)
  v_mfma_f32_16x16x32_bf16 a[132:135], a[56:59], a[180:183], a[132:135]
  s_waitcnt vmcnt(19)
  buffer_load_dwordx4 a[180:183], v2, s[40:43], s65 offen offset:2048 sc1
  v_add_u32 v204, v204, v28
  v_mfma_f32_16x16x32_bf16 a[72:75], a[40:43], a[184:187], a[72:75]
  v_add_u32 v11, s33, v2
  v_mfma_f32_16x16x32_bf16 a[88:91], a[44:47], a[184:187], a[88:91]
  ds_read_b128 v[80:83], v11 offset:0
  v_mfma_f32_16x16x32_bf16 a[104:107], a[48:51], a[184:187], a[104:107]
  buffer_load_dwordx4 v[120:123], v2, s[40:43], s14 offen offset:2048 sc1
  v_mfma_f32_16x16x32_bf16 a[120:123], a[52:55], a[184:187], a[120:123]
  s_add_u32 s33, s33, 32768
  ds_read_b128 v[84:87], v11 offset:1024
  v_add_u32 v204, 155648, v204
  v_mfma_f32_16x16x32_bf16 a[136:139], a[56:59], a[184:187], a[136:139]
  buffer_load_dwordx4 a[184:187], v2, s[40:43], s66 offen offset:2048 sc1
  v_mul_u32_u24 v29, 320, v29
  v_mfma_f32_16x16x32_bf16 a[76:79], a[40:43], a[188:191], a[76:79]
  s_and_b32 s33, s33, 0x1ffff
  v_mfma_f32_16x16x32_bf16 a[92:95], a[44:47], a[188:191], a[92:95]
  ds_read_b128 v[88:91], v11 offset:2048
  v_mfma_f32_16x16x32_bf16 a[108:111], a[48:51], a[188:191], a[108:111]
  ds_read_b128 v[92:95], v11 offset:3072
  v_mfma_f32_16x16x32_bf16 a[124:127], a[52:55], a[188:191], a[124:127]
  v_mfma_f32_16x16x32_bf16 a[140:143], a[56:59], a[188:191], a[140:143]
  s_waitcnt vmcnt(19)
  buffer_load_dwordx4 a[188:191], v2, s[40:43], s67 offen offset:2048 sc1
  v_mfma_f32_16x16x32_bf16 a[64:67], a[60:63], v[216:219], a[64:67]
  v_add_u32 v205, v205, v29
  v_mfma_f32_16x16x32_bf16 a[80:83], a[192:195], v[216:219], a[80:83]
  v_mfma_f32_16x16x32_bf16 a[96:99], a[196:199], v[216:219], a[96:99]
  buffer_load_dwordx4 v[124:127], v2, s[40:43], s14 offen offset:3072 sc1
  v_add_u32 v205, 155648, v205
  v_mfma_f32_16x16x32_bf16 a[112:115], a[200:203], v[216:219], a[112:115]
  v_mfma_f32_16x16x32_bf16 a[128:131], a[204:207], v[216:219], a[128:131]
  buffer_load_dwordx4 v[216:219], v2, s[40:43], s64 offen offset:3072 sc1
  v_mfma_f32_16x16x32_bf16 a[68:71], a[60:63], v[220:223], a[68:71]
  v_mfma_f32_16x16x32_bf16 a[84:87], a[192:195], v[220:223], a[84:87]
  v_mfma_f32_16x16x32_bf16 a[100:103], a[196:199], v[220:223], a[100:103]
  v_mfma_f32_16x16x32_bf16 a[116:119], a[200:203], v[220:223], a[116:119]
  s_waitcnt lgkmcnt(0)
  v_mfma_f32_16x16x32_bf16 a[132:135], a[204:207], v[220:223], a[132:135]
  s_waitcnt vmcnt(19)
  buffer_load_dwordx4 v[220:223], v2, s[40:43], s65 offen offset:3072 sc1
  v_mfma_f32_16x16x32_bf16 a[72:75], a[60:63], v[224:227], a[72:75]
  v_add_u32 v11, s34, v2
  v_mfma_f32_16x16x32_bf16 a[88:91], a[192:195], v[224:227], a[88:91]
  ds_read_b128 v[128:131], v11 offset:0
  v_mfma_f32_16x16x32_bf16 a[104:107], a[196:199], v[224:227], a[104:107]
  s_add_u32 s14, s13, 139264
  buffer_load_dwordx4 v[232:235], v2, s[40:43], s14 offen offset:0 sc1
  v_mfma_f32_16x16x32_bf16 a[120:123], a[200:203], v[224:227], a[120:123]
  s_add_u32 s34, s34, 32768
  ds_read_b128 v[132:135], v11 offset:1024
  v_mfma_f32_16x16x32_bf16 a[136:139], a[204:207], v[224:227], a[136:139]
  buffer_load_dwordx4 v[224:227], v2, s[40:43], s66 offen offset:3072 sc1
  v_mfma_f32_16x16x32_bf16 a[76:79], a[60:63], v[228:231], a[76:79]
  s_and_b32 s34, s34, 0x1ffff
  v_mfma_f32_16x16x32_bf16 a[92:95], a[192:195], v[228:231], a[92:95]
  ds_read_b128 v[136:139], v11 offset:2048
  v_mfma_f32_16x16x32_bf16 a[108:111], a[196:199], v[228:231], a[108:111]
  ds_read_b128 v[140:143], v11 offset:3072
  v_mfma_f32_16x16x32_bf16 a[124:127], a[200:203], v[228:231], a[124:127]
  v_mfma_f32_16x16x32_bf16 a[140:143], a[204:207], v[228:231], a[140:143]
  s_waitcnt vmcnt(19)
  buffer_load_dwordx4 v[228:231], v2, s[40:43], s67 offen offset:3072 sc1
  v_mfma_f32_16x16x32_bf16 a[64:67], a[208:211], a[144:147], a[64:67]
  s_add_u32 s62, s62, 4096
  v_mfma_f32_16x16x32_bf16 a[80:83], a[212:215], a[144:147], a[80:83]
  s_and_b32 s62, s62, 0x7fff
  v_mfma_f32_16x16x32_bf16 a[96:99], a[216:219], a[144:147], a[96:99]
  buffer_load_dwordx4 v[236:239], v2, s[40:43], s14 offen offset:1024 sc1
  v_mfma_f32_16x16x32_bf16 a[112:115], a[220:223], a[144:147], a[112:115]
  s_add_u32 s64, s63, s62
  v_mfma_f32_16x16x32_bf16 a[128:131], a[224:227], a[144:147], a[128:131]
  buffer_load_dwordx4 a[144:147], v2, s[40:43], s64 offen offset:0 sc1
  v_mfma_f32_16x16x32_bf16 a[68:71], a[208:211], a[148:151], a[68:71]
  s_add_u32 s65, s64, 131072
  v_mfma_f32_16x16x32_bf16 a[84:87], a[212:215], a[148:151], a[84:87]
  s_add_u32 s66, s64, 262144
  v_mfma_f32_16x16x32_bf16 a[100:103], a[216:219], a[148:151], a[100:103]
  v_mfma_f32_16x16x32_bf16 a[116:119], a[220:223], a[148:151], a[116:119]
  s_waitcnt lgkmcnt(0)
  v_mfma_f32_16x16x32_bf16 a[132:135], a[224:227], a[148:151], a[132:135]
  s_waitcnt vmcnt(19)
  buffer_load_dwordx4 a[148:151], v2, s[40:43], s65 offen offset:0 sc1
  v_mfma_f32_16x16x32_bf16 a[72:75], a[208:211], a[152:155], a[72:75]
  s_add_u32 s67, s64, 393216
  v_add_u32 v11, s35, v2
  v_mfma_f32_16x16x32_bf16 a[88:91], a[212:215], a[152:155], a[88:91]
  ds_read_b128 v[144:147], v11 offset:0
  v_mfma_f32_16x16x32_bf16 a[104:107], a[216:219], a[152:155], a[104:107]
  v_mfma_f32_16x16x32_bf16 a[120:123], a[220:223], a[152:155], a[120:123]
  ds_read_b128 v[148:151], v11 offset:1024
  v_mfma_f32_16x16x32_bf16 a[136:139], a[224:227], a[152:155], a[136:139]
  buffer_load_dwordx4 a[152:155], v2, s[40:43], s66 offen offset:0 sc1
  v_mfma_f32_16x16x32_bf16 a[76:79], a[208:211], a[156:159], a[76:79]
  v_mfma_f32_16x16x32_bf16 a[92:95], a[212:215], a[156:159], a[92:95]
  ds_read_b128 v[152:155], v11 offset:2048
  v_mfma_f32_16x16x32_bf16 a[108:111], a[216:219], a[156:159], a[108:111]
  ds_read_b128 v[156:159], v11 offset:3072
  v_mfma_f32_16x16x32_bf16 a[124:127], a[220:223], a[156:159], a[124:127]
  v_mfma_f32_16x16x32_bf16 a[140:143], a[224:227], a[156:159], a[140:143]
  s_waitcnt vmcnt(18)
  buffer_load_dwordx4 a[156:159], v2, s[40:43], s67 offen offset:0 sc1
  v_mfma_f32_16x16x32_bf16 a[64:67], a[228:231], a[160:163], a[64:67]
  v_mfma_f32_16x16x32_bf16 a[80:83], a[232:235], a[160:163], a[80:83]
  v_mfma_f32_16x16x32_bf16 a[96:99], a[236:239], a[160:163], a[96:99]
  buffer_load_dwordx4 v[240:243], v2, s[40:43], s14 offen offset:2048 sc1
  v_mfma_f32_16x16x32_bf16 a[112:115], a[240:243], a[160:163], a[112:115]
  v_mfma_f32_16x16x32_bf16 a[128:131], a[244:247], a[160:163], a[128:131]
  buffer_load_dwordx4 a[160:163], v2, s[40:43], s64 offen offset:1024 sc1
  v_mfma_f32_16x16x32_bf16 a[68:71], a[228:231], a[164:167], a[68:71]
  v_mfma_f32_16x16x32_bf16 a[84:87], a[232:235], a[164:167], a[84:87]
  v_mfma_f32_16x16x32_bf16 a[100:103], a[236:239], a[164:167], a[100:103]
  v_mfma_f32_16x16x32_bf16 a[116:119], a[240:243], a[164:167], a[116:119]
  s_waitcnt lgkmcnt(0)
  v_mfma_f32_16x16x32_bf16 a[132:135], a[244:247], a[164:167], a[132:135]
  s_waitcnt vmcnt(19)
  buffer_load_dwordx4 a[164:167], v2, s[40:43], s65 offen offset:1024 sc1
  v_mfma_f32_16x16x32_bf16 a[72:75], a[228:231], a[168:171], a[72:75]
  v_mfma_f32_16x16x32_bf16 a[88:91], a[232:235], a[168:171], a[88:91]
  v_mfma_f32_16x16x32_bf16 a[104:107], a[236:239], a[168:171], a[104:107]
  buffer_load_dwordx4 v[244:247], v2, s[40:43], s14 offen offset:3072 sc1
  v_mfma_f32_16x16x32_bf16 a[120:123], a[240:243], a[168:171], a[120:123]
  v_mfma_f32_16x16x32_bf16 a[136:139], a[244:247], a[168:171], a[136:139]
  buffer_load_dwordx4 a[168:171], v2, s[40:43], s66 offen offset:1024 sc1
  v_mfma_f32_16x16x32_bf16 a[76:79], a[228:231], a[172:175], a[76:79]
  v_mfma_f32_16x16x32_bf16 a[92:95], a[232:235], a[172:175], a[92:95]
  v_mfma_f32_16x16x32_bf16 a[108:111], a[236:239], a[172:175], a[108:111]
  v_mfma_f32_16x16x32_bf16 a[124:127], a[240:243], a[172:175], a[124:127]
  v_mfma_f32_16x16x32_bf16 a[140:143], a[244:247], a[172:175], a[140:143]
  s_waitcnt vmcnt(19)
  buffer_load_dwordx4 a[172:175], v2, s[40:43], s67 offen offset:1024 sc1
  v_mfma_f32_16x16x32_bf16 a[64:67], a[248:251], a[176:179], a[64:67]
  v_mfma_f32_16x16x32_bf16 a[80:83], a[252:255], a[176:179], a[80:83]
  v_mfma_f32_16x16x32_bf16 a[96:99], v[32:35], a[176:179], a[96:99]
  s_add_u32 s14, s13, 143360
  buffer_load_dwordx4 v[64:67], v2, s[40:43], s14 offen offset:0 sc1
  v_mfma_f32_16x16x32_bf16 a[112:115], v[36:39], a[176:179], a[112:115]
  v_mfma_f32_16x16x32_bf16 a[128:131], v[40:43], a[176:179], a[128:131]
  buffer_load_dwordx4 a[176:179], v2, s[40:43], s64 offen offset:2048 sc1
  v_mfma_f32_16x16x32_bf16 a[68:71], a[248:251], a[180:183], a[68:71]
  v_mfma_f32_16x16x32_bf16 a[84:87], a[252:255], a[180:183], a[84:87]
  v_mfma_f32_16x16x32_bf16 a[100:103], v[32:35], a[180:183], a[100:103]
  v_mfma_f32_16x16x32_bf16 a[116:119], v[36:39], a[180:183], a[116:119]
  s_waitcnt lgkmcnt(0)
  v_mfma_f32_16x16x32_bf16 a[132:135], v[40:43], a[180:183], a[132:135]
  s_waitcnt vmcnt(19)
  buffer_load_dwordx4 a[180:183], v2, s[40:43], s65 offen offset:2048 sc1
  v_mfma_f32_16x16x32_bf16 a[72:75], a[248:251], a[184:187], a[72:75]
  v_mfma_f32_16x16x32_bf16 a[88:91], a[252:255], a[184:187], a[88:91]
  v_mfma_f32_16x16x32_bf16 a[104:107], v[32:35], a[184:187], a[104:107]
  buffer_load_dwordx4 v[68:71], v2, s[40:43], s14 offen offset:1024 sc1
  v_mfma_f32_16x16x32_bf16 a[120:123], v[36:39], a[184:187], a[120:123]
  v_mfma_f32_16x16x32_bf16 a[136:139], v[40:43], a[184:187], a[136:139]
  buffer_load_dwordx4 a[184:187], v2, s[40:43], s66 offen offset:2048 sc1
  v_mfma_f32_16x16x32_bf16 a[76:79], a[248:251], a[188:191], a[76:79]
  v_mfma_f32_16x16x32_bf16 a[92:95], a[252:255], a[188:191], a[92:95]
  v_mfma_f32_16x16x32_bf16 a[108:111], v[32:35], a[188:191], a[108:111]
  v_mfma_f32_16x16x32_bf16 a[124:127], v[36:39], a[188:191], a[124:127]
  v_mfma_f32_16x16x32_bf16 a[140:143], v[40:43], a[188:191], a[140:143]
  s_waitcnt vmcnt(19)
  buffer_load_dwordx4 a[188:191], v2, s[40:43], s67 offen offset:2048 sc1
  v_mfma_f32_16x16x32_bf16 a[64:67], v[44:47], v[216:219], a[64:67]
  v_mfma_f32_16x16x32_bf16 a[80:83], v[48:51], v[216:219], a[80:83]
  v_mfma_f32_16x16x32_bf16 a[96:99], v[52:55], v[216:219], a[96:99]
  buffer_load_dwordx4 v[72:75], v2, s[40:43], s14 offen offset:2048 sc1
  v_mfma_f32_16x16x32_bf16 a[112:115], v[56:59], v[216:219], a[112:115]
  v_mfma_f32_16x16x32_bf16 a[128:131], v[60:63], v[216:219], a[128:131]
  buffer_load_dwordx4 v[216:219], v2, s[40:43], s64 offen offset:3072 sc1
  v_mfma_f32_16x16x32_bf16 a[68:71], v[44:47], v[220:223], a[68:71]
  v_mfma_f32_16x16x32_bf16 a[84:87], v[48:51], v[220:223], a[84:87]
  v_mfma_f32_16x16x32_bf16 a[100:103], v[52:55], v[220:223], a[100:103]
  v_mfma_f32_16x16x32_bf16 a[116:119], v[56:59], v[220:223], a[116:119]
  s_barrier
  v_mfma_f32_16x16x32_bf16 a[132:135], v[60:63], v[220:223], a[132:135]
  s_waitcnt vmcnt(19)
  buffer_load_dwordx4 v[220:223], v2, s[40:43], s65 offen offset:3072 sc1
  v_mfma_f32_16x16x32_bf16 a[72:75], v[44:47], v[224:227], a[72:75]
  v_mfma_f32_16x16x32_bf16 a[88:91], v[48:51], v[224:227], a[88:91]
  v_mfma_f32_16x16x32_bf16 a[104:107], v[52:55], v[224:227], a[104:107]
  v_mfma_f32_16x16x32_bf16 a[120:123], v[56:59], v[224:227], a[120:123]
  v_mfma_f32_16x16x32_bf16 a[136:139], v[60:63], v[224:227], a[136:139]
  buffer_load_dwordx4 v[224:227], v2, s[40:43], s66 offen offset:3072 sc1
  v_mfma_f32_16x16x32_bf16 a[76:79], v[44:47], v[228:231], a[76:79]
  v_mfma_f32_16x16x32_bf16 a[92:95], v[48:51], v[228:231], a[92:95]
  v_mfma_f32_16x16x32_bf16 a[108:111], v[52:55], v[228:231], a[108:111]
  v_mfma_f32_16x16x32_bf16 a[124:127], v[56:59], v[228:231], a[124:127]
  v_mfma_f32_16x16x32_bf16 a[140:143], v[60:63], v[228:231], a[140:143]
  s_waitcnt vmcnt(18)
  buffer_load_dwordx4 v[228:231], v2, s[40:43], s67 offen offset:3072 sc1
  v_mfma_f32_16x16x32_bf16 a[64:67], v[96:99], a[144:147], a[64:67]
  s_add_u32 s62, s62, 4096
  v_mfma_f32_16x16x32_bf16 a[80:83], v[100:103], a[144:147], a[80:83]
  s_and_b32 s62, s62, 0x7fff
  buffer_load_dwordx4 v[32:35], v248, s[44:47], 0 offen
  v_mfma_f32_16x16x32_bf16 a[96:99], v[104:107], a[144:147], a[96:99]
  buffer_load_dwordx4 v[76:79], v2, s[40:43], s14 offen offset:3072 sc1
  v_mfma_f32_16x16x32_bf16 a[112:115], v[108:111], a[144:147], a[112:115]
  s_add_u32 s64, s63, s62
  buffer_load_dwordx4 v[44:47], v200, s[40:43], s27 offen sc1
  v_mfma_f32_16x16x32_bf16 a[128:131], v[112:115], a[144:147], a[128:131]
  buffer_load_dwordx4 a[144:147], v2, s[40:43], s64 offen offset:0 sc1
  v_mfma_f32_16x16x32_bf16 a[68:71], v[96:99], a[148:151], a[68:71]
  s_add_u32 s65, s64, 131072
  v_mfma_f32_16x16x32_bf16 a[84:87], v[100:103], a[148:151], a[84:87]
  s_add_u32 s66, s64, 262144
  buffer_load_dwordx4 v[36:39], v249, s[44:47], 0 offen
  v_mfma_f32_16x16x32_bf16 a[100:103], v[104:107], a[148:151], a[100:103]
  v_mfma_f32_16x16x32_bf16 a[116:119], v[108:111], a[148:151], a[116:119]
  buffer_load_dwordx4 v[48:51], v201, s[40:43], s27 offen sc1
  v_mfma_f32_16x16x32_bf16 a[132:135], v[112:115], a[148:151], a[132:135]
  s_waitcnt vmcnt(23)
  buffer_load_dwordx4 a[148:151], v2, s[40:43], s65 offen offset:0 sc1
  v_mfma_f32_16x16x32_bf16 a[72:75], v[96:99], a[152:155], a[72:75]
  s_add_u32 s67, s64, 393216
  v_mfma_f32_16x16x32_bf16 a[88:91], v[100:103], a[152:155], a[88:91]
  buffer_load_dwordx4 v[40:43], v250, s[44:47], 0 offen
  v_mfma_f32_16x16x32_bf16 a[104:107], v[104:107], a[152:155], a[104:107]
  s_add_u32 s14, s13, 159744
  buffer_load_dwordx4 v[176:179], v2, s[40:43], s14 offen offset:0 sc1
  v_mfma_f32_16x16x32_bf16 a[120:123], v[108:111], a[152:155], a[120:123]
  buffer_load_dwordx4 v[52:55], v202, s[40:43], s27 offen sc1
  v_mfma_f32_16x16x32_bf16 a[136:139], v[112:115], a[152:155], a[136:139]
  buffer_load_dwordx4 a[152:155], v2, s[40:43], s66 offen offset:0 sc1
  v_mfma_f32_16x16x32_bf16 a[76:79], v[96:99], a[156:159], a[76:79]
  v_mfma_f32_16x16x32_bf16 a[92:95], v[100:103], a[156:159], a[92:95]
  v_mfma_f32_16x16x32_bf16 a[108:111], v[104:107], a[156:159], a[108:111]
  v_mfma_f32_16x16x32_bf16 a[124:127], v[108:111], a[156:159], a[124:127]
  v_mfma_f32_16x16x32_bf16 a[140:143], v[112:115], a[156:159], a[140:143]
  s_waitcnt vmcnt(25)
  buffer_load_dwordx4 a[156:159], v2, s[40:43], s67 offen offset:0 sc1
  v_mfma_f32_16x16x32_bf16 a[64:67], v[116:119], a[160:163], a[64:67]
  v_mfma_f32_16x16x32_bf16 a[80:83], v[120:123], a[160:163], a[80:83]
  v_mfma_f32_16x16x32_bf16 a[96:99], v[124:127], a[160:163], a[96:99]
  buffer_load_dwordx4 v[180:183], v2, s[40:43], s14 offen offset:1024 sc1
  v_mfma_f32_16x16x32_bf16 a[112:115], v[160:163], a[160:163], a[112:115]
  v_mfma_f32_16x16x32_bf16 a[128:131], v[164:167], a[160:163], a[128:131]
  buffer_load_dwordx4 a[160:163], v2, s[40:43], s64 offen offset:1024 sc1
  v_mfma_f32_16x16x32_bf16 a[68:71], v[116:119], a[164:167], a[68:71]
  v_mfma_f32_16x16x32_bf16 a[84:87], v[120:123], a[164:167], a[84:87]
  v_mfma_f32_16x16x32_bf16 a[100:103], v[124:127], a[164:167], a[100:103]
  v_mfma_f32_16x16x32_bf16 a[116:119], v[160:163], a[164:167], a[116:119]
  v_mfma_f32_16x16x32_bf16 a[132:135], v[164:167], a[164:167], a[132:135]
  s_waitcnt vmcnt(25)
  buffer_load_dwordx4 a[164:167], v2, s[40:43], s65 offen offset:1024 sc1
  v_mfma_f32_16x16x32_bf16 a[72:75], v[116:119], a[168:171], a[72:75]
  v_mfma_f32_16x16x32_bf16 a[88:91], v[120:123], a[168:171], a[88:91]
  v_mfma_f32_16x16x32_bf16 a[104:107], v[124:127], a[168:171], a[104:107]
  buffer_load_dwordx4 v[184:187], v2, s[40:43], s14 offen offset:2048 sc1
  v_mfma_f32_16x16x32_bf16 a[120:123], v[160:163], a[168:171], a[120:123]
  v_mfma_f32_16x16x32_bf16 a[136:139], v[164:167], a[168:171], a[136:139]
  buffer_load_dwordx4 a[168:171], v2, s[40:43], s66 offen offset:1024 sc1
  v_mfma_f32_16x16x32_bf16 a[76:79], v[116:119], a[172:175], a[76:79]
  v_mfma_f32_16x16x32_bf16 a[92:95], v[120:123], a[172:175], a[92:95]
  v_mfma_f32_16x16x32_bf16 a[108:111], v[124:127], a[172:175], a[108:111]
  v_mfma_f32_16x16x32_bf16 a[124:127], v[160:163], a[172:175], a[124:127]
  v_mfma_f32_16x16x32_bf16 a[140:143], v[164:167], a[172:175], a[140:143]
  s_waitcnt vmcnt(25)
  buffer_load_dwordx4 a[172:175], v2, s[40:43], s67 offen offset:1024 sc1
  v_mfma_f32_16x16x32_bf16 a[64:67], v[168:171], a[176:179], a[64:67]
  v_mfma_f32_16x16x32_bf16 a[80:83], v[172:175], a[176:179], a[80:83]
  v_mfma_f32_16x16x32_bf16 a[96:99], v[192:195], a[176:179], a[96:99]
  buffer_load_dwordx4 v[188:191], v2, s[40:43], s14 offen offset:3072 sc1
  v_mfma_f32_16x16x32_bf16 a[112:115], v[196:199], a[176:179], a[112:115]
  v_mfma_f32_16x16x32_bf16 a[128:131], v[208:211], a[176:179], a[128:131]
  buffer_load_dwordx4 a[176:179], v2, s[40:43], s64 offen offset:2048 sc1
  v_mfma_f32_16x16x32_bf16 a[68:71], v[168:171], a[180:183], a[68:71]
  v_mfma_f32_16x16x32_bf16 a[84:87], v[172:175], a[180:183], a[84:87]
  v_mfma_f32_16x16x32_bf16 a[100:103], v[192:195], a[180:183], a[100:103]
  v_mfma_f32_16x16x32_bf16 a[116:119], v[196:199], a[180:183], a[116:119]
  v_mfma_f32_16x16x32_bf16 a[132:135], v[208:211], a[180:183], a[132:135]
  s_waitcnt vmcnt(25)
  buffer_load_dwordx4 a[180:183], v2, s[40:43], s65 offen offset:2048 sc1
  v_mfma_f32_16x16x32_bf16 a[72:75], v[168:171], a[184:187], a[72:75]
  v_mfma_f32_16x16x32_bf16 a[88:91], v[172:175], a[184:187], a[88:91]
  v_mfma_f32_16x16x32_bf16 a[104:107], v[192:195], a[184:187], a[104:107]
  v_mfma_f32_16x16x32_bf16 a[120:123], v[196:199], a[184:187], a[120:123]
  v_mfma_f32_16x16x32_bf16 a[136:139], v[208:211], a[184:187], a[136:139]
  buffer_load_dwordx4 a[184:187], v2, s[40:43], s66 offen offset:2048 sc1
  v_mfma_f32_16x16x32_bf16 a[76:79], v[168:171], a[188:191], a[76:79]
  v_mfma_f32_16x16x32_bf16 a[92:95], v[172:175], a[188:191], a[92:95]
  v_mfma_f32_16x16x32_bf16 a[108:111], v[192:195], a[188:191], a[108:111]
  v_mfma_f32_16x16x32_bf16 a[124:127], v[196:199], a[188:191], a[124:127]
  v_mfma_f32_16x16x32_bf16 a[140:143], v[208:211], a[188:191], a[140:143]
  s_waitcnt vmcnt(24)
  buffer_load_dwordx4 a[188:191], v2, s[40:43], s67 offen offset:2048 sc1
  v_mfma_f32_16x16x32_bf16 a[64:67], v[212:215], v[216:219], a[64:67]
  v_mfma_f32_16x16x32_bf16 a[80:83], v[232:235], v[216:219], a[80:83]
  ds_read_b128 v[120:123], v203 offset:0
  v_mfma_f32_16x16x32_bf16 a[96:99], v[236:239], v[216:219], a[96:99]
  v_add_u32 v20, 43008, v251
  v_mfma_f32_16x16x32_bf16 a[112:115], v[240:243], v[216:219], a[112:115]
  ds_read_b128 v[124:127], v203 offset:16
  v_mfma_f32_16x16x32_bf16 a[128:131], v[244:247], v[216:219], a[128:131]
  buffer_load_dwordx4 v[216:219], v2, s[40:43], s64 offen offset:3072 sc1
  v_mfma_f32_16x16x32_bf16 a[68:71], v[212:215], v[220:223], a[68:71]
  ds_read_b128 v[160:163], v204 offset:0
  v_mfma_f32_16x16x32_bf16 a[84:87], v[232:235], v[220:223], a[84:87]
  v_add_u32 v21, 43008, v252
  v_mfma_f32_16x16x32_bf16 a[100:103], v[236:239], v[220:223], a[100:103]
  ds_read_b128 v[164:167], v204 offset:16
  v_mfma_f32_16x16x32_bf16 a[116:119], v[240:243], v[220:223], a[116:119]
  v_mfma_f32_16x16x32_bf16 a[132:135], v[244:247], v[220:223], a[132:135]
  s_waitcnt vmcnt(24)
  buffer_load_dwordx4 v[220:223], v2, s[40:43], s65 offen offset:3072 sc1
  ds_read_b128 v[168:171], v205 offset:0
  v_mfma_f32_16x16x32_bf16 a[72:75], v[212:215], v[224:227], a[72:75]
  v_add_u32 v22, 43008, v253
  v_mfma_f32_16x16x32_bf16 a[88:91], v[232:235], v[224:227], a[88:91]
  ds_read_b128 v[172:175], v205 offset:16
  v_mfma_f32_16x16x32_bf16 a[104:107], v[236:239], v[224:227], a[104:107]
  v_mfma_f32_16x16x32_bf16 a[120:123], v[240:243], v[224:227], a[120:123]
  v_mfma_f32_16x16x32_bf16 a[136:139], v[244:247], v[224:227], a[136:139]
  s_mul_i32 s23, s20, 21504
  buffer_load_dwordx4 v[224:227], v2, s[40:43], s66 offen offset:3072 sc1
  v_and_b32 v16, 15, v1
  v_mul_u32_u24 v16, 336, v16
  v_mfma_f32_16x16x32_bf16 a[76:79], v[212:215], v[228:231], a[76:79]
  v_lshrrev_b32 v17, 4, v1
  v_lshl_add_u32 v16, v17, 4, v16
  v_mfma_f32_16x16x32_bf16 a[92:95], v[232:235], v[228:231], a[92:95]
  v_add_u32 v16, s23, v16
  v_mfma_f32_16x16x32_bf16 a[108:111], v[236:239], v[228:231], a[108:111]
  v_mfma_f32_16x16x32_bf16 a[124:127], v[240:243], v[228:231], a[124:127]
  s_waitcnt lgkmcnt(0)
  v_mfma_f32_16x16x32_bf16 a[140:143], v[244:247], v[228:231], a[140:143]
  s_waitcnt vmcnt(16)
  buffer_load_dwordx4 v[228:231], v2, s[40:43], s67 offen offset:3072 sc1
  v_mfma_f32_16x16x32_bf16 a[64:67], v[64:67], a[144:147], a[64:67]
  v_lshlrev_b32 v18, 16, v44
  v_and_b32 v19, 0xffff0000, v44
  v_mfma_f32_16x16x32_bf16 a[80:83], v[68:71], a[144:147], a[80:83]
  v_add_f32 v120, v120, v18
  v_add_f32 v121, v121, v19
  v_mfma_f32_16x16x32_bf16 a[96:99], v[72:75], a[144:147], a[96:99]
  v_cvt_pk_bf16_f32 v18, v120, v121
  v_lshlrev_b32 v96, 16, v32
  v_mfma_f32_16x16x32_bf16 a[112:115], v[76:79], a[144:147], a[112:115]
  v_and_b32 v97, 0xffff0000, v32
  v_lshlrev_b32 v120, 16, v18
  v_mfma_f32_16x16x32_bf16 a[128:131], v[80:83], a[144:147], a[128:131]
  v_and_b32 v121, 0xffff0000, v18
  v_lshlrev_b32 v18, 16, v45
  v_mfma_f32_16x16x32_bf16 a[68:71], v[64:67], a[148:151], a[68:71]
  v_and_b32 v19, 0xffff0000, v45
  v_add_f32 v122, v122, v18
  v_mfma_f32_16x16x32_bf16 a[84:87], v[68:71], a[148:151], a[84:87]
  v_add_f32 v123, v123, v19
  v_cvt_pk_bf16_f32 v18, v122, v123
  v_mfma_f32_16x16x32_bf16 a[100:103], v[72:75], a[148:151], a[100:103]
  v_lshlrev_b32 v98, 16, v33
  v_and_b32 v99, 0xffff0000, v33
  v_mfma_f32_16x16x32_bf16 a[116:119], v[76:79], a[148:151], a[116:119]
  v_lshlrev_b32 v122, 16, v18
  v_and_b32 v123, 0xffff0000, v18
  v_mfma_f32_16x16x32_bf16 a[132:135], v[80:83], a[148:151], a[132:135]
  s_waitcnt vmcnt(15)
  v_lshlrev_b32 v18, 16, v46
  v_and_b32 v19, 0xffff0000, v46
  v_mfma_f32_16x16x32_bf16 a[72:75], v[64:67], a[152:155], a[72:75]
  v_add_f32 v124, v124, v18
  v_add_f32 v125, v125, v19
  v_mfma_f32_16x16x32_bf16 a[88:91], v[68:71], a[152:155], a[88:91]
  v_cvt_pk_bf16_f32 v18, v124, v125
  v_lshlrev_b32 v100, 16, v34
  v_mfma_f32_16x16x32_bf16 a[104:107], v[72:75], a[152:155], a[104:107]
  v_and_b32 v101, 0xffff0000, v34
  v_lshlrev_b32 v124, 16, v18
  v_mfma_f32_16x16x32_bf16 a[120:123], v[76:79], a[152:155], a[120:123]
  v_and_b32 v125, 0xffff0000, v18
  v_lshlrev_b32 v18, 16, v47
  v_mfma_f32_16x16x32_bf16 a[136:139], v[80:83], a[152:155], a[136:139]
  v_and_b32 v19, 0xffff0000, v47
  v_add_f32 v126, v126, v18
  v_mfma_f32_16x16x32_bf16 a[76:79], v[64:67], a[156:159], a[76:79]
  v_add_f32 v127, v127, v19
  v_cvt_pk_bf16_f32 v18, v126, v127
  v_mfma_f32_16x16x32_bf16 a[92:95], v[68:71], a[156:159], a[92:95]
  v_lshlrev_b32 v102, 16, v35
  v_and_b32 v103, 0xffff0000, v35
  v_mfma_f32_16x16x32_bf16 a[108:111], v[72:75], a[156:159], a[108:111]
  v_lshlrev_b32 v126, 16, v18
  v_and_b32 v127, 0xffff0000, v18
  v_mfma_f32_16x16x32_bf16 a[124:127], v[76:79], a[156:159], a[124:127]
  v_mfma_f32_16x16x32_bf16 a[140:143], v[80:83], a[156:159], a[140:143]
  s_waitcnt vmcnt(12)
  v_mfma_f32_16x16x32_bf16 a[64:67], v[84:87], a[160:163], a[64:67]
  v_lshlrev_b32 v18, 16, v48
  v_and_b32 v19, 0xffff0000, v48
  v_mfma_f32_16x16x32_bf16 a[80:83], v[88:91], a[160:163], a[80:83]
  v_add_f32 v160, v160, v18
  v_add_f32 v161, v161, v19
  v_mfma_f32_16x16x32_bf16 a[96:99], v[92:95], a[160:163], a[96:99]
  v_cvt_pk_bf16_f32 v18, v160, v161
  v_lshlrev_b32 v104, 16, v36
  v_mfma_f32_16x16x32_bf16 a[112:115], v[128:131], a[160:163], a[112:115]
  v_and_b32 v105, 0xffff0000, v36
  v_lshlrev_b32 v160, 16, v18
  v_mfma_f32_16x16x32_bf16 a[128:131], v[132:135], a[160:163], a[128:131]
  v_and_b32 v161, 0xffff0000, v18
  v_lshlrev_b32 v18, 16, v49
  v_mfma_f32_16x16x32_bf16 a[68:71], v[84:87], a[164:167], a[68:71]
  v_and_b32 v19, 0xffff0000, v49
  v_add_f32 v162, v162, v18
  v_mfma_f32_16x16x32_bf16 a[84:87], v[88:91], a[164:167], a[84:87]
  v_add_f32 v163, v163, v19
  v_cvt_pk_bf16_f32 v18, v162, v163
  v_mfma_f32_16x16x32_bf16 a[100:103], v[92:95], a[164:167], a[100:103]
  v_lshlrev_b32 v106, 16, v37
  v_and_b32 v107, 0xffff0000, v37
  v_mfma_f32_16x16x32_bf16 a[116:119], v[128:131], a[164:167], a[116:119]
  v_lshlrev_b32 v162, 16, v18
  v_and_b32 v163, 0xffff0000, v18
  v_mfma_f32_16x16x32_bf16 a[132:135], v[132:135], a[164:167], a[132:135]
  s_waitcnt vmcnt(9)
  v_lshlrev_b32 v18, 16, v50
  v_and_b32 v19, 0xffff0000, v50
  v_mfma_f32_16x16x32_bf16 a[72:75], v[84:87], a[168:171], a[72:75]
  v_add_f32 v164, v164, v18
  v_add_f32 v165, v165, v19
  v_mfma_f32_16x16x32_bf16 a[88:91], v[88:91], a[168:171], a[88:91]
  v_cvt_pk_bf16_f32 v18, v164, v165
  v_lshlrev_b32 v108, 16, v38
  v_mfma_f32_16x16x32_bf16 a[104:107], v[92:95], a[168:171], a[104:107]
  v_and_b32 v109, 0xffff0000, v38
  v_lshlrev_b32 v164, 16, v18
  v_mfma_f32_16x16x32_bf16 a[120:123], v[128:131], a[168:171], a[120:123]
  v_and_b32 v165, 0xffff0000, v18
  v_lshlrev_b32 v18, 16, v51
  v_mfma_f32_16x16x32_bf16 a[136:139], v[132:135], a[168:171], a[136:139]
  v_and_b32 v19, 0xffff0000, v51
  v_add_f32 v166, v166, v18
  v_mfma_f32_16x16x32_bf16 a[76:79], v[84:87], a[172:175], a[76:79]
  v_add_f32 v167, v167, v19
  v_cvt_pk_bf16_f32 v18, v166, v167
  v_mfma_f32_16x16x32_bf16 a[92:95], v[88:91], a[172:175], a[92:95]
  v_lshlrev_b32 v110, 16, v39
  v_and_b32 v111, 0xffff0000, v39
  v_mfma_f32_16x16x32_bf16 a[108:111], v[92:95], a[172:175], a[108:111]
  v_lshlrev_b32 v166, 16, v18
  v_and_b32 v167, 0xffff0000, v18
  v_mfma_f32_16x16x32_bf16 a[124:127], v[128:131], a[172:175], a[124:127]
  v_mfma_f32_16x16x32_bf16 a[140:143], v[132:135], a[172:175], a[140:143]
  s_waitcnt vmcnt(6)
  v_mfma_f32_16x16x32_bf16 a[64:67], v[136:139], a[176:179], a[64:67]
  v_lshlrev_b32 v18, 16, v52
  v_and_b32 v19, 0xffff0000, v52
  v_mfma_f32_16x16x32_bf16 a[80:83], v[140:143], a[176:179], a[80:83]
  v_add_f32 v168, v168, v18
  v_add_f32 v169, v169, v19
  v_mfma_f32_16x16x32_bf16 a[96:99], v[144:147], a[176:179], a[96:99]
  v_cvt_pk_bf16_f32 v18, v168, v169
  v_lshlrev_b32 v112, 16, v40
  v_mfma_f32_16x16x32_bf16 a[112:115], v[148:151], a[176:179], a[112:115]
  v_and_b32 v113, 0xffff0000, v40
  v_lshlrev_b32 v168, 16, v18
  v_mfma_f32_16x16x32_bf16 a[128:131], v[152:155], a[176:179], a[128:131]
  v_and_b32 v169, 0xffff0000, v18
  v_lshlrev_b32 v18, 16, v53
  v_mfma_f32_16x16x32_bf16 a[68:71], v[136:139], a[180:183], a[68:71]
  v_and_b32 v19, 0xffff0000, v53
  v_add_f32 v170, v170, v18
  v_mfma_f32_16x16x32_bf16 a[84:87], v[140:143], a[180:183], a[84:87]
  v_add_f32 v171, v171, v19
  v_cvt_pk_bf16_f32 v18, v170, v171
  v_mfma_f32_16x16x32_bf16 a[100:103], v[144:147], a[180:183], a[100:103]
  v_lshlrev_b32 v114, 16, v41
  v_and_b32 v115, 0xffff0000, v41
  v_mfma_f32_16x16x32_bf16 a[116:119], v[148:151], a[180:183], a[116:119]
  v_lshlrev_b32 v170, 16, v18
  v_and_b32 v171, 0xffff0000, v18
  v_mfma_f32_16x16x32_bf16 a[132:135], v[152:155], a[180:183], a[132:135]
  s_waitcnt vmcnt(4)
  v_lshlrev_b32 v18, 16, v54
  v_and_b32 v19, 0xffff0000, v54
  v_mfma_f32_16x16x32_bf16 a[72:75], v[136:139], a[184:187], a[72:75]
  v_add_f32 v172, v172, v18
  v_add_f32 v173, v173, v19
  v_mfma_f32_16x16x32_bf16 a[88:91], v[140:143], a[184:187], a[88:91]
  v_cvt_pk_bf16_f32 v18, v172, v173
  v_lshlrev_b32 v116, 16, v42
  v_mfma_f32_16x16x32_bf16 a[104:107], v[144:147], a[184:187], a[104:107]
  v_and_b32 v117, 0xffff0000, v42
  v_lshlrev_b32 v172, 16, v18
  v_mfma_f32_16x16x32_bf16 a[120:123], v[148:151], a[184:187], a[120:123]
  v_and_b32 v173, 0xffff0000, v18
  v_lshlrev_b32 v18, 16, v55
  v_mfma_f32_16x16x32_bf16 a[136:139], v[152:155], a[184:187], a[136:139]
  v_and_b32 v19, 0xffff0000, v55
  v_add_f32 v174, v174, v18
  v_mfma_f32_16x16x32_bf16 a[76:79], v[136:139], a[188:191], a[76:79]
  v_add_f32 v175, v175, v19
  v_cvt_pk_bf16_f32 v18, v174, v175
  v_mfma_f32_16x16x32_bf16 a[92:95], v[140:143], a[188:191], a[92:95]
  v_lshlrev_b32 v118, 16, v43
  v_and_b32 v119, 0xffff0000, v43
  v_mfma_f32_16x16x32_bf16 a[108:111], v[144:147], a[188:191], a[108:111]
  v_lshlrev_b32 v174, 16, v18
  v_and_b32 v175, 0xffff0000, v18
  v_mfma_f32_16x16x32_bf16 a[124:127], v[148:151], a[188:191], a[124:127]
  v_mfma_f32_16x16x32_bf16 a[140:143], v[152:155], a[188:191], a[140:143]
  s_waitcnt vmcnt(2)
  v_mfma_f32_16x16x32_bf16 a[64:67], v[156:159], v[216:219], a[64:67]
  v_mfma_f32_16x16x32_bf16 a[80:83], v[176:179], v[216:219], a[80:83]
  v_mfma_f32_16x16x32_bf16 a[96:99], v[180:183], v[216:219], a[96:99]
  v_mfma_f32_16x16x32_bf16 a[112:115], v[184:187], v[216:219], a[112:115]
  v_mfma_f32_16x16x32_bf16 a[128:131], v[188:191], v[216:219], a[128:131]
  v_mfma_f32_16x16x32_bf16 a[68:71], v[156:159], v[220:223], a[68:71]
  v_mfma_f32_16x16x32_bf16 a[84:87], v[176:179], v[220:223], a[84:87]
  v_mfma_f32_16x16x32_bf16 a[100:103], v[180:183], v[220:223], a[100:103]
  v_mfma_f32_16x16x32_bf16 a[116:119], v[184:187], v[220:223], a[116:119]
  v_mfma_f32_16x16x32_bf16 a[132:135], v[188:191], v[220:223], a[132:135]
  s_waitcnt vmcnt(0)
  ds_write_b128 v16, a[64:67] offset:0
  v_mfma_f32_16x16x32_bf16 a[72:75], v[156:159], v[224:227], a[72:75]
  ds_write_b128 v16, a[80:83] offset:64
  v_mfma_f32_16x16x32_bf16 a[88:91], v[176:179], v[224:227], a[88:91]
  ds_write_b128 v16, a[96:99] offset:128
  v_mfma_f32_16x16x32_bf16 a[104:107], v[180:183], v[224:227], a[104:107]
  ds_write_b128 v16, a[112:115] offset:192
  v_mfma_f32_16x16x32_bf16 a[120:123], v[184:187], v[224:227], a[120:123]
  ds_write_b128 v16, a[128:131] offset:256
  v_mfma_f32_16x16x32_bf16 a[136:139], v[188:191], v[224:227], a[136:139]
  ds_write_b128 v16, a[68:71] offset:5376
  v_mfma_f32_16x16x32_bf16 a[76:79], v[156:159], v[228:231], a[76:79]
  ds_write_b128 v16, a[84:87] offset:5440
  v_mfma_f32_16x16x32_bf16 a[92:95], v[176:179], v[228:231], a[92:95]
  ds_write_b128 v16, a[100:103] offset:5504
  v_mfma_f32_16x16x32_bf16 a[108:111], v[180:183], v[228:231], a[108:111]
  ds_write_b128 v16, a[116:119] offset:5568
  v_mfma_f32_16x16x32_bf16 a[124:127], v[184:187], v[228:231], a[124:127]
  ds_write_b128 v16, a[132:135] offset:5632
  v_mfma_f32_16x16x32_bf16 a[140:143], v[188:191], v[228:231], a[140:143]
  ds_write_b128 v16, a[72:75] offset:10752
  ds_write_b128 v16, a[88:91] offset:10816
  ds_write_b128 v16, a[104:107] offset:10880
  ds_write_b128 v16, a[120:123] offset:10944
  ds_write_b128 v16, a[136:139] offset:11008
  ds_write_b128 v16, a[76:79] offset:16128
  ds_write_b128 v16, a[92:95] offset:16192
  ds_write_b128 v16, a[108:111] offset:16256
  ds_write_b128 v16, a[124:127] offset:16320
  ds_write_b128 v16, a[140:143] offset:16384
  s_waitcnt lgkmcnt(0)
  s_barrier
  ds_read_b128 v[32:35], v251 offset:0
  ds_read_b128 v[36:39], v251 offset:16
  ds_read_b128 v[40:43], v251 offset:21504
  ds_read_b128 v[44:47], v251 offset:21520
  ds_read_b128 v[48:51], v20 offset:0
  ds_read_b128 v[52:55], v20 offset:16
  ds_read_b128 v[56:59], v20 offset:21504
  ds_read_b128 v[60:63], v20 offset:21520
  ds_read_b128 v[64:67], v252 offset:0
  ds_read_b128 v[68:71], v252 offset:16
  ds_read_b128 v[72:75], v252 offset:21504
  ds_read_b128 v[76:79], v252 offset:21520
  ds_read_b128 v[80:83], v21 offset:0
  ds_read_b128 v[84:87], v21 offset:16
  ds_read_b128 v[88:91], v21 offset:21504
  ds_read_b128 v[92:95], v21 offset:21520
  ds_read_b128 v[128:131], v253 offset:0
  ds_read_b128 v[132:135], v253 offset:16
  ds_read_b128 v[136:139], v253 offset:21504
  ds_read_b128 v[140:143], v253 offset:21520
  ds_read_b128 v[144:147], v22 offset:0
  ds_read_b128 v[148:151], v22 offset:16
  ds_read_b128 v[152:155], v22 offset:21504
  ds_read_b128 v[156:159], v22 offset:21520
  s_waitcnt lgkmcnt(15)
  v_pk_add_f32 v[32:33], v[32:33], v[40:41]
  v_pk_add_f32 v[48:49], v[48:49], v[56:57]
  v_pk_add_f32 v[34:35], v[34:35], v[42:43]
  v_pk_add_f32 v[50:51], v[50:51], v[58:59]
  v_pk_add_f32 v[36:37], v[36:37], v[44:45]
  v_pk_add_f32 v[52:53], v[52:53], v[60:61]
  v_pk_add_f32 v[38:39], v[38:39], v[46:47]
  v_pk_add_f32 v[54:55], v[54:55], v[62:63]
  v_pk_add_f32 v[32:33], v[32:33], v[48:49]
  v_pk_add_f32 v[34:35], v[34:35], v[50:51]
  v_pk_add_f32 v[36:37], v[36:37], v[52:53]
  v_pk_add_f32 v[38:39], v[38:39], v[54:55]
  v_cvt_pk_bf16_f32 v40, v32, v33
  v_cvt_pk_bf16_f32 v41, v34, v35
  v_cvt_pk_bf16_f32 v42, v36, v37
  v_cvt_pk_bf16_f32 v43, v38, v39
  v_lshlrev_b32 v32, 16, v40
  v_and_b32 v33, 0xffff0000, v40
  v_lshlrev_b32 v34, 16, v41
  v_and_b32 v35, 0xffff0000, v41
  v_lshlrev_b32 v36, 16, v42
  v_and_b32 v37, 0xffff0000, v42
  v_lshlrev_b32 v38, 16, v43
  v_and_b32 v39, 0xffff0000, v43
  v_pk_add_f32 v[32:33], v[32:33], v[96:97]
  v_pk_add_f32 v[34:35], v[34:35], v[98:99]
  v_pk_add_f32 v[36:37], v[36:37], v[100:101]
  v_pk_add_f32 v[38:39], v[38:39], v[102:103]
  v_cvt_pk_bf16_f32 v40, v32, v33
  v_cvt_pk_bf16_f32 v41, v34, v35
  v_cvt_pk_bf16_f32 v42, v36, v37
  v_cvt_pk_bf16_f32 v43, v38, v39
  v_lshlrev_b32 v32, 16, v40
  v_and_b32 v33, 0xffff0000, v40
  v_lshlrev_b32 v34, 16, v41
  v_and_b32 v35, 0xffff0000, v41
  v_lshlrev_b32 v36, 16, v42
  v_and_b32 v37, 0xffff0000, v42
  v_lshlrev_b32 v38, 16, v43
  v_and_b32 v39, 0xffff0000, v43
  v_pk_add_f32 v[32:33], v[32:33], v[120:121]
  v_pk_add_f32 v[34:35], v[34:35], v[122:123]
  v_pk_add_f32 v[36:37], v[36:37], v[124:125]
  v_pk_add_f32 v[38:39], v[38:39], v[126:127]
  v_cvt_pk_bf16_f32 v44, v32, v33
  v_cvt_pk_bf16_f32 v45, v34, v35
  v_cvt_pk_bf16_f32 v46, v36, v37
  v_cvt_pk_bf16_f32 v47, v38, v39
  buffer_store_dwordx4 v[44:47], v248, s[48:51], 0 offen
  s_waitcnt lgkmcnt(8)
  v_pk_add_f32 v[64:65], v[64:65], v[72:73]
  v_pk_add_f32 v[80:81], v[80:81], v[88:89]
  v_pk_add_f32 v[66:67], v[66:67], v[74:75]
  v_pk_add_f32 v[82:83], v[82:83], v[90:91]
  v_pk_add_f32 v[68:69], v[68:69], v[76:77]
  v_pk_add_f32 v[84:85], v[84:85], v[92:93]
  v_pk_add_f32 v[70:71], v[70:71], v[78:79]
  v_pk_add_f32 v[86:87], v[86:87], v[94:95]
  v_pk_add_f32 v[64:65], v[64:65], v[80:81]
  v_pk_add_f32 v[66:67], v[66:67], v[82:83]
  v_pk_add_f32 v[68:69], v[68:69], v[84:85]
  v_pk_add_f32 v[70:71], v[70:71], v[86:87]
  v_cvt_pk_bf16_f32 v72, v64, v65
  v_cvt_pk_bf16_f32 v73, v66, v67
  v_cvt_pk_bf16_f32 v74, v68, v69
  v_cvt_pk_bf16_f32 v75, v70, v71
  v_lshlrev_b32 v64, 16, v72
  v_and_b32 v65, 0xffff0000, v72
  v_lshlrev_b32 v66, 16, v73
  v_and_b32 v67, 0xffff0000, v73
  v_lshlrev_b32 v68, 16, v74
  v_and_b32 v69, 0xffff0000, v74
  v_lshlrev_b32 v70, 16, v75
  v_and_b32 v71, 0xffff0000, v75
  v_pk_add_f32 v[64:65], v[64:65], v[104:105]
  v_pk_add_f32 v[66:67], v[66:67], v[106:107]
  v_pk_add_f32 v[68:69], v[68:69], v[108:109]
  v_pk_add_f32 v[70:71], v[70:71], v[110:111]
  v_cvt_pk_bf16_f32 v72, v64, v65
  v_cvt_pk_bf16_f32 v73, v66, v67
  v_cvt_pk_bf16_f32 v74, v68, v69
  v_cvt_pk_bf16_f32 v75, v70, v71
  v_lshlrev_b32 v64, 16, v72
  v_and_b32 v65, 0xffff0000, v72
  v_lshlrev_b32 v66, 16, v73
  v_and_b32 v67, 0xffff0000, v73
  v_lshlrev_b32 v68, 16, v74
  v_and_b32 v69, 0xffff0000, v74
  v_lshlrev_b32 v70, 16, v75
  v_and_b32 v71, 0xffff0000, v75
  v_pk_add_f32 v[64:65], v[64:65], v[160:161]
  v_pk_add_f32 v[66:67], v[66:67], v[162:163]
  v_pk_add_f32 v[68:69], v[68:69], v[164:165]
  v_pk_add_f32 v[70:71], v[70:71], v[166:167]
  v_cvt_pk_bf16_f32 v76, v64, v65
  v_cvt_pk_bf16_f32 v77, v66, v67
  v_cvt_pk_bf16_f32 v78, v68, v69
  v_cvt_pk_bf16_f32 v79, v70, v71
  buffer_store_dwordx4 v[76:79], v249, s[48:51], 0 offen
  s_waitcnt lgkmcnt(0)
  v_pk_add_f32 v[128:129], v[128:129], v[136:137]
  v_pk_add_f32 v[144:145], v[144:145], v[152:153]
  v_pk_add_f32 v[130:131], v[130:131], v[138:139]
  v_pk_add_f32 v[146:147], v[146:147], v[154:155]
  v_pk_add_f32 v[132:133], v[132:133], v[140:141]
  v_pk_add_f32 v[148:149], v[148:149], v[156:157]
  v_pk_add_f32 v[134:135], v[134:135], v[142:143]
  v_pk_add_f32 v[150:151], v[150:151], v[158:159]
  v_pk_add_f32 v[128:129], v[128:129], v[144:145]
  v_pk_add_f32 v[130:131], v[130:131], v[146:147]
  v_pk_add_f32 v[132:133], v[132:133], v[148:149]
  v_pk_add_f32 v[134:135], v[134:135], v[150:151]
  v_cvt_pk_bf16_f32 v136, v128, v129
  v_cvt_pk_bf16_f32 v137, v130, v131
  v_cvt_pk_bf16_f32 v138, v132, v133
  v_cvt_pk_bf16_f32 v139, v134, v135
  v_lshlrev_b32 v128, 16, v136
  v_and_b32 v129, 0xffff0000, v136
  v_lshlrev_b32 v130, 16, v137
  v_and_b32 v131, 0xffff0000, v137
  v_lshlrev_b32 v132, 16, v138
  v_and_b32 v133, 0xffff0000, v138
  v_lshlrev_b32 v134, 16, v139
  v_and_b32 v135, 0xffff0000, v139
  v_pk_add_f32 v[128:129], v[128:129], v[112:113]
  v_pk_add_f32 v[130:131], v[130:131], v[114:115]
  v_pk_add_f32 v[132:133], v[132:133], v[116:117]
  v_pk_add_f32 v[134:135], v[134:135], v[118:119]
  v_cvt_pk_bf16_f32 v136, v128, v129
  v_cvt_pk_bf16_f32 v137, v130, v131
  v_cvt_pk_bf16_f32 v138, v132, v133
  v_cvt_pk_bf16_f32 v139, v134, v135
  v_lshlrev_b32 v128, 16, v136
  v_and_b32 v129, 0xffff0000, v136
  v_lshlrev_b32 v130, 16, v137
  v_and_b32 v131, 0xffff0000, v137
  v_lshlrev_b32 v132, 16, v138
  v_and_b32 v133, 0xffff0000, v138
  v_lshlrev_b32 v134, 16, v139
  v_and_b32 v135, 0xffff0000, v139
  v_pk_add_f32 v[128:129], v[128:129], v[168:169]
  v_pk_add_f32 v[130:131], v[130:131], v[170:171]
  v_pk_add_f32 v[132:133], v[132:133], v[172:173]
  v_pk_add_f32 v[134:135], v[134:135], v[174:175]
  v_cvt_pk_bf16_f32 v140, v128, v129
  v_cvt_pk_bf16_f32 v141, v130, v131
  v_cvt_pk_bf16_f32 v142, v132, v133
  v_cvt_pk_bf16_f32 v143, v134, v135
  buffer_store_dwordx4 v[140:143], v250, s[48:51], 0 offen
fa_end:
  s_endpgm
fa_hk0:
  s_getpc_b64 s[10:11]
fa_hp0:
  s_add_u32 s8, s8, 4
  s_addc_u32 s9, s9, 0
  s_sub_u32 s10, s10, fa_hp0-fa_hb0
  s_subb_u32 s11, s11, 0
  s_setpc_b64 s[8:9]
fa_hk1:
  s_getpc_b64 s[10:11]
fa_hp1:
  s_add_u32 s8, s8, 4
  s_addc_u32 s9, s9, 0
  s_sub_u32 s10, s10, fa_hp1-fa_hb1
  s_subb_u32 s11, s11, 0
  s_setpc_b64 s[8:9]
fa_hk2:
  s_getpc_b64 s[10:11]
fa_hp2:
  s_add_u32 s8, s8, 4
  s_addc_u32 s9, s9, 0
  s_sub_u32 s10, s10, fa_hp2-fa_hb2
  s_subb_u32 s11, s11, 0
  s_setpc_b64 s[8:9]
fa_hk3:
  s_getpc_b64 s[10:11]
fa_hp3:
  s_add_u32 s8, s8, 4
  s_addc_u32 s9, s9, 0
  s_sub_u32 s10, s10, fa_hp3-fa_hb3
  s_subb_u32 s11, s11, 0
  s_setpc_b64 s[8:9]
fa_ln_spin:
  s_mov_b32 s83, 200000
fa_ln_spin2:
  buffer_load_dword v15, v229, s[56:59], 0 offen sc1
  s_waitcnt vmcnt(0)
  v_cmp_ne_u32 vcc, 0x01010101, v15
  s_cbranch_vccz fa_ln_ok
  s_sleep 8
  s_sub_u32 s83, s83, 1
  s_cmp_lg_u32 s83, 0
  s_cbranch_scc1 fa_ln_spin2
  s_branch fa_ln_ok
fa_co1:
  buffer_load_dword v232, v234, s[32:35], s29 offen
  buffer_store_dword v229, v225, s[40:43], 0 offen sc1
  ds_read_b128 v[160:163], v221 offset:0
  ds_read_b128 v[164:167], v221 offset:4096
  ds_read_b128 v[168:171], v221 offset:8192
  buffer_store_dword v218, v222, s[40:43], 0 offen sc1
  s_waitcnt lgkmcnt(0)
  buffer_store_dwordx4 v[160:163], v223, s[40:43], s66 offen sc1
  buffer_store_dwordx4 v[164:167], v223, s[40:43], s67 offen sc1
  buffer_store_dwordx4 v[168:171], v224, s[40:43], s78 offen sc1
  s_getpc_b64 s[8:9]
  s_setpc_b64 s[10:11]
  s_mov_b32 s48, s60
  s_mov_b32 s49, s61
  s_mov_b32 s50, s75
  s_lshl_b32 s74, s22, 2
  s_add_u32 s74, s74, s20
  s_lshl_b32 s74, s74, 16
  s_mov_b32 s73, 2097152
  v_mov_b32 v213, 1073741824
  v_mov_b32 v214, 1
  v_writelane_b32 v213, s77, 0
  v_lshlrev_b32 v229, 2, v1
  s_and_b32 s23, s21, 3
  s_cbranch_scc0 fa_arr
  s_getpc_b64 s[8:9]
  s_setpc_b64 s[10:11]
fa_arr:
  buffer_store_byte v214, v213, s[56:59], 0 offen sc1
  s_getpc_b64 s[8:9]
  s_setpc_b64 s[10:11]
  buffer_load_dword v15, v229, s[56:59], 0 offen sc1
  s_getpc_b64 s[8:9]
  s_setpc_b64 s[10:11]
  s_mov_b32 s36, s60
  s_mov_b32 s37, s61
  s_mov_b32 s38, s75
  s_lshr_b32 s27, s20, 1
  s_lshl_b32 s27, s27, 18
  s_mov_b32 s25, 524288
  s_mov_b32 s32, s18
  s_mov_b32 s33, s19
  s_mov_b32 s34, 2621440
  s_mov_b32 s26, 0
  s_movk_i32 s79, 1024
  s_lshl_b32 s23, s22, 2
  s_add_u32 s23, s23, s20
  s_mul_i32 s23, s23, 40960
  v_add_u32 v3, s23, v2
  s_sub_u32 s23, 15, s22
  s_lshl_b32 s23, s23, 2
  s_add_u32 s23, s23, s20
  s_mul_i32 s23, s23, 40960
  s_sub_u32 s23, s23, 2048
  v_add_u32 v5, s23, v2
  v_add_u32 v4, 19456, v3
  v_add_u32 v6, 19456, v5
  s_waitcnt vmcnt(8)
  v_cmp_ne_u32 vcc, 0x01010101, v15
  s_cbranch_vccnz fa_ln_spin
fa_ln_ok:
  s_setpc_b64 s[10:11]
fa_kv_spin:
  s_mov_b32 s83, 200000
fa_kv_spin2:
  buffer_load_dword v15, v8, s[40:43], 0 offen sc1
  s_waitcnt vmcnt(0)
  v_cmp_eq_u32 vcc, 0, v15
  s_cbranch_vccz fa_kv_ok
  s_sleep 8
  s_sub_u32 s83, s83, 1
  s_cmp_lg_u32 s83, 0
  s_cbranch_scc1 fa_kv_spin2
  s_branch fa_kv_ok
fa_top8:
  s_cmp_lg_u32 s20, 0
  s_cbranch_scc1 fa_notop
  s_mov_b32 s23, 2621440
  s_mov_b32 s31, 2625536
  buffer_load_dwordx4 v[96:99], v2, s[40:43], s23 offen offset:0 sc1
  buffer_load_dwordx4 v[100:103], v2, s[40:43], s23 offen offset:1024 sc1
  buffer_load_dwordx4 v[104:107], v2, s[40:43], s23 offen offset:2048 sc1
  buffer_load_dwordx4 v[108:111], v2, s[40:43], s23 offen offset:3072 sc1
  buffer_load_dwordx4 v[112:115], v2, s[40:43], s31 offen offset:0 sc1
  buffer_load_dwordx4 v[116:119], v2, s[40:43], s31 offen offset:1024 sc1
  buffer_load_dwordx4 v[120:123], v2, s[40:43], s31 offen offset:2048 sc1
  buffer_load_dwordx4 v[124:127], v2, s[40:43], s31 offen offset:3072 sc1
  v_mov_b32 v21, 0
  v_mov_b32 v22, 0
  v_and_b32 v23, 7, v1
  s_mov_b32 s23, 0
  s_waitcnt vmcnt(0)
fa_top:
  v_max3_u32 v20, v96, v97, v98
  v_max3_u32 v24, v99, v100, v101
  v_max3_u32 v20, v20, v102, v103
  v_max3_u32 v24, v24, v104, v105
  v_max3_u32 v20, v20, v106, v107
  v_max3_u32 v24, v24, v108, v109
  v_max3_u32 v20, v20, v110, v111
  v_max3_u32 v24, v24, v112, v113
  v_max3_u32 v20, v20, v114, v115
  v_max3_u32 v24, v24, v116, v117
  v_max3_u32 v20, v20, v118, v119
  v_max3_u32 v24, v24, v120, v121
  v_max3_u32 v20, v20, v122, v123
  v_max3_u32 v24, v24, v124, v125
  v_max3_u32 v20, v20, v126, v127
  v_max_u32 v20, v20, v24
  s_nop 1
  v_max_u32_dpp v20, v20, v20 quad_perm:[1,0,3,2] row_mask:0xf bank_mask:0xf
  s_nop 1
  v_max_u32_dpp v20, v20, v20 quad_perm:[2,3,0,1] row_mask:0xf bank_mask:0xf
  s_nop 1
  v_max_u32_dpp v20, v20, v20 row_half_mirror row_mask:0xf bank_mask:0xf
  s_nop 1
  v_max_u32_dpp v20, v20, v20 row_mirror row_mask:0xf bank_mask:0xf
  v_mov_b32 v24, v20
  s_nop 1
  v_permlane16_swap_b32 v20, v24
  v_max_u32 v20, v20, v24
  v_mov_b32 v24, v20
  s_nop 1
  v_permlane32_swap_b32 v20, v24
  v_max_u32 v20, v20, v24
  v_add_u32 v21, v21, v20
  v_cmp_eq_u32 vcc, s23, v23
  v_sub_u32 v96, v96, v20
  v_sub_u32 v97, v97, v20
  v_sub_u32 v98, v98, v20
  v_sub_u32 v99, v99, v20
  v_sub_u32 v100, v100, v20
  v_sub_u32 v101, v101, v20
  v_sub_u32 v102, v102, v20
  v_sub_u32 v103, v103, v20
  v_sub_u32 v104, v104, v20
  v_sub_u32 v105, v105, v20
  v_sub_u32 v106, v106, v20
  v_sub_u32 v107, v107, v20
  v_sub_u32 v108, v108, v20
  v_sub_u32 v109, v109, v20
  v_sub_u32 v110, v110, v20
  v_sub_u32 v111, v111, v20
  v_sub_u32 v112, v112, v20
  v_sub_u32 v113, v113, v20
  v_sub_u32 v114, v114, v20
  v_sub_u32 v115, v115, v20
  v_sub_u32 v116, v116, v20
  v_sub_u32 v117, v117, v20
  v_sub_u32 v118, v118, v20
  v_sub_u32 v119, v119, v20
  v_sub_u32 v120, v120, v20
  v_sub_u32 v121, v121, v20
  v_sub_u32 v122, v122, v20
  v_sub_u32 v123, v123, v20
  v_sub_u32 v124, v124, v20
  v_sub_u32 v125, v125, v20
  v_sub_u32 v126, v126, v20
  v_sub_u32 v127, v127, v20
  v_cndmask_b32 v22, v22, v21, vcc
  s_add_u32 s23, s23, 1
  s_cmp_lt_u32 s23, 8
  s_cbranch_scc1 fa_top
  v_and_b32 v25, 0xffff, v22
  v_sub_u32 v25, 0xffff, v25
  v_and_b32 v25, 2047, v25
  v_ashrrev_i32 v20, 31, v22
  v_not_b32 v20, v20
  v_or_b32 v20, 0x80000000, v20
  v_xor_b32 v26, v22, v20
  v_and_b32 v26, 0xffff0000, v26
  v_mul_f32 v26, 0xbfb8aa3b, v26
  v_exp_f32 v26, v26
  s_nop 0
  v_add_f32 v26, 1.0, v26
  v_rcp_f32 v26, v26
  s_nop 0
  v_cvt_pk_bf16_f32 v26, v26, v26
  v_and_b32 v26, 0xffff0000, v26
  v_lshlrev_b32 v20, 2, v1
  v_add_u32 v20, 2629632, v20
  v_mov_b32 v21, 1073741824
  v_cmp_gt_u32 vcc, 16, v1
  v_add_u32 v25, 1, v25
  v_or_b32 v26, 1, v26
  v_cndmask_b32 v20, v21, v20, vcc
  v_cmp_gt_u32 vcc, 8, v1
  s_nop 1
  v_cndmask_b32 v26, v26, v25, vcc
  buffer_store_dword v26, v20, s[40:43], 0 offen sc1
  s_branch fa_notop
fa_hk4:
  s_getpc_b64 s[38:39]
fa_hp4:
  s_add_u32 s36, s36, 4
  s_addc_u32 s37, s37, 0
  s_sub_u32 s38, s38, fa_hp4-fa_hb4
  s_subb_u32 s39, s39, 0
  s_setpc_b64 s[36:37]
fa_hk5:
  s_getpc_b64 s[38:39]
fa_hp5:
  s_add_u32 s36, s36, 4
  s_addc_u32 s37, s37, 0
  s_sub_u32 s38, s38, fa_hp5-fa_hb5
  s_subb_u32 s39, s39, 0
  s_setpc_b64 s[36:37]
fa_hk6:
  s_getpc_b64 s[38:39]
fa_hp6:
  s_add_u32 s36, s36, 4
  s_addc_u32 s37, s37, 0
  s_add_u32 s38, s38, fa_hb6-fa_hp6
  s_addc_u32 s39, s39, 0
  s_setpc_b64 s[36:37]
fa_DDF:
  v_mfma_f32_16x16x32_bf16 v[96:99], a[128:131], v[32:35], v[192:195]
  s_waitcnt vmcnt(12)
  v_exp_f32 v218, v146
  v_mfma_f32_16x16x32_bf16 v[104:107], a[128:131], v[36:39], v[196:199]
  s_barrier
  v_exp_f32 v219, v147
  v_mfma_f32_16x16x32_bf16 v[128:131], a[128:131], v[64:67], v[200:203]
  s_cmp_ge_u32 s26, s32
  ds_read_b128 a[160:163], v3 offset:16384
  v_add_f32 v226, v216, v217
  v_mfma_f32_16x16x32_bf16 v[136:139], a[128:131], v[68:71], v[204:207]
  s_cbranch_scc1 fa_hk6
fa_hb6:
  v_exp_f32 v220, v148
  v_mfma_f32_16x16x32_bf16 v[100:103], a[132:135], v[32:35], v[192:195]
  ds_read_b128 a[164:167], v3 offset:17408
  v_cvt_pk_bf16_f32 v184, v216, v217
  v_mfma_f32_16x16x32_bf16 v[108:111], a[132:135], v[36:39], v[196:199]
  s_mov_b32 m0, s24
  v_exp_f32 v221, v149
  v_mfma_f32_16x16x32_bf16 v[132:135], a[132:135], v[64:67], v[200:203]
  buffer_load_dwordx4 v2, s[44:47], s26 offen offset:0 sc1 lds
  v_add_f32 v226, v226, v218
  v_mfma_f32_16x16x32_bf16 v[140:143], a[132:135], v[68:71], v[204:207]
  v_exp_f32 v222, v150
  v_mfma_f32_16x16x32_bf16 v[96:99], a[136:139], v[40:43], v[96:99]
  ds_read_b128 a[168:171], v3 offset:18432
  v_add_f32 v226, v226, v219
  v_cvt_pk_bf16_f32 v185, v218, v219
  v_mfma_f32_16x16x32_bf16 v[104:107], a[136:139], v[44:47], v[104:107]
  v_exp_f32 v223, v151
  v_mfma_f32_16x16x32_bf16 v[128:131], a[136:139], v[72:75], v[128:131]
  v_add_f32 v226, v226, v220
  v_add_f32 v226, v226, v221
  v_mfma_f32_16x16x32_bf16 v[136:139], a[136:139], v[76:79], v[136:139]
  v_exp_f32 v216, v152
  v_mfma_f32_16x16x32_bf16 v[100:103], a[140:143], v[40:43], v[100:103]
  ds_read_b128 a[172:175], v3 offset:19456
  v_cvt_pk_bf16_f32 v186, v220, v221
  v_mfma_f32_16x16x32_bf16 v[108:111], a[140:143], v[44:47], v[108:111]
  buffer_load_dwordx4 v2, s[44:47], s26 offen offset:1024 sc1 lds
  v_add_f32 v226, v226, v222
  v_mfma_f32_16x16x32_bf16 v[132:135], a[140:143], v[72:75], v[132:135]
  v_exp_f32 v217, v153
  v_mfma_f32_16x16x32_bf16 v[140:143], a[140:143], v[76:79], v[140:143]
  s_waitcnt lgkmcnt(4)
  v_exp_f32 v218, v154
  v_mfma_f32_16x16x32_bf16 v[96:99], a[144:147], v[48:51], v[96:99]
  ds_read_b128 a[176:179], v3 offset:20480
  v_add_f32 v226, v226, v223
  v_mfma_f32_16x16x32_bf16 v[104:107], a[144:147], v[52:55], v[104:107]
  v_exp_f32 v219, v155
  v_mfma_f32_16x16x32_bf16 v[128:131], a[144:147], v[80:83], v[128:131]
  v_cvt_pk_bf16_f32 v187, v222, v223
  v_add_f32 v227, v216, v217
  v_cvt_pk_bf16_f32 v188, v216, v217
  v_mfma_f32_16x16x32_bf16 v[136:139], a[144:147], v[84:87], v[136:139]
  buffer_load_dwordx4 v2, s[44:47], s26 offen offset:2048 sc1 lds
  v_add_f32 v227, v227, v218
  v_mfma_f32_16x16x32_bf16 v[100:103], a[148:151], v[48:51], v[100:103]
  ds_read_b128 a[180:183], v3 offset:21504
  v_add_f32 v227, v227, v219
  v_mfma_f32_16x16x32_bf16 v[108:111], a[148:151], v[52:55], v[108:111]
  v_exp_f32 v220, v156
  v_mfma_f32_16x16x32_bf16 v[132:135], a[148:151], v[80:83], v[132:135]
  v_exp_f32 v221, v157
  v_mfma_f32_16x16x32_bf16 v[140:143], a[148:151], v[84:87], v[140:143]
  v_exp_f32 v222, v158
  v_mfma_f32_16x16x32_bf16 v[96:99], a[152:155], v[56:59], v[96:99]
  ds_read_b128 a[184:187], v3 offset:22528
  v_cvt_pk_bf16_f32 v189, v218, v219
  v_mfma_f32_16x16x32_bf16 v[104:107], a[152:155], v[60:63], v[104:107]
  buffer_load_dwordx4 v2, s[44:47], s26 offen offset:3072 sc1 lds
  v_add_f32 v227, v227, v220
  v_add_f32 v227, v227, v221
  v_mfma_f32_16x16x32_bf16 v[128:131], a[152:155], v[88:91], v[128:131]
  s_add_u32 s26, s26, 16384
  v_exp_f32 v223, v159
  v_mfma_f32_16x16x32_bf16 v[136:139], a[152:155], v[92:95], v[136:139]
  s_add_u32 s24, s24, 32768
  v_exp_f32 v208, v112
  v_mfma_f32_16x16x32_bf16 v[100:103], a[156:159], v[56:59], v[100:103]
  s_and_b32 s24, s24, 0x1ffff
  ds_read_b128 a[188:191], v3 offset:23552
  v_cvt_pk_bf16_f32 v190, v220, v221
  v_mfma_f32_16x16x32_bf16 v[108:111], a[156:159], v[60:63], v[108:111]
  v_exp_f32 v209, v113
  v_mfma_f32_16x16x32_bf16 v[132:135], a[156:159], v[88:91], v[132:135]
  s_add_u32 m0, s34, 0
  v_exp_f32 v210, v114
  v_mfma_f32_16x16x32_bf16 v[140:143], a[156:159], v[92:95], v[140:143]
  s_waitcnt lgkmcnt(4)
  buffer_load_dwordx4 v8, s[52:55], s33 offen offset:0 lds
  v_add_f32 v227, v227, v222
  v_mfma_f32_16x16x32_bf16 a[0:3], a[160:163], v[160:163], a[0:3]
  ds_read_b128 a[128:131], v3 offset:0
  v_add_f32 v227, v227, v223
  v_mfma_f32_16x16x32_bf16 a[4:7], a[160:163], v[164:167], a[4:7]
  v_exp_f32 v211, v115
  v_mfma_f32_16x16x32_bf16 a[64:67], a[160:163], v[176:179], a[64:67]
  v_cvt_pk_bf16_f32 v191, v222, v223
  v_add_f32 v224, v208, v209
  v_cvt_pk_bf16_f32 v168, v208, v209
  v_mfma_f32_16x16x32_bf16 a[68:71], a[160:163], v[180:183], a[68:71]
  v_exp_f32 v212, v116
  v_mfma_f32_16x16x32_bf16 a[8:11], a[164:167], v[160:163], a[8:11]
  ds_read_b128 a[132:135], v3 offset:1024
  v_add_f32 v224, v224, v210
  v_mfma_f32_16x16x32_bf16 a[12:15], a[164:167], v[164:167], a[12:15]
  buffer_load_dwordx4 v11, s[52:55], s33 offen offset:1024 lds
  v_add_f32 v224, v224, v211
  v_mfma_f32_16x16x32_bf16 a[72:75], a[164:167], v[176:179], a[72:75]
  v_exp_f32 v213, v117
  v_mfma_f32_16x16x32_bf16 a[76:79], a[164:167], v[180:183], a[76:79]
  v_exp_f32 v214, v118
  v_mfma_f32_16x16x32_bf16 a[16:19], a[168:171], v[160:163], a[16:19]
  ds_read_b128 a[136:139], v3 offset:2048
  v_cvt_pk_bf16_f32 v169, v210, v211
  v_mfma_f32_16x16x32_bf16 a[20:23], a[168:171], v[164:167], a[20:23]
  v_exp_f32 v215, v119
  v_mfma_f32_16x16x32_bf16 a[80:83], a[168:171], v[176:179], a[80:83]
  v_add_f32 v224, v224, v212
  v_add_f32 v224, v224, v213
  v_cvt_pk_bf16_f32 v170, v212, v213
  v_mfma_f32_16x16x32_bf16 a[84:87], a[168:171], v[180:183], a[84:87]
  buffer_load_dwordx4 v12, s[52:55], s33 offen offset:2048 lds
  v_add_f32 v224, v224, v214
  v_mfma_f32_16x16x32_bf16 a[24:27], a[172:175], v[160:163], a[24:27]
  ds_read_b128 a[140:143], v3 offset:3072
  v_add_f32 v224, v224, v215
  v_mfma_f32_16x16x32_bf16 a[28:31], a[172:175], v[164:167], a[28:31]
  v_exp_f32 v208, v120
  v_mfma_f32_16x16x32_bf16 a[88:91], a[172:175], v[176:179], a[88:91]
  v_exp_f32 v209, v121
  v_mfma_f32_16x16x32_bf16 a[92:95], a[172:175], v[180:183], a[92:95]
  s_waitcnt lgkmcnt(4)
  v_exp_f32 v210, v122
  v_mfma_f32_16x16x32_bf16 a[32:35], a[176:179], v[160:163], a[32:35]
  ds_read_b128 a[144:147], v3 offset:4096
  v_cvt_pk_bf16_f32 v171, v214, v215
  v_mfma_f32_16x16x32_bf16 a[36:39], a[176:179], v[164:167], a[36:39]
  buffer_load_dwordx4 v13, s[52:55], s33 offen offset:3072 lds
  v_add_f32 v225, v208, v209
  v_mfma_f32_16x16x32_bf16 a[96:99], a[176:179], v[176:179], a[96:99]
  v_exp_f32 v211, v123
  v_mfma_f32_16x16x32_bf16 a[100:103], a[176:179], v[180:183], a[100:103]
  v_exp_f32 v212, v124
  v_mfma_f32_16x16x32_bf16 a[40:43], a[180:183], v[160:163], a[40:43]
  ds_read_b128 a[148:151], v3 offset:5120
  v_cvt_pk_bf16_f32 v172, v208, v209
  v_add_f32 v225, v225, v210
  v_mfma_f32_16x16x32_bf16 a[44:47], a[180:183], v[164:167], a[44:47]
  v_exp_f32 v213, v125
  v_mfma_f32_16x16x32_bf16 a[104:107], a[180:183], v[176:179], a[104:107]
  s_add_u32 m0, s34, 4096
  v_add_f32 v225, v225, v211
  v_cvt_pk_bf16_f32 v173, v210, v211
  v_mfma_f32_16x16x32_bf16 a[108:111], a[180:183], v[180:183], a[108:111]
  buffer_load_dwordx4 v14, s[52:55], s33 offen offset:0 lds
  v_max3_f32 v5, v226, v227, v224
  v_mfma_f32_16x16x32_bf16 a[48:51], a[184:187], v[160:163], a[48:51]
  ds_read_b128 a[152:155], v3 offset:6144
  v_add_f32 v225, v225, v212
  v_mfma_f32_16x16x32_bf16 a[52:55], a[184:187], v[164:167], a[52:55]
  v_exp_f32 v214, v126
  v_mfma_f32_16x16x32_bf16 a[112:115], a[184:187], v[176:179], a[112:115]
  v_exp_f32 v215, v127
  v_mfma_f32_16x16x32_bf16 a[116:119], a[184:187], v[180:183], a[116:119]
  v_add_f32 v225, v225, v213
  v_cvt_pk_bf16_f32 v174, v212, v213
  v_add_f32 v225, v225, v214
  v_mfma_f32_16x16x32_bf16 a[56:59], a[188:191], v[160:163], a[56:59]
  ds_read_b128 a[156:159], v3 offset:7168
  v_add_f32 v225, v225, v215
  v_max_f32 v5, v5, v225
  v_cmp_lt_f32 vcc, s81, v5
  v_mfma_f32_16x16x32_bf16 a[60:63], a[188:191], v[164:167], a[60:63]
  v_exp_f32 v216, v128
  v_mfma_f32_16x16x32_bf16 a[120:123], a[188:191], v[176:179], a[120:123]
  s_waitcnt lgkmcnt(4)
  v_cvt_pk_bf16_f32 v175, v214, v215
  v_mfma_f32_16x16x32_bf16 a[124:127], a[188:191], v[180:183], a[124:127]
  s_cbranch_vccnz fa_stub3
fa_back3:
  v_exp_f32 v217, v129
  v_add_f32 v228, v228, v224
  v_add_f32 v229, v229, v225
  v_add_f32 v230, v230, v226
  v_add_f32 v231, v231, v227
  s_branch fa_DDe
fa_kv2_spin:
  s_mov_b32 s83, 200000
fa_kv2_spin2:
  buffer_load_dword v14, v13, s[40:43], 0 offen sc1
  s_waitcnt vmcnt(0)
  v_cmp_eq_u32 vcc, 0, v14
  s_cbranch_vccz fa_kv2_ok
  s_sleep 8
  s_sub_u32 s83, s83, 1
  s_cmp_lg_u32 s83, 0
  s_cbranch_scc1 fa_kv2_spin2
  s_branch fa_kv2_ok
fa_kv3_spin:
  s_mov_b32 s83, 200000
fa_kv3_spin2:
  buffer_load_dword v14, v13, s[40:43], 0 offen sc1
  s_waitcnt vmcnt(0)
  v_cmp_eq_u32 vcc, 0, v14
  s_cbranch_vccz fa_kv3_ok
  s_sleep 8
  s_sub_u32 s83, s83, 1
  s_cmp_lg_u32 s83, 0
  s_cbranch_scc1 fa_kv3_spin2
  s_branch fa_kv3_ok
fa_sel_spin:
  s_mov_b32 s83, 200000
fa_sel_spin2:
  buffer_load_dword v15, v252, s[40:43], 0 offen sc1
  s_waitcnt vmcnt(0)
  v_cmp_eq_u32 vcc, 0, v15
  s_cbranch_vccz fa_sel_ok
  s_sleep 8
  s_sub_u32 s83, s83, 1
  s_cmp_lg_u32 s83, 0
  s_cbranch_scc1 fa_sel_spin2
  s_branch fa_sel_ok
fa_wof_spin:
  s_mov_b32 s83, 200000
fa_wof_spin2:
  buffer_load_dword v8, v9, s[40:43], 0 offen sc1
  s_waitcnt vmcnt(0)
  v_cmp_eq_u32 vcc, 0, v8
  s_cbranch_vccz fa_wof_ok
  s_sleep 8
  s_sub_u32 s83, s83, 1
  s_cmp_lg_u32 s83, 0
  s_cbranch_scc1 fa_wof_spin2
  s_branch fa_wof_ok
fa_sel4_spin:
  s_mov_b32 s83, 200000
fa_sel4_spin2:
  buffer_load_dword v15, v10, s[40:43], 0 offen sc1
  s_waitcnt vmcnt(0)
  v_cmp_eq_u32 vcc, 0, v15
  s_cbranch_vccz fa_sel4_ok
  s_sleep 8
  s_sub_u32 s83, s83, 1
  s_cmp_lg_u32 s83, 0
  s_cbranch_scc1 fa_sel4_spin2
  s_branch fa_sel4_ok
fa_yf_spin:
  s_mov_b32 s83, 200000
fa_yf_spin2:
  buffer_load_dword v14, v11, s[40:43], 0 offen sc1
  s_waitcnt vmcnt(0)
  v_cmp_eq_u32 vcc, 0, v14
  s_cbranch_vccz fa_yf_ok
  s_sleep 8
  s_sub_u32 s83, s83, 1
  s_cmp_lg_u32 s83, 0
  s_cbranch_scc1 fa_yf_spin2
  s_branch fa_yf_ok
fa_co:
  s_sub_u32 s14, s2, 64
  s_cmp_lt_u32 s14, 96
  s_cbranch_scc1 fa_coT
  s_sub_u32 s14, s2, 128
  s_sub_u32 s23, s2, 224
  s_cmp_lt_u32 s23, 31
  s_cbranch_scc1 fa_coT
  v_cmp_eq_u32 vcc, 0, v14
  s_cbranch_vccnz fa_kv2_spin
fa_kv2_ok:
  s_sub_u32 s14, s2, 170
  s_cmp_lt_u32 s14, 54
  s_cbranch_scc1 fa_coF
  s_cmp_eq_u32 s2, 255
  s_cbranch_scc1 fa_coW
  s_branch fa_coO
fa_coT:
  v_min_u32 v8, 16, v1
  v_lshlrev_b32 v8, 7, v8
  s_lshl_b32 s10, s14, 1
  s_and_b32 s31, s20, 1
  s_add_u32 s10, s10, s31
  s_mul_i32 s10, s10, 2176
  s_lshl_b32 s35, s14, 2
  s_add_u32 s35, s35, s20
  s_mul_i32 s35, s35, 4352
  buffer_load_dword v255, v8, s[52:55], s10 offen
  s_add_u32 s10, s10, 552960
  s_getpc_b64 s[36:37]
  s_setpc_b64 s[38:39]
  buffer_load_dword v255, v8, s[52:55], s10 offen
  s_add_u32 s10, s10, 552960
  s_getpc_b64 s[36:37]
  s_setpc_b64 s[38:39]
  v_cmp_eq_u32 vcc, 0, v14
  s_cbranch_vccnz fa_kv3_spin
fa_kv3_ok:
  buffer_load_dword v255, v8, s[52:55], s10 offen
  s_add_u32 s10, s10, 552960
  buffer_load_dword v255, v8, s[60:63], s35 offen offset:0
  s_getpc_b64 s[36:37]
  s_setpc_b64 s[38:39]
  buffer_load_dword v255, v8, s[52:55], s10 offen
  s_add_u32 s10, s10, 552960
  buffer_load_dword v255, v8, s[60:63], s35 offen offset:2176
  s_mov_b32 s9, -1
  s_and_b32 s32, s21, 3
  s_lshr_b32 s32, s32, 1
  s_add_u32 s32, s32, 6
  s_lshl_b32 s32, s32, 14
  s_getpc_b64 s[36:37]
  s_setpc_b64 s[38:39]
fa_coO:
  s_and_b32 s23, s67, 1
  s_lshl_b32 s23, s23, 2
  s_add_u32 s23, s23, s20
  s_lshr_b32 s31, s67, 1
  s_mul_i32 s33, s23, 0
  s_add_u32 s33, s33, s31
  s_and_b32 s33, s33, 31
  s_andn2_b32 s30, s31, 31
  s_add_u32 s33, s33, s30
  s_lshl_b32 s30, s23, 7
  s_add_u32 s30, s30, s33
  s_mul_i32 s33, s31, 40960
  s_mul_i32 s23, s23, 160
  s_add_u32 s33, s33, s23
  s_add_u32 m0, s34, 0
  v_accvgpr_read_b32 v19, a248
  buffer_load_dwordx4 v19, s[56:59], s33 offen lds
  s_add_u32 m0, s34, 1024
  v_accvgpr_read_b32 v19, a249
  buffer_load_dwordx4 v19, s[56:59], s33 offen lds
  s_add_u32 m0, s34, 2048
  v_accvgpr_read_b32 v19, a250
  buffer_load_dwordx4 v19, s[56:59], s33 offen lds
  s_add_u32 m0, s34, 3072
  v_accvgpr_read_b32 v19, a251
  buffer_load_dwordx4 v19, s[56:59], s33 offen lds
  s_add_u32 m0, s34, 4096
  v_accvgpr_read_b32 v19, a252
  buffer_load_dwordx4 v19, s[56:59], s33 offen lds
  s_add_u32 s32, s26, 32768
  s_mov_b32 s9, -1
  s_lshl_b32 s10, s30, 2
  s_mul_i32 s30, s30, 5120
  s_add_u32 s30, s30, 4194304
  s_getpc_b64 s[36:37]
  s_setpc_b64 s[38:39]
  s_waitcnt vmcnt(8)
  ds_read_b64_tr_b16 v[232:233], v6 offset:0
  ds_read_b64_tr_b16 v[234:235], v6 offset:2560
  ds_read_b64_tr_b16 v[236:237], v6 offset:32
  ds_read_b64_tr_b16 v[238:239], v6 offset:2592
  ds_read_b64_tr_b16 v[240:241], v6 offset:64
  ds_read_b64_tr_b16 v[242:243], v6 offset:2624
  ds_read_b64_tr_b16 v[244:245], v6 offset:96
  ds_read_b64_tr_b16 v[246:247], v6 offset:2656
  ds_read_b64_tr_b16 v[248:249], v6 offset:128
  ds_read_b64_tr_b16 v[250:251], v6 offset:2688
  s_waitcnt lgkmcnt(0)
  s_add_u32 s31, s30, 4096
  buffer_store_dwordx4 v[232:235], v2, s[40:43], s30 offen offset:0 sc1
  buffer_store_dwordx4 v[236:239], v2, s[40:43], s30 offen offset:1024 sc1
  buffer_store_dwordx4 v[240:243], v2, s[40:43], s30 offen offset:2048 sc1
  buffer_store_dwordx4 v[244:247], v2, s[40:43], s30 offen offset:3072 sc1
  buffer_store_dwordx4 v[248:251], v2, s[40:43], s31 offen offset:0 sc1
  s_getpc_b64 s[36:37]
  s_setpc_b64 s[38:39]
  s_add_u32 s23, s10, 2654208
  s_waitcnt vmcnt(8)
  buffer_store_dword v4, off, s[40:43], s23 sc1
  s_sub_u32 s23, s67, 96
  s_cmp_gt_u32 s23, 54
  s_cbranch_scc1 fa_coW
  s_add_u32 s67, s23, 170
  s_cmp_eq_u32 s67, 224
  s_cselect_b32 s67, 255, s67
  s_branch fa_coO
fa_coF:
  v_and_b32 v16, 7, v1
  v_lshlrev_b32 v252, 2, v16
  v_add_u32 v252, 2629632, v252
  buffer_load_dword v15, v252, s[40:43], 0 offen sc1
  s_lshl_b32 s33, s14, 6
  s_and_b32 s31, s20, 1
  s_lshl_b32 s31, s31, 5
  s_add_u32 s33, s33, s31
  s_mul_i32 s35, s14, 40960
  s_mul_i32 s31, s20, 320
  s_add_u32 s35, s35, s31
  s_mul_i32 s10, s14, 20480
  s_mul_i32 s31, s20, 640
  s_add_u32 s10, s10, s31
  s_add_u32 s10, s10, 2686976
  v_lshrrev_b32 v17, 1, v1
  v_mul_u32_u24 v8, 3456, v17
  v_and_b32 v17, 1, v1
  v_lshl_add_u32 v8, v17, 4, v8
  v_add_u32 v11, 109568, v8
  v_add_u32 v12, 219136, v8
  v_add_u32 v13, 328704, v8
  v_add_u32 v14, 442368, v8
  v_lshrrev_b32 v17, 4, v1
  v_lshrrev_b32 v18, 2, v1
  v_lshl_add_u32 v18, v17, 2, v18
  v_lshlrev_b32 v18, 5, v18
  v_and_b32 v19, 3, v1
  v_lshl_add_u32 v9, v19, 3, v18
  v_add_u32 v9, s34, v9
  v_lshlrev_b32 v10, 4, v16
  v_lshl_add_u32 v10, v17, 7, v10
  v_add_u32 v10, 151552, v10
  s_mov_b32 s8, -1
  v_mov_b32 v232, 0
  v_mov_b32 v233, 0
  v_mov_b32 v234, 0
  v_mov_b32 v235, 0
  s_getpc_b64 s[36:37]
  s_setpc_b64 s[38:39]
  s_waitcnt vmcnt(8)
  v_cmp_eq_u32 vcc, 0, v15
  s_cbranch_vccnz fa_sel_spin
fa_sel_ok:
  v_add_u32 v18, -1, v15
  v_and_b32 v18, 2047, v18
  v_lshrrev_b32 v19, 4, v18
  v_mul_u32_u24 v19, 20480, v19
  v_and_b32 v18, 15, v18
  v_lshl_add_u32 v19, v18, 4, v19
  v_lshrrev_b32 v18, 3, v1
  v_lshl_add_u32 v19, v18, 8, v19
  s_lshl_b32 s23, s20, 11
  s_lshl_b32 s31, s20, 10
  s_add_u32 s31, s31, 151552
  s_mov_b32 s14, 4
  s_mov_b32 m0, s31
  s_add_u32 s31, s31, 4096
  buffer_load_dwordx4 v19, s[40:43], s23 offen sc1 lds
  s_add_u32 s23, s23, 8192
  s_mov_b32 m0, s31
  s_add_u32 s31, s31, 4096
  buffer_load_dwordx4 v19, s[40:43], s23 offen sc1 lds
  s_add_u32 s23, s23, 8192
  s_mov_b32 m0, s31
  s_add_u32 s31, s31, 4096
  buffer_load_dwordx4 v19, s[40:43], s23 offen sc1 lds
  s_add_u32 s23, s23, 8192
  s_getpc_b64 s[36:37]
  s_setpc_b64 s[38:39]
  s_branch fa_coG1
fa_coG:
  s_getpc_b64 s[36:37]
  s_setpc_b64 s[38:39]
  v_mfma_f32_16x16x32_bf16 v[232:235], a[192:195], a[212:215], v[232:235]
  v_mfma_f32_16x16x32_bf16 v[232:235], a[196:199], a[216:219], v[232:235]
  v_mfma_f32_16x16x32_bf16 v[232:235], a[200:203], a[220:223], v[232:235]
  v_mfma_f32_16x16x32_bf16 v[232:235], a[204:207], a[224:227], v[232:235]
  v_mfma_f32_16x16x32_bf16 v[232:235], a[208:211], a[228:231], v[232:235]
fa_coG1:
  s_waitcnt vmcnt(4)
  ds_read_b64_tr_b16 a[192:193], v9 offset:0
  ds_read_b64_tr_b16 a[194:195], v9 offset:128
  ds_read_b128 a[212:215], v10 offset:0
  ds_read_b64_tr_b16 a[196:197], v9 offset:1024
  ds_read_b64_tr_b16 a[198:199], v9 offset:1152
  ds_read_b128 a[216:219], v10 offset:512
  ds_read_b64_tr_b16 a[200:201], v9 offset:2048
  ds_read_b64_tr_b16 a[202:203], v9 offset:2176
  ds_read_b128 a[220:223], v10 offset:1024
  ds_read_b64_tr_b16 a[204:205], v9 offset:3072
  ds_read_b64_tr_b16 a[206:207], v9 offset:3200
  ds_read_b128 a[224:227], v10 offset:1536
  ds_read_b64_tr_b16 a[208:209], v9 offset:4096
  ds_read_b64_tr_b16 a[210:211], v9 offset:4224
  ds_read_b128 a[228:231], v10 offset:2048
  v_add_u32 v10, 2560, v10
  s_add_u32 s33, s33, 552960
  s_sub_u32 s14, s14, 1
  s_cmp_lg_u32 s14, 0
  s_cbranch_scc1 fa_coG
  v_accvgpr_read_b32 v8, a248
  v_accvgpr_read_b32 v11, a249
  v_accvgpr_read_b32 v12, a250
  v_accvgpr_read_b32 v13, a251
  v_accvgpr_read_b32 v14, a252
  v_subrev_u32 v11, 1024, v11
  v_subrev_u32 v12, 2048, v12
  v_subrev_u32 v13, 3072, v13
  s_mov_b32 s52, s60
  s_mov_b32 s53, s61
  s_mov_b32 s33, s35
  s_lshl_b32 s23, s20, 9
  v_add_u32 v16, s23, v10
  v_and_b32 v17, 7, v1
  v_mul_u32_u24 v9, 2560, v17
  v_lshrrev_b32 v17, 4, v1
  v_lshl_add_u32 v9, v17, 4, v9
  v_and_b32 v17, 8, v1
  v_lshl_add_u32 v9, v17, 27, v9
  s_waitcnt lgkmcnt(0)
  v_mfma_f32_16x16x32_bf16 v[232:235], a[192:195], a[212:215], v[232:235]
  v_mfma_f32_16x16x32_bf16 v[232:235], a[196:199], a[216:219], v[232:235]
  v_mfma_f32_16x16x32_bf16 v[232:235], a[200:203], a[220:223], v[232:235]
  v_mfma_f32_16x16x32_bf16 v[232:235], a[204:207], a[224:227], v[232:235]
  v_mfma_f32_16x16x32_bf16 v[232:235], a[208:211], a[228:231], v[232:235]
  s_nop 7
  ds_write_b128 v16, v[232:235]
  s_getpc_b64 s[36:37]
  s_setpc_b64 s[38:39]
  ds_read_b128 v[236:239], v10 offset:0
  ds_read_b128 v[240:243], v10 offset:512
  ds_read_b128 v[244:247], v10 offset:1024
  ds_read_b128 v[248:251], v10 offset:1536
  s_waitcnt vmcnt(4)
  ds_read_b64_tr_b16 a[192:193], v6 offset:0
  ds_read_b64_tr_b16 a[194:195], v6 offset:2560
  ds_read_b64_tr_b16 a[196:197], v6 offset:32
  ds_read_b64_tr_b16 a[198:199], v6 offset:2592
  ds_read_b64_tr_b16 a[200:201], v6 offset:64
  ds_read_b64_tr_b16 a[202:203], v6 offset:2624
  ds_read_b64_tr_b16 a[204:205], v6 offset:96
  ds_read_b64_tr_b16 a[206:207], v6 offset:2656
  ds_read_b64_tr_b16 a[208:209], v6 offset:128
  ds_read_b64_tr_b16 a[210:211], v6 offset:2688
  s_add_u32 s33, s33, 160
  s_mov_b32 s8, 0
  s_waitcnt lgkmcnt(10)
  v_cvt_pk_bf16_f32 v236, v236, v244
  v_cvt_pk_bf16_f32 v237, v237, v245
  v_cvt_pk_bf16_f32 v238, v238, v246
  v_cvt_pk_bf16_f32 v239, v239, v247
  v_cvt_pk_bf16_f32 v240, v240, v248
  v_cvt_pk_bf16_f32 v241, v241, v249
  v_cvt_pk_bf16_f32 v242, v242, v250
  v_cvt_pk_bf16_f32 v243, v243, v251
  v_lshlrev_b32 v244, 16, v236
  v_lshlrev_b32 v245, 16, v237
  v_lshlrev_b32 v246, 16, v238
  v_lshlrev_b32 v247, 16, v239
  v_lshlrev_b32 v248, 16, v240
  v_lshlrev_b32 v249, 16, v241
  v_lshlrev_b32 v250, 16, v242
  v_lshlrev_b32 v251, 16, v243
  v_mul_f32 v16, 0xbfb8aa3b, v244
  v_mul_f32 v17, 0xbfb8aa3b, v245
  v_mul_f32 v18, 0xbfb8aa3b, v246
  v_mul_f32 v19, 0xbfb8aa3b, v247
  v_mul_f32 v20, 0xbfb8aa3b, v248
  v_mul_f32 v21, 0xbfb8aa3b, v249
  v_mul_f32 v22, 0xbfb8aa3b, v250
  v_mul_f32 v23, 0xbfb8aa3b, v251
  v_exp_f32 v16, v16
  v_exp_f32 v17, v17
  v_exp_f32 v18, v18
  v_exp_f32 v19, v19
  v_exp_f32 v20, v20
  v_exp_f32 v21, v21
  v_exp_f32 v22, v22
  v_exp_f32 v23, v23
  v_add_f32 v16, 1.0, v16
  v_add_f32 v17, 1.0, v17
  v_add_f32 v18, 1.0, v18
  v_add_f32 v19, 1.0, v19
  v_add_f32 v20, 1.0, v20
  v_add_f32 v21, 1.0, v21
  v_add_f32 v22, 1.0, v22
  v_add_f32 v23, 1.0, v23
  v_rcp_f32 v16, v16
  v_rcp_f32 v17, v17
  v_rcp_f32 v18, v18
  v_rcp_f32 v19, v19
  v_rcp_f32 v20, v20
  v_rcp_f32 v21, v21
  v_rcp_f32 v22, v22
  v_rcp_f32 v23, v23
  v_and_b32 v236, 0xffff0000, v236
  v_and_b32 v237, 0xffff0000, v237
  v_and_b32 v238, 0xffff0000, v238
  v_and_b32 v239, 0xffff0000, v239
  v_and_b32 v240, 0xffff0000, v240
  v_and_b32 v241, 0xffff0000, v241
  v_and_b32 v242, 0xffff0000, v242
  v_and_b32 v243, 0xffff0000, v243
  v_pk_mul_f32 v[244:245], v[244:245], v[16:17]
  v_pk_mul_f32 v[246:247], v[246:247], v[18:19]
  v_pk_mul_f32 v[248:249], v[248:249], v[20:21]
  v_pk_mul_f32 v[250:251], v[250:251], v[22:23]
  v_cvt_pk_bf16_f32 v16, v244, v245
  v_cvt_pk_bf16_f32 v17, v246, v247
  v_cvt_pk_bf16_f32 v18, v248, v249
  v_cvt_pk_bf16_f32 v19, v250, v251
  v_lshlrev_b32 v244, 16, v16
  v_and_b32 v245, 0xffff0000, v16
  v_lshlrev_b32 v246, 16, v17
  v_and_b32 v247, 0xffff0000, v17
  v_lshlrev_b32 v248, 16, v18
  v_and_b32 v249, 0xffff0000, v18
  v_lshlrev_b32 v250, 16, v19
  v_and_b32 v251, 0xffff0000, v19
  v_pk_mul_f32 v[236:237], v[236:237], v[244:245]
  v_pk_mul_f32 v[238:239], v[238:239], v[246:247]
  v_pk_mul_f32 v[240:241], v[240:241], v[248:249]
  v_pk_mul_f32 v[242:243], v[242:243], v[250:251]
  v_cvt_pk_bf16_f32 v232, v236, v237
  v_cvt_pk_bf16_f32 v233, v238, v239
  v_cvt_pk_bf16_f32 v234, v240, v241
  v_cvt_pk_bf16_f32 v235, v242, v243
  s_nop 0
  s_waitcnt lgkmcnt(0)
  v_mfma_f32_16x16x32_bf16 v[236:239], a[192:195], v[232:235], 0
  v_mfma_f32_16x16x32_bf16 v[240:243], a[196:199], v[232:235], 0
  v_mfma_f32_16x16x32_bf16 v[244:247], a[200:203], v[232:235], 0
  v_mfma_f32_16x16x32_bf16 v[248:251], a[204:207], v[232:235], 0
  v_mfma_f32_16x16x32_bf16 v[252:255], a[208:211], v[232:235], 0
  s_nop 3
  buffer_store_dwordx4 v[236:239], v9, s[40:43], s10 offen offset:0 sc1
  buffer_store_dwordx4 v[240:243], v9, s[40:43], s10 offen offset:64 sc1
  buffer_store_dwordx4 v[244:247], v9, s[40:43], s10 offen offset:128 sc1
  buffer_store_dwordx4 v[248:251], v9, s[40:43], s10 offen offset:192 sc1
  buffer_store_dwordx4 v[252:255], v9, s[40:43], s10 offen offset:256 sc1
  s_add_u32 s10, s10, 320
  s_getpc_b64 s[36:37]
  s_setpc_b64 s[38:39]
  s_waitcnt vmcnt(4)
  ds_read_b64_tr_b16 a[192:193], v6 offset:0
  ds_read_b64_tr_b16 a[194:195], v6 offset:2560
  ds_read_b64_tr_b16 a[196:197], v6 offset:32
  ds_read_b64_tr_b16 a[198:199], v6 offset:2592
  ds_read_b64_tr_b16 a[200:201], v6 offset:64
  ds_read_b64_tr_b16 a[202:203], v6 offset:2624
  ds_read_b64_tr_b16 a[204:205], v6 offset:96
  ds_read_b64_tr_b16 a[206:207], v6 offset:2656
  ds_read_b64_tr_b16 a[208:209], v6 offset:128
  ds_read_b64_tr_b16 a[210:211], v6 offset:2688
  s_waitcnt lgkmcnt(0)
  v_mfma_f32_16x16x32_bf16 v[236:239], a[192:195], v[232:235], 0
  v_mfma_f32_16x16x32_bf16 v[240:243], a[196:199], v[232:235], 0
  v_mfma_f32_16x16x32_bf16 v[244:247], a[200:203], v[232:235], 0
  v_mfma_f32_16x16x32_bf16 v[248:251], a[204:207], v[232:235], 0
  v_mfma_f32_16x16x32_bf16 v[252:255], a[208:211], v[232:235], 0
  s_nop 3
  buffer_store_dwordx4 v[236:239], v9, s[40:43], s10 offen offset:0 sc1
  buffer_store_dwordx4 v[240:243], v9, s[40:43], s10 offen offset:64 sc1
  buffer_store_dwordx4 v[244:247], v9, s[40:43], s10 offen offset:128 sc1
  buffer_store_dwordx4 v[248:251], v9, s[40:43], s10 offen offset:192 sc1
  buffer_store_dwordx4 v[252:255], v9, s[40:43], s10 offen offset:256 sc1
  s_add_u32 s10, s10, 320
  s_getpc_b64 s[36:37]
  s_setpc_b64 s[38:39]
  s_sub_u32 s23, s2, 170
  s_lshl_b32 s31, s20, 6
  s_add_u32 s23, s23, s31
  s_lshl_b32 s23, s23, 2
  s_add_u32 s23, s23, 2650112
  s_waitcnt vmcnt(8)
  buffer_store_dword v4, off, s[40:43], s23 sc1
fa_coW:
  s_mov_b32 s12, 1
  s_mov_b32 s9, -1
  s_cmp_lg_u32 s11, 0
  s_cselect_b32 s32, s15, -1
  s_getpc_b64 s[36:37]
  s_setpc_b64 s[38:39]
  s_lshl_b32 s23, s22, 2
  s_add_u32 s23, s23, s20
  s_mul_i32 s13, s23, 163840
  s_add_u32 s13, s13, 4194304
  s_lshl_b32 s23, s23, 7
  s_add_u32 s23, s23, 2654208
  v_and_b32 v9, 31, v1
  v_lshl_add_u32 v9, v9, 2, s23
  v_and_b32 v10, 15, v1
  v_lshlrev_b32 v10, 2, v10
  v_add_u32 v10, 2629632, v10
  buffer_load_dword v8, v9, s[40:43], 0 offen sc1
  buffer_load_dword v15, v10, s[40:43], 0 offen sc1
  v_mov_b32 v20, v228
  v_mov_b32 v21, v229
  s_nop 1
  v_permlane16_swap_b32 v228, v20
  v_permlane16_swap_b32 v229, v21
  v_add_f32 v228, v228, v20
  v_add_f32 v229, v229, v21
  v_mov_b32 v20, v228
  v_mov_b32 v21, v229
  s_nop 1
  v_permlane32_swap_b32 v228, v20
  v_permlane32_swap_b32 v229, v21
  v_add_f32 v228, v228, v20
  v_add_f32 v229, v229, v21
  v_rcp_f32 v16, v228
  v_rcp_f32 v18, v229
  s_lshl_b32 s23, s22, 2
  v_mov_b32 v17, v16
  v_mov_b32 v19, v18
  s_add_u32 s23, s23, s20
  s_lshl_b32 s23, s23, 18
  s_lshl_b32 s31, s21, 12
  s_add_u32 s31, s31, 50331648
  s_add_u32 s64, s23, s31
  s_add_u32 s65, s64, 131072
  v_accvgpr_read_b32 v36, a0
  v_accvgpr_read_b32 v37, a1
  v_accvgpr_read_b32 v38, a2
  v_accvgpr_read_b32 v39, a3
  v_accvgpr_read_b32 v40, a8
  v_accvgpr_read_b32 v41, a9
  v_accvgpr_read_b32 v42, a10
  v_accvgpr_read_b32 v43, a11
  v_pk_mul_f32 v[36:37], v[36:37], v[16:17]
  v_pk_mul_f32 v[38:39], v[38:39], v[16:17]
  v_pk_mul_f32 v[40:41], v[40:41], v[16:17]
  v_pk_mul_f32 v[42:43], v[42:43], v[16:17]
  v_cvt_pk_bf16_f32 v32, v36, v37
  v_cvt_pk_bf16_f32 v33, v38, v39
  v_cvt_pk_bf16_f32 v34, v40, v41
  v_cvt_pk_bf16_f32 v35, v42, v43
  buffer_store_dwordx4 v[32:35], v2, s[40:43], s64 offen offset:0 sc1
  v_accvgpr_read_b32 v48, a16
  v_accvgpr_read_b32 v49, a17
  v_accvgpr_read_b32 v50, a18
  v_accvgpr_read_b32 v51, a19
  v_accvgpr_read_b32 v52, a24
  v_accvgpr_read_b32 v53, a25
  v_accvgpr_read_b32 v54, a26
  v_accvgpr_read_b32 v55, a27
  v_pk_mul_f32 v[48:49], v[48:49], v[16:17]
  v_pk_mul_f32 v[50:51], v[50:51], v[16:17]
  v_pk_mul_f32 v[52:53], v[52:53], v[16:17]
  v_pk_mul_f32 v[54:55], v[54:55], v[16:17]
  v_cvt_pk_bf16_f32 v44, v48, v49
  v_cvt_pk_bf16_f32 v45, v50, v51
  v_cvt_pk_bf16_f32 v46, v52, v53
  v_cvt_pk_bf16_f32 v47, v54, v55
  buffer_store_dwordx4 v[44:47], v2, s[40:43], s64 offen offset:1024 sc1
  v_accvgpr_read_b32 v100, a32
  v_accvgpr_read_b32 v101, a33
  v_accvgpr_read_b32 v102, a34
  v_accvgpr_read_b32 v103, a35
  v_accvgpr_read_b32 v104, a40
  v_accvgpr_read_b32 v105, a41
  v_accvgpr_read_b32 v106, a42
  v_accvgpr_read_b32 v107, a43
  v_pk_mul_f32 v[100:101], v[100:101], v[16:17]
  v_pk_mul_f32 v[102:103], v[102:103], v[16:17]
  v_pk_mul_f32 v[104:105], v[104:105], v[16:17]
  v_pk_mul_f32 v[106:107], v[106:107], v[16:17]
  v_cvt_pk_bf16_f32 v96, v100, v101
  v_cvt_pk_bf16_f32 v97, v102, v103
  v_cvt_pk_bf16_f32 v98, v104, v105
  v_cvt_pk_bf16_f32 v99, v106, v107
  buffer_store_dwordx4 v[96:99], v2, s[40:43], s64 offen offset:2048 sc1
  v_accvgpr_read_b32 v112, a48
  v_accvgpr_read_b32 v113, a49
  v_accvgpr_read_b32 v114, a50
  v_accvgpr_read_b32 v115, a51
  v_accvgpr_read_b32 v116, a56
  v_accvgpr_read_b32 v117, a57
  v_accvgpr_read_b32 v118, a58
  v_accvgpr_read_b32 v119, a59
  v_pk_mul_f32 v[112:113], v[112:113], v[16:17]
  v_pk_mul_f32 v[114:115], v[114:115], v[16:17]
  v_pk_mul_f32 v[116:117], v[116:117], v[16:17]
  v_pk_mul_f32 v[118:119], v[118:119], v[16:17]
  v_cvt_pk_bf16_f32 v108, v112, v113
  v_cvt_pk_bf16_f32 v109, v114, v115
  v_cvt_pk_bf16_f32 v110, v116, v117
  v_cvt_pk_bf16_f32 v111, v118, v119
  buffer_store_dwordx4 v[108:111], v2, s[40:43], s64 offen offset:3072 sc1
  v_accvgpr_read_b32 v36, a4
  v_accvgpr_read_b32 v37, a5
  v_accvgpr_read_b32 v38, a6
  v_accvgpr_read_b32 v39, a7
  v_accvgpr_read_b32 v40, a12
  v_accvgpr_read_b32 v41, a13
  v_accvgpr_read_b32 v42, a14
  v_accvgpr_read_b32 v43, a15
  v_pk_mul_f32 v[36:37], v[36:37], v[18:19]
  v_pk_mul_f32 v[38:39], v[38:39], v[18:19]
  v_pk_mul_f32 v[40:41], v[40:41], v[18:19]
  v_pk_mul_f32 v[42:43], v[42:43], v[18:19]
  v_cvt_pk_bf16_f32 v32, v36, v37
  v_cvt_pk_bf16_f32 v33, v38, v39
  v_cvt_pk_bf16_f32 v34, v40, v41
  v_cvt_pk_bf16_f32 v35, v42, v43
  buffer_store_dwordx4 v[32:35], v2, s[40:43], s65 offen offset:0 sc1
  v_accvgpr_read_b32 v48, a20
  v_accvgpr_read_b32 v49, a21
  v_accvgpr_read_b32 v50, a22
  v_accvgpr_read_b32 v51, a23
  v_accvgpr_read_b32 v52, a28
  v_accvgpr_read_b32 v53, a29
  v_accvgpr_read_b32 v54, a30
  v_accvgpr_read_b32 v55, a31
  v_pk_mul_f32 v[48:49], v[48:49], v[18:19]
  v_pk_mul_f32 v[50:51], v[50:51], v[18:19]
  v_pk_mul_f32 v[52:53], v[52:53], v[18:19]
  v_pk_mul_f32 v[54:55], v[54:55], v[18:19]
  v_cvt_pk_bf16_f32 v44, v48, v49
  v_cvt_pk_bf16_f32 v45, v50, v51
  v_cvt_pk_bf16_f32 v46, v52, v53
  v_cvt_pk_bf16_f32 v47, v54, v55
  buffer_store_dwordx4 v[44:47], v2, s[40:43], s65 offen offset:1024 sc1
  v_accvgpr_read_b32 v100, a36
  v_accvgpr_read_b32 v101, a37
  v_accvgpr_read_b32 v102, a38
  v_accvgpr_read_b32 v103, a39
  v_accvgpr_read_b32 v104, a44
  v_accvgpr_read_b32 v105, a45
  v_accvgpr_read_b32 v106, a46
  v_accvgpr_read_b32 v107, a47
  v_pk_mul_f32 v[100:101], v[100:101], v[18:19]
  v_pk_mul_f32 v[102:103], v[102:103], v[18:19]
  v_pk_mul_f32 v[104:105], v[104:105], v[18:19]
  v_pk_mul_f32 v[106:107], v[106:107], v[18:19]
  v_cvt_pk_bf16_f32 v96, v100, v101
  v_cvt_pk_bf16_f32 v97, v102, v103
  v_cvt_pk_bf16_f32 v98, v104, v105
  v_cvt_pk_bf16_f32 v99, v106, v107
  buffer_store_dwordx4 v[96:99], v2, s[40:43], s65 offen offset:2048 sc1
  v_accvgpr_read_b32 v112, a52
  v_accvgpr_read_b32 v113, a53
  v_accvgpr_read_b32 v114, a54
  v_accvgpr_read_b32 v115, a55
  v_accvgpr_read_b32 v116, a60
  v_accvgpr_read_b32 v117, a61
  v_accvgpr_read_b32 v118, a62
  v_accvgpr_read_b32 v119, a63
  v_pk_mul_f32 v[112:113], v[112:113], v[18:19]
  v_pk_mul_f32 v[114:115], v[114:115], v[18:19]
  v_pk_mul_f32 v[116:117], v[116:117], v[18:19]
  v_pk_mul_f32 v[118:119], v[118:119], v[18:19]
  v_cvt_pk_bf16_f32 v108, v112, v113
  v_cvt_pk_bf16_f32 v109, v114, v115
  v_cvt_pk_bf16_f32 v110, v116, v117
  v_cvt_pk_bf16_f32 v111, v118, v119
  buffer_store_dwordx4 v[108:111], v2, s[40:43], s65 offen offset:3072 sc1
  s_mov_b32 s28, s46
  s_add_u32 s30, s28, 65536
  s_lshl_b32 s23, s20, 12
  s_add_u32 s23, s23, s28
  s_add_u32 s31, s13, 98304
  s_sub_u32 s31, s31, s23
  s_add_u32 s4, s18, s31
  s_addc_u32 s5, s19, 0
  s_add_u32 s6, s4, 4096
  s_addc_u32 s7, s5, 0
  s_waitcnt vmcnt(8)
  v_cmp_eq_u32 vcc, 0, v8
  s_cbranch_vccnz fa_wof_spin
fa_wof_ok:
  v_cmp_eq_u32 vcc, 0, v15
  s_cbranch_vccnz fa_sel4_spin
fa_sel4_ok:
  s_lshl_b32 s31, s21, 6
  s_add_u32 s31, s31, 1
  v_subrev_u32 v16, s31, v15
  v_cmp_gt_u32 vcc, 64, v16
  s_cmp_lt_u32 s20, 2
  s_cselect_b32 s23, 0xff, 0
  s_and_b32 s10, vcc_lo, s23
  s_sub_u32 s23, s10, 1
  s_and_b32 s23, s23, s10
  s_cmp_eq_u32 s20, 1
  s_cselect_b32 s10, s23, s10
  s_cmp_eq_u32 s10, 0
  s_cbranch_scc1 fa_coEnd
  v_min_u32 v11, 53, v1
  s_lshr_b32 s23, s22, 1
  s_lshl_b32 s23, s23, 8
  s_add_u32 s23, s23, 2650112
  v_lshl_add_u32 v11, v11, 2, s23
  buffer_load_dword v14, v11, s[40:43], 0 offen sc1
  v_mul_u32_u24 v16, 3277, v1
  v_lshrrev_b32 v16, 16, v16
  v_mul_u32_u24 v8, 20, v16
  v_sub_u32 v8, v1, v8
  v_lshlrev_b32 v8, 4, v8
  v_mul_u32_u24 v9, 368640, v16
  v_add_u32 v9, v9, v8
  v_cmp_gt_u32 vcc, 3, v16
  v_mov_b32 v19, 1073741824
  s_nop 0
  v_cndmask_b32 v9, v19, v9, vcc
  s_mov_b32 s12, 2
  s_mov_b32 s32, -1
  s_mov_b32 s11, 0
  s_getpc_b64 s[36:37]
  s_setpc_b64 s[38:39]
  v_cmp_eq_u32 vcc, 0, v14
  s_cbranch_vccnz fa_yf_spin
fa_yf_ok:
fa_coY:
  s_ff1_i32_b32 s33, s10
  s_bitset0_b32 s10, s33
  s_sub_u32 s23, s10, 1
  s_and_b32 s10, s10, s23
  s_mul_i32 s14, s33, 2560
  s_mul_i32 s23, s22, 320
  s_add_u32 s14, s14, s23
  s_add_u32 s14, s14, 2686976
  buffer_load_dwordx4 v[64:67], v9, s[40:43], s14 offen sc1
  s_add_u32 s14, s14, 20480
  buffer_load_dwordx4 v[68:71], v9, s[40:43], s14 offen sc1
  s_add_u32 s14, s14, 20480
  buffer_load_dwordx4 v[72:75], v9, s[40:43], s14 offen sc1
  s_add_u32 s14, s14, 20480
  buffer_load_dwordx4 v[76:79], v9, s[40:43], s14 offen sc1
  s_add_u32 s14, s14, 20480
  buffer_load_dwordx4 v[80:83], v9, s[40:43], s14 offen sc1
  s_add_u32 s14, s14, 20480
  buffer_load_dwordx4 v[84:87], v9, s[40:43], s14 offen sc1
  s_add_u32 s14, s14, 20480
  buffer_load_dwordx4 v[88:91], v9, s[40:43], s14 offen sc1
  s_add_u32 s14, s14, 20480
  buffer_load_dwordx4 v[92:95], v9, s[40:43], s14 offen sc1
  s_add_u32 s14, s14, 20480
  buffer_load_dwordx4 v[128:131], v9, s[40:43], s14 offen sc1
  s_add_u32 s14, s14, 20480
  buffer_load_dwordx4 v[132:135], v9, s[40:43], s14 offen sc1
  s_add_u32 s14, s14, 20480
  buffer_load_dwordx4 v[136:139], v9, s[40:43], s14 offen sc1
  s_add_u32 s14, s14, 20480
  buffer_load_dwordx4 v[140:143], v9, s[40:43], s14 offen sc1
  s_add_u32 s14, s14, 20480
  buffer_load_dwordx4 v[144:147], v9, s[40:43], s14 offen sc1
  s_add_u32 s14, s14, 20480
  buffer_load_dwordx4 v[148:151], v9, s[40:43], s14 offen sc1
  s_add_u32 s14, s14, 20480
  buffer_load_dwordx4 v[152:155], v9, s[40:43], s14 offen sc1
  s_add_u32 s14, s14, 20480
  buffer_load_dwordx4 v[156:159], v9, s[40:43], s14 offen sc1
  s_add_u32 s14, s14, 20480
  buffer_load_dwordx4 v[176:179], v9, s[40:43], s14 offen sc1
  s_add_u32 s14, s14, 20480
  buffer_load_dwordx4 v[180:183], v9, s[40:43], s14 offen sc1
  s_add_u32 s14, s14, 20480
  s_lshl_b32 s14, s20, 10
  s_add_u32 s14, s14, 159744
  v_add_u32 v19, s14, v2
  s_add_u32 s23, s33, 8
  v_readlane_b32 s35, v15, s23
  s_waitcnt vmcnt(0)
  v_pk_add_f32 v[64:65], v[64:65], v[68:69]
  v_pk_add_f32 v[66:67], v[66:67], v[70:71]
  v_pk_add_f32 v[64:65], v[64:65], v[72:73]
  v_pk_add_f32 v[66:67], v[66:67], v[74:75]
  v_pk_add_f32 v[64:65], v[64:65], v[76:77]
  v_pk_add_f32 v[66:67], v[66:67], v[78:79]
  v_pk_add_f32 v[64:65], v[64:65], v[80:81]
  v_pk_add_f32 v[66:67], v[66:67], v[82:83]
  v_pk_add_f32 v[64:65], v[64:65], v[84:85]
  v_pk_add_f32 v[66:67], v[66:67], v[86:87]
  v_pk_add_f32 v[64:65], v[64:65], v[88:89]
  v_pk_add_f32 v[66:67], v[66:67], v[90:91]
  v_pk_add_f32 v[64:65], v[64:65], v[92:93]
  v_pk_add_f32 v[66:67], v[66:67], v[94:95]
  v_pk_add_f32 v[64:65], v[64:65], v[128:129]
  v_pk_add_f32 v[66:67], v[66:67], v[130:131]
  v_pk_add_f32 v[64:65], v[64:65], v[132:133]
  v_pk_add_f32 v[66:67], v[66:67], v[134:135]
  v_pk_add_f32 v[64:65], v[64:65], v[136:137]
  v_pk_add_f32 v[66:67], v[66:67], v[138:139]
  v_pk_add_f32 v[64:65], v[64:65], v[140:141]
  v_pk_add_f32 v[66:67], v[66:67], v[142:143]
  v_pk_add_f32 v[64:65], v[64:65], v[144:145]
  v_pk_add_f32 v[66:67], v[66:67], v[146:147]
  v_pk_add_f32 v[64:65], v[64:65], v[148:149]
  v_pk_add_f32 v[66:67], v[66:67], v[150:151]
  v_pk_add_f32 v[64:65], v[64:65], v[152:153]
  v_pk_add_f32 v[66:67], v[66:67], v[154:155]
  v_pk_add_f32 v[64:65], v[64:65], v[156:157]
  v_pk_add_f32 v[66:67], v[66:67], v[158:159]
  v_pk_add_f32 v[64:65], v[64:65], v[176:177]
  v_pk_add_f32 v[66:67], v[66:67], v[178:179]
  v_pk_add_f32 v[64:65], v[64:65], v[180:181]
  v_pk_add_f32 v[66:67], v[66:67], v[182:183]
  ds_write_b128 v19, v[64:67]
  v_add_u32 v19, s14, v8
  s_and_b32 s35, s35, 0xffff0000
  s_waitcnt lgkmcnt(0)
  ds_read_b128 v[64:67], v19
  ds_read_b128 v[68:71], v19 offset:320
  ds_read_b128 v[72:75], v19 offset:640
  s_mul_i32 s14, s33, 320
  s_add_u32 s14, s14, 155648
  v_add_u32 v19, s14, v8
  s_waitcnt lgkmcnt(0)
  v_add_f32 v64, v64, v68
  v_add_f32 v64, v64, v72
  v_cvt_pk_bf16_f32 v64, v64, v64
  v_and_b32 v64, 0xffff0000, v64
  v_mul_f32 v64, s35, v64
  v_cvt_pk_bf16_f32 v64, v64, v64
  v_and_b32 v64, 0xffff0000, v64
  v_add_f32 v65, v65, v69
  v_add_f32 v65, v65, v73
  v_cvt_pk_bf16_f32 v65, v65, v65
  v_and_b32 v65, 0xffff0000, v65
  v_mul_f32 v65, s35, v65
  v_cvt_pk_bf16_f32 v65, v65, v65
  v_and_b32 v65, 0xffff0000, v65
  v_add_f32 v66, v66, v70
  v_add_f32 v66, v66, v74
  v_cvt_pk_bf16_f32 v66, v66, v66
  v_and_b32 v66, 0xffff0000, v66
  v_mul_f32 v66, s35, v66
  v_cvt_pk_bf16_f32 v66, v66, v66
  v_and_b32 v66, 0xffff0000, v66
  v_add_f32 v67, v67, v71
  v_add_f32 v67, v67, v75
  v_cvt_pk_bf16_f32 v67, v67, v67
  v_and_b32 v67, 0xffff0000, v67
  v_mul_f32 v67, s35, v67
  v_cvt_pk_bf16_f32 v67, v67, v67
  v_and_b32 v67, 0xffff0000, v67
  ds_write_b128 v19, v[64:67]
  s_waitcnt lgkmcnt(0)
  s_cmp_lg_u32 s10, 0
  s_cbranch_scc1 fa_coY
fa_coEnd:
  s_mov_b32 s12, 3
  s_mov_b32 s32, -1
  s_setpc_b64 s[38:39]
fa_hk7:
  s_getpc_b64 s[38:39]
fa_hp7:
  s_add_u32 s36, s36, 4
  s_addc_u32 s37, s37, 0
  s_sub_u32 s38, s38, fa_hp7-fa_hb7
  s_subb_u32 s39, s39, 0
  s_setpc_b64 s[36:37]
fa_hk8:
  s_getpc_b64 s[38:39]
fa_hp8:
  s_add_u32 s36, s36, 4
  s_addc_u32 s37, s37, 0
  s_sub_u32 s38, s38, fa_hp8-fa_hb8
  s_subb_u32 s39, s39, 0
  s_setpc_b64 s[36:37]
fa_disp:
  s_cmp_eq_u32 s29, 7
  s_cbranch_scc1 fa_SSW7
  s_cmp_eq_u32 s29, 6
  s_cbranch_scc1 fa_SSW6
  s_cmp_eq_u32 s29, 5
  s_cbranch_scc1 fa_SSW5
  s_cmp_eq_u32 s29, 4
  s_cbranch_scc1 fa_SSW4
  s_cmp_eq_u32 s29, 3
  s_cbranch_scc1 fa_SSW3
  s_cmp_eq_u32 s29, 2
  s_cbranch_scc1 fa_SSW2
  s_cmp_eq_u32 s29, 1
  s_cbranch_scc1 fa_SSW1
  s_branch fa_Bexit
fa_hk9:
  s_getpc_b64 s[38:39]
fa_hp9:
  s_add_u32 s36, s36, 4
  s_addc_u32 s37, s37, 0
  s_add_u32 s38, s38, fa_hb9-fa_hp9
  s_addc_u32 s39, s39, 0
  s_setpc_b64 s[36:37]
fa_puby:
  s_waitcnt vmcnt(0)
  buffer_store_dword v4, v30, s[40:43], 0 offen sc1
  s_cmp_lt_u32 s12, 3
  s_cbranch_scc1 fa_hk9
fa_hb9:
  s_add_u32 s14, s13, 61440
  buffer_load_dwordx4 v[64:67], v2, s[40:43], s14 offen offset:0 sc1
  buffer_load_dwordx4 v[68:71], v2, s[40:43], s14 offen offset:1024 sc1
  buffer_load_dwordx4 v[72:75], v2, s[40:43], s14 offen offset:2048 sc1
  buffer_load_dwordx4 v[76:79], v2, s[40:43], s14 offen offset:3072 sc1
  s_add_u32 s14, s13, 65536
  buffer_load_dwordx4 v[80:83], v2, s[40:43], s14 offen offset:0 sc1
  buffer_load_dwordx4 v[84:87], v2, s[40:43], s14 offen offset:1024 sc1
  buffer_load_dwordx4 v[88:91], v2, s[40:43], s14 offen offset:2048 sc1
  buffer_load_dwordx4 v[92:95], v2, s[40:43], s14 offen offset:3072 sc1
  s_branch fa_pubb
fa_left:
  s_add_u32 s14, s13, 0
  buffer_load_dwordx4 a[0:3], v2, s[40:43], s14 offen offset:0 sc1
  buffer_load_dwordx4 a[4:7], v2, s[40:43], s14 offen offset:1024 sc1
  buffer_load_dwordx4 a[8:11], v2, s[40:43], s14 offen offset:2048 sc1
  buffer_load_dwordx4 a[12:15], v2, s[40:43], s14 offen offset:3072 sc1
  s_add_u32 s14, s13, 4096
  buffer_load_dwordx4 a[16:19], v2, s[40:43], s14 offen offset:0 sc1
  buffer_load_dwordx4 a[20:23], v2, s[40:43], s14 offen offset:1024 sc1
  s_cmp_ge_u32 s29, 7
  s_cbranch_scc1 fa_leftb
  s_add_u32 s14, s13, 4096
  buffer_load_dwordx4 a[24:27], v2, s[40:43], s14 offen offset:2048 sc1
  buffer_load_dwordx4 a[28:31], v2, s[40:43], s14 offen offset:3072 sc1
  s_add_u32 s14, s13, 8192
  buffer_load_dwordx4 a[32:35], v2, s[40:43], s14 offen offset:0 sc1
  buffer_load_dwordx4 a[36:39], v2, s[40:43], s14 offen offset:1024 sc1
  buffer_load_dwordx4 a[40:43], v2, s[40:43], s14 offen offset:2048 sc1
  buffer_load_dwordx4 a[44:47], v2, s[40:43], s14 offen offset:3072 sc1
  s_cmp_ge_u32 s29, 6
  s_cbranch_scc1 fa_leftb
  s_add_u32 s14, s13, 12288
  buffer_load_dwordx4 a[48:51], v2, s[40:43], s14 offen offset:0 sc1
  buffer_load_dwordx4 a[52:55], v2, s[40:43], s14 offen offset:1024 sc1
  buffer_load_dwordx4 a[56:59], v2, s[40:43], s14 offen offset:2048 sc1
  buffer_load_dwordx4 a[60:63], v2, s[40:43], s14 offen offset:3072 sc1
  s_add_u32 s14, s13, 16384
  buffer_load_dwordx4 a[192:195], v2, s[40:43], s14 offen offset:0 sc1
  buffer_load_dwordx4 a[196:199], v2, s[40:43], s14 offen offset:1024 sc1
  s_cmp_ge_u32 s29, 5
  s_cbranch_scc1 fa_leftb
  s_add_u32 s14, s13, 16384
  buffer_load_dwordx4 a[200:203], v2, s[40:43], s14 offen offset:2048 sc1
  buffer_load_dwordx4 a[204:207], v2, s[40:43], s14 offen offset:3072 sc1
  s_add_u32 s14, s13, 20480
  buffer_load_dwordx4 a[208:211], v2, s[40:43], s14 offen offset:0 sc1
  buffer_load_dwordx4 a[212:215], v2, s[40:43], s14 offen offset:1024 sc1
  buffer_load_dwordx4 a[216:219], v2, s[40:43], s14 offen offset:2048 sc1
  buffer_load_dwordx4 a[220:223], v2, s[40:43], s14 offen offset:3072 sc1
  s_cmp_ge_u32 s29, 4
  s_cbranch_scc1 fa_leftb
  s_add_u32 s14, s13, 24576
  buffer_load_dwordx4 a[224:227], v2, s[40:43], s14 offen offset:0 sc1
  buffer_load_dwordx4 a[228:231], v2, s[40:43], s14 offen offset:1024 sc1
  buffer_load_dwordx4 a[232:235], v2, s[40:43], s14 offen offset:2048 sc1
  buffer_load_dwordx4 a[236:239], v2, s[40:43], s14 offen offset:3072 sc1
  s_add_u32 s14, s13, 28672
  buffer_load_dwordx4 a[240:243], v2, s[40:43], s14 offen offset:0 sc1
  buffer_load_dwordx4 a[244:247], v2, s[40:43], s14 offen offset:1024 sc1
  s_cmp_ge_u32 s29, 3
  s_cbranch_scc1 fa_leftb
  s_add_u32 s14, s13, 28672
  buffer_load_dwordx4 a[248:251], v2, s[40:43], s14 offen offset:2048 sc1
  buffer_load_dwordx4 a[252:255], v2, s[40:43], s14 offen offset:3072 sc1
  s_add_u32 s14, s13, 32768
  buffer_load_dwordx4 v[32:35], v2, s[40:43], s14 offen offset:0 sc1
  buffer_load_dwordx4 v[36:39], v2, s[40:43], s14 offen offset:1024 sc1
  buffer_load_dwordx4 v[40:43], v2, s[40:43], s14 offen offset:2048 sc1
  buffer_load_dwordx4 v[44:47], v2, s[40:43], s14 offen offset:3072 sc1
  s_cmp_ge_u32 s29, 2
  s_cbranch_scc1 fa_leftb
  s_add_u32 s14, s13, 36864
  buffer_load_dwordx4 v[48:51], v2, s[40:43], s14 offen offset:0 sc1
  buffer_load_dwordx4 v[52:55], v2, s[40:43], s14 offen offset:1024 sc1
  buffer_load_dwordx4 v[56:59], v2, s[40:43], s14 offen offset:2048 sc1
  buffer_load_dwordx4 v[60:63], v2, s[40:43], s14 offen offset:3072 sc1
  s_add_u32 s14, s13, 40960
  buffer_load_dwordx4 v[96:99], v2, s[40:43], s14 offen offset:0 sc1
  buffer_load_dwordx4 v[100:103], v2, s[40:43], s14 offen offset:1024 sc1
  s_cmp_ge_u32 s29, 1
  s_cbranch_scc1 fa_leftb
  s_add_u32 s14, s13, 40960
  buffer_load_dwordx4 v[104:107], v2, s[40:43], s14 offen offset:2048 sc1
  buffer_load_dwordx4 v[108:111], v2, s[40:43], s14 offen offset:3072 sc1
  s_add_u32 s14, s13, 45056
  buffer_load_dwordx4 v[112:115], v2, s[40:43], s14 offen offset:0 sc1
  buffer_load_dwordx4 v[116:119], v2, s[40:43], s14 offen offset:1024 sc1
  buffer_load_dwordx4 v[120:123], v2, s[40:43], s14 offen offset:2048 sc1
  buffer_load_dwordx4 v[124:127], v2, s[40:43], s14 offen offset:3072 sc1
  s_branch fa_leftb
fa_ctx_spin:
  s_mov_b32 s83, 200000
fa_ctx_spin2:
  buffer_load_dword v13, v12, s[40:43], 0 offen sc1
  s_waitcnt vmcnt(0)
  v_cmp_eq_u32 vcc, 0, v13
  s_cbranch_vccz fa_ctx_ok
  s_sleep 8
  s_sub_u32 s83, s83, 1
  s_cmp_lg_u32 s83, 0
  s_cbranch_scc1 fa_ctx_spin2
  s_branch fa_ctx_ok
fa_stub0:
  s_call_b64 s[76:77], fa_rare00
  s_call_b64 s[76:77], fa_rare10
  s_branch fa_back0
fa_stub1:
  s_call_b64 s[76:77], fa_rare01
  s_call_b64 s[76:77], fa_rare11
  s_branch fa_back1
fa_stub2:
  s_call_b64 s[76:77], fa_rare00
  s_call_b64 s[76:77], fa_rare10
  s_branch fa_back2
fa_stub3:
  s_call_b64 s[76:77], fa_rare01
  s_call_b64 s[76:77], fa_rare11
  s_branch fa_back3
fa_stub4:
  s_call_b64 s[76:77], fa_rare01
  s_call_b64 s[76:77], fa_rare11
  s_branch fa_back4
fa_stub5:
  s_call_b64 s[76:77], fa_rare00
  s_call_b64 s[76:77], fa_rare10
  s_branch fa_back5
fa_stub6:
  s_call_b64 s[76:77], fa_rare11
  s_branch fa_back6
fa_stub7:
  s_call_b64 s[76:77], fa_rare10
  s_branch fa_back7
fa_stub8:
  s_call_b64 s[76:77], fa_rare01
  s_call_b64 s[76:77], fa_rare11
  s_branch fa_back8
fa_stub9:
  s_call_b64 s[76:77], fa_rare10
  s_branch fa_back9
fa_stub10:
  s_call_b64 s[76:77], fa_rare11
  s_branch fa_back10
fa_stub11:
  s_call_b64 s[76:77], fa_rare10
  s_branch fa_back11
fa_stub12:
  s_call_b64 s[76:77], fa_rare11
  s_branch fa_back12
fa_stub13:
  s_call_b64 s[76:77], fa_rare10
  s_branch fa_back13
fa_stub14:
  s_call_b64 s[76:77], fa_rare11
  s_branch fa_back14
fa_stub15:
  s_call_b64 s[76:77], fa_rare10
  s_branch fa_back15
fa_stub16:
  s_call_b64 s[76:77], fa_rare11
  s_branch fa_back16
fa_stub17:
  s_call_b64 s[76:77], fa_rare10
  s_branch fa_back17
fa_stub18:
  s_call_b64 s[76:77], fa_rare11
  s_branch fa_back18
fa_stub19:
  s_call_b64 s[76:77], fa_rare10
  s_branch fa_back19
fa_stub20:
  s_call_b64 s[76:77], fa_rare11
  s_branch fa_back20
fa_stub21:
  s_call_b64 s[76:77], fa_rare10
  s_branch fa_back21
fa_stub22:
  s_call_b64 s[76:77], fa_rare11
  s_branch fa_back22
fa_stub23:
  s_call_b64 s[76:77], fa_rare10
  s_branch fa_back23
fa_stub24:
  s_call_b64 s[76:77], fa_rare11
  s_branch fa_back24
fa_stub25:
  s_call_b64 s[76:77], fa_rare10
  s_branch fa_back25
fa_stub26:
  s_call_b64 s[76:77], fa_rare11
  s_branch fa_back26
fa_stub27:
  s_call_b64 s[76:77], fa_rare10
  s_branch fa_back27
fa_stub28:
  s_call_b64 s[76:77], fa_rare11
  s_branch fa_back28
fa_stub29:
  s_call_b64 s[76:77], fa_rare10
  s_branch fa_back29
fa_stub30:
  s_call_b64 s[76:77], fa_rare11
  s_branch fa_back30
fa_codeend:
fa_rare00:
  s_nop 7
  v_max3_f32 v16, v96, v97, v98
  v_max3_f32 v16, v16, v99, v100
  v_max3_f32 v16, v16, v101, v102
  v_max3_f32 v16, v16, v103, 0
  v_mov_b32 v18, v16
  s_nop 1
  v_permlane16_swap_b32 v16, v18
  v_max_f32 v16, v16, v18
  v_mov_b32 v18, v16
  s_nop 1
  v_permlane32_swap_b32 v16, v18
  v_max_f32 v16, v16, v18
  v_sub_f32 v96, v96, v16
  v_sub_f32 v112, v112, v16
  v_sub_f32 v97, v97, v16
  v_sub_f32 v113, v113, v16
  v_sub_f32 v98, v98, v16
  v_sub_f32 v114, v114, v16
  v_sub_f32 v99, v99, v16
  v_sub_f32 v115, v115, v16
  v_sub_f32 v100, v100, v16
  v_sub_f32 v116, v116, v16
  v_sub_f32 v101, v101, v16
  v_sub_f32 v117, v117, v16
  v_sub_f32 v102, v102, v16
  v_sub_f32 v118, v118, v16
  v_sub_f32 v103, v103, v16
  v_sub_f32 v119, v119, v16
  v_max3_f32 v17, v104, v105, v106
  v_max3_f32 v17, v17, v107, v108
  v_max3_f32 v17, v17, v109, v110
  v_max3_f32 v17, v17, v111, 0
  v_mov_b32 v18, v17
  s_nop 1
  v_permlane16_swap_b32 v17, v18
  v_max_f32 v17, v17, v18
  v_mov_b32 v18, v17
  s_nop 1
  v_permlane32_swap_b32 v17, v18
  v_max_f32 v17, v17, v18
  v_sub_f32 v104, v104, v17
  v_sub_f32 v120, v120, v17
  v_sub_f32 v105, v105, v17
  v_sub_f32 v121, v121, v17
  v_sub_f32 v106, v106, v17
  v_sub_f32 v122, v122, v17
  v_sub_f32 v107, v107, v17
  v_sub_f32 v123, v123, v17
  v_sub_f32 v108, v108, v17
  v_sub_f32 v124, v124, v17
  v_sub_f32 v109, v109, v17
  v_sub_f32 v125, v125, v17
  v_sub_f32 v110, v110, v17
  v_sub_f32 v126, v126, v17
  v_sub_f32 v111, v111, v17
  v_sub_f32 v127, v127, v17
  s_call_b64 s[78:79], fa_resc0
  v_exp_f32 v208, v96
  v_exp_f32 v209, v97
  v_exp_f32 v210, v98
  v_add_f32 v224, v208, v209
  v_cvt_pk_bf16_f32 v160, v208, v209
  v_exp_f32 v211, v99
  v_add_f32 v224, v224, v210
  v_exp_f32 v212, v100
  v_add_f32 v224, v224, v211
  v_cvt_pk_bf16_f32 v161, v210, v211
  v_exp_f32 v213, v101
  v_add_f32 v224, v224, v212
  v_exp_f32 v214, v102
  v_add_f32 v224, v224, v213
  v_cvt_pk_bf16_f32 v162, v212, v213
  v_exp_f32 v215, v103
  v_add_f32 v224, v224, v214
  v_exp_f32 v208, v104
  v_add_f32 v224, v224, v215
  v_cvt_pk_bf16_f32 v163, v214, v215
  v_exp_f32 v209, v105
  v_exp_f32 v210, v106
  v_add_f32 v225, v208, v209
  v_cvt_pk_bf16_f32 v164, v208, v209
  v_exp_f32 v211, v107
  v_add_f32 v225, v225, v210
  v_exp_f32 v212, v108
  v_add_f32 v225, v225, v211
  v_cvt_pk_bf16_f32 v165, v210, v211
  v_exp_f32 v213, v109
  v_add_f32 v225, v225, v212
  v_exp_f32 v214, v110
  v_add_f32 v225, v225, v213
  v_cvt_pk_bf16_f32 v166, v212, v213
  v_exp_f32 v215, v111
  v_add_f32 v225, v225, v214
  s_nop 0
  v_add_f32 v225, v225, v215
  v_cvt_pk_bf16_f32 v167, v214, v215
  s_nop 1
  s_setpc_b64 s[76:77]
fa_rare01:
  s_nop 7
  v_max3_f32 v16, v112, v113, v114
  v_max3_f32 v16, v16, v115, v116
  v_max3_f32 v16, v16, v117, v118
  v_max3_f32 v16, v16, v119, 0
  v_mov_b32 v18, v16
  s_nop 1
  v_permlane16_swap_b32 v16, v18
  v_max_f32 v16, v16, v18
  v_mov_b32 v18, v16
  s_nop 1
  v_permlane32_swap_b32 v16, v18
  v_max_f32 v16, v16, v18
  v_sub_f32 v112, v112, v16
  v_sub_f32 v96, v96, v16
  v_sub_f32 v113, v113, v16
  v_sub_f32 v97, v97, v16
  v_sub_f32 v114, v114, v16
  v_sub_f32 v98, v98, v16
  v_sub_f32 v115, v115, v16
  v_sub_f32 v99, v99, v16
  v_sub_f32 v116, v116, v16
  v_sub_f32 v100, v100, v16
  v_sub_f32 v117, v117, v16
  v_sub_f32 v101, v101, v16
  v_sub_f32 v118, v118, v16
  v_sub_f32 v102, v102, v16
  v_sub_f32 v119, v119, v16
  v_sub_f32 v103, v103, v16
  v_max3_f32 v17, v120, v121, v122
  v_max3_f32 v17, v17, v123, v124
  v_max3_f32 v17, v17, v125, v126
  v_max3_f32 v17, v17, v127, 0
  v_mov_b32 v18, v17
  s_nop 1
  v_permlane16_swap_b32 v17, v18
  v_max_f32 v17, v17, v18
  v_mov_b32 v18, v17
  s_nop 1
  v_permlane32_swap_b32 v17, v18
  v_max_f32 v17, v17, v18
  v_sub_f32 v120, v120, v17
  v_sub_f32 v104, v104, v17
  v_sub_f32 v121, v121, v17
  v_sub_f32 v105, v105, v17
  v_sub_f32 v122, v122, v17
  v_sub_f32 v106, v106, v17
  v_sub_f32 v123, v123, v17
  v_sub_f32 v107, v107, v17
  v_sub_f32 v124, v124, v17
  v_sub_f32 v108, v108, v17
  v_sub_f32 v125, v125, v17
  v_sub_f32 v109, v109, v17
  v_sub_f32 v126, v126, v17
  v_sub_f32 v110, v110, v17
  v_sub_f32 v127, v127, v17
  v_sub_f32 v111, v111, v17
  s_call_b64 s[78:79], fa_resc0
  v_exp_f32 v208, v112
  v_exp_f32 v209, v113
  v_exp_f32 v210, v114
  v_add_f32 v224, v208, v209
  v_cvt_pk_bf16_f32 v168, v208, v209
  v_exp_f32 v211, v115
  v_add_f32 v224, v224, v210
  v_exp_f32 v212, v116
  v_add_f32 v224, v224, v211
  v_cvt_pk_bf16_f32 v169, v210, v211
  v_exp_f32 v213, v117
  v_add_f32 v224, v224, v212
  v_exp_f32 v214, v118
  v_add_f32 v224, v224, v213
  v_cvt_pk_bf16_f32 v170, v212, v213
  v_exp_f32 v215, v119
  v_add_f32 v224, v224, v214
  v_exp_f32 v208, v120
  v_add_f32 v224, v224, v215
  v_cvt_pk_bf16_f32 v171, v214, v215
  v_exp_f32 v209, v121
  v_exp_f32 v210, v122
  v_add_f32 v225, v208, v209
  v_cvt_pk_bf16_f32 v172, v208, v209
  v_exp_f32 v211, v123
  v_add_f32 v225, v225, v210
  v_exp_f32 v212, v124
  v_add_f32 v225, v225, v211
  v_cvt_pk_bf16_f32 v173, v210, v211
  v_exp_f32 v213, v125
  v_add_f32 v225, v225, v212
  v_exp_f32 v214, v126
  v_add_f32 v225, v225, v213
  v_cvt_pk_bf16_f32 v174, v212, v213
  v_exp_f32 v215, v127
  v_add_f32 v225, v225, v214
  s_nop 0
  v_add_f32 v225, v225, v215
  v_cvt_pk_bf16_f32 v175, v214, v215
  s_nop 1
  s_setpc_b64 s[76:77]
fa_resc0:
  v_sub_f32 v192, v192, v16
  v_sub_f32 v193, v193, v16
  v_sub_f32 v194, v194, v16
  v_sub_f32 v195, v195, v16
  v_exp_f32 v18, -v16
  v_sub_f32 v196, v196, v17
  v_sub_f32 v197, v197, v17
  v_sub_f32 v198, v198, v17
  v_sub_f32 v199, v199, v17
  v_exp_f32 v19, -v17
  s_nop 0
  v_mul_f32 v228, v228, v18
  v_mul_f32 v229, v229, v19
  v_accvgpr_read_b32 v20, a0
  v_accvgpr_read_b32 v21, a1
  v_accvgpr_read_b32 v22, a2
  v_accvgpr_read_b32 v23, a3
  v_mul_f32 v20, v20, v18
  v_mul_f32 v21, v21, v18
  v_mul_f32 v22, v22, v18
  v_mul_f32 v23, v23, v18
  v_accvgpr_write_b32 a0, v20
  v_accvgpr_write_b32 a1, v21
  v_accvgpr_write_b32 a2, v22
  v_accvgpr_write_b32 a3, v23
  v_accvgpr_read_b32 v20, a4
  v_accvgpr_read_b32 v21, a5
  v_accvgpr_read_b32 v22, a6
  v_accvgpr_read_b32 v23, a7
  v_mul_f32 v20, v20, v19
  v_mul_f32 v21, v21, v19
  v_mul_f32 v22, v22, v19
  v_mul_f32 v23, v23, v19
  v_accvgpr_write_b32 a4, v20
  v_accvgpr_write_b32 a5, v21
  v_accvgpr_write_b32 a6, v22
  v_accvgpr_write_b32 a7, v23
  v_accvgpr_read_b32 v20, a8
  v_accvgpr_read_b32 v21, a9
  v_accvgpr_read_b32 v22, a10
  v_accvgpr_read_b32 v23, a11
  v_mul_f32 v20, v20, v18
  v_mul_f32 v21, v21, v18
  v_mul_f32 v22, v22, v18
  v_mul_f32 v23, v23, v18
  v_accvgpr_write_b32 a8, v20
  v_accvgpr_write_b32 a9, v21
  v_accvgpr_write_b32 a10, v22
  v_accvgpr_write_b32 a11, v23
  v_accvgpr_read_b32 v20, a12
  v_accvgpr_read_b32 v21, a13
  v_accvgpr_read_b32 v22, a14
  v_accvgpr_read_b32 v23, a15
  v_mul_f32 v20, v20, v19
  v_mul_f32 v21, v21, v19
  v_mul_f32 v22, v22, v19
  v_mul_f32 v23, v23, v19
  v_accvgpr_write_b32 a12, v20
  v_accvgpr_write_b32 a13, v21
  v_accvgpr_write_b32 a14, v22
  v_accvgpr_write_b32 a15, v23
  v_accvgpr_read_b32 v20, a16
  v_accvgpr_read_b32 v21, a17
  v_accvgpr_read_b32 v22, a18
  v_accvgpr_read_b32 v23, a19
  v_mul_f32 v20, v20, v18
  v_mul_f32 v21, v21, v18
  v_mul_f32 v22, v22, v18
  v_mul_f32 v23, v23, v18
  v_accvgpr_write_b32 a16, v20
  v_accvgpr_write_b32 a17, v21
  v_accvgpr_write_b32 a18, v22
  v_accvgpr_write_b32 a19, v23
  v_accvgpr_read_b32 v20, a20
  v_accvgpr_read_b32 v21, a21
  v_accvgpr_read_b32 v22, a22
  v_accvgpr_read_b32 v23, a23
  v_mul_f32 v20, v20, v19
  v_mul_f32 v21, v21, v19
  v_mul_f32 v22, v22, v19
  v_mul_f32 v23, v23, v19
  v_accvgpr_write_b32 a20, v20
  v_accvgpr_write_b32 a21, v21
  v_accvgpr_write_b32 a22, v22
  v_accvgpr_write_b32 a23, v23
  v_accvgpr_read_b32 v20, a24
  v_accvgpr_read_b32 v21, a25
  v_accvgpr_read_b32 v22, a26
  v_accvgpr_read_b32 v23, a27
  v_mul_f32 v20, v20, v18
  v_mul_f32 v21, v21, v18
  v_mul_f32 v22, v22, v18
  v_mul_f32 v23, v23, v18
  v_accvgpr_write_b32 a24, v20
  v_accvgpr_write_b32 a25, v21
  v_accvgpr_write_b32 a26, v22
  v_accvgpr_write_b32 a27, v23
  v_accvgpr_read_b32 v20, a28
  v_accvgpr_read_b32 v21, a29
  v_accvgpr_read_b32 v22, a30
  v_accvgpr_read_b32 v23, a31
  v_mul_f32 v20, v20, v19
  v_mul_f32 v21, v21, v19
  v_mul_f32 v22, v22, v19
  v_mul_f32 v23, v23, v19
  v_accvgpr_write_b32 a28, v20
  v_accvgpr_write_b32 a29, v21
  v_accvgpr_write_b32 a30, v22
  v_accvgpr_write_b32 a31, v23
  v_accvgpr_read_b32 v20, a32
  v_accvgpr_read_b32 v21, a33
  v_accvgpr_read_b32 v22, a34
  v_accvgpr_read_b32 v23, a35
  v_mul_f32 v20, v20, v18
  v_mul_f32 v21, v21, v18
  v_mul_f32 v22, v22, v18
  v_mul_f32 v23, v23, v18
  v_accvgpr_write_b32 a32, v20
  v_accvgpr_write_b32 a33, v21
  v_accvgpr_write_b32 a34, v22
  v_accvgpr_write_b32 a35, v23
  v_accvgpr_read_b32 v20, a36
  v_accvgpr_read_b32 v21, a37
  v_accvgpr_read_b32 v22, a38
  v_accvgpr_read_b32 v23, a39
  v_mul_f32 v20, v20, v19
  v_mul_f32 v21, v21, v19
  v_mul_f32 v22, v22, v19
  v_mul_f32 v23, v23, v19
  v_accvgpr_write_b32 a36, v20
  v_accvgpr_write_b32 a37, v21
  v_accvgpr_write_b32 a38, v22
  v_accvgpr_write_b32 a39, v23
  v_accvgpr_read_b32 v20, a40
  v_accvgpr_read_b32 v21, a41
  v_accvgpr_read_b32 v22, a42
  v_accvgpr_read_b32 v23, a43
  v_mul_f32 v20, v20, v18
  v_mul_f32 v21, v21, v18
  v_mul_f32 v22, v22, v18
  v_mul_f32 v23, v23, v18
  v_accvgpr_write_b32 a40, v20
  v_accvgpr_write_b32 a41, v21
  v_accvgpr_write_b32 a42, v22
  v_accvgpr_write_b32 a43, v23
  v_accvgpr_read_b32 v20, a44
  v_accvgpr_read_b32 v21, a45
  v_accvgpr_read_b32 v22, a46
  v_accvgpr_read_b32 v23, a47
  v_mul_f32 v20, v20, v19
  v_mul_f32 v21, v21, v19
  v_mul_f32 v22, v22, v19
  v_mul_f32 v23, v23, v19
  v_accvgpr_write_b32 a44, v20
  v_accvgpr_write_b32 a45, v21
  v_accvgpr_write_b32 a46, v22
  v_accvgpr_write_b32 a47, v23
  v_accvgpr_read_b32 v20, a48
  v_accvgpr_read_b32 v21, a49
  v_accvgpr_read_b32 v22, a50
  v_accvgpr_read_b32 v23, a51
  v_mul_f32 v20, v20, v18
  v_mul_f32 v21, v21, v18
  v_mul_f32 v22, v22, v18
  v_mul_f32 v23, v23, v18
  v_accvgpr_write_b32 a48, v20
  v_accvgpr_write_b32 a49, v21
  v_accvgpr_write_b32 a50, v22
  v_accvgpr_write_b32 a51, v23
  v_accvgpr_read_b32 v20, a52
  v_accvgpr_read_b32 v21, a53
  v_accvgpr_read_b32 v22, a54
  v_accvgpr_read_b32 v23, a55
  v_mul_f32 v20, v20, v19
  v_mul_f32 v21, v21, v19
  v_mul_f32 v22, v22, v19
  v_mul_f32 v23, v23, v19
  v_accvgpr_write_b32 a52, v20
  v_accvgpr_write_b32 a53, v21
  v_accvgpr_write_b32 a54, v22
  v_accvgpr_write_b32 a55, v23
  v_accvgpr_read_b32 v20, a56
  v_accvgpr_read_b32 v21, a57
  v_accvgpr_read_b32 v22, a58
  v_accvgpr_read_b32 v23, a59
  v_mul_f32 v20, v20, v18
  v_mul_f32 v21, v21, v18
  v_mul_f32 v22, v22, v18
  v_mul_f32 v23, v23, v18
  v_accvgpr_write_b32 a56, v20
  v_accvgpr_write_b32 a57, v21
  v_accvgpr_write_b32 a58, v22
  v_accvgpr_write_b32 a59, v23
  v_accvgpr_read_b32 v20, a60
  v_accvgpr_read_b32 v21, a61
  v_accvgpr_read_b32 v22, a62
  v_accvgpr_read_b32 v23, a63
  v_mul_f32 v20, v20, v19
  v_mul_f32 v21, v21, v19
  v_mul_f32 v22, v22, v19
  v_mul_f32 v23, v23, v19
  v_accvgpr_write_b32 a60, v20
  v_accvgpr_write_b32 a61, v21
  v_accvgpr_write_b32 a62, v22
  v_accvgpr_write_b32 a63, v23
  s_setpc_b64 s[78:79]
fa_rare10:
  s_nop 7
  v_max3_f32 v16, v128, v129, v130
  v_max3_f32 v16, v16, v131, v132
  v_max3_f32 v16, v16, v133, v134
  v_max3_f32 v16, v16, v135, 0
  v_mov_b32 v18, v16
  s_nop 1
  v_permlane16_swap_b32 v16, v18
  v_max_f32 v16, v16, v18
  v_mov_b32 v18, v16
  s_nop 1
  v_permlane32_swap_b32 v16, v18
  v_max_f32 v16, v16, v18
  v_sub_f32 v128, v128, v16
  v_sub_f32 v144, v144, v16
  v_sub_f32 v129, v129, v16
  v_sub_f32 v145, v145, v16
  v_sub_f32 v130, v130, v16
  v_sub_f32 v146, v146, v16
  v_sub_f32 v131, v131, v16
  v_sub_f32 v147, v147, v16
  v_sub_f32 v132, v132, v16
  v_sub_f32 v148, v148, v16
  v_sub_f32 v133, v133, v16
  v_sub_f32 v149, v149, v16
  v_sub_f32 v134, v134, v16
  v_sub_f32 v150, v150, v16
  v_sub_f32 v135, v135, v16
  v_sub_f32 v151, v151, v16
  v_max3_f32 v17, v136, v137, v138
  v_max3_f32 v17, v17, v139, v140
  v_max3_f32 v17, v17, v141, v142
  v_max3_f32 v17, v17, v143, 0
  v_mov_b32 v18, v17
  s_nop 1
  v_permlane16_swap_b32 v17, v18
  v_max_f32 v17, v17, v18
  v_mov_b32 v18, v17
  s_nop 1
  v_permlane32_swap_b32 v17, v18
  v_max_f32 v17, v17, v18
  v_sub_f32 v136, v136, v17
  v_sub_f32 v152, v152, v17
  v_sub_f32 v137, v137, v17
  v_sub_f32 v153, v153, v17
  v_sub_f32 v138, v138, v17
  v_sub_f32 v154, v154, v17
  v_sub_f32 v139, v139, v17
  v_sub_f32 v155, v155, v17
  v_sub_f32 v140, v140, v17
  v_sub_f32 v156, v156, v17
  v_sub_f32 v141, v141, v17
  v_sub_f32 v157, v157, v17
  v_sub_f32 v142, v142, v17
  v_sub_f32 v158, v158, v17
  v_sub_f32 v143, v143, v17
  v_sub_f32 v159, v159, v17
  s_call_b64 s[78:79], fa_resc1
  v_exp_f32 v216, v128
  v_exp_f32 v217, v129
  v_exp_f32 v218, v130
  v_add_f32 v226, v216, v217
  v_cvt_pk_bf16_f32 v176, v216, v217
  v_exp_f32 v219, v131
  v_add_f32 v226, v226, v218
  v_exp_f32 v220, v132
  v_add_f32 v226, v226, v219
  v_cvt_pk_bf16_f32 v177, v218, v219
  v_exp_f32 v221, v133
  v_add_f32 v226, v226, v220
  v_exp_f32 v222, v134
  v_add_f32 v226, v226, v221
  v_cvt_pk_bf16_f32 v178, v220, v221
  v_exp_f32 v223, v135
  v_add_f32 v226, v226, v222
  v_exp_f32 v216, v136
  v_add_f32 v226, v226, v223
  v_cvt_pk_bf16_f32 v179, v222, v223
  v_exp_f32 v217, v137
  v_exp_f32 v218, v138
  v_add_f32 v227, v216, v217
  v_cvt_pk_bf16_f32 v180, v216, v217
  v_exp_f32 v219, v139
  v_add_f32 v227, v227, v218
  v_exp_f32 v220, v140
  v_add_f32 v227, v227, v219
  v_cvt_pk_bf16_f32 v181, v218, v219
  v_exp_f32 v221, v141
  v_add_f32 v227, v227, v220
  v_exp_f32 v222, v142
  v_add_f32 v227, v227, v221
  v_cvt_pk_bf16_f32 v182, v220, v221
  v_exp_f32 v223, v143
  v_add_f32 v227, v227, v222
  s_nop 0
  v_add_f32 v227, v227, v223
  v_cvt_pk_bf16_f32 v183, v222, v223
  v_exp_f32 v216, v144
  s_nop 1
  s_setpc_b64 s[76:77]
fa_rare11:
  s_nop 7
  v_max3_f32 v16, v144, v145, v146
  v_max3_f32 v16, v16, v147, v148
  v_max3_f32 v16, v16, v149, v150
  v_max3_f32 v16, v16, v151, 0
  v_mov_b32 v18, v16
  s_nop 1
  v_permlane16_swap_b32 v16, v18
  v_max_f32 v16, v16, v18
  v_mov_b32 v18, v16
  s_nop 1
  v_permlane32_swap_b32 v16, v18
  v_max_f32 v16, v16, v18
  v_sub_f32 v144, v144, v16
  v_sub_f32 v128, v128, v16
  v_sub_f32 v145, v145, v16
  v_sub_f32 v129, v129, v16
  v_sub_f32 v146, v146, v16
  v_sub_f32 v130, v130, v16
  v_sub_f32 v147, v147, v16
  v_sub_f32 v131, v131, v16
  v_sub_f32 v148, v148, v16
  v_sub_f32 v132, v132, v16
  v_sub_f32 v149, v149, v16
  v_sub_f32 v133, v133, v16
  v_sub_f32 v150, v150, v16
  v_sub_f32 v134, v134, v16
  v_sub_f32 v151, v151, v16
  v_sub_f32 v135, v135, v16
  v_max3_f32 v17, v152, v153, v154
  v_max3_f32 v17, v17, v155, v156
  v_max3_f32 v17, v17, v157, v158
  v_max3_f32 v17, v17, v159, 0
  v_mov_b32 v18, v17
  s_nop 1
  v_permlane16_swap_b32 v17, v18
  v_max_f32 v17, v17, v18
  v_mov_b32 v18, v17
  s_nop 1
  v_permlane32_swap_b32 v17, v18
  v_max_f32 v17, v17, v18
  v_sub_f32 v152, v152, v17
  v_sub_f32 v136, v136, v17
  v_sub_f32 v153, v153, v17
  v_sub_f32 v137, v137, v17
  v_sub_f32 v154, v154, v17
  v_sub_f32 v138, v138, v17
  v_sub_f32 v155, v155, v17
  v_sub_f32 v139, v139, v17
  v_sub_f32 v156, v156, v17
  v_sub_f32 v140, v140, v17
  v_sub_f32 v157, v157, v17
  v_sub_f32 v141, v141, v17
  v_sub_f32 v158, v158, v17
  v_sub_f32 v142, v142, v17
  v_sub_f32 v159, v159, v17
  v_sub_f32 v143, v143, v17
  s_call_b64 s[78:79], fa_resc1
  v_exp_f32 v216, v144
  v_exp_f32 v217, v145
  v_exp_f32 v218, v146
  v_add_f32 v226, v216, v217
  v_cvt_pk_bf16_f32 v184, v216, v217
  v_exp_f32 v219, v147
  v_add_f32 v226, v226, v218
  v_exp_f32 v220, v148
  v_add_f32 v226, v226, v219
  v_cvt_pk_bf16_f32 v185, v218, v219
  v_exp_f32 v221, v149
  v_add_f32 v226, v226, v220
  v_exp_f32 v222, v150
  v_add_f32 v226, v226, v221
  v_cvt_pk_bf16_f32 v186, v220, v221
  v_exp_f32 v223, v151
  v_add_f32 v226, v226, v222
  v_exp_f32 v216, v152
  v_add_f32 v226, v226, v223
  v_cvt_pk_bf16_f32 v187, v222, v223
  v_exp_f32 v217, v153
  v_exp_f32 v218, v154
  v_add_f32 v227, v216, v217
  v_cvt_pk_bf16_f32 v188, v216, v217
  v_exp_f32 v219, v155
  v_add_f32 v227, v227, v218
  v_exp_f32 v220, v156
  v_add_f32 v227, v227, v219
  v_cvt_pk_bf16_f32 v189, v218, v219
  v_exp_f32 v221, v157
  v_add_f32 v227, v227, v220
  v_exp_f32 v222, v158
  v_add_f32 v227, v227, v221
  v_cvt_pk_bf16_f32 v190, v220, v221
  v_exp_f32 v223, v159
  v_add_f32 v227, v227, v222
  s_nop 0
  v_add_f32 v227, v227, v223
  v_cvt_pk_bf16_f32 v191, v222, v223
  v_exp_f32 v216, v128
  s_nop 1
  s_setpc_b64 s[76:77]
fa_resc1:
  v_sub_f32 v200, v200, v16
  v_sub_f32 v201, v201, v16
  v_sub_f32 v202, v202, v16
  v_sub_f32 v203, v203, v16
  v_exp_f32 v18, -v16
  v_sub_f32 v204, v204, v17
  v_sub_f32 v205, v205, v17
  v_sub_f32 v206, v206, v17
  v_sub_f32 v207, v207, v17
  v_exp_f32 v19, -v17
  s_nop 0
  v_mul_f32 v230, v230, v18
  v_mul_f32 v231, v231, v19
  v_accvgpr_read_b32 v20, a64
  v_accvgpr_read_b32 v21, a65
  v_accvgpr_read_b32 v22, a66
  v_accvgpr_read_b32 v23, a67
  v_mul_f32 v20, v20, v18
  v_mul_f32 v21, v21, v18
  v_mul_f32 v22, v22, v18
  v_mul_f32 v23, v23, v18
  v_accvgpr_write_b32 a64, v20
  v_accvgpr_write_b32 a65, v21
  v_accvgpr_write_b32 a66, v22
  v_accvgpr_write_b32 a67, v23
  v_accvgpr_read_b32 v20, a68
  v_accvgpr_read_b32 v21, a69
  v_accvgpr_read_b32 v22, a70
  v_accvgpr_read_b32 v23, a71
  v_mul_f32 v20, v20, v19
  v_mul_f32 v21, v21, v19
  v_mul_f32 v22, v22, v19
  v_mul_f32 v23, v23, v19
  v_accvgpr_write_b32 a68, v20
  v_accvgpr_write_b32 a69, v21
  v_accvgpr_write_b32 a70, v22
  v_accvgpr_write_b32 a71, v23
  v_accvgpr_read_b32 v20, a72
  v_accvgpr_read_b32 v21, a73
  v_accvgpr_read_b32 v22, a74
  v_accvgpr_read_b32 v23, a75
  v_mul_f32 v20, v20, v18
  v_mul_f32 v21, v21, v18
  v_mul_f32 v22, v22, v18
  v_mul_f32 v23, v23, v18
  v_accvgpr_write_b32 a72, v20
  v_accvgpr_write_b32 a73, v21
  v_accvgpr_write_b32 a74, v22
  v_accvgpr_write_b32 a75, v23
  v_accvgpr_read_b32 v20, a76
  v_accvgpr_read_b32 v21, a77
  v_accvgpr_read_b32 v22, a78
  v_accvgpr_read_b32 v23, a79
  v_mul_f32 v20, v20, v19
  v_mul_f32 v21, v21, v19
  v_mul_f32 v22, v22, v19
  v_mul_f32 v23, v23, v19
  v_accvgpr_write_b32 a76, v20
  v_accvgpr_write_b32 a77, v21
  v_accvgpr_write_b32 a78, v22
  v_accvgpr_write_b32 a79, v23
  v_accvgpr_read_b32 v20, a80
  v_accvgpr_read_b32 v21, a81
  v_accvgpr_read_b32 v22, a82
  v_accvgpr_read_b32 v23, a83
  v_mul_f32 v20, v20, v18
  v_mul_f32 v21, v21, v18
  v_mul_f32 v22, v22, v18
  v_mul_f32 v23, v23, v18
  v_accvgpr_write_b32 a80, v20
  v_accvgpr_write_b32 a81, v21
  v_accvgpr_write_b32 a82, v22
  v_accvgpr_write_b32 a83, v23
  v_accvgpr_read_b32 v20, a84
  v_accvgpr_read_b32 v21, a85
  v_accvgpr_read_b32 v22, a86
  v_accvgpr_read_b32 v23, a87
  v_mul_f32 v20, v20, v19
  v_mul_f32 v21, v21, v19
  v_mul_f32 v22, v22, v19
  v_mul_f32 v23, v23, v19
  v_accvgpr_write_b32 a84, v20
  v_accvgpr_write_b32 a85, v21
  v_accvgpr_write_b32 a86, v22
  v_accvgpr_write_b32 a87, v23
  v_accvgpr_read_b32 v20, a88
  v_accvgpr_read_b32 v21, a89
  v_accvgpr_read_b32 v22, a90
  v_accvgpr_read_b32 v23, a91
  v_mul_f32 v20, v20, v18
  v_mul_f32 v21, v21, v18
  v_mul_f32 v22, v22, v18
  v_mul_f32 v23, v23, v18
  v_accvgpr_write_b32 a88, v20
  v_accvgpr_write_b32 a89, v21
  v_accvgpr_write_b32 a90, v22
  v_accvgpr_write_b32 a91, v23
  v_accvgpr_read_b32 v20, a92
  v_accvgpr_read_b32 v21, a93
  v_accvgpr_read_b32 v22, a94
  v_accvgpr_read_b32 v23, a95
  v_mul_f32 v20, v20, v19
  v_mul_f32 v21, v21, v19
  v_mul_f32 v22, v22, v19
  v_mul_f32 v23, v23, v19
  v_accvgpr_write_b32 a92, v20
  v_accvgpr_write_b32 a93, v21
  v_accvgpr_write_b32 a94, v22
  v_accvgpr_write_b32 a95, v23
  v_accvgpr_read_b32 v20, a96
  v_accvgpr_read_b32 v21, a97
  v_accvgpr_read_b32 v22, a98
  v_accvgpr_read_b32 v23, a99
  v_mul_f32 v20, v20, v18
  v_mul_f32 v21, v21, v18
  v_mul_f32 v22, v22, v18
  v_mul_f32 v23, v23, v18
  v_accvgpr_write_b32 a96, v20
  v_accvgpr_write_b32 a97, v21
  v_accvgpr_write_b32 a98, v22
  v_accvgpr_write_b32 a99, v23
  v_accvgpr_read_b32 v20, a100
  v_accvgpr_read_b32 v21, a101
  v_accvgpr_read_b32 v22, a102
  v_accvgpr_read_b32 v23, a103
  v_mul_f32 v20, v20, v19
  v_mul_f32 v21, v21, v19
  v_mul_f32 v22, v22, v19
  v_mul_f32 v23, v23, v19
  v_accvgpr_write_b32 a100, v20
  v_accvgpr_write_b32 a101, v21
  v_accvgpr_write_b32 a102, v22
  v_accvgpr_write_b32 a103, v23
  v_accvgpr_read_b32 v20, a104
  v_accvgpr_read_b32 v21, a105
  v_accvgpr_read_b32 v22, a106
  v_accvgpr_read_b32 v23, a107
  v_mul_f32 v20, v20, v18
  v_mul_f32 v21, v21, v18
  v_mul_f32 v22, v22, v18
  v_mul_f32 v23, v23, v18
  v_accvgpr_write_b32 a104, v20
  v_accvgpr_write_b32 a105, v21
  v_accvgpr_write_b32 a106, v22
  v_accvgpr_write_b32 a107, v23
  v_accvgpr_read_b32 v20, a108
  v_accvgpr_read_b32 v21, a109
  v_accvgpr_read_b32 v22, a110
  v_accvgpr_read_b32 v23, a111
  v_mul_f32 v20, v20, v19
  v_mul_f32 v21, v21, v19
  v_mul_f32 v22, v22, v19
  v_mul_f32 v23, v23, v19
  v_accvgpr_write_b32 a108, v20
  v_accvgpr_write_b32 a109, v21
  v_accvgpr_write_b32 a110, v22
  v_accvgpr_write_b32 a111, v23
  v_accvgpr_read_b32 v20, a112
  v_accvgpr_read_b32 v21, a113
  v_accvgpr_read_b32 v22, a114
  v_accvgpr_read_b32 v23, a115
  v_mul_f32 v20, v20, v18
  v_mul_f32 v21, v21, v18
  v_mul_f32 v22, v22, v18
  v_mul_f32 v23, v23, v18
  v_accvgpr_write_b32 a112, v20
  v_accvgpr_write_b32 a113, v21
  v_accvgpr_write_b32 a114, v22
  v_accvgpr_write_b32 a115, v23
  v_accvgpr_read_b32 v20, a116
  v_accvgpr_read_b32 v21, a117
  v_accvgpr_read_b32 v22, a118
  v_accvgpr_read_b32 v23, a119
  v_mul_f32 v20, v20, v19
  v_mul_f32 v21, v21, v19
  v_mul_f32 v22, v22, v19
  v_mul_f32 v23, v23, v19
  v_accvgpr_write_b32 a116, v20
  v_accvgpr_write_b32 a117, v21
  v_accvgpr_write_b32 a118, v22
  v_accvgpr_write_b32 a119, v23
  v_accvgpr_read_b32 v20, a120
  v_accvgpr_read_b32 v21, a121
  v_accvgpr_read_b32 v22, a122
  v_accvgpr_read_b32 v23, a123
  v_mul_f32 v20, v20, v18
  v_mul_f32 v21, v21, v18
  v_mul_f32 v22, v22, v18
  v_mul_f32 v23, v23, v18
  v_accvgpr_write_b32 a120, v20
  v_accvgpr_write_b32 a121, v21
  v_accvgpr_write_b32 a122, v22
  v_accvgpr_write_b32 a123, v23
  v_accvgpr_read_b32 v20, a124
  v_accvgpr_read_b32 v21, a125
  v_accvgpr_read_b32 v22, a126
  v_accvgpr_read_b32 v23, a127
  v_mul_f32 v20, v20, v19
  v_mul_f32 v21, v21, v19
  v_mul_f32 v22, v22, v19
  v_mul_f32 v23, v23, v19
  v_accvgpr_write_b32 a124, v20
  v_accvgpr_write_b32 a125, v21
  v_accvgpr_write_b32 a126, v22
  v_accvgpr_write_b32 a127, v23
  s_setpc_b64 s[78:79]
.section .rodata,"a"
.p2align 6
.amdhsa_kernel fa_kernel
  .amdhsa_next_free_vgpr 512
  .amdhsa_next_free_sgpr 102
  .amdhsa_accum_offset 256
  .amdhsa_group_segment_fixed_size 0
  .amdhsa_kernarg_size 112
  .amdhsa_user_sgpr_count 2
  .amdhsa_user_sgpr_kernarg_segment_ptr 1
  .amdhsa_system_sgpr_workgroup_id_x 1
  .amdhsa_float_denorm_mode_32 3
.end_amdhsa_kernel
.text
```

```asm
; @launch kernel=fa_kernel grid=(256,1,1) block=(256,1,1) lds=163840
.amdgcn_target "amdgcn-amd-amdhsa--gfx950"
.text
.globl fa_kernel
.p2align 8
.type fa_kernel,@function
fa_kernel:
  s_cmp_ge_u32 s2, 256
  s_cbranch_scc1 fa_end
  s_getpc_b64 s[62:63]
  v_and_b32 v230, 127, v0
  v_lshlrev_b32 v230, 7, v230
  global_load_dword v231, v230, s[62:63]
  s_load_dwordx4 s[4:7], s[0:1], 0
  s_load_dwordx4 s[8:11], s[0:1], 24
  s_load_dwordx2 s[14:15], s[0:1], 56
  s_load_dwordx2 s[12:13], s[0:1], 40
  s_load_dwordx4 s[16:19], s[0:1], 96
  s_load_dwordx2 s[60:61], s[0:1], 16
  v_lshrrev_b32 v16, 6, v0
  v_and_b32 v1, 63, v0
  v_readfirstlane_b32 s20, v16
  s_and_b32 s21, s2, 7
  s_lshl_b32 s21, s21, 2
  s_lshr_b32 s23, s2, 3
  s_and_b32 s23, s23, 3
  s_add_u32 s21, s21, s23
  s_lshr_b32 s22, s2, 5
  v_and_b32 v208, 31, v1
  v_lshrrev_b32 v209, 5, v1
  s_lshl_b32 s31, s2, 2
  s_add_u32 s31, s31, s20
  s_lshl_b32 s31, s31, 1
  v_add_u32 v209, s31, v209
  v_lshlrev_b32 v212, 4, v208
  v_mul_u32_u24 v210, 1280, v209
  v_add_u32 v210, v210, v212
  v_cmp_gt_u32 s[64:65], 16, v208
  v_mov_b32 v19, 1073741824
  v_and_b32 v220, 7, v209
  v_cndmask_b32 v211, v19, v210, s[64:65]
  v_bfe_u32 v17, v1, 1, 3
  v_lshlrev_b32 v17, 13, v17
  v_and_b32 v18, 1, v1
  v_lshl_add_u32 v235, v18, 7, v17
  s_lshl_b32 s74, s22, 1
  s_and_b32 s31, s20, 1
  s_add_u32 s74, s74, s31
  s_lshl_b32 s74, s74, 16
  s_mov_b32 s73, 1048576
  v_and_b32 v16, 15, v1
  v_lshlrev_b32 v17, 10, v16
  v_and_b32 v18, 16, v1
  v_lshl_add_u32 v233, v18, 3, v17
  s_lshl_b32 s30, s23, 5
  s_add_u32 s30, s30, s20
  s_lshl_b32 s30, s30, 14
  s_lshl_b32 s29, s22, 16
  s_lshl_b32 s23, s21, 8
  s_cmp_ge_u32 s20, 2
  s_waitcnt lgkmcnt(0)
  s_mov_b32 s44, s4
  s_mov_b32 s45, s5
  s_mov_b32 s46, 2621440
  s_mov_b32 s47, 0x20000
  s_mov_b32 s68, s14
  s_mov_b32 s69, s15
  s_mov_b32 s70, 1280
  s_mov_b32 s71, 0x20000
  buffer_load_dwordx4 v[160:163], v210, s[44:47], 0 offen
  buffer_load_dwordx4 v[164:167], v210, s[44:47], 0 offen offset:512
  buffer_load_dwordx4 v[168:171], v211, s[44:47], 0 offen offset:1024
  buffer_load_dwordx4 v[172:175], v212, s[68:71], 0 offen offset:0
  buffer_load_dwordx4 v[176:179], v212, s[68:71], 0 offen offset:512
  buffer_load_dwordx4 v[180:183], v212, s[68:71], 0 offen offset:1024
  s_cselect_b32 s62, s10, s8
  s_cselect_b32 s63, s11, s9
  s_add_u32 s62, s62, s23
  s_addc_u32 s63, s63, 0
  s_mov_b32 s36, s62
  s_mov_b32 s37, s63
  s_mov_b32 s38, 0
  s_mov_b32 s39, 0x20000
  s_sub_u32 s38, 4194304, s23
  buffer_load_dword v231, v235, s[36:39], s74 offen
  s_add_u32 s6, s6, s29
  s_addc_u32 s7, s7, 0
  s_mov_b32 s32, s6
  s_mov_b32 s33, s7
  s_mov_b32 s34, 0
  s_mov_b32 s35, 0x20000
  s_sub_u32 s34, 2097152, s29
  buffer_load_dword v232, v233, s[32:35], s30 offen
  s_add_u32 s74, s74, s73
  buffer_load_dword v231, v235, s[36:39], s74 offen
  buffer_load_dword v232, v233, s[32:35], s30 offen offset:256
  s_getpc_b64 s[8:9]
fa_pc:
  s_lshr_b32 s31, s2, 3
  s_and_b32 s31, s31, 15
  s_lshl_b32 s31, s31, 2
  s_add_u32 s31, s31, s20
  s_lshl_b32 s31, s31, 11
  s_min_u32 s31, s31, fa_codeend-fa_pc-2048
  v_lshlrev_b32 v234, 7, v16
  v_add_u32 v230, s31, v234
  global_load_dword v231, v230, s[8:9]
  s_add_u32 s8, s8, fa_co1-fa_pc-4
  s_addc_u32 s9, s9, 0
  s_add_u32 s60, s60, s23
  s_addc_u32 s61, s61, 0
  s_sub_u32 s75, 5242880, s23
  s_mov_b32 s48, s62
  s_mov_b32 s49, s63
  s_mov_b32 s50, s38
  s_mov_b32 s51, 0x20000
  v_lshlrev_b32 v2, 4, v1
  v_lshrrev_b32 v19, 2, v1
  v_lshrrev_b32 v17, 5, v1
  v_mul_u32_u24 v17, 3, v17
  v_and_b32 v18, 3, v1
  v_xor_b32 v17, v17, v18
  v_lshlrev_b32 v17, 4, v17
  v_lshl_add_u32 v3, v19, 10, v17
  s_lshl_b32 s23, s20, 19
  v_add_u32 v3, s23, v3
  v_add_u32 v4, 15360, v3
  v_add_u32 v5, 30720, v3
  v_add_u32 v6, 46080, v3
  v_and_b32 v19, 3, v19
  v_lshrrev_b32 v17, 4, v1
  v_lshlrev_b32 v17, 6, v17
  v_lshl_add_u32 v19, v19, 13, v17
  s_and_b32 s23, s20, 1
  s_lshl_b32 s23, s23, 17
  v_add_u32 v19, s23, v19
  v_lshl_add_u32 v8, v18, 4, v19
  v_xor_b32 v18, 2, v18
  v_lshl_add_u32 v10, v18, 4, v19
  v_add_u32 v9, 31744, v8
  v_add_u32 v11, 95232, v10
  v_add_u32 v10, 63488, v10
  s_lshl_b32 s24, s20, 12
  s_mov_b32 s26, 0
  s_mov_b32 s27, 0
  s_mov_b32 s25, 262144
  s_mov_b32 s79, 64
  s_mov_b32 s40, s18
  s_mov_b32 s41, s19
  s_mov_b32 s42, 67108864
  s_mov_b32 s43, 0x20000
  s_mov_b32 s52, s12
  s_mov_b32 s53, s13
  s_mov_b32 s54, 5242880
  s_mov_b32 s55, 0x20000
  s_mov_b32 s56, s16
  s_mov_b32 s57, s17
  s_mov_b32 s58, 256
  s_mov_b32 s59, 0x20000
  s_and_b32 s29, s2, 7
  s_lshl_b32 s29, s29, 2
  s_add_u32 s29, s29, s20
  s_lshl_b32 s29, s29, 11
  s_and_b32 s23, s21, 3
  s_lshl_b32 s23, s23, 19
  s_add_u32 s29, s29, s23
  s_lshl_b32 s23, s20, 5
  s_add_u32 s23, s23, s21
  s_lshl_b32 s23, s23, 2
  s_add_u32 s23, s23, 2641920
  s_lshl_b32 s31, s22, 9
  s_add_u32 s80, s23, s31
  s_sub_u32 s31, 7680, s31
  s_add_u32 s3, s23, s31
  s_lshl_b32 s23, s21, 7
  s_lshl_b32 s31, s22, 2
  s_add_u32 s23, s23, s31
  s_add_u32 s82, s23, 2637824
  s_sub_u32 s62, s2, 170
  s_lshl_b32 s31, s20, 6
  s_add_u32 s62, s62, s31
  s_lshl_b32 s62, s62, 2
  s_add_u32 s62, s62, 2650112
  s_sub_u32 s23, s2, 170
  s_cmp_lt_u32 s23, 54
  s_cselect_b32 s62, s62, 1073741824
  s_cmp_eq_u32 s20, 0
  s_cselect_b32 s31, s82, 1073741824
  s_cselect_b32 s77, s2, 1073741824
  s_cmp_eq_u32 s2, 255
  s_cselect_b32 s23, 2629632, 1073741824
  v_lshl_add_u32 v225, v16, 2, s23
  v_mov_b32 v229, 0
  v_writelane_b32 v225, s80, 0
  v_writelane_b32 v225, s3, 1
  v_writelane_b32 v225, s31, 2
  s_add_u32 s31, s31, 32
  v_writelane_b32 v225, s31, 5
  s_and_b32 s23, s2, 1
  s_lshl_b32 s23, s23, 2
  s_add_u32 s23, s23, s20
  s_lshl_b32 s23, s23, 7
  s_lshr_b32 s31, s2, 1
  s_add_u32 s23, s23, s31
  s_lshl_b32 s23, s23, 2
  s_add_u32 s23, s23, 2654208
  v_writelane_b32 v225, s23, 3
  v_writelane_b32 v225, s62, 4
  s_and_b32 s23, s21, 3
  s_lshr_b32 s31, s23, 1
  s_lshl_b32 s31, 4, s31
  s_bitcmp1_b32 s23, 0
  s_cselect_b32 s76, s31, 0
  s_cselect_b32 s72, 0, s31
  s_or_b32 s76, s76, 0x20
  s_or_b32 s72, s72, 0x25
  v_mov_b32 v20, 0
  v_mov_b32 v21, 0
  v_mov_b32 v22, 0
  v_mov_b32 v23, 0
  v_lshrrev_b32 v17, 4, v1
  v_lshrrev_b32 v18, 3, v16
  v_mul_u32_u24 v18, 3, v18
  v_xor_b32 v18, v18, v17
  v_lshlrev_b32 v18, 4, v18
  v_lshl_add_u32 v14, v16, 6, v18
  s_and_b32 s23, s20, 1
  s_lshl_b32 s23, s23, 11
  v_add_u32 v14, s23, v14
  v_mfma_f32_32x32x16_bf16 a[0:15], v[20:23], v[20:23], 0
  v_lshrrev_b32 v18, 2, v16
  v_lshlrev_b32 v18, 6, v18
  v_lshl_add_u32 v18, v17, 11, v18
  v_and_b32 v19, 1, v1
  v_mfma_f32_32x32x16_bf16 a[16:31], v[20:23], v[20:23], 0
  v_lshl_add_u32 v18, v19, 3, v18
  v_bfe_u32 v19, v1, 1, 1
  v_and_b32 v17, 1, v17
  v_lshl_or_b32 v19, v17, 1, v19
  v_mfma_f32_32x32x16_bf16 a[32:47], v[20:23], v[20:23], 0
  s_lshr_b32 s23, s20, 1
  s_lshl_b32 s23, s23, 13
  s_add_u32 s23, s23, 16384
  v_add_u32 v18, s23, v18
  v_mfma_f32_32x32x16_bf16 a[48:63], v[20:23], v[20:23], 0
  v_lshl_add_u32 v12, v19, 4, v18
  v_xor_b32 v13, 32, v12
  v_mov_b32 v19, 1073741824
  v_lshlrev_b32 v220, 4, v220
  v_mfma_f32_32x32x16_bf16 a[64:79], v[20:23], v[20:23], 0
  v_lshl_add_u32 v220, v208, 7, v220
  v_add_u32 v220, 131072, v220
  v_lshlrev_b32 v222, 2, v209
  v_cmp_eq_u32 vcc, 0, v208
  v_mfma_f32_32x32x16_bf16 a[80:95], v[20:23], v[20:23], 0
  v_add_u32 v222, 2621440, v222
  v_lshlrev_b32 v221, 4, v0
  v_cndmask_b32 v222, v19, v222, vcc
  v_add_u32 v221, 131072, v221
  v_mfma_f32_32x32x16_bf16 a[96:111], v[20:23], v[20:23], 0
  v_sub_u32 v209, 0xffff, v209
  v_lshrrev_b32 v223, 3, v0
  v_and_b32 v18, 7, v0
  v_lshlrev_b32 v18, 4, v18
  v_mfma_f32_32x32x16_bf16 a[112:127], v[20:23], v[20:23], 0
  v_cmp_gt_u32 vcc, 128, v0
  v_lshl_add_u32 v223, v223, 8, v18
  s_lshr_b32 s66, s2, 1
  s_mul_i32 s66, s66, 20480
  v_mfma_f32_32x32x16_bf16 a[128:143], v[20:23], v[20:23], 0
  s_and_b32 s31, s2, 1
  s_lshl_b32 s31, s31, 7
  s_add_u32 s66, s66, s31
  v_cndmask_b32 v224, v19, v223, vcc
  v_mfma_f32_32x32x16_bf16 a[144:159], v[20:23], v[20:23], 0
  s_add_u32 s67, s66, 8192
  s_add_u32 s78, s66, 16384
  s_mov_b32 s28, 0
  v_mfma_f32_32x32x16_bf16 a[160:175], v[20:23], v[20:23], 0
  v_mfma_f32_32x32x16_bf16 a[176:191], v[20:23], v[20:23], 0
  v_mfma_f32_32x32x16_bf16 a[192:207], v[20:23], v[20:23], 0
  v_mfma_f32_32x32x16_bf16 a[208:223], v[20:23], v[20:23], 0
  v_mfma_f32_32x32x16_bf16 a[224:239], v[20:23], v[20:23], 0
  v_mfma_f32_32x32x16_bf16 a[240:255], v[20:23], v[20:23], 0
  s_waitcnt vmcnt(5)
  v_lshlrev_b32 v184, 16, v160
  v_and_b32 v185, 0xffff0000, v160
  v_lshlrev_b32 v186, 16, v161
  v_and_b32 v187, 0xffff0000, v161
  v_lshlrev_b32 v188, 16, v162
  v_and_b32 v189, 0xffff0000, v162
  v_lshlrev_b32 v190, 16, v163
  v_and_b32 v191, 0xffff0000, v163
  v_lshlrev_b32 v192, 16, v164
  v_and_b32 v193, 0xffff0000, v164
  v_lshlrev_b32 v194, 16, v165
  v_and_b32 v195, 0xffff0000, v165
  v_lshlrev_b32 v196, 16, v166
  v_and_b32 v197, 0xffff0000, v166
  v_lshlrev_b32 v198, 16, v167
  v_and_b32 v199, 0xffff0000, v167
  v_lshlrev_b32 v200, 16, v168
  v_and_b32 v201, 0xffff0000, v168
  v_lshlrev_b32 v202, 16, v169
  v_and_b32 v203, 0xffff0000, v169
  v_lshlrev_b32 v204, 16, v170
  v_and_b32 v205, 0xffff0000, v170
  v_lshlrev_b32 v206, 16, v171
  v_and_b32 v207, 0xffff0000, v171
  v_pk_add_f32 v[16:17], v[184:185], v[186:187]
  v_pk_add_f32 v[18:19], v[188:189], v[190:191]
  v_pk_add_f32 v[16:17], v[16:17], v[192:193]
  v_pk_add_f32 v[18:19], v[18:19], v[194:195]
  v_pk_add_f32 v[16:17], v[16:17], v[196:197]
  v_pk_add_f32 v[18:19], v[18:19], v[198:199]
  v_pk_add_f32 v[16:17], v[16:17], v[200:201]
  v_pk_add_f32 v[18:19], v[18:19], v[202:203]
  v_pk_add_f32 v[16:17], v[16:17], v[204:205]
  v_pk_add_f32 v[18:19], v[18:19], v[206:207]
  v_pk_add_f32 v[16:17], v[16:17], v[18:19]
  v_add_f32 v213, v16, v17
  s_nop 1
  v_add_f32_dpp v213, v213, v213 quad_perm:[1,0,3,2] row_mask:0xf bank_mask:0xf
  s_nop 1
  v_add_f32_dpp v213, v213, v213 quad_perm:[2,3,0,1] row_mask:0xf bank_mask:0xf
  s_nop 1
  v_add_f32_dpp v213, v213, v213 row_half_mirror row_mask:0xf bank_mask:0xf
  s_nop 1
  v_add_f32_dpp v213, v213, v213 row_mirror row_mask:0xf bank_mask:0xf
  v_mov_b32 v214, v213
  s_nop 1
  v_permlane16_swap_b32 v213, v214
  v_add_f32 v213, v213, v214
  v_mul_f32 v216, 0xbacccccd, v213
  v_mul_f32 v217, 0xbacccccd, v213
  v_pk_add_f32 v[20:21], v[184:185], v[216:217]
  v_pk_mul_f32 v[16:17], v[20:21], v[20:21]
  v_pk_add_f32 v[22:23], v[186:187], v[216:217]
  v_pk_fma_f32 v[16:17], v[22:23], v[22:23], v[16:17]
  v_pk_add_f32 v[24:25], v[188:189], v[216:217]
  v_pk_fma_f32 v[16:17], v[24:25], v[24:25], v[16:17]
  v_pk_add_f32 v[26:27], v[190:191], v[216:217]
  v_pk_fma_f32 v[16:17], v[26:27], v[26:27], v[16:17]
  v_pk_add_f32 v[20:21], v[192:193], v[216:217]
  v_pk_fma_f32 v[16:17], v[20:21], v[20:21], v[16:17]
  v_pk_add_f32 v[22:23], v[194:195], v[216:217]
  v_pk_fma_f32 v[16:17], v[22:23], v[22:23], v[16:17]
  v_pk_add_f32 v[24:25], v[196:197], v[216:217]
  v_pk_fma_f32 v[16:17], v[24:25], v[24:25], v[16:17]
  v_pk_add_f32 v[26:27], v[198:199], v[216:217]
  v_pk_fma_f32 v[16:17], v[26:27], v[26:27], v[16:17]
  v_pk_add_f32 v[20:21], v[200:201], v[216:217]
  v_pk_mul_f32 v[18:19], v[20:21], v[20:21]
  v_pk_add_f32 v[22:23], v[202:203], v[216:217]
  v_pk_fma_f32 v[18:19], v[22:23], v[22:23], v[18:19]
  v_pk_add_f32 v[24:25], v[204:205], v[216:217]
  v_pk_fma_f32 v[18:19], v[24:25], v[24:25], v[18:19]
  v_pk_add_f32 v[26:27], v[206:207], v[216:217]
  v_pk_fma_f32 v[18:19], v[26:27], v[26:27], v[18:19]
  v_add_f32 v18, v18, v19
  v_add_f32 v213, v16, v17
  v_cndmask_b32 v18, 0, v18, s[64:65]
  v_add_f32 v213, v213, v18
  s_nop 1
  v_add_f32_dpp v213, v213, v213 quad_perm:[1,0,3,2] row_mask:0xf bank_mask:0xf
  s_nop 1
  v_add_f32_dpp v213, v213, v213 quad_perm:[2,3,0,1] row_mask:0xf bank_mask:0xf
  s_nop 1
  v_add_f32_dpp v213, v213, v213 row_half_mirror row_mask:0xf bank_mask:0xf
  s_nop 1
  v_add_f32_dpp v213, v213, v213 row_mirror row_mask:0xf bank_mask:0xf
  v_mov_b32 v214, v213
  s_nop 1
  v_permlane16_swap_b32 v213, v214
  v_add_f32 v213, v213, v214
  v_mul_f32 v213, 0x3acccccd, v213
  v_cvt_pk_bf16_f32 v213, v213, v213
  v_and_b32 v213, 0xffff0000, v213
  v_add_f32 v213, 0x3727c5ac, v213
  v_cvt_pk_bf16_f32 v213, v213, v213
  v_and_b32 v213, 0xffff0000, v213
  v_sqrt_f32 v213, v213
  v_cvt_pk_bf16_f32 v216, v216, v216
  v_and_b32 v216, 0xffff0000, v216
  v_cvt_pk_bf16_f32 v213, v213, v213
  v_and_b32 v213, 0xffff0000, v213
  v_rcp_f32 v28, v213
  v_mov_b32 v217, v216
  v_mov_b32 v29, v28
  v_pk_add_f32 v[184:185], v[184:185], v[216:217]
  v_lshlrev_b32 v16, 16, v172
  v_cvt_pk_bf16_f32 v185, v184, v185
  v_and_b32 v17, 0xffff0000, v172
  v_lshlrev_b32 v184, 16, v185
  v_and_b32 v185, 0xffff0000, v185
  v_pk_mul_f32 v[184:185], v[184:185], v[28:29]
  v_cvt_pk_bf16_f32 v160, v184, v185
  v_lshlrev_b32 v184, 16, v160
  v_and_b32 v185, 0xffff0000, v160
  v_pk_mul_f32 v[218:219], v[184:185], v[16:17]
  v_pk_add_f32 v[186:187], v[186:187], v[216:217]
  v_lshlrev_b32 v18, 16, v173
  v_cvt_pk_bf16_f32 v187, v186, v187
  v_and_b32 v19, 0xffff0000, v173
  v_lshlrev_b32 v186, 16, v187
  v_and_b32 v187, 0xffff0000, v187
  v_pk_mul_f32 v[186:187], v[186:187], v[28:29]
  v_cvt_pk_bf16_f32 v161, v186, v187
  v_lshlrev_b32 v186, 16, v161
  v_and_b32 v187, 0xffff0000, v161
  v_pk_fma_f32 v[218:219], v[186:187], v[18:19], v[218:219]
  v_pk_add_f32 v[188:189], v[188:189], v[216:217]
  v_lshlrev_b32 v16, 16, v174
  v_cvt_pk_bf16_f32 v189, v188, v189
  v_and_b32 v17, 0xffff0000, v174
  v_lshlrev_b32 v188, 16, v189
  v_and_b32 v189, 0xffff0000, v189
  v_pk_mul_f32 v[188:189], v[188:189], v[28:29]
  v_cvt_pk_bf16_f32 v162, v188, v189
  v_lshlrev_b32 v188, 16, v162
  v_and_b32 v189, 0xffff0000, v162
  v_pk_fma_f32 v[218:219], v[188:189], v[16:17], v[218:219]
  v_pk_add_f32 v[190:191], v[190:191], v[216:217]
  v_lshlrev_b32 v18, 16, v175
  v_cvt_pk_bf16_f32 v191, v190, v191
  v_and_b32 v19, 0xffff0000, v175
  v_lshlrev_b32 v190, 16, v191
  v_and_b32 v191, 0xffff0000, v191
  v_pk_mul_f32 v[190:191], v[190:191], v[28:29]
  v_cvt_pk_bf16_f32 v163, v190, v191
  v_lshlrev_b32 v190, 16, v163
  v_and_b32 v191, 0xffff0000, v163
  v_pk_fma_f32 v[218:219], v[190:191], v[18:19], v[218:219]
  ds_write_b128 v220, v[160:163] offset:0
  v_pk_add_f32 v[192:193], v[192:193], v[216:217]
  v_lshlrev_b32 v16, 16, v176
  v_cvt_pk_bf16_f32 v193, v192, v193
  v_and_b32 v17, 0xffff0000, v176
  v_lshlrev_b32 v192, 16, v193
  v_and_b32 v193, 0xffff0000, v193
  v_pk_mul_f32 v[192:193], v[192:193], v[28:29]
  v_cvt_pk_bf16_f32 v164, v192, v193
  v_lshlrev_b32 v192, 16, v164
  v_and_b32 v193, 0xffff0000, v164
  v_pk_fma_f32 v[218:219], v[192:193], v[16:17], v[218:219]
  v_pk_add_f32 v[194:195], v[194:195], v[216:217]
  v_lshlrev_b32 v18, 16, v177
  v_cvt_pk_bf16_f32 v195, v194, v195
  v_and_b32 v19, 0xffff0000, v177
  v_lshlrev_b32 v194, 16, v195
  v_and_b32 v195, 0xffff0000, v195
  v_pk_mul_f32 v[194:195], v[194:195], v[28:29]
  v_cvt_pk_bf16_f32 v165, v194, v195
  v_lshlrev_b32 v194, 16, v165
  v_and_b32 v195, 0xffff0000, v165
  v_pk_fma_f32 v[218:219], v[194:195], v[18:19], v[218:219]
  v_pk_add_f32 v[196:197], v[196:197], v[216:217]
  v_lshlrev_b32 v16, 16, v178
  v_cvt_pk_bf16_f32 v197, v196, v197
  v_and_b32 v17, 0xffff0000, v178
  v_lshlrev_b32 v196, 16, v197
  v_and_b32 v197, 0xffff0000, v197
  v_pk_mul_f32 v[196:197], v[196:197], v[28:29]
  v_cvt_pk_bf16_f32 v166, v196, v197
  v_lshlrev_b32 v196, 16, v166
  v_and_b32 v197, 0xffff0000, v166
  v_pk_fma_f32 v[218:219], v[196:197], v[16:17], v[218:219]
  v_pk_add_f32 v[198:199], v[198:199], v[216:217]
  v_lshlrev_b32 v18, 16, v179
  v_cvt_pk_bf16_f32 v199, v198, v199
  v_and_b32 v19, 0xffff0000, v179
  v_lshlrev_b32 v198, 16, v199
  v_and_b32 v199, 0xffff0000, v199
  v_pk_mul_f32 v[198:199], v[198:199], v[28:29]
  v_cvt_pk_bf16_f32 v167, v198, v199
  v_lshlrev_b32 v198, 16, v167
  v_and_b32 v199, 0xffff0000, v167
  v_pk_fma_f32 v[218:219], v[198:199], v[18:19], v[218:219]
  ds_write_b128 v220, v[164:167] offset:4096
  v_pk_add_f32 v[200:201], v[200:201], v[216:217]
  v_lshlrev_b32 v16, 16, v180
  v_cvt_pk_bf16_f32 v201, v200, v201
  v_and_b32 v17, 0xffff0000, v180
  v_lshlrev_b32 v200, 16, v201
  v_and_b32 v201, 0xffff0000, v201
  v_pk_mul_f32 v[200:201], v[200:201], v[28:29]
  v_cvt_pk_bf16_f32 v168, v200, v201
  v_lshlrev_b32 v200, 16, v168
  v_and_b32 v201, 0xffff0000, v168
  v_pk_fma_f32 v[218:219], v[200:201], v[16:17], v[218:219]
  v_pk_add_f32 v[202:203], v[202:203], v[216:217]
  v_lshlrev_b32 v18, 16, v181
  v_cvt_pk_bf16_f32 v203, v202, v203
  v_and_b32 v19, 0xffff0000, v181
  v_lshlrev_b32 v202, 16, v203
  v_and_b32 v203, 0xffff0000, v203
  v_pk_mul_f32 v[202:203], v[202:203], v[28:29]
  v_cvt_pk_bf16_f32 v169, v202, v203
  v_lshlrev_b32 v202, 16, v169
  v_and_b32 v203, 0xffff0000, v169
  v_pk_fma_f32 v[218:219], v[202:203], v[18:19], v[218:219]
  v_pk_add_f32 v[204:205], v[204:205], v[216:217]
  v_lshlrev_b32 v16, 16, v182
  v_cvt_pk_bf16_f32 v205, v204, v205
  v_and_b32 v17, 0xffff0000, v182
  v_lshlrev_b32 v204, 16, v205
  v_and_b32 v205, 0xffff0000, v205
  v_pk_mul_f32 v[204:205], v[204:205], v[28:29]
  v_cvt_pk_bf16_f32 v170, v204, v205
  v_lshlrev_b32 v204, 16, v170
  v_and_b32 v205, 0xffff0000, v170
  v_pk_fma_f32 v[218:219], v[204:205], v[16:17], v[218:219]
  v_pk_add_f32 v[206:207], v[206:207], v[216:217]
  v_lshlrev_b32 v18, 16, v183
  v_cvt_pk_bf16_f32 v207, v206, v207
  v_and_b32 v19, 0xffff0000, v183
  v_lshlrev_b32 v206, 16, v207
  v_and_b32 v207, 0xffff0000, v207
  v_pk_mul_f32 v[206:207], v[206:207], v[28:29]
  v_cvt_pk_bf16_f32 v171, v206, v207
  v_lshlrev_b32 v206, 16, v171
  v_and_b32 v207, 0xffff0000, v171
  v_pk_fma_f32 v[218:219], v[206:207], v[18:19], v[218:219]
  ds_write_b128 v220, v[168:171] offset:8192
  v_add_f32 v218, v218, v219
  s_nop 1
  v_add_f32_dpp v218, v218, v218 quad_perm:[1,0,3,2] row_mask:0xf bank_mask:0xf
  s_nop 1
  v_add_f32_dpp v218, v218, v218 quad_perm:[2,3,0,1] row_mask:0xf bank_mask:0xf
  s_nop 1
  v_add_f32_dpp v218, v218, v218 row_half_mirror row_mask:0xf bank_mask:0xf
  s_nop 1
  v_add_f32_dpp v218, v218, v218 row_mirror row_mask:0xf bank_mask:0xf
  v_mov_b32 v214, v218
  s_nop 1
  v_permlane16_swap_b32 v218, v214
  v_add_f32 v218, v218, v214
  v_cvt_pk_bf16_f32 v218, v218, v218
  v_and_b32 v218, 0xffff0000, v218
  v_ashrrev_i32 v214, 31, v218
  v_or_b32 v214, 0x80000000, v214
  v_xor_b32 v218, v218, v214
  v_and_b32 v218, 0xffff0000, v218
  v_or_b32 v218, v218, v209
  v_mov_b32 v19, 1073741824
  s_mov_b32 m0, s24
  s_nop 0
  buffer_load_dwordx4 v3, s[32:35], s26 offen offset:0 sc1 lds
  buffer_load_dwordx4 v4, s[32:35], s26 offen offset:1024 sc1 lds
  buffer_load_dwordx4 v5, s[32:35], s26 offen offset:2048 sc1 lds
  buffer_load_dwordx4 v6, s[32:35], s26 offen offset:3072 sc1 lds
  s_add_u32 m0, s24, 16384
  s_nop 0
  buffer_load_dwordx4 v8, s[36:39], s27 offen offset:0 lds
  buffer_load_dwordx4 v9, s[36:39], s27 offen offset:1024 lds
  buffer_load_dwordx4 v10, s[36:39], s27 offen offset:2048 lds
  buffer_load_dwordx4 v11, s[36:39], s27 offen offset:3072 lds
  s_add_u32 s26, s26, s79
  s_add_u32 s27, s27, s25
  s_add_u32 s24, s24, 32768
  s_and_b32 s24, s24, 0x1ffff
  s_mov_b32 m0, s24
  s_nop 0
  buffer_load_dwordx4 v3, s[32:35], s26 offen offset:0 sc1 lds
  buffer_load_dwordx4 v4, s[32:35], s26 offen offset:1024 sc1 lds
  buffer_load_dwordx4 v5, s[32:35], s26 offen offset:2048 sc1 lds
  buffer_load_dwordx4 v6, s[32:35], s26 offen offset:3072 sc1 lds
  s_add_u32 m0, s24, 16384
  s_nop 0
  buffer_load_dwordx4 v8, s[36:39], s27 offen offset:0 lds
  buffer_load_dwordx4 v9, s[36:39], s27 offen offset:1024 lds
  buffer_load_dwordx4 v10, s[36:39], s27 offen offset:2048 lds
  buffer_load_dwordx4 v11, s[36:39], s27 offen offset:3072 lds
  s_add_u32 s26, s26, s79
  s_add_u32 s27, s27, s25
  s_add_u32 s24, s24, 32768
  s_and_b32 s24, s24, 0x1ffff
  s_mov_b32 m0, s24
  s_nop 0
  buffer_load_dwordx4 v3, s[32:35], s26 offen offset:0 sc1 lds
  buffer_load_dwordx4 v4, s[32:35], s26 offen offset:1024 sc1 lds
  buffer_load_dwordx4 v5, s[32:35], s26 offen offset:2048 sc1 lds
  buffer_load_dwordx4 v6, s[32:35], s26 offen offset:3072 sc1 lds
  s_add_u32 m0, s24, 16384
  s_nop 0
  buffer_load_dwordx4 v8, s[36:39], s27 offen offset:0 lds
  buffer_load_dwordx4 v9, s[36:39], s27 offen offset:1024 lds
  buffer_load_dwordx4 v10, s[36:39], s27 offen offset:2048 lds
  buffer_load_dwordx4 v11, s[36:39], s27 offen offset:3072 lds
  s_add_u32 s26, s26, s79
  s_add_u32 s27, s27, s25
  s_add_u32 s24, s24, 32768
  s_and_b32 s24, s24, 0x1ffff
  buffer_load_dword v231, v19, s[32:35], 0 offen
  s_mov_b32 m0, s24
  s_nop 0
  buffer_load_dwordx4 v3, s[32:35], s26 offen offset:0 sc1 lds
  buffer_load_dwordx4 v4, s[32:35], s26 offen offset:1024 sc1 lds
  buffer_load_dwordx4 v5, s[32:35], s26 offen offset:2048 sc1 lds
  buffer_load_dwordx4 v6, s[32:35], s26 offen offset:3072 sc1 lds
  s_add_u32 m0, s24, 16384
  s_nop 0
  buffer_load_dwordx4 v8, s[36:39], s27 offen offset:0 lds
  buffer_load_dwordx4 v9, s[36:39], s27 offen offset:1024 lds
  buffer_load_dwordx4 v10, s[36:39], s27 offen offset:2048 lds
  buffer_load_dwordx4 v11, s[36:39], s27 offen offset:3072 lds
  s_add_u32 s26, s26, s79
  s_add_u32 s27, s27, s25
  s_add_u32 s24, s24, 32768
  s_and_b32 s24, s24, 0x1ffff
  s_waitcnt vmcnt(25) lgkmcnt(0)
  s_barrier
  s_cmp_ge_u32 s20, 2
  s_cbranch_scc1 fa_roleV
  ds_read_b128 v[96:99], v14 offset:0
  ds_read_b128 v[100:103], v14 offset:1024
  ds_read_b128 v[104:107], v14 offset:4096
  ds_read_b128 v[108:111], v14 offset:5120
  ds_read_b128 v[112:115], v14 offset:8192
  ds_read_b128 v[116:119], v14 offset:9216
  ds_read_b128 v[120:123], v14 offset:12288
  ds_read_b128 v[124:127], v14 offset:13312
  ds_read_b64_tr_b16 v[32:33], v12 offset:0
  ds_read_b64_tr_b16 v[34:35], v12 offset:1024
  ds_read_b64_tr_b16 v[36:37], v13 offset:0
  ds_read_b64_tr_b16 v[38:39], v13 offset:1024
  ds_read_b64_tr_b16 v[40:41], v12 offset:256
  ds_read_b64_tr_b16 v[42:43], v12 offset:1280
  ds_read_b64_tr_b16 v[44:45], v13 offset:256
  ds_read_b64_tr_b16 v[46:47], v13 offset:1280
  ds_read_b64_tr_b16 v[48:49], v12 offset:512
  ds_read_b64_tr_b16 v[50:51], v12 offset:1536
  ds_read_b64_tr_b16 v[52:53], v13 offset:512
  ds_read_b64_tr_b16 v[54:55], v13 offset:1536
  ds_read_b64_tr_b16 v[56:57], v12 offset:768
  ds_read_b64_tr_b16 v[58:59], v12 offset:1792
  ds_read_b64_tr_b16 v[60:61], v13 offset:768
  ds_read_b64_tr_b16 v[62:63], v13 offset:1792
  s_waitcnt lgkmcnt(0)
.p2align 6
fa_loopK:
  v_mfma_f32_16x16x32_bf16 a[192:195], v[32:35], v[96:99], a[192:195]
  s_waitcnt vmcnt(17)
  v_mfma_f32_16x16x32_bf16 a[200:203], v[32:35], v[100:103], a[200:203]
  s_barrier
  v_mfma_f32_16x16x32_bf16 a[0:3], v[32:35], v[104:107], a[0:3]
  ds_read_b64_tr_b16 v[64:65], v12 offset:32768
  v_mfma_f32_16x16x32_bf16 a[8:11], v[32:35], v[108:111], a[8:11]
  v_mfma_f32_16x16x32_bf16 a[64:67], v[32:35], v[112:115], a[64:67]
  s_mov_b32 m0, s24
  ds_read_b64_tr_b16 v[66:67], v12 offset:33792
  v_mfma_f32_16x16x32_bf16 a[72:75], v[32:35], v[116:119], a[72:75]
  buffer_load_dwordx4 v3, s[32:35], s26 offen offset:0 sc1 lds
  v_mfma_f32_16x16x32_bf16 a[128:131], v[32:35], v[120:123], a[128:131]
  ds_read_b128 v[128:131], v14 offset:32768
  v_mfma_f32_16x16x32_bf16 a[136:139], v[32:35], v[124:127], a[136:139]
  buffer_load_dwordx4 v4, s[32:35], s26 offen offset:1024 sc1 lds
  v_mfma_f32_16x16x32_bf16 a[196:199], v[36:39], v[96:99], a[196:199]
  ds_read_b64_tr_b16 v[68:69], v13 offset:32768
  v_mfma_f32_16x16x32_bf16 a[204:207], v[36:39], v[100:103], a[204:207]
  buffer_load_dwordx4 v5, s[32:35], s26 offen offset:2048 sc1 lds
  v_mfma_f32_16x16x32_bf16 a[4:7], v[36:39], v[104:107], a[4:7]
  ds_read_b64_tr_b16 v[70:71], v13 offset:33792
  v_mfma_f32_16x16x32_bf16 a[12:15], v[36:39], v[108:111], a[12:15]
  buffer_load_dwordx4 v6, s[32:35], s26 offen offset:3072 sc1 lds
  v_mfma_f32_16x16x32_bf16 a[68:71], v[36:39], v[112:115], a[68:71]
  s_add_u32 m0, s24, 16384
  ds_read_b128 v[132:135], v14 offset:33792
  v_mfma_f32_16x16x32_bf16 a[76:79], v[36:39], v[116:119], a[76:79]
  buffer_load_dwordx4 v8, s[36:39], s27 offen offset:0 lds
  v_mfma_f32_16x16x32_bf16 a[132:135], v[36:39], v[120:123], a[132:135]
  ds_read_b64_tr_b16 v[72:73], v12 offset:33024
  v_mfma_f32_16x16x32_bf16 a[140:143], v[36:39], v[124:127], a[140:143]
  buffer_load_dwordx4 v9, s[36:39], s27 offen offset:1024 lds
  v_mfma_f32_16x16x32_bf16 a[208:211], v[40:43], v[96:99], a[208:211]
  ds_read_b64_tr_b16 v[74:75], v12 offset:34048
  v_mfma_f32_16x16x32_bf16 a[216:219], v[40:43], v[100:103], a[216:219]
  buffer_load_dwordx4 v10, s[36:39], s27 offen offset:2048 lds
  v_mfma_f32_16x16x32_bf16 a[16:19], v[40:43], v[104:107], a[16:19]
  ds_read_b128 v[136:139], v14 offset:36864
  v_mfma_f32_16x16x32_bf16 a[24:27], v[40:43], v[108:111], a[24:27]
  buffer_load_dwordx4 v11, s[36:39], s27 offen offset:3072 lds
  v_mfma_f32_16x16x32_bf16 a[80:83], v[40:43], v[112:115], a[80:83]
  ds_read_b64_tr_b16 v[76:77], v13 offset:33024
  v_mfma_f32_16x16x32_bf16 a[88:91], v[40:43], v[116:119], a[88:91]
  buffer_load_dword v231, v235, s[48:51], s74 offen sc1
  v_mfma_f32_16x16x32_bf16 a[144:147], v[40:43], v[120:123], a[144:147]
  s_add_u32 s74, s74, s73
  ds_read_b64_tr_b16 v[78:79], v13 offset:34048
  v_mfma_f32_16x16x32_bf16 a[152:155], v[40:43], v[124:127], a[152:155]
  s_bitcmp1_b32 s72, s28
  v_mfma_f32_16x16x32_bf16 a[212:215], v[44:47], v[96:99], a[212:215]
  s_cbranch_scc1 fa_hk0
fa_hb0:
  ds_read_b128 v[140:143], v14 offset:37888
  v_mfma_f32_16x16x32_bf16 a[220:223], v[44:47], v[100:103], a[220:223]
  v_mfma_f32_16x16x32_bf16 a[20:23], v[44:47], v[104:107], a[20:23]
  ds_read_b64_tr_b16 v[80:81], v12 offset:33280
  v_mfma_f32_16x16x32_bf16 a[28:31], v[44:47], v[108:111], a[28:31]
  v_mfma_f32_16x16x32_bf16 a[84:87], v[44:47], v[112:115], a[84:87]
  ds_read_b64_tr_b16 v[82:83], v12 offset:34304
  v_mfma_f32_16x16x32_bf16 a[92:95], v[44:47], v[116:119], a[92:95]
  v_mfma_f32_16x16x32_bf16 a[148:151], v[44:47], v[120:123], a[148:151]
  ds_read_b128 v[144:147], v14 offset:40960
  v_mfma_f32_16x16x32_bf16 a[156:159], v[44:47], v[124:127], a[156:159]
  v_mfma_f32_16x16x32_bf16 a[224:227], v[48:51], v[96:99], a[224:227]
  ds_read_b64_tr_b16 v[84:85], v13 offset:33280
  v_mfma_f32_16x16x32_bf16 a[232:235], v[48:51], v[100:103], a[232:235]
  v_mfma_f32_16x16x32_bf16 a[32:35], v[48:51], v[104:107], a[32:35]
  ds_read_b64_tr_b16 v[86:87], v13 offset:34304
  v_mfma_f32_16x16x32_bf16 a[40:43], v[48:51], v[108:111], a[40:43]
  v_mfma_f32_16x16x32_bf16 a[96:99], v[48:51], v[112:115], a[96:99]
  ds_read_b128 v[148:151], v14 offset:41984
  v_mfma_f32_16x16x32_bf16 a[104:107], v[48:51], v[116:119], a[104:107]
  v_mfma_f32_16x16x32_bf16 a[160:163], v[48:51], v[120:123], a[160:163]
  ds_read_b64_tr_b16 v[88:89], v12 offset:33536
  v_mfma_f32_16x16x32_bf16 a[168:171], v[48:51], v[124:127], a[168:171]
  v_mfma_f32_16x16x32_bf16 a[228:231], v[52:55], v[96:99], a[228:231]
  ds_read_b64_tr_b16 v[90:91], v12 offset:34560
  v_mfma_f32_16x16x32_bf16 a[236:239], v[52:55], v[100:103], a[236:239]
  v_mfma_f32_16x16x32_bf16 a[36:39], v[52:55], v[104:107], a[36:39]
  ds_read_b128 v[152:155], v14 offset:45056
  v_mfma_f32_16x16x32_bf16 a[44:47], v[52:55], v[108:111], a[44:47]
  v_mfma_f32_16x16x32_bf16 a[100:103], v[52:55], v[112:115], a[100:103]
  ds_read_b64_tr_b16 v[92:93], v13 offset:33536
  v_mfma_f32_16x16x32_bf16 a[108:111], v[52:55], v[116:119], a[108:111]
  v_mfma_f32_16x16x32_bf16 a[164:167], v[52:55], v[120:123], a[164:167]
  ds_read_b64_tr_b16 v[94:95], v13 offset:34560
  v_mfma_f32_16x16x32_bf16 a[172:175], v[52:55], v[124:127], a[172:175]
  v_mfma_f32_16x16x32_bf16 a[240:243], v[56:59], v[96:99], a[240:243]
  s_add_u32 s26, s26, s79
  ds_read_b128 v[156:159], v14 offset:46080
  v_mfma_f32_16x16x32_bf16 a[248:251], v[56:59], v[100:103], a[248:251]
  s_add_u32 s27, s27, s25
  v_mfma_f32_16x16x32_bf16 a[48:51], v[56:59], v[104:107], a[48:51]
  s_add_u32 s24, s24, 32768
  v_mfma_f32_16x16x32_bf16 a[56:59], v[56:59], v[108:111], a[56:59]
  s_and_b32 s24, s24, 0x1ffff
  v_mfma_f32_16x16x32_bf16 a[112:115], v[56:59], v[112:115], a[112:115]
  v_xor_b32 v14, 0x10000, v14
  v_mfma_f32_16x16x32_bf16 a[120:123], v[56:59], v[116:119], a[120:123]
  v_xor_b32 v12, 0x10000, v12
  v_mfma_f32_16x16x32_bf16 a[176:179], v[56:59], v[120:123], a[176:179]
  v_xor_b32 v13, 0x10000, v13
  v_mfma_f32_16x16x32_bf16 a[184:187], v[56:59], v[124:127], a[184:187]
  v_mfma_f32_16x16x32_bf16 a[244:247], v[60:63], v[96:99], a[244:247]
  v_mfma_f32_16x16x32_bf16 a[252:255], v[60:63], v[100:103], a[252:255]
  v_mfma_f32_16x16x32_bf16 a[52:55], v[60:63], v[104:107], a[52:55]
  v_mfma_f32_16x16x32_bf16 a[60:63], v[60:63], v[108:111], a[60:63]
  v_mfma_f32_16x16x32_bf16 a[116:119], v[60:63], v[112:115], a[116:119]
  v_mfma_f32_16x16x32_bf16 a[124:127], v[60:63], v[116:119], a[124:127]
  v_mfma_f32_16x16x32_bf16 a[180:183], v[60:63], v[120:123], a[180:183]
  v_mfma_f32_16x16x32_bf16 a[188:191], v[60:63], v[124:127], a[188:191]
  s_waitcnt lgkmcnt(0)
  v_mfma_f32_16x16x32_bf16 a[192:195], v[64:67], v[128:131], a[192:195]
  s_waitcnt vmcnt(18)
  v_mfma_f32_16x16x32_bf16 a[200:203], v[64:67], v[132:135], a[200:203]
  s_barrier
  v_mfma_f32_16x16x32_bf16 a[0:3], v[64:67], v[136:139], a[0:3]
  ds_read_b64_tr_b16 v[32:33], v12 offset:0
  v_mfma_f32_16x16x32_bf16 a[8:11], v[64:67], v[140:143], a[8:11]
  v_mfma_f32_16x16x32_bf16 a[64:67], v[64:67], v[144:147], a[64:67]
  s_mov_b32 m0, s24
  ds_read_b64_tr_b16 v[34:35], v12 offset:1024
  v_mfma_f32_16x16x32_bf16 a[72:75], v[64:67], v[148:151], a[72:75]
  buffer_load_dwordx4 v3, s[32:35], s26 offen offset:0 sc1 lds
  v_mfma_f32_16x16x32_bf16 a[128:131], v[64:67], v[152:155], a[128:131]
  ds_read_b128 v[96:99], v14 offset:0
  v_mfma_f32_16x16x32_bf16 a[136:139], v[64:67], v[156:159], a[136:139]
  v_mfma_f32_16x16x32_bf16 a[196:199], v[68:71], v[128:131], a[196:199]
  ds_read_b64_tr_b16 v[36:37], v13 offset:0
  v_mfma_f32_16x16x32_bf16 a[204:207], v[68:71], v[132:135], a[204:207]
  v_mfma_f32_16x16x32_bf16 a[4:7], v[68:71], v[136:139], a[4:7]
  ds_read_b64_tr_b16 v[38:39], v13 offset:1024
  v_mfma_f32_16x16x32_bf16 a[12:15], v[68:71], v[140:143], a[12:15]
  buffer_load_dwordx4 v4, s[32:35], s26 offen offset:1024 sc1 lds
  v_mfma_f32_16x16x32_bf16 a[68:71], v[68:71], v[144:147], a[68:71]
  ds_read_b128 v[100:103], v14 offset:1024
  v_mfma_f32_16x16x32_bf16 a[76:79], v[68:71], v[148:151], a[76:79]
  v_mfma_f32_16x16x32_bf16 a[132:135], v[68:71], v[152:155], a[132:135]
  ds_read_b64_tr_b16 v[40:41], v12 offset:256
  v_mfma_f32_16x16x32_bf16 a[140:143], v[68:71], v[156:159], a[140:143]
  v_mfma_f32_16x16x32_bf16 a[208:211], v[72:75], v[128:131], a[208:211]
  ds_read_b64_tr_b16 v[42:43], v12 offset:1280
  v_mfma_f32_16x16x32_bf16 a[216:219], v[72:75], v[132:135], a[216:219]
  buffer_load_dwordx4 v5, s[32:35], s26 offen offset:2048 sc1 lds
  v_mfma_f32_16x16x32_bf16 a[16:19], v[72:75], v[136:139], a[16:19]
  ds_read_b128 v[104:107], v14 offset:4096
  v_mfma_f32_16x16x32_bf16 a[24:27], v[72:75], v[140:143], a[24:27]
  v_mfma_f32_16x16x32_bf16 a[80:83], v[72:75], v[144:147], a[80:83]
  ds_read_b64_tr_b16 v[44:45], v13 offset:256
  v_mfma_f32_16x16x32_bf16 a[88:91], v[72:75], v[148:151], a[88:91]
  v_mfma_f32_16x16x32_bf16 a[144:147], v[72:75], v[152:155], a[144:147]
  ds_read_b64_tr_b16 v[46:47], v13 offset:1280
  v_mfma_f32_16x16x32_bf16 a[152:155], v[72:75], v[156:159], a[152:155]
  buffer_load_dwordx4 v6, s[32:35], s26 offen offset:3072 sc1 lds
  v_mfma_f32_16x16x32_bf16 a[212:215], v[76:79], v[128:131], a[212:215]
  ds_read_b128 v[108:111], v14 offset:5120
  v_mfma_f32_16x16x32_bf16 a[220:223], v[76:79], v[132:135], a[220:223]
  v_mfma_f32_16x16x32_bf16 a[20:23], v[76:79], v[136:139], a[20:23]
  ds_read_b64_tr_b16 v[48:49], v12 offset:512
  v_mfma_f32_16x16x32_bf16 a[28:31], v[76:79], v[140:143], a[28:31]
  v_mfma_f32_16x16x32_bf16 a[84:87], v[76:79], v[144:147], a[84:87]
  s_add_u32 m0, s24, 16384
  ds_read_b64_tr_b16 v[50:51], v12 offset:1536
  v_mfma_f32_16x16x32_bf16 a[92:95], v[76:79], v[148:151], a[92:95]
  buffer_load_dwordx4 v8, s[36:39], s27 offen offset:0 lds
  v_mfma_f32_16x16x32_bf16 a[148:151], v[76:79], v[152:155], a[148:151]
  ds_read_b128 v[112:115], v14 offset:8192
  v_mfma_f32_16x16x32_bf16 a[156:159], v[76:79], v[156:159], a[156:159]
  v_mfma_f32_16x16x32_bf16 a[224:227], v[80:83], v[128:131], a[224:227]
  ds_read_b64_tr_b16 v[52:53], v13 offset:512
  v_mfma_f32_16x16x32_bf16 a[232:235], v[80:83], v[132:135], a[232:235]
  v_mfma_f32_16x16x32_bf16 a[32:35], v[80:83], v[136:139], a[32:35]
  ds_read_b64_tr_b16 v[54:55], v13 offset:1536
  v_mfma_f32_16x16x32_bf16 a[40:43], v[80:83], v[140:143], a[40:43]
  buffer_load_dwordx4 v9, s[36:39], s27 offen offset:1024 lds
  v_mfma_f32_16x16x32_bf16 a[96:99], v[80:83], v[144:147], a[96:99]
  ds_read_b128 v[116:119], v14 offset:9216
  v_mfma_f32_16x16x32_bf16 a[104:107], v[80:83], v[148:151], a[104:107]
  v_mfma_f32_16x16x32_bf16 a[160:163], v[80:83], v[152:155], a[160:163]
  ds_read_b64_tr_b16 v[56:57], v12 offset:768
  v_mfma_f32_16x16x32_bf16 a[168:171], v[80:83], v[156:159], a[168:171]
  v_mfma_f32_16x16x32_bf16 a[228:231], v[84:87], v[128:131], a[228:231]
  ds_read_b64_tr_b16 v[58:59], v12 offset:1792
  v_mfma_f32_16x16x32_bf16 a[236:239], v[84:87], v[132:135], a[236:239]
  buffer_load_dwordx4 v10, s[36:39], s27 offen offset:2048 lds
  v_mfma_f32_16x16x32_bf16 a[36:39], v[84:87], v[136:139], a[36:39]
  ds_read_b128 v[120:123], v14 offset:12288
  v_mfma_f32_16x16x32_bf16 a[44:47], v[84:87], v[140:143], a[44:47]
  v_mfma_f32_16x16x32_bf16 a[100:103], v[84:87], v[144:147], a[100:103]
  ds_read_b64_tr_b16 v[60:61], v13 offset:768
  v_mfma_f32_16x16x32_bf16 a[108:111], v[84:87], v[148:151], a[108:111]
  v_mfma_f32_16x16x32_bf16 a[164:167], v[84:87], v[152:155], a[164:167]
  ds_read_b64_tr_b16 v[62:63], v13 offset:1792
  v_mfma_f32_16x16x32_bf16 a[172:175], v[84:87], v[156:159], a[172:175]
  buffer_load_dwordx4 v11, s[36:39], s27 offen offset:3072 lds
  v_mfma_f32_16x16x32_bf16 a[240:243], v[88:91], v[128:131], a[240:243]
  s_add_u32 s26, s26, s79
  ds_read_b128 v[124:127], v14 offset:13312
  v_mfma_f32_16x16x32_bf16 a[248:251], v[88:91], v[132:135], a[248:251]
  s_add_u32 s27, s27, s25
  v_mfma_f32_16x16x32_bf16 a[48:51], v[88:91], v[136:139], a[48:51]
  s_add_u32 s24, s24, 32768
  v_mfma_f32_16x16x32_bf16 a[56:59], v[88:91], v[140:143], a[56:59]
  s_and_b32 s24, s24, 0x1ffff
  v_mfma_f32_16x16x32_bf16 a[112:115], v[88:91], v[144:147], a[112:115]
  v_mfma_f32_16x16x32_bf16 a[120:123], v[88:91], v[148:151], a[120:123]
  s_bitcmp1_b32 s76, s28
  v_mfma_f32_16x16x32_bf16 a[176:179], v[88:91], v[152:155], a[176:179]
  s_cbranch_scc1 fa_hk1
fa_hb1:
  v_mfma_f32_16x16x32_bf16 a[184:187], v[88:91], v[156:159], a[184:187]
  v_mfma_f32_16x16x32_bf16 a[244:247], v[92:95], v[128:131], a[244:247]
  v_mfma_f32_16x16x32_bf16 a[252:255], v[92:95], v[132:135], a[252:255]
  s_add_u32 s28, s28, 1
  v_mfma_f32_16x16x32_bf16 a[52:55], v[92:95], v[136:139], a[52:55]
  v_mfma_f32_16x16x32_bf16 a[60:63], v[92:95], v[140:143], a[60:63]
  v_mfma_f32_16x16x32_bf16 a[116:119], v[92:95], v[144:147], a[116:119]
  v_mfma_f32_16x16x32_bf16 a[124:127], v[92:95], v[148:151], a[124:127]
  s_cmp_lt_u32 s28, 8
  v_mfma_f32_16x16x32_bf16 a[180:183], v[92:95], v[152:155], a[180:183]
  s_waitcnt lgkmcnt(0)
  v_mfma_f32_16x16x32_bf16 a[188:191], v[92:95], v[156:159], a[188:191]
  s_cbranch_scc1 fa_loopK
  s_mov_b32 s64, 16777216
  s_mov_b32 s76, 0x3e0293ee
  s_branch fa_p1epi
fa_roleV:
  ds_read_b128 v[32:35], v14 offset:0
  ds_read_b128 v[36:39], v14 offset:1024
  ds_read_b128 v[40:43], v14 offset:4096
  ds_read_b128 v[44:47], v14 offset:5120
  ds_read_b128 v[48:51], v14 offset:8192
  ds_read_b128 v[52:55], v14 offset:9216
  ds_read_b128 v[56:59], v14 offset:12288
  ds_read_b128 v[60:63], v14 offset:13312
  ds_read_b64_tr_b16 v[96:97], v12 offset:0
  ds_read_b64_tr_b16 v[98:99], v12 offset:1024
  ds_read_b64_tr_b16 v[100:101], v13 offset:0
  ds_read_b64_tr_b16 v[102:103], v13 offset:1024
  ds_read_b64_tr_b16 v[104:105], v12 offset:256
  ds_read_b64_tr_b16 v[106:107], v12 offset:1280
  ds_read_b64_tr_b16 v[108:109], v13 offset:256
  ds_read_b64_tr_b16 v[110:111], v13 offset:1280
  ds_read_b64_tr_b16 v[112:113], v12 offset:512
  ds_read_b64_tr_b16 v[114:115], v12 offset:1536
  ds_read_b64_tr_b16 v[116:117], v13 offset:512
  ds_read_b64_tr_b16 v[118:119], v13 offset:1536
  ds_read_b64_tr_b16 v[120:121], v12 offset:768
  ds_read_b64_tr_b16 v[122:123], v12 offset:1792
  ds_read_b64_tr_b16 v[124:125], v13 offset:768
  ds_read_b64_tr_b16 v[126:127], v13 offset:1792
  s_waitcnt lgkmcnt(0)
.p2align 6
fa_loopV:
  v_mfma_f32_16x16x32_bf16 a[192:195], v[32:35], v[96:99], a[192:195]
  s_waitcnt vmcnt(17)
  v_mfma_f32_16x16x32_bf16 a[200:203], v[32:35], v[100:103], a[200:203]
  s_barrier
  v_mfma_f32_16x16x32_bf16 a[208:211], v[32:35], v[104:107], a[208:211]
  ds_read_b64_tr_b16 v[128:129], v12 offset:32768
  v_mfma_f32_16x16x32_bf16 a[216:219], v[32:35], v[108:111], a[216:219]
  v_mfma_f32_16x16x32_bf16 a[224:227], v[32:35], v[112:115], a[224:227]
  s_mov_b32 m0, s24
  ds_read_b64_tr_b16 v[130:131], v12 offset:33792
  v_mfma_f32_16x16x32_bf16 a[232:235], v[32:35], v[116:119], a[232:235]
  buffer_load_dwordx4 v3, s[32:35], s26 offen offset:0 sc1 lds
  v_mfma_f32_16x16x32_bf16 a[240:243], v[32:35], v[120:123], a[240:243]
  ds_read_b128 v[64:67], v14 offset:32768
  v_mfma_f32_16x16x32_bf16 a[248:251], v[32:35], v[124:127], a[248:251]
  buffer_load_dwordx4 v4, s[32:35], s26 offen offset:1024 sc1 lds
  v_mfma_f32_16x16x32_bf16 a[196:199], v[36:39], v[96:99], a[196:199]
  ds_read_b64_tr_b16 v[132:133], v13 offset:32768
  v_mfma_f32_16x16x32_bf16 a[204:207], v[36:39], v[100:103], a[204:207]
  buffer_load_dwordx4 v5, s[32:35], s26 offen offset:2048 sc1 lds
  v_mfma_f32_16x16x32_bf16 a[212:215], v[36:39], v[104:107], a[212:215]
  ds_read_b64_tr_b16 v[134:135], v13 offset:33792
  v_mfma_f32_16x16x32_bf16 a[220:223], v[36:39], v[108:111], a[220:223]
  buffer_load_dwordx4 v6, s[32:35], s26 offen offset:3072 sc1 lds
  v_mfma_f32_16x16x32_bf16 a[228:231], v[36:39], v[112:115], a[228:231]
  s_add_u32 m0, s24, 16384
  ds_read_b128 v[68:71], v14 offset:33792
  v_mfma_f32_16x16x32_bf16 a[236:239], v[36:39], v[116:119], a[236:239]
  buffer_load_dwordx4 v8, s[36:39], s27 offen offset:0 lds
  v_mfma_f32_16x16x32_bf16 a[244:247], v[36:39], v[120:123], a[244:247]
  ds_read_b64_tr_b16 v[136:137], v12 offset:33024
  v_mfma_f32_16x16x32_bf16 a[252:255], v[36:39], v[124:127], a[252:255]
  buffer_load_dwordx4 v9, s[36:39], s27 offen offset:1024 lds
  v_mfma_f32_16x16x32_bf16 a[0:3], v[40:43], v[96:99], a[0:3]
  ds_read_b64_tr_b16 v[138:139], v12 offset:34048
  v_mfma_f32_16x16x32_bf16 a[8:11], v[40:43], v[100:103], a[8:11]
  buffer_load_dwordx4 v10, s[36:39], s27 offen offset:2048 lds
  v_mfma_f32_16x16x32_bf16 a[16:19], v[40:43], v[104:107], a[16:19]
  ds_read_b128 v[72:75], v14 offset:36864
  v_mfma_f32_16x16x32_bf16 a[24:27], v[40:43], v[108:111], a[24:27]
  buffer_load_dwordx4 v11, s[36:39], s27 offen offset:3072 lds
  v_mfma_f32_16x16x32_bf16 a[32:35], v[40:43], v[112:115], a[32:35]
  ds_read_b64_tr_b16 v[140:141], v13 offset:33024
  v_mfma_f32_16x16x32_bf16 a[40:43], v[40:43], v[116:119], a[40:43]
  buffer_load_dword v231, v235, s[48:51], s74 offen sc1
  v_mfma_f32_16x16x32_bf16 a[48:51], v[40:43], v[120:123], a[48:51]
  s_add_u32 s74, s74, s73
  ds_read_b64_tr_b16 v[142:143], v13 offset:34048
  v_mfma_f32_16x16x32_bf16 a[56:59], v[40:43], v[124:127], a[56:59]
  s_bitcmp1_b32 s72, s28
  v_mfma_f32_16x16x32_bf16 a[4:7], v[44:47], v[96:99], a[4:7]
  s_cbranch_scc1 fa_hk2
fa_hb2:
  ds_read_b128 v[76:79], v14 offset:37888
  v_mfma_f32_16x16x32_bf16 a[12:15], v[44:47], v[100:103], a[12:15]
  v_mfma_f32_16x16x32_bf16 a[20:23], v[44:47], v[104:107], a[20:23]
  ds_read_b64_tr_b16 v[144:145], v12 offset:33280
  v_mfma_f32_16x16x32_bf16 a[28:31], v[44:47], v[108:111], a[28:31]
  v_mfma_f32_16x16x32_bf16 a[36:39], v[44:47], v[112:115], a[36:39]
  ds_read_b64_tr_b16 v[146:147], v12 offset:34304
  v_mfma_f32_16x16x32_bf16 a[44:47], v[44:47], v[116:119], a[44:47]
  v_mfma_f32_16x16x32_bf16 a[52:55], v[44:47], v[120:123], a[52:55]
  ds_read_b128 v[80:83], v14 offset:40960
  v_mfma_f32_16x16x32_bf16 a[60:63], v[44:47], v[124:127], a[60:63]
  v_mfma_f32_16x16x32_bf16 a[64:67], v[48:51], v[96:99], a[64:67]
  ds_read_b64_tr_b16 v[148:149], v13 offset:33280
  v_mfma_f32_16x16x32_bf16 a[72:75], v[48:51], v[100:103], a[72:75]
  v_mfma_f32_16x16x32_bf16 a[80:83], v[48:51], v[104:107], a[80:83]
  ds_read_b64_tr_b16 v[150:151], v13 offset:34304
  v_mfma_f32_16x16x32_bf16 a[88:91], v[48:51], v[108:111], a[88:91]
  v_mfma_f32_16x16x32_bf16 a[96:99], v[48:51], v[112:115], a[96:99]
  ds_read_b128 v[84:87], v14 offset:41984
  v_mfma_f32_16x16x32_bf16 a[104:107], v[48:51], v[116:119], a[104:107]
  v_mfma_f32_16x16x32_bf16 a[112:115], v[48:51], v[120:123], a[112:115]
  ds_read_b64_tr_b16 v[152:153], v12 offset:33536
  v_mfma_f32_16x16x32_bf16 a[120:123], v[48:51], v[124:127], a[120:123]
  v_mfma_f32_16x16x32_bf16 a[68:71], v[52:55], v[96:99], a[68:71]
  ds_read_b64_tr_b16 v[154:155], v12 offset:34560
  v_mfma_f32_16x16x32_bf16 a[76:79], v[52:55], v[100:103], a[76:79]
  v_mfma_f32_16x16x32_bf16 a[84:87], v[52:55], v[104:107], a[84:87]
  ds_read_b128 v[88:91], v14 offset:45056
  v_mfma_f32_16x16x32_bf16 a[92:95], v[52:55], v[108:111], a[92:95]
  v_mfma_f32_16x16x32_bf16 a[100:103], v[52:55], v[112:115], a[100:103]
  ds_read_b64_tr_b16 v[156:157], v13 offset:33536
  v_mfma_f32_16x16x32_bf16 a[108:111], v[52:55], v[116:119], a[108:111]
  v_mfma_f32_16x16x32_bf16 a[116:119], v[52:55], v[120:123], a[116:119]
  ds_read_b64_tr_b16 v[158:159], v13 offset:34560
  v_mfma_f32_16x16x32_bf16 a[124:127], v[52:55], v[124:127], a[124:127]
  v_mfma_f32_16x16x32_bf16 a[128:131], v[56:59], v[96:99], a[128:131]
  s_add_u32 s26, s26, s79
  ds_read_b128 v[92:95], v14 offset:46080
  v_mfma_f32_16x16x32_bf16 a[136:139], v[56:59], v[100:103], a[136:139]
  s_add_u32 s27, s27, s25
  v_mfma_f32_16x16x32_bf16 a[144:147], v[56:59], v[104:107], a[144:147]
  s_add_u32 s24, s24, 32768
  v_mfma_f32_16x16x32_bf16 a[152:155], v[56:59], v[108:111], a[152:155]
  s_and_b32 s24, s24, 0x1ffff
  v_mfma_f32_16x16x32_bf16 a[160:163], v[56:59], v[112:115], a[160:163]
  v_xor_b32 v14, 0x10000, v14
  v_mfma_f32_16x16x32_bf16 a[168:171], v[56:59], v[116:119], a[168:171]
  v_xor_b32 v12, 0x10000, v12
  v_mfma_f32_16x16x32_bf16 a[176:179], v[56:59], v[120:123], a[176:179]
  v_xor_b32 v13, 0x10000, v13
  v_mfma_f32_16x16x32_bf16 a[184:187], v[56:59], v[124:127], a[184:187]
  v_mfma_f32_16x16x32_bf16 a[132:135], v[60:63], v[96:99], a[132:135]
  v_mfma_f32_16x16x32_bf16 a[140:143], v[60:63], v[100:103], a[140:143]
  v_mfma_f32_16x16x32_bf16 a[148:151], v[60:63], v[104:107], a[148:151]
  v_mfma_f32_16x16x32_bf16 a[156:159], v[60:63], v[108:111], a[156:159]
  v_mfma_f32_16x16x32_bf16 a[164:167], v[60:63], v[112:115], a[164:167]
  v_mfma_f32_16x16x32_bf16 a[172:175], v[60:63], v[116:119], a[172:175]
  v_mfma_f32_16x16x32_bf16 a[180:183], v[60:63], v[120:123], a[180:183]
  v_mfma_f32_16x16x32_bf16 a[188:191], v[60:63], v[124:127], a[188:191]
  s_waitcnt lgkmcnt(0)
  v_mfma_f32_16x16x32_bf16 a[192:195], v[64:67], v[128:131], a[192:195]
  s_waitcnt vmcnt(18)
  v_mfma_f32_16x16x32_bf16 a[200:203], v[64:67], v[132:135], a[200:203]
  s_barrier
  v_mfma_f32_16x16x32_bf16 a[208:211], v[64:67], v[136:139], a[208:211]
  ds_read_b64_tr_b16 v[96:97], v12 offset:0
  v_mfma_f32_16x16x32_bf16 a[216:219], v[64:67], v[140:143], a[216:219]
  v_mfma_f32_16x16x32_bf16 a[224:227], v[64:67], v[144:147], a[224:227]
  s_mov_b32 m0, s24
  ds_read_b64_tr_b16 v[98:99], v12 offset:1024
  v_mfma_f32_16x16x32_bf16 a[232:235], v[64:67], v[148:151], a[232:235]
  buffer_load_dwordx4 v3, s[32:35], s26 offen offset:0 sc1 lds
  v_mfma_f32_16x16x32_bf16 a[240:243], v[64:67], v[152:155], a[240:243]
  ds_read_b128 v[32:35], v14 offset:0
  v_mfma_f32_16x16x32_bf16 a[248:251], v[64:67], v[156:159], a[248:251]
  v_mfma_f32_16x16x32_bf16 a[196:199], v[68:71], v[128:131], a[196:199]
  ds_read_b64_tr_b16 v[100:101], v13 offset:0
  v_mfma_f32_16x16x32_bf16 a[204:207], v[68:71], v[132:135], a[204:207]
  v_mfma_f32_16x16x32_bf16 a[212:215], v[68:71], v[136:139], a[212:215]
  ds_read_b64_tr_b16 v[102:103], v13 offset:1024
  v_mfma_f32_16x16x32_bf16 a[220:223], v[68:71], v[140:143], a[220:223]
  buffer_load_dwordx4 v4, s[32:35], s26 offen offset:1024 sc1 lds
  v_mfma_f32_16x16x32_bf16 a[228:231], v[68:71], v[144:147], a[228:231]
  ds_read_b128 v[36:39], v14 offset:1024
  v_mfma_f32_16x16x32_bf16 a[236:239], v[68:71], v[148:151], a[236:239]
  v_mfma_f32_16x16x32_bf16 a[244:247], v[68:71], v[152:155], a[244:247]
  ds_read_b64_tr_b16 v[104:105], v12 offset:256
  v_mfma_f32_16x16x32_bf16 a[252:255], v[68:71], v[156:159], a[252:255]
  v_mfma_f32_16x16x32_bf16 a[0:3], v[72:75], v[128:131], a[0:3]
  ds_read_b64_tr_b16 v[106:107], v12 offset:1280
  v_mfma_f32_16x16x32_bf16 a[8:11], v[72:75], v[132:135], a[8:11]
  buffer_load_dwordx4 v5, s[32:35], s26 offen offset:2048 sc1 lds
  v_mfma_f32_16x16x32_bf16 a[16:19], v[72:75], v[136:139], a[16:19]
  ds_read_b128 v[40:43], v14 offset:4096
  v_mfma_f32_16x16x32_bf16 a[24:27], v[72:75], v[140:143], a[24:27]
  v_mfma_f32_16x16x32_bf16 a[32:35], v[72:75], v[144:147], a[32:35]
  ds_read_b64_tr_b16 v[108:109], v13 offset:256
  v_mfma_f32_16x16x32_bf16 a[40:43], v[72:75], v[148:151], a[40:43]
  v_mfma_f32_16x16x32_bf16 a[48:51], v[72:75], v[152:155], a[48:51]
  ds_read_b64_tr_b16 v[110:111], v13 offset:1280
  v_mfma_f32_16x16x32_bf16 a[56:59], v[72:75], v[156:159], a[56:59]
  buffer_load_dwordx4 v6, s[32:35], s26 offen offset:3072 sc1 lds
  v_mfma_f32_16x16x32_bf16 a[4:7], v[76:79], v[128:131], a[4:7]
  ds_read_b128 v[44:47], v14 offset:5120
  v_mfma_f32_16x16x32_bf16 a[12:15], v[76:79], v[132:135], a[12:15]
  v_mfma_f32_16x16x32_bf16 a[20:23], v[76:79], v[136:139], a[20:23]
  ds_read_b64_tr_b16 v[112:113], v12 offset:512
  v_mfma_f32_16x16x32_bf16 a[28:31], v[76:79], v[140:143], a[28:31]
  v_mfma_f32_16x16x32_bf16 a[36:39], v[76:79], v[144:147], a[36:39]
  s_add_u32 m0, s24, 16384
  ds_read_b64_tr_b16 v[114:115], v12 offset:1536
  v_mfma_f32_16x16x32_bf16 a[44:47], v[76:79], v[148:151], a[44:47]
  buffer_load_dwordx4 v8, s[36:39], s27 offen offset:0 lds
  v_mfma_f32_16x16x32_bf16 a[52:55], v[76:79], v[152:155], a[52:55]
  ds_read_b128 v[48:51], v14 offset:8192
  v_mfma_f32_16x16x32_bf16 a[60:63], v[76:79], v[156:159], a[60:63]
  v_mfma_f32_16x16x32_bf16 a[64:67], v[80:83], v[128:131], a[64:67]
  ds_read_b64_tr_b16 v[116:117], v13 offset:512
  v_mfma_f32_16x16x32_bf16 a[72:75], v[80:83], v[132:135], a[72:75]
  v_mfma_f32_16x16x32_bf16 a[80:83], v[80:83], v[136:139], a[80:83]
  ds_read_b64_tr_b16 v[118:119], v13 offset:1536
  v_mfma_f32_16x16x32_bf16 a[88:91], v[80:83], v[140:143], a[88:91]
  buffer_load_dwordx4 v9, s[36:39], s27 offen offset:1024 lds
  v_mfma_f32_16x16x32_bf16 a[96:99], v[80:83], v[144:147], a[96:99]
  ds_read_b128 v[52:55], v14 offset:9216
  v_mfma_f32_16x16x32_bf16 a[104:107], v[80:83], v[148:151], a[104:107]
  v_mfma_f32_16x16x32_bf16 a[112:115], v[80:83], v[152:155], a[112:115]
  ds_read_b64_tr_b16 v[120:121], v12 offset:768
  v_mfma_f32_16x16x32_bf16 a[120:123], v[80:83], v[156:159], a[120:123]
  v_mfma_f32_16x16x32_bf16 a[68:71], v[84:87], v[128:131], a[68:71]
  ds_read_b64_tr_b16 v[122:123], v12 offset:1792
  v_mfma_f32_16x16x32_bf16 a[76:79], v[84:87], v[132:135], a[76:79]
  buffer_load_dwordx4 v10, s[36:39], s27 offen offset:2048 lds
  v_mfma_f32_16x16x32_bf16 a[84:87], v[84:87], v[136:139], a[84:87]
  ds_read_b128 v[56:59], v14 offset:12288
  v_mfma_f32_16x16x32_bf16 a[92:95], v[84:87], v[140:143], a[92:95]
  v_mfma_f32_16x16x32_bf16 a[100:103], v[84:87], v[144:147], a[100:103]
  ds_read_b64_tr_b16 v[124:125], v13 offset:768
  v_mfma_f32_16x16x32_bf16 a[108:111], v[84:87], v[148:151], a[108:111]
  v_mfma_f32_16x16x32_bf16 a[116:119], v[84:87], v[152:155], a[116:119]
  ds_read_b64_tr_b16 v[126:127], v13 offset:1792
  v_mfma_f32_16x16x32_bf16 a[124:127], v[84:87], v[156:159], a[124:127]
  buffer_load_dwordx4 v11, s[36:39], s27 offen offset:3072 lds
  v_mfma_f32_16x16x32_bf16 a[128:131], v[88:91], v[128:131], a[128:131]
  s_add_u32 s26, s26, s79
  ds_read_b128 v[60:63], v14 offset:13312
  v_mfma_f32_16x16x32_bf16 a[136:139], v[88:91], v[132:135], a[136:139]
  s_add_u32 s27, s27, s25
  v_mfma_f32_16x16x32_bf16 a[144:147], v[88:91], v[136:139], a[144:147]
  s_add_u32 s24, s24, 32768
  v_mfma_f32_16x16x32_bf16 a[152:155], v[88:91], v[140:143], a[152:155]
  s_and_b32 s24, s24, 0x1ffff
  v_mfma_f32_16x16x32_bf16 a[160:163], v[88:91], v[144:147], a[160:163]
  v_mfma_f32_16x16x32_bf16 a[168:171], v[88:91], v[148:151], a[168:171]
  s_bitcmp1_b32 s76, s28
  v_mfma_f32_16x16x32_bf16 a[176:179], v[88:91], v[152:155], a[176:179]
  s_cbranch_scc1 fa_hk3
fa_hb3:
  v_mfma_f32_16x16x32_bf16 a[184:187], v[88:91], v[156:159], a[184:187]
  v_mfma_f32_16x16x32_bf16 a[132:135], v[92:95], v[128:131], a[132:135]
  v_mfma_f32_16x16x32_bf16 a[140:143], v[92:95], v[132:135], a[140:143]
  s_add_u32 s28, s28, 1
  v_mfma_f32_16x16x32_bf16 a[148:151], v[92:95], v[136:139], a[148:151]
  v_mfma_f32_16x16x32_bf16 a[156:159], v[92:95], v[140:143], a[156:159]
  v_mfma_f32_16x16x32_bf16 a[164:167], v[92:95], v[144:147], a[164:167]
  v_mfma_f32_16x16x32_bf16 a[172:175], v[92:95], v[148:151], a[172:175]
  s_cmp_lt_u32 s28, 8
  v_mfma_f32_16x16x32_bf16 a[180:183], v[92:95], v[152:155], a[180:183]
  s_waitcnt lgkmcnt(0)
  v_mfma_f32_16x16x32_bf16 a[188:191], v[92:95], v[156:159], a[188:191]
  s_cbranch_scc1 fa_loopV
  s_mov_b32 s64, 33554432
  s_mov_b32 s76, 1.0
fa_p1epi:
  s_lshr_b32 s23, s20, 1
  s_lshl_b32 s23, s23, 13
  v_subrev_u32 v12, s23, v12
  v_subrev_u32 v13, s23, v13
  s_lshl_b32 s24, s20, 12
  v_add_u32 v14, s24, v2
  ds_read_b64_tr_b16 v[32:33], v12 offset:0
  ds_read_b64_tr_b16 v[34:35], v12 offset:1024
  ds_read_b64_tr_b16 v[36:37], v13 offset:0
  ds_read_b64_tr_b16 v[38:39], v13 offset:1024
  ds_read_b64_tr_b16 v[40:41], v12 offset:256
  ds_read_b64_tr_b16 v[42:43], v12 offset:1280
  ds_read_b64_tr_b16 v[44:45], v13 offset:256
  ds_read_b64_tr_b16 v[46:47], v13 offset:1280
  ds_read_b64_tr_b16 v[48:49], v12 offset:512
  ds_read_b64_tr_b16 v[50:51], v12 offset:1536
  ds_read_b64_tr_b16 v[52:53], v13 offset:512
  ds_read_b64_tr_b16 v[54:55], v13 offset:1536
  ds_read_b64_tr_b16 v[56:57], v12 offset:768
  ds_read_b64_tr_b16 v[58:59], v12 offset:1792
  ds_read_b64_tr_b16 v[60:61], v13 offset:768
  ds_read_b64_tr_b16 v[62:63], v13 offset:1792
  s_waitcnt vmcnt(8)
  ds_read_b128 v[224:227], v14 offset:0
  ds_read_b128 v[228:231], v14 offset:1024
  ds_read_b128 v[232:235], v14 offset:2048
  ds_read_b128 v[236:239], v14 offset:3072
  s_lshl_b32 s23, s21, 19
  s_add_u32 s64, s64, s23
  s_lshl_b32 s23, s22, 14
  s_add_u32 s64, s64, s23
  s_and_b32 s23, s20, 1
  s_lshl_b32 s23, s23, 13
  s_add_u32 s64, s64, s23
  s_lshl_b32 s23, s21, 19
  s_add_u32 s23, s23, 16777216
  s_add_u32 s6, s18, s23
  s_addc_u32 s7, s19, 0
  s_add_u32 s8, s6, 16777216
  s_addc_u32 s9, s7, 0
  s_sub_u32 s23, 16, s22
  s_lshl_b32 s23, s23, 15
  s_mov_b32 s44, s6
  s_mov_b32 s45, s7
  s_mov_b32 s46, s23
  s_mov_b32 s47, 0x20000
  s_mov_b32 s48, s8
  s_mov_b32 s49, s9
  s_mov_b32 s50, s23
  s_mov_b32 s51, 0x20000
  s_lshl_b32 s30, s21, 7
  s_add_u32 s30, s30, 2637824
  s_mov_b32 s81, 0x47800000
  s_cmp_eq_u32 s20, 0
  s_cselect_b32 s65, s82, 1073741824
  s_waitcnt vmcnt(21) lgkmcnt(0)
  v_mfma_f32_16x16x32_bf16 v[96:99], v[32:35], v[224:227], 0
  v_accvgpr_read_b32 v16, a192
  v_accvgpr_read_b32 v17, a193
  v_accvgpr_read_b32 v18, a194
  v_mfma_f32_16x16x32_bf16 v[112:115], v[36:39], v[224:227], 0
  ds_read_b64_tr_b16 v[64:65], v12 offset:8192
  v_accvgpr_read_b32 v19, a195
  v_mfma_f32_16x16x32_bf16 v[128:131], v[40:43], v[224:227], 0
  s_add_u32 m0, s24, 0
  ds_read_b64_tr_b16 v[66:67], v12 offset:9216
  v_accvgpr_read_b32 v20, a196
  v_mfma_f32_16x16x32_bf16 v[144:147], v[44:47], v[224:227], 0
  buffer_load_dwordx4 v3, s[32:35], s26 offen offset:0 sc1 lds
  v_accvgpr_read_b32 v21, a197
  v_mfma_f32_16x16x32_bf16 v[160:163], v[48:51], v[224:227], 0
  ds_read_b64_tr_b16 v[68:69], v13 offset:8192
  v_accvgpr_read_b32 v22, a198
  v_accvgpr_read_b32 v23, a199
  v_mfma_f32_16x16x32_bf16 v[176:179], v[52:55], v[224:227], 0
  ds_read_b64_tr_b16 v[70:71], v13 offset:9216
  v_mul_f32 v16, s76, v16
  v_mfma_f32_16x16x32_bf16 v[192:195], v[56:59], v[224:227], 0
  ds_read_b64_tr_b16 v[72:73], v12 offset:8448
  v_mul_f32 v17, s76, v17
  v_mfma_f32_16x16x32_bf16 v[208:211], v[60:63], v[224:227], 0
  ds_read_b64_tr_b16 v[74:75], v12 offset:9472
  v_mul_f32 v18, s76, v18
  v_mfma_f32_16x16x32_bf16 v[100:103], v[32:35], v[228:231], 0
  buffer_load_dwordx4 v4, s[32:35], s26 offen offset:1024 sc1 lds
  v_mul_f32 v19, s76, v19
  v_mul_f32 v20, s76, v20
  v_mfma_f32_16x16x32_bf16 v[116:119], v[36:39], v[228:231], 0
  ds_read_b64_tr_b16 v[76:77], v13 offset:8448
  v_mul_f32 v21, s76, v21
  v_mfma_f32_16x16x32_bf16 v[132:135], v[40:43], v[228:231], 0
  ds_read_b64_tr_b16 v[78:79], v13 offset:9472
  v_mul_f32 v22, s76, v22
  v_mfma_f32_16x16x32_bf16 v[148:151], v[44:47], v[228:231], 0
  ds_read_b128 v[240:243], v14 offset:32768
  v_mul_f32 v23, s76, v23
  v_mfma_f32_16x16x32_bf16 v[164:167], v[48:51], v[228:231], 0
  ds_read_b128 v[244:247], v14 offset:33792
  v_cvt_pk_bf16_f32 v24, v16, v17
  v_cvt_pk_bf16_f32 v25, v18, v19
  v_mfma_f32_16x16x32_bf16 v[180:183], v[52:55], v[228:231], 0
  buffer_load_dwordx4 v5, s[32:35], s26 offen offset:2048 sc1 lds
  v_cvt_pk_bf16_f32 v26, v20, v21
  v_mfma_f32_16x16x32_bf16 v[196:199], v[56:59], v[228:231], 0
  ds_read_b64_tr_b16 v[80:81], v12 offset:8704
  v_cvt_pk_bf16_f32 v27, v22, v23
  v_mfma_f32_16x16x32_bf16 v[212:215], v[60:63], v[228:231], 0
  ds_read_b64_tr_b16 v[82:83], v12 offset:9728
  buffer_store_dwordx4 v[24:27], v2, s[40:43], s64 offen offset:0 sc1
  v_mfma_f32_16x16x32_bf16 v[104:107], v[32:35], v[232:235], 0
  ds_read_b64_tr_b16 v[84:85], v13 offset:8704
  v_accvgpr_read_b32 v16, a200
  v_mfma_f32_16x16x32_bf16 v[120:123], v[36:39], v[232:235], 0
  ds_read_b64_tr_b16 v[86:87], v13 offset:9728
  v_accvgpr_read_b32 v17, a201
  v_accvgpr_read_b32 v18, a202
  v_mfma_f32_16x16x32_bf16 v[136:139], v[40:43], v[232:235], 0
  buffer_load_dwordx4 v6, s[32:35], s26 offen offset:3072 sc1 lds
  v_accvgpr_read_b32 v19, a203
  v_mfma_f32_16x16x32_bf16 v[152:155], v[44:47], v[232:235], 0
  s_add_u32 s26, s26, 1024
  ds_read_b64_tr_b16 v[88:89], v12 offset:8960
  v_accvgpr_read_b32 v20, a204
  v_mfma_f32_16x16x32_bf16 v[168:171], v[48:51], v[232:235], 0
  ds_read_b64_tr_b16 v[90:91], v12 offset:9984
  v_accvgpr_read_b32 v21, a205
  v_mfma_f32_16x16x32_bf16 v[184:187], v[52:55], v[232:235], 0
  ds_read_b64_tr_b16 v[92:93], v13 offset:8960
  v_accvgpr_read_b32 v22, a206
  v_accvgpr_read_b32 v23, a207
  v_mfma_f32_16x16x32_bf16 v[200:203], v[56:59], v[232:235], 0
  ds_read_b64_tr_b16 v[94:95], v13 offset:9984
  v_mul_f32 v16, s76, v16
  v_mfma_f32_16x16x32_bf16 v[216:219], v[60:63], v[232:235], 0
  v_mul_f32 v17, s76, v17
  v_mul_f32 v18, s76, v18
  v_mfma_f32_16x16x32_bf16 v[108:111], v[32:35], v[236:239], 0
  ds_read_b128 v[248:251], v14 offset:34816
  v_mul_f32 v19, s76, v19
  v_mfma_f32_16x16x32_bf16 v[124:127], v[36:39], v[236:239], 0
  ds_read_b128 v[252:255], v14 offset:35840
  v_mul_f32 v20, s76, v20
  v_mul_f32 v21, s76, v21
  v_mfma_f32_16x16x32_bf16 v[140:143], v[40:43], v[236:239], 0
  v_mul_f32 v22, s76, v22
  v_mul_f32 v23, s76, v23
  v_mfma_f32_16x16x32_bf16 v[156:159], v[44:47], v[236:239], 0
  v_xor_b32 v14, 0x10000, v14
  v_cvt_pk_bf16_f32 v28, v16, v17
  v_mfma_f32_16x16x32_bf16 v[172:175], v[48:51], v[236:239], 0
  v_cvt_pk_bf16_f32 v29, v18, v19
  v_cvt_pk_bf16_f32 v30, v20, v21
  v_mfma_f32_16x16x32_bf16 v[188:191], v[52:55], v[236:239], 0
  v_cvt_pk_bf16_f32 v31, v22, v23
  v_mfma_f32_16x16x32_bf16 v[204:207], v[56:59], v[236:239], 0
  buffer_store_dwordx4 v[28:31], v2, s[40:43], s64 offen offset:1024 sc1
  v_mfma_f32_16x16x32_bf16 v[220:223], v[60:63], v[236:239], 0
  s_waitcnt vmcnt(19) lgkmcnt(0)
  v_mfma_f32_16x16x32_bf16 v[96:99], v[64:67], v[240:243], v[96:99]
  s_barrier
  v_accvgpr_read_b32 v16, a208
  v_accvgpr_read_b32 v17, a209
  v_accvgpr_read_b32 v18, a210
  v_mfma_f32_16x16x32_bf16 v[112:115], v[68:71], v[240:243], v[112:115]
  ds_read_b64_tr_b16 v[32:33], v12 offset:32768
  v_accvgpr_read_b32 v19, a211
  v_mfma_f32_16x16x32_bf16 v[128:131], v[72:75], v[240:243], v[128:131]
  s_add_u32 m0, s24, 32768
  ds_read_b64_tr_b16 v[34:35], v12 offset:33792
  v_accvgpr_read_b32 v20, a212
  v_mfma_f32_16x16x32_bf16 v[144:147], v[76:79], v[240:243], v[144:147]
  buffer_load_dwordx4 v3, s[32:35], s26 offen offset:0 sc1 lds
  v_accvgpr_read_b32 v21, a213
  v_mfma_f32_16x16x32_bf16 v[160:163], v[80:83], v[240:243], v[160:163]
  ds_read_b64_tr_b16 v[36:37], v13 offset:32768
  v_accvgpr_read_b32 v22, a214
  v_accvgpr_read_b32 v23, a215
  v_mfma_f32_16x16x32_bf16 v[176:179], v[84:87], v[240:243], v[176:179]
  ds_read_b64_tr_b16 v[38:39], v13 offset:33792
  v_mul_f32 v16, s76, v16
  v_mfma_f32_16x16x32_bf16 v[192:195], v[88:91], v[240:243], v[192:195]
  ds_read_b64_tr_b16 v[40:41], v12 offset:33024
  v_mul_f32 v17, s76, v17
  v_mfma_f32_16x16x32_bf16 v[208:211], v[92:95], v[240:243], v[208:211]
  ds_read_b64_tr_b16 v[42:43], v12 offset:34048
  v_mul_f32 v18, s76, v18
  v_mfma_f32_16x16x32_bf16 v[100:103], v[64:67], v[244:247], v[100:103]
  buffer_load_dwordx4 v4, s[32:35], s26 offen offset:1024 sc1 lds
  v_mul_f32 v19, s76, v19
  v_mul_f32 v20, s76, v20
  v_mfma_f32_16x16x32_bf16 v[116:119], v[68:71], v[244:247], v[116:119]
  ds_read_b64_tr_b16 v[44:45], v13 offset:33024
  v_mul_f32 v21, s76, v21
  v_mfma_f32_16x16x32_bf16 v[132:135], v[72:75], v[244:247], v[132:135]
  ds_read_b64_tr_b16 v[46:47], v13 offset:34048
  v_mul_f32 v22, s76, v22
  v_mfma_f32_16x16x32_bf16 v[148:151], v[76:79], v[244:247], v[148:151]
  ds_read_b128 v[224:227], v14 offset:0
  v_mul_f32 v23, s76, v23
  v_mfma_f32_16x16x32_bf16 v[164:167], v[80:83], v[244:247], v[164:167]
  ds_read_b128 v[228:231], v14 offset:1024
  v_cvt_pk_bf16_f32 v24, v16, v17
  v_cvt_pk_bf16_f32 v25, v18, v19
  v_mfma_f32_16x16x32_bf16 v[180:183], v[84:87], v[244:247], v[180:183]
  buffer_load_dwordx4 v5, s[32:35], s26 offen offset:2048 sc1 lds
  v_cvt_pk_bf16_f32 v26, v20, v21
  v_mfma_f32_16x16x32_bf16 v[196:199], v[88:91], v[244:247], v[196:199]
  ds_read_b64_tr_b16 v[48:49], v12 offset:33280
  v_cvt_pk_bf16_f32 v27, v22, v23
  v_mfma_f32_16x16x32_bf16 v[212:215], v[92:95], v[244:247], v[212:215]
  ds_read_b64_tr_b16 v[50:51], v12 offset:34304
  buffer_store_dwordx4 v[24:27], v2, s[40:43], s64 offen offset:2048 sc1
  v_mfma_f32_16x16x32_bf16 v[104:107], v[64:67], v[248:251], v[104:107]
  ds_read_b64_tr_b16 v[52:53], v13 offset:33280
  v_accvgpr_read_b32 v16, a216
  v_mfma_f32_16x16x32_bf16 v[120:123], v[68:71], v[248:251], v[120:123]
  ds_read_b64_tr_b16 v[54:55], v13 offset:34304
  v_accvgpr_read_b32 v17, a217
  v_accvgpr_read_b32 v18, a218
  v_mfma_f32_16x16x32_bf16 v[136:139], v[72:75], v[248:251], v[136:139]
  buffer_load_dwordx4 v6, s[32:35], s26 offen offset:3072 sc1 lds
  v_accvgpr_read_b32 v19, a219
  v_mfma_f32_16x16x32_bf16 v[152:155], v[76:79], v[248:251], v[152:155]
  s_add_u32 s26, s26, 1024
  ds_read_b64_tr_b16 v[56:57], v12 offset:33536
  v_accvgpr_read_b32 v20, a220
  v_mfma_f32_16x16x32_bf16 v[168:171], v[80:83], v[248:251], v[168:171]
  ds_read_b64_tr_b16 v[58:59], v12 offset:34560
  v_accvgpr_read_b32 v21, a221
  v_mfma_f32_16x16x32_bf16 v[184:187], v[84:87], v[248:251], v[184:187]
  ds_read_b64_tr_b16 v[60:61], v13 offset:33536
  v_accvgpr_read_b32 v22, a222
  v_accvgpr_read_b32 v23, a223
  v_mfma_f32_16x16x32_bf16 v[200:203], v[88:91], v[248:251], v[200:203]
  s_add_u32 m0, s24, 16384
  ds_read_b64_tr_b16 v[62:63], v13 offset:34560
  v_mul_f32 v16, s76, v16
  v_mfma_f32_16x16x32_bf16 v[216:219], v[92:95], v[248:251], v[216:219]
  buffer_load_dwordx4 v8, s[36:39], s27 offen offset:0 lds
  v_mul_f32 v17, s76, v17
  v_mfma_f32_16x16x32_bf16 v[108:111], v[64:67], v[252:255], v[108:111]
  ds_read_b128 v[232:235], v14 offset:2048
  v_mul_f32 v18, s76, v18
  v_mfma_f32_16x16x32_bf16 v[124:127], v[68:71], v[252:255], v[124:127]
  ds_read_b128 v[236:239], v14 offset:3072
  v_mul_f32 v19, s76, v19
  v_mul_f32 v20, s76, v20
  v_mfma_f32_16x16x32_bf16 v[140:143], v[72:75], v[252:255], v[140:143]
  v_mul_f32 v21, s76, v21
  v_mul_f32 v22, s76, v22
  v_mfma_f32_16x16x32_bf16 v[156:159], v[76:79], v[252:255], v[156:159]
  v_mul_f32 v23, s76, v23
  v_cvt_pk_bf16_f32 v28, v16, v17
  v_mfma_f32_16x16x32_bf16 v[172:175], v[80:83], v[252:255], v[172:175]
  buffer_load_dwordx4 v9, s[36:39], s27 offen offset:1024 lds
  v_cvt_pk_bf16_f32 v29, v18, v19
  v_mfma_f32_16x16x32_bf16 v[188:191], v[84:87], v[252:255], v[188:191]
  v_cvt_pk_bf16_f32 v30, v20, v21
  v_cvt_pk_bf16_f32 v31, v22, v23
  v_mfma_f32_16x16x32_bf16 v[204:207], v[88:91], v[252:255], v[204:207]
  buffer_store_dwordx4 v[28:31], v2, s[40:43], s64 offen offset:3072 sc1
  v_mfma_f32_16x16x32_bf16 v[220:223], v[92:95], v[252:255], v[220:223]
  s_waitcnt vmcnt(18) lgkmcnt(0)
  v_mfma_f32_16x16x32_bf16 v[96:99], v[32:35], v[224:227], v[96:99]
  s_add_u32 s64, s64, 4096
  v_accvgpr_read_b32 v16, a224
  v_accvgpr_read_b32 v17, a225
  v_mfma_f32_16x16x32_bf16 v[112:115], v[36:39], v[224:227], v[112:115]
  ds_read_b64_tr_b16 v[64:65], v12 offset:40960
  v_accvgpr_read_b32 v18, a226
  v_mfma_f32_16x16x32_bf16 v[128:131], v[40:43], v[224:227], v[128:131]
  s_add_u32 m0, s24, 65536
  ds_read_b64_tr_b16 v[66:67], v12 offset:41984
  v_accvgpr_read_b32 v19, a227
  v_mfma_f32_16x16x32_bf16 v[144:147], v[44:47], v[224:227], v[144:147]
  buffer_load_dwordx4 v3, s[32:35], s26 offen offset:0 sc1 lds
  v_accvgpr_read_b32 v20, a228
  v_mfma_f32_16x16x32_bf16 v[160:163], v[48:51], v[224:227], v[160:163]
  ds_read_b64_tr_b16 v[68:69], v13 offset:40960
  v_accvgpr_read_b32 v21, a229
  v_mfma_f32_16x16x32_bf16 v[176:179], v[52:55], v[224:227], v[176:179]
  ds_read_b64_tr_b16 v[70:71], v13 offset:41984
  v_accvgpr_read_b32 v22, a230
  v_mfma_f32_16x16x32_bf16 v[192:195], v[56:59], v[224:227], v[192:195]
  ds_read_b64_tr_b16 v[72:73], v12 offset:41216
  v_accvgpr_read_b32 v23, a231
  v_mfma_f32_16x16x32_bf16 v[208:211], v[60:63], v[224:227], v[208:211]
  ds_read_b64_tr_b16 v[74:75], v12 offset:42240
  v_mul_f32 v16, s76, v16
  v_mfma_f32_16x16x32_bf16 v[100:103], v[32:35], v[228:231], v[100:103]
  buffer_load_dwordx4 v4, s[32:35], s26 offen offset:1024 sc1 lds
  v_mul_f32 v17, s76, v17
  v_mfma_f32_16x16x32_bf16 v[116:119], v[36:39], v[228:231], v[116:119]
  ds_read_b64_tr_b16 v[76:77], v13 offset:41216
  v_mul_f32 v18, s76, v18
  v_mfma_f32_16x16x32_bf16 v[132:135], v[40:43], v[228:231], v[132:135]
  ds_read_b64_tr_b16 v[78:79], v13 offset:42240
  v_mul_f32 v19, s76, v19
  v_mfma_f32_16x16x32_bf16 v[148:151], v[44:47], v[228:231], v[148:151]
  ds_read_b128 v[240:243], v14 offset:32768
  v_mul_f32 v20, s76, v20
  v_mfma_f32_16x16x32_bf16 v[164:167], v[48:51], v[228:231], v[164:167]
  ds_read_b128 v[244:247], v14 offset:33792
  v_mul_f32 v21, s76, v21
  v_mfma_f32_16x16x32_bf16 v[180:183], v[52:55], v[228:231], v[180:183]
  buffer_load_dwordx4 v5, s[32:35], s26 offen offset:2048 sc1 lds
  v_mul_f32 v22, s76, v22
  v_mfma_f32_16x16x32_bf16 v[196:199], v[56:59], v[228:231], v[196:199]
  ds_read_b64_tr_b16 v[80:81], v12 offset:41472
  v_mul_f32 v23, s76, v23
  v_mfma_f32_16x16x32_bf16 v[212:215], v[60:63], v[228:231], v[212:215]
  ds_read_b64_tr_b16 v[82:83], v12 offset:42496
  v_cvt_pk_bf16_f32 v24, v16, v17
  v_mfma_f32_16x16x32_bf16 v[104:107], v[32:35], v[232:235], v[104:107]
  ds_read_b64_tr_b16 v[84:85], v13 offset:41472
  v_cvt_pk_bf16_f32 v25, v18, v19
  v_mfma_f32_16x16x32_bf16 v[120:123], v[36:39], v[232:235], v[120:123]
  ds_read_b64_tr_b16 v[86:87], v13 offset:42496
  v_cvt_pk_bf16_f32 v26, v20, v21
  v_mfma_f32_16x16x32_bf16 v[136:139], v[40:43], v[232:235], v[136:139]
  buffer_load_dwordx4 v6, s[32:35], s26 offen offset:3072 sc1 lds
  v_cvt_pk_bf16_f32 v27, v22, v23
  v_mfma_f32_16x16x32_bf16 v[152:155], v[44:47], v[232:235], v[152:155]
  s_add_u32 s26, s26, 1024
  ds_read_b64_tr_b16 v[88:89], v12 offset:41728
  buffer_store_dwordx4 v[24:27], v2, s[40:43], s64 offen offset:0 sc1
  v_mfma_f32_16x16x32_bf16 v[168:171], v[48:51], v[232:235], v[168:171]
  ds_read_b64_tr_b16 v[90:91], v12 offset:42752
  v_mfma_f32_16x16x32_bf16 v[184:187], v[52:55], v[232:235], v[184:187]
  ds_read_b64_tr_b16 v[92:93], v13 offset:41728
  v_mfma_f32_16x16x32_bf16 v[200:203], v[56:59], v[232:235], v[200:203]
  s_add_u32 m0, s24, 16384
  ds_read_b64_tr_b16 v[94:95], v13 offset:42752
  v_mfma_f32_16x16x32_bf16 v[216:219], v[60:63], v[232:235], v[216:219]
  buffer_load_dwordx4 v10, s[36:39], s27 offen offset:2048 lds
  v_mfma_f32_16x16x32_bf16 v[108:111], v[32:35], v[236:239], v[108:111]
  ds_read_b128 v[248:251], v14 offset:34816
  v_mfma_f32_16x16x32_bf16 v[124:127], v[36:39], v[236:239], v[124:127]
  ds_read_b128 v[252:255], v14 offset:35840
  v_mfma_f32_16x16x32_bf16 v[140:143], v[40:43], v[236:239], v[140:143]
  v_mfma_f32_16x16x32_bf16 v[156:159], v[44:47], v[236:239], v[156:159]
  v_xor_b32 v14, 0x10000, v14
  v_mfma_f32_16x16x32_bf16 v[172:175], v[48:51], v[236:239], v[172:175]
  buffer_load_dwordx4 v11, s[36:39], s27 offen offset:3072 lds
  v_mfma_f32_16x16x32_bf16 v[188:191], v[52:55], v[236:239], v[188:191]
  s_add_u32 s27, s27, 524288
  v_xor_b32 v12, 0x10000, v12
  v_mfma_f32_16x16x32_bf16 v[204:207], v[56:59], v[236:239], v[204:207]
  v_xor_b32 v13, 0x10000, v13
  v_mfma_f32_16x16x32_bf16 v[220:223], v[60:63], v[236:239], v[220:223]
  s_waitcnt vmcnt(16) lgkmcnt(0)
  v_mfma_f32_16x16x32_bf16 v[96:99], v[64:67], v[240:243], v[96:99]
  s_barrier
  v_accvgpr_read_b32 v16, a232
  v_accvgpr_read_b32 v17, a233
  v_mfma_f32_16x16x32_bf16 v[112:115], v[68:71], v[240:243], v[112:115]
  ds_read_b64_tr_b16 v[32:33], v12 offset:0
  v_accvgpr_read_b32 v18, a234
  v_mfma_f32_16x16x32_bf16 v[128:131], v[72:75], v[240:243], v[128:131]
  s_add_u32 m0, s24, 98304
  ds_read_b64_tr_b16 v[34:35], v12 offset:1024
  v_accvgpr_read_b32 v19, a235
  v_mfma_f32_16x16x32_bf16 v[144:147], v[76:79], v[240:243], v[144:147]
  buffer_load_dwordx4 v3, s[32:35], s26 offen offset:0 sc1 lds
  v_accvgpr_read_b32 v20, a236
  v_mfma_f32_16x16x32_bf16 v[160:163], v[80:83], v[240:243], v[160:163]
  ds_read_b64_tr_b16 v[36:37], v13 offset:0
  v_accvgpr_read_b32 v21, a237
  v_mfma_f32_16x16x32_bf16 v[176:179], v[84:87], v[240:243], v[176:179]
  ds_read_b64_tr_b16 v[38:39], v13 offset:1024
  v_accvgpr_read_b32 v22, a238
  v_mfma_f32_16x16x32_bf16 v[192:195], v[88:91], v[240:243], v[192:195]
  ds_read_b64_tr_b16 v[40:41], v12 offset:256
  v_accvgpr_read_b32 v23, a239
  v_mfma_f32_16x16x32_bf16 v[208:211], v[92:95], v[240:243], v[208:211]
  ds_read_b64_tr_b16 v[42:43], v12 offset:1280
  v_mul_f32 v16, s76, v16
  v_mfma_f32_16x16x32_bf16 v[100:103], v[64:67], v[244:247], v[100:103]
  buffer_load_dwordx4 v4, s[32:35], s26 offen offset:1024 sc1 lds
  v_mul_f32 v17, s76, v17
  v_mfma_f32_16x16x32_bf16 v[116:119], v[68:71], v[244:247], v[116:119]
  ds_read_b64_tr_b16 v[44:45], v13 offset:256
  v_mul_f32 v18, s76, v18
  v_mfma_f32_16x16x32_bf16 v[132:135], v[72:75], v[244:247], v[132:135]
  ds_read_b64_tr_b16 v[46:47], v13 offset:1280
  v_mul_f32 v19, s76, v19
  v_mfma_f32_16x16x32_bf16 v[148:151], v[76:79], v[244:247], v[148:151]
  ds_read_b128 v[224:227], v14 offset:0
  v_mul_f32 v20, s76, v20
  v_mfma_f32_16x16x32_bf16 v[164:167], v[80:83], v[244:247], v[164:167]
  ds_read_b128 v[228:231], v14 offset:1024
  v_mul_f32 v21, s76, v21
  v_mfma_f32_16x16x32_bf16 v[180:183], v[84:87], v[244:247], v[180:183]
  buffer_load_dwordx4 v5, s[32:35], s26 offen offset:2048 sc1 lds
  v_mul_f32 v22, s76, v22
  v_mfma_f32_16x16x32_bf16 v[196:199], v[88:91], v[244:247], v[196:199]
  ds_read_b64_tr_b16 v[48:49], v12 offset:512
  v_mul_f32 v23, s76, v23
  v_mfma_f32_16x16x32_bf16 v[212:215], v[92:95], v[244:247], v[212:215]
  ds_read_b64_tr_b16 v[50:51], v12 offset:1536
  v_cvt_pk_bf16_f32 v28, v16, v17
  v_mfma_f32_16x16x32_bf16 v[104:107], v[64:67], v[248:251], v[104:107]
  ds_read_b64_tr_b16 v[52:53], v13 offset:512
  v_cvt_pk_bf16_f32 v29, v18, v19
  v_mfma_f32_16x16x32_bf16 v[120:123], v[68:71], v[248:251], v[120:123]
  ds_read_b64_tr_b16 v[54:55], v13 offset:1536
  v_cvt_pk_bf16_f32 v30, v20, v21
  v_mfma_f32_16x16x32_bf16 v[136:139], v[72:75], v[248:251], v[136:139]
  buffer_load_dwordx4 v6, s[32:35], s26 offen offset:3072 sc1 lds
  v_cvt_pk_bf16_f32 v31, v22, v23
  v_mfma_f32_16x16x32_bf16 v[152:155], v[76:79], v[248:251], v[152:155]
  s_add_u32 s26, s26, 1024
  ds_read_b64_tr_b16 v[56:57], v12 offset:768
  buffer_store_dwordx4 v[28:31], v2, s[40:43], s64 offen offset:1024 sc1
  v_mfma_f32_16x16x32_bf16 v[168:171], v[80:83], v[248:251], v[168:171]
  ds_read_b64_tr_b16 v[58:59], v12 offset:1792
  v_mfma_f32_16x16x32_bf16 v[184:187], v[84:87], v[248:251], v[184:187]
  ds_read_b64_tr_b16 v[60:61], v13 offset:768
  v_mfma_f32_16x16x32_bf16 v[200:203], v[88:91], v[248:251], v[200:203]
  s_add_u32 m0, s24, 49152
  ds_read_b64_tr_b16 v[62:63], v13 offset:1792
  v_mfma_f32_16x16x32_bf16 v[216:219], v[92:95], v[248:251], v[216:219]
  buffer_load_dwordx4 v8, s[36:39], s27 offen offset:0 lds
  v_mfma_f32_16x16x32_bf16 v[108:111], v[64:67], v[252:255], v[108:111]
  ds_read_b128 v[232:235], v14 offset:2048
  v_mfma_f32_16x16x32_bf16 v[124:127], v[68:71], v[252:255], v[124:127]
  ds_read_b128 v[236:239], v14 offset:3072
  v_mfma_f32_16x16x32_bf16 v[140:143], v[72:75], v[252:255], v[140:143]
  v_mfma_f32_16x16x32_bf16 v[156:159], v[76:79], v[252:255], v[156:159]
  v_mfma_f32_16x16x32_bf16 v[172:175], v[80:83], v[252:255], v[172:175]
  buffer_load_dwordx4 v9, s[36:39], s27 offen offset:1024 lds
  v_mfma_f32_16x16x32_bf16 v[188:191], v[84:87], v[252:255], v[188:191]
  v_mfma_f32_16x16x32_bf16 v[204:207], v[88:91], v[252:255], v[204:207]
  v_mfma_f32_16x16x32_bf16 v[220:223], v[92:95], v[252:255], v[220:223]
  s_waitcnt vmcnt(17) lgkmcnt(0)
  v_mfma_f32_16x16x32_bf16 v[96:99], v[32:35], v[224:227], v[96:99]
  v_accvgpr_read_b32 v16, a240
  v_accvgpr_read_b32 v17, a241
  v_mfma_f32_16x16x32_bf16 v[112:115], v[36:39], v[224:227], v[112:115]
  ds_read_b64_tr_b16 v[64:65], v12 offset:8192
  v_accvgpr_read_b32 v18, a242
  v_mfma_f32_16x16x32_bf16 v[128:131], v[40:43], v[224:227], v[128:131]
  s_add_u32 m0, s24, 0
  ds_read_b64_tr_b16 v[66:67], v12 offset:9216
  v_accvgpr_read_b32 v19, a243
  v_mfma_f32_16x16x32_bf16 v[144:147], v[44:47], v[224:227], v[144:147]
  buffer_load_dwordx4 v3, s[32:35], s26 offen offset:0 sc1 lds
  v_accvgpr_read_b32 v20, a244
  v_mfma_f32_16x16x32_bf16 v[160:163], v[48:51], v[224:227], v[160:163]
  ds_read_b64_tr_b16 v[68:69], v13 offset:8192
  v_accvgpr_read_b32 v21, a245
  v_mfma_f32_16x16x32_bf16 v[176:179], v[52:55], v[224:227], v[176:179]
  ds_read_b64_tr_b16 v[70:71], v13 offset:9216
  v_accvgpr_read_b32 v22, a246
  v_mfma_f32_16x16x32_bf16 v[192:195], v[56:59], v[224:227], v[192:195]
  ds_read_b64_tr_b16 v[72:73], v12 offset:8448
  v_accvgpr_read_b32 v23, a247
  v_mfma_f32_16x16x32_bf16 v[208:211], v[60:63], v[224:227], v[208:211]
  ds_read_b64_tr_b16 v[74:75], v12 offset:9472
  v_mul_f32 v16, s76, v16
  v_mfma_f32_16x16x32_bf16 v[100:103], v[32:35], v[228:231], v[100:103]
  buffer_load_dwordx4 v4, s[32:35], s26 offen offset:1024 sc1 lds
  v_mul_f32 v17, s76, v17
  v_mfma_f32_16x16x32_bf16 v[116:119], v[36:39], v[228:231], v[116:119]
  ds_read_b64_tr_b16 v[76:77], v13 offset:8448
  v_mul_f32 v18, s76, v18
  v_mfma_f32_16x16x32_bf16 v[132:135], v[40:43], v[228:231], v[132:135]
  ds_read_b64_tr_b16 v[78:79], v13 offset:9472
  v_mul_f32 v19, s76, v19
  v_mfma_f32_16x16x32_bf16 v[148:151], v[44:47], v[228:231], v[148:151]
  ds_read_b128 v[240:243], v14 offset:32768
  v_mul_f32 v20, s76, v20
  v_mfma_f32_16x16x32_bf16 v[164:167], v[48:51], v[228:231], v[164:167]
  ds_read_b128 v[244:247], v14 offset:33792
  v_mul_f32 v21, s76, v21
  v_mfma_f32_16x16x32_bf16 v[180:183], v[52:55], v[228:231], v[180:183]
  buffer_load_dwordx4 v5, s[32:35], s26 offen offset:2048 sc1 lds
  v_mul_f32 v22, s76, v22
  v_mfma_f32_16x16x32_bf16 v[196:199], v[56:59], v[228:231], v[196:199]
  ds_read_b64_tr_b16 v[80:81], v12 offset:8704
  v_mul_f32 v23, s76, v23
  v_mfma_f32_16x16x32_bf16 v[212:215], v[60:63], v[228:231], v[212:215]
  ds_read_b64_tr_b16 v[82:83], v12 offset:9728
  v_cvt_pk_bf16_f32 v24, v16, v17
  v_mfma_f32_16x16x32_bf16 v[104:107], v[32:35], v[232:235], v[104:107]
  ds_read_b64_tr_b16 v[84:85], v13 offset:8704
  v_cvt_pk_bf16_f32 v25, v18, v19
  v_mfma_f32_16x16x32_bf16 v[120:123], v[36:39], v[232:235], v[120:123]
  ds_read_b64_tr_b16 v[86:87], v13 offset:9728
  v_cvt_pk_bf16_f32 v26, v20, v21
  v_mfma_f32_16x16x32_bf16 v[136:139], v[40:43], v[232:235], v[136:139]
  buffer_load_dwordx4 v6, s[32:35], s26 offen offset:3072 sc1 lds
  v_cvt_pk_bf16_f32 v27, v22, v23
  v_mfma_f32_16x16x32_bf16 v[152:155], v[44:47], v[232:235], v[152:155]
  s_add_u32 s26, s26, 1024
  ds_read_b64_tr_b16 v[88:89], v12 offset:8960
  buffer_store_dwordx4 v[24:27], v2, s[40:43], s64 offen offset:2048 sc1
  v_mfma_f32_16x16x32_bf16 v[168:171], v[48:51], v[232:235], v[168:171]
  ds_read_b64_tr_b16 v[90:91], v12 offset:9984
  v_mfma_f32_16x16x32_bf16 v[184:187], v[52:55], v[232:235], v[184:187]
  ds_read_b64_tr_b16 v[92:93], v13 offset:8960
  v_mfma_f32_16x16x32_bf16 v[200:203], v[56:59], v[232:235], v[200:203]
  s_add_u32 m0, s24, 49152
  ds_read_b64_tr_b16 v[94:95], v13 offset:9984
  v_mfma_f32_16x16x32_bf16 v[216:219], v[60:63], v[232:235], v[216:219]
  buffer_load_dwordx4 v10, s[36:39], s27 offen offset:2048 lds
  v_mfma_f32_16x16x32_bf16 v[108:111], v[32:35], v[236:239], v[108:111]
  ds_read_b128 v[248:251], v14 offset:34816
  v_mfma_f32_16x16x32_bf16 v[124:127], v[36:39], v[236:239], v[124:127]
  ds_read_b128 v[252:255], v14 offset:35840
  v_mfma_f32_16x16x32_bf16 v[140:143], v[40:43], v[236:239], v[140:143]
  v_mfma_f32_16x16x32_bf16 v[156:159], v[44:47], v[236:239], v[156:159]
  v_xor_b32 v14, 0x10000, v14
  v_mfma_f32_16x16x32_bf16 v[172:175], v[48:51], v[236:239], v[172:175]
  buffer_load_dwordx4 v11, s[36:39], s27 offen offset:3072 lds
  v_mfma_f32_16x16x32_bf16 v[188:191], v[52:55], v[236:239], v[188:191]
  s_add_u32 s27, s27, 524288
  v_mfma_f32_16x16x32_bf16 v[204:207], v[56:59], v[236:239], v[204:207]
  v_mfma_f32_16x16x32_bf16 v[220:223], v[60:63], v[236:239], v[220:223]
  s_waitcnt vmcnt(17) lgkmcnt(0)
  v_mfma_f32_16x16x32_bf16 v[96:99], v[64:67], v[240:243], v[96:99]
  s_barrier
  v_accvgpr_read_b32 v16, a248
  v_accvgpr_read_b32 v17, a249
  v_mfma_f32_16x16x32_bf16 v[112:115], v[68:71], v[240:243], v[112:115]
  ds_read_b64_tr_b16 v[32:33], v12 offset:32768
  v_accvgpr_read_b32 v18, a250
  v_mfma_f32_16x16x32_bf16 v[128:131], v[72:75], v[240:243], v[128:131]
  s_add_u32 m0, s24, 32768
  ds_read_b64_tr_b16 v[34:35], v12 offset:33792
  v_accvgpr_read_b32 v19, a251
  v_mfma_f32_16x16x32_bf16 v[144:147], v[76:79], v[240:243], v[144:147]
  buffer_load_dwordx4 v3, s[32:35], s26 offen offset:0 sc1 lds
  v_accvgpr_read_b32 v20, a252
  v_mfma_f32_16x16x32_bf16 v[160:163], v[80:83], v[240:243], v[160:163]
  ds_read_b64_tr_b16 v[36:37], v13 offset:32768
  v_accvgpr_read_b32 v21, a253
  v_mfma_f32_16x16x32_bf16 v[176:179], v[84:87], v[240:243], v[176:179]
  ds_read_b64_tr_b16 v[38:39], v13 offset:33792
  v_accvgpr_read_b32 v22, a254
  v_mfma_f32_16x16x32_bf16 v[192:195], v[88:91], v[240:243], v[192:195]
  ds_read_b64_tr_b16 v[40:41], v12 offset:33024
  v_accvgpr_read_b32 v23, a255
  v_mfma_f32_16x16x32_bf16 v[208:211], v[92:95], v[240:243], v[208:211]
  ds_read_b64_tr_b16 v[42:43], v12 offset:34048
  v_mul_f32 v16, s76, v16
  v_mfma_f32_16x16x32_bf16 v[100:103], v[64:67], v[244:247], v[100:103]
  buffer_load_dwordx4 v4, s[32:35], s26 offen offset:1024 sc1 lds
  v_mul_f32 v17, s76, v17
  v_mfma_f32_16x16x32_bf16 v[116:119], v[68:71], v[244:247], v[116:119]
  ds_read_b64_tr_b16 v[44:45], v13 offset:33024
  v_mul_f32 v18, s76, v18
  v_mfma_f32_16x16x32_bf16 v[132:135], v[72:75], v[244:247], v[132:135]
  ds_read_b64_tr_b16 v[46:47], v13 offset:34048
  v_mul_f32 v19, s76, v19
  v_mfma_f32_16x16x32_bf16 v[148:151], v[76:79], v[244:247], v[148:151]
  ds_read_b128 v[224:227], v14 offset:0
  v_mul_f32 v20, s76, v20
  v_mfma_f32_16x16x32_bf16 v[164:167], v[80:83], v[244:247], v[164:167]
  ds_read_b128 v[228:231], v14 offset:1024
  v_mul_f32 v21, s76, v21
  v_mfma_f32_16x16x32_bf16 v[180:183], v[84:87], v[244:247], v[180:183]
  buffer_load_dwordx4 v5, s[32:35], s26 offen offset:2048 sc1 lds
  v_mul_f32 v22, s76, v22
  v_mfma_f32_16x16x32_bf16 v[196:199], v[88:91], v[244:247], v[196:199]
  ds_read_b64_tr_b16 v[48:49], v12 offset:33280
  v_mul_f32 v23, s76, v23
  v_mfma_f32_16x16x32_bf16 v[212:215], v[92:95], v[244:247], v[212:215]
  ds_read_b64_tr_b16 v[50:51], v12 offset:34304
  v_cvt_pk_bf16_f32 v28, v16, v17
  v_mfma_f32_16x16x32_bf16 v[104:107], v[64:67], v[248:251], v[104:107]
  ds_read_b64_tr_b16 v[52:53], v13 offset:33280
  v_cvt_pk_bf16_f32 v29, v18, v19
  v_mfma_f32_16x16x32_bf16 v[120:123], v[68:71], v[248:251], v[120:123]
  ds_read_b64_tr_b16 v[54:55], v13 offset:34304
  v_cvt_pk_bf16_f32 v30, v20, v21
  v_mfma_f32_16x16x32_bf16 v[136:139], v[72:75], v[248:251], v[136:139]
  buffer_load_dwordx4 v6, s[32:35], s26 offen offset:3072 sc1 lds
  v_cvt_pk_bf16_f32 v31, v22, v23
  v_mfma_f32_16x16x32_bf16 v[152:155], v[76:79], v[248:251], v[152:155]
  s_add_u32 s26, s26, 1024
  ds_read_b64_tr_b16 v[56:57], v12 offset:33536
  buffer_store_dwordx4 v[28:31], v2, s[40:43], s64 offen offset:3072 sc1
  v_mfma_f32_16x16x32_bf16 v[168:171], v[80:83], v[248:251], v[168:171]
  ds_read_b64_tr_b16 v[58:59], v12 offset:34560
  v_mfma_f32_16x16x32_bf16 v[184:187], v[84:87], v[248:251], v[184:187]
  ds_read_b64_tr_b16 v[60:61], v13 offset:33536
  v_mfma_f32_16x16x32_bf16 v[200:203], v[88:91], v[248:251], v[200:203]
  s_add_u32 m0, s24, 81920
  ds_read_b64_tr_b16 v[62:63], v13 offset:34560
  v_mfma_f32_16x16x32_bf16 v[216:219], v[92:95], v[248:251], v[216:219]
  buffer_load_dwordx4 v8, s[36:39], s27 offen offset:0 lds
  v_mfma_f32_16x16x32_bf16 v[108:111], v[64:67], v[252:255], v[108:111]
  ds_read_b128 v[232:235], v14 offset:2048
  v_mfma_f32_16x16x32_bf16 v[124:127], v[68:71], v[252:255], v[124:127]
  ds_read_b128 v[236:239], v14 offset:3072
  v_mfma_f32_16x16x32_bf16 v[140:143], v[72:75], v[252:255], v[140:143]
  v_mfma_f32_16x16x32_bf16 v[156:159], v[76:79], v[252:255], v[156:159]
  v_mfma_f32_16x16x32_bf16 v[172:175], v[80:83], v[252:255], v[172:175]
  buffer_load_dwordx4 v9, s[36:39], s27 offen offset:1024 lds
  v_mfma_f32_16x16x32_bf16 v[188:191], v[84:87], v[252:255], v[188:191]
  v_mfma_f32_16x16x32_bf16 v[204:207], v[88:91], v[252:255], v[204:207]
  v_mfma_f32_16x16x32_bf16 v[220:223], v[92:95], v[252:255], v[220:223]
  s_waitcnt vmcnt(17) lgkmcnt(0)
  v_mfma_f32_16x16x32_bf16 v[96:99], v[32:35], v[224:227], v[96:99]
  s_add_u32 s64, s64, 126976
  v_accvgpr_read_b32 v16, a0
  v_accvgpr_read_b32 v17, a1
  v_mfma_f32_16x16x32_bf16 v[112:115], v[36:39], v[224:227], v[112:115]
  ds_read_b64_tr_b16 v[64:65], v12 offset:40960
  v_accvgpr_read_b32 v18, a2
  v_mfma_f32_16x16x32_bf16 v[128:131], v[40:43], v[224:227], v[128:131]
  s_add_u32 m0, s24, 65536
  ds_read_b64_tr_b16 v[66:67], v12 offset:41984
  v_accvgpr_read_b32 v19, a3
  v_mfma_f32_16x16x32_bf16 v[144:147], v[44:47], v[224:227], v[144:147]
  buffer_load_dwordx4 v3, s[32:35], s26 offen offset:0 sc1 lds
  v_accvgpr_read_b32 v20, a4
  v_mfma_f32_16x16x32_bf16 v[160:163], v[48:51], v[224:227], v[160:163]
  ds_read_b64_tr_b16 v[68:69], v13 offset:40960
  v_accvgpr_read_b32 v21, a5
  v_mfma_f32_16x16x32_bf16 v[176:179], v[52:55], v[224:227], v[176:179]
  ds_read_b64_tr_b16 v[70:71], v13 offset:41984
  v_accvgpr_read_b32 v22, a6
  v_mfma_f32_16x16x32_bf16 v[192:195], v[56:59], v[224:227], v[192:195]
  ds_read_b64_tr_b16 v[72:73], v12 offset:41216
  v_accvgpr_read_b32 v23, a7
  v_mfma_f32_16x16x32_bf16 v[208:211], v[60:63], v[224:227], v[208:211]
  ds_read_b64_tr_b16 v[74:75], v12 offset:42240
  v_mul_f32 v16, s76, v16
  v_mfma_f32_16x16x32_bf16 v[100:103], v[32:35], v[228:231], v[100:103]
  buffer_load_dwordx4 v4, s[32:35], s26 offen offset:1024 sc1 lds
  v_mul_f32 v17, s76, v17
  v_mfma_f32_16x16x32_bf16 v[116:119], v[36:39], v[228:231], v[116:119]
  ds_read_b64_tr_b16 v[76:77], v13 offset:41216
  v_mul_f32 v18, s76, v18
  v_mfma_f32_16x16x32_bf16 v[132:135], v[40:43], v[228:231], v[132:135]
  ds_read_b64_tr_b16 v[78:79], v13 offset:42240
  v_mul_f32 v19, s76, v19
  v_mfma_f32_16x16x32_bf16 v[148:151], v[44:47], v[228:231], v[148:151]
  ds_read_b128 v[240:243], v14 offset:32768
  v_mul_f32 v20, s76, v20
  v_mfma_f32_16x16x32_bf16 v[164:167], v[48:51], v[228:231], v[164:167]
  ds_read_b128 v[244:247], v14 offset:33792
  v_mul_f32 v21, s76, v21
  v_mfma_f32_16x16x32_bf16 v[180:183], v[52:55], v[228:231], v[180:183]
  buffer_load_dwordx4 v5, s[32:35], s26 offen offset:2048 sc1 lds
  v_mul_f32 v22, s76, v22
  v_mfma_f32_16x16x32_bf16 v[196:199], v[56:59], v[228:231], v[196:199]
  ds_read_b64_tr_b16 v[80:81], v12 offset:41472
  v_mul_f32 v23, s76, v23
  v_mfma_f32_16x16x32_bf16 v[212:215], v[60:63], v[228:231], v[212:215]
  ds_read_b64_tr_b16 v[82:83], v12 offset:42496
  v_cvt_pk_bf16_f32 v24, v16, v17
  v_mfma_f32_16x16x32_bf16 v[104:107], v[32:35], v[232:235], v[104:107]
  ds_read_b64_tr_b16 v[84:85], v13 offset:41472
  v_cvt_pk_bf16_f32 v25, v18, v19
  v_mfma_f32_16x16x32_bf16 v[120:123], v[36:39], v[232:235], v[120:123]
  ds_read_b64_tr_b16 v[86:87], v13 offset:42496
  v_cvt_pk_bf16_f32 v26, v20, v21
  v_mfma_f32_16x16x32_bf16 v[136:139], v[40:43], v[232:235], v[136:139]
  buffer_load_dwordx4 v6, s[32:35], s26 offen offset:3072 sc1 lds
  v_cvt_pk_bf16_f32 v27, v22, v23
  v_mfma_f32_16x16x32_bf16 v[152:155], v[44:47], v[232:235], v[152:155]
  s_add_u32 s26, s26, 1024
  ds_read_b64_tr_b16 v[88:89], v12 offset:41728
  buffer_store_dwordx4 v[24:27], v2, s[40:43], s64 offen offset:0 sc1
  v_mfma_f32_16x16x32_bf16 v[168:171], v[48:51], v[232:235], v[168:171]
  ds_read_b64_tr_b16 v[90:91], v12 offset:42752
  v_mfma_f32_16x16x32_bf16 v[184:187], v[52:55], v[232:235], v[184:187]
  ds_read_b64_tr_b16 v[92:93], v13 offset:41728
  v_mfma_f32_16x16x32_bf16 v[200:203], v[56:59], v[232:235], v[200:203]
  s_add_u32 m0, s24, 81920
  ds_read_b64_tr_b16 v[94:95], v13 offset:42752
  v_mfma_f32_16x16x32_bf16 v[216:219], v[60:63], v[232:235], v[216:219]
  buffer_load_dwordx4 v10, s[36:39], s27 offen offset:2048 lds
  v_mfma_f32_16x16x32_bf16 v[108:111], v[32:35], v[236:239], v[108:111]
  ds_read_b128 v[248:251], v14 offset:34816
  v_mfma_f32_16x16x32_bf16 v[124:127], v[36:39], v[236:239], v[124:127]
  ds_read_b128 v[252:255], v14 offset:35840
  v_mfma_f32_16x16x32_bf16 v[140:143], v[40:43], v[236:239], v[140:143]
  v_mfma_f32_16x16x32_bf16 v[156:159], v[44:47], v[236:239], v[156:159]
  v_xor_b32 v14, 0x10000, v14
  v_mfma_f32_16x16x32_bf16 v[172:175], v[48:51], v[236:239], v[172:175]
  buffer_load_dwordx4 v11, s[36:39], s27 offen offset:3072 lds
  v_mfma_f32_16x16x32_bf16 v[188:191], v[52:55], v[236:239], v[188:191]
  s_add_u32 s27, s27, 524288
  v_xor_b32 v12, 0x10000, v12
  v_mfma_f32_16x16x32_bf16 v[204:207], v[56:59], v[236:239], v[204:207]
  v_xor_b32 v13, 0x10000, v13
  v_mfma_f32_16x16x32_bf16 v[220:223], v[60:63], v[236:239], v[220:223]
  s_waitcnt vmcnt(9) lgkmcnt(0)
  v_mfma_f32_16x16x32_bf16 v[96:99], v[64:67], v[240:243], v[96:99]
  s_barrier
  buffer_store_dword v12, off, s[40:43], s65 sc1
  v_accvgpr_read_b32 v16, a8
  v_mfma_f32_16x16x32_bf16 v[112:115], v[68:71], v[240:243], v[112:115]
  ds_read_b64_tr_b16 v[32:33], v12 offset:0
  v_accvgpr_read_b32 v17, a9
  v_mfma_f32_16x16x32_bf16 v[128:131], v[72:75], v[240:243], v[128:131]
  s_add_u32 m0, s24, 98304
  ds_read_b64_tr_b16 v[34:35], v12 offset:1024
  v_accvgpr_read_b32 v18, a10
  v_mfma_f32_16x16x32_bf16 v[144:147], v[76:79], v[240:243], v[144:147]
  buffer_load_dwordx4 v3, s[32:35], s26 offen offset:0 sc1 lds
  v_accvgpr_read_b32 v19, a11
  v_mfma_f32_16x16x32_bf16 v[160:163], v[80:83], v[240:243], v[160:163]
  ds_read_b64_tr_b16 v[36:37], v13 offset:0
  v_accvgpr_read_b32 v20, a12
  v_mfma_f32_16x16x32_bf16 v[176:179], v[84:87], v[240:243], v[176:179]
  ds_read_b64_tr_b16 v[38:39], v13 offset:1024
  v_accvgpr_read_b32 v21, a13
  v_mfma_f32_16x16x32_bf16 v[192:195], v[88:91], v[240:243], v[192:195]
  ds_read_b64_tr_b16 v[40:41], v12 offset:256
  v_accvgpr_read_b32 v22, a14
  v_mfma_f32_16x16x32_bf16 v[208:211], v[92:95], v[240:243], v[208:211]
  ds_read_b64_tr_b16 v[42:43], v12 offset:1280
  v_accvgpr_read_b32 v23, a15
  v_mfma_f32_16x16x32_bf16 v[100:103], v[64:67], v[244:247], v[100:103]
  buffer_load_dwordx4 v4, s[32:35], s26 offen offset:1024 sc1 lds
  v_mul_f32 v16, s76, v16
  v_mfma_f32_16x16x32_bf16 v[116:119], v[68:71], v[244:247], v[116:119]
  ds_read_b64_tr_b16 v[44:45], v13 offset:256
  v_mul_f32 v17, s76, v17
  v_mfma_f32_16x16x32_bf16 v[132:135], v[72:75], v[244:247], v[132:135]
  ds_read_b64_tr_b16 v[46:47], v13 offset:1280
  v_mul_f32 v18, s76, v18
  v_mfma_f32_16x16x32_bf16 v[148:151], v[76:79], v[244:247], v[148:151]
  ds_read_b128 v[224:227], v14 offset:0
  v_mul_f32 v19, s76, v19
  v_mfma_f32_16x16x32_bf16 v[164:167], v[80:83], v[244:247], v[164:167]
  ds_read_b128 v[228:231], v14 offset:1024
  v_mul_f32 v20, s76, v20
  v_mfma_f32_16x16x32_bf16 v[180:183], v[84:87], v[244:247], v[180:183]
  buffer_load_dwordx4 v5, s[32:35], s26 offen offset:2048 sc1 lds
  v_mul_f32 v21, s76, v21
  v_mfma_f32_16x16x32_bf16 v[196:199], v[88:91], v[244:247], v[196:199]
  ds_read_b64_tr_b16 v[48:49], v12 offset:512
  v_mul_f32 v22, s76, v22
  v_mfma_f32_16x16x32_bf16 v[212:215], v[92:95], v[244:247], v[212:215]
  ds_read_b64_tr_b16 v[50:51], v12 offset:1536
  v_mul_f32 v23, s76, v23
  v_mfma_f32_16x16x32_bf16 v[104:107], v[64:67], v[248:251], v[104:107]
  ds_read_b64_tr_b16 v[52:53], v13 offset:512
  v_cvt_pk_bf16_f32 v28, v16, v17
  v_mfma_f32_16x16x32_bf16 v[120:123], v[68:71], v[248:251], v[120:123]
  ds_read_b64_tr_b16 v[54:55], v13 offset:1536
  v_cvt_pk_bf16_f32 v29, v18, v19
  v_mfma_f32_16x16x32_bf16 v[136:139], v[72:75], v[248:251], v[136:139]
  buffer_load_dwordx4 v6, s[32:35], s26 offen offset:3072 sc1 lds
  v_cvt_pk_bf16_f32 v30, v20, v21
  v_mfma_f32_16x16x32_bf16 v[152:155], v[76:79], v[248:251], v[152:155]
  s_add_u32 s26, s26, 1024
  ds_read_b64_tr_b16 v[56:57], v12 offset:768
  v_cvt_pk_bf16_f32 v31, v22, v23
  v_mfma_f32_16x16x32_bf16 v[168:171], v[80:83], v[248:251], v[168:171]
  ds_read_b64_tr_b16 v[58:59], v12 offset:1792
  buffer_store_dwordx4 v[28:31], v2, s[40:43], s64 offen offset:1024 sc1
  v_mfma_f32_16x16x32_bf16 v[184:187], v[84:87], v[248:251], v[184:187]
  ds_read_b64_tr_b16 v[60:61], v13 offset:768
  v_mfma_f32_16x16x32_bf16 v[200:203], v[88:91], v[248:251], v[200:203]
  s_add_u32 m0, s24, 114688
  ds_read_b64_tr_b16 v[62:63], v13 offset:1792
  v_mfma_f32_16x16x32_bf16 v[216:219], v[92:95], v[248:251], v[216:219]
  buffer_load_dwordx4 v8, s[36:39], s27 offen offset:0 lds
  v_mfma_f32_16x16x32_bf16 v[108:111], v[64:67], v[252:255], v[108:111]
  ds_read_b128 v[232:235], v14 offset:2048
  v_mfma_f32_16x16x32_bf16 v[124:127], v[68:71], v[252:255], v[124:127]
  ds_read_b128 v[236:239], v14 offset:3072
  v_mfma_f32_16x16x32_bf16 v[140:143], v[72:75], v[252:255], v[140:143]
  v_mfma_f32_16x16x32_bf16 v[156:159], v[76:79], v[252:255], v[156:159]
  v_mfma_f32_16x16x32_bf16 v[172:175], v[80:83], v[252:255], v[172:175]
  buffer_load_dwordx4 v9, s[36:39], s27 offen offset:1024 lds
  v_mfma_f32_16x16x32_bf16 v[188:191], v[84:87], v[252:255], v[188:191]
  v_mfma_f32_16x16x32_bf16 v[204:207], v[88:91], v[252:255], v[204:207]
  v_mfma_f32_16x16x32_bf16 v[220:223], v[92:95], v[252:255], v[220:223]
  s_waitcnt vmcnt(18) lgkmcnt(0)
  v_mfma_f32_16x16x32_bf16 v[96:99], v[32:35], v[224:227], v[96:99]
  v_accvgpr_read_b32 v16, a16
  v_accvgpr_read_b32 v17, a17
  v_mfma_f32_16x16x32_bf16 v[112:115], v[36:39], v[224:227], v[112:115]
  ds_read_b64_tr_b16 v[64:65], v12 offset:8192
  v_accvgpr_read_b32 v18, a18
  v_mfma_f32_16x16x32_bf16 v[128:131], v[40:43], v[224:227], v[128:131]
  s_add_u32 m0, s24, 0
  ds_read_b64_tr_b16 v[66:67], v12 offset:9216
  v_accvgpr_read_b32 v19, a19
  v_mfma_f32_16x16x32_bf16 v[144:147], v[44:47], v[224:227], v[144:147]
  buffer_load_dwordx4 v3, s[32:35], s26 offen offset:0 sc1 lds
  v_accvgpr_read_b32 v20, a20
  v_mfma_f32_16x16x32_bf16 v[160:163], v[48:51], v[224:227], v[160:163]
  ds_read_b64_tr_b16 v[68:69], v13 offset:8192
  v_accvgpr_read_b32 v21, a21
  v_mfma_f32_16x16x32_bf16 v[176:179], v[52:55], v[224:227], v[176:179]
  ds_read_b64_tr_b16 v[70:71], v13 offset:9216
  v_accvgpr_read_b32 v22, a22
  v_mfma_f32_16x16x32_bf16 v[192:195], v[56:59], v[224:227], v[192:195]
  ds_read_b64_tr_b16 v[72:73], v12 offset:8448
  v_accvgpr_read_b32 v23, a23
  v_mfma_f32_16x16x32_bf16 v[208:211], v[60:63], v[224:227], v[208:211]
  ds_read_b64_tr_b16 v[74:75], v12 offset:9472
  v_mul_f32 v16, s76, v16
  v_mfma_f32_16x16x32_bf16 v[100:103], v[32:35], v[228:231], v[100:103]
  buffer_load_dwordx4 v4, s[32:35], s26 offen offset:1024 sc1 lds
  v_mul_f32 v17, s76, v17
  v_mfma_f32_16x16x32_bf16 v[116:119], v[36:39], v[228:231], v[116:119]
  ds_read_b64_tr_b16 v[76:77], v13 offset:8448
  v_mul_f32 v18, s76, v18
  v_mfma_f32_16x16x32_bf16 v[132:135], v[40:43], v[228:231], v[132:135]
  ds_read_b64_tr_b16 v[78:79], v13 offset:9472
  v_mul_f32 v19, s76, v19
  v_mfma_f32_16x16x32_bf16 v[148:151], v[44:47], v[228:231], v[148:151]
  ds_read_b128 v[240:243], v14 offset:32768
  v_mul_f32 v20, s76, v20
  v_mfma_f32_16x16x32_bf16 v[164:167], v[48:51], v[228:231], v[164:167]
  ds_read_b128 v[244:247], v14 offset:33792
  v_mul_f32 v21, s76, v21
  v_mfma_f32_16x16x32_bf16 v[180:183], v[52:55], v[228:231], v[180:183]
  buffer_load_dwordx4 v5, s[32:35], s26 offen offset:2048 sc1 lds
  v_mul_f32 v22, s76, v22
  v_mfma_f32_16x16x32_bf16 v[196:199], v[56:59], v[228:231], v[196:199]
  ds_read_b64_tr_b16 v[80:81], v12 offset:8704
  v_mul_f32 v23, s76, v23
  v_mfma_f32_16x16x32_bf16 v[212:215], v[60:63], v[228:231], v[212:215]
  ds_read_b64_tr_b16 v[82:83], v12 offset:9728
  v_cvt_pk_bf16_f32 v24, v16, v17
  v_mfma_f32_16x16x32_bf16 v[104:107], v[32:35], v[232:235], v[104:107]
  ds_read_b64_tr_b16 v[84:85], v13 offset:8704
  v_cvt_pk_bf16_f32 v25, v18, v19
  v_mfma_f32_16x16x32_bf16 v[120:123], v[36:39], v[232:235], v[120:123]
  ds_read_b64_tr_b16 v[86:87], v13 offset:9728
  v_cvt_pk_bf16_f32 v26, v20, v21
  v_mfma_f32_16x16x32_bf16 v[136:139], v[40:43], v[232:235], v[136:139]
  buffer_load_dwordx4 v6, s[32:35], s26 offen offset:3072 sc1 lds
  v_cvt_pk_bf16_f32 v27, v22, v23
  v_mfma_f32_16x16x32_bf16 v[152:155], v[44:47], v[232:235], v[152:155]
  s_add_u32 s26, s26, 1024
  ds_read_b64_tr_b16 v[88:89], v12 offset:8960
  buffer_store_dwordx4 v[24:27], v2, s[40:43], s64 offen offset:2048 sc1
  v_mfma_f32_16x16x32_bf16 v[168:171], v[48:51], v[232:235], v[168:171]
  ds_read_b64_tr_b16 v[90:91], v12 offset:9984
  v_mfma_f32_16x16x32_bf16 v[184:187], v[52:55], v[232:235], v[184:187]
  ds_read_b64_tr_b16 v[92:93], v13 offset:8960
  v_mfma_f32_16x16x32_bf16 v[200:203], v[56:59], v[232:235], v[200:203]
  s_add_u32 m0, s24, 114688
  ds_read_b64_tr_b16 v[94:95], v13 offset:9984
  v_mfma_f32_16x16x32_bf16 v[216:219], v[60:63], v[232:235], v[216:219]
  buffer_load_dwordx4 v10, s[36:39], s27 offen offset:2048 lds
  v_mfma_f32_16x16x32_bf16 v[108:111], v[32:35], v[236:239], v[108:111]
  ds_read_b128 v[248:251], v14 offset:34816
  v_mfma_f32_16x16x32_bf16 v[124:127], v[36:39], v[236:239], v[124:127]
  ds_read_b128 v[252:255], v14 offset:35840
  v_mfma_f32_16x16x32_bf16 v[140:143], v[40:43], v[236:239], v[140:143]
  v_mfma_f32_16x16x32_bf16 v[156:159], v[44:47], v[236:239], v[156:159]
  v_xor_b32 v14, 0x10000, v14
  v_mfma_f32_16x16x32_bf16 v[172:175], v[48:51], v[236:239], v[172:175]
  buffer_load_dwordx4 v11, s[36:39], s27 offen offset:3072 lds
  v_mfma_f32_16x16x32_bf16 v[188:191], v[52:55], v[236:239], v[188:191]
  s_add_u32 s27, s27, 524288
  v_mfma_f32_16x16x32_bf16 v[204:207], v[56:59], v[236:239], v[204:207]
  v_mfma_f32_16x16x32_bf16 v[220:223], v[60:63], v[236:239], v[220:223]
  s_waitcnt vmcnt(18) lgkmcnt(0)
  v_mfma_f32_16x16x32_bf16 v[96:99], v[64:67], v[240:243], v[96:99]
  s_barrier
  v_accvgpr_read_b32 v16, a24
  v_accvgpr_read_b32 v17, a25
  v_mfma_f32_16x16x32_bf16 v[112:115], v[68:71], v[240:243], v[112:115]
  ds_read_b64_tr_b16 v[32:33], v12 offset:32768
  v_accvgpr_read_b32 v18, a26
  v_mfma_f32_16x16x32_bf16 v[128:131], v[72:75], v[240:243], v[128:131]
  s_add_u32 m0, s24, 32768
  ds_read_b64_tr_b16 v[34:35], v12 offset:33792
  v_accvgpr_read_b32 v19, a27
  v_mfma_f32_16x16x32_bf16 v[144:147], v[76:79], v[240:243], v[144:147]
  buffer_load_dwordx4 v3, s[32:35], s26 offen offset:0 sc1 lds
  v_accvgpr_read_b32 v20, a28
  v_mfma_f32_16x16x32_bf16 v[160:163], v[80:83], v[240:243], v[160:163]
  ds_read_b64_tr_b16 v[36:37], v13 offset:32768
  v_accvgpr_read_b32 v21, a29
  v_mfma_f32_16x16x32_bf16 v[176:179], v[84:87], v[240:243], v[176:179]
  ds_read_b64_tr_b16 v[38:39], v13 offset:33792
  v_accvgpr_read_b32 v22, a30
  v_mfma_f32_16x16x32_bf16 v[192:195], v[88:91], v[240:243], v[192:195]
  ds_read_b64_tr_b16 v[40:41], v12 offset:33024
  v_accvgpr_read_b32 v23, a31
  v_mfma_f32_16x16x32_bf16 v[208:211], v[92:95], v[240:243], v[208:211]
  ds_read_b64_tr_b16 v[42:43], v12 offset:34048
  v_mul_f32 v16, s76, v16
  v_mfma_f32_16x16x32_bf16 v[100:103], v[64:67], v[244:247], v[100:103]
  buffer_load_dwordx4 v4, s[32:35], s26 offen offset:1024 sc1 lds
  v_mul_f32 v17, s76, v17
  v_mfma_f32_16x16x32_bf16 v[116:119], v[68:71], v[244:247], v[116:119]
  ds_read_b64_tr_b16 v[44:45], v13 offset:33024
  v_mul_f32 v18, s76, v18
  v_mfma_f32_16x16x32_bf16 v[132:135], v[72:75], v[244:247], v[132:135]
  ds_read_b64_tr_b16 v[46:47], v13 offset:34048
  v_mul_f32 v19, s76, v19
  v_mfma_f32_16x16x32_bf16 v[148:151], v[76:79], v[244:247], v[148:151]
  ds_read_b128 v[224:227], v14 offset:0
  v_mul_f32 v20, s76, v20
  v_mfma_f32_16x16x32_bf16 v[164:167], v[80:83], v[244:247], v[164:167]
  ds_read_b128 v[228:231], v14 offset:1024
  v_mul_f32 v21, s76, v21
  v_mfma_f32_16x16x32_bf16 v[180:183], v[84:87], v[244:247], v[180:183]
  buffer_load_dwordx4 v5, s[32:35], s26 offen offset:2048 sc1 lds
  v_mul_f32 v22, s76, v22
  v_mfma_f32_16x16x32_bf16 v[196:199], v[88:91], v[244:247], v[196:199]
  ds_read_b64_tr_b16 v[48:49], v12 offset:33280
  v_mul_f32 v23, s76, v23
  v_mfma_f32_16x16x32_bf16 v[212:215], v[92:95], v[244:247], v[212:215]
  ds_read_b64_tr_b16 v[50:51], v12 offset:34304
  v_cvt_pk_bf16_f32 v28, v16, v17
  v_mfma_f32_16x16x32_bf16 v[104:107], v[64:67], v[248:251], v[104:107]
  ds_read_b64_tr_b16 v[52:53], v13 offset:33280
  v_cvt_pk_bf16_f32 v29, v18, v19
  v_mfma_f32_16x16x32_bf16 v[120:123], v[68:71], v[248:251], v[120:123]
  ds_read_b64_tr_b16 v[54:55], v13 offset:34304
  v_cvt_pk_bf16_f32 v30, v20, v21
  v_mfma_f32_16x16x32_bf16 v[136:139], v[72:75], v[248:251], v[136:139]
  buffer_load_dwordx4 v6, s[32:35], s26 offen offset:3072 sc1 lds
  v_cvt_pk_bf16_f32 v31, v22, v23
  v_mfma_f32_16x16x32_bf16 v[152:155], v[76:79], v[248:251], v[152:155]
  s_add_u32 s26, s26, 1024
  ds_read_b64_tr_b16 v[56:57], v12 offset:33536
  buffer_store_dwordx4 v[28:31], v2, s[40:43], s64 offen offset:3072 sc1
  v_mfma_f32_16x16x32_bf16 v[168:171], v[80:83], v[248:251], v[168:171]
  ds_read_b64_tr_b16 v[58:59], v12 offset:34560
  v_mfma_f32_16x16x32_bf16 v[184:187], v[84:87], v[248:251], v[184:187]
  ds_read_b64_tr_b16 v[60:61], v13 offset:33536
  v_mfma_f32_16x16x32_bf16 v[200:203], v[88:91], v[248:251], v[200:203]
  s_add_u32 m0, s24, 16384
  ds_read_b64_tr_b16 v[62:63], v13 offset:34560
  v_mfma_f32_16x16x32_bf16 v[216:219], v[92:95], v[248:251], v[216:219]
  buffer_load_dwordx4 v8, s[36:39], s27 offen offset:0 lds
  v_mfma_f32_16x16x32_bf16 v[108:111], v[64:67], v[252:255], v[108:111]
  ds_read_b128 v[232:235], v14 offset:2048
  v_mfma_f32_16x16x32_bf16 v[124:127], v[68:71], v[252:255], v[124:127]
  ds_read_b128 v[236:239], v14 offset:3072
  v_mfma_f32_16x16x32_bf16 v[140:143], v[72:75], v[252:255], v[140:143]
  v_mfma_f32_16x16x32_bf16 v[156:159], v[76:79], v[252:255], v[156:159]
  v_mfma_f32_16x16x32_bf16 v[172:175], v[80:83], v[252:255], v[172:175]
  buffer_load_dwordx4 v9, s[36:39], s27 offen offset:1024 lds
  v_mfma_f32_16x16x32_bf16 v[188:191], v[84:87], v[252:255], v[188:191]
  v_mfma_f32_16x16x32_bf16 v[204:207], v[88:91], v[252:255], v[204:207]
  v_mfma_f32_16x16x32_bf16 v[220:223], v[92:95], v[252:255], v[220:223]
  s_waitcnt vmcnt(17) lgkmcnt(0)
  v_mfma_f32_16x16x32_bf16 v[96:99], v[32:35], v[224:227], v[96:99]
  s_add_u32 s64, s64, 4096
  v_accvgpr_read_b32 v16, a32
  v_accvgpr_read_b32 v17, a33
  v_mfma_f32_16x16x32_bf16 v[112:115], v[36:39], v[224:227], v[112:115]
  ds_read_b64_tr_b16 v[64:65], v12 offset:40960
  v_accvgpr_read_b32 v18, a34
  v_mfma_f32_16x16x32_bf16 v[128:131], v[40:43], v[224:227], v[128:131]
  s_add_u32 m0, s24, 65536
  ds_read_b64_tr_b16 v[66:67], v12 offset:41984
  v_accvgpr_read_b32 v19, a35
  v_mfma_f32_16x16x32_bf16 v[144:147], v[44:47], v[224:227], v[144:147]
  buffer_load_dwordx4 v3, s[32:35], s26 offen offset:0 sc1 lds
  v_accvgpr_read_b32 v20, a36
  v_mfma_f32_16x16x32_bf16 v[160:163], v[48:51], v[224:227], v[160:163]
  ds_read_b64_tr_b16 v[68:69], v13 offset:40960
  v_accvgpr_read_b32 v21, a37
  v_mfma_f32_16x16x32_bf16 v[176:179], v[52:55], v[224:227], v[176:179]
  ds_read_b64_tr_b16 v[70:71], v13 offset:41984
  v_accvgpr_read_b32 v22, a38
  v_mfma_f32_16x16x32_bf16 v[192:195], v[56:59], v[224:227], v[192:195]
  ds_read_b64_tr_b16 v[72:73], v12 offset:41216
  v_accvgpr_read_b32 v23, a39
  v_mfma_f32_16x16x32_bf16 v[208:211], v[60:63], v[224:227], v[208:211]
  ds_read_b64_tr_b16 v[74:75], v12 offset:42240
  v_mul_f32 v16, s76, v16
  v_mfma_f32_16x16x32_bf16 v[100:103], v[32:35], v[228:231], v[100:103]
  buffer_load_dwordx4 v4, s[32:35], s26 offen offset:1024 sc1 lds
  v_mul_f32 v17, s76, v17
  v_mfma_f32_16x16x32_bf16 v[116:119], v[36:39], v[228:231], v[116:119]
  ds_read_b64_tr_b16 v[76:77], v13 offset:41216
  v_mul_f32 v18, s76, v18
  v_mfma_f32_16x16x32_bf16 v[132:135], v[40:43], v[228:231], v[132:135]
  ds_read_b64_tr_b16 v[78:79], v13 offset:42240
  v_mul_f32 v19, s76, v19
  v_mfma_f32_16x16x32_bf16 v[148:151], v[44:47], v[228:231], v[148:151]
  ds_read_b128 v[240:243], v14 offset:32768
  v_mul_f32 v20, s76, v20
  v_mfma_f32_16x16x32_bf16 v[164:167], v[48:51], v[228:231], v[164:167]
  ds_read_b128 v[244:247], v14 offset:33792
  v_mul_f32 v21, s76, v21
  v_mfma_f32_16x16x32_bf16 v[180:183], v[52:55], v[228:231], v[180:183]
  buffer_load_dwordx4 v5, s[32:35], s26 offen offset:2048 sc1 lds
  v_mul_f32 v22, s76, v22
  v_mfma_f32_16x16x32_bf16 v[196:199], v[56:59], v[228:231], v[196:199]
  ds_read_b64_tr_b16 v[80:81], v12 offset:41472
  v_mul_f32 v23, s76, v23
  v_mfma_f32_16x16x32_bf16 v[212:215], v[60:63], v[228:231], v[212:215]
  ds_read_b64_tr_b16 v[82:83], v12 offset:42496
  v_cvt_pk_bf16_f32 v24, v16, v17
  v_mfma_f32_16x16x32_bf16 v[104:107], v[32:35], v[232:235], v[104:107]
  ds_read_b64_tr_b16 v[84:85], v13 offset:41472
  v_cvt_pk_bf16_f32 v25, v18, v19
  v_mfma_f32_16x16x32_bf16 v[120:123], v[36:39], v[232:235], v[120:123]
  ds_read_b64_tr_b16 v[86:87], v13 offset:42496
  v_cvt_pk_bf16_f32 v26, v20, v21
  v_mfma_f32_16x16x32_bf16 v[136:139], v[40:43], v[232:235], v[136:139]
  buffer_load_dwordx4 v6, s[32:35], s26 offen offset:3072 sc1 lds
  v_cvt_pk_bf16_f32 v27, v22, v23
  v_mfma_f32_16x16x32_bf16 v[152:155], v[44:47], v[232:235], v[152:155]
  s_add_u32 s26, s26, 1024
  ds_read_b64_tr_b16 v[88:89], v12 offset:41728
  buffer_store_dwordx4 v[24:27], v2, s[40:43], s64 offen offset:0 sc1
  v_mfma_f32_16x16x32_bf16 v[168:171], v[48:51], v[232:235], v[168:171]
  ds_read_b64_tr_b16 v[90:91], v12 offset:42752
  v_mfma_f32_16x16x32_bf16 v[184:187], v[52:55], v[232:235], v[184:187]
  ds_read_b64_tr_b16 v[92:93], v13 offset:41728
  v_mfma_f32_16x16x32_bf16 v[200:203], v[56:59], v[232:235], v[200:203]
  s_add_u32 m0, s24, 16384
  ds_read_b64_tr_b16 v[94:95], v13 offset:42752
  v_mfma_f32_16x16x32_bf16 v[216:219], v[60:63], v[232:235], v[216:219]
  buffer_load_dwordx4 v10, s[36:39], s27 offen offset:2048 lds
  v_mfma_f32_16x16x32_bf16 v[108:111], v[32:35], v[236:239], v[108:111]
  ds_read_b128 v[248:251], v14 offset:34816
  v_mfma_f32_16x16x32_bf16 v[124:127], v[36:39], v[236:239], v[124:127]
  ds_read_b128 v[252:255], v14 offset:35840
  v_mfma_f32_16x16x32_bf16 v[140:143], v[40:43], v[236:239], v[140:143]
  v_mfma_f32_16x16x32_bf16 v[156:159], v[44:47], v[236:239], v[156:159]
  v_xor_b32 v14, 0x10000, v14
  v_mfma_f32_16x16x32_bf16 v[172:175], v[48:51], v[236:239], v[172:175]
  buffer_load_dwordx4 v11, s[36:39], s27 offen offset:3072 lds
  v_mfma_f32_16x16x32_bf16 v[188:191], v[52:55], v[236:239], v[188:191]
  s_add_u32 s27, s27, 524288
  v_xor_b32 v12, 0x10000, v12
  v_mfma_f32_16x16x32_bf16 v[204:207], v[56:59], v[236:239], v[204:207]
  v_xor_b32 v13, 0x10000, v13
  v_mfma_f32_16x16x32_bf16 v[220:223], v[60:63], v[236:239], v[220:223]
  s_waitcnt vmcnt(17) lgkmcnt(0)
  v_mfma_f32_16x16x32_bf16 v[96:99], v[64:67], v[240:243], v[96:99]
  s_barrier
  v_accvgpr_read_b32 v16, a40
  v_accvgpr_read_b32 v17, a41
  v_mfma_f32_16x16x32_bf16 v[112:115], v[68:71], v[240:243], v[112:115]
  ds_read_b64_tr_b16 v[32:33], v12 offset:0
  v_accvgpr_read_b32 v18, a42
  v_mfma_f32_16x16x32_bf16 v[128:131], v[72:75], v[240:243], v[128:131]
  s_add_u32 m0, s24, 98304
  ds_read_b64_tr_b16 v[34:35], v12 offset:1024
  v_accvgpr_read_b32 v19, a43
  v_mfma_f32_16x16x32_bf16 v[144:147], v[76:79], v[240:243], v[144:147]
  buffer_load_dwordx4 v3, s[32:35], s26 offen offset:0 sc1 lds
  v_accvgpr_read_b32 v20, a44
  v_mfma_f32_16x16x32_bf16 v[160:163], v[80:83], v[240:243], v[160:163]
  ds_read_b64_tr_b16 v[36:37], v13 offset:0
  v_accvgpr_read_b32 v21, a45
  v_mfma_f32_16x16x32_bf16 v[176:179], v[84:87], v[240:243], v[176:179]
  ds_read_b64_tr_b16 v[38:39], v13 offset:1024
  v_accvgpr_read_b32 v22, a46
  v_mfma_f32_16x16x32_bf16 v[192:195], v[88:91], v[240:243], v[192:195]
  ds_read_b64_tr_b16 v[40:41], v12 offset:256
  v_accvgpr_read_b32 v23, a47
  v_mfma_f32_16x16x32_bf16 v[208:211], v[92:95], v[240:243], v[208:211]
  ds_read_b64_tr_b16 v[42:43], v12 offset:1280
  v_mul_f32 v16, s76, v16
  v_mfma_f32_16x16x32_bf16 v[100:103], v[64:67], v[244:247], v[100:103]
  buffer_load_dwordx4 v4, s[32:35], s26 offen offset:1024 sc1 lds
  v_mul_f32 v17, s76, v17
  v_mfma_f32_16x16x32_bf16 v[116:119], v[68:71], v[244:247], v[116:119]
  ds_read_b64_tr_b16 v[44:45], v13 offset:256
  v_mul_f32 v18, s76, v18
  v_mfma_f32_16x16x32_bf16 v[132:135], v[72:75], v[244:247], v[132:135]
  ds_read_b64_tr_b16 v[46:47], v13 offset:1280
  v_mul_f32 v19, s76, v19
  v_mfma_f32_16x16x32_bf16 v[148:151], v[76:79], v[244:247], v[148:151]
  ds_read_b128 v[224:227], v14 offset:0
  v_mul_f32 v20, s76, v20
  v_mfma_f32_16x16x32_bf16 v[164:167], v[80:83], v[244:247], v[164:167]
  ds_read_b128 v[228:231], v14 offset:1024
  v_mul_f32 v21, s76, v21
  v_mfma_f32_16x16x32_bf16 v[180:183], v[84:87], v[244:247], v[180:183]
  buffer_load_dwordx4 v5, s[32:35], s26 offen offset:2048 sc1 lds
  v_mul_f32 v22, s76, v22
  v_mfma_f32_16x16x32_bf16 v[196:199], v[88:91], v[244:247], v[196:199]
  ds_read_b64_tr_b16 v[48:49], v12 offset:512
  v_mul_f32 v23, s76, v23
  v_mfma_f32_16x16x32_bf16 v[212:215], v[92:95], v[244:247], v[212:215]
  ds_read_b64_tr_b16 v[50:51], v12 offset:1536
  v_cvt_pk_bf16_f32 v28, v16, v17
  v_mfma_f32_16x16x32_bf16 v[104:107], v[64:67], v[248:251], v[104:107]
  ds_read_b64_tr_b16 v[52:53], v13 offset:512
  v_cvt_pk_bf16_f32 v29, v18, v19
  v_mfma_f32_16x16x32_bf16 v[120:123], v[68:71], v[248:251], v[120:123]
  ds_read_b64_tr_b16 v[54:55], v13 offset:1536
  v_cvt_pk_bf16_f32 v30, v20, v21
  v_mfma_f32_16x16x32_bf16 v[136:139], v[72:75], v[248:251], v[136:139]
  buffer_load_dwordx4 v6, s[32:35], s26 offen offset:3072 sc1 lds
  v_cvt_pk_bf16_f32 v31, v22, v23
  v_mfma_f32_16x16x32_bf16 v[152:155], v[76:79], v[248:251], v[152:155]
  s_add_u32 s26, s26, 1024
  ds_read_b64_tr_b16 v[56:57], v12 offset:768
  buffer_store_dwordx4 v[28:31], v2, s[40:43], s64 offen offset:1024 sc1
  v_mfma_f32_16x16x32_bf16 v[168:171], v[80:83], v[248:251], v[168:171]
  ds_read_b64_tr_b16 v[58:59], v12 offset:1792
  v_mfma_f32_16x16x32_bf16 v[184:187], v[84:87], v[248:251], v[184:187]
  ds_read_b64_tr_b16 v[60:61], v13 offset:768
  v_mfma_f32_16x16x32_bf16 v[200:203], v[88:91], v[248:251], v[200:203]
  s_add_u32 m0, s24, 49152
  ds_read_b64_tr_b16 v[62:63], v13 offset:1792
  v_mfma_f32_16x16x32_bf16 v[216:219], v[92:95], v[248:251], v[216:219]
  buffer_load_dwordx4 v8, s[36:39], s27 offen offset:0 lds
  v_mfma_f32_16x16x32_bf16 v[108:111], v[64:67], v[252:255], v[108:111]
  ds_read_b128 v[232:235], v14 offset:2048
  v_mfma_f32_16x16x32_bf16 v[124:127], v[68:71], v[252:255], v[124:127]
  ds_read_b128 v[236:239], v14 offset:3072
  v_mfma_f32_16x16x32_bf16 v[140:143], v[72:75], v[252:255], v[140:143]
  v_mfma_f32_16x16x32_bf16 v[156:159], v[76:79], v[252:255], v[156:159]
  v_mfma_f32_16x16x32_bf16 v[172:175], v[80:83], v[252:255], v[172:175]
  buffer_load_dwordx4 v9, s[36:39], s27 offen offset:1024 lds
  v_mfma_f32_16x16x32_bf16 v[188:191], v[84:87], v[252:255], v[188:191]
  v_mfma_f32_16x16x32_bf16 v[204:207], v[88:91], v[252:255], v[204:207]
  v_mfma_f32_16x16x32_bf16 v[220:223], v[92:95], v[252:255], v[220:223]
  s_waitcnt vmcnt(17) lgkmcnt(0)
  v_mfma_f32_16x16x32_bf16 v[96:99], v[32:35], v[224:227], v[96:99]
  v_accvgpr_read_b32 v16, a48
  v_accvgpr_read_b32 v17, a49
  v_accvgpr_read_b32 v18, a50
  v_mfma_f32_16x16x32_bf16 v[112:115], v[36:39], v[224:227], v[112:115]
  ds_read_b64_tr_b16 v[64:65], v12 offset:8192
  v_accvgpr_read_b32 v19, a51
  v_mfma_f32_16x16x32_bf16 v[128:131], v[40:43], v[224:227], v[128:131]
  s_add_u32 m0, s24, 0
  ds_read_b64_tr_b16 v[66:67], v12 offset:9216
  v_accvgpr_read_b32 v20, a52
  v_mfma_f32_16x16x32_bf16 v[144:147], v[44:47], v[224:227], v[144:147]
  buffer_load_dwordx4 v3, s[32:35], s26 offen offset:0 sc1 lds
  v_accvgpr_read_b32 v21, a53
  v_accvgpr_read_b32 v22, a54
  v_mfma_f32_16x16x32_bf16 v[160:163], v[48:51], v[224:227], v[160:163]
  ds_read_b64_tr_b16 v[68:69], v13 offset:8192
  v_accvgpr_read_b32 v23, a55
  v_mfma_f32_16x16x32_bf16 v[176:179], v[52:55], v[224:227], v[176:179]
  ds_read_b64_tr_b16 v[70:71], v13 offset:9216
  v_mul_f32 v16, s76, v16
  v_mfma_f32_16x16x32_bf16 v[192:195], v[56:59], v[224:227], v[192:195]
  ds_read_b64_tr_b16 v[72:73], v12 offset:8448
  v_mul_f32 v17, s76, v17
  v_mfma_f32_16x16x32_bf16 v[208:211], v[60:63], v[224:227], v[208:211]
  ds_read_b64_tr_b16 v[74:75], v12 offset:9472
  v_mul_f32 v18, s76, v18
  v_mul_f32 v19, s76, v19
  v_mfma_f32_16x16x32_bf16 v[100:103], v[32:35], v[228:231], v[100:103]
  buffer_load_dwordx4 v4, s[32:35], s26 offen offset:1024 sc1 lds
  v_mul_f32 v20, s76, v20
  v_mfma_f32_16x16x32_bf16 v[116:119], v[36:39], v[228:231], v[116:119]
  ds_read_b64_tr_b16 v[76:77], v13 offset:8448
  v_mul_f32 v21, s76, v21
  v_mfma_f32_16x16x32_bf16 v[132:135], v[40:43], v[228:231], v[132:135]
  ds_read_b64_tr_b16 v[78:79], v13 offset:9472
  v_mul_f32 v22, s76, v22
  v_mfma_f32_16x16x32_bf16 v[148:151], v[44:47], v[228:231], v[148:151]
  ds_read_b128 v[240:243], v14 offset:32768
  v_mul_f32 v23, s76, v23
  v_cvt_pk_bf16_f32 v24, v16, v17
  v_mfma_f32_16x16x32_bf16 v[164:167], v[48:51], v[228:231], v[164:167]
  ds_read_b128 v[244:247], v14 offset:33792
  v_cvt_pk_bf16_f32 v25, v18, v19
  v_mfma_f32_16x16x32_bf16 v[180:183], v[52:55], v[228:231], v[180:183]
  buffer_load_dwordx4 v5, s[32:35], s26 offen offset:2048 sc1 lds
  v_cvt_pk_bf16_f32 v26, v20, v21
  v_mfma_f32_16x16x32_bf16 v[196:199], v[56:59], v[228:231], v[196:199]
  ds_read_b64_tr_b16 v[80:81], v12 offset:8704
  v_cvt_pk_bf16_f32 v27, v22, v23
  v_mfma_f32_16x16x32_bf16 v[212:215], v[60:63], v[228:231], v[212:215]
  ds_read_b64_tr_b16 v[82:83], v12 offset:9728
  buffer_store_dwordx4 v[24:27], v2, s[40:43], s64 offen offset:2048 sc1
  v_accvgpr_read_b32 v16, a56
  v_mfma_f32_16x16x32_bf16 v[104:107], v[32:35], v[232:235], v[104:107]
  ds_read_b64_tr_b16 v[84:85], v13 offset:8704
  v_accvgpr_read_b32 v17, a57
  v_mfma_f32_16x16x32_bf16 v[120:123], v[36:39], v[232:235], v[120:123]
  ds_read_b64_tr_b16 v[86:87], v13 offset:9728
  v_accvgpr_read_b32 v18, a58
  v_mfma_f32_16x16x32_bf16 v[136:139], v[40:43], v[232:235], v[136:139]
  buffer_load_dwordx4 v6, s[32:35], s26 offen offset:3072 sc1 lds
  v_accvgpr_read_b32 v19, a59
  v_accvgpr_read_b32 v20, a60
  v_mfma_f32_16x16x32_bf16 v[152:155], v[44:47], v[232:235], v[152:155]
  s_add_u32 s26, s26, 1024
  ds_read_b64_tr_b16 v[88:89], v12 offset:8960
  v_accvgpr_read_b32 v21, a61
  v_mfma_f32_16x16x32_bf16 v[168:171], v[48:51], v[232:235], v[168:171]
  ds_read_b64_tr_b16 v[90:91], v12 offset:9984
  v_accvgpr_read_b32 v22, a62
  v_mfma_f32_16x16x32_bf16 v[184:187], v[52:55], v[232:235], v[184:187]
  ds_read_b64_tr_b16 v[92:93], v13 offset:8960
  v_accvgpr_read_b32 v23, a63
  v_mfma_f32_16x16x32_bf16 v[200:203], v[56:59], v[232:235], v[200:203]
  s_add_u32 m0, s24, 49152
  ds_read_b64_tr_b16 v[94:95], v13 offset:9984
  v_mul_f32 v16, s76, v16
  v_mul_f32 v17, s76, v17
  v_mfma_f32_16x16x32_bf16 v[216:219], v[60:63], v[232:235], v[216:219]
  buffer_load_dwordx4 v10, s[36:39], s27 offen offset:2048 lds
  v_mul_f32 v18, s76, v18
  v_mfma_f32_16x16x32_bf16 v[108:111], v[32:35], v[236:239], v[108:111]
  ds_read_b128 v[248:251], v14 offset:34816
  v_mul_f32 v19, s76, v19
  v_mfma_f32_16x16x32_bf16 v[124:127], v[36:39], v[236:239], v[124:127]
  ds_read_b128 v[252:255], v14 offset:35840
  v_mul_f32 v20, s76, v20
  v_mfma_f32_16x16x32_bf16 v[140:143], v[40:43], v[236:239], v[140:143]
  v_mul_f32 v21, s76, v21
  v_mul_f32 v22, s76, v22
  v_mul_f32 v23, s76, v23
  v_mfma_f32_16x16x32_bf16 v[156:159], v[44:47], v[236:239], v[156:159]
  v_xor_b32 v14, 0x10000, v14
  v_cvt_pk_bf16_f32 v28, v16, v17
  v_mfma_f32_16x16x32_bf16 v[172:175], v[48:51], v[236:239], v[172:175]
  buffer_load_dwordx4 v11, s[36:39], s27 offen offset:3072 lds
  v_cvt_pk_bf16_f32 v29, v18, v19
  v_mfma_f32_16x16x32_bf16 v[188:191], v[52:55], v[236:239], v[188:191]
  s_add_u32 s27, s27, 524288
  v_cvt_pk_bf16_f32 v30, v20, v21
  v_cvt_pk_bf16_f32 v31, v22, v23
  v_mfma_f32_16x16x32_bf16 v[204:207], v[56:59], v[236:239], v[204:207]
  buffer_store_dwordx4 v[28:31], v2, s[40:43], s64 offen offset:3072 sc1
  v_mfma_f32_16x16x32_bf16 v[220:223], v[60:63], v[236:239], v[220:223]
  s_waitcnt vmcnt(18) lgkmcnt(0)
  v_mfma_f32_16x16x32_bf16 v[96:99], v[64:67], v[240:243], v[96:99]
  s_barrier
  v_accvgpr_read_b32 v16, a64
  v_accvgpr_read_b32 v17, a65
  v_accvgpr_read_b32 v18, a66
  v_mfma_f32_16x16x32_bf16 v[112:115], v[68:71], v[240:243], v[112:115]
  s_add_u32 s64, s64, 126976
  ds_read_b64_tr_b16 v[32:33], v12 offset:32768
  v_accvgpr_read_b32 v19, a67
  v_accvgpr_read_b32 v20, a68
  v_mfma_f32_16x16x32_bf16 v[128:131], v[72:75], v[240:243], v[128:131]
  s_add_u32 m0, s24, 32768
  ds_read_b64_tr_b16 v[34:35], v12 offset:33792
  v_accvgpr_read_b32 v21, a69
  v_mfma_f32_16x16x32_bf16 v[144:147], v[76:79], v[240:243], v[144:147]
  buffer_load_dwordx4 v3, s[32:35], s26 offen offset:0 sc1 lds
  v_accvgpr_read_b32 v22, a70
  v_accvgpr_read_b32 v23, a71
  v_mfma_f32_16x16x32_bf16 v[160:163], v[80:83], v[240:243], v[160:163]
  ds_read_b64_tr_b16 v[36:37], v13 offset:32768
  v_mul_f32 v16, s76, v16
  v_mfma_f32_16x16x32_bf16 v[176:179], v[84:87], v[240:243], v[176:179]
  ds_read_b64_tr_b16 v[38:39], v13 offset:33792
  v_mul_f32 v17, s76, v17
  v_mul_f32 v18, s76, v18
  v_mfma_f32_16x16x32_bf16 v[192:195], v[88:91], v[240:243], v[192:195]
  ds_read_b64_tr_b16 v[40:41], v12 offset:33024
  v_mul_f32 v19, s76, v19
  v_mfma_f32_16x16x32_bf16 v[208:211], v[92:95], v[240:243], v[208:211]
  ds_read_b64_tr_b16 v[42:43], v12 offset:34048
  v_mul_f32 v20, s76, v20
  v_mul_f32 v21, s76, v21
  v_mfma_f32_16x16x32_bf16 v[100:103], v[64:67], v[244:247], v[100:103]
  buffer_load_dwordx4 v4, s[32:35], s26 offen offset:1024 sc1 lds
  v_mul_f32 v22, s76, v22
  v_mfma_f32_16x16x32_bf16 v[116:119], v[68:71], v[244:247], v[116:119]
  ds_read_b64_tr_b16 v[44:45], v13 offset:33024
  v_mul_f32 v23, s76, v23
  v_cvt_pk_bf16_f32 v24, v16, v17
  v_mfma_f32_16x16x32_bf16 v[132:135], v[72:75], v[244:247], v[132:135]
  ds_read_b64_tr_b16 v[46:47], v13 offset:34048
  v_cvt_pk_bf16_f32 v25, v18, v19
  v_mfma_f32_16x16x32_bf16 v[148:151], v[76:79], v[244:247], v[148:151]
  ds_read_b128 v[224:227], v14 offset:0
  v_cvt_pk_bf16_f32 v26, v20, v21
  v_cvt_pk_bf16_f32 v27, v22, v23
  v_mfma_f32_16x16x32_bf16 v[164:167], v[80:83], v[244:247], v[164:167]
  ds_read_b128 v[228:231], v14 offset:1024
  buffer_store_dwordx4 v[24:27], v2, s[40:43], s64 offen offset:0 sc1
  v_mfma_f32_16x16x32_bf16 v[180:183], v[84:87], v[244:247], v[180:183]
  buffer_load_dwordx4 v5, s[32:35], s26 offen offset:2048 sc1 lds
  v_accvgpr_read_b32 v16, a72
  v_accvgpr_read_b32 v17, a73
  v_mfma_f32_16x16x32_bf16 v[196:199], v[88:91], v[244:247], v[196:199]
  ds_read_b64_tr_b16 v[48:49], v12 offset:33280
  v_accvgpr_read_b32 v18, a74
  v_mfma_f32_16x16x32_bf16 v[212:215], v[92:95], v[244:247], v[212:215]
  ds_read_b64_tr_b16 v[50:51], v12 offset:34304
  v_accvgpr_read_b32 v19, a75
  v_accvgpr_read_b32 v20, a76
  v_mfma_f32_16x16x32_bf16 v[104:107], v[64:67], v[248:251], v[104:107]
  ds_read_b64_tr_b16 v[52:53], v13 offset:33280
  v_accvgpr_read_b32 v21, a77
  v_accvgpr_read_b32 v22, a78
  v_mfma_f32_16x16x32_bf16 v[120:123], v[68:71], v[248:251], v[120:123]
  ds_read_b64_tr_b16 v[54:55], v13 offset:34304
  v_accvgpr_read_b32 v23, a79
  v_mfma_f32_16x16x32_bf16 v[136:139], v[72:75], v[248:251], v[136:139]
  buffer_load_dwordx4 v6, s[32:35], s26 offen offset:3072 sc1 lds
  v_mul_f32 v16, s76, v16
  v_mul_f32 v17, s76, v17
  v_mfma_f32_16x16x32_bf16 v[152:155], v[76:79], v[248:251], v[152:155]
  s_add_u32 s26, s26, 1024
  ds_read_b64_tr_b16 v[56:57], v12 offset:33536
  v_mul_f32 v18, s76, v18
  v_mfma_f32_16x16x32_bf16 v[168:171], v[80:83], v[248:251], v[168:171]
  ds_read_b64_tr_b16 v[58:59], v12 offset:34560
  v_mul_f32 v19, s76, v19
  v_mul_f32 v20, s76, v20
  v_mfma_f32_16x16x32_bf16 v[184:187], v[84:87], v[248:251], v[184:187]
  ds_read_b64_tr_b16 v[60:61], v13 offset:33536
  v_mul_f32 v21, s76, v21
  v_mfma_f32_16x16x32_bf16 v[200:203], v[88:91], v[248:251], v[200:203]
  ds_read_b64_tr_b16 v[62:63], v13 offset:34560
  v_mul_f32 v22, s76, v22
  v_mul_f32 v23, s76, v23
  v_mfma_f32_16x16x32_bf16 v[216:219], v[92:95], v[248:251], v[216:219]
  v_cvt_pk_bf16_f32 v28, v16, v17
  v_cvt_pk_bf16_f32 v29, v18, v19
  v_mfma_f32_16x16x32_bf16 v[108:111], v[64:67], v[252:255], v[108:111]
  ds_read_b128 v[232:235], v14 offset:2048
  v_cvt_pk_bf16_f32 v30, v20, v21
  v_cvt_pk_bf16_f32 v31, v22, v23
  v_mfma_f32_16x16x32_bf16 v[124:127], v[68:71], v[252:255], v[124:127]
  ds_read_b128 v[236:239], v14 offset:3072
  buffer_store_dwordx4 v[28:31], v2, s[40:43], s64 offen offset:1024 sc1
  v_mfma_f32_16x16x32_bf16 v[140:143], v[72:75], v[252:255], v[140:143]
  v_and_b32 v11, 15, v1
  v_lshrrev_b32 v10, 4, v1
  v_lshlrev_b32 v10, 2, v10
  v_mfma_f32_16x16x32_bf16 v[156:159], v[76:79], v[252:255], v[156:159]
  v_sub_u32 v11, v11, v10
  v_cmp_le_i32 s[68:69], 0, v11
  v_mfma_f32_16x16x32_bf16 v[172:175], v[80:83], v[252:255], v[172:175]
  v_cmp_le_i32 s[70:71], 1, v11
  v_cmp_le_i32 s[72:73], 2, v11
  v_cmp_le_i32 s[74:75], 3, v11
  v_mfma_f32_16x16x32_bf16 v[188:191], v[84:87], v[252:255], v[188:191]
  v_and_b32 v8, 7, v1
  v_lshlrev_b32 v8, 2, v8
  v_mfma_f32_16x16x32_bf16 v[204:207], v[88:91], v[252:255], v[204:207]
  v_add_u32 v8, s30, v8
  v_mfma_f32_16x16x32_bf16 v[220:223], v[92:95], v[252:255], v[220:223]
  s_waitcnt vmcnt(17) lgkmcnt(0)
  v_mfma_f32_16x16x32_bf16 v[96:99], v[32:35], v[224:227], v[96:99]
  v_accvgpr_read_b32 v16, a80
  v_accvgpr_read_b32 v17, a81
  v_accvgpr_read_b32 v18, a82
  v_mfma_f32_16x16x32_bf16 v[112:115], v[36:39], v[224:227], v[112:115]
  ds_read_b64_tr_b16 v[64:65], v12 offset:40960
  v_accvgpr_read_b32 v19, a83
  v_accvgpr_read_b32 v20, a84
  v_mfma_f32_16x16x32_bf16 v[128:131], v[40:43], v[224:227], v[128:131]
  s_add_u32 m0, s24, 65536
  ds_read_b64_tr_b16 v[66:67], v12 offset:41984
  v_accvgpr_read_b32 v21, a85
  v_accvgpr_read_b32 v22, a86
  v_mfma_f32_16x16x32_bf16 v[144:147], v[44:47], v[224:227], v[144:147]
  buffer_load_dwordx4 v3, s[32:35], s26 offen offset:0 sc1 lds
  v_accvgpr_read_b32 v23, a87
  v_mul_f32 v16, s76, v16
  v_mfma_f32_16x16x32_bf16 v[160:163], v[48:51], v[224:227], v[160:163]
  ds_read_b64_tr_b16 v[68:69], v13 offset:40960
  v_mul_f32 v17, s76, v17
  v_mul_f32 v18, s76, v18
  v_mfma_f32_16x16x32_bf16 v[176:179], v[52:55], v[224:227], v[176:179]
  ds_read_b64_tr_b16 v[70:71], v13 offset:41984
  v_mul_f32 v19, s76, v19
  v_mul_f32 v20, s76, v20
  v_mfma_f32_16x16x32_bf16 v[192:195], v[56:59], v[224:227], v[192:195]
  ds_read_b64_tr_b16 v[72:73], v12 offset:41216
  v_mul_f32 v21, s76, v21
  v_mul_f32 v22, s76, v22
  v_mfma_f32_16x16x32_bf16 v[208:211], v[60:63], v[224:227], v[208:211]
  ds_read_b64_tr_b16 v[74:75], v12 offset:42240
  v_mul_f32 v23, s76, v23
  v_mfma_f32_16x16x32_bf16 v[100:103], v[32:35], v[228:231], v[100:103]
  buffer_load_dwordx4 v4, s[32:35], s26 offen offset:1024 sc1 lds
  v_cvt_pk_bf16_f32 v24, v16, v17
  v_cvt_pk_bf16_f32 v25, v18, v19
  v_mfma_f32_16x16x32_bf16 v[116:119], v[36:39], v[228:231], v[116:119]
  ds_read_b64_tr_b16 v[76:77], v13 offset:41216
  v_cvt_pk_bf16_f32 v26, v20, v21
  v_cvt_pk_bf16_f32 v27, v22, v23
  v_mfma_f32_16x16x32_bf16 v[132:135], v[40:43], v[228:231], v[132:135]
  ds_read_b64_tr_b16 v[78:79], v13 offset:42240
  buffer_store_dwordx4 v[24:27], v2, s[40:43], s64 offen offset:2048 sc1
  v_accvgpr_read_b32 v16, a88
  v_mfma_f32_16x16x32_bf16 v[148:151], v[44:47], v[228:231], v[148:151]
  ds_read_b128 v[240:243], v14 offset:32768
  v_accvgpr_read_b32 v17, a89
  v_accvgpr_read_b32 v18, a90
  v_mfma_f32_16x16x32_bf16 v[164:167], v[48:51], v[228:231], v[164:167]
  ds_read_b128 v[244:247], v14 offset:33792
  v_accvgpr_read_b32 v19, a91
  v_accvgpr_read_b32 v20, a92
  v_mfma_f32_16x16x32_bf16 v[180:183], v[52:55], v[228:231], v[180:183]
  buffer_load_dwordx4 v5, s[32:35], s26 offen offset:2048 sc1 lds
  v_accvgpr_read_b32 v21, a93
  v_accvgpr_read_b32 v22, a94
  v_mfma_f32_16x16x32_bf16 v[196:199], v[56:59], v[228:231], v[196:199]
  ds_read_b64_tr_b16 v[80:81], v12 offset:41472
  v_accvgpr_read_b32 v23, a95
  v_mfma_f32_16x16x32_bf16 v[212:215], v[60:63], v[228:231], v[212:215]
  ds_read_b64_tr_b16 v[82:83], v12 offset:42496
  v_mul_f32 v16, s76, v16
  v_mul_f32 v17, s76, v17
  v_mfma_f32_16x16x32_bf16 v[104:107], v[32:35], v[232:235], v[104:107]
  ds_read_b64_tr_b16 v[84:85], v13 offset:41472
  v_mul_f32 v18, s76, v18
  v_mul_f32 v19, s76, v19
  v_mfma_f32_16x16x32_bf16 v[120:123], v[36:39], v[232:235], v[120:123]
  ds_read_b64_tr_b16 v[86:87], v13 offset:42496
  v_mul_f32 v20, s76, v20
  v_mul_f32 v21, s76, v21
  v_mfma_f32_16x16x32_bf16 v[136:139], v[40:43], v[232:235], v[136:139]
  buffer_load_dwordx4 v6, s[32:35], s26 offen offset:3072 sc1 lds
  v_mul_f32 v22, s76, v22
  v_mul_f32 v23, s76, v23
  v_mfma_f32_16x16x32_bf16 v[152:155], v[44:47], v[232:235], v[152:155]
  s_add_u32 s26, s26, 1024
  ds_read_b64_tr_b16 v[88:89], v12 offset:41728
  v_cvt_pk_bf16_f32 v28, v16, v17
  v_cvt_pk_bf16_f32 v29, v18, v19
  v_mfma_f32_16x16x32_bf16 v[168:171], v[48:51], v[232:235], v[168:171]
  ds_read_b64_tr_b16 v[90:91], v12 offset:42752
  v_cvt_pk_bf16_f32 v30, v20, v21
  v_cvt_pk_bf16_f32 v31, v22, v23
  v_mfma_f32_16x16x32_bf16 v[184:187], v[52:55], v[232:235], v[184:187]
  ds_read_b64_tr_b16 v[92:93], v13 offset:41728
  buffer_store_dwordx4 v[28:31], v2, s[40:43], s64 offen offset:3072 sc1
  v_add_u32 v9, 0, v1
  v_mfma_f32_16x16x32_bf16 v[200:203], v[56:59], v[232:235], v[200:203]
  ds_read_b64_tr_b16 v[94:95], v13 offset:42752
  v_mul_u32_u24 v10, 6554, v9
  v_mfma_f32_16x16x32_bf16 v[216:219], v[60:63], v[232:235], v[216:219]
  v_lshrrev_b32 v10, 16, v10
  v_mul_u32_u24 v10, 1120, v10
  v_lshl_add_u32 v10, v9, 4, v10
  v_mfma_f32_16x16x32_bf16 v[108:111], v[32:35], v[236:239], v[108:111]
  ds_read_b128 v[248:251], v14 offset:34816
  v_accvgpr_write_b32 a248, v10
  v_add_u32 v9, 64, v1
  v_mfma_f32_16x16x32_bf16 v[124:127], v[36:39], v[236:239], v[124:127]
  ds_read_b128 v[252:255], v14 offset:35840
  v_mul_u32_u24 v10, 6554, v9
  v_lshrrev_b32 v10, 16, v10
  v_mfma_f32_16x16x32_bf16 v[140:143], v[40:43], v[236:239], v[140:143]
  v_mul_u32_u24 v10, 1120, v10
  v_lshl_add_u32 v10, v9, 4, v10
  v_accvgpr_write_b32 a249, v10
  v_mfma_f32_16x16x32_bf16 v[156:159], v[44:47], v[236:239], v[156:159]
  v_xor_b32 v14, 0x10000, v14
  v_add_u32 v9, 128, v1
  v_mul_u32_u24 v10, 6554, v9
  v_mfma_f32_16x16x32_bf16 v[172:175], v[48:51], v[236:239], v[172:175]
  v_lshrrev_b32 v10, 16, v10
  v_mul_u32_u24 v10, 1120, v10
  v_lshl_add_u32 v10, v9, 4, v10
  v_mfma_f32_16x16x32_bf16 v[188:191], v[52:55], v[236:239], v[188:191]
  v_xor_b32 v12, 0x10000, v12
  v_accvgpr_write_b32 a250, v10
  v_mfma_f32_16x16x32_bf16 v[204:207], v[56:59], v[236:239], v[204:207]
  v_xor_b32 v13, 0x10000, v13
  v_mfma_f32_16x16x32_bf16 v[220:223], v[60:63], v[236:239], v[220:223]
  s_waitcnt vmcnt(15) lgkmcnt(0)
  v_mfma_f32_16x16x32_bf16 v[96:99], v[64:67], v[240:243], v[96:99]
  s_barrier
  v_accvgpr_read_b32 v16, a96
  v_accvgpr_read_b32 v17, a97
  v_accvgpr_read_b32 v18, a98
  v_accvgpr_read_b32 v19, a99
  v_mfma_f32_16x16x32_bf16 v[112:115], v[68:71], v[240:243], v[112:115]
  s_add_u32 s64, s64, 4096
  ds_read_b64_tr_b16 v[32:33], v12 offset:0
  v_accvgpr_read_b32 v20, a100
  v_accvgpr_read_b32 v21, a101
  v_mfma_f32_16x16x32_bf16 v[128:131], v[72:75], v[240:243], v[128:131]
  s_add_u32 m0, s24, 98304
  ds_read_b64_tr_b16 v[34:35], v12 offset:1024
  v_accvgpr_read_b32 v22, a102
  v_accvgpr_read_b32 v23, a103
  v_mfma_f32_16x16x32_bf16 v[144:147], v[76:79], v[240:243], v[144:147]
  buffer_load_dwordx4 v3, s[32:35], s26 offen offset:0 sc1 lds
  v_mul_f32 v16, s76, v16
  v_mul_f32 v17, s76, v17
  v_mul_f32 v18, s76, v18
  v_mfma_f32_16x16x32_bf16 v[160:163], v[80:83], v[240:243], v[160:163]
  ds_read_b64_tr_b16 v[36:37], v13 offset:0
  v_mul_f32 v19, s76, v19
  v_mul_f32 v20, s76, v20
  v_mfma_f32_16x16x32_bf16 v[176:179], v[84:87], v[240:243], v[176:179]
  ds_read_b64_tr_b16 v[38:39], v13 offset:1024
  v_mul_f32 v21, s76, v21
  v_mul_f32 v22, s76, v22
  v_mfma_f32_16x16x32_bf16 v[192:195], v[88:91], v[240:243], v[192:195]
  ds_read_b64_tr_b16 v[40:41], v12 offset:256
  v_mul_f32 v23, s76, v23
  v_cvt_pk_bf16_f32 v24, v16, v17
  v_cvt_pk_bf16_f32 v25, v18, v19
  v_mfma_f32_16x16x32_bf16 v[208:211], v[92:95], v[240:243], v[208:211]
  ds_read_b64_tr_b16 v[42:43], v12 offset:1280
  v_cvt_pk_bf16_f32 v26, v20, v21
  v_cvt_pk_bf16_f32 v27, v22, v23
  v_mfma_f32_16x16x32_bf16 v[100:103], v[64:67], v[244:247], v[100:103]
  buffer_load_dwordx4 v4, s[32:35], s26 offen offset:1024 sc1 lds
  buffer_store_dwordx4 v[24:27], v2, s[40:43], s64 offen offset:0 sc1
  v_accvgpr_read_b32 v16, a104
  v_mfma_f32_16x16x32_bf16 v[116:119], v[68:71], v[244:247], v[116:119]
  ds_read_b64_tr_b16 v[44:45], v13 offset:256
  v_accvgpr_read_b32 v17, a105
  v_accvgpr_read_b32 v18, a106
  v_mfma_f32_16x16x32_bf16 v[132:135], v[72:75], v[244:247], v[132:135]
  ds_read_b64_tr_b16 v[46:47], v13 offset:1280
  v_accvgpr_read_b32 v19, a107
  v_accvgpr_read_b32 v20, a108
  v_accvgpr_read_b32 v21, a109
  v_mfma_f32_16x16x32_bf16 v[148:151], v[76:79], v[244:247], v[148:151]
  ds_read_b128 v[224:227], v14 offset:0
  v_accvgpr_read_b32 v22, a110
  v_accvgpr_read_b32 v23, a111
  v_mfma_f32_16x16x32_bf16 v[164:167], v[80:83], v[244:247], v[164:167]
  ds_read_b128 v[228:231], v14 offset:1024
  v_mul_f32 v16, s76, v16
  v_mul_f32 v17, s76, v17
  v_mfma_f32_16x16x32_bf16 v[180:183], v[84:87], v[244:247], v[180:183]
  buffer_load_dwordx4 v5, s[32:35], s26 offen offset:2048 sc1 lds
  v_mul_f32 v18, s76, v18
  v_mul_f32 v19, s76, v19
  v_mul_f32 v20, s76, v20
  v_mfma_f32_16x16x32_bf16 v[196:199], v[88:91], v[244:247], v[196:199]
  ds_read_b64_tr_b16 v[48:49], v12 offset:512
  v_mul_f32 v21, s76, v21
  v_mul_f32 v22, s76, v22
  v_mfma_f32_16x16x32_bf16 v[212:215], v[92:95], v[244:247], v[212:215]
  ds_read_b64_tr_b16 v[50:51], v12 offset:1536
  v_mul_f32 v23, s76, v23
  v_cvt_pk_bf16_f32 v28, v16, v17
  v_mfma_f32_16x16x32_bf16 v[104:107], v[64:67], v[248:251], v[104:107]
  ds_read_b64_tr_b16 v[52:53], v13 offset:512
  v_cvt_pk_bf16_f32 v29, v18, v19
  v_cvt_pk_bf16_f32 v30, v20, v21
  v_cvt_pk_bf16_f32 v31, v22, v23
  v_mfma_f32_16x16x32_bf16 v[120:123], v[68:71], v[248:251], v[120:123]
  ds_read_b64_tr_b16 v[54:55], v13 offset:1536
  buffer_store_dwordx4 v[28:31], v2, s[40:43], s64 offen offset:1024 sc1
  v_accvgpr_read_b32 v16, a112
  v_mfma_f32_16x16x32_bf16 v[136:139], v[72:75], v[248:251], v[136:139]
  buffer_load_dwordx4 v6, s[32:35], s26 offen offset:3072 sc1 lds
  v_accvgpr_read_b32 v17, a113
  v_accvgpr_read_b32 v18, a114
  v_mfma_f32_16x16x32_bf16 v[152:155], v[76:79], v[248:251], v[152:155]
  s_add_u32 s26, s26, 1024
  ds_read_b64_tr_b16 v[56:57], v12 offset:768
  v_accvgpr_read_b32 v19, a115
  v_accvgpr_read_b32 v20, a116
  v_mfma_f32_16x16x32_bf16 v[168:171], v[80:83], v[248:251], v[168:171]
  ds_read_b64_tr_b16 v[58:59], v12 offset:1792
  v_accvgpr_read_b32 v21, a117
  v_accvgpr_read_b32 v22, a118
  v_accvgpr_read_b32 v23, a119
  v_mfma_f32_16x16x32_bf16 v[184:187], v[84:87], v[248:251], v[184:187]
  ds_read_b64_tr_b16 v[60:61], v13 offset:768
  v_mul_f32 v16, s76, v16
  v_mul_f32 v17, s76, v17
  v_mfma_f32_16x16x32_bf16 v[200:203], v[88:91], v[248:251], v[200:203]
  ds_read_b64_tr_b16 v[62:63], v13 offset:1792
  v_mul_f32 v18, s76, v18
  v_mul_f32 v19, s76, v19
  v_mfma_f32_16x16x32_bf16 v[216:219], v[92:95], v[248:251], v[216:219]
  v_mul_f32 v20, s76, v20
  v_mul_f32 v21, s76, v21
  v_mul_f32 v22, s76, v22
  v_mul_f32 v23, s76, v23
  v_mfma_f32_16x16x32_bf16 v[108:111], v[64:67], v[252:255], v[108:111]
  ds_read_b128 v[232:235], v14 offset:2048
  v_cvt_pk_bf16_f32 v24, v16, v17
  v_cvt_pk_bf16_f32 v25, v18, v19
  v_mfma_f32_16x16x32_bf16 v[124:127], v[68:71], v[252:255], v[124:127]
  ds_read_b128 v[236:239], v14 offset:3072
  v_cvt_pk_bf16_f32 v26, v20, v21
  v_cvt_pk_bf16_f32 v27, v22, v23
  v_mfma_f32_16x16x32_bf16 v[140:143], v[72:75], v[252:255], v[140:143]
  buffer_store_dwordx4 v[24:27], v2, s[40:43], s64 offen offset:2048 sc1
  v_add_u32 v9, 192, v1
  v_mul_u32_u24 v10, 6554, v9
  v_lshrrev_b32 v10, 16, v10
  v_mfma_f32_16x16x32_bf16 v[156:159], v[76:79], v[252:255], v[156:159]
  v_mul_u32_u24 v10, 1120, v10
  v_lshl_add_u32 v10, v9, 4, v10
  v_accvgpr_write_b32 a251, v10
  v_mfma_f32_16x16x32_bf16 v[172:175], v[80:83], v[252:255], v[172:175]
  v_add_u32 v9, 256, v1
  v_mul_u32_u24 v10, 6554, v9
  v_lshrrev_b32 v10, 16, v10
  v_mfma_f32_16x16x32_bf16 v[188:191], v[84:87], v[252:255], v[188:191]
  v_mul_u32_u24 v10, 1120, v10
  v_lshl_add_u32 v10, v9, 4, v10
  v_accvgpr_write_b32 a252, v10
  v_mfma_f32_16x16x32_bf16 v[204:207], v[88:91], v[252:255], v[204:207]
  v_mfma_f32_16x16x32_bf16 v[220:223], v[92:95], v[252:255], v[220:223]
  s_waitcnt vmcnt(14) lgkmcnt(0)
  v_mfma_f32_16x16x32_bf16 v[96:99], v[32:35], v[224:227], v[96:99]
  v_accvgpr_read_b32 v16, a120
  v_accvgpr_read_b32 v17, a121
  v_accvgpr_read_b32 v18, a122
  v_mfma_f32_16x16x32_bf16 v[112:115], v[36:39], v[224:227], v[112:115]
  s_mul_i32 s34, s20, 5120
  ds_read_b64_tr_b16 v[64:65], v12 offset:8192
  v_accvgpr_read_b32 v19, a123
  v_accvgpr_read_b32 v20, a124
  v_mfma_f32_16x16x32_bf16 v[128:131], v[40:43], v[224:227], v[128:131]
  s_add_u32 s34, s34, 131072
  ds_read_b64_tr_b16 v[66:67], v12 offset:9216
  v_accvgpr_read_b32 v21, a125
  v_accvgpr_read_b32 v22, a126
  v_mfma_f32_16x16x32_bf16 v[144:147], v[44:47], v[224:227], v[144:147]
  s_and_b32 s32, s21, 3
  buffer_load_dword v15, v8, s[40:43], 0 offen sc1
  v_accvgpr_read_b32 v23, a127
  v_mul_f32 v16, s76, v16
  v_mfma_f32_16x16x32_bf16 v[160:163], v[48:51], v[224:227], v[160:163]
  s_min_u32 s32, s32, 2
  ds_read_b64_tr_b16 v[68:69], v13 offset:8192
  v_mul_f32 v17, s76, v17
  v_mul_f32 v18, s76, v18
  v_mfma_f32_16x16x32_bf16 v[176:179], v[52:55], v[224:227], v[176:179]
  s_add_u32 s32, s32, 5
  ds_read_b64_tr_b16 v[70:71], v13 offset:9216
  v_mul_f32 v19, s76, v19
  v_mul_f32 v20, s76, v20
  v_mfma_f32_16x16x32_bf16 v[192:195], v[56:59], v[224:227], v[192:195]
  s_lshl_b32 s32, s32, 14
  ds_read_b64_tr_b16 v[72:73], v12 offset:8448
  v_mul_f32 v21, s76, v21
  v_mul_f32 v22, s76, v22
  v_mfma_f32_16x16x32_bf16 v[208:211], v[60:63], v[224:227], v[208:211]
  s_mov_b32 s9, -1
  ds_read_b64_tr_b16 v[74:75], v12 offset:9472
  v_mul_f32 v23, s76, v23
  v_mfma_f32_16x16x32_bf16 v[100:103], v[32:35], v[228:231], v[100:103]
  s_sub_u32 s23, s2, 64
  v_cvt_pk_bf16_f32 v28, v16, v17
  v_cvt_pk_bf16_f32 v29, v18, v19
  v_cvt_pk_bf16_f32 v30, v20, v21
  v_mfma_f32_16x16x32_bf16 v[116:119], v[36:39], v[228:231], v[116:119]
  s_cmp_lt_u32 s23, 96
  s_cselect_b32 s9, 0, s9
  ds_read_b64_tr_b16 v[76:77], v13 offset:8448
  v_cvt_pk_bf16_f32 v31, v22, v23
  v_mfma_f32_16x16x32_bf16 v[132:135], v[40:43], v[228:231], v[132:135]
  s_cmp_ge_u32 s2, 224
  s_cselect_b32 s9, 0, s9
  ds_read_b64_tr_b16 v[78:79], v13 offset:9472
  buffer_store_dwordx4 v[28:31], v2, s[40:43], s64 offen offset:3072 sc1
  v_accvgpr_read_b32 v16, a128
  v_mfma_f32_16x16x32_bf16 v[148:151], v[44:47], v[228:231], v[148:151]
  s_and_b32 s32, s32, s9
  ds_read_b128 v[240:243], v14 offset:32768
  v_accvgpr_read_b32 v17, a129
  v_accvgpr_read_b32 v18, a130
  v_mfma_f32_16x16x32_bf16 v[164:167], v[48:51], v[228:231], v[164:167]
  s_sub_u32 s23, s2, 170
  ds_read_b128 v[244:247], v14 offset:33792
  v_accvgpr_read_b32 v19, a131
  v_accvgpr_read_b32 v20, a132
  v_mfma_f32_16x16x32_bf16 v[180:183], v[52:55], v[228:231], v[180:183]
  s_cmp_lt_u32 s23, 54
  s_cselect_b32 s32, 98304, s32
  v_accvgpr_read_b32 v21, a133
  v_accvgpr_read_b32 v22, a134
  v_accvgpr_read_b32 v23, a135
  v_mfma_f32_16x16x32_bf16 v[196:199], v[56:59], v[228:231], v[196:199]
  s_mov_b32 s67, s2
  s_add_u32 s64, s64, 126976
  ds_read_b64_tr_b16 v[80:81], v12 offset:8704
  v_mul_f32 v16, s76, v16
  v_mfma_f32_16x16x32_bf16 v[212:215], v[60:63], v[228:231], v[212:215]
  s_mov_b32 s8, 0
  ds_read_b64_tr_b16 v[82:83], v12 offset:9728
  v_mul_f32 v17, s76, v17
  v_mul_f32 v18, s76, v18
  v_mfma_f32_16x16x32_bf16 v[104:107], v[32:35], v[232:235], v[104:107]
  s_mov_b32 s66, 0
  ds_read_b64_tr_b16 v[84:85], v13 offset:8704
  v_mul_f32 v19, s76, v19
  v_mul_f32 v20, s76, v20
  v_mfma_f32_16x16x32_bf16 v[120:123], v[36:39], v[232:235], v[120:123]
  s_mov_b32 s11, 0
  ds_read_b64_tr_b16 v[86:87], v13 offset:9728
  v_mul_f32 v21, s76, v21
  v_mul_f32 v22, s76, v22
  v_mfma_f32_16x16x32_bf16 v[136:139], v[40:43], v[232:235], v[136:139]
  s_mov_b32 s12, 0
  v_mul_f32 v23, s76, v23
  v_cvt_pk_bf16_f32 v24, v16, v17
  v_cvt_pk_bf16_f32 v25, v18, v19
  v_mfma_f32_16x16x32_bf16 v[152:155], v[44:47], v[232:235], v[152:155]
  s_lshl_b32 s15, s22, 1
  ds_read_b64_tr_b16 v[88:89], v12 offset:8960
  v_cvt_pk_bf16_f32 v26, v20, v21
  v_cvt_pk_bf16_f32 v27, v22, v23
  v_mfma_f32_16x16x32_bf16 v[168:171], v[48:51], v[232:235], v[168:171]
  s_add_u32 s23, s15, 6
  ds_read_b64_tr_b16 v[90:91], v12 offset:9984
  buffer_store_dwordx4 v[24:27], v2, s[40:43], s64 offen offset:0 sc1
  v_accvgpr_read_b32 v16, a136
  v_mfma_f32_16x16x32_bf16 v[184:187], v[52:55], v[232:235], v[184:187]
  s_sub_u32 s15, 24, s15
  ds_read_b64_tr_b16 v[92:93], v13 offset:8960
  v_accvgpr_read_b32 v17, a137
  v_accvgpr_read_b32 v18, a138
  v_mfma_f32_16x16x32_bf16 v[200:203], v[56:59], v[232:235], v[200:203]
  s_max_u32 s15, s15, s23
  ds_read_b64_tr_b16 v[94:95], v13 offset:9984
  v_accvgpr_read_b32 v19, a139
  v_mfma_f32_16x16x32_bf16 v[216:219], v[60:63], v[232:235], v[216:219]
  s_lshl_b32 s15, s15, 14
  v_accvgpr_read_b32 v20, a140
  v_accvgpr_read_b32 v21, a141
  v_accvgpr_read_b32 v22, a142
  v_mfma_f32_16x16x32_bf16 v[108:111], v[32:35], v[236:239], v[108:111]
  ds_read_b128 v[248:251], v14 offset:34816
  v_accvgpr_read_b32 v23, a143
  v_mul_f32 v16, s76, v16
  v_mfma_f32_16x16x32_bf16 v[124:127], v[36:39], v[236:239], v[124:127]
  ds_read_b128 v[252:255], v14 offset:35840
  v_mul_f32 v17, s76, v17
  v_mul_f32 v18, s76, v18
  v_mfma_f32_16x16x32_bf16 v[140:143], v[40:43], v[236:239], v[140:143]
  v_mul_f32 v19, s76, v19
  v_mul_f32 v20, s76, v20
  v_mul_f32 v21, s76, v21
  v_mfma_f32_16x16x32_bf16 v[156:159], v[44:47], v[236:239], v[156:159]
  v_xor_b32 v14, 0x10000, v14
  v_mul_f32 v22, s76, v22
  v_mul_f32 v23, s76, v23
  v_mfma_f32_16x16x32_bf16 v[172:175], v[48:51], v[236:239], v[172:175]
  v_cvt_pk_bf16_f32 v28, v16, v17
  v_cvt_pk_bf16_f32 v29, v18, v19
  v_cvt_pk_bf16_f32 v30, v20, v21
  v_mfma_f32_16x16x32_bf16 v[188:191], v[52:55], v[236:239], v[188:191]
  v_cvt_pk_bf16_f32 v31, v22, v23
  v_mfma_f32_16x16x32_bf16 v[204:207], v[56:59], v[236:239], v[204:207]
  buffer_store_dwordx4 v[28:31], v2, s[40:43], s64 offen offset:1024 sc1
  v_mfma_f32_16x16x32_bf16 v[220:223], v[60:63], v[236:239], v[220:223]
  s_waitcnt vmcnt(12) lgkmcnt(0)
  v_mfma_f32_16x16x32_bf16 v[96:99], v[64:67], v[240:243], v[96:99]
  s_barrier
  v_accvgpr_read_b32 v16, a144
  v_accvgpr_read_b32 v17, a145
  v_accvgpr_read_b32 v18, a146
  v_accvgpr_read_b32 v19, a147
  v_mfma_f32_16x16x32_bf16 v[112:115], v[68:71], v[240:243], v[112:115]
  s_and_b32 s23, s20, 1
  ds_read_b64_tr_b16 v[32:33], v12 offset:32768
  v_accvgpr_read_b32 v20, a148
  v_accvgpr_read_b32 v21, a149
  v_mfma_f32_16x16x32_bf16 v[128:131], v[72:75], v[240:243], v[128:131]
  s_lshl_b32 s23, s23, 12
  ds_read_b64_tr_b16 v[34:35], v12 offset:33792
  v_accvgpr_read_b32 v22, a150
  v_accvgpr_read_b32 v23, a151
  v_mfma_f32_16x16x32_bf16 v[144:147], v[76:79], v[240:243], v[144:147]
  s_cmp_lt_u32 s20, 2
  s_cselect_b32 s24, 106496, 0
  v_mul_f32 v16, s76, v16
  v_mul_f32 v17, s76, v17
  v_mul_f32 v18, s76, v18
  v_mfma_f32_16x16x32_bf16 v[160:163], v[80:83], v[240:243], v[160:163]
  s_add_u32 s24, s24, s23
  ds_read_b64_tr_b16 v[36:37], v13 offset:32768
  v_mul_f32 v19, s76, v19
  v_mul_f32 v20, s76, v20
  v_mfma_f32_16x16x32_bf16 v[176:179], v[84:87], v[240:243], v[176:179]
  s_lshl_b32 s26, s20, 12
  ds_read_b64_tr_b16 v[38:39], v13 offset:33792
  v_mul_f32 v21, s76, v21
  v_mul_f32 v22, s76, v22
  v_mfma_f32_16x16x32_bf16 v[192:195], v[88:91], v[240:243], v[192:195]
  s_mov_b32 s27, s26
  ds_read_b64_tr_b16 v[40:41], v12 offset:33024
  v_mul_f32 v23, s76, v23
  v_cvt_pk_bf16_f32 v24, v16, v17
  v_mfma_f32_16x16x32_bf16 v[208:211], v[92:95], v[240:243], v[208:211]
  s_add_u32 s25, s27, 49152
  ds_read_b64_tr_b16 v[42:43], v12 offset:34048
  v_cvt_pk_bf16_f32 v25, v18, v19
  v_cvt_pk_bf16_f32 v26, v20, v21
  v_cvt_pk_bf16_f32 v27, v22, v23
  v_mfma_f32_16x16x32_bf16 v[100:103], v[64:67], v[244:247], v[100:103]
  s_load_dwordx4 s[4:7], s[0:1], 64
  buffer_store_dwordx4 v[24:27], v2, s[40:43], s64 offen offset:2048 sc1
  v_accvgpr_read_b32 v16, a152
  v_accvgpr_read_b32 v17, a153
  v_mfma_f32_16x16x32_bf16 v[116:119], v[68:71], v[244:247], v[116:119]
  s_load_dwordx2 s[60:61], s[0:1], 80
  ds_read_b64_tr_b16 v[44:45], v13 offset:33024
  v_accvgpr_read_b32 v18, a154
  v_accvgpr_read_b32 v19, a155
  v_mfma_f32_16x16x32_bf16 v[132:135], v[72:75], v[244:247], v[132:135]
  s_add_u32 s23, s20, 1
  ds_read_b64_tr_b16 v[46:47], v13 offset:34048
  v_accvgpr_read_b32 v20, a156
  v_accvgpr_read_b32 v21, a157
  v_mfma_f32_16x16x32_bf16 v[148:151], v[76:79], v[244:247], v[148:151]
  s_lshr_b32 s23, s23, 1
  ds_read_b128 v[224:227], v14 offset:0
  v_accvgpr_read_b32 v22, a158
  v_accvgpr_read_b32 v23, a159
  v_mfma_f32_16x16x32_bf16 v[164:167], v[80:83], v[244:247], v[164:167]
  s_lshl_b32 s28, s22, 1
  ds_read_b128 v[228:231], v14 offset:1024
  v_mul_f32 v16, s76, v16
  v_mul_f32 v17, s76, v17
  v_mfma_f32_16x16x32_bf16 v[180:183], v[84:87], v[244:247], v[180:183]
  s_add_u32 s28, s28, s23
  v_mul_f32 v18, s76, v18
  v_mul_f32 v19, s76, v19
  v_mul_f32 v20, s76, v20
  v_mfma_f32_16x16x32_bf16 v[196:199], v[88:91], v[244:247], v[196:199]
  s_lshl_b32 s23, s22, 2
  ds_read_b64_tr_b16 v[48:49], v12 offset:33280
  v_mul_f32 v21, s76, v21
  v_mul_f32 v22, s76, v22
  v_mfma_f32_16x16x32_bf16 v[212:215], v[92:95], v[244:247], v[212:215]
  s_sub_u32 s29, 28, s23
  ds_read_b64_tr_b16 v[50:51], v12 offset:34304
  v_mul_f32 v23, s76, v23
  v_cvt_pk_bf16_f32 v28, v16, v17
  v_cvt_pk_bf16_f32 v29, v18, v19
  v_mfma_f32_16x16x32_bf16 v[104:107], v[64:67], v[248:251], v[104:107]
  s_and_b32 s23, s20, 1
  ds_read_b64_tr_b16 v[52:53], v13 offset:33280
  v_cvt_pk_bf16_f32 v30, v20, v21
  v_cvt_pk_bf16_f32 v31, v22, v23
  v_mfma_f32_16x16x32_bf16 v[120:123], v[68:71], v[248:251], v[120:123]
  s_add_u32 s29, s29, s23
  ds_read_b64_tr_b16 v[54:55], v13 offset:34304
  buffer_store_dwordx4 v[28:31], v2, s[40:43], s64 offen offset:3072 sc1
  v_accvgpr_read_b32 v16, a160
  v_mfma_f32_16x16x32_bf16 v[136:139], v[72:75], v[248:251], v[136:139]
  s_add_u32 s64, s64, 4096
  v_accvgpr_read_b32 v17, a161
  v_accvgpr_read_b32 v18, a162
  v_accvgpr_read_b32 v19, a163
  v_mfma_f32_16x16x32_bf16 v[152:155], v[76:79], v[248:251], v[152:155]
  ds_read_b64_tr_b16 v[56:57], v12 offset:33536
  v_accvgpr_read_b32 v20, a164
  v_accvgpr_read_b32 v21, a165
  v_mfma_f32_16x16x32_bf16 v[168:171], v[80:83], v[248:251], v[168:171]
  ds_read_b64_tr_b16 v[58:59], v12 offset:34560
  v_accvgpr_read_b32 v22, a166
  v_accvgpr_read_b32 v23, a167
  v_mfma_f32_16x16x32_bf16 v[184:187], v[84:87], v[248:251], v[184:187]
  ds_read_b64_tr_b16 v[60:61], v13 offset:33536
  v_mul_f32 v16, s76, v16
  v_mul_f32 v17, s76, v17
  v_mfma_f32_16x16x32_bf16 v[200:203], v[88:91], v[248:251], v[200:203]
  ds_read_b64_tr_b16 v[62:63], v13 offset:34560
  v_mul_f32 v18, s76, v18
  v_mul_f32 v19, s76, v19
  v_mul_f32 v20, s76, v20
  v_mfma_f32_16x16x32_bf16 v[216:219], v[92:95], v[248:251], v[216:219]
  v_mul_f32 v21, s76, v21
  v_mul_f32 v22, s76, v22
  v_mul_f32 v23, s76, v23
  v_mfma_f32_16x16x32_bf16 v[108:111], v[64:67], v[252:255], v[108:111]
  ds_read_b128 v[232:235], v14 offset:2048
  v_cvt_pk_bf16_f32 v24, v16, v17
  v_cvt_pk_bf16_f32 v25, v18, v19
  v_mfma_f32_16x16x32_bf16 v[124:127], v[68:71], v[252:255], v[124:127]
  ds_read_b128 v[236:239], v14 offset:3072
  v_cvt_pk_bf16_f32 v26, v20, v21
  v_cvt_pk_bf16_f32 v27, v22, v23
  v_mfma_f32_16x16x32_bf16 v[140:143], v[72:75], v[252:255], v[140:143]
  buffer_store_dwordx4 v[24:27], v2, s[40:43], s64 offen offset:0 sc1
  v_lshrrev_b32 v6, 2, v1
  v_mul_u32_u24 v6, 160, v6
  v_mfma_f32_16x16x32_bf16 v[156:159], v[76:79], v[252:255], v[156:159]
  v_and_b32 v9, 3, v1
  v_lshl_add_u32 v6, v9, 3, v6
  v_add_u32 v6, s34, v6
  v_mfma_f32_16x16x32_bf16 v[172:175], v[80:83], v[252:255], v[172:175]
  v_mov_b32 v3, v2
  v_mov_b32 v4, 0xff800000
  v_add_u32 v9, 106496, v2
  v_mfma_f32_16x16x32_bf16 v[188:191], v[84:87], v[252:255], v[188:191]
  v_mfma_f32_16x16x32_bf16 v[204:207], v[88:91], v[252:255], v[204:207]
  v_mfma_f32_16x16x32_bf16 v[220:223], v[92:95], v[252:255], v[220:223]
  s_waitcnt vmcnt(8) lgkmcnt(0)
  v_mfma_f32_16x16x32_bf16 v[96:99], v[32:35], v[224:227], v[96:99]
  v_accvgpr_read_b32 v16, a168
  v_accvgpr_read_b32 v17, a169
  v_accvgpr_read_b32 v18, a170
  v_mfma_f32_16x16x32_bf16 v[112:115], v[36:39], v[224:227], v[112:115]
  s_cmp_ge_u32 s20, 2
  s_cselect_b32 s4, s6, s4
  s_cselect_b32 s5, s7, s5
  ds_read_b64_tr_b16 v[64:65], v12 offset:40960
  v_accvgpr_read_b32 v19, a171
  v_accvgpr_read_b32 v20, a172
  v_mfma_f32_16x16x32_bf16 v[128:131], v[40:43], v[224:227], v[128:131]
  s_mov_b32 s62, 2211840
  ds_read_b64_tr_b16 v[66:67], v12 offset:41984
  v_accvgpr_read_b32 v21, a173
  v_accvgpr_read_b32 v22, a174
  v_mfma_f32_16x16x32_bf16 v[144:147], v[44:47], v[224:227], v[144:147]
  s_mov_b32 s63, 0x20000
  v_accvgpr_read_b32 v23, a175
  v_mul_f32 v16, s76, v16
  v_mul_f32 v17, s76, v17
  v_mfma_f32_16x16x32_bf16 v[160:163], v[48:51], v[224:227], v[160:163]
  s_mov_b64 s[56:57], s[52:53]
  ds_read_b64_tr_b16 v[68:69], v13 offset:40960
  v_mul_f32 v18, s76, v18
  v_mfma_f32_16x16x32_bf16 v[176:179], v[52:55], v[224:227], v[176:179]
  s_mov_b32 s58, s54
  ds_read_b64_tr_b16 v[70:71], v13 offset:41984
  v_mul_f32 v19, s76, v19
  v_mul_f32 v20, s76, v20
  v_mfma_f32_16x16x32_bf16 v[192:195], v[56:59], v[224:227], v[192:195]
  s_mov_b64 s[52:53], s[4:5]
  ds_read_b64_tr_b16 v[72:73], v12 offset:41216
  v_mul_f32 v21, s76, v21
  v_mul_f32 v22, s76, v22
  v_mfma_f32_16x16x32_bf16 v[208:211], v[60:63], v[224:227], v[208:211]
  s_mov_b32 s54, 2211840
  ds_read_b64_tr_b16 v[74:75], v12 offset:42240
  v_mul_f32 v23, s76, v23
  v_cvt_pk_bf16_f32 v28, v16, v17
  v_mfma_f32_16x16x32_bf16 v[100:103], v[32:35], v[228:231], v[100:103]
  s_getpc_b64 s[36:37]
fa_copc:
  v_cvt_pk_bf16_f32 v29, v18, v19
  v_cvt_pk_bf16_f32 v30, v20, v21
  v_cvt_pk_bf16_f32 v31, v22, v23
  v_mfma_f32_16x16x32_bf16 v[116:119], v[36:39], v[228:231], v[116:119]
  s_add_u32 s36, s36, fa_co-fa_copc-4
  s_addc_u32 s37, s37, 0
  ds_read_b64_tr_b16 v[76:77], v13 offset:41216
  buffer_store_dwordx4 v[28:31], v2, s[40:43], s64 offen offset:1024 sc1
  v_mfma_f32_16x16x32_bf16 v[132:135], v[40:43], v[228:231], v[132:135]
  ds_read_b64_tr_b16 v[78:79], v13 offset:42240
  v_accvgpr_read_b32 v16, a176
  v_accvgpr_read_b32 v17, a177
  v_mfma_f32_16x16x32_bf16 v[148:151], v[44:47], v[228:231], v[148:151]
  ds_read_b128 v[240:243], v14 offset:32768
  v_accvgpr_read_b32 v18, a178
  v_accvgpr_read_b32 v19, a179
  v_mfma_f32_16x16x32_bf16 v[164:167], v[48:51], v[228:231], v[164:167]
  ds_read_b128 v[244:247], v14 offset:33792
  v_accvgpr_read_b32 v20, a180
  v_accvgpr_read_b32 v21, a181
  v_mfma_f32_16x16x32_bf16 v[180:183], v[52:55], v[228:231], v[180:183]
  v_accvgpr_read_b32 v22, a182
  v_accvgpr_read_b32 v23, a183
  v_mul_f32 v16, s76, v16
  v_mfma_f32_16x16x32_bf16 v[196:199], v[56:59], v[228:231], v[196:199]
  ds_read_b64_tr_b16 v[80:81], v12 offset:41472
  v_mul_f32 v17, s76, v17
  v_mfma_f32_16x16x32_bf16 v[212:215], v[60:63], v[228:231], v[212:215]
  ds_read_b64_tr_b16 v[82:83], v12 offset:42496
  v_mul_f32 v18, s76, v18
  v_mul_f32 v19, s76, v19
  v_mfma_f32_16x16x32_bf16 v[104:107], v[32:35], v[232:235], v[104:107]
  ds_read_b64_tr_b16 v[84:85], v13 offset:41472
  v_mul_f32 v20, s76, v20
  v_mul_f32 v21, s76, v21
  v_mfma_f32_16x16x32_bf16 v[120:123], v[36:39], v[232:235], v[120:123]
  ds_read_b64_tr_b16 v[86:87], v13 offset:42496
  v_mul_f32 v22, s76, v22
  v_mul_f32 v23, s76, v23
  v_mfma_f32_16x16x32_bf16 v[136:139], v[40:43], v[232:235], v[136:139]
  v_cvt_pk_bf16_f32 v24, v16, v17
  v_cvt_pk_bf16_f32 v25, v18, v19
  v_cvt_pk_bf16_f32 v26, v20, v21
  v_mfma_f32_16x16x32_bf16 v[152:155], v[44:47], v[232:235], v[152:155]
  ds_read_b64_tr_b16 v[88:89], v12 offset:41728
  v_cvt_pk_bf16_f32 v27, v22, v23
  v_mfma_f32_16x16x32_bf16 v[168:171], v[48:51], v[232:235], v[168:171]
  ds_read_b64_tr_b16 v[90:91], v12 offset:42752
  buffer_store_dwordx4 v[24:27], v2, s[40:43], s64 offen offset:2048 sc1
  v_accvgpr_read_b32 v16, a184
  v_mfma_f32_16x16x32_bf16 v[184:187], v[52:55], v[232:235], v[184:187]
  ds_read_b64_tr_b16 v[92:93], v13 offset:41728
  v_accvgpr_read_b32 v17, a185
  v_accvgpr_read_b32 v18, a186
  v_mfma_f32_16x16x32_bf16 v[200:203], v[56:59], v[232:235], v[200:203]
  ds_read_b64_tr_b16 v[94:95], v13 offset:42752
  v_accvgpr_read_b32 v19, a187
  v_accvgpr_read_b32 v20, a188
  v_mfma_f32_16x16x32_bf16 v[216:219], v[60:63], v[232:235], v[216:219]
  v_accvgpr_read_b32 v21, a189
  v_accvgpr_read_b32 v22, a190
  v_accvgpr_read_b32 v23, a191
  v_mfma_f32_16x16x32_bf16 v[108:111], v[32:35], v[236:239], v[108:111]
  ds_read_b128 v[248:251], v14 offset:34816
  v_mul_f32 v16, s76, v16
  v_mfma_f32_16x16x32_bf16 v[124:127], v[36:39], v[236:239], v[124:127]
  ds_read_b128 v[252:255], v14 offset:35840
  v_mul_f32 v17, s76, v17
  v_mul_f32 v18, s76, v18
  v_mfma_f32_16x16x32_bf16 v[140:143], v[40:43], v[236:239], v[140:143]
  v_mul_f32 v19, s76, v19
  v_mul_f32 v20, s76, v20
  v_mul_f32 v21, s76, v21
  v_mfma_f32_16x16x32_bf16 v[156:159], v[44:47], v[236:239], v[156:159]
  v_xor_b32 v14, 0x10000, v14
  v_mul_f32 v22, s76, v22
  v_mul_f32 v23, s76, v23
  v_mfma_f32_16x16x32_bf16 v[172:175], v[48:51], v[236:239], v[172:175]
  v_cvt_pk_bf16_f32 v28, v16, v17
  v_cvt_pk_bf16_f32 v29, v18, v19
  v_cvt_pk_bf16_f32 v30, v20, v21
  v_mfma_f32_16x16x32_bf16 v[188:191], v[52:55], v[236:239], v[188:191]
  v_xor_b32 v12, 0x10000, v12
  v_cvt_pk_bf16_f32 v31, v22, v23
  v_mfma_f32_16x16x32_bf16 v[204:207], v[56:59], v[236:239], v[204:207]
  buffer_store_dwordx4 v[28:31], v2, s[40:43], s64 offen offset:3072 sc1
  v_xor_b32 v13, 0x10000, v13
  v_mfma_f32_16x16x32_bf16 v[220:223], v[60:63], v[236:239], v[220:223]
  s_waitcnt vmcnt(9) lgkmcnt(0)
  v_mfma_f32_16x16x32_bf16 v[96:99], v[64:67], v[240:243], v[96:99]
  s_barrier
  v_cmp_eq_u32 vcc, 0, v15
  v_mfma_f32_16x16x32_bf16 v[112:115], v[68:71], v[240:243], v[112:115]
  s_cbranch_vccnz fa_kv_spin
fa_kv_ok:
  v_mfma_f32_16x16x32_bf16 v[128:131], v[72:75], v[240:243], v[128:131]
  s_mov_b32 m0, s24
  v_mov_b32 v228, 0
  v_mfma_f32_16x16x32_bf16 v[144:147], v[76:79], v[240:243], v[144:147]
  buffer_load_dwordx4 v2, s[44:47], s26 offen offset:0 sc1 lds
  v_mfma_f32_16x16x32_bf16 v[160:163], v[80:83], v[240:243], v[160:163]
  s_add_u32 s24, s24, 32768
  v_mov_b32 v229, 0
  v_mfma_f32_16x16x32_bf16 v[176:179], v[84:87], v[240:243], v[176:179]
  s_and_b32 s24, s24, 0x1ffff
  buffer_load_dwordx4 v2, s[44:47], s26 offen offset:1024 sc1 lds
  v_mfma_f32_16x16x32_bf16 v[192:195], v[88:91], v[240:243], v[192:195]
  v_mov_b32 v230, 0
  v_mfma_f32_16x16x32_bf16 v[208:211], v[92:95], v[240:243], v[208:211]
  buffer_load_dwordx4 v2, s[44:47], s26 offen offset:2048 sc1 lds
  v_mfma_f32_16x16x32_bf16 v[100:103], v[64:67], v[244:247], v[100:103]
  v_mov_b32 v231, 0
  v_mfma_f32_16x16x32_bf16 v[116:119], v[68:71], v[244:247], v[116:119]
  buffer_load_dwordx4 v2, s[44:47], s26 offen offset:3072 sc1 lds
  v_mfma_f32_16x16x32_bf16 v[132:135], v[72:75], v[244:247], v[132:135]
  s_add_u32 s26, s26, 16384
  v_cvt_pk_bf16_f32 v32, v96, v97
  v_cvt_pk_bf16_f32 v33, v98, v99
  v_mfma_f32_16x16x32_bf16 v[148:151], v[76:79], v[244:247], v[148:151]
  v_cvt_pk_bf16_f32 v34, v112, v113
  v_cvt_pk_bf16_f32 v35, v114, v115
  v_mfma_f32_16x16x32_bf16 v[164:167], v[80:83], v[244:247], v[164:167]
  s_mov_b32 m0, s24
  v_cvt_pk_bf16_f32 v40, v128, v129
  v_mfma_f32_16x16x32_bf16 v[180:183], v[84:87], v[244:247], v[180:183]
  buffer_load_dwordx4 v2, s[44:47], s26 offen offset:0 sc1 lds
  v_cvt_pk_bf16_f32 v41, v130, v131
  v_cvt_pk_bf16_f32 v42, v144, v145
  v_mfma_f32_16x16x32_bf16 v[196:199], v[88:91], v[244:247], v[196:199]
  s_add_u32 s24, s24, 32768
  v_cvt_pk_bf16_f32 v43, v146, v147
  v_mfma_f32_16x16x32_bf16 v[212:215], v[92:95], v[244:247], v[212:215]
  s_and_b32 s24, s24, 0x1ffff
  buffer_load_dwordx4 v2, s[44:47], s26 offen offset:1024 sc1 lds
  v_cvt_pk_bf16_f32 v48, v160, v161
  v_cvt_pk_bf16_f32 v49, v162, v163
  v_mfma_f32_16x16x32_bf16 v[104:107], v[64:67], v[248:251], v[104:107]
  v_cvt_pk_bf16_f32 v50, v176, v177
  v_cvt_pk_bf16_f32 v51, v178, v179
  v_mfma_f32_16x16x32_bf16 v[120:123], v[68:71], v[248:251], v[120:123]
  buffer_load_dwordx4 v2, s[44:47], s26 offen offset:2048 sc1 lds
  v_cvt_pk_bf16_f32 v56, v192, v193
  v_mfma_f32_16x16x32_bf16 v[136:139], v[72:75], v[248:251], v[136:139]
  v_cvt_pk_bf16_f32 v57, v194, v195
  v_cvt_pk_bf16_f32 v58, v208, v209
  v_mfma_f32_16x16x32_bf16 v[152:155], v[76:79], v[248:251], v[152:155]
  buffer_load_dwordx4 v2, s[44:47], s26 offen offset:3072 sc1 lds
  v_cvt_pk_bf16_f32 v59, v210, v211
  v_mfma_f32_16x16x32_bf16 v[168:171], v[80:83], v[248:251], v[168:171]
  s_add_u32 s26, s26, 16384
  v_cvt_pk_bf16_f32 v36, v100, v101
  v_cvt_pk_bf16_f32 v37, v102, v103
  v_mfma_f32_16x16x32_bf16 v[184:187], v[84:87], v[248:251], v[184:187]
  v_cvt_pk_bf16_f32 v38, v116, v117
  v_mfma_f32_16x16x32_bf16 v[200:203], v[88:91], v[248:251], v[200:203]
  s_mov_b32 m0, s24
  v_cvt_pk_bf16_f32 v39, v118, v119
  v_cvt_pk_bf16_f32 v44, v132, v133
  v_mfma_f32_16x16x32_bf16 v[216:219], v[92:95], v[248:251], v[216:219]
  buffer_load_dwordx4 v2, s[44:47], s26 offen offset:0 sc1 lds
  v_cvt_pk_bf16_f32 v45, v134, v135
  v_mfma_f32_16x16x32_bf16 v[108:111], v[64:67], v[252:255], v[108:111]
  s_add_u32 s24, s24, 32768
  v_cvt_pk_bf16_f32 v46, v148, v149
  v_cvt_pk_bf16_f32 v47, v150, v151
  v_mfma_f32_16x16x32_bf16 v[124:127], v[68:71], v[252:255], v[124:127]
  s_and_b32 s24, s24, 0x1ffff
  buffer_load_dwordx4 v2, s[44:47], s26 offen offset:1024 sc1 lds
  v_cvt_pk_bf16_f32 v52, v164, v165
  v_mfma_f32_16x16x32_bf16 v[140:143], v[72:75], v[252:255], v[140:143]
  v_cvt_pk_bf16_f32 v53, v166, v167
  v_cvt_pk_bf16_f32 v54, v180, v181
  v_mfma_f32_16x16x32_bf16 v[156:159], v[76:79], v[252:255], v[156:159]
  buffer_load_dwordx4 v2, s[44:47], s26 offen offset:2048 sc1 lds
  v_cvt_pk_bf16_f32 v55, v182, v183
  v_mfma_f32_16x16x32_bf16 v[172:175], v[80:83], v[252:255], v[172:175]
  v_cvt_pk_bf16_f32 v60, v196, v197
  v_cvt_pk_bf16_f32 v61, v198, v199
  v_mfma_f32_16x16x32_bf16 v[188:191], v[84:87], v[252:255], v[188:191]
  buffer_load_dwordx4 v2, s[44:47], s26 offen offset:3072 sc1 lds
  v_cvt_pk_bf16_f32 v62, v212, v213
  v_mfma_f32_16x16x32_bf16 v[204:207], v[88:91], v[252:255], v[204:207]
  s_add_u32 s26, s26, 16384
  v_cvt_pk_bf16_f32 v63, v214, v215
  v_mfma_f32_16x16x32_bf16 v[220:223], v[92:95], v[252:255], v[220:223]
  s_mov_b32 m0, s25
  s_nop 0
  v_mfma_f32_32x32x16_bf16 a[0:15], v[228:231], v[228:231], 0
  buffer_load_dwordx4 v2, s[48:51], s27 offen offset:0 sc1 lds
  v_cvt_pk_bf16_f32 v64, v104, v105
  v_cvt_pk_bf16_f32 v65, v106, v107
  v_cvt_pk_bf16_f32 v66, v120, v121
  v_cvt_pk_bf16_f32 v67, v122, v123
  v_mfma_f32_32x32x16_bf16 a[16:31], v[228:231], v[228:231], 0
  buffer_load_dwordx4 v2, s[48:51], s27 offen offset:1024 sc1 lds
  v_cvt_pk_bf16_f32 v72, v136, v137
  v_cvt_pk_bf16_f32 v73, v138, v139
  v_cvt_pk_bf16_f32 v74, v152, v153
  v_cvt_pk_bf16_f32 v75, v154, v155
  v_mfma_f32_32x32x16_bf16 a[32:47], v[228:231], v[228:231], 0
  buffer_load_dwordx4 v2, s[48:51], s27 offen offset:2048 sc1 lds
  v_cvt_pk_bf16_f32 v80, v168, v169
  v_cvt_pk_bf16_f32 v81, v170, v171
  v_cvt_pk_bf16_f32 v82, v184, v185
  v_cvt_pk_bf16_f32 v83, v186, v187
  v_mfma_f32_32x32x16_bf16 a[48:63], v[228:231], v[228:231], 0
  buffer_load_dwordx4 v2, s[48:51], s27 offen offset:3072 sc1 lds
  v_cvt_pk_bf16_f32 v88, v200, v201
  v_cvt_pk_bf16_f32 v89, v202, v203
  v_cvt_pk_bf16_f32 v90, v216, v217
  v_cvt_pk_bf16_f32 v91, v218, v219
  s_add_u32 s27, s27, 16384
  s_add_u32 s25, s25, 32768
  s_and_b32 s25, s25, 0x1ffff
  s_mov_b32 m0, s25
  s_nop 0
  v_mfma_f32_32x32x16_bf16 a[64:79], v[228:231], v[228:231], 0
  buffer_load_dwordx4 v2, s[48:51], s27 offen offset:0 sc1 lds
  v_cvt_pk_bf16_f32 v68, v108, v109
  v_cvt_pk_bf16_f32 v69, v110, v111
  v_cvt_pk_bf16_f32 v70, v124, v125
  v_cvt_pk_bf16_f32 v71, v126, v127
  v_mfma_f32_32x32x16_bf16 a[80:95], v[228:231], v[228:231], 0
  buffer_load_dwordx4 v2, s[48:51], s27 offen offset:1024 sc1 lds
  v_cvt_pk_bf16_f32 v76, v140, v141
  v_cvt_pk_bf16_f32 v77, v142, v143
  v_cvt_pk_bf16_f32 v78, v156, v157
  v_cvt_pk_bf16_f32 v79, v158, v159
  v_mfma_f32_32x32x16_bf16 a[96:111], v[228:231], v[228:231], 0
  buffer_load_dwordx4 v2, s[48:51], s27 offen offset:2048 sc1 lds
  v_cvt_pk_bf16_f32 v84, v172, v173
  v_cvt_pk_bf16_f32 v85, v174, v175
  v_cvt_pk_bf16_f32 v86, v188, v189
  v_cvt_pk_bf16_f32 v87, v190, v191
  v_mfma_f32_32x32x16_bf16 a[112:127], v[228:231], v[228:231], 0
  buffer_load_dwordx4 v2, s[48:51], s27 offen offset:3072 sc1 lds
  v_cvt_pk_bf16_f32 v92, v204, v205
  v_cvt_pk_bf16_f32 v93, v206, v207
  v_cvt_pk_bf16_f32 v94, v220, v221
  v_cvt_pk_bf16_f32 v95, v222, v223
  s_add_u32 s27, s27, 16384
  s_add_u32 s25, s25, 32768
  s_and_b32 s25, s25, 0x1ffff
  s_waitcnt vmcnt(12)
  s_barrier
  ds_read_b128 a[128:131], v9 offset:0
  ds_read_b128 a[132:135], v9 offset:1024
  ds_read_b128 a[136:139], v9 offset:2048
  ds_read_b128 a[140:143], v9 offset:3072
  ds_read_b128 a[144:147], v9 offset:4096
  ds_read_b128 a[148:151], v9 offset:5120
  ds_read_b128 a[152:155], v9 offset:6144
  ds_read_b128 a[156:159], v9 offset:7168
  buffer_store_dword v4, off, s[40:43], s65 offset:32 sc1
  v_add_u32 v13, 32, v8
  v_mov_b32 v14, 0
  s_cmp_eq_u32 s2, 255
  s_cbranch_scc1 fa_top8
fa_notop:
  s_waitcnt lgkmcnt(4)
  v_mfma_f32_16x16x32_bf16 v[96:99], a[128:131], v[32:35], 0
  v_mfma_f32_16x16x32_bf16 v[104:107], a[128:131], v[36:39], 0
  v_mfma_f32_16x16x32_bf16 v[128:131], a[128:131], v[64:67], 0
  v_mfma_f32_16x16x32_bf16 v[136:139], a[128:131], v[68:71], 0
  s_mov_b32 m0, s24
  ds_read_b128 a[128:131], v3 offset:0
  v_mfma_f32_16x16x32_bf16 v[100:103], a[132:135], v[32:35], 0
  buffer_load_dwordx4 v2, s[44:47], s26 offen offset:0 sc1 lds
  v_mfma_f32_16x16x32_bf16 v[108:111], a[132:135], v[36:39], 0
  v_mfma_f32_16x16x32_bf16 v[132:135], a[132:135], v[64:67], 0
  v_mfma_f32_16x16x32_bf16 v[140:143], a[132:135], v[68:71], 0
  ds_read_b128 a[132:135], v3 offset:1024
  v_mfma_f32_16x16x32_bf16 v[96:99], a[136:139], v[40:43], v[96:99]
  v_mfma_f32_16x16x32_bf16 v[104:107], a[136:139], v[44:47], v[104:107]
  v_mfma_f32_16x16x32_bf16 v[128:131], a[136:139], v[72:75], v[128:131]
  buffer_load_dwordx4 v2, s[44:47], s26 offen offset:1024 sc1 lds
  v_mfma_f32_16x16x32_bf16 v[136:139], a[136:139], v[76:79], v[136:139]
  ds_read_b128 a[136:139], v3 offset:2048
  v_mfma_f32_16x16x32_bf16 v[100:103], a[140:143], v[40:43], v[100:103]
  v_mfma_f32_16x16x32_bf16 v[108:111], a[140:143], v[44:47], v[108:111]
  v_mfma_f32_16x16x32_bf16 v[132:135], a[140:143], v[72:75], v[132:135]
  v_mfma_f32_16x16x32_bf16 v[140:143], a[140:143], v[76:79], v[140:143]
  s_waitcnt lgkmcnt(3)
  ds_read_b128 a[140:143], v3 offset:3072
  v_mfma_f32_16x16x32_bf16 v[96:99], a[144:147], v[48:51], v[96:99]
  v_mfma_f32_16x16x32_bf16 v[104:107], a[144:147], v[52:55], v[104:107]
  v_mfma_f32_16x16x32_bf16 v[128:131], a[144:147], v[80:83], v[128:131]
  buffer_load_dwordx4 v2, s[44:47], s26 offen offset:2048 sc1 lds
  v_mfma_f32_16x16x32_bf16 v[136:139], a[144:147], v[84:87], v[136:139]
  ds_read_b128 a[144:147], v3 offset:4096
  v_mfma_f32_16x16x32_bf16 v[100:103], a[148:151], v[48:51], v[100:103]
  v_mfma_f32_16x16x32_bf16 v[108:111], a[148:151], v[52:55], v[108:111]
  v_mfma_f32_16x16x32_bf16 v[132:135], a[148:151], v[80:83], v[132:135]
  v_mfma_f32_16x16x32_bf16 v[140:143], a[148:151], v[84:87], v[140:143]
  ds_read_b128 a[148:151], v3 offset:5120
  v_mfma_f32_16x16x32_bf16 v[96:99], a[152:155], v[56:59], v[96:99]
  buffer_load_dwordx4 v2, s[44:47], s26 offen offset:3072 sc1 lds
  v_mfma_f32_16x16x32_bf16 v[104:107], a[152:155], v[60:63], v[104:107]
  s_add_u32 s26, s26, 16384
  v_mfma_f32_16x16x32_bf16 v[128:131], a[152:155], v[88:91], v[128:131]
  s_add_u32 s24, s24, 32768
  v_mfma_f32_16x16x32_bf16 v[136:139], a[152:155], v[92:95], v[136:139]
  s_and_b32 s24, s24, 0x1ffff
  ds_read_b128 a[152:155], v3 offset:6144
  v_mfma_f32_16x16x32_bf16 v[100:103], a[156:159], v[56:59], v[100:103]
  v_mfma_f32_16x16x32_bf16 v[108:111], a[156:159], v[60:63], v[108:111]
  v_mfma_f32_16x16x32_bf16 v[132:135], a[156:159], v[88:91], v[132:135]
  v_mfma_f32_16x16x32_bf16 v[140:143], a[156:159], v[92:95], v[140:143]
  s_waitcnt lgkmcnt(3)
  ds_read_b128 a[156:159], v3 offset:7168
  s_nop 7
  s_cmp_lg_u32 s28, 0
  s_cbranch_scc1 fa_nomask0
  v_cndmask_b32 v96, v4, v96, s[68:69]
  v_cndmask_b32 v97, v4, v97, s[70:71]
  v_cndmask_b32 v98, v4, v98, s[72:73]
  v_cndmask_b32 v99, v4, v99, s[74:75]
  v_mov_b32 v100, v4
  v_mov_b32 v101, v4
  v_mov_b32 v102, v4
  v_mov_b32 v103, v4
  v_cndmask_b32 v108, v4, v108, s[68:69]
  v_cndmask_b32 v109, v4, v109, s[70:71]
  v_cndmask_b32 v110, v4, v110, s[72:73]
  v_cndmask_b32 v111, v4, v111, s[74:75]
fa_nomask0:
  v_max3_f32 v16, v96, v97, v98
  v_max3_f32 v16, v16, v99, v100
  v_max3_f32 v16, v16, v101, v102
  v_max_f32 v16, v16, v103
  v_max3_f32 v17, v104, v105, v106
  v_max3_f32 v17, v17, v107, v108
  v_max3_f32 v17, v17, v109, v110
  v_max_f32 v17, v17, v111
  v_max3_f32 v18, v128, v129, v130
  v_max3_f32 v18, v18, v131, v132
  v_max3_f32 v18, v18, v133, v134
  v_max_f32 v18, v18, v135
  v_max3_f32 v19, v136, v137, v138
  v_max3_f32 v19, v19, v139, v140
  v_max3_f32 v19, v19, v141, v142
  v_max_f32 v19, v19, v143
  v_mov_b32 v20, v16
  v_mov_b32 v21, v17
  v_mov_b32 v22, v18
  v_mov_b32 v23, v19
  s_nop 0
  v_permlane16_swap_b32 v16, v20
  v_permlane16_swap_b32 v17, v21
  v_permlane16_swap_b32 v18, v22
  v_permlane16_swap_b32 v19, v23
  v_max_f32 v16, v16, v20
  v_max_f32 v17, v17, v21
  v_max_f32 v18, v18, v22
  v_max_f32 v19, v19, v23
  v_mov_b32 v20, v16
  v_mov_b32 v21, v17
  v_mov_b32 v22, v18
  v_mov_b32 v23, v19
  s_nop 0
  v_permlane32_swap_b32 v16, v20
  v_permlane32_swap_b32 v17, v21
  v_permlane32_swap_b32 v18, v22
  v_permlane32_swap_b32 v19, v23
  v_max_f32 v16, v16, v20
  v_max_f32 v17, v17, v21
  v_max_f32 v18, v18, v22
  v_max_f32 v19, v19, v23
  v_sub_f32 v192, 0, v16
  v_sub_f32 v193, 0, v16
  v_sub_f32 v194, 0, v16
  v_sub_f32 v195, 0, v16
  v_sub_f32 v196, 0, v17
  v_sub_f32 v197, 0, v17
  v_sub_f32 v198, 0, v17
  v_sub_f32 v199, 0, v17
  v_sub_f32 v200, 0, v18
  v_sub_f32 v201, 0, v18
  v_sub_f32 v202, 0, v18
  v_sub_f32 v203, 0, v18
  v_sub_f32 v204, 0, v19
  v_sub_f32 v205, 0, v19
  v_sub_f32 v206, 0, v19
  v_sub_f32 v207, 0, v19
  v_sub_f32 v96, v96, v16
  v_sub_f32 v97, v97, v16
  v_sub_f32 v98, v98, v16
  v_sub_f32 v99, v99, v16
  v_sub_f32 v100, v100, v16
  v_sub_f32 v101, v101, v16
  v_sub_f32 v102, v102, v16
  v_sub_f32 v103, v103, v16
  v_sub_f32 v104, v104, v17
  v_sub_f32 v105, v105, v17
  v_sub_f32 v106, v106, v17
  v_sub_f32 v107, v107, v17
  v_sub_f32 v108, v108, v17
  v_sub_f32 v109, v109, v17
  v_sub_f32 v110, v110, v17
  v_sub_f32 v111, v111, v17
  v_sub_f32 v128, v128, v18
  v_sub_f32 v129, v129, v18
  v_sub_f32 v130, v130, v18
  v_sub_f32 v131, v131, v18
  v_sub_f32 v132, v132, v18
  v_sub_f32 v133, v133, v18
  v_sub_f32 v134, v134, v18
  v_sub_f32 v135, v135, v18
  v_sub_f32 v136, v136, v19
  v_sub_f32 v137, v137, v19
  v_sub_f32 v138, v138, v19
  v_sub_f32 v139, v139, v19
  v_sub_f32 v140, v140, v19
  v_sub_f32 v141, v141, v19
  v_sub_f32 v142, v142, v19
  v_sub_f32 v143, v143, v19
  v_mfma_f32_16x16x32_bf16 v[112:115], a[128:131], v[32:35], v[192:195]
  v_exp_f32 v216, v128
  v_exp_f32 v217, v129
  v_mfma_f32_16x16x32_bf16 v[120:123], a[128:131], v[36:39], v[196:199]
  v_exp_f32 v218, v130
  v_add_f32 v226, v216, v217
  v_cvt_pk_bf16_f32 v176, v216, v217
  v_mfma_f32_16x16x32_bf16 v[144:147], a[128:131], v[64:67], v[200:203]
  s_add_u32 s66, s66, 32768
  v_exp_f32 v219, v131
  v_add_f32 v226, v226, v218
  v_add_f32 v226, v226, v219
  v_mfma_f32_16x16x32_bf16 v[152:155], a[128:131], v[68:71], v[204:207]
  s_mov_b32 m0, s25
  ds_read_b128 a[128:131], v3 offset:8192
  v_exp_f32 v220, v132
  v_cvt_pk_bf16_f32 v177, v218, v219
  v_mfma_f32_16x16x32_bf16 v[116:119], a[132:135], v[32:35], v[192:195]
  s_and_b32 s66, s66, 0x1ffff
  buffer_load_dwordx4 v2, s[48:51], s27 offen offset:0 sc1 lds
  v_exp_f32 v221, v133
  v_add_f32 v226, v226, v220
  v_add_f32 v226, v226, v221
  v_mfma_f32_16x16x32_bf16 v[124:127], a[132:135], v[36:39], v[196:199]
  v_exp_f32 v222, v134
  v_cvt_pk_bf16_f32 v178, v220, v221
  v_exp_f32 v223, v135
  v_mfma_f32_16x16x32_bf16 v[148:151], a[132:135], v[64:67], v[200:203]
  v_exp_f32 v216, v136
  v_add_f32 v226, v226, v222
  v_mfma_f32_16x16x32_bf16 v[156:159], a[132:135], v[68:71], v[204:207]
  ds_read_b128 a[132:135], v3 offset:9216
  v_exp_f32 v217, v137
  v_add_f32 v226, v226, v223
  v_mfma_f32_16x16x32_bf16 v[112:115], a[136:139], v[40:43], v[112:115]
  v_exp_f32 v218, v138
  v_cvt_pk_bf16_f32 v179, v222, v223
  v_add_f32 v227, v216, v217
  v_mfma_f32_16x16x32_bf16 v[120:123], a[136:139], v[44:47], v[120:123]
  v_exp_f32 v219, v139
  v_cvt_pk_bf16_f32 v180, v216, v217
  v_add_f32 v227, v227, v218
  v_add_f32 v227, v227, v219
  v_mfma_f32_16x16x32_bf16 v[144:147], a[136:139], v[72:75], v[144:147]
  buffer_load_dwordx4 v2, s[48:51], s27 offen offset:1024 sc1 lds
  v_exp_f32 v220, v140
  v_cvt_pk_bf16_f32 v181, v218, v219
  v_mfma_f32_16x16x32_bf16 v[152:155], a[136:139], v[76:79], v[152:155]
  ds_read_b128 a[136:139], v3 offset:10240
  v_exp_f32 v221, v141
  v_add_f32 v227, v227, v220
  v_mfma_f32_16x16x32_bf16 v[116:119], a[140:143], v[40:43], v[116:119]
  v_exp_f32 v222, v142
  v_add_f32 v227, v227, v221
  v_cvt_pk_bf16_f32 v182, v220, v221
  v_mfma_f32_16x16x32_bf16 v[124:127], a[140:143], v[44:47], v[124:127]
  v_exp_f32 v223, v143
  v_add_f32 v227, v227, v222
  v_add_f32 v227, v227, v223
  v_exp_f32 v208, v96
  v_mfma_f32_16x16x32_bf16 v[148:151], a[140:143], v[72:75], v[148:151]
  v_exp_f32 v209, v97
  v_cvt_pk_bf16_f32 v183, v222, v223
  v_mfma_f32_16x16x32_bf16 v[156:159], a[140:143], v[76:79], v[156:159]
  s_waitcnt lgkmcnt(3)
  ds_read_b128 a[140:143], v3 offset:11264
  v_exp_f32 v210, v98
  v_add_f32 v224, v208, v209
  v_mfma_f32_16x16x32_bf16 v[112:115], a[144:147], v[48:51], v[112:115]
  v_exp_f32 v211, v99
  v_cvt_pk_bf16_f32 v160, v208, v209
  v_add_f32 v224, v224, v210
  v_mfma_f32_16x16x32_bf16 v[120:123], a[144:147], v[52:55], v[120:123]
  v_exp_f32 v212, v100
  v_add_f32 v224, v224, v211
  v_cvt_pk_bf16_f32 v161, v210, v211
  v_mfma_f32_16x16x32_bf16 v[144:147], a[144:147], v[80:83], v[144:147]
  buffer_load_dwordx4 v2, s[48:51], s27 offen offset:2048 sc1 lds
  v_exp_f32 v213, v101
  v_add_f32 v224, v224, v212
  v_add_f32 v224, v224, v213
  v_mfma_f32_16x16x32_bf16 v[152:155], a[144:147], v[84:87], v[152:155]
  ds_read_b128 a[144:147], v3 offset:12288
  v_exp_f32 v214, v102
  v_cvt_pk_bf16_f32 v162, v212, v213
  v_mfma_f32_16x16x32_bf16 v[116:119], a[148:151], v[48:51], v[116:119]
  v_exp_f32 v215, v103
  v_add_f32 v224, v224, v214
  v_add_f32 v224, v224, v215
  v_mfma_f32_16x16x32_bf16 v[124:127], a[148:151], v[52:55], v[124:127]
  v_exp_f32 v208, v104
  v_exp_f32 v209, v105
  v_mfma_f32_16x16x32_bf16 v[148:151], a[148:151], v[80:83], v[148:151]
  v_exp_f32 v210, v106
  v_cvt_pk_bf16_f32 v163, v214, v215
  v_add_f32 v225, v208, v209
  v_mfma_f32_16x16x32_bf16 v[156:159], a[148:151], v[84:87], v[156:159]
  ds_read_b128 a[148:151], v3 offset:13312
  v_exp_f32 v211, v107
  v_cvt_pk_bf16_f32 v164, v208, v209
  v_add_f32 v225, v225, v210
  v_mfma_f32_16x16x32_bf16 v[112:115], a[152:155], v[56:59], v[112:115]
  buffer_load_dwordx4 v2, s[48:51], s27 offen offset:3072 sc1 lds
  v_exp_f32 v212, v108
  v_add_f32 v225, v225, v211
  v_mfma_f32_16x16x32_bf16 v[120:123], a[152:155], v[60:63], v[120:123]
  s_add_u32 s27, s27, 16384
  v_exp_f32 v213, v109
  v_mfma_f32_16x16x32_bf16 v[144:147], a[152:155], v[88:91], v[144:147]
  s_add_u32 s25, s25, 32768
  v_exp_f32 v214, v110
  v_mfma_f32_16x16x32_bf16 v[152:155], a[152:155], v[92:95], v[152:155]
  s_and_b32 s25, s25, 0x1ffff
  ds_read_b128 a[152:155], v3 offset:14336
  v_cvt_pk_bf16_f32 v165, v210, v211
  v_max3_f32 v5, v226, v227, v224
  v_add_f32 v225, v225, v212
  v_add_f32 v225, v225, v213
  v_cvt_pk_bf16_f32 v166, v212, v213
  v_exp_f32 v215, v111
  v_mfma_f32_16x16x32_bf16 v[116:119], a[156:159], v[56:59], v[116:119]
  v_add_f32 v225, v225, v214
  v_add_f32 v225, v225, v215
  v_max_f32 v5, v5, v225
  v_cmp_lt_f32 vcc, s81, v5
  v_mfma_f32_16x16x32_bf16 v[124:127], a[156:159], v[60:63], v[124:127]
  v_mfma_f32_16x16x32_bf16 v[148:151], a[156:159], v[88:91], v[148:151]
  v_cvt_pk_bf16_f32 v167, v214, v215
  v_mfma_f32_16x16x32_bf16 v[156:159], a[156:159], v[92:95], v[156:159]
  s_waitcnt lgkmcnt(3)
  s_cbranch_vccnz fa_stub0
fa_back0:
  ds_read_b128 a[156:159], v3 offset:15360
  v_add_f32 v228, v228, v224
  v_add_f32 v229, v229, v225
  v_add_f32 v230, v230, v226
  v_add_f32 v231, v231, v227
  s_nop 3
  v_exp_f32 v216, v144
  v_exp_f32 v217, v145
  v_add_u32 v3, s66, v2
  buffer_load_dword v14, v13, s[40:43], 0 offen sc1
  s_cmp_eq_u32 s28, 0
  s_cbranch_scc1 fa_AV
  s_sub_u32 s28, s28, 1
  s_cmp_eq_u32 s28, 0
  s_cbranch_scc1 fa_Aexit
.p2align 6
fa_DD:
  v_mfma_f32_16x16x32_bf16 v[96:99], a[128:131], v[32:35], v[192:195]
  s_waitcnt vmcnt(12)
  v_exp_f32 v218, v146
  v_mfma_f32_16x16x32_bf16 v[104:107], a[128:131], v[36:39], v[196:199]
  s_barrier
  v_exp_f32 v219, v147
  v_mfma_f32_16x16x32_bf16 v[128:131], a[128:131], v[64:67], v[200:203]
  s_cmp_ge_u32 s26, s32
  ds_read_b128 a[160:163], v3 offset:16384
  v_add_f32 v226, v216, v217
  v_mfma_f32_16x16x32_bf16 v[136:139], a[128:131], v[68:71], v[204:207]
  s_cbranch_scc1 fa_hk4
fa_hb4:
  v_exp_f32 v220, v148
  v_mfma_f32_16x16x32_bf16 v[100:103], a[132:135], v[32:35], v[192:195]
  ds_read_b128 a[164:167], v3 offset:17408
  v_cvt_pk_bf16_f32 v184, v216, v217
  v_mfma_f32_16x16x32_bf16 v[108:111], a[132:135], v[36:39], v[196:199]
  s_mov_b32 m0, s24
  v_exp_f32 v221, v149
  v_mfma_f32_16x16x32_bf16 v[132:135], a[132:135], v[64:67], v[200:203]
  buffer_load_dwordx4 v2, s[44:47], s26 offen offset:0 sc1 lds
  v_add_f32 v226, v226, v218
  v_mfma_f32_16x16x32_bf16 v[140:143], a[132:135], v[68:71], v[204:207]
  v_exp_f32 v222, v150
  v_mfma_f32_16x16x32_bf16 v[96:99], a[136:139], v[40:43], v[96:99]
  ds_read_b128 a[168:171], v3 offset:18432
  v_add_f32 v226, v226, v219
  v_mfma_f32_16x16x32_bf16 v[104:107], a[136:139], v[44:47], v[104:107]
  v_exp_f32 v223, v151
  v_mfma_f32_16x16x32_bf16 v[128:131], a[136:139], v[72:75], v[128:131]
  v_cvt_pk_bf16_f32 v185, v218, v219
  v_add_f32 v226, v226, v220
  v_mfma_f32_16x16x32_bf16 v[136:139], a[136:139], v[76:79], v[136:139]
  v_exp_f32 v216, v152
  v_mfma_f32_16x16x32_bf16 v[100:103], a[140:143], v[40:43], v[100:103]
  ds_read_b128 a[172:175], v3 offset:19456
  v_add_f32 v226, v226, v221
  v_mfma_f32_16x16x32_bf16 v[108:111], a[140:143], v[44:47], v[108:111]
  v_exp_f32 v217, v153
  v_mfma_f32_16x16x32_bf16 v[132:135], a[140:143], v[72:75], v[132:135]
  v_cvt_pk_bf16_f32 v186, v220, v221
  v_add_f32 v226, v226, v222
  v_mfma_f32_16x16x32_bf16 v[140:143], a[140:143], v[76:79], v[140:143]
  s_waitcnt lgkmcnt(4)
  v_exp_f32 v218, v154
  v_mfma_f32_16x16x32_bf16 v[96:99], a[144:147], v[48:51], v[96:99]
  ds_read_b128 a[176:179], v3 offset:20480
  v_add_f32 v226, v226, v223
  v_mfma_f32_16x16x32_bf16 v[104:107], a[144:147], v[52:55], v[104:107]
  v_exp_f32 v219, v155
  v_mfma_f32_16x16x32_bf16 v[128:131], a[144:147], v[80:83], v[128:131]
  v_cvt_pk_bf16_f32 v187, v222, v223
  v_add_f32 v227, v216, v217
  v_mfma_f32_16x16x32_bf16 v[136:139], a[144:147], v[84:87], v[136:139]
  v_exp_f32 v220, v156
  v_mfma_f32_16x16x32_bf16 v[100:103], a[148:151], v[48:51], v[100:103]
  ds_read_b128 a[180:183], v3 offset:21504
  v_cvt_pk_bf16_f32 v188, v216, v217
  v_mfma_f32_16x16x32_bf16 v[108:111], a[148:151], v[52:55], v[108:111]
  v_exp_f32 v221, v157
  v_mfma_f32_16x16x32_bf16 v[132:135], a[148:151], v[80:83], v[132:135]
  buffer_load_dwordx4 v2, s[44:47], s26 offen offset:1024 sc1 lds
  v_add_f32 v227, v227, v218
  v_mfma_f32_16x16x32_bf16 v[140:143], a[148:151], v[84:87], v[140:143]
  v_exp_f32 v222, v158
  v_mfma_f32_16x16x32_bf16 v[96:99], a[152:155], v[56:59], v[96:99]
  ds_read_b128 a[184:187], v3 offset:22528
  v_add_f32 v227, v227, v219
  v_mfma_f32_16x16x32_bf16 v[104:107], a[152:155], v[60:63], v[104:107]
  v_exp_f32 v223, v159
  v_mfma_f32_16x16x32_bf16 v[128:131], a[152:155], v[88:91], v[128:131]
  v_cvt_pk_bf16_f32 v189, v218, v219
  v_add_f32 v227, v227, v220
  v_mfma_f32_16x16x32_bf16 v[136:139], a[152:155], v[92:95], v[136:139]
  v_exp_f32 v208, v112
  v_mfma_f32_16x16x32_bf16 v[100:103], a[156:159], v[56:59], v[100:103]
  ds_read_b128 a[188:191], v3 offset:23552
  v_add_f32 v227, v227, v221
  v_mfma_f32_16x16x32_bf16 v[108:111], a[156:159], v[60:63], v[108:111]
  v_exp_f32 v209, v113
  v_mfma_f32_16x16x32_bf16 v[132:135], a[156:159], v[88:91], v[132:135]
  v_cvt_pk_bf16_f32 v190, v220, v221
  v_add_f32 v227, v227, v222
  v_add_f32 v227, v227, v223
  v_mfma_f32_16x16x32_bf16 v[140:143], a[156:159], v[92:95], v[140:143]
  s_waitcnt lgkmcnt(4)
  v_exp_f32 v210, v114
  v_mfma_f32_16x16x32_bf16 a[0:3], a[160:163], v[160:163], a[0:3]
  ds_read_b128 a[128:131], v3 offset:0
  v_cvt_pk_bf16_f32 v191, v222, v223
  v_mfma_f32_16x16x32_bf16 a[4:7], a[160:163], v[164:167], a[4:7]
  v_exp_f32 v211, v115
  v_mfma_f32_16x16x32_bf16 a[64:67], a[160:163], v[176:179], a[64:67]
  v_exp_f32 v212, v116
  v_mfma_f32_16x16x32_bf16 a[68:71], a[160:163], v[180:183], a[68:71]
  v_add_f32 v224, v208, v209
  v_cvt_pk_bf16_f32 v168, v208, v209
  v_mfma_f32_16x16x32_bf16 a[8:11], a[164:167], v[160:163], a[8:11]
  ds_read_b128 a[132:135], v3 offset:1024
  v_add_f32 v224, v224, v210
  v_mfma_f32_16x16x32_bf16 a[12:15], a[164:167], v[164:167], a[12:15]
  v_exp_f32 v213, v117
  v_mfma_f32_16x16x32_bf16 a[72:75], a[164:167], v[176:179], a[72:75]
  buffer_load_dwordx4 v2, s[44:47], s26 offen offset:2048 sc1 lds
  v_add_f32 v224, v224, v211
  v_mfma_f32_16x16x32_bf16 a[76:79], a[164:167], v[180:183], a[76:79]
  v_exp_f32 v214, v118
  v_mfma_f32_16x16x32_bf16 a[16:19], a[168:171], v[160:163], a[16:19]
  ds_read_b128 a[136:139], v3 offset:2048
  v_cvt_pk_bf16_f32 v169, v210, v211
  v_mfma_f32_16x16x32_bf16 a[20:23], a[168:171], v[164:167], a[20:23]
  v_exp_f32 v215, v119
  v_mfma_f32_16x16x32_bf16 a[80:83], a[168:171], v[176:179], a[80:83]
  v_add_f32 v224, v224, v212
  v_add_f32 v224, v224, v213
  v_mfma_f32_16x16x32_bf16 a[84:87], a[168:171], v[180:183], a[84:87]
  v_exp_f32 v208, v120
  v_mfma_f32_16x16x32_bf16 a[24:27], a[172:175], v[160:163], a[24:27]
  ds_read_b128 a[140:143], v3 offset:3072
  v_cvt_pk_bf16_f32 v170, v212, v213
  v_mfma_f32_16x16x32_bf16 a[28:31], a[172:175], v[164:167], a[28:31]
  v_exp_f32 v209, v121
  v_mfma_f32_16x16x32_bf16 a[88:91], a[172:175], v[176:179], a[88:91]
  v_exp_f32 v210, v122
  v_mfma_f32_16x16x32_bf16 a[92:95], a[172:175], v[180:183], a[92:95]
  s_waitcnt lgkmcnt(4)
  v_add_f32 v224, v224, v214
  v_add_f32 v224, v224, v215
  v_mfma_f32_16x16x32_bf16 a[32:35], a[176:179], v[160:163], a[32:35]
  ds_read_b128 a[144:147], v3 offset:4096
  v_cvt_pk_bf16_f32 v171, v214, v215
  v_mfma_f32_16x16x32_bf16 a[36:39], a[176:179], v[164:167], a[36:39]
  v_exp_f32 v211, v123
  v_mfma_f32_16x16x32_bf16 a[96:99], a[176:179], v[176:179], a[96:99]
  v_add_f32 v225, v208, v209
  v_cvt_pk_bf16_f32 v172, v208, v209
  v_mfma_f32_16x16x32_bf16 a[100:103], a[176:179], v[180:183], a[100:103]
  v_exp_f32 v212, v124
  v_mfma_f32_16x16x32_bf16 a[40:43], a[180:183], v[160:163], a[40:43]
  ds_read_b128 a[148:151], v3 offset:5120
  v_add_f32 v225, v225, v210
  v_mfma_f32_16x16x32_bf16 a[44:47], a[180:183], v[164:167], a[44:47]
  v_exp_f32 v213, v125
  v_mfma_f32_16x16x32_bf16 a[104:107], a[180:183], v[176:179], a[104:107]
  buffer_load_dwordx4 v2, s[44:47], s26 offen offset:3072 sc1 lds
  v_add_f32 v225, v225, v211
  v_mfma_f32_16x16x32_bf16 a[108:111], a[180:183], v[180:183], a[108:111]
  s_add_u32 s26, s26, 16384
  v_exp_f32 v214, v126
  v_mfma_f32_16x16x32_bf16 a[48:51], a[184:187], v[160:163], a[48:51]
  s_add_u32 s24, s24, 32768
  ds_read_b128 a[152:155], v3 offset:6144
  v_cvt_pk_bf16_f32 v173, v210, v211
  v_mfma_f32_16x16x32_bf16 a[52:55], a[184:187], v[164:167], a[52:55]
  s_and_b32 s24, s24, 0x1ffff
  v_exp_f32 v215, v127
  v_mfma_f32_16x16x32_bf16 a[112:115], a[184:187], v[176:179], a[112:115]
  v_max3_f32 v5, v226, v227, v224
  v_add_f32 v225, v225, v212
  v_mfma_f32_16x16x32_bf16 a[116:119], a[184:187], v[180:183], a[116:119]
  v_add_f32 v225, v225, v213
  v_cvt_pk_bf16_f32 v174, v212, v213
  v_add_f32 v225, v225, v214
  v_mfma_f32_16x16x32_bf16 a[56:59], a[188:191], v[160:163], a[56:59]
  ds_read_b128 a[156:159], v3 offset:7168
  v_add_f32 v225, v225, v215
  v_max_f32 v5, v5, v225
  v_cmp_lt_f32 vcc, s81, v5
  v_mfma_f32_16x16x32_bf16 a[60:63], a[188:191], v[164:167], a[60:63]
  v_exp_f32 v216, v128
  v_mfma_f32_16x16x32_bf16 a[120:123], a[188:191], v[176:179], a[120:123]
  s_waitcnt lgkmcnt(4)
  v_cvt_pk_bf16_f32 v175, v214, v215
  v_mfma_f32_16x16x32_bf16 a[124:127], a[188:191], v[180:183], a[124:127]
  s_cbranch_vccnz fa_stub1
fa_back1:
  v_exp_f32 v217, v129
  v_add_f32 v228, v228, v224
  v_add_f32 v229, v229, v225
  v_add_f32 v230, v230, v226
  v_add_f32 v231, v231, v227
fa_DDe:
  v_mfma_f32_16x16x32_bf16 v[112:115], a[128:131], v[32:35], v[192:195]
  ds_read_b128 a[160:163], v3 offset:24576
  v_add_f32 v226, v216, v217
  v_mfma_f32_16x16x32_bf16 v[120:123], a[128:131], v[36:39], v[196:199]
  v_exp_f32 v218, v130
  v_mfma_f32_16x16x32_bf16 v[144:147], a[128:131], v[64:67], v[200:203]
  s_cmp_ge_u32 s26, s9
  v_exp_f32 v219, v131
  v_mfma_f32_16x16x32_bf16 v[152:155], a[128:131], v[68:71], v[204:207]
  s_cbranch_scc1 fa_hk5
fa_hb5:
  v_exp_f32 v220, v132
  v_mfma_f32_16x16x32_bf16 v[116:119], a[132:135], v[32:35], v[192:195]
  s_add_u32 s66, s66, 32768
  ds_read_b128 a[164:167], v3 offset:25600
  v_cvt_pk_bf16_f32 v176, v216, v217
  v_mfma_f32_16x16x32_bf16 v[124:127], a[132:135], v[36:39], v[196:199]
  s_mov_b32 m0, s25
  v_exp_f32 v221, v133
  v_mfma_f32_16x16x32_bf16 v[148:151], a[132:135], v[64:67], v[200:203]
  s_and_b32 s66, s66, 0x1ffff
  buffer_load_dwordx4 v2, s[48:51], s27 offen offset:0 sc1 lds
  v_add_f32 v226, v226, v218
  v_mfma_f32_16x16x32_bf16 v[156:159], a[132:135], v[68:71], v[204:207]
  v_exp_f32 v222, v134
  v_mfma_f32_16x16x32_bf16 v[112:115], a[136:139], v[40:43], v[112:115]
  ds_read_b128 a[168:171], v3 offset:26624
  v_add_f32 v226, v226, v219
  v_mfma_f32_16x16x32_bf16 v[120:123], a[136:139], v[44:47], v[120:123]
  v_exp_f32 v223, v135
  v_mfma_f32_16x16x32_bf16 v[144:147], a[136:139], v[72:75], v[144:147]
  v_cvt_pk_bf16_f32 v177, v218, v219
  v_add_f32 v226, v226, v220
  v_mfma_f32_16x16x32_bf16 v[152:155], a[136:139], v[76:79], v[152:155]
  v_exp_f32 v216, v136
  v_mfma_f32_16x16x32_bf16 v[116:119], a[140:143], v[40:43], v[116:119]
  ds_read_b128 a[172:175], v3 offset:27648
  v_add_f32 v226, v226, v221
  v_mfma_f32_16x16x32_bf16 v[124:127], a[140:143], v[44:47], v[124:127]
  v_exp_f32 v217, v137
  v_mfma_f32_16x16x32_bf16 v[148:151], a[140:143], v[72:75], v[148:151]
  v_cvt_pk_bf16_f32 v178, v220, v221
  v_add_f32 v226, v226, v222
  v_mfma_f32_16x16x32_bf16 v[156:159], a[140:143], v[76:79], v[156:159]
  s_waitcnt lgkmcnt(4)
  v_exp_f32 v218, v138
  v_mfma_f32_16x16x32_bf16 v[112:115], a[144:147], v[48:51], v[112:115]
  ds_read_b128 a[176:179], v3 offset:28672
  v_add_f32 v226, v226, v223
  v_mfma_f32_16x16x32_bf16 v[120:123], a[144:147], v[52:55], v[120:123]
  v_exp_f32 v219, v139
  v_mfma_f32_16x16x32_bf16 v[144:147], a[144:147], v[80:83], v[144:147]
  v_cvt_pk_bf16_f32 v179, v222, v223
  v_add_f32 v227, v216, v217
  v_mfma_f32_16x16x32_bf16 v[152:155], a[144:147], v[84:87], v[152:155]
  v_exp_f32 v220, v140
  v_mfma_f32_16x16x32_bf16 v[116:119], a[148:151], v[48:51], v[116:119]
  ds_read_b128 a[180:183], v3 offset:29696
  v_cvt_pk_bf16_f32 v180, v216, v217
  v_mfma_f32_16x16x32_bf16 v[124:127], a[148:151], v[52:55], v[124:127]
  v_exp_f32 v221, v141
  v_mfma_f32_16x16x32_bf16 v[148:151], a[148:151], v[80:83], v[148:151]
  buffer_load_dwordx4 v2, s[48:51], s27 offen offset:1024 sc1 lds
  v_add_f32 v227, v227, v218
  v_mfma_f32_16x16x32_bf16 v[156:159], a[148:151], v[84:87], v[156:159]
  v_exp_f32 v222, v142
  v_mfma_f32_16x16x32_bf16 v[112:115], a[152:155], v[56:59], v[112:115]
  ds_read_b128 a[184:187], v3 offset:30720
  v_add_f32 v227, v227, v219
  v_mfma_f32_16x16x32_bf16 v[120:123], a[152:155], v[60:63], v[120:123]
  v_exp_f32 v223, v143
  v_mfma_f32_16x16x32_bf16 v[144:147], a[152:155], v[88:91], v[144:147]
  v_cvt_pk_bf16_f32 v181, v218, v219
  v_add_f32 v227, v227, v220
  v_mfma_f32_16x16x32_bf16 v[152:155], a[152:155], v[92:95], v[152:155]
  v_exp_f32 v208, v96
  v_mfma_f32_16x16x32_bf16 v[116:119], a[156:159], v[56:59], v[116:119]
  ds_read_b128 a[188:191], v3 offset:31744
  v_add_f32 v227, v227, v221
  v_mfma_f32_16x16x32_bf16 v[124:127], a[156:159], v[60:63], v[124:127]
  v_exp_f32 v209, v97
  v_mfma_f32_16x16x32_bf16 v[148:151], a[156:159], v[88:91], v[148:151]
  v_cvt_pk_bf16_f32 v182, v220, v221
  v_add_f32 v227, v227, v222
  v_add_f32 v227, v227, v223
  v_mfma_f32_16x16x32_bf16 v[156:159], a[156:159], v[92:95], v[156:159]
  s_waitcnt lgkmcnt(4)
  v_exp_f32 v210, v98
  v_mfma_f32_16x16x32_bf16 a[0:3], a[160:163], v[168:171], a[0:3]
  ds_read_b128 a[128:131], v3 offset:8192
  v_cvt_pk_bf16_f32 v183, v222, v223
  v_mfma_f32_16x16x32_bf16 a[4:7], a[160:163], v[172:175], a[4:7]
  v_exp_f32 v211, v99
  v_mfma_f32_16x16x32_bf16 a[64:67], a[160:163], v[184:187], a[64:67]
  v_exp_f32 v212, v100
  v_mfma_f32_16x16x32_bf16 a[68:71], a[160:163], v[188:191], a[68:71]
  v_add_f32 v224, v208, v209
  v_cvt_pk_bf16_f32 v160, v208, v209
  v_mfma_f32_16x16x32_bf16 a[8:11], a[164:167], v[168:171], a[8:11]
  ds_read_b128 a[132:135], v3 offset:9216
  v_add_f32 v224, v224, v210
  v_mfma_f32_16x16x32_bf16 a[12:15], a[164:167], v[172:175], a[12:15]
  v_exp_f32 v213, v101
  v_mfma_f32_16x16x32_bf16 a[72:75], a[164:167], v[184:187], a[72:75]
  buffer_load_dwordx4 v2, s[48:51], s27 offen offset:2048 sc1 lds
  v_add_f32 v224, v224, v211
  v_mfma_f32_16x16x32_bf16 a[76:79], a[164:167], v[188:191], a[76:79]
  v_exp_f32 v214, v102
  v_mfma_f32_16x16x32_bf16 a[16:19], a[168:171], v[168:171], a[16:19]
  ds_read_b128 a[136:139], v3 offset:10240
  v_cvt_pk_bf16_f32 v161, v210, v211
  v_mfma_f32_16x16x32_bf16 a[20:23], a[168:171], v[172:175], a[20:23]
  v_exp_f32 v215, v103
  v_mfma_f32_16x16x32_bf16 a[80:83], a[168:171], v[184:187], a[80:83]
  v_add_f32 v224, v224, v212
  v_add_f32 v224, v224, v213
  v_mfma_f32_16x16x32_bf16 a[84:87], a[168:171], v[188:191], a[84:87]
  v_exp_f32 v208, v104
  v_mfma_f32_16x16x32_bf16 a[24:27], a[172:175], v[168:171], a[24:27]
  ds_read_b128 a[140:143], v3 offset:11264
  v_cvt_pk_bf16_f32 v162, v212, v213
  v_mfma_f32_16x16x32_bf16 a[28:31], a[172:175], v[172:175], a[28:31]
  v_exp_f32 v209, v105
  v_mfma_f32_16x16x32_bf16 a[88:91], a[172:175], v[184:187], a[88:91]
  v_exp_f32 v210, v106
  v_mfma_f32_16x16x32_bf16 a[92:95], a[172:175], v[188:191], a[92:95]
  s_waitcnt lgkmcnt(4)
  v_add_f32 v224, v224, v214
  v_add_f32 v224, v224, v215
  v_mfma_f32_16x16x32_bf16 a[32:35], a[176:179], v[168:171], a[32:35]
  ds_read_b128 a[144:147], v3 offset:12288
  v_cvt_pk_bf16_f32 v163, v214, v215
  v_mfma_f32_16x16x32_bf16 a[36:39], a[176:179], v[172:175], a[36:39]
  v_exp_f32 v211, v107
  v_mfma_f32_16x16x32_bf16 a[96:99], a[176:179], v[184:187], a[96:99]
  v_add_f32 v225, v208, v209
  v_cvt_pk_bf16_f32 v164, v208, v209
  v_mfma_f32_16x16x32_bf16 a[100:103], a[176:179], v[188:191], a[100:103]
  v_exp_f32 v212, v108
  v_mfma_f32_16x16x32_bf16 a[40:43], a[180:183], v[168:171], a[40:43]
  ds_read_b128 a[148:151], v3 offset:13312
  v_add_f32 v225, v225, v210
  v_mfma_f32_16x16x32_bf16 a[44:47], a[180:183], v[172:175], a[44:47]
  v_exp_f32 v213, v109
  v_mfma_f32_16x16x32_bf16 a[104:107], a[180:183], v[184:187], a[104:107]
  buffer_load_dwordx4 v2, s[48:51], s27 offen offset:3072 sc1 lds
  v_add_f32 v225, v225, v211
  v_mfma_f32_16x16x32_bf16 a[108:111], a[180:183], v[188:191], a[108:111]
  s_add_u32 s27, s27, 16384
  v_exp_f32 v214, v110
  v_mfma_f32_16x16x32_bf16 a[48:51], a[184:187], v[168:171], a[48:51]
  s_add_u32 s25, s25, 32768
  ds_read_b128 a[152:155], v3 offset:14336
  v_cvt_pk_bf16_f32 v165, v210, v211
  v_mfma_f32_16x16x32_bf16 a[52:55], a[184:187], v[172:175], a[52:55]
  s_and_b32 s25, s25, 0x1ffff
  v_exp_f32 v215, v111
  v_mfma_f32_16x16x32_bf16 a[112:115], a[184:187], v[184:187], a[112:115]
  v_max3_f32 v5, v226, v227, v224
  v_add_f32 v225, v225, v212
  v_mfma_f32_16x16x32_bf16 a[116:119], a[184:187], v[188:191], a[116:119]
  v_add_f32 v225, v225, v213
  v_cvt_pk_bf16_f32 v166, v212, v213
  v_add_f32 v225, v225, v214
  v_mfma_f32_16x16x32_bf16 a[56:59], a[188:191], v[168:171], a[56:59]
  s_sub_u32 s28, s28, 1
  ds_read_b128 a[156:159], v3 offset:15360
  v_add_f32 v225, v225, v215
  v_max_f32 v5, v5, v225
  v_cmp_lt_f32 vcc, s81, v5
  v_mfma_f32_16x16x32_bf16 a[60:63], a[188:191], v[172:175], a[60:63]
  s_cmp_gt_u32 s28, s8
  v_exp_f32 v216, v144
  v_mfma_f32_16x16x32_bf16 a[120:123], a[188:191], v[184:187], a[120:123]
  s_waitcnt lgkmcnt(4)
  v_cvt_pk_bf16_f32 v167, v214, v215
  v_add_u32 v3, s66, v2
  v_mfma_f32_16x16x32_bf16 a[124:127], a[188:191], v[188:191], a[124:127]
  s_cbranch_vccnz fa_stub2
fa_back2:
  v_exp_f32 v217, v145
  v_add_f32 v228, v228, v224
  v_add_f32 v229, v229, v225
  v_add_f32 v230, v230, v226
  v_add_f32 v231, v231, v227
  s_cbranch_scc1 fa_DD
  s_cmp_lg_u32 s8, 0
  s_cbranch_scc1 fa_DDF
fa_Aexit:
  s_bitcmp1_b32 s20, 0
  s_cbranch_scc1 fa_Aodd
  v_mfma_f32_16x16x32_bf16 v[96:99], a[128:131], v[32:35], v[192:195]
  s_waitcnt vmcnt(12)
  v_exp_f32 v218, v146
  v_mfma_f32_16x16x32_bf16 v[104:107], a[128:131], v[36:39], v[196:199]
  s_barrier
  v_exp_f32 v219, v147
  v_mfma_f32_16x16x32_bf16 v[128:131], a[128:131], v[64:67], v[200:203]
  ds_read_b128 a[160:163], v3 offset:16384
  v_add_f32 v226, v216, v217
  v_mfma_f32_16x16x32_bf16 v[136:139], a[128:131], v[68:71], v[204:207]
  v_exp_f32 v220, v148
  v_mfma_f32_16x16x32_bf16 v[100:103], a[132:135], v[32:35], v[192:195]
  ds_read_b128 a[164:167], v3 offset:17408
  v_cvt_pk_bf16_f32 v184, v216, v217
  v_mfma_f32_16x16x32_bf16 v[108:111], a[132:135], v[36:39], v[196:199]
  s_mov_b32 m0, s24
  v_exp_f32 v221, v149
  v_mfma_f32_16x16x32_bf16 v[132:135], a[132:135], v[64:67], v[200:203]
  buffer_load_dwordx4 v2, s[44:47], s26 offen offset:0 sc1 lds
  v_add_f32 v226, v226, v218
  v_mfma_f32_16x16x32_bf16 v[140:143], a[132:135], v[68:71], v[204:207]
  v_exp_f32 v222, v150
  v_mfma_f32_16x16x32_bf16 v[96:99], a[136:139], v[40:43], v[96:99]
  ds_read_b128 a[168:171], v3 offset:18432
  v_add_f32 v226, v226, v219
  v_mfma_f32_16x16x32_bf16 v[104:107], a[136:139], v[44:47], v[104:107]
  v_exp_f32 v223, v151
  v_mfma_f32_16x16x32_bf16 v[128:131], a[136:139], v[72:75], v[128:131]
  v_cvt_pk_bf16_f32 v185, v218, v219
  v_add_f32 v226, v226, v220
  v_mfma_f32_16x16x32_bf16 v[136:139], a[136:139], v[76:79], v[136:139]
  v_exp_f32 v216, v152
  v_mfma_f32_16x16x32_bf16 v[100:103], a[140:143], v[40:43], v[100:103]
  ds_read_b128 a[172:175], v3 offset:19456
  v_add_f32 v226, v226, v221
  v_mfma_f32_16x16x32_bf16 v[108:111], a[140:143], v[44:47], v[108:111]
  v_exp_f32 v217, v153
  v_mfma_f32_16x16x32_bf16 v[132:135], a[140:143], v[72:75], v[132:135]
  v_cvt_pk_bf16_f32 v186, v220, v221
  v_add_f32 v226, v226, v222
  v_mfma_f32_16x16x32_bf16 v[140:143], a[140:143], v[76:79], v[140:143]
  s_waitcnt lgkmcnt(4)
  v_exp_f32 v218, v154
  v_mfma_f32_16x16x32_bf16 v[96:99], a[144:147], v[48:51], v[96:99]
  ds_read_b128 a[176:179], v3 offset:20480
  v_add_f32 v226, v226, v223
  v_mfma_f32_16x16x32_bf16 v[104:107], a[144:147], v[52:55], v[104:107]
  v_exp_f32 v219, v155
  v_mfma_f32_16x16x32_bf16 v[128:131], a[144:147], v[80:83], v[128:131]
  v_cvt_pk_bf16_f32 v187, v222, v223
  v_add_f32 v227, v216, v217
  v_mfma_f32_16x16x32_bf16 v[136:139], a[144:147], v[84:87], v[136:139]
  v_exp_f32 v220, v156
  v_mfma_f32_16x16x32_bf16 v[100:103], a[148:151], v[48:51], v[100:103]
  ds_read_b128 a[180:183], v3 offset:21504
  v_cvt_pk_bf16_f32 v188, v216, v217
  v_mfma_f32_16x16x32_bf16 v[108:111], a[148:151], v[52:55], v[108:111]
  v_exp_f32 v221, v157
  v_mfma_f32_16x16x32_bf16 v[132:135], a[148:151], v[80:83], v[132:135]
  buffer_load_dwordx4 v2, s[44:47], s26 offen offset:1024 sc1 lds
  v_add_f32 v227, v227, v218
  v_mfma_f32_16x16x32_bf16 v[140:143], a[148:151], v[84:87], v[140:143]
  v_exp_f32 v222, v158
  v_mfma_f32_16x16x32_bf16 v[96:99], a[152:155], v[56:59], v[96:99]
  ds_read_b128 a[184:187], v3 offset:22528
  v_add_f32 v227, v227, v219
  v_mfma_f32_16x16x32_bf16 v[104:107], a[152:155], v[60:63], v[104:107]
  v_exp_f32 v223, v159
  v_mfma_f32_16x16x32_bf16 v[128:131], a[152:155], v[88:91], v[128:131]
  v_cvt_pk_bf16_f32 v189, v218, v219
  v_add_f32 v227, v227, v220
  v_mfma_f32_16x16x32_bf16 v[136:139], a[152:155], v[92:95], v[136:139]
  v_exp_f32 v208, v112
  v_mfma_f32_16x16x32_bf16 v[100:103], a[156:159], v[56:59], v[100:103]
  ds_read_b128 a[188:191], v3 offset:23552
  v_add_f32 v227, v227, v221
  v_mfma_f32_16x16x32_bf16 v[108:111], a[156:159], v[60:63], v[108:111]
  v_exp_f32 v209, v113
  v_mfma_f32_16x16x32_bf16 v[132:135], a[156:159], v[88:91], v[132:135]
  v_cvt_pk_bf16_f32 v190, v220, v221
  v_add_f32 v227, v227, v222
  v_add_f32 v227, v227, v223
  v_mfma_f32_16x16x32_bf16 v[140:143], a[156:159], v[92:95], v[140:143]
  s_waitcnt lgkmcnt(4)
  v_exp_f32 v210, v114
  v_mfma_f32_16x16x32_bf16 a[0:3], a[160:163], v[160:163], a[0:3]
  ds_read_b128 a[128:131], v3 offset:0
  v_cvt_pk_bf16_f32 v191, v222, v223
  v_mfma_f32_16x16x32_bf16 a[4:7], a[160:163], v[164:167], a[4:7]
  v_exp_f32 v211, v115
  v_mfma_f32_16x16x32_bf16 a[64:67], a[160:163], v[176:179], a[64:67]
  v_exp_f32 v212, v116
  v_mfma_f32_16x16x32_bf16 a[68:71], a[160:163], v[180:183], a[68:71]
  v_add_f32 v224, v208, v209
  v_cvt_pk_bf16_f32 v168, v208, v209
  v_mfma_f32_16x16x32_bf16 a[8:11], a[164:167], v[160:163], a[8:11]
  ds_read_b128 a[132:135], v3 offset:1024
  v_add_f32 v224, v224, v210
  v_mfma_f32_16x16x32_bf16 a[12:15], a[164:167], v[164:167], a[12:15]
  v_exp_f32 v213, v117
  v_mfma_f32_16x16x32_bf16 a[72:75], a[164:167], v[176:179], a[72:75]
  buffer_load_dwordx4 v2, s[44:47], s26 offen offset:2048 sc1 lds
  v_add_f32 v224, v224, v211
  v_mfma_f32_16x16x32_bf16 a[76:79], a[164:167], v[180:183], a[76:79]
  v_exp_f32 v214, v118
  v_mfma_f32_16x16x32_bf16 a[16:19], a[168:171], v[160:163], a[16:19]
  ds_read_b128 a[136:139], v3 offset:2048
  v_cvt_pk_bf16_f32 v169, v210, v211
  v_mfma_f32_16x16x32_bf16 a[20:23], a[168:171], v[164:167], a[20:23]
  v_exp_f32 v215, v119
  v_mfma_f32_16x16x32_bf16 a[80:83], a[168:171], v[176:179], a[80:83]
  v_add_f32 v224, v224, v212
  v_add_f32 v224, v224, v213
  v_mfma_f32_16x16x32_bf16 a[84:87], a[168:171], v[180:183], a[84:87]
  v_exp_f32 v208, v120
  v_mfma_f32_16x16x32_bf16 a[24:27], a[172:175], v[160:163], a[24:27]
  ds_read_b128 a[140:143], v3 offset:3072
  v_cvt_pk_bf16_f32 v170, v212, v213
  v_mfma_f32_16x16x32_bf16 a[28:31], a[172:175], v[164:167], a[28:31]
  v_exp_f32 v209, v121
  v_mfma_f32_16x16x32_bf16 a[88:91], a[172:175], v[176:179], a[88:91]
  v_exp_f32 v210, v122
  v_mfma_f32_16x16x32_bf16 a[92:95], a[172:175], v[180:183], a[92:95]
  s_waitcnt lgkmcnt(4)
  v_add_f32 v224, v224, v214
  v_add_f32 v224, v224, v215
  v_mfma_f32_16x16x32_bf16 a[32:35], a[176:179], v[160:163], a[32:35]
  ds_read_b128 a[144:147], v3 offset:4096
  v_cvt_pk_bf16_f32 v171, v214, v215
  v_mfma_f32_16x16x32_bf16 a[36:39], a[176:179], v[164:167], a[36:39]
  v_exp_f32 v211, v123
  v_mfma_f32_16x16x32_bf16 a[96:99], a[176:179], v[176:179], a[96:99]
  v_add_f32 v225, v208, v209
  v_cvt_pk_bf16_f32 v172, v208, v209
  v_mfma_f32_16x16x32_bf16 a[100:103], a[176:179], v[180:183], a[100:103]
  v_exp_f32 v212, v124
  v_mfma_f32_16x16x32_bf16 a[40:43], a[180:183], v[160:163], a[40:43]
  ds_read_b128 a[148:151], v3 offset:5120
  v_add_f32 v225, v225, v210
  v_mfma_f32_16x16x32_bf16 a[44:47], a[180:183], v[164:167], a[44:47]
  v_exp_f32 v213, v125
  v_mfma_f32_16x16x32_bf16 a[104:107], a[180:183], v[176:179], a[104:107]
  buffer_load_dwordx4 v2, s[44:47], s26 offen offset:3072 sc1 lds
  v_add_f32 v225, v225, v211
  v_mfma_f32_16x16x32_bf16 a[108:111], a[180:183], v[180:183], a[108:111]
  s_add_u32 s26, s26, 16384
  v_exp_f32 v214, v126
  v_mfma_f32_16x16x32_bf16 a[48:51], a[184:187], v[160:163], a[48:51]
  s_add_u32 s24, s24, 32768
  ds_read_b128 a[152:155], v3 offset:6144
  v_cvt_pk_bf16_f32 v173, v210, v211
  v_mfma_f32_16x16x32_bf16 a[52:55], a[184:187], v[164:167], a[52:55]
  s_and_b32 s24, s24, 0x1ffff
  v_exp_f32 v215, v127
  v_mfma_f32_16x16x32_bf16 a[112:115], a[184:187], v[176:179], a[112:115]
  v_max3_f32 v5, v226, v227, v224
  v_add_f32 v225, v225, v212
  v_mfma_f32_16x16x32_bf16 a[116:119], a[184:187], v[180:183], a[116:119]
  v_add_f32 v225, v225, v213
  v_cvt_pk_bf16_f32 v174, v212, v213
  v_add_f32 v225, v225, v214
  v_mfma_f32_16x16x32_bf16 a[56:59], a[188:191], v[160:163], a[56:59]
  ds_read_b128 a[156:159], v3 offset:7168
  v_add_f32 v225, v225, v215
  v_max_f32 v5, v5, v225
  v_cmp_lt_f32 vcc, s81, v5
  v_mfma_f32_16x16x32_bf16 a[60:63], a[188:191], v[164:167], a[60:63]
  v_exp_f32 v216, v128
  v_mfma_f32_16x16x32_bf16 a[120:123], a[188:191], v[176:179], a[120:123]
  s_waitcnt lgkmcnt(4)
  v_cvt_pk_bf16_f32 v175, v214, v215
  v_mfma_f32_16x16x32_bf16 a[124:127], a[188:191], v[180:183], a[124:127]
  s_cbranch_vccnz fa_stub4
fa_back4:
  v_exp_f32 v217, v129
  v_add_f32 v228, v228, v224
  v_add_f32 v229, v229, v225
  v_add_f32 v230, v230, v226
  v_add_f32 v231, v231, v227
  v_mfma_f32_16x16x32_bf16 v[144:147], a[128:131], v[64:67], v[200:203]
  ds_read_b128 a[160:163], v3 offset:24576
  v_exp_f32 v218, v130
  v_mfma_f32_16x16x32_bf16 v[152:155], a[128:131], v[68:71], v[204:207]
  v_exp_f32 v219, v131
  v_add_f32 v226, v216, v217
  v_mfma_f32_16x16x32_bf16 v[148:151], a[132:135], v[64:67], v[200:203]
  s_add_u32 s66, s66, 32768
  ds_read_b128 a[164:167], v3 offset:25600
  v_exp_f32 v220, v132
  v_mfma_f32_16x16x32_bf16 v[156:159], a[132:135], v[68:71], v[204:207]
  s_and_b32 s66, s66, 0x1ffff
  v_exp_f32 v221, v133
  v_cvt_pk_bf16_f32 v176, v216, v217
  v_mfma_f32_16x16x32_bf16 v[144:147], a[136:139], v[72:75], v[144:147]
  ds_read_b128 a[168:171], v3 offset:26624
  v_add_f32 v226, v226, v218
  v_add_f32 v226, v226, v219
  v_mfma_f32_16x16x32_bf16 v[152:155], a[136:139], v[76:79], v[152:155]
  s_mov_b32 m0, s25
  v_exp_f32 v222, v134
  v_cvt_pk_bf16_f32 v177, v218, v219
  v_mfma_f32_16x16x32_bf16 v[148:151], a[140:143], v[72:75], v[148:151]
  ds_read_b128 a[172:175], v3 offset:27648
  buffer_load_dwordx4 v2, s[48:51], s27 offen offset:0 sc1 lds
  v_add_f32 v226, v226, v220
  v_add_f32 v226, v226, v221
  v_mfma_f32_16x16x32_bf16 v[156:159], a[140:143], v[76:79], v[156:159]
  s_waitcnt lgkmcnt(4)
  v_exp_f32 v223, v135
  v_cvt_pk_bf16_f32 v178, v220, v221
  v_mfma_f32_16x16x32_bf16 v[144:147], a[144:147], v[80:83], v[144:147]
  ds_read_b128 a[176:179], v3 offset:28672
  v_cndmask_b32 v96, v4, v96, s[68:69]
  v_cndmask_b32 v97, v4, v97, s[70:71]
  v_mfma_f32_16x16x32_bf16 v[152:155], a[144:147], v[84:87], v[152:155]
  v_exp_f32 v216, v136
  v_cndmask_b32 v98, v4, v98, s[72:73]
  v_mfma_f32_16x16x32_bf16 v[148:151], a[148:151], v[80:83], v[148:151]
  ds_read_b128 a[180:183], v3 offset:29696
  v_cndmask_b32 v99, v4, v99, s[74:75]
  v_mov_b32 v100, v4
  v_mfma_f32_16x16x32_bf16 v[156:159], a[148:151], v[84:87], v[156:159]
  v_exp_f32 v217, v137
  v_mov_b32 v101, v4
  v_mfma_f32_16x16x32_bf16 v[144:147], a[152:155], v[88:91], v[144:147]
  ds_read_b128 a[184:187], v3 offset:30720
  v_mov_b32 v102, v4
  v_mov_b32 v103, v4
  v_mfma_f32_16x16x32_bf16 v[152:155], a[152:155], v[92:95], v[152:155]
  v_exp_f32 v218, v138
  v_cndmask_b32 v108, v4, v108, s[68:69]
  v_mfma_f32_16x16x32_bf16 v[148:151], a[156:159], v[88:91], v[148:151]
  ds_read_b128 a[188:191], v3 offset:31744
  v_cndmask_b32 v109, v4, v109, s[70:71]
  v_cndmask_b32 v110, v4, v110, s[72:73]
  v_mfma_f32_16x16x32_bf16 v[156:159], a[156:159], v[92:95], v[156:159]
  s_waitcnt lgkmcnt(4)
  v_exp_f32 v219, v139
  v_cndmask_b32 v111, v4, v111, s[74:75]
  v_mfma_f32_16x16x32_bf16 a[0:3], a[160:163], v[168:171], a[0:3]
  ds_read_b128 a[128:131], v3 offset:8192
  v_add_f32 v226, v226, v222
  v_add_f32 v226, v226, v223
  v_mfma_f32_16x16x32_bf16 a[4:7], a[160:163], v[172:175], a[4:7]
  v_exp_f32 v220, v140
  v_cvt_pk_bf16_f32 v179, v222, v223
  v_mfma_f32_16x16x32_bf16 a[64:67], a[160:163], v[184:187], a[64:67]
  buffer_load_dwordx4 v2, s[48:51], s27 offen offset:1024 sc1 lds
  v_add_f32 v227, v216, v217
  v_cvt_pk_bf16_f32 v180, v216, v217
  v_mfma_f32_16x16x32_bf16 a[68:71], a[160:163], v[188:191], a[68:71]
  v_exp_f32 v221, v141
  v_add_f32 v227, v227, v218
  v_mfma_f32_16x16x32_bf16 a[8:11], a[164:167], v[168:171], a[8:11]
  ds_read_b128 a[132:135], v3 offset:9216
  v_exp_f32 v222, v142
  v_mfma_f32_16x16x32_bf16 a[12:15], a[164:167], v[172:175], a[12:15]
  v_exp_f32 v223, v143
  v_mfma_f32_16x16x32_bf16 a[72:75], a[164:167], v[184:187], a[72:75]
  v_exp_f32 v208, v96
  v_mfma_f32_16x16x32_bf16 a[76:79], a[164:167], v[188:191], a[76:79]
  v_exp_f32 v209, v97
  v_mfma_f32_16x16x32_bf16 a[16:19], a[168:171], v[168:171], a[16:19]
  ds_read_b128 a[136:139], v3 offset:10240
  v_add_f32 v227, v227, v219
  v_cvt_pk_bf16_f32 v181, v218, v219
  v_add_f32 v227, v227, v220
  v_add_f32 v227, v227, v221
  v_cvt_pk_bf16_f32 v182, v220, v221
  v_mfma_f32_16x16x32_bf16 a[20:23], a[168:171], v[172:175], a[20:23]
  v_exp_f32 v210, v98
  v_mfma_f32_16x16x32_bf16 a[80:83], a[168:171], v[184:187], a[80:83]
  v_exp_f32 v211, v99
  v_mfma_f32_16x16x32_bf16 a[84:87], a[168:171], v[188:191], a[84:87]
  v_exp_f32 v212, v100
  v_mfma_f32_16x16x32_bf16 a[24:27], a[172:175], v[168:171], a[24:27]
  ds_read_b128 a[140:143], v3 offset:11264
  v_add_f32 v227, v227, v222
  v_add_f32 v227, v227, v223
  v_cvt_pk_bf16_f32 v183, v222, v223
  v_add_f32 v224, v208, v209
  v_cvt_pk_bf16_f32 v160, v208, v209
  v_mfma_f32_16x16x32_bf16 a[28:31], a[172:175], v[172:175], a[28:31]
  v_exp_f32 v213, v101
  v_mfma_f32_16x16x32_bf16 a[88:91], a[172:175], v[184:187], a[88:91]
  buffer_load_dwordx4 v2, s[48:51], s27 offen offset:2048 sc1 lds
  v_add_f32 v224, v224, v210
  v_add_f32 v224, v224, v211
  v_cvt_pk_bf16_f32 v161, v210, v211
  v_mfma_f32_16x16x32_bf16 a[92:95], a[172:175], v[188:191], a[92:95]
  s_waitcnt lgkmcnt(4)
  v_exp_f32 v214, v102
  v_mfma_f32_16x16x32_bf16 a[32:35], a[176:179], v[168:171], a[32:35]
  ds_read_b128 a[144:147], v3 offset:12288
  v_exp_f32 v215, v103
  v_mfma_f32_16x16x32_bf16 a[36:39], a[176:179], v[172:175], a[36:39]
  v_exp_f32 v208, v104
  v_mfma_f32_16x16x32_bf16 a[96:99], a[176:179], v[184:187], a[96:99]
  v_exp_f32 v209, v105
  v_mfma_f32_16x16x32_bf16 a[100:103], a[176:179], v[188:191], a[100:103]
  v_exp_f32 v210, v106
  v_mfma_f32_16x16x32_bf16 a[40:43], a[180:183], v[168:171], a[40:43]
  ds_read_b128 a[148:151], v3 offset:13312
  v_add_f32 v224, v224, v212
  v_add_f32 v224, v224, v213
  v_cvt_pk_bf16_f32 v162, v212, v213
  v_add_f32 v224, v224, v214
  v_add_f32 v224, v224, v215
  v_cvt_pk_bf16_f32 v163, v214, v215
  v_mfma_f32_16x16x32_bf16 a[44:47], a[180:183], v[172:175], a[44:47]
  v_exp_f32 v211, v107
  v_mfma_f32_16x16x32_bf16 a[104:107], a[180:183], v[184:187], a[104:107]
  v_exp_f32 v212, v108
  v_mfma_f32_16x16x32_bf16 a[108:111], a[180:183], v[188:191], a[108:111]
  v_exp_f32 v213, v109
  v_mfma_f32_16x16x32_bf16 a[48:51], a[184:187], v[168:171], a[48:51]
  ds_read_b128 a[152:155], v3 offset:14336
  v_add_f32 v225, v208, v209
  v_cvt_pk_bf16_f32 v164, v208, v209
  v_add_f32 v225, v225, v210
  v_add_f32 v225, v225, v211
  v_cvt_pk_bf16_f32 v165, v210, v211
  v_mfma_f32_16x16x32_bf16 a[52:55], a[184:187], v[172:175], a[52:55]
  v_exp_f32 v214, v110
  v_mfma_f32_16x16x32_bf16 a[112:115], a[184:187], v[184:187], a[112:115]
  buffer_load_dwordx4 v2, s[48:51], s27 offen offset:3072 sc1 lds
  v_max3_f32 v5, v226, v227, v224
  v_add_f32 v225, v225, v212
  v_add_f32 v225, v225, v213
  v_mfma_f32_16x16x32_bf16 a[116:119], a[184:187], v[188:191], a[116:119]
  s_add_u32 s27, s27, 16384
  v_exp_f32 v215, v111
  v_mfma_f32_16x16x32_bf16 a[56:59], a[188:191], v[168:171], a[56:59]
  s_add_u32 s25, s25, 32768
  ds_read_b128 a[156:159], v3 offset:15360
  v_cvt_pk_bf16_f32 v166, v212, v213
  v_add_f32 v225, v225, v214
  v_add_f32 v225, v225, v215
  v_max_f32 v5, v5, v225
  v_cmp_lt_f32 vcc, s81, v5
  v_mfma_f32_16x16x32_bf16 a[60:63], a[188:191], v[172:175], a[60:63]
  s_and_b32 s25, s25, 0x1ffff
  v_exp_f32 v216, v144
  v_mfma_f32_16x16x32_bf16 a[120:123], a[188:191], v[184:187], a[120:123]
  s_waitcnt lgkmcnt(4)
  v_cvt_pk_bf16_f32 v167, v214, v215
  v_add_u32 v3, s66, v2
  v_mfma_f32_16x16x32_bf16 a[124:127], a[188:191], v[188:191], a[124:127]
  s_cbranch_vccnz fa_stub5
fa_back5:
  v_exp_f32 v217, v145
  v_add_f32 v228, v228, v224
  v_add_f32 v229, v229, v225
  v_add_f32 v230, v230, v226
  v_add_f32 v231, v231, v227
fa_AV:
  v_mfma_f32_16x16x32_bf16 v[128:131], a[128:131], v[64:67], v[200:203]
  s_waitcnt vmcnt(12)
  v_exp_f32 v218, v146
  v_mfma_f32_16x16x32_bf16 v[136:139], a[128:131], v[68:71], v[204:207]
  s_barrier
  v_exp_f32 v219, v147
  v_mfma_f32_16x16x32_bf16 v[132:135], a[132:135], v[64:67], v[200:203]
  ds_read_b128 a[160:163], v3 offset:16384
  ds_read_b128 a[164:167], v3 offset:17408
  v_add_f32 v226, v216, v217
  v_mfma_f32_16x16x32_bf16 v[140:143], a[132:135], v[68:71], v[204:207]
  v_exp_f32 v220, v148
  v_mfma_f32_16x16x32_bf16 v[128:131], a[136:139], v[72:75], v[128:131]
  ds_read_b128 a[168:171], v3 offset:18432
  v_cvt_pk_bf16_f32 v184, v216, v217
  v_mfma_f32_16x16x32_bf16 v[136:139], a[136:139], v[76:79], v[136:139]
  s_mov_b32 m0, s24
  v_exp_f32 v221, v149
  v_mfma_f32_16x16x32_bf16 v[132:135], a[140:143], v[72:75], v[132:135]
  ds_read_b128 a[172:175], v3 offset:19456
  buffer_load_dwordx4 v2, s[44:47], s26 offen offset:0 sc1 lds
  v_add_f32 v226, v226, v218
  v_mfma_f32_16x16x32_bf16 v[140:143], a[140:143], v[76:79], v[140:143]
  s_waitcnt lgkmcnt(4)
  v_exp_f32 v222, v150
  v_mfma_f32_16x16x32_bf16 v[128:131], a[144:147], v[80:83], v[128:131]
  ds_read_b128 a[176:179], v3 offset:20480
  v_add_f32 v226, v226, v219
  v_mfma_f32_16x16x32_bf16 v[136:139], a[144:147], v[84:87], v[136:139]
  v_exp_f32 v223, v151
  v_mfma_f32_16x16x32_bf16 v[132:135], a[148:151], v[80:83], v[132:135]
  ds_read_b128 a[180:183], v3 offset:21504
  v_cvt_pk_bf16_f32 v185, v218, v219
  v_mfma_f32_16x16x32_bf16 v[140:143], a[148:151], v[84:87], v[140:143]
  v_add_f32 v226, v226, v220
  v_add_f32 v226, v226, v221
  v_mfma_f32_16x16x32_bf16 v[128:131], a[152:155], v[88:91], v[128:131]
  ds_read_b128 a[184:187], v3 offset:22528
  v_cvt_pk_bf16_f32 v186, v220, v221
  v_mfma_f32_16x16x32_bf16 v[136:139], a[152:155], v[92:95], v[136:139]
  v_exp_f32 v216, v152
  v_mfma_f32_16x16x32_bf16 v[132:135], a[156:159], v[88:91], v[132:135]
  ds_read_b128 a[188:191], v3 offset:23552
  v_add_f32 v226, v226, v222
  v_mfma_f32_16x16x32_bf16 v[140:143], a[156:159], v[92:95], v[140:143]
  s_waitcnt lgkmcnt(4)
  v_exp_f32 v217, v153
  v_mfma_f32_16x16x32_bf16 a[0:3], a[160:163], v[160:163], a[0:3]
  ds_read_b128 a[128:131], v3 offset:0
  v_add_f32 v226, v226, v223
  v_mfma_f32_16x16x32_bf16 a[4:7], a[160:163], v[164:167], a[4:7]
  v_exp_f32 v218, v154
  v_mfma_f32_16x16x32_bf16 a[64:67], a[160:163], v[176:179], a[64:67]
  buffer_load_dwordx4 v2, s[44:47], s26 offen offset:1024 sc1 lds
  v_cvt_pk_bf16_f32 v187, v222, v223
  v_mfma_f32_16x16x32_bf16 a[68:71], a[160:163], v[180:183], a[68:71]
  v_exp_f32 v219, v155
  v_mfma_f32_16x16x32_bf16 a[8:11], a[164:167], v[160:163], a[8:11]
  ds_read_b128 a[132:135], v3 offset:1024
  v_add_f32 v227, v216, v217
  v_mfma_f32_16x16x32_bf16 a[12:15], a[164:167], v[164:167], a[12:15]
  v_exp_f32 v220, v156
  v_mfma_f32_16x16x32_bf16 a[72:75], a[164:167], v[176:179], a[72:75]
  v_exp_f32 v221, v157
  v_mfma_f32_16x16x32_bf16 a[76:79], a[164:167], v[180:183], a[76:79]
  v_cvt_pk_bf16_f32 v188, v216, v217
  v_add_f32 v227, v227, v218
  v_mfma_f32_16x16x32_bf16 a[16:19], a[168:171], v[160:163], a[16:19]
  ds_read_b128 a[136:139], v3 offset:2048
  v_add_f32 v227, v227, v219
  v_mfma_f32_16x16x32_bf16 a[20:23], a[168:171], v[164:167], a[20:23]
  v_exp_f32 v222, v158
  v_mfma_f32_16x16x32_bf16 a[80:83], a[168:171], v[176:179], a[80:83]
  v_exp_f32 v223, v159
  v_mfma_f32_16x16x32_bf16 a[84:87], a[168:171], v[180:183], a[84:87]
  v_cvt_pk_bf16_f32 v189, v218, v219
  v_add_f32 v227, v227, v220
  v_mfma_f32_16x16x32_bf16 a[24:27], a[172:175], v[160:163], a[24:27]
  ds_read_b128 a[140:143], v3 offset:3072
  v_add_f32 v227, v227, v221
  v_mfma_f32_16x16x32_bf16 a[28:31], a[172:175], v[164:167], a[28:31]
  v_cvt_pk_bf16_f32 v190, v220, v221
  v_add_f32 v227, v227, v222
  v_mfma_f32_16x16x32_bf16 a[88:91], a[172:175], v[176:179], a[88:91]
  buffer_load_dwordx4 v2, s[44:47], s26 offen offset:2048 sc1 lds
  v_add_f32 v227, v227, v223
  v_mfma_f32_16x16x32_bf16 a[92:95], a[172:175], v[180:183], a[92:95]
  s_waitcnt lgkmcnt(4)
  v_max_f32 v5, v226, v227
  v_cmp_lt_f32 vcc, s81, v5
  v_mfma_f32_16x16x32_bf16 a[32:35], a[176:179], v[160:163], a[32:35]
  ds_read_b128 a[144:147], v3 offset:4096
  v_mfma_f32_16x16x32_bf16 a[36:39], a[176:179], v[164:167], a[36:39]
  v_mfma_f32_16x16x32_bf16 a[96:99], a[176:179], v[176:179], a[96:99]
  v_mfma_f32_16x16x32_bf16 a[100:103], a[176:179], v[180:183], a[100:103]
  v_mfma_f32_16x16x32_bf16 a[40:43], a[180:183], v[160:163], a[40:43]
  ds_read_b128 a[148:151], v3 offset:5120
  v_mfma_f32_16x16x32_bf16 a[44:47], a[180:183], v[164:167], a[44:47]
  v_mfma_f32_16x16x32_bf16 a[104:107], a[180:183], v[176:179], a[104:107]
  v_mfma_f32_16x16x32_bf16 a[108:111], a[180:183], v[180:183], a[108:111]
  v_mfma_f32_16x16x32_bf16 a[48:51], a[184:187], v[160:163], a[48:51]
  ds_read_b128 a[152:155], v3 offset:6144
  v_mfma_f32_16x16x32_bf16 a[52:55], a[184:187], v[164:167], a[52:55]
  v_mfma_f32_16x16x32_bf16 a[112:115], a[184:187], v[176:179], a[112:115]
  buffer_load_dwordx4 v2, s[44:47], s26 offen offset:3072 sc1 lds
  v_mfma_f32_16x16x32_bf16 a[116:119], a[184:187], v[180:183], a[116:119]
  s_add_u32 s26, s26, 16384
  v_mfma_f32_16x16x32_bf16 a[56:59], a[188:191], v[160:163], a[56:59]
  s_add_u32 s24, s24, 32768
  ds_read_b128 a[156:159], v3 offset:7168
  v_mfma_f32_16x16x32_bf16 a[60:63], a[188:191], v[164:167], a[60:63]
  s_and_b32 s24, s24, 0x1ffff
  v_exp_f32 v216, v128
  v_mfma_f32_16x16x32_bf16 a[120:123], a[188:191], v[176:179], a[120:123]
  s_waitcnt lgkmcnt(4)
  v_cvt_pk_bf16_f32 v191, v222, v223
  v_mfma_f32_16x16x32_bf16 a[124:127], a[188:191], v[180:183], a[124:127]
  s_cbranch_vccnz fa_stub6
fa_back6:
  v_exp_f32 v217, v129
  v_add_f32 v230, v230, v226
  v_add_f32 v231, v231, v227
  v_mfma_f32_16x16x32_bf16 v[144:147], a[128:131], v[64:67], v[200:203]
  ds_read_b128 a[160:163], v3 offset:24576
  v_add_f32 v226, v216, v217
  v_mfma_f32_16x16x32_bf16 v[152:155], a[128:131], v[68:71], v[204:207]
  v_exp_f32 v218, v130
  v_mfma_f32_16x16x32_bf16 v[148:151], a[132:135], v[64:67], v[200:203]
  s_add_u32 s66, s66, 32768
  ds_read_b128 a[164:167], v3 offset:25600
  v_cvt_pk_bf16_f32 v176, v216, v217
  v_mfma_f32_16x16x32_bf16 v[156:159], a[132:135], v[68:71], v[204:207]
  s_mov_b32 m0, s25
  v_exp_f32 v219, v131
  v_mfma_f32_16x16x32_bf16 v[144:147], a[136:139], v[72:75], v[144:147]
  s_and_b32 s66, s66, 0x1ffff
  ds_read_b128 a[168:171], v3 offset:26624
  buffer_load_dwordx4 v2, s[48:51], s27 offen offset:0 sc1 lds
  v_add_f32 v226, v226, v218
  v_add_f32 v226, v226, v219
  v_mfma_f32_16x16x32_bf16 v[152:155], a[136:139], v[76:79], v[152:155]
  v_exp_f32 v220, v132
  v_mfma_f32_16x16x32_bf16 v[148:151], a[140:143], v[72:75], v[148:151]
  ds_read_b128 a[172:175], v3 offset:27648
  v_cvt_pk_bf16_f32 v177, v218, v219
  v_mfma_f32_16x16x32_bf16 v[156:159], a[140:143], v[76:79], v[156:159]
  s_waitcnt lgkmcnt(4)
  v_exp_f32 v221, v133
  v_mfma_f32_16x16x32_bf16 v[144:147], a[144:147], v[80:83], v[144:147]
  ds_read_b128 a[176:179], v3 offset:28672
  v_add_f32 v226, v226, v220
  v_mfma_f32_16x16x32_bf16 v[152:155], a[144:147], v[84:87], v[152:155]
  v_exp_f32 v222, v134
  v_mfma_f32_16x16x32_bf16 v[148:151], a[148:151], v[80:83], v[148:151]
  ds_read_b128 a[180:183], v3 offset:29696
  buffer_load_dwordx4 v2, s[48:51], s27 offen offset:1024 sc1 lds
  v_add_f32 v226, v226, v221
  v_cvt_pk_bf16_f32 v178, v220, v221
  v_mfma_f32_16x16x32_bf16 v[156:159], a[148:151], v[84:87], v[156:159]
  v_exp_f32 v223, v135
  v_mfma_f32_16x16x32_bf16 v[144:147], a[152:155], v[88:91], v[144:147]
  ds_read_b128 a[184:187], v3 offset:30720
  v_add_f32 v226, v226, v222
  v_mfma_f32_16x16x32_bf16 v[152:155], a[152:155], v[92:95], v[152:155]
  v_exp_f32 v216, v136
  v_mfma_f32_16x16x32_bf16 v[148:151], a[156:159], v[88:91], v[148:151]
  ds_read_b128 a[188:191], v3 offset:31744
  v_add_f32 v226, v226, v223
  v_exp_f32 v217, v137
  v_mfma_f32_16x16x32_bf16 v[156:159], a[156:159], v[92:95], v[156:159]
  s_waitcnt lgkmcnt(4)
  v_exp_f32 v218, v138
  v_mfma_f32_16x16x32_bf16 a[64:67], a[160:163], v[184:187], a[64:67]
  ds_read_b128 a[128:131], v3 offset:8192
  v_cvt_pk_bf16_f32 v179, v222, v223
  v_mfma_f32_16x16x32_bf16 a[68:71], a[160:163], v[188:191], a[68:71]
  v_exp_f32 v219, v139
  v_mfma_f32_16x16x32_bf16 a[72:75], a[164:167], v[184:187], a[72:75]
  ds_read_b128 a[132:135], v3 offset:9216
  buffer_load_dwordx4 v2, s[48:51], s27 offen offset:2048 sc1 lds
  v_add_f32 v227, v216, v217
  v_mfma_f32_16x16x32_bf16 a[76:79], a[164:167], v[188:191], a[76:79]
  v_exp_f32 v220, v140
  v_mfma_f32_16x16x32_bf16 a[80:83], a[168:171], v[184:187], a[80:83]
  ds_read_b128 a[136:139], v3 offset:10240
  v_cvt_pk_bf16_f32 v180, v216, v217
  v_mfma_f32_16x16x32_bf16 a[84:87], a[168:171], v[188:191], a[84:87]
  v_exp_f32 v221, v141
  v_mfma_f32_16x16x32_bf16 a[88:91], a[172:175], v[184:187], a[88:91]
  ds_read_b128 a[140:143], v3 offset:11264
  v_add_f32 v227, v227, v218
  v_mfma_f32_16x16x32_bf16 a[92:95], a[172:175], v[188:191], a[92:95]
  s_waitcnt lgkmcnt(4)
  v_exp_f32 v222, v142
  v_mfma_f32_16x16x32_bf16 a[96:99], a[176:179], v[184:187], a[96:99]
  ds_read_b128 a[144:147], v3 offset:12288
  buffer_load_dwordx4 v2, s[48:51], s27 offen offset:3072 sc1 lds
  v_add_f32 v227, v227, v219
  v_cvt_pk_bf16_f32 v181, v218, v219
  v_mfma_f32_16x16x32_bf16 a[100:103], a[176:179], v[188:191], a[100:103]
  s_add_u32 s27, s27, 16384
  v_exp_f32 v223, v143
  v_mfma_f32_16x16x32_bf16 a[104:107], a[180:183], v[184:187], a[104:107]
  s_add_u32 s25, s25, 32768
  ds_read_b128 a[148:151], v3 offset:13312
  v_add_f32 v227, v227, v220
  v_mfma_f32_16x16x32_bf16 a[108:111], a[180:183], v[188:191], a[108:111]
  s_and_b32 s25, s25, 0x1ffff
  v_add_f32 v227, v227, v221
  v_cvt_pk_bf16_f32 v182, v220, v221
  v_add_f32 v227, v227, v222
  v_mfma_f32_16x16x32_bf16 a[112:115], a[184:187], v[184:187], a[112:115]
  ds_read_b128 a[152:155], v3 offset:14336
  v_add_f32 v227, v227, v223
  v_max_f32 v5, v226, v227
  v_cmp_lt_f32 vcc, s81, v5
  v_mfma_f32_16x16x32_bf16 a[116:119], a[184:187], v[188:191], a[116:119]
  v_exp_f32 v216, v144
  v_mfma_f32_16x16x32_bf16 a[120:123], a[188:191], v[184:187], a[120:123]
  s_waitcnt lgkmcnt(3)
  ds_read_b128 a[156:159], v3 offset:15360
  v_cvt_pk_bf16_f32 v183, v222, v223
  v_add_u32 v3, s66, v2
  v_mfma_f32_16x16x32_bf16 a[124:127], a[188:191], v[188:191], a[124:127]
  s_cbranch_vccnz fa_stub7
fa_back7:
  v_exp_f32 v217, v145
  v_add_f32 v230, v230, v226
  v_add_f32 v231, v231, v227
  s_branch fa_SSpre
fa_Aodd:
  v_mfma_f32_16x16x32_bf16 v[128:131], a[128:131], v[64:67], v[200:203]
  s_waitcnt vmcnt(12)
  v_exp_f32 v218, v146
  v_add_f32 v226, v216, v217
  v_mfma_f32_16x16x32_bf16 v[136:139], a[128:131], v[68:71], v[204:207]
  s_barrier
  v_exp_f32 v219, v147
  v_cvt_pk_bf16_f32 v184, v216, v217
  v_mfma_f32_16x16x32_bf16 v[132:135], a[132:135], v[64:67], v[200:203]
  ds_read_b128 a[160:163], v3 offset:16384
  ds_read_b128 a[164:167], v3 offset:17408
  v_exp_f32 v220, v148
  v_mfma_f32_16x16x32_bf16 v[140:143], a[132:135], v[68:71], v[204:207]
  v_exp_f32 v221, v149
  v_add_f32 v226, v226, v218
  v_mfma_f32_16x16x32_bf16 v[128:131], a[136:139], v[72:75], v[128:131]
  ds_read_b128 a[168:171], v3 offset:18432
  v_add_f32 v226, v226, v219
  v_cvt_pk_bf16_f32 v185, v218, v219
  v_mfma_f32_16x16x32_bf16 v[136:139], a[136:139], v[76:79], v[136:139]
  s_mov_b32 m0, s24
  v_exp_f32 v222, v150
  v_add_f32 v226, v226, v220
  v_mfma_f32_16x16x32_bf16 v[132:135], a[140:143], v[72:75], v[132:135]
  ds_read_b128 a[172:175], v3 offset:19456
  buffer_load_dwordx4 v2, s[44:47], s26 offen offset:0 sc1 lds
  v_add_f32 v226, v226, v221
  v_cvt_pk_bf16_f32 v186, v220, v221
  v_mfma_f32_16x16x32_bf16 v[140:143], a[140:143], v[76:79], v[140:143]
  s_waitcnt lgkmcnt(4)
  v_exp_f32 v223, v151
  v_cndmask_b32 v112, v4, v112, s[68:69]
  v_mfma_f32_16x16x32_bf16 v[128:131], a[144:147], v[80:83], v[128:131]
  ds_read_b128 a[176:179], v3 offset:20480
  v_cndmask_b32 v113, v4, v113, s[70:71]
  v_cndmask_b32 v114, v4, v114, s[72:73]
  v_mfma_f32_16x16x32_bf16 v[136:139], a[144:147], v[84:87], v[136:139]
  v_exp_f32 v216, v152
  v_cndmask_b32 v115, v4, v115, s[74:75]
  v_mfma_f32_16x16x32_bf16 v[132:135], a[148:151], v[80:83], v[132:135]
  ds_read_b128 a[180:183], v3 offset:21504
  v_mov_b32 v116, v4
  v_mov_b32 v117, v4
  v_mfma_f32_16x16x32_bf16 v[140:143], a[148:151], v[84:87], v[140:143]
  v_exp_f32 v217, v153
  v_mov_b32 v118, v4
  v_mfma_f32_16x16x32_bf16 v[128:131], a[152:155], v[88:91], v[128:131]
  ds_read_b128 a[184:187], v3 offset:22528
  v_mov_b32 v119, v4
  v_cndmask_b32 v124, v4, v124, s[68:69]
  v_mfma_f32_16x16x32_bf16 v[136:139], a[152:155], v[92:95], v[136:139]
  v_exp_f32 v218, v154
  v_cndmask_b32 v125, v4, v125, s[70:71]
  v_mfma_f32_16x16x32_bf16 v[132:135], a[156:159], v[88:91], v[132:135]
  ds_read_b128 a[188:191], v3 offset:23552
  v_cndmask_b32 v126, v4, v126, s[72:73]
  v_cndmask_b32 v127, v4, v127, s[74:75]
  v_mfma_f32_16x16x32_bf16 v[140:143], a[156:159], v[92:95], v[140:143]
  s_waitcnt lgkmcnt(4)
  v_exp_f32 v219, v155
  v_add_f32 v226, v226, v222
  v_mfma_f32_16x16x32_bf16 a[0:3], a[160:163], v[160:163], a[0:3]
  ds_read_b128 a[128:131], v3 offset:0
  v_add_f32 v226, v226, v223
  v_cvt_pk_bf16_f32 v187, v222, v223
  v_mfma_f32_16x16x32_bf16 a[4:7], a[160:163], v[164:167], a[4:7]
  v_exp_f32 v220, v156
  v_add_f32 v227, v216, v217
  v_mfma_f32_16x16x32_bf16 a[64:67], a[160:163], v[176:179], a[64:67]
  buffer_load_dwordx4 v2, s[44:47], s26 offen offset:1024 sc1 lds
  v_exp_f32 v221, v157
  v_mfma_f32_16x16x32_bf16 a[68:71], a[160:163], v[180:183], a[68:71]
  v_exp_f32 v222, v158
  v_mfma_f32_16x16x32_bf16 a[8:11], a[164:167], v[160:163], a[8:11]
  ds_read_b128 a[132:135], v3 offset:1024
  v_cvt_pk_bf16_f32 v188, v216, v217
  v_add_f32 v227, v227, v218
  v_add_f32 v227, v227, v219
  v_mfma_f32_16x16x32_bf16 a[12:15], a[164:167], v[164:167], a[12:15]
  v_exp_f32 v223, v159
  v_mfma_f32_16x16x32_bf16 a[72:75], a[164:167], v[176:179], a[72:75]
  v_exp_f32 v208, v112
  v_mfma_f32_16x16x32_bf16 a[76:79], a[164:167], v[180:183], a[76:79]
  v_exp_f32 v209, v113
  v_mfma_f32_16x16x32_bf16 a[16:19], a[168:171], v[160:163], a[16:19]
  ds_read_b128 a[136:139], v3 offset:2048
  v_cvt_pk_bf16_f32 v189, v218, v219
  v_add_f32 v227, v227, v220
  v_add_f32 v227, v227, v221
  v_cvt_pk_bf16_f32 v190, v220, v221
  v_add_f32 v227, v227, v222
  v_mfma_f32_16x16x32_bf16 a[20:23], a[168:171], v[164:167], a[20:23]
  v_exp_f32 v210, v114
  v_mfma_f32_16x16x32_bf16 a[80:83], a[168:171], v[176:179], a[80:83]
  v_exp_f32 v211, v115
  v_mfma_f32_16x16x32_bf16 a[84:87], a[168:171], v[180:183], a[84:87]
  v_exp_f32 v212, v116
  v_mfma_f32_16x16x32_bf16 a[24:27], a[172:175], v[160:163], a[24:27]
  ds_read_b128 a[140:143], v3 offset:3072
  v_add_f32 v227, v227, v223
  v_cvt_pk_bf16_f32 v191, v222, v223
  v_add_f32 v224, v208, v209
  v_cvt_pk_bf16_f32 v168, v208, v209
  v_add_f32 v224, v224, v210
  v_mfma_f32_16x16x32_bf16 a[28:31], a[172:175], v[164:167], a[28:31]
  v_exp_f32 v213, v117
  v_mfma_f32_16x16x32_bf16 a[88:91], a[172:175], v[176:179], a[88:91]
  buffer_load_dwordx4 v2, s[44:47], s26 offen offset:2048 sc1 lds
  v_exp_f32 v214, v118
  v_mfma_f32_16x16x32_bf16 a[92:95], a[172:175], v[180:183], a[92:95]
  s_waitcnt lgkmcnt(4)
  v_exp_f32 v215, v119
  v_mfma_f32_16x16x32_bf16 a[32:35], a[176:179], v[160:163], a[32:35]
  ds_read_b128 a[144:147], v3 offset:4096
  v_add_f32 v224, v224, v211
  v_cvt_pk_bf16_f32 v169, v210, v211
  v_add_f32 v224, v224, v212
  v_add_f32 v224, v224, v213
  v_mfma_f32_16x16x32_bf16 a[36:39], a[176:179], v[164:167], a[36:39]
  v_exp_f32 v208, v120
  v_mfma_f32_16x16x32_bf16 a[96:99], a[176:179], v[176:179], a[96:99]
  v_exp_f32 v209, v121
  v_mfma_f32_16x16x32_bf16 a[100:103], a[176:179], v[180:183], a[100:103]
  v_exp_f32 v210, v122
  v_mfma_f32_16x16x32_bf16 a[40:43], a[180:183], v[160:163], a[40:43]
  ds_read_b128 a[148:151], v3 offset:5120
  v_cvt_pk_bf16_f32 v170, v212, v213
  v_add_f32 v224, v224, v214
  v_add_f32 v224, v224, v215
  v_cvt_pk_bf16_f32 v171, v214, v215
  v_add_f32 v225, v208, v209
  v_mfma_f32_16x16x32_bf16 a[44:47], a[180:183], v[164:167], a[44:47]
  v_exp_f32 v211, v123
  v_mfma_f32_16x16x32_bf16 a[104:107], a[180:183], v[176:179], a[104:107]
  v_exp_f32 v212, v124
  v_mfma_f32_16x16x32_bf16 a[108:111], a[180:183], v[180:183], a[108:111]
  v_exp_f32 v213, v125
  v_mfma_f32_16x16x32_bf16 a[48:51], a[184:187], v[160:163], a[48:51]
  ds_read_b128 a[152:155], v3 offset:6144
  v_cvt_pk_bf16_f32 v172, v208, v209
  v_add_f32 v225, v225, v210
  v_add_f32 v225, v225, v211
  v_cvt_pk_bf16_f32 v173, v210, v211
  v_max3_f32 v5, v226, v227, v224
  v_mfma_f32_16x16x32_bf16 a[52:55], a[184:187], v[164:167], a[52:55]
  v_exp_f32 v214, v126
  v_mfma_f32_16x16x32_bf16 a[112:115], a[184:187], v[176:179], a[112:115]
  buffer_load_dwordx4 v2, s[44:47], s26 offen offset:3072 sc1 lds
  v_add_f32 v225, v225, v212
  v_add_f32 v225, v225, v213
  v_cvt_pk_bf16_f32 v174, v212, v213
  v_mfma_f32_16x16x32_bf16 a[116:119], a[184:187], v[180:183], a[116:119]
  s_add_u32 s26, s26, 16384
  v_exp_f32 v215, v127
  v_mfma_f32_16x16x32_bf16 a[56:59], a[188:191], v[160:163], a[56:59]
  s_add_u32 s24, s24, 32768
  ds_read_b128 a[156:159], v3 offset:7168
  v_add_f32 v225, v225, v214
  v_add_f32 v225, v225, v215
  v_max_f32 v5, v5, v225
  v_cmp_lt_f32 vcc, s81, v5
  v_mfma_f32_16x16x32_bf16 a[60:63], a[188:191], v[164:167], a[60:63]
  s_and_b32 s24, s24, 0x1ffff
  v_exp_f32 v216, v128
  v_mfma_f32_16x16x32_bf16 a[120:123], a[188:191], v[176:179], a[120:123]
  s_waitcnt lgkmcnt(4)
  v_cvt_pk_bf16_f32 v175, v214, v215
  v_mfma_f32_16x16x32_bf16 a[124:127], a[188:191], v[180:183], a[124:127]
  s_cbranch_vccnz fa_stub8
fa_back8:
  v_exp_f32 v217, v129
  v_add_f32 v228, v228, v224
  v_add_f32 v229, v229, v225
  v_add_f32 v230, v230, v226
  v_add_f32 v231, v231, v227
  v_mfma_f32_16x16x32_bf16 v[144:147], a[128:131], v[64:67], v[200:203]
  ds_read_b128 a[160:163], v3 offset:24576
  v_add_f32 v226, v216, v217
  v_mfma_f32_16x16x32_bf16 v[152:155], a[128:131], v[68:71], v[204:207]
  v_exp_f32 v218, v130
  v_mfma_f32_16x16x32_bf16 v[148:151], a[132:135], v[64:67], v[200:203]
  s_add_u32 s66, s66, 32768
  ds_read_b128 a[164:167], v3 offset:25600
  v_cvt_pk_bf16_f32 v176, v216, v217
  v_mfma_f32_16x16x32_bf16 v[156:159], a[132:135], v[68:71], v[204:207]
  s_and_b32 s66, s66, 0x1ffff
  v_exp_f32 v219, v131
  v_mfma_f32_16x16x32_bf16 v[144:147], a[136:139], v[72:75], v[144:147]
  ds_read_b128 a[168:171], v3 offset:26624
  v_add_f32 v226, v226, v218
  v_mfma_f32_16x16x32_bf16 v[152:155], a[136:139], v[76:79], v[152:155]
  s_mov_b32 m0, s25
  v_exp_f32 v220, v132
  v_mfma_f32_16x16x32_bf16 v[148:151], a[140:143], v[72:75], v[148:151]
  ds_read_b128 a[172:175], v3 offset:27648
  buffer_load_dwordx4 v2, s[48:51], s27 offen offset:0 sc1 lds
  v_add_f32 v226, v226, v219
  v_mfma_f32_16x16x32_bf16 v[156:159], a[140:143], v[76:79], v[156:159]
  s_waitcnt lgkmcnt(4)
  v_exp_f32 v221, v133
  v_mfma_f32_16x16x32_bf16 v[144:147], a[144:147], v[80:83], v[144:147]
  ds_read_b128 a[176:179], v3 offset:28672
  v_cvt_pk_bf16_f32 v177, v218, v219
  v_mfma_f32_16x16x32_bf16 v[152:155], a[144:147], v[84:87], v[152:155]
  v_exp_f32 v222, v134
  v_mfma_f32_16x16x32_bf16 v[148:151], a[148:151], v[80:83], v[148:151]
  ds_read_b128 a[180:183], v3 offset:29696
  v_add_f32 v226, v226, v220
  v_mfma_f32_16x16x32_bf16 v[156:159], a[148:151], v[84:87], v[156:159]
  v_exp_f32 v223, v135
  v_mfma_f32_16x16x32_bf16 v[144:147], a[152:155], v[88:91], v[144:147]
  ds_read_b128 a[184:187], v3 offset:30720
  v_add_f32 v226, v226, v221
  v_mfma_f32_16x16x32_bf16 v[152:155], a[152:155], v[92:95], v[152:155]
  v_exp_f32 v216, v136
  v_mfma_f32_16x16x32_bf16 v[148:151], a[156:159], v[88:91], v[148:151]
  ds_read_b128 a[188:191], v3 offset:31744
  v_cvt_pk_bf16_f32 v178, v220, v221
  v_mfma_f32_16x16x32_bf16 v[156:159], a[156:159], v[92:95], v[156:159]
  s_waitcnt lgkmcnt(4)
  v_exp_f32 v217, v137
  v_mfma_f32_16x16x32_bf16 a[0:3], a[160:163], v[168:171], a[0:3]
  ds_read_b128 a[128:131], v3 offset:8192
  v_add_f32 v226, v226, v222
  v_mfma_f32_16x16x32_bf16 a[4:7], a[160:163], v[172:175], a[4:7]
  v_exp_f32 v218, v138
  v_mfma_f32_16x16x32_bf16 a[64:67], a[160:163], v[184:187], a[64:67]
  buffer_load_dwordx4 v2, s[48:51], s27 offen offset:1024 sc1 lds
  v_add_f32 v226, v226, v223
  v_mfma_f32_16x16x32_bf16 a[68:71], a[160:163], v[188:191], a[68:71]
  v_exp_f32 v219, v139
  v_mfma_f32_16x16x32_bf16 a[8:11], a[164:167], v[168:171], a[8:11]
  ds_read_b128 a[132:135], v3 offset:9216
  v_cvt_pk_bf16_f32 v179, v222, v223
  v_mfma_f32_16x16x32_bf16 a[12:15], a[164:167], v[172:175], a[12:15]
  v_exp_f32 v220, v140
  v_mfma_f32_16x16x32_bf16 a[72:75], a[164:167], v[184:187], a[72:75]
  v_add_f32 v227, v216, v217
  v_cvt_pk_bf16_f32 v180, v216, v217
  v_mfma_f32_16x16x32_bf16 a[76:79], a[164:167], v[188:191], a[76:79]
  v_exp_f32 v221, v141
  v_mfma_f32_16x16x32_bf16 a[16:19], a[168:171], v[168:171], a[16:19]
  ds_read_b128 a[136:139], v3 offset:10240
  v_add_f32 v227, v227, v218
  v_mfma_f32_16x16x32_bf16 a[20:23], a[168:171], v[172:175], a[20:23]
  v_exp_f32 v222, v142
  v_mfma_f32_16x16x32_bf16 a[80:83], a[168:171], v[184:187], a[80:83]
  v_add_f32 v227, v227, v219
  v_cvt_pk_bf16_f32 v181, v218, v219
  v_mfma_f32_16x16x32_bf16 a[84:87], a[168:171], v[188:191], a[84:87]
  v_exp_f32 v223, v143
  v_mfma_f32_16x16x32_bf16 a[24:27], a[172:175], v[168:171], a[24:27]
  ds_read_b128 a[140:143], v3 offset:11264
  v_add_f32 v227, v227, v220
  v_mfma_f32_16x16x32_bf16 a[28:31], a[172:175], v[172:175], a[28:31]
  v_add_f32 v227, v227, v221
  v_cvt_pk_bf16_f32 v182, v220, v221
  v_mfma_f32_16x16x32_bf16 a[88:91], a[172:175], v[184:187], a[88:91]
  buffer_load_dwordx4 v2, s[48:51], s27 offen offset:2048 sc1 lds
  v_add_f32 v227, v227, v222
  v_mfma_f32_16x16x32_bf16 a[92:95], a[172:175], v[188:191], a[92:95]
  s_waitcnt lgkmcnt(4)
  v_add_f32 v227, v227, v223
  v_max_f32 v5, v226, v227
  v_mfma_f32_16x16x32_bf16 a[32:35], a[176:179], v[168:171], a[32:35]
  ds_read_b128 a[144:147], v3 offset:12288
  v_cmp_lt_f32 vcc, s81, v5
  v_mfma_f32_16x16x32_bf16 a[36:39], a[176:179], v[172:175], a[36:39]
  v_mfma_f32_16x16x32_bf16 a[96:99], a[176:179], v[184:187], a[96:99]
  v_mfma_f32_16x16x32_bf16 a[100:103], a[176:179], v[188:191], a[100:103]
  v_mfma_f32_16x16x32_bf16 a[40:43], a[180:183], v[168:171], a[40:43]
  ds_read_b128 a[148:151], v3 offset:13312
  v_mfma_f32_16x16x32_bf16 a[44:47], a[180:183], v[172:175], a[44:47]
  v_mfma_f32_16x16x32_bf16 a[104:107], a[180:183], v[184:187], a[104:107]
  v_mfma_f32_16x16x32_bf16 a[108:111], a[180:183], v[188:191], a[108:111]
  v_mfma_f32_16x16x32_bf16 a[48:51], a[184:187], v[168:171], a[48:51]
  ds_read_b128 a[152:155], v3 offset:14336
  v_mfma_f32_16x16x32_bf16 a[52:55], a[184:187], v[172:175], a[52:55]
  v_mfma_f32_16x16x32_bf16 a[112:115], a[184:187], v[184:187], a[112:115]
  buffer_load_dwordx4 v2, s[48:51], s27 offen offset:3072 sc1 lds
  v_mfma_f32_16x16x32_bf16 a[116:119], a[184:187], v[188:191], a[116:119]
  s_add_u32 s27, s27, 16384
  v_mfma_f32_16x16x32_bf16 a[56:59], a[188:191], v[168:171], a[56:59]
  s_add_u32 s25, s25, 32768
  ds_read_b128 a[156:159], v3 offset:15360
  v_mfma_f32_16x16x32_bf16 a[60:63], a[188:191], v[172:175], a[60:63]
  s_and_b32 s25, s25, 0x1ffff
  v_exp_f32 v216, v144
  v_mfma_f32_16x16x32_bf16 a[120:123], a[188:191], v[184:187], a[120:123]
  s_waitcnt lgkmcnt(4)
  v_cvt_pk_bf16_f32 v183, v222, v223
  v_add_u32 v3, s66, v2
  v_mfma_f32_16x16x32_bf16 a[124:127], a[188:191], v[188:191], a[124:127]
  s_cbranch_vccnz fa_stub9
fa_back9:
  v_exp_f32 v217, v145
  v_add_f32 v230, v230, v226
  v_add_f32 v231, v231, v227
fa_SSpre:
  s_mov_b32 s11, 1
  s_cmp_lg_u32 s12, 0
  s_cselect_b32 s32, s15, s32
  s_cmp_ge_u32 s20, 2
  s_cselect_b32 s23, 8, 0
  s_cmp_le_u32 s29, s23
  s_cbranch_scc1 fa_chain
.p2align 6
fa_SS:
  v_mfma_f32_16x16x32_bf16 v[128:131], a[128:131], v[64:67], v[200:203]
  s_waitcnt vmcnt(12)
  v_exp_f32 v218, v146
  v_mfma_f32_16x16x32_bf16 v[136:139], a[128:131], v[68:71], v[204:207]
  s_barrier
  v_exp_f32 v219, v147
  v_mfma_f32_16x16x32_bf16 v[132:135], a[132:135], v[64:67], v[200:203]
  s_cmp_ge_u32 s26, s32
  ds_read_b128 a[160:163], v3 offset:16384
  ds_read_b128 a[164:167], v3 offset:17408
  v_add_f32 v226, v216, v217
  v_mfma_f32_16x16x32_bf16 v[140:143], a[132:135], v[68:71], v[204:207]
  s_cbranch_scc1 fa_hk7
fa_hb7:
  v_exp_f32 v220, v148
  v_mfma_f32_16x16x32_bf16 v[128:131], a[136:139], v[72:75], v[128:131]
  ds_read_b128 a[168:171], v3 offset:18432
  v_cvt_pk_bf16_f32 v184, v216, v217
  v_mfma_f32_16x16x32_bf16 v[136:139], a[136:139], v[76:79], v[136:139]
  s_mov_b32 m0, s24
  v_exp_f32 v221, v149
  v_mfma_f32_16x16x32_bf16 v[132:135], a[140:143], v[72:75], v[132:135]
  ds_read_b128 a[172:175], v3 offset:19456
  buffer_load_dwordx4 v2, s[44:47], s26 offen offset:0 sc1 lds
  v_add_f32 v226, v226, v218
  v_add_f32 v226, v226, v219
  v_mfma_f32_16x16x32_bf16 v[140:143], a[140:143], v[76:79], v[140:143]
  s_waitcnt lgkmcnt(4)
  v_exp_f32 v222, v150
  v_mfma_f32_16x16x32_bf16 v[128:131], a[144:147], v[80:83], v[128:131]
  ds_read_b128 a[176:179], v3 offset:20480
  v_cvt_pk_bf16_f32 v185, v218, v219
  v_mfma_f32_16x16x32_bf16 v[136:139], a[144:147], v[84:87], v[136:139]
  v_exp_f32 v223, v151
  v_mfma_f32_16x16x32_bf16 v[132:135], a[148:151], v[80:83], v[132:135]
  ds_read_b128 a[180:183], v3 offset:21504
  v_add_f32 v226, v226, v220
  v_mfma_f32_16x16x32_bf16 v[140:143], a[148:151], v[84:87], v[140:143]
  v_exp_f32 v216, v152
  v_mfma_f32_16x16x32_bf16 v[128:131], a[152:155], v[88:91], v[128:131]
  ds_read_b128 a[184:187], v3 offset:22528
  buffer_load_dwordx4 v2, s[44:47], s26 offen offset:1024 sc1 lds
  v_add_f32 v226, v226, v221
  v_cvt_pk_bf16_f32 v186, v220, v221
  v_mfma_f32_16x16x32_bf16 v[136:139], a[152:155], v[92:95], v[136:139]
  v_exp_f32 v217, v153
  v_mfma_f32_16x16x32_bf16 v[132:135], a[156:159], v[88:91], v[132:135]
  ds_read_b128 a[188:191], v3 offset:23552
  v_add_f32 v226, v226, v222
  v_mfma_f32_16x16x32_bf16 v[140:143], a[156:159], v[92:95], v[140:143]
  s_waitcnt lgkmcnt(4)
  v_exp_f32 v218, v154
  v_mfma_f32_16x16x32_bf16 a[64:67], a[160:163], v[176:179], a[64:67]
  ds_read_b128 a[128:131], v3 offset:0
  v_add_f32 v226, v226, v223
  v_cvt_pk_bf16_f32 v187, v222, v223
  v_mfma_f32_16x16x32_bf16 a[68:71], a[160:163], v[180:183], a[68:71]
  v_exp_f32 v219, v155
  v_mfma_f32_16x16x32_bf16 a[72:75], a[164:167], v[176:179], a[72:75]
  ds_read_b128 a[132:135], v3 offset:1024
  buffer_load_dwordx4 v2, s[44:47], s26 offen offset:2048 sc1 lds
  v_add_f32 v227, v216, v217
  v_mfma_f32_16x16x32_bf16 a[76:79], a[164:167], v[180:183], a[76:79]
  v_exp_f32 v220, v156
  v_mfma_f32_16x16x32_bf16 a[80:83], a[168:171], v[176:179], a[80:83]
  ds_read_b128 a[136:139], v3 offset:2048
  v_cvt_pk_bf16_f32 v188, v216, v217
  v_mfma_f32_16x16x32_bf16 a[84:87], a[168:171], v[180:183], a[84:87]
  v_exp_f32 v221, v157
  v_mfma_f32_16x16x32_bf16 a[88:91], a[172:175], v[176:179], a[88:91]
  ds_read_b128 a[140:143], v3 offset:3072
  v_add_f32 v227, v227, v218
  v_add_f32 v227, v227, v219
  v_mfma_f32_16x16x32_bf16 a[92:95], a[172:175], v[180:183], a[92:95]
  s_waitcnt lgkmcnt(4)
  v_exp_f32 v222, v158
  v_mfma_f32_16x16x32_bf16 a[96:99], a[176:179], v[176:179], a[96:99]
  ds_read_b128 a[144:147], v3 offset:4096
  buffer_load_dwordx4 v2, s[44:47], s26 offen offset:3072 sc1 lds
  v_cvt_pk_bf16_f32 v189, v218, v219
  v_mfma_f32_16x16x32_bf16 a[100:103], a[176:179], v[180:183], a[100:103]
  s_add_u32 s26, s26, 16384
  v_exp_f32 v223, v159
  v_mfma_f32_16x16x32_bf16 a[104:107], a[180:183], v[176:179], a[104:107]
  s_add_u32 s24, s24, 32768
  ds_read_b128 a[148:151], v3 offset:5120
  v_add_f32 v227, v227, v220
  v_mfma_f32_16x16x32_bf16 a[108:111], a[180:183], v[180:183], a[108:111]
  s_and_b32 s24, s24, 0x1ffff
  v_add_f32 v227, v227, v221
  v_cvt_pk_bf16_f32 v190, v220, v221
  v_add_f32 v227, v227, v222
  v_mfma_f32_16x16x32_bf16 a[112:115], a[184:187], v[176:179], a[112:115]
  ds_read_b128 a[152:155], v3 offset:6144
  v_add_f32 v227, v227, v223
  v_max_f32 v5, v226, v227
  v_cmp_lt_f32 vcc, s81, v5
  v_mfma_f32_16x16x32_bf16 a[116:119], a[184:187], v[180:183], a[116:119]
  v_exp_f32 v216, v128
  v_mfma_f32_16x16x32_bf16 a[120:123], a[188:191], v[176:179], a[120:123]
  s_waitcnt lgkmcnt(3)
  ds_read_b128 a[156:159], v3 offset:7168
  v_cvt_pk_bf16_f32 v191, v222, v223
  v_mfma_f32_16x16x32_bf16 a[124:127], a[188:191], v[180:183], a[124:127]
  s_cbranch_vccnz fa_stub10
fa_back10:
  v_exp_f32 v217, v129
  v_add_f32 v230, v230, v226
  v_add_f32 v231, v231, v227
  v_mfma_f32_16x16x32_bf16 v[144:147], a[128:131], v[64:67], v[200:203]
  ds_read_b128 a[160:163], v3 offset:24576
  v_add_f32 v226, v216, v217
  v_mfma_f32_16x16x32_bf16 v[152:155], a[128:131], v[68:71], v[204:207]
  v_exp_f32 v218, v130
  v_mfma_f32_16x16x32_bf16 v[148:151], a[132:135], v[64:67], v[200:203]
  s_add_u32 s66, s66, 32768
  ds_read_b128 a[164:167], v3 offset:25600
  v_cvt_pk_bf16_f32 v176, v216, v217
  v_mfma_f32_16x16x32_bf16 v[156:159], a[132:135], v[68:71], v[204:207]
  s_mov_b32 m0, s25
  v_exp_f32 v219, v131
  v_mfma_f32_16x16x32_bf16 v[144:147], a[136:139], v[72:75], v[144:147]
  s_and_b32 s66, s66, 0x1ffff
  ds_read_b128 a[168:171], v3 offset:26624
  buffer_load_dwordx4 v2, s[48:51], s27 offen offset:0 sc1 lds
  v_add_f32 v226, v226, v218
  v_add_f32 v226, v226, v219
  v_mfma_f32_16x16x32_bf16 v[152:155], a[136:139], v[76:79], v[152:155]
  v_exp_f32 v220, v132
  v_mfma_f32_16x16x32_bf16 v[148:151], a[140:143], v[72:75], v[148:151]
  ds_read_b128 a[172:175], v3 offset:27648
  v_cvt_pk_bf16_f32 v177, v218, v219
  v_mfma_f32_16x16x32_bf16 v[156:159], a[140:143], v[76:79], v[156:159]
  s_waitcnt lgkmcnt(4)
  v_exp_f32 v221, v133
  v_mfma_f32_16x16x32_bf16 v[144:147], a[144:147], v[80:83], v[144:147]
  ds_read_b128 a[176:179], v3 offset:28672
  v_add_f32 v226, v226, v220
  v_mfma_f32_16x16x32_bf16 v[152:155], a[144:147], v[84:87], v[152:155]
  v_exp_f32 v222, v134
  v_mfma_f32_16x16x32_bf16 v[148:151], a[148:151], v[80:83], v[148:151]
  ds_read_b128 a[180:183], v3 offset:29696
  buffer_load_dwordx4 v2, s[48:51], s27 offen offset:1024 sc1 lds
  v_add_f32 v226, v226, v221
  v_cvt_pk_bf16_f32 v178, v220, v221
  v_mfma_f32_16x16x32_bf16 v[156:159], a[148:151], v[84:87], v[156:159]
  v_exp_f32 v223, v135
  v_mfma_f32_16x16x32_bf16 v[144:147], a[152:155], v[88:91], v[144:147]
  ds_read_b128 a[184:187], v3 offset:30720
  v_add_f32 v226, v226, v222
  v_mfma_f32_16x16x32_bf16 v[152:155], a[152:155], v[92:95], v[152:155]
  v_exp_f32 v216, v136
  v_mfma_f32_16x16x32_bf16 v[148:151], a[156:159], v[88:91], v[148:151]
  ds_read_b128 a[188:191], v3 offset:31744
  v_add_f32 v226, v226, v223
  v_exp_f32 v217, v137
  v_mfma_f32_16x16x32_bf16 v[156:159], a[156:159], v[92:95], v[156:159]
  s_waitcnt lgkmcnt(4)
  v_exp_f32 v218, v138
  v_mfma_f32_16x16x32_bf16 a[64:67], a[160:163], v[184:187], a[64:67]
  ds_read_b128 a[128:131], v3 offset:8192
  v_cvt_pk_bf16_f32 v179, v222, v223
  v_mfma_f32_16x16x32_bf16 a[68:71], a[160:163], v[188:191], a[68:71]
  v_exp_f32 v219, v139
  v_mfma_f32_16x16x32_bf16 a[72:75], a[164:167], v[184:187], a[72:75]
  ds_read_b128 a[132:135], v3 offset:9216
  buffer_load_dwordx4 v2, s[48:51], s27 offen offset:2048 sc1 lds
  v_add_f32 v227, v216, v217
  v_mfma_f32_16x16x32_bf16 a[76:79], a[164:167], v[188:191], a[76:79]
  v_exp_f32 v220, v140
  v_mfma_f32_16x16x32_bf16 a[80:83], a[168:171], v[184:187], a[80:83]
  ds_read_b128 a[136:139], v3 offset:10240
  v_cvt_pk_bf16_f32 v180, v216, v217
  v_mfma_f32_16x16x32_bf16 a[84:87], a[168:171], v[188:191], a[84:87]
  v_exp_f32 v221, v141
  v_mfma_f32_16x16x32_bf16 a[88:91], a[172:175], v[184:187], a[88:91]
  ds_read_b128 a[140:143], v3 offset:11264
  v_add_f32 v227, v227, v218
  v_mfma_f32_16x16x32_bf16 a[92:95], a[172:175], v[188:191], a[92:95]
  s_waitcnt lgkmcnt(4)
  v_exp_f32 v222, v142
  v_mfma_f32_16x16x32_bf16 a[96:99], a[176:179], v[184:187], a[96:99]
  ds_read_b128 a[144:147], v3 offset:12288
  buffer_load_dwordx4 v2, s[48:51], s27 offen offset:3072 sc1 lds
  v_add_f32 v227, v227, v219
  v_cvt_pk_bf16_f32 v181, v218, v219
  v_mfma_f32_16x16x32_bf16 a[100:103], a[176:179], v[188:191], a[100:103]
  s_add_u32 s27, s27, 16384
  v_exp_f32 v223, v143
  v_mfma_f32_16x16x32_bf16 a[104:107], a[180:183], v[184:187], a[104:107]
  s_add_u32 s25, s25, 32768
  ds_read_b128 a[148:151], v3 offset:13312
  v_add_f32 v227, v227, v220
  v_mfma_f32_16x16x32_bf16 a[108:111], a[180:183], v[188:191], a[108:111]
  s_and_b32 s25, s25, 0x1ffff
  v_add_f32 v227, v227, v221
  v_cvt_pk_bf16_f32 v182, v220, v221
  v_add_f32 v227, v227, v222
  v_mfma_f32_16x16x32_bf16 a[112:115], a[184:187], v[184:187], a[112:115]
  s_sub_u32 s29, s29, 1
  ds_read_b128 a[152:155], v3 offset:14336
  v_add_f32 v227, v227, v223
  v_max_f32 v5, v226, v227
  v_cmp_lt_f32 vcc, s81, v5
  v_mfma_f32_16x16x32_bf16 a[116:119], a[184:187], v[188:191], a[116:119]
  s_cmp_gt_u32 s29, 8
  v_exp_f32 v216, v144
  v_mfma_f32_16x16x32_bf16 a[120:123], a[188:191], v[184:187], a[120:123]
  s_waitcnt lgkmcnt(3)
  ds_read_b128 a[156:159], v3 offset:15360
  v_cvt_pk_bf16_f32 v183, v222, v223
  v_add_u32 v3, s66, v2
  v_mfma_f32_16x16x32_bf16 a[124:127], a[188:191], v[188:191], a[124:127]
  s_cbranch_vccnz fa_stub11
fa_back11:
  v_exp_f32 v217, v145
  v_add_f32 v230, v230, v226
  v_add_f32 v231, v231, v227
  s_cbranch_scc1 fa_SS
fa_chain:
fa_hb8:
  s_cmp_lt_u32 s12, 2
  s_cbranch_scc1 fa_hk8
  s_cmp_eq_u32 s29, 8
  s_cbranch_scc0 fa_disp
fa_SSW8:
  v_mfma_f32_16x16x32_bf16 v[128:131], a[128:131], v[64:67], v[200:203]
  s_waitcnt vmcnt(12)
  v_exp_f32 v218, v146
  v_mfma_f32_16x16x32_bf16 v[136:139], a[128:131], v[68:71], v[204:207]
  s_barrier
  v_exp_f32 v219, v147
  v_mfma_f32_16x16x32_bf16 v[132:135], a[132:135], v[64:67], v[200:203]
  ds_read_b128 a[160:163], v3 offset:16384
  ds_read_b128 a[164:167], v3 offset:17408
  v_add_f32 v226, v216, v217
  v_mfma_f32_16x16x32_bf16 v[140:143], a[132:135], v[68:71], v[204:207]
  s_mov_b32 m0, s24
  v_exp_f32 v220, v148
  v_mfma_f32_16x16x32_bf16 v[128:131], a[136:139], v[72:75], v[128:131]
  ds_read_b128 a[168:171], v3 offset:18432
  buffer_load_dwordx4 v2, s[44:47], s26 offen offset:0 sc1 lds
  v_cvt_pk_bf16_f32 v184, v216, v217
  v_mfma_f32_16x16x32_bf16 v[136:139], a[136:139], v[76:79], v[136:139]
  v_exp_f32 v221, v149
  v_mfma_f32_16x16x32_bf16 v[132:135], a[140:143], v[72:75], v[132:135]
  ds_read_b128 a[172:175], v3 offset:19456
  v_add_f32 v226, v226, v218
  v_add_f32 v226, v226, v219
  v_mfma_f32_16x16x32_bf16 v[140:143], a[140:143], v[76:79], v[140:143]
  s_waitcnt lgkmcnt(4)
  v_exp_f32 v222, v150
  v_mfma_f32_16x16x32_bf16 v[128:131], a[144:147], v[80:83], v[128:131]
  s_add_u32 s14, s13, 0
  ds_read_b128 a[176:179], v3 offset:20480
  buffer_load_dwordx4 a[0:3], v2, s[40:43], s14 offen offset:0 sc1
  v_cvt_pk_bf16_f32 v185, v218, v219
  v_mfma_f32_16x16x32_bf16 v[136:139], a[144:147], v[84:87], v[136:139]
  v_exp_f32 v223, v151
  v_mfma_f32_16x16x32_bf16 v[132:135], a[148:151], v[80:83], v[132:135]
  ds_read_b128 a[180:183], v3 offset:21504
  buffer_load_dwordx4 v2, s[44:47], s26 offen offset:1024 sc1 lds
  v_add_f32 v226, v226, v220
  v_mfma_f32_16x16x32_bf16 v[140:143], a[148:151], v[84:87], v[140:143]
  v_exp_f32 v216, v152
  v_mfma_f32_16x16x32_bf16 v[128:131], a[152:155], v[88:91], v[128:131]
  ds_read_b128 a[184:187], v3 offset:22528
  v_add_f32 v226, v226, v221
  v_cvt_pk_bf16_f32 v186, v220, v221
  v_mfma_f32_16x16x32_bf16 v[136:139], a[152:155], v[92:95], v[136:139]
  v_exp_f32 v217, v153
  v_mfma_f32_16x16x32_bf16 v[132:135], a[156:159], v[88:91], v[132:135]
  ds_read_b128 a[188:191], v3 offset:23552
  buffer_load_dwordx4 a[4:7], v2, s[40:43], s14 offen offset:1024 sc1
  v_add_f32 v226, v226, v222
  v_mfma_f32_16x16x32_bf16 v[140:143], a[156:159], v[92:95], v[140:143]
  s_waitcnt lgkmcnt(4)
  v_exp_f32 v218, v154
  v_mfma_f32_16x16x32_bf16 a[64:67], a[160:163], v[176:179], a[64:67]
  ds_read_b128 a[128:131], v3 offset:0
  v_add_f32 v226, v226, v223
  v_cvt_pk_bf16_f32 v187, v222, v223
  v_mfma_f32_16x16x32_bf16 a[68:71], a[160:163], v[180:183], a[68:71]
  v_exp_f32 v219, v155
  v_mfma_f32_16x16x32_bf16 a[72:75], a[164:167], v[176:179], a[72:75]
  ds_read_b128 a[132:135], v3 offset:1024
  buffer_load_dwordx4 v2, s[44:47], s26 offen offset:2048 sc1 lds
  v_add_f32 v227, v216, v217
  v_mfma_f32_16x16x32_bf16 a[76:79], a[164:167], v[180:183], a[76:79]
  v_exp_f32 v220, v156
  v_mfma_f32_16x16x32_bf16 a[80:83], a[168:171], v[176:179], a[80:83]
  ds_read_b128 a[136:139], v3 offset:2048
  v_cvt_pk_bf16_f32 v188, v216, v217
  v_mfma_f32_16x16x32_bf16 a[84:87], a[168:171], v[180:183], a[84:87]
  v_exp_f32 v221, v157
  v_mfma_f32_16x16x32_bf16 a[88:91], a[172:175], v[176:179], a[88:91]
  ds_read_b128 a[140:143], v3 offset:3072
  buffer_load_dwordx4 a[8:11], v2, s[40:43], s14 offen offset:2048 sc1
  v_add_f32 v227, v227, v218
  v_add_f32 v227, v227, v219
  v_mfma_f32_16x16x32_bf16 a[92:95], a[172:175], v[180:183], a[92:95]
  s_waitcnt lgkmcnt(4)
  v_exp_f32 v222, v158
  v_mfma_f32_16x16x32_bf16 a[96:99], a[176:179], v[176:179], a[96:99]
  ds_read_b128 a[144:147], v3 offset:4096
  buffer_load_dwordx4 v2, s[44:47], s26 offen offset:3072 sc1 lds
  v_cvt_pk_bf16_f32 v189, v218, v219
  v_mfma_f32_16x16x32_bf16 a[100:103], a[176:179], v[180:183], a[100:103]
  s_add_u32 s26, s26, 16384
  v_exp_f32 v223, v159
  v_mfma_f32_16x16x32_bf16 a[104:107], a[180:183], v[176:179], a[104:107]
  s_add_u32 s24, s24, 32768
  ds_read_b128 a[148:151], v3 offset:5120
  v_add_f32 v227, v227, v220
  v_mfma_f32_16x16x32_bf16 a[108:111], a[180:183], v[180:183], a[108:111]
  s_and_b32 s24, s24, 0x1ffff
  v_add_f32 v227, v227, v221
  v_cvt_pk_bf16_f32 v190, v220, v221
  v_add_f32 v227, v227, v222
  v_mfma_f32_16x16x32_bf16 a[112:115], a[184:187], v[176:179], a[112:115]
  ds_read_b128 a[152:155], v3 offset:6144
  v_add_f32 v227, v227, v223
  v_max_f32 v5, v226, v227
  v_cmp_lt_f32 vcc, s81, v5
  v_mfma_f32_16x16x32_bf16 a[116:119], a[184:187], v[180:183], a[116:119]
  v_exp_f32 v216, v128
  v_mfma_f32_16x16x32_bf16 a[120:123], a[188:191], v[176:179], a[120:123]
  s_waitcnt lgkmcnt(3)
  ds_read_b128 a[156:159], v3 offset:7168
  v_cvt_pk_bf16_f32 v191, v222, v223
  v_mfma_f32_16x16x32_bf16 a[124:127], a[188:191], v[180:183], a[124:127]
  s_cbranch_vccnz fa_stub12
fa_back12:
  v_exp_f32 v217, v129
  v_add_f32 v230, v230, v226
  v_add_f32 v231, v231, v227
  v_mfma_f32_16x16x32_bf16 v[144:147], a[128:131], v[64:67], v[200:203]
  ds_read_b128 a[160:163], v3 offset:24576
  v_add_f32 v226, v216, v217
  v_mfma_f32_16x16x32_bf16 v[152:155], a[128:131], v[68:71], v[204:207]
  v_exp_f32 v218, v130
  v_mfma_f32_16x16x32_bf16 v[148:151], a[132:135], v[64:67], v[200:203]
  s_add_u32 s66, s66, 32768
  ds_read_b128 a[164:167], v3 offset:25600
  v_cvt_pk_bf16_f32 v176, v216, v217
  v_mfma_f32_16x16x32_bf16 v[156:159], a[132:135], v[68:71], v[204:207]
  s_mov_b32 m0, s25
  v_exp_f32 v219, v131
  v_mfma_f32_16x16x32_bf16 v[144:147], a[136:139], v[72:75], v[144:147]
  s_and_b32 s66, s66, 0x1ffff
  ds_read_b128 a[168:171], v3 offset:26624
  buffer_load_dwordx4 v2, s[48:51], s27 offen offset:0 sc1 lds
  v_add_f32 v226, v226, v218
  v_add_f32 v226, v226, v219
  v_mfma_f32_16x16x32_bf16 v[152:155], a[136:139], v[76:79], v[152:155]
  v_exp_f32 v220, v132
  v_mfma_f32_16x16x32_bf16 v[148:151], a[140:143], v[72:75], v[148:151]
  ds_read_b128 a[172:175], v3 offset:27648
  v_cvt_pk_bf16_f32 v177, v218, v219
  v_mfma_f32_16x16x32_bf16 v[156:159], a[140:143], v[76:79], v[156:159]
  s_waitcnt lgkmcnt(4)
  v_exp_f32 v221, v133
  v_mfma_f32_16x16x32_bf16 v[144:147], a[144:147], v[80:83], v[144:147]
  s_add_u32 s14, s13, 0
  ds_read_b128 a[176:179], v3 offset:28672
  buffer_load_dwordx4 a[12:15], v2, s[40:43], s14 offen offset:3072 sc1
  v_add_f32 v226, v226, v220
  v_mfma_f32_16x16x32_bf16 v[152:155], a[144:147], v[84:87], v[152:155]
  v_exp_f32 v222, v134
  v_mfma_f32_16x16x32_bf16 v[148:151], a[148:151], v[80:83], v[148:151]
  ds_read_b128 a[180:183], v3 offset:29696
  buffer_load_dwordx4 v2, s[48:51], s27 offen offset:1024 sc1 lds
  v_add_f32 v226, v226, v221
  v_cvt_pk_bf16_f32 v178, v220, v221
  v_mfma_f32_16x16x32_bf16 v[156:159], a[148:151], v[84:87], v[156:159]
  v_exp_f32 v223, v135
  v_mfma_f32_16x16x32_bf16 v[144:147], a[152:155], v[88:91], v[144:147]
  ds_read_b128 a[184:187], v3 offset:30720
  v_add_f32 v226, v226, v222
  v_mfma_f32_16x16x32_bf16 v[152:155], a[152:155], v[92:95], v[152:155]
  v_exp_f32 v216, v136
  v_mfma_f32_16x16x32_bf16 v[148:151], a[156:159], v[88:91], v[148:151]
  s_add_u32 s14, s13, 4096
  ds_read_b128 a[188:191], v3 offset:31744
  buffer_load_dwordx4 a[16:19], v2, s[40:43], s14 offen offset:0 sc1
  v_add_f32 v226, v226, v223
  v_exp_f32 v217, v137
  v_mfma_f32_16x16x32_bf16 v[156:159], a[156:159], v[92:95], v[156:159]
  s_waitcnt lgkmcnt(4)
  v_exp_f32 v218, v138
  v_mfma_f32_16x16x32_bf16 a[64:67], a[160:163], v[184:187], a[64:67]
  ds_read_b128 a[128:131], v3 offset:8192
  v_cvt_pk_bf16_f32 v179, v222, v223
  v_mfma_f32_16x16x32_bf16 a[68:71], a[160:163], v[188:191], a[68:71]
  v_exp_f32 v219, v139
  v_mfma_f32_16x16x32_bf16 a[72:75], a[164:167], v[184:187], a[72:75]
  ds_read_b128 a[132:135], v3 offset:9216
  buffer_load_dwordx4 v2, s[48:51], s27 offen offset:2048 sc1 lds
  v_add_f32 v227, v216, v217
  v_mfma_f32_16x16x32_bf16 a[76:79], a[164:167], v[188:191], a[76:79]
  v_exp_f32 v220, v140
  v_mfma_f32_16x16x32_bf16 a[80:83], a[168:171], v[184:187], a[80:83]
  ds_read_b128 a[136:139], v3 offset:10240
  v_cvt_pk_bf16_f32 v180, v216, v217
  v_mfma_f32_16x16x32_bf16 a[84:87], a[168:171], v[188:191], a[84:87]
  v_exp_f32 v221, v141
  v_mfma_f32_16x16x32_bf16 a[88:91], a[172:175], v[184:187], a[88:91]
  ds_read_b128 a[140:143], v3 offset:11264
  buffer_load_dwordx4 a[20:23], v2, s[40:43], s14 offen offset:1024 sc1
  v_add_f32 v227, v227, v218
  v_mfma_f32_16x16x32_bf16 a[92:95], a[172:175], v[188:191], a[92:95]
  s_waitcnt lgkmcnt(4)
  v_exp_f32 v222, v142
  v_mfma_f32_16x16x32_bf16 a[96:99], a[176:179], v[184:187], a[96:99]
  ds_read_b128 a[144:147], v3 offset:12288
  buffer_load_dwordx4 v2, s[48:51], s27 offen offset:3072 sc1 lds
  v_add_f32 v227, v227, v219
  v_cvt_pk_bf16_f32 v181, v218, v219
  v_mfma_f32_16x16x32_bf16 a[100:103], a[176:179], v[188:191], a[100:103]
  s_add_u32 s27, s27, 16384
  v_exp_f32 v223, v143
  v_mfma_f32_16x16x32_bf16 a[104:107], a[180:183], v[184:187], a[104:107]
  s_add_u32 s25, s25, 32768
  ds_read_b128 a[148:151], v3 offset:13312
  v_add_f32 v227, v227, v220
  v_mfma_f32_16x16x32_bf16 a[108:111], a[180:183], v[188:191], a[108:111]
  s_and_b32 s25, s25, 0x1ffff
  v_add_f32 v227, v227, v221
  v_cvt_pk_bf16_f32 v182, v220, v221
  v_add_f32 v227, v227, v222
  v_mfma_f32_16x16x32_bf16 a[112:115], a[184:187], v[184:187], a[112:115]
  ds_read_b128 a[152:155], v3 offset:14336
  v_add_f32 v227, v227, v223
  v_max_f32 v5, v226, v227
  v_cmp_lt_f32 vcc, s81, v5
  v_mfma_f32_16x16x32_bf16 a[116:119], a[184:187], v[188:191], a[116:119]
  v_exp_f32 v216, v144
  v_mfma_f32_16x16x32_bf16 a[120:123], a[188:191], v[184:187], a[120:123]
  s_waitcnt lgkmcnt(3)
  ds_read_b128 a[156:159], v3 offset:15360
  v_cvt_pk_bf16_f32 v183, v222, v223
  v_add_u32 v3, s66, v2
  v_mfma_f32_16x16x32_bf16 a[124:127], a[188:191], v[188:191], a[124:127]
  s_cbranch_vccnz fa_stub13
fa_back13:
  v_exp_f32 v217, v145
  v_add_f32 v230, v230, v226
  v_add_f32 v231, v231, v227
fa_SSW7:
  v_mfma_f32_16x16x32_bf16 v[128:131], a[128:131], v[64:67], v[200:203]
  s_waitcnt vmcnt(12)
  v_exp_f32 v218, v146
  v_mfma_f32_16x16x32_bf16 v[136:139], a[128:131], v[68:71], v[204:207]
  s_barrier
  v_exp_f32 v219, v147
  v_mfma_f32_16x16x32_bf16 v[132:135], a[132:135], v[64:67], v[200:203]
  ds_read_b128 a[160:163], v3 offset:16384
  ds_read_b128 a[164:167], v3 offset:17408
  v_add_f32 v226, v216, v217
  v_mfma_f32_16x16x32_bf16 v[140:143], a[132:135], v[68:71], v[204:207]
  s_mov_b32 m0, s24
  v_exp_f32 v220, v148
  v_mfma_f32_16x16x32_bf16 v[128:131], a[136:139], v[72:75], v[128:131]
  ds_read_b128 a[168:171], v3 offset:18432
  buffer_load_dwordx4 v2, s[44:47], s26 offen offset:0 sc1 lds
  v_cvt_pk_bf16_f32 v184, v216, v217
  v_mfma_f32_16x16x32_bf16 v[136:139], a[136:139], v[76:79], v[136:139]
  v_exp_f32 v221, v149
  v_mfma_f32_16x16x32_bf16 v[132:135], a[140:143], v[72:75], v[132:135]
  ds_read_b128 a[172:175], v3 offset:19456
  v_add_f32 v226, v226, v218
  v_add_f32 v226, v226, v219
  v_mfma_f32_16x16x32_bf16 v[140:143], a[140:143], v[76:79], v[140:143]
  s_waitcnt lgkmcnt(4)
  v_exp_f32 v222, v150
  v_mfma_f32_16x16x32_bf16 v[128:131], a[144:147], v[80:83], v[128:131]
  s_add_u32 s14, s13, 4096
  ds_read_b128 a[176:179], v3 offset:20480
  buffer_load_dwordx4 a[24:27], v2, s[40:43], s14 offen offset:2048 sc1
  v_cvt_pk_bf16_f32 v185, v218, v219
  v_mfma_f32_16x16x32_bf16 v[136:139], a[144:147], v[84:87], v[136:139]
  v_exp_f32 v223, v151
  v_mfma_f32_16x16x32_bf16 v[132:135], a[148:151], v[80:83], v[132:135]
  ds_read_b128 a[180:183], v3 offset:21504
  buffer_load_dwordx4 v2, s[44:47], s26 offen offset:1024 sc1 lds
  v_add_f32 v226, v226, v220
  v_mfma_f32_16x16x32_bf16 v[140:143], a[148:151], v[84:87], v[140:143]
  v_exp_f32 v216, v152
  v_mfma_f32_16x16x32_bf16 v[128:131], a[152:155], v[88:91], v[128:131]
  ds_read_b128 a[184:187], v3 offset:22528
  v_add_f32 v226, v226, v221
  v_cvt_pk_bf16_f32 v186, v220, v221
  v_mfma_f32_16x16x32_bf16 v[136:139], a[152:155], v[92:95], v[136:139]
  v_exp_f32 v217, v153
  v_mfma_f32_16x16x32_bf16 v[132:135], a[156:159], v[88:91], v[132:135]
  ds_read_b128 a[188:191], v3 offset:23552
  buffer_load_dwordx4 a[28:31], v2, s[40:43], s14 offen offset:3072 sc1
  v_add_f32 v226, v226, v222
  v_mfma_f32_16x16x32_bf16 v[140:143], a[156:159], v[92:95], v[140:143]
  s_waitcnt lgkmcnt(4)
  v_exp_f32 v218, v154
  v_mfma_f32_16x16x32_bf16 a[64:67], a[160:163], v[176:179], a[64:67]
  ds_read_b128 a[128:131], v3 offset:0
  v_add_f32 v226, v226, v223
  v_cvt_pk_bf16_f32 v187, v222, v223
  v_mfma_f32_16x16x32_bf16 a[68:71], a[160:163], v[180:183], a[68:71]
  v_exp_f32 v219, v155
  v_mfma_f32_16x16x32_bf16 a[72:75], a[164:167], v[176:179], a[72:75]
  ds_read_b128 a[132:135], v3 offset:1024
  buffer_load_dwordx4 v2, s[44:47], s26 offen offset:2048 sc1 lds
  v_add_f32 v227, v216, v217
  v_mfma_f32_16x16x32_bf16 a[76:79], a[164:167], v[180:183], a[76:79]
  v_exp_f32 v220, v156
  v_mfma_f32_16x16x32_bf16 a[80:83], a[168:171], v[176:179], a[80:83]
  ds_read_b128 a[136:139], v3 offset:2048
  v_cvt_pk_bf16_f32 v188, v216, v217
  v_mfma_f32_16x16x32_bf16 a[84:87], a[168:171], v[180:183], a[84:87]
  v_exp_f32 v221, v157
  v_mfma_f32_16x16x32_bf16 a[88:91], a[172:175], v[176:179], a[88:91]
  s_add_u32 s14, s13, 8192
  ds_read_b128 a[140:143], v3 offset:3072
  buffer_load_dwordx4 a[32:35], v2, s[40:43], s14 offen offset:0 sc1
  v_add_f32 v227, v227, v218
  v_add_f32 v227, v227, v219
  v_mfma_f32_16x16x32_bf16 a[92:95], a[172:175], v[180:183], a[92:95]
  s_waitcnt lgkmcnt(4)
  v_exp_f32 v222, v158
  v_mfma_f32_16x16x32_bf16 a[96:99], a[176:179], v[176:179], a[96:99]
  ds_read_b128 a[144:147], v3 offset:4096
  buffer_load_dwordx4 v2, s[44:47], s26 offen offset:3072 sc1 lds
  v_cvt_pk_bf16_f32 v189, v218, v219
  v_mfma_f32_16x16x32_bf16 a[100:103], a[176:179], v[180:183], a[100:103]
  s_add_u32 s26, s26, 16384
  v_exp_f32 v223, v159
  v_mfma_f32_16x16x32_bf16 a[104:107], a[180:183], v[176:179], a[104:107]
  s_add_u32 s24, s24, 32768
  ds_read_b128 a[148:151], v3 offset:5120
  v_add_f32 v227, v227, v220
  v_mfma_f32_16x16x32_bf16 a[108:111], a[180:183], v[180:183], a[108:111]
  s_and_b32 s24, s24, 0x1ffff
  v_add_f32 v227, v227, v221
  v_cvt_pk_bf16_f32 v190, v220, v221
  v_add_f32 v227, v227, v222
  v_mfma_f32_16x16x32_bf16 a[112:115], a[184:187], v[176:179], a[112:115]
  ds_read_b128 a[152:155], v3 offset:6144
  v_add_f32 v227, v227, v223
  v_max_f32 v5, v226, v227
  v_cmp_lt_f32 vcc, s81, v5
  v_mfma_f32_16x16x32_bf16 a[116:119], a[184:187], v[180:183], a[116:119]
  v_exp_f32 v216, v128
  v_mfma_f32_16x16x32_bf16 a[120:123], a[188:191], v[176:179], a[120:123]
  s_waitcnt lgkmcnt(3)
  ds_read_b128 a[156:159], v3 offset:7168
  v_cvt_pk_bf16_f32 v191, v222, v223
  v_mfma_f32_16x16x32_bf16 a[124:127], a[188:191], v[180:183], a[124:127]
  s_cbranch_vccnz fa_stub14
fa_back14:
  v_exp_f32 v217, v129
  v_add_f32 v230, v230, v226
  v_add_f32 v231, v231, v227
  v_mfma_f32_16x16x32_bf16 v[144:147], a[128:131], v[64:67], v[200:203]
  ds_read_b128 a[160:163], v3 offset:24576
  v_add_f32 v226, v216, v217
  v_mfma_f32_16x16x32_bf16 v[152:155], a[128:131], v[68:71], v[204:207]
  v_exp_f32 v218, v130
  v_mfma_f32_16x16x32_bf16 v[148:151], a[132:135], v[64:67], v[200:203]
  s_add_u32 s66, s66, 32768
  ds_read_b128 a[164:167], v3 offset:25600
  v_cvt_pk_bf16_f32 v176, v216, v217
  v_mfma_f32_16x16x32_bf16 v[156:159], a[132:135], v[68:71], v[204:207]
  s_mov_b32 m0, s25
  v_exp_f32 v219, v131
  v_mfma_f32_16x16x32_bf16 v[144:147], a[136:139], v[72:75], v[144:147]
  s_and_b32 s66, s66, 0x1ffff
  ds_read_b128 a[168:171], v3 offset:26624
  buffer_load_dwordx4 v2, s[48:51], s27 offen offset:0 sc1 lds
  v_add_f32 v226, v226, v218
  v_add_f32 v226, v226, v219
  v_mfma_f32_16x16x32_bf16 v[152:155], a[136:139], v[76:79], v[152:155]
  v_exp_f32 v220, v132
  v_mfma_f32_16x16x32_bf16 v[148:151], a[140:143], v[72:75], v[148:151]
  ds_read_b128 a[172:175], v3 offset:27648
  v_cvt_pk_bf16_f32 v177, v218, v219
  v_mfma_f32_16x16x32_bf16 v[156:159], a[140:143], v[76:79], v[156:159]
  s_waitcnt lgkmcnt(4)
  v_exp_f32 v221, v133
  v_mfma_f32_16x16x32_bf16 v[144:147], a[144:147], v[80:83], v[144:147]
  s_add_u32 s14, s13, 8192
  ds_read_b128 a[176:179], v3 offset:28672
  buffer_load_dwordx4 a[36:39], v2, s[40:43], s14 offen offset:1024 sc1
  v_add_f32 v226, v226, v220
  v_mfma_f32_16x16x32_bf16 v[152:155], a[144:147], v[84:87], v[152:155]
  v_exp_f32 v222, v134
  v_mfma_f32_16x16x32_bf16 v[148:151], a[148:151], v[80:83], v[148:151]
  ds_read_b128 a[180:183], v3 offset:29696
  buffer_load_dwordx4 v2, s[48:51], s27 offen offset:1024 sc1 lds
  v_add_f32 v226, v226, v221
  v_cvt_pk_bf16_f32 v178, v220, v221
  v_mfma_f32_16x16x32_bf16 v[156:159], a[148:151], v[84:87], v[156:159]
  v_exp_f32 v223, v135
  v_mfma_f32_16x16x32_bf16 v[144:147], a[152:155], v[88:91], v[144:147]
  ds_read_b128 a[184:187], v3 offset:30720
  v_add_f32 v226, v226, v222
  v_mfma_f32_16x16x32_bf16 v[152:155], a[152:155], v[92:95], v[152:155]
  v_exp_f32 v216, v136
  v_mfma_f32_16x16x32_bf16 v[148:151], a[156:159], v[88:91], v[148:151]
  ds_read_b128 a[188:191], v3 offset:31744
  buffer_load_dwordx4 a[40:43], v2, s[40:43], s14 offen offset:2048 sc1
  v_add_f32 v226, v226, v223
  v_exp_f32 v217, v137
  v_mfma_f32_16x16x32_bf16 v[156:159], a[156:159], v[92:95], v[156:159]
  s_waitcnt lgkmcnt(4)
  v_exp_f32 v218, v138
  v_mfma_f32_16x16x32_bf16 a[64:67], a[160:163], v[184:187], a[64:67]
  ds_read_b128 a[128:131], v3 offset:8192
  v_cvt_pk_bf16_f32 v179, v222, v223
  v_mfma_f32_16x16x32_bf16 a[68:71], a[160:163], v[188:191], a[68:71]
  v_exp_f32 v219, v139
  v_mfma_f32_16x16x32_bf16 a[72:75], a[164:167], v[184:187], a[72:75]
  ds_read_b128 a[132:135], v3 offset:9216
  buffer_load_dwordx4 v2, s[48:51], s27 offen offset:2048 sc1 lds
  v_add_f32 v227, v216, v217
  v_mfma_f32_16x16x32_bf16 a[76:79], a[164:167], v[188:191], a[76:79]
  v_exp_f32 v220, v140
  v_mfma_f32_16x16x32_bf16 a[80:83], a[168:171], v[184:187], a[80:83]
  ds_read_b128 a[136:139], v3 offset:10240
  v_cvt_pk_bf16_f32 v180, v216, v217
  v_mfma_f32_16x16x32_bf16 a[84:87], a[168:171], v[188:191], a[84:87]
  v_exp_f32 v221, v141
  v_mfma_f32_16x16x32_bf16 a[88:91], a[172:175], v[184:187], a[88:91]
  ds_read_b128 a[140:143], v3 offset:11264
  buffer_load_dwordx4 a[44:47], v2, s[40:43], s14 offen offset:3072 sc1
  v_add_f32 v227, v227, v218
  v_mfma_f32_16x16x32_bf16 a[92:95], a[172:175], v[188:191], a[92:95]
  s_waitcnt lgkmcnt(4)
  v_exp_f32 v222, v142
  v_mfma_f32_16x16x32_bf16 a[96:99], a[176:179], v[184:187], a[96:99]
  ds_read_b128 a[144:147], v3 offset:12288
  buffer_load_dwordx4 v2, s[48:51], s27 offen offset:3072 sc1 lds
  v_add_f32 v227, v227, v219
  v_cvt_pk_bf16_f32 v181, v218, v219
  v_mfma_f32_16x16x32_bf16 a[100:103], a[176:179], v[188:191], a[100:103]
  s_add_u32 s27, s27, 16384
  v_exp_f32 v223, v143
  v_mfma_f32_16x16x32_bf16 a[104:107], a[180:183], v[184:187], a[104:107]
  s_add_u32 s25, s25, 32768
  ds_read_b128 a[148:151], v3 offset:13312
  v_add_f32 v227, v227, v220
  v_mfma_f32_16x16x32_bf16 a[108:111], a[180:183], v[188:191], a[108:111]
  s_and_b32 s25, s25, 0x1ffff
  v_add_f32 v227, v227, v221
  v_cvt_pk_bf16_f32 v182, v220, v221
  v_add_f32 v227, v227, v222
  v_mfma_f32_16x16x32_bf16 a[112:115], a[184:187], v[184:187], a[112:115]
  ds_read_b128 a[152:155], v3 offset:14336
  v_add_f32 v227, v227, v223
  v_max_f32 v5, v226, v227
  v_cmp_lt_f32 vcc, s81, v5
  v_mfma_f32_16x16x32_bf16 a[116:119], a[184:187], v[188:191], a[116:119]
  v_exp_f32 v216, v144
  v_mfma_f32_16x16x32_bf16 a[120:123], a[188:191], v[184:187], a[120:123]
  s_waitcnt lgkmcnt(3)
  ds_read_b128 a[156:159], v3 offset:15360
  v_cvt_pk_bf16_f32 v183, v222, v223
  v_add_u32 v3, s66, v2
  v_mfma_f32_16x16x32_bf16 a[124:127], a[188:191], v[188:191], a[124:127]
  s_cbranch_vccnz fa_stub15
fa_back15:
  v_exp_f32 v217, v145
  v_add_f32 v230, v230, v226
  v_add_f32 v231, v231, v227
fa_SSW6:
  v_mfma_f32_16x16x32_bf16 v[128:131], a[128:131], v[64:67], v[200:203]
  s_waitcnt vmcnt(12)
  v_exp_f32 v218, v146
  v_mfma_f32_16x16x32_bf16 v[136:139], a[128:131], v[68:71], v[204:207]
  s_barrier
  v_exp_f32 v219, v147
  v_mfma_f32_16x16x32_bf16 v[132:135], a[132:135], v[64:67], v[200:203]
  ds_read_b128 a[160:163], v3 offset:16384
  ds_read_b128 a[164:167], v3 offset:17408
  v_add_f32 v226, v216, v217
  v_mfma_f32_16x16x32_bf16 v[140:143], a[132:135], v[68:71], v[204:207]
  s_mov_b32 m0, s24
  v_exp_f32 v220, v148
  v_mfma_f32_16x16x32_bf16 v[128:131], a[136:139], v[72:75], v[128:131]
  ds_read_b128 a[168:171], v3 offset:18432
  buffer_load_dwordx4 v2, s[44:47], s26 offen offset:0 sc1 lds
  v_cvt_pk_bf16_f32 v184, v216, v217
  v_mfma_f32_16x16x32_bf16 v[136:139], a[136:139], v[76:79], v[136:139]
  v_exp_f32 v221, v149
  v_mfma_f32_16x16x32_bf16 v[132:135], a[140:143], v[72:75], v[132:135]
  ds_read_b128 a[172:175], v3 offset:19456
  v_add_f32 v226, v226, v218
  v_add_f32 v226, v226, v219
  v_mfma_f32_16x16x32_bf16 v[140:143], a[140:143], v[76:79], v[140:143]
  s_waitcnt lgkmcnt(4)
  v_exp_f32 v222, v150
  v_mfma_f32_16x16x32_bf16 v[128:131], a[144:147], v[80:83], v[128:131]
  s_add_u32 s14, s13, 12288
  ds_read_b128 a[176:179], v3 offset:20480
  buffer_load_dwordx4 a[48:51], v2, s[40:43], s14 offen offset:0 sc1
  v_cvt_pk_bf16_f32 v185, v218, v219
  v_mfma_f32_16x16x32_bf16 v[136:139], a[144:147], v[84:87], v[136:139]
  v_exp_f32 v223, v151
  v_mfma_f32_16x16x32_bf16 v[132:135], a[148:151], v[80:83], v[132:135]
  ds_read_b128 a[180:183], v3 offset:21504
  buffer_load_dwordx4 v2, s[44:47], s26 offen offset:1024 sc1 lds
  v_add_f32 v226, v226, v220
  v_mfma_f32_16x16x32_bf16 v[140:143], a[148:151], v[84:87], v[140:143]
  v_exp_f32 v216, v152
  v_mfma_f32_16x16x32_bf16 v[128:131], a[152:155], v[88:91], v[128:131]
  ds_read_b128 a[184:187], v3 offset:22528
  v_add_f32 v226, v226, v221
  v_cvt_pk_bf16_f32 v186, v220, v221
  v_mfma_f32_16x16x32_bf16 v[136:139], a[152:155], v[92:95], v[136:139]
  v_exp_f32 v217, v153
  v_mfma_f32_16x16x32_bf16 v[132:135], a[156:159], v[88:91], v[132:135]
  ds_read_b128 a[188:191], v3 offset:23552
  buffer_load_dwordx4 a[52:55], v2, s[40:43], s14 offen offset:1024 sc1
  v_add_f32 v226, v226, v222
  v_mfma_f32_16x16x32_bf16 v[140:143], a[156:159], v[92:95], v[140:143]
  s_waitcnt lgkmcnt(4)
  v_exp_f32 v218, v154
  v_mfma_f32_16x16x32_bf16 a[64:67], a[160:163], v[176:179], a[64:67]
  ds_read_b128 a[128:131], v3 offset:0
  v_add_f32 v226, v226, v223
  v_cvt_pk_bf16_f32 v187, v222, v223
  v_mfma_f32_16x16x32_bf16 a[68:71], a[160:163], v[180:183], a[68:71]
  v_exp_f32 v219, v155
  v_mfma_f32_16x16x32_bf16 a[72:75], a[164:167], v[176:179], a[72:75]
  ds_read_b128 a[132:135], v3 offset:1024
  buffer_load_dwordx4 v2, s[44:47], s26 offen offset:2048 sc1 lds
  v_add_f32 v227, v216, v217
  v_mfma_f32_16x16x32_bf16 a[76:79], a[164:167], v[180:183], a[76:79]
  v_exp_f32 v220, v156
  v_mfma_f32_16x16x32_bf16 a[80:83], a[168:171], v[176:179], a[80:83]
  ds_read_b128 a[136:139], v3 offset:2048
  v_cvt_pk_bf16_f32 v188, v216, v217
  v_mfma_f32_16x16x32_bf16 a[84:87], a[168:171], v[180:183], a[84:87]
  v_exp_f32 v221, v157
  v_mfma_f32_16x16x32_bf16 a[88:91], a[172:175], v[176:179], a[88:91]
  ds_read_b128 a[140:143], v3 offset:3072
  buffer_load_dwordx4 a[56:59], v2, s[40:43], s14 offen offset:2048 sc1
  v_add_f32 v227, v227, v218
  v_add_f32 v227, v227, v219
  v_mfma_f32_16x16x32_bf16 a[92:95], a[172:175], v[180:183], a[92:95]
  s_waitcnt lgkmcnt(4)
  v_exp_f32 v222, v158
  v_mfma_f32_16x16x32_bf16 a[96:99], a[176:179], v[176:179], a[96:99]
  ds_read_b128 a[144:147], v3 offset:4096
  buffer_load_dwordx4 v2, s[44:47], s26 offen offset:3072 sc1 lds
  v_cvt_pk_bf16_f32 v189, v218, v219
  v_mfma_f32_16x16x32_bf16 a[100:103], a[176:179], v[180:183], a[100:103]
  s_add_u32 s26, s26, 16384
  v_exp_f32 v223, v159
  v_mfma_f32_16x16x32_bf16 a[104:107], a[180:183], v[176:179], a[104:107]
  s_add_u32 s24, s24, 32768
  ds_read_b128 a[148:151], v3 offset:5120
  v_add_f32 v227, v227, v220
  v_mfma_f32_16x16x32_bf16 a[108:111], a[180:183], v[180:183], a[108:111]
  s_and_b32 s24, s24, 0x1ffff
  v_add_f32 v227, v227, v221
  v_cvt_pk_bf16_f32 v190, v220, v221
  v_add_f32 v227, v227, v222
  v_mfma_f32_16x16x32_bf16 a[112:115], a[184:187], v[176:179], a[112:115]
  ds_read_b128 a[152:155], v3 offset:6144
  v_add_f32 v227, v227, v223
  v_max_f32 v5, v226, v227
  v_cmp_lt_f32 vcc, s81, v5
  v_mfma_f32_16x16x32_bf16 a[116:119], a[184:187], v[180:183], a[116:119]
  v_exp_f32 v216, v128
  v_mfma_f32_16x16x32_bf16 a[120:123], a[188:191], v[176:179], a[120:123]
  s_waitcnt lgkmcnt(3)
  ds_read_b128 a[156:159], v3 offset:7168
  v_cvt_pk_bf16_f32 v191, v222, v223
  v_mfma_f32_16x16x32_bf16 a[124:127], a[188:191], v[180:183], a[124:127]
  s_cbranch_vccnz fa_stub16
fa_back16:
  v_exp_f32 v217, v129
  v_add_f32 v230, v230, v226
  v_add_f32 v231, v231, v227
  v_mfma_f32_16x16x32_bf16 v[144:147], a[128:131], v[64:67], v[200:203]
  ds_read_b128 a[160:163], v3 offset:24576
  v_add_f32 v226, v216, v217
  v_mfma_f32_16x16x32_bf16 v[152:155], a[128:131], v[68:71], v[204:207]
  v_exp_f32 v218, v130
  v_mfma_f32_16x16x32_bf16 v[148:151], a[132:135], v[64:67], v[200:203]
  s_add_u32 s66, s66, 32768
  ds_read_b128 a[164:167], v3 offset:25600
  v_cvt_pk_bf16_f32 v176, v216, v217
  v_mfma_f32_16x16x32_bf16 v[156:159], a[132:135], v[68:71], v[204:207]
  s_mov_b32 m0, s25
  v_exp_f32 v219, v131
  v_mfma_f32_16x16x32_bf16 v[144:147], a[136:139], v[72:75], v[144:147]
  s_and_b32 s66, s66, 0x1ffff
  ds_read_b128 a[168:171], v3 offset:26624
  buffer_load_dwordx4 v2, s[48:51], s27 offen offset:0 sc1 lds
  v_add_f32 v226, v226, v218
  v_add_f32 v226, v226, v219
  v_mfma_f32_16x16x32_bf16 v[152:155], a[136:139], v[76:79], v[152:155]
  v_exp_f32 v220, v132
  v_mfma_f32_16x16x32_bf16 v[148:151], a[140:143], v[72:75], v[148:151]
  ds_read_b128 a[172:175], v3 offset:27648
  v_cvt_pk_bf16_f32 v177, v218, v219
  v_mfma_f32_16x16x32_bf16 v[156:159], a[140:143], v[76:79], v[156:159]
  s_waitcnt lgkmcnt(4)
  v_exp_f32 v221, v133
  v_mfma_f32_16x16x32_bf16 v[144:147], a[144:147], v[80:83], v[144:147]
  s_add_u32 s14, s13, 12288
  ds_read_b128 a[176:179], v3 offset:28672
  buffer_load_dwordx4 a[60:63], v2, s[40:43], s14 offen offset:3072 sc1
  v_add_f32 v226, v226, v220
  v_mfma_f32_16x16x32_bf16 v[152:155], a[144:147], v[84:87], v[152:155]
  v_exp_f32 v222, v134
  v_mfma_f32_16x16x32_bf16 v[148:151], a[148:151], v[80:83], v[148:151]
  ds_read_b128 a[180:183], v3 offset:29696
  buffer_load_dwordx4 v2, s[48:51], s27 offen offset:1024 sc1 lds
  v_add_f32 v226, v226, v221
  v_cvt_pk_bf16_f32 v178, v220, v221
  v_mfma_f32_16x16x32_bf16 v[156:159], a[148:151], v[84:87], v[156:159]
  v_exp_f32 v223, v135
  v_mfma_f32_16x16x32_bf16 v[144:147], a[152:155], v[88:91], v[144:147]
  ds_read_b128 a[184:187], v3 offset:30720
  v_add_f32 v226, v226, v222
  v_mfma_f32_16x16x32_bf16 v[152:155], a[152:155], v[92:95], v[152:155]
  v_exp_f32 v216, v136
  v_mfma_f32_16x16x32_bf16 v[148:151], a[156:159], v[88:91], v[148:151]
  s_add_u32 s14, s13, 16384
  ds_read_b128 a[188:191], v3 offset:31744
  buffer_load_dwordx4 a[192:195], v2, s[40:43], s14 offen offset:0 sc1
  v_add_f32 v226, v226, v223
  v_exp_f32 v217, v137
  v_mfma_f32_16x16x32_bf16 v[156:159], a[156:159], v[92:95], v[156:159]
  s_waitcnt lgkmcnt(4)
  v_exp_f32 v218, v138
  v_mfma_f32_16x16x32_bf16 a[64:67], a[160:163], v[184:187], a[64:67]
  ds_read_b128 a[128:131], v3 offset:8192
  v_cvt_pk_bf16_f32 v179, v222, v223
  v_mfma_f32_16x16x32_bf16 a[68:71], a[160:163], v[188:191], a[68:71]
  v_exp_f32 v219, v139
  v_mfma_f32_16x16x32_bf16 a[72:75], a[164:167], v[184:187], a[72:75]
  ds_read_b128 a[132:135], v3 offset:9216
  buffer_load_dwordx4 v2, s[48:51], s27 offen offset:2048 sc1 lds
  v_add_f32 v227, v216, v217
  v_mfma_f32_16x16x32_bf16 a[76:79], a[164:167], v[188:191], a[76:79]
  v_exp_f32 v220, v140
  v_mfma_f32_16x16x32_bf16 a[80:83], a[168:171], v[184:187], a[80:83]
  ds_read_b128 a[136:139], v3 offset:10240
  v_cvt_pk_bf16_f32 v180, v216, v217
  v_mfma_f32_16x16x32_bf16 a[84:87], a[168:171], v[188:191], a[84:87]
  v_exp_f32 v221, v141
  v_mfma_f32_16x16x32_bf16 a[88:91], a[172:175], v[184:187], a[88:91]
  ds_read_b128 a[140:143], v3 offset:11264
  buffer_load_dwordx4 a[196:199], v2, s[40:43], s14 offen offset:1024 sc1
  v_add_f32 v227, v227, v218
  v_mfma_f32_16x16x32_bf16 a[92:95], a[172:175], v[188:191], a[92:95]
  s_waitcnt lgkmcnt(4)
  v_exp_f32 v222, v142
  v_mfma_f32_16x16x32_bf16 a[96:99], a[176:179], v[184:187], a[96:99]
  ds_read_b128 a[144:147], v3 offset:12288
  buffer_load_dwordx4 v2, s[48:51], s27 offen offset:3072 sc1 lds
  v_add_f32 v227, v227, v219
  v_cvt_pk_bf16_f32 v181, v218, v219
  v_mfma_f32_16x16x32_bf16 a[100:103], a[176:179], v[188:191], a[100:103]
  s_add_u32 s27, s27, 16384
  v_exp_f32 v223, v143
  v_mfma_f32_16x16x32_bf16 a[104:107], a[180:183], v[184:187], a[104:107]
  s_add_u32 s25, s25, 32768
  ds_read_b128 a[148:151], v3 offset:13312
  v_add_f32 v227, v227, v220
  v_mfma_f32_16x16x32_bf16 a[108:111], a[180:183], v[188:191], a[108:111]
  s_and_b32 s25, s25, 0x1ffff
  v_add_f32 v227, v227, v221
  v_cvt_pk_bf16_f32 v182, v220, v221
  v_add_f32 v227, v227, v222
  v_mfma_f32_16x16x32_bf16 a[112:115], a[184:187], v[184:187], a[112:115]
  ds_read_b128 a[152:155], v3 offset:14336
  v_add_f32 v227, v227, v223
  v_max_f32 v5, v226, v227
  v_cmp_lt_f32 vcc, s81, v5
  v_mfma_f32_16x16x32_bf16 a[116:119], a[184:187], v[188:191], a[116:119]
  v_exp_f32 v216, v144
  v_mfma_f32_16x16x32_bf16 a[120:123], a[188:191], v[184:187], a[120:123]
  s_waitcnt lgkmcnt(3)
  ds_read_b128 a[156:159], v3 offset:15360
  v_cvt_pk_bf16_f32 v183, v222, v223
  v_add_u32 v3, s66, v2
  v_mfma_f32_16x16x32_bf16 a[124:127], a[188:191], v[188:191], a[124:127]
  s_cbranch_vccnz fa_stub17
fa_back17:
  v_exp_f32 v217, v145
  v_add_f32 v230, v230, v226
  v_add_f32 v231, v231, v227
fa_SSW5:
  v_mfma_f32_16x16x32_bf16 v[128:131], a[128:131], v[64:67], v[200:203]
  s_waitcnt vmcnt(12)
  v_exp_f32 v218, v146
  v_mfma_f32_16x16x32_bf16 v[136:139], a[128:131], v[68:71], v[204:207]
  s_barrier
  v_exp_f32 v219, v147
  v_mfma_f32_16x16x32_bf16 v[132:135], a[132:135], v[64:67], v[200:203]
  ds_read_b128 a[160:163], v3 offset:16384
  ds_read_b128 a[164:167], v3 offset:17408
  v_add_f32 v226, v216, v217
  v_mfma_f32_16x16x32_bf16 v[140:143], a[132:135], v[68:71], v[204:207]
  s_mov_b32 m0, s24
  v_exp_f32 v220, v148
  v_mfma_f32_16x16x32_bf16 v[128:131], a[136:139], v[72:75], v[128:131]
  ds_read_b128 a[168:171], v3 offset:18432
  buffer_load_dwordx4 v2, s[44:47], s26 offen offset:0 sc1 lds
  v_cvt_pk_bf16_f32 v184, v216, v217
  v_mfma_f32_16x16x32_bf16 v[136:139], a[136:139], v[76:79], v[136:139]
  v_exp_f32 v221, v149
  v_mfma_f32_16x16x32_bf16 v[132:135], a[140:143], v[72:75], v[132:135]
  ds_read_b128 a[172:175], v3 offset:19456
  v_add_f32 v226, v226, v218
  v_add_f32 v226, v226, v219
  v_mfma_f32_16x16x32_bf16 v[140:143], a[140:143], v[76:79], v[140:143]
  s_waitcnt lgkmcnt(4)
  v_exp_f32 v222, v150
  v_mfma_f32_16x16x32_bf16 v[128:131], a[144:147], v[80:83], v[128:131]
  s_add_u32 s14, s13, 16384
  ds_read_b128 a[176:179], v3 offset:20480
  buffer_load_dwordx4 a[200:203], v2, s[40:43], s14 offen offset:2048 sc1
  v_cvt_pk_bf16_f32 v185, v218, v219
  v_mfma_f32_16x16x32_bf16 v[136:139], a[144:147], v[84:87], v[136:139]
  v_exp_f32 v223, v151
  v_mfma_f32_16x16x32_bf16 v[132:135], a[148:151], v[80:83], v[132:135]
  ds_read_b128 a[180:183], v3 offset:21504
  buffer_load_dwordx4 v2, s[44:47], s26 offen offset:1024 sc1 lds
  v_add_f32 v226, v226, v220
  v_mfma_f32_16x16x32_bf16 v[140:143], a[148:151], v[84:87], v[140:143]
  v_exp_f32 v216, v152
  v_mfma_f32_16x16x32_bf16 v[128:131], a[152:155], v[88:91], v[128:131]
  ds_read_b128 a[184:187], v3 offset:22528
  v_add_f32 v226, v226, v221
  v_cvt_pk_bf16_f32 v186, v220, v221
  v_mfma_f32_16x16x32_bf16 v[136:139], a[152:155], v[92:95], v[136:139]
  v_exp_f32 v217, v153
  v_mfma_f32_16x16x32_bf16 v[132:135], a[156:159], v[88:91], v[132:135]
  ds_read_b128 a[188:191], v3 offset:23552
  buffer_load_dwordx4 a[204:207], v2, s[40:43], s14 offen offset:3072 sc1
  v_add_f32 v226, v226, v222
  v_mfma_f32_16x16x32_bf16 v[140:143], a[156:159], v[92:95], v[140:143]
  s_waitcnt lgkmcnt(4)
  v_exp_f32 v218, v154
  v_mfma_f32_16x16x32_bf16 a[64:67], a[160:163], v[176:179], a[64:67]
  ds_read_b128 a[128:131], v3 offset:0
  v_add_f32 v226, v226, v223
  v_cvt_pk_bf16_f32 v187, v222, v223
  v_mfma_f32_16x16x32_bf16 a[68:71], a[160:163], v[180:183], a[68:71]
  v_exp_f32 v219, v155
  v_mfma_f32_16x16x32_bf16 a[72:75], a[164:167], v[176:179], a[72:75]
  ds_read_b128 a[132:135], v3 offset:1024
  buffer_load_dwordx4 v2, s[44:47], s26 offen offset:2048 sc1 lds
  v_add_f32 v227, v216, v217
  v_mfma_f32_16x16x32_bf16 a[76:79], a[164:167], v[180:183], a[76:79]
  v_exp_f32 v220, v156
  v_mfma_f32_16x16x32_bf16 a[80:83], a[168:171], v[176:179], a[80:83]
  ds_read_b128 a[136:139], v3 offset:2048
  v_cvt_pk_bf16_f32 v188, v216, v217
  v_mfma_f32_16x16x32_bf16 a[84:87], a[168:171], v[180:183], a[84:87]
  v_exp_f32 v221, v157
  v_mfma_f32_16x16x32_bf16 a[88:91], a[172:175], v[176:179], a[88:91]
  s_add_u32 s14, s13, 20480
  ds_read_b128 a[140:143], v3 offset:3072
  buffer_load_dwordx4 a[208:211], v2, s[40:43], s14 offen offset:0 sc1
  v_add_f32 v227, v227, v218
  v_add_f32 v227, v227, v219
  v_mfma_f32_16x16x32_bf16 a[92:95], a[172:175], v[180:183], a[92:95]
  s_waitcnt lgkmcnt(4)
  v_exp_f32 v222, v158
  v_mfma_f32_16x16x32_bf16 a[96:99], a[176:179], v[176:179], a[96:99]
  ds_read_b128 a[144:147], v3 offset:4096
  buffer_load_dwordx4 v2, s[44:47], s26 offen offset:3072 sc1 lds
  v_cvt_pk_bf16_f32 v189, v218, v219
  v_mfma_f32_16x16x32_bf16 a[100:103], a[176:179], v[180:183], a[100:103]
  s_add_u32 s26, s26, 16384
  v_exp_f32 v223, v159
  v_mfma_f32_16x16x32_bf16 a[104:107], a[180:183], v[176:179], a[104:107]
  s_add_u32 s24, s24, 32768
  ds_read_b128 a[148:151], v3 offset:5120
  v_add_f32 v227, v227, v220
  v_mfma_f32_16x16x32_bf16 a[108:111], a[180:183], v[180:183], a[108:111]
  s_and_b32 s24, s24, 0x1ffff
  v_add_f32 v227, v227, v221
  v_cvt_pk_bf16_f32 v190, v220, v221
  v_add_f32 v227, v227, v222
  v_mfma_f32_16x16x32_bf16 a[112:115], a[184:187], v[176:179], a[112:115]
  ds_read_b128 a[152:155], v3 offset:6144
  v_add_f32 v227, v227, v223
  v_max_f32 v5, v226, v227
  v_cmp_lt_f32 vcc, s81, v5
  v_mfma_f32_16x16x32_bf16 a[116:119], a[184:187], v[180:183], a[116:119]
  v_exp_f32 v216, v128
  v_mfma_f32_16x16x32_bf16 a[120:123], a[188:191], v[176:179], a[120:123]
  s_waitcnt lgkmcnt(3)
  ds_read_b128 a[156:159], v3 offset:7168
  v_cvt_pk_bf16_f32 v191, v222, v223
  v_mfma_f32_16x16x32_bf16 a[124:127], a[188:191], v[180:183], a[124:127]
  s_cbranch_vccnz fa_stub18
fa_back18:
  v_exp_f32 v217, v129
  v_add_f32 v230, v230, v226
  v_add_f32 v231, v231, v227
  v_mfma_f32_16x16x32_bf16 v[144:147], a[128:131], v[64:67], v[200:203]
  ds_read_b128 a[160:163], v3 offset:24576
  v_add_f32 v226, v216, v217
  v_mfma_f32_16x16x32_bf16 v[152:155], a[128:131], v[68:71], v[204:207]
  v_exp_f32 v218, v130
  v_mfma_f32_16x16x32_bf16 v[148:151], a[132:135], v[64:67], v[200:203]
  s_add_u32 s66, s66, 32768
  ds_read_b128 a[164:167], v3 offset:25600
  v_cvt_pk_bf16_f32 v176, v216, v217
  v_mfma_f32_16x16x32_bf16 v[156:159], a[132:135], v[68:71], v[204:207]
  s_mov_b32 m0, s25
  v_exp_f32 v219, v131
  v_mfma_f32_16x16x32_bf16 v[144:147], a[136:139], v[72:75], v[144:147]
  s_and_b32 s66, s66, 0x1ffff
  ds_read_b128 a[168:171], v3 offset:26624
  buffer_load_dwordx4 v2, s[48:51], s27 offen offset:0 sc1 lds
  v_add_f32 v226, v226, v218
  v_add_f32 v226, v226, v219
  v_mfma_f32_16x16x32_bf16 v[152:155], a[136:139], v[76:79], v[152:155]
  v_exp_f32 v220, v132
  v_mfma_f32_16x16x32_bf16 v[148:151], a[140:143], v[72:75], v[148:151]
  ds_read_b128 a[172:175], v3 offset:27648
  v_cvt_pk_bf16_f32 v177, v218, v219
  v_mfma_f32_16x16x32_bf16 v[156:159], a[140:143], v[76:79], v[156:159]
  s_waitcnt lgkmcnt(4)
  v_exp_f32 v221, v133
  v_mfma_f32_16x16x32_bf16 v[144:147], a[144:147], v[80:83], v[144:147]
  s_add_u32 s14, s13, 20480
  ds_read_b128 a[176:179], v3 offset:28672
  buffer_load_dwordx4 a[212:215], v2, s[40:43], s14 offen offset:1024 sc1
  v_add_f32 v226, v226, v220
  v_mfma_f32_16x16x32_bf16 v[152:155], a[144:147], v[84:87], v[152:155]
  v_exp_f32 v222, v134
  v_mfma_f32_16x16x32_bf16 v[148:151], a[148:151], v[80:83], v[148:151]
  ds_read_b128 a[180:183], v3 offset:29696
  buffer_load_dwordx4 v2, s[48:51], s27 offen offset:1024 sc1 lds
  v_add_f32 v226, v226, v221
  v_cvt_pk_bf16_f32 v178, v220, v221
  v_mfma_f32_16x16x32_bf16 v[156:159], a[148:151], v[84:87], v[156:159]
  v_exp_f32 v223, v135
  v_mfma_f32_16x16x32_bf16 v[144:147], a[152:155], v[88:91], v[144:147]
  ds_read_b128 a[184:187], v3 offset:30720
  v_add_f32 v226, v226, v222
  v_mfma_f32_16x16x32_bf16 v[152:155], a[152:155], v[92:95], v[152:155]
  v_exp_f32 v216, v136
  v_mfma_f32_16x16x32_bf16 v[148:151], a[156:159], v[88:91], v[148:151]
  ds_read_b128 a[188:191], v3 offset:31744
  buffer_load_dwordx4 a[216:219], v2, s[40:43], s14 offen offset:2048 sc1
  v_add_f32 v226, v226, v223
  v_exp_f32 v217, v137
  v_mfma_f32_16x16x32_bf16 v[156:159], a[156:159], v[92:95], v[156:159]
  s_waitcnt lgkmcnt(4)
  v_exp_f32 v218, v138
  v_mfma_f32_16x16x32_bf16 a[64:67], a[160:163], v[184:187], a[64:67]
  ds_read_b128 a[128:131], v3 offset:8192
  v_cvt_pk_bf16_f32 v179, v222, v223
  v_mfma_f32_16x16x32_bf16 a[68:71], a[160:163], v[188:191], a[68:71]
  v_exp_f32 v219, v139
  v_mfma_f32_16x16x32_bf16 a[72:75], a[164:167], v[184:187], a[72:75]
  ds_read_b128 a[132:135], v3 offset:9216
  buffer_load_dwordx4 v2, s[48:51], s27 offen offset:2048 sc1 lds
  v_add_f32 v227, v216, v217
  v_mfma_f32_16x16x32_bf16 a[76:79], a[164:167], v[188:191], a[76:79]
  v_exp_f32 v220, v140
  v_mfma_f32_16x16x32_bf16 a[80:83], a[168:171], v[184:187], a[80:83]
  ds_read_b128 a[136:139], v3 offset:10240
  v_cvt_pk_bf16_f32 v180, v216, v217
  v_mfma_f32_16x16x32_bf16 a[84:87], a[168:171], v[188:191], a[84:87]
  v_exp_f32 v221, v141
  v_mfma_f32_16x16x32_bf16 a[88:91], a[172:175], v[184:187], a[88:91]
  ds_read_b128 a[140:143], v3 offset:11264
  buffer_load_dwordx4 a[220:223], v2, s[40:43], s14 offen offset:3072 sc1
  v_add_f32 v227, v227, v218
  v_mfma_f32_16x16x32_bf16 a[92:95], a[172:175], v[188:191], a[92:95]
  s_waitcnt lgkmcnt(4)
  v_exp_f32 v222, v142
  v_mfma_f32_16x16x32_bf16 a[96:99], a[176:179], v[184:187], a[96:99]
  ds_read_b128 a[144:147], v3 offset:12288
  buffer_load_dwordx4 v2, s[48:51], s27 offen offset:3072 sc1 lds
  v_add_f32 v227, v227, v219
  v_cvt_pk_bf16_f32 v181, v218, v219
  v_mfma_f32_16x16x32_bf16 a[100:103], a[176:179], v[188:191], a[100:103]
  s_add_u32 s27, s27, 16384
  v_exp_f32 v223, v143
  v_mfma_f32_16x16x32_bf16 a[104:107], a[180:183], v[184:187], a[104:107]
  s_add_u32 s25, s25, 32768
  ds_read_b128 a[148:151], v3 offset:13312
  v_add_f32 v227, v227, v220
  v_mfma_f32_16x16x32_bf16 a[108:111], a[180:183], v[188:191], a[108:111]
  s_and_b32 s25, s25, 0x1ffff
  v_add_f32 v227, v227, v221
  v_cvt_pk_bf16_f32 v182, v220, v221
  v_add_f32 v227, v227, v222
  v_mfma_f32_16x16x32_bf16 a[112:115], a[184:187], v[184:187], a[112:115]
  ds_read_b128 a[152:155], v3 offset:14336
  v_add_f32 v227, v227, v223
  v_max_f32 v5, v226, v227
  v_cmp_lt_f32 vcc, s81, v5
  v_mfma_f32_16x16x32_bf16 a[116:119], a[184:187], v[188:191], a[116:119]
  v_exp_f32 v216, v144
  v_mfma_f32_16x16x32_bf16 a[120:123], a[188:191], v[184:187], a[120:123]
  s_waitcnt lgkmcnt(3)
  ds_read_b128 a[156:159], v3 offset:15360
  v_cvt_pk_bf16_f32 v183, v222, v223
  v_add_u32 v3, s66, v2
  v_mfma_f32_16x16x32_bf16 a[124:127], a[188:191], v[188:191], a[124:127]
  s_cbranch_vccnz fa_stub19
fa_back19:
  v_exp_f32 v217, v145
  v_add_f32 v230, v230, v226
  v_add_f32 v231, v231, v227
fa_SSW4:
  v_mfma_f32_16x16x32_bf16 v[128:131], a[128:131], v[64:67], v[200:203]
  s_waitcnt vmcnt(12)
  v_exp_f32 v218, v146
  v_mfma_f32_16x16x32_bf16 v[136:139], a[128:131], v[68:71], v[204:207]
  s_barrier
  v_exp_f32 v219, v147
  v_mfma_f32_16x16x32_bf16 v[132:135], a[132:135], v[64:67], v[200:203]
  ds_read_b128 a[160:163], v3 offset:16384
  ds_read_b128 a[164:167], v3 offset:17408
  v_add_f32 v226, v216, v217
  v_mfma_f32_16x16x32_bf16 v[140:143], a[132:135], v[68:71], v[204:207]
  s_mov_b32 m0, s24
  v_exp_f32 v220, v148
  v_mfma_f32_16x16x32_bf16 v[128:131], a[136:139], v[72:75], v[128:131]
  ds_read_b128 a[168:171], v3 offset:18432
  buffer_load_dwordx4 v2, s[44:47], s26 offen offset:0 sc1 lds
  v_cvt_pk_bf16_f32 v184, v216, v217
  v_mfma_f32_16x16x32_bf16 v[136:139], a[136:139], v[76:79], v[136:139]
  v_exp_f32 v221, v149
  v_mfma_f32_16x16x32_bf16 v[132:135], a[140:143], v[72:75], v[132:135]
  ds_read_b128 a[172:175], v3 offset:19456
  v_add_f32 v226, v226, v218
  v_add_f32 v226, v226, v219
  v_mfma_f32_16x16x32_bf16 v[140:143], a[140:143], v[76:79], v[140:143]
  s_waitcnt lgkmcnt(4)
  v_exp_f32 v222, v150
  v_mfma_f32_16x16x32_bf16 v[128:131], a[144:147], v[80:83], v[128:131]
  s_add_u32 s14, s13, 24576
  ds_read_b128 a[176:179], v3 offset:20480
  buffer_load_dwordx4 a[224:227], v2, s[40:43], s14 offen offset:0 sc1
  v_cvt_pk_bf16_f32 v185, v218, v219
  v_mfma_f32_16x16x32_bf16 v[136:139], a[144:147], v[84:87], v[136:139]
  v_exp_f32 v223, v151
  v_mfma_f32_16x16x32_bf16 v[132:135], a[148:151], v[80:83], v[132:135]
  ds_read_b128 a[180:183], v3 offset:21504
  buffer_load_dwordx4 v2, s[44:47], s26 offen offset:1024 sc1 lds
  v_add_f32 v226, v226, v220
  v_mfma_f32_16x16x32_bf16 v[140:143], a[148:151], v[84:87], v[140:143]
  v_exp_f32 v216, v152
  v_mfma_f32_16x16x32_bf16 v[128:131], a[152:155], v[88:91], v[128:131]
  ds_read_b128 a[184:187], v3 offset:22528
  v_add_f32 v226, v226, v221
  v_cvt_pk_bf16_f32 v186, v220, v221
  v_mfma_f32_16x16x32_bf16 v[136:139], a[152:155], v[92:95], v[136:139]
  v_exp_f32 v217, v153
  v_mfma_f32_16x16x32_bf16 v[132:135], a[156:159], v[88:91], v[132:135]
  ds_read_b128 a[188:191], v3 offset:23552
  buffer_load_dwordx4 a[228:231], v2, s[40:43], s14 offen offset:1024 sc1
  v_add_f32 v226, v226, v222
  v_mfma_f32_16x16x32_bf16 v[140:143], a[156:159], v[92:95], v[140:143]
  s_waitcnt lgkmcnt(4)
  v_exp_f32 v218, v154
  v_mfma_f32_16x16x32_bf16 a[64:67], a[160:163], v[176:179], a[64:67]
  ds_read_b128 a[128:131], v3 offset:0
  v_add_f32 v226, v226, v223
  v_cvt_pk_bf16_f32 v187, v222, v223
  v_mfma_f32_16x16x32_bf16 a[68:71], a[160:163], v[180:183], a[68:71]
  v_exp_f32 v219, v155
  v_mfma_f32_16x16x32_bf16 a[72:75], a[164:167], v[176:179], a[72:75]
  ds_read_b128 a[132:135], v3 offset:1024
  buffer_load_dwordx4 v2, s[44:47], s26 offen offset:2048 sc1 lds
  v_add_f32 v227, v216, v217
  v_mfma_f32_16x16x32_bf16 a[76:79], a[164:167], v[180:183], a[76:79]
  v_exp_f32 v220, v156
  v_mfma_f32_16x16x32_bf16 a[80:83], a[168:171], v[176:179], a[80:83]
  ds_read_b128 a[136:139], v3 offset:2048
  v_cvt_pk_bf16_f32 v188, v216, v217
  v_mfma_f32_16x16x32_bf16 a[84:87], a[168:171], v[180:183], a[84:87]
  v_exp_f32 v221, v157
  v_mfma_f32_16x16x32_bf16 a[88:91], a[172:175], v[176:179], a[88:91]
  ds_read_b128 a[140:143], v3 offset:3072
  buffer_load_dwordx4 a[232:235], v2, s[40:43], s14 offen offset:2048 sc1
  v_add_f32 v227, v227, v218
  v_add_f32 v227, v227, v219
  v_mfma_f32_16x16x32_bf16 a[92:95], a[172:175], v[180:183], a[92:95]
  s_waitcnt lgkmcnt(4)
  v_exp_f32 v222, v158
  v_mfma_f32_16x16x32_bf16 a[96:99], a[176:179], v[176:179], a[96:99]
  ds_read_b128 a[144:147], v3 offset:4096
  buffer_load_dwordx4 v2, s[44:47], s26 offen offset:3072 sc1 lds
  v_cvt_pk_bf16_f32 v189, v218, v219
  v_mfma_f32_16x16x32_bf16 a[100:103], a[176:179], v[180:183], a[100:103]
  s_add_u32 s26, s26, 16384
  v_exp_f32 v223, v159
  v_mfma_f32_16x16x32_bf16 a[104:107], a[180:183], v[176:179], a[104:107]
  s_add_u32 s24, s24, 32768
  ds_read_b128 a[148:151], v3 offset:5120
  v_add_f32 v227, v227, v220
  v_mfma_f32_16x16x32_bf16 a[108:111], a[180:183], v[180:183], a[108:111]
  s_and_b32 s24, s24, 0x1ffff
  v_add_f32 v227, v227, v221
  v_cvt_pk_bf16_f32 v190, v220, v221
  v_add_f32 v227, v227, v222
  v_mfma_f32_16x16x32_bf16 a[112:115], a[184:187], v[176:179], a[112:115]
  ds_read_b128 a[152:155], v3 offset:6144
  v_add_f32 v227, v227, v223
  v_max_f32 v5, v226, v227
  v_cmp_lt_f32 vcc, s81, v5
  v_mfma_f32_16x16x32_bf16 a[116:119], a[184:187], v[180:183], a[116:119]
  v_exp_f32 v216, v128
  v_mfma_f32_16x16x32_bf16 a[120:123], a[188:191], v[176:179], a[120:123]
  s_waitcnt lgkmcnt(3)
  ds_read_b128 a[156:159], v3 offset:7168
  v_cvt_pk_bf16_f32 v191, v222, v223
  v_mfma_f32_16x16x32_bf16 a[124:127], a[188:191], v[180:183], a[124:127]
  s_cbranch_vccnz fa_stub20
fa_back20:
  v_exp_f32 v217, v129
  v_add_f32 v230, v230, v226
  v_add_f32 v231, v231, v227
  v_mfma_f32_16x16x32_bf16 v[144:147], a[128:131], v[64:67], v[200:203]
  ds_read_b128 a[160:163], v3 offset:24576
  v_add_f32 v226, v216, v217
  v_mfma_f32_16x16x32_bf16 v[152:155], a[128:131], v[68:71], v[204:207]
  v_exp_f32 v218, v130
  v_mfma_f32_16x16x32_bf16 v[148:151], a[132:135], v[64:67], v[200:203]
  s_add_u32 s66, s66, 32768
  ds_read_b128 a[164:167], v3 offset:25600
  v_cvt_pk_bf16_f32 v176, v216, v217
  v_mfma_f32_16x16x32_bf16 v[156:159], a[132:135], v[68:71], v[204:207]
  s_mov_b32 m0, s25
  v_exp_f32 v219, v131
  v_mfma_f32_16x16x32_bf16 v[144:147], a[136:139], v[72:75], v[144:147]
  s_and_b32 s66, s66, 0x1ffff
  ds_read_b128 a[168:171], v3 offset:26624
  buffer_load_dwordx4 v2, s[48:51], s27 offen offset:0 sc1 lds
  v_add_f32 v226, v226, v218
  v_add_f32 v226, v226, v219
  v_mfma_f32_16x16x32_bf16 v[152:155], a[136:139], v[76:79], v[152:155]
  v_exp_f32 v220, v132
  v_mfma_f32_16x16x32_bf16 v[148:151], a[140:143], v[72:75], v[148:151]
  ds_read_b128 a[172:175], v3 offset:27648
  v_cvt_pk_bf16_f32 v177, v218, v219
  v_mfma_f32_16x16x32_bf16 v[156:159], a[140:143], v[76:79], v[156:159]
  s_waitcnt lgkmcnt(4)
  v_exp_f32 v221, v133
  v_mfma_f32_16x16x32_bf16 v[144:147], a[144:147], v[80:83], v[144:147]
  s_add_u32 s14, s13, 24576
  ds_read_b128 a[176:179], v3 offset:28672
  buffer_load_dwordx4 a[236:239], v2, s[40:43], s14 offen offset:3072 sc1
  v_add_f32 v226, v226, v220
  v_mfma_f32_16x16x32_bf16 v[152:155], a[144:147], v[84:87], v[152:155]
  v_exp_f32 v222, v134
  v_mfma_f32_16x16x32_bf16 v[148:151], a[148:151], v[80:83], v[148:151]
  ds_read_b128 a[180:183], v3 offset:29696
  buffer_load_dwordx4 v2, s[48:51], s27 offen offset:1024 sc1 lds
  v_add_f32 v226, v226, v221
  v_cvt_pk_bf16_f32 v178, v220, v221
  v_mfma_f32_16x16x32_bf16 v[156:159], a[148:151], v[84:87], v[156:159]
  v_exp_f32 v223, v135
  v_mfma_f32_16x16x32_bf16 v[144:147], a[152:155], v[88:91], v[144:147]
  ds_read_b128 a[184:187], v3 offset:30720
  v_add_f32 v226, v226, v222
  v_mfma_f32_16x16x32_bf16 v[152:155], a[152:155], v[92:95], v[152:155]
  v_exp_f32 v216, v136
  v_mfma_f32_16x16x32_bf16 v[148:151], a[156:159], v[88:91], v[148:151]
  s_add_u32 s14, s13, 28672
  ds_read_b128 a[188:191], v3 offset:31744
  buffer_load_dwordx4 a[240:243], v2, s[40:43], s14 offen offset:0 sc1
  v_add_f32 v226, v226, v223
  v_exp_f32 v217, v137
  v_mfma_f32_16x16x32_bf16 v[156:159], a[156:159], v[92:95], v[156:159]
  s_waitcnt lgkmcnt(4)
  v_exp_f32 v218, v138
  v_mfma_f32_16x16x32_bf16 a[64:67], a[160:163], v[184:187], a[64:67]
  ds_read_b128 a[128:131], v3 offset:8192
  v_cvt_pk_bf16_f32 v179, v222, v223
  v_mfma_f32_16x16x32_bf16 a[68:71], a[160:163], v[188:191], a[68:71]
  v_exp_f32 v219, v139
  v_mfma_f32_16x16x32_bf16 a[72:75], a[164:167], v[184:187], a[72:75]
  ds_read_b128 a[132:135], v3 offset:9216
  buffer_load_dwordx4 v2, s[48:51], s27 offen offset:2048 sc1 lds
  v_add_f32 v227, v216, v217
  v_mfma_f32_16x16x32_bf16 a[76:79], a[164:167], v[188:191], a[76:79]
  v_exp_f32 v220, v140
  v_mfma_f32_16x16x32_bf16 a[80:83], a[168:171], v[184:187], a[80:83]
  ds_read_b128 a[136:139], v3 offset:10240
  v_cvt_pk_bf16_f32 v180, v216, v217
  v_mfma_f32_16x16x32_bf16 a[84:87], a[168:171], v[188:191], a[84:87]
  v_exp_f32 v221, v141
  v_mfma_f32_16x16x32_bf16 a[88:91], a[172:175], v[184:187], a[88:91]
  ds_read_b128 a[140:143], v3 offset:11264
  buffer_load_dwordx4 a[244:247], v2, s[40:43], s14 offen offset:1024 sc1
  v_add_f32 v227, v227, v218
  v_mfma_f32_16x16x32_bf16 a[92:95], a[172:175], v[188:191], a[92:95]
  s_waitcnt lgkmcnt(4)
  v_exp_f32 v222, v142
  v_mfma_f32_16x16x32_bf16 a[96:99], a[176:179], v[184:187], a[96:99]
  ds_read_b128 a[144:147], v3 offset:12288
  buffer_load_dwordx4 v2, s[48:51], s27 offen offset:3072 sc1 lds
  v_add_f32 v227, v227, v219
  v_cvt_pk_bf16_f32 v181, v218, v219
  v_mfma_f32_16x16x32_bf16 a[100:103], a[176:179], v[188:191], a[100:103]
  s_add_u32 s27, s27, 16384
  v_exp_f32 v223, v143
  v_mfma_f32_16x16x32_bf16 a[104:107], a[180:183], v[184:187], a[104:107]
  s_add_u32 s25, s25, 32768
  ds_read_b128 a[148:151], v3 offset:13312
  v_add_f32 v227, v227, v220
  v_mfma_f32_16x16x32_bf16 a[108:111], a[180:183], v[188:191], a[108:111]
  s_and_b32 s25, s25, 0x1ffff
  v_add_f32 v227, v227, v221
  v_cvt_pk_bf16_f32 v182, v220, v221
  v_add_f32 v227, v227, v222
  v_mfma_f32_16x16x32_bf16 a[112:115], a[184:187], v[184:187], a[112:115]
  ds_read_b128 a[152:155], v3 offset:14336
  v_add_f32 v227, v227, v223
  v_max_f32 v5, v226, v227
  v_cmp_lt_f32 vcc, s81, v5
  v_mfma_f32_16x16x32_bf16 a[116:119], a[184:187], v[188:191], a[116:119]
  v_exp_f32 v216, v144
  v_mfma_f32_16x16x32_bf16 a[120:123], a[188:191], v[184:187], a[120:123]
  s_waitcnt lgkmcnt(3)
  ds_read_b128 a[156:159], v3 offset:15360
  v_cvt_pk_bf16_f32 v183, v222, v223
  v_add_u32 v3, s66, v2
  v_mfma_f32_16x16x32_bf16 a[124:127], a[188:191], v[188:191], a[124:127]
  s_cbranch_vccnz fa_stub21
fa_back21:
  v_exp_f32 v217, v145
  v_add_f32 v230, v230, v226
  v_add_f32 v231, v231, v227
fa_SSW3:
  v_mfma_f32_16x16x32_bf16 v[128:131], a[128:131], v[64:67], v[200:203]
  s_waitcnt vmcnt(12)
  v_exp_f32 v218, v146
  v_mfma_f32_16x16x32_bf16 v[136:139], a[128:131], v[68:71], v[204:207]
  s_barrier
  v_exp_f32 v219, v147
  v_mfma_f32_16x16x32_bf16 v[132:135], a[132:135], v[64:67], v[200:203]
  s_cmp_ge_u32 s26, s46
  s_cselect_b64 s[44:45], s[4:5], s[44:45]
  s_cselect_b32 s46, s30, s46
  ds_read_b128 a[160:163], v3 offset:16384
  ds_read_b128 a[164:167], v3 offset:17408
  v_add_f32 v226, v216, v217
  v_mfma_f32_16x16x32_bf16 v[140:143], a[132:135], v[68:71], v[204:207]
  s_mov_b32 m0, s24
  v_exp_f32 v220, v148
  v_mfma_f32_16x16x32_bf16 v[128:131], a[136:139], v[72:75], v[128:131]
  ds_read_b128 a[168:171], v3 offset:18432
  buffer_load_dwordx4 v2, s[44:47], s26 offen offset:0 sc1 lds
  v_cvt_pk_bf16_f32 v184, v216, v217
  v_mfma_f32_16x16x32_bf16 v[136:139], a[136:139], v[76:79], v[136:139]
  v_exp_f32 v221, v149
  v_mfma_f32_16x16x32_bf16 v[132:135], a[140:143], v[72:75], v[132:135]
  ds_read_b128 a[172:175], v3 offset:19456
  v_add_f32 v226, v226, v218
  v_add_f32 v226, v226, v219
  v_mfma_f32_16x16x32_bf16 v[140:143], a[140:143], v[76:79], v[140:143]
  s_waitcnt lgkmcnt(4)
  v_exp_f32 v222, v150
  v_mfma_f32_16x16x32_bf16 v[128:131], a[144:147], v[80:83], v[128:131]
  s_add_u32 s14, s13, 28672
  ds_read_b128 a[176:179], v3 offset:20480
  buffer_load_dwordx4 a[248:251], v2, s[40:43], s14 offen offset:2048 sc1
  v_cvt_pk_bf16_f32 v185, v218, v219
  v_mfma_f32_16x16x32_bf16 v[136:139], a[144:147], v[84:87], v[136:139]
  v_exp_f32 v223, v151
  v_mfma_f32_16x16x32_bf16 v[132:135], a[148:151], v[80:83], v[132:135]
  ds_read_b128 a[180:183], v3 offset:21504
  buffer_load_dwordx4 v2, s[44:47], s26 offen offset:1024 sc1 lds
  v_add_f32 v226, v226, v220
  v_mfma_f32_16x16x32_bf16 v[140:143], a[148:151], v[84:87], v[140:143]
  v_exp_f32 v216, v152
  v_mfma_f32_16x16x32_bf16 v[128:131], a[152:155], v[88:91], v[128:131]
  ds_read_b128 a[184:187], v3 offset:22528
  v_add_f32 v226, v226, v221
  v_cvt_pk_bf16_f32 v186, v220, v221
  v_mfma_f32_16x16x32_bf16 v[136:139], a[152:155], v[92:95], v[136:139]
  v_exp_f32 v217, v153
  v_mfma_f32_16x16x32_bf16 v[132:135], a[156:159], v[88:91], v[132:135]
  ds_read_b128 a[188:191], v3 offset:23552
  buffer_load_dwordx4 a[252:255], v2, s[40:43], s14 offen offset:3072 sc1
  v_add_f32 v226, v226, v222
  v_mfma_f32_16x16x32_bf16 v[140:143], a[156:159], v[92:95], v[140:143]
  s_waitcnt lgkmcnt(4)
  v_exp_f32 v218, v154
  v_mfma_f32_16x16x32_bf16 a[64:67], a[160:163], v[176:179], a[64:67]
  ds_read_b128 a[128:131], v3 offset:0
  v_add_f32 v226, v226, v223
  v_cvt_pk_bf16_f32 v187, v222, v223
  v_mfma_f32_16x16x32_bf16 a[68:71], a[160:163], v[180:183], a[68:71]
  v_exp_f32 v219, v155
  v_mfma_f32_16x16x32_bf16 a[72:75], a[164:167], v[176:179], a[72:75]
  ds_read_b128 a[132:135], v3 offset:1024
  buffer_load_dwordx4 v2, s[44:47], s26 offen offset:2048 sc1 lds
  v_add_f32 v227, v216, v217
  v_mfma_f32_16x16x32_bf16 a[76:79], a[164:167], v[180:183], a[76:79]
  v_exp_f32 v220, v156
  v_mfma_f32_16x16x32_bf16 a[80:83], a[168:171], v[176:179], a[80:83]
  ds_read_b128 a[136:139], v3 offset:2048
  v_cvt_pk_bf16_f32 v188, v216, v217
  v_mfma_f32_16x16x32_bf16 a[84:87], a[168:171], v[180:183], a[84:87]
  v_exp_f32 v221, v157
  v_mfma_f32_16x16x32_bf16 a[88:91], a[172:175], v[176:179], a[88:91]
  s_add_u32 s14, s13, 32768
  ds_read_b128 a[140:143], v3 offset:3072
  buffer_load_dwordx4 v[32:35], v2, s[40:43], s14 offen offset:0 sc1
  v_add_f32 v227, v227, v218
  v_add_f32 v227, v227, v219
  v_mfma_f32_16x16x32_bf16 a[92:95], a[172:175], v[180:183], a[92:95]
  s_waitcnt lgkmcnt(4)
  v_exp_f32 v222, v158
  v_mfma_f32_16x16x32_bf16 a[96:99], a[176:179], v[176:179], a[96:99]
  ds_read_b128 a[144:147], v3 offset:4096
  buffer_load_dwordx4 v2, s[44:47], s26 offen offset:3072 sc1 lds
  v_cvt_pk_bf16_f32 v189, v218, v219
  v_mfma_f32_16x16x32_bf16 a[100:103], a[176:179], v[180:183], a[100:103]
  s_add_u32 s26, s26, 16384
  v_exp_f32 v223, v159
  v_mfma_f32_16x16x32_bf16 a[104:107], a[180:183], v[176:179], a[104:107]
  s_add_u32 s24, s24, 32768
  ds_read_b128 a[148:151], v3 offset:5120
  v_add_f32 v227, v227, v220
  v_mfma_f32_16x16x32_bf16 a[108:111], a[180:183], v[180:183], a[108:111]
  s_and_b32 s24, s24, 0x1ffff
  v_add_f32 v227, v227, v221
  v_cvt_pk_bf16_f32 v190, v220, v221
  v_add_f32 v227, v227, v222
  v_mfma_f32_16x16x32_bf16 a[112:115], a[184:187], v[176:179], a[112:115]
  ds_read_b128 a[152:155], v3 offset:6144
  v_add_f32 v227, v227, v223
  v_max_f32 v5, v226, v227
  v_cmp_lt_f32 vcc, s81, v5
  v_mfma_f32_16x16x32_bf16 a[116:119], a[184:187], v[180:183], a[116:119]
  v_exp_f32 v216, v128
  v_mfma_f32_16x16x32_bf16 a[120:123], a[188:191], v[176:179], a[120:123]
  s_waitcnt lgkmcnt(3)
  ds_read_b128 a[156:159], v3 offset:7168
  v_cvt_pk_bf16_f32 v191, v222, v223
  v_mfma_f32_16x16x32_bf16 a[124:127], a[188:191], v[180:183], a[124:127]
  s_cbranch_vccnz fa_stub22
fa_back22:
  v_exp_f32 v217, v129
  v_add_f32 v230, v230, v226
  v_add_f32 v231, v231, v227
  v_mfma_f32_16x16x32_bf16 v[144:147], a[128:131], v[64:67], v[200:203]
  ds_read_b128 a[160:163], v3 offset:24576
  v_add_f32 v226, v216, v217
  v_mfma_f32_16x16x32_bf16 v[152:155], a[128:131], v[68:71], v[204:207]
  v_exp_f32 v218, v130
  v_mfma_f32_16x16x32_bf16 v[148:151], a[132:135], v[64:67], v[200:203]
  s_cmp_ge_u32 s27, s50
  s_cselect_b64 s[48:49], s[6:7], s[48:49]
  s_cselect_b32 s50, s30, s50
  ds_read_b128 a[164:167], v3 offset:25600
  v_cvt_pk_bf16_f32 v176, v216, v217
  v_mfma_f32_16x16x32_bf16 v[156:159], a[132:135], v[68:71], v[204:207]
  s_mov_b32 m0, s25
  v_exp_f32 v219, v131
  v_mfma_f32_16x16x32_bf16 v[144:147], a[136:139], v[72:75], v[144:147]
  s_add_u32 s66, s66, 32768
  ds_read_b128 a[168:171], v3 offset:26624
  buffer_load_dwordx4 v2, s[48:51], s27 offen offset:0 sc1 lds
  v_add_f32 v226, v226, v218
  v_add_f32 v226, v226, v219
  v_mfma_f32_16x16x32_bf16 v[152:155], a[136:139], v[76:79], v[152:155]
  s_and_b32 s66, s66, 0x1ffff
  v_exp_f32 v220, v132
  v_mfma_f32_16x16x32_bf16 v[148:151], a[140:143], v[72:75], v[148:151]
  ds_read_b128 a[172:175], v3 offset:27648
  v_cvt_pk_bf16_f32 v177, v218, v219
  v_mfma_f32_16x16x32_bf16 v[156:159], a[140:143], v[76:79], v[156:159]
  s_waitcnt lgkmcnt(4)
  v_exp_f32 v221, v133
  v_mfma_f32_16x16x32_bf16 v[144:147], a[144:147], v[80:83], v[144:147]
  s_add_u32 s14, s13, 32768
  ds_read_b128 a[176:179], v3 offset:28672
  buffer_load_dwordx4 v[36:39], v2, s[40:43], s14 offen offset:1024 sc1
  v_add_f32 v226, v226, v220
  v_mfma_f32_16x16x32_bf16 v[152:155], a[144:147], v[84:87], v[152:155]
  v_exp_f32 v222, v134
  v_mfma_f32_16x16x32_bf16 v[148:151], a[148:151], v[80:83], v[148:151]
  ds_read_b128 a[180:183], v3 offset:29696
  buffer_load_dwordx4 v2, s[48:51], s27 offen offset:1024 sc1 lds
  v_add_f32 v226, v226, v221
  v_cvt_pk_bf16_f32 v178, v220, v221
  v_mfma_f32_16x16x32_bf16 v[156:159], a[148:151], v[84:87], v[156:159]
  v_exp_f32 v223, v135
  v_mfma_f32_16x16x32_bf16 v[144:147], a[152:155], v[88:91], v[144:147]
  ds_read_b128 a[184:187], v3 offset:30720
  v_add_f32 v226, v226, v222
  v_mfma_f32_16x16x32_bf16 v[152:155], a[152:155], v[92:95], v[152:155]
  v_exp_f32 v216, v136
  v_mfma_f32_16x16x32_bf16 v[148:151], a[156:159], v[88:91], v[148:151]
  ds_read_b128 a[188:191], v3 offset:31744
  buffer_load_dwordx4 v[40:43], v2, s[40:43], s14 offen offset:2048 sc1
  v_add_f32 v226, v226, v223
  v_exp_f32 v217, v137
  v_mfma_f32_16x16x32_bf16 v[156:159], a[156:159], v[92:95], v[156:159]
  s_waitcnt lgkmcnt(4)
  v_exp_f32 v218, v138
  v_mfma_f32_16x16x32_bf16 a[64:67], a[160:163], v[184:187], a[64:67]
  ds_read_b128 a[128:131], v3 offset:8192
  v_cvt_pk_bf16_f32 v179, v222, v223
  v_mfma_f32_16x16x32_bf16 a[68:71], a[160:163], v[188:191], a[68:71]
  v_exp_f32 v219, v139
  v_mfma_f32_16x16x32_bf16 a[72:75], a[164:167], v[184:187], a[72:75]
  ds_read_b128 a[132:135], v3 offset:9216
  buffer_load_dwordx4 v2, s[48:51], s27 offen offset:2048 sc1 lds
  v_add_f32 v227, v216, v217
  v_mfma_f32_16x16x32_bf16 a[76:79], a[164:167], v[188:191], a[76:79]
  v_exp_f32 v220, v140
  v_mfma_f32_16x16x32_bf16 a[80:83], a[168:171], v[184:187], a[80:83]
  ds_read_b128 a[136:139], v3 offset:10240
  v_cvt_pk_bf16_f32 v180, v216, v217
  v_mfma_f32_16x16x32_bf16 a[84:87], a[168:171], v[188:191], a[84:87]
  v_exp_f32 v221, v141
  v_mfma_f32_16x16x32_bf16 a[88:91], a[172:175], v[184:187], a[88:91]
  ds_read_b128 a[140:143], v3 offset:11264
  buffer_load_dwordx4 v[44:47], v2, s[40:43], s14 offen offset:3072 sc1
  v_add_f32 v227, v227, v218
  v_mfma_f32_16x16x32_bf16 a[92:95], a[172:175], v[188:191], a[92:95]
  s_waitcnt lgkmcnt(4)
  v_exp_f32 v222, v142
  v_mfma_f32_16x16x32_bf16 a[96:99], a[176:179], v[184:187], a[96:99]
  ds_read_b128 a[144:147], v3 offset:12288
  buffer_load_dwordx4 v2, s[48:51], s27 offen offset:3072 sc1 lds
  v_add_f32 v227, v227, v219
  v_cvt_pk_bf16_f32 v181, v218, v219
  v_mfma_f32_16x16x32_bf16 a[100:103], a[176:179], v[188:191], a[100:103]
  s_add_u32 s27, s27, 16384
  v_exp_f32 v223, v143
  v_mfma_f32_16x16x32_bf16 a[104:107], a[180:183], v[184:187], a[104:107]
  s_add_u32 s25, s25, 32768
  ds_read_b128 a[148:151], v3 offset:13312
  v_add_f32 v227, v227, v220
  v_mfma_f32_16x16x32_bf16 a[108:111], a[180:183], v[188:191], a[108:111]
  s_and_b32 s25, s25, 0x1ffff
  v_add_f32 v227, v227, v221
  v_cvt_pk_bf16_f32 v182, v220, v221
  v_add_f32 v227, v227, v222
  v_mfma_f32_16x16x32_bf16 a[112:115], a[184:187], v[184:187], a[112:115]
  ds_read_b128 a[152:155], v3 offset:14336
  v_add_f32 v227, v227, v223
  v_max_f32 v5, v226, v227
  v_cmp_lt_f32 vcc, s81, v5
  v_mfma_f32_16x16x32_bf16 a[116:119], a[184:187], v[188:191], a[116:119]
  v_exp_f32 v216, v144
  v_mfma_f32_16x16x32_bf16 a[120:123], a[188:191], v[184:187], a[120:123]
  s_waitcnt lgkmcnt(3)
  ds_read_b128 a[156:159], v3 offset:15360
  v_cvt_pk_bf16_f32 v183, v222, v223
  v_add_u32 v3, s66, v2
  v_mfma_f32_16x16x32_bf16 a[124:127], a[188:191], v[188:191], a[124:127]
  s_cbranch_vccnz fa_stub23
fa_back23:
  v_exp_f32 v217, v145
  v_add_f32 v230, v230, v226
  v_add_f32 v231, v231, v227
fa_SSW2:
  v_mfma_f32_16x16x32_bf16 v[128:131], a[128:131], v[64:67], v[200:203]
  s_waitcnt vmcnt(12)
  v_exp_f32 v218, v146
  v_mfma_f32_16x16x32_bf16 v[136:139], a[128:131], v[68:71], v[204:207]
  s_barrier
  v_exp_f32 v219, v147
  v_mfma_f32_16x16x32_bf16 v[132:135], a[132:135], v[64:67], v[200:203]
  s_cmp_ge_u32 s26, s46
  s_cselect_b64 s[44:45], s[4:5], s[44:45]
  s_cselect_b32 s46, s30, s46
  ds_read_b128 a[160:163], v3 offset:16384
  ds_read_b128 a[164:167], v3 offset:17408
  v_add_f32 v226, v216, v217
  v_mfma_f32_16x16x32_bf16 v[140:143], a[132:135], v[68:71], v[204:207]
  s_mov_b32 m0, s24
  v_exp_f32 v220, v148
  v_mfma_f32_16x16x32_bf16 v[128:131], a[136:139], v[72:75], v[128:131]
  ds_read_b128 a[168:171], v3 offset:18432
  buffer_load_dwordx4 v2, s[44:47], s26 offen offset:0 sc1 lds
  v_cvt_pk_bf16_f32 v184, v216, v217
  v_mfma_f32_16x16x32_bf16 v[136:139], a[136:139], v[76:79], v[136:139]
  v_exp_f32 v221, v149
  v_mfma_f32_16x16x32_bf16 v[132:135], a[140:143], v[72:75], v[132:135]
  ds_read_b128 a[172:175], v3 offset:19456
  v_add_f32 v226, v226, v218
  v_add_f32 v226, v226, v219
  v_mfma_f32_16x16x32_bf16 v[140:143], a[140:143], v[76:79], v[140:143]
  s_waitcnt lgkmcnt(4)
  v_exp_f32 v222, v150
  v_mfma_f32_16x16x32_bf16 v[128:131], a[144:147], v[80:83], v[128:131]
  s_add_u32 s14, s13, 36864
  ds_read_b128 a[176:179], v3 offset:20480
  buffer_load_dwordx4 v[48:51], v2, s[40:43], s14 offen offset:0 sc1
  v_cvt_pk_bf16_f32 v185, v218, v219
  v_mfma_f32_16x16x32_bf16 v[136:139], a[144:147], v[84:87], v[136:139]
  v_exp_f32 v223, v151
  v_mfma_f32_16x16x32_bf16 v[132:135], a[148:151], v[80:83], v[132:135]
  ds_read_b128 a[180:183], v3 offset:21504
  buffer_load_dwordx4 v2, s[44:47], s26 offen offset:1024 sc1 lds
  v_add_f32 v226, v226, v220
  v_mfma_f32_16x16x32_bf16 v[140:143], a[148:151], v[84:87], v[140:143]
  v_exp_f32 v216, v152
  v_mfma_f32_16x16x32_bf16 v[128:131], a[152:155], v[88:91], v[128:131]
  ds_read_b128 a[184:187], v3 offset:22528
  v_add_f32 v226, v226, v221
  v_cvt_pk_bf16_f32 v186, v220, v221
  v_mfma_f32_16x16x32_bf16 v[136:139], a[152:155], v[92:95], v[136:139]
  v_exp_f32 v217, v153
  v_mfma_f32_16x16x32_bf16 v[132:135], a[156:159], v[88:91], v[132:135]
  ds_read_b128 a[188:191], v3 offset:23552
  buffer_load_dwordx4 v[52:55], v2, s[40:43], s14 offen offset:1024 sc1
  v_add_f32 v226, v226, v222
  v_mfma_f32_16x16x32_bf16 v[140:143], a[156:159], v[92:95], v[140:143]
  s_waitcnt lgkmcnt(4)
  v_exp_f32 v218, v154
  v_mfma_f32_16x16x32_bf16 a[64:67], a[160:163], v[176:179], a[64:67]
  ds_read_b128 a[128:131], v3 offset:0
  v_add_f32 v226, v226, v223
  v_cvt_pk_bf16_f32 v187, v222, v223
  v_mfma_f32_16x16x32_bf16 a[68:71], a[160:163], v[180:183], a[68:71]
  v_exp_f32 v219, v155
  v_mfma_f32_16x16x32_bf16 a[72:75], a[164:167], v[176:179], a[72:75]
  ds_read_b128 a[132:135], v3 offset:1024
  buffer_load_dwordx4 v2, s[44:47], s26 offen offset:2048 sc1 lds
  v_add_f32 v227, v216, v217
  v_mfma_f32_16x16x32_bf16 a[76:79], a[164:167], v[180:183], a[76:79]
  v_exp_f32 v220, v156
  v_mfma_f32_16x16x32_bf16 a[80:83], a[168:171], v[176:179], a[80:83]
  ds_read_b128 a[136:139], v3 offset:2048
  v_cvt_pk_bf16_f32 v188, v216, v217
  v_mfma_f32_16x16x32_bf16 a[84:87], a[168:171], v[180:183], a[84:87]
  v_exp_f32 v221, v157
  v_mfma_f32_16x16x32_bf16 a[88:91], a[172:175], v[176:179], a[88:91]
  ds_read_b128 a[140:143], v3 offset:3072
  buffer_load_dwordx4 v[56:59], v2, s[40:43], s14 offen offset:2048 sc1
  v_add_f32 v227, v227, v218
  v_add_f32 v227, v227, v219
  v_mfma_f32_16x16x32_bf16 a[92:95], a[172:175], v[180:183], a[92:95]
  s_waitcnt lgkmcnt(4)
  v_exp_f32 v222, v158
  v_mfma_f32_16x16x32_bf16 a[96:99], a[176:179], v[176:179], a[96:99]
  ds_read_b128 a[144:147], v3 offset:4096
  buffer_load_dwordx4 v2, s[44:47], s26 offen offset:3072 sc1 lds
  v_cvt_pk_bf16_f32 v189, v218, v219
  v_mfma_f32_16x16x32_bf16 a[100:103], a[176:179], v[180:183], a[100:103]
  s_add_u32 s26, s26, 16384
  v_exp_f32 v223, v159
  v_mfma_f32_16x16x32_bf16 a[104:107], a[180:183], v[176:179], a[104:107]
  s_add_u32 s24, s24, 32768
  ds_read_b128 a[148:151], v3 offset:5120
  v_add_f32 v227, v227, v220
  v_mfma_f32_16x16x32_bf16 a[108:111], a[180:183], v[180:183], a[108:111]
  s_and_b32 s24, s24, 0x1ffff
  v_add_f32 v227, v227, v221
  v_cvt_pk_bf16_f32 v190, v220, v221
  v_add_f32 v227, v227, v222
  v_mfma_f32_16x16x32_bf16 a[112:115], a[184:187], v[176:179], a[112:115]
  ds_read_b128 a[152:155], v3 offset:6144
  v_add_f32 v227, v227, v223
  v_max_f32 v5, v226, v227
  v_cmp_lt_f32 vcc, s81, v5
  v_mfma_f32_16x16x32_bf16 a[116:119], a[184:187], v[180:183], a[116:119]
  v_exp_f32 v216, v128
  v_mfma_f32_16x16x32_bf16 a[120:123], a[188:191], v[176:179], a[120:123]
  s_waitcnt lgkmcnt(3)
  ds_read_b128 a[156:159], v3 offset:7168
  v_cvt_pk_bf16_f32 v191, v222, v223
  v_mfma_f32_16x16x32_bf16 a[124:127], a[188:191], v[180:183], a[124:127]
  s_cbranch_vccnz fa_stub24
fa_back24:
  v_exp_f32 v217, v129
  v_add_f32 v230, v230, v226
  v_add_f32 v231, v231, v227
  v_mfma_f32_16x16x32_bf16 v[144:147], a[128:131], v[64:67], v[200:203]
  ds_read_b128 a[160:163], v3 offset:24576
  v_add_f32 v226, v216, v217
  v_mfma_f32_16x16x32_bf16 v[152:155], a[128:131], v[68:71], v[204:207]
  v_exp_f32 v218, v130
  v_mfma_f32_16x16x32_bf16 v[148:151], a[132:135], v[64:67], v[200:203]
  s_cmp_ge_u32 s27, s50
  s_cselect_b64 s[48:49], s[6:7], s[48:49]
  s_cselect_b32 s50, s30, s50
  ds_read_b128 a[164:167], v3 offset:25600
  v_cvt_pk_bf16_f32 v176, v216, v217
  v_mfma_f32_16x16x32_bf16 v[156:159], a[132:135], v[68:71], v[204:207]
  s_mov_b32 m0, s25
  v_exp_f32 v219, v131
  v_mfma_f32_16x16x32_bf16 v[144:147], a[136:139], v[72:75], v[144:147]
  s_add_u32 s66, s66, 32768
  ds_read_b128 a[168:171], v3 offset:26624
  buffer_load_dwordx4 v2, s[48:51], s27 offen offset:0 sc1 lds
  v_add_f32 v226, v226, v218
  v_add_f32 v226, v226, v219
  v_mfma_f32_16x16x32_bf16 v[152:155], a[136:139], v[76:79], v[152:155]
  s_and_b32 s66, s66, 0x1ffff
  v_exp_f32 v220, v132
  v_mfma_f32_16x16x32_bf16 v[148:151], a[140:143], v[72:75], v[148:151]
  ds_read_b128 a[172:175], v3 offset:27648
  v_cvt_pk_bf16_f32 v177, v218, v219
  v_mfma_f32_16x16x32_bf16 v[156:159], a[140:143], v[76:79], v[156:159]
  s_waitcnt lgkmcnt(4)
  v_exp_f32 v221, v133
  v_mfma_f32_16x16x32_bf16 v[144:147], a[144:147], v[80:83], v[144:147]
  s_add_u32 s14, s13, 36864
  ds_read_b128 a[176:179], v3 offset:28672
  buffer_load_dwordx4 v[60:63], v2, s[40:43], s14 offen offset:3072 sc1
  v_add_f32 v226, v226, v220
  v_mfma_f32_16x16x32_bf16 v[152:155], a[144:147], v[84:87], v[152:155]
  v_exp_f32 v222, v134
  v_mfma_f32_16x16x32_bf16 v[148:151], a[148:151], v[80:83], v[148:151]
  ds_read_b128 a[180:183], v3 offset:29696
  buffer_load_dwordx4 v2, s[48:51], s27 offen offset:1024 sc1 lds
  v_add_f32 v226, v226, v221
  v_cvt_pk_bf16_f32 v178, v220, v221
  v_mfma_f32_16x16x32_bf16 v[156:159], a[148:151], v[84:87], v[156:159]
  v_exp_f32 v223, v135
  v_mfma_f32_16x16x32_bf16 v[144:147], a[152:155], v[88:91], v[144:147]
  ds_read_b128 a[184:187], v3 offset:30720
  v_add_f32 v226, v226, v222
  v_mfma_f32_16x16x32_bf16 v[152:155], a[152:155], v[92:95], v[152:155]
  v_exp_f32 v216, v136
  v_mfma_f32_16x16x32_bf16 v[148:151], a[156:159], v[88:91], v[148:151]
  s_add_u32 s14, s13, 40960
  ds_read_b128 a[188:191], v3 offset:31744
  buffer_load_dwordx4 v[96:99], v2, s[40:43], s14 offen offset:0 sc1
  v_add_f32 v226, v226, v223
  v_exp_f32 v217, v137
  v_mfma_f32_16x16x32_bf16 v[156:159], a[156:159], v[92:95], v[156:159]
  s_waitcnt lgkmcnt(4)
  v_exp_f32 v218, v138
  v_mfma_f32_16x16x32_bf16 a[64:67], a[160:163], v[184:187], a[64:67]
  ds_read_b128 a[128:131], v3 offset:8192
  v_cvt_pk_bf16_f32 v179, v222, v223
  v_mfma_f32_16x16x32_bf16 a[68:71], a[160:163], v[188:191], a[68:71]
  v_exp_f32 v219, v139
  v_mfma_f32_16x16x32_bf16 a[72:75], a[164:167], v[184:187], a[72:75]
  ds_read_b128 a[132:135], v3 offset:9216
  buffer_load_dwordx4 v2, s[48:51], s27 offen offset:2048 sc1 lds
  v_add_f32 v227, v216, v217
  v_mfma_f32_16x16x32_bf16 a[76:79], a[164:167], v[188:191], a[76:79]
  v_exp_f32 v220, v140
  v_mfma_f32_16x16x32_bf16 a[80:83], a[168:171], v[184:187], a[80:83]
  ds_read_b128 a[136:139], v3 offset:10240
  v_cvt_pk_bf16_f32 v180, v216, v217
  v_mfma_f32_16x16x32_bf16 a[84:87], a[168:171], v[188:191], a[84:87]
  v_exp_f32 v221, v141
  v_mfma_f32_16x16x32_bf16 a[88:91], a[172:175], v[184:187], a[88:91]
  ds_read_b128 a[140:143], v3 offset:11264
  buffer_load_dwordx4 v[100:103], v2, s[40:43], s14 offen offset:1024 sc1
  v_add_f32 v227, v227, v218
  v_mfma_f32_16x16x32_bf16 a[92:95], a[172:175], v[188:191], a[92:95]
  s_waitcnt lgkmcnt(4)
  v_exp_f32 v222, v142
  v_mfma_f32_16x16x32_bf16 a[96:99], a[176:179], v[184:187], a[96:99]
  ds_read_b128 a[144:147], v3 offset:12288
  buffer_load_dwordx4 v2, s[48:51], s27 offen offset:3072 sc1 lds
  v_add_f32 v227, v227, v219
  v_cvt_pk_bf16_f32 v181, v218, v219
  v_mfma_f32_16x16x32_bf16 a[100:103], a[176:179], v[188:191], a[100:103]
  s_add_u32 s27, s27, 16384
  v_exp_f32 v223, v143
  v_mfma_f32_16x16x32_bf16 a[104:107], a[180:183], v[184:187], a[104:107]
  s_add_u32 s25, s25, 32768
  ds_read_b128 a[148:151], v3 offset:13312
  v_add_f32 v227, v227, v220
  v_mfma_f32_16x16x32_bf16 a[108:111], a[180:183], v[188:191], a[108:111]
  s_and_b32 s25, s25, 0x1ffff
  v_add_f32 v227, v227, v221
  v_cvt_pk_bf16_f32 v182, v220, v221
  v_add_f32 v227, v227, v222
  v_mfma_f32_16x16x32_bf16 a[112:115], a[184:187], v[184:187], a[112:115]
  ds_read_b128 a[152:155], v3 offset:14336
  v_add_f32 v227, v227, v223
  v_max_f32 v5, v226, v227
  v_cmp_lt_f32 vcc, s81, v5
  v_mfma_f32_16x16x32_bf16 a[116:119], a[184:187], v[188:191], a[116:119]
  v_exp_f32 v216, v144
  v_mfma_f32_16x16x32_bf16 a[120:123], a[188:191], v[184:187], a[120:123]
  s_waitcnt lgkmcnt(3)
  ds_read_b128 a[156:159], v3 offset:15360
  v_cvt_pk_bf16_f32 v183, v222, v223
  v_add_u32 v3, s66, v2
  v_mfma_f32_16x16x32_bf16 a[124:127], a[188:191], v[188:191], a[124:127]
  s_cbranch_vccnz fa_stub25
fa_back25:
  v_exp_f32 v217, v145
  v_add_f32 v230, v230, v226
  v_add_f32 v231, v231, v227
fa_SSW1:
  v_mfma_f32_16x16x32_bf16 v[128:131], a[128:131], v[64:67], v[200:203]
  s_waitcnt vmcnt(8)
  v_exp_f32 v218, v146
  v_mfma_f32_16x16x32_bf16 v[136:139], a[128:131], v[68:71], v[204:207]
  s_barrier
  v_exp_f32 v219, v147
  v_mfma_f32_16x16x32_bf16 v[132:135], a[132:135], v[64:67], v[200:203]
  s_cmp_ge_u32 s26, s46
  s_cselect_b64 s[44:45], s[4:5], s[44:45]
  s_cselect_b32 s46, s30, s46
  ds_read_b128 a[160:163], v3 offset:16384
  ds_read_b128 a[164:167], v3 offset:17408
  v_add_f32 v226, v216, v217
  v_mfma_f32_16x16x32_bf16 v[140:143], a[132:135], v[68:71], v[204:207]
  s_mov_b32 m0, s24
  v_exp_f32 v220, v148
  v_mfma_f32_16x16x32_bf16 v[128:131], a[136:139], v[72:75], v[128:131]
  ds_read_b128 a[168:171], v3 offset:18432
  buffer_load_dwordx4 v2, s[44:47], s26 offen offset:0 sc1 lds
  v_cvt_pk_bf16_f32 v184, v216, v217
  v_mfma_f32_16x16x32_bf16 v[136:139], a[136:139], v[76:79], v[136:139]
  v_exp_f32 v221, v149
  v_mfma_f32_16x16x32_bf16 v[132:135], a[140:143], v[72:75], v[132:135]
  ds_read_b128 a[172:175], v3 offset:19456
  v_add_f32 v226, v226, v218
  v_add_f32 v226, v226, v219
  v_mfma_f32_16x16x32_bf16 v[140:143], a[140:143], v[76:79], v[140:143]
  s_waitcnt lgkmcnt(4)
  v_exp_f32 v222, v150
  v_mfma_f32_16x16x32_bf16 v[128:131], a[144:147], v[80:83], v[128:131]
  s_add_u32 s14, s13, 40960
  ds_read_b128 a[176:179], v3 offset:20480
  buffer_load_dwordx4 v[104:107], v2, s[40:43], s14 offen offset:2048 sc1
  v_cvt_pk_bf16_f32 v185, v218, v219
  v_mfma_f32_16x16x32_bf16 v[136:139], a[144:147], v[84:87], v[136:139]
  v_exp_f32 v223, v151
  v_mfma_f32_16x16x32_bf16 v[132:135], a[148:151], v[80:83], v[132:135]
  ds_read_b128 a[180:183], v3 offset:21504
  buffer_load_dwordx4 v2, s[44:47], s26 offen offset:1024 sc1 lds
  v_add_f32 v226, v226, v220
  v_mfma_f32_16x16x32_bf16 v[140:143], a[148:151], v[84:87], v[140:143]
  v_exp_f32 v216, v152
  v_mfma_f32_16x16x32_bf16 v[128:131], a[152:155], v[88:91], v[128:131]
  ds_read_b128 a[184:187], v3 offset:22528
  v_add_f32 v226, v226, v221
  v_cvt_pk_bf16_f32 v186, v220, v221
  v_mfma_f32_16x16x32_bf16 v[136:139], a[152:155], v[92:95], v[136:139]
  v_exp_f32 v217, v153
  v_mfma_f32_16x16x32_bf16 v[132:135], a[156:159], v[88:91], v[132:135]
  ds_read_b128 a[188:191], v3 offset:23552
  buffer_load_dwordx4 v[108:111], v2, s[40:43], s14 offen offset:3072 sc1
  v_add_f32 v226, v226, v222
  v_mfma_f32_16x16x32_bf16 v[140:143], a[156:159], v[92:95], v[140:143]
  s_waitcnt lgkmcnt(4)
  v_exp_f32 v218, v154
  v_mfma_f32_16x16x32_bf16 a[64:67], a[160:163], v[176:179], a[64:67]
  ds_read_b128 a[128:131], v3 offset:0
  v_add_f32 v226, v226, v223
  v_cvt_pk_bf16_f32 v187, v222, v223
  v_mfma_f32_16x16x32_bf16 a[68:71], a[160:163], v[180:183], a[68:71]
  v_exp_f32 v219, v155
  v_mfma_f32_16x16x32_bf16 a[72:75], a[164:167], v[176:179], a[72:75]
  ds_read_b128 a[132:135], v3 offset:1024
  buffer_load_dwordx4 v2, s[44:47], s26 offen offset:2048 sc1 lds
  v_add_f32 v227, v216, v217
  v_mfma_f32_16x16x32_bf16 a[76:79], a[164:167], v[180:183], a[76:79]
  v_exp_f32 v220, v156
  v_mfma_f32_16x16x32_bf16 a[80:83], a[168:171], v[176:179], a[80:83]
  ds_read_b128 a[136:139], v3 offset:2048
  v_cvt_pk_bf16_f32 v188, v216, v217
  v_mfma_f32_16x16x32_bf16 a[84:87], a[168:171], v[180:183], a[84:87]
  v_exp_f32 v221, v157
  v_mfma_f32_16x16x32_bf16 a[88:91], a[172:175], v[176:179], a[88:91]
  s_add_u32 s14, s13, 45056
  ds_read_b128 a[140:143], v3 offset:3072
  buffer_load_dwordx4 v[112:115], v2, s[40:43], s14 offen offset:0 sc1
  v_add_f32 v227, v227, v218
  v_add_f32 v227, v227, v219
  v_mfma_f32_16x16x32_bf16 a[92:95], a[172:175], v[180:183], a[92:95]
  s_waitcnt lgkmcnt(4)
  v_exp_f32 v222, v158
  v_mfma_f32_16x16x32_bf16 a[96:99], a[176:179], v[176:179], a[96:99]
  ds_read_b128 a[144:147], v3 offset:4096
  buffer_load_dwordx4 v2, s[44:47], s26 offen offset:3072 sc1 lds
  v_cvt_pk_bf16_f32 v189, v218, v219
  v_mfma_f32_16x16x32_bf16 a[100:103], a[176:179], v[180:183], a[100:103]
  s_add_u32 s26, s26, 16384
  v_exp_f32 v223, v159
  v_mfma_f32_16x16x32_bf16 a[104:107], a[180:183], v[176:179], a[104:107]
  s_add_u32 s24, s24, 32768
  ds_read_b128 a[148:151], v3 offset:5120
  v_add_f32 v227, v227, v220
  v_mfma_f32_16x16x32_bf16 a[108:111], a[180:183], v[180:183], a[108:111]
  s_and_b32 s24, s24, 0x1ffff
  v_add_f32 v227, v227, v221
  v_cvt_pk_bf16_f32 v190, v220, v221
  v_add_f32 v227, v227, v222
  v_mfma_f32_16x16x32_bf16 a[112:115], a[184:187], v[176:179], a[112:115]
  ds_read_b128 a[152:155], v3 offset:6144
  v_add_f32 v227, v227, v223
  v_max_f32 v5, v226, v227
  v_cmp_lt_f32 vcc, s81, v5
  v_mfma_f32_16x16x32_bf16 a[116:119], a[184:187], v[180:183], a[116:119]
  v_exp_f32 v216, v128
  v_mfma_f32_16x16x32_bf16 a[120:123], a[188:191], v[176:179], a[120:123]
  s_waitcnt lgkmcnt(3)
  ds_read_b128 a[156:159], v3 offset:7168
  v_cvt_pk_bf16_f32 v191, v222, v223
  v_mfma_f32_16x16x32_bf16 a[124:127], a[188:191], v[180:183], a[124:127]
  s_cbranch_vccnz fa_stub26
fa_back26:
  v_exp_f32 v217, v129
  v_add_f32 v230, v230, v226
  v_add_f32 v231, v231, v227
  v_mfma_f32_16x16x32_bf16 v[144:147], a[128:131], v[64:67], v[200:203]
  ds_read_b128 a[160:163], v3 offset:24576
  v_add_f32 v226, v216, v217
  v_mfma_f32_16x16x32_bf16 v[152:155], a[128:131], v[68:71], v[204:207]
  v_exp_f32 v218, v130
  v_mfma_f32_16x16x32_bf16 v[148:151], a[132:135], v[64:67], v[200:203]
  s_cmp_ge_u32 s27, s50
  s_cselect_b64 s[48:49], s[6:7], s[48:49]
  s_cselect_b32 s50, s30, s50
  ds_read_b128 a[164:167], v3 offset:25600
  v_cvt_pk_bf16_f32 v176, v216, v217
  v_mfma_f32_16x16x32_bf16 v[156:159], a[132:135], v[68:71], v[204:207]
  s_mov_b32 m0, s25
  v_exp_f32 v219, v131
  v_mfma_f32_16x16x32_bf16 v[144:147], a[136:139], v[72:75], v[144:147]
  s_add_u32 s66, s66, 32768
  ds_read_b128 a[168:171], v3 offset:26624
  buffer_load_dwordx4 v2, s[48:51], s27 offen offset:0 sc1 lds
  v_add_f32 v226, v226, v218
  v_add_f32 v226, v226, v219
  v_mfma_f32_16x16x32_bf16 v[152:155], a[136:139], v[76:79], v[152:155]
  s_and_b32 s66, s66, 0x1ffff
  v_exp_f32 v220, v132
  v_mfma_f32_16x16x32_bf16 v[148:151], a[140:143], v[72:75], v[148:151]
  ds_read_b128 a[172:175], v3 offset:27648
  v_cvt_pk_bf16_f32 v177, v218, v219
  v_mfma_f32_16x16x32_bf16 v[156:159], a[140:143], v[76:79], v[156:159]
  s_waitcnt lgkmcnt(4)
  v_exp_f32 v221, v133
  v_mfma_f32_16x16x32_bf16 v[144:147], a[144:147], v[80:83], v[144:147]
  s_add_u32 s14, s13, 45056
  ds_read_b128 a[176:179], v3 offset:28672
  buffer_load_dwordx4 v[116:119], v2, s[40:43], s14 offen offset:1024 sc1
  v_add_f32 v226, v226, v220
  v_mfma_f32_16x16x32_bf16 v[152:155], a[144:147], v[84:87], v[152:155]
  v_exp_f32 v222, v134
  v_mfma_f32_16x16x32_bf16 v[148:151], a[148:151], v[80:83], v[148:151]
  ds_read_b128 a[180:183], v3 offset:29696
  buffer_load_dwordx4 v2, s[48:51], s27 offen offset:1024 sc1 lds
  v_add_f32 v226, v226, v221
  v_cvt_pk_bf16_f32 v178, v220, v221
  v_mfma_f32_16x16x32_bf16 v[156:159], a[148:151], v[84:87], v[156:159]
  v_exp_f32 v223, v135
  v_mfma_f32_16x16x32_bf16 v[144:147], a[152:155], v[88:91], v[144:147]
  ds_read_b128 a[184:187], v3 offset:30720
  v_add_f32 v226, v226, v222
  v_mfma_f32_16x16x32_bf16 v[152:155], a[152:155], v[92:95], v[152:155]
  v_exp_f32 v216, v136
  v_mfma_f32_16x16x32_bf16 v[148:151], a[156:159], v[88:91], v[148:151]
  ds_read_b128 a[188:191], v3 offset:31744
  buffer_load_dwordx4 v[120:123], v2, s[40:43], s14 offen offset:2048 sc1
  v_add_f32 v226, v226, v223
  v_exp_f32 v217, v137
  v_mfma_f32_16x16x32_bf16 v[156:159], a[156:159], v[92:95], v[156:159]
  s_waitcnt lgkmcnt(4)
  v_exp_f32 v218, v138
  v_mfma_f32_16x16x32_bf16 a[64:67], a[160:163], v[184:187], a[64:67]
  ds_read_b128 a[128:131], v3 offset:8192
  v_cvt_pk_bf16_f32 v179, v222, v223
  v_mfma_f32_16x16x32_bf16 a[68:71], a[160:163], v[188:191], a[68:71]
  v_exp_f32 v219, v139
  v_mfma_f32_16x16x32_bf16 a[72:75], a[164:167], v[184:187], a[72:75]
  ds_read_b128 a[132:135], v3 offset:9216
  buffer_load_dwordx4 v2, s[48:51], s27 offen offset:2048 sc1 lds
  v_add_f32 v227, v216, v217
  v_mfma_f32_16x16x32_bf16 a[76:79], a[164:167], v[188:191], a[76:79]
  v_exp_f32 v220, v140
  v_mfma_f32_16x16x32_bf16 a[80:83], a[168:171], v[184:187], a[80:83]
  ds_read_b128 a[136:139], v3 offset:10240
  v_cvt_pk_bf16_f32 v180, v216, v217
  v_mfma_f32_16x16x32_bf16 a[84:87], a[168:171], v[188:191], a[84:87]
  v_exp_f32 v221, v141
  v_mfma_f32_16x16x32_bf16 a[88:91], a[172:175], v[184:187], a[88:91]
  ds_read_b128 a[140:143], v3 offset:11264
  buffer_load_dwordx4 v[124:127], v2, s[40:43], s14 offen offset:3072 sc1
  v_add_f32 v227, v227, v218
  v_mfma_f32_16x16x32_bf16 a[92:95], a[172:175], v[188:191], a[92:95]
  s_waitcnt lgkmcnt(4)
  v_exp_f32 v222, v142
  v_mfma_f32_16x16x32_bf16 a[96:99], a[176:179], v[184:187], a[96:99]
  ds_read_b128 a[144:147], v3 offset:12288
  buffer_load_dwordx4 v2, s[48:51], s27 offen offset:3072 sc1 lds
  v_add_f32 v227, v227, v219
  v_cvt_pk_bf16_f32 v181, v218, v219
  v_mfma_f32_16x16x32_bf16 a[100:103], a[176:179], v[188:191], a[100:103]
  s_add_u32 s27, s27, 16384
  v_exp_f32 v223, v143
  v_mfma_f32_16x16x32_bf16 a[104:107], a[180:183], v[184:187], a[104:107]
  s_add_u32 s25, s25, 32768
  ds_read_b128 a[148:151], v3 offset:13312
  v_add_f32 v227, v227, v220
  v_mfma_f32_16x16x32_bf16 a[108:111], a[180:183], v[188:191], a[108:111]
  s_and_b32 s25, s25, 0x1ffff
  v_add_f32 v227, v227, v221
  v_cvt_pk_bf16_f32 v182, v220, v221
  v_add_f32 v227, v227, v222
  v_mfma_f32_16x16x32_bf16 a[112:115], a[184:187], v[184:187], a[112:115]
  ds_read_b128 a[152:155], v3 offset:14336
  v_add_f32 v227, v227, v223
  v_max_f32 v5, v226, v227
  v_cmp_lt_f32 vcc, s81, v5
  v_mfma_f32_16x16x32_bf16 a[116:119], a[184:187], v[188:191], a[116:119]
  v_exp_f32 v216, v144
  v_mfma_f32_16x16x32_bf16 a[120:123], a[188:191], v[184:187], a[120:123]
  s_waitcnt lgkmcnt(3)
  ds_read_b128 a[156:159], v3 offset:15360
  v_cvt_pk_bf16_f32 v183, v222, v223
  v_add_u32 v3, s66, v2
  v_mfma_f32_16x16x32_bf16 a[124:127], a[188:191], v[188:191], a[124:127]
  s_cbranch_vccnz fa_stub27
fa_back27:
  v_exp_f32 v217, v145
  v_add_f32 v230, v230, v226
  v_add_f32 v231, v231, v227
fa_Bexit:
  s_bitcmp1_b32 s20, 0
  s_cbranch_scc1 fa_Bodd
  v_mfma_f32_16x16x32_bf16 v[128:131], a[128:131], v[64:67], v[200:203]
  s_waitcnt vmcnt(8)
  v_exp_f32 v218, v146
  v_mfma_f32_16x16x32_bf16 v[136:139], a[128:131], v[68:71], v[204:207]
  s_barrier
  v_exp_f32 v219, v147
  v_mfma_f32_16x16x32_bf16 v[132:135], a[132:135], v[64:67], v[200:203]
  ds_read_b128 a[160:163], v3 offset:16384
  ds_read_b128 a[164:167], v3 offset:17408
  v_add_f32 v226, v216, v217
  v_mfma_f32_16x16x32_bf16 v[140:143], a[132:135], v[68:71], v[204:207]
  s_add_u32 s14, s13, 49152
  buffer_load_dwordx4 v[160:163], v2, s[40:43], s14 offen offset:0 sc1
  v_cvt_pk_bf16_f32 v184, v216, v217
  v_mfma_f32_16x16x32_bf16 v[128:131], a[136:139], v[72:75], v[128:131]
  ds_read_b128 a[168:171], v3 offset:18432
  v_add_f32 v226, v226, v218
  v_mfma_f32_16x16x32_bf16 v[136:139], a[136:139], v[76:79], v[136:139]
  v_exp_f32 v220, v148
  v_mfma_f32_16x16x32_bf16 v[132:135], a[140:143], v[72:75], v[132:135]
  ds_read_b128 a[172:175], v3 offset:19456
  v_add_f32 v226, v226, v219
  v_cvt_pk_bf16_f32 v185, v218, v219
  v_mfma_f32_16x16x32_bf16 v[140:143], a[140:143], v[76:79], v[140:143]
  s_waitcnt lgkmcnt(4)
  buffer_load_dwordx4 v[164:167], v2, s[40:43], s14 offen offset:1024 sc1
  v_add_f32 v226, v226, v220
  v_mfma_f32_16x16x32_bf16 v[128:131], a[144:147], v[80:83], v[128:131]
  ds_read_b128 a[176:179], v3 offset:20480
  v_mfma_f32_16x16x32_bf16 v[136:139], a[144:147], v[84:87], v[136:139]
  v_exp_f32 v221, v149
  v_mfma_f32_16x16x32_bf16 v[132:135], a[148:151], v[80:83], v[132:135]
  ds_read_b128 a[180:183], v3 offset:21504
  v_add_f32 v226, v226, v221
  v_mfma_f32_16x16x32_bf16 v[140:143], a[148:151], v[84:87], v[140:143]
  v_exp_f32 v222, v150
  v_mfma_f32_16x16x32_bf16 v[128:131], a[152:155], v[88:91], v[128:131]
  ds_read_b128 a[184:187], v3 offset:22528
  buffer_load_dwordx4 v[168:171], v2, s[40:43], s14 offen offset:2048 sc1
  v_cvt_pk_bf16_f32 v186, v220, v221
  v_mfma_f32_16x16x32_bf16 v[136:139], a[152:155], v[92:95], v[136:139]
  v_exp_f32 v223, v151
  v_mfma_f32_16x16x32_bf16 v[132:135], a[156:159], v[88:91], v[132:135]
  ds_read_b128 a[188:191], v3 offset:23552
  v_add_f32 v226, v226, v222
  v_add_f32 v226, v226, v223
  v_mfma_f32_16x16x32_bf16 v[140:143], a[156:159], v[92:95], v[140:143]
  s_waitcnt lgkmcnt(4)
  v_exp_f32 v216, v152
  v_mfma_f32_16x16x32_bf16 a[64:67], a[160:163], v[176:179], a[64:67]
  v_exp_f32 v217, v153
  v_mfma_f32_16x16x32_bf16 a[68:71], a[160:163], v[180:183], a[68:71]
  buffer_load_dwordx4 v[172:175], v2, s[40:43], s14 offen offset:3072 sc1
  v_cvt_pk_bf16_f32 v187, v222, v223
  v_add_f32 v227, v216, v217
  v_mfma_f32_16x16x32_bf16 a[72:75], a[164:167], v[176:179], a[72:75]
  v_exp_f32 v218, v154
  v_mfma_f32_16x16x32_bf16 a[76:79], a[164:167], v[180:183], a[76:79]
  v_exp_f32 v219, v155
  v_mfma_f32_16x16x32_bf16 a[80:83], a[168:171], v[176:179], a[80:83]
  v_exp_f32 v220, v156
  v_mfma_f32_16x16x32_bf16 a[84:87], a[168:171], v[180:183], a[84:87]
  s_add_u32 s14, s13, 53248
  buffer_load_dwordx4 v[192:195], v2, s[40:43], s14 offen offset:0 sc1
  v_cvt_pk_bf16_f32 v188, v216, v217
  v_add_f32 v227, v227, v218
  v_mfma_f32_16x16x32_bf16 a[88:91], a[172:175], v[176:179], a[88:91]
  v_exp_f32 v221, v157
  v_mfma_f32_16x16x32_bf16 a[92:95], a[172:175], v[180:183], a[92:95]
  s_waitcnt lgkmcnt(0)
  v_exp_f32 v222, v158
  v_mfma_f32_16x16x32_bf16 a[96:99], a[176:179], v[176:179], a[96:99]
  v_add_f32 v227, v227, v219
  v_cvt_pk_bf16_f32 v189, v218, v219
  v_mfma_f32_16x16x32_bf16 a[100:103], a[176:179], v[180:183], a[100:103]
  v_exp_f32 v223, v159
  v_mfma_f32_16x16x32_bf16 a[104:107], a[180:183], v[176:179], a[104:107]
  buffer_load_dwordx4 v[196:199], v2, s[40:43], s14 offen offset:1024 sc1
  v_add_f32 v227, v227, v220
  v_mfma_f32_16x16x32_bf16 a[108:111], a[180:183], v[180:183], a[108:111]
  v_add_f32 v227, v227, v221
  v_cvt_pk_bf16_f32 v190, v220, v221
  v_add_f32 v227, v227, v222
  v_mfma_f32_16x16x32_bf16 a[112:115], a[184:187], v[176:179], a[112:115]
  v_add_f32 v227, v227, v223
  v_max_f32 v5, v226, v227
  v_cmp_lt_f32 vcc, s81, v5
  v_mfma_f32_16x16x32_bf16 a[116:119], a[184:187], v[180:183], a[116:119]
  v_exp_f32 v216, v128
  v_mfma_f32_16x16x32_bf16 a[120:123], a[188:191], v[176:179], a[120:123]
  v_cvt_pk_bf16_f32 v191, v222, v223
  v_mfma_f32_16x16x32_bf16 a[124:127], a[188:191], v[180:183], a[124:127]
  s_cbranch_vccnz fa_stub28
fa_back28:
  v_exp_f32 v217, v129
  v_add_f32 v230, v230, v226
  v_add_f32 v231, v231, v227
  ds_read_b128 a[160:163], v3 offset:24576
  ds_read_b128 a[164:167], v3 offset:25600
  ds_read_b128 a[168:171], v3 offset:26624
  ds_read_b128 a[172:175], v3 offset:27648
  ds_read_b128 a[176:179], v3 offset:28672
  ds_read_b128 a[180:183], v3 offset:29696
  ds_read_b128 a[184:187], v3 offset:30720
  ds_read_b128 a[188:191], v3 offset:31744
  v_cndmask_b32 v128, v4, v128, s[68:69]
  v_cndmask_b32 v129, v4, v129, s[70:71]
  v_cndmask_b32 v130, v4, v130, s[72:73]
  v_cndmask_b32 v131, v4, v131, s[74:75]
  v_mov_b32 v132, v4
  v_mov_b32 v133, v4
  v_mov_b32 v134, v4
  v_mov_b32 v135, v4
  v_cndmask_b32 v140, v4, v140, s[68:69]
  v_cndmask_b32 v141, v4, v141, s[70:71]
  v_cndmask_b32 v142, v4, v142, s[72:73]
  v_cndmask_b32 v143, v4, v143, s[74:75]
  v_exp_f32 v216, v128
  v_exp_f32 v217, v129
  v_exp_f32 v218, v130
  v_add_f32 v226, v216, v217
  v_cvt_pk_bf16_f32 v176, v216, v217
  v_add_f32 v226, v226, v218
  v_exp_f32 v219, v131
  v_exp_f32 v220, v132
  v_add_f32 v226, v226, v219
  v_cvt_pk_bf16_f32 v177, v218, v219
  v_add_f32 v226, v226, v220
  v_exp_f32 v221, v133
  s_waitcnt lgkmcnt(4)
  v_mfma_f32_16x16x32_bf16 a[64:67], a[160:163], v[184:187], a[64:67]
  v_exp_f32 v222, v134
  v_add_f32 v226, v226, v221
  v_mfma_f32_16x16x32_bf16 a[68:71], a[160:163], v[188:191], a[68:71]
  s_add_u32 s14, s13, 53248
  buffer_load_dwordx4 v[208:211], v2, s[40:43], s14 offen offset:2048 sc1
  v_exp_f32 v223, v135
  v_mfma_f32_16x16x32_bf16 a[72:75], a[164:167], v[184:187], a[72:75]
  s_add_u32 s66, s66, 32768
  v_exp_f32 v216, v136
  v_mfma_f32_16x16x32_bf16 a[76:79], a[164:167], v[188:191], a[76:79]
  s_and_b32 s66, s66, 0x1ffff
  v_exp_f32 v217, v137
  v_mfma_f32_16x16x32_bf16 a[80:83], a[168:171], v[184:187], a[80:83]
  buffer_load_dwordx4 v[212:215], v2, s[40:43], s14 offen offset:3072 sc1
  v_cvt_pk_bf16_f32 v178, v220, v221
  v_add_f32 v226, v226, v222
  v_add_f32 v226, v226, v223
  v_cvt_pk_bf16_f32 v179, v222, v223
  v_mfma_f32_16x16x32_bf16 a[84:87], a[168:171], v[188:191], a[84:87]
  v_exp_f32 v218, v138
  v_mfma_f32_16x16x32_bf16 a[88:91], a[172:175], v[184:187], a[88:91]
  v_exp_f32 v219, v139
  v_mfma_f32_16x16x32_bf16 a[92:95], a[172:175], v[188:191], a[92:95]
  s_waitcnt lgkmcnt(0)
  v_exp_f32 v220, v140
  v_mfma_f32_16x16x32_bf16 a[96:99], a[176:179], v[184:187], a[96:99]
  s_add_u32 s14, s13, 57344
  buffer_load_dwordx4 v[232:235], v2, s[40:43], s14 offen offset:0 sc1
  v_add_f32 v227, v216, v217
  v_cvt_pk_bf16_f32 v180, v216, v217
  v_add_f32 v227, v227, v218
  v_add_f32 v227, v227, v219
  v_cvt_pk_bf16_f32 v181, v218, v219
  v_exp_f32 v221, v141
  v_mfma_f32_16x16x32_bf16 a[100:103], a[176:179], v[188:191], a[100:103]
  v_exp_f32 v222, v142
  v_mfma_f32_16x16x32_bf16 a[104:107], a[180:183], v[184:187], a[104:107]
  v_exp_f32 v223, v143
  v_mfma_f32_16x16x32_bf16 a[108:111], a[180:183], v[188:191], a[108:111]
  buffer_load_dwordx4 v[236:239], v2, s[40:43], s14 offen offset:1024 sc1
  v_add_f32 v227, v227, v220
  v_add_f32 v227, v227, v221
  v_cvt_pk_bf16_f32 v182, v220, v221
  v_add_f32 v227, v227, v222
  v_mfma_f32_16x16x32_bf16 a[112:115], a[184:187], v[184:187], a[112:115]
  v_add_f32 v227, v227, v223
  v_max_f32 v5, v226, v227
  v_cmp_lt_f32 vcc, s81, v5
  v_mfma_f32_16x16x32_bf16 a[116:119], a[184:187], v[188:191], a[116:119]
  v_mfma_f32_16x16x32_bf16 a[120:123], a[188:191], v[184:187], a[120:123]
  v_cvt_pk_bf16_f32 v183, v222, v223
  v_add_u32 v3, s66, v2
  v_mfma_f32_16x16x32_bf16 a[124:127], a[188:191], v[188:191], a[124:127]
  s_cbranch_vccnz fa_stub29
fa_back29:
  v_add_f32 v230, v230, v226
  v_add_f32 v231, v231, v227
  s_cmp_ge_u32 s20, 2
  s_cbranch_scc1 fa_nb0
  s_waitcnt vmcnt(10)
  s_barrier
fa_nb0:
  ds_read_b128 a[160:163], v3 offset:16384
  ds_read_b128 a[164:167], v3 offset:17408
  ds_read_b128 a[168:171], v3 offset:18432
  ds_read_b128 a[172:175], v3 offset:19456
  ds_read_b128 a[176:179], v3 offset:20480
  ds_read_b128 a[180:183], v3 offset:21504
  ds_read_b128 a[184:187], v3 offset:22528
  ds_read_b128 a[188:191], v3 offset:23552
  s_waitcnt lgkmcnt(4)
  v_mfma_f32_16x16x32_bf16 a[64:67], a[160:163], v[176:179], a[64:67]
  v_mfma_f32_16x16x32_bf16 a[68:71], a[160:163], v[180:183], a[68:71]
  s_add_u32 s14, s13, 57344
  buffer_load_dwordx4 v[240:243], v2, s[40:43], s14 offen offset:2048 sc1
  v_mfma_f32_16x16x32_bf16 a[72:75], a[164:167], v[176:179], a[72:75]
  v_mfma_f32_16x16x32_bf16 a[76:79], a[164:167], v[180:183], a[76:79]
  v_mfma_f32_16x16x32_bf16 a[80:83], a[168:171], v[176:179], a[80:83]
  v_mfma_f32_16x16x32_bf16 a[84:87], a[168:171], v[180:183], a[84:87]
  v_mfma_f32_16x16x32_bf16 a[88:91], a[172:175], v[176:179], a[88:91]
  v_mfma_f32_16x16x32_bf16 a[92:95], a[172:175], v[180:183], a[92:95]
  s_waitcnt lgkmcnt(0)
  v_mfma_f32_16x16x32_bf16 a[96:99], a[176:179], v[176:179], a[96:99]
  buffer_load_dwordx4 v[244:247], v2, s[40:43], s14 offen offset:3072 sc1
  v_mfma_f32_16x16x32_bf16 a[100:103], a[176:179], v[180:183], a[100:103]
  v_mfma_f32_16x16x32_bf16 a[104:107], a[180:183], v[176:179], a[104:107]
  v_mfma_f32_16x16x32_bf16 a[108:111], a[180:183], v[180:183], a[108:111]
  v_mfma_f32_16x16x32_bf16 a[112:115], a[184:187], v[176:179], a[112:115]
  v_mfma_f32_16x16x32_bf16 a[116:119], a[184:187], v[180:183], a[116:119]
  v_mfma_f32_16x16x32_bf16 a[120:123], a[188:191], v[176:179], a[120:123]
  v_mfma_f32_16x16x32_bf16 a[124:127], a[188:191], v[180:183], a[124:127]
  s_branch fa_Bdone
fa_Bodd:
  s_cmp_ge_u32 s20, 2
  s_cbranch_scc1 fa_nb1
  s_waitcnt vmcnt(8)
  s_barrier
fa_nb1:
  ds_read_b128 a[160:163], v3 offset:16384
  ds_read_b128 a[164:167], v3 offset:17408
  ds_read_b128 a[168:171], v3 offset:18432
  ds_read_b128 a[172:175], v3 offset:19456
  ds_read_b128 a[176:179], v3 offset:20480
  ds_read_b128 a[180:183], v3 offset:21504
  ds_read_b128 a[184:187], v3 offset:22528
  ds_read_b128 a[188:191], v3 offset:23552
  v_cndmask_b32 v144, v4, v144, s[68:69]
  v_cndmask_b32 v145, v4, v145, s[70:71]
  v_cndmask_b32 v146, v4, v146, s[72:73]
  v_cndmask_b32 v147, v4, v147, s[74:75]
  v_mov_b32 v148, v4
  v_mov_b32 v149, v4
  v_mov_b32 v150, v4
  v_mov_b32 v151, v4
  v_cndmask_b32 v156, v4, v156, s[68:69]
  v_cndmask_b32 v157, v4, v157, s[70:71]
  v_cndmask_b32 v158, v4, v158, s[72:73]
  v_cndmask_b32 v159, v4, v159, s[74:75]
  v_exp_f32 v216, v144
  v_exp_f32 v217, v145
  v_exp_f32 v218, v146
  v_add_f32 v226, v216, v217
  v_cvt_pk_bf16_f32 v184, v216, v217
  v_add_f32 v226, v226, v218
  v_exp_f32 v219, v147
  v_exp_f32 v220, v148
  v_add_f32 v226, v226, v219
  v_cvt_pk_bf16_f32 v185, v218, v219
  v_add_f32 v226, v226, v220
  v_exp_f32 v221, v149
  s_waitcnt lgkmcnt(4)
  v_mfma_f32_16x16x32_bf16 a[64:67], a[160:163], v[176:179], a[64:67]
  v_exp_f32 v222, v150
  v_add_f32 v226, v226, v221
  v_mfma_f32_16x16x32_bf16 a[68:71], a[160:163], v[180:183], a[68:71]
  s_add_u32 s14, s13, 49152
  buffer_load_dwordx4 v[160:163], v2, s[40:43], s14 offen offset:0 sc1
  v_exp_f32 v223, v151
  v_mfma_f32_16x16x32_bf16 a[72:75], a[164:167], v[176:179], a[72:75]
  v_exp_f32 v216, v152
  v_cvt_pk_bf16_f32 v186, v220, v221
  v_add_f32 v226, v226, v222
  v_mfma_f32_16x16x32_bf16 a[76:79], a[164:167], v[180:183], a[76:79]
  buffer_load_dwordx4 v[164:167], v2, s[40:43], s14 offen offset:1024 sc1
  v_exp_f32 v217, v153
  v_mfma_f32_16x16x32_bf16 a[80:83], a[168:171], v[176:179], a[80:83]
  v_exp_f32 v218, v154
  v_add_f32 v226, v226, v223
  v_mfma_f32_16x16x32_bf16 a[84:87], a[168:171], v[180:183], a[84:87]
  buffer_load_dwordx4 v[168:171], v2, s[40:43], s14 offen offset:2048 sc1
  v_exp_f32 v219, v155
  v_cvt_pk_bf16_f32 v187, v222, v223
  v_mfma_f32_16x16x32_bf16 a[88:91], a[172:175], v[176:179], a[88:91]
  v_exp_f32 v220, v156
  v_mfma_f32_16x16x32_bf16 a[92:95], a[172:175], v[180:183], a[92:95]
  s_waitcnt lgkmcnt(0)
  buffer_load_dwordx4 v[172:175], v2, s[40:43], s14 offen offset:3072 sc1
  v_add_f32 v227, v216, v217
  v_cvt_pk_bf16_f32 v188, v216, v217
  v_add_f32 v227, v227, v218
  v_mfma_f32_16x16x32_bf16 a[96:99], a[176:179], v[176:179], a[96:99]
  v_exp_f32 v221, v157
  v_mfma_f32_16x16x32_bf16 a[100:103], a[176:179], v[180:183], a[100:103]
  s_add_u32 s14, s13, 53248
  buffer_load_dwordx4 v[192:195], v2, s[40:43], s14 offen offset:0 sc1
  v_exp_f32 v222, v158
  v_mfma_f32_16x16x32_bf16 a[104:107], a[180:183], v[176:179], a[104:107]
  v_exp_f32 v223, v159
  v_mfma_f32_16x16x32_bf16 a[108:111], a[180:183], v[180:183], a[108:111]
  buffer_load_dwordx4 v[196:199], v2, s[40:43], s14 offen offset:1024 sc1
  v_add_f32 v227, v227, v219
  v_cvt_pk_bf16_f32 v189, v218, v219
  v_add_f32 v227, v227, v220
  v_add_f32 v227, v227, v221
  v_cvt_pk_bf16_f32 v190, v220, v221
  v_add_f32 v227, v227, v222
  v_mfma_f32_16x16x32_bf16 a[112:115], a[184:187], v[176:179], a[112:115]
  v_add_f32 v227, v227, v223
  v_max_f32 v5, v226, v227
  v_cmp_lt_f32 vcc, s81, v5
  v_mfma_f32_16x16x32_bf16 a[116:119], a[184:187], v[180:183], a[116:119]
  buffer_load_dwordx4 v[208:211], v2, s[40:43], s14 offen offset:2048 sc1
  v_mfma_f32_16x16x32_bf16 a[120:123], a[188:191], v[176:179], a[120:123]
  v_cvt_pk_bf16_f32 v191, v222, v223
  v_mfma_f32_16x16x32_bf16 a[124:127], a[188:191], v[180:183], a[124:127]
  s_cbranch_vccnz fa_stub30
fa_back30:
  v_add_f32 v230, v230, v226
  v_add_f32 v231, v231, v227
  ds_read_b128 a[160:163], v3 offset:24576
  ds_read_b128 a[164:167], v3 offset:25600
  ds_read_b128 a[168:171], v3 offset:26624
  ds_read_b128 a[172:175], v3 offset:27648
  ds_read_b128 a[176:179], v3 offset:28672
  ds_read_b128 a[180:183], v3 offset:29696
  ds_read_b128 a[184:187], v3 offset:30720
  ds_read_b128 a[188:191], v3 offset:31744
  s_waitcnt lgkmcnt(4)
  v_mfma_f32_16x16x32_bf16 a[64:67], a[160:163], v[184:187], a[64:67]
  v_mfma_f32_16x16x32_bf16 a[68:71], a[160:163], v[188:191], a[68:71]
  s_add_u32 s14, s13, 53248
  buffer_load_dwordx4 v[212:215], v2, s[40:43], s14 offen offset:3072 sc1
  v_mfma_f32_16x16x32_bf16 a[72:75], a[164:167], v[184:187], a[72:75]
  s_add_u32 s66, s66, 32768
  v_mfma_f32_16x16x32_bf16 a[76:79], a[164:167], v[188:191], a[76:79]
  s_add_u32 s14, s13, 57344
  buffer_load_dwordx4 v[232:235], v2, s[40:43], s14 offen offset:0 sc1
  v_mfma_f32_16x16x32_bf16 a[80:83], a[168:171], v[184:187], a[80:83]
  s_and_b32 s66, s66, 0x1ffff
  v_mfma_f32_16x16x32_bf16 a[84:87], a[168:171], v[188:191], a[84:87]
  v_mfma_f32_16x16x32_bf16 a[88:91], a[172:175], v[184:187], a[88:91]
  buffer_load_dwordx4 v[236:239], v2, s[40:43], s14 offen offset:1024 sc1
  v_mfma_f32_16x16x32_bf16 a[92:95], a[172:175], v[188:191], a[92:95]
  s_waitcnt lgkmcnt(0)
  v_mfma_f32_16x16x32_bf16 a[96:99], a[176:179], v[184:187], a[96:99]
  v_mfma_f32_16x16x32_bf16 a[100:103], a[176:179], v[188:191], a[100:103]
  buffer_load_dwordx4 v[240:243], v2, s[40:43], s14 offen offset:2048 sc1
  v_mfma_f32_16x16x32_bf16 a[104:107], a[180:183], v[184:187], a[104:107]
  v_mfma_f32_16x16x32_bf16 a[108:111], a[180:183], v[188:191], a[108:111]
  v_mfma_f32_16x16x32_bf16 a[112:115], a[184:187], v[184:187], a[112:115]
  buffer_load_dwordx4 v[244:247], v2, s[40:43], s14 offen offset:3072 sc1
  v_mfma_f32_16x16x32_bf16 a[116:119], a[184:187], v[188:191], a[116:119]
  v_mfma_f32_16x16x32_bf16 a[120:123], a[188:191], v[184:187], a[120:123]
  v_add_u32 v3, s66, v2
  v_mfma_f32_16x16x32_bf16 a[124:127], a[188:191], v[188:191], a[124:127]
fa_Bdone:
fa_epi:
  v_mov_b32 v20, v230
  v_mov_b32 v21, v231
  s_nop 1
  v_permlane16_swap_b32 v230, v20
  v_permlane16_swap_b32 v231, v21
  v_add_f32 v230, v230, v20
  v_add_f32 v231, v231, v21
  v_mov_b32 v20, v230
  v_mov_b32 v21, v231
  s_nop 1
  v_permlane32_swap_b32 v230, v20
  v_permlane32_swap_b32 v231, v21
  v_add_f32 v230, v230, v20
  v_add_f32 v231, v231, v21
  v_rcp_f32 v16, v230
  v_rcp_f32 v18, v231
  s_sub_u32 s23, 15, s22
  s_lshl_b32 s23, s23, 2
  v_mov_b32 v17, v16
  v_mov_b32 v19, v18
  s_add_u32 s23, s23, s20
  s_lshl_b32 s23, s23, 18
  s_lshl_b32 s31, s21, 12
  s_add_u32 s31, s31, 50331648
  s_add_u32 s64, s23, s31
  s_add_u32 s65, s64, 131072
  v_accvgpr_read_b32 v68, a64
  v_accvgpr_read_b32 v69, a65
  v_accvgpr_read_b32 v70, a66
  v_accvgpr_read_b32 v71, a67
  v_accvgpr_read_b32 v72, a72
  v_accvgpr_read_b32 v73, a73
  v_accvgpr_read_b32 v74, a74
  v_accvgpr_read_b32 v75, a75
  v_pk_mul_f32 v[68:69], v[68:69], v[16:17]
  v_pk_mul_f32 v[70:71], v[70:71], v[16:17]
  v_pk_mul_f32 v[72:73], v[72:73], v[16:17]
  v_pk_mul_f32 v[74:75], v[74:75], v[16:17]
  v_cvt_pk_bf16_f32 v64, v68, v69
  v_cvt_pk_bf16_f32 v65, v70, v71
  v_cvt_pk_bf16_f32 v66, v72, v73
  v_cvt_pk_bf16_f32 v67, v74, v75
  buffer_store_dwordx4 v[64:67], v2, s[40:43], s64 offen offset:0 sc1
  v_accvgpr_read_b32 v80, a80
  v_accvgpr_read_b32 v81, a81
  v_accvgpr_read_b32 v82, a82
  v_accvgpr_read_b32 v83, a83
  v_accvgpr_read_b32 v84, a88
  v_accvgpr_read_b32 v85, a89
  v_accvgpr_read_b32 v86, a90
  v_accvgpr_read_b32 v87, a91
  v_pk_mul_f32 v[80:81], v[80:81], v[16:17]
  v_pk_mul_f32 v[82:83], v[82:83], v[16:17]
  v_pk_mul_f32 v[84:85], v[84:85], v[16:17]
  v_pk_mul_f32 v[86:87], v[86:87], v[16:17]
  v_cvt_pk_bf16_f32 v76, v80, v81
  v_cvt_pk_bf16_f32 v77, v82, v83
  v_cvt_pk_bf16_f32 v78, v84, v85
  v_cvt_pk_bf16_f32 v79, v86, v87
  buffer_store_dwordx4 v[76:79], v2, s[40:43], s64 offen offset:1024 sc1
  v_accvgpr_read_b32 v132, a96
  v_accvgpr_read_b32 v133, a97
  v_accvgpr_read_b32 v134, a98
  v_accvgpr_read_b32 v135, a99
  v_accvgpr_read_b32 v136, a104
  v_accvgpr_read_b32 v137, a105
  v_accvgpr_read_b32 v138, a106
  v_accvgpr_read_b32 v139, a107
  v_pk_mul_f32 v[132:133], v[132:133], v[16:17]
  v_pk_mul_f32 v[134:135], v[134:135], v[16:17]
  v_pk_mul_f32 v[136:137], v[136:137], v[16:17]
  v_pk_mul_f32 v[138:139], v[138:139], v[16:17]
  v_cvt_pk_bf16_f32 v128, v132, v133
  v_cvt_pk_bf16_f32 v129, v134, v135
  v_cvt_pk_bf16_f32 v130, v136, v137
  v_cvt_pk_bf16_f32 v131, v138, v139
  buffer_store_dwordx4 v[128:131], v2, s[40:43], s64 offen offset:2048 sc1
  v_accvgpr_read_b32 v144, a112
  v_accvgpr_read_b32 v145, a113
  v_accvgpr_read_b32 v146, a114
  v_accvgpr_read_b32 v147, a115
  v_accvgpr_read_b32 v148, a120
  v_accvgpr_read_b32 v149, a121
  v_accvgpr_read_b32 v150, a122
  v_accvgpr_read_b32 v151, a123
  v_pk_mul_f32 v[144:145], v[144:145], v[16:17]
  v_pk_mul_f32 v[146:147], v[146:147], v[16:17]
  v_pk_mul_f32 v[148:149], v[148:149], v[16:17]
  v_pk_mul_f32 v[150:151], v[150:151], v[16:17]
  v_cvt_pk_bf16_f32 v140, v144, v145
  v_cvt_pk_bf16_f32 v141, v146, v147
  v_cvt_pk_bf16_f32 v142, v148, v149
  v_cvt_pk_bf16_f32 v143, v150, v151
  buffer_store_dwordx4 v[140:143], v2, s[40:43], s64 offen offset:3072 sc1
  v_accvgpr_read_b32 v68, a68
  v_accvgpr_read_b32 v69, a69
  v_accvgpr_read_b32 v70, a70
  v_accvgpr_read_b32 v71, a71
  v_accvgpr_read_b32 v72, a76
  v_accvgpr_read_b32 v73, a77
  v_accvgpr_read_b32 v74, a78
  v_accvgpr_read_b32 v75, a79
  v_pk_mul_f32 v[68:69], v[68:69], v[18:19]
  v_pk_mul_f32 v[70:71], v[70:71], v[18:19]
  v_pk_mul_f32 v[72:73], v[72:73], v[18:19]
  v_pk_mul_f32 v[74:75], v[74:75], v[18:19]
  v_cvt_pk_bf16_f32 v64, v68, v69
  v_cvt_pk_bf16_f32 v65, v70, v71
  v_cvt_pk_bf16_f32 v66, v72, v73
  v_cvt_pk_bf16_f32 v67, v74, v75
  buffer_store_dwordx4 v[64:67], v2, s[40:43], s65 offen offset:0 sc1
  v_accvgpr_read_b32 v80, a84
  v_accvgpr_read_b32 v81, a85
  v_accvgpr_read_b32 v82, a86
  v_accvgpr_read_b32 v83, a87
  v_accvgpr_read_b32 v84, a92
  v_accvgpr_read_b32 v85, a93
  v_accvgpr_read_b32 v86, a94
  v_accvgpr_read_b32 v87, a95
  v_pk_mul_f32 v[80:81], v[80:81], v[18:19]
  v_pk_mul_f32 v[82:83], v[82:83], v[18:19]
  v_pk_mul_f32 v[84:85], v[84:85], v[18:19]
  v_pk_mul_f32 v[86:87], v[86:87], v[18:19]
  v_cvt_pk_bf16_f32 v76, v80, v81
  v_cvt_pk_bf16_f32 v77, v82, v83
  v_cvt_pk_bf16_f32 v78, v84, v85
  v_cvt_pk_bf16_f32 v79, v86, v87
  buffer_store_dwordx4 v[76:79], v2, s[40:43], s65 offen offset:1024 sc1
  v_accvgpr_read_b32 v132, a100
  v_accvgpr_read_b32 v133, a101
  v_accvgpr_read_b32 v134, a102
  v_accvgpr_read_b32 v135, a103
  v_accvgpr_read_b32 v136, a108
  v_accvgpr_read_b32 v137, a109
  v_accvgpr_read_b32 v138, a110
  v_accvgpr_read_b32 v139, a111
  v_pk_mul_f32 v[132:133], v[132:133], v[18:19]
  v_pk_mul_f32 v[134:135], v[134:135], v[18:19]
  v_pk_mul_f32 v[136:137], v[136:137], v[18:19]
  v_pk_mul_f32 v[138:139], v[138:139], v[18:19]
  v_cvt_pk_bf16_f32 v128, v132, v133
  v_cvt_pk_bf16_f32 v129, v134, v135
  v_cvt_pk_bf16_f32 v130, v136, v137
  v_cvt_pk_bf16_f32 v131, v138, v139
  buffer_store_dwordx4 v[128:131], v2, s[40:43], s65 offen offset:2048 sc1
  v_accvgpr_read_b32 v144, a116
  v_accvgpr_read_b32 v145, a117
  v_accvgpr_read_b32 v146, a118
  v_accvgpr_read_b32 v147, a119
  v_accvgpr_read_b32 v148, a124
  v_accvgpr_read_b32 v149, a125
  v_accvgpr_read_b32 v150, a126
  v_accvgpr_read_b32 v151, a127
  v_pk_mul_f32 v[144:145], v[144:145], v[18:19]
  v_pk_mul_f32 v[146:147], v[146:147], v[18:19]
  v_pk_mul_f32 v[148:149], v[148:149], v[18:19]
  v_pk_mul_f32 v[150:151], v[150:151], v[18:19]
  v_cvt_pk_bf16_f32 v140, v144, v145
  v_cvt_pk_bf16_f32 v141, v146, v147
  v_cvt_pk_bf16_f32 v142, v148, v149
  v_cvt_pk_bf16_f32 v143, v150, v151
  buffer_store_dwordx4 v[140:143], v2, s[40:43], s65 offen offset:3072 sc1
  s_load_dwordx2 s[8:9], s[0:1], 0
  s_load_dwordx2 s[16:17], s[0:1], 88
  v_mov_b32 v30, 1073741824
  v_writelane_b32 v30, s80, 0
  v_writelane_b32 v30, s3, 1
  s_cmp_lt_u32 s12, 3
  s_cbranch_scc1 fa_puby
  s_add_u32 s14, s13, 61440
  buffer_load_dwordx4 v[64:67], v2, s[40:43], s14 offen offset:0 sc1
  buffer_load_dwordx4 v[68:71], v2, s[40:43], s14 offen offset:1024 sc1
  buffer_load_dwordx4 v[72:75], v2, s[40:43], s14 offen offset:2048 sc1
  buffer_load_dwordx4 v[76:79], v2, s[40:43], s14 offen offset:3072 sc1
  s_add_u32 s14, s13, 65536
  buffer_load_dwordx4 v[80:83], v2, s[40:43], s14 offen offset:0 sc1
  buffer_load_dwordx4 v[84:87], v2, s[40:43], s14 offen offset:1024 sc1
  buffer_load_dwordx4 v[88:91], v2, s[40:43], s14 offen offset:2048 sc1
  buffer_load_dwordx4 v[92:95], v2, s[40:43], s14 offen offset:3072 sc1
  s_waitcnt vmcnt(8)
  buffer_store_dword v4, v30, s[40:43], 0 offen sc1
fa_pubb:
  s_cmp_lt_u32 s29, 8
  s_cbranch_scc1 fa_left
fa_leftb:
  s_add_u32 s14, s13, 69632
  buffer_load_dwordx4 v[128:131], v2, s[40:43], s14 offen offset:0 sc1
  buffer_load_dwordx4 v[132:135], v2, s[40:43], s14 offen offset:1024 sc1
  buffer_load_dwordx4 v[136:139], v2, s[40:43], s14 offen offset:2048 sc1
  buffer_load_dwordx4 v[140:143], v2, s[40:43], s14 offen offset:3072 sc1
  s_add_u32 s14, s13, 73728
  buffer_load_dwordx4 v[144:147], v2, s[40:43], s14 offen offset:0 sc1
  buffer_load_dwordx4 v[148:151], v2, s[40:43], s14 offen offset:1024 sc1
  s_lshl_b32 s63, s21, 19
  s_lshl_b32 s23, s20, 15
  s_add_u32 s63, s63, s23
  s_add_u32 s63, s63, 50331648
  s_mul_i32 s62, s22, 0
  s_and_b32 s62, s62, 0x7fff
  s_add_u32 s64, s63, s62
  s_add_u32 s65, s64, 131072
  s_add_u32 s66, s64, 262144
  s_add_u32 s67, s64, 393216
  v_bfe_u32 v12, v1, 3, 1
  v_lshlrev_b32 v12, 7, v12
  v_and_b32 v13, 7, v1
  v_lshl_add_u32 v12, v13, 2, v12
  s_lshl_b32 s23, s21, 8
  s_lshl_b32 s31, s20, 5
  s_add_u32 s23, s23, s31
  s_add_u32 s23, s23, 2641920
  v_add_u32 v12, s23, v12
  v_mov_b32 v20, 0
  v_mov_b32 v21, 0
  v_mov_b32 v22, 0
  v_mov_b32 v23, 0
  v_add_u32 v16, 158208, v2
  ds_write_b128 v16, v[20:23]
  buffer_load_dwordx4 v[152:155], v2, s[40:43], s14 offen offset:2048 sc1
  buffer_load_dwordx4 v[156:159], v2, s[40:43], s14 offen offset:3072 sc1
  s_add_u32 s14, s13, 77824
  buffer_load_dwordx4 v[176:179], v2, s[40:43], s14 offen offset:0 sc1
  buffer_load_dwordx4 v[180:183], v2, s[40:43], s14 offen offset:1024 sc1
  buffer_load_dwordx4 v[184:187], v2, s[40:43], s14 offen offset:2048 sc1
  buffer_load_dwordx4 v[188:191], v2, s[40:43], s14 offen offset:3072 sc1
  s_lshl_b32 s34, s28, 1
  s_and_b32 s23, s20, 1
  s_lshl_b32 s23, s23, 12
  s_cmp_lt_u32 s20, 2
  s_cselect_b32 s33, 106496, 0
  s_add_u32 s33, s33, s23
  s_add_u32 s33, s33, s34
  s_and_b32 s33, s33, 0x1ffff
  s_lshl_b32 s23, s20, 12
  s_add_u32 s34, s34, 49152
  s_add_u32 s34, s34, s23
  s_and_b32 s34, s34, 0x1ffff
  s_add_u32 s23, s23, s28
  s_cmp_lt_u32 s29, 3
  s_cselect_b32 s26, s23, s26
  s_cselect_b32 s27, s23, s27
  s_cselect_b32 s24, s33, s24
  s_cselect_b32 s25, s34, s25
  s_mov_b64 s[44:45], s[4:5]
  s_mov_b64 s[48:49], s[6:7]
  s_mov_b32 s46, s30
  s_mov_b32 s50, s30
  s_add_u32 s23, s28, 49152
fa_pk:
  s_cmp_ge_u32 s26, s23
  s_cbranch_scc1 fa_pkd
  s_mov_b32 m0, s24
  s_add_u32 s24, s24, 32768
  s_and_b32 s24, s24, 0x1ffff
  buffer_load_dwordx4 v2, s[44:47], s26 offen offset:0 sc1 lds
  buffer_load_dwordx4 v2, s[44:47], s26 offen offset:1024 sc1 lds
  buffer_load_dwordx4 v2, s[44:47], s26 offen offset:2048 sc1 lds
  buffer_load_dwordx4 v2, s[44:47], s26 offen offset:3072 sc1 lds
  s_add_u32 s26, s26, 16384
  s_branch fa_pk
fa_pkd:
  s_add_u32 s23, s28, 32768
fa_pv:
  s_cmp_ge_u32 s27, s23
  s_cbranch_scc1 fa_pvd
  s_mov_b32 m0, s25
  s_add_u32 s25, s25, 32768
  s_and_b32 s25, s25, 0x1ffff
  buffer_load_dwordx4 v2, s[48:51], s27 offen offset:0 sc1 lds
  buffer_load_dwordx4 v2, s[48:51], s27 offen offset:1024 sc1 lds
  buffer_load_dwordx4 v2, s[48:51], s27 offen offset:2048 sc1 lds
  buffer_load_dwordx4 v2, s[48:51], s27 offen offset:3072 sc1 lds
  s_add_u32 s27, s27, 16384
  s_branch fa_pv
fa_pvd:
  s_lshl_b32 s35, s20, 12
  s_add_u32 s35, s35, 131072
  s_mov_b32 m0, s35
  s_add_u32 s14, s13, 155648
  buffer_load_dwordx4 v2, s[40:43], s14 offen offset:0 sc1 lds
  buffer_load_dwordx4 v2, s[40:43], s14 offen offset:1024 sc1 lds
  buffer_load_dwordx4 v2, s[40:43], s14 offen offset:2048 sc1 lds
  buffer_load_dwordx4 v2, s[40:43], s14 offen offset:3072 sc1 lds
  s_waitcnt lgkmcnt(0)
  s_barrier
  s_mov_b32 m0, s24
  s_add_u32 s24, s24, 32768
  s_and_b32 s24, s24, 0x1ffff
  buffer_load_dwordx4 v2, s[44:47], s26 offen offset:0 sc1 lds
  buffer_load_dwordx4 v2, s[44:47], s26 offen offset:1024 sc1 lds
  buffer_load_dwordx4 v2, s[44:47], s26 offen offset:2048 sc1 lds
  buffer_load_dwordx4 v2, s[44:47], s26 offen offset:3072 sc1 lds
  s_add_u32 s26, s26, 16384
  buffer_load_dword v13, v12, s[40:43], 0 offen sc1
  s_mov_b32 m0, s25
  s_add_u32 s25, s25, 32768
  s_and_b32 s25, s25, 0x1ffff
  buffer_load_dwordx4 v2, s[48:51], s27 offen offset:0 sc1 lds
  buffer_load_dwordx4 v2, s[48:51], s27 offen offset:1024 sc1 lds
  buffer_load_dwordx4 v2, s[48:51], s27 offen offset:2048 sc1 lds
  buffer_load_dwordx4 v2, s[48:51], s27 offen offset:3072 sc1 lds
  s_add_u32 s27, s27, 16384
  s_mov_b32 m0, s25
  s_add_u32 s25, s25, 32768
  s_and_b32 s25, s25, 0x1ffff
  buffer_load_dwordx4 v2, s[48:51], s27 offen offset:0 sc1 lds
  buffer_load_dwordx4 v2, s[48:51], s27 offen offset:1024 sc1 lds
  buffer_load_dwordx4 v2, s[48:51], s27 offen offset:2048 sc1 lds
  buffer_load_dwordx4 v2, s[48:51], s27 offen offset:3072 sc1 lds
  s_add_u32 s27, s27, 16384
  s_mov_b32 s44, s8
  s_mov_b32 s45, s9
  s_mov_b32 s46, 2621440
  s_mov_b32 s47, 0x20000
  s_mov_b32 s48, s16
  s_mov_b32 s49, s17
  s_mov_b32 s50, 2621440
  s_mov_b32 s51, 0x20000
  s_lshl_b32 s25, s21, 6
  s_mul_i32 s26, s22, 160
  s_mul_i32 s27, s22, 2560
  s_waitcnt vmcnt(8)
  v_cmp_eq_u32 vcc, 0, v13
  s_cbranch_vccnz fa_ctx_spin
fa_ctx_ok:
  buffer_load_dwordx4 a[144:147], v2, s[40:43], s64 offen offset:0 sc1
  buffer_load_dwordx4 a[148:151], v2, s[40:43], s65 offen offset:0 sc1
  buffer_load_dwordx4 a[152:155], v2, s[40:43], s66 offen offset:0 sc1
  buffer_load_dwordx4 a[156:159], v2, s[40:43], s67 offen offset:0 sc1
  buffer_load_dwordx4 a[160:163], v2, s[40:43], s64 offen offset:1024 sc1
  buffer_load_dwordx4 a[164:167], v2, s[40:43], s65 offen offset:1024 sc1
  buffer_load_dwordx4 a[168:171], v2, s[40:43], s66 offen offset:1024 sc1
  buffer_load_dwordx4 a[172:175], v2, s[40:43], s67 offen offset:1024 sc1
  buffer_load_dwordx4 a[176:179], v2, s[40:43], s64 offen offset:2048 sc1
  buffer_load_dwordx4 a[180:183], v2, s[40:43], s65 offen offset:2048 sc1
  buffer_load_dwordx4 a[184:187], v2, s[40:43], s66 offen offset:2048 sc1
  buffer_load_dwordx4 a[188:191], v2, s[40:43], s67 offen offset:2048 sc1
  buffer_load_dwordx4 v[216:219], v2, s[40:43], s64 offen offset:3072 sc1
  buffer_load_dwordx4 v[220:223], v2, s[40:43], s65 offen offset:3072 sc1
  buffer_load_dwordx4 v[224:227], v2, s[40:43], s66 offen offset:3072 sc1
  buffer_load_dwordx4 v[228:231], v2, s[40:43], s67 offen offset:3072 sc1
  s_add_u32 s62, s62, 4096
  s_and_b32 s62, s62, 0x7fff
  s_add_u32 s64, s63, s62
  s_add_u32 s65, s64, 131072
  s_add_u32 s66, s64, 262144
  s_add_u32 s67, s64, 393216
  s_waitcnt vmcnt(14)
  v_mfma_f32_16x16x32_bf16 a[64:67], a[0:3], a[144:147], 0
  v_mfma_f32_16x16x32_bf16 a[80:83], a[4:7], a[144:147], 0
  v_mfma_f32_16x16x32_bf16 a[96:99], a[8:11], a[144:147], 0
  v_mfma_f32_16x16x32_bf16 a[112:115], a[12:15], a[144:147], 0
  v_mfma_f32_16x16x32_bf16 a[128:131], a[16:19], a[144:147], 0
  buffer_load_dwordx4 a[144:147], v2, s[40:43], s64 offen offset:0 sc1
  v_mfma_f32_16x16x32_bf16 a[68:71], a[0:3], a[148:151], 0
  v_mfma_f32_16x16x32_bf16 a[84:87], a[4:7], a[148:151], 0
  v_mfma_f32_16x16x32_bf16 a[100:103], a[8:11], a[148:151], 0
  v_mfma_f32_16x16x32_bf16 a[116:119], a[12:15], a[148:151], 0
  v_mfma_f32_16x16x32_bf16 a[132:135], a[16:19], a[148:151], 0
  s_waitcnt vmcnt(13)
  buffer_load_dwordx4 a[148:151], v2, s[40:43], s65 offen offset:0 sc1
  v_mfma_f32_16x16x32_bf16 a[72:75], a[0:3], a[152:155], 0
  v_mfma_f32_16x16x32_bf16 a[88:91], a[4:7], a[152:155], 0
  v_mfma_f32_16x16x32_bf16 a[104:107], a[8:11], a[152:155], 0
  v_mfma_f32_16x16x32_bf16 a[120:123], a[12:15], a[152:155], 0
  v_mfma_f32_16x16x32_bf16 a[136:139], a[16:19], a[152:155], 0
  buffer_load_dwordx4 a[152:155], v2, s[40:43], s66 offen offset:0 sc1
  v_mfma_f32_16x16x32_bf16 a[76:79], a[0:3], a[156:159], 0
  v_mfma_f32_16x16x32_bf16 a[92:95], a[4:7], a[156:159], 0
  v_mfma_f32_16x16x32_bf16 a[108:111], a[8:11], a[156:159], 0
  v_mfma_f32_16x16x32_bf16 a[124:127], a[12:15], a[156:159], 0
  v_mfma_f32_16x16x32_bf16 a[140:143], a[16:19], a[156:159], 0
  s_waitcnt vmcnt(13)
  buffer_load_dwordx4 a[156:159], v2, s[40:43], s67 offen offset:0 sc1
  v_mfma_f32_16x16x32_bf16 a[64:67], a[20:23], a[160:163], a[64:67]
  v_add_u32 v16, 0, v0
  v_mfma_f32_16x16x32_bf16 a[80:83], a[24:27], a[160:163], a[80:83]
  v_mfma_f32_16x16x32_bf16 a[96:99], a[28:31], a[160:163], a[96:99]
  s_add_u32 s14, s13, 81920
  buffer_load_dwordx4 a[0:3], v2, s[40:43], s14 offen offset:0 sc1
  v_mul_u32_u24 v17, 6554, v16
  v_mfma_f32_16x16x32_bf16 a[112:115], a[32:35], a[160:163], a[112:115]
  v_mfma_f32_16x16x32_bf16 a[128:131], a[36:39], a[160:163], a[128:131]
  buffer_load_dwordx4 a[160:163], v2, s[40:43], s64 offen offset:1024 sc1
  v_mfma_f32_16x16x32_bf16 a[68:71], a[20:23], a[164:167], a[68:71]
  v_lshrrev_b32 v17, 16, v17
  v_mfma_f32_16x16x32_bf16 a[84:87], a[24:27], a[164:167], a[84:87]
  v_mul_u32_u24 v18, 10, v17
  v_mfma_f32_16x16x32_bf16 a[100:103], a[28:31], a[164:167], a[100:103]
  v_mfma_f32_16x16x32_bf16 a[116:119], a[32:35], a[164:167], a[116:119]
  v_mfma_f32_16x16x32_bf16 a[132:135], a[36:39], a[164:167], a[132:135]
  s_waitcnt vmcnt(14)
  buffer_load_dwordx4 a[164:167], v2, s[40:43], s65 offen offset:1024 sc1
  v_sub_u32 v18, v16, v18
  v_mfma_f32_16x16x32_bf16 a[72:75], a[20:23], a[168:171], a[72:75]
  v_mfma_f32_16x16x32_bf16 a[88:91], a[24:27], a[168:171], a[88:91]
  v_mfma_f32_16x16x32_bf16 a[104:107], a[28:31], a[168:171], a[104:107]
  buffer_load_dwordx4 a[4:7], v2, s[40:43], s14 offen offset:1024 sc1
  v_mfma_f32_16x16x32_bf16 a[120:123], a[32:35], a[168:171], a[120:123]
  v_mul_u32_u24 v251, 336, v17
  v_mfma_f32_16x16x32_bf16 a[136:139], a[36:39], a[168:171], a[136:139]
  buffer_load_dwordx4 a[168:171], v2, s[40:43], s66 offen offset:1024 sc1
  v_lshl_add_u32 v251, v18, 5, v251
  v_mfma_f32_16x16x32_bf16 a[76:79], a[20:23], a[172:175], a[76:79]
  v_mfma_f32_16x16x32_bf16 a[92:95], a[24:27], a[172:175], a[92:95]
  v_mfma_f32_16x16x32_bf16 a[108:111], a[28:31], a[172:175], a[108:111]
  v_mfma_f32_16x16x32_bf16 a[124:127], a[32:35], a[172:175], a[124:127]
  v_mfma_f32_16x16x32_bf16 a[140:143], a[36:39], a[172:175], a[140:143]
  s_waitcnt vmcnt(15)
  buffer_load_dwordx4 a[172:175], v2, s[40:43], s67 offen offset:1024 sc1
  v_mfma_f32_16x16x32_bf16 a[64:67], a[40:43], a[176:179], a[64:67]
  v_lshlrev_b32 v203, 5, v18
  v_mfma_f32_16x16x32_bf16 a[80:83], a[44:47], a[176:179], a[80:83]
  v_mfma_f32_16x16x32_bf16 a[96:99], a[48:51], a[176:179], a[96:99]
  buffer_load_dwordx4 a[8:11], v2, s[40:43], s14 offen offset:2048 sc1
  v_add_u32 v17, s25, v17
  v_mfma_f32_16x16x32_bf16 a[112:115], a[52:55], a[176:179], a[112:115]
  v_mfma_f32_16x16x32_bf16 a[128:131], a[56:59], a[176:179], a[128:131]
  buffer_load_dwordx4 a[176:179], v2, s[40:43], s64 offen offset:2048 sc1
  v_mfma_f32_16x16x32_bf16 a[68:71], a[40:43], a[180:183], a[68:71]
  v_add_u32 v24, 1, v17
  v_mfma_f32_16x16x32_bf16 a[84:87], a[44:47], a[180:183], a[84:87]
  v_mul_u32_u24 v248, 1280, v17
  v_mfma_f32_16x16x32_bf16 a[100:103], a[48:51], a[180:183], a[100:103]
  v_mfma_f32_16x16x32_bf16 a[116:119], a[52:55], a[180:183], a[116:119]
  v_mfma_f32_16x16x32_bf16 a[132:135], a[56:59], a[180:183], a[132:135]
  s_waitcnt vmcnt(16)
  buffer_load_dwordx4 a[180:183], v2, s[40:43], s65 offen offset:2048 sc1
  v_lshl_add_u32 v248, v18, 4, v248
  v_mfma_f32_16x16x32_bf16 a[72:75], a[40:43], a[184:187], a[72:75]
  v_mfma_f32_16x16x32_bf16 a[88:91], a[44:47], a[184:187], a[88:91]
  v_mfma_f32_16x16x32_bf16 a[104:107], a[48:51], a[184:187], a[104:107]
  buffer_load_dwordx4 a[12:15], v2, s[40:43], s14 offen offset:3072 sc1
  v_mfma_f32_16x16x32_bf16 a[120:123], a[52:55], a[184:187], a[120:123]
  v_add_u32 v248, s26, v248
  v_mfma_f32_16x16x32_bf16 a[136:139], a[56:59], a[184:187], a[136:139]
  buffer_load_dwordx4 a[184:187], v2, s[40:43], s66 offen offset:2048 sc1
  v_lshrrev_b32 v19, 4, v17
  v_mfma_f32_16x16x32_bf16 a[76:79], a[40:43], a[188:191], a[76:79]
  v_mfma_f32_16x16x32_bf16 a[92:95], a[44:47], a[188:191], a[92:95]
  v_mfma_f32_16x16x32_bf16 a[108:111], a[48:51], a[188:191], a[108:111]
  v_mfma_f32_16x16x32_bf16 a[124:127], a[52:55], a[188:191], a[124:127]
  v_mfma_f32_16x16x32_bf16 a[140:143], a[56:59], a[188:191], a[140:143]
  s_waitcnt vmcnt(17)
  buffer_load_dwordx4 a[188:191], v2, s[40:43], s67 offen offset:2048 sc1
  v_mfma_f32_16x16x32_bf16 a[64:67], a[60:63], v[216:219], a[64:67]
  v_mul_u32_u24 v19, 20480, v19
  v_mfma_f32_16x16x32_bf16 a[80:83], a[192:195], v[216:219], a[80:83]
  v_mfma_f32_16x16x32_bf16 a[96:99], a[196:199], v[216:219], a[96:99]
  s_add_u32 s14, s13, 86016
  buffer_load_dwordx4 a[16:19], v2, s[40:43], s14 offen offset:0 sc1
  v_and_b32 v17, 15, v17
  v_mfma_f32_16x16x32_bf16 a[112:115], a[200:203], v[216:219], a[112:115]
  v_mfma_f32_16x16x32_bf16 a[128:131], a[204:207], v[216:219], a[128:131]
  buffer_load_dwordx4 v[216:219], v2, s[40:43], s64 offen offset:3072 sc1
  v_mfma_f32_16x16x32_bf16 a[68:71], a[60:63], v[220:223], a[68:71]
  v_lshl_add_u32 v19, v17, 4, v19
  v_mfma_f32_16x16x32_bf16 a[84:87], a[192:195], v[220:223], a[84:87]
  v_lshl_add_u32 v200, v18, 8, v19
  v_mfma_f32_16x16x32_bf16 a[100:103], a[196:199], v[220:223], a[100:103]
  v_mfma_f32_16x16x32_bf16 a[116:119], a[200:203], v[220:223], a[116:119]
  v_mfma_f32_16x16x32_bf16 a[132:135], a[204:207], v[220:223], a[132:135]
  s_waitcnt vmcnt(18)
  buffer_load_dwordx4 v[220:223], v2, s[40:43], s65 offen offset:3072 sc1
  v_mov_b32 v27, 8
  v_mfma_f32_16x16x32_bf16 a[72:75], a[60:63], v[224:227], a[72:75]
  v_mfma_f32_16x16x32_bf16 a[88:91], a[192:195], v[224:227], a[88:91]
  v_mfma_f32_16x16x32_bf16 a[104:107], a[196:199], v[224:227], a[104:107]
  buffer_load_dwordx4 a[20:23], v2, s[40:43], s14 offen offset:1024 sc1
  v_mfma_f32_16x16x32_bf16 a[120:123], a[200:203], v[224:227], a[120:123]
  v_add_u32 v16, 256, v0
  v_mfma_f32_16x16x32_bf16 a[136:139], a[204:207], v[224:227], a[136:139]
  buffer_load_dwordx4 v[224:227], v2, s[40:43], s66 offen offset:3072 sc1
  v_mul_u32_u24 v17, 6554, v16
  v_mfma_f32_16x16x32_bf16 a[76:79], a[60:63], v[228:231], a[76:79]
  v_mfma_f32_16x16x32_bf16 a[92:95], a[192:195], v[228:231], a[92:95]
  v_mfma_f32_16x16x32_bf16 a[108:111], a[196:199], v[228:231], a[108:111]
  v_mfma_f32_16x16x32_bf16 a[124:127], a[200:203], v[228:231], a[124:127]
  v_mfma_f32_16x16x32_bf16 a[140:143], a[204:207], v[228:231], a[140:143]
  s_waitcnt vmcnt(19)
  buffer_load_dwordx4 v[228:231], v2, s[40:43], s67 offen offset:3072 sc1
  v_mfma_f32_16x16x32_bf16 a[64:67], a[208:211], a[144:147], a[64:67]
  s_add_u32 s62, s62, 4096
  v_lshrrev_b32 v17, 16, v17
  v_mfma_f32_16x16x32_bf16 a[80:83], a[212:215], a[144:147], a[80:83]
  s_and_b32 s62, s62, 0x7fff
  v_mfma_f32_16x16x32_bf16 a[96:99], a[216:219], a[144:147], a[96:99]
  buffer_load_dwordx4 a[24:27], v2, s[40:43], s14 offen offset:2048 sc1
  v_mul_u32_u24 v18, 10, v17
  v_mfma_f32_16x16x32_bf16 a[112:115], a[220:223], a[144:147], a[112:115]
  s_add_u32 s64, s63, s62
  v_mfma_f32_16x16x32_bf16 a[128:131], a[224:227], a[144:147], a[128:131]
  buffer_load_dwordx4 a[144:147], v2, s[40:43], s64 offen offset:0 sc1
  v_mfma_f32_16x16x32_bf16 a[68:71], a[208:211], a[148:151], a[68:71]
  s_add_u32 s65, s64, 131072
  v_sub_u32 v18, v16, v18
  v_mfma_f32_16x16x32_bf16 a[84:87], a[212:215], a[148:151], a[84:87]
  s_add_u32 s66, s64, 262144
  v_mul_u32_u24 v252, 336, v17
  v_mfma_f32_16x16x32_bf16 a[100:103], a[216:219], a[148:151], a[100:103]
  v_mfma_f32_16x16x32_bf16 a[116:119], a[220:223], a[148:151], a[116:119]
  v_mfma_f32_16x16x32_bf16 a[132:135], a[224:227], a[148:151], a[132:135]
  s_waitcnt vmcnt(20)
  buffer_load_dwordx4 a[148:151], v2, s[40:43], s65 offen offset:0 sc1
  v_lshl_add_u32 v252, v18, 5, v252
  v_mfma_f32_16x16x32_bf16 a[72:75], a[208:211], a[152:155], a[72:75]
  s_add_u32 s67, s64, 393216
  v_mfma_f32_16x16x32_bf16 a[88:91], a[212:215], a[152:155], a[88:91]
  v_mfma_f32_16x16x32_bf16 a[104:107], a[216:219], a[152:155], a[104:107]
  v_mfma_f32_16x16x32_bf16 a[120:123], a[220:223], a[152:155], a[120:123]
  v_lshlrev_b32 v204, 5, v18
  v_mfma_f32_16x16x32_bf16 a[136:139], a[224:227], a[152:155], a[136:139]
  buffer_load_dwordx4 a[152:155], v2, s[40:43], s66 offen offset:0 sc1
  v_add_u32 v17, s25, v17
  v_mfma_f32_16x16x32_bf16 a[76:79], a[208:211], a[156:159], a[76:79]
  v_mfma_f32_16x16x32_bf16 a[92:95], a[212:215], a[156:159], a[92:95]
  v_mfma_f32_16x16x32_bf16 a[108:111], a[216:219], a[156:159], a[108:111]
  v_mfma_f32_16x16x32_bf16 a[124:127], a[220:223], a[156:159], a[124:127]
  v_mfma_f32_16x16x32_bf16 a[140:143], a[224:227], a[156:159], a[140:143]
  s_waitcnt vmcnt(19)
  buffer_load_dwordx4 a[156:159], v2, s[40:43], s67 offen offset:0 sc1
  v_mfma_f32_16x16x32_bf16 a[64:67], a[228:231], a[160:163], a[64:67]
  v_add_u32 v25, 1, v17
  v_mfma_f32_16x16x32_bf16 a[80:83], a[232:235], a[160:163], a[80:83]
  v_mfma_f32_16x16x32_bf16 a[96:99], a[236:239], a[160:163], a[96:99]
  buffer_load_dwordx4 a[28:31], v2, s[40:43], s14 offen offset:3072 sc1
  v_mul_u32_u24 v249, 1280, v17
  v_mfma_f32_16x16x32_bf16 a[112:115], a[240:243], a[160:163], a[112:115]
  v_mfma_f32_16x16x32_bf16 a[128:131], a[244:247], a[160:163], a[128:131]
  buffer_load_dwordx4 a[160:163], v2, s[40:43], s64 offen offset:1024 sc1
  v_mfma_f32_16x16x32_bf16 a[68:71], a[228:231], a[164:167], a[68:71]
  v_lshl_add_u32 v249, v18, 4, v249
  v_mfma_f32_16x16x32_bf16 a[84:87], a[232:235], a[164:167], a[84:87]
  v_add_u32 v249, s26, v249
  v_mfma_f32_16x16x32_bf16 a[100:103], a[236:239], a[164:167], a[100:103]
  v_mfma_f32_16x16x32_bf16 a[116:119], a[240:243], a[164:167], a[116:119]
  v_mfma_f32_16x16x32_bf16 a[132:135], a[244:247], a[164:167], a[132:135]
  s_waitcnt vmcnt(19)
  buffer_load_dwordx4 a[164:167], v2, s[40:43], s65 offen offset:1024 sc1
  v_lshrrev_b32 v19, 4, v17
  v_mfma_f32_16x16x32_bf16 a[72:75], a[228:231], a[168:171], a[72:75]
  v_mfma_f32_16x16x32_bf16 a[88:91], a[232:235], a[168:171], a[88:91]
  v_mfma_f32_16x16x32_bf16 a[104:107], a[236:239], a[168:171], a[104:107]
  s_add_u32 s14, s13, 90112
  buffer_load_dwordx4 a[32:35], v2, s[40:43], s14 offen offset:0 sc1
  v_mfma_f32_16x16x32_bf16 a[120:123], a[240:243], a[168:171], a[120:123]
  v_mul_u32_u24 v19, 20480, v19
  v_mfma_f32_16x16x32_bf16 a[136:139], a[244:247], a[168:171], a[136:139]
  buffer_load_dwordx4 a[168:171], v2, s[40:43], s66 offen offset:1024 sc1
  v_and_b32 v17, 15, v17
  v_mfma_f32_16x16x32_bf16 a[76:79], a[228:231], a[172:175], a[76:79]
  v_mfma_f32_16x16x32_bf16 a[92:95], a[232:235], a[172:175], a[92:95]
  v_mfma_f32_16x16x32_bf16 a[108:111], a[236:239], a[172:175], a[108:111]
  v_mfma_f32_16x16x32_bf16 a[124:127], a[240:243], a[172:175], a[124:127]
  v_mfma_f32_16x16x32_bf16 a[140:143], a[244:247], a[172:175], a[140:143]
  s_waitcnt vmcnt(19)
  buffer_load_dwordx4 a[172:175], v2, s[40:43], s67 offen offset:1024 sc1
  v_mfma_f32_16x16x32_bf16 a[64:67], a[248:251], a[176:179], a[64:67]
  v_lshl_add_u32 v19, v17, 4, v19
  v_mfma_f32_16x16x32_bf16 a[80:83], a[252:255], a[176:179], a[80:83]
  v_mfma_f32_16x16x32_bf16 a[96:99], v[32:35], a[176:179], a[96:99]
  buffer_load_dwordx4 a[36:39], v2, s[40:43], s14 offen offset:1024 sc1
  v_lshl_add_u32 v201, v18, 8, v19
  v_mfma_f32_16x16x32_bf16 a[112:115], v[36:39], a[176:179], a[112:115]
  v_mfma_f32_16x16x32_bf16 a[128:131], v[40:43], a[176:179], a[128:131]
  buffer_load_dwordx4 a[176:179], v2, s[40:43], s64 offen offset:2048 sc1
  v_mfma_f32_16x16x32_bf16 a[68:71], a[248:251], a[180:183], a[68:71]
  v_mov_b32 v28, 8
  v_mfma_f32_16x16x32_bf16 a[84:87], a[252:255], a[180:183], a[84:87]
  v_add_u32 v16, 512, v0
  v_mfma_f32_16x16x32_bf16 a[100:103], v[32:35], a[180:183], a[100:103]
  v_mfma_f32_16x16x32_bf16 a[116:119], v[36:39], a[180:183], a[116:119]
  v_mfma_f32_16x16x32_bf16 a[132:135], v[40:43], a[180:183], a[132:135]
  s_waitcnt vmcnt(19)
  buffer_load_dwordx4 a[180:183], v2, s[40:43], s65 offen offset:2048 sc1
  v_mul_u32_u24 v17, 6554, v16
  v_mfma_f32_16x16x32_bf16 a[72:75], a[248:251], a[184:187], a[72:75]
  v_mfma_f32_16x16x32_bf16 a[88:91], a[252:255], a[184:187], a[88:91]
  v_mfma_f32_16x16x32_bf16 a[104:107], v[32:35], a[184:187], a[104:107]
  buffer_load_dwordx4 a[40:43], v2, s[40:43], s14 offen offset:2048 sc1
  v_mfma_f32_16x16x32_bf16 a[120:123], v[36:39], a[184:187], a[120:123]
  v_lshrrev_b32 v17, 16, v17
  v_mfma_f32_16x16x32_bf16 a[136:139], v[40:43], a[184:187], a[136:139]
  buffer_load_dwordx4 a[184:187], v2, s[40:43], s66 offen offset:2048 sc1
  v_mul_u32_u24 v18, 10, v17
  v_mfma_f32_16x16x32_bf16 a[76:79], a[248:251], a[188:191], a[76:79]
  v_mfma_f32_16x16x32_bf16 a[92:95], a[252:255], a[188:191], a[92:95]
  v_mfma_f32_16x16x32_bf16 a[108:111], v[32:35], a[188:191], a[108:111]
  v_mfma_f32_16x16x32_bf16 a[124:127], v[36:39], a[188:191], a[124:127]
  v_mfma_f32_16x16x32_bf16 a[140:143], v[40:43], a[188:191], a[140:143]
  s_waitcnt vmcnt(19)
  buffer_load_dwordx4 a[188:191], v2, s[40:43], s67 offen offset:2048 sc1
  v_mfma_f32_16x16x32_bf16 a[64:67], v[44:47], v[216:219], a[64:67]
  v_sub_u32 v18, v16, v18
  v_mfma_f32_16x16x32_bf16 a[80:83], v[48:51], v[216:219], a[80:83]
  v_mfma_f32_16x16x32_bf16 a[96:99], v[52:55], v[216:219], a[96:99]
  buffer_load_dwordx4 a[44:47], v2, s[40:43], s14 offen offset:3072 sc1
  v_mul_u32_u24 v253, 336, v17
  v_mfma_f32_16x16x32_bf16 a[112:115], v[56:59], v[216:219], a[112:115]
  v_mfma_f32_16x16x32_bf16 a[128:131], v[60:63], v[216:219], a[128:131]
  buffer_load_dwordx4 v[216:219], v2, s[40:43], s64 offen offset:3072 sc1
  v_mfma_f32_16x16x32_bf16 a[68:71], v[44:47], v[220:223], a[68:71]
  v_lshl_add_u32 v253, v18, 5, v253
  v_mfma_f32_16x16x32_bf16 a[84:87], v[48:51], v[220:223], a[84:87]
  v_lshlrev_b32 v205, 5, v18
  v_mfma_f32_16x16x32_bf16 a[100:103], v[52:55], v[220:223], a[100:103]
  v_mfma_f32_16x16x32_bf16 a[116:119], v[56:59], v[220:223], a[116:119]
  v_mfma_f32_16x16x32_bf16 a[132:135], v[60:63], v[220:223], a[132:135]
  s_waitcnt vmcnt(19)
  buffer_load_dwordx4 v[220:223], v2, s[40:43], s65 offen offset:3072 sc1
  v_add_u32 v17, s25, v17
  v_mfma_f32_16x16x32_bf16 a[72:75], v[44:47], v[224:227], a[72:75]
  v_mfma_f32_16x16x32_bf16 a[88:91], v[48:51], v[224:227], a[88:91]
  v_mfma_f32_16x16x32_bf16 a[104:107], v[52:55], v[224:227], a[104:107]
  v_mfma_f32_16x16x32_bf16 a[120:123], v[56:59], v[224:227], a[120:123]
  v_add_u32 v26, 1, v17
  v_mfma_f32_16x16x32_bf16 a[136:139], v[60:63], v[224:227], a[136:139]
  buffer_load_dwordx4 v[224:227], v2, s[40:43], s66 offen offset:3072 sc1
  v_mul_u32_u24 v250, 1280, v17
  v_mfma_f32_16x16x32_bf16 a[76:79], v[44:47], v[228:231], a[76:79]
  v_mfma_f32_16x16x32_bf16 a[92:95], v[48:51], v[228:231], a[92:95]
  v_mfma_f32_16x16x32_bf16 a[108:111], v[52:55], v[228:231], a[108:111]
  v_mfma_f32_16x16x32_bf16 a[124:127], v[56:59], v[228:231], a[124:127]
  v_mfma_f32_16x16x32_bf16 a[140:143], v[60:63], v[228:231], a[140:143]
  s_waitcnt vmcnt(18)
  buffer_load_dwordx4 v[228:231], v2, s[40:43], s67 offen offset:3072 sc1
  v_mfma_f32_16x16x32_bf16 a[64:67], v[96:99], a[144:147], a[64:67]
  s_add_u32 s62, s62, 4096
  v_lshl_add_u32 v250, v18, 4, v250
  v_mfma_f32_16x16x32_bf16 a[80:83], v[100:103], a[144:147], a[80:83]
  s_and_b32 s62, s62, 0x7fff
  v_mfma_f32_16x16x32_bf16 a[96:99], v[104:107], a[144:147], a[96:99]
  s_add_u32 s14, s13, 94208
  buffer_load_dwordx4 a[48:51], v2, s[40:43], s14 offen offset:0 sc1
  v_add_u32 v250, s26, v250
  v_mfma_f32_16x16x32_bf16 a[112:115], v[108:111], a[144:147], a[112:115]
  s_add_u32 s64, s63, s62
  v_mfma_f32_16x16x32_bf16 a[128:131], v[112:115], a[144:147], a[128:131]
  buffer_load_dwordx4 a[144:147], v2, s[40:43], s64 offen offset:0 sc1
  v_mfma_f32_16x16x32_bf16 a[68:71], v[96:99], a[148:151], a[68:71]
  s_add_u32 s65, s64, 131072
  v_lshrrev_b32 v19, 4, v17
  v_mfma_f32_16x16x32_bf16 a[84:87], v[100:103], a[148:151], a[84:87]
  s_add_u32 s66, s64, 262144
  v_mul_u32_u24 v19, 20480, v19
  v_mfma_f32_16x16x32_bf16 a[100:103], v[104:107], a[148:151], a[100:103]
  v_mfma_f32_16x16x32_bf16 a[116:119], v[108:111], a[148:151], a[116:119]
  v_mfma_f32_16x16x32_bf16 a[132:135], v[112:115], a[148:151], a[132:135]
  s_waitcnt vmcnt(19)
  buffer_load_dwordx4 a[148:151], v2, s[40:43], s65 offen offset:0 sc1
  v_and_b32 v17, 15, v17
  v_mfma_f32_16x16x32_bf16 a[72:75], v[96:99], a[152:155], a[72:75]
  s_add_u32 s67, s64, 393216
  v_mfma_f32_16x16x32_bf16 a[88:91], v[100:103], a[152:155], a[88:91]
  v_mfma_f32_16x16x32_bf16 a[104:107], v[104:107], a[152:155], a[104:107]
  buffer_load_dwordx4 a[52:55], v2, s[40:43], s14 offen offset:1024 sc1
  v_mfma_f32_16x16x32_bf16 a[120:123], v[108:111], a[152:155], a[120:123]
  v_lshl_add_u32 v19, v17, 4, v19
  v_mfma_f32_16x16x32_bf16 a[136:139], v[112:115], a[152:155], a[136:139]
  buffer_load_dwordx4 a[152:155], v2, s[40:43], s66 offen offset:0 sc1
  v_lshl_add_u32 v202, v18, 8, v19
  v_mfma_f32_16x16x32_bf16 a[76:79], v[96:99], a[156:159], a[76:79]
  v_mfma_f32_16x16x32_bf16 a[92:95], v[100:103], a[156:159], a[92:95]
  v_mfma_f32_16x16x32_bf16 a[108:111], v[104:107], a[156:159], a[108:111]
  v_mfma_f32_16x16x32_bf16 a[124:127], v[108:111], a[156:159], a[124:127]
  v_mfma_f32_16x16x32_bf16 a[140:143], v[112:115], a[156:159], a[140:143]
  s_waitcnt vmcnt(19)
  buffer_load_dwordx4 a[156:159], v2, s[40:43], s67 offen offset:0 sc1
  v_mfma_f32_16x16x32_bf16 a[64:67], v[116:119], a[160:163], a[64:67]
  v_mov_b32 v29, 8
  v_mfma_f32_16x16x32_bf16 a[80:83], v[120:123], a[160:163], a[80:83]
  v_mfma_f32_16x16x32_bf16 a[96:99], v[124:127], a[160:163], a[96:99]
  buffer_load_dwordx4 a[56:59], v2, s[40:43], s14 offen offset:2048 sc1
  v_cmp_gt_u32 vcc, 128, v0
  v_mfma_f32_16x16x32_bf16 a[112:115], v[160:163], a[160:163], a[112:115]
  v_mfma_f32_16x16x32_bf16 a[128:131], v[164:167], a[160:163], a[128:131]
  buffer_load_dwordx4 a[160:163], v2, s[40:43], s64 offen offset:1024 sc1
  v_mfma_f32_16x16x32_bf16 a[68:71], v[116:119], a[164:167], a[68:71]
  v_mov_b32 v16, 1073741824
  v_mfma_f32_16x16x32_bf16 a[84:87], v[120:123], a[164:167], a[84:87]
  v_mov_b32 v17, 0
  v_mfma_f32_16x16x32_bf16 a[100:103], v[124:127], a[164:167], a[100:103]
  v_mfma_f32_16x16x32_bf16 a[116:119], v[160:163], a[164:167], a[116:119]
  v_mfma_f32_16x16x32_bf16 a[132:135], v[164:167], a[164:167], a[132:135]
  s_waitcnt vmcnt(19)
  buffer_load_dwordx4 a[164:167], v2, s[40:43], s65 offen offset:1024 sc1
  v_cndmask_b32 v250, v16, v250, vcc
  v_mfma_f32_16x16x32_bf16 a[72:75], v[116:119], a[168:171], a[72:75]
  v_mfma_f32_16x16x32_bf16 a[88:91], v[120:123], a[168:171], a[88:91]
  v_mfma_f32_16x16x32_bf16 a[104:107], v[124:127], a[168:171], a[104:107]
  buffer_load_dwordx4 a[60:63], v2, s[40:43], s14 offen offset:3072 sc1
  v_mfma_f32_16x16x32_bf16 a[120:123], v[160:163], a[168:171], a[120:123]
  v_cndmask_b32 v202, v16, v202, vcc
  v_mfma_f32_16x16x32_bf16 a[136:139], v[164:167], a[168:171], a[136:139]
  buffer_load_dwordx4 a[168:171], v2, s[40:43], s66 offen offset:1024 sc1
  v_cndmask_b32 v253, v17, v253, vcc
  v_mfma_f32_16x16x32_bf16 a[76:79], v[116:119], a[172:175], a[76:79]
  v_mfma_f32_16x16x32_bf16 a[92:95], v[120:123], a[172:175], a[92:95]
  v_mfma_f32_16x16x32_bf16 a[108:111], v[124:127], a[172:175], a[108:111]
  v_mfma_f32_16x16x32_bf16 a[124:127], v[160:163], a[172:175], a[124:127]
  v_mfma_f32_16x16x32_bf16 a[140:143], v[164:167], a[172:175], a[140:143]
  s_waitcnt vmcnt(19)
  buffer_load_dwordx4 a[172:175], v2, s[40:43], s67 offen offset:1024 sc1
  v_mfma_f32_16x16x32_bf16 a[64:67], v[168:171], a[176:179], a[64:67]
  v_readlane_b32 s68, v15, 0
  v_mfma_f32_16x16x32_bf16 a[80:83], v[172:175], a[176:179], a[80:83]
  v_mfma_f32_16x16x32_bf16 a[96:99], v[192:195], a[176:179], a[96:99]
  s_add_u32 s14, s13, 106496
  buffer_load_dwordx4 a[224:227], v2, s[40:43], s14 offen offset:0 sc1
  v_readlane_b32 s69, v15, 1
  v_mfma_f32_16x16x32_bf16 a[112:115], v[196:199], a[176:179], a[112:115]
  v_mfma_f32_16x16x32_bf16 a[128:131], v[208:211], a[176:179], a[128:131]
  buffer_load_dwordx4 a[176:179], v2, s[40:43], s64 offen offset:2048 sc1
  v_mfma_f32_16x16x32_bf16 a[68:71], v[168:171], a[180:183], a[68:71]
  v_readlane_b32 s70, v15, 2
  v_mfma_f32_16x16x32_bf16 a[84:87], v[172:175], a[180:183], a[84:87]
  v_readlane_b32 s71, v15, 3
  v_mfma_f32_16x16x32_bf16 a[100:103], v[192:195], a[180:183], a[100:103]
  v_mfma_f32_16x16x32_bf16 a[116:119], v[196:199], a[180:183], a[116:119]
  v_mfma_f32_16x16x32_bf16 a[132:135], v[208:211], a[180:183], a[132:135]
  s_waitcnt vmcnt(19)
  buffer_load_dwordx4 a[180:183], v2, s[40:43], s65 offen offset:2048 sc1
  v_readlane_b32 s72, v15, 4
  v_mfma_f32_16x16x32_bf16 a[72:75], v[168:171], a[184:187], a[72:75]
  v_mfma_f32_16x16x32_bf16 a[88:91], v[172:175], a[184:187], a[88:91]
  v_mfma_f32_16x16x32_bf16 a[104:107], v[192:195], a[184:187], a[104:107]
  v_mfma_f32_16x16x32_bf16 a[120:123], v[196:199], a[184:187], a[120:123]
  v_readlane_b32 s73, v15, 5
  v_mfma_f32_16x16x32_bf16 a[136:139], v[208:211], a[184:187], a[136:139]
  buffer_load_dwordx4 a[184:187], v2, s[40:43], s66 offen offset:2048 sc1
  v_readlane_b32 s74, v15, 6
  v_mfma_f32_16x16x32_bf16 a[76:79], v[168:171], a[188:191], a[76:79]
  v_mfma_f32_16x16x32_bf16 a[92:95], v[172:175], a[188:191], a[92:95]
  v_mfma_f32_16x16x32_bf16 a[108:111], v[192:195], a[188:191], a[108:111]
  v_mfma_f32_16x16x32_bf16 a[124:127], v[196:199], a[188:191], a[124:127]
  v_mfma_f32_16x16x32_bf16 a[140:143], v[208:211], a[188:191], a[140:143]
  s_waitcnt vmcnt(18)
  buffer_load_dwordx4 a[188:191], v2, s[40:43], s67 offen offset:2048 sc1
  v_mfma_f32_16x16x32_bf16 a[64:67], v[212:215], v[216:219], a[64:67]
  v_readlane_b32 s75, v15, 7
  v_mfma_f32_16x16x32_bf16 a[80:83], v[232:235], v[216:219], a[80:83]
  v_mfma_f32_16x16x32_bf16 a[96:99], v[236:239], v[216:219], a[96:99]
  buffer_load_dwordx4 a[228:231], v2, s[40:43], s14 offen offset:1024 sc1
  v_cmp_eq_u32 s[52:53], s68, v24
  v_mfma_f32_16x16x32_bf16 a[112:115], v[240:243], v[216:219], a[112:115]
  v_mfma_f32_16x16x32_bf16 a[128:131], v[244:247], v[216:219], a[128:131]
  buffer_load_dwordx4 v[216:219], v2, s[40:43], s64 offen offset:3072 sc1
  v_mfma_f32_16x16x32_bf16 a[68:71], v[212:215], v[220:223], a[68:71]
  v_cmp_eq_u32 s[54:55], s68, v25
  v_mfma_f32_16x16x32_bf16 a[84:87], v[232:235], v[220:223], a[84:87]
  v_cmp_eq_u32 s[56:57], s68, v26
  v_mfma_f32_16x16x32_bf16 a[100:103], v[236:239], v[220:223], a[100:103]
  v_mfma_f32_16x16x32_bf16 a[116:119], v[240:243], v[220:223], a[116:119]
  v_mfma_f32_16x16x32_bf16 a[132:135], v[244:247], v[220:223], a[132:135]
  s_waitcnt vmcnt(19)
  buffer_load_dwordx4 v[220:223], v2, s[40:43], s65 offen offset:3072 sc1
  v_cndmask_b32 v27, v27, 0, s[52:53]
  v_mfma_f32_16x16x32_bf16 a[72:75], v[212:215], v[224:227], a[72:75]
  v_mfma_f32_16x16x32_bf16 a[88:91], v[232:235], v[224:227], a[88:91]
  v_mfma_f32_16x16x32_bf16 a[104:107], v[236:239], v[224:227], a[104:107]
  buffer_load_dwordx4 a[232:235], v2, s[40:43], s14 offen offset:2048 sc1
  v_mfma_f32_16x16x32_bf16 a[120:123], v[240:243], v[224:227], a[120:123]
  v_cndmask_b32 v28, v28, 0, s[54:55]
  v_mfma_f32_16x16x32_bf16 a[136:139], v[244:247], v[224:227], a[136:139]
  buffer_load_dwordx4 v[224:227], v2, s[40:43], s66 offen offset:3072 sc1
  v_cndmask_b32 v29, v29, 0, s[56:57]
  v_mfma_f32_16x16x32_bf16 a[76:79], v[212:215], v[228:231], a[76:79]
  v_mfma_f32_16x16x32_bf16 a[92:95], v[232:235], v[228:231], a[92:95]
  v_mfma_f32_16x16x32_bf16 a[108:111], v[236:239], v[228:231], a[108:111]
  v_mfma_f32_16x16x32_bf16 a[124:127], v[240:243], v[228:231], a[124:127]
  v_mfma_f32_16x16x32_bf16 a[140:143], v[244:247], v[228:231], a[140:143]
  s_waitcnt vmcnt(19)
  buffer_load_dwordx4 v[228:231], v2, s[40:43], s67 offen offset:3072 sc1
  v_mfma_f32_16x16x32_bf16 a[64:67], v[64:67], a[144:147], a[64:67]
  s_add_u32 s62, s62, 4096
  v_cmp_eq_u32 s[52:53], s69, v24
  v_mfma_f32_16x16x32_bf16 a[80:83], v[68:71], a[144:147], a[80:83]
  s_and_b32 s62, s62, 0x7fff
  v_mfma_f32_16x16x32_bf16 a[96:99], v[72:75], a[144:147], a[96:99]
  buffer_load_dwordx4 a[236:239], v2, s[40:43], s14 offen offset:3072 sc1
  v_cmp_eq_u32 s[54:55], s69, v25
  v_mfma_f32_16x16x32_bf16 a[112:115], v[76:79], a[144:147], a[112:115]
  s_add_u32 s64, s63, s62
  v_mfma_f32_16x16x32_bf16 a[128:131], v[80:83], a[144:147], a[128:131]
  buffer_load_dwordx4 a[144:147], v2, s[40:43], s64 offen offset:0 sc1
  v_mfma_f32_16x16x32_bf16 a[68:71], v[64:67], a[148:151], a[68:71]
  s_add_u32 s65, s64, 131072
  v_cmp_eq_u32 s[56:57], s69, v26
  v_mfma_f32_16x16x32_bf16 a[84:87], v[68:71], a[148:151], a[84:87]
  s_add_u32 s66, s64, 262144
  v_cndmask_b32 v27, v27, 1, s[52:53]
  v_mfma_f32_16x16x32_bf16 a[100:103], v[72:75], a[148:151], a[100:103]
  v_mfma_f32_16x16x32_bf16 a[116:119], v[76:79], a[148:151], a[116:119]
  v_mfma_f32_16x16x32_bf16 a[132:135], v[80:83], a[148:151], a[132:135]
  s_waitcnt vmcnt(19)
  buffer_load_dwordx4 a[148:151], v2, s[40:43], s65 offen offset:0 sc1
  v_cndmask_b32 v28, v28, 1, s[54:55]
  v_mfma_f32_16x16x32_bf16 a[72:75], v[64:67], a[152:155], a[72:75]
  s_add_u32 s67, s64, 393216
  v_add_u32 v11, s33, v2
  v_mfma_f32_16x16x32_bf16 a[88:91], v[68:71], a[152:155], a[88:91]
  ds_read_b128 a[192:195], v11 offset:0
  v_mfma_f32_16x16x32_bf16 a[104:107], v[72:75], a[152:155], a[104:107]
  s_add_u32 s14, s13, 110592
  buffer_load_dwordx4 a[240:243], v2, s[40:43], s14 offen offset:0 sc1
  v_mfma_f32_16x16x32_bf16 a[120:123], v[76:79], a[152:155], a[120:123]
  s_add_u32 s33, s33, 32768
  ds_read_b128 a[196:199], v11 offset:1024
  v_cndmask_b32 v29, v29, 1, s[56:57]
  v_mfma_f32_16x16x32_bf16 a[136:139], v[80:83], a[152:155], a[136:139]
  buffer_load_dwordx4 a[152:155], v2, s[40:43], s66 offen offset:0 sc1
  v_cmp_eq_u32 s[52:53], s70, v24
  v_mfma_f32_16x16x32_bf16 a[76:79], v[64:67], a[156:159], a[76:79]
  s_and_b32 s33, s33, 0x1ffff
  v_mfma_f32_16x16x32_bf16 a[92:95], v[68:71], a[156:159], a[92:95]
  ds_read_b128 a[200:203], v11 offset:2048
  v_mfma_f32_16x16x32_bf16 a[108:111], v[72:75], a[156:159], a[108:111]
  ds_read_b128 a[204:207], v11 offset:3072
  v_mfma_f32_16x16x32_bf16 a[124:127], v[76:79], a[156:159], a[124:127]
  v_mfma_f32_16x16x32_bf16 a[140:143], v[80:83], a[156:159], a[140:143]
  s_waitcnt vmcnt(19)
  buffer_load_dwordx4 a[156:159], v2, s[40:43], s67 offen offset:0 sc1
  v_mfma_f32_16x16x32_bf16 a[64:67], v[84:87], a[160:163], a[64:67]
  v_cmp_eq_u32 s[54:55], s70, v25
  v_mfma_f32_16x16x32_bf16 a[80:83], v[88:91], a[160:163], a[80:83]
  v_mfma_f32_16x16x32_bf16 a[96:99], v[92:95], a[160:163], a[96:99]
  buffer_load_dwordx4 a[244:247], v2, s[40:43], s14 offen offset:1024 sc1
  v_cmp_eq_u32 s[56:57], s70, v26
  v_mfma_f32_16x16x32_bf16 a[112:115], v[128:131], a[160:163], a[112:115]
  v_mfma_f32_16x16x32_bf16 a[128:131], v[132:135], a[160:163], a[128:131]
  buffer_load_dwordx4 a[160:163], v2, s[40:43], s64 offen offset:1024 sc1
  v_mfma_f32_16x16x32_bf16 a[68:71], v[84:87], a[164:167], a[68:71]
  v_cndmask_b32 v27, v27, 2, s[52:53]
  v_mfma_f32_16x16x32_bf16 a[84:87], v[88:91], a[164:167], a[84:87]
  v_cndmask_b32 v28, v28, 2, s[54:55]
  v_mfma_f32_16x16x32_bf16 a[100:103], v[92:95], a[164:167], a[100:103]
  v_mfma_f32_16x16x32_bf16 a[116:119], v[128:131], a[164:167], a[116:119]
  s_waitcnt lgkmcnt(0)
  v_mfma_f32_16x16x32_bf16 a[132:135], v[132:135], a[164:167], a[132:135]
  s_waitcnt vmcnt(19)
  buffer_load_dwordx4 a[164:167], v2, s[40:43], s65 offen offset:1024 sc1
  v_cndmask_b32 v29, v29, 2, s[56:57]
  v_mfma_f32_16x16x32_bf16 a[72:75], v[84:87], a[168:171], a[72:75]
  v_add_u32 v11, s34, v2
  v_mfma_f32_16x16x32_bf16 a[88:91], v[88:91], a[168:171], a[88:91]
  ds_read_b128 a[208:211], v11 offset:0
  v_mfma_f32_16x16x32_bf16 a[104:107], v[92:95], a[168:171], a[104:107]
  v_mfma_f32_16x16x32_bf16 a[120:123], v[128:131], a[168:171], a[120:123]
  s_add_u32 s34, s34, 32768
  ds_read_b128 a[212:215], v11 offset:1024
  v_cmp_eq_u32 s[52:53], s71, v24
  v_mfma_f32_16x16x32_bf16 a[136:139], v[132:135], a[168:171], a[136:139]
  buffer_load_dwordx4 a[168:171], v2, s[40:43], s66 offen offset:1024 sc1
  v_cmp_eq_u32 s[54:55], s71, v25
  v_mfma_f32_16x16x32_bf16 a[76:79], v[84:87], a[172:175], a[76:79]
  s_and_b32 s34, s34, 0x1ffff
  v_mfma_f32_16x16x32_bf16 a[92:95], v[88:91], a[172:175], a[92:95]
  ds_read_b128 a[216:219], v11 offset:2048
  v_mfma_f32_16x16x32_bf16 a[108:111], v[92:95], a[172:175], a[108:111]
  ds_read_b128 a[220:223], v11 offset:3072
  v_mfma_f32_16x16x32_bf16 a[124:127], v[128:131], a[172:175], a[124:127]
  v_mfma_f32_16x16x32_bf16 a[140:143], v[132:135], a[172:175], a[140:143]
  s_waitcnt vmcnt(18)
  buffer_load_dwordx4 a[172:175], v2, s[40:43], s67 offen offset:1024 sc1
  v_mfma_f32_16x16x32_bf16 a[64:67], v[136:139], a[176:179], a[64:67]
  v_cmp_eq_u32 s[56:57], s71, v26
  v_mfma_f32_16x16x32_bf16 a[80:83], v[140:143], a[176:179], a[80:83]
  v_mfma_f32_16x16x32_bf16 a[96:99], v[144:147], a[176:179], a[96:99]
  buffer_load_dwordx4 a[248:251], v2, s[40:43], s14 offen offset:2048 sc1
  v_cndmask_b32 v27, v27, 3, s[52:53]
  v_mfma_f32_16x16x32_bf16 a[112:115], v[148:151], a[176:179], a[112:115]
  v_mfma_f32_16x16x32_bf16 a[128:131], v[152:155], a[176:179], a[128:131]
  buffer_load_dwordx4 a[176:179], v2, s[40:43], s64 offen offset:2048 sc1
  v_mfma_f32_16x16x32_bf16 a[68:71], v[136:139], a[180:183], a[68:71]
  v_cndmask_b32 v28, v28, 3, s[54:55]
  v_mfma_f32_16x16x32_bf16 a[84:87], v[140:143], a[180:183], a[84:87]
  v_cndmask_b32 v29, v29, 3, s[56:57]
  v_mfma_f32_16x16x32_bf16 a[100:103], v[144:147], a[180:183], a[100:103]
  v_mfma_f32_16x16x32_bf16 a[116:119], v[148:151], a[180:183], a[116:119]
  s_waitcnt lgkmcnt(0)
  v_mfma_f32_16x16x32_bf16 a[132:135], v[152:155], a[180:183], a[132:135]
  s_waitcnt vmcnt(19)
  buffer_load_dwordx4 a[180:183], v2, s[40:43], s65 offen offset:2048 sc1
  v_cmp_eq_u32 s[52:53], s72, v24
  v_mfma_f32_16x16x32_bf16 a[72:75], v[136:139], a[184:187], a[72:75]
  v_add_u32 v11, s33, v2
  v_mfma_f32_16x16x32_bf16 a[88:91], v[140:143], a[184:187], a[88:91]
  ds_read_b128 v[32:35], v11 offset:0
  v_mfma_f32_16x16x32_bf16 a[104:107], v[144:147], a[184:187], a[104:107]
  buffer_load_dwordx4 a[252:255], v2, s[40:43], s14 offen offset:3072 sc1
  v_mfma_f32_16x16x32_bf16 a[120:123], v[148:151], a[184:187], a[120:123]
  s_add_u32 s33, s33, 32768
  ds_read_b128 v[36:39], v11 offset:1024
  v_cmp_eq_u32 s[54:55], s72, v25
  v_mfma_f32_16x16x32_bf16 a[136:139], v[152:155], a[184:187], a[136:139]
  buffer_load_dwordx4 a[184:187], v2, s[40:43], s66 offen offset:2048 sc1
  v_cmp_eq_u32 s[56:57], s72, v26
  v_mfma_f32_16x16x32_bf16 a[76:79], v[136:139], a[188:191], a[76:79]
  s_and_b32 s33, s33, 0x1ffff
  v_mfma_f32_16x16x32_bf16 a[92:95], v[140:143], a[188:191], a[92:95]
  ds_read_b128 v[40:43], v11 offset:2048
  v_mfma_f32_16x16x32_bf16 a[108:111], v[144:147], a[188:191], a[108:111]
  ds_read_b128 v[44:47], v11 offset:3072
  v_mfma_f32_16x16x32_bf16 a[124:127], v[148:151], a[188:191], a[124:127]
  v_mfma_f32_16x16x32_bf16 a[140:143], v[152:155], a[188:191], a[140:143]
  s_waitcnt vmcnt(19)
  buffer_load_dwordx4 a[188:191], v2, s[40:43], s67 offen offset:2048 sc1
  v_mfma_f32_16x16x32_bf16 a[64:67], v[156:159], v[216:219], a[64:67]
  v_cndmask_b32 v27, v27, 4, s[52:53]
  v_mfma_f32_16x16x32_bf16 a[80:83], v[176:179], v[216:219], a[80:83]
  v_mfma_f32_16x16x32_bf16 a[96:99], v[180:183], v[216:219], a[96:99]
  s_add_u32 s14, s13, 122880
  buffer_load_dwordx4 v[96:99], v2, s[40:43], s14 offen offset:0 sc1
  v_cndmask_b32 v28, v28, 4, s[54:55]
  v_mfma_f32_16x16x32_bf16 a[112:115], v[184:187], v[216:219], a[112:115]
  v_mfma_f32_16x16x32_bf16 a[128:131], v[188:191], v[216:219], a[128:131]
  buffer_load_dwordx4 v[216:219], v2, s[40:43], s64 offen offset:3072 sc1
  v_mfma_f32_16x16x32_bf16 a[68:71], v[156:159], v[220:223], a[68:71]
  v_cndmask_b32 v29, v29, 4, s[56:57]
  v_mfma_f32_16x16x32_bf16 a[84:87], v[176:179], v[220:223], a[84:87]
  v_cmp_eq_u32 s[52:53], s73, v24
  v_mfma_f32_16x16x32_bf16 a[100:103], v[180:183], v[220:223], a[100:103]
  v_mfma_f32_16x16x32_bf16 a[116:119], v[184:187], v[220:223], a[116:119]
  s_waitcnt lgkmcnt(0)
  v_mfma_f32_16x16x32_bf16 a[132:135], v[188:191], v[220:223], a[132:135]
  s_waitcnt vmcnt(19)
  buffer_load_dwordx4 v[220:223], v2, s[40:43], s65 offen offset:3072 sc1
  v_cmp_eq_u32 s[54:55], s73, v25
  v_mfma_f32_16x16x32_bf16 a[72:75], v[156:159], v[224:227], a[72:75]
  v_add_u32 v11, s34, v2
  v_mfma_f32_16x16x32_bf16 a[88:91], v[176:179], v[224:227], a[88:91]
  ds_read_b128 v[48:51], v11 offset:0
  v_mfma_f32_16x16x32_bf16 a[104:107], v[180:183], v[224:227], a[104:107]
  buffer_load_dwordx4 v[100:103], v2, s[40:43], s14 offen offset:1024 sc1
  v_mfma_f32_16x16x32_bf16 a[120:123], v[184:187], v[224:227], a[120:123]
  s_add_u32 s34, s34, 32768
  ds_read_b128 v[52:55], v11 offset:1024
  v_cmp_eq_u32 s[56:57], s73, v26
  v_mfma_f32_16x16x32_bf16 a[136:139], v[188:191], v[224:227], a[136:139]
  buffer_load_dwordx4 v[224:227], v2, s[40:43], s66 offen offset:3072 sc1
  v_cndmask_b32 v27, v27, 5, s[52:53]
  v_mfma_f32_16x16x32_bf16 a[76:79], v[156:159], v[228:231], a[76:79]
  s_and_b32 s34, s34, 0x1ffff
  v_mfma_f32_16x16x32_bf16 a[92:95], v[176:179], v[228:231], a[92:95]
  ds_read_b128 v[56:59], v11 offset:2048
  v_mfma_f32_16x16x32_bf16 a[108:111], v[180:183], v[228:231], a[108:111]
  ds_read_b128 v[60:63], v11 offset:3072
  v_mfma_f32_16x16x32_bf16 a[124:127], v[184:187], v[228:231], a[124:127]
  v_mfma_f32_16x16x32_bf16 a[140:143], v[188:191], v[228:231], a[140:143]
  s_waitcnt vmcnt(19)
  buffer_load_dwordx4 v[228:231], v2, s[40:43], s67 offen offset:3072 sc1
  v_mfma_f32_16x16x32_bf16 a[64:67], a[0:3], a[144:147], a[64:67]
  s_add_u32 s62, s62, 4096
  v_cndmask_b32 v28, v28, 5, s[54:55]
  v_mfma_f32_16x16x32_bf16 a[80:83], a[4:7], a[144:147], a[80:83]
  s_and_b32 s62, s62, 0x7fff
  v_mfma_f32_16x16x32_bf16 a[96:99], a[8:11], a[144:147], a[96:99]
  buffer_load_dwordx4 v[104:107], v2, s[40:43], s14 offen offset:2048 sc1
  v_cndmask_b32 v29, v29, 5, s[56:57]
  v_mfma_f32_16x16x32_bf16 a[112:115], a[12:15], a[144:147], a[112:115]
  s_add_u32 s64, s63, s62
  v_mfma_f32_16x16x32_bf16 a[128:131], a[16:19], a[144:147], a[128:131]
  buffer_load_dwordx4 a[144:147], v2, s[40:43], s64 offen offset:0 sc1
  v_mfma_f32_16x16x32_bf16 a[68:71], a[0:3], a[148:151], a[68:71]
  s_add_u32 s65, s64, 131072
  v_cmp_eq_u32 s[52:53], s74, v24
  v_mfma_f32_16x16x32_bf16 a[84:87], a[4:7], a[148:151], a[84:87]
  s_add_u32 s66, s64, 262144
  v_cmp_eq_u32 s[54:55], s74, v25
  v_mfma_f32_16x16x32_bf16 a[100:103], a[8:11], a[148:151], a[100:103]
  v_mfma_f32_16x16x32_bf16 a[116:119], a[12:15], a[148:151], a[116:119]
  s_waitcnt lgkmcnt(0)
  v_mfma_f32_16x16x32_bf16 a[132:135], a[16:19], a[148:151], a[132:135]
  s_waitcnt vmcnt(19)
  buffer_load_dwordx4 a[148:151], v2, s[40:43], s65 offen offset:0 sc1
  v_cmp_eq_u32 s[56:57], s74, v26
  v_mfma_f32_16x16x32_bf16 a[72:75], a[0:3], a[152:155], a[72:75]
  s_add_u32 s67, s64, 393216
  v_add_u32 v11, s33, v2
  v_mfma_f32_16x16x32_bf16 a[88:91], a[4:7], a[152:155], a[88:91]
  ds_read_b128 v[160:163], v11 offset:0
  v_mfma_f32_16x16x32_bf16 a[104:107], a[8:11], a[152:155], a[104:107]
  buffer_load_dwordx4 v[108:111], v2, s[40:43], s14 offen offset:3072 sc1
  v_mfma_f32_16x16x32_bf16 a[120:123], a[12:15], a[152:155], a[120:123]
  s_add_u32 s33, s33, 32768
  ds_read_b128 v[164:167], v11 offset:1024
  v_cndmask_b32 v27, v27, 6, s[52:53]
  v_mfma_f32_16x16x32_bf16 a[136:139], a[16:19], a[152:155], a[136:139]
  buffer_load_dwordx4 a[152:155], v2, s[40:43], s66 offen offset:0 sc1
  v_cndmask_b32 v28, v28, 6, s[54:55]
  v_mfma_f32_16x16x32_bf16 a[76:79], a[0:3], a[156:159], a[76:79]
  s_and_b32 s33, s33, 0x1ffff
  v_mfma_f32_16x16x32_bf16 a[92:95], a[4:7], a[156:159], a[92:95]
  ds_read_b128 v[168:171], v11 offset:2048
  v_mfma_f32_16x16x32_bf16 a[108:111], a[8:11], a[156:159], a[108:111]
  ds_read_b128 v[172:175], v11 offset:3072
  v_mfma_f32_16x16x32_bf16 a[124:127], a[12:15], a[156:159], a[124:127]
  v_mfma_f32_16x16x32_bf16 a[140:143], a[16:19], a[156:159], a[140:143]
  s_waitcnt vmcnt(19)
  buffer_load_dwordx4 a[156:159], v2, s[40:43], s67 offen offset:0 sc1
  v_mfma_f32_16x16x32_bf16 a[64:67], a[20:23], a[160:163], a[64:67]
  v_cndmask_b32 v29, v29, 6, s[56:57]
  v_mfma_f32_16x16x32_bf16 a[80:83], a[24:27], a[160:163], a[80:83]
  v_mfma_f32_16x16x32_bf16 a[96:99], a[28:31], a[160:163], a[96:99]
  s_add_u32 s14, s13, 126976
  buffer_load_dwordx4 v[112:115], v2, s[40:43], s14 offen offset:0 sc1
  v_cmp_eq_u32 s[52:53], s75, v24
  v_mfma_f32_16x16x32_bf16 a[112:115], a[32:35], a[160:163], a[112:115]
  v_mfma_f32_16x16x32_bf16 a[128:131], a[36:39], a[160:163], a[128:131]
  buffer_load_dwordx4 a[160:163], v2, s[40:43], s64 offen offset:1024 sc1
  v_mfma_f32_16x16x32_bf16 a[68:71], a[20:23], a[164:167], a[68:71]
  v_cmp_eq_u32 s[54:55], s75, v25
  v_mfma_f32_16x16x32_bf16 a[84:87], a[24:27], a[164:167], a[84:87]
  v_cmp_eq_u32 s[56:57], s75, v26
  v_mfma_f32_16x16x32_bf16 a[100:103], a[28:31], a[164:167], a[100:103]
  v_mfma_f32_16x16x32_bf16 a[116:119], a[32:35], a[164:167], a[116:119]
  s_waitcnt lgkmcnt(0)
  v_mfma_f32_16x16x32_bf16 a[132:135], a[36:39], a[164:167], a[132:135]
  s_waitcnt vmcnt(20)
  buffer_load_dwordx4 a[164:167], v2, s[40:43], s65 offen offset:1024 sc1
  v_cndmask_b32 v27, v27, 7, s[52:53]
  v_mfma_f32_16x16x32_bf16 a[72:75], a[20:23], a[168:171], a[72:75]
  v_add_u32 v11, s34, v2
  v_mfma_f32_16x16x32_bf16 a[88:91], a[24:27], a[168:171], a[88:91]
  ds_read_b128 v[192:195], v11 offset:0
  v_mfma_f32_16x16x32_bf16 a[104:107], a[28:31], a[168:171], a[104:107]
  v_mfma_f32_16x16x32_bf16 a[120:123], a[32:35], a[168:171], a[120:123]
  s_add_u32 s34, s34, 32768
  ds_read_b128 v[196:199], v11 offset:1024
  v_cndmask_b32 v28, v28, 7, s[54:55]
  v_mfma_f32_16x16x32_bf16 a[136:139], a[36:39], a[168:171], a[136:139]
  buffer_load_dwordx4 a[168:171], v2, s[40:43], s66 offen offset:1024 sc1
  v_cndmask_b32 v29, v29, 7, s[56:57]
  v_mfma_f32_16x16x32_bf16 a[76:79], a[20:23], a[172:175], a[76:79]
  s_and_b32 s34, s34, 0x1ffff
  v_mfma_f32_16x16x32_bf16 a[92:95], a[24:27], a[172:175], a[92:95]
  ds_read_b128 v[208:211], v11 offset:2048
  v_mfma_f32_16x16x32_bf16 a[108:111], a[28:31], a[172:175], a[108:111]
  ds_read_b128 v[212:215], v11 offset:3072
  v_mfma_f32_16x16x32_bf16 a[124:127], a[32:35], a[172:175], a[124:127]
  v_mfma_f32_16x16x32_bf16 a[140:143], a[36:39], a[172:175], a[140:143]
  s_waitcnt vmcnt(19)
  buffer_load_dwordx4 a[172:175], v2, s[40:43], s67 offen offset:1024 sc1
  v_mfma_f32_16x16x32_bf16 a[64:67], a[40:43], a[176:179], a[64:67]
  v_mul_u32_u24 v27, 320, v27
  v_mfma_f32_16x16x32_bf16 a[80:83], a[44:47], a[176:179], a[80:83]
  v_mfma_f32_16x16x32_bf16 a[96:99], a[48:51], a[176:179], a[96:99]
  buffer_load_dwordx4 v[116:119], v2, s[40:43], s14 offen offset:1024 sc1
  v_add_u32 v203, v203, v27
  v_mfma_f32_16x16x32_bf16 a[112:115], a[52:55], a[176:179], a[112:115]
  v_mfma_f32_16x16x32_bf16 a[128:131], a[56:59], a[176:179], a[128:131]
  buffer_load_dwordx4 a[176:179], v2, s[40:43], s64 offen offset:2048 sc1
  v_mfma_f32_16x16x32_bf16 a[68:71], a[40:43], a[180:183], a[68:71]
  v_add_u32 v203, 155648, v203
  v_mfma_f32_16x16x32_bf16 a[84:87], a[44:47], a[180:183], a[84:87]
  v_mul_u32_u24 v28, 320, v28
  v_mfma_f32_16x16x32_bf16 a[100:103], a[48:51], a[180:183], a[100:103]
  v_mfma_f32_16x16x32_bf16 a[116:119], a[52:55], a[180:183], a[116:119]
  s_waitcnt lgkmcnt(0)
  v_mfma_f32_16x16x32_bf16 a[132:135], a[56:59], a[180:183], a[132:135]
  s_waitcnt vmcnt(19)
  buffer_load_dwordx4 a[180:183], v2, s[40:43], s65 offen offset:2048 sc1
  v_add_u32 v204, v204, v28
  v_mfma_f32_16x16x32_bf16 a[72:75], a[40:43], a[184:187], a[72:75]
  v_add_u32 v11, s33, v2
  v_mfma_f32_16x16x32_bf16 a[88:91], a[44:47], a[184:187], a[88:91]
  ds_read_b128 v[80:83], v11 offset:0
  v_mfma_f32_16x16x32_bf16 a[104:107], a[48:51], a[184:187], a[104:107]
  buffer_load_dwordx4 v[120:123], v2, s[40:43], s14 offen offset:2048 sc1
  v_mfma_f32_16x16x32_bf16 a[120:123], a[52:55], a[184:187], a[120:123]
  s_add_u32 s33, s33, 32768
  ds_read_b128 v[84:87], v11 offset:1024
  v_add_u32 v204, 155648, v204
  v_mfma_f32_16x16x32_bf16 a[136:139], a[56:59], a[184:187], a[136:139]
  buffer_load_dwordx4 a[184:187], v2, s[40:43], s66 offen offset:2048 sc1
  v_mul_u32_u24 v29, 320, v29
  v_mfma_f32_16x16x32_bf16 a[76:79], a[40:43], a[188:191], a[76:79]
  s_and_b32 s33, s33, 0x1ffff
  v_mfma_f32_16x16x32_bf16 a[92:95], a[44:47], a[188:191], a[92:95]
  ds_read_b128 v[88:91], v11 offset:2048
  v_mfma_f32_16x16x32_bf16 a[108:111], a[48:51], a[188:191], a[108:111]
  ds_read_b128 v[92:95], v11 offset:3072
  v_mfma_f32_16x16x32_bf16 a[124:127], a[52:55], a[188:191], a[124:127]
  v_mfma_f32_16x16x32_bf16 a[140:143], a[56:59], a[188:191], a[140:143]
  s_waitcnt vmcnt(19)
  buffer_load_dwordx4 a[188:191], v2, s[40:43], s67 offen offset:2048 sc1
  v_mfma_f32_16x16x32_bf16 a[64:67], a[60:63], v[216:219], a[64:67]
  v_add_u32 v205, v205, v29
  v_mfma_f32_16x16x32_bf16 a[80:83], a[192:195], v[216:219], a[80:83]
  v_mfma_f32_16x16x32_bf16 a[96:99], a[196:199], v[216:219], a[96:99]
  buffer_load_dwordx4 v[124:127], v2, s[40:43], s14 offen offset:3072 sc1
  v_add_u32 v205, 155648, v205
  v_mfma_f32_16x16x32_bf16 a[112:115], a[200:203], v[216:219], a[112:115]
  v_mfma_f32_16x16x32_bf16 a[128:131], a[204:207], v[216:219], a[128:131]
  buffer_load_dwordx4 v[216:219], v2, s[40:43], s64 offen offset:3072 sc1
  v_mfma_f32_16x16x32_bf16 a[68:71], a[60:63], v[220:223], a[68:71]
  v_mfma_f32_16x16x32_bf16 a[84:87], a[192:195], v[220:223], a[84:87]
  v_mfma_f32_16x16x32_bf16 a[100:103], a[196:199], v[220:223], a[100:103]
  v_mfma_f32_16x16x32_bf16 a[116:119], a[200:203], v[220:223], a[116:119]
  s_waitcnt lgkmcnt(0)
  v_mfma_f32_16x16x32_bf16 a[132:135], a[204:207], v[220:223], a[132:135]
  s_waitcnt vmcnt(19)
  buffer_load_dwordx4 v[220:223], v2, s[40:43], s65 offen offset:3072 sc1
  v_mfma_f32_16x16x32_bf16 a[72:75], a[60:63], v[224:227], a[72:75]
  v_add_u32 v11, s34, v2
  v_mfma_f32_16x16x32_bf16 a[88:91], a[192:195], v[224:227], a[88:91]
  ds_read_b128 v[128:131], v11 offset:0
  v_mfma_f32_16x16x32_bf16 a[104:107], a[196:199], v[224:227], a[104:107]
  s_add_u32 s14, s13, 139264
  buffer_load_dwordx4 v[232:235], v2, s[40:43], s14 offen offset:0 sc1
  v_mfma_f32_16x16x32_bf16 a[120:123], a[200:203], v[224:227], a[120:123]
  s_add_u32 s34, s34, 32768
  ds_read_b128 v[132:135], v11 offset:1024
  v_mfma_f32_16x16x32_bf16 a[136:139], a[204:207], v[224:227], a[136:139]
  buffer_load_dwordx4 v[224:227], v2, s[40:43], s66 offen offset:3072 sc1
  v_mfma_f32_16x16x32_bf16 a[76:79], a[60:63], v[228:231], a[76:79]
  s_and_b32 s34, s34, 0x1ffff
  v_mfma_f32_16x16x32_bf16 a[92:95], a[192:195], v[228:231], a[92:95]
  ds_read_b128 v[136:139], v11 offset:2048
  v_mfma_f32_16x16x32_bf16 a[108:111], a[196:199], v[228:231], a[108:111]
  ds_read_b128 v[140:143], v11 offset:3072
  v_mfma_f32_16x16x32_bf16 a[124:127], a[200:203], v[228:231], a[124:127]
  v_mfma_f32_16x16x32_bf16 a[140:143], a[204:207], v[228:231], a[140:143]
  s_waitcnt vmcnt(19)
  buffer_load_dwordx4 v[228:231], v2, s[40:43], s67 offen offset:3072 sc1
  v_mfma_f32_16x16x32_bf16 a[64:67], a[208:211], a[144:147], a[64:67]
  s_add_u32 s62, s62, 4096
  v_mfma_f32_16x16x32_bf16 a[80:83], a[212:215], a[144:147], a[80:83]
  s_and_b32 s62, s62, 0x7fff
  v_mfma_f32_16x16x32_bf16 a[96:99], a[216:219], a[144:147], a[96:99]
  buffer_load_dwordx4 v[236:239], v2, s[40:43], s14 offen offset:1024 sc1
  v_mfma_f32_16x16x32_bf16 a[112:115], a[220:223], a[144:147], a[112:115]
  s_add_u32 s64, s63, s62
  v_mfma_f32_16x16x32_bf16 a[128:131], a[224:227], a[144:147], a[128:131]
  buffer_load_dwordx4 a[144:147], v2, s[40:43], s64 offen offset:0 sc1
  v_mfma_f32_16x16x32_bf16 a[68:71], a[208:211], a[148:151], a[68:71]
  s_add_u32 s65, s64, 131072
  v_mfma_f32_16x16x32_bf16 a[84:87], a[212:215], a[148:151], a[84:87]
  s_add_u32 s66, s64, 262144
  v_mfma_f32_16x16x32_bf16 a[100:103], a[216:219], a[148:151], a[100:103]
  v_mfma_f32_16x16x32_bf16 a[116:119], a[220:223], a[148:151], a[116:119]
  s_waitcnt lgkmcnt(0)
  v_mfma_f32_16x16x32_bf16 a[132:135], a[224:227], a[148:151], a[132:135]
  s_waitcnt vmcnt(19)
  buffer_load_dwordx4 a[148:151], v2, s[40:43], s65 offen offset:0 sc1
  v_mfma_f32_16x16x32_bf16 a[72:75], a[208:211], a[152:155], a[72:75]
  s_add_u32 s67, s64, 393216
  v_add_u32 v11, s35, v2
  v_mfma_f32_16x16x32_bf16 a[88:91], a[212:215], a[152:155], a[88:91]
  ds_read_b128 v[144:147], v11 offset:0
  v_mfma_f32_16x16x32_bf16 a[104:107], a[216:219], a[152:155], a[104:107]
  v_mfma_f32_16x16x32_bf16 a[120:123], a[220:223], a[152:155], a[120:123]
  ds_read_b128 v[148:151], v11 offset:1024
  v_mfma_f32_16x16x32_bf16 a[136:139], a[224:227], a[152:155], a[136:139]
  buffer_load_dwordx4 a[152:155], v2, s[40:43], s66 offen offset:0 sc1
  v_mfma_f32_16x16x32_bf16 a[76:79], a[208:211], a[156:159], a[76:79]
  v_mfma_f32_16x16x32_bf16 a[92:95], a[212:215], a[156:159], a[92:95]
  ds_read_b128 v[152:155], v11 offset:2048
  v_mfma_f32_16x16x32_bf16 a[108:111], a[216:219], a[156:159], a[108:111]
  ds_read_b128 v[156:159], v11 offset:3072
  v_mfma_f32_16x16x32_bf16 a[124:127], a[220:223], a[156:159], a[124:127]
  v_mfma_f32_16x16x32_bf16 a[140:143], a[224:227], a[156:159], a[140:143]
  s_waitcnt vmcnt(18)
  buffer_load_dwordx4 a[156:159], v2, s[40:43], s67 offen offset:0 sc1
  v_mfma_f32_16x16x32_bf16 a[64:67], a[228:231], a[160:163], a[64:67]
  v_mfma_f32_16x16x32_bf16 a[80:83], a[232:235], a[160:163], a[80:83]
  v_mfma_f32_16x16x32_bf16 a[96:99], a[236:239], a[160:163], a[96:99]
  buffer_load_dwordx4 v[240:243], v2, s[40:43], s14 offen offset:2048 sc1
  v_mfma_f32_16x16x32_bf16 a[112:115], a[240:243], a[160:163], a[112:115]
  v_mfma_f32_16x16x32_bf16 a[128:131], a[244:247], a[160:163], a[128:131]
  buffer_load_dwordx4 a[160:163], v2, s[40:43], s64 offen offset:1024 sc1
  v_mfma_f32_16x16x32_bf16 a[68:71], a[228:231], a[164:167], a[68:71]
  v_mfma_f32_16x16x32_bf16 a[84:87], a[232:235], a[164:167], a[84:87]
  v_mfma_f32_16x16x32_bf16 a[100:103], a[236:239], a[164:167], a[100:103]
  v_mfma_f32_16x16x32_bf16 a[116:119], a[240:243], a[164:167], a[116:119]
  s_waitcnt lgkmcnt(0)
  v_mfma_f32_16x16x32_bf16 a[132:135], a[244:247], a[164:167], a[132:135]
  s_waitcnt vmcnt(19)
  buffer_load_dwordx4 a[164:167], v2, s[40:43], s65 offen offset:1024 sc1
  v_mfma_f32_16x16x32_bf16 a[72:75], a[228:231], a[168:171], a[72:75]
  v_mfma_f32_16x16x32_bf16 a[88:91], a[232:235], a[168:171], a[88:91]
  v_mfma_f32_16x16x32_bf16 a[104:107], a[236:239], a[168:171], a[104:107]
  buffer_load_dwordx4 v[244:247], v2, s[40:43], s14 offen offset:3072 sc1
  v_mfma_f32_16x16x32_bf16 a[120:123], a[240:243], a[168:171], a[120:123]
  v_mfma_f32_16x16x32_bf16 a[136:139], a[244:247], a[168:171], a[136:139]
  buffer_load_dwordx4 a[168:171], v2, s[40:43], s66 offen offset:1024 sc1
  v_mfma_f32_16x16x32_bf16 a[76:79], a[228:231], a[172:175], a[76:79]
  v_mfma_f32_16x16x32_bf16 a[92:95], a[232:235], a[172:175], a[92:95]
  v_mfma_f32_16x16x32_bf16 a[108:111], a[236:239], a[172:175], a[108:111]
  v_mfma_f32_16x16x32_bf16 a[124:127], a[240:243], a[172:175], a[124:127]
  v_mfma_f32_16x16x32_bf16 a[140:143], a[244:247], a[172:175], a[140:143]
  s_waitcnt vmcnt(19)
  buffer_load_dwordx4 a[172:175], v2, s[40:43], s67 offen offset:1024 sc1
  v_mfma_f32_16x16x32_bf16 a[64:67], a[248:251], a[176:179], a[64:67]
  v_mfma_f32_16x16x32_bf16 a[80:83], a[252:255], a[176:179], a[80:83]
  v_mfma_f32_16x16x32_bf16 a[96:99], v[32:35], a[176:179], a[96:99]
  s_add_u32 s14, s13, 143360
  buffer_load_dwordx4 v[64:67], v2, s[40:43], s14 offen offset:0 sc1
  v_mfma_f32_16x16x32_bf16 a[112:115], v[36:39], a[176:179], a[112:115]
  v_mfma_f32_16x16x32_bf16 a[128:131], v[40:43], a[176:179], a[128:131]
  buffer_load_dwordx4 a[176:179], v2, s[40:43], s64 offen offset:2048 sc1
  v_mfma_f32_16x16x32_bf16 a[68:71], a[248:251], a[180:183], a[68:71]
  v_mfma_f32_16x16x32_bf16 a[84:87], a[252:255], a[180:183], a[84:87]
  v_mfma_f32_16x16x32_bf16 a[100:103], v[32:35], a[180:183], a[100:103]
  v_mfma_f32_16x16x32_bf16 a[116:119], v[36:39], a[180:183], a[116:119]
  s_waitcnt lgkmcnt(0)
  v_mfma_f32_16x16x32_bf16 a[132:135], v[40:43], a[180:183], a[132:135]
  s_waitcnt vmcnt(19)
  buffer_load_dwordx4 a[180:183], v2, s[40:43], s65 offen offset:2048 sc1
  v_mfma_f32_16x16x32_bf16 a[72:75], a[248:251], a[184:187], a[72:75]
  v_mfma_f32_16x16x32_bf16 a[88:91], a[252:255], a[184:187], a[88:91]
  v_mfma_f32_16x16x32_bf16 a[104:107], v[32:35], a[184:187], a[104:107]
  buffer_load_dwordx4 v[68:71], v2, s[40:43], s14 offen offset:1024 sc1
  v_mfma_f32_16x16x32_bf16 a[120:123], v[36:39], a[184:187], a[120:123]
  v_mfma_f32_16x16x32_bf16 a[136:139], v[40:43], a[184:187], a[136:139]
  buffer_load_dwordx4 a[184:187], v2, s[40:43], s66 offen offset:2048 sc1
  v_mfma_f32_16x16x32_bf16 a[76:79], a[248:251], a[188:191], a[76:79]
  v_mfma_f32_16x16x32_bf16 a[92:95], a[252:255], a[188:191], a[92:95]
  v_mfma_f32_16x16x32_bf16 a[108:111], v[32:35], a[188:191], a[108:111]
  v_mfma_f32_16x16x32_bf16 a[124:127], v[36:39], a[188:191], a[124:127]
  v_mfma_f32_16x16x32_bf16 a[140:143], v[40:43], a[188:191], a[140:143]
  s_waitcnt vmcnt(19)
  buffer_load_dwordx4 a[188:191], v2, s[40:43], s67 offen offset:2048 sc1
  v_mfma_f32_16x16x32_bf16 a[64:67], v[44:47], v[216:219], a[64:67]
  v_mfma_f32_16x16x32_bf16 a[80:83], v[48:51], v[216:219], a[80:83]
  v_mfma_f32_16x16x32_bf16 a[96:99], v[52:55], v[216:219], a[96:99]
  buffer_load_dwordx4 v[72:75], v2, s[40:43], s14 offen offset:2048 sc1
  v_mfma_f32_16x16x32_bf16 a[112:115], v[56:59], v[216:219], a[112:115]
  v_mfma_f32_16x16x32_bf16 a[128:131], v[60:63], v[216:219], a[128:131]
  buffer_load_dwordx4 v[216:219], v2, s[40:43], s64 offen offset:3072 sc1
  v_mfma_f32_16x16x32_bf16 a[68:71], v[44:47], v[220:223], a[68:71]
  v_mfma_f32_16x16x32_bf16 a[84:87], v[48:51], v[220:223], a[84:87]
  v_mfma_f32_16x16x32_bf16 a[100:103], v[52:55], v[220:223], a[100:103]
  v_mfma_f32_16x16x32_bf16 a[116:119], v[56:59], v[220:223], a[116:119]
  s_barrier
  v_mfma_f32_16x16x32_bf16 a[132:135], v[60:63], v[220:223], a[132:135]
  s_waitcnt vmcnt(19)
  buffer_load_dwordx4 v[220:223], v2, s[40:43], s65 offen offset:3072 sc1
  v_mfma_f32_16x16x32_bf16 a[72:75], v[44:47], v[224:227], a[72:75]
  v_mfma_f32_16x16x32_bf16 a[88:91], v[48:51], v[224:227], a[88:91]
  v_mfma_f32_16x16x32_bf16 a[104:107], v[52:55], v[224:227], a[104:107]
  v_mfma_f32_16x16x32_bf16 a[120:123], v[56:59], v[224:227], a[120:123]
  v_mfma_f32_16x16x32_bf16 a[136:139], v[60:63], v[224:227], a[136:139]
  buffer_load_dwordx4 v[224:227], v2, s[40:43], s66 offen offset:3072 sc1
  v_mfma_f32_16x16x32_bf16 a[76:79], v[44:47], v[228:231], a[76:79]
  v_mfma_f32_16x16x32_bf16 a[92:95], v[48:51], v[228:231], a[92:95]
  v_mfma_f32_16x16x32_bf16 a[108:111], v[52:55], v[228:231], a[108:111]
  v_mfma_f32_16x16x32_bf16 a[124:127], v[56:59], v[228:231], a[124:127]
  v_mfma_f32_16x16x32_bf16 a[140:143], v[60:63], v[228:231], a[140:143]
  s_waitcnt vmcnt(18)
  buffer_load_dwordx4 v[228:231], v2, s[40:43], s67 offen offset:3072 sc1
  v_mfma_f32_16x16x32_bf16 a[64:67], v[96:99], a[144:147], a[64:67]
  s_add_u32 s62, s62, 4096
  v_mfma_f32_16x16x32_bf16 a[80:83], v[100:103], a[144:147], a[80:83]
  s_and_b32 s62, s62, 0x7fff
  v_mfma_f32_16x16x32_bf16 a[96:99], v[104:107], a[144:147], a[96:99]
  buffer_load_dwordx4 v[76:79], v2, s[40:43], s14 offen offset:3072 sc1
  v_mfma_f32_16x16x32_bf16 a[112:115], v[108:111], a[144:147], a[112:115]
  s_add_u32 s64, s63, s62
  v_mfma_f32_16x16x32_bf16 a[128:131], v[112:115], a[144:147], a[128:131]
  buffer_load_dwordx4 a[144:147], v2, s[40:43], s64 offen offset:0 sc1
  v_mfma_f32_16x16x32_bf16 a[68:71], v[96:99], a[148:151], a[68:71]
  s_add_u32 s65, s64, 131072
  v_mfma_f32_16x16x32_bf16 a[84:87], v[100:103], a[148:151], a[84:87]
  s_add_u32 s66, s64, 262144
  v_mfma_f32_16x16x32_bf16 a[100:103], v[104:107], a[148:151], a[100:103]
  v_mfma_f32_16x16x32_bf16 a[116:119], v[108:111], a[148:151], a[116:119]
  v_mfma_f32_16x16x32_bf16 a[132:135], v[112:115], a[148:151], a[132:135]
  s_waitcnt vmcnt(19)
  buffer_load_dwordx4 a[148:151], v2, s[40:43], s65 offen offset:0 sc1
  v_mfma_f32_16x16x32_bf16 a[72:75], v[96:99], a[152:155], a[72:75]
  s_add_u32 s67, s64, 393216
  v_mfma_f32_16x16x32_bf16 a[88:91], v[100:103], a[152:155], a[88:91]
  v_mfma_f32_16x16x32_bf16 a[104:107], v[104:107], a[152:155], a[104:107]
  s_add_u32 s14, s13, 159744
  buffer_load_dwordx4 v[176:179], v2, s[40:43], s14 offen offset:0 sc1
  v_mfma_f32_16x16x32_bf16 a[120:123], v[108:111], a[152:155], a[120:123]
  v_mfma_f32_16x16x32_bf16 a[136:139], v[112:115], a[152:155], a[136:139]
  buffer_load_dwordx4 a[152:155], v2, s[40:43], s66 offen offset:0 sc1
  v_mfma_f32_16x16x32_bf16 a[76:79], v[96:99], a[156:159], a[76:79]
  v_mfma_f32_16x16x32_bf16 a[92:95], v[100:103], a[156:159], a[92:95]
  v_mfma_f32_16x16x32_bf16 a[108:111], v[104:107], a[156:159], a[108:111]
  v_mfma_f32_16x16x32_bf16 a[124:127], v[108:111], a[156:159], a[124:127]
  v_mfma_f32_16x16x32_bf16 a[140:143], v[112:115], a[156:159], a[140:143]
  s_waitcnt vmcnt(19)
  buffer_load_dwordx4 a[156:159], v2, s[40:43], s67 offen offset:0 sc1
  v_mfma_f32_16x16x32_bf16 a[64:67], v[116:119], a[160:163], a[64:67]
  v_mfma_f32_16x16x32_bf16 a[80:83], v[120:123], a[160:163], a[80:83]
  v_mfma_f32_16x16x32_bf16 a[96:99], v[124:127], a[160:163], a[96:99]
  buffer_load_dwordx4 v[180:183], v2, s[40:43], s14 offen offset:1024 sc1
  v_mfma_f32_16x16x32_bf16 a[112:115], v[160:163], a[160:163], a[112:115]
  v_mfma_f32_16x16x32_bf16 a[128:131], v[164:167], a[160:163], a[128:131]
  buffer_load_dwordx4 a[160:163], v2, s[40:43], s64 offen offset:1024 sc1
  v_mfma_f32_16x16x32_bf16 a[68:71], v[116:119], a[164:167], a[68:71]
  v_mfma_f32_16x16x32_bf16 a[84:87], v[120:123], a[164:167], a[84:87]
  v_mfma_f32_16x16x32_bf16 a[100:103], v[124:127], a[164:167], a[100:103]
  v_mfma_f32_16x16x32_bf16 a[116:119], v[160:163], a[164:167], a[116:119]
  v_mfma_f32_16x16x32_bf16 a[132:135], v[164:167], a[164:167], a[132:135]
  s_waitcnt vmcnt(19)
  buffer_load_dwordx4 a[164:167], v2, s[40:43], s65 offen offset:1024 sc1
  v_mfma_f32_16x16x32_bf16 a[72:75], v[116:119], a[168:171], a[72:75]
  v_mfma_f32_16x16x32_bf16 a[88:91], v[120:123], a[168:171], a[88:91]
  v_mfma_f32_16x16x32_bf16 a[104:107], v[124:127], a[168:171], a[104:107]
  buffer_load_dwordx4 v[184:187], v2, s[40:43], s14 offen offset:2048 sc1
  v_mfma_f32_16x16x32_bf16 a[120:123], v[160:163], a[168:171], a[120:123]
  v_mfma_f32_16x16x32_bf16 a[136:139], v[164:167], a[168:171], a[136:139]
  buffer_load_dwordx4 a[168:171], v2, s[40:43], s66 offen offset:1024 sc1
  v_mfma_f32_16x16x32_bf16 a[76:79], v[116:119], a[172:175], a[76:79]
  v_mfma_f32_16x16x32_bf16 a[92:95], v[120:123], a[172:175], a[92:95]
  v_mfma_f32_16x16x32_bf16 a[108:111], v[124:127], a[172:175], a[108:111]
  v_mfma_f32_16x16x32_bf16 a[124:127], v[160:163], a[172:175], a[124:127]
  v_mfma_f32_16x16x32_bf16 a[140:143], v[164:167], a[172:175], a[140:143]
  s_waitcnt vmcnt(19)
  buffer_load_dwordx4 a[172:175], v2, s[40:43], s67 offen offset:1024 sc1
  v_mfma_f32_16x16x32_bf16 a[64:67], v[168:171], a[176:179], a[64:67]
  v_mfma_f32_16x16x32_bf16 a[80:83], v[172:175], a[176:179], a[80:83]
  buffer_load_dwordx4 v[32:35], v248, s[44:47], 0 offen
  v_mfma_f32_16x16x32_bf16 a[96:99], v[192:195], a[176:179], a[96:99]
  buffer_load_dwordx4 v[188:191], v2, s[40:43], s14 offen offset:3072 sc1
  v_mfma_f32_16x16x32_bf16 a[112:115], v[196:199], a[176:179], a[112:115]
  v_mfma_f32_16x16x32_bf16 a[128:131], v[208:211], a[176:179], a[128:131]
  buffer_load_dwordx4 a[176:179], v2, s[40:43], s64 offen offset:2048 sc1
  v_mfma_f32_16x16x32_bf16 a[68:71], v[168:171], a[180:183], a[68:71]
  v_mfma_f32_16x16x32_bf16 a[84:87], v[172:175], a[180:183], a[84:87]
  v_mfma_f32_16x16x32_bf16 a[100:103], v[192:195], a[180:183], a[100:103]
  v_mfma_f32_16x16x32_bf16 a[116:119], v[196:199], a[180:183], a[116:119]
  v_mfma_f32_16x16x32_bf16 a[132:135], v[208:211], a[180:183], a[132:135]
  s_waitcnt vmcnt(20)
  buffer_load_dwordx4 a[180:183], v2, s[40:43], s65 offen offset:2048 sc1
  v_mfma_f32_16x16x32_bf16 a[72:75], v[168:171], a[184:187], a[72:75]
  v_mfma_f32_16x16x32_bf16 a[88:91], v[172:175], a[184:187], a[88:91]
  buffer_load_dwordx4 v[44:47], v200, s[40:43], s27 offen sc1
  v_mfma_f32_16x16x32_bf16 a[104:107], v[192:195], a[184:187], a[104:107]
  v_mfma_f32_16x16x32_bf16 a[120:123], v[196:199], a[184:187], a[120:123]
  v_mfma_f32_16x16x32_bf16 a[136:139], v[208:211], a[184:187], a[136:139]
  buffer_load_dwordx4 a[184:187], v2, s[40:43], s66 offen offset:2048 sc1
  v_mfma_f32_16x16x32_bf16 a[76:79], v[168:171], a[188:191], a[76:79]
  v_mfma_f32_16x16x32_bf16 a[92:95], v[172:175], a[188:191], a[92:95]
  v_mfma_f32_16x16x32_bf16 a[108:111], v[192:195], a[188:191], a[108:111]
  v_mfma_f32_16x16x32_bf16 a[124:127], v[196:199], a[188:191], a[124:127]
  v_mfma_f32_16x16x32_bf16 a[140:143], v[208:211], a[188:191], a[140:143]
  s_waitcnt vmcnt(20)
  buffer_load_dwordx4 a[188:191], v2, s[40:43], s67 offen offset:2048 sc1
  v_mfma_f32_16x16x32_bf16 a[64:67], v[212:215], v[216:219], a[64:67]
  ds_read_b128 v[120:123], v203 offset:0
  v_mfma_f32_16x16x32_bf16 a[80:83], v[232:235], v[216:219], a[80:83]
  buffer_load_dwordx4 v[36:39], v249, s[44:47], 0 offen
  v_mfma_f32_16x16x32_bf16 a[96:99], v[236:239], v[216:219], a[96:99]
  v_add_u32 v20, 43008, v251
  v_mfma_f32_16x16x32_bf16 a[112:115], v[240:243], v[216:219], a[112:115]
  ds_read_b128 v[124:127], v203 offset:16
  v_mfma_f32_16x16x32_bf16 a[128:131], v[244:247], v[216:219], a[128:131]
  buffer_load_dwordx4 v[216:219], v2, s[40:43], s64 offen offset:3072 sc1
  v_mfma_f32_16x16x32_bf16 a[68:71], v[212:215], v[220:223], a[68:71]
  ds_read_b128 v[160:163], v204 offset:0
  v_mfma_f32_16x16x32_bf16 a[84:87], v[232:235], v[220:223], a[84:87]
  ds_read_b128 v[164:167], v204 offset:16
  v_add_u32 v21, 43008, v252
  v_mfma_f32_16x16x32_bf16 a[100:103], v[236:239], v[220:223], a[100:103]
  v_mfma_f32_16x16x32_bf16 a[116:119], v[240:243], v[220:223], a[116:119]
  ds_read_b128 v[168:171], v205 offset:0
  v_mfma_f32_16x16x32_bf16 a[132:135], v[244:247], v[220:223], a[132:135]
  s_waitcnt vmcnt(21)
  buffer_load_dwordx4 v[220:223], v2, s[40:43], s65 offen offset:3072 sc1
  v_mfma_f32_16x16x32_bf16 a[72:75], v[212:215], v[224:227], a[72:75]
  ds_read_b128 v[172:175], v205 offset:16
  v_add_u32 v22, 43008, v253
  v_mfma_f32_16x16x32_bf16 a[88:91], v[232:235], v[224:227], a[88:91]
  buffer_load_dwordx4 v[48:51], v201, s[40:43], s27 offen sc1
  v_mfma_f32_16x16x32_bf16 a[104:107], v[236:239], v[224:227], a[104:107]
  v_mfma_f32_16x16x32_bf16 a[120:123], v[240:243], v[224:227], a[120:123]
  v_mfma_f32_16x16x32_bf16 a[136:139], v[244:247], v[224:227], a[136:139]
  s_mul_i32 s23, s20, 21504
  buffer_load_dwordx4 v[224:227], v2, s[40:43], s66 offen offset:3072 sc1
  v_and_b32 v16, 15, v1
  v_mul_u32_u24 v16, 336, v16
  v_mfma_f32_16x16x32_bf16 a[76:79], v[212:215], v[228:231], a[76:79]
  v_lshrrev_b32 v17, 4, v1
  v_lshl_add_u32 v16, v17, 4, v16
  v_mfma_f32_16x16x32_bf16 a[92:95], v[232:235], v[228:231], a[92:95]
  v_add_u32 v16, s23, v16
  v_mfma_f32_16x16x32_bf16 a[108:111], v[236:239], v[228:231], a[108:111]
  v_mfma_f32_16x16x32_bf16 a[124:127], v[240:243], v[228:231], a[124:127]
  s_waitcnt lgkmcnt(0)
  v_mfma_f32_16x16x32_bf16 a[140:143], v[244:247], v[228:231], a[140:143]
  s_waitcnt vmcnt(21)
  buffer_load_dwordx4 v[228:231], v2, s[40:43], s67 offen offset:3072 sc1
  v_mfma_f32_16x16x32_bf16 a[64:67], v[64:67], a[144:147], a[64:67]
  v_mfma_f32_16x16x32_bf16 a[80:83], v[68:71], a[144:147], a[80:83]
  buffer_load_dwordx4 v[40:43], v250, s[44:47], 0 offen
  v_mfma_f32_16x16x32_bf16 a[96:99], v[72:75], a[144:147], a[96:99]
  v_mfma_f32_16x16x32_bf16 a[112:115], v[76:79], a[144:147], a[112:115]
  v_mfma_f32_16x16x32_bf16 a[128:131], v[80:83], a[144:147], a[128:131]
  v_mfma_f32_16x16x32_bf16 a[68:71], v[64:67], a[148:151], a[68:71]
  v_mfma_f32_16x16x32_bf16 a[84:87], v[68:71], a[148:151], a[84:87]
  v_mfma_f32_16x16x32_bf16 a[100:103], v[72:75], a[148:151], a[100:103]
  v_mfma_f32_16x16x32_bf16 a[116:119], v[76:79], a[148:151], a[116:119]
  v_mfma_f32_16x16x32_bf16 a[132:135], v[80:83], a[148:151], a[132:135]
  s_waitcnt vmcnt(20)
  v_mfma_f32_16x16x32_bf16 a[72:75], v[64:67], a[152:155], a[72:75]
  v_mfma_f32_16x16x32_bf16 a[88:91], v[68:71], a[152:155], a[88:91]
  buffer_load_dwordx4 v[52:55], v202, s[40:43], s27 offen sc1
  v_mfma_f32_16x16x32_bf16 a[104:107], v[72:75], a[152:155], a[104:107]
  v_mfma_f32_16x16x32_bf16 a[120:123], v[76:79], a[152:155], a[120:123]
  v_mfma_f32_16x16x32_bf16 a[136:139], v[80:83], a[152:155], a[136:139]
  v_mfma_f32_16x16x32_bf16 a[76:79], v[64:67], a[156:159], a[76:79]
  v_mfma_f32_16x16x32_bf16 a[92:95], v[68:71], a[156:159], a[92:95]
  v_mfma_f32_16x16x32_bf16 a[108:111], v[72:75], a[156:159], a[108:111]
  v_mfma_f32_16x16x32_bf16 a[124:127], v[76:79], a[156:159], a[124:127]
  v_mfma_f32_16x16x32_bf16 a[140:143], v[80:83], a[156:159], a[140:143]
  s_waitcnt vmcnt(10)
  v_mfma_f32_16x16x32_bf16 a[64:67], v[84:87], a[160:163], a[64:67]
  v_lshlrev_b32 v18, 16, v44
  v_and_b32 v19, 0xffff0000, v44
  v_mfma_f32_16x16x32_bf16 a[80:83], v[88:91], a[160:163], a[80:83]
  v_add_f32 v120, v120, v18
  v_add_f32 v121, v121, v19
  v_mfma_f32_16x16x32_bf16 a[96:99], v[92:95], a[160:163], a[96:99]
  v_cvt_pk_bf16_f32 v18, v120, v121
  v_lshlrev_b32 v96, 16, v32
  v_mfma_f32_16x16x32_bf16 a[112:115], v[128:131], a[160:163], a[112:115]
  v_and_b32 v97, 0xffff0000, v32
  v_lshlrev_b32 v120, 16, v18
  v_mfma_f32_16x16x32_bf16 a[128:131], v[132:135], a[160:163], a[128:131]
  v_and_b32 v121, 0xffff0000, v18
  v_lshlrev_b32 v18, 16, v45
  v_mfma_f32_16x16x32_bf16 a[68:71], v[84:87], a[164:167], a[68:71]
  v_and_b32 v19, 0xffff0000, v45
  v_add_f32 v122, v122, v18
  v_mfma_f32_16x16x32_bf16 a[84:87], v[88:91], a[164:167], a[84:87]
  v_add_f32 v123, v123, v19
  v_cvt_pk_bf16_f32 v18, v122, v123
  v_mfma_f32_16x16x32_bf16 a[100:103], v[92:95], a[164:167], a[100:103]
  v_lshlrev_b32 v98, 16, v33
  v_and_b32 v99, 0xffff0000, v33
  v_mfma_f32_16x16x32_bf16 a[116:119], v[128:131], a[164:167], a[116:119]
  v_lshlrev_b32 v122, 16, v18
  v_and_b32 v123, 0xffff0000, v18
  v_mfma_f32_16x16x32_bf16 a[132:135], v[132:135], a[164:167], a[132:135]
  s_waitcnt vmcnt(15)
  v_lshlrev_b32 v18, 16, v46
  v_and_b32 v19, 0xffff0000, v46
  v_mfma_f32_16x16x32_bf16 a[72:75], v[84:87], a[168:171], a[72:75]
  v_add_f32 v124, v124, v18
  v_add_f32 v125, v125, v19
  v_mfma_f32_16x16x32_bf16 a[88:91], v[88:91], a[168:171], a[88:91]
  v_cvt_pk_bf16_f32 v18, v124, v125
  v_lshlrev_b32 v100, 16, v34
  v_mfma_f32_16x16x32_bf16 a[104:107], v[92:95], a[168:171], a[104:107]
  v_and_b32 v101, 0xffff0000, v34
  v_lshlrev_b32 v124, 16, v18
  v_mfma_f32_16x16x32_bf16 a[120:123], v[128:131], a[168:171], a[120:123]
  v_and_b32 v125, 0xffff0000, v18
  v_lshlrev_b32 v18, 16, v47
  v_mfma_f32_16x16x32_bf16 a[136:139], v[132:135], a[168:171], a[136:139]
  v_and_b32 v19, 0xffff0000, v47
  v_add_f32 v126, v126, v18
  v_mfma_f32_16x16x32_bf16 a[76:79], v[84:87], a[172:175], a[76:79]
  v_add_f32 v127, v127, v19
  v_cvt_pk_bf16_f32 v18, v126, v127
  v_mfma_f32_16x16x32_bf16 a[92:95], v[88:91], a[172:175], a[92:95]
  v_lshlrev_b32 v102, 16, v35
  v_and_b32 v103, 0xffff0000, v35
  v_mfma_f32_16x16x32_bf16 a[108:111], v[92:95], a[172:175], a[108:111]
  v_lshlrev_b32 v126, 16, v18
  v_and_b32 v127, 0xffff0000, v18
  v_mfma_f32_16x16x32_bf16 a[124:127], v[128:131], a[172:175], a[124:127]
  v_mfma_f32_16x16x32_bf16 a[140:143], v[132:135], a[172:175], a[140:143]
  s_waitcnt vmcnt(4)
  v_mfma_f32_16x16x32_bf16 a[64:67], v[136:139], a[176:179], a[64:67]
  v_lshlrev_b32 v18, 16, v48
  v_and_b32 v19, 0xffff0000, v48
  v_mfma_f32_16x16x32_bf16 a[80:83], v[140:143], a[176:179], a[80:83]
  v_add_f32 v160, v160, v18
  v_add_f32 v161, v161, v19
  v_mfma_f32_16x16x32_bf16 a[96:99], v[144:147], a[176:179], a[96:99]
  v_cvt_pk_bf16_f32 v18, v160, v161
  v_lshlrev_b32 v104, 16, v36
  v_mfma_f32_16x16x32_bf16 a[112:115], v[148:151], a[176:179], a[112:115]
  v_and_b32 v105, 0xffff0000, v36
  v_lshlrev_b32 v160, 16, v18
  v_mfma_f32_16x16x32_bf16 a[128:131], v[152:155], a[176:179], a[128:131]
  v_and_b32 v161, 0xffff0000, v18
  v_lshlrev_b32 v18, 16, v49
  v_mfma_f32_16x16x32_bf16 a[68:71], v[136:139], a[180:183], a[68:71]
  v_and_b32 v19, 0xffff0000, v49
  v_add_f32 v162, v162, v18
  v_mfma_f32_16x16x32_bf16 a[84:87], v[140:143], a[180:183], a[84:87]
  v_add_f32 v163, v163, v19
  v_cvt_pk_bf16_f32 v18, v162, v163
  v_mfma_f32_16x16x32_bf16 a[100:103], v[144:147], a[180:183], a[100:103]
  v_lshlrev_b32 v106, 16, v37
  v_and_b32 v107, 0xffff0000, v37
  v_mfma_f32_16x16x32_bf16 a[116:119], v[148:151], a[180:183], a[116:119]
  v_lshlrev_b32 v162, 16, v18
  v_and_b32 v163, 0xffff0000, v18
  v_mfma_f32_16x16x32_bf16 a[132:135], v[152:155], a[180:183], a[132:135]
  s_waitcnt vmcnt(8)
  v_lshlrev_b32 v18, 16, v50
  v_and_b32 v19, 0xffff0000, v50
  v_mfma_f32_16x16x32_bf16 a[72:75], v[136:139], a[184:187], a[72:75]
  v_add_f32 v164, v164, v18
  v_add_f32 v165, v165, v19
  v_mfma_f32_16x16x32_bf16 a[88:91], v[140:143], a[184:187], a[88:91]
  v_cvt_pk_bf16_f32 v18, v164, v165
  v_lshlrev_b32 v108, 16, v38
  v_mfma_f32_16x16x32_bf16 a[104:107], v[144:147], a[184:187], a[104:107]
  v_and_b32 v109, 0xffff0000, v38
  v_lshlrev_b32 v164, 16, v18
  v_mfma_f32_16x16x32_bf16 a[120:123], v[148:151], a[184:187], a[120:123]
  v_and_b32 v165, 0xffff0000, v18
  v_lshlrev_b32 v18, 16, v51
  v_mfma_f32_16x16x32_bf16 a[136:139], v[152:155], a[184:187], a[136:139]
  v_and_b32 v19, 0xffff0000, v51
  v_add_f32 v166, v166, v18
  v_mfma_f32_16x16x32_bf16 a[76:79], v[136:139], a[188:191], a[76:79]
  v_add_f32 v167, v167, v19
  v_cvt_pk_bf16_f32 v18, v166, v167
  v_mfma_f32_16x16x32_bf16 a[92:95], v[140:143], a[188:191], a[92:95]
  v_lshlrev_b32 v110, 16, v39
  v_and_b32 v111, 0xffff0000, v39
  v_mfma_f32_16x16x32_bf16 a[108:111], v[144:147], a[188:191], a[108:111]
  v_lshlrev_b32 v166, 16, v18
  v_and_b32 v167, 0xffff0000, v18
  v_mfma_f32_16x16x32_bf16 a[124:127], v[148:151], a[188:191], a[124:127]
  v_mfma_f32_16x16x32_bf16 a[140:143], v[152:155], a[188:191], a[140:143]
  s_waitcnt vmcnt(0)
  v_mfma_f32_16x16x32_bf16 a[64:67], v[156:159], v[216:219], a[64:67]
  v_lshlrev_b32 v18, 16, v52
  v_and_b32 v19, 0xffff0000, v52
  v_mfma_f32_16x16x32_bf16 a[80:83], v[176:179], v[216:219], a[80:83]
  v_add_f32 v168, v168, v18
  v_add_f32 v169, v169, v19
  v_mfma_f32_16x16x32_bf16 a[96:99], v[180:183], v[216:219], a[96:99]
  v_cvt_pk_bf16_f32 v18, v168, v169
  v_lshlrev_b32 v112, 16, v40
  v_mfma_f32_16x16x32_bf16 a[112:115], v[184:187], v[216:219], a[112:115]
  v_and_b32 v113, 0xffff0000, v40
  v_lshlrev_b32 v168, 16, v18
  v_mfma_f32_16x16x32_bf16 a[128:131], v[188:191], v[216:219], a[128:131]
  v_and_b32 v169, 0xffff0000, v18
  v_lshlrev_b32 v18, 16, v53
  v_mfma_f32_16x16x32_bf16 a[68:71], v[156:159], v[220:223], a[68:71]
  v_and_b32 v19, 0xffff0000, v53
  v_add_f32 v170, v170, v18
  v_mfma_f32_16x16x32_bf16 a[84:87], v[176:179], v[220:223], a[84:87]
  v_add_f32 v171, v171, v19
  v_cvt_pk_bf16_f32 v18, v170, v171
  v_mfma_f32_16x16x32_bf16 a[100:103], v[180:183], v[220:223], a[100:103]
  v_lshlrev_b32 v114, 16, v41
  v_and_b32 v115, 0xffff0000, v41
  v_mfma_f32_16x16x32_bf16 a[116:119], v[184:187], v[220:223], a[116:119]
  v_lshlrev_b32 v170, 16, v18
  v_and_b32 v171, 0xffff0000, v18
  v_mfma_f32_16x16x32_bf16 a[132:135], v[188:191], v[220:223], a[132:135]
  s_waitcnt vmcnt(2)
  ds_write_b128 v16, a[64:67] offset:0
  v_lshlrev_b32 v18, 16, v54
  v_and_b32 v19, 0xffff0000, v54
  v_mfma_f32_16x16x32_bf16 a[72:75], v[156:159], v[224:227], a[72:75]
  ds_write_b128 v16, a[80:83] offset:64
  v_add_f32 v172, v172, v18
  v_add_f32 v173, v173, v19
  v_mfma_f32_16x16x32_bf16 a[88:91], v[176:179], v[224:227], a[88:91]
  ds_write_b128 v16, a[96:99] offset:128
  v_cvt_pk_bf16_f32 v18, v172, v173
  v_lshlrev_b32 v116, 16, v42
  v_mfma_f32_16x16x32_bf16 a[104:107], v[180:183], v[224:227], a[104:107]
  ds_write_b128 v16, a[112:115] offset:192
  v_and_b32 v117, 0xffff0000, v42
  v_lshlrev_b32 v172, 16, v18
  v_mfma_f32_16x16x32_bf16 a[120:123], v[184:187], v[224:227], a[120:123]
  ds_write_b128 v16, a[128:131] offset:256
  v_and_b32 v173, 0xffff0000, v18
  v_lshlrev_b32 v18, 16, v55
  v_mfma_f32_16x16x32_bf16 a[136:139], v[188:191], v[224:227], a[136:139]
  ds_write_b128 v16, a[68:71] offset:5376
  v_and_b32 v19, 0xffff0000, v55
  v_add_f32 v174, v174, v18
  v_mfma_f32_16x16x32_bf16 a[76:79], v[156:159], v[228:231], a[76:79]
  ds_write_b128 v16, a[84:87] offset:5440
  v_add_f32 v175, v175, v19
  v_cvt_pk_bf16_f32 v18, v174, v175
  v_mfma_f32_16x16x32_bf16 a[92:95], v[176:179], v[228:231], a[92:95]
  ds_write_b128 v16, a[100:103] offset:5504
  v_lshlrev_b32 v118, 16, v43
  v_and_b32 v119, 0xffff0000, v43
  v_mfma_f32_16x16x32_bf16 a[108:111], v[180:183], v[228:231], a[108:111]
  ds_write_b128 v16, a[116:119] offset:5568
  v_lshlrev_b32 v174, 16, v18
  v_and_b32 v175, 0xffff0000, v18
  v_mfma_f32_16x16x32_bf16 a[124:127], v[184:187], v[228:231], a[124:127]
  ds_write_b128 v16, a[132:135] offset:5632
  v_mfma_f32_16x16x32_bf16 a[140:143], v[188:191], v[228:231], a[140:143]
  ds_write_b128 v16, a[72:75] offset:10752
  ds_write_b128 v16, a[88:91] offset:10816
  ds_write_b128 v16, a[104:107] offset:10880
  ds_write_b128 v16, a[120:123] offset:10944
  ds_write_b128 v16, a[136:139] offset:11008
  ds_write_b128 v16, a[76:79] offset:16128
  ds_write_b128 v16, a[92:95] offset:16192
  ds_write_b128 v16, a[108:111] offset:16256
  ds_write_b128 v16, a[124:127] offset:16320
  ds_write_b128 v16, a[140:143] offset:16384
  s_waitcnt lgkmcnt(0)
  s_barrier
  ds_read_b128 v[32:35], v251 offset:0
  ds_read_b128 v[36:39], v251 offset:16
  ds_read_b128 v[40:43], v251 offset:21504
  ds_read_b128 v[44:47], v251 offset:21520
  ds_read_b128 v[48:51], v20 offset:0
  ds_read_b128 v[52:55], v20 offset:16
  ds_read_b128 v[56:59], v20 offset:21504
  ds_read_b128 v[60:63], v20 offset:21520
  ds_read_b128 v[64:67], v252 offset:0
  ds_read_b128 v[68:71], v252 offset:16
  ds_read_b128 v[72:75], v252 offset:21504
  ds_read_b128 v[76:79], v252 offset:21520
  ds_read_b128 v[80:83], v21 offset:0
  ds_read_b128 v[84:87], v21 offset:16
  ds_read_b128 v[88:91], v21 offset:21504
  ds_read_b128 v[92:95], v21 offset:21520
  ds_read_b128 v[128:131], v253 offset:0
  ds_read_b128 v[132:135], v253 offset:16
  ds_read_b128 v[136:139], v253 offset:21504
  ds_read_b128 v[140:143], v253 offset:21520
  ds_read_b128 v[144:147], v22 offset:0
  ds_read_b128 v[148:151], v22 offset:16
  ds_read_b128 v[152:155], v22 offset:21504
  ds_read_b128 v[156:159], v22 offset:21520
  s_waitcnt lgkmcnt(15)
  v_pk_add_f32 v[32:33], v[32:33], v[40:41]
  v_pk_add_f32 v[48:49], v[48:49], v[56:57]
  v_pk_add_f32 v[34:35], v[34:35], v[42:43]
  v_pk_add_f32 v[50:51], v[50:51], v[58:59]
  v_pk_add_f32 v[36:37], v[36:37], v[44:45]
  v_pk_add_f32 v[52:53], v[52:53], v[60:61]
  v_pk_add_f32 v[38:39], v[38:39], v[46:47]
  v_pk_add_f32 v[54:55], v[54:55], v[62:63]
  v_pk_add_f32 v[32:33], v[32:33], v[48:49]
  v_pk_add_f32 v[34:35], v[34:35], v[50:51]
  v_pk_add_f32 v[36:37], v[36:37], v[52:53]
  v_pk_add_f32 v[38:39], v[38:39], v[54:55]
  v_cvt_pk_bf16_f32 v40, v32, v33
  v_cvt_pk_bf16_f32 v41, v34, v35
  v_cvt_pk_bf16_f32 v42, v36, v37
  v_cvt_pk_bf16_f32 v43, v38, v39
  v_lshlrev_b32 v32, 16, v40
  v_and_b32 v33, 0xffff0000, v40
  v_lshlrev_b32 v34, 16, v41
  v_and_b32 v35, 0xffff0000, v41
  v_lshlrev_b32 v36, 16, v42
  v_and_b32 v37, 0xffff0000, v42
  v_lshlrev_b32 v38, 16, v43
  v_and_b32 v39, 0xffff0000, v43
  v_pk_add_f32 v[32:33], v[32:33], v[96:97]
  v_pk_add_f32 v[34:35], v[34:35], v[98:99]
  v_pk_add_f32 v[36:37], v[36:37], v[100:101]
  v_pk_add_f32 v[38:39], v[38:39], v[102:103]
  v_cvt_pk_bf16_f32 v40, v32, v33
  v_cvt_pk_bf16_f32 v41, v34, v35
  v_cvt_pk_bf16_f32 v42, v36, v37
  v_cvt_pk_bf16_f32 v43, v38, v39
  v_lshlrev_b32 v32, 16, v40
  v_and_b32 v33, 0xffff0000, v40
  v_lshlrev_b32 v34, 16, v41
  v_and_b32 v35, 0xffff0000, v41
  v_lshlrev_b32 v36, 16, v42
  v_and_b32 v37, 0xffff0000, v42
  v_lshlrev_b32 v38, 16, v43
  v_and_b32 v39, 0xffff0000, v43
  v_pk_add_f32 v[32:33], v[32:33], v[120:121]
  v_pk_add_f32 v[34:35], v[34:35], v[122:123]
  v_pk_add_f32 v[36:37], v[36:37], v[124:125]
  v_pk_add_f32 v[38:39], v[38:39], v[126:127]
  v_cvt_pk_bf16_f32 v44, v32, v33
  v_cvt_pk_bf16_f32 v45, v34, v35
  v_cvt_pk_bf16_f32 v46, v36, v37
  v_cvt_pk_bf16_f32 v47, v38, v39
  buffer_store_dwordx4 v[44:47], v248, s[48:51], 0 offen
  s_waitcnt lgkmcnt(8)
  v_pk_add_f32 v[64:65], v[64:65], v[72:73]
  v_pk_add_f32 v[80:81], v[80:81], v[88:89]
  v_pk_add_f32 v[66:67], v[66:67], v[74:75]
  v_pk_add_f32 v[82:83], v[82:83], v[90:91]
  v_pk_add_f32 v[68:69], v[68:69], v[76:77]
  v_pk_add_f32 v[84:85], v[84:85], v[92:93]
  v_pk_add_f32 v[70:71], v[70:71], v[78:79]
  v_pk_add_f32 v[86:87], v[86:87], v[94:95]
  v_pk_add_f32 v[64:65], v[64:65], v[80:81]
  v_pk_add_f32 v[66:67], v[66:67], v[82:83]
  v_pk_add_f32 v[68:69], v[68:69], v[84:85]
  v_pk_add_f32 v[70:71], v[70:71], v[86:87]
  v_cvt_pk_bf16_f32 v72, v64, v65
  v_cvt_pk_bf16_f32 v73, v66, v67
  v_cvt_pk_bf16_f32 v74, v68, v69
  v_cvt_pk_bf16_f32 v75, v70, v71
  v_lshlrev_b32 v64, 16, v72
  v_and_b32 v65, 0xffff0000, v72
  v_lshlrev_b32 v66, 16, v73
  v_and_b32 v67, 0xffff0000, v73
  v_lshlrev_b32 v68, 16, v74
  v_and_b32 v69, 0xffff0000, v74
  v_lshlrev_b32 v70, 16, v75
  v_and_b32 v71, 0xffff0000, v75
  v_pk_add_f32 v[64:65], v[64:65], v[104:105]
  v_pk_add_f32 v[66:67], v[66:67], v[106:107]
  v_pk_add_f32 v[68:69], v[68:69], v[108:109]
  v_pk_add_f32 v[70:71], v[70:71], v[110:111]
  v_cvt_pk_bf16_f32 v72, v64, v65
  v_cvt_pk_bf16_f32 v73, v66, v67
  v_cvt_pk_bf16_f32 v74, v68, v69
  v_cvt_pk_bf16_f32 v75, v70, v71
  v_lshlrev_b32 v64, 16, v72
  v_and_b32 v65, 0xffff0000, v72
  v_lshlrev_b32 v66, 16, v73
  v_and_b32 v67, 0xffff0000, v73
  v_lshlrev_b32 v68, 16, v74
  v_and_b32 v69, 0xffff0000, v74
  v_lshlrev_b32 v70, 16, v75
  v_and_b32 v71, 0xffff0000, v75
  v_pk_add_f32 v[64:65], v[64:65], v[160:161]
  v_pk_add_f32 v[66:67], v[66:67], v[162:163]
  v_pk_add_f32 v[68:69], v[68:69], v[164:165]
  v_pk_add_f32 v[70:71], v[70:71], v[166:167]
  v_cvt_pk_bf16_f32 v76, v64, v65
  v_cvt_pk_bf16_f32 v77, v66, v67
  v_cvt_pk_bf16_f32 v78, v68, v69
  v_cvt_pk_bf16_f32 v79, v70, v71
  buffer_store_dwordx4 v[76:79], v249, s[48:51], 0 offen
  s_waitcnt lgkmcnt(0)
  v_pk_add_f32 v[128:129], v[128:129], v[136:137]
  v_pk_add_f32 v[144:145], v[144:145], v[152:153]
  v_pk_add_f32 v[130:131], v[130:131], v[138:139]
  v_pk_add_f32 v[146:147], v[146:147], v[154:155]
  v_pk_add_f32 v[132:133], v[132:133], v[140:141]
  v_pk_add_f32 v[148:149], v[148:149], v[156:157]
  v_pk_add_f32 v[134:135], v[134:135], v[142:143]
  v_pk_add_f32 v[150:151], v[150:151], v[158:159]
  v_pk_add_f32 v[128:129], v[128:129], v[144:145]
  v_pk_add_f32 v[130:131], v[130:131], v[146:147]
  v_pk_add_f32 v[132:133], v[132:133], v[148:149]
  v_pk_add_f32 v[134:135], v[134:135], v[150:151]
  v_cvt_pk_bf16_f32 v136, v128, v129
  v_cvt_pk_bf16_f32 v137, v130, v131
  v_cvt_pk_bf16_f32 v138, v132, v133
  v_cvt_pk_bf16_f32 v139, v134, v135
  v_lshlrev_b32 v128, 16, v136
  v_and_b32 v129, 0xffff0000, v136
  v_lshlrev_b32 v130, 16, v137
  v_and_b32 v131, 0xffff0000, v137
  v_lshlrev_b32 v132, 16, v138
  v_and_b32 v133, 0xffff0000, v138
  v_lshlrev_b32 v134, 16, v139
  v_and_b32 v135, 0xffff0000, v139
  v_pk_add_f32 v[128:129], v[128:129], v[112:113]
  v_pk_add_f32 v[130:131], v[130:131], v[114:115]
  v_pk_add_f32 v[132:133], v[132:133], v[116:117]
  v_pk_add_f32 v[134:135], v[134:135], v[118:119]
  v_cvt_pk_bf16_f32 v136, v128, v129
  v_cvt_pk_bf16_f32 v137, v130, v131
  v_cvt_pk_bf16_f32 v138, v132, v133
  v_cvt_pk_bf16_f32 v139, v134, v135
  v_lshlrev_b32 v128, 16, v136
  v_and_b32 v129, 0xffff0000, v136
  v_lshlrev_b32 v130, 16, v137
  v_and_b32 v131, 0xffff0000, v137
  v_lshlrev_b32 v132, 16, v138
  v_and_b32 v133, 0xffff0000, v138
  v_lshlrev_b32 v134, 16, v139
  v_and_b32 v135, 0xffff0000, v139
  v_pk_add_f32 v[128:129], v[128:129], v[168:169]
  v_pk_add_f32 v[130:131], v[130:131], v[170:171]
  v_pk_add_f32 v[132:133], v[132:133], v[172:173]
  v_pk_add_f32 v[134:135], v[134:135], v[174:175]
  v_cvt_pk_bf16_f32 v140, v128, v129
  v_cvt_pk_bf16_f32 v141, v130, v131
  v_cvt_pk_bf16_f32 v142, v132, v133
  v_cvt_pk_bf16_f32 v143, v134, v135
  buffer_store_dwordx4 v[140:143], v250, s[48:51], 0 offen
fa_end:
  s_endpgm
fa_hk0:
  s_getpc_b64 s[10:11]
fa_hp0:
  s_add_u32 s8, s8, 4
  s_addc_u32 s9, s9, 0
  s_sub_u32 s10, s10, fa_hp0-fa_hb0
  s_subb_u32 s11, s11, 0
  s_setpc_b64 s[8:9]
fa_hk1:
  s_getpc_b64 s[10:11]
fa_hp1:
  s_add_u32 s8, s8, 4
  s_addc_u32 s9, s9, 0
  s_sub_u32 s10, s10, fa_hp1-fa_hb1
  s_subb_u32 s11, s11, 0
  s_setpc_b64 s[8:9]
fa_hk2:
  s_getpc_b64 s[10:11]
fa_hp2:
  s_add_u32 s8, s8, 4
  s_addc_u32 s9, s9, 0
  s_sub_u32 s10, s10, fa_hp2-fa_hb2
  s_subb_u32 s11, s11, 0
  s_setpc_b64 s[8:9]
fa_hk3:
  s_getpc_b64 s[10:11]
fa_hp3:
  s_add_u32 s8, s8, 4
  s_addc_u32 s9, s9, 0
  s_sub_u32 s10, s10, fa_hp3-fa_hb3
  s_subb_u32 s11, s11, 0
  s_setpc_b64 s[8:9]
fa_ln_spin:
  s_mov_b32 s83, 200000
fa_ln_spin2:
  buffer_load_dword v15, v229, s[56:59], 0 offen sc1
  s_waitcnt vmcnt(0)
  v_cmp_ne_u32 vcc, 0x01010101, v15
  s_cbranch_vccz fa_ln_ok
  s_sleep 8
  s_sub_u32 s83, s83, 1
  s_cmp_lg_u32 s83, 0
  s_cbranch_scc1 fa_ln_spin2
  s_branch fa_ln_ok
fa_co1:
  buffer_load_dword v232, v234, s[32:35], s29 offen
  buffer_store_dword v229, v225, s[40:43], 0 offen sc1
  ds_read_b128 v[160:163], v221 offset:0
  ds_read_b128 v[164:167], v221 offset:4096
  ds_read_b128 v[168:171], v221 offset:8192
  buffer_store_dword v218, v222, s[40:43], 0 offen sc1
  s_waitcnt lgkmcnt(0)
  buffer_store_dwordx4 v[160:163], v223, s[40:43], s66 offen sc1
  buffer_store_dwordx4 v[164:167], v223, s[40:43], s67 offen sc1
  buffer_store_dwordx4 v[168:171], v224, s[40:43], s78 offen sc1
  s_getpc_b64 s[8:9]
  s_setpc_b64 s[10:11]
  s_mov_b32 s48, s60
  s_mov_b32 s49, s61
  s_mov_b32 s50, s75
  s_lshl_b32 s74, s22, 2
  s_add_u32 s74, s74, s20
  s_lshl_b32 s74, s74, 16
  s_mov_b32 s73, 2097152
  v_mov_b32 v213, 1073741824
  v_mov_b32 v214, 1
  v_writelane_b32 v213, s77, 0
  v_lshlrev_b32 v229, 2, v1
  s_and_b32 s23, s21, 3
  s_cbranch_scc0 fa_arr
  s_getpc_b64 s[8:9]
  s_setpc_b64 s[10:11]
fa_arr:
  buffer_store_byte v214, v213, s[56:59], 0 offen sc1
  s_getpc_b64 s[8:9]
  s_setpc_b64 s[10:11]
  buffer_load_dword v15, v229, s[56:59], 0 offen sc1
  s_getpc_b64 s[8:9]
  s_setpc_b64 s[10:11]
  s_mov_b32 s36, s60
  s_mov_b32 s37, s61
  s_mov_b32 s38, s75
  s_lshr_b32 s27, s20, 1
  s_lshl_b32 s27, s27, 18
  s_mov_b32 s25, 524288
  s_mov_b32 s32, s18
  s_mov_b32 s33, s19
  s_mov_b32 s34, 2621440
  s_mov_b32 s26, 0
  s_movk_i32 s79, 1024
  s_lshl_b32 s23, s22, 2
  s_add_u32 s23, s23, s20
  s_mul_i32 s23, s23, 40960
  v_add_u32 v3, s23, v2
  s_sub_u32 s23, 15, s22
  s_lshl_b32 s23, s23, 2
  s_add_u32 s23, s23, s20
  s_mul_i32 s23, s23, 40960
  s_sub_u32 s23, s23, 2048
  v_add_u32 v5, s23, v2
  v_add_u32 v4, 19456, v3
  v_add_u32 v6, 19456, v5
  s_waitcnt vmcnt(8)
  v_cmp_ne_u32 vcc, 0x01010101, v15
  s_cbranch_vccnz fa_ln_spin
fa_ln_ok:
  s_setpc_b64 s[10:11]
fa_kv_spin:
  s_mov_b32 s83, 200000
fa_kv_spin2:
  buffer_load_dword v15, v8, s[40:43], 0 offen sc1
  s_waitcnt vmcnt(0)
  v_cmp_eq_u32 vcc, 0, v15
  s_cbranch_vccz fa_kv_ok
  s_sleep 8
  s_sub_u32 s83, s83, 1
  s_cmp_lg_u32 s83, 0
  s_cbranch_scc1 fa_kv_spin2
  s_branch fa_kv_ok
fa_top8:
  s_cmp_lg_u32 s20, 0
  s_cbranch_scc1 fa_notop
  s_mov_b32 s23, 2621440
  s_mov_b32 s31, 2625536
  buffer_load_dwordx4 v[96:99], v2, s[40:43], s23 offen offset:0 sc1
  buffer_load_dwordx4 v[100:103], v2, s[40:43], s23 offen offset:1024 sc1
  buffer_load_dwordx4 v[104:107], v2, s[40:43], s23 offen offset:2048 sc1
  buffer_load_dwordx4 v[108:111], v2, s[40:43], s23 offen offset:3072 sc1
  buffer_load_dwordx4 v[112:115], v2, s[40:43], s31 offen offset:0 sc1
  buffer_load_dwordx4 v[116:119], v2, s[40:43], s31 offen offset:1024 sc1
  buffer_load_dwordx4 v[120:123], v2, s[40:43], s31 offen offset:2048 sc1
  buffer_load_dwordx4 v[124:127], v2, s[40:43], s31 offen offset:3072 sc1
  v_mov_b32 v21, 0
  v_mov_b32 v22, 0
  v_and_b32 v23, 7, v1
  s_mov_b32 s23, 0
  s_waitcnt vmcnt(0)
fa_top:
  v_max3_u32 v20, v96, v97, v98
  v_max3_u32 v24, v99, v100, v101
  v_max3_u32 v20, v20, v102, v103
  v_max3_u32 v24, v24, v104, v105
  v_max3_u32 v20, v20, v106, v107
  v_max3_u32 v24, v24, v108, v109
  v_max3_u32 v20, v20, v110, v111
  v_max3_u32 v24, v24, v112, v113
  v_max3_u32 v20, v20, v114, v115
  v_max3_u32 v24, v24, v116, v117
  v_max3_u32 v20, v20, v118, v119
  v_max3_u32 v24, v24, v120, v121
  v_max3_u32 v20, v20, v122, v123
  v_max3_u32 v24, v24, v124, v125
  v_max3_u32 v20, v20, v126, v127
  v_max_u32 v20, v20, v24
  s_nop 1
  v_max_u32_dpp v20, v20, v20 quad_perm:[1,0,3,2] row_mask:0xf bank_mask:0xf
  s_nop 1
  v_max_u32_dpp v20, v20, v20 quad_perm:[2,3,0,1] row_mask:0xf bank_mask:0xf
  s_nop 1
  v_max_u32_dpp v20, v20, v20 row_half_mirror row_mask:0xf bank_mask:0xf
  s_nop 1
  v_max_u32_dpp v20, v20, v20 row_mirror row_mask:0xf bank_mask:0xf
  v_mov_b32 v24, v20
  s_nop 1
  v_permlane16_swap_b32 v20, v24
  v_max_u32 v20, v20, v24
  v_mov_b32 v24, v20
  s_nop 1
  v_permlane32_swap_b32 v20, v24
  v_max_u32 v20, v20, v24
  v_add_u32 v21, v21, v20
  v_cmp_eq_u32 vcc, s23, v23
  v_sub_u32 v96, v96, v20
  v_sub_u32 v97, v97, v20
  v_sub_u32 v98, v98, v20
  v_sub_u32 v99, v99, v20
  v_sub_u32 v100, v100, v20
  v_sub_u32 v101, v101, v20
  v_sub_u32 v102, v102, v20
  v_sub_u32 v103, v103, v20
  v_sub_u32 v104, v104, v20
  v_sub_u32 v105, v105, v20
  v_sub_u32 v106, v106, v20
  v_sub_u32 v107, v107, v20
  v_sub_u32 v108, v108, v20
  v_sub_u32 v109, v109, v20
  v_sub_u32 v110, v110, v20
  v_sub_u32 v111, v111, v20
  v_sub_u32 v112, v112, v20
  v_sub_u32 v113, v113, v20
  v_sub_u32 v114, v114, v20
  v_sub_u32 v115, v115, v20
  v_sub_u32 v116, v116, v20
  v_sub_u32 v117, v117, v20
  v_sub_u32 v118, v118, v20
  v_sub_u32 v119, v119, v20
  v_sub_u32 v120, v120, v20
  v_sub_u32 v121, v121, v20
  v_sub_u32 v122, v122, v20
  v_sub_u32 v123, v123, v20
  v_sub_u32 v124, v124, v20
  v_sub_u32 v125, v125, v20
  v_sub_u32 v126, v126, v20
  v_sub_u32 v127, v127, v20
  v_cndmask_b32 v22, v22, v21, vcc
  s_add_u32 s23, s23, 1
  s_cmp_lt_u32 s23, 8
  s_cbranch_scc1 fa_top
  v_and_b32 v25, 0xffff, v22
  v_sub_u32 v25, 0xffff, v25
  v_and_b32 v25, 2047, v25
  v_ashrrev_i32 v20, 31, v22
  v_not_b32 v20, v20
  v_or_b32 v20, 0x80000000, v20
  v_xor_b32 v26, v22, v20
  v_and_b32 v26, 0xffff0000, v26
  v_mul_f32 v26, 0xbfb8aa3b, v26
  v_exp_f32 v26, v26
  s_nop 0
  v_add_f32 v26, 1.0, v26
  v_rcp_f32 v26, v26
  s_nop 0
  v_cvt_pk_bf16_f32 v26, v26, v26
  v_and_b32 v26, 0xffff0000, v26
  v_lshlrev_b32 v20, 2, v1
  v_add_u32 v20, 2629632, v20
  v_mov_b32 v21, 1073741824
  v_cmp_gt_u32 vcc, 16, v1
  v_add_u32 v25, 1, v25
  v_or_b32 v26, 1, v26
  v_cndmask_b32 v20, v21, v20, vcc
  v_cmp_gt_u32 vcc, 8, v1
  s_nop 1
  v_cndmask_b32 v26, v26, v25, vcc
  buffer_store_dword v26, v20, s[40:43], 0 offen sc1
  s_branch fa_notop
fa_hk4:
  s_getpc_b64 s[38:39]
fa_hp4:
  s_add_u32 s36, s36, 4
  s_addc_u32 s37, s37, 0
  s_sub_u32 s38, s38, fa_hp4-fa_hb4
  s_subb_u32 s39, s39, 0
  s_setpc_b64 s[36:37]
fa_hk5:
  s_getpc_b64 s[38:39]
fa_hp5:
  s_add_u32 s36, s36, 4
  s_addc_u32 s37, s37, 0
  s_sub_u32 s38, s38, fa_hp5-fa_hb5
  s_subb_u32 s39, s39, 0
  s_setpc_b64 s[36:37]
fa_hk6:
  s_getpc_b64 s[38:39]
fa_hp6:
  s_add_u32 s36, s36, 4
  s_addc_u32 s37, s37, 0
  s_add_u32 s38, s38, fa_hb6-fa_hp6
  s_addc_u32 s39, s39, 0
  s_setpc_b64 s[36:37]
fa_DDF:
  v_mfma_f32_16x16x32_bf16 v[96:99], a[128:131], v[32:35], v[192:195]
  s_waitcnt vmcnt(12)
  v_exp_f32 v218, v146
  v_mfma_f32_16x16x32_bf16 v[104:107], a[128:131], v[36:39], v[196:199]
  s_barrier
  v_exp_f32 v219, v147
  v_mfma_f32_16x16x32_bf16 v[128:131], a[128:131], v[64:67], v[200:203]
  s_cmp_ge_u32 s26, s32
  ds_read_b128 a[160:163], v3 offset:16384
  v_add_f32 v226, v216, v217
  v_mfma_f32_16x16x32_bf16 v[136:139], a[128:131], v[68:71], v[204:207]
  s_cbranch_scc1 fa_hk6
fa_hb6:
  v_exp_f32 v220, v148
  v_mfma_f32_16x16x32_bf16 v[100:103], a[132:135], v[32:35], v[192:195]
  ds_read_b128 a[164:167], v3 offset:17408
  v_cvt_pk_bf16_f32 v184, v216, v217
  v_mfma_f32_16x16x32_bf16 v[108:111], a[132:135], v[36:39], v[196:199]
  s_mov_b32 m0, s24
  v_exp_f32 v221, v149
  v_mfma_f32_16x16x32_bf16 v[132:135], a[132:135], v[64:67], v[200:203]
  buffer_load_dwordx4 v2, s[44:47], s26 offen offset:0 sc1 lds
  v_add_f32 v226, v226, v218
  v_mfma_f32_16x16x32_bf16 v[140:143], a[132:135], v[68:71], v[204:207]
  v_exp_f32 v222, v150
  v_mfma_f32_16x16x32_bf16 v[96:99], a[136:139], v[40:43], v[96:99]
  ds_read_b128 a[168:171], v3 offset:18432
  v_add_f32 v226, v226, v219
  v_cvt_pk_bf16_f32 v185, v218, v219
  v_mfma_f32_16x16x32_bf16 v[104:107], a[136:139], v[44:47], v[104:107]
  v_exp_f32 v223, v151
  v_mfma_f32_16x16x32_bf16 v[128:131], a[136:139], v[72:75], v[128:131]
  v_add_f32 v226, v226, v220
  v_add_f32 v226, v226, v221
  v_mfma_f32_16x16x32_bf16 v[136:139], a[136:139], v[76:79], v[136:139]
  v_exp_f32 v216, v152
  v_mfma_f32_16x16x32_bf16 v[100:103], a[140:143], v[40:43], v[100:103]
  ds_read_b128 a[172:175], v3 offset:19456
  v_cvt_pk_bf16_f32 v186, v220, v221
  v_mfma_f32_16x16x32_bf16 v[108:111], a[140:143], v[44:47], v[108:111]
  buffer_load_dwordx4 v2, s[44:47], s26 offen offset:1024 sc1 lds
  v_add_f32 v226, v226, v222
  v_mfma_f32_16x16x32_bf16 v[132:135], a[140:143], v[72:75], v[132:135]
  v_exp_f32 v217, v153
  v_mfma_f32_16x16x32_bf16 v[140:143], a[140:143], v[76:79], v[140:143]
  s_waitcnt lgkmcnt(4)
  v_exp_f32 v218, v154
  v_mfma_f32_16x16x32_bf16 v[96:99], a[144:147], v[48:51], v[96:99]
  ds_read_b128 a[176:179], v3 offset:20480
  v_add_f32 v226, v226, v223
  v_mfma_f32_16x16x32_bf16 v[104:107], a[144:147], v[52:55], v[104:107]
  v_exp_f32 v219, v155
  v_mfma_f32_16x16x32_bf16 v[128:131], a[144:147], v[80:83], v[128:131]
  v_cvt_pk_bf16_f32 v187, v222, v223
  v_add_f32 v227, v216, v217
  v_cvt_pk_bf16_f32 v188, v216, v217
  v_mfma_f32_16x16x32_bf16 v[136:139], a[144:147], v[84:87], v[136:139]
  buffer_load_dwordx4 v2, s[44:47], s26 offen offset:2048 sc1 lds
  v_add_f32 v227, v227, v218
  v_mfma_f32_16x16x32_bf16 v[100:103], a[148:151], v[48:51], v[100:103]
  ds_read_b128 a[180:183], v3 offset:21504
  v_add_f32 v227, v227, v219
  v_mfma_f32_16x16x32_bf16 v[108:111], a[148:151], v[52:55], v[108:111]
  v_exp_f32 v220, v156
  v_mfma_f32_16x16x32_bf16 v[132:135], a[148:151], v[80:83], v[132:135]
  v_exp_f32 v221, v157
  v_mfma_f32_16x16x32_bf16 v[140:143], a[148:151], v[84:87], v[140:143]
  v_exp_f32 v222, v158
  v_mfma_f32_16x16x32_bf16 v[96:99], a[152:155], v[56:59], v[96:99]
  ds_read_b128 a[184:187], v3 offset:22528
  v_cvt_pk_bf16_f32 v189, v218, v219
  v_mfma_f32_16x16x32_bf16 v[104:107], a[152:155], v[60:63], v[104:107]
  buffer_load_dwordx4 v2, s[44:47], s26 offen offset:3072 sc1 lds
  v_add_f32 v227, v227, v220
  v_add_f32 v227, v227, v221
  v_mfma_f32_16x16x32_bf16 v[128:131], a[152:155], v[88:91], v[128:131]
  s_add_u32 s26, s26, 16384
  v_exp_f32 v223, v159
  v_mfma_f32_16x16x32_bf16 v[136:139], a[152:155], v[92:95], v[136:139]
  s_add_u32 s24, s24, 32768
  v_exp_f32 v208, v112
  v_mfma_f32_16x16x32_bf16 v[100:103], a[156:159], v[56:59], v[100:103]
  s_and_b32 s24, s24, 0x1ffff
  ds_read_b128 a[188:191], v3 offset:23552
  v_cvt_pk_bf16_f32 v190, v220, v221
  v_mfma_f32_16x16x32_bf16 v[108:111], a[156:159], v[60:63], v[108:111]
  v_exp_f32 v209, v113
  v_mfma_f32_16x16x32_bf16 v[132:135], a[156:159], v[88:91], v[132:135]
  s_add_u32 m0, s34, 0
  v_exp_f32 v210, v114
  v_mfma_f32_16x16x32_bf16 v[140:143], a[156:159], v[92:95], v[140:143]
  s_waitcnt lgkmcnt(4)
  buffer_load_dwordx4 v8, s[52:55], s33 offen offset:0 lds
  v_add_f32 v227, v227, v222
  v_mfma_f32_16x16x32_bf16 a[0:3], a[160:163], v[160:163], a[0:3]
  ds_read_b128 a[128:131], v3 offset:0
  v_add_f32 v227, v227, v223
  v_mfma_f32_16x16x32_bf16 a[4:7], a[160:163], v[164:167], a[4:7]
  v_exp_f32 v211, v115
  v_mfma_f32_16x16x32_bf16 a[64:67], a[160:163], v[176:179], a[64:67]
  v_cvt_pk_bf16_f32 v191, v222, v223
  v_add_f32 v224, v208, v209
  v_cvt_pk_bf16_f32 v168, v208, v209
  v_mfma_f32_16x16x32_bf16 a[68:71], a[160:163], v[180:183], a[68:71]
  v_exp_f32 v212, v116
  v_mfma_f32_16x16x32_bf16 a[8:11], a[164:167], v[160:163], a[8:11]
  ds_read_b128 a[132:135], v3 offset:1024
  v_add_f32 v224, v224, v210
  v_mfma_f32_16x16x32_bf16 a[12:15], a[164:167], v[164:167], a[12:15]
  buffer_load_dwordx4 v11, s[52:55], s33 offen offset:1024 lds
  v_add_f32 v224, v224, v211
  v_mfma_f32_16x16x32_bf16 a[72:75], a[164:167], v[176:179], a[72:75]
  v_exp_f32 v213, v117
  v_mfma_f32_16x16x32_bf16 a[76:79], a[164:167], v[180:183], a[76:79]
  v_exp_f32 v214, v118
  v_mfma_f32_16x16x32_bf16 a[16:19], a[168:171], v[160:163], a[16:19]
  ds_read_b128 a[136:139], v3 offset:2048
  v_cvt_pk_bf16_f32 v169, v210, v211
  v_mfma_f32_16x16x32_bf16 a[20:23], a[168:171], v[164:167], a[20:23]
  v_exp_f32 v215, v119
  v_mfma_f32_16x16x32_bf16 a[80:83], a[168:171], v[176:179], a[80:83]
  v_add_f32 v224, v224, v212
  v_add_f32 v224, v224, v213
  v_cvt_pk_bf16_f32 v170, v212, v213
  v_mfma_f32_16x16x32_bf16 a[84:87], a[168:171], v[180:183], a[84:87]
  buffer_load_dwordx4 v12, s[52:55], s33 offen offset:2048 lds
  v_add_f32 v224, v224, v214
  v_mfma_f32_16x16x32_bf16 a[24:27], a[172:175], v[160:163], a[24:27]
  ds_read_b128 a[140:143], v3 offset:3072
  v_add_f32 v224, v224, v215
  v_mfma_f32_16x16x32_bf16 a[28:31], a[172:175], v[164:167], a[28:31]
  v_exp_f32 v208, v120
  v_mfma_f32_16x16x32_bf16 a[88:91], a[172:175], v[176:179], a[88:91]
  v_exp_f32 v209, v121
  v_mfma_f32_16x16x32_bf16 a[92:95], a[172:175], v[180:183], a[92:95]
  s_waitcnt lgkmcnt(4)
  v_exp_f32 v210, v122
  v_mfma_f32_16x16x32_bf16 a[32:35], a[176:179], v[160:163], a[32:35]
  ds_read_b128 a[144:147], v3 offset:4096
  v_cvt_pk_bf16_f32 v171, v214, v215
  v_mfma_f32_16x16x32_bf16 a[36:39], a[176:179], v[164:167], a[36:39]
  buffer_load_dwordx4 v13, s[52:55], s33 offen offset:3072 lds
  v_add_f32 v225, v208, v209
  v_mfma_f32_16x16x32_bf16 a[96:99], a[176:179], v[176:179], a[96:99]
  v_exp_f32 v211, v123
  v_mfma_f32_16x16x32_bf16 a[100:103], a[176:179], v[180:183], a[100:103]
  v_exp_f32 v212, v124
  v_mfma_f32_16x16x32_bf16 a[40:43], a[180:183], v[160:163], a[40:43]
  ds_read_b128 a[148:151], v3 offset:5120
  v_cvt_pk_bf16_f32 v172, v208, v209
  v_add_f32 v225, v225, v210
  v_mfma_f32_16x16x32_bf16 a[44:47], a[180:183], v[164:167], a[44:47]
  v_exp_f32 v213, v125
  v_mfma_f32_16x16x32_bf16 a[104:107], a[180:183], v[176:179], a[104:107]
  s_add_u32 m0, s34, 4096
  v_add_f32 v225, v225, v211
  v_cvt_pk_bf16_f32 v173, v210, v211
  v_mfma_f32_16x16x32_bf16 a[108:111], a[180:183], v[180:183], a[108:111]
  buffer_load_dwordx4 v14, s[52:55], s33 offen offset:0 lds
  v_max3_f32 v5, v226, v227, v224
  v_mfma_f32_16x16x32_bf16 a[48:51], a[184:187], v[160:163], a[48:51]
  ds_read_b128 a[152:155], v3 offset:6144
  v_add_f32 v225, v225, v212
  v_mfma_f32_16x16x32_bf16 a[52:55], a[184:187], v[164:167], a[52:55]
  v_exp_f32 v214, v126
  v_mfma_f32_16x16x32_bf16 a[112:115], a[184:187], v[176:179], a[112:115]
  v_exp_f32 v215, v127
  v_mfma_f32_16x16x32_bf16 a[116:119], a[184:187], v[180:183], a[116:119]
  v_add_f32 v225, v225, v213
  v_cvt_pk_bf16_f32 v174, v212, v213
  v_add_f32 v225, v225, v214
  v_mfma_f32_16x16x32_bf16 a[56:59], a[188:191], v[160:163], a[56:59]
  ds_read_b128 a[156:159], v3 offset:7168
  v_add_f32 v225, v225, v215
  v_max_f32 v5, v5, v225
  v_cmp_lt_f32 vcc, s81, v5
  v_mfma_f32_16x16x32_bf16 a[60:63], a[188:191], v[164:167], a[60:63]
  v_exp_f32 v216, v128
  v_mfma_f32_16x16x32_bf16 a[120:123], a[188:191], v[176:179], a[120:123]
  s_waitcnt lgkmcnt(4)
  v_cvt_pk_bf16_f32 v175, v214, v215
  v_mfma_f32_16x16x32_bf16 a[124:127], a[188:191], v[180:183], a[124:127]
  s_cbranch_vccnz fa_stub3
fa_back3:
  v_exp_f32 v217, v129
  v_add_f32 v228, v228, v224
  v_add_f32 v229, v229, v225
  v_add_f32 v230, v230, v226
  v_add_f32 v231, v231, v227
  s_branch fa_DDe
fa_kv2_spin:
  s_mov_b32 s83, 200000
fa_kv2_spin2:
  buffer_load_dword v14, v13, s[40:43], 0 offen sc1
  s_waitcnt vmcnt(0)
  v_cmp_eq_u32 vcc, 0, v14
  s_cbranch_vccz fa_kv2_ok
  s_sleep 8
  s_sub_u32 s83, s83, 1
  s_cmp_lg_u32 s83, 0
  s_cbranch_scc1 fa_kv2_spin2
  s_branch fa_kv2_ok
fa_kv3_spin:
  s_mov_b32 s83, 200000
fa_kv3_spin2:
  buffer_load_dword v14, v13, s[40:43], 0 offen sc1
  s_waitcnt vmcnt(0)
  v_cmp_eq_u32 vcc, 0, v14
  s_cbranch_vccz fa_kv3_ok
  s_sleep 8
  s_sub_u32 s83, s83, 1
  s_cmp_lg_u32 s83, 0
  s_cbranch_scc1 fa_kv3_spin2
  s_branch fa_kv3_ok
fa_sel_spin:
  s_mov_b32 s83, 200000
fa_sel_spin2:
  buffer_load_dword v15, v252, s[40:43], 0 offen sc1
  s_waitcnt vmcnt(0)
  v_cmp_eq_u32 vcc, 0, v15
  s_cbranch_vccz fa_sel_ok
  s_sleep 8
  s_sub_u32 s83, s83, 1
  s_cmp_lg_u32 s83, 0
  s_cbranch_scc1 fa_sel_spin2
  s_branch fa_sel_ok
fa_wof_spin:
  s_mov_b32 s83, 200000
fa_wof_spin2:
  buffer_load_dword v8, v9, s[40:43], 0 offen sc1
  s_waitcnt vmcnt(0)
  v_cmp_eq_u32 vcc, 0, v8
  s_cbranch_vccz fa_wof_ok
  s_sleep 8
  s_sub_u32 s83, s83, 1
  s_cmp_lg_u32 s83, 0
  s_cbranch_scc1 fa_wof_spin2
  s_branch fa_wof_ok
fa_sel4_spin:
  s_mov_b32 s83, 200000
fa_sel4_spin2:
  buffer_load_dword v15, v10, s[40:43], 0 offen sc1
  s_waitcnt vmcnt(0)
  v_cmp_eq_u32 vcc, 0, v15
  s_cbranch_vccz fa_sel4_ok
  s_sleep 8
  s_sub_u32 s83, s83, 1
  s_cmp_lg_u32 s83, 0
  s_cbranch_scc1 fa_sel4_spin2
  s_branch fa_sel4_ok
fa_yf_spin:
  s_mov_b32 s83, 200000
fa_yf_spin2:
  buffer_load_dword v14, v11, s[40:43], 0 offen sc1
  s_waitcnt vmcnt(0)
  v_cmp_eq_u32 vcc, 0, v14
  s_cbranch_vccz fa_yf_ok
  s_sleep 8
  s_sub_u32 s83, s83, 1
  s_cmp_lg_u32 s83, 0
  s_cbranch_scc1 fa_yf_spin2
  s_branch fa_yf_ok
fa_co:
  s_sub_u32 s14, s2, 64
  s_cmp_lt_u32 s14, 96
  s_cbranch_scc1 fa_coT
  s_sub_u32 s14, s2, 128
  s_sub_u32 s23, s2, 224
  s_cmp_lt_u32 s23, 31
  s_cbranch_scc1 fa_coT
  v_cmp_eq_u32 vcc, 0, v14
  s_cbranch_vccnz fa_kv2_spin
fa_kv2_ok:
  s_sub_u32 s14, s2, 170
  s_cmp_lt_u32 s14, 54
  s_cbranch_scc1 fa_coF
  s_cmp_eq_u32 s2, 255
  s_cbranch_scc1 fa_coW
  s_branch fa_coO
fa_coT:
  v_min_u32 v8, 16, v1
  v_lshlrev_b32 v8, 7, v8
  s_lshl_b32 s10, s14, 1
  s_and_b32 s31, s20, 1
  s_add_u32 s10, s10, s31
  s_mul_i32 s10, s10, 2176
  s_lshl_b32 s35, s14, 2
  s_add_u32 s35, s35, s20
  s_mul_i32 s35, s35, 4352
  buffer_load_dword v255, v8, s[52:55], s10 offen
  s_add_u32 s10, s10, 552960
  s_getpc_b64 s[36:37]
  s_setpc_b64 s[38:39]
  buffer_load_dword v255, v8, s[52:55], s10 offen
  s_add_u32 s10, s10, 552960
  s_getpc_b64 s[36:37]
  s_setpc_b64 s[38:39]
  v_cmp_eq_u32 vcc, 0, v14
  s_cbranch_vccnz fa_kv3_spin
fa_kv3_ok:
  buffer_load_dword v255, v8, s[52:55], s10 offen
  s_add_u32 s10, s10, 552960
  buffer_load_dword v255, v8, s[60:63], s35 offen offset:0
  s_getpc_b64 s[36:37]
  s_setpc_b64 s[38:39]
  buffer_load_dword v255, v8, s[52:55], s10 offen
  s_add_u32 s10, s10, 552960
  buffer_load_dword v255, v8, s[60:63], s35 offen offset:2176
  s_mov_b32 s9, -1
  s_and_b32 s32, s21, 3
  s_lshr_b32 s32, s32, 1
  s_add_u32 s32, s32, 6
  s_lshl_b32 s32, s32, 14
  s_getpc_b64 s[36:37]
  s_setpc_b64 s[38:39]
fa_coO:
  s_and_b32 s23, s67, 1
  s_lshl_b32 s23, s23, 2
  s_add_u32 s23, s23, s20
  s_lshr_b32 s31, s67, 1
  s_mul_i32 s33, s23, 0
  s_add_u32 s33, s33, s31
  s_and_b32 s33, s33, 31
  s_andn2_b32 s30, s31, 31
  s_add_u32 s33, s33, s30
  s_lshl_b32 s30, s23, 7
  s_add_u32 s30, s30, s33
  s_mul_i32 s33, s31, 40960
  s_mul_i32 s23, s23, 160
  s_add_u32 s33, s33, s23
  s_add_u32 m0, s34, 0
  v_accvgpr_read_b32 v19, a248
  buffer_load_dwordx4 v19, s[56:59], s33 offen lds
  s_add_u32 m0, s34, 1024
  v_accvgpr_read_b32 v19, a249
  buffer_load_dwordx4 v19, s[56:59], s33 offen lds
  s_add_u32 m0, s34, 2048
  v_accvgpr_read_b32 v19, a250
  buffer_load_dwordx4 v19, s[56:59], s33 offen lds
  s_add_u32 m0, s34, 3072
  v_accvgpr_read_b32 v19, a251
  buffer_load_dwordx4 v19, s[56:59], s33 offen lds
  s_add_u32 m0, s34, 4096
  v_accvgpr_read_b32 v19, a252
  buffer_load_dwordx4 v19, s[56:59], s33 offen lds
  s_add_u32 s32, s26, 32768
  s_mov_b32 s9, -1
  s_lshl_b32 s10, s30, 2
  s_mul_i32 s30, s30, 5120
  s_add_u32 s30, s30, 4194304
  s_getpc_b64 s[36:37]
  s_setpc_b64 s[38:39]
  s_waitcnt vmcnt(8)
  ds_read_b64_tr_b16 v[232:233], v6 offset:0
  ds_read_b64_tr_b16 v[234:235], v6 offset:2560
  ds_read_b64_tr_b16 v[236:237], v6 offset:32
  ds_read_b64_tr_b16 v[238:239], v6 offset:2592
  ds_read_b64_tr_b16 v[240:241], v6 offset:64
  ds_read_b64_tr_b16 v[242:243], v6 offset:2624
  ds_read_b64_tr_b16 v[244:245], v6 offset:96
  ds_read_b64_tr_b16 v[246:247], v6 offset:2656
  ds_read_b64_tr_b16 v[248:249], v6 offset:128
  ds_read_b64_tr_b16 v[250:251], v6 offset:2688
  s_waitcnt lgkmcnt(0)
  s_add_u32 s31, s30, 4096
  buffer_store_dwordx4 v[232:235], v2, s[40:43], s30 offen offset:0 sc1
  buffer_store_dwordx4 v[236:239], v2, s[40:43], s30 offen offset:1024 sc1
  buffer_store_dwordx4 v[240:243], v2, s[40:43], s30 offen offset:2048 sc1
  buffer_store_dwordx4 v[244:247], v2, s[40:43], s30 offen offset:3072 sc1
  buffer_store_dwordx4 v[248:251], v2, s[40:43], s31 offen offset:0 sc1
  s_getpc_b64 s[36:37]
  s_setpc_b64 s[38:39]
  s_add_u32 s23, s10, 2654208
  s_waitcnt vmcnt(8)
  buffer_store_dword v4, off, s[40:43], s23 sc1
  s_sub_u32 s23, s67, 96
  s_cmp_gt_u32 s23, 54
  s_cbranch_scc1 fa_coW
  s_add_u32 s67, s23, 170
  s_cmp_eq_u32 s67, 224
  s_cselect_b32 s67, 255, s67
  s_branch fa_coO
fa_coF:
  v_and_b32 v16, 7, v1
  v_lshlrev_b32 v252, 2, v16
  v_add_u32 v252, 2629632, v252
  buffer_load_dword v15, v252, s[40:43], 0 offen sc1
  s_lshl_b32 s33, s14, 6
  s_and_b32 s31, s20, 1
  s_lshl_b32 s31, s31, 5
  s_add_u32 s33, s33, s31
  s_mul_i32 s35, s14, 40960
  s_mul_i32 s31, s20, 320
  s_add_u32 s35, s35, s31
  s_mul_i32 s10, s14, 20480
  s_mul_i32 s31, s20, 640
  s_add_u32 s10, s10, s31
  s_add_u32 s10, s10, 2686976
  v_lshrrev_b32 v17, 1, v1
  v_mul_u32_u24 v8, 3456, v17
  v_and_b32 v17, 1, v1
  v_lshl_add_u32 v8, v17, 4, v8
  v_add_u32 v11, 109568, v8
  v_add_u32 v12, 219136, v8
  v_add_u32 v13, 328704, v8
  v_add_u32 v14, 442368, v8
  v_lshrrev_b32 v17, 4, v1
  v_lshrrev_b32 v18, 2, v1
  v_lshl_add_u32 v18, v17, 2, v18
  v_lshlrev_b32 v18, 5, v18
  v_and_b32 v19, 3, v1
  v_lshl_add_u32 v9, v19, 3, v18
  v_add_u32 v9, s34, v9
  v_lshlrev_b32 v10, 4, v16
  v_lshl_add_u32 v10, v17, 7, v10
  v_add_u32 v10, 151552, v10
  s_mov_b32 s8, -1
  v_mov_b32 v232, 0
  v_mov_b32 v233, 0
  v_mov_b32 v234, 0
  v_mov_b32 v235, 0
  s_getpc_b64 s[36:37]
  s_setpc_b64 s[38:39]
  s_waitcnt vmcnt(8)
  v_cmp_eq_u32 vcc, 0, v15
  s_cbranch_vccnz fa_sel_spin
fa_sel_ok:
  v_add_u32 v18, -1, v15
  v_and_b32 v18, 2047, v18
  v_lshrrev_b32 v19, 4, v18
  v_mul_u32_u24 v19, 20480, v19
  v_and_b32 v18, 15, v18
  v_lshl_add_u32 v19, v18, 4, v19
  v_lshrrev_b32 v18, 3, v1
  v_lshl_add_u32 v19, v18, 8, v19
  s_lshl_b32 s23, s20, 11
  s_lshl_b32 s31, s20, 10
  s_add_u32 s31, s31, 151552
  s_mov_b32 s14, 4
  s_mov_b32 m0, s31
  s_add_u32 s31, s31, 4096
  buffer_load_dwordx4 v19, s[40:43], s23 offen sc1 lds
  s_add_u32 s23, s23, 8192
  s_mov_b32 m0, s31
  s_add_u32 s31, s31, 4096
  buffer_load_dwordx4 v19, s[40:43], s23 offen sc1 lds
  s_add_u32 s23, s23, 8192
  s_mov_b32 m0, s31
  s_add_u32 s31, s31, 4096
  buffer_load_dwordx4 v19, s[40:43], s23 offen sc1 lds
  s_add_u32 s23, s23, 8192
  s_getpc_b64 s[36:37]
  s_setpc_b64 s[38:39]
  s_branch fa_coG1
fa_coG:
  s_getpc_b64 s[36:37]
  s_setpc_b64 s[38:39]
  v_mfma_f32_16x16x32_bf16 v[232:235], a[192:195], a[212:215], v[232:235]
  v_mfma_f32_16x16x32_bf16 v[232:235], a[196:199], a[216:219], v[232:235]
  v_mfma_f32_16x16x32_bf16 v[232:235], a[200:203], a[220:223], v[232:235]
  v_mfma_f32_16x16x32_bf16 v[232:235], a[204:207], a[224:227], v[232:235]
  v_mfma_f32_16x16x32_bf16 v[232:235], a[208:211], a[228:231], v[232:235]
fa_coG1:
  s_waitcnt vmcnt(4)
  ds_read_b64_tr_b16 a[192:193], v9 offset:0
  ds_read_b64_tr_b16 a[194:195], v9 offset:128
  ds_read_b128 a[212:215], v10 offset:0
  ds_read_b64_tr_b16 a[196:197], v9 offset:1024
  ds_read_b64_tr_b16 a[198:199], v9 offset:1152
  ds_read_b128 a[216:219], v10 offset:512
  ds_read_b64_tr_b16 a[200:201], v9 offset:2048
  ds_read_b64_tr_b16 a[202:203], v9 offset:2176
  ds_read_b128 a[220:223], v10 offset:1024
  ds_read_b64_tr_b16 a[204:205], v9 offset:3072
  ds_read_b64_tr_b16 a[206:207], v9 offset:3200
  ds_read_b128 a[224:227], v10 offset:1536
  ds_read_b64_tr_b16 a[208:209], v9 offset:4096
  ds_read_b64_tr_b16 a[210:211], v9 offset:4224
  ds_read_b128 a[228:231], v10 offset:2048
  v_add_u32 v10, 2560, v10
  s_add_u32 s33, s33, 552960
  s_sub_u32 s14, s14, 1
  s_cmp_lg_u32 s14, 0
  s_cbranch_scc1 fa_coG
  v_accvgpr_read_b32 v8, a248
  v_accvgpr_read_b32 v11, a249
  v_accvgpr_read_b32 v12, a250
  v_accvgpr_read_b32 v13, a251
  v_accvgpr_read_b32 v14, a252
  v_subrev_u32 v11, 1024, v11
  v_subrev_u32 v12, 2048, v12
  v_subrev_u32 v13, 3072, v13
  s_mov_b32 s52, s60
  s_mov_b32 s53, s61
  s_mov_b32 s33, s35
  s_lshl_b32 s23, s20, 9
  v_add_u32 v16, s23, v10
  v_and_b32 v17, 7, v1
  v_mul_u32_u24 v9, 2560, v17
  v_lshrrev_b32 v17, 4, v1
  v_lshl_add_u32 v9, v17, 4, v9
  v_and_b32 v17, 8, v1
  v_lshl_add_u32 v9, v17, 27, v9
  s_waitcnt lgkmcnt(0)
  v_mfma_f32_16x16x32_bf16 v[232:235], a[192:195], a[212:215], v[232:235]
  v_mfma_f32_16x16x32_bf16 v[232:235], a[196:199], a[216:219], v[232:235]
  v_mfma_f32_16x16x32_bf16 v[232:235], a[200:203], a[220:223], v[232:235]
  v_mfma_f32_16x16x32_bf16 v[232:235], a[204:207], a[224:227], v[232:235]
  v_mfma_f32_16x16x32_bf16 v[232:235], a[208:211], a[228:231], v[232:235]
  s_nop 7
  ds_write_b128 v16, v[232:235]
  s_getpc_b64 s[36:37]
  s_setpc_b64 s[38:39]
  ds_read_b128 v[236:239], v10 offset:0
  ds_read_b128 v[240:243], v10 offset:512
  ds_read_b128 v[244:247], v10 offset:1024
  ds_read_b128 v[248:251], v10 offset:1536
  s_waitcnt vmcnt(4)
  ds_read_b64_tr_b16 a[192:193], v6 offset:0
  ds_read_b64_tr_b16 a[194:195], v6 offset:2560
  ds_read_b64_tr_b16 a[196:197], v6 offset:32
  ds_read_b64_tr_b16 a[198:199], v6 offset:2592
  ds_read_b64_tr_b16 a[200:201], v6 offset:64
  ds_read_b64_tr_b16 a[202:203], v6 offset:2624
  ds_read_b64_tr_b16 a[204:205], v6 offset:96
  ds_read_b64_tr_b16 a[206:207], v6 offset:2656
  ds_read_b64_tr_b16 a[208:209], v6 offset:128
  ds_read_b64_tr_b16 a[210:211], v6 offset:2688
  s_add_u32 s33, s33, 160
  s_mov_b32 s8, 0
  s_waitcnt lgkmcnt(10)
  v_cvt_pk_bf16_f32 v236, v236, v244
  v_cvt_pk_bf16_f32 v237, v237, v245
  v_cvt_pk_bf16_f32 v238, v238, v246
  v_cvt_pk_bf16_f32 v239, v239, v247
  v_cvt_pk_bf16_f32 v240, v240, v248
  v_cvt_pk_bf16_f32 v241, v241, v249
  v_cvt_pk_bf16_f32 v242, v242, v250
  v_cvt_pk_bf16_f32 v243, v243, v251
  v_lshlrev_b32 v244, 16, v236
  v_lshlrev_b32 v245, 16, v237
  v_lshlrev_b32 v246, 16, v238
  v_lshlrev_b32 v247, 16, v239
  v_lshlrev_b32 v248, 16, v240
  v_lshlrev_b32 v249, 16, v241
  v_lshlrev_b32 v250, 16, v242
  v_lshlrev_b32 v251, 16, v243
  v_mul_f32 v16, 0xbfb8aa3b, v244
  v_mul_f32 v17, 0xbfb8aa3b, v245
  v_mul_f32 v18, 0xbfb8aa3b, v246
  v_mul_f32 v19, 0xbfb8aa3b, v247
  v_mul_f32 v20, 0xbfb8aa3b, v248
  v_mul_f32 v21, 0xbfb8aa3b, v249
  v_mul_f32 v22, 0xbfb8aa3b, v250
  v_mul_f32 v23, 0xbfb8aa3b, v251
  v_exp_f32 v16, v16
  v_exp_f32 v17, v17
  v_exp_f32 v18, v18
  v_exp_f32 v19, v19
  v_exp_f32 v20, v20
  v_exp_f32 v21, v21
  v_exp_f32 v22, v22
  v_exp_f32 v23, v23
  v_add_f32 v16, 1.0, v16
  v_add_f32 v17, 1.0, v17
  v_add_f32 v18, 1.0, v18
  v_add_f32 v19, 1.0, v19
  v_add_f32 v20, 1.0, v20
  v_add_f32 v21, 1.0, v21
  v_add_f32 v22, 1.0, v22
  v_add_f32 v23, 1.0, v23
  v_rcp_f32 v16, v16
  v_rcp_f32 v17, v17
  v_rcp_f32 v18, v18
  v_rcp_f32 v19, v19
  v_rcp_f32 v20, v20
  v_rcp_f32 v21, v21
  v_rcp_f32 v22, v22
  v_rcp_f32 v23, v23
  v_and_b32 v236, 0xffff0000, v236
  v_and_b32 v237, 0xffff0000, v237
  v_and_b32 v238, 0xffff0000, v238
  v_and_b32 v239, 0xffff0000, v239
  v_and_b32 v240, 0xffff0000, v240
  v_and_b32 v241, 0xffff0000, v241
  v_and_b32 v242, 0xffff0000, v242
  v_and_b32 v243, 0xffff0000, v243
  v_pk_mul_f32 v[244:245], v[244:245], v[16:17]
  v_pk_mul_f32 v[246:247], v[246:247], v[18:19]
  v_pk_mul_f32 v[248:249], v[248:249], v[20:21]
  v_pk_mul_f32 v[250:251], v[250:251], v[22:23]
  v_cvt_pk_bf16_f32 v16, v244, v245
  v_cvt_pk_bf16_f32 v17, v246, v247
  v_cvt_pk_bf16_f32 v18, v248, v249
  v_cvt_pk_bf16_f32 v19, v250, v251
  v_lshlrev_b32 v244, 16, v16
  v_and_b32 v245, 0xffff0000, v16
  v_lshlrev_b32 v246, 16, v17
  v_and_b32 v247, 0xffff0000, v17
  v_lshlrev_b32 v248, 16, v18
  v_and_b32 v249, 0xffff0000, v18
  v_lshlrev_b32 v250, 16, v19
  v_and_b32 v251, 0xffff0000, v19
  v_pk_mul_f32 v[236:237], v[236:237], v[244:245]
  v_pk_mul_f32 v[238:239], v[238:239], v[246:247]
  v_pk_mul_f32 v[240:241], v[240:241], v[248:249]
  v_pk_mul_f32 v[242:243], v[242:243], v[250:251]
  v_cvt_pk_bf16_f32 v232, v236, v237
  v_cvt_pk_bf16_f32 v233, v238, v239
  v_cvt_pk_bf16_f32 v234, v240, v241
  v_cvt_pk_bf16_f32 v235, v242, v243
  s_nop 0
  s_waitcnt lgkmcnt(0)
  v_mfma_f32_16x16x32_bf16 v[236:239], a[192:195], v[232:235], 0
  v_mfma_f32_16x16x32_bf16 v[240:243], a[196:199], v[232:235], 0
  v_mfma_f32_16x16x32_bf16 v[244:247], a[200:203], v[232:235], 0
  v_mfma_f32_16x16x32_bf16 v[248:251], a[204:207], v[232:235], 0
  v_mfma_f32_16x16x32_bf16 v[252:255], a[208:211], v[232:235], 0
  s_nop 3
  buffer_store_dwordx4 v[236:239], v9, s[40:43], s10 offen offset:0 sc1
  buffer_store_dwordx4 v[240:243], v9, s[40:43], s10 offen offset:64 sc1
  buffer_store_dwordx4 v[244:247], v9, s[40:43], s10 offen offset:128 sc1
  buffer_store_dwordx4 v[248:251], v9, s[40:43], s10 offen offset:192 sc1
  buffer_store_dwordx4 v[252:255], v9, s[40:43], s10 offen offset:256 sc1
  s_add_u32 s10, s10, 320
  s_getpc_b64 s[36:37]
  s_setpc_b64 s[38:39]
  s_waitcnt vmcnt(4)
  ds_read_b64_tr_b16 a[192:193], v6 offset:0
  ds_read_b64_tr_b16 a[194:195], v6 offset:2560
  ds_read_b64_tr_b16 a[196:197], v6 offset:32
  ds_read_b64_tr_b16 a[198:199], v6 offset:2592
  ds_read_b64_tr_b16 a[200:201], v6 offset:64
  ds_read_b64_tr_b16 a[202:203], v6 offset:2624
  ds_read_b64_tr_b16 a[204:205], v6 offset:96
  ds_read_b64_tr_b16 a[206:207], v6 offset:2656
  ds_read_b64_tr_b16 a[208:209], v6 offset:128
  ds_read_b64_tr_b16 a[210:211], v6 offset:2688
  s_waitcnt lgkmcnt(0)
  v_mfma_f32_16x16x32_bf16 v[236:239], a[192:195], v[232:235], 0
  v_mfma_f32_16x16x32_bf16 v[240:243], a[196:199], v[232:235], 0
  v_mfma_f32_16x16x32_bf16 v[244:247], a[200:203], v[232:235], 0
  v_mfma_f32_16x16x32_bf16 v[248:251], a[204:207], v[232:235], 0
  v_mfma_f32_16x16x32_bf16 v[252:255], a[208:211], v[232:235], 0
  s_nop 3
  buffer_store_dwordx4 v[236:239], v9, s[40:43], s10 offen offset:0 sc1
  buffer_store_dwordx4 v[240:243], v9, s[40:43], s10 offen offset:64 sc1
  buffer_store_dwordx4 v[244:247], v9, s[40:43], s10 offen offset:128 sc1
  buffer_store_dwordx4 v[248:251], v9, s[40:43], s10 offen offset:192 sc1
  buffer_store_dwordx4 v[252:255], v9, s[40:43], s10 offen offset:256 sc1
  s_add_u32 s10, s10, 320
  s_getpc_b64 s[36:37]
  s_setpc_b64 s[38:39]
  s_sub_u32 s23, s2, 170
  s_lshl_b32 s31, s20, 6
  s_add_u32 s23, s23, s31
  s_lshl_b32 s23, s23, 2
  s_add_u32 s23, s23, 2650112
  s_waitcnt vmcnt(8)
  buffer_store_dword v4, off, s[40:43], s23 sc1
fa_coW:
  s_mov_b32 s12, 1
  s_mov_b32 s9, -1
  s_cmp_lg_u32 s11, 0
  s_cselect_b32 s32, s15, -1
  s_getpc_b64 s[36:37]
  s_setpc_b64 s[38:39]
  s_lshl_b32 s23, s22, 2
  s_add_u32 s23, s23, s20
  s_mul_i32 s13, s23, 163840
  s_add_u32 s13, s13, 4194304
  s_lshl_b32 s23, s23, 7
  s_add_u32 s23, s23, 2654208
  v_and_b32 v9, 31, v1
  v_lshl_add_u32 v9, v9, 2, s23
  v_and_b32 v10, 15, v1
  v_lshlrev_b32 v10, 2, v10
  v_add_u32 v10, 2629632, v10
  buffer_load_dword v8, v9, s[40:43], 0 offen sc1
  buffer_load_dword v15, v10, s[40:43], 0 offen sc1
  v_mov_b32 v20, v228
  v_mov_b32 v21, v229
  s_nop 1
  v_permlane16_swap_b32 v228, v20
  v_permlane16_swap_b32 v229, v21
  v_add_f32 v228, v228, v20
  v_add_f32 v229, v229, v21
  v_mov_b32 v20, v228
  v_mov_b32 v21, v229
  s_nop 1
  v_permlane32_swap_b32 v228, v20
  v_permlane32_swap_b32 v229, v21
  v_add_f32 v228, v228, v20
  v_add_f32 v229, v229, v21
  v_rcp_f32 v16, v228
  v_rcp_f32 v18, v229
  s_lshl_b32 s23, s22, 2
  v_mov_b32 v17, v16
  v_mov_b32 v19, v18
  s_add_u32 s23, s23, s20
  s_lshl_b32 s23, s23, 18
  s_lshl_b32 s31, s21, 12
  s_add_u32 s31, s31, 50331648
  s_add_u32 s64, s23, s31
  s_add_u32 s65, s64, 131072
  v_accvgpr_read_b32 v36, a0
  v_accvgpr_read_b32 v37, a1
  v_accvgpr_read_b32 v38, a2
  v_accvgpr_read_b32 v39, a3
  v_accvgpr_read_b32 v40, a8
  v_accvgpr_read_b32 v41, a9
  v_accvgpr_read_b32 v42, a10
  v_accvgpr_read_b32 v43, a11
  v_pk_mul_f32 v[36:37], v[36:37], v[16:17]
  v_pk_mul_f32 v[38:39], v[38:39], v[16:17]
  v_pk_mul_f32 v[40:41], v[40:41], v[16:17]
  v_pk_mul_f32 v[42:43], v[42:43], v[16:17]
  v_cvt_pk_bf16_f32 v32, v36, v37
  v_cvt_pk_bf16_f32 v33, v38, v39
  v_cvt_pk_bf16_f32 v34, v40, v41
  v_cvt_pk_bf16_f32 v35, v42, v43
  buffer_store_dwordx4 v[32:35], v2, s[40:43], s64 offen offset:0 sc1
  v_accvgpr_read_b32 v48, a16
  v_accvgpr_read_b32 v49, a17
  v_accvgpr_read_b32 v50, a18
  v_accvgpr_read_b32 v51, a19
  v_accvgpr_read_b32 v52, a24
  v_accvgpr_read_b32 v53, a25
  v_accvgpr_read_b32 v54, a26
  v_accvgpr_read_b32 v55, a27
  v_pk_mul_f32 v[48:49], v[48:49], v[16:17]
  v_pk_mul_f32 v[50:51], v[50:51], v[16:17]
  v_pk_mul_f32 v[52:53], v[52:53], v[16:17]
  v_pk_mul_f32 v[54:55], v[54:55], v[16:17]
  v_cvt_pk_bf16_f32 v44, v48, v49
  v_cvt_pk_bf16_f32 v45, v50, v51
  v_cvt_pk_bf16_f32 v46, v52, v53
  v_cvt_pk_bf16_f32 v47, v54, v55
  buffer_store_dwordx4 v[44:47], v2, s[40:43], s64 offen offset:1024 sc1
  v_accvgpr_read_b32 v100, a32
  v_accvgpr_read_b32 v101, a33
  v_accvgpr_read_b32 v102, a34
  v_accvgpr_read_b32 v103, a35
  v_accvgpr_read_b32 v104, a40
  v_accvgpr_read_b32 v105, a41
  v_accvgpr_read_b32 v106, a42
  v_accvgpr_read_b32 v107, a43
  v_pk_mul_f32 v[100:101], v[100:101], v[16:17]
  v_pk_mul_f32 v[102:103], v[102:103], v[16:17]
  v_pk_mul_f32 v[104:105], v[104:105], v[16:17]
  v_pk_mul_f32 v[106:107], v[106:107], v[16:17]
  v_cvt_pk_bf16_f32 v96, v100, v101
  v_cvt_pk_bf16_f32 v97, v102, v103
  v_cvt_pk_bf16_f32 v98, v104, v105
  v_cvt_pk_bf16_f32 v99, v106, v107
  buffer_store_dwordx4 v[96:99], v2, s[40:43], s64 offen offset:2048 sc1
  v_accvgpr_read_b32 v112, a48
  v_accvgpr_read_b32 v113, a49
  v_accvgpr_read_b32 v114, a50
  v_accvgpr_read_b32 v115, a51
  v_accvgpr_read_b32 v116, a56
  v_accvgpr_read_b32 v117, a57
  v_accvgpr_read_b32 v118, a58
  v_accvgpr_read_b32 v119, a59
  v_pk_mul_f32 v[112:113], v[112:113], v[16:17]
  v_pk_mul_f32 v[114:115], v[114:115], v[16:17]
  v_pk_mul_f32 v[116:117], v[116:117], v[16:17]
  v_pk_mul_f32 v[118:119], v[118:119], v[16:17]
  v_cvt_pk_bf16_f32 v108, v112, v113
  v_cvt_pk_bf16_f32 v109, v114, v115
  v_cvt_pk_bf16_f32 v110, v116, v117
  v_cvt_pk_bf16_f32 v111, v118, v119
  buffer_store_dwordx4 v[108:111], v2, s[40:43], s64 offen offset:3072 sc1
  v_accvgpr_read_b32 v36, a4
  v_accvgpr_read_b32 v37, a5
  v_accvgpr_read_b32 v38, a6
  v_accvgpr_read_b32 v39, a7
  v_accvgpr_read_b32 v40, a12
  v_accvgpr_read_b32 v41, a13
  v_accvgpr_read_b32 v42, a14
  v_accvgpr_read_b32 v43, a15
  v_pk_mul_f32 v[36:37], v[36:37], v[18:19]
  v_pk_mul_f32 v[38:39], v[38:39], v[18:19]
  v_pk_mul_f32 v[40:41], v[40:41], v[18:19]
  v_pk_mul_f32 v[42:43], v[42:43], v[18:19]
  v_cvt_pk_bf16_f32 v32, v36, v37
  v_cvt_pk_bf16_f32 v33, v38, v39
  v_cvt_pk_bf16_f32 v34, v40, v41
  v_cvt_pk_bf16_f32 v35, v42, v43
  buffer_store_dwordx4 v[32:35], v2, s[40:43], s65 offen offset:0 sc1
  v_accvgpr_read_b32 v48, a20
  v_accvgpr_read_b32 v49, a21
  v_accvgpr_read_b32 v50, a22
  v_accvgpr_read_b32 v51, a23
  v_accvgpr_read_b32 v52, a28
  v_accvgpr_read_b32 v53, a29
  v_accvgpr_read_b32 v54, a30
  v_accvgpr_read_b32 v55, a31
  v_pk_mul_f32 v[48:49], v[48:49], v[18:19]
  v_pk_mul_f32 v[50:51], v[50:51], v[18:19]
  v_pk_mul_f32 v[52:53], v[52:53], v[18:19]
  v_pk_mul_f32 v[54:55], v[54:55], v[18:19]
  v_cvt_pk_bf16_f32 v44, v48, v49
  v_cvt_pk_bf16_f32 v45, v50, v51
  v_cvt_pk_bf16_f32 v46, v52, v53
  v_cvt_pk_bf16_f32 v47, v54, v55
  buffer_store_dwordx4 v[44:47], v2, s[40:43], s65 offen offset:1024 sc1
  v_accvgpr_read_b32 v100, a36
  v_accvgpr_read_b32 v101, a37
  v_accvgpr_read_b32 v102, a38
  v_accvgpr_read_b32 v103, a39
  v_accvgpr_read_b32 v104, a44
  v_accvgpr_read_b32 v105, a45
  v_accvgpr_read_b32 v106, a46
  v_accvgpr_read_b32 v107, a47
  v_pk_mul_f32 v[100:101], v[100:101], v[18:19]
  v_pk_mul_f32 v[102:103], v[102:103], v[18:19]
  v_pk_mul_f32 v[104:105], v[104:105], v[18:19]
  v_pk_mul_f32 v[106:107], v[106:107], v[18:19]
  v_cvt_pk_bf16_f32 v96, v100, v101
  v_cvt_pk_bf16_f32 v97, v102, v103
  v_cvt_pk_bf16_f32 v98, v104, v105
  v_cvt_pk_bf16_f32 v99, v106, v107
  buffer_store_dwordx4 v[96:99], v2, s[40:43], s65 offen offset:2048 sc1
  v_accvgpr_read_b32 v112, a52
  v_accvgpr_read_b32 v113, a53
  v_accvgpr_read_b32 v114, a54
  v_accvgpr_read_b32 v115, a55
  v_accvgpr_read_b32 v116, a60
  v_accvgpr_read_b32 v117, a61
  v_accvgpr_read_b32 v118, a62
  v_accvgpr_read_b32 v119, a63
  v_pk_mul_f32 v[112:113], v[112:113], v[18:19]
  v_pk_mul_f32 v[114:115], v[114:115], v[18:19]
  v_pk_mul_f32 v[116:117], v[116:117], v[18:19]
  v_pk_mul_f32 v[118:119], v[118:119], v[18:19]
  v_cvt_pk_bf16_f32 v108, v112, v113
  v_cvt_pk_bf16_f32 v109, v114, v115
  v_cvt_pk_bf16_f32 v110, v116, v117
  v_cvt_pk_bf16_f32 v111, v118, v119
  buffer_store_dwordx4 v[108:111], v2, s[40:43], s65 offen offset:3072 sc1
  s_mov_b32 s28, s46
  s_add_u32 s30, s28, 65536
  s_lshl_b32 s23, s20, 12
  s_add_u32 s23, s23, s28
  s_add_u32 s31, s13, 98304
  s_sub_u32 s31, s31, s23
  s_add_u32 s4, s18, s31
  s_addc_u32 s5, s19, 0
  s_add_u32 s6, s4, 4096
  s_addc_u32 s7, s5, 0
  s_waitcnt vmcnt(8)
  v_cmp_eq_u32 vcc, 0, v8
  s_cbranch_vccnz fa_wof_spin
fa_wof_ok:
  v_cmp_eq_u32 vcc, 0, v15
  s_cbranch_vccnz fa_sel4_spin
fa_sel4_ok:
  s_lshl_b32 s31, s21, 6
  s_add_u32 s31, s31, 1
  v_subrev_u32 v16, s31, v15
  v_cmp_gt_u32 vcc, 64, v16
  s_cmp_lt_u32 s20, 2
  s_cselect_b32 s23, 0xff, 0
  s_and_b32 s10, vcc_lo, s23
  s_sub_u32 s23, s10, 1
  s_and_b32 s23, s23, s10
  s_cmp_eq_u32 s20, 1
  s_cselect_b32 s10, s23, s10
  s_cmp_eq_u32 s10, 0
  s_cbranch_scc1 fa_coEnd
  v_min_u32 v11, 53, v1
  s_lshr_b32 s23, s22, 1
  s_lshl_b32 s23, s23, 8
  s_add_u32 s23, s23, 2650112
  v_lshl_add_u32 v11, v11, 2, s23
  buffer_load_dword v14, v11, s[40:43], 0 offen sc1
  v_mul_u32_u24 v16, 3277, v1
  v_lshrrev_b32 v16, 16, v16
  v_mul_u32_u24 v8, 20, v16
  v_sub_u32 v8, v1, v8
  v_lshlrev_b32 v8, 4, v8
  v_mul_u32_u24 v9, 368640, v16
  v_add_u32 v9, v9, v8
  v_cmp_gt_u32 vcc, 3, v16
  v_mov_b32 v19, 1073741824
  s_nop 0
  v_cndmask_b32 v9, v19, v9, vcc
  s_mov_b32 s12, 2
  s_mov_b32 s32, -1
  s_mov_b32 s11, 0
  s_getpc_b64 s[36:37]
  s_setpc_b64 s[38:39]
  v_cmp_eq_u32 vcc, 0, v14
  s_cbranch_vccnz fa_yf_spin
fa_yf_ok:
fa_coY:
  s_ff1_i32_b32 s33, s10
  s_bitset0_b32 s10, s33
  s_sub_u32 s23, s10, 1
  s_and_b32 s10, s10, s23
  s_mul_i32 s14, s33, 2560
  s_mul_i32 s23, s22, 320
  s_add_u32 s14, s14, s23
  s_add_u32 s14, s14, 2686976
  buffer_load_dwordx4 v[64:67], v9, s[40:43], s14 offen sc1
  s_add_u32 s14, s14, 20480
  buffer_load_dwordx4 v[68:71], v9, s[40:43], s14 offen sc1
  s_add_u32 s14, s14, 20480
  buffer_load_dwordx4 v[72:75], v9, s[40:43], s14 offen sc1
  s_add_u32 s14, s14, 20480
  buffer_load_dwordx4 v[76:79], v9, s[40:43], s14 offen sc1
  s_add_u32 s14, s14, 20480
  buffer_load_dwordx4 v[80:83], v9, s[40:43], s14 offen sc1
  s_add_u32 s14, s14, 20480
  buffer_load_dwordx4 v[84:87], v9, s[40:43], s14 offen sc1
  s_add_u32 s14, s14, 20480
  buffer_load_dwordx4 v[88:91], v9, s[40:43], s14 offen sc1
  s_add_u32 s14, s14, 20480
  buffer_load_dwordx4 v[92:95], v9, s[40:43], s14 offen sc1
  s_add_u32 s14, s14, 20480
  buffer_load_dwordx4 v[128:131], v9, s[40:43], s14 offen sc1
  s_add_u32 s14, s14, 20480
  buffer_load_dwordx4 v[132:135], v9, s[40:43], s14 offen sc1
  s_add_u32 s14, s14, 20480
  buffer_load_dwordx4 v[136:139], v9, s[40:43], s14 offen sc1
  s_add_u32 s14, s14, 20480
  buffer_load_dwordx4 v[140:143], v9, s[40:43], s14 offen sc1
  s_add_u32 s14, s14, 20480
  buffer_load_dwordx4 v[144:147], v9, s[40:43], s14 offen sc1
  s_add_u32 s14, s14, 20480
  buffer_load_dwordx4 v[148:151], v9, s[40:43], s14 offen sc1
  s_add_u32 s14, s14, 20480
  buffer_load_dwordx4 v[152:155], v9, s[40:43], s14 offen sc1
  s_add_u32 s14, s14, 20480
  buffer_load_dwordx4 v[156:159], v9, s[40:43], s14 offen sc1
  s_add_u32 s14, s14, 20480
  buffer_load_dwordx4 v[176:179], v9, s[40:43], s14 offen sc1
  s_add_u32 s14, s14, 20480
  buffer_load_dwordx4 v[180:183], v9, s[40:43], s14 offen sc1
  s_add_u32 s14, s14, 20480
  s_lshl_b32 s14, s20, 10
  s_add_u32 s14, s14, 159744
  v_add_u32 v19, s14, v2
  s_add_u32 s23, s33, 8
  v_readlane_b32 s35, v15, s23
  s_waitcnt vmcnt(0)
  v_pk_add_f32 v[64:65], v[64:65], v[68:69]
  v_pk_add_f32 v[66:67], v[66:67], v[70:71]
  v_pk_add_f32 v[64:65], v[64:65], v[72:73]
  v_pk_add_f32 v[66:67], v[66:67], v[74:75]
  v_pk_add_f32 v[64:65], v[64:65], v[76:77]
  v_pk_add_f32 v[66:67], v[66:67], v[78:79]
  v_pk_add_f32 v[64:65], v[64:65], v[80:81]
  v_pk_add_f32 v[66:67], v[66:67], v[82:83]
  v_pk_add_f32 v[64:65], v[64:65], v[84:85]
  v_pk_add_f32 v[66:67], v[66:67], v[86:87]
  v_pk_add_f32 v[64:65], v[64:65], v[88:89]
  v_pk_add_f32 v[66:67], v[66:67], v[90:91]
  v_pk_add_f32 v[64:65], v[64:65], v[92:93]
  v_pk_add_f32 v[66:67], v[66:67], v[94:95]
  v_pk_add_f32 v[64:65], v[64:65], v[128:129]
  v_pk_add_f32 v[66:67], v[66:67], v[130:131]
  v_pk_add_f32 v[64:65], v[64:65], v[132:133]
  v_pk_add_f32 v[66:67], v[66:67], v[134:135]
  v_pk_add_f32 v[64:65], v[64:65], v[136:137]
  v_pk_add_f32 v[66:67], v[66:67], v[138:139]
  v_pk_add_f32 v[64:65], v[64:65], v[140:141]
  v_pk_add_f32 v[66:67], v[66:67], v[142:143]
  v_pk_add_f32 v[64:65], v[64:65], v[144:145]
  v_pk_add_f32 v[66:67], v[66:67], v[146:147]
  v_pk_add_f32 v[64:65], v[64:65], v[148:149]
  v_pk_add_f32 v[66:67], v[66:67], v[150:151]
  v_pk_add_f32 v[64:65], v[64:65], v[152:153]
  v_pk_add_f32 v[66:67], v[66:67], v[154:155]
  v_pk_add_f32 v[64:65], v[64:65], v[156:157]
  v_pk_add_f32 v[66:67], v[66:67], v[158:159]
  v_pk_add_f32 v[64:65], v[64:65], v[176:177]
  v_pk_add_f32 v[66:67], v[66:67], v[178:179]
  v_pk_add_f32 v[64:65], v[64:65], v[180:181]
  v_pk_add_f32 v[66:67], v[66:67], v[182:183]
  ds_write_b128 v19, v[64:67]
  v_add_u32 v19, s14, v8
  s_and_b32 s35, s35, 0xffff0000
  s_waitcnt lgkmcnt(0)
  ds_read_b128 v[64:67], v19
  ds_read_b128 v[68:71], v19 offset:320
  ds_read_b128 v[72:75], v19 offset:640
  s_mul_i32 s14, s33, 320
  s_add_u32 s14, s14, 155648
  v_add_u32 v19, s14, v8
  s_waitcnt lgkmcnt(0)
  v_add_f32 v64, v64, v68
  v_add_f32 v64, v64, v72
  v_cvt_pk_bf16_f32 v64, v64, v64
  v_and_b32 v64, 0xffff0000, v64
  v_mul_f32 v64, s35, v64
  v_cvt_pk_bf16_f32 v64, v64, v64
  v_and_b32 v64, 0xffff0000, v64
  v_add_f32 v65, v65, v69
  v_add_f32 v65, v65, v73
  v_cvt_pk_bf16_f32 v65, v65, v65
  v_and_b32 v65, 0xffff0000, v65
  v_mul_f32 v65, s35, v65
  v_cvt_pk_bf16_f32 v65, v65, v65
  v_and_b32 v65, 0xffff0000, v65
  v_add_f32 v66, v66, v70
  v_add_f32 v66, v66, v74
  v_cvt_pk_bf16_f32 v66, v66, v66
  v_and_b32 v66, 0xffff0000, v66
  v_mul_f32 v66, s35, v66
  v_cvt_pk_bf16_f32 v66, v66, v66
  v_and_b32 v66, 0xffff0000, v66
  v_add_f32 v67, v67, v71
  v_add_f32 v67, v67, v75
  v_cvt_pk_bf16_f32 v67, v67, v67
  v_and_b32 v67, 0xffff0000, v67
  v_mul_f32 v67, s35, v67
  v_cvt_pk_bf16_f32 v67, v67, v67
  v_and_b32 v67, 0xffff0000, v67
  ds_write_b128 v19, v[64:67]
  s_waitcnt lgkmcnt(0)
  s_cmp_lg_u32 s10, 0
  s_cbranch_scc1 fa_coY
fa_coEnd:
  s_mov_b32 s12, 3
  s_mov_b32 s32, -1
  s_setpc_b64 s[38:39]
fa_hk7:
  s_getpc_b64 s[38:39]
fa_hp7:
  s_add_u32 s36, s36, 4
  s_addc_u32 s37, s37, 0
  s_sub_u32 s38, s38, fa_hp7-fa_hb7
  s_subb_u32 s39, s39, 0
  s_setpc_b64 s[36:37]
fa_hk8:
  s_getpc_b64 s[38:39]
fa_hp8:
  s_add_u32 s36, s36, 4
  s_addc_u32 s37, s37, 0
  s_sub_u32 s38, s38, fa_hp8-fa_hb8
  s_subb_u32 s39, s39, 0
  s_setpc_b64 s[36:37]
fa_disp:
  s_cmp_eq_u32 s29, 7
  s_cbranch_scc1 fa_SSW7
  s_cmp_eq_u32 s29, 6
  s_cbranch_scc1 fa_SSW6
  s_cmp_eq_u32 s29, 5
  s_cbranch_scc1 fa_SSW5
  s_cmp_eq_u32 s29, 4
  s_cbranch_scc1 fa_SSW4
  s_cmp_eq_u32 s29, 3
  s_cbranch_scc1 fa_SSW3
  s_cmp_eq_u32 s29, 2
  s_cbranch_scc1 fa_SSW2
  s_cmp_eq_u32 s29, 1
  s_cbranch_scc1 fa_SSW1
  s_branch fa_Bexit
fa_hk9:
  s_getpc_b64 s[38:39]
fa_hp9:
  s_add_u32 s36, s36, 4
  s_addc_u32 s37, s37, 0
  s_add_u32 s38, s38, fa_hb9-fa_hp9
  s_addc_u32 s39, s39, 0
  s_setpc_b64 s[36:37]
fa_puby:
  s_waitcnt vmcnt(0)
  buffer_store_dword v4, v30, s[40:43], 0 offen sc1
  s_cmp_lt_u32 s12, 3
  s_cbranch_scc1 fa_hk9
fa_hb9:
  s_add_u32 s14, s13, 61440
  buffer_load_dwordx4 v[64:67], v2, s[40:43], s14 offen offset:0 sc1
  buffer_load_dwordx4 v[68:71], v2, s[40:43], s14 offen offset:1024 sc1
  buffer_load_dwordx4 v[72:75], v2, s[40:43], s14 offen offset:2048 sc1
  buffer_load_dwordx4 v[76:79], v2, s[40:43], s14 offen offset:3072 sc1
  s_add_u32 s14, s13, 65536
  buffer_load_dwordx4 v[80:83], v2, s[40:43], s14 offen offset:0 sc1
  buffer_load_dwordx4 v[84:87], v2, s[40:43], s14 offen offset:1024 sc1
  buffer_load_dwordx4 v[88:91], v2, s[40:43], s14 offen offset:2048 sc1
  buffer_load_dwordx4 v[92:95], v2, s[40:43], s14 offen offset:3072 sc1
  s_branch fa_pubb
fa_left:
  s_add_u32 s14, s13, 0
  buffer_load_dwordx4 a[0:3], v2, s[40:43], s14 offen offset:0 sc1
  buffer_load_dwordx4 a[4:7], v2, s[40:43], s14 offen offset:1024 sc1
  buffer_load_dwordx4 a[8:11], v2, s[40:43], s14 offen offset:2048 sc1
  buffer_load_dwordx4 a[12:15], v2, s[40:43], s14 offen offset:3072 sc1
  s_add_u32 s14, s13, 4096
  buffer_load_dwordx4 a[16:19], v2, s[40:43], s14 offen offset:0 sc1
  buffer_load_dwordx4 a[20:23], v2, s[40:43], s14 offen offset:1024 sc1
  s_cmp_ge_u32 s29, 7
  s_cbranch_scc1 fa_leftb
  s_add_u32 s14, s13, 4096
  buffer_load_dwordx4 a[24:27], v2, s[40:43], s14 offen offset:2048 sc1
  buffer_load_dwordx4 a[28:31], v2, s[40:43], s14 offen offset:3072 sc1
  s_add_u32 s14, s13, 8192
  buffer_load_dwordx4 a[32:35], v2, s[40:43], s14 offen offset:0 sc1
  buffer_load_dwordx4 a[36:39], v2, s[40:43], s14 offen offset:1024 sc1
  buffer_load_dwordx4 a[40:43], v2, s[40:43], s14 offen offset:2048 sc1
  buffer_load_dwordx4 a[44:47], v2, s[40:43], s14 offen offset:3072 sc1
  s_cmp_ge_u32 s29, 6
  s_cbranch_scc1 fa_leftb
  s_add_u32 s14, s13, 12288
  buffer_load_dwordx4 a[48:51], v2, s[40:43], s14 offen offset:0 sc1
  buffer_load_dwordx4 a[52:55], v2, s[40:43], s14 offen offset:1024 sc1
  buffer_load_dwordx4 a[56:59], v2, s[40:43], s14 offen offset:2048 sc1
  buffer_load_dwordx4 a[60:63], v2, s[40:43], s14 offen offset:3072 sc1
  s_add_u32 s14, s13, 16384
  buffer_load_dwordx4 a[192:195], v2, s[40:43], s14 offen offset:0 sc1
  buffer_load_dwordx4 a[196:199], v2, s[40:43], s14 offen offset:1024 sc1
  s_cmp_ge_u32 s29, 5
  s_cbranch_scc1 fa_leftb
  s_add_u32 s14, s13, 16384
  buffer_load_dwordx4 a[200:203], v2, s[40:43], s14 offen offset:2048 sc1
  buffer_load_dwordx4 a[204:207], v2, s[40:43], s14 offen offset:3072 sc1
  s_add_u32 s14, s13, 20480
  buffer_load_dwordx4 a[208:211], v2, s[40:43], s14 offen offset:0 sc1
  buffer_load_dwordx4 a[212:215], v2, s[40:43], s14 offen offset:1024 sc1
  buffer_load_dwordx4 a[216:219], v2, s[40:43], s14 offen offset:2048 sc1
  buffer_load_dwordx4 a[220:223], v2, s[40:43], s14 offen offset:3072 sc1
  s_cmp_ge_u32 s29, 4
  s_cbranch_scc1 fa_leftb
  s_add_u32 s14, s13, 24576
  buffer_load_dwordx4 a[224:227], v2, s[40:43], s14 offen offset:0 sc1
  buffer_load_dwordx4 a[228:231], v2, s[40:43], s14 offen offset:1024 sc1
  buffer_load_dwordx4 a[232:235], v2, s[40:43], s14 offen offset:2048 sc1
  buffer_load_dwordx4 a[236:239], v2, s[40:43], s14 offen offset:3072 sc1
  s_add_u32 s14, s13, 28672
  buffer_load_dwordx4 a[240:243], v2, s[40:43], s14 offen offset:0 sc1
  buffer_load_dwordx4 a[244:247], v2, s[40:43], s14 offen offset:1024 sc1
  s_cmp_ge_u32 s29, 3
  s_cbranch_scc1 fa_leftb
  s_add_u32 s14, s13, 28672
  buffer_load_dwordx4 a[248:251], v2, s[40:43], s14 offen offset:2048 sc1
  buffer_load_dwordx4 a[252:255], v2, s[40:43], s14 offen offset:3072 sc1
  s_add_u32 s14, s13, 32768
  buffer_load_dwordx4 v[32:35], v2, s[40:43], s14 offen offset:0 sc1
  buffer_load_dwordx4 v[36:39], v2, s[40:43], s14 offen offset:1024 sc1
  buffer_load_dwordx4 v[40:43], v2, s[40:43], s14 offen offset:2048 sc1
  buffer_load_dwordx4 v[44:47], v2, s[40:43], s14 offen offset:3072 sc1
  s_cmp_ge_u32 s29, 2
  s_cbranch_scc1 fa_leftb
  s_add_u32 s14, s13, 36864
  buffer_load_dwordx4 v[48:51], v2, s[40:43], s14 offen offset:0 sc1
  buffer_load_dwordx4 v[52:55], v2, s[40:43], s14 offen offset:1024 sc1
  buffer_load_dwordx4 v[56:59], v2, s[40:43], s14 offen offset:2048 sc1
  buffer_load_dwordx4 v[60:63], v2, s[40:43], s14 offen offset:3072 sc1
  s_add_u32 s14, s13, 40960
  buffer_load_dwordx4 v[96:99], v2, s[40:43], s14 offen offset:0 sc1
  buffer_load_dwordx4 v[100:103], v2, s[40:43], s14 offen offset:1024 sc1
  s_cmp_ge_u32 s29, 1
  s_cbranch_scc1 fa_leftb
  s_add_u32 s14, s13, 40960
  buffer_load_dwordx4 v[104:107], v2, s[40:43], s14 offen offset:2048 sc1
  buffer_load_dwordx4 v[108:111], v2, s[40:43], s14 offen offset:3072 sc1
  s_add_u32 s14, s13, 45056
  buffer_load_dwordx4 v[112:115], v2, s[40:43], s14 offen offset:0 sc1
  buffer_load_dwordx4 v[116:119], v2, s[40:43], s14 offen offset:1024 sc1
  buffer_load_dwordx4 v[120:123], v2, s[40:43], s14 offen offset:2048 sc1
  buffer_load_dwordx4 v[124:127], v2, s[40:43], s14 offen offset:3072 sc1
  s_branch fa_leftb
fa_ctx_spin:
  s_mov_b32 s83, 200000
fa_ctx_spin2:
  buffer_load_dword v13, v12, s[40:43], 0 offen sc1
  s_waitcnt vmcnt(0)
  v_cmp_eq_u32 vcc, 0, v13
  s_cbranch_vccz fa_ctx_ok
  s_sleep 8
  s_sub_u32 s83, s83, 1
  s_cmp_lg_u32 s83, 0
  s_cbranch_scc1 fa_ctx_spin2
  s_branch fa_ctx_ok
fa_stub0:
  s_call_b64 s[76:77], fa_rare00
  s_call_b64 s[76:77], fa_rare10
  s_branch fa_back0
fa_stub1:
  s_call_b64 s[76:77], fa_rare01
  s_call_b64 s[76:77], fa_rare11
  s_branch fa_back1
fa_stub2:
  s_call_b64 s[76:77], fa_rare00
  s_call_b64 s[76:77], fa_rare10
  s_branch fa_back2
fa_stub3:
  s_call_b64 s[76:77], fa_rare01
  s_call_b64 s[76:77], fa_rare11
  s_branch fa_back3
fa_stub4:
  s_call_b64 s[76:77], fa_rare01
  s_call_b64 s[76:77], fa_rare11
  s_branch fa_back4
fa_stub5:
  s_call_b64 s[76:77], fa_rare00
  s_call_b64 s[76:77], fa_rare10
  s_branch fa_back5
fa_stub6:
  s_call_b64 s[76:77], fa_rare11
  s_branch fa_back6
fa_stub7:
  s_call_b64 s[76:77], fa_rare10
  s_branch fa_back7
fa_stub8:
  s_call_b64 s[76:77], fa_rare01
  s_call_b64 s[76:77], fa_rare11
  s_branch fa_back8
fa_stub9:
  s_call_b64 s[76:77], fa_rare10
  s_branch fa_back9
fa_stub10:
  s_call_b64 s[76:77], fa_rare11
  s_branch fa_back10
fa_stub11:
  s_call_b64 s[76:77], fa_rare10
  s_branch fa_back11
fa_stub12:
  s_call_b64 s[76:77], fa_rare11
  s_branch fa_back12
fa_stub13:
  s_call_b64 s[76:77], fa_rare10
  s_branch fa_back13
fa_stub14:
  s_call_b64 s[76:77], fa_rare11
  s_branch fa_back14
fa_stub15:
  s_call_b64 s[76:77], fa_rare10
  s_branch fa_back15
fa_stub16:
  s_call_b64 s[76:77], fa_rare11
  s_branch fa_back16
fa_stub17:
  s_call_b64 s[76:77], fa_rare10
  s_branch fa_back17
fa_stub18:
  s_call_b64 s[76:77], fa_rare11
  s_branch fa_back18
fa_stub19:
  s_call_b64 s[76:77], fa_rare10
  s_branch fa_back19
fa_stub20:
  s_call_b64 s[76:77], fa_rare11
  s_branch fa_back20
fa_stub21:
  s_call_b64 s[76:77], fa_rare10
  s_branch fa_back21
fa_stub22:
  s_call_b64 s[76:77], fa_rare11
  s_branch fa_back22
fa_stub23:
  s_call_b64 s[76:77], fa_rare10
  s_branch fa_back23
fa_stub24:
  s_call_b64 s[76:77], fa_rare11
  s_branch fa_back24
fa_stub25:
  s_call_b64 s[76:77], fa_rare10
  s_branch fa_back25
fa_stub26:
  s_call_b64 s[76:77], fa_rare11
  s_branch fa_back26
fa_stub27:
  s_call_b64 s[76:77], fa_rare10
  s_branch fa_back27
fa_stub28:
  s_call_b64 s[76:77], fa_rare11
  s_branch fa_back28
fa_stub29:
  s_call_b64 s[76:77], fa_rare10
  s_branch fa_back29
fa_stub30:
  s_call_b64 s[76:77], fa_rare11
  s_branch fa_back30
fa_codeend:
fa_rare00:
  s_nop 7
  v_max3_f32 v16, v96, v97, v98
  v_max3_f32 v16, v16, v99, v100
  v_max3_f32 v16, v16, v101, v102
  v_max3_f32 v16, v16, v103, 0
  v_mov_b32 v18, v16
  s_nop 1
  v_permlane16_swap_b32 v16, v18
  v_max_f32 v16, v16, v18
  v_mov_b32 v18, v16
  s_nop 1
  v_permlane32_swap_b32 v16, v18
  v_max_f32 v16, v16, v18
  v_sub_f32 v96, v96, v16
  v_sub_f32 v112, v112, v16
  v_sub_f32 v97, v97, v16
  v_sub_f32 v113, v113, v16
  v_sub_f32 v98, v98, v16
  v_sub_f32 v114, v114, v16
  v_sub_f32 v99, v99, v16
  v_sub_f32 v115, v115, v16
  v_sub_f32 v100, v100, v16
  v_sub_f32 v116, v116, v16
  v_sub_f32 v101, v101, v16
  v_sub_f32 v117, v117, v16
  v_sub_f32 v102, v102, v16
  v_sub_f32 v118, v118, v16
  v_sub_f32 v103, v103, v16
  v_sub_f32 v119, v119, v16
  v_max3_f32 v17, v104, v105, v106
  v_max3_f32 v17, v17, v107, v108
  v_max3_f32 v17, v17, v109, v110
  v_max3_f32 v17, v17, v111, 0
  v_mov_b32 v18, v17
  s_nop 1
  v_permlane16_swap_b32 v17, v18
  v_max_f32 v17, v17, v18
  v_mov_b32 v18, v17
  s_nop 1
  v_permlane32_swap_b32 v17, v18
  v_max_f32 v17, v17, v18
  v_sub_f32 v104, v104, v17
  v_sub_f32 v120, v120, v17
  v_sub_f32 v105, v105, v17
  v_sub_f32 v121, v121, v17
  v_sub_f32 v106, v106, v17
  v_sub_f32 v122, v122, v17
  v_sub_f32 v107, v107, v17
  v_sub_f32 v123, v123, v17
  v_sub_f32 v108, v108, v17
  v_sub_f32 v124, v124, v17
  v_sub_f32 v109, v109, v17
  v_sub_f32 v125, v125, v17
  v_sub_f32 v110, v110, v17
  v_sub_f32 v126, v126, v17
  v_sub_f32 v111, v111, v17
  v_sub_f32 v127, v127, v17
  s_call_b64 s[78:79], fa_resc0
  v_exp_f32 v208, v96
  v_exp_f32 v209, v97
  v_exp_f32 v210, v98
  v_add_f32 v224, v208, v209
  v_cvt_pk_bf16_f32 v160, v208, v209
  v_exp_f32 v211, v99
  v_add_f32 v224, v224, v210
  v_exp_f32 v212, v100
  v_add_f32 v224, v224, v211
  v_cvt_pk_bf16_f32 v161, v210, v211
  v_exp_f32 v213, v101
  v_add_f32 v224, v224, v212
  v_exp_f32 v214, v102
  v_add_f32 v224, v224, v213
  v_cvt_pk_bf16_f32 v162, v212, v213
  v_exp_f32 v215, v103
  v_add_f32 v224, v224, v214
  v_exp_f32 v208, v104
  v_add_f32 v224, v224, v215
  v_cvt_pk_bf16_f32 v163, v214, v215
  v_exp_f32 v209, v105
  v_exp_f32 v210, v106
  v_add_f32 v225, v208, v209
  v_cvt_pk_bf16_f32 v164, v208, v209
  v_exp_f32 v211, v107
  v_add_f32 v225, v225, v210
  v_exp_f32 v212, v108
  v_add_f32 v225, v225, v211
  v_cvt_pk_bf16_f32 v165, v210, v211
  v_exp_f32 v213, v109
  v_add_f32 v225, v225, v212
  v_exp_f32 v214, v110
  v_add_f32 v225, v225, v213
  v_cvt_pk_bf16_f32 v166, v212, v213
  v_exp_f32 v215, v111
  v_add_f32 v225, v225, v214
  s_nop 0
  v_add_f32 v225, v225, v215
  v_cvt_pk_bf16_f32 v167, v214, v215
  s_nop 1
  s_setpc_b64 s[76:77]
fa_rare01:
  s_nop 7
  v_max3_f32 v16, v112, v113, v114
  v_max3_f32 v16, v16, v115, v116
  v_max3_f32 v16, v16, v117, v118
  v_max3_f32 v16, v16, v119, 0
  v_mov_b32 v18, v16
  s_nop 1
  v_permlane16_swap_b32 v16, v18
  v_max_f32 v16, v16, v18
  v_mov_b32 v18, v16
  s_nop 1
  v_permlane32_swap_b32 v16, v18
  v_max_f32 v16, v16, v18
  v_sub_f32 v112, v112, v16
  v_sub_f32 v96, v96, v16
  v_sub_f32 v113, v113, v16
  v_sub_f32 v97, v97, v16
  v_sub_f32 v114, v114, v16
  v_sub_f32 v98, v98, v16
  v_sub_f32 v115, v115, v16
  v_sub_f32 v99, v99, v16
  v_sub_f32 v116, v116, v16
  v_sub_f32 v100, v100, v16
  v_sub_f32 v117, v117, v16
  v_sub_f32 v101, v101, v16
  v_sub_f32 v118, v118, v16
  v_sub_f32 v102, v102, v16
  v_sub_f32 v119, v119, v16
  v_sub_f32 v103, v103, v16
  v_max3_f32 v17, v120, v121, v122
  v_max3_f32 v17, v17, v123, v124
  v_max3_f32 v17, v17, v125, v126
  v_max3_f32 v17, v17, v127, 0
  v_mov_b32 v18, v17
  s_nop 1
  v_permlane16_swap_b32 v17, v18
  v_max_f32 v17, v17, v18
  v_mov_b32 v18, v17
  s_nop 1
  v_permlane32_swap_b32 v17, v18
  v_max_f32 v17, v17, v18
  v_sub_f32 v120, v120, v17
  v_sub_f32 v104, v104, v17
  v_sub_f32 v121, v121, v17
  v_sub_f32 v105, v105, v17
  v_sub_f32 v122, v122, v17
  v_sub_f32 v106, v106, v17
  v_sub_f32 v123, v123, v17
  v_sub_f32 v107, v107, v17
  v_sub_f32 v124, v124, v17
  v_sub_f32 v108, v108, v17
  v_sub_f32 v125, v125, v17
  v_sub_f32 v109, v109, v17
  v_sub_f32 v126, v126, v17
  v_sub_f32 v110, v110, v17
  v_sub_f32 v127, v127, v17
  v_sub_f32 v111, v111, v17
  s_call_b64 s[78:79], fa_resc0
  v_exp_f32 v208, v112
  v_exp_f32 v209, v113
  v_exp_f32 v210, v114
  v_add_f32 v224, v208, v209
  v_cvt_pk_bf16_f32 v168, v208, v209
  v_exp_f32 v211, v115
  v_add_f32 v224, v224, v210
  v_exp_f32 v212, v116
  v_add_f32 v224, v224, v211
  v_cvt_pk_bf16_f32 v169, v210, v211
  v_exp_f32 v213, v117
  v_add_f32 v224, v224, v212
  v_exp_f32 v214, v118
  v_add_f32 v224, v224, v213
  v_cvt_pk_bf16_f32 v170, v212, v213
  v_exp_f32 v215, v119
  v_add_f32 v224, v224, v214
  v_exp_f32 v208, v120
  v_add_f32 v224, v224, v215
  v_cvt_pk_bf16_f32 v171, v214, v215
  v_exp_f32 v209, v121
  v_exp_f32 v210, v122
  v_add_f32 v225, v208, v209
  v_cvt_pk_bf16_f32 v172, v208, v209
  v_exp_f32 v211, v123
  v_add_f32 v225, v225, v210
  v_exp_f32 v212, v124
  v_add_f32 v225, v225, v211
  v_cvt_pk_bf16_f32 v173, v210, v211
  v_exp_f32 v213, v125
  v_add_f32 v225, v225, v212
  v_exp_f32 v214, v126
  v_add_f32 v225, v225, v213
  v_cvt_pk_bf16_f32 v174, v212, v213
  v_exp_f32 v215, v127
  v_add_f32 v225, v225, v214
  s_nop 0
  v_add_f32 v225, v225, v215
  v_cvt_pk_bf16_f32 v175, v214, v215
  s_nop 1
  s_setpc_b64 s[76:77]
fa_resc0:
  v_sub_f32 v192, v192, v16
  v_sub_f32 v193, v193, v16
  v_sub_f32 v194, v194, v16
  v_sub_f32 v195, v195, v16
  v_exp_f32 v18, -v16
  v_sub_f32 v196, v196, v17
  v_sub_f32 v197, v197, v17
  v_sub_f32 v198, v198, v17
  v_sub_f32 v199, v199, v17
  v_exp_f32 v19, -v17
  s_nop 0
  v_mul_f32 v228, v228, v18
  v_mul_f32 v229, v229, v19
  v_accvgpr_read_b32 v20, a0
  v_accvgpr_read_b32 v21, a1
  v_accvgpr_read_b32 v22, a2
  v_accvgpr_read_b32 v23, a3
  v_mul_f32 v20, v20, v18
  v_mul_f32 v21, v21, v18
  v_mul_f32 v22, v22, v18
  v_mul_f32 v23, v23, v18
  v_accvgpr_write_b32 a0, v20
  v_accvgpr_write_b32 a1, v21
  v_accvgpr_write_b32 a2, v22
  v_accvgpr_write_b32 a3, v23
  v_accvgpr_read_b32 v20, a4
  v_accvgpr_read_b32 v21, a5
  v_accvgpr_read_b32 v22, a6
  v_accvgpr_read_b32 v23, a7
  v_mul_f32 v20, v20, v19
  v_mul_f32 v21, v21, v19
  v_mul_f32 v22, v22, v19
  v_mul_f32 v23, v23, v19
  v_accvgpr_write_b32 a4, v20
  v_accvgpr_write_b32 a5, v21
  v_accvgpr_write_b32 a6, v22
  v_accvgpr_write_b32 a7, v23
  v_accvgpr_read_b32 v20, a8
  v_accvgpr_read_b32 v21, a9
  v_accvgpr_read_b32 v22, a10
  v_accvgpr_read_b32 v23, a11
  v_mul_f32 v20, v20, v18
  v_mul_f32 v21, v21, v18
  v_mul_f32 v22, v22, v18
  v_mul_f32 v23, v23, v18
  v_accvgpr_write_b32 a8, v20
  v_accvgpr_write_b32 a9, v21
  v_accvgpr_write_b32 a10, v22
  v_accvgpr_write_b32 a11, v23
  v_accvgpr_read_b32 v20, a12
  v_accvgpr_read_b32 v21, a13
  v_accvgpr_read_b32 v22, a14
  v_accvgpr_read_b32 v23, a15
  v_mul_f32 v20, v20, v19
  v_mul_f32 v21, v21, v19
  v_mul_f32 v22, v22, v19
  v_mul_f32 v23, v23, v19
  v_accvgpr_write_b32 a12, v20
  v_accvgpr_write_b32 a13, v21
  v_accvgpr_write_b32 a14, v22
  v_accvgpr_write_b32 a15, v23
  v_accvgpr_read_b32 v20, a16
  v_accvgpr_read_b32 v21, a17
  v_accvgpr_read_b32 v22, a18
  v_accvgpr_read_b32 v23, a19
  v_mul_f32 v20, v20, v18
  v_mul_f32 v21, v21, v18
  v_mul_f32 v22, v22, v18
  v_mul_f32 v23, v23, v18
  v_accvgpr_write_b32 a16, v20
  v_accvgpr_write_b32 a17, v21
  v_accvgpr_write_b32 a18, v22
  v_accvgpr_write_b32 a19, v23
  v_accvgpr_read_b32 v20, a20
  v_accvgpr_read_b32 v21, a21
  v_accvgpr_read_b32 v22, a22
  v_accvgpr_read_b32 v23, a23
  v_mul_f32 v20, v20, v19
  v_mul_f32 v21, v21, v19
  v_mul_f32 v22, v22, v19
  v_mul_f32 v23, v23, v19
  v_accvgpr_write_b32 a20, v20
  v_accvgpr_write_b32 a21, v21
  v_accvgpr_write_b32 a22, v22
  v_accvgpr_write_b32 a23, v23
  v_accvgpr_read_b32 v20, a24
  v_accvgpr_read_b32 v21, a25
  v_accvgpr_read_b32 v22, a26
  v_accvgpr_read_b32 v23, a27
  v_mul_f32 v20, v20, v18
  v_mul_f32 v21, v21, v18
  v_mul_f32 v22, v22, v18
  v_mul_f32 v23, v23, v18
  v_accvgpr_write_b32 a24, v20
  v_accvgpr_write_b32 a25, v21
  v_accvgpr_write_b32 a26, v22
  v_accvgpr_write_b32 a27, v23
  v_accvgpr_read_b32 v20, a28
  v_accvgpr_read_b32 v21, a29
  v_accvgpr_read_b32 v22, a30
  v_accvgpr_read_b32 v23, a31
  v_mul_f32 v20, v20, v19
  v_mul_f32 v21, v21, v19
  v_mul_f32 v22, v22, v19
  v_mul_f32 v23, v23, v19
  v_accvgpr_write_b32 a28, v20
  v_accvgpr_write_b32 a29, v21
  v_accvgpr_write_b32 a30, v22
  v_accvgpr_write_b32 a31, v23
  v_accvgpr_read_b32 v20, a32
  v_accvgpr_read_b32 v21, a33
  v_accvgpr_read_b32 v22, a34
  v_accvgpr_read_b32 v23, a35
  v_mul_f32 v20, v20, v18
  v_mul_f32 v21, v21, v18
  v_mul_f32 v22, v22, v18
  v_mul_f32 v23, v23, v18
  v_accvgpr_write_b32 a32, v20
  v_accvgpr_write_b32 a33, v21
  v_accvgpr_write_b32 a34, v22
  v_accvgpr_write_b32 a35, v23
  v_accvgpr_read_b32 v20, a36
  v_accvgpr_read_b32 v21, a37
  v_accvgpr_read_b32 v22, a38
  v_accvgpr_read_b32 v23, a39
  v_mul_f32 v20, v20, v19
  v_mul_f32 v21, v21, v19
  v_mul_f32 v22, v22, v19
  v_mul_f32 v23, v23, v19
  v_accvgpr_write_b32 a36, v20
  v_accvgpr_write_b32 a37, v21
  v_accvgpr_write_b32 a38, v22
  v_accvgpr_write_b32 a39, v23
  v_accvgpr_read_b32 v20, a40
  v_accvgpr_read_b32 v21, a41
  v_accvgpr_read_b32 v22, a42
  v_accvgpr_read_b32 v23, a43
  v_mul_f32 v20, v20, v18
  v_mul_f32 v21, v21, v18
  v_mul_f32 v22, v22, v18
  v_mul_f32 v23, v23, v18
  v_accvgpr_write_b32 a40, v20
  v_accvgpr_write_b32 a41, v21
  v_accvgpr_write_b32 a42, v22
  v_accvgpr_write_b32 a43, v23
  v_accvgpr_read_b32 v20, a44
  v_accvgpr_read_b32 v21, a45
  v_accvgpr_read_b32 v22, a46
  v_accvgpr_read_b32 v23, a47
  v_mul_f32 v20, v20, v19
  v_mul_f32 v21, v21, v19
  v_mul_f32 v22, v22, v19
  v_mul_f32 v23, v23, v19
  v_accvgpr_write_b32 a44, v20
  v_accvgpr_write_b32 a45, v21
  v_accvgpr_write_b32 a46, v22
  v_accvgpr_write_b32 a47, v23
  v_accvgpr_read_b32 v20, a48
  v_accvgpr_read_b32 v21, a49
  v_accvgpr_read_b32 v22, a50
  v_accvgpr_read_b32 v23, a51
  v_mul_f32 v20, v20, v18
  v_mul_f32 v21, v21, v18
  v_mul_f32 v22, v22, v18
  v_mul_f32 v23, v23, v18
  v_accvgpr_write_b32 a48, v20
  v_accvgpr_write_b32 a49, v21
  v_accvgpr_write_b32 a50, v22
  v_accvgpr_write_b32 a51, v23
  v_accvgpr_read_b32 v20, a52
  v_accvgpr_read_b32 v21, a53
  v_accvgpr_read_b32 v22, a54
  v_accvgpr_read_b32 v23, a55
  v_mul_f32 v20, v20, v19
  v_mul_f32 v21, v21, v19
  v_mul_f32 v22, v22, v19
  v_mul_f32 v23, v23, v19
  v_accvgpr_write_b32 a52, v20
  v_accvgpr_write_b32 a53, v21
  v_accvgpr_write_b32 a54, v22
  v_accvgpr_write_b32 a55, v23
  v_accvgpr_read_b32 v20, a56
  v_accvgpr_read_b32 v21, a57
  v_accvgpr_read_b32 v22, a58
  v_accvgpr_read_b32 v23, a59
  v_mul_f32 v20, v20, v18
  v_mul_f32 v21, v21, v18
  v_mul_f32 v22, v22, v18
  v_mul_f32 v23, v23, v18
  v_accvgpr_write_b32 a56, v20
  v_accvgpr_write_b32 a57, v21
  v_accvgpr_write_b32 a58, v22
  v_accvgpr_write_b32 a59, v23
  v_accvgpr_read_b32 v20, a60
  v_accvgpr_read_b32 v21, a61
  v_accvgpr_read_b32 v22, a62
  v_accvgpr_read_b32 v23, a63
  v_mul_f32 v20, v20, v19
  v_mul_f32 v21, v21, v19
  v_mul_f32 v22, v22, v19
  v_mul_f32 v23, v23, v19
  v_accvgpr_write_b32 a60, v20
  v_accvgpr_write_b32 a61, v21
  v_accvgpr_write_b32 a62, v22
  v_accvgpr_write_b32 a63, v23
  s_setpc_b64 s[78:79]
fa_rare10:
  s_nop 7
  v_max3_f32 v16, v128, v129, v130
  v_max3_f32 v16, v16, v131, v132
  v_max3_f32 v16, v16, v133, v134
  v_max3_f32 v16, v16, v135, 0
  v_mov_b32 v18, v16
  s_nop 1
  v_permlane16_swap_b32 v16, v18
  v_max_f32 v16, v16, v18
  v_mov_b32 v18, v16
  s_nop 1
  v_permlane32_swap_b32 v16, v18
  v_max_f32 v16, v16, v18
  v_sub_f32 v128, v128, v16
  v_sub_f32 v144, v144, v16
  v_sub_f32 v129, v129, v16
  v_sub_f32 v145, v145, v16
  v_sub_f32 v130, v130, v16
  v_sub_f32 v146, v146, v16
  v_sub_f32 v131, v131, v16
  v_sub_f32 v147, v147, v16
  v_sub_f32 v132, v132, v16
  v_sub_f32 v148, v148, v16
  v_sub_f32 v133, v133, v16
  v_sub_f32 v149, v149, v16
  v_sub_f32 v134, v134, v16
  v_sub_f32 v150, v150, v16
  v_sub_f32 v135, v135, v16
  v_sub_f32 v151, v151, v16
  v_max3_f32 v17, v136, v137, v138
  v_max3_f32 v17, v17, v139, v140
  v_max3_f32 v17, v17, v141, v142
  v_max3_f32 v17, v17, v143, 0
  v_mov_b32 v18, v17
  s_nop 1
  v_permlane16_swap_b32 v17, v18
  v_max_f32 v17, v17, v18
  v_mov_b32 v18, v17
  s_nop 1
  v_permlane32_swap_b32 v17, v18
  v_max_f32 v17, v17, v18
  v_sub_f32 v136, v136, v17
  v_sub_f32 v152, v152, v17
  v_sub_f32 v137, v137, v17
  v_sub_f32 v153, v153, v17
  v_sub_f32 v138, v138, v17
  v_sub_f32 v154, v154, v17
  v_sub_f32 v139, v139, v17
  v_sub_f32 v155, v155, v17
  v_sub_f32 v140, v140, v17
  v_sub_f32 v156, v156, v17
  v_sub_f32 v141, v141, v17
  v_sub_f32 v157, v157, v17
  v_sub_f32 v142, v142, v17
  v_sub_f32 v158, v158, v17
  v_sub_f32 v143, v143, v17
  v_sub_f32 v159, v159, v17
  s_call_b64 s[78:79], fa_resc1
  v_exp_f32 v216, v128
  v_exp_f32 v217, v129
  v_exp_f32 v218, v130
  v_add_f32 v226, v216, v217
  v_cvt_pk_bf16_f32 v176, v216, v217
  v_exp_f32 v219, v131
  v_add_f32 v226, v226, v218
  v_exp_f32 v220, v132
  v_add_f32 v226, v226, v219
  v_cvt_pk_bf16_f32 v177, v218, v219
  v_exp_f32 v221, v133
  v_add_f32 v226, v226, v220
  v_exp_f32 v222, v134
  v_add_f32 v226, v226, v221
  v_cvt_pk_bf16_f32 v178, v220, v221
  v_exp_f32 v223, v135
  v_add_f32 v226, v226, v222
  v_exp_f32 v216, v136
  v_add_f32 v226, v226, v223
  v_cvt_pk_bf16_f32 v179, v222, v223
  v_exp_f32 v217, v137
  v_exp_f32 v218, v138
  v_add_f32 v227, v216, v217
  v_cvt_pk_bf16_f32 v180, v216, v217
  v_exp_f32 v219, v139
  v_add_f32 v227, v227, v218
  v_exp_f32 v220, v140
  v_add_f32 v227, v227, v219
  v_cvt_pk_bf16_f32 v181, v218, v219
  v_exp_f32 v221, v141
  v_add_f32 v227, v227, v220
  v_exp_f32 v222, v142
  v_add_f32 v227, v227, v221
  v_cvt_pk_bf16_f32 v182, v220, v221
  v_exp_f32 v223, v143
  v_add_f32 v227, v227, v222
  s_nop 0
  v_add_f32 v227, v227, v223
  v_cvt_pk_bf16_f32 v183, v222, v223
  v_exp_f32 v216, v144
  s_nop 1
  s_setpc_b64 s[76:77]
fa_rare11:
  s_nop 7
  v_max3_f32 v16, v144, v145, v146
  v_max3_f32 v16, v16, v147, v148
  v_max3_f32 v16, v16, v149, v150
  v_max3_f32 v16, v16, v151, 0
  v_mov_b32 v18, v16
  s_nop 1
  v_permlane16_swap_b32 v16, v18
  v_max_f32 v16, v16, v18
  v_mov_b32 v18, v16
  s_nop 1
  v_permlane32_swap_b32 v16, v18
  v_max_f32 v16, v16, v18
  v_sub_f32 v144, v144, v16
  v_sub_f32 v128, v128, v16
  v_sub_f32 v145, v145, v16
  v_sub_f32 v129, v129, v16
  v_sub_f32 v146, v146, v16
  v_sub_f32 v130, v130, v16
  v_sub_f32 v147, v147, v16
  v_sub_f32 v131, v131, v16
  v_sub_f32 v148, v148, v16
  v_sub_f32 v132, v132, v16
  v_sub_f32 v149, v149, v16
  v_sub_f32 v133, v133, v16
  v_sub_f32 v150, v150, v16
  v_sub_f32 v134, v134, v16
  v_sub_f32 v151, v151, v16
  v_sub_f32 v135, v135, v16
  v_max3_f32 v17, v152, v153, v154
  v_max3_f32 v17, v17, v155, v156
  v_max3_f32 v17, v17, v157, v158
  v_max3_f32 v17, v17, v159, 0
  v_mov_b32 v18, v17
  s_nop 1
  v_permlane16_swap_b32 v17, v18
  v_max_f32 v17, v17, v18
  v_mov_b32 v18, v17
  s_nop 1
  v_permlane32_swap_b32 v17, v18
  v_max_f32 v17, v17, v18
  v_sub_f32 v152, v152, v17
  v_sub_f32 v136, v136, v17
  v_sub_f32 v153, v153, v17
  v_sub_f32 v137, v137, v17
  v_sub_f32 v154, v154, v17
  v_sub_f32 v138, v138, v17
  v_sub_f32 v155, v155, v17
  v_sub_f32 v139, v139, v17
  v_sub_f32 v156, v156, v17
  v_sub_f32 v140, v140, v17
  v_sub_f32 v157, v157, v17
  v_sub_f32 v141, v141, v17
  v_sub_f32 v158, v158, v17
  v_sub_f32 v142, v142, v17
  v_sub_f32 v159, v159, v17
  v_sub_f32 v143, v143, v17
  s_call_b64 s[78:79], fa_resc1
  v_exp_f32 v216, v144
  v_exp_f32 v217, v145
  v_exp_f32 v218, v146
  v_add_f32 v226, v216, v217
  v_cvt_pk_bf16_f32 v184, v216, v217
  v_exp_f32 v219, v147
  v_add_f32 v226, v226, v218
  v_exp_f32 v220, v148
  v_add_f32 v226, v226, v219
  v_cvt_pk_bf16_f32 v185, v218, v219
  v_exp_f32 v221, v149
  v_add_f32 v226, v226, v220
  v_exp_f32 v222, v150
  v_add_f32 v226, v226, v221
  v_cvt_pk_bf16_f32 v186, v220, v221
  v_exp_f32 v223, v151
  v_add_f32 v226, v226, v222
  v_exp_f32 v216, v152
  v_add_f32 v226, v226, v223
  v_cvt_pk_bf16_f32 v187, v222, v223
  v_exp_f32 v217, v153
  v_exp_f32 v218, v154
  v_add_f32 v227, v216, v217
  v_cvt_pk_bf16_f32 v188, v216, v217
  v_exp_f32 v219, v155
  v_add_f32 v227, v227, v218
  v_exp_f32 v220, v156
  v_add_f32 v227, v227, v219
  v_cvt_pk_bf16_f32 v189, v218, v219
  v_exp_f32 v221, v157
  v_add_f32 v227, v227, v220
  v_exp_f32 v222, v158
  v_add_f32 v227, v227, v221
  v_cvt_pk_bf16_f32 v190, v220, v221
  v_exp_f32 v223, v159
  v_add_f32 v227, v227, v222
  s_nop 0
  v_add_f32 v227, v227, v223
  v_cvt_pk_bf16_f32 v191, v222, v223
  v_exp_f32 v216, v128
  s_nop 1
  s_setpc_b64 s[76:77]
fa_resc1:
  v_sub_f32 v200, v200, v16
  v_sub_f32 v201, v201, v16
  v_sub_f32 v202, v202, v16
  v_sub_f32 v203, v203, v16
  v_exp_f32 v18, -v16
  v_sub_f32 v204, v204, v17
  v_sub_f32 v205, v205, v17
  v_sub_f32 v206, v206, v17
  v_sub_f32 v207, v207, v17
  v_exp_f32 v19, -v17
  s_nop 0
  v_mul_f32 v230, v230, v18
  v_mul_f32 v231, v231, v19
  v_accvgpr_read_b32 v20, a64
  v_accvgpr_read_b32 v21, a65
  v_accvgpr_read_b32 v22, a66
  v_accvgpr_read_b32 v23, a67
  v_mul_f32 v20, v20, v18
  v_mul_f32 v21, v21, v18
  v_mul_f32 v22, v22, v18
  v_mul_f32 v23, v23, v18
  v_accvgpr_write_b32 a64, v20
  v_accvgpr_write_b32 a65, v21
  v_accvgpr_write_b32 a66, v22
  v_accvgpr_write_b32 a67, v23
  v_accvgpr_read_b32 v20, a68
  v_accvgpr_read_b32 v21, a69
  v_accvgpr_read_b32 v22, a70
  v_accvgpr_read_b32 v23, a71
  v_mul_f32 v20, v20, v19
  v_mul_f32 v21, v21, v19
  v_mul_f32 v22, v22, v19
  v_mul_f32 v23, v23, v19
  v_accvgpr_write_b32 a68, v20
  v_accvgpr_write_b32 a69, v21
  v_accvgpr_write_b32 a70, v22
  v_accvgpr_write_b32 a71, v23
  v_accvgpr_read_b32 v20, a72
  v_accvgpr_read_b32 v21, a73
  v_accvgpr_read_b32 v22, a74
  v_accvgpr_read_b32 v23, a75
  v_mul_f32 v20, v20, v18
  v_mul_f32 v21, v21, v18
  v_mul_f32 v22, v22, v18
  v_mul_f32 v23, v23, v18
  v_accvgpr_write_b32 a72, v20
  v_accvgpr_write_b32 a73, v21
  v_accvgpr_write_b32 a74, v22
  v_accvgpr_write_b32 a75, v23
  v_accvgpr_read_b32 v20, a76
  v_accvgpr_read_b32 v21, a77
  v_accvgpr_read_b32 v22, a78
  v_accvgpr_read_b32 v23, a79
  v_mul_f32 v20, v20, v19
  v_mul_f32 v21, v21, v19
  v_mul_f32 v22, v22, v19
  v_mul_f32 v23, v23, v19
  v_accvgpr_write_b32 a76, v20
  v_accvgpr_write_b32 a77, v21
  v_accvgpr_write_b32 a78, v22
  v_accvgpr_write_b32 a79, v23
  v_accvgpr_read_b32 v20, a80
  v_accvgpr_read_b32 v21, a81
  v_accvgpr_read_b32 v22, a82
  v_accvgpr_read_b32 v23, a83
  v_mul_f32 v20, v20, v18
  v_mul_f32 v21, v21, v18
  v_mul_f32 v22, v22, v18
  v_mul_f32 v23, v23, v18
  v_accvgpr_write_b32 a80, v20
  v_accvgpr_write_b32 a81, v21
  v_accvgpr_write_b32 a82, v22
  v_accvgpr_write_b32 a83, v23
  v_accvgpr_read_b32 v20, a84
  v_accvgpr_read_b32 v21, a85
  v_accvgpr_read_b32 v22, a86
  v_accvgpr_read_b32 v23, a87
  v_mul_f32 v20, v20, v19
  v_mul_f32 v21, v21, v19
  v_mul_f32 v22, v22, v19
  v_mul_f32 v23, v23, v19
  v_accvgpr_write_b32 a84, v20
  v_accvgpr_write_b32 a85, v21
  v_accvgpr_write_b32 a86, v22
  v_accvgpr_write_b32 a87, v23
  v_accvgpr_read_b32 v20, a88
  v_accvgpr_read_b32 v21, a89
  v_accvgpr_read_b32 v22, a90
  v_accvgpr_read_b32 v23, a91
  v_mul_f32 v20, v20, v18
  v_mul_f32 v21, v21, v18
  v_mul_f32 v22, v22, v18
  v_mul_f32 v23, v23, v18
  v_accvgpr_write_b32 a88, v20
  v_accvgpr_write_b32 a89, v21
  v_accvgpr_write_b32 a90, v22
  v_accvgpr_write_b32 a91, v23
  v_accvgpr_read_b32 v20, a92
  v_accvgpr_read_b32 v21, a93
  v_accvgpr_read_b32 v22, a94
  v_accvgpr_read_b32 v23, a95
  v_mul_f32 v20, v20, v19
  v_mul_f32 v21, v21, v19
  v_mul_f32 v22, v22, v19
  v_mul_f32 v23, v23, v19
  v_accvgpr_write_b32 a92, v20
  v_accvgpr_write_b32 a93, v21
  v_accvgpr_write_b32 a94, v22
  v_accvgpr_write_b32 a95, v23
  v_accvgpr_read_b32 v20, a96
  v_accvgpr_read_b32 v21, a97
  v_accvgpr_read_b32 v22, a98
  v_accvgpr_read_b32 v23, a99
  v_mul_f32 v20, v20, v18
  v_mul_f32 v21, v21, v18
  v_mul_f32 v22, v22, v18
  v_mul_f32 v23, v23, v18
  v_accvgpr_write_b32 a96, v20
  v_accvgpr_write_b32 a97, v21
  v_accvgpr_write_b32 a98, v22
  v_accvgpr_write_b32 a99, v23
  v_accvgpr_read_b32 v20, a100
  v_accvgpr_read_b32 v21, a101
  v_accvgpr_read_b32 v22, a102
  v_accvgpr_read_b32 v23, a103
  v_mul_f32 v20, v20, v19
  v_mul_f32 v21, v21, v19
  v_mul_f32 v22, v22, v19
  v_mul_f32 v23, v23, v19
  v_accvgpr_write_b32 a100, v20
  v_accvgpr_write_b32 a101, v21
  v_accvgpr_write_b32 a102, v22
  v_accvgpr_write_b32 a103, v23
  v_accvgpr_read_b32 v20, a104
  v_accvgpr_read_b32 v21, a105
  v_accvgpr_read_b32 v22, a106
  v_accvgpr_read_b32 v23, a107
  v_mul_f32 v20, v20, v18
  v_mul_f32 v21, v21, v18
  v_mul_f32 v22, v22, v18
  v_mul_f32 v23, v23, v18
  v_accvgpr_write_b32 a104, v20
  v_accvgpr_write_b32 a105, v21
  v_accvgpr_write_b32 a106, v22
  v_accvgpr_write_b32 a107, v23
  v_accvgpr_read_b32 v20, a108
  v_accvgpr_read_b32 v21, a109
  v_accvgpr_read_b32 v22, a110
  v_accvgpr_read_b32 v23, a111
  v_mul_f32 v20, v20, v19
  v_mul_f32 v21, v21, v19
  v_mul_f32 v22, v22, v19
  v_mul_f32 v23, v23, v19
  v_accvgpr_write_b32 a108, v20
  v_accvgpr_write_b32 a109, v21
  v_accvgpr_write_b32 a110, v22
  v_accvgpr_write_b32 a111, v23
  v_accvgpr_read_b32 v20, a112
  v_accvgpr_read_b32 v21, a113
  v_accvgpr_read_b32 v22, a114
  v_accvgpr_read_b32 v23, a115
  v_mul_f32 v20, v20, v18
  v_mul_f32 v21, v21, v18
  v_mul_f32 v22, v22, v18
  v_mul_f32 v23, v23, v18
  v_accvgpr_write_b32 a112, v20
  v_accvgpr_write_b32 a113, v21
  v_accvgpr_write_b32 a114, v22
  v_accvgpr_write_b32 a115, v23
  v_accvgpr_read_b32 v20, a116
  v_accvgpr_read_b32 v21, a117
  v_accvgpr_read_b32 v22, a118
  v_accvgpr_read_b32 v23, a119
  v_mul_f32 v20, v20, v19
  v_mul_f32 v21, v21, v19
  v_mul_f32 v22, v22, v19
  v_mul_f32 v23, v23, v19
  v_accvgpr_write_b32 a116, v20
  v_accvgpr_write_b32 a117, v21
  v_accvgpr_write_b32 a118, v22
  v_accvgpr_write_b32 a119, v23
  v_accvgpr_read_b32 v20, a120
  v_accvgpr_read_b32 v21, a121
  v_accvgpr_read_b32 v22, a122
  v_accvgpr_read_b32 v23, a123
  v_mul_f32 v20, v20, v18
  v_mul_f32 v21, v21, v18
  v_mul_f32 v22, v22, v18
  v_mul_f32 v23, v23, v18
  v_accvgpr_write_b32 a120, v20
  v_accvgpr_write_b32 a121, v21
  v_accvgpr_write_b32 a122, v22
  v_accvgpr_write_b32 a123, v23
  v_accvgpr_read_b32 v20, a124
  v_accvgpr_read_b32 v21, a125
  v_accvgpr_read_b32 v22, a126
  v_accvgpr_read_b32 v23, a127
  v_mul_f32 v20, v20, v19
  v_mul_f32 v21, v21, v19
  v_mul_f32 v22, v22, v19
  v_mul_f32 v23, v23, v19
  v_accvgpr_write_b32 a124, v20
  v_accvgpr_write_b32 a125, v21
  v_accvgpr_write_b32 a126, v22
  v_accvgpr_write_b32 a127, v23
  s_setpc_b64 s[78:79]
.section .rodata,"a"
.p2align 6
.amdhsa_kernel fa_kernel
  .amdhsa_next_free_vgpr 512
  .amdhsa_next_free_sgpr 102
  .amdhsa_accum_offset 256
  .amdhsa_group_segment_fixed_size 0
  .amdhsa_kernarg_size 112
  .amdhsa_user_sgpr_count 2
  .amdhsa_user_sgpr_kernarg_segment_ptr 1
  .amdhsa_system_sgpr_workgroup_id_x 1
  .amdhsa_float_denorm_mode_32 3
.end_amdhsa_kernel
.text
```

```asm
; @launch kernel=fa_kernel grid=(256,1,1) block=(256,1,1) lds=163840
.amdgcn_target "amdgcn-amd-amdhsa--gfx950"
.text
.globl fa_kernel
.p2align 8
.type fa_kernel,@function
fa_kernel:
  s_cmp_ge_u32 s2, 256
  s_cbranch_scc1 fa_end
  s_getpc_b64 s[62:63]
  v_and_b32 v230, 127, v0
  v_lshlrev_b32 v230, 7, v230
  global_load_dword v231, v230, s[62:63]
  s_load_dwordx4 s[4:7], s[0:1], 0
  s_load_dwordx4 s[8:11], s[0:1], 24
  s_load_dwordx2 s[14:15], s[0:1], 56
  s_load_dwordx2 s[12:13], s[0:1], 40
  s_load_dwordx4 s[16:19], s[0:1], 96
  s_load_dwordx2 s[60:61], s[0:1], 16
  v_lshrrev_b32 v16, 6, v0
  v_and_b32 v1, 63, v0
  v_readfirstlane_b32 s20, v16
  s_and_b32 s21, s2, 7
  s_lshl_b32 s21, s21, 2
  s_lshr_b32 s23, s2, 3
  s_and_b32 s23, s23, 3
  s_add_u32 s21, s21, s23
  s_lshr_b32 s22, s2, 5
  v_and_b32 v208, 31, v1
  v_lshrrev_b32 v209, 5, v1
  s_lshl_b32 s31, s2, 2
  s_add_u32 s31, s31, s20
  s_lshl_b32 s31, s31, 1
  v_add_u32 v209, s31, v209
  v_lshlrev_b32 v212, 4, v208
  v_mul_u32_u24 v210, 1280, v209
  v_add_u32 v210, v210, v212
  v_cmp_gt_u32 s[64:65], 16, v208
  v_mov_b32 v19, 1073741824
  v_and_b32 v220, 7, v209
  v_cndmask_b32 v211, v19, v210, s[64:65]
  v_bfe_u32 v17, v1, 1, 3
  v_lshlrev_b32 v17, 13, v17
  v_and_b32 v18, 1, v1
  v_lshl_add_u32 v235, v18, 7, v17
  s_lshl_b32 s74, s22, 1
  s_and_b32 s31, s20, 1
  s_add_u32 s74, s74, s31
  s_lshl_b32 s74, s74, 16
  s_mov_b32 s73, 1048576
  v_and_b32 v16, 15, v1
  v_lshlrev_b32 v17, 10, v16
  v_and_b32 v18, 16, v1
  v_lshl_add_u32 v233, v18, 3, v17
  s_lshl_b32 s30, s23, 5
  s_add_u32 s30, s30, s20
  s_lshl_b32 s30, s30, 14
  s_lshl_b32 s29, s22, 16
  s_lshl_b32 s23, s21, 8
  s_cmp_ge_u32 s20, 2
  s_waitcnt lgkmcnt(0)
  s_mov_b32 s44, s4
  s_mov_b32 s45, s5
  s_mov_b32 s46, 2621440
  s_mov_b32 s47, 0x20000
  s_mov_b32 s68, s14
  s_mov_b32 s69, s15
  s_mov_b32 s70, 1280
  s_mov_b32 s71, 0x20000
  buffer_load_dwordx4 v[160:163], v210, s[44:47], 0 offen
  buffer_load_dwordx4 v[164:167], v210, s[44:47], 0 offen offset:512
  buffer_load_dwordx4 v[168:171], v211, s[44:47], 0 offen offset:1024
  buffer_load_dwordx4 v[172:175], v212, s[68:71], 0 offen offset:0
  buffer_load_dwordx4 v[176:179], v212, s[68:71], 0 offen offset:512
  buffer_load_dwordx4 v[180:183], v212, s[68:71], 0 offen offset:1024
  s_cselect_b32 s62, s10, s8
  s_cselect_b32 s63, s11, s9
  s_add_u32 s62, s62, s23
  s_addc_u32 s63, s63, 0
  s_mov_b32 s36, s62
  s_mov_b32 s37, s63
  s_mov_b32 s38, 0
  s_mov_b32 s39, 0x20000
  s_sub_u32 s38, 4194304, s23
  buffer_load_dword v231, v235, s[36:39], s74 offen
  s_add_u32 s6, s6, s29
  s_addc_u32 s7, s7, 0
  s_mov_b32 s32, s6
  s_mov_b32 s33, s7
  s_mov_b32 s34, 0
  s_mov_b32 s35, 0x20000
  s_sub_u32 s34, 2097152, s29
  buffer_load_dword v232, v233, s[32:35], s30 offen
  s_add_u32 s74, s74, s73
  buffer_load_dword v231, v235, s[36:39], s74 offen
  buffer_load_dword v232, v233, s[32:35], s30 offen offset:256
  s_getpc_b64 s[8:9]
fa_pc:
  s_lshr_b32 s31, s2, 3
  s_and_b32 s31, s31, 15
  s_lshl_b32 s31, s31, 2
  s_add_u32 s31, s31, s20
  s_lshl_b32 s31, s31, 11
  s_min_u32 s31, s31, fa_codeend-fa_pc-2048
  v_lshlrev_b32 v234, 7, v16
  v_add_u32 v230, s31, v234
  global_load_dword v231, v230, s[8:9]
  s_add_u32 s8, s8, fa_co1-fa_pc-4
  s_addc_u32 s9, s9, 0
  s_add_u32 s60, s60, s23
  s_addc_u32 s61, s61, 0
  s_sub_u32 s75, 5242880, s23
  s_mov_b32 s48, s62
  s_mov_b32 s49, s63
  s_mov_b32 s50, s38
  s_mov_b32 s51, 0x20000
  v_lshlrev_b32 v2, 4, v1
  v_lshrrev_b32 v19, 2, v1
  v_lshrrev_b32 v17, 5, v1
  v_mul_u32_u24 v17, 3, v17
  v_and_b32 v18, 3, v1
  v_xor_b32 v17, v17, v18
  v_lshlrev_b32 v17, 4, v17
  v_lshl_add_u32 v3, v19, 10, v17
  s_lshl_b32 s23, s20, 19
  v_add_u32 v3, s23, v3
  v_add_u32 v4, 15360, v3
  v_add_u32 v5, 30720, v3
  v_add_u32 v6, 46080, v3
  v_and_b32 v19, 3, v19
  v_lshrrev_b32 v17, 4, v1
  v_lshlrev_b32 v17, 6, v17
  v_lshl_add_u32 v19, v19, 13, v17
  s_and_b32 s23, s20, 1
  s_lshl_b32 s23, s23, 17
  v_add_u32 v19, s23, v19
  v_lshl_add_u32 v8, v18, 4, v19
  v_xor_b32 v18, 2, v18
  v_lshl_add_u32 v10, v18, 4, v19
  v_add_u32 v9, 31744, v8
  v_add_u32 v11, 95232, v10
  v_add_u32 v10, 63488, v10
  s_lshl_b32 s24, s20, 12
  s_mov_b32 s26, 0
  s_mov_b32 s27, 0
  s_mov_b32 s25, 262144
  s_mov_b32 s79, 64
  s_mov_b32 s40, s18
  s_mov_b32 s41, s19
  s_mov_b32 s42, 67108864
  s_mov_b32 s43, 0x20000
  s_mov_b32 s52, s12
  s_mov_b32 s53, s13
  s_mov_b32 s54, 5242880
  s_mov_b32 s55, 0x20000
  s_mov_b32 s56, s16
  s_mov_b32 s57, s17
  s_mov_b32 s58, 256
  s_mov_b32 s59, 0x20000
  s_and_b32 s29, s2, 7
  s_lshl_b32 s29, s29, 2
  s_add_u32 s29, s29, s20
  s_lshl_b32 s29, s29, 11
  s_and_b32 s23, s21, 3
  s_lshl_b32 s23, s23, 19
  s_add_u32 s29, s29, s23
  s_mul_i32 s23, s20, 4352
  s_lshl_b32 s31, s21, 2
  s_add_u32 s23, s23, s31
  s_add_u32 s23, s23, 3801088
  s_mul_i32 s31, s22, 17408
  s_add_u32 s80, s23, s31
  s_sub_u32 s31, 261120, s31
  s_add_u32 s3, s23, s31
  s_lshl_b32 s23, s21, 7
  s_lshl_b32 s31, s22, 2
  s_add_u32 s23, s23, s31
  s_add_u32 s82, s23, 2637824
  s_sub_u32 s62, s2, 170
  s_lshl_b32 s31, s20, 6
  s_add_u32 s62, s62, s31
  s_lshl_b32 s62, s62, 2
  s_add_u32 s62, s62, 2650112
  s_sub_u32 s23, s2, 170
  s_cmp_lt_u32 s23, 54
  s_cselect_b32 s62, s62, 1073741824
  s_cmp_eq_u32 s20, 0
  s_cselect_b32 s31, s82, 1073741824
  s_cselect_b32 s77, s2, 1073741824
  s_cmp_eq_u32 s2, 255
  s_cselect_b32 s23, 2629632, 1073741824
  v_lshl_add_u32 v225, v16, 2, s23
  v_mov_b32 v229, 0
  v_writelane_b32 v225, s80, 0
  v_writelane_b32 v225, s3, 1
  v_writelane_b32 v225, s31, 2
  s_add_u32 s31, s31, 32
  v_writelane_b32 v225, s31, 5
  s_and_b32 s23, s2, 1
  s_lshl_b32 s23, s23, 2
  s_add_u32 s23, s23, s20
  s_lshl_b32 s23, s23, 7
  s_lshr_b32 s31, s2, 1
  s_add_u32 s23, s23, s31
  s_lshl_b32 s23, s23, 2
  s_add_u32 s23, s23, 2654208
  v_writelane_b32 v225, s23, 3
  v_writelane_b32 v225, s62, 4
  s_and_b32 s23, s21, 3
  s_lshr_b32 s31, s23, 1
  s_lshl_b32 s31, 4, s31
  s_bitcmp1_b32 s23, 0
  s_cselect_b32 s76, s31, 0
  s_cselect_b32 s72, 0, s31
  s_or_b32 s76, s76, 0x20
  s_or_b32 s72, s72, 0x25
  v_mov_b32 v20, 0
  v_mov_b32 v21, 0
  v_mov_b32 v22, 0
  v_mov_b32 v23, 0
  v_lshrrev_b32 v17, 4, v1
  v_lshrrev_b32 v18, 3, v16
  v_mul_u32_u24 v18, 3, v18
  v_xor_b32 v18, v18, v17
  v_lshlrev_b32 v18, 4, v18
  v_lshl_add_u32 v14, v16, 6, v18
  s_and_b32 s23, s20, 1
  s_lshl_b32 s23, s23, 11
  v_add_u32 v14, s23, v14
  v_mfma_f32_32x32x16_bf16 a[0:15], v[20:23], v[20:23], 0
  v_lshrrev_b32 v18, 2, v16
  v_lshlrev_b32 v18, 6, v18
  v_lshl_add_u32 v18, v17, 11, v18
  v_and_b32 v19, 1, v1
  v_mfma_f32_32x32x16_bf16 a[16:31], v[20:23], v[20:23], 0
  v_lshl_add_u32 v18, v19, 3, v18
  v_bfe_u32 v19, v1, 1, 1
  v_and_b32 v17, 1, v17
  v_lshl_or_b32 v19, v17, 1, v19
  v_mfma_f32_32x32x16_bf16 a[32:47], v[20:23], v[20:23], 0
  s_lshr_b32 s23, s20, 1
  s_lshl_b32 s23, s23, 13
  s_add_u32 s23, s23, 16384
  v_add_u32 v18, s23, v18
  v_mfma_f32_32x32x16_bf16 a[48:63], v[20:23], v[20:23], 0
  v_lshl_add_u32 v12, v19, 4, v18
  v_xor_b32 v13, 32, v12
  v_mov_b32 v19, 1073741824
  v_lshlrev_b32 v220, 4, v220
  v_mfma_f32_32x32x16_bf16 a[64:79], v[20:23], v[20:23], 0
  v_lshl_add_u32 v220, v208, 7, v220
  v_add_u32 v220, 131072, v220
  v_lshlrev_b32 v222, 2, v209
  v_cmp_eq_u32 vcc, 0, v208
  v_mfma_f32_32x32x16_bf16 a[80:95], v[20:23], v[20:23], 0
  v_add_u32 v222, 2621440, v222
  v_lshlrev_b32 v221, 4, v0
  v_cndmask_b32 v222, v19, v222, vcc
  v_add_u32 v221, 131072, v221
  v_mfma_f32_32x32x16_bf16 a[96:111], v[20:23], v[20:23], 0
  v_sub_u32 v209, 0xffff, v209
  v_lshrrev_b32 v223, 3, v0
  v_and_b32 v18, 7, v0
  v_lshlrev_b32 v18, 4, v18
  v_mfma_f32_32x32x16_bf16 a[112:127], v[20:23], v[20:23], 0
  v_cmp_gt_u32 vcc, 128, v0
  v_lshl_add_u32 v223, v223, 8, v18
  s_lshr_b32 s66, s2, 1
  s_mul_i32 s66, s66, 20480
  v_mfma_f32_32x32x16_bf16 a[128:143], v[20:23], v[20:23], 0
  s_and_b32 s31, s2, 1
  s_lshl_b32 s31, s31, 7
  s_add_u32 s66, s66, s31
  v_cndmask_b32 v224, v19, v223, vcc
  v_mfma_f32_32x32x16_bf16 a[144:159], v[20:23], v[20:23], 0
  s_add_u32 s67, s66, 8192
  s_add_u32 s78, s66, 16384
  s_mov_b32 s28, 0
  v_mfma_f32_32x32x16_bf16 a[160:175], v[20:23], v[20:23], 0
  v_mfma_f32_32x32x16_bf16 a[176:191], v[20:23], v[20:23], 0
  v_mfma_f32_32x32x16_bf16 a[192:207], v[20:23], v[20:23], 0
  v_mfma_f32_32x32x16_bf16 a[208:223], v[20:23], v[20:23], 0
  v_mfma_f32_32x32x16_bf16 a[224:239], v[20:23], v[20:23], 0
  v_mfma_f32_32x32x16_bf16 a[240:255], v[20:23], v[20:23], 0
  s_waitcnt vmcnt(5)
  v_lshlrev_b32 v184, 16, v160
  v_and_b32 v185, 0xffff0000, v160
  v_lshlrev_b32 v186, 16, v161
  v_and_b32 v187, 0xffff0000, v161
  v_lshlrev_b32 v188, 16, v162
  v_and_b32 v189, 0xffff0000, v162
  v_lshlrev_b32 v190, 16, v163
  v_and_b32 v191, 0xffff0000, v163
  v_lshlrev_b32 v192, 16, v164
  v_and_b32 v193, 0xffff0000, v164
  v_lshlrev_b32 v194, 16, v165
  v_and_b32 v195, 0xffff0000, v165
  v_lshlrev_b32 v196, 16, v166
  v_and_b32 v197, 0xffff0000, v166
  v_lshlrev_b32 v198, 16, v167
  v_and_b32 v199, 0xffff0000, v167
  v_lshlrev_b32 v200, 16, v168
  v_and_b32 v201, 0xffff0000, v168
  v_lshlrev_b32 v202, 16, v169
  v_and_b32 v203, 0xffff0000, v169
  v_lshlrev_b32 v204, 16, v170
  v_and_b32 v205, 0xffff0000, v170
  v_lshlrev_b32 v206, 16, v171
  v_and_b32 v207, 0xffff0000, v171
  v_pk_add_f32 v[16:17], v[184:185], v[186:187]
  v_pk_add_f32 v[18:19], v[188:189], v[190:191]
  v_pk_add_f32 v[16:17], v[16:17], v[192:193]
  v_pk_add_f32 v[18:19], v[18:19], v[194:195]
  v_pk_add_f32 v[16:17], v[16:17], v[196:197]
  v_pk_add_f32 v[18:19], v[18:19], v[198:199]
  v_pk_add_f32 v[16:17], v[16:17], v[200:201]
  v_pk_add_f32 v[18:19], v[18:19], v[202:203]
  v_pk_add_f32 v[16:17], v[16:17], v[204:205]
  v_pk_add_f32 v[18:19], v[18:19], v[206:207]
  v_pk_add_f32 v[16:17], v[16:17], v[18:19]
  v_add_f32 v213, v16, v17
  s_nop 1
  v_add_f32_dpp v213, v213, v213 quad_perm:[1,0,3,2] row_mask:0xf bank_mask:0xf
  s_nop 1
  v_add_f32_dpp v213, v213, v213 quad_perm:[2,3,0,1] row_mask:0xf bank_mask:0xf
  s_nop 1
  v_add_f32_dpp v213, v213, v213 row_half_mirror row_mask:0xf bank_mask:0xf
  s_nop 1
  v_add_f32_dpp v213, v213, v213 row_mirror row_mask:0xf bank_mask:0xf
  v_mov_b32 v214, v213
  s_nop 1
  v_permlane16_swap_b32 v213, v214
  v_add_f32 v213, v213, v214
  v_mul_f32 v216, 0xbacccccd, v213
  v_mul_f32 v217, 0xbacccccd, v213
  v_pk_add_f32 v[20:21], v[184:185], v[216:217]
  v_pk_mul_f32 v[16:17], v[20:21], v[20:21]
  v_pk_add_f32 v[22:23], v[186:187], v[216:217]
  v_pk_fma_f32 v[16:17], v[22:23], v[22:23], v[16:17]
  v_pk_add_f32 v[24:25], v[188:189], v[216:217]
  v_pk_fma_f32 v[16:17], v[24:25], v[24:25], v[16:17]
  v_pk_add_f32 v[26:27], v[190:191], v[216:217]
  v_pk_fma_f32 v[16:17], v[26:27], v[26:27], v[16:17]
  v_pk_add_f32 v[20:21], v[192:193], v[216:217]
  v_pk_fma_f32 v[16:17], v[20:21], v[20:21], v[16:17]
  v_pk_add_f32 v[22:23], v[194:195], v[216:217]
  v_pk_fma_f32 v[16:17], v[22:23], v[22:23], v[16:17]
  v_pk_add_f32 v[24:25], v[196:197], v[216:217]
  v_pk_fma_f32 v[16:17], v[24:25], v[24:25], v[16:17]
  v_pk_add_f32 v[26:27], v[198:199], v[216:217]
  v_pk_fma_f32 v[16:17], v[26:27], v[26:27], v[16:17]
  v_pk_add_f32 v[20:21], v[200:201], v[216:217]
  v_pk_mul_f32 v[18:19], v[20:21], v[20:21]
  v_pk_add_f32 v[22:23], v[202:203], v[216:217]
  v_pk_fma_f32 v[18:19], v[22:23], v[22:23], v[18:19]
  v_pk_add_f32 v[24:25], v[204:205], v[216:217]
  v_pk_fma_f32 v[18:19], v[24:25], v[24:25], v[18:19]
  v_pk_add_f32 v[26:27], v[206:207], v[216:217]
  v_pk_fma_f32 v[18:19], v[26:27], v[26:27], v[18:19]
  v_add_f32 v18, v18, v19
  v_add_f32 v213, v16, v17
  v_cndmask_b32 v18, 0, v18, s[64:65]
  v_add_f32 v213, v213, v18
  s_nop 1
  v_add_f32_dpp v213, v213, v213 quad_perm:[1,0,3,2] row_mask:0xf bank_mask:0xf
  s_nop 1
  v_add_f32_dpp v213, v213, v213 quad_perm:[2,3,0,1] row_mask:0xf bank_mask:0xf
  s_nop 1
  v_add_f32_dpp v213, v213, v213 row_half_mirror row_mask:0xf bank_mask:0xf
  s_nop 1
  v_add_f32_dpp v213, v213, v213 row_mirror row_mask:0xf bank_mask:0xf
  v_mov_b32 v214, v213
  s_nop 1
  v_permlane16_swap_b32 v213, v214
  v_add_f32 v213, v213, v214
  v_mul_f32 v213, 0x3acccccd, v213
  v_cvt_pk_bf16_f32 v213, v213, v213
  v_and_b32 v213, 0xffff0000, v213
  v_add_f32 v213, 0x3727c5ac, v213
  v_cvt_pk_bf16_f32 v213, v213, v213
  v_and_b32 v213, 0xffff0000, v213
  v_sqrt_f32 v213, v213
  v_cvt_pk_bf16_f32 v216, v216, v216
  v_and_b32 v216, 0xffff0000, v216
  v_cvt_pk_bf16_f32 v213, v213, v213
  v_and_b32 v213, 0xffff0000, v213
  v_rcp_f32 v28, v213
  v_mov_b32 v217, v216
  v_mov_b32 v29, v28
  v_pk_add_f32 v[184:185], v[184:185], v[216:217]
  v_lshlrev_b32 v16, 16, v172
  v_cvt_pk_bf16_f32 v185, v184, v185
  v_and_b32 v17, 0xffff0000, v172
  v_lshlrev_b32 v184, 16, v185
  v_and_b32 v185, 0xffff0000, v185
  v_pk_mul_f32 v[184:185], v[184:185], v[28:29]
  v_cvt_pk_bf16_f32 v160, v184, v185
  v_lshlrev_b32 v184, 16, v160
  v_and_b32 v185, 0xffff0000, v160
  v_pk_mul_f32 v[218:219], v[184:185], v[16:17]
  v_pk_add_f32 v[186:187], v[186:187], v[216:217]
  v_lshlrev_b32 v18, 16, v173
  v_cvt_pk_bf16_f32 v187, v186, v187
  v_and_b32 v19, 0xffff0000, v173
  v_lshlrev_b32 v186, 16, v187
  v_and_b32 v187, 0xffff0000, v187
  v_pk_mul_f32 v[186:187], v[186:187], v[28:29]
  v_cvt_pk_bf16_f32 v161, v186, v187
  v_lshlrev_b32 v186, 16, v161
  v_and_b32 v187, 0xffff0000, v161
  v_pk_fma_f32 v[218:219], v[186:187], v[18:19], v[218:219]
  v_pk_add_f32 v[188:189], v[188:189], v[216:217]
  v_lshlrev_b32 v16, 16, v174
  v_cvt_pk_bf16_f32 v189, v188, v189
  v_and_b32 v17, 0xffff0000, v174
  v_lshlrev_b32 v188, 16, v189
  v_and_b32 v189, 0xffff0000, v189
  v_pk_mul_f32 v[188:189], v[188:189], v[28:29]
  v_cvt_pk_bf16_f32 v162, v188, v189
  v_lshlrev_b32 v188, 16, v162
  v_and_b32 v189, 0xffff0000, v162
  v_pk_fma_f32 v[218:219], v[188:189], v[16:17], v[218:219]
  v_pk_add_f32 v[190:191], v[190:191], v[216:217]
  v_lshlrev_b32 v18, 16, v175
  v_cvt_pk_bf16_f32 v191, v190, v191
  v_and_b32 v19, 0xffff0000, v175
  v_lshlrev_b32 v190, 16, v191
  v_and_b32 v191, 0xffff0000, v191
  v_pk_mul_f32 v[190:191], v[190:191], v[28:29]
  v_cvt_pk_bf16_f32 v163, v190, v191
  v_lshlrev_b32 v190, 16, v163
  v_and_b32 v191, 0xffff0000, v163
  v_pk_fma_f32 v[218:219], v[190:191], v[18:19], v[218:219]
  ds_write_b128 v220, v[160:163] offset:0
  v_pk_add_f32 v[192:193], v[192:193], v[216:217]
  v_lshlrev_b32 v16, 16, v176
  v_cvt_pk_bf16_f32 v193, v192, v193
  v_and_b32 v17, 0xffff0000, v176
  v_lshlrev_b32 v192, 16, v193
  v_and_b32 v193, 0xffff0000, v193
  v_pk_mul_f32 v[192:193], v[192:193], v[28:29]
  v_cvt_pk_bf16_f32 v164, v192, v193
  v_lshlrev_b32 v192, 16, v164
  v_and_b32 v193, 0xffff0000, v164
  v_pk_fma_f32 v[218:219], v[192:193], v[16:17], v[218:219]
  v_pk_add_f32 v[194:195], v[194:195], v[216:217]
  v_lshlrev_b32 v18, 16, v177
  v_cvt_pk_bf16_f32 v195, v194, v195
  v_and_b32 v19, 0xffff0000, v177
  v_lshlrev_b32 v194, 16, v195
  v_and_b32 v195, 0xffff0000, v195
  v_pk_mul_f32 v[194:195], v[194:195], v[28:29]
  v_cvt_pk_bf16_f32 v165, v194, v195
  v_lshlrev_b32 v194, 16, v165
  v_and_b32 v195, 0xffff0000, v165
  v_pk_fma_f32 v[218:219], v[194:195], v[18:19], v[218:219]
  v_pk_add_f32 v[196:197], v[196:197], v[216:217]
  v_lshlrev_b32 v16, 16, v178
  v_cvt_pk_bf16_f32 v197, v196, v197
  v_and_b32 v17, 0xffff0000, v178
  v_lshlrev_b32 v196, 16, v197
  v_and_b32 v197, 0xffff0000, v197
  v_pk_mul_f32 v[196:197], v[196:197], v[28:29]
  v_cvt_pk_bf16_f32 v166, v196, v197
  v_lshlrev_b32 v196, 16, v166
  v_and_b32 v197, 0xffff0000, v166
  v_pk_fma_f32 v[218:219], v[196:197], v[16:17], v[218:219]
  v_pk_add_f32 v[198:199], v[198:199], v[216:217]
  v_lshlrev_b32 v18, 16, v179
  v_cvt_pk_bf16_f32 v199, v198, v199
  v_and_b32 v19, 0xffff0000, v179
  v_lshlrev_b32 v198, 16, v199
  v_and_b32 v199, 0xffff0000, v199
  v_pk_mul_f32 v[198:199], v[198:199], v[28:29]
  v_cvt_pk_bf16_f32 v167, v198, v199
  v_lshlrev_b32 v198, 16, v167
  v_and_b32 v199, 0xffff0000, v167
  v_pk_fma_f32 v[218:219], v[198:199], v[18:19], v[218:219]
  ds_write_b128 v220, v[164:167] offset:4096
  v_pk_add_f32 v[200:201], v[200:201], v[216:217]
  v_lshlrev_b32 v16, 16, v180
  v_cvt_pk_bf16_f32 v201, v200, v201
  v_and_b32 v17, 0xffff0000, v180
  v_lshlrev_b32 v200, 16, v201
  v_and_b32 v201, 0xffff0000, v201
  v_pk_mul_f32 v[200:201], v[200:201], v[28:29]
  v_cvt_pk_bf16_f32 v168, v200, v201
  v_lshlrev_b32 v200, 16, v168
  v_and_b32 v201, 0xffff0000, v168
  v_pk_fma_f32 v[218:219], v[200:201], v[16:17], v[218:219]
  v_pk_add_f32 v[202:203], v[202:203], v[216:217]
  v_lshlrev_b32 v18, 16, v181
  v_cvt_pk_bf16_f32 v203, v202, v203
  v_and_b32 v19, 0xffff0000, v181
  v_lshlrev_b32 v202, 16, v203
  v_and_b32 v203, 0xffff0000, v203
  v_pk_mul_f32 v[202:203], v[202:203], v[28:29]
  v_cvt_pk_bf16_f32 v169, v202, v203
  v_lshlrev_b32 v202, 16, v169
  v_and_b32 v203, 0xffff0000, v169
  v_pk_fma_f32 v[218:219], v[202:203], v[18:19], v[218:219]
  v_pk_add_f32 v[204:205], v[204:205], v[216:217]
  v_lshlrev_b32 v16, 16, v182
  v_cvt_pk_bf16_f32 v205, v204, v205
  v_and_b32 v17, 0xffff0000, v182
  v_lshlrev_b32 v204, 16, v205
  v_and_b32 v205, 0xffff0000, v205
  v_pk_mul_f32 v[204:205], v[204:205], v[28:29]
  v_cvt_pk_bf16_f32 v170, v204, v205
  v_lshlrev_b32 v204, 16, v170
  v_and_b32 v205, 0xffff0000, v170
  v_pk_fma_f32 v[218:219], v[204:205], v[16:17], v[218:219]
  v_pk_add_f32 v[206:207], v[206:207], v[216:217]
  v_lshlrev_b32 v18, 16, v183
  v_cvt_pk_bf16_f32 v207, v206, v207
  v_and_b32 v19, 0xffff0000, v183
  v_lshlrev_b32 v206, 16, v207
  v_and_b32 v207, 0xffff0000, v207
  v_pk_mul_f32 v[206:207], v[206:207], v[28:29]
  v_cvt_pk_bf16_f32 v171, v206, v207
  v_lshlrev_b32 v206, 16, v171
  v_and_b32 v207, 0xffff0000, v171
  v_pk_fma_f32 v[218:219], v[206:207], v[18:19], v[218:219]
  ds_write_b128 v220, v[168:171] offset:8192
  v_add_f32 v218, v218, v219
  s_nop 1
  v_add_f32_dpp v218, v218, v218 quad_perm:[1,0,3,2] row_mask:0xf bank_mask:0xf
  s_nop 1
  v_add_f32_dpp v218, v218, v218 quad_perm:[2,3,0,1] row_mask:0xf bank_mask:0xf
  s_nop 1
  v_add_f32_dpp v218, v218, v218 row_half_mirror row_mask:0xf bank_mask:0xf
  s_nop 1
  v_add_f32_dpp v218, v218, v218 row_mirror row_mask:0xf bank_mask:0xf
  v_mov_b32 v214, v218
  s_nop 1
  v_permlane16_swap_b32 v218, v214
  v_add_f32 v218, v218, v214
  v_cvt_pk_bf16_f32 v218, v218, v218
  v_and_b32 v218, 0xffff0000, v218
  v_ashrrev_i32 v214, 31, v218
  v_or_b32 v214, 0x80000000, v214
  v_xor_b32 v218, v218, v214
  v_and_b32 v218, 0xffff0000, v218
  v_or_b32 v218, v218, v209
  v_mov_b32 v19, 1073741824
  s_mov_b32 m0, s24
  s_nop 0
  buffer_load_dwordx4 v3, s[32:35], s26 offen offset:0 sc1 lds
  buffer_load_dwordx4 v4, s[32:35], s26 offen offset:1024 sc1 lds
  buffer_load_dwordx4 v5, s[32:35], s26 offen offset:2048 sc1 lds
  buffer_load_dwordx4 v6, s[32:35], s26 offen offset:3072 sc1 lds
  s_add_u32 m0, s24, 16384
  s_nop 0
  buffer_load_dwordx4 v8, s[36:39], s27 offen offset:0 lds
  buffer_load_dwordx4 v9, s[36:39], s27 offen offset:1024 lds
  buffer_load_dwordx4 v10, s[36:39], s27 offen offset:2048 lds
  buffer_load_dwordx4 v11, s[36:39], s27 offen offset:3072 lds
  s_add_u32 s26, s26, s79
  s_add_u32 s27, s27, s25
  s_add_u32 s24, s24, 32768
  s_and_b32 s24, s24, 0x1ffff
  s_mov_b32 m0, s24
  s_nop 0
  buffer_load_dwordx4 v3, s[32:35], s26 offen offset:0 sc1 lds
  buffer_load_dwordx4 v4, s[32:35], s26 offen offset:1024 sc1 lds
  buffer_load_dwordx4 v5, s[32:35], s26 offen offset:2048 sc1 lds
  buffer_load_dwordx4 v6, s[32:35], s26 offen offset:3072 sc1 lds
  s_add_u32 m0, s24, 16384
  s_nop 0
  buffer_load_dwordx4 v8, s[36:39], s27 offen offset:0 lds
  buffer_load_dwordx4 v9, s[36:39], s27 offen offset:1024 lds
  buffer_load_dwordx4 v10, s[36:39], s27 offen offset:2048 lds
  buffer_load_dwordx4 v11, s[36:39], s27 offen offset:3072 lds
  s_add_u32 s26, s26, s79
  s_add_u32 s27, s27, s25
  s_add_u32 s24, s24, 32768
  s_and_b32 s24, s24, 0x1ffff
  s_waitcnt vmcnt(8) lgkmcnt(0)
  s_barrier
  s_cmp_ge_u32 s20, 2
  s_cbranch_scc1 fa_roleV
  ds_read_b128 v[96:99], v14 offset:0
  ds_read_b128 v[100:103], v14 offset:1024
  ds_read_b128 v[104:107], v14 offset:4096
  ds_read_b128 v[108:111], v14 offset:5120
  ds_read_b128 v[112:115], v14 offset:8192
  ds_read_b128 v[116:119], v14 offset:9216
  ds_read_b128 v[120:123], v14 offset:12288
  ds_read_b128 v[124:127], v14 offset:13312
  ds_read_b64_tr_b16 v[32:33], v12 offset:0
  ds_read_b64_tr_b16 v[34:35], v12 offset:1024
  ds_read_b64_tr_b16 v[36:37], v13 offset:0
  ds_read_b64_tr_b16 v[38:39], v13 offset:1024
  ds_read_b64_tr_b16 v[40:41], v12 offset:256
  ds_read_b64_tr_b16 v[42:43], v12 offset:1280
  ds_read_b64_tr_b16 v[44:45], v13 offset:256
  ds_read_b64_tr_b16 v[46:47], v13 offset:1280
  ds_read_b64_tr_b16 v[48:49], v12 offset:512
  ds_read_b64_tr_b16 v[50:51], v12 offset:1536
  ds_read_b64_tr_b16 v[52:53], v13 offset:512
  ds_read_b64_tr_b16 v[54:55], v13 offset:1536
  ds_read_b64_tr_b16 v[56:57], v12 offset:768
  ds_read_b64_tr_b16 v[58:59], v12 offset:1792
  ds_read_b64_tr_b16 v[60:61], v13 offset:768
  ds_read_b64_tr_b16 v[62:63], v13 offset:1792
  s_mov_b32 m0, s24
  s_nop 0
  buffer_load_dwordx4 v3, s[32:35], s26 offen offset:0 sc1 lds
  buffer_load_dwordx4 v4, s[32:35], s26 offen offset:1024 sc1 lds
  buffer_load_dwordx4 v5, s[32:35], s26 offen offset:2048 sc1 lds
  buffer_load_dwordx4 v6, s[32:35], s26 offen offset:3072 sc1 lds
  s_add_u32 m0, s24, 16384
  s_nop 0
  buffer_load_dwordx4 v8, s[36:39], s27 offen offset:0 lds
  buffer_load_dwordx4 v9, s[36:39], s27 offen offset:1024 lds
  buffer_load_dwordx4 v10, s[36:39], s27 offen offset:2048 lds
  buffer_load_dwordx4 v11, s[36:39], s27 offen offset:3072 lds
  s_add_u32 s26, s26, s79
  s_add_u32 s27, s27, s25
  s_add_u32 s24, s24, 32768
  s_and_b32 s24, s24, 0x1ffff
  buffer_load_dword v231, v19, s[32:35], 0 offen
  s_mov_b32 m0, s24
  s_nop 0
  buffer_load_dwordx4 v3, s[32:35], s26 offen offset:0 sc1 lds
  buffer_load_dwordx4 v4, s[32:35], s26 offen offset:1024 sc1 lds
  buffer_load_dwordx4 v5, s[32:35], s26 offen offset:2048 sc1 lds
  buffer_load_dwordx4 v6, s[32:35], s26 offen offset:3072 sc1 lds
  s_add_u32 m0, s24, 16384
  s_nop 0
  buffer_load_dwordx4 v8, s[36:39], s27 offen offset:0 lds
  buffer_load_dwordx4 v9, s[36:39], s27 offen offset:1024 lds
  buffer_load_dwordx4 v10, s[36:39], s27 offen offset:2048 lds
  buffer_load_dwordx4 v11, s[36:39], s27 offen offset:3072 lds
  s_add_u32 s26, s26, s79
  s_add_u32 s27, s27, s25
  s_add_u32 s24, s24, 32768
  s_and_b32 s24, s24, 0x1ffff
  s_waitcnt lgkmcnt(0)
.p2align 6
fa_loopK:
  v_mfma_f32_16x16x32_bf16 a[192:195], v[32:35], v[96:99], a[192:195]
  s_waitcnt vmcnt(17)
  v_mfma_f32_16x16x32_bf16 a[200:203], v[32:35], v[100:103], a[200:203]
  s_barrier
  v_mfma_f32_16x16x32_bf16 a[0:3], v[32:35], v[104:107], a[0:3]
  ds_read_b64_tr_b16 v[64:65], v12 offset:32768
  v_mfma_f32_16x16x32_bf16 a[8:11], v[32:35], v[108:111], a[8:11]
  v_mfma_f32_16x16x32_bf16 a[64:67], v[32:35], v[112:115], a[64:67]
  s_mov_b32 m0, s24
  ds_read_b64_tr_b16 v[66:67], v12 offset:33792
  v_mfma_f32_16x16x32_bf16 a[72:75], v[32:35], v[116:119], a[72:75]
  buffer_load_dwordx4 v3, s[32:35], s26 offen offset:0 sc1 lds
  v_mfma_f32_16x16x32_bf16 a[128:131], v[32:35], v[120:123], a[128:131]
  ds_read_b128 v[128:131], v14 offset:32768
  v_mfma_f32_16x16x32_bf16 a[136:139], v[32:35], v[124:127], a[136:139]
  buffer_load_dwordx4 v4, s[32:35], s26 offen offset:1024 sc1 lds
  v_mfma_f32_16x16x32_bf16 a[196:199], v[36:39], v[96:99], a[196:199]
  ds_read_b64_tr_b16 v[68:69], v13 offset:32768
  v_mfma_f32_16x16x32_bf16 a[204:207], v[36:39], v[100:103], a[204:207]
  buffer_load_dwordx4 v5, s[32:35], s26 offen offset:2048 sc1 lds
  v_mfma_f32_16x16x32_bf16 a[4:7], v[36:39], v[104:107], a[4:7]
  ds_read_b64_tr_b16 v[70:71], v13 offset:33792
  v_mfma_f32_16x16x32_bf16 a[12:15], v[36:39], v[108:111], a[12:15]
  buffer_load_dwordx4 v6, s[32:35], s26 offen offset:3072 sc1 lds
  v_mfma_f32_16x16x32_bf16 a[68:71], v[36:39], v[112:115], a[68:71]
  s_add_u32 m0, s24, 16384
  ds_read_b128 v[132:135], v14 offset:33792
  v_mfma_f32_16x16x32_bf16 a[76:79], v[36:39], v[116:119], a[76:79]
  buffer_load_dwordx4 v8, s[36:39], s27 offen offset:0 lds
  v_mfma_f32_16x16x32_bf16 a[132:135], v[36:39], v[120:123], a[132:135]
  ds_read_b64_tr_b16 v[72:73], v12 offset:33024
  v_mfma_f32_16x16x32_bf16 a[140:143], v[36:39], v[124:127], a[140:143]
  buffer_load_dwordx4 v9, s[36:39], s27 offen offset:1024 lds
  v_mfma_f32_16x16x32_bf16 a[208:211], v[40:43], v[96:99], a[208:211]
  ds_read_b64_tr_b16 v[74:75], v12 offset:34048
  v_mfma_f32_16x16x32_bf16 a[216:219], v[40:43], v[100:103], a[216:219]
  buffer_load_dwordx4 v10, s[36:39], s27 offen offset:2048 lds
  v_mfma_f32_16x16x32_bf16 a[16:19], v[40:43], v[104:107], a[16:19]
  ds_read_b128 v[136:139], v14 offset:36864
  v_mfma_f32_16x16x32_bf16 a[24:27], v[40:43], v[108:111], a[24:27]
  buffer_load_dwordx4 v11, s[36:39], s27 offen offset:3072 lds
  v_mfma_f32_16x16x32_bf16 a[80:83], v[40:43], v[112:115], a[80:83]
  ds_read_b64_tr_b16 v[76:77], v13 offset:33024
  v_mfma_f32_16x16x32_bf16 a[88:91], v[40:43], v[116:119], a[88:91]
  buffer_load_dword v231, v235, s[48:51], s74 offen sc1
  v_mfma_f32_16x16x32_bf16 a[144:147], v[40:43], v[120:123], a[144:147]
  s_add_u32 s74, s74, s73
  ds_read_b64_tr_b16 v[78:79], v13 offset:34048
  v_mfma_f32_16x16x32_bf16 a[152:155], v[40:43], v[124:127], a[152:155]
  s_bitcmp1_b32 s72, s28
  v_mfma_f32_16x16x32_bf16 a[212:215], v[44:47], v[96:99], a[212:215]
  s_cbranch_scc1 fa_hk0
fa_hb0:
  ds_read_b128 v[140:143], v14 offset:37888
  v_mfma_f32_16x16x32_bf16 a[220:223], v[44:47], v[100:103], a[220:223]
  v_mfma_f32_16x16x32_bf16 a[20:23], v[44:47], v[104:107], a[20:23]
  ds_read_b64_tr_b16 v[80:81], v12 offset:33280
  v_mfma_f32_16x16x32_bf16 a[28:31], v[44:47], v[108:111], a[28:31]
  v_mfma_f32_16x16x32_bf16 a[84:87], v[44:47], v[112:115], a[84:87]
  ds_read_b64_tr_b16 v[82:83], v12 offset:34304
  v_mfma_f32_16x16x32_bf16 a[92:95], v[44:47], v[116:119], a[92:95]
  v_mfma_f32_16x16x32_bf16 a[148:151], v[44:47], v[120:123], a[148:151]
  ds_read_b128 v[144:147], v14 offset:40960
  v_mfma_f32_16x16x32_bf16 a[156:159], v[44:47], v[124:127], a[156:159]
  v_mfma_f32_16x16x32_bf16 a[224:227], v[48:51], v[96:99], a[224:227]
  ds_read_b64_tr_b16 v[84:85], v13 offset:33280
  v_mfma_f32_16x16x32_bf16 a[232:235], v[48:51], v[100:103], a[232:235]
  v_mfma_f32_16x16x32_bf16 a[32:35], v[48:51], v[104:107], a[32:35]
  ds_read_b64_tr_b16 v[86:87], v13 offset:34304
  v_mfma_f32_16x16x32_bf16 a[40:43], v[48:51], v[108:111], a[40:43]
  v_mfma_f32_16x16x32_bf16 a[96:99], v[48:51], v[112:115], a[96:99]
  ds_read_b128 v[148:151], v14 offset:41984
  v_mfma_f32_16x16x32_bf16 a[104:107], v[48:51], v[116:119], a[104:107]
  v_mfma_f32_16x16x32_bf16 a[160:163], v[48:51], v[120:123], a[160:163]
  ds_read_b64_tr_b16 v[88:89], v12 offset:33536
  v_mfma_f32_16x16x32_bf16 a[168:171], v[48:51], v[124:127], a[168:171]
  v_mfma_f32_16x16x32_bf16 a[228:231], v[52:55], v[96:99], a[228:231]
  ds_read_b64_tr_b16 v[90:91], v12 offset:34560
  v_mfma_f32_16x16x32_bf16 a[236:239], v[52:55], v[100:103], a[236:239]
  v_mfma_f32_16x16x32_bf16 a[36:39], v[52:55], v[104:107], a[36:39]
  ds_read_b128 v[152:155], v14 offset:45056
  v_mfma_f32_16x16x32_bf16 a[44:47], v[52:55], v[108:111], a[44:47]
  v_mfma_f32_16x16x32_bf16 a[100:103], v[52:55], v[112:115], a[100:103]
  ds_read_b64_tr_b16 v[92:93], v13 offset:33536
  v_mfma_f32_16x16x32_bf16 a[108:111], v[52:55], v[116:119], a[108:111]
  v_mfma_f32_16x16x32_bf16 a[164:167], v[52:55], v[120:123], a[164:167]
  ds_read_b64_tr_b16 v[94:95], v13 offset:34560
  v_mfma_f32_16x16x32_bf16 a[172:175], v[52:55], v[124:127], a[172:175]
  v_mfma_f32_16x16x32_bf16 a[240:243], v[56:59], v[96:99], a[240:243]
  s_add_u32 s26, s26, s79
  ds_read_b128 v[156:159], v14 offset:46080
  v_mfma_f32_16x16x32_bf16 a[248:251], v[56:59], v[100:103], a[248:251]
  s_add_u32 s27, s27, s25
  v_mfma_f32_16x16x32_bf16 a[48:51], v[56:59], v[104:107], a[48:51]
  s_add_u32 s24, s24, 32768
  v_mfma_f32_16x16x32_bf16 a[56:59], v[56:59], v[108:111], a[56:59]
  s_and_b32 s24, s24, 0x1ffff
  v_mfma_f32_16x16x32_bf16 a[112:115], v[56:59], v[112:115], a[112:115]
  v_xor_b32 v14, 0x10000, v14
  v_mfma_f32_16x16x32_bf16 a[120:123], v[56:59], v[116:119], a[120:123]
  v_xor_b32 v12, 0x10000, v12
  v_mfma_f32_16x16x32_bf16 a[176:179], v[56:59], v[120:123], a[176:179]
  v_xor_b32 v13, 0x10000, v13
  v_mfma_f32_16x16x32_bf16 a[184:187], v[56:59], v[124:127], a[184:187]
  v_mfma_f32_16x16x32_bf16 a[244:247], v[60:63], v[96:99], a[244:247]
  v_mfma_f32_16x16x32_bf16 a[252:255], v[60:63], v[100:103], a[252:255]
  v_mfma_f32_16x16x32_bf16 a[52:55], v[60:63], v[104:107], a[52:55]
  v_mfma_f32_16x16x32_bf16 a[60:63], v[60:63], v[108:111], a[60:63]
  v_mfma_f32_16x16x32_bf16 a[116:119], v[60:63], v[112:115], a[116:119]
  v_mfma_f32_16x16x32_bf16 a[124:127], v[60:63], v[116:119], a[124:127]
  v_mfma_f32_16x16x32_bf16 a[180:183], v[60:63], v[120:123], a[180:183]
  v_mfma_f32_16x16x32_bf16 a[188:191], v[60:63], v[124:127], a[188:191]
  s_waitcnt lgkmcnt(0)
  v_mfma_f32_16x16x32_bf16 a[192:195], v[64:67], v[128:131], a[192:195]
  s_waitcnt vmcnt(18)
  v_mfma_f32_16x16x32_bf16 a[200:203], v[64:67], v[132:135], a[200:203]
  s_barrier
  v_mfma_f32_16x16x32_bf16 a[0:3], v[64:67], v[136:139], a[0:3]
  ds_read_b64_tr_b16 v[32:33], v12 offset:0
  v_mfma_f32_16x16x32_bf16 a[8:11], v[64:67], v[140:143], a[8:11]
  v_mfma_f32_16x16x32_bf16 a[64:67], v[64:67], v[144:147], a[64:67]
  s_mov_b32 m0, s24
  ds_read_b64_tr_b16 v[34:35], v12 offset:1024
  v_mfma_f32_16x16x32_bf16 a[72:75], v[64:67], v[148:151], a[72:75]
  buffer_load_dwordx4 v3, s[32:35], s26 offen offset:0 sc1 lds
  v_mfma_f32_16x16x32_bf16 a[128:131], v[64:67], v[152:155], a[128:131]
  ds_read_b128 v[96:99], v14 offset:0
  v_mfma_f32_16x16x32_bf16 a[136:139], v[64:67], v[156:159], a[136:139]
  v_mfma_f32_16x16x32_bf16 a[196:199], v[68:71], v[128:131], a[196:199]
  ds_read_b64_tr_b16 v[36:37], v13 offset:0
  v_mfma_f32_16x16x32_bf16 a[204:207], v[68:71], v[132:135], a[204:207]
  v_mfma_f32_16x16x32_bf16 a[4:7], v[68:71], v[136:139], a[4:7]
  ds_read_b64_tr_b16 v[38:39], v13 offset:1024
  v_mfma_f32_16x16x32_bf16 a[12:15], v[68:71], v[140:143], a[12:15]
  buffer_load_dwordx4 v4, s[32:35], s26 offen offset:1024 sc1 lds
  v_mfma_f32_16x16x32_bf16 a[68:71], v[68:71], v[144:147], a[68:71]
  ds_read_b128 v[100:103], v14 offset:1024
  v_mfma_f32_16x16x32_bf16 a[76:79], v[68:71], v[148:151], a[76:79]
  v_mfma_f32_16x16x32_bf16 a[132:135], v[68:71], v[152:155], a[132:135]
  ds_read_b64_tr_b16 v[40:41], v12 offset:256
  v_mfma_f32_16x16x32_bf16 a[140:143], v[68:71], v[156:159], a[140:143]
  v_mfma_f32_16x16x32_bf16 a[208:211], v[72:75], v[128:131], a[208:211]
  ds_read_b64_tr_b16 v[42:43], v12 offset:1280
  v_mfma_f32_16x16x32_bf16 a[216:219], v[72:75], v[132:135], a[216:219]
  buffer_load_dwordx4 v5, s[32:35], s26 offen offset:2048 sc1 lds
  v_mfma_f32_16x16x32_bf16 a[16:19], v[72:75], v[136:139], a[16:19]
  ds_read_b128 v[104:107], v14 offset:4096
  v_mfma_f32_16x16x32_bf16 a[24:27], v[72:75], v[140:143], a[24:27]
  v_mfma_f32_16x16x32_bf16 a[80:83], v[72:75], v[144:147], a[80:83]
  ds_read_b64_tr_b16 v[44:45], v13 offset:256
  v_mfma_f32_16x16x32_bf16 a[88:91], v[72:75], v[148:151], a[88:91]
  v_mfma_f32_16x16x32_bf16 a[144:147], v[72:75], v[152:155], a[144:147]
  ds_read_b64_tr_b16 v[46:47], v13 offset:1280
  v_mfma_f32_16x16x32_bf16 a[152:155], v[72:75], v[156:159], a[152:155]
  buffer_load_dwordx4 v6, s[32:35], s26 offen offset:3072 sc1 lds
  v_mfma_f32_16x16x32_bf16 a[212:215], v[76:79], v[128:131], a[212:215]
  ds_read_b128 v[108:111], v14 offset:5120
  v_mfma_f32_16x16x32_bf16 a[220:223], v[76:79], v[132:135], a[220:223]
  v_mfma_f32_16x16x32_bf16 a[20:23], v[76:79], v[136:139], a[20:23]
  ds_read_b64_tr_b16 v[48:49], v12 offset:512
  v_mfma_f32_16x16x32_bf16 a[28:31], v[76:79], v[140:143], a[28:31]
  v_mfma_f32_16x16x32_bf16 a[84:87], v[76:79], v[144:147], a[84:87]
  s_add_u32 m0, s24, 16384
  ds_read_b64_tr_b16 v[50:51], v12 offset:1536
  v_mfma_f32_16x16x32_bf16 a[92:95], v[76:79], v[148:151], a[92:95]
  buffer_load_dwordx4 v8, s[36:39], s27 offen offset:0 lds
  v_mfma_f32_16x16x32_bf16 a[148:151], v[76:79], v[152:155], a[148:151]
  ds_read_b128 v[112:115], v14 offset:8192
  v_mfma_f32_16x16x32_bf16 a[156:159], v[76:79], v[156:159], a[156:159]
  v_mfma_f32_16x16x32_bf16 a[224:227], v[80:83], v[128:131], a[224:227]
  ds_read_b64_tr_b16 v[52:53], v13 offset:512
  v_mfma_f32_16x16x32_bf16 a[232:235], v[80:83], v[132:135], a[232:235]
  v_mfma_f32_16x16x32_bf16 a[32:35], v[80:83], v[136:139], a[32:35]
  ds_read_b64_tr_b16 v[54:55], v13 offset:1536
  v_mfma_f32_16x16x32_bf16 a[40:43], v[80:83], v[140:143], a[40:43]
  buffer_load_dwordx4 v9, s[36:39], s27 offen offset:1024 lds
  v_mfma_f32_16x16x32_bf16 a[96:99], v[80:83], v[144:147], a[96:99]
  ds_read_b128 v[116:119], v14 offset:9216
  v_mfma_f32_16x16x32_bf16 a[104:107], v[80:83], v[148:151], a[104:107]
  v_mfma_f32_16x16x32_bf16 a[160:163], v[80:83], v[152:155], a[160:163]
  ds_read_b64_tr_b16 v[56:57], v12 offset:768
  v_mfma_f32_16x16x32_bf16 a[168:171], v[80:83], v[156:159], a[168:171]
  v_mfma_f32_16x16x32_bf16 a[228:231], v[84:87], v[128:131], a[228:231]
  ds_read_b64_tr_b16 v[58:59], v12 offset:1792
  v_mfma_f32_16x16x32_bf16 a[236:239], v[84:87], v[132:135], a[236:239]
  buffer_load_dwordx4 v10, s[36:39], s27 offen offset:2048 lds
  v_mfma_f32_16x16x32_bf16 a[36:39], v[84:87], v[136:139], a[36:39]
  ds_read_b128 v[120:123], v14 offset:12288
  v_mfma_f32_16x16x32_bf16 a[44:47], v[84:87], v[140:143], a[44:47]
  v_mfma_f32_16x16x32_bf16 a[100:103], v[84:87], v[144:147], a[100:103]
  ds_read_b64_tr_b16 v[60:61], v13 offset:768
  v_mfma_f32_16x16x32_bf16 a[108:111], v[84:87], v[148:151], a[108:111]
  v_mfma_f32_16x16x32_bf16 a[164:167], v[84:87], v[152:155], a[164:167]
  ds_read_b64_tr_b16 v[62:63], v13 offset:1792
  v_mfma_f32_16x16x32_bf16 a[172:175], v[84:87], v[156:159], a[172:175]
  buffer_load_dwordx4 v11, s[36:39], s27 offen offset:3072 lds
  v_mfma_f32_16x16x32_bf16 a[240:243], v[88:91], v[128:131], a[240:243]
  s_add_u32 s26, s26, s79
  ds_read_b128 v[124:127], v14 offset:13312
  v_mfma_f32_16x16x32_bf16 a[248:251], v[88:91], v[132:135], a[248:251]
  s_add_u32 s27, s27, s25
  v_mfma_f32_16x16x32_bf16 a[48:51], v[88:91], v[136:139], a[48:51]
  s_add_u32 s24, s24, 32768
  v_mfma_f32_16x16x32_bf16 a[56:59], v[88:91], v[140:143], a[56:59]
  s_and_b32 s24, s24, 0x1ffff
  v_mfma_f32_16x16x32_bf16 a[112:115], v[88:91], v[144:147], a[112:115]
  v_mfma_f32_16x16x32_bf16 a[120:123], v[88:91], v[148:151], a[120:123]
  s_bitcmp1_b32 s76, s28
  v_mfma_f32_16x16x32_bf16 a[176:179], v[88:91], v[152:155], a[176:179]
  s_cbranch_scc1 fa_hk1
fa_hb1:
  v_mfma_f32_16x16x32_bf16 a[184:187], v[88:91], v[156:159], a[184:187]
  v_mfma_f32_16x16x32_bf16 a[244:247], v[92:95], v[128:131], a[244:247]
  v_mfma_f32_16x16x32_bf16 a[252:255], v[92:95], v[132:135], a[252:255]
  s_add_u32 s28, s28, 1
  v_mfma_f32_16x16x32_bf16 a[52:55], v[92:95], v[136:139], a[52:55]
  v_mfma_f32_16x16x32_bf16 a[60:63], v[92:95], v[140:143], a[60:63]
  v_mfma_f32_16x16x32_bf16 a[116:119], v[92:95], v[144:147], a[116:119]
  v_mfma_f32_16x16x32_bf16 a[124:127], v[92:95], v[148:151], a[124:127]
  s_cmp_lt_u32 s28, 8
  v_mfma_f32_16x16x32_bf16 a[180:183], v[92:95], v[152:155], a[180:183]
  s_waitcnt lgkmcnt(0)
  v_mfma_f32_16x16x32_bf16 a[188:191], v[92:95], v[156:159], a[188:191]
  s_cbranch_scc1 fa_loopK
  s_mov_b32 s64, 16777216
  s_mov_b32 s76, 0x3e0293ee
  s_branch fa_p1epi
fa_roleV:
  ds_read_b128 v[32:35], v14 offset:0
  ds_read_b128 v[36:39], v14 offset:1024
  ds_read_b128 v[40:43], v14 offset:4096
  ds_read_b128 v[44:47], v14 offset:5120
  ds_read_b128 v[48:51], v14 offset:8192
  ds_read_b128 v[52:55], v14 offset:9216
  ds_read_b128 v[56:59], v14 offset:12288
  ds_read_b128 v[60:63], v14 offset:13312
  ds_read_b64_tr_b16 v[96:97], v12 offset:0
  ds_read_b64_tr_b16 v[98:99], v12 offset:1024
  ds_read_b64_tr_b16 v[100:101], v13 offset:0
  ds_read_b64_tr_b16 v[102:103], v13 offset:1024
  ds_read_b64_tr_b16 v[104:105], v12 offset:256
  ds_read_b64_tr_b16 v[106:107], v12 offset:1280
  ds_read_b64_tr_b16 v[108:109], v13 offset:256
  ds_read_b64_tr_b16 v[110:111], v13 offset:1280
  ds_read_b64_tr_b16 v[112:113], v12 offset:512
  ds_read_b64_tr_b16 v[114:115], v12 offset:1536
  ds_read_b64_tr_b16 v[116:117], v13 offset:512
  ds_read_b64_tr_b16 v[118:119], v13 offset:1536
  ds_read_b64_tr_b16 v[120:121], v12 offset:768
  ds_read_b64_tr_b16 v[122:123], v12 offset:1792
  ds_read_b64_tr_b16 v[124:125], v13 offset:768
  ds_read_b64_tr_b16 v[126:127], v13 offset:1792
  s_mov_b32 m0, s24
  s_nop 0
  buffer_load_dwordx4 v3, s[32:35], s26 offen offset:0 sc1 lds
  buffer_load_dwordx4 v4, s[32:35], s26 offen offset:1024 sc1 lds
  buffer_load_dwordx4 v5, s[32:35], s26 offen offset:2048 sc1 lds
  buffer_load_dwordx4 v6, s[32:35], s26 offen offset:3072 sc1 lds
  s_add_u32 m0, s24, 16384
  s_nop 0
  buffer_load_dwordx4 v8, s[36:39], s27 offen offset:0 lds
  buffer_load_dwordx4 v9, s[36:39], s27 offen offset:1024 lds
  buffer_load_dwordx4 v10, s[36:39], s27 offen offset:2048 lds
  buffer_load_dwordx4 v11, s[36:39], s27 offen offset:3072 lds
  s_add_u32 s26, s26, s79
  s_add_u32 s27, s27, s25
  s_add_u32 s24, s24, 32768
  s_and_b32 s24, s24, 0x1ffff
  buffer_load_dword v231, v19, s[32:35], 0 offen
  s_mov_b32 m0, s24
  s_nop 0
  buffer_load_dwordx4 v3, s[32:35], s26 offen offset:0 sc1 lds
  buffer_load_dwordx4 v4, s[32:35], s26 offen offset:1024 sc1 lds
  buffer_load_dwordx4 v5, s[32:35], s26 offen offset:2048 sc1 lds
  buffer_load_dwordx4 v6, s[32:35], s26 offen offset:3072 sc1 lds
  s_add_u32 m0, s24, 16384
  s_nop 0
  buffer_load_dwordx4 v8, s[36:39], s27 offen offset:0 lds
  buffer_load_dwordx4 v9, s[36:39], s27 offen offset:1024 lds
  buffer_load_dwordx4 v10, s[36:39], s27 offen offset:2048 lds
  buffer_load_dwordx4 v11, s[36:39], s27 offen offset:3072 lds
  s_add_u32 s26, s26, s79
  s_add_u32 s27, s27, s25
  s_add_u32 s24, s24, 32768
  s_and_b32 s24, s24, 0x1ffff
  s_waitcnt lgkmcnt(0)
.p2align 6
fa_loopV:
  v_mfma_f32_16x16x32_bf16 a[192:195], v[32:35], v[96:99], a[192:195]
  s_waitcnt vmcnt(17)
  v_mfma_f32_16x16x32_bf16 a[200:203], v[32:35], v[100:103], a[200:203]
  s_barrier
  v_mfma_f32_16x16x32_bf16 a[208:211], v[32:35], v[104:107], a[208:211]
  ds_read_b64_tr_b16 v[128:129], v12 offset:32768
  v_mfma_f32_16x16x32_bf16 a[216:219], v[32:35], v[108:111], a[216:219]
  v_mfma_f32_16x16x32_bf16 a[224:227], v[32:35], v[112:115], a[224:227]
  s_mov_b32 m0, s24
  ds_read_b64_tr_b16 v[130:131], v12 offset:33792
  v_mfma_f32_16x16x32_bf16 a[232:235], v[32:35], v[116:119], a[232:235]
  buffer_load_dwordx4 v3, s[32:35], s26 offen offset:0 sc1 lds
  v_mfma_f32_16x16x32_bf16 a[240:243], v[32:35], v[120:123], a[240:243]
  ds_read_b128 v[64:67], v14 offset:32768
  v_mfma_f32_16x16x32_bf16 a[248:251], v[32:35], v[124:127], a[248:251]
  buffer_load_dwordx4 v4, s[32:35], s26 offen offset:1024 sc1 lds
  v_mfma_f32_16x16x32_bf16 a[196:199], v[36:39], v[96:99], a[196:199]
  ds_read_b64_tr_b16 v[132:133], v13 offset:32768
  v_mfma_f32_16x16x32_bf16 a[204:207], v[36:39], v[100:103], a[204:207]
  buffer_load_dwordx4 v5, s[32:35], s26 offen offset:2048 sc1 lds
  v_mfma_f32_16x16x32_bf16 a[212:215], v[36:39], v[104:107], a[212:215]
  ds_read_b64_tr_b16 v[134:135], v13 offset:33792
  v_mfma_f32_16x16x32_bf16 a[220:223], v[36:39], v[108:111], a[220:223]
  buffer_load_dwordx4 v6, s[32:35], s26 offen offset:3072 sc1 lds
  v_mfma_f32_16x16x32_bf16 a[228:231], v[36:39], v[112:115], a[228:231]
  s_add_u32 m0, s24, 16384
  ds_read_b128 v[68:71], v14 offset:33792
  v_mfma_f32_16x16x32_bf16 a[236:239], v[36:39], v[116:119], a[236:239]
  buffer_load_dwordx4 v8, s[36:39], s27 offen offset:0 lds
  v_mfma_f32_16x16x32_bf16 a[244:247], v[36:39], v[120:123], a[244:247]
  ds_read_b64_tr_b16 v[136:137], v12 offset:33024
  v_mfma_f32_16x16x32_bf16 a[252:255], v[36:39], v[124:127], a[252:255]
  buffer_load_dwordx4 v9, s[36:39], s27 offen offset:1024 lds
  v_mfma_f32_16x16x32_bf16 a[0:3], v[40:43], v[96:99], a[0:3]
  ds_read_b64_tr_b16 v[138:139], v12 offset:34048
  v_mfma_f32_16x16x32_bf16 a[8:11], v[40:43], v[100:103], a[8:11]
  buffer_load_dwordx4 v10, s[36:39], s27 offen offset:2048 lds
  v_mfma_f32_16x16x32_bf16 a[16:19], v[40:43], v[104:107], a[16:19]
  ds_read_b128 v[72:75], v14 offset:36864
  v_mfma_f32_16x16x32_bf16 a[24:27], v[40:43], v[108:111], a[24:27]
  buffer_load_dwordx4 v11, s[36:39], s27 offen offset:3072 lds
  v_mfma_f32_16x16x32_bf16 a[32:35], v[40:43], v[112:115], a[32:35]
  ds_read_b64_tr_b16 v[140:141], v13 offset:33024
  v_mfma_f32_16x16x32_bf16 a[40:43], v[40:43], v[116:119], a[40:43]
  buffer_load_dword v231, v235, s[48:51], s74 offen sc1
  v_mfma_f32_16x16x32_bf16 a[48:51], v[40:43], v[120:123], a[48:51]
  s_add_u32 s74, s74, s73
  ds_read_b64_tr_b16 v[142:143], v13 offset:34048
  v_mfma_f32_16x16x32_bf16 a[56:59], v[40:43], v[124:127], a[56:59]
  s_bitcmp1_b32 s72, s28
  v_mfma_f32_16x16x32_bf16 a[4:7], v[44:47], v[96:99], a[4:7]
  s_cbranch_scc1 fa_hk2
fa_hb2:
  ds_read_b128 v[76:79], v14 offset:37888
  v_mfma_f32_16x16x32_bf16 a[12:15], v[44:47], v[100:103], a[12:15]
  v_mfma_f32_16x16x32_bf16 a[20:23], v[44:47], v[104:107], a[20:23]
  ds_read_b64_tr_b16 v[144:145], v12 offset:33280
  v_mfma_f32_16x16x32_bf16 a[28:31], v[44:47], v[108:111], a[28:31]
  v_mfma_f32_16x16x32_bf16 a[36:39], v[44:47], v[112:115], a[36:39]
  ds_read_b64_tr_b16 v[146:147], v12 offset:34304
  v_mfma_f32_16x16x32_bf16 a[44:47], v[44:47], v[116:119], a[44:47]
  v_mfma_f32_16x16x32_bf16 a[52:55], v[44:47], v[120:123], a[52:55]
  ds_read_b128 v[80:83], v14 offset:40960
  v_mfma_f32_16x16x32_bf16 a[60:63], v[44:47], v[124:127], a[60:63]
  v_mfma_f32_16x16x32_bf16 a[64:67], v[48:51], v[96:99], a[64:67]
  ds_read_b64_tr_b16 v[148:149], v13 offset:33280
  v_mfma_f32_16x16x32_bf16 a[72:75], v[48:51], v[100:103], a[72:75]
  v_mfma_f32_16x16x32_bf16 a[80:83], v[48:51], v[104:107], a[80:83]
  ds_read_b64_tr_b16 v[150:151], v13 offset:34304
  v_mfma_f32_16x16x32_bf16 a[88:91], v[48:51], v[108:111], a[88:91]
  v_mfma_f32_16x16x32_bf16 a[96:99], v[48:51], v[112:115], a[96:99]
  ds_read_b128 v[84:87], v14 offset:41984
  v_mfma_f32_16x16x32_bf16 a[104:107], v[48:51], v[116:119], a[104:107]
  v_mfma_f32_16x16x32_bf16 a[112:115], v[48:51], v[120:123], a[112:115]
  ds_read_b64_tr_b16 v[152:153], v12 offset:33536
  v_mfma_f32_16x16x32_bf16 a[120:123], v[48:51], v[124:127], a[120:123]
  v_mfma_f32_16x16x32_bf16 a[68:71], v[52:55], v[96:99], a[68:71]
  ds_read_b64_tr_b16 v[154:155], v12 offset:34560
  v_mfma_f32_16x16x32_bf16 a[76:79], v[52:55], v[100:103], a[76:79]
  v_mfma_f32_16x16x32_bf16 a[84:87], v[52:55], v[104:107], a[84:87]
  ds_read_b128 v[88:91], v14 offset:45056
  v_mfma_f32_16x16x32_bf16 a[92:95], v[52:55], v[108:111], a[92:95]
  v_mfma_f32_16x16x32_bf16 a[100:103], v[52:55], v[112:115], a[100:103]
  ds_read_b64_tr_b16 v[156:157], v13 offset:33536
  v_mfma_f32_16x16x32_bf16 a[108:111], v[52:55], v[116:119], a[108:111]
  v_mfma_f32_16x16x32_bf16 a[116:119], v[52:55], v[120:123], a[116:119]
  ds_read_b64_tr_b16 v[158:159], v13 offset:34560
  v_mfma_f32_16x16x32_bf16 a[124:127], v[52:55], v[124:127], a[124:127]
  v_mfma_f32_16x16x32_bf16 a[128:131], v[56:59], v[96:99], a[128:131]
  s_add_u32 s26, s26, s79
  ds_read_b128 v[92:95], v14 offset:46080
  v_mfma_f32_16x16x32_bf16 a[136:139], v[56:59], v[100:103], a[136:139]
  s_add_u32 s27, s27, s25
  v_mfma_f32_16x16x32_bf16 a[144:147], v[56:59], v[104:107], a[144:147]
  s_add_u32 s24, s24, 32768
  v_mfma_f32_16x16x32_bf16 a[152:155], v[56:59], v[108:111], a[152:155]
  s_and_b32 s24, s24, 0x1ffff
  v_mfma_f32_16x16x32_bf16 a[160:163], v[56:59], v[112:115], a[160:163]
  v_xor_b32 v14, 0x10000, v14
  v_mfma_f32_16x16x32_bf16 a[168:171], v[56:59], v[116:119], a[168:171]
  v_xor_b32 v12, 0x10000, v12
  v_mfma_f32_16x16x32_bf16 a[176:179], v[56:59], v[120:123], a[176:179]
  v_xor_b32 v13, 0x10000, v13
  v_mfma_f32_16x16x32_bf16 a[184:187], v[56:59], v[124:127], a[184:187]
  v_mfma_f32_16x16x32_bf16 a[132:135], v[60:63], v[96:99], a[132:135]
  v_mfma_f32_16x16x32_bf16 a[140:143], v[60:63], v[100:103], a[140:143]
  v_mfma_f32_16x16x32_bf16 a[148:151], v[60:63], v[104:107], a[148:151]
  v_mfma_f32_16x16x32_bf16 a[156:159], v[60:63], v[108:111], a[156:159]
  v_mfma_f32_16x16x32_bf16 a[164:167], v[60:63], v[112:115], a[164:167]
  v_mfma_f32_16x16x32_bf16 a[172:175], v[60:63], v[116:119], a[172:175]
  v_mfma_f32_16x16x32_bf16 a[180:183], v[60:63], v[120:123], a[180:183]
  v_mfma_f32_16x16x32_bf16 a[188:191], v[60:63], v[124:127], a[188:191]
  s_waitcnt lgkmcnt(0)
  v_mfma_f32_16x16x32_bf16 a[192:195], v[64:67], v[128:131], a[192:195]
  s_waitcnt vmcnt(18)
  v_mfma_f32_16x16x32_bf16 a[200:203], v[64:67], v[132:135], a[200:203]
  s_barrier
  v_mfma_f32_16x16x32_bf16 a[208:211], v[64:67], v[136:139], a[208:211]
  ds_read_b64_tr_b16 v[96:97], v12 offset:0
  v_mfma_f32_16x16x32_bf16 a[216:219], v[64:67], v[140:143], a[216:219]
  v_mfma_f32_16x16x32_bf16 a[224:227], v[64:67], v[144:147], a[224:227]
  s_mov_b32 m0, s24
  ds_read_b64_tr_b16 v[98:99], v12 offset:1024
  v_mfma_f32_16x16x32_bf16 a[232:235], v[64:67], v[148:151], a[232:235]
  buffer_load_dwordx4 v3, s[32:35], s26 offen offset:0 sc1 lds
  v_mfma_f32_16x16x32_bf16 a[240:243], v[64:67], v[152:155], a[240:243]
  ds_read_b128 v[32:35], v14 offset:0
  v_mfma_f32_16x16x32_bf16 a[248:251], v[64:67], v[156:159], a[248:251]
  v_mfma_f32_16x16x32_bf16 a[196:199], v[68:71], v[128:131], a[196:199]
  ds_read_b64_tr_b16 v[100:101], v13 offset:0
  v_mfma_f32_16x16x32_bf16 a[204:207], v[68:71], v[132:135], a[204:207]
  v_mfma_f32_16x16x32_bf16 a[212:215], v[68:71], v[136:139], a[212:215]
  ds_read_b64_tr_b16 v[102:103], v13 offset:1024
  v_mfma_f32_16x16x32_bf16 a[220:223], v[68:71], v[140:143], a[220:223]
  buffer_load_dwordx4 v4, s[32:35], s26 offen offset:1024 sc1 lds
  v_mfma_f32_16x16x32_bf16 a[228:231], v[68:71], v[144:147], a[228:231]
  ds_read_b128 v[36:39], v14 offset:1024
  v_mfma_f32_16x16x32_bf16 a[236:239], v[68:71], v[148:151], a[236:239]
  v_mfma_f32_16x16x32_bf16 a[244:247], v[68:71], v[152:155], a[244:247]
  ds_read_b64_tr_b16 v[104:105], v12 offset:256
  v_mfma_f32_16x16x32_bf16 a[252:255], v[68:71], v[156:159], a[252:255]
  v_mfma_f32_16x16x32_bf16 a[0:3], v[72:75], v[128:131], a[0:3]
  ds_read_b64_tr_b16 v[106:107], v12 offset:1280
  v_mfma_f32_16x16x32_bf16 a[8:11], v[72:75], v[132:135], a[8:11]
  buffer_load_dwordx4 v5, s[32:35], s26 offen offset:2048 sc1 lds
  v_mfma_f32_16x16x32_bf16 a[16:19], v[72:75], v[136:139], a[16:19]
  ds_read_b128 v[40:43], v14 offset:4096
  v_mfma_f32_16x16x32_bf16 a[24:27], v[72:75], v[140:143], a[24:27]
  v_mfma_f32_16x16x32_bf16 a[32:35], v[72:75], v[144:147], a[32:35]
  ds_read_b64_tr_b16 v[108:109], v13 offset:256
  v_mfma_f32_16x16x32_bf16 a[40:43], v[72:75], v[148:151], a[40:43]
  v_mfma_f32_16x16x32_bf16 a[48:51], v[72:75], v[152:155], a[48:51]
  ds_read_b64_tr_b16 v[110:111], v13 offset:1280
  v_mfma_f32_16x16x32_bf16 a[56:59], v[72:75], v[156:159], a[56:59]
  buffer_load_dwordx4 v6, s[32:35], s26 offen offset:3072 sc1 lds
  v_mfma_f32_16x16x32_bf16 a[4:7], v[76:79], v[128:131], a[4:7]
  ds_read_b128 v[44:47], v14 offset:5120
  v_mfma_f32_16x16x32_bf16 a[12:15], v[76:79], v[132:135], a[12:15]
  v_mfma_f32_16x16x32_bf16 a[20:23], v[76:79], v[136:139], a[20:23]
  ds_read_b64_tr_b16 v[112:113], v12 offset:512
  v_mfma_f32_16x16x32_bf16 a[28:31], v[76:79], v[140:143], a[28:31]
  v_mfma_f32_16x16x32_bf16 a[36:39], v[76:79], v[144:147], a[36:39]
  s_add_u32 m0, s24, 16384
  ds_read_b64_tr_b16 v[114:115], v12 offset:1536
  v_mfma_f32_16x16x32_bf16 a[44:47], v[76:79], v[148:151], a[44:47]
  buffer_load_dwordx4 v8, s[36:39], s27 offen offset:0 lds
  v_mfma_f32_16x16x32_bf16 a[52:55], v[76:79], v[152:155], a[52:55]
  ds_read_b128 v[48:51], v14 offset:8192
  v_mfma_f32_16x16x32_bf16 a[60:63], v[76:79], v[156:159], a[60:63]
  v_mfma_f32_16x16x32_bf16 a[64:67], v[80:83], v[128:131], a[64:67]
  ds_read_b64_tr_b16 v[116:117], v13 offset:512
  v_mfma_f32_16x16x32_bf16 a[72:75], v[80:83], v[132:135], a[72:75]
  v_mfma_f32_16x16x32_bf16 a[80:83], v[80:83], v[136:139], a[80:83]
  ds_read_b64_tr_b16 v[118:119], v13 offset:1536
  v_mfma_f32_16x16x32_bf16 a[88:91], v[80:83], v[140:143], a[88:91]
  buffer_load_dwordx4 v9, s[36:39], s27 offen offset:1024 lds
  v_mfma_f32_16x16x32_bf16 a[96:99], v[80:83], v[144:147], a[96:99]
  ds_read_b128 v[52:55], v14 offset:9216
  v_mfma_f32_16x16x32_bf16 a[104:107], v[80:83], v[148:151], a[104:107]
  v_mfma_f32_16x16x32_bf16 a[112:115], v[80:83], v[152:155], a[112:115]
  ds_read_b64_tr_b16 v[120:121], v12 offset:768
  v_mfma_f32_16x16x32_bf16 a[120:123], v[80:83], v[156:159], a[120:123]
  v_mfma_f32_16x16x32_bf16 a[68:71], v[84:87], v[128:131], a[68:71]
  ds_read_b64_tr_b16 v[122:123], v12 offset:1792
  v_mfma_f32_16x16x32_bf16 a[76:79], v[84:87], v[132:135], a[76:79]
  buffer_load_dwordx4 v10, s[36:39], s27 offen offset:2048 lds
  v_mfma_f32_16x16x32_bf16 a[84:87], v[84:87], v[136:139], a[84:87]
  ds_read_b128 v[56:59], v14 offset:12288
  v_mfma_f32_16x16x32_bf16 a[92:95], v[84:87], v[140:143], a[92:95]
  v_mfma_f32_16x16x32_bf16 a[100:103], v[84:87], v[144:147], a[100:103]
  ds_read_b64_tr_b16 v[124:125], v13 offset:768
  v_mfma_f32_16x16x32_bf16 a[108:111], v[84:87], v[148:151], a[108:111]
  v_mfma_f32_16x16x32_bf16 a[116:119], v[84:87], v[152:155], a[116:119]
  ds_read_b64_tr_b16 v[126:127], v13 offset:1792
  v_mfma_f32_16x16x32_bf16 a[124:127], v[84:87], v[156:159], a[124:127]
  buffer_load_dwordx4 v11, s[36:39], s27 offen offset:3072 lds
  v_mfma_f32_16x16x32_bf16 a[128:131], v[88:91], v[128:131], a[128:131]
  s_add_u32 s26, s26, s79
  ds_read_b128 v[60:63], v14 offset:13312
  v_mfma_f32_16x16x32_bf16 a[136:139], v[88:91], v[132:135], a[136:139]
  s_add_u32 s27, s27, s25
  v_mfma_f32_16x16x32_bf16 a[144:147], v[88:91], v[136:139], a[144:147]
  s_add_u32 s24, s24, 32768
  v_mfma_f32_16x16x32_bf16 a[152:155], v[88:91], v[140:143], a[152:155]
  s_and_b32 s24, s24, 0x1ffff
  v_mfma_f32_16x16x32_bf16 a[160:163], v[88:91], v[144:147], a[160:163]
  v_mfma_f32_16x16x32_bf16 a[168:171], v[88:91], v[148:151], a[168:171]
  s_bitcmp1_b32 s76, s28
  v_mfma_f32_16x16x32_bf16 a[176:179], v[88:91], v[152:155], a[176:179]
  s_cbranch_scc1 fa_hk3
fa_hb3:
  v_mfma_f32_16x16x32_bf16 a[184:187], v[88:91], v[156:159], a[184:187]
  v_mfma_f32_16x16x32_bf16 a[132:135], v[92:95], v[128:131], a[132:135]
  v_mfma_f32_16x16x32_bf16 a[140:143], v[92:95], v[132:135], a[140:143]
  s_add_u32 s28, s28, 1
  v_mfma_f32_16x16x32_bf16 a[148:151], v[92:95], v[136:139], a[148:151]
  v_mfma_f32_16x16x32_bf16 a[156:159], v[92:95], v[140:143], a[156:159]
  v_mfma_f32_16x16x32_bf16 a[164:167], v[92:95], v[144:147], a[164:167]
  v_mfma_f32_16x16x32_bf16 a[172:175], v[92:95], v[148:151], a[172:175]
  s_cmp_lt_u32 s28, 8
  v_mfma_f32_16x16x32_bf16 a[180:183], v[92:95], v[152:155], a[180:183]
  s_waitcnt lgkmcnt(0)
  v_mfma_f32_16x16x32_bf16 a[188:191], v[92:95], v[156:159], a[188:191]
  s_cbranch_scc1 fa_loopV
  s_mov_b32 s64, 33554432
  s_mov_b32 s76, 1.0
fa_p1epi:
  s_lshr_b32 s23, s20, 1
  s_lshl_b32 s23, s23, 13
  v_subrev_u32 v12, s23, v12
  v_subrev_u32 v13, s23, v13
  s_lshl_b32 s24, s20, 12
  v_add_u32 v14, s24, v2
  ds_read_b64_tr_b16 v[32:33], v12 offset:0
  ds_read_b64_tr_b16 v[34:35], v12 offset:1024
  ds_read_b64_tr_b16 v[36:37], v13 offset:0
  ds_read_b64_tr_b16 v[38:39], v13 offset:1024
  ds_read_b64_tr_b16 v[40:41], v12 offset:256
  ds_read_b64_tr_b16 v[42:43], v12 offset:1280
  ds_read_b64_tr_b16 v[44:45], v13 offset:256
  ds_read_b64_tr_b16 v[46:47], v13 offset:1280
  ds_read_b64_tr_b16 v[48:49], v12 offset:512
  ds_read_b64_tr_b16 v[50:51], v12 offset:1536
  ds_read_b64_tr_b16 v[52:53], v13 offset:512
  ds_read_b64_tr_b16 v[54:55], v13 offset:1536
  ds_read_b64_tr_b16 v[56:57], v12 offset:768
  ds_read_b64_tr_b16 v[58:59], v12 offset:1792
  ds_read_b64_tr_b16 v[60:61], v13 offset:768
  ds_read_b64_tr_b16 v[62:63], v13 offset:1792
  s_waitcnt vmcnt(8)
  ds_read_b128 v[224:227], v14 offset:0
  ds_read_b128 v[228:231], v14 offset:1024
  ds_read_b128 v[232:235], v14 offset:2048
  ds_read_b128 v[236:239], v14 offset:3072
  s_lshl_b32 s23, s21, 19
  s_add_u32 s64, s64, s23
  s_lshl_b32 s23, s22, 14
  s_add_u32 s64, s64, s23
  s_and_b32 s23, s20, 1
  s_lshl_b32 s23, s23, 13
  s_add_u32 s64, s64, s23
  s_lshl_b32 s23, s21, 19
  s_add_u32 s23, s23, 16777216
  s_add_u32 s6, s18, s23
  s_addc_u32 s7, s19, 0
  s_add_u32 s8, s6, 16777216
  s_addc_u32 s9, s7, 0
  s_sub_u32 s23, 16, s22
  s_lshl_b32 s23, s23, 15
  s_mov_b32 s44, s6
  s_mov_b32 s45, s7
  s_mov_b32 s46, s23
  s_mov_b32 s47, 0x20000
  s_mov_b32 s48, s8
  s_mov_b32 s49, s9
  s_mov_b32 s50, s23
  s_mov_b32 s51, 0x20000
  s_lshl_b32 s30, s21, 7
  s_add_u32 s30, s30, 2637824
  s_mov_b32 s81, 0x47800000
  s_cmp_eq_u32 s20, 0
  s_cselect_b32 s65, s82, 1073741824
  s_waitcnt vmcnt(21) lgkmcnt(0)
  v_mfma_f32_16x16x32_bf16 v[96:99], v[32:35], v[224:227], 0
  v_accvgpr_read_b32 v16, a192
  v_accvgpr_read_b32 v17, a193
  v_accvgpr_read_b32 v18, a194
  v_mfma_f32_16x16x32_bf16 v[112:115], v[36:39], v[224:227], 0
  ds_read_b64_tr_b16 v[64:65], v12 offset:8192
  v_accvgpr_read_b32 v19, a195
  v_mfma_f32_16x16x32_bf16 v[128:131], v[40:43], v[224:227], 0
  s_add_u32 m0, s24, 0
  ds_read_b64_tr_b16 v[66:67], v12 offset:9216
  v_accvgpr_read_b32 v20, a196
  v_mfma_f32_16x16x32_bf16 v[144:147], v[44:47], v[224:227], 0
  buffer_load_dwordx4 v3, s[32:35], s26 offen offset:0 sc1 lds
  v_accvgpr_read_b32 v21, a197
  v_mfma_f32_16x16x32_bf16 v[160:163], v[48:51], v[224:227], 0
  ds_read_b64_tr_b16 v[68:69], v13 offset:8192
  v_accvgpr_read_b32 v22, a198
  v_accvgpr_read_b32 v23, a199
  v_mfma_f32_16x16x32_bf16 v[176:179], v[52:55], v[224:227], 0
  ds_read_b64_tr_b16 v[70:71], v13 offset:9216
  v_mul_f32 v16, s76, v16
  v_mfma_f32_16x16x32_bf16 v[192:195], v[56:59], v[224:227], 0
  ds_read_b64_tr_b16 v[72:73], v12 offset:8448
  v_mul_f32 v17, s76, v17
  v_mfma_f32_16x16x32_bf16 v[208:211], v[60:63], v[224:227], 0
  ds_read_b64_tr_b16 v[74:75], v12 offset:9472
  v_mul_f32 v18, s76, v18
  v_mfma_f32_16x16x32_bf16 v[100:103], v[32:35], v[228:231], 0
  buffer_load_dwordx4 v4, s[32:35], s26 offen offset:1024 sc1 lds
  v_mul_f32 v19, s76, v19
  v_mul_f32 v20, s76, v20
  v_mfma_f32_16x16x32_bf16 v[116:119], v[36:39], v[228:231], 0
  ds_read_b64_tr_b16 v[76:77], v13 offset:8448
  v_mul_f32 v21, s76, v21
  v_mfma_f32_16x16x32_bf16 v[132:135], v[40:43], v[228:231], 0
  ds_read_b64_tr_b16 v[78:79], v13 offset:9472
  v_mul_f32 v22, s76, v22
  v_mfma_f32_16x16x32_bf16 v[148:151], v[44:47], v[228:231], 0
  ds_read_b128 v[240:243], v14 offset:32768
  v_mul_f32 v23, s76, v23
  v_mfma_f32_16x16x32_bf16 v[164:167], v[48:51], v[228:231], 0
  ds_read_b128 v[244:247], v14 offset:33792
  v_cvt_pk_bf16_f32 v24, v16, v17
  v_cvt_pk_bf16_f32 v25, v18, v19
  v_mfma_f32_16x16x32_bf16 v[180:183], v[52:55], v[228:231], 0
  buffer_load_dwordx4 v5, s[32:35], s26 offen offset:2048 sc1 lds
  v_cvt_pk_bf16_f32 v26, v20, v21
  v_mfma_f32_16x16x32_bf16 v[196:199], v[56:59], v[228:231], 0
  ds_read_b64_tr_b16 v[80:81], v12 offset:8704
  v_cvt_pk_bf16_f32 v27, v22, v23
  v_mfma_f32_16x16x32_bf16 v[212:215], v[60:63], v[228:231], 0
  ds_read_b64_tr_b16 v[82:83], v12 offset:9728
  buffer_store_dwordx4 v[24:27], v2, s[40:43], s64 offen offset:0 sc1
  v_mfma_f32_16x16x32_bf16 v[104:107], v[32:35], v[232:235], 0
  ds_read_b64_tr_b16 v[84:85], v13 offset:8704
  v_accvgpr_read_b32 v16, a200
  v_mfma_f32_16x16x32_bf16 v[120:123], v[36:39], v[232:235], 0
  ds_read_b64_tr_b16 v[86:87], v13 offset:9728
  v_accvgpr_read_b32 v17, a201
  v_accvgpr_read_b32 v18, a202
  v_mfma_f32_16x16x32_bf16 v[136:139], v[40:43], v[232:235], 0
  buffer_load_dwordx4 v6, s[32:35], s26 offen offset:3072 sc1 lds
  v_accvgpr_read_b32 v19, a203
  v_mfma_f32_16x16x32_bf16 v[152:155], v[44:47], v[232:235], 0
  s_add_u32 s26, s26, 1024
  ds_read_b64_tr_b16 v[88:89], v12 offset:8960
  v_accvgpr_read_b32 v20, a204
  v_mfma_f32_16x16x32_bf16 v[168:171], v[48:51], v[232:235], 0
  ds_read_b64_tr_b16 v[90:91], v12 offset:9984
  v_accvgpr_read_b32 v21, a205
  v_mfma_f32_16x16x32_bf16 v[184:187], v[52:55], v[232:235], 0
  ds_read_b64_tr_b16 v[92:93], v13 offset:8960
  v_accvgpr_read_b32 v22, a206
  v_accvgpr_read_b32 v23, a207
  v_mfma_f32_16x16x32_bf16 v[200:203], v[56:59], v[232:235], 0
  ds_read_b64_tr_b16 v[94:95], v13 offset:9984
  v_mul_f32 v16, s76, v16
  v_mfma_f32_16x16x32_bf16 v[216:219], v[60:63], v[232:235], 0
  v_mul_f32 v17, s76, v17
  v_mul_f32 v18, s76, v18
  v_mfma_f32_16x16x32_bf16 v[108:111], v[32:35], v[236:239], 0
  ds_read_b128 v[248:251], v14 offset:34816
  v_mul_f32 v19, s76, v19
  v_mfma_f32_16x16x32_bf16 v[124:127], v[36:39], v[236:239], 0
  ds_read_b128 v[252:255], v14 offset:35840
  v_mul_f32 v20, s76, v20
  v_mul_f32 v21, s76, v21
  v_mfma_f32_16x16x32_bf16 v[140:143], v[40:43], v[236:239], 0
  v_mul_f32 v22, s76, v22
  v_mul_f32 v23, s76, v23
  v_mfma_f32_16x16x32_bf16 v[156:159], v[44:47], v[236:239], 0
  v_xor_b32 v14, 0x10000, v14
  v_cvt_pk_bf16_f32 v28, v16, v17
  v_mfma_f32_16x16x32_bf16 v[172:175], v[48:51], v[236:239], 0
  v_cvt_pk_bf16_f32 v29, v18, v19
  v_cvt_pk_bf16_f32 v30, v20, v21
  v_mfma_f32_16x16x32_bf16 v[188:191], v[52:55], v[236:239], 0
  v_cvt_pk_bf16_f32 v31, v22, v23
  v_mfma_f32_16x16x32_bf16 v[204:207], v[56:59], v[236:239], 0
  buffer_store_dwordx4 v[28:31], v2, s[40:43], s64 offen offset:1024 sc1
  v_mfma_f32_16x16x32_bf16 v[220:223], v[60:63], v[236:239], 0
  s_waitcnt vmcnt(19) lgkmcnt(0)
  v_mfma_f32_16x16x32_bf16 v[96:99], v[64:67], v[240:243], v[96:99]
  s_barrier
  v_accvgpr_read_b32 v16, a208
  v_accvgpr_read_b32 v17, a209
  v_accvgpr_read_b32 v18, a210
  v_mfma_f32_16x16x32_bf16 v[112:115], v[68:71], v[240:243], v[112:115]
  ds_read_b64_tr_b16 v[32:33], v12 offset:32768
  v_accvgpr_read_b32 v19, a211
  v_mfma_f32_16x16x32_bf16 v[128:131], v[72:75], v[240:243], v[128:131]
  s_add_u32 m0, s24, 32768
  ds_read_b64_tr_b16 v[34:35], v12 offset:33792
  v_accvgpr_read_b32 v20, a212
  v_mfma_f32_16x16x32_bf16 v[144:147], v[76:79], v[240:243], v[144:147]
  buffer_load_dwordx4 v3, s[32:35], s26 offen offset:0 sc1 lds
  v_accvgpr_read_b32 v21, a213
  v_mfma_f32_16x16x32_bf16 v[160:163], v[80:83], v[240:243], v[160:163]
  ds_read_b64_tr_b16 v[36:37], v13 offset:32768
  v_accvgpr_read_b32 v22, a214
  v_accvgpr_read_b32 v23, a215
  v_mfma_f32_16x16x32_bf16 v[176:179], v[84:87], v[240:243], v[176:179]
  ds_read_b64_tr_b16 v[38:39], v13 offset:33792
  v_mul_f32 v16, s76, v16
  v_mfma_f32_16x16x32_bf16 v[192:195], v[88:91], v[240:243], v[192:195]
  ds_read_b64_tr_b16 v[40:41], v12 offset:33024
  v_mul_f32 v17, s76, v17
  v_mfma_f32_16x16x32_bf16 v[208:211], v[92:95], v[240:243], v[208:211]
  ds_read_b64_tr_b16 v[42:43], v12 offset:34048
  v_mul_f32 v18, s76, v18
  v_mfma_f32_16x16x32_bf16 v[100:103], v[64:67], v[244:247], v[100:103]
  buffer_load_dwordx4 v4, s[32:35], s26 offen offset:1024 sc1 lds
  v_mul_f32 v19, s76, v19
  v_mul_f32 v20, s76, v20
  v_mfma_f32_16x16x32_bf16 v[116:119], v[68:71], v[244:247], v[116:119]
  ds_read_b64_tr_b16 v[44:45], v13 offset:33024
  v_mul_f32 v21, s76, v21
  v_mfma_f32_16x16x32_bf16 v[132:135], v[72:75], v[244:247], v[132:135]
  ds_read_b64_tr_b16 v[46:47], v13 offset:34048
  v_mul_f32 v22, s76, v22
  v_mfma_f32_16x16x32_bf16 v[148:151], v[76:79], v[244:247], v[148:151]
  ds_read_b128 v[224:227], v14 offset:0
  v_mul_f32 v23, s76, v23
  v_mfma_f32_16x16x32_bf16 v[164:167], v[80:83], v[244:247], v[164:167]
  ds_read_b128 v[228:231], v14 offset:1024
  v_cvt_pk_bf16_f32 v24, v16, v17
  v_cvt_pk_bf16_f32 v25, v18, v19
  v_mfma_f32_16x16x32_bf16 v[180:183], v[84:87], v[244:247], v[180:183]
  buffer_load_dwordx4 v5, s[32:35], s26 offen offset:2048 sc1 lds
  v_cvt_pk_bf16_f32 v26, v20, v21
  v_mfma_f32_16x16x32_bf16 v[196:199], v[88:91], v[244:247], v[196:199]
  ds_read_b64_tr_b16 v[48:49], v12 offset:33280
  v_cvt_pk_bf16_f32 v27, v22, v23
  v_mfma_f32_16x16x32_bf16 v[212:215], v[92:95], v[244:247], v[212:215]
  ds_read_b64_tr_b16 v[50:51], v12 offset:34304
  buffer_store_dwordx4 v[24:27], v2, s[40:43], s64 offen offset:2048 sc1
  v_mfma_f32_16x16x32_bf16 v[104:107], v[64:67], v[248:251], v[104:107]
  ds_read_b64_tr_b16 v[52:53], v13 offset:33280
  v_accvgpr_read_b32 v16, a216
  v_mfma_f32_16x16x32_bf16 v[120:123], v[68:71], v[248:251], v[120:123]
  ds_read_b64_tr_b16 v[54:55], v13 offset:34304
  v_accvgpr_read_b32 v17, a217
  v_accvgpr_read_b32 v18, a218
  v_mfma_f32_16x16x32_bf16 v[136:139], v[72:75], v[248:251], v[136:139]
  buffer_load_dwordx4 v6, s[32:35], s26 offen offset:3072 sc1 lds
  v_accvgpr_read_b32 v19, a219
  v_mfma_f32_16x16x32_bf16 v[152:155], v[76:79], v[248:251], v[152:155]
  s_add_u32 s26, s26, 1024
  ds_read_b64_tr_b16 v[56:57], v12 offset:33536
  v_accvgpr_read_b32 v20, a220
  v_mfma_f32_16x16x32_bf16 v[168:171], v[80:83], v[248:251], v[168:171]
  ds_read_b64_tr_b16 v[58:59], v12 offset:34560
  v_accvgpr_read_b32 v21, a221
  v_mfma_f32_16x16x32_bf16 v[184:187], v[84:87], v[248:251], v[184:187]
  ds_read_b64_tr_b16 v[60:61], v13 offset:33536
  v_accvgpr_read_b32 v22, a222
  v_accvgpr_read_b32 v23, a223
  v_mfma_f32_16x16x32_bf16 v[200:203], v[88:91], v[248:251], v[200:203]
  s_add_u32 m0, s24, 16384
  ds_read_b64_tr_b16 v[62:63], v13 offset:34560
  v_mul_f32 v16, s76, v16
  v_mfma_f32_16x16x32_bf16 v[216:219], v[92:95], v[248:251], v[216:219]
  buffer_load_dwordx4 v8, s[36:39], s27 offen offset:0 lds
  v_mul_f32 v17, s76, v17
  v_mfma_f32_16x16x32_bf16 v[108:111], v[64:67], v[252:255], v[108:111]
  ds_read_b128 v[232:235], v14 offset:2048
  v_mul_f32 v18, s76, v18
  v_mfma_f32_16x16x32_bf16 v[124:127], v[68:71], v[252:255], v[124:127]
  ds_read_b128 v[236:239], v14 offset:3072
  v_mul_f32 v19, s76, v19
  v_mul_f32 v20, s76, v20
  v_mfma_f32_16x16x32_bf16 v[140:143], v[72:75], v[252:255], v[140:143]
  v_mul_f32 v21, s76, v21
  v_mul_f32 v22, s76, v22
  v_mfma_f32_16x16x32_bf16 v[156:159], v[76:79], v[252:255], v[156:159]
  v_mul_f32 v23, s76, v23
  v_cvt_pk_bf16_f32 v28, v16, v17
  v_mfma_f32_16x16x32_bf16 v[172:175], v[80:83], v[252:255], v[172:175]
  buffer_load_dwordx4 v9, s[36:39], s27 offen offset:1024 lds
  v_cvt_pk_bf16_f32 v29, v18, v19
  v_mfma_f32_16x16x32_bf16 v[188:191], v[84:87], v[252:255], v[188:191]
  v_cvt_pk_bf16_f32 v30, v20, v21
  v_cvt_pk_bf16_f32 v31, v22, v23
  v_mfma_f32_16x16x32_bf16 v[204:207], v[88:91], v[252:255], v[204:207]
  buffer_store_dwordx4 v[28:31], v2, s[40:43], s64 offen offset:3072 sc1
  v_mfma_f32_16x16x32_bf16 v[220:223], v[92:95], v[252:255], v[220:223]
  s_waitcnt vmcnt(18) lgkmcnt(0)
  v_mfma_f32_16x16x32_bf16 v[96:99], v[32:35], v[224:227], v[96:99]
  s_add_u32 s64, s64, 4096
  v_accvgpr_read_b32 v16, a224
  v_accvgpr_read_b32 v17, a225
  v_mfma_f32_16x16x32_bf16 v[112:115], v[36:39], v[224:227], v[112:115]
  ds_read_b64_tr_b16 v[64:65], v12 offset:40960
  v_accvgpr_read_b32 v18, a226
  v_mfma_f32_16x16x32_bf16 v[128:131], v[40:43], v[224:227], v[128:131]
  s_add_u32 m0, s24, 65536
  ds_read_b64_tr_b16 v[66:67], v12 offset:41984
  v_accvgpr_read_b32 v19, a227
  v_mfma_f32_16x16x32_bf16 v[144:147], v[44:47], v[224:227], v[144:147]
  buffer_load_dwordx4 v3, s[32:35], s26 offen offset:0 sc1 lds
  v_accvgpr_read_b32 v20, a228
  v_mfma_f32_16x16x32_bf16 v[160:163], v[48:51], v[224:227], v[160:163]
  ds_read_b64_tr_b16 v[68:69], v13 offset:40960
  v_accvgpr_read_b32 v21, a229
  v_mfma_f32_16x16x32_bf16 v[176:179], v[52:55], v[224:227], v[176:179]
  ds_read_b64_tr_b16 v[70:71], v13 offset:41984
  v_accvgpr_read_b32 v22, a230
  v_mfma_f32_16x16x32_bf16 v[192:195], v[56:59], v[224:227], v[192:195]
  ds_read_b64_tr_b16 v[72:73], v12 offset:41216
  v_accvgpr_read_b32 v23, a231
  v_mfma_f32_16x16x32_bf16 v[208:211], v[60:63], v[224:227], v[208:211]
  ds_read_b64_tr_b16 v[74:75], v12 offset:42240
  v_mul_f32 v16, s76, v16
  v_mfma_f32_16x16x32_bf16 v[100:103], v[32:35], v[228:231], v[100:103]
  buffer_load_dwordx4 v4, s[32:35], s26 offen offset:1024 sc1 lds
  v_mul_f32 v17, s76, v17
  v_mfma_f32_16x16x32_bf16 v[116:119], v[36:39], v[228:231], v[116:119]
  ds_read_b64_tr_b16 v[76:77], v13 offset:41216
  v_mul_f32 v18, s76, v18
  v_mfma_f32_16x16x32_bf16 v[132:135], v[40:43], v[228:231], v[132:135]
  ds_read_b64_tr_b16 v[78:79], v13 offset:42240
  v_mul_f32 v19, s76, v19
  v_mfma_f32_16x16x32_bf16 v[148:151], v[44:47], v[228:231], v[148:151]
  ds_read_b128 v[240:243], v14 offset:32768
  v_mul_f32 v20, s76, v20
  v_mfma_f32_16x16x32_bf16 v[164:167], v[48:51], v[228:231], v[164:167]
  ds_read_b128 v[244:247], v14 offset:33792
  v_mul_f32 v21, s76, v21
  v_mfma_f32_16x16x32_bf16 v[180:183], v[52:55], v[228:231], v[180:183]
  buffer_load_dwordx4 v5, s[32:35], s26 offen offset:2048 sc1 lds
  v_mul_f32 v22, s76, v22
  v_mfma_f32_16x16x32_bf16 v[196:199], v[56:59], v[228:231], v[196:199]
  ds_read_b64_tr_b16 v[80:81], v12 offset:41472
  v_mul_f32 v23, s76, v23
  v_mfma_f32_16x16x32_bf16 v[212:215], v[60:63], v[228:231], v[212:215]
  ds_read_b64_tr_b16 v[82:83], v12 offset:42496
  v_cvt_pk_bf16_f32 v24, v16, v17
  v_mfma_f32_16x16x32_bf16 v[104:107], v[32:35], v[232:235], v[104:107]
  ds_read_b64_tr_b16 v[84:85], v13 offset:41472
  v_cvt_pk_bf16_f32 v25, v18, v19
  v_mfma_f32_16x16x32_bf16 v[120:123], v[36:39], v[232:235], v[120:123]
  ds_read_b64_tr_b16 v[86:87], v13 offset:42496
  v_cvt_pk_bf16_f32 v26, v20, v21
  v_mfma_f32_16x16x32_bf16 v[136:139], v[40:43], v[232:235], v[136:139]
  buffer_load_dwordx4 v6, s[32:35], s26 offen offset:3072 sc1 lds
  v_cvt_pk_bf16_f32 v27, v22, v23
  v_mfma_f32_16x16x32_bf16 v[152:155], v[44:47], v[232:235], v[152:155]
  s_add_u32 s26, s26, 1024
  ds_read_b64_tr_b16 v[88:89], v12 offset:41728
  buffer_store_dwordx4 v[24:27], v2, s[40:43], s64 offen offset:0 sc1
  v_mfma_f32_16x16x32_bf16 v[168:171], v[48:51], v[232:235], v[168:171]
  ds_read_b64_tr_b16 v[90:91], v12 offset:42752
  v_mfma_f32_16x16x32_bf16 v[184:187], v[52:55], v[232:235], v[184:187]
  ds_read_b64_tr_b16 v[92:93], v13 offset:41728
  v_mfma_f32_16x16x32_bf16 v[200:203], v[56:59], v[232:235], v[200:203]
  s_add_u32 m0, s24, 16384
  ds_read_b64_tr_b16 v[94:95], v13 offset:42752
  v_mfma_f32_16x16x32_bf16 v[216:219], v[60:63], v[232:235], v[216:219]
  buffer_load_dwordx4 v10, s[36:39], s27 offen offset:2048 lds
  v_mfma_f32_16x16x32_bf16 v[108:111], v[32:35], v[236:239], v[108:111]
  ds_read_b128 v[248:251], v14 offset:34816
  v_mfma_f32_16x16x32_bf16 v[124:127], v[36:39], v[236:239], v[124:127]
  ds_read_b128 v[252:255], v14 offset:35840
  v_mfma_f32_16x16x32_bf16 v[140:143], v[40:43], v[236:239], v[140:143]
  v_mfma_f32_16x16x32_bf16 v[156:159], v[44:47], v[236:239], v[156:159]
  v_xor_b32 v14, 0x10000, v14
  v_mfma_f32_16x16x32_bf16 v[172:175], v[48:51], v[236:239], v[172:175]
  buffer_load_dwordx4 v11, s[36:39], s27 offen offset:3072 lds
  v_mfma_f32_16x16x32_bf16 v[188:191], v[52:55], v[236:239], v[188:191]
  s_add_u32 s27, s27, 524288
  v_xor_b32 v12, 0x10000, v12
  v_mfma_f32_16x16x32_bf16 v[204:207], v[56:59], v[236:239], v[204:207]
  v_xor_b32 v13, 0x10000, v13
  v_mfma_f32_16x16x32_bf16 v[220:223], v[60:63], v[236:239], v[220:223]
  s_waitcnt vmcnt(16) lgkmcnt(0)
  v_mfma_f32_16x16x32_bf16 v[96:99], v[64:67], v[240:243], v[96:99]
  s_barrier
  v_accvgpr_read_b32 v16, a232
  v_accvgpr_read_b32 v17, a233
  v_mfma_f32_16x16x32_bf16 v[112:115], v[68:71], v[240:243], v[112:115]
  ds_read_b64_tr_b16 v[32:33], v12 offset:0
  v_accvgpr_read_b32 v18, a234
  v_mfma_f32_16x16x32_bf16 v[128:131], v[72:75], v[240:243], v[128:131]
  s_add_u32 m0, s24, 98304
  ds_read_b64_tr_b16 v[34:35], v12 offset:1024
  v_accvgpr_read_b32 v19, a235
  v_mfma_f32_16x16x32_bf16 v[144:147], v[76:79], v[240:243], v[144:147]
  buffer_load_dwordx4 v3, s[32:35], s26 offen offset:0 sc1 lds
  v_accvgpr_read_b32 v20, a236
  v_mfma_f32_16x16x32_bf16 v[160:163], v[80:83], v[240:243], v[160:163]
  ds_read_b64_tr_b16 v[36:37], v13 offset:0
  v_accvgpr_read_b32 v21, a237
  v_mfma_f32_16x16x32_bf16 v[176:179], v[84:87], v[240:243], v[176:179]
  ds_read_b64_tr_b16 v[38:39], v13 offset:1024
  v_accvgpr_read_b32 v22, a238
  v_mfma_f32_16x16x32_bf16 v[192:195], v[88:91], v[240:243], v[192:195]
  ds_read_b64_tr_b16 v[40:41], v12 offset:256
  v_accvgpr_read_b32 v23, a239
  v_mfma_f32_16x16x32_bf16 v[208:211], v[92:95], v[240:243], v[208:211]
  ds_read_b64_tr_b16 v[42:43], v12 offset:1280
  v_mul_f32 v16, s76, v16
  v_mfma_f32_16x16x32_bf16 v[100:103], v[64:67], v[244:247], v[100:103]
  buffer_load_dwordx4 v4, s[32:35], s26 offen offset:1024 sc1 lds
  v_mul_f32 v17, s76, v17
  v_mfma_f32_16x16x32_bf16 v[116:119], v[68:71], v[244:247], v[116:119]
  ds_read_b64_tr_b16 v[44:45], v13 offset:256
  v_mul_f32 v18, s76, v18
  v_mfma_f32_16x16x32_bf16 v[132:135], v[72:75], v[244:247], v[132:135]
  ds_read_b64_tr_b16 v[46:47], v13 offset:1280
  v_mul_f32 v19, s76, v19
  v_mfma_f32_16x16x32_bf16 v[148:151], v[76:79], v[244:247], v[148:151]
  ds_read_b128 v[224:227], v14 offset:0
  v_mul_f32 v20, s76, v20
  v_mfma_f32_16x16x32_bf16 v[164:167], v[80:83], v[244:247], v[164:167]
  ds_read_b128 v[228:231], v14 offset:1024
  v_mul_f32 v21, s76, v21
  v_mfma_f32_16x16x32_bf16 v[180:183], v[84:87], v[244:247], v[180:183]
  buffer_load_dwordx4 v5, s[32:35], s26 offen offset:2048 sc1 lds
  v_mul_f32 v22, s76, v22
  v_mfma_f32_16x16x32_bf16 v[196:199], v[88:91], v[244:247], v[196:199]
  ds_read_b64_tr_b16 v[48:49], v12 offset:512
  v_mul_f32 v23, s76, v23
  v_mfma_f32_16x16x32_bf16 v[212:215], v[92:95], v[244:247], v[212:215]
  ds_read_b64_tr_b16 v[50:51], v12 offset:1536
  v_cvt_pk_bf16_f32 v28, v16, v17
  v_mfma_f32_16x16x32_bf16 v[104:107], v[64:67], v[248:251], v[104:107]
  ds_read_b64_tr_b16 v[52:53], v13 offset:512
  v_cvt_pk_bf16_f32 v29, v18, v19
  v_mfma_f32_16x16x32_bf16 v[120:123], v[68:71], v[248:251], v[120:123]
  ds_read_b64_tr_b16 v[54:55], v13 offset:1536
  v_cvt_pk_bf16_f32 v30, v20, v21
  v_mfma_f32_16x16x32_bf16 v[136:139], v[72:75], v[248:251], v[136:139]
  buffer_load_dwordx4 v6, s[32:35], s26 offen offset:3072 sc1 lds
  v_cvt_pk_bf16_f32 v31, v22, v23
  v_mfma_f32_16x16x32_bf16 v[152:155], v[76:79], v[248:251], v[152:155]
  s_add_u32 s26, s26, 1024
  ds_read_b64_tr_b16 v[56:57], v12 offset:768
  buffer_store_dwordx4 v[28:31], v2, s[40:43], s64 offen offset:1024 sc1
  v_mfma_f32_16x16x32_bf16 v[168:171], v[80:83], v[248:251], v[168:171]
  ds_read_b64_tr_b16 v[58:59], v12 offset:1792
  v_mfma_f32_16x16x32_bf16 v[184:187], v[84:87], v[248:251], v[184:187]
  ds_read_b64_tr_b16 v[60:61], v13 offset:768
  v_mfma_f32_16x16x32_bf16 v[200:203], v[88:91], v[248:251], v[200:203]
  s_add_u32 m0, s24, 49152
  ds_read_b64_tr_b16 v[62:63], v13 offset:1792
  v_mfma_f32_16x16x32_bf16 v[216:219], v[92:95], v[248:251], v[216:219]
  buffer_load_dwordx4 v8, s[36:39], s27 offen offset:0 lds
  v_mfma_f32_16x16x32_bf16 v[108:111], v[64:67], v[252:255], v[108:111]
  ds_read_b128 v[232:235], v14 offset:2048
  v_mfma_f32_16x16x32_bf16 v[124:127], v[68:71], v[252:255], v[124:127]
  ds_read_b128 v[236:239], v14 offset:3072
  v_mfma_f32_16x16x32_bf16 v[140:143], v[72:75], v[252:255], v[140:143]
  v_mfma_f32_16x16x32_bf16 v[156:159], v[76:79], v[252:255], v[156:159]
  v_mfma_f32_16x16x32_bf16 v[172:175], v[80:83], v[252:255], v[172:175]
  buffer_load_dwordx4 v9, s[36:39], s27 offen offset:1024 lds
  v_mfma_f32_16x16x32_bf16 v[188:191], v[84:87], v[252:255], v[188:191]
  v_mfma_f32_16x16x32_bf16 v[204:207], v[88:91], v[252:255], v[204:207]
  v_mfma_f32_16x16x32_bf16 v[220:223], v[92:95], v[252:255], v[220:223]
  s_waitcnt vmcnt(17) lgkmcnt(0)
  v_mfma_f32_16x16x32_bf16 v[96:99], v[32:35], v[224:227], v[96:99]
  v_accvgpr_read_b32 v16, a240
  v_accvgpr_read_b32 v17, a241
  v_mfma_f32_16x16x32_bf16 v[112:115], v[36:39], v[224:227], v[112:115]
  ds_read_b64_tr_b16 v[64:65], v12 offset:8192
  v_accvgpr_read_b32 v18, a242
  v_mfma_f32_16x16x32_bf16 v[128:131], v[40:43], v[224:227], v[128:131]
  s_add_u32 m0, s24, 0
  ds_read_b64_tr_b16 v[66:67], v12 offset:9216
  v_accvgpr_read_b32 v19, a243
  v_mfma_f32_16x16x32_bf16 v[144:147], v[44:47], v[224:227], v[144:147]
  buffer_load_dwordx4 v3, s[32:35], s26 offen offset:0 sc1 lds
  v_accvgpr_read_b32 v20, a244
  v_mfma_f32_16x16x32_bf16 v[160:163], v[48:51], v[224:227], v[160:163]
  ds_read_b64_tr_b16 v[68:69], v13 offset:8192
  v_accvgpr_read_b32 v21, a245
  v_mfma_f32_16x16x32_bf16 v[176:179], v[52:55], v[224:227], v[176:179]
  ds_read_b64_tr_b16 v[70:71], v13 offset:9216
  v_accvgpr_read_b32 v22, a246
  v_mfma_f32_16x16x32_bf16 v[192:195], v[56:59], v[224:227], v[192:195]
  ds_read_b64_tr_b16 v[72:73], v12 offset:8448
  v_accvgpr_read_b32 v23, a247
  v_mfma_f32_16x16x32_bf16 v[208:211], v[60:63], v[224:227], v[208:211]
  ds_read_b64_tr_b16 v[74:75], v12 offset:9472
  v_mul_f32 v16, s76, v16
  v_mfma_f32_16x16x32_bf16 v[100:103], v[32:35], v[228:231], v[100:103]
  buffer_load_dwordx4 v4, s[32:35], s26 offen offset:1024 sc1 lds
  v_mul_f32 v17, s76, v17
  v_mfma_f32_16x16x32_bf16 v[116:119], v[36:39], v[228:231], v[116:119]
  ds_read_b64_tr_b16 v[76:77], v13 offset:8448
  v_mul_f32 v18, s76, v18
  v_mfma_f32_16x16x32_bf16 v[132:135], v[40:43], v[228:231], v[132:135]
  ds_read_b64_tr_b16 v[78:79], v13 offset:9472
  v_mul_f32 v19, s76, v19
  v_mfma_f32_16x16x32_bf16 v[148:151], v[44:47], v[228:231], v[148:151]
  ds_read_b128 v[240:243], v14 offset:32768
  v_mul_f32 v20, s76, v20
  v_mfma_f32_16x16x32_bf16 v[164:167], v[48:51], v[228:231], v[164:167]
  ds_read_b128 v[244:247], v14 offset:33792
  v_mul_f32 v21, s76, v21
  v_mfma_f32_16x16x32_bf16 v[180:183], v[52:55], v[228:231], v[180:183]
  buffer_load_dwordx4 v5, s[32:35], s26 offen offset:2048 sc1 lds
  v_mul_f32 v22, s76, v22
  v_mfma_f32_16x16x32_bf16 v[196:199], v[56:59], v[228:231], v[196:199]
  ds_read_b64_tr_b16 v[80:81], v12 offset:8704
  v_mul_f32 v23, s76, v23
  v_mfma_f32_16x16x32_bf16 v[212:215], v[60:63], v[228:231], v[212:215]
  ds_read_b64_tr_b16 v[82:83], v12 offset:9728
  v_cvt_pk_bf16_f32 v24, v16, v17
  v_mfma_f32_16x16x32_bf16 v[104:107], v[32:35], v[232:235], v[104:107]
  ds_read_b64_tr_b16 v[84:85], v13 offset:8704
  v_cvt_pk_bf16_f32 v25, v18, v19
  v_mfma_f32_16x16x32_bf16 v[120:123], v[36:39], v[232:235], v[120:123]
  ds_read_b64_tr_b16 v[86:87], v13 offset:9728
  v_cvt_pk_bf16_f32 v26, v20, v21
  v_mfma_f32_16x16x32_bf16 v[136:139], v[40:43], v[232:235], v[136:139]
  buffer_load_dwordx4 v6, s[32:35], s26 offen offset:3072 sc1 lds
  v_cvt_pk_bf16_f32 v27, v22, v23
  v_mfma_f32_16x16x32_bf16 v[152:155], v[44:47], v[232:235], v[152:155]
  s_add_u32 s26, s26, 1024
  ds_read_b64_tr_b16 v[88:89], v12 offset:8960
  buffer_store_dwordx4 v[24:27], v2, s[40:43], s64 offen offset:2048 sc1
  v_mfma_f32_16x16x32_bf16 v[168:171], v[48:51], v[232:235], v[168:171]
  ds_read_b64_tr_b16 v[90:91], v12 offset:9984
  v_mfma_f32_16x16x32_bf16 v[184:187], v[52:55], v[232:235], v[184:187]
  ds_read_b64_tr_b16 v[92:93], v13 offset:8960
  v_mfma_f32_16x16x32_bf16 v[200:203], v[56:59], v[232:235], v[200:203]
  s_add_u32 m0, s24, 49152
  ds_read_b64_tr_b16 v[94:95], v13 offset:9984
  v_mfma_f32_16x16x32_bf16 v[216:219], v[60:63], v[232:235], v[216:219]
  buffer_load_dwordx4 v10, s[36:39], s27 offen offset:2048 lds
  v_mfma_f32_16x16x32_bf16 v[108:111], v[32:35], v[236:239], v[108:111]
  ds_read_b128 v[248:251], v14 offset:34816
  v_mfma_f32_16x16x32_bf16 v[124:127], v[36:39], v[236:239], v[124:127]
  ds_read_b128 v[252:255], v14 offset:35840
  v_mfma_f32_16x16x32_bf16 v[140:143], v[40:43], v[236:239], v[140:143]
  v_mfma_f32_16x16x32_bf16 v[156:159], v[44:47], v[236:239], v[156:159]
  v_xor_b32 v14, 0x10000, v14
  v_mfma_f32_16x16x32_bf16 v[172:175], v[48:51], v[236:239], v[172:175]
  buffer_load_dwordx4 v11, s[36:39], s27 offen offset:3072 lds
  v_mfma_f32_16x16x32_bf16 v[188:191], v[52:55], v[236:239], v[188:191]
  s_add_u32 s27, s27, 524288
  v_mfma_f32_16x16x32_bf16 v[204:207], v[56:59], v[236:239], v[204:207]
  v_mfma_f32_16x16x32_bf16 v[220:223], v[60:63], v[236:239], v[220:223]
  s_waitcnt vmcnt(17) lgkmcnt(0)
  v_mfma_f32_16x16x32_bf16 v[96:99], v[64:67], v[240:243], v[96:99]
  s_barrier
  v_accvgpr_read_b32 v16, a248
  v_accvgpr_read_b32 v17, a249
  v_mfma_f32_16x16x32_bf16 v[112:115], v[68:71], v[240:243], v[112:115]
  ds_read_b64_tr_b16 v[32:33], v12 offset:32768
  v_accvgpr_read_b32 v18, a250
  v_mfma_f32_16x16x32_bf16 v[128:131], v[72:75], v[240:243], v[128:131]
  s_add_u32 m0, s24, 32768
  ds_read_b64_tr_b16 v[34:35], v12 offset:33792
  v_accvgpr_read_b32 v19, a251
  v_mfma_f32_16x16x32_bf16 v[144:147], v[76:79], v[240:243], v[144:147]
  buffer_load_dwordx4 v3, s[32:35], s26 offen offset:0 sc1 lds
  v_accvgpr_read_b32 v20, a252
  v_mfma_f32_16x16x32_bf16 v[160:163], v[80:83], v[240:243], v[160:163]
  ds_read_b64_tr_b16 v[36:37], v13 offset:32768
  v_accvgpr_read_b32 v21, a253
  v_mfma_f32_16x16x32_bf16 v[176:179], v[84:87], v[240:243], v[176:179]
  ds_read_b64_tr_b16 v[38:39], v13 offset:33792
  v_accvgpr_read_b32 v22, a254
  v_mfma_f32_16x16x32_bf16 v[192:195], v[88:91], v[240:243], v[192:195]
  ds_read_b64_tr_b16 v[40:41], v12 offset:33024
  v_accvgpr_read_b32 v23, a255
  v_mfma_f32_16x16x32_bf16 v[208:211], v[92:95], v[240:243], v[208:211]
  ds_read_b64_tr_b16 v[42:43], v12 offset:34048
  v_mul_f32 v16, s76, v16
  v_mfma_f32_16x16x32_bf16 v[100:103], v[64:67], v[244:247], v[100:103]
  buffer_load_dwordx4 v4, s[32:35], s26 offen offset:1024 sc1 lds
  v_mul_f32 v17, s76, v17
  v_mfma_f32_16x16x32_bf16 v[116:119], v[68:71], v[244:247], v[116:119]
  ds_read_b64_tr_b16 v[44:45], v13 offset:33024
  v_mul_f32 v18, s76, v18
  v_mfma_f32_16x16x32_bf16 v[132:135], v[72:75], v[244:247], v[132:135]
  ds_read_b64_tr_b16 v[46:47], v13 offset:34048
  v_mul_f32 v19, s76, v19
  v_mfma_f32_16x16x32_bf16 v[148:151], v[76:79], v[244:247], v[148:151]
  ds_read_b128 v[224:227], v14 offset:0
  v_mul_f32 v20, s76, v20
  v_mfma_f32_16x16x32_bf16 v[164:167], v[80:83], v[244:247], v[164:167]
  ds_read_b128 v[228:231], v14 offset:1024
  v_mul_f32 v21, s76, v21
  v_mfma_f32_16x16x32_bf16 v[180:183], v[84:87], v[244:247], v[180:183]
  buffer_load_dwordx4 v5, s[32:35], s26 offen offset:2048 sc1 lds
  v_mul_f32 v22, s76, v22
  v_mfma_f32_16x16x32_bf16 v[196:199], v[88:91], v[244:247], v[196:199]
  ds_read_b64_tr_b16 v[48:49], v12 offset:33280
  v_mul_f32 v23, s76, v23
  v_mfma_f32_16x16x32_bf16 v[212:215], v[92:95], v[244:247], v[212:215]
  ds_read_b64_tr_b16 v[50:51], v12 offset:34304
  v_cvt_pk_bf16_f32 v28, v16, v17
  v_mfma_f32_16x16x32_bf16 v[104:107], v[64:67], v[248:251], v[104:107]
  ds_read_b64_tr_b16 v[52:53], v13 offset:33280
  v_cvt_pk_bf16_f32 v29, v18, v19
  v_mfma_f32_16x16x32_bf16 v[120:123], v[68:71], v[248:251], v[120:123]
  ds_read_b64_tr_b16 v[54:55], v13 offset:34304
  v_cvt_pk_bf16_f32 v30, v20, v21
  v_mfma_f32_16x16x32_bf16 v[136:139], v[72:75], v[248:251], v[136:139]
  buffer_load_dwordx4 v6, s[32:35], s26 offen offset:3072 sc1 lds
  v_cvt_pk_bf16_f32 v31, v22, v23
  v_mfma_f32_16x16x32_bf16 v[152:155], v[76:79], v[248:251], v[152:155]
  s_add_u32 s26, s26, 1024
  ds_read_b64_tr_b16 v[56:57], v12 offset:33536
  buffer_store_dwordx4 v[28:31], v2, s[40:43], s64 offen offset:3072 sc1
  v_mfma_f32_16x16x32_bf16 v[168:171], v[80:83], v[248:251], v[168:171]
  ds_read_b64_tr_b16 v[58:59], v12 offset:34560
  v_mfma_f32_16x16x32_bf16 v[184:187], v[84:87], v[248:251], v[184:187]
  ds_read_b64_tr_b16 v[60:61], v13 offset:33536
  v_mfma_f32_16x16x32_bf16 v[200:203], v[88:91], v[248:251], v[200:203]
  s_add_u32 m0, s24, 81920
  ds_read_b64_tr_b16 v[62:63], v13 offset:34560
  v_mfma_f32_16x16x32_bf16 v[216:219], v[92:95], v[248:251], v[216:219]
  buffer_load_dwordx4 v8, s[36:39], s27 offen offset:0 lds
  v_mfma_f32_16x16x32_bf16 v[108:111], v[64:67], v[252:255], v[108:111]
  ds_read_b128 v[232:235], v14 offset:2048
  v_mfma_f32_16x16x32_bf16 v[124:127], v[68:71], v[252:255], v[124:127]
  ds_read_b128 v[236:239], v14 offset:3072
  v_mfma_f32_16x16x32_bf16 v[140:143], v[72:75], v[252:255], v[140:143]
  v_mfma_f32_16x16x32_bf16 v[156:159], v[76:79], v[252:255], v[156:159]
  v_mfma_f32_16x16x32_bf16 v[172:175], v[80:83], v[252:255], v[172:175]
  buffer_load_dwordx4 v9, s[36:39], s27 offen offset:1024 lds
  v_mfma_f32_16x16x32_bf16 v[188:191], v[84:87], v[252:255], v[188:191]
  v_mfma_f32_16x16x32_bf16 v[204:207], v[88:91], v[252:255], v[204:207]
  v_mfma_f32_16x16x32_bf16 v[220:223], v[92:95], v[252:255], v[220:223]
  s_waitcnt vmcnt(17) lgkmcnt(0)
  v_mfma_f32_16x16x32_bf16 v[96:99], v[32:35], v[224:227], v[96:99]
  s_add_u32 s64, s64, 126976
  v_accvgpr_read_b32 v16, a0
  v_accvgpr_read_b32 v17, a1
  v_mfma_f32_16x16x32_bf16 v[112:115], v[36:39], v[224:227], v[112:115]
  ds_read_b64_tr_b16 v[64:65], v12 offset:40960
  v_accvgpr_read_b32 v18, a2
  v_mfma_f32_16x16x32_bf16 v[128:131], v[40:43], v[224:227], v[128:131]
  s_add_u32 m0, s24, 65536
  ds_read_b64_tr_b16 v[66:67], v12 offset:41984
  v_accvgpr_read_b32 v19, a3
  v_mfma_f32_16x16x32_bf16 v[144:147], v[44:47], v[224:227], v[144:147]
  buffer_load_dwordx4 v3, s[32:35], s26 offen offset:0 sc1 lds
  v_accvgpr_read_b32 v20, a4
  v_mfma_f32_16x16x32_bf16 v[160:163], v[48:51], v[224:227], v[160:163]
  ds_read_b64_tr_b16 v[68:69], v13 offset:40960
  v_accvgpr_read_b32 v21, a5
  v_mfma_f32_16x16x32_bf16 v[176:179], v[52:55], v[224:227], v[176:179]
  ds_read_b64_tr_b16 v[70:71], v13 offset:41984
  v_accvgpr_read_b32 v22, a6
  v_mfma_f32_16x16x32_bf16 v[192:195], v[56:59], v[224:227], v[192:195]
  ds_read_b64_tr_b16 v[72:73], v12 offset:41216
  v_accvgpr_read_b32 v23, a7
  v_mfma_f32_16x16x32_bf16 v[208:211], v[60:63], v[224:227], v[208:211]
  ds_read_b64_tr_b16 v[74:75], v12 offset:42240
  v_mul_f32 v16, s76, v16
  v_mfma_f32_16x16x32_bf16 v[100:103], v[32:35], v[228:231], v[100:103]
  buffer_load_dwordx4 v4, s[32:35], s26 offen offset:1024 sc1 lds
  v_mul_f32 v17, s76, v17
  v_mfma_f32_16x16x32_bf16 v[116:119], v[36:39], v[228:231], v[116:119]
  ds_read_b64_tr_b16 v[76:77], v13 offset:41216
  v_mul_f32 v18, s76, v18
  v_mfma_f32_16x16x32_bf16 v[132:135], v[40:43], v[228:231], v[132:135]
  ds_read_b64_tr_b16 v[78:79], v13 offset:42240
  v_mul_f32 v19, s76, v19
  v_mfma_f32_16x16x32_bf16 v[148:151], v[44:47], v[228:231], v[148:151]
  ds_read_b128 v[240:243], v14 offset:32768
  v_mul_f32 v20, s76, v20
  v_mfma_f32_16x16x32_bf16 v[164:167], v[48:51], v[228:231], v[164:167]
  ds_read_b128 v[244:247], v14 offset:33792
  v_mul_f32 v21, s76, v21
  v_mfma_f32_16x16x32_bf16 v[180:183], v[52:55], v[228:231], v[180:183]
  buffer_load_dwordx4 v5, s[32:35], s26 offen offset:2048 sc1 lds
  v_mul_f32 v22, s76, v22
  v_mfma_f32_16x16x32_bf16 v[196:199], v[56:59], v[228:231], v[196:199]
  ds_read_b64_tr_b16 v[80:81], v12 offset:41472
  v_mul_f32 v23, s76, v23
  v_mfma_f32_16x16x32_bf16 v[212:215], v[60:63], v[228:231], v[212:215]
  ds_read_b64_tr_b16 v[82:83], v12 offset:42496
  v_cvt_pk_bf16_f32 v24, v16, v17
  v_mfma_f32_16x16x32_bf16 v[104:107], v[32:35], v[232:235], v[104:107]
  ds_read_b64_tr_b16 v[84:85], v13 offset:41472
  v_cvt_pk_bf16_f32 v25, v18, v19
  v_mfma_f32_16x16x32_bf16 v[120:123], v[36:39], v[232:235], v[120:123]
  ds_read_b64_tr_b16 v[86:87], v13 offset:42496
  v_cvt_pk_bf16_f32 v26, v20, v21
  v_mfma_f32_16x16x32_bf16 v[136:139], v[40:43], v[232:235], v[136:139]
  buffer_load_dwordx4 v6, s[32:35], s26 offen offset:3072 sc1 lds
  v_cvt_pk_bf16_f32 v27, v22, v23
  v_mfma_f32_16x16x32_bf16 v[152:155], v[44:47], v[232:235], v[152:155]
  s_add_u32 s26, s26, 1024
  ds_read_b64_tr_b16 v[88:89], v12 offset:41728
  buffer_store_dwordx4 v[24:27], v2, s[40:43], s64 offen offset:0 sc1
  v_mfma_f32_16x16x32_bf16 v[168:171], v[48:51], v[232:235], v[168:171]
  ds_read_b64_tr_b16 v[90:91], v12 offset:42752
  v_mfma_f32_16x16x32_bf16 v[184:187], v[52:55], v[232:235], v[184:187]
  ds_read_b64_tr_b16 v[92:93], v13 offset:41728
  v_mfma_f32_16x16x32_bf16 v[200:203], v[56:59], v[232:235], v[200:203]
  s_add_u32 m0, s24, 81920
  ds_read_b64_tr_b16 v[94:95], v13 offset:42752
  v_mfma_f32_16x16x32_bf16 v[216:219], v[60:63], v[232:235], v[216:219]
  buffer_load_dwordx4 v10, s[36:39], s27 offen offset:2048 lds
  v_mfma_f32_16x16x32_bf16 v[108:111], v[32:35], v[236:239], v[108:111]
  ds_read_b128 v[248:251], v14 offset:34816
  v_mfma_f32_16x16x32_bf16 v[124:127], v[36:39], v[236:239], v[124:127]
  ds_read_b128 v[252:255], v14 offset:35840
  v_mfma_f32_16x16x32_bf16 v[140:143], v[40:43], v[236:239], v[140:143]
  v_mfma_f32_16x16x32_bf16 v[156:159], v[44:47], v[236:239], v[156:159]
  v_xor_b32 v14, 0x10000, v14
  v_mfma_f32_16x16x32_bf16 v[172:175], v[48:51], v[236:239], v[172:175]
  buffer_load_dwordx4 v11, s[36:39], s27 offen offset:3072 lds
  v_mfma_f32_16x16x32_bf16 v[188:191], v[52:55], v[236:239], v[188:191]
  s_add_u32 s27, s27, 524288
  v_xor_b32 v12, 0x10000, v12
  v_mfma_f32_16x16x32_bf16 v[204:207], v[56:59], v[236:239], v[204:207]
  v_xor_b32 v13, 0x10000, v13
  v_mfma_f32_16x16x32_bf16 v[220:223], v[60:63], v[236:239], v[220:223]
  s_waitcnt vmcnt(9) lgkmcnt(0)
  v_mfma_f32_16x16x32_bf16 v[96:99], v[64:67], v[240:243], v[96:99]
  s_barrier
  buffer_store_dword v12, off, s[40:43], s65 sc1
  v_accvgpr_read_b32 v16, a8
  v_mfma_f32_16x16x32_bf16 v[112:115], v[68:71], v[240:243], v[112:115]
  ds_read_b64_tr_b16 v[32:33], v12 offset:0
  v_accvgpr_read_b32 v17, a9
  v_mfma_f32_16x16x32_bf16 v[128:131], v[72:75], v[240:243], v[128:131]
  s_add_u32 m0, s24, 98304
  ds_read_b64_tr_b16 v[34:35], v12 offset:1024
  v_accvgpr_read_b32 v18, a10
  v_mfma_f32_16x16x32_bf16 v[144:147], v[76:79], v[240:243], v[144:147]
  buffer_load_dwordx4 v3, s[32:35], s26 offen offset:0 sc1 lds
  v_accvgpr_read_b32 v19, a11
  v_mfma_f32_16x16x32_bf16 v[160:163], v[80:83], v[240:243], v[160:163]
  ds_read_b64_tr_b16 v[36:37], v13 offset:0
  v_accvgpr_read_b32 v20, a12
  v_mfma_f32_16x16x32_bf16 v[176:179], v[84:87], v[240:243], v[176:179]
  ds_read_b64_tr_b16 v[38:39], v13 offset:1024
  v_accvgpr_read_b32 v21, a13
  v_mfma_f32_16x16x32_bf16 v[192:195], v[88:91], v[240:243], v[192:195]
  ds_read_b64_tr_b16 v[40:41], v12 offset:256
  v_accvgpr_read_b32 v22, a14
  v_mfma_f32_16x16x32_bf16 v[208:211], v[92:95], v[240:243], v[208:211]
  ds_read_b64_tr_b16 v[42:43], v12 offset:1280
  v_accvgpr_read_b32 v23, a15
  v_mfma_f32_16x16x32_bf16 v[100:103], v[64:67], v[244:247], v[100:103]
  buffer_load_dwordx4 v4, s[32:35], s26 offen offset:1024 sc1 lds
  v_mul_f32 v16, s76, v16
  v_mfma_f32_16x16x32_bf16 v[116:119], v[68:71], v[244:247], v[116:119]
  ds_read_b64_tr_b16 v[44:45], v13 offset:256
  v_mul_f32 v17, s76, v17
  v_mfma_f32_16x16x32_bf16 v[132:135], v[72:75], v[244:247], v[132:135]
  ds_read_b64_tr_b16 v[46:47], v13 offset:1280
  v_mul_f32 v18, s76, v18
  v_mfma_f32_16x16x32_bf16 v[148:151], v[76:79], v[244:247], v[148:151]
  ds_read_b128 v[224:227], v14 offset:0
  v_mul_f32 v19, s76, v19
  v_mfma_f32_16x16x32_bf16 v[164:167], v[80:83], v[244:247], v[164:167]
  ds_read_b128 v[228:231], v14 offset:1024
  v_mul_f32 v20, s76, v20
  v_mfma_f32_16x16x32_bf16 v[180:183], v[84:87], v[244:247], v[180:183]
  buffer_load_dwordx4 v5, s[32:35], s26 offen offset:2048 sc1 lds
  v_mul_f32 v21, s76, v21
  v_mfma_f32_16x16x32_bf16 v[196:199], v[88:91], v[244:247], v[196:199]
  ds_read_b64_tr_b16 v[48:49], v12 offset:512
  v_mul_f32 v22, s76, v22
  v_mfma_f32_16x16x32_bf16 v[212:215], v[92:95], v[244:247], v[212:215]
  ds_read_b64_tr_b16 v[50:51], v12 offset:1536
  v_mul_f32 v23, s76, v23
  v_mfma_f32_16x16x32_bf16 v[104:107], v[64:67], v[248:251], v[104:107]
  ds_read_b64_tr_b16 v[52:53], v13 offset:512
  v_cvt_pk_bf16_f32 v28, v16, v17
  v_mfma_f32_16x16x32_bf16 v[120:123], v[68:71], v[248:251], v[120:123]
  ds_read_b64_tr_b16 v[54:55], v13 offset:1536
  v_cvt_pk_bf16_f32 v29, v18, v19
  v_mfma_f32_16x16x32_bf16 v[136:139], v[72:75], v[248:251], v[136:139]
  buffer_load_dwordx4 v6, s[32:35], s26 offen offset:3072 sc1 lds
  v_cvt_pk_bf16_f32 v30, v20, v21
  v_mfma_f32_16x16x32_bf16 v[152:155], v[76:79], v[248:251], v[152:155]
  s_add_u32 s26, s26, 1024
  ds_read_b64_tr_b16 v[56:57], v12 offset:768
  v_cvt_pk_bf16_f32 v31, v22, v23
  v_mfma_f32_16x16x32_bf16 v[168:171], v[80:83], v[248:251], v[168:171]
  ds_read_b64_tr_b16 v[58:59], v12 offset:1792
  buffer_store_dwordx4 v[28:31], v2, s[40:43], s64 offen offset:1024 sc1
  v_mfma_f32_16x16x32_bf16 v[184:187], v[84:87], v[248:251], v[184:187]
  ds_read_b64_tr_b16 v[60:61], v13 offset:768
  v_mfma_f32_16x16x32_bf16 v[200:203], v[88:91], v[248:251], v[200:203]
  s_add_u32 m0, s24, 114688
  ds_read_b64_tr_b16 v[62:63], v13 offset:1792
  v_mfma_f32_16x16x32_bf16 v[216:219], v[92:95], v[248:251], v[216:219]
  buffer_load_dwordx4 v8, s[36:39], s27 offen offset:0 lds
  v_mfma_f32_16x16x32_bf16 v[108:111], v[64:67], v[252:255], v[108:111]
  ds_read_b128 v[232:235], v14 offset:2048
  v_mfma_f32_16x16x32_bf16 v[124:127], v[68:71], v[252:255], v[124:127]
  ds_read_b128 v[236:239], v14 offset:3072
  v_mfma_f32_16x16x32_bf16 v[140:143], v[72:75], v[252:255], v[140:143]
  v_mfma_f32_16x16x32_bf16 v[156:159], v[76:79], v[252:255], v[156:159]
  v_mfma_f32_16x16x32_bf16 v[172:175], v[80:83], v[252:255], v[172:175]
  buffer_load_dwordx4 v9, s[36:39], s27 offen offset:1024 lds
  v_mfma_f32_16x16x32_bf16 v[188:191], v[84:87], v[252:255], v[188:191]
  v_mfma_f32_16x16x32_bf16 v[204:207], v[88:91], v[252:255], v[204:207]
  v_mfma_f32_16x16x32_bf16 v[220:223], v[92:95], v[252:255], v[220:223]
  s_waitcnt vmcnt(18) lgkmcnt(0)
  v_mfma_f32_16x16x32_bf16 v[96:99], v[32:35], v[224:227], v[96:99]
  v_accvgpr_read_b32 v16, a16
  v_accvgpr_read_b32 v17, a17
  v_mfma_f32_16x16x32_bf16 v[112:115], v[36:39], v[224:227], v[112:115]
  ds_read_b64_tr_b16 v[64:65], v12 offset:8192
  v_accvgpr_read_b32 v18, a18
  v_mfma_f32_16x16x32_bf16 v[128:131], v[40:43], v[224:227], v[128:131]
  s_add_u32 m0, s24, 0
  ds_read_b64_tr_b16 v[66:67], v12 offset:9216
  v_accvgpr_read_b32 v19, a19
  v_mfma_f32_16x16x32_bf16 v[144:147], v[44:47], v[224:227], v[144:147]
  buffer_load_dwordx4 v3, s[32:35], s26 offen offset:0 sc1 lds
  v_accvgpr_read_b32 v20, a20
  v_mfma_f32_16x16x32_bf16 v[160:163], v[48:51], v[224:227], v[160:163]
  ds_read_b64_tr_b16 v[68:69], v13 offset:8192
  v_accvgpr_read_b32 v21, a21
  v_mfma_f32_16x16x32_bf16 v[176:179], v[52:55], v[224:227], v[176:179]
  ds_read_b64_tr_b16 v[70:71], v13 offset:9216
  v_accvgpr_read_b32 v22, a22
  v_mfma_f32_16x16x32_bf16 v[192:195], v[56:59], v[224:227], v[192:195]
  ds_read_b64_tr_b16 v[72:73], v12 offset:8448
  v_accvgpr_read_b32 v23, a23
  v_mfma_f32_16x16x32_bf16 v[208:211], v[60:63], v[224:227], v[208:211]
  ds_read_b64_tr_b16 v[74:75], v12 offset:9472
  v_mul_f32 v16, s76, v16
  v_mfma_f32_16x16x32_bf16 v[100:103], v[32:35], v[228:231], v[100:103]
  buffer_load_dwordx4 v4, s[32:35], s26 offen offset:1024 sc1 lds
  v_mul_f32 v17, s76, v17
  v_mfma_f32_16x16x32_bf16 v[116:119], v[36:39], v[228:231], v[116:119]
  ds_read_b64_tr_b16 v[76:77], v13 offset:8448
  v_mul_f32 v18, s76, v18
  v_mfma_f32_16x16x32_bf16 v[132:135], v[40:43], v[228:231], v[132:135]
  ds_read_b64_tr_b16 v[78:79], v13 offset:9472
  v_mul_f32 v19, s76, v19
  v_mfma_f32_16x16x32_bf16 v[148:151], v[44:47], v[228:231], v[148:151]
  ds_read_b128 v[240:243], v14 offset:32768
  v_mul_f32 v20, s76, v20
  v_mfma_f32_16x16x32_bf16 v[164:167], v[48:51], v[228:231], v[164:167]
  ds_read_b128 v[244:247], v14 offset:33792
  v_mul_f32 v21, s76, v21
  v_mfma_f32_16x16x32_bf16 v[180:183], v[52:55], v[228:231], v[180:183]
  buffer_load_dwordx4 v5, s[32:35], s26 offen offset:2048 sc1 lds
  v_mul_f32 v22, s76, v22
  v_mfma_f32_16x16x32_bf16 v[196:199], v[56:59], v[228:231], v[196:199]
  ds_read_b64_tr_b16 v[80:81], v12 offset:8704
  v_mul_f32 v23, s76, v23
  v_mfma_f32_16x16x32_bf16 v[212:215], v[60:63], v[228:231], v[212:215]
  ds_read_b64_tr_b16 v[82:83], v12 offset:9728
  v_cvt_pk_bf16_f32 v24, v16, v17
  v_mfma_f32_16x16x32_bf16 v[104:107], v[32:35], v[232:235], v[104:107]
  ds_read_b64_tr_b16 v[84:85], v13 offset:8704
  v_cvt_pk_bf16_f32 v25, v18, v19
  v_mfma_f32_16x16x32_bf16 v[120:123], v[36:39], v[232:235], v[120:123]
  ds_read_b64_tr_b16 v[86:87], v13 offset:9728
  v_cvt_pk_bf16_f32 v26, v20, v21
  v_mfma_f32_16x16x32_bf16 v[136:139], v[40:43], v[232:235], v[136:139]
  buffer_load_dwordx4 v6, s[32:35], s26 offen offset:3072 sc1 lds
  v_cvt_pk_bf16_f32 v27, v22, v23
  v_mfma_f32_16x16x32_bf16 v[152:155], v[44:47], v[232:235], v[152:155]
  s_add_u32 s26, s26, 1024
  ds_read_b64_tr_b16 v[88:89], v12 offset:8960
  buffer_store_dwordx4 v[24:27], v2, s[40:43], s64 offen offset:2048 sc1
  v_mfma_f32_16x16x32_bf16 v[168:171], v[48:51], v[232:235], v[168:171]
  ds_read_b64_tr_b16 v[90:91], v12 offset:9984
  v_mfma_f32_16x16x32_bf16 v[184:187], v[52:55], v[232:235], v[184:187]
  ds_read_b64_tr_b16 v[92:93], v13 offset:8960
  v_mfma_f32_16x16x32_bf16 v[200:203], v[56:59], v[232:235], v[200:203]
  s_add_u32 m0, s24, 114688
  ds_read_b64_tr_b16 v[94:95], v13 offset:9984
  v_mfma_f32_16x16x32_bf16 v[216:219], v[60:63], v[232:235], v[216:219]
  buffer_load_dwordx4 v10, s[36:39], s27 offen offset:2048 lds
  v_mfma_f32_16x16x32_bf16 v[108:111], v[32:35], v[236:239], v[108:111]
  ds_read_b128 v[248:251], v14 offset:34816
  v_mfma_f32_16x16x32_bf16 v[124:127], v[36:39], v[236:239], v[124:127]
  ds_read_b128 v[252:255], v14 offset:35840
  v_mfma_f32_16x16x32_bf16 v[140:143], v[40:43], v[236:239], v[140:143]
  v_mfma_f32_16x16x32_bf16 v[156:159], v[44:47], v[236:239], v[156:159]
  v_xor_b32 v14, 0x10000, v14
  v_mfma_f32_16x16x32_bf16 v[172:175], v[48:51], v[236:239], v[172:175]
  buffer_load_dwordx4 v11, s[36:39], s27 offen offset:3072 lds
  v_mfma_f32_16x16x32_bf16 v[188:191], v[52:55], v[236:239], v[188:191]
  s_add_u32 s27, s27, 524288
  v_mfma_f32_16x16x32_bf16 v[204:207], v[56:59], v[236:239], v[204:207]
  v_mfma_f32_16x16x32_bf16 v[220:223], v[60:63], v[236:239], v[220:223]
  s_waitcnt vmcnt(18) lgkmcnt(0)
  v_mfma_f32_16x16x32_bf16 v[96:99], v[64:67], v[240:243], v[96:99]
  s_barrier
  v_accvgpr_read_b32 v16, a24
  v_accvgpr_read_b32 v17, a25
  v_mfma_f32_16x16x32_bf16 v[112:115], v[68:71], v[240:243], v[112:115]
  ds_read_b64_tr_b16 v[32:33], v12 offset:32768
  v_accvgpr_read_b32 v18, a26
  v_mfma_f32_16x16x32_bf16 v[128:131], v[72:75], v[240:243], v[128:131]
  s_add_u32 m0, s24, 32768
  ds_read_b64_tr_b16 v[34:35], v12 offset:33792
  v_accvgpr_read_b32 v19, a27
  v_mfma_f32_16x16x32_bf16 v[144:147], v[76:79], v[240:243], v[144:147]
  buffer_load_dwordx4 v3, s[32:35], s26 offen offset:0 sc1 lds
  v_accvgpr_read_b32 v20, a28
  v_mfma_f32_16x16x32_bf16 v[160:163], v[80:83], v[240:243], v[160:163]
  ds_read_b64_tr_b16 v[36:37], v13 offset:32768
  v_accvgpr_read_b32 v21, a29
  v_mfma_f32_16x16x32_bf16 v[176:179], v[84:87], v[240:243], v[176:179]
  ds_read_b64_tr_b16 v[38:39], v13 offset:33792
  v_accvgpr_read_b32 v22, a30
  v_mfma_f32_16x16x32_bf16 v[192:195], v[88:91], v[240:243], v[192:195]
  ds_read_b64_tr_b16 v[40:41], v12 offset:33024
  v_accvgpr_read_b32 v23, a31
  v_mfma_f32_16x16x32_bf16 v[208:211], v[92:95], v[240:243], v[208:211]
  ds_read_b64_tr_b16 v[42:43], v12 offset:34048
  v_mul_f32 v16, s76, v16
  v_mfma_f32_16x16x32_bf16 v[100:103], v[64:67], v[244:247], v[100:103]
  buffer_load_dwordx4 v4, s[32:35], s26 offen offset:1024 sc1 lds
  v_mul_f32 v17, s76, v17
  v_mfma_f32_16x16x32_bf16 v[116:119], v[68:71], v[244:247], v[116:119]
  ds_read_b64_tr_b16 v[44:45], v13 offset:33024
  v_mul_f32 v18, s76, v18
  v_mfma_f32_16x16x32_bf16 v[132:135], v[72:75], v[244:247], v[132:135]
  ds_read_b64_tr_b16 v[46:47], v13 offset:34048
  v_mul_f32 v19, s76, v19
  v_mfma_f32_16x16x32_bf16 v[148:151], v[76:79], v[244:247], v[148:151]
  ds_read_b128 v[224:227], v14 offset:0
  v_mul_f32 v20, s76, v20
  v_mfma_f32_16x16x32_bf16 v[164:167], v[80:83], v[244:247], v[164:167]
  ds_read_b128 v[228:231], v14 offset:1024
  v_mul_f32 v21, s76, v21
  v_mfma_f32_16x16x32_bf16 v[180:183], v[84:87], v[244:247], v[180:183]
  buffer_load_dwordx4 v5, s[32:35], s26 offen offset:2048 sc1 lds
  v_mul_f32 v22, s76, v22
  v_mfma_f32_16x16x32_bf16 v[196:199], v[88:91], v[244:247], v[196:199]
  ds_read_b64_tr_b16 v[48:49], v12 offset:33280
  v_mul_f32 v23, s76, v23
  v_mfma_f32_16x16x32_bf16 v[212:215], v[92:95], v[244:247], v[212:215]
  ds_read_b64_tr_b16 v[50:51], v12 offset:34304
  v_cvt_pk_bf16_f32 v28, v16, v17
  v_mfma_f32_16x16x32_bf16 v[104:107], v[64:67], v[248:251], v[104:107]
  ds_read_b64_tr_b16 v[52:53], v13 offset:33280
  v_cvt_pk_bf16_f32 v29, v18, v19
  v_mfma_f32_16x16x32_bf16 v[120:123], v[68:71], v[248:251], v[120:123]
  ds_read_b64_tr_b16 v[54:55], v13 offset:34304
  v_cvt_pk_bf16_f32 v30, v20, v21
  v_mfma_f32_16x16x32_bf16 v[136:139], v[72:75], v[248:251], v[136:139]
  buffer_load_dwordx4 v6, s[32:35], s26 offen offset:3072 sc1 lds
  v_cvt_pk_bf16_f32 v31, v22, v23
  v_mfma_f32_16x16x32_bf16 v[152:155], v[76:79], v[248:251], v[152:155]
  s_add_u32 s26, s26, 1024
  ds_read_b64_tr_b16 v[56:57], v12 offset:33536
  buffer_store_dwordx4 v[28:31], v2, s[40:43], s64 offen offset:3072 sc1
  v_mfma_f32_16x16x32_bf16 v[168:171], v[80:83], v[248:251], v[168:171]
  ds_read_b64_tr_b16 v[58:59], v12 offset:34560
  v_mfma_f32_16x16x32_bf16 v[184:187], v[84:87], v[248:251], v[184:187]
  ds_read_b64_tr_b16 v[60:61], v13 offset:33536
  v_mfma_f32_16x16x32_bf16 v[200:203], v[88:91], v[248:251], v[200:203]
  s_add_u32 m0, s24, 16384
  ds_read_b64_tr_b16 v[62:63], v13 offset:34560
  v_mfma_f32_16x16x32_bf16 v[216:219], v[92:95], v[248:251], v[216:219]
  buffer_load_dwordx4 v8, s[36:39], s27 offen offset:0 lds
  v_mfma_f32_16x16x32_bf16 v[108:111], v[64:67], v[252:255], v[108:111]
  ds_read_b128 v[232:235], v14 offset:2048
  v_mfma_f32_16x16x32_bf16 v[124:127], v[68:71], v[252:255], v[124:127]
  ds_read_b128 v[236:239], v14 offset:3072
  v_mfma_f32_16x16x32_bf16 v[140:143], v[72:75], v[252:255], v[140:143]
  v_mfma_f32_16x16x32_bf16 v[156:159], v[76:79], v[252:255], v[156:159]
  v_mfma_f32_16x16x32_bf16 v[172:175], v[80:83], v[252:255], v[172:175]
  buffer_load_dwordx4 v9, s[36:39], s27 offen offset:1024 lds
  v_mfma_f32_16x16x32_bf16 v[188:191], v[84:87], v[252:255], v[188:191]
  v_mfma_f32_16x16x32_bf16 v[204:207], v[88:91], v[252:255], v[204:207]
  v_mfma_f32_16x16x32_bf16 v[220:223], v[92:95], v[252:255], v[220:223]
  s_waitcnt vmcnt(17) lgkmcnt(0)
  v_mfma_f32_16x16x32_bf16 v[96:99], v[32:35], v[224:227], v[96:99]
  s_add_u32 s64, s64, 4096
  v_accvgpr_read_b32 v16, a32
  v_accvgpr_read_b32 v17, a33
  v_mfma_f32_16x16x32_bf16 v[112:115], v[36:39], v[224:227], v[112:115]
  ds_read_b64_tr_b16 v[64:65], v12 offset:40960
  v_accvgpr_read_b32 v18, a34
  v_mfma_f32_16x16x32_bf16 v[128:131], v[40:43], v[224:227], v[128:131]
  s_add_u32 m0, s24, 65536
  ds_read_b64_tr_b16 v[66:67], v12 offset:41984
  v_accvgpr_read_b32 v19, a35
  v_mfma_f32_16x16x32_bf16 v[144:147], v[44:47], v[224:227], v[144:147]
  buffer_load_dwordx4 v3, s[32:35], s26 offen offset:0 sc1 lds
  v_accvgpr_read_b32 v20, a36
  v_mfma_f32_16x16x32_bf16 v[160:163], v[48:51], v[224:227], v[160:163]
  ds_read_b64_tr_b16 v[68:69], v13 offset:40960
  v_accvgpr_read_b32 v21, a37
  v_mfma_f32_16x16x32_bf16 v[176:179], v[52:55], v[224:227], v[176:179]
  ds_read_b64_tr_b16 v[70:71], v13 offset:41984
  v_accvgpr_read_b32 v22, a38
  v_mfma_f32_16x16x32_bf16 v[192:195], v[56:59], v[224:227], v[192:195]
  ds_read_b64_tr_b16 v[72:73], v12 offset:41216
  v_accvgpr_read_b32 v23, a39
  v_mfma_f32_16x16x32_bf16 v[208:211], v[60:63], v[224:227], v[208:211]
  ds_read_b64_tr_b16 v[74:75], v12 offset:42240
  v_mul_f32 v16, s76, v16
  v_mfma_f32_16x16x32_bf16 v[100:103], v[32:35], v[228:231], v[100:103]
  buffer_load_dwordx4 v4, s[32:35], s26 offen offset:1024 sc1 lds
  v_mul_f32 v17, s76, v17
  v_mfma_f32_16x16x32_bf16 v[116:119], v[36:39], v[228:231], v[116:119]
  ds_read_b64_tr_b16 v[76:77], v13 offset:41216
  v_mul_f32 v18, s76, v18
  v_mfma_f32_16x16x32_bf16 v[132:135], v[40:43], v[228:231], v[132:135]
  ds_read_b64_tr_b16 v[78:79], v13 offset:42240
  v_mul_f32 v19, s76, v19
  v_mfma_f32_16x16x32_bf16 v[148:151], v[44:47], v[228:231], v[148:151]
  ds_read_b128 v[240:243], v14 offset:32768
  v_mul_f32 v20, s76, v20
  v_mfma_f32_16x16x32_bf16 v[164:167], v[48:51], v[228:231], v[164:167]
  ds_read_b128 v[244:247], v14 offset:33792
  v_mul_f32 v21, s76, v21
  v_mfma_f32_16x16x32_bf16 v[180:183], v[52:55], v[228:231], v[180:183]
  buffer_load_dwordx4 v5, s[32:35], s26 offen offset:2048 sc1 lds
  v_mul_f32 v22, s76, v22
  v_mfma_f32_16x16x32_bf16 v[196:199], v[56:59], v[228:231], v[196:199]
  ds_read_b64_tr_b16 v[80:81], v12 offset:41472
  v_mul_f32 v23, s76, v23
  v_mfma_f32_16x16x32_bf16 v[212:215], v[60:63], v[228:231], v[212:215]
  ds_read_b64_tr_b16 v[82:83], v12 offset:42496
  v_cvt_pk_bf16_f32 v24, v16, v17
  v_mfma_f32_16x16x32_bf16 v[104:107], v[32:35], v[232:235], v[104:107]
  ds_read_b64_tr_b16 v[84:85], v13 offset:41472
  v_cvt_pk_bf16_f32 v25, v18, v19
  v_mfma_f32_16x16x32_bf16 v[120:123], v[36:39], v[232:235], v[120:123]
  ds_read_b64_tr_b16 v[86:87], v13 offset:42496
  v_cvt_pk_bf16_f32 v26, v20, v21
  v_mfma_f32_16x16x32_bf16 v[136:139], v[40:43], v[232:235], v[136:139]
  buffer_load_dwordx4 v6, s[32:35], s26 offen offset:3072 sc1 lds
  v_cvt_pk_bf16_f32 v27, v22, v23
  v_mfma_f32_16x16x32_bf16 v[152:155], v[44:47], v[232:235], v[152:155]
  s_add_u32 s26, s26, 1024
  ds_read_b64_tr_b16 v[88:89], v12 offset:41728
  buffer_store_dwordx4 v[24:27], v2, s[40:43], s64 offen offset:0 sc1
  v_mfma_f32_16x16x32_bf16 v[168:171], v[48:51], v[232:235], v[168:171]
  ds_read_b64_tr_b16 v[90:91], v12 offset:42752
  v_mfma_f32_16x16x32_bf16 v[184:187], v[52:55], v[232:235], v[184:187]
  ds_read_b64_tr_b16 v[92:93], v13 offset:41728
  v_mfma_f32_16x16x32_bf16 v[200:203], v[56:59], v[232:235], v[200:203]
  s_add_u32 m0, s24, 16384
  ds_read_b64_tr_b16 v[94:95], v13 offset:42752
  v_mfma_f32_16x16x32_bf16 v[216:219], v[60:63], v[232:235], v[216:219]
  buffer_load_dwordx4 v10, s[36:39], s27 offen offset:2048 lds
  v_mfma_f32_16x16x32_bf16 v[108:111], v[32:35], v[236:239], v[108:111]
  ds_read_b128 v[248:251], v14 offset:34816
  v_mfma_f32_16x16x32_bf16 v[124:127], v[36:39], v[236:239], v[124:127]
  ds_read_b128 v[252:255], v14 offset:35840
  v_mfma_f32_16x16x32_bf16 v[140:143], v[40:43], v[236:239], v[140:143]
  v_mfma_f32_16x16x32_bf16 v[156:159], v[44:47], v[236:239], v[156:159]
  v_xor_b32 v14, 0x10000, v14
  v_mfma_f32_16x16x32_bf16 v[172:175], v[48:51], v[236:239], v[172:175]
  buffer_load_dwordx4 v11, s[36:39], s27 offen offset:3072 lds
  v_mfma_f32_16x16x32_bf16 v[188:191], v[52:55], v[236:239], v[188:191]
  s_add_u32 s27, s27, 524288
  v_xor_b32 v12, 0x10000, v12
  v_mfma_f32_16x16x32_bf16 v[204:207], v[56:59], v[236:239], v[204:207]
  v_xor_b32 v13, 0x10000, v13
  v_mfma_f32_16x16x32_bf16 v[220:223], v[60:63], v[236:239], v[220:223]
  s_waitcnt vmcnt(17) lgkmcnt(0)
  v_mfma_f32_16x16x32_bf16 v[96:99], v[64:67], v[240:243], v[96:99]
  s_barrier
  v_accvgpr_read_b32 v16, a40
  v_accvgpr_read_b32 v17, a41
  v_mfma_f32_16x16x32_bf16 v[112:115], v[68:71], v[240:243], v[112:115]
  ds_read_b64_tr_b16 v[32:33], v12 offset:0
  v_accvgpr_read_b32 v18, a42
  v_mfma_f32_16x16x32_bf16 v[128:131], v[72:75], v[240:243], v[128:131]
  s_add_u32 m0, s24, 98304
  ds_read_b64_tr_b16 v[34:35], v12 offset:1024
  v_accvgpr_read_b32 v19, a43
  v_mfma_f32_16x16x32_bf16 v[144:147], v[76:79], v[240:243], v[144:147]
  buffer_load_dwordx4 v3, s[32:35], s26 offen offset:0 sc1 lds
  v_accvgpr_read_b32 v20, a44
  v_mfma_f32_16x16x32_bf16 v[160:163], v[80:83], v[240:243], v[160:163]
  ds_read_b64_tr_b16 v[36:37], v13 offset:0
  v_accvgpr_read_b32 v21, a45
  v_mfma_f32_16x16x32_bf16 v[176:179], v[84:87], v[240:243], v[176:179]
  ds_read_b64_tr_b16 v[38:39], v13 offset:1024
  v_accvgpr_read_b32 v22, a46
  v_mfma_f32_16x16x32_bf16 v[192:195], v[88:91], v[240:243], v[192:195]
  ds_read_b64_tr_b16 v[40:41], v12 offset:256
  v_accvgpr_read_b32 v23, a47
  v_mfma_f32_16x16x32_bf16 v[208:211], v[92:95], v[240:243], v[208:211]
  ds_read_b64_tr_b16 v[42:43], v12 offset:1280
  v_mul_f32 v16, s76, v16
  v_mfma_f32_16x16x32_bf16 v[100:103], v[64:67], v[244:247], v[100:103]
  buffer_load_dwordx4 v4, s[32:35], s26 offen offset:1024 sc1 lds
  v_mul_f32 v17, s76, v17
  v_mfma_f32_16x16x32_bf16 v[116:119], v[68:71], v[244:247], v[116:119]
  ds_read_b64_tr_b16 v[44:45], v13 offset:256
  v_mul_f32 v18, s76, v18
  v_mfma_f32_16x16x32_bf16 v[132:135], v[72:75], v[244:247], v[132:135]
  ds_read_b64_tr_b16 v[46:47], v13 offset:1280
  v_mul_f32 v19, s76, v19
  v_mfma_f32_16x16x32_bf16 v[148:151], v[76:79], v[244:247], v[148:151]
  ds_read_b128 v[224:227], v14 offset:0
  v_mul_f32 v20, s76, v20
  v_mfma_f32_16x16x32_bf16 v[164:167], v[80:83], v[244:247], v[164:167]
  ds_read_b128 v[228:231], v14 offset:1024
  v_mul_f32 v21, s76, v21
  v_mfma_f32_16x16x32_bf16 v[180:183], v[84:87], v[244:247], v[180:183]
  buffer_load_dwordx4 v5, s[32:35], s26 offen offset:2048 sc1 lds
  v_mul_f32 v22, s76, v22
  v_mfma_f32_16x16x32_bf16 v[196:199], v[88:91], v[244:247], v[196:199]
  ds_read_b64_tr_b16 v[48:49], v12 offset:512
  v_mul_f32 v23, s76, v23
  v_mfma_f32_16x16x32_bf16 v[212:215], v[92:95], v[244:247], v[212:215]
  ds_read_b64_tr_b16 v[50:51], v12 offset:1536
  v_cvt_pk_bf16_f32 v28, v16, v17
  v_mfma_f32_16x16x32_bf16 v[104:107], v[64:67], v[248:251], v[104:107]
  ds_read_b64_tr_b16 v[52:53], v13 offset:512
  v_cvt_pk_bf16_f32 v29, v18, v19
  v_mfma_f32_16x16x32_bf16 v[120:123], v[68:71], v[248:251], v[120:123]
  ds_read_b64_tr_b16 v[54:55], v13 offset:1536
  v_cvt_pk_bf16_f32 v30, v20, v21
  v_mfma_f32_16x16x32_bf16 v[136:139], v[72:75], v[248:251], v[136:139]
  buffer_load_dwordx4 v6, s[32:35], s26 offen offset:3072 sc1 lds
  v_cvt_pk_bf16_f32 v31, v22, v23
  v_mfma_f32_16x16x32_bf16 v[152:155], v[76:79], v[248:251], v[152:155]
  s_add_u32 s26, s26, 1024
  ds_read_b64_tr_b16 v[56:57], v12 offset:768
  buffer_store_dwordx4 v[28:31], v2, s[40:43], s64 offen offset:1024 sc1
  v_mfma_f32_16x16x32_bf16 v[168:171], v[80:83], v[248:251], v[168:171]
  ds_read_b64_tr_b16 v[58:59], v12 offset:1792
  v_mfma_f32_16x16x32_bf16 v[184:187], v[84:87], v[248:251], v[184:187]
  ds_read_b64_tr_b16 v[60:61], v13 offset:768
  v_mfma_f32_16x16x32_bf16 v[200:203], v[88:91], v[248:251], v[200:203]
  s_add_u32 m0, s24, 49152
  ds_read_b64_tr_b16 v[62:63], v13 offset:1792
  v_mfma_f32_16x16x32_bf16 v[216:219], v[92:95], v[248:251], v[216:219]
  buffer_load_dwordx4 v8, s[36:39], s27 offen offset:0 lds
  v_mfma_f32_16x16x32_bf16 v[108:111], v[64:67], v[252:255], v[108:111]
  ds_read_b128 v[232:235], v14 offset:2048
  v_mfma_f32_16x16x32_bf16 v[124:127], v[68:71], v[252:255], v[124:127]
  ds_read_b128 v[236:239], v14 offset:3072
  v_mfma_f32_16x16x32_bf16 v[140:143], v[72:75], v[252:255], v[140:143]
  v_mfma_f32_16x16x32_bf16 v[156:159], v[76:79], v[252:255], v[156:159]
  v_mfma_f32_16x16x32_bf16 v[172:175], v[80:83], v[252:255], v[172:175]
  buffer_load_dwordx4 v9, s[36:39], s27 offen offset:1024 lds
  v_mfma_f32_16x16x32_bf16 v[188:191], v[84:87], v[252:255], v[188:191]
  v_mfma_f32_16x16x32_bf16 v[204:207], v[88:91], v[252:255], v[204:207]
  v_mfma_f32_16x16x32_bf16 v[220:223], v[92:95], v[252:255], v[220:223]
  s_waitcnt vmcnt(17) lgkmcnt(0)
  v_mfma_f32_16x16x32_bf16 v[96:99], v[32:35], v[224:227], v[96:99]
  v_accvgpr_read_b32 v16, a48
  v_accvgpr_read_b32 v17, a49
  v_accvgpr_read_b32 v18, a50
  v_mfma_f32_16x16x32_bf16 v[112:115], v[36:39], v[224:227], v[112:115]
  ds_read_b64_tr_b16 v[64:65], v12 offset:8192
  v_accvgpr_read_b32 v19, a51
  v_mfma_f32_16x16x32_bf16 v[128:131], v[40:43], v[224:227], v[128:131]
  s_add_u32 m0, s24, 0
  ds_read_b64_tr_b16 v[66:67], v12 offset:9216
  v_accvgpr_read_b32 v20, a52
  v_mfma_f32_16x16x32_bf16 v[144:147], v[44:47], v[224:227], v[144:147]
  buffer_load_dwordx4 v3, s[32:35], s26 offen offset:0 sc1 lds
  v_accvgpr_read_b32 v21, a53
  v_accvgpr_read_b32 v22, a54
  v_mfma_f32_16x16x32_bf16 v[160:163], v[48:51], v[224:227], v[160:163]
  ds_read_b64_tr_b16 v[68:69], v13 offset:8192
  v_accvgpr_read_b32 v23, a55
  v_mfma_f32_16x16x32_bf16 v[176:179], v[52:55], v[224:227], v[176:179]
  ds_read_b64_tr_b16 v[70:71], v13 offset:9216
  v_mul_f32 v16, s76, v16
  v_mfma_f32_16x16x32_bf16 v[192:195], v[56:59], v[224:227], v[192:195]
  ds_read_b64_tr_b16 v[72:73], v12 offset:8448
  v_mul_f32 v17, s76, v17
  v_mfma_f32_16x16x32_bf16 v[208:211], v[60:63], v[224:227], v[208:211]
  ds_read_b64_tr_b16 v[74:75], v12 offset:9472
  v_mul_f32 v18, s76, v18
  v_mul_f32 v19, s76, v19
  v_mfma_f32_16x16x32_bf16 v[100:103], v[32:35], v[228:231], v[100:103]
  buffer_load_dwordx4 v4, s[32:35], s26 offen offset:1024 sc1 lds
  v_mul_f32 v20, s76, v20
  v_mfma_f32_16x16x32_bf16 v[116:119], v[36:39], v[228:231], v[116:119]
  ds_read_b64_tr_b16 v[76:77], v13 offset:8448
  v_mul_f32 v21, s76, v21
  v_mfma_f32_16x16x32_bf16 v[132:135], v[40:43], v[228:231], v[132:135]
  ds_read_b64_tr_b16 v[78:79], v13 offset:9472
  v_mul_f32 v22, s76, v22
  v_mfma_f32_16x16x32_bf16 v[148:151], v[44:47], v[228:231], v[148:151]
  ds_read_b128 v[240:243], v14 offset:32768
  v_mul_f32 v23, s76, v23
  v_cvt_pk_bf16_f32 v24, v16, v17
  v_mfma_f32_16x16x32_bf16 v[164:167], v[48:51], v[228:231], v[164:167]
  ds_read_b128 v[244:247], v14 offset:33792
  v_cvt_pk_bf16_f32 v25, v18, v19
  v_mfma_f32_16x16x32_bf16 v[180:183], v[52:55], v[228:231], v[180:183]
  buffer_load_dwordx4 v5, s[32:35], s26 offen offset:2048 sc1 lds
  v_cvt_pk_bf16_f32 v26, v20, v21
  v_mfma_f32_16x16x32_bf16 v[196:199], v[56:59], v[228:231], v[196:199]
  ds_read_b64_tr_b16 v[80:81], v12 offset:8704
  v_cvt_pk_bf16_f32 v27, v22, v23
  v_mfma_f32_16x16x32_bf16 v[212:215], v[60:63], v[228:231], v[212:215]
  ds_read_b64_tr_b16 v[82:83], v12 offset:9728
  buffer_store_dwordx4 v[24:27], v2, s[40:43], s64 offen offset:2048 sc1
  v_accvgpr_read_b32 v16, a56
  v_mfma_f32_16x16x32_bf16 v[104:107], v[32:35], v[232:235], v[104:107]
  ds_read_b64_tr_b16 v[84:85], v13 offset:8704
  v_accvgpr_read_b32 v17, a57
  v_mfma_f32_16x16x32_bf16 v[120:123], v[36:39], v[232:235], v[120:123]
  ds_read_b64_tr_b16 v[86:87], v13 offset:9728
  v_accvgpr_read_b32 v18, a58
  v_mfma_f32_16x16x32_bf16 v[136:139], v[40:43], v[232:235], v[136:139]
  buffer_load_dwordx4 v6, s[32:35], s26 offen offset:3072 sc1 lds
  v_accvgpr_read_b32 v19, a59
  v_accvgpr_read_b32 v20, a60
  v_mfma_f32_16x16x32_bf16 v[152:155], v[44:47], v[232:235], v[152:155]
  s_add_u32 s26, s26, 1024
  ds_read_b64_tr_b16 v[88:89], v12 offset:8960
  v_accvgpr_read_b32 v21, a61
  v_mfma_f32_16x16x32_bf16 v[168:171], v[48:51], v[232:235], v[168:171]
  ds_read_b64_tr_b16 v[90:91], v12 offset:9984
  v_accvgpr_read_b32 v22, a62
  v_mfma_f32_16x16x32_bf16 v[184:187], v[52:55], v[232:235], v[184:187]
  ds_read_b64_tr_b16 v[92:93], v13 offset:8960
  v_accvgpr_read_b32 v23, a63
  v_mfma_f32_16x16x32_bf16 v[200:203], v[56:59], v[232:235], v[200:203]
  s_add_u32 m0, s24, 49152
  ds_read_b64_tr_b16 v[94:95], v13 offset:9984
  v_mul_f32 v16, s76, v16
  v_mul_f32 v17, s76, v17
  v_mfma_f32_16x16x32_bf16 v[216:219], v[60:63], v[232:235], v[216:219]
  buffer_load_dwordx4 v10, s[36:39], s27 offen offset:2048 lds
  v_mul_f32 v18, s76, v18
  v_mfma_f32_16x16x32_bf16 v[108:111], v[32:35], v[236:239], v[108:111]
  ds_read_b128 v[248:251], v14 offset:34816
  v_mul_f32 v19, s76, v19
  v_mfma_f32_16x16x32_bf16 v[124:127], v[36:39], v[236:239], v[124:127]
  ds_read_b128 v[252:255], v14 offset:35840
  v_mul_f32 v20, s76, v20
  v_mfma_f32_16x16x32_bf16 v[140:143], v[40:43], v[236:239], v[140:143]
  v_mul_f32 v21, s76, v21
  v_mul_f32 v22, s76, v22
  v_mul_f32 v23, s76, v23
  v_mfma_f32_16x16x32_bf16 v[156:159], v[44:47], v[236:239], v[156:159]
  v_xor_b32 v14, 0x10000, v14
  v_cvt_pk_bf16_f32 v28, v16, v17
  v_mfma_f32_16x16x32_bf16 v[172:175], v[48:51], v[236:239], v[172:175]
  buffer_load_dwordx4 v11, s[36:39], s27 offen offset:3072 lds
  v_cvt_pk_bf16_f32 v29, v18, v19
  v_mfma_f32_16x16x32_bf16 v[188:191], v[52:55], v[236:239], v[188:191]
  s_add_u32 s27, s27, 524288
  v_cvt_pk_bf16_f32 v30, v20, v21
  v_cvt_pk_bf16_f32 v31, v22, v23
  v_mfma_f32_16x16x32_bf16 v[204:207], v[56:59], v[236:239], v[204:207]
  buffer_store_dwordx4 v[28:31], v2, s[40:43], s64 offen offset:3072 sc1
  v_mfma_f32_16x16x32_bf16 v[220:223], v[60:63], v[236:239], v[220:223]
  s_waitcnt vmcnt(18) lgkmcnt(0)
  v_mfma_f32_16x16x32_bf16 v[96:99], v[64:67], v[240:243], v[96:99]
  s_barrier
  v_accvgpr_read_b32 v16, a64
  v_accvgpr_read_b32 v17, a65
  v_accvgpr_read_b32 v18, a66
  v_mfma_f32_16x16x32_bf16 v[112:115], v[68:71], v[240:243], v[112:115]
  s_add_u32 s64, s64, 126976
  ds_read_b64_tr_b16 v[32:33], v12 offset:32768
  v_accvgpr_read_b32 v19, a67
  v_accvgpr_read_b32 v20, a68
  v_mfma_f32_16x16x32_bf16 v[128:131], v[72:75], v[240:243], v[128:131]
  s_add_u32 m0, s24, 32768
  ds_read_b64_tr_b16 v[34:35], v12 offset:33792
  v_accvgpr_read_b32 v21, a69
  v_mfma_f32_16x16x32_bf16 v[144:147], v[76:79], v[240:243], v[144:147]
  buffer_load_dwordx4 v3, s[32:35], s26 offen offset:0 sc1 lds
  v_accvgpr_read_b32 v22, a70
  v_accvgpr_read_b32 v23, a71
  v_mfma_f32_16x16x32_bf16 v[160:163], v[80:83], v[240:243], v[160:163]
  ds_read_b64_tr_b16 v[36:37], v13 offset:32768
  v_mul_f32 v16, s76, v16
  v_mfma_f32_16x16x32_bf16 v[176:179], v[84:87], v[240:243], v[176:179]
  ds_read_b64_tr_b16 v[38:39], v13 offset:33792
  v_mul_f32 v17, s76, v17
  v_mul_f32 v18, s76, v18
  v_mfma_f32_16x16x32_bf16 v[192:195], v[88:91], v[240:243], v[192:195]
  ds_read_b64_tr_b16 v[40:41], v12 offset:33024
  v_mul_f32 v19, s76, v19
  v_mfma_f32_16x16x32_bf16 v[208:211], v[92:95], v[240:243], v[208:211]
  ds_read_b64_tr_b16 v[42:43], v12 offset:34048
  v_mul_f32 v20, s76, v20
  v_mul_f32 v21, s76, v21
  v_mfma_f32_16x16x32_bf16 v[100:103], v[64:67], v[244:247], v[100:103]
  buffer_load_dwordx4 v4, s[32:35], s26 offen offset:1024 sc1 lds
  v_mul_f32 v22, s76, v22
  v_mfma_f32_16x16x32_bf16 v[116:119], v[68:71], v[244:247], v[116:119]
  ds_read_b64_tr_b16 v[44:45], v13 offset:33024
  v_mul_f32 v23, s76, v23
  v_cvt_pk_bf16_f32 v24, v16, v17
  v_mfma_f32_16x16x32_bf16 v[132:135], v[72:75], v[244:247], v[132:135]
  ds_read_b64_tr_b16 v[46:47], v13 offset:34048
  v_cvt_pk_bf16_f32 v25, v18, v19
  v_mfma_f32_16x16x32_bf16 v[148:151], v[76:79], v[244:247], v[148:151]
  ds_read_b128 v[224:227], v14 offset:0
  v_cvt_pk_bf16_f32 v26, v20, v21
  v_cvt_pk_bf16_f32 v27, v22, v23
  v_mfma_f32_16x16x32_bf16 v[164:167], v[80:83], v[244:247], v[164:167]
  ds_read_b128 v[228:231], v14 offset:1024
  buffer_store_dwordx4 v[24:27], v2, s[40:43], s64 offen offset:0 sc1
  v_mfma_f32_16x16x32_bf16 v[180:183], v[84:87], v[244:247], v[180:183]
  buffer_load_dwordx4 v5, s[32:35], s26 offen offset:2048 sc1 lds
  v_accvgpr_read_b32 v16, a72
  v_accvgpr_read_b32 v17, a73
  v_mfma_f32_16x16x32_bf16 v[196:199], v[88:91], v[244:247], v[196:199]
  ds_read_b64_tr_b16 v[48:49], v12 offset:33280
  v_accvgpr_read_b32 v18, a74
  v_mfma_f32_16x16x32_bf16 v[212:215], v[92:95], v[244:247], v[212:215]
  ds_read_b64_tr_b16 v[50:51], v12 offset:34304
  v_accvgpr_read_b32 v19, a75
  v_accvgpr_read_b32 v20, a76
  v_mfma_f32_16x16x32_bf16 v[104:107], v[64:67], v[248:251], v[104:107]
  ds_read_b64_tr_b16 v[52:53], v13 offset:33280
  v_accvgpr_read_b32 v21, a77
  v_accvgpr_read_b32 v22, a78
  v_mfma_f32_16x16x32_bf16 v[120:123], v[68:71], v[248:251], v[120:123]
  ds_read_b64_tr_b16 v[54:55], v13 offset:34304
  v_accvgpr_read_b32 v23, a79
  v_mfma_f32_16x16x32_bf16 v[136:139], v[72:75], v[248:251], v[136:139]
  buffer_load_dwordx4 v6, s[32:35], s26 offen offset:3072 sc1 lds
  v_mul_f32 v16, s76, v16
  v_mul_f32 v17, s76, v17
  v_mfma_f32_16x16x32_bf16 v[152:155], v[76:79], v[248:251], v[152:155]
  s_add_u32 s26, s26, 1024
  ds_read_b64_tr_b16 v[56:57], v12 offset:33536
  v_mul_f32 v18, s76, v18
  v_mfma_f32_16x16x32_bf16 v[168:171], v[80:83], v[248:251], v[168:171]
  ds_read_b64_tr_b16 v[58:59], v12 offset:34560
  v_mul_f32 v19, s76, v19
  v_mul_f32 v20, s76, v20
  v_mfma_f32_16x16x32_bf16 v[184:187], v[84:87], v[248:251], v[184:187]
  ds_read_b64_tr_b16 v[60:61], v13 offset:33536
  v_mul_f32 v21, s76, v21
  v_mfma_f32_16x16x32_bf16 v[200:203], v[88:91], v[248:251], v[200:203]
  ds_read_b64_tr_b16 v[62:63], v13 offset:34560
  v_mul_f32 v22, s76, v22
  v_mul_f32 v23, s76, v23
  v_mfma_f32_16x16x32_bf16 v[216:219], v[92:95], v[248:251], v[216:219]
  v_cvt_pk_bf16_f32 v28, v16, v17
  v_cvt_pk_bf16_f32 v29, v18, v19
  v_mfma_f32_16x16x32_bf16 v[108:111], v[64:67], v[252:255], v[108:111]
  ds_read_b128 v[232:235], v14 offset:2048
  v_cvt_pk_bf16_f32 v30, v20, v21
  v_cvt_pk_bf16_f32 v31, v22, v23
  v_mfma_f32_16x16x32_bf16 v[124:127], v[68:71], v[252:255], v[124:127]
  ds_read_b128 v[236:239], v14 offset:3072
  buffer_store_dwordx4 v[28:31], v2, s[40:43], s64 offen offset:1024 sc1
  v_mfma_f32_16x16x32_bf16 v[140:143], v[72:75], v[252:255], v[140:143]
  v_and_b32 v11, 15, v1
  v_lshrrev_b32 v10, 4, v1
  v_lshlrev_b32 v10, 2, v10
  v_mfma_f32_16x16x32_bf16 v[156:159], v[76:79], v[252:255], v[156:159]
  v_sub_u32 v11, v11, v10
  v_cmp_le_i32 s[68:69], 0, v11
  v_mfma_f32_16x16x32_bf16 v[172:175], v[80:83], v[252:255], v[172:175]
  v_cmp_le_i32 s[70:71], 1, v11
  v_cmp_le_i32 s[72:73], 2, v11
  v_cmp_le_i32 s[74:75], 3, v11
  v_mfma_f32_16x16x32_bf16 v[188:191], v[84:87], v[252:255], v[188:191]
  v_and_b32 v8, 7, v1
  v_lshlrev_b32 v8, 2, v8
  v_mfma_f32_16x16x32_bf16 v[204:207], v[88:91], v[252:255], v[204:207]
  v_add_u32 v8, s30, v8
  v_mfma_f32_16x16x32_bf16 v[220:223], v[92:95], v[252:255], v[220:223]
  s_waitcnt vmcnt(17) lgkmcnt(0)
  v_mfma_f32_16x16x32_bf16 v[96:99], v[32:35], v[224:227], v[96:99]
  v_accvgpr_read_b32 v16, a80
  v_accvgpr_read_b32 v17, a81
  v_accvgpr_read_b32 v18, a82
  v_mfma_f32_16x16x32_bf16 v[112:115], v[36:39], v[224:227], v[112:115]
  ds_read_b64_tr_b16 v[64:65], v12 offset:40960
  v_accvgpr_read_b32 v19, a83
  v_accvgpr_read_b32 v20, a84
  v_mfma_f32_16x16x32_bf16 v[128:131], v[40:43], v[224:227], v[128:131]
  s_add_u32 m0, s24, 65536
  ds_read_b64_tr_b16 v[66:67], v12 offset:41984
  v_accvgpr_read_b32 v21, a85
  v_accvgpr_read_b32 v22, a86
  v_mfma_f32_16x16x32_bf16 v[144:147], v[44:47], v[224:227], v[144:147]
  buffer_load_dwordx4 v3, s[32:35], s26 offen offset:0 sc1 lds
  v_accvgpr_read_b32 v23, a87
  v_mul_f32 v16, s76, v16
  v_mfma_f32_16x16x32_bf16 v[160:163], v[48:51], v[224:227], v[160:163]
  ds_read_b64_tr_b16 v[68:69], v13 offset:40960
  v_mul_f32 v17, s76, v17
  v_mul_f32 v18, s76, v18
  v_mfma_f32_16x16x32_bf16 v[176:179], v[52:55], v[224:227], v[176:179]
  ds_read_b64_tr_b16 v[70:71], v13 offset:41984
  v_mul_f32 v19, s76, v19
  v_mul_f32 v20, s76, v20
  v_mfma_f32_16x16x32_bf16 v[192:195], v[56:59], v[224:227], v[192:195]
  ds_read_b64_tr_b16 v[72:73], v12 offset:41216
  v_mul_f32 v21, s76, v21
  v_mul_f32 v22, s76, v22
  v_mfma_f32_16x16x32_bf16 v[208:211], v[60:63], v[224:227], v[208:211]
  ds_read_b64_tr_b16 v[74:75], v12 offset:42240
  v_mul_f32 v23, s76, v23
  v_mfma_f32_16x16x32_bf16 v[100:103], v[32:35], v[228:231], v[100:103]
  buffer_load_dwordx4 v4, s[32:35], s26 offen offset:1024 sc1 lds
  v_cvt_pk_bf16_f32 v24, v16, v17
  v_cvt_pk_bf16_f32 v25, v18, v19
  v_mfma_f32_16x16x32_bf16 v[116:119], v[36:39], v[228:231], v[116:119]
  ds_read_b64_tr_b16 v[76:77], v13 offset:41216
  v_cvt_pk_bf16_f32 v26, v20, v21
  v_cvt_pk_bf16_f32 v27, v22, v23
  v_mfma_f32_16x16x32_bf16 v[132:135], v[40:43], v[228:231], v[132:135]
  ds_read_b64_tr_b16 v[78:79], v13 offset:42240
  buffer_store_dwordx4 v[24:27], v2, s[40:43], s64 offen offset:2048 sc1
  v_accvgpr_read_b32 v16, a88
  v_mfma_f32_16x16x32_bf16 v[148:151], v[44:47], v[228:231], v[148:151]
  ds_read_b128 v[240:243], v14 offset:32768
  v_accvgpr_read_b32 v17, a89
  v_accvgpr_read_b32 v18, a90
  v_mfma_f32_16x16x32_bf16 v[164:167], v[48:51], v[228:231], v[164:167]
  ds_read_b128 v[244:247], v14 offset:33792
  v_accvgpr_read_b32 v19, a91
  v_accvgpr_read_b32 v20, a92
  v_mfma_f32_16x16x32_bf16 v[180:183], v[52:55], v[228:231], v[180:183]
  buffer_load_dwordx4 v5, s[32:35], s26 offen offset:2048 sc1 lds
  v_accvgpr_read_b32 v21, a93
  v_accvgpr_read_b32 v22, a94
  v_mfma_f32_16x16x32_bf16 v[196:199], v[56:59], v[228:231], v[196:199]
  ds_read_b64_tr_b16 v[80:81], v12 offset:41472
  v_accvgpr_read_b32 v23, a95
  v_mfma_f32_16x16x32_bf16 v[212:215], v[60:63], v[228:231], v[212:215]
  ds_read_b64_tr_b16 v[82:83], v12 offset:42496
  v_mul_f32 v16, s76, v16
  v_mul_f32 v17, s76, v17
  v_mfma_f32_16x16x32_bf16 v[104:107], v[32:35], v[232:235], v[104:107]
  ds_read_b64_tr_b16 v[84:85], v13 offset:41472
  v_mul_f32 v18, s76, v18
  v_mul_f32 v19, s76, v19
  v_mfma_f32_16x16x32_bf16 v[120:123], v[36:39], v[232:235], v[120:123]
  ds_read_b64_tr_b16 v[86:87], v13 offset:42496
  v_mul_f32 v20, s76, v20
  v_mul_f32 v21, s76, v21
  v_mfma_f32_16x16x32_bf16 v[136:139], v[40:43], v[232:235], v[136:139]
  buffer_load_dwordx4 v6, s[32:35], s26 offen offset:3072 sc1 lds
  v_mul_f32 v22, s76, v22
  v_mul_f32 v23, s76, v23
  v_mfma_f32_16x16x32_bf16 v[152:155], v[44:47], v[232:235], v[152:155]
  s_add_u32 s26, s26, 1024
  ds_read_b64_tr_b16 v[88:89], v12 offset:41728
  v_cvt_pk_bf16_f32 v28, v16, v17
  v_cvt_pk_bf16_f32 v29, v18, v19
  v_mfma_f32_16x16x32_bf16 v[168:171], v[48:51], v[232:235], v[168:171]
  ds_read_b64_tr_b16 v[90:91], v12 offset:42752
  v_cvt_pk_bf16_f32 v30, v20, v21
  v_cvt_pk_bf16_f32 v31, v22, v23
  v_mfma_f32_16x16x32_bf16 v[184:187], v[52:55], v[232:235], v[184:187]
  ds_read_b64_tr_b16 v[92:93], v13 offset:41728
  buffer_store_dwordx4 v[28:31], v2, s[40:43], s64 offen offset:3072 sc1
  v_add_u32 v9, 0, v1
  v_mfma_f32_16x16x32_bf16 v[200:203], v[56:59], v[232:235], v[200:203]
  ds_read_b64_tr_b16 v[94:95], v13 offset:42752
  v_mul_u32_u24 v10, 6554, v9
  v_mfma_f32_16x16x32_bf16 v[216:219], v[60:63], v[232:235], v[216:219]
  v_lshrrev_b32 v10, 16, v10
  v_mul_u32_u24 v10, 1120, v10
  v_lshl_add_u32 v10, v9, 4, v10
  v_mfma_f32_16x16x32_bf16 v[108:111], v[32:35], v[236:239], v[108:111]
  ds_read_b128 v[248:251], v14 offset:34816
  v_accvgpr_write_b32 a248, v10
  v_add_u32 v9, 64, v1
  v_mfma_f32_16x16x32_bf16 v[124:127], v[36:39], v[236:239], v[124:127]
  ds_read_b128 v[252:255], v14 offset:35840
  v_mul_u32_u24 v10, 6554, v9
  v_lshrrev_b32 v10, 16, v10
  v_mfma_f32_16x16x32_bf16 v[140:143], v[40:43], v[236:239], v[140:143]
  v_mul_u32_u24 v10, 1120, v10
  v_lshl_add_u32 v10, v9, 4, v10
  v_accvgpr_write_b32 a249, v10
  v_mfma_f32_16x16x32_bf16 v[156:159], v[44:47], v[236:239], v[156:159]
  v_xor_b32 v14, 0x10000, v14
  v_add_u32 v9, 128, v1
  v_mul_u32_u24 v10, 6554, v9
  v_mfma_f32_16x16x32_bf16 v[172:175], v[48:51], v[236:239], v[172:175]
  v_lshrrev_b32 v10, 16, v10
  v_mul_u32_u24 v10, 1120, v10
  v_lshl_add_u32 v10, v9, 4, v10
  v_mfma_f32_16x16x32_bf16 v[188:191], v[52:55], v[236:239], v[188:191]
  v_xor_b32 v12, 0x10000, v12
  v_accvgpr_write_b32 a250, v10
  v_mfma_f32_16x16x32_bf16 v[204:207], v[56:59], v[236:239], v[204:207]
  v_xor_b32 v13, 0x10000, v13
  v_mfma_f32_16x16x32_bf16 v[220:223], v[60:63], v[236:239], v[220:223]
  s_waitcnt vmcnt(15) lgkmcnt(0)
  v_mfma_f32_16x16x32_bf16 v[96:99], v[64:67], v[240:243], v[96:99]
  s_barrier
  v_accvgpr_read_b32 v16, a96
  v_accvgpr_read_b32 v17, a97
  v_accvgpr_read_b32 v18, a98
  v_accvgpr_read_b32 v19, a99
  v_mfma_f32_16x16x32_bf16 v[112:115], v[68:71], v[240:243], v[112:115]
  s_add_u32 s64, s64, 4096
  ds_read_b64_tr_b16 v[32:33], v12 offset:0
  v_accvgpr_read_b32 v20, a100
  v_accvgpr_read_b32 v21, a101
  v_mfma_f32_16x16x32_bf16 v[128:131], v[72:75], v[240:243], v[128:131]
  s_add_u32 m0, s24, 98304
  ds_read_b64_tr_b16 v[34:35], v12 offset:1024
  v_accvgpr_read_b32 v22, a102
  v_accvgpr_read_b32 v23, a103
  v_mfma_f32_16x16x32_bf16 v[144:147], v[76:79], v[240:243], v[144:147]
  buffer_load_dwordx4 v3, s[32:35], s26 offen offset:0 sc1 lds
  v_mul_f32 v16, s76, v16
  v_mul_f32 v17, s76, v17
  v_mul_f32 v18, s76, v18
  v_mfma_f32_16x16x32_bf16 v[160:163], v[80:83], v[240:243], v[160:163]
  ds_read_b64_tr_b16 v[36:37], v13 offset:0
  v_mul_f32 v19, s76, v19
  v_mul_f32 v20, s76, v20
  v_mfma_f32_16x16x32_bf16 v[176:179], v[84:87], v[240:243], v[176:179]
  ds_read_b64_tr_b16 v[38:39], v13 offset:1024
  v_mul_f32 v21, s76, v21
  v_mul_f32 v22, s76, v22
  v_mfma_f32_16x16x32_bf16 v[192:195], v[88:91], v[240:243], v[192:195]
  ds_read_b64_tr_b16 v[40:41], v12 offset:256
  v_mul_f32 v23, s76, v23
  v_cvt_pk_bf16_f32 v24, v16, v17
  v_cvt_pk_bf16_f32 v25, v18, v19
  v_mfma_f32_16x16x32_bf16 v[208:211], v[92:95], v[240:243], v[208:211]
  ds_read_b64_tr_b16 v[42:43], v12 offset:1280
  v_cvt_pk_bf16_f32 v26, v20, v21
  v_cvt_pk_bf16_f32 v27, v22, v23
  v_mfma_f32_16x16x32_bf16 v[100:103], v[64:67], v[244:247], v[100:103]
  buffer_load_dwordx4 v4, s[32:35], s26 offen offset:1024 sc1 lds
  buffer_store_dwordx4 v[24:27], v2, s[40:43], s64 offen offset:0 sc1
  v_accvgpr_read_b32 v16, a104
  v_mfma_f32_16x16x32_bf16 v[116:119], v[68:71], v[244:247], v[116:119]
  ds_read_b64_tr_b16 v[44:45], v13 offset:256
  v_accvgpr_read_b32 v17, a105
  v_accvgpr_read_b32 v18, a106
  v_mfma_f32_16x16x32_bf16 v[132:135], v[72:75], v[244:247], v[132:135]
  ds_read_b64_tr_b16 v[46:47], v13 offset:1280
  v_accvgpr_read_b32 v19, a107
  v_accvgpr_read_b32 v20, a108
  v_accvgpr_read_b32 v21, a109
  v_mfma_f32_16x16x32_bf16 v[148:151], v[76:79], v[244:247], v[148:151]
  ds_read_b128 v[224:227], v14 offset:0
  v_accvgpr_read_b32 v22, a110
  v_accvgpr_read_b32 v23, a111
  v_mfma_f32_16x16x32_bf16 v[164:167], v[80:83], v[244:247], v[164:167]
  ds_read_b128 v[228:231], v14 offset:1024
  v_mul_f32 v16, s76, v16
  v_mul_f32 v17, s76, v17
  v_mfma_f32_16x16x32_bf16 v[180:183], v[84:87], v[244:247], v[180:183]
  buffer_load_dwordx4 v5, s[32:35], s26 offen offset:2048 sc1 lds
  v_mul_f32 v18, s76, v18
  v_mul_f32 v19, s76, v19
  v_mul_f32 v20, s76, v20
  v_mfma_f32_16x16x32_bf16 v[196:199], v[88:91], v[244:247], v[196:199]
  ds_read_b64_tr_b16 v[48:49], v12 offset:512
  v_mul_f32 v21, s76, v21
  v_mul_f32 v22, s76, v22
  v_mfma_f32_16x16x32_bf16 v[212:215], v[92:95], v[244:247], v[212:215]
  ds_read_b64_tr_b16 v[50:51], v12 offset:1536
  v_mul_f32 v23, s76, v23
  v_cvt_pk_bf16_f32 v28, v16, v17
  v_mfma_f32_16x16x32_bf16 v[104:107], v[64:67], v[248:251], v[104:107]
  ds_read_b64_tr_b16 v[52:53], v13 offset:512
  v_cvt_pk_bf16_f32 v29, v18, v19
  v_cvt_pk_bf16_f32 v30, v20, v21
  v_cvt_pk_bf16_f32 v31, v22, v23
  v_mfma_f32_16x16x32_bf16 v[120:123], v[68:71], v[248:251], v[120:123]
  ds_read_b64_tr_b16 v[54:55], v13 offset:1536
  buffer_store_dwordx4 v[28:31], v2, s[40:43], s64 offen offset:1024 sc1
  v_accvgpr_read_b32 v16, a112
  v_mfma_f32_16x16x32_bf16 v[136:139], v[72:75], v[248:251], v[136:139]
  buffer_load_dwordx4 v6, s[32:35], s26 offen offset:3072 sc1 lds
  v_accvgpr_read_b32 v17, a113
  v_accvgpr_read_b32 v18, a114
  v_mfma_f32_16x16x32_bf16 v[152:155], v[76:79], v[248:251], v[152:155]
  s_add_u32 s26, s26, 1024
  ds_read_b64_tr_b16 v[56:57], v12 offset:768
  v_accvgpr_read_b32 v19, a115
  v_accvgpr_read_b32 v20, a116
  v_mfma_f32_16x16x32_bf16 v[168:171], v[80:83], v[248:251], v[168:171]
  ds_read_b64_tr_b16 v[58:59], v12 offset:1792
  v_accvgpr_read_b32 v21, a117
  v_accvgpr_read_b32 v22, a118
  v_accvgpr_read_b32 v23, a119
  v_mfma_f32_16x16x32_bf16 v[184:187], v[84:87], v[248:251], v[184:187]
  ds_read_b64_tr_b16 v[60:61], v13 offset:768
  v_mul_f32 v16, s76, v16
  v_mul_f32 v17, s76, v17
  v_mfma_f32_16x16x32_bf16 v[200:203], v[88:91], v[248:251], v[200:203]
  ds_read_b64_tr_b16 v[62:63], v13 offset:1792
  v_mul_f32 v18, s76, v18
  v_mul_f32 v19, s76, v19
  v_mfma_f32_16x16x32_bf16 v[216:219], v[92:95], v[248:251], v[216:219]
  v_mul_f32 v20, s76, v20
  v_mul_f32 v21, s76, v21
  v_mul_f32 v22, s76, v22
  v_mul_f32 v23, s76, v23
  v_mfma_f32_16x16x32_bf16 v[108:111], v[64:67], v[252:255], v[108:111]
  ds_read_b128 v[232:235], v14 offset:2048
  v_cvt_pk_bf16_f32 v24, v16, v17
  v_cvt_pk_bf16_f32 v25, v18, v19
  v_mfma_f32_16x16x32_bf16 v[124:127], v[68:71], v[252:255], v[124:127]
  ds_read_b128 v[236:239], v14 offset:3072
  v_cvt_pk_bf16_f32 v26, v20, v21
  v_cvt_pk_bf16_f32 v27, v22, v23
  v_mfma_f32_16x16x32_bf16 v[140:143], v[72:75], v[252:255], v[140:143]
  buffer_store_dwordx4 v[24:27], v2, s[40:43], s64 offen offset:2048 sc1
  v_add_u32 v9, 192, v1
  v_mul_u32_u24 v10, 6554, v9
  v_lshrrev_b32 v10, 16, v10
  v_mfma_f32_16x16x32_bf16 v[156:159], v[76:79], v[252:255], v[156:159]
  v_mul_u32_u24 v10, 1120, v10
  v_lshl_add_u32 v10, v9, 4, v10
  v_accvgpr_write_b32 a251, v10
  v_mfma_f32_16x16x32_bf16 v[172:175], v[80:83], v[252:255], v[172:175]
  v_add_u32 v9, 256, v1
  v_mul_u32_u24 v10, 6554, v9
  v_lshrrev_b32 v10, 16, v10
  v_mfma_f32_16x16x32_bf16 v[188:191], v[84:87], v[252:255], v[188:191]
  v_mul_u32_u24 v10, 1120, v10
  v_lshl_add_u32 v10, v9, 4, v10
  v_accvgpr_write_b32 a252, v10
  v_mfma_f32_16x16x32_bf16 v[204:207], v[88:91], v[252:255], v[204:207]
  v_mfma_f32_16x16x32_bf16 v[220:223], v[92:95], v[252:255], v[220:223]
  s_waitcnt vmcnt(14) lgkmcnt(0)
  v_mfma_f32_16x16x32_bf16 v[96:99], v[32:35], v[224:227], v[96:99]
  v_accvgpr_read_b32 v16, a120
  v_accvgpr_read_b32 v17, a121
  v_accvgpr_read_b32 v18, a122
  v_mfma_f32_16x16x32_bf16 v[112:115], v[36:39], v[224:227], v[112:115]
  s_mul_i32 s34, s20, 5120
  ds_read_b64_tr_b16 v[64:65], v12 offset:8192
  v_accvgpr_read_b32 v19, a123
  v_accvgpr_read_b32 v20, a124
  v_mfma_f32_16x16x32_bf16 v[128:131], v[40:43], v[224:227], v[128:131]
  s_add_u32 s34, s34, 131072
  ds_read_b64_tr_b16 v[66:67], v12 offset:9216
  v_accvgpr_read_b32 v21, a125
  v_accvgpr_read_b32 v22, a126
  v_mfma_f32_16x16x32_bf16 v[144:147], v[44:47], v[224:227], v[144:147]
  s_and_b32 s32, s21, 3
  buffer_load_dword v15, v8, s[40:43], 0 offen sc1
  v_accvgpr_read_b32 v23, a127
  v_mul_f32 v16, s76, v16
  v_mfma_f32_16x16x32_bf16 v[160:163], v[48:51], v[224:227], v[160:163]
  s_min_u32 s32, s32, 2
  ds_read_b64_tr_b16 v[68:69], v13 offset:8192
  v_mul_f32 v17, s76, v17
  v_mul_f32 v18, s76, v18
  v_mfma_f32_16x16x32_bf16 v[176:179], v[52:55], v[224:227], v[176:179]
  s_add_u32 s32, s32, 5
  ds_read_b64_tr_b16 v[70:71], v13 offset:9216
  v_mul_f32 v19, s76, v19
  v_mul_f32 v20, s76, v20
  v_mfma_f32_16x16x32_bf16 v[192:195], v[56:59], v[224:227], v[192:195]
  s_lshl_b32 s32, s32, 14
  ds_read_b64_tr_b16 v[72:73], v12 offset:8448
  v_mul_f32 v21, s76, v21
  v_mul_f32 v22, s76, v22
  v_mfma_f32_16x16x32_bf16 v[208:211], v[60:63], v[224:227], v[208:211]
  s_mov_b32 s9, -1
  ds_read_b64_tr_b16 v[74:75], v12 offset:9472
  v_mul_f32 v23, s76, v23
  v_mfma_f32_16x16x32_bf16 v[100:103], v[32:35], v[228:231], v[100:103]
  s_sub_u32 s23, s2, 64
  v_cvt_pk_bf16_f32 v28, v16, v17
  v_cvt_pk_bf16_f32 v29, v18, v19
  v_cvt_pk_bf16_f32 v30, v20, v21
  v_mfma_f32_16x16x32_bf16 v[116:119], v[36:39], v[228:231], v[116:119]
  s_cmp_lt_u32 s23, 96
  s_cselect_b32 s9, 0, s9
  ds_read_b64_tr_b16 v[76:77], v13 offset:8448
  v_cvt_pk_bf16_f32 v31, v22, v23
  v_mfma_f32_16x16x32_bf16 v[132:135], v[40:43], v[228:231], v[132:135]
  s_cmp_ge_u32 s2, 224
  s_cselect_b32 s9, 0, s9
  ds_read_b64_tr_b16 v[78:79], v13 offset:9472
  buffer_store_dwordx4 v[28:31], v2, s[40:43], s64 offen offset:3072 sc1
  v_accvgpr_read_b32 v16, a128
  v_mfma_f32_16x16x32_bf16 v[148:151], v[44:47], v[228:231], v[148:151]
  s_and_b32 s32, s32, s9
  ds_read_b128 v[240:243], v14 offset:32768
  v_accvgpr_read_b32 v17, a129
  v_accvgpr_read_b32 v18, a130
  v_mfma_f32_16x16x32_bf16 v[164:167], v[48:51], v[228:231], v[164:167]
  s_sub_u32 s23, s2, 170
  ds_read_b128 v[244:247], v14 offset:33792
  v_accvgpr_read_b32 v19, a131
  v_accvgpr_read_b32 v20, a132
  v_mfma_f32_16x16x32_bf16 v[180:183], v[52:55], v[228:231], v[180:183]
  s_cmp_lt_u32 s23, 54
  s_cselect_b32 s32, 98304, s32
  v_accvgpr_read_b32 v21, a133
  v_accvgpr_read_b32 v22, a134
  v_accvgpr_read_b32 v23, a135
  v_mfma_f32_16x16x32_bf16 v[196:199], v[56:59], v[228:231], v[196:199]
  s_mov_b32 s67, s2
  s_add_u32 s64, s64, 126976
  ds_read_b64_tr_b16 v[80:81], v12 offset:8704
  v_mul_f32 v16, s76, v16
  v_mfma_f32_16x16x32_bf16 v[212:215], v[60:63], v[228:231], v[212:215]
  s_mov_b32 s8, 0
  ds_read_b64_tr_b16 v[82:83], v12 offset:9728
  v_mul_f32 v17, s76, v17
  v_mul_f32 v18, s76, v18
  v_mfma_f32_16x16x32_bf16 v[104:107], v[32:35], v[232:235], v[104:107]
  s_mov_b32 s66, 0
  ds_read_b64_tr_b16 v[84:85], v13 offset:8704
  v_mul_f32 v19, s76, v19
  v_mul_f32 v20, s76, v20
  v_mfma_f32_16x16x32_bf16 v[120:123], v[36:39], v[232:235], v[120:123]
  s_mov_b32 s11, 0
  ds_read_b64_tr_b16 v[86:87], v13 offset:9728
  v_mul_f32 v21, s76, v21
  v_mul_f32 v22, s76, v22
  v_mfma_f32_16x16x32_bf16 v[136:139], v[40:43], v[232:235], v[136:139]
  s_mov_b32 s12, 0
  v_mul_f32 v23, s76, v23
  v_cvt_pk_bf16_f32 v24, v16, v17
  v_cvt_pk_bf16_f32 v25, v18, v19
  v_mfma_f32_16x16x32_bf16 v[152:155], v[44:47], v[232:235], v[152:155]
  s_lshl_b32 s15, s22, 1
  ds_read_b64_tr_b16 v[88:89], v12 offset:8960
  v_cvt_pk_bf16_f32 v26, v20, v21
  v_cvt_pk_bf16_f32 v27, v22, v23
  v_mfma_f32_16x16x32_bf16 v[168:171], v[48:51], v[232:235], v[168:171]
  s_add_u32 s23, s15, 6
  ds_read_b64_tr_b16 v[90:91], v12 offset:9984
  buffer_store_dwordx4 v[24:27], v2, s[40:43], s64 offen offset:0 sc1
  v_accvgpr_read_b32 v16, a136
  v_mfma_f32_16x16x32_bf16 v[184:187], v[52:55], v[232:235], v[184:187]
  s_sub_u32 s15, 24, s15
  ds_read_b64_tr_b16 v[92:93], v13 offset:8960
  v_accvgpr_read_b32 v17, a137
  v_accvgpr_read_b32 v18, a138
  v_mfma_f32_16x16x32_bf16 v[200:203], v[56:59], v[232:235], v[200:203]
  s_max_u32 s15, s15, s23
  ds_read_b64_tr_b16 v[94:95], v13 offset:9984
  v_accvgpr_read_b32 v19, a139
  v_mfma_f32_16x16x32_bf16 v[216:219], v[60:63], v[232:235], v[216:219]
  s_lshl_b32 s15, s15, 14
  v_accvgpr_read_b32 v20, a140
  v_accvgpr_read_b32 v21, a141
  v_accvgpr_read_b32 v22, a142
  v_mfma_f32_16x16x32_bf16 v[108:111], v[32:35], v[236:239], v[108:111]
  ds_read_b128 v[248:251], v14 offset:34816
  v_accvgpr_read_b32 v23, a143
  v_mul_f32 v16, s76, v16
  v_mfma_f32_16x16x32_bf16 v[124:127], v[36:39], v[236:239], v[124:127]
  ds_read_b128 v[252:255], v14 offset:35840
  v_mul_f32 v17, s76, v17
  v_mul_f32 v18, s76, v18
  v_mfma_f32_16x16x32_bf16 v[140:143], v[40:43], v[236:239], v[140:143]
  v_mul_f32 v19, s76, v19
  v_mul_f32 v20, s76, v20
  v_mul_f32 v21, s76, v21
  v_mfma_f32_16x16x32_bf16 v[156:159], v[44:47], v[236:239], v[156:159]
  v_xor_b32 v14, 0x10000, v14
  v_mul_f32 v22, s76, v22
  v_mul_f32 v23, s76, v23
  v_mfma_f32_16x16x32_bf16 v[172:175], v[48:51], v[236:239], v[172:175]
  v_cvt_pk_bf16_f32 v28, v16, v17
  v_cvt_pk_bf16_f32 v29, v18, v19
  v_cvt_pk_bf16_f32 v30, v20, v21
  v_mfma_f32_16x16x32_bf16 v[188:191], v[52:55], v[236:239], v[188:191]
  v_cvt_pk_bf16_f32 v31, v22, v23
  v_mfma_f32_16x16x32_bf16 v[204:207], v[56:59], v[236:239], v[204:207]
  buffer_store_dwordx4 v[28:31], v2, s[40:43], s64 offen offset:1024 sc1
  v_mfma_f32_16x16x32_bf16 v[220:223], v[60:63], v[236:239], v[220:223]
  s_waitcnt vmcnt(12) lgkmcnt(0)
  v_mfma_f32_16x16x32_bf16 v[96:99], v[64:67], v[240:243], v[96:99]
  s_barrier
  v_accvgpr_read_b32 v16, a144
  v_accvgpr_read_b32 v17, a145
  v_accvgpr_read_b32 v18, a146
  v_accvgpr_read_b32 v19, a147
  v_mfma_f32_16x16x32_bf16 v[112:115], v[68:71], v[240:243], v[112:115]
  s_and_b32 s23, s20, 1
  ds_read_b64_tr_b16 v[32:33], v12 offset:32768
  v_accvgpr_read_b32 v20, a148
  v_accvgpr_read_b32 v21, a149
  v_mfma_f32_16x16x32_bf16 v[128:131], v[72:75], v[240:243], v[128:131]
  s_lshl_b32 s23, s23, 12
  ds_read_b64_tr_b16 v[34:35], v12 offset:33792
  v_accvgpr_read_b32 v22, a150
  v_accvgpr_read_b32 v23, a151
  v_mfma_f32_16x16x32_bf16 v[144:147], v[76:79], v[240:243], v[144:147]
  s_cmp_lt_u32 s20, 2
  s_cselect_b32 s24, 106496, 0
  v_mul_f32 v16, s76, v16
  v_mul_f32 v17, s76, v17
  v_mul_f32 v18, s76, v18
  v_mfma_f32_16x16x32_bf16 v[160:163], v[80:83], v[240:243], v[160:163]
  s_add_u32 s24, s24, s23
  ds_read_b64_tr_b16 v[36:37], v13 offset:32768
  v_mul_f32 v19, s76, v19
  v_mul_f32 v20, s76, v20
  v_mfma_f32_16x16x32_bf16 v[176:179], v[84:87], v[240:243], v[176:179]
  s_lshl_b32 s26, s20, 12
  ds_read_b64_tr_b16 v[38:39], v13 offset:33792
  v_mul_f32 v21, s76, v21
  v_mul_f32 v22, s76, v22
  v_mfma_f32_16x16x32_bf16 v[192:195], v[88:91], v[240:243], v[192:195]
  s_mov_b32 s27, s26
  ds_read_b64_tr_b16 v[40:41], v12 offset:33024
  v_mul_f32 v23, s76, v23
  v_cvt_pk_bf16_f32 v24, v16, v17
  v_mfma_f32_16x16x32_bf16 v[208:211], v[92:95], v[240:243], v[208:211]
  s_add_u32 s25, s27, 49152
  ds_read_b64_tr_b16 v[42:43], v12 offset:34048
  v_cvt_pk_bf16_f32 v25, v18, v19
  v_cvt_pk_bf16_f32 v26, v20, v21
  v_cvt_pk_bf16_f32 v27, v22, v23
  v_mfma_f32_16x16x32_bf16 v[100:103], v[64:67], v[244:247], v[100:103]
  s_load_dwordx4 s[4:7], s[0:1], 64
  buffer_store_dwordx4 v[24:27], v2, s[40:43], s64 offen offset:2048 sc1
  v_accvgpr_read_b32 v16, a152
  v_accvgpr_read_b32 v17, a153
  v_mfma_f32_16x16x32_bf16 v[116:119], v[68:71], v[244:247], v[116:119]
  s_load_dwordx2 s[60:61], s[0:1], 80
  ds_read_b64_tr_b16 v[44:45], v13 offset:33024
  v_accvgpr_read_b32 v18, a154
  v_accvgpr_read_b32 v19, a155
  v_mfma_f32_16x16x32_bf16 v[132:135], v[72:75], v[244:247], v[132:135]
  s_add_u32 s23, s20, 1
  ds_read_b64_tr_b16 v[46:47], v13 offset:34048
  v_accvgpr_read_b32 v20, a156
  v_accvgpr_read_b32 v21, a157
  v_mfma_f32_16x16x32_bf16 v[148:151], v[76:79], v[244:247], v[148:151]
  s_lshr_b32 s23, s23, 1
  ds_read_b128 v[224:227], v14 offset:0
  v_accvgpr_read_b32 v22, a158
  v_accvgpr_read_b32 v23, a159
  v_mfma_f32_16x16x32_bf16 v[164:167], v[80:83], v[244:247], v[164:167]
  s_lshl_b32 s28, s22, 1
  ds_read_b128 v[228:231], v14 offset:1024
  v_mul_f32 v16, s76, v16
  v_mul_f32 v17, s76, v17
  v_mfma_f32_16x16x32_bf16 v[180:183], v[84:87], v[244:247], v[180:183]
  s_add_u32 s28, s28, s23
  v_mul_f32 v18, s76, v18
  v_mul_f32 v19, s76, v19
  v_mul_f32 v20, s76, v20
  v_mfma_f32_16x16x32_bf16 v[196:199], v[88:91], v[244:247], v[196:199]
  s_lshl_b32 s23, s22, 2
  ds_read_b64_tr_b16 v[48:49], v12 offset:33280
  v_mul_f32 v21, s76, v21
  v_mul_f32 v22, s76, v22
  v_mfma_f32_16x16x32_bf16 v[212:215], v[92:95], v[244:247], v[212:215]
  s_sub_u32 s29, 28, s23
  ds_read_b64_tr_b16 v[50:51], v12 offset:34304
  v_mul_f32 v23, s76, v23
  v_cvt_pk_bf16_f32 v28, v16, v17
  v_cvt_pk_bf16_f32 v29, v18, v19
  v_mfma_f32_16x16x32_bf16 v[104:107], v[64:67], v[248:251], v[104:107]
  s_and_b32 s23, s20, 1
  ds_read_b64_tr_b16 v[52:53], v13 offset:33280
  v_cvt_pk_bf16_f32 v30, v20, v21
  v_cvt_pk_bf16_f32 v31, v22, v23
  v_mfma_f32_16x16x32_bf16 v[120:123], v[68:71], v[248:251], v[120:123]
  s_add_u32 s29, s29, s23
  ds_read_b64_tr_b16 v[54:55], v13 offset:34304
  buffer_store_dwordx4 v[28:31], v2, s[40:43], s64 offen offset:3072 sc1
  v_accvgpr_read_b32 v16, a160
  v_mfma_f32_16x16x32_bf16 v[136:139], v[72:75], v[248:251], v[136:139]
  s_add_u32 s64, s64, 4096
  v_accvgpr_read_b32 v17, a161
  v_accvgpr_read_b32 v18, a162
  v_accvgpr_read_b32 v19, a163
  v_mfma_f32_16x16x32_bf16 v[152:155], v[76:79], v[248:251], v[152:155]
  ds_read_b64_tr_b16 v[56:57], v12 offset:33536
  v_accvgpr_read_b32 v20, a164
  v_accvgpr_read_b32 v21, a165
  v_mfma_f32_16x16x32_bf16 v[168:171], v[80:83], v[248:251], v[168:171]
  ds_read_b64_tr_b16 v[58:59], v12 offset:34560
  v_accvgpr_read_b32 v22, a166
  v_accvgpr_read_b32 v23, a167
  v_mfma_f32_16x16x32_bf16 v[184:187], v[84:87], v[248:251], v[184:187]
  ds_read_b64_tr_b16 v[60:61], v13 offset:33536
  v_mul_f32 v16, s76, v16
  v_mul_f32 v17, s76, v17
  v_mfma_f32_16x16x32_bf16 v[200:203], v[88:91], v[248:251], v[200:203]
  ds_read_b64_tr_b16 v[62:63], v13 offset:34560
  v_mul_f32 v18, s76, v18
  v_mul_f32 v19, s76, v19
  v_mul_f32 v20, s76, v20
  v_mfma_f32_16x16x32_bf16 v[216:219], v[92:95], v[248:251], v[216:219]
  v_mul_f32 v21, s76, v21
  v_mul_f32 v22, s76, v22
  v_mul_f32 v23, s76, v23
  v_mfma_f32_16x16x32_bf16 v[108:111], v[64:67], v[252:255], v[108:111]
  ds_read_b128 v[232:235], v14 offset:2048
  v_cvt_pk_bf16_f32 v24, v16, v17
  v_cvt_pk_bf16_f32 v25, v18, v19
  v_mfma_f32_16x16x32_bf16 v[124:127], v[68:71], v[252:255], v[124:127]
  ds_read_b128 v[236:239], v14 offset:3072
  v_cvt_pk_bf16_f32 v26, v20, v21
  v_cvt_pk_bf16_f32 v27, v22, v23
  v_mfma_f32_16x16x32_bf16 v[140:143], v[72:75], v[252:255], v[140:143]
  buffer_store_dwordx4 v[24:27], v2, s[40:43], s64 offen offset:0 sc1
  v_lshrrev_b32 v6, 2, v1
  v_mul_u32_u24 v6, 160, v6
  v_mfma_f32_16x16x32_bf16 v[156:159], v[76:79], v[252:255], v[156:159]
  v_and_b32 v9, 3, v1
  v_lshl_add_u32 v6, v9, 3, v6
  v_add_u32 v6, s34, v6
  v_mfma_f32_16x16x32_bf16 v[172:175], v[80:83], v[252:255], v[172:175]
  v_mov_b32 v3, v2
  v_mov_b32 v4, 0xff800000
  v_add_u32 v9, 106496, v2
  v_mfma_f32_16x16x32_bf16 v[188:191], v[84:87], v[252:255], v[188:191]
  v_mfma_f32_16x16x32_bf16 v[204:207], v[88:91], v[252:255], v[204:207]
  v_mfma_f32_16x16x32_bf16 v[220:223], v[92:95], v[252:255], v[220:223]
  s_waitcnt vmcnt(8) lgkmcnt(0)
  v_mfma_f32_16x16x32_bf16 v[96:99], v[32:35], v[224:227], v[96:99]
  v_accvgpr_read_b32 v16, a168
  v_accvgpr_read_b32 v17, a169
  v_accvgpr_read_b32 v18, a170
  v_mfma_f32_16x16x32_bf16 v[112:115], v[36:39], v[224:227], v[112:115]
  s_cmp_ge_u32 s20, 2
  s_cselect_b32 s4, s6, s4
  s_cselect_b32 s5, s7, s5
  ds_read_b64_tr_b16 v[64:65], v12 offset:40960
  v_accvgpr_read_b32 v19, a171
  v_accvgpr_read_b32 v20, a172
  v_mfma_f32_16x16x32_bf16 v[128:131], v[40:43], v[224:227], v[128:131]
  s_mov_b32 s62, 2211840
  ds_read_b64_tr_b16 v[66:67], v12 offset:41984
  v_accvgpr_read_b32 v21, a173
  v_accvgpr_read_b32 v22, a174
  v_mfma_f32_16x16x32_bf16 v[144:147], v[44:47], v[224:227], v[144:147]
  s_mov_b32 s63, 0x20000
  v_accvgpr_read_b32 v23, a175
  v_mul_f32 v16, s76, v16
  v_mul_f32 v17, s76, v17
  v_mfma_f32_16x16x32_bf16 v[160:163], v[48:51], v[224:227], v[160:163]
  s_mov_b64 s[56:57], s[52:53]
  ds_read_b64_tr_b16 v[68:69], v13 offset:40960
  v_mul_f32 v18, s76, v18
  v_mfma_f32_16x16x32_bf16 v[176:179], v[52:55], v[224:227], v[176:179]
  s_mov_b32 s58, s54
  ds_read_b64_tr_b16 v[70:71], v13 offset:41984
  v_mul_f32 v19, s76, v19
  v_mul_f32 v20, s76, v20
  v_mfma_f32_16x16x32_bf16 v[192:195], v[56:59], v[224:227], v[192:195]
  s_mov_b64 s[52:53], s[4:5]
  ds_read_b64_tr_b16 v[72:73], v12 offset:41216
  v_mul_f32 v21, s76, v21
  v_mul_f32 v22, s76, v22
  v_mfma_f32_16x16x32_bf16 v[208:211], v[60:63], v[224:227], v[208:211]
  s_mov_b32 s54, 2211840
  ds_read_b64_tr_b16 v[74:75], v12 offset:42240
  v_mul_f32 v23, s76, v23
  v_cvt_pk_bf16_f32 v28, v16, v17
  v_mfma_f32_16x16x32_bf16 v[100:103], v[32:35], v[228:231], v[100:103]
  s_getpc_b64 s[36:37]
fa_copc:
  v_cvt_pk_bf16_f32 v29, v18, v19
  v_cvt_pk_bf16_f32 v30, v20, v21
  v_cvt_pk_bf16_f32 v31, v22, v23
  v_mfma_f32_16x16x32_bf16 v[116:119], v[36:39], v[228:231], v[116:119]
  s_add_u32 s36, s36, fa_co-fa_copc-4
  s_addc_u32 s37, s37, 0
  ds_read_b64_tr_b16 v[76:77], v13 offset:41216
  buffer_store_dwordx4 v[28:31], v2, s[40:43], s64 offen offset:1024 sc1
  v_mfma_f32_16x16x32_bf16 v[132:135], v[40:43], v[228:231], v[132:135]
  ds_read_b64_tr_b16 v[78:79], v13 offset:42240
  v_accvgpr_read_b32 v16, a176
  v_accvgpr_read_b32 v17, a177
  v_mfma_f32_16x16x32_bf16 v[148:151], v[44:47], v[228:231], v[148:151]
  ds_read_b128 v[240:243], v14 offset:32768
  v_accvgpr_read_b32 v18, a178
  v_accvgpr_read_b32 v19, a179
  v_mfma_f32_16x16x32_bf16 v[164:167], v[48:51], v[228:231], v[164:167]
  ds_read_b128 v[244:247], v14 offset:33792
  v_accvgpr_read_b32 v20, a180
  v_accvgpr_read_b32 v21, a181
  v_mfma_f32_16x16x32_bf16 v[180:183], v[52:55], v[228:231], v[180:183]
  v_accvgpr_read_b32 v22, a182
  v_accvgpr_read_b32 v23, a183
  v_mul_f32 v16, s76, v16
  v_mfma_f32_16x16x32_bf16 v[196:199], v[56:59], v[228:231], v[196:199]
  ds_read_b64_tr_b16 v[80:81], v12 offset:41472
  v_mul_f32 v17, s76, v17
  v_mfma_f32_16x16x32_bf16 v[212:215], v[60:63], v[228:231], v[212:215]
  ds_read_b64_tr_b16 v[82:83], v12 offset:42496
  v_mul_f32 v18, s76, v18
  v_mul_f32 v19, s76, v19
  v_mfma_f32_16x16x32_bf16 v[104:107], v[32:35], v[232:235], v[104:107]
  ds_read_b64_tr_b16 v[84:85], v13 offset:41472
  v_mul_f32 v20, s76, v20
  v_mul_f32 v21, s76, v21
  v_mfma_f32_16x16x32_bf16 v[120:123], v[36:39], v[232:235], v[120:123]
  ds_read_b64_tr_b16 v[86:87], v13 offset:42496
  v_mul_f32 v22, s76, v22
  v_mul_f32 v23, s76, v23
  v_mfma_f32_16x16x32_bf16 v[136:139], v[40:43], v[232:235], v[136:139]
  v_cvt_pk_bf16_f32 v24, v16, v17
  v_cvt_pk_bf16_f32 v25, v18, v19
  v_cvt_pk_bf16_f32 v26, v20, v21
  v_mfma_f32_16x16x32_bf16 v[152:155], v[44:47], v[232:235], v[152:155]
  ds_read_b64_tr_b16 v[88:89], v12 offset:41728
  v_cvt_pk_bf16_f32 v27, v22, v23
  v_mfma_f32_16x16x32_bf16 v[168:171], v[48:51], v[232:235], v[168:171]
  ds_read_b64_tr_b16 v[90:91], v12 offset:42752
  buffer_store_dwordx4 v[24:27], v2, s[40:43], s64 offen offset:2048 sc1
  v_accvgpr_read_b32 v16, a184
  v_mfma_f32_16x16x32_bf16 v[184:187], v[52:55], v[232:235], v[184:187]
  ds_read_b64_tr_b16 v[92:93], v13 offset:41728
  v_accvgpr_read_b32 v17, a185
  v_accvgpr_read_b32 v18, a186
  v_mfma_f32_16x16x32_bf16 v[200:203], v[56:59], v[232:235], v[200:203]
  ds_read_b64_tr_b16 v[94:95], v13 offset:42752
  v_accvgpr_read_b32 v19, a187
  v_accvgpr_read_b32 v20, a188
  v_mfma_f32_16x16x32_bf16 v[216:219], v[60:63], v[232:235], v[216:219]
  v_accvgpr_read_b32 v21, a189
  v_accvgpr_read_b32 v22, a190
  v_accvgpr_read_b32 v23, a191
  v_mfma_f32_16x16x32_bf16 v[108:111], v[32:35], v[236:239], v[108:111]
  ds_read_b128 v[248:251], v14 offset:34816
  v_mul_f32 v16, s76, v16
  v_mfma_f32_16x16x32_bf16 v[124:127], v[36:39], v[236:239], v[124:127]
  ds_read_b128 v[252:255], v14 offset:35840
  v_mul_f32 v17, s76, v17
  v_mul_f32 v18, s76, v18
  v_mfma_f32_16x16x32_bf16 v[140:143], v[40:43], v[236:239], v[140:143]
  v_mul_f32 v19, s76, v19
  v_mul_f32 v20, s76, v20
  v_mul_f32 v21, s76, v21
  v_mfma_f32_16x16x32_bf16 v[156:159], v[44:47], v[236:239], v[156:159]
  v_xor_b32 v14, 0x10000, v14
  v_mul_f32 v22, s76, v22
  v_mul_f32 v23, s76, v23
  v_mfma_f32_16x16x32_bf16 v[172:175], v[48:51], v[236:239], v[172:175]
  v_cvt_pk_bf16_f32 v28, v16, v17
  v_cvt_pk_bf16_f32 v29, v18, v19
  v_cvt_pk_bf16_f32 v30, v20, v21
  v_mfma_f32_16x16x32_bf16 v[188:191], v[52:55], v[236:239], v[188:191]
  v_xor_b32 v12, 0x10000, v12
  v_cvt_pk_bf16_f32 v31, v22, v23
  v_mfma_f32_16x16x32_bf16 v[204:207], v[56:59], v[236:239], v[204:207]
  buffer_store_dwordx4 v[28:31], v2, s[40:43], s64 offen offset:3072 sc1
  v_xor_b32 v13, 0x10000, v13
  v_mfma_f32_16x16x32_bf16 v[220:223], v[60:63], v[236:239], v[220:223]
  s_waitcnt vmcnt(9) lgkmcnt(0)
  v_mfma_f32_16x16x32_bf16 v[96:99], v[64:67], v[240:243], v[96:99]
  s_barrier
  v_cmp_eq_u32 vcc, 0, v15
  v_mfma_f32_16x16x32_bf16 v[112:115], v[68:71], v[240:243], v[112:115]
  s_cbranch_vccnz fa_kv_spin
fa_kv_ok:
  v_mfma_f32_16x16x32_bf16 v[128:131], v[72:75], v[240:243], v[128:131]
  s_mov_b32 m0, s24
  v_mov_b32 v228, 0
  v_mfma_f32_16x16x32_bf16 v[144:147], v[76:79], v[240:243], v[144:147]
  buffer_load_dwordx4 v2, s[44:47], s26 offen offset:0 sc1 lds
  v_mfma_f32_16x16x32_bf16 v[160:163], v[80:83], v[240:243], v[160:163]
  s_add_u32 s24, s24, 32768
  v_mov_b32 v229, 0
  v_mfma_f32_16x16x32_bf16 v[176:179], v[84:87], v[240:243], v[176:179]
  s_and_b32 s24, s24, 0x1ffff
  buffer_load_dwordx4 v2, s[44:47], s26 offen offset:1024 sc1 lds
  v_mfma_f32_16x16x32_bf16 v[192:195], v[88:91], v[240:243], v[192:195]
  v_mov_b32 v230, 0
  v_mfma_f32_16x16x32_bf16 v[208:211], v[92:95], v[240:243], v[208:211]
  buffer_load_dwordx4 v2, s[44:47], s26 offen offset:2048 sc1 lds
  v_mfma_f32_16x16x32_bf16 v[100:103], v[64:67], v[244:247], v[100:103]
  v_mov_b32 v231, 0
  v_mfma_f32_16x16x32_bf16 v[116:119], v[68:71], v[244:247], v[116:119]
  buffer_load_dwordx4 v2, s[44:47], s26 offen offset:3072 sc1 lds
  v_mfma_f32_16x16x32_bf16 v[132:135], v[72:75], v[244:247], v[132:135]
  s_add_u32 s26, s26, 16384
  v_cvt_pk_bf16_f32 v32, v96, v97
  v_cvt_pk_bf16_f32 v33, v98, v99
  v_mfma_f32_16x16x32_bf16 v[148:151], v[76:79], v[244:247], v[148:151]
  v_cvt_pk_bf16_f32 v34, v112, v113
  v_cvt_pk_bf16_f32 v35, v114, v115
  v_mfma_f32_16x16x32_bf16 v[164:167], v[80:83], v[244:247], v[164:167]
  s_mov_b32 m0, s24
  v_cvt_pk_bf16_f32 v40, v128, v129
  v_mfma_f32_16x16x32_bf16 v[180:183], v[84:87], v[244:247], v[180:183]
  buffer_load_dwordx4 v2, s[44:47], s26 offen offset:0 sc1 lds
  v_cvt_pk_bf16_f32 v41, v130, v131
  v_cvt_pk_bf16_f32 v42, v144, v145
  v_mfma_f32_16x16x32_bf16 v[196:199], v[88:91], v[244:247], v[196:199]
  s_add_u32 s24, s24, 32768
  v_cvt_pk_bf16_f32 v43, v146, v147
  v_mfma_f32_16x16x32_bf16 v[212:215], v[92:95], v[244:247], v[212:215]
  s_and_b32 s24, s24, 0x1ffff
  buffer_load_dwordx4 v2, s[44:47], s26 offen offset:1024 sc1 lds
  v_cvt_pk_bf16_f32 v48, v160, v161
  v_cvt_pk_bf16_f32 v49, v162, v163
  v_mfma_f32_16x16x32_bf16 v[104:107], v[64:67], v[248:251], v[104:107]
  v_cvt_pk_bf16_f32 v50, v176, v177
  v_cvt_pk_bf16_f32 v51, v178, v179
  v_mfma_f32_16x16x32_bf16 v[120:123], v[68:71], v[248:251], v[120:123]
  buffer_load_dwordx4 v2, s[44:47], s26 offen offset:2048 sc1 lds
  v_cvt_pk_bf16_f32 v56, v192, v193
  v_mfma_f32_16x16x32_bf16 v[136:139], v[72:75], v[248:251], v[136:139]
  v_cvt_pk_bf16_f32 v57, v194, v195
  v_cvt_pk_bf16_f32 v58, v208, v209
  v_mfma_f32_16x16x32_bf16 v[152:155], v[76:79], v[248:251], v[152:155]
  buffer_load_dwordx4 v2, s[44:47], s26 offen offset:3072 sc1 lds
  v_cvt_pk_bf16_f32 v59, v210, v211
  v_mfma_f32_16x16x32_bf16 v[168:171], v[80:83], v[248:251], v[168:171]
  s_add_u32 s26, s26, 16384
  v_cvt_pk_bf16_f32 v36, v100, v101
  v_cvt_pk_bf16_f32 v37, v102, v103
  v_mfma_f32_16x16x32_bf16 v[184:187], v[84:87], v[248:251], v[184:187]
  v_cvt_pk_bf16_f32 v38, v116, v117
  v_mfma_f32_16x16x32_bf16 v[200:203], v[88:91], v[248:251], v[200:203]
  s_mov_b32 m0, s24
  v_cvt_pk_bf16_f32 v39, v118, v119
  v_cvt_pk_bf16_f32 v44, v132, v133
  v_mfma_f32_16x16x32_bf16 v[216:219], v[92:95], v[248:251], v[216:219]
  buffer_load_dwordx4 v2, s[44:47], s26 offen offset:0 sc1 lds
  v_cvt_pk_bf16_f32 v45, v134, v135
  v_mfma_f32_16x16x32_bf16 v[108:111], v[64:67], v[252:255], v[108:111]
  s_add_u32 s24, s24, 32768
  v_cvt_pk_bf16_f32 v46, v148, v149
  v_cvt_pk_bf16_f32 v47, v150, v151
  v_mfma_f32_16x16x32_bf16 v[124:127], v[68:71], v[252:255], v[124:127]
  s_and_b32 s24, s24, 0x1ffff
  buffer_load_dwordx4 v2, s[44:47], s26 offen offset:1024 sc1 lds
  v_cvt_pk_bf16_f32 v52, v164, v165
  v_mfma_f32_16x16x32_bf16 v[140:143], v[72:75], v[252:255], v[140:143]
  v_cvt_pk_bf16_f32 v53, v166, v167
  v_cvt_pk_bf16_f32 v54, v180, v181
  v_mfma_f32_16x16x32_bf16 v[156:159], v[76:79], v[252:255], v[156:159]
  buffer_load_dwordx4 v2, s[44:47], s26 offen offset:2048 sc1 lds
  v_cvt_pk_bf16_f32 v55, v182, v183
  v_mfma_f32_16x16x32_bf16 v[172:175], v[80:83], v[252:255], v[172:175]
  v_cvt_pk_bf16_f32 v60, v196, v197
  v_cvt_pk_bf16_f32 v61, v198, v199
  v_mfma_f32_16x16x32_bf16 v[188:191], v[84:87], v[252:255], v[188:191]
  buffer_load_dwordx4 v2, s[44:47], s26 offen offset:3072 sc1 lds
  v_cvt_pk_bf16_f32 v62, v212, v213
  v_mfma_f32_16x16x32_bf16 v[204:207], v[88:91], v[252:255], v[204:207]
  s_add_u32 s26, s26, 16384
  v_cvt_pk_bf16_f32 v63, v214, v215
  v_mfma_f32_16x16x32_bf16 v[220:223], v[92:95], v[252:255], v[220:223]
  s_mov_b32 m0, s25
  s_nop 0
  v_mfma_f32_32x32x16_bf16 a[0:15], v[228:231], v[228:231], 0
  buffer_load_dwordx4 v2, s[48:51], s27 offen offset:0 sc1 lds
  v_cvt_pk_bf16_f32 v64, v104, v105
  v_cvt_pk_bf16_f32 v65, v106, v107
  v_cvt_pk_bf16_f32 v66, v120, v121
  v_cvt_pk_bf16_f32 v67, v122, v123
  v_mfma_f32_32x32x16_bf16 a[16:31], v[228:231], v[228:231], 0
  buffer_load_dwordx4 v2, s[48:51], s27 offen offset:1024 sc1 lds
  v_cvt_pk_bf16_f32 v72, v136, v137
  v_cvt_pk_bf16_f32 v73, v138, v139
  v_cvt_pk_bf16_f32 v74, v152, v153
  v_cvt_pk_bf16_f32 v75, v154, v155
  v_mfma_f32_32x32x16_bf16 a[32:47], v[228:231], v[228:231], 0
  buffer_load_dwordx4 v2, s[48:51], s27 offen offset:2048 sc1 lds
  v_cvt_pk_bf16_f32 v80, v168, v169
  v_cvt_pk_bf16_f32 v81, v170, v171
  v_cvt_pk_bf16_f32 v82, v184, v185
  v_cvt_pk_bf16_f32 v83, v186, v187
  v_mfma_f32_32x32x16_bf16 a[48:63], v[228:231], v[228:231], 0
  buffer_load_dwordx4 v2, s[48:51], s27 offen offset:3072 sc1 lds
  v_cvt_pk_bf16_f32 v88, v200, v201
  v_cvt_pk_bf16_f32 v89, v202, v203
  v_cvt_pk_bf16_f32 v90, v216, v217
  v_cvt_pk_bf16_f32 v91, v218, v219
  s_add_u32 s27, s27, 16384
  s_add_u32 s25, s25, 32768
  s_and_b32 s25, s25, 0x1ffff
  s_mov_b32 m0, s25
  s_nop 0
  v_mfma_f32_32x32x16_bf16 a[64:79], v[228:231], v[228:231], 0
  buffer_load_dwordx4 v2, s[48:51], s27 offen offset:0 sc1 lds
  v_cvt_pk_bf16_f32 v68, v108, v109
  v_cvt_pk_bf16_f32 v69, v110, v111
  v_cvt_pk_bf16_f32 v70, v124, v125
  v_cvt_pk_bf16_f32 v71, v126, v127
  v_mfma_f32_32x32x16_bf16 a[80:95], v[228:231], v[228:231], 0
  buffer_load_dwordx4 v2, s[48:51], s27 offen offset:1024 sc1 lds
  v_cvt_pk_bf16_f32 v76, v140, v141
  v_cvt_pk_bf16_f32 v77, v142, v143
  v_cvt_pk_bf16_f32 v78, v156, v157
  v_cvt_pk_bf16_f32 v79, v158, v159
  v_mfma_f32_32x32x16_bf16 a[96:111], v[228:231], v[228:231], 0
  buffer_load_dwordx4 v2, s[48:51], s27 offen offset:2048 sc1 lds
  v_cvt_pk_bf16_f32 v84, v172, v173
  v_cvt_pk_bf16_f32 v85, v174, v175
  v_cvt_pk_bf16_f32 v86, v188, v189
  v_cvt_pk_bf16_f32 v87, v190, v191
  v_mfma_f32_32x32x16_bf16 a[112:127], v[228:231], v[228:231], 0
  buffer_load_dwordx4 v2, s[48:51], s27 offen offset:3072 sc1 lds
  v_cvt_pk_bf16_f32 v92, v204, v205
  v_cvt_pk_bf16_f32 v93, v206, v207
  v_cvt_pk_bf16_f32 v94, v220, v221
  v_cvt_pk_bf16_f32 v95, v222, v223
  s_add_u32 s27, s27, 16384
  s_add_u32 s25, s25, 32768
  s_and_b32 s25, s25, 0x1ffff
  s_waitcnt vmcnt(12)
  s_barrier
  ds_read_b128 a[128:131], v9 offset:0
  ds_read_b128 a[132:135], v9 offset:1024
  ds_read_b128 a[136:139], v9 offset:2048
  ds_read_b128 a[140:143], v9 offset:3072
  ds_read_b128 a[144:147], v9 offset:4096
  ds_read_b128 a[148:151], v9 offset:5120
  ds_read_b128 a[152:155], v9 offset:6144
  ds_read_b128 a[156:159], v9 offset:7168
  buffer_store_dword v4, off, s[40:43], s65 offset:32 sc1
  v_add_u32 v13, 32, v8
  v_mov_b32 v14, 0
  s_cmp_eq_u32 s2, 255
  s_cbranch_scc1 fa_top8
fa_notop:
  s_waitcnt lgkmcnt(4)
  v_mfma_f32_16x16x32_bf16 v[96:99], a[128:131], v[32:35], 0
  v_mfma_f32_16x16x32_bf16 v[104:107], a[128:131], v[36:39], 0
  v_mfma_f32_16x16x32_bf16 v[128:131], a[128:131], v[64:67], 0
  v_mfma_f32_16x16x32_bf16 v[136:139], a[128:131], v[68:71], 0
  s_mov_b32 m0, s24
  ds_read_b128 a[128:131], v3 offset:0
  v_mfma_f32_16x16x32_bf16 v[100:103], a[132:135], v[32:35], 0
  buffer_load_dwordx4 v2, s[44:47], s26 offen offset:0 sc1 lds
  v_mfma_f32_16x16x32_bf16 v[108:111], a[132:135], v[36:39], 0
  v_mfma_f32_16x16x32_bf16 v[132:135], a[132:135], v[64:67], 0
  v_mfma_f32_16x16x32_bf16 v[140:143], a[132:135], v[68:71], 0
  ds_read_b128 a[132:135], v3 offset:1024
  v_mfma_f32_16x16x32_bf16 v[96:99], a[136:139], v[40:43], v[96:99]
  v_mfma_f32_16x16x32_bf16 v[104:107], a[136:139], v[44:47], v[104:107]
  v_mfma_f32_16x16x32_bf16 v[128:131], a[136:139], v[72:75], v[128:131]
  buffer_load_dwordx4 v2, s[44:47], s26 offen offset:1024 sc1 lds
  v_mfma_f32_16x16x32_bf16 v[136:139], a[136:139], v[76:79], v[136:139]
  ds_read_b128 a[136:139], v3 offset:2048
  v_mfma_f32_16x16x32_bf16 v[100:103], a[140:143], v[40:43], v[100:103]
  v_mfma_f32_16x16x32_bf16 v[108:111], a[140:143], v[44:47], v[108:111]
  v_mfma_f32_16x16x32_bf16 v[132:135], a[140:143], v[72:75], v[132:135]
  v_mfma_f32_16x16x32_bf16 v[140:143], a[140:143], v[76:79], v[140:143]
  s_waitcnt lgkmcnt(3)
  ds_read_b128 a[140:143], v3 offset:3072
  v_mfma_f32_16x16x32_bf16 v[96:99], a[144:147], v[48:51], v[96:99]
  v_mfma_f32_16x16x32_bf16 v[104:107], a[144:147], v[52:55], v[104:107]
  v_mfma_f32_16x16x32_bf16 v[128:131], a[144:147], v[80:83], v[128:131]
  buffer_load_dwordx4 v2, s[44:47], s26 offen offset:2048 sc1 lds
  v_mfma_f32_16x16x32_bf16 v[136:139], a[144:147], v[84:87], v[136:139]
  ds_read_b128 a[144:147], v3 offset:4096
  v_mfma_f32_16x16x32_bf16 v[100:103], a[148:151], v[48:51], v[100:103]
  v_mfma_f32_16x16x32_bf16 v[108:111], a[148:151], v[52:55], v[108:111]
  v_mfma_f32_16x16x32_bf16 v[132:135], a[148:151], v[80:83], v[132:135]
  v_mfma_f32_16x16x32_bf16 v[140:143], a[148:151], v[84:87], v[140:143]
  ds_read_b128 a[148:151], v3 offset:5120
  v_mfma_f32_16x16x32_bf16 v[96:99], a[152:155], v[56:59], v[96:99]
  buffer_load_dwordx4 v2, s[44:47], s26 offen offset:3072 sc1 lds
  v_mfma_f32_16x16x32_bf16 v[104:107], a[152:155], v[60:63], v[104:107]
  s_add_u32 s26, s26, 16384
  v_mfma_f32_16x16x32_bf16 v[128:131], a[152:155], v[88:91], v[128:131]
  s_add_u32 s24, s24, 32768
  v_mfma_f32_16x16x32_bf16 v[136:139], a[152:155], v[92:95], v[136:139]
  s_and_b32 s24, s24, 0x1ffff
  ds_read_b128 a[152:155], v3 offset:6144
  v_mfma_f32_16x16x32_bf16 v[100:103], a[156:159], v[56:59], v[100:103]
  v_mfma_f32_16x16x32_bf16 v[108:111], a[156:159], v[60:63], v[108:111]
  v_mfma_f32_16x16x32_bf16 v[132:135], a[156:159], v[88:91], v[132:135]
  v_mfma_f32_16x16x32_bf16 v[140:143], a[156:159], v[92:95], v[140:143]
  s_waitcnt lgkmcnt(3)
  ds_read_b128 a[156:159], v3 offset:7168
  s_nop 7
  s_cmp_lg_u32 s28, 0
  s_cbranch_scc1 fa_nomask0
  v_cndmask_b32 v96, v4, v96, s[68:69]
  v_cndmask_b32 v97, v4, v97, s[70:71]
  v_cndmask_b32 v98, v4, v98, s[72:73]
  v_cndmask_b32 v99, v4, v99, s[74:75]
  v_mov_b32 v100, v4
  v_mov_b32 v101, v4
  v_mov_b32 v102, v4
  v_mov_b32 v103, v4
  v_cndmask_b32 v108, v4, v108, s[68:69]
  v_cndmask_b32 v109, v4, v109, s[70:71]
  v_cndmask_b32 v110, v4, v110, s[72:73]
  v_cndmask_b32 v111, v4, v111, s[74:75]
fa_nomask0:
  v_max3_f32 v16, v96, v97, v98
  v_max3_f32 v16, v16, v99, v100
  v_max3_f32 v16, v16, v101, v102
  v_max_f32 v16, v16, v103
  v_max3_f32 v17, v104, v105, v106
  v_max3_f32 v17, v17, v107, v108
  v_max3_f32 v17, v17, v109, v110
  v_max_f32 v17, v17, v111
  v_max3_f32 v18, v128, v129, v130
  v_max3_f32 v18, v18, v131, v132
  v_max3_f32 v18, v18, v133, v134
  v_max_f32 v18, v18, v135
  v_max3_f32 v19, v136, v137, v138
  v_max3_f32 v19, v19, v139, v140
  v_max3_f32 v19, v19, v141, v142
  v_max_f32 v19, v19, v143
  v_mov_b32 v20, v16
  v_mov_b32 v21, v17
  v_mov_b32 v22, v18
  v_mov_b32 v23, v19
  s_nop 0
  v_permlane16_swap_b32 v16, v20
  v_permlane16_swap_b32 v17, v21
  v_permlane16_swap_b32 v18, v22
  v_permlane16_swap_b32 v19, v23
  v_max_f32 v16, v16, v20
  v_max_f32 v17, v17, v21
  v_max_f32 v18, v18, v22
  v_max_f32 v19, v19, v23
  v_mov_b32 v20, v16
  v_mov_b32 v21, v17
  v_mov_b32 v22, v18
  v_mov_b32 v23, v19
  s_nop 0
  v_permlane32_swap_b32 v16, v20
  v_permlane32_swap_b32 v17, v21
  v_permlane32_swap_b32 v18, v22
  v_permlane32_swap_b32 v19, v23
  v_max_f32 v16, v16, v20
  v_max_f32 v17, v17, v21
  v_max_f32 v18, v18, v22
  v_max_f32 v19, v19, v23
  v_sub_f32 v192, 0, v16
  v_sub_f32 v193, 0, v16
  v_sub_f32 v194, 0, v16
  v_sub_f32 v195, 0, v16
  v_sub_f32 v196, 0, v17
  v_sub_f32 v197, 0, v17
  v_sub_f32 v198, 0, v17
  v_sub_f32 v199, 0, v17
  v_sub_f32 v200, 0, v18
  v_sub_f32 v201, 0, v18
  v_sub_f32 v202, 0, v18
  v_sub_f32 v203, 0, v18
  v_sub_f32 v204, 0, v19
  v_sub_f32 v205, 0, v19
  v_sub_f32 v206, 0, v19
  v_sub_f32 v207, 0, v19
  v_sub_f32 v96, v96, v16
  v_sub_f32 v97, v97, v16
  v_sub_f32 v98, v98, v16
  v_sub_f32 v99, v99, v16
  v_sub_f32 v100, v100, v16
  v_sub_f32 v101, v101, v16
  v_sub_f32 v102, v102, v16
  v_sub_f32 v103, v103, v16
  v_sub_f32 v104, v104, v17
  v_sub_f32 v105, v105, v17
  v_sub_f32 v106, v106, v17
  v_sub_f32 v107, v107, v17
  v_sub_f32 v108, v108, v17
  v_sub_f32 v109, v109, v17
  v_sub_f32 v110, v110, v17
  v_sub_f32 v111, v111, v17
  v_sub_f32 v128, v128, v18
  v_sub_f32 v129, v129, v18
  v_sub_f32 v130, v130, v18
  v_sub_f32 v131, v131, v18
  v_sub_f32 v132, v132, v18
  v_sub_f32 v133, v133, v18
  v_sub_f32 v134, v134, v18
  v_sub_f32 v135, v135, v18
  v_sub_f32 v136, v136, v19
  v_sub_f32 v137, v137, v19
  v_sub_f32 v138, v138, v19
  v_sub_f32 v139, v139, v19
  v_sub_f32 v140, v140, v19
  v_sub_f32 v141, v141, v19
  v_sub_f32 v142, v142, v19
  v_sub_f32 v143, v143, v19
  v_mfma_f32_16x16x32_bf16 v[112:115], a[128:131], v[32:35], v[192:195]
  v_exp_f32 v216, v128
  v_exp_f32 v217, v129
  v_mfma_f32_16x16x32_bf16 v[120:123], a[128:131], v[36:39], v[196:199]
  v_exp_f32 v218, v130
  v_add_f32 v226, v216, v217
  v_cvt_pk_bf16_f32 v176, v216, v217
  v_mfma_f32_16x16x32_bf16 v[144:147], a[128:131], v[64:67], v[200:203]
  s_add_u32 s66, s66, 32768
  v_exp_f32 v219, v131
  v_add_f32 v226, v226, v218
  v_add_f32 v226, v226, v219
  v_mfma_f32_16x16x32_bf16 v[152:155], a[128:131], v[68:71], v[204:207]
  s_mov_b32 m0, s25
  ds_read_b128 a[128:131], v3 offset:8192
  v_exp_f32 v220, v132
  v_cvt_pk_bf16_f32 v177, v218, v219
  v_mfma_f32_16x16x32_bf16 v[116:119], a[132:135], v[32:35], v[192:195]
  s_and_b32 s66, s66, 0x1ffff
  buffer_load_dwordx4 v2, s[48:51], s27 offen offset:0 sc1 lds
  v_exp_f32 v221, v133
  v_add_f32 v226, v226, v220
  v_add_f32 v226, v226, v221
  v_mfma_f32_16x16x32_bf16 v[124:127], a[132:135], v[36:39], v[196:199]
  v_exp_f32 v222, v134
  v_cvt_pk_bf16_f32 v178, v220, v221
  v_exp_f32 v223, v135
  v_mfma_f32_16x16x32_bf16 v[148:151], a[132:135], v[64:67], v[200:203]
  v_exp_f32 v216, v136
  v_add_f32 v226, v226, v222
  v_mfma_f32_16x16x32_bf16 v[156:159], a[132:135], v[68:71], v[204:207]
  ds_read_b128 a[132:135], v3 offset:9216
  v_exp_f32 v217, v137
  v_add_f32 v226, v226, v223
  v_mfma_f32_16x16x32_bf16 v[112:115], a[136:139], v[40:43], v[112:115]
  v_exp_f32 v218, v138
  v_cvt_pk_bf16_f32 v179, v222, v223
  v_add_f32 v227, v216, v217
  v_mfma_f32_16x16x32_bf16 v[120:123], a[136:139], v[44:47], v[120:123]
  v_exp_f32 v219, v139
  v_cvt_pk_bf16_f32 v180, v216, v217
  v_add_f32 v227, v227, v218
  v_add_f32 v227, v227, v219
  v_mfma_f32_16x16x32_bf16 v[144:147], a[136:139], v[72:75], v[144:147]
  buffer_load_dwordx4 v2, s[48:51], s27 offen offset:1024 sc1 lds
  v_exp_f32 v220, v140
  v_cvt_pk_bf16_f32 v181, v218, v219
  v_mfma_f32_16x16x32_bf16 v[152:155], a[136:139], v[76:79], v[152:155]
  ds_read_b128 a[136:139], v3 offset:10240
  v_exp_f32 v221, v141
  v_add_f32 v227, v227, v220
  v_mfma_f32_16x16x32_bf16 v[116:119], a[140:143], v[40:43], v[116:119]
  v_exp_f32 v222, v142
  v_add_f32 v227, v227, v221
  v_cvt_pk_bf16_f32 v182, v220, v221
  v_mfma_f32_16x16x32_bf16 v[124:127], a[140:143], v[44:47], v[124:127]
  v_exp_f32 v223, v143
  v_add_f32 v227, v227, v222
  v_add_f32 v227, v227, v223
  v_exp_f32 v208, v96
  v_mfma_f32_16x16x32_bf16 v[148:151], a[140:143], v[72:75], v[148:151]
  v_exp_f32 v209, v97
  v_cvt_pk_bf16_f32 v183, v222, v223
  v_mfma_f32_16x16x32_bf16 v[156:159], a[140:143], v[76:79], v[156:159]
  s_waitcnt lgkmcnt(3)
  ds_read_b128 a[140:143], v3 offset:11264
  v_exp_f32 v210, v98
  v_add_f32 v224, v208, v209
  v_mfma_f32_16x16x32_bf16 v[112:115], a[144:147], v[48:51], v[112:115]
  v_exp_f32 v211, v99
  v_cvt_pk_bf16_f32 v160, v208, v209
  v_add_f32 v224, v224, v210
  v_mfma_f32_16x16x32_bf16 v[120:123], a[144:147], v[52:55], v[120:123]
  v_exp_f32 v212, v100
  v_add_f32 v224, v224, v211
  v_cvt_pk_bf16_f32 v161, v210, v211
  v_mfma_f32_16x16x32_bf16 v[144:147], a[144:147], v[80:83], v[144:147]
  buffer_load_dwordx4 v2, s[48:51], s27 offen offset:2048 sc1 lds
  v_exp_f32 v213, v101
  v_add_f32 v224, v224, v212
  v_add_f32 v224, v224, v213
  v_mfma_f32_16x16x32_bf16 v[152:155], a[144:147], v[84:87], v[152:155]
  ds_read_b128 a[144:147], v3 offset:12288
  v_exp_f32 v214, v102
  v_cvt_pk_bf16_f32 v162, v212, v213
  v_mfma_f32_16x16x32_bf16 v[116:119], a[148:151], v[48:51], v[116:119]
  v_exp_f32 v215, v103
  v_add_f32 v224, v224, v214
  v_add_f32 v224, v224, v215
  v_mfma_f32_16x16x32_bf16 v[124:127], a[148:151], v[52:55], v[124:127]
  v_exp_f32 v208, v104
  v_exp_f32 v209, v105
  v_mfma_f32_16x16x32_bf16 v[148:151], a[148:151], v[80:83], v[148:151]
  v_exp_f32 v210, v106
  v_cvt_pk_bf16_f32 v163, v214, v215
  v_add_f32 v225, v208, v209
  v_mfma_f32_16x16x32_bf16 v[156:159], a[148:151], v[84:87], v[156:159]
  ds_read_b128 a[148:151], v3 offset:13312
  v_exp_f32 v211, v107
  v_cvt_pk_bf16_f32 v164, v208, v209
  v_add_f32 v225, v225, v210
  v_mfma_f32_16x16x32_bf16 v[112:115], a[152:155], v[56:59], v[112:115]
  buffer_load_dwordx4 v2, s[48:51], s27 offen offset:3072 sc1 lds
  v_exp_f32 v212, v108
  v_add_f32 v225, v225, v211
  v_mfma_f32_16x16x32_bf16 v[120:123], a[152:155], v[60:63], v[120:123]
  s_add_u32 s27, s27, 16384
  v_exp_f32 v213, v109
  v_mfma_f32_16x16x32_bf16 v[144:147], a[152:155], v[88:91], v[144:147]
  s_add_u32 s25, s25, 32768
  v_exp_f32 v214, v110
  v_mfma_f32_16x16x32_bf16 v[152:155], a[152:155], v[92:95], v[152:155]
  s_and_b32 s25, s25, 0x1ffff
  ds_read_b128 a[152:155], v3 offset:14336
  v_cvt_pk_bf16_f32 v165, v210, v211
  v_max3_f32 v5, v226, v227, v224
  v_add_f32 v225, v225, v212
  v_add_f32 v225, v225, v213
  v_cvt_pk_bf16_f32 v166, v212, v213
  v_exp_f32 v215, v111
  v_mfma_f32_16x16x32_bf16 v[116:119], a[156:159], v[56:59], v[116:119]
  v_add_f32 v225, v225, v214
  v_add_f32 v225, v225, v215
  v_max_f32 v5, v5, v225
  v_cmp_lt_f32 vcc, s81, v5
  v_mfma_f32_16x16x32_bf16 v[124:127], a[156:159], v[60:63], v[124:127]
  v_mfma_f32_16x16x32_bf16 v[148:151], a[156:159], v[88:91], v[148:151]
  v_cvt_pk_bf16_f32 v167, v214, v215
  v_mfma_f32_16x16x32_bf16 v[156:159], a[156:159], v[92:95], v[156:159]
  s_waitcnt lgkmcnt(3)
  s_cbranch_vccnz fa_stub0
fa_back0:
  ds_read_b128 a[156:159], v3 offset:15360
  v_add_f32 v228, v228, v224
  v_add_f32 v229, v229, v225
  v_add_f32 v230, v230, v226
  v_add_f32 v231, v231, v227
  s_nop 3
  v_exp_f32 v216, v144
  v_exp_f32 v217, v145
  v_add_u32 v3, s66, v2
  buffer_load_dword v14, v13, s[40:43], 0 offen sc1
  s_cmp_eq_u32 s28, 0
  s_cbranch_scc1 fa_AV
  s_sub_u32 s28, s28, 1
  s_cmp_eq_u32 s28, 0
  s_cbranch_scc1 fa_Aexit
.p2align 6
fa_DD:
  v_mfma_f32_16x16x32_bf16 v[96:99], a[128:131], v[32:35], v[192:195]
  s_waitcnt vmcnt(12)
  v_exp_f32 v218, v146
  v_mfma_f32_16x16x32_bf16 v[104:107], a[128:131], v[36:39], v[196:199]
  s_barrier
  v_exp_f32 v219, v147
  v_mfma_f32_16x16x32_bf16 v[128:131], a[128:131], v[64:67], v[200:203]
  s_cmp_ge_u32 s26, s32
  ds_read_b128 a[160:163], v3 offset:16384
  v_add_f32 v226, v216, v217
  v_mfma_f32_16x16x32_bf16 v[136:139], a[128:131], v[68:71], v[204:207]
  s_cbranch_scc1 fa_hk4
fa_hb4:
  v_exp_f32 v220, v148
  v_mfma_f32_16x16x32_bf16 v[100:103], a[132:135], v[32:35], v[192:195]
  ds_read_b128 a[164:167], v3 offset:17408
  v_cvt_pk_bf16_f32 v184, v216, v217
  v_mfma_f32_16x16x32_bf16 v[108:111], a[132:135], v[36:39], v[196:199]
  s_mov_b32 m0, s24
  v_exp_f32 v221, v149
  v_mfma_f32_16x16x32_bf16 v[132:135], a[132:135], v[64:67], v[200:203]
  buffer_load_dwordx4 v2, s[44:47], s26 offen offset:0 sc1 lds
  v_add_f32 v226, v226, v218
  v_mfma_f32_16x16x32_bf16 v[140:143], a[132:135], v[68:71], v[204:207]
  v_exp_f32 v222, v150
  v_mfma_f32_16x16x32_bf16 v[96:99], a[136:139], v[40:43], v[96:99]
  ds_read_b128 a[168:171], v3 offset:18432
  v_add_f32 v226, v226, v219
  v_mfma_f32_16x16x32_bf16 v[104:107], a[136:139], v[44:47], v[104:107]
  v_exp_f32 v223, v151
  v_mfma_f32_16x16x32_bf16 v[128:131], a[136:139], v[72:75], v[128:131]
  v_cvt_pk_bf16_f32 v185, v218, v219
  v_add_f32 v226, v226, v220
  v_mfma_f32_16x16x32_bf16 v[136:139], a[136:139], v[76:79], v[136:139]
  v_exp_f32 v216, v152
  v_mfma_f32_16x16x32_bf16 v[100:103], a[140:143], v[40:43], v[100:103]
  ds_read_b128 a[172:175], v3 offset:19456
  v_add_f32 v226, v226, v221
  v_mfma_f32_16x16x32_bf16 v[108:111], a[140:143], v[44:47], v[108:111]
  v_exp_f32 v217, v153
  v_mfma_f32_16x16x32_bf16 v[132:135], a[140:143], v[72:75], v[132:135]
  v_cvt_pk_bf16_f32 v186, v220, v221
  v_add_f32 v226, v226, v222
  v_mfma_f32_16x16x32_bf16 v[140:143], a[140:143], v[76:79], v[140:143]
  s_waitcnt lgkmcnt(4)
  v_exp_f32 v218, v154
  v_mfma_f32_16x16x32_bf16 v[96:99], a[144:147], v[48:51], v[96:99]
  ds_read_b128 a[176:179], v3 offset:20480
  v_add_f32 v226, v226, v223
  v_mfma_f32_16x16x32_bf16 v[104:107], a[144:147], v[52:55], v[104:107]
  v_exp_f32 v219, v155
  v_mfma_f32_16x16x32_bf16 v[128:131], a[144:147], v[80:83], v[128:131]
  v_cvt_pk_bf16_f32 v187, v222, v223
  v_add_f32 v227, v216, v217
  v_mfma_f32_16x16x32_bf16 v[136:139], a[144:147], v[84:87], v[136:139]
  v_exp_f32 v220, v156
  v_mfma_f32_16x16x32_bf16 v[100:103], a[148:151], v[48:51], v[100:103]
  ds_read_b128 a[180:183], v3 offset:21504
  v_cvt_pk_bf16_f32 v188, v216, v217
  v_mfma_f32_16x16x32_bf16 v[108:111], a[148:151], v[52:55], v[108:111]
  v_exp_f32 v221, v157
  v_mfma_f32_16x16x32_bf16 v[132:135], a[148:151], v[80:83], v[132:135]
  buffer_load_dwordx4 v2, s[44:47], s26 offen offset:1024 sc1 lds
  v_add_f32 v227, v227, v218
  v_mfma_f32_16x16x32_bf16 v[140:143], a[148:151], v[84:87], v[140:143]
  v_exp_f32 v222, v158
  v_mfma_f32_16x16x32_bf16 v[96:99], a[152:155], v[56:59], v[96:99]
  ds_read_b128 a[184:187], v3 offset:22528
  v_add_f32 v227, v227, v219
  v_mfma_f32_16x16x32_bf16 v[104:107], a[152:155], v[60:63], v[104:107]
  v_exp_f32 v223, v159
  v_mfma_f32_16x16x32_bf16 v[128:131], a[152:155], v[88:91], v[128:131]
  v_cvt_pk_bf16_f32 v189, v218, v219
  v_add_f32 v227, v227, v220
  v_mfma_f32_16x16x32_bf16 v[136:139], a[152:155], v[92:95], v[136:139]
  v_exp_f32 v208, v112
  v_mfma_f32_16x16x32_bf16 v[100:103], a[156:159], v[56:59], v[100:103]
  ds_read_b128 a[188:191], v3 offset:23552
  v_add_f32 v227, v227, v221
  v_mfma_f32_16x16x32_bf16 v[108:111], a[156:159], v[60:63], v[108:111]
  v_exp_f32 v209, v113
  v_mfma_f32_16x16x32_bf16 v[132:135], a[156:159], v[88:91], v[132:135]
  v_cvt_pk_bf16_f32 v190, v220, v221
  v_add_f32 v227, v227, v222
  v_add_f32 v227, v227, v223
  v_mfma_f32_16x16x32_bf16 v[140:143], a[156:159], v[92:95], v[140:143]
  s_waitcnt lgkmcnt(4)
  v_exp_f32 v210, v114
  v_mfma_f32_16x16x32_bf16 a[0:3], a[160:163], v[160:163], a[0:3]
  ds_read_b128 a[128:131], v3 offset:0
  v_cvt_pk_bf16_f32 v191, v222, v223
  v_mfma_f32_16x16x32_bf16 a[4:7], a[160:163], v[164:167], a[4:7]
  v_exp_f32 v211, v115
  v_mfma_f32_16x16x32_bf16 a[64:67], a[160:163], v[176:179], a[64:67]
  v_exp_f32 v212, v116
  v_mfma_f32_16x16x32_bf16 a[68:71], a[160:163], v[180:183], a[68:71]
  v_add_f32 v224, v208, v209
  v_cvt_pk_bf16_f32 v168, v208, v209
  v_mfma_f32_16x16x32_bf16 a[8:11], a[164:167], v[160:163], a[8:11]
  ds_read_b128 a[132:135], v3 offset:1024
  v_add_f32 v224, v224, v210
  v_mfma_f32_16x16x32_bf16 a[12:15], a[164:167], v[164:167], a[12:15]
  v_exp_f32 v213, v117
  v_mfma_f32_16x16x32_bf16 a[72:75], a[164:167], v[176:179], a[72:75]
  buffer_load_dwordx4 v2, s[44:47], s26 offen offset:2048 sc1 lds
  v_add_f32 v224, v224, v211
  v_mfma_f32_16x16x32_bf16 a[76:79], a[164:167], v[180:183], a[76:79]
  v_exp_f32 v214, v118
  v_mfma_f32_16x16x32_bf16 a[16:19], a[168:171], v[160:163], a[16:19]
  ds_read_b128 a[136:139], v3 offset:2048
  v_cvt_pk_bf16_f32 v169, v210, v211
  v_mfma_f32_16x16x32_bf16 a[20:23], a[168:171], v[164:167], a[20:23]
  v_exp_f32 v215, v119
  v_mfma_f32_16x16x32_bf16 a[80:83], a[168:171], v[176:179], a[80:83]
  v_add_f32 v224, v224, v212
  v_add_f32 v224, v224, v213
  v_mfma_f32_16x16x32_bf16 a[84:87], a[168:171], v[180:183], a[84:87]
  v_exp_f32 v208, v120
  v_mfma_f32_16x16x32_bf16 a[24:27], a[172:175], v[160:163], a[24:27]
  ds_read_b128 a[140:143], v3 offset:3072
  v_cvt_pk_bf16_f32 v170, v212, v213
  v_mfma_f32_16x16x32_bf16 a[28:31], a[172:175], v[164:167], a[28:31]
  v_exp_f32 v209, v121
  v_mfma_f32_16x16x32_bf16 a[88:91], a[172:175], v[176:179], a[88:91]
  v_exp_f32 v210, v122
  v_mfma_f32_16x16x32_bf16 a[92:95], a[172:175], v[180:183], a[92:95]
  s_waitcnt lgkmcnt(4)
  v_add_f32 v224, v224, v214
  v_add_f32 v224, v224, v215
  v_mfma_f32_16x16x32_bf16 a[32:35], a[176:179], v[160:163], a[32:35]
  ds_read_b128 a[144:147], v3 offset:4096
  v_cvt_pk_bf16_f32 v171, v214, v215
  v_mfma_f32_16x16x32_bf16 a[36:39], a[176:179], v[164:167], a[36:39]
  v_exp_f32 v211, v123
  v_mfma_f32_16x16x32_bf16 a[96:99], a[176:179], v[176:179], a[96:99]
  v_add_f32 v225, v208, v209
  v_cvt_pk_bf16_f32 v172, v208, v209
  v_mfma_f32_16x16x32_bf16 a[100:103], a[176:179], v[180:183], a[100:103]
  v_exp_f32 v212, v124
  v_mfma_f32_16x16x32_bf16 a[40:43], a[180:183], v[160:163], a[40:43]
  ds_read_b128 a[148:151], v3 offset:5120
  v_add_f32 v225, v225, v210
  v_mfma_f32_16x16x32_bf16 a[44:47], a[180:183], v[164:167], a[44:47]
  v_exp_f32 v213, v125
  v_mfma_f32_16x16x32_bf16 a[104:107], a[180:183], v[176:179], a[104:107]
  buffer_load_dwordx4 v2, s[44:47], s26 offen offset:3072 sc1 lds
  v_add_f32 v225, v225, v211
  v_mfma_f32_16x16x32_bf16 a[108:111], a[180:183], v[180:183], a[108:111]
  s_add_u32 s26, s26, 16384
  v_exp_f32 v214, v126
  v_mfma_f32_16x16x32_bf16 a[48:51], a[184:187], v[160:163], a[48:51]
  s_add_u32 s24, s24, 32768
  ds_read_b128 a[152:155], v3 offset:6144
  v_cvt_pk_bf16_f32 v173, v210, v211
  v_mfma_f32_16x16x32_bf16 a[52:55], a[184:187], v[164:167], a[52:55]
  s_and_b32 s24, s24, 0x1ffff
  v_exp_f32 v215, v127
  v_mfma_f32_16x16x32_bf16 a[112:115], a[184:187], v[176:179], a[112:115]
  v_max3_f32 v5, v226, v227, v224
  v_add_f32 v225, v225, v212
  v_mfma_f32_16x16x32_bf16 a[116:119], a[184:187], v[180:183], a[116:119]
  v_add_f32 v225, v225, v213
  v_cvt_pk_bf16_f32 v174, v212, v213
  v_add_f32 v225, v225, v214
  v_mfma_f32_16x16x32_bf16 a[56:59], a[188:191], v[160:163], a[56:59]
  ds_read_b128 a[156:159], v3 offset:7168
  v_add_f32 v225, v225, v215
  v_max_f32 v5, v5, v225
  v_cmp_lt_f32 vcc, s81, v5
  v_mfma_f32_16x16x32_bf16 a[60:63], a[188:191], v[164:167], a[60:63]
  v_exp_f32 v216, v128
  v_mfma_f32_16x16x32_bf16 a[120:123], a[188:191], v[176:179], a[120:123]
  s_waitcnt lgkmcnt(4)
  v_cvt_pk_bf16_f32 v175, v214, v215
  v_mfma_f32_16x16x32_bf16 a[124:127], a[188:191], v[180:183], a[124:127]
  s_cbranch_vccnz fa_stub1
fa_back1:
  v_exp_f32 v217, v129
  v_add_f32 v228, v228, v224
  v_add_f32 v229, v229, v225
  v_add_f32 v230, v230, v226
  v_add_f32 v231, v231, v227
fa_DDe:
  v_mfma_f32_16x16x32_bf16 v[112:115], a[128:131], v[32:35], v[192:195]
  ds_read_b128 a[160:163], v3 offset:24576
  v_add_f32 v226, v216, v217
  v_mfma_f32_16x16x32_bf16 v[120:123], a[128:131], v[36:39], v[196:199]
  v_exp_f32 v218, v130
  v_mfma_f32_16x16x32_bf16 v[144:147], a[128:131], v[64:67], v[200:203]
  s_cmp_ge_u32 s26, s9
  v_exp_f32 v219, v131
  v_mfma_f32_16x16x32_bf16 v[152:155], a[128:131], v[68:71], v[204:207]
  s_cbranch_scc1 fa_hk5
fa_hb5:
  v_exp_f32 v220, v132
  v_mfma_f32_16x16x32_bf16 v[116:119], a[132:135], v[32:35], v[192:195]
  s_add_u32 s66, s66, 32768
  ds_read_b128 a[164:167], v3 offset:25600
  v_cvt_pk_bf16_f32 v176, v216, v217
  v_mfma_f32_16x16x32_bf16 v[124:127], a[132:135], v[36:39], v[196:199]
  s_mov_b32 m0, s25
  v_exp_f32 v221, v133
  v_mfma_f32_16x16x32_bf16 v[148:151], a[132:135], v[64:67], v[200:203]
  s_and_b32 s66, s66, 0x1ffff
  buffer_load_dwordx4 v2, s[48:51], s27 offen offset:0 sc1 lds
  v_add_f32 v226, v226, v218
  v_mfma_f32_16x16x32_bf16 v[156:159], a[132:135], v[68:71], v[204:207]
  v_exp_f32 v222, v134
  v_mfma_f32_16x16x32_bf16 v[112:115], a[136:139], v[40:43], v[112:115]
  ds_read_b128 a[168:171], v3 offset:26624
  v_add_f32 v226, v226, v219
  v_mfma_f32_16x16x32_bf16 v[120:123], a[136:139], v[44:47], v[120:123]
  v_exp_f32 v223, v135
  v_mfma_f32_16x16x32_bf16 v[144:147], a[136:139], v[72:75], v[144:147]
  v_cvt_pk_bf16_f32 v177, v218, v219
  v_add_f32 v226, v226, v220
  v_mfma_f32_16x16x32_bf16 v[152:155], a[136:139], v[76:79], v[152:155]
  v_exp_f32 v216, v136
  v_mfma_f32_16x16x32_bf16 v[116:119], a[140:143], v[40:43], v[116:119]
  ds_read_b128 a[172:175], v3 offset:27648
  v_add_f32 v226, v226, v221
  v_mfma_f32_16x16x32_bf16 v[124:127], a[140:143], v[44:47], v[124:127]
  v_exp_f32 v217, v137
  v_mfma_f32_16x16x32_bf16 v[148:151], a[140:143], v[72:75], v[148:151]
  v_cvt_pk_bf16_f32 v178, v220, v221
  v_add_f32 v226, v226, v222
  v_mfma_f32_16x16x32_bf16 v[156:159], a[140:143], v[76:79], v[156:159]
  s_waitcnt lgkmcnt(4)
  v_exp_f32 v218, v138
  v_mfma_f32_16x16x32_bf16 v[112:115], a[144:147], v[48:51], v[112:115]
  ds_read_b128 a[176:179], v3 offset:28672
  v_add_f32 v226, v226, v223
  v_mfma_f32_16x16x32_bf16 v[120:123], a[144:147], v[52:55], v[120:123]
  v_exp_f32 v219, v139
  v_mfma_f32_16x16x32_bf16 v[144:147], a[144:147], v[80:83], v[144:147]
  v_cvt_pk_bf16_f32 v179, v222, v223
  v_add_f32 v227, v216, v217
  v_mfma_f32_16x16x32_bf16 v[152:155], a[144:147], v[84:87], v[152:155]
  v_exp_f32 v220, v140
  v_mfma_f32_16x16x32_bf16 v[116:119], a[148:151], v[48:51], v[116:119]
  ds_read_b128 a[180:183], v3 offset:29696
  v_cvt_pk_bf16_f32 v180, v216, v217
  v_mfma_f32_16x16x32_bf16 v[124:127], a[148:151], v[52:55], v[124:127]
  v_exp_f32 v221, v141
  v_mfma_f32_16x16x32_bf16 v[148:151], a[148:151], v[80:83], v[148:151]
  buffer_load_dwordx4 v2, s[48:51], s27 offen offset:1024 sc1 lds
  v_add_f32 v227, v227, v218
  v_mfma_f32_16x16x32_bf16 v[156:159], a[148:151], v[84:87], v[156:159]
  v_exp_f32 v222, v142
  v_mfma_f32_16x16x32_bf16 v[112:115], a[152:155], v[56:59], v[112:115]
  ds_read_b128 a[184:187], v3 offset:30720
  v_add_f32 v227, v227, v219
  v_mfma_f32_16x16x32_bf16 v[120:123], a[152:155], v[60:63], v[120:123]
  v_exp_f32 v223, v143
  v_mfma_f32_16x16x32_bf16 v[144:147], a[152:155], v[88:91], v[144:147]
  v_cvt_pk_bf16_f32 v181, v218, v219
  v_add_f32 v227, v227, v220
  v_mfma_f32_16x16x32_bf16 v[152:155], a[152:155], v[92:95], v[152:155]
  v_exp_f32 v208, v96
  v_mfma_f32_16x16x32_bf16 v[116:119], a[156:159], v[56:59], v[116:119]
  ds_read_b128 a[188:191], v3 offset:31744
  v_add_f32 v227, v227, v221
  v_mfma_f32_16x16x32_bf16 v[124:127], a[156:159], v[60:63], v[124:127]
  v_exp_f32 v209, v97
  v_mfma_f32_16x16x32_bf16 v[148:151], a[156:159], v[88:91], v[148:151]
  v_cvt_pk_bf16_f32 v182, v220, v221
  v_add_f32 v227, v227, v222
  v_add_f32 v227, v227, v223
  v_mfma_f32_16x16x32_bf16 v[156:159], a[156:159], v[92:95], v[156:159]
  s_waitcnt lgkmcnt(4)
  v_exp_f32 v210, v98
  v_mfma_f32_16x16x32_bf16 a[0:3], a[160:163], v[168:171], a[0:3]
  ds_read_b128 a[128:131], v3 offset:8192
  v_cvt_pk_bf16_f32 v183, v222, v223
  v_mfma_f32_16x16x32_bf16 a[4:7], a[160:163], v[172:175], a[4:7]
  v_exp_f32 v211, v99
  v_mfma_f32_16x16x32_bf16 a[64:67], a[160:163], v[184:187], a[64:67]
  v_exp_f32 v212, v100
  v_mfma_f32_16x16x32_bf16 a[68:71], a[160:163], v[188:191], a[68:71]
  v_add_f32 v224, v208, v209
  v_cvt_pk_bf16_f32 v160, v208, v209
  v_mfma_f32_16x16x32_bf16 a[8:11], a[164:167], v[168:171], a[8:11]
  ds_read_b128 a[132:135], v3 offset:9216
  v_add_f32 v224, v224, v210
  v_mfma_f32_16x16x32_bf16 a[12:15], a[164:167], v[172:175], a[12:15]
  v_exp_f32 v213, v101
  v_mfma_f32_16x16x32_bf16 a[72:75], a[164:167], v[184:187], a[72:75]
  buffer_load_dwordx4 v2, s[48:51], s27 offen offset:2048 sc1 lds
  v_add_f32 v224, v224, v211
  v_mfma_f32_16x16x32_bf16 a[76:79], a[164:167], v[188:191], a[76:79]
  v_exp_f32 v214, v102
  v_mfma_f32_16x16x32_bf16 a[16:19], a[168:171], v[168:171], a[16:19]
  ds_read_b128 a[136:139], v3 offset:10240
  v_cvt_pk_bf16_f32 v161, v210, v211
  v_mfma_f32_16x16x32_bf16 a[20:23], a[168:171], v[172:175], a[20:23]
  v_exp_f32 v215, v103
  v_mfma_f32_16x16x32_bf16 a[80:83], a[168:171], v[184:187], a[80:83]
  v_add_f32 v224, v224, v212
  v_add_f32 v224, v224, v213
  v_mfma_f32_16x16x32_bf16 a[84:87], a[168:171], v[188:191], a[84:87]
  v_exp_f32 v208, v104
  v_mfma_f32_16x16x32_bf16 a[24:27], a[172:175], v[168:171], a[24:27]
  ds_read_b128 a[140:143], v3 offset:11264
  v_cvt_pk_bf16_f32 v162, v212, v213
  v_mfma_f32_16x16x32_bf16 a[28:31], a[172:175], v[172:175], a[28:31]
  v_exp_f32 v209, v105
  v_mfma_f32_16x16x32_bf16 a[88:91], a[172:175], v[184:187], a[88:91]
  v_exp_f32 v210, v106
  v_mfma_f32_16x16x32_bf16 a[92:95], a[172:175], v[188:191], a[92:95]
  s_waitcnt lgkmcnt(4)
  v_add_f32 v224, v224, v214
  v_add_f32 v224, v224, v215
  v_mfma_f32_16x16x32_bf16 a[32:35], a[176:179], v[168:171], a[32:35]
  ds_read_b128 a[144:147], v3 offset:12288
  v_cvt_pk_bf16_f32 v163, v214, v215
  v_mfma_f32_16x16x32_bf16 a[36:39], a[176:179], v[172:175], a[36:39]
  v_exp_f32 v211, v107
  v_mfma_f32_16x16x32_bf16 a[96:99], a[176:179], v[184:187], a[96:99]
  v_add_f32 v225, v208, v209
  v_cvt_pk_bf16_f32 v164, v208, v209
  v_mfma_f32_16x16x32_bf16 a[100:103], a[176:179], v[188:191], a[100:103]
  v_exp_f32 v212, v108
  v_mfma_f32_16x16x32_bf16 a[40:43], a[180:183], v[168:171], a[40:43]
  ds_read_b128 a[148:151], v3 offset:13312
  v_add_f32 v225, v225, v210
  v_mfma_f32_16x16x32_bf16 a[44:47], a[180:183], v[172:175], a[44:47]
  v_exp_f32 v213, v109
  v_mfma_f32_16x16x32_bf16 a[104:107], a[180:183], v[184:187], a[104:107]
  buffer_load_dwordx4 v2, s[48:51], s27 offen offset:3072 sc1 lds
  v_add_f32 v225, v225, v211
  v_mfma_f32_16x16x32_bf16 a[108:111], a[180:183], v[188:191], a[108:111]
  s_add_u32 s27, s27, 16384
  v_exp_f32 v214, v110
  v_mfma_f32_16x16x32_bf16 a[48:51], a[184:187], v[168:171], a[48:51]
  s_add_u32 s25, s25, 32768
  ds_read_b128 a[152:155], v3 offset:14336
  v_cvt_pk_bf16_f32 v165, v210, v211
  v_mfma_f32_16x16x32_bf16 a[52:55], a[184:187], v[172:175], a[52:55]
  s_and_b32 s25, s25, 0x1ffff
  v_exp_f32 v215, v111
  v_mfma_f32_16x16x32_bf16 a[112:115], a[184:187], v[184:187], a[112:115]
  v_max3_f32 v5, v226, v227, v224
  v_add_f32 v225, v225, v212
  v_mfma_f32_16x16x32_bf16 a[116:119], a[184:187], v[188:191], a[116:119]
  v_add_f32 v225, v225, v213
  v_cvt_pk_bf16_f32 v166, v212, v213
  v_add_f32 v225, v225, v214
  v_mfma_f32_16x16x32_bf16 a[56:59], a[188:191], v[168:171], a[56:59]
  s_sub_u32 s28, s28, 1
  ds_read_b128 a[156:159], v3 offset:15360
  v_add_f32 v225, v225, v215
  v_max_f32 v5, v5, v225
  v_cmp_lt_f32 vcc, s81, v5
  v_mfma_f32_16x16x32_bf16 a[60:63], a[188:191], v[172:175], a[60:63]
  s_cmp_gt_u32 s28, s8
  v_exp_f32 v216, v144
  v_mfma_f32_16x16x32_bf16 a[120:123], a[188:191], v[184:187], a[120:123]
  s_waitcnt lgkmcnt(4)
  v_cvt_pk_bf16_f32 v167, v214, v215
  v_add_u32 v3, s66, v2
  v_mfma_f32_16x16x32_bf16 a[124:127], a[188:191], v[188:191], a[124:127]
  s_cbranch_vccnz fa_stub2
fa_back2:
  v_exp_f32 v217, v145
  v_add_f32 v228, v228, v224
  v_add_f32 v229, v229, v225
  v_add_f32 v230, v230, v226
  v_add_f32 v231, v231, v227
  s_cbranch_scc1 fa_DD
  s_cmp_lg_u32 s8, 0
  s_cbranch_scc1 fa_DDF
fa_Aexit:
  s_bitcmp1_b32 s20, 0
  s_cbranch_scc1 fa_Aodd
  v_mfma_f32_16x16x32_bf16 v[96:99], a[128:131], v[32:35], v[192:195]
  s_waitcnt vmcnt(12)
  v_exp_f32 v218, v146
  v_mfma_f32_16x16x32_bf16 v[104:107], a[128:131], v[36:39], v[196:199]
  s_barrier
  v_exp_f32 v219, v147
  v_mfma_f32_16x16x32_bf16 v[128:131], a[128:131], v[64:67], v[200:203]
  ds_read_b128 a[160:163], v3 offset:16384
  v_add_f32 v226, v216, v217
  v_mfma_f32_16x16x32_bf16 v[136:139], a[128:131], v[68:71], v[204:207]
  v_exp_f32 v220, v148
  v_mfma_f32_16x16x32_bf16 v[100:103], a[132:135], v[32:35], v[192:195]
  ds_read_b128 a[164:167], v3 offset:17408
  v_cvt_pk_bf16_f32 v184, v216, v217
  v_mfma_f32_16x16x32_bf16 v[108:111], a[132:135], v[36:39], v[196:199]
  s_mov_b32 m0, s24
  v_exp_f32 v221, v149
  v_mfma_f32_16x16x32_bf16 v[132:135], a[132:135], v[64:67], v[200:203]
  buffer_load_dwordx4 v2, s[44:47], s26 offen offset:0 sc1 lds
  v_add_f32 v226, v226, v218
  v_mfma_f32_16x16x32_bf16 v[140:143], a[132:135], v[68:71], v[204:207]
  v_exp_f32 v222, v150
  v_mfma_f32_16x16x32_bf16 v[96:99], a[136:139], v[40:43], v[96:99]
  ds_read_b128 a[168:171], v3 offset:18432
  v_add_f32 v226, v226, v219
  v_mfma_f32_16x16x32_bf16 v[104:107], a[136:139], v[44:47], v[104:107]
  v_exp_f32 v223, v151
  v_mfma_f32_16x16x32_bf16 v[128:131], a[136:139], v[72:75], v[128:131]
  v_cvt_pk_bf16_f32 v185, v218, v219
  v_add_f32 v226, v226, v220
  v_mfma_f32_16x16x32_bf16 v[136:139], a[136:139], v[76:79], v[136:139]
  v_exp_f32 v216, v152
  v_mfma_f32_16x16x32_bf16 v[100:103], a[140:143], v[40:43], v[100:103]
  ds_read_b128 a[172:175], v3 offset:19456
  v_add_f32 v226, v226, v221
  v_mfma_f32_16x16x32_bf16 v[108:111], a[140:143], v[44:47], v[108:111]
  v_exp_f32 v217, v153
  v_mfma_f32_16x16x32_bf16 v[132:135], a[140:143], v[72:75], v[132:135]
  v_cvt_pk_bf16_f32 v186, v220, v221
  v_add_f32 v226, v226, v222
  v_mfma_f32_16x16x32_bf16 v[140:143], a[140:143], v[76:79], v[140:143]
  s_waitcnt lgkmcnt(4)
  v_exp_f32 v218, v154
  v_mfma_f32_16x16x32_bf16 v[96:99], a[144:147], v[48:51], v[96:99]
  ds_read_b128 a[176:179], v3 offset:20480
  v_add_f32 v226, v226, v223
  v_mfma_f32_16x16x32_bf16 v[104:107], a[144:147], v[52:55], v[104:107]
  v_exp_f32 v219, v155
  v_mfma_f32_16x16x32_bf16 v[128:131], a[144:147], v[80:83], v[128:131]
  v_cvt_pk_bf16_f32 v187, v222, v223
  v_add_f32 v227, v216, v217
  v_mfma_f32_16x16x32_bf16 v[136:139], a[144:147], v[84:87], v[136:139]
  v_exp_f32 v220, v156
  v_mfma_f32_16x16x32_bf16 v[100:103], a[148:151], v[48:51], v[100:103]
  ds_read_b128 a[180:183], v3 offset:21504
  v_cvt_pk_bf16_f32 v188, v216, v217
  v_mfma_f32_16x16x32_bf16 v[108:111], a[148:151], v[52:55], v[108:111]
  v_exp_f32 v221, v157
  v_mfma_f32_16x16x32_bf16 v[132:135], a[148:151], v[80:83], v[132:135]
  buffer_load_dwordx4 v2, s[44:47], s26 offen offset:1024 sc1 lds
  v_add_f32 v227, v227, v218
  v_mfma_f32_16x16x32_bf16 v[140:143], a[148:151], v[84:87], v[140:143]
  v_exp_f32 v222, v158
  v_mfma_f32_16x16x32_bf16 v[96:99], a[152:155], v[56:59], v[96:99]
  ds_read_b128 a[184:187], v3 offset:22528
  v_add_f32 v227, v227, v219
  v_mfma_f32_16x16x32_bf16 v[104:107], a[152:155], v[60:63], v[104:107]
  v_exp_f32 v223, v159
  v_mfma_f32_16x16x32_bf16 v[128:131], a[152:155], v[88:91], v[128:131]
  v_cvt_pk_bf16_f32 v189, v218, v219
  v_add_f32 v227, v227, v220
  v_mfma_f32_16x16x32_bf16 v[136:139], a[152:155], v[92:95], v[136:139]
  v_exp_f32 v208, v112
  v_mfma_f32_16x16x32_bf16 v[100:103], a[156:159], v[56:59], v[100:103]
  ds_read_b128 a[188:191], v3 offset:23552
  v_add_f32 v227, v227, v221
  v_mfma_f32_16x16x32_bf16 v[108:111], a[156:159], v[60:63], v[108:111]
  v_exp_f32 v209, v113
  v_mfma_f32_16x16x32_bf16 v[132:135], a[156:159], v[88:91], v[132:135]
  v_cvt_pk_bf16_f32 v190, v220, v221
  v_add_f32 v227, v227, v222
  v_add_f32 v227, v227, v223
  v_mfma_f32_16x16x32_bf16 v[140:143], a[156:159], v[92:95], v[140:143]
  s_waitcnt lgkmcnt(4)
  v_exp_f32 v210, v114
  v_mfma_f32_16x16x32_bf16 a[0:3], a[160:163], v[160:163], a[0:3]
  ds_read_b128 a[128:131], v3 offset:0
  v_cvt_pk_bf16_f32 v191, v222, v223
  v_mfma_f32_16x16x32_bf16 a[4:7], a[160:163], v[164:167], a[4:7]
  v_exp_f32 v211, v115
  v_mfma_f32_16x16x32_bf16 a[64:67], a[160:163], v[176:179], a[64:67]
  v_exp_f32 v212, v116
  v_mfma_f32_16x16x32_bf16 a[68:71], a[160:163], v[180:183], a[68:71]
  v_add_f32 v224, v208, v209
  v_cvt_pk_bf16_f32 v168, v208, v209
  v_mfma_f32_16x16x32_bf16 a[8:11], a[164:167], v[160:163], a[8:11]
  ds_read_b128 a[132:135], v3 offset:1024
  v_add_f32 v224, v224, v210
  v_mfma_f32_16x16x32_bf16 a[12:15], a[164:167], v[164:167], a[12:15]
  v_exp_f32 v213, v117
  v_mfma_f32_16x16x32_bf16 a[72:75], a[164:167], v[176:179], a[72:75]
  buffer_load_dwordx4 v2, s[44:47], s26 offen offset:2048 sc1 lds
  v_add_f32 v224, v224, v211
  v_mfma_f32_16x16x32_bf16 a[76:79], a[164:167], v[180:183], a[76:79]
  v_exp_f32 v214, v118
  v_mfma_f32_16x16x32_bf16 a[16:19], a[168:171], v[160:163], a[16:19]
  ds_read_b128 a[136:139], v3 offset:2048
  v_cvt_pk_bf16_f32 v169, v210, v211
  v_mfma_f32_16x16x32_bf16 a[20:23], a[168:171], v[164:167], a[20:23]
  v_exp_f32 v215, v119
  v_mfma_f32_16x16x32_bf16 a[80:83], a[168:171], v[176:179], a[80:83]
  v_add_f32 v224, v224, v212
  v_add_f32 v224, v224, v213
  v_mfma_f32_16x16x32_bf16 a[84:87], a[168:171], v[180:183], a[84:87]
  v_exp_f32 v208, v120
  v_mfma_f32_16x16x32_bf16 a[24:27], a[172:175], v[160:163], a[24:27]
  ds_read_b128 a[140:143], v3 offset:3072
  v_cvt_pk_bf16_f32 v170, v212, v213
  v_mfma_f32_16x16x32_bf16 a[28:31], a[172:175], v[164:167], a[28:31]
  v_exp_f32 v209, v121
  v_mfma_f32_16x16x32_bf16 a[88:91], a[172:175], v[176:179], a[88:91]
  v_exp_f32 v210, v122
  v_mfma_f32_16x16x32_bf16 a[92:95], a[172:175], v[180:183], a[92:95]
  s_waitcnt lgkmcnt(4)
  v_add_f32 v224, v224, v214
  v_add_f32 v224, v224, v215
  v_mfma_f32_16x16x32_bf16 a[32:35], a[176:179], v[160:163], a[32:35]
  ds_read_b128 a[144:147], v3 offset:4096
  v_cvt_pk_bf16_f32 v171, v214, v215
  v_mfma_f32_16x16x32_bf16 a[36:39], a[176:179], v[164:167], a[36:39]
  v_exp_f32 v211, v123
  v_mfma_f32_16x16x32_bf16 a[96:99], a[176:179], v[176:179], a[96:99]
  v_add_f32 v225, v208, v209
  v_cvt_pk_bf16_f32 v172, v208, v209
  v_mfma_f32_16x16x32_bf16 a[100:103], a[176:179], v[180:183], a[100:103]
  v_exp_f32 v212, v124
  v_mfma_f32_16x16x32_bf16 a[40:43], a[180:183], v[160:163], a[40:43]
  ds_read_b128 a[148:151], v3 offset:5120
  v_add_f32 v225, v225, v210
  v_mfma_f32_16x16x32_bf16 a[44:47], a[180:183], v[164:167], a[44:47]
  v_exp_f32 v213, v125
  v_mfma_f32_16x16x32_bf16 a[104:107], a[180:183], v[176:179], a[104:107]
  buffer_load_dwordx4 v2, s[44:47], s26 offen offset:3072 sc1 lds
  v_add_f32 v225, v225, v211
  v_mfma_f32_16x16x32_bf16 a[108:111], a[180:183], v[180:183], a[108:111]
  s_add_u32 s26, s26, 16384
  v_exp_f32 v214, v126
  v_mfma_f32_16x16x32_bf16 a[48:51], a[184:187], v[160:163], a[48:51]
  s_add_u32 s24, s24, 32768
  ds_read_b128 a[152:155], v3 offset:6144
  v_cvt_pk_bf16_f32 v173, v210, v211
  v_mfma_f32_16x16x32_bf16 a[52:55], a[184:187], v[164:167], a[52:55]
  s_and_b32 s24, s24, 0x1ffff
  v_exp_f32 v215, v127
  v_mfma_f32_16x16x32_bf16 a[112:115], a[184:187], v[176:179], a[112:115]
  v_max3_f32 v5, v226, v227, v224
  v_add_f32 v225, v225, v212
  v_mfma_f32_16x16x32_bf16 a[116:119], a[184:187], v[180:183], a[116:119]
  v_add_f32 v225, v225, v213
  v_cvt_pk_bf16_f32 v174, v212, v213
  v_add_f32 v225, v225, v214
  v_mfma_f32_16x16x32_bf16 a[56:59], a[188:191], v[160:163], a[56:59]
  ds_read_b128 a[156:159], v3 offset:7168
  v_add_f32 v225, v225, v215
  v_max_f32 v5, v5, v225
  v_cmp_lt_f32 vcc, s81, v5
  v_mfma_f32_16x16x32_bf16 a[60:63], a[188:191], v[164:167], a[60:63]
  v_exp_f32 v216, v128
  v_mfma_f32_16x16x32_bf16 a[120:123], a[188:191], v[176:179], a[120:123]
  s_waitcnt lgkmcnt(4)
  v_cvt_pk_bf16_f32 v175, v214, v215
  v_mfma_f32_16x16x32_bf16 a[124:127], a[188:191], v[180:183], a[124:127]
  s_cbranch_vccnz fa_stub4
fa_back4:
  v_exp_f32 v217, v129
  v_add_f32 v228, v228, v224
  v_add_f32 v229, v229, v225
  v_add_f32 v230, v230, v226
  v_add_f32 v231, v231, v227
  v_mfma_f32_16x16x32_bf16 v[144:147], a[128:131], v[64:67], v[200:203]
  ds_read_b128 a[160:163], v3 offset:24576
  v_exp_f32 v218, v130
  v_mfma_f32_16x16x32_bf16 v[152:155], a[128:131], v[68:71], v[204:207]
  v_exp_f32 v219, v131
  v_add_f32 v226, v216, v217
  v_mfma_f32_16x16x32_bf16 v[148:151], a[132:135], v[64:67], v[200:203]
  s_add_u32 s66, s66, 32768
  ds_read_b128 a[164:167], v3 offset:25600
  v_exp_f32 v220, v132
  v_mfma_f32_16x16x32_bf16 v[156:159], a[132:135], v[68:71], v[204:207]
  s_and_b32 s66, s66, 0x1ffff
  v_exp_f32 v221, v133
  v_cvt_pk_bf16_f32 v176, v216, v217
  v_mfma_f32_16x16x32_bf16 v[144:147], a[136:139], v[72:75], v[144:147]
  ds_read_b128 a[168:171], v3 offset:26624
  v_add_f32 v226, v226, v218
  v_add_f32 v226, v226, v219
  v_mfma_f32_16x16x32_bf16 v[152:155], a[136:139], v[76:79], v[152:155]
  s_mov_b32 m0, s25
  v_exp_f32 v222, v134
  v_cvt_pk_bf16_f32 v177, v218, v219
  v_mfma_f32_16x16x32_bf16 v[148:151], a[140:143], v[72:75], v[148:151]
  ds_read_b128 a[172:175], v3 offset:27648
  buffer_load_dwordx4 v2, s[48:51], s27 offen offset:0 sc1 lds
  v_add_f32 v226, v226, v220
  v_add_f32 v226, v226, v221
  v_mfma_f32_16x16x32_bf16 v[156:159], a[140:143], v[76:79], v[156:159]
  s_waitcnt lgkmcnt(4)
  v_exp_f32 v223, v135
  v_cvt_pk_bf16_f32 v178, v220, v221
  v_mfma_f32_16x16x32_bf16 v[144:147], a[144:147], v[80:83], v[144:147]
  ds_read_b128 a[176:179], v3 offset:28672
  v_cndmask_b32 v96, v4, v96, s[68:69]
  v_cndmask_b32 v97, v4, v97, s[70:71]
  v_mfma_f32_16x16x32_bf16 v[152:155], a[144:147], v[84:87], v[152:155]
  v_exp_f32 v216, v136
  v_cndmask_b32 v98, v4, v98, s[72:73]
  v_mfma_f32_16x16x32_bf16 v[148:151], a[148:151], v[80:83], v[148:151]
  ds_read_b128 a[180:183], v3 offset:29696
  v_cndmask_b32 v99, v4, v99, s[74:75]
  v_mov_b32 v100, v4
  v_mfma_f32_16x16x32_bf16 v[156:159], a[148:151], v[84:87], v[156:159]
  v_exp_f32 v217, v137
  v_mov_b32 v101, v4
  v_mfma_f32_16x16x32_bf16 v[144:147], a[152:155], v[88:91], v[144:147]
  ds_read_b128 a[184:187], v3 offset:30720
  v_mov_b32 v102, v4
  v_mov_b32 v103, v4
  v_mfma_f32_16x16x32_bf16 v[152:155], a[152:155], v[92:95], v[152:155]
  v_exp_f32 v218, v138
  v_cndmask_b32 v108, v4, v108, s[68:69]
  v_mfma_f32_16x16x32_bf16 v[148:151], a[156:159], v[88:91], v[148:151]
  ds_read_b128 a[188:191], v3 offset:31744
  v_cndmask_b32 v109, v4, v109, s[70:71]
  v_cndmask_b32 v110, v4, v110, s[72:73]
  v_mfma_f32_16x16x32_bf16 v[156:159], a[156:159], v[92:95], v[156:159]
  s_waitcnt lgkmcnt(4)
  v_exp_f32 v219, v139
  v_cndmask_b32 v111, v4, v111, s[74:75]
  v_mfma_f32_16x16x32_bf16 a[0:3], a[160:163], v[168:171], a[0:3]
  ds_read_b128 a[128:131], v3 offset:8192
  v_add_f32 v226, v226, v222
  v_add_f32 v226, v226, v223
  v_mfma_f32_16x16x32_bf16 a[4:7], a[160:163], v[172:175], a[4:7]
  v_exp_f32 v220, v140
  v_cvt_pk_bf16_f32 v179, v222, v223
  v_mfma_f32_16x16x32_bf16 a[64:67], a[160:163], v[184:187], a[64:67]
  buffer_load_dwordx4 v2, s[48:51], s27 offen offset:1024 sc1 lds
  v_add_f32 v227, v216, v217
  v_cvt_pk_bf16_f32 v180, v216, v217
  v_mfma_f32_16x16x32_bf16 a[68:71], a[160:163], v[188:191], a[68:71]
  v_exp_f32 v221, v141
  v_add_f32 v227, v227, v218
  v_mfma_f32_16x16x32_bf16 a[8:11], a[164:167], v[168:171], a[8:11]
  ds_read_b128 a[132:135], v3 offset:9216
  v_exp_f32 v222, v142
  v_mfma_f32_16x16x32_bf16 a[12:15], a[164:167], v[172:175], a[12:15]
  v_exp_f32 v223, v143
  v_mfma_f32_16x16x32_bf16 a[72:75], a[164:167], v[184:187], a[72:75]
  v_exp_f32 v208, v96
  v_mfma_f32_16x16x32_bf16 a[76:79], a[164:167], v[188:191], a[76:79]
  v_exp_f32 v209, v97
  v_mfma_f32_16x16x32_bf16 a[16:19], a[168:171], v[168:171], a[16:19]
  ds_read_b128 a[136:139], v3 offset:10240
  v_add_f32 v227, v227, v219
  v_cvt_pk_bf16_f32 v181, v218, v219
  v_add_f32 v227, v227, v220
  v_add_f32 v227, v227, v221
  v_cvt_pk_bf16_f32 v182, v220, v221
  v_mfma_f32_16x16x32_bf16 a[20:23], a[168:171], v[172:175], a[20:23]
  v_exp_f32 v210, v98
  v_mfma_f32_16x16x32_bf16 a[80:83], a[168:171], v[184:187], a[80:83]
  v_exp_f32 v211, v99
  v_mfma_f32_16x16x32_bf16 a[84:87], a[168:171], v[188:191], a[84:87]
  v_exp_f32 v212, v100
  v_mfma_f32_16x16x32_bf16 a[24:27], a[172:175], v[168:171], a[24:27]
  ds_read_b128 a[140:143], v3 offset:11264
  v_add_f32 v227, v227, v222
  v_add_f32 v227, v227, v223
  v_cvt_pk_bf16_f32 v183, v222, v223
  v_add_f32 v224, v208, v209
  v_cvt_pk_bf16_f32 v160, v208, v209
  v_mfma_f32_16x16x32_bf16 a[28:31], a[172:175], v[172:175], a[28:31]
  v_exp_f32 v213, v101
  v_mfma_f32_16x16x32_bf16 a[88:91], a[172:175], v[184:187], a[88:91]
  buffer_load_dwordx4 v2, s[48:51], s27 offen offset:2048 sc1 lds
  v_add_f32 v224, v224, v210
  v_add_f32 v224, v224, v211
  v_cvt_pk_bf16_f32 v161, v210, v211
  v_mfma_f32_16x16x32_bf16 a[92:95], a[172:175], v[188:191], a[92:95]
  s_waitcnt lgkmcnt(4)
  v_exp_f32 v214, v102
  v_mfma_f32_16x16x32_bf16 a[32:35], a[176:179], v[168:171], a[32:35]
  ds_read_b128 a[144:147], v3 offset:12288
  v_exp_f32 v215, v103
  v_mfma_f32_16x16x32_bf16 a[36:39], a[176:179], v[172:175], a[36:39]
  v_exp_f32 v208, v104
  v_mfma_f32_16x16x32_bf16 a[96:99], a[176:179], v[184:187], a[96:99]
  v_exp_f32 v209, v105
  v_mfma_f32_16x16x32_bf16 a[100:103], a[176:179], v[188:191], a[100:103]
  v_exp_f32 v210, v106
  v_mfma_f32_16x16x32_bf16 a[40:43], a[180:183], v[168:171], a[40:43]
  ds_read_b128 a[148:151], v3 offset:13312
  v_add_f32 v224, v224, v212
  v_add_f32 v224, v224, v213
  v_cvt_pk_bf16_f32 v162, v212, v213
  v_add_f32 v224, v224, v214
  v_add_f32 v224, v224, v215
  v_cvt_pk_bf16_f32 v163, v214, v215
  v_mfma_f32_16x16x32_bf16 a[44:47], a[180:183], v[172:175], a[44:47]
  v_exp_f32 v211, v107
  v_mfma_f32_16x16x32_bf16 a[104:107], a[180:183], v[184:187], a[104:107]
  v_exp_f32 v212, v108
  v_mfma_f32_16x16x32_bf16 a[108:111], a[180:183], v[188:191], a[108:111]
  v_exp_f32 v213, v109
  v_mfma_f32_16x16x32_bf16 a[48:51], a[184:187], v[168:171], a[48:51]
  ds_read_b128 a[152:155], v3 offset:14336
  v_add_f32 v225, v208, v209
  v_cvt_pk_bf16_f32 v164, v208, v209
  v_add_f32 v225, v225, v210
  v_add_f32 v225, v225, v211
  v_cvt_pk_bf16_f32 v165, v210, v211
  v_mfma_f32_16x16x32_bf16 a[52:55], a[184:187], v[172:175], a[52:55]
  v_exp_f32 v214, v110
  v_mfma_f32_16x16x32_bf16 a[112:115], a[184:187], v[184:187], a[112:115]
  buffer_load_dwordx4 v2, s[48:51], s27 offen offset:3072 sc1 lds
  v_max3_f32 v5, v226, v227, v224
  v_add_f32 v225, v225, v212
  v_add_f32 v225, v225, v213
  v_mfma_f32_16x16x32_bf16 a[116:119], a[184:187], v[188:191], a[116:119]
  s_add_u32 s27, s27, 16384
  v_exp_f32 v215, v111
  v_mfma_f32_16x16x32_bf16 a[56:59], a[188:191], v[168:171], a[56:59]
  s_add_u32 s25, s25, 32768
  ds_read_b128 a[156:159], v3 offset:15360
  v_cvt_pk_bf16_f32 v166, v212, v213
  v_add_f32 v225, v225, v214
  v_add_f32 v225, v225, v215
  v_max_f32 v5, v5, v225
  v_cmp_lt_f32 vcc, s81, v5
  v_mfma_f32_16x16x32_bf16 a[60:63], a[188:191], v[172:175], a[60:63]
  s_and_b32 s25, s25, 0x1ffff
  v_exp_f32 v216, v144
  v_mfma_f32_16x16x32_bf16 a[120:123], a[188:191], v[184:187], a[120:123]
  s_waitcnt lgkmcnt(4)
  v_cvt_pk_bf16_f32 v167, v214, v215
  v_add_u32 v3, s66, v2
  v_mfma_f32_16x16x32_bf16 a[124:127], a[188:191], v[188:191], a[124:127]
  s_cbranch_vccnz fa_stub5
fa_back5:
  v_exp_f32 v217, v145
  v_add_f32 v228, v228, v224
  v_add_f32 v229, v229, v225
  v_add_f32 v230, v230, v226
  v_add_f32 v231, v231, v227
fa_AV:
  v_mfma_f32_16x16x32_bf16 v[128:131], a[128:131], v[64:67], v[200:203]
  s_waitcnt vmcnt(12)
  v_exp_f32 v218, v146
  v_mfma_f32_16x16x32_bf16 v[136:139], a[128:131], v[68:71], v[204:207]
  s_barrier
  v_exp_f32 v219, v147
  v_mfma_f32_16x16x32_bf16 v[132:135], a[132:135], v[64:67], v[200:203]
  ds_read_b128 a[160:163], v3 offset:16384
  ds_read_b128 a[164:167], v3 offset:17408
  v_add_f32 v226, v216, v217
  v_mfma_f32_16x16x32_bf16 v[140:143], a[132:135], v[68:71], v[204:207]
  v_exp_f32 v220, v148
  v_mfma_f32_16x16x32_bf16 v[128:131], a[136:139], v[72:75], v[128:131]
  ds_read_b128 a[168:171], v3 offset:18432
  v_cvt_pk_bf16_f32 v184, v216, v217
  v_mfma_f32_16x16x32_bf16 v[136:139], a[136:139], v[76:79], v[136:139]
  s_mov_b32 m0, s24
  v_exp_f32 v221, v149
  v_mfma_f32_16x16x32_bf16 v[132:135], a[140:143], v[72:75], v[132:135]
  ds_read_b128 a[172:175], v3 offset:19456
  buffer_load_dwordx4 v2, s[44:47], s26 offen offset:0 sc1 lds
  v_add_f32 v226, v226, v218
  v_mfma_f32_16x16x32_bf16 v[140:143], a[140:143], v[76:79], v[140:143]
  s_waitcnt lgkmcnt(4)
  v_exp_f32 v222, v150
  v_mfma_f32_16x16x32_bf16 v[128:131], a[144:147], v[80:83], v[128:131]
  ds_read_b128 a[176:179], v3 offset:20480
  v_add_f32 v226, v226, v219
  v_mfma_f32_16x16x32_bf16 v[136:139], a[144:147], v[84:87], v[136:139]
  v_exp_f32 v223, v151
  v_mfma_f32_16x16x32_bf16 v[132:135], a[148:151], v[80:83], v[132:135]
  ds_read_b128 a[180:183], v3 offset:21504
  v_cvt_pk_bf16_f32 v185, v218, v219
  v_mfma_f32_16x16x32_bf16 v[140:143], a[148:151], v[84:87], v[140:143]
  v_add_f32 v226, v226, v220
  v_add_f32 v226, v226, v221
  v_mfma_f32_16x16x32_bf16 v[128:131], a[152:155], v[88:91], v[128:131]
  ds_read_b128 a[184:187], v3 offset:22528
  v_cvt_pk_bf16_f32 v186, v220, v221
  v_mfma_f32_16x16x32_bf16 v[136:139], a[152:155], v[92:95], v[136:139]
  v_exp_f32 v216, v152
  v_mfma_f32_16x16x32_bf16 v[132:135], a[156:159], v[88:91], v[132:135]
  ds_read_b128 a[188:191], v3 offset:23552
  v_add_f32 v226, v226, v222
  v_mfma_f32_16x16x32_bf16 v[140:143], a[156:159], v[92:95], v[140:143]
  s_waitcnt lgkmcnt(4)
  v_exp_f32 v217, v153
  v_mfma_f32_16x16x32_bf16 a[0:3], a[160:163], v[160:163], a[0:3]
  ds_read_b128 a[128:131], v3 offset:0
  v_add_f32 v226, v226, v223
  v_mfma_f32_16x16x32_bf16 a[4:7], a[160:163], v[164:167], a[4:7]
  v_exp_f32 v218, v154
  v_mfma_f32_16x16x32_bf16 a[64:67], a[160:163], v[176:179], a[64:67]
  buffer_load_dwordx4 v2, s[44:47], s26 offen offset:1024 sc1 lds
  v_cvt_pk_bf16_f32 v187, v222, v223
  v_mfma_f32_16x16x32_bf16 a[68:71], a[160:163], v[180:183], a[68:71]
  v_exp_f32 v219, v155
  v_mfma_f32_16x16x32_bf16 a[8:11], a[164:167], v[160:163], a[8:11]
  ds_read_b128 a[132:135], v3 offset:1024
  v_add_f32 v227, v216, v217
  v_mfma_f32_16x16x32_bf16 a[12:15], a[164:167], v[164:167], a[12:15]
  v_exp_f32 v220, v156
  v_mfma_f32_16x16x32_bf16 a[72:75], a[164:167], v[176:179], a[72:75]
  v_exp_f32 v221, v157
  v_mfma_f32_16x16x32_bf16 a[76:79], a[164:167], v[180:183], a[76:79]
  v_cvt_pk_bf16_f32 v188, v216, v217
  v_add_f32 v227, v227, v218
  v_mfma_f32_16x16x32_bf16 a[16:19], a[168:171], v[160:163], a[16:19]
  ds_read_b128 a[136:139], v3 offset:2048
  v_add_f32 v227, v227, v219
  v_mfma_f32_16x16x32_bf16 a[20:23], a[168:171], v[164:167], a[20:23]
  v_exp_f32 v222, v158
  v_mfma_f32_16x16x32_bf16 a[80:83], a[168:171], v[176:179], a[80:83]
  v_exp_f32 v223, v159
  v_mfma_f32_16x16x32_bf16 a[84:87], a[168:171], v[180:183], a[84:87]
  v_cvt_pk_bf16_f32 v189, v218, v219
  v_add_f32 v227, v227, v220
  v_mfma_f32_16x16x32_bf16 a[24:27], a[172:175], v[160:163], a[24:27]
  ds_read_b128 a[140:143], v3 offset:3072
  v_add_f32 v227, v227, v221
  v_mfma_f32_16x16x32_bf16 a[28:31], a[172:175], v[164:167], a[28:31]
  v_cvt_pk_bf16_f32 v190, v220, v221
  v_add_f32 v227, v227, v222
  v_mfma_f32_16x16x32_bf16 a[88:91], a[172:175], v[176:179], a[88:91]
  buffer_load_dwordx4 v2, s[44:47], s26 offen offset:2048 sc1 lds
  v_add_f32 v227, v227, v223
  v_mfma_f32_16x16x32_bf16 a[92:95], a[172:175], v[180:183], a[92:95]
  s_waitcnt lgkmcnt(4)
  v_max_f32 v5, v226, v227
  v_cmp_lt_f32 vcc, s81, v5
  v_mfma_f32_16x16x32_bf16 a[32:35], a[176:179], v[160:163], a[32:35]
  ds_read_b128 a[144:147], v3 offset:4096
  v_mfma_f32_16x16x32_bf16 a[36:39], a[176:179], v[164:167], a[36:39]
  v_mfma_f32_16x16x32_bf16 a[96:99], a[176:179], v[176:179], a[96:99]
  v_mfma_f32_16x16x32_bf16 a[100:103], a[176:179], v[180:183], a[100:103]
  v_mfma_f32_16x16x32_bf16 a[40:43], a[180:183], v[160:163], a[40:43]
  ds_read_b128 a[148:151], v3 offset:5120
  v_mfma_f32_16x16x32_bf16 a[44:47], a[180:183], v[164:167], a[44:47]
  v_mfma_f32_16x16x32_bf16 a[104:107], a[180:183], v[176:179], a[104:107]
  v_mfma_f32_16x16x32_bf16 a[108:111], a[180:183], v[180:183], a[108:111]
  v_mfma_f32_16x16x32_bf16 a[48:51], a[184:187], v[160:163], a[48:51]
  ds_read_b128 a[152:155], v3 offset:6144
  v_mfma_f32_16x16x32_bf16 a[52:55], a[184:187], v[164:167], a[52:55]
  v_mfma_f32_16x16x32_bf16 a[112:115], a[184:187], v[176:179], a[112:115]
  buffer_load_dwordx4 v2, s[44:47], s26 offen offset:3072 sc1 lds
  v_mfma_f32_16x16x32_bf16 a[116:119], a[184:187], v[180:183], a[116:119]
  s_add_u32 s26, s26, 16384
  v_mfma_f32_16x16x32_bf16 a[56:59], a[188:191], v[160:163], a[56:59]
  s_add_u32 s24, s24, 32768
  ds_read_b128 a[156:159], v3 offset:7168
  v_mfma_f32_16x16x32_bf16 a[60:63], a[188:191], v[164:167], a[60:63]
  s_and_b32 s24, s24, 0x1ffff
  v_exp_f32 v216, v128
  v_mfma_f32_16x16x32_bf16 a[120:123], a[188:191], v[176:179], a[120:123]
  s_waitcnt lgkmcnt(4)
  v_cvt_pk_bf16_f32 v191, v222, v223
  v_mfma_f32_16x16x32_bf16 a[124:127], a[188:191], v[180:183], a[124:127]
  s_cbranch_vccnz fa_stub6
fa_back6:
  v_exp_f32 v217, v129
  v_add_f32 v230, v230, v226
  v_add_f32 v231, v231, v227
  v_mfma_f32_16x16x32_bf16 v[144:147], a[128:131], v[64:67], v[200:203]
  ds_read_b128 a[160:163], v3 offset:24576
  v_add_f32 v226, v216, v217
  v_mfma_f32_16x16x32_bf16 v[152:155], a[128:131], v[68:71], v[204:207]
  v_exp_f32 v218, v130
  v_mfma_f32_16x16x32_bf16 v[148:151], a[132:135], v[64:67], v[200:203]
  s_add_u32 s66, s66, 32768
  ds_read_b128 a[164:167], v3 offset:25600
  v_cvt_pk_bf16_f32 v176, v216, v217
  v_mfma_f32_16x16x32_bf16 v[156:159], a[132:135], v[68:71], v[204:207]
  s_mov_b32 m0, s25
  v_exp_f32 v219, v131
  v_mfma_f32_16x16x32_bf16 v[144:147], a[136:139], v[72:75], v[144:147]
  s_and_b32 s66, s66, 0x1ffff
  ds_read_b128 a[168:171], v3 offset:26624
  buffer_load_dwordx4 v2, s[48:51], s27 offen offset:0 sc1 lds
  v_add_f32 v226, v226, v218
  v_add_f32 v226, v226, v219
  v_mfma_f32_16x16x32_bf16 v[152:155], a[136:139], v[76:79], v[152:155]
  v_exp_f32 v220, v132
  v_mfma_f32_16x16x32_bf16 v[148:151], a[140:143], v[72:75], v[148:151]
  ds_read_b128 a[172:175], v3 offset:27648
  v_cvt_pk_bf16_f32 v177, v218, v219
  v_mfma_f32_16x16x32_bf16 v[156:159], a[140:143], v[76:79], v[156:159]
  s_waitcnt lgkmcnt(4)
  v_exp_f32 v221, v133
  v_mfma_f32_16x16x32_bf16 v[144:147], a[144:147], v[80:83], v[144:147]
  ds_read_b128 a[176:179], v3 offset:28672
  v_add_f32 v226, v226, v220
  v_mfma_f32_16x16x32_bf16 v[152:155], a[144:147], v[84:87], v[152:155]
  v_exp_f32 v222, v134
  v_mfma_f32_16x16x32_bf16 v[148:151], a[148:151], v[80:83], v[148:151]
  ds_read_b128 a[180:183], v3 offset:29696
  buffer_load_dwordx4 v2, s[48:51], s27 offen offset:1024 sc1 lds
  v_add_f32 v226, v226, v221
  v_cvt_pk_bf16_f32 v178, v220, v221
  v_mfma_f32_16x16x32_bf16 v[156:159], a[148:151], v[84:87], v[156:159]
  v_exp_f32 v223, v135
  v_mfma_f32_16x16x32_bf16 v[144:147], a[152:155], v[88:91], v[144:147]
  ds_read_b128 a[184:187], v3 offset:30720
  v_add_f32 v226, v226, v222
  v_mfma_f32_16x16x32_bf16 v[152:155], a[152:155], v[92:95], v[152:155]
  v_exp_f32 v216, v136
  v_mfma_f32_16x16x32_bf16 v[148:151], a[156:159], v[88:91], v[148:151]
  ds_read_b128 a[188:191], v3 offset:31744
  v_add_f32 v226, v226, v223
  v_exp_f32 v217, v137
  v_mfma_f32_16x16x32_bf16 v[156:159], a[156:159], v[92:95], v[156:159]
  s_waitcnt lgkmcnt(4)
  v_exp_f32 v218, v138
  v_mfma_f32_16x16x32_bf16 a[64:67], a[160:163], v[184:187], a[64:67]
  ds_read_b128 a[128:131], v3 offset:8192
  v_cvt_pk_bf16_f32 v179, v222, v223
  v_mfma_f32_16x16x32_bf16 a[68:71], a[160:163], v[188:191], a[68:71]
  v_exp_f32 v219, v139
  v_mfma_f32_16x16x32_bf16 a[72:75], a[164:167], v[184:187], a[72:75]
  ds_read_b128 a[132:135], v3 offset:9216
  buffer_load_dwordx4 v2, s[48:51], s27 offen offset:2048 sc1 lds
  v_add_f32 v227, v216, v217
  v_mfma_f32_16x16x32_bf16 a[76:79], a[164:167], v[188:191], a[76:79]
  v_exp_f32 v220, v140
  v_mfma_f32_16x16x32_bf16 a[80:83], a[168:171], v[184:187], a[80:83]
  ds_read_b128 a[136:139], v3 offset:10240
  v_cvt_pk_bf16_f32 v180, v216, v217
  v_mfma_f32_16x16x32_bf16 a[84:87], a[168:171], v[188:191], a[84:87]
  v_exp_f32 v221, v141
  v_mfma_f32_16x16x32_bf16 a[88:91], a[172:175], v[184:187], a[88:91]
  ds_read_b128 a[140:143], v3 offset:11264
  v_add_f32 v227, v227, v218
  v_mfma_f32_16x16x32_bf16 a[92:95], a[172:175], v[188:191], a[92:95]
  s_waitcnt lgkmcnt(4)
  v_exp_f32 v222, v142
  v_mfma_f32_16x16x32_bf16 a[96:99], a[176:179], v[184:187], a[96:99]
  ds_read_b128 a[144:147], v3 offset:12288
  buffer_load_dwordx4 v2, s[48:51], s27 offen offset:3072 sc1 lds
  v_add_f32 v227, v227, v219
  v_cvt_pk_bf16_f32 v181, v218, v219
  v_mfma_f32_16x16x32_bf16 a[100:103], a[176:179], v[188:191], a[100:103]
  s_add_u32 s27, s27, 16384
  v_exp_f32 v223, v143
  v_mfma_f32_16x16x32_bf16 a[104:107], a[180:183], v[184:187], a[104:107]
  s_add_u32 s25, s25, 32768
  ds_read_b128 a[148:151], v3 offset:13312
  v_add_f32 v227, v227, v220
  v_mfma_f32_16x16x32_bf16 a[108:111], a[180:183], v[188:191], a[108:111]
  s_and_b32 s25, s25, 0x1ffff
  v_add_f32 v227, v227, v221
  v_cvt_pk_bf16_f32 v182, v220, v221
  v_add_f32 v227, v227, v222
  v_mfma_f32_16x16x32_bf16 a[112:115], a[184:187], v[184:187], a[112:115]
  ds_read_b128 a[152:155], v3 offset:14336
  v_add_f32 v227, v227, v223
  v_max_f32 v5, v226, v227
  v_cmp_lt_f32 vcc, s81, v5
  v_mfma_f32_16x16x32_bf16 a[116:119], a[184:187], v[188:191], a[116:119]
  v_exp_f32 v216, v144
  v_mfma_f32_16x16x32_bf16 a[120:123], a[188:191], v[184:187], a[120:123]
  s_waitcnt lgkmcnt(3)
  ds_read_b128 a[156:159], v3 offset:15360
  v_cvt_pk_bf16_f32 v183, v222, v223
  v_add_u32 v3, s66, v2
  v_mfma_f32_16x16x32_bf16 a[124:127], a[188:191], v[188:191], a[124:127]
  s_cbranch_vccnz fa_stub7
fa_back7:
  v_exp_f32 v217, v145
  v_add_f32 v230, v230, v226
  v_add_f32 v231, v231, v227
  s_branch fa_SSpre
fa_Aodd:
  v_mfma_f32_16x16x32_bf16 v[128:131], a[128:131], v[64:67], v[200:203]
  s_waitcnt vmcnt(12)
  v_exp_f32 v218, v146
  v_add_f32 v226, v216, v217
  v_mfma_f32_16x16x32_bf16 v[136:139], a[128:131], v[68:71], v[204:207]
  s_barrier
  v_exp_f32 v219, v147
  v_cvt_pk_bf16_f32 v184, v216, v217
  v_mfma_f32_16x16x32_bf16 v[132:135], a[132:135], v[64:67], v[200:203]
  ds_read_b128 a[160:163], v3 offset:16384
  ds_read_b128 a[164:167], v3 offset:17408
  v_exp_f32 v220, v148
  v_mfma_f32_16x16x32_bf16 v[140:143], a[132:135], v[68:71], v[204:207]
  v_exp_f32 v221, v149
  v_add_f32 v226, v226, v218
  v_mfma_f32_16x16x32_bf16 v[128:131], a[136:139], v[72:75], v[128:131]
  ds_read_b128 a[168:171], v3 offset:18432
  v_add_f32 v226, v226, v219
  v_cvt_pk_bf16_f32 v185, v218, v219
  v_mfma_f32_16x16x32_bf16 v[136:139], a[136:139], v[76:79], v[136:139]
  s_mov_b32 m0, s24
  v_exp_f32 v222, v150
  v_add_f32 v226, v226, v220
  v_mfma_f32_16x16x32_bf16 v[132:135], a[140:143], v[72:75], v[132:135]
  ds_read_b128 a[172:175], v3 offset:19456
  buffer_load_dwordx4 v2, s[44:47], s26 offen offset:0 sc1 lds
  v_add_f32 v226, v226, v221
  v_cvt_pk_bf16_f32 v186, v220, v221
  v_mfma_f32_16x16x32_bf16 v[140:143], a[140:143], v[76:79], v[140:143]
  s_waitcnt lgkmcnt(4)
  v_exp_f32 v223, v151
  v_cndmask_b32 v112, v4, v112, s[68:69]
  v_mfma_f32_16x16x32_bf16 v[128:131], a[144:147], v[80:83], v[128:131]
  ds_read_b128 a[176:179], v3 offset:20480
  v_cndmask_b32 v113, v4, v113, s[70:71]
  v_cndmask_b32 v114, v4, v114, s[72:73]
  v_mfma_f32_16x16x32_bf16 v[136:139], a[144:147], v[84:87], v[136:139]
  v_exp_f32 v216, v152
  v_cndmask_b32 v115, v4, v115, s[74:75]
  v_mfma_f32_16x16x32_bf16 v[132:135], a[148:151], v[80:83], v[132:135]
  ds_read_b128 a[180:183], v3 offset:21504
  v_mov_b32 v116, v4
  v_mov_b32 v117, v4
  v_mfma_f32_16x16x32_bf16 v[140:143], a[148:151], v[84:87], v[140:143]
  v_exp_f32 v217, v153
  v_mov_b32 v118, v4
  v_mfma_f32_16x16x32_bf16 v[128:131], a[152:155], v[88:91], v[128:131]
  ds_read_b128 a[184:187], v3 offset:22528
  v_mov_b32 v119, v4
  v_cndmask_b32 v124, v4, v124, s[68:69]
  v_mfma_f32_16x16x32_bf16 v[136:139], a[152:155], v[92:95], v[136:139]
  v_exp_f32 v218, v154
  v_cndmask_b32 v125, v4, v125, s[70:71]
  v_mfma_f32_16x16x32_bf16 v[132:135], a[156:159], v[88:91], v[132:135]
  ds_read_b128 a[188:191], v3 offset:23552
  v_cndmask_b32 v126, v4, v126, s[72:73]
  v_cndmask_b32 v127, v4, v127, s[74:75]
  v_mfma_f32_16x16x32_bf16 v[140:143], a[156:159], v[92:95], v[140:143]
  s_waitcnt lgkmcnt(4)
  v_exp_f32 v219, v155
  v_add_f32 v226, v226, v222
  v_mfma_f32_16x16x32_bf16 a[0:3], a[160:163], v[160:163], a[0:3]
  ds_read_b128 a[128:131], v3 offset:0
  v_add_f32 v226, v226, v223
  v_cvt_pk_bf16_f32 v187, v222, v223
  v_mfma_f32_16x16x32_bf16 a[4:7], a[160:163], v[164:167], a[4:7]
  v_exp_f32 v220, v156
  v_add_f32 v227, v216, v217
  v_mfma_f32_16x16x32_bf16 a[64:67], a[160:163], v[176:179], a[64:67]
  buffer_load_dwordx4 v2, s[44:47], s26 offen offset:1024 sc1 lds
  v_exp_f32 v221, v157
  v_mfma_f32_16x16x32_bf16 a[68:71], a[160:163], v[180:183], a[68:71]
  v_exp_f32 v222, v158
  v_mfma_f32_16x16x32_bf16 a[8:11], a[164:167], v[160:163], a[8:11]
  ds_read_b128 a[132:135], v3 offset:1024
  v_cvt_pk_bf16_f32 v188, v216, v217
  v_add_f32 v227, v227, v218
  v_add_f32 v227, v227, v219
  v_mfma_f32_16x16x32_bf16 a[12:15], a[164:167], v[164:167], a[12:15]
  v_exp_f32 v223, v159
  v_mfma_f32_16x16x32_bf16 a[72:75], a[164:167], v[176:179], a[72:75]
  v_exp_f32 v208, v112
  v_mfma_f32_16x16x32_bf16 a[76:79], a[164:167], v[180:183], a[76:79]
  v_exp_f32 v209, v113
  v_mfma_f32_16x16x32_bf16 a[16:19], a[168:171], v[160:163], a[16:19]
  ds_read_b128 a[136:139], v3 offset:2048
  v_cvt_pk_bf16_f32 v189, v218, v219
  v_add_f32 v227, v227, v220
  v_add_f32 v227, v227, v221
  v_cvt_pk_bf16_f32 v190, v220, v221
  v_add_f32 v227, v227, v222
  v_mfma_f32_16x16x32_bf16 a[20:23], a[168:171], v[164:167], a[20:23]
  v_exp_f32 v210, v114
  v_mfma_f32_16x16x32_bf16 a[80:83], a[168:171], v[176:179], a[80:83]
  v_exp_f32 v211, v115
  v_mfma_f32_16x16x32_bf16 a[84:87], a[168:171], v[180:183], a[84:87]
  v_exp_f32 v212, v116
  v_mfma_f32_16x16x32_bf16 a[24:27], a[172:175], v[160:163], a[24:27]
  ds_read_b128 a[140:143], v3 offset:3072
  v_add_f32 v227, v227, v223
  v_cvt_pk_bf16_f32 v191, v222, v223
  v_add_f32 v224, v208, v209
  v_cvt_pk_bf16_f32 v168, v208, v209
  v_add_f32 v224, v224, v210
  v_mfma_f32_16x16x32_bf16 a[28:31], a[172:175], v[164:167], a[28:31]
  v_exp_f32 v213, v117
  v_mfma_f32_16x16x32_bf16 a[88:91], a[172:175], v[176:179], a[88:91]
  buffer_load_dwordx4 v2, s[44:47], s26 offen offset:2048 sc1 lds
  v_exp_f32 v214, v118
  v_mfma_f32_16x16x32_bf16 a[92:95], a[172:175], v[180:183], a[92:95]
  s_waitcnt lgkmcnt(4)
  v_exp_f32 v215, v119
  v_mfma_f32_16x16x32_bf16 a[32:35], a[176:179], v[160:163], a[32:35]
  ds_read_b128 a[144:147], v3 offset:4096
  v_add_f32 v224, v224, v211
  v_cvt_pk_bf16_f32 v169, v210, v211
  v_add_f32 v224, v224, v212
  v_add_f32 v224, v224, v213
  v_mfma_f32_16x16x32_bf16 a[36:39], a[176:179], v[164:167], a[36:39]
  v_exp_f32 v208, v120
  v_mfma_f32_16x16x32_bf16 a[96:99], a[176:179], v[176:179], a[96:99]
  v_exp_f32 v209, v121
  v_mfma_f32_16x16x32_bf16 a[100:103], a[176:179], v[180:183], a[100:103]
  v_exp_f32 v210, v122
  v_mfma_f32_16x16x32_bf16 a[40:43], a[180:183], v[160:163], a[40:43]
  ds_read_b128 a[148:151], v3 offset:5120
  v_cvt_pk_bf16_f32 v170, v212, v213
  v_add_f32 v224, v224, v214
  v_add_f32 v224, v224, v215
  v_cvt_pk_bf16_f32 v171, v214, v215
  v_add_f32 v225, v208, v209
  v_mfma_f32_16x16x32_bf16 a[44:47], a[180:183], v[164:167], a[44:47]
  v_exp_f32 v211, v123
  v_mfma_f32_16x16x32_bf16 a[104:107], a[180:183], v[176:179], a[104:107]
  v_exp_f32 v212, v124
  v_mfma_f32_16x16x32_bf16 a[108:111], a[180:183], v[180:183], a[108:111]
  v_exp_f32 v213, v125
  v_mfma_f32_16x16x32_bf16 a[48:51], a[184:187], v[160:163], a[48:51]
  ds_read_b128 a[152:155], v3 offset:6144
  v_cvt_pk_bf16_f32 v172, v208, v209
  v_add_f32 v225, v225, v210
  v_add_f32 v225, v225, v211
  v_cvt_pk_bf16_f32 v173, v210, v211
  v_max3_f32 v5, v226, v227, v224
  v_mfma_f32_16x16x32_bf16 a[52:55], a[184:187], v[164:167], a[52:55]
  v_exp_f32 v214, v126
  v_mfma_f32_16x16x32_bf16 a[112:115], a[184:187], v[176:179], a[112:115]
  buffer_load_dwordx4 v2, s[44:47], s26 offen offset:3072 sc1 lds
  v_add_f32 v225, v225, v212
  v_add_f32 v225, v225, v213
  v_cvt_pk_bf16_f32 v174, v212, v213
  v_mfma_f32_16x16x32_bf16 a[116:119], a[184:187], v[180:183], a[116:119]
  s_add_u32 s26, s26, 16384
  v_exp_f32 v215, v127
  v_mfma_f32_16x16x32_bf16 a[56:59], a[188:191], v[160:163], a[56:59]
  s_add_u32 s24, s24, 32768
  ds_read_b128 a[156:159], v3 offset:7168
  v_add_f32 v225, v225, v214
  v_add_f32 v225, v225, v215
  v_max_f32 v5, v5, v225
  v_cmp_lt_f32 vcc, s81, v5
  v_mfma_f32_16x16x32_bf16 a[60:63], a[188:191], v[164:167], a[60:63]
  s_and_b32 s24, s24, 0x1ffff
  v_exp_f32 v216, v128
  v_mfma_f32_16x16x32_bf16 a[120:123], a[188:191], v[176:179], a[120:123]
  s_waitcnt lgkmcnt(4)
  v_cvt_pk_bf16_f32 v175, v214, v215
  v_mfma_f32_16x16x32_bf16 a[124:127], a[188:191], v[180:183], a[124:127]
  s_cbranch_vccnz fa_stub8
fa_back8:
  v_exp_f32 v217, v129
  v_add_f32 v228, v228, v224
  v_add_f32 v229, v229, v225
  v_add_f32 v230, v230, v226
  v_add_f32 v231, v231, v227
  v_mfma_f32_16x16x32_bf16 v[144:147], a[128:131], v[64:67], v[200:203]
  ds_read_b128 a[160:163], v3 offset:24576
  v_add_f32 v226, v216, v217
  v_mfma_f32_16x16x32_bf16 v[152:155], a[128:131], v[68:71], v[204:207]
  v_exp_f32 v218, v130
  v_mfma_f32_16x16x32_bf16 v[148:151], a[132:135], v[64:67], v[200:203]
  s_add_u32 s66, s66, 32768
  ds_read_b128 a[164:167], v3 offset:25600
  v_cvt_pk_bf16_f32 v176, v216, v217
  v_mfma_f32_16x16x32_bf16 v[156:159], a[132:135], v[68:71], v[204:207]
  s_and_b32 s66, s66, 0x1ffff
  v_exp_f32 v219, v131
  v_mfma_f32_16x16x32_bf16 v[144:147], a[136:139], v[72:75], v[144:147]
  ds_read_b128 a[168:171], v3 offset:26624
  v_add_f32 v226, v226, v218
  v_mfma_f32_16x16x32_bf16 v[152:155], a[136:139], v[76:79], v[152:155]
  s_mov_b32 m0, s25
  v_exp_f32 v220, v132
  v_mfma_f32_16x16x32_bf16 v[148:151], a[140:143], v[72:75], v[148:151]
  ds_read_b128 a[172:175], v3 offset:27648
  buffer_load_dwordx4 v2, s[48:51], s27 offen offset:0 sc1 lds
  v_add_f32 v226, v226, v219
  v_mfma_f32_16x16x32_bf16 v[156:159], a[140:143], v[76:79], v[156:159]
  s_waitcnt lgkmcnt(4)
  v_exp_f32 v221, v133
  v_mfma_f32_16x16x32_bf16 v[144:147], a[144:147], v[80:83], v[144:147]
  ds_read_b128 a[176:179], v3 offset:28672
  v_cvt_pk_bf16_f32 v177, v218, v219
  v_mfma_f32_16x16x32_bf16 v[152:155], a[144:147], v[84:87], v[152:155]
  v_exp_f32 v222, v134
  v_mfma_f32_16x16x32_bf16 v[148:151], a[148:151], v[80:83], v[148:151]
  ds_read_b128 a[180:183], v3 offset:29696
  v_add_f32 v226, v226, v220
  v_mfma_f32_16x16x32_bf16 v[156:159], a[148:151], v[84:87], v[156:159]
  v_exp_f32 v223, v135
  v_mfma_f32_16x16x32_bf16 v[144:147], a[152:155], v[88:91], v[144:147]
  ds_read_b128 a[184:187], v3 offset:30720
  v_add_f32 v226, v226, v221
  v_mfma_f32_16x16x32_bf16 v[152:155], a[152:155], v[92:95], v[152:155]
  v_exp_f32 v216, v136
  v_mfma_f32_16x16x32_bf16 v[148:151], a[156:159], v[88:91], v[148:151]
  ds_read_b128 a[188:191], v3 offset:31744
  v_cvt_pk_bf16_f32 v178, v220, v221
  v_mfma_f32_16x16x32_bf16 v[156:159], a[156:159], v[92:95], v[156:159]
  s_waitcnt lgkmcnt(4)
  v_exp_f32 v217, v137
  v_mfma_f32_16x16x32_bf16 a[0:3], a[160:163], v[168:171], a[0:3]
  ds_read_b128 a[128:131], v3 offset:8192
  v_add_f32 v226, v226, v222
  v_mfma_f32_16x16x32_bf16 a[4:7], a[160:163], v[172:175], a[4:7]
  v_exp_f32 v218, v138
  v_mfma_f32_16x16x32_bf16 a[64:67], a[160:163], v[184:187], a[64:67]
  buffer_load_dwordx4 v2, s[48:51], s27 offen offset:1024 sc1 lds
  v_add_f32 v226, v226, v223
  v_mfma_f32_16x16x32_bf16 a[68:71], a[160:163], v[188:191], a[68:71]
  v_exp_f32 v219, v139
  v_mfma_f32_16x16x32_bf16 a[8:11], a[164:167], v[168:171], a[8:11]
  ds_read_b128 a[132:135], v3 offset:9216
  v_cvt_pk_bf16_f32 v179, v222, v223
  v_mfma_f32_16x16x32_bf16 a[12:15], a[164:167], v[172:175], a[12:15]
  v_exp_f32 v220, v140
  v_mfma_f32_16x16x32_bf16 a[72:75], a[164:167], v[184:187], a[72:75]
  v_add_f32 v227, v216, v217
  v_cvt_pk_bf16_f32 v180, v216, v217
  v_mfma_f32_16x16x32_bf16 a[76:79], a[164:167], v[188:191], a[76:79]
  v_exp_f32 v221, v141
  v_mfma_f32_16x16x32_bf16 a[16:19], a[168:171], v[168:171], a[16:19]
  ds_read_b128 a[136:139], v3 offset:10240
  v_add_f32 v227, v227, v218
  v_mfma_f32_16x16x32_bf16 a[20:23], a[168:171], v[172:175], a[20:23]
  v_exp_f32 v222, v142
  v_mfma_f32_16x16x32_bf16 a[80:83], a[168:171], v[184:187], a[80:83]
  v_add_f32 v227, v227, v219
  v_cvt_pk_bf16_f32 v181, v218, v219
  v_mfma_f32_16x16x32_bf16 a[84:87], a[168:171], v[188:191], a[84:87]
  v_exp_f32 v223, v143
  v_mfma_f32_16x16x32_bf16 a[24:27], a[172:175], v[168:171], a[24:27]
  ds_read_b128 a[140:143], v3 offset:11264
  v_add_f32 v227, v227, v220
  v_mfma_f32_16x16x32_bf16 a[28:31], a[172:175], v[172:175], a[28:31]
  v_add_f32 v227, v227, v221
  v_cvt_pk_bf16_f32 v182, v220, v221
  v_mfma_f32_16x16x32_bf16 a[88:91], a[172:175], v[184:187], a[88:91]
  buffer_load_dwordx4 v2, s[48:51], s27 offen offset:2048 sc1 lds
  v_add_f32 v227, v227, v222
  v_mfma_f32_16x16x32_bf16 a[92:95], a[172:175], v[188:191], a[92:95]
  s_waitcnt lgkmcnt(4)
  v_add_f32 v227, v227, v223
  v_max_f32 v5, v226, v227
  v_mfma_f32_16x16x32_bf16 a[32:35], a[176:179], v[168:171], a[32:35]
  ds_read_b128 a[144:147], v3 offset:12288
  v_cmp_lt_f32 vcc, s81, v5
  v_mfma_f32_16x16x32_bf16 a[36:39], a[176:179], v[172:175], a[36:39]
  v_mfma_f32_16x16x32_bf16 a[96:99], a[176:179], v[184:187], a[96:99]
  v_mfma_f32_16x16x32_bf16 a[100:103], a[176:179], v[188:191], a[100:103]
  v_mfma_f32_16x16x32_bf16 a[40:43], a[180:183], v[168:171], a[40:43]
  ds_read_b128 a[148:151], v3 offset:13312
  v_mfma_f32_16x16x32_bf16 a[44:47], a[180:183], v[172:175], a[44:47]
  v_mfma_f32_16x16x32_bf16 a[104:107], a[180:183], v[184:187], a[104:107]
  v_mfma_f32_16x16x32_bf16 a[108:111], a[180:183], v[188:191], a[108:111]
  v_mfma_f32_16x16x32_bf16 a[48:51], a[184:187], v[168:171], a[48:51]
  ds_read_b128 a[152:155], v3 offset:14336
  v_mfma_f32_16x16x32_bf16 a[52:55], a[184:187], v[172:175], a[52:55]
  v_mfma_f32_16x16x32_bf16 a[112:115], a[184:187], v[184:187], a[112:115]
  buffer_load_dwordx4 v2, s[48:51], s27 offen offset:3072 sc1 lds
  v_mfma_f32_16x16x32_bf16 a[116:119], a[184:187], v[188:191], a[116:119]
  s_add_u32 s27, s27, 16384
  v_mfma_f32_16x16x32_bf16 a[56:59], a[188:191], v[168:171], a[56:59]
  s_add_u32 s25, s25, 32768
  ds_read_b128 a[156:159], v3 offset:15360
  v_mfma_f32_16x16x32_bf16 a[60:63], a[188:191], v[172:175], a[60:63]
  s_and_b32 s25, s25, 0x1ffff
  v_exp_f32 v216, v144
  v_mfma_f32_16x16x32_bf16 a[120:123], a[188:191], v[184:187], a[120:123]
  s_waitcnt lgkmcnt(4)
  v_cvt_pk_bf16_f32 v183, v222, v223
  v_add_u32 v3, s66, v2
  v_mfma_f32_16x16x32_bf16 a[124:127], a[188:191], v[188:191], a[124:127]
  s_cbranch_vccnz fa_stub9
fa_back9:
  v_exp_f32 v217, v145
  v_add_f32 v230, v230, v226
  v_add_f32 v231, v231, v227
fa_SSpre:
  s_mov_b32 s11, 1
  s_cmp_lg_u32 s12, 0
  s_cselect_b32 s32, s15, s32
  s_cmp_ge_u32 s20, 2
  s_cselect_b32 s23, 8, 0
  s_cmp_le_u32 s29, s23
  s_cbranch_scc1 fa_chain
.p2align 6
fa_SS:
  v_mfma_f32_16x16x32_bf16 v[128:131], a[128:131], v[64:67], v[200:203]
  s_waitcnt vmcnt(12)
  v_exp_f32 v218, v146
  v_mfma_f32_16x16x32_bf16 v[136:139], a[128:131], v[68:71], v[204:207]
  s_barrier
  v_exp_f32 v219, v147
  v_mfma_f32_16x16x32_bf16 v[132:135], a[132:135], v[64:67], v[200:203]
  s_cmp_ge_u32 s26, s32
  ds_read_b128 a[160:163], v3 offset:16384
  ds_read_b128 a[164:167], v3 offset:17408
  v_add_f32 v226, v216, v217
  v_mfma_f32_16x16x32_bf16 v[140:143], a[132:135], v[68:71], v[204:207]
  s_cbranch_scc1 fa_hk7
fa_hb7:
  v_exp_f32 v220, v148
  v_mfma_f32_16x16x32_bf16 v[128:131], a[136:139], v[72:75], v[128:131]
  ds_read_b128 a[168:171], v3 offset:18432
  v_cvt_pk_bf16_f32 v184, v216, v217
  v_mfma_f32_16x16x32_bf16 v[136:139], a[136:139], v[76:79], v[136:139]
  s_mov_b32 m0, s24
  v_exp_f32 v221, v149
  v_mfma_f32_16x16x32_bf16 v[132:135], a[140:143], v[72:75], v[132:135]
  ds_read_b128 a[172:175], v3 offset:19456
  buffer_load_dwordx4 v2, s[44:47], s26 offen offset:0 sc1 lds
  v_add_f32 v226, v226, v218
  v_add_f32 v226, v226, v219
  v_mfma_f32_16x16x32_bf16 v[140:143], a[140:143], v[76:79], v[140:143]
  s_waitcnt lgkmcnt(4)
  v_exp_f32 v222, v150
  v_mfma_f32_16x16x32_bf16 v[128:131], a[144:147], v[80:83], v[128:131]
  ds_read_b128 a[176:179], v3 offset:20480
  v_cvt_pk_bf16_f32 v185, v218, v219
  v_mfma_f32_16x16x32_bf16 v[136:139], a[144:147], v[84:87], v[136:139]
  v_exp_f32 v223, v151
  v_mfma_f32_16x16x32_bf16 v[132:135], a[148:151], v[80:83], v[132:135]
  ds_read_b128 a[180:183], v3 offset:21504
  v_add_f32 v226, v226, v220
  v_mfma_f32_16x16x32_bf16 v[140:143], a[148:151], v[84:87], v[140:143]
  v_exp_f32 v216, v152
  v_mfma_f32_16x16x32_bf16 v[128:131], a[152:155], v[88:91], v[128:131]
  ds_read_b128 a[184:187], v3 offset:22528
  buffer_load_dwordx4 v2, s[44:47], s26 offen offset:1024 sc1 lds
  v_add_f32 v226, v226, v221
  v_cvt_pk_bf16_f32 v186, v220, v221
  v_mfma_f32_16x16x32_bf16 v[136:139], a[152:155], v[92:95], v[136:139]
  v_exp_f32 v217, v153
  v_mfma_f32_16x16x32_bf16 v[132:135], a[156:159], v[88:91], v[132:135]
  ds_read_b128 a[188:191], v3 offset:23552
  v_add_f32 v226, v226, v222
  v_mfma_f32_16x16x32_bf16 v[140:143], a[156:159], v[92:95], v[140:143]
  s_waitcnt lgkmcnt(4)
  v_exp_f32 v218, v154
  v_mfma_f32_16x16x32_bf16 a[64:67], a[160:163], v[176:179], a[64:67]
  ds_read_b128 a[128:131], v3 offset:0
  v_add_f32 v226, v226, v223
  v_cvt_pk_bf16_f32 v187, v222, v223
  v_mfma_f32_16x16x32_bf16 a[68:71], a[160:163], v[180:183], a[68:71]
  v_exp_f32 v219, v155
  v_mfma_f32_16x16x32_bf16 a[72:75], a[164:167], v[176:179], a[72:75]
  ds_read_b128 a[132:135], v3 offset:1024
  buffer_load_dwordx4 v2, s[44:47], s26 offen offset:2048 sc1 lds
  v_add_f32 v227, v216, v217
  v_mfma_f32_16x16x32_bf16 a[76:79], a[164:167], v[180:183], a[76:79]
  v_exp_f32 v220, v156
  v_mfma_f32_16x16x32_bf16 a[80:83], a[168:171], v[176:179], a[80:83]
  ds_read_b128 a[136:139], v3 offset:2048
  v_cvt_pk_bf16_f32 v188, v216, v217
  v_mfma_f32_16x16x32_bf16 a[84:87], a[168:171], v[180:183], a[84:87]
  v_exp_f32 v221, v157
  v_mfma_f32_16x16x32_bf16 a[88:91], a[172:175], v[176:179], a[88:91]
  ds_read_b128 a[140:143], v3 offset:3072
  v_add_f32 v227, v227, v218
  v_add_f32 v227, v227, v219
  v_mfma_f32_16x16x32_bf16 a[92:95], a[172:175], v[180:183], a[92:95]
  s_waitcnt lgkmcnt(4)
  v_exp_f32 v222, v158
  v_mfma_f32_16x16x32_bf16 a[96:99], a[176:179], v[176:179], a[96:99]
  ds_read_b128 a[144:147], v3 offset:4096
  buffer_load_dwordx4 v2, s[44:47], s26 offen offset:3072 sc1 lds
  v_cvt_pk_bf16_f32 v189, v218, v219
  v_mfma_f32_16x16x32_bf16 a[100:103], a[176:179], v[180:183], a[100:103]
  s_add_u32 s26, s26, 16384
  v_exp_f32 v223, v159
  v_mfma_f32_16x16x32_bf16 a[104:107], a[180:183], v[176:179], a[104:107]
  s_add_u32 s24, s24, 32768
  ds_read_b128 a[148:151], v3 offset:5120
  v_add_f32 v227, v227, v220
  v_mfma_f32_16x16x32_bf16 a[108:111], a[180:183], v[180:183], a[108:111]
  s_and_b32 s24, s24, 0x1ffff
  v_add_f32 v227, v227, v221
  v_cvt_pk_bf16_f32 v190, v220, v221
  v_add_f32 v227, v227, v222
  v_mfma_f32_16x16x32_bf16 a[112:115], a[184:187], v[176:179], a[112:115]
  ds_read_b128 a[152:155], v3 offset:6144
  v_add_f32 v227, v227, v223
  v_max_f32 v5, v226, v227
  v_cmp_lt_f32 vcc, s81, v5
  v_mfma_f32_16x16x32_bf16 a[116:119], a[184:187], v[180:183], a[116:119]
  v_exp_f32 v216, v128
  v_mfma_f32_16x16x32_bf16 a[120:123], a[188:191], v[176:179], a[120:123]
  s_waitcnt lgkmcnt(3)
  ds_read_b128 a[156:159], v3 offset:7168
  v_cvt_pk_bf16_f32 v191, v222, v223
  v_mfma_f32_16x16x32_bf16 a[124:127], a[188:191], v[180:183], a[124:127]
  s_cbranch_vccnz fa_stub10
fa_back10:
  v_exp_f32 v217, v129
  v_add_f32 v230, v230, v226
  v_add_f32 v231, v231, v227
  v_mfma_f32_16x16x32_bf16 v[144:147], a[128:131], v[64:67], v[200:203]
  ds_read_b128 a[160:163], v3 offset:24576
  v_add_f32 v226, v216, v217
  v_mfma_f32_16x16x32_bf16 v[152:155], a[128:131], v[68:71], v[204:207]
  v_exp_f32 v218, v130
  v_mfma_f32_16x16x32_bf16 v[148:151], a[132:135], v[64:67], v[200:203]
  s_add_u32 s66, s66, 32768
  ds_read_b128 a[164:167], v3 offset:25600
  v_cvt_pk_bf16_f32 v176, v216, v217
  v_mfma_f32_16x16x32_bf16 v[156:159], a[132:135], v[68:71], v[204:207]
  s_mov_b32 m0, s25
  v_exp_f32 v219, v131
  v_mfma_f32_16x16x32_bf16 v[144:147], a[136:139], v[72:75], v[144:147]
  s_and_b32 s66, s66, 0x1ffff
  ds_read_b128 a[168:171], v3 offset:26624
  buffer_load_dwordx4 v2, s[48:51], s27 offen offset:0 sc1 lds
  v_add_f32 v226, v226, v218
  v_add_f32 v226, v226, v219
  v_mfma_f32_16x16x32_bf16 v[152:155], a[136:139], v[76:79], v[152:155]
  v_exp_f32 v220, v132
  v_mfma_f32_16x16x32_bf16 v[148:151], a[140:143], v[72:75], v[148:151]
  ds_read_b128 a[172:175], v3 offset:27648
  v_cvt_pk_bf16_f32 v177, v218, v219
  v_mfma_f32_16x16x32_bf16 v[156:159], a[140:143], v[76:79], v[156:159]
  s_waitcnt lgkmcnt(4)
  v_exp_f32 v221, v133
  v_mfma_f32_16x16x32_bf16 v[144:147], a[144:147], v[80:83], v[144:147]
  ds_read_b128 a[176:179], v3 offset:28672
  v_add_f32 v226, v226, v220
  v_mfma_f32_16x16x32_bf16 v[152:155], a[144:147], v[84:87], v[152:155]
  v_exp_f32 v222, v134
  v_mfma_f32_16x16x32_bf16 v[148:151], a[148:151], v[80:83], v[148:151]
  ds_read_b128 a[180:183], v3 offset:29696
  buffer_load_dwordx4 v2, s[48:51], s27 offen offset:1024 sc1 lds
  v_add_f32 v226, v226, v221
  v_cvt_pk_bf16_f32 v178, v220, v221
  v_mfma_f32_16x16x32_bf16 v[156:159], a[148:151], v[84:87], v[156:159]
  v_exp_f32 v223, v135
  v_mfma_f32_16x16x32_bf16 v[144:147], a[152:155], v[88:91], v[144:147]
  ds_read_b128 a[184:187], v3 offset:30720
  v_add_f32 v226, v226, v222
  v_mfma_f32_16x16x32_bf16 v[152:155], a[152:155], v[92:95], v[152:155]
  v_exp_f32 v216, v136
  v_mfma_f32_16x16x32_bf16 v[148:151], a[156:159], v[88:91], v[148:151]
  ds_read_b128 a[188:191], v3 offset:31744
  v_add_f32 v226, v226, v223
  v_exp_f32 v217, v137
  v_mfma_f32_16x16x32_bf16 v[156:159], a[156:159], v[92:95], v[156:159]
  s_waitcnt lgkmcnt(4)
  v_exp_f32 v218, v138
  v_mfma_f32_16x16x32_bf16 a[64:67], a[160:163], v[184:187], a[64:67]
  ds_read_b128 a[128:131], v3 offset:8192
  v_cvt_pk_bf16_f32 v179, v222, v223
  v_mfma_f32_16x16x32_bf16 a[68:71], a[160:163], v[188:191], a[68:71]
  v_exp_f32 v219, v139
  v_mfma_f32_16x16x32_bf16 a[72:75], a[164:167], v[184:187], a[72:75]
  ds_read_b128 a[132:135], v3 offset:9216
  buffer_load_dwordx4 v2, s[48:51], s27 offen offset:2048 sc1 lds
  v_add_f32 v227, v216, v217
  v_mfma_f32_16x16x32_bf16 a[76:79], a[164:167], v[188:191], a[76:79]
  v_exp_f32 v220, v140
  v_mfma_f32_16x16x32_bf16 a[80:83], a[168:171], v[184:187], a[80:83]
  ds_read_b128 a[136:139], v3 offset:10240
  v_cvt_pk_bf16_f32 v180, v216, v217
  v_mfma_f32_16x16x32_bf16 a[84:87], a[168:171], v[188:191], a[84:87]
  v_exp_f32 v221, v141
  v_mfma_f32_16x16x32_bf16 a[88:91], a[172:175], v[184:187], a[88:91]
  ds_read_b128 a[140:143], v3 offset:11264
  v_add_f32 v227, v227, v218
  v_mfma_f32_16x16x32_bf16 a[92:95], a[172:175], v[188:191], a[92:95]
  s_waitcnt lgkmcnt(4)
  v_exp_f32 v222, v142
  v_mfma_f32_16x16x32_bf16 a[96:99], a[176:179], v[184:187], a[96:99]
  ds_read_b128 a[144:147], v3 offset:12288
  buffer_load_dwordx4 v2, s[48:51], s27 offen offset:3072 sc1 lds
  v_add_f32 v227, v227, v219
  v_cvt_pk_bf16_f32 v181, v218, v219
  v_mfma_f32_16x16x32_bf16 a[100:103], a[176:179], v[188:191], a[100:103]
  s_add_u32 s27, s27, 16384
  v_exp_f32 v223, v143
  v_mfma_f32_16x16x32_bf16 a[104:107], a[180:183], v[184:187], a[104:107]
  s_add_u32 s25, s25, 32768
  ds_read_b128 a[148:151], v3 offset:13312
  v_add_f32 v227, v227, v220
  v_mfma_f32_16x16x32_bf16 a[108:111], a[180:183], v[188:191], a[108:111]
  s_and_b32 s25, s25, 0x1ffff
  v_add_f32 v227, v227, v221
  v_cvt_pk_bf16_f32 v182, v220, v221
  v_add_f32 v227, v227, v222
  v_mfma_f32_16x16x32_bf16 a[112:115], a[184:187], v[184:187], a[112:115]
  s_sub_u32 s29, s29, 1
  ds_read_b128 a[152:155], v3 offset:14336
  v_add_f32 v227, v227, v223
  v_max_f32 v5, v226, v227
  v_cmp_lt_f32 vcc, s81, v5
  v_mfma_f32_16x16x32_bf16 a[116:119], a[184:187], v[188:191], a[116:119]
  s_cmp_gt_u32 s29, 8
  v_exp_f32 v216, v144
  v_mfma_f32_16x16x32_bf16 a[120:123], a[188:191], v[184:187], a[120:123]
  s_waitcnt lgkmcnt(3)
  ds_read_b128 a[156:159], v3 offset:15360
  v_cvt_pk_bf16_f32 v183, v222, v223
  v_add_u32 v3, s66, v2
  v_mfma_f32_16x16x32_bf16 a[124:127], a[188:191], v[188:191], a[124:127]
  s_cbranch_vccnz fa_stub11
fa_back11:
  v_exp_f32 v217, v145
  v_add_f32 v230, v230, v226
  v_add_f32 v231, v231, v227
  s_cbranch_scc1 fa_SS
fa_chain:
fa_hb8:
  s_cmp_lt_u32 s12, 2
  s_cbranch_scc1 fa_hk8
  s_cmp_eq_u32 s29, 8
  s_cbranch_scc0 fa_disp
fa_SSW8:
  v_mfma_f32_16x16x32_bf16 v[128:131], a[128:131], v[64:67], v[200:203]
  s_waitcnt vmcnt(12)
  v_exp_f32 v218, v146
  v_mfma_f32_16x16x32_bf16 v[136:139], a[128:131], v[68:71], v[204:207]
  s_barrier
  v_exp_f32 v219, v147
  v_mfma_f32_16x16x32_bf16 v[132:135], a[132:135], v[64:67], v[200:203]
  ds_read_b128 a[160:163], v3 offset:16384
  ds_read_b128 a[164:167], v3 offset:17408
  v_add_f32 v226, v216, v217
  v_mfma_f32_16x16x32_bf16 v[140:143], a[132:135], v[68:71], v[204:207]
  s_mov_b32 m0, s24
  v_exp_f32 v220, v148
  v_mfma_f32_16x16x32_bf16 v[128:131], a[136:139], v[72:75], v[128:131]
  ds_read_b128 a[168:171], v3 offset:18432
  buffer_load_dwordx4 v2, s[44:47], s26 offen offset:0 sc1 lds
  v_cvt_pk_bf16_f32 v184, v216, v217
  v_mfma_f32_16x16x32_bf16 v[136:139], a[136:139], v[76:79], v[136:139]
  v_exp_f32 v221, v149
  v_mfma_f32_16x16x32_bf16 v[132:135], a[140:143], v[72:75], v[132:135]
  ds_read_b128 a[172:175], v3 offset:19456
  v_add_f32 v226, v226, v218
  v_add_f32 v226, v226, v219
  v_mfma_f32_16x16x32_bf16 v[140:143], a[140:143], v[76:79], v[140:143]
  s_waitcnt lgkmcnt(4)
  v_exp_f32 v222, v150
  v_mfma_f32_16x16x32_bf16 v[128:131], a[144:147], v[80:83], v[128:131]
  ds_read_b128 a[176:179], v3 offset:20480
  v_cvt_pk_bf16_f32 v185, v218, v219
  v_mfma_f32_16x16x32_bf16 v[136:139], a[144:147], v[84:87], v[136:139]
  v_exp_f32 v223, v151
  v_mfma_f32_16x16x32_bf16 v[132:135], a[148:151], v[80:83], v[132:135]
  ds_read_b128 a[180:183], v3 offset:21504
  buffer_load_dwordx4 v2, s[44:47], s26 offen offset:1024 sc1 lds
  v_add_f32 v226, v226, v220
  v_mfma_f32_16x16x32_bf16 v[140:143], a[148:151], v[84:87], v[140:143]
  v_exp_f32 v216, v152
  v_mfma_f32_16x16x32_bf16 v[128:131], a[152:155], v[88:91], v[128:131]
  ds_read_b128 a[184:187], v3 offset:22528
  v_add_f32 v226, v226, v221
  v_cvt_pk_bf16_f32 v186, v220, v221
  v_mfma_f32_16x16x32_bf16 v[136:139], a[152:155], v[92:95], v[136:139]
  v_exp_f32 v217, v153
  v_mfma_f32_16x16x32_bf16 v[132:135], a[156:159], v[88:91], v[132:135]
  s_add_u32 s14, s13, 0
  ds_read_b128 a[188:191], v3 offset:23552
  buffer_load_dwordx4 a[0:3], v2, s[40:43], s14 offen offset:0 sc1
  v_add_f32 v226, v226, v222
  v_mfma_f32_16x16x32_bf16 v[140:143], a[156:159], v[92:95], v[140:143]
  s_waitcnt lgkmcnt(4)
  v_exp_f32 v218, v154
  v_mfma_f32_16x16x32_bf16 a[64:67], a[160:163], v[176:179], a[64:67]
  ds_read_b128 a[128:131], v3 offset:0
  v_add_f32 v226, v226, v223
  v_cvt_pk_bf16_f32 v187, v222, v223
  v_mfma_f32_16x16x32_bf16 a[68:71], a[160:163], v[180:183], a[68:71]
  v_exp_f32 v219, v155
  v_mfma_f32_16x16x32_bf16 a[72:75], a[164:167], v[176:179], a[72:75]
  ds_read_b128 a[132:135], v3 offset:1024
  buffer_load_dwordx4 v2, s[44:47], s26 offen offset:2048 sc1 lds
  v_add_f32 v227, v216, v217
  v_mfma_f32_16x16x32_bf16 a[76:79], a[164:167], v[180:183], a[76:79]
  v_exp_f32 v220, v156
  v_mfma_f32_16x16x32_bf16 a[80:83], a[168:171], v[176:179], a[80:83]
  ds_read_b128 a[136:139], v3 offset:2048
  v_cvt_pk_bf16_f32 v188, v216, v217
  v_mfma_f32_16x16x32_bf16 a[84:87], a[168:171], v[180:183], a[84:87]
  v_exp_f32 v221, v157
  v_mfma_f32_16x16x32_bf16 a[88:91], a[172:175], v[176:179], a[88:91]
  ds_read_b128 a[140:143], v3 offset:3072
  v_add_f32 v227, v227, v218
  v_add_f32 v227, v227, v219
  v_mfma_f32_16x16x32_bf16 a[92:95], a[172:175], v[180:183], a[92:95]
  s_waitcnt lgkmcnt(4)
  v_exp_f32 v222, v158
  v_mfma_f32_16x16x32_bf16 a[96:99], a[176:179], v[176:179], a[96:99]
  ds_read_b128 a[144:147], v3 offset:4096
  buffer_load_dwordx4 v2, s[44:47], s26 offen offset:3072 sc1 lds
  v_cvt_pk_bf16_f32 v189, v218, v219
  v_mfma_f32_16x16x32_bf16 a[100:103], a[176:179], v[180:183], a[100:103]
  s_add_u32 s26, s26, 16384
  v_exp_f32 v223, v159
  v_mfma_f32_16x16x32_bf16 a[104:107], a[180:183], v[176:179], a[104:107]
  s_add_u32 s24, s24, 32768
  ds_read_b128 a[148:151], v3 offset:5120
  v_add_f32 v227, v227, v220
  v_mfma_f32_16x16x32_bf16 a[108:111], a[180:183], v[180:183], a[108:111]
  s_and_b32 s24, s24, 0x1ffff
  v_add_f32 v227, v227, v221
  v_cvt_pk_bf16_f32 v190, v220, v221
  v_add_f32 v227, v227, v222
  v_mfma_f32_16x16x32_bf16 a[112:115], a[184:187], v[176:179], a[112:115]
  ds_read_b128 a[152:155], v3 offset:6144
  v_add_f32 v227, v227, v223
  v_max_f32 v5, v226, v227
  v_cmp_lt_f32 vcc, s81, v5
  v_mfma_f32_16x16x32_bf16 a[116:119], a[184:187], v[180:183], a[116:119]
  v_exp_f32 v216, v128
  v_mfma_f32_16x16x32_bf16 a[120:123], a[188:191], v[176:179], a[120:123]
  s_waitcnt lgkmcnt(3)
  ds_read_b128 a[156:159], v3 offset:7168
  v_cvt_pk_bf16_f32 v191, v222, v223
  v_mfma_f32_16x16x32_bf16 a[124:127], a[188:191], v[180:183], a[124:127]
  s_cbranch_vccnz fa_stub12
fa_back12:
  v_exp_f32 v217, v129
  v_add_f32 v230, v230, v226
  v_add_f32 v231, v231, v227
  v_mfma_f32_16x16x32_bf16 v[144:147], a[128:131], v[64:67], v[200:203]
  ds_read_b128 a[160:163], v3 offset:24576
  v_add_f32 v226, v216, v217
  v_mfma_f32_16x16x32_bf16 v[152:155], a[128:131], v[68:71], v[204:207]
  v_exp_f32 v218, v130
  v_mfma_f32_16x16x32_bf16 v[148:151], a[132:135], v[64:67], v[200:203]
  s_add_u32 s66, s66, 32768
  ds_read_b128 a[164:167], v3 offset:25600
  v_cvt_pk_bf16_f32 v176, v216, v217
  v_mfma_f32_16x16x32_bf16 v[156:159], a[132:135], v[68:71], v[204:207]
  s_mov_b32 m0, s25
  v_exp_f32 v219, v131
  v_mfma_f32_16x16x32_bf16 v[144:147], a[136:139], v[72:75], v[144:147]
  s_and_b32 s66, s66, 0x1ffff
  ds_read_b128 a[168:171], v3 offset:26624
  buffer_load_dwordx4 v2, s[48:51], s27 offen offset:0 sc1 lds
  v_add_f32 v226, v226, v218
  v_add_f32 v226, v226, v219
  v_mfma_f32_16x16x32_bf16 v[152:155], a[136:139], v[76:79], v[152:155]
  v_exp_f32 v220, v132
  v_mfma_f32_16x16x32_bf16 v[148:151], a[140:143], v[72:75], v[148:151]
  ds_read_b128 a[172:175], v3 offset:27648
  v_cvt_pk_bf16_f32 v177, v218, v219
  v_mfma_f32_16x16x32_bf16 v[156:159], a[140:143], v[76:79], v[156:159]
  s_waitcnt lgkmcnt(4)
  v_exp_f32 v221, v133
  v_mfma_f32_16x16x32_bf16 v[144:147], a[144:147], v[80:83], v[144:147]
  s_add_u32 s14, s13, 0
  ds_read_b128 a[176:179], v3 offset:28672
  buffer_load_dwordx4 a[4:7], v2, s[40:43], s14 offen offset:1024 sc1
  v_add_f32 v226, v226, v220
  v_mfma_f32_16x16x32_bf16 v[152:155], a[144:147], v[84:87], v[152:155]
  v_exp_f32 v222, v134
  v_mfma_f32_16x16x32_bf16 v[148:151], a[148:151], v[80:83], v[148:151]
  ds_read_b128 a[180:183], v3 offset:29696
  buffer_load_dwordx4 v2, s[48:51], s27 offen offset:1024 sc1 lds
  v_add_f32 v226, v226, v221
  v_cvt_pk_bf16_f32 v178, v220, v221
  v_mfma_f32_16x16x32_bf16 v[156:159], a[148:151], v[84:87], v[156:159]
  v_exp_f32 v223, v135
  v_mfma_f32_16x16x32_bf16 v[144:147], a[152:155], v[88:91], v[144:147]
  ds_read_b128 a[184:187], v3 offset:30720
  v_add_f32 v226, v226, v222
  v_mfma_f32_16x16x32_bf16 v[152:155], a[152:155], v[92:95], v[152:155]
  v_exp_f32 v216, v136
  v_mfma_f32_16x16x32_bf16 v[148:151], a[156:159], v[88:91], v[148:151]
  ds_read_b128 a[188:191], v3 offset:31744
  v_add_f32 v226, v226, v223
  v_exp_f32 v217, v137
  v_mfma_f32_16x16x32_bf16 v[156:159], a[156:159], v[92:95], v[156:159]
  s_waitcnt lgkmcnt(4)
  v_exp_f32 v218, v138
  v_mfma_f32_16x16x32_bf16 a[64:67], a[160:163], v[184:187], a[64:67]
  ds_read_b128 a[128:131], v3 offset:8192
  v_cvt_pk_bf16_f32 v179, v222, v223
  v_mfma_f32_16x16x32_bf16 a[68:71], a[160:163], v[188:191], a[68:71]
  v_exp_f32 v219, v139
  v_mfma_f32_16x16x32_bf16 a[72:75], a[164:167], v[184:187], a[72:75]
  ds_read_b128 a[132:135], v3 offset:9216
  buffer_load_dwordx4 v2, s[48:51], s27 offen offset:2048 sc1 lds
  v_add_f32 v227, v216, v217
  v_mfma_f32_16x16x32_bf16 a[76:79], a[164:167], v[188:191], a[76:79]
  v_exp_f32 v220, v140
  v_mfma_f32_16x16x32_bf16 a[80:83], a[168:171], v[184:187], a[80:83]
  ds_read_b128 a[136:139], v3 offset:10240
  v_cvt_pk_bf16_f32 v180, v216, v217
  v_mfma_f32_16x16x32_bf16 a[84:87], a[168:171], v[188:191], a[84:87]
  v_exp_f32 v221, v141
  v_mfma_f32_16x16x32_bf16 a[88:91], a[172:175], v[184:187], a[88:91]
  ds_read_b128 a[140:143], v3 offset:11264
  buffer_load_dwordx4 a[8:11], v2, s[40:43], s14 offen offset:2048 sc1
  v_add_f32 v227, v227, v218
  v_mfma_f32_16x16x32_bf16 a[92:95], a[172:175], v[188:191], a[92:95]
  s_waitcnt lgkmcnt(4)
  v_exp_f32 v222, v142
  v_mfma_f32_16x16x32_bf16 a[96:99], a[176:179], v[184:187], a[96:99]
  ds_read_b128 a[144:147], v3 offset:12288
  buffer_load_dwordx4 v2, s[48:51], s27 offen offset:3072 sc1 lds
  v_add_f32 v227, v227, v219
  v_cvt_pk_bf16_f32 v181, v218, v219
  v_mfma_f32_16x16x32_bf16 a[100:103], a[176:179], v[188:191], a[100:103]
  s_add_u32 s27, s27, 16384
  v_exp_f32 v223, v143
  v_mfma_f32_16x16x32_bf16 a[104:107], a[180:183], v[184:187], a[104:107]
  s_add_u32 s25, s25, 32768
  ds_read_b128 a[148:151], v3 offset:13312
  v_add_f32 v227, v227, v220
  v_mfma_f32_16x16x32_bf16 a[108:111], a[180:183], v[188:191], a[108:111]
  s_and_b32 s25, s25, 0x1ffff
  v_add_f32 v227, v227, v221
  v_cvt_pk_bf16_f32 v182, v220, v221
  v_add_f32 v227, v227, v222
  v_mfma_f32_16x16x32_bf16 a[112:115], a[184:187], v[184:187], a[112:115]
  ds_read_b128 a[152:155], v3 offset:14336
  v_add_f32 v227, v227, v223
  v_max_f32 v5, v226, v227
  v_cmp_lt_f32 vcc, s81, v5
  v_mfma_f32_16x16x32_bf16 a[116:119], a[184:187], v[188:191], a[116:119]
  v_exp_f32 v216, v144
  v_mfma_f32_16x16x32_bf16 a[120:123], a[188:191], v[184:187], a[120:123]
  s_waitcnt lgkmcnt(3)
  ds_read_b128 a[156:159], v3 offset:15360
  v_cvt_pk_bf16_f32 v183, v222, v223
  v_add_u32 v3, s66, v2
  v_mfma_f32_16x16x32_bf16 a[124:127], a[188:191], v[188:191], a[124:127]
  s_cbranch_vccnz fa_stub13
fa_back13:
  v_exp_f32 v217, v145
  v_add_f32 v230, v230, v226
  v_add_f32 v231, v231, v227
fa_SSW7:
  v_mfma_f32_16x16x32_bf16 v[128:131], a[128:131], v[64:67], v[200:203]
  s_waitcnt vmcnt(12)
  v_exp_f32 v218, v146
  v_mfma_f32_16x16x32_bf16 v[136:139], a[128:131], v[68:71], v[204:207]
  s_barrier
  v_exp_f32 v219, v147
  v_mfma_f32_16x16x32_bf16 v[132:135], a[132:135], v[64:67], v[200:203]
  ds_read_b128 a[160:163], v3 offset:16384
  ds_read_b128 a[164:167], v3 offset:17408
  v_add_f32 v226, v216, v217
  v_mfma_f32_16x16x32_bf16 v[140:143], a[132:135], v[68:71], v[204:207]
  s_mov_b32 m0, s24
  v_exp_f32 v220, v148
  v_mfma_f32_16x16x32_bf16 v[128:131], a[136:139], v[72:75], v[128:131]
  ds_read_b128 a[168:171], v3 offset:18432
  buffer_load_dwordx4 v2, s[44:47], s26 offen offset:0 sc1 lds
  v_cvt_pk_bf16_f32 v184, v216, v217
  v_mfma_f32_16x16x32_bf16 v[136:139], a[136:139], v[76:79], v[136:139]
  v_exp_f32 v221, v149
  v_mfma_f32_16x16x32_bf16 v[132:135], a[140:143], v[72:75], v[132:135]
  ds_read_b128 a[172:175], v3 offset:19456
  v_add_f32 v226, v226, v218
  v_add_f32 v226, v226, v219
  v_mfma_f32_16x16x32_bf16 v[140:143], a[140:143], v[76:79], v[140:143]
  s_waitcnt lgkmcnt(4)
  v_exp_f32 v222, v150
  v_mfma_f32_16x16x32_bf16 v[128:131], a[144:147], v[80:83], v[128:131]
  ds_read_b128 a[176:179], v3 offset:20480
  v_cvt_pk_bf16_f32 v185, v218, v219
  v_mfma_f32_16x16x32_bf16 v[136:139], a[144:147], v[84:87], v[136:139]
  v_exp_f32 v223, v151
  v_mfma_f32_16x16x32_bf16 v[132:135], a[148:151], v[80:83], v[132:135]
  ds_read_b128 a[180:183], v3 offset:21504
  buffer_load_dwordx4 v2, s[44:47], s26 offen offset:1024 sc1 lds
  v_add_f32 v226, v226, v220
  v_mfma_f32_16x16x32_bf16 v[140:143], a[148:151], v[84:87], v[140:143]
  v_exp_f32 v216, v152
  v_mfma_f32_16x16x32_bf16 v[128:131], a[152:155], v[88:91], v[128:131]
  ds_read_b128 a[184:187], v3 offset:22528
  v_add_f32 v226, v226, v221
  v_cvt_pk_bf16_f32 v186, v220, v221
  v_mfma_f32_16x16x32_bf16 v[136:139], a[152:155], v[92:95], v[136:139]
  v_exp_f32 v217, v153
  v_mfma_f32_16x16x32_bf16 v[132:135], a[156:159], v[88:91], v[132:135]
  s_add_u32 s14, s13, 0
  ds_read_b128 a[188:191], v3 offset:23552
  buffer_load_dwordx4 a[12:15], v2, s[40:43], s14 offen offset:3072 sc1
  v_add_f32 v226, v226, v222
  v_mfma_f32_16x16x32_bf16 v[140:143], a[156:159], v[92:95], v[140:143]
  s_waitcnt lgkmcnt(4)
  v_exp_f32 v218, v154
  v_mfma_f32_16x16x32_bf16 a[64:67], a[160:163], v[176:179], a[64:67]
  ds_read_b128 a[128:131], v3 offset:0
  v_add_f32 v226, v226, v223
  v_cvt_pk_bf16_f32 v187, v222, v223
  v_mfma_f32_16x16x32_bf16 a[68:71], a[160:163], v[180:183], a[68:71]
  v_exp_f32 v219, v155
  v_mfma_f32_16x16x32_bf16 a[72:75], a[164:167], v[176:179], a[72:75]
  ds_read_b128 a[132:135], v3 offset:1024
  buffer_load_dwordx4 v2, s[44:47], s26 offen offset:2048 sc1 lds
  v_add_f32 v227, v216, v217
  v_mfma_f32_16x16x32_bf16 a[76:79], a[164:167], v[180:183], a[76:79]
  v_exp_f32 v220, v156
  v_mfma_f32_16x16x32_bf16 a[80:83], a[168:171], v[176:179], a[80:83]
  ds_read_b128 a[136:139], v3 offset:2048
  v_cvt_pk_bf16_f32 v188, v216, v217
  v_mfma_f32_16x16x32_bf16 a[84:87], a[168:171], v[180:183], a[84:87]
  v_exp_f32 v221, v157
  v_mfma_f32_16x16x32_bf16 a[88:91], a[172:175], v[176:179], a[88:91]
  ds_read_b128 a[140:143], v3 offset:3072
  v_add_f32 v227, v227, v218
  v_add_f32 v227, v227, v219
  v_mfma_f32_16x16x32_bf16 a[92:95], a[172:175], v[180:183], a[92:95]
  s_waitcnt lgkmcnt(4)
  v_exp_f32 v222, v158
  v_mfma_f32_16x16x32_bf16 a[96:99], a[176:179], v[176:179], a[96:99]
  ds_read_b128 a[144:147], v3 offset:4096
  buffer_load_dwordx4 v2, s[44:47], s26 offen offset:3072 sc1 lds
  v_cvt_pk_bf16_f32 v189, v218, v219
  v_mfma_f32_16x16x32_bf16 a[100:103], a[176:179], v[180:183], a[100:103]
  s_add_u32 s26, s26, 16384
  v_exp_f32 v223, v159
  v_mfma_f32_16x16x32_bf16 a[104:107], a[180:183], v[176:179], a[104:107]
  s_add_u32 s24, s24, 32768
  ds_read_b128 a[148:151], v3 offset:5120
  v_add_f32 v227, v227, v220
  v_mfma_f32_16x16x32_bf16 a[108:111], a[180:183], v[180:183], a[108:111]
  s_and_b32 s24, s24, 0x1ffff
  v_add_f32 v227, v227, v221
  v_cvt_pk_bf16_f32 v190, v220, v221
  v_add_f32 v227, v227, v222
  v_mfma_f32_16x16x32_bf16 a[112:115], a[184:187], v[176:179], a[112:115]
  ds_read_b128 a[152:155], v3 offset:6144
  v_add_f32 v227, v227, v223
  v_max_f32 v5, v226, v227
  v_cmp_lt_f32 vcc, s81, v5
  v_mfma_f32_16x16x32_bf16 a[116:119], a[184:187], v[180:183], a[116:119]
  v_exp_f32 v216, v128
  v_mfma_f32_16x16x32_bf16 a[120:123], a[188:191], v[176:179], a[120:123]
  s_waitcnt lgkmcnt(3)
  ds_read_b128 a[156:159], v3 offset:7168
  v_cvt_pk_bf16_f32 v191, v222, v223
  v_mfma_f32_16x16x32_bf16 a[124:127], a[188:191], v[180:183], a[124:127]
  s_cbranch_vccnz fa_stub14
fa_back14:
  v_exp_f32 v217, v129
  v_add_f32 v230, v230, v226
  v_add_f32 v231, v231, v227
  v_mfma_f32_16x16x32_bf16 v[144:147], a[128:131], v[64:67], v[200:203]
  ds_read_b128 a[160:163], v3 offset:24576
  v_add_f32 v226, v216, v217
  v_mfma_f32_16x16x32_bf16 v[152:155], a[128:131], v[68:71], v[204:207]
  v_exp_f32 v218, v130
  v_mfma_f32_16x16x32_bf16 v[148:151], a[132:135], v[64:67], v[200:203]
  s_add_u32 s66, s66, 32768
  ds_read_b128 a[164:167], v3 offset:25600
  v_cvt_pk_bf16_f32 v176, v216, v217
  v_mfma_f32_16x16x32_bf16 v[156:159], a[132:135], v[68:71], v[204:207]
  s_mov_b32 m0, s25
  v_exp_f32 v219, v131
  v_mfma_f32_16x16x32_bf16 v[144:147], a[136:139], v[72:75], v[144:147]
  s_and_b32 s66, s66, 0x1ffff
  ds_read_b128 a[168:171], v3 offset:26624
  buffer_load_dwordx4 v2, s[48:51], s27 offen offset:0 sc1 lds
  v_add_f32 v226, v226, v218
  v_add_f32 v226, v226, v219
  v_mfma_f32_16x16x32_bf16 v[152:155], a[136:139], v[76:79], v[152:155]
  v_exp_f32 v220, v132
  v_mfma_f32_16x16x32_bf16 v[148:151], a[140:143], v[72:75], v[148:151]
  ds_read_b128 a[172:175], v3 offset:27648
  v_cvt_pk_bf16_f32 v177, v218, v219
  v_mfma_f32_16x16x32_bf16 v[156:159], a[140:143], v[76:79], v[156:159]
  s_waitcnt lgkmcnt(4)
  v_exp_f32 v221, v133
  v_mfma_f32_16x16x32_bf16 v[144:147], a[144:147], v[80:83], v[144:147]
  s_add_u32 s14, s13, 4096
  ds_read_b128 a[176:179], v3 offset:28672
  buffer_load_dwordx4 a[16:19], v2, s[40:43], s14 offen offset:0 sc1
  v_add_f32 v226, v226, v220
  v_mfma_f32_16x16x32_bf16 v[152:155], a[144:147], v[84:87], v[152:155]
  v_exp_f32 v222, v134
  v_mfma_f32_16x16x32_bf16 v[148:151], a[148:151], v[80:83], v[148:151]
  ds_read_b128 a[180:183], v3 offset:29696
  buffer_load_dwordx4 v2, s[48:51], s27 offen offset:1024 sc1 lds
  v_add_f32 v226, v226, v221
  v_cvt_pk_bf16_f32 v178, v220, v221
  v_mfma_f32_16x16x32_bf16 v[156:159], a[148:151], v[84:87], v[156:159]
  v_exp_f32 v223, v135
  v_mfma_f32_16x16x32_bf16 v[144:147], a[152:155], v[88:91], v[144:147]
  ds_read_b128 a[184:187], v3 offset:30720
  v_add_f32 v226, v226, v222
  v_mfma_f32_16x16x32_bf16 v[152:155], a[152:155], v[92:95], v[152:155]
  v_exp_f32 v216, v136
  v_mfma_f32_16x16x32_bf16 v[148:151], a[156:159], v[88:91], v[148:151]
  ds_read_b128 a[188:191], v3 offset:31744
  v_add_f32 v226, v226, v223
  v_exp_f32 v217, v137
  v_mfma_f32_16x16x32_bf16 v[156:159], a[156:159], v[92:95], v[156:159]
  s_waitcnt lgkmcnt(4)
  v_exp_f32 v218, v138
  v_mfma_f32_16x16x32_bf16 a[64:67], a[160:163], v[184:187], a[64:67]
  ds_read_b128 a[128:131], v3 offset:8192
  v_cvt_pk_bf16_f32 v179, v222, v223
  v_mfma_f32_16x16x32_bf16 a[68:71], a[160:163], v[188:191], a[68:71]
  v_exp_f32 v219, v139
  v_mfma_f32_16x16x32_bf16 a[72:75], a[164:167], v[184:187], a[72:75]
  ds_read_b128 a[132:135], v3 offset:9216
  buffer_load_dwordx4 v2, s[48:51], s27 offen offset:2048 sc1 lds
  v_add_f32 v227, v216, v217
  v_mfma_f32_16x16x32_bf16 a[76:79], a[164:167], v[188:191], a[76:79]
  v_exp_f32 v220, v140
  v_mfma_f32_16x16x32_bf16 a[80:83], a[168:171], v[184:187], a[80:83]
  ds_read_b128 a[136:139], v3 offset:10240
  v_cvt_pk_bf16_f32 v180, v216, v217
  v_mfma_f32_16x16x32_bf16 a[84:87], a[168:171], v[188:191], a[84:87]
  v_exp_f32 v221, v141
  v_mfma_f32_16x16x32_bf16 a[88:91], a[172:175], v[184:187], a[88:91]
  ds_read_b128 a[140:143], v3 offset:11264
  buffer_load_dwordx4 a[20:23], v2, s[40:43], s14 offen offset:1024 sc1
  v_add_f32 v227, v227, v218
  v_mfma_f32_16x16x32_bf16 a[92:95], a[172:175], v[188:191], a[92:95]
  s_waitcnt lgkmcnt(4)
  v_exp_f32 v222, v142
  v_mfma_f32_16x16x32_bf16 a[96:99], a[176:179], v[184:187], a[96:99]
  ds_read_b128 a[144:147], v3 offset:12288
  buffer_load_dwordx4 v2, s[48:51], s27 offen offset:3072 sc1 lds
  v_add_f32 v227, v227, v219
  v_cvt_pk_bf16_f32 v181, v218, v219
  v_mfma_f32_16x16x32_bf16 a[100:103], a[176:179], v[188:191], a[100:103]
  s_add_u32 s27, s27, 16384
  v_exp_f32 v223, v143
  v_mfma_f32_16x16x32_bf16 a[104:107], a[180:183], v[184:187], a[104:107]
  s_add_u32 s25, s25, 32768
  ds_read_b128 a[148:151], v3 offset:13312
  v_add_f32 v227, v227, v220
  v_mfma_f32_16x16x32_bf16 a[108:111], a[180:183], v[188:191], a[108:111]
  s_and_b32 s25, s25, 0x1ffff
  v_add_f32 v227, v227, v221
  v_cvt_pk_bf16_f32 v182, v220, v221
  v_add_f32 v227, v227, v222
  v_mfma_f32_16x16x32_bf16 a[112:115], a[184:187], v[184:187], a[112:115]
  ds_read_b128 a[152:155], v3 offset:14336
  v_add_f32 v227, v227, v223
  v_max_f32 v5, v226, v227
  v_cmp_lt_f32 vcc, s81, v5
  v_mfma_f32_16x16x32_bf16 a[116:119], a[184:187], v[188:191], a[116:119]
  v_exp_f32 v216, v144
  v_mfma_f32_16x16x32_bf16 a[120:123], a[188:191], v[184:187], a[120:123]
  s_waitcnt lgkmcnt(3)
  ds_read_b128 a[156:159], v3 offset:15360
  v_cvt_pk_bf16_f32 v183, v222, v223
  v_add_u32 v3, s66, v2
  v_mfma_f32_16x16x32_bf16 a[124:127], a[188:191], v[188:191], a[124:127]
  s_cbranch_vccnz fa_stub15
fa_back15:
  v_exp_f32 v217, v145
  v_add_f32 v230, v230, v226
  v_add_f32 v231, v231, v227
fa_SSW6:
  v_mfma_f32_16x16x32_bf16 v[128:131], a[128:131], v[64:67], v[200:203]
  s_waitcnt vmcnt(12)
  v_exp_f32 v218, v146
  v_mfma_f32_16x16x32_bf16 v[136:139], a[128:131], v[68:71], v[204:207]
  s_barrier
  v_exp_f32 v219, v147
  v_mfma_f32_16x16x32_bf16 v[132:135], a[132:135], v[64:67], v[200:203]
  ds_read_b128 a[160:163], v3 offset:16384
  ds_read_b128 a[164:167], v3 offset:17408
  v_add_f32 v226, v216, v217
  v_mfma_f32_16x16x32_bf16 v[140:143], a[132:135], v[68:71], v[204:207]
  s_mov_b32 m0, s24
  v_exp_f32 v220, v148
  v_mfma_f32_16x16x32_bf16 v[128:131], a[136:139], v[72:75], v[128:131]
  ds_read_b128 a[168:171], v3 offset:18432
  buffer_load_dwordx4 v2, s[44:47], s26 offen offset:0 sc1 lds
  v_cvt_pk_bf16_f32 v184, v216, v217
  v_mfma_f32_16x16x32_bf16 v[136:139], a[136:139], v[76:79], v[136:139]
  v_exp_f32 v221, v149
  v_mfma_f32_16x16x32_bf16 v[132:135], a[140:143], v[72:75], v[132:135]
  ds_read_b128 a[172:175], v3 offset:19456
  v_add_f32 v226, v226, v218
  v_add_f32 v226, v226, v219
  v_mfma_f32_16x16x32_bf16 v[140:143], a[140:143], v[76:79], v[140:143]
  s_waitcnt lgkmcnt(4)
  v_exp_f32 v222, v150
  v_mfma_f32_16x16x32_bf16 v[128:131], a[144:147], v[80:83], v[128:131]
  s_add_u32 s14, s13, 4096
  ds_read_b128 a[176:179], v3 offset:20480
  buffer_load_dwordx4 a[24:27], v2, s[40:43], s14 offen offset:2048 sc1
  v_cvt_pk_bf16_f32 v185, v218, v219
  v_mfma_f32_16x16x32_bf16 v[136:139], a[144:147], v[84:87], v[136:139]
  v_exp_f32 v223, v151
  v_mfma_f32_16x16x32_bf16 v[132:135], a[148:151], v[80:83], v[132:135]
  ds_read_b128 a[180:183], v3 offset:21504
  buffer_load_dwordx4 v2, s[44:47], s26 offen offset:1024 sc1 lds
  v_add_f32 v226, v226, v220
  v_mfma_f32_16x16x32_bf16 v[140:143], a[148:151], v[84:87], v[140:143]
  v_exp_f32 v216, v152
  v_mfma_f32_16x16x32_bf16 v[128:131], a[152:155], v[88:91], v[128:131]
  ds_read_b128 a[184:187], v3 offset:22528
  v_add_f32 v226, v226, v221
  v_cvt_pk_bf16_f32 v186, v220, v221
  v_mfma_f32_16x16x32_bf16 v[136:139], a[152:155], v[92:95], v[136:139]
  v_exp_f32 v217, v153
  v_mfma_f32_16x16x32_bf16 v[132:135], a[156:159], v[88:91], v[132:135]
  ds_read_b128 a[188:191], v3 offset:23552
  v_add_f32 v226, v226, v222
  v_mfma_f32_16x16x32_bf16 v[140:143], a[156:159], v[92:95], v[140:143]
  s_waitcnt lgkmcnt(4)
  v_exp_f32 v218, v154
  v_mfma_f32_16x16x32_bf16 a[64:67], a[160:163], v[176:179], a[64:67]
  ds_read_b128 a[128:131], v3 offset:0
  v_add_f32 v226, v226, v223
  v_cvt_pk_bf16_f32 v187, v222, v223
  v_mfma_f32_16x16x32_bf16 a[68:71], a[160:163], v[180:183], a[68:71]
  v_exp_f32 v219, v155
  v_mfma_f32_16x16x32_bf16 a[72:75], a[164:167], v[176:179], a[72:75]
  ds_read_b128 a[132:135], v3 offset:1024
  buffer_load_dwordx4 v2, s[44:47], s26 offen offset:2048 sc1 lds
  v_add_f32 v227, v216, v217
  v_mfma_f32_16x16x32_bf16 a[76:79], a[164:167], v[180:183], a[76:79]
  v_exp_f32 v220, v156
  v_mfma_f32_16x16x32_bf16 a[80:83], a[168:171], v[176:179], a[80:83]
  ds_read_b128 a[136:139], v3 offset:2048
  v_cvt_pk_bf16_f32 v188, v216, v217
  v_mfma_f32_16x16x32_bf16 a[84:87], a[168:171], v[180:183], a[84:87]
  v_exp_f32 v221, v157
  v_mfma_f32_16x16x32_bf16 a[88:91], a[172:175], v[176:179], a[88:91]
  ds_read_b128 a[140:143], v3 offset:3072
  buffer_load_dwordx4 a[28:31], v2, s[40:43], s14 offen offset:3072 sc1
  v_add_f32 v227, v227, v218
  v_add_f32 v227, v227, v219
  v_mfma_f32_16x16x32_bf16 a[92:95], a[172:175], v[180:183], a[92:95]
  s_waitcnt lgkmcnt(4)
  v_exp_f32 v222, v158
  v_mfma_f32_16x16x32_bf16 a[96:99], a[176:179], v[176:179], a[96:99]
  ds_read_b128 a[144:147], v3 offset:4096
  buffer_load_dwordx4 v2, s[44:47], s26 offen offset:3072 sc1 lds
  v_cvt_pk_bf16_f32 v189, v218, v219
  v_mfma_f32_16x16x32_bf16 a[100:103], a[176:179], v[180:183], a[100:103]
  s_add_u32 s26, s26, 16384
  v_exp_f32 v223, v159
  v_mfma_f32_16x16x32_bf16 a[104:107], a[180:183], v[176:179], a[104:107]
  s_add_u32 s24, s24, 32768
  ds_read_b128 a[148:151], v3 offset:5120
  v_add_f32 v227, v227, v220
  v_mfma_f32_16x16x32_bf16 a[108:111], a[180:183], v[180:183], a[108:111]
  s_and_b32 s24, s24, 0x1ffff
  v_add_f32 v227, v227, v221
  v_cvt_pk_bf16_f32 v190, v220, v221
  v_add_f32 v227, v227, v222
  v_mfma_f32_16x16x32_bf16 a[112:115], a[184:187], v[176:179], a[112:115]
  ds_read_b128 a[152:155], v3 offset:6144
  v_add_f32 v227, v227, v223
  v_max_f32 v5, v226, v227
  v_cmp_lt_f32 vcc, s81, v5
  v_mfma_f32_16x16x32_bf16 a[116:119], a[184:187], v[180:183], a[116:119]
  v_exp_f32 v216, v128
  v_mfma_f32_16x16x32_bf16 a[120:123], a[188:191], v[176:179], a[120:123]
  s_waitcnt lgkmcnt(3)
  ds_read_b128 a[156:159], v3 offset:7168
  v_cvt_pk_bf16_f32 v191, v222, v223
  v_mfma_f32_16x16x32_bf16 a[124:127], a[188:191], v[180:183], a[124:127]
  s_cbranch_vccnz fa_stub16
fa_back16:
  v_exp_f32 v217, v129
  v_add_f32 v230, v230, v226
  v_add_f32 v231, v231, v227
  v_mfma_f32_16x16x32_bf16 v[144:147], a[128:131], v[64:67], v[200:203]
  ds_read_b128 a[160:163], v3 offset:24576
  v_add_f32 v226, v216, v217
  v_mfma_f32_16x16x32_bf16 v[152:155], a[128:131], v[68:71], v[204:207]
  v_exp_f32 v218, v130
  v_mfma_f32_16x16x32_bf16 v[148:151], a[132:135], v[64:67], v[200:203]
  s_add_u32 s66, s66, 32768
  ds_read_b128 a[164:167], v3 offset:25600
  v_cvt_pk_bf16_f32 v176, v216, v217
  v_mfma_f32_16x16x32_bf16 v[156:159], a[132:135], v[68:71], v[204:207]
  s_mov_b32 m0, s25
  v_exp_f32 v219, v131
  v_mfma_f32_16x16x32_bf16 v[144:147], a[136:139], v[72:75], v[144:147]
  s_and_b32 s66, s66, 0x1ffff
  ds_read_b128 a[168:171], v3 offset:26624
  buffer_load_dwordx4 v2, s[48:51], s27 offen offset:0 sc1 lds
  v_add_f32 v226, v226, v218
  v_add_f32 v226, v226, v219
  v_mfma_f32_16x16x32_bf16 v[152:155], a[136:139], v[76:79], v[152:155]
  v_exp_f32 v220, v132
  v_mfma_f32_16x16x32_bf16 v[148:151], a[140:143], v[72:75], v[148:151]
  ds_read_b128 a[172:175], v3 offset:27648
  v_cvt_pk_bf16_f32 v177, v218, v219
  v_mfma_f32_16x16x32_bf16 v[156:159], a[140:143], v[76:79], v[156:159]
  s_waitcnt lgkmcnt(4)
  v_exp_f32 v221, v133
  v_mfma_f32_16x16x32_bf16 v[144:147], a[144:147], v[80:83], v[144:147]
  s_add_u32 s14, s13, 8192
  ds_read_b128 a[176:179], v3 offset:28672
  buffer_load_dwordx4 a[32:35], v2, s[40:43], s14 offen offset:0 sc1
  v_add_f32 v226, v226, v220
  v_mfma_f32_16x16x32_bf16 v[152:155], a[144:147], v[84:87], v[152:155]
  v_exp_f32 v222, v134
  v_mfma_f32_16x16x32_bf16 v[148:151], a[148:151], v[80:83], v[148:151]
  ds_read_b128 a[180:183], v3 offset:29696
  buffer_load_dwordx4 v2, s[48:51], s27 offen offset:1024 sc1 lds
  v_add_f32 v226, v226, v221
  v_cvt_pk_bf16_f32 v178, v220, v221
  v_mfma_f32_16x16x32_bf16 v[156:159], a[148:151], v[84:87], v[156:159]
  v_exp_f32 v223, v135
  v_mfma_f32_16x16x32_bf16 v[144:147], a[152:155], v[88:91], v[144:147]
  ds_read_b128 a[184:187], v3 offset:30720
  v_add_f32 v226, v226, v222
  v_mfma_f32_16x16x32_bf16 v[152:155], a[152:155], v[92:95], v[152:155]
  v_exp_f32 v216, v136
  v_mfma_f32_16x16x32_bf16 v[148:151], a[156:159], v[88:91], v[148:151]
  ds_read_b128 a[188:191], v3 offset:31744
  v_add_f32 v226, v226, v223
  v_exp_f32 v217, v137
  v_mfma_f32_16x16x32_bf16 v[156:159], a[156:159], v[92:95], v[156:159]
  s_waitcnt lgkmcnt(4)
  v_exp_f32 v218, v138
  v_mfma_f32_16x16x32_bf16 a[64:67], a[160:163], v[184:187], a[64:67]
  ds_read_b128 a[128:131], v3 offset:8192
  v_cvt_pk_bf16_f32 v179, v222, v223
  v_mfma_f32_16x16x32_bf16 a[68:71], a[160:163], v[188:191], a[68:71]
  v_exp_f32 v219, v139
  v_mfma_f32_16x16x32_bf16 a[72:75], a[164:167], v[184:187], a[72:75]
  ds_read_b128 a[132:135], v3 offset:9216
  buffer_load_dwordx4 v2, s[48:51], s27 offen offset:2048 sc1 lds
  v_add_f32 v227, v216, v217
  v_mfma_f32_16x16x32_bf16 a[76:79], a[164:167], v[188:191], a[76:79]
  v_exp_f32 v220, v140
  v_mfma_f32_16x16x32_bf16 a[80:83], a[168:171], v[184:187], a[80:83]
  ds_read_b128 a[136:139], v3 offset:10240
  v_cvt_pk_bf16_f32 v180, v216, v217
  v_mfma_f32_16x16x32_bf16 a[84:87], a[168:171], v[188:191], a[84:87]
  v_exp_f32 v221, v141
  v_mfma_f32_16x16x32_bf16 a[88:91], a[172:175], v[184:187], a[88:91]
  ds_read_b128 a[140:143], v3 offset:11264
  buffer_load_dwordx4 a[36:39], v2, s[40:43], s14 offen offset:1024 sc1
  v_add_f32 v227, v227, v218
  v_mfma_f32_16x16x32_bf16 a[92:95], a[172:175], v[188:191], a[92:95]
  s_waitcnt lgkmcnt(4)
  v_exp_f32 v222, v142
  v_mfma_f32_16x16x32_bf16 a[96:99], a[176:179], v[184:187], a[96:99]
  ds_read_b128 a[144:147], v3 offset:12288
  buffer_load_dwordx4 v2, s[48:51], s27 offen offset:3072 sc1 lds
  v_add_f32 v227, v227, v219
  v_cvt_pk_bf16_f32 v181, v218, v219
  v_mfma_f32_16x16x32_bf16 a[100:103], a[176:179], v[188:191], a[100:103]
  s_add_u32 s27, s27, 16384
  v_exp_f32 v223, v143
  v_mfma_f32_16x16x32_bf16 a[104:107], a[180:183], v[184:187], a[104:107]
  s_add_u32 s25, s25, 32768
  ds_read_b128 a[148:151], v3 offset:13312
  v_add_f32 v227, v227, v220
  v_mfma_f32_16x16x32_bf16 a[108:111], a[180:183], v[188:191], a[108:111]
  s_and_b32 s25, s25, 0x1ffff
  v_add_f32 v227, v227, v221
  v_cvt_pk_bf16_f32 v182, v220, v221
  v_add_f32 v227, v227, v222
  v_mfma_f32_16x16x32_bf16 a[112:115], a[184:187], v[184:187], a[112:115]
  ds_read_b128 a[152:155], v3 offset:14336
  v_add_f32 v227, v227, v223
  v_max_f32 v5, v226, v227
  v_cmp_lt_f32 vcc, s81, v5
  v_mfma_f32_16x16x32_bf16 a[116:119], a[184:187], v[188:191], a[116:119]
  v_exp_f32 v216, v144
  v_mfma_f32_16x16x32_bf16 a[120:123], a[188:191], v[184:187], a[120:123]
  s_waitcnt lgkmcnt(3)
  ds_read_b128 a[156:159], v3 offset:15360
  v_cvt_pk_bf16_f32 v183, v222, v223
  v_add_u32 v3, s66, v2
  v_mfma_f32_16x16x32_bf16 a[124:127], a[188:191], v[188:191], a[124:127]
  s_cbranch_vccnz fa_stub17
fa_back17:
  v_exp_f32 v217, v145
  v_add_f32 v230, v230, v226
  v_add_f32 v231, v231, v227
fa_SSW5:
  v_mfma_f32_16x16x32_bf16 v[128:131], a[128:131], v[64:67], v[200:203]
  s_waitcnt vmcnt(12)
  v_exp_f32 v218, v146
  v_mfma_f32_16x16x32_bf16 v[136:139], a[128:131], v[68:71], v[204:207]
  s_barrier
  v_exp_f32 v219, v147
  v_mfma_f32_16x16x32_bf16 v[132:135], a[132:135], v[64:67], v[200:203]
  ds_read_b128 a[160:163], v3 offset:16384
  ds_read_b128 a[164:167], v3 offset:17408
  v_add_f32 v226, v216, v217
  v_mfma_f32_16x16x32_bf16 v[140:143], a[132:135], v[68:71], v[204:207]
  s_mov_b32 m0, s24
  v_exp_f32 v220, v148
  v_mfma_f32_16x16x32_bf16 v[128:131], a[136:139], v[72:75], v[128:131]
  ds_read_b128 a[168:171], v3 offset:18432
  buffer_load_dwordx4 v2, s[44:47], s26 offen offset:0 sc1 lds
  v_cvt_pk_bf16_f32 v184, v216, v217
  v_mfma_f32_16x16x32_bf16 v[136:139], a[136:139], v[76:79], v[136:139]
  v_exp_f32 v221, v149
  v_mfma_f32_16x16x32_bf16 v[132:135], a[140:143], v[72:75], v[132:135]
  ds_read_b128 a[172:175], v3 offset:19456
  v_add_f32 v226, v226, v218
  v_add_f32 v226, v226, v219
  v_mfma_f32_16x16x32_bf16 v[140:143], a[140:143], v[76:79], v[140:143]
  s_waitcnt lgkmcnt(4)
  v_exp_f32 v222, v150
  v_mfma_f32_16x16x32_bf16 v[128:131], a[144:147], v[80:83], v[128:131]
  s_add_u32 s14, s13, 8192
  ds_read_b128 a[176:179], v3 offset:20480
  buffer_load_dwordx4 a[40:43], v2, s[40:43], s14 offen offset:2048 sc1
  v_cvt_pk_bf16_f32 v185, v218, v219
  v_mfma_f32_16x16x32_bf16 v[136:139], a[144:147], v[84:87], v[136:139]
  v_exp_f32 v223, v151
  v_mfma_f32_16x16x32_bf16 v[132:135], a[148:151], v[80:83], v[132:135]
  ds_read_b128 a[180:183], v3 offset:21504
  buffer_load_dwordx4 v2, s[44:47], s26 offen offset:1024 sc1 lds
  v_add_f32 v226, v226, v220
  v_mfma_f32_16x16x32_bf16 v[140:143], a[148:151], v[84:87], v[140:143]
  v_exp_f32 v216, v152
  v_mfma_f32_16x16x32_bf16 v[128:131], a[152:155], v[88:91], v[128:131]
  ds_read_b128 a[184:187], v3 offset:22528
  v_add_f32 v226, v226, v221
  v_cvt_pk_bf16_f32 v186, v220, v221
  v_mfma_f32_16x16x32_bf16 v[136:139], a[152:155], v[92:95], v[136:139]
  v_exp_f32 v217, v153
  v_mfma_f32_16x16x32_bf16 v[132:135], a[156:159], v[88:91], v[132:135]
  ds_read_b128 a[188:191], v3 offset:23552
  buffer_load_dwordx4 a[44:47], v2, s[40:43], s14 offen offset:3072 sc1
  v_add_f32 v226, v226, v222
  v_mfma_f32_16x16x32_bf16 v[140:143], a[156:159], v[92:95], v[140:143]
  s_waitcnt lgkmcnt(4)
  v_exp_f32 v218, v154
  v_mfma_f32_16x16x32_bf16 a[64:67], a[160:163], v[176:179], a[64:67]
  ds_read_b128 a[128:131], v3 offset:0
  v_add_f32 v226, v226, v223
  v_cvt_pk_bf16_f32 v187, v222, v223
  v_mfma_f32_16x16x32_bf16 a[68:71], a[160:163], v[180:183], a[68:71]
  v_exp_f32 v219, v155
  v_mfma_f32_16x16x32_bf16 a[72:75], a[164:167], v[176:179], a[72:75]
  ds_read_b128 a[132:135], v3 offset:1024
  buffer_load_dwordx4 v2, s[44:47], s26 offen offset:2048 sc1 lds
  v_add_f32 v227, v216, v217
  v_mfma_f32_16x16x32_bf16 a[76:79], a[164:167], v[180:183], a[76:79]
  v_exp_f32 v220, v156
  v_mfma_f32_16x16x32_bf16 a[80:83], a[168:171], v[176:179], a[80:83]
  ds_read_b128 a[136:139], v3 offset:2048
  v_cvt_pk_bf16_f32 v188, v216, v217
  v_mfma_f32_16x16x32_bf16 a[84:87], a[168:171], v[180:183], a[84:87]
  v_exp_f32 v221, v157
  v_mfma_f32_16x16x32_bf16 a[88:91], a[172:175], v[176:179], a[88:91]
  s_add_u32 s14, s13, 12288
  ds_read_b128 a[140:143], v3 offset:3072
  buffer_load_dwordx4 a[48:51], v2, s[40:43], s14 offen offset:0 sc1
  v_add_f32 v227, v227, v218
  v_add_f32 v227, v227, v219
  v_mfma_f32_16x16x32_bf16 a[92:95], a[172:175], v[180:183], a[92:95]
  s_waitcnt lgkmcnt(4)
  v_exp_f32 v222, v158
  v_mfma_f32_16x16x32_bf16 a[96:99], a[176:179], v[176:179], a[96:99]
  ds_read_b128 a[144:147], v3 offset:4096
  buffer_load_dwordx4 v2, s[44:47], s26 offen offset:3072 sc1 lds
  v_cvt_pk_bf16_f32 v189, v218, v219
  v_mfma_f32_16x16x32_bf16 a[100:103], a[176:179], v[180:183], a[100:103]
  s_add_u32 s26, s26, 16384
  v_exp_f32 v223, v159
  v_mfma_f32_16x16x32_bf16 a[104:107], a[180:183], v[176:179], a[104:107]
  s_add_u32 s24, s24, 32768
  ds_read_b128 a[148:151], v3 offset:5120
  v_add_f32 v227, v227, v220
  v_mfma_f32_16x16x32_bf16 a[108:111], a[180:183], v[180:183], a[108:111]
  s_and_b32 s24, s24, 0x1ffff
  v_add_f32 v227, v227, v221
  v_cvt_pk_bf16_f32 v190, v220, v221
  v_add_f32 v227, v227, v222
  v_mfma_f32_16x16x32_bf16 a[112:115], a[184:187], v[176:179], a[112:115]
  ds_read_b128 a[152:155], v3 offset:6144
  v_add_f32 v227, v227, v223
  v_max_f32 v5, v226, v227
  v_cmp_lt_f32 vcc, s81, v5
  v_mfma_f32_16x16x32_bf16 a[116:119], a[184:187], v[180:183], a[116:119]
  v_exp_f32 v216, v128
  v_mfma_f32_16x16x32_bf16 a[120:123], a[188:191], v[176:179], a[120:123]
  s_waitcnt lgkmcnt(3)
  ds_read_b128 a[156:159], v3 offset:7168
  v_cvt_pk_bf16_f32 v191, v222, v223
  v_mfma_f32_16x16x32_bf16 a[124:127], a[188:191], v[180:183], a[124:127]
  s_cbranch_vccnz fa_stub18
fa_back18:
  v_exp_f32 v217, v129
  v_add_f32 v230, v230, v226
  v_add_f32 v231, v231, v227
  v_mfma_f32_16x16x32_bf16 v[144:147], a[128:131], v[64:67], v[200:203]
  ds_read_b128 a[160:163], v3 offset:24576
  v_add_f32 v226, v216, v217
  v_mfma_f32_16x16x32_bf16 v[152:155], a[128:131], v[68:71], v[204:207]
  v_exp_f32 v218, v130
  v_mfma_f32_16x16x32_bf16 v[148:151], a[132:135], v[64:67], v[200:203]
  s_add_u32 s66, s66, 32768
  ds_read_b128 a[164:167], v3 offset:25600
  v_cvt_pk_bf16_f32 v176, v216, v217
  v_mfma_f32_16x16x32_bf16 v[156:159], a[132:135], v[68:71], v[204:207]
  s_mov_b32 m0, s25
  v_exp_f32 v219, v131
  v_mfma_f32_16x16x32_bf16 v[144:147], a[136:139], v[72:75], v[144:147]
  s_and_b32 s66, s66, 0x1ffff
  ds_read_b128 a[168:171], v3 offset:26624
  buffer_load_dwordx4 v2, s[48:51], s27 offen offset:0 sc1 lds
  v_add_f32 v226, v226, v218
  v_add_f32 v226, v226, v219
  v_mfma_f32_16x16x32_bf16 v[152:155], a[136:139], v[76:79], v[152:155]
  v_exp_f32 v220, v132
  v_mfma_f32_16x16x32_bf16 v[148:151], a[140:143], v[72:75], v[148:151]
  ds_read_b128 a[172:175], v3 offset:27648
  v_cvt_pk_bf16_f32 v177, v218, v219
  v_mfma_f32_16x16x32_bf16 v[156:159], a[140:143], v[76:79], v[156:159]
  s_waitcnt lgkmcnt(4)
  v_exp_f32 v221, v133
  v_mfma_f32_16x16x32_bf16 v[144:147], a[144:147], v[80:83], v[144:147]
  s_add_u32 s14, s13, 12288
  ds_read_b128 a[176:179], v3 offset:28672
  buffer_load_dwordx4 a[52:55], v2, s[40:43], s14 offen offset:1024 sc1
  v_add_f32 v226, v226, v220
  v_mfma_f32_16x16x32_bf16 v[152:155], a[144:147], v[84:87], v[152:155]
  v_exp_f32 v222, v134
  v_mfma_f32_16x16x32_bf16 v[148:151], a[148:151], v[80:83], v[148:151]
  ds_read_b128 a[180:183], v3 offset:29696
  buffer_load_dwordx4 v2, s[48:51], s27 offen offset:1024 sc1 lds
  v_add_f32 v226, v226, v221
  v_cvt_pk_bf16_f32 v178, v220, v221
  v_mfma_f32_16x16x32_bf16 v[156:159], a[148:151], v[84:87], v[156:159]
  v_exp_f32 v223, v135
  v_mfma_f32_16x16x32_bf16 v[144:147], a[152:155], v[88:91], v[144:147]
  ds_read_b128 a[184:187], v3 offset:30720
  v_add_f32 v226, v226, v222
  v_mfma_f32_16x16x32_bf16 v[152:155], a[152:155], v[92:95], v[152:155]
  v_exp_f32 v216, v136
  v_mfma_f32_16x16x32_bf16 v[148:151], a[156:159], v[88:91], v[148:151]
  ds_read_b128 a[188:191], v3 offset:31744
  buffer_load_dwordx4 a[56:59], v2, s[40:43], s14 offen offset:2048 sc1
  v_add_f32 v226, v226, v223
  v_exp_f32 v217, v137
  v_mfma_f32_16x16x32_bf16 v[156:159], a[156:159], v[92:95], v[156:159]
  s_waitcnt lgkmcnt(4)
  v_exp_f32 v218, v138
  v_mfma_f32_16x16x32_bf16 a[64:67], a[160:163], v[184:187], a[64:67]
  ds_read_b128 a[128:131], v3 offset:8192
  v_cvt_pk_bf16_f32 v179, v222, v223
  v_mfma_f32_16x16x32_bf16 a[68:71], a[160:163], v[188:191], a[68:71]
  v_exp_f32 v219, v139
  v_mfma_f32_16x16x32_bf16 a[72:75], a[164:167], v[184:187], a[72:75]
  ds_read_b128 a[132:135], v3 offset:9216
  buffer_load_dwordx4 v2, s[48:51], s27 offen offset:2048 sc1 lds
  v_add_f32 v227, v216, v217
  v_mfma_f32_16x16x32_bf16 a[76:79], a[164:167], v[188:191], a[76:79]
  v_exp_f32 v220, v140
  v_mfma_f32_16x16x32_bf16 a[80:83], a[168:171], v[184:187], a[80:83]
  ds_read_b128 a[136:139], v3 offset:10240
  v_cvt_pk_bf16_f32 v180, v216, v217
  v_mfma_f32_16x16x32_bf16 a[84:87], a[168:171], v[188:191], a[84:87]
  v_exp_f32 v221, v141
  v_mfma_f32_16x16x32_bf16 a[88:91], a[172:175], v[184:187], a[88:91]
  ds_read_b128 a[140:143], v3 offset:11264
  buffer_load_dwordx4 a[60:63], v2, s[40:43], s14 offen offset:3072 sc1
  v_add_f32 v227, v227, v218
  v_mfma_f32_16x16x32_bf16 a[92:95], a[172:175], v[188:191], a[92:95]
  s_waitcnt lgkmcnt(4)
  v_exp_f32 v222, v142
  v_mfma_f32_16x16x32_bf16 a[96:99], a[176:179], v[184:187], a[96:99]
  ds_read_b128 a[144:147], v3 offset:12288
  buffer_load_dwordx4 v2, s[48:51], s27 offen offset:3072 sc1 lds
  v_add_f32 v227, v227, v219
  v_cvt_pk_bf16_f32 v181, v218, v219
  v_mfma_f32_16x16x32_bf16 a[100:103], a[176:179], v[188:191], a[100:103]
  s_add_u32 s27, s27, 16384
  v_exp_f32 v223, v143
  v_mfma_f32_16x16x32_bf16 a[104:107], a[180:183], v[184:187], a[104:107]
  s_add_u32 s25, s25, 32768
  ds_read_b128 a[148:151], v3 offset:13312
  v_add_f32 v227, v227, v220
  v_mfma_f32_16x16x32_bf16 a[108:111], a[180:183], v[188:191], a[108:111]
  s_and_b32 s25, s25, 0x1ffff
  v_add_f32 v227, v227, v221
  v_cvt_pk_bf16_f32 v182, v220, v221
  v_add_f32 v227, v227, v222
  v_mfma_f32_16x16x32_bf16 a[112:115], a[184:187], v[184:187], a[112:115]
  ds_read_b128 a[152:155], v3 offset:14336
  v_add_f32 v227, v227, v223
  v_max_f32 v5, v226, v227
  v_cmp_lt_f32 vcc, s81, v5
  v_mfma_f32_16x16x32_bf16 a[116:119], a[184:187], v[188:191], a[116:119]
  v_exp_f32 v216, v144
  v_mfma_f32_16x16x32_bf16 a[120:123], a[188:191], v[184:187], a[120:123]
  s_waitcnt lgkmcnt(3)
  ds_read_b128 a[156:159], v3 offset:15360
  v_cvt_pk_bf16_f32 v183, v222, v223
  v_add_u32 v3, s66, v2
  v_mfma_f32_16x16x32_bf16 a[124:127], a[188:191], v[188:191], a[124:127]
  s_cbranch_vccnz fa_stub19
fa_back19:
  v_exp_f32 v217, v145
  v_add_f32 v230, v230, v226
  v_add_f32 v231, v231, v227
fa_SSW4:
  v_mfma_f32_16x16x32_bf16 v[128:131], a[128:131], v[64:67], v[200:203]
  s_waitcnt vmcnt(12)
  v_exp_f32 v218, v146
  v_mfma_f32_16x16x32_bf16 v[136:139], a[128:131], v[68:71], v[204:207]
  s_barrier
  v_exp_f32 v219, v147
  v_mfma_f32_16x16x32_bf16 v[132:135], a[132:135], v[64:67], v[200:203]
  ds_read_b128 a[160:163], v3 offset:16384
  ds_read_b128 a[164:167], v3 offset:17408
  v_add_f32 v226, v216, v217
  v_mfma_f32_16x16x32_bf16 v[140:143], a[132:135], v[68:71], v[204:207]
  s_mov_b32 m0, s24
  v_exp_f32 v220, v148
  v_mfma_f32_16x16x32_bf16 v[128:131], a[136:139], v[72:75], v[128:131]
  ds_read_b128 a[168:171], v3 offset:18432
  buffer_load_dwordx4 v2, s[44:47], s26 offen offset:0 sc1 lds
  v_cvt_pk_bf16_f32 v184, v216, v217
  v_mfma_f32_16x16x32_bf16 v[136:139], a[136:139], v[76:79], v[136:139]
  v_exp_f32 v221, v149
  v_mfma_f32_16x16x32_bf16 v[132:135], a[140:143], v[72:75], v[132:135]
  s_add_u32 s14, s13, 16384
  ds_read_b128 a[172:175], v3 offset:19456
  buffer_load_dwordx4 a[192:195], v2, s[40:43], s14 offen offset:0 sc1
  v_add_f32 v226, v226, v218
  v_add_f32 v226, v226, v219
  v_mfma_f32_16x16x32_bf16 v[140:143], a[140:143], v[76:79], v[140:143]
  s_waitcnt lgkmcnt(4)
  v_exp_f32 v222, v150
  v_mfma_f32_16x16x32_bf16 v[128:131], a[144:147], v[80:83], v[128:131]
  ds_read_b128 a[176:179], v3 offset:20480
  v_cvt_pk_bf16_f32 v185, v218, v219
  v_mfma_f32_16x16x32_bf16 v[136:139], a[144:147], v[84:87], v[136:139]
  v_exp_f32 v223, v151
  v_mfma_f32_16x16x32_bf16 v[132:135], a[148:151], v[80:83], v[132:135]
  ds_read_b128 a[180:183], v3 offset:21504
  buffer_load_dwordx4 v2, s[44:47], s26 offen offset:1024 sc1 lds
  v_add_f32 v226, v226, v220
  v_mfma_f32_16x16x32_bf16 v[140:143], a[148:151], v[84:87], v[140:143]
  v_exp_f32 v216, v152
  v_mfma_f32_16x16x32_bf16 v[128:131], a[152:155], v[88:91], v[128:131]
  ds_read_b128 a[184:187], v3 offset:22528
  v_add_f32 v226, v226, v221
  v_cvt_pk_bf16_f32 v186, v220, v221
  v_mfma_f32_16x16x32_bf16 v[136:139], a[152:155], v[92:95], v[136:139]
  v_exp_f32 v217, v153
  v_mfma_f32_16x16x32_bf16 v[132:135], a[156:159], v[88:91], v[132:135]
  ds_read_b128 a[188:191], v3 offset:23552
  buffer_load_dwordx4 a[196:199], v2, s[40:43], s14 offen offset:1024 sc1
  v_add_f32 v226, v226, v222
  v_mfma_f32_16x16x32_bf16 v[140:143], a[156:159], v[92:95], v[140:143]
  s_waitcnt lgkmcnt(4)
  v_exp_f32 v218, v154
  v_mfma_f32_16x16x32_bf16 a[64:67], a[160:163], v[176:179], a[64:67]
  ds_read_b128 a[128:131], v3 offset:0
  v_add_f32 v226, v226, v223
  v_cvt_pk_bf16_f32 v187, v222, v223
  v_mfma_f32_16x16x32_bf16 a[68:71], a[160:163], v[180:183], a[68:71]
  v_exp_f32 v219, v155
  v_mfma_f32_16x16x32_bf16 a[72:75], a[164:167], v[176:179], a[72:75]
  ds_read_b128 a[132:135], v3 offset:1024
  buffer_load_dwordx4 v2, s[44:47], s26 offen offset:2048 sc1 lds
  v_add_f32 v227, v216, v217
  v_mfma_f32_16x16x32_bf16 a[76:79], a[164:167], v[180:183], a[76:79]
  v_exp_f32 v220, v156
  v_mfma_f32_16x16x32_bf16 a[80:83], a[168:171], v[176:179], a[80:83]
  ds_read_b128 a[136:139], v3 offset:2048
  buffer_load_dwordx4 a[200:203], v2, s[40:43], s14 offen offset:2048 sc1
  v_cvt_pk_bf16_f32 v188, v216, v217
  v_mfma_f32_16x16x32_bf16 a[84:87], a[168:171], v[180:183], a[84:87]
  v_exp_f32 v221, v157
  v_mfma_f32_16x16x32_bf16 a[88:91], a[172:175], v[176:179], a[88:91]
  ds_read_b128 a[140:143], v3 offset:3072
  v_add_f32 v227, v227, v218
  v_add_f32 v227, v227, v219
  v_mfma_f32_16x16x32_bf16 a[92:95], a[172:175], v[180:183], a[92:95]
  s_waitcnt lgkmcnt(4)
  v_exp_f32 v222, v158
  v_mfma_f32_16x16x32_bf16 a[96:99], a[176:179], v[176:179], a[96:99]
  ds_read_b128 a[144:147], v3 offset:4096
  buffer_load_dwordx4 v2, s[44:47], s26 offen offset:3072 sc1 lds
  v_cvt_pk_bf16_f32 v189, v218, v219
  v_mfma_f32_16x16x32_bf16 a[100:103], a[176:179], v[180:183], a[100:103]
  s_add_u32 s26, s26, 16384
  v_exp_f32 v223, v159
  v_mfma_f32_16x16x32_bf16 a[104:107], a[180:183], v[176:179], a[104:107]
  s_add_u32 s24, s24, 32768
  ds_read_b128 a[148:151], v3 offset:5120
  buffer_load_dwordx4 a[204:207], v2, s[40:43], s14 offen offset:3072 sc1
  v_add_f32 v227, v227, v220
  v_mfma_f32_16x16x32_bf16 a[108:111], a[180:183], v[180:183], a[108:111]
  s_and_b32 s24, s24, 0x1ffff
  v_add_f32 v227, v227, v221
  v_cvt_pk_bf16_f32 v190, v220, v221
  v_add_f32 v227, v227, v222
  v_mfma_f32_16x16x32_bf16 a[112:115], a[184:187], v[176:179], a[112:115]
  ds_read_b128 a[152:155], v3 offset:6144
  v_add_f32 v227, v227, v223
  v_max_f32 v5, v226, v227
  v_cmp_lt_f32 vcc, s81, v5
  v_mfma_f32_16x16x32_bf16 a[116:119], a[184:187], v[180:183], a[116:119]
  v_exp_f32 v216, v128
  v_mfma_f32_16x16x32_bf16 a[120:123], a[188:191], v[176:179], a[120:123]
  s_waitcnt lgkmcnt(3)
  ds_read_b128 a[156:159], v3 offset:7168
  v_cvt_pk_bf16_f32 v191, v222, v223
  v_mfma_f32_16x16x32_bf16 a[124:127], a[188:191], v[180:183], a[124:127]
  s_cbranch_vccnz fa_stub20
fa_back20:
  v_exp_f32 v217, v129
  v_add_f32 v230, v230, v226
  v_add_f32 v231, v231, v227
  v_mfma_f32_16x16x32_bf16 v[144:147], a[128:131], v[64:67], v[200:203]
  ds_read_b128 a[160:163], v3 offset:24576
  v_add_f32 v226, v216, v217
  v_mfma_f32_16x16x32_bf16 v[152:155], a[128:131], v[68:71], v[204:207]
  v_exp_f32 v218, v130
  v_mfma_f32_16x16x32_bf16 v[148:151], a[132:135], v[64:67], v[200:203]
  s_add_u32 s66, s66, 32768
  ds_read_b128 a[164:167], v3 offset:25600
  v_cvt_pk_bf16_f32 v176, v216, v217
  v_mfma_f32_16x16x32_bf16 v[156:159], a[132:135], v[68:71], v[204:207]
  s_mov_b32 m0, s25
  v_exp_f32 v219, v131
  v_mfma_f32_16x16x32_bf16 v[144:147], a[136:139], v[72:75], v[144:147]
  s_and_b32 s66, s66, 0x1ffff
  ds_read_b128 a[168:171], v3 offset:26624
  buffer_load_dwordx4 v2, s[48:51], s27 offen offset:0 sc1 lds
  v_add_f32 v226, v226, v218
  v_add_f32 v226, v226, v219
  v_mfma_f32_16x16x32_bf16 v[152:155], a[136:139], v[76:79], v[152:155]
  v_exp_f32 v220, v132
  v_mfma_f32_16x16x32_bf16 v[148:151], a[140:143], v[72:75], v[148:151]
  s_add_u32 s14, s13, 20480
  ds_read_b128 a[172:175], v3 offset:27648
  buffer_load_dwordx4 a[208:211], v2, s[40:43], s14 offen offset:0 sc1
  v_cvt_pk_bf16_f32 v177, v218, v219
  v_mfma_f32_16x16x32_bf16 v[156:159], a[140:143], v[76:79], v[156:159]
  s_waitcnt lgkmcnt(4)
  v_exp_f32 v221, v133
  v_mfma_f32_16x16x32_bf16 v[144:147], a[144:147], v[80:83], v[144:147]
  ds_read_b128 a[176:179], v3 offset:28672
  v_add_f32 v226, v226, v220
  v_mfma_f32_16x16x32_bf16 v[152:155], a[144:147], v[84:87], v[152:155]
  v_exp_f32 v222, v134
  v_mfma_f32_16x16x32_bf16 v[148:151], a[148:151], v[80:83], v[148:151]
  ds_read_b128 a[180:183], v3 offset:29696
  buffer_load_dwordx4 v2, s[48:51], s27 offen offset:1024 sc1 lds
  v_add_f32 v226, v226, v221
  v_cvt_pk_bf16_f32 v178, v220, v221
  v_mfma_f32_16x16x32_bf16 v[156:159], a[148:151], v[84:87], v[156:159]
  v_exp_f32 v223, v135
  v_mfma_f32_16x16x32_bf16 v[144:147], a[152:155], v[88:91], v[144:147]
  ds_read_b128 a[184:187], v3 offset:30720
  v_add_f32 v226, v226, v222
  v_mfma_f32_16x16x32_bf16 v[152:155], a[152:155], v[92:95], v[152:155]
  v_exp_f32 v216, v136
  v_mfma_f32_16x16x32_bf16 v[148:151], a[156:159], v[88:91], v[148:151]
  ds_read_b128 a[188:191], v3 offset:31744
  buffer_load_dwordx4 a[212:215], v2, s[40:43], s14 offen offset:1024 sc1
  v_add_f32 v226, v226, v223
  v_exp_f32 v217, v137
  v_mfma_f32_16x16x32_bf16 v[156:159], a[156:159], v[92:95], v[156:159]
  s_waitcnt lgkmcnt(4)
  v_exp_f32 v218, v138
  v_mfma_f32_16x16x32_bf16 a[64:67], a[160:163], v[184:187], a[64:67]
  ds_read_b128 a[128:131], v3 offset:8192
  v_cvt_pk_bf16_f32 v179, v222, v223
  v_mfma_f32_16x16x32_bf16 a[68:71], a[160:163], v[188:191], a[68:71]
  v_exp_f32 v219, v139
  v_mfma_f32_16x16x32_bf16 a[72:75], a[164:167], v[184:187], a[72:75]
  ds_read_b128 a[132:135], v3 offset:9216
  buffer_load_dwordx4 v2, s[48:51], s27 offen offset:2048 sc1 lds
  v_add_f32 v227, v216, v217
  v_mfma_f32_16x16x32_bf16 a[76:79], a[164:167], v[188:191], a[76:79]
  v_exp_f32 v220, v140
  v_mfma_f32_16x16x32_bf16 a[80:83], a[168:171], v[184:187], a[80:83]
  ds_read_b128 a[136:139], v3 offset:10240
  buffer_load_dwordx4 a[216:219], v2, s[40:43], s14 offen offset:2048 sc1
  v_cvt_pk_bf16_f32 v180, v216, v217
  v_mfma_f32_16x16x32_bf16 a[84:87], a[168:171], v[188:191], a[84:87]
  v_exp_f32 v221, v141
  v_mfma_f32_16x16x32_bf16 a[88:91], a[172:175], v[184:187], a[88:91]
  ds_read_b128 a[140:143], v3 offset:11264
  v_add_f32 v227, v227, v218
  v_mfma_f32_16x16x32_bf16 a[92:95], a[172:175], v[188:191], a[92:95]
  s_waitcnt lgkmcnt(4)
  v_exp_f32 v222, v142
  v_mfma_f32_16x16x32_bf16 a[96:99], a[176:179], v[184:187], a[96:99]
  ds_read_b128 a[144:147], v3 offset:12288
  buffer_load_dwordx4 v2, s[48:51], s27 offen offset:3072 sc1 lds
  v_add_f32 v227, v227, v219
  v_cvt_pk_bf16_f32 v181, v218, v219
  v_mfma_f32_16x16x32_bf16 a[100:103], a[176:179], v[188:191], a[100:103]
  s_add_u32 s27, s27, 16384
  v_exp_f32 v223, v143
  v_mfma_f32_16x16x32_bf16 a[104:107], a[180:183], v[184:187], a[104:107]
  s_add_u32 s25, s25, 32768
  ds_read_b128 a[148:151], v3 offset:13312
  buffer_load_dwordx4 a[220:223], v2, s[40:43], s14 offen offset:3072 sc1
  v_add_f32 v227, v227, v220
  v_mfma_f32_16x16x32_bf16 a[108:111], a[180:183], v[188:191], a[108:111]
  s_and_b32 s25, s25, 0x1ffff
  v_add_f32 v227, v227, v221
  v_cvt_pk_bf16_f32 v182, v220, v221
  v_add_f32 v227, v227, v222
  v_mfma_f32_16x16x32_bf16 a[112:115], a[184:187], v[184:187], a[112:115]
  ds_read_b128 a[152:155], v3 offset:14336
  v_add_f32 v227, v227, v223
  v_max_f32 v5, v226, v227
  v_cmp_lt_f32 vcc, s81, v5
  v_mfma_f32_16x16x32_bf16 a[116:119], a[184:187], v[188:191], a[116:119]
  v_exp_f32 v216, v144
  v_mfma_f32_16x16x32_bf16 a[120:123], a[188:191], v[184:187], a[120:123]
  s_waitcnt lgkmcnt(3)
  ds_read_b128 a[156:159], v3 offset:15360
  v_cvt_pk_bf16_f32 v183, v222, v223
  v_add_u32 v3, s66, v2
  v_mfma_f32_16x16x32_bf16 a[124:127], a[188:191], v[188:191], a[124:127]
  s_cbranch_vccnz fa_stub21
fa_back21:
  v_exp_f32 v217, v145
  v_add_f32 v230, v230, v226
  v_add_f32 v231, v231, v227
fa_SSW3:
  v_mfma_f32_16x16x32_bf16 v[128:131], a[128:131], v[64:67], v[200:203]
  s_waitcnt vmcnt(12)
  v_exp_f32 v218, v146
  v_mfma_f32_16x16x32_bf16 v[136:139], a[128:131], v[68:71], v[204:207]
  s_barrier
  v_exp_f32 v219, v147
  v_mfma_f32_16x16x32_bf16 v[132:135], a[132:135], v[64:67], v[200:203]
  s_cmp_ge_u32 s26, s46
  s_cselect_b64 s[44:45], s[4:5], s[44:45]
  s_cselect_b32 s46, s30, s46
  ds_read_b128 a[160:163], v3 offset:16384
  ds_read_b128 a[164:167], v3 offset:17408
  v_add_f32 v226, v216, v217
  v_mfma_f32_16x16x32_bf16 v[140:143], a[132:135], v[68:71], v[204:207]
  s_mov_b32 m0, s24
  v_exp_f32 v220, v148
  v_mfma_f32_16x16x32_bf16 v[128:131], a[136:139], v[72:75], v[128:131]
  ds_read_b128 a[168:171], v3 offset:18432
  buffer_load_dwordx4 v2, s[44:47], s26 offen offset:0 sc1 lds
  v_cvt_pk_bf16_f32 v184, v216, v217
  v_mfma_f32_16x16x32_bf16 v[136:139], a[136:139], v[76:79], v[136:139]
  v_exp_f32 v221, v149
  v_mfma_f32_16x16x32_bf16 v[132:135], a[140:143], v[72:75], v[132:135]
  s_add_u32 s14, s13, 24576
  ds_read_b128 a[172:175], v3 offset:19456
  buffer_load_dwordx4 a[224:227], v2, s[40:43], s14 offen offset:0 sc1
  v_add_f32 v226, v226, v218
  v_add_f32 v226, v226, v219
  v_mfma_f32_16x16x32_bf16 v[140:143], a[140:143], v[76:79], v[140:143]
  s_waitcnt lgkmcnt(4)
  v_exp_f32 v222, v150
  v_mfma_f32_16x16x32_bf16 v[128:131], a[144:147], v[80:83], v[128:131]
  ds_read_b128 a[176:179], v3 offset:20480
  v_cvt_pk_bf16_f32 v185, v218, v219
  v_mfma_f32_16x16x32_bf16 v[136:139], a[144:147], v[84:87], v[136:139]
  v_exp_f32 v223, v151
  v_mfma_f32_16x16x32_bf16 v[132:135], a[148:151], v[80:83], v[132:135]
  ds_read_b128 a[180:183], v3 offset:21504
  buffer_load_dwordx4 v2, s[44:47], s26 offen offset:1024 sc1 lds
  v_add_f32 v226, v226, v220
  v_mfma_f32_16x16x32_bf16 v[140:143], a[148:151], v[84:87], v[140:143]
  v_exp_f32 v216, v152
  v_mfma_f32_16x16x32_bf16 v[128:131], a[152:155], v[88:91], v[128:131]
  ds_read_b128 a[184:187], v3 offset:22528
  v_add_f32 v226, v226, v221
  v_cvt_pk_bf16_f32 v186, v220, v221
  v_mfma_f32_16x16x32_bf16 v[136:139], a[152:155], v[92:95], v[136:139]
  v_exp_f32 v217, v153
  v_mfma_f32_16x16x32_bf16 v[132:135], a[156:159], v[88:91], v[132:135]
  ds_read_b128 a[188:191], v3 offset:23552
  buffer_load_dwordx4 a[228:231], v2, s[40:43], s14 offen offset:1024 sc1
  v_add_f32 v226, v226, v222
  v_mfma_f32_16x16x32_bf16 v[140:143], a[156:159], v[92:95], v[140:143]
  s_waitcnt lgkmcnt(4)
  v_exp_f32 v218, v154
  v_mfma_f32_16x16x32_bf16 a[64:67], a[160:163], v[176:179], a[64:67]
  ds_read_b128 a[128:131], v3 offset:0
  v_add_f32 v226, v226, v223
  v_cvt_pk_bf16_f32 v187, v222, v223
  v_mfma_f32_16x16x32_bf16 a[68:71], a[160:163], v[180:183], a[68:71]
  v_exp_f32 v219, v155
  v_mfma_f32_16x16x32_bf16 a[72:75], a[164:167], v[176:179], a[72:75]
  ds_read_b128 a[132:135], v3 offset:1024
  buffer_load_dwordx4 v2, s[44:47], s26 offen offset:2048 sc1 lds
  v_add_f32 v227, v216, v217
  v_mfma_f32_16x16x32_bf16 a[76:79], a[164:167], v[180:183], a[76:79]
  v_exp_f32 v220, v156
  v_mfma_f32_16x16x32_bf16 a[80:83], a[168:171], v[176:179], a[80:83]
  ds_read_b128 a[136:139], v3 offset:2048
  buffer_load_dwordx4 a[232:235], v2, s[40:43], s14 offen offset:2048 sc1
  v_cvt_pk_bf16_f32 v188, v216, v217
  v_mfma_f32_16x16x32_bf16 a[84:87], a[168:171], v[180:183], a[84:87]
  v_exp_f32 v221, v157
  v_mfma_f32_16x16x32_bf16 a[88:91], a[172:175], v[176:179], a[88:91]
  ds_read_b128 a[140:143], v3 offset:3072
  v_add_f32 v227, v227, v218
  v_add_f32 v227, v227, v219
  v_mfma_f32_16x16x32_bf16 a[92:95], a[172:175], v[180:183], a[92:95]
  s_waitcnt lgkmcnt(4)
  v_exp_f32 v222, v158
  v_mfma_f32_16x16x32_bf16 a[96:99], a[176:179], v[176:179], a[96:99]
  ds_read_b128 a[144:147], v3 offset:4096
  buffer_load_dwordx4 v2, s[44:47], s26 offen offset:3072 sc1 lds
  v_cvt_pk_bf16_f32 v189, v218, v219
  v_mfma_f32_16x16x32_bf16 a[100:103], a[176:179], v[180:183], a[100:103]
  s_add_u32 s26, s26, 16384
  v_exp_f32 v223, v159
  v_mfma_f32_16x16x32_bf16 a[104:107], a[180:183], v[176:179], a[104:107]
  s_add_u32 s24, s24, 32768
  ds_read_b128 a[148:151], v3 offset:5120
  buffer_load_dwordx4 a[236:239], v2, s[40:43], s14 offen offset:3072 sc1
  v_add_f32 v227, v227, v220
  v_mfma_f32_16x16x32_bf16 a[108:111], a[180:183], v[180:183], a[108:111]
  s_and_b32 s24, s24, 0x1ffff
  v_add_f32 v227, v227, v221
  v_cvt_pk_bf16_f32 v190, v220, v221
  v_add_f32 v227, v227, v222
  v_mfma_f32_16x16x32_bf16 a[112:115], a[184:187], v[176:179], a[112:115]
  ds_read_b128 a[152:155], v3 offset:6144
  v_add_f32 v227, v227, v223
  v_max_f32 v5, v226, v227
  v_cmp_lt_f32 vcc, s81, v5
  v_mfma_f32_16x16x32_bf16 a[116:119], a[184:187], v[180:183], a[116:119]
  v_exp_f32 v216, v128
  v_mfma_f32_16x16x32_bf16 a[120:123], a[188:191], v[176:179], a[120:123]
  s_waitcnt lgkmcnt(3)
  ds_read_b128 a[156:159], v3 offset:7168
  v_cvt_pk_bf16_f32 v191, v222, v223
  v_mfma_f32_16x16x32_bf16 a[124:127], a[188:191], v[180:183], a[124:127]
  s_cbranch_vccnz fa_stub22
fa_back22:
  v_exp_f32 v217, v129
  v_add_f32 v230, v230, v226
  v_add_f32 v231, v231, v227
  v_mfma_f32_16x16x32_bf16 v[144:147], a[128:131], v[64:67], v[200:203]
  ds_read_b128 a[160:163], v3 offset:24576
  v_add_f32 v226, v216, v217
  v_mfma_f32_16x16x32_bf16 v[152:155], a[128:131], v[68:71], v[204:207]
  v_exp_f32 v218, v130
  v_mfma_f32_16x16x32_bf16 v[148:151], a[132:135], v[64:67], v[200:203]
  s_cmp_ge_u32 s27, s50
  s_cselect_b64 s[48:49], s[6:7], s[48:49]
  s_cselect_b32 s50, s30, s50
  ds_read_b128 a[164:167], v3 offset:25600
  v_cvt_pk_bf16_f32 v176, v216, v217
  v_mfma_f32_16x16x32_bf16 v[156:159], a[132:135], v[68:71], v[204:207]
  s_mov_b32 m0, s25
  v_exp_f32 v219, v131
  v_mfma_f32_16x16x32_bf16 v[144:147], a[136:139], v[72:75], v[144:147]
  s_add_u32 s66, s66, 32768
  ds_read_b128 a[168:171], v3 offset:26624
  buffer_load_dwordx4 v2, s[48:51], s27 offen offset:0 sc1 lds
  v_add_f32 v226, v226, v218
  v_add_f32 v226, v226, v219
  v_mfma_f32_16x16x32_bf16 v[152:155], a[136:139], v[76:79], v[152:155]
  s_and_b32 s66, s66, 0x1ffff
  v_exp_f32 v220, v132
  v_mfma_f32_16x16x32_bf16 v[148:151], a[140:143], v[72:75], v[148:151]
  s_add_u32 s14, s13, 28672
  ds_read_b128 a[172:175], v3 offset:27648
  buffer_load_dwordx4 a[240:243], v2, s[40:43], s14 offen offset:0 sc1
  v_cvt_pk_bf16_f32 v177, v218, v219
  v_mfma_f32_16x16x32_bf16 v[156:159], a[140:143], v[76:79], v[156:159]
  s_waitcnt lgkmcnt(4)
  v_exp_f32 v221, v133
  v_mfma_f32_16x16x32_bf16 v[144:147], a[144:147], v[80:83], v[144:147]
  ds_read_b128 a[176:179], v3 offset:28672
  v_add_f32 v226, v226, v220
  v_mfma_f32_16x16x32_bf16 v[152:155], a[144:147], v[84:87], v[152:155]
  v_exp_f32 v222, v134
  v_mfma_f32_16x16x32_bf16 v[148:151], a[148:151], v[80:83], v[148:151]
  ds_read_b128 a[180:183], v3 offset:29696
  buffer_load_dwordx4 v2, s[48:51], s27 offen offset:1024 sc1 lds
  v_add_f32 v226, v226, v221
  v_cvt_pk_bf16_f32 v178, v220, v221
  v_mfma_f32_16x16x32_bf16 v[156:159], a[148:151], v[84:87], v[156:159]
  v_exp_f32 v223, v135
  v_mfma_f32_16x16x32_bf16 v[144:147], a[152:155], v[88:91], v[144:147]
  ds_read_b128 a[184:187], v3 offset:30720
  v_add_f32 v226, v226, v222
  v_mfma_f32_16x16x32_bf16 v[152:155], a[152:155], v[92:95], v[152:155]
  v_exp_f32 v216, v136
  v_mfma_f32_16x16x32_bf16 v[148:151], a[156:159], v[88:91], v[148:151]
  ds_read_b128 a[188:191], v3 offset:31744
  buffer_load_dwordx4 a[244:247], v2, s[40:43], s14 offen offset:1024 sc1
  v_add_f32 v226, v226, v223
  v_exp_f32 v217, v137
  v_mfma_f32_16x16x32_bf16 v[156:159], a[156:159], v[92:95], v[156:159]
  s_waitcnt lgkmcnt(4)
  v_exp_f32 v218, v138
  v_mfma_f32_16x16x32_bf16 a[64:67], a[160:163], v[184:187], a[64:67]
  ds_read_b128 a[128:131], v3 offset:8192
  v_cvt_pk_bf16_f32 v179, v222, v223
  v_mfma_f32_16x16x32_bf16 a[68:71], a[160:163], v[188:191], a[68:71]
  v_exp_f32 v219, v139
  v_mfma_f32_16x16x32_bf16 a[72:75], a[164:167], v[184:187], a[72:75]
  ds_read_b128 a[132:135], v3 offset:9216
  buffer_load_dwordx4 v2, s[48:51], s27 offen offset:2048 sc1 lds
  v_add_f32 v227, v216, v217
  v_mfma_f32_16x16x32_bf16 a[76:79], a[164:167], v[188:191], a[76:79]
  v_exp_f32 v220, v140
  v_mfma_f32_16x16x32_bf16 a[80:83], a[168:171], v[184:187], a[80:83]
  ds_read_b128 a[136:139], v3 offset:10240
  buffer_load_dwordx4 a[248:251], v2, s[40:43], s14 offen offset:2048 sc1
  v_cvt_pk_bf16_f32 v180, v216, v217
  v_mfma_f32_16x16x32_bf16 a[84:87], a[168:171], v[188:191], a[84:87]
  v_exp_f32 v221, v141
  v_mfma_f32_16x16x32_bf16 a[88:91], a[172:175], v[184:187], a[88:91]
  ds_read_b128 a[140:143], v3 offset:11264
  v_add_f32 v227, v227, v218
  v_mfma_f32_16x16x32_bf16 a[92:95], a[172:175], v[188:191], a[92:95]
  s_waitcnt lgkmcnt(4)
  v_exp_f32 v222, v142
  v_mfma_f32_16x16x32_bf16 a[96:99], a[176:179], v[184:187], a[96:99]
  ds_read_b128 a[144:147], v3 offset:12288
  buffer_load_dwordx4 v2, s[48:51], s27 offen offset:3072 sc1 lds
  v_add_f32 v227, v227, v219
  v_cvt_pk_bf16_f32 v181, v218, v219
  v_mfma_f32_16x16x32_bf16 a[100:103], a[176:179], v[188:191], a[100:103]
  s_add_u32 s27, s27, 16384
  v_exp_f32 v223, v143
  v_mfma_f32_16x16x32_bf16 a[104:107], a[180:183], v[184:187], a[104:107]
  s_add_u32 s25, s25, 32768
  ds_read_b128 a[148:151], v3 offset:13312
  buffer_load_dwordx4 a[252:255], v2, s[40:43], s14 offen offset:3072 sc1
  v_add_f32 v227, v227, v220
  v_mfma_f32_16x16x32_bf16 a[108:111], a[180:183], v[188:191], a[108:111]
  s_and_b32 s25, s25, 0x1ffff
  v_add_f32 v227, v227, v221
  v_cvt_pk_bf16_f32 v182, v220, v221
  v_add_f32 v227, v227, v222
  v_mfma_f32_16x16x32_bf16 a[112:115], a[184:187], v[184:187], a[112:115]
  ds_read_b128 a[152:155], v3 offset:14336
  v_add_f32 v227, v227, v223
  v_max_f32 v5, v226, v227
  v_cmp_lt_f32 vcc, s81, v5
  v_mfma_f32_16x16x32_bf16 a[116:119], a[184:187], v[188:191], a[116:119]
  v_exp_f32 v216, v144
  v_mfma_f32_16x16x32_bf16 a[120:123], a[188:191], v[184:187], a[120:123]
  s_waitcnt lgkmcnt(3)
  ds_read_b128 a[156:159], v3 offset:15360
  v_cvt_pk_bf16_f32 v183, v222, v223
  v_add_u32 v3, s66, v2
  v_mfma_f32_16x16x32_bf16 a[124:127], a[188:191], v[188:191], a[124:127]
  s_cbranch_vccnz fa_stub23
fa_back23:
  v_exp_f32 v217, v145
  v_add_f32 v230, v230, v226
  v_add_f32 v231, v231, v227
fa_SSW2:
  v_mfma_f32_16x16x32_bf16 v[128:131], a[128:131], v[64:67], v[200:203]
  s_waitcnt vmcnt(12)
  v_exp_f32 v218, v146
  v_mfma_f32_16x16x32_bf16 v[136:139], a[128:131], v[68:71], v[204:207]
  s_barrier
  v_exp_f32 v219, v147
  v_mfma_f32_16x16x32_bf16 v[132:135], a[132:135], v[64:67], v[200:203]
  s_cmp_ge_u32 s26, s46
  s_cselect_b64 s[44:45], s[4:5], s[44:45]
  s_cselect_b32 s46, s30, s46
  ds_read_b128 a[160:163], v3 offset:16384
  ds_read_b128 a[164:167], v3 offset:17408
  v_add_f32 v226, v216, v217
  v_mfma_f32_16x16x32_bf16 v[140:143], a[132:135], v[68:71], v[204:207]
  s_mov_b32 m0, s24
  v_exp_f32 v220, v148
  v_mfma_f32_16x16x32_bf16 v[128:131], a[136:139], v[72:75], v[128:131]
  ds_read_b128 a[168:171], v3 offset:18432
  buffer_load_dwordx4 v2, s[44:47], s26 offen offset:0 sc1 lds
  v_cvt_pk_bf16_f32 v184, v216, v217
  v_mfma_f32_16x16x32_bf16 v[136:139], a[136:139], v[76:79], v[136:139]
  v_exp_f32 v221, v149
  v_mfma_f32_16x16x32_bf16 v[132:135], a[140:143], v[72:75], v[132:135]
  s_add_u32 s14, s13, 32768
  ds_read_b128 a[172:175], v3 offset:19456
  buffer_load_dwordx4 v[32:35], v2, s[40:43], s14 offen offset:0 sc1
  v_add_f32 v226, v226, v218
  v_add_f32 v226, v226, v219
  v_mfma_f32_16x16x32_bf16 v[140:143], a[140:143], v[76:79], v[140:143]
  s_waitcnt lgkmcnt(4)
  v_exp_f32 v222, v150
  v_mfma_f32_16x16x32_bf16 v[128:131], a[144:147], v[80:83], v[128:131]
  ds_read_b128 a[176:179], v3 offset:20480
  v_cvt_pk_bf16_f32 v185, v218, v219
  v_mfma_f32_16x16x32_bf16 v[136:139], a[144:147], v[84:87], v[136:139]
  v_exp_f32 v223, v151
  v_mfma_f32_16x16x32_bf16 v[132:135], a[148:151], v[80:83], v[132:135]
  ds_read_b128 a[180:183], v3 offset:21504
  buffer_load_dwordx4 v2, s[44:47], s26 offen offset:1024 sc1 lds
  v_add_f32 v226, v226, v220
  v_mfma_f32_16x16x32_bf16 v[140:143], a[148:151], v[84:87], v[140:143]
  v_exp_f32 v216, v152
  v_mfma_f32_16x16x32_bf16 v[128:131], a[152:155], v[88:91], v[128:131]
  ds_read_b128 a[184:187], v3 offset:22528
  v_add_f32 v226, v226, v221
  v_cvt_pk_bf16_f32 v186, v220, v221
  v_mfma_f32_16x16x32_bf16 v[136:139], a[152:155], v[92:95], v[136:139]
  v_exp_f32 v217, v153
  v_mfma_f32_16x16x32_bf16 v[132:135], a[156:159], v[88:91], v[132:135]
  ds_read_b128 a[188:191], v3 offset:23552
  buffer_load_dwordx4 v[36:39], v2, s[40:43], s14 offen offset:1024 sc1
  v_add_f32 v226, v226, v222
  v_mfma_f32_16x16x32_bf16 v[140:143], a[156:159], v[92:95], v[140:143]
  s_waitcnt lgkmcnt(4)
  v_exp_f32 v218, v154
  v_mfma_f32_16x16x32_bf16 a[64:67], a[160:163], v[176:179], a[64:67]
  ds_read_b128 a[128:131], v3 offset:0
  v_add_f32 v226, v226, v223
  v_cvt_pk_bf16_f32 v187, v222, v223
  v_mfma_f32_16x16x32_bf16 a[68:71], a[160:163], v[180:183], a[68:71]
  v_exp_f32 v219, v155
  v_mfma_f32_16x16x32_bf16 a[72:75], a[164:167], v[176:179], a[72:75]
  ds_read_b128 a[132:135], v3 offset:1024
  buffer_load_dwordx4 v2, s[44:47], s26 offen offset:2048 sc1 lds
  v_add_f32 v227, v216, v217
  v_mfma_f32_16x16x32_bf16 a[76:79], a[164:167], v[180:183], a[76:79]
  v_exp_f32 v220, v156
  v_mfma_f32_16x16x32_bf16 a[80:83], a[168:171], v[176:179], a[80:83]
  ds_read_b128 a[136:139], v3 offset:2048
  buffer_load_dwordx4 v[40:43], v2, s[40:43], s14 offen offset:2048 sc1
  v_cvt_pk_bf16_f32 v188, v216, v217
  v_mfma_f32_16x16x32_bf16 a[84:87], a[168:171], v[180:183], a[84:87]
  v_exp_f32 v221, v157
  v_mfma_f32_16x16x32_bf16 a[88:91], a[172:175], v[176:179], a[88:91]
  ds_read_b128 a[140:143], v3 offset:3072
  v_add_f32 v227, v227, v218
  v_add_f32 v227, v227, v219
  v_mfma_f32_16x16x32_bf16 a[92:95], a[172:175], v[180:183], a[92:95]
  s_waitcnt lgkmcnt(4)
  v_exp_f32 v222, v158
  v_mfma_f32_16x16x32_bf16 a[96:99], a[176:179], v[176:179], a[96:99]
  ds_read_b128 a[144:147], v3 offset:4096
  buffer_load_dwordx4 v2, s[44:47], s26 offen offset:3072 sc1 lds
  v_cvt_pk_bf16_f32 v189, v218, v219
  v_mfma_f32_16x16x32_bf16 a[100:103], a[176:179], v[180:183], a[100:103]
  s_add_u32 s26, s26, 16384
  v_exp_f32 v223, v159
  v_mfma_f32_16x16x32_bf16 a[104:107], a[180:183], v[176:179], a[104:107]
  s_add_u32 s24, s24, 32768
  ds_read_b128 a[148:151], v3 offset:5120
  buffer_load_dwordx4 v[44:47], v2, s[40:43], s14 offen offset:3072 sc1
  v_add_f32 v227, v227, v220
  v_mfma_f32_16x16x32_bf16 a[108:111], a[180:183], v[180:183], a[108:111]
  s_and_b32 s24, s24, 0x1ffff
  v_add_f32 v227, v227, v221
  v_cvt_pk_bf16_f32 v190, v220, v221
  v_add_f32 v227, v227, v222
  v_mfma_f32_16x16x32_bf16 a[112:115], a[184:187], v[176:179], a[112:115]
  ds_read_b128 a[152:155], v3 offset:6144
  v_add_f32 v227, v227, v223
  v_max_f32 v5, v226, v227
  v_cmp_lt_f32 vcc, s81, v5
  v_mfma_f32_16x16x32_bf16 a[116:119], a[184:187], v[180:183], a[116:119]
  v_exp_f32 v216, v128
  v_mfma_f32_16x16x32_bf16 a[120:123], a[188:191], v[176:179], a[120:123]
  s_waitcnt lgkmcnt(3)
  ds_read_b128 a[156:159], v3 offset:7168
  v_cvt_pk_bf16_f32 v191, v222, v223
  v_mfma_f32_16x16x32_bf16 a[124:127], a[188:191], v[180:183], a[124:127]
  s_cbranch_vccnz fa_stub24
fa_back24:
  v_exp_f32 v217, v129
  v_add_f32 v230, v230, v226
  v_add_f32 v231, v231, v227
  v_mfma_f32_16x16x32_bf16 v[144:147], a[128:131], v[64:67], v[200:203]
  ds_read_b128 a[160:163], v3 offset:24576
  v_add_f32 v226, v216, v217
  v_mfma_f32_16x16x32_bf16 v[152:155], a[128:131], v[68:71], v[204:207]
  v_exp_f32 v218, v130
  v_mfma_f32_16x16x32_bf16 v[148:151], a[132:135], v[64:67], v[200:203]
  s_cmp_ge_u32 s27, s50
  s_cselect_b64 s[48:49], s[6:7], s[48:49]
  s_cselect_b32 s50, s30, s50
  ds_read_b128 a[164:167], v3 offset:25600
  v_cvt_pk_bf16_f32 v176, v216, v217
  v_mfma_f32_16x16x32_bf16 v[156:159], a[132:135], v[68:71], v[204:207]
  s_mov_b32 m0, s25
  v_exp_f32 v219, v131
  v_mfma_f32_16x16x32_bf16 v[144:147], a[136:139], v[72:75], v[144:147]
  s_add_u32 s66, s66, 32768
  ds_read_b128 a[168:171], v3 offset:26624
  buffer_load_dwordx4 v2, s[48:51], s27 offen offset:0 sc1 lds
  v_add_f32 v226, v226, v218
  v_add_f32 v226, v226, v219
  v_mfma_f32_16x16x32_bf16 v[152:155], a[136:139], v[76:79], v[152:155]
  s_and_b32 s66, s66, 0x1ffff
  v_exp_f32 v220, v132
  v_mfma_f32_16x16x32_bf16 v[148:151], a[140:143], v[72:75], v[148:151]
  s_add_u32 s14, s13, 36864
  ds_read_b128 a[172:175], v3 offset:27648
  buffer_load_dwordx4 v[48:51], v2, s[40:43], s14 offen offset:0 sc1
  v_cvt_pk_bf16_f32 v177, v218, v219
  v_mfma_f32_16x16x32_bf16 v[156:159], a[140:143], v[76:79], v[156:159]
  s_waitcnt lgkmcnt(4)
  v_exp_f32 v221, v133
  v_mfma_f32_16x16x32_bf16 v[144:147], a[144:147], v[80:83], v[144:147]
  ds_read_b128 a[176:179], v3 offset:28672
  v_add_f32 v226, v226, v220
  v_mfma_f32_16x16x32_bf16 v[152:155], a[144:147], v[84:87], v[152:155]
  v_exp_f32 v222, v134
  v_mfma_f32_16x16x32_bf16 v[148:151], a[148:151], v[80:83], v[148:151]
  ds_read_b128 a[180:183], v3 offset:29696
  buffer_load_dwordx4 v2, s[48:51], s27 offen offset:1024 sc1 lds
  v_add_f32 v226, v226, v221
  v_cvt_pk_bf16_f32 v178, v220, v221
  v_mfma_f32_16x16x32_bf16 v[156:159], a[148:151], v[84:87], v[156:159]
  v_exp_f32 v223, v135
  v_mfma_f32_16x16x32_bf16 v[144:147], a[152:155], v[88:91], v[144:147]
  ds_read_b128 a[184:187], v3 offset:30720
  v_add_f32 v226, v226, v222
  v_mfma_f32_16x16x32_bf16 v[152:155], a[152:155], v[92:95], v[152:155]
  v_exp_f32 v216, v136
  v_mfma_f32_16x16x32_bf16 v[148:151], a[156:159], v[88:91], v[148:151]
  ds_read_b128 a[188:191], v3 offset:31744
  buffer_load_dwordx4 v[52:55], v2, s[40:43], s14 offen offset:1024 sc1
  v_add_f32 v226, v226, v223
  v_exp_f32 v217, v137
  v_mfma_f32_16x16x32_bf16 v[156:159], a[156:159], v[92:95], v[156:159]
  s_waitcnt lgkmcnt(4)
  v_exp_f32 v218, v138
  v_mfma_f32_16x16x32_bf16 a[64:67], a[160:163], v[184:187], a[64:67]
  ds_read_b128 a[128:131], v3 offset:8192
  v_cvt_pk_bf16_f32 v179, v222, v223
  v_mfma_f32_16x16x32_bf16 a[68:71], a[160:163], v[188:191], a[68:71]
  v_exp_f32 v219, v139
  v_mfma_f32_16x16x32_bf16 a[72:75], a[164:167], v[184:187], a[72:75]
  ds_read_b128 a[132:135], v3 offset:9216
  buffer_load_dwordx4 v2, s[48:51], s27 offen offset:2048 sc1 lds
  v_add_f32 v227, v216, v217
  v_mfma_f32_16x16x32_bf16 a[76:79], a[164:167], v[188:191], a[76:79]
  v_exp_f32 v220, v140
  v_mfma_f32_16x16x32_bf16 a[80:83], a[168:171], v[184:187], a[80:83]
  ds_read_b128 a[136:139], v3 offset:10240
  buffer_load_dwordx4 v[56:59], v2, s[40:43], s14 offen offset:2048 sc1
  v_cvt_pk_bf16_f32 v180, v216, v217
  v_mfma_f32_16x16x32_bf16 a[84:87], a[168:171], v[188:191], a[84:87]
  v_exp_f32 v221, v141
  v_mfma_f32_16x16x32_bf16 a[88:91], a[172:175], v[184:187], a[88:91]
  ds_read_b128 a[140:143], v3 offset:11264
  v_add_f32 v227, v227, v218
  v_mfma_f32_16x16x32_bf16 a[92:95], a[172:175], v[188:191], a[92:95]
  s_waitcnt lgkmcnt(4)
  v_exp_f32 v222, v142
  v_mfma_f32_16x16x32_bf16 a[96:99], a[176:179], v[184:187], a[96:99]
  ds_read_b128 a[144:147], v3 offset:12288
  buffer_load_dwordx4 v2, s[48:51], s27 offen offset:3072 sc1 lds
  v_add_f32 v227, v227, v219
  v_cvt_pk_bf16_f32 v181, v218, v219
  v_mfma_f32_16x16x32_bf16 a[100:103], a[176:179], v[188:191], a[100:103]
  s_add_u32 s27, s27, 16384
  v_exp_f32 v223, v143
  v_mfma_f32_16x16x32_bf16 a[104:107], a[180:183], v[184:187], a[104:107]
  s_add_u32 s25, s25, 32768
  ds_read_b128 a[148:151], v3 offset:13312
  buffer_load_dwordx4 v[60:63], v2, s[40:43], s14 offen offset:3072 sc1
  v_add_f32 v227, v227, v220
  v_mfma_f32_16x16x32_bf16 a[108:111], a[180:183], v[188:191], a[108:111]
  s_and_b32 s25, s25, 0x1ffff
  v_add_f32 v227, v227, v221
  v_cvt_pk_bf16_f32 v182, v220, v221
  v_add_f32 v227, v227, v222
  v_mfma_f32_16x16x32_bf16 a[112:115], a[184:187], v[184:187], a[112:115]
  ds_read_b128 a[152:155], v3 offset:14336
  v_add_f32 v227, v227, v223
  v_max_f32 v5, v226, v227
  v_cmp_lt_f32 vcc, s81, v5
  v_mfma_f32_16x16x32_bf16 a[116:119], a[184:187], v[188:191], a[116:119]
  v_exp_f32 v216, v144
  v_mfma_f32_16x16x32_bf16 a[120:123], a[188:191], v[184:187], a[120:123]
  s_waitcnt lgkmcnt(3)
  ds_read_b128 a[156:159], v3 offset:15360
  v_cvt_pk_bf16_f32 v183, v222, v223
  v_add_u32 v3, s66, v2
  v_mfma_f32_16x16x32_bf16 a[124:127], a[188:191], v[188:191], a[124:127]
  s_cbranch_vccnz fa_stub25
fa_back25:
  v_exp_f32 v217, v145
  v_add_f32 v230, v230, v226
  v_add_f32 v231, v231, v227
fa_SSW1:
  v_mfma_f32_16x16x32_bf16 v[128:131], a[128:131], v[64:67], v[200:203]
  s_waitcnt vmcnt(8)
  v_exp_f32 v218, v146
  v_mfma_f32_16x16x32_bf16 v[136:139], a[128:131], v[68:71], v[204:207]
  s_barrier
  v_exp_f32 v219, v147
  v_mfma_f32_16x16x32_bf16 v[132:135], a[132:135], v[64:67], v[200:203]
  s_cmp_ge_u32 s26, s46
  s_cselect_b64 s[44:45], s[4:5], s[44:45]
  s_cselect_b32 s46, s30, s46
  ds_read_b128 a[160:163], v3 offset:16384
  ds_read_b128 a[164:167], v3 offset:17408
  v_add_f32 v226, v216, v217
  v_mfma_f32_16x16x32_bf16 v[140:143], a[132:135], v[68:71], v[204:207]
  s_mov_b32 m0, s24
  v_exp_f32 v220, v148
  v_mfma_f32_16x16x32_bf16 v[128:131], a[136:139], v[72:75], v[128:131]
  ds_read_b128 a[168:171], v3 offset:18432
  buffer_load_dwordx4 v2, s[44:47], s26 offen offset:0 sc1 lds
  v_cvt_pk_bf16_f32 v184, v216, v217
  v_mfma_f32_16x16x32_bf16 v[136:139], a[136:139], v[76:79], v[136:139]
  v_exp_f32 v221, v149
  v_mfma_f32_16x16x32_bf16 v[132:135], a[140:143], v[72:75], v[132:135]
  s_add_u32 s14, s13, 40960
  ds_read_b128 a[172:175], v3 offset:19456
  buffer_load_dwordx4 v[96:99], v2, s[40:43], s14 offen offset:0 sc1
  v_add_f32 v226, v226, v218
  v_add_f32 v226, v226, v219
  v_mfma_f32_16x16x32_bf16 v[140:143], a[140:143], v[76:79], v[140:143]
  s_waitcnt lgkmcnt(4)
  v_exp_f32 v222, v150
  v_mfma_f32_16x16x32_bf16 v[128:131], a[144:147], v[80:83], v[128:131]
  ds_read_b128 a[176:179], v3 offset:20480
  v_cvt_pk_bf16_f32 v185, v218, v219
  v_mfma_f32_16x16x32_bf16 v[136:139], a[144:147], v[84:87], v[136:139]
  v_exp_f32 v223, v151
  v_mfma_f32_16x16x32_bf16 v[132:135], a[148:151], v[80:83], v[132:135]
  ds_read_b128 a[180:183], v3 offset:21504
  buffer_load_dwordx4 v2, s[44:47], s26 offen offset:1024 sc1 lds
  v_add_f32 v226, v226, v220
  v_mfma_f32_16x16x32_bf16 v[140:143], a[148:151], v[84:87], v[140:143]
  v_exp_f32 v216, v152
  v_mfma_f32_16x16x32_bf16 v[128:131], a[152:155], v[88:91], v[128:131]
  ds_read_b128 a[184:187], v3 offset:22528
  v_add_f32 v226, v226, v221
  v_cvt_pk_bf16_f32 v186, v220, v221
  v_mfma_f32_16x16x32_bf16 v[136:139], a[152:155], v[92:95], v[136:139]
  v_exp_f32 v217, v153
  v_mfma_f32_16x16x32_bf16 v[132:135], a[156:159], v[88:91], v[132:135]
  ds_read_b128 a[188:191], v3 offset:23552
  buffer_load_dwordx4 v[100:103], v2, s[40:43], s14 offen offset:1024 sc1
  v_add_f32 v226, v226, v222
  v_mfma_f32_16x16x32_bf16 v[140:143], a[156:159], v[92:95], v[140:143]
  s_waitcnt lgkmcnt(4)
  v_exp_f32 v218, v154
  v_mfma_f32_16x16x32_bf16 a[64:67], a[160:163], v[176:179], a[64:67]
  ds_read_b128 a[128:131], v3 offset:0
  v_add_f32 v226, v226, v223
  v_cvt_pk_bf16_f32 v187, v222, v223
  v_mfma_f32_16x16x32_bf16 a[68:71], a[160:163], v[180:183], a[68:71]
  v_exp_f32 v219, v155
  v_mfma_f32_16x16x32_bf16 a[72:75], a[164:167], v[176:179], a[72:75]
  ds_read_b128 a[132:135], v3 offset:1024
  buffer_load_dwordx4 v2, s[44:47], s26 offen offset:2048 sc1 lds
  v_add_f32 v227, v216, v217
  v_mfma_f32_16x16x32_bf16 a[76:79], a[164:167], v[180:183], a[76:79]
  v_exp_f32 v220, v156
  v_mfma_f32_16x16x32_bf16 a[80:83], a[168:171], v[176:179], a[80:83]
  ds_read_b128 a[136:139], v3 offset:2048
  buffer_load_dwordx4 v[104:107], v2, s[40:43], s14 offen offset:2048 sc1
  v_cvt_pk_bf16_f32 v188, v216, v217
  v_mfma_f32_16x16x32_bf16 a[84:87], a[168:171], v[180:183], a[84:87]
  v_exp_f32 v221, v157
  v_mfma_f32_16x16x32_bf16 a[88:91], a[172:175], v[176:179], a[88:91]
  ds_read_b128 a[140:143], v3 offset:3072
  v_add_f32 v227, v227, v218
  v_add_f32 v227, v227, v219
  v_mfma_f32_16x16x32_bf16 a[92:95], a[172:175], v[180:183], a[92:95]
  s_waitcnt lgkmcnt(4)
  v_exp_f32 v222, v158
  v_mfma_f32_16x16x32_bf16 a[96:99], a[176:179], v[176:179], a[96:99]
  ds_read_b128 a[144:147], v3 offset:4096
  buffer_load_dwordx4 v2, s[44:47], s26 offen offset:3072 sc1 lds
  v_cvt_pk_bf16_f32 v189, v218, v219
  v_mfma_f32_16x16x32_bf16 a[100:103], a[176:179], v[180:183], a[100:103]
  s_add_u32 s26, s26, 16384
  v_exp_f32 v223, v159
  v_mfma_f32_16x16x32_bf16 a[104:107], a[180:183], v[176:179], a[104:107]
  s_add_u32 s24, s24, 32768
  ds_read_b128 a[148:151], v3 offset:5120
  buffer_load_dwordx4 v[108:111], v2, s[40:43], s14 offen offset:3072 sc1
  v_add_f32 v227, v227, v220
  v_mfma_f32_16x16x32_bf16 a[108:111], a[180:183], v[180:183], a[108:111]
  s_and_b32 s24, s24, 0x1ffff
  v_add_f32 v227, v227, v221
  v_cvt_pk_bf16_f32 v190, v220, v221
  v_add_f32 v227, v227, v222
  v_mfma_f32_16x16x32_bf16 a[112:115], a[184:187], v[176:179], a[112:115]
  ds_read_b128 a[152:155], v3 offset:6144
  v_add_f32 v227, v227, v223
  v_max_f32 v5, v226, v227
  v_cmp_lt_f32 vcc, s81, v5
  v_mfma_f32_16x16x32_bf16 a[116:119], a[184:187], v[180:183], a[116:119]
  v_exp_f32 v216, v128
  v_mfma_f32_16x16x32_bf16 a[120:123], a[188:191], v[176:179], a[120:123]
  s_waitcnt lgkmcnt(3)
  ds_read_b128 a[156:159], v3 offset:7168
  v_cvt_pk_bf16_f32 v191, v222, v223
  v_mfma_f32_16x16x32_bf16 a[124:127], a[188:191], v[180:183], a[124:127]
  s_cbranch_vccnz fa_stub26
fa_back26:
  v_exp_f32 v217, v129
  v_add_f32 v230, v230, v226
  v_add_f32 v231, v231, v227
  v_mfma_f32_16x16x32_bf16 v[144:147], a[128:131], v[64:67], v[200:203]
  ds_read_b128 a[160:163], v3 offset:24576
  v_add_f32 v226, v216, v217
  v_mfma_f32_16x16x32_bf16 v[152:155], a[128:131], v[68:71], v[204:207]
  v_exp_f32 v218, v130
  v_mfma_f32_16x16x32_bf16 v[148:151], a[132:135], v[64:67], v[200:203]
  s_cmp_ge_u32 s27, s50
  s_cselect_b64 s[48:49], s[6:7], s[48:49]
  s_cselect_b32 s50, s30, s50
  ds_read_b128 a[164:167], v3 offset:25600
  v_cvt_pk_bf16_f32 v176, v216, v217
  v_mfma_f32_16x16x32_bf16 v[156:159], a[132:135], v[68:71], v[204:207]
  s_mov_b32 m0, s25
  v_exp_f32 v219, v131
  v_mfma_f32_16x16x32_bf16 v[144:147], a[136:139], v[72:75], v[144:147]
  s_add_u32 s66, s66, 32768
  ds_read_b128 a[168:171], v3 offset:26624
  buffer_load_dwordx4 v2, s[48:51], s27 offen offset:0 sc1 lds
  v_add_f32 v226, v226, v218
  v_add_f32 v226, v226, v219
  v_mfma_f32_16x16x32_bf16 v[152:155], a[136:139], v[76:79], v[152:155]
  s_and_b32 s66, s66, 0x1ffff
  v_exp_f32 v220, v132
  v_mfma_f32_16x16x32_bf16 v[148:151], a[140:143], v[72:75], v[148:151]
  s_add_u32 s14, s13, 45056
  ds_read_b128 a[172:175], v3 offset:27648
  buffer_load_dwordx4 v[112:115], v2, s[40:43], s14 offen offset:0 sc1
  v_cvt_pk_bf16_f32 v177, v218, v219
  v_mfma_f32_16x16x32_bf16 v[156:159], a[140:143], v[76:79], v[156:159]
  s_waitcnt lgkmcnt(4)
  v_exp_f32 v221, v133
  v_mfma_f32_16x16x32_bf16 v[144:147], a[144:147], v[80:83], v[144:147]
  ds_read_b128 a[176:179], v3 offset:28672
  v_add_f32 v226, v226, v220
  v_mfma_f32_16x16x32_bf16 v[152:155], a[144:147], v[84:87], v[152:155]
  v_exp_f32 v222, v134
  v_mfma_f32_16x16x32_bf16 v[148:151], a[148:151], v[80:83], v[148:151]
  ds_read_b128 a[180:183], v3 offset:29696
  buffer_load_dwordx4 v2, s[48:51], s27 offen offset:1024 sc1 lds
  v_add_f32 v226, v226, v221
  v_cvt_pk_bf16_f32 v178, v220, v221
  v_mfma_f32_16x16x32_bf16 v[156:159], a[148:151], v[84:87], v[156:159]
  v_exp_f32 v223, v135
  v_mfma_f32_16x16x32_bf16 v[144:147], a[152:155], v[88:91], v[144:147]
  ds_read_b128 a[184:187], v3 offset:30720
  v_add_f32 v226, v226, v222
  v_mfma_f32_16x16x32_bf16 v[152:155], a[152:155], v[92:95], v[152:155]
  v_exp_f32 v216, v136
  v_mfma_f32_16x16x32_bf16 v[148:151], a[156:159], v[88:91], v[148:151]
  ds_read_b128 a[188:191], v3 offset:31744
  buffer_load_dwordx4 v[116:119], v2, s[40:43], s14 offen offset:1024 sc1
  v_add_f32 v226, v226, v223
  v_exp_f32 v217, v137
  v_mfma_f32_16x16x32_bf16 v[156:159], a[156:159], v[92:95], v[156:159]
  s_waitcnt lgkmcnt(4)
  v_exp_f32 v218, v138
  v_mfma_f32_16x16x32_bf16 a[64:67], a[160:163], v[184:187], a[64:67]
  ds_read_b128 a[128:131], v3 offset:8192
  v_cvt_pk_bf16_f32 v179, v222, v223
  v_mfma_f32_16x16x32_bf16 a[68:71], a[160:163], v[188:191], a[68:71]
  v_exp_f32 v219, v139
  v_mfma_f32_16x16x32_bf16 a[72:75], a[164:167], v[184:187], a[72:75]
  ds_read_b128 a[132:135], v3 offset:9216
  buffer_load_dwordx4 v2, s[48:51], s27 offen offset:2048 sc1 lds
  v_add_f32 v227, v216, v217
  v_mfma_f32_16x16x32_bf16 a[76:79], a[164:167], v[188:191], a[76:79]
  v_exp_f32 v220, v140
  v_mfma_f32_16x16x32_bf16 a[80:83], a[168:171], v[184:187], a[80:83]
  ds_read_b128 a[136:139], v3 offset:10240
  buffer_load_dwordx4 v[120:123], v2, s[40:43], s14 offen offset:2048 sc1
  v_cvt_pk_bf16_f32 v180, v216, v217
  v_mfma_f32_16x16x32_bf16 a[84:87], a[168:171], v[188:191], a[84:87]
  v_exp_f32 v221, v141
  v_mfma_f32_16x16x32_bf16 a[88:91], a[172:175], v[184:187], a[88:91]
  ds_read_b128 a[140:143], v3 offset:11264
  v_add_f32 v227, v227, v218
  v_mfma_f32_16x16x32_bf16 a[92:95], a[172:175], v[188:191], a[92:95]
  s_waitcnt lgkmcnt(4)
  v_exp_f32 v222, v142
  v_mfma_f32_16x16x32_bf16 a[96:99], a[176:179], v[184:187], a[96:99]
  ds_read_b128 a[144:147], v3 offset:12288
  buffer_load_dwordx4 v2, s[48:51], s27 offen offset:3072 sc1 lds
  v_add_f32 v227, v227, v219
  v_cvt_pk_bf16_f32 v181, v218, v219
  v_mfma_f32_16x16x32_bf16 a[100:103], a[176:179], v[188:191], a[100:103]
  s_add_u32 s27, s27, 16384
  v_exp_f32 v223, v143
  v_mfma_f32_16x16x32_bf16 a[104:107], a[180:183], v[184:187], a[104:107]
  s_add_u32 s25, s25, 32768
  ds_read_b128 a[148:151], v3 offset:13312
  buffer_load_dwordx4 v[124:127], v2, s[40:43], s14 offen offset:3072 sc1
  v_add_f32 v227, v227, v220
  v_mfma_f32_16x16x32_bf16 a[108:111], a[180:183], v[188:191], a[108:111]
  s_and_b32 s25, s25, 0x1ffff
  v_add_f32 v227, v227, v221
  v_cvt_pk_bf16_f32 v182, v220, v221
  v_add_f32 v227, v227, v222
  v_mfma_f32_16x16x32_bf16 a[112:115], a[184:187], v[184:187], a[112:115]
  ds_read_b128 a[152:155], v3 offset:14336
  v_add_f32 v227, v227, v223
  v_max_f32 v5, v226, v227
  v_cmp_lt_f32 vcc, s81, v5
  v_mfma_f32_16x16x32_bf16 a[116:119], a[184:187], v[188:191], a[116:119]
  v_exp_f32 v216, v144
  v_mfma_f32_16x16x32_bf16 a[120:123], a[188:191], v[184:187], a[120:123]
  s_waitcnt lgkmcnt(3)
  ds_read_b128 a[156:159], v3 offset:15360
  v_cvt_pk_bf16_f32 v183, v222, v223
  v_add_u32 v3, s66, v2
  v_mfma_f32_16x16x32_bf16 a[124:127], a[188:191], v[188:191], a[124:127]
  s_cbranch_vccnz fa_stub27
fa_back27:
  v_exp_f32 v217, v145
  v_add_f32 v230, v230, v226
  v_add_f32 v231, v231, v227
fa_Bexit:
  s_bitcmp1_b32 s20, 0
  s_cbranch_scc1 fa_Bodd
  v_mfma_f32_16x16x32_bf16 v[128:131], a[128:131], v[64:67], v[200:203]
  s_waitcnt vmcnt(8)
  v_exp_f32 v218, v146
  v_mfma_f32_16x16x32_bf16 v[136:139], a[128:131], v[68:71], v[204:207]
  s_barrier
  v_exp_f32 v219, v147
  v_mfma_f32_16x16x32_bf16 v[132:135], a[132:135], v[64:67], v[200:203]
  ds_read_b128 a[160:163], v3 offset:16384
  ds_read_b128 a[164:167], v3 offset:17408
  v_add_f32 v226, v216, v217
  v_mfma_f32_16x16x32_bf16 v[140:143], a[132:135], v[68:71], v[204:207]
  s_add_u32 s14, s13, 49152
  buffer_load_dwordx4 v[160:163], v2, s[40:43], s14 offen offset:0 sc1
  v_cvt_pk_bf16_f32 v184, v216, v217
  v_mfma_f32_16x16x32_bf16 v[128:131], a[136:139], v[72:75], v[128:131]
  ds_read_b128 a[168:171], v3 offset:18432
  v_add_f32 v226, v226, v218
  v_mfma_f32_16x16x32_bf16 v[136:139], a[136:139], v[76:79], v[136:139]
  v_exp_f32 v220, v148
  v_mfma_f32_16x16x32_bf16 v[132:135], a[140:143], v[72:75], v[132:135]
  ds_read_b128 a[172:175], v3 offset:19456
  v_add_f32 v226, v226, v219
  v_cvt_pk_bf16_f32 v185, v218, v219
  v_mfma_f32_16x16x32_bf16 v[140:143], a[140:143], v[76:79], v[140:143]
  s_waitcnt lgkmcnt(4)
  buffer_load_dwordx4 v[164:167], v2, s[40:43], s14 offen offset:1024 sc1
  v_add_f32 v226, v226, v220
  v_mfma_f32_16x16x32_bf16 v[128:131], a[144:147], v[80:83], v[128:131]
  ds_read_b128 a[176:179], v3 offset:20480
  v_mfma_f32_16x16x32_bf16 v[136:139], a[144:147], v[84:87], v[136:139]
  v_exp_f32 v221, v149
  v_mfma_f32_16x16x32_bf16 v[132:135], a[148:151], v[80:83], v[132:135]
  ds_read_b128 a[180:183], v3 offset:21504
  v_add_f32 v226, v226, v221
  v_mfma_f32_16x16x32_bf16 v[140:143], a[148:151], v[84:87], v[140:143]
  v_exp_f32 v222, v150
  v_mfma_f32_16x16x32_bf16 v[128:131], a[152:155], v[88:91], v[128:131]
  ds_read_b128 a[184:187], v3 offset:22528
  buffer_load_dwordx4 v[168:171], v2, s[40:43], s14 offen offset:2048 sc1
  v_cvt_pk_bf16_f32 v186, v220, v221
  v_mfma_f32_16x16x32_bf16 v[136:139], a[152:155], v[92:95], v[136:139]
  v_exp_f32 v223, v151
  v_mfma_f32_16x16x32_bf16 v[132:135], a[156:159], v[88:91], v[132:135]
  ds_read_b128 a[188:191], v3 offset:23552
  v_add_f32 v226, v226, v222
  v_add_f32 v226, v226, v223
  v_mfma_f32_16x16x32_bf16 v[140:143], a[156:159], v[92:95], v[140:143]
  s_waitcnt lgkmcnt(4)
  v_exp_f32 v216, v152
  v_mfma_f32_16x16x32_bf16 a[64:67], a[160:163], v[176:179], a[64:67]
  v_exp_f32 v217, v153
  v_mfma_f32_16x16x32_bf16 a[68:71], a[160:163], v[180:183], a[68:71]
  buffer_load_dwordx4 v[172:175], v2, s[40:43], s14 offen offset:3072 sc1
  v_cvt_pk_bf16_f32 v187, v222, v223
  v_add_f32 v227, v216, v217
  v_mfma_f32_16x16x32_bf16 a[72:75], a[164:167], v[176:179], a[72:75]
  v_exp_f32 v218, v154
  v_mfma_f32_16x16x32_bf16 a[76:79], a[164:167], v[180:183], a[76:79]
  v_exp_f32 v219, v155
  v_mfma_f32_16x16x32_bf16 a[80:83], a[168:171], v[176:179], a[80:83]
  v_exp_f32 v220, v156
  v_mfma_f32_16x16x32_bf16 a[84:87], a[168:171], v[180:183], a[84:87]
  s_add_u32 s14, s13, 53248
  buffer_load_dwordx4 v[192:195], v2, s[40:43], s14 offen offset:0 sc1
  v_cvt_pk_bf16_f32 v188, v216, v217
  v_add_f32 v227, v227, v218
  v_mfma_f32_16x16x32_bf16 a[88:91], a[172:175], v[176:179], a[88:91]
  v_exp_f32 v221, v157
  v_mfma_f32_16x16x32_bf16 a[92:95], a[172:175], v[180:183], a[92:95]
  s_waitcnt lgkmcnt(0)
  v_exp_f32 v222, v158
  v_mfma_f32_16x16x32_bf16 a[96:99], a[176:179], v[176:179], a[96:99]
  v_add_f32 v227, v227, v219
  v_cvt_pk_bf16_f32 v189, v218, v219
  v_mfma_f32_16x16x32_bf16 a[100:103], a[176:179], v[180:183], a[100:103]
  v_exp_f32 v223, v159
  v_mfma_f32_16x16x32_bf16 a[104:107], a[180:183], v[176:179], a[104:107]
  buffer_load_dwordx4 v[196:199], v2, s[40:43], s14 offen offset:1024 sc1
  v_add_f32 v227, v227, v220
  v_mfma_f32_16x16x32_bf16 a[108:111], a[180:183], v[180:183], a[108:111]
  v_add_f32 v227, v227, v221
  v_cvt_pk_bf16_f32 v190, v220, v221
  v_add_f32 v227, v227, v222
  v_mfma_f32_16x16x32_bf16 a[112:115], a[184:187], v[176:179], a[112:115]
  v_add_f32 v227, v227, v223
  v_max_f32 v5, v226, v227
  v_cmp_lt_f32 vcc, s81, v5
  v_mfma_f32_16x16x32_bf16 a[116:119], a[184:187], v[180:183], a[116:119]
  v_exp_f32 v216, v128
  v_mfma_f32_16x16x32_bf16 a[120:123], a[188:191], v[176:179], a[120:123]
  v_cvt_pk_bf16_f32 v191, v222, v223
  v_mfma_f32_16x16x32_bf16 a[124:127], a[188:191], v[180:183], a[124:127]
  s_cbranch_vccnz fa_stub28
fa_back28:
  v_exp_f32 v217, v129
  v_add_f32 v230, v230, v226
  v_add_f32 v231, v231, v227
  ds_read_b128 a[160:163], v3 offset:24576
  ds_read_b128 a[164:167], v3 offset:25600
  ds_read_b128 a[168:171], v3 offset:26624
  ds_read_b128 a[172:175], v3 offset:27648
  ds_read_b128 a[176:179], v3 offset:28672
  ds_read_b128 a[180:183], v3 offset:29696
  ds_read_b128 a[184:187], v3 offset:30720
  ds_read_b128 a[188:191], v3 offset:31744
  v_cndmask_b32 v128, v4, v128, s[68:69]
  v_cndmask_b32 v129, v4, v129, s[70:71]
  v_cndmask_b32 v130, v4, v130, s[72:73]
  v_cndmask_b32 v131, v4, v131, s[74:75]
  v_mov_b32 v132, v4
  v_mov_b32 v133, v4
  v_mov_b32 v134, v4
  v_mov_b32 v135, v4
  v_cndmask_b32 v140, v4, v140, s[68:69]
  v_cndmask_b32 v141, v4, v141, s[70:71]
  v_cndmask_b32 v142, v4, v142, s[72:73]
  v_cndmask_b32 v143, v4, v143, s[74:75]
  v_exp_f32 v216, v128
  v_exp_f32 v217, v129
  v_exp_f32 v218, v130
  v_add_f32 v226, v216, v217
  v_cvt_pk_bf16_f32 v176, v216, v217
  v_add_f32 v226, v226, v218
  v_exp_f32 v219, v131
  v_exp_f32 v220, v132
  v_add_f32 v226, v226, v219
  v_cvt_pk_bf16_f32 v177, v218, v219
  v_add_f32 v226, v226, v220
  v_exp_f32 v221, v133
  s_waitcnt lgkmcnt(4)
  v_mfma_f32_16x16x32_bf16 a[64:67], a[160:163], v[184:187], a[64:67]
  v_exp_f32 v222, v134
  v_add_f32 v226, v226, v221
  v_mfma_f32_16x16x32_bf16 a[68:71], a[160:163], v[188:191], a[68:71]
  s_add_u32 s14, s13, 53248
  buffer_load_dwordx4 v[208:211], v2, s[40:43], s14 offen offset:2048 sc1
  v_exp_f32 v223, v135
  v_mfma_f32_16x16x32_bf16 a[72:75], a[164:167], v[184:187], a[72:75]
  s_add_u32 s66, s66, 32768
  v_exp_f32 v216, v136
  v_mfma_f32_16x16x32_bf16 a[76:79], a[164:167], v[188:191], a[76:79]
  s_and_b32 s66, s66, 0x1ffff
  v_exp_f32 v217, v137
  v_mfma_f32_16x16x32_bf16 a[80:83], a[168:171], v[184:187], a[80:83]
  buffer_load_dwordx4 v[212:215], v2, s[40:43], s14 offen offset:3072 sc1
  v_cvt_pk_bf16_f32 v178, v220, v221
  v_add_f32 v226, v226, v222
  v_add_f32 v226, v226, v223
  v_cvt_pk_bf16_f32 v179, v222, v223
  v_mfma_f32_16x16x32_bf16 a[84:87], a[168:171], v[188:191], a[84:87]
  v_exp_f32 v218, v138
  v_mfma_f32_16x16x32_bf16 a[88:91], a[172:175], v[184:187], a[88:91]
  v_exp_f32 v219, v139
  v_mfma_f32_16x16x32_bf16 a[92:95], a[172:175], v[188:191], a[92:95]
  s_waitcnt lgkmcnt(0)
  v_exp_f32 v220, v140
  v_mfma_f32_16x16x32_bf16 a[96:99], a[176:179], v[184:187], a[96:99]
  s_add_u32 s14, s13, 57344
  buffer_load_dwordx4 v[232:235], v2, s[40:43], s14 offen offset:0 sc1
  v_add_f32 v227, v216, v217
  v_cvt_pk_bf16_f32 v180, v216, v217
  v_add_f32 v227, v227, v218
  v_add_f32 v227, v227, v219
  v_cvt_pk_bf16_f32 v181, v218, v219
  v_exp_f32 v221, v141
  v_mfma_f32_16x16x32_bf16 a[100:103], a[176:179], v[188:191], a[100:103]
  v_exp_f32 v222, v142
  v_mfma_f32_16x16x32_bf16 a[104:107], a[180:183], v[184:187], a[104:107]
  v_exp_f32 v223, v143
  v_mfma_f32_16x16x32_bf16 a[108:111], a[180:183], v[188:191], a[108:111]
  buffer_load_dwordx4 v[236:239], v2, s[40:43], s14 offen offset:1024 sc1
  v_add_f32 v227, v227, v220
  v_add_f32 v227, v227, v221
  v_cvt_pk_bf16_f32 v182, v220, v221
  v_add_f32 v227, v227, v222
  v_mfma_f32_16x16x32_bf16 a[112:115], a[184:187], v[184:187], a[112:115]
  v_add_f32 v227, v227, v223
  v_max_f32 v5, v226, v227
  v_cmp_lt_f32 vcc, s81, v5
  v_mfma_f32_16x16x32_bf16 a[116:119], a[184:187], v[188:191], a[116:119]
  v_mfma_f32_16x16x32_bf16 a[120:123], a[188:191], v[184:187], a[120:123]
  v_cvt_pk_bf16_f32 v183, v222, v223
  v_add_u32 v3, s66, v2
  v_mfma_f32_16x16x32_bf16 a[124:127], a[188:191], v[188:191], a[124:127]
  s_cbranch_vccnz fa_stub29
fa_back29:
  v_add_f32 v230, v230, v226
  v_add_f32 v231, v231, v227
  s_cmp_ge_u32 s20, 2
  s_cbranch_scc1 fa_nb0
  s_waitcnt vmcnt(10)
  s_barrier
fa_nb0:
  ds_read_b128 a[160:163], v3 offset:16384
  ds_read_b128 a[164:167], v3 offset:17408
  ds_read_b128 a[168:171], v3 offset:18432
  ds_read_b128 a[172:175], v3 offset:19456
  ds_read_b128 a[176:179], v3 offset:20480
  ds_read_b128 a[180:183], v3 offset:21504
  ds_read_b128 a[184:187], v3 offset:22528
  ds_read_b128 a[188:191], v3 offset:23552
  s_waitcnt lgkmcnt(4)
  v_mfma_f32_16x16x32_bf16 a[64:67], a[160:163], v[176:179], a[64:67]
  v_mfma_f32_16x16x32_bf16 a[68:71], a[160:163], v[180:183], a[68:71]
  s_add_u32 s14, s13, 57344
  buffer_load_dwordx4 v[240:243], v2, s[40:43], s14 offen offset:2048 sc1
  v_mfma_f32_16x16x32_bf16 a[72:75], a[164:167], v[176:179], a[72:75]
  v_mfma_f32_16x16x32_bf16 a[76:79], a[164:167], v[180:183], a[76:79]
  v_mfma_f32_16x16x32_bf16 a[80:83], a[168:171], v[176:179], a[80:83]
  v_mfma_f32_16x16x32_bf16 a[84:87], a[168:171], v[180:183], a[84:87]
  v_mfma_f32_16x16x32_bf16 a[88:91], a[172:175], v[176:179], a[88:91]
  v_mfma_f32_16x16x32_bf16 a[92:95], a[172:175], v[180:183], a[92:95]
  s_waitcnt lgkmcnt(0)
  v_mfma_f32_16x16x32_bf16 a[96:99], a[176:179], v[176:179], a[96:99]
  buffer_load_dwordx4 v[244:247], v2, s[40:43], s14 offen offset:3072 sc1
  v_mfma_f32_16x16x32_bf16 a[100:103], a[176:179], v[180:183], a[100:103]
  v_mfma_f32_16x16x32_bf16 a[104:107], a[180:183], v[176:179], a[104:107]
  v_mfma_f32_16x16x32_bf16 a[108:111], a[180:183], v[180:183], a[108:111]
  v_mfma_f32_16x16x32_bf16 a[112:115], a[184:187], v[176:179], a[112:115]
  v_mfma_f32_16x16x32_bf16 a[116:119], a[184:187], v[180:183], a[116:119]
  v_mfma_f32_16x16x32_bf16 a[120:123], a[188:191], v[176:179], a[120:123]
  v_mfma_f32_16x16x32_bf16 a[124:127], a[188:191], v[180:183], a[124:127]
  s_branch fa_Bdone
fa_Bodd:
  s_cmp_ge_u32 s20, 2
  s_cbranch_scc1 fa_nb1
  s_waitcnt vmcnt(8)
  s_barrier
fa_nb1:
  ds_read_b128 a[160:163], v3 offset:16384
  ds_read_b128 a[164:167], v3 offset:17408
  ds_read_b128 a[168:171], v3 offset:18432
  ds_read_b128 a[172:175], v3 offset:19456
  ds_read_b128 a[176:179], v3 offset:20480
  ds_read_b128 a[180:183], v3 offset:21504
  ds_read_b128 a[184:187], v3 offset:22528
  ds_read_b128 a[188:191], v3 offset:23552
  v_cndmask_b32 v144, v4, v144, s[68:69]
  v_cndmask_b32 v145, v4, v145, s[70:71]
  v_cndmask_b32 v146, v4, v146, s[72:73]
  v_cndmask_b32 v147, v4, v147, s[74:75]
  v_mov_b32 v148, v4
  v_mov_b32 v149, v4
  v_mov_b32 v150, v4
  v_mov_b32 v151, v4
  v_cndmask_b32 v156, v4, v156, s[68:69]
  v_cndmask_b32 v157, v4, v157, s[70:71]
  v_cndmask_b32 v158, v4, v158, s[72:73]
  v_cndmask_b32 v159, v4, v159, s[74:75]
  v_exp_f32 v216, v144
  v_exp_f32 v217, v145
  v_exp_f32 v218, v146
  v_add_f32 v226, v216, v217
  v_cvt_pk_bf16_f32 v184, v216, v217
  v_add_f32 v226, v226, v218
  v_exp_f32 v219, v147
  v_exp_f32 v220, v148
  v_add_f32 v226, v226, v219
  v_cvt_pk_bf16_f32 v185, v218, v219
  v_add_f32 v226, v226, v220
  v_exp_f32 v221, v149
  s_waitcnt lgkmcnt(4)
  v_mfma_f32_16x16x32_bf16 a[64:67], a[160:163], v[176:179], a[64:67]
  v_exp_f32 v222, v150
  v_add_f32 v226, v226, v221
  v_mfma_f32_16x16x32_bf16 a[68:71], a[160:163], v[180:183], a[68:71]
  s_add_u32 s14, s13, 49152
  buffer_load_dwordx4 v[160:163], v2, s[40:43], s14 offen offset:0 sc1
  v_exp_f32 v223, v151
  v_mfma_f32_16x16x32_bf16 a[72:75], a[164:167], v[176:179], a[72:75]
  v_exp_f32 v216, v152
  v_cvt_pk_bf16_f32 v186, v220, v221
  v_add_f32 v226, v226, v222
  v_mfma_f32_16x16x32_bf16 a[76:79], a[164:167], v[180:183], a[76:79]
  buffer_load_dwordx4 v[164:167], v2, s[40:43], s14 offen offset:1024 sc1
  v_exp_f32 v217, v153
  v_mfma_f32_16x16x32_bf16 a[80:83], a[168:171], v[176:179], a[80:83]
  v_exp_f32 v218, v154
  v_add_f32 v226, v226, v223
  v_mfma_f32_16x16x32_bf16 a[84:87], a[168:171], v[180:183], a[84:87]
  buffer_load_dwordx4 v[168:171], v2, s[40:43], s14 offen offset:2048 sc1
  v_exp_f32 v219, v155
  v_cvt_pk_bf16_f32 v187, v222, v223
  v_mfma_f32_16x16x32_bf16 a[88:91], a[172:175], v[176:179], a[88:91]
  v_exp_f32 v220, v156
  v_mfma_f32_16x16x32_bf16 a[92:95], a[172:175], v[180:183], a[92:95]
  s_waitcnt lgkmcnt(0)
  buffer_load_dwordx4 v[172:175], v2, s[40:43], s14 offen offset:3072 sc1
  v_add_f32 v227, v216, v217
  v_cvt_pk_bf16_f32 v188, v216, v217
  v_add_f32 v227, v227, v218
  v_mfma_f32_16x16x32_bf16 a[96:99], a[176:179], v[176:179], a[96:99]
  v_exp_f32 v221, v157
  v_mfma_f32_16x16x32_bf16 a[100:103], a[176:179], v[180:183], a[100:103]
  s_add_u32 s14, s13, 53248
  buffer_load_dwordx4 v[192:195], v2, s[40:43], s14 offen offset:0 sc1
  v_exp_f32 v222, v158
  v_mfma_f32_16x16x32_bf16 a[104:107], a[180:183], v[176:179], a[104:107]
  v_exp_f32 v223, v159
  v_mfma_f32_16x16x32_bf16 a[108:111], a[180:183], v[180:183], a[108:111]
  buffer_load_dwordx4 v[196:199], v2, s[40:43], s14 offen offset:1024 sc1
  v_add_f32 v227, v227, v219
  v_cvt_pk_bf16_f32 v189, v218, v219
  v_add_f32 v227, v227, v220
  v_add_f32 v227, v227, v221
  v_cvt_pk_bf16_f32 v190, v220, v221
  v_add_f32 v227, v227, v222
  v_mfma_f32_16x16x32_bf16 a[112:115], a[184:187], v[176:179], a[112:115]
  v_add_f32 v227, v227, v223
  v_max_f32 v5, v226, v227
  v_cmp_lt_f32 vcc, s81, v5
  v_mfma_f32_16x16x32_bf16 a[116:119], a[184:187], v[180:183], a[116:119]
  buffer_load_dwordx4 v[208:211], v2, s[40:43], s14 offen offset:2048 sc1
  v_mfma_f32_16x16x32_bf16 a[120:123], a[188:191], v[176:179], a[120:123]
  v_cvt_pk_bf16_f32 v191, v222, v223
  v_mfma_f32_16x16x32_bf16 a[124:127], a[188:191], v[180:183], a[124:127]
  s_cbranch_vccnz fa_stub30
fa_back30:
  v_add_f32 v230, v230, v226
  v_add_f32 v231, v231, v227
  ds_read_b128 a[160:163], v3 offset:24576
  ds_read_b128 a[164:167], v3 offset:25600
  ds_read_b128 a[168:171], v3 offset:26624
  ds_read_b128 a[172:175], v3 offset:27648
  ds_read_b128 a[176:179], v3 offset:28672
  ds_read_b128 a[180:183], v3 offset:29696
  ds_read_b128 a[184:187], v3 offset:30720
  ds_read_b128 a[188:191], v3 offset:31744
  s_waitcnt lgkmcnt(4)
  v_mfma_f32_16x16x32_bf16 a[64:67], a[160:163], v[184:187], a[64:67]
  v_mfma_f32_16x16x32_bf16 a[68:71], a[160:163], v[188:191], a[68:71]
  s_add_u32 s14, s13, 53248
  buffer_load_dwordx4 v[212:215], v2, s[40:43], s14 offen offset:3072 sc1
  v_mfma_f32_16x16x32_bf16 a[72:75], a[164:167], v[184:187], a[72:75]
  s_add_u32 s66, s66, 32768
  v_mfma_f32_16x16x32_bf16 a[76:79], a[164:167], v[188:191], a[76:79]
  s_add_u32 s14, s13, 57344
  buffer_load_dwordx4 v[232:235], v2, s[40:43], s14 offen offset:0 sc1
  v_mfma_f32_16x16x32_bf16 a[80:83], a[168:171], v[184:187], a[80:83]
  s_and_b32 s66, s66, 0x1ffff
  v_mfma_f32_16x16x32_bf16 a[84:87], a[168:171], v[188:191], a[84:87]
  v_mfma_f32_16x16x32_bf16 a[88:91], a[172:175], v[184:187], a[88:91]
  buffer_load_dwordx4 v[236:239], v2, s[40:43], s14 offen offset:1024 sc1
  v_mfma_f32_16x16x32_bf16 a[92:95], a[172:175], v[188:191], a[92:95]
  s_waitcnt lgkmcnt(0)
  v_mfma_f32_16x16x32_bf16 a[96:99], a[176:179], v[184:187], a[96:99]
  v_mfma_f32_16x16x32_bf16 a[100:103], a[176:179], v[188:191], a[100:103]
  buffer_load_dwordx4 v[240:243], v2, s[40:43], s14 offen offset:2048 sc1
  v_mfma_f32_16x16x32_bf16 a[104:107], a[180:183], v[184:187], a[104:107]
  v_mfma_f32_16x16x32_bf16 a[108:111], a[180:183], v[188:191], a[108:111]
  v_mfma_f32_16x16x32_bf16 a[112:115], a[184:187], v[184:187], a[112:115]
  buffer_load_dwordx4 v[244:247], v2, s[40:43], s14 offen offset:3072 sc1
  v_mfma_f32_16x16x32_bf16 a[116:119], a[184:187], v[188:191], a[116:119]
  v_mfma_f32_16x16x32_bf16 a[120:123], a[188:191], v[184:187], a[120:123]
  v_add_u32 v3, s66, v2
  v_mfma_f32_16x16x32_bf16 a[124:127], a[188:191], v[188:191], a[124:127]
fa_Bdone:
fa_epi:
  v_mov_b32 v20, v230
  v_mov_b32 v21, v231
  s_nop 1
  v_permlane16_swap_b32 v230, v20
  v_permlane16_swap_b32 v231, v21
  v_add_f32 v230, v230, v20
  v_add_f32 v231, v231, v21
  v_mov_b32 v20, v230
  v_mov_b32 v21, v231
  s_nop 1
  v_permlane32_swap_b32 v230, v20
  v_permlane32_swap_b32 v231, v21
  v_add_f32 v230, v230, v20
  v_add_f32 v231, v231, v21
  v_rcp_f32 v16, v230
  v_rcp_f32 v18, v231
  s_sub_u32 s23, 15, s22
  s_lshl_b32 s23, s23, 2
  v_mov_b32 v17, v16
  v_mov_b32 v19, v18
  s_add_u32 s23, s23, s20
  s_lshl_b32 s23, s23, 18
  s_lshl_b32 s31, s21, 12
  s_add_u32 s31, s31, 50331648
  s_add_u32 s64, s23, s31
  s_add_u32 s65, s64, 131072
  v_accvgpr_read_b32 v68, a64
  v_accvgpr_read_b32 v69, a65
  v_accvgpr_read_b32 v70, a66
  v_accvgpr_read_b32 v71, a67
  v_accvgpr_read_b32 v72, a72
  v_accvgpr_read_b32 v73, a73
  v_accvgpr_read_b32 v74, a74
  v_accvgpr_read_b32 v75, a75
  v_pk_mul_f32 v[68:69], v[68:69], v[16:17]
  v_pk_mul_f32 v[70:71], v[70:71], v[16:17]
  v_pk_mul_f32 v[72:73], v[72:73], v[16:17]
  v_pk_mul_f32 v[74:75], v[74:75], v[16:17]
  v_cvt_pk_bf16_f32 v64, v68, v69
  v_cvt_pk_bf16_f32 v65, v70, v71
  v_cvt_pk_bf16_f32 v66, v72, v73
  v_cvt_pk_bf16_f32 v67, v74, v75
  buffer_store_dwordx4 v[64:67], v2, s[40:43], s64 offen offset:0 sc1
  v_accvgpr_read_b32 v80, a80
  v_accvgpr_read_b32 v81, a81
  v_accvgpr_read_b32 v82, a82
  v_accvgpr_read_b32 v83, a83
  v_accvgpr_read_b32 v84, a88
  v_accvgpr_read_b32 v85, a89
  v_accvgpr_read_b32 v86, a90
  v_accvgpr_read_b32 v87, a91
  v_pk_mul_f32 v[80:81], v[80:81], v[16:17]
  v_pk_mul_f32 v[82:83], v[82:83], v[16:17]
  v_pk_mul_f32 v[84:85], v[84:85], v[16:17]
  v_pk_mul_f32 v[86:87], v[86:87], v[16:17]
  v_cvt_pk_bf16_f32 v76, v80, v81
  v_cvt_pk_bf16_f32 v77, v82, v83
  v_cvt_pk_bf16_f32 v78, v84, v85
  v_cvt_pk_bf16_f32 v79, v86, v87
  buffer_store_dwordx4 v[76:79], v2, s[40:43], s64 offen offset:1024 sc1
  v_accvgpr_read_b32 v132, a96
  v_accvgpr_read_b32 v133, a97
  v_accvgpr_read_b32 v134, a98
  v_accvgpr_read_b32 v135, a99
  v_accvgpr_read_b32 v136, a104
  v_accvgpr_read_b32 v137, a105
  v_accvgpr_read_b32 v138, a106
  v_accvgpr_read_b32 v139, a107
  v_pk_mul_f32 v[132:133], v[132:133], v[16:17]
  v_pk_mul_f32 v[134:135], v[134:135], v[16:17]
  v_pk_mul_f32 v[136:137], v[136:137], v[16:17]
  v_pk_mul_f32 v[138:139], v[138:139], v[16:17]
  v_cvt_pk_bf16_f32 v128, v132, v133
  v_cvt_pk_bf16_f32 v129, v134, v135
  v_cvt_pk_bf16_f32 v130, v136, v137
  v_cvt_pk_bf16_f32 v131, v138, v139
  buffer_store_dwordx4 v[128:131], v2, s[40:43], s64 offen offset:2048 sc1
  v_accvgpr_read_b32 v144, a112
  v_accvgpr_read_b32 v145, a113
  v_accvgpr_read_b32 v146, a114
  v_accvgpr_read_b32 v147, a115
  v_accvgpr_read_b32 v148, a120
  v_accvgpr_read_b32 v149, a121
  v_accvgpr_read_b32 v150, a122
  v_accvgpr_read_b32 v151, a123
  v_pk_mul_f32 v[144:145], v[144:145], v[16:17]
  v_pk_mul_f32 v[146:147], v[146:147], v[16:17]
  v_pk_mul_f32 v[148:149], v[148:149], v[16:17]
  v_pk_mul_f32 v[150:151], v[150:151], v[16:17]
  v_cvt_pk_bf16_f32 v140, v144, v145
  v_cvt_pk_bf16_f32 v141, v146, v147
  v_cvt_pk_bf16_f32 v142, v148, v149
  v_cvt_pk_bf16_f32 v143, v150, v151
  buffer_store_dwordx4 v[140:143], v2, s[40:43], s64 offen offset:3072 sc1
  v_accvgpr_read_b32 v68, a68
  v_accvgpr_read_b32 v69, a69
  v_accvgpr_read_b32 v70, a70
  v_accvgpr_read_b32 v71, a71
  v_accvgpr_read_b32 v72, a76
  v_accvgpr_read_b32 v73, a77
  v_accvgpr_read_b32 v74, a78
  v_accvgpr_read_b32 v75, a79
  v_pk_mul_f32 v[68:69], v[68:69], v[18:19]
  v_pk_mul_f32 v[70:71], v[70:71], v[18:19]
  v_pk_mul_f32 v[72:73], v[72:73], v[18:19]
  v_pk_mul_f32 v[74:75], v[74:75], v[18:19]
  v_cvt_pk_bf16_f32 v64, v68, v69
  v_cvt_pk_bf16_f32 v65, v70, v71
  v_cvt_pk_bf16_f32 v66, v72, v73
  v_cvt_pk_bf16_f32 v67, v74, v75
  buffer_store_dwordx4 v[64:67], v2, s[40:43], s65 offen offset:0 sc1
  v_accvgpr_read_b32 v80, a84
  v_accvgpr_read_b32 v81, a85
  v_accvgpr_read_b32 v82, a86
  v_accvgpr_read_b32 v83, a87
  v_accvgpr_read_b32 v84, a92
  v_accvgpr_read_b32 v85, a93
  v_accvgpr_read_b32 v86, a94
  v_accvgpr_read_b32 v87, a95
  v_pk_mul_f32 v[80:81], v[80:81], v[18:19]
  v_pk_mul_f32 v[82:83], v[82:83], v[18:19]
  v_pk_mul_f32 v[84:85], v[84:85], v[18:19]
  v_pk_mul_f32 v[86:87], v[86:87], v[18:19]
  v_cvt_pk_bf16_f32 v76, v80, v81
  v_cvt_pk_bf16_f32 v77, v82, v83
  v_cvt_pk_bf16_f32 v78, v84, v85
  v_cvt_pk_bf16_f32 v79, v86, v87
  buffer_store_dwordx4 v[76:79], v2, s[40:43], s65 offen offset:1024 sc1
  v_accvgpr_read_b32 v132, a100
  v_accvgpr_read_b32 v133, a101
  v_accvgpr_read_b32 v134, a102
  v_accvgpr_read_b32 v135, a103
  v_accvgpr_read_b32 v136, a108
  v_accvgpr_read_b32 v137, a109
  v_accvgpr_read_b32 v138, a110
  v_accvgpr_read_b32 v139, a111
  v_pk_mul_f32 v[132:133], v[132:133], v[18:19]
  v_pk_mul_f32 v[134:135], v[134:135], v[18:19]
  v_pk_mul_f32 v[136:137], v[136:137], v[18:19]
  v_pk_mul_f32 v[138:139], v[138:139], v[18:19]
  v_cvt_pk_bf16_f32 v128, v132, v133
  v_cvt_pk_bf16_f32 v129, v134, v135
  v_cvt_pk_bf16_f32 v130, v136, v137
  v_cvt_pk_bf16_f32 v131, v138, v139
  buffer_store_dwordx4 v[128:131], v2, s[40:43], s65 offen offset:2048 sc1
  v_accvgpr_read_b32 v144, a116
  v_accvgpr_read_b32 v145, a117
  v_accvgpr_read_b32 v146, a118
  v_accvgpr_read_b32 v147, a119
  v_accvgpr_read_b32 v148, a124
  v_accvgpr_read_b32 v149, a125
  v_accvgpr_read_b32 v150, a126
  v_accvgpr_read_b32 v151, a127
  v_pk_mul_f32 v[144:145], v[144:145], v[18:19]
  v_pk_mul_f32 v[146:147], v[146:147], v[18:19]
  v_pk_mul_f32 v[148:149], v[148:149], v[18:19]
  v_pk_mul_f32 v[150:151], v[150:151], v[18:19]
  v_cvt_pk_bf16_f32 v140, v144, v145
  v_cvt_pk_bf16_f32 v141, v146, v147
  v_cvt_pk_bf16_f32 v142, v148, v149
  v_cvt_pk_bf16_f32 v143, v150, v151
  buffer_store_dwordx4 v[140:143], v2, s[40:43], s65 offen offset:3072 sc1
  s_load_dwordx2 s[8:9], s[0:1], 0
  s_load_dwordx2 s[16:17], s[0:1], 88
  v_mov_b32 v30, 1073741824
  v_writelane_b32 v30, s80, 0
  v_writelane_b32 v30, s3, 1
  s_cmp_lt_u32 s12, 3
  s_cbranch_scc1 fa_puby
  s_add_u32 s14, s13, 61440
  buffer_load_dwordx4 v[64:67], v2, s[40:43], s14 offen offset:0 sc1
  buffer_load_dwordx4 v[68:71], v2, s[40:43], s14 offen offset:1024 sc1
  buffer_load_dwordx4 v[72:75], v2, s[40:43], s14 offen offset:2048 sc1
  buffer_load_dwordx4 v[76:79], v2, s[40:43], s14 offen offset:3072 sc1
  s_waitcnt vmcnt(4)
  buffer_store_dword v4, v30, s[40:43], 0 offen sc1
fa_pubb:
  s_cmp_lt_u32 s29, 8
  s_cbranch_scc1 fa_left
fa_leftb:
  s_add_u32 s14, s13, 65536
  buffer_load_dwordx4 v[80:83], v2, s[40:43], s14 offen offset:0 sc1
  buffer_load_dwordx4 v[84:87], v2, s[40:43], s14 offen offset:1024 sc1
  buffer_load_dwordx4 v[88:91], v2, s[40:43], s14 offen offset:2048 sc1
  buffer_load_dwordx4 v[92:95], v2, s[40:43], s14 offen offset:3072 sc1
  s_add_u32 s14, s13, 69632
  buffer_load_dwordx4 v[128:131], v2, s[40:43], s14 offen offset:0 sc1
  buffer_load_dwordx4 v[132:135], v2, s[40:43], s14 offen offset:1024 sc1
  buffer_load_dwordx4 v[136:139], v2, s[40:43], s14 offen offset:2048 sc1
  buffer_load_dwordx4 v[140:143], v2, s[40:43], s14 offen offset:3072 sc1
  s_add_u32 s14, s13, 73728
  buffer_load_dwordx4 v[144:147], v2, s[40:43], s14 offen offset:0 sc1
  buffer_load_dwordx4 v[148:151], v2, s[40:43], s14 offen offset:1024 sc1
  s_lshl_b32 s63, s21, 19
  s_lshl_b32 s23, s20, 15
  s_add_u32 s63, s63, s23
  s_add_u32 s63, s63, 50331648
  s_mul_i32 s62, s22, 0
  s_and_b32 s62, s62, 0x7fff
  s_add_u32 s64, s63, s62
  s_add_u32 s65, s64, 131072
  s_add_u32 s66, s64, 262144
  s_add_u32 s67, s64, 393216
  v_bfe_u32 v12, v1, 3, 1
  v_mul_u32_u24 v12, 4352, v12
  v_and_b32 v13, 7, v1
  v_lshl_add_u32 v12, v13, 2, v12
  s_mul_i32 s23, s21, 8704
  s_lshl_b32 s31, s20, 5
  s_add_u32 s23, s23, s31
  s_add_u32 s23, s23, 3801088
  v_add_u32 v12, s23, v12
  v_mov_b32 v20, 0
  v_mov_b32 v21, 0
  v_mov_b32 v22, 0
  v_mov_b32 v23, 0
  v_add_u32 v16, 158208, v2
  ds_write_b128 v16, v[20:23]
  buffer_load_dwordx4 v[152:155], v2, s[40:43], s14 offen offset:2048 sc1
  buffer_load_dwordx4 v[156:159], v2, s[40:43], s14 offen offset:3072 sc1
  s_add_u32 s14, s13, 77824
  buffer_load_dwordx4 v[176:179], v2, s[40:43], s14 offen offset:0 sc1
  buffer_load_dwordx4 v[180:183], v2, s[40:43], s14 offen offset:1024 sc1
  buffer_load_dwordx4 v[184:187], v2, s[40:43], s14 offen offset:2048 sc1
  buffer_load_dwordx4 v[188:191], v2, s[40:43], s14 offen offset:3072 sc1
  s_lshl_b32 s34, s28, 1
  s_and_b32 s23, s20, 1
  s_lshl_b32 s23, s23, 12
  s_cmp_lt_u32 s20, 2
  s_cselect_b32 s33, 106496, 0
  s_add_u32 s33, s33, s23
  s_add_u32 s33, s33, s34
  s_and_b32 s33, s33, 0x1ffff
  s_lshl_b32 s23, s20, 12
  s_add_u32 s34, s34, 49152
  s_add_u32 s34, s34, s23
  s_and_b32 s34, s34, 0x1ffff
  s_add_u32 s23, s23, s28
  s_cmp_lt_u32 s29, 3
  s_cselect_b32 s26, s23, s26
  s_cselect_b32 s27, s23, s27
  s_cselect_b32 s24, s33, s24
  s_cselect_b32 s25, s34, s25
  s_mov_b64 s[44:45], s[4:5]
  s_mov_b64 s[48:49], s[6:7]
  s_mov_b32 s46, s30
  s_mov_b32 s50, s30
  s_add_u32 s23, s28, 49152
fa_pk:
  s_cmp_ge_u32 s26, s23
  s_cbranch_scc1 fa_pkd
  s_mov_b32 m0, s24
  s_add_u32 s24, s24, 32768
  s_and_b32 s24, s24, 0x1ffff
  buffer_load_dwordx4 v2, s[44:47], s26 offen offset:0 sc1 lds
  buffer_load_dwordx4 v2, s[44:47], s26 offen offset:1024 sc1 lds
  buffer_load_dwordx4 v2, s[44:47], s26 offen offset:2048 sc1 lds
  buffer_load_dwordx4 v2, s[44:47], s26 offen offset:3072 sc1 lds
  s_add_u32 s26, s26, 16384
  s_branch fa_pk
fa_pkd:
  s_add_u32 s23, s28, 32768
fa_pv:
  s_cmp_ge_u32 s27, s23
  s_cbranch_scc1 fa_pvd
  s_mov_b32 m0, s25
  s_add_u32 s25, s25, 32768
  s_and_b32 s25, s25, 0x1ffff
  buffer_load_dwordx4 v2, s[48:51], s27 offen offset:0 sc1 lds
  buffer_load_dwordx4 v2, s[48:51], s27 offen offset:1024 sc1 lds
  buffer_load_dwordx4 v2, s[48:51], s27 offen offset:2048 sc1 lds
  buffer_load_dwordx4 v2, s[48:51], s27 offen offset:3072 sc1 lds
  s_add_u32 s27, s27, 16384
  s_branch fa_pv
fa_pvd:
  s_lshl_b32 s35, s20, 12
  s_add_u32 s35, s35, 131072
  s_mov_b32 m0, s35
  s_add_u32 s14, s13, 155648
  buffer_load_dwordx4 v2, s[40:43], s14 offen offset:0 sc1 lds
  buffer_load_dwordx4 v2, s[40:43], s14 offen offset:1024 sc1 lds
  buffer_load_dwordx4 v2, s[40:43], s14 offen offset:2048 sc1 lds
  buffer_load_dwordx4 v2, s[40:43], s14 offen offset:3072 sc1 lds
  s_waitcnt lgkmcnt(0)
  s_barrier
  s_mov_b32 m0, s24
  s_add_u32 s24, s24, 32768
  s_and_b32 s24, s24, 0x1ffff
  buffer_load_dwordx4 v2, s[44:47], s26 offen offset:0 sc1 lds
  buffer_load_dwordx4 v2, s[44:47], s26 offen offset:1024 sc1 lds
  buffer_load_dwordx4 v2, s[44:47], s26 offen offset:2048 sc1 lds
  buffer_load_dwordx4 v2, s[44:47], s26 offen offset:3072 sc1 lds
  s_add_u32 s26, s26, 16384
  buffer_load_dword v13, v12, s[40:43], 0 offen sc1
  s_mov_b32 m0, s25
  s_add_u32 s25, s25, 32768
  s_and_b32 s25, s25, 0x1ffff
  buffer_load_dwordx4 v2, s[48:51], s27 offen offset:0 sc1 lds
  buffer_load_dwordx4 v2, s[48:51], s27 offen offset:1024 sc1 lds
  buffer_load_dwordx4 v2, s[48:51], s27 offen offset:2048 sc1 lds
  buffer_load_dwordx4 v2, s[48:51], s27 offen offset:3072 sc1 lds
  s_add_u32 s27, s27, 16384
  s_mov_b32 m0, s25
  s_add_u32 s25, s25, 32768
  s_and_b32 s25, s25, 0x1ffff
  buffer_load_dwordx4 v2, s[48:51], s27 offen offset:0 sc1 lds
  buffer_load_dwordx4 v2, s[48:51], s27 offen offset:1024 sc1 lds
  buffer_load_dwordx4 v2, s[48:51], s27 offen offset:2048 sc1 lds
  buffer_load_dwordx4 v2, s[48:51], s27 offen offset:3072 sc1 lds
  s_add_u32 s27, s27, 16384
  s_mov_b32 s44, s8
  s_mov_b32 s45, s9
  s_mov_b32 s46, 2621440
  s_mov_b32 s47, 0x20000
  s_mov_b32 s48, s16
  s_mov_b32 s49, s17
  s_mov_b32 s50, 2621440
  s_mov_b32 s51, 0x20000
  s_lshl_b32 s25, s21, 6
  s_mul_i32 s26, s22, 160
  s_mul_i32 s27, s22, 2560
  s_waitcnt vmcnt(8)
  v_cmp_eq_u32 vcc, 0, v13
  s_cbranch_vccnz fa_ctx_spin
fa_ctx_ok:
  buffer_load_dwordx4 a[144:147], v2, s[40:43], s64 offen offset:0 sc1
  buffer_load_dwordx4 a[148:151], v2, s[40:43], s65 offen offset:0 sc1
  buffer_load_dwordx4 a[152:155], v2, s[40:43], s66 offen offset:0 sc1
  buffer_load_dwordx4 a[156:159], v2, s[40:43], s67 offen offset:0 sc1
  buffer_load_dwordx4 a[160:163], v2, s[40:43], s64 offen offset:1024 sc1
  buffer_load_dwordx4 a[164:167], v2, s[40:43], s65 offen offset:1024 sc1
  buffer_load_dwordx4 a[168:171], v2, s[40:43], s66 offen offset:1024 sc1
  buffer_load_dwordx4 a[172:175], v2, s[40:43], s67 offen offset:1024 sc1
  buffer_load_dwordx4 a[176:179], v2, s[40:43], s64 offen offset:2048 sc1
  buffer_load_dwordx4 a[180:183], v2, s[40:43], s65 offen offset:2048 sc1
  buffer_load_dwordx4 a[184:187], v2, s[40:43], s66 offen offset:2048 sc1
  buffer_load_dwordx4 a[188:191], v2, s[40:43], s67 offen offset:2048 sc1
  buffer_load_dwordx4 v[216:219], v2, s[40:43], s64 offen offset:3072 sc1
  buffer_load_dwordx4 v[220:223], v2, s[40:43], s65 offen offset:3072 sc1
  buffer_load_dwordx4 v[224:227], v2, s[40:43], s66 offen offset:3072 sc1
  buffer_load_dwordx4 v[228:231], v2, s[40:43], s67 offen offset:3072 sc1
  s_add_u32 s62, s62, 4096
  s_and_b32 s62, s62, 0x7fff
  s_add_u32 s64, s63, s62
  s_add_u32 s65, s64, 131072
  s_add_u32 s66, s64, 262144
  s_add_u32 s67, s64, 393216
  s_waitcnt vmcnt(14)
  v_mfma_f32_16x16x32_bf16 a[64:67], a[0:3], a[144:147], 0
  v_mfma_f32_16x16x32_bf16 a[80:83], a[4:7], a[144:147], 0
  v_mfma_f32_16x16x32_bf16 a[96:99], a[8:11], a[144:147], 0
  v_mfma_f32_16x16x32_bf16 a[112:115], a[12:15], a[144:147], 0
  v_mfma_f32_16x16x32_bf16 a[128:131], a[16:19], a[144:147], 0
  buffer_load_dwordx4 a[144:147], v2, s[40:43], s64 offen offset:0 sc1
  v_mfma_f32_16x16x32_bf16 a[68:71], a[0:3], a[148:151], 0
  v_mfma_f32_16x16x32_bf16 a[84:87], a[4:7], a[148:151], 0
  v_mfma_f32_16x16x32_bf16 a[100:103], a[8:11], a[148:151], 0
  v_mfma_f32_16x16x32_bf16 a[116:119], a[12:15], a[148:151], 0
  v_mfma_f32_16x16x32_bf16 a[132:135], a[16:19], a[148:151], 0
  s_waitcnt vmcnt(13)
  buffer_load_dwordx4 a[148:151], v2, s[40:43], s65 offen offset:0 sc1
  v_mfma_f32_16x16x32_bf16 a[72:75], a[0:3], a[152:155], 0
  v_mfma_f32_16x16x32_bf16 a[88:91], a[4:7], a[152:155], 0
  v_mfma_f32_16x16x32_bf16 a[104:107], a[8:11], a[152:155], 0
  v_mfma_f32_16x16x32_bf16 a[120:123], a[12:15], a[152:155], 0
  v_mfma_f32_16x16x32_bf16 a[136:139], a[16:19], a[152:155], 0
  buffer_load_dwordx4 a[152:155], v2, s[40:43], s66 offen offset:0 sc1
  v_mfma_f32_16x16x32_bf16 a[76:79], a[0:3], a[156:159], 0
  v_mfma_f32_16x16x32_bf16 a[92:95], a[4:7], a[156:159], 0
  v_mfma_f32_16x16x32_bf16 a[108:111], a[8:11], a[156:159], 0
  v_mfma_f32_16x16x32_bf16 a[124:127], a[12:15], a[156:159], 0
  v_mfma_f32_16x16x32_bf16 a[140:143], a[16:19], a[156:159], 0
  s_waitcnt vmcnt(13)
  buffer_load_dwordx4 a[156:159], v2, s[40:43], s67 offen offset:0 sc1
  v_mfma_f32_16x16x32_bf16 a[64:67], a[20:23], a[160:163], a[64:67]
  v_add_u32 v16, 0, v0
  v_mfma_f32_16x16x32_bf16 a[80:83], a[24:27], a[160:163], a[80:83]
  v_mfma_f32_16x16x32_bf16 a[96:99], a[28:31], a[160:163], a[96:99]
  s_add_u32 s14, s13, 81920
  buffer_load_dwordx4 a[0:3], v2, s[40:43], s14 offen offset:0 sc1
  v_mul_u32_u24 v17, 6554, v16
  v_mfma_f32_16x16x32_bf16 a[112:115], a[32:35], a[160:163], a[112:115]
  v_mfma_f32_16x16x32_bf16 a[128:131], a[36:39], a[160:163], a[128:131]
  buffer_load_dwordx4 a[160:163], v2, s[40:43], s64 offen offset:1024 sc1
  v_mfma_f32_16x16x32_bf16 a[68:71], a[20:23], a[164:167], a[68:71]
  v_lshrrev_b32 v17, 16, v17
  v_mfma_f32_16x16x32_bf16 a[84:87], a[24:27], a[164:167], a[84:87]
  v_mul_u32_u24 v18, 10, v17
  v_mfma_f32_16x16x32_bf16 a[100:103], a[28:31], a[164:167], a[100:103]
  v_mfma_f32_16x16x32_bf16 a[116:119], a[32:35], a[164:167], a[116:119]
  v_mfma_f32_16x16x32_bf16 a[132:135], a[36:39], a[164:167], a[132:135]
  s_waitcnt vmcnt(14)
  buffer_load_dwordx4 a[164:167], v2, s[40:43], s65 offen offset:1024 sc1
  v_sub_u32 v18, v16, v18
  v_mfma_f32_16x16x32_bf16 a[72:75], a[20:23], a[168:171], a[72:75]
  v_mfma_f32_16x16x32_bf16 a[88:91], a[24:27], a[168:171], a[88:91]
  v_mfma_f32_16x16x32_bf16 a[104:107], a[28:31], a[168:171], a[104:107]
  buffer_load_dwordx4 a[4:7], v2, s[40:43], s14 offen offset:1024 sc1
  v_mfma_f32_16x16x32_bf16 a[120:123], a[32:35], a[168:171], a[120:123]
  v_mul_u32_u24 v251, 336, v17
  v_mfma_f32_16x16x32_bf16 a[136:139], a[36:39], a[168:171], a[136:139]
  buffer_load_dwordx4 a[168:171], v2, s[40:43], s66 offen offset:1024 sc1
  v_lshl_add_u32 v251, v18, 5, v251
  v_mfma_f32_16x16x32_bf16 a[76:79], a[20:23], a[172:175], a[76:79]
  v_mfma_f32_16x16x32_bf16 a[92:95], a[24:27], a[172:175], a[92:95]
  v_mfma_f32_16x16x32_bf16 a[108:111], a[28:31], a[172:175], a[108:111]
  v_mfma_f32_16x16x32_bf16 a[124:127], a[32:35], a[172:175], a[124:127]
  v_mfma_f32_16x16x32_bf16 a[140:143], a[36:39], a[172:175], a[140:143]
  s_waitcnt vmcnt(15)
  buffer_load_dwordx4 a[172:175], v2, s[40:43], s67 offen offset:1024 sc1
  v_mfma_f32_16x16x32_bf16 a[64:67], a[40:43], a[176:179], a[64:67]
  v_lshlrev_b32 v203, 5, v18
  v_mfma_f32_16x16x32_bf16 a[80:83], a[44:47], a[176:179], a[80:83]
  v_mfma_f32_16x16x32_bf16 a[96:99], a[48:51], a[176:179], a[96:99]
  buffer_load_dwordx4 a[8:11], v2, s[40:43], s14 offen offset:2048 sc1
  v_add_u32 v17, s25, v17
  v_mfma_f32_16x16x32_bf16 a[112:115], a[52:55], a[176:179], a[112:115]
  v_mfma_f32_16x16x32_bf16 a[128:131], a[56:59], a[176:179], a[128:131]
  buffer_load_dwordx4 a[176:179], v2, s[40:43], s64 offen offset:2048 sc1
  v_mfma_f32_16x16x32_bf16 a[68:71], a[40:43], a[180:183], a[68:71]
  v_add_u32 v24, 1, v17
  v_mfma_f32_16x16x32_bf16 a[84:87], a[44:47], a[180:183], a[84:87]
  v_mul_u32_u24 v248, 1280, v17
  v_mfma_f32_16x16x32_bf16 a[100:103], a[48:51], a[180:183], a[100:103]
  v_mfma_f32_16x16x32_bf16 a[116:119], a[52:55], a[180:183], a[116:119]
  v_mfma_f32_16x16x32_bf16 a[132:135], a[56:59], a[180:183], a[132:135]
  s_waitcnt vmcnt(16)
  buffer_load_dwordx4 a[180:183], v2, s[40:43], s65 offen offset:2048 sc1
  v_lshl_add_u32 v248, v18, 4, v248
  v_mfma_f32_16x16x32_bf16 a[72:75], a[40:43], a[184:187], a[72:75]
  v_mfma_f32_16x16x32_bf16 a[88:91], a[44:47], a[184:187], a[88:91]
  v_mfma_f32_16x16x32_bf16 a[104:107], a[48:51], a[184:187], a[104:107]
  buffer_load_dwordx4 a[12:15], v2, s[40:43], s14 offen offset:3072 sc1
  v_mfma_f32_16x16x32_bf16 a[120:123], a[52:55], a[184:187], a[120:123]
  v_add_u32 v248, s26, v248
  v_mfma_f32_16x16x32_bf16 a[136:139], a[56:59], a[184:187], a[136:139]
  buffer_load_dwordx4 a[184:187], v2, s[40:43], s66 offen offset:2048 sc1
  v_lshrrev_b32 v19, 4, v17
  v_mfma_f32_16x16x32_bf16 a[76:79], a[40:43], a[188:191], a[76:79]
  v_mfma_f32_16x16x32_bf16 a[92:95], a[44:47], a[188:191], a[92:95]
  v_mfma_f32_16x16x32_bf16 a[108:111], a[48:51], a[188:191], a[108:111]
  v_mfma_f32_16x16x32_bf16 a[124:127], a[52:55], a[188:191], a[124:127]
  v_mfma_f32_16x16x32_bf16 a[140:143], a[56:59], a[188:191], a[140:143]
  s_waitcnt vmcnt(17)
  buffer_load_dwordx4 a[188:191], v2, s[40:43], s67 offen offset:2048 sc1
  v_mfma_f32_16x16x32_bf16 a[64:67], a[60:63], v[216:219], a[64:67]
  v_mul_u32_u24 v19, 20480, v19
  v_mfma_f32_16x16x32_bf16 a[80:83], a[192:195], v[216:219], a[80:83]
  v_mfma_f32_16x16x32_bf16 a[96:99], a[196:199], v[216:219], a[96:99]
  s_add_u32 s14, s13, 86016
  buffer_load_dwordx4 a[16:19], v2, s[40:43], s14 offen offset:0 sc1
  v_and_b32 v17, 15, v17
  v_mfma_f32_16x16x32_bf16 a[112:115], a[200:203], v[216:219], a[112:115]
  v_mfma_f32_16x16x32_bf16 a[128:131], a[204:207], v[216:219], a[128:131]
  buffer_load_dwordx4 v[216:219], v2, s[40:43], s64 offen offset:3072 sc1
  v_mfma_f32_16x16x32_bf16 a[68:71], a[60:63], v[220:223], a[68:71]
  v_lshl_add_u32 v19, v17, 4, v19
  v_mfma_f32_16x16x32_bf16 a[84:87], a[192:195], v[220:223], a[84:87]
  v_lshl_add_u32 v200, v18, 8, v19
  v_mfma_f32_16x16x32_bf16 a[100:103], a[196:199], v[220:223], a[100:103]
  v_mfma_f32_16x16x32_bf16 a[116:119], a[200:203], v[220:223], a[116:119]
  v_mfma_f32_16x16x32_bf16 a[132:135], a[204:207], v[220:223], a[132:135]
  s_waitcnt vmcnt(18)
  buffer_load_dwordx4 v[220:223], v2, s[40:43], s65 offen offset:3072 sc1
  v_mov_b32 v27, 8
  v_mfma_f32_16x16x32_bf16 a[72:75], a[60:63], v[224:227], a[72:75]
  v_mfma_f32_16x16x32_bf16 a[88:91], a[192:195], v[224:227], a[88:91]
  v_mfma_f32_16x16x32_bf16 a[104:107], a[196:199], v[224:227], a[104:107]
  buffer_load_dwordx4 a[20:23], v2, s[40:43], s14 offen offset:1024 sc1
  v_mfma_f32_16x16x32_bf16 a[120:123], a[200:203], v[224:227], a[120:123]
  v_add_u32 v16, 256, v0
  v_mfma_f32_16x16x32_bf16 a[136:139], a[204:207], v[224:227], a[136:139]
  buffer_load_dwordx4 v[224:227], v2, s[40:43], s66 offen offset:3072 sc1
  v_mul_u32_u24 v17, 6554, v16
  v_mfma_f32_16x16x32_bf16 a[76:79], a[60:63], v[228:231], a[76:79]
  v_mfma_f32_16x16x32_bf16 a[92:95], a[192:195], v[228:231], a[92:95]
  v_mfma_f32_16x16x32_bf16 a[108:111], a[196:199], v[228:231], a[108:111]
  v_mfma_f32_16x16x32_bf16 a[124:127], a[200:203], v[228:231], a[124:127]
  v_mfma_f32_16x16x32_bf16 a[140:143], a[204:207], v[228:231], a[140:143]
  s_waitcnt vmcnt(19)
  buffer_load_dwordx4 v[228:231], v2, s[40:43], s67 offen offset:3072 sc1
  v_mfma_f32_16x16x32_bf16 a[64:67], a[208:211], a[144:147], a[64:67]
  s_add_u32 s62, s62, 4096
  v_lshrrev_b32 v17, 16, v17
  v_mfma_f32_16x16x32_bf16 a[80:83], a[212:215], a[144:147], a[80:83]
  s_and_b32 s62, s62, 0x7fff
  v_mfma_f32_16x16x32_bf16 a[96:99], a[216:219], a[144:147], a[96:99]
  buffer_load_dwordx4 a[24:27], v2, s[40:43], s14 offen offset:2048 sc1
  v_mul_u32_u24 v18, 10, v17
  v_mfma_f32_16x16x32_bf16 a[112:115], a[220:223], a[144:147], a[112:115]
  s_add_u32 s64, s63, s62
  v_mfma_f32_16x16x32_bf16 a[128:131], a[224:227], a[144:147], a[128:131]
  buffer_load_dwordx4 a[144:147], v2, s[40:43], s64 offen offset:0 sc1
  v_mfma_f32_16x16x32_bf16 a[68:71], a[208:211], a[148:151], a[68:71]
  s_add_u32 s65, s64, 131072
  v_sub_u32 v18, v16, v18
  v_mfma_f32_16x16x32_bf16 a[84:87], a[212:215], a[148:151], a[84:87]
  s_add_u32 s66, s64, 262144
  v_mul_u32_u24 v252, 336, v17
  v_mfma_f32_16x16x32_bf16 a[100:103], a[216:219], a[148:151], a[100:103]
  v_mfma_f32_16x16x32_bf16 a[116:119], a[220:223], a[148:151], a[116:119]
  v_mfma_f32_16x16x32_bf16 a[132:135], a[224:227], a[148:151], a[132:135]
  s_waitcnt vmcnt(20)
  buffer_load_dwordx4 a[148:151], v2, s[40:43], s65 offen offset:0 sc1
  v_lshl_add_u32 v252, v18, 5, v252
  v_mfma_f32_16x16x32_bf16 a[72:75], a[208:211], a[152:155], a[72:75]
  s_add_u32 s67, s64, 393216
  v_mfma_f32_16x16x32_bf16 a[88:91], a[212:215], a[152:155], a[88:91]
  v_mfma_f32_16x16x32_bf16 a[104:107], a[216:219], a[152:155], a[104:107]
  v_mfma_f32_16x16x32_bf16 a[120:123], a[220:223], a[152:155], a[120:123]
  v_lshlrev_b32 v204, 5, v18
  v_mfma_f32_16x16x32_bf16 a[136:139], a[224:227], a[152:155], a[136:139]
  buffer_load_dwordx4 a[152:155], v2, s[40:43], s66 offen offset:0 sc1
  v_add_u32 v17, s25, v17
  v_mfma_f32_16x16x32_bf16 a[76:79], a[208:211], a[156:159], a[76:79]
  v_mfma_f32_16x16x32_bf16 a[92:95], a[212:215], a[156:159], a[92:95]
  v_mfma_f32_16x16x32_bf16 a[108:111], a[216:219], a[156:159], a[108:111]
  v_mfma_f32_16x16x32_bf16 a[124:127], a[220:223], a[156:159], a[124:127]
  v_mfma_f32_16x16x32_bf16 a[140:143], a[224:227], a[156:159], a[140:143]
  s_waitcnt vmcnt(19)
  buffer_load_dwordx4 a[156:159], v2, s[40:43], s67 offen offset:0 sc1
  v_mfma_f32_16x16x32_bf16 a[64:67], a[228:231], a[160:163], a[64:67]
  v_add_u32 v25, 1, v17
  v_mfma_f32_16x16x32_bf16 a[80:83], a[232:235], a[160:163], a[80:83]
  v_mfma_f32_16x16x32_bf16 a[96:99], a[236:239], a[160:163], a[96:99]
  buffer_load_dwordx4 a[28:31], v2, s[40:43], s14 offen offset:3072 sc1
  v_mul_u32_u24 v249, 1280, v17
  v_mfma_f32_16x16x32_bf16 a[112:115], a[240:243], a[160:163], a[112:115]
  v_mfma_f32_16x16x32_bf16 a[128:131], a[244:247], a[160:163], a[128:131]
  buffer_load_dwordx4 a[160:163], v2, s[40:43], s64 offen offset:1024 sc1
  v_mfma_f32_16x16x32_bf16 a[68:71], a[228:231], a[164:167], a[68:71]
  v_lshl_add_u32 v249, v18, 4, v249
  v_mfma_f32_16x16x32_bf16 a[84:87], a[232:235], a[164:167], a[84:87]
  v_add_u32 v249, s26, v249
  v_mfma_f32_16x16x32_bf16 a[100:103], a[236:239], a[164:167], a[100:103]
  v_mfma_f32_16x16x32_bf16 a[116:119], a[240:243], a[164:167], a[116:119]
  v_mfma_f32_16x16x32_bf16 a[132:135], a[244:247], a[164:167], a[132:135]
  s_waitcnt vmcnt(19)
  buffer_load_dwordx4 a[164:167], v2, s[40:43], s65 offen offset:1024 sc1
  v_lshrrev_b32 v19, 4, v17
  v_mfma_f32_16x16x32_bf16 a[72:75], a[228:231], a[168:171], a[72:75]
  v_mfma_f32_16x16x32_bf16 a[88:91], a[232:235], a[168:171], a[88:91]
  v_mfma_f32_16x16x32_bf16 a[104:107], a[236:239], a[168:171], a[104:107]
  s_add_u32 s14, s13, 90112
  buffer_load_dwordx4 a[32:35], v2, s[40:43], s14 offen offset:0 sc1
  v_mfma_f32_16x16x32_bf16 a[120:123], a[240:243], a[168:171], a[120:123]
  v_mul_u32_u24 v19, 20480, v19
  v_mfma_f32_16x16x32_bf16 a[136:139], a[244:247], a[168:171], a[136:139]
  buffer_load_dwordx4 a[168:171], v2, s[40:43], s66 offen offset:1024 sc1
  v_and_b32 v17, 15, v17
  v_mfma_f32_16x16x32_bf16 a[76:79], a[228:231], a[172:175], a[76:79]
  v_mfma_f32_16x16x32_bf16 a[92:95], a[232:235], a[172:175], a[92:95]
  v_mfma_f32_16x16x32_bf16 a[108:111], a[236:239], a[172:175], a[108:111]
  v_mfma_f32_16x16x32_bf16 a[124:127], a[240:243], a[172:175], a[124:127]
  v_mfma_f32_16x16x32_bf16 a[140:143], a[244:247], a[172:175], a[140:143]
  s_waitcnt vmcnt(19)
  buffer_load_dwordx4 a[172:175], v2, s[40:43], s67 offen offset:1024 sc1
  v_mfma_f32_16x16x32_bf16 a[64:67], a[248:251], a[176:179], a[64:67]
  v_lshl_add_u32 v19, v17, 4, v19
  v_mfma_f32_16x16x32_bf16 a[80:83], a[252:255], a[176:179], a[80:83]
  v_mfma_f32_16x16x32_bf16 a[96:99], v[32:35], a[176:179], a[96:99]
  buffer_load_dwordx4 a[36:39], v2, s[40:43], s14 offen offset:1024 sc1
  v_lshl_add_u32 v201, v18, 8, v19
  v_mfma_f32_16x16x32_bf16 a[112:115], v[36:39], a[176:179], a[112:115]
  v_mfma_f32_16x16x32_bf16 a[128:131], v[40:43], a[176:179], a[128:131]
  buffer_load_dwordx4 a[176:179], v2, s[40:43], s64 offen offset:2048 sc1
  v_mfma_f32_16x16x32_bf16 a[68:71], a[248:251], a[180:183], a[68:71]
  v_mov_b32 v28, 8
  v_mfma_f32_16x16x32_bf16 a[84:87], a[252:255], a[180:183], a[84:87]
  v_add_u32 v16, 512, v0
  v_mfma_f32_16x16x32_bf16 a[100:103], v[32:35], a[180:183], a[100:103]
  v_mfma_f32_16x16x32_bf16 a[116:119], v[36:39], a[180:183], a[116:119]
  v_mfma_f32_16x16x32_bf16 a[132:135], v[40:43], a[180:183], a[132:135]
  s_waitcnt vmcnt(19)
  buffer_load_dwordx4 a[180:183], v2, s[40:43], s65 offen offset:2048 sc1
  v_mul_u32_u24 v17, 6554, v16
  v_mfma_f32_16x16x32_bf16 a[72:75], a[248:251], a[184:187], a[72:75]
  v_mfma_f32_16x16x32_bf16 a[88:91], a[252:255], a[184:187], a[88:91]
  v_mfma_f32_16x16x32_bf16 a[104:107], v[32:35], a[184:187], a[104:107]
  buffer_load_dwordx4 a[40:43], v2, s[40:43], s14 offen offset:2048 sc1
  v_mfma_f32_16x16x32_bf16 a[120:123], v[36:39], a[184:187], a[120:123]
  v_lshrrev_b32 v17, 16, v17
  v_mfma_f32_16x16x32_bf16 a[136:139], v[40:43], a[184:187], a[136:139]
  buffer_load_dwordx4 a[184:187], v2, s[40:43], s66 offen offset:2048 sc1
  v_mul_u32_u24 v18, 10, v17
  v_mfma_f32_16x16x32_bf16 a[76:79], a[248:251], a[188:191], a[76:79]
  v_mfma_f32_16x16x32_bf16 a[92:95], a[252:255], a[188:191], a[92:95]
  v_mfma_f32_16x16x32_bf16 a[108:111], v[32:35], a[188:191], a[108:111]
  v_mfma_f32_16x16x32_bf16 a[124:127], v[36:39], a[188:191], a[124:127]
  v_mfma_f32_16x16x32_bf16 a[140:143], v[40:43], a[188:191], a[140:143]
  s_waitcnt vmcnt(19)
  buffer_load_dwordx4 a[188:191], v2, s[40:43], s67 offen offset:2048 sc1
  v_mfma_f32_16x16x32_bf16 a[64:67], v[44:47], v[216:219], a[64:67]
  v_sub_u32 v18, v16, v18
  v_mfma_f32_16x16x32_bf16 a[80:83], v[48:51], v[216:219], a[80:83]
  v_mfma_f32_16x16x32_bf16 a[96:99], v[52:55], v[216:219], a[96:99]
  buffer_load_dwordx4 a[44:47], v2, s[40:43], s14 offen offset:3072 sc1
  v_mul_u32_u24 v253, 336, v17
  v_mfma_f32_16x16x32_bf16 a[112:115], v[56:59], v[216:219], a[112:115]
  v_mfma_f32_16x16x32_bf16 a[128:131], v[60:63], v[216:219], a[128:131]
  buffer_load_dwordx4 v[216:219], v2, s[40:43], s64 offen offset:3072 sc1
  v_mfma_f32_16x16x32_bf16 a[68:71], v[44:47], v[220:223], a[68:71]
  v_lshl_add_u32 v253, v18, 5, v253
  v_mfma_f32_16x16x32_bf16 a[84:87], v[48:51], v[220:223], a[84:87]
  v_lshlrev_b32 v205, 5, v18
  v_mfma_f32_16x16x32_bf16 a[100:103], v[52:55], v[220:223], a[100:103]
  v_mfma_f32_16x16x32_bf16 a[116:119], v[56:59], v[220:223], a[116:119]
  v_mfma_f32_16x16x32_bf16 a[132:135], v[60:63], v[220:223], a[132:135]
  s_waitcnt vmcnt(19)
  buffer_load_dwordx4 v[220:223], v2, s[40:43], s65 offen offset:3072 sc1
  v_add_u32 v17, s25, v17
  v_mfma_f32_16x16x32_bf16 a[72:75], v[44:47], v[224:227], a[72:75]
  v_mfma_f32_16x16x32_bf16 a[88:91], v[48:51], v[224:227], a[88:91]
  v_mfma_f32_16x16x32_bf16 a[104:107], v[52:55], v[224:227], a[104:107]
  v_mfma_f32_16x16x32_bf16 a[120:123], v[56:59], v[224:227], a[120:123]
  v_add_u32 v26, 1, v17
  v_mfma_f32_16x16x32_bf16 a[136:139], v[60:63], v[224:227], a[136:139]
  buffer_load_dwordx4 v[224:227], v2, s[40:43], s66 offen offset:3072 sc1
  v_mul_u32_u24 v250, 1280, v17
  v_mfma_f32_16x16x32_bf16 a[76:79], v[44:47], v[228:231], a[76:79]
  v_mfma_f32_16x16x32_bf16 a[92:95], v[48:51], v[228:231], a[92:95]
  v_mfma_f32_16x16x32_bf16 a[108:111], v[52:55], v[228:231], a[108:111]
  v_mfma_f32_16x16x32_bf16 a[124:127], v[56:59], v[228:231], a[124:127]
  v_mfma_f32_16x16x32_bf16 a[140:143], v[60:63], v[228:231], a[140:143]
  s_waitcnt vmcnt(18)
  buffer_load_dwordx4 v[228:231], v2, s[40:43], s67 offen offset:3072 sc1
  v_mfma_f32_16x16x32_bf16 a[64:67], v[96:99], a[144:147], a[64:67]
  s_add_u32 s62, s62, 4096
  v_lshl_add_u32 v250, v18, 4, v250
  v_mfma_f32_16x16x32_bf16 a[80:83], v[100:103], a[144:147], a[80:83]
  s_and_b32 s62, s62, 0x7fff
  v_mfma_f32_16x16x32_bf16 a[96:99], v[104:107], a[144:147], a[96:99]
  s_add_u32 s14, s13, 94208
  buffer_load_dwordx4 a[48:51], v2, s[40:43], s14 offen offset:0 sc1
  v_add_u32 v250, s26, v250
  v_mfma_f32_16x16x32_bf16 a[112:115], v[108:111], a[144:147], a[112:115]
  s_add_u32 s64, s63, s62
  v_mfma_f32_16x16x32_bf16 a[128:131], v[112:115], a[144:147], a[128:131]
  buffer_load_dwordx4 a[144:147], v2, s[40:43], s64 offen offset:0 sc1
  v_mfma_f32_16x16x32_bf16 a[68:71], v[96:99], a[148:151], a[68:71]
  s_add_u32 s65, s64, 131072
  v_lshrrev_b32 v19, 4, v17
  v_mfma_f32_16x16x32_bf16 a[84:87], v[100:103], a[148:151], a[84:87]
  s_add_u32 s66, s64, 262144
  v_mul_u32_u24 v19, 20480, v19
  v_mfma_f32_16x16x32_bf16 a[100:103], v[104:107], a[148:151], a[100:103]
  v_mfma_f32_16x16x32_bf16 a[116:119], v[108:111], a[148:151], a[116:119]
  v_mfma_f32_16x16x32_bf16 a[132:135], v[112:115], a[148:151], a[132:135]
  s_waitcnt vmcnt(19)
  buffer_load_dwordx4 a[148:151], v2, s[40:43], s65 offen offset:0 sc1
  v_and_b32 v17, 15, v17
  v_mfma_f32_16x16x32_bf16 a[72:75], v[96:99], a[152:155], a[72:75]
  s_add_u32 s67, s64, 393216
  v_mfma_f32_16x16x32_bf16 a[88:91], v[100:103], a[152:155], a[88:91]
  v_mfma_f32_16x16x32_bf16 a[104:107], v[104:107], a[152:155], a[104:107]
  buffer_load_dwordx4 a[52:55], v2, s[40:43], s14 offen offset:1024 sc1
  v_mfma_f32_16x16x32_bf16 a[120:123], v[108:111], a[152:155], a[120:123]
  v_lshl_add_u32 v19, v17, 4, v19
  v_mfma_f32_16x16x32_bf16 a[136:139], v[112:115], a[152:155], a[136:139]
  buffer_load_dwordx4 a[152:155], v2, s[40:43], s66 offen offset:0 sc1
  v_lshl_add_u32 v202, v18, 8, v19
  v_mfma_f32_16x16x32_bf16 a[76:79], v[96:99], a[156:159], a[76:79]
  v_mfma_f32_16x16x32_bf16 a[92:95], v[100:103], a[156:159], a[92:95]
  v_mfma_f32_16x16x32_bf16 a[108:111], v[104:107], a[156:159], a[108:111]
  v_mfma_f32_16x16x32_bf16 a[124:127], v[108:111], a[156:159], a[124:127]
  v_mfma_f32_16x16x32_bf16 a[140:143], v[112:115], a[156:159], a[140:143]
  s_waitcnt vmcnt(19)
  buffer_load_dwordx4 a[156:159], v2, s[40:43], s67 offen offset:0 sc1
  v_mfma_f32_16x16x32_bf16 a[64:67], v[116:119], a[160:163], a[64:67]
  v_mov_b32 v29, 8
  v_mfma_f32_16x16x32_bf16 a[80:83], v[120:123], a[160:163], a[80:83]
  v_mfma_f32_16x16x32_bf16 a[96:99], v[124:127], a[160:163], a[96:99]
  buffer_load_dwordx4 a[56:59], v2, s[40:43], s14 offen offset:2048 sc1
  v_cmp_gt_u32 vcc, 128, v0
  v_mfma_f32_16x16x32_bf16 a[112:115], v[160:163], a[160:163], a[112:115]
  v_mfma_f32_16x16x32_bf16 a[128:131], v[164:167], a[160:163], a[128:131]
  buffer_load_dwordx4 a[160:163], v2, s[40:43], s64 offen offset:1024 sc1
  v_mfma_f32_16x16x32_bf16 a[68:71], v[116:119], a[164:167], a[68:71]
  v_mov_b32 v16, 1073741824
  v_mfma_f32_16x16x32_bf16 a[84:87], v[120:123], a[164:167], a[84:87]
  v_mov_b32 v17, 0
  v_mfma_f32_16x16x32_bf16 a[100:103], v[124:127], a[164:167], a[100:103]
  v_mfma_f32_16x16x32_bf16 a[116:119], v[160:163], a[164:167], a[116:119]
  v_mfma_f32_16x16x32_bf16 a[132:135], v[164:167], a[164:167], a[132:135]
  s_waitcnt vmcnt(19)
  buffer_load_dwordx4 a[164:167], v2, s[40:43], s65 offen offset:1024 sc1
  v_cndmask_b32 v250, v16, v250, vcc
  v_mfma_f32_16x16x32_bf16 a[72:75], v[116:119], a[168:171], a[72:75]
  v_mfma_f32_16x16x32_bf16 a[88:91], v[120:123], a[168:171], a[88:91]
  v_mfma_f32_16x16x32_bf16 a[104:107], v[124:127], a[168:171], a[104:107]
  buffer_load_dwordx4 a[60:63], v2, s[40:43], s14 offen offset:3072 sc1
  v_mfma_f32_16x16x32_bf16 a[120:123], v[160:163], a[168:171], a[120:123]
  v_cndmask_b32 v202, v16, v202, vcc
  v_mfma_f32_16x16x32_bf16 a[136:139], v[164:167], a[168:171], a[136:139]
  buffer_load_dwordx4 a[168:171], v2, s[40:43], s66 offen offset:1024 sc1
  v_cndmask_b32 v253, v17, v253, vcc
  v_mfma_f32_16x16x32_bf16 a[76:79], v[116:119], a[172:175], a[76:79]
  v_mfma_f32_16x16x32_bf16 a[92:95], v[120:123], a[172:175], a[92:95]
  v_mfma_f32_16x16x32_bf16 a[108:111], v[124:127], a[172:175], a[108:111]
  v_mfma_f32_16x16x32_bf16 a[124:127], v[160:163], a[172:175], a[124:127]
  v_mfma_f32_16x16x32_bf16 a[140:143], v[164:167], a[172:175], a[140:143]
  s_waitcnt vmcnt(19)
  buffer_load_dwordx4 a[172:175], v2, s[40:43], s67 offen offset:1024 sc1
  v_mfma_f32_16x16x32_bf16 a[64:67], v[168:171], a[176:179], a[64:67]
  v_readlane_b32 s68, v15, 0
  v_mfma_f32_16x16x32_bf16 a[80:83], v[172:175], a[176:179], a[80:83]
  v_mfma_f32_16x16x32_bf16 a[96:99], v[192:195], a[176:179], a[96:99]
  s_add_u32 s14, s13, 106496
  buffer_load_dwordx4 a[224:227], v2, s[40:43], s14 offen offset:0 sc1
  v_readlane_b32 s69, v15, 1
  v_mfma_f32_16x16x32_bf16 a[112:115], v[196:199], a[176:179], a[112:115]
  v_mfma_f32_16x16x32_bf16 a[128:131], v[208:211], a[176:179], a[128:131]
  buffer_load_dwordx4 a[176:179], v2, s[40:43], s64 offen offset:2048 sc1
  v_mfma_f32_16x16x32_bf16 a[68:71], v[168:171], a[180:183], a[68:71]
  v_readlane_b32 s70, v15, 2
  v_mfma_f32_16x16x32_bf16 a[84:87], v[172:175], a[180:183], a[84:87]
  v_readlane_b32 s71, v15, 3
  v_mfma_f32_16x16x32_bf16 a[100:103], v[192:195], a[180:183], a[100:103]
  v_mfma_f32_16x16x32_bf16 a[116:119], v[196:199], a[180:183], a[116:119]
  v_mfma_f32_16x16x32_bf16 a[132:135], v[208:211], a[180:183], a[132:135]
  s_waitcnt vmcnt(19)
  buffer_load_dwordx4 a[180:183], v2, s[40:43], s65 offen offset:2048 sc1
  v_readlane_b32 s72, v15, 4
  v_mfma_f32_16x16x32_bf16 a[72:75], v[168:171], a[184:187], a[72:75]
  v_mfma_f32_16x16x32_bf16 a[88:91], v[172:175], a[184:187], a[88:91]
  v_mfma_f32_16x16x32_bf16 a[104:107], v[192:195], a[184:187], a[104:107]
  v_mfma_f32_16x16x32_bf16 a[120:123], v[196:199], a[184:187], a[120:123]
  v_readlane_b32 s73, v15, 5
  v_mfma_f32_16x16x32_bf16 a[136:139], v[208:211], a[184:187], a[136:139]
  buffer_load_dwordx4 a[184:187], v2, s[40:43], s66 offen offset:2048 sc1
  v_readlane_b32 s74, v15, 6
  v_mfma_f32_16x16x32_bf16 a[76:79], v[168:171], a[188:191], a[76:79]
  v_mfma_f32_16x16x32_bf16 a[92:95], v[172:175], a[188:191], a[92:95]
  v_mfma_f32_16x16x32_bf16 a[108:111], v[192:195], a[188:191], a[108:111]
  v_mfma_f32_16x16x32_bf16 a[124:127], v[196:199], a[188:191], a[124:127]
  v_mfma_f32_16x16x32_bf16 a[140:143], v[208:211], a[188:191], a[140:143]
  s_waitcnt vmcnt(18)
  buffer_load_dwordx4 a[188:191], v2, s[40:43], s67 offen offset:2048 sc1
  v_mfma_f32_16x16x32_bf16 a[64:67], v[212:215], v[216:219], a[64:67]
  v_readlane_b32 s75, v15, 7
  v_mfma_f32_16x16x32_bf16 a[80:83], v[232:235], v[216:219], a[80:83]
  v_mfma_f32_16x16x32_bf16 a[96:99], v[236:239], v[216:219], a[96:99]
  buffer_load_dwordx4 a[228:231], v2, s[40:43], s14 offen offset:1024 sc1
  v_cmp_eq_u32 s[52:53], s68, v24
  v_mfma_f32_16x16x32_bf16 a[112:115], v[240:243], v[216:219], a[112:115]
  v_mfma_f32_16x16x32_bf16 a[128:131], v[244:247], v[216:219], a[128:131]
  buffer_load_dwordx4 v[216:219], v2, s[40:43], s64 offen offset:3072 sc1
  v_mfma_f32_16x16x32_bf16 a[68:71], v[212:215], v[220:223], a[68:71]
  v_cmp_eq_u32 s[54:55], s68, v25
  v_mfma_f32_16x16x32_bf16 a[84:87], v[232:235], v[220:223], a[84:87]
  v_cmp_eq_u32 s[56:57], s68, v26
  v_mfma_f32_16x16x32_bf16 a[100:103], v[236:239], v[220:223], a[100:103]
  v_mfma_f32_16x16x32_bf16 a[116:119], v[240:243], v[220:223], a[116:119]
  v_mfma_f32_16x16x32_bf16 a[132:135], v[244:247], v[220:223], a[132:135]
  s_waitcnt vmcnt(19)
  buffer_load_dwordx4 v[220:223], v2, s[40:43], s65 offen offset:3072 sc1
  v_cndmask_b32 v27, v27, 0, s[52:53]
  v_mfma_f32_16x16x32_bf16 a[72:75], v[212:215], v[224:227], a[72:75]
  v_mfma_f32_16x16x32_bf16 a[88:91], v[232:235], v[224:227], a[88:91]
  v_mfma_f32_16x16x32_bf16 a[104:107], v[236:239], v[224:227], a[104:107]
  buffer_load_dwordx4 a[232:235], v2, s[40:43], s14 offen offset:2048 sc1
  v_mfma_f32_16x16x32_bf16 a[120:123], v[240:243], v[224:227], a[120:123]
  v_cndmask_b32 v28, v28, 0, s[54:55]
  v_mfma_f32_16x16x32_bf16 a[136:139], v[244:247], v[224:227], a[136:139]
  buffer_load_dwordx4 v[224:227], v2, s[40:43], s66 offen offset:3072 sc1
  v_cndmask_b32 v29, v29, 0, s[56:57]
  v_mfma_f32_16x16x32_bf16 a[76:79], v[212:215], v[228:231], a[76:79]
  v_mfma_f32_16x16x32_bf16 a[92:95], v[232:235], v[228:231], a[92:95]
  v_mfma_f32_16x16x32_bf16 a[108:111], v[236:239], v[228:231], a[108:111]
  v_mfma_f32_16x16x32_bf16 a[124:127], v[240:243], v[228:231], a[124:127]
  v_mfma_f32_16x16x32_bf16 a[140:143], v[244:247], v[228:231], a[140:143]
  s_waitcnt vmcnt(19)
  buffer_load_dwordx4 v[228:231], v2, s[40:43], s67 offen offset:3072 sc1
  v_mfma_f32_16x16x32_bf16 a[64:67], v[64:67], a[144:147], a[64:67]
  s_add_u32 s62, s62, 4096
  v_cmp_eq_u32 s[52:53], s69, v24
  v_mfma_f32_16x16x32_bf16 a[80:83], v[68:71], a[144:147], a[80:83]
  s_and_b32 s62, s62, 0x7fff
  v_mfma_f32_16x16x32_bf16 a[96:99], v[72:75], a[144:147], a[96:99]
  buffer_load_dwordx4 a[236:239], v2, s[40:43], s14 offen offset:3072 sc1
  v_cmp_eq_u32 s[54:55], s69, v25
  v_mfma_f32_16x16x32_bf16 a[112:115], v[76:79], a[144:147], a[112:115]
  s_add_u32 s64, s63, s62
  v_mfma_f32_16x16x32_bf16 a[128:131], v[80:83], a[144:147], a[128:131]
  buffer_load_dwordx4 a[144:147], v2, s[40:43], s64 offen offset:0 sc1
  v_mfma_f32_16x16x32_bf16 a[68:71], v[64:67], a[148:151], a[68:71]
  s_add_u32 s65, s64, 131072
  v_cmp_eq_u32 s[56:57], s69, v26
  v_mfma_f32_16x16x32_bf16 a[84:87], v[68:71], a[148:151], a[84:87]
  s_add_u32 s66, s64, 262144
  v_cndmask_b32 v27, v27, 1, s[52:53]
  v_mfma_f32_16x16x32_bf16 a[100:103], v[72:75], a[148:151], a[100:103]
  v_mfma_f32_16x16x32_bf16 a[116:119], v[76:79], a[148:151], a[116:119]
  v_mfma_f32_16x16x32_bf16 a[132:135], v[80:83], a[148:151], a[132:135]
  s_waitcnt vmcnt(19)
  buffer_load_dwordx4 a[148:151], v2, s[40:43], s65 offen offset:0 sc1
  v_cndmask_b32 v28, v28, 1, s[54:55]
  v_mfma_f32_16x16x32_bf16 a[72:75], v[64:67], a[152:155], a[72:75]
  s_add_u32 s67, s64, 393216
  v_add_u32 v11, s33, v2
  v_mfma_f32_16x16x32_bf16 a[88:91], v[68:71], a[152:155], a[88:91]
  ds_read_b128 a[192:195], v11 offset:0
  v_mfma_f32_16x16x32_bf16 a[104:107], v[72:75], a[152:155], a[104:107]
  s_add_u32 s14, s13, 110592
  buffer_load_dwordx4 a[240:243], v2, s[40:43], s14 offen offset:0 sc1
  v_mfma_f32_16x16x32_bf16 a[120:123], v[76:79], a[152:155], a[120:123]
  s_add_u32 s33, s33, 32768
  ds_read_b128 a[196:199], v11 offset:1024
  v_cndmask_b32 v29, v29, 1, s[56:57]
  v_mfma_f32_16x16x32_bf16 a[136:139], v[80:83], a[152:155], a[136:139]
  buffer_load_dwordx4 a[152:155], v2, s[40:43], s66 offen offset:0 sc1
  v_cmp_eq_u32 s[52:53], s70, v24
  v_mfma_f32_16x16x32_bf16 a[76:79], v[64:67], a[156:159], a[76:79]
  s_and_b32 s33, s33, 0x1ffff
  v_mfma_f32_16x16x32_bf16 a[92:95], v[68:71], a[156:159], a[92:95]
  ds_read_b128 a[200:203], v11 offset:2048
  v_mfma_f32_16x16x32_bf16 a[108:111], v[72:75], a[156:159], a[108:111]
  ds_read_b128 a[204:207], v11 offset:3072
  v_mfma_f32_16x16x32_bf16 a[124:127], v[76:79], a[156:159], a[124:127]
  v_mfma_f32_16x16x32_bf16 a[140:143], v[80:83], a[156:159], a[140:143]
  s_waitcnt vmcnt(19)
  buffer_load_dwordx4 a[156:159], v2, s[40:43], s67 offen offset:0 sc1
  v_mfma_f32_16x16x32_bf16 a[64:67], v[84:87], a[160:163], a[64:67]
  v_cmp_eq_u32 s[54:55], s70, v25
  v_mfma_f32_16x16x32_bf16 a[80:83], v[88:91], a[160:163], a[80:83]
  v_mfma_f32_16x16x32_bf16 a[96:99], v[92:95], a[160:163], a[96:99]
  buffer_load_dwordx4 a[244:247], v2, s[40:43], s14 offen offset:1024 sc1
  v_cmp_eq_u32 s[56:57], s70, v26
  v_mfma_f32_16x16x32_bf16 a[112:115], v[128:131], a[160:163], a[112:115]
  v_mfma_f32_16x16x32_bf16 a[128:131], v[132:135], a[160:163], a[128:131]
  buffer_load_dwordx4 a[160:163], v2, s[40:43], s64 offen offset:1024 sc1
  v_mfma_f32_16x16x32_bf16 a[68:71], v[84:87], a[164:167], a[68:71]
  v_cndmask_b32 v27, v27, 2, s[52:53]
  v_mfma_f32_16x16x32_bf16 a[84:87], v[88:91], a[164:167], a[84:87]
  v_cndmask_b32 v28, v28, 2, s[54:55]
  v_mfma_f32_16x16x32_bf16 a[100:103], v[92:95], a[164:167], a[100:103]
  v_mfma_f32_16x16x32_bf16 a[116:119], v[128:131], a[164:167], a[116:119]
  s_waitcnt lgkmcnt(0)
  v_mfma_f32_16x16x32_bf16 a[132:135], v[132:135], a[164:167], a[132:135]
  s_waitcnt vmcnt(19)
  buffer_load_dwordx4 a[164:167], v2, s[40:43], s65 offen offset:1024 sc1
  v_cndmask_b32 v29, v29, 2, s[56:57]
  v_mfma_f32_16x16x32_bf16 a[72:75], v[84:87], a[168:171], a[72:75]
  v_add_u32 v11, s34, v2
  v_mfma_f32_16x16x32_bf16 a[88:91], v[88:91], a[168:171], a[88:91]
  ds_read_b128 a[208:211], v11 offset:0
  v_mfma_f32_16x16x32_bf16 a[104:107], v[92:95], a[168:171], a[104:107]
  v_mfma_f32_16x16x32_bf16 a[120:123], v[128:131], a[168:171], a[120:123]
  s_add_u32 s34, s34, 32768
  ds_read_b128 a[212:215], v11 offset:1024
  v_cmp_eq_u32 s[52:53], s71, v24
  v_mfma_f32_16x16x32_bf16 a[136:139], v[132:135], a[168:171], a[136:139]
  buffer_load_dwordx4 a[168:171], v2, s[40:43], s66 offen offset:1024 sc1
  v_cmp_eq_u32 s[54:55], s71, v25
  v_mfma_f32_16x16x32_bf16 a[76:79], v[84:87], a[172:175], a[76:79]
  s_and_b32 s34, s34, 0x1ffff
  v_mfma_f32_16x16x32_bf16 a[92:95], v[88:91], a[172:175], a[92:95]
  ds_read_b128 a[216:219], v11 offset:2048
  v_mfma_f32_16x16x32_bf16 a[108:111], v[92:95], a[172:175], a[108:111]
  ds_read_b128 a[220:223], v11 offset:3072
  v_mfma_f32_16x16x32_bf16 a[124:127], v[128:131], a[172:175], a[124:127]
  v_mfma_f32_16x16x32_bf16 a[140:143], v[132:135], a[172:175], a[140:143]
  s_waitcnt vmcnt(18)
  buffer_load_dwordx4 a[172:175], v2, s[40:43], s67 offen offset:1024 sc1
  v_mfma_f32_16x16x32_bf16 a[64:67], v[136:139], a[176:179], a[64:67]
  v_cmp_eq_u32 s[56:57], s71, v26
  v_mfma_f32_16x16x32_bf16 a[80:83], v[140:143], a[176:179], a[80:83]
  v_mfma_f32_16x16x32_bf16 a[96:99], v[144:147], a[176:179], a[96:99]
  buffer_load_dwordx4 a[248:251], v2, s[40:43], s14 offen offset:2048 sc1
  v_cndmask_b32 v27, v27, 3, s[52:53]
  v_mfma_f32_16x16x32_bf16 a[112:115], v[148:151], a[176:179], a[112:115]
  v_mfma_f32_16x16x32_bf16 a[128:131], v[152:155], a[176:179], a[128:131]
  buffer_load_dwordx4 a[176:179], v2, s[40:43], s64 offen offset:2048 sc1
  v_mfma_f32_16x16x32_bf16 a[68:71], v[136:139], a[180:183], a[68:71]
  v_cndmask_b32 v28, v28, 3, s[54:55]
  v_mfma_f32_16x16x32_bf16 a[84:87], v[140:143], a[180:183], a[84:87]
  v_cndmask_b32 v29, v29, 3, s[56:57]
  v_mfma_f32_16x16x32_bf16 a[100:103], v[144:147], a[180:183], a[100:103]
  v_mfma_f32_16x16x32_bf16 a[116:119], v[148:151], a[180:183], a[116:119]
  s_waitcnt lgkmcnt(0)
  v_mfma_f32_16x16x32_bf16 a[132:135], v[152:155], a[180:183], a[132:135]
  s_waitcnt vmcnt(19)
  buffer_load_dwordx4 a[180:183], v2, s[40:43], s65 offen offset:2048 sc1
  v_cmp_eq_u32 s[52:53], s72, v24
  v_mfma_f32_16x16x32_bf16 a[72:75], v[136:139], a[184:187], a[72:75]
  v_add_u32 v11, s33, v2
  v_mfma_f32_16x16x32_bf16 a[88:91], v[140:143], a[184:187], a[88:91]
  ds_read_b128 v[32:35], v11 offset:0
  v_mfma_f32_16x16x32_bf16 a[104:107], v[144:147], a[184:187], a[104:107]
  buffer_load_dwordx4 a[252:255], v2, s[40:43], s14 offen offset:3072 sc1
  v_mfma_f32_16x16x32_bf16 a[120:123], v[148:151], a[184:187], a[120:123]
  s_add_u32 s33, s33, 32768
  ds_read_b128 v[36:39], v11 offset:1024
  v_cmp_eq_u32 s[54:55], s72, v25
  v_mfma_f32_16x16x32_bf16 a[136:139], v[152:155], a[184:187], a[136:139]
  buffer_load_dwordx4 a[184:187], v2, s[40:43], s66 offen offset:2048 sc1
  v_cmp_eq_u32 s[56:57], s72, v26
  v_mfma_f32_16x16x32_bf16 a[76:79], v[136:139], a[188:191], a[76:79]
  s_and_b32 s33, s33, 0x1ffff
  v_mfma_f32_16x16x32_bf16 a[92:95], v[140:143], a[188:191], a[92:95]
  ds_read_b128 v[40:43], v11 offset:2048
  v_mfma_f32_16x16x32_bf16 a[108:111], v[144:147], a[188:191], a[108:111]
  ds_read_b128 v[44:47], v11 offset:3072
  v_mfma_f32_16x16x32_bf16 a[124:127], v[148:151], a[188:191], a[124:127]
  v_mfma_f32_16x16x32_bf16 a[140:143], v[152:155], a[188:191], a[140:143]
  s_waitcnt vmcnt(19)
  buffer_load_dwordx4 a[188:191], v2, s[40:43], s67 offen offset:2048 sc1
  v_mfma_f32_16x16x32_bf16 a[64:67], v[156:159], v[216:219], a[64:67]
  v_cndmask_b32 v27, v27, 4, s[52:53]
  v_mfma_f32_16x16x32_bf16 a[80:83], v[176:179], v[216:219], a[80:83]
  v_mfma_f32_16x16x32_bf16 a[96:99], v[180:183], v[216:219], a[96:99]
  s_add_u32 s14, s13, 122880
  buffer_load_dwordx4 v[96:99], v2, s[40:43], s14 offen offset:0 sc1
  v_cndmask_b32 v28, v28, 4, s[54:55]
  v_mfma_f32_16x16x32_bf16 a[112:115], v[184:187], v[216:219], a[112:115]
  v_mfma_f32_16x16x32_bf16 a[128:131], v[188:191], v[216:219], a[128:131]
  buffer_load_dwordx4 v[216:219], v2, s[40:43], s64 offen offset:3072 sc1
  v_mfma_f32_16x16x32_bf16 a[68:71], v[156:159], v[220:223], a[68:71]
  v_cndmask_b32 v29, v29, 4, s[56:57]
  v_mfma_f32_16x16x32_bf16 a[84:87], v[176:179], v[220:223], a[84:87]
  v_cmp_eq_u32 s[52:53], s73, v24
  v_mfma_f32_16x16x32_bf16 a[100:103], v[180:183], v[220:223], a[100:103]
  v_mfma_f32_16x16x32_bf16 a[116:119], v[184:187], v[220:223], a[116:119]
  s_waitcnt lgkmcnt(0)
  v_mfma_f32_16x16x32_bf16 a[132:135], v[188:191], v[220:223], a[132:135]
  s_waitcnt vmcnt(19)
  buffer_load_dwordx4 v[220:223], v2, s[40:43], s65 offen offset:3072 sc1
  v_cmp_eq_u32 s[54:55], s73, v25
  v_mfma_f32_16x16x32_bf16 a[72:75], v[156:159], v[224:227], a[72:75]
  v_add_u32 v11, s34, v2
  v_mfma_f32_16x16x32_bf16 a[88:91], v[176:179], v[224:227], a[88:91]
  ds_read_b128 v[48:51], v11 offset:0
  v_mfma_f32_16x16x32_bf16 a[104:107], v[180:183], v[224:227], a[104:107]
  buffer_load_dwordx4 v[100:103], v2, s[40:43], s14 offen offset:1024 sc1
  v_mfma_f32_16x16x32_bf16 a[120:123], v[184:187], v[224:227], a[120:123]
  s_add_u32 s34, s34, 32768
  ds_read_b128 v[52:55], v11 offset:1024
  v_cmp_eq_u32 s[56:57], s73, v26
  v_mfma_f32_16x16x32_bf16 a[136:139], v[188:191], v[224:227], a[136:139]
  buffer_load_dwordx4 v[224:227], v2, s[40:43], s66 offen offset:3072 sc1
  v_cndmask_b32 v27, v27, 5, s[52:53]
  v_mfma_f32_16x16x32_bf16 a[76:79], v[156:159], v[228:231], a[76:79]
  s_and_b32 s34, s34, 0x1ffff
  v_mfma_f32_16x16x32_bf16 a[92:95], v[176:179], v[228:231], a[92:95]
  ds_read_b128 v[56:59], v11 offset:2048
  v_mfma_f32_16x16x32_bf16 a[108:111], v[180:183], v[228:231], a[108:111]
  ds_read_b128 v[60:63], v11 offset:3072
  v_mfma_f32_16x16x32_bf16 a[124:127], v[184:187], v[228:231], a[124:127]
  v_mfma_f32_16x16x32_bf16 a[140:143], v[188:191], v[228:231], a[140:143]
  s_waitcnt vmcnt(19)
  buffer_load_dwordx4 v[228:231], v2, s[40:43], s67 offen offset:3072 sc1
  v_mfma_f32_16x16x32_bf16 a[64:67], a[0:3], a[144:147], a[64:67]
  s_add_u32 s62, s62, 4096
  v_cndmask_b32 v28, v28, 5, s[54:55]
  v_mfma_f32_16x16x32_bf16 a[80:83], a[4:7], a[144:147], a[80:83]
  s_and_b32 s62, s62, 0x7fff
  v_mfma_f32_16x16x32_bf16 a[96:99], a[8:11], a[144:147], a[96:99]
  buffer_load_dwordx4 v[104:107], v2, s[40:43], s14 offen offset:2048 sc1
  v_cndmask_b32 v29, v29, 5, s[56:57]
  v_mfma_f32_16x16x32_bf16 a[112:115], a[12:15], a[144:147], a[112:115]
  s_add_u32 s64, s63, s62
  v_mfma_f32_16x16x32_bf16 a[128:131], a[16:19], a[144:147], a[128:131]
  buffer_load_dwordx4 a[144:147], v2, s[40:43], s64 offen offset:0 sc1
  v_mfma_f32_16x16x32_bf16 a[68:71], a[0:3], a[148:151], a[68:71]
  s_add_u32 s65, s64, 131072
  v_cmp_eq_u32 s[52:53], s74, v24
  v_mfma_f32_16x16x32_bf16 a[84:87], a[4:7], a[148:151], a[84:87]
  s_add_u32 s66, s64, 262144
  v_cmp_eq_u32 s[54:55], s74, v25
  v_mfma_f32_16x16x32_bf16 a[100:103], a[8:11], a[148:151], a[100:103]
  v_mfma_f32_16x16x32_bf16 a[116:119], a[12:15], a[148:151], a[116:119]
  s_waitcnt lgkmcnt(0)
  v_mfma_f32_16x16x32_bf16 a[132:135], a[16:19], a[148:151], a[132:135]
  s_waitcnt vmcnt(19)
  buffer_load_dwordx4 a[148:151], v2, s[40:43], s65 offen offset:0 sc1
  v_cmp_eq_u32 s[56:57], s74, v26
  v_mfma_f32_16x16x32_bf16 a[72:75], a[0:3], a[152:155], a[72:75]
  s_add_u32 s67, s64, 393216
  v_add_u32 v11, s33, v2
  v_mfma_f32_16x16x32_bf16 a[88:91], a[4:7], a[152:155], a[88:91]
  ds_read_b128 v[160:163], v11 offset:0
  v_mfma_f32_16x16x32_bf16 a[104:107], a[8:11], a[152:155], a[104:107]
  buffer_load_dwordx4 v[108:111], v2, s[40:43], s14 offen offset:3072 sc1
  v_mfma_f32_16x16x32_bf16 a[120:123], a[12:15], a[152:155], a[120:123]
  s_add_u32 s33, s33, 32768
  ds_read_b128 v[164:167], v11 offset:1024
  v_cndmask_b32 v27, v27, 6, s[52:53]
  v_mfma_f32_16x16x32_bf16 a[136:139], a[16:19], a[152:155], a[136:139]
  buffer_load_dwordx4 a[152:155], v2, s[40:43], s66 offen offset:0 sc1
  v_cndmask_b32 v28, v28, 6, s[54:55]
  v_mfma_f32_16x16x32_bf16 a[76:79], a[0:3], a[156:159], a[76:79]
  s_and_b32 s33, s33, 0x1ffff
  v_mfma_f32_16x16x32_bf16 a[92:95], a[4:7], a[156:159], a[92:95]
  ds_read_b128 v[168:171], v11 offset:2048
  v_mfma_f32_16x16x32_bf16 a[108:111], a[8:11], a[156:159], a[108:111]
  ds_read_b128 v[172:175], v11 offset:3072
  v_mfma_f32_16x16x32_bf16 a[124:127], a[12:15], a[156:159], a[124:127]
  v_mfma_f32_16x16x32_bf16 a[140:143], a[16:19], a[156:159], a[140:143]
  s_waitcnt vmcnt(19)
  buffer_load_dwordx4 a[156:159], v2, s[40:43], s67 offen offset:0 sc1
  v_mfma_f32_16x16x32_bf16 a[64:67], a[20:23], a[160:163], a[64:67]
  v_cndmask_b32 v29, v29, 6, s[56:57]
  v_mfma_f32_16x16x32_bf16 a[80:83], a[24:27], a[160:163], a[80:83]
  v_mfma_f32_16x16x32_bf16 a[96:99], a[28:31], a[160:163], a[96:99]
  s_add_u32 s14, s13, 126976
  buffer_load_dwordx4 v[112:115], v2, s[40:43], s14 offen offset:0 sc1
  v_cmp_eq_u32 s[52:53], s75, v24
  v_mfma_f32_16x16x32_bf16 a[112:115], a[32:35], a[160:163], a[112:115]
  v_mfma_f32_16x16x32_bf16 a[128:131], a[36:39], a[160:163], a[128:131]
  buffer_load_dwordx4 a[160:163], v2, s[40:43], s64 offen offset:1024 sc1
  v_mfma_f32_16x16x32_bf16 a[68:71], a[20:23], a[164:167], a[68:71]
  v_cmp_eq_u32 s[54:55], s75, v25
  v_mfma_f32_16x16x32_bf16 a[84:87], a[24:27], a[164:167], a[84:87]
  v_cmp_eq_u32 s[56:57], s75, v26
  v_mfma_f32_16x16x32_bf16 a[100:103], a[28:31], a[164:167], a[100:103]
  v_mfma_f32_16x16x32_bf16 a[116:119], a[32:35], a[164:167], a[116:119]
  s_waitcnt lgkmcnt(0)
  v_mfma_f32_16x16x32_bf16 a[132:135], a[36:39], a[164:167], a[132:135]
  s_waitcnt vmcnt(20)
  buffer_load_dwordx4 a[164:167], v2, s[40:43], s65 offen offset:1024 sc1
  v_cndmask_b32 v27, v27, 7, s[52:53]
  v_mfma_f32_16x16x32_bf16 a[72:75], a[20:23], a[168:171], a[72:75]
  v_add_u32 v11, s34, v2
  v_mfma_f32_16x16x32_bf16 a[88:91], a[24:27], a[168:171], a[88:91]
  ds_read_b128 v[192:195], v11 offset:0
  v_mfma_f32_16x16x32_bf16 a[104:107], a[28:31], a[168:171], a[104:107]
  v_mfma_f32_16x16x32_bf16 a[120:123], a[32:35], a[168:171], a[120:123]
  s_add_u32 s34, s34, 32768
  ds_read_b128 v[196:199], v11 offset:1024
  v_cndmask_b32 v28, v28, 7, s[54:55]
  v_mfma_f32_16x16x32_bf16 a[136:139], a[36:39], a[168:171], a[136:139]
  buffer_load_dwordx4 a[168:171], v2, s[40:43], s66 offen offset:1024 sc1
  v_cndmask_b32 v29, v29, 7, s[56:57]
  v_mfma_f32_16x16x32_bf16 a[76:79], a[20:23], a[172:175], a[76:79]
  s_and_b32 s34, s34, 0x1ffff
  v_mfma_f32_16x16x32_bf16 a[92:95], a[24:27], a[172:175], a[92:95]
  ds_read_b128 v[208:211], v11 offset:2048
  v_mfma_f32_16x16x32_bf16 a[108:111], a[28:31], a[172:175], a[108:111]
  ds_read_b128 v[212:215], v11 offset:3072
  v_mfma_f32_16x16x32_bf16 a[124:127], a[32:35], a[172:175], a[124:127]
  v_mfma_f32_16x16x32_bf16 a[140:143], a[36:39], a[172:175], a[140:143]
  s_waitcnt vmcnt(19)
  buffer_load_dwordx4 a[172:175], v2, s[40:43], s67 offen offset:1024 sc1
  v_mfma_f32_16x16x32_bf16 a[64:67], a[40:43], a[176:179], a[64:67]
  v_mul_u32_u24 v27, 320, v27
  v_mfma_f32_16x16x32_bf16 a[80:83], a[44:47], a[176:179], a[80:83]
  v_mfma_f32_16x16x32_bf16 a[96:99], a[48:51], a[176:179], a[96:99]
  buffer_load_dwordx4 v[116:119], v2, s[40:43], s14 offen offset:1024 sc1
  v_add_u32 v203, v203, v27
  v_mfma_f32_16x16x32_bf16 a[112:115], a[52:55], a[176:179], a[112:115]
  v_mfma_f32_16x16x32_bf16 a[128:131], a[56:59], a[176:179], a[128:131]
  buffer_load_dwordx4 a[176:179], v2, s[40:43], s64 offen offset:2048 sc1
  v_mfma_f32_16x16x32_bf16 a[68:71], a[40:43], a[180:183], a[68:71]
  v_add_u32 v203, 155648, v203
  v_mfma_f32_16x16x32_bf16 a[84:87], a[44:47], a[180:183], a[84:87]
  v_mul_u32_u24 v28, 320, v28
  v_mfma_f32_16x16x32_bf16 a[100:103], a[48:51], a[180:183], a[100:103]
  v_mfma_f32_16x16x32_bf16 a[116:119], a[52:55], a[180:183], a[116:119]
  s_waitcnt lgkmcnt(0)
  v_mfma_f32_16x16x32_bf16 a[132:135], a[56:59], a[180:183], a[132:135]
  s_waitcnt vmcnt(19)
  buffer_load_dwordx4 a[180:183], v2, s[40:43], s65 offen offset:2048 sc1
  v_add_u32 v204, v204, v28
  v_mfma_f32_16x16x32_bf16 a[72:75], a[40:43], a[184:187], a[72:75]
  v_add_u32 v11, s33, v2
  v_mfma_f32_16x16x32_bf16 a[88:91], a[44:47], a[184:187], a[88:91]
  ds_read_b128 v[80:83], v11 offset:0
  v_mfma_f32_16x16x32_bf16 a[104:107], a[48:51], a[184:187], a[104:107]
  buffer_load_dwordx4 v[120:123], v2, s[40:43], s14 offen offset:2048 sc1
  v_mfma_f32_16x16x32_bf16 a[120:123], a[52:55], a[184:187], a[120:123]
  s_add_u32 s33, s33, 32768
  ds_read_b128 v[84:87], v11 offset:1024
  v_add_u32 v204, 155648, v204
  v_mfma_f32_16x16x32_bf16 a[136:139], a[56:59], a[184:187], a[136:139]
  buffer_load_dwordx4 a[184:187], v2, s[40:43], s66 offen offset:2048 sc1
  v_mul_u32_u24 v29, 320, v29
  v_mfma_f32_16x16x32_bf16 a[76:79], a[40:43], a[188:191], a[76:79]
  s_and_b32 s33, s33, 0x1ffff
  v_mfma_f32_16x16x32_bf16 a[92:95], a[44:47], a[188:191], a[92:95]
  ds_read_b128 v[88:91], v11 offset:2048
  v_mfma_f32_16x16x32_bf16 a[108:111], a[48:51], a[188:191], a[108:111]
  ds_read_b128 v[92:95], v11 offset:3072
  v_mfma_f32_16x16x32_bf16 a[124:127], a[52:55], a[188:191], a[124:127]
  v_mfma_f32_16x16x32_bf16 a[140:143], a[56:59], a[188:191], a[140:143]
  s_waitcnt vmcnt(19)
  buffer_load_dwordx4 a[188:191], v2, s[40:43], s67 offen offset:2048 sc1
  v_mfma_f32_16x16x32_bf16 a[64:67], a[60:63], v[216:219], a[64:67]
  v_add_u32 v205, v205, v29
  v_mfma_f32_16x16x32_bf16 a[80:83], a[192:195], v[216:219], a[80:83]
  v_mfma_f32_16x16x32_bf16 a[96:99], a[196:199], v[216:219], a[96:99]
  buffer_load_dwordx4 v[124:127], v2, s[40:43], s14 offen offset:3072 sc1
  v_add_u32 v205, 155648, v205
  v_mfma_f32_16x16x32_bf16 a[112:115], a[200:203], v[216:219], a[112:115]
  v_mfma_f32_16x16x32_bf16 a[128:131], a[204:207], v[216:219], a[128:131]
  buffer_load_dwordx4 v[216:219], v2, s[40:43], s64 offen offset:3072 sc1
  v_mfma_f32_16x16x32_bf16 a[68:71], a[60:63], v[220:223], a[68:71]
  v_mfma_f32_16x16x32_bf16 a[84:87], a[192:195], v[220:223], a[84:87]
  v_mfma_f32_16x16x32_bf16 a[100:103], a[196:199], v[220:223], a[100:103]
  v_mfma_f32_16x16x32_bf16 a[116:119], a[200:203], v[220:223], a[116:119]
  s_waitcnt lgkmcnt(0)
  v_mfma_f32_16x16x32_bf16 a[132:135], a[204:207], v[220:223], a[132:135]
  s_waitcnt vmcnt(19)
  buffer_load_dwordx4 v[220:223], v2, s[40:43], s65 offen offset:3072 sc1
  v_mfma_f32_16x16x32_bf16 a[72:75], a[60:63], v[224:227], a[72:75]
  v_add_u32 v11, s34, v2
  v_mfma_f32_16x16x32_bf16 a[88:91], a[192:195], v[224:227], a[88:91]
  ds_read_b128 v[128:131], v11 offset:0
  v_mfma_f32_16x16x32_bf16 a[104:107], a[196:199], v[224:227], a[104:107]
  s_add_u32 s14, s13, 139264
  buffer_load_dwordx4 v[232:235], v2, s[40:43], s14 offen offset:0 sc1
  v_mfma_f32_16x16x32_bf16 a[120:123], a[200:203], v[224:227], a[120:123]
  s_add_u32 s34, s34, 32768
  ds_read_b128 v[132:135], v11 offset:1024
  v_mfma_f32_16x16x32_bf16 a[136:139], a[204:207], v[224:227], a[136:139]
  buffer_load_dwordx4 v[224:227], v2, s[40:43], s66 offen offset:3072 sc1
  v_mfma_f32_16x16x32_bf16 a[76:79], a[60:63], v[228:231], a[76:79]
  s_and_b32 s34, s34, 0x1ffff
  v_mfma_f32_16x16x32_bf16 a[92:95], a[192:195], v[228:231], a[92:95]
  ds_read_b128 v[136:139], v11 offset:2048
  v_mfma_f32_16x16x32_bf16 a[108:111], a[196:199], v[228:231], a[108:111]
  ds_read_b128 v[140:143], v11 offset:3072
  v_mfma_f32_16x16x32_bf16 a[124:127], a[200:203], v[228:231], a[124:127]
  v_mfma_f32_16x16x32_bf16 a[140:143], a[204:207], v[228:231], a[140:143]
  s_waitcnt vmcnt(19)
  buffer_load_dwordx4 v[228:231], v2, s[40:43], s67 offen offset:3072 sc1
  v_mfma_f32_16x16x32_bf16 a[64:67], a[208:211], a[144:147], a[64:67]
  s_add_u32 s62, s62, 4096
  v_mfma_f32_16x16x32_bf16 a[80:83], a[212:215], a[144:147], a[80:83]
  s_and_b32 s62, s62, 0x7fff
  v_mfma_f32_16x16x32_bf16 a[96:99], a[216:219], a[144:147], a[96:99]
  buffer_load_dwordx4 v[236:239], v2, s[40:43], s14 offen offset:1024 sc1
  v_mfma_f32_16x16x32_bf16 a[112:115], a[220:223], a[144:147], a[112:115]
  s_add_u32 s64, s63, s62
  v_mfma_f32_16x16x32_bf16 a[128:131], a[224:227], a[144:147], a[128:131]
  buffer_load_dwordx4 a[144:147], v2, s[40:43], s64 offen offset:0 sc1
  v_mfma_f32_16x16x32_bf16 a[68:71], a[208:211], a[148:151], a[68:71]
  s_add_u32 s65, s64, 131072
  v_mfma_f32_16x16x32_bf16 a[84:87], a[212:215], a[148:151], a[84:87]
  s_add_u32 s66, s64, 262144
  v_mfma_f32_16x16x32_bf16 a[100:103], a[216:219], a[148:151], a[100:103]
  v_mfma_f32_16x16x32_bf16 a[116:119], a[220:223], a[148:151], a[116:119]
  s_waitcnt lgkmcnt(0)
  v_mfma_f32_16x16x32_bf16 a[132:135], a[224:227], a[148:151], a[132:135]
  s_waitcnt vmcnt(19)
  buffer_load_dwordx4 a[148:151], v2, s[40:43], s65 offen offset:0 sc1
  v_mfma_f32_16x16x32_bf16 a[72:75], a[208:211], a[152:155], a[72:75]
  s_add_u32 s67, s64, 393216
  v_add_u32 v11, s35, v2
  v_mfma_f32_16x16x32_bf16 a[88:91], a[212:215], a[152:155], a[88:91]
  ds_read_b128 v[144:147], v11 offset:0
  v_mfma_f32_16x16x32_bf16 a[104:107], a[216:219], a[152:155], a[104:107]
  v_mfma_f32_16x16x32_bf16 a[120:123], a[220:223], a[152:155], a[120:123]
  ds_read_b128 v[148:151], v11 offset:1024
  v_mfma_f32_16x16x32_bf16 a[136:139], a[224:227], a[152:155], a[136:139]
  buffer_load_dwordx4 a[152:155], v2, s[40:43], s66 offen offset:0 sc1
  v_mfma_f32_16x16x32_bf16 a[76:79], a[208:211], a[156:159], a[76:79]
  v_mfma_f32_16x16x32_bf16 a[92:95], a[212:215], a[156:159], a[92:95]
  ds_read_b128 v[152:155], v11 offset:2048
  v_mfma_f32_16x16x32_bf16 a[108:111], a[216:219], a[156:159], a[108:111]
  ds_read_b128 v[156:159], v11 offset:3072
  v_mfma_f32_16x16x32_bf16 a[124:127], a[220:223], a[156:159], a[124:127]
  v_mfma_f32_16x16x32_bf16 a[140:143], a[224:227], a[156:159], a[140:143]
  s_waitcnt vmcnt(18)
  buffer_load_dwordx4 a[156:159], v2, s[40:43], s67 offen offset:0 sc1
  v_mfma_f32_16x16x32_bf16 a[64:67], a[228:231], a[160:163], a[64:67]
  v_mfma_f32_16x16x32_bf16 a[80:83], a[232:235], a[160:163], a[80:83]
  v_mfma_f32_16x16x32_bf16 a[96:99], a[236:239], a[160:163], a[96:99]
  buffer_load_dwordx4 v[240:243], v2, s[40:43], s14 offen offset:2048 sc1
  v_mfma_f32_16x16x32_bf16 a[112:115], a[240:243], a[160:163], a[112:115]
  v_mfma_f32_16x16x32_bf16 a[128:131], a[244:247], a[160:163], a[128:131]
  buffer_load_dwordx4 a[160:163], v2, s[40:43], s64 offen offset:1024 sc1
  v_mfma_f32_16x16x32_bf16 a[68:71], a[228:231], a[164:167], a[68:71]
  v_mfma_f32_16x16x32_bf16 a[84:87], a[232:235], a[164:167], a[84:87]
  v_mfma_f32_16x16x32_bf16 a[100:103], a[236:239], a[164:167], a[100:103]
  v_mfma_f32_16x16x32_bf16 a[116:119], a[240:243], a[164:167], a[116:119]
  s_waitcnt lgkmcnt(0)
  v_mfma_f32_16x16x32_bf16 a[132:135], a[244:247], a[164:167], a[132:135]
  s_waitcnt vmcnt(19)
  buffer_load_dwordx4 a[164:167], v2, s[40:43], s65 offen offset:1024 sc1
  v_mfma_f32_16x16x32_bf16 a[72:75], a[228:231], a[168:171], a[72:75]
  v_mfma_f32_16x16x32_bf16 a[88:91], a[232:235], a[168:171], a[88:91]
  v_mfma_f32_16x16x32_bf16 a[104:107], a[236:239], a[168:171], a[104:107]
  buffer_load_dwordx4 v[244:247], v2, s[40:43], s14 offen offset:3072 sc1
  v_mfma_f32_16x16x32_bf16 a[120:123], a[240:243], a[168:171], a[120:123]
  v_mfma_f32_16x16x32_bf16 a[136:139], a[244:247], a[168:171], a[136:139]
  buffer_load_dwordx4 a[168:171], v2, s[40:43], s66 offen offset:1024 sc1
  v_mfma_f32_16x16x32_bf16 a[76:79], a[228:231], a[172:175], a[76:79]
  v_mfma_f32_16x16x32_bf16 a[92:95], a[232:235], a[172:175], a[92:95]
  v_mfma_f32_16x16x32_bf16 a[108:111], a[236:239], a[172:175], a[108:111]
  v_mfma_f32_16x16x32_bf16 a[124:127], a[240:243], a[172:175], a[124:127]
  v_mfma_f32_16x16x32_bf16 a[140:143], a[244:247], a[172:175], a[140:143]
  s_waitcnt vmcnt(19)
  buffer_load_dwordx4 a[172:175], v2, s[40:43], s67 offen offset:1024 sc1
  v_mfma_f32_16x16x32_bf16 a[64:67], a[248:251], a[176:179], a[64:67]
  v_mfma_f32_16x16x32_bf16 a[80:83], a[252:255], a[176:179], a[80:83]
  v_mfma_f32_16x16x32_bf16 a[96:99], v[32:35], a[176:179], a[96:99]
  s_add_u32 s14, s13, 143360
  buffer_load_dwordx4 v[64:67], v2, s[40:43], s14 offen offset:0 sc1
  v_mfma_f32_16x16x32_bf16 a[112:115], v[36:39], a[176:179], a[112:115]
  v_mfma_f32_16x16x32_bf16 a[128:131], v[40:43], a[176:179], a[128:131]
  buffer_load_dwordx4 a[176:179], v2, s[40:43], s64 offen offset:2048 sc1
  v_mfma_f32_16x16x32_bf16 a[68:71], a[248:251], a[180:183], a[68:71]
  v_mfma_f32_16x16x32_bf16 a[84:87], a[252:255], a[180:183], a[84:87]
  v_mfma_f32_16x16x32_bf16 a[100:103], v[32:35], a[180:183], a[100:103]
  v_mfma_f32_16x16x32_bf16 a[116:119], v[36:39], a[180:183], a[116:119]
  s_waitcnt lgkmcnt(0)
  v_mfma_f32_16x16x32_bf16 a[132:135], v[40:43], a[180:183], a[132:135]
  s_waitcnt vmcnt(19)
  buffer_load_dwordx4 a[180:183], v2, s[40:43], s65 offen offset:2048 sc1
  v_mfma_f32_16x16x32_bf16 a[72:75], a[248:251], a[184:187], a[72:75]
  v_mfma_f32_16x16x32_bf16 a[88:91], a[252:255], a[184:187], a[88:91]
  v_mfma_f32_16x16x32_bf16 a[104:107], v[32:35], a[184:187], a[104:107]
  buffer_load_dwordx4 v[68:71], v2, s[40:43], s14 offen offset:1024 sc1
  v_mfma_f32_16x16x32_bf16 a[120:123], v[36:39], a[184:187], a[120:123]
  v_mfma_f32_16x16x32_bf16 a[136:139], v[40:43], a[184:187], a[136:139]
  buffer_load_dwordx4 a[184:187], v2, s[40:43], s66 offen offset:2048 sc1
  v_mfma_f32_16x16x32_bf16 a[76:79], a[248:251], a[188:191], a[76:79]
  v_mfma_f32_16x16x32_bf16 a[92:95], a[252:255], a[188:191], a[92:95]
  v_mfma_f32_16x16x32_bf16 a[108:111], v[32:35], a[188:191], a[108:111]
  v_mfma_f32_16x16x32_bf16 a[124:127], v[36:39], a[188:191], a[124:127]
  v_mfma_f32_16x16x32_bf16 a[140:143], v[40:43], a[188:191], a[140:143]
  s_waitcnt vmcnt(19)
  buffer_load_dwordx4 a[188:191], v2, s[40:43], s67 offen offset:2048 sc1
  v_mfma_f32_16x16x32_bf16 a[64:67], v[44:47], v[216:219], a[64:67]
  v_mfma_f32_16x16x32_bf16 a[80:83], v[48:51], v[216:219], a[80:83]
  v_mfma_f32_16x16x32_bf16 a[96:99], v[52:55], v[216:219], a[96:99]
  buffer_load_dwordx4 v[72:75], v2, s[40:43], s14 offen offset:2048 sc1
  v_mfma_f32_16x16x32_bf16 a[112:115], v[56:59], v[216:219], a[112:115]
  v_mfma_f32_16x16x32_bf16 a[128:131], v[60:63], v[216:219], a[128:131]
  buffer_load_dwordx4 v[216:219], v2, s[40:43], s64 offen offset:3072 sc1
  v_mfma_f32_16x16x32_bf16 a[68:71], v[44:47], v[220:223], a[68:71]
  v_mfma_f32_16x16x32_bf16 a[84:87], v[48:51], v[220:223], a[84:87]
  v_mfma_f32_16x16x32_bf16 a[100:103], v[52:55], v[220:223], a[100:103]
  v_mfma_f32_16x16x32_bf16 a[116:119], v[56:59], v[220:223], a[116:119]
  s_barrier
  v_mfma_f32_16x16x32_bf16 a[132:135], v[60:63], v[220:223], a[132:135]
  s_waitcnt vmcnt(19)
  buffer_load_dwordx4 v[220:223], v2, s[40:43], s65 offen offset:3072 sc1
  v_mfma_f32_16x16x32_bf16 a[72:75], v[44:47], v[224:227], a[72:75]
  v_mfma_f32_16x16x32_bf16 a[88:91], v[48:51], v[224:227], a[88:91]
  v_mfma_f32_16x16x32_bf16 a[104:107], v[52:55], v[224:227], a[104:107]
  v_mfma_f32_16x16x32_bf16 a[120:123], v[56:59], v[224:227], a[120:123]
  v_mfma_f32_16x16x32_bf16 a[136:139], v[60:63], v[224:227], a[136:139]
  buffer_load_dwordx4 v[224:227], v2, s[40:43], s66 offen offset:3072 sc1
  v_mfma_f32_16x16x32_bf16 a[76:79], v[44:47], v[228:231], a[76:79]
  v_mfma_f32_16x16x32_bf16 a[92:95], v[48:51], v[228:231], a[92:95]
  v_mfma_f32_16x16x32_bf16 a[108:111], v[52:55], v[228:231], a[108:111]
  v_mfma_f32_16x16x32_bf16 a[124:127], v[56:59], v[228:231], a[124:127]
  v_mfma_f32_16x16x32_bf16 a[140:143], v[60:63], v[228:231], a[140:143]
  s_waitcnt vmcnt(18)
  buffer_load_dwordx4 v[228:231], v2, s[40:43], s67 offen offset:3072 sc1
  v_mfma_f32_16x16x32_bf16 a[64:67], v[96:99], a[144:147], a[64:67]
  s_add_u32 s62, s62, 4096
  v_mfma_f32_16x16x32_bf16 a[80:83], v[100:103], a[144:147], a[80:83]
  s_and_b32 s62, s62, 0x7fff
  v_mfma_f32_16x16x32_bf16 a[96:99], v[104:107], a[144:147], a[96:99]
  buffer_load_dwordx4 v[76:79], v2, s[40:43], s14 offen offset:3072 sc1
  v_mfma_f32_16x16x32_bf16 a[112:115], v[108:111], a[144:147], a[112:115]
  s_add_u32 s64, s63, s62
  v_mfma_f32_16x16x32_bf16 a[128:131], v[112:115], a[144:147], a[128:131]
  buffer_load_dwordx4 a[144:147], v2, s[40:43], s64 offen offset:0 sc1
  v_mfma_f32_16x16x32_bf16 a[68:71], v[96:99], a[148:151], a[68:71]
  s_add_u32 s65, s64, 131072
  v_mfma_f32_16x16x32_bf16 a[84:87], v[100:103], a[148:151], a[84:87]
  s_add_u32 s66, s64, 262144
  v_mfma_f32_16x16x32_bf16 a[100:103], v[104:107], a[148:151], a[100:103]
  v_mfma_f32_16x16x32_bf16 a[116:119], v[108:111], a[148:151], a[116:119]
  v_mfma_f32_16x16x32_bf16 a[132:135], v[112:115], a[148:151], a[132:135]
  s_waitcnt vmcnt(19)
  buffer_load_dwordx4 a[148:151], v2, s[40:43], s65 offen offset:0 sc1
  v_mfma_f32_16x16x32_bf16 a[72:75], v[96:99], a[152:155], a[72:75]
  s_add_u32 s67, s64, 393216
  v_mfma_f32_16x16x32_bf16 a[88:91], v[100:103], a[152:155], a[88:91]
  v_mfma_f32_16x16x32_bf16 a[104:107], v[104:107], a[152:155], a[104:107]
  s_add_u32 s14, s13, 159744
  buffer_load_dwordx4 v[176:179], v2, s[40:43], s14 offen offset:0 sc1
  v_mfma_f32_16x16x32_bf16 a[120:123], v[108:111], a[152:155], a[120:123]
  v_mfma_f32_16x16x32_bf16 a[136:139], v[112:115], a[152:155], a[136:139]
  buffer_load_dwordx4 a[152:155], v2, s[40:43], s66 offen offset:0 sc1
  v_mfma_f32_16x16x32_bf16 a[76:79], v[96:99], a[156:159], a[76:79]
  v_mfma_f32_16x16x32_bf16 a[92:95], v[100:103], a[156:159], a[92:95]
  v_mfma_f32_16x16x32_bf16 a[108:111], v[104:107], a[156:159], a[108:111]
  v_mfma_f32_16x16x32_bf16 a[124:127], v[108:111], a[156:159], a[124:127]
  v_mfma_f32_16x16x32_bf16 a[140:143], v[112:115], a[156:159], a[140:143]
  s_waitcnt vmcnt(19)
  buffer_load_dwordx4 a[156:159], v2, s[40:43], s67 offen offset:0 sc1
  v_mfma_f32_16x16x32_bf16 a[64:67], v[116:119], a[160:163], a[64:67]
  v_mfma_f32_16x16x32_bf16 a[80:83], v[120:123], a[160:163], a[80:83]
  v_mfma_f32_16x16x32_bf16 a[96:99], v[124:127], a[160:163], a[96:99]
  buffer_load_dwordx4 v[180:183], v2, s[40:43], s14 offen offset:1024 sc1
  v_mfma_f32_16x16x32_bf16 a[112:115], v[160:163], a[160:163], a[112:115]
  v_mfma_f32_16x16x32_bf16 a[128:131], v[164:167], a[160:163], a[128:131]
  buffer_load_dwordx4 a[160:163], v2, s[40:43], s64 offen offset:1024 sc1
  v_mfma_f32_16x16x32_bf16 a[68:71], v[116:119], a[164:167], a[68:71]
  v_mfma_f32_16x16x32_bf16 a[84:87], v[120:123], a[164:167], a[84:87]
  v_mfma_f32_16x16x32_bf16 a[100:103], v[124:127], a[164:167], a[100:103]
  v_mfma_f32_16x16x32_bf16 a[116:119], v[160:163], a[164:167], a[116:119]
  v_mfma_f32_16x16x32_bf16 a[132:135], v[164:167], a[164:167], a[132:135]
  s_waitcnt vmcnt(19)
  buffer_load_dwordx4 a[164:167], v2, s[40:43], s65 offen offset:1024 sc1
  v_mfma_f32_16x16x32_bf16 a[72:75], v[116:119], a[168:171], a[72:75]
  v_mfma_f32_16x16x32_bf16 a[88:91], v[120:123], a[168:171], a[88:91]
  v_mfma_f32_16x16x32_bf16 a[104:107], v[124:127], a[168:171], a[104:107]
  buffer_load_dwordx4 v[184:187], v2, s[40:43], s14 offen offset:2048 sc1
  v_mfma_f32_16x16x32_bf16 a[120:123], v[160:163], a[168:171], a[120:123]
  v_mfma_f32_16x16x32_bf16 a[136:139], v[164:167], a[168:171], a[136:139]
  buffer_load_dwordx4 a[168:171], v2, s[40:43], s66 offen offset:1024 sc1
  v_mfma_f32_16x16x32_bf16 a[76:79], v[116:119], a[172:175], a[76:79]
  v_mfma_f32_16x16x32_bf16 a[92:95], v[120:123], a[172:175], a[92:95]
  v_mfma_f32_16x16x32_bf16 a[108:111], v[124:127], a[172:175], a[108:111]
  v_mfma_f32_16x16x32_bf16 a[124:127], v[160:163], a[172:175], a[124:127]
  v_mfma_f32_16x16x32_bf16 a[140:143], v[164:167], a[172:175], a[140:143]
  s_waitcnt vmcnt(19)
  buffer_load_dwordx4 a[172:175], v2, s[40:43], s67 offen offset:1024 sc1
  v_mfma_f32_16x16x32_bf16 a[64:67], v[168:171], a[176:179], a[64:67]
  v_mfma_f32_16x16x32_bf16 a[80:83], v[172:175], a[176:179], a[80:83]
  buffer_load_dwordx4 v[32:35], v248, s[44:47], 0 offen
  v_mfma_f32_16x16x32_bf16 a[96:99], v[192:195], a[176:179], a[96:99]
  buffer_load_dwordx4 v[188:191], v2, s[40:43], s14 offen offset:3072 sc1
  v_mfma_f32_16x16x32_bf16 a[112:115], v[196:199], a[176:179], a[112:115]
  v_mfma_f32_16x16x32_bf16 a[128:131], v[208:211], a[176:179], a[128:131]
  buffer_load_dwordx4 a[176:179], v2, s[40:43], s64 offen offset:2048 sc1
  v_mfma_f32_16x16x32_bf16 a[68:71], v[168:171], a[180:183], a[68:71]
  v_mfma_f32_16x16x32_bf16 a[84:87], v[172:175], a[180:183], a[84:87]
  v_mfma_f32_16x16x32_bf16 a[100:103], v[192:195], a[180:183], a[100:103]
  v_mfma_f32_16x16x32_bf16 a[116:119], v[196:199], a[180:183], a[116:119]
  v_mfma_f32_16x16x32_bf16 a[132:135], v[208:211], a[180:183], a[132:135]
  s_waitcnt vmcnt(20)
  buffer_load_dwordx4 a[180:183], v2, s[40:43], s65 offen offset:2048 sc1
  v_mfma_f32_16x16x32_bf16 a[72:75], v[168:171], a[184:187], a[72:75]
  v_mfma_f32_16x16x32_bf16 a[88:91], v[172:175], a[184:187], a[88:91]
  buffer_load_dwordx4 v[44:47], v200, s[40:43], s27 offen sc1
  v_mfma_f32_16x16x32_bf16 a[104:107], v[192:195], a[184:187], a[104:107]
  v_mfma_f32_16x16x32_bf16 a[120:123], v[196:199], a[184:187], a[120:123]
  v_mfma_f32_16x16x32_bf16 a[136:139], v[208:211], a[184:187], a[136:139]
  buffer_load_dwordx4 a[184:187], v2, s[40:43], s66 offen offset:2048 sc1
  v_mfma_f32_16x16x32_bf16 a[76:79], v[168:171], a[188:191], a[76:79]
  v_mfma_f32_16x16x32_bf16 a[92:95], v[172:175], a[188:191], a[92:95]
  v_mfma_f32_16x16x32_bf16 a[108:111], v[192:195], a[188:191], a[108:111]
  v_mfma_f32_16x16x32_bf16 a[124:127], v[196:199], a[188:191], a[124:127]
  v_mfma_f32_16x16x32_bf16 a[140:143], v[208:211], a[188:191], a[140:143]
  s_waitcnt vmcnt(20)
  buffer_load_dwordx4 a[188:191], v2, s[40:43], s67 offen offset:2048 sc1
  v_mfma_f32_16x16x32_bf16 a[64:67], v[212:215], v[216:219], a[64:67]
  ds_read_b128 v[120:123], v203 offset:0
  v_mfma_f32_16x16x32_bf16 a[80:83], v[232:235], v[216:219], a[80:83]
  buffer_load_dwordx4 v[36:39], v249, s[44:47], 0 offen
  v_mfma_f32_16x16x32_bf16 a[96:99], v[236:239], v[216:219], a[96:99]
  v_add_u32 v20, 43008, v251
  v_mfma_f32_16x16x32_bf16 a[112:115], v[240:243], v[216:219], a[112:115]
  ds_read_b128 v[124:127], v203 offset:16
  v_mfma_f32_16x16x32_bf16 a[128:131], v[244:247], v[216:219], a[128:131]
  buffer_load_dwordx4 v[216:219], v2, s[40:43], s64 offen offset:3072 sc1
  v_mfma_f32_16x16x32_bf16 a[68:71], v[212:215], v[220:223], a[68:71]
  ds_read_b128 v[160:163], v204 offset:0
  v_mfma_f32_16x16x32_bf16 a[84:87], v[232:235], v[220:223], a[84:87]
  ds_read_b128 v[164:167], v204 offset:16
  v_add_u32 v21, 43008, v252
  v_mfma_f32_16x16x32_bf16 a[100:103], v[236:239], v[220:223], a[100:103]
  v_mfma_f32_16x16x32_bf16 a[116:119], v[240:243], v[220:223], a[116:119]
  ds_read_b128 v[168:171], v205 offset:0
  v_mfma_f32_16x16x32_bf16 a[132:135], v[244:247], v[220:223], a[132:135]
  s_waitcnt vmcnt(21)
  buffer_load_dwordx4 v[220:223], v2, s[40:43], s65 offen offset:3072 sc1
  v_mfma_f32_16x16x32_bf16 a[72:75], v[212:215], v[224:227], a[72:75]
  ds_read_b128 v[172:175], v205 offset:16
  v_add_u32 v22, 43008, v253
  v_mfma_f32_16x16x32_bf16 a[88:91], v[232:235], v[224:227], a[88:91]
  buffer_load_dwordx4 v[48:51], v201, s[40:43], s27 offen sc1
  v_mfma_f32_16x16x32_bf16 a[104:107], v[236:239], v[224:227], a[104:107]
  v_mfma_f32_16x16x32_bf16 a[120:123], v[240:243], v[224:227], a[120:123]
  v_mfma_f32_16x16x32_bf16 a[136:139], v[244:247], v[224:227], a[136:139]
  s_mul_i32 s23, s20, 21504
  buffer_load_dwordx4 v[224:227], v2, s[40:43], s66 offen offset:3072 sc1
  v_and_b32 v16, 15, v1
  v_mul_u32_u24 v16, 336, v16
  v_mfma_f32_16x16x32_bf16 a[76:79], v[212:215], v[228:231], a[76:79]
  v_lshrrev_b32 v17, 4, v1
  v_lshl_add_u32 v16, v17, 4, v16
  v_mfma_f32_16x16x32_bf16 a[92:95], v[232:235], v[228:231], a[92:95]
  v_add_u32 v16, s23, v16
  v_mfma_f32_16x16x32_bf16 a[108:111], v[236:239], v[228:231], a[108:111]
  v_mfma_f32_16x16x32_bf16 a[124:127], v[240:243], v[228:231], a[124:127]
  s_waitcnt lgkmcnt(0)
  v_mfma_f32_16x16x32_bf16 a[140:143], v[244:247], v[228:231], a[140:143]
  s_waitcnt vmcnt(21)
  buffer_load_dwordx4 v[228:231], v2, s[40:43], s67 offen offset:3072 sc1
  v_mfma_f32_16x16x32_bf16 a[64:67], v[64:67], a[144:147], a[64:67]
  v_mfma_f32_16x16x32_bf16 a[80:83], v[68:71], a[144:147], a[80:83]
  buffer_load_dwordx4 v[40:43], v250, s[44:47], 0 offen
  v_mfma_f32_16x16x32_bf16 a[96:99], v[72:75], a[144:147], a[96:99]
  v_mfma_f32_16x16x32_bf16 a[112:115], v[76:79], a[144:147], a[112:115]
  v_mfma_f32_16x16x32_bf16 a[128:131], v[80:83], a[144:147], a[128:131]
  v_mfma_f32_16x16x32_bf16 a[68:71], v[64:67], a[148:151], a[68:71]
  v_mfma_f32_16x16x32_bf16 a[84:87], v[68:71], a[148:151], a[84:87]
  v_mfma_f32_16x16x32_bf16 a[100:103], v[72:75], a[148:151], a[100:103]
  v_mfma_f32_16x16x32_bf16 a[116:119], v[76:79], a[148:151], a[116:119]
  v_mfma_f32_16x16x32_bf16 a[132:135], v[80:83], a[148:151], a[132:135]
  s_waitcnt vmcnt(20)
  v_mfma_f32_16x16x32_bf16 a[72:75], v[64:67], a[152:155], a[72:75]
  v_mfma_f32_16x16x32_bf16 a[88:91], v[68:71], a[152:155], a[88:91]
  buffer_load_dwordx4 v[52:55], v202, s[40:43], s27 offen sc1
  v_mfma_f32_16x16x32_bf16 a[104:107], v[72:75], a[152:155], a[104:107]
  v_mfma_f32_16x16x32_bf16 a[120:123], v[76:79], a[152:155], a[120:123]
  v_mfma_f32_16x16x32_bf16 a[136:139], v[80:83], a[152:155], a[136:139]
  v_mfma_f32_16x16x32_bf16 a[76:79], v[64:67], a[156:159], a[76:79]
  v_mfma_f32_16x16x32_bf16 a[92:95], v[68:71], a[156:159], a[92:95]
  v_mfma_f32_16x16x32_bf16 a[108:111], v[72:75], a[156:159], a[108:111]
  v_mfma_f32_16x16x32_bf16 a[124:127], v[76:79], a[156:159], a[124:127]
  v_mfma_f32_16x16x32_bf16 a[140:143], v[80:83], a[156:159], a[140:143]
  s_waitcnt vmcnt(10)
  v_mfma_f32_16x16x32_bf16 a[64:67], v[84:87], a[160:163], a[64:67]
  v_lshlrev_b32 v18, 16, v44
  v_and_b32 v19, 0xffff0000, v44
  v_mfma_f32_16x16x32_bf16 a[80:83], v[88:91], a[160:163], a[80:83]
  v_add_f32 v120, v120, v18
  v_add_f32 v121, v121, v19
  v_mfma_f32_16x16x32_bf16 a[96:99], v[92:95], a[160:163], a[96:99]
  v_cvt_pk_bf16_f32 v18, v120, v121
  v_lshlrev_b32 v96, 16, v32
  v_mfma_f32_16x16x32_bf16 a[112:115], v[128:131], a[160:163], a[112:115]
  v_and_b32 v97, 0xffff0000, v32
  v_lshlrev_b32 v120, 16, v18
  v_mfma_f32_16x16x32_bf16 a[128:131], v[132:135], a[160:163], a[128:131]
  v_and_b32 v121, 0xffff0000, v18
  v_lshlrev_b32 v18, 16, v45
  v_mfma_f32_16x16x32_bf16 a[68:71], v[84:87], a[164:167], a[68:71]
  v_and_b32 v19, 0xffff0000, v45
  v_add_f32 v122, v122, v18
  v_mfma_f32_16x16x32_bf16 a[84:87], v[88:91], a[164:167], a[84:87]
  v_add_f32 v123, v123, v19
  v_cvt_pk_bf16_f32 v18, v122, v123
  v_mfma_f32_16x16x32_bf16 a[100:103], v[92:95], a[164:167], a[100:103]
  v_lshlrev_b32 v98, 16, v33
  v_and_b32 v99, 0xffff0000, v33
  v_mfma_f32_16x16x32_bf16 a[116:119], v[128:131], a[164:167], a[116:119]
  v_lshlrev_b32 v122, 16, v18
  v_and_b32 v123, 0xffff0000, v18
  v_mfma_f32_16x16x32_bf16 a[132:135], v[132:135], a[164:167], a[132:135]
  s_waitcnt vmcnt(15)
  v_lshlrev_b32 v18, 16, v46
  v_and_b32 v19, 0xffff0000, v46
  v_mfma_f32_16x16x32_bf16 a[72:75], v[84:87], a[168:171], a[72:75]
  v_add_f32 v124, v124, v18
  v_add_f32 v125, v125, v19
  v_mfma_f32_16x16x32_bf16 a[88:91], v[88:91], a[168:171], a[88:91]
  v_cvt_pk_bf16_f32 v18, v124, v125
  v_lshlrev_b32 v100, 16, v34
  v_mfma_f32_16x16x32_bf16 a[104:107], v[92:95], a[168:171], a[104:107]
  v_and_b32 v101, 0xffff0000, v34
  v_lshlrev_b32 v124, 16, v18
  v_mfma_f32_16x16x32_bf16 a[120:123], v[128:131], a[168:171], a[120:123]
  v_and_b32 v125, 0xffff0000, v18
  v_lshlrev_b32 v18, 16, v47
  v_mfma_f32_16x16x32_bf16 a[136:139], v[132:135], a[168:171], a[136:139]
  v_and_b32 v19, 0xffff0000, v47
  v_add_f32 v126, v126, v18
  v_mfma_f32_16x16x32_bf16 a[76:79], v[84:87], a[172:175], a[76:79]
  v_add_f32 v127, v127, v19
  v_cvt_pk_bf16_f32 v18, v126, v127
  v_mfma_f32_16x16x32_bf16 a[92:95], v[88:91], a[172:175], a[92:95]
  v_lshlrev_b32 v102, 16, v35
  v_and_b32 v103, 0xffff0000, v35
  v_mfma_f32_16x16x32_bf16 a[108:111], v[92:95], a[172:175], a[108:111]
  v_lshlrev_b32 v126, 16, v18
  v_and_b32 v127, 0xffff0000, v18
  v_mfma_f32_16x16x32_bf16 a[124:127], v[128:131], a[172:175], a[124:127]
  v_mfma_f32_16x16x32_bf16 a[140:143], v[132:135], a[172:175], a[140:143]
  s_waitcnt vmcnt(4)
  v_mfma_f32_16x16x32_bf16 a[64:67], v[136:139], a[176:179], a[64:67]
  v_lshlrev_b32 v18, 16, v48
  v_and_b32 v19, 0xffff0000, v48
  v_mfma_f32_16x16x32_bf16 a[80:83], v[140:143], a[176:179], a[80:83]
  v_add_f32 v160, v160, v18
  v_add_f32 v161, v161, v19
  v_mfma_f32_16x16x32_bf16 a[96:99], v[144:147], a[176:179], a[96:99]
  v_cvt_pk_bf16_f32 v18, v160, v161
  v_lshlrev_b32 v104, 16, v36
  v_mfma_f32_16x16x32_bf16 a[112:115], v[148:151], a[176:179], a[112:115]
  v_and_b32 v105, 0xffff0000, v36
  v_lshlrev_b32 v160, 16, v18
  v_mfma_f32_16x16x32_bf16 a[128:131], v[152:155], a[176:179], a[128:131]
  v_and_b32 v161, 0xffff0000, v18
  v_lshlrev_b32 v18, 16, v49
  v_mfma_f32_16x16x32_bf16 a[68:71], v[136:139], a[180:183], a[68:71]
  v_and_b32 v19, 0xffff0000, v49
  v_add_f32 v162, v162, v18
  v_mfma_f32_16x16x32_bf16 a[84:87], v[140:143], a[180:183], a[84:87]
  v_add_f32 v163, v163, v19
  v_cvt_pk_bf16_f32 v18, v162, v163
  v_mfma_f32_16x16x32_bf16 a[100:103], v[144:147], a[180:183], a[100:103]
  v_lshlrev_b32 v106, 16, v37
  v_and_b32 v107, 0xffff0000, v37
  v_mfma_f32_16x16x32_bf16 a[116:119], v[148:151], a[180:183], a[116:119]
  v_lshlrev_b32 v162, 16, v18
  v_and_b32 v163, 0xffff0000, v18
  v_mfma_f32_16x16x32_bf16 a[132:135], v[152:155], a[180:183], a[132:135]
  s_waitcnt vmcnt(8)
  v_lshlrev_b32 v18, 16, v50
  v_and_b32 v19, 0xffff0000, v50
  v_mfma_f32_16x16x32_bf16 a[72:75], v[136:139], a[184:187], a[72:75]
  v_add_f32 v164, v164, v18
  v_add_f32 v165, v165, v19
  v_mfma_f32_16x16x32_bf16 a[88:91], v[140:143], a[184:187], a[88:91]
  v_cvt_pk_bf16_f32 v18, v164, v165
  v_lshlrev_b32 v108, 16, v38
  v_mfma_f32_16x16x32_bf16 a[104:107], v[144:147], a[184:187], a[104:107]
  v_and_b32 v109, 0xffff0000, v38
  v_lshlrev_b32 v164, 16, v18
  v_mfma_f32_16x16x32_bf16 a[120:123], v[148:151], a[184:187], a[120:123]
  v_and_b32 v165, 0xffff0000, v18
  v_lshlrev_b32 v18, 16, v51
  v_mfma_f32_16x16x32_bf16 a[136:139], v[152:155], a[184:187], a[136:139]
  v_and_b32 v19, 0xffff0000, v51
  v_add_f32 v166, v166, v18
  v_mfma_f32_16x16x32_bf16 a[76:79], v[136:139], a[188:191], a[76:79]
  v_add_f32 v167, v167, v19
  v_cvt_pk_bf16_f32 v18, v166, v167
  v_mfma_f32_16x16x32_bf16 a[92:95], v[140:143], a[188:191], a[92:95]
  v_lshlrev_b32 v110, 16, v39
  v_and_b32 v111, 0xffff0000, v39
  v_mfma_f32_16x16x32_bf16 a[108:111], v[144:147], a[188:191], a[108:111]
  v_lshlrev_b32 v166, 16, v18
  v_and_b32 v167, 0xffff0000, v18
  v_mfma_f32_16x16x32_bf16 a[124:127], v[148:151], a[188:191], a[124:127]
  v_mfma_f32_16x16x32_bf16 a[140:143], v[152:155], a[188:191], a[140:143]
  s_waitcnt vmcnt(0)
  v_mfma_f32_16x16x32_bf16 a[64:67], v[156:159], v[216:219], a[64:67]
  v_lshlrev_b32 v18, 16, v52
  v_and_b32 v19, 0xffff0000, v52
  v_mfma_f32_16x16x32_bf16 a[80:83], v[176:179], v[216:219], a[80:83]
  v_add_f32 v168, v168, v18
  v_add_f32 v169, v169, v19
  v_mfma_f32_16x16x32_bf16 a[96:99], v[180:183], v[216:219], a[96:99]
  v_cvt_pk_bf16_f32 v18, v168, v169
  v_lshlrev_b32 v112, 16, v40
  v_mfma_f32_16x16x32_bf16 a[112:115], v[184:187], v[216:219], a[112:115]
  v_and_b32 v113, 0xffff0000, v40
  v_lshlrev_b32 v168, 16, v18
  v_mfma_f32_16x16x32_bf16 a[128:131], v[188:191], v[216:219], a[128:131]
  v_and_b32 v169, 0xffff0000, v18
  v_lshlrev_b32 v18, 16, v53
  v_mfma_f32_16x16x32_bf16 a[68:71], v[156:159], v[220:223], a[68:71]
  v_and_b32 v19, 0xffff0000, v53
  v_add_f32 v170, v170, v18
  v_mfma_f32_16x16x32_bf16 a[84:87], v[176:179], v[220:223], a[84:87]
  v_add_f32 v171, v171, v19
  v_cvt_pk_bf16_f32 v18, v170, v171
  v_mfma_f32_16x16x32_bf16 a[100:103], v[180:183], v[220:223], a[100:103]
  v_lshlrev_b32 v114, 16, v41
  v_and_b32 v115, 0xffff0000, v41
  v_mfma_f32_16x16x32_bf16 a[116:119], v[184:187], v[220:223], a[116:119]
  v_lshlrev_b32 v170, 16, v18
  v_and_b32 v171, 0xffff0000, v18
  v_mfma_f32_16x16x32_bf16 a[132:135], v[188:191], v[220:223], a[132:135]
  s_waitcnt vmcnt(2)
  ds_write_b128 v16, a[64:67] offset:0
  v_lshlrev_b32 v18, 16, v54
  v_and_b32 v19, 0xffff0000, v54
  v_mfma_f32_16x16x32_bf16 a[72:75], v[156:159], v[224:227], a[72:75]
  ds_write_b128 v16, a[80:83] offset:64
  v_add_f32 v172, v172, v18
  v_add_f32 v173, v173, v19
  v_mfma_f32_16x16x32_bf16 a[88:91], v[176:179], v[224:227], a[88:91]
  ds_write_b128 v16, a[96:99] offset:128
  v_cvt_pk_bf16_f32 v18, v172, v173
  v_lshlrev_b32 v116, 16, v42
  v_mfma_f32_16x16x32_bf16 a[104:107], v[180:183], v[224:227], a[104:107]
  ds_write_b128 v16, a[112:115] offset:192
  v_and_b32 v117, 0xffff0000, v42
  v_lshlrev_b32 v172, 16, v18
  v_mfma_f32_16x16x32_bf16 a[120:123], v[184:187], v[224:227], a[120:123]
  ds_write_b128 v16, a[128:131] offset:256
  v_and_b32 v173, 0xffff0000, v18
  v_lshlrev_b32 v18, 16, v55
  v_mfma_f32_16x16x32_bf16 a[136:139], v[188:191], v[224:227], a[136:139]
  ds_write_b128 v16, a[68:71] offset:5376
  v_and_b32 v19, 0xffff0000, v55
  v_add_f32 v174, v174, v18
  v_mfma_f32_16x16x32_bf16 a[76:79], v[156:159], v[228:231], a[76:79]
  ds_write_b128 v16, a[84:87] offset:5440
  v_add_f32 v175, v175, v19
  v_cvt_pk_bf16_f32 v18, v174, v175
  v_mfma_f32_16x16x32_bf16 a[92:95], v[176:179], v[228:231], a[92:95]
  ds_write_b128 v16, a[100:103] offset:5504
  v_lshlrev_b32 v118, 16, v43
  v_and_b32 v119, 0xffff0000, v43
  v_mfma_f32_16x16x32_bf16 a[108:111], v[180:183], v[228:231], a[108:111]
  ds_write_b128 v16, a[116:119] offset:5568
  v_lshlrev_b32 v174, 16, v18
  v_and_b32 v175, 0xffff0000, v18
  v_mfma_f32_16x16x32_bf16 a[124:127], v[184:187], v[228:231], a[124:127]
  ds_write_b128 v16, a[132:135] offset:5632
  v_mfma_f32_16x16x32_bf16 a[140:143], v[188:191], v[228:231], a[140:143]
  ds_write_b128 v16, a[72:75] offset:10752
  ds_write_b128 v16, a[88:91] offset:10816
  ds_write_b128 v16, a[104:107] offset:10880
  ds_write_b128 v16, a[120:123] offset:10944
  ds_write_b128 v16, a[136:139] offset:11008
  ds_write_b128 v16, a[76:79] offset:16128
  ds_write_b128 v16, a[92:95] offset:16192
  ds_write_b128 v16, a[108:111] offset:16256
  ds_write_b128 v16, a[124:127] offset:16320
  ds_write_b128 v16, a[140:143] offset:16384
  s_waitcnt lgkmcnt(0)
  s_barrier
  ds_read_b128 v[32:35], v251 offset:0
  ds_read_b128 v[36:39], v251 offset:16
  ds_read_b128 v[40:43], v251 offset:21504
  ds_read_b128 v[44:47], v251 offset:21520
  ds_read_b128 v[48:51], v20 offset:0
  ds_read_b128 v[52:55], v20 offset:16
  ds_read_b128 v[56:59], v20 offset:21504
  ds_read_b128 v[60:63], v20 offset:21520
  ds_read_b128 v[64:67], v252 offset:0
  ds_read_b128 v[68:71], v252 offset:16
  ds_read_b128 v[72:75], v252 offset:21504
  ds_read_b128 v[76:79], v252 offset:21520
  ds_read_b128 v[80:83], v21 offset:0
  ds_read_b128 v[84:87], v21 offset:16
  ds_read_b128 v[88:91], v21 offset:21504
  ds_read_b128 v[92:95], v21 offset:21520
  ds_read_b128 v[128:131], v253 offset:0
  ds_read_b128 v[132:135], v253 offset:16
  ds_read_b128 v[136:139], v253 offset:21504
  ds_read_b128 v[140:143], v253 offset:21520
  ds_read_b128 v[144:147], v22 offset:0
  ds_read_b128 v[148:151], v22 offset:16
  ds_read_b128 v[152:155], v22 offset:21504
  ds_read_b128 v[156:159], v22 offset:21520
  s_waitcnt lgkmcnt(15)
  v_pk_add_f32 v[32:33], v[32:33], v[40:41]
  v_pk_add_f32 v[48:49], v[48:49], v[56:57]
  v_pk_add_f32 v[34:35], v[34:35], v[42:43]
  v_pk_add_f32 v[50:51], v[50:51], v[58:59]
  v_pk_add_f32 v[36:37], v[36:37], v[44:45]
  v_pk_add_f32 v[52:53], v[52:53], v[60:61]
  v_pk_add_f32 v[38:39], v[38:39], v[46:47]
  v_pk_add_f32 v[54:55], v[54:55], v[62:63]
  v_pk_add_f32 v[32:33], v[32:33], v[48:49]
  v_pk_add_f32 v[34:35], v[34:35], v[50:51]
  v_pk_add_f32 v[36:37], v[36:37], v[52:53]
  v_pk_add_f32 v[38:39], v[38:39], v[54:55]
  v_cvt_pk_bf16_f32 v40, v32, v33
  v_cvt_pk_bf16_f32 v41, v34, v35
  v_cvt_pk_bf16_f32 v42, v36, v37
  v_cvt_pk_bf16_f32 v43, v38, v39
  v_lshlrev_b32 v32, 16, v40
  v_and_b32 v33, 0xffff0000, v40
  v_lshlrev_b32 v34, 16, v41
  v_and_b32 v35, 0xffff0000, v41
  v_lshlrev_b32 v36, 16, v42
  v_and_b32 v37, 0xffff0000, v42
  v_lshlrev_b32 v38, 16, v43
  v_and_b32 v39, 0xffff0000, v43
  v_pk_add_f32 v[32:33], v[32:33], v[96:97]
  v_pk_add_f32 v[34:35], v[34:35], v[98:99]
  v_pk_add_f32 v[36:37], v[36:37], v[100:101]
  v_pk_add_f32 v[38:39], v[38:39], v[102:103]
  v_cvt_pk_bf16_f32 v40, v32, v33
  v_cvt_pk_bf16_f32 v41, v34, v35
  v_cvt_pk_bf16_f32 v42, v36, v37
  v_cvt_pk_bf16_f32 v43, v38, v39
  v_lshlrev_b32 v32, 16, v40
  v_and_b32 v33, 0xffff0000, v40
  v_lshlrev_b32 v34, 16, v41
  v_and_b32 v35, 0xffff0000, v41
  v_lshlrev_b32 v36, 16, v42
  v_and_b32 v37, 0xffff0000, v42
  v_lshlrev_b32 v38, 16, v43
  v_and_b32 v39, 0xffff0000, v43
  v_pk_add_f32 v[32:33], v[32:33], v[120:121]
  v_pk_add_f32 v[34:35], v[34:35], v[122:123]
  v_pk_add_f32 v[36:37], v[36:37], v[124:125]
  v_pk_add_f32 v[38:39], v[38:39], v[126:127]
  v_cvt_pk_bf16_f32 v44, v32, v33
  v_cvt_pk_bf16_f32 v45, v34, v35
  v_cvt_pk_bf16_f32 v46, v36, v37
  v_cvt_pk_bf16_f32 v47, v38, v39
  buffer_store_dwordx4 v[44:47], v248, s[48:51], 0 offen
  s_waitcnt lgkmcnt(8)
  v_pk_add_f32 v[64:65], v[64:65], v[72:73]
  v_pk_add_f32 v[80:81], v[80:81], v[88:89]
  v_pk_add_f32 v[66:67], v[66:67], v[74:75]
  v_pk_add_f32 v[82:83], v[82:83], v[90:91]
  v_pk_add_f32 v[68:69], v[68:69], v[76:77]
  v_pk_add_f32 v[84:85], v[84:85], v[92:93]
  v_pk_add_f32 v[70:71], v[70:71], v[78:79]
  v_pk_add_f32 v[86:87], v[86:87], v[94:95]
  v_pk_add_f32 v[64:65], v[64:65], v[80:81]
  v_pk_add_f32 v[66:67], v[66:67], v[82:83]
  v_pk_add_f32 v[68:69], v[68:69], v[84:85]
  v_pk_add_f32 v[70:71], v[70:71], v[86:87]
  v_cvt_pk_bf16_f32 v72, v64, v65
  v_cvt_pk_bf16_f32 v73, v66, v67
  v_cvt_pk_bf16_f32 v74, v68, v69
  v_cvt_pk_bf16_f32 v75, v70, v71
  v_lshlrev_b32 v64, 16, v72
  v_and_b32 v65, 0xffff0000, v72
  v_lshlrev_b32 v66, 16, v73
  v_and_b32 v67, 0xffff0000, v73
  v_lshlrev_b32 v68, 16, v74
  v_and_b32 v69, 0xffff0000, v74
  v_lshlrev_b32 v70, 16, v75
  v_and_b32 v71, 0xffff0000, v75
  v_pk_add_f32 v[64:65], v[64:65], v[104:105]
  v_pk_add_f32 v[66:67], v[66:67], v[106:107]
  v_pk_add_f32 v[68:69], v[68:69], v[108:109]
  v_pk_add_f32 v[70:71], v[70:71], v[110:111]
  v_cvt_pk_bf16_f32 v72, v64, v65
  v_cvt_pk_bf16_f32 v73, v66, v67
  v_cvt_pk_bf16_f32 v74, v68, v69
  v_cvt_pk_bf16_f32 v75, v70, v71
  v_lshlrev_b32 v64, 16, v72
  v_and_b32 v65, 0xffff0000, v72
  v_lshlrev_b32 v66, 16, v73
  v_and_b32 v67, 0xffff0000, v73
  v_lshlrev_b32 v68, 16, v74
  v_and_b32 v69, 0xffff0000, v74
  v_lshlrev_b32 v70, 16, v75
  v_and_b32 v71, 0xffff0000, v75
  v_pk_add_f32 v[64:65], v[64:65], v[160:161]
  v_pk_add_f32 v[66:67], v[66:67], v[162:163]
  v_pk_add_f32 v[68:69], v[68:69], v[164:165]
  v_pk_add_f32 v[70:71], v[70:71], v[166:167]
  v_cvt_pk_bf16_f32 v76, v64, v65
  v_cvt_pk_bf16_f32 v77, v66, v67
  v_cvt_pk_bf16_f32 v78, v68, v69
  v_cvt_pk_bf16_f32 v79, v70, v71
  buffer_store_dwordx4 v[76:79], v249, s[48:51], 0 offen
  s_waitcnt lgkmcnt(0)
  v_pk_add_f32 v[128:129], v[128:129], v[136:137]
  v_pk_add_f32 v[144:145], v[144:145], v[152:153]
  v_pk_add_f32 v[130:131], v[130:131], v[138:139]
  v_pk_add_f32 v[146:147], v[146:147], v[154:155]
  v_pk_add_f32 v[132:133], v[132:133], v[140:141]
  v_pk_add_f32 v[148:149], v[148:149], v[156:157]
  v_pk_add_f32 v[134:135], v[134:135], v[142:143]
  v_pk_add_f32 v[150:151], v[150:151], v[158:159]
  v_pk_add_f32 v[128:129], v[128:129], v[144:145]
  v_pk_add_f32 v[130:131], v[130:131], v[146:147]
  v_pk_add_f32 v[132:133], v[132:133], v[148:149]
  v_pk_add_f32 v[134:135], v[134:135], v[150:151]
  v_cvt_pk_bf16_f32 v136, v128, v129
  v_cvt_pk_bf16_f32 v137, v130, v131
  v_cvt_pk_bf16_f32 v138, v132, v133
  v_cvt_pk_bf16_f32 v139, v134, v135
  v_lshlrev_b32 v128, 16, v136
  v_and_b32 v129, 0xffff0000, v136
  v_lshlrev_b32 v130, 16, v137
  v_and_b32 v131, 0xffff0000, v137
  v_lshlrev_b32 v132, 16, v138
  v_and_b32 v133, 0xffff0000, v138
  v_lshlrev_b32 v134, 16, v139
  v_and_b32 v135, 0xffff0000, v139
  v_pk_add_f32 v[128:129], v[128:129], v[112:113]
  v_pk_add_f32 v[130:131], v[130:131], v[114:115]
  v_pk_add_f32 v[132:133], v[132:133], v[116:117]
  v_pk_add_f32 v[134:135], v[134:135], v[118:119]
  v_cvt_pk_bf16_f32 v136, v128, v129
  v_cvt_pk_bf16_f32 v137, v130, v131
  v_cvt_pk_bf16_f32 v138, v132, v133
  v_cvt_pk_bf16_f32 v139, v134, v135
  v_lshlrev_b32 v128, 16, v136
  v_and_b32 v129, 0xffff0000, v136
  v_lshlrev_b32 v130, 16, v137
  v_and_b32 v131, 0xffff0000, v137
  v_lshlrev_b32 v132, 16, v138
  v_and_b32 v133, 0xffff0000, v138
  v_lshlrev_b32 v134, 16, v139
  v_and_b32 v135, 0xffff0000, v139
  v_pk_add_f32 v[128:129], v[128:129], v[168:169]
  v_pk_add_f32 v[130:131], v[130:131], v[170:171]
  v_pk_add_f32 v[132:133], v[132:133], v[172:173]
  v_pk_add_f32 v[134:135], v[134:135], v[174:175]
  v_cvt_pk_bf16_f32 v140, v128, v129
  v_cvt_pk_bf16_f32 v141, v130, v131
  v_cvt_pk_bf16_f32 v142, v132, v133
  v_cvt_pk_bf16_f32 v143, v134, v135
  buffer_store_dwordx4 v[140:143], v250, s[48:51], 0 offen
fa_end:
  s_endpgm
fa_hk0:
  s_getpc_b64 s[10:11]
fa_hp0:
  s_add_u32 s8, s8, 4
  s_addc_u32 s9, s9, 0
  s_sub_u32 s10, s10, fa_hp0-fa_hb0
  s_subb_u32 s11, s11, 0
  s_setpc_b64 s[8:9]
fa_hk1:
  s_getpc_b64 s[10:11]
fa_hp1:
  s_add_u32 s8, s8, 4
  s_addc_u32 s9, s9, 0
  s_sub_u32 s10, s10, fa_hp1-fa_hb1
  s_subb_u32 s11, s11, 0
  s_setpc_b64 s[8:9]
fa_hk2:
  s_getpc_b64 s[10:11]
fa_hp2:
  s_add_u32 s8, s8, 4
  s_addc_u32 s9, s9, 0
  s_sub_u32 s10, s10, fa_hp2-fa_hb2
  s_subb_u32 s11, s11, 0
  s_setpc_b64 s[8:9]
fa_hk3:
  s_getpc_b64 s[10:11]
fa_hp3:
  s_add_u32 s8, s8, 4
  s_addc_u32 s9, s9, 0
  s_sub_u32 s10, s10, fa_hp3-fa_hb3
  s_subb_u32 s11, s11, 0
  s_setpc_b64 s[8:9]
fa_ln_spin:
  s_mov_b32 s83, 200000
fa_ln_spin2:
  buffer_load_dword v15, v229, s[56:59], 0 offen sc1
  s_waitcnt vmcnt(0)
  v_cmp_ne_u32 vcc, 0x01010101, v15
  s_cbranch_vccz fa_ln_ok
  s_sleep 8
  s_sub_u32 s83, s83, 1
  s_cmp_lg_u32 s83, 0
  s_cbranch_scc1 fa_ln_spin2
  s_branch fa_ln_ok
fa_co1:
  buffer_load_dword v232, v234, s[32:35], s29 offen
  buffer_store_dword v229, v225, s[40:43], 0 offen sc1
  ds_read_b128 v[160:163], v221 offset:0
  ds_read_b128 v[164:167], v221 offset:4096
  ds_read_b128 v[168:171], v221 offset:8192
  buffer_store_dword v218, v222, s[40:43], 0 offen sc1
  s_waitcnt lgkmcnt(0)
  buffer_store_dwordx4 v[160:163], v223, s[40:43], s66 offen sc1
  buffer_store_dwordx4 v[164:167], v223, s[40:43], s67 offen sc1
  buffer_store_dwordx4 v[168:171], v224, s[40:43], s78 offen sc1
  s_getpc_b64 s[8:9]
  s_setpc_b64 s[10:11]
  s_mov_b32 s48, s60
  s_mov_b32 s49, s61
  s_mov_b32 s50, s75
  s_lshl_b32 s74, s22, 2
  s_add_u32 s74, s74, s20
  s_lshl_b32 s74, s74, 16
  s_mov_b32 s73, 2097152
  v_mov_b32 v213, 1073741824
  v_mov_b32 v214, 1
  v_writelane_b32 v213, s77, 0
  v_lshlrev_b32 v229, 2, v1
  s_and_b32 s23, s21, 3
  s_cbranch_scc0 fa_arr
  s_getpc_b64 s[8:9]
  s_setpc_b64 s[10:11]
fa_arr:
  buffer_store_byte v214, v213, s[56:59], 0 offen sc1
  s_getpc_b64 s[8:9]
  s_setpc_b64 s[10:11]
  buffer_load_dword v15, v229, s[56:59], 0 offen sc1
  s_getpc_b64 s[8:9]
  s_setpc_b64 s[10:11]
  s_mov_b32 s36, s60
  s_mov_b32 s37, s61
  s_mov_b32 s38, s75
  s_lshr_b32 s27, s20, 1
  s_lshl_b32 s27, s27, 18
  s_mov_b32 s25, 524288
  s_mov_b32 s32, s18
  s_mov_b32 s33, s19
  s_mov_b32 s34, 2621440
  s_mov_b32 s26, 0
  s_movk_i32 s79, 1024
  s_lshl_b32 s23, s22, 2
  s_add_u32 s23, s23, s20
  s_mul_i32 s23, s23, 40960
  v_add_u32 v3, s23, v2
  s_sub_u32 s23, 15, s22
  s_lshl_b32 s23, s23, 2
  s_add_u32 s23, s23, s20
  s_mul_i32 s23, s23, 40960
  s_sub_u32 s23, s23, 2048
  v_add_u32 v5, s23, v2
  v_add_u32 v4, 19456, v3
  v_add_u32 v6, 19456, v5
  s_waitcnt vmcnt(8)
  v_cmp_ne_u32 vcc, 0x01010101, v15
  s_cbranch_vccnz fa_ln_spin
fa_ln_ok:
  s_setpc_b64 s[10:11]
fa_kv_spin:
  s_mov_b32 s83, 200000
fa_kv_spin2:
  buffer_load_dword v15, v8, s[40:43], 0 offen sc1
  s_waitcnt vmcnt(0)
  v_cmp_eq_u32 vcc, 0, v15
  s_cbranch_vccz fa_kv_ok
  s_sleep 8
  s_sub_u32 s83, s83, 1
  s_cmp_lg_u32 s83, 0
  s_cbranch_scc1 fa_kv_spin2
  s_branch fa_kv_ok
fa_top8:
  s_cmp_lg_u32 s20, 0
  s_cbranch_scc1 fa_notop
  s_mov_b32 s23, 2621440
  s_mov_b32 s31, 2625536
  buffer_load_dwordx4 v[96:99], v2, s[40:43], s23 offen offset:0 sc1
  buffer_load_dwordx4 v[100:103], v2, s[40:43], s23 offen offset:1024 sc1
  buffer_load_dwordx4 v[104:107], v2, s[40:43], s23 offen offset:2048 sc1
  buffer_load_dwordx4 v[108:111], v2, s[40:43], s23 offen offset:3072 sc1
  buffer_load_dwordx4 v[112:115], v2, s[40:43], s31 offen offset:0 sc1
  buffer_load_dwordx4 v[116:119], v2, s[40:43], s31 offen offset:1024 sc1
  buffer_load_dwordx4 v[120:123], v2, s[40:43], s31 offen offset:2048 sc1
  buffer_load_dwordx4 v[124:127], v2, s[40:43], s31 offen offset:3072 sc1
  v_mov_b32 v21, 0
  v_mov_b32 v22, 0
  v_and_b32 v23, 7, v1
  s_mov_b32 s23, 0
  s_waitcnt vmcnt(0)
fa_top:
  v_max3_u32 v20, v96, v97, v98
  v_max3_u32 v24, v99, v100, v101
  v_max3_u32 v20, v20, v102, v103
  v_max3_u32 v24, v24, v104, v105
  v_max3_u32 v20, v20, v106, v107
  v_max3_u32 v24, v24, v108, v109
  v_max3_u32 v20, v20, v110, v111
  v_max3_u32 v24, v24, v112, v113
  v_max3_u32 v20, v20, v114, v115
  v_max3_u32 v24, v24, v116, v117
  v_max3_u32 v20, v20, v118, v119
  v_max3_u32 v24, v24, v120, v121
  v_max3_u32 v20, v20, v122, v123
  v_max3_u32 v24, v24, v124, v125
  v_max3_u32 v20, v20, v126, v127
  v_max_u32 v20, v20, v24
  s_nop 1
  v_max_u32_dpp v20, v20, v20 quad_perm:[1,0,3,2] row_mask:0xf bank_mask:0xf
  s_nop 1
  v_max_u32_dpp v20, v20, v20 quad_perm:[2,3,0,1] row_mask:0xf bank_mask:0xf
  s_nop 1
  v_max_u32_dpp v20, v20, v20 row_half_mirror row_mask:0xf bank_mask:0xf
  s_nop 1
  v_max_u32_dpp v20, v20, v20 row_mirror row_mask:0xf bank_mask:0xf
  v_mov_b32 v24, v20
  s_nop 1
  v_permlane16_swap_b32 v20, v24
  v_max_u32 v20, v20, v24
  v_mov_b32 v24, v20
  s_nop 1
  v_permlane32_swap_b32 v20, v24
  v_max_u32 v20, v20, v24
  v_add_u32 v21, v21, v20
  v_cmp_eq_u32 vcc, s23, v23
  v_sub_u32 v96, v96, v20
  v_sub_u32 v97, v97, v20
  v_sub_u32 v98, v98, v20
  v_sub_u32 v99, v99, v20
  v_sub_u32 v100, v100, v20
  v_sub_u32 v101, v101, v20
  v_sub_u32 v102, v102, v20
  v_sub_u32 v103, v103, v20
  v_sub_u32 v104, v104, v20
  v_sub_u32 v105, v105, v20
  v_sub_u32 v106, v106, v20
  v_sub_u32 v107, v107, v20
  v_sub_u32 v108, v108, v20
  v_sub_u32 v109, v109, v20
  v_sub_u32 v110, v110, v20
  v_sub_u32 v111, v111, v20
  v_sub_u32 v112, v112, v20
  v_sub_u32 v113, v113, v20
  v_sub_u32 v114, v114, v20
  v_sub_u32 v115, v115, v20
  v_sub_u32 v116, v116, v20
  v_sub_u32 v117, v117, v20
  v_sub_u32 v118, v118, v20
  v_sub_u32 v119, v119, v20
  v_sub_u32 v120, v120, v20
  v_sub_u32 v121, v121, v20
  v_sub_u32 v122, v122, v20
  v_sub_u32 v123, v123, v20
  v_sub_u32 v124, v124, v20
  v_sub_u32 v125, v125, v20
  v_sub_u32 v126, v126, v20
  v_sub_u32 v127, v127, v20
  v_cndmask_b32 v22, v22, v21, vcc
  s_add_u32 s23, s23, 1
  s_cmp_lt_u32 s23, 8
  s_cbranch_scc1 fa_top
  v_and_b32 v25, 0xffff, v22
  v_sub_u32 v25, 0xffff, v25
  v_and_b32 v25, 2047, v25
  v_ashrrev_i32 v20, 31, v22
  v_not_b32 v20, v20
  v_or_b32 v20, 0x80000000, v20
  v_xor_b32 v26, v22, v20
  v_and_b32 v26, 0xffff0000, v26
  v_mul_f32 v26, 0xbfb8aa3b, v26
  v_exp_f32 v26, v26
  s_nop 0
  v_add_f32 v26, 1.0, v26
  v_rcp_f32 v26, v26
  s_nop 0
  v_cvt_pk_bf16_f32 v26, v26, v26
  v_and_b32 v26, 0xffff0000, v26
  v_lshlrev_b32 v20, 2, v1
  v_add_u32 v20, 2629632, v20
  v_mov_b32 v21, 1073741824
  v_cmp_gt_u32 vcc, 16, v1
  v_add_u32 v25, 1, v25
  v_or_b32 v26, 1, v26
  v_cndmask_b32 v20, v21, v20, vcc
  v_cmp_gt_u32 vcc, 8, v1
  s_nop 1
  v_cndmask_b32 v26, v26, v25, vcc
  buffer_store_dword v26, v20, s[40:43], 0 offen sc1
  s_branch fa_notop
fa_hk4:
  s_getpc_b64 s[38:39]
fa_hp4:
  s_add_u32 s36, s36, 4
  s_addc_u32 s37, s37, 0
  s_sub_u32 s38, s38, fa_hp4-fa_hb4
  s_subb_u32 s39, s39, 0
  s_setpc_b64 s[36:37]
fa_hk5:
  s_getpc_b64 s[38:39]
fa_hp5:
  s_add_u32 s36, s36, 4
  s_addc_u32 s37, s37, 0
  s_sub_u32 s38, s38, fa_hp5-fa_hb5
  s_subb_u32 s39, s39, 0
  s_setpc_b64 s[36:37]
fa_hk6:
  s_getpc_b64 s[38:39]
fa_hp6:
  s_add_u32 s36, s36, 4
  s_addc_u32 s37, s37, 0
  s_add_u32 s38, s38, fa_hb6-fa_hp6
  s_addc_u32 s39, s39, 0
  s_setpc_b64 s[36:37]
fa_DDF:
  v_mfma_f32_16x16x32_bf16 v[96:99], a[128:131], v[32:35], v[192:195]
  s_waitcnt vmcnt(12)
  v_exp_f32 v218, v146
  v_mfma_f32_16x16x32_bf16 v[104:107], a[128:131], v[36:39], v[196:199]
  s_barrier
  v_exp_f32 v219, v147
  v_mfma_f32_16x16x32_bf16 v[128:131], a[128:131], v[64:67], v[200:203]
  s_cmp_ge_u32 s26, s32
  ds_read_b128 a[160:163], v3 offset:16384
  v_add_f32 v226, v216, v217
  v_mfma_f32_16x16x32_bf16 v[136:139], a[128:131], v[68:71], v[204:207]
  s_cbranch_scc1 fa_hk6
fa_hb6:
  v_exp_f32 v220, v148
  v_mfma_f32_16x16x32_bf16 v[100:103], a[132:135], v[32:35], v[192:195]
  ds_read_b128 a[164:167], v3 offset:17408
  v_cvt_pk_bf16_f32 v184, v216, v217
  v_mfma_f32_16x16x32_bf16 v[108:111], a[132:135], v[36:39], v[196:199]
  s_mov_b32 m0, s24
  v_exp_f32 v221, v149
  v_mfma_f32_16x16x32_bf16 v[132:135], a[132:135], v[64:67], v[200:203]
  buffer_load_dwordx4 v2, s[44:47], s26 offen offset:0 sc1 lds
  v_add_f32 v226, v226, v218
  v_mfma_f32_16x16x32_bf16 v[140:143], a[132:135], v[68:71], v[204:207]
  v_exp_f32 v222, v150
  v_mfma_f32_16x16x32_bf16 v[96:99], a[136:139], v[40:43], v[96:99]
  ds_read_b128 a[168:171], v3 offset:18432
  v_add_f32 v226, v226, v219
  v_cvt_pk_bf16_f32 v185, v218, v219
  v_mfma_f32_16x16x32_bf16 v[104:107], a[136:139], v[44:47], v[104:107]
  v_exp_f32 v223, v151
  v_mfma_f32_16x16x32_bf16 v[128:131], a[136:139], v[72:75], v[128:131]
  v_add_f32 v226, v226, v220
  v_add_f32 v226, v226, v221
  v_mfma_f32_16x16x32_bf16 v[136:139], a[136:139], v[76:79], v[136:139]
  v_exp_f32 v216, v152
  v_mfma_f32_16x16x32_bf16 v[100:103], a[140:143], v[40:43], v[100:103]
  ds_read_b128 a[172:175], v3 offset:19456
  v_cvt_pk_bf16_f32 v186, v220, v221
  v_mfma_f32_16x16x32_bf16 v[108:111], a[140:143], v[44:47], v[108:111]
  buffer_load_dwordx4 v2, s[44:47], s26 offen offset:1024 sc1 lds
  v_add_f32 v226, v226, v222
  v_mfma_f32_16x16x32_bf16 v[132:135], a[140:143], v[72:75], v[132:135]
  v_exp_f32 v217, v153
  v_mfma_f32_16x16x32_bf16 v[140:143], a[140:143], v[76:79], v[140:143]
  s_waitcnt lgkmcnt(4)
  v_exp_f32 v218, v154
  v_mfma_f32_16x16x32_bf16 v[96:99], a[144:147], v[48:51], v[96:99]
  ds_read_b128 a[176:179], v3 offset:20480
  v_add_f32 v226, v226, v223
  v_mfma_f32_16x16x32_bf16 v[104:107], a[144:147], v[52:55], v[104:107]
  v_exp_f32 v219, v155
  v_mfma_f32_16x16x32_bf16 v[128:131], a[144:147], v[80:83], v[128:131]
  v_cvt_pk_bf16_f32 v187, v222, v223
  v_add_f32 v227, v216, v217
  v_cvt_pk_bf16_f32 v188, v216, v217
  v_mfma_f32_16x16x32_bf16 v[136:139], a[144:147], v[84:87], v[136:139]
  buffer_load_dwordx4 v2, s[44:47], s26 offen offset:2048 sc1 lds
  v_add_f32 v227, v227, v218
  v_mfma_f32_16x16x32_bf16 v[100:103], a[148:151], v[48:51], v[100:103]
  ds_read_b128 a[180:183], v3 offset:21504
  v_add_f32 v227, v227, v219
  v_mfma_f32_16x16x32_bf16 v[108:111], a[148:151], v[52:55], v[108:111]
  v_exp_f32 v220, v156
  v_mfma_f32_16x16x32_bf16 v[132:135], a[148:151], v[80:83], v[132:135]
  v_exp_f32 v221, v157
  v_mfma_f32_16x16x32_bf16 v[140:143], a[148:151], v[84:87], v[140:143]
  v_exp_f32 v222, v158
  v_mfma_f32_16x16x32_bf16 v[96:99], a[152:155], v[56:59], v[96:99]
  ds_read_b128 a[184:187], v3 offset:22528
  v_cvt_pk_bf16_f32 v189, v218, v219
  v_mfma_f32_16x16x32_bf16 v[104:107], a[152:155], v[60:63], v[104:107]
  buffer_load_dwordx4 v2, s[44:47], s26 offen offset:3072 sc1 lds
  v_add_f32 v227, v227, v220
  v_add_f32 v227, v227, v221
  v_mfma_f32_16x16x32_bf16 v[128:131], a[152:155], v[88:91], v[128:131]
  s_add_u32 s26, s26, 16384
  v_exp_f32 v223, v159
  v_mfma_f32_16x16x32_bf16 v[136:139], a[152:155], v[92:95], v[136:139]
  s_add_u32 s24, s24, 32768
  v_exp_f32 v208, v112
  v_mfma_f32_16x16x32_bf16 v[100:103], a[156:159], v[56:59], v[100:103]
  s_and_b32 s24, s24, 0x1ffff
  ds_read_b128 a[188:191], v3 offset:23552
  v_cvt_pk_bf16_f32 v190, v220, v221
  v_mfma_f32_16x16x32_bf16 v[108:111], a[156:159], v[60:63], v[108:111]
  v_exp_f32 v209, v113
  v_mfma_f32_16x16x32_bf16 v[132:135], a[156:159], v[88:91], v[132:135]
  s_add_u32 m0, s34, 0
  v_exp_f32 v210, v114
  v_mfma_f32_16x16x32_bf16 v[140:143], a[156:159], v[92:95], v[140:143]
  s_waitcnt lgkmcnt(4)
  buffer_load_dwordx4 v8, s[52:55], s33 offen offset:0 lds
  v_add_f32 v227, v227, v222
  v_mfma_f32_16x16x32_bf16 a[0:3], a[160:163], v[160:163], a[0:3]
  ds_read_b128 a[128:131], v3 offset:0
  v_add_f32 v227, v227, v223
  v_mfma_f32_16x16x32_bf16 a[4:7], a[160:163], v[164:167], a[4:7]
  v_exp_f32 v211, v115
  v_mfma_f32_16x16x32_bf16 a[64:67], a[160:163], v[176:179], a[64:67]
  v_cvt_pk_bf16_f32 v191, v222, v223
  v_add_f32 v224, v208, v209
  v_cvt_pk_bf16_f32 v168, v208, v209
  v_mfma_f32_16x16x32_bf16 a[68:71], a[160:163], v[180:183], a[68:71]
  v_exp_f32 v212, v116
  v_mfma_f32_16x16x32_bf16 a[8:11], a[164:167], v[160:163], a[8:11]
  ds_read_b128 a[132:135], v3 offset:1024
  v_add_f32 v224, v224, v210
  v_mfma_f32_16x16x32_bf16 a[12:15], a[164:167], v[164:167], a[12:15]
  buffer_load_dwordx4 v11, s[52:55], s33 offen offset:1024 lds
  v_add_f32 v224, v224, v211
  v_mfma_f32_16x16x32_bf16 a[72:75], a[164:167], v[176:179], a[72:75]
  v_exp_f32 v213, v117
  v_mfma_f32_16x16x32_bf16 a[76:79], a[164:167], v[180:183], a[76:79]
  v_exp_f32 v214, v118
  v_mfma_f32_16x16x32_bf16 a[16:19], a[168:171], v[160:163], a[16:19]
  ds_read_b128 a[136:139], v3 offset:2048
  v_cvt_pk_bf16_f32 v169, v210, v211
  v_mfma_f32_16x16x32_bf16 a[20:23], a[168:171], v[164:167], a[20:23]
  v_exp_f32 v215, v119
  v_mfma_f32_16x16x32_bf16 a[80:83], a[168:171], v[176:179], a[80:83]
  v_add_f32 v224, v224, v212
  v_add_f32 v224, v224, v213
  v_cvt_pk_bf16_f32 v170, v212, v213
  v_mfma_f32_16x16x32_bf16 a[84:87], a[168:171], v[180:183], a[84:87]
  buffer_load_dwordx4 v12, s[52:55], s33 offen offset:2048 lds
  v_add_f32 v224, v224, v214
  v_mfma_f32_16x16x32_bf16 a[24:27], a[172:175], v[160:163], a[24:27]
  ds_read_b128 a[140:143], v3 offset:3072
  v_add_f32 v224, v224, v215
  v_mfma_f32_16x16x32_bf16 a[28:31], a[172:175], v[164:167], a[28:31]
  v_exp_f32 v208, v120
  v_mfma_f32_16x16x32_bf16 a[88:91], a[172:175], v[176:179], a[88:91]
  v_exp_f32 v209, v121
  v_mfma_f32_16x16x32_bf16 a[92:95], a[172:175], v[180:183], a[92:95]
  s_waitcnt lgkmcnt(4)
  v_exp_f32 v210, v122
  v_mfma_f32_16x16x32_bf16 a[32:35], a[176:179], v[160:163], a[32:35]
  ds_read_b128 a[144:147], v3 offset:4096
  v_cvt_pk_bf16_f32 v171, v214, v215
  v_mfma_f32_16x16x32_bf16 a[36:39], a[176:179], v[164:167], a[36:39]
  buffer_load_dwordx4 v13, s[52:55], s33 offen offset:3072 lds
  v_add_f32 v225, v208, v209
  v_mfma_f32_16x16x32_bf16 a[96:99], a[176:179], v[176:179], a[96:99]
  v_exp_f32 v211, v123
  v_mfma_f32_16x16x32_bf16 a[100:103], a[176:179], v[180:183], a[100:103]
  v_exp_f32 v212, v124
  v_mfma_f32_16x16x32_bf16 a[40:43], a[180:183], v[160:163], a[40:43]
  ds_read_b128 a[148:151], v3 offset:5120
  v_cvt_pk_bf16_f32 v172, v208, v209
  v_add_f32 v225, v225, v210
  v_mfma_f32_16x16x32_bf16 a[44:47], a[180:183], v[164:167], a[44:47]
  v_exp_f32 v213, v125
  v_mfma_f32_16x16x32_bf16 a[104:107], a[180:183], v[176:179], a[104:107]
  s_add_u32 m0, s34, 4096
  v_add_f32 v225, v225, v211
  v_cvt_pk_bf16_f32 v173, v210, v211
  v_mfma_f32_16x16x32_bf16 a[108:111], a[180:183], v[180:183], a[108:111]
  buffer_load_dwordx4 v14, s[52:55], s33 offen offset:0 lds
  v_max3_f32 v5, v226, v227, v224
  v_mfma_f32_16x16x32_bf16 a[48:51], a[184:187], v[160:163], a[48:51]
  ds_read_b128 a[152:155], v3 offset:6144
  v_add_f32 v225, v225, v212
  v_mfma_f32_16x16x32_bf16 a[52:55], a[184:187], v[164:167], a[52:55]
  v_exp_f32 v214, v126
  v_mfma_f32_16x16x32_bf16 a[112:115], a[184:187], v[176:179], a[112:115]
  v_exp_f32 v215, v127
  v_mfma_f32_16x16x32_bf16 a[116:119], a[184:187], v[180:183], a[116:119]
  v_add_f32 v225, v225, v213
  v_cvt_pk_bf16_f32 v174, v212, v213
  v_add_f32 v225, v225, v214
  v_mfma_f32_16x16x32_bf16 a[56:59], a[188:191], v[160:163], a[56:59]
  ds_read_b128 a[156:159], v3 offset:7168
  v_add_f32 v225, v225, v215
  v_max_f32 v5, v5, v225
  v_cmp_lt_f32 vcc, s81, v5
  v_mfma_f32_16x16x32_bf16 a[60:63], a[188:191], v[164:167], a[60:63]
  v_exp_f32 v216, v128
  v_mfma_f32_16x16x32_bf16 a[120:123], a[188:191], v[176:179], a[120:123]
  s_waitcnt lgkmcnt(4)
  v_cvt_pk_bf16_f32 v175, v214, v215
  v_mfma_f32_16x16x32_bf16 a[124:127], a[188:191], v[180:183], a[124:127]
  s_cbranch_vccnz fa_stub3
fa_back3:
  v_exp_f32 v217, v129
  v_add_f32 v228, v228, v224
  v_add_f32 v229, v229, v225
  v_add_f32 v230, v230, v226
  v_add_f32 v231, v231, v227
  s_branch fa_DDe
fa_kv2_spin:
  s_mov_b32 s83, 200000
fa_kv2_spin2:
  buffer_load_dword v14, v13, s[40:43], 0 offen sc1
  s_waitcnt vmcnt(0)
  v_cmp_eq_u32 vcc, 0, v14
  s_cbranch_vccz fa_kv2_ok
  s_sleep 8
  s_sub_u32 s83, s83, 1
  s_cmp_lg_u32 s83, 0
  s_cbranch_scc1 fa_kv2_spin2
  s_branch fa_kv2_ok
fa_kv3_spin:
  s_mov_b32 s83, 200000
fa_kv3_spin2:
  buffer_load_dword v14, v13, s[40:43], 0 offen sc1
  s_waitcnt vmcnt(0)
  v_cmp_eq_u32 vcc, 0, v14
  s_cbranch_vccz fa_kv3_ok
  s_sleep 8
  s_sub_u32 s83, s83, 1
  s_cmp_lg_u32 s83, 0
  s_cbranch_scc1 fa_kv3_spin2
  s_branch fa_kv3_ok
fa_sel_spin:
  s_mov_b32 s83, 200000
fa_sel_spin2:
  buffer_load_dword v15, v252, s[40:43], 0 offen sc1
  s_waitcnt vmcnt(0)
  v_cmp_eq_u32 vcc, 0, v15
  s_cbranch_vccz fa_sel_ok
  s_sleep 8
  s_sub_u32 s83, s83, 1
  s_cmp_lg_u32 s83, 0
  s_cbranch_scc1 fa_sel_spin2
  s_branch fa_sel_ok
fa_wof_spin:
  s_mov_b32 s83, 200000
fa_wof_spin2:
  buffer_load_dword v8, v9, s[40:43], 0 offen sc1
  s_waitcnt vmcnt(0)
  v_cmp_eq_u32 vcc, 0, v8
  s_cbranch_vccz fa_wof_ok
  s_sleep 8
  s_sub_u32 s83, s83, 1
  s_cmp_lg_u32 s83, 0
  s_cbranch_scc1 fa_wof_spin2
  s_branch fa_wof_ok
fa_sel4_spin:
  s_mov_b32 s83, 200000
fa_sel4_spin2:
  buffer_load_dword v15, v10, s[40:43], 0 offen sc1
  s_waitcnt vmcnt(0)
  v_cmp_eq_u32 vcc, 0, v15
  s_cbranch_vccz fa_sel4_ok
  s_sleep 8
  s_sub_u32 s83, s83, 1
  s_cmp_lg_u32 s83, 0
  s_cbranch_scc1 fa_sel4_spin2
  s_branch fa_sel4_ok
fa_yf_spin:
  s_mov_b32 s83, 200000
fa_yf_spin2:
  buffer_load_dword v14, v11, s[40:43], 0 offen sc1
  s_waitcnt vmcnt(0)
  v_cmp_eq_u32 vcc, 0, v14
  s_cbranch_vccz fa_yf_ok
  s_sleep 8
  s_sub_u32 s83, s83, 1
  s_cmp_lg_u32 s83, 0
  s_cbranch_scc1 fa_yf_spin2
  s_branch fa_yf_ok
fa_co:
  s_sub_u32 s14, s2, 64
  s_cmp_lt_u32 s14, 96
  s_cbranch_scc1 fa_coT
  s_sub_u32 s14, s2, 128
  s_sub_u32 s23, s2, 224
  s_cmp_lt_u32 s23, 31
  s_cbranch_scc1 fa_coT
  v_cmp_eq_u32 vcc, 0, v14
  s_cbranch_vccnz fa_kv2_spin
fa_kv2_ok:
  s_sub_u32 s14, s2, 170
  s_cmp_lt_u32 s14, 54
  s_cbranch_scc1 fa_coF
  s_cmp_eq_u32 s2, 255
  s_cbranch_scc1 fa_coW
  s_branch fa_coO
fa_coT:
  v_min_u32 v8, 16, v1
  v_lshlrev_b32 v8, 7, v8
  s_lshl_b32 s10, s14, 1
  s_and_b32 s31, s20, 1
  s_add_u32 s10, s10, s31
  s_mul_i32 s10, s10, 2176
  s_lshl_b32 s35, s14, 2
  s_add_u32 s35, s35, s20
  s_mul_i32 s35, s35, 4352
  buffer_load_dword v255, v8, s[52:55], s10 offen
  s_add_u32 s10, s10, 552960
  s_getpc_b64 s[36:37]
  s_setpc_b64 s[38:39]
  buffer_load_dword v255, v8, s[52:55], s10 offen
  s_add_u32 s10, s10, 552960
  s_getpc_b64 s[36:37]
  s_setpc_b64 s[38:39]
  v_cmp_eq_u32 vcc, 0, v14
  s_cbranch_vccnz fa_kv3_spin
fa_kv3_ok:
  buffer_load_dword v255, v8, s[52:55], s10 offen
  s_add_u32 s10, s10, 552960
  buffer_load_dword v255, v8, s[60:63], s35 offen offset:0
  s_getpc_b64 s[36:37]
  s_setpc_b64 s[38:39]
  buffer_load_dword v255, v8, s[52:55], s10 offen
  s_add_u32 s10, s10, 552960
  buffer_load_dword v255, v8, s[60:63], s35 offen offset:2176
  s_mov_b32 s9, -1
  s_and_b32 s32, s21, 3
  s_lshr_b32 s32, s32, 1
  s_add_u32 s32, s32, 6
  s_lshl_b32 s32, s32, 14
  s_getpc_b64 s[36:37]
  s_setpc_b64 s[38:39]
fa_coO:
  s_and_b32 s23, s67, 1
  s_lshl_b32 s23, s23, 2
  s_add_u32 s23, s23, s20
  s_lshr_b32 s31, s67, 1
  s_mul_i32 s33, s23, 0
  s_add_u32 s33, s33, s31
  s_and_b32 s33, s33, 31
  s_andn2_b32 s30, s31, 31
  s_add_u32 s33, s33, s30
  s_lshl_b32 s30, s23, 7
  s_add_u32 s30, s30, s33
  s_mul_i32 s33, s31, 40960
  s_mul_i32 s23, s23, 160
  s_add_u32 s33, s33, s23
  s_add_u32 m0, s34, 0
  v_accvgpr_read_b32 v19, a248
  buffer_load_dwordx4 v19, s[56:59], s33 offen lds
  s_add_u32 m0, s34, 1024
  v_accvgpr_read_b32 v19, a249
  buffer_load_dwordx4 v19, s[56:59], s33 offen lds
  s_add_u32 m0, s34, 2048
  v_accvgpr_read_b32 v19, a250
  buffer_load_dwordx4 v19, s[56:59], s33 offen lds
  s_add_u32 m0, s34, 3072
  v_accvgpr_read_b32 v19, a251
  buffer_load_dwordx4 v19, s[56:59], s33 offen lds
  s_add_u32 m0, s34, 4096
  v_accvgpr_read_b32 v19, a252
  buffer_load_dwordx4 v19, s[56:59], s33 offen lds
  s_add_u32 s32, s26, 32768
  s_mov_b32 s9, -1
  s_lshl_b32 s10, s30, 2
  s_mul_i32 s30, s30, 5120
  s_add_u32 s30, s30, 4194304
  s_getpc_b64 s[36:37]
  s_setpc_b64 s[38:39]
  s_waitcnt vmcnt(8)
  ds_read_b64_tr_b16 v[232:233], v6 offset:0
  ds_read_b64_tr_b16 v[234:235], v6 offset:2560
  ds_read_b64_tr_b16 v[236:237], v6 offset:32
  ds_read_b64_tr_b16 v[238:239], v6 offset:2592
  ds_read_b64_tr_b16 v[240:241], v6 offset:64
  ds_read_b64_tr_b16 v[242:243], v6 offset:2624
  ds_read_b64_tr_b16 v[244:245], v6 offset:96
  ds_read_b64_tr_b16 v[246:247], v6 offset:2656
  ds_read_b64_tr_b16 v[248:249], v6 offset:128
  ds_read_b64_tr_b16 v[250:251], v6 offset:2688
  s_waitcnt lgkmcnt(0)
  s_add_u32 s31, s30, 4096
  buffer_store_dwordx4 v[232:235], v2, s[40:43], s30 offen offset:0 sc1
  buffer_store_dwordx4 v[236:239], v2, s[40:43], s30 offen offset:1024 sc1
  buffer_store_dwordx4 v[240:243], v2, s[40:43], s30 offen offset:2048 sc1
  buffer_store_dwordx4 v[244:247], v2, s[40:43], s30 offen offset:3072 sc1
  buffer_store_dwordx4 v[248:251], v2, s[40:43], s31 offen offset:0 sc1
  s_getpc_b64 s[36:37]
  s_setpc_b64 s[38:39]
  s_add_u32 s23, s10, 2654208
  s_waitcnt vmcnt(8)
  buffer_store_dword v4, off, s[40:43], s23 sc1
  s_cmp_lg_u32 s67, s2
  s_cbranch_scc1 fa_coW
  s_sub_u32 s23, s2, 64
  s_sub_u32 s31, s2, 192
  s_cmp_lt_u32 s23, 32
  s_cselect_b32 s23, s23, s31
  s_cmp_gt_u32 s23, 54
  s_cbranch_scc1 fa_coW
  s_add_u32 s67, s23, 170
  s_cmp_eq_u32 s67, 224
  s_cselect_b32 s67, 255, s67
  s_branch fa_coO
fa_coF:
  v_and_b32 v16, 7, v1
  v_lshlrev_b32 v252, 2, v16
  v_add_u32 v252, 2629632, v252
  buffer_load_dword v15, v252, s[40:43], 0 offen sc1
  s_lshl_b32 s33, s14, 6
  s_and_b32 s31, s20, 1
  s_lshl_b32 s31, s31, 5
  s_add_u32 s33, s33, s31
  s_mul_i32 s35, s14, 40960
  s_mul_i32 s31, s20, 320
  s_add_u32 s35, s35, s31
  s_mul_i32 s10, s14, 20480
  s_mul_i32 s31, s20, 640
  s_add_u32 s10, s10, s31
  s_add_u32 s10, s10, 2686976
  v_lshrrev_b32 v17, 1, v1
  v_mul_u32_u24 v8, 3456, v17
  v_and_b32 v17, 1, v1
  v_lshl_add_u32 v8, v17, 4, v8
  v_add_u32 v11, 109568, v8
  v_add_u32 v12, 219136, v8
  v_add_u32 v13, 328704, v8
  v_add_u32 v14, 442368, v8
  v_lshrrev_b32 v17, 4, v1
  v_lshrrev_b32 v18, 2, v1
  v_lshl_add_u32 v18, v17, 2, v18
  v_lshlrev_b32 v18, 5, v18
  v_and_b32 v19, 3, v1
  v_lshl_add_u32 v9, v19, 3, v18
  v_add_u32 v9, s34, v9
  v_lshlrev_b32 v10, 4, v16
  v_lshl_add_u32 v10, v17, 7, v10
  v_add_u32 v10, 151552, v10
  s_mov_b32 s8, -1
  v_mov_b32 v232, 0
  v_mov_b32 v233, 0
  v_mov_b32 v234, 0
  v_mov_b32 v235, 0
  s_getpc_b64 s[36:37]
  s_setpc_b64 s[38:39]
  s_waitcnt vmcnt(8)
  v_cmp_eq_u32 vcc, 0, v15
  s_cbranch_vccnz fa_sel_spin
fa_sel_ok:
  v_add_u32 v18, -1, v15
  v_and_b32 v18, 2047, v18
  v_lshrrev_b32 v19, 4, v18
  v_mul_u32_u24 v19, 20480, v19
  v_and_b32 v18, 15, v18
  v_lshl_add_u32 v19, v18, 4, v19
  v_lshrrev_b32 v18, 3, v1
  v_lshl_add_u32 v19, v18, 8, v19
  s_lshl_b32 s23, s20, 11
  s_lshl_b32 s31, s20, 10
  s_add_u32 s31, s31, 151552
  s_mov_b32 s14, 4
  s_mov_b32 m0, s31
  s_add_u32 s31, s31, 4096
  buffer_load_dwordx4 v19, s[40:43], s23 offen sc1 lds
  s_add_u32 s23, s23, 8192
  s_mov_b32 m0, s31
  s_add_u32 s31, s31, 4096
  buffer_load_dwordx4 v19, s[40:43], s23 offen sc1 lds
  s_add_u32 s23, s23, 8192
  s_mov_b32 m0, s31
  s_add_u32 s31, s31, 4096
  buffer_load_dwordx4 v19, s[40:43], s23 offen sc1 lds
  s_add_u32 s23, s23, 8192
  s_getpc_b64 s[36:37]
  s_setpc_b64 s[38:39]
  s_branch fa_coG1
fa_coG:
  s_getpc_b64 s[36:37]
  s_setpc_b64 s[38:39]
  v_mfma_f32_16x16x32_bf16 v[232:235], a[192:195], a[212:215], v[232:235]
  v_mfma_f32_16x16x32_bf16 v[232:235], a[196:199], a[216:219], v[232:235]
  v_mfma_f32_16x16x32_bf16 v[232:235], a[200:203], a[220:223], v[232:235]
  v_mfma_f32_16x16x32_bf16 v[232:235], a[204:207], a[224:227], v[232:235]
  v_mfma_f32_16x16x32_bf16 v[232:235], a[208:211], a[228:231], v[232:235]
fa_coG1:
  s_waitcnt vmcnt(4)
  ds_read_b64_tr_b16 a[192:193], v9 offset:0
  ds_read_b64_tr_b16 a[194:195], v9 offset:128
  ds_read_b128 a[212:215], v10 offset:0
  ds_read_b64_tr_b16 a[196:197], v9 offset:1024
  ds_read_b64_tr_b16 a[198:199], v9 offset:1152
  ds_read_b128 a[216:219], v10 offset:512
  ds_read_b64_tr_b16 a[200:201], v9 offset:2048
  ds_read_b64_tr_b16 a[202:203], v9 offset:2176
  ds_read_b128 a[220:223], v10 offset:1024
  ds_read_b64_tr_b16 a[204:205], v9 offset:3072
  ds_read_b64_tr_b16 a[206:207], v9 offset:3200
  ds_read_b128 a[224:227], v10 offset:1536
  ds_read_b64_tr_b16 a[208:209], v9 offset:4096
  ds_read_b64_tr_b16 a[210:211], v9 offset:4224
  ds_read_b128 a[228:231], v10 offset:2048
  v_add_u32 v10, 2560, v10
  s_add_u32 s33, s33, 552960
  s_sub_u32 s14, s14, 1
  s_cmp_lg_u32 s14, 0
  s_cbranch_scc1 fa_coG
  v_accvgpr_read_b32 v8, a248
  v_accvgpr_read_b32 v11, a249
  v_accvgpr_read_b32 v12, a250
  v_accvgpr_read_b32 v13, a251
  v_accvgpr_read_b32 v14, a252
  v_subrev_u32 v11, 1024, v11
  v_subrev_u32 v12, 2048, v12
  v_subrev_u32 v13, 3072, v13
  s_mov_b32 s52, s60
  s_mov_b32 s53, s61
  s_mov_b32 s33, s35
  s_lshl_b32 s23, s20, 9
  v_add_u32 v16, s23, v10
  v_and_b32 v17, 7, v1
  v_mul_u32_u24 v9, 2560, v17
  v_lshrrev_b32 v17, 4, v1
  v_lshl_add_u32 v9, v17, 4, v9
  v_and_b32 v17, 8, v1
  v_lshl_add_u32 v9, v17, 27, v9
  s_waitcnt lgkmcnt(0)
  v_mfma_f32_16x16x32_bf16 v[232:235], a[192:195], a[212:215], v[232:235]
  v_mfma_f32_16x16x32_bf16 v[232:235], a[196:199], a[216:219], v[232:235]
  v_mfma_f32_16x16x32_bf16 v[232:235], a[200:203], a[220:223], v[232:235]
  v_mfma_f32_16x16x32_bf16 v[232:235], a[204:207], a[224:227], v[232:235]
  v_mfma_f32_16x16x32_bf16 v[232:235], a[208:211], a[228:231], v[232:235]
  s_nop 7
  ds_write_b128 v16, v[232:235]
  s_getpc_b64 s[36:37]
  s_setpc_b64 s[38:39]
  ds_read_b128 v[236:239], v10 offset:0
  ds_read_b128 v[240:243], v10 offset:512
  ds_read_b128 v[244:247], v10 offset:1024
  ds_read_b128 v[248:251], v10 offset:1536
  s_waitcnt vmcnt(4)
  ds_read_b64_tr_b16 a[192:193], v6 offset:0
  ds_read_b64_tr_b16 a[194:195], v6 offset:2560
  ds_read_b64_tr_b16 a[196:197], v6 offset:32
  ds_read_b64_tr_b16 a[198:199], v6 offset:2592
  ds_read_b64_tr_b16 a[200:201], v6 offset:64
  ds_read_b64_tr_b16 a[202:203], v6 offset:2624
  ds_read_b64_tr_b16 a[204:205], v6 offset:96
  ds_read_b64_tr_b16 a[206:207], v6 offset:2656
  ds_read_b64_tr_b16 a[208:209], v6 offset:128
  ds_read_b64_tr_b16 a[210:211], v6 offset:2688
  s_add_u32 s33, s33, 160
  s_mov_b32 s8, 0
  s_waitcnt lgkmcnt(10)
  v_cvt_pk_bf16_f32 v236, v236, v244
  v_cvt_pk_bf16_f32 v237, v237, v245
  v_cvt_pk_bf16_f32 v238, v238, v246
  v_cvt_pk_bf16_f32 v239, v239, v247
  v_cvt_pk_bf16_f32 v240, v240, v248
  v_cvt_pk_bf16_f32 v241, v241, v249
  v_cvt_pk_bf16_f32 v242, v242, v250
  v_cvt_pk_bf16_f32 v243, v243, v251
  v_lshlrev_b32 v244, 16, v236
  v_lshlrev_b32 v245, 16, v237
  v_lshlrev_b32 v246, 16, v238
  v_lshlrev_b32 v247, 16, v239
  v_lshlrev_b32 v248, 16, v240
  v_lshlrev_b32 v249, 16, v241
  v_lshlrev_b32 v250, 16, v242
  v_lshlrev_b32 v251, 16, v243
  v_mul_f32 v16, 0xbfb8aa3b, v244
  v_mul_f32 v17, 0xbfb8aa3b, v245
  v_mul_f32 v18, 0xbfb8aa3b, v246
  v_mul_f32 v19, 0xbfb8aa3b, v247
  v_mul_f32 v20, 0xbfb8aa3b, v248
  v_mul_f32 v21, 0xbfb8aa3b, v249
  v_mul_f32 v22, 0xbfb8aa3b, v250
  v_mul_f32 v23, 0xbfb8aa3b, v251
  v_exp_f32 v16, v16
  v_exp_f32 v17, v17
  v_exp_f32 v18, v18
  v_exp_f32 v19, v19
  v_exp_f32 v20, v20
  v_exp_f32 v21, v21
  v_exp_f32 v22, v22
  v_exp_f32 v23, v23
  v_add_f32 v16, 1.0, v16
  v_add_f32 v17, 1.0, v17
  v_add_f32 v18, 1.0, v18
  v_add_f32 v19, 1.0, v19
  v_add_f32 v20, 1.0, v20
  v_add_f32 v21, 1.0, v21
  v_add_f32 v22, 1.0, v22
  v_add_f32 v23, 1.0, v23
  v_rcp_f32 v16, v16
  v_rcp_f32 v17, v17
  v_rcp_f32 v18, v18
  v_rcp_f32 v19, v19
  v_rcp_f32 v20, v20
  v_rcp_f32 v21, v21
  v_rcp_f32 v22, v22
  v_rcp_f32 v23, v23
  v_and_b32 v236, 0xffff0000, v236
  v_and_b32 v237, 0xffff0000, v237
  v_and_b32 v238, 0xffff0000, v238
  v_and_b32 v239, 0xffff0000, v239
  v_and_b32 v240, 0xffff0000, v240
  v_and_b32 v241, 0xffff0000, v241
  v_and_b32 v242, 0xffff0000, v242
  v_and_b32 v243, 0xffff0000, v243
  v_pk_mul_f32 v[244:245], v[244:245], v[16:17]
  v_pk_mul_f32 v[246:247], v[246:247], v[18:19]
  v_pk_mul_f32 v[248:249], v[248:249], v[20:21]
  v_pk_mul_f32 v[250:251], v[250:251], v[22:23]
  v_cvt_pk_bf16_f32 v16, v244, v245
  v_cvt_pk_bf16_f32 v17, v246, v247
  v_cvt_pk_bf16_f32 v18, v248, v249
  v_cvt_pk_bf16_f32 v19, v250, v251
  v_lshlrev_b32 v244, 16, v16
  v_and_b32 v245, 0xffff0000, v16
  v_lshlrev_b32 v246, 16, v17
  v_and_b32 v247, 0xffff0000, v17
  v_lshlrev_b32 v248, 16, v18
  v_and_b32 v249, 0xffff0000, v18
  v_lshlrev_b32 v250, 16, v19
  v_and_b32 v251, 0xffff0000, v19
  v_pk_mul_f32 v[236:237], v[236:237], v[244:245]
  v_pk_mul_f32 v[238:239], v[238:239], v[246:247]
  v_pk_mul_f32 v[240:241], v[240:241], v[248:249]
  v_pk_mul_f32 v[242:243], v[242:243], v[250:251]
  v_cvt_pk_bf16_f32 v232, v236, v237
  v_cvt_pk_bf16_f32 v233, v238, v239
  v_cvt_pk_bf16_f32 v234, v240, v241
  v_cvt_pk_bf16_f32 v235, v242, v243
  s_nop 0
  s_waitcnt lgkmcnt(0)
  v_mfma_f32_16x16x32_bf16 v[236:239], a[192:195], v[232:235], 0
  v_mfma_f32_16x16x32_bf16 v[240:243], a[196:199], v[232:235], 0
  v_mfma_f32_16x16x32_bf16 v[244:247], a[200:203], v[232:235], 0
  v_mfma_f32_16x16x32_bf16 v[248:251], a[204:207], v[232:235], 0
  v_mfma_f32_16x16x32_bf16 v[252:255], a[208:211], v[232:235], 0
  s_nop 3
  buffer_store_dwordx4 v[236:239], v9, s[40:43], s10 offen offset:0 sc1
  buffer_store_dwordx4 v[240:243], v9, s[40:43], s10 offen offset:64 sc1
  buffer_store_dwordx4 v[244:247], v9, s[40:43], s10 offen offset:128 sc1
  buffer_store_dwordx4 v[248:251], v9, s[40:43], s10 offen offset:192 sc1
  buffer_store_dwordx4 v[252:255], v9, s[40:43], s10 offen offset:256 sc1
  s_add_u32 s10, s10, 320
  s_getpc_b64 s[36:37]
  s_setpc_b64 s[38:39]
  s_waitcnt vmcnt(4)
  ds_read_b64_tr_b16 a[192:193], v6 offset:0
  ds_read_b64_tr_b16 a[194:195], v6 offset:2560
  ds_read_b64_tr_b16 a[196:197], v6 offset:32
  ds_read_b64_tr_b16 a[198:199], v6 offset:2592
  ds_read_b64_tr_b16 a[200:201], v6 offset:64
  ds_read_b64_tr_b16 a[202:203], v6 offset:2624
  ds_read_b64_tr_b16 a[204:205], v6 offset:96
  ds_read_b64_tr_b16 a[206:207], v6 offset:2656
  ds_read_b64_tr_b16 a[208:209], v6 offset:128
  ds_read_b64_tr_b16 a[210:211], v6 offset:2688
  s_waitcnt lgkmcnt(0)
  v_mfma_f32_16x16x32_bf16 v[236:239], a[192:195], v[232:235], 0
  v_mfma_f32_16x16x32_bf16 v[240:243], a[196:199], v[232:235], 0
  v_mfma_f32_16x16x32_bf16 v[244:247], a[200:203], v[232:235], 0
  v_mfma_f32_16x16x32_bf16 v[248:251], a[204:207], v[232:235], 0
  v_mfma_f32_16x16x32_bf16 v[252:255], a[208:211], v[232:235], 0
  s_nop 3
  buffer_store_dwordx4 v[236:239], v9, s[40:43], s10 offen offset:0 sc1
  buffer_store_dwordx4 v[240:243], v9, s[40:43], s10 offen offset:64 sc1
  buffer_store_dwordx4 v[244:247], v9, s[40:43], s10 offen offset:128 sc1
  buffer_store_dwordx4 v[248:251], v9, s[40:43], s10 offen offset:192 sc1
  buffer_store_dwordx4 v[252:255], v9, s[40:43], s10 offen offset:256 sc1
  s_add_u32 s10, s10, 320
  s_getpc_b64 s[36:37]
  s_setpc_b64 s[38:39]
  s_sub_u32 s23, s2, 170
  s_lshl_b32 s31, s20, 6
  s_add_u32 s23, s23, s31
  s_lshl_b32 s23, s23, 2
  s_add_u32 s23, s23, 2650112
  s_waitcnt vmcnt(8)
  buffer_store_dword v4, off, s[40:43], s23 sc1
fa_coW:
  s_mov_b32 s12, 1
  s_mov_b32 s9, -1
  s_cmp_lg_u32 s11, 0
  s_cselect_b32 s32, s15, -1
  s_getpc_b64 s[36:37]
  s_setpc_b64 s[38:39]
  s_lshl_b32 s23, s22, 2
  s_add_u32 s23, s23, s20
  s_mul_i32 s13, s23, 163840
  s_add_u32 s13, s13, 4194304
  s_lshl_b32 s23, s23, 7
  s_add_u32 s23, s23, 2654208
  v_and_b32 v9, 31, v1
  v_lshl_add_u32 v9, v9, 2, s23
  v_and_b32 v10, 15, v1
  v_lshlrev_b32 v10, 2, v10
  v_add_u32 v10, 2629632, v10
  buffer_load_dword v8, v9, s[40:43], 0 offen sc1
  buffer_load_dword v15, v10, s[40:43], 0 offen sc1
  v_mov_b32 v20, v228
  v_mov_b32 v21, v229
  s_nop 1
  v_permlane16_swap_b32 v228, v20
  v_permlane16_swap_b32 v229, v21
  v_add_f32 v228, v228, v20
  v_add_f32 v229, v229, v21
  v_mov_b32 v20, v228
  v_mov_b32 v21, v229
  s_nop 1
  v_permlane32_swap_b32 v228, v20
  v_permlane32_swap_b32 v229, v21
  v_add_f32 v228, v228, v20
  v_add_f32 v229, v229, v21
  v_rcp_f32 v16, v228
  v_rcp_f32 v18, v229
  s_lshl_b32 s23, s22, 2
  v_mov_b32 v17, v16
  v_mov_b32 v19, v18
  s_add_u32 s23, s23, s20
  s_lshl_b32 s23, s23, 18
  s_lshl_b32 s31, s21, 12
  s_add_u32 s31, s31, 50331648
  s_add_u32 s64, s23, s31
  s_add_u32 s65, s64, 131072
  v_accvgpr_read_b32 v36, a0
  v_accvgpr_read_b32 v37, a1
  v_accvgpr_read_b32 v38, a2
  v_accvgpr_read_b32 v39, a3
  v_accvgpr_read_b32 v40, a8
  v_accvgpr_read_b32 v41, a9
  v_accvgpr_read_b32 v42, a10
  v_accvgpr_read_b32 v43, a11
  v_pk_mul_f32 v[36:37], v[36:37], v[16:17]
  v_pk_mul_f32 v[38:39], v[38:39], v[16:17]
  v_pk_mul_f32 v[40:41], v[40:41], v[16:17]
  v_pk_mul_f32 v[42:43], v[42:43], v[16:17]
  v_cvt_pk_bf16_f32 v32, v36, v37
  v_cvt_pk_bf16_f32 v33, v38, v39
  v_cvt_pk_bf16_f32 v34, v40, v41
  v_cvt_pk_bf16_f32 v35, v42, v43
  buffer_store_dwordx4 v[32:35], v2, s[40:43], s64 offen offset:0 sc1
  v_accvgpr_read_b32 v48, a16
  v_accvgpr_read_b32 v49, a17
  v_accvgpr_read_b32 v50, a18
  v_accvgpr_read_b32 v51, a19
  v_accvgpr_read_b32 v52, a24
  v_accvgpr_read_b32 v53, a25
  v_accvgpr_read_b32 v54, a26
  v_accvgpr_read_b32 v55, a27
  v_pk_mul_f32 v[48:49], v[48:49], v[16:17]
  v_pk_mul_f32 v[50:51], v[50:51], v[16:17]
  v_pk_mul_f32 v[52:53], v[52:53], v[16:17]
  v_pk_mul_f32 v[54:55], v[54:55], v[16:17]
  v_cvt_pk_bf16_f32 v44, v48, v49
  v_cvt_pk_bf16_f32 v45, v50, v51
  v_cvt_pk_bf16_f32 v46, v52, v53
  v_cvt_pk_bf16_f32 v47, v54, v55
  buffer_store_dwordx4 v[44:47], v2, s[40:43], s64 offen offset:1024 sc1
  v_accvgpr_read_b32 v100, a32
  v_accvgpr_read_b32 v101, a33
  v_accvgpr_read_b32 v102, a34
  v_accvgpr_read_b32 v103, a35
  v_accvgpr_read_b32 v104, a40
  v_accvgpr_read_b32 v105, a41
  v_accvgpr_read_b32 v106, a42
  v_accvgpr_read_b32 v107, a43
  v_pk_mul_f32 v[100:101], v[100:101], v[16:17]
  v_pk_mul_f32 v[102:103], v[102:103], v[16:17]
  v_pk_mul_f32 v[104:105], v[104:105], v[16:17]
  v_pk_mul_f32 v[106:107], v[106:107], v[16:17]
  v_cvt_pk_bf16_f32 v96, v100, v101
  v_cvt_pk_bf16_f32 v97, v102, v103
  v_cvt_pk_bf16_f32 v98, v104, v105
  v_cvt_pk_bf16_f32 v99, v106, v107
  buffer_store_dwordx4 v[96:99], v2, s[40:43], s64 offen offset:2048 sc1
  v_accvgpr_read_b32 v112, a48
  v_accvgpr_read_b32 v113, a49
  v_accvgpr_read_b32 v114, a50
  v_accvgpr_read_b32 v115, a51
  v_accvgpr_read_b32 v116, a56
  v_accvgpr_read_b32 v117, a57
  v_accvgpr_read_b32 v118, a58
  v_accvgpr_read_b32 v119, a59
  v_pk_mul_f32 v[112:113], v[112:113], v[16:17]
  v_pk_mul_f32 v[114:115], v[114:115], v[16:17]
  v_pk_mul_f32 v[116:117], v[116:117], v[16:17]
  v_pk_mul_f32 v[118:119], v[118:119], v[16:17]
  v_cvt_pk_bf16_f32 v108, v112, v113
  v_cvt_pk_bf16_f32 v109, v114, v115
  v_cvt_pk_bf16_f32 v110, v116, v117
  v_cvt_pk_bf16_f32 v111, v118, v119
  buffer_store_dwordx4 v[108:111], v2, s[40:43], s64 offen offset:3072 sc1
  v_accvgpr_read_b32 v36, a4
  v_accvgpr_read_b32 v37, a5
  v_accvgpr_read_b32 v38, a6
  v_accvgpr_read_b32 v39, a7
  v_accvgpr_read_b32 v40, a12
  v_accvgpr_read_b32 v41, a13
  v_accvgpr_read_b32 v42, a14
  v_accvgpr_read_b32 v43, a15
  v_pk_mul_f32 v[36:37], v[36:37], v[18:19]
  v_pk_mul_f32 v[38:39], v[38:39], v[18:19]
  v_pk_mul_f32 v[40:41], v[40:41], v[18:19]
  v_pk_mul_f32 v[42:43], v[42:43], v[18:19]
  v_cvt_pk_bf16_f32 v32, v36, v37
  v_cvt_pk_bf16_f32 v33, v38, v39
  v_cvt_pk_bf16_f32 v34, v40, v41
  v_cvt_pk_bf16_f32 v35, v42, v43
  buffer_store_dwordx4 v[32:35], v2, s[40:43], s65 offen offset:0 sc1
  v_accvgpr_read_b32 v48, a20
  v_accvgpr_read_b32 v49, a21
  v_accvgpr_read_b32 v50, a22
  v_accvgpr_read_b32 v51, a23
  v_accvgpr_read_b32 v52, a28
  v_accvgpr_read_b32 v53, a29
  v_accvgpr_read_b32 v54, a30
  v_accvgpr_read_b32 v55, a31
  v_pk_mul_f32 v[48:49], v[48:49], v[18:19]
  v_pk_mul_f32 v[50:51], v[50:51], v[18:19]
  v_pk_mul_f32 v[52:53], v[52:53], v[18:19]
  v_pk_mul_f32 v[54:55], v[54:55], v[18:19]
  v_cvt_pk_bf16_f32 v44, v48, v49
  v_cvt_pk_bf16_f32 v45, v50, v51
  v_cvt_pk_bf16_f32 v46, v52, v53
  v_cvt_pk_bf16_f32 v47, v54, v55
  buffer_store_dwordx4 v[44:47], v2, s[40:43], s65 offen offset:1024 sc1
  v_accvgpr_read_b32 v100, a36
  v_accvgpr_read_b32 v101, a37
  v_accvgpr_read_b32 v102, a38
  v_accvgpr_read_b32 v103, a39
  v_accvgpr_read_b32 v104, a44
  v_accvgpr_read_b32 v105, a45
  v_accvgpr_read_b32 v106, a46
  v_accvgpr_read_b32 v107, a47
  v_pk_mul_f32 v[100:101], v[100:101], v[18:19]
  v_pk_mul_f32 v[102:103], v[102:103], v[18:19]
  v_pk_mul_f32 v[104:105], v[104:105], v[18:19]
  v_pk_mul_f32 v[106:107], v[106:107], v[18:19]
  v_cvt_pk_bf16_f32 v96, v100, v101
  v_cvt_pk_bf16_f32 v97, v102, v103
  v_cvt_pk_bf16_f32 v98, v104, v105
  v_cvt_pk_bf16_f32 v99, v106, v107
  buffer_store_dwordx4 v[96:99], v2, s[40:43], s65 offen offset:2048 sc1
  v_accvgpr_read_b32 v112, a52
  v_accvgpr_read_b32 v113, a53
  v_accvgpr_read_b32 v114, a54
  v_accvgpr_read_b32 v115, a55
  v_accvgpr_read_b32 v116, a60
  v_accvgpr_read_b32 v117, a61
  v_accvgpr_read_b32 v118, a62
  v_accvgpr_read_b32 v119, a63
  v_pk_mul_f32 v[112:113], v[112:113], v[18:19]
  v_pk_mul_f32 v[114:115], v[114:115], v[18:19]
  v_pk_mul_f32 v[116:117], v[116:117], v[18:19]
  v_pk_mul_f32 v[118:119], v[118:119], v[18:19]
  v_cvt_pk_bf16_f32 v108, v112, v113
  v_cvt_pk_bf16_f32 v109, v114, v115
  v_cvt_pk_bf16_f32 v110, v116, v117
  v_cvt_pk_bf16_f32 v111, v118, v119
  buffer_store_dwordx4 v[108:111], v2, s[40:43], s65 offen offset:3072 sc1
  s_mov_b32 s28, s46
  s_add_u32 s30, s28, 65536
  s_lshl_b32 s23, s20, 12
  s_add_u32 s23, s23, s28
  s_add_u32 s31, s13, 98304
  s_sub_u32 s31, s31, s23
  s_add_u32 s4, s18, s31
  s_addc_u32 s5, s19, 0
  s_add_u32 s6, s4, 4096
  s_addc_u32 s7, s5, 0
  s_waitcnt vmcnt(8)
  v_cmp_eq_u32 vcc, 0, v8
  s_cbranch_vccnz fa_wof_spin
fa_wof_ok:
  v_cmp_eq_u32 vcc, 0, v15
  s_cbranch_vccnz fa_sel4_spin
fa_sel4_ok:
  s_lshl_b32 s31, s21, 6
  s_add_u32 s31, s31, 1
  v_subrev_u32 v16, s31, v15
  v_cmp_gt_u32 vcc, 64, v16
  s_cmp_lt_u32 s20, 2
  s_cselect_b32 s23, 0xff, 0
  s_and_b32 s10, vcc_lo, s23
  s_sub_u32 s23, s10, 1
  s_and_b32 s23, s23, s10
  s_cmp_eq_u32 s20, 1
  s_cselect_b32 s10, s23, s10
  s_cmp_eq_u32 s10, 0
  s_cbranch_scc1 fa_coEnd
  v_min_u32 v11, 53, v1
  s_lshr_b32 s23, s22, 1
  s_lshl_b32 s23, s23, 8
  s_add_u32 s23, s23, 2650112
  v_lshl_add_u32 v11, v11, 2, s23
  buffer_load_dword v14, v11, s[40:43], 0 offen sc1
  v_mul_u32_u24 v16, 3277, v1
  v_lshrrev_b32 v16, 16, v16
  v_mul_u32_u24 v8, 20, v16
  v_sub_u32 v8, v1, v8
  v_lshlrev_b32 v8, 4, v8
  v_mul_u32_u24 v9, 368640, v16
  v_add_u32 v9, v9, v8
  v_cmp_gt_u32 vcc, 3, v16
  v_mov_b32 v19, 1073741824
  s_nop 0
  v_cndmask_b32 v9, v19, v9, vcc
  s_mov_b32 s12, 2
  s_mov_b32 s32, -1
  s_mov_b32 s11, 0
  s_getpc_b64 s[36:37]
  s_setpc_b64 s[38:39]
  v_cmp_eq_u32 vcc, 0, v14
  s_cbranch_vccnz fa_yf_spin
fa_yf_ok:
fa_coY:
  s_ff1_i32_b32 s33, s10
  s_bitset0_b32 s10, s33
  s_sub_u32 s23, s10, 1
  s_and_b32 s10, s10, s23
  s_mul_i32 s14, s33, 2560
  s_mul_i32 s23, s22, 320
  s_add_u32 s14, s14, s23
  s_add_u32 s14, s14, 2686976
  buffer_load_dwordx4 v[64:67], v9, s[40:43], s14 offen sc1
  s_add_u32 s14, s14, 20480
  buffer_load_dwordx4 v[68:71], v9, s[40:43], s14 offen sc1
  s_add_u32 s14, s14, 20480
  buffer_load_dwordx4 v[72:75], v9, s[40:43], s14 offen sc1
  s_add_u32 s14, s14, 20480
  buffer_load_dwordx4 v[76:79], v9, s[40:43], s14 offen sc1
  s_add_u32 s14, s14, 20480
  buffer_load_dwordx4 v[80:83], v9, s[40:43], s14 offen sc1
  s_add_u32 s14, s14, 20480
  buffer_load_dwordx4 v[84:87], v9, s[40:43], s14 offen sc1
  s_add_u32 s14, s14, 20480
  buffer_load_dwordx4 v[88:91], v9, s[40:43], s14 offen sc1
  s_add_u32 s14, s14, 20480
  buffer_load_dwordx4 v[92:95], v9, s[40:43], s14 offen sc1
  s_add_u32 s14, s14, 20480
  buffer_load_dwordx4 v[128:131], v9, s[40:43], s14 offen sc1
  s_add_u32 s14, s14, 20480
  buffer_load_dwordx4 v[132:135], v9, s[40:43], s14 offen sc1
  s_add_u32 s14, s14, 20480
  buffer_load_dwordx4 v[136:139], v9, s[40:43], s14 offen sc1
  s_add_u32 s14, s14, 20480
  buffer_load_dwordx4 v[140:143], v9, s[40:43], s14 offen sc1
  s_add_u32 s14, s14, 20480
  buffer_load_dwordx4 v[144:147], v9, s[40:43], s14 offen sc1
  s_add_u32 s14, s14, 20480
  buffer_load_dwordx4 v[148:151], v9, s[40:43], s14 offen sc1
  s_add_u32 s14, s14, 20480
  buffer_load_dwordx4 v[152:155], v9, s[40:43], s14 offen sc1
  s_add_u32 s14, s14, 20480
  buffer_load_dwordx4 v[156:159], v9, s[40:43], s14 offen sc1
  s_add_u32 s14, s14, 20480
  buffer_load_dwordx4 v[176:179], v9, s[40:43], s14 offen sc1
  s_add_u32 s14, s14, 20480
  buffer_load_dwordx4 v[180:183], v9, s[40:43], s14 offen sc1
  s_add_u32 s14, s14, 20480
  s_lshl_b32 s14, s20, 10
  s_add_u32 s14, s14, 159744
  v_add_u32 v19, s14, v2
  s_add_u32 s23, s33, 8
  v_readlane_b32 s35, v15, s23
  s_waitcnt vmcnt(0)
  v_pk_add_f32 v[64:65], v[64:65], v[68:69]
  v_pk_add_f32 v[66:67], v[66:67], v[70:71]
  v_pk_add_f32 v[64:65], v[64:65], v[72:73]
  v_pk_add_f32 v[66:67], v[66:67], v[74:75]
  v_pk_add_f32 v[64:65], v[64:65], v[76:77]
  v_pk_add_f32 v[66:67], v[66:67], v[78:79]
  v_pk_add_f32 v[64:65], v[64:65], v[80:81]
  v_pk_add_f32 v[66:67], v[66:67], v[82:83]
  v_pk_add_f32 v[64:65], v[64:65], v[84:85]
  v_pk_add_f32 v[66:67], v[66:67], v[86:87]
  v_pk_add_f32 v[64:65], v[64:65], v[88:89]
  v_pk_add_f32 v[66:67], v[66:67], v[90:91]
  v_pk_add_f32 v[64:65], v[64:65], v[92:93]
  v_pk_add_f32 v[66:67], v[66:67], v[94:95]
  v_pk_add_f32 v[64:65], v[64:65], v[128:129]
  v_pk_add_f32 v[66:67], v[66:67], v[130:131]
  v_pk_add_f32 v[64:65], v[64:65], v[132:133]
  v_pk_add_f32 v[66:67], v[66:67], v[134:135]
  v_pk_add_f32 v[64:65], v[64:65], v[136:137]
  v_pk_add_f32 v[66:67], v[66:67], v[138:139]
  v_pk_add_f32 v[64:65], v[64:65], v[140:141]
  v_pk_add_f32 v[66:67], v[66:67], v[142:143]
  v_pk_add_f32 v[64:65], v[64:65], v[144:145]
  v_pk_add_f32 v[66:67], v[66:67], v[146:147]
  v_pk_add_f32 v[64:65], v[64:65], v[148:149]
  v_pk_add_f32 v[66:67], v[66:67], v[150:151]
  v_pk_add_f32 v[64:65], v[64:65], v[152:153]
  v_pk_add_f32 v[66:67], v[66:67], v[154:155]
  v_pk_add_f32 v[64:65], v[64:65], v[156:157]
  v_pk_add_f32 v[66:67], v[66:67], v[158:159]
  v_pk_add_f32 v[64:65], v[64:65], v[176:177]
  v_pk_add_f32 v[66:67], v[66:67], v[178:179]
  v_pk_add_f32 v[64:65], v[64:65], v[180:181]
  v_pk_add_f32 v[66:67], v[66:67], v[182:183]
  ds_write_b128 v19, v[64:67]
  v_add_u32 v19, s14, v8
  s_and_b32 s35, s35, 0xffff0000
  s_waitcnt lgkmcnt(0)
  ds_read_b128 v[64:67], v19
  ds_read_b128 v[68:71], v19 offset:320
  ds_read_b128 v[72:75], v19 offset:640
  s_mul_i32 s14, s33, 320
  s_add_u32 s14, s14, 155648
  v_add_u32 v19, s14, v8
  s_waitcnt lgkmcnt(0)
  v_add_f32 v64, v64, v68
  v_add_f32 v64, v64, v72
  v_cvt_pk_bf16_f32 v64, v64, v64
  v_and_b32 v64, 0xffff0000, v64
  v_mul_f32 v64, s35, v64
  v_cvt_pk_bf16_f32 v64, v64, v64
  v_and_b32 v64, 0xffff0000, v64
  v_add_f32 v65, v65, v69
  v_add_f32 v65, v65, v73
  v_cvt_pk_bf16_f32 v65, v65, v65
  v_and_b32 v65, 0xffff0000, v65
  v_mul_f32 v65, s35, v65
  v_cvt_pk_bf16_f32 v65, v65, v65
  v_and_b32 v65, 0xffff0000, v65
  v_add_f32 v66, v66, v70
  v_add_f32 v66, v66, v74
  v_cvt_pk_bf16_f32 v66, v66, v66
  v_and_b32 v66, 0xffff0000, v66
  v_mul_f32 v66, s35, v66
  v_cvt_pk_bf16_f32 v66, v66, v66
  v_and_b32 v66, 0xffff0000, v66
  v_add_f32 v67, v67, v71
  v_add_f32 v67, v67, v75
  v_cvt_pk_bf16_f32 v67, v67, v67
  v_and_b32 v67, 0xffff0000, v67
  v_mul_f32 v67, s35, v67
  v_cvt_pk_bf16_f32 v67, v67, v67
  v_and_b32 v67, 0xffff0000, v67
  ds_write_b128 v19, v[64:67]
  s_waitcnt lgkmcnt(0)
  s_cmp_lg_u32 s10, 0
  s_cbranch_scc1 fa_coY
fa_coEnd:
  s_mov_b32 s12, 3
  s_mov_b32 s32, -1
  s_setpc_b64 s[38:39]
fa_hk7:
  s_getpc_b64 s[38:39]
fa_hp7:
  s_add_u32 s36, s36, 4
  s_addc_u32 s37, s37, 0
  s_sub_u32 s38, s38, fa_hp7-fa_hb7
  s_subb_u32 s39, s39, 0
  s_setpc_b64 s[36:37]
fa_hk8:
  s_getpc_b64 s[38:39]
fa_hp8:
  s_add_u32 s36, s36, 4
  s_addc_u32 s37, s37, 0
  s_sub_u32 s38, s38, fa_hp8-fa_hb8
  s_subb_u32 s39, s39, 0
  s_setpc_b64 s[36:37]
fa_disp:
  s_cmp_eq_u32 s29, 7
  s_cbranch_scc1 fa_SSW7
  s_cmp_eq_u32 s29, 6
  s_cbranch_scc1 fa_SSW6
  s_cmp_eq_u32 s29, 5
  s_cbranch_scc1 fa_SSW5
  s_cmp_eq_u32 s29, 4
  s_cbranch_scc1 fa_SSW4
  s_cmp_eq_u32 s29, 3
  s_cbranch_scc1 fa_SSW3
  s_cmp_eq_u32 s29, 2
  s_cbranch_scc1 fa_SSW2
  s_cmp_eq_u32 s29, 1
  s_cbranch_scc1 fa_SSW1
  s_branch fa_Bexit
fa_hk9:
  s_getpc_b64 s[38:39]
fa_hp9:
  s_add_u32 s36, s36, 4
  s_addc_u32 s37, s37, 0
  s_add_u32 s38, s38, fa_hb9-fa_hp9
  s_addc_u32 s39, s39, 0
  s_setpc_b64 s[36:37]
fa_puby:
  s_waitcnt vmcnt(0)
  buffer_store_dword v4, v30, s[40:43], 0 offen sc1
  s_cmp_lt_u32 s12, 3
  s_cbranch_scc1 fa_hk9
fa_hb9:
  s_add_u32 s14, s13, 61440
  buffer_load_dwordx4 v[64:67], v2, s[40:43], s14 offen offset:0 sc1
  buffer_load_dwordx4 v[68:71], v2, s[40:43], s14 offen offset:1024 sc1
  buffer_load_dwordx4 v[72:75], v2, s[40:43], s14 offen offset:2048 sc1
  buffer_load_dwordx4 v[76:79], v2, s[40:43], s14 offen offset:3072 sc1
  s_branch fa_pubb
fa_left:
  s_add_u32 s14, s13, 0
  buffer_load_dwordx4 a[0:3], v2, s[40:43], s14 offen offset:0 sc1
  buffer_load_dwordx4 a[4:7], v2, s[40:43], s14 offen offset:1024 sc1
  buffer_load_dwordx4 a[8:11], v2, s[40:43], s14 offen offset:2048 sc1
  s_cmp_ge_u32 s29, 7
  s_cbranch_scc1 fa_leftb
  s_add_u32 s14, s13, 0
  buffer_load_dwordx4 a[12:15], v2, s[40:43], s14 offen offset:3072 sc1
  s_add_u32 s14, s13, 4096
  buffer_load_dwordx4 a[16:19], v2, s[40:43], s14 offen offset:0 sc1
  buffer_load_dwordx4 a[20:23], v2, s[40:43], s14 offen offset:1024 sc1
  s_cmp_ge_u32 s29, 6
  s_cbranch_scc1 fa_leftb
  s_add_u32 s14, s13, 4096
  buffer_load_dwordx4 a[24:27], v2, s[40:43], s14 offen offset:2048 sc1
  buffer_load_dwordx4 a[28:31], v2, s[40:43], s14 offen offset:3072 sc1
  s_add_u32 s14, s13, 8192
  buffer_load_dwordx4 a[32:35], v2, s[40:43], s14 offen offset:0 sc1
  buffer_load_dwordx4 a[36:39], v2, s[40:43], s14 offen offset:1024 sc1
  s_cmp_ge_u32 s29, 5
  s_cbranch_scc1 fa_leftb
  s_add_u32 s14, s13, 8192
  buffer_load_dwordx4 a[40:43], v2, s[40:43], s14 offen offset:2048 sc1
  buffer_load_dwordx4 a[44:47], v2, s[40:43], s14 offen offset:3072 sc1
  s_add_u32 s14, s13, 12288
  buffer_load_dwordx4 a[48:51], v2, s[40:43], s14 offen offset:0 sc1
  buffer_load_dwordx4 a[52:55], v2, s[40:43], s14 offen offset:1024 sc1
  buffer_load_dwordx4 a[56:59], v2, s[40:43], s14 offen offset:2048 sc1
  buffer_load_dwordx4 a[60:63], v2, s[40:43], s14 offen offset:3072 sc1
  s_cmp_ge_u32 s29, 4
  s_cbranch_scc1 fa_leftb
  s_add_u32 s14, s13, 16384
  buffer_load_dwordx4 a[192:195], v2, s[40:43], s14 offen offset:0 sc1
  buffer_load_dwordx4 a[196:199], v2, s[40:43], s14 offen offset:1024 sc1
  buffer_load_dwordx4 a[200:203], v2, s[40:43], s14 offen offset:2048 sc1
  buffer_load_dwordx4 a[204:207], v2, s[40:43], s14 offen offset:3072 sc1
  s_add_u32 s14, s13, 20480
  buffer_load_dwordx4 a[208:211], v2, s[40:43], s14 offen offset:0 sc1
  buffer_load_dwordx4 a[212:215], v2, s[40:43], s14 offen offset:1024 sc1
  buffer_load_dwordx4 a[216:219], v2, s[40:43], s14 offen offset:2048 sc1
  buffer_load_dwordx4 a[220:223], v2, s[40:43], s14 offen offset:3072 sc1
  s_cmp_ge_u32 s29, 3
  s_cbranch_scc1 fa_leftb
  s_add_u32 s14, s13, 24576
  buffer_load_dwordx4 a[224:227], v2, s[40:43], s14 offen offset:0 sc1
  buffer_load_dwordx4 a[228:231], v2, s[40:43], s14 offen offset:1024 sc1
  buffer_load_dwordx4 a[232:235], v2, s[40:43], s14 offen offset:2048 sc1
  buffer_load_dwordx4 a[236:239], v2, s[40:43], s14 offen offset:3072 sc1
  s_add_u32 s14, s13, 28672
  buffer_load_dwordx4 a[240:243], v2, s[40:43], s14 offen offset:0 sc1
  buffer_load_dwordx4 a[244:247], v2, s[40:43], s14 offen offset:1024 sc1
  buffer_load_dwordx4 a[248:251], v2, s[40:43], s14 offen offset:2048 sc1
  buffer_load_dwordx4 a[252:255], v2, s[40:43], s14 offen offset:3072 sc1
  s_cmp_ge_u32 s29, 2
  s_cbranch_scc1 fa_leftb
  s_add_u32 s14, s13, 32768
  buffer_load_dwordx4 v[32:35], v2, s[40:43], s14 offen offset:0 sc1
  buffer_load_dwordx4 v[36:39], v2, s[40:43], s14 offen offset:1024 sc1
  buffer_load_dwordx4 v[40:43], v2, s[40:43], s14 offen offset:2048 sc1
  buffer_load_dwordx4 v[44:47], v2, s[40:43], s14 offen offset:3072 sc1
  s_add_u32 s14, s13, 36864
  buffer_load_dwordx4 v[48:51], v2, s[40:43], s14 offen offset:0 sc1
  buffer_load_dwordx4 v[52:55], v2, s[40:43], s14 offen offset:1024 sc1
  buffer_load_dwordx4 v[56:59], v2, s[40:43], s14 offen offset:2048 sc1
  buffer_load_dwordx4 v[60:63], v2, s[40:43], s14 offen offset:3072 sc1
  s_cmp_ge_u32 s29, 1
  s_cbranch_scc1 fa_leftb
  s_add_u32 s14, s13, 40960
  buffer_load_dwordx4 v[96:99], v2, s[40:43], s14 offen offset:0 sc1
  buffer_load_dwordx4 v[100:103], v2, s[40:43], s14 offen offset:1024 sc1
  buffer_load_dwordx4 v[104:107], v2, s[40:43], s14 offen offset:2048 sc1
  buffer_load_dwordx4 v[108:111], v2, s[40:43], s14 offen offset:3072 sc1
  s_add_u32 s14, s13, 45056
  buffer_load_dwordx4 v[112:115], v2, s[40:43], s14 offen offset:0 sc1
  buffer_load_dwordx4 v[116:119], v2, s[40:43], s14 offen offset:1024 sc1
  buffer_load_dwordx4 v[120:123], v2, s[40:43], s14 offen offset:2048 sc1
  buffer_load_dwordx4 v[124:127], v2, s[40:43], s14 offen offset:3072 sc1
  s_branch fa_leftb
fa_ctx_spin:
  s_mov_b32 s83, 200000
fa_ctx_spin2:
  buffer_load_dword v13, v12, s[40:43], 0 offen sc1
  s_waitcnt vmcnt(0)
  v_cmp_eq_u32 vcc, 0, v13
  s_cbranch_vccz fa_ctx_ok
  s_sleep 8
  s_sub_u32 s83, s83, 1
  s_cmp_lg_u32 s83, 0
  s_cbranch_scc1 fa_ctx_spin2
  s_branch fa_ctx_ok
fa_stub0:
  s_call_b64 s[76:77], fa_rare00
  s_call_b64 s[76:77], fa_rare10
  s_branch fa_back0
fa_stub1:
  s_call_b64 s[76:77], fa_rare01
  s_call_b64 s[76:77], fa_rare11
  s_branch fa_back1
fa_stub2:
  s_call_b64 s[76:77], fa_rare00
  s_call_b64 s[76:77], fa_rare10
  s_branch fa_back2
fa_stub3:
  s_call_b64 s[76:77], fa_rare01
  s_call_b64 s[76:77], fa_rare11
  s_branch fa_back3
fa_stub4:
  s_call_b64 s[76:77], fa_rare01
  s_call_b64 s[76:77], fa_rare11
  s_branch fa_back4
fa_stub5:
  s_call_b64 s[76:77], fa_rare00
  s_call_b64 s[76:77], fa_rare10
  s_branch fa_back5
fa_stub6:
  s_call_b64 s[76:77], fa_rare11
  s_branch fa_back6
fa_stub7:
  s_call_b64 s[76:77], fa_rare10
  s_branch fa_back7
fa_stub8:
  s_call_b64 s[76:77], fa_rare01
  s_call_b64 s[76:77], fa_rare11
  s_branch fa_back8
fa_stub9:
  s_call_b64 s[76:77], fa_rare10
  s_branch fa_back9
fa_stub10:
  s_call_b64 s[76:77], fa_rare11
  s_branch fa_back10
fa_stub11:
  s_call_b64 s[76:77], fa_rare10
  s_branch fa_back11
fa_stub12:
  s_call_b64 s[76:77], fa_rare11
  s_branch fa_back12
fa_stub13:
  s_call_b64 s[76:77], fa_rare10
  s_branch fa_back13
fa_stub14:
  s_call_b64 s[76:77], fa_rare11
  s_branch fa_back14
fa_stub15:
  s_call_b64 s[76:77], fa_rare10
  s_branch fa_back15
fa_stub16:
  s_call_b64 s[76:77], fa_rare11
  s_branch fa_back16
fa_stub17:
  s_call_b64 s[76:77], fa_rare10
  s_branch fa_back17
fa_stub18:
  s_call_b64 s[76:77], fa_rare11
  s_branch fa_back18
fa_stub19:
  s_call_b64 s[76:77], fa_rare10
  s_branch fa_back19
fa_stub20:
  s_call_b64 s[76:77], fa_rare11
  s_branch fa_back20
fa_stub21:
  s_call_b64 s[76:77], fa_rare10
  s_branch fa_back21
fa_stub22:
  s_call_b64 s[76:77], fa_rare11
  s_branch fa_back22
fa_stub23:
  s_call_b64 s[76:77], fa_rare10
  s_branch fa_back23
fa_stub24:
  s_call_b64 s[76:77], fa_rare11
  s_branch fa_back24
fa_stub25:
  s_call_b64 s[76:77], fa_rare10
  s_branch fa_back25
fa_stub26:
  s_call_b64 s[76:77], fa_rare11
  s_branch fa_back26
fa_stub27:
  s_call_b64 s[76:77], fa_rare10
  s_branch fa_back27
fa_stub28:
  s_call_b64 s[76:77], fa_rare11
  s_branch fa_back28
fa_stub29:
  s_call_b64 s[76:77], fa_rare10
  s_branch fa_back29
fa_stub30:
  s_call_b64 s[76:77], fa_rare11
  s_branch fa_back30
fa_codeend:
fa_rare00:
  s_nop 7
  v_max3_f32 v16, v96, v97, v98
  v_max3_f32 v16, v16, v99, v100
  v_max3_f32 v16, v16, v101, v102
  v_max3_f32 v16, v16, v103, 0
  v_mov_b32 v18, v16
  s_nop 1
  v_permlane16_swap_b32 v16, v18
  v_max_f32 v16, v16, v18
  v_mov_b32 v18, v16
  s_nop 1
  v_permlane32_swap_b32 v16, v18
  v_max_f32 v16, v16, v18
  v_sub_f32 v96, v96, v16
  v_sub_f32 v112, v112, v16
  v_sub_f32 v97, v97, v16
  v_sub_f32 v113, v113, v16
  v_sub_f32 v98, v98, v16
  v_sub_f32 v114, v114, v16
  v_sub_f32 v99, v99, v16
  v_sub_f32 v115, v115, v16
  v_sub_f32 v100, v100, v16
  v_sub_f32 v116, v116, v16
  v_sub_f32 v101, v101, v16
  v_sub_f32 v117, v117, v16
  v_sub_f32 v102, v102, v16
  v_sub_f32 v118, v118, v16
  v_sub_f32 v103, v103, v16
  v_sub_f32 v119, v119, v16
  v_max3_f32 v17, v104, v105, v106
  v_max3_f32 v17, v17, v107, v108
  v_max3_f32 v17, v17, v109, v110
  v_max3_f32 v17, v17, v111, 0
  v_mov_b32 v18, v17
  s_nop 1
  v_permlane16_swap_b32 v17, v18
  v_max_f32 v17, v17, v18
  v_mov_b32 v18, v17
  s_nop 1
  v_permlane32_swap_b32 v17, v18
  v_max_f32 v17, v17, v18
  v_sub_f32 v104, v104, v17
  v_sub_f32 v120, v120, v17
  v_sub_f32 v105, v105, v17
  v_sub_f32 v121, v121, v17
  v_sub_f32 v106, v106, v17
  v_sub_f32 v122, v122, v17
  v_sub_f32 v107, v107, v17
  v_sub_f32 v123, v123, v17
  v_sub_f32 v108, v108, v17
  v_sub_f32 v124, v124, v17
  v_sub_f32 v109, v109, v17
  v_sub_f32 v125, v125, v17
  v_sub_f32 v110, v110, v17
  v_sub_f32 v126, v126, v17
  v_sub_f32 v111, v111, v17
  v_sub_f32 v127, v127, v17
  s_call_b64 s[78:79], fa_resc0
  v_exp_f32 v208, v96
  v_exp_f32 v209, v97
  v_exp_f32 v210, v98
  v_add_f32 v224, v208, v209
  v_cvt_pk_bf16_f32 v160, v208, v209
  v_exp_f32 v211, v99
  v_add_f32 v224, v224, v210
  v_exp_f32 v212, v100
  v_add_f32 v224, v224, v211
  v_cvt_pk_bf16_f32 v161, v210, v211
  v_exp_f32 v213, v101
  v_add_f32 v224, v224, v212
  v_exp_f32 v214, v102
  v_add_f32 v224, v224, v213
  v_cvt_pk_bf16_f32 v162, v212, v213
  v_exp_f32 v215, v103
  v_add_f32 v224, v224, v214
  v_exp_f32 v208, v104
  v_add_f32 v224, v224, v215
  v_cvt_pk_bf16_f32 v163, v214, v215
  v_exp_f32 v209, v105
  v_exp_f32 v210, v106
  v_add_f32 v225, v208, v209
  v_cvt_pk_bf16_f32 v164, v208, v209
  v_exp_f32 v211, v107
  v_add_f32 v225, v225, v210
  v_exp_f32 v212, v108
  v_add_f32 v225, v225, v211
  v_cvt_pk_bf16_f32 v165, v210, v211
  v_exp_f32 v213, v109
  v_add_f32 v225, v225, v212
  v_exp_f32 v214, v110
  v_add_f32 v225, v225, v213
  v_cvt_pk_bf16_f32 v166, v212, v213
  v_exp_f32 v215, v111
  v_add_f32 v225, v225, v214
  s_nop 0
  v_add_f32 v225, v225, v215
  v_cvt_pk_bf16_f32 v167, v214, v215
  s_nop 1
  s_setpc_b64 s[76:77]
fa_rare01:
  s_nop 7
  v_max3_f32 v16, v112, v113, v114
  v_max3_f32 v16, v16, v115, v116
  v_max3_f32 v16, v16, v117, v118
  v_max3_f32 v16, v16, v119, 0
  v_mov_b32 v18, v16
  s_nop 1
  v_permlane16_swap_b32 v16, v18
  v_max_f32 v16, v16, v18
  v_mov_b32 v18, v16
  s_nop 1
  v_permlane32_swap_b32 v16, v18
  v_max_f32 v16, v16, v18
  v_sub_f32 v112, v112, v16
  v_sub_f32 v96, v96, v16
  v_sub_f32 v113, v113, v16
  v_sub_f32 v97, v97, v16
  v_sub_f32 v114, v114, v16
  v_sub_f32 v98, v98, v16
  v_sub_f32 v115, v115, v16
  v_sub_f32 v99, v99, v16
  v_sub_f32 v116, v116, v16
  v_sub_f32 v100, v100, v16
  v_sub_f32 v117, v117, v16
  v_sub_f32 v101, v101, v16
  v_sub_f32 v118, v118, v16
  v_sub_f32 v102, v102, v16
  v_sub_f32 v119, v119, v16
  v_sub_f32 v103, v103, v16
  v_max3_f32 v17, v120, v121, v122
  v_max3_f32 v17, v17, v123, v124
  v_max3_f32 v17, v17, v125, v126
  v_max3_f32 v17, v17, v127, 0
  v_mov_b32 v18, v17
  s_nop 1
  v_permlane16_swap_b32 v17, v18
  v_max_f32 v17, v17, v18
  v_mov_b32 v18, v17
  s_nop 1
  v_permlane32_swap_b32 v17, v18
  v_max_f32 v17, v17, v18
  v_sub_f32 v120, v120, v17
  v_sub_f32 v104, v104, v17
  v_sub_f32 v121, v121, v17
  v_sub_f32 v105, v105, v17
  v_sub_f32 v122, v122, v17
  v_sub_f32 v106, v106, v17
  v_sub_f32 v123, v123, v17
  v_sub_f32 v107, v107, v17
  v_sub_f32 v124, v124, v17
  v_sub_f32 v108, v108, v17
  v_sub_f32 v125, v125, v17
  v_sub_f32 v109, v109, v17
  v_sub_f32 v126, v126, v17
  v_sub_f32 v110, v110, v17
  v_sub_f32 v127, v127, v17
  v_sub_f32 v111, v111, v17
  s_call_b64 s[78:79], fa_resc0
  v_exp_f32 v208, v112
  v_exp_f32 v209, v113
  v_exp_f32 v210, v114
  v_add_f32 v224, v208, v209
  v_cvt_pk_bf16_f32 v168, v208, v209
  v_exp_f32 v211, v115
  v_add_f32 v224, v224, v210
  v_exp_f32 v212, v116
  v_add_f32 v224, v224, v211
  v_cvt_pk_bf16_f32 v169, v210, v211
  v_exp_f32 v213, v117
  v_add_f32 v224, v224, v212
  v_exp_f32 v214, v118
  v_add_f32 v224, v224, v213
  v_cvt_pk_bf16_f32 v170, v212, v213
  v_exp_f32 v215, v119
  v_add_f32 v224, v224, v214
  v_exp_f32 v208, v120
  v_add_f32 v224, v224, v215
  v_cvt_pk_bf16_f32 v171, v214, v215
  v_exp_f32 v209, v121
  v_exp_f32 v210, v122
  v_add_f32 v225, v208, v209
  v_cvt_pk_bf16_f32 v172, v208, v209
  v_exp_f32 v211, v123
  v_add_f32 v225, v225, v210
  v_exp_f32 v212, v124
  v_add_f32 v225, v225, v211
  v_cvt_pk_bf16_f32 v173, v210, v211
  v_exp_f32 v213, v125
  v_add_f32 v225, v225, v212
  v_exp_f32 v214, v126
  v_add_f32 v225, v225, v213
  v_cvt_pk_bf16_f32 v174, v212, v213
  v_exp_f32 v215, v127
  v_add_f32 v225, v225, v214
  s_nop 0
  v_add_f32 v225, v225, v215
  v_cvt_pk_bf16_f32 v175, v214, v215
  s_nop 1
  s_setpc_b64 s[76:77]
fa_resc0:
  v_sub_f32 v192, v192, v16
  v_sub_f32 v193, v193, v16
  v_sub_f32 v194, v194, v16
  v_sub_f32 v195, v195, v16
  v_exp_f32 v18, -v16
  v_sub_f32 v196, v196, v17
  v_sub_f32 v197, v197, v17
  v_sub_f32 v198, v198, v17
  v_sub_f32 v199, v199, v17
  v_exp_f32 v19, -v17
  s_nop 0
  v_mul_f32 v228, v228, v18
  v_mul_f32 v229, v229, v19
  v_accvgpr_read_b32 v20, a0
  v_accvgpr_read_b32 v21, a1
  v_accvgpr_read_b32 v22, a2
  v_accvgpr_read_b32 v23, a3
  v_mul_f32 v20, v20, v18
  v_mul_f32 v21, v21, v18
  v_mul_f32 v22, v22, v18
  v_mul_f32 v23, v23, v18
  v_accvgpr_write_b32 a0, v20
  v_accvgpr_write_b32 a1, v21
  v_accvgpr_write_b32 a2, v22
  v_accvgpr_write_b32 a3, v23
  v_accvgpr_read_b32 v20, a4
  v_accvgpr_read_b32 v21, a5
  v_accvgpr_read_b32 v22, a6
  v_accvgpr_read_b32 v23, a7
  v_mul_f32 v20, v20, v19
  v_mul_f32 v21, v21, v19
  v_mul_f32 v22, v22, v19
  v_mul_f32 v23, v23, v19
  v_accvgpr_write_b32 a4, v20
  v_accvgpr_write_b32 a5, v21
  v_accvgpr_write_b32 a6, v22
  v_accvgpr_write_b32 a7, v23
  v_accvgpr_read_b32 v20, a8
  v_accvgpr_read_b32 v21, a9
  v_accvgpr_read_b32 v22, a10
  v_accvgpr_read_b32 v23, a11
  v_mul_f32 v20, v20, v18
  v_mul_f32 v21, v21, v18
  v_mul_f32 v22, v22, v18
  v_mul_f32 v23, v23, v18
  v_accvgpr_write_b32 a8, v20
  v_accvgpr_write_b32 a9, v21
  v_accvgpr_write_b32 a10, v22
  v_accvgpr_write_b32 a11, v23
  v_accvgpr_read_b32 v20, a12
  v_accvgpr_read_b32 v21, a13
  v_accvgpr_read_b32 v22, a14
  v_accvgpr_read_b32 v23, a15
  v_mul_f32 v20, v20, v19
  v_mul_f32 v21, v21, v19
  v_mul_f32 v22, v22, v19
  v_mul_f32 v23, v23, v19
  v_accvgpr_write_b32 a12, v20
  v_accvgpr_write_b32 a13, v21
  v_accvgpr_write_b32 a14, v22
  v_accvgpr_write_b32 a15, v23
  v_accvgpr_read_b32 v20, a16
  v_accvgpr_read_b32 v21, a17
  v_accvgpr_read_b32 v22, a18
  v_accvgpr_read_b32 v23, a19
  v_mul_f32 v20, v20, v18
  v_mul_f32 v21, v21, v18
  v_mul_f32 v22, v22, v18
  v_mul_f32 v23, v23, v18
  v_accvgpr_write_b32 a16, v20
  v_accvgpr_write_b32 a17, v21
  v_accvgpr_write_b32 a18, v22
  v_accvgpr_write_b32 a19, v23
  v_accvgpr_read_b32 v20, a20
  v_accvgpr_read_b32 v21, a21
  v_accvgpr_read_b32 v22, a22
  v_accvgpr_read_b32 v23, a23
  v_mul_f32 v20, v20, v19
  v_mul_f32 v21, v21, v19
  v_mul_f32 v22, v22, v19
  v_mul_f32 v23, v23, v19
  v_accvgpr_write_b32 a20, v20
  v_accvgpr_write_b32 a21, v21
  v_accvgpr_write_b32 a22, v22
  v_accvgpr_write_b32 a23, v23
  v_accvgpr_read_b32 v20, a24
  v_accvgpr_read_b32 v21, a25
  v_accvgpr_read_b32 v22, a26
  v_accvgpr_read_b32 v23, a27
  v_mul_f32 v20, v20, v18
  v_mul_f32 v21, v21, v18
  v_mul_f32 v22, v22, v18
  v_mul_f32 v23, v23, v18
  v_accvgpr_write_b32 a24, v20
  v_accvgpr_write_b32 a25, v21
  v_accvgpr_write_b32 a26, v22
  v_accvgpr_write_b32 a27, v23
  v_accvgpr_read_b32 v20, a28
  v_accvgpr_read_b32 v21, a29
  v_accvgpr_read_b32 v22, a30
  v_accvgpr_read_b32 v23, a31
  v_mul_f32 v20, v20, v19
  v_mul_f32 v21, v21, v19
  v_mul_f32 v22, v22, v19
  v_mul_f32 v23, v23, v19
  v_accvgpr_write_b32 a28, v20
  v_accvgpr_write_b32 a29, v21
  v_accvgpr_write_b32 a30, v22
  v_accvgpr_write_b32 a31, v23
  v_accvgpr_read_b32 v20, a32
  v_accvgpr_read_b32 v21, a33
  v_accvgpr_read_b32 v22, a34
  v_accvgpr_read_b32 v23, a35
  v_mul_f32 v20, v20, v18
  v_mul_f32 v21, v21, v18
  v_mul_f32 v22, v22, v18
  v_mul_f32 v23, v23, v18
  v_accvgpr_write_b32 a32, v20
  v_accvgpr_write_b32 a33, v21
  v_accvgpr_write_b32 a34, v22
  v_accvgpr_write_b32 a35, v23
  v_accvgpr_read_b32 v20, a36
  v_accvgpr_read_b32 v21, a37
  v_accvgpr_read_b32 v22, a38
  v_accvgpr_read_b32 v23, a39
  v_mul_f32 v20, v20, v19
  v_mul_f32 v21, v21, v19
  v_mul_f32 v22, v22, v19
  v_mul_f32 v23, v23, v19
  v_accvgpr_write_b32 a36, v20
  v_accvgpr_write_b32 a37, v21
  v_accvgpr_write_b32 a38, v22
  v_accvgpr_write_b32 a39, v23
  v_accvgpr_read_b32 v20, a40
  v_accvgpr_read_b32 v21, a41
  v_accvgpr_read_b32 v22, a42
  v_accvgpr_read_b32 v23, a43
  v_mul_f32 v20, v20, v18
  v_mul_f32 v21, v21, v18
  v_mul_f32 v22, v22, v18
  v_mul_f32 v23, v23, v18
  v_accvgpr_write_b32 a40, v20
  v_accvgpr_write_b32 a41, v21
  v_accvgpr_write_b32 a42, v22
  v_accvgpr_write_b32 a43, v23
  v_accvgpr_read_b32 v20, a44
  v_accvgpr_read_b32 v21, a45
  v_accvgpr_read_b32 v22, a46
  v_accvgpr_read_b32 v23, a47
  v_mul_f32 v20, v20, v19
  v_mul_f32 v21, v21, v19
  v_mul_f32 v22, v22, v19
  v_mul_f32 v23, v23, v19
  v_accvgpr_write_b32 a44, v20
  v_accvgpr_write_b32 a45, v21
  v_accvgpr_write_b32 a46, v22
  v_accvgpr_write_b32 a47, v23
  v_accvgpr_read_b32 v20, a48
  v_accvgpr_read_b32 v21, a49
  v_accvgpr_read_b32 v22, a50
  v_accvgpr_read_b32 v23, a51
  v_mul_f32 v20, v20, v18
  v_mul_f32 v21, v21, v18
  v_mul_f32 v22, v22, v18
  v_mul_f32 v23, v23, v18
  v_accvgpr_write_b32 a48, v20
  v_accvgpr_write_b32 a49, v21
  v_accvgpr_write_b32 a50, v22
  v_accvgpr_write_b32 a51, v23
  v_accvgpr_read_b32 v20, a52
  v_accvgpr_read_b32 v21, a53
  v_accvgpr_read_b32 v22, a54
  v_accvgpr_read_b32 v23, a55
  v_mul_f32 v20, v20, v19
  v_mul_f32 v21, v21, v19
  v_mul_f32 v22, v22, v19
  v_mul_f32 v23, v23, v19
  v_accvgpr_write_b32 a52, v20
  v_accvgpr_write_b32 a53, v21
  v_accvgpr_write_b32 a54, v22
  v_accvgpr_write_b32 a55, v23
  v_accvgpr_read_b32 v20, a56
  v_accvgpr_read_b32 v21, a57
  v_accvgpr_read_b32 v22, a58
  v_accvgpr_read_b32 v23, a59
  v_mul_f32 v20, v20, v18
  v_mul_f32 v21, v21, v18
  v_mul_f32 v22, v22, v18
  v_mul_f32 v23, v23, v18
  v_accvgpr_write_b32 a56, v20
  v_accvgpr_write_b32 a57, v21
  v_accvgpr_write_b32 a58, v22
  v_accvgpr_write_b32 a59, v23
  v_accvgpr_read_b32 v20, a60
  v_accvgpr_read_b32 v21, a61
  v_accvgpr_read_b32 v22, a62
  v_accvgpr_read_b32 v23, a63
  v_mul_f32 v20, v20, v19
  v_mul_f32 v21, v21, v19
  v_mul_f32 v22, v22, v19
  v_mul_f32 v23, v23, v19
  v_accvgpr_write_b32 a60, v20
  v_accvgpr_write_b32 a61, v21
  v_accvgpr_write_b32 a62, v22
  v_accvgpr_write_b32 a63, v23
  s_setpc_b64 s[78:79]
fa_rare10:
  s_nop 7
  v_max3_f32 v16, v128, v129, v130
  v_max3_f32 v16, v16, v131, v132
  v_max3_f32 v16, v16, v133, v134
  v_max3_f32 v16, v16, v135, 0
  v_mov_b32 v18, v16
  s_nop 1
  v_permlane16_swap_b32 v16, v18
  v_max_f32 v16, v16, v18
  v_mov_b32 v18, v16
  s_nop 1
  v_permlane32_swap_b32 v16, v18
  v_max_f32 v16, v16, v18
  v_sub_f32 v128, v128, v16
  v_sub_f32 v144, v144, v16
  v_sub_f32 v129, v129, v16
  v_sub_f32 v145, v145, v16
  v_sub_f32 v130, v130, v16
  v_sub_f32 v146, v146, v16
  v_sub_f32 v131, v131, v16
  v_sub_f32 v147, v147, v16
  v_sub_f32 v132, v132, v16
  v_sub_f32 v148, v148, v16
  v_sub_f32 v133, v133, v16
  v_sub_f32 v149, v149, v16
  v_sub_f32 v134, v134, v16
  v_sub_f32 v150, v150, v16
  v_sub_f32 v135, v135, v16
  v_sub_f32 v151, v151, v16
  v_max3_f32 v17, v136, v137, v138
  v_max3_f32 v17, v17, v139, v140
  v_max3_f32 v17, v17, v141, v142
  v_max3_f32 v17, v17, v143, 0
  v_mov_b32 v18, v17
  s_nop 1
  v_permlane16_swap_b32 v17, v18
  v_max_f32 v17, v17, v18
  v_mov_b32 v18, v17
  s_nop 1
  v_permlane32_swap_b32 v17, v18
  v_max_f32 v17, v17, v18
  v_sub_f32 v136, v136, v17
  v_sub_f32 v152, v152, v17
  v_sub_f32 v137, v137, v17
  v_sub_f32 v153, v153, v17
  v_sub_f32 v138, v138, v17
  v_sub_f32 v154, v154, v17
  v_sub_f32 v139, v139, v17
  v_sub_f32 v155, v155, v17
  v_sub_f32 v140, v140, v17
  v_sub_f32 v156, v156, v17
  v_sub_f32 v141, v141, v17
  v_sub_f32 v157, v157, v17
  v_sub_f32 v142, v142, v17
  v_sub_f32 v158, v158, v17
  v_sub_f32 v143, v143, v17
  v_sub_f32 v159, v159, v17
  s_call_b64 s[78:79], fa_resc1
  v_exp_f32 v216, v128
  v_exp_f32 v217, v129
  v_exp_f32 v218, v130
  v_add_f32 v226, v216, v217
  v_cvt_pk_bf16_f32 v176, v216, v217
  v_exp_f32 v219, v131
  v_add_f32 v226, v226, v218
  v_exp_f32 v220, v132
  v_add_f32 v226, v226, v219
  v_cvt_pk_bf16_f32 v177, v218, v219
  v_exp_f32 v221, v133
  v_add_f32 v226, v226, v220
  v_exp_f32 v222, v134
  v_add_f32 v226, v226, v221
  v_cvt_pk_bf16_f32 v178, v220, v221
  v_exp_f32 v223, v135
  v_add_f32 v226, v226, v222
  v_exp_f32 v216, v136
  v_add_f32 v226, v226, v223
  v_cvt_pk_bf16_f32 v179, v222, v223
  v_exp_f32 v217, v137
  v_exp_f32 v218, v138
  v_add_f32 v227, v216, v217
  v_cvt_pk_bf16_f32 v180, v216, v217
  v_exp_f32 v219, v139
  v_add_f32 v227, v227, v218
  v_exp_f32 v220, v140
  v_add_f32 v227, v227, v219
  v_cvt_pk_bf16_f32 v181, v218, v219
  v_exp_f32 v221, v141
  v_add_f32 v227, v227, v220
  v_exp_f32 v222, v142
  v_add_f32 v227, v227, v221
  v_cvt_pk_bf16_f32 v182, v220, v221
  v_exp_f32 v223, v143
  v_add_f32 v227, v227, v222
  s_nop 0
  v_add_f32 v227, v227, v223
  v_cvt_pk_bf16_f32 v183, v222, v223
  v_exp_f32 v216, v144
  s_nop 1
  s_setpc_b64 s[76:77]
fa_rare11:
  s_nop 7
  v_max3_f32 v16, v144, v145, v146
  v_max3_f32 v16, v16, v147, v148
  v_max3_f32 v16, v16, v149, v150
  v_max3_f32 v16, v16, v151, 0
  v_mov_b32 v18, v16
  s_nop 1
  v_permlane16_swap_b32 v16, v18
  v_max_f32 v16, v16, v18
  v_mov_b32 v18, v16
  s_nop 1
  v_permlane32_swap_b32 v16, v18
  v_max_f32 v16, v16, v18
  v_sub_f32 v144, v144, v16
  v_sub_f32 v128, v128, v16
  v_sub_f32 v145, v145, v16
  v_sub_f32 v129, v129, v16
  v_sub_f32 v146, v146, v16
  v_sub_f32 v130, v130, v16
  v_sub_f32 v147, v147, v16
  v_sub_f32 v131, v131, v16
  v_sub_f32 v148, v148, v16
  v_sub_f32 v132, v132, v16
  v_sub_f32 v149, v149, v16
  v_sub_f32 v133, v133, v16
  v_sub_f32 v150, v150, v16
  v_sub_f32 v134, v134, v16
  v_sub_f32 v151, v151, v16
  v_sub_f32 v135, v135, v16
  v_max3_f32 v17, v152, v153, v154
  v_max3_f32 v17, v17, v155, v156
  v_max3_f32 v17, v17, v157, v158
  v_max3_f32 v17, v17, v159, 0
  v_mov_b32 v18, v17
  s_nop 1
  v_permlane16_swap_b32 v17, v18
  v_max_f32 v17, v17, v18
  v_mov_b32 v18, v17
  s_nop 1
  v_permlane32_swap_b32 v17, v18
  v_max_f32 v17, v17, v18
  v_sub_f32 v152, v152, v17
  v_sub_f32 v136, v136, v17
  v_sub_f32 v153, v153, v17
  v_sub_f32 v137, v137, v17
  v_sub_f32 v154, v154, v17
  v_sub_f32 v138, v138, v17
  v_sub_f32 v155, v155, v17
  v_sub_f32 v139, v139, v17
  v_sub_f32 v156, v156, v17
  v_sub_f32 v140, v140, v17
  v_sub_f32 v157, v157, v17
  v_sub_f32 v141, v141, v17
  v_sub_f32 v158, v158, v17
  v_sub_f32 v142, v142, v17
  v_sub_f32 v159, v159, v17
  v_sub_f32 v143, v143, v17
  s_call_b64 s[78:79], fa_resc1
  v_exp_f32 v216, v144
  v_exp_f32 v217, v145
  v_exp_f32 v218, v146
  v_add_f32 v226, v216, v217
  v_cvt_pk_bf16_f32 v184, v216, v217
  v_exp_f32 v219, v147
  v_add_f32 v226, v226, v218
  v_exp_f32 v220, v148
  v_add_f32 v226, v226, v219
  v_cvt_pk_bf16_f32 v185, v218, v219
  v_exp_f32 v221, v149
  v_add_f32 v226, v226, v220
  v_exp_f32 v222, v150
  v_add_f32 v226, v226, v221
  v_cvt_pk_bf16_f32 v186, v220, v221
  v_exp_f32 v223, v151
  v_add_f32 v226, v226, v222
  v_exp_f32 v216, v152
  v_add_f32 v226, v226, v223
  v_cvt_pk_bf16_f32 v187, v222, v223
  v_exp_f32 v217, v153
  v_exp_f32 v218, v154
  v_add_f32 v227, v216, v217
  v_cvt_pk_bf16_f32 v188, v216, v217
  v_exp_f32 v219, v155
  v_add_f32 v227, v227, v218
  v_exp_f32 v220, v156
  v_add_f32 v227, v227, v219
  v_cvt_pk_bf16_f32 v189, v218, v219
  v_exp_f32 v221, v157
  v_add_f32 v227, v227, v220
  v_exp_f32 v222, v158
  v_add_f32 v227, v227, v221
  v_cvt_pk_bf16_f32 v190, v220, v221
  v_exp_f32 v223, v159
  v_add_f32 v227, v227, v222
  s_nop 0
  v_add_f32 v227, v227, v223
  v_cvt_pk_bf16_f32 v191, v222, v223
  v_exp_f32 v216, v128
  s_nop 1
  s_setpc_b64 s[76:77]
fa_resc1:
  v_sub_f32 v200, v200, v16
  v_sub_f32 v201, v201, v16
  v_sub_f32 v202, v202, v16
  v_sub_f32 v203, v203, v16
  v_exp_f32 v18, -v16
  v_sub_f32 v204, v204, v17
  v_sub_f32 v205, v205, v17
  v_sub_f32 v206, v206, v17
  v_sub_f32 v207, v207, v17
  v_exp_f32 v19, -v17
  s_nop 0
  v_mul_f32 v230, v230, v18
  v_mul_f32 v231, v231, v19
  v_accvgpr_read_b32 v20, a64
  v_accvgpr_read_b32 v21, a65
  v_accvgpr_read_b32 v22, a66
  v_accvgpr_read_b32 v23, a67
  v_mul_f32 v20, v20, v18
  v_mul_f32 v21, v21, v18
  v_mul_f32 v22, v22, v18
  v_mul_f32 v23, v23, v18
  v_accvgpr_write_b32 a64, v20
  v_accvgpr_write_b32 a65, v21
  v_accvgpr_write_b32 a66, v22
  v_accvgpr_write_b32 a67, v23
  v_accvgpr_read_b32 v20, a68
  v_accvgpr_read_b32 v21, a69
  v_accvgpr_read_b32 v22, a70
  v_accvgpr_read_b32 v23, a71
  v_mul_f32 v20, v20, v19
  v_mul_f32 v21, v21, v19
  v_mul_f32 v22, v22, v19
  v_mul_f32 v23, v23, v19
  v_accvgpr_write_b32 a68, v20
  v_accvgpr_write_b32 a69, v21
  v_accvgpr_write_b32 a70, v22
  v_accvgpr_write_b32 a71, v23
  v_accvgpr_read_b32 v20, a72
  v_accvgpr_read_b32 v21, a73
  v_accvgpr_read_b32 v22, a74
  v_accvgpr_read_b32 v23, a75
  v_mul_f32 v20, v20, v18
  v_mul_f32 v21, v21, v18
  v_mul_f32 v22, v22, v18
  v_mul_f32 v23, v23, v18
  v_accvgpr_write_b32 a72, v20
  v_accvgpr_write_b32 a73, v21
  v_accvgpr_write_b32 a74, v22
  v_accvgpr_write_b32 a75, v23
  v_accvgpr_read_b32 v20, a76
  v_accvgpr_read_b32 v21, a77
  v_accvgpr_read_b32 v22, a78
  v_accvgpr_read_b32 v23, a79
  v_mul_f32 v20, v20, v19
  v_mul_f32 v21, v21, v19
  v_mul_f32 v22, v22, v19
  v_mul_f32 v23, v23, v19
  v_accvgpr_write_b32 a76, v20
  v_accvgpr_write_b32 a77, v21
  v_accvgpr_write_b32 a78, v22
  v_accvgpr_write_b32 a79, v23
  v_accvgpr_read_b32 v20, a80
  v_accvgpr_read_b32 v21, a81
  v_accvgpr_read_b32 v22, a82
  v_accvgpr_read_b32 v23, a83
  v_mul_f32 v20, v20, v18
  v_mul_f32 v21, v21, v18
  v_mul_f32 v22, v22, v18
  v_mul_f32 v23, v23, v18
  v_accvgpr_write_b32 a80, v20
  v_accvgpr_write_b32 a81, v21
  v_accvgpr_write_b32 a82, v22
  v_accvgpr_write_b32 a83, v23
  v_accvgpr_read_b32 v20, a84
  v_accvgpr_read_b32 v21, a85
  v_accvgpr_read_b32 v22, a86
  v_accvgpr_read_b32 v23, a87
  v_mul_f32 v20, v20, v19
  v_mul_f32 v21, v21, v19
  v_mul_f32 v22, v22, v19
  v_mul_f32 v23, v23, v19
  v_accvgpr_write_b32 a84, v20
  v_accvgpr_write_b32 a85, v21
  v_accvgpr_write_b32 a86, v22
  v_accvgpr_write_b32 a87, v23
  v_accvgpr_read_b32 v20, a88
  v_accvgpr_read_b32 v21, a89
  v_accvgpr_read_b32 v22, a90
  v_accvgpr_read_b32 v23, a91
  v_mul_f32 v20, v20, v18
  v_mul_f32 v21, v21, v18
  v_mul_f32 v22, v22, v18
  v_mul_f32 v23, v23, v18
  v_accvgpr_write_b32 a88, v20
  v_accvgpr_write_b32 a89, v21
  v_accvgpr_write_b32 a90, v22
  v_accvgpr_write_b32 a91, v23
  v_accvgpr_read_b32 v20, a92
  v_accvgpr_read_b32 v21, a93
  v_accvgpr_read_b32 v22, a94
  v_accvgpr_read_b32 v23, a95
  v_mul_f32 v20, v20, v19
  v_mul_f32 v21, v21, v19
  v_mul_f32 v22, v22, v19
  v_mul_f32 v23, v23, v19
  v_accvgpr_write_b32 a92, v20
  v_accvgpr_write_b32 a93, v21
  v_accvgpr_write_b32 a94, v22
  v_accvgpr_write_b32 a95, v23
  v_accvgpr_read_b32 v20, a96
  v_accvgpr_read_b32 v21, a97
  v_accvgpr_read_b32 v22, a98
  v_accvgpr_read_b32 v23, a99
  v_mul_f32 v20, v20, v18
  v_mul_f32 v21, v21, v18
  v_mul_f32 v22, v22, v18
  v_mul_f32 v23, v23, v18
  v_accvgpr_write_b32 a96, v20
  v_accvgpr_write_b32 a97, v21
  v_accvgpr_write_b32 a98, v22
  v_accvgpr_write_b32 a99, v23
  v_accvgpr_read_b32 v20, a100
  v_accvgpr_read_b32 v21, a101
  v_accvgpr_read_b32 v22, a102
  v_accvgpr_read_b32 v23, a103
  v_mul_f32 v20, v20, v19
  v_mul_f32 v21, v21, v19
  v_mul_f32 v22, v22, v19
  v_mul_f32 v23, v23, v19
  v_accvgpr_write_b32 a100, v20
  v_accvgpr_write_b32 a101, v21
  v_accvgpr_write_b32 a102, v22
  v_accvgpr_write_b32 a103, v23
  v_accvgpr_read_b32 v20, a104
  v_accvgpr_read_b32 v21, a105
  v_accvgpr_read_b32 v22, a106
  v_accvgpr_read_b32 v23, a107
  v_mul_f32 v20, v20, v18
  v_mul_f32 v21, v21, v18
  v_mul_f32 v22, v22, v18
  v_mul_f32 v23, v23, v18
  v_accvgpr_write_b32 a104, v20
  v_accvgpr_write_b32 a105, v21
  v_accvgpr_write_b32 a106, v22
  v_accvgpr_write_b32 a107, v23
  v_accvgpr_read_b32 v20, a108
  v_accvgpr_read_b32 v21, a109
  v_accvgpr_read_b32 v22, a110
  v_accvgpr_read_b32 v23, a111
  v_mul_f32 v20, v20, v19
  v_mul_f32 v21, v21, v19
  v_mul_f32 v22, v22, v19
  v_mul_f32 v23, v23, v19
  v_accvgpr_write_b32 a108, v20
  v_accvgpr_write_b32 a109, v21
  v_accvgpr_write_b32 a110, v22
  v_accvgpr_write_b32 a111, v23
  v_accvgpr_read_b32 v20, a112
  v_accvgpr_read_b32 v21, a113
  v_accvgpr_read_b32 v22, a114
  v_accvgpr_read_b32 v23, a115
  v_mul_f32 v20, v20, v18
  v_mul_f32 v21, v21, v18
  v_mul_f32 v22, v22, v18
  v_mul_f32 v23, v23, v18
  v_accvgpr_write_b32 a112, v20
  v_accvgpr_write_b32 a113, v21
  v_accvgpr_write_b32 a114, v22
  v_accvgpr_write_b32 a115, v23
  v_accvgpr_read_b32 v20, a116
  v_accvgpr_read_b32 v21, a117
  v_accvgpr_read_b32 v22, a118
  v_accvgpr_read_b32 v23, a119
  v_mul_f32 v20, v20, v19
  v_mul_f32 v21, v21, v19
  v_mul_f32 v22, v22, v19
  v_mul_f32 v23, v23, v19
  v_accvgpr_write_b32 a116, v20
  v_accvgpr_write_b32 a117, v21
  v_accvgpr_write_b32 a118, v22
  v_accvgpr_write_b32 a119, v23
  v_accvgpr_read_b32 v20, a120
  v_accvgpr_read_b32 v21, a121
  v_accvgpr_read_b32 v22, a122
  v_accvgpr_read_b32 v23, a123
  v_mul_f32 v20, v20, v18
  v_mul_f32 v21, v21, v18
  v_mul_f32 v22, v22, v18
  v_mul_f32 v23, v23, v18
  v_accvgpr_write_b32 a120, v20
  v_accvgpr_write_b32 a121, v21
  v_accvgpr_write_b32 a122, v22
  v_accvgpr_write_b32 a123, v23
  v_accvgpr_read_b32 v20, a124
  v_accvgpr_read_b32 v21, a125
  v_accvgpr_read_b32 v22, a126
  v_accvgpr_read_b32 v23, a127
  v_mul_f32 v20, v20, v19
  v_mul_f32 v21, v21, v19
  v_mul_f32 v22, v22, v19
  v_mul_f32 v23, v23, v19
  v_accvgpr_write_b32 a124, v20
  v_accvgpr_write_b32 a125, v21
  v_accvgpr_write_b32 a126, v22
  v_accvgpr_write_b32 a127, v23
  s_setpc_b64 s[78:79]
.section .rodata,"a"
.p2align 6
.amdhsa_kernel fa_kernel
  .amdhsa_next_free_vgpr 512
  .amdhsa_next_free_sgpr 102
  .amdhsa_accum_offset 256
  .amdhsa_group_segment_fixed_size 0
  .amdhsa_kernarg_size 112
  .amdhsa_user_sgpr_count 2
  .amdhsa_user_sgpr_kernarg_segment_ptr 1
  .amdhsa_system_sgpr_workgroup_id_x 1
  .amdhsa_float_denorm_mode_32 3
.end_amdhsa_kernel
.text
```

```asm
; @launch kernel=fa_kernel grid=(256,1,1) block=(256,1,1) lds=163840
.amdgcn_target "amdgcn-amd-amdhsa--gfx950"
.text
.globl fa_kernel
.p2align 8
.type fa_kernel,@function
fa_kernel:
  s_cmp_ge_u32 s2, 256
  s_cbranch_scc1 fa_end
  s_getpc_b64 s[62:63]
  v_and_b32 v230, 127, v0
  v_lshlrev_b32 v230, 7, v230
  global_load_dword v231, v230, s[62:63]
  s_load_dwordx4 s[4:7], s[0:1], 0
  s_load_dwordx4 s[8:11], s[0:1], 24
  s_load_dwordx2 s[14:15], s[0:1], 56
  s_load_dwordx2 s[12:13], s[0:1], 40
  s_load_dwordx4 s[16:19], s[0:1], 96
  s_load_dwordx2 s[60:61], s[0:1], 16
  v_lshrrev_b32 v16, 6, v0
  v_and_b32 v1, 63, v0
  v_readfirstlane_b32 s20, v16
  s_and_b32 s21, s2, 7
  s_lshl_b32 s21, s21, 2
  s_lshr_b32 s23, s2, 3
  s_and_b32 s23, s23, 3
  s_add_u32 s21, s21, s23
  s_lshr_b32 s22, s2, 5
  v_and_b32 v208, 31, v1
  v_lshrrev_b32 v209, 5, v1
  s_lshl_b32 s31, s2, 2
  s_add_u32 s31, s31, s20
  s_lshl_b32 s31, s31, 1
  v_add_u32 v209, s31, v209
  v_lshlrev_b32 v212, 4, v208
  v_mul_u32_u24 v210, 1280, v209
  v_add_u32 v210, v210, v212
  v_cmp_gt_u32 s[64:65], 16, v208
  v_mov_b32 v19, 1073741824
  v_and_b32 v220, 7, v209
  v_cndmask_b32 v211, v19, v210, s[64:65]
  v_bfe_u32 v17, v1, 1, 3
  v_lshlrev_b32 v17, 13, v17
  v_and_b32 v18, 1, v1
  v_lshl_add_u32 v235, v18, 7, v17
  s_lshl_b32 s74, s22, 1
  s_and_b32 s31, s20, 1
  s_add_u32 s74, s74, s31
  s_lshl_b32 s74, s74, 16
  s_mov_b32 s73, 1048576
  v_and_b32 v16, 15, v1
  v_lshlrev_b32 v17, 10, v16
  v_and_b32 v18, 16, v1
  v_lshl_add_u32 v233, v18, 3, v17
  s_lshl_b32 s30, s23, 5
  s_add_u32 s30, s30, s20
  s_lshl_b32 s30, s30, 14
  s_lshl_b32 s29, s22, 16
  s_lshl_b32 s23, s21, 8
  s_cmp_ge_u32 s20, 2
  s_waitcnt lgkmcnt(0)
  s_mov_b32 s44, s4
  s_mov_b32 s45, s5
  s_mov_b32 s46, 2621440
  s_mov_b32 s47, 0x20000
  s_mov_b32 s68, s14
  s_mov_b32 s69, s15
  s_mov_b32 s70, 1280
  s_mov_b32 s71, 0x20000
  buffer_load_dwordx4 v[160:163], v210, s[44:47], 0 offen
  buffer_load_dwordx4 v[164:167], v210, s[44:47], 0 offen offset:512
  buffer_load_dwordx4 v[168:171], v211, s[44:47], 0 offen offset:1024
  buffer_load_dwordx4 v[172:175], v212, s[68:71], 0 offen offset:0
  buffer_load_dwordx4 v[176:179], v212, s[68:71], 0 offen offset:512
  buffer_load_dwordx4 v[180:183], v212, s[68:71], 0 offen offset:1024
  s_cselect_b32 s62, s10, s8
  s_cselect_b32 s63, s11, s9
  s_add_u32 s62, s62, s23
  s_addc_u32 s63, s63, 0
  s_mov_b32 s36, s62
  s_mov_b32 s37, s63
  s_mov_b32 s38, 0
  s_mov_b32 s39, 0x20000
  s_sub_u32 s38, 4194304, s23
  buffer_load_dword v231, v235, s[36:39], s74 offen
  s_add_u32 s6, s6, s29
  s_addc_u32 s7, s7, 0
  s_mov_b32 s32, s6
  s_mov_b32 s33, s7
  s_mov_b32 s34, 0
  s_mov_b32 s35, 0x20000
  s_sub_u32 s34, 2097152, s29
  buffer_load_dword v232, v233, s[32:35], s30 offen
  s_add_u32 s74, s74, s73
  buffer_load_dword v231, v235, s[36:39], s74 offen
  buffer_load_dword v232, v233, s[32:35], s30 offen offset:256
  s_getpc_b64 s[8:9]
fa_pc:
  s_lshr_b32 s31, s2, 3
  s_and_b32 s31, s31, 15
  s_lshl_b32 s31, s31, 2
  s_add_u32 s31, s31, s20
  s_lshl_b32 s31, s31, 11
  s_min_u32 s31, s31, fa_codeend-fa_pc-2048
  v_lshlrev_b32 v234, 7, v16
  v_add_u32 v230, s31, v234
  global_load_dword v231, v230, s[8:9]
  s_add_u32 s8, s8, fa_co1-fa_pc-4
  s_addc_u32 s9, s9, 0
  s_add_u32 s60, s60, s23
  s_addc_u32 s61, s61, 0
  s_sub_u32 s75, 5242880, s23
  s_mov_b32 s48, s62
  s_mov_b32 s49, s63
  s_mov_b32 s50, s38
  s_mov_b32 s51, 0x20000
  v_lshlrev_b32 v2, 4, v1
  v_lshrrev_b32 v19, 2, v1
  v_lshrrev_b32 v17, 5, v1
  v_mul_u32_u24 v17, 3, v17
  v_and_b32 v18, 3, v1
  v_xor_b32 v17, v17, v18
  v_lshlrev_b32 v17, 4, v17
  v_lshl_add_u32 v3, v19, 10, v17
  s_lshl_b32 s23, s20, 19
  v_add_u32 v3, s23, v3
  v_add_u32 v4, 15360, v3
  v_add_u32 v5, 30720, v3
  v_add_u32 v6, 46080, v3
  v_and_b32 v19, 3, v19
  v_lshrrev_b32 v17, 4, v1
  v_lshlrev_b32 v17, 6, v17
  v_lshl_add_u32 v19, v19, 13, v17
  s_and_b32 s23, s20, 1
  s_lshl_b32 s23, s23, 17
  v_add_u32 v19, s23, v19
  v_lshl_add_u32 v8, v18, 4, v19
  v_xor_b32 v18, 2, v18
  v_lshl_add_u32 v10, v18, 4, v19
  v_add_u32 v9, 31744, v8
  v_add_u32 v11, 95232, v10
  v_add_u32 v10, 63488, v10
  s_lshl_b32 s24, s20, 12
  s_mov_b32 s26, 0
  s_mov_b32 s27, 0
  s_mov_b32 s25, 262144
  s_mov_b32 s79, 64
  s_mov_b32 s40, s18
  s_mov_b32 s41, s19
  s_mov_b32 s42, 67108864
  s_mov_b32 s43, 0x20000
  s_mov_b32 s52, s12
  s_mov_b32 s53, s13
  s_mov_b32 s54, 5242880
  s_mov_b32 s55, 0x20000
  s_mov_b32 s56, s16
  s_mov_b32 s57, s17
  s_mov_b32 s58, 256
  s_mov_b32 s59, 0x20000
  s_and_b32 s29, s2, 7
  s_lshl_b32 s29, s29, 2
  s_add_u32 s29, s29, s20
  s_lshl_b32 s29, s29, 11
  s_and_b32 s23, s21, 3
  s_lshl_b32 s23, s23, 19
  s_add_u32 s29, s29, s23
  s_mul_i32 s23, s20, 4352
  s_lshl_b32 s31, s21, 2
  s_add_u32 s23, s23, s31
  s_add_u32 s23, s23, 3801088
  s_mul_i32 s31, s22, 17408
  s_add_u32 s80, s23, s31
  s_sub_u32 s31, 261120, s31
  s_add_u32 s3, s23, s31
  s_lshl_b32 s23, s21, 7
  s_lshl_b32 s31, s22, 2
  s_add_u32 s23, s23, s31
  s_add_u32 s82, s23, 2637824
  s_sub_u32 s62, s2, 170
  s_lshl_b32 s31, s20, 6
  s_add_u32 s62, s62, s31
  s_lshl_b32 s62, s62, 2
  s_add_u32 s62, s62, 2650112
  s_sub_u32 s23, s2, 170
  s_cmp_lt_u32 s23, 54
  s_cselect_b32 s62, s62, 1073741824
  s_cmp_eq_u32 s20, 0
  s_cselect_b32 s31, s82, 1073741824
  s_cselect_b32 s77, s2, 1073741824
  s_cmp_eq_u32 s2, 255
  s_cselect_b32 s23, 2629632, 1073741824
  v_lshl_add_u32 v225, v16, 2, s23
  v_mov_b32 v229, 0
  v_writelane_b32 v225, s80, 0
  v_writelane_b32 v225, s3, 1
  v_writelane_b32 v225, s31, 2
  s_add_u32 s31, s31, 32
  v_writelane_b32 v225, s31, 5
  s_and_b32 s23, s2, 1
  s_lshl_b32 s23, s23, 2
  s_add_u32 s23, s23, s20
  s_lshl_b32 s23, s23, 7
  s_lshr_b32 s31, s2, 1
  s_add_u32 s23, s23, s31
  s_lshl_b32 s23, s23, 2
  s_add_u32 s23, s23, 2654208
  v_writelane_b32 v225, s23, 3
  v_writelane_b32 v225, s62, 4
  s_and_b32 s23, s21, 3
  s_lshr_b32 s31, s23, 1
  s_lshl_b32 s31, 4, s31
  s_bitcmp1_b32 s23, 0
  s_cselect_b32 s76, s31, 0
  s_cselect_b32 s72, 0, s31
  s_or_b32 s76, s76, 0x20
  s_or_b32 s72, s72, 0x25
  v_mov_b32 v20, 0
  v_mov_b32 v21, 0
  v_mov_b32 v22, 0
  v_mov_b32 v23, 0
  v_lshrrev_b32 v17, 4, v1
  v_lshrrev_b32 v18, 3, v16
  v_mul_u32_u24 v18, 3, v18
  v_xor_b32 v18, v18, v17
  v_lshlrev_b32 v18, 4, v18
  v_lshl_add_u32 v14, v16, 6, v18
  s_and_b32 s23, s20, 1
  s_lshl_b32 s23, s23, 11
  v_add_u32 v14, s23, v14
  v_mfma_f32_32x32x16_bf16 a[0:15], v[20:23], v[20:23], 0
  v_lshrrev_b32 v18, 2, v16
  v_lshlrev_b32 v18, 6, v18
  v_lshl_add_u32 v18, v17, 11, v18
  v_and_b32 v19, 1, v1
  v_mfma_f32_32x32x16_bf16 a[16:31], v[20:23], v[20:23], 0
  v_lshl_add_u32 v18, v19, 3, v18
  v_bfe_u32 v19, v1, 1, 1
  v_and_b32 v17, 1, v17
  v_lshl_or_b32 v19, v17, 1, v19
  v_mfma_f32_32x32x16_bf16 a[32:47], v[20:23], v[20:23], 0
  s_lshr_b32 s23, s20, 1
  s_lshl_b32 s23, s23, 13
  s_add_u32 s23, s23, 16384
  v_add_u32 v18, s23, v18
  v_mfma_f32_32x32x16_bf16 a[48:63], v[20:23], v[20:23], 0
  v_lshl_add_u32 v12, v19, 4, v18
  v_xor_b32 v13, 32, v12
  v_mov_b32 v19, 1073741824
  v_lshlrev_b32 v220, 4, v220
  v_mfma_f32_32x32x16_bf16 a[64:79], v[20:23], v[20:23], 0
  v_lshl_add_u32 v220, v208, 7, v220
  v_add_u32 v220, 131072, v220
  v_lshlrev_b32 v222, 2, v209
  v_cmp_eq_u32 vcc, 0, v208
  v_mfma_f32_32x32x16_bf16 a[80:95], v[20:23], v[20:23], 0
  v_add_u32 v222, 2621440, v222
  v_lshlrev_b32 v221, 4, v0
  v_cndmask_b32 v222, v19, v222, vcc
  v_add_u32 v221, 131072, v221
  v_mfma_f32_32x32x16_bf16 a[96:111], v[20:23], v[20:23], 0
  v_sub_u32 v209, 0xffff, v209
  v_lshrrev_b32 v223, 3, v0
  v_and_b32 v18, 7, v0
  v_lshlrev_b32 v18, 4, v18
  v_mfma_f32_32x32x16_bf16 a[112:127], v[20:23], v[20:23], 0
  v_cmp_gt_u32 vcc, 128, v0
  v_lshl_add_u32 v223, v223, 8, v18
  s_lshr_b32 s66, s2, 1
  s_mul_i32 s66, s66, 20480
  v_mfma_f32_32x32x16_bf16 a[128:143], v[20:23], v[20:23], 0
  s_and_b32 s31, s2, 1
  s_lshl_b32 s31, s31, 7
  s_add_u32 s66, s66, s31
  v_cndmask_b32 v224, v19, v223, vcc
  v_mfma_f32_32x32x16_bf16 a[144:159], v[20:23], v[20:23], 0
  s_add_u32 s67, s66, 8192
  s_add_u32 s78, s66, 16384
  s_mov_b32 s28, 0
  v_mfma_f32_32x32x16_bf16 a[160:175], v[20:23], v[20:23], 0
  v_mfma_f32_32x32x16_bf16 a[176:191], v[20:23], v[20:23], 0
  v_mfma_f32_32x32x16_bf16 a[192:207], v[20:23], v[20:23], 0
  v_mfma_f32_32x32x16_bf16 a[208:223], v[20:23], v[20:23], 0
  v_mfma_f32_32x32x16_bf16 a[224:239], v[20:23], v[20:23], 0
  v_mfma_f32_32x32x16_bf16 a[240:255], v[20:23], v[20:23], 0
  s_waitcnt vmcnt(5)
  v_lshlrev_b32 v184, 16, v160
  v_and_b32 v185, 0xffff0000, v160
  v_lshlrev_b32 v186, 16, v161
  v_and_b32 v187, 0xffff0000, v161
  v_lshlrev_b32 v188, 16, v162
  v_and_b32 v189, 0xffff0000, v162
  v_lshlrev_b32 v190, 16, v163
  v_and_b32 v191, 0xffff0000, v163
  v_lshlrev_b32 v192, 16, v164
  v_and_b32 v193, 0xffff0000, v164
  v_lshlrev_b32 v194, 16, v165
  v_and_b32 v195, 0xffff0000, v165
  v_lshlrev_b32 v196, 16, v166
  v_and_b32 v197, 0xffff0000, v166
  v_lshlrev_b32 v198, 16, v167
  v_and_b32 v199, 0xffff0000, v167
  v_lshlrev_b32 v200, 16, v168
  v_and_b32 v201, 0xffff0000, v168
  v_lshlrev_b32 v202, 16, v169
  v_and_b32 v203, 0xffff0000, v169
  v_lshlrev_b32 v204, 16, v170
  v_and_b32 v205, 0xffff0000, v170
  v_lshlrev_b32 v206, 16, v171
  v_and_b32 v207, 0xffff0000, v171
  v_pk_add_f32 v[16:17], v[184:185], v[186:187]
  v_pk_add_f32 v[18:19], v[188:189], v[190:191]
  v_pk_add_f32 v[16:17], v[16:17], v[192:193]
  v_pk_add_f32 v[18:19], v[18:19], v[194:195]
  v_pk_add_f32 v[16:17], v[16:17], v[196:197]
  v_pk_add_f32 v[18:19], v[18:19], v[198:199]
  v_pk_add_f32 v[16:17], v[16:17], v[200:201]
  v_pk_add_f32 v[18:19], v[18:19], v[202:203]
  v_pk_add_f32 v[16:17], v[16:17], v[204:205]
  v_pk_add_f32 v[18:19], v[18:19], v[206:207]
  v_pk_add_f32 v[16:17], v[16:17], v[18:19]
  v_add_f32 v213, v16, v17
  s_nop 1
  v_add_f32_dpp v213, v213, v213 quad_perm:[1,0,3,2] row_mask:0xf bank_mask:0xf
  s_nop 1
  v_add_f32_dpp v213, v213, v213 quad_perm:[2,3,0,1] row_mask:0xf bank_mask:0xf
  s_nop 1
  v_add_f32_dpp v213, v213, v213 row_half_mirror row_mask:0xf bank_mask:0xf
  s_nop 1
  v_add_f32_dpp v213, v213, v213 row_mirror row_mask:0xf bank_mask:0xf
  v_mov_b32 v214, v213
  s_nop 1
  v_permlane16_swap_b32 v213, v214
  v_add_f32 v213, v213, v214
  v_mul_f32 v216, 0xbacccccd, v213
  v_mul_f32 v217, 0xbacccccd, v213
  v_pk_add_f32 v[20:21], v[184:185], v[216:217]
  v_pk_mul_f32 v[16:17], v[20:21], v[20:21]
  v_pk_add_f32 v[22:23], v[186:187], v[216:217]
  v_pk_fma_f32 v[16:17], v[22:23], v[22:23], v[16:17]
  v_pk_add_f32 v[24:25], v[188:189], v[216:217]
  v_pk_fma_f32 v[16:17], v[24:25], v[24:25], v[16:17]
  v_pk_add_f32 v[26:27], v[190:191], v[216:217]
  v_pk_fma_f32 v[16:17], v[26:27], v[26:27], v[16:17]
  v_pk_add_f32 v[20:21], v[192:193], v[216:217]
  v_pk_fma_f32 v[16:17], v[20:21], v[20:21], v[16:17]
  v_pk_add_f32 v[22:23], v[194:195], v[216:217]
  v_pk_fma_f32 v[16:17], v[22:23], v[22:23], v[16:17]
  v_pk_add_f32 v[24:25], v[196:197], v[216:217]
  v_pk_fma_f32 v[16:17], v[24:25], v[24:25], v[16:17]
  v_pk_add_f32 v[26:27], v[198:199], v[216:217]
  v_pk_fma_f32 v[16:17], v[26:27], v[26:27], v[16:17]
  v_pk_add_f32 v[20:21], v[200:201], v[216:217]
  v_pk_mul_f32 v[18:19], v[20:21], v[20:21]
  v_pk_add_f32 v[22:23], v[202:203], v[216:217]
  v_pk_fma_f32 v[18:19], v[22:23], v[22:23], v[18:19]
  v_pk_add_f32 v[24:25], v[204:205], v[216:217]
  v_pk_fma_f32 v[18:19], v[24:25], v[24:25], v[18:19]
  v_pk_add_f32 v[26:27], v[206:207], v[216:217]
  v_pk_fma_f32 v[18:19], v[26:27], v[26:27], v[18:19]
  v_add_f32 v18, v18, v19
  v_add_f32 v213, v16, v17
  v_cndmask_b32 v18, 0, v18, s[64:65]
  v_add_f32 v213, v213, v18
  s_nop 1
  v_add_f32_dpp v213, v213, v213 quad_perm:[1,0,3,2] row_mask:0xf bank_mask:0xf
  s_nop 1
  v_add_f32_dpp v213, v213, v213 quad_perm:[2,3,0,1] row_mask:0xf bank_mask:0xf
  s_nop 1
  v_add_f32_dpp v213, v213, v213 row_half_mirror row_mask:0xf bank_mask:0xf
  s_nop 1
  v_add_f32_dpp v213, v213, v213 row_mirror row_mask:0xf bank_mask:0xf
  v_mov_b32 v214, v213
  s_nop 1
  v_permlane16_swap_b32 v213, v214
  v_add_f32 v213, v213, v214
  v_mul_f32 v213, 0x3acccccd, v213
  v_cvt_pk_bf16_f32 v213, v213, v213
  v_and_b32 v213, 0xffff0000, v213
  v_add_f32 v213, 0x3727c5ac, v213
  v_cvt_pk_bf16_f32 v213, v213, v213
  v_and_b32 v213, 0xffff0000, v213
  v_sqrt_f32 v213, v213
  v_cvt_pk_bf16_f32 v216, v216, v216
  v_and_b32 v216, 0xffff0000, v216
  v_cvt_pk_bf16_f32 v213, v213, v213
  v_and_b32 v213, 0xffff0000, v213
  v_rcp_f32 v28, v213
  v_mov_b32 v217, v216
  v_mov_b32 v29, v28
  v_pk_add_f32 v[184:185], v[184:185], v[216:217]
  v_lshlrev_b32 v16, 16, v172
  v_cvt_pk_bf16_f32 v185, v184, v185
  v_and_b32 v17, 0xffff0000, v172
  v_lshlrev_b32 v184, 16, v185
  v_and_b32 v185, 0xffff0000, v185
  v_pk_mul_f32 v[184:185], v[184:185], v[28:29]
  v_cvt_pk_bf16_f32 v160, v184, v185
  v_lshlrev_b32 v184, 16, v160
  v_and_b32 v185, 0xffff0000, v160
  v_pk_mul_f32 v[218:219], v[184:185], v[16:17]
  v_pk_add_f32 v[186:187], v[186:187], v[216:217]
  v_lshlrev_b32 v18, 16, v173
  v_cvt_pk_bf16_f32 v187, v186, v187
  v_and_b32 v19, 0xffff0000, v173
  v_lshlrev_b32 v186, 16, v187
  v_and_b32 v187, 0xffff0000, v187
  v_pk_mul_f32 v[186:187], v[186:187], v[28:29]
  v_cvt_pk_bf16_f32 v161, v186, v187
  v_lshlrev_b32 v186, 16, v161
  v_and_b32 v187, 0xffff0000, v161
  v_pk_fma_f32 v[218:219], v[186:187], v[18:19], v[218:219]
  v_pk_add_f32 v[188:189], v[188:189], v[216:217]
  v_lshlrev_b32 v16, 16, v174
  v_cvt_pk_bf16_f32 v189, v188, v189
  v_and_b32 v17, 0xffff0000, v174
  v_lshlrev_b32 v188, 16, v189
  v_and_b32 v189, 0xffff0000, v189
  v_pk_mul_f32 v[188:189], v[188:189], v[28:29]
  v_cvt_pk_bf16_f32 v162, v188, v189
  v_lshlrev_b32 v188, 16, v162
  v_and_b32 v189, 0xffff0000, v162
  v_pk_fma_f32 v[218:219], v[188:189], v[16:17], v[218:219]
  v_pk_add_f32 v[190:191], v[190:191], v[216:217]
  v_lshlrev_b32 v18, 16, v175
  v_cvt_pk_bf16_f32 v191, v190, v191
  v_and_b32 v19, 0xffff0000, v175
  v_lshlrev_b32 v190, 16, v191
  v_and_b32 v191, 0xffff0000, v191
  v_pk_mul_f32 v[190:191], v[190:191], v[28:29]
  v_cvt_pk_bf16_f32 v163, v190, v191
  v_lshlrev_b32 v190, 16, v163
  v_and_b32 v191, 0xffff0000, v163
  v_pk_fma_f32 v[218:219], v[190:191], v[18:19], v[218:219]
  ds_write_b128 v220, v[160:163] offset:0
  v_pk_add_f32 v[192:193], v[192:193], v[216:217]
  v_lshlrev_b32 v16, 16, v176
  v_cvt_pk_bf16_f32 v193, v192, v193
  v_and_b32 v17, 0xffff0000, v176
  v_lshlrev_b32 v192, 16, v193
  v_and_b32 v193, 0xffff0000, v193
  v_pk_mul_f32 v[192:193], v[192:193], v[28:29]
  v_cvt_pk_bf16_f32 v164, v192, v193
  v_lshlrev_b32 v192, 16, v164
  v_and_b32 v193, 0xffff0000, v164
  v_pk_fma_f32 v[218:219], v[192:193], v[16:17], v[218:219]
  v_pk_add_f32 v[194:195], v[194:195], v[216:217]
  v_lshlrev_b32 v18, 16, v177
  v_cvt_pk_bf16_f32 v195, v194, v195
  v_and_b32 v19, 0xffff0000, v177
  v_lshlrev_b32 v194, 16, v195
  v_and_b32 v195, 0xffff0000, v195
  v_pk_mul_f32 v[194:195], v[194:195], v[28:29]
  v_cvt_pk_bf16_f32 v165, v194, v195
  v_lshlrev_b32 v194, 16, v165
  v_and_b32 v195, 0xffff0000, v165
  v_pk_fma_f32 v[218:219], v[194:195], v[18:19], v[218:219]
  v_pk_add_f32 v[196:197], v[196:197], v[216:217]
  v_lshlrev_b32 v16, 16, v178
  v_cvt_pk_bf16_f32 v197, v196, v197
  v_and_b32 v17, 0xffff0000, v178
  v_lshlrev_b32 v196, 16, v197
  v_and_b32 v197, 0xffff0000, v197
  v_pk_mul_f32 v[196:197], v[196:197], v[28:29]
  v_cvt_pk_bf16_f32 v166, v196, v197
  v_lshlrev_b32 v196, 16, v166
  v_and_b32 v197, 0xffff0000, v166
  v_pk_fma_f32 v[218:219], v[196:197], v[16:17], v[218:219]
  v_pk_add_f32 v[198:199], v[198:199], v[216:217]
  v_lshlrev_b32 v18, 16, v179
  v_cvt_pk_bf16_f32 v199, v198, v199
  v_and_b32 v19, 0xffff0000, v179
  v_lshlrev_b32 v198, 16, v199
  v_and_b32 v199, 0xffff0000, v199
  v_pk_mul_f32 v[198:199], v[198:199], v[28:29]
  v_cvt_pk_bf16_f32 v167, v198, v199
  v_lshlrev_b32 v198, 16, v167
  v_and_b32 v199, 0xffff0000, v167
  v_pk_fma_f32 v[218:219], v[198:199], v[18:19], v[218:219]
  ds_write_b128 v220, v[164:167] offset:4096
  v_pk_add_f32 v[200:201], v[200:201], v[216:217]
  v_lshlrev_b32 v16, 16, v180
  v_cvt_pk_bf16_f32 v201, v200, v201
  v_and_b32 v17, 0xffff0000, v180
  v_lshlrev_b32 v200, 16, v201
  v_and_b32 v201, 0xffff0000, v201
  v_pk_mul_f32 v[200:201], v[200:201], v[28:29]
  v_cvt_pk_bf16_f32 v168, v200, v201
  v_lshlrev_b32 v200, 16, v168
  v_and_b32 v201, 0xffff0000, v168
  v_pk_fma_f32 v[218:219], v[200:201], v[16:17], v[218:219]
  v_pk_add_f32 v[202:203], v[202:203], v[216:217]
  v_lshlrev_b32 v18, 16, v181
  v_cvt_pk_bf16_f32 v203, v202, v203
  v_and_b32 v19, 0xffff0000, v181
  v_lshlrev_b32 v202, 16, v203
  v_and_b32 v203, 0xffff0000, v203
  v_pk_mul_f32 v[202:203], v[202:203], v[28:29]
  v_cvt_pk_bf16_f32 v169, v202, v203
  v_lshlrev_b32 v202, 16, v169
  v_and_b32 v203, 0xffff0000, v169
  v_pk_fma_f32 v[218:219], v[202:203], v[18:19], v[218:219]
  v_pk_add_f32 v[204:205], v[204:205], v[216:217]
  v_lshlrev_b32 v16, 16, v182
  v_cvt_pk_bf16_f32 v205, v204, v205
  v_and_b32 v17, 0xffff0000, v182
  v_lshlrev_b32 v204, 16, v205
  v_and_b32 v205, 0xffff0000, v205
  v_pk_mul_f32 v[204:205], v[204:205], v[28:29]
  v_cvt_pk_bf16_f32 v170, v204, v205
  v_lshlrev_b32 v204, 16, v170
  v_and_b32 v205, 0xffff0000, v170
  v_pk_fma_f32 v[218:219], v[204:205], v[16:17], v[218:219]
  v_pk_add_f32 v[206:207], v[206:207], v[216:217]
  v_lshlrev_b32 v18, 16, v183
  v_cvt_pk_bf16_f32 v207, v206, v207
  v_and_b32 v19, 0xffff0000, v183
  v_lshlrev_b32 v206, 16, v207
  v_and_b32 v207, 0xffff0000, v207
  v_pk_mul_f32 v[206:207], v[206:207], v[28:29]
  v_cvt_pk_bf16_f32 v171, v206, v207
  v_lshlrev_b32 v206, 16, v171
  v_and_b32 v207, 0xffff0000, v171
  v_pk_fma_f32 v[218:219], v[206:207], v[18:19], v[218:219]
  ds_write_b128 v220, v[168:171] offset:8192
  v_add_f32 v218, v218, v219
  s_nop 1
  v_add_f32_dpp v218, v218, v218 quad_perm:[1,0,3,2] row_mask:0xf bank_mask:0xf
  s_nop 1
  v_add_f32_dpp v218, v218, v218 quad_perm:[2,3,0,1] row_mask:0xf bank_mask:0xf
  s_nop 1
  v_add_f32_dpp v218, v218, v218 row_half_mirror row_mask:0xf bank_mask:0xf
  s_nop 1
  v_add_f32_dpp v218, v218, v218 row_mirror row_mask:0xf bank_mask:0xf
  v_mov_b32 v214, v218
  s_nop 1
  v_permlane16_swap_b32 v218, v214
  v_add_f32 v218, v218, v214
  v_cvt_pk_bf16_f32 v218, v218, v218
  v_and_b32 v218, 0xffff0000, v218
  v_ashrrev_i32 v214, 31, v218
  v_or_b32 v214, 0x80000000, v214
  v_xor_b32 v218, v218, v214
  v_and_b32 v218, 0xffff0000, v218
  v_or_b32 v218, v218, v209
  v_mov_b32 v19, 1073741824
  s_mov_b32 m0, s24
  s_nop 0
  buffer_load_dwordx4 v3, s[32:35], s26 offen offset:0 sc1 lds
  buffer_load_dwordx4 v4, s[32:35], s26 offen offset:1024 sc1 lds
  buffer_load_dwordx4 v5, s[32:35], s26 offen offset:2048 sc1 lds
  buffer_load_dwordx4 v6, s[32:35], s26 offen offset:3072 sc1 lds
  s_add_u32 m0, s24, 16384
  s_nop 0
  buffer_load_dwordx4 v8, s[36:39], s27 offen offset:0 lds
  buffer_load_dwordx4 v9, s[36:39], s27 offen offset:1024 lds
  buffer_load_dwordx4 v10, s[36:39], s27 offen offset:2048 lds
  buffer_load_dwordx4 v11, s[36:39], s27 offen offset:3072 lds
  s_add_u32 s26, s26, s79
  s_add_u32 s27, s27, s25
  s_add_u32 s24, s24, 32768
  s_and_b32 s24, s24, 0x1ffff
  s_mov_b32 m0, s24
  s_nop 0
  buffer_load_dwordx4 v3, s[32:35], s26 offen offset:0 sc1 lds
  buffer_load_dwordx4 v4, s[32:35], s26 offen offset:1024 sc1 lds
  buffer_load_dwordx4 v5, s[32:35], s26 offen offset:2048 sc1 lds
  buffer_load_dwordx4 v6, s[32:35], s26 offen offset:3072 sc1 lds
  s_add_u32 m0, s24, 16384
  s_nop 0
  buffer_load_dwordx4 v8, s[36:39], s27 offen offset:0 lds
  buffer_load_dwordx4 v9, s[36:39], s27 offen offset:1024 lds
  buffer_load_dwordx4 v10, s[36:39], s27 offen offset:2048 lds
  buffer_load_dwordx4 v11, s[36:39], s27 offen offset:3072 lds
  s_add_u32 s26, s26, s79
  s_add_u32 s27, s27, s25
  s_add_u32 s24, s24, 32768
  s_and_b32 s24, s24, 0x1ffff
  s_waitcnt vmcnt(8) lgkmcnt(0)
  s_barrier
  s_cmp_ge_u32 s20, 2
  s_cbranch_scc1 fa_roleV
  ds_read_b128 v[96:99], v14 offset:0
  ds_read_b128 v[100:103], v14 offset:1024
  ds_read_b128 v[104:107], v14 offset:4096
  ds_read_b128 v[108:111], v14 offset:5120
  ds_read_b128 v[112:115], v14 offset:8192
  ds_read_b128 v[116:119], v14 offset:9216
  ds_read_b128 v[120:123], v14 offset:12288
  ds_read_b128 v[124:127], v14 offset:13312
  ds_read_b64_tr_b16 v[32:33], v12 offset:0
  ds_read_b64_tr_b16 v[34:35], v12 offset:1024
  ds_read_b64_tr_b16 v[36:37], v13 offset:0
  ds_read_b64_tr_b16 v[38:39], v13 offset:1024
  ds_read_b64_tr_b16 v[40:41], v12 offset:256
  ds_read_b64_tr_b16 v[42:43], v12 offset:1280
  ds_read_b64_tr_b16 v[44:45], v13 offset:256
  ds_read_b64_tr_b16 v[46:47], v13 offset:1280
  ds_read_b64_tr_b16 v[48:49], v12 offset:512
  ds_read_b64_tr_b16 v[50:51], v12 offset:1536
  ds_read_b64_tr_b16 v[52:53], v13 offset:512
  ds_read_b64_tr_b16 v[54:55], v13 offset:1536
  ds_read_b64_tr_b16 v[56:57], v12 offset:768
  ds_read_b64_tr_b16 v[58:59], v12 offset:1792
  ds_read_b64_tr_b16 v[60:61], v13 offset:768
  ds_read_b64_tr_b16 v[62:63], v13 offset:1792
  s_mov_b32 m0, s24
  s_nop 0
  buffer_load_dwordx4 v3, s[32:35], s26 offen offset:0 sc1 lds
  buffer_load_dwordx4 v4, s[32:35], s26 offen offset:1024 sc1 lds
  buffer_load_dwordx4 v5, s[32:35], s26 offen offset:2048 sc1 lds
  buffer_load_dwordx4 v6, s[32:35], s26 offen offset:3072 sc1 lds
  s_add_u32 m0, s24, 16384
  s_nop 0
  buffer_load_dwordx4 v8, s[36:39], s27 offen offset:0 lds
  buffer_load_dwordx4 v9, s[36:39], s27 offen offset:1024 lds
  buffer_load_dwordx4 v10, s[36:39], s27 offen offset:2048 lds
  buffer_load_dwordx4 v11, s[36:39], s27 offen offset:3072 lds
  s_add_u32 s26, s26, s79
  s_add_u32 s27, s27, s25
  s_add_u32 s24, s24, 32768
  s_and_b32 s24, s24, 0x1ffff
  buffer_load_dword v231, v19, s[32:35], 0 offen
  s_mov_b32 m0, s24
  s_nop 0
  buffer_load_dwordx4 v3, s[32:35], s26 offen offset:0 sc1 lds
  buffer_load_dwordx4 v4, s[32:35], s26 offen offset:1024 sc1 lds
  buffer_load_dwordx4 v5, s[32:35], s26 offen offset:2048 sc1 lds
  buffer_load_dwordx4 v6, s[32:35], s26 offen offset:3072 sc1 lds
  s_add_u32 m0, s24, 16384
  s_nop 0
  buffer_load_dwordx4 v8, s[36:39], s27 offen offset:0 lds
  buffer_load_dwordx4 v9, s[36:39], s27 offen offset:1024 lds
  buffer_load_dwordx4 v10, s[36:39], s27 offen offset:2048 lds
  buffer_load_dwordx4 v11, s[36:39], s27 offen offset:3072 lds
  s_add_u32 s26, s26, s79
  s_add_u32 s27, s27, s25
  s_add_u32 s24, s24, 32768
  s_and_b32 s24, s24, 0x1ffff
  s_waitcnt lgkmcnt(0)
.p2align 6
fa_loopK:
  v_mfma_f32_16x16x32_bf16 a[192:195], v[32:35], v[96:99], a[192:195]
  s_waitcnt vmcnt(17)
  v_mfma_f32_16x16x32_bf16 a[200:203], v[32:35], v[100:103], a[200:203]
  s_barrier
  v_mfma_f32_16x16x32_bf16 a[0:3], v[32:35], v[104:107], a[0:3]
  ds_read_b64_tr_b16 v[64:65], v12 offset:32768
  v_mfma_f32_16x16x32_bf16 a[8:11], v[32:35], v[108:111], a[8:11]
  v_mfma_f32_16x16x32_bf16 a[64:67], v[32:35], v[112:115], a[64:67]
  s_mov_b32 m0, s24
  ds_read_b64_tr_b16 v[66:67], v12 offset:33792
  v_mfma_f32_16x16x32_bf16 a[72:75], v[32:35], v[116:119], a[72:75]
  buffer_load_dwordx4 v3, s[32:35], s26 offen offset:0 sc1 lds
  v_mfma_f32_16x16x32_bf16 a[128:131], v[32:35], v[120:123], a[128:131]
  ds_read_b128 v[128:131], v14 offset:32768
  v_mfma_f32_16x16x32_bf16 a[136:139], v[32:35], v[124:127], a[136:139]
  buffer_load_dwordx4 v4, s[32:35], s26 offen offset:1024 sc1 lds
  v_mfma_f32_16x16x32_bf16 a[196:199], v[36:39], v[96:99], a[196:199]
  ds_read_b64_tr_b16 v[68:69], v13 offset:32768
  v_mfma_f32_16x16x32_bf16 a[204:207], v[36:39], v[100:103], a[204:207]
  buffer_load_dwordx4 v5, s[32:35], s26 offen offset:2048 sc1 lds
  v_mfma_f32_16x16x32_bf16 a[4:7], v[36:39], v[104:107], a[4:7]
  ds_read_b64_tr_b16 v[70:71], v13 offset:33792
  v_mfma_f32_16x16x32_bf16 a[12:15], v[36:39], v[108:111], a[12:15]
  buffer_load_dwordx4 v6, s[32:35], s26 offen offset:3072 sc1 lds
  v_mfma_f32_16x16x32_bf16 a[68:71], v[36:39], v[112:115], a[68:71]
  s_add_u32 m0, s24, 16384
  ds_read_b128 v[132:135], v14 offset:33792
  v_mfma_f32_16x16x32_bf16 a[76:79], v[36:39], v[116:119], a[76:79]
  buffer_load_dwordx4 v8, s[36:39], s27 offen offset:0 lds
  v_mfma_f32_16x16x32_bf16 a[132:135], v[36:39], v[120:123], a[132:135]
  ds_read_b64_tr_b16 v[72:73], v12 offset:33024
  v_mfma_f32_16x16x32_bf16 a[140:143], v[36:39], v[124:127], a[140:143]
  buffer_load_dwordx4 v9, s[36:39], s27 offen offset:1024 lds
  v_mfma_f32_16x16x32_bf16 a[208:211], v[40:43], v[96:99], a[208:211]
  ds_read_b64_tr_b16 v[74:75], v12 offset:34048
  v_mfma_f32_16x16x32_bf16 a[216:219], v[40:43], v[100:103], a[216:219]
  buffer_load_dwordx4 v10, s[36:39], s27 offen offset:2048 lds
  v_mfma_f32_16x16x32_bf16 a[16:19], v[40:43], v[104:107], a[16:19]
  ds_read_b128 v[136:139], v14 offset:36864
  v_mfma_f32_16x16x32_bf16 a[24:27], v[40:43], v[108:111], a[24:27]
  buffer_load_dwordx4 v11, s[36:39], s27 offen offset:3072 lds
  v_mfma_f32_16x16x32_bf16 a[80:83], v[40:43], v[112:115], a[80:83]
  ds_read_b64_tr_b16 v[76:77], v13 offset:33024
  v_mfma_f32_16x16x32_bf16 a[88:91], v[40:43], v[116:119], a[88:91]
  buffer_load_dword v231, v235, s[48:51], s74 offen sc1
  v_mfma_f32_16x16x32_bf16 a[144:147], v[40:43], v[120:123], a[144:147]
  s_add_u32 s74, s74, s73
  ds_read_b64_tr_b16 v[78:79], v13 offset:34048
  v_mfma_f32_16x16x32_bf16 a[152:155], v[40:43], v[124:127], a[152:155]
  s_bitcmp1_b32 s72, s28
  v_mfma_f32_16x16x32_bf16 a[212:215], v[44:47], v[96:99], a[212:215]
  s_cbranch_scc1 fa_hk0
fa_hb0:
  ds_read_b128 v[140:143], v14 offset:37888
  v_mfma_f32_16x16x32_bf16 a[220:223], v[44:47], v[100:103], a[220:223]
  v_mfma_f32_16x16x32_bf16 a[20:23], v[44:47], v[104:107], a[20:23]
  ds_read_b64_tr_b16 v[80:81], v12 offset:33280
  v_mfma_f32_16x16x32_bf16 a[28:31], v[44:47], v[108:111], a[28:31]
  v_mfma_f32_16x16x32_bf16 a[84:87], v[44:47], v[112:115], a[84:87]
  ds_read_b64_tr_b16 v[82:83], v12 offset:34304
  v_mfma_f32_16x16x32_bf16 a[92:95], v[44:47], v[116:119], a[92:95]
  v_mfma_f32_16x16x32_bf16 a[148:151], v[44:47], v[120:123], a[148:151]
  ds_read_b128 v[144:147], v14 offset:40960
  v_mfma_f32_16x16x32_bf16 a[156:159], v[44:47], v[124:127], a[156:159]
  v_mfma_f32_16x16x32_bf16 a[224:227], v[48:51], v[96:99], a[224:227]
  ds_read_b64_tr_b16 v[84:85], v13 offset:33280
  v_mfma_f32_16x16x32_bf16 a[232:235], v[48:51], v[100:103], a[232:235]
  v_mfma_f32_16x16x32_bf16 a[32:35], v[48:51], v[104:107], a[32:35]
  ds_read_b64_tr_b16 v[86:87], v13 offset:34304
  v_mfma_f32_16x16x32_bf16 a[40:43], v[48:51], v[108:111], a[40:43]
  v_mfma_f32_16x16x32_bf16 a[96:99], v[48:51], v[112:115], a[96:99]
  ds_read_b128 v[148:151], v14 offset:41984
  v_mfma_f32_16x16x32_bf16 a[104:107], v[48:51], v[116:119], a[104:107]
  v_mfma_f32_16x16x32_bf16 a[160:163], v[48:51], v[120:123], a[160:163]
  ds_read_b64_tr_b16 v[88:89], v12 offset:33536
  v_mfma_f32_16x16x32_bf16 a[168:171], v[48:51], v[124:127], a[168:171]
  v_mfma_f32_16x16x32_bf16 a[228:231], v[52:55], v[96:99], a[228:231]
  ds_read_b64_tr_b16 v[90:91], v12 offset:34560
  v_mfma_f32_16x16x32_bf16 a[236:239], v[52:55], v[100:103], a[236:239]
  v_mfma_f32_16x16x32_bf16 a[36:39], v[52:55], v[104:107], a[36:39]
  ds_read_b128 v[152:155], v14 offset:45056
  v_mfma_f32_16x16x32_bf16 a[44:47], v[52:55], v[108:111], a[44:47]
  v_mfma_f32_16x16x32_bf16 a[100:103], v[52:55], v[112:115], a[100:103]
  ds_read_b64_tr_b16 v[92:93], v13 offset:33536
  v_mfma_f32_16x16x32_bf16 a[108:111], v[52:55], v[116:119], a[108:111]
  v_mfma_f32_16x16x32_bf16 a[164:167], v[52:55], v[120:123], a[164:167]
  ds_read_b64_tr_b16 v[94:95], v13 offset:34560
  v_mfma_f32_16x16x32_bf16 a[172:175], v[52:55], v[124:127], a[172:175]
  v_mfma_f32_16x16x32_bf16 a[240:243], v[56:59], v[96:99], a[240:243]
  s_add_u32 s26, s26, s79
  ds_read_b128 v[156:159], v14 offset:46080
  v_mfma_f32_16x16x32_bf16 a[248:251], v[56:59], v[100:103], a[248:251]
  s_add_u32 s27, s27, s25
  v_mfma_f32_16x16x32_bf16 a[48:51], v[56:59], v[104:107], a[48:51]
  s_add_u32 s24, s24, 32768
  v_mfma_f32_16x16x32_bf16 a[56:59], v[56:59], v[108:111], a[56:59]
  s_and_b32 s24, s24, 0x1ffff
  v_mfma_f32_16x16x32_bf16 a[112:115], v[56:59], v[112:115], a[112:115]
  v_xor_b32 v14, 0x10000, v14
  v_mfma_f32_16x16x32_bf16 a[120:123], v[56:59], v[116:119], a[120:123]
  v_xor_b32 v12, 0x10000, v12
  v_mfma_f32_16x16x32_bf16 a[176:179], v[56:59], v[120:123], a[176:179]
  v_xor_b32 v13, 0x10000, v13
  v_mfma_f32_16x16x32_bf16 a[184:187], v[56:59], v[124:127], a[184:187]
  v_mfma_f32_16x16x32_bf16 a[244:247], v[60:63], v[96:99], a[244:247]
  v_mfma_f32_16x16x32_bf16 a[252:255], v[60:63], v[100:103], a[252:255]
  v_mfma_f32_16x16x32_bf16 a[52:55], v[60:63], v[104:107], a[52:55]
  v_mfma_f32_16x16x32_bf16 a[60:63], v[60:63], v[108:111], a[60:63]
  v_mfma_f32_16x16x32_bf16 a[116:119], v[60:63], v[112:115], a[116:119]
  v_mfma_f32_16x16x32_bf16 a[124:127], v[60:63], v[116:119], a[124:127]
  v_mfma_f32_16x16x32_bf16 a[180:183], v[60:63], v[120:123], a[180:183]
  v_mfma_f32_16x16x32_bf16 a[188:191], v[60:63], v[124:127], a[188:191]
  s_waitcnt lgkmcnt(0)
  v_mfma_f32_16x16x32_bf16 a[192:195], v[64:67], v[128:131], a[192:195]
  s_waitcnt vmcnt(18)
  v_mfma_f32_16x16x32_bf16 a[200:203], v[64:67], v[132:135], a[200:203]
  s_barrier
  v_mfma_f32_16x16x32_bf16 a[0:3], v[64:67], v[136:139], a[0:3]
  ds_read_b64_tr_b16 v[32:33], v12 offset:0
  v_mfma_f32_16x16x32_bf16 a[8:11], v[64:67], v[140:143], a[8:11]
  v_mfma_f32_16x16x32_bf16 a[64:67], v[64:67], v[144:147], a[64:67]
  s_mov_b32 m0, s24
  ds_read_b64_tr_b16 v[34:35], v12 offset:1024
  v_mfma_f32_16x16x32_bf16 a[72:75], v[64:67], v[148:151], a[72:75]
  buffer_load_dwordx4 v3, s[32:35], s26 offen offset:0 sc1 lds
  v_mfma_f32_16x16x32_bf16 a[128:131], v[64:67], v[152:155], a[128:131]
  ds_read_b128 v[96:99], v14 offset:0
  v_mfma_f32_16x16x32_bf16 a[136:139], v[64:67], v[156:159], a[136:139]
  v_mfma_f32_16x16x32_bf16 a[196:199], v[68:71], v[128:131], a[196:199]
  ds_read_b64_tr_b16 v[36:37], v13 offset:0
  v_mfma_f32_16x16x32_bf16 a[204:207], v[68:71], v[132:135], a[204:207]
  v_mfma_f32_16x16x32_bf16 a[4:7], v[68:71], v[136:139], a[4:7]
  ds_read_b64_tr_b16 v[38:39], v13 offset:1024
  v_mfma_f32_16x16x32_bf16 a[12:15], v[68:71], v[140:143], a[12:15]
  buffer_load_dwordx4 v4, s[32:35], s26 offen offset:1024 sc1 lds
  v_mfma_f32_16x16x32_bf16 a[68:71], v[68:71], v[144:147], a[68:71]
  ds_read_b128 v[100:103], v14 offset:1024
  v_mfma_f32_16x16x32_bf16 a[76:79], v[68:71], v[148:151], a[76:79]
  v_mfma_f32_16x16x32_bf16 a[132:135], v[68:71], v[152:155], a[132:135]
  ds_read_b64_tr_b16 v[40:41], v12 offset:256
  v_mfma_f32_16x16x32_bf16 a[140:143], v[68:71], v[156:159], a[140:143]
  v_mfma_f32_16x16x32_bf16 a[208:211], v[72:75], v[128:131], a[208:211]
  ds_read_b64_tr_b16 v[42:43], v12 offset:1280
  v_mfma_f32_16x16x32_bf16 a[216:219], v[72:75], v[132:135], a[216:219]
  buffer_load_dwordx4 v5, s[32:35], s26 offen offset:2048 sc1 lds
  v_mfma_f32_16x16x32_bf16 a[16:19], v[72:75], v[136:139], a[16:19]
  ds_read_b128 v[104:107], v14 offset:4096
  v_mfma_f32_16x16x32_bf16 a[24:27], v[72:75], v[140:143], a[24:27]
  v_mfma_f32_16x16x32_bf16 a[80:83], v[72:75], v[144:147], a[80:83]
  ds_read_b64_tr_b16 v[44:45], v13 offset:256
  v_mfma_f32_16x16x32_bf16 a[88:91], v[72:75], v[148:151], a[88:91]
  v_mfma_f32_16x16x32_bf16 a[144:147], v[72:75], v[152:155], a[144:147]
  ds_read_b64_tr_b16 v[46:47], v13 offset:1280
  v_mfma_f32_16x16x32_bf16 a[152:155], v[72:75], v[156:159], a[152:155]
  buffer_load_dwordx4 v6, s[32:35], s26 offen offset:3072 sc1 lds
  v_mfma_f32_16x16x32_bf16 a[212:215], v[76:79], v[128:131], a[212:215]
  ds_read_b128 v[108:111], v14 offset:5120
  v_mfma_f32_16x16x32_bf16 a[220:223], v[76:79], v[132:135], a[220:223]
  v_mfma_f32_16x16x32_bf16 a[20:23], v[76:79], v[136:139], a[20:23]
  ds_read_b64_tr_b16 v[48:49], v12 offset:512
  v_mfma_f32_16x16x32_bf16 a[28:31], v[76:79], v[140:143], a[28:31]
  v_mfma_f32_16x16x32_bf16 a[84:87], v[76:79], v[144:147], a[84:87]
  s_add_u32 m0, s24, 16384
  ds_read_b64_tr_b16 v[50:51], v12 offset:1536
  v_mfma_f32_16x16x32_bf16 a[92:95], v[76:79], v[148:151], a[92:95]
  buffer_load_dwordx4 v8, s[36:39], s27 offen offset:0 lds
  v_mfma_f32_16x16x32_bf16 a[148:151], v[76:79], v[152:155], a[148:151]
  ds_read_b128 v[112:115], v14 offset:8192
  v_mfma_f32_16x16x32_bf16 a[156:159], v[76:79], v[156:159], a[156:159]
  v_mfma_f32_16x16x32_bf16 a[224:227], v[80:83], v[128:131], a[224:227]
  ds_read_b64_tr_b16 v[52:53], v13 offset:512
  v_mfma_f32_16x16x32_bf16 a[232:235], v[80:83], v[132:135], a[232:235]
  v_mfma_f32_16x16x32_bf16 a[32:35], v[80:83], v[136:139], a[32:35]
  ds_read_b64_tr_b16 v[54:55], v13 offset:1536
  v_mfma_f32_16x16x32_bf16 a[40:43], v[80:83], v[140:143], a[40:43]
  buffer_load_dwordx4 v9, s[36:39], s27 offen offset:1024 lds
  v_mfma_f32_16x16x32_bf16 a[96:99], v[80:83], v[144:147], a[96:99]
  ds_read_b128 v[116:119], v14 offset:9216
  v_mfma_f32_16x16x32_bf16 a[104:107], v[80:83], v[148:151], a[104:107]
  v_mfma_f32_16x16x32_bf16 a[160:163], v[80:83], v[152:155], a[160:163]
  ds_read_b64_tr_b16 v[56:57], v12 offset:768
  v_mfma_f32_16x16x32_bf16 a[168:171], v[80:83], v[156:159], a[168:171]
  v_mfma_f32_16x16x32_bf16 a[228:231], v[84:87], v[128:131], a[228:231]
  ds_read_b64_tr_b16 v[58:59], v12 offset:1792
  v_mfma_f32_16x16x32_bf16 a[236:239], v[84:87], v[132:135], a[236:239]
  buffer_load_dwordx4 v10, s[36:39], s27 offen offset:2048 lds
  v_mfma_f32_16x16x32_bf16 a[36:39], v[84:87], v[136:139], a[36:39]
  ds_read_b128 v[120:123], v14 offset:12288
  v_mfma_f32_16x16x32_bf16 a[44:47], v[84:87], v[140:143], a[44:47]
  v_mfma_f32_16x16x32_bf16 a[100:103], v[84:87], v[144:147], a[100:103]
  ds_read_b64_tr_b16 v[60:61], v13 offset:768
  v_mfma_f32_16x16x32_bf16 a[108:111], v[84:87], v[148:151], a[108:111]
  v_mfma_f32_16x16x32_bf16 a[164:167], v[84:87], v[152:155], a[164:167]
  ds_read_b64_tr_b16 v[62:63], v13 offset:1792
  v_mfma_f32_16x16x32_bf16 a[172:175], v[84:87], v[156:159], a[172:175]
  buffer_load_dwordx4 v11, s[36:39], s27 offen offset:3072 lds
  v_mfma_f32_16x16x32_bf16 a[240:243], v[88:91], v[128:131], a[240:243]
  s_add_u32 s26, s26, s79
  ds_read_b128 v[124:127], v14 offset:13312
  v_mfma_f32_16x16x32_bf16 a[248:251], v[88:91], v[132:135], a[248:251]
  s_add_u32 s27, s27, s25
  v_mfma_f32_16x16x32_bf16 a[48:51], v[88:91], v[136:139], a[48:51]
  s_add_u32 s24, s24, 32768
  v_mfma_f32_16x16x32_bf16 a[56:59], v[88:91], v[140:143], a[56:59]
  s_and_b32 s24, s24, 0x1ffff
  v_mfma_f32_16x16x32_bf16 a[112:115], v[88:91], v[144:147], a[112:115]
  v_mfma_f32_16x16x32_bf16 a[120:123], v[88:91], v[148:151], a[120:123]
  s_bitcmp1_b32 s76, s28
  v_mfma_f32_16x16x32_bf16 a[176:179], v[88:91], v[152:155], a[176:179]
  s_cbranch_scc1 fa_hk1
fa_hb1:
  v_mfma_f32_16x16x32_bf16 a[184:187], v[88:91], v[156:159], a[184:187]
  v_mfma_f32_16x16x32_bf16 a[244:247], v[92:95], v[128:131], a[244:247]
  v_mfma_f32_16x16x32_bf16 a[252:255], v[92:95], v[132:135], a[252:255]
  s_add_u32 s28, s28, 1
  v_mfma_f32_16x16x32_bf16 a[52:55], v[92:95], v[136:139], a[52:55]
  v_mfma_f32_16x16x32_bf16 a[60:63], v[92:95], v[140:143], a[60:63]
  v_mfma_f32_16x16x32_bf16 a[116:119], v[92:95], v[144:147], a[116:119]
  v_mfma_f32_16x16x32_bf16 a[124:127], v[92:95], v[148:151], a[124:127]
  s_cmp_lt_u32 s28, 8
  v_mfma_f32_16x16x32_bf16 a[180:183], v[92:95], v[152:155], a[180:183]
  s_waitcnt lgkmcnt(0)
  v_mfma_f32_16x16x32_bf16 a[188:191], v[92:95], v[156:159], a[188:191]
  s_cbranch_scc1 fa_loopK
  s_mov_b32 s64, 16777216
  s_mov_b32 s76, 0x3e0293ee
  s_branch fa_p1epi
fa_roleV:
  ds_read_b128 v[32:35], v14 offset:0
  ds_read_b128 v[36:39], v14 offset:1024
  ds_read_b128 v[40:43], v14 offset:4096
  ds_read_b128 v[44:47], v14 offset:5120
  ds_read_b128 v[48:51], v14 offset:8192
  ds_read_b128 v[52:55], v14 offset:9216
  ds_read_b128 v[56:59], v14 offset:12288
  ds_read_b128 v[60:63], v14 offset:13312
  ds_read_b64_tr_b16 v[96:97], v12 offset:0
  ds_read_b64_tr_b16 v[98:99], v12 offset:1024
  ds_read_b64_tr_b16 v[100:101], v13 offset:0
  ds_read_b64_tr_b16 v[102:103], v13 offset:1024
  ds_read_b64_tr_b16 v[104:105], v12 offset:256
  ds_read_b64_tr_b16 v[106:107], v12 offset:1280
  ds_read_b64_tr_b16 v[108:109], v13 offset:256
  ds_read_b64_tr_b16 v[110:111], v13 offset:1280
  ds_read_b64_tr_b16 v[112:113], v12 offset:512
  ds_read_b64_tr_b16 v[114:115], v12 offset:1536
  ds_read_b64_tr_b16 v[116:117], v13 offset:512
  ds_read_b64_tr_b16 v[118:119], v13 offset:1536
  ds_read_b64_tr_b16 v[120:121], v12 offset:768
  ds_read_b64_tr_b16 v[122:123], v12 offset:1792
  ds_read_b64_tr_b16 v[124:125], v13 offset:768
  ds_read_b64_tr_b16 v[126:127], v13 offset:1792
  s_mov_b32 m0, s24
  s_nop 0
  buffer_load_dwordx4 v3, s[32:35], s26 offen offset:0 sc1 lds
  buffer_load_dwordx4 v4, s[32:35], s26 offen offset:1024 sc1 lds
  buffer_load_dwordx4 v5, s[32:35], s26 offen offset:2048 sc1 lds
  buffer_load_dwordx4 v6, s[32:35], s26 offen offset:3072 sc1 lds
  s_add_u32 m0, s24, 16384
  s_nop 0
  buffer_load_dwordx4 v8, s[36:39], s27 offen offset:0 lds
  buffer_load_dwordx4 v9, s[36:39], s27 offen offset:1024 lds
  buffer_load_dwordx4 v10, s[36:39], s27 offen offset:2048 lds
  buffer_load_dwordx4 v11, s[36:39], s27 offen offset:3072 lds
  s_add_u32 s26, s26, s79
  s_add_u32 s27, s27, s25
  s_add_u32 s24, s24, 32768
  s_and_b32 s24, s24, 0x1ffff
  buffer_load_dword v231, v19, s[32:35], 0 offen
  s_mov_b32 m0, s24
  s_nop 0
  buffer_load_dwordx4 v3, s[32:35], s26 offen offset:0 sc1 lds
  buffer_load_dwordx4 v4, s[32:35], s26 offen offset:1024 sc1 lds
  buffer_load_dwordx4 v5, s[32:35], s26 offen offset:2048 sc1 lds
  buffer_load_dwordx4 v6, s[32:35], s26 offen offset:3072 sc1 lds
  s_add_u32 m0, s24, 16384
  s_nop 0
  buffer_load_dwordx4 v8, s[36:39], s27 offen offset:0 lds
  buffer_load_dwordx4 v9, s[36:39], s27 offen offset:1024 lds
  buffer_load_dwordx4 v10, s[36:39], s27 offen offset:2048 lds
  buffer_load_dwordx4 v11, s[36:39], s27 offen offset:3072 lds
  s_add_u32 s26, s26, s79
  s_add_u32 s27, s27, s25
  s_add_u32 s24, s24, 32768
  s_and_b32 s24, s24, 0x1ffff
  s_waitcnt lgkmcnt(0)
.p2align 6
fa_loopV:
  v_mfma_f32_16x16x32_bf16 a[192:195], v[32:35], v[96:99], a[192:195]
  s_waitcnt vmcnt(17)
  v_mfma_f32_16x16x32_bf16 a[200:203], v[32:35], v[100:103], a[200:203]
  s_barrier
  v_mfma_f32_16x16x32_bf16 a[208:211], v[32:35], v[104:107], a[208:211]
  ds_read_b64_tr_b16 v[128:129], v12 offset:32768
  v_mfma_f32_16x16x32_bf16 a[216:219], v[32:35], v[108:111], a[216:219]
  v_mfma_f32_16x16x32_bf16 a[224:227], v[32:35], v[112:115], a[224:227]
  s_mov_b32 m0, s24
  ds_read_b64_tr_b16 v[130:131], v12 offset:33792
  v_mfma_f32_16x16x32_bf16 a[232:235], v[32:35], v[116:119], a[232:235]
  buffer_load_dwordx4 v3, s[32:35], s26 offen offset:0 sc1 lds
  v_mfma_f32_16x16x32_bf16 a[240:243], v[32:35], v[120:123], a[240:243]
  ds_read_b128 v[64:67], v14 offset:32768
  v_mfma_f32_16x16x32_bf16 a[248:251], v[32:35], v[124:127], a[248:251]
  buffer_load_dwordx4 v4, s[32:35], s26 offen offset:1024 sc1 lds
  v_mfma_f32_16x16x32_bf16 a[196:199], v[36:39], v[96:99], a[196:199]
  ds_read_b64_tr_b16 v[132:133], v13 offset:32768
  v_mfma_f32_16x16x32_bf16 a[204:207], v[36:39], v[100:103], a[204:207]
  buffer_load_dwordx4 v5, s[32:35], s26 offen offset:2048 sc1 lds
  v_mfma_f32_16x16x32_bf16 a[212:215], v[36:39], v[104:107], a[212:215]
  ds_read_b64_tr_b16 v[134:135], v13 offset:33792
  v_mfma_f32_16x16x32_bf16 a[220:223], v[36:39], v[108:111], a[220:223]
  buffer_load_dwordx4 v6, s[32:35], s26 offen offset:3072 sc1 lds
  v_mfma_f32_16x16x32_bf16 a[228:231], v[36:39], v[112:115], a[228:231]
  s_add_u32 m0, s24, 16384
  ds_read_b128 v[68:71], v14 offset:33792
  v_mfma_f32_16x16x32_bf16 a[236:239], v[36:39], v[116:119], a[236:239]
  buffer_load_dwordx4 v8, s[36:39], s27 offen offset:0 lds
  v_mfma_f32_16x16x32_bf16 a[244:247], v[36:39], v[120:123], a[244:247]
  ds_read_b64_tr_b16 v[136:137], v12 offset:33024
  v_mfma_f32_16x16x32_bf16 a[252:255], v[36:39], v[124:127], a[252:255]
  buffer_load_dwordx4 v9, s[36:39], s27 offen offset:1024 lds
  v_mfma_f32_16x16x32_bf16 a[0:3], v[40:43], v[96:99], a[0:3]
  ds_read_b64_tr_b16 v[138:139], v12 offset:34048
  v_mfma_f32_16x16x32_bf16 a[8:11], v[40:43], v[100:103], a[8:11]
  buffer_load_dwordx4 v10, s[36:39], s27 offen offset:2048 lds
  v_mfma_f32_16x16x32_bf16 a[16:19], v[40:43], v[104:107], a[16:19]
  ds_read_b128 v[72:75], v14 offset:36864
  v_mfma_f32_16x16x32_bf16 a[24:27], v[40:43], v[108:111], a[24:27]
  buffer_load_dwordx4 v11, s[36:39], s27 offen offset:3072 lds
  v_mfma_f32_16x16x32_bf16 a[32:35], v[40:43], v[112:115], a[32:35]
  ds_read_b64_tr_b16 v[140:141], v13 offset:33024
  v_mfma_f32_16x16x32_bf16 a[40:43], v[40:43], v[116:119], a[40:43]
  buffer_load_dword v231, v235, s[48:51], s74 offen sc1
  v_mfma_f32_16x16x32_bf16 a[48:51], v[40:43], v[120:123], a[48:51]
  s_add_u32 s74, s74, s73
  ds_read_b64_tr_b16 v[142:143], v13 offset:34048
  v_mfma_f32_16x16x32_bf16 a[56:59], v[40:43], v[124:127], a[56:59]
  s_bitcmp1_b32 s72, s28
  v_mfma_f32_16x16x32_bf16 a[4:7], v[44:47], v[96:99], a[4:7]
  s_cbranch_scc1 fa_hk2
fa_hb2:
  ds_read_b128 v[76:79], v14 offset:37888
  v_mfma_f32_16x16x32_bf16 a[12:15], v[44:47], v[100:103], a[12:15]
  v_mfma_f32_16x16x32_bf16 a[20:23], v[44:47], v[104:107], a[20:23]
  ds_read_b64_tr_b16 v[144:145], v12 offset:33280
  v_mfma_f32_16x16x32_bf16 a[28:31], v[44:47], v[108:111], a[28:31]
  v_mfma_f32_16x16x32_bf16 a[36:39], v[44:47], v[112:115], a[36:39]
  ds_read_b64_tr_b16 v[146:147], v12 offset:34304
  v_mfma_f32_16x16x32_bf16 a[44:47], v[44:47], v[116:119], a[44:47]
  v_mfma_f32_16x16x32_bf16 a[52:55], v[44:47], v[120:123], a[52:55]
  ds_read_b128 v[80:83], v14 offset:40960
  v_mfma_f32_16x16x32_bf16 a[60:63], v[44:47], v[124:127], a[60:63]
  v_mfma_f32_16x16x32_bf16 a[64:67], v[48:51], v[96:99], a[64:67]
  ds_read_b64_tr_b16 v[148:149], v13 offset:33280
  v_mfma_f32_16x16x32_bf16 a[72:75], v[48:51], v[100:103], a[72:75]
  v_mfma_f32_16x16x32_bf16 a[80:83], v[48:51], v[104:107], a[80:83]
  ds_read_b64_tr_b16 v[150:151], v13 offset:34304
  v_mfma_f32_16x16x32_bf16 a[88:91], v[48:51], v[108:111], a[88:91]
  v_mfma_f32_16x16x32_bf16 a[96:99], v[48:51], v[112:115], a[96:99]
  ds_read_b128 v[84:87], v14 offset:41984
  v_mfma_f32_16x16x32_bf16 a[104:107], v[48:51], v[116:119], a[104:107]
  v_mfma_f32_16x16x32_bf16 a[112:115], v[48:51], v[120:123], a[112:115]
  ds_read_b64_tr_b16 v[152:153], v12 offset:33536
  v_mfma_f32_16x16x32_bf16 a[120:123], v[48:51], v[124:127], a[120:123]
  v_mfma_f32_16x16x32_bf16 a[68:71], v[52:55], v[96:99], a[68:71]
  ds_read_b64_tr_b16 v[154:155], v12 offset:34560
  v_mfma_f32_16x16x32_bf16 a[76:79], v[52:55], v[100:103], a[76:79]
  v_mfma_f32_16x16x32_bf16 a[84:87], v[52:55], v[104:107], a[84:87]
  ds_read_b128 v[88:91], v14 offset:45056
  v_mfma_f32_16x16x32_bf16 a[92:95], v[52:55], v[108:111], a[92:95]
  v_mfma_f32_16x16x32_bf16 a[100:103], v[52:55], v[112:115], a[100:103]
  ds_read_b64_tr_b16 v[156:157], v13 offset:33536
  v_mfma_f32_16x16x32_bf16 a[108:111], v[52:55], v[116:119], a[108:111]
  v_mfma_f32_16x16x32_bf16 a[116:119], v[52:55], v[120:123], a[116:119]
  ds_read_b64_tr_b16 v[158:159], v13 offset:34560
  v_mfma_f32_16x16x32_bf16 a[124:127], v[52:55], v[124:127], a[124:127]
  v_mfma_f32_16x16x32_bf16 a[128:131], v[56:59], v[96:99], a[128:131]
  s_add_u32 s26, s26, s79
  ds_read_b128 v[92:95], v14 offset:46080
  v_mfma_f32_16x16x32_bf16 a[136:139], v[56:59], v[100:103], a[136:139]
  s_add_u32 s27, s27, s25
  v_mfma_f32_16x16x32_bf16 a[144:147], v[56:59], v[104:107], a[144:147]
  s_add_u32 s24, s24, 32768
  v_mfma_f32_16x16x32_bf16 a[152:155], v[56:59], v[108:111], a[152:155]
  s_and_b32 s24, s24, 0x1ffff
  v_mfma_f32_16x16x32_bf16 a[160:163], v[56:59], v[112:115], a[160:163]
  v_xor_b32 v14, 0x10000, v14
  v_mfma_f32_16x16x32_bf16 a[168:171], v[56:59], v[116:119], a[168:171]
  v_xor_b32 v12, 0x10000, v12
  v_mfma_f32_16x16x32_bf16 a[176:179], v[56:59], v[120:123], a[176:179]
  v_xor_b32 v13, 0x10000, v13
  v_mfma_f32_16x16x32_bf16 a[184:187], v[56:59], v[124:127], a[184:187]
  v_mfma_f32_16x16x32_bf16 a[132:135], v[60:63], v[96:99], a[132:135]
  v_mfma_f32_16x16x32_bf16 a[140:143], v[60:63], v[100:103], a[140:143]
  v_mfma_f32_16x16x32_bf16 a[148:151], v[60:63], v[104:107], a[148:151]
  v_mfma_f32_16x16x32_bf16 a[156:159], v[60:63], v[108:111], a[156:159]
  v_mfma_f32_16x16x32_bf16 a[164:167], v[60:63], v[112:115], a[164:167]
  v_mfma_f32_16x16x32_bf16 a[172:175], v[60:63], v[116:119], a[172:175]
  v_mfma_f32_16x16x32_bf16 a[180:183], v[60:63], v[120:123], a[180:183]
  v_mfma_f32_16x16x32_bf16 a[188:191], v[60:63], v[124:127], a[188:191]
  s_waitcnt lgkmcnt(0)
  v_mfma_f32_16x16x32_bf16 a[192:195], v[64:67], v[128:131], a[192:195]
  s_waitcnt vmcnt(18)
  v_mfma_f32_16x16x32_bf16 a[200:203], v[64:67], v[132:135], a[200:203]
  s_barrier
  v_mfma_f32_16x16x32_bf16 a[208:211], v[64:67], v[136:139], a[208:211]
  ds_read_b64_tr_b16 v[96:97], v12 offset:0
  v_mfma_f32_16x16x32_bf16 a[216:219], v[64:67], v[140:143], a[216:219]
  v_mfma_f32_16x16x32_bf16 a[224:227], v[64:67], v[144:147], a[224:227]
  s_mov_b32 m0, s24
  ds_read_b64_tr_b16 v[98:99], v12 offset:1024
  v_mfma_f32_16x16x32_bf16 a[232:235], v[64:67], v[148:151], a[232:235]
  buffer_load_dwordx4 v3, s[32:35], s26 offen offset:0 sc1 lds
  v_mfma_f32_16x16x32_bf16 a[240:243], v[64:67], v[152:155], a[240:243]
  ds_read_b128 v[32:35], v14 offset:0
  v_mfma_f32_16x16x32_bf16 a[248:251], v[64:67], v[156:159], a[248:251]
  v_mfma_f32_16x16x32_bf16 a[196:199], v[68:71], v[128:131], a[196:199]
  ds_read_b64_tr_b16 v[100:101], v13 offset:0
  v_mfma_f32_16x16x32_bf16 a[204:207], v[68:71], v[132:135], a[204:207]
  v_mfma_f32_16x16x32_bf16 a[212:215], v[68:71], v[136:139], a[212:215]
  ds_read_b64_tr_b16 v[102:103], v13 offset:1024
  v_mfma_f32_16x16x32_bf16 a[220:223], v[68:71], v[140:143], a[220:223]
  buffer_load_dwordx4 v4, s[32:35], s26 offen offset:1024 sc1 lds
  v_mfma_f32_16x16x32_bf16 a[228:231], v[68:71], v[144:147], a[228:231]
  ds_read_b128 v[36:39], v14 offset:1024
  v_mfma_f32_16x16x32_bf16 a[236:239], v[68:71], v[148:151], a[236:239]
  v_mfma_f32_16x16x32_bf16 a[244:247], v[68:71], v[152:155], a[244:247]
  ds_read_b64_tr_b16 v[104:105], v12 offset:256
  v_mfma_f32_16x16x32_bf16 a[252:255], v[68:71], v[156:159], a[252:255]
  v_mfma_f32_16x16x32_bf16 a[0:3], v[72:75], v[128:131], a[0:3]
  ds_read_b64_tr_b16 v[106:107], v12 offset:1280
  v_mfma_f32_16x16x32_bf16 a[8:11], v[72:75], v[132:135], a[8:11]
  buffer_load_dwordx4 v5, s[32:35], s26 offen offset:2048 sc1 lds
  v_mfma_f32_16x16x32_bf16 a[16:19], v[72:75], v[136:139], a[16:19]
  ds_read_b128 v[40:43], v14 offset:4096
  v_mfma_f32_16x16x32_bf16 a[24:27], v[72:75], v[140:143], a[24:27]
  v_mfma_f32_16x16x32_bf16 a[32:35], v[72:75], v[144:147], a[32:35]
  ds_read_b64_tr_b16 v[108:109], v13 offset:256
  v_mfma_f32_16x16x32_bf16 a[40:43], v[72:75], v[148:151], a[40:43]
  v_mfma_f32_16x16x32_bf16 a[48:51], v[72:75], v[152:155], a[48:51]
  ds_read_b64_tr_b16 v[110:111], v13 offset:1280
  v_mfma_f32_16x16x32_bf16 a[56:59], v[72:75], v[156:159], a[56:59]
  buffer_load_dwordx4 v6, s[32:35], s26 offen offset:3072 sc1 lds
  v_mfma_f32_16x16x32_bf16 a[4:7], v[76:79], v[128:131], a[4:7]
  ds_read_b128 v[44:47], v14 offset:5120
  v_mfma_f32_16x16x32_bf16 a[12:15], v[76:79], v[132:135], a[12:15]
  v_mfma_f32_16x16x32_bf16 a[20:23], v[76:79], v[136:139], a[20:23]
  ds_read_b64_tr_b16 v[112:113], v12 offset:512
  v_mfma_f32_16x16x32_bf16 a[28:31], v[76:79], v[140:143], a[28:31]
  v_mfma_f32_16x16x32_bf16 a[36:39], v[76:79], v[144:147], a[36:39]
  s_add_u32 m0, s24, 16384
  ds_read_b64_tr_b16 v[114:115], v12 offset:1536
  v_mfma_f32_16x16x32_bf16 a[44:47], v[76:79], v[148:151], a[44:47]
  buffer_load_dwordx4 v8, s[36:39], s27 offen offset:0 lds
  v_mfma_f32_16x16x32_bf16 a[52:55], v[76:79], v[152:155], a[52:55]
  ds_read_b128 v[48:51], v14 offset:8192
  v_mfma_f32_16x16x32_bf16 a[60:63], v[76:79], v[156:159], a[60:63]
  v_mfma_f32_16x16x32_bf16 a[64:67], v[80:83], v[128:131], a[64:67]
  ds_read_b64_tr_b16 v[116:117], v13 offset:512
  v_mfma_f32_16x16x32_bf16 a[72:75], v[80:83], v[132:135], a[72:75]
  v_mfma_f32_16x16x32_bf16 a[80:83], v[80:83], v[136:139], a[80:83]
  ds_read_b64_tr_b16 v[118:119], v13 offset:1536
  v_mfma_f32_16x16x32_bf16 a[88:91], v[80:83], v[140:143], a[88:91]
  buffer_load_dwordx4 v9, s[36:39], s27 offen offset:1024 lds
  v_mfma_f32_16x16x32_bf16 a[96:99], v[80:83], v[144:147], a[96:99]
  ds_read_b128 v[52:55], v14 offset:9216
  v_mfma_f32_16x16x32_bf16 a[104:107], v[80:83], v[148:151], a[104:107]
  v_mfma_f32_16x16x32_bf16 a[112:115], v[80:83], v[152:155], a[112:115]
  ds_read_b64_tr_b16 v[120:121], v12 offset:768
  v_mfma_f32_16x16x32_bf16 a[120:123], v[80:83], v[156:159], a[120:123]
  v_mfma_f32_16x16x32_bf16 a[68:71], v[84:87], v[128:131], a[68:71]
  ds_read_b64_tr_b16 v[122:123], v12 offset:1792
  v_mfma_f32_16x16x32_bf16 a[76:79], v[84:87], v[132:135], a[76:79]
  buffer_load_dwordx4 v10, s[36:39], s27 offen offset:2048 lds
  v_mfma_f32_16x16x32_bf16 a[84:87], v[84:87], v[136:139], a[84:87]
  ds_read_b128 v[56:59], v14 offset:12288
  v_mfma_f32_16x16x32_bf16 a[92:95], v[84:87], v[140:143], a[92:95]
  v_mfma_f32_16x16x32_bf16 a[100:103], v[84:87], v[144:147], a[100:103]
  ds_read_b64_tr_b16 v[124:125], v13 offset:768
  v_mfma_f32_16x16x32_bf16 a[108:111], v[84:87], v[148:151], a[108:111]
  v_mfma_f32_16x16x32_bf16 a[116:119], v[84:87], v[152:155], a[116:119]
  ds_read_b64_tr_b16 v[126:127], v13 offset:1792
  v_mfma_f32_16x16x32_bf16 a[124:127], v[84:87], v[156:159], a[124:127]
  buffer_load_dwordx4 v11, s[36:39], s27 offen offset:3072 lds
  v_mfma_f32_16x16x32_bf16 a[128:131], v[88:91], v[128:131], a[128:131]
  s_add_u32 s26, s26, s79
  ds_read_b128 v[60:63], v14 offset:13312
  v_mfma_f32_16x16x32_bf16 a[136:139], v[88:91], v[132:135], a[136:139]
  s_add_u32 s27, s27, s25
  v_mfma_f32_16x16x32_bf16 a[144:147], v[88:91], v[136:139], a[144:147]
  s_add_u32 s24, s24, 32768
  v_mfma_f32_16x16x32_bf16 a[152:155], v[88:91], v[140:143], a[152:155]
  s_and_b32 s24, s24, 0x1ffff
  v_mfma_f32_16x16x32_bf16 a[160:163], v[88:91], v[144:147], a[160:163]
  v_mfma_f32_16x16x32_bf16 a[168:171], v[88:91], v[148:151], a[168:171]
  s_bitcmp1_b32 s76, s28
  v_mfma_f32_16x16x32_bf16 a[176:179], v[88:91], v[152:155], a[176:179]
  s_cbranch_scc1 fa_hk3
fa_hb3:
  v_mfma_f32_16x16x32_bf16 a[184:187], v[88:91], v[156:159], a[184:187]
  v_mfma_f32_16x16x32_bf16 a[132:135], v[92:95], v[128:131], a[132:135]
  v_mfma_f32_16x16x32_bf16 a[140:143], v[92:95], v[132:135], a[140:143]
  s_add_u32 s28, s28, 1
  v_mfma_f32_16x16x32_bf16 a[148:151], v[92:95], v[136:139], a[148:151]
  v_mfma_f32_16x16x32_bf16 a[156:159], v[92:95], v[140:143], a[156:159]
  v_mfma_f32_16x16x32_bf16 a[164:167], v[92:95], v[144:147], a[164:167]
  v_mfma_f32_16x16x32_bf16 a[172:175], v[92:95], v[148:151], a[172:175]
  s_cmp_lt_u32 s28, 8
  v_mfma_f32_16x16x32_bf16 a[180:183], v[92:95], v[152:155], a[180:183]
  s_waitcnt lgkmcnt(0)
  v_mfma_f32_16x16x32_bf16 a[188:191], v[92:95], v[156:159], a[188:191]
  s_cbranch_scc1 fa_loopV
  s_mov_b32 s64, 33554432
  s_mov_b32 s76, 1.0
fa_p1epi:
  s_lshr_b32 s23, s20, 1
  s_lshl_b32 s23, s23, 13
  v_subrev_u32 v12, s23, v12
  v_subrev_u32 v13, s23, v13
  s_lshl_b32 s24, s20, 12
  v_add_u32 v14, s24, v2
  ds_read_b64_tr_b16 v[32:33], v12 offset:0
  ds_read_b64_tr_b16 v[34:35], v12 offset:1024
  ds_read_b64_tr_b16 v[36:37], v13 offset:0
  ds_read_b64_tr_b16 v[38:39], v13 offset:1024
  ds_read_b64_tr_b16 v[40:41], v12 offset:256
  ds_read_b64_tr_b16 v[42:43], v12 offset:1280
  ds_read_b64_tr_b16 v[44:45], v13 offset:256
  ds_read_b64_tr_b16 v[46:47], v13 offset:1280
  ds_read_b64_tr_b16 v[48:49], v12 offset:512
  ds_read_b64_tr_b16 v[50:51], v12 offset:1536
  ds_read_b64_tr_b16 v[52:53], v13 offset:512
  ds_read_b64_tr_b16 v[54:55], v13 offset:1536
  ds_read_b64_tr_b16 v[56:57], v12 offset:768
  ds_read_b64_tr_b16 v[58:59], v12 offset:1792
  ds_read_b64_tr_b16 v[60:61], v13 offset:768
  ds_read_b64_tr_b16 v[62:63], v13 offset:1792
  s_waitcnt vmcnt(8)
  ds_read_b128 v[224:227], v14 offset:0
  ds_read_b128 v[228:231], v14 offset:1024
  ds_read_b128 v[232:235], v14 offset:2048
  ds_read_b128 v[236:239], v14 offset:3072
  s_lshl_b32 s23, s21, 19
  s_add_u32 s64, s64, s23
  s_lshl_b32 s23, s22, 14
  s_add_u32 s64, s64, s23
  s_and_b32 s23, s20, 1
  s_lshl_b32 s23, s23, 13
  s_add_u32 s64, s64, s23
  s_lshl_b32 s23, s21, 19
  s_add_u32 s23, s23, 16777216
  s_add_u32 s6, s18, s23
  s_addc_u32 s7, s19, 0
  s_add_u32 s8, s6, 16777216
  s_addc_u32 s9, s7, 0
  s_sub_u32 s23, 16, s22
  s_lshl_b32 s23, s23, 15
  s_mov_b32 s44, s6
  s_mov_b32 s45, s7
  s_mov_b32 s46, s23
  s_mov_b32 s47, 0x20000
  s_mov_b32 s48, s8
  s_mov_b32 s49, s9
  s_mov_b32 s50, s23
  s_mov_b32 s51, 0x20000
  s_lshl_b32 s30, s21, 7
  s_add_u32 s30, s30, 2637824
  s_mov_b32 s81, 0x47800000
  s_cmp_eq_u32 s20, 0
  s_cselect_b32 s65, s82, 1073741824
  s_waitcnt vmcnt(21) lgkmcnt(0)
  v_mfma_f32_16x16x32_bf16 v[96:99], v[32:35], v[224:227], 0
  v_accvgpr_read_b32 v16, a192
  v_accvgpr_read_b32 v17, a193
  v_accvgpr_read_b32 v18, a194
  v_mfma_f32_16x16x32_bf16 v[112:115], v[36:39], v[224:227], 0
  ds_read_b64_tr_b16 v[64:65], v12 offset:8192
  v_accvgpr_read_b32 v19, a195
  v_mfma_f32_16x16x32_bf16 v[128:131], v[40:43], v[224:227], 0
  s_add_u32 m0, s24, 0
  ds_read_b64_tr_b16 v[66:67], v12 offset:9216
  v_accvgpr_read_b32 v20, a196
  v_mfma_f32_16x16x32_bf16 v[144:147], v[44:47], v[224:227], 0
  buffer_load_dwordx4 v3, s[32:35], s26 offen offset:0 sc1 lds
  v_accvgpr_read_b32 v21, a197
  v_mfma_f32_16x16x32_bf16 v[160:163], v[48:51], v[224:227], 0
  ds_read_b64_tr_b16 v[68:69], v13 offset:8192
  v_accvgpr_read_b32 v22, a198
  v_accvgpr_read_b32 v23, a199
  v_mfma_f32_16x16x32_bf16 v[176:179], v[52:55], v[224:227], 0
  ds_read_b64_tr_b16 v[70:71], v13 offset:9216
  v_mul_f32 v16, s76, v16
  v_mfma_f32_16x16x32_bf16 v[192:195], v[56:59], v[224:227], 0
  ds_read_b64_tr_b16 v[72:73], v12 offset:8448
  v_mul_f32 v17, s76, v17
  v_mfma_f32_16x16x32_bf16 v[208:211], v[60:63], v[224:227], 0
  ds_read_b64_tr_b16 v[74:75], v12 offset:9472
  v_mul_f32 v18, s76, v18
  v_mfma_f32_16x16x32_bf16 v[100:103], v[32:35], v[228:231], 0
  buffer_load_dwordx4 v4, s[32:35], s26 offen offset:1024 sc1 lds
  v_mul_f32 v19, s76, v19
  v_mul_f32 v20, s76, v20
  v_mfma_f32_16x16x32_bf16 v[116:119], v[36:39], v[228:231], 0
  ds_read_b64_tr_b16 v[76:77], v13 offset:8448
  v_mul_f32 v21, s76, v21
  v_mfma_f32_16x16x32_bf16 v[132:135], v[40:43], v[228:231], 0
  ds_read_b64_tr_b16 v[78:79], v13 offset:9472
  v_mul_f32 v22, s76, v22
  v_mfma_f32_16x16x32_bf16 v[148:151], v[44:47], v[228:231], 0
  ds_read_b128 v[240:243], v14 offset:32768
  v_mul_f32 v23, s76, v23
  v_mfma_f32_16x16x32_bf16 v[164:167], v[48:51], v[228:231], 0
  ds_read_b128 v[244:247], v14 offset:33792
  v_cvt_pk_bf16_f32 v24, v16, v17
  v_cvt_pk_bf16_f32 v25, v18, v19
  v_mfma_f32_16x16x32_bf16 v[180:183], v[52:55], v[228:231], 0
  buffer_load_dwordx4 v5, s[32:35], s26 offen offset:2048 sc1 lds
  v_cvt_pk_bf16_f32 v26, v20, v21
  v_mfma_f32_16x16x32_bf16 v[196:199], v[56:59], v[228:231], 0
  ds_read_b64_tr_b16 v[80:81], v12 offset:8704
  v_cvt_pk_bf16_f32 v27, v22, v23
  v_mfma_f32_16x16x32_bf16 v[212:215], v[60:63], v[228:231], 0
  ds_read_b64_tr_b16 v[82:83], v12 offset:9728
  buffer_store_dwordx4 v[24:27], v2, s[40:43], s64 offen offset:0 sc1
  v_mfma_f32_16x16x32_bf16 v[104:107], v[32:35], v[232:235], 0
  ds_read_b64_tr_b16 v[84:85], v13 offset:8704
  v_accvgpr_read_b32 v16, a200
  v_mfma_f32_16x16x32_bf16 v[120:123], v[36:39], v[232:235], 0
  ds_read_b64_tr_b16 v[86:87], v13 offset:9728
  v_accvgpr_read_b32 v17, a201
  v_accvgpr_read_b32 v18, a202
  v_mfma_f32_16x16x32_bf16 v[136:139], v[40:43], v[232:235], 0
  buffer_load_dwordx4 v6, s[32:35], s26 offen offset:3072 sc1 lds
  v_accvgpr_read_b32 v19, a203
  v_mfma_f32_16x16x32_bf16 v[152:155], v[44:47], v[232:235], 0
  s_add_u32 s26, s26, 1024
  ds_read_b64_tr_b16 v[88:89], v12 offset:8960
  v_accvgpr_read_b32 v20, a204
  v_mfma_f32_16x16x32_bf16 v[168:171], v[48:51], v[232:235], 0
  ds_read_b64_tr_b16 v[90:91], v12 offset:9984
  v_accvgpr_read_b32 v21, a205
  v_mfma_f32_16x16x32_bf16 v[184:187], v[52:55], v[232:235], 0
  ds_read_b64_tr_b16 v[92:93], v13 offset:8960
  v_accvgpr_read_b32 v22, a206
  v_accvgpr_read_b32 v23, a207
  v_mfma_f32_16x16x32_bf16 v[200:203], v[56:59], v[232:235], 0
  ds_read_b64_tr_b16 v[94:95], v13 offset:9984
  v_mul_f32 v16, s76, v16
  v_mfma_f32_16x16x32_bf16 v[216:219], v[60:63], v[232:235], 0
  v_mul_f32 v17, s76, v17
  v_mul_f32 v18, s76, v18
  v_mfma_f32_16x16x32_bf16 v[108:111], v[32:35], v[236:239], 0
  ds_read_b128 v[248:251], v14 offset:34816
  v_mul_f32 v19, s76, v19
  v_mfma_f32_16x16x32_bf16 v[124:127], v[36:39], v[236:239], 0
  ds_read_b128 v[252:255], v14 offset:35840
  v_mul_f32 v20, s76, v20
  v_mul_f32 v21, s76, v21
  v_mfma_f32_16x16x32_bf16 v[140:143], v[40:43], v[236:239], 0
  v_mul_f32 v22, s76, v22
  v_mul_f32 v23, s76, v23
  v_mfma_f32_16x16x32_bf16 v[156:159], v[44:47], v[236:239], 0
  v_xor_b32 v14, 0x10000, v14
  v_cvt_pk_bf16_f32 v28, v16, v17
  v_mfma_f32_16x16x32_bf16 v[172:175], v[48:51], v[236:239], 0
  v_cvt_pk_bf16_f32 v29, v18, v19
  v_cvt_pk_bf16_f32 v30, v20, v21
  v_mfma_f32_16x16x32_bf16 v[188:191], v[52:55], v[236:239], 0
  v_cvt_pk_bf16_f32 v31, v22, v23
  v_mfma_f32_16x16x32_bf16 v[204:207], v[56:59], v[236:239], 0
  buffer_store_dwordx4 v[28:31], v2, s[40:43], s64 offen offset:1024 sc1
  v_mfma_f32_16x16x32_bf16 v[220:223], v[60:63], v[236:239], 0
  s_waitcnt vmcnt(19) lgkmcnt(0)
  v_mfma_f32_16x16x32_bf16 v[96:99], v[64:67], v[240:243], v[96:99]
  s_barrier
  v_accvgpr_read_b32 v16, a208
  v_accvgpr_read_b32 v17, a209
  v_accvgpr_read_b32 v18, a210
  v_mfma_f32_16x16x32_bf16 v[112:115], v[68:71], v[240:243], v[112:115]
  ds_read_b64_tr_b16 v[32:33], v12 offset:32768
  v_accvgpr_read_b32 v19, a211
  v_mfma_f32_16x16x32_bf16 v[128:131], v[72:75], v[240:243], v[128:131]
  s_add_u32 m0, s24, 32768
  ds_read_b64_tr_b16 v[34:35], v12 offset:33792
  v_accvgpr_read_b32 v20, a212
  v_mfma_f32_16x16x32_bf16 v[144:147], v[76:79], v[240:243], v[144:147]
  buffer_load_dwordx4 v3, s[32:35], s26 offen offset:0 sc1 lds
  v_accvgpr_read_b32 v21, a213
  v_mfma_f32_16x16x32_bf16 v[160:163], v[80:83], v[240:243], v[160:163]
  ds_read_b64_tr_b16 v[36:37], v13 offset:32768
  v_accvgpr_read_b32 v22, a214
  v_accvgpr_read_b32 v23, a215
  v_mfma_f32_16x16x32_bf16 v[176:179], v[84:87], v[240:243], v[176:179]
  ds_read_b64_tr_b16 v[38:39], v13 offset:33792
  v_mul_f32 v16, s76, v16
  v_mfma_f32_16x16x32_bf16 v[192:195], v[88:91], v[240:243], v[192:195]
  ds_read_b64_tr_b16 v[40:41], v12 offset:33024
  v_mul_f32 v17, s76, v17
  v_mfma_f32_16x16x32_bf16 v[208:211], v[92:95], v[240:243], v[208:211]
  ds_read_b64_tr_b16 v[42:43], v12 offset:34048
  v_mul_f32 v18, s76, v18
  v_mfma_f32_16x16x32_bf16 v[100:103], v[64:67], v[244:247], v[100:103]
  buffer_load_dwordx4 v4, s[32:35], s26 offen offset:1024 sc1 lds
  v_mul_f32 v19, s76, v19
  v_mul_f32 v20, s76, v20
  v_mfma_f32_16x16x32_bf16 v[116:119], v[68:71], v[244:247], v[116:119]
  ds_read_b64_tr_b16 v[44:45], v13 offset:33024
  v_mul_f32 v21, s76, v21
  v_mfma_f32_16x16x32_bf16 v[132:135], v[72:75], v[244:247], v[132:135]
  ds_read_b64_tr_b16 v[46:47], v13 offset:34048
  v_mul_f32 v22, s76, v22
  v_mfma_f32_16x16x32_bf16 v[148:151], v[76:79], v[244:247], v[148:151]
  ds_read_b128 v[224:227], v14 offset:0
  v_mul_f32 v23, s76, v23
  v_mfma_f32_16x16x32_bf16 v[164:167], v[80:83], v[244:247], v[164:167]
  ds_read_b128 v[228:231], v14 offset:1024
  v_cvt_pk_bf16_f32 v24, v16, v17
  v_cvt_pk_bf16_f32 v25, v18, v19
  v_mfma_f32_16x16x32_bf16 v[180:183], v[84:87], v[244:247], v[180:183]
  buffer_load_dwordx4 v5, s[32:35], s26 offen offset:2048 sc1 lds
  v_cvt_pk_bf16_f32 v26, v20, v21
  v_mfma_f32_16x16x32_bf16 v[196:199], v[88:91], v[244:247], v[196:199]
  ds_read_b64_tr_b16 v[48:49], v12 offset:33280
  v_cvt_pk_bf16_f32 v27, v22, v23
  v_mfma_f32_16x16x32_bf16 v[212:215], v[92:95], v[244:247], v[212:215]
  ds_read_b64_tr_b16 v[50:51], v12 offset:34304
  buffer_store_dwordx4 v[24:27], v2, s[40:43], s64 offen offset:2048 sc1
  v_mfma_f32_16x16x32_bf16 v[104:107], v[64:67], v[248:251], v[104:107]
  ds_read_b64_tr_b16 v[52:53], v13 offset:33280
  v_accvgpr_read_b32 v16, a216
  v_mfma_f32_16x16x32_bf16 v[120:123], v[68:71], v[248:251], v[120:123]
  ds_read_b64_tr_b16 v[54:55], v13 offset:34304
  v_accvgpr_read_b32 v17, a217
  v_accvgpr_read_b32 v18, a218
  v_mfma_f32_16x16x32_bf16 v[136:139], v[72:75], v[248:251], v[136:139]
  buffer_load_dwordx4 v6, s[32:35], s26 offen offset:3072 sc1 lds
  v_accvgpr_read_b32 v19, a219
  v_mfma_f32_16x16x32_bf16 v[152:155], v[76:79], v[248:251], v[152:155]
  s_add_u32 s26, s26, 1024
  ds_read_b64_tr_b16 v[56:57], v12 offset:33536
  v_accvgpr_read_b32 v20, a220
  v_mfma_f32_16x16x32_bf16 v[168:171], v[80:83], v[248:251], v[168:171]
  ds_read_b64_tr_b16 v[58:59], v12 offset:34560
  v_accvgpr_read_b32 v21, a221
  v_mfma_f32_16x16x32_bf16 v[184:187], v[84:87], v[248:251], v[184:187]
  ds_read_b64_tr_b16 v[60:61], v13 offset:33536
  v_accvgpr_read_b32 v22, a222
  v_accvgpr_read_b32 v23, a223
  v_mfma_f32_16x16x32_bf16 v[200:203], v[88:91], v[248:251], v[200:203]
  s_add_u32 m0, s24, 16384
  ds_read_b64_tr_b16 v[62:63], v13 offset:34560
  v_mul_f32 v16, s76, v16
  v_mfma_f32_16x16x32_bf16 v[216:219], v[92:95], v[248:251], v[216:219]
  buffer_load_dwordx4 v8, s[36:39], s27 offen offset:0 lds
  v_mul_f32 v17, s76, v17
  v_mfma_f32_16x16x32_bf16 v[108:111], v[64:67], v[252:255], v[108:111]
  ds_read_b128 v[232:235], v14 offset:2048
  v_mul_f32 v18, s76, v18
  v_mfma_f32_16x16x32_bf16 v[124:127], v[68:71], v[252:255], v[124:127]
  ds_read_b128 v[236:239], v14 offset:3072
  v_mul_f32 v19, s76, v19
  v_mul_f32 v20, s76, v20
  v_mfma_f32_16x16x32_bf16 v[140:143], v[72:75], v[252:255], v[140:143]
  v_mul_f32 v21, s76, v21
  v_mul_f32 v22, s76, v22
  v_mfma_f32_16x16x32_bf16 v[156:159], v[76:79], v[252:255], v[156:159]
  v_mul_f32 v23, s76, v23
  v_cvt_pk_bf16_f32 v28, v16, v17
  v_mfma_f32_16x16x32_bf16 v[172:175], v[80:83], v[252:255], v[172:175]
  buffer_load_dwordx4 v9, s[36:39], s27 offen offset:1024 lds
  v_cvt_pk_bf16_f32 v29, v18, v19
  v_mfma_f32_16x16x32_bf16 v[188:191], v[84:87], v[252:255], v[188:191]
  v_cvt_pk_bf16_f32 v30, v20, v21
  v_cvt_pk_bf16_f32 v31, v22, v23
  v_mfma_f32_16x16x32_bf16 v[204:207], v[88:91], v[252:255], v[204:207]
  buffer_store_dwordx4 v[28:31], v2, s[40:43], s64 offen offset:3072 sc1
  v_mfma_f32_16x16x32_bf16 v[220:223], v[92:95], v[252:255], v[220:223]
  s_waitcnt vmcnt(18) lgkmcnt(0)
  v_mfma_f32_16x16x32_bf16 v[96:99], v[32:35], v[224:227], v[96:99]
  s_add_u32 s64, s64, 4096
  v_accvgpr_read_b32 v16, a224
  v_accvgpr_read_b32 v17, a225
  v_mfma_f32_16x16x32_bf16 v[112:115], v[36:39], v[224:227], v[112:115]
  ds_read_b64_tr_b16 v[64:65], v12 offset:40960
  v_accvgpr_read_b32 v18, a226
  v_mfma_f32_16x16x32_bf16 v[128:131], v[40:43], v[224:227], v[128:131]
  s_add_u32 m0, s24, 65536
  ds_read_b64_tr_b16 v[66:67], v12 offset:41984
  v_accvgpr_read_b32 v19, a227
  v_mfma_f32_16x16x32_bf16 v[144:147], v[44:47], v[224:227], v[144:147]
  buffer_load_dwordx4 v3, s[32:35], s26 offen offset:0 sc1 lds
  v_accvgpr_read_b32 v20, a228
  v_mfma_f32_16x16x32_bf16 v[160:163], v[48:51], v[224:227], v[160:163]
  ds_read_b64_tr_b16 v[68:69], v13 offset:40960
  v_accvgpr_read_b32 v21, a229
  v_mfma_f32_16x16x32_bf16 v[176:179], v[52:55], v[224:227], v[176:179]
  ds_read_b64_tr_b16 v[70:71], v13 offset:41984
  v_accvgpr_read_b32 v22, a230
  v_mfma_f32_16x16x32_bf16 v[192:195], v[56:59], v[224:227], v[192:195]
  ds_read_b64_tr_b16 v[72:73], v12 offset:41216
  v_accvgpr_read_b32 v23, a231
  v_mfma_f32_16x16x32_bf16 v[208:211], v[60:63], v[224:227], v[208:211]
  ds_read_b64_tr_b16 v[74:75], v12 offset:42240
  v_mul_f32 v16, s76, v16
  v_mfma_f32_16x16x32_bf16 v[100:103], v[32:35], v[228:231], v[100:103]
  buffer_load_dwordx4 v4, s[32:35], s26 offen offset:1024 sc1 lds
  v_mul_f32 v17, s76, v17
  v_mfma_f32_16x16x32_bf16 v[116:119], v[36:39], v[228:231], v[116:119]
  ds_read_b64_tr_b16 v[76:77], v13 offset:41216
  v_mul_f32 v18, s76, v18
  v_mfma_f32_16x16x32_bf16 v[132:135], v[40:43], v[228:231], v[132:135]
  ds_read_b64_tr_b16 v[78:79], v13 offset:42240
  v_mul_f32 v19, s76, v19
  v_mfma_f32_16x16x32_bf16 v[148:151], v[44:47], v[228:231], v[148:151]
  ds_read_b128 v[240:243], v14 offset:32768
  v_mul_f32 v20, s76, v20
  v_mfma_f32_16x16x32_bf16 v[164:167], v[48:51], v[228:231], v[164:167]
  ds_read_b128 v[244:247], v14 offset:33792
  v_mul_f32 v21, s76, v21
  v_mfma_f32_16x16x32_bf16 v[180:183], v[52:55], v[228:231], v[180:183]
  buffer_load_dwordx4 v5, s[32:35], s26 offen offset:2048 sc1 lds
  v_mul_f32 v22, s76, v22
  v_mfma_f32_16x16x32_bf16 v[196:199], v[56:59], v[228:231], v[196:199]
  ds_read_b64_tr_b16 v[80:81], v12 offset:41472
  v_mul_f32 v23, s76, v23
  v_mfma_f32_16x16x32_bf16 v[212:215], v[60:63], v[228:231], v[212:215]
  ds_read_b64_tr_b16 v[82:83], v12 offset:42496
  v_cvt_pk_bf16_f32 v24, v16, v17
  v_mfma_f32_16x16x32_bf16 v[104:107], v[32:35], v[232:235], v[104:107]
  ds_read_b64_tr_b16 v[84:85], v13 offset:41472
  v_cvt_pk_bf16_f32 v25, v18, v19
  v_mfma_f32_16x16x32_bf16 v[120:123], v[36:39], v[232:235], v[120:123]
  ds_read_b64_tr_b16 v[86:87], v13 offset:42496
  v_cvt_pk_bf16_f32 v26, v20, v21
  v_mfma_f32_16x16x32_bf16 v[136:139], v[40:43], v[232:235], v[136:139]
  buffer_load_dwordx4 v6, s[32:35], s26 offen offset:3072 sc1 lds
  v_cvt_pk_bf16_f32 v27, v22, v23
  v_mfma_f32_16x16x32_bf16 v[152:155], v[44:47], v[232:235], v[152:155]
  s_add_u32 s26, s26, 1024
  ds_read_b64_tr_b16 v[88:89], v12 offset:41728
  buffer_store_dwordx4 v[24:27], v2, s[40:43], s64 offen offset:0 sc1
  v_mfma_f32_16x16x32_bf16 v[168:171], v[48:51], v[232:235], v[168:171]
  ds_read_b64_tr_b16 v[90:91], v12 offset:42752
  v_mfma_f32_16x16x32_bf16 v[184:187], v[52:55], v[232:235], v[184:187]
  ds_read_b64_tr_b16 v[92:93], v13 offset:41728
  v_mfma_f32_16x16x32_bf16 v[200:203], v[56:59], v[232:235], v[200:203]
  s_add_u32 m0, s24, 16384
  ds_read_b64_tr_b16 v[94:95], v13 offset:42752
  v_mfma_f32_16x16x32_bf16 v[216:219], v[60:63], v[232:235], v[216:219]
  buffer_load_dwordx4 v10, s[36:39], s27 offen offset:2048 lds
  v_mfma_f32_16x16x32_bf16 v[108:111], v[32:35], v[236:239], v[108:111]
  ds_read_b128 v[248:251], v14 offset:34816
  v_mfma_f32_16x16x32_bf16 v[124:127], v[36:39], v[236:239], v[124:127]
  ds_read_b128 v[252:255], v14 offset:35840
  v_mfma_f32_16x16x32_bf16 v[140:143], v[40:43], v[236:239], v[140:143]
  v_mfma_f32_16x16x32_bf16 v[156:159], v[44:47], v[236:239], v[156:159]
  v_xor_b32 v14, 0x10000, v14
  v_mfma_f32_16x16x32_bf16 v[172:175], v[48:51], v[236:239], v[172:175]
  buffer_load_dwordx4 v11, s[36:39], s27 offen offset:3072 lds
  v_mfma_f32_16x16x32_bf16 v[188:191], v[52:55], v[236:239], v[188:191]
  s_add_u32 s27, s27, 524288
  v_xor_b32 v12, 0x10000, v12
  v_mfma_f32_16x16x32_bf16 v[204:207], v[56:59], v[236:239], v[204:207]
  v_xor_b32 v13, 0x10000, v13
  v_mfma_f32_16x16x32_bf16 v[220:223], v[60:63], v[236:239], v[220:223]
  s_waitcnt vmcnt(16) lgkmcnt(0)
  v_mfma_f32_16x16x32_bf16 v[96:99], v[64:67], v[240:243], v[96:99]
  s_barrier
  v_accvgpr_read_b32 v16, a232
  v_accvgpr_read_b32 v17, a233
  v_mfma_f32_16x16x32_bf16 v[112:115], v[68:71], v[240:243], v[112:115]
  ds_read_b64_tr_b16 v[32:33], v12 offset:0
  v_accvgpr_read_b32 v18, a234
  v_mfma_f32_16x16x32_bf16 v[128:131], v[72:75], v[240:243], v[128:131]
  s_add_u32 m0, s24, 98304
  ds_read_b64_tr_b16 v[34:35], v12 offset:1024
  v_accvgpr_read_b32 v19, a235
  v_mfma_f32_16x16x32_bf16 v[144:147], v[76:79], v[240:243], v[144:147]
  buffer_load_dwordx4 v3, s[32:35], s26 offen offset:0 sc1 lds
  v_accvgpr_read_b32 v20, a236
  v_mfma_f32_16x16x32_bf16 v[160:163], v[80:83], v[240:243], v[160:163]
  ds_read_b64_tr_b16 v[36:37], v13 offset:0
  v_accvgpr_read_b32 v21, a237
  v_mfma_f32_16x16x32_bf16 v[176:179], v[84:87], v[240:243], v[176:179]
  ds_read_b64_tr_b16 v[38:39], v13 offset:1024
  v_accvgpr_read_b32 v22, a238
  v_mfma_f32_16x16x32_bf16 v[192:195], v[88:91], v[240:243], v[192:195]
  ds_read_b64_tr_b16 v[40:41], v12 offset:256
  v_accvgpr_read_b32 v23, a239
  v_mfma_f32_16x16x32_bf16 v[208:211], v[92:95], v[240:243], v[208:211]
  ds_read_b64_tr_b16 v[42:43], v12 offset:1280
  v_mul_f32 v16, s76, v16
  v_mfma_f32_16x16x32_bf16 v[100:103], v[64:67], v[244:247], v[100:103]
  buffer_load_dwordx4 v4, s[32:35], s26 offen offset:1024 sc1 lds
  v_mul_f32 v17, s76, v17
  v_mfma_f32_16x16x32_bf16 v[116:119], v[68:71], v[244:247], v[116:119]
  ds_read_b64_tr_b16 v[44:45], v13 offset:256
  v_mul_f32 v18, s76, v18
  v_mfma_f32_16x16x32_bf16 v[132:135], v[72:75], v[244:247], v[132:135]
  ds_read_b64_tr_b16 v[46:47], v13 offset:1280
  v_mul_f32 v19, s76, v19
  v_mfma_f32_16x16x32_bf16 v[148:151], v[76:79], v[244:247], v[148:151]
  ds_read_b128 v[224:227], v14 offset:0
  v_mul_f32 v20, s76, v20
  v_mfma_f32_16x16x32_bf16 v[164:167], v[80:83], v[244:247], v[164:167]
  ds_read_b128 v[228:231], v14 offset:1024
  v_mul_f32 v21, s76, v21
  v_mfma_f32_16x16x32_bf16 v[180:183], v[84:87], v[244:247], v[180:183]
  buffer_load_dwordx4 v5, s[32:35], s26 offen offset:2048 sc1 lds
  v_mul_f32 v22, s76, v22
  v_mfma_f32_16x16x32_bf16 v[196:199], v[88:91], v[244:247], v[196:199]
  ds_read_b64_tr_b16 v[48:49], v12 offset:512
  v_mul_f32 v23, s76, v23
  v_mfma_f32_16x16x32_bf16 v[212:215], v[92:95], v[244:247], v[212:215]
  ds_read_b64_tr_b16 v[50:51], v12 offset:1536
  v_cvt_pk_bf16_f32 v28, v16, v17
  v_mfma_f32_16x16x32_bf16 v[104:107], v[64:67], v[248:251], v[104:107]
  ds_read_b64_tr_b16 v[52:53], v13 offset:512
  v_cvt_pk_bf16_f32 v29, v18, v19
  v_mfma_f32_16x16x32_bf16 v[120:123], v[68:71], v[248:251], v[120:123]
  ds_read_b64_tr_b16 v[54:55], v13 offset:1536
  v_cvt_pk_bf16_f32 v30, v20, v21
  v_mfma_f32_16x16x32_bf16 v[136:139], v[72:75], v[248:251], v[136:139]
  buffer_load_dwordx4 v6, s[32:35], s26 offen offset:3072 sc1 lds
  v_cvt_pk_bf16_f32 v31, v22, v23
  v_mfma_f32_16x16x32_bf16 v[152:155], v[76:79], v[248:251], v[152:155]
  s_add_u32 s26, s26, 1024
  ds_read_b64_tr_b16 v[56:57], v12 offset:768
  buffer_store_dwordx4 v[28:31], v2, s[40:43], s64 offen offset:1024 sc1
  v_mfma_f32_16x16x32_bf16 v[168:171], v[80:83], v[248:251], v[168:171]
  ds_read_b64_tr_b16 v[58:59], v12 offset:1792
  v_mfma_f32_16x16x32_bf16 v[184:187], v[84:87], v[248:251], v[184:187]
  ds_read_b64_tr_b16 v[60:61], v13 offset:768
  v_mfma_f32_16x16x32_bf16 v[200:203], v[88:91], v[248:251], v[200:203]
  s_add_u32 m0, s24, 49152
  ds_read_b64_tr_b16 v[62:63], v13 offset:1792
  v_mfma_f32_16x16x32_bf16 v[216:219], v[92:95], v[248:251], v[216:219]
  buffer_load_dwordx4 v8, s[36:39], s27 offen offset:0 lds
  v_mfma_f32_16x16x32_bf16 v[108:111], v[64:67], v[252:255], v[108:111]
  ds_read_b128 v[232:235], v14 offset:2048
  v_mfma_f32_16x16x32_bf16 v[124:127], v[68:71], v[252:255], v[124:127]
  ds_read_b128 v[236:239], v14 offset:3072
  v_mfma_f32_16x16x32_bf16 v[140:143], v[72:75], v[252:255], v[140:143]
  v_mfma_f32_16x16x32_bf16 v[156:159], v[76:79], v[252:255], v[156:159]
  v_mfma_f32_16x16x32_bf16 v[172:175], v[80:83], v[252:255], v[172:175]
  buffer_load_dwordx4 v9, s[36:39], s27 offen offset:1024 lds
  v_mfma_f32_16x16x32_bf16 v[188:191], v[84:87], v[252:255], v[188:191]
  v_mfma_f32_16x16x32_bf16 v[204:207], v[88:91], v[252:255], v[204:207]
  v_mfma_f32_16x16x32_bf16 v[220:223], v[92:95], v[252:255], v[220:223]
  s_waitcnt vmcnt(17) lgkmcnt(0)
  v_mfma_f32_16x16x32_bf16 v[96:99], v[32:35], v[224:227], v[96:99]
  v_accvgpr_read_b32 v16, a240
  v_accvgpr_read_b32 v17, a241
  v_mfma_f32_16x16x32_bf16 v[112:115], v[36:39], v[224:227], v[112:115]
  ds_read_b64_tr_b16 v[64:65], v12 offset:8192
  v_accvgpr_read_b32 v18, a242
  v_mfma_f32_16x16x32_bf16 v[128:131], v[40:43], v[224:227], v[128:131]
  s_add_u32 m0, s24, 0
  ds_read_b64_tr_b16 v[66:67], v12 offset:9216
  v_accvgpr_read_b32 v19, a243
  v_mfma_f32_16x16x32_bf16 v[144:147], v[44:47], v[224:227], v[144:147]
  buffer_load_dwordx4 v3, s[32:35], s26 offen offset:0 sc1 lds
  v_accvgpr_read_b32 v20, a244
  v_mfma_f32_16x16x32_bf16 v[160:163], v[48:51], v[224:227], v[160:163]
  ds_read_b64_tr_b16 v[68:69], v13 offset:8192
  v_accvgpr_read_b32 v21, a245
  v_mfma_f32_16x16x32_bf16 v[176:179], v[52:55], v[224:227], v[176:179]
  ds_read_b64_tr_b16 v[70:71], v13 offset:9216
  v_accvgpr_read_b32 v22, a246
  v_mfma_f32_16x16x32_bf16 v[192:195], v[56:59], v[224:227], v[192:195]
  ds_read_b64_tr_b16 v[72:73], v12 offset:8448
  v_accvgpr_read_b32 v23, a247
  v_mfma_f32_16x16x32_bf16 v[208:211], v[60:63], v[224:227], v[208:211]
  ds_read_b64_tr_b16 v[74:75], v12 offset:9472
  v_mul_f32 v16, s76, v16
  v_mfma_f32_16x16x32_bf16 v[100:103], v[32:35], v[228:231], v[100:103]
  buffer_load_dwordx4 v4, s[32:35], s26 offen offset:1024 sc1 lds
  v_mul_f32 v17, s76, v17
  v_mfma_f32_16x16x32_bf16 v[116:119], v[36:39], v[228:231], v[116:119]
  ds_read_b64_tr_b16 v[76:77], v13 offset:8448
  v_mul_f32 v18, s76, v18
  v_mfma_f32_16x16x32_bf16 v[132:135], v[40:43], v[228:231], v[132:135]
  ds_read_b64_tr_b16 v[78:79], v13 offset:9472
  v_mul_f32 v19, s76, v19
  v_mfma_f32_16x16x32_bf16 v[148:151], v[44:47], v[228:231], v[148:151]
  ds_read_b128 v[240:243], v14 offset:32768
  v_mul_f32 v20, s76, v20
  v_mfma_f32_16x16x32_bf16 v[164:167], v[48:51], v[228:231], v[164:167]
  ds_read_b128 v[244:247], v14 offset:33792
  v_mul_f32 v21, s76, v21
  v_mfma_f32_16x16x32_bf16 v[180:183], v[52:55], v[228:231], v[180:183]
  buffer_load_dwordx4 v5, s[32:35], s26 offen offset:2048 sc1 lds
  v_mul_f32 v22, s76, v22
  v_mfma_f32_16x16x32_bf16 v[196:199], v[56:59], v[228:231], v[196:199]
  ds_read_b64_tr_b16 v[80:81], v12 offset:8704
  v_mul_f32 v23, s76, v23
  v_mfma_f32_16x16x32_bf16 v[212:215], v[60:63], v[228:231], v[212:215]
  ds_read_b64_tr_b16 v[82:83], v12 offset:9728
  v_cvt_pk_bf16_f32 v24, v16, v17
  v_mfma_f32_16x16x32_bf16 v[104:107], v[32:35], v[232:235], v[104:107]
  ds_read_b64_tr_b16 v[84:85], v13 offset:8704
  v_cvt_pk_bf16_f32 v25, v18, v19
  v_mfma_f32_16x16x32_bf16 v[120:123], v[36:39], v[232:235], v[120:123]
  ds_read_b64_tr_b16 v[86:87], v13 offset:9728
  v_cvt_pk_bf16_f32 v26, v20, v21
  v_mfma_f32_16x16x32_bf16 v[136:139], v[40:43], v[232:235], v[136:139]
  buffer_load_dwordx4 v6, s[32:35], s26 offen offset:3072 sc1 lds
  v_cvt_pk_bf16_f32 v27, v22, v23
  v_mfma_f32_16x16x32_bf16 v[152:155], v[44:47], v[232:235], v[152:155]
  s_add_u32 s26, s26, 1024
  ds_read_b64_tr_b16 v[88:89], v12 offset:8960
  buffer_store_dwordx4 v[24:27], v2, s[40:43], s64 offen offset:2048 sc1
  v_mfma_f32_16x16x32_bf16 v[168:171], v[48:51], v[232:235], v[168:171]
  ds_read_b64_tr_b16 v[90:91], v12 offset:9984
  v_mfma_f32_16x16x32_bf16 v[184:187], v[52:55], v[232:235], v[184:187]
  ds_read_b64_tr_b16 v[92:93], v13 offset:8960
  v_mfma_f32_16x16x32_bf16 v[200:203], v[56:59], v[232:235], v[200:203]
  s_add_u32 m0, s24, 49152
  ds_read_b64_tr_b16 v[94:95], v13 offset:9984
  v_mfma_f32_16x16x32_bf16 v[216:219], v[60:63], v[232:235], v[216:219]
  buffer_load_dwordx4 v10, s[36:39], s27 offen offset:2048 lds
  v_mfma_f32_16x16x32_bf16 v[108:111], v[32:35], v[236:239], v[108:111]
  ds_read_b128 v[248:251], v14 offset:34816
  v_mfma_f32_16x16x32_bf16 v[124:127], v[36:39], v[236:239], v[124:127]
  ds_read_b128 v[252:255], v14 offset:35840
  v_mfma_f32_16x16x32_bf16 v[140:143], v[40:43], v[236:239], v[140:143]
  v_mfma_f32_16x16x32_bf16 v[156:159], v[44:47], v[236:239], v[156:159]
  v_xor_b32 v14, 0x10000, v14
  v_mfma_f32_16x16x32_bf16 v[172:175], v[48:51], v[236:239], v[172:175]
  buffer_load_dwordx4 v11, s[36:39], s27 offen offset:3072 lds
  v_mfma_f32_16x16x32_bf16 v[188:191], v[52:55], v[236:239], v[188:191]
  s_add_u32 s27, s27, 524288
  v_mfma_f32_16x16x32_bf16 v[204:207], v[56:59], v[236:239], v[204:207]
  v_mfma_f32_16x16x32_bf16 v[220:223], v[60:63], v[236:239], v[220:223]
  s_waitcnt vmcnt(17) lgkmcnt(0)
  v_mfma_f32_16x16x32_bf16 v[96:99], v[64:67], v[240:243], v[96:99]
  s_barrier
  v_accvgpr_read_b32 v16, a248
  v_accvgpr_read_b32 v17, a249
  v_mfma_f32_16x16x32_bf16 v[112:115], v[68:71], v[240:243], v[112:115]
  ds_read_b64_tr_b16 v[32:33], v12 offset:32768
  v_accvgpr_read_b32 v18, a250
  v_mfma_f32_16x16x32_bf16 v[128:131], v[72:75], v[240:243], v[128:131]
  s_add_u32 m0, s24, 32768
  ds_read_b64_tr_b16 v[34:35], v12 offset:33792
  v_accvgpr_read_b32 v19, a251
  v_mfma_f32_16x16x32_bf16 v[144:147], v[76:79], v[240:243], v[144:147]
  buffer_load_dwordx4 v3, s[32:35], s26 offen offset:0 sc1 lds
  v_accvgpr_read_b32 v20, a252
  v_mfma_f32_16x16x32_bf16 v[160:163], v[80:83], v[240:243], v[160:163]
  ds_read_b64_tr_b16 v[36:37], v13 offset:32768
  v_accvgpr_read_b32 v21, a253
  v_mfma_f32_16x16x32_bf16 v[176:179], v[84:87], v[240:243], v[176:179]
  ds_read_b64_tr_b16 v[38:39], v13 offset:33792
  v_accvgpr_read_b32 v22, a254
  v_mfma_f32_16x16x32_bf16 v[192:195], v[88:91], v[240:243], v[192:195]
  ds_read_b64_tr_b16 v[40:41], v12 offset:33024
  v_accvgpr_read_b32 v23, a255
  v_mfma_f32_16x16x32_bf16 v[208:211], v[92:95], v[240:243], v[208:211]
  ds_read_b64_tr_b16 v[42:43], v12 offset:34048
  v_mul_f32 v16, s76, v16
  v_mfma_f32_16x16x32_bf16 v[100:103], v[64:67], v[244:247], v[100:103]
  buffer_load_dwordx4 v4, s[32:35], s26 offen offset:1024 sc1 lds
  v_mul_f32 v17, s76, v17
  v_mfma_f32_16x16x32_bf16 v[116:119], v[68:71], v[244:247], v[116:119]
  ds_read_b64_tr_b16 v[44:45], v13 offset:33024
  v_mul_f32 v18, s76, v18
  v_mfma_f32_16x16x32_bf16 v[132:135], v[72:75], v[244:247], v[132:135]
  ds_read_b64_tr_b16 v[46:47], v13 offset:34048
  v_mul_f32 v19, s76, v19
  v_mfma_f32_16x16x32_bf16 v[148:151], v[76:79], v[244:247], v[148:151]
  ds_read_b128 v[224:227], v14 offset:0
  v_mul_f32 v20, s76, v20
  v_mfma_f32_16x16x32_bf16 v[164:167], v[80:83], v[244:247], v[164:167]
  ds_read_b128 v[228:231], v14 offset:1024
  v_mul_f32 v21, s76, v21
  v_mfma_f32_16x16x32_bf16 v[180:183], v[84:87], v[244:247], v[180:183]
  buffer_load_dwordx4 v5, s[32:35], s26 offen offset:2048 sc1 lds
  v_mul_f32 v22, s76, v22
  v_mfma_f32_16x16x32_bf16 v[196:199], v[88:91], v[244:247], v[196:199]
  ds_read_b64_tr_b16 v[48:49], v12 offset:33280
  v_mul_f32 v23, s76, v23
  v_mfma_f32_16x16x32_bf16 v[212:215], v[92:95], v[244:247], v[212:215]
  ds_read_b64_tr_b16 v[50:51], v12 offset:34304
  v_cvt_pk_bf16_f32 v28, v16, v17
  v_mfma_f32_16x16x32_bf16 v[104:107], v[64:67], v[248:251], v[104:107]
  ds_read_b64_tr_b16 v[52:53], v13 offset:33280
  v_cvt_pk_bf16_f32 v29, v18, v19
  v_mfma_f32_16x16x32_bf16 v[120:123], v[68:71], v[248:251], v[120:123]
  ds_read_b64_tr_b16 v[54:55], v13 offset:34304
  v_cvt_pk_bf16_f32 v30, v20, v21
  v_mfma_f32_16x16x32_bf16 v[136:139], v[72:75], v[248:251], v[136:139]
  buffer_load_dwordx4 v6, s[32:35], s26 offen offset:3072 sc1 lds
  v_cvt_pk_bf16_f32 v31, v22, v23
  v_mfma_f32_16x16x32_bf16 v[152:155], v[76:79], v[248:251], v[152:155]
  s_add_u32 s26, s26, 1024
  ds_read_b64_tr_b16 v[56:57], v12 offset:33536
  buffer_store_dwordx4 v[28:31], v2, s[40:43], s64 offen offset:3072 sc1
  v_mfma_f32_16x16x32_bf16 v[168:171], v[80:83], v[248:251], v[168:171]
  ds_read_b64_tr_b16 v[58:59], v12 offset:34560
  v_mfma_f32_16x16x32_bf16 v[184:187], v[84:87], v[248:251], v[184:187]
  ds_read_b64_tr_b16 v[60:61], v13 offset:33536
  v_mfma_f32_16x16x32_bf16 v[200:203], v[88:91], v[248:251], v[200:203]
  s_add_u32 m0, s24, 81920
  ds_read_b64_tr_b16 v[62:63], v13 offset:34560
  v_mfma_f32_16x16x32_bf16 v[216:219], v[92:95], v[248:251], v[216:219]
  buffer_load_dwordx4 v8, s[36:39], s27 offen offset:0 lds
  v_mfma_f32_16x16x32_bf16 v[108:111], v[64:67], v[252:255], v[108:111]
  ds_read_b128 v[232:235], v14 offset:2048
  v_mfma_f32_16x16x32_bf16 v[124:127], v[68:71], v[252:255], v[124:127]
  ds_read_b128 v[236:239], v14 offset:3072
  v_mfma_f32_16x16x32_bf16 v[140:143], v[72:75], v[252:255], v[140:143]
  v_mfma_f32_16x16x32_bf16 v[156:159], v[76:79], v[252:255], v[156:159]
  v_mfma_f32_16x16x32_bf16 v[172:175], v[80:83], v[252:255], v[172:175]
  buffer_load_dwordx4 v9, s[36:39], s27 offen offset:1024 lds
  v_mfma_f32_16x16x32_bf16 v[188:191], v[84:87], v[252:255], v[188:191]
  v_mfma_f32_16x16x32_bf16 v[204:207], v[88:91], v[252:255], v[204:207]
  v_mfma_f32_16x16x32_bf16 v[220:223], v[92:95], v[252:255], v[220:223]
  s_waitcnt vmcnt(17) lgkmcnt(0)
  v_mfma_f32_16x16x32_bf16 v[96:99], v[32:35], v[224:227], v[96:99]
  s_add_u32 s64, s64, 126976
  v_accvgpr_read_b32 v16, a0
  v_accvgpr_read_b32 v17, a1
  v_mfma_f32_16x16x32_bf16 v[112:115], v[36:39], v[224:227], v[112:115]
  ds_read_b64_tr_b16 v[64:65], v12 offset:40960
  v_accvgpr_read_b32 v18, a2
  v_mfma_f32_16x16x32_bf16 v[128:131], v[40:43], v[224:227], v[128:131]
  s_add_u32 m0, s24, 65536
  ds_read_b64_tr_b16 v[66:67], v12 offset:41984
  v_accvgpr_read_b32 v19, a3
  v_mfma_f32_16x16x32_bf16 v[144:147], v[44:47], v[224:227], v[144:147]
  buffer_load_dwordx4 v3, s[32:35], s26 offen offset:0 sc1 lds
  v_accvgpr_read_b32 v20, a4
  v_mfma_f32_16x16x32_bf16 v[160:163], v[48:51], v[224:227], v[160:163]
  ds_read_b64_tr_b16 v[68:69], v13 offset:40960
  v_accvgpr_read_b32 v21, a5
  v_mfma_f32_16x16x32_bf16 v[176:179], v[52:55], v[224:227], v[176:179]
  ds_read_b64_tr_b16 v[70:71], v13 offset:41984
  v_accvgpr_read_b32 v22, a6
  v_mfma_f32_16x16x32_bf16 v[192:195], v[56:59], v[224:227], v[192:195]
  ds_read_b64_tr_b16 v[72:73], v12 offset:41216
  v_accvgpr_read_b32 v23, a7
  v_mfma_f32_16x16x32_bf16 v[208:211], v[60:63], v[224:227], v[208:211]
  ds_read_b64_tr_b16 v[74:75], v12 offset:42240
  v_mul_f32 v16, s76, v16
  v_mfma_f32_16x16x32_bf16 v[100:103], v[32:35], v[228:231], v[100:103]
  buffer_load_dwordx4 v4, s[32:35], s26 offen offset:1024 sc1 lds
  v_mul_f32 v17, s76, v17
  v_mfma_f32_16x16x32_bf16 v[116:119], v[36:39], v[228:231], v[116:119]
  ds_read_b64_tr_b16 v[76:77], v13 offset:41216
  v_mul_f32 v18, s76, v18
  v_mfma_f32_16x16x32_bf16 v[132:135], v[40:43], v[228:231], v[132:135]
  ds_read_b64_tr_b16 v[78:79], v13 offset:42240
  v_mul_f32 v19, s76, v19
  v_mfma_f32_16x16x32_bf16 v[148:151], v[44:47], v[228:231], v[148:151]
  ds_read_b128 v[240:243], v14 offset:32768
  v_mul_f32 v20, s76, v20
  v_mfma_f32_16x16x32_bf16 v[164:167], v[48:51], v[228:231], v[164:167]
  ds_read_b128 v[244:247], v14 offset:33792
  v_mul_f32 v21, s76, v21
  v_mfma_f32_16x16x32_bf16 v[180:183], v[52:55], v[228:231], v[180:183]
  buffer_load_dwordx4 v5, s[32:35], s26 offen offset:2048 sc1 lds
  v_mul_f32 v22, s76, v22
  v_mfma_f32_16x16x32_bf16 v[196:199], v[56:59], v[228:231], v[196:199]
  ds_read_b64_tr_b16 v[80:81], v12 offset:41472
  v_mul_f32 v23, s76, v23
  v_mfma_f32_16x16x32_bf16 v[212:215], v[60:63], v[228:231], v[212:215]
  ds_read_b64_tr_b16 v[82:83], v12 offset:42496
  v_cvt_pk_bf16_f32 v24, v16, v17
  v_mfma_f32_16x16x32_bf16 v[104:107], v[32:35], v[232:235], v[104:107]
  ds_read_b64_tr_b16 v[84:85], v13 offset:41472
  v_cvt_pk_bf16_f32 v25, v18, v19
  v_mfma_f32_16x16x32_bf16 v[120:123], v[36:39], v[232:235], v[120:123]
  ds_read_b64_tr_b16 v[86:87], v13 offset:42496
  v_cvt_pk_bf16_f32 v26, v20, v21
  v_mfma_f32_16x16x32_bf16 v[136:139], v[40:43], v[232:235], v[136:139]
  buffer_load_dwordx4 v6, s[32:35], s26 offen offset:3072 sc1 lds
  v_cvt_pk_bf16_f32 v27, v22, v23
  v_mfma_f32_16x16x32_bf16 v[152:155], v[44:47], v[232:235], v[152:155]
  s_add_u32 s26, s26, 1024
  ds_read_b64_tr_b16 v[88:89], v12 offset:41728
  buffer_store_dwordx4 v[24:27], v2, s[40:43], s64 offen offset:0 sc1
  v_mfma_f32_16x16x32_bf16 v[168:171], v[48:51], v[232:235], v[168:171]
  ds_read_b64_tr_b16 v[90:91], v12 offset:42752
  v_mfma_f32_16x16x32_bf16 v[184:187], v[52:55], v[232:235], v[184:187]
  ds_read_b64_tr_b16 v[92:93], v13 offset:41728
  v_mfma_f32_16x16x32_bf16 v[200:203], v[56:59], v[232:235], v[200:203]
  s_add_u32 m0, s24, 81920
  ds_read_b64_tr_b16 v[94:95], v13 offset:42752
  v_mfma_f32_16x16x32_bf16 v[216:219], v[60:63], v[232:235], v[216:219]
  buffer_load_dwordx4 v10, s[36:39], s27 offen offset:2048 lds
  v_mfma_f32_16x16x32_bf16 v[108:111], v[32:35], v[236:239], v[108:111]
  ds_read_b128 v[248:251], v14 offset:34816
  v_mfma_f32_16x16x32_bf16 v[124:127], v[36:39], v[236:239], v[124:127]
  ds_read_b128 v[252:255], v14 offset:35840
  v_mfma_f32_16x16x32_bf16 v[140:143], v[40:43], v[236:239], v[140:143]
  v_mfma_f32_16x16x32_bf16 v[156:159], v[44:47], v[236:239], v[156:159]
  v_xor_b32 v14, 0x10000, v14
  v_mfma_f32_16x16x32_bf16 v[172:175], v[48:51], v[236:239], v[172:175]
  buffer_load_dwordx4 v11, s[36:39], s27 offen offset:3072 lds
  v_mfma_f32_16x16x32_bf16 v[188:191], v[52:55], v[236:239], v[188:191]
  s_add_u32 s27, s27, 524288
  v_xor_b32 v12, 0x10000, v12
  v_mfma_f32_16x16x32_bf16 v[204:207], v[56:59], v[236:239], v[204:207]
  v_xor_b32 v13, 0x10000, v13
  v_mfma_f32_16x16x32_bf16 v[220:223], v[60:63], v[236:239], v[220:223]
  s_waitcnt vmcnt(9) lgkmcnt(0)
  v_mfma_f32_16x16x32_bf16 v[96:99], v[64:67], v[240:243], v[96:99]
  s_barrier
  buffer_store_dword v12, off, s[40:43], s65 sc1
  v_accvgpr_read_b32 v16, a8
  v_mfma_f32_16x16x32_bf16 v[112:115], v[68:71], v[240:243], v[112:115]
  ds_read_b64_tr_b16 v[32:33], v12 offset:0
  v_accvgpr_read_b32 v17, a9
  v_mfma_f32_16x16x32_bf16 v[128:131], v[72:75], v[240:243], v[128:131]
  s_add_u32 m0, s24, 98304
  ds_read_b64_tr_b16 v[34:35], v12 offset:1024
  v_accvgpr_read_b32 v18, a10
  v_mfma_f32_16x16x32_bf16 v[144:147], v[76:79], v[240:243], v[144:147]
  buffer_load_dwordx4 v3, s[32:35], s26 offen offset:0 sc1 lds
  v_accvgpr_read_b32 v19, a11
  v_mfma_f32_16x16x32_bf16 v[160:163], v[80:83], v[240:243], v[160:163]
  ds_read_b64_tr_b16 v[36:37], v13 offset:0
  v_accvgpr_read_b32 v20, a12
  v_mfma_f32_16x16x32_bf16 v[176:179], v[84:87], v[240:243], v[176:179]
  ds_read_b64_tr_b16 v[38:39], v13 offset:1024
  v_accvgpr_read_b32 v21, a13
  v_mfma_f32_16x16x32_bf16 v[192:195], v[88:91], v[240:243], v[192:195]
  ds_read_b64_tr_b16 v[40:41], v12 offset:256
  v_accvgpr_read_b32 v22, a14
  v_mfma_f32_16x16x32_bf16 v[208:211], v[92:95], v[240:243], v[208:211]
  ds_read_b64_tr_b16 v[42:43], v12 offset:1280
  v_accvgpr_read_b32 v23, a15
  v_mfma_f32_16x16x32_bf16 v[100:103], v[64:67], v[244:247], v[100:103]
  buffer_load_dwordx4 v4, s[32:35], s26 offen offset:1024 sc1 lds
  v_mul_f32 v16, s76, v16
  v_mfma_f32_16x16x32_bf16 v[116:119], v[68:71], v[244:247], v[116:119]
  ds_read_b64_tr_b16 v[44:45], v13 offset:256
  v_mul_f32 v17, s76, v17
  v_mfma_f32_16x16x32_bf16 v[132:135], v[72:75], v[244:247], v[132:135]
  ds_read_b64_tr_b16 v[46:47], v13 offset:1280
  v_mul_f32 v18, s76, v18
  v_mfma_f32_16x16x32_bf16 v[148:151], v[76:79], v[244:247], v[148:151]
  ds_read_b128 v[224:227], v14 offset:0
  v_mul_f32 v19, s76, v19
  v_mfma_f32_16x16x32_bf16 v[164:167], v[80:83], v[244:247], v[164:167]
  ds_read_b128 v[228:231], v14 offset:1024
  v_mul_f32 v20, s76, v20
  v_mfma_f32_16x16x32_bf16 v[180:183], v[84:87], v[244:247], v[180:183]
  buffer_load_dwordx4 v5, s[32:35], s26 offen offset:2048 sc1 lds
  v_mul_f32 v21, s76, v21
  v_mfma_f32_16x16x32_bf16 v[196:199], v[88:91], v[244:247], v[196:199]
  ds_read_b64_tr_b16 v[48:49], v12 offset:512
  v_mul_f32 v22, s76, v22
  v_mfma_f32_16x16x32_bf16 v[212:215], v[92:95], v[244:247], v[212:215]
  ds_read_b64_tr_b16 v[50:51], v12 offset:1536
  v_mul_f32 v23, s76, v23
  v_mfma_f32_16x16x32_bf16 v[104:107], v[64:67], v[248:251], v[104:107]
  ds_read_b64_tr_b16 v[52:53], v13 offset:512
  v_cvt_pk_bf16_f32 v28, v16, v17
  v_mfma_f32_16x16x32_bf16 v[120:123], v[68:71], v[248:251], v[120:123]
  ds_read_b64_tr_b16 v[54:55], v13 offset:1536
  v_cvt_pk_bf16_f32 v29, v18, v19
  v_mfma_f32_16x16x32_bf16 v[136:139], v[72:75], v[248:251], v[136:139]
  buffer_load_dwordx4 v6, s[32:35], s26 offen offset:3072 sc1 lds
  v_cvt_pk_bf16_f32 v30, v20, v21
  v_mfma_f32_16x16x32_bf16 v[152:155], v[76:79], v[248:251], v[152:155]
  s_add_u32 s26, s26, 1024
  ds_read_b64_tr_b16 v[56:57], v12 offset:768
  v_cvt_pk_bf16_f32 v31, v22, v23
  v_mfma_f32_16x16x32_bf16 v[168:171], v[80:83], v[248:251], v[168:171]
  ds_read_b64_tr_b16 v[58:59], v12 offset:1792
  buffer_store_dwordx4 v[28:31], v2, s[40:43], s64 offen offset:1024 sc1
  v_mfma_f32_16x16x32_bf16 v[184:187], v[84:87], v[248:251], v[184:187]
  ds_read_b64_tr_b16 v[60:61], v13 offset:768
  v_mfma_f32_16x16x32_bf16 v[200:203], v[88:91], v[248:251], v[200:203]
  s_add_u32 m0, s24, 114688
  ds_read_b64_tr_b16 v[62:63], v13 offset:1792
  v_mfma_f32_16x16x32_bf16 v[216:219], v[92:95], v[248:251], v[216:219]
  buffer_load_dwordx4 v8, s[36:39], s27 offen offset:0 lds
  v_mfma_f32_16x16x32_bf16 v[108:111], v[64:67], v[252:255], v[108:111]
  ds_read_b128 v[232:235], v14 offset:2048
  v_mfma_f32_16x16x32_bf16 v[124:127], v[68:71], v[252:255], v[124:127]
  ds_read_b128 v[236:239], v14 offset:3072
  v_mfma_f32_16x16x32_bf16 v[140:143], v[72:75], v[252:255], v[140:143]
  v_mfma_f32_16x16x32_bf16 v[156:159], v[76:79], v[252:255], v[156:159]
  v_mfma_f32_16x16x32_bf16 v[172:175], v[80:83], v[252:255], v[172:175]
  buffer_load_dwordx4 v9, s[36:39], s27 offen offset:1024 lds
  v_mfma_f32_16x16x32_bf16 v[188:191], v[84:87], v[252:255], v[188:191]
  v_mfma_f32_16x16x32_bf16 v[204:207], v[88:91], v[252:255], v[204:207]
  v_mfma_f32_16x16x32_bf16 v[220:223], v[92:95], v[252:255], v[220:223]
  s_waitcnt vmcnt(18) lgkmcnt(0)
  v_mfma_f32_16x16x32_bf16 v[96:99], v[32:35], v[224:227], v[96:99]
  v_accvgpr_read_b32 v16, a16
  v_accvgpr_read_b32 v17, a17
  v_mfma_f32_16x16x32_bf16 v[112:115], v[36:39], v[224:227], v[112:115]
  ds_read_b64_tr_b16 v[64:65], v12 offset:8192
  v_accvgpr_read_b32 v18, a18
  v_mfma_f32_16x16x32_bf16 v[128:131], v[40:43], v[224:227], v[128:131]
  s_add_u32 m0, s24, 0
  ds_read_b64_tr_b16 v[66:67], v12 offset:9216
  v_accvgpr_read_b32 v19, a19
  v_mfma_f32_16x16x32_bf16 v[144:147], v[44:47], v[224:227], v[144:147]
  buffer_load_dwordx4 v3, s[32:35], s26 offen offset:0 sc1 lds
  v_accvgpr_read_b32 v20, a20
  v_mfma_f32_16x16x32_bf16 v[160:163], v[48:51], v[224:227], v[160:163]
  ds_read_b64_tr_b16 v[68:69], v13 offset:8192
  v_accvgpr_read_b32 v21, a21
  v_mfma_f32_16x16x32_bf16 v[176:179], v[52:55], v[224:227], v[176:179]
  ds_read_b64_tr_b16 v[70:71], v13 offset:9216
  v_accvgpr_read_b32 v22, a22
  v_mfma_f32_16x16x32_bf16 v[192:195], v[56:59], v[224:227], v[192:195]
  ds_read_b64_tr_b16 v[72:73], v12 offset:8448
  v_accvgpr_read_b32 v23, a23
  v_mfma_f32_16x16x32_bf16 v[208:211], v[60:63], v[224:227], v[208:211]
  ds_read_b64_tr_b16 v[74:75], v12 offset:9472
  v_mul_f32 v16, s76, v16
  v_mfma_f32_16x16x32_bf16 v[100:103], v[32:35], v[228:231], v[100:103]
  buffer_load_dwordx4 v4, s[32:35], s26 offen offset:1024 sc1 lds
  v_mul_f32 v17, s76, v17
  v_mfma_f32_16x16x32_bf16 v[116:119], v[36:39], v[228:231], v[116:119]
  ds_read_b64_tr_b16 v[76:77], v13 offset:8448
  v_mul_f32 v18, s76, v18
  v_mfma_f32_16x16x32_bf16 v[132:135], v[40:43], v[228:231], v[132:135]
  ds_read_b64_tr_b16 v[78:79], v13 offset:9472
  v_mul_f32 v19, s76, v19
  v_mfma_f32_16x16x32_bf16 v[148:151], v[44:47], v[228:231], v[148:151]
  ds_read_b128 v[240:243], v14 offset:32768
  v_mul_f32 v20, s76, v20
  v_mfma_f32_16x16x32_bf16 v[164:167], v[48:51], v[228:231], v[164:167]
  ds_read_b128 v[244:247], v14 offset:33792
  v_mul_f32 v21, s76, v21
  v_mfma_f32_16x16x32_bf16 v[180:183], v[52:55], v[228:231], v[180:183]
  buffer_load_dwordx4 v5, s[32:35], s26 offen offset:2048 sc1 lds
  v_mul_f32 v22, s76, v22
  v_mfma_f32_16x16x32_bf16 v[196:199], v[56:59], v[228:231], v[196:199]
  ds_read_b64_tr_b16 v[80:81], v12 offset:8704
  v_mul_f32 v23, s76, v23
  v_mfma_f32_16x16x32_bf16 v[212:215], v[60:63], v[228:231], v[212:215]
  ds_read_b64_tr_b16 v[82:83], v12 offset:9728
  v_cvt_pk_bf16_f32 v24, v16, v17
  v_mfma_f32_16x16x32_bf16 v[104:107], v[32:35], v[232:235], v[104:107]
  ds_read_b64_tr_b16 v[84:85], v13 offset:8704
  v_cvt_pk_bf16_f32 v25, v18, v19
  v_mfma_f32_16x16x32_bf16 v[120:123], v[36:39], v[232:235], v[120:123]
  ds_read_b64_tr_b16 v[86:87], v13 offset:9728
  v_cvt_pk_bf16_f32 v26, v20, v21
  v_mfma_f32_16x16x32_bf16 v[136:139], v[40:43], v[232:235], v[136:139]
  buffer_load_dwordx4 v6, s[32:35], s26 offen offset:3072 sc1 lds
  v_cvt_pk_bf16_f32 v27, v22, v23
  v_mfma_f32_16x16x32_bf16 v[152:155], v[44:47], v[232:235], v[152:155]
  s_add_u32 s26, s26, 1024
  ds_read_b64_tr_b16 v[88:89], v12 offset:8960
  buffer_store_dwordx4 v[24:27], v2, s[40:43], s64 offen offset:2048 sc1
  v_mfma_f32_16x16x32_bf16 v[168:171], v[48:51], v[232:235], v[168:171]
  ds_read_b64_tr_b16 v[90:91], v12 offset:9984
  v_mfma_f32_16x16x32_bf16 v[184:187], v[52:55], v[232:235], v[184:187]
  ds_read_b64_tr_b16 v[92:93], v13 offset:8960
  v_mfma_f32_16x16x32_bf16 v[200:203], v[56:59], v[232:235], v[200:203]
  s_add_u32 m0, s24, 114688
  ds_read_b64_tr_b16 v[94:95], v13 offset:9984
  v_mfma_f32_16x16x32_bf16 v[216:219], v[60:63], v[232:235], v[216:219]
  buffer_load_dwordx4 v10, s[36:39], s27 offen offset:2048 lds
  v_mfma_f32_16x16x32_bf16 v[108:111], v[32:35], v[236:239], v[108:111]
  ds_read_b128 v[248:251], v14 offset:34816
  v_mfma_f32_16x16x32_bf16 v[124:127], v[36:39], v[236:239], v[124:127]
  ds_read_b128 v[252:255], v14 offset:35840
  v_mfma_f32_16x16x32_bf16 v[140:143], v[40:43], v[236:239], v[140:143]
  v_mfma_f32_16x16x32_bf16 v[156:159], v[44:47], v[236:239], v[156:159]
  v_xor_b32 v14, 0x10000, v14
  v_mfma_f32_16x16x32_bf16 v[172:175], v[48:51], v[236:239], v[172:175]
  buffer_load_dwordx4 v11, s[36:39], s27 offen offset:3072 lds
  v_mfma_f32_16x16x32_bf16 v[188:191], v[52:55], v[236:239], v[188:191]
  s_add_u32 s27, s27, 524288
  v_mfma_f32_16x16x32_bf16 v[204:207], v[56:59], v[236:239], v[204:207]
  v_mfma_f32_16x16x32_bf16 v[220:223], v[60:63], v[236:239], v[220:223]
  s_waitcnt vmcnt(18) lgkmcnt(0)
  v_mfma_f32_16x16x32_bf16 v[96:99], v[64:67], v[240:243], v[96:99]
  s_barrier
  v_accvgpr_read_b32 v16, a24
  v_accvgpr_read_b32 v17, a25
  v_mfma_f32_16x16x32_bf16 v[112:115], v[68:71], v[240:243], v[112:115]
  ds_read_b64_tr_b16 v[32:33], v12 offset:32768
  v_accvgpr_read_b32 v18, a26
  v_mfma_f32_16x16x32_bf16 v[128:131], v[72:75], v[240:243], v[128:131]
  s_add_u32 m0, s24, 32768
  ds_read_b64_tr_b16 v[34:35], v12 offset:33792
  v_accvgpr_read_b32 v19, a27
  v_mfma_f32_16x16x32_bf16 v[144:147], v[76:79], v[240:243], v[144:147]
  buffer_load_dwordx4 v3, s[32:35], s26 offen offset:0 sc1 lds
  v_accvgpr_read_b32 v20, a28
  v_mfma_f32_16x16x32_bf16 v[160:163], v[80:83], v[240:243], v[160:163]
  ds_read_b64_tr_b16 v[36:37], v13 offset:32768
  v_accvgpr_read_b32 v21, a29
  v_mfma_f32_16x16x32_bf16 v[176:179], v[84:87], v[240:243], v[176:179]
  ds_read_b64_tr_b16 v[38:39], v13 offset:33792
  v_accvgpr_read_b32 v22, a30
  v_mfma_f32_16x16x32_bf16 v[192:195], v[88:91], v[240:243], v[192:195]
  ds_read_b64_tr_b16 v[40:41], v12 offset:33024
  v_accvgpr_read_b32 v23, a31
  v_mfma_f32_16x16x32_bf16 v[208:211], v[92:95], v[240:243], v[208:211]
  ds_read_b64_tr_b16 v[42:43], v12 offset:34048
  v_mul_f32 v16, s76, v16
  v_mfma_f32_16x16x32_bf16 v[100:103], v[64:67], v[244:247], v[100:103]
  buffer_load_dwordx4 v4, s[32:35], s26 offen offset:1024 sc1 lds
  v_mul_f32 v17, s76, v17
  v_mfma_f32_16x16x32_bf16 v[116:119], v[68:71], v[244:247], v[116:119]
  ds_read_b64_tr_b16 v[44:45], v13 offset:33024
  v_mul_f32 v18, s76, v18
  v_mfma_f32_16x16x32_bf16 v[132:135], v[72:75], v[244:247], v[132:135]
  ds_read_b64_tr_b16 v[46:47], v13 offset:34048
  v_mul_f32 v19, s76, v19
  v_mfma_f32_16x16x32_bf16 v[148:151], v[76:79], v[244:247], v[148:151]
  ds_read_b128 v[224:227], v14 offset:0
  v_mul_f32 v20, s76, v20
  v_mfma_f32_16x16x32_bf16 v[164:167], v[80:83], v[244:247], v[164:167]
  ds_read_b128 v[228:231], v14 offset:1024
  v_mul_f32 v21, s76, v21
  v_mfma_f32_16x16x32_bf16 v[180:183], v[84:87], v[244:247], v[180:183]
  buffer_load_dwordx4 v5, s[32:35], s26 offen offset:2048 sc1 lds
  v_mul_f32 v22, s76, v22
  v_mfma_f32_16x16x32_bf16 v[196:199], v[88:91], v[244:247], v[196:199]
  ds_read_b64_tr_b16 v[48:49], v12 offset:33280
  v_mul_f32 v23, s76, v23
  v_mfma_f32_16x16x32_bf16 v[212:215], v[92:95], v[244:247], v[212:215]
  ds_read_b64_tr_b16 v[50:51], v12 offset:34304
  v_cvt_pk_bf16_f32 v28, v16, v17
  v_mfma_f32_16x16x32_bf16 v[104:107], v[64:67], v[248:251], v[104:107]
  ds_read_b64_tr_b16 v[52:53], v13 offset:33280
  v_cvt_pk_bf16_f32 v29, v18, v19
  v_mfma_f32_16x16x32_bf16 v[120:123], v[68:71], v[248:251], v[120:123]
  ds_read_b64_tr_b16 v[54:55], v13 offset:34304
  v_cvt_pk_bf16_f32 v30, v20, v21
  v_mfma_f32_16x16x32_bf16 v[136:139], v[72:75], v[248:251], v[136:139]
  buffer_load_dwordx4 v6, s[32:35], s26 offen offset:3072 sc1 lds
  v_cvt_pk_bf16_f32 v31, v22, v23
  v_mfma_f32_16x16x32_bf16 v[152:155], v[76:79], v[248:251], v[152:155]
  s_add_u32 s26, s26, 1024
  ds_read_b64_tr_b16 v[56:57], v12 offset:33536
  buffer_store_dwordx4 v[28:31], v2, s[40:43], s64 offen offset:3072 sc1
  v_mfma_f32_16x16x32_bf16 v[168:171], v[80:83], v[248:251], v[168:171]
  ds_read_b64_tr_b16 v[58:59], v12 offset:34560
  v_mfma_f32_16x16x32_bf16 v[184:187], v[84:87], v[248:251], v[184:187]
  ds_read_b64_tr_b16 v[60:61], v13 offset:33536
  v_mfma_f32_16x16x32_bf16 v[200:203], v[88:91], v[248:251], v[200:203]
  s_add_u32 m0, s24, 16384
  ds_read_b64_tr_b16 v[62:63], v13 offset:34560
  v_mfma_f32_16x16x32_bf16 v[216:219], v[92:95], v[248:251], v[216:219]
  buffer_load_dwordx4 v8, s[36:39], s27 offen offset:0 lds
  v_mfma_f32_16x16x32_bf16 v[108:111], v[64:67], v[252:255], v[108:111]
  ds_read_b128 v[232:235], v14 offset:2048
  v_mfma_f32_16x16x32_bf16 v[124:127], v[68:71], v[252:255], v[124:127]
  ds_read_b128 v[236:239], v14 offset:3072
  v_mfma_f32_16x16x32_bf16 v[140:143], v[72:75], v[252:255], v[140:143]
  v_mfma_f32_16x16x32_bf16 v[156:159], v[76:79], v[252:255], v[156:159]
  v_mfma_f32_16x16x32_bf16 v[172:175], v[80:83], v[252:255], v[172:175]
  buffer_load_dwordx4 v9, s[36:39], s27 offen offset:1024 lds
  v_mfma_f32_16x16x32_bf16 v[188:191], v[84:87], v[252:255], v[188:191]
  v_mfma_f32_16x16x32_bf16 v[204:207], v[88:91], v[252:255], v[204:207]
  v_mfma_f32_16x16x32_bf16 v[220:223], v[92:95], v[252:255], v[220:223]
  s_waitcnt vmcnt(17) lgkmcnt(0)
  v_mfma_f32_16x16x32_bf16 v[96:99], v[32:35], v[224:227], v[96:99]
  s_add_u32 s64, s64, 4096
  v_accvgpr_read_b32 v16, a32
  v_accvgpr_read_b32 v17, a33
  v_mfma_f32_16x16x32_bf16 v[112:115], v[36:39], v[224:227], v[112:115]
  ds_read_b64_tr_b16 v[64:65], v12 offset:40960
  v_accvgpr_read_b32 v18, a34
  v_mfma_f32_16x16x32_bf16 v[128:131], v[40:43], v[224:227], v[128:131]
  s_add_u32 m0, s24, 65536
  ds_read_b64_tr_b16 v[66:67], v12 offset:41984
  v_accvgpr_read_b32 v19, a35
  v_mfma_f32_16x16x32_bf16 v[144:147], v[44:47], v[224:227], v[144:147]
  buffer_load_dwordx4 v3, s[32:35], s26 offen offset:0 sc1 lds
  v_accvgpr_read_b32 v20, a36
  v_mfma_f32_16x16x32_bf16 v[160:163], v[48:51], v[224:227], v[160:163]
  ds_read_b64_tr_b16 v[68:69], v13 offset:40960
  v_accvgpr_read_b32 v21, a37
  v_mfma_f32_16x16x32_bf16 v[176:179], v[52:55], v[224:227], v[176:179]
  ds_read_b64_tr_b16 v[70:71], v13 offset:41984
  v_accvgpr_read_b32 v22, a38
  v_mfma_f32_16x16x32_bf16 v[192:195], v[56:59], v[224:227], v[192:195]
  ds_read_b64_tr_b16 v[72:73], v12 offset:41216
  v_accvgpr_read_b32 v23, a39
  v_mfma_f32_16x16x32_bf16 v[208:211], v[60:63], v[224:227], v[208:211]
  ds_read_b64_tr_b16 v[74:75], v12 offset:42240
  v_mul_f32 v16, s76, v16
  v_mfma_f32_16x16x32_bf16 v[100:103], v[32:35], v[228:231], v[100:103]
  buffer_load_dwordx4 v4, s[32:35], s26 offen offset:1024 sc1 lds
  v_mul_f32 v17, s76, v17
  v_mfma_f32_16x16x32_bf16 v[116:119], v[36:39], v[228:231], v[116:119]
  ds_read_b64_tr_b16 v[76:77], v13 offset:41216
  v_mul_f32 v18, s76, v18
  v_mfma_f32_16x16x32_bf16 v[132:135], v[40:43], v[228:231], v[132:135]
  ds_read_b64_tr_b16 v[78:79], v13 offset:42240
  v_mul_f32 v19, s76, v19
  v_mfma_f32_16x16x32_bf16 v[148:151], v[44:47], v[228:231], v[148:151]
  ds_read_b128 v[240:243], v14 offset:32768
  v_mul_f32 v20, s76, v20
  v_mfma_f32_16x16x32_bf16 v[164:167], v[48:51], v[228:231], v[164:167]
  ds_read_b128 v[244:247], v14 offset:33792
  v_mul_f32 v21, s76, v21
  v_mfma_f32_16x16x32_bf16 v[180:183], v[52:55], v[228:231], v[180:183]
  buffer_load_dwordx4 v5, s[32:35], s26 offen offset:2048 sc1 lds
  v_mul_f32 v22, s76, v22
  v_mfma_f32_16x16x32_bf16 v[196:199], v[56:59], v[228:231], v[196:199]
  ds_read_b64_tr_b16 v[80:81], v12 offset:41472
  v_mul_f32 v23, s76, v23
  v_mfma_f32_16x16x32_bf16 v[212:215], v[60:63], v[228:231], v[212:215]
  ds_read_b64_tr_b16 v[82:83], v12 offset:42496
  v_cvt_pk_bf16_f32 v24, v16, v17
  v_mfma_f32_16x16x32_bf16 v[104:107], v[32:35], v[232:235], v[104:107]
  ds_read_b64_tr_b16 v[84:85], v13 offset:41472
  v_cvt_pk_bf16_f32 v25, v18, v19
  v_mfma_f32_16x16x32_bf16 v[120:123], v[36:39], v[232:235], v[120:123]
  ds_read_b64_tr_b16 v[86:87], v13 offset:42496
  v_cvt_pk_bf16_f32 v26, v20, v21
  v_mfma_f32_16x16x32_bf16 v[136:139], v[40:43], v[232:235], v[136:139]
  buffer_load_dwordx4 v6, s[32:35], s26 offen offset:3072 sc1 lds
  v_cvt_pk_bf16_f32 v27, v22, v23
  v_mfma_f32_16x16x32_bf16 v[152:155], v[44:47], v[232:235], v[152:155]
  s_add_u32 s26, s26, 1024
  ds_read_b64_tr_b16 v[88:89], v12 offset:41728
  buffer_store_dwordx4 v[24:27], v2, s[40:43], s64 offen offset:0 sc1
  v_mfma_f32_16x16x32_bf16 v[168:171], v[48:51], v[232:235], v[168:171]
  ds_read_b64_tr_b16 v[90:91], v12 offset:42752
  v_mfma_f32_16x16x32_bf16 v[184:187], v[52:55], v[232:235], v[184:187]
  ds_read_b64_tr_b16 v[92:93], v13 offset:41728
  v_mfma_f32_16x16x32_bf16 v[200:203], v[56:59], v[232:235], v[200:203]
  s_add_u32 m0, s24, 16384
  ds_read_b64_tr_b16 v[94:95], v13 offset:42752
  v_mfma_f32_16x16x32_bf16 v[216:219], v[60:63], v[232:235], v[216:219]
  buffer_load_dwordx4 v10, s[36:39], s27 offen offset:2048 lds
  v_mfma_f32_16x16x32_bf16 v[108:111], v[32:35], v[236:239], v[108:111]
  ds_read_b128 v[248:251], v14 offset:34816
  v_mfma_f32_16x16x32_bf16 v[124:127], v[36:39], v[236:239], v[124:127]
  ds_read_b128 v[252:255], v14 offset:35840
  v_mfma_f32_16x16x32_bf16 v[140:143], v[40:43], v[236:239], v[140:143]
  v_mfma_f32_16x16x32_bf16 v[156:159], v[44:47], v[236:239], v[156:159]
  v_xor_b32 v14, 0x10000, v14
  v_mfma_f32_16x16x32_bf16 v[172:175], v[48:51], v[236:239], v[172:175]
  buffer_load_dwordx4 v11, s[36:39], s27 offen offset:3072 lds
  v_mfma_f32_16x16x32_bf16 v[188:191], v[52:55], v[236:239], v[188:191]
  s_add_u32 s27, s27, 524288
  v_xor_b32 v12, 0x10000, v12
  v_mfma_f32_16x16x32_bf16 v[204:207], v[56:59], v[236:239], v[204:207]
  v_xor_b32 v13, 0x10000, v13
  v_mfma_f32_16x16x32_bf16 v[220:223], v[60:63], v[236:239], v[220:223]
  s_waitcnt vmcnt(17) lgkmcnt(0)
  v_mfma_f32_16x16x32_bf16 v[96:99], v[64:67], v[240:243], v[96:99]
  s_barrier
  v_accvgpr_read_b32 v16, a40
  v_accvgpr_read_b32 v17, a41
  v_mfma_f32_16x16x32_bf16 v[112:115], v[68:71], v[240:243], v[112:115]
  ds_read_b64_tr_b16 v[32:33], v12 offset:0
  v_accvgpr_read_b32 v18, a42
  v_mfma_f32_16x16x32_bf16 v[128:131], v[72:75], v[240:243], v[128:131]
  s_add_u32 m0, s24, 98304
  ds_read_b64_tr_b16 v[34:35], v12 offset:1024
  v_accvgpr_read_b32 v19, a43
  v_mfma_f32_16x16x32_bf16 v[144:147], v[76:79], v[240:243], v[144:147]
  buffer_load_dwordx4 v3, s[32:35], s26 offen offset:0 sc1 lds
  v_accvgpr_read_b32 v20, a44
  v_mfma_f32_16x16x32_bf16 v[160:163], v[80:83], v[240:243], v[160:163]
  ds_read_b64_tr_b16 v[36:37], v13 offset:0
  v_accvgpr_read_b32 v21, a45
  v_mfma_f32_16x16x32_bf16 v[176:179], v[84:87], v[240:243], v[176:179]
  ds_read_b64_tr_b16 v[38:39], v13 offset:1024
  v_accvgpr_read_b32 v22, a46
  v_mfma_f32_16x16x32_bf16 v[192:195], v[88:91], v[240:243], v[192:195]
  ds_read_b64_tr_b16 v[40:41], v12 offset:256
  v_accvgpr_read_b32 v23, a47
  v_mfma_f32_16x16x32_bf16 v[208:211], v[92:95], v[240:243], v[208:211]
  ds_read_b64_tr_b16 v[42:43], v12 offset:1280
  v_mul_f32 v16, s76, v16
  v_mfma_f32_16x16x32_bf16 v[100:103], v[64:67], v[244:247], v[100:103]
  buffer_load_dwordx4 v4, s[32:35], s26 offen offset:1024 sc1 lds
  v_mul_f32 v17, s76, v17
  v_mfma_f32_16x16x32_bf16 v[116:119], v[68:71], v[244:247], v[116:119]
  ds_read_b64_tr_b16 v[44:45], v13 offset:256
  v_mul_f32 v18, s76, v18
  v_mfma_f32_16x16x32_bf16 v[132:135], v[72:75], v[244:247], v[132:135]
  ds_read_b64_tr_b16 v[46:47], v13 offset:1280
  v_mul_f32 v19, s76, v19
  v_mfma_f32_16x16x32_bf16 v[148:151], v[76:79], v[244:247], v[148:151]
  ds_read_b128 v[224:227], v14 offset:0
  v_mul_f32 v20, s76, v20
  v_mfma_f32_16x16x32_bf16 v[164:167], v[80:83], v[244:247], v[164:167]
  ds_read_b128 v[228:231], v14 offset:1024
  v_mul_f32 v21, s76, v21
  v_mfma_f32_16x16x32_bf16 v[180:183], v[84:87], v[244:247], v[180:183]
  buffer_load_dwordx4 v5, s[32:35], s26 offen offset:2048 sc1 lds
  v_mul_f32 v22, s76, v22
  v_mfma_f32_16x16x32_bf16 v[196:199], v[88:91], v[244:247], v[196:199]
  ds_read_b64_tr_b16 v[48:49], v12 offset:512
  v_mul_f32 v23, s76, v23
  v_mfma_f32_16x16x32_bf16 v[212:215], v[92:95], v[244:247], v[212:215]
  ds_read_b64_tr_b16 v[50:51], v12 offset:1536
  v_cvt_pk_bf16_f32 v28, v16, v17
  v_mfma_f32_16x16x32_bf16 v[104:107], v[64:67], v[248:251], v[104:107]
  ds_read_b64_tr_b16 v[52:53], v13 offset:512
  v_cvt_pk_bf16_f32 v29, v18, v19
  v_mfma_f32_16x16x32_bf16 v[120:123], v[68:71], v[248:251], v[120:123]
  ds_read_b64_tr_b16 v[54:55], v13 offset:1536
  v_cvt_pk_bf16_f32 v30, v20, v21
  v_mfma_f32_16x16x32_bf16 v[136:139], v[72:75], v[248:251], v[136:139]
  buffer_load_dwordx4 v6, s[32:35], s26 offen offset:3072 sc1 lds
  v_cvt_pk_bf16_f32 v31, v22, v23
  v_mfma_f32_16x16x32_bf16 v[152:155], v[76:79], v[248:251], v[152:155]
  s_add_u32 s26, s26, 1024
  ds_read_b64_tr_b16 v[56:57], v12 offset:768
  buffer_store_dwordx4 v[28:31], v2, s[40:43], s64 offen offset:1024 sc1
  v_mfma_f32_16x16x32_bf16 v[168:171], v[80:83], v[248:251], v[168:171]
  ds_read_b64_tr_b16 v[58:59], v12 offset:1792
  v_mfma_f32_16x16x32_bf16 v[184:187], v[84:87], v[248:251], v[184:187]
  ds_read_b64_tr_b16 v[60:61], v13 offset:768
  v_mfma_f32_16x16x32_bf16 v[200:203], v[88:91], v[248:251], v[200:203]
  s_add_u32 m0, s24, 49152
  ds_read_b64_tr_b16 v[62:63], v13 offset:1792
  v_mfma_f32_16x16x32_bf16 v[216:219], v[92:95], v[248:251], v[216:219]
  buffer_load_dwordx4 v8, s[36:39], s27 offen offset:0 lds
  v_mfma_f32_16x16x32_bf16 v[108:111], v[64:67], v[252:255], v[108:111]
  ds_read_b128 v[232:235], v14 offset:2048
  v_mfma_f32_16x16x32_bf16 v[124:127], v[68:71], v[252:255], v[124:127]
  ds_read_b128 v[236:239], v14 offset:3072
  v_mfma_f32_16x16x32_bf16 v[140:143], v[72:75], v[252:255], v[140:143]
  v_mfma_f32_16x16x32_bf16 v[156:159], v[76:79], v[252:255], v[156:159]
  v_mfma_f32_16x16x32_bf16 v[172:175], v[80:83], v[252:255], v[172:175]
  buffer_load_dwordx4 v9, s[36:39], s27 offen offset:1024 lds
  v_mfma_f32_16x16x32_bf16 v[188:191], v[84:87], v[252:255], v[188:191]
  v_mfma_f32_16x16x32_bf16 v[204:207], v[88:91], v[252:255], v[204:207]
  v_mfma_f32_16x16x32_bf16 v[220:223], v[92:95], v[252:255], v[220:223]
  s_waitcnt vmcnt(17) lgkmcnt(0)
  v_mfma_f32_16x16x32_bf16 v[96:99], v[32:35], v[224:227], v[96:99]
  v_accvgpr_read_b32 v16, a48
  v_accvgpr_read_b32 v17, a49
  v_accvgpr_read_b32 v18, a50
  v_mfma_f32_16x16x32_bf16 v[112:115], v[36:39], v[224:227], v[112:115]
  ds_read_b64_tr_b16 v[64:65], v12 offset:8192
  v_accvgpr_read_b32 v19, a51
  v_mfma_f32_16x16x32_bf16 v[128:131], v[40:43], v[224:227], v[128:131]
  s_add_u32 m0, s24, 0
  ds_read_b64_tr_b16 v[66:67], v12 offset:9216
  v_accvgpr_read_b32 v20, a52
  v_mfma_f32_16x16x32_bf16 v[144:147], v[44:47], v[224:227], v[144:147]
  buffer_load_dwordx4 v3, s[32:35], s26 offen offset:0 sc1 lds
  v_accvgpr_read_b32 v21, a53
  v_accvgpr_read_b32 v22, a54
  v_mfma_f32_16x16x32_bf16 v[160:163], v[48:51], v[224:227], v[160:163]
  ds_read_b64_tr_b16 v[68:69], v13 offset:8192
  v_accvgpr_read_b32 v23, a55
  v_mfma_f32_16x16x32_bf16 v[176:179], v[52:55], v[224:227], v[176:179]
  ds_read_b64_tr_b16 v[70:71], v13 offset:9216
  v_mul_f32 v16, s76, v16
  v_mfma_f32_16x16x32_bf16 v[192:195], v[56:59], v[224:227], v[192:195]
  ds_read_b64_tr_b16 v[72:73], v12 offset:8448
  v_mul_f32 v17, s76, v17
  v_mfma_f32_16x16x32_bf16 v[208:211], v[60:63], v[224:227], v[208:211]
  ds_read_b64_tr_b16 v[74:75], v12 offset:9472
  v_mul_f32 v18, s76, v18
  v_mul_f32 v19, s76, v19
  v_mfma_f32_16x16x32_bf16 v[100:103], v[32:35], v[228:231], v[100:103]
  buffer_load_dwordx4 v4, s[32:35], s26 offen offset:1024 sc1 lds
  v_mul_f32 v20, s76, v20
  v_mfma_f32_16x16x32_bf16 v[116:119], v[36:39], v[228:231], v[116:119]
  ds_read_b64_tr_b16 v[76:77], v13 offset:8448
  v_mul_f32 v21, s76, v21
  v_mfma_f32_16x16x32_bf16 v[132:135], v[40:43], v[228:231], v[132:135]
  ds_read_b64_tr_b16 v[78:79], v13 offset:9472
  v_mul_f32 v22, s76, v22
  v_mfma_f32_16x16x32_bf16 v[148:151], v[44:47], v[228:231], v[148:151]
  ds_read_b128 v[240:243], v14 offset:32768
  v_mul_f32 v23, s76, v23
  v_cvt_pk_bf16_f32 v24, v16, v17
  v_mfma_f32_16x16x32_bf16 v[164:167], v[48:51], v[228:231], v[164:167]
  ds_read_b128 v[244:247], v14 offset:33792
  v_cvt_pk_bf16_f32 v25, v18, v19
  v_mfma_f32_16x16x32_bf16 v[180:183], v[52:55], v[228:231], v[180:183]
  buffer_load_dwordx4 v5, s[32:35], s26 offen offset:2048 sc1 lds
  v_cvt_pk_bf16_f32 v26, v20, v21
  v_mfma_f32_16x16x32_bf16 v[196:199], v[56:59], v[228:231], v[196:199]
  ds_read_b64_tr_b16 v[80:81], v12 offset:8704
  v_cvt_pk_bf16_f32 v27, v22, v23
  v_mfma_f32_16x16x32_bf16 v[212:215], v[60:63], v[228:231], v[212:215]
  ds_read_b64_tr_b16 v[82:83], v12 offset:9728
  buffer_store_dwordx4 v[24:27], v2, s[40:43], s64 offen offset:2048 sc1
  v_accvgpr_read_b32 v16, a56
  v_mfma_f32_16x16x32_bf16 v[104:107], v[32:35], v[232:235], v[104:107]
  ds_read_b64_tr_b16 v[84:85], v13 offset:8704
  v_accvgpr_read_b32 v17, a57
  v_mfma_f32_16x16x32_bf16 v[120:123], v[36:39], v[232:235], v[120:123]
  ds_read_b64_tr_b16 v[86:87], v13 offset:9728
  v_accvgpr_read_b32 v18, a58
  v_mfma_f32_16x16x32_bf16 v[136:139], v[40:43], v[232:235], v[136:139]
  buffer_load_dwordx4 v6, s[32:35], s26 offen offset:3072 sc1 lds
  v_accvgpr_read_b32 v19, a59
  v_accvgpr_read_b32 v20, a60
  v_mfma_f32_16x16x32_bf16 v[152:155], v[44:47], v[232:235], v[152:155]
  s_add_u32 s26, s26, 1024
  ds_read_b64_tr_b16 v[88:89], v12 offset:8960
  v_accvgpr_read_b32 v21, a61
  v_mfma_f32_16x16x32_bf16 v[168:171], v[48:51], v[232:235], v[168:171]
  ds_read_b64_tr_b16 v[90:91], v12 offset:9984
  v_accvgpr_read_b32 v22, a62
  v_mfma_f32_16x16x32_bf16 v[184:187], v[52:55], v[232:235], v[184:187]
  ds_read_b64_tr_b16 v[92:93], v13 offset:8960
  v_accvgpr_read_b32 v23, a63
  v_mfma_f32_16x16x32_bf16 v[200:203], v[56:59], v[232:235], v[200:203]
  s_add_u32 m0, s24, 49152
  ds_read_b64_tr_b16 v[94:95], v13 offset:9984
  v_mul_f32 v16, s76, v16
  v_mul_f32 v17, s76, v17
  v_mfma_f32_16x16x32_bf16 v[216:219], v[60:63], v[232:235], v[216:219]
  buffer_load_dwordx4 v10, s[36:39], s27 offen offset:2048 lds
  v_mul_f32 v18, s76, v18
  v_mfma_f32_16x16x32_bf16 v[108:111], v[32:35], v[236:239], v[108:111]
  ds_read_b128 v[248:251], v14 offset:34816
  v_mul_f32 v19, s76, v19
  v_mfma_f32_16x16x32_bf16 v[124:127], v[36:39], v[236:239], v[124:127]
  ds_read_b128 v[252:255], v14 offset:35840
  v_mul_f32 v20, s76, v20
  v_mfma_f32_16x16x32_bf16 v[140:143], v[40:43], v[236:239], v[140:143]
  v_mul_f32 v21, s76, v21
  v_mul_f32 v22, s76, v22
  v_mul_f32 v23, s76, v23
  v_mfma_f32_16x16x32_bf16 v[156:159], v[44:47], v[236:239], v[156:159]
  v_xor_b32 v14, 0x10000, v14
  v_cvt_pk_bf16_f32 v28, v16, v17
  v_mfma_f32_16x16x32_bf16 v[172:175], v[48:51], v[236:239], v[172:175]
  buffer_load_dwordx4 v11, s[36:39], s27 offen offset:3072 lds
  v_cvt_pk_bf16_f32 v29, v18, v19
  v_mfma_f32_16x16x32_bf16 v[188:191], v[52:55], v[236:239], v[188:191]
  s_add_u32 s27, s27, 524288
  v_cvt_pk_bf16_f32 v30, v20, v21
  v_cvt_pk_bf16_f32 v31, v22, v23
  v_mfma_f32_16x16x32_bf16 v[204:207], v[56:59], v[236:239], v[204:207]
  buffer_store_dwordx4 v[28:31], v2, s[40:43], s64 offen offset:3072 sc1
  v_mfma_f32_16x16x32_bf16 v[220:223], v[60:63], v[236:239], v[220:223]
  s_waitcnt vmcnt(18) lgkmcnt(0)
  v_mfma_f32_16x16x32_bf16 v[96:99], v[64:67], v[240:243], v[96:99]
  s_barrier
  v_accvgpr_read_b32 v16, a64
  v_accvgpr_read_b32 v17, a65
  v_accvgpr_read_b32 v18, a66
  v_mfma_f32_16x16x32_bf16 v[112:115], v[68:71], v[240:243], v[112:115]
  s_add_u32 s64, s64, 126976
  ds_read_b64_tr_b16 v[32:33], v12 offset:32768
  v_accvgpr_read_b32 v19, a67
  v_accvgpr_read_b32 v20, a68
  v_mfma_f32_16x16x32_bf16 v[128:131], v[72:75], v[240:243], v[128:131]
  s_add_u32 m0, s24, 32768
  ds_read_b64_tr_b16 v[34:35], v12 offset:33792
  v_accvgpr_read_b32 v21, a69
  v_mfma_f32_16x16x32_bf16 v[144:147], v[76:79], v[240:243], v[144:147]
  buffer_load_dwordx4 v3, s[32:35], s26 offen offset:0 sc1 lds
  v_accvgpr_read_b32 v22, a70
  v_accvgpr_read_b32 v23, a71
  v_mfma_f32_16x16x32_bf16 v[160:163], v[80:83], v[240:243], v[160:163]
  ds_read_b64_tr_b16 v[36:37], v13 offset:32768
  v_mul_f32 v16, s76, v16
  v_mfma_f32_16x16x32_bf16 v[176:179], v[84:87], v[240:243], v[176:179]
  ds_read_b64_tr_b16 v[38:39], v13 offset:33792
  v_mul_f32 v17, s76, v17
  v_mul_f32 v18, s76, v18
  v_mfma_f32_16x16x32_bf16 v[192:195], v[88:91], v[240:243], v[192:195]
  ds_read_b64_tr_b16 v[40:41], v12 offset:33024
  v_mul_f32 v19, s76, v19
  v_mfma_f32_16x16x32_bf16 v[208:211], v[92:95], v[240:243], v[208:211]
  ds_read_b64_tr_b16 v[42:43], v12 offset:34048
  v_mul_f32 v20, s76, v20
  v_mul_f32 v21, s76, v21
  v_mfma_f32_16x16x32_bf16 v[100:103], v[64:67], v[244:247], v[100:103]
  buffer_load_dwordx4 v4, s[32:35], s26 offen offset:1024 sc1 lds
  v_mul_f32 v22, s76, v22
  v_mfma_f32_16x16x32_bf16 v[116:119], v[68:71], v[244:247], v[116:119]
  ds_read_b64_tr_b16 v[44:45], v13 offset:33024
  v_mul_f32 v23, s76, v23
  v_cvt_pk_bf16_f32 v24, v16, v17
  v_mfma_f32_16x16x32_bf16 v[132:135], v[72:75], v[244:247], v[132:135]
  ds_read_b64_tr_b16 v[46:47], v13 offset:34048
  v_cvt_pk_bf16_f32 v25, v18, v19
  v_mfma_f32_16x16x32_bf16 v[148:151], v[76:79], v[244:247], v[148:151]
  ds_read_b128 v[224:227], v14 offset:0
  v_cvt_pk_bf16_f32 v26, v20, v21
  v_cvt_pk_bf16_f32 v27, v22, v23
  v_mfma_f32_16x16x32_bf16 v[164:167], v[80:83], v[244:247], v[164:167]
  ds_read_b128 v[228:231], v14 offset:1024
  buffer_store_dwordx4 v[24:27], v2, s[40:43], s64 offen offset:0 sc1
  v_mfma_f32_16x16x32_bf16 v[180:183], v[84:87], v[244:247], v[180:183]
  buffer_load_dwordx4 v5, s[32:35], s26 offen offset:2048 sc1 lds
  v_accvgpr_read_b32 v16, a72
  v_accvgpr_read_b32 v17, a73
  v_mfma_f32_16x16x32_bf16 v[196:199], v[88:91], v[244:247], v[196:199]
  ds_read_b64_tr_b16 v[48:49], v12 offset:33280
  v_accvgpr_read_b32 v18, a74
  v_mfma_f32_16x16x32_bf16 v[212:215], v[92:95], v[244:247], v[212:215]
  ds_read_b64_tr_b16 v[50:51], v12 offset:34304
  v_accvgpr_read_b32 v19, a75
  v_accvgpr_read_b32 v20, a76
  v_mfma_f32_16x16x32_bf16 v[104:107], v[64:67], v[248:251], v[104:107]
  ds_read_b64_tr_b16 v[52:53], v13 offset:33280
  v_accvgpr_read_b32 v21, a77
  v_accvgpr_read_b32 v22, a78
  v_mfma_f32_16x16x32_bf16 v[120:123], v[68:71], v[248:251], v[120:123]
  ds_read_b64_tr_b16 v[54:55], v13 offset:34304
  v_accvgpr_read_b32 v23, a79
  v_mfma_f32_16x16x32_bf16 v[136:139], v[72:75], v[248:251], v[136:139]
  buffer_load_dwordx4 v6, s[32:35], s26 offen offset:3072 sc1 lds
  v_mul_f32 v16, s76, v16
  v_mul_f32 v17, s76, v17
  v_mfma_f32_16x16x32_bf16 v[152:155], v[76:79], v[248:251], v[152:155]
  s_add_u32 s26, s26, 1024
  ds_read_b64_tr_b16 v[56:57], v12 offset:33536
  v_mul_f32 v18, s76, v18
  v_mfma_f32_16x16x32_bf16 v[168:171], v[80:83], v[248:251], v[168:171]
  ds_read_b64_tr_b16 v[58:59], v12 offset:34560
  v_mul_f32 v19, s76, v19
  v_mul_f32 v20, s76, v20
  v_mfma_f32_16x16x32_bf16 v[184:187], v[84:87], v[248:251], v[184:187]
  ds_read_b64_tr_b16 v[60:61], v13 offset:33536
  v_mul_f32 v21, s76, v21
  v_mfma_f32_16x16x32_bf16 v[200:203], v[88:91], v[248:251], v[200:203]
  ds_read_b64_tr_b16 v[62:63], v13 offset:34560
  v_mul_f32 v22, s76, v22
  v_mul_f32 v23, s76, v23
  v_mfma_f32_16x16x32_bf16 v[216:219], v[92:95], v[248:251], v[216:219]
  v_cvt_pk_bf16_f32 v28, v16, v17
  v_cvt_pk_bf16_f32 v29, v18, v19
  v_mfma_f32_16x16x32_bf16 v[108:111], v[64:67], v[252:255], v[108:111]
  ds_read_b128 v[232:235], v14 offset:2048
  v_cvt_pk_bf16_f32 v30, v20, v21
  v_cvt_pk_bf16_f32 v31, v22, v23
  v_mfma_f32_16x16x32_bf16 v[124:127], v[68:71], v[252:255], v[124:127]
  ds_read_b128 v[236:239], v14 offset:3072
  buffer_store_dwordx4 v[28:31], v2, s[40:43], s64 offen offset:1024 sc1
  v_mfma_f32_16x16x32_bf16 v[140:143], v[72:75], v[252:255], v[140:143]
  v_and_b32 v11, 15, v1
  v_lshrrev_b32 v10, 4, v1
  v_lshlrev_b32 v10, 2, v10
  v_mfma_f32_16x16x32_bf16 v[156:159], v[76:79], v[252:255], v[156:159]
  v_sub_u32 v11, v11, v10
  v_cmp_le_i32 s[68:69], 0, v11
  v_mfma_f32_16x16x32_bf16 v[172:175], v[80:83], v[252:255], v[172:175]
  v_cmp_le_i32 s[70:71], 1, v11
  v_cmp_le_i32 s[72:73], 2, v11
  v_cmp_le_i32 s[74:75], 3, v11
  v_mfma_f32_16x16x32_bf16 v[188:191], v[84:87], v[252:255], v[188:191]
  v_and_b32 v8, 7, v1
  v_lshlrev_b32 v8, 2, v8
  v_mfma_f32_16x16x32_bf16 v[204:207], v[88:91], v[252:255], v[204:207]
  v_add_u32 v8, s30, v8
  v_mfma_f32_16x16x32_bf16 v[220:223], v[92:95], v[252:255], v[220:223]
  s_waitcnt vmcnt(17) lgkmcnt(0)
  v_mfma_f32_16x16x32_bf16 v[96:99], v[32:35], v[224:227], v[96:99]
  v_accvgpr_read_b32 v16, a80
  v_accvgpr_read_b32 v17, a81
  v_accvgpr_read_b32 v18, a82
  v_mfma_f32_16x16x32_bf16 v[112:115], v[36:39], v[224:227], v[112:115]
  ds_read_b64_tr_b16 v[64:65], v12 offset:40960
  v_accvgpr_read_b32 v19, a83
  v_accvgpr_read_b32 v20, a84
  v_mfma_f32_16x16x32_bf16 v[128:131], v[40:43], v[224:227], v[128:131]
  s_add_u32 m0, s24, 65536
  ds_read_b64_tr_b16 v[66:67], v12 offset:41984
  v_accvgpr_read_b32 v21, a85
  v_accvgpr_read_b32 v22, a86
  v_mfma_f32_16x16x32_bf16 v[144:147], v[44:47], v[224:227], v[144:147]
  buffer_load_dwordx4 v3, s[32:35], s26 offen offset:0 sc1 lds
  v_accvgpr_read_b32 v23, a87
  v_mul_f32 v16, s76, v16
  v_mfma_f32_16x16x32_bf16 v[160:163], v[48:51], v[224:227], v[160:163]
  ds_read_b64_tr_b16 v[68:69], v13 offset:40960
  v_mul_f32 v17, s76, v17
  v_mul_f32 v18, s76, v18
  v_mfma_f32_16x16x32_bf16 v[176:179], v[52:55], v[224:227], v[176:179]
  ds_read_b64_tr_b16 v[70:71], v13 offset:41984
  v_mul_f32 v19, s76, v19
  v_mul_f32 v20, s76, v20
  v_mfma_f32_16x16x32_bf16 v[192:195], v[56:59], v[224:227], v[192:195]
  ds_read_b64_tr_b16 v[72:73], v12 offset:41216
  v_mul_f32 v21, s76, v21
  v_mul_f32 v22, s76, v22
  v_mfma_f32_16x16x32_bf16 v[208:211], v[60:63], v[224:227], v[208:211]
  ds_read_b64_tr_b16 v[74:75], v12 offset:42240
  v_mul_f32 v23, s76, v23
  v_mfma_f32_16x16x32_bf16 v[100:103], v[32:35], v[228:231], v[100:103]
  buffer_load_dwordx4 v4, s[32:35], s26 offen offset:1024 sc1 lds
  v_cvt_pk_bf16_f32 v24, v16, v17
  v_cvt_pk_bf16_f32 v25, v18, v19
  v_mfma_f32_16x16x32_bf16 v[116:119], v[36:39], v[228:231], v[116:119]
  ds_read_b64_tr_b16 v[76:77], v13 offset:41216
  v_cvt_pk_bf16_f32 v26, v20, v21
  v_cvt_pk_bf16_f32 v27, v22, v23
  v_mfma_f32_16x16x32_bf16 v[132:135], v[40:43], v[228:231], v[132:135]
  ds_read_b64_tr_b16 v[78:79], v13 offset:42240
  buffer_store_dwordx4 v[24:27], v2, s[40:43], s64 offen offset:2048 sc1
  v_accvgpr_read_b32 v16, a88
  v_mfma_f32_16x16x32_bf16 v[148:151], v[44:47], v[228:231], v[148:151]
  ds_read_b128 v[240:243], v14 offset:32768
  v_accvgpr_read_b32 v17, a89
  v_accvgpr_read_b32 v18, a90
  v_mfma_f32_16x16x32_bf16 v[164:167], v[48:51], v[228:231], v[164:167]
  ds_read_b128 v[244:247], v14 offset:33792
  v_accvgpr_read_b32 v19, a91
  v_accvgpr_read_b32 v20, a92
  v_mfma_f32_16x16x32_bf16 v[180:183], v[52:55], v[228:231], v[180:183]
  buffer_load_dwordx4 v5, s[32:35], s26 offen offset:2048 sc1 lds
  v_accvgpr_read_b32 v21, a93
  v_accvgpr_read_b32 v22, a94
  v_mfma_f32_16x16x32_bf16 v[196:199], v[56:59], v[228:231], v[196:199]
  ds_read_b64_tr_b16 v[80:81], v12 offset:41472
  v_accvgpr_read_b32 v23, a95
  v_mfma_f32_16x16x32_bf16 v[212:215], v[60:63], v[228:231], v[212:215]
  ds_read_b64_tr_b16 v[82:83], v12 offset:42496
  v_mul_f32 v16, s76, v16
  v_mul_f32 v17, s76, v17
  v_mfma_f32_16x16x32_bf16 v[104:107], v[32:35], v[232:235], v[104:107]
  ds_read_b64_tr_b16 v[84:85], v13 offset:41472
  v_mul_f32 v18, s76, v18
  v_mul_f32 v19, s76, v19
  v_mfma_f32_16x16x32_bf16 v[120:123], v[36:39], v[232:235], v[120:123]
  ds_read_b64_tr_b16 v[86:87], v13 offset:42496
  v_mul_f32 v20, s76, v20
  v_mul_f32 v21, s76, v21
  v_mfma_f32_16x16x32_bf16 v[136:139], v[40:43], v[232:235], v[136:139]
  buffer_load_dwordx4 v6, s[32:35], s26 offen offset:3072 sc1 lds
  v_mul_f32 v22, s76, v22
  v_mul_f32 v23, s76, v23
  v_mfma_f32_16x16x32_bf16 v[152:155], v[44:47], v[232:235], v[152:155]
  s_add_u32 s26, s26, 1024
  ds_read_b64_tr_b16 v[88:89], v12 offset:41728
  v_cvt_pk_bf16_f32 v28, v16, v17
  v_cvt_pk_bf16_f32 v29, v18, v19
  v_mfma_f32_16x16x32_bf16 v[168:171], v[48:51], v[232:235], v[168:171]
  ds_read_b64_tr_b16 v[90:91], v12 offset:42752
  v_cvt_pk_bf16_f32 v30, v20, v21
  v_cvt_pk_bf16_f32 v31, v22, v23
  v_mfma_f32_16x16x32_bf16 v[184:187], v[52:55], v[232:235], v[184:187]
  ds_read_b64_tr_b16 v[92:93], v13 offset:41728
  buffer_store_dwordx4 v[28:31], v2, s[40:43], s64 offen offset:3072 sc1
  v_add_u32 v9, 0, v1
  v_mfma_f32_16x16x32_bf16 v[200:203], v[56:59], v[232:235], v[200:203]
  ds_read_b64_tr_b16 v[94:95], v13 offset:42752
  v_mul_u32_u24 v10, 6554, v9
  v_mfma_f32_16x16x32_bf16 v[216:219], v[60:63], v[232:235], v[216:219]
  v_lshrrev_b32 v10, 16, v10
  v_mul_u32_u24 v10, 1120, v10
  v_lshl_add_u32 v10, v9, 4, v10
  v_mfma_f32_16x16x32_bf16 v[108:111], v[32:35], v[236:239], v[108:111]
  ds_read_b128 v[248:251], v14 offset:34816
  v_accvgpr_write_b32 a248, v10
  v_add_u32 v9, 64, v1
  v_mfma_f32_16x16x32_bf16 v[124:127], v[36:39], v[236:239], v[124:127]
  ds_read_b128 v[252:255], v14 offset:35840
  v_mul_u32_u24 v10, 6554, v9
  v_lshrrev_b32 v10, 16, v10
  v_mfma_f32_16x16x32_bf16 v[140:143], v[40:43], v[236:239], v[140:143]
  v_mul_u32_u24 v10, 1120, v10
  v_lshl_add_u32 v10, v9, 4, v10
  v_accvgpr_write_b32 a249, v10
  v_mfma_f32_16x16x32_bf16 v[156:159], v[44:47], v[236:239], v[156:159]
  v_xor_b32 v14, 0x10000, v14
  v_add_u32 v9, 128, v1
  v_mul_u32_u24 v10, 6554, v9
  v_mfma_f32_16x16x32_bf16 v[172:175], v[48:51], v[236:239], v[172:175]
  v_lshrrev_b32 v10, 16, v10
  v_mul_u32_u24 v10, 1120, v10
  v_lshl_add_u32 v10, v9, 4, v10
  v_mfma_f32_16x16x32_bf16 v[188:191], v[52:55], v[236:239], v[188:191]
  v_xor_b32 v12, 0x10000, v12
  v_accvgpr_write_b32 a250, v10
  v_mfma_f32_16x16x32_bf16 v[204:207], v[56:59], v[236:239], v[204:207]
  v_xor_b32 v13, 0x10000, v13
  v_mfma_f32_16x16x32_bf16 v[220:223], v[60:63], v[236:239], v[220:223]
  s_waitcnt vmcnt(15) lgkmcnt(0)
  v_mfma_f32_16x16x32_bf16 v[96:99], v[64:67], v[240:243], v[96:99]
  s_barrier
  v_accvgpr_read_b32 v16, a96
  v_accvgpr_read_b32 v17, a97
  v_accvgpr_read_b32 v18, a98
  v_accvgpr_read_b32 v19, a99
  v_mfma_f32_16x16x32_bf16 v[112:115], v[68:71], v[240:243], v[112:115]
  s_add_u32 s64, s64, 4096
  ds_read_b64_tr_b16 v[32:33], v12 offset:0
  v_accvgpr_read_b32 v20, a100
  v_accvgpr_read_b32 v21, a101
  v_mfma_f32_16x16x32_bf16 v[128:131], v[72:75], v[240:243], v[128:131]
  s_add_u32 m0, s24, 98304
  ds_read_b64_tr_b16 v[34:35], v12 offset:1024
  v_accvgpr_read_b32 v22, a102
  v_accvgpr_read_b32 v23, a103
  v_mfma_f32_16x16x32_bf16 v[144:147], v[76:79], v[240:243], v[144:147]
  buffer_load_dwordx4 v3, s[32:35], s26 offen offset:0 sc1 lds
  v_mul_f32 v16, s76, v16
  v_mul_f32 v17, s76, v17
  v_mul_f32 v18, s76, v18
  v_mfma_f32_16x16x32_bf16 v[160:163], v[80:83], v[240:243], v[160:163]
  ds_read_b64_tr_b16 v[36:37], v13 offset:0
  v_mul_f32 v19, s76, v19
  v_mul_f32 v20, s76, v20
  v_mfma_f32_16x16x32_bf16 v[176:179], v[84:87], v[240:243], v[176:179]
  ds_read_b64_tr_b16 v[38:39], v13 offset:1024
  v_mul_f32 v21, s76, v21
  v_mul_f32 v22, s76, v22
  v_mfma_f32_16x16x32_bf16 v[192:195], v[88:91], v[240:243], v[192:195]
  ds_read_b64_tr_b16 v[40:41], v12 offset:256
  v_mul_f32 v23, s76, v23
  v_cvt_pk_bf16_f32 v24, v16, v17
  v_cvt_pk_bf16_f32 v25, v18, v19
  v_mfma_f32_16x16x32_bf16 v[208:211], v[92:95], v[240:243], v[208:211]
  ds_read_b64_tr_b16 v[42:43], v12 offset:1280
  v_cvt_pk_bf16_f32 v26, v20, v21
  v_cvt_pk_bf16_f32 v27, v22, v23
  v_mfma_f32_16x16x32_bf16 v[100:103], v[64:67], v[244:247], v[100:103]
  buffer_load_dwordx4 v4, s[32:35], s26 offen offset:1024 sc1 lds
  buffer_store_dwordx4 v[24:27], v2, s[40:43], s64 offen offset:0 sc1
  v_accvgpr_read_b32 v16, a104
  v_mfma_f32_16x16x32_bf16 v[116:119], v[68:71], v[244:247], v[116:119]
  ds_read_b64_tr_b16 v[44:45], v13 offset:256
  v_accvgpr_read_b32 v17, a105
  v_accvgpr_read_b32 v18, a106
  v_mfma_f32_16x16x32_bf16 v[132:135], v[72:75], v[244:247], v[132:135]
  ds_read_b64_tr_b16 v[46:47], v13 offset:1280
  v_accvgpr_read_b32 v19, a107
  v_accvgpr_read_b32 v20, a108
  v_accvgpr_read_b32 v21, a109
  v_mfma_f32_16x16x32_bf16 v[148:151], v[76:79], v[244:247], v[148:151]
  ds_read_b128 v[224:227], v14 offset:0
  v_accvgpr_read_b32 v22, a110
  v_accvgpr_read_b32 v23, a111
  v_mfma_f32_16x16x32_bf16 v[164:167], v[80:83], v[244:247], v[164:167]
  ds_read_b128 v[228:231], v14 offset:1024
  v_mul_f32 v16, s76, v16
  v_mul_f32 v17, s76, v17
  v_mfma_f32_16x16x32_bf16 v[180:183], v[84:87], v[244:247], v[180:183]
  buffer_load_dwordx4 v5, s[32:35], s26 offen offset:2048 sc1 lds
  v_mul_f32 v18, s76, v18
  v_mul_f32 v19, s76, v19
  v_mul_f32 v20, s76, v20
  v_mfma_f32_16x16x32_bf16 v[196:199], v[88:91], v[244:247], v[196:199]
  ds_read_b64_tr_b16 v[48:49], v12 offset:512
  v_mul_f32 v21, s76, v21
  v_mul_f32 v22, s76, v22
  v_mfma_f32_16x16x32_bf16 v[212:215], v[92:95], v[244:247], v[212:215]
  ds_read_b64_tr_b16 v[50:51], v12 offset:1536
  v_mul_f32 v23, s76, v23
  v_cvt_pk_bf16_f32 v28, v16, v17
  v_mfma_f32_16x16x32_bf16 v[104:107], v[64:67], v[248:251], v[104:107]
  ds_read_b64_tr_b16 v[52:53], v13 offset:512
  v_cvt_pk_bf16_f32 v29, v18, v19
  v_cvt_pk_bf16_f32 v30, v20, v21
  v_cvt_pk_bf16_f32 v31, v22, v23
  v_mfma_f32_16x16x32_bf16 v[120:123], v[68:71], v[248:251], v[120:123]
  ds_read_b64_tr_b16 v[54:55], v13 offset:1536
  buffer_store_dwordx4 v[28:31], v2, s[40:43], s64 offen offset:1024 sc1
  v_accvgpr_read_b32 v16, a112
  v_mfma_f32_16x16x32_bf16 v[136:139], v[72:75], v[248:251], v[136:139]
  buffer_load_dwordx4 v6, s[32:35], s26 offen offset:3072 sc1 lds
  v_accvgpr_read_b32 v17, a113
  v_accvgpr_read_b32 v18, a114
  v_mfma_f32_16x16x32_bf16 v[152:155], v[76:79], v[248:251], v[152:155]
  s_add_u32 s26, s26, 1024
  ds_read_b64_tr_b16 v[56:57], v12 offset:768
  v_accvgpr_read_b32 v19, a115
  v_accvgpr_read_b32 v20, a116
  v_mfma_f32_16x16x32_bf16 v[168:171], v[80:83], v[248:251], v[168:171]
  ds_read_b64_tr_b16 v[58:59], v12 offset:1792
  v_accvgpr_read_b32 v21, a117
  v_accvgpr_read_b32 v22, a118
  v_accvgpr_read_b32 v23, a119
  v_mfma_f32_16x16x32_bf16 v[184:187], v[84:87], v[248:251], v[184:187]
  ds_read_b64_tr_b16 v[60:61], v13 offset:768
  v_mul_f32 v16, s76, v16
  v_mul_f32 v17, s76, v17
  v_mfma_f32_16x16x32_bf16 v[200:203], v[88:91], v[248:251], v[200:203]
  ds_read_b64_tr_b16 v[62:63], v13 offset:1792
  v_mul_f32 v18, s76, v18
  v_mul_f32 v19, s76, v19
  v_mfma_f32_16x16x32_bf16 v[216:219], v[92:95], v[248:251], v[216:219]
  v_mul_f32 v20, s76, v20
  v_mul_f32 v21, s76, v21
  v_mul_f32 v22, s76, v22
  v_mul_f32 v23, s76, v23
  v_mfma_f32_16x16x32_bf16 v[108:111], v[64:67], v[252:255], v[108:111]
  ds_read_b128 v[232:235], v14 offset:2048
  v_cvt_pk_bf16_f32 v24, v16, v17
  v_cvt_pk_bf16_f32 v25, v18, v19
  v_mfma_f32_16x16x32_bf16 v[124:127], v[68:71], v[252:255], v[124:127]
  ds_read_b128 v[236:239], v14 offset:3072
  v_cvt_pk_bf16_f32 v26, v20, v21
  v_cvt_pk_bf16_f32 v27, v22, v23
  v_mfma_f32_16x16x32_bf16 v[140:143], v[72:75], v[252:255], v[140:143]
  buffer_store_dwordx4 v[24:27], v2, s[40:43], s64 offen offset:2048 sc1
  v_add_u32 v9, 192, v1
  v_mul_u32_u24 v10, 6554, v9
  v_lshrrev_b32 v10, 16, v10
  v_mfma_f32_16x16x32_bf16 v[156:159], v[76:79], v[252:255], v[156:159]
  v_mul_u32_u24 v10, 1120, v10
  v_lshl_add_u32 v10, v9, 4, v10
  v_accvgpr_write_b32 a251, v10
  v_mfma_f32_16x16x32_bf16 v[172:175], v[80:83], v[252:255], v[172:175]
  v_add_u32 v9, 256, v1
  v_mul_u32_u24 v10, 6554, v9
  v_lshrrev_b32 v10, 16, v10
  v_mfma_f32_16x16x32_bf16 v[188:191], v[84:87], v[252:255], v[188:191]
  v_mul_u32_u24 v10, 1120, v10
  v_lshl_add_u32 v10, v9, 4, v10
  v_accvgpr_write_b32 a252, v10
  v_mfma_f32_16x16x32_bf16 v[204:207], v[88:91], v[252:255], v[204:207]
  v_mfma_f32_16x16x32_bf16 v[220:223], v[92:95], v[252:255], v[220:223]
  s_waitcnt vmcnt(14) lgkmcnt(0)
  v_mfma_f32_16x16x32_bf16 v[96:99], v[32:35], v[224:227], v[96:99]
  v_accvgpr_read_b32 v16, a120
  v_accvgpr_read_b32 v17, a121
  v_accvgpr_read_b32 v18, a122
  v_mfma_f32_16x16x32_bf16 v[112:115], v[36:39], v[224:227], v[112:115]
  s_mul_i32 s34, s20, 5120
  ds_read_b64_tr_b16 v[64:65], v12 offset:8192
  v_accvgpr_read_b32 v19, a123
  v_accvgpr_read_b32 v20, a124
  v_mfma_f32_16x16x32_bf16 v[128:131], v[40:43], v[224:227], v[128:131]
  s_add_u32 s34, s34, 131072
  ds_read_b64_tr_b16 v[66:67], v12 offset:9216
  v_accvgpr_read_b32 v21, a125
  v_accvgpr_read_b32 v22, a126
  v_mfma_f32_16x16x32_bf16 v[144:147], v[44:47], v[224:227], v[144:147]
  s_and_b32 s32, s21, 3
  buffer_load_dword v15, v8, s[40:43], 0 offen sc1
  v_accvgpr_read_b32 v23, a127
  v_mul_f32 v16, s76, v16
  v_mfma_f32_16x16x32_bf16 v[160:163], v[48:51], v[224:227], v[160:163]
  s_min_u32 s32, s32, 2
  ds_read_b64_tr_b16 v[68:69], v13 offset:8192
  v_mul_f32 v17, s76, v17
  v_mul_f32 v18, s76, v18
  v_mfma_f32_16x16x32_bf16 v[176:179], v[52:55], v[224:227], v[176:179]
  s_add_u32 s32, s32, 5
  ds_read_b64_tr_b16 v[70:71], v13 offset:9216
  v_mul_f32 v19, s76, v19
  v_mul_f32 v20, s76, v20
  v_mfma_f32_16x16x32_bf16 v[192:195], v[56:59], v[224:227], v[192:195]
  s_lshl_b32 s32, s32, 14
  ds_read_b64_tr_b16 v[72:73], v12 offset:8448
  v_mul_f32 v21, s76, v21
  v_mul_f32 v22, s76, v22
  v_mfma_f32_16x16x32_bf16 v[208:211], v[60:63], v[224:227], v[208:211]
  s_mov_b32 s9, -1
  ds_read_b64_tr_b16 v[74:75], v12 offset:9472
  v_mul_f32 v23, s76, v23
  v_mfma_f32_16x16x32_bf16 v[100:103], v[32:35], v[228:231], v[100:103]
  s_sub_u32 s23, s2, 64
  v_cvt_pk_bf16_f32 v28, v16, v17
  v_cvt_pk_bf16_f32 v29, v18, v19
  v_cvt_pk_bf16_f32 v30, v20, v21
  v_mfma_f32_16x16x32_bf16 v[116:119], v[36:39], v[228:231], v[116:119]
  s_cmp_lt_u32 s23, 96
  s_cselect_b32 s9, 0, s9
  ds_read_b64_tr_b16 v[76:77], v13 offset:8448
  v_cvt_pk_bf16_f32 v31, v22, v23
  v_mfma_f32_16x16x32_bf16 v[132:135], v[40:43], v[228:231], v[132:135]
  s_cmp_ge_u32 s2, 224
  s_cselect_b32 s9, 0, s9
  ds_read_b64_tr_b16 v[78:79], v13 offset:9472
  buffer_store_dwordx4 v[28:31], v2, s[40:43], s64 offen offset:3072 sc1
  v_accvgpr_read_b32 v16, a128
  v_mfma_f32_16x16x32_bf16 v[148:151], v[44:47], v[228:231], v[148:151]
  s_and_b32 s32, s32, s9
  ds_read_b128 v[240:243], v14 offset:32768
  v_accvgpr_read_b32 v17, a129
  v_accvgpr_read_b32 v18, a130
  v_mfma_f32_16x16x32_bf16 v[164:167], v[48:51], v[228:231], v[164:167]
  s_sub_u32 s23, s2, 170
  ds_read_b128 v[244:247], v14 offset:33792
  v_accvgpr_read_b32 v19, a131
  v_accvgpr_read_b32 v20, a132
  v_mfma_f32_16x16x32_bf16 v[180:183], v[52:55], v[228:231], v[180:183]
  s_cmp_lt_u32 s23, 54
  s_cselect_b32 s32, 98304, s32
  v_accvgpr_read_b32 v21, a133
  v_accvgpr_read_b32 v22, a134
  v_accvgpr_read_b32 v23, a135
  v_mfma_f32_16x16x32_bf16 v[196:199], v[56:59], v[228:231], v[196:199]
  s_mov_b32 s67, s2
  s_add_u32 s64, s64, 126976
  ds_read_b64_tr_b16 v[80:81], v12 offset:8704
  v_mul_f32 v16, s76, v16
  v_mfma_f32_16x16x32_bf16 v[212:215], v[60:63], v[228:231], v[212:215]
  s_mov_b32 s8, 0
  ds_read_b64_tr_b16 v[82:83], v12 offset:9728
  v_mul_f32 v17, s76, v17
  v_mul_f32 v18, s76, v18
  v_mfma_f32_16x16x32_bf16 v[104:107], v[32:35], v[232:235], v[104:107]
  s_mov_b32 s66, 0
  ds_read_b64_tr_b16 v[84:85], v13 offset:8704
  v_mul_f32 v19, s76, v19
  v_mul_f32 v20, s76, v20
  v_mfma_f32_16x16x32_bf16 v[120:123], v[36:39], v[232:235], v[120:123]
  s_mov_b32 s11, 0
  ds_read_b64_tr_b16 v[86:87], v13 offset:9728
  v_mul_f32 v21, s76, v21
  v_mul_f32 v22, s76, v22
  v_mfma_f32_16x16x32_bf16 v[136:139], v[40:43], v[232:235], v[136:139]
  s_mov_b32 s12, 0
  v_mul_f32 v23, s76, v23
  v_cvt_pk_bf16_f32 v24, v16, v17
  v_cvt_pk_bf16_f32 v25, v18, v19
  v_mfma_f32_16x16x32_bf16 v[152:155], v[44:47], v[232:235], v[152:155]
  s_lshl_b32 s15, s22, 1
  ds_read_b64_tr_b16 v[88:89], v12 offset:8960
  v_cvt_pk_bf16_f32 v26, v20, v21
  v_cvt_pk_bf16_f32 v27, v22, v23
  v_mfma_f32_16x16x32_bf16 v[168:171], v[48:51], v[232:235], v[168:171]
  s_add_u32 s23, s15, 6
  ds_read_b64_tr_b16 v[90:91], v12 offset:9984
  buffer_store_dwordx4 v[24:27], v2, s[40:43], s64 offen offset:0 sc1
  v_accvgpr_read_b32 v16, a136
  v_mfma_f32_16x16x32_bf16 v[184:187], v[52:55], v[232:235], v[184:187]
  s_sub_u32 s15, 24, s15
  ds_read_b64_tr_b16 v[92:93], v13 offset:8960
  v_accvgpr_read_b32 v17, a137
  v_accvgpr_read_b32 v18, a138
  v_mfma_f32_16x16x32_bf16 v[200:203], v[56:59], v[232:235], v[200:203]
  s_max_u32 s15, s15, s23
  ds_read_b64_tr_b16 v[94:95], v13 offset:9984
  v_accvgpr_read_b32 v19, a139
  v_mfma_f32_16x16x32_bf16 v[216:219], v[60:63], v[232:235], v[216:219]
  s_lshl_b32 s15, s15, 14
  v_accvgpr_read_b32 v20, a140
  v_accvgpr_read_b32 v21, a141
  v_accvgpr_read_b32 v22, a142
  v_mfma_f32_16x16x32_bf16 v[108:111], v[32:35], v[236:239], v[108:111]
  ds_read_b128 v[248:251], v14 offset:34816
  v_accvgpr_read_b32 v23, a143
  v_mul_f32 v16, s76, v16
  v_mfma_f32_16x16x32_bf16 v[124:127], v[36:39], v[236:239], v[124:127]
  ds_read_b128 v[252:255], v14 offset:35840
  v_mul_f32 v17, s76, v17
  v_mul_f32 v18, s76, v18
  v_mfma_f32_16x16x32_bf16 v[140:143], v[40:43], v[236:239], v[140:143]
  v_mul_f32 v19, s76, v19
  v_mul_f32 v20, s76, v20
  v_mul_f32 v21, s76, v21
  v_mfma_f32_16x16x32_bf16 v[156:159], v[44:47], v[236:239], v[156:159]
  v_xor_b32 v14, 0x10000, v14
  v_mul_f32 v22, s76, v22
  v_mul_f32 v23, s76, v23
  v_mfma_f32_16x16x32_bf16 v[172:175], v[48:51], v[236:239], v[172:175]
  v_cvt_pk_bf16_f32 v28, v16, v17
  v_cvt_pk_bf16_f32 v29, v18, v19
  v_cvt_pk_bf16_f32 v30, v20, v21
  v_mfma_f32_16x16x32_bf16 v[188:191], v[52:55], v[236:239], v[188:191]
  v_cvt_pk_bf16_f32 v31, v22, v23
  v_mfma_f32_16x16x32_bf16 v[204:207], v[56:59], v[236:239], v[204:207]
  buffer_store_dwordx4 v[28:31], v2, s[40:43], s64 offen offset:1024 sc1
  v_mfma_f32_16x16x32_bf16 v[220:223], v[60:63], v[236:239], v[220:223]
  s_waitcnt vmcnt(12) lgkmcnt(0)
  v_mfma_f32_16x16x32_bf16 v[96:99], v[64:67], v[240:243], v[96:99]
  s_barrier
  v_accvgpr_read_b32 v16, a144
  v_accvgpr_read_b32 v17, a145
  v_accvgpr_read_b32 v18, a146
  v_accvgpr_read_b32 v19, a147
  v_mfma_f32_16x16x32_bf16 v[112:115], v[68:71], v[240:243], v[112:115]
  s_and_b32 s23, s20, 1
  ds_read_b64_tr_b16 v[32:33], v12 offset:32768
  v_accvgpr_read_b32 v20, a148
  v_accvgpr_read_b32 v21, a149
  v_mfma_f32_16x16x32_bf16 v[128:131], v[72:75], v[240:243], v[128:131]
  s_lshl_b32 s23, s23, 12
  ds_read_b64_tr_b16 v[34:35], v12 offset:33792
  v_accvgpr_read_b32 v22, a150
  v_accvgpr_read_b32 v23, a151
  v_mfma_f32_16x16x32_bf16 v[144:147], v[76:79], v[240:243], v[144:147]
  s_cmp_lt_u32 s20, 2
  s_cselect_b32 s24, 106496, 0
  v_mul_f32 v16, s76, v16
  v_mul_f32 v17, s76, v17
  v_mul_f32 v18, s76, v18
  v_mfma_f32_16x16x32_bf16 v[160:163], v[80:83], v[240:243], v[160:163]
  s_add_u32 s24, s24, s23
  ds_read_b64_tr_b16 v[36:37], v13 offset:32768
  v_mul_f32 v19, s76, v19
  v_mul_f32 v20, s76, v20
  v_mfma_f32_16x16x32_bf16 v[176:179], v[84:87], v[240:243], v[176:179]
  s_lshl_b32 s26, s20, 12
  ds_read_b64_tr_b16 v[38:39], v13 offset:33792
  v_mul_f32 v21, s76, v21
  v_mul_f32 v22, s76, v22
  v_mfma_f32_16x16x32_bf16 v[192:195], v[88:91], v[240:243], v[192:195]
  s_mov_b32 s27, s26
  ds_read_b64_tr_b16 v[40:41], v12 offset:33024
  v_mul_f32 v23, s76, v23
  v_cvt_pk_bf16_f32 v24, v16, v17
  v_mfma_f32_16x16x32_bf16 v[208:211], v[92:95], v[240:243], v[208:211]
  s_add_u32 s25, s27, 49152
  ds_read_b64_tr_b16 v[42:43], v12 offset:34048
  v_cvt_pk_bf16_f32 v25, v18, v19
  v_cvt_pk_bf16_f32 v26, v20, v21
  v_cvt_pk_bf16_f32 v27, v22, v23
  v_mfma_f32_16x16x32_bf16 v[100:103], v[64:67], v[244:247], v[100:103]
  s_load_dwordx4 s[4:7], s[0:1], 64
  buffer_store_dwordx4 v[24:27], v2, s[40:43], s64 offen offset:2048 sc1
  v_accvgpr_read_b32 v16, a152
  v_accvgpr_read_b32 v17, a153
  v_mfma_f32_16x16x32_bf16 v[116:119], v[68:71], v[244:247], v[116:119]
  s_load_dwordx2 s[60:61], s[0:1], 80
  ds_read_b64_tr_b16 v[44:45], v13 offset:33024
  v_accvgpr_read_b32 v18, a154
  v_accvgpr_read_b32 v19, a155
  v_mfma_f32_16x16x32_bf16 v[132:135], v[72:75], v[244:247], v[132:135]
  s_add_u32 s23, s20, 1
  ds_read_b64_tr_b16 v[46:47], v13 offset:34048
  v_accvgpr_read_b32 v20, a156
  v_accvgpr_read_b32 v21, a157
  v_mfma_f32_16x16x32_bf16 v[148:151], v[76:79], v[244:247], v[148:151]
  s_lshr_b32 s23, s23, 1
  ds_read_b128 v[224:227], v14 offset:0
  v_accvgpr_read_b32 v22, a158
  v_accvgpr_read_b32 v23, a159
  v_mfma_f32_16x16x32_bf16 v[164:167], v[80:83], v[244:247], v[164:167]
  s_lshl_b32 s28, s22, 1
  ds_read_b128 v[228:231], v14 offset:1024
  v_mul_f32 v16, s76, v16
  v_mul_f32 v17, s76, v17
  v_mfma_f32_16x16x32_bf16 v[180:183], v[84:87], v[244:247], v[180:183]
  s_add_u32 s28, s28, s23
  v_mul_f32 v18, s76, v18
  v_mul_f32 v19, s76, v19
  v_mul_f32 v20, s76, v20
  v_mfma_f32_16x16x32_bf16 v[196:199], v[88:91], v[244:247], v[196:199]
  s_lshl_b32 s23, s22, 2
  ds_read_b64_tr_b16 v[48:49], v12 offset:33280
  v_mul_f32 v21, s76, v21
  v_mul_f32 v22, s76, v22
  v_mfma_f32_16x16x32_bf16 v[212:215], v[92:95], v[244:247], v[212:215]
  s_sub_u32 s29, 28, s23
  ds_read_b64_tr_b16 v[50:51], v12 offset:34304
  v_mul_f32 v23, s76, v23
  v_cvt_pk_bf16_f32 v28, v16, v17
  v_cvt_pk_bf16_f32 v29, v18, v19
  v_mfma_f32_16x16x32_bf16 v[104:107], v[64:67], v[248:251], v[104:107]
  s_and_b32 s23, s20, 1
  ds_read_b64_tr_b16 v[52:53], v13 offset:33280
  v_cvt_pk_bf16_f32 v30, v20, v21
  v_cvt_pk_bf16_f32 v31, v22, v23
  v_mfma_f32_16x16x32_bf16 v[120:123], v[68:71], v[248:251], v[120:123]
  s_add_u32 s29, s29, s23
  ds_read_b64_tr_b16 v[54:55], v13 offset:34304
  buffer_store_dwordx4 v[28:31], v2, s[40:43], s64 offen offset:3072 sc1
  v_accvgpr_read_b32 v16, a160
  v_mfma_f32_16x16x32_bf16 v[136:139], v[72:75], v[248:251], v[136:139]
  s_add_u32 s64, s64, 4096
  v_accvgpr_read_b32 v17, a161
  v_accvgpr_read_b32 v18, a162
  v_accvgpr_read_b32 v19, a163
  v_mfma_f32_16x16x32_bf16 v[152:155], v[76:79], v[248:251], v[152:155]
  ds_read_b64_tr_b16 v[56:57], v12 offset:33536
  v_accvgpr_read_b32 v20, a164
  v_accvgpr_read_b32 v21, a165
  v_mfma_f32_16x16x32_bf16 v[168:171], v[80:83], v[248:251], v[168:171]
  ds_read_b64_tr_b16 v[58:59], v12 offset:34560
  v_accvgpr_read_b32 v22, a166
  v_accvgpr_read_b32 v23, a167
  v_mfma_f32_16x16x32_bf16 v[184:187], v[84:87], v[248:251], v[184:187]
  ds_read_b64_tr_b16 v[60:61], v13 offset:33536
  v_mul_f32 v16, s76, v16
  v_mul_f32 v17, s76, v17
  v_mfma_f32_16x16x32_bf16 v[200:203], v[88:91], v[248:251], v[200:203]
  ds_read_b64_tr_b16 v[62:63], v13 offset:34560
  v_mul_f32 v18, s76, v18
  v_mul_f32 v19, s76, v19
  v_mul_f32 v20, s76, v20
  v_mfma_f32_16x16x32_bf16 v[216:219], v[92:95], v[248:251], v[216:219]
  v_mul_f32 v21, s76, v21
  v_mul_f32 v22, s76, v22
  v_mul_f32 v23, s76, v23
  v_mfma_f32_16x16x32_bf16 v[108:111], v[64:67], v[252:255], v[108:111]
  ds_read_b128 v[232:235], v14 offset:2048
  v_cvt_pk_bf16_f32 v24, v16, v17
  v_cvt_pk_bf16_f32 v25, v18, v19
  v_mfma_f32_16x16x32_bf16 v[124:127], v[68:71], v[252:255], v[124:127]
  ds_read_b128 v[236:239], v14 offset:3072
  v_cvt_pk_bf16_f32 v26, v20, v21
  v_cvt_pk_bf16_f32 v27, v22, v23
  v_mfma_f32_16x16x32_bf16 v[140:143], v[72:75], v[252:255], v[140:143]
  buffer_store_dwordx4 v[24:27], v2, s[40:43], s64 offen offset:0 sc1
  v_lshrrev_b32 v6, 2, v1
  v_mul_u32_u24 v6, 160, v6
  v_mfma_f32_16x16x32_bf16 v[156:159], v[76:79], v[252:255], v[156:159]
  v_and_b32 v9, 3, v1
  v_lshl_add_u32 v6, v9, 3, v6
  v_add_u32 v6, s34, v6
  v_mfma_f32_16x16x32_bf16 v[172:175], v[80:83], v[252:255], v[172:175]
  v_mov_b32 v3, v2
  v_mov_b32 v4, 0xff800000
  v_add_u32 v9, 106496, v2
  v_mfma_f32_16x16x32_bf16 v[188:191], v[84:87], v[252:255], v[188:191]
  v_mfma_f32_16x16x32_bf16 v[204:207], v[88:91], v[252:255], v[204:207]
  v_mfma_f32_16x16x32_bf16 v[220:223], v[92:95], v[252:255], v[220:223]
  s_waitcnt vmcnt(8) lgkmcnt(0)
  v_mfma_f32_16x16x32_bf16 v[96:99], v[32:35], v[224:227], v[96:99]
  v_accvgpr_read_b32 v16, a168
  v_accvgpr_read_b32 v17, a169
  v_accvgpr_read_b32 v18, a170
  v_mfma_f32_16x16x32_bf16 v[112:115], v[36:39], v[224:227], v[112:115]
  s_cmp_ge_u32 s20, 2
  s_cselect_b32 s4, s6, s4
  s_cselect_b32 s5, s7, s5
  ds_read_b64_tr_b16 v[64:65], v12 offset:40960
  v_accvgpr_read_b32 v19, a171
  v_accvgpr_read_b32 v20, a172
  v_mfma_f32_16x16x32_bf16 v[128:131], v[40:43], v[224:227], v[128:131]
  s_mov_b32 s62, 2211840
  ds_read_b64_tr_b16 v[66:67], v12 offset:41984
  v_accvgpr_read_b32 v21, a173
  v_accvgpr_read_b32 v22, a174
  v_mfma_f32_16x16x32_bf16 v[144:147], v[44:47], v[224:227], v[144:147]
  s_mov_b32 s63, 0x20000
  v_accvgpr_read_b32 v23, a175
  v_mul_f32 v16, s76, v16
  v_mul_f32 v17, s76, v17
  v_mfma_f32_16x16x32_bf16 v[160:163], v[48:51], v[224:227], v[160:163]
  s_mov_b64 s[56:57], s[52:53]
  ds_read_b64_tr_b16 v[68:69], v13 offset:40960
  v_mul_f32 v18, s76, v18
  v_mfma_f32_16x16x32_bf16 v[176:179], v[52:55], v[224:227], v[176:179]
  s_mov_b32 s58, s54
  ds_read_b64_tr_b16 v[70:71], v13 offset:41984
  v_mul_f32 v19, s76, v19
  v_mul_f32 v20, s76, v20
  v_mfma_f32_16x16x32_bf16 v[192:195], v[56:59], v[224:227], v[192:195]
  s_mov_b64 s[52:53], s[4:5]
  ds_read_b64_tr_b16 v[72:73], v12 offset:41216
  v_mul_f32 v21, s76, v21
  v_mul_f32 v22, s76, v22
  v_mfma_f32_16x16x32_bf16 v[208:211], v[60:63], v[224:227], v[208:211]
  s_mov_b32 s54, 2211840
  ds_read_b64_tr_b16 v[74:75], v12 offset:42240
  v_mul_f32 v23, s76, v23
  v_cvt_pk_bf16_f32 v28, v16, v17
  v_mfma_f32_16x16x32_bf16 v[100:103], v[32:35], v[228:231], v[100:103]
  s_getpc_b64 s[36:37]
fa_copc:
  v_cvt_pk_bf16_f32 v29, v18, v19
  v_cvt_pk_bf16_f32 v30, v20, v21
  v_cvt_pk_bf16_f32 v31, v22, v23
  v_mfma_f32_16x16x32_bf16 v[116:119], v[36:39], v[228:231], v[116:119]
  s_add_u32 s36, s36, fa_co-fa_copc-4
  s_addc_u32 s37, s37, 0
  ds_read_b64_tr_b16 v[76:77], v13 offset:41216
  buffer_store_dwordx4 v[28:31], v2, s[40:43], s64 offen offset:1024 sc1
  v_mfma_f32_16x16x32_bf16 v[132:135], v[40:43], v[228:231], v[132:135]
  ds_read_b64_tr_b16 v[78:79], v13 offset:42240
  v_accvgpr_read_b32 v16, a176
  v_accvgpr_read_b32 v17, a177
  v_mfma_f32_16x16x32_bf16 v[148:151], v[44:47], v[228:231], v[148:151]
  ds_read_b128 v[240:243], v14 offset:32768
  v_accvgpr_read_b32 v18, a178
  v_accvgpr_read_b32 v19, a179
  v_mfma_f32_16x16x32_bf16 v[164:167], v[48:51], v[228:231], v[164:167]
  ds_read_b128 v[244:247], v14 offset:33792
  v_accvgpr_read_b32 v20, a180
  v_accvgpr_read_b32 v21, a181
  v_mfma_f32_16x16x32_bf16 v[180:183], v[52:55], v[228:231], v[180:183]
  v_accvgpr_read_b32 v22, a182
  v_accvgpr_read_b32 v23, a183
  v_mul_f32 v16, s76, v16
  v_mfma_f32_16x16x32_bf16 v[196:199], v[56:59], v[228:231], v[196:199]
  ds_read_b64_tr_b16 v[80:81], v12 offset:41472
  v_mul_f32 v17, s76, v17
  v_mfma_f32_16x16x32_bf16 v[212:215], v[60:63], v[228:231], v[212:215]
  ds_read_b64_tr_b16 v[82:83], v12 offset:42496
  v_mul_f32 v18, s76, v18
  v_mul_f32 v19, s76, v19
  v_mfma_f32_16x16x32_bf16 v[104:107], v[32:35], v[232:235], v[104:107]
  ds_read_b64_tr_b16 v[84:85], v13 offset:41472
  v_mul_f32 v20, s76, v20
  v_mul_f32 v21, s76, v21
  v_mfma_f32_16x16x32_bf16 v[120:123], v[36:39], v[232:235], v[120:123]
  ds_read_b64_tr_b16 v[86:87], v13 offset:42496
  v_mul_f32 v22, s76, v22
  v_mul_f32 v23, s76, v23
  v_mfma_f32_16x16x32_bf16 v[136:139], v[40:43], v[232:235], v[136:139]
  v_cvt_pk_bf16_f32 v24, v16, v17
  v_cvt_pk_bf16_f32 v25, v18, v19
  v_cvt_pk_bf16_f32 v26, v20, v21
  v_mfma_f32_16x16x32_bf16 v[152:155], v[44:47], v[232:235], v[152:155]
  ds_read_b64_tr_b16 v[88:89], v12 offset:41728
  v_cvt_pk_bf16_f32 v27, v22, v23
  v_mfma_f32_16x16x32_bf16 v[168:171], v[48:51], v[232:235], v[168:171]
  ds_read_b64_tr_b16 v[90:91], v12 offset:42752
  buffer_store_dwordx4 v[24:27], v2, s[40:43], s64 offen offset:2048 sc1
  v_accvgpr_read_b32 v16, a184
  v_mfma_f32_16x16x32_bf16 v[184:187], v[52:55], v[232:235], v[184:187]
  ds_read_b64_tr_b16 v[92:93], v13 offset:41728
  v_accvgpr_read_b32 v17, a185
  v_accvgpr_read_b32 v18, a186
  v_mfma_f32_16x16x32_bf16 v[200:203], v[56:59], v[232:235], v[200:203]
  ds_read_b64_tr_b16 v[94:95], v13 offset:42752
  v_accvgpr_read_b32 v19, a187
  v_accvgpr_read_b32 v20, a188
  v_mfma_f32_16x16x32_bf16 v[216:219], v[60:63], v[232:235], v[216:219]
  v_accvgpr_read_b32 v21, a189
  v_accvgpr_read_b32 v22, a190
  v_accvgpr_read_b32 v23, a191
  v_mfma_f32_16x16x32_bf16 v[108:111], v[32:35], v[236:239], v[108:111]
  ds_read_b128 v[248:251], v14 offset:34816
  v_mul_f32 v16, s76, v16
  v_mfma_f32_16x16x32_bf16 v[124:127], v[36:39], v[236:239], v[124:127]
  ds_read_b128 v[252:255], v14 offset:35840
  v_mul_f32 v17, s76, v17
  v_mul_f32 v18, s76, v18
  v_mfma_f32_16x16x32_bf16 v[140:143], v[40:43], v[236:239], v[140:143]
  v_mul_f32 v19, s76, v19
  v_mul_f32 v20, s76, v20
  v_mul_f32 v21, s76, v21
  v_mfma_f32_16x16x32_bf16 v[156:159], v[44:47], v[236:239], v[156:159]
  v_xor_b32 v14, 0x10000, v14
  v_mul_f32 v22, s76, v22
  v_mul_f32 v23, s76, v23
  v_mfma_f32_16x16x32_bf16 v[172:175], v[48:51], v[236:239], v[172:175]
  v_cvt_pk_bf16_f32 v28, v16, v17
  v_cvt_pk_bf16_f32 v29, v18, v19
  v_cvt_pk_bf16_f32 v30, v20, v21
  v_mfma_f32_16x16x32_bf16 v[188:191], v[52:55], v[236:239], v[188:191]
  v_xor_b32 v12, 0x10000, v12
  v_cvt_pk_bf16_f32 v31, v22, v23
  v_mfma_f32_16x16x32_bf16 v[204:207], v[56:59], v[236:239], v[204:207]
  buffer_store_dwordx4 v[28:31], v2, s[40:43], s64 offen offset:3072 sc1
  v_xor_b32 v13, 0x10000, v13
  v_mfma_f32_16x16x32_bf16 v[220:223], v[60:63], v[236:239], v[220:223]
  s_waitcnt vmcnt(9) lgkmcnt(0)
  v_mfma_f32_16x16x32_bf16 v[96:99], v[64:67], v[240:243], v[96:99]
  s_barrier
  v_cmp_eq_u32 vcc, 0, v15
  v_mfma_f32_16x16x32_bf16 v[112:115], v[68:71], v[240:243], v[112:115]
  s_cbranch_vccnz fa_kv_spin
fa_kv_ok:
  v_mfma_f32_16x16x32_bf16 v[128:131], v[72:75], v[240:243], v[128:131]
  s_mov_b32 m0, s24
  v_mov_b32 v228, 0
  v_mfma_f32_16x16x32_bf16 v[144:147], v[76:79], v[240:243], v[144:147]
  buffer_load_dwordx4 v2, s[44:47], s26 offen offset:0 sc1 lds
  v_mfma_f32_16x16x32_bf16 v[160:163], v[80:83], v[240:243], v[160:163]
  s_add_u32 s24, s24, 32768
  v_mov_b32 v229, 0
  v_mfma_f32_16x16x32_bf16 v[176:179], v[84:87], v[240:243], v[176:179]
  s_and_b32 s24, s24, 0x1ffff
  buffer_load_dwordx4 v2, s[44:47], s26 offen offset:1024 sc1 lds
  v_mfma_f32_16x16x32_bf16 v[192:195], v[88:91], v[240:243], v[192:195]
  v_mov_b32 v230, 0
  v_mfma_f32_16x16x32_bf16 v[208:211], v[92:95], v[240:243], v[208:211]
  buffer_load_dwordx4 v2, s[44:47], s26 offen offset:2048 sc1 lds
  v_mfma_f32_16x16x32_bf16 v[100:103], v[64:67], v[244:247], v[100:103]
  v_mov_b32 v231, 0
  v_mfma_f32_16x16x32_bf16 v[116:119], v[68:71], v[244:247], v[116:119]
  buffer_load_dwordx4 v2, s[44:47], s26 offen offset:3072 sc1 lds
  v_mfma_f32_16x16x32_bf16 v[132:135], v[72:75], v[244:247], v[132:135]
  s_add_u32 s26, s26, 16384
  v_cvt_pk_bf16_f32 v32, v96, v97
  v_cvt_pk_bf16_f32 v33, v98, v99
  v_mfma_f32_16x16x32_bf16 v[148:151], v[76:79], v[244:247], v[148:151]
  v_cvt_pk_bf16_f32 v34, v112, v113
  v_cvt_pk_bf16_f32 v35, v114, v115
  v_mfma_f32_16x16x32_bf16 v[164:167], v[80:83], v[244:247], v[164:167]
  s_mov_b32 m0, s24
  v_cvt_pk_bf16_f32 v40, v128, v129
  v_mfma_f32_16x16x32_bf16 v[180:183], v[84:87], v[244:247], v[180:183]
  buffer_load_dwordx4 v2, s[44:47], s26 offen offset:0 sc1 lds
  v_cvt_pk_bf16_f32 v41, v130, v131
  v_cvt_pk_bf16_f32 v42, v144, v145
  v_mfma_f32_16x16x32_bf16 v[196:199], v[88:91], v[244:247], v[196:199]
  s_add_u32 s24, s24, 32768
  v_cvt_pk_bf16_f32 v43, v146, v147
  v_mfma_f32_16x16x32_bf16 v[212:215], v[92:95], v[244:247], v[212:215]
  s_and_b32 s24, s24, 0x1ffff
  buffer_load_dwordx4 v2, s[44:47], s26 offen offset:1024 sc1 lds
  v_cvt_pk_bf16_f32 v48, v160, v161
  v_cvt_pk_bf16_f32 v49, v162, v163
  v_mfma_f32_16x16x32_bf16 v[104:107], v[64:67], v[248:251], v[104:107]
  v_cvt_pk_bf16_f32 v50, v176, v177
  v_cvt_pk_bf16_f32 v51, v178, v179
  v_mfma_f32_16x16x32_bf16 v[120:123], v[68:71], v[248:251], v[120:123]
  buffer_load_dwordx4 v2, s[44:47], s26 offen offset:2048 sc1 lds
  v_cvt_pk_bf16_f32 v56, v192, v193
  v_mfma_f32_16x16x32_bf16 v[136:139], v[72:75], v[248:251], v[136:139]
  v_cvt_pk_bf16_f32 v57, v194, v195
  v_cvt_pk_bf16_f32 v58, v208, v209
  v_mfma_f32_16x16x32_bf16 v[152:155], v[76:79], v[248:251], v[152:155]
  buffer_load_dwordx4 v2, s[44:47], s26 offen offset:3072 sc1 lds
  v_cvt_pk_bf16_f32 v59, v210, v211
  v_mfma_f32_16x16x32_bf16 v[168:171], v[80:83], v[248:251], v[168:171]
  s_add_u32 s26, s26, 16384
  v_cvt_pk_bf16_f32 v36, v100, v101
  v_cvt_pk_bf16_f32 v37, v102, v103
  v_mfma_f32_16x16x32_bf16 v[184:187], v[84:87], v[248:251], v[184:187]
  v_cvt_pk_bf16_f32 v38, v116, v117
  v_mfma_f32_16x16x32_bf16 v[200:203], v[88:91], v[248:251], v[200:203]
  s_mov_b32 m0, s24
  v_cvt_pk_bf16_f32 v39, v118, v119
  v_cvt_pk_bf16_f32 v44, v132, v133
  v_mfma_f32_16x16x32_bf16 v[216:219], v[92:95], v[248:251], v[216:219]
  buffer_load_dwordx4 v2, s[44:47], s26 offen offset:0 sc1 lds
  v_cvt_pk_bf16_f32 v45, v134, v135
  v_mfma_f32_16x16x32_bf16 v[108:111], v[64:67], v[252:255], v[108:111]
  s_add_u32 s24, s24, 32768
  v_cvt_pk_bf16_f32 v46, v148, v149
  v_cvt_pk_bf16_f32 v47, v150, v151
  v_mfma_f32_16x16x32_bf16 v[124:127], v[68:71], v[252:255], v[124:127]
  s_and_b32 s24, s24, 0x1ffff
  buffer_load_dwordx4 v2, s[44:47], s26 offen offset:1024 sc1 lds
  v_cvt_pk_bf16_f32 v52, v164, v165
  v_mfma_f32_16x16x32_bf16 v[140:143], v[72:75], v[252:255], v[140:143]
  v_cvt_pk_bf16_f32 v53, v166, v167
  v_cvt_pk_bf16_f32 v54, v180, v181
  v_mfma_f32_16x16x32_bf16 v[156:159], v[76:79], v[252:255], v[156:159]
  buffer_load_dwordx4 v2, s[44:47], s26 offen offset:2048 sc1 lds
  v_cvt_pk_bf16_f32 v55, v182, v183
  v_mfma_f32_16x16x32_bf16 v[172:175], v[80:83], v[252:255], v[172:175]
  v_cvt_pk_bf16_f32 v60, v196, v197
  v_cvt_pk_bf16_f32 v61, v198, v199
  v_mfma_f32_16x16x32_bf16 v[188:191], v[84:87], v[252:255], v[188:191]
  buffer_load_dwordx4 v2, s[44:47], s26 offen offset:3072 sc1 lds
  v_cvt_pk_bf16_f32 v62, v212, v213
  v_mfma_f32_16x16x32_bf16 v[204:207], v[88:91], v[252:255], v[204:207]
  s_add_u32 s26, s26, 16384
  v_cvt_pk_bf16_f32 v63, v214, v215
  v_mfma_f32_16x16x32_bf16 v[220:223], v[92:95], v[252:255], v[220:223]
  s_mov_b32 m0, s25
  s_nop 0
  v_mfma_f32_32x32x16_bf16 a[0:15], v[228:231], v[228:231], 0
  buffer_load_dwordx4 v2, s[48:51], s27 offen offset:0 sc1 lds
  v_cvt_pk_bf16_f32 v64, v104, v105
  v_cvt_pk_bf16_f32 v65, v106, v107
  v_cvt_pk_bf16_f32 v66, v120, v121
  v_cvt_pk_bf16_f32 v67, v122, v123
  v_mfma_f32_32x32x16_bf16 a[16:31], v[228:231], v[228:231], 0
  buffer_load_dwordx4 v2, s[48:51], s27 offen offset:1024 sc1 lds
  v_cvt_pk_bf16_f32 v72, v136, v137
  v_cvt_pk_bf16_f32 v73, v138, v139
  v_cvt_pk_bf16_f32 v74, v152, v153
  v_cvt_pk_bf16_f32 v75, v154, v155
  v_mfma_f32_32x32x16_bf16 a[32:47], v[228:231], v[228:231], 0
  buffer_load_dwordx4 v2, s[48:51], s27 offen offset:2048 sc1 lds
  v_cvt_pk_bf16_f32 v80, v168, v169
  v_cvt_pk_bf16_f32 v81, v170, v171
  v_cvt_pk_bf16_f32 v82, v184, v185
  v_cvt_pk_bf16_f32 v83, v186, v187
  v_mfma_f32_32x32x16_bf16 a[48:63], v[228:231], v[228:231], 0
  buffer_load_dwordx4 v2, s[48:51], s27 offen offset:3072 sc1 lds
  v_cvt_pk_bf16_f32 v88, v200, v201
  v_cvt_pk_bf16_f32 v89, v202, v203
  v_cvt_pk_bf16_f32 v90, v216, v217
  v_cvt_pk_bf16_f32 v91, v218, v219
  s_add_u32 s27, s27, 16384
  s_add_u32 s25, s25, 32768
  s_and_b32 s25, s25, 0x1ffff
  s_mov_b32 m0, s25
  s_nop 0
  v_mfma_f32_32x32x16_bf16 a[64:79], v[228:231], v[228:231], 0
  buffer_load_dwordx4 v2, s[48:51], s27 offen offset:0 sc1 lds
  v_cvt_pk_bf16_f32 v68, v108, v109
  v_cvt_pk_bf16_f32 v69, v110, v111
  v_cvt_pk_bf16_f32 v70, v124, v125
  v_cvt_pk_bf16_f32 v71, v126, v127
  v_mfma_f32_32x32x16_bf16 a[80:95], v[228:231], v[228:231], 0
  buffer_load_dwordx4 v2, s[48:51], s27 offen offset:1024 sc1 lds
  v_cvt_pk_bf16_f32 v76, v140, v141
  v_cvt_pk_bf16_f32 v77, v142, v143
  v_cvt_pk_bf16_f32 v78, v156, v157
  v_cvt_pk_bf16_f32 v79, v158, v159
  v_mfma_f32_32x32x16_bf16 a[96:111], v[228:231], v[228:231], 0
  buffer_load_dwordx4 v2, s[48:51], s27 offen offset:2048 sc1 lds
  v_cvt_pk_bf16_f32 v84, v172, v173
  v_cvt_pk_bf16_f32 v85, v174, v175
  v_cvt_pk_bf16_f32 v86, v188, v189
  v_cvt_pk_bf16_f32 v87, v190, v191
  v_mfma_f32_32x32x16_bf16 a[112:127], v[228:231], v[228:231], 0
  buffer_load_dwordx4 v2, s[48:51], s27 offen offset:3072 sc1 lds
  v_cvt_pk_bf16_f32 v92, v204, v205
  v_cvt_pk_bf16_f32 v93, v206, v207
  v_cvt_pk_bf16_f32 v94, v220, v221
  v_cvt_pk_bf16_f32 v95, v222, v223
  s_add_u32 s27, s27, 16384
  s_add_u32 s25, s25, 32768
  s_and_b32 s25, s25, 0x1ffff
  s_waitcnt vmcnt(12)
  s_barrier
  ds_read_b128 a[128:131], v9 offset:0
  ds_read_b128 a[132:135], v9 offset:1024
  ds_read_b128 a[136:139], v9 offset:2048
  ds_read_b128 a[140:143], v9 offset:3072
  ds_read_b128 a[144:147], v9 offset:4096
  ds_read_b128 a[148:151], v9 offset:5120
  ds_read_b128 a[152:155], v9 offset:6144
  ds_read_b128 a[156:159], v9 offset:7168
  buffer_store_dword v4, off, s[40:43], s65 offset:32 sc1
  v_add_u32 v13, 32, v8
  v_mov_b32 v14, 0
  s_cmp_eq_u32 s2, 255
  s_cbranch_scc1 fa_top8
fa_notop:
  s_waitcnt lgkmcnt(4)
  v_mfma_f32_16x16x32_bf16 v[96:99], a[128:131], v[32:35], 0
  v_mfma_f32_16x16x32_bf16 v[104:107], a[128:131], v[36:39], 0
  v_mfma_f32_16x16x32_bf16 v[128:131], a[128:131], v[64:67], 0
  v_mfma_f32_16x16x32_bf16 v[136:139], a[128:131], v[68:71], 0
  s_mov_b32 m0, s24
  ds_read_b128 a[128:131], v3 offset:0
  v_mfma_f32_16x16x32_bf16 v[100:103], a[132:135], v[32:35], 0
  buffer_load_dwordx4 v2, s[44:47], s26 offen offset:0 sc1 lds
  v_mfma_f32_16x16x32_bf16 v[108:111], a[132:135], v[36:39], 0
  v_mfma_f32_16x16x32_bf16 v[132:135], a[132:135], v[64:67], 0
  v_mfma_f32_16x16x32_bf16 v[140:143], a[132:135], v[68:71], 0
  ds_read_b128 a[132:135], v3 offset:1024
  v_mfma_f32_16x16x32_bf16 v[96:99], a[136:139], v[40:43], v[96:99]
  v_mfma_f32_16x16x32_bf16 v[104:107], a[136:139], v[44:47], v[104:107]
  v_mfma_f32_16x16x32_bf16 v[128:131], a[136:139], v[72:75], v[128:131]
  buffer_load_dwordx4 v2, s[44:47], s26 offen offset:1024 sc1 lds
  v_mfma_f32_16x16x32_bf16 v[136:139], a[136:139], v[76:79], v[136:139]
  ds_read_b128 a[136:139], v3 offset:2048
  v_mfma_f32_16x16x32_bf16 v[100:103], a[140:143], v[40:43], v[100:103]
  v_mfma_f32_16x16x32_bf16 v[108:111], a[140:143], v[44:47], v[108:111]
  v_mfma_f32_16x16x32_bf16 v[132:135], a[140:143], v[72:75], v[132:135]
  v_mfma_f32_16x16x32_bf16 v[140:143], a[140:143], v[76:79], v[140:143]
  s_waitcnt lgkmcnt(3)
  ds_read_b128 a[140:143], v3 offset:3072
  v_mfma_f32_16x16x32_bf16 v[96:99], a[144:147], v[48:51], v[96:99]
  v_mfma_f32_16x16x32_bf16 v[104:107], a[144:147], v[52:55], v[104:107]
  v_mfma_f32_16x16x32_bf16 v[128:131], a[144:147], v[80:83], v[128:131]
  buffer_load_dwordx4 v2, s[44:47], s26 offen offset:2048 sc1 lds
  v_mfma_f32_16x16x32_bf16 v[136:139], a[144:147], v[84:87], v[136:139]
  ds_read_b128 a[144:147], v3 offset:4096
  v_mfma_f32_16x16x32_bf16 v[100:103], a[148:151], v[48:51], v[100:103]
  v_mfma_f32_16x16x32_bf16 v[108:111], a[148:151], v[52:55], v[108:111]
  v_mfma_f32_16x16x32_bf16 v[132:135], a[148:151], v[80:83], v[132:135]
  v_mfma_f32_16x16x32_bf16 v[140:143], a[148:151], v[84:87], v[140:143]
  ds_read_b128 a[148:151], v3 offset:5120
  v_mfma_f32_16x16x32_bf16 v[96:99], a[152:155], v[56:59], v[96:99]
  buffer_load_dwordx4 v2, s[44:47], s26 offen offset:3072 sc1 lds
  v_mfma_f32_16x16x32_bf16 v[104:107], a[152:155], v[60:63], v[104:107]
  s_add_u32 s26, s26, 16384
  v_mfma_f32_16x16x32_bf16 v[128:131], a[152:155], v[88:91], v[128:131]
  s_add_u32 s24, s24, 32768
  v_mfma_f32_16x16x32_bf16 v[136:139], a[152:155], v[92:95], v[136:139]
  s_and_b32 s24, s24, 0x1ffff
  ds_read_b128 a[152:155], v3 offset:6144
  v_mfma_f32_16x16x32_bf16 v[100:103], a[156:159], v[56:59], v[100:103]
  v_mfma_f32_16x16x32_bf16 v[108:111], a[156:159], v[60:63], v[108:111]
  v_mfma_f32_16x16x32_bf16 v[132:135], a[156:159], v[88:91], v[132:135]
  v_mfma_f32_16x16x32_bf16 v[140:143], a[156:159], v[92:95], v[140:143]
  s_waitcnt lgkmcnt(3)
  ds_read_b128 a[156:159], v3 offset:7168
  s_nop 7
  s_cmp_lg_u32 s28, 0
  s_cbranch_scc1 fa_nomask0
  v_cndmask_b32 v96, v4, v96, s[68:69]
  v_cndmask_b32 v97, v4, v97, s[70:71]
  v_cndmask_b32 v98, v4, v98, s[72:73]
  v_cndmask_b32 v99, v4, v99, s[74:75]
  v_mov_b32 v100, v4
  v_mov_b32 v101, v4
  v_mov_b32 v102, v4
  v_mov_b32 v103, v4
  v_cndmask_b32 v108, v4, v108, s[68:69]
  v_cndmask_b32 v109, v4, v109, s[70:71]
  v_cndmask_b32 v110, v4, v110, s[72:73]
  v_cndmask_b32 v111, v4, v111, s[74:75]
fa_nomask0:
  v_max3_f32 v16, v96, v97, v98
  v_max3_f32 v16, v16, v99, v100
  v_max3_f32 v16, v16, v101, v102
  v_max_f32 v16, v16, v103
  v_max3_f32 v17, v104, v105, v106
  v_max3_f32 v17, v17, v107, v108
  v_max3_f32 v17, v17, v109, v110
  v_max_f32 v17, v17, v111
  v_max3_f32 v18, v128, v129, v130
  v_max3_f32 v18, v18, v131, v132
  v_max3_f32 v18, v18, v133, v134
  v_max_f32 v18, v18, v135
  v_max3_f32 v19, v136, v137, v138
  v_max3_f32 v19, v19, v139, v140
  v_max3_f32 v19, v19, v141, v142
  v_max_f32 v19, v19, v143
  v_mov_b32 v20, v16
  v_mov_b32 v21, v17
  v_mov_b32 v22, v18
  v_mov_b32 v23, v19
  s_nop 0
  v_permlane16_swap_b32 v16, v20
  v_permlane16_swap_b32 v17, v21
  v_permlane16_swap_b32 v18, v22
  v_permlane16_swap_b32 v19, v23
  v_max_f32 v16, v16, v20
  v_max_f32 v17, v17, v21
  v_max_f32 v18, v18, v22
  v_max_f32 v19, v19, v23
  v_mov_b32 v20, v16
  v_mov_b32 v21, v17
  v_mov_b32 v22, v18
  v_mov_b32 v23, v19
  s_nop 0
  v_permlane32_swap_b32 v16, v20
  v_permlane32_swap_b32 v17, v21
  v_permlane32_swap_b32 v18, v22
  v_permlane32_swap_b32 v19, v23
  v_max_f32 v16, v16, v20
  v_max_f32 v17, v17, v21
  v_max_f32 v18, v18, v22
  v_max_f32 v19, v19, v23
  v_sub_f32 v192, 0, v16
  v_sub_f32 v193, 0, v16
  v_sub_f32 v194, 0, v16
  v_sub_f32 v195, 0, v16
  v_sub_f32 v196, 0, v17
  v_sub_f32 v197, 0, v17
  v_sub_f32 v198, 0, v17
  v_sub_f32 v199, 0, v17
  v_sub_f32 v200, 0, v18
  v_sub_f32 v201, 0, v18
  v_sub_f32 v202, 0, v18
  v_sub_f32 v203, 0, v18
  v_sub_f32 v204, 0, v19
  v_sub_f32 v205, 0, v19
  v_sub_f32 v206, 0, v19
  v_sub_f32 v207, 0, v19
  v_sub_f32 v96, v96, v16
  v_sub_f32 v97, v97, v16
  v_sub_f32 v98, v98, v16
  v_sub_f32 v99, v99, v16
  v_sub_f32 v100, v100, v16
  v_sub_f32 v101, v101, v16
  v_sub_f32 v102, v102, v16
  v_sub_f32 v103, v103, v16
  v_sub_f32 v104, v104, v17
  v_sub_f32 v105, v105, v17
  v_sub_f32 v106, v106, v17
  v_sub_f32 v107, v107, v17
  v_sub_f32 v108, v108, v17
  v_sub_f32 v109, v109, v17
  v_sub_f32 v110, v110, v17
  v_sub_f32 v111, v111, v17
  v_sub_f32 v128, v128, v18
  v_sub_f32 v129, v129, v18
  v_sub_f32 v130, v130, v18
  v_sub_f32 v131, v131, v18
  v_sub_f32 v132, v132, v18
  v_sub_f32 v133, v133, v18
  v_sub_f32 v134, v134, v18
  v_sub_f32 v135, v135, v18
  v_sub_f32 v136, v136, v19
  v_sub_f32 v137, v137, v19
  v_sub_f32 v138, v138, v19
  v_sub_f32 v139, v139, v19
  v_sub_f32 v140, v140, v19
  v_sub_f32 v141, v141, v19
  v_sub_f32 v142, v142, v19
  v_sub_f32 v143, v143, v19
  v_mfma_f32_16x16x32_bf16 v[112:115], a[128:131], v[32:35], v[192:195]
  v_exp_f32 v216, v128
  v_exp_f32 v217, v129
  v_mfma_f32_16x16x32_bf16 v[120:123], a[128:131], v[36:39], v[196:199]
  v_exp_f32 v218, v130
  v_add_f32 v226, v216, v217
  v_cvt_pk_bf16_f32 v176, v216, v217
  v_mfma_f32_16x16x32_bf16 v[144:147], a[128:131], v[64:67], v[200:203]
  s_add_u32 s66, s66, 32768
  v_exp_f32 v219, v131
  v_add_f32 v226, v226, v218
  v_add_f32 v226, v226, v219
  v_mfma_f32_16x16x32_bf16 v[152:155], a[128:131], v[68:71], v[204:207]
  s_mov_b32 m0, s25
  ds_read_b128 a[128:131], v3 offset:8192
  v_exp_f32 v220, v132
  v_cvt_pk_bf16_f32 v177, v218, v219
  v_mfma_f32_16x16x32_bf16 v[116:119], a[132:135], v[32:35], v[192:195]
  s_and_b32 s66, s66, 0x1ffff
  buffer_load_dwordx4 v2, s[48:51], s27 offen offset:0 sc1 lds
  v_exp_f32 v221, v133
  v_add_f32 v226, v226, v220
  v_add_f32 v226, v226, v221
  v_mfma_f32_16x16x32_bf16 v[124:127], a[132:135], v[36:39], v[196:199]
  v_exp_f32 v222, v134
  v_cvt_pk_bf16_f32 v178, v220, v221
  v_exp_f32 v223, v135
  v_mfma_f32_16x16x32_bf16 v[148:151], a[132:135], v[64:67], v[200:203]
  v_exp_f32 v216, v136
  v_add_f32 v226, v226, v222
  v_mfma_f32_16x16x32_bf16 v[156:159], a[132:135], v[68:71], v[204:207]
  ds_read_b128 a[132:135], v3 offset:9216
  v_exp_f32 v217, v137
  v_add_f32 v226, v226, v223
  v_mfma_f32_16x16x32_bf16 v[112:115], a[136:139], v[40:43], v[112:115]
  v_exp_f32 v218, v138
  v_cvt_pk_bf16_f32 v179, v222, v223
  v_add_f32 v227, v216, v217
  v_mfma_f32_16x16x32_bf16 v[120:123], a[136:139], v[44:47], v[120:123]
  v_exp_f32 v219, v139
  v_cvt_pk_bf16_f32 v180, v216, v217
  v_add_f32 v227, v227, v218
  v_add_f32 v227, v227, v219
  v_mfma_f32_16x16x32_bf16 v[144:147], a[136:139], v[72:75], v[144:147]
  buffer_load_dwordx4 v2, s[48:51], s27 offen offset:1024 sc1 lds
  v_exp_f32 v220, v140
  v_cvt_pk_bf16_f32 v181, v218, v219
  v_mfma_f32_16x16x32_bf16 v[152:155], a[136:139], v[76:79], v[152:155]
  ds_read_b128 a[136:139], v3 offset:10240
  v_exp_f32 v221, v141
  v_add_f32 v227, v227, v220
  v_mfma_f32_16x16x32_bf16 v[116:119], a[140:143], v[40:43], v[116:119]
  v_exp_f32 v222, v142
  v_add_f32 v227, v227, v221
  v_cvt_pk_bf16_f32 v182, v220, v221
  v_mfma_f32_16x16x32_bf16 v[124:127], a[140:143], v[44:47], v[124:127]
  v_exp_f32 v223, v143
  v_add_f32 v227, v227, v222
  v_add_f32 v227, v227, v223
  v_exp_f32 v208, v96
  v_mfma_f32_16x16x32_bf16 v[148:151], a[140:143], v[72:75], v[148:151]
  v_exp_f32 v209, v97
  v_cvt_pk_bf16_f32 v183, v222, v223
  v_mfma_f32_16x16x32_bf16 v[156:159], a[140:143], v[76:79], v[156:159]
  s_waitcnt lgkmcnt(3)
  ds_read_b128 a[140:143], v3 offset:11264
  v_exp_f32 v210, v98
  v_add_f32 v224, v208, v209
  v_mfma_f32_16x16x32_bf16 v[112:115], a[144:147], v[48:51], v[112:115]
  v_exp_f32 v211, v99
  v_cvt_pk_bf16_f32 v160, v208, v209
  v_add_f32 v224, v224, v210
  v_mfma_f32_16x16x32_bf16 v[120:123], a[144:147], v[52:55], v[120:123]
  v_exp_f32 v212, v100
  v_add_f32 v224, v224, v211
  v_cvt_pk_bf16_f32 v161, v210, v211
  v_mfma_f32_16x16x32_bf16 v[144:147], a[144:147], v[80:83], v[144:147]
  buffer_load_dwordx4 v2, s[48:51], s27 offen offset:2048 sc1 lds
  v_exp_f32 v213, v101
  v_add_f32 v224, v224, v212
  v_add_f32 v224, v224, v213
  v_mfma_f32_16x16x32_bf16 v[152:155], a[144:147], v[84:87], v[152:155]
  ds_read_b128 a[144:147], v3 offset:12288
  v_exp_f32 v214, v102
  v_cvt_pk_bf16_f32 v162, v212, v213
  v_mfma_f32_16x16x32_bf16 v[116:119], a[148:151], v[48:51], v[116:119]
  v_exp_f32 v215, v103
  v_add_f32 v224, v224, v214
  v_add_f32 v224, v224, v215
  v_mfma_f32_16x16x32_bf16 v[124:127], a[148:151], v[52:55], v[124:127]
  v_exp_f32 v208, v104
  v_exp_f32 v209, v105
  v_mfma_f32_16x16x32_bf16 v[148:151], a[148:151], v[80:83], v[148:151]
  v_exp_f32 v210, v106
  v_cvt_pk_bf16_f32 v163, v214, v215
  v_add_f32 v225, v208, v209
  v_mfma_f32_16x16x32_bf16 v[156:159], a[148:151], v[84:87], v[156:159]
  ds_read_b128 a[148:151], v3 offset:13312
  v_exp_f32 v211, v107
  v_cvt_pk_bf16_f32 v164, v208, v209
  v_add_f32 v225, v225, v210
  v_mfma_f32_16x16x32_bf16 v[112:115], a[152:155], v[56:59], v[112:115]
  buffer_load_dwordx4 v2, s[48:51], s27 offen offset:3072 sc1 lds
  v_exp_f32 v212, v108
  v_add_f32 v225, v225, v211
  v_mfma_f32_16x16x32_bf16 v[120:123], a[152:155], v[60:63], v[120:123]
  s_add_u32 s27, s27, 16384
  v_exp_f32 v213, v109
  v_mfma_f32_16x16x32_bf16 v[144:147], a[152:155], v[88:91], v[144:147]
  s_add_u32 s25, s25, 32768
  v_exp_f32 v214, v110
  v_mfma_f32_16x16x32_bf16 v[152:155], a[152:155], v[92:95], v[152:155]
  s_and_b32 s25, s25, 0x1ffff
  ds_read_b128 a[152:155], v3 offset:14336
  v_cvt_pk_bf16_f32 v165, v210, v211
  v_max3_f32 v5, v226, v227, v224
  v_add_f32 v225, v225, v212
  v_add_f32 v225, v225, v213
  v_cvt_pk_bf16_f32 v166, v212, v213
  v_exp_f32 v215, v111
  v_mfma_f32_16x16x32_bf16 v[116:119], a[156:159], v[56:59], v[116:119]
  v_add_f32 v225, v225, v214
  v_add_f32 v225, v225, v215
  v_max_f32 v5, v5, v225
  v_cmp_lt_f32 vcc, s81, v5
  v_mfma_f32_16x16x32_bf16 v[124:127], a[156:159], v[60:63], v[124:127]
  v_mfma_f32_16x16x32_bf16 v[148:151], a[156:159], v[88:91], v[148:151]
  v_cvt_pk_bf16_f32 v167, v214, v215
  v_mfma_f32_16x16x32_bf16 v[156:159], a[156:159], v[92:95], v[156:159]
  s_waitcnt lgkmcnt(3)
  s_cbranch_vccnz fa_stub0
fa_back0:
  ds_read_b128 a[156:159], v3 offset:15360
  v_add_f32 v228, v228, v224
  v_add_f32 v229, v229, v225
  v_add_f32 v230, v230, v226
  v_add_f32 v231, v231, v227
  s_nop 3
  v_exp_f32 v216, v144
  v_exp_f32 v217, v145
  v_add_u32 v3, s66, v2
  buffer_load_dword v14, v13, s[40:43], 0 offen sc1
  s_cmp_eq_u32 s28, 0
  s_cbranch_scc1 fa_AV
  s_sub_u32 s28, s28, 1
  s_cmp_eq_u32 s28, 0
  s_cbranch_scc1 fa_Aexit
.p2align 6
fa_DD:
  v_mfma_f32_16x16x32_bf16 v[96:99], a[128:131], v[32:35], v[192:195]
  s_waitcnt vmcnt(12)
  v_exp_f32 v218, v146
  v_mfma_f32_16x16x32_bf16 v[104:107], a[128:131], v[36:39], v[196:199]
  s_barrier
  v_exp_f32 v219, v147
  v_mfma_f32_16x16x32_bf16 v[128:131], a[128:131], v[64:67], v[200:203]
  s_cmp_ge_u32 s26, s32
  ds_read_b128 a[160:163], v3 offset:16384
  v_add_f32 v226, v216, v217
  v_mfma_f32_16x16x32_bf16 v[136:139], a[128:131], v[68:71], v[204:207]
  s_cbranch_scc1 fa_hk4
fa_hb4:
  v_exp_f32 v220, v148
  v_mfma_f32_16x16x32_bf16 v[100:103], a[132:135], v[32:35], v[192:195]
  ds_read_b128 a[164:167], v3 offset:17408
  v_cvt_pk_bf16_f32 v184, v216, v217
  v_mfma_f32_16x16x32_bf16 v[108:111], a[132:135], v[36:39], v[196:199]
  s_mov_b32 m0, s24
  v_exp_f32 v221, v149
  v_mfma_f32_16x16x32_bf16 v[132:135], a[132:135], v[64:67], v[200:203]
  buffer_load_dwordx4 v2, s[44:47], s26 offen offset:0 sc1 lds
  v_add_f32 v226, v226, v218
  v_mfma_f32_16x16x32_bf16 v[140:143], a[132:135], v[68:71], v[204:207]
  v_exp_f32 v222, v150
  v_mfma_f32_16x16x32_bf16 v[96:99], a[136:139], v[40:43], v[96:99]
  ds_read_b128 a[168:171], v3 offset:18432
  v_add_f32 v226, v226, v219
  v_mfma_f32_16x16x32_bf16 v[104:107], a[136:139], v[44:47], v[104:107]
  v_exp_f32 v223, v151
  v_mfma_f32_16x16x32_bf16 v[128:131], a[136:139], v[72:75], v[128:131]
  v_cvt_pk_bf16_f32 v185, v218, v219
  v_add_f32 v226, v226, v220
  v_mfma_f32_16x16x32_bf16 v[136:139], a[136:139], v[76:79], v[136:139]
  v_exp_f32 v216, v152
  v_mfma_f32_16x16x32_bf16 v[100:103], a[140:143], v[40:43], v[100:103]
  ds_read_b128 a[172:175], v3 offset:19456
  v_add_f32 v226, v226, v221
  v_mfma_f32_16x16x32_bf16 v[108:111], a[140:143], v[44:47], v[108:111]
  v_exp_f32 v217, v153
  v_mfma_f32_16x16x32_bf16 v[132:135], a[140:143], v[72:75], v[132:135]
  v_cvt_pk_bf16_f32 v186, v220, v221
  v_add_f32 v226, v226, v222
  v_mfma_f32_16x16x32_bf16 v[140:143], a[140:143], v[76:79], v[140:143]
  s_waitcnt lgkmcnt(4)
  v_exp_f32 v218, v154
  v_mfma_f32_16x16x32_bf16 v[96:99], a[144:147], v[48:51], v[96:99]
  ds_read_b128 a[176:179], v3 offset:20480
  v_add_f32 v226, v226, v223
  v_mfma_f32_16x16x32_bf16 v[104:107], a[144:147], v[52:55], v[104:107]
  v_exp_f32 v219, v155
  v_mfma_f32_16x16x32_bf16 v[128:131], a[144:147], v[80:83], v[128:131]
  v_cvt_pk_bf16_f32 v187, v222, v223
  v_add_f32 v227, v216, v217
  v_mfma_f32_16x16x32_bf16 v[136:139], a[144:147], v[84:87], v[136:139]
  v_exp_f32 v220, v156
  v_mfma_f32_16x16x32_bf16 v[100:103], a[148:151], v[48:51], v[100:103]
  ds_read_b128 a[180:183], v3 offset:21504
  v_cvt_pk_bf16_f32 v188, v216, v217
  v_mfma_f32_16x16x32_bf16 v[108:111], a[148:151], v[52:55], v[108:111]
  v_exp_f32 v221, v157
  v_mfma_f32_16x16x32_bf16 v[132:135], a[148:151], v[80:83], v[132:135]
  buffer_load_dwordx4 v2, s[44:47], s26 offen offset:1024 sc1 lds
  v_add_f32 v227, v227, v218
  v_mfma_f32_16x16x32_bf16 v[140:143], a[148:151], v[84:87], v[140:143]
  v_exp_f32 v222, v158
  v_mfma_f32_16x16x32_bf16 v[96:99], a[152:155], v[56:59], v[96:99]
  ds_read_b128 a[184:187], v3 offset:22528
  v_add_f32 v227, v227, v219
  v_mfma_f32_16x16x32_bf16 v[104:107], a[152:155], v[60:63], v[104:107]
  v_exp_f32 v223, v159
  v_mfma_f32_16x16x32_bf16 v[128:131], a[152:155], v[88:91], v[128:131]
  v_cvt_pk_bf16_f32 v189, v218, v219
  v_add_f32 v227, v227, v220
  v_mfma_f32_16x16x32_bf16 v[136:139], a[152:155], v[92:95], v[136:139]
  v_exp_f32 v208, v112
  v_mfma_f32_16x16x32_bf16 v[100:103], a[156:159], v[56:59], v[100:103]
  ds_read_b128 a[188:191], v3 offset:23552
  v_add_f32 v227, v227, v221
  v_mfma_f32_16x16x32_bf16 v[108:111], a[156:159], v[60:63], v[108:111]
  v_exp_f32 v209, v113
  v_mfma_f32_16x16x32_bf16 v[132:135], a[156:159], v[88:91], v[132:135]
  v_cvt_pk_bf16_f32 v190, v220, v221
  v_add_f32 v227, v227, v222
  v_add_f32 v227, v227, v223
  v_mfma_f32_16x16x32_bf16 v[140:143], a[156:159], v[92:95], v[140:143]
  s_waitcnt lgkmcnt(4)
  v_exp_f32 v210, v114
  v_mfma_f32_16x16x32_bf16 a[0:3], a[160:163], v[160:163], a[0:3]
  ds_read_b128 a[128:131], v3 offset:0
  v_cvt_pk_bf16_f32 v191, v222, v223
  v_mfma_f32_16x16x32_bf16 a[4:7], a[160:163], v[164:167], a[4:7]
  v_exp_f32 v211, v115
  v_mfma_f32_16x16x32_bf16 a[64:67], a[160:163], v[176:179], a[64:67]
  v_exp_f32 v212, v116
  v_mfma_f32_16x16x32_bf16 a[68:71], a[160:163], v[180:183], a[68:71]
  v_add_f32 v224, v208, v209
  v_cvt_pk_bf16_f32 v168, v208, v209
  v_mfma_f32_16x16x32_bf16 a[8:11], a[164:167], v[160:163], a[8:11]
  ds_read_b128 a[132:135], v3 offset:1024
  v_add_f32 v224, v224, v210
  v_mfma_f32_16x16x32_bf16 a[12:15], a[164:167], v[164:167], a[12:15]
  v_exp_f32 v213, v117
  v_mfma_f32_16x16x32_bf16 a[72:75], a[164:167], v[176:179], a[72:75]
  buffer_load_dwordx4 v2, s[44:47], s26 offen offset:2048 sc1 lds
  v_add_f32 v224, v224, v211
  v_mfma_f32_16x16x32_bf16 a[76:79], a[164:167], v[180:183], a[76:79]
  v_exp_f32 v214, v118
  v_mfma_f32_16x16x32_bf16 a[16:19], a[168:171], v[160:163], a[16:19]
  ds_read_b128 a[136:139], v3 offset:2048
  v_cvt_pk_bf16_f32 v169, v210, v211
  v_mfma_f32_16x16x32_bf16 a[20:23], a[168:171], v[164:167], a[20:23]
  v_exp_f32 v215, v119
  v_mfma_f32_16x16x32_bf16 a[80:83], a[168:171], v[176:179], a[80:83]
  v_add_f32 v224, v224, v212
  v_add_f32 v224, v224, v213
  v_mfma_f32_16x16x32_bf16 a[84:87], a[168:171], v[180:183], a[84:87]
  v_exp_f32 v208, v120
  v_mfma_f32_16x16x32_bf16 a[24:27], a[172:175], v[160:163], a[24:27]
  ds_read_b128 a[140:143], v3 offset:3072
  v_cvt_pk_bf16_f32 v170, v212, v213
  v_mfma_f32_16x16x32_bf16 a[28:31], a[172:175], v[164:167], a[28:31]
  v_exp_f32 v209, v121
  v_mfma_f32_16x16x32_bf16 a[88:91], a[172:175], v[176:179], a[88:91]
  v_exp_f32 v210, v122
  v_mfma_f32_16x16x32_bf16 a[92:95], a[172:175], v[180:183], a[92:95]
  s_waitcnt lgkmcnt(4)
  v_add_f32 v224, v224, v214
  v_add_f32 v224, v224, v215
  v_mfma_f32_16x16x32_bf16 a[32:35], a[176:179], v[160:163], a[32:35]
  ds_read_b128 a[144:147], v3 offset:4096
  v_cvt_pk_bf16_f32 v171, v214, v215
  v_mfma_f32_16x16x32_bf16 a[36:39], a[176:179], v[164:167], a[36:39]
  v_exp_f32 v211, v123
  v_mfma_f32_16x16x32_bf16 a[96:99], a[176:179], v[176:179], a[96:99]
  v_add_f32 v225, v208, v209
  v_cvt_pk_bf16_f32 v172, v208, v209
  v_mfma_f32_16x16x32_bf16 a[100:103], a[176:179], v[180:183], a[100:103]
  v_exp_f32 v212, v124
  v_mfma_f32_16x16x32_bf16 a[40:43], a[180:183], v[160:163], a[40:43]
  ds_read_b128 a[148:151], v3 offset:5120
  v_add_f32 v225, v225, v210
  v_mfma_f32_16x16x32_bf16 a[44:47], a[180:183], v[164:167], a[44:47]
  v_exp_f32 v213, v125
  v_mfma_f32_16x16x32_bf16 a[104:107], a[180:183], v[176:179], a[104:107]
  buffer_load_dwordx4 v2, s[44:47], s26 offen offset:3072 sc1 lds
  v_add_f32 v225, v225, v211
  v_mfma_f32_16x16x32_bf16 a[108:111], a[180:183], v[180:183], a[108:111]
  s_add_u32 s26, s26, 16384
  v_exp_f32 v214, v126
  v_mfma_f32_16x16x32_bf16 a[48:51], a[184:187], v[160:163], a[48:51]
  s_add_u32 s24, s24, 32768
  ds_read_b128 a[152:155], v3 offset:6144
  v_cvt_pk_bf16_f32 v173, v210, v211
  v_mfma_f32_16x16x32_bf16 a[52:55], a[184:187], v[164:167], a[52:55]
  s_and_b32 s24, s24, 0x1ffff
  v_exp_f32 v215, v127
  v_mfma_f32_16x16x32_bf16 a[112:115], a[184:187], v[176:179], a[112:115]
  v_max3_f32 v5, v226, v227, v224
  v_add_f32 v225, v225, v212
  v_mfma_f32_16x16x32_bf16 a[116:119], a[184:187], v[180:183], a[116:119]
  v_add_f32 v225, v225, v213
  v_cvt_pk_bf16_f32 v174, v212, v213
  v_add_f32 v225, v225, v214
  v_mfma_f32_16x16x32_bf16 a[56:59], a[188:191], v[160:163], a[56:59]
  ds_read_b128 a[156:159], v3 offset:7168
  v_add_f32 v225, v225, v215
  v_max_f32 v5, v5, v225
  v_cmp_lt_f32 vcc, s81, v5
  v_mfma_f32_16x16x32_bf16 a[60:63], a[188:191], v[164:167], a[60:63]
  v_exp_f32 v216, v128
  v_mfma_f32_16x16x32_bf16 a[120:123], a[188:191], v[176:179], a[120:123]
  s_waitcnt lgkmcnt(4)
  v_cvt_pk_bf16_f32 v175, v214, v215
  v_mfma_f32_16x16x32_bf16 a[124:127], a[188:191], v[180:183], a[124:127]
  s_cbranch_vccnz fa_stub1
fa_back1:
  v_exp_f32 v217, v129
  v_add_f32 v228, v228, v224
  v_add_f32 v229, v229, v225
  v_add_f32 v230, v230, v226
  v_add_f32 v231, v231, v227
fa_DDe:
  v_mfma_f32_16x16x32_bf16 v[112:115], a[128:131], v[32:35], v[192:195]
  ds_read_b128 a[160:163], v3 offset:24576
  v_add_f32 v226, v216, v217
  v_mfma_f32_16x16x32_bf16 v[120:123], a[128:131], v[36:39], v[196:199]
  v_exp_f32 v218, v130
  v_mfma_f32_16x16x32_bf16 v[144:147], a[128:131], v[64:67], v[200:203]
  s_cmp_ge_u32 s26, s9
  v_exp_f32 v219, v131
  v_mfma_f32_16x16x32_bf16 v[152:155], a[128:131], v[68:71], v[204:207]
  s_cbranch_scc1 fa_hk5
fa_hb5:
  v_exp_f32 v220, v132
  v_mfma_f32_16x16x32_bf16 v[116:119], a[132:135], v[32:35], v[192:195]
  s_add_u32 s66, s66, 32768
  ds_read_b128 a[164:167], v3 offset:25600
  v_cvt_pk_bf16_f32 v176, v216, v217
  v_mfma_f32_16x16x32_bf16 v[124:127], a[132:135], v[36:39], v[196:199]
  s_mov_b32 m0, s25
  v_exp_f32 v221, v133
  v_mfma_f32_16x16x32_bf16 v[148:151], a[132:135], v[64:67], v[200:203]
  s_and_b32 s66, s66, 0x1ffff
  buffer_load_dwordx4 v2, s[48:51], s27 offen offset:0 sc1 lds
  v_add_f32 v226, v226, v218
  v_mfma_f32_16x16x32_bf16 v[156:159], a[132:135], v[68:71], v[204:207]
  v_exp_f32 v222, v134
  v_mfma_f32_16x16x32_bf16 v[112:115], a[136:139], v[40:43], v[112:115]
  ds_read_b128 a[168:171], v3 offset:26624
  v_add_f32 v226, v226, v219
  v_mfma_f32_16x16x32_bf16 v[120:123], a[136:139], v[44:47], v[120:123]
  v_exp_f32 v223, v135
  v_mfma_f32_16x16x32_bf16 v[144:147], a[136:139], v[72:75], v[144:147]
  v_cvt_pk_bf16_f32 v177, v218, v219
  v_add_f32 v226, v226, v220
  v_mfma_f32_16x16x32_bf16 v[152:155], a[136:139], v[76:79], v[152:155]
  v_exp_f32 v216, v136
  v_mfma_f32_16x16x32_bf16 v[116:119], a[140:143], v[40:43], v[116:119]
  ds_read_b128 a[172:175], v3 offset:27648
  v_add_f32 v226, v226, v221
  v_mfma_f32_16x16x32_bf16 v[124:127], a[140:143], v[44:47], v[124:127]
  v_exp_f32 v217, v137
  v_mfma_f32_16x16x32_bf16 v[148:151], a[140:143], v[72:75], v[148:151]
  v_cvt_pk_bf16_f32 v178, v220, v221
  v_add_f32 v226, v226, v222
  v_mfma_f32_16x16x32_bf16 v[156:159], a[140:143], v[76:79], v[156:159]
  s_waitcnt lgkmcnt(4)
  v_exp_f32 v218, v138
  v_mfma_f32_16x16x32_bf16 v[112:115], a[144:147], v[48:51], v[112:115]
  ds_read_b128 a[176:179], v3 offset:28672
  v_add_f32 v226, v226, v223
  v_mfma_f32_16x16x32_bf16 v[120:123], a[144:147], v[52:55], v[120:123]
  v_exp_f32 v219, v139
  v_mfma_f32_16x16x32_bf16 v[144:147], a[144:147], v[80:83], v[144:147]
  v_cvt_pk_bf16_f32 v179, v222, v223
  v_add_f32 v227, v216, v217
  v_mfma_f32_16x16x32_bf16 v[152:155], a[144:147], v[84:87], v[152:155]
  v_exp_f32 v220, v140
  v_mfma_f32_16x16x32_bf16 v[116:119], a[148:151], v[48:51], v[116:119]
  ds_read_b128 a[180:183], v3 offset:29696
  v_cvt_pk_bf16_f32 v180, v216, v217
  v_mfma_f32_16x16x32_bf16 v[124:127], a[148:151], v[52:55], v[124:127]
  v_exp_f32 v221, v141
  v_mfma_f32_16x16x32_bf16 v[148:151], a[148:151], v[80:83], v[148:151]
  buffer_load_dwordx4 v2, s[48:51], s27 offen offset:1024 sc1 lds
  v_add_f32 v227, v227, v218
  v_mfma_f32_16x16x32_bf16 v[156:159], a[148:151], v[84:87], v[156:159]
  v_exp_f32 v222, v142
  v_mfma_f32_16x16x32_bf16 v[112:115], a[152:155], v[56:59], v[112:115]
  ds_read_b128 a[184:187], v3 offset:30720
  v_add_f32 v227, v227, v219
  v_mfma_f32_16x16x32_bf16 v[120:123], a[152:155], v[60:63], v[120:123]
  v_exp_f32 v223, v143
  v_mfma_f32_16x16x32_bf16 v[144:147], a[152:155], v[88:91], v[144:147]
  v_cvt_pk_bf16_f32 v181, v218, v219
  v_add_f32 v227, v227, v220
  v_mfma_f32_16x16x32_bf16 v[152:155], a[152:155], v[92:95], v[152:155]
  v_exp_f32 v208, v96
  v_mfma_f32_16x16x32_bf16 v[116:119], a[156:159], v[56:59], v[116:119]
  ds_read_b128 a[188:191], v3 offset:31744
  v_add_f32 v227, v227, v221
  v_mfma_f32_16x16x32_bf16 v[124:127], a[156:159], v[60:63], v[124:127]
  v_exp_f32 v209, v97
  v_mfma_f32_16x16x32_bf16 v[148:151], a[156:159], v[88:91], v[148:151]
  v_cvt_pk_bf16_f32 v182, v220, v221
  v_add_f32 v227, v227, v222
  v_add_f32 v227, v227, v223
  v_mfma_f32_16x16x32_bf16 v[156:159], a[156:159], v[92:95], v[156:159]
  s_waitcnt lgkmcnt(4)
  v_exp_f32 v210, v98
  v_mfma_f32_16x16x32_bf16 a[0:3], a[160:163], v[168:171], a[0:3]
  ds_read_b128 a[128:131], v3 offset:8192
  v_cvt_pk_bf16_f32 v183, v222, v223
  v_mfma_f32_16x16x32_bf16 a[4:7], a[160:163], v[172:175], a[4:7]
  v_exp_f32 v211, v99
  v_mfma_f32_16x16x32_bf16 a[64:67], a[160:163], v[184:187], a[64:67]
  v_exp_f32 v212, v100
  v_mfma_f32_16x16x32_bf16 a[68:71], a[160:163], v[188:191], a[68:71]
  v_add_f32 v224, v208, v209
  v_cvt_pk_bf16_f32 v160, v208, v209
  v_mfma_f32_16x16x32_bf16 a[8:11], a[164:167], v[168:171], a[8:11]
  ds_read_b128 a[132:135], v3 offset:9216
  v_add_f32 v224, v224, v210
  v_mfma_f32_16x16x32_bf16 a[12:15], a[164:167], v[172:175], a[12:15]
  v_exp_f32 v213, v101
  v_mfma_f32_16x16x32_bf16 a[72:75], a[164:167], v[184:187], a[72:75]
  buffer_load_dwordx4 v2, s[48:51], s27 offen offset:2048 sc1 lds
  v_add_f32 v224, v224, v211
  v_mfma_f32_16x16x32_bf16 a[76:79], a[164:167], v[188:191], a[76:79]
  v_exp_f32 v214, v102
  v_mfma_f32_16x16x32_bf16 a[16:19], a[168:171], v[168:171], a[16:19]
  ds_read_b128 a[136:139], v3 offset:10240
  v_cvt_pk_bf16_f32 v161, v210, v211
  v_mfma_f32_16x16x32_bf16 a[20:23], a[168:171], v[172:175], a[20:23]
  v_exp_f32 v215, v103
  v_mfma_f32_16x16x32_bf16 a[80:83], a[168:171], v[184:187], a[80:83]
  v_add_f32 v224, v224, v212
  v_add_f32 v224, v224, v213
  v_mfma_f32_16x16x32_bf16 a[84:87], a[168:171], v[188:191], a[84:87]
  v_exp_f32 v208, v104
  v_mfma_f32_16x16x32_bf16 a[24:27], a[172:175], v[168:171], a[24:27]
  ds_read_b128 a[140:143], v3 offset:11264
  v_cvt_pk_bf16_f32 v162, v212, v213
  v_mfma_f32_16x16x32_bf16 a[28:31], a[172:175], v[172:175], a[28:31]
  v_exp_f32 v209, v105
  v_mfma_f32_16x16x32_bf16 a[88:91], a[172:175], v[184:187], a[88:91]
  v_exp_f32 v210, v106
  v_mfma_f32_16x16x32_bf16 a[92:95], a[172:175], v[188:191], a[92:95]
  s_waitcnt lgkmcnt(4)
  v_add_f32 v224, v224, v214
  v_add_f32 v224, v224, v215
  v_mfma_f32_16x16x32_bf16 a[32:35], a[176:179], v[168:171], a[32:35]
  ds_read_b128 a[144:147], v3 offset:12288
  v_cvt_pk_bf16_f32 v163, v214, v215
  v_mfma_f32_16x16x32_bf16 a[36:39], a[176:179], v[172:175], a[36:39]
  v_exp_f32 v211, v107
  v_mfma_f32_16x16x32_bf16 a[96:99], a[176:179], v[184:187], a[96:99]
  v_add_f32 v225, v208, v209
  v_cvt_pk_bf16_f32 v164, v208, v209
  v_mfma_f32_16x16x32_bf16 a[100:103], a[176:179], v[188:191], a[100:103]
  v_exp_f32 v212, v108
  v_mfma_f32_16x16x32_bf16 a[40:43], a[180:183], v[168:171], a[40:43]
  ds_read_b128 a[148:151], v3 offset:13312
  v_add_f32 v225, v225, v210
  v_mfma_f32_16x16x32_bf16 a[44:47], a[180:183], v[172:175], a[44:47]
  v_exp_f32 v213, v109
  v_mfma_f32_16x16x32_bf16 a[104:107], a[180:183], v[184:187], a[104:107]
  buffer_load_dwordx4 v2, s[48:51], s27 offen offset:3072 sc1 lds
  v_add_f32 v225, v225, v211
  v_mfma_f32_16x16x32_bf16 a[108:111], a[180:183], v[188:191], a[108:111]
  s_add_u32 s27, s27, 16384
  v_exp_f32 v214, v110
  v_mfma_f32_16x16x32_bf16 a[48:51], a[184:187], v[168:171], a[48:51]
  s_add_u32 s25, s25, 32768
  ds_read_b128 a[152:155], v3 offset:14336
  v_cvt_pk_bf16_f32 v165, v210, v211
  v_mfma_f32_16x16x32_bf16 a[52:55], a[184:187], v[172:175], a[52:55]
  s_and_b32 s25, s25, 0x1ffff
  v_exp_f32 v215, v111
  v_mfma_f32_16x16x32_bf16 a[112:115], a[184:187], v[184:187], a[112:115]
  v_max3_f32 v5, v226, v227, v224
  v_add_f32 v225, v225, v212
  v_mfma_f32_16x16x32_bf16 a[116:119], a[184:187], v[188:191], a[116:119]
  v_add_f32 v225, v225, v213
  v_cvt_pk_bf16_f32 v166, v212, v213
  v_add_f32 v225, v225, v214
  v_mfma_f32_16x16x32_bf16 a[56:59], a[188:191], v[168:171], a[56:59]
  s_sub_u32 s28, s28, 1
  ds_read_b128 a[156:159], v3 offset:15360
  v_add_f32 v225, v225, v215
  v_max_f32 v5, v5, v225
  v_cmp_lt_f32 vcc, s81, v5
  v_mfma_f32_16x16x32_bf16 a[60:63], a[188:191], v[172:175], a[60:63]
  s_cmp_gt_u32 s28, s8
  v_exp_f32 v216, v144
  v_mfma_f32_16x16x32_bf16 a[120:123], a[188:191], v[184:187], a[120:123]
  s_waitcnt lgkmcnt(4)
  v_cvt_pk_bf16_f32 v167, v214, v215
  v_add_u32 v3, s66, v2
  v_mfma_f32_16x16x32_bf16 a[124:127], a[188:191], v[188:191], a[124:127]
  s_cbranch_vccnz fa_stub2
fa_back2:
  v_exp_f32 v217, v145
  v_add_f32 v228, v228, v224
  v_add_f32 v229, v229, v225
  v_add_f32 v230, v230, v226
  v_add_f32 v231, v231, v227
  s_cbranch_scc1 fa_DD
  s_cmp_lg_u32 s8, 0
  s_cbranch_scc1 fa_DDF
fa_Aexit:
  s_bitcmp1_b32 s20, 0
  s_cbranch_scc1 fa_Aodd
  v_mfma_f32_16x16x32_bf16 v[96:99], a[128:131], v[32:35], v[192:195]
  s_waitcnt vmcnt(12)
  v_exp_f32 v218, v146
  v_mfma_f32_16x16x32_bf16 v[104:107], a[128:131], v[36:39], v[196:199]
  s_barrier
  v_exp_f32 v219, v147
  v_mfma_f32_16x16x32_bf16 v[128:131], a[128:131], v[64:67], v[200:203]
  ds_read_b128 a[160:163], v3 offset:16384
  v_add_f32 v226, v216, v217
  v_mfma_f32_16x16x32_bf16 v[136:139], a[128:131], v[68:71], v[204:207]
  v_exp_f32 v220, v148
  v_mfma_f32_16x16x32_bf16 v[100:103], a[132:135], v[32:35], v[192:195]
  ds_read_b128 a[164:167], v3 offset:17408
  v_cvt_pk_bf16_f32 v184, v216, v217
  v_mfma_f32_16x16x32_bf16 v[108:111], a[132:135], v[36:39], v[196:199]
  s_mov_b32 m0, s24
  v_exp_f32 v221, v149
  v_mfma_f32_16x16x32_bf16 v[132:135], a[132:135], v[64:67], v[200:203]
  buffer_load_dwordx4 v2, s[44:47], s26 offen offset:0 sc1 lds
  v_add_f32 v226, v226, v218
  v_mfma_f32_16x16x32_bf16 v[140:143], a[132:135], v[68:71], v[204:207]
  v_exp_f32 v222, v150
  v_mfma_f32_16x16x32_bf16 v[96:99], a[136:139], v[40:43], v[96:99]
  ds_read_b128 a[168:171], v3 offset:18432
  v_add_f32 v226, v226, v219
  v_mfma_f32_16x16x32_bf16 v[104:107], a[136:139], v[44:47], v[104:107]
  v_exp_f32 v223, v151
  v_mfma_f32_16x16x32_bf16 v[128:131], a[136:139], v[72:75], v[128:131]
  v_cvt_pk_bf16_f32 v185, v218, v219
  v_add_f32 v226, v226, v220
  v_mfma_f32_16x16x32_bf16 v[136:139], a[136:139], v[76:79], v[136:139]
  v_exp_f32 v216, v152
  v_mfma_f32_16x16x32_bf16 v[100:103], a[140:143], v[40:43], v[100:103]
  ds_read_b128 a[172:175], v3 offset:19456
  v_add_f32 v226, v226, v221
  v_mfma_f32_16x16x32_bf16 v[108:111], a[140:143], v[44:47], v[108:111]
  v_exp_f32 v217, v153
  v_mfma_f32_16x16x32_bf16 v[132:135], a[140:143], v[72:75], v[132:135]
  v_cvt_pk_bf16_f32 v186, v220, v221
  v_add_f32 v226, v226, v222
  v_mfma_f32_16x16x32_bf16 v[140:143], a[140:143], v[76:79], v[140:143]
  s_waitcnt lgkmcnt(4)
  v_exp_f32 v218, v154
  v_mfma_f32_16x16x32_bf16 v[96:99], a[144:147], v[48:51], v[96:99]
  ds_read_b128 a[176:179], v3 offset:20480
  v_add_f32 v226, v226, v223
  v_mfma_f32_16x16x32_bf16 v[104:107], a[144:147], v[52:55], v[104:107]
  v_exp_f32 v219, v155
  v_mfma_f32_16x16x32_bf16 v[128:131], a[144:147], v[80:83], v[128:131]
  v_cvt_pk_bf16_f32 v187, v222, v223
  v_add_f32 v227, v216, v217
  v_mfma_f32_16x16x32_bf16 v[136:139], a[144:147], v[84:87], v[136:139]
  v_exp_f32 v220, v156
  v_mfma_f32_16x16x32_bf16 v[100:103], a[148:151], v[48:51], v[100:103]
  ds_read_b128 a[180:183], v3 offset:21504
  v_cvt_pk_bf16_f32 v188, v216, v217
  v_mfma_f32_16x16x32_bf16 v[108:111], a[148:151], v[52:55], v[108:111]
  v_exp_f32 v221, v157
  v_mfma_f32_16x16x32_bf16 v[132:135], a[148:151], v[80:83], v[132:135]
  buffer_load_dwordx4 v2, s[44:47], s26 offen offset:1024 sc1 lds
  v_add_f32 v227, v227, v218
  v_mfma_f32_16x16x32_bf16 v[140:143], a[148:151], v[84:87], v[140:143]
  v_exp_f32 v222, v158
  v_mfma_f32_16x16x32_bf16 v[96:99], a[152:155], v[56:59], v[96:99]
  ds_read_b128 a[184:187], v3 offset:22528
  v_add_f32 v227, v227, v219
  v_mfma_f32_16x16x32_bf16 v[104:107], a[152:155], v[60:63], v[104:107]
  v_exp_f32 v223, v159
  v_mfma_f32_16x16x32_bf16 v[128:131], a[152:155], v[88:91], v[128:131]
  v_cvt_pk_bf16_f32 v189, v218, v219
  v_add_f32 v227, v227, v220
  v_mfma_f32_16x16x32_bf16 v[136:139], a[152:155], v[92:95], v[136:139]
  v_exp_f32 v208, v112
  v_mfma_f32_16x16x32_bf16 v[100:103], a[156:159], v[56:59], v[100:103]
  ds_read_b128 a[188:191], v3 offset:23552
  v_add_f32 v227, v227, v221
  v_mfma_f32_16x16x32_bf16 v[108:111], a[156:159], v[60:63], v[108:111]
  v_exp_f32 v209, v113
  v_mfma_f32_16x16x32_bf16 v[132:135], a[156:159], v[88:91], v[132:135]
  v_cvt_pk_bf16_f32 v190, v220, v221
  v_add_f32 v227, v227, v222
  v_add_f32 v227, v227, v223
  v_mfma_f32_16x16x32_bf16 v[140:143], a[156:159], v[92:95], v[140:143]
  s_waitcnt lgkmcnt(4)
  v_exp_f32 v210, v114
  v_mfma_f32_16x16x32_bf16 a[0:3], a[160:163], v[160:163], a[0:3]
  ds_read_b128 a[128:131], v3 offset:0
  v_cvt_pk_bf16_f32 v191, v222, v223
  v_mfma_f32_16x16x32_bf16 a[4:7], a[160:163], v[164:167], a[4:7]
  v_exp_f32 v211, v115
  v_mfma_f32_16x16x32_bf16 a[64:67], a[160:163], v[176:179], a[64:67]
  v_exp_f32 v212, v116
  v_mfma_f32_16x16x32_bf16 a[68:71], a[160:163], v[180:183], a[68:71]
  v_add_f32 v224, v208, v209
  v_cvt_pk_bf16_f32 v168, v208, v209
  v_mfma_f32_16x16x32_bf16 a[8:11], a[164:167], v[160:163], a[8:11]
  ds_read_b128 a[132:135], v3 offset:1024
  v_add_f32 v224, v224, v210
  v_mfma_f32_16x16x32_bf16 a[12:15], a[164:167], v[164:167], a[12:15]
  v_exp_f32 v213, v117
  v_mfma_f32_16x16x32_bf16 a[72:75], a[164:167], v[176:179], a[72:75]
  buffer_load_dwordx4 v2, s[44:47], s26 offen offset:2048 sc1 lds
  v_add_f32 v224, v224, v211
  v_mfma_f32_16x16x32_bf16 a[76:79], a[164:167], v[180:183], a[76:79]
  v_exp_f32 v214, v118
  v_mfma_f32_16x16x32_bf16 a[16:19], a[168:171], v[160:163], a[16:19]
  ds_read_b128 a[136:139], v3 offset:2048
  v_cvt_pk_bf16_f32 v169, v210, v211
  v_mfma_f32_16x16x32_bf16 a[20:23], a[168:171], v[164:167], a[20:23]
  v_exp_f32 v215, v119
  v_mfma_f32_16x16x32_bf16 a[80:83], a[168:171], v[176:179], a[80:83]
  v_add_f32 v224, v224, v212
  v_add_f32 v224, v224, v213
  v_mfma_f32_16x16x32_bf16 a[84:87], a[168:171], v[180:183], a[84:87]
  v_exp_f32 v208, v120
  v_mfma_f32_16x16x32_bf16 a[24:27], a[172:175], v[160:163], a[24:27]
  ds_read_b128 a[140:143], v3 offset:3072
  v_cvt_pk_bf16_f32 v170, v212, v213
  v_mfma_f32_16x16x32_bf16 a[28:31], a[172:175], v[164:167], a[28:31]
  v_exp_f32 v209, v121
  v_mfma_f32_16x16x32_bf16 a[88:91], a[172:175], v[176:179], a[88:91]
  v_exp_f32 v210, v122
  v_mfma_f32_16x16x32_bf16 a[92:95], a[172:175], v[180:183], a[92:95]
  s_waitcnt lgkmcnt(4)
  v_add_f32 v224, v224, v214
  v_add_f32 v224, v224, v215
  v_mfma_f32_16x16x32_bf16 a[32:35], a[176:179], v[160:163], a[32:35]
  ds_read_b128 a[144:147], v3 offset:4096
  v_cvt_pk_bf16_f32 v171, v214, v215
  v_mfma_f32_16x16x32_bf16 a[36:39], a[176:179], v[164:167], a[36:39]
  v_exp_f32 v211, v123
  v_mfma_f32_16x16x32_bf16 a[96:99], a[176:179], v[176:179], a[96:99]
  v_add_f32 v225, v208, v209
  v_cvt_pk_bf16_f32 v172, v208, v209
  v_mfma_f32_16x16x32_bf16 a[100:103], a[176:179], v[180:183], a[100:103]
  v_exp_f32 v212, v124
  v_mfma_f32_16x16x32_bf16 a[40:43], a[180:183], v[160:163], a[40:43]
  ds_read_b128 a[148:151], v3 offset:5120
  v_add_f32 v225, v225, v210
  v_mfma_f32_16x16x32_bf16 a[44:47], a[180:183], v[164:167], a[44:47]
  v_exp_f32 v213, v125
  v_mfma_f32_16x16x32_bf16 a[104:107], a[180:183], v[176:179], a[104:107]
  buffer_load_dwordx4 v2, s[44:47], s26 offen offset:3072 sc1 lds
  v_add_f32 v225, v225, v211
  v_mfma_f32_16x16x32_bf16 a[108:111], a[180:183], v[180:183], a[108:111]
  s_add_u32 s26, s26, 16384
  v_exp_f32 v214, v126
  v_mfma_f32_16x16x32_bf16 a[48:51], a[184:187], v[160:163], a[48:51]
  s_add_u32 s24, s24, 32768
  ds_read_b128 a[152:155], v3 offset:6144
  v_cvt_pk_bf16_f32 v173, v210, v211
  v_mfma_f32_16x16x32_bf16 a[52:55], a[184:187], v[164:167], a[52:55]
  s_and_b32 s24, s24, 0x1ffff
  v_exp_f32 v215, v127
  v_mfma_f32_16x16x32_bf16 a[112:115], a[184:187], v[176:179], a[112:115]
  v_max3_f32 v5, v226, v227, v224
  v_add_f32 v225, v225, v212
  v_mfma_f32_16x16x32_bf16 a[116:119], a[184:187], v[180:183], a[116:119]
  v_add_f32 v225, v225, v213
  v_cvt_pk_bf16_f32 v174, v212, v213
  v_add_f32 v225, v225, v214
  v_mfma_f32_16x16x32_bf16 a[56:59], a[188:191], v[160:163], a[56:59]
  ds_read_b128 a[156:159], v3 offset:7168
  v_add_f32 v225, v225, v215
  v_max_f32 v5, v5, v225
  v_cmp_lt_f32 vcc, s81, v5
  v_mfma_f32_16x16x32_bf16 a[60:63], a[188:191], v[164:167], a[60:63]
  v_exp_f32 v216, v128
  v_mfma_f32_16x16x32_bf16 a[120:123], a[188:191], v[176:179], a[120:123]
  s_waitcnt lgkmcnt(4)
  v_cvt_pk_bf16_f32 v175, v214, v215
  v_mfma_f32_16x16x32_bf16 a[124:127], a[188:191], v[180:183], a[124:127]
  s_cbranch_vccnz fa_stub4
fa_back4:
  v_exp_f32 v217, v129
  v_add_f32 v228, v228, v224
  v_add_f32 v229, v229, v225
  v_add_f32 v230, v230, v226
  v_add_f32 v231, v231, v227
  v_mfma_f32_16x16x32_bf16 v[144:147], a[128:131], v[64:67], v[200:203]
  ds_read_b128 a[160:163], v3 offset:24576
  v_exp_f32 v218, v130
  v_mfma_f32_16x16x32_bf16 v[152:155], a[128:131], v[68:71], v[204:207]
  v_exp_f32 v219, v131
  v_add_f32 v226, v216, v217
  v_mfma_f32_16x16x32_bf16 v[148:151], a[132:135], v[64:67], v[200:203]
  s_add_u32 s66, s66, 32768
  ds_read_b128 a[164:167], v3 offset:25600
  v_exp_f32 v220, v132
  v_mfma_f32_16x16x32_bf16 v[156:159], a[132:135], v[68:71], v[204:207]
  s_and_b32 s66, s66, 0x1ffff
  v_exp_f32 v221, v133
  v_cvt_pk_bf16_f32 v176, v216, v217
  v_mfma_f32_16x16x32_bf16 v[144:147], a[136:139], v[72:75], v[144:147]
  ds_read_b128 a[168:171], v3 offset:26624
  v_add_f32 v226, v226, v218
  v_add_f32 v226, v226, v219
  v_mfma_f32_16x16x32_bf16 v[152:155], a[136:139], v[76:79], v[152:155]
  s_mov_b32 m0, s25
  v_exp_f32 v222, v134
  v_cvt_pk_bf16_f32 v177, v218, v219
  v_mfma_f32_16x16x32_bf16 v[148:151], a[140:143], v[72:75], v[148:151]
  ds_read_b128 a[172:175], v3 offset:27648
  buffer_load_dwordx4 v2, s[48:51], s27 offen offset:0 sc1 lds
  v_add_f32 v226, v226, v220
  v_add_f32 v226, v226, v221
  v_mfma_f32_16x16x32_bf16 v[156:159], a[140:143], v[76:79], v[156:159]
  s_waitcnt lgkmcnt(4)
  v_exp_f32 v223, v135
  v_cvt_pk_bf16_f32 v178, v220, v221
  v_mfma_f32_16x16x32_bf16 v[144:147], a[144:147], v[80:83], v[144:147]
  ds_read_b128 a[176:179], v3 offset:28672
  v_cndmask_b32 v96, v4, v96, s[68:69]
  v_cndmask_b32 v97, v4, v97, s[70:71]
  v_mfma_f32_16x16x32_bf16 v[152:155], a[144:147], v[84:87], v[152:155]
  v_exp_f32 v216, v136
  v_cndmask_b32 v98, v4, v98, s[72:73]
  v_mfma_f32_16x16x32_bf16 v[148:151], a[148:151], v[80:83], v[148:151]
  ds_read_b128 a[180:183], v3 offset:29696
  v_cndmask_b32 v99, v4, v99, s[74:75]
  v_mov_b32 v100, v4
  v_mfma_f32_16x16x32_bf16 v[156:159], a[148:151], v[84:87], v[156:159]
  v_exp_f32 v217, v137
  v_mov_b32 v101, v4
  v_mfma_f32_16x16x32_bf16 v[144:147], a[152:155], v[88:91], v[144:147]
  ds_read_b128 a[184:187], v3 offset:30720
  v_mov_b32 v102, v4
  v_mov_b32 v103, v4
  v_mfma_f32_16x16x32_bf16 v[152:155], a[152:155], v[92:95], v[152:155]
  v_exp_f32 v218, v138
  v_cndmask_b32 v108, v4, v108, s[68:69]
  v_mfma_f32_16x16x32_bf16 v[148:151], a[156:159], v[88:91], v[148:151]
  ds_read_b128 a[188:191], v3 offset:31744
  v_cndmask_b32 v109, v4, v109, s[70:71]
  v_cndmask_b32 v110, v4, v110, s[72:73]
  v_mfma_f32_16x16x32_bf16 v[156:159], a[156:159], v[92:95], v[156:159]
  s_waitcnt lgkmcnt(4)
  v_exp_f32 v219, v139
  v_cndmask_b32 v111, v4, v111, s[74:75]
  v_mfma_f32_16x16x32_bf16 a[0:3], a[160:163], v[168:171], a[0:3]
  ds_read_b128 a[128:131], v3 offset:8192
  v_add_f32 v226, v226, v222
  v_add_f32 v226, v226, v223
  v_mfma_f32_16x16x32_bf16 a[4:7], a[160:163], v[172:175], a[4:7]
  v_exp_f32 v220, v140
  v_cvt_pk_bf16_f32 v179, v222, v223
  v_mfma_f32_16x16x32_bf16 a[64:67], a[160:163], v[184:187], a[64:67]
  buffer_load_dwordx4 v2, s[48:51], s27 offen offset:1024 sc1 lds
  v_add_f32 v227, v216, v217
  v_cvt_pk_bf16_f32 v180, v216, v217
  v_mfma_f32_16x16x32_bf16 a[68:71], a[160:163], v[188:191], a[68:71]
  v_exp_f32 v221, v141
  v_add_f32 v227, v227, v218
  v_mfma_f32_16x16x32_bf16 a[8:11], a[164:167], v[168:171], a[8:11]
  ds_read_b128 a[132:135], v3 offset:9216
  v_exp_f32 v222, v142
  v_mfma_f32_16x16x32_bf16 a[12:15], a[164:167], v[172:175], a[12:15]
  v_exp_f32 v223, v143
  v_mfma_f32_16x16x32_bf16 a[72:75], a[164:167], v[184:187], a[72:75]
  v_exp_f32 v208, v96
  v_mfma_f32_16x16x32_bf16 a[76:79], a[164:167], v[188:191], a[76:79]
  v_exp_f32 v209, v97
  v_mfma_f32_16x16x32_bf16 a[16:19], a[168:171], v[168:171], a[16:19]
  ds_read_b128 a[136:139], v3 offset:10240
  v_add_f32 v227, v227, v219
  v_cvt_pk_bf16_f32 v181, v218, v219
  v_add_f32 v227, v227, v220
  v_add_f32 v227, v227, v221
  v_cvt_pk_bf16_f32 v182, v220, v221
  v_mfma_f32_16x16x32_bf16 a[20:23], a[168:171], v[172:175], a[20:23]
  v_exp_f32 v210, v98
  v_mfma_f32_16x16x32_bf16 a[80:83], a[168:171], v[184:187], a[80:83]
  v_exp_f32 v211, v99
  v_mfma_f32_16x16x32_bf16 a[84:87], a[168:171], v[188:191], a[84:87]
  v_exp_f32 v212, v100
  v_mfma_f32_16x16x32_bf16 a[24:27], a[172:175], v[168:171], a[24:27]
  ds_read_b128 a[140:143], v3 offset:11264
  v_add_f32 v227, v227, v222
  v_add_f32 v227, v227, v223
  v_cvt_pk_bf16_f32 v183, v222, v223
  v_add_f32 v224, v208, v209
  v_cvt_pk_bf16_f32 v160, v208, v209
  v_mfma_f32_16x16x32_bf16 a[28:31], a[172:175], v[172:175], a[28:31]
  v_exp_f32 v213, v101
  v_mfma_f32_16x16x32_bf16 a[88:91], a[172:175], v[184:187], a[88:91]
  buffer_load_dwordx4 v2, s[48:51], s27 offen offset:2048 sc1 lds
  v_add_f32 v224, v224, v210
  v_add_f32 v224, v224, v211
  v_cvt_pk_bf16_f32 v161, v210, v211
  v_mfma_f32_16x16x32_bf16 a[92:95], a[172:175], v[188:191], a[92:95]
  s_waitcnt lgkmcnt(4)
  v_exp_f32 v214, v102
  v_mfma_f32_16x16x32_bf16 a[32:35], a[176:179], v[168:171], a[32:35]
  ds_read_b128 a[144:147], v3 offset:12288
  v_exp_f32 v215, v103
  v_mfma_f32_16x16x32_bf16 a[36:39], a[176:179], v[172:175], a[36:39]
  v_exp_f32 v208, v104
  v_mfma_f32_16x16x32_bf16 a[96:99], a[176:179], v[184:187], a[96:99]
  v_exp_f32 v209, v105
  v_mfma_f32_16x16x32_bf16 a[100:103], a[176:179], v[188:191], a[100:103]
  v_exp_f32 v210, v106
  v_mfma_f32_16x16x32_bf16 a[40:43], a[180:183], v[168:171], a[40:43]
  ds_read_b128 a[148:151], v3 offset:13312
  v_add_f32 v224, v224, v212
  v_add_f32 v224, v224, v213
  v_cvt_pk_bf16_f32 v162, v212, v213
  v_add_f32 v224, v224, v214
  v_add_f32 v224, v224, v215
  v_cvt_pk_bf16_f32 v163, v214, v215
  v_mfma_f32_16x16x32_bf16 a[44:47], a[180:183], v[172:175], a[44:47]
  v_exp_f32 v211, v107
  v_mfma_f32_16x16x32_bf16 a[104:107], a[180:183], v[184:187], a[104:107]
  v_exp_f32 v212, v108
  v_mfma_f32_16x16x32_bf16 a[108:111], a[180:183], v[188:191], a[108:111]
  v_exp_f32 v213, v109
  v_mfma_f32_16x16x32_bf16 a[48:51], a[184:187], v[168:171], a[48:51]
  ds_read_b128 a[152:155], v3 offset:14336
  v_add_f32 v225, v208, v209
  v_cvt_pk_bf16_f32 v164, v208, v209
  v_add_f32 v225, v225, v210
  v_add_f32 v225, v225, v211
  v_cvt_pk_bf16_f32 v165, v210, v211
  v_mfma_f32_16x16x32_bf16 a[52:55], a[184:187], v[172:175], a[52:55]
  v_exp_f32 v214, v110
  v_mfma_f32_16x16x32_bf16 a[112:115], a[184:187], v[184:187], a[112:115]
  buffer_load_dwordx4 v2, s[48:51], s27 offen offset:3072 sc1 lds
  v_max3_f32 v5, v226, v227, v224
  v_add_f32 v225, v225, v212
  v_add_f32 v225, v225, v213
  v_mfma_f32_16x16x32_bf16 a[116:119], a[184:187], v[188:191], a[116:119]
  s_add_u32 s27, s27, 16384
  v_exp_f32 v215, v111
  v_mfma_f32_16x16x32_bf16 a[56:59], a[188:191], v[168:171], a[56:59]
  s_add_u32 s25, s25, 32768
  ds_read_b128 a[156:159], v3 offset:15360
  v_cvt_pk_bf16_f32 v166, v212, v213
  v_add_f32 v225, v225, v214
  v_add_f32 v225, v225, v215
  v_max_f32 v5, v5, v225
  v_cmp_lt_f32 vcc, s81, v5
  v_mfma_f32_16x16x32_bf16 a[60:63], a[188:191], v[172:175], a[60:63]
  s_and_b32 s25, s25, 0x1ffff
  v_exp_f32 v216, v144
  v_mfma_f32_16x16x32_bf16 a[120:123], a[188:191], v[184:187], a[120:123]
  s_waitcnt lgkmcnt(4)
  v_cvt_pk_bf16_f32 v167, v214, v215
  v_add_u32 v3, s66, v2
  v_mfma_f32_16x16x32_bf16 a[124:127], a[188:191], v[188:191], a[124:127]
  s_cbranch_vccnz fa_stub5
fa_back5:
  v_exp_f32 v217, v145
  v_add_f32 v228, v228, v224
  v_add_f32 v229, v229, v225
  v_add_f32 v230, v230, v226
  v_add_f32 v231, v231, v227
fa_AV:
  v_mfma_f32_16x16x32_bf16 v[128:131], a[128:131], v[64:67], v[200:203]
  s_waitcnt vmcnt(12)
  v_exp_f32 v218, v146
  v_mfma_f32_16x16x32_bf16 v[136:139], a[128:131], v[68:71], v[204:207]
  s_barrier
  v_exp_f32 v219, v147
  v_mfma_f32_16x16x32_bf16 v[132:135], a[132:135], v[64:67], v[200:203]
  ds_read_b128 a[160:163], v3 offset:16384
  ds_read_b128 a[164:167], v3 offset:17408
  v_add_f32 v226, v216, v217
  v_mfma_f32_16x16x32_bf16 v[140:143], a[132:135], v[68:71], v[204:207]
  v_exp_f32 v220, v148
  v_mfma_f32_16x16x32_bf16 v[128:131], a[136:139], v[72:75], v[128:131]
  ds_read_b128 a[168:171], v3 offset:18432
  v_cvt_pk_bf16_f32 v184, v216, v217
  v_mfma_f32_16x16x32_bf16 v[136:139], a[136:139], v[76:79], v[136:139]
  s_mov_b32 m0, s24
  v_exp_f32 v221, v149
  v_mfma_f32_16x16x32_bf16 v[132:135], a[140:143], v[72:75], v[132:135]
  ds_read_b128 a[172:175], v3 offset:19456
  buffer_load_dwordx4 v2, s[44:47], s26 offen offset:0 sc1 lds
  v_add_f32 v226, v226, v218
  v_mfma_f32_16x16x32_bf16 v[140:143], a[140:143], v[76:79], v[140:143]
  s_waitcnt lgkmcnt(4)
  v_exp_f32 v222, v150
  v_mfma_f32_16x16x32_bf16 v[128:131], a[144:147], v[80:83], v[128:131]
  ds_read_b128 a[176:179], v3 offset:20480
  v_add_f32 v226, v226, v219
  v_mfma_f32_16x16x32_bf16 v[136:139], a[144:147], v[84:87], v[136:139]
  v_exp_f32 v223, v151
  v_mfma_f32_16x16x32_bf16 v[132:135], a[148:151], v[80:83], v[132:135]
  ds_read_b128 a[180:183], v3 offset:21504
  v_cvt_pk_bf16_f32 v185, v218, v219
  v_mfma_f32_16x16x32_bf16 v[140:143], a[148:151], v[84:87], v[140:143]
  v_add_f32 v226, v226, v220
  v_add_f32 v226, v226, v221
  v_mfma_f32_16x16x32_bf16 v[128:131], a[152:155], v[88:91], v[128:131]
  ds_read_b128 a[184:187], v3 offset:22528
  v_cvt_pk_bf16_f32 v186, v220, v221
  v_mfma_f32_16x16x32_bf16 v[136:139], a[152:155], v[92:95], v[136:139]
  v_exp_f32 v216, v152
  v_mfma_f32_16x16x32_bf16 v[132:135], a[156:159], v[88:91], v[132:135]
  ds_read_b128 a[188:191], v3 offset:23552
  v_add_f32 v226, v226, v222
  v_mfma_f32_16x16x32_bf16 v[140:143], a[156:159], v[92:95], v[140:143]
  s_waitcnt lgkmcnt(4)
  v_exp_f32 v217, v153
  v_mfma_f32_16x16x32_bf16 a[0:3], a[160:163], v[160:163], a[0:3]
  ds_read_b128 a[128:131], v3 offset:0
  v_add_f32 v226, v226, v223
  v_mfma_f32_16x16x32_bf16 a[4:7], a[160:163], v[164:167], a[4:7]
  v_exp_f32 v218, v154
  v_mfma_f32_16x16x32_bf16 a[64:67], a[160:163], v[176:179], a[64:67]
  buffer_load_dwordx4 v2, s[44:47], s26 offen offset:1024 sc1 lds
  v_cvt_pk_bf16_f32 v187, v222, v223
  v_mfma_f32_16x16x32_bf16 a[68:71], a[160:163], v[180:183], a[68:71]
  v_exp_f32 v219, v155
  v_mfma_f32_16x16x32_bf16 a[8:11], a[164:167], v[160:163], a[8:11]
  ds_read_b128 a[132:135], v3 offset:1024
  v_add_f32 v227, v216, v217
  v_mfma_f32_16x16x32_bf16 a[12:15], a[164:167], v[164:167], a[12:15]
  v_exp_f32 v220, v156
  v_mfma_f32_16x16x32_bf16 a[72:75], a[164:167], v[176:179], a[72:75]
  v_exp_f32 v221, v157
  v_mfma_f32_16x16x32_bf16 a[76:79], a[164:167], v[180:183], a[76:79]
  v_cvt_pk_bf16_f32 v188, v216, v217
  v_add_f32 v227, v227, v218
  v_mfma_f32_16x16x32_bf16 a[16:19], a[168:171], v[160:163], a[16:19]
  ds_read_b128 a[136:139], v3 offset:2048
  v_add_f32 v227, v227, v219
  v_mfma_f32_16x16x32_bf16 a[20:23], a[168:171], v[164:167], a[20:23]
  v_exp_f32 v222, v158
  v_mfma_f32_16x16x32_bf16 a[80:83], a[168:171], v[176:179], a[80:83]
  v_exp_f32 v223, v159
  v_mfma_f32_16x16x32_bf16 a[84:87], a[168:171], v[180:183], a[84:87]
  v_cvt_pk_bf16_f32 v189, v218, v219
  v_add_f32 v227, v227, v220
  v_mfma_f32_16x16x32_bf16 a[24:27], a[172:175], v[160:163], a[24:27]
  ds_read_b128 a[140:143], v3 offset:3072
  v_add_f32 v227, v227, v221
  v_mfma_f32_16x16x32_bf16 a[28:31], a[172:175], v[164:167], a[28:31]
  v_cvt_pk_bf16_f32 v190, v220, v221
  v_add_f32 v227, v227, v222
  v_mfma_f32_16x16x32_bf16 a[88:91], a[172:175], v[176:179], a[88:91]
  buffer_load_dwordx4 v2, s[44:47], s26 offen offset:2048 sc1 lds
  v_add_f32 v227, v227, v223
  v_mfma_f32_16x16x32_bf16 a[92:95], a[172:175], v[180:183], a[92:95]
  s_waitcnt lgkmcnt(4)
  v_max_f32 v5, v226, v227
  v_cmp_lt_f32 vcc, s81, v5
  v_mfma_f32_16x16x32_bf16 a[32:35], a[176:179], v[160:163], a[32:35]
  ds_read_b128 a[144:147], v3 offset:4096
  v_mfma_f32_16x16x32_bf16 a[36:39], a[176:179], v[164:167], a[36:39]
  v_mfma_f32_16x16x32_bf16 a[96:99], a[176:179], v[176:179], a[96:99]
  v_mfma_f32_16x16x32_bf16 a[100:103], a[176:179], v[180:183], a[100:103]
  v_mfma_f32_16x16x32_bf16 a[40:43], a[180:183], v[160:163], a[40:43]
  ds_read_b128 a[148:151], v3 offset:5120
  v_mfma_f32_16x16x32_bf16 a[44:47], a[180:183], v[164:167], a[44:47]
  v_mfma_f32_16x16x32_bf16 a[104:107], a[180:183], v[176:179], a[104:107]
  v_mfma_f32_16x16x32_bf16 a[108:111], a[180:183], v[180:183], a[108:111]
  v_mfma_f32_16x16x32_bf16 a[48:51], a[184:187], v[160:163], a[48:51]
  ds_read_b128 a[152:155], v3 offset:6144
  v_mfma_f32_16x16x32_bf16 a[52:55], a[184:187], v[164:167], a[52:55]
  v_mfma_f32_16x16x32_bf16 a[112:115], a[184:187], v[176:179], a[112:115]
  buffer_load_dwordx4 v2, s[44:47], s26 offen offset:3072 sc1 lds
  v_mfma_f32_16x16x32_bf16 a[116:119], a[184:187], v[180:183], a[116:119]
  s_add_u32 s26, s26, 16384
  v_mfma_f32_16x16x32_bf16 a[56:59], a[188:191], v[160:163], a[56:59]
  s_add_u32 s24, s24, 32768
  ds_read_b128 a[156:159], v3 offset:7168
  v_mfma_f32_16x16x32_bf16 a[60:63], a[188:191], v[164:167], a[60:63]
  s_and_b32 s24, s24, 0x1ffff
  v_exp_f32 v216, v128
  v_mfma_f32_16x16x32_bf16 a[120:123], a[188:191], v[176:179], a[120:123]
  s_waitcnt lgkmcnt(4)
  v_cvt_pk_bf16_f32 v191, v222, v223
  v_mfma_f32_16x16x32_bf16 a[124:127], a[188:191], v[180:183], a[124:127]
  s_cbranch_vccnz fa_stub6
fa_back6:
  v_exp_f32 v217, v129
  v_add_f32 v230, v230, v226
  v_add_f32 v231, v231, v227
  v_mfma_f32_16x16x32_bf16 v[144:147], a[128:131], v[64:67], v[200:203]
  ds_read_b128 a[160:163], v3 offset:24576
  v_add_f32 v226, v216, v217
  v_mfma_f32_16x16x32_bf16 v[152:155], a[128:131], v[68:71], v[204:207]
  v_exp_f32 v218, v130
  v_mfma_f32_16x16x32_bf16 v[148:151], a[132:135], v[64:67], v[200:203]
  s_add_u32 s66, s66, 32768
  ds_read_b128 a[164:167], v3 offset:25600
  v_cvt_pk_bf16_f32 v176, v216, v217
  v_mfma_f32_16x16x32_bf16 v[156:159], a[132:135], v[68:71], v[204:207]
  s_mov_b32 m0, s25
  v_exp_f32 v219, v131
  v_mfma_f32_16x16x32_bf16 v[144:147], a[136:139], v[72:75], v[144:147]
  s_and_b32 s66, s66, 0x1ffff
  ds_read_b128 a[168:171], v3 offset:26624
  buffer_load_dwordx4 v2, s[48:51], s27 offen offset:0 sc1 lds
  v_add_f32 v226, v226, v218
  v_add_f32 v226, v226, v219
  v_mfma_f32_16x16x32_bf16 v[152:155], a[136:139], v[76:79], v[152:155]
  v_exp_f32 v220, v132
  v_mfma_f32_16x16x32_bf16 v[148:151], a[140:143], v[72:75], v[148:151]
  ds_read_b128 a[172:175], v3 offset:27648
  v_cvt_pk_bf16_f32 v177, v218, v219
  v_mfma_f32_16x16x32_bf16 v[156:159], a[140:143], v[76:79], v[156:159]
  s_waitcnt lgkmcnt(4)
  v_exp_f32 v221, v133
  v_mfma_f32_16x16x32_bf16 v[144:147], a[144:147], v[80:83], v[144:147]
  ds_read_b128 a[176:179], v3 offset:28672
  v_add_f32 v226, v226, v220
  v_mfma_f32_16x16x32_bf16 v[152:155], a[144:147], v[84:87], v[152:155]
  v_exp_f32 v222, v134
  v_mfma_f32_16x16x32_bf16 v[148:151], a[148:151], v[80:83], v[148:151]
  ds_read_b128 a[180:183], v3 offset:29696
  buffer_load_dwordx4 v2, s[48:51], s27 offen offset:1024 sc1 lds
  v_add_f32 v226, v226, v221
  v_cvt_pk_bf16_f32 v178, v220, v221
  v_mfma_f32_16x16x32_bf16 v[156:159], a[148:151], v[84:87], v[156:159]
  v_exp_f32 v223, v135
  v_mfma_f32_16x16x32_bf16 v[144:147], a[152:155], v[88:91], v[144:147]
  ds_read_b128 a[184:187], v3 offset:30720
  v_add_f32 v226, v226, v222
  v_mfma_f32_16x16x32_bf16 v[152:155], a[152:155], v[92:95], v[152:155]
  v_exp_f32 v216, v136
  v_mfma_f32_16x16x32_bf16 v[148:151], a[156:159], v[88:91], v[148:151]
  ds_read_b128 a[188:191], v3 offset:31744
  v_add_f32 v226, v226, v223
  v_exp_f32 v217, v137
  v_mfma_f32_16x16x32_bf16 v[156:159], a[156:159], v[92:95], v[156:159]
  s_waitcnt lgkmcnt(4)
  v_exp_f32 v218, v138
  v_mfma_f32_16x16x32_bf16 a[64:67], a[160:163], v[184:187], a[64:67]
  ds_read_b128 a[128:131], v3 offset:8192
  v_cvt_pk_bf16_f32 v179, v222, v223
  v_mfma_f32_16x16x32_bf16 a[68:71], a[160:163], v[188:191], a[68:71]
  v_exp_f32 v219, v139
  v_mfma_f32_16x16x32_bf16 a[72:75], a[164:167], v[184:187], a[72:75]
  ds_read_b128 a[132:135], v3 offset:9216
  buffer_load_dwordx4 v2, s[48:51], s27 offen offset:2048 sc1 lds
  v_add_f32 v227, v216, v217
  v_mfma_f32_16x16x32_bf16 a[76:79], a[164:167], v[188:191], a[76:79]
  v_exp_f32 v220, v140
  v_mfma_f32_16x16x32_bf16 a[80:83], a[168:171], v[184:187], a[80:83]
  ds_read_b128 a[136:139], v3 offset:10240
  v_cvt_pk_bf16_f32 v180, v216, v217
  v_mfma_f32_16x16x32_bf16 a[84:87], a[168:171], v[188:191], a[84:87]
  v_exp_f32 v221, v141
  v_mfma_f32_16x16x32_bf16 a[88:91], a[172:175], v[184:187], a[88:91]
  ds_read_b128 a[140:143], v3 offset:11264
  v_add_f32 v227, v227, v218
  v_mfma_f32_16x16x32_bf16 a[92:95], a[172:175], v[188:191], a[92:95]
  s_waitcnt lgkmcnt(4)
  v_exp_f32 v222, v142
  v_mfma_f32_16x16x32_bf16 a[96:99], a[176:179], v[184:187], a[96:99]
  ds_read_b128 a[144:147], v3 offset:12288
  buffer_load_dwordx4 v2, s[48:51], s27 offen offset:3072 sc1 lds
  v_add_f32 v227, v227, v219
  v_cvt_pk_bf16_f32 v181, v218, v219
  v_mfma_f32_16x16x32_bf16 a[100:103], a[176:179], v[188:191], a[100:103]
  s_add_u32 s27, s27, 16384
  v_exp_f32 v223, v143
  v_mfma_f32_16x16x32_bf16 a[104:107], a[180:183], v[184:187], a[104:107]
  s_add_u32 s25, s25, 32768
  ds_read_b128 a[148:151], v3 offset:13312
  v_add_f32 v227, v227, v220
  v_mfma_f32_16x16x32_bf16 a[108:111], a[180:183], v[188:191], a[108:111]
  s_and_b32 s25, s25, 0x1ffff
  v_add_f32 v227, v227, v221
  v_cvt_pk_bf16_f32 v182, v220, v221
  v_add_f32 v227, v227, v222
  v_mfma_f32_16x16x32_bf16 a[112:115], a[184:187], v[184:187], a[112:115]
  ds_read_b128 a[152:155], v3 offset:14336
  v_add_f32 v227, v227, v223
  v_max_f32 v5, v226, v227
  v_cmp_lt_f32 vcc, s81, v5
  v_mfma_f32_16x16x32_bf16 a[116:119], a[184:187], v[188:191], a[116:119]
  v_exp_f32 v216, v144
  v_mfma_f32_16x16x32_bf16 a[120:123], a[188:191], v[184:187], a[120:123]
  s_waitcnt lgkmcnt(3)
  ds_read_b128 a[156:159], v3 offset:15360
  v_cvt_pk_bf16_f32 v183, v222, v223
  v_add_u32 v3, s66, v2
  v_mfma_f32_16x16x32_bf16 a[124:127], a[188:191], v[188:191], a[124:127]
  s_cbranch_vccnz fa_stub7
fa_back7:
  v_exp_f32 v217, v145
  v_add_f32 v230, v230, v226
  v_add_f32 v231, v231, v227
  s_branch fa_SSpre
fa_Aodd:
  v_mfma_f32_16x16x32_bf16 v[128:131], a[128:131], v[64:67], v[200:203]
  s_waitcnt vmcnt(12)
  v_exp_f32 v218, v146
  v_add_f32 v226, v216, v217
  v_mfma_f32_16x16x32_bf16 v[136:139], a[128:131], v[68:71], v[204:207]
  s_barrier
  v_exp_f32 v219, v147
  v_cvt_pk_bf16_f32 v184, v216, v217
  v_mfma_f32_16x16x32_bf16 v[132:135], a[132:135], v[64:67], v[200:203]
  ds_read_b128 a[160:163], v3 offset:16384
  ds_read_b128 a[164:167], v3 offset:17408
  v_exp_f32 v220, v148
  v_mfma_f32_16x16x32_bf16 v[140:143], a[132:135], v[68:71], v[204:207]
  v_exp_f32 v221, v149
  v_add_f32 v226, v226, v218
  v_mfma_f32_16x16x32_bf16 v[128:131], a[136:139], v[72:75], v[128:131]
  ds_read_b128 a[168:171], v3 offset:18432
  v_add_f32 v226, v226, v219
  v_cvt_pk_bf16_f32 v185, v218, v219
  v_mfma_f32_16x16x32_bf16 v[136:139], a[136:139], v[76:79], v[136:139]
  s_mov_b32 m0, s24
  v_exp_f32 v222, v150
  v_add_f32 v226, v226, v220
  v_mfma_f32_16x16x32_bf16 v[132:135], a[140:143], v[72:75], v[132:135]
  ds_read_b128 a[172:175], v3 offset:19456
  buffer_load_dwordx4 v2, s[44:47], s26 offen offset:0 sc1 lds
  v_add_f32 v226, v226, v221
  v_cvt_pk_bf16_f32 v186, v220, v221
  v_mfma_f32_16x16x32_bf16 v[140:143], a[140:143], v[76:79], v[140:143]
  s_waitcnt lgkmcnt(4)
  v_exp_f32 v223, v151
  v_cndmask_b32 v112, v4, v112, s[68:69]
  v_mfma_f32_16x16x32_bf16 v[128:131], a[144:147], v[80:83], v[128:131]
  ds_read_b128 a[176:179], v3 offset:20480
  v_cndmask_b32 v113, v4, v113, s[70:71]
  v_cndmask_b32 v114, v4, v114, s[72:73]
  v_mfma_f32_16x16x32_bf16 v[136:139], a[144:147], v[84:87], v[136:139]
  v_exp_f32 v216, v152
  v_cndmask_b32 v115, v4, v115, s[74:75]
  v_mfma_f32_16x16x32_bf16 v[132:135], a[148:151], v[80:83], v[132:135]
  ds_read_b128 a[180:183], v3 offset:21504
  v_mov_b32 v116, v4
  v_mov_b32 v117, v4
  v_mfma_f32_16x16x32_bf16 v[140:143], a[148:151], v[84:87], v[140:143]
  v_exp_f32 v217, v153
  v_mov_b32 v118, v4
  v_mfma_f32_16x16x32_bf16 v[128:131], a[152:155], v[88:91], v[128:131]
  ds_read_b128 a[184:187], v3 offset:22528
  v_mov_b32 v119, v4
  v_cndmask_b32 v124, v4, v124, s[68:69]
  v_mfma_f32_16x16x32_bf16 v[136:139], a[152:155], v[92:95], v[136:139]
  v_exp_f32 v218, v154
  v_cndmask_b32 v125, v4, v125, s[70:71]
  v_mfma_f32_16x16x32_bf16 v[132:135], a[156:159], v[88:91], v[132:135]
  ds_read_b128 a[188:191], v3 offset:23552
  v_cndmask_b32 v126, v4, v126, s[72:73]
  v_cndmask_b32 v127, v4, v127, s[74:75]
  v_mfma_f32_16x16x32_bf16 v[140:143], a[156:159], v[92:95], v[140:143]
  s_waitcnt lgkmcnt(4)
  v_exp_f32 v219, v155
  v_add_f32 v226, v226, v222
  v_mfma_f32_16x16x32_bf16 a[0:3], a[160:163], v[160:163], a[0:3]
  ds_read_b128 a[128:131], v3 offset:0
  v_add_f32 v226, v226, v223
  v_cvt_pk_bf16_f32 v187, v222, v223
  v_mfma_f32_16x16x32_bf16 a[4:7], a[160:163], v[164:167], a[4:7]
  v_exp_f32 v220, v156
  v_add_f32 v227, v216, v217
  v_mfma_f32_16x16x32_bf16 a[64:67], a[160:163], v[176:179], a[64:67]
  buffer_load_dwordx4 v2, s[44:47], s26 offen offset:1024 sc1 lds
  v_exp_f32 v221, v157
  v_mfma_f32_16x16x32_bf16 a[68:71], a[160:163], v[180:183], a[68:71]
  v_exp_f32 v222, v158
  v_mfma_f32_16x16x32_bf16 a[8:11], a[164:167], v[160:163], a[8:11]
  ds_read_b128 a[132:135], v3 offset:1024
  v_cvt_pk_bf16_f32 v188, v216, v217
  v_add_f32 v227, v227, v218
  v_add_f32 v227, v227, v219
  v_mfma_f32_16x16x32_bf16 a[12:15], a[164:167], v[164:167], a[12:15]
  v_exp_f32 v223, v159
  v_mfma_f32_16x16x32_bf16 a[72:75], a[164:167], v[176:179], a[72:75]
  v_exp_f32 v208, v112
  v_mfma_f32_16x16x32_bf16 a[76:79], a[164:167], v[180:183], a[76:79]
  v_exp_f32 v209, v113
  v_mfma_f32_16x16x32_bf16 a[16:19], a[168:171], v[160:163], a[16:19]
  ds_read_b128 a[136:139], v3 offset:2048
  v_cvt_pk_bf16_f32 v189, v218, v219
  v_add_f32 v227, v227, v220
  v_add_f32 v227, v227, v221
  v_cvt_pk_bf16_f32 v190, v220, v221
  v_add_f32 v227, v227, v222
  v_mfma_f32_16x16x32_bf16 a[20:23], a[168:171], v[164:167], a[20:23]
  v_exp_f32 v210, v114
  v_mfma_f32_16x16x32_bf16 a[80:83], a[168:171], v[176:179], a[80:83]
  v_exp_f32 v211, v115
  v_mfma_f32_16x16x32_bf16 a[84:87], a[168:171], v[180:183], a[84:87]
  v_exp_f32 v212, v116
  v_mfma_f32_16x16x32_bf16 a[24:27], a[172:175], v[160:163], a[24:27]
  ds_read_b128 a[140:143], v3 offset:3072
  v_add_f32 v227, v227, v223
  v_cvt_pk_bf16_f32 v191, v222, v223
  v_add_f32 v224, v208, v209
  v_cvt_pk_bf16_f32 v168, v208, v209
  v_add_f32 v224, v224, v210
  v_mfma_f32_16x16x32_bf16 a[28:31], a[172:175], v[164:167], a[28:31]
  v_exp_f32 v213, v117
  v_mfma_f32_16x16x32_bf16 a[88:91], a[172:175], v[176:179], a[88:91]
  buffer_load_dwordx4 v2, s[44:47], s26 offen offset:2048 sc1 lds
  v_exp_f32 v214, v118
  v_mfma_f32_16x16x32_bf16 a[92:95], a[172:175], v[180:183], a[92:95]
  s_waitcnt lgkmcnt(4)
  v_exp_f32 v215, v119
  v_mfma_f32_16x16x32_bf16 a[32:35], a[176:179], v[160:163], a[32:35]
  ds_read_b128 a[144:147], v3 offset:4096
  v_add_f32 v224, v224, v211
  v_cvt_pk_bf16_f32 v169, v210, v211
  v_add_f32 v224, v224, v212
  v_add_f32 v224, v224, v213
  v_mfma_f32_16x16x32_bf16 a[36:39], a[176:179], v[164:167], a[36:39]
  v_exp_f32 v208, v120
  v_mfma_f32_16x16x32_bf16 a[96:99], a[176:179], v[176:179], a[96:99]
  v_exp_f32 v209, v121
  v_mfma_f32_16x16x32_bf16 a[100:103], a[176:179], v[180:183], a[100:103]
  v_exp_f32 v210, v122
  v_mfma_f32_16x16x32_bf16 a[40:43], a[180:183], v[160:163], a[40:43]
  ds_read_b128 a[148:151], v3 offset:5120
  v_cvt_pk_bf16_f32 v170, v212, v213
  v_add_f32 v224, v224, v214
  v_add_f32 v224, v224, v215
  v_cvt_pk_bf16_f32 v171, v214, v215
  v_add_f32 v225, v208, v209
  v_mfma_f32_16x16x32_bf16 a[44:47], a[180:183], v[164:167], a[44:47]
  v_exp_f32 v211, v123
  v_mfma_f32_16x16x32_bf16 a[104:107], a[180:183], v[176:179], a[104:107]
  v_exp_f32 v212, v124
  v_mfma_f32_16x16x32_bf16 a[108:111], a[180:183], v[180:183], a[108:111]
  v_exp_f32 v213, v125
  v_mfma_f32_16x16x32_bf16 a[48:51], a[184:187], v[160:163], a[48:51]
  ds_read_b128 a[152:155], v3 offset:6144
  v_cvt_pk_bf16_f32 v172, v208, v209
  v_add_f32 v225, v225, v210
  v_add_f32 v225, v225, v211
  v_cvt_pk_bf16_f32 v173, v210, v211
  v_max3_f32 v5, v226, v227, v224
  v_mfma_f32_16x16x32_bf16 a[52:55], a[184:187], v[164:167], a[52:55]
  v_exp_f32 v214, v126
  v_mfma_f32_16x16x32_bf16 a[112:115], a[184:187], v[176:179], a[112:115]
  buffer_load_dwordx4 v2, s[44:47], s26 offen offset:3072 sc1 lds
  v_add_f32 v225, v225, v212
  v_add_f32 v225, v225, v213
  v_cvt_pk_bf16_f32 v174, v212, v213
  v_mfma_f32_16x16x32_bf16 a[116:119], a[184:187], v[180:183], a[116:119]
  s_add_u32 s26, s26, 16384
  v_exp_f32 v215, v127
  v_mfma_f32_16x16x32_bf16 a[56:59], a[188:191], v[160:163], a[56:59]
  s_add_u32 s24, s24, 32768
  ds_read_b128 a[156:159], v3 offset:7168
  v_add_f32 v225, v225, v214
  v_add_f32 v225, v225, v215
  v_max_f32 v5, v5, v225
  v_cmp_lt_f32 vcc, s81, v5
  v_mfma_f32_16x16x32_bf16 a[60:63], a[188:191], v[164:167], a[60:63]
  s_and_b32 s24, s24, 0x1ffff
  v_exp_f32 v216, v128
  v_mfma_f32_16x16x32_bf16 a[120:123], a[188:191], v[176:179], a[120:123]
  s_waitcnt lgkmcnt(4)
  v_cvt_pk_bf16_f32 v175, v214, v215
  v_mfma_f32_16x16x32_bf16 a[124:127], a[188:191], v[180:183], a[124:127]
  s_cbranch_vccnz fa_stub8
fa_back8:
  v_exp_f32 v217, v129
  v_add_f32 v228, v228, v224
  v_add_f32 v229, v229, v225
  v_add_f32 v230, v230, v226
  v_add_f32 v231, v231, v227
  v_mfma_f32_16x16x32_bf16 v[144:147], a[128:131], v[64:67], v[200:203]
  ds_read_b128 a[160:163], v3 offset:24576
  v_add_f32 v226, v216, v217
  v_mfma_f32_16x16x32_bf16 v[152:155], a[128:131], v[68:71], v[204:207]
  v_exp_f32 v218, v130
  v_mfma_f32_16x16x32_bf16 v[148:151], a[132:135], v[64:67], v[200:203]
  s_add_u32 s66, s66, 32768
  ds_read_b128 a[164:167], v3 offset:25600
  v_cvt_pk_bf16_f32 v176, v216, v217
  v_mfma_f32_16x16x32_bf16 v[156:159], a[132:135], v[68:71], v[204:207]
  s_and_b32 s66, s66, 0x1ffff
  v_exp_f32 v219, v131
  v_mfma_f32_16x16x32_bf16 v[144:147], a[136:139], v[72:75], v[144:147]
  ds_read_b128 a[168:171], v3 offset:26624
  v_add_f32 v226, v226, v218
  v_mfma_f32_16x16x32_bf16 v[152:155], a[136:139], v[76:79], v[152:155]
  s_mov_b32 m0, s25
  v_exp_f32 v220, v132
  v_mfma_f32_16x16x32_bf16 v[148:151], a[140:143], v[72:75], v[148:151]
  ds_read_b128 a[172:175], v3 offset:27648
  buffer_load_dwordx4 v2, s[48:51], s27 offen offset:0 sc1 lds
  v_add_f32 v226, v226, v219
  v_mfma_f32_16x16x32_bf16 v[156:159], a[140:143], v[76:79], v[156:159]
  s_waitcnt lgkmcnt(4)
  v_exp_f32 v221, v133
  v_mfma_f32_16x16x32_bf16 v[144:147], a[144:147], v[80:83], v[144:147]
  ds_read_b128 a[176:179], v3 offset:28672
  v_cvt_pk_bf16_f32 v177, v218, v219
  v_mfma_f32_16x16x32_bf16 v[152:155], a[144:147], v[84:87], v[152:155]
  v_exp_f32 v222, v134
  v_mfma_f32_16x16x32_bf16 v[148:151], a[148:151], v[80:83], v[148:151]
  ds_read_b128 a[180:183], v3 offset:29696
  v_add_f32 v226, v226, v220
  v_mfma_f32_16x16x32_bf16 v[156:159], a[148:151], v[84:87], v[156:159]
  v_exp_f32 v223, v135
  v_mfma_f32_16x16x32_bf16 v[144:147], a[152:155], v[88:91], v[144:147]
  ds_read_b128 a[184:187], v3 offset:30720
  v_add_f32 v226, v226, v221
  v_mfma_f32_16x16x32_bf16 v[152:155], a[152:155], v[92:95], v[152:155]
  v_exp_f32 v216, v136
  v_mfma_f32_16x16x32_bf16 v[148:151], a[156:159], v[88:91], v[148:151]
  ds_read_b128 a[188:191], v3 offset:31744
  v_cvt_pk_bf16_f32 v178, v220, v221
  v_mfma_f32_16x16x32_bf16 v[156:159], a[156:159], v[92:95], v[156:159]
  s_waitcnt lgkmcnt(4)
  v_exp_f32 v217, v137
  v_mfma_f32_16x16x32_bf16 a[0:3], a[160:163], v[168:171], a[0:3]
  ds_read_b128 a[128:131], v3 offset:8192
  v_add_f32 v226, v226, v222
  v_mfma_f32_16x16x32_bf16 a[4:7], a[160:163], v[172:175], a[4:7]
  v_exp_f32 v218, v138
  v_mfma_f32_16x16x32_bf16 a[64:67], a[160:163], v[184:187], a[64:67]
  buffer_load_dwordx4 v2, s[48:51], s27 offen offset:1024 sc1 lds
  v_add_f32 v226, v226, v223
  v_mfma_f32_16x16x32_bf16 a[68:71], a[160:163], v[188:191], a[68:71]
  v_exp_f32 v219, v139
  v_mfma_f32_16x16x32_bf16 a[8:11], a[164:167], v[168:171], a[8:11]
  ds_read_b128 a[132:135], v3 offset:9216
  v_cvt_pk_bf16_f32 v179, v222, v223
  v_mfma_f32_16x16x32_bf16 a[12:15], a[164:167], v[172:175], a[12:15]
  v_exp_f32 v220, v140
  v_mfma_f32_16x16x32_bf16 a[72:75], a[164:167], v[184:187], a[72:75]
  v_add_f32 v227, v216, v217
  v_cvt_pk_bf16_f32 v180, v216, v217
  v_mfma_f32_16x16x32_bf16 a[76:79], a[164:167], v[188:191], a[76:79]
  v_exp_f32 v221, v141
  v_mfma_f32_16x16x32_bf16 a[16:19], a[168:171], v[168:171], a[16:19]
  ds_read_b128 a[136:139], v3 offset:10240
  v_add_f32 v227, v227, v218
  v_mfma_f32_16x16x32_bf16 a[20:23], a[168:171], v[172:175], a[20:23]
  v_exp_f32 v222, v142
  v_mfma_f32_16x16x32_bf16 a[80:83], a[168:171], v[184:187], a[80:83]
  v_add_f32 v227, v227, v219
  v_cvt_pk_bf16_f32 v181, v218, v219
  v_mfma_f32_16x16x32_bf16 a[84:87], a[168:171], v[188:191], a[84:87]
  v_exp_f32 v223, v143
  v_mfma_f32_16x16x32_bf16 a[24:27], a[172:175], v[168:171], a[24:27]
  ds_read_b128 a[140:143], v3 offset:11264
  v_add_f32 v227, v227, v220
  v_mfma_f32_16x16x32_bf16 a[28:31], a[172:175], v[172:175], a[28:31]
  v_add_f32 v227, v227, v221
  v_cvt_pk_bf16_f32 v182, v220, v221
  v_mfma_f32_16x16x32_bf16 a[88:91], a[172:175], v[184:187], a[88:91]
  buffer_load_dwordx4 v2, s[48:51], s27 offen offset:2048 sc1 lds
  v_add_f32 v227, v227, v222
  v_mfma_f32_16x16x32_bf16 a[92:95], a[172:175], v[188:191], a[92:95]
  s_waitcnt lgkmcnt(4)
  v_add_f32 v227, v227, v223
  v_max_f32 v5, v226, v227
  v_mfma_f32_16x16x32_bf16 a[32:35], a[176:179], v[168:171], a[32:35]
  ds_read_b128 a[144:147], v3 offset:12288
  v_cmp_lt_f32 vcc, s81, v5
  v_mfma_f32_16x16x32_bf16 a[36:39], a[176:179], v[172:175], a[36:39]
  v_mfma_f32_16x16x32_bf16 a[96:99], a[176:179], v[184:187], a[96:99]
  v_mfma_f32_16x16x32_bf16 a[100:103], a[176:179], v[188:191], a[100:103]
  v_mfma_f32_16x16x32_bf16 a[40:43], a[180:183], v[168:171], a[40:43]
  ds_read_b128 a[148:151], v3 offset:13312
  v_mfma_f32_16x16x32_bf16 a[44:47], a[180:183], v[172:175], a[44:47]
  v_mfma_f32_16x16x32_bf16 a[104:107], a[180:183], v[184:187], a[104:107]
  v_mfma_f32_16x16x32_bf16 a[108:111], a[180:183], v[188:191], a[108:111]
  v_mfma_f32_16x16x32_bf16 a[48:51], a[184:187], v[168:171], a[48:51]
  ds_read_b128 a[152:155], v3 offset:14336
  v_mfma_f32_16x16x32_bf16 a[52:55], a[184:187], v[172:175], a[52:55]
  v_mfma_f32_16x16x32_bf16 a[112:115], a[184:187], v[184:187], a[112:115]
  buffer_load_dwordx4 v2, s[48:51], s27 offen offset:3072 sc1 lds
  v_mfma_f32_16x16x32_bf16 a[116:119], a[184:187], v[188:191], a[116:119]
  s_add_u32 s27, s27, 16384
  v_mfma_f32_16x16x32_bf16 a[56:59], a[188:191], v[168:171], a[56:59]
  s_add_u32 s25, s25, 32768
  ds_read_b128 a[156:159], v3 offset:15360
  v_mfma_f32_16x16x32_bf16 a[60:63], a[188:191], v[172:175], a[60:63]
  s_and_b32 s25, s25, 0x1ffff
  v_exp_f32 v216, v144
  v_mfma_f32_16x16x32_bf16 a[120:123], a[188:191], v[184:187], a[120:123]
  s_waitcnt lgkmcnt(4)
  v_cvt_pk_bf16_f32 v183, v222, v223
  v_add_u32 v3, s66, v2
  v_mfma_f32_16x16x32_bf16 a[124:127], a[188:191], v[188:191], a[124:127]
  s_cbranch_vccnz fa_stub9
fa_back9:
  v_exp_f32 v217, v145
  v_add_f32 v230, v230, v226
  v_add_f32 v231, v231, v227
fa_SSpre:
  s_mov_b32 s11, 1
  s_cmp_lg_u32 s12, 0
  s_cselect_b32 s32, s15, s32
  s_cmp_ge_u32 s20, 2
  s_cselect_b32 s23, 8, 0
  s_cmp_le_u32 s29, s23
  s_cbranch_scc1 fa_chain
.p2align 6
fa_SS:
  v_mfma_f32_16x16x32_bf16 v[128:131], a[128:131], v[64:67], v[200:203]
  s_waitcnt vmcnt(12)
  v_exp_f32 v218, v146
  v_mfma_f32_16x16x32_bf16 v[136:139], a[128:131], v[68:71], v[204:207]
  s_barrier
  v_exp_f32 v219, v147
  v_mfma_f32_16x16x32_bf16 v[132:135], a[132:135], v[64:67], v[200:203]
  s_cmp_ge_u32 s26, s32
  ds_read_b128 a[160:163], v3 offset:16384
  ds_read_b128 a[164:167], v3 offset:17408
  v_add_f32 v226, v216, v217
  v_mfma_f32_16x16x32_bf16 v[140:143], a[132:135], v[68:71], v[204:207]
  s_cbranch_scc1 fa_hk7
fa_hb7:
  v_exp_f32 v220, v148
  v_mfma_f32_16x16x32_bf16 v[128:131], a[136:139], v[72:75], v[128:131]
  ds_read_b128 a[168:171], v3 offset:18432
  v_cvt_pk_bf16_f32 v184, v216, v217
  v_mfma_f32_16x16x32_bf16 v[136:139], a[136:139], v[76:79], v[136:139]
  s_mov_b32 m0, s24
  v_exp_f32 v221, v149
  v_mfma_f32_16x16x32_bf16 v[132:135], a[140:143], v[72:75], v[132:135]
  ds_read_b128 a[172:175], v3 offset:19456
  buffer_load_dwordx4 v2, s[44:47], s26 offen offset:0 sc1 lds
  v_add_f32 v226, v226, v218
  v_add_f32 v226, v226, v219
  v_mfma_f32_16x16x32_bf16 v[140:143], a[140:143], v[76:79], v[140:143]
  s_waitcnt lgkmcnt(4)
  v_exp_f32 v222, v150
  v_mfma_f32_16x16x32_bf16 v[128:131], a[144:147], v[80:83], v[128:131]
  ds_read_b128 a[176:179], v3 offset:20480
  v_cvt_pk_bf16_f32 v185, v218, v219
  v_mfma_f32_16x16x32_bf16 v[136:139], a[144:147], v[84:87], v[136:139]
  v_exp_f32 v223, v151
  v_mfma_f32_16x16x32_bf16 v[132:135], a[148:151], v[80:83], v[132:135]
  ds_read_b128 a[180:183], v3 offset:21504
  v_add_f32 v226, v226, v220
  v_mfma_f32_16x16x32_bf16 v[140:143], a[148:151], v[84:87], v[140:143]
  v_exp_f32 v216, v152
  v_mfma_f32_16x16x32_bf16 v[128:131], a[152:155], v[88:91], v[128:131]
  ds_read_b128 a[184:187], v3 offset:22528
  buffer_load_dwordx4 v2, s[44:47], s26 offen offset:1024 sc1 lds
  v_add_f32 v226, v226, v221
  v_cvt_pk_bf16_f32 v186, v220, v221
  v_mfma_f32_16x16x32_bf16 v[136:139], a[152:155], v[92:95], v[136:139]
  v_exp_f32 v217, v153
  v_mfma_f32_16x16x32_bf16 v[132:135], a[156:159], v[88:91], v[132:135]
  ds_read_b128 a[188:191], v3 offset:23552
  v_add_f32 v226, v226, v222
  v_mfma_f32_16x16x32_bf16 v[140:143], a[156:159], v[92:95], v[140:143]
  s_waitcnt lgkmcnt(4)
  v_exp_f32 v218, v154
  v_mfma_f32_16x16x32_bf16 a[64:67], a[160:163], v[176:179], a[64:67]
  ds_read_b128 a[128:131], v3 offset:0
  v_add_f32 v226, v226, v223
  v_cvt_pk_bf16_f32 v187, v222, v223
  v_mfma_f32_16x16x32_bf16 a[68:71], a[160:163], v[180:183], a[68:71]
  v_exp_f32 v219, v155
  v_mfma_f32_16x16x32_bf16 a[72:75], a[164:167], v[176:179], a[72:75]
  ds_read_b128 a[132:135], v3 offset:1024
  buffer_load_dwordx4 v2, s[44:47], s26 offen offset:2048 sc1 lds
  v_add_f32 v227, v216, v217
  v_mfma_f32_16x16x32_bf16 a[76:79], a[164:167], v[180:183], a[76:79]
  v_exp_f32 v220, v156
  v_mfma_f32_16x16x32_bf16 a[80:83], a[168:171], v[176:179], a[80:83]
  ds_read_b128 a[136:139], v3 offset:2048
  v_cvt_pk_bf16_f32 v188, v216, v217
  v_mfma_f32_16x16x32_bf16 a[84:87], a[168:171], v[180:183], a[84:87]
  v_exp_f32 v221, v157
  v_mfma_f32_16x16x32_bf16 a[88:91], a[172:175], v[176:179], a[88:91]
  ds_read_b128 a[140:143], v3 offset:3072
  v_add_f32 v227, v227, v218
  v_add_f32 v227, v227, v219
  v_mfma_f32_16x16x32_bf16 a[92:95], a[172:175], v[180:183], a[92:95]
  s_waitcnt lgkmcnt(4)
  v_exp_f32 v222, v158
  v_mfma_f32_16x16x32_bf16 a[96:99], a[176:179], v[176:179], a[96:99]
  ds_read_b128 a[144:147], v3 offset:4096
  buffer_load_dwordx4 v2, s[44:47], s26 offen offset:3072 sc1 lds
  v_cvt_pk_bf16_f32 v189, v218, v219
  v_mfma_f32_16x16x32_bf16 a[100:103], a[176:179], v[180:183], a[100:103]
  s_add_u32 s26, s26, 16384
  v_exp_f32 v223, v159
  v_mfma_f32_16x16x32_bf16 a[104:107], a[180:183], v[176:179], a[104:107]
  s_add_u32 s24, s24, 32768
  ds_read_b128 a[148:151], v3 offset:5120
  v_add_f32 v227, v227, v220
  v_mfma_f32_16x16x32_bf16 a[108:111], a[180:183], v[180:183], a[108:111]
  s_and_b32 s24, s24, 0x1ffff
  v_add_f32 v227, v227, v221
  v_cvt_pk_bf16_f32 v190, v220, v221
  v_add_f32 v227, v227, v222
  v_mfma_f32_16x16x32_bf16 a[112:115], a[184:187], v[176:179], a[112:115]
  ds_read_b128 a[152:155], v3 offset:6144
  v_add_f32 v227, v227, v223
  v_max_f32 v5, v226, v227
  v_cmp_lt_f32 vcc, s81, v5
  v_mfma_f32_16x16x32_bf16 a[116:119], a[184:187], v[180:183], a[116:119]
  v_exp_f32 v216, v128
  v_mfma_f32_16x16x32_bf16 a[120:123], a[188:191], v[176:179], a[120:123]
  s_waitcnt lgkmcnt(3)
  ds_read_b128 a[156:159], v3 offset:7168
  v_cvt_pk_bf16_f32 v191, v222, v223
  v_mfma_f32_16x16x32_bf16 a[124:127], a[188:191], v[180:183], a[124:127]
  s_cbranch_vccnz fa_stub10
fa_back10:
  v_exp_f32 v217, v129
  v_add_f32 v230, v230, v226
  v_add_f32 v231, v231, v227
  v_mfma_f32_16x16x32_bf16 v[144:147], a[128:131], v[64:67], v[200:203]
  ds_read_b128 a[160:163], v3 offset:24576
  v_add_f32 v226, v216, v217
  v_mfma_f32_16x16x32_bf16 v[152:155], a[128:131], v[68:71], v[204:207]
  v_exp_f32 v218, v130
  v_mfma_f32_16x16x32_bf16 v[148:151], a[132:135], v[64:67], v[200:203]
  s_add_u32 s66, s66, 32768
  ds_read_b128 a[164:167], v3 offset:25600
  v_cvt_pk_bf16_f32 v176, v216, v217
  v_mfma_f32_16x16x32_bf16 v[156:159], a[132:135], v[68:71], v[204:207]
  s_mov_b32 m0, s25
  v_exp_f32 v219, v131
  v_mfma_f32_16x16x32_bf16 v[144:147], a[136:139], v[72:75], v[144:147]
  s_and_b32 s66, s66, 0x1ffff
  ds_read_b128 a[168:171], v3 offset:26624
  buffer_load_dwordx4 v2, s[48:51], s27 offen offset:0 sc1 lds
  v_add_f32 v226, v226, v218
  v_add_f32 v226, v226, v219
  v_mfma_f32_16x16x32_bf16 v[152:155], a[136:139], v[76:79], v[152:155]
  v_exp_f32 v220, v132
  v_mfma_f32_16x16x32_bf16 v[148:151], a[140:143], v[72:75], v[148:151]
  ds_read_b128 a[172:175], v3 offset:27648
  v_cvt_pk_bf16_f32 v177, v218, v219
  v_mfma_f32_16x16x32_bf16 v[156:159], a[140:143], v[76:79], v[156:159]
  s_waitcnt lgkmcnt(4)
  v_exp_f32 v221, v133
  v_mfma_f32_16x16x32_bf16 v[144:147], a[144:147], v[80:83], v[144:147]
  ds_read_b128 a[176:179], v3 offset:28672
  v_add_f32 v226, v226, v220
  v_mfma_f32_16x16x32_bf16 v[152:155], a[144:147], v[84:87], v[152:155]
  v_exp_f32 v222, v134
  v_mfma_f32_16x16x32_bf16 v[148:151], a[148:151], v[80:83], v[148:151]
  ds_read_b128 a[180:183], v3 offset:29696
  buffer_load_dwordx4 v2, s[48:51], s27 offen offset:1024 sc1 lds
  v_add_f32 v226, v226, v221
  v_cvt_pk_bf16_f32 v178, v220, v221
  v_mfma_f32_16x16x32_bf16 v[156:159], a[148:151], v[84:87], v[156:159]
  v_exp_f32 v223, v135
  v_mfma_f32_16x16x32_bf16 v[144:147], a[152:155], v[88:91], v[144:147]
  ds_read_b128 a[184:187], v3 offset:30720
  v_add_f32 v226, v226, v222
  v_mfma_f32_16x16x32_bf16 v[152:155], a[152:155], v[92:95], v[152:155]
  v_exp_f32 v216, v136
  v_mfma_f32_16x16x32_bf16 v[148:151], a[156:159], v[88:91], v[148:151]
  ds_read_b128 a[188:191], v3 offset:31744
  v_add_f32 v226, v226, v223
  v_exp_f32 v217, v137
  v_mfma_f32_16x16x32_bf16 v[156:159], a[156:159], v[92:95], v[156:159]
  s_waitcnt lgkmcnt(4)
  v_exp_f32 v218, v138
  v_mfma_f32_16x16x32_bf16 a[64:67], a[160:163], v[184:187], a[64:67]
  ds_read_b128 a[128:131], v3 offset:8192
  v_cvt_pk_bf16_f32 v179, v222, v223
  v_mfma_f32_16x16x32_bf16 a[68:71], a[160:163], v[188:191], a[68:71]
  v_exp_f32 v219, v139
  v_mfma_f32_16x16x32_bf16 a[72:75], a[164:167], v[184:187], a[72:75]
  ds_read_b128 a[132:135], v3 offset:9216
  buffer_load_dwordx4 v2, s[48:51], s27 offen offset:2048 sc1 lds
  v_add_f32 v227, v216, v217
  v_mfma_f32_16x16x32_bf16 a[76:79], a[164:167], v[188:191], a[76:79]
  v_exp_f32 v220, v140
  v_mfma_f32_16x16x32_bf16 a[80:83], a[168:171], v[184:187], a[80:83]
  ds_read_b128 a[136:139], v3 offset:10240
  v_cvt_pk_bf16_f32 v180, v216, v217
  v_mfma_f32_16x16x32_bf16 a[84:87], a[168:171], v[188:191], a[84:87]
  v_exp_f32 v221, v141
  v_mfma_f32_16x16x32_bf16 a[88:91], a[172:175], v[184:187], a[88:91]
  ds_read_b128 a[140:143], v3 offset:11264
  v_add_f32 v227, v227, v218
  v_mfma_f32_16x16x32_bf16 a[92:95], a[172:175], v[188:191], a[92:95]
  s_waitcnt lgkmcnt(4)
  v_exp_f32 v222, v142
  v_mfma_f32_16x16x32_bf16 a[96:99], a[176:179], v[184:187], a[96:99]
  ds_read_b128 a[144:147], v3 offset:12288
  buffer_load_dwordx4 v2, s[48:51], s27 offen offset:3072 sc1 lds
  v_add_f32 v227, v227, v219
  v_cvt_pk_bf16_f32 v181, v218, v219
  v_mfma_f32_16x16x32_bf16 a[100:103], a[176:179], v[188:191], a[100:103]
  s_add_u32 s27, s27, 16384
  v_exp_f32 v223, v143
  v_mfma_f32_16x16x32_bf16 a[104:107], a[180:183], v[184:187], a[104:107]
  s_add_u32 s25, s25, 32768
  ds_read_b128 a[148:151], v3 offset:13312
  v_add_f32 v227, v227, v220
  v_mfma_f32_16x16x32_bf16 a[108:111], a[180:183], v[188:191], a[108:111]
  s_and_b32 s25, s25, 0x1ffff
  v_add_f32 v227, v227, v221
  v_cvt_pk_bf16_f32 v182, v220, v221
  v_add_f32 v227, v227, v222
  v_mfma_f32_16x16x32_bf16 a[112:115], a[184:187], v[184:187], a[112:115]
  s_sub_u32 s29, s29, 1
  ds_read_b128 a[152:155], v3 offset:14336
  v_add_f32 v227, v227, v223
  v_max_f32 v5, v226, v227
  v_cmp_lt_f32 vcc, s81, v5
  v_mfma_f32_16x16x32_bf16 a[116:119], a[184:187], v[188:191], a[116:119]
  s_cmp_gt_u32 s29, 8
  v_exp_f32 v216, v144
  v_mfma_f32_16x16x32_bf16 a[120:123], a[188:191], v[184:187], a[120:123]
  s_waitcnt lgkmcnt(3)
  ds_read_b128 a[156:159], v3 offset:15360
  v_cvt_pk_bf16_f32 v183, v222, v223
  v_add_u32 v3, s66, v2
  v_mfma_f32_16x16x32_bf16 a[124:127], a[188:191], v[188:191], a[124:127]
  s_cbranch_vccnz fa_stub11
fa_back11:
  v_exp_f32 v217, v145
  v_add_f32 v230, v230, v226
  v_add_f32 v231, v231, v227
  s_cbranch_scc1 fa_SS
fa_chain:
  s_setprio 3
fa_hb8:
  s_cmp_lt_u32 s12, 2
  s_cbranch_scc1 fa_hk8
  s_cmp_eq_u32 s29, 8
  s_cbranch_scc0 fa_disp
fa_SSW8:
  v_mfma_f32_16x16x32_bf16 v[128:131], a[128:131], v[64:67], v[200:203]
  s_waitcnt vmcnt(12)
  v_exp_f32 v218, v146
  v_mfma_f32_16x16x32_bf16 v[136:139], a[128:131], v[68:71], v[204:207]
  s_barrier
  v_exp_f32 v219, v147
  v_mfma_f32_16x16x32_bf16 v[132:135], a[132:135], v[64:67], v[200:203]
  ds_read_b128 a[160:163], v3 offset:16384
  ds_read_b128 a[164:167], v3 offset:17408
  v_add_f32 v226, v216, v217
  v_mfma_f32_16x16x32_bf16 v[140:143], a[132:135], v[68:71], v[204:207]
  s_mov_b32 m0, s24
  v_exp_f32 v220, v148
  v_mfma_f32_16x16x32_bf16 v[128:131], a[136:139], v[72:75], v[128:131]
  ds_read_b128 a[168:171], v3 offset:18432
  buffer_load_dwordx4 v2, s[44:47], s26 offen offset:0 sc1 lds
  v_cvt_pk_bf16_f32 v184, v216, v217
  v_mfma_f32_16x16x32_bf16 v[136:139], a[136:139], v[76:79], v[136:139]
  v_exp_f32 v221, v149
  v_mfma_f32_16x16x32_bf16 v[132:135], a[140:143], v[72:75], v[132:135]
  ds_read_b128 a[172:175], v3 offset:19456
  v_add_f32 v226, v226, v218
  v_add_f32 v226, v226, v219
  v_mfma_f32_16x16x32_bf16 v[140:143], a[140:143], v[76:79], v[140:143]
  s_waitcnt lgkmcnt(4)
  v_exp_f32 v222, v150
  v_mfma_f32_16x16x32_bf16 v[128:131], a[144:147], v[80:83], v[128:131]
  ds_read_b128 a[176:179], v3 offset:20480
  v_cvt_pk_bf16_f32 v185, v218, v219
  v_mfma_f32_16x16x32_bf16 v[136:139], a[144:147], v[84:87], v[136:139]
  v_exp_f32 v223, v151
  v_mfma_f32_16x16x32_bf16 v[132:135], a[148:151], v[80:83], v[132:135]
  ds_read_b128 a[180:183], v3 offset:21504
  buffer_load_dwordx4 v2, s[44:47], s26 offen offset:1024 sc1 lds
  v_add_f32 v226, v226, v220
  v_mfma_f32_16x16x32_bf16 v[140:143], a[148:151], v[84:87], v[140:143]
  v_exp_f32 v216, v152
  v_mfma_f32_16x16x32_bf16 v[128:131], a[152:155], v[88:91], v[128:131]
  ds_read_b128 a[184:187], v3 offset:22528
  v_add_f32 v226, v226, v221
  v_cvt_pk_bf16_f32 v186, v220, v221
  v_mfma_f32_16x16x32_bf16 v[136:139], a[152:155], v[92:95], v[136:139]
  v_exp_f32 v217, v153
  v_mfma_f32_16x16x32_bf16 v[132:135], a[156:159], v[88:91], v[132:135]
  s_add_u32 s14, s13, 0
  ds_read_b128 a[188:191], v3 offset:23552
  buffer_load_dwordx4 a[192:195], v2, s[40:43], s14 offen offset:0 sc1
  v_add_f32 v226, v226, v222
  v_mfma_f32_16x16x32_bf16 v[140:143], a[156:159], v[92:95], v[140:143]
  s_waitcnt lgkmcnt(4)
  v_exp_f32 v218, v154
  v_mfma_f32_16x16x32_bf16 a[64:67], a[160:163], v[176:179], a[64:67]
  ds_read_b128 a[128:131], v3 offset:0
  v_add_f32 v226, v226, v223
  v_cvt_pk_bf16_f32 v187, v222, v223
  v_mfma_f32_16x16x32_bf16 a[68:71], a[160:163], v[180:183], a[68:71]
  v_exp_f32 v219, v155
  v_mfma_f32_16x16x32_bf16 a[72:75], a[164:167], v[176:179], a[72:75]
  ds_read_b128 a[132:135], v3 offset:1024
  buffer_load_dwordx4 v2, s[44:47], s26 offen offset:2048 sc1 lds
  v_add_f32 v227, v216, v217
  v_mfma_f32_16x16x32_bf16 a[76:79], a[164:167], v[180:183], a[76:79]
  v_exp_f32 v220, v156
  v_mfma_f32_16x16x32_bf16 a[80:83], a[168:171], v[176:179], a[80:83]
  ds_read_b128 a[136:139], v3 offset:2048
  v_cvt_pk_bf16_f32 v188, v216, v217
  v_mfma_f32_16x16x32_bf16 a[84:87], a[168:171], v[180:183], a[84:87]
  v_exp_f32 v221, v157
  v_mfma_f32_16x16x32_bf16 a[88:91], a[172:175], v[176:179], a[88:91]
  ds_read_b128 a[140:143], v3 offset:3072
  v_add_f32 v227, v227, v218
  v_add_f32 v227, v227, v219
  v_mfma_f32_16x16x32_bf16 a[92:95], a[172:175], v[180:183], a[92:95]
  s_waitcnt lgkmcnt(4)
  v_exp_f32 v222, v158
  v_mfma_f32_16x16x32_bf16 a[96:99], a[176:179], v[176:179], a[96:99]
  ds_read_b128 a[144:147], v3 offset:4096
  buffer_load_dwordx4 v2, s[44:47], s26 offen offset:3072 sc1 lds
  v_cvt_pk_bf16_f32 v189, v218, v219
  v_mfma_f32_16x16x32_bf16 a[100:103], a[176:179], v[180:183], a[100:103]
  s_add_u32 s26, s26, 16384
  v_exp_f32 v223, v159
  v_mfma_f32_16x16x32_bf16 a[104:107], a[180:183], v[176:179], a[104:107]
  s_add_u32 s24, s24, 32768
  ds_read_b128 a[148:151], v3 offset:5120
  v_add_f32 v227, v227, v220
  v_mfma_f32_16x16x32_bf16 a[108:111], a[180:183], v[180:183], a[108:111]
  s_and_b32 s24, s24, 0x1ffff
  v_add_f32 v227, v227, v221
  v_cvt_pk_bf16_f32 v190, v220, v221
  v_add_f32 v227, v227, v222
  v_mfma_f32_16x16x32_bf16 a[112:115], a[184:187], v[176:179], a[112:115]
  ds_read_b128 a[152:155], v3 offset:6144
  v_add_f32 v227, v227, v223
  v_max_f32 v5, v226, v227
  v_cmp_lt_f32 vcc, s81, v5
  v_mfma_f32_16x16x32_bf16 a[116:119], a[184:187], v[180:183], a[116:119]
  v_exp_f32 v216, v128
  v_mfma_f32_16x16x32_bf16 a[120:123], a[188:191], v[176:179], a[120:123]
  s_waitcnt lgkmcnt(3)
  ds_read_b128 a[156:159], v3 offset:7168
  v_cvt_pk_bf16_f32 v191, v222, v223
  v_mfma_f32_16x16x32_bf16 a[124:127], a[188:191], v[180:183], a[124:127]
  s_cbranch_vccnz fa_stub12
fa_back12:
  v_exp_f32 v217, v129
  v_add_f32 v230, v230, v226
  v_add_f32 v231, v231, v227
  v_mfma_f32_16x16x32_bf16 v[144:147], a[128:131], v[64:67], v[200:203]
  ds_read_b128 a[160:163], v3 offset:24576
  v_add_f32 v226, v216, v217
  v_mfma_f32_16x16x32_bf16 v[152:155], a[128:131], v[68:71], v[204:207]
  v_exp_f32 v218, v130
  v_mfma_f32_16x16x32_bf16 v[148:151], a[132:135], v[64:67], v[200:203]
  s_add_u32 s66, s66, 32768
  ds_read_b128 a[164:167], v3 offset:25600
  v_cvt_pk_bf16_f32 v176, v216, v217
  v_mfma_f32_16x16x32_bf16 v[156:159], a[132:135], v[68:71], v[204:207]
  s_mov_b32 m0, s25
  v_exp_f32 v219, v131
  v_mfma_f32_16x16x32_bf16 v[144:147], a[136:139], v[72:75], v[144:147]
  s_and_b32 s66, s66, 0x1ffff
  ds_read_b128 a[168:171], v3 offset:26624
  buffer_load_dwordx4 v2, s[48:51], s27 offen offset:0 sc1 lds
  v_add_f32 v226, v226, v218
  v_add_f32 v226, v226, v219
  v_mfma_f32_16x16x32_bf16 v[152:155], a[136:139], v[76:79], v[152:155]
  v_exp_f32 v220, v132
  v_mfma_f32_16x16x32_bf16 v[148:151], a[140:143], v[72:75], v[148:151]
  ds_read_b128 a[172:175], v3 offset:27648
  v_cvt_pk_bf16_f32 v177, v218, v219
  v_mfma_f32_16x16x32_bf16 v[156:159], a[140:143], v[76:79], v[156:159]
  s_waitcnt lgkmcnt(4)
  v_exp_f32 v221, v133
  v_mfma_f32_16x16x32_bf16 v[144:147], a[144:147], v[80:83], v[144:147]
  s_add_u32 s14, s13, 0
  ds_read_b128 a[176:179], v3 offset:28672
  buffer_load_dwordx4 a[196:199], v2, s[40:43], s14 offen offset:1024 sc1
  v_add_f32 v226, v226, v220
  v_mfma_f32_16x16x32_bf16 v[152:155], a[144:147], v[84:87], v[152:155]
  v_exp_f32 v222, v134
  v_mfma_f32_16x16x32_bf16 v[148:151], a[148:151], v[80:83], v[148:151]
  ds_read_b128 a[180:183], v3 offset:29696
  buffer_load_dwordx4 v2, s[48:51], s27 offen offset:1024 sc1 lds
  v_add_f32 v226, v226, v221
  v_cvt_pk_bf16_f32 v178, v220, v221
  v_mfma_f32_16x16x32_bf16 v[156:159], a[148:151], v[84:87], v[156:159]
  v_exp_f32 v223, v135
  v_mfma_f32_16x16x32_bf16 v[144:147], a[152:155], v[88:91], v[144:147]
  ds_read_b128 a[184:187], v3 offset:30720
  v_add_f32 v226, v226, v222
  v_mfma_f32_16x16x32_bf16 v[152:155], a[152:155], v[92:95], v[152:155]
  v_exp_f32 v216, v136
  v_mfma_f32_16x16x32_bf16 v[148:151], a[156:159], v[88:91], v[148:151]
  ds_read_b128 a[188:191], v3 offset:31744
  v_add_f32 v226, v226, v223
  v_exp_f32 v217, v137
  v_mfma_f32_16x16x32_bf16 v[156:159], a[156:159], v[92:95], v[156:159]
  s_waitcnt lgkmcnt(4)
  v_exp_f32 v218, v138
  v_mfma_f32_16x16x32_bf16 a[64:67], a[160:163], v[184:187], a[64:67]
  ds_read_b128 a[128:131], v3 offset:8192
  v_cvt_pk_bf16_f32 v179, v222, v223
  v_mfma_f32_16x16x32_bf16 a[68:71], a[160:163], v[188:191], a[68:71]
  v_exp_f32 v219, v139
  v_mfma_f32_16x16x32_bf16 a[72:75], a[164:167], v[184:187], a[72:75]
  ds_read_b128 a[132:135], v3 offset:9216
  buffer_load_dwordx4 v2, s[48:51], s27 offen offset:2048 sc1 lds
  v_add_f32 v227, v216, v217
  v_mfma_f32_16x16x32_bf16 a[76:79], a[164:167], v[188:191], a[76:79]
  v_exp_f32 v220, v140
  v_mfma_f32_16x16x32_bf16 a[80:83], a[168:171], v[184:187], a[80:83]
  ds_read_b128 a[136:139], v3 offset:10240
  v_cvt_pk_bf16_f32 v180, v216, v217
  v_mfma_f32_16x16x32_bf16 a[84:87], a[168:171], v[188:191], a[84:87]
  v_exp_f32 v221, v141
  v_mfma_f32_16x16x32_bf16 a[88:91], a[172:175], v[184:187], a[88:91]
  ds_read_b128 a[140:143], v3 offset:11264
  buffer_load_dwordx4 a[200:203], v2, s[40:43], s14 offen offset:2048 sc1
  v_add_f32 v227, v227, v218
  v_mfma_f32_16x16x32_bf16 a[92:95], a[172:175], v[188:191], a[92:95]
  s_waitcnt lgkmcnt(4)
  v_exp_f32 v222, v142
  v_mfma_f32_16x16x32_bf16 a[96:99], a[176:179], v[184:187], a[96:99]
  ds_read_b128 a[144:147], v3 offset:12288
  buffer_load_dwordx4 v2, s[48:51], s27 offen offset:3072 sc1 lds
  v_add_f32 v227, v227, v219
  v_cvt_pk_bf16_f32 v181, v218, v219
  v_mfma_f32_16x16x32_bf16 a[100:103], a[176:179], v[188:191], a[100:103]
  s_add_u32 s27, s27, 16384
  v_exp_f32 v223, v143
  v_mfma_f32_16x16x32_bf16 a[104:107], a[180:183], v[184:187], a[104:107]
  s_add_u32 s25, s25, 32768
  ds_read_b128 a[148:151], v3 offset:13312
  v_add_f32 v227, v227, v220
  v_mfma_f32_16x16x32_bf16 a[108:111], a[180:183], v[188:191], a[108:111]
  s_and_b32 s25, s25, 0x1ffff
  v_add_f32 v227, v227, v221
  v_cvt_pk_bf16_f32 v182, v220, v221
  v_add_f32 v227, v227, v222
  v_mfma_f32_16x16x32_bf16 a[112:115], a[184:187], v[184:187], a[112:115]
  ds_read_b128 a[152:155], v3 offset:14336
  v_add_f32 v227, v227, v223
  v_max_f32 v5, v226, v227
  v_cmp_lt_f32 vcc, s81, v5
  v_mfma_f32_16x16x32_bf16 a[116:119], a[184:187], v[188:191], a[116:119]
  v_exp_f32 v216, v144
  v_mfma_f32_16x16x32_bf16 a[120:123], a[188:191], v[184:187], a[120:123]
  s_waitcnt lgkmcnt(3)
  ds_read_b128 a[156:159], v3 offset:15360
  v_cvt_pk_bf16_f32 v183, v222, v223
  v_add_u32 v3, s66, v2
  v_mfma_f32_16x16x32_bf16 a[124:127], a[188:191], v[188:191], a[124:127]
  s_cbranch_vccnz fa_stub13
fa_back13:
  v_exp_f32 v217, v145
  v_add_f32 v230, v230, v226
  v_add_f32 v231, v231, v227
fa_SSW7:
  v_mfma_f32_16x16x32_bf16 v[128:131], a[128:131], v[64:67], v[200:203]
  s_waitcnt vmcnt(12)
  v_exp_f32 v218, v146
  v_mfma_f32_16x16x32_bf16 v[136:139], a[128:131], v[68:71], v[204:207]
  s_barrier
  v_exp_f32 v219, v147
  v_mfma_f32_16x16x32_bf16 v[132:135], a[132:135], v[64:67], v[200:203]
  ds_read_b128 a[160:163], v3 offset:16384
  ds_read_b128 a[164:167], v3 offset:17408
  v_add_f32 v226, v216, v217
  v_mfma_f32_16x16x32_bf16 v[140:143], a[132:135], v[68:71], v[204:207]
  s_mov_b32 m0, s24
  v_exp_f32 v220, v148
  v_mfma_f32_16x16x32_bf16 v[128:131], a[136:139], v[72:75], v[128:131]
  ds_read_b128 a[168:171], v3 offset:18432
  buffer_load_dwordx4 v2, s[44:47], s26 offen offset:0 sc1 lds
  v_cvt_pk_bf16_f32 v184, v216, v217
  v_mfma_f32_16x16x32_bf16 v[136:139], a[136:139], v[76:79], v[136:139]
  v_exp_f32 v221, v149
  v_mfma_f32_16x16x32_bf16 v[132:135], a[140:143], v[72:75], v[132:135]
  ds_read_b128 a[172:175], v3 offset:19456
  v_add_f32 v226, v226, v218
  v_add_f32 v226, v226, v219
  v_mfma_f32_16x16x32_bf16 v[140:143], a[140:143], v[76:79], v[140:143]
  s_waitcnt lgkmcnt(4)
  v_exp_f32 v222, v150
  v_mfma_f32_16x16x32_bf16 v[128:131], a[144:147], v[80:83], v[128:131]
  ds_read_b128 a[176:179], v3 offset:20480
  v_cvt_pk_bf16_f32 v185, v218, v219
  v_mfma_f32_16x16x32_bf16 v[136:139], a[144:147], v[84:87], v[136:139]
  v_exp_f32 v223, v151
  v_mfma_f32_16x16x32_bf16 v[132:135], a[148:151], v[80:83], v[132:135]
  ds_read_b128 a[180:183], v3 offset:21504
  buffer_load_dwordx4 v2, s[44:47], s26 offen offset:1024 sc1 lds
  v_add_f32 v226, v226, v220
  v_mfma_f32_16x16x32_bf16 v[140:143], a[148:151], v[84:87], v[140:143]
  v_exp_f32 v216, v152
  v_mfma_f32_16x16x32_bf16 v[128:131], a[152:155], v[88:91], v[128:131]
  ds_read_b128 a[184:187], v3 offset:22528
  v_add_f32 v226, v226, v221
  v_cvt_pk_bf16_f32 v186, v220, v221
  v_mfma_f32_16x16x32_bf16 v[136:139], a[152:155], v[92:95], v[136:139]
  v_exp_f32 v217, v153
  v_mfma_f32_16x16x32_bf16 v[132:135], a[156:159], v[88:91], v[132:135]
  s_add_u32 s14, s13, 0
  ds_read_b128 a[188:191], v3 offset:23552
  buffer_load_dwordx4 a[204:207], v2, s[40:43], s14 offen offset:3072 sc1
  v_add_f32 v226, v226, v222
  v_mfma_f32_16x16x32_bf16 v[140:143], a[156:159], v[92:95], v[140:143]
  s_waitcnt lgkmcnt(4)
  v_exp_f32 v218, v154
  v_mfma_f32_16x16x32_bf16 a[64:67], a[160:163], v[176:179], a[64:67]
  ds_read_b128 a[128:131], v3 offset:0
  v_add_f32 v226, v226, v223
  v_cvt_pk_bf16_f32 v187, v222, v223
  v_mfma_f32_16x16x32_bf16 a[68:71], a[160:163], v[180:183], a[68:71]
  v_exp_f32 v219, v155
  v_mfma_f32_16x16x32_bf16 a[72:75], a[164:167], v[176:179], a[72:75]
  ds_read_b128 a[132:135], v3 offset:1024
  buffer_load_dwordx4 v2, s[44:47], s26 offen offset:2048 sc1 lds
  v_add_f32 v227, v216, v217
  v_mfma_f32_16x16x32_bf16 a[76:79], a[164:167], v[180:183], a[76:79]
  v_exp_f32 v220, v156
  v_mfma_f32_16x16x32_bf16 a[80:83], a[168:171], v[176:179], a[80:83]
  ds_read_b128 a[136:139], v3 offset:2048
  v_cvt_pk_bf16_f32 v188, v216, v217
  v_mfma_f32_16x16x32_bf16 a[84:87], a[168:171], v[180:183], a[84:87]
  v_exp_f32 v221, v157
  v_mfma_f32_16x16x32_bf16 a[88:91], a[172:175], v[176:179], a[88:91]
  ds_read_b128 a[140:143], v3 offset:3072
  v_add_f32 v227, v227, v218
  v_add_f32 v227, v227, v219
  v_mfma_f32_16x16x32_bf16 a[92:95], a[172:175], v[180:183], a[92:95]
  s_waitcnt lgkmcnt(4)
  v_exp_f32 v222, v158
  v_mfma_f32_16x16x32_bf16 a[96:99], a[176:179], v[176:179], a[96:99]
  ds_read_b128 a[144:147], v3 offset:4096
  buffer_load_dwordx4 v2, s[44:47], s26 offen offset:3072 sc1 lds
  v_cvt_pk_bf16_f32 v189, v218, v219
  v_mfma_f32_16x16x32_bf16 a[100:103], a[176:179], v[180:183], a[100:103]
  s_add_u32 s26, s26, 16384
  v_exp_f32 v223, v159
  v_mfma_f32_16x16x32_bf16 a[104:107], a[180:183], v[176:179], a[104:107]
  s_add_u32 s24, s24, 32768
  ds_read_b128 a[148:151], v3 offset:5120
  v_add_f32 v227, v227, v220
  v_mfma_f32_16x16x32_bf16 a[108:111], a[180:183], v[180:183], a[108:111]
  s_and_b32 s24, s24, 0x1ffff
  v_add_f32 v227, v227, v221
  v_cvt_pk_bf16_f32 v190, v220, v221
  v_add_f32 v227, v227, v222
  v_mfma_f32_16x16x32_bf16 a[112:115], a[184:187], v[176:179], a[112:115]
  ds_read_b128 a[152:155], v3 offset:6144
  v_add_f32 v227, v227, v223
  v_max_f32 v5, v226, v227
  v_cmp_lt_f32 vcc, s81, v5
  v_mfma_f32_16x16x32_bf16 a[116:119], a[184:187], v[180:183], a[116:119]
  v_exp_f32 v216, v128
  v_mfma_f32_16x16x32_bf16 a[120:123], a[188:191], v[176:179], a[120:123]
  s_waitcnt lgkmcnt(3)
  ds_read_b128 a[156:159], v3 offset:7168
  v_cvt_pk_bf16_f32 v191, v222, v223
  v_mfma_f32_16x16x32_bf16 a[124:127], a[188:191], v[180:183], a[124:127]
  s_cbranch_vccnz fa_stub14
fa_back14:
  v_exp_f32 v217, v129
  v_add_f32 v230, v230, v226
  v_add_f32 v231, v231, v227
  v_mfma_f32_16x16x32_bf16 v[144:147], a[128:131], v[64:67], v[200:203]
  ds_read_b128 a[160:163], v3 offset:24576
  v_add_f32 v226, v216, v217
  v_mfma_f32_16x16x32_bf16 v[152:155], a[128:131], v[68:71], v[204:207]
  v_exp_f32 v218, v130
  v_mfma_f32_16x16x32_bf16 v[148:151], a[132:135], v[64:67], v[200:203]
  s_add_u32 s66, s66, 32768
  ds_read_b128 a[164:167], v3 offset:25600
  v_cvt_pk_bf16_f32 v176, v216, v217
  v_mfma_f32_16x16x32_bf16 v[156:159], a[132:135], v[68:71], v[204:207]
  s_mov_b32 m0, s25
  v_exp_f32 v219, v131
  v_mfma_f32_16x16x32_bf16 v[144:147], a[136:139], v[72:75], v[144:147]
  s_and_b32 s66, s66, 0x1ffff
  ds_read_b128 a[168:171], v3 offset:26624
  buffer_load_dwordx4 v2, s[48:51], s27 offen offset:0 sc1 lds
  v_add_f32 v226, v226, v218
  v_add_f32 v226, v226, v219
  v_mfma_f32_16x16x32_bf16 v[152:155], a[136:139], v[76:79], v[152:155]
  v_exp_f32 v220, v132
  v_mfma_f32_16x16x32_bf16 v[148:151], a[140:143], v[72:75], v[148:151]
  ds_read_b128 a[172:175], v3 offset:27648
  v_cvt_pk_bf16_f32 v177, v218, v219
  v_mfma_f32_16x16x32_bf16 v[156:159], a[140:143], v[76:79], v[156:159]
  s_waitcnt lgkmcnt(4)
  v_exp_f32 v221, v133
  v_mfma_f32_16x16x32_bf16 v[144:147], a[144:147], v[80:83], v[144:147]
  s_add_u32 s14, s13, 4096
  ds_read_b128 a[176:179], v3 offset:28672
  buffer_load_dwordx4 a[208:211], v2, s[40:43], s14 offen offset:0 sc1
  v_add_f32 v226, v226, v220
  v_mfma_f32_16x16x32_bf16 v[152:155], a[144:147], v[84:87], v[152:155]
  v_exp_f32 v222, v134
  v_mfma_f32_16x16x32_bf16 v[148:151], a[148:151], v[80:83], v[148:151]
  ds_read_b128 a[180:183], v3 offset:29696
  buffer_load_dwordx4 v2, s[48:51], s27 offen offset:1024 sc1 lds
  v_add_f32 v226, v226, v221
  v_cvt_pk_bf16_f32 v178, v220, v221
  v_mfma_f32_16x16x32_bf16 v[156:159], a[148:151], v[84:87], v[156:159]
  v_exp_f32 v223, v135
  v_mfma_f32_16x16x32_bf16 v[144:147], a[152:155], v[88:91], v[144:147]
  ds_read_b128 a[184:187], v3 offset:30720
  v_add_f32 v226, v226, v222
  v_mfma_f32_16x16x32_bf16 v[152:155], a[152:155], v[92:95], v[152:155]
  v_exp_f32 v216, v136
  v_mfma_f32_16x16x32_bf16 v[148:151], a[156:159], v[88:91], v[148:151]
  ds_read_b128 a[188:191], v3 offset:31744
  v_add_f32 v226, v226, v223
  v_exp_f32 v217, v137
  v_mfma_f32_16x16x32_bf16 v[156:159], a[156:159], v[92:95], v[156:159]
  s_waitcnt lgkmcnt(4)
  v_exp_f32 v218, v138
  v_mfma_f32_16x16x32_bf16 a[64:67], a[160:163], v[184:187], a[64:67]
  ds_read_b128 a[128:131], v3 offset:8192
  v_cvt_pk_bf16_f32 v179, v222, v223
  v_mfma_f32_16x16x32_bf16 a[68:71], a[160:163], v[188:191], a[68:71]
  v_exp_f32 v219, v139
  v_mfma_f32_16x16x32_bf16 a[72:75], a[164:167], v[184:187], a[72:75]
  ds_read_b128 a[132:135], v3 offset:9216
  buffer_load_dwordx4 v2, s[48:51], s27 offen offset:2048 sc1 lds
  v_add_f32 v227, v216, v217
  v_mfma_f32_16x16x32_bf16 a[76:79], a[164:167], v[188:191], a[76:79]
  v_exp_f32 v220, v140
  v_mfma_f32_16x16x32_bf16 a[80:83], a[168:171], v[184:187], a[80:83]
  ds_read_b128 a[136:139], v3 offset:10240
  v_cvt_pk_bf16_f32 v180, v216, v217
  v_mfma_f32_16x16x32_bf16 a[84:87], a[168:171], v[188:191], a[84:87]
  v_exp_f32 v221, v141
  v_mfma_f32_16x16x32_bf16 a[88:91], a[172:175], v[184:187], a[88:91]
  ds_read_b128 a[140:143], v3 offset:11264
  buffer_load_dwordx4 a[212:215], v2, s[40:43], s14 offen offset:1024 sc1
  v_add_f32 v227, v227, v218
  v_mfma_f32_16x16x32_bf16 a[92:95], a[172:175], v[188:191], a[92:95]
  s_waitcnt lgkmcnt(4)
  v_exp_f32 v222, v142
  v_mfma_f32_16x16x32_bf16 a[96:99], a[176:179], v[184:187], a[96:99]
  ds_read_b128 a[144:147], v3 offset:12288
  buffer_load_dwordx4 v2, s[48:51], s27 offen offset:3072 sc1 lds
  v_add_f32 v227, v227, v219
  v_cvt_pk_bf16_f32 v181, v218, v219
  v_mfma_f32_16x16x32_bf16 a[100:103], a[176:179], v[188:191], a[100:103]
  s_add_u32 s27, s27, 16384
  v_exp_f32 v223, v143
  v_mfma_f32_16x16x32_bf16 a[104:107], a[180:183], v[184:187], a[104:107]
  s_add_u32 s25, s25, 32768
  ds_read_b128 a[148:151], v3 offset:13312
  v_add_f32 v227, v227, v220
  v_mfma_f32_16x16x32_bf16 a[108:111], a[180:183], v[188:191], a[108:111]
  s_and_b32 s25, s25, 0x1ffff
  v_add_f32 v227, v227, v221
  v_cvt_pk_bf16_f32 v182, v220, v221
  v_add_f32 v227, v227, v222
  v_mfma_f32_16x16x32_bf16 a[112:115], a[184:187], v[184:187], a[112:115]
  ds_read_b128 a[152:155], v3 offset:14336
  v_add_f32 v227, v227, v223
  v_max_f32 v5, v226, v227
  v_cmp_lt_f32 vcc, s81, v5
  v_mfma_f32_16x16x32_bf16 a[116:119], a[184:187], v[188:191], a[116:119]
  v_exp_f32 v216, v144
  v_mfma_f32_16x16x32_bf16 a[120:123], a[188:191], v[184:187], a[120:123]
  s_waitcnt lgkmcnt(3)
  ds_read_b128 a[156:159], v3 offset:15360
  v_cvt_pk_bf16_f32 v183, v222, v223
  v_add_u32 v3, s66, v2
  v_mfma_f32_16x16x32_bf16 a[124:127], a[188:191], v[188:191], a[124:127]
  s_cbranch_vccnz fa_stub15
fa_back15:
  v_exp_f32 v217, v145
  v_add_f32 v230, v230, v226
  v_add_f32 v231, v231, v227
fa_SSW6:
  v_mfma_f32_16x16x32_bf16 v[128:131], a[128:131], v[64:67], v[200:203]
  s_waitcnt vmcnt(12)
  v_exp_f32 v218, v146
  v_mfma_f32_16x16x32_bf16 v[136:139], a[128:131], v[68:71], v[204:207]
  s_barrier
  v_exp_f32 v219, v147
  v_mfma_f32_16x16x32_bf16 v[132:135], a[132:135], v[64:67], v[200:203]
  ds_read_b128 a[160:163], v3 offset:16384
  ds_read_b128 a[164:167], v3 offset:17408
  v_add_f32 v226, v216, v217
  v_mfma_f32_16x16x32_bf16 v[140:143], a[132:135], v[68:71], v[204:207]
  s_mov_b32 m0, s24
  v_exp_f32 v220, v148
  v_mfma_f32_16x16x32_bf16 v[128:131], a[136:139], v[72:75], v[128:131]
  ds_read_b128 a[168:171], v3 offset:18432
  buffer_load_dwordx4 v2, s[44:47], s26 offen offset:0 sc1 lds
  v_cvt_pk_bf16_f32 v184, v216, v217
  v_mfma_f32_16x16x32_bf16 v[136:139], a[136:139], v[76:79], v[136:139]
  v_exp_f32 v221, v149
  v_mfma_f32_16x16x32_bf16 v[132:135], a[140:143], v[72:75], v[132:135]
  ds_read_b128 a[172:175], v3 offset:19456
  v_add_f32 v226, v226, v218
  v_add_f32 v226, v226, v219
  v_mfma_f32_16x16x32_bf16 v[140:143], a[140:143], v[76:79], v[140:143]
  s_waitcnt lgkmcnt(4)
  v_exp_f32 v222, v150
  v_mfma_f32_16x16x32_bf16 v[128:131], a[144:147], v[80:83], v[128:131]
  s_add_u32 s14, s13, 4096
  ds_read_b128 a[176:179], v3 offset:20480
  buffer_load_dwordx4 a[216:219], v2, s[40:43], s14 offen offset:2048 sc1
  v_cvt_pk_bf16_f32 v185, v218, v219
  v_mfma_f32_16x16x32_bf16 v[136:139], a[144:147], v[84:87], v[136:139]
  v_exp_f32 v223, v151
  v_mfma_f32_16x16x32_bf16 v[132:135], a[148:151], v[80:83], v[132:135]
  ds_read_b128 a[180:183], v3 offset:21504
  buffer_load_dwordx4 v2, s[44:47], s26 offen offset:1024 sc1 lds
  v_add_f32 v226, v226, v220
  v_mfma_f32_16x16x32_bf16 v[140:143], a[148:151], v[84:87], v[140:143]
  v_exp_f32 v216, v152
  v_mfma_f32_16x16x32_bf16 v[128:131], a[152:155], v[88:91], v[128:131]
  ds_read_b128 a[184:187], v3 offset:22528
  v_add_f32 v226, v226, v221
  v_cvt_pk_bf16_f32 v186, v220, v221
  v_mfma_f32_16x16x32_bf16 v[136:139], a[152:155], v[92:95], v[136:139]
  v_exp_f32 v217, v153
  v_mfma_f32_16x16x32_bf16 v[132:135], a[156:159], v[88:91], v[132:135]
  ds_read_b128 a[188:191], v3 offset:23552
  v_add_f32 v226, v226, v222
  v_mfma_f32_16x16x32_bf16 v[140:143], a[156:159], v[92:95], v[140:143]
  s_waitcnt lgkmcnt(4)
  v_exp_f32 v218, v154
  v_mfma_f32_16x16x32_bf16 a[64:67], a[160:163], v[176:179], a[64:67]
  ds_read_b128 a[128:131], v3 offset:0
  v_add_f32 v226, v226, v223
  v_cvt_pk_bf16_f32 v187, v222, v223
  v_mfma_f32_16x16x32_bf16 a[68:71], a[160:163], v[180:183], a[68:71]
  v_exp_f32 v219, v155
  v_mfma_f32_16x16x32_bf16 a[72:75], a[164:167], v[176:179], a[72:75]
  ds_read_b128 a[132:135], v3 offset:1024
  buffer_load_dwordx4 v2, s[44:47], s26 offen offset:2048 sc1 lds
  v_add_f32 v227, v216, v217
  v_mfma_f32_16x16x32_bf16 a[76:79], a[164:167], v[180:183], a[76:79]
  v_exp_f32 v220, v156
  v_mfma_f32_16x16x32_bf16 a[80:83], a[168:171], v[176:179], a[80:83]
  ds_read_b128 a[136:139], v3 offset:2048
  v_cvt_pk_bf16_f32 v188, v216, v217
  v_mfma_f32_16x16x32_bf16 a[84:87], a[168:171], v[180:183], a[84:87]
  v_exp_f32 v221, v157
  v_mfma_f32_16x16x32_bf16 a[88:91], a[172:175], v[176:179], a[88:91]
  ds_read_b128 a[140:143], v3 offset:3072
  buffer_load_dwordx4 a[220:223], v2, s[40:43], s14 offen offset:3072 sc1
  v_add_f32 v227, v227, v218
  v_add_f32 v227, v227, v219
  v_mfma_f32_16x16x32_bf16 a[92:95], a[172:175], v[180:183], a[92:95]
  s_waitcnt lgkmcnt(4)
  v_exp_f32 v222, v158
  v_mfma_f32_16x16x32_bf16 a[96:99], a[176:179], v[176:179], a[96:99]
  ds_read_b128 a[144:147], v3 offset:4096
  buffer_load_dwordx4 v2, s[44:47], s26 offen offset:3072 sc1 lds
  v_cvt_pk_bf16_f32 v189, v218, v219
  v_mfma_f32_16x16x32_bf16 a[100:103], a[176:179], v[180:183], a[100:103]
  s_add_u32 s26, s26, 16384
  v_exp_f32 v223, v159
  v_mfma_f32_16x16x32_bf16 a[104:107], a[180:183], v[176:179], a[104:107]
  s_add_u32 s24, s24, 32768
  ds_read_b128 a[148:151], v3 offset:5120
  v_add_f32 v227, v227, v220
  v_mfma_f32_16x16x32_bf16 a[108:111], a[180:183], v[180:183], a[108:111]
  s_and_b32 s24, s24, 0x1ffff
  v_add_f32 v227, v227, v221
  v_cvt_pk_bf16_f32 v190, v220, v221
  v_add_f32 v227, v227, v222
  v_mfma_f32_16x16x32_bf16 a[112:115], a[184:187], v[176:179], a[112:115]
  ds_read_b128 a[152:155], v3 offset:6144
  v_add_f32 v227, v227, v223
  v_max_f32 v5, v226, v227
  v_cmp_lt_f32 vcc, s81, v5
  v_mfma_f32_16x16x32_bf16 a[116:119], a[184:187], v[180:183], a[116:119]
  v_exp_f32 v216, v128
  v_mfma_f32_16x16x32_bf16 a[120:123], a[188:191], v[176:179], a[120:123]
  s_waitcnt lgkmcnt(3)
  ds_read_b128 a[156:159], v3 offset:7168
  v_cvt_pk_bf16_f32 v191, v222, v223
  v_mfma_f32_16x16x32_bf16 a[124:127], a[188:191], v[180:183], a[124:127]
  s_cbranch_vccnz fa_stub16
fa_back16:
  v_exp_f32 v217, v129
  v_add_f32 v230, v230, v226
  v_add_f32 v231, v231, v227
  v_mfma_f32_16x16x32_bf16 v[144:147], a[128:131], v[64:67], v[200:203]
  ds_read_b128 a[160:163], v3 offset:24576
  v_add_f32 v226, v216, v217
  v_mfma_f32_16x16x32_bf16 v[152:155], a[128:131], v[68:71], v[204:207]
  v_exp_f32 v218, v130
  v_mfma_f32_16x16x32_bf16 v[148:151], a[132:135], v[64:67], v[200:203]
  s_add_u32 s66, s66, 32768
  ds_read_b128 a[164:167], v3 offset:25600
  v_cvt_pk_bf16_f32 v176, v216, v217
  v_mfma_f32_16x16x32_bf16 v[156:159], a[132:135], v[68:71], v[204:207]
  s_mov_b32 m0, s25
  v_exp_f32 v219, v131
  v_mfma_f32_16x16x32_bf16 v[144:147], a[136:139], v[72:75], v[144:147]
  s_and_b32 s66, s66, 0x1ffff
  ds_read_b128 a[168:171], v3 offset:26624
  buffer_load_dwordx4 v2, s[48:51], s27 offen offset:0 sc1 lds
  v_add_f32 v226, v226, v218
  v_add_f32 v226, v226, v219
  v_mfma_f32_16x16x32_bf16 v[152:155], a[136:139], v[76:79], v[152:155]
  v_exp_f32 v220, v132
  v_mfma_f32_16x16x32_bf16 v[148:151], a[140:143], v[72:75], v[148:151]
  ds_read_b128 a[172:175], v3 offset:27648
  v_cvt_pk_bf16_f32 v177, v218, v219
  v_mfma_f32_16x16x32_bf16 v[156:159], a[140:143], v[76:79], v[156:159]
  s_waitcnt lgkmcnt(4)
  v_exp_f32 v221, v133
  v_mfma_f32_16x16x32_bf16 v[144:147], a[144:147], v[80:83], v[144:147]
  s_add_u32 s14, s13, 8192
  ds_read_b128 a[176:179], v3 offset:28672
  buffer_load_dwordx4 a[224:227], v2, s[40:43], s14 offen offset:0 sc1
  v_add_f32 v226, v226, v220
  v_mfma_f32_16x16x32_bf16 v[152:155], a[144:147], v[84:87], v[152:155]
  v_exp_f32 v222, v134
  v_mfma_f32_16x16x32_bf16 v[148:151], a[148:151], v[80:83], v[148:151]
  ds_read_b128 a[180:183], v3 offset:29696
  buffer_load_dwordx4 v2, s[48:51], s27 offen offset:1024 sc1 lds
  v_add_f32 v226, v226, v221
  v_cvt_pk_bf16_f32 v178, v220, v221
  v_mfma_f32_16x16x32_bf16 v[156:159], a[148:151], v[84:87], v[156:159]
  v_exp_f32 v223, v135
  v_mfma_f32_16x16x32_bf16 v[144:147], a[152:155], v[88:91], v[144:147]
  ds_read_b128 a[184:187], v3 offset:30720
  v_add_f32 v226, v226, v222
  v_mfma_f32_16x16x32_bf16 v[152:155], a[152:155], v[92:95], v[152:155]
  v_exp_f32 v216, v136
  v_mfma_f32_16x16x32_bf16 v[148:151], a[156:159], v[88:91], v[148:151]
  ds_read_b128 a[188:191], v3 offset:31744
  v_add_f32 v226, v226, v223
  v_exp_f32 v217, v137
  v_mfma_f32_16x16x32_bf16 v[156:159], a[156:159], v[92:95], v[156:159]
  s_waitcnt lgkmcnt(4)
  v_exp_f32 v218, v138
  v_mfma_f32_16x16x32_bf16 a[64:67], a[160:163], v[184:187], a[64:67]
  ds_read_b128 a[128:131], v3 offset:8192
  v_cvt_pk_bf16_f32 v179, v222, v223
  v_mfma_f32_16x16x32_bf16 a[68:71], a[160:163], v[188:191], a[68:71]
  v_exp_f32 v219, v139
  v_mfma_f32_16x16x32_bf16 a[72:75], a[164:167], v[184:187], a[72:75]
  ds_read_b128 a[132:135], v3 offset:9216
  buffer_load_dwordx4 v2, s[48:51], s27 offen offset:2048 sc1 lds
  v_add_f32 v227, v216, v217
  v_mfma_f32_16x16x32_bf16 a[76:79], a[164:167], v[188:191], a[76:79]
  v_exp_f32 v220, v140
  v_mfma_f32_16x16x32_bf16 a[80:83], a[168:171], v[184:187], a[80:83]
  ds_read_b128 a[136:139], v3 offset:10240
  v_cvt_pk_bf16_f32 v180, v216, v217
  v_mfma_f32_16x16x32_bf16 a[84:87], a[168:171], v[188:191], a[84:87]
  v_exp_f32 v221, v141
  v_mfma_f32_16x16x32_bf16 a[88:91], a[172:175], v[184:187], a[88:91]
  ds_read_b128 a[140:143], v3 offset:11264
  buffer_load_dwordx4 a[228:231], v2, s[40:43], s14 offen offset:1024 sc1
  v_add_f32 v227, v227, v218
  v_mfma_f32_16x16x32_bf16 a[92:95], a[172:175], v[188:191], a[92:95]
  s_waitcnt lgkmcnt(4)
  v_exp_f32 v222, v142
  v_mfma_f32_16x16x32_bf16 a[96:99], a[176:179], v[184:187], a[96:99]
  ds_read_b128 a[144:147], v3 offset:12288
  buffer_load_dwordx4 v2, s[48:51], s27 offen offset:3072 sc1 lds
  v_add_f32 v227, v227, v219
  v_cvt_pk_bf16_f32 v181, v218, v219
  v_mfma_f32_16x16x32_bf16 a[100:103], a[176:179], v[188:191], a[100:103]
  s_add_u32 s27, s27, 16384
  v_exp_f32 v223, v143
  v_mfma_f32_16x16x32_bf16 a[104:107], a[180:183], v[184:187], a[104:107]
  s_add_u32 s25, s25, 32768
  ds_read_b128 a[148:151], v3 offset:13312
  v_add_f32 v227, v227, v220
  v_mfma_f32_16x16x32_bf16 a[108:111], a[180:183], v[188:191], a[108:111]
  s_and_b32 s25, s25, 0x1ffff
  v_add_f32 v227, v227, v221
  v_cvt_pk_bf16_f32 v182, v220, v221
  v_add_f32 v227, v227, v222
  v_mfma_f32_16x16x32_bf16 a[112:115], a[184:187], v[184:187], a[112:115]
  ds_read_b128 a[152:155], v3 offset:14336
  v_add_f32 v227, v227, v223
  v_max_f32 v5, v226, v227
  v_cmp_lt_f32 vcc, s81, v5
  v_mfma_f32_16x16x32_bf16 a[116:119], a[184:187], v[188:191], a[116:119]
  v_exp_f32 v216, v144
  v_mfma_f32_16x16x32_bf16 a[120:123], a[188:191], v[184:187], a[120:123]
  s_waitcnt lgkmcnt(3)
  ds_read_b128 a[156:159], v3 offset:15360
  v_cvt_pk_bf16_f32 v183, v222, v223
  v_add_u32 v3, s66, v2
  v_mfma_f32_16x16x32_bf16 a[124:127], a[188:191], v[188:191], a[124:127]
  s_cbranch_vccnz fa_stub17
fa_back17:
  v_exp_f32 v217, v145
  v_add_f32 v230, v230, v226
  v_add_f32 v231, v231, v227
fa_SSW5:
  v_mfma_f32_16x16x32_bf16 v[128:131], a[128:131], v[64:67], v[200:203]
  s_waitcnt vmcnt(12)
  v_exp_f32 v218, v146
  v_mfma_f32_16x16x32_bf16 v[136:139], a[128:131], v[68:71], v[204:207]
  s_barrier
  v_exp_f32 v219, v147
  v_mfma_f32_16x16x32_bf16 v[132:135], a[132:135], v[64:67], v[200:203]
  ds_read_b128 a[160:163], v3 offset:16384
  ds_read_b128 a[164:167], v3 offset:17408
  v_add_f32 v226, v216, v217
  v_mfma_f32_16x16x32_bf16 v[140:143], a[132:135], v[68:71], v[204:207]
  s_mov_b32 m0, s24
  v_exp_f32 v220, v148
  v_mfma_f32_16x16x32_bf16 v[128:131], a[136:139], v[72:75], v[128:131]
  ds_read_b128 a[168:171], v3 offset:18432
  buffer_load_dwordx4 v2, s[44:47], s26 offen offset:0 sc1 lds
  v_cvt_pk_bf16_f32 v184, v216, v217
  v_mfma_f32_16x16x32_bf16 v[136:139], a[136:139], v[76:79], v[136:139]
  v_exp_f32 v221, v149
  v_mfma_f32_16x16x32_bf16 v[132:135], a[140:143], v[72:75], v[132:135]
  ds_read_b128 a[172:175], v3 offset:19456
  v_add_f32 v226, v226, v218
  v_add_f32 v226, v226, v219
  v_mfma_f32_16x16x32_bf16 v[140:143], a[140:143], v[76:79], v[140:143]
  s_waitcnt lgkmcnt(4)
  v_exp_f32 v222, v150
  v_mfma_f32_16x16x32_bf16 v[128:131], a[144:147], v[80:83], v[128:131]
  s_add_u32 s14, s13, 8192
  ds_read_b128 a[176:179], v3 offset:20480
  buffer_load_dwordx4 a[232:235], v2, s[40:43], s14 offen offset:2048 sc1
  v_cvt_pk_bf16_f32 v185, v218, v219
  v_mfma_f32_16x16x32_bf16 v[136:139], a[144:147], v[84:87], v[136:139]
  v_exp_f32 v223, v151
  v_mfma_f32_16x16x32_bf16 v[132:135], a[148:151], v[80:83], v[132:135]
  ds_read_b128 a[180:183], v3 offset:21504
  buffer_load_dwordx4 v2, s[44:47], s26 offen offset:1024 sc1 lds
  v_add_f32 v226, v226, v220
  v_mfma_f32_16x16x32_bf16 v[140:143], a[148:151], v[84:87], v[140:143]
  v_exp_f32 v216, v152
  v_mfma_f32_16x16x32_bf16 v[128:131], a[152:155], v[88:91], v[128:131]
  ds_read_b128 a[184:187], v3 offset:22528
  v_add_f32 v226, v226, v221
  v_cvt_pk_bf16_f32 v186, v220, v221
  v_mfma_f32_16x16x32_bf16 v[136:139], a[152:155], v[92:95], v[136:139]
  v_exp_f32 v217, v153
  v_mfma_f32_16x16x32_bf16 v[132:135], a[156:159], v[88:91], v[132:135]
  ds_read_b128 a[188:191], v3 offset:23552
  buffer_load_dwordx4 a[236:239], v2, s[40:43], s14 offen offset:3072 sc1
  v_add_f32 v226, v226, v222
  v_mfma_f32_16x16x32_bf16 v[140:143], a[156:159], v[92:95], v[140:143]
  s_waitcnt lgkmcnt(4)
  v_exp_f32 v218, v154
  v_mfma_f32_16x16x32_bf16 a[64:67], a[160:163], v[176:179], a[64:67]
  ds_read_b128 a[128:131], v3 offset:0
  v_add_f32 v226, v226, v223
  v_cvt_pk_bf16_f32 v187, v222, v223
  v_mfma_f32_16x16x32_bf16 a[68:71], a[160:163], v[180:183], a[68:71]
  v_exp_f32 v219, v155
  v_mfma_f32_16x16x32_bf16 a[72:75], a[164:167], v[176:179], a[72:75]
  ds_read_b128 a[132:135], v3 offset:1024
  buffer_load_dwordx4 v2, s[44:47], s26 offen offset:2048 sc1 lds
  v_add_f32 v227, v216, v217
  v_mfma_f32_16x16x32_bf16 a[76:79], a[164:167], v[180:183], a[76:79]
  v_exp_f32 v220, v156
  v_mfma_f32_16x16x32_bf16 a[80:83], a[168:171], v[176:179], a[80:83]
  ds_read_b128 a[136:139], v3 offset:2048
  v_cvt_pk_bf16_f32 v188, v216, v217
  v_mfma_f32_16x16x32_bf16 a[84:87], a[168:171], v[180:183], a[84:87]
  v_exp_f32 v221, v157
  v_mfma_f32_16x16x32_bf16 a[88:91], a[172:175], v[176:179], a[88:91]
  s_add_u32 s14, s13, 12288
  ds_read_b128 a[140:143], v3 offset:3072
  buffer_load_dwordx4 a[240:243], v2, s[40:43], s14 offen offset:0 sc1
  v_add_f32 v227, v227, v218
  v_add_f32 v227, v227, v219
  v_mfma_f32_16x16x32_bf16 a[92:95], a[172:175], v[180:183], a[92:95]
  s_waitcnt lgkmcnt(4)
  v_exp_f32 v222, v158
  v_mfma_f32_16x16x32_bf16 a[96:99], a[176:179], v[176:179], a[96:99]
  ds_read_b128 a[144:147], v3 offset:4096
  buffer_load_dwordx4 v2, s[44:47], s26 offen offset:3072 sc1 lds
  v_cvt_pk_bf16_f32 v189, v218, v219
  v_mfma_f32_16x16x32_bf16 a[100:103], a[176:179], v[180:183], a[100:103]
  s_add_u32 s26, s26, 16384
  v_exp_f32 v223, v159
  v_mfma_f32_16x16x32_bf16 a[104:107], a[180:183], v[176:179], a[104:107]
  s_add_u32 s24, s24, 32768
  ds_read_b128 a[148:151], v3 offset:5120
  v_add_f32 v227, v227, v220
  v_mfma_f32_16x16x32_bf16 a[108:111], a[180:183], v[180:183], a[108:111]
  s_and_b32 s24, s24, 0x1ffff
  v_add_f32 v227, v227, v221
  v_cvt_pk_bf16_f32 v190, v220, v221
  v_add_f32 v227, v227, v222
  v_mfma_f32_16x16x32_bf16 a[112:115], a[184:187], v[176:179], a[112:115]
  ds_read_b128 a[152:155], v3 offset:6144
  v_add_f32 v227, v227, v223
  v_max_f32 v5, v226, v227
  v_cmp_lt_f32 vcc, s81, v5
  v_mfma_f32_16x16x32_bf16 a[116:119], a[184:187], v[180:183], a[116:119]
  v_exp_f32 v216, v128
  v_mfma_f32_16x16x32_bf16 a[120:123], a[188:191], v[176:179], a[120:123]
  s_waitcnt lgkmcnt(3)
  ds_read_b128 a[156:159], v3 offset:7168
  v_cvt_pk_bf16_f32 v191, v222, v223
  v_mfma_f32_16x16x32_bf16 a[124:127], a[188:191], v[180:183], a[124:127]
  s_cbranch_vccnz fa_stub18
fa_back18:
  v_exp_f32 v217, v129
  v_add_f32 v230, v230, v226
  v_add_f32 v231, v231, v227
  v_mfma_f32_16x16x32_bf16 v[144:147], a[128:131], v[64:67], v[200:203]
  ds_read_b128 a[160:163], v3 offset:24576
  v_add_f32 v226, v216, v217
  v_mfma_f32_16x16x32_bf16 v[152:155], a[128:131], v[68:71], v[204:207]
  v_exp_f32 v218, v130
  v_mfma_f32_16x16x32_bf16 v[148:151], a[132:135], v[64:67], v[200:203]
  s_add_u32 s66, s66, 32768
  ds_read_b128 a[164:167], v3 offset:25600
  v_cvt_pk_bf16_f32 v176, v216, v217
  v_mfma_f32_16x16x32_bf16 v[156:159], a[132:135], v[68:71], v[204:207]
  s_mov_b32 m0, s25
  v_exp_f32 v219, v131
  v_mfma_f32_16x16x32_bf16 v[144:147], a[136:139], v[72:75], v[144:147]
  s_and_b32 s66, s66, 0x1ffff
  ds_read_b128 a[168:171], v3 offset:26624
  buffer_load_dwordx4 v2, s[48:51], s27 offen offset:0 sc1 lds
  v_add_f32 v226, v226, v218
  v_add_f32 v226, v226, v219
  v_mfma_f32_16x16x32_bf16 v[152:155], a[136:139], v[76:79], v[152:155]
  v_exp_f32 v220, v132
  v_mfma_f32_16x16x32_bf16 v[148:151], a[140:143], v[72:75], v[148:151]
  ds_read_b128 a[172:175], v3 offset:27648
  v_cvt_pk_bf16_f32 v177, v218, v219
  v_mfma_f32_16x16x32_bf16 v[156:159], a[140:143], v[76:79], v[156:159]
  s_waitcnt lgkmcnt(4)
  v_exp_f32 v221, v133
  v_mfma_f32_16x16x32_bf16 v[144:147], a[144:147], v[80:83], v[144:147]
  s_add_u32 s14, s13, 12288
  ds_read_b128 a[176:179], v3 offset:28672
  buffer_load_dwordx4 a[244:247], v2, s[40:43], s14 offen offset:1024 sc1
  v_add_f32 v226, v226, v220
  v_mfma_f32_16x16x32_bf16 v[152:155], a[144:147], v[84:87], v[152:155]
  v_exp_f32 v222, v134
  v_mfma_f32_16x16x32_bf16 v[148:151], a[148:151], v[80:83], v[148:151]
  ds_read_b128 a[180:183], v3 offset:29696
  buffer_load_dwordx4 v2, s[48:51], s27 offen offset:1024 sc1 lds
  v_add_f32 v226, v226, v221
  v_cvt_pk_bf16_f32 v178, v220, v221
  v_mfma_f32_16x16x32_bf16 v[156:159], a[148:151], v[84:87], v[156:159]
  v_exp_f32 v223, v135
  v_mfma_f32_16x16x32_bf16 v[144:147], a[152:155], v[88:91], v[144:147]
  ds_read_b128 a[184:187], v3 offset:30720
  v_add_f32 v226, v226, v222
  v_mfma_f32_16x16x32_bf16 v[152:155], a[152:155], v[92:95], v[152:155]
  v_exp_f32 v216, v136
  v_mfma_f32_16x16x32_bf16 v[148:151], a[156:159], v[88:91], v[148:151]
  ds_read_b128 a[188:191], v3 offset:31744
  buffer_load_dwordx4 a[248:251], v2, s[40:43], s14 offen offset:2048 sc1
  v_add_f32 v226, v226, v223
  v_exp_f32 v217, v137
  v_mfma_f32_16x16x32_bf16 v[156:159], a[156:159], v[92:95], v[156:159]
  s_waitcnt lgkmcnt(4)
  v_exp_f32 v218, v138
  v_mfma_f32_16x16x32_bf16 a[64:67], a[160:163], v[184:187], a[64:67]
  ds_read_b128 a[128:131], v3 offset:8192
  v_cvt_pk_bf16_f32 v179, v222, v223
  v_mfma_f32_16x16x32_bf16 a[68:71], a[160:163], v[188:191], a[68:71]
  v_exp_f32 v219, v139
  v_mfma_f32_16x16x32_bf16 a[72:75], a[164:167], v[184:187], a[72:75]
  ds_read_b128 a[132:135], v3 offset:9216
  buffer_load_dwordx4 v2, s[48:51], s27 offen offset:2048 sc1 lds
  v_add_f32 v227, v216, v217
  v_mfma_f32_16x16x32_bf16 a[76:79], a[164:167], v[188:191], a[76:79]
  v_exp_f32 v220, v140
  v_mfma_f32_16x16x32_bf16 a[80:83], a[168:171], v[184:187], a[80:83]
  ds_read_b128 a[136:139], v3 offset:10240
  v_cvt_pk_bf16_f32 v180, v216, v217
  v_mfma_f32_16x16x32_bf16 a[84:87], a[168:171], v[188:191], a[84:87]
  v_exp_f32 v221, v141
  v_mfma_f32_16x16x32_bf16 a[88:91], a[172:175], v[184:187], a[88:91]
  ds_read_b128 a[140:143], v3 offset:11264
  buffer_load_dwordx4 a[252:255], v2, s[40:43], s14 offen offset:3072 sc1
  v_add_f32 v227, v227, v218
  v_mfma_f32_16x16x32_bf16 a[92:95], a[172:175], v[188:191], a[92:95]
  s_waitcnt lgkmcnt(4)
  v_exp_f32 v222, v142
  v_mfma_f32_16x16x32_bf16 a[96:99], a[176:179], v[184:187], a[96:99]
  ds_read_b128 a[144:147], v3 offset:12288
  buffer_load_dwordx4 v2, s[48:51], s27 offen offset:3072 sc1 lds
  v_add_f32 v227, v227, v219
  v_cvt_pk_bf16_f32 v181, v218, v219
  v_mfma_f32_16x16x32_bf16 a[100:103], a[176:179], v[188:191], a[100:103]
  s_add_u32 s27, s27, 16384
  v_exp_f32 v223, v143
  v_mfma_f32_16x16x32_bf16 a[104:107], a[180:183], v[184:187], a[104:107]
  s_add_u32 s25, s25, 32768
  ds_read_b128 a[148:151], v3 offset:13312
  v_add_f32 v227, v227, v220
  v_mfma_f32_16x16x32_bf16 a[108:111], a[180:183], v[188:191], a[108:111]
  s_and_b32 s25, s25, 0x1ffff
  v_add_f32 v227, v227, v221
  v_cvt_pk_bf16_f32 v182, v220, v221
  v_add_f32 v227, v227, v222
  v_mfma_f32_16x16x32_bf16 a[112:115], a[184:187], v[184:187], a[112:115]
  ds_read_b128 a[152:155], v3 offset:14336
  v_add_f32 v227, v227, v223
  v_max_f32 v5, v226, v227
  v_cmp_lt_f32 vcc, s81, v5
  v_mfma_f32_16x16x32_bf16 a[116:119], a[184:187], v[188:191], a[116:119]
  v_exp_f32 v216, v144
  v_mfma_f32_16x16x32_bf16 a[120:123], a[188:191], v[184:187], a[120:123]
  s_waitcnt lgkmcnt(3)
  ds_read_b128 a[156:159], v3 offset:15360
  v_cvt_pk_bf16_f32 v183, v222, v223
  v_add_u32 v3, s66, v2
  v_mfma_f32_16x16x32_bf16 a[124:127], a[188:191], v[188:191], a[124:127]
  s_cbranch_vccnz fa_stub19
fa_back19:
  v_exp_f32 v217, v145
  v_add_f32 v230, v230, v226
  v_add_f32 v231, v231, v227
fa_SSW4:
  v_mfma_f32_16x16x32_bf16 v[128:131], a[128:131], v[64:67], v[200:203]
  s_waitcnt vmcnt(12)
  v_exp_f32 v218, v146
  v_mfma_f32_16x16x32_bf16 v[136:139], a[128:131], v[68:71], v[204:207]
  s_barrier
  v_exp_f32 v219, v147
  v_mfma_f32_16x16x32_bf16 v[132:135], a[132:135], v[64:67], v[200:203]
  ds_read_b128 a[160:163], v3 offset:16384
  ds_read_b128 a[164:167], v3 offset:17408
  v_add_f32 v226, v216, v217
  v_mfma_f32_16x16x32_bf16 v[140:143], a[132:135], v[68:71], v[204:207]
  s_mov_b32 m0, s24
  v_exp_f32 v220, v148
  v_mfma_f32_16x16x32_bf16 v[128:131], a[136:139], v[72:75], v[128:131]
  ds_read_b128 a[168:171], v3 offset:18432
  buffer_load_dwordx4 v2, s[44:47], s26 offen offset:0 sc1 lds
  v_cvt_pk_bf16_f32 v184, v216, v217
  v_mfma_f32_16x16x32_bf16 v[136:139], a[136:139], v[76:79], v[136:139]
  v_exp_f32 v221, v149
  v_mfma_f32_16x16x32_bf16 v[132:135], a[140:143], v[72:75], v[132:135]
  s_add_u32 s14, s13, 16384
  ds_read_b128 a[172:175], v3 offset:19456
  buffer_load_dwordx4 a[0:3], v2, s[40:43], s14 offen offset:0 sc1
  v_add_f32 v226, v226, v218
  v_add_f32 v226, v226, v219
  v_mfma_f32_16x16x32_bf16 v[140:143], a[140:143], v[76:79], v[140:143]
  s_waitcnt lgkmcnt(4)
  v_exp_f32 v222, v150
  v_mfma_f32_16x16x32_bf16 v[128:131], a[144:147], v[80:83], v[128:131]
  ds_read_b128 a[176:179], v3 offset:20480
  v_cvt_pk_bf16_f32 v185, v218, v219
  v_mfma_f32_16x16x32_bf16 v[136:139], a[144:147], v[84:87], v[136:139]
  v_exp_f32 v223, v151
  v_mfma_f32_16x16x32_bf16 v[132:135], a[148:151], v[80:83], v[132:135]
  ds_read_b128 a[180:183], v3 offset:21504
  buffer_load_dwordx4 v2, s[44:47], s26 offen offset:1024 sc1 lds
  v_add_f32 v226, v226, v220
  v_mfma_f32_16x16x32_bf16 v[140:143], a[148:151], v[84:87], v[140:143]
  v_exp_f32 v216, v152
  v_mfma_f32_16x16x32_bf16 v[128:131], a[152:155], v[88:91], v[128:131]
  ds_read_b128 a[184:187], v3 offset:22528
  v_add_f32 v226, v226, v221
  v_cvt_pk_bf16_f32 v186, v220, v221
  v_mfma_f32_16x16x32_bf16 v[136:139], a[152:155], v[92:95], v[136:139]
  v_exp_f32 v217, v153
  v_mfma_f32_16x16x32_bf16 v[132:135], a[156:159], v[88:91], v[132:135]
  ds_read_b128 a[188:191], v3 offset:23552
  buffer_load_dwordx4 a[4:7], v2, s[40:43], s14 offen offset:1024 sc1
  v_add_f32 v226, v226, v222
  v_mfma_f32_16x16x32_bf16 v[140:143], a[156:159], v[92:95], v[140:143]
  s_waitcnt lgkmcnt(4)
  v_exp_f32 v218, v154
  v_mfma_f32_16x16x32_bf16 a[64:67], a[160:163], v[176:179], a[64:67]
  ds_read_b128 a[128:131], v3 offset:0
  v_add_f32 v226, v226, v223
  v_cvt_pk_bf16_f32 v187, v222, v223
  v_mfma_f32_16x16x32_bf16 a[68:71], a[160:163], v[180:183], a[68:71]
  v_exp_f32 v219, v155
  v_mfma_f32_16x16x32_bf16 a[72:75], a[164:167], v[176:179], a[72:75]
  ds_read_b128 a[132:135], v3 offset:1024
  buffer_load_dwordx4 v2, s[44:47], s26 offen offset:2048 sc1 lds
  v_add_f32 v227, v216, v217
  v_mfma_f32_16x16x32_bf16 a[76:79], a[164:167], v[180:183], a[76:79]
  v_exp_f32 v220, v156
  v_mfma_f32_16x16x32_bf16 a[80:83], a[168:171], v[176:179], a[80:83]
  ds_read_b128 a[136:139], v3 offset:2048
  buffer_load_dwordx4 a[8:11], v2, s[40:43], s14 offen offset:2048 sc1
  v_cvt_pk_bf16_f32 v188, v216, v217
  v_mfma_f32_16x16x32_bf16 a[84:87], a[168:171], v[180:183], a[84:87]
  v_exp_f32 v221, v157
  v_mfma_f32_16x16x32_bf16 a[88:91], a[172:175], v[176:179], a[88:91]
  ds_read_b128 a[140:143], v3 offset:3072
  v_add_f32 v227, v227, v218
  v_add_f32 v227, v227, v219
  v_mfma_f32_16x16x32_bf16 a[92:95], a[172:175], v[180:183], a[92:95]
  s_waitcnt lgkmcnt(4)
  v_exp_f32 v222, v158
  v_mfma_f32_16x16x32_bf16 a[96:99], a[176:179], v[176:179], a[96:99]
  ds_read_b128 a[144:147], v3 offset:4096
  buffer_load_dwordx4 v2, s[44:47], s26 offen offset:3072 sc1 lds
  v_cvt_pk_bf16_f32 v189, v218, v219
  v_mfma_f32_16x16x32_bf16 a[100:103], a[176:179], v[180:183], a[100:103]
  s_add_u32 s26, s26, 16384
  v_exp_f32 v223, v159
  v_mfma_f32_16x16x32_bf16 a[104:107], a[180:183], v[176:179], a[104:107]
  s_add_u32 s24, s24, 32768
  ds_read_b128 a[148:151], v3 offset:5120
  buffer_load_dwordx4 a[12:15], v2, s[40:43], s14 offen offset:3072 sc1
  v_add_f32 v227, v227, v220
  v_mfma_f32_16x16x32_bf16 a[108:111], a[180:183], v[180:183], a[108:111]
  s_and_b32 s24, s24, 0x1ffff
  v_add_f32 v227, v227, v221
  v_cvt_pk_bf16_f32 v190, v220, v221
  v_add_f32 v227, v227, v222
  v_mfma_f32_16x16x32_bf16 a[112:115], a[184:187], v[176:179], a[112:115]
  ds_read_b128 a[152:155], v3 offset:6144
  v_add_f32 v227, v227, v223
  v_max_f32 v5, v226, v227
  v_cmp_lt_f32 vcc, s81, v5
  v_mfma_f32_16x16x32_bf16 a[116:119], a[184:187], v[180:183], a[116:119]
  v_exp_f32 v216, v128
  v_mfma_f32_16x16x32_bf16 a[120:123], a[188:191], v[176:179], a[120:123]
  s_waitcnt lgkmcnt(3)
  ds_read_b128 a[156:159], v3 offset:7168
  v_cvt_pk_bf16_f32 v191, v222, v223
  v_mfma_f32_16x16x32_bf16 a[124:127], a[188:191], v[180:183], a[124:127]
  s_cbranch_vccnz fa_stub20
fa_back20:
  v_exp_f32 v217, v129
  v_add_f32 v230, v230, v226
  v_add_f32 v231, v231, v227
  v_mfma_f32_16x16x32_bf16 v[144:147], a[128:131], v[64:67], v[200:203]
  ds_read_b128 a[160:163], v3 offset:24576
  v_add_f32 v226, v216, v217
  v_mfma_f32_16x16x32_bf16 v[152:155], a[128:131], v[68:71], v[204:207]
  v_exp_f32 v218, v130
  v_mfma_f32_16x16x32_bf16 v[148:151], a[132:135], v[64:67], v[200:203]
  s_add_u32 s66, s66, 32768
  ds_read_b128 a[164:167], v3 offset:25600
  v_cvt_pk_bf16_f32 v176, v216, v217
  v_mfma_f32_16x16x32_bf16 v[156:159], a[132:135], v[68:71], v[204:207]
  s_mov_b32 m0, s25
  v_exp_f32 v219, v131
  v_mfma_f32_16x16x32_bf16 v[144:147], a[136:139], v[72:75], v[144:147]
  s_and_b32 s66, s66, 0x1ffff
  ds_read_b128 a[168:171], v3 offset:26624
  buffer_load_dwordx4 v2, s[48:51], s27 offen offset:0 sc1 lds
  v_add_f32 v226, v226, v218
  v_add_f32 v226, v226, v219
  v_mfma_f32_16x16x32_bf16 v[152:155], a[136:139], v[76:79], v[152:155]
  v_exp_f32 v220, v132
  v_mfma_f32_16x16x32_bf16 v[148:151], a[140:143], v[72:75], v[148:151]
  s_add_u32 s14, s13, 20480
  ds_read_b128 a[172:175], v3 offset:27648
  buffer_load_dwordx4 a[16:19], v2, s[40:43], s14 offen offset:0 sc1
  v_cvt_pk_bf16_f32 v177, v218, v219
  v_mfma_f32_16x16x32_bf16 v[156:159], a[140:143], v[76:79], v[156:159]
  s_waitcnt lgkmcnt(4)
  v_exp_f32 v221, v133
  v_mfma_f32_16x16x32_bf16 v[144:147], a[144:147], v[80:83], v[144:147]
  ds_read_b128 a[176:179], v3 offset:28672
  v_add_f32 v226, v226, v220
  v_mfma_f32_16x16x32_bf16 v[152:155], a[144:147], v[84:87], v[152:155]
  v_exp_f32 v222, v134
  v_mfma_f32_16x16x32_bf16 v[148:151], a[148:151], v[80:83], v[148:151]
  ds_read_b128 a[180:183], v3 offset:29696
  buffer_load_dwordx4 v2, s[48:51], s27 offen offset:1024 sc1 lds
  v_add_f32 v226, v226, v221
  v_cvt_pk_bf16_f32 v178, v220, v221
  v_mfma_f32_16x16x32_bf16 v[156:159], a[148:151], v[84:87], v[156:159]
  v_exp_f32 v223, v135
  v_mfma_f32_16x16x32_bf16 v[144:147], a[152:155], v[88:91], v[144:147]
  ds_read_b128 a[184:187], v3 offset:30720
  v_add_f32 v226, v226, v222
  v_mfma_f32_16x16x32_bf16 v[152:155], a[152:155], v[92:95], v[152:155]
  v_exp_f32 v216, v136
  v_mfma_f32_16x16x32_bf16 v[148:151], a[156:159], v[88:91], v[148:151]
  ds_read_b128 a[188:191], v3 offset:31744
  buffer_load_dwordx4 a[20:23], v2, s[40:43], s14 offen offset:1024 sc1
  v_add_f32 v226, v226, v223
  v_exp_f32 v217, v137
  v_mfma_f32_16x16x32_bf16 v[156:159], a[156:159], v[92:95], v[156:159]
  s_waitcnt lgkmcnt(4)
  v_exp_f32 v218, v138
  v_mfma_f32_16x16x32_bf16 a[64:67], a[160:163], v[184:187], a[64:67]
  ds_read_b128 a[128:131], v3 offset:8192
  v_cvt_pk_bf16_f32 v179, v222, v223
  v_mfma_f32_16x16x32_bf16 a[68:71], a[160:163], v[188:191], a[68:71]
  v_exp_f32 v219, v139
  v_mfma_f32_16x16x32_bf16 a[72:75], a[164:167], v[184:187], a[72:75]
  ds_read_b128 a[132:135], v3 offset:9216
  buffer_load_dwordx4 v2, s[48:51], s27 offen offset:2048 sc1 lds
  v_add_f32 v227, v216, v217
  v_mfma_f32_16x16x32_bf16 a[76:79], a[164:167], v[188:191], a[76:79]
  v_exp_f32 v220, v140
  v_mfma_f32_16x16x32_bf16 a[80:83], a[168:171], v[184:187], a[80:83]
  ds_read_b128 a[136:139], v3 offset:10240
  buffer_load_dwordx4 a[24:27], v2, s[40:43], s14 offen offset:2048 sc1
  v_cvt_pk_bf16_f32 v180, v216, v217
  v_mfma_f32_16x16x32_bf16 a[84:87], a[168:171], v[188:191], a[84:87]
  v_exp_f32 v221, v141
  v_mfma_f32_16x16x32_bf16 a[88:91], a[172:175], v[184:187], a[88:91]
  ds_read_b128 a[140:143], v3 offset:11264
  v_add_f32 v227, v227, v218
  v_mfma_f32_16x16x32_bf16 a[92:95], a[172:175], v[188:191], a[92:95]
  s_waitcnt lgkmcnt(4)
  v_exp_f32 v222, v142
  v_mfma_f32_16x16x32_bf16 a[96:99], a[176:179], v[184:187], a[96:99]
  ds_read_b128 a[144:147], v3 offset:12288
  buffer_load_dwordx4 v2, s[48:51], s27 offen offset:3072 sc1 lds
  v_add_f32 v227, v227, v219
  v_cvt_pk_bf16_f32 v181, v218, v219
  v_mfma_f32_16x16x32_bf16 a[100:103], a[176:179], v[188:191], a[100:103]
  s_add_u32 s27, s27, 16384
  v_exp_f32 v223, v143
  v_mfma_f32_16x16x32_bf16 a[104:107], a[180:183], v[184:187], a[104:107]
  s_add_u32 s25, s25, 32768
  ds_read_b128 a[148:151], v3 offset:13312
  buffer_load_dwordx4 a[28:31], v2, s[40:43], s14 offen offset:3072 sc1
  v_add_f32 v227, v227, v220
  v_mfma_f32_16x16x32_bf16 a[108:111], a[180:183], v[188:191], a[108:111]
  s_and_b32 s25, s25, 0x1ffff
  v_add_f32 v227, v227, v221
  v_cvt_pk_bf16_f32 v182, v220, v221
  v_add_f32 v227, v227, v222
  v_mfma_f32_16x16x32_bf16 a[112:115], a[184:187], v[184:187], a[112:115]
  ds_read_b128 a[152:155], v3 offset:14336
  v_add_f32 v227, v227, v223
  v_max_f32 v5, v226, v227
  v_cmp_lt_f32 vcc, s81, v5
  v_mfma_f32_16x16x32_bf16 a[116:119], a[184:187], v[188:191], a[116:119]
  v_exp_f32 v216, v144
  v_mfma_f32_16x16x32_bf16 a[120:123], a[188:191], v[184:187], a[120:123]
  s_waitcnt lgkmcnt(3)
  ds_read_b128 a[156:159], v3 offset:15360
  v_cvt_pk_bf16_f32 v183, v222, v223
  v_add_u32 v3, s66, v2
  v_mfma_f32_16x16x32_bf16 a[124:127], a[188:191], v[188:191], a[124:127]
  s_cbranch_vccnz fa_stub21
fa_back21:
  v_exp_f32 v217, v145
  v_add_f32 v230, v230, v226
  v_add_f32 v231, v231, v227
fa_SSW3:
  v_mfma_f32_16x16x32_bf16 v[128:131], a[128:131], v[64:67], v[200:203]
  s_waitcnt vmcnt(12)
  v_exp_f32 v218, v146
  v_mfma_f32_16x16x32_bf16 v[136:139], a[128:131], v[68:71], v[204:207]
  s_barrier
  v_exp_f32 v219, v147
  v_mfma_f32_16x16x32_bf16 v[132:135], a[132:135], v[64:67], v[200:203]
  s_cmp_ge_u32 s26, s46
  s_cselect_b64 s[44:45], s[4:5], s[44:45]
  s_cselect_b32 s46, s30, s46
  ds_read_b128 a[160:163], v3 offset:16384
  ds_read_b128 a[164:167], v3 offset:17408
  v_add_f32 v226, v216, v217
  v_mfma_f32_16x16x32_bf16 v[140:143], a[132:135], v[68:71], v[204:207]
  s_mov_b32 m0, s24
  v_exp_f32 v220, v148
  v_mfma_f32_16x16x32_bf16 v[128:131], a[136:139], v[72:75], v[128:131]
  ds_read_b128 a[168:171], v3 offset:18432
  buffer_load_dwordx4 v2, s[44:47], s26 offen offset:0 sc1 lds
  v_cvt_pk_bf16_f32 v184, v216, v217
  v_mfma_f32_16x16x32_bf16 v[136:139], a[136:139], v[76:79], v[136:139]
  v_exp_f32 v221, v149
  v_mfma_f32_16x16x32_bf16 v[132:135], a[140:143], v[72:75], v[132:135]
  s_add_u32 s14, s13, 24576
  ds_read_b128 a[172:175], v3 offset:19456
  buffer_load_dwordx4 a[32:35], v2, s[40:43], s14 offen offset:0 sc1
  v_add_f32 v226, v226, v218
  v_add_f32 v226, v226, v219
  v_mfma_f32_16x16x32_bf16 v[140:143], a[140:143], v[76:79], v[140:143]
  s_waitcnt lgkmcnt(4)
  v_exp_f32 v222, v150
  v_mfma_f32_16x16x32_bf16 v[128:131], a[144:147], v[80:83], v[128:131]
  ds_read_b128 a[176:179], v3 offset:20480
  v_cvt_pk_bf16_f32 v185, v218, v219
  v_mfma_f32_16x16x32_bf16 v[136:139], a[144:147], v[84:87], v[136:139]
  v_exp_f32 v223, v151
  v_mfma_f32_16x16x32_bf16 v[132:135], a[148:151], v[80:83], v[132:135]
  ds_read_b128 a[180:183], v3 offset:21504
  buffer_load_dwordx4 v2, s[44:47], s26 offen offset:1024 sc1 lds
  v_add_f32 v226, v226, v220
  v_mfma_f32_16x16x32_bf16 v[140:143], a[148:151], v[84:87], v[140:143]
  v_exp_f32 v216, v152
  v_mfma_f32_16x16x32_bf16 v[128:131], a[152:155], v[88:91], v[128:131]
  ds_read_b128 a[184:187], v3 offset:22528
  v_add_f32 v226, v226, v221
  v_cvt_pk_bf16_f32 v186, v220, v221
  v_mfma_f32_16x16x32_bf16 v[136:139], a[152:155], v[92:95], v[136:139]
  v_exp_f32 v217, v153
  v_mfma_f32_16x16x32_bf16 v[132:135], a[156:159], v[88:91], v[132:135]
  ds_read_b128 a[188:191], v3 offset:23552
  buffer_load_dwordx4 a[36:39], v2, s[40:43], s14 offen offset:1024 sc1
  v_add_f32 v226, v226, v222
  v_mfma_f32_16x16x32_bf16 v[140:143], a[156:159], v[92:95], v[140:143]
  s_waitcnt lgkmcnt(4)
  v_exp_f32 v218, v154
  v_mfma_f32_16x16x32_bf16 a[64:67], a[160:163], v[176:179], a[64:67]
  ds_read_b128 a[128:131], v3 offset:0
  v_add_f32 v226, v226, v223
  v_cvt_pk_bf16_f32 v187, v222, v223
  v_mfma_f32_16x16x32_bf16 a[68:71], a[160:163], v[180:183], a[68:71]
  v_exp_f32 v219, v155
  v_mfma_f32_16x16x32_bf16 a[72:75], a[164:167], v[176:179], a[72:75]
  ds_read_b128 a[132:135], v3 offset:1024
  buffer_load_dwordx4 v2, s[44:47], s26 offen offset:2048 sc1 lds
  v_add_f32 v227, v216, v217
  v_mfma_f32_16x16x32_bf16 a[76:79], a[164:167], v[180:183], a[76:79]
  v_exp_f32 v220, v156
  v_mfma_f32_16x16x32_bf16 a[80:83], a[168:171], v[176:179], a[80:83]
  ds_read_b128 a[136:139], v3 offset:2048
  buffer_load_dwordx4 a[40:43], v2, s[40:43], s14 offen offset:2048 sc1
  v_cvt_pk_bf16_f32 v188, v216, v217
  v_mfma_f32_16x16x32_bf16 a[84:87], a[168:171], v[180:183], a[84:87]
  v_exp_f32 v221, v157
  v_mfma_f32_16x16x32_bf16 a[88:91], a[172:175], v[176:179], a[88:91]
  ds_read_b128 a[140:143], v3 offset:3072
  v_add_f32 v227, v227, v218
  v_add_f32 v227, v227, v219
  v_mfma_f32_16x16x32_bf16 a[92:95], a[172:175], v[180:183], a[92:95]
  s_waitcnt lgkmcnt(4)
  v_exp_f32 v222, v158
  v_mfma_f32_16x16x32_bf16 a[96:99], a[176:179], v[176:179], a[96:99]
  ds_read_b128 a[144:147], v3 offset:4096
  buffer_load_dwordx4 v2, s[44:47], s26 offen offset:3072 sc1 lds
  v_cvt_pk_bf16_f32 v189, v218, v219
  v_mfma_f32_16x16x32_bf16 a[100:103], a[176:179], v[180:183], a[100:103]
  s_add_u32 s26, s26, 16384
  v_exp_f32 v223, v159
  v_mfma_f32_16x16x32_bf16 a[104:107], a[180:183], v[176:179], a[104:107]
  s_add_u32 s24, s24, 32768
  ds_read_b128 a[148:151], v3 offset:5120
  buffer_load_dwordx4 a[44:47], v2, s[40:43], s14 offen offset:3072 sc1
  v_add_f32 v227, v227, v220
  v_mfma_f32_16x16x32_bf16 a[108:111], a[180:183], v[180:183], a[108:111]
  s_and_b32 s24, s24, 0x1ffff
  v_add_f32 v227, v227, v221
  v_cvt_pk_bf16_f32 v190, v220, v221
  v_add_f32 v227, v227, v222
  v_mfma_f32_16x16x32_bf16 a[112:115], a[184:187], v[176:179], a[112:115]
  ds_read_b128 a[152:155], v3 offset:6144
  v_add_f32 v227, v227, v223
  v_max_f32 v5, v226, v227
  v_cmp_lt_f32 vcc, s81, v5
  v_mfma_f32_16x16x32_bf16 a[116:119], a[184:187], v[180:183], a[116:119]
  v_exp_f32 v216, v128
  v_mfma_f32_16x16x32_bf16 a[120:123], a[188:191], v[176:179], a[120:123]
  s_waitcnt lgkmcnt(3)
  ds_read_b128 a[156:159], v3 offset:7168
  v_cvt_pk_bf16_f32 v191, v222, v223
  v_mfma_f32_16x16x32_bf16 a[124:127], a[188:191], v[180:183], a[124:127]
  s_cbranch_vccnz fa_stub22
fa_back22:
  v_exp_f32 v217, v129
  v_add_f32 v230, v230, v226
  v_add_f32 v231, v231, v227
  v_mfma_f32_16x16x32_bf16 v[144:147], a[128:131], v[64:67], v[200:203]
  ds_read_b128 a[160:163], v3 offset:24576
  v_add_f32 v226, v216, v217
  v_mfma_f32_16x16x32_bf16 v[152:155], a[128:131], v[68:71], v[204:207]
  v_exp_f32 v218, v130
  v_mfma_f32_16x16x32_bf16 v[148:151], a[132:135], v[64:67], v[200:203]
  s_cmp_ge_u32 s27, s50
  s_cselect_b64 s[48:49], s[6:7], s[48:49]
  s_cselect_b32 s50, s30, s50
  ds_read_b128 a[164:167], v3 offset:25600
  v_cvt_pk_bf16_f32 v176, v216, v217
  v_mfma_f32_16x16x32_bf16 v[156:159], a[132:135], v[68:71], v[204:207]
  s_mov_b32 m0, s25
  v_exp_f32 v219, v131
  v_mfma_f32_16x16x32_bf16 v[144:147], a[136:139], v[72:75], v[144:147]
  s_add_u32 s66, s66, 32768
  ds_read_b128 a[168:171], v3 offset:26624
  buffer_load_dwordx4 v2, s[48:51], s27 offen offset:0 sc1 lds
  v_add_f32 v226, v226, v218
  v_add_f32 v226, v226, v219
  v_mfma_f32_16x16x32_bf16 v[152:155], a[136:139], v[76:79], v[152:155]
  s_and_b32 s66, s66, 0x1ffff
  v_exp_f32 v220, v132
  v_mfma_f32_16x16x32_bf16 v[148:151], a[140:143], v[72:75], v[148:151]
  s_add_u32 s14, s13, 28672
  ds_read_b128 a[172:175], v3 offset:27648
  buffer_load_dwordx4 a[48:51], v2, s[40:43], s14 offen offset:0 sc1
  v_cvt_pk_bf16_f32 v177, v218, v219
  v_mfma_f32_16x16x32_bf16 v[156:159], a[140:143], v[76:79], v[156:159]
  s_waitcnt lgkmcnt(4)
  v_exp_f32 v221, v133
  v_mfma_f32_16x16x32_bf16 v[144:147], a[144:147], v[80:83], v[144:147]
  ds_read_b128 a[176:179], v3 offset:28672
  v_add_f32 v226, v226, v220
  v_mfma_f32_16x16x32_bf16 v[152:155], a[144:147], v[84:87], v[152:155]
  v_exp_f32 v222, v134
  v_mfma_f32_16x16x32_bf16 v[148:151], a[148:151], v[80:83], v[148:151]
  ds_read_b128 a[180:183], v3 offset:29696
  buffer_load_dwordx4 v2, s[48:51], s27 offen offset:1024 sc1 lds
  v_add_f32 v226, v226, v221
  v_cvt_pk_bf16_f32 v178, v220, v221
  v_mfma_f32_16x16x32_bf16 v[156:159], a[148:151], v[84:87], v[156:159]
  v_exp_f32 v223, v135
  v_mfma_f32_16x16x32_bf16 v[144:147], a[152:155], v[88:91], v[144:147]
  ds_read_b128 a[184:187], v3 offset:30720
  v_add_f32 v226, v226, v222
  v_mfma_f32_16x16x32_bf16 v[152:155], a[152:155], v[92:95], v[152:155]
  v_exp_f32 v216, v136
  v_mfma_f32_16x16x32_bf16 v[148:151], a[156:159], v[88:91], v[148:151]
  ds_read_b128 a[188:191], v3 offset:31744
  buffer_load_dwordx4 a[52:55], v2, s[40:43], s14 offen offset:1024 sc1
  v_add_f32 v226, v226, v223
  v_exp_f32 v217, v137
  v_mfma_f32_16x16x32_bf16 v[156:159], a[156:159], v[92:95], v[156:159]
  s_waitcnt lgkmcnt(4)
  v_exp_f32 v218, v138
  v_mfma_f32_16x16x32_bf16 a[64:67], a[160:163], v[184:187], a[64:67]
  ds_read_b128 a[128:131], v3 offset:8192
  v_cvt_pk_bf16_f32 v179, v222, v223
  v_mfma_f32_16x16x32_bf16 a[68:71], a[160:163], v[188:191], a[68:71]
  v_exp_f32 v219, v139
  v_mfma_f32_16x16x32_bf16 a[72:75], a[164:167], v[184:187], a[72:75]
  ds_read_b128 a[132:135], v3 offset:9216
  buffer_load_dwordx4 v2, s[48:51], s27 offen offset:2048 sc1 lds
  v_add_f32 v227, v216, v217
  v_mfma_f32_16x16x32_bf16 a[76:79], a[164:167], v[188:191], a[76:79]
  v_exp_f32 v220, v140
  v_mfma_f32_16x16x32_bf16 a[80:83], a[168:171], v[184:187], a[80:83]
  ds_read_b128 a[136:139], v3 offset:10240
  buffer_load_dwordx4 a[56:59], v2, s[40:43], s14 offen offset:2048 sc1
  v_cvt_pk_bf16_f32 v180, v216, v217
  v_mfma_f32_16x16x32_bf16 a[84:87], a[168:171], v[188:191], a[84:87]
  v_exp_f32 v221, v141
  v_mfma_f32_16x16x32_bf16 a[88:91], a[172:175], v[184:187], a[88:91]
  ds_read_b128 a[140:143], v3 offset:11264
  v_add_f32 v227, v227, v218
  v_mfma_f32_16x16x32_bf16 a[92:95], a[172:175], v[188:191], a[92:95]
  s_waitcnt lgkmcnt(4)
  v_exp_f32 v222, v142
  v_mfma_f32_16x16x32_bf16 a[96:99], a[176:179], v[184:187], a[96:99]
  ds_read_b128 a[144:147], v3 offset:12288
  buffer_load_dwordx4 v2, s[48:51], s27 offen offset:3072 sc1 lds
  v_add_f32 v227, v227, v219
  v_cvt_pk_bf16_f32 v181, v218, v219
  v_mfma_f32_16x16x32_bf16 a[100:103], a[176:179], v[188:191], a[100:103]
  s_add_u32 s27, s27, 16384
  v_exp_f32 v223, v143
  v_mfma_f32_16x16x32_bf16 a[104:107], a[180:183], v[184:187], a[104:107]
  s_add_u32 s25, s25, 32768
  ds_read_b128 a[148:151], v3 offset:13312
  buffer_load_dwordx4 a[60:63], v2, s[40:43], s14 offen offset:3072 sc1
  v_add_f32 v227, v227, v220
  v_mfma_f32_16x16x32_bf16 a[108:111], a[180:183], v[188:191], a[108:111]
  s_and_b32 s25, s25, 0x1ffff
  v_add_f32 v227, v227, v221
  v_cvt_pk_bf16_f32 v182, v220, v221
  v_add_f32 v227, v227, v222
  v_mfma_f32_16x16x32_bf16 a[112:115], a[184:187], v[184:187], a[112:115]
  ds_read_b128 a[152:155], v3 offset:14336
  v_add_f32 v227, v227, v223
  v_max_f32 v5, v226, v227
  v_cmp_lt_f32 vcc, s81, v5
  v_mfma_f32_16x16x32_bf16 a[116:119], a[184:187], v[188:191], a[116:119]
  v_exp_f32 v216, v144
  v_mfma_f32_16x16x32_bf16 a[120:123], a[188:191], v[184:187], a[120:123]
  s_waitcnt lgkmcnt(3)
  ds_read_b128 a[156:159], v3 offset:15360
  v_cvt_pk_bf16_f32 v183, v222, v223
  v_add_u32 v3, s66, v2
  v_mfma_f32_16x16x32_bf16 a[124:127], a[188:191], v[188:191], a[124:127]
  s_cbranch_vccnz fa_stub23
fa_back23:
  v_exp_f32 v217, v145
  v_add_f32 v230, v230, v226
  v_add_f32 v231, v231, v227
fa_SSW2:
  v_mfma_f32_16x16x32_bf16 v[128:131], a[128:131], v[64:67], v[200:203]
  s_waitcnt vmcnt(12)
  v_exp_f32 v218, v146
  v_mfma_f32_16x16x32_bf16 v[136:139], a[128:131], v[68:71], v[204:207]
  s_barrier
  v_exp_f32 v219, v147
  v_mfma_f32_16x16x32_bf16 v[132:135], a[132:135], v[64:67], v[200:203]
  s_cmp_ge_u32 s26, s46
  s_cselect_b64 s[44:45], s[4:5], s[44:45]
  s_cselect_b32 s46, s30, s46
  ds_read_b128 a[160:163], v3 offset:16384
  ds_read_b128 a[164:167], v3 offset:17408
  v_add_f32 v226, v216, v217
  v_mfma_f32_16x16x32_bf16 v[140:143], a[132:135], v[68:71], v[204:207]
  s_mov_b32 m0, s24
  v_exp_f32 v220, v148
  v_mfma_f32_16x16x32_bf16 v[128:131], a[136:139], v[72:75], v[128:131]
  ds_read_b128 a[168:171], v3 offset:18432
  buffer_load_dwordx4 v2, s[44:47], s26 offen offset:0 sc1 lds
  v_cvt_pk_bf16_f32 v184, v216, v217
  v_mfma_f32_16x16x32_bf16 v[136:139], a[136:139], v[76:79], v[136:139]
  v_exp_f32 v221, v149
  v_mfma_f32_16x16x32_bf16 v[132:135], a[140:143], v[72:75], v[132:135]
  s_add_u32 s14, s13, 32768
  ds_read_b128 a[172:175], v3 offset:19456
  buffer_load_dwordx4 v[32:35], v2, s[40:43], s14 offen offset:0 sc1
  v_add_f32 v226, v226, v218
  v_add_f32 v226, v226, v219
  v_mfma_f32_16x16x32_bf16 v[140:143], a[140:143], v[76:79], v[140:143]
  s_waitcnt lgkmcnt(4)
  v_exp_f32 v222, v150
  v_mfma_f32_16x16x32_bf16 v[128:131], a[144:147], v[80:83], v[128:131]
  ds_read_b128 a[176:179], v3 offset:20480
  v_cvt_pk_bf16_f32 v185, v218, v219
  v_mfma_f32_16x16x32_bf16 v[136:139], a[144:147], v[84:87], v[136:139]
  v_exp_f32 v223, v151
  v_mfma_f32_16x16x32_bf16 v[132:135], a[148:151], v[80:83], v[132:135]
  ds_read_b128 a[180:183], v3 offset:21504
  buffer_load_dwordx4 v2, s[44:47], s26 offen offset:1024 sc1 lds
  v_add_f32 v226, v226, v220
  v_mfma_f32_16x16x32_bf16 v[140:143], a[148:151], v[84:87], v[140:143]
  v_exp_f32 v216, v152
  v_mfma_f32_16x16x32_bf16 v[128:131], a[152:155], v[88:91], v[128:131]
  ds_read_b128 a[184:187], v3 offset:22528
  v_add_f32 v226, v226, v221
  v_cvt_pk_bf16_f32 v186, v220, v221
  v_mfma_f32_16x16x32_bf16 v[136:139], a[152:155], v[92:95], v[136:139]
  v_exp_f32 v217, v153
  v_mfma_f32_16x16x32_bf16 v[132:135], a[156:159], v[88:91], v[132:135]
  ds_read_b128 a[188:191], v3 offset:23552
  buffer_load_dwordx4 v[36:39], v2, s[40:43], s14 offen offset:1024 sc1
  v_add_f32 v226, v226, v222
  v_mfma_f32_16x16x32_bf16 v[140:143], a[156:159], v[92:95], v[140:143]
  s_waitcnt lgkmcnt(4)
  v_exp_f32 v218, v154
  v_mfma_f32_16x16x32_bf16 a[64:67], a[160:163], v[176:179], a[64:67]
  ds_read_b128 a[128:131], v3 offset:0
  v_add_f32 v226, v226, v223
  v_cvt_pk_bf16_f32 v187, v222, v223
  v_mfma_f32_16x16x32_bf16 a[68:71], a[160:163], v[180:183], a[68:71]
  v_exp_f32 v219, v155
  v_mfma_f32_16x16x32_bf16 a[72:75], a[164:167], v[176:179], a[72:75]
  ds_read_b128 a[132:135], v3 offset:1024
  buffer_load_dwordx4 v2, s[44:47], s26 offen offset:2048 sc1 lds
  v_add_f32 v227, v216, v217
  v_mfma_f32_16x16x32_bf16 a[76:79], a[164:167], v[180:183], a[76:79]
  v_exp_f32 v220, v156
  v_mfma_f32_16x16x32_bf16 a[80:83], a[168:171], v[176:179], a[80:83]
  ds_read_b128 a[136:139], v3 offset:2048
  buffer_load_dwordx4 v[40:43], v2, s[40:43], s14 offen offset:2048 sc1
  v_cvt_pk_bf16_f32 v188, v216, v217
  v_mfma_f32_16x16x32_bf16 a[84:87], a[168:171], v[180:183], a[84:87]
  v_exp_f32 v221, v157
  v_mfma_f32_16x16x32_bf16 a[88:91], a[172:175], v[176:179], a[88:91]
  ds_read_b128 a[140:143], v3 offset:3072
  v_add_f32 v227, v227, v218
  v_add_f32 v227, v227, v219
  v_mfma_f32_16x16x32_bf16 a[92:95], a[172:175], v[180:183], a[92:95]
  s_waitcnt lgkmcnt(4)
  v_exp_f32 v222, v158
  v_mfma_f32_16x16x32_bf16 a[96:99], a[176:179], v[176:179], a[96:99]
  ds_read_b128 a[144:147], v3 offset:4096
  buffer_load_dwordx4 v2, s[44:47], s26 offen offset:3072 sc1 lds
  v_cvt_pk_bf16_f32 v189, v218, v219
  v_mfma_f32_16x16x32_bf16 a[100:103], a[176:179], v[180:183], a[100:103]
  s_add_u32 s26, s26, 16384
  v_exp_f32 v223, v159
  v_mfma_f32_16x16x32_bf16 a[104:107], a[180:183], v[176:179], a[104:107]
  s_add_u32 s24, s24, 32768
  ds_read_b128 a[148:151], v3 offset:5120
  buffer_load_dwordx4 v[44:47], v2, s[40:43], s14 offen offset:3072 sc1
  v_add_f32 v227, v227, v220
  v_mfma_f32_16x16x32_bf16 a[108:111], a[180:183], v[180:183], a[108:111]
  s_and_b32 s24, s24, 0x1ffff
  v_add_f32 v227, v227, v221
  v_cvt_pk_bf16_f32 v190, v220, v221
  v_add_f32 v227, v227, v222
  v_mfma_f32_16x16x32_bf16 a[112:115], a[184:187], v[176:179], a[112:115]
  ds_read_b128 a[152:155], v3 offset:6144
  v_add_f32 v227, v227, v223
  v_max_f32 v5, v226, v227
  v_cmp_lt_f32 vcc, s81, v5
  v_mfma_f32_16x16x32_bf16 a[116:119], a[184:187], v[180:183], a[116:119]
  v_exp_f32 v216, v128
  v_mfma_f32_16x16x32_bf16 a[120:123], a[188:191], v[176:179], a[120:123]
  s_waitcnt lgkmcnt(3)
  ds_read_b128 a[156:159], v3 offset:7168
  v_cvt_pk_bf16_f32 v191, v222, v223
  v_mfma_f32_16x16x32_bf16 a[124:127], a[188:191], v[180:183], a[124:127]
  s_cbranch_vccnz fa_stub24
fa_back24:
  v_exp_f32 v217, v129
  v_add_f32 v230, v230, v226
  v_add_f32 v231, v231, v227
  v_mfma_f32_16x16x32_bf16 v[144:147], a[128:131], v[64:67], v[200:203]
  ds_read_b128 a[160:163], v3 offset:24576
  v_add_f32 v226, v216, v217
  v_mfma_f32_16x16x32_bf16 v[152:155], a[128:131], v[68:71], v[204:207]
  v_exp_f32 v218, v130
  v_mfma_f32_16x16x32_bf16 v[148:151], a[132:135], v[64:67], v[200:203]
  s_cmp_ge_u32 s27, s50
  s_cselect_b64 s[48:49], s[6:7], s[48:49]
  s_cselect_b32 s50, s30, s50
  ds_read_b128 a[164:167], v3 offset:25600
  v_cvt_pk_bf16_f32 v176, v216, v217
  v_mfma_f32_16x16x32_bf16 v[156:159], a[132:135], v[68:71], v[204:207]
  s_mov_b32 m0, s25
  v_exp_f32 v219, v131
  v_mfma_f32_16x16x32_bf16 v[144:147], a[136:139], v[72:75], v[144:147]
  s_add_u32 s66, s66, 32768
  ds_read_b128 a[168:171], v3 offset:26624
  buffer_load_dwordx4 v2, s[48:51], s27 offen offset:0 sc1 lds
  v_add_f32 v226, v226, v218
  v_add_f32 v226, v226, v219
  v_mfma_f32_16x16x32_bf16 v[152:155], a[136:139], v[76:79], v[152:155]
  s_and_b32 s66, s66, 0x1ffff
  v_exp_f32 v220, v132
  v_mfma_f32_16x16x32_bf16 v[148:151], a[140:143], v[72:75], v[148:151]
  s_add_u32 s14, s13, 36864
  ds_read_b128 a[172:175], v3 offset:27648
  buffer_load_dwordx4 v[48:51], v2, s[40:43], s14 offen offset:0 sc1
  v_cvt_pk_bf16_f32 v177, v218, v219
  v_mfma_f32_16x16x32_bf16 v[156:159], a[140:143], v[76:79], v[156:159]
  s_waitcnt lgkmcnt(4)
  v_exp_f32 v221, v133
  v_mfma_f32_16x16x32_bf16 v[144:147], a[144:147], v[80:83], v[144:147]
  ds_read_b128 a[176:179], v3 offset:28672
  v_add_f32 v226, v226, v220
  v_mfma_f32_16x16x32_bf16 v[152:155], a[144:147], v[84:87], v[152:155]
  v_exp_f32 v222, v134
  v_mfma_f32_16x16x32_bf16 v[148:151], a[148:151], v[80:83], v[148:151]
  ds_read_b128 a[180:183], v3 offset:29696
  buffer_load_dwordx4 v2, s[48:51], s27 offen offset:1024 sc1 lds
  v_add_f32 v226, v226, v221
  v_cvt_pk_bf16_f32 v178, v220, v221
  v_mfma_f32_16x16x32_bf16 v[156:159], a[148:151], v[84:87], v[156:159]
  v_exp_f32 v223, v135
  v_mfma_f32_16x16x32_bf16 v[144:147], a[152:155], v[88:91], v[144:147]
  ds_read_b128 a[184:187], v3 offset:30720
  v_add_f32 v226, v226, v222
  v_mfma_f32_16x16x32_bf16 v[152:155], a[152:155], v[92:95], v[152:155]
  v_exp_f32 v216, v136
  v_mfma_f32_16x16x32_bf16 v[148:151], a[156:159], v[88:91], v[148:151]
  ds_read_b128 a[188:191], v3 offset:31744
  buffer_load_dwordx4 v[52:55], v2, s[40:43], s14 offen offset:1024 sc1
  v_add_f32 v226, v226, v223
  v_exp_f32 v217, v137
  v_mfma_f32_16x16x32_bf16 v[156:159], a[156:159], v[92:95], v[156:159]
  s_waitcnt lgkmcnt(4)
  v_exp_f32 v218, v138
  v_mfma_f32_16x16x32_bf16 a[64:67], a[160:163], v[184:187], a[64:67]
  ds_read_b128 a[128:131], v3 offset:8192
  v_cvt_pk_bf16_f32 v179, v222, v223
  v_mfma_f32_16x16x32_bf16 a[68:71], a[160:163], v[188:191], a[68:71]
  v_exp_f32 v219, v139
  v_mfma_f32_16x16x32_bf16 a[72:75], a[164:167], v[184:187], a[72:75]
  ds_read_b128 a[132:135], v3 offset:9216
  buffer_load_dwordx4 v2, s[48:51], s27 offen offset:2048 sc1 lds
  v_add_f32 v227, v216, v217
  v_mfma_f32_16x16x32_bf16 a[76:79], a[164:167], v[188:191], a[76:79]
  v_exp_f32 v220, v140
  v_mfma_f32_16x16x32_bf16 a[80:83], a[168:171], v[184:187], a[80:83]
  ds_read_b128 a[136:139], v3 offset:10240
  buffer_load_dwordx4 v[56:59], v2, s[40:43], s14 offen offset:2048 sc1
  v_cvt_pk_bf16_f32 v180, v216, v217
  v_mfma_f32_16x16x32_bf16 a[84:87], a[168:171], v[188:191], a[84:87]
  v_exp_f32 v221, v141
  v_mfma_f32_16x16x32_bf16 a[88:91], a[172:175], v[184:187], a[88:91]
  ds_read_b128 a[140:143], v3 offset:11264
  v_add_f32 v227, v227, v218
  v_mfma_f32_16x16x32_bf16 a[92:95], a[172:175], v[188:191], a[92:95]
  s_waitcnt lgkmcnt(4)
  v_exp_f32 v222, v142
  v_mfma_f32_16x16x32_bf16 a[96:99], a[176:179], v[184:187], a[96:99]
  ds_read_b128 a[144:147], v3 offset:12288
  buffer_load_dwordx4 v2, s[48:51], s27 offen offset:3072 sc1 lds
  v_add_f32 v227, v227, v219
  v_cvt_pk_bf16_f32 v181, v218, v219
  v_mfma_f32_16x16x32_bf16 a[100:103], a[176:179], v[188:191], a[100:103]
  s_add_u32 s27, s27, 16384
  v_exp_f32 v223, v143
  v_mfma_f32_16x16x32_bf16 a[104:107], a[180:183], v[184:187], a[104:107]
  s_add_u32 s25, s25, 32768
  ds_read_b128 a[148:151], v3 offset:13312
  buffer_load_dwordx4 v[60:63], v2, s[40:43], s14 offen offset:3072 sc1
  v_add_f32 v227, v227, v220
  v_mfma_f32_16x16x32_bf16 a[108:111], a[180:183], v[188:191], a[108:111]
  s_and_b32 s25, s25, 0x1ffff
  v_add_f32 v227, v227, v221
  v_cvt_pk_bf16_f32 v182, v220, v221
  v_add_f32 v227, v227, v222
  v_mfma_f32_16x16x32_bf16 a[112:115], a[184:187], v[184:187], a[112:115]
  ds_read_b128 a[152:155], v3 offset:14336
  v_add_f32 v227, v227, v223
  v_max_f32 v5, v226, v227
  v_cmp_lt_f32 vcc, s81, v5
  v_mfma_f32_16x16x32_bf16 a[116:119], a[184:187], v[188:191], a[116:119]
  v_exp_f32 v216, v144
  v_mfma_f32_16x16x32_bf16 a[120:123], a[188:191], v[184:187], a[120:123]
  s_waitcnt lgkmcnt(3)
  ds_read_b128 a[156:159], v3 offset:15360
  v_cvt_pk_bf16_f32 v183, v222, v223
  v_add_u32 v3, s66, v2
  v_mfma_f32_16x16x32_bf16 a[124:127], a[188:191], v[188:191], a[124:127]
  s_cbranch_vccnz fa_stub25
fa_back25:
  v_exp_f32 v217, v145
  v_add_f32 v230, v230, v226
  v_add_f32 v231, v231, v227
fa_SSW1:
  v_mfma_f32_16x16x32_bf16 v[128:131], a[128:131], v[64:67], v[200:203]
  s_waitcnt vmcnt(8)
  v_exp_f32 v218, v146
  v_mfma_f32_16x16x32_bf16 v[136:139], a[128:131], v[68:71], v[204:207]
  s_barrier
  v_exp_f32 v219, v147
  v_mfma_f32_16x16x32_bf16 v[132:135], a[132:135], v[64:67], v[200:203]
  s_cmp_ge_u32 s26, s46
  s_cselect_b64 s[44:45], s[4:5], s[44:45]
  s_cselect_b32 s46, s30, s46
  ds_read_b128 a[160:163], v3 offset:16384
  ds_read_b128 a[164:167], v3 offset:17408
  v_add_f32 v226, v216, v217
  v_mfma_f32_16x16x32_bf16 v[140:143], a[132:135], v[68:71], v[204:207]
  s_mov_b32 m0, s24
  v_exp_f32 v220, v148
  v_mfma_f32_16x16x32_bf16 v[128:131], a[136:139], v[72:75], v[128:131]
  ds_read_b128 a[168:171], v3 offset:18432
  buffer_load_dwordx4 v2, s[44:47], s26 offen offset:0 sc1 lds
  v_cvt_pk_bf16_f32 v184, v216, v217
  v_mfma_f32_16x16x32_bf16 v[136:139], a[136:139], v[76:79], v[136:139]
  v_exp_f32 v221, v149
  v_mfma_f32_16x16x32_bf16 v[132:135], a[140:143], v[72:75], v[132:135]
  s_add_u32 s14, s13, 40960
  ds_read_b128 a[172:175], v3 offset:19456
  buffer_load_dwordx4 v[96:99], v2, s[40:43], s14 offen offset:0 sc1
  v_add_f32 v226, v226, v218
  v_add_f32 v226, v226, v219
  v_mfma_f32_16x16x32_bf16 v[140:143], a[140:143], v[76:79], v[140:143]
  s_waitcnt lgkmcnt(4)
  v_exp_f32 v222, v150
  v_mfma_f32_16x16x32_bf16 v[128:131], a[144:147], v[80:83], v[128:131]
  ds_read_b128 a[176:179], v3 offset:20480
  v_cvt_pk_bf16_f32 v185, v218, v219
  v_mfma_f32_16x16x32_bf16 v[136:139], a[144:147], v[84:87], v[136:139]
  v_exp_f32 v223, v151
  v_mfma_f32_16x16x32_bf16 v[132:135], a[148:151], v[80:83], v[132:135]
  ds_read_b128 a[180:183], v3 offset:21504
  buffer_load_dwordx4 v2, s[44:47], s26 offen offset:1024 sc1 lds
  v_add_f32 v226, v226, v220
  v_mfma_f32_16x16x32_bf16 v[140:143], a[148:151], v[84:87], v[140:143]
  v_exp_f32 v216, v152
  v_mfma_f32_16x16x32_bf16 v[128:131], a[152:155], v[88:91], v[128:131]
  ds_read_b128 a[184:187], v3 offset:22528
  v_add_f32 v226, v226, v221
  v_cvt_pk_bf16_f32 v186, v220, v221
  v_mfma_f32_16x16x32_bf16 v[136:139], a[152:155], v[92:95], v[136:139]
  v_exp_f32 v217, v153
  v_mfma_f32_16x16x32_bf16 v[132:135], a[156:159], v[88:91], v[132:135]
  ds_read_b128 a[188:191], v3 offset:23552
  buffer_load_dwordx4 v[100:103], v2, s[40:43], s14 offen offset:1024 sc1
  v_add_f32 v226, v226, v222
  v_mfma_f32_16x16x32_bf16 v[140:143], a[156:159], v[92:95], v[140:143]
  s_waitcnt lgkmcnt(4)
  v_exp_f32 v218, v154
  v_mfma_f32_16x16x32_bf16 a[64:67], a[160:163], v[176:179], a[64:67]
  ds_read_b128 a[128:131], v3 offset:0
  v_add_f32 v226, v226, v223
  v_cvt_pk_bf16_f32 v187, v222, v223
  v_mfma_f32_16x16x32_bf16 a[68:71], a[160:163], v[180:183], a[68:71]
  v_exp_f32 v219, v155
  v_mfma_f32_16x16x32_bf16 a[72:75], a[164:167], v[176:179], a[72:75]
  ds_read_b128 a[132:135], v3 offset:1024
  buffer_load_dwordx4 v2, s[44:47], s26 offen offset:2048 sc1 lds
  v_add_f32 v227, v216, v217
  v_mfma_f32_16x16x32_bf16 a[76:79], a[164:167], v[180:183], a[76:79]
  v_exp_f32 v220, v156
  v_mfma_f32_16x16x32_bf16 a[80:83], a[168:171], v[176:179], a[80:83]
  ds_read_b128 a[136:139], v3 offset:2048
  buffer_load_dwordx4 v[104:107], v2, s[40:43], s14 offen offset:2048 sc1
  v_cvt_pk_bf16_f32 v188, v216, v217
  v_mfma_f32_16x16x32_bf16 a[84:87], a[168:171], v[180:183], a[84:87]
  v_exp_f32 v221, v157
  v_mfma_f32_16x16x32_bf16 a[88:91], a[172:175], v[176:179], a[88:91]
  ds_read_b128 a[140:143], v3 offset:3072
  v_add_f32 v227, v227, v218
  v_add_f32 v227, v227, v219
  v_mfma_f32_16x16x32_bf16 a[92:95], a[172:175], v[180:183], a[92:95]
  s_waitcnt lgkmcnt(4)
  v_exp_f32 v222, v158
  v_mfma_f32_16x16x32_bf16 a[96:99], a[176:179], v[176:179], a[96:99]
  ds_read_b128 a[144:147], v3 offset:4096
  buffer_load_dwordx4 v2, s[44:47], s26 offen offset:3072 sc1 lds
  v_cvt_pk_bf16_f32 v189, v218, v219
  v_mfma_f32_16x16x32_bf16 a[100:103], a[176:179], v[180:183], a[100:103]
  s_add_u32 s26, s26, 16384
  v_exp_f32 v223, v159
  v_mfma_f32_16x16x32_bf16 a[104:107], a[180:183], v[176:179], a[104:107]
  s_add_u32 s24, s24, 32768
  ds_read_b128 a[148:151], v3 offset:5120
  buffer_load_dwordx4 v[108:111], v2, s[40:43], s14 offen offset:3072 sc1
  v_add_f32 v227, v227, v220
  v_mfma_f32_16x16x32_bf16 a[108:111], a[180:183], v[180:183], a[108:111]
  s_and_b32 s24, s24, 0x1ffff
  v_add_f32 v227, v227, v221
  v_cvt_pk_bf16_f32 v190, v220, v221
  v_add_f32 v227, v227, v222
  v_mfma_f32_16x16x32_bf16 a[112:115], a[184:187], v[176:179], a[112:115]
  ds_read_b128 a[152:155], v3 offset:6144
  v_add_f32 v227, v227, v223
  v_max_f32 v5, v226, v227
  v_cmp_lt_f32 vcc, s81, v5
  v_mfma_f32_16x16x32_bf16 a[116:119], a[184:187], v[180:183], a[116:119]
  v_exp_f32 v216, v128
  v_mfma_f32_16x16x32_bf16 a[120:123], a[188:191], v[176:179], a[120:123]
  s_waitcnt lgkmcnt(3)
  ds_read_b128 a[156:159], v3 offset:7168
  v_cvt_pk_bf16_f32 v191, v222, v223
  v_mfma_f32_16x16x32_bf16 a[124:127], a[188:191], v[180:183], a[124:127]
  s_cbranch_vccnz fa_stub26
fa_back26:
  v_exp_f32 v217, v129
  v_add_f32 v230, v230, v226
  v_add_f32 v231, v231, v227
  v_mfma_f32_16x16x32_bf16 v[144:147], a[128:131], v[64:67], v[200:203]
  ds_read_b128 a[160:163], v3 offset:24576
  v_add_f32 v226, v216, v217
  v_mfma_f32_16x16x32_bf16 v[152:155], a[128:131], v[68:71], v[204:207]
  v_exp_f32 v218, v130
  v_mfma_f32_16x16x32_bf16 v[148:151], a[132:135], v[64:67], v[200:203]
  s_cmp_ge_u32 s27, s50
  s_cselect_b64 s[48:49], s[6:7], s[48:49]
  s_cselect_b32 s50, s30, s50
  ds_read_b128 a[164:167], v3 offset:25600
  v_cvt_pk_bf16_f32 v176, v216, v217
  v_mfma_f32_16x16x32_bf16 v[156:159], a[132:135], v[68:71], v[204:207]
  s_mov_b32 m0, s25
  v_exp_f32 v219, v131
  v_mfma_f32_16x16x32_bf16 v[144:147], a[136:139], v[72:75], v[144:147]
  s_add_u32 s66, s66, 32768
  ds_read_b128 a[168:171], v3 offset:26624
  buffer_load_dwordx4 v2, s[48:51], s27 offen offset:0 sc1 lds
  v_add_f32 v226, v226, v218
  v_add_f32 v226, v226, v219
  v_mfma_f32_16x16x32_bf16 v[152:155], a[136:139], v[76:79], v[152:155]
  s_and_b32 s66, s66, 0x1ffff
  v_exp_f32 v220, v132
  v_mfma_f32_16x16x32_bf16 v[148:151], a[140:143], v[72:75], v[148:151]
  s_add_u32 s14, s13, 45056
  ds_read_b128 a[172:175], v3 offset:27648
  buffer_load_dwordx4 v[112:115], v2, s[40:43], s14 offen offset:0 sc1
  v_cvt_pk_bf16_f32 v177, v218, v219
  v_mfma_f32_16x16x32_bf16 v[156:159], a[140:143], v[76:79], v[156:159]
  s_waitcnt lgkmcnt(4)
  v_exp_f32 v221, v133
  v_mfma_f32_16x16x32_bf16 v[144:147], a[144:147], v[80:83], v[144:147]
  ds_read_b128 a[176:179], v3 offset:28672
  v_add_f32 v226, v226, v220
  v_mfma_f32_16x16x32_bf16 v[152:155], a[144:147], v[84:87], v[152:155]
  v_exp_f32 v222, v134
  v_mfma_f32_16x16x32_bf16 v[148:151], a[148:151], v[80:83], v[148:151]
  ds_read_b128 a[180:183], v3 offset:29696
  buffer_load_dwordx4 v2, s[48:51], s27 offen offset:1024 sc1 lds
  v_add_f32 v226, v226, v221
  v_cvt_pk_bf16_f32 v178, v220, v221
  v_mfma_f32_16x16x32_bf16 v[156:159], a[148:151], v[84:87], v[156:159]
  v_exp_f32 v223, v135
  v_mfma_f32_16x16x32_bf16 v[144:147], a[152:155], v[88:91], v[144:147]
  ds_read_b128 a[184:187], v3 offset:30720
  v_add_f32 v226, v226, v222
  v_mfma_f32_16x16x32_bf16 v[152:155], a[152:155], v[92:95], v[152:155]
  v_exp_f32 v216, v136
  v_mfma_f32_16x16x32_bf16 v[148:151], a[156:159], v[88:91], v[148:151]
  ds_read_b128 a[188:191], v3 offset:31744
  buffer_load_dwordx4 v[116:119], v2, s[40:43], s14 offen offset:1024 sc1
  v_add_f32 v226, v226, v223
  v_exp_f32 v217, v137
  v_mfma_f32_16x16x32_bf16 v[156:159], a[156:159], v[92:95], v[156:159]
  s_waitcnt lgkmcnt(4)
  v_exp_f32 v218, v138
  v_mfma_f32_16x16x32_bf16 a[64:67], a[160:163], v[184:187], a[64:67]
  ds_read_b128 a[128:131], v3 offset:8192
  v_cvt_pk_bf16_f32 v179, v222, v223
  v_mfma_f32_16x16x32_bf16 a[68:71], a[160:163], v[188:191], a[68:71]
  v_exp_f32 v219, v139
  v_mfma_f32_16x16x32_bf16 a[72:75], a[164:167], v[184:187], a[72:75]
  ds_read_b128 a[132:135], v3 offset:9216
  buffer_load_dwordx4 v2, s[48:51], s27 offen offset:2048 sc1 lds
  v_add_f32 v227, v216, v217
  v_mfma_f32_16x16x32_bf16 a[76:79], a[164:167], v[188:191], a[76:79]
  v_exp_f32 v220, v140
  v_mfma_f32_16x16x32_bf16 a[80:83], a[168:171], v[184:187], a[80:83]
  ds_read_b128 a[136:139], v3 offset:10240
  buffer_load_dwordx4 v[120:123], v2, s[40:43], s14 offen offset:2048 sc1
  v_cvt_pk_bf16_f32 v180, v216, v217
  v_mfma_f32_16x16x32_bf16 a[84:87], a[168:171], v[188:191], a[84:87]
  v_exp_f32 v221, v141
  v_mfma_f32_16x16x32_bf16 a[88:91], a[172:175], v[184:187], a[88:91]
  ds_read_b128 a[140:143], v3 offset:11264
  v_add_f32 v227, v227, v218
  v_mfma_f32_16x16x32_bf16 a[92:95], a[172:175], v[188:191], a[92:95]
  s_waitcnt lgkmcnt(4)
  v_exp_f32 v222, v142
  v_mfma_f32_16x16x32_bf16 a[96:99], a[176:179], v[184:187], a[96:99]
  ds_read_b128 a[144:147], v3 offset:12288
  buffer_load_dwordx4 v2, s[48:51], s27 offen offset:3072 sc1 lds
  v_add_f32 v227, v227, v219
  v_cvt_pk_bf16_f32 v181, v218, v219
  v_mfma_f32_16x16x32_bf16 a[100:103], a[176:179], v[188:191], a[100:103]
  s_add_u32 s27, s27, 16384
  v_exp_f32 v223, v143
  v_mfma_f32_16x16x32_bf16 a[104:107], a[180:183], v[184:187], a[104:107]
  s_add_u32 s25, s25, 32768
  ds_read_b128 a[148:151], v3 offset:13312
  buffer_load_dwordx4 v[124:127], v2, s[40:43], s14 offen offset:3072 sc1
  v_add_f32 v227, v227, v220
  v_mfma_f32_16x16x32_bf16 a[108:111], a[180:183], v[188:191], a[108:111]
  s_and_b32 s25, s25, 0x1ffff
  v_add_f32 v227, v227, v221
  v_cvt_pk_bf16_f32 v182, v220, v221
  v_add_f32 v227, v227, v222
  v_mfma_f32_16x16x32_bf16 a[112:115], a[184:187], v[184:187], a[112:115]
  ds_read_b128 a[152:155], v3 offset:14336
  v_add_f32 v227, v227, v223
  v_max_f32 v5, v226, v227
  v_cmp_lt_f32 vcc, s81, v5
  v_mfma_f32_16x16x32_bf16 a[116:119], a[184:187], v[188:191], a[116:119]
  v_exp_f32 v216, v144
  v_mfma_f32_16x16x32_bf16 a[120:123], a[188:191], v[184:187], a[120:123]
  s_waitcnt lgkmcnt(3)
  ds_read_b128 a[156:159], v3 offset:15360
  v_cvt_pk_bf16_f32 v183, v222, v223
  v_add_u32 v3, s66, v2
  v_mfma_f32_16x16x32_bf16 a[124:127], a[188:191], v[188:191], a[124:127]
  s_cbranch_vccnz fa_stub27
fa_back27:
  v_exp_f32 v217, v145
  v_add_f32 v230, v230, v226
  v_add_f32 v231, v231, v227
fa_Bexit:
  s_bitcmp1_b32 s20, 0
  s_cbranch_scc1 fa_Bodd
  v_mfma_f32_16x16x32_bf16 v[128:131], a[128:131], v[64:67], v[200:203]
  s_waitcnt vmcnt(8)
  v_exp_f32 v218, v146
  v_mfma_f32_16x16x32_bf16 v[136:139], a[128:131], v[68:71], v[204:207]
  s_barrier
  v_exp_f32 v219, v147
  v_mfma_f32_16x16x32_bf16 v[132:135], a[132:135], v[64:67], v[200:203]
  ds_read_b128 a[160:163], v3 offset:16384
  ds_read_b128 a[164:167], v3 offset:17408
  v_add_f32 v226, v216, v217
  v_mfma_f32_16x16x32_bf16 v[140:143], a[132:135], v[68:71], v[204:207]
  s_add_u32 s14, s13, 49152
  buffer_load_dwordx4 v[160:163], v2, s[40:43], s14 offen offset:0 sc1
  v_cvt_pk_bf16_f32 v184, v216, v217
  v_mfma_f32_16x16x32_bf16 v[128:131], a[136:139], v[72:75], v[128:131]
  ds_read_b128 a[168:171], v3 offset:18432
  v_add_f32 v226, v226, v218
  v_mfma_f32_16x16x32_bf16 v[136:139], a[136:139], v[76:79], v[136:139]
  v_exp_f32 v220, v148
  v_mfma_f32_16x16x32_bf16 v[132:135], a[140:143], v[72:75], v[132:135]
  ds_read_b128 a[172:175], v3 offset:19456
  v_add_f32 v226, v226, v219
  v_cvt_pk_bf16_f32 v185, v218, v219
  v_mfma_f32_16x16x32_bf16 v[140:143], a[140:143], v[76:79], v[140:143]
  s_waitcnt lgkmcnt(4)
  buffer_load_dwordx4 v[164:167], v2, s[40:43], s14 offen offset:1024 sc1
  v_add_f32 v226, v226, v220
  v_mfma_f32_16x16x32_bf16 v[128:131], a[144:147], v[80:83], v[128:131]
  ds_read_b128 a[176:179], v3 offset:20480
  v_mfma_f32_16x16x32_bf16 v[136:139], a[144:147], v[84:87], v[136:139]
  v_exp_f32 v221, v149
  v_mfma_f32_16x16x32_bf16 v[132:135], a[148:151], v[80:83], v[132:135]
  ds_read_b128 a[180:183], v3 offset:21504
  v_add_f32 v226, v226, v221
  v_mfma_f32_16x16x32_bf16 v[140:143], a[148:151], v[84:87], v[140:143]
  v_exp_f32 v222, v150
  v_mfma_f32_16x16x32_bf16 v[128:131], a[152:155], v[88:91], v[128:131]
  ds_read_b128 a[184:187], v3 offset:22528
  buffer_load_dwordx4 v[168:171], v2, s[40:43], s14 offen offset:2048 sc1
  v_cvt_pk_bf16_f32 v186, v220, v221
  v_mfma_f32_16x16x32_bf16 v[136:139], a[152:155], v[92:95], v[136:139]
  v_exp_f32 v223, v151
  v_mfma_f32_16x16x32_bf16 v[132:135], a[156:159], v[88:91], v[132:135]
  ds_read_b128 a[188:191], v3 offset:23552
  v_add_f32 v226, v226, v222
  v_add_f32 v226, v226, v223
  v_mfma_f32_16x16x32_bf16 v[140:143], a[156:159], v[92:95], v[140:143]
  s_waitcnt lgkmcnt(4)
  v_exp_f32 v216, v152
  v_mfma_f32_16x16x32_bf16 a[64:67], a[160:163], v[176:179], a[64:67]
  v_exp_f32 v217, v153
  v_mfma_f32_16x16x32_bf16 a[68:71], a[160:163], v[180:183], a[68:71]
  buffer_load_dwordx4 v[172:175], v2, s[40:43], s14 offen offset:3072 sc1
  v_cvt_pk_bf16_f32 v187, v222, v223
  v_add_f32 v227, v216, v217
  v_mfma_f32_16x16x32_bf16 a[72:75], a[164:167], v[176:179], a[72:75]
  v_exp_f32 v218, v154
  v_mfma_f32_16x16x32_bf16 a[76:79], a[164:167], v[180:183], a[76:79]
  v_exp_f32 v219, v155
  v_mfma_f32_16x16x32_bf16 a[80:83], a[168:171], v[176:179], a[80:83]
  v_exp_f32 v220, v156
  v_mfma_f32_16x16x32_bf16 a[84:87], a[168:171], v[180:183], a[84:87]
  s_add_u32 s14, s13, 53248
  buffer_load_dwordx4 v[192:195], v2, s[40:43], s14 offen offset:0 sc1
  v_cvt_pk_bf16_f32 v188, v216, v217
  v_add_f32 v227, v227, v218
  v_mfma_f32_16x16x32_bf16 a[88:91], a[172:175], v[176:179], a[88:91]
  v_exp_f32 v221, v157
  v_mfma_f32_16x16x32_bf16 a[92:95], a[172:175], v[180:183], a[92:95]
  s_waitcnt lgkmcnt(0)
  v_exp_f32 v222, v158
  v_mfma_f32_16x16x32_bf16 a[96:99], a[176:179], v[176:179], a[96:99]
  v_add_f32 v227, v227, v219
  v_cvt_pk_bf16_f32 v189, v218, v219
  v_mfma_f32_16x16x32_bf16 a[100:103], a[176:179], v[180:183], a[100:103]
  v_exp_f32 v223, v159
  v_mfma_f32_16x16x32_bf16 a[104:107], a[180:183], v[176:179], a[104:107]
  buffer_load_dwordx4 v[196:199], v2, s[40:43], s14 offen offset:1024 sc1
  v_add_f32 v227, v227, v220
  v_mfma_f32_16x16x32_bf16 a[108:111], a[180:183], v[180:183], a[108:111]
  v_add_f32 v227, v227, v221
  v_cvt_pk_bf16_f32 v190, v220, v221
  v_add_f32 v227, v227, v222
  v_mfma_f32_16x16x32_bf16 a[112:115], a[184:187], v[176:179], a[112:115]
  v_add_f32 v227, v227, v223
  v_max_f32 v5, v226, v227
  v_cmp_lt_f32 vcc, s81, v5
  v_mfma_f32_16x16x32_bf16 a[116:119], a[184:187], v[180:183], a[116:119]
  v_exp_f32 v216, v128
  v_mfma_f32_16x16x32_bf16 a[120:123], a[188:191], v[176:179], a[120:123]
  v_cvt_pk_bf16_f32 v191, v222, v223
  v_mfma_f32_16x16x32_bf16 a[124:127], a[188:191], v[180:183], a[124:127]
  s_cbranch_vccnz fa_stub28
fa_back28:
  v_exp_f32 v217, v129
  v_add_f32 v230, v230, v226
  v_add_f32 v231, v231, v227
  ds_read_b128 a[160:163], v3 offset:24576
  ds_read_b128 a[164:167], v3 offset:25600
  ds_read_b128 a[168:171], v3 offset:26624
  ds_read_b128 a[172:175], v3 offset:27648
  ds_read_b128 a[176:179], v3 offset:28672
  ds_read_b128 a[180:183], v3 offset:29696
  ds_read_b128 a[184:187], v3 offset:30720
  ds_read_b128 a[188:191], v3 offset:31744
  v_cndmask_b32 v128, v4, v128, s[68:69]
  v_cndmask_b32 v129, v4, v129, s[70:71]
  v_cndmask_b32 v130, v4, v130, s[72:73]
  v_cndmask_b32 v131, v4, v131, s[74:75]
  v_mov_b32 v132, v4
  v_mov_b32 v133, v4
  v_mov_b32 v134, v4
  v_mov_b32 v135, v4
  v_cndmask_b32 v140, v4, v140, s[68:69]
  v_cndmask_b32 v141, v4, v141, s[70:71]
  v_cndmask_b32 v142, v4, v142, s[72:73]
  v_cndmask_b32 v143, v4, v143, s[74:75]
  v_exp_f32 v216, v128
  v_exp_f32 v217, v129
  v_exp_f32 v218, v130
  v_add_f32 v226, v216, v217
  v_cvt_pk_bf16_f32 v176, v216, v217
  v_add_f32 v226, v226, v218
  v_exp_f32 v219, v131
  v_exp_f32 v220, v132
  v_add_f32 v226, v226, v219
  v_cvt_pk_bf16_f32 v177, v218, v219
  v_add_f32 v226, v226, v220
  v_exp_f32 v221, v133
  s_waitcnt lgkmcnt(4)
  v_mfma_f32_16x16x32_bf16 a[64:67], a[160:163], v[184:187], a[64:67]
  v_exp_f32 v222, v134
  v_add_f32 v226, v226, v221
  v_mfma_f32_16x16x32_bf16 a[68:71], a[160:163], v[188:191], a[68:71]
  s_add_u32 s14, s13, 53248
  buffer_load_dwordx4 v[208:211], v2, s[40:43], s14 offen offset:2048 sc1
  v_exp_f32 v223, v135
  v_mfma_f32_16x16x32_bf16 a[72:75], a[164:167], v[184:187], a[72:75]
  s_add_u32 s66, s66, 32768
  v_exp_f32 v216, v136
  v_mfma_f32_16x16x32_bf16 a[76:79], a[164:167], v[188:191], a[76:79]
  s_and_b32 s66, s66, 0x1ffff
  v_exp_f32 v217, v137
  v_mfma_f32_16x16x32_bf16 a[80:83], a[168:171], v[184:187], a[80:83]
  buffer_load_dwordx4 v[212:215], v2, s[40:43], s14 offen offset:3072 sc1
  v_cvt_pk_bf16_f32 v178, v220, v221
  v_add_f32 v226, v226, v222
  v_add_f32 v226, v226, v223
  v_cvt_pk_bf16_f32 v179, v222, v223
  v_mfma_f32_16x16x32_bf16 a[84:87], a[168:171], v[188:191], a[84:87]
  v_exp_f32 v218, v138
  v_mfma_f32_16x16x32_bf16 a[88:91], a[172:175], v[184:187], a[88:91]
  v_exp_f32 v219, v139
  v_mfma_f32_16x16x32_bf16 a[92:95], a[172:175], v[188:191], a[92:95]
  s_waitcnt lgkmcnt(0)
  v_exp_f32 v220, v140
  v_mfma_f32_16x16x32_bf16 a[96:99], a[176:179], v[184:187], a[96:99]
  s_add_u32 s14, s13, 57344
  buffer_load_dwordx4 v[232:235], v2, s[40:43], s14 offen offset:0 sc1
  v_add_f32 v227, v216, v217
  v_cvt_pk_bf16_f32 v180, v216, v217
  v_add_f32 v227, v227, v218
  v_add_f32 v227, v227, v219
  v_cvt_pk_bf16_f32 v181, v218, v219
  v_exp_f32 v221, v141
  v_mfma_f32_16x16x32_bf16 a[100:103], a[176:179], v[188:191], a[100:103]
  v_exp_f32 v222, v142
  v_mfma_f32_16x16x32_bf16 a[104:107], a[180:183], v[184:187], a[104:107]
  v_exp_f32 v223, v143
  v_mfma_f32_16x16x32_bf16 a[108:111], a[180:183], v[188:191], a[108:111]
  buffer_load_dwordx4 v[236:239], v2, s[40:43], s14 offen offset:1024 sc1
  v_add_f32 v227, v227, v220
  v_add_f32 v227, v227, v221
  v_cvt_pk_bf16_f32 v182, v220, v221
  v_add_f32 v227, v227, v222
  v_mfma_f32_16x16x32_bf16 a[112:115], a[184:187], v[184:187], a[112:115]
  v_add_f32 v227, v227, v223
  v_max_f32 v5, v226, v227
  v_cmp_lt_f32 vcc, s81, v5
  v_mfma_f32_16x16x32_bf16 a[116:119], a[184:187], v[188:191], a[116:119]
  v_mfma_f32_16x16x32_bf16 a[120:123], a[188:191], v[184:187], a[120:123]
  v_cvt_pk_bf16_f32 v183, v222, v223
  v_add_u32 v3, s66, v2
  v_mfma_f32_16x16x32_bf16 a[124:127], a[188:191], v[188:191], a[124:127]
  s_cbranch_vccnz fa_stub29
fa_back29:
  v_add_f32 v230, v230, v226
  v_add_f32 v231, v231, v227
  s_cmp_ge_u32 s20, 2
  s_cbranch_scc1 fa_nb0
  s_waitcnt vmcnt(10)
  s_barrier
fa_nb0:
  ds_read_b128 a[160:163], v3 offset:16384
  ds_read_b128 a[164:167], v3 offset:17408
  ds_read_b128 a[168:171], v3 offset:18432
  ds_read_b128 a[172:175], v3 offset:19456
  ds_read_b128 a[176:179], v3 offset:20480
  ds_read_b128 a[180:183], v3 offset:21504
  ds_read_b128 a[184:187], v3 offset:22528
  ds_read_b128 a[188:191], v3 offset:23552
  s_waitcnt lgkmcnt(4)
  v_mfma_f32_16x16x32_bf16 a[64:67], a[160:163], v[176:179], a[64:67]
  v_mfma_f32_16x16x32_bf16 a[68:71], a[160:163], v[180:183], a[68:71]
  s_add_u32 s14, s13, 57344
  buffer_load_dwordx4 v[240:243], v2, s[40:43], s14 offen offset:2048 sc1
  v_mfma_f32_16x16x32_bf16 a[72:75], a[164:167], v[176:179], a[72:75]
  v_mfma_f32_16x16x32_bf16 a[76:79], a[164:167], v[180:183], a[76:79]
  v_mfma_f32_16x16x32_bf16 a[80:83], a[168:171], v[176:179], a[80:83]
  v_mfma_f32_16x16x32_bf16 a[84:87], a[168:171], v[180:183], a[84:87]
  v_mfma_f32_16x16x32_bf16 a[88:91], a[172:175], v[176:179], a[88:91]
  v_mfma_f32_16x16x32_bf16 a[92:95], a[172:175], v[180:183], a[92:95]
  s_waitcnt lgkmcnt(0)
  v_mfma_f32_16x16x32_bf16 a[96:99], a[176:179], v[176:179], a[96:99]
  buffer_load_dwordx4 v[244:247], v2, s[40:43], s14 offen offset:3072 sc1
  v_mfma_f32_16x16x32_bf16 a[100:103], a[176:179], v[180:183], a[100:103]
  v_mfma_f32_16x16x32_bf16 a[104:107], a[180:183], v[176:179], a[104:107]
  v_mfma_f32_16x16x32_bf16 a[108:111], a[180:183], v[180:183], a[108:111]
  v_mfma_f32_16x16x32_bf16 a[112:115], a[184:187], v[176:179], a[112:115]
  v_mfma_f32_16x16x32_bf16 a[116:119], a[184:187], v[180:183], a[116:119]
  v_mfma_f32_16x16x32_bf16 a[120:123], a[188:191], v[176:179], a[120:123]
  v_mfma_f32_16x16x32_bf16 a[124:127], a[188:191], v[180:183], a[124:127]
  s_branch fa_Bdone
fa_Bodd:
  s_cmp_ge_u32 s20, 2
  s_cbranch_scc1 fa_nb1
  s_waitcnt vmcnt(8)
  s_barrier
fa_nb1:
  ds_read_b128 a[160:163], v3 offset:16384
  ds_read_b128 a[164:167], v3 offset:17408
  ds_read_b128 a[168:171], v3 offset:18432
  ds_read_b128 a[172:175], v3 offset:19456
  ds_read_b128 a[176:179], v3 offset:20480
  ds_read_b128 a[180:183], v3 offset:21504
  ds_read_b128 a[184:187], v3 offset:22528
  ds_read_b128 a[188:191], v3 offset:23552
  v_cndmask_b32 v144, v4, v144, s[68:69]
  v_cndmask_b32 v145, v4, v145, s[70:71]
  v_cndmask_b32 v146, v4, v146, s[72:73]
  v_cndmask_b32 v147, v4, v147, s[74:75]
  v_mov_b32 v148, v4
  v_mov_b32 v149, v4
  v_mov_b32 v150, v4
  v_mov_b32 v151, v4
  v_cndmask_b32 v156, v4, v156, s[68:69]
  v_cndmask_b32 v157, v4, v157, s[70:71]
  v_cndmask_b32 v158, v4, v158, s[72:73]
  v_cndmask_b32 v159, v4, v159, s[74:75]
  v_exp_f32 v216, v144
  v_exp_f32 v217, v145
  v_exp_f32 v218, v146
  v_add_f32 v226, v216, v217
  v_cvt_pk_bf16_f32 v184, v216, v217
  v_add_f32 v226, v226, v218
  v_exp_f32 v219, v147
  v_exp_f32 v220, v148
  v_add_f32 v226, v226, v219
  v_cvt_pk_bf16_f32 v185, v218, v219
  v_add_f32 v226, v226, v220
  v_exp_f32 v221, v149
  s_waitcnt lgkmcnt(4)
  v_mfma_f32_16x16x32_bf16 a[64:67], a[160:163], v[176:179], a[64:67]
  v_exp_f32 v222, v150
  v_add_f32 v226, v226, v221
  v_mfma_f32_16x16x32_bf16 a[68:71], a[160:163], v[180:183], a[68:71]
  s_add_u32 s14, s13, 49152
  buffer_load_dwordx4 v[160:163], v2, s[40:43], s14 offen offset:0 sc1
  v_exp_f32 v223, v151
  v_mfma_f32_16x16x32_bf16 a[72:75], a[164:167], v[176:179], a[72:75]
  v_exp_f32 v216, v152
  v_cvt_pk_bf16_f32 v186, v220, v221
  v_add_f32 v226, v226, v222
  v_mfma_f32_16x16x32_bf16 a[76:79], a[164:167], v[180:183], a[76:79]
  buffer_load_dwordx4 v[164:167], v2, s[40:43], s14 offen offset:1024 sc1
  v_exp_f32 v217, v153
  v_mfma_f32_16x16x32_bf16 a[80:83], a[168:171], v[176:179], a[80:83]
  v_exp_f32 v218, v154
  v_add_f32 v226, v226, v223
  v_mfma_f32_16x16x32_bf16 a[84:87], a[168:171], v[180:183], a[84:87]
  buffer_load_dwordx4 v[168:171], v2, s[40:43], s14 offen offset:2048 sc1
  v_exp_f32 v219, v155
  v_cvt_pk_bf16_f32 v187, v222, v223
  v_mfma_f32_16x16x32_bf16 a[88:91], a[172:175], v[176:179], a[88:91]
  v_exp_f32 v220, v156
  v_mfma_f32_16x16x32_bf16 a[92:95], a[172:175], v[180:183], a[92:95]
  s_waitcnt lgkmcnt(0)
  buffer_load_dwordx4 v[172:175], v2, s[40:43], s14 offen offset:3072 sc1
  v_add_f32 v227, v216, v217
  v_cvt_pk_bf16_f32 v188, v216, v217
  v_add_f32 v227, v227, v218
  v_mfma_f32_16x16x32_bf16 a[96:99], a[176:179], v[176:179], a[96:99]
  v_exp_f32 v221, v157
  v_mfma_f32_16x16x32_bf16 a[100:103], a[176:179], v[180:183], a[100:103]
  s_add_u32 s14, s13, 53248
  buffer_load_dwordx4 v[192:195], v2, s[40:43], s14 offen offset:0 sc1
  v_exp_f32 v222, v158
  v_mfma_f32_16x16x32_bf16 a[104:107], a[180:183], v[176:179], a[104:107]
  v_exp_f32 v223, v159
  v_mfma_f32_16x16x32_bf16 a[108:111], a[180:183], v[180:183], a[108:111]
  buffer_load_dwordx4 v[196:199], v2, s[40:43], s14 offen offset:1024 sc1
  v_add_f32 v227, v227, v219
  v_cvt_pk_bf16_f32 v189, v218, v219
  v_add_f32 v227, v227, v220
  v_add_f32 v227, v227, v221
  v_cvt_pk_bf16_f32 v190, v220, v221
  v_add_f32 v227, v227, v222
  v_mfma_f32_16x16x32_bf16 a[112:115], a[184:187], v[176:179], a[112:115]
  v_add_f32 v227, v227, v223
  v_max_f32 v5, v226, v227
  v_cmp_lt_f32 vcc, s81, v5
  v_mfma_f32_16x16x32_bf16 a[116:119], a[184:187], v[180:183], a[116:119]
  buffer_load_dwordx4 v[208:211], v2, s[40:43], s14 offen offset:2048 sc1
  v_mfma_f32_16x16x32_bf16 a[120:123], a[188:191], v[176:179], a[120:123]
  v_cvt_pk_bf16_f32 v191, v222, v223
  v_mfma_f32_16x16x32_bf16 a[124:127], a[188:191], v[180:183], a[124:127]
  s_cbranch_vccnz fa_stub30
fa_back30:
  v_add_f32 v230, v230, v226
  v_add_f32 v231, v231, v227
  ds_read_b128 a[160:163], v3 offset:24576
  ds_read_b128 a[164:167], v3 offset:25600
  ds_read_b128 a[168:171], v3 offset:26624
  ds_read_b128 a[172:175], v3 offset:27648
  ds_read_b128 a[176:179], v3 offset:28672
  ds_read_b128 a[180:183], v3 offset:29696
  ds_read_b128 a[184:187], v3 offset:30720
  ds_read_b128 a[188:191], v3 offset:31744
  s_waitcnt lgkmcnt(4)
  v_mfma_f32_16x16x32_bf16 a[64:67], a[160:163], v[184:187], a[64:67]
  v_mfma_f32_16x16x32_bf16 a[68:71], a[160:163], v[188:191], a[68:71]
  s_add_u32 s14, s13, 53248
  buffer_load_dwordx4 v[212:215], v2, s[40:43], s14 offen offset:3072 sc1
  v_mfma_f32_16x16x32_bf16 a[72:75], a[164:167], v[184:187], a[72:75]
  s_add_u32 s66, s66, 32768
  v_mfma_f32_16x16x32_bf16 a[76:79], a[164:167], v[188:191], a[76:79]
  s_add_u32 s14, s13, 57344
  buffer_load_dwordx4 v[232:235], v2, s[40:43], s14 offen offset:0 sc1
  v_mfma_f32_16x16x32_bf16 a[80:83], a[168:171], v[184:187], a[80:83]
  s_and_b32 s66, s66, 0x1ffff
  v_mfma_f32_16x16x32_bf16 a[84:87], a[168:171], v[188:191], a[84:87]
  v_mfma_f32_16x16x32_bf16 a[88:91], a[172:175], v[184:187], a[88:91]
  buffer_load_dwordx4 v[236:239], v2, s[40:43], s14 offen offset:1024 sc1
  v_mfma_f32_16x16x32_bf16 a[92:95], a[172:175], v[188:191], a[92:95]
  s_waitcnt lgkmcnt(0)
  v_mfma_f32_16x16x32_bf16 a[96:99], a[176:179], v[184:187], a[96:99]
  v_mfma_f32_16x16x32_bf16 a[100:103], a[176:179], v[188:191], a[100:103]
  buffer_load_dwordx4 v[240:243], v2, s[40:43], s14 offen offset:2048 sc1
  v_mfma_f32_16x16x32_bf16 a[104:107], a[180:183], v[184:187], a[104:107]
  v_mfma_f32_16x16x32_bf16 a[108:111], a[180:183], v[188:191], a[108:111]
  v_mfma_f32_16x16x32_bf16 a[112:115], a[184:187], v[184:187], a[112:115]
  buffer_load_dwordx4 v[244:247], v2, s[40:43], s14 offen offset:3072 sc1
  v_mfma_f32_16x16x32_bf16 a[116:119], a[184:187], v[188:191], a[116:119]
  v_mfma_f32_16x16x32_bf16 a[120:123], a[188:191], v[184:187], a[120:123]
  v_add_u32 v3, s66, v2
  v_mfma_f32_16x16x32_bf16 a[124:127], a[188:191], v[188:191], a[124:127]
fa_Bdone:
fa_epi:
  v_mov_b32 v20, v230
  v_mov_b32 v21, v231
  s_nop 1
  v_permlane16_swap_b32 v230, v20
  v_permlane16_swap_b32 v231, v21
  v_add_f32 v230, v230, v20
  v_add_f32 v231, v231, v21
  v_mov_b32 v20, v230
  v_mov_b32 v21, v231
  s_nop 1
  v_permlane32_swap_b32 v230, v20
  v_permlane32_swap_b32 v231, v21
  v_add_f32 v230, v230, v20
  v_add_f32 v231, v231, v21
  v_rcp_f32 v16, v230
  v_rcp_f32 v18, v231
  s_sub_u32 s23, 15, s22
  s_lshl_b32 s23, s23, 2
  v_mov_b32 v17, v16
  v_mov_b32 v19, v18
  s_add_u32 s23, s23, s20
  s_lshl_b32 s23, s23, 18
  s_lshl_b32 s31, s21, 12
  s_add_u32 s31, s31, 50331648
  s_add_u32 s64, s23, s31
  s_add_u32 s65, s64, 131072
  v_accvgpr_read_b32 v68, a64
  v_accvgpr_read_b32 v69, a65
  v_accvgpr_read_b32 v70, a66
  v_accvgpr_read_b32 v71, a67
  v_accvgpr_read_b32 v72, a72
  v_accvgpr_read_b32 v73, a73
  v_accvgpr_read_b32 v74, a74
  v_accvgpr_read_b32 v75, a75
  v_pk_mul_f32 v[68:69], v[68:69], v[16:17]
  v_pk_mul_f32 v[70:71], v[70:71], v[16:17]
  v_pk_mul_f32 v[72:73], v[72:73], v[16:17]
  v_pk_mul_f32 v[74:75], v[74:75], v[16:17]
  v_cvt_pk_bf16_f32 v64, v68, v69
  v_cvt_pk_bf16_f32 v65, v70, v71
  v_cvt_pk_bf16_f32 v66, v72, v73
  v_cvt_pk_bf16_f32 v67, v74, v75
  buffer_store_dwordx4 v[64:67], v2, s[40:43], s64 offen offset:0 sc1
  v_accvgpr_read_b32 v80, a80
  v_accvgpr_read_b32 v81, a81
  v_accvgpr_read_b32 v82, a82
  v_accvgpr_read_b32 v83, a83
  v_accvgpr_read_b32 v84, a88
  v_accvgpr_read_b32 v85, a89
  v_accvgpr_read_b32 v86, a90
  v_accvgpr_read_b32 v87, a91
  v_pk_mul_f32 v[80:81], v[80:81], v[16:17]
  v_pk_mul_f32 v[82:83], v[82:83], v[16:17]
  v_pk_mul_f32 v[84:85], v[84:85], v[16:17]
  v_pk_mul_f32 v[86:87], v[86:87], v[16:17]
  v_cvt_pk_bf16_f32 v76, v80, v81
  v_cvt_pk_bf16_f32 v77, v82, v83
  v_cvt_pk_bf16_f32 v78, v84, v85
  v_cvt_pk_bf16_f32 v79, v86, v87
  buffer_store_dwordx4 v[76:79], v2, s[40:43], s64 offen offset:1024 sc1
  v_accvgpr_read_b32 v132, a96
  v_accvgpr_read_b32 v133, a97
  v_accvgpr_read_b32 v134, a98
  v_accvgpr_read_b32 v135, a99
  v_accvgpr_read_b32 v136, a104
  v_accvgpr_read_b32 v137, a105
  v_accvgpr_read_b32 v138, a106
  v_accvgpr_read_b32 v139, a107
  v_pk_mul_f32 v[132:133], v[132:133], v[16:17]
  v_pk_mul_f32 v[134:135], v[134:135], v[16:17]
  v_pk_mul_f32 v[136:137], v[136:137], v[16:17]
  v_pk_mul_f32 v[138:139], v[138:139], v[16:17]
  v_cvt_pk_bf16_f32 v128, v132, v133
  v_cvt_pk_bf16_f32 v129, v134, v135
  v_cvt_pk_bf16_f32 v130, v136, v137
  v_cvt_pk_bf16_f32 v131, v138, v139
  buffer_store_dwordx4 v[128:131], v2, s[40:43], s64 offen offset:2048 sc1
  v_accvgpr_read_b32 v144, a112
  v_accvgpr_read_b32 v145, a113
  v_accvgpr_read_b32 v146, a114
  v_accvgpr_read_b32 v147, a115
  v_accvgpr_read_b32 v148, a120
  v_accvgpr_read_b32 v149, a121
  v_accvgpr_read_b32 v150, a122
  v_accvgpr_read_b32 v151, a123
  v_pk_mul_f32 v[144:145], v[144:145], v[16:17]
  v_pk_mul_f32 v[146:147], v[146:147], v[16:17]
  v_pk_mul_f32 v[148:149], v[148:149], v[16:17]
  v_pk_mul_f32 v[150:151], v[150:151], v[16:17]
  v_cvt_pk_bf16_f32 v140, v144, v145
  v_cvt_pk_bf16_f32 v141, v146, v147
  v_cvt_pk_bf16_f32 v142, v148, v149
  v_cvt_pk_bf16_f32 v143, v150, v151
  buffer_store_dwordx4 v[140:143], v2, s[40:43], s64 offen offset:3072 sc1
  v_accvgpr_read_b32 v68, a68
  v_accvgpr_read_b32 v69, a69
  v_accvgpr_read_b32 v70, a70
  v_accvgpr_read_b32 v71, a71
  v_accvgpr_read_b32 v72, a76
  v_accvgpr_read_b32 v73, a77
  v_accvgpr_read_b32 v74, a78
  v_accvgpr_read_b32 v75, a79
  v_pk_mul_f32 v[68:69], v[68:69], v[18:19]
  v_pk_mul_f32 v[70:71], v[70:71], v[18:19]
  v_pk_mul_f32 v[72:73], v[72:73], v[18:19]
  v_pk_mul_f32 v[74:75], v[74:75], v[18:19]
  v_cvt_pk_bf16_f32 v64, v68, v69
  v_cvt_pk_bf16_f32 v65, v70, v71
  v_cvt_pk_bf16_f32 v66, v72, v73
  v_cvt_pk_bf16_f32 v67, v74, v75
  buffer_store_dwordx4 v[64:67], v2, s[40:43], s65 offen offset:0 sc1
  v_accvgpr_read_b32 v80, a84
  v_accvgpr_read_b32 v81, a85
  v_accvgpr_read_b32 v82, a86
  v_accvgpr_read_b32 v83, a87
  v_accvgpr_read_b32 v84, a92
  v_accvgpr_read_b32 v85, a93
  v_accvgpr_read_b32 v86, a94
  v_accvgpr_read_b32 v87, a95
  v_pk_mul_f32 v[80:81], v[80:81], v[18:19]
  v_pk_mul_f32 v[82:83], v[82:83], v[18:19]
  v_pk_mul_f32 v[84:85], v[84:85], v[18:19]
  v_pk_mul_f32 v[86:87], v[86:87], v[18:19]
  v_cvt_pk_bf16_f32 v76, v80, v81
  v_cvt_pk_bf16_f32 v77, v82, v83
  v_cvt_pk_bf16_f32 v78, v84, v85
  v_cvt_pk_bf16_f32 v79, v86, v87
  buffer_store_dwordx4 v[76:79], v2, s[40:43], s65 offen offset:1024 sc1
  v_accvgpr_read_b32 v132, a100
  v_accvgpr_read_b32 v133, a101
  v_accvgpr_read_b32 v134, a102
  v_accvgpr_read_b32 v135, a103
  v_accvgpr_read_b32 v136, a108
  v_accvgpr_read_b32 v137, a109
  v_accvgpr_read_b32 v138, a110
  v_accvgpr_read_b32 v139, a111
  v_pk_mul_f32 v[132:133], v[132:133], v[18:19]
  v_pk_mul_f32 v[134:135], v[134:135], v[18:19]
  v_pk_mul_f32 v[136:137], v[136:137], v[18:19]
  v_pk_mul_f32 v[138:139], v[138:139], v[18:19]
  v_cvt_pk_bf16_f32 v128, v132, v133
  v_cvt_pk_bf16_f32 v129, v134, v135
  v_cvt_pk_bf16_f32 v130, v136, v137
  v_cvt_pk_bf16_f32 v131, v138, v139
  buffer_store_dwordx4 v[128:131], v2, s[40:43], s65 offen offset:2048 sc1
  v_accvgpr_read_b32 v144, a116
  v_accvgpr_read_b32 v145, a117
  v_accvgpr_read_b32 v146, a118
  v_accvgpr_read_b32 v147, a119
  v_accvgpr_read_b32 v148, a124
  v_accvgpr_read_b32 v149, a125
  v_accvgpr_read_b32 v150, a126
  v_accvgpr_read_b32 v151, a127
  v_pk_mul_f32 v[144:145], v[144:145], v[18:19]
  v_pk_mul_f32 v[146:147], v[146:147], v[18:19]
  v_pk_mul_f32 v[148:149], v[148:149], v[18:19]
  v_pk_mul_f32 v[150:151], v[150:151], v[18:19]
  v_cvt_pk_bf16_f32 v140, v144, v145
  v_cvt_pk_bf16_f32 v141, v146, v147
  v_cvt_pk_bf16_f32 v142, v148, v149
  v_cvt_pk_bf16_f32 v143, v150, v151
  buffer_store_dwordx4 v[140:143], v2, s[40:43], s65 offen offset:3072 sc1
  s_load_dwordx2 s[8:9], s[0:1], 0
  s_load_dwordx2 s[16:17], s[0:1], 88
  v_mov_b32 v30, 1073741824
  v_writelane_b32 v30, s80, 0
  v_writelane_b32 v30, s3, 1
  s_cmp_lt_u32 s12, 3
  s_cbranch_scc1 fa_puby
  s_add_u32 s14, s13, 61440
  buffer_load_dwordx4 v[64:67], v2, s[40:43], s14 offen offset:0 sc1
  buffer_load_dwordx4 v[68:71], v2, s[40:43], s14 offen offset:1024 sc1
  buffer_load_dwordx4 v[72:75], v2, s[40:43], s14 offen offset:2048 sc1
  buffer_load_dwordx4 v[76:79], v2, s[40:43], s14 offen offset:3072 sc1
  s_waitcnt vmcnt(4)
  buffer_store_dword v4, v30, s[40:43], 0 offen sc1
fa_pubb:
  s_setprio 0
  s_cmp_lt_u32 s29, 8
  s_cbranch_scc1 fa_left
fa_leftb:
  s_add_u32 s14, s13, 65536
  buffer_load_dwordx4 v[80:83], v2, s[40:43], s14 offen offset:0 sc1
  buffer_load_dwordx4 v[84:87], v2, s[40:43], s14 offen offset:1024 sc1
  buffer_load_dwordx4 v[88:91], v2, s[40:43], s14 offen offset:2048 sc1
  buffer_load_dwordx4 v[92:95], v2, s[40:43], s14 offen offset:3072 sc1
  s_add_u32 s14, s13, 69632
  buffer_load_dwordx4 v[128:131], v2, s[40:43], s14 offen offset:0 sc1
  buffer_load_dwordx4 v[132:135], v2, s[40:43], s14 offen offset:1024 sc1
  buffer_load_dwordx4 v[136:139], v2, s[40:43], s14 offen offset:2048 sc1
  buffer_load_dwordx4 v[140:143], v2, s[40:43], s14 offen offset:3072 sc1
  s_add_u32 s14, s13, 73728
  buffer_load_dwordx4 v[144:147], v2, s[40:43], s14 offen offset:0 sc1
  buffer_load_dwordx4 v[148:151], v2, s[40:43], s14 offen offset:1024 sc1
  s_lshl_b32 s63, s21, 19
  s_lshl_b32 s23, s20, 15
  s_add_u32 s63, s63, s23
  s_add_u32 s63, s63, 50331648
  s_mul_i32 s62, s22, 0
  s_and_b32 s62, s62, 0x7fff
  s_add_u32 s64, s63, s62
  s_add_u32 s65, s64, 131072
  s_add_u32 s66, s64, 262144
  s_add_u32 s67, s64, 393216
  v_bfe_u32 v12, v1, 3, 1
  v_mul_u32_u24 v12, 4352, v12
  v_and_b32 v13, 7, v1
  v_lshl_add_u32 v12, v13, 2, v12
  s_mul_i32 s23, s21, 8704
  s_lshl_b32 s31, s20, 5
  s_add_u32 s23, s23, s31
  s_add_u32 s23, s23, 3801088
  v_add_u32 v12, s23, v12
  v_mov_b32 v20, 0
  v_mov_b32 v21, 0
  v_mov_b32 v22, 0
  v_mov_b32 v23, 0
  v_add_u32 v16, 158208, v2
  ds_write_b128 v16, v[20:23]
  buffer_load_dwordx4 v[152:155], v2, s[40:43], s14 offen offset:2048 sc1
  buffer_load_dwordx4 v[156:159], v2, s[40:43], s14 offen offset:3072 sc1
  s_add_u32 s14, s13, 77824
  buffer_load_dwordx4 v[176:179], v2, s[40:43], s14 offen offset:0 sc1
  buffer_load_dwordx4 v[180:183], v2, s[40:43], s14 offen offset:1024 sc1
  buffer_load_dwordx4 v[184:187], v2, s[40:43], s14 offen offset:2048 sc1
  buffer_load_dwordx4 v[188:191], v2, s[40:43], s14 offen offset:3072 sc1
  s_lshl_b32 s34, s28, 1
  s_and_b32 s23, s20, 1
  s_lshl_b32 s23, s23, 12
  s_cmp_lt_u32 s20, 2
  s_cselect_b32 s33, 106496, 0
  s_add_u32 s33, s33, s23
  s_add_u32 s33, s33, s34
  s_and_b32 s33, s33, 0x1ffff
  s_lshl_b32 s23, s20, 12
  s_add_u32 s34, s34, 49152
  s_add_u32 s34, s34, s23
  s_and_b32 s34, s34, 0x1ffff
  s_add_u32 s23, s23, s28
  s_cmp_lt_u32 s29, 3
  s_cselect_b32 s26, s23, s26
  s_cselect_b32 s27, s23, s27
  s_cselect_b32 s24, s33, s24
  s_cselect_b32 s25, s34, s25
  s_mov_b64 s[44:45], s[4:5]
  s_mov_b64 s[48:49], s[6:7]
  s_mov_b32 s46, s30
  s_mov_b32 s50, s30
  s_add_u32 s23, s28, 49152
fa_pk:
  s_cmp_ge_u32 s26, s23
  s_cbranch_scc1 fa_pkd
  s_mov_b32 m0, s24
  s_add_u32 s24, s24, 32768
  s_and_b32 s24, s24, 0x1ffff
  buffer_load_dwordx4 v2, s[44:47], s26 offen offset:0 sc1 lds
  buffer_load_dwordx4 v2, s[44:47], s26 offen offset:1024 sc1 lds
  buffer_load_dwordx4 v2, s[44:47], s26 offen offset:2048 sc1 lds
  buffer_load_dwordx4 v2, s[44:47], s26 offen offset:3072 sc1 lds
  s_add_u32 s26, s26, 16384
  s_branch fa_pk
fa_pkd:
  s_add_u32 s23, s28, 32768
fa_pv:
  s_cmp_ge_u32 s27, s23
  s_cbranch_scc1 fa_pvd
  s_mov_b32 m0, s25
  s_add_u32 s25, s25, 32768
  s_and_b32 s25, s25, 0x1ffff
  buffer_load_dwordx4 v2, s[48:51], s27 offen offset:0 sc1 lds
  buffer_load_dwordx4 v2, s[48:51], s27 offen offset:1024 sc1 lds
  buffer_load_dwordx4 v2, s[48:51], s27 offen offset:2048 sc1 lds
  buffer_load_dwordx4 v2, s[48:51], s27 offen offset:3072 sc1 lds
  s_add_u32 s27, s27, 16384
  s_branch fa_pv
fa_pvd:
  s_lshl_b32 s35, s20, 12
  s_add_u32 s35, s35, 131072
  s_mov_b32 m0, s35
  s_add_u32 s14, s13, 155648
  buffer_load_dwordx4 v2, s[40:43], s14 offen offset:0 sc1 lds
  buffer_load_dwordx4 v2, s[40:43], s14 offen offset:1024 sc1 lds
  buffer_load_dwordx4 v2, s[40:43], s14 offen offset:2048 sc1 lds
  buffer_load_dwordx4 v2, s[40:43], s14 offen offset:3072 sc1 lds
  s_waitcnt lgkmcnt(0)
  s_barrier
  s_mov_b32 m0, s24
  s_add_u32 s24, s24, 32768
  s_and_b32 s24, s24, 0x1ffff
  buffer_load_dwordx4 v2, s[44:47], s26 offen offset:0 sc1 lds
  buffer_load_dwordx4 v2, s[44:47], s26 offen offset:1024 sc1 lds
  buffer_load_dwordx4 v2, s[44:47], s26 offen offset:2048 sc1 lds
  buffer_load_dwordx4 v2, s[44:47], s26 offen offset:3072 sc1 lds
  s_add_u32 s26, s26, 16384
  buffer_load_dword v13, v12, s[40:43], 0 offen sc1
  s_mov_b32 m0, s25
  s_add_u32 s25, s25, 32768
  s_and_b32 s25, s25, 0x1ffff
  buffer_load_dwordx4 v2, s[48:51], s27 offen offset:0 sc1 lds
  buffer_load_dwordx4 v2, s[48:51], s27 offen offset:1024 sc1 lds
  buffer_load_dwordx4 v2, s[48:51], s27 offen offset:2048 sc1 lds
  buffer_load_dwordx4 v2, s[48:51], s27 offen offset:3072 sc1 lds
  s_add_u32 s27, s27, 16384
  s_mov_b32 m0, s25
  s_add_u32 s25, s25, 32768
  s_and_b32 s25, s25, 0x1ffff
  buffer_load_dwordx4 v2, s[48:51], s27 offen offset:0 sc1 lds
  buffer_load_dwordx4 v2, s[48:51], s27 offen offset:1024 sc1 lds
  buffer_load_dwordx4 v2, s[48:51], s27 offen offset:2048 sc1 lds
  buffer_load_dwordx4 v2, s[48:51], s27 offen offset:3072 sc1 lds
  s_add_u32 s27, s27, 16384
  s_mov_b32 s44, s8
  s_mov_b32 s45, s9
  s_mov_b32 s46, 2621440
  s_mov_b32 s47, 0x20000
  s_mov_b32 s48, s16
  s_mov_b32 s49, s17
  s_mov_b32 s50, 2621440
  s_mov_b32 s51, 0x20000
  s_lshl_b32 s25, s21, 6
  s_mul_i32 s26, s22, 160
  s_mul_i32 s27, s22, 2560
  s_waitcnt vmcnt(8)
  v_cmp_eq_u32 vcc, 0, v13
  s_cbranch_vccnz fa_ctx_spin
fa_ctx_ok:
  buffer_load_dwordx4 a[144:147], v2, s[40:43], s64 offen offset:0 sc1
  buffer_load_dwordx4 a[148:151], v2, s[40:43], s65 offen offset:0 sc1
  buffer_load_dwordx4 a[152:155], v2, s[40:43], s66 offen offset:0 sc1
  buffer_load_dwordx4 a[156:159], v2, s[40:43], s67 offen offset:0 sc1
  buffer_load_dwordx4 a[160:163], v2, s[40:43], s64 offen offset:1024 sc1
  buffer_load_dwordx4 a[164:167], v2, s[40:43], s65 offen offset:1024 sc1
  buffer_load_dwordx4 a[168:171], v2, s[40:43], s66 offen offset:1024 sc1
  buffer_load_dwordx4 a[172:175], v2, s[40:43], s67 offen offset:1024 sc1
  buffer_load_dwordx4 a[176:179], v2, s[40:43], s64 offen offset:2048 sc1
  buffer_load_dwordx4 a[180:183], v2, s[40:43], s65 offen offset:2048 sc1
  buffer_load_dwordx4 a[184:187], v2, s[40:43], s66 offen offset:2048 sc1
  buffer_load_dwordx4 a[188:191], v2, s[40:43], s67 offen offset:2048 sc1
  buffer_load_dwordx4 v[216:219], v2, s[40:43], s64 offen offset:3072 sc1
  buffer_load_dwordx4 v[220:223], v2, s[40:43], s65 offen offset:3072 sc1
  buffer_load_dwordx4 v[224:227], v2, s[40:43], s66 offen offset:3072 sc1
  buffer_load_dwordx4 v[228:231], v2, s[40:43], s67 offen offset:3072 sc1
  s_add_u32 s62, s62, 4096
  s_and_b32 s62, s62, 0x7fff
  s_add_u32 s64, s63, s62
  s_add_u32 s65, s64, 131072
  s_add_u32 s66, s64, 262144
  s_add_u32 s67, s64, 393216
  s_waitcnt vmcnt(14)
  v_mfma_f32_16x16x32_bf16 a[64:67], a[192:195], a[144:147], 0
  v_mfma_f32_16x16x32_bf16 a[80:83], a[196:199], a[144:147], 0
  v_mfma_f32_16x16x32_bf16 a[96:99], a[200:203], a[144:147], 0
  v_mfma_f32_16x16x32_bf16 a[112:115], a[204:207], a[144:147], 0
  v_mfma_f32_16x16x32_bf16 a[128:131], a[208:211], a[144:147], 0
  buffer_load_dwordx4 a[144:147], v2, s[40:43], s64 offen offset:0 sc1
  v_mfma_f32_16x16x32_bf16 a[68:71], a[192:195], a[148:151], 0
  v_mfma_f32_16x16x32_bf16 a[84:87], a[196:199], a[148:151], 0
  v_mfma_f32_16x16x32_bf16 a[100:103], a[200:203], a[148:151], 0
  v_mfma_f32_16x16x32_bf16 a[116:119], a[204:207], a[148:151], 0
  v_mfma_f32_16x16x32_bf16 a[132:135], a[208:211], a[148:151], 0
  s_waitcnt vmcnt(13)
  buffer_load_dwordx4 a[148:151], v2, s[40:43], s65 offen offset:0 sc1
  v_mfma_f32_16x16x32_bf16 a[72:75], a[192:195], a[152:155], 0
  v_mfma_f32_16x16x32_bf16 a[88:91], a[196:199], a[152:155], 0
  v_mfma_f32_16x16x32_bf16 a[104:107], a[200:203], a[152:155], 0
  v_mfma_f32_16x16x32_bf16 a[120:123], a[204:207], a[152:155], 0
  v_mfma_f32_16x16x32_bf16 a[136:139], a[208:211], a[152:155], 0
  buffer_load_dwordx4 a[152:155], v2, s[40:43], s66 offen offset:0 sc1
  v_mfma_f32_16x16x32_bf16 a[76:79], a[192:195], a[156:159], 0
  v_mfma_f32_16x16x32_bf16 a[92:95], a[196:199], a[156:159], 0
  v_mfma_f32_16x16x32_bf16 a[108:111], a[200:203], a[156:159], 0
  v_mfma_f32_16x16x32_bf16 a[124:127], a[204:207], a[156:159], 0
  v_mfma_f32_16x16x32_bf16 a[140:143], a[208:211], a[156:159], 0
  s_waitcnt vmcnt(13)
  buffer_load_dwordx4 a[156:159], v2, s[40:43], s67 offen offset:0 sc1
  v_mfma_f32_16x16x32_bf16 a[64:67], a[212:215], a[160:163], a[64:67]
  v_add_u32 v16, 0, v0
  v_mfma_f32_16x16x32_bf16 a[80:83], a[216:219], a[160:163], a[80:83]
  v_mfma_f32_16x16x32_bf16 a[96:99], a[220:223], a[160:163], a[96:99]
  s_add_u32 s14, s13, 81920
  buffer_load_dwordx4 a[192:195], v2, s[40:43], s14 offen offset:0 sc1
  v_mul_u32_u24 v17, 6554, v16
  v_mfma_f32_16x16x32_bf16 a[112:115], a[224:227], a[160:163], a[112:115]
  v_mfma_f32_16x16x32_bf16 a[128:131], a[228:231], a[160:163], a[128:131]
  buffer_load_dwordx4 a[160:163], v2, s[40:43], s64 offen offset:1024 sc1
  v_mfma_f32_16x16x32_bf16 a[68:71], a[212:215], a[164:167], a[68:71]
  v_lshrrev_b32 v17, 16, v17
  v_mfma_f32_16x16x32_bf16 a[84:87], a[216:219], a[164:167], a[84:87]
  v_mul_u32_u24 v18, 10, v17
  v_mfma_f32_16x16x32_bf16 a[100:103], a[220:223], a[164:167], a[100:103]
  v_mfma_f32_16x16x32_bf16 a[116:119], a[224:227], a[164:167], a[116:119]
  v_mfma_f32_16x16x32_bf16 a[132:135], a[228:231], a[164:167], a[132:135]
  s_waitcnt vmcnt(14)
  buffer_load_dwordx4 a[164:167], v2, s[40:43], s65 offen offset:1024 sc1
  v_sub_u32 v18, v16, v18
  v_mfma_f32_16x16x32_bf16 a[72:75], a[212:215], a[168:171], a[72:75]
  v_mfma_f32_16x16x32_bf16 a[88:91], a[216:219], a[168:171], a[88:91]
  v_mfma_f32_16x16x32_bf16 a[104:107], a[220:223], a[168:171], a[104:107]
  buffer_load_dwordx4 a[196:199], v2, s[40:43], s14 offen offset:1024 sc1
  v_mfma_f32_16x16x32_bf16 a[120:123], a[224:227], a[168:171], a[120:123]
  v_mul_u32_u24 v251, 336, v17
  v_mfma_f32_16x16x32_bf16 a[136:139], a[228:231], a[168:171], a[136:139]
  buffer_load_dwordx4 a[168:171], v2, s[40:43], s66 offen offset:1024 sc1
  v_lshl_add_u32 v251, v18, 5, v251
  v_mfma_f32_16x16x32_bf16 a[76:79], a[212:215], a[172:175], a[76:79]
  v_mfma_f32_16x16x32_bf16 a[92:95], a[216:219], a[172:175], a[92:95]
  v_mfma_f32_16x16x32_bf16 a[108:111], a[220:223], a[172:175], a[108:111]
  v_mfma_f32_16x16x32_bf16 a[124:127], a[224:227], a[172:175], a[124:127]
  v_mfma_f32_16x16x32_bf16 a[140:143], a[228:231], a[172:175], a[140:143]
  s_waitcnt vmcnt(15)
  buffer_load_dwordx4 a[172:175], v2, s[40:43], s67 offen offset:1024 sc1
  v_mfma_f32_16x16x32_bf16 a[64:67], a[232:235], a[176:179], a[64:67]
  v_lshlrev_b32 v203, 5, v18
  v_mfma_f32_16x16x32_bf16 a[80:83], a[236:239], a[176:179], a[80:83]
  v_mfma_f32_16x16x32_bf16 a[96:99], a[240:243], a[176:179], a[96:99]
  buffer_load_dwordx4 a[200:203], v2, s[40:43], s14 offen offset:2048 sc1
  v_add_u32 v17, s25, v17
  v_mfma_f32_16x16x32_bf16 a[112:115], a[244:247], a[176:179], a[112:115]
  v_mfma_f32_16x16x32_bf16 a[128:131], a[248:251], a[176:179], a[128:131]
  buffer_load_dwordx4 a[176:179], v2, s[40:43], s64 offen offset:2048 sc1
  v_mfma_f32_16x16x32_bf16 a[68:71], a[232:235], a[180:183], a[68:71]
  v_add_u32 v24, 1, v17
  v_mfma_f32_16x16x32_bf16 a[84:87], a[236:239], a[180:183], a[84:87]
  v_mul_u32_u24 v248, 1280, v17
  v_mfma_f32_16x16x32_bf16 a[100:103], a[240:243], a[180:183], a[100:103]
  v_mfma_f32_16x16x32_bf16 a[116:119], a[244:247], a[180:183], a[116:119]
  v_mfma_f32_16x16x32_bf16 a[132:135], a[248:251], a[180:183], a[132:135]
  s_waitcnt vmcnt(16)
  buffer_load_dwordx4 a[180:183], v2, s[40:43], s65 offen offset:2048 sc1
  v_lshl_add_u32 v248, v18, 4, v248
  v_mfma_f32_16x16x32_bf16 a[72:75], a[232:235], a[184:187], a[72:75]
  v_mfma_f32_16x16x32_bf16 a[88:91], a[236:239], a[184:187], a[88:91]
  v_mfma_f32_16x16x32_bf16 a[104:107], a[240:243], a[184:187], a[104:107]
  buffer_load_dwordx4 a[204:207], v2, s[40:43], s14 offen offset:3072 sc1
  v_mfma_f32_16x16x32_bf16 a[120:123], a[244:247], a[184:187], a[120:123]
  v_add_u32 v248, s26, v248
  v_mfma_f32_16x16x32_bf16 a[136:139], a[248:251], a[184:187], a[136:139]
  buffer_load_dwordx4 a[184:187], v2, s[40:43], s66 offen offset:2048 sc1
  v_lshrrev_b32 v19, 4, v17
  v_mfma_f32_16x16x32_bf16 a[76:79], a[232:235], a[188:191], a[76:79]
  v_mfma_f32_16x16x32_bf16 a[92:95], a[236:239], a[188:191], a[92:95]
  v_mfma_f32_16x16x32_bf16 a[108:111], a[240:243], a[188:191], a[108:111]
  v_mfma_f32_16x16x32_bf16 a[124:127], a[244:247], a[188:191], a[124:127]
  v_mfma_f32_16x16x32_bf16 a[140:143], a[248:251], a[188:191], a[140:143]
  s_waitcnt vmcnt(17)
  buffer_load_dwordx4 a[188:191], v2, s[40:43], s67 offen offset:2048 sc1
  v_mfma_f32_16x16x32_bf16 a[64:67], a[252:255], v[216:219], a[64:67]
  v_mul_u32_u24 v19, 20480, v19
  v_mfma_f32_16x16x32_bf16 a[80:83], a[0:3], v[216:219], a[80:83]
  v_mfma_f32_16x16x32_bf16 a[96:99], a[4:7], v[216:219], a[96:99]
  s_add_u32 s14, s13, 86016
  buffer_load_dwordx4 a[208:211], v2, s[40:43], s14 offen offset:0 sc1
  v_and_b32 v17, 15, v17
  v_mfma_f32_16x16x32_bf16 a[112:115], a[8:11], v[216:219], a[112:115]
  v_mfma_f32_16x16x32_bf16 a[128:131], a[12:15], v[216:219], a[128:131]
  buffer_load_dwordx4 v[216:219], v2, s[40:43], s64 offen offset:3072 sc1
  v_mfma_f32_16x16x32_bf16 a[68:71], a[252:255], v[220:223], a[68:71]
  v_lshl_add_u32 v19, v17, 4, v19
  v_mfma_f32_16x16x32_bf16 a[84:87], a[0:3], v[220:223], a[84:87]
  v_lshl_add_u32 v200, v18, 8, v19
  v_mfma_f32_16x16x32_bf16 a[100:103], a[4:7], v[220:223], a[100:103]
  v_mfma_f32_16x16x32_bf16 a[116:119], a[8:11], v[220:223], a[116:119]
  v_mfma_f32_16x16x32_bf16 a[132:135], a[12:15], v[220:223], a[132:135]
  s_waitcnt vmcnt(18)
  buffer_load_dwordx4 v[220:223], v2, s[40:43], s65 offen offset:3072 sc1
  v_mov_b32 v27, 8
  v_mfma_f32_16x16x32_bf16 a[72:75], a[252:255], v[224:227], a[72:75]
  v_mfma_f32_16x16x32_bf16 a[88:91], a[0:3], v[224:227], a[88:91]
  v_mfma_f32_16x16x32_bf16 a[104:107], a[4:7], v[224:227], a[104:107]
  buffer_load_dwordx4 a[212:215], v2, s[40:43], s14 offen offset:1024 sc1
  v_mfma_f32_16x16x32_bf16 a[120:123], a[8:11], v[224:227], a[120:123]
  v_add_u32 v16, 256, v0
  v_mfma_f32_16x16x32_bf16 a[136:139], a[12:15], v[224:227], a[136:139]
  buffer_load_dwordx4 v[224:227], v2, s[40:43], s66 offen offset:3072 sc1
  v_mul_u32_u24 v17, 6554, v16
  v_mfma_f32_16x16x32_bf16 a[76:79], a[252:255], v[228:231], a[76:79]
  v_mfma_f32_16x16x32_bf16 a[92:95], a[0:3], v[228:231], a[92:95]
  v_mfma_f32_16x16x32_bf16 a[108:111], a[4:7], v[228:231], a[108:111]
  v_mfma_f32_16x16x32_bf16 a[124:127], a[8:11], v[228:231], a[124:127]
  v_mfma_f32_16x16x32_bf16 a[140:143], a[12:15], v[228:231], a[140:143]
  s_waitcnt vmcnt(19)
  buffer_load_dwordx4 v[228:231], v2, s[40:43], s67 offen offset:3072 sc1
  v_mfma_f32_16x16x32_bf16 a[64:67], a[16:19], a[144:147], a[64:67]
  s_add_u32 s62, s62, 4096
  v_lshrrev_b32 v17, 16, v17
  v_mfma_f32_16x16x32_bf16 a[80:83], a[20:23], a[144:147], a[80:83]
  s_and_b32 s62, s62, 0x7fff
  v_mfma_f32_16x16x32_bf16 a[96:99], a[24:27], a[144:147], a[96:99]
  buffer_load_dwordx4 a[216:219], v2, s[40:43], s14 offen offset:2048 sc1
  v_mul_u32_u24 v18, 10, v17
  v_mfma_f32_16x16x32_bf16 a[112:115], a[28:31], a[144:147], a[112:115]
  s_add_u32 s64, s63, s62
  v_mfma_f32_16x16x32_bf16 a[128:131], a[32:35], a[144:147], a[128:131]
  buffer_load_dwordx4 a[144:147], v2, s[40:43], s64 offen offset:0 sc1
  v_mfma_f32_16x16x32_bf16 a[68:71], a[16:19], a[148:151], a[68:71]
  s_add_u32 s65, s64, 131072
  v_sub_u32 v18, v16, v18
  v_mfma_f32_16x16x32_bf16 a[84:87], a[20:23], a[148:151], a[84:87]
  s_add_u32 s66, s64, 262144
  v_mul_u32_u24 v252, 336, v17
  v_mfma_f32_16x16x32_bf16 a[100:103], a[24:27], a[148:151], a[100:103]
  v_mfma_f32_16x16x32_bf16 a[116:119], a[28:31], a[148:151], a[116:119]
  v_mfma_f32_16x16x32_bf16 a[132:135], a[32:35], a[148:151], a[132:135]
  s_waitcnt vmcnt(20)
  buffer_load_dwordx4 a[148:151], v2, s[40:43], s65 offen offset:0 sc1
  v_lshl_add_u32 v252, v18, 5, v252
  v_mfma_f32_16x16x32_bf16 a[72:75], a[16:19], a[152:155], a[72:75]
  s_add_u32 s67, s64, 393216
  v_mfma_f32_16x16x32_bf16 a[88:91], a[20:23], a[152:155], a[88:91]
  v_mfma_f32_16x16x32_bf16 a[104:107], a[24:27], a[152:155], a[104:107]
  v_mfma_f32_16x16x32_bf16 a[120:123], a[28:31], a[152:155], a[120:123]
  v_lshlrev_b32 v204, 5, v18
  v_mfma_f32_16x16x32_bf16 a[136:139], a[32:35], a[152:155], a[136:139]
  buffer_load_dwordx4 a[152:155], v2, s[40:43], s66 offen offset:0 sc1
  v_add_u32 v17, s25, v17
  v_mfma_f32_16x16x32_bf16 a[76:79], a[16:19], a[156:159], a[76:79]
  v_mfma_f32_16x16x32_bf16 a[92:95], a[20:23], a[156:159], a[92:95]
  v_mfma_f32_16x16x32_bf16 a[108:111], a[24:27], a[156:159], a[108:111]
  v_mfma_f32_16x16x32_bf16 a[124:127], a[28:31], a[156:159], a[124:127]
  v_mfma_f32_16x16x32_bf16 a[140:143], a[32:35], a[156:159], a[140:143]
  s_waitcnt vmcnt(19)
  buffer_load_dwordx4 a[156:159], v2, s[40:43], s67 offen offset:0 sc1
  v_mfma_f32_16x16x32_bf16 a[64:67], a[36:39], a[160:163], a[64:67]
  v_add_u32 v25, 1, v17
  v_mfma_f32_16x16x32_bf16 a[80:83], a[40:43], a[160:163], a[80:83]
  v_mfma_f32_16x16x32_bf16 a[96:99], a[44:47], a[160:163], a[96:99]
  buffer_load_dwordx4 a[220:223], v2, s[40:43], s14 offen offset:3072 sc1
  v_mul_u32_u24 v249, 1280, v17
  v_mfma_f32_16x16x32_bf16 a[112:115], a[48:51], a[160:163], a[112:115]
  v_mfma_f32_16x16x32_bf16 a[128:131], a[52:55], a[160:163], a[128:131]
  buffer_load_dwordx4 a[160:163], v2, s[40:43], s64 offen offset:1024 sc1
  v_mfma_f32_16x16x32_bf16 a[68:71], a[36:39], a[164:167], a[68:71]
  v_lshl_add_u32 v249, v18, 4, v249
  v_mfma_f32_16x16x32_bf16 a[84:87], a[40:43], a[164:167], a[84:87]
  v_add_u32 v249, s26, v249
  v_mfma_f32_16x16x32_bf16 a[100:103], a[44:47], a[164:167], a[100:103]
  v_mfma_f32_16x16x32_bf16 a[116:119], a[48:51], a[164:167], a[116:119]
  v_mfma_f32_16x16x32_bf16 a[132:135], a[52:55], a[164:167], a[132:135]
  s_waitcnt vmcnt(19)
  buffer_load_dwordx4 a[164:167], v2, s[40:43], s65 offen offset:1024 sc1
  v_lshrrev_b32 v19, 4, v17
  v_mfma_f32_16x16x32_bf16 a[72:75], a[36:39], a[168:171], a[72:75]
  v_mfma_f32_16x16x32_bf16 a[88:91], a[40:43], a[168:171], a[88:91]
  v_mfma_f32_16x16x32_bf16 a[104:107], a[44:47], a[168:171], a[104:107]
  s_add_u32 s14, s13, 90112
  buffer_load_dwordx4 a[224:227], v2, s[40:43], s14 offen offset:0 sc1
  v_mfma_f32_16x16x32_bf16 a[120:123], a[48:51], a[168:171], a[120:123]
  v_mul_u32_u24 v19, 20480, v19
  v_mfma_f32_16x16x32_bf16 a[136:139], a[52:55], a[168:171], a[136:139]
  buffer_load_dwordx4 a[168:171], v2, s[40:43], s66 offen offset:1024 sc1
  v_and_b32 v17, 15, v17
  v_mfma_f32_16x16x32_bf16 a[76:79], a[36:39], a[172:175], a[76:79]
  v_mfma_f32_16x16x32_bf16 a[92:95], a[40:43], a[172:175], a[92:95]
  v_mfma_f32_16x16x32_bf16 a[108:111], a[44:47], a[172:175], a[108:111]
  v_mfma_f32_16x16x32_bf16 a[124:127], a[48:51], a[172:175], a[124:127]
  v_mfma_f32_16x16x32_bf16 a[140:143], a[52:55], a[172:175], a[140:143]
  s_waitcnt vmcnt(19)
  buffer_load_dwordx4 a[172:175], v2, s[40:43], s67 offen offset:1024 sc1
  v_mfma_f32_16x16x32_bf16 a[64:67], a[56:59], a[176:179], a[64:67]
  v_lshl_add_u32 v19, v17, 4, v19
  v_mfma_f32_16x16x32_bf16 a[80:83], a[60:63], a[176:179], a[80:83]
  v_mfma_f32_16x16x32_bf16 a[96:99], v[32:35], a[176:179], a[96:99]
  buffer_load_dwordx4 a[228:231], v2, s[40:43], s14 offen offset:1024 sc1
  v_lshl_add_u32 v201, v18, 8, v19
  v_mfma_f32_16x16x32_bf16 a[112:115], v[36:39], a[176:179], a[112:115]
  v_mfma_f32_16x16x32_bf16 a[128:131], v[40:43], a[176:179], a[128:131]
  buffer_load_dwordx4 a[176:179], v2, s[40:43], s64 offen offset:2048 sc1
  v_mfma_f32_16x16x32_bf16 a[68:71], a[56:59], a[180:183], a[68:71]
  v_mov_b32 v28, 8
  v_mfma_f32_16x16x32_bf16 a[84:87], a[60:63], a[180:183], a[84:87]
  v_add_u32 v16, 512, v0
  v_mfma_f32_16x16x32_bf16 a[100:103], v[32:35], a[180:183], a[100:103]
  v_mfma_f32_16x16x32_bf16 a[116:119], v[36:39], a[180:183], a[116:119]
  v_mfma_f32_16x16x32_bf16 a[132:135], v[40:43], a[180:183], a[132:135]
  s_waitcnt vmcnt(19)
  buffer_load_dwordx4 a[180:183], v2, s[40:43], s65 offen offset:2048 sc1
  v_mul_u32_u24 v17, 6554, v16
  v_mfma_f32_16x16x32_bf16 a[72:75], a[56:59], a[184:187], a[72:75]
  v_mfma_f32_16x16x32_bf16 a[88:91], a[60:63], a[184:187], a[88:91]
  v_mfma_f32_16x16x32_bf16 a[104:107], v[32:35], a[184:187], a[104:107]
  buffer_load_dwordx4 a[232:235], v2, s[40:43], s14 offen offset:2048 sc1
  v_mfma_f32_16x16x32_bf16 a[120:123], v[36:39], a[184:187], a[120:123]
  v_lshrrev_b32 v17, 16, v17
  v_mfma_f32_16x16x32_bf16 a[136:139], v[40:43], a[184:187], a[136:139]
  buffer_load_dwordx4 a[184:187], v2, s[40:43], s66 offen offset:2048 sc1
  v_mul_u32_u24 v18, 10, v17
  v_mfma_f32_16x16x32_bf16 a[76:79], a[56:59], a[188:191], a[76:79]
  v_mfma_f32_16x16x32_bf16 a[92:95], a[60:63], a[188:191], a[92:95]
  v_mfma_f32_16x16x32_bf16 a[108:111], v[32:35], a[188:191], a[108:111]
  v_mfma_f32_16x16x32_bf16 a[124:127], v[36:39], a[188:191], a[124:127]
  v_mfma_f32_16x16x32_bf16 a[140:143], v[40:43], a[188:191], a[140:143]
  s_waitcnt vmcnt(19)
  buffer_load_dwordx4 a[188:191], v2, s[40:43], s67 offen offset:2048 sc1
  v_mfma_f32_16x16x32_bf16 a[64:67], v[44:47], v[216:219], a[64:67]
  v_sub_u32 v18, v16, v18
  v_mfma_f32_16x16x32_bf16 a[80:83], v[48:51], v[216:219], a[80:83]
  v_mfma_f32_16x16x32_bf16 a[96:99], v[52:55], v[216:219], a[96:99]
  buffer_load_dwordx4 a[236:239], v2, s[40:43], s14 offen offset:3072 sc1
  v_mul_u32_u24 v253, 336, v17
  v_mfma_f32_16x16x32_bf16 a[112:115], v[56:59], v[216:219], a[112:115]
  v_mfma_f32_16x16x32_bf16 a[128:131], v[60:63], v[216:219], a[128:131]
  buffer_load_dwordx4 v[216:219], v2, s[40:43], s64 offen offset:3072 sc1
  v_mfma_f32_16x16x32_bf16 a[68:71], v[44:47], v[220:223], a[68:71]
  v_lshl_add_u32 v253, v18, 5, v253
  v_mfma_f32_16x16x32_bf16 a[84:87], v[48:51], v[220:223], a[84:87]
  v_lshlrev_b32 v205, 5, v18
  v_mfma_f32_16x16x32_bf16 a[100:103], v[52:55], v[220:223], a[100:103]
  v_mfma_f32_16x16x32_bf16 a[116:119], v[56:59], v[220:223], a[116:119]
  v_mfma_f32_16x16x32_bf16 a[132:135], v[60:63], v[220:223], a[132:135]
  s_waitcnt vmcnt(19)
  buffer_load_dwordx4 v[220:223], v2, s[40:43], s65 offen offset:3072 sc1
  v_add_u32 v17, s25, v17
  v_mfma_f32_16x16x32_bf16 a[72:75], v[44:47], v[224:227], a[72:75]
  v_mfma_f32_16x16x32_bf16 a[88:91], v[48:51], v[224:227], a[88:91]
  v_mfma_f32_16x16x32_bf16 a[104:107], v[52:55], v[224:227], a[104:107]
  v_mfma_f32_16x16x32_bf16 a[120:123], v[56:59], v[224:227], a[120:123]
  v_add_u32 v26, 1, v17
  v_mfma_f32_16x16x32_bf16 a[136:139], v[60:63], v[224:227], a[136:139]
  buffer_load_dwordx4 v[224:227], v2, s[40:43], s66 offen offset:3072 sc1
  v_mul_u32_u24 v250, 1280, v17
  v_mfma_f32_16x16x32_bf16 a[76:79], v[44:47], v[228:231], a[76:79]
  v_mfma_f32_16x16x32_bf16 a[92:95], v[48:51], v[228:231], a[92:95]
  v_mfma_f32_16x16x32_bf16 a[108:111], v[52:55], v[228:231], a[108:111]
  v_mfma_f32_16x16x32_bf16 a[124:127], v[56:59], v[228:231], a[124:127]
  v_mfma_f32_16x16x32_bf16 a[140:143], v[60:63], v[228:231], a[140:143]
  s_waitcnt vmcnt(18)
  buffer_load_dwordx4 v[228:231], v2, s[40:43], s67 offen offset:3072 sc1
  v_mfma_f32_16x16x32_bf16 a[64:67], v[96:99], a[144:147], a[64:67]
  s_add_u32 s62, s62, 4096
  v_lshl_add_u32 v250, v18, 4, v250
  v_mfma_f32_16x16x32_bf16 a[80:83], v[100:103], a[144:147], a[80:83]
  s_and_b32 s62, s62, 0x7fff
  v_mfma_f32_16x16x32_bf16 a[96:99], v[104:107], a[144:147], a[96:99]
  s_add_u32 s14, s13, 94208
  buffer_load_dwordx4 a[240:243], v2, s[40:43], s14 offen offset:0 sc1
  v_add_u32 v250, s26, v250
  v_mfma_f32_16x16x32_bf16 a[112:115], v[108:111], a[144:147], a[112:115]
  s_add_u32 s64, s63, s62
  v_mfma_f32_16x16x32_bf16 a[128:131], v[112:115], a[144:147], a[128:131]
  buffer_load_dwordx4 a[144:147], v2, s[40:43], s64 offen offset:0 sc1
  v_mfma_f32_16x16x32_bf16 a[68:71], v[96:99], a[148:151], a[68:71]
  s_add_u32 s65, s64, 131072
  v_lshrrev_b32 v19, 4, v17
  v_mfma_f32_16x16x32_bf16 a[84:87], v[100:103], a[148:151], a[84:87]
  s_add_u32 s66, s64, 262144
  v_mul_u32_u24 v19, 20480, v19
  v_mfma_f32_16x16x32_bf16 a[100:103], v[104:107], a[148:151], a[100:103]
  v_mfma_f32_16x16x32_bf16 a[116:119], v[108:111], a[148:151], a[116:119]
  v_mfma_f32_16x16x32_bf16 a[132:135], v[112:115], a[148:151], a[132:135]
  s_waitcnt vmcnt(19)
  buffer_load_dwordx4 a[148:151], v2, s[40:43], s65 offen offset:0 sc1
  v_and_b32 v17, 15, v17
  v_mfma_f32_16x16x32_bf16 a[72:75], v[96:99], a[152:155], a[72:75]
  s_add_u32 s67, s64, 393216
  v_mfma_f32_16x16x32_bf16 a[88:91], v[100:103], a[152:155], a[88:91]
  v_mfma_f32_16x16x32_bf16 a[104:107], v[104:107], a[152:155], a[104:107]
  buffer_load_dwordx4 a[244:247], v2, s[40:43], s14 offen offset:1024 sc1
  v_mfma_f32_16x16x32_bf16 a[120:123], v[108:111], a[152:155], a[120:123]
  v_lshl_add_u32 v19, v17, 4, v19
  v_mfma_f32_16x16x32_bf16 a[136:139], v[112:115], a[152:155], a[136:139]
  buffer_load_dwordx4 a[152:155], v2, s[40:43], s66 offen offset:0 sc1
  v_lshl_add_u32 v202, v18, 8, v19
  v_mfma_f32_16x16x32_bf16 a[76:79], v[96:99], a[156:159], a[76:79]
  v_mfma_f32_16x16x32_bf16 a[92:95], v[100:103], a[156:159], a[92:95]
  v_mfma_f32_16x16x32_bf16 a[108:111], v[104:107], a[156:159], a[108:111]
  v_mfma_f32_16x16x32_bf16 a[124:127], v[108:111], a[156:159], a[124:127]
  v_mfma_f32_16x16x32_bf16 a[140:143], v[112:115], a[156:159], a[140:143]
  s_waitcnt vmcnt(19)
  buffer_load_dwordx4 a[156:159], v2, s[40:43], s67 offen offset:0 sc1
  v_mfma_f32_16x16x32_bf16 a[64:67], v[116:119], a[160:163], a[64:67]
  v_mov_b32 v29, 8
  v_mfma_f32_16x16x32_bf16 a[80:83], v[120:123], a[160:163], a[80:83]
  v_mfma_f32_16x16x32_bf16 a[96:99], v[124:127], a[160:163], a[96:99]
  buffer_load_dwordx4 a[248:251], v2, s[40:43], s14 offen offset:2048 sc1
  v_cmp_gt_u32 vcc, 128, v0
  v_mfma_f32_16x16x32_bf16 a[112:115], v[160:163], a[160:163], a[112:115]
  v_mfma_f32_16x16x32_bf16 a[128:131], v[164:167], a[160:163], a[128:131]
  buffer_load_dwordx4 a[160:163], v2, s[40:43], s64 offen offset:1024 sc1
  v_mfma_f32_16x16x32_bf16 a[68:71], v[116:119], a[164:167], a[68:71]
  v_mov_b32 v16, 1073741824
  v_mfma_f32_16x16x32_bf16 a[84:87], v[120:123], a[164:167], a[84:87]
  v_mov_b32 v17, 0
  v_mfma_f32_16x16x32_bf16 a[100:103], v[124:127], a[164:167], a[100:103]
  v_mfma_f32_16x16x32_bf16 a[116:119], v[160:163], a[164:167], a[116:119]
  v_mfma_f32_16x16x32_bf16 a[132:135], v[164:167], a[164:167], a[132:135]
  s_waitcnt vmcnt(19)
  buffer_load_dwordx4 a[164:167], v2, s[40:43], s65 offen offset:1024 sc1
  v_cndmask_b32 v250, v16, v250, vcc
  v_mfma_f32_16x16x32_bf16 a[72:75], v[116:119], a[168:171], a[72:75]
  v_mfma_f32_16x16x32_bf16 a[88:91], v[120:123], a[168:171], a[88:91]
  v_mfma_f32_16x16x32_bf16 a[104:107], v[124:127], a[168:171], a[104:107]
  buffer_load_dwordx4 a[252:255], v2, s[40:43], s14 offen offset:3072 sc1
  v_mfma_f32_16x16x32_bf16 a[120:123], v[160:163], a[168:171], a[120:123]
  v_cndmask_b32 v202, v16, v202, vcc
  v_mfma_f32_16x16x32_bf16 a[136:139], v[164:167], a[168:171], a[136:139]
  buffer_load_dwordx4 a[168:171], v2, s[40:43], s66 offen offset:1024 sc1
  v_cndmask_b32 v253, v17, v253, vcc
  v_mfma_f32_16x16x32_bf16 a[76:79], v[116:119], a[172:175], a[76:79]
  v_mfma_f32_16x16x32_bf16 a[92:95], v[120:123], a[172:175], a[92:95]
  v_mfma_f32_16x16x32_bf16 a[108:111], v[124:127], a[172:175], a[108:111]
  v_mfma_f32_16x16x32_bf16 a[124:127], v[160:163], a[172:175], a[124:127]
  v_mfma_f32_16x16x32_bf16 a[140:143], v[164:167], a[172:175], a[140:143]
  s_waitcnt vmcnt(19)
  buffer_load_dwordx4 a[172:175], v2, s[40:43], s67 offen offset:1024 sc1
  v_mfma_f32_16x16x32_bf16 a[64:67], v[168:171], a[176:179], a[64:67]
  v_readlane_b32 s68, v15, 0
  v_mfma_f32_16x16x32_bf16 a[80:83], v[172:175], a[176:179], a[80:83]
  v_mfma_f32_16x16x32_bf16 a[96:99], v[192:195], a[176:179], a[96:99]
  s_add_u32 s14, s13, 106496
  buffer_load_dwordx4 a[32:35], v2, s[40:43], s14 offen offset:0 sc1
  v_readlane_b32 s69, v15, 1
  v_mfma_f32_16x16x32_bf16 a[112:115], v[196:199], a[176:179], a[112:115]
  v_mfma_f32_16x16x32_bf16 a[128:131], v[208:211], a[176:179], a[128:131]
  buffer_load_dwordx4 a[176:179], v2, s[40:43], s64 offen offset:2048 sc1
  v_mfma_f32_16x16x32_bf16 a[68:71], v[168:171], a[180:183], a[68:71]
  v_readlane_b32 s70, v15, 2
  v_mfma_f32_16x16x32_bf16 a[84:87], v[172:175], a[180:183], a[84:87]
  v_readlane_b32 s71, v15, 3
  v_mfma_f32_16x16x32_bf16 a[100:103], v[192:195], a[180:183], a[100:103]
  v_mfma_f32_16x16x32_bf16 a[116:119], v[196:199], a[180:183], a[116:119]
  v_mfma_f32_16x16x32_bf16 a[132:135], v[208:211], a[180:183], a[132:135]
  s_waitcnt vmcnt(19)
  buffer_load_dwordx4 a[180:183], v2, s[40:43], s65 offen offset:2048 sc1
  v_readlane_b32 s72, v15, 4
  v_mfma_f32_16x16x32_bf16 a[72:75], v[168:171], a[184:187], a[72:75]
  v_mfma_f32_16x16x32_bf16 a[88:91], v[172:175], a[184:187], a[88:91]
  v_mfma_f32_16x16x32_bf16 a[104:107], v[192:195], a[184:187], a[104:107]
  v_mfma_f32_16x16x32_bf16 a[120:123], v[196:199], a[184:187], a[120:123]
  v_readlane_b32 s73, v15, 5
  v_mfma_f32_16x16x32_bf16 a[136:139], v[208:211], a[184:187], a[136:139]
  buffer_load_dwordx4 a[184:187], v2, s[40:43], s66 offen offset:2048 sc1
  v_readlane_b32 s74, v15, 6
  v_mfma_f32_16x16x32_bf16 a[76:79], v[168:171], a[188:191], a[76:79]
  v_mfma_f32_16x16x32_bf16 a[92:95], v[172:175], a[188:191], a[92:95]
  v_mfma_f32_16x16x32_bf16 a[108:111], v[192:195], a[188:191], a[108:111]
  v_mfma_f32_16x16x32_bf16 a[124:127], v[196:199], a[188:191], a[124:127]
  v_mfma_f32_16x16x32_bf16 a[140:143], v[208:211], a[188:191], a[140:143]
  s_waitcnt vmcnt(18)
  buffer_load_dwordx4 a[188:191], v2, s[40:43], s67 offen offset:2048 sc1
  v_mfma_f32_16x16x32_bf16 a[64:67], v[212:215], v[216:219], a[64:67]
  v_readlane_b32 s75, v15, 7
  v_mfma_f32_16x16x32_bf16 a[80:83], v[232:235], v[216:219], a[80:83]
  v_mfma_f32_16x16x32_bf16 a[96:99], v[236:239], v[216:219], a[96:99]
  buffer_load_dwordx4 a[36:39], v2, s[40:43], s14 offen offset:1024 sc1
  v_cmp_eq_u32 s[52:53], s68, v24
  v_mfma_f32_16x16x32_bf16 a[112:115], v[240:243], v[216:219], a[112:115]
  v_mfma_f32_16x16x32_bf16 a[128:131], v[244:247], v[216:219], a[128:131]
  buffer_load_dwordx4 v[216:219], v2, s[40:43], s64 offen offset:3072 sc1
  v_mfma_f32_16x16x32_bf16 a[68:71], v[212:215], v[220:223], a[68:71]
  v_cmp_eq_u32 s[54:55], s68, v25
  v_mfma_f32_16x16x32_bf16 a[84:87], v[232:235], v[220:223], a[84:87]
  v_cmp_eq_u32 s[56:57], s68, v26
  v_mfma_f32_16x16x32_bf16 a[100:103], v[236:239], v[220:223], a[100:103]
  v_mfma_f32_16x16x32_bf16 a[116:119], v[240:243], v[220:223], a[116:119]
  v_mfma_f32_16x16x32_bf16 a[132:135], v[244:247], v[220:223], a[132:135]
  s_waitcnt vmcnt(19)
  buffer_load_dwordx4 v[220:223], v2, s[40:43], s65 offen offset:3072 sc1
  v_cndmask_b32 v27, v27, 0, s[52:53]
  v_mfma_f32_16x16x32_bf16 a[72:75], v[212:215], v[224:227], a[72:75]
  v_mfma_f32_16x16x32_bf16 a[88:91], v[232:235], v[224:227], a[88:91]
  v_mfma_f32_16x16x32_bf16 a[104:107], v[236:239], v[224:227], a[104:107]
  buffer_load_dwordx4 a[40:43], v2, s[40:43], s14 offen offset:2048 sc1
  v_mfma_f32_16x16x32_bf16 a[120:123], v[240:243], v[224:227], a[120:123]
  v_cndmask_b32 v28, v28, 0, s[54:55]
  v_mfma_f32_16x16x32_bf16 a[136:139], v[244:247], v[224:227], a[136:139]
  buffer_load_dwordx4 v[224:227], v2, s[40:43], s66 offen offset:3072 sc1
  v_cndmask_b32 v29, v29, 0, s[56:57]
  v_mfma_f32_16x16x32_bf16 a[76:79], v[212:215], v[228:231], a[76:79]
  v_mfma_f32_16x16x32_bf16 a[92:95], v[232:235], v[228:231], a[92:95]
  v_mfma_f32_16x16x32_bf16 a[108:111], v[236:239], v[228:231], a[108:111]
  v_mfma_f32_16x16x32_bf16 a[124:127], v[240:243], v[228:231], a[124:127]
  v_mfma_f32_16x16x32_bf16 a[140:143], v[244:247], v[228:231], a[140:143]
  s_waitcnt vmcnt(19)
  buffer_load_dwordx4 v[228:231], v2, s[40:43], s67 offen offset:3072 sc1
  v_mfma_f32_16x16x32_bf16 a[64:67], v[64:67], a[144:147], a[64:67]
  s_add_u32 s62, s62, 4096
  v_cmp_eq_u32 s[52:53], s69, v24
  v_mfma_f32_16x16x32_bf16 a[80:83], v[68:71], a[144:147], a[80:83]
  s_and_b32 s62, s62, 0x7fff
  v_mfma_f32_16x16x32_bf16 a[96:99], v[72:75], a[144:147], a[96:99]
  buffer_load_dwordx4 a[44:47], v2, s[40:43], s14 offen offset:3072 sc1
  v_cmp_eq_u32 s[54:55], s69, v25
  v_mfma_f32_16x16x32_bf16 a[112:115], v[76:79], a[144:147], a[112:115]
  s_add_u32 s64, s63, s62
  v_mfma_f32_16x16x32_bf16 a[128:131], v[80:83], a[144:147], a[128:131]
  buffer_load_dwordx4 a[144:147], v2, s[40:43], s64 offen offset:0 sc1
  v_mfma_f32_16x16x32_bf16 a[68:71], v[64:67], a[148:151], a[68:71]
  s_add_u32 s65, s64, 131072
  v_cmp_eq_u32 s[56:57], s69, v26
  v_mfma_f32_16x16x32_bf16 a[84:87], v[68:71], a[148:151], a[84:87]
  s_add_u32 s66, s64, 262144
  v_cndmask_b32 v27, v27, 1, s[52:53]
  v_mfma_f32_16x16x32_bf16 a[100:103], v[72:75], a[148:151], a[100:103]
  v_mfma_f32_16x16x32_bf16 a[116:119], v[76:79], a[148:151], a[116:119]
  v_mfma_f32_16x16x32_bf16 a[132:135], v[80:83], a[148:151], a[132:135]
  s_waitcnt vmcnt(19)
  buffer_load_dwordx4 a[148:151], v2, s[40:43], s65 offen offset:0 sc1
  v_cndmask_b32 v28, v28, 1, s[54:55]
  v_mfma_f32_16x16x32_bf16 a[72:75], v[64:67], a[152:155], a[72:75]
  s_add_u32 s67, s64, 393216
  v_add_u32 v11, s33, v2
  v_mfma_f32_16x16x32_bf16 a[88:91], v[68:71], a[152:155], a[88:91]
  ds_read_b128 a[0:3], v11 offset:0
  v_mfma_f32_16x16x32_bf16 a[104:107], v[72:75], a[152:155], a[104:107]
  s_add_u32 s14, s13, 110592
  buffer_load_dwordx4 a[48:51], v2, s[40:43], s14 offen offset:0 sc1
  v_mfma_f32_16x16x32_bf16 a[120:123], v[76:79], a[152:155], a[120:123]
  s_add_u32 s33, s33, 32768
  ds_read_b128 a[4:7], v11 offset:1024
  v_cndmask_b32 v29, v29, 1, s[56:57]
  v_mfma_f32_16x16x32_bf16 a[136:139], v[80:83], a[152:155], a[136:139]
  buffer_load_dwordx4 a[152:155], v2, s[40:43], s66 offen offset:0 sc1
  v_cmp_eq_u32 s[52:53], s70, v24
  v_mfma_f32_16x16x32_bf16 a[76:79], v[64:67], a[156:159], a[76:79]
  s_and_b32 s33, s33, 0x1ffff
  v_mfma_f32_16x16x32_bf16 a[92:95], v[68:71], a[156:159], a[92:95]
  ds_read_b128 a[8:11], v11 offset:2048
  v_mfma_f32_16x16x32_bf16 a[108:111], v[72:75], a[156:159], a[108:111]
  ds_read_b128 a[12:15], v11 offset:3072
  v_mfma_f32_16x16x32_bf16 a[124:127], v[76:79], a[156:159], a[124:127]
  v_mfma_f32_16x16x32_bf16 a[140:143], v[80:83], a[156:159], a[140:143]
  s_waitcnt vmcnt(19)
  buffer_load_dwordx4 a[156:159], v2, s[40:43], s67 offen offset:0 sc1
  v_mfma_f32_16x16x32_bf16 a[64:67], v[84:87], a[160:163], a[64:67]
  v_cmp_eq_u32 s[54:55], s70, v25
  v_mfma_f32_16x16x32_bf16 a[80:83], v[88:91], a[160:163], a[80:83]
  v_mfma_f32_16x16x32_bf16 a[96:99], v[92:95], a[160:163], a[96:99]
  buffer_load_dwordx4 a[52:55], v2, s[40:43], s14 offen offset:1024 sc1
  v_cmp_eq_u32 s[56:57], s70, v26
  v_mfma_f32_16x16x32_bf16 a[112:115], v[128:131], a[160:163], a[112:115]
  v_mfma_f32_16x16x32_bf16 a[128:131], v[132:135], a[160:163], a[128:131]
  buffer_load_dwordx4 a[160:163], v2, s[40:43], s64 offen offset:1024 sc1
  v_mfma_f32_16x16x32_bf16 a[68:71], v[84:87], a[164:167], a[68:71]
  v_cndmask_b32 v27, v27, 2, s[52:53]
  v_mfma_f32_16x16x32_bf16 a[84:87], v[88:91], a[164:167], a[84:87]
  v_cndmask_b32 v28, v28, 2, s[54:55]
  v_mfma_f32_16x16x32_bf16 a[100:103], v[92:95], a[164:167], a[100:103]
  v_mfma_f32_16x16x32_bf16 a[116:119], v[128:131], a[164:167], a[116:119]
  s_waitcnt lgkmcnt(0)
  v_mfma_f32_16x16x32_bf16 a[132:135], v[132:135], a[164:167], a[132:135]
  s_waitcnt vmcnt(19)
  buffer_load_dwordx4 a[164:167], v2, s[40:43], s65 offen offset:1024 sc1
  v_cndmask_b32 v29, v29, 2, s[56:57]
  v_mfma_f32_16x16x32_bf16 a[72:75], v[84:87], a[168:171], a[72:75]
  v_add_u32 v11, s34, v2
  v_mfma_f32_16x16x32_bf16 a[88:91], v[88:91], a[168:171], a[88:91]
  ds_read_b128 a[16:19], v11 offset:0
  v_mfma_f32_16x16x32_bf16 a[104:107], v[92:95], a[168:171], a[104:107]
  v_mfma_f32_16x16x32_bf16 a[120:123], v[128:131], a[168:171], a[120:123]
  s_add_u32 s34, s34, 32768
  ds_read_b128 a[20:23], v11 offset:1024
  v_cmp_eq_u32 s[52:53], s71, v24
  v_mfma_f32_16x16x32_bf16 a[136:139], v[132:135], a[168:171], a[136:139]
  buffer_load_dwordx4 a[168:171], v2, s[40:43], s66 offen offset:1024 sc1
  v_cmp_eq_u32 s[54:55], s71, v25
  v_mfma_f32_16x16x32_bf16 a[76:79], v[84:87], a[172:175], a[76:79]
  s_and_b32 s34, s34, 0x1ffff
  v_mfma_f32_16x16x32_bf16 a[92:95], v[88:91], a[172:175], a[92:95]
  ds_read_b128 a[24:27], v11 offset:2048
  v_mfma_f32_16x16x32_bf16 a[108:111], v[92:95], a[172:175], a[108:111]
  ds_read_b128 a[28:31], v11 offset:3072
  v_mfma_f32_16x16x32_bf16 a[124:127], v[128:131], a[172:175], a[124:127]
  v_mfma_f32_16x16x32_bf16 a[140:143], v[132:135], a[172:175], a[140:143]
  s_waitcnt vmcnt(18)
  buffer_load_dwordx4 a[172:175], v2, s[40:43], s67 offen offset:1024 sc1
  v_mfma_f32_16x16x32_bf16 a[64:67], v[136:139], a[176:179], a[64:67]
  v_cmp_eq_u32 s[56:57], s71, v26
  v_mfma_f32_16x16x32_bf16 a[80:83], v[140:143], a[176:179], a[80:83]
  v_mfma_f32_16x16x32_bf16 a[96:99], v[144:147], a[176:179], a[96:99]
  buffer_load_dwordx4 a[56:59], v2, s[40:43], s14 offen offset:2048 sc1
  v_cndmask_b32 v27, v27, 3, s[52:53]
  v_mfma_f32_16x16x32_bf16 a[112:115], v[148:151], a[176:179], a[112:115]
  v_mfma_f32_16x16x32_bf16 a[128:131], v[152:155], a[176:179], a[128:131]
  buffer_load_dwordx4 a[176:179], v2, s[40:43], s64 offen offset:2048 sc1
  v_mfma_f32_16x16x32_bf16 a[68:71], v[136:139], a[180:183], a[68:71]
  v_cndmask_b32 v28, v28, 3, s[54:55]
  v_mfma_f32_16x16x32_bf16 a[84:87], v[140:143], a[180:183], a[84:87]
  v_cndmask_b32 v29, v29, 3, s[56:57]
  v_mfma_f32_16x16x32_bf16 a[100:103], v[144:147], a[180:183], a[100:103]
  v_mfma_f32_16x16x32_bf16 a[116:119], v[148:151], a[180:183], a[116:119]
  s_waitcnt lgkmcnt(0)
  v_mfma_f32_16x16x32_bf16 a[132:135], v[152:155], a[180:183], a[132:135]
  s_waitcnt vmcnt(19)
  buffer_load_dwordx4 a[180:183], v2, s[40:43], s65 offen offset:2048 sc1
  v_cmp_eq_u32 s[52:53], s72, v24
  v_mfma_f32_16x16x32_bf16 a[72:75], v[136:139], a[184:187], a[72:75]
  v_add_u32 v11, s33, v2
  v_mfma_f32_16x16x32_bf16 a[88:91], v[140:143], a[184:187], a[88:91]
  ds_read_b128 v[32:35], v11 offset:0
  v_mfma_f32_16x16x32_bf16 a[104:107], v[144:147], a[184:187], a[104:107]
  buffer_load_dwordx4 a[60:63], v2, s[40:43], s14 offen offset:3072 sc1
  v_mfma_f32_16x16x32_bf16 a[120:123], v[148:151], a[184:187], a[120:123]
  s_add_u32 s33, s33, 32768
  ds_read_b128 v[36:39], v11 offset:1024
  v_cmp_eq_u32 s[54:55], s72, v25
  v_mfma_f32_16x16x32_bf16 a[136:139], v[152:155], a[184:187], a[136:139]
  buffer_load_dwordx4 a[184:187], v2, s[40:43], s66 offen offset:2048 sc1
  v_cmp_eq_u32 s[56:57], s72, v26
  v_mfma_f32_16x16x32_bf16 a[76:79], v[136:139], a[188:191], a[76:79]
  s_and_b32 s33, s33, 0x1ffff
  v_mfma_f32_16x16x32_bf16 a[92:95], v[140:143], a[188:191], a[92:95]
  ds_read_b128 v[40:43], v11 offset:2048
  v_mfma_f32_16x16x32_bf16 a[108:111], v[144:147], a[188:191], a[108:111]
  ds_read_b128 v[44:47], v11 offset:3072
  v_mfma_f32_16x16x32_bf16 a[124:127], v[148:151], a[188:191], a[124:127]
  v_mfma_f32_16x16x32_bf16 a[140:143], v[152:155], a[188:191], a[140:143]
  s_waitcnt vmcnt(19)
  buffer_load_dwordx4 a[188:191], v2, s[40:43], s67 offen offset:2048 sc1
  v_mfma_f32_16x16x32_bf16 a[64:67], v[156:159], v[216:219], a[64:67]
  v_cndmask_b32 v27, v27, 4, s[52:53]
  v_mfma_f32_16x16x32_bf16 a[80:83], v[176:179], v[216:219], a[80:83]
  v_mfma_f32_16x16x32_bf16 a[96:99], v[180:183], v[216:219], a[96:99]
  s_add_u32 s14, s13, 122880
  buffer_load_dwordx4 v[96:99], v2, s[40:43], s14 offen offset:0 sc1
  v_cndmask_b32 v28, v28, 4, s[54:55]
  v_mfma_f32_16x16x32_bf16 a[112:115], v[184:187], v[216:219], a[112:115]
  v_mfma_f32_16x16x32_bf16 a[128:131], v[188:191], v[216:219], a[128:131]
  buffer_load_dwordx4 v[216:219], v2, s[40:43], s64 offen offset:3072 sc1
  v_mfma_f32_16x16x32_bf16 a[68:71], v[156:159], v[220:223], a[68:71]
  v_cndmask_b32 v29, v29, 4, s[56:57]
  v_mfma_f32_16x16x32_bf16 a[84:87], v[176:179], v[220:223], a[84:87]
  v_cmp_eq_u32 s[52:53], s73, v24
  v_mfma_f32_16x16x32_bf16 a[100:103], v[180:183], v[220:223], a[100:103]
  v_mfma_f32_16x16x32_bf16 a[116:119], v[184:187], v[220:223], a[116:119]
  s_waitcnt lgkmcnt(0)
  v_mfma_f32_16x16x32_bf16 a[132:135], v[188:191], v[220:223], a[132:135]
  s_waitcnt vmcnt(19)
  buffer_load_dwordx4 v[220:223], v2, s[40:43], s65 offen offset:3072 sc1
  v_cmp_eq_u32 s[54:55], s73, v25
  v_mfma_f32_16x16x32_bf16 a[72:75], v[156:159], v[224:227], a[72:75]
  v_add_u32 v11, s34, v2
  v_mfma_f32_16x16x32_bf16 a[88:91], v[176:179], v[224:227], a[88:91]
  ds_read_b128 v[48:51], v11 offset:0
  v_mfma_f32_16x16x32_bf16 a[104:107], v[180:183], v[224:227], a[104:107]
  buffer_load_dwordx4 v[100:103], v2, s[40:43], s14 offen offset:1024 sc1
  v_mfma_f32_16x16x32_bf16 a[120:123], v[184:187], v[224:227], a[120:123]
  s_add_u32 s34, s34, 32768
  ds_read_b128 v[52:55], v11 offset:1024
  v_cmp_eq_u32 s[56:57], s73, v26
  v_mfma_f32_16x16x32_bf16 a[136:139], v[188:191], v[224:227], a[136:139]
  buffer_load_dwordx4 v[224:227], v2, s[40:43], s66 offen offset:3072 sc1
  v_cndmask_b32 v27, v27, 5, s[52:53]
  v_mfma_f32_16x16x32_bf16 a[76:79], v[156:159], v[228:231], a[76:79]
  s_and_b32 s34, s34, 0x1ffff
  v_mfma_f32_16x16x32_bf16 a[92:95], v[176:179], v[228:231], a[92:95]
  ds_read_b128 v[56:59], v11 offset:2048
  v_mfma_f32_16x16x32_bf16 a[108:111], v[180:183], v[228:231], a[108:111]
  ds_read_b128 v[60:63], v11 offset:3072
  v_mfma_f32_16x16x32_bf16 a[124:127], v[184:187], v[228:231], a[124:127]
  v_mfma_f32_16x16x32_bf16 a[140:143], v[188:191], v[228:231], a[140:143]
  s_waitcnt vmcnt(19)
  buffer_load_dwordx4 v[228:231], v2, s[40:43], s67 offen offset:3072 sc1
  v_mfma_f32_16x16x32_bf16 a[64:67], a[192:195], a[144:147], a[64:67]
  s_add_u32 s62, s62, 4096
  v_cndmask_b32 v28, v28, 5, s[54:55]
  v_mfma_f32_16x16x32_bf16 a[80:83], a[196:199], a[144:147], a[80:83]
  s_and_b32 s62, s62, 0x7fff
  v_mfma_f32_16x16x32_bf16 a[96:99], a[200:203], a[144:147], a[96:99]
  buffer_load_dwordx4 v[104:107], v2, s[40:43], s14 offen offset:2048 sc1
  v_cndmask_b32 v29, v29, 5, s[56:57]
  v_mfma_f32_16x16x32_bf16 a[112:115], a[204:207], a[144:147], a[112:115]
  s_add_u32 s64, s63, s62
  v_mfma_f32_16x16x32_bf16 a[128:131], a[208:211], a[144:147], a[128:131]
  buffer_load_dwordx4 a[144:147], v2, s[40:43], s64 offen offset:0 sc1
  v_mfma_f32_16x16x32_bf16 a[68:71], a[192:195], a[148:151], a[68:71]
  s_add_u32 s65, s64, 131072
  v_cmp_eq_u32 s[52:53], s74, v24
  v_mfma_f32_16x16x32_bf16 a[84:87], a[196:199], a[148:151], a[84:87]
  s_add_u32 s66, s64, 262144
  v_cmp_eq_u32 s[54:55], s74, v25
  v_mfma_f32_16x16x32_bf16 a[100:103], a[200:203], a[148:151], a[100:103]
  v_mfma_f32_16x16x32_bf16 a[116:119], a[204:207], a[148:151], a[116:119]
  s_waitcnt lgkmcnt(0)
  v_mfma_f32_16x16x32_bf16 a[132:135], a[208:211], a[148:151], a[132:135]
  s_waitcnt vmcnt(19)
  buffer_load_dwordx4 a[148:151], v2, s[40:43], s65 offen offset:0 sc1
  v_cmp_eq_u32 s[56:57], s74, v26
  v_mfma_f32_16x16x32_bf16 a[72:75], a[192:195], a[152:155], a[72:75]
  s_add_u32 s67, s64, 393216
  v_add_u32 v11, s33, v2
  v_mfma_f32_16x16x32_bf16 a[88:91], a[196:199], a[152:155], a[88:91]
  ds_read_b128 v[160:163], v11 offset:0
  v_mfma_f32_16x16x32_bf16 a[104:107], a[200:203], a[152:155], a[104:107]
  buffer_load_dwordx4 v[108:111], v2, s[40:43], s14 offen offset:3072 sc1
  v_mfma_f32_16x16x32_bf16 a[120:123], a[204:207], a[152:155], a[120:123]
  s_add_u32 s33, s33, 32768
  ds_read_b128 v[164:167], v11 offset:1024
  v_cndmask_b32 v27, v27, 6, s[52:53]
  v_mfma_f32_16x16x32_bf16 a[136:139], a[208:211], a[152:155], a[136:139]
  buffer_load_dwordx4 a[152:155], v2, s[40:43], s66 offen offset:0 sc1
  v_cndmask_b32 v28, v28, 6, s[54:55]
  v_mfma_f32_16x16x32_bf16 a[76:79], a[192:195], a[156:159], a[76:79]
  s_and_b32 s33, s33, 0x1ffff
  v_mfma_f32_16x16x32_bf16 a[92:95], a[196:199], a[156:159], a[92:95]
  ds_read_b128 v[168:171], v11 offset:2048
  v_mfma_f32_16x16x32_bf16 a[108:111], a[200:203], a[156:159], a[108:111]
  ds_read_b128 v[172:175], v11 offset:3072
  v_mfma_f32_16x16x32_bf16 a[124:127], a[204:207], a[156:159], a[124:127]
  v_mfma_f32_16x16x32_bf16 a[140:143], a[208:211], a[156:159], a[140:143]
  s_waitcnt vmcnt(19)
  buffer_load_dwordx4 a[156:159], v2, s[40:43], s67 offen offset:0 sc1
  v_mfma_f32_16x16x32_bf16 a[64:67], a[212:215], a[160:163], a[64:67]
  v_cndmask_b32 v29, v29, 6, s[56:57]
  v_mfma_f32_16x16x32_bf16 a[80:83], a[216:219], a[160:163], a[80:83]
  v_mfma_f32_16x16x32_bf16 a[96:99], a[220:223], a[160:163], a[96:99]
  s_add_u32 s14, s13, 126976
  buffer_load_dwordx4 v[112:115], v2, s[40:43], s14 offen offset:0 sc1
  v_cmp_eq_u32 s[52:53], s75, v24
  v_mfma_f32_16x16x32_bf16 a[112:115], a[224:227], a[160:163], a[112:115]
  v_mfma_f32_16x16x32_bf16 a[128:131], a[228:231], a[160:163], a[128:131]
  buffer_load_dwordx4 a[160:163], v2, s[40:43], s64 offen offset:1024 sc1
  v_mfma_f32_16x16x32_bf16 a[68:71], a[212:215], a[164:167], a[68:71]
  v_cmp_eq_u32 s[54:55], s75, v25
  v_mfma_f32_16x16x32_bf16 a[84:87], a[216:219], a[164:167], a[84:87]
  v_cmp_eq_u32 s[56:57], s75, v26
  v_mfma_f32_16x16x32_bf16 a[100:103], a[220:223], a[164:167], a[100:103]
  v_mfma_f32_16x16x32_bf16 a[116:119], a[224:227], a[164:167], a[116:119]
  s_waitcnt lgkmcnt(0)
  v_mfma_f32_16x16x32_bf16 a[132:135], a[228:231], a[164:167], a[132:135]
  s_waitcnt vmcnt(20)
  buffer_load_dwordx4 a[164:167], v2, s[40:43], s65 offen offset:1024 sc1
  v_cndmask_b32 v27, v27, 7, s[52:53]
  v_mfma_f32_16x16x32_bf16 a[72:75], a[212:215], a[168:171], a[72:75]
  v_add_u32 v11, s34, v2
  v_mfma_f32_16x16x32_bf16 a[88:91], a[216:219], a[168:171], a[88:91]
  ds_read_b128 v[192:195], v11 offset:0
  v_mfma_f32_16x16x32_bf16 a[104:107], a[220:223], a[168:171], a[104:107]
  v_mfma_f32_16x16x32_bf16 a[120:123], a[224:227], a[168:171], a[120:123]
  s_add_u32 s34, s34, 32768
  ds_read_b128 v[196:199], v11 offset:1024
  v_cndmask_b32 v28, v28, 7, s[54:55]
  v_mfma_f32_16x16x32_bf16 a[136:139], a[228:231], a[168:171], a[136:139]
  buffer_load_dwordx4 a[168:171], v2, s[40:43], s66 offen offset:1024 sc1
  v_cndmask_b32 v29, v29, 7, s[56:57]
  v_mfma_f32_16x16x32_bf16 a[76:79], a[212:215], a[172:175], a[76:79]
  s_and_b32 s34, s34, 0x1ffff
  v_mfma_f32_16x16x32_bf16 a[92:95], a[216:219], a[172:175], a[92:95]
  ds_read_b128 v[208:211], v11 offset:2048
  v_mfma_f32_16x16x32_bf16 a[108:111], a[220:223], a[172:175], a[108:111]
  ds_read_b128 v[212:215], v11 offset:3072
  v_mfma_f32_16x16x32_bf16 a[124:127], a[224:227], a[172:175], a[124:127]
  v_mfma_f32_16x16x32_bf16 a[140:143], a[228:231], a[172:175], a[140:143]
  s_waitcnt vmcnt(19)
  buffer_load_dwordx4 a[172:175], v2, s[40:43], s67 offen offset:1024 sc1
  v_mfma_f32_16x16x32_bf16 a[64:67], a[232:235], a[176:179], a[64:67]
  v_mul_u32_u24 v27, 320, v27
  v_mfma_f32_16x16x32_bf16 a[80:83], a[236:239], a[176:179], a[80:83]
  v_mfma_f32_16x16x32_bf16 a[96:99], a[240:243], a[176:179], a[96:99]
  buffer_load_dwordx4 v[116:119], v2, s[40:43], s14 offen offset:1024 sc1
  v_add_u32 v203, v203, v27
  v_mfma_f32_16x16x32_bf16 a[112:115], a[244:247], a[176:179], a[112:115]
  v_mfma_f32_16x16x32_bf16 a[128:131], a[248:251], a[176:179], a[128:131]
  buffer_load_dwordx4 a[176:179], v2, s[40:43], s64 offen offset:2048 sc1
  v_mfma_f32_16x16x32_bf16 a[68:71], a[232:235], a[180:183], a[68:71]
  v_add_u32 v203, 155648, v203
  v_mfma_f32_16x16x32_bf16 a[84:87], a[236:239], a[180:183], a[84:87]
  v_mul_u32_u24 v28, 320, v28
  v_mfma_f32_16x16x32_bf16 a[100:103], a[240:243], a[180:183], a[100:103]
  v_mfma_f32_16x16x32_bf16 a[116:119], a[244:247], a[180:183], a[116:119]
  s_waitcnt lgkmcnt(0)
  v_mfma_f32_16x16x32_bf16 a[132:135], a[248:251], a[180:183], a[132:135]
  s_waitcnt vmcnt(19)
  buffer_load_dwordx4 a[180:183], v2, s[40:43], s65 offen offset:2048 sc1
  v_add_u32 v204, v204, v28
  v_mfma_f32_16x16x32_bf16 a[72:75], a[232:235], a[184:187], a[72:75]
  v_add_u32 v11, s33, v2
  v_mfma_f32_16x16x32_bf16 a[88:91], a[236:239], a[184:187], a[88:91]
  ds_read_b128 v[80:83], v11 offset:0
  v_mfma_f32_16x16x32_bf16 a[104:107], a[240:243], a[184:187], a[104:107]
  buffer_load_dwordx4 v[120:123], v2, s[40:43], s14 offen offset:2048 sc1
  v_mfma_f32_16x16x32_bf16 a[120:123], a[244:247], a[184:187], a[120:123]
  s_add_u32 s33, s33, 32768
  ds_read_b128 v[84:87], v11 offset:1024
  v_add_u32 v204, 155648, v204
  v_mfma_f32_16x16x32_bf16 a[136:139], a[248:251], a[184:187], a[136:139]
  buffer_load_dwordx4 a[184:187], v2, s[40:43], s66 offen offset:2048 sc1
  v_mul_u32_u24 v29, 320, v29
  v_mfma_f32_16x16x32_bf16 a[76:79], a[232:235], a[188:191], a[76:79]
  s_and_b32 s33, s33, 0x1ffff
  v_mfma_f32_16x16x32_bf16 a[92:95], a[236:239], a[188:191], a[92:95]
  ds_read_b128 v[88:91], v11 offset:2048
  v_mfma_f32_16x16x32_bf16 a[108:111], a[240:243], a[188:191], a[108:111]
  ds_read_b128 v[92:95], v11 offset:3072
  v_mfma_f32_16x16x32_bf16 a[124:127], a[244:247], a[188:191], a[124:127]
  v_mfma_f32_16x16x32_bf16 a[140:143], a[248:251], a[188:191], a[140:143]
  s_waitcnt vmcnt(19)
  buffer_load_dwordx4 a[188:191], v2, s[40:43], s67 offen offset:2048 sc1
  v_mfma_f32_16x16x32_bf16 a[64:67], a[252:255], v[216:219], a[64:67]
  v_add_u32 v205, v205, v29
  v_mfma_f32_16x16x32_bf16 a[80:83], a[0:3], v[216:219], a[80:83]
  v_mfma_f32_16x16x32_bf16 a[96:99], a[4:7], v[216:219], a[96:99]
  buffer_load_dwordx4 v[124:127], v2, s[40:43], s14 offen offset:3072 sc1
  v_add_u32 v205, 155648, v205
  v_mfma_f32_16x16x32_bf16 a[112:115], a[8:11], v[216:219], a[112:115]
  v_mfma_f32_16x16x32_bf16 a[128:131], a[12:15], v[216:219], a[128:131]
  buffer_load_dwordx4 v[216:219], v2, s[40:43], s64 offen offset:3072 sc1
  v_mfma_f32_16x16x32_bf16 a[68:71], a[252:255], v[220:223], a[68:71]
  v_mfma_f32_16x16x32_bf16 a[84:87], a[0:3], v[220:223], a[84:87]
  v_mfma_f32_16x16x32_bf16 a[100:103], a[4:7], v[220:223], a[100:103]
  v_mfma_f32_16x16x32_bf16 a[116:119], a[8:11], v[220:223], a[116:119]
  s_waitcnt lgkmcnt(0)
  v_mfma_f32_16x16x32_bf16 a[132:135], a[12:15], v[220:223], a[132:135]
  s_waitcnt vmcnt(19)
  buffer_load_dwordx4 v[220:223], v2, s[40:43], s65 offen offset:3072 sc1
  v_mfma_f32_16x16x32_bf16 a[72:75], a[252:255], v[224:227], a[72:75]
  v_add_u32 v11, s34, v2
  v_mfma_f32_16x16x32_bf16 a[88:91], a[0:3], v[224:227], a[88:91]
  ds_read_b128 v[128:131], v11 offset:0
  v_mfma_f32_16x16x32_bf16 a[104:107], a[4:7], v[224:227], a[104:107]
  s_add_u32 s14, s13, 139264
  buffer_load_dwordx4 v[232:235], v2, s[40:43], s14 offen offset:0 sc1
  v_mfma_f32_16x16x32_bf16 a[120:123], a[8:11], v[224:227], a[120:123]
  s_add_u32 s34, s34, 32768
  ds_read_b128 v[132:135], v11 offset:1024
  v_mfma_f32_16x16x32_bf16 a[136:139], a[12:15], v[224:227], a[136:139]
  buffer_load_dwordx4 v[224:227], v2, s[40:43], s66 offen offset:3072 sc1
  v_mfma_f32_16x16x32_bf16 a[76:79], a[252:255], v[228:231], a[76:79]
  s_and_b32 s34, s34, 0x1ffff
  v_mfma_f32_16x16x32_bf16 a[92:95], a[0:3], v[228:231], a[92:95]
  ds_read_b128 v[136:139], v11 offset:2048
  v_mfma_f32_16x16x32_bf16 a[108:111], a[4:7], v[228:231], a[108:111]
  ds_read_b128 v[140:143], v11 offset:3072
  v_mfma_f32_16x16x32_bf16 a[124:127], a[8:11], v[228:231], a[124:127]
  v_mfma_f32_16x16x32_bf16 a[140:143], a[12:15], v[228:231], a[140:143]
  s_waitcnt vmcnt(19)
  buffer_load_dwordx4 v[228:231], v2, s[40:43], s67 offen offset:3072 sc1
  v_mfma_f32_16x16x32_bf16 a[64:67], a[16:19], a[144:147], a[64:67]
  s_add_u32 s62, s62, 4096
  v_mfma_f32_16x16x32_bf16 a[80:83], a[20:23], a[144:147], a[80:83]
  s_and_b32 s62, s62, 0x7fff
  v_mfma_f32_16x16x32_bf16 a[96:99], a[24:27], a[144:147], a[96:99]
  buffer_load_dwordx4 v[236:239], v2, s[40:43], s14 offen offset:1024 sc1
  v_mfma_f32_16x16x32_bf16 a[112:115], a[28:31], a[144:147], a[112:115]
  s_add_u32 s64, s63, s62
  v_mfma_f32_16x16x32_bf16 a[128:131], a[32:35], a[144:147], a[128:131]
  buffer_load_dwordx4 a[144:147], v2, s[40:43], s64 offen offset:0 sc1
  v_mfma_f32_16x16x32_bf16 a[68:71], a[16:19], a[148:151], a[68:71]
  s_add_u32 s65, s64, 131072
  v_mfma_f32_16x16x32_bf16 a[84:87], a[20:23], a[148:151], a[84:87]
  s_add_u32 s66, s64, 262144
  v_mfma_f32_16x16x32_bf16 a[100:103], a[24:27], a[148:151], a[100:103]
  v_mfma_f32_16x16x32_bf16 a[116:119], a[28:31], a[148:151], a[116:119]
  s_waitcnt lgkmcnt(0)
  v_mfma_f32_16x16x32_bf16 a[132:135], a[32:35], a[148:151], a[132:135]
  s_waitcnt vmcnt(19)
  buffer_load_dwordx4 a[148:151], v2, s[40:43], s65 offen offset:0 sc1
  v_mfma_f32_16x16x32_bf16 a[72:75], a[16:19], a[152:155], a[72:75]
  s_add_u32 s67, s64, 393216
  v_add_u32 v11, s35, v2
  v_mfma_f32_16x16x32_bf16 a[88:91], a[20:23], a[152:155], a[88:91]
  ds_read_b128 v[144:147], v11 offset:0
  v_mfma_f32_16x16x32_bf16 a[104:107], a[24:27], a[152:155], a[104:107]
  v_mfma_f32_16x16x32_bf16 a[120:123], a[28:31], a[152:155], a[120:123]
  ds_read_b128 v[148:151], v11 offset:1024
  v_mfma_f32_16x16x32_bf16 a[136:139], a[32:35], a[152:155], a[136:139]
  buffer_load_dwordx4 a[152:155], v2, s[40:43], s66 offen offset:0 sc1
  v_mfma_f32_16x16x32_bf16 a[76:79], a[16:19], a[156:159], a[76:79]
  v_mfma_f32_16x16x32_bf16 a[92:95], a[20:23], a[156:159], a[92:95]
  ds_read_b128 v[152:155], v11 offset:2048
  v_mfma_f32_16x16x32_bf16 a[108:111], a[24:27], a[156:159], a[108:111]
  ds_read_b128 v[156:159], v11 offset:3072
  v_mfma_f32_16x16x32_bf16 a[124:127], a[28:31], a[156:159], a[124:127]
  v_mfma_f32_16x16x32_bf16 a[140:143], a[32:35], a[156:159], a[140:143]
  s_waitcnt vmcnt(18)
  buffer_load_dwordx4 a[156:159], v2, s[40:43], s67 offen offset:0 sc1
  v_mfma_f32_16x16x32_bf16 a[64:67], a[36:39], a[160:163], a[64:67]
  v_mfma_f32_16x16x32_bf16 a[80:83], a[40:43], a[160:163], a[80:83]
  v_mfma_f32_16x16x32_bf16 a[96:99], a[44:47], a[160:163], a[96:99]
  buffer_load_dwordx4 v[240:243], v2, s[40:43], s14 offen offset:2048 sc1
  v_mfma_f32_16x16x32_bf16 a[112:115], a[48:51], a[160:163], a[112:115]
  v_mfma_f32_16x16x32_bf16 a[128:131], a[52:55], a[160:163], a[128:131]
  buffer_load_dwordx4 a[160:163], v2, s[40:43], s64 offen offset:1024 sc1
  v_mfma_f32_16x16x32_bf16 a[68:71], a[36:39], a[164:167], a[68:71]
  v_mfma_f32_16x16x32_bf16 a[84:87], a[40:43], a[164:167], a[84:87]
  v_mfma_f32_16x16x32_bf16 a[100:103], a[44:47], a[164:167], a[100:103]
  v_mfma_f32_16x16x32_bf16 a[116:119], a[48:51], a[164:167], a[116:119]
  s_waitcnt lgkmcnt(0)
  v_mfma_f32_16x16x32_bf16 a[132:135], a[52:55], a[164:167], a[132:135]
  s_waitcnt vmcnt(19)
  buffer_load_dwordx4 a[164:167], v2, s[40:43], s65 offen offset:1024 sc1
  v_mfma_f32_16x16x32_bf16 a[72:75], a[36:39], a[168:171], a[72:75]
  v_mfma_f32_16x16x32_bf16 a[88:91], a[40:43], a[168:171], a[88:91]
  v_mfma_f32_16x16x32_bf16 a[104:107], a[44:47], a[168:171], a[104:107]
  buffer_load_dwordx4 v[244:247], v2, s[40:43], s14 offen offset:3072 sc1
  v_mfma_f32_16x16x32_bf16 a[120:123], a[48:51], a[168:171], a[120:123]
  v_mfma_f32_16x16x32_bf16 a[136:139], a[52:55], a[168:171], a[136:139]
  buffer_load_dwordx4 a[168:171], v2, s[40:43], s66 offen offset:1024 sc1
  v_mfma_f32_16x16x32_bf16 a[76:79], a[36:39], a[172:175], a[76:79]
  v_mfma_f32_16x16x32_bf16 a[92:95], a[40:43], a[172:175], a[92:95]
  v_mfma_f32_16x16x32_bf16 a[108:111], a[44:47], a[172:175], a[108:111]
  v_mfma_f32_16x16x32_bf16 a[124:127], a[48:51], a[172:175], a[124:127]
  v_mfma_f32_16x16x32_bf16 a[140:143], a[52:55], a[172:175], a[140:143]
  s_waitcnt vmcnt(19)
  buffer_load_dwordx4 a[172:175], v2, s[40:43], s67 offen offset:1024 sc1
  v_mfma_f32_16x16x32_bf16 a[64:67], a[56:59], a[176:179], a[64:67]
  v_mfma_f32_16x16x32_bf16 a[80:83], a[60:63], a[176:179], a[80:83]
  v_mfma_f32_16x16x32_bf16 a[96:99], v[32:35], a[176:179], a[96:99]
  s_add_u32 s14, s13, 143360
  buffer_load_dwordx4 v[64:67], v2, s[40:43], s14 offen offset:0 sc1
  v_mfma_f32_16x16x32_bf16 a[112:115], v[36:39], a[176:179], a[112:115]
  v_mfma_f32_16x16x32_bf16 a[128:131], v[40:43], a[176:179], a[128:131]
  buffer_load_dwordx4 a[176:179], v2, s[40:43], s64 offen offset:2048 sc1
  v_mfma_f32_16x16x32_bf16 a[68:71], a[56:59], a[180:183], a[68:71]
  v_mfma_f32_16x16x32_bf16 a[84:87], a[60:63], a[180:183], a[84:87]
  v_mfma_f32_16x16x32_bf16 a[100:103], v[32:35], a[180:183], a[100:103]
  v_mfma_f32_16x16x32_bf16 a[116:119], v[36:39], a[180:183], a[116:119]
  s_waitcnt lgkmcnt(0)
  v_mfma_f32_16x16x32_bf16 a[132:135], v[40:43], a[180:183], a[132:135]
  s_waitcnt vmcnt(19)
  buffer_load_dwordx4 a[180:183], v2, s[40:43], s65 offen offset:2048 sc1
  v_mfma_f32_16x16x32_bf16 a[72:75], a[56:59], a[184:187], a[72:75]
  v_mfma_f32_16x16x32_bf16 a[88:91], a[60:63], a[184:187], a[88:91]
  v_mfma_f32_16x16x32_bf16 a[104:107], v[32:35], a[184:187], a[104:107]
  buffer_load_dwordx4 v[68:71], v2, s[40:43], s14 offen offset:1024 sc1
  v_mfma_f32_16x16x32_bf16 a[120:123], v[36:39], a[184:187], a[120:123]
  v_mfma_f32_16x16x32_bf16 a[136:139], v[40:43], a[184:187], a[136:139]
  buffer_load_dwordx4 a[184:187], v2, s[40:43], s66 offen offset:2048 sc1
  v_mfma_f32_16x16x32_bf16 a[76:79], a[56:59], a[188:191], a[76:79]
  v_mfma_f32_16x16x32_bf16 a[92:95], a[60:63], a[188:191], a[92:95]
  v_mfma_f32_16x16x32_bf16 a[108:111], v[32:35], a[188:191], a[108:111]
  v_mfma_f32_16x16x32_bf16 a[124:127], v[36:39], a[188:191], a[124:127]
  v_mfma_f32_16x16x32_bf16 a[140:143], v[40:43], a[188:191], a[140:143]
  s_waitcnt vmcnt(19)
  buffer_load_dwordx4 a[188:191], v2, s[40:43], s67 offen offset:2048 sc1
  v_mfma_f32_16x16x32_bf16 a[64:67], v[44:47], v[216:219], a[64:67]
  v_mfma_f32_16x16x32_bf16 a[80:83], v[48:51], v[216:219], a[80:83]
  v_mfma_f32_16x16x32_bf16 a[96:99], v[52:55], v[216:219], a[96:99]
  buffer_load_dwordx4 v[72:75], v2, s[40:43], s14 offen offset:2048 sc1
  v_mfma_f32_16x16x32_bf16 a[112:115], v[56:59], v[216:219], a[112:115]
  v_mfma_f32_16x16x32_bf16 a[128:131], v[60:63], v[216:219], a[128:131]
  buffer_load_dwordx4 v[216:219], v2, s[40:43], s64 offen offset:3072 sc1
  v_mfma_f32_16x16x32_bf16 a[68:71], v[44:47], v[220:223], a[68:71]
  v_mfma_f32_16x16x32_bf16 a[84:87], v[48:51], v[220:223], a[84:87]
  v_mfma_f32_16x16x32_bf16 a[100:103], v[52:55], v[220:223], a[100:103]
  v_mfma_f32_16x16x32_bf16 a[116:119], v[56:59], v[220:223], a[116:119]
  s_barrier
  v_mfma_f32_16x16x32_bf16 a[132:135], v[60:63], v[220:223], a[132:135]
  s_waitcnt vmcnt(19)
  buffer_load_dwordx4 v[220:223], v2, s[40:43], s65 offen offset:3072 sc1
  v_mfma_f32_16x16x32_bf16 a[72:75], v[44:47], v[224:227], a[72:75]
  v_mfma_f32_16x16x32_bf16 a[88:91], v[48:51], v[224:227], a[88:91]
  v_mfma_f32_16x16x32_bf16 a[104:107], v[52:55], v[224:227], a[104:107]
  v_mfma_f32_16x16x32_bf16 a[120:123], v[56:59], v[224:227], a[120:123]
  v_mfma_f32_16x16x32_bf16 a[136:139], v[60:63], v[224:227], a[136:139]
  buffer_load_dwordx4 v[224:227], v2, s[40:43], s66 offen offset:3072 sc1
  v_mfma_f32_16x16x32_bf16 a[76:79], v[44:47], v[228:231], a[76:79]
  v_mfma_f32_16x16x32_bf16 a[92:95], v[48:51], v[228:231], a[92:95]
  v_mfma_f32_16x16x32_bf16 a[108:111], v[52:55], v[228:231], a[108:111]
  v_mfma_f32_16x16x32_bf16 a[124:127], v[56:59], v[228:231], a[124:127]
  v_mfma_f32_16x16x32_bf16 a[140:143], v[60:63], v[228:231], a[140:143]
  s_waitcnt vmcnt(18)
  buffer_load_dwordx4 v[228:231], v2, s[40:43], s67 offen offset:3072 sc1
  v_mfma_f32_16x16x32_bf16 a[64:67], v[96:99], a[144:147], a[64:67]
  s_add_u32 s62, s62, 4096
  v_mfma_f32_16x16x32_bf16 a[80:83], v[100:103], a[144:147], a[80:83]
  s_and_b32 s62, s62, 0x7fff
  v_mfma_f32_16x16x32_bf16 a[96:99], v[104:107], a[144:147], a[96:99]
  buffer_load_dwordx4 v[76:79], v2, s[40:43], s14 offen offset:3072 sc1
  v_mfma_f32_16x16x32_bf16 a[112:115], v[108:111], a[144:147], a[112:115]
  s_add_u32 s64, s63, s62
  v_mfma_f32_16x16x32_bf16 a[128:131], v[112:115], a[144:147], a[128:131]
  buffer_load_dwordx4 a[144:147], v2, s[40:43], s64 offen offset:0 sc1
  v_mfma_f32_16x16x32_bf16 a[68:71], v[96:99], a[148:151], a[68:71]
  s_add_u32 s65, s64, 131072
  v_mfma_f32_16x16x32_bf16 a[84:87], v[100:103], a[148:151], a[84:87]
  s_add_u32 s66, s64, 262144
  v_mfma_f32_16x16x32_bf16 a[100:103], v[104:107], a[148:151], a[100:103]
  v_mfma_f32_16x16x32_bf16 a[116:119], v[108:111], a[148:151], a[116:119]
  v_mfma_f32_16x16x32_bf16 a[132:135], v[112:115], a[148:151], a[132:135]
  s_waitcnt vmcnt(19)
  buffer_load_dwordx4 a[148:151], v2, s[40:43], s65 offen offset:0 sc1
  v_mfma_f32_16x16x32_bf16 a[72:75], v[96:99], a[152:155], a[72:75]
  s_add_u32 s67, s64, 393216
  v_mfma_f32_16x16x32_bf16 a[88:91], v[100:103], a[152:155], a[88:91]
  v_mfma_f32_16x16x32_bf16 a[104:107], v[104:107], a[152:155], a[104:107]
  s_add_u32 s14, s13, 159744
  buffer_load_dwordx4 v[176:179], v2, s[40:43], s14 offen offset:0 sc1
  v_mfma_f32_16x16x32_bf16 a[120:123], v[108:111], a[152:155], a[120:123]
  v_mfma_f32_16x16x32_bf16 a[136:139], v[112:115], a[152:155], a[136:139]
  buffer_load_dwordx4 a[152:155], v2, s[40:43], s66 offen offset:0 sc1
  v_mfma_f32_16x16x32_bf16 a[76:79], v[96:99], a[156:159], a[76:79]
  v_mfma_f32_16x16x32_bf16 a[92:95], v[100:103], a[156:159], a[92:95]
  v_mfma_f32_16x16x32_bf16 a[108:111], v[104:107], a[156:159], a[108:111]
  v_mfma_f32_16x16x32_bf16 a[124:127], v[108:111], a[156:159], a[124:127]
  v_mfma_f32_16x16x32_bf16 a[140:143], v[112:115], a[156:159], a[140:143]
  s_waitcnt vmcnt(19)
  buffer_load_dwordx4 a[156:159], v2, s[40:43], s67 offen offset:0 sc1
  v_mfma_f32_16x16x32_bf16 a[64:67], v[116:119], a[160:163], a[64:67]
  v_mfma_f32_16x16x32_bf16 a[80:83], v[120:123], a[160:163], a[80:83]
  v_mfma_f32_16x16x32_bf16 a[96:99], v[124:127], a[160:163], a[96:99]
  buffer_load_dwordx4 v[180:183], v2, s[40:43], s14 offen offset:1024 sc1
  v_mfma_f32_16x16x32_bf16 a[112:115], v[160:163], a[160:163], a[112:115]
  v_mfma_f32_16x16x32_bf16 a[128:131], v[164:167], a[160:163], a[128:131]
  buffer_load_dwordx4 a[160:163], v2, s[40:43], s64 offen offset:1024 sc1
  v_mfma_f32_16x16x32_bf16 a[68:71], v[116:119], a[164:167], a[68:71]
  v_mfma_f32_16x16x32_bf16 a[84:87], v[120:123], a[164:167], a[84:87]
  v_mfma_f32_16x16x32_bf16 a[100:103], v[124:127], a[164:167], a[100:103]
  v_mfma_f32_16x16x32_bf16 a[116:119], v[160:163], a[164:167], a[116:119]
  v_mfma_f32_16x16x32_bf16 a[132:135], v[164:167], a[164:167], a[132:135]
  s_waitcnt vmcnt(19)
  buffer_load_dwordx4 a[164:167], v2, s[40:43], s65 offen offset:1024 sc1
  v_mfma_f32_16x16x32_bf16 a[72:75], v[116:119], a[168:171], a[72:75]
  v_mfma_f32_16x16x32_bf16 a[88:91], v[120:123], a[168:171], a[88:91]
  v_mfma_f32_16x16x32_bf16 a[104:107], v[124:127], a[168:171], a[104:107]
  buffer_load_dwordx4 v[184:187], v2, s[40:43], s14 offen offset:2048 sc1
  v_mfma_f32_16x16x32_bf16 a[120:123], v[160:163], a[168:171], a[120:123]
  v_mfma_f32_16x16x32_bf16 a[136:139], v[164:167], a[168:171], a[136:139]
  buffer_load_dwordx4 a[168:171], v2, s[40:43], s66 offen offset:1024 sc1
  v_mfma_f32_16x16x32_bf16 a[76:79], v[116:119], a[172:175], a[76:79]
  v_mfma_f32_16x16x32_bf16 a[92:95], v[120:123], a[172:175], a[92:95]
  v_mfma_f32_16x16x32_bf16 a[108:111], v[124:127], a[172:175], a[108:111]
  v_mfma_f32_16x16x32_bf16 a[124:127], v[160:163], a[172:175], a[124:127]
  v_mfma_f32_16x16x32_bf16 a[140:143], v[164:167], a[172:175], a[140:143]
  s_waitcnt vmcnt(19)
  buffer_load_dwordx4 a[172:175], v2, s[40:43], s67 offen offset:1024 sc1
  v_mfma_f32_16x16x32_bf16 a[64:67], v[168:171], a[176:179], a[64:67]
  v_mfma_f32_16x16x32_bf16 a[80:83], v[172:175], a[176:179], a[80:83]
  buffer_load_dwordx4 v[32:35], v248, s[44:47], 0 offen
  v_mfma_f32_16x16x32_bf16 a[96:99], v[192:195], a[176:179], a[96:99]
  buffer_load_dwordx4 v[188:191], v2, s[40:43], s14 offen offset:3072 sc1
  v_mfma_f32_16x16x32_bf16 a[112:115], v[196:199], a[176:179], a[112:115]
  v_mfma_f32_16x16x32_bf16 a[128:131], v[208:211], a[176:179], a[128:131]
  buffer_load_dwordx4 a[176:179], v2, s[40:43], s64 offen offset:2048 sc1
  v_mfma_f32_16x16x32_bf16 a[68:71], v[168:171], a[180:183], a[68:71]
  v_mfma_f32_16x16x32_bf16 a[84:87], v[172:175], a[180:183], a[84:87]
  v_mfma_f32_16x16x32_bf16 a[100:103], v[192:195], a[180:183], a[100:103]
  v_mfma_f32_16x16x32_bf16 a[116:119], v[196:199], a[180:183], a[116:119]
  v_mfma_f32_16x16x32_bf16 a[132:135], v[208:211], a[180:183], a[132:135]
  s_waitcnt vmcnt(20)
  buffer_load_dwordx4 a[180:183], v2, s[40:43], s65 offen offset:2048 sc1
  v_mfma_f32_16x16x32_bf16 a[72:75], v[168:171], a[184:187], a[72:75]
  v_mfma_f32_16x16x32_bf16 a[88:91], v[172:175], a[184:187], a[88:91]
  buffer_load_dwordx4 v[44:47], v200, s[40:43], s27 offen sc1
  v_mfma_f32_16x16x32_bf16 a[104:107], v[192:195], a[184:187], a[104:107]
  v_mfma_f32_16x16x32_bf16 a[120:123], v[196:199], a[184:187], a[120:123]
  v_mfma_f32_16x16x32_bf16 a[136:139], v[208:211], a[184:187], a[136:139]
  buffer_load_dwordx4 a[184:187], v2, s[40:43], s66 offen offset:2048 sc1
  v_mfma_f32_16x16x32_bf16 a[76:79], v[168:171], a[188:191], a[76:79]
  v_mfma_f32_16x16x32_bf16 a[92:95], v[172:175], a[188:191], a[92:95]
  v_mfma_f32_16x16x32_bf16 a[108:111], v[192:195], a[188:191], a[108:111]
  v_mfma_f32_16x16x32_bf16 a[124:127], v[196:199], a[188:191], a[124:127]
  v_mfma_f32_16x16x32_bf16 a[140:143], v[208:211], a[188:191], a[140:143]
  s_waitcnt vmcnt(20)
  buffer_load_dwordx4 a[188:191], v2, s[40:43], s67 offen offset:2048 sc1
  v_mfma_f32_16x16x32_bf16 a[64:67], v[212:215], v[216:219], a[64:67]
  ds_read_b128 v[120:123], v203 offset:0
  v_mfma_f32_16x16x32_bf16 a[80:83], v[232:235], v[216:219], a[80:83]
  buffer_load_dwordx4 v[36:39], v249, s[44:47], 0 offen
  v_mfma_f32_16x16x32_bf16 a[96:99], v[236:239], v[216:219], a[96:99]
  v_add_u32 v20, 43008, v251
  v_mfma_f32_16x16x32_bf16 a[112:115], v[240:243], v[216:219], a[112:115]
  ds_read_b128 v[124:127], v203 offset:16
  v_mfma_f32_16x16x32_bf16 a[128:131], v[244:247], v[216:219], a[128:131]
  buffer_load_dwordx4 v[216:219], v2, s[40:43], s64 offen offset:3072 sc1
  v_mfma_f32_16x16x32_bf16 a[68:71], v[212:215], v[220:223], a[68:71]
  ds_read_b128 v[160:163], v204 offset:0
  v_mfma_f32_16x16x32_bf16 a[84:87], v[232:235], v[220:223], a[84:87]
  ds_read_b128 v[164:167], v204 offset:16
  v_add_u32 v21, 43008, v252
  v_mfma_f32_16x16x32_bf16 a[100:103], v[236:239], v[220:223], a[100:103]
  v_mfma_f32_16x16x32_bf16 a[116:119], v[240:243], v[220:223], a[116:119]
  ds_read_b128 v[168:171], v205 offset:0
  v_mfma_f32_16x16x32_bf16 a[132:135], v[244:247], v[220:223], a[132:135]
  s_waitcnt vmcnt(21)
  buffer_load_dwordx4 v[220:223], v2, s[40:43], s65 offen offset:3072 sc1
  v_mfma_f32_16x16x32_bf16 a[72:75], v[212:215], v[224:227], a[72:75]
  ds_read_b128 v[172:175], v205 offset:16
  v_add_u32 v22, 43008, v253
  v_mfma_f32_16x16x32_bf16 a[88:91], v[232:235], v[224:227], a[88:91]
  buffer_load_dwordx4 v[48:51], v201, s[40:43], s27 offen sc1
  v_mfma_f32_16x16x32_bf16 a[104:107], v[236:239], v[224:227], a[104:107]
  v_mfma_f32_16x16x32_bf16 a[120:123], v[240:243], v[224:227], a[120:123]
  v_mfma_f32_16x16x32_bf16 a[136:139], v[244:247], v[224:227], a[136:139]
  s_mul_i32 s23, s20, 21504
  buffer_load_dwordx4 v[224:227], v2, s[40:43], s66 offen offset:3072 sc1
  v_and_b32 v16, 15, v1
  v_mul_u32_u24 v16, 336, v16
  v_mfma_f32_16x16x32_bf16 a[76:79], v[212:215], v[228:231], a[76:79]
  v_lshrrev_b32 v17, 4, v1
  v_lshl_add_u32 v16, v17, 4, v16
  v_mfma_f32_16x16x32_bf16 a[92:95], v[232:235], v[228:231], a[92:95]
  v_add_u32 v16, s23, v16
  v_mfma_f32_16x16x32_bf16 a[108:111], v[236:239], v[228:231], a[108:111]
  v_mfma_f32_16x16x32_bf16 a[124:127], v[240:243], v[228:231], a[124:127]
  s_waitcnt lgkmcnt(0)
  v_mfma_f32_16x16x32_bf16 a[140:143], v[244:247], v[228:231], a[140:143]
  s_waitcnt vmcnt(21)
  buffer_load_dwordx4 v[228:231], v2, s[40:43], s67 offen offset:3072 sc1
  v_mfma_f32_16x16x32_bf16 a[64:67], v[64:67], a[144:147], a[64:67]
  v_mfma_f32_16x16x32_bf16 a[80:83], v[68:71], a[144:147], a[80:83]
  buffer_load_dwordx4 v[40:43], v250, s[44:47], 0 offen
  v_mfma_f32_16x16x32_bf16 a[96:99], v[72:75], a[144:147], a[96:99]
  v_mfma_f32_16x16x32_bf16 a[112:115], v[76:79], a[144:147], a[112:115]
  v_mfma_f32_16x16x32_bf16 a[128:131], v[80:83], a[144:147], a[128:131]
  v_mfma_f32_16x16x32_bf16 a[68:71], v[64:67], a[148:151], a[68:71]
  v_mfma_f32_16x16x32_bf16 a[84:87], v[68:71], a[148:151], a[84:87]
  v_mfma_f32_16x16x32_bf16 a[100:103], v[72:75], a[148:151], a[100:103]
  v_mfma_f32_16x16x32_bf16 a[116:119], v[76:79], a[148:151], a[116:119]
  v_mfma_f32_16x16x32_bf16 a[132:135], v[80:83], a[148:151], a[132:135]
  s_waitcnt vmcnt(20)
  v_mfma_f32_16x16x32_bf16 a[72:75], v[64:67], a[152:155], a[72:75]
  v_mfma_f32_16x16x32_bf16 a[88:91], v[68:71], a[152:155], a[88:91]
  buffer_load_dwordx4 v[52:55], v202, s[40:43], s27 offen sc1
  v_mfma_f32_16x16x32_bf16 a[104:107], v[72:75], a[152:155], a[104:107]
  v_mfma_f32_16x16x32_bf16 a[120:123], v[76:79], a[152:155], a[120:123]
  v_mfma_f32_16x16x32_bf16 a[136:139], v[80:83], a[152:155], a[136:139]
  v_mfma_f32_16x16x32_bf16 a[76:79], v[64:67], a[156:159], a[76:79]
  v_mfma_f32_16x16x32_bf16 a[92:95], v[68:71], a[156:159], a[92:95]
  v_mfma_f32_16x16x32_bf16 a[108:111], v[72:75], a[156:159], a[108:111]
  v_mfma_f32_16x16x32_bf16 a[124:127], v[76:79], a[156:159], a[124:127]
  v_mfma_f32_16x16x32_bf16 a[140:143], v[80:83], a[156:159], a[140:143]
  s_waitcnt vmcnt(10)
  v_mfma_f32_16x16x32_bf16 a[64:67], v[84:87], a[160:163], a[64:67]
  v_lshlrev_b32 v18, 16, v44
  v_and_b32 v19, 0xffff0000, v44
  v_mfma_f32_16x16x32_bf16 a[80:83], v[88:91], a[160:163], a[80:83]
  v_add_f32 v120, v120, v18
  v_add_f32 v121, v121, v19
  v_mfma_f32_16x16x32_bf16 a[96:99], v[92:95], a[160:163], a[96:99]
  v_cvt_pk_bf16_f32 v18, v120, v121
  v_lshlrev_b32 v96, 16, v32
  v_mfma_f32_16x16x32_bf16 a[112:115], v[128:131], a[160:163], a[112:115]
  v_and_b32 v97, 0xffff0000, v32
  v_lshlrev_b32 v120, 16, v18
  v_mfma_f32_16x16x32_bf16 a[128:131], v[132:135], a[160:163], a[128:131]
  v_and_b32 v121, 0xffff0000, v18
  v_lshlrev_b32 v18, 16, v45
  v_mfma_f32_16x16x32_bf16 a[68:71], v[84:87], a[164:167], a[68:71]
  v_and_b32 v19, 0xffff0000, v45
  v_add_f32 v122, v122, v18
  v_mfma_f32_16x16x32_bf16 a[84:87], v[88:91], a[164:167], a[84:87]
  v_add_f32 v123, v123, v19
  v_cvt_pk_bf16_f32 v18, v122, v123
  v_mfma_f32_16x16x32_bf16 a[100:103], v[92:95], a[164:167], a[100:103]
  v_lshlrev_b32 v98, 16, v33
  v_and_b32 v99, 0xffff0000, v33
  v_mfma_f32_16x16x32_bf16 a[116:119], v[128:131], a[164:167], a[116:119]
  v_lshlrev_b32 v122, 16, v18
  v_and_b32 v123, 0xffff0000, v18
  v_mfma_f32_16x16x32_bf16 a[132:135], v[132:135], a[164:167], a[132:135]
  s_waitcnt vmcnt(15)
  v_lshlrev_b32 v18, 16, v46
  v_and_b32 v19, 0xffff0000, v46
  v_mfma_f32_16x16x32_bf16 a[72:75], v[84:87], a[168:171], a[72:75]
  v_add_f32 v124, v124, v18
  v_add_f32 v125, v125, v19
  v_mfma_f32_16x16x32_bf16 a[88:91], v[88:91], a[168:171], a[88:91]
  v_cvt_pk_bf16_f32 v18, v124, v125
  v_lshlrev_b32 v100, 16, v34
  v_mfma_f32_16x16x32_bf16 a[104:107], v[92:95], a[168:171], a[104:107]
  v_and_b32 v101, 0xffff0000, v34
  v_lshlrev_b32 v124, 16, v18
  v_mfma_f32_16x16x32_bf16 a[120:123], v[128:131], a[168:171], a[120:123]
  v_and_b32 v125, 0xffff0000, v18
  v_lshlrev_b32 v18, 16, v47
  v_mfma_f32_16x16x32_bf16 a[136:139], v[132:135], a[168:171], a[136:139]
  v_and_b32 v19, 0xffff0000, v47
  v_add_f32 v126, v126, v18
  v_mfma_f32_16x16x32_bf16 a[76:79], v[84:87], a[172:175], a[76:79]
  v_add_f32 v127, v127, v19
  v_cvt_pk_bf16_f32 v18, v126, v127
  v_mfma_f32_16x16x32_bf16 a[92:95], v[88:91], a[172:175], a[92:95]
  v_lshlrev_b32 v102, 16, v35
  v_and_b32 v103, 0xffff0000, v35
  v_mfma_f32_16x16x32_bf16 a[108:111], v[92:95], a[172:175], a[108:111]
  v_lshlrev_b32 v126, 16, v18
  v_and_b32 v127, 0xffff0000, v18
  v_mfma_f32_16x16x32_bf16 a[124:127], v[128:131], a[172:175], a[124:127]
  v_mfma_f32_16x16x32_bf16 a[140:143], v[132:135], a[172:175], a[140:143]
  s_waitcnt vmcnt(4)
  v_mfma_f32_16x16x32_bf16 a[64:67], v[136:139], a[176:179], a[64:67]
  v_lshlrev_b32 v18, 16, v48
  v_and_b32 v19, 0xffff0000, v48
  v_mfma_f32_16x16x32_bf16 a[80:83], v[140:143], a[176:179], a[80:83]
  v_add_f32 v160, v160, v18
  v_add_f32 v161, v161, v19
  v_mfma_f32_16x16x32_bf16 a[96:99], v[144:147], a[176:179], a[96:99]
  v_cvt_pk_bf16_f32 v18, v160, v161
  v_lshlrev_b32 v104, 16, v36
  v_mfma_f32_16x16x32_bf16 a[112:115], v[148:151], a[176:179], a[112:115]
  v_and_b32 v105, 0xffff0000, v36
  v_lshlrev_b32 v160, 16, v18
  v_mfma_f32_16x16x32_bf16 a[128:131], v[152:155], a[176:179], a[128:131]
  v_and_b32 v161, 0xffff0000, v18
  v_lshlrev_b32 v18, 16, v49
  v_mfma_f32_16x16x32_bf16 a[68:71], v[136:139], a[180:183], a[68:71]
  v_and_b32 v19, 0xffff0000, v49
  v_add_f32 v162, v162, v18
  v_mfma_f32_16x16x32_bf16 a[84:87], v[140:143], a[180:183], a[84:87]
  v_add_f32 v163, v163, v19
  v_cvt_pk_bf16_f32 v18, v162, v163
  v_mfma_f32_16x16x32_bf16 a[100:103], v[144:147], a[180:183], a[100:103]
  v_lshlrev_b32 v106, 16, v37
  v_and_b32 v107, 0xffff0000, v37
  v_mfma_f32_16x16x32_bf16 a[116:119], v[148:151], a[180:183], a[116:119]
  v_lshlrev_b32 v162, 16, v18
  v_and_b32 v163, 0xffff0000, v18
  v_mfma_f32_16x16x32_bf16 a[132:135], v[152:155], a[180:183], a[132:135]
  s_waitcnt vmcnt(8)
  v_lshlrev_b32 v18, 16, v50
  v_and_b32 v19, 0xffff0000, v50
  v_mfma_f32_16x16x32_bf16 a[72:75], v[136:139], a[184:187], a[72:75]
  v_add_f32 v164, v164, v18
  v_add_f32 v165, v165, v19
  v_mfma_f32_16x16x32_bf16 a[88:91], v[140:143], a[184:187], a[88:91]
  v_cvt_pk_bf16_f32 v18, v164, v165
  v_lshlrev_b32 v108, 16, v38
  v_mfma_f32_16x16x32_bf16 a[104:107], v[144:147], a[184:187], a[104:107]
  v_and_b32 v109, 0xffff0000, v38
  v_lshlrev_b32 v164, 16, v18
  v_mfma_f32_16x16x32_bf16 a[120:123], v[148:151], a[184:187], a[120:123]
  v_and_b32 v165, 0xffff0000, v18
  v_lshlrev_b32 v18, 16, v51
  v_mfma_f32_16x16x32_bf16 a[136:139], v[152:155], a[184:187], a[136:139]
  v_and_b32 v19, 0xffff0000, v51
  v_add_f32 v166, v166, v18
  v_mfma_f32_16x16x32_bf16 a[76:79], v[136:139], a[188:191], a[76:79]
  v_add_f32 v167, v167, v19
  v_cvt_pk_bf16_f32 v18, v166, v167
  v_mfma_f32_16x16x32_bf16 a[92:95], v[140:143], a[188:191], a[92:95]
  v_lshlrev_b32 v110, 16, v39
  v_and_b32 v111, 0xffff0000, v39
  v_mfma_f32_16x16x32_bf16 a[108:111], v[144:147], a[188:191], a[108:111]
  v_lshlrev_b32 v166, 16, v18
  v_and_b32 v167, 0xffff0000, v18
  v_mfma_f32_16x16x32_bf16 a[124:127], v[148:151], a[188:191], a[124:127]
  v_mfma_f32_16x16x32_bf16 a[140:143], v[152:155], a[188:191], a[140:143]
  s_waitcnt vmcnt(0)
  v_mfma_f32_16x16x32_bf16 a[64:67], v[156:159], v[216:219], a[64:67]
  v_lshlrev_b32 v18, 16, v52
  v_and_b32 v19, 0xffff0000, v52
  v_mfma_f32_16x16x32_bf16 a[80:83], v[176:179], v[216:219], a[80:83]
  v_add_f32 v168, v168, v18
  v_add_f32 v169, v169, v19
  v_mfma_f32_16x16x32_bf16 a[96:99], v[180:183], v[216:219], a[96:99]
  v_cvt_pk_bf16_f32 v18, v168, v169
  v_lshlrev_b32 v112, 16, v40
  v_mfma_f32_16x16x32_bf16 a[112:115], v[184:187], v[216:219], a[112:115]
  v_and_b32 v113, 0xffff0000, v40
  v_lshlrev_b32 v168, 16, v18
  v_mfma_f32_16x16x32_bf16 a[128:131], v[188:191], v[216:219], a[128:131]
  v_and_b32 v169, 0xffff0000, v18
  v_lshlrev_b32 v18, 16, v53
  v_mfma_f32_16x16x32_bf16 a[68:71], v[156:159], v[220:223], a[68:71]
  v_and_b32 v19, 0xffff0000, v53
  v_add_f32 v170, v170, v18
  v_mfma_f32_16x16x32_bf16 a[84:87], v[176:179], v[220:223], a[84:87]
  v_add_f32 v171, v171, v19
  v_cvt_pk_bf16_f32 v18, v170, v171
  v_mfma_f32_16x16x32_bf16 a[100:103], v[180:183], v[220:223], a[100:103]
  v_lshlrev_b32 v114, 16, v41
  v_and_b32 v115, 0xffff0000, v41
  v_mfma_f32_16x16x32_bf16 a[116:119], v[184:187], v[220:223], a[116:119]
  v_lshlrev_b32 v170, 16, v18
  v_and_b32 v171, 0xffff0000, v18
  v_mfma_f32_16x16x32_bf16 a[132:135], v[188:191], v[220:223], a[132:135]
  s_waitcnt vmcnt(2)
  ds_write_b128 v16, a[64:67] offset:0
  v_lshlrev_b32 v18, 16, v54
  v_and_b32 v19, 0xffff0000, v54
  v_mfma_f32_16x16x32_bf16 a[72:75], v[156:159], v[224:227], a[72:75]
  ds_write_b128 v16, a[80:83] offset:64
  v_add_f32 v172, v172, v18
  v_add_f32 v173, v173, v19
  v_mfma_f32_16x16x32_bf16 a[88:91], v[176:179], v[224:227], a[88:91]
  ds_write_b128 v16, a[96:99] offset:128
  v_cvt_pk_bf16_f32 v18, v172, v173
  v_lshlrev_b32 v116, 16, v42
  v_mfma_f32_16x16x32_bf16 a[104:107], v[180:183], v[224:227], a[104:107]
  ds_write_b128 v16, a[112:115] offset:192
  v_and_b32 v117, 0xffff0000, v42
  v_lshlrev_b32 v172, 16, v18
  v_mfma_f32_16x16x32_bf16 a[120:123], v[184:187], v[224:227], a[120:123]
  ds_write_b128 v16, a[128:131] offset:256
  v_and_b32 v173, 0xffff0000, v18
  v_lshlrev_b32 v18, 16, v55
  v_mfma_f32_16x16x32_bf16 a[136:139], v[188:191], v[224:227], a[136:139]
  ds_write_b128 v16, a[68:71] offset:5376
  v_and_b32 v19, 0xffff0000, v55
  v_add_f32 v174, v174, v18
  v_mfma_f32_16x16x32_bf16 a[76:79], v[156:159], v[228:231], a[76:79]
  ds_write_b128 v16, a[84:87] offset:5440
  v_add_f32 v175, v175, v19
  v_cvt_pk_bf16_f32 v18, v174, v175
  v_mfma_f32_16x16x32_bf16 a[92:95], v[176:179], v[228:231], a[92:95]
  ds_write_b128 v16, a[100:103] offset:5504
  v_lshlrev_b32 v118, 16, v43
  v_and_b32 v119, 0xffff0000, v43
  v_mfma_f32_16x16x32_bf16 a[108:111], v[180:183], v[228:231], a[108:111]
  ds_write_b128 v16, a[116:119] offset:5568
  v_lshlrev_b32 v174, 16, v18
  v_and_b32 v175, 0xffff0000, v18
  v_mfma_f32_16x16x32_bf16 a[124:127], v[184:187], v[228:231], a[124:127]
  ds_write_b128 v16, a[132:135] offset:5632
  v_mfma_f32_16x16x32_bf16 a[140:143], v[188:191], v[228:231], a[140:143]
  ds_write_b128 v16, a[72:75] offset:10752
  ds_write_b128 v16, a[88:91] offset:10816
  ds_write_b128 v16, a[104:107] offset:10880
  ds_write_b128 v16, a[120:123] offset:10944
  ds_write_b128 v16, a[136:139] offset:11008
  ds_write_b128 v16, a[76:79] offset:16128
  ds_write_b128 v16, a[92:95] offset:16192
  ds_write_b128 v16, a[108:111] offset:16256
  ds_write_b128 v16, a[124:127] offset:16320
  ds_write_b128 v16, a[140:143] offset:16384
  s_waitcnt lgkmcnt(0)
  s_barrier
  ds_read_b128 v[32:35], v251 offset:0
  ds_read_b128 v[36:39], v251 offset:16
  ds_read_b128 v[40:43], v251 offset:21504
  ds_read_b128 v[44:47], v251 offset:21520
  ds_read_b128 v[48:51], v20 offset:0
  ds_read_b128 v[52:55], v20 offset:16
  ds_read_b128 v[56:59], v20 offset:21504
  ds_read_b128 v[60:63], v20 offset:21520
  ds_read_b128 v[64:67], v252 offset:0
  ds_read_b128 v[68:71], v252 offset:16
  ds_read_b128 v[72:75], v252 offset:21504
  ds_read_b128 v[76:79], v252 offset:21520
  ds_read_b128 v[80:83], v21 offset:0
  ds_read_b128 v[84:87], v21 offset:16
  ds_read_b128 v[88:91], v21 offset:21504
  ds_read_b128 v[92:95], v21 offset:21520
  ds_read_b128 v[128:131], v253 offset:0
  ds_read_b128 v[132:135], v253 offset:16
  ds_read_b128 v[136:139], v253 offset:21504
  ds_read_b128 v[140:143], v253 offset:21520
  ds_read_b128 v[144:147], v22 offset:0
  ds_read_b128 v[148:151], v22 offset:16
  ds_read_b128 v[152:155], v22 offset:21504
  ds_read_b128 v[156:159], v22 offset:21520
  s_waitcnt lgkmcnt(15)
  v_pk_add_f32 v[32:33], v[32:33], v[40:41]
  v_pk_add_f32 v[48:49], v[48:49], v[56:57]
  v_pk_add_f32 v[34:35], v[34:35], v[42:43]
  v_pk_add_f32 v[50:51], v[50:51], v[58:59]
  v_pk_add_f32 v[36:37], v[36:37], v[44:45]
  v_pk_add_f32 v[52:53], v[52:53], v[60:61]
  v_pk_add_f32 v[38:39], v[38:39], v[46:47]
  v_pk_add_f32 v[54:55], v[54:55], v[62:63]
  v_pk_add_f32 v[32:33], v[32:33], v[48:49]
  v_pk_add_f32 v[34:35], v[34:35], v[50:51]
  v_pk_add_f32 v[36:37], v[36:37], v[52:53]
  v_pk_add_f32 v[38:39], v[38:39], v[54:55]
  v_cvt_pk_bf16_f32 v40, v32, v33
  v_cvt_pk_bf16_f32 v41, v34, v35
  v_cvt_pk_bf16_f32 v42, v36, v37
  v_cvt_pk_bf16_f32 v43, v38, v39
  v_lshlrev_b32 v32, 16, v40
  v_and_b32 v33, 0xffff0000, v40
  v_lshlrev_b32 v34, 16, v41
  v_and_b32 v35, 0xffff0000, v41
  v_lshlrev_b32 v36, 16, v42
  v_and_b32 v37, 0xffff0000, v42
  v_lshlrev_b32 v38, 16, v43
  v_and_b32 v39, 0xffff0000, v43
  v_pk_add_f32 v[32:33], v[32:33], v[96:97]
  v_pk_add_f32 v[34:35], v[34:35], v[98:99]
  v_pk_add_f32 v[36:37], v[36:37], v[100:101]
  v_pk_add_f32 v[38:39], v[38:39], v[102:103]
  v_cvt_pk_bf16_f32 v40, v32, v33
  v_cvt_pk_bf16_f32 v41, v34, v35
  v_cvt_pk_bf16_f32 v42, v36, v37
  v_cvt_pk_bf16_f32 v43, v38, v39
  v_lshlrev_b32 v32, 16, v40
  v_and_b32 v33, 0xffff0000, v40
  v_lshlrev_b32 v34, 16, v41
  v_and_b32 v35, 0xffff0000, v41
  v_lshlrev_b32 v36, 16, v42
  v_and_b32 v37, 0xffff0000, v42
  v_lshlrev_b32 v38, 16, v43
  v_and_b32 v39, 0xffff0000, v43
  v_pk_add_f32 v[32:33], v[32:33], v[120:121]
  v_pk_add_f32 v[34:35], v[34:35], v[122:123]
  v_pk_add_f32 v[36:37], v[36:37], v[124:125]
  v_pk_add_f32 v[38:39], v[38:39], v[126:127]
  v_cvt_pk_bf16_f32 v44, v32, v33
  v_cvt_pk_bf16_f32 v45, v34, v35
  v_cvt_pk_bf16_f32 v46, v36, v37
  v_cvt_pk_bf16_f32 v47, v38, v39
  buffer_store_dwordx4 v[44:47], v248, s[48:51], 0 offen
  s_waitcnt lgkmcnt(8)
  v_pk_add_f32 v[64:65], v[64:65], v[72:73]
  v_pk_add_f32 v[80:81], v[80:81], v[88:89]
  v_pk_add_f32 v[66:67], v[66:67], v[74:75]
  v_pk_add_f32 v[82:83], v[82:83], v[90:91]
  v_pk_add_f32 v[68:69], v[68:69], v[76:77]
  v_pk_add_f32 v[84:85], v[84:85], v[92:93]
  v_pk_add_f32 v[70:71], v[70:71], v[78:79]
  v_pk_add_f32 v[86:87], v[86:87], v[94:95]
  v_pk_add_f32 v[64:65], v[64:65], v[80:81]
  v_pk_add_f32 v[66:67], v[66:67], v[82:83]
  v_pk_add_f32 v[68:69], v[68:69], v[84:85]
  v_pk_add_f32 v[70:71], v[70:71], v[86:87]
  v_cvt_pk_bf16_f32 v72, v64, v65
  v_cvt_pk_bf16_f32 v73, v66, v67
  v_cvt_pk_bf16_f32 v74, v68, v69
  v_cvt_pk_bf16_f32 v75, v70, v71
  v_lshlrev_b32 v64, 16, v72
  v_and_b32 v65, 0xffff0000, v72
  v_lshlrev_b32 v66, 16, v73
  v_and_b32 v67, 0xffff0000, v73
  v_lshlrev_b32 v68, 16, v74
  v_and_b32 v69, 0xffff0000, v74
  v_lshlrev_b32 v70, 16, v75
  v_and_b32 v71, 0xffff0000, v75
  v_pk_add_f32 v[64:65], v[64:65], v[104:105]
  v_pk_add_f32 v[66:67], v[66:67], v[106:107]
  v_pk_add_f32 v[68:69], v[68:69], v[108:109]
  v_pk_add_f32 v[70:71], v[70:71], v[110:111]
  v_cvt_pk_bf16_f32 v72, v64, v65
  v_cvt_pk_bf16_f32 v73, v66, v67
  v_cvt_pk_bf16_f32 v74, v68, v69
  v_cvt_pk_bf16_f32 v75, v70, v71
  v_lshlrev_b32 v64, 16, v72
  v_and_b32 v65, 0xffff0000, v72
  v_lshlrev_b32 v66, 16, v73
  v_and_b32 v67, 0xffff0000, v73
  v_lshlrev_b32 v68, 16, v74
  v_and_b32 v69, 0xffff0000, v74
  v_lshlrev_b32 v70, 16, v75
  v_and_b32 v71, 0xffff0000, v75
  v_pk_add_f32 v[64:65], v[64:65], v[160:161]
  v_pk_add_f32 v[66:67], v[66:67], v[162:163]
  v_pk_add_f32 v[68:69], v[68:69], v[164:165]
  v_pk_add_f32 v[70:71], v[70:71], v[166:167]
  v_cvt_pk_bf16_f32 v76, v64, v65
  v_cvt_pk_bf16_f32 v77, v66, v67
  v_cvt_pk_bf16_f32 v78, v68, v69
  v_cvt_pk_bf16_f32 v79, v70, v71
  buffer_store_dwordx4 v[76:79], v249, s[48:51], 0 offen
  s_waitcnt lgkmcnt(0)
  v_pk_add_f32 v[128:129], v[128:129], v[136:137]
  v_pk_add_f32 v[144:145], v[144:145], v[152:153]
  v_pk_add_f32 v[130:131], v[130:131], v[138:139]
  v_pk_add_f32 v[146:147], v[146:147], v[154:155]
  v_pk_add_f32 v[132:133], v[132:133], v[140:141]
  v_pk_add_f32 v[148:149], v[148:149], v[156:157]
  v_pk_add_f32 v[134:135], v[134:135], v[142:143]
  v_pk_add_f32 v[150:151], v[150:151], v[158:159]
  v_pk_add_f32 v[128:129], v[128:129], v[144:145]
  v_pk_add_f32 v[130:131], v[130:131], v[146:147]
  v_pk_add_f32 v[132:133], v[132:133], v[148:149]
  v_pk_add_f32 v[134:135], v[134:135], v[150:151]
  v_cvt_pk_bf16_f32 v136, v128, v129
  v_cvt_pk_bf16_f32 v137, v130, v131
  v_cvt_pk_bf16_f32 v138, v132, v133
  v_cvt_pk_bf16_f32 v139, v134, v135
  v_lshlrev_b32 v128, 16, v136
  v_and_b32 v129, 0xffff0000, v136
  v_lshlrev_b32 v130, 16, v137
  v_and_b32 v131, 0xffff0000, v137
  v_lshlrev_b32 v132, 16, v138
  v_and_b32 v133, 0xffff0000, v138
  v_lshlrev_b32 v134, 16, v139
  v_and_b32 v135, 0xffff0000, v139
  v_pk_add_f32 v[128:129], v[128:129], v[112:113]
  v_pk_add_f32 v[130:131], v[130:131], v[114:115]
  v_pk_add_f32 v[132:133], v[132:133], v[116:117]
  v_pk_add_f32 v[134:135], v[134:135], v[118:119]
  v_cvt_pk_bf16_f32 v136, v128, v129
  v_cvt_pk_bf16_f32 v137, v130, v131
  v_cvt_pk_bf16_f32 v138, v132, v133
  v_cvt_pk_bf16_f32 v139, v134, v135
  v_lshlrev_b32 v128, 16, v136
  v_and_b32 v129, 0xffff0000, v136
  v_lshlrev_b32 v130, 16, v137
  v_and_b32 v131, 0xffff0000, v137
  v_lshlrev_b32 v132, 16, v138
  v_and_b32 v133, 0xffff0000, v138
  v_lshlrev_b32 v134, 16, v139
  v_and_b32 v135, 0xffff0000, v139
  v_pk_add_f32 v[128:129], v[128:129], v[168:169]
  v_pk_add_f32 v[130:131], v[130:131], v[170:171]
  v_pk_add_f32 v[132:133], v[132:133], v[172:173]
  v_pk_add_f32 v[134:135], v[134:135], v[174:175]
  v_cvt_pk_bf16_f32 v140, v128, v129
  v_cvt_pk_bf16_f32 v141, v130, v131
  v_cvt_pk_bf16_f32 v142, v132, v133
  v_cvt_pk_bf16_f32 v143, v134, v135
  buffer_store_dwordx4 v[140:143], v250, s[48:51], 0 offen
fa_end:
  s_endpgm
fa_hk0:
  s_getpc_b64 s[10:11]
fa_hp0:
  s_add_u32 s8, s8, 4
  s_addc_u32 s9, s9, 0
  s_sub_u32 s10, s10, fa_hp0-fa_hb0
  s_subb_u32 s11, s11, 0
  s_setpc_b64 s[8:9]
fa_hk1:
  s_getpc_b64 s[10:11]
fa_hp1:
  s_add_u32 s8, s8, 4
  s_addc_u32 s9, s9, 0
  s_sub_u32 s10, s10, fa_hp1-fa_hb1
  s_subb_u32 s11, s11, 0
  s_setpc_b64 s[8:9]
fa_hk2:
  s_getpc_b64 s[10:11]
fa_hp2:
  s_add_u32 s8, s8, 4
  s_addc_u32 s9, s9, 0
  s_sub_u32 s10, s10, fa_hp2-fa_hb2
  s_subb_u32 s11, s11, 0
  s_setpc_b64 s[8:9]
fa_hk3:
  s_getpc_b64 s[10:11]
fa_hp3:
  s_add_u32 s8, s8, 4
  s_addc_u32 s9, s9, 0
  s_sub_u32 s10, s10, fa_hp3-fa_hb3
  s_subb_u32 s11, s11, 0
  s_setpc_b64 s[8:9]
fa_ln_spin:
  s_mov_b32 s83, 200000
fa_ln_spin2:
  buffer_load_dword v15, v229, s[56:59], 0 offen sc1
  s_waitcnt vmcnt(0)
  v_cmp_ne_u32 vcc, 0x01010101, v15
  s_cbranch_vccz fa_ln_ok
  s_sleep 8
  s_sub_u32 s83, s83, 1
  s_cmp_lg_u32 s83, 0
  s_cbranch_scc1 fa_ln_spin2
  s_branch fa_ln_ok
fa_co1:
  buffer_load_dword v232, v234, s[32:35], s29 offen
  buffer_store_dword v229, v225, s[40:43], 0 offen sc1
  ds_read_b128 v[160:163], v221 offset:0
  ds_read_b128 v[164:167], v221 offset:4096
  ds_read_b128 v[168:171], v221 offset:8192
  buffer_store_dword v218, v222, s[40:43], 0 offen sc1
  s_waitcnt lgkmcnt(0)
  buffer_store_dwordx4 v[160:163], v223, s[40:43], s66 offen sc1
  buffer_store_dwordx4 v[164:167], v223, s[40:43], s67 offen sc1
  buffer_store_dwordx4 v[168:171], v224, s[40:43], s78 offen sc1
  s_getpc_b64 s[8:9]
  s_setpc_b64 s[10:11]
  s_mov_b32 s48, s60
  s_mov_b32 s49, s61
  s_mov_b32 s50, s75
  s_lshl_b32 s74, s22, 2
  s_add_u32 s74, s74, s20
  s_lshl_b32 s74, s74, 16
  s_mov_b32 s73, 2097152
  v_mov_b32 v213, 1073741824
  v_mov_b32 v214, 1
  v_writelane_b32 v213, s77, 0
  v_lshlrev_b32 v229, 2, v1
  s_and_b32 s23, s21, 3
  s_cbranch_scc0 fa_arr
  s_getpc_b64 s[8:9]
  s_setpc_b64 s[10:11]
fa_arr:
  buffer_store_byte v214, v213, s[56:59], 0 offen sc1
  s_getpc_b64 s[8:9]
  s_setpc_b64 s[10:11]
  buffer_load_dword v15, v229, s[56:59], 0 offen sc1
  s_getpc_b64 s[8:9]
  s_setpc_b64 s[10:11]
  s_mov_b32 s36, s60
  s_mov_b32 s37, s61
  s_mov_b32 s38, s75
  s_lshr_b32 s27, s20, 1
  s_lshl_b32 s27, s27, 18
  s_mov_b32 s25, 524288
  s_mov_b32 s32, s18
  s_mov_b32 s33, s19
  s_mov_b32 s34, 2621440
  s_mov_b32 s26, 0
  s_movk_i32 s79, 1024
  s_lshl_b32 s23, s22, 2
  s_add_u32 s23, s23, s20
  s_mul_i32 s23, s23, 40960
  v_add_u32 v3, s23, v2
  s_sub_u32 s23, 15, s22
  s_lshl_b32 s23, s23, 2
  s_add_u32 s23, s23, s20
  s_mul_i32 s23, s23, 40960
  s_sub_u32 s23, s23, 2048
  v_add_u32 v5, s23, v2
  v_add_u32 v4, 19456, v3
  v_add_u32 v6, 19456, v5
  s_waitcnt vmcnt(8)
  v_cmp_ne_u32 vcc, 0x01010101, v15
  s_cbranch_vccnz fa_ln_spin
fa_ln_ok:
  s_setpc_b64 s[10:11]
fa_kv_spin:
  s_mov_b32 s83, 200000
fa_kv_spin2:
  buffer_load_dword v15, v8, s[40:43], 0 offen sc1
  s_waitcnt vmcnt(0)
  v_cmp_eq_u32 vcc, 0, v15
  s_cbranch_vccz fa_kv_ok
  s_sleep 8
  s_sub_u32 s83, s83, 1
  s_cmp_lg_u32 s83, 0
  s_cbranch_scc1 fa_kv_spin2
  s_branch fa_kv_ok
fa_top8:
  s_cmp_lg_u32 s20, 0
  s_cbranch_scc1 fa_notop
  s_mov_b32 s23, 2621440
  s_mov_b32 s31, 2625536
  buffer_load_dwordx4 v[96:99], v2, s[40:43], s23 offen offset:0 sc1
  buffer_load_dwordx4 v[100:103], v2, s[40:43], s23 offen offset:1024 sc1
  buffer_load_dwordx4 v[104:107], v2, s[40:43], s23 offen offset:2048 sc1
  buffer_load_dwordx4 v[108:111], v2, s[40:43], s23 offen offset:3072 sc1
  buffer_load_dwordx4 v[112:115], v2, s[40:43], s31 offen offset:0 sc1
  buffer_load_dwordx4 v[116:119], v2, s[40:43], s31 offen offset:1024 sc1
  buffer_load_dwordx4 v[120:123], v2, s[40:43], s31 offen offset:2048 sc1
  buffer_load_dwordx4 v[124:127], v2, s[40:43], s31 offen offset:3072 sc1
  v_mov_b32 v21, 0
  v_mov_b32 v22, 0
  v_and_b32 v23, 7, v1
  s_mov_b32 s23, 0
  s_waitcnt vmcnt(0)
fa_top:
  v_max3_u32 v20, v96, v97, v98
  v_max3_u32 v24, v99, v100, v101
  v_max3_u32 v20, v20, v102, v103
  v_max3_u32 v24, v24, v104, v105
  v_max3_u32 v20, v20, v106, v107
  v_max3_u32 v24, v24, v108, v109
  v_max3_u32 v20, v20, v110, v111
  v_max3_u32 v24, v24, v112, v113
  v_max3_u32 v20, v20, v114, v115
  v_max3_u32 v24, v24, v116, v117
  v_max3_u32 v20, v20, v118, v119
  v_max3_u32 v24, v24, v120, v121
  v_max3_u32 v20, v20, v122, v123
  v_max3_u32 v24, v24, v124, v125
  v_max3_u32 v20, v20, v126, v127
  v_max_u32 v20, v20, v24
  s_nop 1
  v_max_u32_dpp v20, v20, v20 quad_perm:[1,0,3,2] row_mask:0xf bank_mask:0xf
  s_nop 1
  v_max_u32_dpp v20, v20, v20 quad_perm:[2,3,0,1] row_mask:0xf bank_mask:0xf
  s_nop 1
  v_max_u32_dpp v20, v20, v20 row_half_mirror row_mask:0xf bank_mask:0xf
  s_nop 1
  v_max_u32_dpp v20, v20, v20 row_mirror row_mask:0xf bank_mask:0xf
  v_mov_b32 v24, v20
  s_nop 1
  v_permlane16_swap_b32 v20, v24
  v_max_u32 v20, v20, v24
  v_mov_b32 v24, v20
  s_nop 1
  v_permlane32_swap_b32 v20, v24
  v_max_u32 v20, v20, v24
  v_add_u32 v21, v21, v20
  v_cmp_eq_u32 vcc, s23, v23
  v_sub_u32 v96, v96, v20
  v_sub_u32 v97, v97, v20
  v_sub_u32 v98, v98, v20
  v_sub_u32 v99, v99, v20
  v_sub_u32 v100, v100, v20
  v_sub_u32 v101, v101, v20
  v_sub_u32 v102, v102, v20
  v_sub_u32 v103, v103, v20
  v_sub_u32 v104, v104, v20
  v_sub_u32 v105, v105, v20
  v_sub_u32 v106, v106, v20
  v_sub_u32 v107, v107, v20
  v_sub_u32 v108, v108, v20
  v_sub_u32 v109, v109, v20
  v_sub_u32 v110, v110, v20
  v_sub_u32 v111, v111, v20
  v_sub_u32 v112, v112, v20
  v_sub_u32 v113, v113, v20
  v_sub_u32 v114, v114, v20
  v_sub_u32 v115, v115, v20
  v_sub_u32 v116, v116, v20
  v_sub_u32 v117, v117, v20
  v_sub_u32 v118, v118, v20
  v_sub_u32 v119, v119, v20
  v_sub_u32 v120, v120, v20
  v_sub_u32 v121, v121, v20
  v_sub_u32 v122, v122, v20
  v_sub_u32 v123, v123, v20
  v_sub_u32 v124, v124, v20
  v_sub_u32 v125, v125, v20
  v_sub_u32 v126, v126, v20
  v_sub_u32 v127, v127, v20
  v_cndmask_b32 v22, v22, v21, vcc
  s_add_u32 s23, s23, 1
  s_cmp_lt_u32 s23, 8
  s_cbranch_scc1 fa_top
  v_and_b32 v25, 0xffff, v22
  v_sub_u32 v25, 0xffff, v25
  v_and_b32 v25, 2047, v25
  v_ashrrev_i32 v20, 31, v22
  v_not_b32 v20, v20
  v_or_b32 v20, 0x80000000, v20
  v_xor_b32 v26, v22, v20
  v_and_b32 v26, 0xffff0000, v26
  v_mul_f32 v26, 0xbfb8aa3b, v26
  v_exp_f32 v26, v26
  s_nop 0
  v_add_f32 v26, 1.0, v26
  v_rcp_f32 v26, v26
  s_nop 0
  v_cvt_pk_bf16_f32 v26, v26, v26
  v_and_b32 v26, 0xffff0000, v26
  v_lshlrev_b32 v20, 2, v1
  v_add_u32 v20, 2629632, v20
  v_mov_b32 v21, 1073741824
  v_cmp_gt_u32 vcc, 16, v1
  v_add_u32 v25, 1, v25
  v_or_b32 v26, 1, v26
  v_cndmask_b32 v20, v21, v20, vcc
  v_cmp_gt_u32 vcc, 8, v1
  s_nop 1
  v_cndmask_b32 v26, v26, v25, vcc
  buffer_store_dword v26, v20, s[40:43], 0 offen sc1
  s_branch fa_notop
fa_hk4:
  s_getpc_b64 s[38:39]
fa_hp4:
  s_add_u32 s36, s36, 4
  s_addc_u32 s37, s37, 0
  s_sub_u32 s38, s38, fa_hp4-fa_hb4
  s_subb_u32 s39, s39, 0
  s_setpc_b64 s[36:37]
fa_hk5:
  s_getpc_b64 s[38:39]
fa_hp5:
  s_add_u32 s36, s36, 4
  s_addc_u32 s37, s37, 0
  s_sub_u32 s38, s38, fa_hp5-fa_hb5
  s_subb_u32 s39, s39, 0
  s_setpc_b64 s[36:37]
fa_hk6:
  s_getpc_b64 s[38:39]
fa_hp6:
  s_add_u32 s36, s36, 4
  s_addc_u32 s37, s37, 0
  s_add_u32 s38, s38, fa_hb6-fa_hp6
  s_addc_u32 s39, s39, 0
  s_setpc_b64 s[36:37]
fa_DDF:
  v_mfma_f32_16x16x32_bf16 v[96:99], a[128:131], v[32:35], v[192:195]
  s_waitcnt vmcnt(4)
  v_exp_f32 v218, v146
  v_mfma_f32_16x16x32_bf16 v[104:107], a[128:131], v[36:39], v[196:199]
  s_barrier
  v_exp_f32 v219, v147
  v_mfma_f32_16x16x32_bf16 v[128:131], a[128:131], v[64:67], v[200:203]
  s_cmp_ge_u32 s26, s32
  ds_read_b128 a[160:163], v3 offset:16384
  v_exp_f32 v220, v148
  v_mfma_f32_16x16x32_bf16 v[136:139], a[128:131], v[68:71], v[204:207]
  s_cbranch_scc1 fa_hk6
fa_hb6:
  ds_read_b64_tr_b16 a[192:193], v9 offset:0
  v_add_f32 v226, v216, v217
  v_mfma_f32_16x16x32_bf16 v[100:103], a[132:135], v[32:35], v[192:195]
  ds_read_b128 a[164:167], v3 offset:17408
  ds_read_b64_tr_b16 a[194:195], v9 offset:128
  v_cvt_pk_bf16_f32 v184, v216, v217
  v_mfma_f32_16x16x32_bf16 v[108:111], a[132:135], v[36:39], v[196:199]
  s_mov_b32 m0, s24
  ds_read_b128 a[212:215], v10 offset:0
  ds_read_b64_tr_b16 a[196:197], v9 offset:1024
  v_add_f32 v226, v226, v218
  v_mfma_f32_16x16x32_bf16 v[132:135], a[132:135], v[64:67], v[200:203]
  buffer_load_dwordx4 v2, s[44:47], s26 offen offset:0 sc1 lds
  v_add_f32 v226, v226, v219
  v_mfma_f32_16x16x32_bf16 v[140:143], a[132:135], v[68:71], v[204:207]
  ds_read_b64_tr_b16 a[198:199], v9 offset:1152
  ds_read_b128 a[216:219], v10 offset:512
  v_cvt_pk_bf16_f32 v185, v218, v219
  v_mfma_f32_16x16x32_bf16 v[96:99], a[136:139], v[40:43], v[96:99]
  ds_read_b128 a[168:171], v3 offset:18432
  ds_read_b64_tr_b16 a[200:201], v9 offset:2048
  v_add_f32 v226, v226, v220
  v_exp_f32 v221, v149
  v_mfma_f32_16x16x32_bf16 v[104:107], a[136:139], v[44:47], v[104:107]
  ds_read_b64_tr_b16 a[202:203], v9 offset:2176
  ds_read_b128 a[220:223], v10 offset:1024
  v_add_f32 v226, v226, v221
  v_mfma_f32_16x16x32_bf16 v[128:131], a[136:139], v[72:75], v[128:131]
  ds_read_b64_tr_b16 a[204:205], v9 offset:3072
  ds_read_b64_tr_b16 a[206:207], v9 offset:3200
  v_cvt_pk_bf16_f32 v186, v220, v221
  v_mfma_f32_16x16x32_bf16 v[136:139], a[136:139], v[76:79], v[136:139]
  ds_read_b128 a[224:227], v10 offset:1536
  ds_read_b64_tr_b16 a[208:209], v9 offset:4096
  v_mfma_f32_16x16x32_bf16 v[100:103], a[140:143], v[40:43], v[100:103]
  ds_read_b128 a[172:175], v3 offset:19456
  v_mfma_f32_16x16x32_bf16 v[108:111], a[140:143], v[44:47], v[108:111]
  buffer_load_dwordx4 v2, s[44:47], s26 offen offset:1024 sc1 lds
  v_mfma_f32_16x16x32_bf16 v[132:135], a[140:143], v[72:75], v[132:135]
  ds_read_b64_tr_b16 a[210:211], v9 offset:4224
  ds_read_b128 a[228:231], v10 offset:2048
  v_mfma_f32_16x16x32_bf16 v[140:143], a[140:143], v[76:79], v[140:143]
  s_waitcnt lgkmcnt(4)
  v_exp_f32 v222, v150
  v_mfma_f32_16x16x32_bf16 v[96:99], a[144:147], v[48:51], v[96:99]
  ds_read_b128 a[176:179], v3 offset:20480
  v_add_f32 v226, v226, v222
  v_mfma_f32_16x16x32_bf16 v[104:107], a[144:147], v[52:55], v[104:107]
  v_exp_f32 v223, v151
  v_mfma_f32_16x16x32_bf16 v[128:131], a[144:147], v[80:83], v[128:131]
  v_exp_f32 v216, v152
  v_add_u32 v10, 2560, v10
  v_mfma_f32_16x16x32_bf16 v[136:139], a[144:147], v[84:87], v[136:139]
  buffer_load_dwordx4 v2, s[44:47], s26 offen offset:2048 sc1 lds
  v_add_f32 v226, v226, v223
  v_mfma_f32_16x16x32_bf16 v[100:103], a[148:151], v[48:51], v[100:103]
  ds_read_b128 a[180:183], v3 offset:21504
  v_cvt_pk_bf16_f32 v187, v222, v223
  v_and_b32 v232, s4, v232
  v_mfma_f32_16x16x32_bf16 v[108:111], a[148:151], v[52:55], v[108:111]
  v_exp_f32 v217, v153
  v_and_b32 v233, s4, v233
  v_mfma_f32_16x16x32_bf16 v[132:135], a[148:151], v[80:83], v[132:135]
  v_exp_f32 v218, v154
  v_and_b32 v234, s4, v234
  v_mfma_f32_16x16x32_bf16 v[140:143], a[148:151], v[84:87], v[140:143]
  v_exp_f32 v219, v155
  v_and_b32 v235, s4, v235
  v_mfma_f32_16x16x32_bf16 v[96:99], a[152:155], v[56:59], v[96:99]
  ds_read_b128 a[184:187], v3 offset:22528
  v_add_f32 v227, v216, v217
  v_cvt_pk_bf16_f32 v188, v216, v217
  v_add_f32 v227, v227, v218
  v_add_f32 v227, v227, v219
  v_mfma_f32_16x16x32_bf16 v[104:107], a[152:155], v[60:63], v[104:107]
  buffer_load_dwordx4 v2, s[44:47], s26 offen offset:3072 sc1 lds
  v_cvt_pk_bf16_f32 v189, v218, v219
  v_mfma_f32_16x16x32_bf16 v[128:131], a[152:155], v[88:91], v[128:131]
  s_add_u32 s26, s26, 16384
  v_exp_f32 v220, v156
  v_mfma_f32_16x16x32_bf16 v[136:139], a[152:155], v[92:95], v[136:139]
  s_add_u32 s24, s24, 32768
  v_exp_f32 v221, v157
  v_mfma_f32_16x16x32_bf16 v[100:103], a[156:159], v[56:59], v[100:103]
  s_and_b32 s24, s24, 0x1ffff
  ds_read_b128 a[188:191], v3 offset:23552
  v_add_f32 v227, v227, v220
  v_add_f32 v227, v227, v221
  v_mfma_f32_16x16x32_bf16 v[108:111], a[156:159], v[60:63], v[108:111]
  v_exp_f32 v222, v158
  v_mfma_f32_16x16x32_bf16 v[132:135], a[156:159], v[88:91], v[132:135]
  s_add_u32 m0, s34, 0
  v_exp_f32 v223, v159
  v_mfma_f32_16x16x32_bf16 v[140:143], a[156:159], v[92:95], v[140:143]
  s_waitcnt lgkmcnt(4)
  buffer_load_dwordx4 v8, s[52:55], s33 offen offset:0 lds
  v_cvt_pk_bf16_f32 v190, v220, v221
  v_add_f32 v227, v227, v222
  v_add_f32 v227, v227, v223
  v_mfma_f32_16x16x32_bf16 a[0:3], a[160:163], v[160:163], a[0:3]
  ds_read_b128 a[128:131], v3 offset:0
  v_cvt_pk_bf16_f32 v191, v222, v223
  v_mfma_f32_16x16x32_bf16 a[4:7], a[160:163], v[164:167], a[4:7]
  s_mov_b32 s4, s5
  v_exp_f32 v208, v112
  v_mfma_f32_16x16x32_bf16 a[64:67], a[160:163], v[176:179], a[64:67]
  s_mov_b32 s5, -1
  v_exp_f32 v209, v113
  v_mfma_f32_16x16x32_bf16 v[232:235], a[192:195], a[212:215], v[232:235]
  v_mfma_f32_16x16x32_bf16 a[68:71], a[160:163], v[180:183], a[68:71]
  v_exp_f32 v210, v114
  v_mfma_f32_16x16x32_bf16 a[8:11], a[164:167], v[160:163], a[8:11]
  ds_read_b128 a[132:135], v3 offset:1024
  v_add_f32 v224, v208, v209
  v_cvt_pk_bf16_f32 v168, v208, v209
  v_mfma_f32_16x16x32_bf16 a[12:15], a[164:167], v[164:167], a[12:15]
  buffer_load_dwordx4 v11, s[52:55], s33 offen offset:1024 lds
  v_add_f32 v224, v224, v210
  v_mfma_f32_16x16x32_bf16 a[72:75], a[164:167], v[176:179], a[72:75]
  v_exp_f32 v211, v115
  v_mfma_f32_16x16x32_bf16 a[76:79], a[164:167], v[180:183], a[76:79]
  v_exp_f32 v212, v116
  v_mfma_f32_16x16x32_bf16 v[232:235], a[196:199], a[216:219], v[232:235]
  v_mfma_f32_16x16x32_bf16 a[16:19], a[168:171], v[160:163], a[16:19]
  ds_read_b128 a[136:139], v3 offset:2048
  v_add_f32 v224, v224, v211
  v_cvt_pk_bf16_f32 v169, v210, v211
  v_mfma_f32_16x16x32_bf16 a[20:23], a[168:171], v[164:167], a[20:23]
  v_exp_f32 v213, v117
  v_mfma_f32_16x16x32_bf16 a[80:83], a[168:171], v[176:179], a[80:83]
  v_exp_f32 v214, v118
  v_mfma_f32_16x16x32_bf16 a[84:87], a[168:171], v[180:183], a[84:87]
  buffer_load_dwordx4 v12, s[52:55], s33 offen offset:2048 lds
  v_add_f32 v224, v224, v212
  v_add_f32 v224, v224, v213
  v_cvt_pk_bf16_f32 v170, v212, v213
  v_mfma_f32_16x16x32_bf16 a[24:27], a[172:175], v[160:163], a[24:27]
  ds_read_b128 a[140:143], v3 offset:3072
  v_add_f32 v224, v224, v214
  v_mfma_f32_16x16x32_bf16 v[232:235], a[200:203], a[220:223], v[232:235]
  v_mfma_f32_16x16x32_bf16 a[28:31], a[172:175], v[164:167], a[28:31]
  v_exp_f32 v215, v119
  v_mfma_f32_16x16x32_bf16 a[88:91], a[172:175], v[176:179], a[88:91]
  v_exp_f32 v208, v120
  v_mfma_f32_16x16x32_bf16 a[92:95], a[172:175], v[180:183], a[92:95]
  s_waitcnt lgkmcnt(4)
  v_exp_f32 v209, v121
  v_mfma_f32_16x16x32_bf16 a[32:35], a[176:179], v[160:163], a[32:35]
  ds_read_b128 a[144:147], v3 offset:4096
  v_add_f32 v224, v224, v215
  v_cvt_pk_bf16_f32 v171, v214, v215
  v_add_f32 v225, v208, v209
  v_mfma_f32_16x16x32_bf16 a[36:39], a[176:179], v[164:167], a[36:39]
  buffer_load_dwordx4 v13, s[52:55], s33 offen offset:3072 lds
  v_cvt_pk_bf16_f32 v172, v208, v209
  v_mfma_f32_16x16x32_bf16 v[232:235], a[204:207], a[224:227], v[232:235]
  v_mfma_f32_16x16x32_bf16 a[96:99], a[176:179], v[176:179], a[96:99]
  v_exp_f32 v210, v122
  v_mfma_f32_16x16x32_bf16 a[100:103], a[176:179], v[180:183], a[100:103]
  v_exp_f32 v211, v123
  v_mfma_f32_16x16x32_bf16 a[40:43], a[180:183], v[160:163], a[40:43]
  ds_read_b128 a[148:151], v3 offset:5120
  v_add_f32 v225, v225, v210
  v_add_f32 v225, v225, v211
  v_mfma_f32_16x16x32_bf16 a[44:47], a[180:183], v[164:167], a[44:47]
  v_exp_f32 v212, v124
  v_mfma_f32_16x16x32_bf16 a[104:107], a[180:183], v[176:179], a[104:107]
  s_add_u32 m0, s34, 4096
  v_exp_f32 v213, v125
  v_mfma_f32_16x16x32_bf16 v[232:235], a[208:211], a[228:231], v[232:235]
  v_mfma_f32_16x16x32_bf16 a[108:111], a[180:183], v[180:183], a[108:111]
  buffer_load_dwordx4 v14, s[52:55], s33 offen offset:0 lds
  v_cvt_pk_bf16_f32 v173, v210, v211
  v_max3_f32 v5, v226, v227, v224
  v_mfma_f32_16x16x32_bf16 a[48:51], a[184:187], v[160:163], a[48:51]
  ds_read_b128 a[152:155], v3 offset:6144
  v_add_f32 v225, v225, v212
  v_mfma_f32_16x16x32_bf16 a[52:55], a[184:187], v[164:167], a[52:55]
  s_add_u32 s33, s33, s6
  v_exp_f32 v214, v126
  v_mfma_f32_16x16x32_bf16 a[112:115], a[184:187], v[176:179], a[112:115]
  v_exp_f32 v215, v127
  v_mfma_f32_16x16x32_bf16 a[116:119], a[184:187], v[180:183], a[116:119]
  v_add_f32 v225, v225, v213
  v_cvt_pk_bf16_f32 v174, v212, v213
  v_add_f32 v225, v225, v214
  v_mfma_f32_16x16x32_bf16 a[56:59], a[188:191], v[160:163], a[56:59]
  ds_read_b128 a[156:159], v3 offset:7168
  v_add_f32 v225, v225, v215
  v_max_f32 v5, v5, v225
  v_cmp_lt_f32 vcc, s81, v5
  v_mfma_f32_16x16x32_bf16 a[60:63], a[188:191], v[164:167], a[60:63]
  v_exp_f32 v216, v128
  v_mfma_f32_16x16x32_bf16 a[120:123], a[188:191], v[176:179], a[120:123]
  s_waitcnt lgkmcnt(4)
  v_cvt_pk_bf16_f32 v175, v214, v215
  v_mfma_f32_16x16x32_bf16 a[124:127], a[188:191], v[180:183], a[124:127]
  s_cbranch_vccnz fa_stub3
fa_back3:
  v_exp_f32 v217, v129
  v_add_f32 v228, v228, v224
  v_add_f32 v229, v229, v225
  v_add_f32 v230, v230, v226
  v_add_f32 v231, v231, v227
  s_branch fa_DDe
fa_kv2_spin:
  s_mov_b32 s83, 200000
fa_kv2_spin2:
  buffer_load_dword v14, v13, s[40:43], 0 offen sc1
  s_waitcnt vmcnt(0)
  v_cmp_eq_u32 vcc, 0, v14
  s_cbranch_vccz fa_kv2_ok
  s_sleep 8
  s_sub_u32 s83, s83, 1
  s_cmp_lg_u32 s83, 0
  s_cbranch_scc1 fa_kv2_spin2
  s_branch fa_kv2_ok
fa_kv3_spin:
  s_mov_b32 s83, 200000
fa_kv3_spin2:
  buffer_load_dword v14, v13, s[40:43], 0 offen sc1
  s_waitcnt vmcnt(0)
  v_cmp_eq_u32 vcc, 0, v14
  s_cbranch_vccz fa_kv3_ok
  s_sleep 8
  s_sub_u32 s83, s83, 1
  s_cmp_lg_u32 s83, 0
  s_cbranch_scc1 fa_kv3_spin2
  s_branch fa_kv3_ok
fa_sel_spin:
  s_mov_b32 s83, 200000
fa_sel_spin2:
  buffer_load_dword v15, v252, s[40:43], 0 offen sc1
  s_waitcnt vmcnt(0)
  v_cmp_eq_u32 vcc, 0, v15
  s_cbranch_vccz fa_sel_ok
  s_sleep 8
  s_sub_u32 s83, s83, 1
  s_cmp_lg_u32 s83, 0
  s_cbranch_scc1 fa_sel_spin2
  s_branch fa_sel_ok
fa_wof_spin:
  s_mov_b32 s83, 200000
fa_wof_spin2:
  buffer_load_dword v8, v9, s[40:43], 0 offen sc1
  s_waitcnt vmcnt(0)
  v_cmp_eq_u32 vcc, 0, v8
  s_cbranch_vccz fa_wof_ok
  s_sleep 8
  s_sub_u32 s83, s83, 1
  s_cmp_lg_u32 s83, 0
  s_cbranch_scc1 fa_wof_spin2
  s_branch fa_wof_ok
fa_sel4_spin:
  s_mov_b32 s83, 200000
fa_sel4_spin2:
  buffer_load_dword v15, v10, s[40:43], 0 offen sc1
  s_waitcnt vmcnt(0)
  v_cmp_eq_u32 vcc, 0, v15
  s_cbranch_vccz fa_sel4_ok
  s_sleep 8
  s_sub_u32 s83, s83, 1
  s_cmp_lg_u32 s83, 0
  s_cbranch_scc1 fa_sel4_spin2
  s_branch fa_sel4_ok
fa_yf_spin:
  s_mov_b32 s83, 200000
fa_yf_spin2:
  buffer_load_dword v14, v11, s[40:43], 0 offen sc1
  s_waitcnt vmcnt(0)
  v_cmp_eq_u32 vcc, 0, v14
  s_cbranch_vccz fa_yf_ok
  s_sleep 8
  s_sub_u32 s83, s83, 1
  s_cmp_lg_u32 s83, 0
  s_cbranch_scc1 fa_yf_spin2
  s_branch fa_yf_ok
fa_co:
  s_sub_u32 s14, s2, 64
  s_cmp_lt_u32 s14, 96
  s_cbranch_scc1 fa_coT
  s_sub_u32 s14, s2, 128
  s_sub_u32 s23, s2, 224
  s_cmp_lt_u32 s23, 31
  s_cbranch_scc1 fa_coT
  v_cmp_eq_u32 vcc, 0, v14
  s_cbranch_vccnz fa_kv2_spin
fa_kv2_ok:
  s_sub_u32 s14, s2, 170
  s_cmp_lt_u32 s14, 54
  s_cbranch_scc1 fa_coF
  s_cmp_eq_u32 s2, 255
  s_cbranch_scc1 fa_coW
  s_cmp_lt_u32 s2, 32
  s_cbranch_scc1 fa_coW
  s_branch fa_coO
fa_coT:
  v_min_u32 v8, 16, v1
  v_lshlrev_b32 v8, 7, v8
  s_lshl_b32 s10, s14, 1
  s_and_b32 s31, s20, 1
  s_add_u32 s10, s10, s31
  s_mul_i32 s10, s10, 2176
  s_lshl_b32 s35, s14, 2
  s_add_u32 s35, s35, s20
  s_mul_i32 s35, s35, 4352
  buffer_load_dword v255, v8, s[52:55], s10 offen
  s_add_u32 s10, s10, 552960
  s_getpc_b64 s[36:37]
  s_setpc_b64 s[38:39]
  buffer_load_dword v255, v8, s[52:55], s10 offen
  s_add_u32 s10, s10, 552960
  s_getpc_b64 s[36:37]
  s_setpc_b64 s[38:39]
  v_cmp_eq_u32 vcc, 0, v14
  s_cbranch_vccnz fa_kv3_spin
fa_kv3_ok:
  buffer_load_dword v255, v8, s[52:55], s10 offen
  s_add_u32 s10, s10, 552960
  buffer_load_dword v255, v8, s[60:63], s35 offen offset:0
  s_getpc_b64 s[36:37]
  s_setpc_b64 s[38:39]
  buffer_load_dword v255, v8, s[52:55], s10 offen
  s_add_u32 s10, s10, 552960
  buffer_load_dword v255, v8, s[60:63], s35 offen offset:2176
  s_mov_b32 s9, -1
  s_and_b32 s32, s21, 3
  s_lshr_b32 s32, s32, 1
  s_add_u32 s32, s32, 6
  s_lshl_b32 s32, s32, 14
  s_getpc_b64 s[36:37]
  s_setpc_b64 s[38:39]
fa_coO:
  s_and_b32 s23, s67, 1
  s_lshl_b32 s23, s23, 2
  s_add_u32 s23, s23, s20
  s_lshr_b32 s31, s67, 1
  s_mul_i32 s33, s23, 0
  s_add_u32 s33, s33, s31
  s_and_b32 s33, s33, 31
  s_andn2_b32 s30, s31, 31
  s_add_u32 s33, s33, s30
  s_lshl_b32 s30, s23, 7
  s_add_u32 s30, s30, s33
  s_mul_i32 s33, s31, 40960
  s_mul_i32 s23, s23, 160
  s_add_u32 s33, s33, s23
  s_add_u32 m0, s34, 0
  v_accvgpr_read_b32 v19, a248
  buffer_load_dwordx4 v19, s[56:59], s33 offen lds
  s_add_u32 m0, s34, 1024
  v_accvgpr_read_b32 v19, a249
  buffer_load_dwordx4 v19, s[56:59], s33 offen lds
  s_add_u32 m0, s34, 2048
  v_accvgpr_read_b32 v19, a250
  buffer_load_dwordx4 v19, s[56:59], s33 offen lds
  s_add_u32 m0, s34, 3072
  v_accvgpr_read_b32 v19, a251
  buffer_load_dwordx4 v19, s[56:59], s33 offen lds
  s_add_u32 m0, s34, 4096
  v_accvgpr_read_b32 v19, a252
  buffer_load_dwordx4 v19, s[56:59], s33 offen lds
  s_lshl_b32 s32, s11, 15
  s_add_u32 s32, s32, s26
  s_mov_b32 s9, -1
  s_lshl_b32 s10, s30, 2
  s_mul_i32 s30, s30, 5120
  s_add_u32 s30, s30, 4194304
  s_getpc_b64 s[36:37]
  s_setpc_b64 s[38:39]
  s_waitcnt vmcnt(8)
  ds_read_b64_tr_b16 v[232:233], v6 offset:0
  ds_read_b64_tr_b16 v[234:235], v6 offset:2560
  ds_read_b64_tr_b16 v[236:237], v6 offset:32
  ds_read_b64_tr_b16 v[238:239], v6 offset:2592
  ds_read_b64_tr_b16 v[240:241], v6 offset:64
  ds_read_b64_tr_b16 v[242:243], v6 offset:2624
  ds_read_b64_tr_b16 v[244:245], v6 offset:96
  ds_read_b64_tr_b16 v[246:247], v6 offset:2656
  ds_read_b64_tr_b16 v[248:249], v6 offset:128
  ds_read_b64_tr_b16 v[250:251], v6 offset:2688
  s_waitcnt lgkmcnt(0)
  s_add_u32 s31, s30, 4096
  buffer_store_dwordx4 v[232:235], v2, s[40:43], s30 offen offset:0 sc1
  buffer_store_dwordx4 v[236:239], v2, s[40:43], s30 offen offset:1024 sc1
  buffer_store_dwordx4 v[240:243], v2, s[40:43], s30 offen offset:2048 sc1
  buffer_store_dwordx4 v[244:247], v2, s[40:43], s30 offen offset:3072 sc1
  buffer_store_dwordx4 v[248:251], v2, s[40:43], s31 offen offset:0 sc1
  s_getpc_b64 s[36:37]
  s_setpc_b64 s[38:39]
  s_add_u32 s23, s10, 2654208
  s_waitcnt vmcnt(8)
  buffer_store_dword v4, off, s[40:43], s23 sc1
  s_cmp_lg_u32 s67, s2
  s_cbranch_scc1 fa_coW
  s_sub_u32 s67, s2, 128
  s_cmp_lt_u32 s67, 32
  s_cbranch_scc1 fa_coO
  s_sub_u32 s23, s2, 96
  s_sub_u32 s31, s2, 192
  s_cmp_lt_u32 s23, 32
  s_cselect_b32 s23, s23, s31
  s_cmp_gt_u32 s23, 54
  s_cbranch_scc1 fa_coW
  s_add_u32 s67, s23, 170
  s_cmp_eq_u32 s67, 224
  s_cselect_b32 s67, 255, s67
  s_branch fa_coO
fa_coF:
  v_and_b32 v16, 7, v1
  v_lshlrev_b32 v252, 2, v16
  v_add_u32 v252, 2629632, v252
  buffer_load_dword v15, v252, s[40:43], 0 offen sc1
  s_lshl_b32 s33, s14, 6
  s_and_b32 s31, s20, 1
  s_lshl_b32 s31, s31, 5
  s_add_u32 s33, s33, s31
  s_mul_i32 s35, s14, 40960
  s_mul_i32 s31, s20, 320
  s_add_u32 s35, s35, s31
  s_mul_i32 s10, s14, 20480
  s_mul_i32 s31, s20, 640
  s_add_u32 s10, s10, s31
  s_add_u32 s10, s10, 2686976
  v_lshrrev_b32 v17, 1, v1
  v_mul_u32_u24 v8, 3456, v17
  v_and_b32 v17, 1, v1
  v_lshl_add_u32 v8, v17, 4, v8
  v_add_u32 v11, 109568, v8
  v_add_u32 v12, 219136, v8
  v_add_u32 v13, 328704, v8
  v_add_u32 v14, 442368, v8
  v_lshrrev_b32 v17, 4, v1
  v_lshrrev_b32 v18, 2, v1
  v_lshl_add_u32 v18, v17, 2, v18
  v_lshlrev_b32 v18, 5, v18
  v_and_b32 v19, 3, v1
  v_lshl_add_u32 v9, v19, 3, v18
  v_add_u32 v9, s34, v9
  v_lshlrev_b32 v10, 4, v16
  v_lshl_add_u32 v10, v17, 7, v10
  v_add_u32 v10, 148992, v10
  s_mov_b32 s8, -1
  s_mov_b32 s4, 0
  s_mov_b32 s5, 0
  s_mov_b32 s6, 552960
  s_getpc_b64 s[36:37]
  s_setpc_b64 s[38:39]
  s_waitcnt vmcnt(8)
  v_cmp_eq_u32 vcc, 0, v15
  s_cbranch_vccnz fa_sel_spin
fa_sel_ok:
  v_add_u32 v18, -1, v15
  v_and_b32 v18, 2047, v18
  v_lshrrev_b32 v19, 4, v18
  v_mul_u32_u24 v19, 20480, v19
  v_and_b32 v18, 15, v18
  v_lshl_add_u32 v19, v18, 4, v19
  v_lshrrev_b32 v18, 3, v1
  v_lshl_add_u32 v19, v18, 8, v19
  s_lshl_b32 s23, s20, 11
  s_lshl_b32 s31, s20, 10
  s_add_u32 s31, s31, 151552
  s_mov_b32 s32, 180224
  s_mov_b32 m0, s31
  s_add_u32 s31, s31, 4096
  buffer_load_dwordx4 v19, s[40:43], s23 offen sc1 lds
  s_add_u32 s23, s23, 8192
  s_mov_b32 m0, s31
  s_add_u32 s31, s31, 4096
  buffer_load_dwordx4 v19, s[40:43], s23 offen sc1 lds
  s_add_u32 s23, s23, 8192
  s_mov_b32 m0, s31
  s_add_u32 s31, s31, 4096
  buffer_load_dwordx4 v19, s[40:43], s23 offen sc1 lds
  s_add_u32 s23, s23, 8192
  s_getpc_b64 s[36:37]
  s_setpc_b64 s[38:39]
  v_accvgpr_read_b32 v8, a248
  v_accvgpr_read_b32 v11, a249
  v_accvgpr_read_b32 v12, a250
  v_accvgpr_read_b32 v13, a251
  v_accvgpr_read_b32 v14, a252
  v_subrev_u32 v11, 1024, v11
  v_subrev_u32 v12, 2048, v12
  v_subrev_u32 v13, 3072, v13
  s_mov_b32 s52, s60
  s_mov_b32 s53, s61
  s_mov_b32 s33, s35
  s_movk_i32 s6, 160
  s_mov_b32 s9, 0
  v_and_b32 v17, 7, v1
  v_mul_u32_u24 v15, 2560, v17
  v_lshrrev_b32 v17, 4, v1
  v_lshl_add_u32 v15, v17, 4, v15
  v_and_b32 v17, 8, v1
  v_lshl_add_u32 v15, v17, 27, v15
  s_getpc_b64 s[36:37]
  s_setpc_b64 s[38:39]
  s_lshl_b32 s23, s20, 9
  v_add_u32 v16, s23, v10
  s_mov_b32 s9, -1
  ds_write_b128 v16, v[232:235]
  s_getpc_b64 s[36:37]
  s_setpc_b64 s[38:39]
  ds_read_b128 v[236:239], v10 offset:0
  ds_read_b128 v[240:243], v10 offset:512
  ds_read_b128 v[244:247], v10 offset:1024
  ds_read_b128 v[248:251], v10 offset:1536
  s_waitcnt vmcnt(4)
  ds_read_b64_tr_b16 a[192:193], v6 offset:0
  ds_read_b64_tr_b16 a[194:195], v6 offset:2560
  ds_read_b64_tr_b16 a[196:197], v6 offset:32
  ds_read_b64_tr_b16 a[198:199], v6 offset:2592
  ds_read_b64_tr_b16 a[200:201], v6 offset:64
  ds_read_b64_tr_b16 a[202:203], v6 offset:2624
  ds_read_b64_tr_b16 a[204:205], v6 offset:96
  ds_read_b64_tr_b16 a[206:207], v6 offset:2656
  ds_read_b64_tr_b16 a[208:209], v6 offset:128
  ds_read_b64_tr_b16 a[210:211], v6 offset:2688
  v_subrev_u32 v10, 10240, v10
  s_mov_b32 s8, 0
  s_waitcnt lgkmcnt(10)
  v_cvt_pk_bf16_f32 v236, v236, v244
  v_cvt_pk_bf16_f32 v237, v237, v245
  v_cvt_pk_bf16_f32 v238, v238, v246
  v_cvt_pk_bf16_f32 v239, v239, v247
  v_cvt_pk_bf16_f32 v240, v240, v248
  v_cvt_pk_bf16_f32 v241, v241, v249
  v_cvt_pk_bf16_f32 v242, v242, v250
  v_cvt_pk_bf16_f32 v243, v243, v251
  v_lshlrev_b32 v244, 16, v236
  v_lshlrev_b32 v245, 16, v237
  v_lshlrev_b32 v246, 16, v238
  v_lshlrev_b32 v247, 16, v239
  v_lshlrev_b32 v248, 16, v240
  v_lshlrev_b32 v249, 16, v241
  v_lshlrev_b32 v250, 16, v242
  v_lshlrev_b32 v251, 16, v243
  v_mul_f32 v16, 0xbfb8aa3b, v244
  v_mul_f32 v17, 0xbfb8aa3b, v245
  v_mul_f32 v18, 0xbfb8aa3b, v246
  v_mul_f32 v19, 0xbfb8aa3b, v247
  v_mul_f32 v20, 0xbfb8aa3b, v248
  v_mul_f32 v21, 0xbfb8aa3b, v249
  v_mul_f32 v22, 0xbfb8aa3b, v250
  v_mul_f32 v23, 0xbfb8aa3b, v251
  v_exp_f32 v16, v16
  v_exp_f32 v17, v17
  v_exp_f32 v18, v18
  v_exp_f32 v19, v19
  v_exp_f32 v20, v20
  v_exp_f32 v21, v21
  v_exp_f32 v22, v22
  v_exp_f32 v23, v23
  v_add_f32 v16, 1.0, v16
  v_add_f32 v17, 1.0, v17
  v_add_f32 v18, 1.0, v18
  v_add_f32 v19, 1.0, v19
  v_add_f32 v20, 1.0, v20
  v_add_f32 v21, 1.0, v21
  v_add_f32 v22, 1.0, v22
  v_add_f32 v23, 1.0, v23
  v_rcp_f32 v16, v16
  v_rcp_f32 v17, v17
  v_rcp_f32 v18, v18
  v_rcp_f32 v19, v19
  v_rcp_f32 v20, v20
  v_rcp_f32 v21, v21
  v_rcp_f32 v22, v22
  v_rcp_f32 v23, v23
  v_and_b32 v236, 0xffff0000, v236
  v_and_b32 v237, 0xffff0000, v237
  v_and_b32 v238, 0xffff0000, v238
  v_and_b32 v239, 0xffff0000, v239
  v_and_b32 v240, 0xffff0000, v240
  v_and_b32 v241, 0xffff0000, v241
  v_and_b32 v242, 0xffff0000, v242
  v_and_b32 v243, 0xffff0000, v243
  v_pk_mul_f32 v[244:245], v[244:245], v[16:17]
  v_pk_mul_f32 v[246:247], v[246:247], v[18:19]
  v_pk_mul_f32 v[248:249], v[248:249], v[20:21]
  v_pk_mul_f32 v[250:251], v[250:251], v[22:23]
  v_cvt_pk_bf16_f32 v16, v244, v245
  v_cvt_pk_bf16_f32 v17, v246, v247
  v_cvt_pk_bf16_f32 v18, v248, v249
  v_cvt_pk_bf16_f32 v19, v250, v251
  v_lshlrev_b32 v244, 16, v16
  v_and_b32 v245, 0xffff0000, v16
  v_lshlrev_b32 v246, 16, v17
  v_and_b32 v247, 0xffff0000, v17
  v_lshlrev_b32 v248, 16, v18
  v_and_b32 v249, 0xffff0000, v18
  v_lshlrev_b32 v250, 16, v19
  v_and_b32 v251, 0xffff0000, v19
  v_pk_mul_f32 v[236:237], v[236:237], v[244:245]
  v_pk_mul_f32 v[238:239], v[238:239], v[246:247]
  v_pk_mul_f32 v[240:241], v[240:241], v[248:249]
  v_pk_mul_f32 v[242:243], v[242:243], v[250:251]
  v_cvt_pk_bf16_f32 v16, v236, v237
  v_cvt_pk_bf16_f32 v17, v238, v239
  v_cvt_pk_bf16_f32 v18, v240, v241
  v_cvt_pk_bf16_f32 v19, v242, v243
  v_accvgpr_write_b32 a232, v16
  v_accvgpr_write_b32 a233, v17
  v_accvgpr_write_b32 a234, v18
  v_accvgpr_write_b32 a235, v19
  s_nop 0
  s_waitcnt lgkmcnt(0)
  v_mfma_f32_16x16x32_bf16 v[236:239], a[192:195], a[232:235], 0
  v_mfma_f32_16x16x32_bf16 v[240:243], a[196:199], a[232:235], 0
  v_mfma_f32_16x16x32_bf16 v[244:247], a[200:203], a[232:235], 0
  v_mfma_f32_16x16x32_bf16 v[248:251], a[204:207], a[232:235], 0
  v_mfma_f32_16x16x32_bf16 v[252:255], a[208:211], a[232:235], 0
  s_nop 3
  buffer_store_dwordx4 v[236:239], v15, s[40:43], s10 offen offset:0 sc1
  buffer_store_dwordx4 v[240:243], v15, s[40:43], s10 offen offset:64 sc1
  buffer_store_dwordx4 v[244:247], v15, s[40:43], s10 offen offset:128 sc1
  buffer_store_dwordx4 v[248:251], v15, s[40:43], s10 offen offset:192 sc1
  buffer_store_dwordx4 v[252:255], v15, s[40:43], s10 offen offset:256 sc1
  s_add_u32 s10, s10, 320
  s_getpc_b64 s[36:37]
  s_setpc_b64 s[38:39]
  s_waitcnt vmcnt(4)
  ds_read_b64_tr_b16 a[192:193], v6 offset:0
  ds_read_b64_tr_b16 a[194:195], v6 offset:2560
  ds_read_b64_tr_b16 a[196:197], v6 offset:32
  ds_read_b64_tr_b16 a[198:199], v6 offset:2592
  ds_read_b64_tr_b16 a[200:201], v6 offset:64
  ds_read_b64_tr_b16 a[202:203], v6 offset:2624
  ds_read_b64_tr_b16 a[204:205], v6 offset:96
  ds_read_b64_tr_b16 a[206:207], v6 offset:2656
  ds_read_b64_tr_b16 a[208:209], v6 offset:128
  ds_read_b64_tr_b16 a[210:211], v6 offset:2688
  s_waitcnt lgkmcnt(0)
  v_mfma_f32_16x16x32_bf16 v[236:239], a[192:195], a[232:235], 0
  v_mfma_f32_16x16x32_bf16 v[240:243], a[196:199], a[232:235], 0
  v_mfma_f32_16x16x32_bf16 v[244:247], a[200:203], a[232:235], 0
  v_mfma_f32_16x16x32_bf16 v[248:251], a[204:207], a[232:235], 0
  v_mfma_f32_16x16x32_bf16 v[252:255], a[208:211], a[232:235], 0
  s_nop 3
  buffer_store_dwordx4 v[236:239], v15, s[40:43], s10 offen offset:0 sc1
  buffer_store_dwordx4 v[240:243], v15, s[40:43], s10 offen offset:64 sc1
  buffer_store_dwordx4 v[244:247], v15, s[40:43], s10 offen offset:128 sc1
  buffer_store_dwordx4 v[248:251], v15, s[40:43], s10 offen offset:192 sc1
  buffer_store_dwordx4 v[252:255], v15, s[40:43], s10 offen offset:256 sc1
  s_add_u32 s10, s10, 320
  s_getpc_b64 s[36:37]
  s_setpc_b64 s[38:39]
  s_sub_u32 s23, s2, 170
  s_lshl_b32 s31, s20, 6
  s_add_u32 s23, s23, s31
  s_lshl_b32 s23, s23, 2
  s_add_u32 s23, s23, 2650112
  s_waitcnt vmcnt(8)
  buffer_store_dword v4, off, s[40:43], s23 sc1
fa_coW:
  s_mov_b32 s12, 1
  s_mov_b32 s9, -1
  s_cmp_lg_u32 s11, 0
  s_cselect_b32 s32, s15, -1
  s_getpc_b64 s[36:37]
  s_setpc_b64 s[38:39]
  s_lshl_b32 s23, s22, 2
  s_add_u32 s23, s23, s20
  s_mul_i32 s13, s23, 163840
  s_add_u32 s13, s13, 4194304
  s_lshl_b32 s23, s23, 7
  s_add_u32 s23, s23, 2654208
  v_and_b32 v9, 31, v1
  v_lshl_add_u32 v9, v9, 2, s23
  v_and_b32 v10, 15, v1
  v_lshlrev_b32 v10, 2, v10
  v_add_u32 v10, 2629632, v10
  buffer_load_dword v8, v9, s[40:43], 0 offen sc1
  buffer_load_dword v15, v10, s[40:43], 0 offen sc1
  v_mov_b32 v20, v228
  v_mov_b32 v21, v229
  s_nop 1
  v_permlane16_swap_b32 v228, v20
  v_permlane16_swap_b32 v229, v21
  v_add_f32 v228, v228, v20
  v_add_f32 v229, v229, v21
  v_mov_b32 v20, v228
  v_mov_b32 v21, v229
  s_nop 1
  v_permlane32_swap_b32 v228, v20
  v_permlane32_swap_b32 v229, v21
  v_add_f32 v228, v228, v20
  v_add_f32 v229, v229, v21
  v_rcp_f32 v16, v228
  v_rcp_f32 v18, v229
  s_lshl_b32 s23, s22, 2
  v_mov_b32 v17, v16
  v_mov_b32 v19, v18
  s_add_u32 s23, s23, s20
  s_lshl_b32 s23, s23, 18
  s_lshl_b32 s31, s21, 12
  s_add_u32 s31, s31, 50331648
  s_add_u32 s64, s23, s31
  s_add_u32 s65, s64, 131072
  v_accvgpr_read_b32 v36, a0
  v_accvgpr_read_b32 v37, a1
  v_accvgpr_read_b32 v38, a2
  v_accvgpr_read_b32 v39, a3
  v_accvgpr_read_b32 v40, a8
  v_accvgpr_read_b32 v41, a9
  v_accvgpr_read_b32 v42, a10
  v_accvgpr_read_b32 v43, a11
  v_pk_mul_f32 v[36:37], v[36:37], v[16:17]
  v_pk_mul_f32 v[38:39], v[38:39], v[16:17]
  v_pk_mul_f32 v[40:41], v[40:41], v[16:17]
  v_pk_mul_f32 v[42:43], v[42:43], v[16:17]
  v_cvt_pk_bf16_f32 v32, v36, v37
  v_cvt_pk_bf16_f32 v33, v38, v39
  v_cvt_pk_bf16_f32 v34, v40, v41
  v_cvt_pk_bf16_f32 v35, v42, v43
  buffer_store_dwordx4 v[32:35], v2, s[40:43], s64 offen offset:0 sc1
  v_accvgpr_read_b32 v48, a16
  v_accvgpr_read_b32 v49, a17
  v_accvgpr_read_b32 v50, a18
  v_accvgpr_read_b32 v51, a19
  v_accvgpr_read_b32 v52, a24
  v_accvgpr_read_b32 v53, a25
  v_accvgpr_read_b32 v54, a26
  v_accvgpr_read_b32 v55, a27
  v_pk_mul_f32 v[48:49], v[48:49], v[16:17]
  v_pk_mul_f32 v[50:51], v[50:51], v[16:17]
  v_pk_mul_f32 v[52:53], v[52:53], v[16:17]
  v_pk_mul_f32 v[54:55], v[54:55], v[16:17]
  v_cvt_pk_bf16_f32 v44, v48, v49
  v_cvt_pk_bf16_f32 v45, v50, v51
  v_cvt_pk_bf16_f32 v46, v52, v53
  v_cvt_pk_bf16_f32 v47, v54, v55
  buffer_store_dwordx4 v[44:47], v2, s[40:43], s64 offen offset:1024 sc1
  v_accvgpr_read_b32 v100, a32
  v_accvgpr_read_b32 v101, a33
  v_accvgpr_read_b32 v102, a34
  v_accvgpr_read_b32 v103, a35
  v_accvgpr_read_b32 v104, a40
  v_accvgpr_read_b32 v105, a41
  v_accvgpr_read_b32 v106, a42
  v_accvgpr_read_b32 v107, a43
  v_pk_mul_f32 v[100:101], v[100:101], v[16:17]
  v_pk_mul_f32 v[102:103], v[102:103], v[16:17]
  v_pk_mul_f32 v[104:105], v[104:105], v[16:17]
  v_pk_mul_f32 v[106:107], v[106:107], v[16:17]
  v_cvt_pk_bf16_f32 v96, v100, v101
  v_cvt_pk_bf16_f32 v97, v102, v103
  v_cvt_pk_bf16_f32 v98, v104, v105
  v_cvt_pk_bf16_f32 v99, v106, v107
  buffer_store_dwordx4 v[96:99], v2, s[40:43], s64 offen offset:2048 sc1
  v_accvgpr_read_b32 v112, a48
  v_accvgpr_read_b32 v113, a49
  v_accvgpr_read_b32 v114, a50
  v_accvgpr_read_b32 v115, a51
  v_accvgpr_read_b32 v116, a56
  v_accvgpr_read_b32 v117, a57
  v_accvgpr_read_b32 v118, a58
  v_accvgpr_read_b32 v119, a59
  v_pk_mul_f32 v[112:113], v[112:113], v[16:17]
  v_pk_mul_f32 v[114:115], v[114:115], v[16:17]
  v_pk_mul_f32 v[116:117], v[116:117], v[16:17]
  v_pk_mul_f32 v[118:119], v[118:119], v[16:17]
  v_cvt_pk_bf16_f32 v108, v112, v113
  v_cvt_pk_bf16_f32 v109, v114, v115
  v_cvt_pk_bf16_f32 v110, v116, v117
  v_cvt_pk_bf16_f32 v111, v118, v119
  buffer_store_dwordx4 v[108:111], v2, s[40:43], s64 offen offset:3072 sc1
  v_accvgpr_read_b32 v36, a4
  v_accvgpr_read_b32 v37, a5
  v_accvgpr_read_b32 v38, a6
  v_accvgpr_read_b32 v39, a7
  v_accvgpr_read_b32 v40, a12
  v_accvgpr_read_b32 v41, a13
  v_accvgpr_read_b32 v42, a14
  v_accvgpr_read_b32 v43, a15
  v_pk_mul_f32 v[36:37], v[36:37], v[18:19]
  v_pk_mul_f32 v[38:39], v[38:39], v[18:19]
  v_pk_mul_f32 v[40:41], v[40:41], v[18:19]
  v_pk_mul_f32 v[42:43], v[42:43], v[18:19]
  v_cvt_pk_bf16_f32 v32, v36, v37
  v_cvt_pk_bf16_f32 v33, v38, v39
  v_cvt_pk_bf16_f32 v34, v40, v41
  v_cvt_pk_bf16_f32 v35, v42, v43
  buffer_store_dwordx4 v[32:35], v2, s[40:43], s65 offen offset:0 sc1
  v_accvgpr_read_b32 v48, a20
  v_accvgpr_read_b32 v49, a21
  v_accvgpr_read_b32 v50, a22
  v_accvgpr_read_b32 v51, a23
  v_accvgpr_read_b32 v52, a28
  v_accvgpr_read_b32 v53, a29
  v_accvgpr_read_b32 v54, a30
  v_accvgpr_read_b32 v55, a31
  v_pk_mul_f32 v[48:49], v[48:49], v[18:19]
  v_pk_mul_f32 v[50:51], v[50:51], v[18:19]
  v_pk_mul_f32 v[52:53], v[52:53], v[18:19]
  v_pk_mul_f32 v[54:55], v[54:55], v[18:19]
  v_cvt_pk_bf16_f32 v44, v48, v49
  v_cvt_pk_bf16_f32 v45, v50, v51
  v_cvt_pk_bf16_f32 v46, v52, v53
  v_cvt_pk_bf16_f32 v47, v54, v55
  buffer_store_dwordx4 v[44:47], v2, s[40:43], s65 offen offset:1024 sc1
  v_accvgpr_read_b32 v100, a36
  v_accvgpr_read_b32 v101, a37
  v_accvgpr_read_b32 v102, a38
  v_accvgpr_read_b32 v103, a39
  v_accvgpr_read_b32 v104, a44
  v_accvgpr_read_b32 v105, a45
  v_accvgpr_read_b32 v106, a46
  v_accvgpr_read_b32 v107, a47
  v_pk_mul_f32 v[100:101], v[100:101], v[18:19]
  v_pk_mul_f32 v[102:103], v[102:103], v[18:19]
  v_pk_mul_f32 v[104:105], v[104:105], v[18:19]
  v_pk_mul_f32 v[106:107], v[106:107], v[18:19]
  v_cvt_pk_bf16_f32 v96, v100, v101
  v_cvt_pk_bf16_f32 v97, v102, v103
  v_cvt_pk_bf16_f32 v98, v104, v105
  v_cvt_pk_bf16_f32 v99, v106, v107
  buffer_store_dwordx4 v[96:99], v2, s[40:43], s65 offen offset:2048 sc1
  v_accvgpr_read_b32 v112, a52
  v_accvgpr_read_b32 v113, a53
  v_accvgpr_read_b32 v114, a54
  v_accvgpr_read_b32 v115, a55
  v_accvgpr_read_b32 v116, a60
  v_accvgpr_read_b32 v117, a61
  v_accvgpr_read_b32 v118, a62
  v_accvgpr_read_b32 v119, a63
  v_pk_mul_f32 v[112:113], v[112:113], v[18:19]
  v_pk_mul_f32 v[114:115], v[114:115], v[18:19]
  v_pk_mul_f32 v[116:117], v[116:117], v[18:19]
  v_pk_mul_f32 v[118:119], v[118:119], v[18:19]
  v_cvt_pk_bf16_f32 v108, v112, v113
  v_cvt_pk_bf16_f32 v109, v114, v115
  v_cvt_pk_bf16_f32 v110, v116, v117
  v_cvt_pk_bf16_f32 v111, v118, v119
  buffer_store_dwordx4 v[108:111], v2, s[40:43], s65 offen offset:3072 sc1
  s_mov_b32 s28, s46
  s_add_u32 s30, s28, 65536
  s_lshl_b32 s23, s20, 12
  s_add_u32 s23, s23, s28
  s_add_u32 s31, s13, 98304
  s_sub_u32 s31, s31, s23
  s_add_u32 s4, s18, s31
  s_addc_u32 s5, s19, 0
  s_add_u32 s6, s4, 4096
  s_addc_u32 s7, s5, 0
  s_waitcnt vmcnt(8)
  v_cmp_eq_u32 vcc, 0, v8
  s_cbranch_vccnz fa_wof_spin
fa_wof_ok:
  v_cmp_eq_u32 vcc, 0, v15
  s_cbranch_vccnz fa_sel4_spin
fa_sel4_ok:
  s_lshl_b32 s31, s21, 6
  s_add_u32 s31, s31, 1
  v_subrev_u32 v16, s31, v15
  v_cmp_gt_u32 vcc, 64, v16
  s_cmp_lt_u32 s20, 2
  s_cselect_b32 s23, 0xff, 0
  s_and_b32 s10, vcc_lo, s23
  s_sub_u32 s23, s10, 1
  s_and_b32 s23, s23, s10
  s_cmp_eq_u32 s20, 1
  s_cselect_b32 s10, s23, s10
  s_cmp_eq_u32 s10, 0
  s_cbranch_scc1 fa_coEnd
  v_min_u32 v11, 53, v1
  s_lshr_b32 s23, s22, 1
  s_lshl_b32 s23, s23, 8
  s_add_u32 s23, s23, 2650112
  v_lshl_add_u32 v11, v11, 2, s23
  buffer_load_dword v14, v11, s[40:43], 0 offen sc1
  v_mul_u32_u24 v16, 3277, v1
  v_lshrrev_b32 v16, 16, v16
  v_mul_u32_u24 v8, 20, v16
  v_sub_u32 v8, v1, v8
  v_lshlrev_b32 v8, 4, v8
  v_mul_u32_u24 v9, 368640, v16
  v_add_u32 v9, v9, v8
  v_cmp_gt_u32 vcc, 3, v16
  v_mov_b32 v19, 1073741824
  s_nop 0
  v_cndmask_b32 v9, v19, v9, vcc
  s_mov_b32 s12, 2
  s_mov_b32 s32, -1
  s_mov_b32 s11, 0
  s_getpc_b64 s[36:37]
  s_setpc_b64 s[38:39]
  v_cmp_eq_u32 vcc, 0, v14
  s_cbranch_vccnz fa_yf_spin
fa_yf_ok:
fa_coY:
  s_ff1_i32_b32 s33, s10
  s_bitset0_b32 s10, s33
  s_sub_u32 s23, s10, 1
  s_and_b32 s10, s10, s23
  s_mul_i32 s14, s33, 2560
  s_mul_i32 s23, s22, 320
  s_add_u32 s14, s14, s23
  s_add_u32 s14, s14, 2686976
  buffer_load_dwordx4 v[64:67], v9, s[40:43], s14 offen sc1
  s_add_u32 s14, s14, 20480
  buffer_load_dwordx4 v[68:71], v9, s[40:43], s14 offen sc1
  s_add_u32 s14, s14, 20480
  buffer_load_dwordx4 v[72:75], v9, s[40:43], s14 offen sc1
  s_add_u32 s14, s14, 20480
  buffer_load_dwordx4 v[76:79], v9, s[40:43], s14 offen sc1
  s_add_u32 s14, s14, 20480
  buffer_load_dwordx4 v[80:83], v9, s[40:43], s14 offen sc1
  s_add_u32 s14, s14, 20480
  buffer_load_dwordx4 v[84:87], v9, s[40:43], s14 offen sc1
  s_add_u32 s14, s14, 20480
  buffer_load_dwordx4 v[88:91], v9, s[40:43], s14 offen sc1
  s_add_u32 s14, s14, 20480
  buffer_load_dwordx4 v[92:95], v9, s[40:43], s14 offen sc1
  s_add_u32 s14, s14, 20480
  buffer_load_dwordx4 v[128:131], v9, s[40:43], s14 offen sc1
  s_add_u32 s14, s14, 20480
  buffer_load_dwordx4 v[132:135], v9, s[40:43], s14 offen sc1
  s_add_u32 s14, s14, 20480
  buffer_load_dwordx4 v[136:139], v9, s[40:43], s14 offen sc1
  s_add_u32 s14, s14, 20480
  buffer_load_dwordx4 v[140:143], v9, s[40:43], s14 offen sc1
  s_add_u32 s14, s14, 20480
  buffer_load_dwordx4 v[144:147], v9, s[40:43], s14 offen sc1
  s_add_u32 s14, s14, 20480
  buffer_load_dwordx4 v[148:151], v9, s[40:43], s14 offen sc1
  s_add_u32 s14, s14, 20480
  buffer_load_dwordx4 v[152:155], v9, s[40:43], s14 offen sc1
  s_add_u32 s14, s14, 20480
  buffer_load_dwordx4 v[156:159], v9, s[40:43], s14 offen sc1
  s_add_u32 s14, s14, 20480
  buffer_load_dwordx4 v[176:179], v9, s[40:43], s14 offen sc1
  s_add_u32 s14, s14, 20480
  buffer_load_dwordx4 v[180:183], v9, s[40:43], s14 offen sc1
  s_add_u32 s14, s14, 20480
  s_lshl_b32 s14, s20, 10
  s_add_u32 s14, s14, 159744
  v_add_u32 v19, s14, v2
  s_add_u32 s23, s33, 8
  v_readlane_b32 s35, v15, s23
  s_waitcnt vmcnt(0)
  v_pk_add_f32 v[64:65], v[64:65], v[68:69]
  v_pk_add_f32 v[66:67], v[66:67], v[70:71]
  v_pk_add_f32 v[64:65], v[64:65], v[72:73]
  v_pk_add_f32 v[66:67], v[66:67], v[74:75]
  v_pk_add_f32 v[64:65], v[64:65], v[76:77]
  v_pk_add_f32 v[66:67], v[66:67], v[78:79]
  v_pk_add_f32 v[64:65], v[64:65], v[80:81]
  v_pk_add_f32 v[66:67], v[66:67], v[82:83]
  v_pk_add_f32 v[64:65], v[64:65], v[84:85]
  v_pk_add_f32 v[66:67], v[66:67], v[86:87]
  v_pk_add_f32 v[64:65], v[64:65], v[88:89]
  v_pk_add_f32 v[66:67], v[66:67], v[90:91]
  v_pk_add_f32 v[64:65], v[64:65], v[92:93]
  v_pk_add_f32 v[66:67], v[66:67], v[94:95]
  v_pk_add_f32 v[64:65], v[64:65], v[128:129]
  v_pk_add_f32 v[66:67], v[66:67], v[130:131]
  v_pk_add_f32 v[64:65], v[64:65], v[132:133]
  v_pk_add_f32 v[66:67], v[66:67], v[134:135]
  v_pk_add_f32 v[64:65], v[64:65], v[136:137]
  v_pk_add_f32 v[66:67], v[66:67], v[138:139]
  v_pk_add_f32 v[64:65], v[64:65], v[140:141]
  v_pk_add_f32 v[66:67], v[66:67], v[142:143]
  v_pk_add_f32 v[64:65], v[64:65], v[144:145]
  v_pk_add_f32 v[66:67], v[66:67], v[146:147]
  v_pk_add_f32 v[64:65], v[64:65], v[148:149]
  v_pk_add_f32 v[66:67], v[66:67], v[150:151]
  v_pk_add_f32 v[64:65], v[64:65], v[152:153]
  v_pk_add_f32 v[66:67], v[66:67], v[154:155]
  v_pk_add_f32 v[64:65], v[64:65], v[156:157]
  v_pk_add_f32 v[66:67], v[66:67], v[158:159]
  v_pk_add_f32 v[64:65], v[64:65], v[176:177]
  v_pk_add_f32 v[66:67], v[66:67], v[178:179]
  v_pk_add_f32 v[64:65], v[64:65], v[180:181]
  v_pk_add_f32 v[66:67], v[66:67], v[182:183]
  ds_write_b128 v19, v[64:67]
  v_add_u32 v19, s14, v8
  s_and_b32 s35, s35, 0xffff0000
  s_waitcnt lgkmcnt(0)
  ds_read_b128 v[64:67], v19
  ds_read_b128 v[68:71], v19 offset:320
  ds_read_b128 v[72:75], v19 offset:640
  s_mul_i32 s14, s33, 320
  s_add_u32 s14, s14, 155648
  v_add_u32 v19, s14, v8
  s_waitcnt lgkmcnt(0)
  v_add_f32 v64, v64, v68
  v_add_f32 v64, v64, v72
  v_cvt_pk_bf16_f32 v64, v64, v64
  v_and_b32 v64, 0xffff0000, v64
  v_mul_f32 v64, s35, v64
  v_cvt_pk_bf16_f32 v64, v64, v64
  v_and_b32 v64, 0xffff0000, v64
  v_add_f32 v65, v65, v69
  v_add_f32 v65, v65, v73
  v_cvt_pk_bf16_f32 v65, v65, v65
  v_and_b32 v65, 0xffff0000, v65
  v_mul_f32 v65, s35, v65
  v_cvt_pk_bf16_f32 v65, v65, v65
  v_and_b32 v65, 0xffff0000, v65
  v_add_f32 v66, v66, v70
  v_add_f32 v66, v66, v74
  v_cvt_pk_bf16_f32 v66, v66, v66
  v_and_b32 v66, 0xffff0000, v66
  v_mul_f32 v66, s35, v66
  v_cvt_pk_bf16_f32 v66, v66, v66
  v_and_b32 v66, 0xffff0000, v66
  v_add_f32 v67, v67, v71
  v_add_f32 v67, v67, v75
  v_cvt_pk_bf16_f32 v67, v67, v67
  v_and_b32 v67, 0xffff0000, v67
  v_mul_f32 v67, s35, v67
  v_cvt_pk_bf16_f32 v67, v67, v67
  v_and_b32 v67, 0xffff0000, v67
  ds_write_b128 v19, v[64:67]
  s_waitcnt lgkmcnt(0)
  s_cmp_lg_u32 s10, 0
  s_cbranch_scc1 fa_coY
fa_coEnd:
  s_mov_b32 s12, 3
  s_mov_b32 s32, -1
  s_setpc_b64 s[38:39]
fa_hk7:
  s_getpc_b64 s[38:39]
fa_hp7:
  s_add_u32 s36, s36, 4
  s_addc_u32 s37, s37, 0
  s_sub_u32 s38, s38, fa_hp7-fa_hb7
  s_subb_u32 s39, s39, 0
  s_setpc_b64 s[36:37]
fa_hk8:
  s_getpc_b64 s[38:39]
fa_hp8:
  s_add_u32 s36, s36, 4
  s_addc_u32 s37, s37, 0
  s_sub_u32 s38, s38, fa_hp8-fa_hb8
  s_subb_u32 s39, s39, 0
  s_setpc_b64 s[36:37]
fa_disp:
  s_cmp_eq_u32 s29, 7
  s_cbranch_scc1 fa_SSW7
  s_cmp_eq_u32 s29, 6
  s_cbranch_scc1 fa_SSW6
  s_cmp_eq_u32 s29, 5
  s_cbranch_scc1 fa_SSW5
  s_cmp_eq_u32 s29, 4
  s_cbranch_scc1 fa_SSW4
  s_cmp_eq_u32 s29, 3
  s_cbranch_scc1 fa_SSW3
  s_cmp_eq_u32 s29, 2
  s_cbranch_scc1 fa_SSW2
  s_cmp_eq_u32 s29, 1
  s_cbranch_scc1 fa_SSW1
  s_branch fa_Bexit
fa_hk9:
  s_getpc_b64 s[38:39]
fa_hp9:
  s_add_u32 s36, s36, 4
  s_addc_u32 s37, s37, 0
  s_add_u32 s38, s38, fa_hb9-fa_hp9
  s_addc_u32 s39, s39, 0
  s_setpc_b64 s[36:37]
fa_puby:
  s_waitcnt vmcnt(0)
  buffer_store_dword v4, v30, s[40:43], 0 offen sc1
  s_cmp_lt_u32 s12, 3
  s_cbranch_scc1 fa_hk9
fa_hb9:
  s_add_u32 s14, s13, 61440
  buffer_load_dwordx4 v[64:67], v2, s[40:43], s14 offen offset:0 sc1
  buffer_load_dwordx4 v[68:71], v2, s[40:43], s14 offen offset:1024 sc1
  buffer_load_dwordx4 v[72:75], v2, s[40:43], s14 offen offset:2048 sc1
  buffer_load_dwordx4 v[76:79], v2, s[40:43], s14 offen offset:3072 sc1
  s_branch fa_pubb
fa_left:
  s_add_u32 s14, s13, 0
  buffer_load_dwordx4 a[192:195], v2, s[40:43], s14 offen offset:0 sc1
  buffer_load_dwordx4 a[196:199], v2, s[40:43], s14 offen offset:1024 sc1
  buffer_load_dwordx4 a[200:203], v2, s[40:43], s14 offen offset:2048 sc1
  s_cmp_ge_u32 s29, 7
  s_cbranch_scc1 fa_leftb
  s_add_u32 s14, s13, 0
  buffer_load_dwordx4 a[204:207], v2, s[40:43], s14 offen offset:3072 sc1
  s_add_u32 s14, s13, 4096
  buffer_load_dwordx4 a[208:211], v2, s[40:43], s14 offen offset:0 sc1
  buffer_load_dwordx4 a[212:215], v2, s[40:43], s14 offen offset:1024 sc1
  s_cmp_ge_u32 s29, 6
  s_cbranch_scc1 fa_leftb
  s_add_u32 s14, s13, 4096
  buffer_load_dwordx4 a[216:219], v2, s[40:43], s14 offen offset:2048 sc1
  buffer_load_dwordx4 a[220:223], v2, s[40:43], s14 offen offset:3072 sc1
  s_add_u32 s14, s13, 8192
  buffer_load_dwordx4 a[224:227], v2, s[40:43], s14 offen offset:0 sc1
  buffer_load_dwordx4 a[228:231], v2, s[40:43], s14 offen offset:1024 sc1
  s_cmp_ge_u32 s29, 5
  s_cbranch_scc1 fa_leftb
  s_add_u32 s14, s13, 8192
  buffer_load_dwordx4 a[232:235], v2, s[40:43], s14 offen offset:2048 sc1
  buffer_load_dwordx4 a[236:239], v2, s[40:43], s14 offen offset:3072 sc1
  s_add_u32 s14, s13, 12288
  buffer_load_dwordx4 a[240:243], v2, s[40:43], s14 offen offset:0 sc1
  buffer_load_dwordx4 a[244:247], v2, s[40:43], s14 offen offset:1024 sc1
  buffer_load_dwordx4 a[248:251], v2, s[40:43], s14 offen offset:2048 sc1
  buffer_load_dwordx4 a[252:255], v2, s[40:43], s14 offen offset:3072 sc1
fa_left4:
  s_cmp_ge_u32 s29, 4
  s_cbranch_scc1 fa_leftb
  s_add_u32 s14, s13, 16384
  buffer_load_dwordx4 a[0:3], v2, s[40:43], s14 offen offset:0 sc1
  buffer_load_dwordx4 a[4:7], v2, s[40:43], s14 offen offset:1024 sc1
  buffer_load_dwordx4 a[8:11], v2, s[40:43], s14 offen offset:2048 sc1
  buffer_load_dwordx4 a[12:15], v2, s[40:43], s14 offen offset:3072 sc1
  s_add_u32 s14, s13, 20480
  buffer_load_dwordx4 a[16:19], v2, s[40:43], s14 offen offset:0 sc1
  buffer_load_dwordx4 a[20:23], v2, s[40:43], s14 offen offset:1024 sc1
  buffer_load_dwordx4 a[24:27], v2, s[40:43], s14 offen offset:2048 sc1
  buffer_load_dwordx4 a[28:31], v2, s[40:43], s14 offen offset:3072 sc1
  s_cmp_ge_u32 s29, 3
  s_cbranch_scc1 fa_leftb
  s_add_u32 s14, s13, 24576
  buffer_load_dwordx4 a[32:35], v2, s[40:43], s14 offen offset:0 sc1
  buffer_load_dwordx4 a[36:39], v2, s[40:43], s14 offen offset:1024 sc1
  buffer_load_dwordx4 a[40:43], v2, s[40:43], s14 offen offset:2048 sc1
  buffer_load_dwordx4 a[44:47], v2, s[40:43], s14 offen offset:3072 sc1
  s_add_u32 s14, s13, 28672
  buffer_load_dwordx4 a[48:51], v2, s[40:43], s14 offen offset:0 sc1
  buffer_load_dwordx4 a[52:55], v2, s[40:43], s14 offen offset:1024 sc1
  buffer_load_dwordx4 a[56:59], v2, s[40:43], s14 offen offset:2048 sc1
  buffer_load_dwordx4 a[60:63], v2, s[40:43], s14 offen offset:3072 sc1
  s_cmp_ge_u32 s29, 2
  s_cbranch_scc1 fa_leftb
  s_add_u32 s14, s13, 32768
  buffer_load_dwordx4 v[32:35], v2, s[40:43], s14 offen offset:0 sc1
  buffer_load_dwordx4 v[36:39], v2, s[40:43], s14 offen offset:1024 sc1
  buffer_load_dwordx4 v[40:43], v2, s[40:43], s14 offen offset:2048 sc1
  buffer_load_dwordx4 v[44:47], v2, s[40:43], s14 offen offset:3072 sc1
  s_add_u32 s14, s13, 36864
  buffer_load_dwordx4 v[48:51], v2, s[40:43], s14 offen offset:0 sc1
  buffer_load_dwordx4 v[52:55], v2, s[40:43], s14 offen offset:1024 sc1
  buffer_load_dwordx4 v[56:59], v2, s[40:43], s14 offen offset:2048 sc1
  buffer_load_dwordx4 v[60:63], v2, s[40:43], s14 offen offset:3072 sc1
  s_cmp_ge_u32 s29, 1
  s_cbranch_scc1 fa_leftb
  s_add_u32 s14, s13, 40960
  buffer_load_dwordx4 v[96:99], v2, s[40:43], s14 offen offset:0 sc1
  buffer_load_dwordx4 v[100:103], v2, s[40:43], s14 offen offset:1024 sc1
  buffer_load_dwordx4 v[104:107], v2, s[40:43], s14 offen offset:2048 sc1
  buffer_load_dwordx4 v[108:111], v2, s[40:43], s14 offen offset:3072 sc1
  s_add_u32 s14, s13, 45056
  buffer_load_dwordx4 v[112:115], v2, s[40:43], s14 offen offset:0 sc1
  buffer_load_dwordx4 v[116:119], v2, s[40:43], s14 offen offset:1024 sc1
  buffer_load_dwordx4 v[120:123], v2, s[40:43], s14 offen offset:2048 sc1
  buffer_load_dwordx4 v[124:127], v2, s[40:43], s14 offen offset:3072 sc1
  s_branch fa_leftb
fa_ctx_spin:
  s_mov_b32 s83, 200000
fa_ctx_spin2:
  buffer_load_dword v13, v12, s[40:43], 0 offen sc1
  s_waitcnt vmcnt(0)
  v_cmp_eq_u32 vcc, 0, v13
  s_cbranch_vccz fa_ctx_ok
  s_sleep 8
  s_sub_u32 s83, s83, 1
  s_cmp_lg_u32 s83, 0
  s_cbranch_scc1 fa_ctx_spin2
  s_branch fa_ctx_ok
fa_stub0:
  s_call_b64 s[76:77], fa_rare00
  s_call_b64 s[76:77], fa_rare10
  s_branch fa_back0
fa_stub1:
  s_call_b64 s[76:77], fa_rare01
  s_call_b64 s[76:77], fa_rare11
  s_branch fa_back1
fa_stub2:
  s_call_b64 s[76:77], fa_rare00
  s_call_b64 s[76:77], fa_rare10
  s_branch fa_back2
fa_stub3:
  s_call_b64 s[76:77], fa_rare01
  s_call_b64 s[76:77], fa_rare11
  s_branch fa_back3
fa_stub4:
  s_call_b64 s[76:77], fa_rare01
  s_call_b64 s[76:77], fa_rare11
  s_branch fa_back4
fa_stub5:
  s_call_b64 s[76:77], fa_rare00
  s_call_b64 s[76:77], fa_rare10
  s_branch fa_back5
fa_stub6:
  s_call_b64 s[76:77], fa_rare11
  s_branch fa_back6
fa_stub7:
  s_call_b64 s[76:77], fa_rare10
  s_branch fa_back7
fa_stub8:
  s_call_b64 s[76:77], fa_rare01
  s_call_b64 s[76:77], fa_rare11
  s_branch fa_back8
fa_stub9:
  s_call_b64 s[76:77], fa_rare10
  s_branch fa_back9
fa_stub10:
  s_call_b64 s[76:77], fa_rare11
  s_branch fa_back10
fa_stub11:
  s_call_b64 s[76:77], fa_rare10
  s_branch fa_back11
fa_stub12:
  s_call_b64 s[76:77], fa_rare11
  s_branch fa_back12
fa_stub13:
  s_call_b64 s[76:77], fa_rare10
  s_branch fa_back13
fa_stub14:
  s_call_b64 s[76:77], fa_rare11
  s_branch fa_back14
fa_stub15:
  s_call_b64 s[76:77], fa_rare10
  s_branch fa_back15
fa_stub16:
  s_call_b64 s[76:77], fa_rare11
  s_branch fa_back16
fa_stub17:
  s_call_b64 s[76:77], fa_rare10
  s_branch fa_back17
fa_stub18:
  s_call_b64 s[76:77], fa_rare11
  s_branch fa_back18
fa_stub19:
  s_call_b64 s[76:77], fa_rare10
  s_branch fa_back19
fa_stub20:
  s_call_b64 s[76:77], fa_rare11
  s_branch fa_back20
fa_stub21:
  s_call_b64 s[76:77], fa_rare10
  s_branch fa_back21
fa_stub22:
  s_call_b64 s[76:77], fa_rare11
  s_branch fa_back22
fa_stub23:
  s_call_b64 s[76:77], fa_rare10
  s_branch fa_back23
fa_stub24:
  s_call_b64 s[76:77], fa_rare11
  s_branch fa_back24
fa_stub25:
  s_call_b64 s[76:77], fa_rare10
  s_branch fa_back25
fa_stub26:
  s_call_b64 s[76:77], fa_rare11
  s_branch fa_back26
fa_stub27:
  s_call_b64 s[76:77], fa_rare10
  s_branch fa_back27
fa_stub28:
  s_call_b64 s[76:77], fa_rare11
  s_branch fa_back28
fa_stub29:
  s_call_b64 s[76:77], fa_rare10
  s_branch fa_back29
fa_stub30:
  s_call_b64 s[76:77], fa_rare11
  s_branch fa_back30
fa_codeend:
fa_rare00:
  s_nop 7
  v_max3_f32 v16, v96, v97, v98
  v_max3_f32 v16, v16, v99, v100
  v_max3_f32 v16, v16, v101, v102
  v_max3_f32 v16, v16, v103, 0
  v_mov_b32 v18, v16
  s_nop 1
  v_permlane16_swap_b32 v16, v18
  v_max_f32 v16, v16, v18
  v_mov_b32 v18, v16
  s_nop 1
  v_permlane32_swap_b32 v16, v18
  v_max_f32 v16, v16, v18
  v_sub_f32 v96, v96, v16
  v_sub_f32 v112, v112, v16
  v_sub_f32 v97, v97, v16
  v_sub_f32 v113, v113, v16
  v_sub_f32 v98, v98, v16
  v_sub_f32 v114, v114, v16
  v_sub_f32 v99, v99, v16
  v_sub_f32 v115, v115, v16
  v_sub_f32 v100, v100, v16
  v_sub_f32 v116, v116, v16
  v_sub_f32 v101, v101, v16
  v_sub_f32 v117, v117, v16
  v_sub_f32 v102, v102, v16
  v_sub_f32 v118, v118, v16
  v_sub_f32 v103, v103, v16
  v_sub_f32 v119, v119, v16
  v_max3_f32 v17, v104, v105, v106
  v_max3_f32 v17, v17, v107, v108
  v_max3_f32 v17, v17, v109, v110
  v_max3_f32 v17, v17, v111, 0
  v_mov_b32 v18, v17
  s_nop 1
  v_permlane16_swap_b32 v17, v18
  v_max_f32 v17, v17, v18
  v_mov_b32 v18, v17
  s_nop 1
  v_permlane32_swap_b32 v17, v18
  v_max_f32 v17, v17, v18
  v_sub_f32 v104, v104, v17
  v_sub_f32 v120, v120, v17
  v_sub_f32 v105, v105, v17
  v_sub_f32 v121, v121, v17
  v_sub_f32 v106, v106, v17
  v_sub_f32 v122, v122, v17
  v_sub_f32 v107, v107, v17
  v_sub_f32 v123, v123, v17
  v_sub_f32 v108, v108, v17
  v_sub_f32 v124, v124, v17
  v_sub_f32 v109, v109, v17
  v_sub_f32 v125, v125, v17
  v_sub_f32 v110, v110, v17
  v_sub_f32 v126, v126, v17
  v_sub_f32 v111, v111, v17
  v_sub_f32 v127, v127, v17
  s_call_b64 s[78:79], fa_resc0
  v_exp_f32 v208, v96
  v_exp_f32 v209, v97
  v_exp_f32 v210, v98
  v_add_f32 v224, v208, v209
  v_cvt_pk_bf16_f32 v160, v208, v209
  v_exp_f32 v211, v99
  v_add_f32 v224, v224, v210
  v_exp_f32 v212, v100
  v_add_f32 v224, v224, v211
  v_cvt_pk_bf16_f32 v161, v210, v211
  v_exp_f32 v213, v101
  v_add_f32 v224, v224, v212
  v_exp_f32 v214, v102
  v_add_f32 v224, v224, v213
  v_cvt_pk_bf16_f32 v162, v212, v213
  v_exp_f32 v215, v103
  v_add_f32 v224, v224, v214
  v_exp_f32 v208, v104
  v_add_f32 v224, v224, v215
  v_cvt_pk_bf16_f32 v163, v214, v215
  v_exp_f32 v209, v105
  v_exp_f32 v210, v106
  v_add_f32 v225, v208, v209
  v_cvt_pk_bf16_f32 v164, v208, v209
  v_exp_f32 v211, v107
  v_add_f32 v225, v225, v210
  v_exp_f32 v212, v108
  v_add_f32 v225, v225, v211
  v_cvt_pk_bf16_f32 v165, v210, v211
  v_exp_f32 v213, v109
  v_add_f32 v225, v225, v212
  v_exp_f32 v214, v110
  v_add_f32 v225, v225, v213
  v_cvt_pk_bf16_f32 v166, v212, v213
  v_exp_f32 v215, v111
  v_add_f32 v225, v225, v214
  s_nop 0
  v_add_f32 v225, v225, v215
  v_cvt_pk_bf16_f32 v167, v214, v215
  s_nop 1
  s_setpc_b64 s[76:77]
fa_rare01:
  s_nop 7
  v_max3_f32 v16, v112, v113, v114
  v_max3_f32 v16, v16, v115, v116
  v_max3_f32 v16, v16, v117, v118
  v_max3_f32 v16, v16, v119, 0
  v_mov_b32 v18, v16
  s_nop 1
  v_permlane16_swap_b32 v16, v18
  v_max_f32 v16, v16, v18
  v_mov_b32 v18, v16
  s_nop 1
  v_permlane32_swap_b32 v16, v18
  v_max_f32 v16, v16, v18
  v_sub_f32 v112, v112, v16
  v_sub_f32 v96, v96, v16
  v_sub_f32 v113, v113, v16
  v_sub_f32 v97, v97, v16
  v_sub_f32 v114, v114, v16
  v_sub_f32 v98, v98, v16
  v_sub_f32 v115, v115, v16
  v_sub_f32 v99, v99, v16
  v_sub_f32 v116, v116, v16
  v_sub_f32 v100, v100, v16
  v_sub_f32 v117, v117, v16
  v_sub_f32 v101, v101, v16
  v_sub_f32 v118, v118, v16
  v_sub_f32 v102, v102, v16
  v_sub_f32 v119, v119, v16
  v_sub_f32 v103, v103, v16
  v_max3_f32 v17, v120, v121, v122
  v_max3_f32 v17, v17, v123, v124
  v_max3_f32 v17, v17, v125, v126
  v_max3_f32 v17, v17, v127, 0
  v_mov_b32 v18, v17
  s_nop 1
  v_permlane16_swap_b32 v17, v18
  v_max_f32 v17, v17, v18
  v_mov_b32 v18, v17
  s_nop 1
  v_permlane32_swap_b32 v17, v18
  v_max_f32 v17, v17, v18
  v_sub_f32 v120, v120, v17
  v_sub_f32 v104, v104, v17
  v_sub_f32 v121, v121, v17
  v_sub_f32 v105, v105, v17
  v_sub_f32 v122, v122, v17
  v_sub_f32 v106, v106, v17
  v_sub_f32 v123, v123, v17
  v_sub_f32 v107, v107, v17
  v_sub_f32 v124, v124, v17
  v_sub_f32 v108, v108, v17
  v_sub_f32 v125, v125, v17
  v_sub_f32 v109, v109, v17
  v_sub_f32 v126, v126, v17
  v_sub_f32 v110, v110, v17
  v_sub_f32 v127, v127, v17
  v_sub_f32 v111, v111, v17
  s_call_b64 s[78:79], fa_resc0
  v_exp_f32 v208, v112
  v_exp_f32 v209, v113
  v_exp_f32 v210, v114
  v_add_f32 v224, v208, v209
  v_cvt_pk_bf16_f32 v168, v208, v209
  v_exp_f32 v211, v115
  v_add_f32 v224, v224, v210
  v_exp_f32 v212, v116
  v_add_f32 v224, v224, v211
  v_cvt_pk_bf16_f32 v169, v210, v211
  v_exp_f32 v213, v117
  v_add_f32 v224, v224, v212
  v_exp_f32 v214, v118
  v_add_f32 v224, v224, v213
  v_cvt_pk_bf16_f32 v170, v212, v213
  v_exp_f32 v215, v119
  v_add_f32 v224, v224, v214
  v_exp_f32 v208, v120
  v_add_f32 v224, v224, v215
  v_cvt_pk_bf16_f32 v171, v214, v215
  v_exp_f32 v209, v121
  v_exp_f32 v210, v122
  v_add_f32 v225, v208, v209
  v_cvt_pk_bf16_f32 v172, v208, v209
  v_exp_f32 v211, v123
  v_add_f32 v225, v225, v210
  v_exp_f32 v212, v124
  v_add_f32 v225, v225, v211
  v_cvt_pk_bf16_f32 v173, v210, v211
  v_exp_f32 v213, v125
  v_add_f32 v225, v225, v212
  v_exp_f32 v214, v126
  v_add_f32 v225, v225, v213
  v_cvt_pk_bf16_f32 v174, v212, v213
  v_exp_f32 v215, v127
  v_add_f32 v225, v225, v214
  s_nop 0
  v_add_f32 v225, v225, v215
  v_cvt_pk_bf16_f32 v175, v214, v215
  s_nop 1
  s_setpc_b64 s[76:77]
fa_resc0:
  v_sub_f32 v192, v192, v16
  v_sub_f32 v193, v193, v16
  v_sub_f32 v194, v194, v16
  v_sub_f32 v195, v195, v16
  v_exp_f32 v18, -v16
  v_sub_f32 v196, v196, v17
  v_sub_f32 v197, v197, v17
  v_sub_f32 v198, v198, v17
  v_sub_f32 v199, v199, v17
  v_exp_f32 v19, -v17
  s_nop 0
  v_mul_f32 v228, v228, v18
  v_mul_f32 v229, v229, v19
  v_accvgpr_read_b32 v20, a0
  v_accvgpr_read_b32 v21, a1
  v_accvgpr_read_b32 v22, a2
  v_accvgpr_read_b32 v23, a3
  v_mul_f32 v20, v20, v18
  v_mul_f32 v21, v21, v18
  v_mul_f32 v22, v22, v18
  v_mul_f32 v23, v23, v18
  v_accvgpr_write_b32 a0, v20
  v_accvgpr_write_b32 a1, v21
  v_accvgpr_write_b32 a2, v22
  v_accvgpr_write_b32 a3, v23
  v_accvgpr_read_b32 v20, a4
  v_accvgpr_read_b32 v21, a5
  v_accvgpr_read_b32 v22, a6
  v_accvgpr_read_b32 v23, a7
  v_mul_f32 v20, v20, v19
  v_mul_f32 v21, v21, v19
  v_mul_f32 v22, v22, v19
  v_mul_f32 v23, v23, v19
  v_accvgpr_write_b32 a4, v20
  v_accvgpr_write_b32 a5, v21
  v_accvgpr_write_b32 a6, v22
  v_accvgpr_write_b32 a7, v23
  v_accvgpr_read_b32 v20, a8
  v_accvgpr_read_b32 v21, a9
  v_accvgpr_read_b32 v22, a10
  v_accvgpr_read_b32 v23, a11
  v_mul_f32 v20, v20, v18
  v_mul_f32 v21, v21, v18
  v_mul_f32 v22, v22, v18
  v_mul_f32 v23, v23, v18
  v_accvgpr_write_b32 a8, v20
  v_accvgpr_write_b32 a9, v21
  v_accvgpr_write_b32 a10, v22
  v_accvgpr_write_b32 a11, v23
  v_accvgpr_read_b32 v20, a12
  v_accvgpr_read_b32 v21, a13
  v_accvgpr_read_b32 v22, a14
  v_accvgpr_read_b32 v23, a15
  v_mul_f32 v20, v20, v19
  v_mul_f32 v21, v21, v19
  v_mul_f32 v22, v22, v19
  v_mul_f32 v23, v23, v19
  v_accvgpr_write_b32 a12, v20
  v_accvgpr_write_b32 a13, v21
  v_accvgpr_write_b32 a14, v22
  v_accvgpr_write_b32 a15, v23
  v_accvgpr_read_b32 v20, a16
  v_accvgpr_read_b32 v21, a17
  v_accvgpr_read_b32 v22, a18
  v_accvgpr_read_b32 v23, a19
  v_mul_f32 v20, v20, v18
  v_mul_f32 v21, v21, v18
  v_mul_f32 v22, v22, v18
  v_mul_f32 v23, v23, v18
  v_accvgpr_write_b32 a16, v20
  v_accvgpr_write_b32 a17, v21
  v_accvgpr_write_b32 a18, v22
  v_accvgpr_write_b32 a19, v23
  v_accvgpr_read_b32 v20, a20
  v_accvgpr_read_b32 v21, a21
  v_accvgpr_read_b32 v22, a22
  v_accvgpr_read_b32 v23, a23
  v_mul_f32 v20, v20, v19
  v_mul_f32 v21, v21, v19
  v_mul_f32 v22, v22, v19
  v_mul_f32 v23, v23, v19
  v_accvgpr_write_b32 a20, v20
  v_accvgpr_write_b32 a21, v21
  v_accvgpr_write_b32 a22, v22
  v_accvgpr_write_b32 a23, v23
  v_accvgpr_read_b32 v20, a24
  v_accvgpr_read_b32 v21, a25
  v_accvgpr_read_b32 v22, a26
  v_accvgpr_read_b32 v23, a27
  v_mul_f32 v20, v20, v18
  v_mul_f32 v21, v21, v18
  v_mul_f32 v22, v22, v18
  v_mul_f32 v23, v23, v18
  v_accvgpr_write_b32 a24, v20
  v_accvgpr_write_b32 a25, v21
  v_accvgpr_write_b32 a26, v22
  v_accvgpr_write_b32 a27, v23
  v_accvgpr_read_b32 v20, a28
  v_accvgpr_read_b32 v21, a29
  v_accvgpr_read_b32 v22, a30
  v_accvgpr_read_b32 v23, a31
  v_mul_f32 v20, v20, v19
  v_mul_f32 v21, v21, v19
  v_mul_f32 v22, v22, v19
  v_mul_f32 v23, v23, v19
  v_accvgpr_write_b32 a28, v20
  v_accvgpr_write_b32 a29, v21
  v_accvgpr_write_b32 a30, v22
  v_accvgpr_write_b32 a31, v23
  v_accvgpr_read_b32 v20, a32
  v_accvgpr_read_b32 v21, a33
  v_accvgpr_read_b32 v22, a34
  v_accvgpr_read_b32 v23, a35
  v_mul_f32 v20, v20, v18
  v_mul_f32 v21, v21, v18
  v_mul_f32 v22, v22, v18
  v_mul_f32 v23, v23, v18
  v_accvgpr_write_b32 a32, v20
  v_accvgpr_write_b32 a33, v21
  v_accvgpr_write_b32 a34, v22
  v_accvgpr_write_b32 a35, v23
  v_accvgpr_read_b32 v20, a36
  v_accvgpr_read_b32 v21, a37
  v_accvgpr_read_b32 v22, a38
  v_accvgpr_read_b32 v23, a39
  v_mul_f32 v20, v20, v19
  v_mul_f32 v21, v21, v19
  v_mul_f32 v22, v22, v19
  v_mul_f32 v23, v23, v19
  v_accvgpr_write_b32 a36, v20
  v_accvgpr_write_b32 a37, v21
  v_accvgpr_write_b32 a38, v22
  v_accvgpr_write_b32 a39, v23
  v_accvgpr_read_b32 v20, a40
  v_accvgpr_read_b32 v21, a41
  v_accvgpr_read_b32 v22, a42
  v_accvgpr_read_b32 v23, a43
  v_mul_f32 v20, v20, v18
  v_mul_f32 v21, v21, v18
  v_mul_f32 v22, v22, v18
  v_mul_f32 v23, v23, v18
  v_accvgpr_write_b32 a40, v20
  v_accvgpr_write_b32 a41, v21
  v_accvgpr_write_b32 a42, v22
  v_accvgpr_write_b32 a43, v23
  v_accvgpr_read_b32 v20, a44
  v_accvgpr_read_b32 v21, a45
  v_accvgpr_read_b32 v22, a46
  v_accvgpr_read_b32 v23, a47
  v_mul_f32 v20, v20, v19
  v_mul_f32 v21, v21, v19
  v_mul_f32 v22, v22, v19
  v_mul_f32 v23, v23, v19
  v_accvgpr_write_b32 a44, v20
  v_accvgpr_write_b32 a45, v21
  v_accvgpr_write_b32 a46, v22
  v_accvgpr_write_b32 a47, v23
  v_accvgpr_read_b32 v20, a48
  v_accvgpr_read_b32 v21, a49
  v_accvgpr_read_b32 v22, a50
  v_accvgpr_read_b32 v23, a51
  v_mul_f32 v20, v20, v18
  v_mul_f32 v21, v21, v18
  v_mul_f32 v22, v22, v18
  v_mul_f32 v23, v23, v18
  v_accvgpr_write_b32 a48, v20
  v_accvgpr_write_b32 a49, v21
  v_accvgpr_write_b32 a50, v22
  v_accvgpr_write_b32 a51, v23
  v_accvgpr_read_b32 v20, a52
  v_accvgpr_read_b32 v21, a53
  v_accvgpr_read_b32 v22, a54
  v_accvgpr_read_b32 v23, a55
  v_mul_f32 v20, v20, v19
  v_mul_f32 v21, v21, v19
  v_mul_f32 v22, v22, v19
  v_mul_f32 v23, v23, v19
  v_accvgpr_write_b32 a52, v20
  v_accvgpr_write_b32 a53, v21
  v_accvgpr_write_b32 a54, v22
  v_accvgpr_write_b32 a55, v23
  v_accvgpr_read_b32 v20, a56
  v_accvgpr_read_b32 v21, a57
  v_accvgpr_read_b32 v22, a58
  v_accvgpr_read_b32 v23, a59
  v_mul_f32 v20, v20, v18
  v_mul_f32 v21, v21, v18
  v_mul_f32 v22, v22, v18
  v_mul_f32 v23, v23, v18
  v_accvgpr_write_b32 a56, v20
  v_accvgpr_write_b32 a57, v21
  v_accvgpr_write_b32 a58, v22
  v_accvgpr_write_b32 a59, v23
  v_accvgpr_read_b32 v20, a60
  v_accvgpr_read_b32 v21, a61
  v_accvgpr_read_b32 v22, a62
  v_accvgpr_read_b32 v23, a63
  v_mul_f32 v20, v20, v19
  v_mul_f32 v21, v21, v19
  v_mul_f32 v22, v22, v19
  v_mul_f32 v23, v23, v19
  v_accvgpr_write_b32 a60, v20
  v_accvgpr_write_b32 a61, v21
  v_accvgpr_write_b32 a62, v22
  v_accvgpr_write_b32 a63, v23
  s_setpc_b64 s[78:79]
fa_rare10:
  s_nop 7
  v_max3_f32 v16, v128, v129, v130
  v_max3_f32 v16, v16, v131, v132
  v_max3_f32 v16, v16, v133, v134
  v_max3_f32 v16, v16, v135, 0
  v_mov_b32 v18, v16
  s_nop 1
  v_permlane16_swap_b32 v16, v18
  v_max_f32 v16, v16, v18
  v_mov_b32 v18, v16
  s_nop 1
  v_permlane32_swap_b32 v16, v18
  v_max_f32 v16, v16, v18
  v_sub_f32 v128, v128, v16
  v_sub_f32 v144, v144, v16
  v_sub_f32 v129, v129, v16
  v_sub_f32 v145, v145, v16
  v_sub_f32 v130, v130, v16
  v_sub_f32 v146, v146, v16
  v_sub_f32 v131, v131, v16
  v_sub_f32 v147, v147, v16
  v_sub_f32 v132, v132, v16
  v_sub_f32 v148, v148, v16
  v_sub_f32 v133, v133, v16
  v_sub_f32 v149, v149, v16
  v_sub_f32 v134, v134, v16
  v_sub_f32 v150, v150, v16
  v_sub_f32 v135, v135, v16
  v_sub_f32 v151, v151, v16
  v_max3_f32 v17, v136, v137, v138
  v_max3_f32 v17, v17, v139, v140
  v_max3_f32 v17, v17, v141, v142
  v_max3_f32 v17, v17, v143, 0
  v_mov_b32 v18, v17
  s_nop 1
  v_permlane16_swap_b32 v17, v18
  v_max_f32 v17, v17, v18
  v_mov_b32 v18, v17
  s_nop 1
  v_permlane32_swap_b32 v17, v18
  v_max_f32 v17, v17, v18
  v_sub_f32 v136, v136, v17
  v_sub_f32 v152, v152, v17
  v_sub_f32 v137, v137, v17
  v_sub_f32 v153, v153, v17
  v_sub_f32 v138, v138, v17
  v_sub_f32 v154, v154, v17
  v_sub_f32 v139, v139, v17
  v_sub_f32 v155, v155, v17
  v_sub_f32 v140, v140, v17
  v_sub_f32 v156, v156, v17
  v_sub_f32 v141, v141, v17
  v_sub_f32 v157, v157, v17
  v_sub_f32 v142, v142, v17
  v_sub_f32 v158, v158, v17
  v_sub_f32 v143, v143, v17
  v_sub_f32 v159, v159, v17
  s_call_b64 s[78:79], fa_resc1
  v_exp_f32 v216, v128
  v_exp_f32 v217, v129
  v_exp_f32 v218, v130
  v_add_f32 v226, v216, v217
  v_cvt_pk_bf16_f32 v176, v216, v217
  v_exp_f32 v219, v131
  v_add_f32 v226, v226, v218
  v_exp_f32 v220, v132
  v_add_f32 v226, v226, v219
  v_cvt_pk_bf16_f32 v177, v218, v219
  v_exp_f32 v221, v133
  v_add_f32 v226, v226, v220
  v_exp_f32 v222, v134
  v_add_f32 v226, v226, v221
  v_cvt_pk_bf16_f32 v178, v220, v221
  v_exp_f32 v223, v135
  v_add_f32 v226, v226, v222
  v_exp_f32 v216, v136
  v_add_f32 v226, v226, v223
  v_cvt_pk_bf16_f32 v179, v222, v223
  v_exp_f32 v217, v137
  v_exp_f32 v218, v138
  v_add_f32 v227, v216, v217
  v_cvt_pk_bf16_f32 v180, v216, v217
  v_exp_f32 v219, v139
  v_add_f32 v227, v227, v218
  v_exp_f32 v220, v140
  v_add_f32 v227, v227, v219
  v_cvt_pk_bf16_f32 v181, v218, v219
  v_exp_f32 v221, v141
  v_add_f32 v227, v227, v220
  v_exp_f32 v222, v142
  v_add_f32 v227, v227, v221
  v_cvt_pk_bf16_f32 v182, v220, v221
  v_exp_f32 v223, v143
  v_add_f32 v227, v227, v222
  s_nop 0
  v_add_f32 v227, v227, v223
  v_cvt_pk_bf16_f32 v183, v222, v223
  v_exp_f32 v216, v144
  s_nop 1
  s_setpc_b64 s[76:77]
fa_rare11:
  s_nop 7
  v_max3_f32 v16, v144, v145, v146
  v_max3_f32 v16, v16, v147, v148
  v_max3_f32 v16, v16, v149, v150
  v_max3_f32 v16, v16, v151, 0
  v_mov_b32 v18, v16
  s_nop 1
  v_permlane16_swap_b32 v16, v18
  v_max_f32 v16, v16, v18
  v_mov_b32 v18, v16
  s_nop 1
  v_permlane32_swap_b32 v16, v18
  v_max_f32 v16, v16, v18
  v_sub_f32 v144, v144, v16
  v_sub_f32 v128, v128, v16
  v_sub_f32 v145, v145, v16
  v_sub_f32 v129, v129, v16
  v_sub_f32 v146, v146, v16
  v_sub_f32 v130, v130, v16
  v_sub_f32 v147, v147, v16
  v_sub_f32 v131, v131, v16
  v_sub_f32 v148, v148, v16
  v_sub_f32 v132, v132, v16
  v_sub_f32 v149, v149, v16
  v_sub_f32 v133, v133, v16
  v_sub_f32 v150, v150, v16
  v_sub_f32 v134, v134, v16
  v_sub_f32 v151, v151, v16
  v_sub_f32 v135, v135, v16
  v_max3_f32 v17, v152, v153, v154
  v_max3_f32 v17, v17, v155, v156
  v_max3_f32 v17, v17, v157, v158
  v_max3_f32 v17, v17, v159, 0
  v_mov_b32 v18, v17
  s_nop 1
  v_permlane16_swap_b32 v17, v18
  v_max_f32 v17, v17, v18
  v_mov_b32 v18, v17
  s_nop 1
  v_permlane32_swap_b32 v17, v18
  v_max_f32 v17, v17, v18
  v_sub_f32 v152, v152, v17
  v_sub_f32 v136, v136, v17
  v_sub_f32 v153, v153, v17
  v_sub_f32 v137, v137, v17
  v_sub_f32 v154, v154, v17
  v_sub_f32 v138, v138, v17
  v_sub_f32 v155, v155, v17
  v_sub_f32 v139, v139, v17
  v_sub_f32 v156, v156, v17
  v_sub_f32 v140, v140, v17
  v_sub_f32 v157, v157, v17
  v_sub_f32 v141, v141, v17
  v_sub_f32 v158, v158, v17
  v_sub_f32 v142, v142, v17
  v_sub_f32 v159, v159, v17
  v_sub_f32 v143, v143, v17
  s_call_b64 s[78:79], fa_resc1
  v_exp_f32 v216, v144
  v_exp_f32 v217, v145
  v_exp_f32 v218, v146
  v_add_f32 v226, v216, v217
  v_cvt_pk_bf16_f32 v184, v216, v217
  v_exp_f32 v219, v147
  v_add_f32 v226, v226, v218
  v_exp_f32 v220, v148
  v_add_f32 v226, v226, v219
  v_cvt_pk_bf16_f32 v185, v218, v219
  v_exp_f32 v221, v149
  v_add_f32 v226, v226, v220
  v_exp_f32 v222, v150
  v_add_f32 v226, v226, v221
  v_cvt_pk_bf16_f32 v186, v220, v221
  v_exp_f32 v223, v151
  v_add_f32 v226, v226, v222
  v_exp_f32 v216, v152
  v_add_f32 v226, v226, v223
  v_cvt_pk_bf16_f32 v187, v222, v223
  v_exp_f32 v217, v153
  v_exp_f32 v218, v154
  v_add_f32 v227, v216, v217
  v_cvt_pk_bf16_f32 v188, v216, v217
  v_exp_f32 v219, v155
  v_add_f32 v227, v227, v218
  v_exp_f32 v220, v156
  v_add_f32 v227, v227, v219
  v_cvt_pk_bf16_f32 v189, v218, v219
  v_exp_f32 v221, v157
  v_add_f32 v227, v227, v220
  v_exp_f32 v222, v158
  v_add_f32 v227, v227, v221
  v_cvt_pk_bf16_f32 v190, v220, v221
  v_exp_f32 v223, v159
  v_add_f32 v227, v227, v222
  s_nop 0
  v_add_f32 v227, v227, v223
  v_cvt_pk_bf16_f32 v191, v222, v223
  v_exp_f32 v216, v128
  s_nop 1
  s_setpc_b64 s[76:77]
fa_resc1:
  v_sub_f32 v200, v200, v16
  v_sub_f32 v201, v201, v16
  v_sub_f32 v202, v202, v16
  v_sub_f32 v203, v203, v16
  v_exp_f32 v18, -v16
  v_sub_f32 v204, v204, v17
  v_sub_f32 v205, v205, v17
  v_sub_f32 v206, v206, v17
  v_sub_f32 v207, v207, v17
  v_exp_f32 v19, -v17
  s_nop 0
  v_mul_f32 v230, v230, v18
  v_mul_f32 v231, v231, v19
  v_accvgpr_read_b32 v20, a64
  v_accvgpr_read_b32 v21, a65
  v_accvgpr_read_b32 v22, a66
  v_accvgpr_read_b32 v23, a67
  v_mul_f32 v20, v20, v18
  v_mul_f32 v21, v21, v18
  v_mul_f32 v22, v22, v18
  v_mul_f32 v23, v23, v18
  v_accvgpr_write_b32 a64, v20
  v_accvgpr_write_b32 a65, v21
  v_accvgpr_write_b32 a66, v22
  v_accvgpr_write_b32 a67, v23
  v_accvgpr_read_b32 v20, a68
  v_accvgpr_read_b32 v21, a69
  v_accvgpr_read_b32 v22, a70
  v_accvgpr_read_b32 v23, a71
  v_mul_f32 v20, v20, v19
  v_mul_f32 v21, v21, v19
  v_mul_f32 v22, v22, v19
  v_mul_f32 v23, v23, v19
  v_accvgpr_write_b32 a68, v20
  v_accvgpr_write_b32 a69, v21
  v_accvgpr_write_b32 a70, v22
  v_accvgpr_write_b32 a71, v23
  v_accvgpr_read_b32 v20, a72
  v_accvgpr_read_b32 v21, a73
  v_accvgpr_read_b32 v22, a74
  v_accvgpr_read_b32 v23, a75
  v_mul_f32 v20, v20, v18
  v_mul_f32 v21, v21, v18
  v_mul_f32 v22, v22, v18
  v_mul_f32 v23, v23, v18
  v_accvgpr_write_b32 a72, v20
  v_accvgpr_write_b32 a73, v21
  v_accvgpr_write_b32 a74, v22
  v_accvgpr_write_b32 a75, v23
  v_accvgpr_read_b32 v20, a76
  v_accvgpr_read_b32 v21, a77
  v_accvgpr_read_b32 v22, a78
  v_accvgpr_read_b32 v23, a79
  v_mul_f32 v20, v20, v19
  v_mul_f32 v21, v21, v19
  v_mul_f32 v22, v22, v19
  v_mul_f32 v23, v23, v19
  v_accvgpr_write_b32 a76, v20
  v_accvgpr_write_b32 a77, v21
  v_accvgpr_write_b32 a78, v22
  v_accvgpr_write_b32 a79, v23
  v_accvgpr_read_b32 v20, a80
  v_accvgpr_read_b32 v21, a81
  v_accvgpr_read_b32 v22, a82
  v_accvgpr_read_b32 v23, a83
  v_mul_f32 v20, v20, v18
  v_mul_f32 v21, v21, v18
  v_mul_f32 v22, v22, v18
  v_mul_f32 v23, v23, v18
  v_accvgpr_write_b32 a80, v20
  v_accvgpr_write_b32 a81, v21
  v_accvgpr_write_b32 a82, v22
  v_accvgpr_write_b32 a83, v23
  v_accvgpr_read_b32 v20, a84
  v_accvgpr_read_b32 v21, a85
  v_accvgpr_read_b32 v22, a86
  v_accvgpr_read_b32 v23, a87
  v_mul_f32 v20, v20, v19
  v_mul_f32 v21, v21, v19
  v_mul_f32 v22, v22, v19
  v_mul_f32 v23, v23, v19
  v_accvgpr_write_b32 a84, v20
  v_accvgpr_write_b32 a85, v21
  v_accvgpr_write_b32 a86, v22
  v_accvgpr_write_b32 a87, v23
  v_accvgpr_read_b32 v20, a88
  v_accvgpr_read_b32 v21, a89
  v_accvgpr_read_b32 v22, a90
  v_accvgpr_read_b32 v23, a91
  v_mul_f32 v20, v20, v18
  v_mul_f32 v21, v21, v18
  v_mul_f32 v22, v22, v18
  v_mul_f32 v23, v23, v18
  v_accvgpr_write_b32 a88, v20
  v_accvgpr_write_b32 a89, v21
  v_accvgpr_write_b32 a90, v22
  v_accvgpr_write_b32 a91, v23
  v_accvgpr_read_b32 v20, a92
  v_accvgpr_read_b32 v21, a93
  v_accvgpr_read_b32 v22, a94
  v_accvgpr_read_b32 v23, a95
  v_mul_f32 v20, v20, v19
  v_mul_f32 v21, v21, v19
  v_mul_f32 v22, v22, v19
  v_mul_f32 v23, v23, v19
  v_accvgpr_write_b32 a92, v20
  v_accvgpr_write_b32 a93, v21
  v_accvgpr_write_b32 a94, v22
  v_accvgpr_write_b32 a95, v23
  v_accvgpr_read_b32 v20, a96
  v_accvgpr_read_b32 v21, a97
  v_accvgpr_read_b32 v22, a98
  v_accvgpr_read_b32 v23, a99
  v_mul_f32 v20, v20, v18
  v_mul_f32 v21, v21, v18
  v_mul_f32 v22, v22, v18
  v_mul_f32 v23, v23, v18
  v_accvgpr_write_b32 a96, v20
  v_accvgpr_write_b32 a97, v21
  v_accvgpr_write_b32 a98, v22
  v_accvgpr_write_b32 a99, v23
  v_accvgpr_read_b32 v20, a100
  v_accvgpr_read_b32 v21, a101
  v_accvgpr_read_b32 v22, a102
  v_accvgpr_read_b32 v23, a103
  v_mul_f32 v20, v20, v19
  v_mul_f32 v21, v21, v19
  v_mul_f32 v22, v22, v19
  v_mul_f32 v23, v23, v19
  v_accvgpr_write_b32 a100, v20
  v_accvgpr_write_b32 a101, v21
  v_accvgpr_write_b32 a102, v22
  v_accvgpr_write_b32 a103, v23
  v_accvgpr_read_b32 v20, a104
  v_accvgpr_read_b32 v21, a105
  v_accvgpr_read_b32 v22, a106
  v_accvgpr_read_b32 v23, a107
  v_mul_f32 v20, v20, v18
  v_mul_f32 v21, v21, v18
  v_mul_f32 v22, v22, v18
  v_mul_f32 v23, v23, v18
  v_accvgpr_write_b32 a104, v20
  v_accvgpr_write_b32 a105, v21
  v_accvgpr_write_b32 a106, v22
  v_accvgpr_write_b32 a107, v23
  v_accvgpr_read_b32 v20, a108
  v_accvgpr_read_b32 v21, a109
  v_accvgpr_read_b32 v22, a110
  v_accvgpr_read_b32 v23, a111
  v_mul_f32 v20, v20, v19
  v_mul_f32 v21, v21, v19
  v_mul_f32 v22, v22, v19
  v_mul_f32 v23, v23, v19
  v_accvgpr_write_b32 a108, v20
  v_accvgpr_write_b32 a109, v21
  v_accvgpr_write_b32 a110, v22
  v_accvgpr_write_b32 a111, v23
  v_accvgpr_read_b32 v20, a112
  v_accvgpr_read_b32 v21, a113
  v_accvgpr_read_b32 v22, a114
  v_accvgpr_read_b32 v23, a115
  v_mul_f32 v20, v20, v18
  v_mul_f32 v21, v21, v18
  v_mul_f32 v22, v22, v18
  v_mul_f32 v23, v23, v18
  v_accvgpr_write_b32 a112, v20
  v_accvgpr_write_b32 a113, v21
  v_accvgpr_write_b32 a114, v22
  v_accvgpr_write_b32 a115, v23
  v_accvgpr_read_b32 v20, a116
  v_accvgpr_read_b32 v21, a117
  v_accvgpr_read_b32 v22, a118
  v_accvgpr_read_b32 v23, a119
  v_mul_f32 v20, v20, v19
  v_mul_f32 v21, v21, v19
  v_mul_f32 v22, v22, v19
  v_mul_f32 v23, v23, v19
  v_accvgpr_write_b32 a116, v20
  v_accvgpr_write_b32 a117, v21
  v_accvgpr_write_b32 a118, v22
  v_accvgpr_write_b32 a119, v23
  v_accvgpr_read_b32 v20, a120
  v_accvgpr_read_b32 v21, a121
  v_accvgpr_read_b32 v22, a122
  v_accvgpr_read_b32 v23, a123
  v_mul_f32 v20, v20, v18
  v_mul_f32 v21, v21, v18
  v_mul_f32 v22, v22, v18
  v_mul_f32 v23, v23, v18
  v_accvgpr_write_b32 a120, v20
  v_accvgpr_write_b32 a121, v21
  v_accvgpr_write_b32 a122, v22
  v_accvgpr_write_b32 a123, v23
  v_accvgpr_read_b32 v20, a124
  v_accvgpr_read_b32 v21, a125
  v_accvgpr_read_b32 v22, a126
  v_accvgpr_read_b32 v23, a127
  v_mul_f32 v20, v20, v19
  v_mul_f32 v21, v21, v19
  v_mul_f32 v22, v22, v19
  v_mul_f32 v23, v23, v19
  v_accvgpr_write_b32 a124, v20
  v_accvgpr_write_b32 a125, v21
  v_accvgpr_write_b32 a126, v22
  v_accvgpr_write_b32 a127, v23
  s_setpc_b64 s[78:79]
.section .rodata,"a"
.p2align 6
.amdhsa_kernel fa_kernel
  .amdhsa_next_free_vgpr 512
  .amdhsa_next_free_sgpr 102
  .amdhsa_accum_offset 256
  .amdhsa_group_segment_fixed_size 0
  .amdhsa_kernarg_size 112
  .amdhsa_user_sgpr_count 2
  .amdhsa_user_sgpr_kernarg_segment_ptr 1
  .amdhsa_system_sgpr_workgroup_id_x 1
  .amdhsa_float_denorm_mode_32 3
.end_amdhsa_kernel
.text
```

```asm
; @launch kernel=fa_kernel grid=(256,1,1) block=(256,1,1) lds=163840
.amdgcn_target "amdgcn-amd-amdhsa--gfx950"
.text
.globl fa_kernel
.p2align 8
.type fa_kernel,@function
fa_kernel:
  s_cmp_ge_u32 s2, 256
  s_cbranch_scc1 fa_end
  s_getpc_b64 s[62:63]
  v_and_b32 v230, 127, v0
  v_lshlrev_b32 v230, 7, v230
  global_load_dword v231, v230, s[62:63]
  s_load_dwordx4 s[4:7], s[0:1], 0
  s_load_dwordx4 s[8:11], s[0:1], 24
  s_load_dwordx2 s[14:15], s[0:1], 56
  s_load_dwordx2 s[12:13], s[0:1], 40
  s_load_dwordx4 s[16:19], s[0:1], 96
  s_load_dwordx2 s[60:61], s[0:1], 16
  v_lshrrev_b32 v16, 6, v0
  v_and_b32 v1, 63, v0
  v_readfirstlane_b32 s20, v16
  s_and_b32 s21, s2, 7
  s_lshl_b32 s21, s21, 2
  s_lshr_b32 s23, s2, 3
  s_and_b32 s23, s23, 3
  s_add_u32 s21, s21, s23
  s_lshr_b32 s22, s2, 5
  v_and_b32 v208, 31, v1
  v_lshrrev_b32 v209, 5, v1
  s_lshl_b32 s31, s2, 2
  s_add_u32 s31, s31, s20
  s_lshl_b32 s31, s31, 1
  v_add_u32 v209, s31, v209
  v_lshlrev_b32 v212, 4, v208
  v_mul_u32_u24 v210, 1280, v209
  v_add_u32 v210, v210, v212
  v_cmp_gt_u32 s[64:65], 16, v208
  v_mov_b32 v19, 1073741824
  v_and_b32 v220, 7, v209
  v_cndmask_b32 v211, v19, v210, s[64:65]
  v_bfe_u32 v17, v1, 1, 3
  v_lshlrev_b32 v17, 13, v17
  v_and_b32 v18, 1, v1
  v_lshl_add_u32 v235, v18, 7, v17
  s_lshl_b32 s74, s22, 1
  s_and_b32 s31, s20, 1
  s_add_u32 s74, s74, s31
  s_lshl_b32 s74, s74, 16
  s_mov_b32 s73, 1048576
  v_and_b32 v16, 15, v1
  v_lshlrev_b32 v17, 10, v16
  v_and_b32 v18, 16, v1
  v_lshl_add_u32 v233, v18, 3, v17
  s_lshl_b32 s30, s23, 5
  s_add_u32 s30, s30, s20
  s_lshl_b32 s30, s30, 14
  s_lshl_b32 s29, s22, 16
  s_lshl_b32 s23, s21, 8
  s_cmp_ge_u32 s20, 2
  s_waitcnt lgkmcnt(0)
  s_mov_b32 s44, s4
  s_mov_b32 s45, s5
  s_mov_b32 s46, 2621440
  s_mov_b32 s47, 0x20000
  s_mov_b32 s68, s14
  s_mov_b32 s69, s15
  s_mov_b32 s70, 1280
  s_mov_b32 s71, 0x20000
  buffer_load_dwordx4 v[160:163], v210, s[44:47], 0 offen
  buffer_load_dwordx4 v[164:167], v210, s[44:47], 0 offen offset:512
  buffer_load_dwordx4 v[168:171], v211, s[44:47], 0 offen offset:1024
  buffer_load_dwordx4 v[172:175], v212, s[68:71], 0 offen offset:0
  buffer_load_dwordx4 v[176:179], v212, s[68:71], 0 offen offset:512
  buffer_load_dwordx4 v[180:183], v212, s[68:71], 0 offen offset:1024
  s_cselect_b32 s62, s10, s8
  s_cselect_b32 s63, s11, s9
  s_add_u32 s62, s62, s23
  s_addc_u32 s63, s63, 0
  s_mov_b32 s36, s62
  s_mov_b32 s37, s63
  s_mov_b32 s38, 0
  s_mov_b32 s39, 0x20000
  s_sub_u32 s38, 4194304, s23
  buffer_load_dword v231, v235, s[36:39], s74 offen
  s_add_u32 s6, s6, s29
  s_addc_u32 s7, s7, 0
  s_mov_b32 s32, s6
  s_mov_b32 s33, s7
  s_mov_b32 s34, 0
  s_mov_b32 s35, 0x20000
  s_sub_u32 s34, 2097152, s29
  buffer_load_dword v232, v233, s[32:35], s30 offen
  s_add_u32 s74, s74, s73
  buffer_load_dword v231, v235, s[36:39], s74 offen
  buffer_load_dword v232, v233, s[32:35], s30 offen offset:256
  s_getpc_b64 s[8:9]
fa_pc:
  s_lshr_b32 s31, s2, 3
  s_and_b32 s31, s31, 15
  s_lshl_b32 s31, s31, 2
  s_add_u32 s31, s31, s20
  s_lshl_b32 s31, s31, 11
  s_min_u32 s31, s31, fa_codeend-fa_pc-2048
  v_lshlrev_b32 v234, 7, v16
  v_add_u32 v230, s31, v234
  global_load_dword v231, v230, s[8:9]
  s_add_u32 s8, s8, fa_co1-fa_pc-4
  s_addc_u32 s9, s9, 0
  s_add_u32 s60, s60, s23
  s_addc_u32 s61, s61, 0
  s_sub_u32 s75, 5242880, s23
  s_mov_b32 s48, s62
  s_mov_b32 s49, s63
  s_mov_b32 s50, s38
  s_mov_b32 s51, 0x20000
  v_lshlrev_b32 v2, 4, v1
  v_lshrrev_b32 v19, 2, v1
  v_lshrrev_b32 v17, 5, v1
  v_mul_u32_u24 v17, 3, v17
  v_and_b32 v18, 3, v1
  v_xor_b32 v17, v17, v18
  v_lshlrev_b32 v17, 4, v17
  v_lshl_add_u32 v3, v19, 10, v17
  s_lshl_b32 s23, s20, 19
  v_add_u32 v3, s23, v3
  v_add_u32 v4, 15360, v3
  v_add_u32 v5, 30720, v3
  v_add_u32 v6, 46080, v3
  v_and_b32 v19, 3, v19
  v_lshrrev_b32 v17, 4, v1
  v_lshlrev_b32 v17, 6, v17
  v_lshl_add_u32 v19, v19, 13, v17
  s_and_b32 s23, s20, 1
  s_lshl_b32 s23, s23, 17
  v_add_u32 v19, s23, v19
  v_lshl_add_u32 v8, v18, 4, v19
  v_xor_b32 v18, 2, v18
  v_lshl_add_u32 v10, v18, 4, v19
  v_add_u32 v9, 31744, v8
  v_add_u32 v11, 95232, v10
  v_add_u32 v10, 63488, v10
  s_lshl_b32 s24, s20, 12
  s_mov_b32 s26, 0
  s_mov_b32 s27, 0
  s_mov_b32 s25, 262144
  s_mov_b32 s79, 64
  s_mov_b32 s40, s18
  s_mov_b32 s41, s19
  s_mov_b32 s42, 67108864
  s_mov_b32 s43, 0x20000
  s_mov_b32 s52, s12
  s_mov_b32 s53, s13
  s_mov_b32 s54, 5242880
  s_mov_b32 s55, 0x20000
  s_mov_b32 s56, s16
  s_mov_b32 s57, s17
  s_mov_b32 s58, 256
  s_mov_b32 s59, 0x20000
  s_and_b32 s29, s2, 7
  s_lshl_b32 s29, s29, 2
  s_add_u32 s29, s29, s20
  s_lshl_b32 s29, s29, 11
  s_and_b32 s23, s21, 3
  s_lshl_b32 s23, s23, 19
  s_add_u32 s29, s29, s23
  s_mul_i32 s23, s20, 4352
  s_lshl_b32 s31, s21, 2
  s_add_u32 s23, s23, s31
  s_add_u32 s23, s23, 3801088
  s_mul_i32 s31, s22, 17408
  s_add_u32 s80, s23, s31
  s_sub_u32 s31, 261120, s31
  s_add_u32 s3, s23, s31
  s_lshl_b32 s23, s21, 7
  s_lshl_b32 s31, s22, 2
  s_add_u32 s23, s23, s31
  s_add_u32 s82, s23, 2637824
  s_sub_u32 s62, s2, 170
  s_lshl_b32 s31, s20, 6
  s_add_u32 s62, s62, s31
  s_lshl_b32 s62, s62, 2
  s_add_u32 s62, s62, 2650112
  s_sub_u32 s23, s2, 170
  s_cmp_lt_u32 s23, 54
  s_cselect_b32 s62, s62, 1073741824
  s_cmp_eq_u32 s20, 0
  s_cselect_b32 s31, s82, 1073741824
  s_cselect_b32 s77, s2, 1073741824
  s_cmp_eq_u32 s2, 255
  s_cselect_b32 s23, 2629632, 1073741824
  v_lshl_add_u32 v225, v16, 2, s23
  v_mov_b32 v229, 0
  v_writelane_b32 v225, s80, 0
  v_writelane_b32 v225, s3, 1
  v_writelane_b32 v225, s31, 2
  s_add_u32 s31, s31, 32
  v_writelane_b32 v225, s31, 5
  s_and_b32 s23, s2, 1
  s_lshl_b32 s23, s23, 2
  s_add_u32 s23, s23, s20
  s_lshl_b32 s23, s23, 7
  s_lshr_b32 s31, s2, 1
  s_add_u32 s23, s23, s31
  s_lshl_b32 s23, s23, 2
  s_add_u32 s23, s23, 2654208
  v_writelane_b32 v225, s23, 3
  v_writelane_b32 v225, s62, 4
  s_and_b32 s23, s21, 3
  s_lshr_b32 s31, s23, 1
  s_lshl_b32 s31, 4, s31
  s_bitcmp1_b32 s23, 0
  s_cselect_b32 s76, s31, 0
  s_cselect_b32 s72, 0, s31
  s_or_b32 s76, s76, 0x20
  s_or_b32 s72, s72, 0x25
  v_mov_b32 v20, 0
  v_mov_b32 v21, 0
  v_mov_b32 v22, 0
  v_mov_b32 v23, 0
  v_lshrrev_b32 v17, 4, v1
  v_lshrrev_b32 v18, 3, v16
  v_mul_u32_u24 v18, 3, v18
  v_xor_b32 v18, v18, v17
  v_lshlrev_b32 v18, 4, v18
  v_lshl_add_u32 v14, v16, 6, v18
  s_and_b32 s23, s20, 1
  s_lshl_b32 s23, s23, 11
  v_add_u32 v14, s23, v14
  v_mfma_f32_32x32x16_bf16 a[0:15], v[20:23], v[20:23], 0
  v_lshrrev_b32 v18, 2, v16
  v_lshlrev_b32 v18, 6, v18
  v_lshl_add_u32 v18, v17, 11, v18
  v_and_b32 v19, 1, v1
  v_mfma_f32_32x32x16_bf16 a[16:31], v[20:23], v[20:23], 0
  v_lshl_add_u32 v18, v19, 3, v18
  v_bfe_u32 v19, v1, 1, 1
  v_and_b32 v17, 1, v17
  v_lshl_or_b32 v19, v17, 1, v19
  v_mfma_f32_32x32x16_bf16 a[32:47], v[20:23], v[20:23], 0
  s_lshr_b32 s23, s20, 1
  s_lshl_b32 s23, s23, 13
  s_add_u32 s23, s23, 16384
  v_add_u32 v18, s23, v18
  v_mfma_f32_32x32x16_bf16 a[48:63], v[20:23], v[20:23], 0
  v_lshl_add_u32 v12, v19, 4, v18
  v_xor_b32 v13, 32, v12
  v_mov_b32 v19, 1073741824
  v_lshlrev_b32 v220, 4, v220
  v_mfma_f32_32x32x16_bf16 a[64:79], v[20:23], v[20:23], 0
  v_lshl_add_u32 v220, v208, 7, v220
  v_add_u32 v220, 131072, v220
  v_lshlrev_b32 v222, 2, v209
  v_cmp_eq_u32 vcc, 0, v208
  v_mfma_f32_32x32x16_bf16 a[80:95], v[20:23], v[20:23], 0
  v_add_u32 v222, 2621440, v222
  v_lshlrev_b32 v221, 4, v0
  v_cndmask_b32 v222, v19, v222, vcc
  v_add_u32 v221, 131072, v221
  v_mfma_f32_32x32x16_bf16 a[96:111], v[20:23], v[20:23], 0
  v_sub_u32 v209, 0xffff, v209
  v_lshrrev_b32 v223, 3, v0
  v_and_b32 v18, 7, v0
  v_lshlrev_b32 v18, 4, v18
  v_mfma_f32_32x32x16_bf16 a[112:127], v[20:23], v[20:23], 0
  v_cmp_gt_u32 vcc, 128, v0
  v_lshl_add_u32 v223, v223, 8, v18
  s_lshr_b32 s66, s2, 1
  s_mul_i32 s66, s66, 20480
  v_mfma_f32_32x32x16_bf16 a[128:143], v[20:23], v[20:23], 0
  s_and_b32 s31, s2, 1
  s_lshl_b32 s31, s31, 7
  s_add_u32 s66, s66, s31
  v_cndmask_b32 v224, v19, v223, vcc
  v_mfma_f32_32x32x16_bf16 a[144:159], v[20:23], v[20:23], 0
  s_add_u32 s67, s66, 8192
  s_add_u32 s78, s66, 16384
  s_mov_b32 s28, 0
  v_mfma_f32_32x32x16_bf16 a[160:175], v[20:23], v[20:23], 0
  v_mfma_f32_32x32x16_bf16 a[176:191], v[20:23], v[20:23], 0
  v_mfma_f32_32x32x16_bf16 a[192:207], v[20:23], v[20:23], 0
  v_mfma_f32_32x32x16_bf16 a[208:223], v[20:23], v[20:23], 0
  v_mfma_f32_32x32x16_bf16 a[224:239], v[20:23], v[20:23], 0
  v_mfma_f32_32x32x16_bf16 a[240:255], v[20:23], v[20:23], 0
  s_waitcnt vmcnt(5)
  v_lshlrev_b32 v184, 16, v160
  v_and_b32 v185, 0xffff0000, v160
  v_lshlrev_b32 v186, 16, v161
  v_and_b32 v187, 0xffff0000, v161
  v_lshlrev_b32 v188, 16, v162
  v_and_b32 v189, 0xffff0000, v162
  v_lshlrev_b32 v190, 16, v163
  v_and_b32 v191, 0xffff0000, v163
  v_lshlrev_b32 v192, 16, v164
  v_and_b32 v193, 0xffff0000, v164
  v_lshlrev_b32 v194, 16, v165
  v_and_b32 v195, 0xffff0000, v165
  v_lshlrev_b32 v196, 16, v166
  v_and_b32 v197, 0xffff0000, v166
  v_lshlrev_b32 v198, 16, v167
  v_and_b32 v199, 0xffff0000, v167
  v_lshlrev_b32 v200, 16, v168
  v_and_b32 v201, 0xffff0000, v168
  v_lshlrev_b32 v202, 16, v169
  v_and_b32 v203, 0xffff0000, v169
  v_lshlrev_b32 v204, 16, v170
  v_and_b32 v205, 0xffff0000, v170
  v_lshlrev_b32 v206, 16, v171
  v_and_b32 v207, 0xffff0000, v171
  v_pk_add_f32 v[16:17], v[184:185], v[186:187]
  v_pk_add_f32 v[18:19], v[188:189], v[190:191]
  v_pk_add_f32 v[16:17], v[16:17], v[192:193]
  v_pk_add_f32 v[18:19], v[18:19], v[194:195]
  v_pk_add_f32 v[16:17], v[16:17], v[196:197]
  v_pk_add_f32 v[18:19], v[18:19], v[198:199]
  v_pk_add_f32 v[16:17], v[16:17], v[200:201]
  v_pk_add_f32 v[18:19], v[18:19], v[202:203]
  v_pk_add_f32 v[16:17], v[16:17], v[204:205]
  v_pk_add_f32 v[18:19], v[18:19], v[206:207]
  v_pk_add_f32 v[16:17], v[16:17], v[18:19]
  v_add_f32 v213, v16, v17
  s_nop 1
  v_add_f32_dpp v213, v213, v213 quad_perm:[1,0,3,2] row_mask:0xf bank_mask:0xf
  s_nop 1
  v_add_f32_dpp v213, v213, v213 quad_perm:[2,3,0,1] row_mask:0xf bank_mask:0xf
  s_nop 1
  v_add_f32_dpp v213, v213, v213 row_half_mirror row_mask:0xf bank_mask:0xf
  s_nop 1
  v_add_f32_dpp v213, v213, v213 row_mirror row_mask:0xf bank_mask:0xf
  v_mov_b32 v214, v213
  s_nop 1
  v_permlane16_swap_b32 v213, v214
  v_add_f32 v213, v213, v214
  v_mul_f32 v216, 0xbacccccd, v213
  v_mul_f32 v217, 0xbacccccd, v213
  v_pk_add_f32 v[20:21], v[184:185], v[216:217]
  v_pk_mul_f32 v[16:17], v[20:21], v[20:21]
  v_pk_add_f32 v[22:23], v[186:187], v[216:217]
  v_pk_fma_f32 v[16:17], v[22:23], v[22:23], v[16:17]
  v_pk_add_f32 v[24:25], v[188:189], v[216:217]
  v_pk_fma_f32 v[16:17], v[24:25], v[24:25], v[16:17]
  v_pk_add_f32 v[26:27], v[190:191], v[216:217]
  v_pk_fma_f32 v[16:17], v[26:27], v[26:27], v[16:17]
  v_pk_add_f32 v[20:21], v[192:193], v[216:217]
  v_pk_fma_f32 v[16:17], v[20:21], v[20:21], v[16:17]
  v_pk_add_f32 v[22:23], v[194:195], v[216:217]
  v_pk_fma_f32 v[16:17], v[22:23], v[22:23], v[16:17]
  v_pk_add_f32 v[24:25], v[196:197], v[216:217]
  v_pk_fma_f32 v[16:17], v[24:25], v[24:25], v[16:17]
  v_pk_add_f32 v[26:27], v[198:199], v[216:217]
  v_pk_fma_f32 v[16:17], v[26:27], v[26:27], v[16:17]
  v_pk_add_f32 v[20:21], v[200:201], v[216:217]
  v_pk_mul_f32 v[18:19], v[20:21], v[20:21]
  v_pk_add_f32 v[22:23], v[202:203], v[216:217]
  v_pk_fma_f32 v[18:19], v[22:23], v[22:23], v[18:19]
  v_pk_add_f32 v[24:25], v[204:205], v[216:217]
  v_pk_fma_f32 v[18:19], v[24:25], v[24:25], v[18:19]
  v_pk_add_f32 v[26:27], v[206:207], v[216:217]
  v_pk_fma_f32 v[18:19], v[26:27], v[26:27], v[18:19]
  v_add_f32 v18, v18, v19
  v_add_f32 v213, v16, v17
  v_cndmask_b32 v18, 0, v18, s[64:65]
  v_add_f32 v213, v213, v18
  s_nop 1
  v_add_f32_dpp v213, v213, v213 quad_perm:[1,0,3,2] row_mask:0xf bank_mask:0xf
  s_nop 1
  v_add_f32_dpp v213, v213, v213 quad_perm:[2,3,0,1] row_mask:0xf bank_mask:0xf
  s_nop 1
  v_add_f32_dpp v213, v213, v213 row_half_mirror row_mask:0xf bank_mask:0xf
  s_nop 1
  v_add_f32_dpp v213, v213, v213 row_mirror row_mask:0xf bank_mask:0xf
  v_mov_b32 v214, v213
  s_nop 1
  v_permlane16_swap_b32 v213, v214
  v_add_f32 v213, v213, v214
  v_mul_f32 v213, 0x3acccccd, v213
  v_cvt_pk_bf16_f32 v213, v213, v213
  v_and_b32 v213, 0xffff0000, v213
  v_add_f32 v213, 0x3727c5ac, v213
  v_cvt_pk_bf16_f32 v213, v213, v213
  v_and_b32 v213, 0xffff0000, v213
  v_sqrt_f32 v213, v213
  v_cvt_pk_bf16_f32 v216, v216, v216
  v_and_b32 v216, 0xffff0000, v216
  v_cvt_pk_bf16_f32 v213, v213, v213
  v_and_b32 v213, 0xffff0000, v213
  v_rcp_f32 v28, v213
  v_mov_b32 v217, v216
  v_mov_b32 v29, v28
  v_pk_add_f32 v[184:185], v[184:185], v[216:217]
  v_lshlrev_b32 v16, 16, v172
  v_cvt_pk_bf16_f32 v185, v184, v185
  v_and_b32 v17, 0xffff0000, v172
  v_lshlrev_b32 v184, 16, v185
  v_and_b32 v185, 0xffff0000, v185
  v_pk_mul_f32 v[184:185], v[184:185], v[28:29]
  v_cvt_pk_bf16_f32 v160, v184, v185
  v_lshlrev_b32 v184, 16, v160
  v_and_b32 v185, 0xffff0000, v160
  v_pk_mul_f32 v[218:219], v[184:185], v[16:17]
  v_pk_add_f32 v[186:187], v[186:187], v[216:217]
  v_lshlrev_b32 v18, 16, v173
  v_cvt_pk_bf16_f32 v187, v186, v187
  v_and_b32 v19, 0xffff0000, v173
  v_lshlrev_b32 v186, 16, v187
  v_and_b32 v187, 0xffff0000, v187
  v_pk_mul_f32 v[186:187], v[186:187], v[28:29]
  v_cvt_pk_bf16_f32 v161, v186, v187
  v_lshlrev_b32 v186, 16, v161
  v_and_b32 v187, 0xffff0000, v161
  v_pk_fma_f32 v[218:219], v[186:187], v[18:19], v[218:219]
  v_pk_add_f32 v[188:189], v[188:189], v[216:217]
  v_lshlrev_b32 v16, 16, v174
  v_cvt_pk_bf16_f32 v189, v188, v189
  v_and_b32 v17, 0xffff0000, v174
  v_lshlrev_b32 v188, 16, v189
  v_and_b32 v189, 0xffff0000, v189
  v_pk_mul_f32 v[188:189], v[188:189], v[28:29]
  v_cvt_pk_bf16_f32 v162, v188, v189
  v_lshlrev_b32 v188, 16, v162
  v_and_b32 v189, 0xffff0000, v162
  v_pk_fma_f32 v[218:219], v[188:189], v[16:17], v[218:219]
  v_pk_add_f32 v[190:191], v[190:191], v[216:217]
  v_lshlrev_b32 v18, 16, v175
  v_cvt_pk_bf16_f32 v191, v190, v191
  v_and_b32 v19, 0xffff0000, v175
  v_lshlrev_b32 v190, 16, v191
  v_and_b32 v191, 0xffff0000, v191
  v_pk_mul_f32 v[190:191], v[190:191], v[28:29]
  v_cvt_pk_bf16_f32 v163, v190, v191
  v_lshlrev_b32 v190, 16, v163
  v_and_b32 v191, 0xffff0000, v163
  v_pk_fma_f32 v[218:219], v[190:191], v[18:19], v[218:219]
  ds_write_b128 v220, v[160:163] offset:0
  v_pk_add_f32 v[192:193], v[192:193], v[216:217]
  v_lshlrev_b32 v16, 16, v176
  v_cvt_pk_bf16_f32 v193, v192, v193
  v_and_b32 v17, 0xffff0000, v176
  v_lshlrev_b32 v192, 16, v193
  v_and_b32 v193, 0xffff0000, v193
  v_pk_mul_f32 v[192:193], v[192:193], v[28:29]
  v_cvt_pk_bf16_f32 v164, v192, v193
  v_lshlrev_b32 v192, 16, v164
  v_and_b32 v193, 0xffff0000, v164
  v_pk_fma_f32 v[218:219], v[192:193], v[16:17], v[218:219]
  v_pk_add_f32 v[194:195], v[194:195], v[216:217]
  v_lshlrev_b32 v18, 16, v177
  v_cvt_pk_bf16_f32 v195, v194, v195
  v_and_b32 v19, 0xffff0000, v177
  v_lshlrev_b32 v194, 16, v195
  v_and_b32 v195, 0xffff0000, v195
  v_pk_mul_f32 v[194:195], v[194:195], v[28:29]
  v_cvt_pk_bf16_f32 v165, v194, v195
  v_lshlrev_b32 v194, 16, v165
  v_and_b32 v195, 0xffff0000, v165
  v_pk_fma_f32 v[218:219], v[194:195], v[18:19], v[218:219]
  v_pk_add_f32 v[196:197], v[196:197], v[216:217]
  v_lshlrev_b32 v16, 16, v178
  v_cvt_pk_bf16_f32 v197, v196, v197
  v_and_b32 v17, 0xffff0000, v178
  v_lshlrev_b32 v196, 16, v197
  v_and_b32 v197, 0xffff0000, v197
  v_pk_mul_f32 v[196:197], v[196:197], v[28:29]
  v_cvt_pk_bf16_f32 v166, v196, v197
  v_lshlrev_b32 v196, 16, v166
  v_and_b32 v197, 0xffff0000, v166
  v_pk_fma_f32 v[218:219], v[196:197], v[16:17], v[218:219]
  v_pk_add_f32 v[198:199], v[198:199], v[216:217]
  v_lshlrev_b32 v18, 16, v179
  v_cvt_pk_bf16_f32 v199, v198, v199
  v_and_b32 v19, 0xffff0000, v179
  v_lshlrev_b32 v198, 16, v199
  v_and_b32 v199, 0xffff0000, v199
  v_pk_mul_f32 v[198:199], v[198:199], v[28:29]
  v_cvt_pk_bf16_f32 v167, v198, v199
  v_lshlrev_b32 v198, 16, v167
  v_and_b32 v199, 0xffff0000, v167
  v_pk_fma_f32 v[218:219], v[198:199], v[18:19], v[218:219]
  ds_write_b128 v220, v[164:167] offset:4096
  v_pk_add_f32 v[200:201], v[200:201], v[216:217]
  v_lshlrev_b32 v16, 16, v180
  v_cvt_pk_bf16_f32 v201, v200, v201
  v_and_b32 v17, 0xffff0000, v180
  v_lshlrev_b32 v200, 16, v201
  v_and_b32 v201, 0xffff0000, v201
  v_pk_mul_f32 v[200:201], v[200:201], v[28:29]
  v_cvt_pk_bf16_f32 v168, v200, v201
  v_lshlrev_b32 v200, 16, v168
  v_and_b32 v201, 0xffff0000, v168
  v_pk_fma_f32 v[218:219], v[200:201], v[16:17], v[218:219]
  v_pk_add_f32 v[202:203], v[202:203], v[216:217]
  v_lshlrev_b32 v18, 16, v181
  v_cvt_pk_bf16_f32 v203, v202, v203
  v_and_b32 v19, 0xffff0000, v181
  v_lshlrev_b32 v202, 16, v203
  v_and_b32 v203, 0xffff0000, v203
  v_pk_mul_f32 v[202:203], v[202:203], v[28:29]
  v_cvt_pk_bf16_f32 v169, v202, v203
  v_lshlrev_b32 v202, 16, v169
  v_and_b32 v203, 0xffff0000, v169
  v_pk_fma_f32 v[218:219], v[202:203], v[18:19], v[218:219]
  v_pk_add_f32 v[204:205], v[204:205], v[216:217]
  v_lshlrev_b32 v16, 16, v182
  v_cvt_pk_bf16_f32 v205, v204, v205
  v_and_b32 v17, 0xffff0000, v182
  v_lshlrev_b32 v204, 16, v205
  v_and_b32 v205, 0xffff0000, v205
  v_pk_mul_f32 v[204:205], v[204:205], v[28:29]
  v_cvt_pk_bf16_f32 v170, v204, v205
  v_lshlrev_b32 v204, 16, v170
  v_and_b32 v205, 0xffff0000, v170
  v_pk_fma_f32 v[218:219], v[204:205], v[16:17], v[218:219]
  v_pk_add_f32 v[206:207], v[206:207], v[216:217]
  v_lshlrev_b32 v18, 16, v183
  v_cvt_pk_bf16_f32 v207, v206, v207
  v_and_b32 v19, 0xffff0000, v183
  v_lshlrev_b32 v206, 16, v207
  v_and_b32 v207, 0xffff0000, v207
  v_pk_mul_f32 v[206:207], v[206:207], v[28:29]
  v_cvt_pk_bf16_f32 v171, v206, v207
  v_lshlrev_b32 v206, 16, v171
  v_and_b32 v207, 0xffff0000, v171
  v_pk_fma_f32 v[218:219], v[206:207], v[18:19], v[218:219]
  ds_write_b128 v220, v[168:171] offset:8192
  v_add_f32 v218, v218, v219
  s_nop 1
  v_add_f32_dpp v218, v218, v218 quad_perm:[1,0,3,2] row_mask:0xf bank_mask:0xf
  s_nop 1
  v_add_f32_dpp v218, v218, v218 quad_perm:[2,3,0,1] row_mask:0xf bank_mask:0xf
  s_nop 1
  v_add_f32_dpp v218, v218, v218 row_half_mirror row_mask:0xf bank_mask:0xf
  s_nop 1
  v_add_f32_dpp v218, v218, v218 row_mirror row_mask:0xf bank_mask:0xf
  v_mov_b32 v214, v218
  s_nop 1
  v_permlane16_swap_b32 v218, v214
  v_add_f32 v218, v218, v214
  v_cvt_pk_bf16_f32 v218, v218, v218
  v_and_b32 v218, 0xffff0000, v218
  v_ashrrev_i32 v214, 31, v218
  v_or_b32 v214, 0x80000000, v214
  v_xor_b32 v218, v218, v214
  v_and_b32 v218, 0xffff0000, v218
  v_or_b32 v218, v218, v209
  v_mov_b32 v19, 1073741824
  s_mov_b32 m0, s24
  s_nop 0
  buffer_load_dwordx4 v3, s[32:35], s26 offen offset:0 sc1 lds
  buffer_load_dwordx4 v4, s[32:35], s26 offen offset:1024 sc1 lds
  buffer_load_dwordx4 v5, s[32:35], s26 offen offset:2048 sc1 lds
  buffer_load_dwordx4 v6, s[32:35], s26 offen offset:3072 sc1 lds
  s_add_u32 m0, s24, 16384
  s_nop 0
  buffer_load_dwordx4 v8, s[36:39], s27 offen offset:0 lds
  buffer_load_dwordx4 v9, s[36:39], s27 offen offset:1024 lds
  buffer_load_dwordx4 v10, s[36:39], s27 offen offset:2048 lds
  buffer_load_dwordx4 v11, s[36:39], s27 offen offset:3072 lds
  s_add_u32 s26, s26, s79
  s_add_u32 s27, s27, s25
  s_add_u32 s24, s24, 32768
  s_and_b32 s24, s24, 0x1ffff
  s_mov_b32 m0, s24
  s_nop 0
  buffer_load_dwordx4 v3, s[32:35], s26 offen offset:0 sc1 lds
  buffer_load_dwordx4 v4, s[32:35], s26 offen offset:1024 sc1 lds
  buffer_load_dwordx4 v5, s[32:35], s26 offen offset:2048 sc1 lds
  buffer_load_dwordx4 v6, s[32:35], s26 offen offset:3072 sc1 lds
  s_add_u32 m0, s24, 16384
  s_nop 0
  buffer_load_dwordx4 v8, s[36:39], s27 offen offset:0 lds
  buffer_load_dwordx4 v9, s[36:39], s27 offen offset:1024 lds
  buffer_load_dwordx4 v10, s[36:39], s27 offen offset:2048 lds
  buffer_load_dwordx4 v11, s[36:39], s27 offen offset:3072 lds
  s_add_u32 s26, s26, s79
  s_add_u32 s27, s27, s25
  s_add_u32 s24, s24, 32768
  s_and_b32 s24, s24, 0x1ffff
  s_waitcnt vmcnt(8) lgkmcnt(0)
  s_barrier
  s_cmp_ge_u32 s20, 2
  s_cbranch_scc1 fa_roleV
  ds_read_b128 v[96:99], v14 offset:0
  ds_read_b128 v[100:103], v14 offset:1024
  ds_read_b128 v[104:107], v14 offset:4096
  ds_read_b128 v[108:111], v14 offset:5120
  ds_read_b128 v[112:115], v14 offset:8192
  ds_read_b128 v[116:119], v14 offset:9216
  ds_read_b128 v[120:123], v14 offset:12288
  ds_read_b128 v[124:127], v14 offset:13312
  ds_read_b64_tr_b16 v[32:33], v12 offset:0
  ds_read_b64_tr_b16 v[34:35], v12 offset:1024
  ds_read_b64_tr_b16 v[36:37], v13 offset:0
  ds_read_b64_tr_b16 v[38:39], v13 offset:1024
  ds_read_b64_tr_b16 v[40:41], v12 offset:256
  ds_read_b64_tr_b16 v[42:43], v12 offset:1280
  ds_read_b64_tr_b16 v[44:45], v13 offset:256
  ds_read_b64_tr_b16 v[46:47], v13 offset:1280
  ds_read_b64_tr_b16 v[48:49], v12 offset:512
  ds_read_b64_tr_b16 v[50:51], v12 offset:1536
  ds_read_b64_tr_b16 v[52:53], v13 offset:512
  ds_read_b64_tr_b16 v[54:55], v13 offset:1536
  ds_read_b64_tr_b16 v[56:57], v12 offset:768
  ds_read_b64_tr_b16 v[58:59], v12 offset:1792
  ds_read_b64_tr_b16 v[60:61], v13 offset:768
  ds_read_b64_tr_b16 v[62:63], v13 offset:1792
  s_mov_b32 m0, s24
  s_nop 0
  buffer_load_dwordx4 v3, s[32:35], s26 offen offset:0 sc1 lds
  buffer_load_dwordx4 v4, s[32:35], s26 offen offset:1024 sc1 lds
  buffer_load_dwordx4 v5, s[32:35], s26 offen offset:2048 sc1 lds
  buffer_load_dwordx4 v6, s[32:35], s26 offen offset:3072 sc1 lds
  s_add_u32 m0, s24, 16384
  s_nop 0
  buffer_load_dwordx4 v8, s[36:39], s27 offen offset:0 lds
  buffer_load_dwordx4 v9, s[36:39], s27 offen offset:1024 lds
  buffer_load_dwordx4 v10, s[36:39], s27 offen offset:2048 lds
  buffer_load_dwordx4 v11, s[36:39], s27 offen offset:3072 lds
  s_add_u32 s26, s26, s79
  s_add_u32 s27, s27, s25
  s_add_u32 s24, s24, 32768
  s_and_b32 s24, s24, 0x1ffff
  buffer_load_dword v231, v19, s[32:35], 0 offen
  s_mov_b32 m0, s24
  s_nop 0
  buffer_load_dwordx4 v3, s[32:35], s26 offen offset:0 sc1 lds
  buffer_load_dwordx4 v4, s[32:35], s26 offen offset:1024 sc1 lds
  buffer_load_dwordx4 v5, s[32:35], s26 offen offset:2048 sc1 lds
  buffer_load_dwordx4 v6, s[32:35], s26 offen offset:3072 sc1 lds
  s_add_u32 m0, s24, 16384
  s_nop 0
  buffer_load_dwordx4 v8, s[36:39], s27 offen offset:0 lds
  buffer_load_dwordx4 v9, s[36:39], s27 offen offset:1024 lds
  buffer_load_dwordx4 v10, s[36:39], s27 offen offset:2048 lds
  buffer_load_dwordx4 v11, s[36:39], s27 offen offset:3072 lds
  s_add_u32 s26, s26, s79
  s_add_u32 s27, s27, s25
  s_add_u32 s24, s24, 32768
  s_and_b32 s24, s24, 0x1ffff
  s_waitcnt lgkmcnt(0)
.p2align 6
fa_loopK:
  v_mfma_f32_16x16x32_bf16 a[192:195], v[32:35], v[96:99], a[192:195]
  s_waitcnt vmcnt(17)
  v_mfma_f32_16x16x32_bf16 a[200:203], v[32:35], v[100:103], a[200:203]
  s_barrier
  v_mfma_f32_16x16x32_bf16 a[0:3], v[32:35], v[104:107], a[0:3]
  ds_read_b64_tr_b16 v[64:65], v12 offset:32768
  v_mfma_f32_16x16x32_bf16 a[8:11], v[32:35], v[108:111], a[8:11]
  v_mfma_f32_16x16x32_bf16 a[64:67], v[32:35], v[112:115], a[64:67]
  s_mov_b32 m0, s24
  ds_read_b64_tr_b16 v[66:67], v12 offset:33792
  v_mfma_f32_16x16x32_bf16 a[72:75], v[32:35], v[116:119], a[72:75]
  buffer_load_dwordx4 v3, s[32:35], s26 offen offset:0 sc1 lds
  v_mfma_f32_16x16x32_bf16 a[128:131], v[32:35], v[120:123], a[128:131]
  ds_read_b128 v[128:131], v14 offset:32768
  v_mfma_f32_16x16x32_bf16 a[136:139], v[32:35], v[124:127], a[136:139]
  buffer_load_dwordx4 v4, s[32:35], s26 offen offset:1024 sc1 lds
  v_mfma_f32_16x16x32_bf16 a[196:199], v[36:39], v[96:99], a[196:199]
  ds_read_b64_tr_b16 v[68:69], v13 offset:32768
  v_mfma_f32_16x16x32_bf16 a[204:207], v[36:39], v[100:103], a[204:207]
  buffer_load_dwordx4 v5, s[32:35], s26 offen offset:2048 sc1 lds
  v_mfma_f32_16x16x32_bf16 a[4:7], v[36:39], v[104:107], a[4:7]
  ds_read_b64_tr_b16 v[70:71], v13 offset:33792
  v_mfma_f32_16x16x32_bf16 a[12:15], v[36:39], v[108:111], a[12:15]
  buffer_load_dwordx4 v6, s[32:35], s26 offen offset:3072 sc1 lds
  v_mfma_f32_16x16x32_bf16 a[68:71], v[36:39], v[112:115], a[68:71]
  s_add_u32 m0, s24, 16384
  ds_read_b128 v[132:135], v14 offset:33792
  v_mfma_f32_16x16x32_bf16 a[76:79], v[36:39], v[116:119], a[76:79]
  buffer_load_dwordx4 v8, s[36:39], s27 offen offset:0 lds
  v_mfma_f32_16x16x32_bf16 a[132:135], v[36:39], v[120:123], a[132:135]
  ds_read_b64_tr_b16 v[72:73], v12 offset:33024
  v_mfma_f32_16x16x32_bf16 a[140:143], v[36:39], v[124:127], a[140:143]
  buffer_load_dwordx4 v9, s[36:39], s27 offen offset:1024 lds
  v_mfma_f32_16x16x32_bf16 a[208:211], v[40:43], v[96:99], a[208:211]
  ds_read_b64_tr_b16 v[74:75], v12 offset:34048
  v_mfma_f32_16x16x32_bf16 a[216:219], v[40:43], v[100:103], a[216:219]
  buffer_load_dwordx4 v10, s[36:39], s27 offen offset:2048 lds
  v_mfma_f32_16x16x32_bf16 a[16:19], v[40:43], v[104:107], a[16:19]
  ds_read_b128 v[136:139], v14 offset:36864
  v_mfma_f32_16x16x32_bf16 a[24:27], v[40:43], v[108:111], a[24:27]
  buffer_load_dwordx4 v11, s[36:39], s27 offen offset:3072 lds
  v_mfma_f32_16x16x32_bf16 a[80:83], v[40:43], v[112:115], a[80:83]
  ds_read_b64_tr_b16 v[76:77], v13 offset:33024
  v_mfma_f32_16x16x32_bf16 a[88:91], v[40:43], v[116:119], a[88:91]
  buffer_load_dword v231, v235, s[48:51], s74 offen sc1
  v_mfma_f32_16x16x32_bf16 a[144:147], v[40:43], v[120:123], a[144:147]
  s_add_u32 s74, s74, s73
  ds_read_b64_tr_b16 v[78:79], v13 offset:34048
  v_mfma_f32_16x16x32_bf16 a[152:155], v[40:43], v[124:127], a[152:155]
  s_bitcmp1_b32 s72, s28
  v_mfma_f32_16x16x32_bf16 a[212:215], v[44:47], v[96:99], a[212:215]
  s_cbranch_scc1 fa_hk0
fa_hb0:
  ds_read_b128 v[140:143], v14 offset:37888
  v_mfma_f32_16x16x32_bf16 a[220:223], v[44:47], v[100:103], a[220:223]
  v_mfma_f32_16x16x32_bf16 a[20:23], v[44:47], v[104:107], a[20:23]
  ds_read_b64_tr_b16 v[80:81], v12 offset:33280
  v_mfma_f32_16x16x32_bf16 a[28:31], v[44:47], v[108:111], a[28:31]
  v_mfma_f32_16x16x32_bf16 a[84:87], v[44:47], v[112:115], a[84:87]
  ds_read_b64_tr_b16 v[82:83], v12 offset:34304
  v_mfma_f32_16x16x32_bf16 a[92:95], v[44:47], v[116:119], a[92:95]
  v_mfma_f32_16x16x32_bf16 a[148:151], v[44:47], v[120:123], a[148:151]
  ds_read_b128 v[144:147], v14 offset:40960
  v_mfma_f32_16x16x32_bf16 a[156:159], v[44:47], v[124:127], a[156:159]
  v_mfma_f32_16x16x32_bf16 a[224:227], v[48:51], v[96:99], a[224:227]
  ds_read_b64_tr_b16 v[84:85], v13 offset:33280
  v_mfma_f32_16x16x32_bf16 a[232:235], v[48:51], v[100:103], a[232:235]
  v_mfma_f32_16x16x32_bf16 a[32:35], v[48:51], v[104:107], a[32:35]
  ds_read_b64_tr_b16 v[86:87], v13 offset:34304
  v_mfma_f32_16x16x32_bf16 a[40:43], v[48:51], v[108:111], a[40:43]
  v_mfma_f32_16x16x32_bf16 a[96:99], v[48:51], v[112:115], a[96:99]
  ds_read_b128 v[148:151], v14 offset:41984
  v_mfma_f32_16x16x32_bf16 a[104:107], v[48:51], v[116:119], a[104:107]
  v_mfma_f32_16x16x32_bf16 a[160:163], v[48:51], v[120:123], a[160:163]
  ds_read_b64_tr_b16 v[88:89], v12 offset:33536
  v_mfma_f32_16x16x32_bf16 a[168:171], v[48:51], v[124:127], a[168:171]
  v_mfma_f32_16x16x32_bf16 a[228:231], v[52:55], v[96:99], a[228:231]
  ds_read_b64_tr_b16 v[90:91], v12 offset:34560
  v_mfma_f32_16x16x32_bf16 a[236:239], v[52:55], v[100:103], a[236:239]
  v_mfma_f32_16x16x32_bf16 a[36:39], v[52:55], v[104:107], a[36:39]
  ds_read_b128 v[152:155], v14 offset:45056
  v_mfma_f32_16x16x32_bf16 a[44:47], v[52:55], v[108:111], a[44:47]
  v_mfma_f32_16x16x32_bf16 a[100:103], v[52:55], v[112:115], a[100:103]
  ds_read_b64_tr_b16 v[92:93], v13 offset:33536
  v_mfma_f32_16x16x32_bf16 a[108:111], v[52:55], v[116:119], a[108:111]
  v_mfma_f32_16x16x32_bf16 a[164:167], v[52:55], v[120:123], a[164:167]
  ds_read_b64_tr_b16 v[94:95], v13 offset:34560
  v_mfma_f32_16x16x32_bf16 a[172:175], v[52:55], v[124:127], a[172:175]
  v_mfma_f32_16x16x32_bf16 a[240:243], v[56:59], v[96:99], a[240:243]
  s_add_u32 s26, s26, s79
  ds_read_b128 v[156:159], v14 offset:46080
  v_mfma_f32_16x16x32_bf16 a[248:251], v[56:59], v[100:103], a[248:251]
  s_add_u32 s27, s27, s25
  v_mfma_f32_16x16x32_bf16 a[48:51], v[56:59], v[104:107], a[48:51]
  s_add_u32 s24, s24, 32768
  v_mfma_f32_16x16x32_bf16 a[56:59], v[56:59], v[108:111], a[56:59]
  s_and_b32 s24, s24, 0x1ffff
  v_mfma_f32_16x16x32_bf16 a[112:115], v[56:59], v[112:115], a[112:115]
  v_xor_b32 v14, 0x10000, v14
  v_mfma_f32_16x16x32_bf16 a[120:123], v[56:59], v[116:119], a[120:123]
  v_xor_b32 v12, 0x10000, v12
  v_mfma_f32_16x16x32_bf16 a[176:179], v[56:59], v[120:123], a[176:179]
  v_xor_b32 v13, 0x10000, v13
  v_mfma_f32_16x16x32_bf16 a[184:187], v[56:59], v[124:127], a[184:187]
  v_mfma_f32_16x16x32_bf16 a[244:247], v[60:63], v[96:99], a[244:247]
  v_mfma_f32_16x16x32_bf16 a[252:255], v[60:63], v[100:103], a[252:255]
  v_mfma_f32_16x16x32_bf16 a[52:55], v[60:63], v[104:107], a[52:55]
  v_mfma_f32_16x16x32_bf16 a[60:63], v[60:63], v[108:111], a[60:63]
  v_mfma_f32_16x16x32_bf16 a[116:119], v[60:63], v[112:115], a[116:119]
  v_mfma_f32_16x16x32_bf16 a[124:127], v[60:63], v[116:119], a[124:127]
  v_mfma_f32_16x16x32_bf16 a[180:183], v[60:63], v[120:123], a[180:183]
  v_mfma_f32_16x16x32_bf16 a[188:191], v[60:63], v[124:127], a[188:191]
  s_waitcnt lgkmcnt(0)
  v_mfma_f32_16x16x32_bf16 a[192:195], v[64:67], v[128:131], a[192:195]
  s_waitcnt vmcnt(18)
  v_mfma_f32_16x16x32_bf16 a[200:203], v[64:67], v[132:135], a[200:203]
  s_barrier
  v_mfma_f32_16x16x32_bf16 a[0:3], v[64:67], v[136:139], a[0:3]
  ds_read_b64_tr_b16 v[32:33], v12 offset:0
  v_mfma_f32_16x16x32_bf16 a[8:11], v[64:67], v[140:143], a[8:11]
  v_mfma_f32_16x16x32_bf16 a[64:67], v[64:67], v[144:147], a[64:67]
  s_mov_b32 m0, s24
  ds_read_b64_tr_b16 v[34:35], v12 offset:1024
  v_mfma_f32_16x16x32_bf16 a[72:75], v[64:67], v[148:151], a[72:75]
  buffer_load_dwordx4 v3, s[32:35], s26 offen offset:0 sc1 lds
  v_mfma_f32_16x16x32_bf16 a[128:131], v[64:67], v[152:155], a[128:131]
  ds_read_b128 v[96:99], v14 offset:0
  v_mfma_f32_16x16x32_bf16 a[136:139], v[64:67], v[156:159], a[136:139]
  v_mfma_f32_16x16x32_bf16 a[196:199], v[68:71], v[128:131], a[196:199]
  ds_read_b64_tr_b16 v[36:37], v13 offset:0
  v_mfma_f32_16x16x32_bf16 a[204:207], v[68:71], v[132:135], a[204:207]
  v_mfma_f32_16x16x32_bf16 a[4:7], v[68:71], v[136:139], a[4:7]
  ds_read_b64_tr_b16 v[38:39], v13 offset:1024
  v_mfma_f32_16x16x32_bf16 a[12:15], v[68:71], v[140:143], a[12:15]
  buffer_load_dwordx4 v4, s[32:35], s26 offen offset:1024 sc1 lds
  v_mfma_f32_16x16x32_bf16 a[68:71], v[68:71], v[144:147], a[68:71]
  ds_read_b128 v[100:103], v14 offset:1024
  v_mfma_f32_16x16x32_bf16 a[76:79], v[68:71], v[148:151], a[76:79]
  v_mfma_f32_16x16x32_bf16 a[132:135], v[68:71], v[152:155], a[132:135]
  ds_read_b64_tr_b16 v[40:41], v12 offset:256
  v_mfma_f32_16x16x32_bf16 a[140:143], v[68:71], v[156:159], a[140:143]
  v_mfma_f32_16x16x32_bf16 a[208:211], v[72:75], v[128:131], a[208:211]
  ds_read_b64_tr_b16 v[42:43], v12 offset:1280
  v_mfma_f32_16x16x32_bf16 a[216:219], v[72:75], v[132:135], a[216:219]
  buffer_load_dwordx4 v5, s[32:35], s26 offen offset:2048 sc1 lds
  v_mfma_f32_16x16x32_bf16 a[16:19], v[72:75], v[136:139], a[16:19]
  ds_read_b128 v[104:107], v14 offset:4096
  v_mfma_f32_16x16x32_bf16 a[24:27], v[72:75], v[140:143], a[24:27]
  v_mfma_f32_16x16x32_bf16 a[80:83], v[72:75], v[144:147], a[80:83]
  ds_read_b64_tr_b16 v[44:45], v13 offset:256
  v_mfma_f32_16x16x32_bf16 a[88:91], v[72:75], v[148:151], a[88:91]
  v_mfma_f32_16x16x32_bf16 a[144:147], v[72:75], v[152:155], a[144:147]
  ds_read_b64_tr_b16 v[46:47], v13 offset:1280
  v_mfma_f32_16x16x32_bf16 a[152:155], v[72:75], v[156:159], a[152:155]
  buffer_load_dwordx4 v6, s[32:35], s26 offen offset:3072 sc1 lds
  v_mfma_f32_16x16x32_bf16 a[212:215], v[76:79], v[128:131], a[212:215]
  ds_read_b128 v[108:111], v14 offset:5120
  v_mfma_f32_16x16x32_bf16 a[220:223], v[76:79], v[132:135], a[220:223]
  v_mfma_f32_16x16x32_bf16 a[20:23], v[76:79], v[136:139], a[20:23]
  ds_read_b64_tr_b16 v[48:49], v12 offset:512
  v_mfma_f32_16x16x32_bf16 a[28:31], v[76:79], v[140:143], a[28:31]
  v_mfma_f32_16x16x32_bf16 a[84:87], v[76:79], v[144:147], a[84:87]
  s_add_u32 m0, s24, 16384
  ds_read_b64_tr_b16 v[50:51], v12 offset:1536
  v_mfma_f32_16x16x32_bf16 a[92:95], v[76:79], v[148:151], a[92:95]
  buffer_load_dwordx4 v8, s[36:39], s27 offen offset:0 lds
  v_mfma_f32_16x16x32_bf16 a[148:151], v[76:79], v[152:155], a[148:151]
  ds_read_b128 v[112:115], v14 offset:8192
  v_mfma_f32_16x16x32_bf16 a[156:159], v[76:79], v[156:159], a[156:159]
  v_mfma_f32_16x16x32_bf16 a[224:227], v[80:83], v[128:131], a[224:227]
  ds_read_b64_tr_b16 v[52:53], v13 offset:512
  v_mfma_f32_16x16x32_bf16 a[232:235], v[80:83], v[132:135], a[232:235]
  v_mfma_f32_16x16x32_bf16 a[32:35], v[80:83], v[136:139], a[32:35]
  ds_read_b64_tr_b16 v[54:55], v13 offset:1536
  v_mfma_f32_16x16x32_bf16 a[40:43], v[80:83], v[140:143], a[40:43]
  buffer_load_dwordx4 v9, s[36:39], s27 offen offset:1024 lds
  v_mfma_f32_16x16x32_bf16 a[96:99], v[80:83], v[144:147], a[96:99]
  ds_read_b128 v[116:119], v14 offset:9216
  v_mfma_f32_16x16x32_bf16 a[104:107], v[80:83], v[148:151], a[104:107]
  v_mfma_f32_16x16x32_bf16 a[160:163], v[80:83], v[152:155], a[160:163]
  ds_read_b64_tr_b16 v[56:57], v12 offset:768
  v_mfma_f32_16x16x32_bf16 a[168:171], v[80:83], v[156:159], a[168:171]
  v_mfma_f32_16x16x32_bf16 a[228:231], v[84:87], v[128:131], a[228:231]
  ds_read_b64_tr_b16 v[58:59], v12 offset:1792
  v_mfma_f32_16x16x32_bf16 a[236:239], v[84:87], v[132:135], a[236:239]
  buffer_load_dwordx4 v10, s[36:39], s27 offen offset:2048 lds
  v_mfma_f32_16x16x32_bf16 a[36:39], v[84:87], v[136:139], a[36:39]
  ds_read_b128 v[120:123], v14 offset:12288
  v_mfma_f32_16x16x32_bf16 a[44:47], v[84:87], v[140:143], a[44:47]
  v_mfma_f32_16x16x32_bf16 a[100:103], v[84:87], v[144:147], a[100:103]
  ds_read_b64_tr_b16 v[60:61], v13 offset:768
  v_mfma_f32_16x16x32_bf16 a[108:111], v[84:87], v[148:151], a[108:111]
  v_mfma_f32_16x16x32_bf16 a[164:167], v[84:87], v[152:155], a[164:167]
  ds_read_b64_tr_b16 v[62:63], v13 offset:1792
  v_mfma_f32_16x16x32_bf16 a[172:175], v[84:87], v[156:159], a[172:175]
  buffer_load_dwordx4 v11, s[36:39], s27 offen offset:3072 lds
  v_mfma_f32_16x16x32_bf16 a[240:243], v[88:91], v[128:131], a[240:243]
  s_add_u32 s26, s26, s79
  ds_read_b128 v[124:127], v14 offset:13312
  v_mfma_f32_16x16x32_bf16 a[248:251], v[88:91], v[132:135], a[248:251]
  s_add_u32 s27, s27, s25
  v_mfma_f32_16x16x32_bf16 a[48:51], v[88:91], v[136:139], a[48:51]
  s_add_u32 s24, s24, 32768
  v_mfma_f32_16x16x32_bf16 a[56:59], v[88:91], v[140:143], a[56:59]
  s_and_b32 s24, s24, 0x1ffff
  v_mfma_f32_16x16x32_bf16 a[112:115], v[88:91], v[144:147], a[112:115]
  v_mfma_f32_16x16x32_bf16 a[120:123], v[88:91], v[148:151], a[120:123]
  s_bitcmp1_b32 s76, s28
  v_mfma_f32_16x16x32_bf16 a[176:179], v[88:91], v[152:155], a[176:179]
  s_cbranch_scc1 fa_hk1
fa_hb1:
  v_mfma_f32_16x16x32_bf16 a[184:187], v[88:91], v[156:159], a[184:187]
  v_mfma_f32_16x16x32_bf16 a[244:247], v[92:95], v[128:131], a[244:247]
  v_mfma_f32_16x16x32_bf16 a[252:255], v[92:95], v[132:135], a[252:255]
  s_add_u32 s28, s28, 1
  v_mfma_f32_16x16x32_bf16 a[52:55], v[92:95], v[136:139], a[52:55]
  v_mfma_f32_16x16x32_bf16 a[60:63], v[92:95], v[140:143], a[60:63]
  v_mfma_f32_16x16x32_bf16 a[116:119], v[92:95], v[144:147], a[116:119]
  v_mfma_f32_16x16x32_bf16 a[124:127], v[92:95], v[148:151], a[124:127]
  s_cmp_lt_u32 s28, 8
  v_mfma_f32_16x16x32_bf16 a[180:183], v[92:95], v[152:155], a[180:183]
  s_waitcnt lgkmcnt(0)
  v_mfma_f32_16x16x32_bf16 a[188:191], v[92:95], v[156:159], a[188:191]
  s_cbranch_scc1 fa_loopK
  s_mov_b32 s64, 16777216
  s_mov_b32 s76, 0x3e0293ee
  s_branch fa_p1epi
fa_roleV:
  ds_read_b128 v[32:35], v14 offset:0
  ds_read_b128 v[36:39], v14 offset:1024
  ds_read_b128 v[40:43], v14 offset:4096
  ds_read_b128 v[44:47], v14 offset:5120
  ds_read_b128 v[48:51], v14 offset:8192
  ds_read_b128 v[52:55], v14 offset:9216
  ds_read_b128 v[56:59], v14 offset:12288
  ds_read_b128 v[60:63], v14 offset:13312
  ds_read_b64_tr_b16 v[96:97], v12 offset:0
  ds_read_b64_tr_b16 v[98:99], v12 offset:1024
  ds_read_b64_tr_b16 v[100:101], v13 offset:0
  ds_read_b64_tr_b16 v[102:103], v13 offset:1024
  ds_read_b64_tr_b16 v[104:105], v12 offset:256
  ds_read_b64_tr_b16 v[106:107], v12 offset:1280
  ds_read_b64_tr_b16 v[108:109], v13 offset:256
  ds_read_b64_tr_b16 v[110:111], v13 offset:1280
  ds_read_b64_tr_b16 v[112:113], v12 offset:512
  ds_read_b64_tr_b16 v[114:115], v12 offset:1536
  ds_read_b64_tr_b16 v[116:117], v13 offset:512
  ds_read_b64_tr_b16 v[118:119], v13 offset:1536
  ds_read_b64_tr_b16 v[120:121], v12 offset:768
  ds_read_b64_tr_b16 v[122:123], v12 offset:1792
  ds_read_b64_tr_b16 v[124:125], v13 offset:768
  ds_read_b64_tr_b16 v[126:127], v13 offset:1792
  s_mov_b32 m0, s24
  s_nop 0
  buffer_load_dwordx4 v3, s[32:35], s26 offen offset:0 sc1 lds
  buffer_load_dwordx4 v4, s[32:35], s26 offen offset:1024 sc1 lds
  buffer_load_dwordx4 v5, s[32:35], s26 offen offset:2048 sc1 lds
  buffer_load_dwordx4 v6, s[32:35], s26 offen offset:3072 sc1 lds
  s_add_u32 m0, s24, 16384
  s_nop 0
  buffer_load_dwordx4 v8, s[36:39], s27 offen offset:0 lds
  buffer_load_dwordx4 v9, s[36:39], s27 offen offset:1024 lds
  buffer_load_dwordx4 v10, s[36:39], s27 offen offset:2048 lds
  buffer_load_dwordx4 v11, s[36:39], s27 offen offset:3072 lds
  s_add_u32 s26, s26, s79
  s_add_u32 s27, s27, s25
  s_add_u32 s24, s24, 32768
  s_and_b32 s24, s24, 0x1ffff
  buffer_load_dword v231, v19, s[32:35], 0 offen
  s_mov_b32 m0, s24
  s_nop 0
  buffer_load_dwordx4 v3, s[32:35], s26 offen offset:0 sc1 lds
  buffer_load_dwordx4 v4, s[32:35], s26 offen offset:1024 sc1 lds
  buffer_load_dwordx4 v5, s[32:35], s26 offen offset:2048 sc1 lds
  buffer_load_dwordx4 v6, s[32:35], s26 offen offset:3072 sc1 lds
  s_add_u32 m0, s24, 16384
  s_nop 0
  buffer_load_dwordx4 v8, s[36:39], s27 offen offset:0 lds
  buffer_load_dwordx4 v9, s[36:39], s27 offen offset:1024 lds
  buffer_load_dwordx4 v10, s[36:39], s27 offen offset:2048 lds
  buffer_load_dwordx4 v11, s[36:39], s27 offen offset:3072 lds
  s_add_u32 s26, s26, s79
  s_add_u32 s27, s27, s25
  s_add_u32 s24, s24, 32768
  s_and_b32 s24, s24, 0x1ffff
  s_waitcnt lgkmcnt(0)
.p2align 6
fa_loopV:
  v_mfma_f32_16x16x32_bf16 a[192:195], v[32:35], v[96:99], a[192:195]
  s_waitcnt vmcnt(17)
  v_mfma_f32_16x16x32_bf16 a[200:203], v[32:35], v[100:103], a[200:203]
  s_barrier
  v_mfma_f32_16x16x32_bf16 a[208:211], v[32:35], v[104:107], a[208:211]
  ds_read_b64_tr_b16 v[128:129], v12 offset:32768
  v_mfma_f32_16x16x32_bf16 a[216:219], v[32:35], v[108:111], a[216:219]
  v_mfma_f32_16x16x32_bf16 a[224:227], v[32:35], v[112:115], a[224:227]
  s_mov_b32 m0, s24
  ds_read_b64_tr_b16 v[130:131], v12 offset:33792
  v_mfma_f32_16x16x32_bf16 a[232:235], v[32:35], v[116:119], a[232:235]
  buffer_load_dwordx4 v3, s[32:35], s26 offen offset:0 sc1 lds
  v_mfma_f32_16x16x32_bf16 a[240:243], v[32:35], v[120:123], a[240:243]
  ds_read_b128 v[64:67], v14 offset:32768
  v_mfma_f32_16x16x32_bf16 a[248:251], v[32:35], v[124:127], a[248:251]
  buffer_load_dwordx4 v4, s[32:35], s26 offen offset:1024 sc1 lds
  v_mfma_f32_16x16x32_bf16 a[196:199], v[36:39], v[96:99], a[196:199]
  ds_read_b64_tr_b16 v[132:133], v13 offset:32768
  v_mfma_f32_16x16x32_bf16 a[204:207], v[36:39], v[100:103], a[204:207]
  buffer_load_dwordx4 v5, s[32:35], s26 offen offset:2048 sc1 lds
  v_mfma_f32_16x16x32_bf16 a[212:215], v[36:39], v[104:107], a[212:215]
  ds_read_b64_tr_b16 v[134:135], v13 offset:33792
  v_mfma_f32_16x16x32_bf16 a[220:223], v[36:39], v[108:111], a[220:223]
  buffer_load_dwordx4 v6, s[32:35], s26 offen offset:3072 sc1 lds
  v_mfma_f32_16x16x32_bf16 a[228:231], v[36:39], v[112:115], a[228:231]
  s_add_u32 m0, s24, 16384
  ds_read_b128 v[68:71], v14 offset:33792
  v_mfma_f32_16x16x32_bf16 a[236:239], v[36:39], v[116:119], a[236:239]
  buffer_load_dwordx4 v8, s[36:39], s27 offen offset:0 lds
  v_mfma_f32_16x16x32_bf16 a[244:247], v[36:39], v[120:123], a[244:247]
  ds_read_b64_tr_b16 v[136:137], v12 offset:33024
  v_mfma_f32_16x16x32_bf16 a[252:255], v[36:39], v[124:127], a[252:255]
  buffer_load_dwordx4 v9, s[36:39], s27 offen offset:1024 lds
  v_mfma_f32_16x16x32_bf16 a[0:3], v[40:43], v[96:99], a[0:3]
  ds_read_b64_tr_b16 v[138:139], v12 offset:34048
  v_mfma_f32_16x16x32_bf16 a[8:11], v[40:43], v[100:103], a[8:11]
  buffer_load_dwordx4 v10, s[36:39], s27 offen offset:2048 lds
  v_mfma_f32_16x16x32_bf16 a[16:19], v[40:43], v[104:107], a[16:19]
  ds_read_b128 v[72:75], v14 offset:36864
  v_mfma_f32_16x16x32_bf16 a[24:27], v[40:43], v[108:111], a[24:27]
  buffer_load_dwordx4 v11, s[36:39], s27 offen offset:3072 lds
  v_mfma_f32_16x16x32_bf16 a[32:35], v[40:43], v[112:115], a[32:35]
  ds_read_b64_tr_b16 v[140:141], v13 offset:33024
  v_mfma_f32_16x16x32_bf16 a[40:43], v[40:43], v[116:119], a[40:43]
  buffer_load_dword v231, v235, s[48:51], s74 offen sc1
  v_mfma_f32_16x16x32_bf16 a[48:51], v[40:43], v[120:123], a[48:51]
  s_add_u32 s74, s74, s73
  ds_read_b64_tr_b16 v[142:143], v13 offset:34048
  v_mfma_f32_16x16x32_bf16 a[56:59], v[40:43], v[124:127], a[56:59]
  s_bitcmp1_b32 s72, s28
  v_mfma_f32_16x16x32_bf16 a[4:7], v[44:47], v[96:99], a[4:7]
  s_cbranch_scc1 fa_hk2
fa_hb2:
  ds_read_b128 v[76:79], v14 offset:37888
  v_mfma_f32_16x16x32_bf16 a[12:15], v[44:47], v[100:103], a[12:15]
  v_mfma_f32_16x16x32_bf16 a[20:23], v[44:47], v[104:107], a[20:23]
  ds_read_b64_tr_b16 v[144:145], v12 offset:33280
  v_mfma_f32_16x16x32_bf16 a[28:31], v[44:47], v[108:111], a[28:31]
  v_mfma_f32_16x16x32_bf16 a[36:39], v[44:47], v[112:115], a[36:39]
  ds_read_b64_tr_b16 v[146:147], v12 offset:34304
  v_mfma_f32_16x16x32_bf16 a[44:47], v[44:47], v[116:119], a[44:47]
  v_mfma_f32_16x16x32_bf16 a[52:55], v[44:47], v[120:123], a[52:55]
  ds_read_b128 v[80:83], v14 offset:40960
  v_mfma_f32_16x16x32_bf16 a[60:63], v[44:47], v[124:127], a[60:63]
  v_mfma_f32_16x16x32_bf16 a[64:67], v[48:51], v[96:99], a[64:67]
  ds_read_b64_tr_b16 v[148:149], v13 offset:33280
  v_mfma_f32_16x16x32_bf16 a[72:75], v[48:51], v[100:103], a[72:75]
  v_mfma_f32_16x16x32_bf16 a[80:83], v[48:51], v[104:107], a[80:83]
  ds_read_b64_tr_b16 v[150:151], v13 offset:34304
  v_mfma_f32_16x16x32_bf16 a[88:91], v[48:51], v[108:111], a[88:91]
  v_mfma_f32_16x16x32_bf16 a[96:99], v[48:51], v[112:115], a[96:99]
  ds_read_b128 v[84:87], v14 offset:41984
  v_mfma_f32_16x16x32_bf16 a[104:107], v[48:51], v[116:119], a[104:107]
  v_mfma_f32_16x16x32_bf16 a[112:115], v[48:51], v[120:123], a[112:115]
  ds_read_b64_tr_b16 v[152:153], v12 offset:33536
  v_mfma_f32_16x16x32_bf16 a[120:123], v[48:51], v[124:127], a[120:123]
  v_mfma_f32_16x16x32_bf16 a[68:71], v[52:55], v[96:99], a[68:71]
  ds_read_b64_tr_b16 v[154:155], v12 offset:34560
  v_mfma_f32_16x16x32_bf16 a[76:79], v[52:55], v[100:103], a[76:79]
  v_mfma_f32_16x16x32_bf16 a[84:87], v[52:55], v[104:107], a[84:87]
  ds_read_b128 v[88:91], v14 offset:45056
  v_mfma_f32_16x16x32_bf16 a[92:95], v[52:55], v[108:111], a[92:95]
  v_mfma_f32_16x16x32_bf16 a[100:103], v[52:55], v[112:115], a[100:103]
  ds_read_b64_tr_b16 v[156:157], v13 offset:33536
  v_mfma_f32_16x16x32_bf16 a[108:111], v[52:55], v[116:119], a[108:111]
  v_mfma_f32_16x16x32_bf16 a[116:119], v[52:55], v[120:123], a[116:119]
  ds_read_b64_tr_b16 v[158:159], v13 offset:34560
  v_mfma_f32_16x16x32_bf16 a[124:127], v[52:55], v[124:127], a[124:127]
  v_mfma_f32_16x16x32_bf16 a[128:131], v[56:59], v[96:99], a[128:131]
  s_add_u32 s26, s26, s79
  ds_read_b128 v[92:95], v14 offset:46080
  v_mfma_f32_16x16x32_bf16 a[136:139], v[56:59], v[100:103], a[136:139]
  s_add_u32 s27, s27, s25
  v_mfma_f32_16x16x32_bf16 a[144:147], v[56:59], v[104:107], a[144:147]
  s_add_u32 s24, s24, 32768
  v_mfma_f32_16x16x32_bf16 a[152:155], v[56:59], v[108:111], a[152:155]
  s_and_b32 s24, s24, 0x1ffff
  v_mfma_f32_16x16x32_bf16 a[160:163], v[56:59], v[112:115], a[160:163]
  v_xor_b32 v14, 0x10000, v14
  v_mfma_f32_16x16x32_bf16 a[168:171], v[56:59], v[116:119], a[168:171]
  v_xor_b32 v12, 0x10000, v12
  v_mfma_f32_16x16x32_bf16 a[176:179], v[56:59], v[120:123], a[176:179]
  v_xor_b32 v13, 0x10000, v13
  v_mfma_f32_16x16x32_bf16 a[184:187], v[56:59], v[124:127], a[184:187]
  v_mfma_f32_16x16x32_bf16 a[132:135], v[60:63], v[96:99], a[132:135]
  v_mfma_f32_16x16x32_bf16 a[140:143], v[60:63], v[100:103], a[140:143]
  v_mfma_f32_16x16x32_bf16 a[148:151], v[60:63], v[104:107], a[148:151]
  v_mfma_f32_16x16x32_bf16 a[156:159], v[60:63], v[108:111], a[156:159]
  v_mfma_f32_16x16x32_bf16 a[164:167], v[60:63], v[112:115], a[164:167]
  v_mfma_f32_16x16x32_bf16 a[172:175], v[60:63], v[116:119], a[172:175]
  v_mfma_f32_16x16x32_bf16 a[180:183], v[60:63], v[120:123], a[180:183]
  v_mfma_f32_16x16x32_bf16 a[188:191], v[60:63], v[124:127], a[188:191]
  s_waitcnt lgkmcnt(0)
  v_mfma_f32_16x16x32_bf16 a[192:195], v[64:67], v[128:131], a[192:195]
  s_waitcnt vmcnt(18)
  v_mfma_f32_16x16x32_bf16 a[200:203], v[64:67], v[132:135], a[200:203]
  s_barrier
  v_mfma_f32_16x16x32_bf16 a[208:211], v[64:67], v[136:139], a[208:211]
  ds_read_b64_tr_b16 v[96:97], v12 offset:0
  v_mfma_f32_16x16x32_bf16 a[216:219], v[64:67], v[140:143], a[216:219]
  v_mfma_f32_16x16x32_bf16 a[224:227], v[64:67], v[144:147], a[224:227]
  s_mov_b32 m0, s24
  ds_read_b64_tr_b16 v[98:99], v12 offset:1024
  v_mfma_f32_16x16x32_bf16 a[232:235], v[64:67], v[148:151], a[232:235]
  buffer_load_dwordx4 v3, s[32:35], s26 offen offset:0 sc1 lds
  v_mfma_f32_16x16x32_bf16 a[240:243], v[64:67], v[152:155], a[240:243]
  ds_read_b128 v[32:35], v14 offset:0
  v_mfma_f32_16x16x32_bf16 a[248:251], v[64:67], v[156:159], a[248:251]
  v_mfma_f32_16x16x32_bf16 a[196:199], v[68:71], v[128:131], a[196:199]
  ds_read_b64_tr_b16 v[100:101], v13 offset:0
  v_mfma_f32_16x16x32_bf16 a[204:207], v[68:71], v[132:135], a[204:207]
  v_mfma_f32_16x16x32_bf16 a[212:215], v[68:71], v[136:139], a[212:215]
  ds_read_b64_tr_b16 v[102:103], v13 offset:1024
  v_mfma_f32_16x16x32_bf16 a[220:223], v[68:71], v[140:143], a[220:223]
  buffer_load_dwordx4 v4, s[32:35], s26 offen offset:1024 sc1 lds
  v_mfma_f32_16x16x32_bf16 a[228:231], v[68:71], v[144:147], a[228:231]
  ds_read_b128 v[36:39], v14 offset:1024
  v_mfma_f32_16x16x32_bf16 a[236:239], v[68:71], v[148:151], a[236:239]
  v_mfma_f32_16x16x32_bf16 a[244:247], v[68:71], v[152:155], a[244:247]
  ds_read_b64_tr_b16 v[104:105], v12 offset:256
  v_mfma_f32_16x16x32_bf16 a[252:255], v[68:71], v[156:159], a[252:255]
  v_mfma_f32_16x16x32_bf16 a[0:3], v[72:75], v[128:131], a[0:3]
  ds_read_b64_tr_b16 v[106:107], v12 offset:1280
  v_mfma_f32_16x16x32_bf16 a[8:11], v[72:75], v[132:135], a[8:11]
  buffer_load_dwordx4 v5, s[32:35], s26 offen offset:2048 sc1 lds
  v_mfma_f32_16x16x32_bf16 a[16:19], v[72:75], v[136:139], a[16:19]
  ds_read_b128 v[40:43], v14 offset:4096
  v_mfma_f32_16x16x32_bf16 a[24:27], v[72:75], v[140:143], a[24:27]
  v_mfma_f32_16x16x32_bf16 a[32:35], v[72:75], v[144:147], a[32:35]
  ds_read_b64_tr_b16 v[108:109], v13 offset:256
  v_mfma_f32_16x16x32_bf16 a[40:43], v[72:75], v[148:151], a[40:43]
  v_mfma_f32_16x16x32_bf16 a[48:51], v[72:75], v[152:155], a[48:51]
  ds_read_b64_tr_b16 v[110:111], v13 offset:1280
  v_mfma_f32_16x16x32_bf16 a[56:59], v[72:75], v[156:159], a[56:59]
  buffer_load_dwordx4 v6, s[32:35], s26 offen offset:3072 sc1 lds
  v_mfma_f32_16x16x32_bf16 a[4:7], v[76:79], v[128:131], a[4:7]
  ds_read_b128 v[44:47], v14 offset:5120
  v_mfma_f32_16x16x32_bf16 a[12:15], v[76:79], v[132:135], a[12:15]
  v_mfma_f32_16x16x32_bf16 a[20:23], v[76:79], v[136:139], a[20:23]
  ds_read_b64_tr_b16 v[112:113], v12 offset:512
  v_mfma_f32_16x16x32_bf16 a[28:31], v[76:79], v[140:143], a[28:31]
  v_mfma_f32_16x16x32_bf16 a[36:39], v[76:79], v[144:147], a[36:39]
  s_add_u32 m0, s24, 16384
  ds_read_b64_tr_b16 v[114:115], v12 offset:1536
  v_mfma_f32_16x16x32_bf16 a[44:47], v[76:79], v[148:151], a[44:47]
  buffer_load_dwordx4 v8, s[36:39], s27 offen offset:0 lds
  v_mfma_f32_16x16x32_bf16 a[52:55], v[76:79], v[152:155], a[52:55]
  ds_read_b128 v[48:51], v14 offset:8192
  v_mfma_f32_16x16x32_bf16 a[60:63], v[76:79], v[156:159], a[60:63]
  v_mfma_f32_16x16x32_bf16 a[64:67], v[80:83], v[128:131], a[64:67]
  ds_read_b64_tr_b16 v[116:117], v13 offset:512
  v_mfma_f32_16x16x32_bf16 a[72:75], v[80:83], v[132:135], a[72:75]
  v_mfma_f32_16x16x32_bf16 a[80:83], v[80:83], v[136:139], a[80:83]
  ds_read_b64_tr_b16 v[118:119], v13 offset:1536
  v_mfma_f32_16x16x32_bf16 a[88:91], v[80:83], v[140:143], a[88:91]
  buffer_load_dwordx4 v9, s[36:39], s27 offen offset:1024 lds
  v_mfma_f32_16x16x32_bf16 a[96:99], v[80:83], v[144:147], a[96:99]
  ds_read_b128 v[52:55], v14 offset:9216
  v_mfma_f32_16x16x32_bf16 a[104:107], v[80:83], v[148:151], a[104:107]
  v_mfma_f32_16x16x32_bf16 a[112:115], v[80:83], v[152:155], a[112:115]
  ds_read_b64_tr_b16 v[120:121], v12 offset:768
  v_mfma_f32_16x16x32_bf16 a[120:123], v[80:83], v[156:159], a[120:123]
  v_mfma_f32_16x16x32_bf16 a[68:71], v[84:87], v[128:131], a[68:71]
  ds_read_b64_tr_b16 v[122:123], v12 offset:1792
  v_mfma_f32_16x16x32_bf16 a[76:79], v[84:87], v[132:135], a[76:79]
  buffer_load_dwordx4 v10, s[36:39], s27 offen offset:2048 lds
  v_mfma_f32_16x16x32_bf16 a[84:87], v[84:87], v[136:139], a[84:87]
  ds_read_b128 v[56:59], v14 offset:12288
  v_mfma_f32_16x16x32_bf16 a[92:95], v[84:87], v[140:143], a[92:95]
  v_mfma_f32_16x16x32_bf16 a[100:103], v[84:87], v[144:147], a[100:103]
  ds_read_b64_tr_b16 v[124:125], v13 offset:768
  v_mfma_f32_16x16x32_bf16 a[108:111], v[84:87], v[148:151], a[108:111]
  v_mfma_f32_16x16x32_bf16 a[116:119], v[84:87], v[152:155], a[116:119]
  ds_read_b64_tr_b16 v[126:127], v13 offset:1792
  v_mfma_f32_16x16x32_bf16 a[124:127], v[84:87], v[156:159], a[124:127]
  buffer_load_dwordx4 v11, s[36:39], s27 offen offset:3072 lds
  v_mfma_f32_16x16x32_bf16 a[128:131], v[88:91], v[128:131], a[128:131]
  s_add_u32 s26, s26, s79
  ds_read_b128 v[60:63], v14 offset:13312
  v_mfma_f32_16x16x32_bf16 a[136:139], v[88:91], v[132:135], a[136:139]
  s_add_u32 s27, s27, s25
  v_mfma_f32_16x16x32_bf16 a[144:147], v[88:91], v[136:139], a[144:147]
  s_add_u32 s24, s24, 32768
  v_mfma_f32_16x16x32_bf16 a[152:155], v[88:91], v[140:143], a[152:155]
  s_and_b32 s24, s24, 0x1ffff
  v_mfma_f32_16x16x32_bf16 a[160:163], v[88:91], v[144:147], a[160:163]
  v_mfma_f32_16x16x32_bf16 a[168:171], v[88:91], v[148:151], a[168:171]
  s_bitcmp1_b32 s76, s28
  v_mfma_f32_16x16x32_bf16 a[176:179], v[88:91], v[152:155], a[176:179]
  s_cbranch_scc1 fa_hk3
fa_hb3:
  v_mfma_f32_16x16x32_bf16 a[184:187], v[88:91], v[156:159], a[184:187]
  v_mfma_f32_16x16x32_bf16 a[132:135], v[92:95], v[128:131], a[132:135]
  v_mfma_f32_16x16x32_bf16 a[140:143], v[92:95], v[132:135], a[140:143]
  s_add_u32 s28, s28, 1
  v_mfma_f32_16x16x32_bf16 a[148:151], v[92:95], v[136:139], a[148:151]
  v_mfma_f32_16x16x32_bf16 a[156:159], v[92:95], v[140:143], a[156:159]
  v_mfma_f32_16x16x32_bf16 a[164:167], v[92:95], v[144:147], a[164:167]
  v_mfma_f32_16x16x32_bf16 a[172:175], v[92:95], v[148:151], a[172:175]
  s_cmp_lt_u32 s28, 8
  v_mfma_f32_16x16x32_bf16 a[180:183], v[92:95], v[152:155], a[180:183]
  s_waitcnt lgkmcnt(0)
  v_mfma_f32_16x16x32_bf16 a[188:191], v[92:95], v[156:159], a[188:191]
  s_cbranch_scc1 fa_loopV
  s_mov_b32 s64, 33554432
  s_mov_b32 s76, 1.0
fa_p1epi:
  s_lshr_b32 s23, s20, 1
  s_lshl_b32 s23, s23, 13
  v_subrev_u32 v12, s23, v12
  v_subrev_u32 v13, s23, v13
  s_lshl_b32 s24, s20, 12
  v_add_u32 v14, s24, v2
  ds_read_b64_tr_b16 v[32:33], v12 offset:0
  ds_read_b64_tr_b16 v[34:35], v12 offset:1024
  ds_read_b64_tr_b16 v[36:37], v13 offset:0
  ds_read_b64_tr_b16 v[38:39], v13 offset:1024
  ds_read_b64_tr_b16 v[40:41], v12 offset:256
  ds_read_b64_tr_b16 v[42:43], v12 offset:1280
  ds_read_b64_tr_b16 v[44:45], v13 offset:256
  ds_read_b64_tr_b16 v[46:47], v13 offset:1280
  ds_read_b64_tr_b16 v[48:49], v12 offset:512
  ds_read_b64_tr_b16 v[50:51], v12 offset:1536
  ds_read_b64_tr_b16 v[52:53], v13 offset:512
  ds_read_b64_tr_b16 v[54:55], v13 offset:1536
  ds_read_b64_tr_b16 v[56:57], v12 offset:768
  ds_read_b64_tr_b16 v[58:59], v12 offset:1792
  ds_read_b64_tr_b16 v[60:61], v13 offset:768
  ds_read_b64_tr_b16 v[62:63], v13 offset:1792
  s_waitcnt vmcnt(8)
  ds_read_b128 v[224:227], v14 offset:0
  ds_read_b128 v[228:231], v14 offset:1024
  ds_read_b128 v[232:235], v14 offset:2048
  ds_read_b128 v[236:239], v14 offset:3072
  s_lshl_b32 s23, s21, 19
  s_add_u32 s64, s64, s23
  s_lshl_b32 s23, s22, 14
  s_add_u32 s64, s64, s23
  s_and_b32 s23, s20, 1
  s_lshl_b32 s23, s23, 13
  s_add_u32 s64, s64, s23
  s_lshl_b32 s23, s21, 19
  s_add_u32 s23, s23, 16777216
  s_add_u32 s6, s18, s23
  s_addc_u32 s7, s19, 0
  s_add_u32 s8, s6, 16777216
  s_addc_u32 s9, s7, 0
  s_sub_u32 s23, 16, s22
  s_lshl_b32 s23, s23, 15
  s_mov_b32 s44, s6
  s_mov_b32 s45, s7
  s_mov_b32 s46, s23
  s_mov_b32 s47, 0x20000
  s_mov_b32 s48, s8
  s_mov_b32 s49, s9
  s_mov_b32 s50, s23
  s_mov_b32 s51, 0x20000
  s_lshl_b32 s30, s21, 7
  s_add_u32 s30, s30, 2637824
  s_mov_b32 s81, 0x47800000
  s_cmp_eq_u32 s20, 0
  s_cselect_b32 s65, s82, 1073741824
  s_waitcnt vmcnt(21) lgkmcnt(0)
  v_mfma_f32_16x16x32_bf16 v[96:99], v[32:35], v[224:227], 0
  v_accvgpr_read_b32 v16, a192
  v_accvgpr_read_b32 v17, a193
  v_accvgpr_read_b32 v18, a194
  v_mfma_f32_16x16x32_bf16 v[112:115], v[36:39], v[224:227], 0
  ds_read_b64_tr_b16 v[64:65], v12 offset:8192
  v_accvgpr_read_b32 v19, a195
  v_mfma_f32_16x16x32_bf16 v[128:131], v[40:43], v[224:227], 0
  s_add_u32 m0, s24, 0
  ds_read_b64_tr_b16 v[66:67], v12 offset:9216
  v_accvgpr_read_b32 v20, a196
  v_mfma_f32_16x16x32_bf16 v[144:147], v[44:47], v[224:227], 0
  buffer_load_dwordx4 v3, s[32:35], s26 offen offset:0 sc1 lds
  v_accvgpr_read_b32 v21, a197
  v_mfma_f32_16x16x32_bf16 v[160:163], v[48:51], v[224:227], 0
  ds_read_b64_tr_b16 v[68:69], v13 offset:8192
  v_accvgpr_read_b32 v22, a198
  v_accvgpr_read_b32 v23, a199
  v_mfma_f32_16x16x32_bf16 v[176:179], v[52:55], v[224:227], 0
  ds_read_b64_tr_b16 v[70:71], v13 offset:9216
  v_mul_f32 v16, s76, v16
  v_mfma_f32_16x16x32_bf16 v[192:195], v[56:59], v[224:227], 0
  ds_read_b64_tr_b16 v[72:73], v12 offset:8448
  v_mul_f32 v17, s76, v17
  v_mfma_f32_16x16x32_bf16 v[208:211], v[60:63], v[224:227], 0
  ds_read_b64_tr_b16 v[74:75], v12 offset:9472
  v_mul_f32 v18, s76, v18
  v_mfma_f32_16x16x32_bf16 v[100:103], v[32:35], v[228:231], 0
  buffer_load_dwordx4 v4, s[32:35], s26 offen offset:1024 sc1 lds
  v_mul_f32 v19, s76, v19
  v_mul_f32 v20, s76, v20
  v_mfma_f32_16x16x32_bf16 v[116:119], v[36:39], v[228:231], 0
  ds_read_b64_tr_b16 v[76:77], v13 offset:8448
  v_mul_f32 v21, s76, v21
  v_mfma_f32_16x16x32_bf16 v[132:135], v[40:43], v[228:231], 0
  ds_read_b64_tr_b16 v[78:79], v13 offset:9472
  v_mul_f32 v22, s76, v22
  v_mfma_f32_16x16x32_bf16 v[148:151], v[44:47], v[228:231], 0
  ds_read_b128 v[240:243], v14 offset:32768
  v_mul_f32 v23, s76, v23
  v_mfma_f32_16x16x32_bf16 v[164:167], v[48:51], v[228:231], 0
  ds_read_b128 v[244:247], v14 offset:33792
  v_cvt_pk_bf16_f32 v24, v16, v17
  v_cvt_pk_bf16_f32 v25, v18, v19
  v_mfma_f32_16x16x32_bf16 v[180:183], v[52:55], v[228:231], 0
  buffer_load_dwordx4 v5, s[32:35], s26 offen offset:2048 sc1 lds
  v_cvt_pk_bf16_f32 v26, v20, v21
  v_mfma_f32_16x16x32_bf16 v[196:199], v[56:59], v[228:231], 0
  ds_read_b64_tr_b16 v[80:81], v12 offset:8704
  v_cvt_pk_bf16_f32 v27, v22, v23
  v_mfma_f32_16x16x32_bf16 v[212:215], v[60:63], v[228:231], 0
  ds_read_b64_tr_b16 v[82:83], v12 offset:9728
  buffer_store_dwordx4 v[24:27], v2, s[40:43], s64 offen offset:0 sc1
  v_mfma_f32_16x16x32_bf16 v[104:107], v[32:35], v[232:235], 0
  ds_read_b64_tr_b16 v[84:85], v13 offset:8704
  v_accvgpr_read_b32 v16, a200
  v_mfma_f32_16x16x32_bf16 v[120:123], v[36:39], v[232:235], 0
  ds_read_b64_tr_b16 v[86:87], v13 offset:9728
  v_accvgpr_read_b32 v17, a201
  v_accvgpr_read_b32 v18, a202
  v_mfma_f32_16x16x32_bf16 v[136:139], v[40:43], v[232:235], 0
  buffer_load_dwordx4 v6, s[32:35], s26 offen offset:3072 sc1 lds
  v_accvgpr_read_b32 v19, a203
  v_mfma_f32_16x16x32_bf16 v[152:155], v[44:47], v[232:235], 0
  s_add_u32 s26, s26, 1024
  ds_read_b64_tr_b16 v[88:89], v12 offset:8960
  v_accvgpr_read_b32 v20, a204
  v_mfma_f32_16x16x32_bf16 v[168:171], v[48:51], v[232:235], 0
  ds_read_b64_tr_b16 v[90:91], v12 offset:9984
  v_accvgpr_read_b32 v21, a205
  v_mfma_f32_16x16x32_bf16 v[184:187], v[52:55], v[232:235], 0
  ds_read_b64_tr_b16 v[92:93], v13 offset:8960
  v_accvgpr_read_b32 v22, a206
  v_accvgpr_read_b32 v23, a207
  v_mfma_f32_16x16x32_bf16 v[200:203], v[56:59], v[232:235], 0
  ds_read_b64_tr_b16 v[94:95], v13 offset:9984
  v_mul_f32 v16, s76, v16
  v_mfma_f32_16x16x32_bf16 v[216:219], v[60:63], v[232:235], 0
  v_mul_f32 v17, s76, v17
  v_mul_f32 v18, s76, v18
  v_mfma_f32_16x16x32_bf16 v[108:111], v[32:35], v[236:239], 0
  ds_read_b128 v[248:251], v14 offset:34816
  v_mul_f32 v19, s76, v19
  v_mfma_f32_16x16x32_bf16 v[124:127], v[36:39], v[236:239], 0
  ds_read_b128 v[252:255], v14 offset:35840
  v_mul_f32 v20, s76, v20
  v_mul_f32 v21, s76, v21
  v_mfma_f32_16x16x32_bf16 v[140:143], v[40:43], v[236:239], 0
  v_mul_f32 v22, s76, v22
  v_mul_f32 v23, s76, v23
  v_mfma_f32_16x16x32_bf16 v[156:159], v[44:47], v[236:239], 0
  v_xor_b32 v14, 0x10000, v14
  v_cvt_pk_bf16_f32 v28, v16, v17
  v_mfma_f32_16x16x32_bf16 v[172:175], v[48:51], v[236:239], 0
  v_cvt_pk_bf16_f32 v29, v18, v19
  v_cvt_pk_bf16_f32 v30, v20, v21
  v_mfma_f32_16x16x32_bf16 v[188:191], v[52:55], v[236:239], 0
  v_cvt_pk_bf16_f32 v31, v22, v23
  v_mfma_f32_16x16x32_bf16 v[204:207], v[56:59], v[236:239], 0
  buffer_store_dwordx4 v[28:31], v2, s[40:43], s64 offen offset:1024 sc1
  v_mfma_f32_16x16x32_bf16 v[220:223], v[60:63], v[236:239], 0
  s_waitcnt vmcnt(19) lgkmcnt(0)
  v_mfma_f32_16x16x32_bf16 v[96:99], v[64:67], v[240:243], v[96:99]
  s_barrier
  v_accvgpr_read_b32 v16, a208
  v_accvgpr_read_b32 v17, a209
  v_accvgpr_read_b32 v18, a210
  v_mfma_f32_16x16x32_bf16 v[112:115], v[68:71], v[240:243], v[112:115]
  ds_read_b64_tr_b16 v[32:33], v12 offset:32768
  v_accvgpr_read_b32 v19, a211
  v_mfma_f32_16x16x32_bf16 v[128:131], v[72:75], v[240:243], v[128:131]
  s_add_u32 m0, s24, 32768
  ds_read_b64_tr_b16 v[34:35], v12 offset:33792
  v_accvgpr_read_b32 v20, a212
  v_mfma_f32_16x16x32_bf16 v[144:147], v[76:79], v[240:243], v[144:147]
  buffer_load_dwordx4 v3, s[32:35], s26 offen offset:0 sc1 lds
  v_accvgpr_read_b32 v21, a213
  v_mfma_f32_16x16x32_bf16 v[160:163], v[80:83], v[240:243], v[160:163]
  ds_read_b64_tr_b16 v[36:37], v13 offset:32768
  v_accvgpr_read_b32 v22, a214
  v_accvgpr_read_b32 v23, a215
  v_mfma_f32_16x16x32_bf16 v[176:179], v[84:87], v[240:243], v[176:179]
  ds_read_b64_tr_b16 v[38:39], v13 offset:33792
  v_mul_f32 v16, s76, v16
  v_mfma_f32_16x16x32_bf16 v[192:195], v[88:91], v[240:243], v[192:195]
  ds_read_b64_tr_b16 v[40:41], v12 offset:33024
  v_mul_f32 v17, s76, v17
  v_mfma_f32_16x16x32_bf16 v[208:211], v[92:95], v[240:243], v[208:211]
  ds_read_b64_tr_b16 v[42:43], v12 offset:34048
  v_mul_f32 v18, s76, v18
  v_mfma_f32_16x16x32_bf16 v[100:103], v[64:67], v[244:247], v[100:103]
  buffer_load_dwordx4 v4, s[32:35], s26 offen offset:1024 sc1 lds
  v_mul_f32 v19, s76, v19
  v_mul_f32 v20, s76, v20
  v_mfma_f32_16x16x32_bf16 v[116:119], v[68:71], v[244:247], v[116:119]
  ds_read_b64_tr_b16 v[44:45], v13 offset:33024
  v_mul_f32 v21, s76, v21
  v_mfma_f32_16x16x32_bf16 v[132:135], v[72:75], v[244:247], v[132:135]
  ds_read_b64_tr_b16 v[46:47], v13 offset:34048
  v_mul_f32 v22, s76, v22
  v_mfma_f32_16x16x32_bf16 v[148:151], v[76:79], v[244:247], v[148:151]
  ds_read_b128 v[224:227], v14 offset:0
  v_mul_f32 v23, s76, v23
  v_mfma_f32_16x16x32_bf16 v[164:167], v[80:83], v[244:247], v[164:167]
  ds_read_b128 v[228:231], v14 offset:1024
  v_cvt_pk_bf16_f32 v24, v16, v17
  v_cvt_pk_bf16_f32 v25, v18, v19
  v_mfma_f32_16x16x32_bf16 v[180:183], v[84:87], v[244:247], v[180:183]
  buffer_load_dwordx4 v5, s[32:35], s26 offen offset:2048 sc1 lds
  v_cvt_pk_bf16_f32 v26, v20, v21
  v_mfma_f32_16x16x32_bf16 v[196:199], v[88:91], v[244:247], v[196:199]
  ds_read_b64_tr_b16 v[48:49], v12 offset:33280
  v_cvt_pk_bf16_f32 v27, v22, v23
  v_mfma_f32_16x16x32_bf16 v[212:215], v[92:95], v[244:247], v[212:215]
  ds_read_b64_tr_b16 v[50:51], v12 offset:34304
  buffer_store_dwordx4 v[24:27], v2, s[40:43], s64 offen offset:2048 sc1
  v_mfma_f32_16x16x32_bf16 v[104:107], v[64:67], v[248:251], v[104:107]
  ds_read_b64_tr_b16 v[52:53], v13 offset:33280
  v_accvgpr_read_b32 v16, a216
  v_mfma_f32_16x16x32_bf16 v[120:123], v[68:71], v[248:251], v[120:123]
  ds_read_b64_tr_b16 v[54:55], v13 offset:34304
  v_accvgpr_read_b32 v17, a217
  v_accvgpr_read_b32 v18, a218
  v_mfma_f32_16x16x32_bf16 v[136:139], v[72:75], v[248:251], v[136:139]
  buffer_load_dwordx4 v6, s[32:35], s26 offen offset:3072 sc1 lds
  v_accvgpr_read_b32 v19, a219
  v_mfma_f32_16x16x32_bf16 v[152:155], v[76:79], v[248:251], v[152:155]
  s_add_u32 s26, s26, 1024
  ds_read_b64_tr_b16 v[56:57], v12 offset:33536
  v_accvgpr_read_b32 v20, a220
  v_mfma_f32_16x16x32_bf16 v[168:171], v[80:83], v[248:251], v[168:171]
  ds_read_b64_tr_b16 v[58:59], v12 offset:34560
  v_accvgpr_read_b32 v21, a221
  v_mfma_f32_16x16x32_bf16 v[184:187], v[84:87], v[248:251], v[184:187]
  ds_read_b64_tr_b16 v[60:61], v13 offset:33536
  v_accvgpr_read_b32 v22, a222
  v_accvgpr_read_b32 v23, a223
  v_mfma_f32_16x16x32_bf16 v[200:203], v[88:91], v[248:251], v[200:203]
  s_add_u32 m0, s24, 16384
  ds_read_b64_tr_b16 v[62:63], v13 offset:34560
  v_mul_f32 v16, s76, v16
  v_mfma_f32_16x16x32_bf16 v[216:219], v[92:95], v[248:251], v[216:219]
  buffer_load_dwordx4 v8, s[36:39], s27 offen offset:0 lds
  v_mul_f32 v17, s76, v17
  v_mfma_f32_16x16x32_bf16 v[108:111], v[64:67], v[252:255], v[108:111]
  ds_read_b128 v[232:235], v14 offset:2048
  v_mul_f32 v18, s76, v18
  v_mfma_f32_16x16x32_bf16 v[124:127], v[68:71], v[252:255], v[124:127]
  ds_read_b128 v[236:239], v14 offset:3072
  v_mul_f32 v19, s76, v19
  v_mul_f32 v20, s76, v20
  v_mfma_f32_16x16x32_bf16 v[140:143], v[72:75], v[252:255], v[140:143]
  v_mul_f32 v21, s76, v21
  v_mul_f32 v22, s76, v22
  v_mfma_f32_16x16x32_bf16 v[156:159], v[76:79], v[252:255], v[156:159]
  v_mul_f32 v23, s76, v23
  v_cvt_pk_bf16_f32 v28, v16, v17
  v_mfma_f32_16x16x32_bf16 v[172:175], v[80:83], v[252:255], v[172:175]
  buffer_load_dwordx4 v9, s[36:39], s27 offen offset:1024 lds
  v_cvt_pk_bf16_f32 v29, v18, v19
  v_mfma_f32_16x16x32_bf16 v[188:191], v[84:87], v[252:255], v[188:191]
  v_cvt_pk_bf16_f32 v30, v20, v21
  v_cvt_pk_bf16_f32 v31, v22, v23
  v_mfma_f32_16x16x32_bf16 v[204:207], v[88:91], v[252:255], v[204:207]
  buffer_store_dwordx4 v[28:31], v2, s[40:43], s64 offen offset:3072 sc1
  v_mfma_f32_16x16x32_bf16 v[220:223], v[92:95], v[252:255], v[220:223]
  s_waitcnt vmcnt(18) lgkmcnt(0)
  v_mfma_f32_16x16x32_bf16 v[96:99], v[32:35], v[224:227], v[96:99]
  s_add_u32 s64, s64, 4096
  v_accvgpr_read_b32 v16, a224
  v_accvgpr_read_b32 v17, a225
  v_mfma_f32_16x16x32_bf16 v[112:115], v[36:39], v[224:227], v[112:115]
  ds_read_b64_tr_b16 v[64:65], v12 offset:40960
  v_accvgpr_read_b32 v18, a226
  v_mfma_f32_16x16x32_bf16 v[128:131], v[40:43], v[224:227], v[128:131]
  s_add_u32 m0, s24, 65536
  ds_read_b64_tr_b16 v[66:67], v12 offset:41984
  v_accvgpr_read_b32 v19, a227
  v_mfma_f32_16x16x32_bf16 v[144:147], v[44:47], v[224:227], v[144:147]
  buffer_load_dwordx4 v3, s[32:35], s26 offen offset:0 sc1 lds
  v_accvgpr_read_b32 v20, a228
  v_mfma_f32_16x16x32_bf16 v[160:163], v[48:51], v[224:227], v[160:163]
  ds_read_b64_tr_b16 v[68:69], v13 offset:40960
  v_accvgpr_read_b32 v21, a229
  v_mfma_f32_16x16x32_bf16 v[176:179], v[52:55], v[224:227], v[176:179]
  ds_read_b64_tr_b16 v[70:71], v13 offset:41984
  v_accvgpr_read_b32 v22, a230
  v_mfma_f32_16x16x32_bf16 v[192:195], v[56:59], v[224:227], v[192:195]
  ds_read_b64_tr_b16 v[72:73], v12 offset:41216
  v_accvgpr_read_b32 v23, a231
  v_mfma_f32_16x16x32_bf16 v[208:211], v[60:63], v[224:227], v[208:211]
  ds_read_b64_tr_b16 v[74:75], v12 offset:42240
  v_mul_f32 v16, s76, v16
  v_mfma_f32_16x16x32_bf16 v[100:103], v[32:35], v[228:231], v[100:103]
  buffer_load_dwordx4 v4, s[32:35], s26 offen offset:1024 sc1 lds
  v_mul_f32 v17, s76, v17
  v_mfma_f32_16x16x32_bf16 v[116:119], v[36:39], v[228:231], v[116:119]
  ds_read_b64_tr_b16 v[76:77], v13 offset:41216
  v_mul_f32 v18, s76, v18
  v_mfma_f32_16x16x32_bf16 v[132:135], v[40:43], v[228:231], v[132:135]
  ds_read_b64_tr_b16 v[78:79], v13 offset:42240
  v_mul_f32 v19, s76, v19
  v_mfma_f32_16x16x32_bf16 v[148:151], v[44:47], v[228:231], v[148:151]
  ds_read_b128 v[240:243], v14 offset:32768
  v_mul_f32 v20, s76, v20
  v_mfma_f32_16x16x32_bf16 v[164:167], v[48:51], v[228:231], v[164:167]
  ds_read_b128 v[244:247], v14 offset:33792
  v_mul_f32 v21, s76, v21
  v_mfma_f32_16x16x32_bf16 v[180:183], v[52:55], v[228:231], v[180:183]
  buffer_load_dwordx4 v5, s[32:35], s26 offen offset:2048 sc1 lds
  v_mul_f32 v22, s76, v22
  v_mfma_f32_16x16x32_bf16 v[196:199], v[56:59], v[228:231], v[196:199]
  ds_read_b64_tr_b16 v[80:81], v12 offset:41472
  v_mul_f32 v23, s76, v23
  v_mfma_f32_16x16x32_bf16 v[212:215], v[60:63], v[228:231], v[212:215]
  ds_read_b64_tr_b16 v[82:83], v12 offset:42496
  v_cvt_pk_bf16_f32 v24, v16, v17
  v_mfma_f32_16x16x32_bf16 v[104:107], v[32:35], v[232:235], v[104:107]
  ds_read_b64_tr_b16 v[84:85], v13 offset:41472
  v_cvt_pk_bf16_f32 v25, v18, v19
  v_mfma_f32_16x16x32_bf16 v[120:123], v[36:39], v[232:235], v[120:123]
  ds_read_b64_tr_b16 v[86:87], v13 offset:42496
  v_cvt_pk_bf16_f32 v26, v20, v21
  v_mfma_f32_16x16x32_bf16 v[136:139], v[40:43], v[232:235], v[136:139]
  buffer_load_dwordx4 v6, s[32:35], s26 offen offset:3072 sc1 lds
  v_cvt_pk_bf16_f32 v27, v22, v23
  v_mfma_f32_16x16x32_bf16 v[152:155], v[44:47], v[232:235], v[152:155]
  s_add_u32 s26, s26, 1024
  ds_read_b64_tr_b16 v[88:89], v12 offset:41728
  buffer_store_dwordx4 v[24:27], v2, s[40:43], s64 offen offset:0 sc1
  v_mfma_f32_16x16x32_bf16 v[168:171], v[48:51], v[232:235], v[168:171]
  ds_read_b64_tr_b16 v[90:91], v12 offset:42752
  v_mfma_f32_16x16x32_bf16 v[184:187], v[52:55], v[232:235], v[184:187]
  ds_read_b64_tr_b16 v[92:93], v13 offset:41728
  v_mfma_f32_16x16x32_bf16 v[200:203], v[56:59], v[232:235], v[200:203]
  s_add_u32 m0, s24, 16384
  ds_read_b64_tr_b16 v[94:95], v13 offset:42752
  v_mfma_f32_16x16x32_bf16 v[216:219], v[60:63], v[232:235], v[216:219]
  buffer_load_dwordx4 v10, s[36:39], s27 offen offset:2048 lds
  v_mfma_f32_16x16x32_bf16 v[108:111], v[32:35], v[236:239], v[108:111]
  ds_read_b128 v[248:251], v14 offset:34816
  v_mfma_f32_16x16x32_bf16 v[124:127], v[36:39], v[236:239], v[124:127]
  ds_read_b128 v[252:255], v14 offset:35840
  v_mfma_f32_16x16x32_bf16 v[140:143], v[40:43], v[236:239], v[140:143]
  v_mfma_f32_16x16x32_bf16 v[156:159], v[44:47], v[236:239], v[156:159]
  v_xor_b32 v14, 0x10000, v14
  v_mfma_f32_16x16x32_bf16 v[172:175], v[48:51], v[236:239], v[172:175]
  buffer_load_dwordx4 v11, s[36:39], s27 offen offset:3072 lds
  v_mfma_f32_16x16x32_bf16 v[188:191], v[52:55], v[236:239], v[188:191]
  s_add_u32 s27, s27, 524288
  v_xor_b32 v12, 0x10000, v12
  v_mfma_f32_16x16x32_bf16 v[204:207], v[56:59], v[236:239], v[204:207]
  v_xor_b32 v13, 0x10000, v13
  v_mfma_f32_16x16x32_bf16 v[220:223], v[60:63], v[236:239], v[220:223]
  s_waitcnt vmcnt(16) lgkmcnt(0)
  v_mfma_f32_16x16x32_bf16 v[96:99], v[64:67], v[240:243], v[96:99]
  s_barrier
  v_accvgpr_read_b32 v16, a232
  v_accvgpr_read_b32 v17, a233
  v_mfma_f32_16x16x32_bf16 v[112:115], v[68:71], v[240:243], v[112:115]
  ds_read_b64_tr_b16 v[32:33], v12 offset:0
  v_accvgpr_read_b32 v18, a234
  v_mfma_f32_16x16x32_bf16 v[128:131], v[72:75], v[240:243], v[128:131]
  s_add_u32 m0, s24, 98304
  ds_read_b64_tr_b16 v[34:35], v12 offset:1024
  v_accvgpr_read_b32 v19, a235
  v_mfma_f32_16x16x32_bf16 v[144:147], v[76:79], v[240:243], v[144:147]
  buffer_load_dwordx4 v3, s[32:35], s26 offen offset:0 sc1 lds
  v_accvgpr_read_b32 v20, a236
  v_mfma_f32_16x16x32_bf16 v[160:163], v[80:83], v[240:243], v[160:163]
  ds_read_b64_tr_b16 v[36:37], v13 offset:0
  v_accvgpr_read_b32 v21, a237
  v_mfma_f32_16x16x32_bf16 v[176:179], v[84:87], v[240:243], v[176:179]
  ds_read_b64_tr_b16 v[38:39], v13 offset:1024
  v_accvgpr_read_b32 v22, a238
  v_mfma_f32_16x16x32_bf16 v[192:195], v[88:91], v[240:243], v[192:195]
  ds_read_b64_tr_b16 v[40:41], v12 offset:256
  v_accvgpr_read_b32 v23, a239
  v_mfma_f32_16x16x32_bf16 v[208:211], v[92:95], v[240:243], v[208:211]
  ds_read_b64_tr_b16 v[42:43], v12 offset:1280
  v_mul_f32 v16, s76, v16
  v_mfma_f32_16x16x32_bf16 v[100:103], v[64:67], v[244:247], v[100:103]
  buffer_load_dwordx4 v4, s[32:35], s26 offen offset:1024 sc1 lds
  v_mul_f32 v17, s76, v17
  v_mfma_f32_16x16x32_bf16 v[116:119], v[68:71], v[244:247], v[116:119]
  ds_read_b64_tr_b16 v[44:45], v13 offset:256
  v_mul_f32 v18, s76, v18
  v_mfma_f32_16x16x32_bf16 v[132:135], v[72:75], v[244:247], v[132:135]
  ds_read_b64_tr_b16 v[46:47], v13 offset:1280
  v_mul_f32 v19, s76, v19
  v_mfma_f32_16x16x32_bf16 v[148:151], v[76:79], v[244:247], v[148:151]
  ds_read_b128 v[224:227], v14 offset:0
  v_mul_f32 v20, s76, v20
  v_mfma_f32_16x16x32_bf16 v[164:167], v[80:83], v[244:247], v[164:167]
  ds_read_b128 v[228:231], v14 offset:1024
  v_mul_f32 v21, s76, v21
  v_mfma_f32_16x16x32_bf16 v[180:183], v[84:87], v[244:247], v[180:183]
  buffer_load_dwordx4 v5, s[32:35], s26 offen offset:2048 sc1 lds
  v_mul_f32 v22, s76, v22
  v_mfma_f32_16x16x32_bf16 v[196:199], v[88:91], v[244:247], v[196:199]
  ds_read_b64_tr_b16 v[48:49], v12 offset:512
  v_mul_f32 v23, s76, v23
  v_mfma_f32_16x16x32_bf16 v[212:215], v[92:95], v[244:247], v[212:215]
  ds_read_b64_tr_b16 v[50:51], v12 offset:1536
  v_cvt_pk_bf16_f32 v28, v16, v17
  v_mfma_f32_16x16x32_bf16 v[104:107], v[64:67], v[248:251], v[104:107]
  ds_read_b64_tr_b16 v[52:53], v13 offset:512
  v_cvt_pk_bf16_f32 v29, v18, v19
  v_mfma_f32_16x16x32_bf16 v[120:123], v[68:71], v[248:251], v[120:123]
  ds_read_b64_tr_b16 v[54:55], v13 offset:1536
  v_cvt_pk_bf16_f32 v30, v20, v21
  v_mfma_f32_16x16x32_bf16 v[136:139], v[72:75], v[248:251], v[136:139]
  buffer_load_dwordx4 v6, s[32:35], s26 offen offset:3072 sc1 lds
  v_cvt_pk_bf16_f32 v31, v22, v23
  v_mfma_f32_16x16x32_bf16 v[152:155], v[76:79], v[248:251], v[152:155]
  s_add_u32 s26, s26, 1024
  ds_read_b64_tr_b16 v[56:57], v12 offset:768
  buffer_store_dwordx4 v[28:31], v2, s[40:43], s64 offen offset:1024 sc1
  v_mfma_f32_16x16x32_bf16 v[168:171], v[80:83], v[248:251], v[168:171]
  ds_read_b64_tr_b16 v[58:59], v12 offset:1792
  v_mfma_f32_16x16x32_bf16 v[184:187], v[84:87], v[248:251], v[184:187]
  ds_read_b64_tr_b16 v[60:61], v13 offset:768
  v_mfma_f32_16x16x32_bf16 v[200:203], v[88:91], v[248:251], v[200:203]
  s_add_u32 m0, s24, 49152
  ds_read_b64_tr_b16 v[62:63], v13 offset:1792
  v_mfma_f32_16x16x32_bf16 v[216:219], v[92:95], v[248:251], v[216:219]
  buffer_load_dwordx4 v8, s[36:39], s27 offen offset:0 lds
  v_mfma_f32_16x16x32_bf16 v[108:111], v[64:67], v[252:255], v[108:111]
  ds_read_b128 v[232:235], v14 offset:2048
  v_mfma_f32_16x16x32_bf16 v[124:127], v[68:71], v[252:255], v[124:127]
  ds_read_b128 v[236:239], v14 offset:3072
  v_mfma_f32_16x16x32_bf16 v[140:143], v[72:75], v[252:255], v[140:143]
  v_mfma_f32_16x16x32_bf16 v[156:159], v[76:79], v[252:255], v[156:159]
  v_mfma_f32_16x16x32_bf16 v[172:175], v[80:83], v[252:255], v[172:175]
  buffer_load_dwordx4 v9, s[36:39], s27 offen offset:1024 lds
  v_mfma_f32_16x16x32_bf16 v[188:191], v[84:87], v[252:255], v[188:191]
  v_mfma_f32_16x16x32_bf16 v[204:207], v[88:91], v[252:255], v[204:207]
  v_mfma_f32_16x16x32_bf16 v[220:223], v[92:95], v[252:255], v[220:223]
  s_waitcnt vmcnt(17) lgkmcnt(0)
  v_mfma_f32_16x16x32_bf16 v[96:99], v[32:35], v[224:227], v[96:99]
  v_accvgpr_read_b32 v16, a240
  v_accvgpr_read_b32 v17, a241
  v_mfma_f32_16x16x32_bf16 v[112:115], v[36:39], v[224:227], v[112:115]
  ds_read_b64_tr_b16 v[64:65], v12 offset:8192
  v_accvgpr_read_b32 v18, a242
  v_mfma_f32_16x16x32_bf16 v[128:131], v[40:43], v[224:227], v[128:131]
  s_add_u32 m0, s24, 0
  ds_read_b64_tr_b16 v[66:67], v12 offset:9216
  v_accvgpr_read_b32 v19, a243
  v_mfma_f32_16x16x32_bf16 v[144:147], v[44:47], v[224:227], v[144:147]
  buffer_load_dwordx4 v3, s[32:35], s26 offen offset:0 sc1 lds
  v_accvgpr_read_b32 v20, a244
  v_mfma_f32_16x16x32_bf16 v[160:163], v[48:51], v[224:227], v[160:163]
  ds_read_b64_tr_b16 v[68:69], v13 offset:8192
  v_accvgpr_read_b32 v21, a245
  v_mfma_f32_16x16x32_bf16 v[176:179], v[52:55], v[224:227], v[176:179]
  ds_read_b64_tr_b16 v[70:71], v13 offset:9216
  v_accvgpr_read_b32 v22, a246
  v_mfma_f32_16x16x32_bf16 v[192:195], v[56:59], v[224:227], v[192:195]
  ds_read_b64_tr_b16 v[72:73], v12 offset:8448
  v_accvgpr_read_b32 v23, a247
  v_mfma_f32_16x16x32_bf16 v[208:211], v[60:63], v[224:227], v[208:211]
  ds_read_b64_tr_b16 v[74:75], v12 offset:9472
  v_mul_f32 v16, s76, v16
  v_mfma_f32_16x16x32_bf16 v[100:103], v[32:35], v[228:231], v[100:103]
  buffer_load_dwordx4 v4, s[32:35], s26 offen offset:1024 sc1 lds
  v_mul_f32 v17, s76, v17
  v_mfma_f32_16x16x32_bf16 v[116:119], v[36:39], v[228:231], v[116:119]
  ds_read_b64_tr_b16 v[76:77], v13 offset:8448
  v_mul_f32 v18, s76, v18
  v_mfma_f32_16x16x32_bf16 v[132:135], v[40:43], v[228:231], v[132:135]
  ds_read_b64_tr_b16 v[78:79], v13 offset:9472
  v_mul_f32 v19, s76, v19
  v_mfma_f32_16x16x32_bf16 v[148:151], v[44:47], v[228:231], v[148:151]
  ds_read_b128 v[240:243], v14 offset:32768
  v_mul_f32 v20, s76, v20
  v_mfma_f32_16x16x32_bf16 v[164:167], v[48:51], v[228:231], v[164:167]
  ds_read_b128 v[244:247], v14 offset:33792
  v_mul_f32 v21, s76, v21
  v_mfma_f32_16x16x32_bf16 v[180:183], v[52:55], v[228:231], v[180:183]
  buffer_load_dwordx4 v5, s[32:35], s26 offen offset:2048 sc1 lds
  v_mul_f32 v22, s76, v22
  v_mfma_f32_16x16x32_bf16 v[196:199], v[56:59], v[228:231], v[196:199]
  ds_read_b64_tr_b16 v[80:81], v12 offset:8704
  v_mul_f32 v23, s76, v23
  v_mfma_f32_16x16x32_bf16 v[212:215], v[60:63], v[228:231], v[212:215]
  ds_read_b64_tr_b16 v[82:83], v12 offset:9728
  v_cvt_pk_bf16_f32 v24, v16, v17
  v_mfma_f32_16x16x32_bf16 v[104:107], v[32:35], v[232:235], v[104:107]
  ds_read_b64_tr_b16 v[84:85], v13 offset:8704
  v_cvt_pk_bf16_f32 v25, v18, v19
  v_mfma_f32_16x16x32_bf16 v[120:123], v[36:39], v[232:235], v[120:123]
  ds_read_b64_tr_b16 v[86:87], v13 offset:9728
  v_cvt_pk_bf16_f32 v26, v20, v21
  v_mfma_f32_16x16x32_bf16 v[136:139], v[40:43], v[232:235], v[136:139]
  buffer_load_dwordx4 v6, s[32:35], s26 offen offset:3072 sc1 lds
  v_cvt_pk_bf16_f32 v27, v22, v23
  v_mfma_f32_16x16x32_bf16 v[152:155], v[44:47], v[232:235], v[152:155]
  s_add_u32 s26, s26, 1024
  ds_read_b64_tr_b16 v[88:89], v12 offset:8960
  buffer_store_dwordx4 v[24:27], v2, s[40:43], s64 offen offset:2048 sc1
  v_mfma_f32_16x16x32_bf16 v[168:171], v[48:51], v[232:235], v[168:171]
  ds_read_b64_tr_b16 v[90:91], v12 offset:9984
  v_mfma_f32_16x16x32_bf16 v[184:187], v[52:55], v[232:235], v[184:187]
  ds_read_b64_tr_b16 v[92:93], v13 offset:8960
  v_mfma_f32_16x16x32_bf16 v[200:203], v[56:59], v[232:235], v[200:203]
  s_add_u32 m0, s24, 49152
  ds_read_b64_tr_b16 v[94:95], v13 offset:9984
  v_mfma_f32_16x16x32_bf16 v[216:219], v[60:63], v[232:235], v[216:219]
  buffer_load_dwordx4 v10, s[36:39], s27 offen offset:2048 lds
  v_mfma_f32_16x16x32_bf16 v[108:111], v[32:35], v[236:239], v[108:111]
  ds_read_b128 v[248:251], v14 offset:34816
  v_mfma_f32_16x16x32_bf16 v[124:127], v[36:39], v[236:239], v[124:127]
  ds_read_b128 v[252:255], v14 offset:35840
  v_mfma_f32_16x16x32_bf16 v[140:143], v[40:43], v[236:239], v[140:143]
  v_mfma_f32_16x16x32_bf16 v[156:159], v[44:47], v[236:239], v[156:159]
  v_xor_b32 v14, 0x10000, v14
  v_mfma_f32_16x16x32_bf16 v[172:175], v[48:51], v[236:239], v[172:175]
  buffer_load_dwordx4 v11, s[36:39], s27 offen offset:3072 lds
  v_mfma_f32_16x16x32_bf16 v[188:191], v[52:55], v[236:239], v[188:191]
  s_add_u32 s27, s27, 524288
  v_mfma_f32_16x16x32_bf16 v[204:207], v[56:59], v[236:239], v[204:207]
  v_mfma_f32_16x16x32_bf16 v[220:223], v[60:63], v[236:239], v[220:223]
  s_waitcnt vmcnt(17) lgkmcnt(0)
  v_mfma_f32_16x16x32_bf16 v[96:99], v[64:67], v[240:243], v[96:99]
  s_barrier
  v_accvgpr_read_b32 v16, a248
  v_accvgpr_read_b32 v17, a249
  v_mfma_f32_16x16x32_bf16 v[112:115], v[68:71], v[240:243], v[112:115]
  ds_read_b64_tr_b16 v[32:33], v12 offset:32768
  v_accvgpr_read_b32 v18, a250
  v_mfma_f32_16x16x32_bf16 v[128:131], v[72:75], v[240:243], v[128:131]
  s_add_u32 m0, s24, 32768
  ds_read_b64_tr_b16 v[34:35], v12 offset:33792
  v_accvgpr_read_b32 v19, a251
  v_mfma_f32_16x16x32_bf16 v[144:147], v[76:79], v[240:243], v[144:147]
  buffer_load_dwordx4 v3, s[32:35], s26 offen offset:0 sc1 lds
  v_accvgpr_read_b32 v20, a252
  v_mfma_f32_16x16x32_bf16 v[160:163], v[80:83], v[240:243], v[160:163]
  ds_read_b64_tr_b16 v[36:37], v13 offset:32768
  v_accvgpr_read_b32 v21, a253
  v_mfma_f32_16x16x32_bf16 v[176:179], v[84:87], v[240:243], v[176:179]
  ds_read_b64_tr_b16 v[38:39], v13 offset:33792
  v_accvgpr_read_b32 v22, a254
  v_mfma_f32_16x16x32_bf16 v[192:195], v[88:91], v[240:243], v[192:195]
  ds_read_b64_tr_b16 v[40:41], v12 offset:33024
  v_accvgpr_read_b32 v23, a255
  v_mfma_f32_16x16x32_bf16 v[208:211], v[92:95], v[240:243], v[208:211]
  ds_read_b64_tr_b16 v[42:43], v12 offset:34048
  v_mul_f32 v16, s76, v16
  v_mfma_f32_16x16x32_bf16 v[100:103], v[64:67], v[244:247], v[100:103]
  buffer_load_dwordx4 v4, s[32:35], s26 offen offset:1024 sc1 lds
  v_mul_f32 v17, s76, v17
  v_mfma_f32_16x16x32_bf16 v[116:119], v[68:71], v[244:247], v[116:119]
  ds_read_b64_tr_b16 v[44:45], v13 offset:33024
  v_mul_f32 v18, s76, v18
  v_mfma_f32_16x16x32_bf16 v[132:135], v[72:75], v[244:247], v[132:135]
  ds_read_b64_tr_b16 v[46:47], v13 offset:34048
  v_mul_f32 v19, s76, v19
  v_mfma_f32_16x16x32_bf16 v[148:151], v[76:79], v[244:247], v[148:151]
  ds_read_b128 v[224:227], v14 offset:0
  v_mul_f32 v20, s76, v20
  v_mfma_f32_16x16x32_bf16 v[164:167], v[80:83], v[244:247], v[164:167]
  ds_read_b128 v[228:231], v14 offset:1024
  v_mul_f32 v21, s76, v21
  v_mfma_f32_16x16x32_bf16 v[180:183], v[84:87], v[244:247], v[180:183]
  buffer_load_dwordx4 v5, s[32:35], s26 offen offset:2048 sc1 lds
  v_mul_f32 v22, s76, v22
  v_mfma_f32_16x16x32_bf16 v[196:199], v[88:91], v[244:247], v[196:199]
  ds_read_b64_tr_b16 v[48:49], v12 offset:33280
  v_mul_f32 v23, s76, v23
  v_mfma_f32_16x16x32_bf16 v[212:215], v[92:95], v[244:247], v[212:215]
  ds_read_b64_tr_b16 v[50:51], v12 offset:34304
  v_cvt_pk_bf16_f32 v28, v16, v17
  v_mfma_f32_16x16x32_bf16 v[104:107], v[64:67], v[248:251], v[104:107]
  ds_read_b64_tr_b16 v[52:53], v13 offset:33280
  v_cvt_pk_bf16_f32 v29, v18, v19
  v_mfma_f32_16x16x32_bf16 v[120:123], v[68:71], v[248:251], v[120:123]
  ds_read_b64_tr_b16 v[54:55], v13 offset:34304
  v_cvt_pk_bf16_f32 v30, v20, v21
  v_mfma_f32_16x16x32_bf16 v[136:139], v[72:75], v[248:251], v[136:139]
  buffer_load_dwordx4 v6, s[32:35], s26 offen offset:3072 sc1 lds
  v_cvt_pk_bf16_f32 v31, v22, v23
  v_mfma_f32_16x16x32_bf16 v[152:155], v[76:79], v[248:251], v[152:155]
  s_add_u32 s26, s26, 1024
  ds_read_b64_tr_b16 v[56:57], v12 offset:33536
  buffer_store_dwordx4 v[28:31], v2, s[40:43], s64 offen offset:3072 sc1
  v_mfma_f32_16x16x32_bf16 v[168:171], v[80:83], v[248:251], v[168:171]
  ds_read_b64_tr_b16 v[58:59], v12 offset:34560
  v_mfma_f32_16x16x32_bf16 v[184:187], v[84:87], v[248:251], v[184:187]
  ds_read_b64_tr_b16 v[60:61], v13 offset:33536
  v_mfma_f32_16x16x32_bf16 v[200:203], v[88:91], v[248:251], v[200:203]
  s_add_u32 m0, s24, 81920
  ds_read_b64_tr_b16 v[62:63], v13 offset:34560
  v_mfma_f32_16x16x32_bf16 v[216:219], v[92:95], v[248:251], v[216:219]
  buffer_load_dwordx4 v8, s[36:39], s27 offen offset:0 lds
  v_mfma_f32_16x16x32_bf16 v[108:111], v[64:67], v[252:255], v[108:111]
  ds_read_b128 v[232:235], v14 offset:2048
  v_mfma_f32_16x16x32_bf16 v[124:127], v[68:71], v[252:255], v[124:127]
  ds_read_b128 v[236:239], v14 offset:3072
  v_mfma_f32_16x16x32_bf16 v[140:143], v[72:75], v[252:255], v[140:143]
  v_mfma_f32_16x16x32_bf16 v[156:159], v[76:79], v[252:255], v[156:159]
  v_mfma_f32_16x16x32_bf16 v[172:175], v[80:83], v[252:255], v[172:175]
  buffer_load_dwordx4 v9, s[36:39], s27 offen offset:1024 lds
  v_mfma_f32_16x16x32_bf16 v[188:191], v[84:87], v[252:255], v[188:191]
  v_mfma_f32_16x16x32_bf16 v[204:207], v[88:91], v[252:255], v[204:207]
  v_mfma_f32_16x16x32_bf16 v[220:223], v[92:95], v[252:255], v[220:223]
  s_waitcnt vmcnt(17) lgkmcnt(0)
  v_mfma_f32_16x16x32_bf16 v[96:99], v[32:35], v[224:227], v[96:99]
  s_add_u32 s64, s64, 126976
  v_accvgpr_read_b32 v16, a0
  v_accvgpr_read_b32 v17, a1
  v_mfma_f32_16x16x32_bf16 v[112:115], v[36:39], v[224:227], v[112:115]
  ds_read_b64_tr_b16 v[64:65], v12 offset:40960
  v_accvgpr_read_b32 v18, a2
  v_mfma_f32_16x16x32_bf16 v[128:131], v[40:43], v[224:227], v[128:131]
  s_add_u32 m0, s24, 65536
  ds_read_b64_tr_b16 v[66:67], v12 offset:41984
  v_accvgpr_read_b32 v19, a3
  v_mfma_f32_16x16x32_bf16 v[144:147], v[44:47], v[224:227], v[144:147]
  buffer_load_dwordx4 v3, s[32:35], s26 offen offset:0 sc1 lds
  v_accvgpr_read_b32 v20, a4
  v_mfma_f32_16x16x32_bf16 v[160:163], v[48:51], v[224:227], v[160:163]
  ds_read_b64_tr_b16 v[68:69], v13 offset:40960
  v_accvgpr_read_b32 v21, a5
  v_mfma_f32_16x16x32_bf16 v[176:179], v[52:55], v[224:227], v[176:179]
  ds_read_b64_tr_b16 v[70:71], v13 offset:41984
  v_accvgpr_read_b32 v22, a6
  v_mfma_f32_16x16x32_bf16 v[192:195], v[56:59], v[224:227], v[192:195]
  ds_read_b64_tr_b16 v[72:73], v12 offset:41216
  v_accvgpr_read_b32 v23, a7
  v_mfma_f32_16x16x32_bf16 v[208:211], v[60:63], v[224:227], v[208:211]
  ds_read_b64_tr_b16 v[74:75], v12 offset:42240
  v_mul_f32 v16, s76, v16
  v_mfma_f32_16x16x32_bf16 v[100:103], v[32:35], v[228:231], v[100:103]
  buffer_load_dwordx4 v4, s[32:35], s26 offen offset:1024 sc1 lds
  v_mul_f32 v17, s76, v17
  v_mfma_f32_16x16x32_bf16 v[116:119], v[36:39], v[228:231], v[116:119]
  ds_read_b64_tr_b16 v[76:77], v13 offset:41216
  v_mul_f32 v18, s76, v18
  v_mfma_f32_16x16x32_bf16 v[132:135], v[40:43], v[228:231], v[132:135]
  ds_read_b64_tr_b16 v[78:79], v13 offset:42240
  v_mul_f32 v19, s76, v19
  v_mfma_f32_16x16x32_bf16 v[148:151], v[44:47], v[228:231], v[148:151]
  ds_read_b128 v[240:243], v14 offset:32768
  v_mul_f32 v20, s76, v20
  v_mfma_f32_16x16x32_bf16 v[164:167], v[48:51], v[228:231], v[164:167]
  ds_read_b128 v[244:247], v14 offset:33792
  v_mul_f32 v21, s76, v21
  v_mfma_f32_16x16x32_bf16 v[180:183], v[52:55], v[228:231], v[180:183]
  buffer_load_dwordx4 v5, s[32:35], s26 offen offset:2048 sc1 lds
  v_mul_f32 v22, s76, v22
  v_mfma_f32_16x16x32_bf16 v[196:199], v[56:59], v[228:231], v[196:199]
  ds_read_b64_tr_b16 v[80:81], v12 offset:41472
  v_mul_f32 v23, s76, v23
  v_mfma_f32_16x16x32_bf16 v[212:215], v[60:63], v[228:231], v[212:215]
  ds_read_b64_tr_b16 v[82:83], v12 offset:42496
  v_cvt_pk_bf16_f32 v24, v16, v17
  v_mfma_f32_16x16x32_bf16 v[104:107], v[32:35], v[232:235], v[104:107]
  ds_read_b64_tr_b16 v[84:85], v13 offset:41472
  v_cvt_pk_bf16_f32 v25, v18, v19
  v_mfma_f32_16x16x32_bf16 v[120:123], v[36:39], v[232:235], v[120:123]
  ds_read_b64_tr_b16 v[86:87], v13 offset:42496
  v_cvt_pk_bf16_f32 v26, v20, v21
  v_mfma_f32_16x16x32_bf16 v[136:139], v[40:43], v[232:235], v[136:139]
  buffer_load_dwordx4 v6, s[32:35], s26 offen offset:3072 sc1 lds
  v_cvt_pk_bf16_f32 v27, v22, v23
  v_mfma_f32_16x16x32_bf16 v[152:155], v[44:47], v[232:235], v[152:155]
  s_add_u32 s26, s26, 1024
  ds_read_b64_tr_b16 v[88:89], v12 offset:41728
  buffer_store_dwordx4 v[24:27], v2, s[40:43], s64 offen offset:0 sc1
  v_mfma_f32_16x16x32_bf16 v[168:171], v[48:51], v[232:235], v[168:171]
  ds_read_b64_tr_b16 v[90:91], v12 offset:42752
  v_mfma_f32_16x16x32_bf16 v[184:187], v[52:55], v[232:235], v[184:187]
  ds_read_b64_tr_b16 v[92:93], v13 offset:41728
  v_mfma_f32_16x16x32_bf16 v[200:203], v[56:59], v[232:235], v[200:203]
  s_add_u32 m0, s24, 81920
  ds_read_b64_tr_b16 v[94:95], v13 offset:42752
  v_mfma_f32_16x16x32_bf16 v[216:219], v[60:63], v[232:235], v[216:219]
  buffer_load_dwordx4 v10, s[36:39], s27 offen offset:2048 lds
  v_mfma_f32_16x16x32_bf16 v[108:111], v[32:35], v[236:239], v[108:111]
  ds_read_b128 v[248:251], v14 offset:34816
  v_mfma_f32_16x16x32_bf16 v[124:127], v[36:39], v[236:239], v[124:127]
  ds_read_b128 v[252:255], v14 offset:35840
  v_mfma_f32_16x16x32_bf16 v[140:143], v[40:43], v[236:239], v[140:143]
  v_mfma_f32_16x16x32_bf16 v[156:159], v[44:47], v[236:239], v[156:159]
  v_xor_b32 v14, 0x10000, v14
  v_mfma_f32_16x16x32_bf16 v[172:175], v[48:51], v[236:239], v[172:175]
  buffer_load_dwordx4 v11, s[36:39], s27 offen offset:3072 lds
  v_mfma_f32_16x16x32_bf16 v[188:191], v[52:55], v[236:239], v[188:191]
  s_add_u32 s27, s27, 524288
  v_xor_b32 v12, 0x10000, v12
  v_mfma_f32_16x16x32_bf16 v[204:207], v[56:59], v[236:239], v[204:207]
  v_xor_b32 v13, 0x10000, v13
  v_mfma_f32_16x16x32_bf16 v[220:223], v[60:63], v[236:239], v[220:223]
  s_waitcnt vmcnt(9) lgkmcnt(0)
  v_mfma_f32_16x16x32_bf16 v[96:99], v[64:67], v[240:243], v[96:99]
  s_barrier
  buffer_store_dword v12, off, s[40:43], s65 sc1
  v_accvgpr_read_b32 v16, a8
  v_mfma_f32_16x16x32_bf16 v[112:115], v[68:71], v[240:243], v[112:115]
  ds_read_b64_tr_b16 v[32:33], v12 offset:0
  v_accvgpr_read_b32 v17, a9
  v_mfma_f32_16x16x32_bf16 v[128:131], v[72:75], v[240:243], v[128:131]
  s_add_u32 m0, s24, 98304
  ds_read_b64_tr_b16 v[34:35], v12 offset:1024
  v_accvgpr_read_b32 v18, a10
  v_mfma_f32_16x16x32_bf16 v[144:147], v[76:79], v[240:243], v[144:147]
  buffer_load_dwordx4 v3, s[32:35], s26 offen offset:0 sc1 lds
  v_accvgpr_read_b32 v19, a11
  v_mfma_f32_16x16x32_bf16 v[160:163], v[80:83], v[240:243], v[160:163]
  ds_read_b64_tr_b16 v[36:37], v13 offset:0
  v_accvgpr_read_b32 v20, a12
  v_mfma_f32_16x16x32_bf16 v[176:179], v[84:87], v[240:243], v[176:179]
  ds_read_b64_tr_b16 v[38:39], v13 offset:1024
  v_accvgpr_read_b32 v21, a13
  v_mfma_f32_16x16x32_bf16 v[192:195], v[88:91], v[240:243], v[192:195]
  ds_read_b64_tr_b16 v[40:41], v12 offset:256
  v_accvgpr_read_b32 v22, a14
  v_mfma_f32_16x16x32_bf16 v[208:211], v[92:95], v[240:243], v[208:211]
  ds_read_b64_tr_b16 v[42:43], v12 offset:1280
  v_accvgpr_read_b32 v23, a15
  v_mfma_f32_16x16x32_bf16 v[100:103], v[64:67], v[244:247], v[100:103]
  buffer_load_dwordx4 v4, s[32:35], s26 offen offset:1024 sc1 lds
  v_mul_f32 v16, s76, v16
  v_mfma_f32_16x16x32_bf16 v[116:119], v[68:71], v[244:247], v[116:119]
  ds_read_b64_tr_b16 v[44:45], v13 offset:256
  v_mul_f32 v17, s76, v17
  v_mfma_f32_16x16x32_bf16 v[132:135], v[72:75], v[244:247], v[132:135]
  ds_read_b64_tr_b16 v[46:47], v13 offset:1280
  v_mul_f32 v18, s76, v18
  v_mfma_f32_16x16x32_bf16 v[148:151], v[76:79], v[244:247], v[148:151]
  ds_read_b128 v[224:227], v14 offset:0
  v_mul_f32 v19, s76, v19
  v_mfma_f32_16x16x32_bf16 v[164:167], v[80:83], v[244:247], v[164:167]
  ds_read_b128 v[228:231], v14 offset:1024
  v_mul_f32 v20, s76, v20
  v_mfma_f32_16x16x32_bf16 v[180:183], v[84:87], v[244:247], v[180:183]
  buffer_load_dwordx4 v5, s[32:35], s26 offen offset:2048 sc1 lds
  v_mul_f32 v21, s76, v21
  v_mfma_f32_16x16x32_bf16 v[196:199], v[88:91], v[244:247], v[196:199]
  ds_read_b64_tr_b16 v[48:49], v12 offset:512
  v_mul_f32 v22, s76, v22
  v_mfma_f32_16x16x32_bf16 v[212:215], v[92:95], v[244:247], v[212:215]
  ds_read_b64_tr_b16 v[50:51], v12 offset:1536
  v_mul_f32 v23, s76, v23
  v_mfma_f32_16x16x32_bf16 v[104:107], v[64:67], v[248:251], v[104:107]
  ds_read_b64_tr_b16 v[52:53], v13 offset:512
  v_cvt_pk_bf16_f32 v28, v16, v17
  v_mfma_f32_16x16x32_bf16 v[120:123], v[68:71], v[248:251], v[120:123]
  ds_read_b64_tr_b16 v[54:55], v13 offset:1536
  v_cvt_pk_bf16_f32 v29, v18, v19
  v_mfma_f32_16x16x32_bf16 v[136:139], v[72:75], v[248:251], v[136:139]
  buffer_load_dwordx4 v6, s[32:35], s26 offen offset:3072 sc1 lds
  v_cvt_pk_bf16_f32 v30, v20, v21
  v_mfma_f32_16x16x32_bf16 v[152:155], v[76:79], v[248:251], v[152:155]
  s_add_u32 s26, s26, 1024
  ds_read_b64_tr_b16 v[56:57], v12 offset:768
  v_cvt_pk_bf16_f32 v31, v22, v23
  v_mfma_f32_16x16x32_bf16 v[168:171], v[80:83], v[248:251], v[168:171]
  ds_read_b64_tr_b16 v[58:59], v12 offset:1792
  buffer_store_dwordx4 v[28:31], v2, s[40:43], s64 offen offset:1024 sc1
  v_mfma_f32_16x16x32_bf16 v[184:187], v[84:87], v[248:251], v[184:187]
  ds_read_b64_tr_b16 v[60:61], v13 offset:768
  v_mfma_f32_16x16x32_bf16 v[200:203], v[88:91], v[248:251], v[200:203]
  s_add_u32 m0, s24, 114688
  ds_read_b64_tr_b16 v[62:63], v13 offset:1792
  v_mfma_f32_16x16x32_bf16 v[216:219], v[92:95], v[248:251], v[216:219]
  buffer_load_dwordx4 v8, s[36:39], s27 offen offset:0 lds
  v_mfma_f32_16x16x32_bf16 v[108:111], v[64:67], v[252:255], v[108:111]
  ds_read_b128 v[232:235], v14 offset:2048
  v_mfma_f32_16x16x32_bf16 v[124:127], v[68:71], v[252:255], v[124:127]
  ds_read_b128 v[236:239], v14 offset:3072
  v_mfma_f32_16x16x32_bf16 v[140:143], v[72:75], v[252:255], v[140:143]
  v_mfma_f32_16x16x32_bf16 v[156:159], v[76:79], v[252:255], v[156:159]
  v_mfma_f32_16x16x32_bf16 v[172:175], v[80:83], v[252:255], v[172:175]
  buffer_load_dwordx4 v9, s[36:39], s27 offen offset:1024 lds
  v_mfma_f32_16x16x32_bf16 v[188:191], v[84:87], v[252:255], v[188:191]
  v_mfma_f32_16x16x32_bf16 v[204:207], v[88:91], v[252:255], v[204:207]
  v_mfma_f32_16x16x32_bf16 v[220:223], v[92:95], v[252:255], v[220:223]
  s_waitcnt vmcnt(18) lgkmcnt(0)
  v_mfma_f32_16x16x32_bf16 v[96:99], v[32:35], v[224:227], v[96:99]
  v_accvgpr_read_b32 v16, a16
  v_accvgpr_read_b32 v17, a17
  v_mfma_f32_16x16x32_bf16 v[112:115], v[36:39], v[224:227], v[112:115]
  ds_read_b64_tr_b16 v[64:65], v12 offset:8192
  v_accvgpr_read_b32 v18, a18
  v_mfma_f32_16x16x32_bf16 v[128:131], v[40:43], v[224:227], v[128:131]
  s_add_u32 m0, s24, 0
  ds_read_b64_tr_b16 v[66:67], v12 offset:9216
  v_accvgpr_read_b32 v19, a19
  v_mfma_f32_16x16x32_bf16 v[144:147], v[44:47], v[224:227], v[144:147]
  buffer_load_dwordx4 v3, s[32:35], s26 offen offset:0 sc1 lds
  v_accvgpr_read_b32 v20, a20
  v_mfma_f32_16x16x32_bf16 v[160:163], v[48:51], v[224:227], v[160:163]
  ds_read_b64_tr_b16 v[68:69], v13 offset:8192
  v_accvgpr_read_b32 v21, a21
  v_mfma_f32_16x16x32_bf16 v[176:179], v[52:55], v[224:227], v[176:179]
  ds_read_b64_tr_b16 v[70:71], v13 offset:9216
  v_accvgpr_read_b32 v22, a22
  v_mfma_f32_16x16x32_bf16 v[192:195], v[56:59], v[224:227], v[192:195]
  ds_read_b64_tr_b16 v[72:73], v12 offset:8448
  v_accvgpr_read_b32 v23, a23
  v_mfma_f32_16x16x32_bf16 v[208:211], v[60:63], v[224:227], v[208:211]
  ds_read_b64_tr_b16 v[74:75], v12 offset:9472
  v_mul_f32 v16, s76, v16
  v_mfma_f32_16x16x32_bf16 v[100:103], v[32:35], v[228:231], v[100:103]
  buffer_load_dwordx4 v4, s[32:35], s26 offen offset:1024 sc1 lds
  v_mul_f32 v17, s76, v17
  v_mfma_f32_16x16x32_bf16 v[116:119], v[36:39], v[228:231], v[116:119]
  ds_read_b64_tr_b16 v[76:77], v13 offset:8448
  v_mul_f32 v18, s76, v18
  v_mfma_f32_16x16x32_bf16 v[132:135], v[40:43], v[228:231], v[132:135]
  ds_read_b64_tr_b16 v[78:79], v13 offset:9472
  v_mul_f32 v19, s76, v19
  v_mfma_f32_16x16x32_bf16 v[148:151], v[44:47], v[228:231], v[148:151]
  ds_read_b128 v[240:243], v14 offset:32768
  v_mul_f32 v20, s76, v20
  v_mfma_f32_16x16x32_bf16 v[164:167], v[48:51], v[228:231], v[164:167]
  ds_read_b128 v[244:247], v14 offset:33792
  v_mul_f32 v21, s76, v21
  v_mfma_f32_16x16x32_bf16 v[180:183], v[52:55], v[228:231], v[180:183]
  buffer_load_dwordx4 v5, s[32:35], s26 offen offset:2048 sc1 lds
  v_mul_f32 v22, s76, v22
  v_mfma_f32_16x16x32_bf16 v[196:199], v[56:59], v[228:231], v[196:199]
  ds_read_b64_tr_b16 v[80:81], v12 offset:8704
  v_mul_f32 v23, s76, v23
  v_mfma_f32_16x16x32_bf16 v[212:215], v[60:63], v[228:231], v[212:215]
  ds_read_b64_tr_b16 v[82:83], v12 offset:9728
  v_cvt_pk_bf16_f32 v24, v16, v17
  v_mfma_f32_16x16x32_bf16 v[104:107], v[32:35], v[232:235], v[104:107]
  ds_read_b64_tr_b16 v[84:85], v13 offset:8704
  v_cvt_pk_bf16_f32 v25, v18, v19
  v_mfma_f32_16x16x32_bf16 v[120:123], v[36:39], v[232:235], v[120:123]
  ds_read_b64_tr_b16 v[86:87], v13 offset:9728
  v_cvt_pk_bf16_f32 v26, v20, v21
  v_mfma_f32_16x16x32_bf16 v[136:139], v[40:43], v[232:235], v[136:139]
  buffer_load_dwordx4 v6, s[32:35], s26 offen offset:3072 sc1 lds
  v_cvt_pk_bf16_f32 v27, v22, v23
  v_mfma_f32_16x16x32_bf16 v[152:155], v[44:47], v[232:235], v[152:155]
  s_add_u32 s26, s26, 1024
  ds_read_b64_tr_b16 v[88:89], v12 offset:8960
  buffer_store_dwordx4 v[24:27], v2, s[40:43], s64 offen offset:2048 sc1
  v_mfma_f32_16x16x32_bf16 v[168:171], v[48:51], v[232:235], v[168:171]
  ds_read_b64_tr_b16 v[90:91], v12 offset:9984
  v_mfma_f32_16x16x32_bf16 v[184:187], v[52:55], v[232:235], v[184:187]
  ds_read_b64_tr_b16 v[92:93], v13 offset:8960
  v_mfma_f32_16x16x32_bf16 v[200:203], v[56:59], v[232:235], v[200:203]
  s_add_u32 m0, s24, 114688
  ds_read_b64_tr_b16 v[94:95], v13 offset:9984
  v_mfma_f32_16x16x32_bf16 v[216:219], v[60:63], v[232:235], v[216:219]
  buffer_load_dwordx4 v10, s[36:39], s27 offen offset:2048 lds
  v_mfma_f32_16x16x32_bf16 v[108:111], v[32:35], v[236:239], v[108:111]
  ds_read_b128 v[248:251], v14 offset:34816
  v_mfma_f32_16x16x32_bf16 v[124:127], v[36:39], v[236:239], v[124:127]
  ds_read_b128 v[252:255], v14 offset:35840
  v_mfma_f32_16x16x32_bf16 v[140:143], v[40:43], v[236:239], v[140:143]
  v_mfma_f32_16x16x32_bf16 v[156:159], v[44:47], v[236:239], v[156:159]
  v_xor_b32 v14, 0x10000, v14
  v_mfma_f32_16x16x32_bf16 v[172:175], v[48:51], v[236:239], v[172:175]
  buffer_load_dwordx4 v11, s[36:39], s27 offen offset:3072 lds
  v_mfma_f32_16x16x32_bf16 v[188:191], v[52:55], v[236:239], v[188:191]
  s_add_u32 s27, s27, 524288
  v_mfma_f32_16x16x32_bf16 v[204:207], v[56:59], v[236:239], v[204:207]
  v_mfma_f32_16x16x32_bf16 v[220:223], v[60:63], v[236:239], v[220:223]
  s_waitcnt vmcnt(18) lgkmcnt(0)
  v_mfma_f32_16x16x32_bf16 v[96:99], v[64:67], v[240:243], v[96:99]
  s_barrier
  v_accvgpr_read_b32 v16, a24
  v_accvgpr_read_b32 v17, a25
  v_mfma_f32_16x16x32_bf16 v[112:115], v[68:71], v[240:243], v[112:115]
  ds_read_b64_tr_b16 v[32:33], v12 offset:32768
  v_accvgpr_read_b32 v18, a26
  v_mfma_f32_16x16x32_bf16 v[128:131], v[72:75], v[240:243], v[128:131]
  s_add_u32 m0, s24, 32768
  ds_read_b64_tr_b16 v[34:35], v12 offset:33792
  v_accvgpr_read_b32 v19, a27
  v_mfma_f32_16x16x32_bf16 v[144:147], v[76:79], v[240:243], v[144:147]
  buffer_load_dwordx4 v3, s[32:35], s26 offen offset:0 sc1 lds
  v_accvgpr_read_b32 v20, a28
  v_mfma_f32_16x16x32_bf16 v[160:163], v[80:83], v[240:243], v[160:163]
  ds_read_b64_tr_b16 v[36:37], v13 offset:32768
  v_accvgpr_read_b32 v21, a29
  v_mfma_f32_16x16x32_bf16 v[176:179], v[84:87], v[240:243], v[176:179]
  ds_read_b64_tr_b16 v[38:39], v13 offset:33792
  v_accvgpr_read_b32 v22, a30
  v_mfma_f32_16x16x32_bf16 v[192:195], v[88:91], v[240:243], v[192:195]
  ds_read_b64_tr_b16 v[40:41], v12 offset:33024
  v_accvgpr_read_b32 v23, a31
  v_mfma_f32_16x16x32_bf16 v[208:211], v[92:95], v[240:243], v[208:211]
  ds_read_b64_tr_b16 v[42:43], v12 offset:34048
  v_mul_f32 v16, s76, v16
  v_mfma_f32_16x16x32_bf16 v[100:103], v[64:67], v[244:247], v[100:103]
  buffer_load_dwordx4 v4, s[32:35], s26 offen offset:1024 sc1 lds
  v_mul_f32 v17, s76, v17
  v_mfma_f32_16x16x32_bf16 v[116:119], v[68:71], v[244:247], v[116:119]
  ds_read_b64_tr_b16 v[44:45], v13 offset:33024
  v_mul_f32 v18, s76, v18
  v_mfma_f32_16x16x32_bf16 v[132:135], v[72:75], v[244:247], v[132:135]
  ds_read_b64_tr_b16 v[46:47], v13 offset:34048
  v_mul_f32 v19, s76, v19
  v_mfma_f32_16x16x32_bf16 v[148:151], v[76:79], v[244:247], v[148:151]
  ds_read_b128 v[224:227], v14 offset:0
  v_mul_f32 v20, s76, v20
  v_mfma_f32_16x16x32_bf16 v[164:167], v[80:83], v[244:247], v[164:167]
  ds_read_b128 v[228:231], v14 offset:1024
  v_mul_f32 v21, s76, v21
  v_mfma_f32_16x16x32_bf16 v[180:183], v[84:87], v[244:247], v[180:183]
  buffer_load_dwordx4 v5, s[32:35], s26 offen offset:2048 sc1 lds
  v_mul_f32 v22, s76, v22
  v_mfma_f32_16x16x32_bf16 v[196:199], v[88:91], v[244:247], v[196:199]
  ds_read_b64_tr_b16 v[48:49], v12 offset:33280
  v_mul_f32 v23, s76, v23
  v_mfma_f32_16x16x32_bf16 v[212:215], v[92:95], v[244:247], v[212:215]
  ds_read_b64_tr_b16 v[50:51], v12 offset:34304
  v_cvt_pk_bf16_f32 v28, v16, v17
  v_mfma_f32_16x16x32_bf16 v[104:107], v[64:67], v[248:251], v[104:107]
  ds_read_b64_tr_b16 v[52:53], v13 offset:33280
  v_cvt_pk_bf16_f32 v29, v18, v19
  v_mfma_f32_16x16x32_bf16 v[120:123], v[68:71], v[248:251], v[120:123]
  ds_read_b64_tr_b16 v[54:55], v13 offset:34304
  v_cvt_pk_bf16_f32 v30, v20, v21
  v_mfma_f32_16x16x32_bf16 v[136:139], v[72:75], v[248:251], v[136:139]
  buffer_load_dwordx4 v6, s[32:35], s26 offen offset:3072 sc1 lds
  v_cvt_pk_bf16_f32 v31, v22, v23
  v_mfma_f32_16x16x32_bf16 v[152:155], v[76:79], v[248:251], v[152:155]
  s_add_u32 s26, s26, 1024
  ds_read_b64_tr_b16 v[56:57], v12 offset:33536
  buffer_store_dwordx4 v[28:31], v2, s[40:43], s64 offen offset:3072 sc1
  v_mfma_f32_16x16x32_bf16 v[168:171], v[80:83], v[248:251], v[168:171]
  ds_read_b64_tr_b16 v[58:59], v12 offset:34560
  v_mfma_f32_16x16x32_bf16 v[184:187], v[84:87], v[248:251], v[184:187]
  ds_read_b64_tr_b16 v[60:61], v13 offset:33536
  v_mfma_f32_16x16x32_bf16 v[200:203], v[88:91], v[248:251], v[200:203]
  s_add_u32 m0, s24, 16384
  ds_read_b64_tr_b16 v[62:63], v13 offset:34560
  v_mfma_f32_16x16x32_bf16 v[216:219], v[92:95], v[248:251], v[216:219]
  buffer_load_dwordx4 v8, s[36:39], s27 offen offset:0 lds
  v_mfma_f32_16x16x32_bf16 v[108:111], v[64:67], v[252:255], v[108:111]
  ds_read_b128 v[232:235], v14 offset:2048
  v_mfma_f32_16x16x32_bf16 v[124:127], v[68:71], v[252:255], v[124:127]
  ds_read_b128 v[236:239], v14 offset:3072
  v_mfma_f32_16x16x32_bf16 v[140:143], v[72:75], v[252:255], v[140:143]
  v_mfma_f32_16x16x32_bf16 v[156:159], v[76:79], v[252:255], v[156:159]
  v_mfma_f32_16x16x32_bf16 v[172:175], v[80:83], v[252:255], v[172:175]
  buffer_load_dwordx4 v9, s[36:39], s27 offen offset:1024 lds
  v_mfma_f32_16x16x32_bf16 v[188:191], v[84:87], v[252:255], v[188:191]
  v_mfma_f32_16x16x32_bf16 v[204:207], v[88:91], v[252:255], v[204:207]
  v_mfma_f32_16x16x32_bf16 v[220:223], v[92:95], v[252:255], v[220:223]
  s_waitcnt vmcnt(17) lgkmcnt(0)
  v_mfma_f32_16x16x32_bf16 v[96:99], v[32:35], v[224:227], v[96:99]
  s_add_u32 s64, s64, 4096
  v_accvgpr_read_b32 v16, a32
  v_accvgpr_read_b32 v17, a33
  v_mfma_f32_16x16x32_bf16 v[112:115], v[36:39], v[224:227], v[112:115]
  ds_read_b64_tr_b16 v[64:65], v12 offset:40960
  v_accvgpr_read_b32 v18, a34
  v_mfma_f32_16x16x32_bf16 v[128:131], v[40:43], v[224:227], v[128:131]
  s_add_u32 m0, s24, 65536
  ds_read_b64_tr_b16 v[66:67], v12 offset:41984
  v_accvgpr_read_b32 v19, a35
  v_mfma_f32_16x16x32_bf16 v[144:147], v[44:47], v[224:227], v[144:147]
  buffer_load_dwordx4 v3, s[32:35], s26 offen offset:0 sc1 lds
  v_accvgpr_read_b32 v20, a36
  v_mfma_f32_16x16x32_bf16 v[160:163], v[48:51], v[224:227], v[160:163]
  ds_read_b64_tr_b16 v[68:69], v13 offset:40960
  v_accvgpr_read_b32 v21, a37
  v_mfma_f32_16x16x32_bf16 v[176:179], v[52:55], v[224:227], v[176:179]
  ds_read_b64_tr_b16 v[70:71], v13 offset:41984
  v_accvgpr_read_b32 v22, a38
  v_mfma_f32_16x16x32_bf16 v[192:195], v[56:59], v[224:227], v[192:195]
  ds_read_b64_tr_b16 v[72:73], v12 offset:41216
  v_accvgpr_read_b32 v23, a39
  v_mfma_f32_16x16x32_bf16 v[208:211], v[60:63], v[224:227], v[208:211]
  ds_read_b64_tr_b16 v[74:75], v12 offset:42240
  v_mul_f32 v16, s76, v16
  v_mfma_f32_16x16x32_bf16 v[100:103], v[32:35], v[228:231], v[100:103]
  buffer_load_dwordx4 v4, s[32:35], s26 offen offset:1024 sc1 lds
  v_mul_f32 v17, s76, v17
  v_mfma_f32_16x16x32_bf16 v[116:119], v[36:39], v[228:231], v[116:119]
  ds_read_b64_tr_b16 v[76:77], v13 offset:41216
  v_mul_f32 v18, s76, v18
  v_mfma_f32_16x16x32_bf16 v[132:135], v[40:43], v[228:231], v[132:135]
  ds_read_b64_tr_b16 v[78:79], v13 offset:42240
  v_mul_f32 v19, s76, v19
  v_mfma_f32_16x16x32_bf16 v[148:151], v[44:47], v[228:231], v[148:151]
  ds_read_b128 v[240:243], v14 offset:32768
  v_mul_f32 v20, s76, v20
  v_mfma_f32_16x16x32_bf16 v[164:167], v[48:51], v[228:231], v[164:167]
  ds_read_b128 v[244:247], v14 offset:33792
  v_mul_f32 v21, s76, v21
  v_mfma_f32_16x16x32_bf16 v[180:183], v[52:55], v[228:231], v[180:183]
  buffer_load_dwordx4 v5, s[32:35], s26 offen offset:2048 sc1 lds
  v_mul_f32 v22, s76, v22
  v_mfma_f32_16x16x32_bf16 v[196:199], v[56:59], v[228:231], v[196:199]
  ds_read_b64_tr_b16 v[80:81], v12 offset:41472
  v_mul_f32 v23, s76, v23
  v_mfma_f32_16x16x32_bf16 v[212:215], v[60:63], v[228:231], v[212:215]
  ds_read_b64_tr_b16 v[82:83], v12 offset:42496
  v_cvt_pk_bf16_f32 v24, v16, v17
  v_mfma_f32_16x16x32_bf16 v[104:107], v[32:35], v[232:235], v[104:107]
  ds_read_b64_tr_b16 v[84:85], v13 offset:41472
  v_cvt_pk_bf16_f32 v25, v18, v19
  v_mfma_f32_16x16x32_bf16 v[120:123], v[36:39], v[232:235], v[120:123]
  ds_read_b64_tr_b16 v[86:87], v13 offset:42496
  v_cvt_pk_bf16_f32 v26, v20, v21
  v_mfma_f32_16x16x32_bf16 v[136:139], v[40:43], v[232:235], v[136:139]
  buffer_load_dwordx4 v6, s[32:35], s26 offen offset:3072 sc1 lds
  v_cvt_pk_bf16_f32 v27, v22, v23
  v_mfma_f32_16x16x32_bf16 v[152:155], v[44:47], v[232:235], v[152:155]
  s_add_u32 s26, s26, 1024
  ds_read_b64_tr_b16 v[88:89], v12 offset:41728
  buffer_store_dwordx4 v[24:27], v2, s[40:43], s64 offen offset:0 sc1
  v_mfma_f32_16x16x32_bf16 v[168:171], v[48:51], v[232:235], v[168:171]
  ds_read_b64_tr_b16 v[90:91], v12 offset:42752
  v_mfma_f32_16x16x32_bf16 v[184:187], v[52:55], v[232:235], v[184:187]
  ds_read_b64_tr_b16 v[92:93], v13 offset:41728
  v_mfma_f32_16x16x32_bf16 v[200:203], v[56:59], v[232:235], v[200:203]
  s_add_u32 m0, s24, 16384
  ds_read_b64_tr_b16 v[94:95], v13 offset:42752
  v_mfma_f32_16x16x32_bf16 v[216:219], v[60:63], v[232:235], v[216:219]
  buffer_load_dwordx4 v10, s[36:39], s27 offen offset:2048 lds
  v_mfma_f32_16x16x32_bf16 v[108:111], v[32:35], v[236:239], v[108:111]
  ds_read_b128 v[248:251], v14 offset:34816
  v_mfma_f32_16x16x32_bf16 v[124:127], v[36:39], v[236:239], v[124:127]
  ds_read_b128 v[252:255], v14 offset:35840
  v_mfma_f32_16x16x32_bf16 v[140:143], v[40:43], v[236:239], v[140:143]
  v_mfma_f32_16x16x32_bf16 v[156:159], v[44:47], v[236:239], v[156:159]
  v_xor_b32 v14, 0x10000, v14
  v_mfma_f32_16x16x32_bf16 v[172:175], v[48:51], v[236:239], v[172:175]
  buffer_load_dwordx4 v11, s[36:39], s27 offen offset:3072 lds
  v_mfma_f32_16x16x32_bf16 v[188:191], v[52:55], v[236:239], v[188:191]
  s_add_u32 s27, s27, 524288
  v_xor_b32 v12, 0x10000, v12
  v_mfma_f32_16x16x32_bf16 v[204:207], v[56:59], v[236:239], v[204:207]
  v_xor_b32 v13, 0x10000, v13
  v_mfma_f32_16x16x32_bf16 v[220:223], v[60:63], v[236:239], v[220:223]
  s_waitcnt vmcnt(17) lgkmcnt(0)
  v_mfma_f32_16x16x32_bf16 v[96:99], v[64:67], v[240:243], v[96:99]
  s_barrier
  v_accvgpr_read_b32 v16, a40
  v_accvgpr_read_b32 v17, a41
  v_mfma_f32_16x16x32_bf16 v[112:115], v[68:71], v[240:243], v[112:115]
  ds_read_b64_tr_b16 v[32:33], v12 offset:0
  v_accvgpr_read_b32 v18, a42
  v_mfma_f32_16x16x32_bf16 v[128:131], v[72:75], v[240:243], v[128:131]
  s_add_u32 m0, s24, 98304
  ds_read_b64_tr_b16 v[34:35], v12 offset:1024
  v_accvgpr_read_b32 v19, a43
  v_mfma_f32_16x16x32_bf16 v[144:147], v[76:79], v[240:243], v[144:147]
  buffer_load_dwordx4 v3, s[32:35], s26 offen offset:0 sc1 lds
  v_accvgpr_read_b32 v20, a44
  v_mfma_f32_16x16x32_bf16 v[160:163], v[80:83], v[240:243], v[160:163]
  ds_read_b64_tr_b16 v[36:37], v13 offset:0
  v_accvgpr_read_b32 v21, a45
  v_mfma_f32_16x16x32_bf16 v[176:179], v[84:87], v[240:243], v[176:179]
  ds_read_b64_tr_b16 v[38:39], v13 offset:1024
  v_accvgpr_read_b32 v22, a46
  v_mfma_f32_16x16x32_bf16 v[192:195], v[88:91], v[240:243], v[192:195]
  ds_read_b64_tr_b16 v[40:41], v12 offset:256
  v_accvgpr_read_b32 v23, a47
  v_mfma_f32_16x16x32_bf16 v[208:211], v[92:95], v[240:243], v[208:211]
  ds_read_b64_tr_b16 v[42:43], v12 offset:1280
  v_mul_f32 v16, s76, v16
  v_mfma_f32_16x16x32_bf16 v[100:103], v[64:67], v[244:247], v[100:103]
  buffer_load_dwordx4 v4, s[32:35], s26 offen offset:1024 sc1 lds
  v_mul_f32 v17, s76, v17
  v_mfma_f32_16x16x32_bf16 v[116:119], v[68:71], v[244:247], v[116:119]
  ds_read_b64_tr_b16 v[44:45], v13 offset:256
  v_mul_f32 v18, s76, v18
  v_mfma_f32_16x16x32_bf16 v[132:135], v[72:75], v[244:247], v[132:135]
  ds_read_b64_tr_b16 v[46:47], v13 offset:1280
  v_mul_f32 v19, s76, v19
  v_mfma_f32_16x16x32_bf16 v[148:151], v[76:79], v[244:247], v[148:151]
  ds_read_b128 v[224:227], v14 offset:0
  v_mul_f32 v20, s76, v20
  v_mfma_f32_16x16x32_bf16 v[164:167], v[80:83], v[244:247], v[164:167]
  ds_read_b128 v[228:231], v14 offset:1024
  v_mul_f32 v21, s76, v21
  v_mfma_f32_16x16x32_bf16 v[180:183], v[84:87], v[244:247], v[180:183]
  buffer_load_dwordx4 v5, s[32:35], s26 offen offset:2048 sc1 lds
  v_mul_f32 v22, s76, v22
  v_mfma_f32_16x16x32_bf16 v[196:199], v[88:91], v[244:247], v[196:199]
  ds_read_b64_tr_b16 v[48:49], v12 offset:512
  v_mul_f32 v23, s76, v23
  v_mfma_f32_16x16x32_bf16 v[212:215], v[92:95], v[244:247], v[212:215]
  ds_read_b64_tr_b16 v[50:51], v12 offset:1536
  v_cvt_pk_bf16_f32 v28, v16, v17
  v_mfma_f32_16x16x32_bf16 v[104:107], v[64:67], v[248:251], v[104:107]
  ds_read_b64_tr_b16 v[52:53], v13 offset:512
  v_cvt_pk_bf16_f32 v29, v18, v19
  v_mfma_f32_16x16x32_bf16 v[120:123], v[68:71], v[248:251], v[120:123]
  ds_read_b64_tr_b16 v[54:55], v13 offset:1536
  v_cvt_pk_bf16_f32 v30, v20, v21
  v_mfma_f32_16x16x32_bf16 v[136:139], v[72:75], v[248:251], v[136:139]
  buffer_load_dwordx4 v6, s[32:35], s26 offen offset:3072 sc1 lds
  v_cvt_pk_bf16_f32 v31, v22, v23
  v_mfma_f32_16x16x32_bf16 v[152:155], v[76:79], v[248:251], v[152:155]
  s_add_u32 s26, s26, 1024
  ds_read_b64_tr_b16 v[56:57], v12 offset:768
  buffer_store_dwordx4 v[28:31], v2, s[40:43], s64 offen offset:1024 sc1
  v_mfma_f32_16x16x32_bf16 v[168:171], v[80:83], v[248:251], v[168:171]
  ds_read_b64_tr_b16 v[58:59], v12 offset:1792
  v_mfma_f32_16x16x32_bf16 v[184:187], v[84:87], v[248:251], v[184:187]
  ds_read_b64_tr_b16 v[60:61], v13 offset:768
  v_mfma_f32_16x16x32_bf16 v[200:203], v[88:91], v[248:251], v[200:203]
  s_add_u32 m0, s24, 49152
  ds_read_b64_tr_b16 v[62:63], v13 offset:1792
  v_mfma_f32_16x16x32_bf16 v[216:219], v[92:95], v[248:251], v[216:219]
  buffer_load_dwordx4 v8, s[36:39], s27 offen offset:0 lds
  v_mfma_f32_16x16x32_bf16 v[108:111], v[64:67], v[252:255], v[108:111]
  ds_read_b128 v[232:235], v14 offset:2048
  v_mfma_f32_16x16x32_bf16 v[124:127], v[68:71], v[252:255], v[124:127]
  ds_read_b128 v[236:239], v14 offset:3072
  v_mfma_f32_16x16x32_bf16 v[140:143], v[72:75], v[252:255], v[140:143]
  v_mfma_f32_16x16x32_bf16 v[156:159], v[76:79], v[252:255], v[156:159]
  v_mfma_f32_16x16x32_bf16 v[172:175], v[80:83], v[252:255], v[172:175]
  buffer_load_dwordx4 v9, s[36:39], s27 offen offset:1024 lds
  v_mfma_f32_16x16x32_bf16 v[188:191], v[84:87], v[252:255], v[188:191]
  v_mfma_f32_16x16x32_bf16 v[204:207], v[88:91], v[252:255], v[204:207]
  v_mfma_f32_16x16x32_bf16 v[220:223], v[92:95], v[252:255], v[220:223]
  s_waitcnt vmcnt(17) lgkmcnt(0)
  v_mfma_f32_16x16x32_bf16 v[96:99], v[32:35], v[224:227], v[96:99]
  v_accvgpr_read_b32 v16, a48
  v_accvgpr_read_b32 v17, a49
  v_accvgpr_read_b32 v18, a50
  v_mfma_f32_16x16x32_bf16 v[112:115], v[36:39], v[224:227], v[112:115]
  ds_read_b64_tr_b16 v[64:65], v12 offset:8192
  v_accvgpr_read_b32 v19, a51
  v_mfma_f32_16x16x32_bf16 v[128:131], v[40:43], v[224:227], v[128:131]
  s_add_u32 m0, s24, 0
  ds_read_b64_tr_b16 v[66:67], v12 offset:9216
  v_accvgpr_read_b32 v20, a52
  v_mfma_f32_16x16x32_bf16 v[144:147], v[44:47], v[224:227], v[144:147]
  buffer_load_dwordx4 v3, s[32:35], s26 offen offset:0 sc1 lds
  v_accvgpr_read_b32 v21, a53
  v_accvgpr_read_b32 v22, a54
  v_mfma_f32_16x16x32_bf16 v[160:163], v[48:51], v[224:227], v[160:163]
  ds_read_b64_tr_b16 v[68:69], v13 offset:8192
  v_accvgpr_read_b32 v23, a55
  v_mfma_f32_16x16x32_bf16 v[176:179], v[52:55], v[224:227], v[176:179]
  ds_read_b64_tr_b16 v[70:71], v13 offset:9216
  v_mul_f32 v16, s76, v16
  v_mfma_f32_16x16x32_bf16 v[192:195], v[56:59], v[224:227], v[192:195]
  ds_read_b64_tr_b16 v[72:73], v12 offset:8448
  v_mul_f32 v17, s76, v17
  v_mfma_f32_16x16x32_bf16 v[208:211], v[60:63], v[224:227], v[208:211]
  ds_read_b64_tr_b16 v[74:75], v12 offset:9472
  v_mul_f32 v18, s76, v18
  v_mul_f32 v19, s76, v19
  v_mfma_f32_16x16x32_bf16 v[100:103], v[32:35], v[228:231], v[100:103]
  buffer_load_dwordx4 v4, s[32:35], s26 offen offset:1024 sc1 lds
  v_mul_f32 v20, s76, v20
  v_mfma_f32_16x16x32_bf16 v[116:119], v[36:39], v[228:231], v[116:119]
  ds_read_b64_tr_b16 v[76:77], v13 offset:8448
  v_mul_f32 v21, s76, v21
  v_mfma_f32_16x16x32_bf16 v[132:135], v[40:43], v[228:231], v[132:135]
  ds_read_b64_tr_b16 v[78:79], v13 offset:9472
  v_mul_f32 v22, s76, v22
  v_mfma_f32_16x16x32_bf16 v[148:151], v[44:47], v[228:231], v[148:151]
  ds_read_b128 v[240:243], v14 offset:32768
  v_mul_f32 v23, s76, v23
  v_cvt_pk_bf16_f32 v24, v16, v17
  v_mfma_f32_16x16x32_bf16 v[164:167], v[48:51], v[228:231], v[164:167]
  ds_read_b128 v[244:247], v14 offset:33792
  v_cvt_pk_bf16_f32 v25, v18, v19
  v_mfma_f32_16x16x32_bf16 v[180:183], v[52:55], v[228:231], v[180:183]
  buffer_load_dwordx4 v5, s[32:35], s26 offen offset:2048 sc1 lds
  v_cvt_pk_bf16_f32 v26, v20, v21
  v_mfma_f32_16x16x32_bf16 v[196:199], v[56:59], v[228:231], v[196:199]
  ds_read_b64_tr_b16 v[80:81], v12 offset:8704
  v_cvt_pk_bf16_f32 v27, v22, v23
  v_mfma_f32_16x16x32_bf16 v[212:215], v[60:63], v[228:231], v[212:215]
  ds_read_b64_tr_b16 v[82:83], v12 offset:9728
  buffer_store_dwordx4 v[24:27], v2, s[40:43], s64 offen offset:2048 sc1
  v_accvgpr_read_b32 v16, a56
  v_mfma_f32_16x16x32_bf16 v[104:107], v[32:35], v[232:235], v[104:107]
  ds_read_b64_tr_b16 v[84:85], v13 offset:8704
  v_accvgpr_read_b32 v17, a57
  v_mfma_f32_16x16x32_bf16 v[120:123], v[36:39], v[232:235], v[120:123]
  ds_read_b64_tr_b16 v[86:87], v13 offset:9728
  v_accvgpr_read_b32 v18, a58
  v_mfma_f32_16x16x32_bf16 v[136:139], v[40:43], v[232:235], v[136:139]
  buffer_load_dwordx4 v6, s[32:35], s26 offen offset:3072 sc1 lds
  v_accvgpr_read_b32 v19, a59
  v_accvgpr_read_b32 v20, a60
  v_mfma_f32_16x16x32_bf16 v[152:155], v[44:47], v[232:235], v[152:155]
  s_add_u32 s26, s26, 1024
  ds_read_b64_tr_b16 v[88:89], v12 offset:8960
  v_accvgpr_read_b32 v21, a61
  v_mfma_f32_16x16x32_bf16 v[168:171], v[48:51], v[232:235], v[168:171]
  ds_read_b64_tr_b16 v[90:91], v12 offset:9984
  v_accvgpr_read_b32 v22, a62
  v_mfma_f32_16x16x32_bf16 v[184:187], v[52:55], v[232:235], v[184:187]
  ds_read_b64_tr_b16 v[92:93], v13 offset:8960
  v_accvgpr_read_b32 v23, a63
  v_mfma_f32_16x16x32_bf16 v[200:203], v[56:59], v[232:235], v[200:203]
  s_add_u32 m0, s24, 49152
  ds_read_b64_tr_b16 v[94:95], v13 offset:9984
  v_mul_f32 v16, s76, v16
  v_mul_f32 v17, s76, v17
  v_mfma_f32_16x16x32_bf16 v[216:219], v[60:63], v[232:235], v[216:219]
  buffer_load_dwordx4 v10, s[36:39], s27 offen offset:2048 lds
  v_mul_f32 v18, s76, v18
  v_mfma_f32_16x16x32_bf16 v[108:111], v[32:35], v[236:239], v[108:111]
  ds_read_b128 v[248:251], v14 offset:34816
  v_mul_f32 v19, s76, v19
  v_mfma_f32_16x16x32_bf16 v[124:127], v[36:39], v[236:239], v[124:127]
  ds_read_b128 v[252:255], v14 offset:35840
  v_mul_f32 v20, s76, v20
  v_mfma_f32_16x16x32_bf16 v[140:143], v[40:43], v[236:239], v[140:143]
  v_mul_f32 v21, s76, v21
  v_mul_f32 v22, s76, v22
  v_mul_f32 v23, s76, v23
  v_mfma_f32_16x16x32_bf16 v[156:159], v[44:47], v[236:239], v[156:159]
  v_xor_b32 v14, 0x10000, v14
  v_cvt_pk_bf16_f32 v28, v16, v17
  v_mfma_f32_16x16x32_bf16 v[172:175], v[48:51], v[236:239], v[172:175]
  buffer_load_dwordx4 v11, s[36:39], s27 offen offset:3072 lds
  v_cvt_pk_bf16_f32 v29, v18, v19
  v_mfma_f32_16x16x32_bf16 v[188:191], v[52:55], v[236:239], v[188:191]
  s_add_u32 s27, s27, 524288
  v_cvt_pk_bf16_f32 v30, v20, v21
  v_cvt_pk_bf16_f32 v31, v22, v23
  v_mfma_f32_16x16x32_bf16 v[204:207], v[56:59], v[236:239], v[204:207]
  buffer_store_dwordx4 v[28:31], v2, s[40:43], s64 offen offset:3072 sc1
  v_mfma_f32_16x16x32_bf16 v[220:223], v[60:63], v[236:239], v[220:223]
  s_waitcnt vmcnt(18) lgkmcnt(0)
  v_mfma_f32_16x16x32_bf16 v[96:99], v[64:67], v[240:243], v[96:99]
  s_barrier
  v_accvgpr_read_b32 v16, a64
  v_accvgpr_read_b32 v17, a65
  v_accvgpr_read_b32 v18, a66
  v_mfma_f32_16x16x32_bf16 v[112:115], v[68:71], v[240:243], v[112:115]
  s_add_u32 s64, s64, 126976
  ds_read_b64_tr_b16 v[32:33], v12 offset:32768
  v_accvgpr_read_b32 v19, a67
  v_accvgpr_read_b32 v20, a68
  v_mfma_f32_16x16x32_bf16 v[128:131], v[72:75], v[240:243], v[128:131]
  s_add_u32 m0, s24, 32768
  ds_read_b64_tr_b16 v[34:35], v12 offset:33792
  v_accvgpr_read_b32 v21, a69
  v_mfma_f32_16x16x32_bf16 v[144:147], v[76:79], v[240:243], v[144:147]
  buffer_load_dwordx4 v3, s[32:35], s26 offen offset:0 sc1 lds
  v_accvgpr_read_b32 v22, a70
  v_accvgpr_read_b32 v23, a71
  v_mfma_f32_16x16x32_bf16 v[160:163], v[80:83], v[240:243], v[160:163]
  ds_read_b64_tr_b16 v[36:37], v13 offset:32768
  v_mul_f32 v16, s76, v16
  v_mfma_f32_16x16x32_bf16 v[176:179], v[84:87], v[240:243], v[176:179]
  ds_read_b64_tr_b16 v[38:39], v13 offset:33792
  v_mul_f32 v17, s76, v17
  v_mul_f32 v18, s76, v18
  v_mfma_f32_16x16x32_bf16 v[192:195], v[88:91], v[240:243], v[192:195]
  ds_read_b64_tr_b16 v[40:41], v12 offset:33024
  v_mul_f32 v19, s76, v19
  v_mfma_f32_16x16x32_bf16 v[208:211], v[92:95], v[240:243], v[208:211]
  ds_read_b64_tr_b16 v[42:43], v12 offset:34048
  v_mul_f32 v20, s76, v20
  v_mul_f32 v21, s76, v21
  v_mfma_f32_16x16x32_bf16 v[100:103], v[64:67], v[244:247], v[100:103]
  buffer_load_dwordx4 v4, s[32:35], s26 offen offset:1024 sc1 lds
  v_mul_f32 v22, s76, v22
  v_mfma_f32_16x16x32_bf16 v[116:119], v[68:71], v[244:247], v[116:119]
  ds_read_b64_tr_b16 v[44:45], v13 offset:33024
  v_mul_f32 v23, s76, v23
  v_cvt_pk_bf16_f32 v24, v16, v17
  v_mfma_f32_16x16x32_bf16 v[132:135], v[72:75], v[244:247], v[132:135]
  ds_read_b64_tr_b16 v[46:47], v13 offset:34048
  v_cvt_pk_bf16_f32 v25, v18, v19
  v_mfma_f32_16x16x32_bf16 v[148:151], v[76:79], v[244:247], v[148:151]
  ds_read_b128 v[224:227], v14 offset:0
  v_cvt_pk_bf16_f32 v26, v20, v21
  v_cvt_pk_bf16_f32 v27, v22, v23
  v_mfma_f32_16x16x32_bf16 v[164:167], v[80:83], v[244:247], v[164:167]
  ds_read_b128 v[228:231], v14 offset:1024
  buffer_store_dwordx4 v[24:27], v2, s[40:43], s64 offen offset:0 sc1
  v_mfma_f32_16x16x32_bf16 v[180:183], v[84:87], v[244:247], v[180:183]
  buffer_load_dwordx4 v5, s[32:35], s26 offen offset:2048 sc1 lds
  v_accvgpr_read_b32 v16, a72
  v_accvgpr_read_b32 v17, a73
  v_mfma_f32_16x16x32_bf16 v[196:199], v[88:91], v[244:247], v[196:199]
  ds_read_b64_tr_b16 v[48:49], v12 offset:33280
  v_accvgpr_read_b32 v18, a74
  v_mfma_f32_16x16x32_bf16 v[212:215], v[92:95], v[244:247], v[212:215]
  ds_read_b64_tr_b16 v[50:51], v12 offset:34304
  v_accvgpr_read_b32 v19, a75
  v_accvgpr_read_b32 v20, a76
  v_mfma_f32_16x16x32_bf16 v[104:107], v[64:67], v[248:251], v[104:107]
  ds_read_b64_tr_b16 v[52:53], v13 offset:33280
  v_accvgpr_read_b32 v21, a77
  v_accvgpr_read_b32 v22, a78
  v_mfma_f32_16x16x32_bf16 v[120:123], v[68:71], v[248:251], v[120:123]
  ds_read_b64_tr_b16 v[54:55], v13 offset:34304
  v_accvgpr_read_b32 v23, a79
  v_mfma_f32_16x16x32_bf16 v[136:139], v[72:75], v[248:251], v[136:139]
  buffer_load_dwordx4 v6, s[32:35], s26 offen offset:3072 sc1 lds
  v_mul_f32 v16, s76, v16
  v_mul_f32 v17, s76, v17
  v_mfma_f32_16x16x32_bf16 v[152:155], v[76:79], v[248:251], v[152:155]
  s_add_u32 s26, s26, 1024
  ds_read_b64_tr_b16 v[56:57], v12 offset:33536
  v_mul_f32 v18, s76, v18
  v_mfma_f32_16x16x32_bf16 v[168:171], v[80:83], v[248:251], v[168:171]
  ds_read_b64_tr_b16 v[58:59], v12 offset:34560
  v_mul_f32 v19, s76, v19
  v_mul_f32 v20, s76, v20
  v_mfma_f32_16x16x32_bf16 v[184:187], v[84:87], v[248:251], v[184:187]
  ds_read_b64_tr_b16 v[60:61], v13 offset:33536
  v_mul_f32 v21, s76, v21
  v_mfma_f32_16x16x32_bf16 v[200:203], v[88:91], v[248:251], v[200:203]
  ds_read_b64_tr_b16 v[62:63], v13 offset:34560
  v_mul_f32 v22, s76, v22
  v_mul_f32 v23, s76, v23
  v_mfma_f32_16x16x32_bf16 v[216:219], v[92:95], v[248:251], v[216:219]
  v_cvt_pk_bf16_f32 v28, v16, v17
  v_cvt_pk_bf16_f32 v29, v18, v19
  v_mfma_f32_16x16x32_bf16 v[108:111], v[64:67], v[252:255], v[108:111]
  ds_read_b128 v[232:235], v14 offset:2048
  v_cvt_pk_bf16_f32 v30, v20, v21
  v_cvt_pk_bf16_f32 v31, v22, v23
  v_mfma_f32_16x16x32_bf16 v[124:127], v[68:71], v[252:255], v[124:127]
  ds_read_b128 v[236:239], v14 offset:3072
  buffer_store_dwordx4 v[28:31], v2, s[40:43], s64 offen offset:1024 sc1
  v_mfma_f32_16x16x32_bf16 v[140:143], v[72:75], v[252:255], v[140:143]
  v_and_b32 v11, 15, v1
  v_lshrrev_b32 v10, 4, v1
  v_lshlrev_b32 v10, 2, v10
  v_mfma_f32_16x16x32_bf16 v[156:159], v[76:79], v[252:255], v[156:159]
  v_sub_u32 v11, v11, v10
  v_cmp_le_i32 s[68:69], 0, v11
  v_mfma_f32_16x16x32_bf16 v[172:175], v[80:83], v[252:255], v[172:175]
  v_cmp_le_i32 s[70:71], 1, v11
  v_cmp_le_i32 s[72:73], 2, v11
  v_cmp_le_i32 s[74:75], 3, v11
  v_mfma_f32_16x16x32_bf16 v[188:191], v[84:87], v[252:255], v[188:191]
  v_and_b32 v8, 7, v1
  v_lshlrev_b32 v8, 2, v8
  v_mfma_f32_16x16x32_bf16 v[204:207], v[88:91], v[252:255], v[204:207]
  v_add_u32 v8, s30, v8
  v_mfma_f32_16x16x32_bf16 v[220:223], v[92:95], v[252:255], v[220:223]
  s_waitcnt vmcnt(17) lgkmcnt(0)
  v_mfma_f32_16x16x32_bf16 v[96:99], v[32:35], v[224:227], v[96:99]
  v_accvgpr_read_b32 v16, a80
  v_accvgpr_read_b32 v17, a81
  v_accvgpr_read_b32 v18, a82
  v_mfma_f32_16x16x32_bf16 v[112:115], v[36:39], v[224:227], v[112:115]
  ds_read_b64_tr_b16 v[64:65], v12 offset:40960
  v_accvgpr_read_b32 v19, a83
  v_accvgpr_read_b32 v20, a84
  v_mfma_f32_16x16x32_bf16 v[128:131], v[40:43], v[224:227], v[128:131]
  s_add_u32 m0, s24, 65536
  ds_read_b64_tr_b16 v[66:67], v12 offset:41984
  v_accvgpr_read_b32 v21, a85
  v_accvgpr_read_b32 v22, a86
  v_mfma_f32_16x16x32_bf16 v[144:147], v[44:47], v[224:227], v[144:147]
  buffer_load_dwordx4 v3, s[32:35], s26 offen offset:0 sc1 lds
  v_accvgpr_read_b32 v23, a87
  v_mul_f32 v16, s76, v16
  v_mfma_f32_16x16x32_bf16 v[160:163], v[48:51], v[224:227], v[160:163]
  ds_read_b64_tr_b16 v[68:69], v13 offset:40960
  v_mul_f32 v17, s76, v17
  v_mul_f32 v18, s76, v18
  v_mfma_f32_16x16x32_bf16 v[176:179], v[52:55], v[224:227], v[176:179]
  ds_read_b64_tr_b16 v[70:71], v13 offset:41984
  v_mul_f32 v19, s76, v19
  v_mul_f32 v20, s76, v20
  v_mfma_f32_16x16x32_bf16 v[192:195], v[56:59], v[224:227], v[192:195]
  ds_read_b64_tr_b16 v[72:73], v12 offset:41216
  v_mul_f32 v21, s76, v21
  v_mul_f32 v22, s76, v22
  v_mfma_f32_16x16x32_bf16 v[208:211], v[60:63], v[224:227], v[208:211]
  ds_read_b64_tr_b16 v[74:75], v12 offset:42240
  v_mul_f32 v23, s76, v23
  v_mfma_f32_16x16x32_bf16 v[100:103], v[32:35], v[228:231], v[100:103]
  buffer_load_dwordx4 v4, s[32:35], s26 offen offset:1024 sc1 lds
  v_cvt_pk_bf16_f32 v24, v16, v17
  v_cvt_pk_bf16_f32 v25, v18, v19
  v_mfma_f32_16x16x32_bf16 v[116:119], v[36:39], v[228:231], v[116:119]
  ds_read_b64_tr_b16 v[76:77], v13 offset:41216
  v_cvt_pk_bf16_f32 v26, v20, v21
  v_cvt_pk_bf16_f32 v27, v22, v23
  v_mfma_f32_16x16x32_bf16 v[132:135], v[40:43], v[228:231], v[132:135]
  ds_read_b64_tr_b16 v[78:79], v13 offset:42240
  buffer_store_dwordx4 v[24:27], v2, s[40:43], s64 offen offset:2048 sc1
  v_accvgpr_read_b32 v16, a88
  v_mfma_f32_16x16x32_bf16 v[148:151], v[44:47], v[228:231], v[148:151]
  ds_read_b128 v[240:243], v14 offset:32768
  v_accvgpr_read_b32 v17, a89
  v_accvgpr_read_b32 v18, a90
  v_mfma_f32_16x16x32_bf16 v[164:167], v[48:51], v[228:231], v[164:167]
  ds_read_b128 v[244:247], v14 offset:33792
  v_accvgpr_read_b32 v19, a91
  v_accvgpr_read_b32 v20, a92
  v_mfma_f32_16x16x32_bf16 v[180:183], v[52:55], v[228:231], v[180:183]
  buffer_load_dwordx4 v5, s[32:35], s26 offen offset:2048 sc1 lds
  v_accvgpr_read_b32 v21, a93
  v_accvgpr_read_b32 v22, a94
  v_mfma_f32_16x16x32_bf16 v[196:199], v[56:59], v[228:231], v[196:199]
  ds_read_b64_tr_b16 v[80:81], v12 offset:41472
  v_accvgpr_read_b32 v23, a95
  v_mfma_f32_16x16x32_bf16 v[212:215], v[60:63], v[228:231], v[212:215]
  ds_read_b64_tr_b16 v[82:83], v12 offset:42496
  v_mul_f32 v16, s76, v16
  v_mul_f32 v17, s76, v17
  v_mfma_f32_16x16x32_bf16 v[104:107], v[32:35], v[232:235], v[104:107]
  ds_read_b64_tr_b16 v[84:85], v13 offset:41472
  v_mul_f32 v18, s76, v18
  v_mul_f32 v19, s76, v19
  v_mfma_f32_16x16x32_bf16 v[120:123], v[36:39], v[232:235], v[120:123]
  ds_read_b64_tr_b16 v[86:87], v13 offset:42496
  v_mul_f32 v20, s76, v20
  v_mul_f32 v21, s76, v21
  v_mfma_f32_16x16x32_bf16 v[136:139], v[40:43], v[232:235], v[136:139]
  buffer_load_dwordx4 v6, s[32:35], s26 offen offset:3072 sc1 lds
  v_mul_f32 v22, s76, v22
  v_mul_f32 v23, s76, v23
  v_mfma_f32_16x16x32_bf16 v[152:155], v[44:47], v[232:235], v[152:155]
  s_add_u32 s26, s26, 1024
  ds_read_b64_tr_b16 v[88:89], v12 offset:41728
  v_cvt_pk_bf16_f32 v28, v16, v17
  v_cvt_pk_bf16_f32 v29, v18, v19
  v_mfma_f32_16x16x32_bf16 v[168:171], v[48:51], v[232:235], v[168:171]
  ds_read_b64_tr_b16 v[90:91], v12 offset:42752
  v_cvt_pk_bf16_f32 v30, v20, v21
  v_cvt_pk_bf16_f32 v31, v22, v23
  v_mfma_f32_16x16x32_bf16 v[184:187], v[52:55], v[232:235], v[184:187]
  ds_read_b64_tr_b16 v[92:93], v13 offset:41728
  buffer_store_dwordx4 v[28:31], v2, s[40:43], s64 offen offset:3072 sc1
  v_add_u32 v9, 0, v1
  v_mfma_f32_16x16x32_bf16 v[200:203], v[56:59], v[232:235], v[200:203]
  ds_read_b64_tr_b16 v[94:95], v13 offset:42752
  v_mul_u32_u24 v10, 6554, v9
  v_mfma_f32_16x16x32_bf16 v[216:219], v[60:63], v[232:235], v[216:219]
  v_lshrrev_b32 v10, 16, v10
  v_mul_u32_u24 v10, 1120, v10
  v_lshl_add_u32 v10, v9, 4, v10
  v_mfma_f32_16x16x32_bf16 v[108:111], v[32:35], v[236:239], v[108:111]
  ds_read_b128 v[248:251], v14 offset:34816
  v_accvgpr_write_b32 a248, v10
  v_add_u32 v9, 64, v1
  v_mfma_f32_16x16x32_bf16 v[124:127], v[36:39], v[236:239], v[124:127]
  ds_read_b128 v[252:255], v14 offset:35840
  v_mul_u32_u24 v10, 6554, v9
  v_lshrrev_b32 v10, 16, v10
  v_mfma_f32_16x16x32_bf16 v[140:143], v[40:43], v[236:239], v[140:143]
  v_mul_u32_u24 v10, 1120, v10
  v_lshl_add_u32 v10, v9, 4, v10
  v_accvgpr_write_b32 a249, v10
  v_mfma_f32_16x16x32_bf16 v[156:159], v[44:47], v[236:239], v[156:159]
  v_xor_b32 v14, 0x10000, v14
  v_add_u32 v9, 128, v1
  v_mul_u32_u24 v10, 6554, v9
  v_mfma_f32_16x16x32_bf16 v[172:175], v[48:51], v[236:239], v[172:175]
  v_lshrrev_b32 v10, 16, v10
  v_mul_u32_u24 v10, 1120, v10
  v_lshl_add_u32 v10, v9, 4, v10
  v_mfma_f32_16x16x32_bf16 v[188:191], v[52:55], v[236:239], v[188:191]
  v_xor_b32 v12, 0x10000, v12
  v_accvgpr_write_b32 a250, v10
  v_mfma_f32_16x16x32_bf16 v[204:207], v[56:59], v[236:239], v[204:207]
  v_xor_b32 v13, 0x10000, v13
  v_mfma_f32_16x16x32_bf16 v[220:223], v[60:63], v[236:239], v[220:223]
  s_waitcnt vmcnt(15) lgkmcnt(0)
  v_mfma_f32_16x16x32_bf16 v[96:99], v[64:67], v[240:243], v[96:99]
  s_barrier
  v_accvgpr_read_b32 v16, a96
  v_accvgpr_read_b32 v17, a97
  v_accvgpr_read_b32 v18, a98
  v_accvgpr_read_b32 v19, a99
  v_mfma_f32_16x16x32_bf16 v[112:115], v[68:71], v[240:243], v[112:115]
  s_add_u32 s64, s64, 4096
  ds_read_b64_tr_b16 v[32:33], v12 offset:0
  v_accvgpr_read_b32 v20, a100
  v_accvgpr_read_b32 v21, a101
  v_mfma_f32_16x16x32_bf16 v[128:131], v[72:75], v[240:243], v[128:131]
  s_add_u32 m0, s24, 98304
  ds_read_b64_tr_b16 v[34:35], v12 offset:1024
  v_accvgpr_read_b32 v22, a102
  v_accvgpr_read_b32 v23, a103
  v_mfma_f32_16x16x32_bf16 v[144:147], v[76:79], v[240:243], v[144:147]
  buffer_load_dwordx4 v3, s[32:35], s26 offen offset:0 sc1 lds
  v_mul_f32 v16, s76, v16
  v_mul_f32 v17, s76, v17
  v_mul_f32 v18, s76, v18
  v_mfma_f32_16x16x32_bf16 v[160:163], v[80:83], v[240:243], v[160:163]
  ds_read_b64_tr_b16 v[36:37], v13 offset:0
  v_mul_f32 v19, s76, v19
  v_mul_f32 v20, s76, v20
  v_mfma_f32_16x16x32_bf16 v[176:179], v[84:87], v[240:243], v[176:179]
  ds_read_b64_tr_b16 v[38:39], v13 offset:1024
  v_mul_f32 v21, s76, v21
  v_mul_f32 v22, s76, v22
  v_mfma_f32_16x16x32_bf16 v[192:195], v[88:91], v[240:243], v[192:195]
  ds_read_b64_tr_b16 v[40:41], v12 offset:256
  v_mul_f32 v23, s76, v23
  v_cvt_pk_bf16_f32 v24, v16, v17
  v_cvt_pk_bf16_f32 v25, v18, v19
  v_mfma_f32_16x16x32_bf16 v[208:211], v[92:95], v[240:243], v[208:211]
  ds_read_b64_tr_b16 v[42:43], v12 offset:1280
  v_cvt_pk_bf16_f32 v26, v20, v21
  v_cvt_pk_bf16_f32 v27, v22, v23
  v_mfma_f32_16x16x32_bf16 v[100:103], v[64:67], v[244:247], v[100:103]
  buffer_load_dwordx4 v4, s[32:35], s26 offen offset:1024 sc1 lds
  buffer_store_dwordx4 v[24:27], v2, s[40:43], s64 offen offset:0 sc1
  v_accvgpr_read_b32 v16, a104
  v_mfma_f32_16x16x32_bf16 v[116:119], v[68:71], v[244:247], v[116:119]
  ds_read_b64_tr_b16 v[44:45], v13 offset:256
  v_accvgpr_read_b32 v17, a105
  v_accvgpr_read_b32 v18, a106
  v_mfma_f32_16x16x32_bf16 v[132:135], v[72:75], v[244:247], v[132:135]
  ds_read_b64_tr_b16 v[46:47], v13 offset:1280
  v_accvgpr_read_b32 v19, a107
  v_accvgpr_read_b32 v20, a108
  v_accvgpr_read_b32 v21, a109
  v_mfma_f32_16x16x32_bf16 v[148:151], v[76:79], v[244:247], v[148:151]
  ds_read_b128 v[224:227], v14 offset:0
  v_accvgpr_read_b32 v22, a110
  v_accvgpr_read_b32 v23, a111
  v_mfma_f32_16x16x32_bf16 v[164:167], v[80:83], v[244:247], v[164:167]
  ds_read_b128 v[228:231], v14 offset:1024
  v_mul_f32 v16, s76, v16
  v_mul_f32 v17, s76, v17
  v_mfma_f32_16x16x32_bf16 v[180:183], v[84:87], v[244:247], v[180:183]
  buffer_load_dwordx4 v5, s[32:35], s26 offen offset:2048 sc1 lds
  v_mul_f32 v18, s76, v18
  v_mul_f32 v19, s76, v19
  v_mul_f32 v20, s76, v20
  v_mfma_f32_16x16x32_bf16 v[196:199], v[88:91], v[244:247], v[196:199]
  ds_read_b64_tr_b16 v[48:49], v12 offset:512
  v_mul_f32 v21, s76, v21
  v_mul_f32 v22, s76, v22
  v_mfma_f32_16x16x32_bf16 v[212:215], v[92:95], v[244:247], v[212:215]
  ds_read_b64_tr_b16 v[50:51], v12 offset:1536
  v_mul_f32 v23, s76, v23
  v_cvt_pk_bf16_f32 v28, v16, v17
  v_mfma_f32_16x16x32_bf16 v[104:107], v[64:67], v[248:251], v[104:107]
  ds_read_b64_tr_b16 v[52:53], v13 offset:512
  v_cvt_pk_bf16_f32 v29, v18, v19
  v_cvt_pk_bf16_f32 v30, v20, v21
  v_cvt_pk_bf16_f32 v31, v22, v23
  v_mfma_f32_16x16x32_bf16 v[120:123], v[68:71], v[248:251], v[120:123]
  ds_read_b64_tr_b16 v[54:55], v13 offset:1536
  buffer_store_dwordx4 v[28:31], v2, s[40:43], s64 offen offset:1024 sc1
  v_accvgpr_read_b32 v16, a112
  v_mfma_f32_16x16x32_bf16 v[136:139], v[72:75], v[248:251], v[136:139]
  buffer_load_dwordx4 v6, s[32:35], s26 offen offset:3072 sc1 lds
  v_accvgpr_read_b32 v17, a113
  v_accvgpr_read_b32 v18, a114
  v_mfma_f32_16x16x32_bf16 v[152:155], v[76:79], v[248:251], v[152:155]
  s_add_u32 s26, s26, 1024
  ds_read_b64_tr_b16 v[56:57], v12 offset:768
  v_accvgpr_read_b32 v19, a115
  v_accvgpr_read_b32 v20, a116
  v_mfma_f32_16x16x32_bf16 v[168:171], v[80:83], v[248:251], v[168:171]
  ds_read_b64_tr_b16 v[58:59], v12 offset:1792
  v_accvgpr_read_b32 v21, a117
  v_accvgpr_read_b32 v22, a118
  v_accvgpr_read_b32 v23, a119
  v_mfma_f32_16x16x32_bf16 v[184:187], v[84:87], v[248:251], v[184:187]
  ds_read_b64_tr_b16 v[60:61], v13 offset:768
  v_mul_f32 v16, s76, v16
  v_mul_f32 v17, s76, v17
  v_mfma_f32_16x16x32_bf16 v[200:203], v[88:91], v[248:251], v[200:203]
  ds_read_b64_tr_b16 v[62:63], v13 offset:1792
  v_mul_f32 v18, s76, v18
  v_mul_f32 v19, s76, v19
  v_mfma_f32_16x16x32_bf16 v[216:219], v[92:95], v[248:251], v[216:219]
  v_mul_f32 v20, s76, v20
  v_mul_f32 v21, s76, v21
  v_mul_f32 v22, s76, v22
  v_mul_f32 v23, s76, v23
  v_mfma_f32_16x16x32_bf16 v[108:111], v[64:67], v[252:255], v[108:111]
  ds_read_b128 v[232:235], v14 offset:2048
  v_cvt_pk_bf16_f32 v24, v16, v17
  v_cvt_pk_bf16_f32 v25, v18, v19
  v_mfma_f32_16x16x32_bf16 v[124:127], v[68:71], v[252:255], v[124:127]
  ds_read_b128 v[236:239], v14 offset:3072
  v_cvt_pk_bf16_f32 v26, v20, v21
  v_cvt_pk_bf16_f32 v27, v22, v23
  v_mfma_f32_16x16x32_bf16 v[140:143], v[72:75], v[252:255], v[140:143]
  buffer_store_dwordx4 v[24:27], v2, s[40:43], s64 offen offset:2048 sc1
  v_add_u32 v9, 192, v1
  v_mul_u32_u24 v10, 6554, v9
  v_lshrrev_b32 v10, 16, v10
  v_mfma_f32_16x16x32_bf16 v[156:159], v[76:79], v[252:255], v[156:159]
  v_mul_u32_u24 v10, 1120, v10
  v_lshl_add_u32 v10, v9, 4, v10
  v_accvgpr_write_b32 a251, v10
  v_mfma_f32_16x16x32_bf16 v[172:175], v[80:83], v[252:255], v[172:175]
  v_add_u32 v9, 256, v1
  v_mul_u32_u24 v10, 6554, v9
  v_lshrrev_b32 v10, 16, v10
  v_mfma_f32_16x16x32_bf16 v[188:191], v[84:87], v[252:255], v[188:191]
  v_mul_u32_u24 v10, 1120, v10
  v_lshl_add_u32 v10, v9, 4, v10
  v_accvgpr_write_b32 a252, v10
  v_mfma_f32_16x16x32_bf16 v[204:207], v[88:91], v[252:255], v[204:207]
  v_mfma_f32_16x16x32_bf16 v[220:223], v[92:95], v[252:255], v[220:223]
  s_waitcnt vmcnt(14) lgkmcnt(0)
  v_mfma_f32_16x16x32_bf16 v[96:99], v[32:35], v[224:227], v[96:99]
  v_accvgpr_read_b32 v16, a120
  v_accvgpr_read_b32 v17, a121
  v_accvgpr_read_b32 v18, a122
  v_mfma_f32_16x16x32_bf16 v[112:115], v[36:39], v[224:227], v[112:115]
  s_mul_i32 s34, s20, 5120
  ds_read_b64_tr_b16 v[64:65], v12 offset:8192
  v_accvgpr_read_b32 v19, a123
  v_accvgpr_read_b32 v20, a124
  v_mfma_f32_16x16x32_bf16 v[128:131], v[40:43], v[224:227], v[128:131]
  s_add_u32 s34, s34, 131072
  ds_read_b64_tr_b16 v[66:67], v12 offset:9216
  v_accvgpr_read_b32 v21, a125
  v_accvgpr_read_b32 v22, a126
  v_mfma_f32_16x16x32_bf16 v[144:147], v[44:47], v[224:227], v[144:147]
  s_and_b32 s32, s21, 3
  buffer_load_dword v15, v8, s[40:43], 0 offen sc1
  v_accvgpr_read_b32 v23, a127
  v_mul_f32 v16, s76, v16
  v_mfma_f32_16x16x32_bf16 v[160:163], v[48:51], v[224:227], v[160:163]
  s_min_u32 s32, s32, 2
  ds_read_b64_tr_b16 v[68:69], v13 offset:8192
  v_mul_f32 v17, s76, v17
  v_mul_f32 v18, s76, v18
  v_mfma_f32_16x16x32_bf16 v[176:179], v[52:55], v[224:227], v[176:179]
  s_add_u32 s32, s32, 5
  ds_read_b64_tr_b16 v[70:71], v13 offset:9216
  v_mul_f32 v19, s76, v19
  v_mul_f32 v20, s76, v20
  v_mfma_f32_16x16x32_bf16 v[192:195], v[56:59], v[224:227], v[192:195]
  s_lshl_b32 s32, s32, 14
  ds_read_b64_tr_b16 v[72:73], v12 offset:8448
  v_mul_f32 v21, s76, v21
  v_mul_f32 v22, s76, v22
  v_mfma_f32_16x16x32_bf16 v[208:211], v[60:63], v[224:227], v[208:211]
  s_mov_b32 s9, -1
  ds_read_b64_tr_b16 v[74:75], v12 offset:9472
  v_mul_f32 v23, s76, v23
  v_mfma_f32_16x16x32_bf16 v[100:103], v[32:35], v[228:231], v[100:103]
  s_sub_u32 s23, s2, 64
  v_cvt_pk_bf16_f32 v28, v16, v17
  v_cvt_pk_bf16_f32 v29, v18, v19
  v_cvt_pk_bf16_f32 v30, v20, v21
  v_mfma_f32_16x16x32_bf16 v[116:119], v[36:39], v[228:231], v[116:119]
  s_cmp_lt_u32 s23, 96
  s_cselect_b32 s9, 0, s9
  ds_read_b64_tr_b16 v[76:77], v13 offset:8448
  v_cvt_pk_bf16_f32 v31, v22, v23
  v_mfma_f32_16x16x32_bf16 v[132:135], v[40:43], v[228:231], v[132:135]
  s_cmp_ge_u32 s2, 224
  s_cselect_b32 s9, 0, s9
  ds_read_b64_tr_b16 v[78:79], v13 offset:9472
  buffer_store_dwordx4 v[28:31], v2, s[40:43], s64 offen offset:3072 sc1
  v_accvgpr_read_b32 v16, a128
  v_mfma_f32_16x16x32_bf16 v[148:151], v[44:47], v[228:231], v[148:151]
  s_and_b32 s32, s32, s9
  ds_read_b128 v[240:243], v14 offset:32768
  v_accvgpr_read_b32 v17, a129
  v_accvgpr_read_b32 v18, a130
  v_mfma_f32_16x16x32_bf16 v[164:167], v[48:51], v[228:231], v[164:167]
  s_sub_u32 s23, s2, 170
  ds_read_b128 v[244:247], v14 offset:33792
  v_accvgpr_read_b32 v19, a131
  v_accvgpr_read_b32 v20, a132
  v_mfma_f32_16x16x32_bf16 v[180:183], v[52:55], v[228:231], v[180:183]
  s_cmp_lt_u32 s23, 54
  s_cselect_b32 s32, 81920, s32
  v_accvgpr_read_b32 v21, a133
  v_accvgpr_read_b32 v22, a134
  v_accvgpr_read_b32 v23, a135
  v_mfma_f32_16x16x32_bf16 v[196:199], v[56:59], v[228:231], v[196:199]
  s_mov_b32 s67, s2
  s_add_u32 s64, s64, 126976
  ds_read_b64_tr_b16 v[80:81], v12 offset:8704
  v_mul_f32 v16, s76, v16
  v_mfma_f32_16x16x32_bf16 v[212:215], v[60:63], v[228:231], v[212:215]
  s_mov_b32 s8, 0
  ds_read_b64_tr_b16 v[82:83], v12 offset:9728
  v_mul_f32 v17, s76, v17
  v_mul_f32 v18, s76, v18
  v_mfma_f32_16x16x32_bf16 v[104:107], v[32:35], v[232:235], v[104:107]
  s_mov_b32 s66, 0
  ds_read_b64_tr_b16 v[84:85], v13 offset:8704
  v_mul_f32 v19, s76, v19
  v_mul_f32 v20, s76, v20
  v_mfma_f32_16x16x32_bf16 v[120:123], v[36:39], v[232:235], v[120:123]
  s_mov_b32 s11, 0
  ds_read_b64_tr_b16 v[86:87], v13 offset:9728
  v_mul_f32 v21, s76, v21
  v_mul_f32 v22, s76, v22
  v_mfma_f32_16x16x32_bf16 v[136:139], v[40:43], v[232:235], v[136:139]
  s_mov_b32 s12, 0
  v_mul_f32 v23, s76, v23
  v_cvt_pk_bf16_f32 v24, v16, v17
  v_cvt_pk_bf16_f32 v25, v18, v19
  v_mfma_f32_16x16x32_bf16 v[152:155], v[44:47], v[232:235], v[152:155]
  s_lshl_b32 s15, s22, 1
  ds_read_b64_tr_b16 v[88:89], v12 offset:8960
  v_cvt_pk_bf16_f32 v26, v20, v21
  v_cvt_pk_bf16_f32 v27, v22, v23
  v_mfma_f32_16x16x32_bf16 v[168:171], v[48:51], v[232:235], v[168:171]
  s_add_u32 s23, s15, 6
  ds_read_b64_tr_b16 v[90:91], v12 offset:9984
  buffer_store_dwordx4 v[24:27], v2, s[40:43], s64 offen offset:0 sc1
  v_accvgpr_read_b32 v16, a136
  v_mfma_f32_16x16x32_bf16 v[184:187], v[52:55], v[232:235], v[184:187]
  s_sub_u32 s15, 24, s15
  ds_read_b64_tr_b16 v[92:93], v13 offset:8960
  v_accvgpr_read_b32 v17, a137
  v_accvgpr_read_b32 v18, a138
  v_mfma_f32_16x16x32_bf16 v[200:203], v[56:59], v[232:235], v[200:203]
  s_max_u32 s15, s15, s23
  ds_read_b64_tr_b16 v[94:95], v13 offset:9984
  v_accvgpr_read_b32 v19, a139
  v_mfma_f32_16x16x32_bf16 v[216:219], v[60:63], v[232:235], v[216:219]
  s_lshl_b32 s15, s15, 14
  v_accvgpr_read_b32 v20, a140
  v_accvgpr_read_b32 v21, a141
  v_accvgpr_read_b32 v22, a142
  v_mfma_f32_16x16x32_bf16 v[108:111], v[32:35], v[236:239], v[108:111]
  ds_read_b128 v[248:251], v14 offset:34816
  v_accvgpr_read_b32 v23, a143
  v_mul_f32 v16, s76, v16
  v_mfma_f32_16x16x32_bf16 v[124:127], v[36:39], v[236:239], v[124:127]
  ds_read_b128 v[252:255], v14 offset:35840
  v_mul_f32 v17, s76, v17
  v_mul_f32 v18, s76, v18
  v_mfma_f32_16x16x32_bf16 v[140:143], v[40:43], v[236:239], v[140:143]
  v_mul_f32 v19, s76, v19
  v_mul_f32 v20, s76, v20
  v_mul_f32 v21, s76, v21
  v_mfma_f32_16x16x32_bf16 v[156:159], v[44:47], v[236:239], v[156:159]
  v_xor_b32 v14, 0x10000, v14
  v_mul_f32 v22, s76, v22
  v_mul_f32 v23, s76, v23
  v_mfma_f32_16x16x32_bf16 v[172:175], v[48:51], v[236:239], v[172:175]
  v_cvt_pk_bf16_f32 v28, v16, v17
  v_cvt_pk_bf16_f32 v29, v18, v19
  v_cvt_pk_bf16_f32 v30, v20, v21
  v_mfma_f32_16x16x32_bf16 v[188:191], v[52:55], v[236:239], v[188:191]
  v_cvt_pk_bf16_f32 v31, v22, v23
  v_mfma_f32_16x16x32_bf16 v[204:207], v[56:59], v[236:239], v[204:207]
  buffer_store_dwordx4 v[28:31], v2, s[40:43], s64 offen offset:1024 sc1
  v_mfma_f32_16x16x32_bf16 v[220:223], v[60:63], v[236:239], v[220:223]
  s_waitcnt vmcnt(12) lgkmcnt(0)
  v_mfma_f32_16x16x32_bf16 v[96:99], v[64:67], v[240:243], v[96:99]
  s_barrier
  v_accvgpr_read_b32 v16, a144
  v_accvgpr_read_b32 v17, a145
  v_accvgpr_read_b32 v18, a146
  v_accvgpr_read_b32 v19, a147
  v_mfma_f32_16x16x32_bf16 v[112:115], v[68:71], v[240:243], v[112:115]
  s_and_b32 s23, s20, 1
  ds_read_b64_tr_b16 v[32:33], v12 offset:32768
  v_accvgpr_read_b32 v20, a148
  v_accvgpr_read_b32 v21, a149
  v_mfma_f32_16x16x32_bf16 v[128:131], v[72:75], v[240:243], v[128:131]
  s_lshl_b32 s23, s23, 12
  ds_read_b64_tr_b16 v[34:35], v12 offset:33792
  v_accvgpr_read_b32 v22, a150
  v_accvgpr_read_b32 v23, a151
  v_mfma_f32_16x16x32_bf16 v[144:147], v[76:79], v[240:243], v[144:147]
  s_cmp_lt_u32 s20, 2
  s_cselect_b32 s24, 106496, 0
  v_mul_f32 v16, s76, v16
  v_mul_f32 v17, s76, v17
  v_mul_f32 v18, s76, v18
  v_mfma_f32_16x16x32_bf16 v[160:163], v[80:83], v[240:243], v[160:163]
  s_add_u32 s24, s24, s23
  ds_read_b64_tr_b16 v[36:37], v13 offset:32768
  v_mul_f32 v19, s76, v19
  v_mul_f32 v20, s76, v20
  v_mfma_f32_16x16x32_bf16 v[176:179], v[84:87], v[240:243], v[176:179]
  s_lshl_b32 s26, s20, 12
  ds_read_b64_tr_b16 v[38:39], v13 offset:33792
  v_mul_f32 v21, s76, v21
  v_mul_f32 v22, s76, v22
  v_mfma_f32_16x16x32_bf16 v[192:195], v[88:91], v[240:243], v[192:195]
  s_mov_b32 s27, s26
  ds_read_b64_tr_b16 v[40:41], v12 offset:33024
  v_mul_f32 v23, s76, v23
  v_cvt_pk_bf16_f32 v24, v16, v17
  v_mfma_f32_16x16x32_bf16 v[208:211], v[92:95], v[240:243], v[208:211]
  s_add_u32 s25, s27, 49152
  ds_read_b64_tr_b16 v[42:43], v12 offset:34048
  v_cvt_pk_bf16_f32 v25, v18, v19
  v_cvt_pk_bf16_f32 v26, v20, v21
  v_cvt_pk_bf16_f32 v27, v22, v23
  v_mfma_f32_16x16x32_bf16 v[100:103], v[64:67], v[244:247], v[100:103]
  s_load_dwordx4 s[4:7], s[0:1], 64
  buffer_store_dwordx4 v[24:27], v2, s[40:43], s64 offen offset:2048 sc1
  v_accvgpr_read_b32 v16, a152
  v_accvgpr_read_b32 v17, a153
  v_mfma_f32_16x16x32_bf16 v[116:119], v[68:71], v[244:247], v[116:119]
  s_load_dwordx2 s[60:61], s[0:1], 80
  ds_read_b64_tr_b16 v[44:45], v13 offset:33024
  v_accvgpr_read_b32 v18, a154
  v_accvgpr_read_b32 v19, a155
  v_mfma_f32_16x16x32_bf16 v[132:135], v[72:75], v[244:247], v[132:135]
  s_add_u32 s23, s20, 1
  ds_read_b64_tr_b16 v[46:47], v13 offset:34048
  v_accvgpr_read_b32 v20, a156
  v_accvgpr_read_b32 v21, a157
  v_mfma_f32_16x16x32_bf16 v[148:151], v[76:79], v[244:247], v[148:151]
  s_lshr_b32 s23, s23, 1
  ds_read_b128 v[224:227], v14 offset:0
  v_accvgpr_read_b32 v22, a158
  v_accvgpr_read_b32 v23, a159
  v_mfma_f32_16x16x32_bf16 v[164:167], v[80:83], v[244:247], v[164:167]
  s_lshl_b32 s28, s22, 1
  ds_read_b128 v[228:231], v14 offset:1024
  v_mul_f32 v16, s76, v16
  v_mul_f32 v17, s76, v17
  v_mfma_f32_16x16x32_bf16 v[180:183], v[84:87], v[244:247], v[180:183]
  s_add_u32 s28, s28, s23
  v_mul_f32 v18, s76, v18
  v_mul_f32 v19, s76, v19
  v_mul_f32 v20, s76, v20
  v_mfma_f32_16x16x32_bf16 v[196:199], v[88:91], v[244:247], v[196:199]
  s_lshl_b32 s23, s22, 2
  ds_read_b64_tr_b16 v[48:49], v12 offset:33280
  v_mul_f32 v21, s76, v21
  v_mul_f32 v22, s76, v22
  v_mfma_f32_16x16x32_bf16 v[212:215], v[92:95], v[244:247], v[212:215]
  s_sub_u32 s29, 28, s23
  ds_read_b64_tr_b16 v[50:51], v12 offset:34304
  v_mul_f32 v23, s76, v23
  v_cvt_pk_bf16_f32 v28, v16, v17
  v_cvt_pk_bf16_f32 v29, v18, v19
  v_mfma_f32_16x16x32_bf16 v[104:107], v[64:67], v[248:251], v[104:107]
  s_and_b32 s23, s20, 1
  ds_read_b64_tr_b16 v[52:53], v13 offset:33280
  v_cvt_pk_bf16_f32 v30, v20, v21
  v_cvt_pk_bf16_f32 v31, v22, v23
  v_mfma_f32_16x16x32_bf16 v[120:123], v[68:71], v[248:251], v[120:123]
  s_add_u32 s29, s29, s23
  ds_read_b64_tr_b16 v[54:55], v13 offset:34304
  buffer_store_dwordx4 v[28:31], v2, s[40:43], s64 offen offset:3072 sc1
  v_accvgpr_read_b32 v16, a160
  v_mfma_f32_16x16x32_bf16 v[136:139], v[72:75], v[248:251], v[136:139]
  s_add_u32 s64, s64, 4096
  v_accvgpr_read_b32 v17, a161
  v_accvgpr_read_b32 v18, a162
  v_accvgpr_read_b32 v19, a163
  v_mfma_f32_16x16x32_bf16 v[152:155], v[76:79], v[248:251], v[152:155]
  ds_read_b64_tr_b16 v[56:57], v12 offset:33536
  v_accvgpr_read_b32 v20, a164
  v_accvgpr_read_b32 v21, a165
  v_mfma_f32_16x16x32_bf16 v[168:171], v[80:83], v[248:251], v[168:171]
  ds_read_b64_tr_b16 v[58:59], v12 offset:34560
  v_accvgpr_read_b32 v22, a166
  v_accvgpr_read_b32 v23, a167
  v_mfma_f32_16x16x32_bf16 v[184:187], v[84:87], v[248:251], v[184:187]
  ds_read_b64_tr_b16 v[60:61], v13 offset:33536
  v_mul_f32 v16, s76, v16
  v_mul_f32 v17, s76, v17
  v_mfma_f32_16x16x32_bf16 v[200:203], v[88:91], v[248:251], v[200:203]
  ds_read_b64_tr_b16 v[62:63], v13 offset:34560
  v_mul_f32 v18, s76, v18
  v_mul_f32 v19, s76, v19
  v_mul_f32 v20, s76, v20
  v_mfma_f32_16x16x32_bf16 v[216:219], v[92:95], v[248:251], v[216:219]
  v_mul_f32 v21, s76, v21
  v_mul_f32 v22, s76, v22
  v_mul_f32 v23, s76, v23
  v_mfma_f32_16x16x32_bf16 v[108:111], v[64:67], v[252:255], v[108:111]
  ds_read_b128 v[232:235], v14 offset:2048
  v_cvt_pk_bf16_f32 v24, v16, v17
  v_cvt_pk_bf16_f32 v25, v18, v19
  v_mfma_f32_16x16x32_bf16 v[124:127], v[68:71], v[252:255], v[124:127]
  ds_read_b128 v[236:239], v14 offset:3072
  v_cvt_pk_bf16_f32 v26, v20, v21
  v_cvt_pk_bf16_f32 v27, v22, v23
  v_mfma_f32_16x16x32_bf16 v[140:143], v[72:75], v[252:255], v[140:143]
  buffer_store_dwordx4 v[24:27], v2, s[40:43], s64 offen offset:0 sc1
  v_lshrrev_b32 v6, 2, v1
  v_mul_u32_u24 v6, 160, v6
  v_mfma_f32_16x16x32_bf16 v[156:159], v[76:79], v[252:255], v[156:159]
  v_and_b32 v9, 3, v1
  v_lshl_add_u32 v6, v9, 3, v6
  v_add_u32 v6, s34, v6
  v_mfma_f32_16x16x32_bf16 v[172:175], v[80:83], v[252:255], v[172:175]
  v_mov_b32 v3, v2
  v_mov_b32 v4, 0xff800000
  v_add_u32 v9, 106496, v2
  v_mfma_f32_16x16x32_bf16 v[188:191], v[84:87], v[252:255], v[188:191]
  v_mfma_f32_16x16x32_bf16 v[204:207], v[88:91], v[252:255], v[204:207]
  v_mfma_f32_16x16x32_bf16 v[220:223], v[92:95], v[252:255], v[220:223]
  s_waitcnt vmcnt(8) lgkmcnt(0)
  v_mfma_f32_16x16x32_bf16 v[96:99], v[32:35], v[224:227], v[96:99]
  v_accvgpr_read_b32 v16, a168
  v_accvgpr_read_b32 v17, a169
  v_accvgpr_read_b32 v18, a170
  v_mfma_f32_16x16x32_bf16 v[112:115], v[36:39], v[224:227], v[112:115]
  s_cmp_ge_u32 s20, 2
  s_cselect_b32 s4, s6, s4
  s_cselect_b32 s5, s7, s5
  ds_read_b64_tr_b16 v[64:65], v12 offset:40960
  v_accvgpr_read_b32 v19, a171
  v_accvgpr_read_b32 v20, a172
  v_mfma_f32_16x16x32_bf16 v[128:131], v[40:43], v[224:227], v[128:131]
  s_mov_b32 s62, 2211840
  ds_read_b64_tr_b16 v[66:67], v12 offset:41984
  v_accvgpr_read_b32 v21, a173
  v_accvgpr_read_b32 v22, a174
  v_mfma_f32_16x16x32_bf16 v[144:147], v[44:47], v[224:227], v[144:147]
  s_mov_b32 s63, 0x20000
  v_accvgpr_read_b32 v23, a175
  v_mul_f32 v16, s76, v16
  v_mul_f32 v17, s76, v17
  v_mfma_f32_16x16x32_bf16 v[160:163], v[48:51], v[224:227], v[160:163]
  s_mov_b64 s[56:57], s[52:53]
  ds_read_b64_tr_b16 v[68:69], v13 offset:40960
  v_mul_f32 v18, s76, v18
  v_mfma_f32_16x16x32_bf16 v[176:179], v[52:55], v[224:227], v[176:179]
  s_mov_b32 s58, s54
  ds_read_b64_tr_b16 v[70:71], v13 offset:41984
  v_mul_f32 v19, s76, v19
  v_mul_f32 v20, s76, v20
  v_mfma_f32_16x16x32_bf16 v[192:195], v[56:59], v[224:227], v[192:195]
  s_mov_b64 s[52:53], s[4:5]
  ds_read_b64_tr_b16 v[72:73], v12 offset:41216
  v_mul_f32 v21, s76, v21
  v_mul_f32 v22, s76, v22
  v_mfma_f32_16x16x32_bf16 v[208:211], v[60:63], v[224:227], v[208:211]
  s_mov_b32 s54, 2211840
  ds_read_b64_tr_b16 v[74:75], v12 offset:42240
  v_mul_f32 v23, s76, v23
  v_cvt_pk_bf16_f32 v28, v16, v17
  v_mfma_f32_16x16x32_bf16 v[100:103], v[32:35], v[228:231], v[100:103]
  s_getpc_b64 s[36:37]
fa_copc:
  v_cvt_pk_bf16_f32 v29, v18, v19
  v_cvt_pk_bf16_f32 v30, v20, v21
  v_cvt_pk_bf16_f32 v31, v22, v23
  v_mfma_f32_16x16x32_bf16 v[116:119], v[36:39], v[228:231], v[116:119]
  s_add_u32 s36, s36, fa_co-fa_copc-4
  s_addc_u32 s37, s37, 0
  ds_read_b64_tr_b16 v[76:77], v13 offset:41216
  buffer_store_dwordx4 v[28:31], v2, s[40:43], s64 offen offset:1024 sc1
  v_mfma_f32_16x16x32_bf16 v[132:135], v[40:43], v[228:231], v[132:135]
  s_lshl_b32 s31, s20, 11
  ds_read_b64_tr_b16 v[78:79], v13 offset:42240
  v_accvgpr_read_b32 v16, a176
  v_accvgpr_read_b32 v17, a177
  v_mfma_f32_16x16x32_bf16 v[148:151], v[44:47], v[228:231], v[148:151]
  s_add_u32 s31, s31, 2621440
  ds_read_b128 v[240:243], v14 offset:32768
  v_accvgpr_read_b32 v18, a178
  v_accvgpr_read_b32 v19, a179
  v_mfma_f32_16x16x32_bf16 v[164:167], v[48:51], v[228:231], v[164:167]
  s_cmp_eq_u32 s2, 255
  s_cselect_b32 s31, s31, 1073741824
  ds_read_b128 v[244:247], v14 offset:33792
  v_accvgpr_read_b32 v20, a180
  v_accvgpr_read_b32 v21, a181
  v_mfma_f32_16x16x32_bf16 v[180:183], v[52:55], v[228:231], v[180:183]
  v_accvgpr_read_b32 v22, a182
  v_accvgpr_read_b32 v23, a183
  v_mul_f32 v16, s76, v16
  v_mfma_f32_16x16x32_bf16 v[196:199], v[56:59], v[228:231], v[196:199]
  ds_read_b64_tr_b16 v[80:81], v12 offset:41472
  v_mul_f32 v17, s76, v17
  v_mfma_f32_16x16x32_bf16 v[212:215], v[60:63], v[228:231], v[212:215]
  ds_read_b64_tr_b16 v[82:83], v12 offset:42496
  v_mul_f32 v18, s76, v18
  v_mul_f32 v19, s76, v19
  v_mfma_f32_16x16x32_bf16 v[104:107], v[32:35], v[232:235], v[104:107]
  ds_read_b64_tr_b16 v[84:85], v13 offset:41472
  v_mul_f32 v20, s76, v20
  v_mul_f32 v21, s76, v21
  v_mfma_f32_16x16x32_bf16 v[120:123], v[36:39], v[232:235], v[120:123]
  ds_read_b64_tr_b16 v[86:87], v13 offset:42496
  v_mul_f32 v22, s76, v22
  v_mul_f32 v23, s76, v23
  v_mfma_f32_16x16x32_bf16 v[136:139], v[40:43], v[232:235], v[136:139]
  v_cvt_pk_bf16_f32 v24, v16, v17
  v_cvt_pk_bf16_f32 v25, v18, v19
  v_cvt_pk_bf16_f32 v26, v20, v21
  v_mfma_f32_16x16x32_bf16 v[152:155], v[44:47], v[232:235], v[152:155]
  ds_read_b64_tr_b16 v[88:89], v12 offset:41728
  v_cvt_pk_bf16_f32 v27, v22, v23
  v_mfma_f32_16x16x32_bf16 v[168:171], v[48:51], v[232:235], v[168:171]
  ds_read_b64_tr_b16 v[90:91], v12 offset:42752
  buffer_store_dwordx4 v[24:27], v2, s[40:43], s64 offen offset:2048 sc1
  v_accvgpr_read_b32 v16, a184
  v_mfma_f32_16x16x32_bf16 v[184:187], v[52:55], v[232:235], v[184:187]
  ds_read_b64_tr_b16 v[92:93], v13 offset:41728
  v_accvgpr_read_b32 v17, a185
  v_accvgpr_read_b32 v18, a186
  v_mfma_f32_16x16x32_bf16 v[200:203], v[56:59], v[232:235], v[200:203]
  ds_read_b64_tr_b16 v[94:95], v13 offset:42752
  v_accvgpr_read_b32 v19, a187
  v_accvgpr_read_b32 v20, a188
  v_mfma_f32_16x16x32_bf16 v[216:219], v[60:63], v[232:235], v[216:219]
  v_accvgpr_read_b32 v21, a189
  v_accvgpr_read_b32 v22, a190
  v_accvgpr_read_b32 v23, a191
  v_mfma_f32_16x16x32_bf16 v[108:111], v[32:35], v[236:239], v[108:111]
  ds_read_b128 v[248:251], v14 offset:34816
  v_mul_f32 v16, s76, v16
  v_mfma_f32_16x16x32_bf16 v[124:127], v[36:39], v[236:239], v[124:127]
  ds_read_b128 v[252:255], v14 offset:35840
  v_mul_f32 v17, s76, v17
  v_mul_f32 v18, s76, v18
  v_mfma_f32_16x16x32_bf16 v[140:143], v[40:43], v[236:239], v[140:143]
  v_mul_f32 v19, s76, v19
  v_mul_f32 v20, s76, v20
  v_mul_f32 v21, s76, v21
  v_mfma_f32_16x16x32_bf16 v[156:159], v[44:47], v[236:239], v[156:159]
  v_xor_b32 v14, 0x10000, v14
  v_mul_f32 v22, s76, v22
  v_mul_f32 v23, s76, v23
  v_mfma_f32_16x16x32_bf16 v[172:175], v[48:51], v[236:239], v[172:175]
  v_cvt_pk_bf16_f32 v28, v16, v17
  v_cvt_pk_bf16_f32 v29, v18, v19
  v_cvt_pk_bf16_f32 v30, v20, v21
  v_mfma_f32_16x16x32_bf16 v[188:191], v[52:55], v[236:239], v[188:191]
  v_xor_b32 v12, 0x10000, v12
  v_cvt_pk_bf16_f32 v31, v22, v23
  v_mfma_f32_16x16x32_bf16 v[204:207], v[56:59], v[236:239], v[204:207]
  buffer_store_dwordx4 v[28:31], v2, s[40:43], s64 offen offset:3072 sc1
  v_xor_b32 v13, 0x10000, v13
  v_mfma_f32_16x16x32_bf16 v[220:223], v[60:63], v[236:239], v[220:223]
  s_waitcnt vmcnt(9) lgkmcnt(0)
  v_mfma_f32_16x16x32_bf16 v[96:99], v[64:67], v[240:243], v[96:99]
  s_barrier
  buffer_load_dwordx4 v[232:235], v2, s[40:43], s31 offen sc1
  v_cmp_eq_u32 vcc, 0, v15
  v_mfma_f32_16x16x32_bf16 v[112:115], v[68:71], v[240:243], v[112:115]
  s_cbranch_vccnz fa_kv_spin
fa_kv_ok:
  buffer_load_dwordx4 v[236:239], v2, s[40:43], s31 offen offset:1024 sc1
  v_mfma_f32_16x16x32_bf16 v[128:131], v[72:75], v[240:243], v[128:131]
  s_mov_b32 m0, s24
  v_mov_b32 v228, 0
  v_mfma_f32_16x16x32_bf16 v[144:147], v[76:79], v[240:243], v[144:147]
  buffer_load_dwordx4 v2, s[44:47], s26 offen offset:0 sc1 lds
  v_mfma_f32_16x16x32_bf16 v[160:163], v[80:83], v[240:243], v[160:163]
  s_add_u32 s24, s24, 32768
  v_mov_b32 v229, 0
  v_mfma_f32_16x16x32_bf16 v[176:179], v[84:87], v[240:243], v[176:179]
  s_and_b32 s24, s24, 0x1ffff
  buffer_load_dwordx4 v2, s[44:47], s26 offen offset:1024 sc1 lds
  v_mfma_f32_16x16x32_bf16 v[192:195], v[88:91], v[240:243], v[192:195]
  v_mov_b32 v230, 0
  v_mfma_f32_16x16x32_bf16 v[208:211], v[92:95], v[240:243], v[208:211]
  buffer_load_dwordx4 v2, s[44:47], s26 offen offset:2048 sc1 lds
  v_mfma_f32_16x16x32_bf16 v[100:103], v[64:67], v[244:247], v[100:103]
  v_mov_b32 v231, 0
  v_mfma_f32_16x16x32_bf16 v[116:119], v[68:71], v[244:247], v[116:119]
  buffer_load_dwordx4 v2, s[44:47], s26 offen offset:3072 sc1 lds
  v_mfma_f32_16x16x32_bf16 v[132:135], v[72:75], v[244:247], v[132:135]
  s_add_u32 s26, s26, 16384
  v_cvt_pk_bf16_f32 v32, v96, v97
  v_cvt_pk_bf16_f32 v33, v98, v99
  v_mfma_f32_16x16x32_bf16 v[148:151], v[76:79], v[244:247], v[148:151]
  v_cvt_pk_bf16_f32 v34, v112, v113
  v_cvt_pk_bf16_f32 v35, v114, v115
  v_mfma_f32_16x16x32_bf16 v[164:167], v[80:83], v[244:247], v[164:167]
  s_mov_b32 m0, s24
  v_cvt_pk_bf16_f32 v40, v128, v129
  v_mfma_f32_16x16x32_bf16 v[180:183], v[84:87], v[244:247], v[180:183]
  buffer_load_dwordx4 v2, s[44:47], s26 offen offset:0 sc1 lds
  v_cvt_pk_bf16_f32 v41, v130, v131
  v_cvt_pk_bf16_f32 v42, v144, v145
  v_mfma_f32_16x16x32_bf16 v[196:199], v[88:91], v[244:247], v[196:199]
  s_add_u32 s24, s24, 32768
  v_cvt_pk_bf16_f32 v43, v146, v147
  v_mfma_f32_16x16x32_bf16 v[212:215], v[92:95], v[244:247], v[212:215]
  s_and_b32 s24, s24, 0x1ffff
  buffer_load_dwordx4 v2, s[44:47], s26 offen offset:1024 sc1 lds
  v_cvt_pk_bf16_f32 v48, v160, v161
  v_cvt_pk_bf16_f32 v49, v162, v163
  v_mfma_f32_16x16x32_bf16 v[104:107], v[64:67], v[248:251], v[104:107]
  v_cvt_pk_bf16_f32 v50, v176, v177
  v_cvt_pk_bf16_f32 v51, v178, v179
  v_mfma_f32_16x16x32_bf16 v[120:123], v[68:71], v[248:251], v[120:123]
  buffer_load_dwordx4 v2, s[44:47], s26 offen offset:2048 sc1 lds
  v_cvt_pk_bf16_f32 v56, v192, v193
  v_mfma_f32_16x16x32_bf16 v[136:139], v[72:75], v[248:251], v[136:139]
  v_cvt_pk_bf16_f32 v57, v194, v195
  v_cvt_pk_bf16_f32 v58, v208, v209
  v_mfma_f32_16x16x32_bf16 v[152:155], v[76:79], v[248:251], v[152:155]
  buffer_load_dwordx4 v2, s[44:47], s26 offen offset:3072 sc1 lds
  v_cvt_pk_bf16_f32 v59, v210, v211
  v_mfma_f32_16x16x32_bf16 v[168:171], v[80:83], v[248:251], v[168:171]
  s_add_u32 s26, s26, 16384
  v_cvt_pk_bf16_f32 v36, v100, v101
  v_cvt_pk_bf16_f32 v37, v102, v103
  v_mfma_f32_16x16x32_bf16 v[184:187], v[84:87], v[248:251], v[184:187]
  v_cvt_pk_bf16_f32 v38, v116, v117
  v_mfma_f32_16x16x32_bf16 v[200:203], v[88:91], v[248:251], v[200:203]
  s_mov_b32 m0, s24
  v_cvt_pk_bf16_f32 v39, v118, v119
  v_cvt_pk_bf16_f32 v44, v132, v133
  v_mfma_f32_16x16x32_bf16 v[216:219], v[92:95], v[248:251], v[216:219]
  buffer_load_dwordx4 v2, s[44:47], s26 offen offset:0 sc1 lds
  v_cvt_pk_bf16_f32 v45, v134, v135
  v_mfma_f32_16x16x32_bf16 v[108:111], v[64:67], v[252:255], v[108:111]
  s_add_u32 s24, s24, 32768
  v_cvt_pk_bf16_f32 v46, v148, v149
  v_cvt_pk_bf16_f32 v47, v150, v151
  v_mfma_f32_16x16x32_bf16 v[124:127], v[68:71], v[252:255], v[124:127]
  s_and_b32 s24, s24, 0x1ffff
  buffer_load_dwordx4 v2, s[44:47], s26 offen offset:1024 sc1 lds
  v_cvt_pk_bf16_f32 v52, v164, v165
  v_mfma_f32_16x16x32_bf16 v[140:143], v[72:75], v[252:255], v[140:143]
  v_cvt_pk_bf16_f32 v53, v166, v167
  v_cvt_pk_bf16_f32 v54, v180, v181
  v_mfma_f32_16x16x32_bf16 v[156:159], v[76:79], v[252:255], v[156:159]
  buffer_load_dwordx4 v2, s[44:47], s26 offen offset:2048 sc1 lds
  v_cvt_pk_bf16_f32 v55, v182, v183
  v_mfma_f32_16x16x32_bf16 v[172:175], v[80:83], v[252:255], v[172:175]
  v_cvt_pk_bf16_f32 v60, v196, v197
  v_cvt_pk_bf16_f32 v61, v198, v199
  v_mfma_f32_16x16x32_bf16 v[188:191], v[84:87], v[252:255], v[188:191]
  buffer_load_dwordx4 v2, s[44:47], s26 offen offset:3072 sc1 lds
  v_cvt_pk_bf16_f32 v62, v212, v213
  v_mfma_f32_16x16x32_bf16 v[204:207], v[88:91], v[252:255], v[204:207]
  s_add_u32 s26, s26, 16384
  v_cvt_pk_bf16_f32 v63, v214, v215
  v_mfma_f32_16x16x32_bf16 v[220:223], v[92:95], v[252:255], v[220:223]
  s_mov_b32 m0, s25
  s_nop 0
  v_mfma_f32_32x32x16_bf16 a[0:15], v[228:231], v[228:231], 0
  buffer_load_dwordx4 v2, s[48:51], s27 offen offset:0 sc1 lds
  v_cvt_pk_bf16_f32 v64, v104, v105
  v_cvt_pk_bf16_f32 v65, v106, v107
  v_cvt_pk_bf16_f32 v66, v120, v121
  v_cvt_pk_bf16_f32 v67, v122, v123
  v_mfma_f32_32x32x16_bf16 a[16:31], v[228:231], v[228:231], 0
  buffer_load_dwordx4 v2, s[48:51], s27 offen offset:1024 sc1 lds
  v_cvt_pk_bf16_f32 v72, v136, v137
  v_cvt_pk_bf16_f32 v73, v138, v139
  v_cvt_pk_bf16_f32 v74, v152, v153
  v_cvt_pk_bf16_f32 v75, v154, v155
  v_mfma_f32_32x32x16_bf16 a[32:47], v[228:231], v[228:231], 0
  buffer_load_dwordx4 v2, s[48:51], s27 offen offset:2048 sc1 lds
  v_cvt_pk_bf16_f32 v80, v168, v169
  v_cvt_pk_bf16_f32 v81, v170, v171
  v_cvt_pk_bf16_f32 v82, v184, v185
  v_cvt_pk_bf16_f32 v83, v186, v187
  v_mfma_f32_32x32x16_bf16 a[48:63], v[228:231], v[228:231], 0
  buffer_load_dwordx4 v2, s[48:51], s27 offen offset:3072 sc1 lds
  v_cvt_pk_bf16_f32 v88, v200, v201
  v_cvt_pk_bf16_f32 v89, v202, v203
  v_cvt_pk_bf16_f32 v90, v216, v217
  v_cvt_pk_bf16_f32 v91, v218, v219
  s_add_u32 s27, s27, 16384
  s_add_u32 s25, s25, 32768
  s_and_b32 s25, s25, 0x1ffff
  s_mov_b32 m0, s25
  s_nop 0
  v_mfma_f32_32x32x16_bf16 a[64:79], v[228:231], v[228:231], 0
  buffer_load_dwordx4 v2, s[48:51], s27 offen offset:0 sc1 lds
  v_cvt_pk_bf16_f32 v68, v108, v109
  v_cvt_pk_bf16_f32 v69, v110, v111
  v_cvt_pk_bf16_f32 v70, v124, v125
  v_cvt_pk_bf16_f32 v71, v126, v127
  v_mfma_f32_32x32x16_bf16 a[80:95], v[228:231], v[228:231], 0
  buffer_load_dwordx4 v2, s[48:51], s27 offen offset:1024 sc1 lds
  v_cvt_pk_bf16_f32 v76, v140, v141
  v_cvt_pk_bf16_f32 v77, v142, v143
  v_cvt_pk_bf16_f32 v78, v156, v157
  v_cvt_pk_bf16_f32 v79, v158, v159
  v_mfma_f32_32x32x16_bf16 a[96:111], v[228:231], v[228:231], 0
  buffer_load_dwordx4 v2, s[48:51], s27 offen offset:2048 sc1 lds
  v_cvt_pk_bf16_f32 v84, v172, v173
  v_cvt_pk_bf16_f32 v85, v174, v175
  v_cvt_pk_bf16_f32 v86, v188, v189
  v_cvt_pk_bf16_f32 v87, v190, v191
  v_mfma_f32_32x32x16_bf16 a[112:127], v[228:231], v[228:231], 0
  buffer_load_dwordx4 v2, s[48:51], s27 offen offset:3072 sc1 lds
  v_cvt_pk_bf16_f32 v92, v204, v205
  v_cvt_pk_bf16_f32 v93, v206, v207
  v_cvt_pk_bf16_f32 v94, v220, v221
  v_cvt_pk_bf16_f32 v95, v222, v223
  s_add_u32 s27, s27, 16384
  s_add_u32 s25, s25, 32768
  s_and_b32 s25, s25, 0x1ffff
  s_waitcnt vmcnt(12)
  s_barrier
  ds_read_b128 a[128:131], v9 offset:0
  ds_read_b128 a[132:135], v9 offset:1024
  ds_read_b128 a[136:139], v9 offset:2048
  ds_read_b128 a[140:143], v9 offset:3072
  ds_read_b128 a[144:147], v9 offset:4096
  ds_read_b128 a[148:151], v9 offset:5120
  ds_read_b128 a[152:155], v9 offset:6144
  ds_read_b128 a[156:159], v9 offset:7168
  buffer_store_dword v4, off, s[40:43], s65 offset:32 sc1
  v_add_u32 v13, 32, v8
  v_mov_b32 v14, 0
  s_cmp_eq_u32 s2, 255
  s_cbranch_scc1 fa_top8
fa_notop:
  s_waitcnt lgkmcnt(4)
  v_mfma_f32_16x16x32_bf16 v[96:99], a[128:131], v[32:35], 0
  v_mfma_f32_16x16x32_bf16 v[104:107], a[128:131], v[36:39], 0
  v_mfma_f32_16x16x32_bf16 v[128:131], a[128:131], v[64:67], 0
  v_mfma_f32_16x16x32_bf16 v[136:139], a[128:131], v[68:71], 0
  s_mov_b32 m0, s24
  ds_read_b128 a[128:131], v3 offset:0
  v_mfma_f32_16x16x32_bf16 v[100:103], a[132:135], v[32:35], 0
  buffer_load_dwordx4 v2, s[44:47], s26 offen offset:0 sc1 lds
  v_mfma_f32_16x16x32_bf16 v[108:111], a[132:135], v[36:39], 0
  v_mfma_f32_16x16x32_bf16 v[132:135], a[132:135], v[64:67], 0
  v_mfma_f32_16x16x32_bf16 v[140:143], a[132:135], v[68:71], 0
  ds_read_b128 a[132:135], v3 offset:1024
  v_mfma_f32_16x16x32_bf16 v[96:99], a[136:139], v[40:43], v[96:99]
  v_mfma_f32_16x16x32_bf16 v[104:107], a[136:139], v[44:47], v[104:107]
  v_mfma_f32_16x16x32_bf16 v[128:131], a[136:139], v[72:75], v[128:131]
  buffer_load_dwordx4 v2, s[44:47], s26 offen offset:1024 sc1 lds
  v_mfma_f32_16x16x32_bf16 v[136:139], a[136:139], v[76:79], v[136:139]
  ds_read_b128 a[136:139], v3 offset:2048
  v_mfma_f32_16x16x32_bf16 v[100:103], a[140:143], v[40:43], v[100:103]
  v_mfma_f32_16x16x32_bf16 v[108:111], a[140:143], v[44:47], v[108:111]
  v_mfma_f32_16x16x32_bf16 v[132:135], a[140:143], v[72:75], v[132:135]
  v_mfma_f32_16x16x32_bf16 v[140:143], a[140:143], v[76:79], v[140:143]
  s_waitcnt lgkmcnt(3)
  ds_read_b128 a[140:143], v3 offset:3072
  v_mfma_f32_16x16x32_bf16 v[96:99], a[144:147], v[48:51], v[96:99]
  v_mfma_f32_16x16x32_bf16 v[104:107], a[144:147], v[52:55], v[104:107]
  v_mfma_f32_16x16x32_bf16 v[128:131], a[144:147], v[80:83], v[128:131]
  buffer_load_dwordx4 v2, s[44:47], s26 offen offset:2048 sc1 lds
  v_mfma_f32_16x16x32_bf16 v[136:139], a[144:147], v[84:87], v[136:139]
  ds_read_b128 a[144:147], v3 offset:4096
  v_mfma_f32_16x16x32_bf16 v[100:103], a[148:151], v[48:51], v[100:103]
  v_mfma_f32_16x16x32_bf16 v[108:111], a[148:151], v[52:55], v[108:111]
  v_mfma_f32_16x16x32_bf16 v[132:135], a[148:151], v[80:83], v[132:135]
  v_mfma_f32_16x16x32_bf16 v[140:143], a[148:151], v[84:87], v[140:143]
  ds_read_b128 a[148:151], v3 offset:5120
  v_mfma_f32_16x16x32_bf16 v[96:99], a[152:155], v[56:59], v[96:99]
  buffer_load_dwordx4 v2, s[44:47], s26 offen offset:3072 sc1 lds
  v_mfma_f32_16x16x32_bf16 v[104:107], a[152:155], v[60:63], v[104:107]
  s_add_u32 s26, s26, 16384
  v_mfma_f32_16x16x32_bf16 v[128:131], a[152:155], v[88:91], v[128:131]
  s_add_u32 s24, s24, 32768
  v_mfma_f32_16x16x32_bf16 v[136:139], a[152:155], v[92:95], v[136:139]
  s_and_b32 s24, s24, 0x1ffff
  ds_read_b128 a[152:155], v3 offset:6144
  v_mfma_f32_16x16x32_bf16 v[100:103], a[156:159], v[56:59], v[100:103]
  v_mfma_f32_16x16x32_bf16 v[108:111], a[156:159], v[60:63], v[108:111]
  v_mfma_f32_16x16x32_bf16 v[132:135], a[156:159], v[88:91], v[132:135]
  v_mfma_f32_16x16x32_bf16 v[140:143], a[156:159], v[92:95], v[140:143]
  s_waitcnt lgkmcnt(3)
  ds_read_b128 a[156:159], v3 offset:7168
  s_nop 7
  s_cmp_lg_u32 s28, 0
  s_cbranch_scc1 fa_nomask0
  v_cndmask_b32 v96, v4, v96, s[68:69]
  v_cndmask_b32 v97, v4, v97, s[70:71]
  v_cndmask_b32 v98, v4, v98, s[72:73]
  v_cndmask_b32 v99, v4, v99, s[74:75]
  v_mov_b32 v100, v4
  v_mov_b32 v101, v4
  v_mov_b32 v102, v4
  v_mov_b32 v103, v4
  v_cndmask_b32 v108, v4, v108, s[68:69]
  v_cndmask_b32 v109, v4, v109, s[70:71]
  v_cndmask_b32 v110, v4, v110, s[72:73]
  v_cndmask_b32 v111, v4, v111, s[74:75]
fa_nomask0:
  v_max3_f32 v16, v96, v97, v98
  v_max3_f32 v16, v16, v99, v100
  v_max3_f32 v16, v16, v101, v102
  v_max_f32 v16, v16, v103
  v_max3_f32 v17, v104, v105, v106
  v_max3_f32 v17, v17, v107, v108
  v_max3_f32 v17, v17, v109, v110
  v_max_f32 v17, v17, v111
  v_max3_f32 v18, v128, v129, v130
  v_max3_f32 v18, v18, v131, v132
  v_max3_f32 v18, v18, v133, v134
  v_max_f32 v18, v18, v135
  v_max3_f32 v19, v136, v137, v138
  v_max3_f32 v19, v19, v139, v140
  v_max3_f32 v19, v19, v141, v142
  v_max_f32 v19, v19, v143
  v_mov_b32 v20, v16
  v_mov_b32 v21, v17
  v_mov_b32 v22, v18
  v_mov_b32 v23, v19
  s_nop 0
  v_permlane16_swap_b32 v16, v20
  v_permlane16_swap_b32 v17, v21
  v_permlane16_swap_b32 v18, v22
  v_permlane16_swap_b32 v19, v23
  v_max_f32 v16, v16, v20
  v_max_f32 v17, v17, v21
  v_max_f32 v18, v18, v22
  v_max_f32 v19, v19, v23
  v_mov_b32 v20, v16
  v_mov_b32 v21, v17
  v_mov_b32 v22, v18
  v_mov_b32 v23, v19
  s_nop 0
  v_permlane32_swap_b32 v16, v20
  v_permlane32_swap_b32 v17, v21
  v_permlane32_swap_b32 v18, v22
  v_permlane32_swap_b32 v19, v23
  v_max_f32 v16, v16, v20
  v_max_f32 v17, v17, v21
  v_max_f32 v18, v18, v22
  v_max_f32 v19, v19, v23
  v_sub_f32 v192, 0, v16
  v_sub_f32 v193, 0, v16
  v_sub_f32 v194, 0, v16
  v_sub_f32 v195, 0, v16
  v_sub_f32 v196, 0, v17
  v_sub_f32 v197, 0, v17
  v_sub_f32 v198, 0, v17
  v_sub_f32 v199, 0, v17
  v_sub_f32 v200, 0, v18
  v_sub_f32 v201, 0, v18
  v_sub_f32 v202, 0, v18
  v_sub_f32 v203, 0, v18
  v_sub_f32 v204, 0, v19
  v_sub_f32 v205, 0, v19
  v_sub_f32 v206, 0, v19
  v_sub_f32 v207, 0, v19
  v_sub_f32 v96, v96, v16
  v_sub_f32 v97, v97, v16
  v_sub_f32 v98, v98, v16
  v_sub_f32 v99, v99, v16
  v_sub_f32 v100, v100, v16
  v_sub_f32 v101, v101, v16
  v_sub_f32 v102, v102, v16
  v_sub_f32 v103, v103, v16
  v_sub_f32 v104, v104, v17
  v_sub_f32 v105, v105, v17
  v_sub_f32 v106, v106, v17
  v_sub_f32 v107, v107, v17
  v_sub_f32 v108, v108, v17
  v_sub_f32 v109, v109, v17
  v_sub_f32 v110, v110, v17
  v_sub_f32 v111, v111, v17
  v_sub_f32 v128, v128, v18
  v_sub_f32 v129, v129, v18
  v_sub_f32 v130, v130, v18
  v_sub_f32 v131, v131, v18
  v_sub_f32 v132, v132, v18
  v_sub_f32 v133, v133, v18
  v_sub_f32 v134, v134, v18
  v_sub_f32 v135, v135, v18
  v_sub_f32 v136, v136, v19
  v_sub_f32 v137, v137, v19
  v_sub_f32 v138, v138, v19
  v_sub_f32 v139, v139, v19
  v_sub_f32 v140, v140, v19
  v_sub_f32 v141, v141, v19
  v_sub_f32 v142, v142, v19
  v_sub_f32 v143, v143, v19
  v_mfma_f32_16x16x32_bf16 v[112:115], a[128:131], v[32:35], v[192:195]
  v_exp_f32 v216, v128
  v_exp_f32 v217, v129
  v_mfma_f32_16x16x32_bf16 v[120:123], a[128:131], v[36:39], v[196:199]
  v_exp_f32 v218, v130
  v_add_f32 v226, v216, v217
  v_cvt_pk_bf16_f32 v176, v216, v217
  v_mfma_f32_16x16x32_bf16 v[144:147], a[128:131], v[64:67], v[200:203]
  s_add_u32 s66, s66, 32768
  v_exp_f32 v219, v131
  v_add_f32 v226, v226, v218
  v_add_f32 v226, v226, v219
  v_mfma_f32_16x16x32_bf16 v[152:155], a[128:131], v[68:71], v[204:207]
  s_mov_b32 m0, s25
  ds_read_b128 a[128:131], v3 offset:8192
  v_exp_f32 v220, v132
  v_cvt_pk_bf16_f32 v177, v218, v219
  v_mfma_f32_16x16x32_bf16 v[116:119], a[132:135], v[32:35], v[192:195]
  s_and_b32 s66, s66, 0x1ffff
  buffer_load_dwordx4 v2, s[48:51], s27 offen offset:0 sc1 lds
  v_exp_f32 v221, v133
  v_add_f32 v226, v226, v220
  v_add_f32 v226, v226, v221
  v_mfma_f32_16x16x32_bf16 v[124:127], a[132:135], v[36:39], v[196:199]
  v_exp_f32 v222, v134
  v_cvt_pk_bf16_f32 v178, v220, v221
  v_exp_f32 v223, v135
  v_mfma_f32_16x16x32_bf16 v[148:151], a[132:135], v[64:67], v[200:203]
  v_exp_f32 v216, v136
  v_add_f32 v226, v226, v222
  v_mfma_f32_16x16x32_bf16 v[156:159], a[132:135], v[68:71], v[204:207]
  ds_read_b128 a[132:135], v3 offset:9216
  v_exp_f32 v217, v137
  v_add_f32 v226, v226, v223
  v_mfma_f32_16x16x32_bf16 v[112:115], a[136:139], v[40:43], v[112:115]
  v_exp_f32 v218, v138
  v_cvt_pk_bf16_f32 v179, v222, v223
  v_add_f32 v227, v216, v217
  v_mfma_f32_16x16x32_bf16 v[120:123], a[136:139], v[44:47], v[120:123]
  v_exp_f32 v219, v139
  v_cvt_pk_bf16_f32 v180, v216, v217
  v_add_f32 v227, v227, v218
  v_add_f32 v227, v227, v219
  v_mfma_f32_16x16x32_bf16 v[144:147], a[136:139], v[72:75], v[144:147]
  buffer_load_dwordx4 v2, s[48:51], s27 offen offset:1024 sc1 lds
  v_exp_f32 v220, v140
  v_cvt_pk_bf16_f32 v181, v218, v219
  v_mfma_f32_16x16x32_bf16 v[152:155], a[136:139], v[76:79], v[152:155]
  ds_read_b128 a[136:139], v3 offset:10240
  v_exp_f32 v221, v141
  v_add_f32 v227, v227, v220
  v_mfma_f32_16x16x32_bf16 v[116:119], a[140:143], v[40:43], v[116:119]
  v_exp_f32 v222, v142
  v_add_f32 v227, v227, v221
  v_cvt_pk_bf16_f32 v182, v220, v221
  v_mfma_f32_16x16x32_bf16 v[124:127], a[140:143], v[44:47], v[124:127]
  v_exp_f32 v223, v143
  v_add_f32 v227, v227, v222
  v_add_f32 v227, v227, v223
  v_exp_f32 v208, v96
  v_mfma_f32_16x16x32_bf16 v[148:151], a[140:143], v[72:75], v[148:151]
  v_exp_f32 v209, v97
  v_cvt_pk_bf16_f32 v183, v222, v223
  v_mfma_f32_16x16x32_bf16 v[156:159], a[140:143], v[76:79], v[156:159]
  s_waitcnt lgkmcnt(3)
  ds_read_b128 a[140:143], v3 offset:11264
  v_exp_f32 v210, v98
  v_add_f32 v224, v208, v209
  v_mfma_f32_16x16x32_bf16 v[112:115], a[144:147], v[48:51], v[112:115]
  v_exp_f32 v211, v99
  v_cvt_pk_bf16_f32 v160, v208, v209
  v_add_f32 v224, v224, v210
  v_mfma_f32_16x16x32_bf16 v[120:123], a[144:147], v[52:55], v[120:123]
  v_exp_f32 v212, v100
  v_add_f32 v224, v224, v211
  v_cvt_pk_bf16_f32 v161, v210, v211
  v_mfma_f32_16x16x32_bf16 v[144:147], a[144:147], v[80:83], v[144:147]
  buffer_load_dwordx4 v2, s[48:51], s27 offen offset:2048 sc1 lds
  v_exp_f32 v213, v101
  v_add_f32 v224, v224, v212
  v_add_f32 v224, v224, v213
  v_mfma_f32_16x16x32_bf16 v[152:155], a[144:147], v[84:87], v[152:155]
  ds_read_b128 a[144:147], v3 offset:12288
  v_exp_f32 v214, v102
  v_cvt_pk_bf16_f32 v162, v212, v213
  v_mfma_f32_16x16x32_bf16 v[116:119], a[148:151], v[48:51], v[116:119]
  v_exp_f32 v215, v103
  v_add_f32 v224, v224, v214
  v_add_f32 v224, v224, v215
  v_mfma_f32_16x16x32_bf16 v[124:127], a[148:151], v[52:55], v[124:127]
  v_exp_f32 v208, v104
  v_exp_f32 v209, v105
  v_mfma_f32_16x16x32_bf16 v[148:151], a[148:151], v[80:83], v[148:151]
  v_exp_f32 v210, v106
  v_cvt_pk_bf16_f32 v163, v214, v215
  v_add_f32 v225, v208, v209
  v_mfma_f32_16x16x32_bf16 v[156:159], a[148:151], v[84:87], v[156:159]
  ds_read_b128 a[148:151], v3 offset:13312
  v_exp_f32 v211, v107
  v_cvt_pk_bf16_f32 v164, v208, v209
  v_add_f32 v225, v225, v210
  v_mfma_f32_16x16x32_bf16 v[112:115], a[152:155], v[56:59], v[112:115]
  buffer_load_dwordx4 v2, s[48:51], s27 offen offset:3072 sc1 lds
  v_exp_f32 v212, v108
  v_add_f32 v225, v225, v211
  v_mfma_f32_16x16x32_bf16 v[120:123], a[152:155], v[60:63], v[120:123]
  s_add_u32 s27, s27, 16384
  v_exp_f32 v213, v109
  v_mfma_f32_16x16x32_bf16 v[144:147], a[152:155], v[88:91], v[144:147]
  s_add_u32 s25, s25, 32768
  v_exp_f32 v214, v110
  v_mfma_f32_16x16x32_bf16 v[152:155], a[152:155], v[92:95], v[152:155]
  s_and_b32 s25, s25, 0x1ffff
  ds_read_b128 a[152:155], v3 offset:14336
  v_cvt_pk_bf16_f32 v165, v210, v211
  v_max3_f32 v5, v226, v227, v224
  v_add_f32 v225, v225, v212
  v_add_f32 v225, v225, v213
  v_cvt_pk_bf16_f32 v166, v212, v213
  v_exp_f32 v215, v111
  v_mfma_f32_16x16x32_bf16 v[116:119], a[156:159], v[56:59], v[116:119]
  v_add_f32 v225, v225, v214
  v_add_f32 v225, v225, v215
  v_max_f32 v5, v5, v225
  v_cmp_lt_f32 vcc, s81, v5
  v_mfma_f32_16x16x32_bf16 v[124:127], a[156:159], v[60:63], v[124:127]
  v_mfma_f32_16x16x32_bf16 v[148:151], a[156:159], v[88:91], v[148:151]
  v_cvt_pk_bf16_f32 v167, v214, v215
  v_mfma_f32_16x16x32_bf16 v[156:159], a[156:159], v[92:95], v[156:159]
  s_waitcnt lgkmcnt(3)
  s_cbranch_vccnz fa_stub0
fa_back0:
  ds_read_b128 a[156:159], v3 offset:15360
  v_add_f32 v228, v228, v224
  v_add_f32 v229, v229, v225
  v_add_f32 v230, v230, v226
  v_add_f32 v231, v231, v227
  s_nop 3
  v_exp_f32 v216, v144
  v_exp_f32 v217, v145
  v_add_u32 v3, s66, v2
  buffer_load_dword v14, v13, s[40:43], 0 offen sc1
  s_cmp_eq_u32 s28, 0
  s_cbranch_scc1 fa_AV
  s_sub_u32 s28, s28, 1
  s_cmp_eq_u32 s28, 0
  s_cbranch_scc1 fa_Aexit
.p2align 6
fa_DD:
  v_mfma_f32_16x16x32_bf16 v[96:99], a[128:131], v[32:35], v[192:195]
  s_waitcnt vmcnt(12)
  v_exp_f32 v218, v146
  v_mfma_f32_16x16x32_bf16 v[104:107], a[128:131], v[36:39], v[196:199]
  s_barrier
  v_exp_f32 v219, v147
  v_mfma_f32_16x16x32_bf16 v[128:131], a[128:131], v[64:67], v[200:203]
  s_cmp_ge_u32 s26, s32
  ds_read_b128 a[160:163], v3 offset:16384
  v_add_f32 v226, v216, v217
  v_mfma_f32_16x16x32_bf16 v[136:139], a[128:131], v[68:71], v[204:207]
  s_cbranch_scc1 fa_hk4
fa_hb4:
  v_exp_f32 v220, v148
  v_mfma_f32_16x16x32_bf16 v[100:103], a[132:135], v[32:35], v[192:195]
  ds_read_b128 a[164:167], v3 offset:17408
  v_cvt_pk_bf16_f32 v184, v216, v217
  v_mfma_f32_16x16x32_bf16 v[108:111], a[132:135], v[36:39], v[196:199]
  s_mov_b32 m0, s24
  v_exp_f32 v221, v149
  v_mfma_f32_16x16x32_bf16 v[132:135], a[132:135], v[64:67], v[200:203]
  buffer_load_dwordx4 v2, s[44:47], s26 offen offset:0 sc1 lds
  v_add_f32 v226, v226, v218
  v_mfma_f32_16x16x32_bf16 v[140:143], a[132:135], v[68:71], v[204:207]
  v_exp_f32 v222, v150
  v_mfma_f32_16x16x32_bf16 v[96:99], a[136:139], v[40:43], v[96:99]
  ds_read_b128 a[168:171], v3 offset:18432
  v_add_f32 v226, v226, v219
  v_mfma_f32_16x16x32_bf16 v[104:107], a[136:139], v[44:47], v[104:107]
  v_exp_f32 v223, v151
  v_mfma_f32_16x16x32_bf16 v[128:131], a[136:139], v[72:75], v[128:131]
  v_cvt_pk_bf16_f32 v185, v218, v219
  v_add_f32 v226, v226, v220
  v_mfma_f32_16x16x32_bf16 v[136:139], a[136:139], v[76:79], v[136:139]
  v_exp_f32 v216, v152
  v_mfma_f32_16x16x32_bf16 v[100:103], a[140:143], v[40:43], v[100:103]
  ds_read_b128 a[172:175], v3 offset:19456
  v_add_f32 v226, v226, v221
  v_mfma_f32_16x16x32_bf16 v[108:111], a[140:143], v[44:47], v[108:111]
  v_exp_f32 v217, v153
  v_mfma_f32_16x16x32_bf16 v[132:135], a[140:143], v[72:75], v[132:135]
  v_cvt_pk_bf16_f32 v186, v220, v221
  v_add_f32 v226, v226, v222
  v_mfma_f32_16x16x32_bf16 v[140:143], a[140:143], v[76:79], v[140:143]
  s_waitcnt lgkmcnt(4)
  v_exp_f32 v218, v154
  v_mfma_f32_16x16x32_bf16 v[96:99], a[144:147], v[48:51], v[96:99]
  ds_read_b128 a[176:179], v3 offset:20480
  v_add_f32 v226, v226, v223
  v_mfma_f32_16x16x32_bf16 v[104:107], a[144:147], v[52:55], v[104:107]
  v_exp_f32 v219, v155
  v_mfma_f32_16x16x32_bf16 v[128:131], a[144:147], v[80:83], v[128:131]
  v_cvt_pk_bf16_f32 v187, v222, v223
  v_add_f32 v227, v216, v217
  v_mfma_f32_16x16x32_bf16 v[136:139], a[144:147], v[84:87], v[136:139]
  v_exp_f32 v220, v156
  v_mfma_f32_16x16x32_bf16 v[100:103], a[148:151], v[48:51], v[100:103]
  ds_read_b128 a[180:183], v3 offset:21504
  v_cvt_pk_bf16_f32 v188, v216, v217
  v_mfma_f32_16x16x32_bf16 v[108:111], a[148:151], v[52:55], v[108:111]
  v_exp_f32 v221, v157
  v_mfma_f32_16x16x32_bf16 v[132:135], a[148:151], v[80:83], v[132:135]
  buffer_load_dwordx4 v2, s[44:47], s26 offen offset:1024 sc1 lds
  v_add_f32 v227, v227, v218
  v_mfma_f32_16x16x32_bf16 v[140:143], a[148:151], v[84:87], v[140:143]
  v_exp_f32 v222, v158
  v_mfma_f32_16x16x32_bf16 v[96:99], a[152:155], v[56:59], v[96:99]
  ds_read_b128 a[184:187], v3 offset:22528
  v_add_f32 v227, v227, v219
  v_mfma_f32_16x16x32_bf16 v[104:107], a[152:155], v[60:63], v[104:107]
  v_exp_f32 v223, v159
  v_mfma_f32_16x16x32_bf16 v[128:131], a[152:155], v[88:91], v[128:131]
  v_cvt_pk_bf16_f32 v189, v218, v219
  v_add_f32 v227, v227, v220
  v_mfma_f32_16x16x32_bf16 v[136:139], a[152:155], v[92:95], v[136:139]
  v_exp_f32 v208, v112
  v_mfma_f32_16x16x32_bf16 v[100:103], a[156:159], v[56:59], v[100:103]
  ds_read_b128 a[188:191], v3 offset:23552
  v_add_f32 v227, v227, v221
  v_mfma_f32_16x16x32_bf16 v[108:111], a[156:159], v[60:63], v[108:111]
  v_exp_f32 v209, v113
  v_mfma_f32_16x16x32_bf16 v[132:135], a[156:159], v[88:91], v[132:135]
  v_cvt_pk_bf16_f32 v190, v220, v221
  v_add_f32 v227, v227, v222
  v_add_f32 v227, v227, v223
  v_mfma_f32_16x16x32_bf16 v[140:143], a[156:159], v[92:95], v[140:143]
  s_waitcnt lgkmcnt(4)
  v_exp_f32 v210, v114
  v_mfma_f32_16x16x32_bf16 a[0:3], a[160:163], v[160:163], a[0:3]
  ds_read_b128 a[128:131], v3 offset:0
  v_cvt_pk_bf16_f32 v191, v222, v223
  v_mfma_f32_16x16x32_bf16 a[4:7], a[160:163], v[164:167], a[4:7]
  v_exp_f32 v211, v115
  v_mfma_f32_16x16x32_bf16 a[64:67], a[160:163], v[176:179], a[64:67]
  v_exp_f32 v212, v116
  v_mfma_f32_16x16x32_bf16 a[68:71], a[160:163], v[180:183], a[68:71]
  v_add_f32 v224, v208, v209
  v_cvt_pk_bf16_f32 v168, v208, v209
  v_mfma_f32_16x16x32_bf16 a[8:11], a[164:167], v[160:163], a[8:11]
  ds_read_b128 a[132:135], v3 offset:1024
  v_add_f32 v224, v224, v210
  v_mfma_f32_16x16x32_bf16 a[12:15], a[164:167], v[164:167], a[12:15]
  v_exp_f32 v213, v117
  v_mfma_f32_16x16x32_bf16 a[72:75], a[164:167], v[176:179], a[72:75]
  buffer_load_dwordx4 v2, s[44:47], s26 offen offset:2048 sc1 lds
  v_add_f32 v224, v224, v211
  v_mfma_f32_16x16x32_bf16 a[76:79], a[164:167], v[180:183], a[76:79]
  v_exp_f32 v214, v118
  v_mfma_f32_16x16x32_bf16 a[16:19], a[168:171], v[160:163], a[16:19]
  ds_read_b128 a[136:139], v3 offset:2048
  v_cvt_pk_bf16_f32 v169, v210, v211
  v_mfma_f32_16x16x32_bf16 a[20:23], a[168:171], v[164:167], a[20:23]
  v_exp_f32 v215, v119
  v_mfma_f32_16x16x32_bf16 a[80:83], a[168:171], v[176:179], a[80:83]
  v_add_f32 v224, v224, v212
  v_add_f32 v224, v224, v213
  v_mfma_f32_16x16x32_bf16 a[84:87], a[168:171], v[180:183], a[84:87]
  v_exp_f32 v208, v120
  v_mfma_f32_16x16x32_bf16 a[24:27], a[172:175], v[160:163], a[24:27]
  ds_read_b128 a[140:143], v3 offset:3072
  v_cvt_pk_bf16_f32 v170, v212, v213
  v_mfma_f32_16x16x32_bf16 a[28:31], a[172:175], v[164:167], a[28:31]
  v_exp_f32 v209, v121
  v_mfma_f32_16x16x32_bf16 a[88:91], a[172:175], v[176:179], a[88:91]
  v_exp_f32 v210, v122
  v_mfma_f32_16x16x32_bf16 a[92:95], a[172:175], v[180:183], a[92:95]
  s_waitcnt lgkmcnt(4)
  v_add_f32 v224, v224, v214
  v_add_f32 v224, v224, v215
  v_mfma_f32_16x16x32_bf16 a[32:35], a[176:179], v[160:163], a[32:35]
  ds_read_b128 a[144:147], v3 offset:4096
  v_cvt_pk_bf16_f32 v171, v214, v215
  v_mfma_f32_16x16x32_bf16 a[36:39], a[176:179], v[164:167], a[36:39]
  v_exp_f32 v211, v123
  v_mfma_f32_16x16x32_bf16 a[96:99], a[176:179], v[176:179], a[96:99]
  v_add_f32 v225, v208, v209
  v_cvt_pk_bf16_f32 v172, v208, v209
  v_mfma_f32_16x16x32_bf16 a[100:103], a[176:179], v[180:183], a[100:103]
  v_exp_f32 v212, v124
  v_mfma_f32_16x16x32_bf16 a[40:43], a[180:183], v[160:163], a[40:43]
  ds_read_b128 a[148:151], v3 offset:5120
  v_add_f32 v225, v225, v210
  v_mfma_f32_16x16x32_bf16 a[44:47], a[180:183], v[164:167], a[44:47]
  v_exp_f32 v213, v125
  v_mfma_f32_16x16x32_bf16 a[104:107], a[180:183], v[176:179], a[104:107]
  buffer_load_dwordx4 v2, s[44:47], s26 offen offset:3072 sc1 lds
  v_add_f32 v225, v225, v211
  v_mfma_f32_16x16x32_bf16 a[108:111], a[180:183], v[180:183], a[108:111]
  s_add_u32 s26, s26, 16384
  v_exp_f32 v214, v126
  v_mfma_f32_16x16x32_bf16 a[48:51], a[184:187], v[160:163], a[48:51]
  s_add_u32 s24, s24, 32768
  ds_read_b128 a[152:155], v3 offset:6144
  v_cvt_pk_bf16_f32 v173, v210, v211
  v_mfma_f32_16x16x32_bf16 a[52:55], a[184:187], v[164:167], a[52:55]
  s_and_b32 s24, s24, 0x1ffff
  v_exp_f32 v215, v127
  v_mfma_f32_16x16x32_bf16 a[112:115], a[184:187], v[176:179], a[112:115]
  v_max3_f32 v5, v226, v227, v224
  v_add_f32 v225, v225, v212
  v_mfma_f32_16x16x32_bf16 a[116:119], a[184:187], v[180:183], a[116:119]
  v_add_f32 v225, v225, v213
  v_cvt_pk_bf16_f32 v174, v212, v213
  v_add_f32 v225, v225, v214
  v_mfma_f32_16x16x32_bf16 a[56:59], a[188:191], v[160:163], a[56:59]
  ds_read_b128 a[156:159], v3 offset:7168
  v_add_f32 v225, v225, v215
  v_max_f32 v5, v5, v225
  v_cmp_lt_f32 vcc, s81, v5
  v_mfma_f32_16x16x32_bf16 a[60:63], a[188:191], v[164:167], a[60:63]
  v_exp_f32 v216, v128
  v_mfma_f32_16x16x32_bf16 a[120:123], a[188:191], v[176:179], a[120:123]
  s_waitcnt lgkmcnt(4)
  v_cvt_pk_bf16_f32 v175, v214, v215
  v_mfma_f32_16x16x32_bf16 a[124:127], a[188:191], v[180:183], a[124:127]
  s_cbranch_vccnz fa_stub1
fa_back1:
  v_exp_f32 v217, v129
  v_add_f32 v228, v228, v224
  v_add_f32 v229, v229, v225
  v_add_f32 v230, v230, v226
  v_add_f32 v231, v231, v227
fa_DDe:
  v_mfma_f32_16x16x32_bf16 v[112:115], a[128:131], v[32:35], v[192:195]
  ds_read_b128 a[160:163], v3 offset:24576
  v_add_f32 v226, v216, v217
  v_mfma_f32_16x16x32_bf16 v[120:123], a[128:131], v[36:39], v[196:199]
  v_exp_f32 v218, v130
  v_mfma_f32_16x16x32_bf16 v[144:147], a[128:131], v[64:67], v[200:203]
  s_cmp_ge_u32 s26, s9
  v_exp_f32 v219, v131
  v_mfma_f32_16x16x32_bf16 v[152:155], a[128:131], v[68:71], v[204:207]
  s_cbranch_scc1 fa_hk5
fa_hb5:
  v_exp_f32 v220, v132
  v_mfma_f32_16x16x32_bf16 v[116:119], a[132:135], v[32:35], v[192:195]
  s_add_u32 s66, s66, 32768
  ds_read_b128 a[164:167], v3 offset:25600
  v_cvt_pk_bf16_f32 v176, v216, v217
  v_mfma_f32_16x16x32_bf16 v[124:127], a[132:135], v[36:39], v[196:199]
  s_mov_b32 m0, s25
  v_exp_f32 v221, v133
  v_mfma_f32_16x16x32_bf16 v[148:151], a[132:135], v[64:67], v[200:203]
  s_and_b32 s66, s66, 0x1ffff
  buffer_load_dwordx4 v2, s[48:51], s27 offen offset:0 sc1 lds
  v_add_f32 v226, v226, v218
  v_mfma_f32_16x16x32_bf16 v[156:159], a[132:135], v[68:71], v[204:207]
  v_exp_f32 v222, v134
  v_mfma_f32_16x16x32_bf16 v[112:115], a[136:139], v[40:43], v[112:115]
  ds_read_b128 a[168:171], v3 offset:26624
  v_add_f32 v226, v226, v219
  v_mfma_f32_16x16x32_bf16 v[120:123], a[136:139], v[44:47], v[120:123]
  v_exp_f32 v223, v135
  v_mfma_f32_16x16x32_bf16 v[144:147], a[136:139], v[72:75], v[144:147]
  v_cvt_pk_bf16_f32 v177, v218, v219
  v_add_f32 v226, v226, v220
  v_mfma_f32_16x16x32_bf16 v[152:155], a[136:139], v[76:79], v[152:155]
  v_exp_f32 v216, v136
  v_mfma_f32_16x16x32_bf16 v[116:119], a[140:143], v[40:43], v[116:119]
  ds_read_b128 a[172:175], v3 offset:27648
  v_add_f32 v226, v226, v221
  v_mfma_f32_16x16x32_bf16 v[124:127], a[140:143], v[44:47], v[124:127]
  v_exp_f32 v217, v137
  v_mfma_f32_16x16x32_bf16 v[148:151], a[140:143], v[72:75], v[148:151]
  v_cvt_pk_bf16_f32 v178, v220, v221
  v_add_f32 v226, v226, v222
  v_mfma_f32_16x16x32_bf16 v[156:159], a[140:143], v[76:79], v[156:159]
  s_waitcnt lgkmcnt(4)
  v_exp_f32 v218, v138
  v_mfma_f32_16x16x32_bf16 v[112:115], a[144:147], v[48:51], v[112:115]
  ds_read_b128 a[176:179], v3 offset:28672
  v_add_f32 v226, v226, v223
  v_mfma_f32_16x16x32_bf16 v[120:123], a[144:147], v[52:55], v[120:123]
  v_exp_f32 v219, v139
  v_mfma_f32_16x16x32_bf16 v[144:147], a[144:147], v[80:83], v[144:147]
  v_cvt_pk_bf16_f32 v179, v222, v223
  v_add_f32 v227, v216, v217
  v_mfma_f32_16x16x32_bf16 v[152:155], a[144:147], v[84:87], v[152:155]
  v_exp_f32 v220, v140
  v_mfma_f32_16x16x32_bf16 v[116:119], a[148:151], v[48:51], v[116:119]
  ds_read_b128 a[180:183], v3 offset:29696
  v_cvt_pk_bf16_f32 v180, v216, v217
  v_mfma_f32_16x16x32_bf16 v[124:127], a[148:151], v[52:55], v[124:127]
  v_exp_f32 v221, v141
  v_mfma_f32_16x16x32_bf16 v[148:151], a[148:151], v[80:83], v[148:151]
  buffer_load_dwordx4 v2, s[48:51], s27 offen offset:1024 sc1 lds
  v_add_f32 v227, v227, v218
  v_mfma_f32_16x16x32_bf16 v[156:159], a[148:151], v[84:87], v[156:159]
  v_exp_f32 v222, v142
  v_mfma_f32_16x16x32_bf16 v[112:115], a[152:155], v[56:59], v[112:115]
  ds_read_b128 a[184:187], v3 offset:30720
  v_add_f32 v227, v227, v219
  v_mfma_f32_16x16x32_bf16 v[120:123], a[152:155], v[60:63], v[120:123]
  v_exp_f32 v223, v143
  v_mfma_f32_16x16x32_bf16 v[144:147], a[152:155], v[88:91], v[144:147]
  v_cvt_pk_bf16_f32 v181, v218, v219
  v_add_f32 v227, v227, v220
  v_mfma_f32_16x16x32_bf16 v[152:155], a[152:155], v[92:95], v[152:155]
  v_exp_f32 v208, v96
  v_mfma_f32_16x16x32_bf16 v[116:119], a[156:159], v[56:59], v[116:119]
  ds_read_b128 a[188:191], v3 offset:31744
  v_add_f32 v227, v227, v221
  v_mfma_f32_16x16x32_bf16 v[124:127], a[156:159], v[60:63], v[124:127]
  v_exp_f32 v209, v97
  v_mfma_f32_16x16x32_bf16 v[148:151], a[156:159], v[88:91], v[148:151]
  v_cvt_pk_bf16_f32 v182, v220, v221
  v_add_f32 v227, v227, v222
  v_add_f32 v227, v227, v223
  v_mfma_f32_16x16x32_bf16 v[156:159], a[156:159], v[92:95], v[156:159]
  s_waitcnt lgkmcnt(4)
  v_exp_f32 v210, v98
  v_mfma_f32_16x16x32_bf16 a[0:3], a[160:163], v[168:171], a[0:3]
  ds_read_b128 a[128:131], v3 offset:8192
  v_cvt_pk_bf16_f32 v183, v222, v223
  v_mfma_f32_16x16x32_bf16 a[4:7], a[160:163], v[172:175], a[4:7]
  v_exp_f32 v211, v99
  v_mfma_f32_16x16x32_bf16 a[64:67], a[160:163], v[184:187], a[64:67]
  v_exp_f32 v212, v100
  v_mfma_f32_16x16x32_bf16 a[68:71], a[160:163], v[188:191], a[68:71]
  v_add_f32 v224, v208, v209
  v_cvt_pk_bf16_f32 v160, v208, v209
  v_mfma_f32_16x16x32_bf16 a[8:11], a[164:167], v[168:171], a[8:11]
  ds_read_b128 a[132:135], v3 offset:9216
  v_add_f32 v224, v224, v210
  v_mfma_f32_16x16x32_bf16 a[12:15], a[164:167], v[172:175], a[12:15]
  v_exp_f32 v213, v101
  v_mfma_f32_16x16x32_bf16 a[72:75], a[164:167], v[184:187], a[72:75]
  buffer_load_dwordx4 v2, s[48:51], s27 offen offset:2048 sc1 lds
  v_add_f32 v224, v224, v211
  v_mfma_f32_16x16x32_bf16 a[76:79], a[164:167], v[188:191], a[76:79]
  v_exp_f32 v214, v102
  v_mfma_f32_16x16x32_bf16 a[16:19], a[168:171], v[168:171], a[16:19]
  ds_read_b128 a[136:139], v3 offset:10240
  v_cvt_pk_bf16_f32 v161, v210, v211
  v_mfma_f32_16x16x32_bf16 a[20:23], a[168:171], v[172:175], a[20:23]
  v_exp_f32 v215, v103
  v_mfma_f32_16x16x32_bf16 a[80:83], a[168:171], v[184:187], a[80:83]
  v_add_f32 v224, v224, v212
  v_add_f32 v224, v224, v213
  v_mfma_f32_16x16x32_bf16 a[84:87], a[168:171], v[188:191], a[84:87]
  v_exp_f32 v208, v104
  v_mfma_f32_16x16x32_bf16 a[24:27], a[172:175], v[168:171], a[24:27]
  ds_read_b128 a[140:143], v3 offset:11264
  v_cvt_pk_bf16_f32 v162, v212, v213
  v_mfma_f32_16x16x32_bf16 a[28:31], a[172:175], v[172:175], a[28:31]
  v_exp_f32 v209, v105
  v_mfma_f32_16x16x32_bf16 a[88:91], a[172:175], v[184:187], a[88:91]
  v_exp_f32 v210, v106
  v_mfma_f32_16x16x32_bf16 a[92:95], a[172:175], v[188:191], a[92:95]
  s_waitcnt lgkmcnt(4)
  v_add_f32 v224, v224, v214
  v_add_f32 v224, v224, v215
  v_mfma_f32_16x16x32_bf16 a[32:35], a[176:179], v[168:171], a[32:35]
  ds_read_b128 a[144:147], v3 offset:12288
  v_cvt_pk_bf16_f32 v163, v214, v215
  v_mfma_f32_16x16x32_bf16 a[36:39], a[176:179], v[172:175], a[36:39]
  v_exp_f32 v211, v107
  v_mfma_f32_16x16x32_bf16 a[96:99], a[176:179], v[184:187], a[96:99]
  v_add_f32 v225, v208, v209
  v_cvt_pk_bf16_f32 v164, v208, v209
  v_mfma_f32_16x16x32_bf16 a[100:103], a[176:179], v[188:191], a[100:103]
  v_exp_f32 v212, v108
  v_mfma_f32_16x16x32_bf16 a[40:43], a[180:183], v[168:171], a[40:43]
  ds_read_b128 a[148:151], v3 offset:13312
  v_add_f32 v225, v225, v210
  v_mfma_f32_16x16x32_bf16 a[44:47], a[180:183], v[172:175], a[44:47]
  v_exp_f32 v213, v109
  v_mfma_f32_16x16x32_bf16 a[104:107], a[180:183], v[184:187], a[104:107]
  buffer_load_dwordx4 v2, s[48:51], s27 offen offset:3072 sc1 lds
  v_add_f32 v225, v225, v211
  v_mfma_f32_16x16x32_bf16 a[108:111], a[180:183], v[188:191], a[108:111]
  s_add_u32 s27, s27, 16384
  v_exp_f32 v214, v110
  v_mfma_f32_16x16x32_bf16 a[48:51], a[184:187], v[168:171], a[48:51]
  s_add_u32 s25, s25, 32768
  ds_read_b128 a[152:155], v3 offset:14336
  v_cvt_pk_bf16_f32 v165, v210, v211
  v_mfma_f32_16x16x32_bf16 a[52:55], a[184:187], v[172:175], a[52:55]
  s_and_b32 s25, s25, 0x1ffff
  v_exp_f32 v215, v111
  v_mfma_f32_16x16x32_bf16 a[112:115], a[184:187], v[184:187], a[112:115]
  v_max3_f32 v5, v226, v227, v224
  v_add_f32 v225, v225, v212
  v_mfma_f32_16x16x32_bf16 a[116:119], a[184:187], v[188:191], a[116:119]
  v_add_f32 v225, v225, v213
  v_cvt_pk_bf16_f32 v166, v212, v213
  v_add_f32 v225, v225, v214
  v_mfma_f32_16x16x32_bf16 a[56:59], a[188:191], v[168:171], a[56:59]
  s_sub_u32 s28, s28, 1
  ds_read_b128 a[156:159], v3 offset:15360
  v_add_f32 v225, v225, v215
  v_max_f32 v5, v5, v225
  v_cmp_lt_f32 vcc, s81, v5
  v_mfma_f32_16x16x32_bf16 a[60:63], a[188:191], v[172:175], a[60:63]
  s_cmp_gt_u32 s28, s8
  v_exp_f32 v216, v144
  v_mfma_f32_16x16x32_bf16 a[120:123], a[188:191], v[184:187], a[120:123]
  s_waitcnt lgkmcnt(4)
  v_cvt_pk_bf16_f32 v167, v214, v215
  v_add_u32 v3, s66, v2
  v_mfma_f32_16x16x32_bf16 a[124:127], a[188:191], v[188:191], a[124:127]
  s_cbranch_vccnz fa_stub2
fa_back2:
  v_exp_f32 v217, v145
  v_add_f32 v228, v228, v224
  v_add_f32 v229, v229, v225
  v_add_f32 v230, v230, v226
  v_add_f32 v231, v231, v227
  s_cbranch_scc1 fa_DD
  s_cmp_lg_u32 s8, 0
  s_cbranch_scc1 fa_DDF
fa_Aexit:
  s_bitcmp1_b32 s20, 0
  s_cbranch_scc1 fa_Aodd
  v_mfma_f32_16x16x32_bf16 v[96:99], a[128:131], v[32:35], v[192:195]
  s_waitcnt vmcnt(12)
  v_exp_f32 v218, v146
  v_mfma_f32_16x16x32_bf16 v[104:107], a[128:131], v[36:39], v[196:199]
  s_barrier
  v_exp_f32 v219, v147
  v_mfma_f32_16x16x32_bf16 v[128:131], a[128:131], v[64:67], v[200:203]
  ds_read_b128 a[160:163], v3 offset:16384
  v_add_f32 v226, v216, v217
  v_mfma_f32_16x16x32_bf16 v[136:139], a[128:131], v[68:71], v[204:207]
  v_exp_f32 v220, v148
  v_mfma_f32_16x16x32_bf16 v[100:103], a[132:135], v[32:35], v[192:195]
  ds_read_b128 a[164:167], v3 offset:17408
  v_cvt_pk_bf16_f32 v184, v216, v217
  v_mfma_f32_16x16x32_bf16 v[108:111], a[132:135], v[36:39], v[196:199]
  s_mov_b32 m0, s24
  v_exp_f32 v221, v149
  v_mfma_f32_16x16x32_bf16 v[132:135], a[132:135], v[64:67], v[200:203]
  buffer_load_dwordx4 v2, s[44:47], s26 offen offset:0 sc1 lds
  v_add_f32 v226, v226, v218
  v_mfma_f32_16x16x32_bf16 v[140:143], a[132:135], v[68:71], v[204:207]
  v_exp_f32 v222, v150
  v_mfma_f32_16x16x32_bf16 v[96:99], a[136:139], v[40:43], v[96:99]
  ds_read_b128 a[168:171], v3 offset:18432
  v_add_f32 v226, v226, v219
  v_mfma_f32_16x16x32_bf16 v[104:107], a[136:139], v[44:47], v[104:107]
  v_exp_f32 v223, v151
  v_mfma_f32_16x16x32_bf16 v[128:131], a[136:139], v[72:75], v[128:131]
  v_cvt_pk_bf16_f32 v185, v218, v219
  v_add_f32 v226, v226, v220
  v_mfma_f32_16x16x32_bf16 v[136:139], a[136:139], v[76:79], v[136:139]
  v_exp_f32 v216, v152
  v_mfma_f32_16x16x32_bf16 v[100:103], a[140:143], v[40:43], v[100:103]
  ds_read_b128 a[172:175], v3 offset:19456
  v_add_f32 v226, v226, v221
  v_mfma_f32_16x16x32_bf16 v[108:111], a[140:143], v[44:47], v[108:111]
  v_exp_f32 v217, v153
  v_mfma_f32_16x16x32_bf16 v[132:135], a[140:143], v[72:75], v[132:135]
  v_cvt_pk_bf16_f32 v186, v220, v221
  v_add_f32 v226, v226, v222
  v_mfma_f32_16x16x32_bf16 v[140:143], a[140:143], v[76:79], v[140:143]
  s_waitcnt lgkmcnt(4)
  v_exp_f32 v218, v154
  v_mfma_f32_16x16x32_bf16 v[96:99], a[144:147], v[48:51], v[96:99]
  ds_read_b128 a[176:179], v3 offset:20480
  v_add_f32 v226, v226, v223
  v_mfma_f32_16x16x32_bf16 v[104:107], a[144:147], v[52:55], v[104:107]
  v_exp_f32 v219, v155
  v_mfma_f32_16x16x32_bf16 v[128:131], a[144:147], v[80:83], v[128:131]
  v_cvt_pk_bf16_f32 v187, v222, v223
  v_add_f32 v227, v216, v217
  v_mfma_f32_16x16x32_bf16 v[136:139], a[144:147], v[84:87], v[136:139]
  v_exp_f32 v220, v156
  v_mfma_f32_16x16x32_bf16 v[100:103], a[148:151], v[48:51], v[100:103]
  ds_read_b128 a[180:183], v3 offset:21504
  v_cvt_pk_bf16_f32 v188, v216, v217
  v_mfma_f32_16x16x32_bf16 v[108:111], a[148:151], v[52:55], v[108:111]
  v_exp_f32 v221, v157
  v_mfma_f32_16x16x32_bf16 v[132:135], a[148:151], v[80:83], v[132:135]
  buffer_load_dwordx4 v2, s[44:47], s26 offen offset:1024 sc1 lds
  v_add_f32 v227, v227, v218
  v_mfma_f32_16x16x32_bf16 v[140:143], a[148:151], v[84:87], v[140:143]
  v_exp_f32 v222, v158
  v_mfma_f32_16x16x32_bf16 v[96:99], a[152:155], v[56:59], v[96:99]
  ds_read_b128 a[184:187], v3 offset:22528
  v_add_f32 v227, v227, v219
  v_mfma_f32_16x16x32_bf16 v[104:107], a[152:155], v[60:63], v[104:107]
  v_exp_f32 v223, v159
  v_mfma_f32_16x16x32_bf16 v[128:131], a[152:155], v[88:91], v[128:131]
  v_cvt_pk_bf16_f32 v189, v218, v219
  v_add_f32 v227, v227, v220
  v_mfma_f32_16x16x32_bf16 v[136:139], a[152:155], v[92:95], v[136:139]
  v_exp_f32 v208, v112
  v_mfma_f32_16x16x32_bf16 v[100:103], a[156:159], v[56:59], v[100:103]
  ds_read_b128 a[188:191], v3 offset:23552
  v_add_f32 v227, v227, v221
  v_mfma_f32_16x16x32_bf16 v[108:111], a[156:159], v[60:63], v[108:111]
  v_exp_f32 v209, v113
  v_mfma_f32_16x16x32_bf16 v[132:135], a[156:159], v[88:91], v[132:135]
  v_cvt_pk_bf16_f32 v190, v220, v221
  v_add_f32 v227, v227, v222
  v_add_f32 v227, v227, v223
  v_mfma_f32_16x16x32_bf16 v[140:143], a[156:159], v[92:95], v[140:143]
  s_waitcnt lgkmcnt(4)
  v_exp_f32 v210, v114
  v_mfma_f32_16x16x32_bf16 a[0:3], a[160:163], v[160:163], a[0:3]
  ds_read_b128 a[128:131], v3 offset:0
  v_cvt_pk_bf16_f32 v191, v222, v223
  v_mfma_f32_16x16x32_bf16 a[4:7], a[160:163], v[164:167], a[4:7]
  v_exp_f32 v211, v115
  v_mfma_f32_16x16x32_bf16 a[64:67], a[160:163], v[176:179], a[64:67]
  v_exp_f32 v212, v116
  v_mfma_f32_16x16x32_bf16 a[68:71], a[160:163], v[180:183], a[68:71]
  v_add_f32 v224, v208, v209
  v_cvt_pk_bf16_f32 v168, v208, v209
  v_mfma_f32_16x16x32_bf16 a[8:11], a[164:167], v[160:163], a[8:11]
  ds_read_b128 a[132:135], v3 offset:1024
  v_add_f32 v224, v224, v210
  v_mfma_f32_16x16x32_bf16 a[12:15], a[164:167], v[164:167], a[12:15]
  v_exp_f32 v213, v117
  v_mfma_f32_16x16x32_bf16 a[72:75], a[164:167], v[176:179], a[72:75]
  buffer_load_dwordx4 v2, s[44:47], s26 offen offset:2048 sc1 lds
  v_add_f32 v224, v224, v211
  v_mfma_f32_16x16x32_bf16 a[76:79], a[164:167], v[180:183], a[76:79]
  v_exp_f32 v214, v118
  v_mfma_f32_16x16x32_bf16 a[16:19], a[168:171], v[160:163], a[16:19]
  ds_read_b128 a[136:139], v3 offset:2048
  v_cvt_pk_bf16_f32 v169, v210, v211
  v_mfma_f32_16x16x32_bf16 a[20:23], a[168:171], v[164:167], a[20:23]
  v_exp_f32 v215, v119
  v_mfma_f32_16x16x32_bf16 a[80:83], a[168:171], v[176:179], a[80:83]
  v_add_f32 v224, v224, v212
  v_add_f32 v224, v224, v213
  v_mfma_f32_16x16x32_bf16 a[84:87], a[168:171], v[180:183], a[84:87]
  v_exp_f32 v208, v120
  v_mfma_f32_16x16x32_bf16 a[24:27], a[172:175], v[160:163], a[24:27]
  ds_read_b128 a[140:143], v3 offset:3072
  v_cvt_pk_bf16_f32 v170, v212, v213
  v_mfma_f32_16x16x32_bf16 a[28:31], a[172:175], v[164:167], a[28:31]
  v_exp_f32 v209, v121
  v_mfma_f32_16x16x32_bf16 a[88:91], a[172:175], v[176:179], a[88:91]
  v_exp_f32 v210, v122
  v_mfma_f32_16x16x32_bf16 a[92:95], a[172:175], v[180:183], a[92:95]
  s_waitcnt lgkmcnt(4)
  v_add_f32 v224, v224, v214
  v_add_f32 v224, v224, v215
  v_mfma_f32_16x16x32_bf16 a[32:35], a[176:179], v[160:163], a[32:35]
  ds_read_b128 a[144:147], v3 offset:4096
  v_cvt_pk_bf16_f32 v171, v214, v215
  v_mfma_f32_16x16x32_bf16 a[36:39], a[176:179], v[164:167], a[36:39]
  v_exp_f32 v211, v123
  v_mfma_f32_16x16x32_bf16 a[96:99], a[176:179], v[176:179], a[96:99]
  v_add_f32 v225, v208, v209
  v_cvt_pk_bf16_f32 v172, v208, v209
  v_mfma_f32_16x16x32_bf16 a[100:103], a[176:179], v[180:183], a[100:103]
  v_exp_f32 v212, v124
  v_mfma_f32_16x16x32_bf16 a[40:43], a[180:183], v[160:163], a[40:43]
  ds_read_b128 a[148:151], v3 offset:5120
  v_add_f32 v225, v225, v210
  v_mfma_f32_16x16x32_bf16 a[44:47], a[180:183], v[164:167], a[44:47]
  v_exp_f32 v213, v125
  v_mfma_f32_16x16x32_bf16 a[104:107], a[180:183], v[176:179], a[104:107]
  buffer_load_dwordx4 v2, s[44:47], s26 offen offset:3072 sc1 lds
  v_add_f32 v225, v225, v211
  v_mfma_f32_16x16x32_bf16 a[108:111], a[180:183], v[180:183], a[108:111]
  s_add_u32 s26, s26, 16384
  v_exp_f32 v214, v126
  v_mfma_f32_16x16x32_bf16 a[48:51], a[184:187], v[160:163], a[48:51]
  s_add_u32 s24, s24, 32768
  ds_read_b128 a[152:155], v3 offset:6144
  v_cvt_pk_bf16_f32 v173, v210, v211
  v_mfma_f32_16x16x32_bf16 a[52:55], a[184:187], v[164:167], a[52:55]
  s_and_b32 s24, s24, 0x1ffff
  v_exp_f32 v215, v127
  v_mfma_f32_16x16x32_bf16 a[112:115], a[184:187], v[176:179], a[112:115]
  v_max3_f32 v5, v226, v227, v224
  v_add_f32 v225, v225, v212
  v_mfma_f32_16x16x32_bf16 a[116:119], a[184:187], v[180:183], a[116:119]
  v_add_f32 v225, v225, v213
  v_cvt_pk_bf16_f32 v174, v212, v213
  v_add_f32 v225, v225, v214
  v_mfma_f32_16x16x32_bf16 a[56:59], a[188:191], v[160:163], a[56:59]
  ds_read_b128 a[156:159], v3 offset:7168
  v_add_f32 v225, v225, v215
  v_max_f32 v5, v5, v225
  v_cmp_lt_f32 vcc, s81, v5
  v_mfma_f32_16x16x32_bf16 a[60:63], a[188:191], v[164:167], a[60:63]
  v_exp_f32 v216, v128
  v_mfma_f32_16x16x32_bf16 a[120:123], a[188:191], v[176:179], a[120:123]
  s_waitcnt lgkmcnt(4)
  v_cvt_pk_bf16_f32 v175, v214, v215
  v_mfma_f32_16x16x32_bf16 a[124:127], a[188:191], v[180:183], a[124:127]
  s_cbranch_vccnz fa_stub4
fa_back4:
  v_exp_f32 v217, v129
  v_add_f32 v228, v228, v224
  v_add_f32 v229, v229, v225
  v_add_f32 v230, v230, v226
  v_add_f32 v231, v231, v227
  v_mfma_f32_16x16x32_bf16 v[144:147], a[128:131], v[64:67], v[200:203]
  ds_read_b128 a[160:163], v3 offset:24576
  v_exp_f32 v218, v130
  v_mfma_f32_16x16x32_bf16 v[152:155], a[128:131], v[68:71], v[204:207]
  v_exp_f32 v219, v131
  v_add_f32 v226, v216, v217
  v_mfma_f32_16x16x32_bf16 v[148:151], a[132:135], v[64:67], v[200:203]
  s_add_u32 s66, s66, 32768
  ds_read_b128 a[164:167], v3 offset:25600
  v_exp_f32 v220, v132
  v_mfma_f32_16x16x32_bf16 v[156:159], a[132:135], v[68:71], v[204:207]
  s_and_b32 s66, s66, 0x1ffff
  v_exp_f32 v221, v133
  v_cvt_pk_bf16_f32 v176, v216, v217
  v_mfma_f32_16x16x32_bf16 v[144:147], a[136:139], v[72:75], v[144:147]
  ds_read_b128 a[168:171], v3 offset:26624
  v_add_f32 v226, v226, v218
  v_add_f32 v226, v226, v219
  v_mfma_f32_16x16x32_bf16 v[152:155], a[136:139], v[76:79], v[152:155]
  s_mov_b32 m0, s25
  v_exp_f32 v222, v134
  v_cvt_pk_bf16_f32 v177, v218, v219
  v_mfma_f32_16x16x32_bf16 v[148:151], a[140:143], v[72:75], v[148:151]
  ds_read_b128 a[172:175], v3 offset:27648
  buffer_load_dwordx4 v2, s[48:51], s27 offen offset:0 sc1 lds
  v_add_f32 v226, v226, v220
  v_add_f32 v226, v226, v221
  v_mfma_f32_16x16x32_bf16 v[156:159], a[140:143], v[76:79], v[156:159]
  s_waitcnt lgkmcnt(4)
  v_exp_f32 v223, v135
  v_cvt_pk_bf16_f32 v178, v220, v221
  v_mfma_f32_16x16x32_bf16 v[144:147], a[144:147], v[80:83], v[144:147]
  ds_read_b128 a[176:179], v3 offset:28672
  v_cndmask_b32 v96, v4, v96, s[68:69]
  v_cndmask_b32 v97, v4, v97, s[70:71]
  v_mfma_f32_16x16x32_bf16 v[152:155], a[144:147], v[84:87], v[152:155]
  v_exp_f32 v216, v136
  v_cndmask_b32 v98, v4, v98, s[72:73]
  v_mfma_f32_16x16x32_bf16 v[148:151], a[148:151], v[80:83], v[148:151]
  ds_read_b128 a[180:183], v3 offset:29696
  v_cndmask_b32 v99, v4, v99, s[74:75]
  v_mov_b32 v100, v4
  v_mfma_f32_16x16x32_bf16 v[156:159], a[148:151], v[84:87], v[156:159]
  v_exp_f32 v217, v137
  v_mov_b32 v101, v4
  v_mfma_f32_16x16x32_bf16 v[144:147], a[152:155], v[88:91], v[144:147]
  ds_read_b128 a[184:187], v3 offset:30720
  v_mov_b32 v102, v4
  v_mov_b32 v103, v4
  v_mfma_f32_16x16x32_bf16 v[152:155], a[152:155], v[92:95], v[152:155]
  v_exp_f32 v218, v138
  v_cndmask_b32 v108, v4, v108, s[68:69]
  v_mfma_f32_16x16x32_bf16 v[148:151], a[156:159], v[88:91], v[148:151]
  ds_read_b128 a[188:191], v3 offset:31744
  v_cndmask_b32 v109, v4, v109, s[70:71]
  v_cndmask_b32 v110, v4, v110, s[72:73]
  v_mfma_f32_16x16x32_bf16 v[156:159], a[156:159], v[92:95], v[156:159]
  s_waitcnt lgkmcnt(4)
  v_exp_f32 v219, v139
  v_cndmask_b32 v111, v4, v111, s[74:75]
  v_mfma_f32_16x16x32_bf16 a[0:3], a[160:163], v[168:171], a[0:3]
  ds_read_b128 a[128:131], v3 offset:8192
  v_add_f32 v226, v226, v222
  v_add_f32 v226, v226, v223
  v_mfma_f32_16x16x32_bf16 a[4:7], a[160:163], v[172:175], a[4:7]
  v_exp_f32 v220, v140
  v_cvt_pk_bf16_f32 v179, v222, v223
  v_mfma_f32_16x16x32_bf16 a[64:67], a[160:163], v[184:187], a[64:67]
  buffer_load_dwordx4 v2, s[48:51], s27 offen offset:1024 sc1 lds
  v_add_f32 v227, v216, v217
  v_cvt_pk_bf16_f32 v180, v216, v217
  v_mfma_f32_16x16x32_bf16 a[68:71], a[160:163], v[188:191], a[68:71]
  v_exp_f32 v221, v141
  v_add_f32 v227, v227, v218
  v_mfma_f32_16x16x32_bf16 a[8:11], a[164:167], v[168:171], a[8:11]
  ds_read_b128 a[132:135], v3 offset:9216
  v_exp_f32 v222, v142
  v_mfma_f32_16x16x32_bf16 a[12:15], a[164:167], v[172:175], a[12:15]
  v_exp_f32 v223, v143
  v_mfma_f32_16x16x32_bf16 a[72:75], a[164:167], v[184:187], a[72:75]
  v_exp_f32 v208, v96
  v_mfma_f32_16x16x32_bf16 a[76:79], a[164:167], v[188:191], a[76:79]
  v_exp_f32 v209, v97
  v_mfma_f32_16x16x32_bf16 a[16:19], a[168:171], v[168:171], a[16:19]
  ds_read_b128 a[136:139], v3 offset:10240
  v_add_f32 v227, v227, v219
  v_cvt_pk_bf16_f32 v181, v218, v219
  v_add_f32 v227, v227, v220
  v_add_f32 v227, v227, v221
  v_cvt_pk_bf16_f32 v182, v220, v221
  v_mfma_f32_16x16x32_bf16 a[20:23], a[168:171], v[172:175], a[20:23]
  v_exp_f32 v210, v98
  v_mfma_f32_16x16x32_bf16 a[80:83], a[168:171], v[184:187], a[80:83]
  v_exp_f32 v211, v99
  v_mfma_f32_16x16x32_bf16 a[84:87], a[168:171], v[188:191], a[84:87]
  v_exp_f32 v212, v100
  v_mfma_f32_16x16x32_bf16 a[24:27], a[172:175], v[168:171], a[24:27]
  ds_read_b128 a[140:143], v3 offset:11264
  v_add_f32 v227, v227, v222
  v_add_f32 v227, v227, v223
  v_cvt_pk_bf16_f32 v183, v222, v223
  v_add_f32 v224, v208, v209
  v_cvt_pk_bf16_f32 v160, v208, v209
  v_mfma_f32_16x16x32_bf16 a[28:31], a[172:175], v[172:175], a[28:31]
  v_exp_f32 v213, v101
  v_mfma_f32_16x16x32_bf16 a[88:91], a[172:175], v[184:187], a[88:91]
  buffer_load_dwordx4 v2, s[48:51], s27 offen offset:2048 sc1 lds
  v_add_f32 v224, v224, v210
  v_add_f32 v224, v224, v211
  v_cvt_pk_bf16_f32 v161, v210, v211
  v_mfma_f32_16x16x32_bf16 a[92:95], a[172:175], v[188:191], a[92:95]
  s_waitcnt lgkmcnt(4)
  v_exp_f32 v214, v102
  v_mfma_f32_16x16x32_bf16 a[32:35], a[176:179], v[168:171], a[32:35]
  ds_read_b128 a[144:147], v3 offset:12288
  v_exp_f32 v215, v103
  v_mfma_f32_16x16x32_bf16 a[36:39], a[176:179], v[172:175], a[36:39]
  v_exp_f32 v208, v104
  v_mfma_f32_16x16x32_bf16 a[96:99], a[176:179], v[184:187], a[96:99]
  v_exp_f32 v209, v105
  v_mfma_f32_16x16x32_bf16 a[100:103], a[176:179], v[188:191], a[100:103]
  v_exp_f32 v210, v106
  v_mfma_f32_16x16x32_bf16 a[40:43], a[180:183], v[168:171], a[40:43]
  ds_read_b128 a[148:151], v3 offset:13312
  v_add_f32 v224, v224, v212
  v_add_f32 v224, v224, v213
  v_cvt_pk_bf16_f32 v162, v212, v213
  v_add_f32 v224, v224, v214
  v_add_f32 v224, v224, v215
  v_cvt_pk_bf16_f32 v163, v214, v215
  v_mfma_f32_16x16x32_bf16 a[44:47], a[180:183], v[172:175], a[44:47]
  v_exp_f32 v211, v107
  v_mfma_f32_16x16x32_bf16 a[104:107], a[180:183], v[184:187], a[104:107]
  v_exp_f32 v212, v108
  v_mfma_f32_16x16x32_bf16 a[108:111], a[180:183], v[188:191], a[108:111]
  v_exp_f32 v213, v109
  v_mfma_f32_16x16x32_bf16 a[48:51], a[184:187], v[168:171], a[48:51]
  ds_read_b128 a[152:155], v3 offset:14336
  v_add_f32 v225, v208, v209
  v_cvt_pk_bf16_f32 v164, v208, v209
  v_add_f32 v225, v225, v210
  v_add_f32 v225, v225, v211
  v_cvt_pk_bf16_f32 v165, v210, v211
  v_mfma_f32_16x16x32_bf16 a[52:55], a[184:187], v[172:175], a[52:55]
  v_exp_f32 v214, v110
  v_mfma_f32_16x16x32_bf16 a[112:115], a[184:187], v[184:187], a[112:115]
  buffer_load_dwordx4 v2, s[48:51], s27 offen offset:3072 sc1 lds
  v_max3_f32 v5, v226, v227, v224
  v_add_f32 v225, v225, v212
  v_add_f32 v225, v225, v213
  v_mfma_f32_16x16x32_bf16 a[116:119], a[184:187], v[188:191], a[116:119]
  s_add_u32 s27, s27, 16384
  v_exp_f32 v215, v111
  v_mfma_f32_16x16x32_bf16 a[56:59], a[188:191], v[168:171], a[56:59]
  s_add_u32 s25, s25, 32768
  ds_read_b128 a[156:159], v3 offset:15360
  v_cvt_pk_bf16_f32 v166, v212, v213
  v_add_f32 v225, v225, v214
  v_add_f32 v225, v225, v215
  v_max_f32 v5, v5, v225
  v_cmp_lt_f32 vcc, s81, v5
  v_mfma_f32_16x16x32_bf16 a[60:63], a[188:191], v[172:175], a[60:63]
  s_and_b32 s25, s25, 0x1ffff
  v_exp_f32 v216, v144
  v_mfma_f32_16x16x32_bf16 a[120:123], a[188:191], v[184:187], a[120:123]
  s_waitcnt lgkmcnt(4)
  v_cvt_pk_bf16_f32 v167, v214, v215
  v_add_u32 v3, s66, v2
  v_mfma_f32_16x16x32_bf16 a[124:127], a[188:191], v[188:191], a[124:127]
  s_cbranch_vccnz fa_stub5
fa_back5:
  v_exp_f32 v217, v145
  v_add_f32 v228, v228, v224
  v_add_f32 v229, v229, v225
  v_add_f32 v230, v230, v226
  v_add_f32 v231, v231, v227
fa_AV:
  v_mfma_f32_16x16x32_bf16 v[128:131], a[128:131], v[64:67], v[200:203]
  s_waitcnt vmcnt(12)
  v_exp_f32 v218, v146
  v_mfma_f32_16x16x32_bf16 v[136:139], a[128:131], v[68:71], v[204:207]
  s_barrier
  v_exp_f32 v219, v147
  v_mfma_f32_16x16x32_bf16 v[132:135], a[132:135], v[64:67], v[200:203]
  ds_read_b128 a[160:163], v3 offset:16384
  ds_read_b128 a[164:167], v3 offset:17408
  v_add_f32 v226, v216, v217
  v_mfma_f32_16x16x32_bf16 v[140:143], a[132:135], v[68:71], v[204:207]
  v_exp_f32 v220, v148
  v_mfma_f32_16x16x32_bf16 v[128:131], a[136:139], v[72:75], v[128:131]
  ds_read_b128 a[168:171], v3 offset:18432
  v_cvt_pk_bf16_f32 v184, v216, v217
  v_mfma_f32_16x16x32_bf16 v[136:139], a[136:139], v[76:79], v[136:139]
  s_mov_b32 m0, s24
  v_exp_f32 v221, v149
  v_mfma_f32_16x16x32_bf16 v[132:135], a[140:143], v[72:75], v[132:135]
  ds_read_b128 a[172:175], v3 offset:19456
  buffer_load_dwordx4 v2, s[44:47], s26 offen offset:0 sc1 lds
  v_add_f32 v226, v226, v218
  v_mfma_f32_16x16x32_bf16 v[140:143], a[140:143], v[76:79], v[140:143]
  s_waitcnt lgkmcnt(4)
  v_exp_f32 v222, v150
  v_mfma_f32_16x16x32_bf16 v[128:131], a[144:147], v[80:83], v[128:131]
  ds_read_b128 a[176:179], v3 offset:20480
  v_add_f32 v226, v226, v219
  v_mfma_f32_16x16x32_bf16 v[136:139], a[144:147], v[84:87], v[136:139]
  v_exp_f32 v223, v151
  v_mfma_f32_16x16x32_bf16 v[132:135], a[148:151], v[80:83], v[132:135]
  ds_read_b128 a[180:183], v3 offset:21504
  v_cvt_pk_bf16_f32 v185, v218, v219
  v_mfma_f32_16x16x32_bf16 v[140:143], a[148:151], v[84:87], v[140:143]
  v_add_f32 v226, v226, v220
  v_add_f32 v226, v226, v221
  v_mfma_f32_16x16x32_bf16 v[128:131], a[152:155], v[88:91], v[128:131]
  ds_read_b128 a[184:187], v3 offset:22528
  v_cvt_pk_bf16_f32 v186, v220, v221
  v_mfma_f32_16x16x32_bf16 v[136:139], a[152:155], v[92:95], v[136:139]
  v_exp_f32 v216, v152
  v_mfma_f32_16x16x32_bf16 v[132:135], a[156:159], v[88:91], v[132:135]
  ds_read_b128 a[188:191], v3 offset:23552
  v_add_f32 v226, v226, v222
  v_mfma_f32_16x16x32_bf16 v[140:143], a[156:159], v[92:95], v[140:143]
  s_waitcnt lgkmcnt(4)
  v_exp_f32 v217, v153
  v_mfma_f32_16x16x32_bf16 a[0:3], a[160:163], v[160:163], a[0:3]
  ds_read_b128 a[128:131], v3 offset:0
  v_add_f32 v226, v226, v223
  v_mfma_f32_16x16x32_bf16 a[4:7], a[160:163], v[164:167], a[4:7]
  v_exp_f32 v218, v154
  v_mfma_f32_16x16x32_bf16 a[64:67], a[160:163], v[176:179], a[64:67]
  buffer_load_dwordx4 v2, s[44:47], s26 offen offset:1024 sc1 lds
  v_cvt_pk_bf16_f32 v187, v222, v223
  v_mfma_f32_16x16x32_bf16 a[68:71], a[160:163], v[180:183], a[68:71]
  v_exp_f32 v219, v155
  v_mfma_f32_16x16x32_bf16 a[8:11], a[164:167], v[160:163], a[8:11]
  ds_read_b128 a[132:135], v3 offset:1024
  v_add_f32 v227, v216, v217
  v_mfma_f32_16x16x32_bf16 a[12:15], a[164:167], v[164:167], a[12:15]
  v_exp_f32 v220, v156
  v_mfma_f32_16x16x32_bf16 a[72:75], a[164:167], v[176:179], a[72:75]
  v_exp_f32 v221, v157
  v_mfma_f32_16x16x32_bf16 a[76:79], a[164:167], v[180:183], a[76:79]
  v_cvt_pk_bf16_f32 v188, v216, v217
  v_add_f32 v227, v227, v218
  v_mfma_f32_16x16x32_bf16 a[16:19], a[168:171], v[160:163], a[16:19]
  ds_read_b128 a[136:139], v3 offset:2048
  v_add_f32 v227, v227, v219
  v_mfma_f32_16x16x32_bf16 a[20:23], a[168:171], v[164:167], a[20:23]
  v_exp_f32 v222, v158
  v_mfma_f32_16x16x32_bf16 a[80:83], a[168:171], v[176:179], a[80:83]
  v_exp_f32 v223, v159
  v_mfma_f32_16x16x32_bf16 a[84:87], a[168:171], v[180:183], a[84:87]
  v_cvt_pk_bf16_f32 v189, v218, v219
  v_add_f32 v227, v227, v220
  v_mfma_f32_16x16x32_bf16 a[24:27], a[172:175], v[160:163], a[24:27]
  ds_read_b128 a[140:143], v3 offset:3072
  v_add_f32 v227, v227, v221
  v_mfma_f32_16x16x32_bf16 a[28:31], a[172:175], v[164:167], a[28:31]
  v_cvt_pk_bf16_f32 v190, v220, v221
  v_add_f32 v227, v227, v222
  v_mfma_f32_16x16x32_bf16 a[88:91], a[172:175], v[176:179], a[88:91]
  buffer_load_dwordx4 v2, s[44:47], s26 offen offset:2048 sc1 lds
  v_add_f32 v227, v227, v223
  v_mfma_f32_16x16x32_bf16 a[92:95], a[172:175], v[180:183], a[92:95]
  s_waitcnt lgkmcnt(4)
  v_max_f32 v5, v226, v227
  v_cmp_lt_f32 vcc, s81, v5
  v_mfma_f32_16x16x32_bf16 a[32:35], a[176:179], v[160:163], a[32:35]
  ds_read_b128 a[144:147], v3 offset:4096
  v_mfma_f32_16x16x32_bf16 a[36:39], a[176:179], v[164:167], a[36:39]
  v_mfma_f32_16x16x32_bf16 a[96:99], a[176:179], v[176:179], a[96:99]
  v_mfma_f32_16x16x32_bf16 a[100:103], a[176:179], v[180:183], a[100:103]
  v_mfma_f32_16x16x32_bf16 a[40:43], a[180:183], v[160:163], a[40:43]
  ds_read_b128 a[148:151], v3 offset:5120
  v_mfma_f32_16x16x32_bf16 a[44:47], a[180:183], v[164:167], a[44:47]
  v_mfma_f32_16x16x32_bf16 a[104:107], a[180:183], v[176:179], a[104:107]
  v_mfma_f32_16x16x32_bf16 a[108:111], a[180:183], v[180:183], a[108:111]
  v_mfma_f32_16x16x32_bf16 a[48:51], a[184:187], v[160:163], a[48:51]
  ds_read_b128 a[152:155], v3 offset:6144
  v_mfma_f32_16x16x32_bf16 a[52:55], a[184:187], v[164:167], a[52:55]
  v_mfma_f32_16x16x32_bf16 a[112:115], a[184:187], v[176:179], a[112:115]
  buffer_load_dwordx4 v2, s[44:47], s26 offen offset:3072 sc1 lds
  v_mfma_f32_16x16x32_bf16 a[116:119], a[184:187], v[180:183], a[116:119]
  s_add_u32 s26, s26, 16384
  v_mfma_f32_16x16x32_bf16 a[56:59], a[188:191], v[160:163], a[56:59]
  s_add_u32 s24, s24, 32768
  ds_read_b128 a[156:159], v3 offset:7168
  v_mfma_f32_16x16x32_bf16 a[60:63], a[188:191], v[164:167], a[60:63]
  s_and_b32 s24, s24, 0x1ffff
  v_exp_f32 v216, v128
  v_mfma_f32_16x16x32_bf16 a[120:123], a[188:191], v[176:179], a[120:123]
  s_waitcnt lgkmcnt(4)
  v_cvt_pk_bf16_f32 v191, v222, v223
  v_mfma_f32_16x16x32_bf16 a[124:127], a[188:191], v[180:183], a[124:127]
  s_cbranch_vccnz fa_stub6
fa_back6:
  v_exp_f32 v217, v129
  v_add_f32 v230, v230, v226
  v_add_f32 v231, v231, v227
  v_mfma_f32_16x16x32_bf16 v[144:147], a[128:131], v[64:67], v[200:203]
  ds_read_b128 a[160:163], v3 offset:24576
  v_add_f32 v226, v216, v217
  v_mfma_f32_16x16x32_bf16 v[152:155], a[128:131], v[68:71], v[204:207]
  v_exp_f32 v218, v130
  v_mfma_f32_16x16x32_bf16 v[148:151], a[132:135], v[64:67], v[200:203]
  s_add_u32 s66, s66, 32768
  ds_read_b128 a[164:167], v3 offset:25600
  v_cvt_pk_bf16_f32 v176, v216, v217
  v_mfma_f32_16x16x32_bf16 v[156:159], a[132:135], v[68:71], v[204:207]
  s_mov_b32 m0, s25
  v_exp_f32 v219, v131
  v_mfma_f32_16x16x32_bf16 v[144:147], a[136:139], v[72:75], v[144:147]
  s_and_b32 s66, s66, 0x1ffff
  ds_read_b128 a[168:171], v3 offset:26624
  buffer_load_dwordx4 v2, s[48:51], s27 offen offset:0 sc1 lds
  v_add_f32 v226, v226, v218
  v_add_f32 v226, v226, v219
  v_mfma_f32_16x16x32_bf16 v[152:155], a[136:139], v[76:79], v[152:155]
  v_exp_f32 v220, v132
  v_mfma_f32_16x16x32_bf16 v[148:151], a[140:143], v[72:75], v[148:151]
  ds_read_b128 a[172:175], v3 offset:27648
  v_cvt_pk_bf16_f32 v177, v218, v219
  v_mfma_f32_16x16x32_bf16 v[156:159], a[140:143], v[76:79], v[156:159]
  s_waitcnt lgkmcnt(4)
  v_exp_f32 v221, v133
  v_mfma_f32_16x16x32_bf16 v[144:147], a[144:147], v[80:83], v[144:147]
  ds_read_b128 a[176:179], v3 offset:28672
  v_add_f32 v226, v226, v220
  v_mfma_f32_16x16x32_bf16 v[152:155], a[144:147], v[84:87], v[152:155]
  v_exp_f32 v222, v134
  v_mfma_f32_16x16x32_bf16 v[148:151], a[148:151], v[80:83], v[148:151]
  ds_read_b128 a[180:183], v3 offset:29696
  buffer_load_dwordx4 v2, s[48:51], s27 offen offset:1024 sc1 lds
  v_add_f32 v226, v226, v221
  v_cvt_pk_bf16_f32 v178, v220, v221
  v_mfma_f32_16x16x32_bf16 v[156:159], a[148:151], v[84:87], v[156:159]
  v_exp_f32 v223, v135
  v_mfma_f32_16x16x32_bf16 v[144:147], a[152:155], v[88:91], v[144:147]
  ds_read_b128 a[184:187], v3 offset:30720
  v_add_f32 v226, v226, v222
  v_mfma_f32_16x16x32_bf16 v[152:155], a[152:155], v[92:95], v[152:155]
  v_exp_f32 v216, v136
  v_mfma_f32_16x16x32_bf16 v[148:151], a[156:159], v[88:91], v[148:151]
  ds_read_b128 a[188:191], v3 offset:31744
  v_add_f32 v226, v226, v223
  v_exp_f32 v217, v137
  v_mfma_f32_16x16x32_bf16 v[156:159], a[156:159], v[92:95], v[156:159]
  s_waitcnt lgkmcnt(4)
  v_exp_f32 v218, v138
  v_mfma_f32_16x16x32_bf16 a[64:67], a[160:163], v[184:187], a[64:67]
  ds_read_b128 a[128:131], v3 offset:8192
  v_cvt_pk_bf16_f32 v179, v222, v223
  v_mfma_f32_16x16x32_bf16 a[68:71], a[160:163], v[188:191], a[68:71]
  v_exp_f32 v219, v139
  v_mfma_f32_16x16x32_bf16 a[72:75], a[164:167], v[184:187], a[72:75]
  ds_read_b128 a[132:135], v3 offset:9216
  buffer_load_dwordx4 v2, s[48:51], s27 offen offset:2048 sc1 lds
  v_add_f32 v227, v216, v217
  v_mfma_f32_16x16x32_bf16 a[76:79], a[164:167], v[188:191], a[76:79]
  v_exp_f32 v220, v140
  v_mfma_f32_16x16x32_bf16 a[80:83], a[168:171], v[184:187], a[80:83]
  ds_read_b128 a[136:139], v3 offset:10240
  v_cvt_pk_bf16_f32 v180, v216, v217
  v_mfma_f32_16x16x32_bf16 a[84:87], a[168:171], v[188:191], a[84:87]
  v_exp_f32 v221, v141
  v_mfma_f32_16x16x32_bf16 a[88:91], a[172:175], v[184:187], a[88:91]
  ds_read_b128 a[140:143], v3 offset:11264
  v_add_f32 v227, v227, v218
  v_mfma_f32_16x16x32_bf16 a[92:95], a[172:175], v[188:191], a[92:95]
  s_waitcnt lgkmcnt(4)
  v_exp_f32 v222, v142
  v_mfma_f32_16x16x32_bf16 a[96:99], a[176:179], v[184:187], a[96:99]
  ds_read_b128 a[144:147], v3 offset:12288
  buffer_load_dwordx4 v2, s[48:51], s27 offen offset:3072 sc1 lds
  v_add_f32 v227, v227, v219
  v_cvt_pk_bf16_f32 v181, v218, v219
  v_mfma_f32_16x16x32_bf16 a[100:103], a[176:179], v[188:191], a[100:103]
  s_add_u32 s27, s27, 16384
  v_exp_f32 v223, v143
  v_mfma_f32_16x16x32_bf16 a[104:107], a[180:183], v[184:187], a[104:107]
  s_add_u32 s25, s25, 32768
  ds_read_b128 a[148:151], v3 offset:13312
  v_add_f32 v227, v227, v220
  v_mfma_f32_16x16x32_bf16 a[108:111], a[180:183], v[188:191], a[108:111]
  s_and_b32 s25, s25, 0x1ffff
  v_add_f32 v227, v227, v221
  v_cvt_pk_bf16_f32 v182, v220, v221
  v_add_f32 v227, v227, v222
  v_mfma_f32_16x16x32_bf16 a[112:115], a[184:187], v[184:187], a[112:115]
  ds_read_b128 a[152:155], v3 offset:14336
  v_add_f32 v227, v227, v223
  v_max_f32 v5, v226, v227
  v_cmp_lt_f32 vcc, s81, v5
  v_mfma_f32_16x16x32_bf16 a[116:119], a[184:187], v[188:191], a[116:119]
  v_exp_f32 v216, v144
  v_mfma_f32_16x16x32_bf16 a[120:123], a[188:191], v[184:187], a[120:123]
  s_waitcnt lgkmcnt(3)
  ds_read_b128 a[156:159], v3 offset:15360
  v_cvt_pk_bf16_f32 v183, v222, v223
  v_add_u32 v3, s66, v2
  v_mfma_f32_16x16x32_bf16 a[124:127], a[188:191], v[188:191], a[124:127]
  s_cbranch_vccnz fa_stub7
fa_back7:
  v_exp_f32 v217, v145
  v_add_f32 v230, v230, v226
  v_add_f32 v231, v231, v227
  s_branch fa_SSpre
fa_Aodd:
  v_mfma_f32_16x16x32_bf16 v[128:131], a[128:131], v[64:67], v[200:203]
  s_waitcnt vmcnt(12)
  v_exp_f32 v218, v146
  v_add_f32 v226, v216, v217
  v_mfma_f32_16x16x32_bf16 v[136:139], a[128:131], v[68:71], v[204:207]
  s_barrier
  v_exp_f32 v219, v147
  v_cvt_pk_bf16_f32 v184, v216, v217
  v_mfma_f32_16x16x32_bf16 v[132:135], a[132:135], v[64:67], v[200:203]
  ds_read_b128 a[160:163], v3 offset:16384
  ds_read_b128 a[164:167], v3 offset:17408
  v_exp_f32 v220, v148
  v_mfma_f32_16x16x32_bf16 v[140:143], a[132:135], v[68:71], v[204:207]
  v_exp_f32 v221, v149
  v_add_f32 v226, v226, v218
  v_mfma_f32_16x16x32_bf16 v[128:131], a[136:139], v[72:75], v[128:131]
  ds_read_b128 a[168:171], v3 offset:18432
  v_add_f32 v226, v226, v219
  v_cvt_pk_bf16_f32 v185, v218, v219
  v_mfma_f32_16x16x32_bf16 v[136:139], a[136:139], v[76:79], v[136:139]
  s_mov_b32 m0, s24
  v_exp_f32 v222, v150
  v_add_f32 v226, v226, v220
  v_mfma_f32_16x16x32_bf16 v[132:135], a[140:143], v[72:75], v[132:135]
  ds_read_b128 a[172:175], v3 offset:19456
  buffer_load_dwordx4 v2, s[44:47], s26 offen offset:0 sc1 lds
  v_add_f32 v226, v226, v221
  v_cvt_pk_bf16_f32 v186, v220, v221
  v_mfma_f32_16x16x32_bf16 v[140:143], a[140:143], v[76:79], v[140:143]
  s_waitcnt lgkmcnt(4)
  v_exp_f32 v223, v151
  v_cndmask_b32 v112, v4, v112, s[68:69]
  v_mfma_f32_16x16x32_bf16 v[128:131], a[144:147], v[80:83], v[128:131]
  ds_read_b128 a[176:179], v3 offset:20480
  v_cndmask_b32 v113, v4, v113, s[70:71]
  v_cndmask_b32 v114, v4, v114, s[72:73]
  v_mfma_f32_16x16x32_bf16 v[136:139], a[144:147], v[84:87], v[136:139]
  v_exp_f32 v216, v152
  v_cndmask_b32 v115, v4, v115, s[74:75]
  v_mfma_f32_16x16x32_bf16 v[132:135], a[148:151], v[80:83], v[132:135]
  ds_read_b128 a[180:183], v3 offset:21504
  v_mov_b32 v116, v4
  v_mov_b32 v117, v4
  v_mfma_f32_16x16x32_bf16 v[140:143], a[148:151], v[84:87], v[140:143]
  v_exp_f32 v217, v153
  v_mov_b32 v118, v4
  v_mfma_f32_16x16x32_bf16 v[128:131], a[152:155], v[88:91], v[128:131]
  ds_read_b128 a[184:187], v3 offset:22528
  v_mov_b32 v119, v4
  v_cndmask_b32 v124, v4, v124, s[68:69]
  v_mfma_f32_16x16x32_bf16 v[136:139], a[152:155], v[92:95], v[136:139]
  v_exp_f32 v218, v154
  v_cndmask_b32 v125, v4, v125, s[70:71]
  v_mfma_f32_16x16x32_bf16 v[132:135], a[156:159], v[88:91], v[132:135]
  ds_read_b128 a[188:191], v3 offset:23552
  v_cndmask_b32 v126, v4, v126, s[72:73]
  v_cndmask_b32 v127, v4, v127, s[74:75]
  v_mfma_f32_16x16x32_bf16 v[140:143], a[156:159], v[92:95], v[140:143]
  s_waitcnt lgkmcnt(4)
  v_exp_f32 v219, v155
  v_add_f32 v226, v226, v222
  v_mfma_f32_16x16x32_bf16 a[0:3], a[160:163], v[160:163], a[0:3]
  ds_read_b128 a[128:131], v3 offset:0
  v_add_f32 v226, v226, v223
  v_cvt_pk_bf16_f32 v187, v222, v223
  v_mfma_f32_16x16x32_bf16 a[4:7], a[160:163], v[164:167], a[4:7]
  v_exp_f32 v220, v156
  v_add_f32 v227, v216, v217
  v_mfma_f32_16x16x32_bf16 a[64:67], a[160:163], v[176:179], a[64:67]
  buffer_load_dwordx4 v2, s[44:47], s26 offen offset:1024 sc1 lds
  v_exp_f32 v221, v157
  v_mfma_f32_16x16x32_bf16 a[68:71], a[160:163], v[180:183], a[68:71]
  v_exp_f32 v222, v158
  v_mfma_f32_16x16x32_bf16 a[8:11], a[164:167], v[160:163], a[8:11]
  ds_read_b128 a[132:135], v3 offset:1024
  v_cvt_pk_bf16_f32 v188, v216, v217
  v_add_f32 v227, v227, v218
  v_add_f32 v227, v227, v219
  v_mfma_f32_16x16x32_bf16 a[12:15], a[164:167], v[164:167], a[12:15]
  v_exp_f32 v223, v159
  v_mfma_f32_16x16x32_bf16 a[72:75], a[164:167], v[176:179], a[72:75]
  v_exp_f32 v208, v112
  v_mfma_f32_16x16x32_bf16 a[76:79], a[164:167], v[180:183], a[76:79]
  v_exp_f32 v209, v113
  v_mfma_f32_16x16x32_bf16 a[16:19], a[168:171], v[160:163], a[16:19]
  ds_read_b128 a[136:139], v3 offset:2048
  v_cvt_pk_bf16_f32 v189, v218, v219
  v_add_f32 v227, v227, v220
  v_add_f32 v227, v227, v221
  v_cvt_pk_bf16_f32 v190, v220, v221
  v_add_f32 v227, v227, v222
  v_mfma_f32_16x16x32_bf16 a[20:23], a[168:171], v[164:167], a[20:23]
  v_exp_f32 v210, v114
  v_mfma_f32_16x16x32_bf16 a[80:83], a[168:171], v[176:179], a[80:83]
  v_exp_f32 v211, v115
  v_mfma_f32_16x16x32_bf16 a[84:87], a[168:171], v[180:183], a[84:87]
  v_exp_f32 v212, v116
  v_mfma_f32_16x16x32_bf16 a[24:27], a[172:175], v[160:163], a[24:27]
  ds_read_b128 a[140:143], v3 offset:3072
  v_add_f32 v227, v227, v223
  v_cvt_pk_bf16_f32 v191, v222, v223
  v_add_f32 v224, v208, v209
  v_cvt_pk_bf16_f32 v168, v208, v209
  v_add_f32 v224, v224, v210
  v_mfma_f32_16x16x32_bf16 a[28:31], a[172:175], v[164:167], a[28:31]
  v_exp_f32 v213, v117
  v_mfma_f32_16x16x32_bf16 a[88:91], a[172:175], v[176:179], a[88:91]
  buffer_load_dwordx4 v2, s[44:47], s26 offen offset:2048 sc1 lds
  v_exp_f32 v214, v118
  v_mfma_f32_16x16x32_bf16 a[92:95], a[172:175], v[180:183], a[92:95]
  s_waitcnt lgkmcnt(4)
  v_exp_f32 v215, v119
  v_mfma_f32_16x16x32_bf16 a[32:35], a[176:179], v[160:163], a[32:35]
  ds_read_b128 a[144:147], v3 offset:4096
  v_add_f32 v224, v224, v211
  v_cvt_pk_bf16_f32 v169, v210, v211
  v_add_f32 v224, v224, v212
  v_add_f32 v224, v224, v213
  v_mfma_f32_16x16x32_bf16 a[36:39], a[176:179], v[164:167], a[36:39]
  v_exp_f32 v208, v120
  v_mfma_f32_16x16x32_bf16 a[96:99], a[176:179], v[176:179], a[96:99]
  v_exp_f32 v209, v121
  v_mfma_f32_16x16x32_bf16 a[100:103], a[176:179], v[180:183], a[100:103]
  v_exp_f32 v210, v122
  v_mfma_f32_16x16x32_bf16 a[40:43], a[180:183], v[160:163], a[40:43]
  ds_read_b128 a[148:151], v3 offset:5120
  v_cvt_pk_bf16_f32 v170, v212, v213
  v_add_f32 v224, v224, v214
  v_add_f32 v224, v224, v215
  v_cvt_pk_bf16_f32 v171, v214, v215
  v_add_f32 v225, v208, v209
  v_mfma_f32_16x16x32_bf16 a[44:47], a[180:183], v[164:167], a[44:47]
  v_exp_f32 v211, v123
  v_mfma_f32_16x16x32_bf16 a[104:107], a[180:183], v[176:179], a[104:107]
  v_exp_f32 v212, v124
  v_mfma_f32_16x16x32_bf16 a[108:111], a[180:183], v[180:183], a[108:111]
  v_exp_f32 v213, v125
  v_mfma_f32_16x16x32_bf16 a[48:51], a[184:187], v[160:163], a[48:51]
  ds_read_b128 a[152:155], v3 offset:6144
  v_cvt_pk_bf16_f32 v172, v208, v209
  v_add_f32 v225, v225, v210
  v_add_f32 v225, v225, v211
  v_cvt_pk_bf16_f32 v173, v210, v211
  v_max3_f32 v5, v226, v227, v224
  v_mfma_f32_16x16x32_bf16 a[52:55], a[184:187], v[164:167], a[52:55]
  v_exp_f32 v214, v126
  v_mfma_f32_16x16x32_bf16 a[112:115], a[184:187], v[176:179], a[112:115]
  buffer_load_dwordx4 v2, s[44:47], s26 offen offset:3072 sc1 lds
  v_add_f32 v225, v225, v212
  v_add_f32 v225, v225, v213
  v_cvt_pk_bf16_f32 v174, v212, v213
  v_mfma_f32_16x16x32_bf16 a[116:119], a[184:187], v[180:183], a[116:119]
  s_add_u32 s26, s26, 16384
  v_exp_f32 v215, v127
  v_mfma_f32_16x16x32_bf16 a[56:59], a[188:191], v[160:163], a[56:59]
  s_add_u32 s24, s24, 32768
  ds_read_b128 a[156:159], v3 offset:7168
  v_add_f32 v225, v225, v214
  v_add_f32 v225, v225, v215
  v_max_f32 v5, v5, v225
  v_cmp_lt_f32 vcc, s81, v5
  v_mfma_f32_16x16x32_bf16 a[60:63], a[188:191], v[164:167], a[60:63]
  s_and_b32 s24, s24, 0x1ffff
  v_exp_f32 v216, v128
  v_mfma_f32_16x16x32_bf16 a[120:123], a[188:191], v[176:179], a[120:123]
  s_waitcnt lgkmcnt(4)
  v_cvt_pk_bf16_f32 v175, v214, v215
  v_mfma_f32_16x16x32_bf16 a[124:127], a[188:191], v[180:183], a[124:127]
  s_cbranch_vccnz fa_stub8
fa_back8:
  v_exp_f32 v217, v129
  v_add_f32 v228, v228, v224
  v_add_f32 v229, v229, v225
  v_add_f32 v230, v230, v226
  v_add_f32 v231, v231, v227
  v_mfma_f32_16x16x32_bf16 v[144:147], a[128:131], v[64:67], v[200:203]
  ds_read_b128 a[160:163], v3 offset:24576
  v_add_f32 v226, v216, v217
  v_mfma_f32_16x16x32_bf16 v[152:155], a[128:131], v[68:71], v[204:207]
  v_exp_f32 v218, v130
  v_mfma_f32_16x16x32_bf16 v[148:151], a[132:135], v[64:67], v[200:203]
  s_add_u32 s66, s66, 32768
  ds_read_b128 a[164:167], v3 offset:25600
  v_cvt_pk_bf16_f32 v176, v216, v217
  v_mfma_f32_16x16x32_bf16 v[156:159], a[132:135], v[68:71], v[204:207]
  s_and_b32 s66, s66, 0x1ffff
  v_exp_f32 v219, v131
  v_mfma_f32_16x16x32_bf16 v[144:147], a[136:139], v[72:75], v[144:147]
  ds_read_b128 a[168:171], v3 offset:26624
  v_add_f32 v226, v226, v218
  v_mfma_f32_16x16x32_bf16 v[152:155], a[136:139], v[76:79], v[152:155]
  s_mov_b32 m0, s25
  v_exp_f32 v220, v132
  v_mfma_f32_16x16x32_bf16 v[148:151], a[140:143], v[72:75], v[148:151]
  ds_read_b128 a[172:175], v3 offset:27648
  buffer_load_dwordx4 v2, s[48:51], s27 offen offset:0 sc1 lds
  v_add_f32 v226, v226, v219
  v_mfma_f32_16x16x32_bf16 v[156:159], a[140:143], v[76:79], v[156:159]
  s_waitcnt lgkmcnt(4)
  v_exp_f32 v221, v133
  v_mfma_f32_16x16x32_bf16 v[144:147], a[144:147], v[80:83], v[144:147]
  ds_read_b128 a[176:179], v3 offset:28672
  v_cvt_pk_bf16_f32 v177, v218, v219
  v_mfma_f32_16x16x32_bf16 v[152:155], a[144:147], v[84:87], v[152:155]
  v_exp_f32 v222, v134
  v_mfma_f32_16x16x32_bf16 v[148:151], a[148:151], v[80:83], v[148:151]
  ds_read_b128 a[180:183], v3 offset:29696
  v_add_f32 v226, v226, v220
  v_mfma_f32_16x16x32_bf16 v[156:159], a[148:151], v[84:87], v[156:159]
  v_exp_f32 v223, v135
  v_mfma_f32_16x16x32_bf16 v[144:147], a[152:155], v[88:91], v[144:147]
  ds_read_b128 a[184:187], v3 offset:30720
  v_add_f32 v226, v226, v221
  v_mfma_f32_16x16x32_bf16 v[152:155], a[152:155], v[92:95], v[152:155]
  v_exp_f32 v216, v136
  v_mfma_f32_16x16x32_bf16 v[148:151], a[156:159], v[88:91], v[148:151]
  ds_read_b128 a[188:191], v3 offset:31744
  v_cvt_pk_bf16_f32 v178, v220, v221
  v_mfma_f32_16x16x32_bf16 v[156:159], a[156:159], v[92:95], v[156:159]
  s_waitcnt lgkmcnt(4)
  v_exp_f32 v217, v137
  v_mfma_f32_16x16x32_bf16 a[0:3], a[160:163], v[168:171], a[0:3]
  ds_read_b128 a[128:131], v3 offset:8192
  v_add_f32 v226, v226, v222
  v_mfma_f32_16x16x32_bf16 a[4:7], a[160:163], v[172:175], a[4:7]
  v_exp_f32 v218, v138
  v_mfma_f32_16x16x32_bf16 a[64:67], a[160:163], v[184:187], a[64:67]
  buffer_load_dwordx4 v2, s[48:51], s27 offen offset:1024 sc1 lds
  v_add_f32 v226, v226, v223
  v_mfma_f32_16x16x32_bf16 a[68:71], a[160:163], v[188:191], a[68:71]
  v_exp_f32 v219, v139
  v_mfma_f32_16x16x32_bf16 a[8:11], a[164:167], v[168:171], a[8:11]
  ds_read_b128 a[132:135], v3 offset:9216
  v_cvt_pk_bf16_f32 v179, v222, v223
  v_mfma_f32_16x16x32_bf16 a[12:15], a[164:167], v[172:175], a[12:15]
  v_exp_f32 v220, v140
  v_mfma_f32_16x16x32_bf16 a[72:75], a[164:167], v[184:187], a[72:75]
  v_add_f32 v227, v216, v217
  v_cvt_pk_bf16_f32 v180, v216, v217
  v_mfma_f32_16x16x32_bf16 a[76:79], a[164:167], v[188:191], a[76:79]
  v_exp_f32 v221, v141
  v_mfma_f32_16x16x32_bf16 a[16:19], a[168:171], v[168:171], a[16:19]
  ds_read_b128 a[136:139], v3 offset:10240
  v_add_f32 v227, v227, v218
  v_mfma_f32_16x16x32_bf16 a[20:23], a[168:171], v[172:175], a[20:23]
  v_exp_f32 v222, v142
  v_mfma_f32_16x16x32_bf16 a[80:83], a[168:171], v[184:187], a[80:83]
  v_add_f32 v227, v227, v219
  v_cvt_pk_bf16_f32 v181, v218, v219
  v_mfma_f32_16x16x32_bf16 a[84:87], a[168:171], v[188:191], a[84:87]
  v_exp_f32 v223, v143
  v_mfma_f32_16x16x32_bf16 a[24:27], a[172:175], v[168:171], a[24:27]
  ds_read_b128 a[140:143], v3 offset:11264
  v_add_f32 v227, v227, v220
  v_mfma_f32_16x16x32_bf16 a[28:31], a[172:175], v[172:175], a[28:31]
  v_add_f32 v227, v227, v221
  v_cvt_pk_bf16_f32 v182, v220, v221
  v_mfma_f32_16x16x32_bf16 a[88:91], a[172:175], v[184:187], a[88:91]
  buffer_load_dwordx4 v2, s[48:51], s27 offen offset:2048 sc1 lds
  v_add_f32 v227, v227, v222
  v_mfma_f32_16x16x32_bf16 a[92:95], a[172:175], v[188:191], a[92:95]
  s_waitcnt lgkmcnt(4)
  v_add_f32 v227, v227, v223
  v_max_f32 v5, v226, v227
  v_mfma_f32_16x16x32_bf16 a[32:35], a[176:179], v[168:171], a[32:35]
  ds_read_b128 a[144:147], v3 offset:12288
  v_cmp_lt_f32 vcc, s81, v5
  v_mfma_f32_16x16x32_bf16 a[36:39], a[176:179], v[172:175], a[36:39]
  v_mfma_f32_16x16x32_bf16 a[96:99], a[176:179], v[184:187], a[96:99]
  v_mfma_f32_16x16x32_bf16 a[100:103], a[176:179], v[188:191], a[100:103]
  v_mfma_f32_16x16x32_bf16 a[40:43], a[180:183], v[168:171], a[40:43]
  ds_read_b128 a[148:151], v3 offset:13312
  v_mfma_f32_16x16x32_bf16 a[44:47], a[180:183], v[172:175], a[44:47]
  v_mfma_f32_16x16x32_bf16 a[104:107], a[180:183], v[184:187], a[104:107]
  v_mfma_f32_16x16x32_bf16 a[108:111], a[180:183], v[188:191], a[108:111]
  v_mfma_f32_16x16x32_bf16 a[48:51], a[184:187], v[168:171], a[48:51]
  ds_read_b128 a[152:155], v3 offset:14336
  v_mfma_f32_16x16x32_bf16 a[52:55], a[184:187], v[172:175], a[52:55]
  v_mfma_f32_16x16x32_bf16 a[112:115], a[184:187], v[184:187], a[112:115]
  buffer_load_dwordx4 v2, s[48:51], s27 offen offset:3072 sc1 lds
  v_mfma_f32_16x16x32_bf16 a[116:119], a[184:187], v[188:191], a[116:119]
  s_add_u32 s27, s27, 16384
  v_mfma_f32_16x16x32_bf16 a[56:59], a[188:191], v[168:171], a[56:59]
  s_add_u32 s25, s25, 32768
  ds_read_b128 a[156:159], v3 offset:15360
  v_mfma_f32_16x16x32_bf16 a[60:63], a[188:191], v[172:175], a[60:63]
  s_and_b32 s25, s25, 0x1ffff
  v_exp_f32 v216, v144
  v_mfma_f32_16x16x32_bf16 a[120:123], a[188:191], v[184:187], a[120:123]
  s_waitcnt lgkmcnt(4)
  v_cvt_pk_bf16_f32 v183, v222, v223
  v_add_u32 v3, s66, v2
  v_mfma_f32_16x16x32_bf16 a[124:127], a[188:191], v[188:191], a[124:127]
  s_cbranch_vccnz fa_stub9
fa_back9:
  v_exp_f32 v217, v145
  v_add_f32 v230, v230, v226
  v_add_f32 v231, v231, v227
fa_SSpre:
  s_mov_b32 s11, 1
  s_cmp_lg_u32 s12, 0
  s_cselect_b32 s32, s15, s32
  s_cmp_ge_u32 s20, 2
  s_cselect_b32 s23, 8, 0
  s_cmp_le_u32 s29, s23
  s_cbranch_scc1 fa_chain
.p2align 6
fa_SS:
  v_mfma_f32_16x16x32_bf16 v[128:131], a[128:131], v[64:67], v[200:203]
  s_waitcnt vmcnt(12)
  v_exp_f32 v218, v146
  v_mfma_f32_16x16x32_bf16 v[136:139], a[128:131], v[68:71], v[204:207]
  s_barrier
  v_exp_f32 v219, v147
  v_mfma_f32_16x16x32_bf16 v[132:135], a[132:135], v[64:67], v[200:203]
  s_cmp_ge_u32 s26, s32
  ds_read_b128 a[160:163], v3 offset:16384
  ds_read_b128 a[164:167], v3 offset:17408
  v_add_f32 v226, v216, v217
  v_mfma_f32_16x16x32_bf16 v[140:143], a[132:135], v[68:71], v[204:207]
  s_cbranch_scc1 fa_hk7
fa_hb7:
  v_exp_f32 v220, v148
  v_mfma_f32_16x16x32_bf16 v[128:131], a[136:139], v[72:75], v[128:131]
  ds_read_b128 a[168:171], v3 offset:18432
  v_cvt_pk_bf16_f32 v184, v216, v217
  v_mfma_f32_16x16x32_bf16 v[136:139], a[136:139], v[76:79], v[136:139]
  s_mov_b32 m0, s24
  v_exp_f32 v221, v149
  v_mfma_f32_16x16x32_bf16 v[132:135], a[140:143], v[72:75], v[132:135]
  ds_read_b128 a[172:175], v3 offset:19456
  buffer_load_dwordx4 v2, s[44:47], s26 offen offset:0 sc1 lds
  v_add_f32 v226, v226, v218
  v_add_f32 v226, v226, v219
  v_mfma_f32_16x16x32_bf16 v[140:143], a[140:143], v[76:79], v[140:143]
  s_waitcnt lgkmcnt(4)
  v_exp_f32 v222, v150
  v_mfma_f32_16x16x32_bf16 v[128:131], a[144:147], v[80:83], v[128:131]
  ds_read_b128 a[176:179], v3 offset:20480
  v_cvt_pk_bf16_f32 v185, v218, v219
  v_mfma_f32_16x16x32_bf16 v[136:139], a[144:147], v[84:87], v[136:139]
  v_exp_f32 v223, v151
  v_mfma_f32_16x16x32_bf16 v[132:135], a[148:151], v[80:83], v[132:135]
  ds_read_b128 a[180:183], v3 offset:21504
  v_add_f32 v226, v226, v220
  v_mfma_f32_16x16x32_bf16 v[140:143], a[148:151], v[84:87], v[140:143]
  v_exp_f32 v216, v152
  v_mfma_f32_16x16x32_bf16 v[128:131], a[152:155], v[88:91], v[128:131]
  ds_read_b128 a[184:187], v3 offset:22528
  buffer_load_dwordx4 v2, s[44:47], s26 offen offset:1024 sc1 lds
  v_add_f32 v226, v226, v221
  v_cvt_pk_bf16_f32 v186, v220, v221
  v_mfma_f32_16x16x32_bf16 v[136:139], a[152:155], v[92:95], v[136:139]
  v_exp_f32 v217, v153
  v_mfma_f32_16x16x32_bf16 v[132:135], a[156:159], v[88:91], v[132:135]
  ds_read_b128 a[188:191], v3 offset:23552
  v_add_f32 v226, v226, v222
  v_mfma_f32_16x16x32_bf16 v[140:143], a[156:159], v[92:95], v[140:143]
  s_waitcnt lgkmcnt(4)
  v_exp_f32 v218, v154
  v_mfma_f32_16x16x32_bf16 a[64:67], a[160:163], v[176:179], a[64:67]
  ds_read_b128 a[128:131], v3 offset:0
  v_add_f32 v226, v226, v223
  v_cvt_pk_bf16_f32 v187, v222, v223
  v_mfma_f32_16x16x32_bf16 a[68:71], a[160:163], v[180:183], a[68:71]
  v_exp_f32 v219, v155
  v_mfma_f32_16x16x32_bf16 a[72:75], a[164:167], v[176:179], a[72:75]
  ds_read_b128 a[132:135], v3 offset:1024
  buffer_load_dwordx4 v2, s[44:47], s26 offen offset:2048 sc1 lds
  v_add_f32 v227, v216, v217
  v_mfma_f32_16x16x32_bf16 a[76:79], a[164:167], v[180:183], a[76:79]
  v_exp_f32 v220, v156
  v_mfma_f32_16x16x32_bf16 a[80:83], a[168:171], v[176:179], a[80:83]
  ds_read_b128 a[136:139], v3 offset:2048
  v_cvt_pk_bf16_f32 v188, v216, v217
  v_mfma_f32_16x16x32_bf16 a[84:87], a[168:171], v[180:183], a[84:87]
  v_exp_f32 v221, v157
  v_mfma_f32_16x16x32_bf16 a[88:91], a[172:175], v[176:179], a[88:91]
  ds_read_b128 a[140:143], v3 offset:3072
  v_add_f32 v227, v227, v218
  v_add_f32 v227, v227, v219
  v_mfma_f32_16x16x32_bf16 a[92:95], a[172:175], v[180:183], a[92:95]
  s_waitcnt lgkmcnt(4)
  v_exp_f32 v222, v158
  v_mfma_f32_16x16x32_bf16 a[96:99], a[176:179], v[176:179], a[96:99]
  ds_read_b128 a[144:147], v3 offset:4096
  buffer_load_dwordx4 v2, s[44:47], s26 offen offset:3072 sc1 lds
  v_cvt_pk_bf16_f32 v189, v218, v219
  v_mfma_f32_16x16x32_bf16 a[100:103], a[176:179], v[180:183], a[100:103]
  s_add_u32 s26, s26, 16384
  v_exp_f32 v223, v159
  v_mfma_f32_16x16x32_bf16 a[104:107], a[180:183], v[176:179], a[104:107]
  s_add_u32 s24, s24, 32768
  ds_read_b128 a[148:151], v3 offset:5120
  v_add_f32 v227, v227, v220
  v_mfma_f32_16x16x32_bf16 a[108:111], a[180:183], v[180:183], a[108:111]
  s_and_b32 s24, s24, 0x1ffff
  v_add_f32 v227, v227, v221
  v_cvt_pk_bf16_f32 v190, v220, v221
  v_add_f32 v227, v227, v222
  v_mfma_f32_16x16x32_bf16 a[112:115], a[184:187], v[176:179], a[112:115]
  ds_read_b128 a[152:155], v3 offset:6144
  v_add_f32 v227, v227, v223
  v_max_f32 v5, v226, v227
  v_cmp_lt_f32 vcc, s81, v5
  v_mfma_f32_16x16x32_bf16 a[116:119], a[184:187], v[180:183], a[116:119]
  v_exp_f32 v216, v128
  v_mfma_f32_16x16x32_bf16 a[120:123], a[188:191], v[176:179], a[120:123]
  s_waitcnt lgkmcnt(3)
  ds_read_b128 a[156:159], v3 offset:7168
  v_cvt_pk_bf16_f32 v191, v222, v223
  v_mfma_f32_16x16x32_bf16 a[124:127], a[188:191], v[180:183], a[124:127]
  s_cbranch_vccnz fa_stub10
fa_back10:
  v_exp_f32 v217, v129
  v_add_f32 v230, v230, v226
  v_add_f32 v231, v231, v227
  v_mfma_f32_16x16x32_bf16 v[144:147], a[128:131], v[64:67], v[200:203]
  ds_read_b128 a[160:163], v3 offset:24576
  v_add_f32 v226, v216, v217
  v_mfma_f32_16x16x32_bf16 v[152:155], a[128:131], v[68:71], v[204:207]
  v_exp_f32 v218, v130
  v_mfma_f32_16x16x32_bf16 v[148:151], a[132:135], v[64:67], v[200:203]
  s_add_u32 s66, s66, 32768
  ds_read_b128 a[164:167], v3 offset:25600
  v_cvt_pk_bf16_f32 v176, v216, v217
  v_mfma_f32_16x16x32_bf16 v[156:159], a[132:135], v[68:71], v[204:207]
  s_mov_b32 m0, s25
  v_exp_f32 v219, v131
  v_mfma_f32_16x16x32_bf16 v[144:147], a[136:139], v[72:75], v[144:147]
  s_and_b32 s66, s66, 0x1ffff
  ds_read_b128 a[168:171], v3 offset:26624
  buffer_load_dwordx4 v2, s[48:51], s27 offen offset:0 sc1 lds
  v_add_f32 v226, v226, v218
  v_add_f32 v226, v226, v219
  v_mfma_f32_16x16x32_bf16 v[152:155], a[136:139], v[76:79], v[152:155]
  v_exp_f32 v220, v132
  v_mfma_f32_16x16x32_bf16 v[148:151], a[140:143], v[72:75], v[148:151]
  ds_read_b128 a[172:175], v3 offset:27648
  v_cvt_pk_bf16_f32 v177, v218, v219
  v_mfma_f32_16x16x32_bf16 v[156:159], a[140:143], v[76:79], v[156:159]
  s_waitcnt lgkmcnt(4)
  v_exp_f32 v221, v133
  v_mfma_f32_16x16x32_bf16 v[144:147], a[144:147], v[80:83], v[144:147]
  ds_read_b128 a[176:179], v3 offset:28672
  v_add_f32 v226, v226, v220
  v_mfma_f32_16x16x32_bf16 v[152:155], a[144:147], v[84:87], v[152:155]
  v_exp_f32 v222, v134
  v_mfma_f32_16x16x32_bf16 v[148:151], a[148:151], v[80:83], v[148:151]
  ds_read_b128 a[180:183], v3 offset:29696
  buffer_load_dwordx4 v2, s[48:51], s27 offen offset:1024 sc1 lds
  v_add_f32 v226, v226, v221
  v_cvt_pk_bf16_f32 v178, v220, v221
  v_mfma_f32_16x16x32_bf16 v[156:159], a[148:151], v[84:87], v[156:159]
  v_exp_f32 v223, v135
  v_mfma_f32_16x16x32_bf16 v[144:147], a[152:155], v[88:91], v[144:147]
  ds_read_b128 a[184:187], v3 offset:30720
  v_add_f32 v226, v226, v222
  v_mfma_f32_16x16x32_bf16 v[152:155], a[152:155], v[92:95], v[152:155]
  v_exp_f32 v216, v136
  v_mfma_f32_16x16x32_bf16 v[148:151], a[156:159], v[88:91], v[148:151]
  ds_read_b128 a[188:191], v3 offset:31744
  v_add_f32 v226, v226, v223
  v_exp_f32 v217, v137
  v_mfma_f32_16x16x32_bf16 v[156:159], a[156:159], v[92:95], v[156:159]
  s_waitcnt lgkmcnt(4)
  v_exp_f32 v218, v138
  v_mfma_f32_16x16x32_bf16 a[64:67], a[160:163], v[184:187], a[64:67]
  ds_read_b128 a[128:131], v3 offset:8192
  v_cvt_pk_bf16_f32 v179, v222, v223
  v_mfma_f32_16x16x32_bf16 a[68:71], a[160:163], v[188:191], a[68:71]
  v_exp_f32 v219, v139
  v_mfma_f32_16x16x32_bf16 a[72:75], a[164:167], v[184:187], a[72:75]
  ds_read_b128 a[132:135], v3 offset:9216
  buffer_load_dwordx4 v2, s[48:51], s27 offen offset:2048 sc1 lds
  v_add_f32 v227, v216, v217
  v_mfma_f32_16x16x32_bf16 a[76:79], a[164:167], v[188:191], a[76:79]
  v_exp_f32 v220, v140
  v_mfma_f32_16x16x32_bf16 a[80:83], a[168:171], v[184:187], a[80:83]
  ds_read_b128 a[136:139], v3 offset:10240
  v_cvt_pk_bf16_f32 v180, v216, v217
  v_mfma_f32_16x16x32_bf16 a[84:87], a[168:171], v[188:191], a[84:87]
  v_exp_f32 v221, v141
  v_mfma_f32_16x16x32_bf16 a[88:91], a[172:175], v[184:187], a[88:91]
  ds_read_b128 a[140:143], v3 offset:11264
  v_add_f32 v227, v227, v218
  v_mfma_f32_16x16x32_bf16 a[92:95], a[172:175], v[188:191], a[92:95]
  s_waitcnt lgkmcnt(4)
  v_exp_f32 v222, v142
  v_mfma_f32_16x16x32_bf16 a[96:99], a[176:179], v[184:187], a[96:99]
  ds_read_b128 a[144:147], v3 offset:12288
  buffer_load_dwordx4 v2, s[48:51], s27 offen offset:3072 sc1 lds
  v_add_f32 v227, v227, v219
  v_cvt_pk_bf16_f32 v181, v218, v219
  v_mfma_f32_16x16x32_bf16 a[100:103], a[176:179], v[188:191], a[100:103]
  s_add_u32 s27, s27, 16384
  v_exp_f32 v223, v143
  v_mfma_f32_16x16x32_bf16 a[104:107], a[180:183], v[184:187], a[104:107]
  s_add_u32 s25, s25, 32768
  ds_read_b128 a[148:151], v3 offset:13312
  v_add_f32 v227, v227, v220
  v_mfma_f32_16x16x32_bf16 a[108:111], a[180:183], v[188:191], a[108:111]
  s_and_b32 s25, s25, 0x1ffff
  v_add_f32 v227, v227, v221
  v_cvt_pk_bf16_f32 v182, v220, v221
  v_add_f32 v227, v227, v222
  v_mfma_f32_16x16x32_bf16 a[112:115], a[184:187], v[184:187], a[112:115]
  s_sub_u32 s29, s29, 1
  ds_read_b128 a[152:155], v3 offset:14336
  v_add_f32 v227, v227, v223
  v_max_f32 v5, v226, v227
  v_cmp_lt_f32 vcc, s81, v5
  v_mfma_f32_16x16x32_bf16 a[116:119], a[184:187], v[188:191], a[116:119]
  s_cmp_gt_u32 s29, 8
  v_exp_f32 v216, v144
  v_mfma_f32_16x16x32_bf16 a[120:123], a[188:191], v[184:187], a[120:123]
  s_waitcnt lgkmcnt(3)
  ds_read_b128 a[156:159], v3 offset:15360
  v_cvt_pk_bf16_f32 v183, v222, v223
  v_add_u32 v3, s66, v2
  v_mfma_f32_16x16x32_bf16 a[124:127], a[188:191], v[188:191], a[124:127]
  s_cbranch_vccnz fa_stub11
fa_back11:
  v_exp_f32 v217, v145
  v_add_f32 v230, v230, v226
  v_add_f32 v231, v231, v227
  s_cbranch_scc1 fa_SS
fa_chain:
  s_setprio 3
fa_hb8:
  s_cmp_lt_u32 s12, 2
  s_cbranch_scc1 fa_hk8
  s_cmp_eq_u32 s29, 8
  s_cbranch_scc0 fa_disp
fa_SSW8:
  v_mfma_f32_16x16x32_bf16 v[128:131], a[128:131], v[64:67], v[200:203]
  s_waitcnt vmcnt(12)
  v_exp_f32 v218, v146
  v_mfma_f32_16x16x32_bf16 v[136:139], a[128:131], v[68:71], v[204:207]
  s_barrier
  v_exp_f32 v219, v147
  v_mfma_f32_16x16x32_bf16 v[132:135], a[132:135], v[64:67], v[200:203]
  ds_read_b128 a[160:163], v3 offset:16384
  ds_read_b128 a[164:167], v3 offset:17408
  v_add_f32 v226, v216, v217
  v_mfma_f32_16x16x32_bf16 v[140:143], a[132:135], v[68:71], v[204:207]
  s_mov_b32 m0, s24
  v_exp_f32 v220, v148
  v_mfma_f32_16x16x32_bf16 v[128:131], a[136:139], v[72:75], v[128:131]
  ds_read_b128 a[168:171], v3 offset:18432
  buffer_load_dwordx4 v2, s[44:47], s26 offen offset:0 sc1 lds
  v_cvt_pk_bf16_f32 v184, v216, v217
  v_mfma_f32_16x16x32_bf16 v[136:139], a[136:139], v[76:79], v[136:139]
  v_exp_f32 v221, v149
  v_mfma_f32_16x16x32_bf16 v[132:135], a[140:143], v[72:75], v[132:135]
  ds_read_b128 a[172:175], v3 offset:19456
  v_add_f32 v226, v226, v218
  v_add_f32 v226, v226, v219
  v_mfma_f32_16x16x32_bf16 v[140:143], a[140:143], v[76:79], v[140:143]
  s_waitcnt lgkmcnt(4)
  v_exp_f32 v222, v150
  v_mfma_f32_16x16x32_bf16 v[128:131], a[144:147], v[80:83], v[128:131]
  ds_read_b128 a[176:179], v3 offset:20480
  v_cvt_pk_bf16_f32 v185, v218, v219
  v_mfma_f32_16x16x32_bf16 v[136:139], a[144:147], v[84:87], v[136:139]
  v_exp_f32 v223, v151
  v_mfma_f32_16x16x32_bf16 v[132:135], a[148:151], v[80:83], v[132:135]
  ds_read_b128 a[180:183], v3 offset:21504
  buffer_load_dwordx4 v2, s[44:47], s26 offen offset:1024 sc1 lds
  v_add_f32 v226, v226, v220
  v_mfma_f32_16x16x32_bf16 v[140:143], a[148:151], v[84:87], v[140:143]
  v_exp_f32 v216, v152
  v_mfma_f32_16x16x32_bf16 v[128:131], a[152:155], v[88:91], v[128:131]
  ds_read_b128 a[184:187], v3 offset:22528
  v_add_f32 v226, v226, v221
  v_cvt_pk_bf16_f32 v186, v220, v221
  v_mfma_f32_16x16x32_bf16 v[136:139], a[152:155], v[92:95], v[136:139]
  v_exp_f32 v217, v153
  v_mfma_f32_16x16x32_bf16 v[132:135], a[156:159], v[88:91], v[132:135]
  s_add_u32 s14, s13, 0
  ds_read_b128 a[188:191], v3 offset:23552
  buffer_load_dwordx4 a[192:195], v2, s[40:43], s14 offen offset:0 sc1
  v_add_f32 v226, v226, v222
  v_mfma_f32_16x16x32_bf16 v[140:143], a[156:159], v[92:95], v[140:143]
  s_waitcnt lgkmcnt(4)
  v_exp_f32 v218, v154
  v_mfma_f32_16x16x32_bf16 a[64:67], a[160:163], v[176:179], a[64:67]
  ds_read_b128 a[128:131], v3 offset:0
  v_add_f32 v226, v226, v223
  v_cvt_pk_bf16_f32 v187, v222, v223
  v_mfma_f32_16x16x32_bf16 a[68:71], a[160:163], v[180:183], a[68:71]
  v_exp_f32 v219, v155
  v_mfma_f32_16x16x32_bf16 a[72:75], a[164:167], v[176:179], a[72:75]
  ds_read_b128 a[132:135], v3 offset:1024
  buffer_load_dwordx4 v2, s[44:47], s26 offen offset:2048 sc1 lds
  v_add_f32 v227, v216, v217
  v_mfma_f32_16x16x32_bf16 a[76:79], a[164:167], v[180:183], a[76:79]
  v_exp_f32 v220, v156
  v_mfma_f32_16x16x32_bf16 a[80:83], a[168:171], v[176:179], a[80:83]
  ds_read_b128 a[136:139], v3 offset:2048
  v_cvt_pk_bf16_f32 v188, v216, v217
  v_mfma_f32_16x16x32_bf16 a[84:87], a[168:171], v[180:183], a[84:87]
  v_exp_f32 v221, v157
  v_mfma_f32_16x16x32_bf16 a[88:91], a[172:175], v[176:179], a[88:91]
  ds_read_b128 a[140:143], v3 offset:3072
  v_add_f32 v227, v227, v218
  v_add_f32 v227, v227, v219
  v_mfma_f32_16x16x32_bf16 a[92:95], a[172:175], v[180:183], a[92:95]
  s_waitcnt lgkmcnt(4)
  v_exp_f32 v222, v158
  v_mfma_f32_16x16x32_bf16 a[96:99], a[176:179], v[176:179], a[96:99]
  ds_read_b128 a[144:147], v3 offset:4096
  buffer_load_dwordx4 v2, s[44:47], s26 offen offset:3072 sc1 lds
  v_cvt_pk_bf16_f32 v189, v218, v219
  v_mfma_f32_16x16x32_bf16 a[100:103], a[176:179], v[180:183], a[100:103]
  s_add_u32 s26, s26, 16384
  v_exp_f32 v223, v159
  v_mfma_f32_16x16x32_bf16 a[104:107], a[180:183], v[176:179], a[104:107]
  s_add_u32 s24, s24, 32768
  ds_read_b128 a[148:151], v3 offset:5120
  v_add_f32 v227, v227, v220
  v_mfma_f32_16x16x32_bf16 a[108:111], a[180:183], v[180:183], a[108:111]
  s_and_b32 s24, s24, 0x1ffff
  v_add_f32 v227, v227, v221
  v_cvt_pk_bf16_f32 v190, v220, v221
  v_add_f32 v227, v227, v222
  v_mfma_f32_16x16x32_bf16 a[112:115], a[184:187], v[176:179], a[112:115]
  ds_read_b128 a[152:155], v3 offset:6144
  v_add_f32 v227, v227, v223
  v_max_f32 v5, v226, v227
  v_cmp_lt_f32 vcc, s81, v5
  v_mfma_f32_16x16x32_bf16 a[116:119], a[184:187], v[180:183], a[116:119]
  v_exp_f32 v216, v128
  v_mfma_f32_16x16x32_bf16 a[120:123], a[188:191], v[176:179], a[120:123]
  s_waitcnt lgkmcnt(3)
  ds_read_b128 a[156:159], v3 offset:7168
  v_cvt_pk_bf16_f32 v191, v222, v223
  v_mfma_f32_16x16x32_bf16 a[124:127], a[188:191], v[180:183], a[124:127]
  s_cbranch_vccnz fa_stub12
fa_back12:
  v_exp_f32 v217, v129
  v_add_f32 v230, v230, v226
  v_add_f32 v231, v231, v227
  v_mfma_f32_16x16x32_bf16 v[144:147], a[128:131], v[64:67], v[200:203]
  ds_read_b128 a[160:163], v3 offset:24576
  v_add_f32 v226, v216, v217
  v_mfma_f32_16x16x32_bf16 v[152:155], a[128:131], v[68:71], v[204:207]
  v_exp_f32 v218, v130
  v_mfma_f32_16x16x32_bf16 v[148:151], a[132:135], v[64:67], v[200:203]
  s_add_u32 s66, s66, 32768
  ds_read_b128 a[164:167], v3 offset:25600
  v_cvt_pk_bf16_f32 v176, v216, v217
  v_mfma_f32_16x16x32_bf16 v[156:159], a[132:135], v[68:71], v[204:207]
  s_mov_b32 m0, s25
  v_exp_f32 v219, v131
  v_mfma_f32_16x16x32_bf16 v[144:147], a[136:139], v[72:75], v[144:147]
  s_and_b32 s66, s66, 0x1ffff
  ds_read_b128 a[168:171], v3 offset:26624
  buffer_load_dwordx4 v2, s[48:51], s27 offen offset:0 sc1 lds
  v_add_f32 v226, v226, v218
  v_add_f32 v226, v226, v219
  v_mfma_f32_16x16x32_bf16 v[152:155], a[136:139], v[76:79], v[152:155]
  v_exp_f32 v220, v132
  v_mfma_f32_16x16x32_bf16 v[148:151], a[140:143], v[72:75], v[148:151]
  ds_read_b128 a[172:175], v3 offset:27648
  v_cvt_pk_bf16_f32 v177, v218, v219
  v_mfma_f32_16x16x32_bf16 v[156:159], a[140:143], v[76:79], v[156:159]
  s_waitcnt lgkmcnt(4)
  v_exp_f32 v221, v133
  v_mfma_f32_16x16x32_bf16 v[144:147], a[144:147], v[80:83], v[144:147]
  s_add_u32 s14, s13, 0
  ds_read_b128 a[176:179], v3 offset:28672
  buffer_load_dwordx4 a[196:199], v2, s[40:43], s14 offen offset:1024 sc1
  v_add_f32 v226, v226, v220
  v_mfma_f32_16x16x32_bf16 v[152:155], a[144:147], v[84:87], v[152:155]
  v_exp_f32 v222, v134
  v_mfma_f32_16x16x32_bf16 v[148:151], a[148:151], v[80:83], v[148:151]
  ds_read_b128 a[180:183], v3 offset:29696
  buffer_load_dwordx4 v2, s[48:51], s27 offen offset:1024 sc1 lds
  v_add_f32 v226, v226, v221
  v_cvt_pk_bf16_f32 v178, v220, v221
  v_mfma_f32_16x16x32_bf16 v[156:159], a[148:151], v[84:87], v[156:159]
  v_exp_f32 v223, v135
  v_mfma_f32_16x16x32_bf16 v[144:147], a[152:155], v[88:91], v[144:147]
  ds_read_b128 a[184:187], v3 offset:30720
  v_add_f32 v226, v226, v222
  v_mfma_f32_16x16x32_bf16 v[152:155], a[152:155], v[92:95], v[152:155]
  v_exp_f32 v216, v136
  v_mfma_f32_16x16x32_bf16 v[148:151], a[156:159], v[88:91], v[148:151]
  ds_read_b128 a[188:191], v3 offset:31744
  v_add_f32 v226, v226, v223
  v_exp_f32 v217, v137
  v_mfma_f32_16x16x32_bf16 v[156:159], a[156:159], v[92:95], v[156:159]
  s_waitcnt lgkmcnt(4)
  v_exp_f32 v218, v138
  v_mfma_f32_16x16x32_bf16 a[64:67], a[160:163], v[184:187], a[64:67]
  ds_read_b128 a[128:131], v3 offset:8192
  v_cvt_pk_bf16_f32 v179, v222, v223
  v_mfma_f32_16x16x32_bf16 a[68:71], a[160:163], v[188:191], a[68:71]
  v_exp_f32 v219, v139
  v_mfma_f32_16x16x32_bf16 a[72:75], a[164:167], v[184:187], a[72:75]
  ds_read_b128 a[132:135], v3 offset:9216
  buffer_load_dwordx4 v2, s[48:51], s27 offen offset:2048 sc1 lds
  v_add_f32 v227, v216, v217
  v_mfma_f32_16x16x32_bf16 a[76:79], a[164:167], v[188:191], a[76:79]
  v_exp_f32 v220, v140
  v_mfma_f32_16x16x32_bf16 a[80:83], a[168:171], v[184:187], a[80:83]
  ds_read_b128 a[136:139], v3 offset:10240
  v_cvt_pk_bf16_f32 v180, v216, v217
  v_mfma_f32_16x16x32_bf16 a[84:87], a[168:171], v[188:191], a[84:87]
  v_exp_f32 v221, v141
  v_mfma_f32_16x16x32_bf16 a[88:91], a[172:175], v[184:187], a[88:91]
  ds_read_b128 a[140:143], v3 offset:11264
  buffer_load_dwordx4 a[200:203], v2, s[40:43], s14 offen offset:2048 sc1
  v_add_f32 v227, v227, v218
  v_mfma_f32_16x16x32_bf16 a[92:95], a[172:175], v[188:191], a[92:95]
  s_waitcnt lgkmcnt(4)
  v_exp_f32 v222, v142
  v_mfma_f32_16x16x32_bf16 a[96:99], a[176:179], v[184:187], a[96:99]
  ds_read_b128 a[144:147], v3 offset:12288
  buffer_load_dwordx4 v2, s[48:51], s27 offen offset:3072 sc1 lds
  v_add_f32 v227, v227, v219
  v_cvt_pk_bf16_f32 v181, v218, v219
  v_mfma_f32_16x16x32_bf16 a[100:103], a[176:179], v[188:191], a[100:103]
  s_add_u32 s27, s27, 16384
  v_exp_f32 v223, v143
  v_mfma_f32_16x16x32_bf16 a[104:107], a[180:183], v[184:187], a[104:107]
  s_add_u32 s25, s25, 32768
  ds_read_b128 a[148:151], v3 offset:13312
  v_add_f32 v227, v227, v220
  v_mfma_f32_16x16x32_bf16 a[108:111], a[180:183], v[188:191], a[108:111]
  s_and_b32 s25, s25, 0x1ffff
  v_add_f32 v227, v227, v221
  v_cvt_pk_bf16_f32 v182, v220, v221
  v_add_f32 v227, v227, v222
  v_mfma_f32_16x16x32_bf16 a[112:115], a[184:187], v[184:187], a[112:115]
  ds_read_b128 a[152:155], v3 offset:14336
  v_add_f32 v227, v227, v223
  v_max_f32 v5, v226, v227
  v_cmp_lt_f32 vcc, s81, v5
  v_mfma_f32_16x16x32_bf16 a[116:119], a[184:187], v[188:191], a[116:119]
  v_exp_f32 v216, v144
  v_mfma_f32_16x16x32_bf16 a[120:123], a[188:191], v[184:187], a[120:123]
  s_waitcnt lgkmcnt(3)
  ds_read_b128 a[156:159], v3 offset:15360
  v_cvt_pk_bf16_f32 v183, v222, v223
  v_add_u32 v3, s66, v2
  v_mfma_f32_16x16x32_bf16 a[124:127], a[188:191], v[188:191], a[124:127]
  s_cbranch_vccnz fa_stub13
fa_back13:
  v_exp_f32 v217, v145
  v_add_f32 v230, v230, v226
  v_add_f32 v231, v231, v227
fa_SSW7:
  v_mfma_f32_16x16x32_bf16 v[128:131], a[128:131], v[64:67], v[200:203]
  s_waitcnt vmcnt(12)
  v_exp_f32 v218, v146
  v_mfma_f32_16x16x32_bf16 v[136:139], a[128:131], v[68:71], v[204:207]
  s_barrier
  v_exp_f32 v219, v147
  v_mfma_f32_16x16x32_bf16 v[132:135], a[132:135], v[64:67], v[200:203]
  ds_read_b128 a[160:163], v3 offset:16384
  ds_read_b128 a[164:167], v3 offset:17408
  v_add_f32 v226, v216, v217
  v_mfma_f32_16x16x32_bf16 v[140:143], a[132:135], v[68:71], v[204:207]
  s_mov_b32 m0, s24
  v_exp_f32 v220, v148
  v_mfma_f32_16x16x32_bf16 v[128:131], a[136:139], v[72:75], v[128:131]
  ds_read_b128 a[168:171], v3 offset:18432
  buffer_load_dwordx4 v2, s[44:47], s26 offen offset:0 sc1 lds
  v_cvt_pk_bf16_f32 v184, v216, v217
  v_mfma_f32_16x16x32_bf16 v[136:139], a[136:139], v[76:79], v[136:139]
  v_exp_f32 v221, v149
  v_mfma_f32_16x16x32_bf16 v[132:135], a[140:143], v[72:75], v[132:135]
  ds_read_b128 a[172:175], v3 offset:19456
  v_add_f32 v226, v226, v218
  v_add_f32 v226, v226, v219
  v_mfma_f32_16x16x32_bf16 v[140:143], a[140:143], v[76:79], v[140:143]
  s_waitcnt lgkmcnt(4)
  v_exp_f32 v222, v150
  v_mfma_f32_16x16x32_bf16 v[128:131], a[144:147], v[80:83], v[128:131]
  ds_read_b128 a[176:179], v3 offset:20480
  v_cvt_pk_bf16_f32 v185, v218, v219
  v_mfma_f32_16x16x32_bf16 v[136:139], a[144:147], v[84:87], v[136:139]
  v_exp_f32 v223, v151
  v_mfma_f32_16x16x32_bf16 v[132:135], a[148:151], v[80:83], v[132:135]
  ds_read_b128 a[180:183], v3 offset:21504
  buffer_load_dwordx4 v2, s[44:47], s26 offen offset:1024 sc1 lds
  v_add_f32 v226, v226, v220
  v_mfma_f32_16x16x32_bf16 v[140:143], a[148:151], v[84:87], v[140:143]
  v_exp_f32 v216, v152
  v_mfma_f32_16x16x32_bf16 v[128:131], a[152:155], v[88:91], v[128:131]
  ds_read_b128 a[184:187], v3 offset:22528
  v_add_f32 v226, v226, v221
  v_cvt_pk_bf16_f32 v186, v220, v221
  v_mfma_f32_16x16x32_bf16 v[136:139], a[152:155], v[92:95], v[136:139]
  v_exp_f32 v217, v153
  v_mfma_f32_16x16x32_bf16 v[132:135], a[156:159], v[88:91], v[132:135]
  s_add_u32 s14, s13, 0
  ds_read_b128 a[188:191], v3 offset:23552
  buffer_load_dwordx4 a[204:207], v2, s[40:43], s14 offen offset:3072 sc1
  v_add_f32 v226, v226, v222
  v_mfma_f32_16x16x32_bf16 v[140:143], a[156:159], v[92:95], v[140:143]
  s_waitcnt lgkmcnt(4)
  v_exp_f32 v218, v154
  v_mfma_f32_16x16x32_bf16 a[64:67], a[160:163], v[176:179], a[64:67]
  ds_read_b128 a[128:131], v3 offset:0
  v_add_f32 v226, v226, v223
  v_cvt_pk_bf16_f32 v187, v222, v223
  v_mfma_f32_16x16x32_bf16 a[68:71], a[160:163], v[180:183], a[68:71]
  v_exp_f32 v219, v155
  v_mfma_f32_16x16x32_bf16 a[72:75], a[164:167], v[176:179], a[72:75]
  ds_read_b128 a[132:135], v3 offset:1024
  buffer_load_dwordx4 v2, s[44:47], s26 offen offset:2048 sc1 lds
  v_add_f32 v227, v216, v217
  v_mfma_f32_16x16x32_bf16 a[76:79], a[164:167], v[180:183], a[76:79]
  v_exp_f32 v220, v156
  v_mfma_f32_16x16x32_bf16 a[80:83], a[168:171], v[176:179], a[80:83]
  ds_read_b128 a[136:139], v3 offset:2048
  v_cvt_pk_bf16_f32 v188, v216, v217
  v_mfma_f32_16x16x32_bf16 a[84:87], a[168:171], v[180:183], a[84:87]
  v_exp_f32 v221, v157
  v_mfma_f32_16x16x32_bf16 a[88:91], a[172:175], v[176:179], a[88:91]
  ds_read_b128 a[140:143], v3 offset:3072
  v_add_f32 v227, v227, v218
  v_add_f32 v227, v227, v219
  v_mfma_f32_16x16x32_bf16 a[92:95], a[172:175], v[180:183], a[92:95]
  s_waitcnt lgkmcnt(4)
  v_exp_f32 v222, v158
  v_mfma_f32_16x16x32_bf16 a[96:99], a[176:179], v[176:179], a[96:99]
  ds_read_b128 a[144:147], v3 offset:4096
  buffer_load_dwordx4 v2, s[44:47], s26 offen offset:3072 sc1 lds
  v_cvt_pk_bf16_f32 v189, v218, v219
  v_mfma_f32_16x16x32_bf16 a[100:103], a[176:179], v[180:183], a[100:103]
  s_add_u32 s26, s26, 16384
  v_exp_f32 v223, v159
  v_mfma_f32_16x16x32_bf16 a[104:107], a[180:183], v[176:179], a[104:107]
  s_add_u32 s24, s24, 32768
  ds_read_b128 a[148:151], v3 offset:5120
  v_add_f32 v227, v227, v220
  v_mfma_f32_16x16x32_bf16 a[108:111], a[180:183], v[180:183], a[108:111]
  s_and_b32 s24, s24, 0x1ffff
  v_add_f32 v227, v227, v221
  v_cvt_pk_bf16_f32 v190, v220, v221
  v_add_f32 v227, v227, v222
  v_mfma_f32_16x16x32_bf16 a[112:115], a[184:187], v[176:179], a[112:115]
  ds_read_b128 a[152:155], v3 offset:6144
  v_add_f32 v227, v227, v223
  v_max_f32 v5, v226, v227
  v_cmp_lt_f32 vcc, s81, v5
  v_mfma_f32_16x16x32_bf16 a[116:119], a[184:187], v[180:183], a[116:119]
  v_exp_f32 v216, v128
  v_mfma_f32_16x16x32_bf16 a[120:123], a[188:191], v[176:179], a[120:123]
  s_waitcnt lgkmcnt(3)
  ds_read_b128 a[156:159], v3 offset:7168
  v_cvt_pk_bf16_f32 v191, v222, v223
  v_mfma_f32_16x16x32_bf16 a[124:127], a[188:191], v[180:183], a[124:127]
  s_cbranch_vccnz fa_stub14
fa_back14:
  v_exp_f32 v217, v129
  v_add_f32 v230, v230, v226
  v_add_f32 v231, v231, v227
  v_mfma_f32_16x16x32_bf16 v[144:147], a[128:131], v[64:67], v[200:203]
  ds_read_b128 a[160:163], v3 offset:24576
  v_add_f32 v226, v216, v217
  v_mfma_f32_16x16x32_bf16 v[152:155], a[128:131], v[68:71], v[204:207]
  v_exp_f32 v218, v130
  v_mfma_f32_16x16x32_bf16 v[148:151], a[132:135], v[64:67], v[200:203]
  s_add_u32 s66, s66, 32768
  ds_read_b128 a[164:167], v3 offset:25600
  v_cvt_pk_bf16_f32 v176, v216, v217
  v_mfma_f32_16x16x32_bf16 v[156:159], a[132:135], v[68:71], v[204:207]
  s_mov_b32 m0, s25
  v_exp_f32 v219, v131
  v_mfma_f32_16x16x32_bf16 v[144:147], a[136:139], v[72:75], v[144:147]
  s_and_b32 s66, s66, 0x1ffff
  ds_read_b128 a[168:171], v3 offset:26624
  buffer_load_dwordx4 v2, s[48:51], s27 offen offset:0 sc1 lds
  v_add_f32 v226, v226, v218
  v_add_f32 v226, v226, v219
  v_mfma_f32_16x16x32_bf16 v[152:155], a[136:139], v[76:79], v[152:155]
  v_exp_f32 v220, v132
  v_mfma_f32_16x16x32_bf16 v[148:151], a[140:143], v[72:75], v[148:151]
  ds_read_b128 a[172:175], v3 offset:27648
  v_cvt_pk_bf16_f32 v177, v218, v219
  v_mfma_f32_16x16x32_bf16 v[156:159], a[140:143], v[76:79], v[156:159]
  s_waitcnt lgkmcnt(4)
  v_exp_f32 v221, v133
  v_mfma_f32_16x16x32_bf16 v[144:147], a[144:147], v[80:83], v[144:147]
  s_add_u32 s14, s13, 4096
  ds_read_b128 a[176:179], v3 offset:28672
  buffer_load_dwordx4 a[208:211], v2, s[40:43], s14 offen offset:0 sc1
  v_add_f32 v226, v226, v220
  v_mfma_f32_16x16x32_bf16 v[152:155], a[144:147], v[84:87], v[152:155]
  v_exp_f32 v222, v134
  v_mfma_f32_16x16x32_bf16 v[148:151], a[148:151], v[80:83], v[148:151]
  ds_read_b128 a[180:183], v3 offset:29696
  buffer_load_dwordx4 v2, s[48:51], s27 offen offset:1024 sc1 lds
  v_add_f32 v226, v226, v221
  v_cvt_pk_bf16_f32 v178, v220, v221
  v_mfma_f32_16x16x32_bf16 v[156:159], a[148:151], v[84:87], v[156:159]
  v_exp_f32 v223, v135
  v_mfma_f32_16x16x32_bf16 v[144:147], a[152:155], v[88:91], v[144:147]
  ds_read_b128 a[184:187], v3 offset:30720
  v_add_f32 v226, v226, v222
  v_mfma_f32_16x16x32_bf16 v[152:155], a[152:155], v[92:95], v[152:155]
  v_exp_f32 v216, v136
  v_mfma_f32_16x16x32_bf16 v[148:151], a[156:159], v[88:91], v[148:151]
  ds_read_b128 a[188:191], v3 offset:31744
  v_add_f32 v226, v226, v223
  v_exp_f32 v217, v137
  v_mfma_f32_16x16x32_bf16 v[156:159], a[156:159], v[92:95], v[156:159]
  s_waitcnt lgkmcnt(4)
  v_exp_f32 v218, v138
  v_mfma_f32_16x16x32_bf16 a[64:67], a[160:163], v[184:187], a[64:67]
  ds_read_b128 a[128:131], v3 offset:8192
  v_cvt_pk_bf16_f32 v179, v222, v223
  v_mfma_f32_16x16x32_bf16 a[68:71], a[160:163], v[188:191], a[68:71]
  v_exp_f32 v219, v139
  v_mfma_f32_16x16x32_bf16 a[72:75], a[164:167], v[184:187], a[72:75]
  ds_read_b128 a[132:135], v3 offset:9216
  buffer_load_dwordx4 v2, s[48:51], s27 offen offset:2048 sc1 lds
  v_add_f32 v227, v216, v217
  v_mfma_f32_16x16x32_bf16 a[76:79], a[164:167], v[188:191], a[76:79]
  v_exp_f32 v220, v140
  v_mfma_f32_16x16x32_bf16 a[80:83], a[168:171], v[184:187], a[80:83]
  ds_read_b128 a[136:139], v3 offset:10240
  v_cvt_pk_bf16_f32 v180, v216, v217
  v_mfma_f32_16x16x32_bf16 a[84:87], a[168:171], v[188:191], a[84:87]
  v_exp_f32 v221, v141
  v_mfma_f32_16x16x32_bf16 a[88:91], a[172:175], v[184:187], a[88:91]
  ds_read_b128 a[140:143], v3 offset:11264
  buffer_load_dwordx4 a[212:215], v2, s[40:43], s14 offen offset:1024 sc1
  v_add_f32 v227, v227, v218
  v_mfma_f32_16x16x32_bf16 a[92:95], a[172:175], v[188:191], a[92:95]
  s_waitcnt lgkmcnt(4)
  v_exp_f32 v222, v142
  v_mfma_f32_16x16x32_bf16 a[96:99], a[176:179], v[184:187], a[96:99]
  ds_read_b128 a[144:147], v3 offset:12288
  buffer_load_dwordx4 v2, s[48:51], s27 offen offset:3072 sc1 lds
  v_add_f32 v227, v227, v219
  v_cvt_pk_bf16_f32 v181, v218, v219
  v_mfma_f32_16x16x32_bf16 a[100:103], a[176:179], v[188:191], a[100:103]
  s_add_u32 s27, s27, 16384
  v_exp_f32 v223, v143
  v_mfma_f32_16x16x32_bf16 a[104:107], a[180:183], v[184:187], a[104:107]
  s_add_u32 s25, s25, 32768
  ds_read_b128 a[148:151], v3 offset:13312
  v_add_f32 v227, v227, v220
  v_mfma_f32_16x16x32_bf16 a[108:111], a[180:183], v[188:191], a[108:111]
  s_and_b32 s25, s25, 0x1ffff
  v_add_f32 v227, v227, v221
  v_cvt_pk_bf16_f32 v182, v220, v221
  v_add_f32 v227, v227, v222
  v_mfma_f32_16x16x32_bf16 a[112:115], a[184:187], v[184:187], a[112:115]
  ds_read_b128 a[152:155], v3 offset:14336
  v_add_f32 v227, v227, v223
  v_max_f32 v5, v226, v227
  v_cmp_lt_f32 vcc, s81, v5
  v_mfma_f32_16x16x32_bf16 a[116:119], a[184:187], v[188:191], a[116:119]
  v_exp_f32 v216, v144
  v_mfma_f32_16x16x32_bf16 a[120:123], a[188:191], v[184:187], a[120:123]
  s_waitcnt lgkmcnt(3)
  ds_read_b128 a[156:159], v3 offset:15360
  v_cvt_pk_bf16_f32 v183, v222, v223
  v_add_u32 v3, s66, v2
  v_mfma_f32_16x16x32_bf16 a[124:127], a[188:191], v[188:191], a[124:127]
  s_cbranch_vccnz fa_stub15
fa_back15:
  v_exp_f32 v217, v145
  v_add_f32 v230, v230, v226
  v_add_f32 v231, v231, v227
fa_SSW6:
  v_mfma_f32_16x16x32_bf16 v[128:131], a[128:131], v[64:67], v[200:203]
  s_waitcnt vmcnt(12)
  v_exp_f32 v218, v146
  v_mfma_f32_16x16x32_bf16 v[136:139], a[128:131], v[68:71], v[204:207]
  s_barrier
  v_exp_f32 v219, v147
  v_mfma_f32_16x16x32_bf16 v[132:135], a[132:135], v[64:67], v[200:203]
  ds_read_b128 a[160:163], v3 offset:16384
  ds_read_b128 a[164:167], v3 offset:17408
  v_add_f32 v226, v216, v217
  v_mfma_f32_16x16x32_bf16 v[140:143], a[132:135], v[68:71], v[204:207]
  s_mov_b32 m0, s24
  v_exp_f32 v220, v148
  v_mfma_f32_16x16x32_bf16 v[128:131], a[136:139], v[72:75], v[128:131]
  ds_read_b128 a[168:171], v3 offset:18432
  buffer_load_dwordx4 v2, s[44:47], s26 offen offset:0 sc1 lds
  v_cvt_pk_bf16_f32 v184, v216, v217
  v_mfma_f32_16x16x32_bf16 v[136:139], a[136:139], v[76:79], v[136:139]
  v_exp_f32 v221, v149
  v_mfma_f32_16x16x32_bf16 v[132:135], a[140:143], v[72:75], v[132:135]
  ds_read_b128 a[172:175], v3 offset:19456
  v_add_f32 v226, v226, v218
  v_add_f32 v226, v226, v219
  v_mfma_f32_16x16x32_bf16 v[140:143], a[140:143], v[76:79], v[140:143]
  s_waitcnt lgkmcnt(4)
  v_exp_f32 v222, v150
  v_mfma_f32_16x16x32_bf16 v[128:131], a[144:147], v[80:83], v[128:131]
  s_add_u32 s14, s13, 4096
  ds_read_b128 a[176:179], v3 offset:20480
  buffer_load_dwordx4 a[216:219], v2, s[40:43], s14 offen offset:2048 sc1
  v_cvt_pk_bf16_f32 v185, v218, v219
  v_mfma_f32_16x16x32_bf16 v[136:139], a[144:147], v[84:87], v[136:139]
  v_exp_f32 v223, v151
  v_mfma_f32_16x16x32_bf16 v[132:135], a[148:151], v[80:83], v[132:135]
  ds_read_b128 a[180:183], v3 offset:21504
  buffer_load_dwordx4 v2, s[44:47], s26 offen offset:1024 sc1 lds
  v_add_f32 v226, v226, v220
  v_mfma_f32_16x16x32_bf16 v[140:143], a[148:151], v[84:87], v[140:143]
  v_exp_f32 v216, v152
  v_mfma_f32_16x16x32_bf16 v[128:131], a[152:155], v[88:91], v[128:131]
  ds_read_b128 a[184:187], v3 offset:22528
  v_add_f32 v226, v226, v221
  v_cvt_pk_bf16_f32 v186, v220, v221
  v_mfma_f32_16x16x32_bf16 v[136:139], a[152:155], v[92:95], v[136:139]
  v_exp_f32 v217, v153
  v_mfma_f32_16x16x32_bf16 v[132:135], a[156:159], v[88:91], v[132:135]
  ds_read_b128 a[188:191], v3 offset:23552
  v_add_f32 v226, v226, v222
  v_mfma_f32_16x16x32_bf16 v[140:143], a[156:159], v[92:95], v[140:143]
  s_waitcnt lgkmcnt(4)
  v_exp_f32 v218, v154
  v_mfma_f32_16x16x32_bf16 a[64:67], a[160:163], v[176:179], a[64:67]
  ds_read_b128 a[128:131], v3 offset:0
  v_add_f32 v226, v226, v223
  v_cvt_pk_bf16_f32 v187, v222, v223
  v_mfma_f32_16x16x32_bf16 a[68:71], a[160:163], v[180:183], a[68:71]
  v_exp_f32 v219, v155
  v_mfma_f32_16x16x32_bf16 a[72:75], a[164:167], v[176:179], a[72:75]
  ds_read_b128 a[132:135], v3 offset:1024
  buffer_load_dwordx4 v2, s[44:47], s26 offen offset:2048 sc1 lds
  v_add_f32 v227, v216, v217
  v_mfma_f32_16x16x32_bf16 a[76:79], a[164:167], v[180:183], a[76:79]
  v_exp_f32 v220, v156
  v_mfma_f32_16x16x32_bf16 a[80:83], a[168:171], v[176:179], a[80:83]
  ds_read_b128 a[136:139], v3 offset:2048
  v_cvt_pk_bf16_f32 v188, v216, v217
  v_mfma_f32_16x16x32_bf16 a[84:87], a[168:171], v[180:183], a[84:87]
  v_exp_f32 v221, v157
  v_mfma_f32_16x16x32_bf16 a[88:91], a[172:175], v[176:179], a[88:91]
  ds_read_b128 a[140:143], v3 offset:3072
  buffer_load_dwordx4 a[220:223], v2, s[40:43], s14 offen offset:3072 sc1
  v_add_f32 v227, v227, v218
  v_add_f32 v227, v227, v219
  v_mfma_f32_16x16x32_bf16 a[92:95], a[172:175], v[180:183], a[92:95]
  s_waitcnt lgkmcnt(4)
  v_exp_f32 v222, v158
  v_mfma_f32_16x16x32_bf16 a[96:99], a[176:179], v[176:179], a[96:99]
  ds_read_b128 a[144:147], v3 offset:4096
  buffer_load_dwordx4 v2, s[44:47], s26 offen offset:3072 sc1 lds
  v_cvt_pk_bf16_f32 v189, v218, v219
  v_mfma_f32_16x16x32_bf16 a[100:103], a[176:179], v[180:183], a[100:103]
  s_add_u32 s26, s26, 16384
  v_exp_f32 v223, v159
  v_mfma_f32_16x16x32_bf16 a[104:107], a[180:183], v[176:179], a[104:107]
  s_add_u32 s24, s24, 32768
  ds_read_b128 a[148:151], v3 offset:5120
  v_add_f32 v227, v227, v220
  v_mfma_f32_16x16x32_bf16 a[108:111], a[180:183], v[180:183], a[108:111]
  s_and_b32 s24, s24, 0x1ffff
  v_add_f32 v227, v227, v221
  v_cvt_pk_bf16_f32 v190, v220, v221
  v_add_f32 v227, v227, v222
  v_mfma_f32_16x16x32_bf16 a[112:115], a[184:187], v[176:179], a[112:115]
  ds_read_b128 a[152:155], v3 offset:6144
  v_add_f32 v227, v227, v223
  v_max_f32 v5, v226, v227
  v_cmp_lt_f32 vcc, s81, v5
  v_mfma_f32_16x16x32_bf16 a[116:119], a[184:187], v[180:183], a[116:119]
  v_exp_f32 v216, v128
  v_mfma_f32_16x16x32_bf16 a[120:123], a[188:191], v[176:179], a[120:123]
  s_waitcnt lgkmcnt(3)
  ds_read_b128 a[156:159], v3 offset:7168
  v_cvt_pk_bf16_f32 v191, v222, v223
  v_mfma_f32_16x16x32_bf16 a[124:127], a[188:191], v[180:183], a[124:127]
  s_cbranch_vccnz fa_stub16
fa_back16:
  v_exp_f32 v217, v129
  v_add_f32 v230, v230, v226
  v_add_f32 v231, v231, v227
  v_mfma_f32_16x16x32_bf16 v[144:147], a[128:131], v[64:67], v[200:203]
  ds_read_b128 a[160:163], v3 offset:24576
  v_add_f32 v226, v216, v217
  v_mfma_f32_16x16x32_bf16 v[152:155], a[128:131], v[68:71], v[204:207]
  v_exp_f32 v218, v130
  v_mfma_f32_16x16x32_bf16 v[148:151], a[132:135], v[64:67], v[200:203]
  s_add_u32 s66, s66, 32768
  ds_read_b128 a[164:167], v3 offset:25600
  v_cvt_pk_bf16_f32 v176, v216, v217
  v_mfma_f32_16x16x32_bf16 v[156:159], a[132:135], v[68:71], v[204:207]
  s_mov_b32 m0, s25
  v_exp_f32 v219, v131
  v_mfma_f32_16x16x32_bf16 v[144:147], a[136:139], v[72:75], v[144:147]
  s_and_b32 s66, s66, 0x1ffff
  ds_read_b128 a[168:171], v3 offset:26624
  buffer_load_dwordx4 v2, s[48:51], s27 offen offset:0 sc1 lds
  v_add_f32 v226, v226, v218
  v_add_f32 v226, v226, v219
  v_mfma_f32_16x16x32_bf16 v[152:155], a[136:139], v[76:79], v[152:155]
  v_exp_f32 v220, v132
  v_mfma_f32_16x16x32_bf16 v[148:151], a[140:143], v[72:75], v[148:151]
  ds_read_b128 a[172:175], v3 offset:27648
  v_cvt_pk_bf16_f32 v177, v218, v219
  v_mfma_f32_16x16x32_bf16 v[156:159], a[140:143], v[76:79], v[156:159]
  s_waitcnt lgkmcnt(4)
  v_exp_f32 v221, v133
  v_mfma_f32_16x16x32_bf16 v[144:147], a[144:147], v[80:83], v[144:147]
  s_add_u32 s14, s13, 8192
  ds_read_b128 a[176:179], v3 offset:28672
  buffer_load_dwordx4 a[224:227], v2, s[40:43], s14 offen offset:0 sc1
  v_add_f32 v226, v226, v220
  v_mfma_f32_16x16x32_bf16 v[152:155], a[144:147], v[84:87], v[152:155]
  v_exp_f32 v222, v134
  v_mfma_f32_16x16x32_bf16 v[148:151], a[148:151], v[80:83], v[148:151]
  ds_read_b128 a[180:183], v3 offset:29696
  buffer_load_dwordx4 v2, s[48:51], s27 offen offset:1024 sc1 lds
  v_add_f32 v226, v226, v221
  v_cvt_pk_bf16_f32 v178, v220, v221
  v_mfma_f32_16x16x32_bf16 v[156:159], a[148:151], v[84:87], v[156:159]
  v_exp_f32 v223, v135
  v_mfma_f32_16x16x32_bf16 v[144:147], a[152:155], v[88:91], v[144:147]
  ds_read_b128 a[184:187], v3 offset:30720
  v_add_f32 v226, v226, v222
  v_mfma_f32_16x16x32_bf16 v[152:155], a[152:155], v[92:95], v[152:155]
  v_exp_f32 v216, v136
  v_mfma_f32_16x16x32_bf16 v[148:151], a[156:159], v[88:91], v[148:151]
  ds_read_b128 a[188:191], v3 offset:31744
  v_add_f32 v226, v226, v223
  v_exp_f32 v217, v137
  v_mfma_f32_16x16x32_bf16 v[156:159], a[156:159], v[92:95], v[156:159]
  s_waitcnt lgkmcnt(4)
  v_exp_f32 v218, v138
  v_mfma_f32_16x16x32_bf16 a[64:67], a[160:163], v[184:187], a[64:67]
  ds_read_b128 a[128:131], v3 offset:8192
  v_cvt_pk_bf16_f32 v179, v222, v223
  v_mfma_f32_16x16x32_bf16 a[68:71], a[160:163], v[188:191], a[68:71]
  v_exp_f32 v219, v139
  v_mfma_f32_16x16x32_bf16 a[72:75], a[164:167], v[184:187], a[72:75]
  ds_read_b128 a[132:135], v3 offset:9216
  buffer_load_dwordx4 v2, s[48:51], s27 offen offset:2048 sc1 lds
  v_add_f32 v227, v216, v217
  v_mfma_f32_16x16x32_bf16 a[76:79], a[164:167], v[188:191], a[76:79]
  v_exp_f32 v220, v140
  v_mfma_f32_16x16x32_bf16 a[80:83], a[168:171], v[184:187], a[80:83]
  ds_read_b128 a[136:139], v3 offset:10240
  v_cvt_pk_bf16_f32 v180, v216, v217
  v_mfma_f32_16x16x32_bf16 a[84:87], a[168:171], v[188:191], a[84:87]
  v_exp_f32 v221, v141
  v_mfma_f32_16x16x32_bf16 a[88:91], a[172:175], v[184:187], a[88:91]
  ds_read_b128 a[140:143], v3 offset:11264
  buffer_load_dwordx4 a[228:231], v2, s[40:43], s14 offen offset:1024 sc1
  v_add_f32 v227, v227, v218
  v_mfma_f32_16x16x32_bf16 a[92:95], a[172:175], v[188:191], a[92:95]
  s_waitcnt lgkmcnt(4)
  v_exp_f32 v222, v142
  v_mfma_f32_16x16x32_bf16 a[96:99], a[176:179], v[184:187], a[96:99]
  ds_read_b128 a[144:147], v3 offset:12288
  buffer_load_dwordx4 v2, s[48:51], s27 offen offset:3072 sc1 lds
  v_add_f32 v227, v227, v219
  v_cvt_pk_bf16_f32 v181, v218, v219
  v_mfma_f32_16x16x32_bf16 a[100:103], a[176:179], v[188:191], a[100:103]
  s_add_u32 s27, s27, 16384
  v_exp_f32 v223, v143
  v_mfma_f32_16x16x32_bf16 a[104:107], a[180:183], v[184:187], a[104:107]
  s_add_u32 s25, s25, 32768
  ds_read_b128 a[148:151], v3 offset:13312
  v_add_f32 v227, v227, v220
  v_mfma_f32_16x16x32_bf16 a[108:111], a[180:183], v[188:191], a[108:111]
  s_and_b32 s25, s25, 0x1ffff
  v_add_f32 v227, v227, v221
  v_cvt_pk_bf16_f32 v182, v220, v221
  v_add_f32 v227, v227, v222
  v_mfma_f32_16x16x32_bf16 a[112:115], a[184:187], v[184:187], a[112:115]
  ds_read_b128 a[152:155], v3 offset:14336
  v_add_f32 v227, v227, v223
  v_max_f32 v5, v226, v227
  v_cmp_lt_f32 vcc, s81, v5
  v_mfma_f32_16x16x32_bf16 a[116:119], a[184:187], v[188:191], a[116:119]
  v_exp_f32 v216, v144
  v_mfma_f32_16x16x32_bf16 a[120:123], a[188:191], v[184:187], a[120:123]
  s_waitcnt lgkmcnt(3)
  ds_read_b128 a[156:159], v3 offset:15360
  v_cvt_pk_bf16_f32 v183, v222, v223
  v_add_u32 v3, s66, v2
  v_mfma_f32_16x16x32_bf16 a[124:127], a[188:191], v[188:191], a[124:127]
  s_cbranch_vccnz fa_stub17
fa_back17:
  v_exp_f32 v217, v145
  v_add_f32 v230, v230, v226
  v_add_f32 v231, v231, v227
fa_SSW5:
  v_mfma_f32_16x16x32_bf16 v[128:131], a[128:131], v[64:67], v[200:203]
  s_waitcnt vmcnt(12)
  v_exp_f32 v218, v146
  v_mfma_f32_16x16x32_bf16 v[136:139], a[128:131], v[68:71], v[204:207]
  s_barrier
  v_exp_f32 v219, v147
  v_mfma_f32_16x16x32_bf16 v[132:135], a[132:135], v[64:67], v[200:203]
  ds_read_b128 a[160:163], v3 offset:16384
  ds_read_b128 a[164:167], v3 offset:17408
  v_add_f32 v226, v216, v217
  v_mfma_f32_16x16x32_bf16 v[140:143], a[132:135], v[68:71], v[204:207]
  s_mov_b32 m0, s24
  v_exp_f32 v220, v148
  v_mfma_f32_16x16x32_bf16 v[128:131], a[136:139], v[72:75], v[128:131]
  ds_read_b128 a[168:171], v3 offset:18432
  buffer_load_dwordx4 v2, s[44:47], s26 offen offset:0 sc1 lds
  v_cvt_pk_bf16_f32 v184, v216, v217
  v_mfma_f32_16x16x32_bf16 v[136:139], a[136:139], v[76:79], v[136:139]
  v_exp_f32 v221, v149
  v_mfma_f32_16x16x32_bf16 v[132:135], a[140:143], v[72:75], v[132:135]
  ds_read_b128 a[172:175], v3 offset:19456
  v_add_f32 v226, v226, v218
  v_add_f32 v226, v226, v219
  v_mfma_f32_16x16x32_bf16 v[140:143], a[140:143], v[76:79], v[140:143]
  s_waitcnt lgkmcnt(4)
  v_exp_f32 v222, v150
  v_mfma_f32_16x16x32_bf16 v[128:131], a[144:147], v[80:83], v[128:131]
  s_add_u32 s14, s13, 8192
  ds_read_b128 a[176:179], v3 offset:20480
  buffer_load_dwordx4 a[232:235], v2, s[40:43], s14 offen offset:2048 sc1
  v_cvt_pk_bf16_f32 v185, v218, v219
  v_mfma_f32_16x16x32_bf16 v[136:139], a[144:147], v[84:87], v[136:139]
  v_exp_f32 v223, v151
  v_mfma_f32_16x16x32_bf16 v[132:135], a[148:151], v[80:83], v[132:135]
  ds_read_b128 a[180:183], v3 offset:21504
  buffer_load_dwordx4 v2, s[44:47], s26 offen offset:1024 sc1 lds
  v_add_f32 v226, v226, v220
  v_mfma_f32_16x16x32_bf16 v[140:143], a[148:151], v[84:87], v[140:143]
  v_exp_f32 v216, v152
  v_mfma_f32_16x16x32_bf16 v[128:131], a[152:155], v[88:91], v[128:131]
  ds_read_b128 a[184:187], v3 offset:22528
  v_add_f32 v226, v226, v221
  v_cvt_pk_bf16_f32 v186, v220, v221
  v_mfma_f32_16x16x32_bf16 v[136:139], a[152:155], v[92:95], v[136:139]
  v_exp_f32 v217, v153
  v_mfma_f32_16x16x32_bf16 v[132:135], a[156:159], v[88:91], v[132:135]
  ds_read_b128 a[188:191], v3 offset:23552
  buffer_load_dwordx4 a[236:239], v2, s[40:43], s14 offen offset:3072 sc1
  v_add_f32 v226, v226, v222
  v_mfma_f32_16x16x32_bf16 v[140:143], a[156:159], v[92:95], v[140:143]
  s_waitcnt lgkmcnt(4)
  v_exp_f32 v218, v154
  v_mfma_f32_16x16x32_bf16 a[64:67], a[160:163], v[176:179], a[64:67]
  ds_read_b128 a[128:131], v3 offset:0
  v_add_f32 v226, v226, v223
  v_cvt_pk_bf16_f32 v187, v222, v223
  v_mfma_f32_16x16x32_bf16 a[68:71], a[160:163], v[180:183], a[68:71]
  v_exp_f32 v219, v155
  v_mfma_f32_16x16x32_bf16 a[72:75], a[164:167], v[176:179], a[72:75]
  ds_read_b128 a[132:135], v3 offset:1024
  buffer_load_dwordx4 v2, s[44:47], s26 offen offset:2048 sc1 lds
  v_add_f32 v227, v216, v217
  v_mfma_f32_16x16x32_bf16 a[76:79], a[164:167], v[180:183], a[76:79]
  v_exp_f32 v220, v156
  v_mfma_f32_16x16x32_bf16 a[80:83], a[168:171], v[176:179], a[80:83]
  ds_read_b128 a[136:139], v3 offset:2048
  v_cvt_pk_bf16_f32 v188, v216, v217
  v_mfma_f32_16x16x32_bf16 a[84:87], a[168:171], v[180:183], a[84:87]
  v_exp_f32 v221, v157
  v_mfma_f32_16x16x32_bf16 a[88:91], a[172:175], v[176:179], a[88:91]
  s_add_u32 s14, s13, 12288
  ds_read_b128 a[140:143], v3 offset:3072
  buffer_load_dwordx4 a[240:243], v2, s[40:43], s14 offen offset:0 sc1
  v_add_f32 v227, v227, v218
  v_add_f32 v227, v227, v219
  v_mfma_f32_16x16x32_bf16 a[92:95], a[172:175], v[180:183], a[92:95]
  s_waitcnt lgkmcnt(4)
  v_exp_f32 v222, v158
  v_mfma_f32_16x16x32_bf16 a[96:99], a[176:179], v[176:179], a[96:99]
  ds_read_b128 a[144:147], v3 offset:4096
  buffer_load_dwordx4 v2, s[44:47], s26 offen offset:3072 sc1 lds
  v_cvt_pk_bf16_f32 v189, v218, v219
  v_mfma_f32_16x16x32_bf16 a[100:103], a[176:179], v[180:183], a[100:103]
  s_add_u32 s26, s26, 16384
  v_exp_f32 v223, v159
  v_mfma_f32_16x16x32_bf16 a[104:107], a[180:183], v[176:179], a[104:107]
  s_add_u32 s24, s24, 32768
  ds_read_b128 a[148:151], v3 offset:5120
  v_add_f32 v227, v227, v220
  v_mfma_f32_16x16x32_bf16 a[108:111], a[180:183], v[180:183], a[108:111]
  s_and_b32 s24, s24, 0x1ffff
  v_add_f32 v227, v227, v221
  v_cvt_pk_bf16_f32 v190, v220, v221
  v_add_f32 v227, v227, v222
  v_mfma_f32_16x16x32_bf16 a[112:115], a[184:187], v[176:179], a[112:115]
  ds_read_b128 a[152:155], v3 offset:6144
  v_add_f32 v227, v227, v223
  v_max_f32 v5, v226, v227
  v_cmp_lt_f32 vcc, s81, v5
  v_mfma_f32_16x16x32_bf16 a[116:119], a[184:187], v[180:183], a[116:119]
  v_exp_f32 v216, v128
  v_mfma_f32_16x16x32_bf16 a[120:123], a[188:191], v[176:179], a[120:123]
  s_waitcnt lgkmcnt(3)
  ds_read_b128 a[156:159], v3 offset:7168
  v_cvt_pk_bf16_f32 v191, v222, v223
  v_mfma_f32_16x16x32_bf16 a[124:127], a[188:191], v[180:183], a[124:127]
  s_cbranch_vccnz fa_stub18
fa_back18:
  v_exp_f32 v217, v129
  v_add_f32 v230, v230, v226
  v_add_f32 v231, v231, v227
  v_mfma_f32_16x16x32_bf16 v[144:147], a[128:131], v[64:67], v[200:203]
  ds_read_b128 a[160:163], v3 offset:24576
  v_add_f32 v226, v216, v217
  v_mfma_f32_16x16x32_bf16 v[152:155], a[128:131], v[68:71], v[204:207]
  v_exp_f32 v218, v130
  v_mfma_f32_16x16x32_bf16 v[148:151], a[132:135], v[64:67], v[200:203]
  s_add_u32 s66, s66, 32768
  ds_read_b128 a[164:167], v3 offset:25600
  v_cvt_pk_bf16_f32 v176, v216, v217
  v_mfma_f32_16x16x32_bf16 v[156:159], a[132:135], v[68:71], v[204:207]
  s_mov_b32 m0, s25
  v_exp_f32 v219, v131
  v_mfma_f32_16x16x32_bf16 v[144:147], a[136:139], v[72:75], v[144:147]
  s_and_b32 s66, s66, 0x1ffff
  ds_read_b128 a[168:171], v3 offset:26624
  buffer_load_dwordx4 v2, s[48:51], s27 offen offset:0 sc1 lds
  v_add_f32 v226, v226, v218
  v_add_f32 v226, v226, v219
  v_mfma_f32_16x16x32_bf16 v[152:155], a[136:139], v[76:79], v[152:155]
  v_exp_f32 v220, v132
  v_mfma_f32_16x16x32_bf16 v[148:151], a[140:143], v[72:75], v[148:151]
  ds_read_b128 a[172:175], v3 offset:27648
  v_cvt_pk_bf16_f32 v177, v218, v219
  v_mfma_f32_16x16x32_bf16 v[156:159], a[140:143], v[76:79], v[156:159]
  s_waitcnt lgkmcnt(4)
  v_exp_f32 v221, v133
  v_mfma_f32_16x16x32_bf16 v[144:147], a[144:147], v[80:83], v[144:147]
  s_add_u32 s14, s13, 12288
  ds_read_b128 a[176:179], v3 offset:28672
  buffer_load_dwordx4 a[244:247], v2, s[40:43], s14 offen offset:1024 sc1
  v_add_f32 v226, v226, v220
  v_mfma_f32_16x16x32_bf16 v[152:155], a[144:147], v[84:87], v[152:155]
  v_exp_f32 v222, v134
  v_mfma_f32_16x16x32_bf16 v[148:151], a[148:151], v[80:83], v[148:151]
  ds_read_b128 a[180:183], v3 offset:29696
  buffer_load_dwordx4 v2, s[48:51], s27 offen offset:1024 sc1 lds
  v_add_f32 v226, v226, v221
  v_cvt_pk_bf16_f32 v178, v220, v221
  v_mfma_f32_16x16x32_bf16 v[156:159], a[148:151], v[84:87], v[156:159]
  v_exp_f32 v223, v135
  v_mfma_f32_16x16x32_bf16 v[144:147], a[152:155], v[88:91], v[144:147]
  ds_read_b128 a[184:187], v3 offset:30720
  v_add_f32 v226, v226, v222
  v_mfma_f32_16x16x32_bf16 v[152:155], a[152:155], v[92:95], v[152:155]
  v_exp_f32 v216, v136
  v_mfma_f32_16x16x32_bf16 v[148:151], a[156:159], v[88:91], v[148:151]
  ds_read_b128 a[188:191], v3 offset:31744
  buffer_load_dwordx4 a[248:251], v2, s[40:43], s14 offen offset:2048 sc1
  v_add_f32 v226, v226, v223
  v_exp_f32 v217, v137
  v_mfma_f32_16x16x32_bf16 v[156:159], a[156:159], v[92:95], v[156:159]
  s_waitcnt lgkmcnt(4)
  v_exp_f32 v218, v138
  v_mfma_f32_16x16x32_bf16 a[64:67], a[160:163], v[184:187], a[64:67]
  ds_read_b128 a[128:131], v3 offset:8192
  v_cvt_pk_bf16_f32 v179, v222, v223
  v_mfma_f32_16x16x32_bf16 a[68:71], a[160:163], v[188:191], a[68:71]
  v_exp_f32 v219, v139
  v_mfma_f32_16x16x32_bf16 a[72:75], a[164:167], v[184:187], a[72:75]
  ds_read_b128 a[132:135], v3 offset:9216
  buffer_load_dwordx4 v2, s[48:51], s27 offen offset:2048 sc1 lds
  v_add_f32 v227, v216, v217
  v_mfma_f32_16x16x32_bf16 a[76:79], a[164:167], v[188:191], a[76:79]
  v_exp_f32 v220, v140
  v_mfma_f32_16x16x32_bf16 a[80:83], a[168:171], v[184:187], a[80:83]
  ds_read_b128 a[136:139], v3 offset:10240
  v_cvt_pk_bf16_f32 v180, v216, v217
  v_mfma_f32_16x16x32_bf16 a[84:87], a[168:171], v[188:191], a[84:87]
  v_exp_f32 v221, v141
  v_mfma_f32_16x16x32_bf16 a[88:91], a[172:175], v[184:187], a[88:91]
  ds_read_b128 a[140:143], v3 offset:11264
  buffer_load_dwordx4 a[252:255], v2, s[40:43], s14 offen offset:3072 sc1
  v_add_f32 v227, v227, v218
  v_mfma_f32_16x16x32_bf16 a[92:95], a[172:175], v[188:191], a[92:95]
  s_waitcnt lgkmcnt(4)
  v_exp_f32 v222, v142
  v_mfma_f32_16x16x32_bf16 a[96:99], a[176:179], v[184:187], a[96:99]
  ds_read_b128 a[144:147], v3 offset:12288
  buffer_load_dwordx4 v2, s[48:51], s27 offen offset:3072 sc1 lds
  v_add_f32 v227, v227, v219
  v_cvt_pk_bf16_f32 v181, v218, v219
  v_mfma_f32_16x16x32_bf16 a[100:103], a[176:179], v[188:191], a[100:103]
  s_add_u32 s27, s27, 16384
  v_exp_f32 v223, v143
  v_mfma_f32_16x16x32_bf16 a[104:107], a[180:183], v[184:187], a[104:107]
  s_add_u32 s25, s25, 32768
  ds_read_b128 a[148:151], v3 offset:13312
  v_add_f32 v227, v227, v220
  v_mfma_f32_16x16x32_bf16 a[108:111], a[180:183], v[188:191], a[108:111]
  s_and_b32 s25, s25, 0x1ffff
  v_add_f32 v227, v227, v221
  v_cvt_pk_bf16_f32 v182, v220, v221
  v_add_f32 v227, v227, v222
  v_mfma_f32_16x16x32_bf16 a[112:115], a[184:187], v[184:187], a[112:115]
  ds_read_b128 a[152:155], v3 offset:14336
  v_add_f32 v227, v227, v223
  v_max_f32 v5, v226, v227
  v_cmp_lt_f32 vcc, s81, v5
  v_mfma_f32_16x16x32_bf16 a[116:119], a[184:187], v[188:191], a[116:119]
  v_exp_f32 v216, v144
  v_mfma_f32_16x16x32_bf16 a[120:123], a[188:191], v[184:187], a[120:123]
  s_waitcnt lgkmcnt(3)
  ds_read_b128 a[156:159], v3 offset:15360
  v_cvt_pk_bf16_f32 v183, v222, v223
  v_add_u32 v3, s66, v2
  v_mfma_f32_16x16x32_bf16 a[124:127], a[188:191], v[188:191], a[124:127]
  s_cbranch_vccnz fa_stub19
fa_back19:
  v_exp_f32 v217, v145
  v_add_f32 v230, v230, v226
  v_add_f32 v231, v231, v227
fa_SSW4:
  v_mfma_f32_16x16x32_bf16 v[128:131], a[128:131], v[64:67], v[200:203]
  s_waitcnt vmcnt(12)
  v_exp_f32 v218, v146
  v_mfma_f32_16x16x32_bf16 v[136:139], a[128:131], v[68:71], v[204:207]
  s_barrier
  v_exp_f32 v219, v147
  v_mfma_f32_16x16x32_bf16 v[132:135], a[132:135], v[64:67], v[200:203]
  ds_read_b128 a[160:163], v3 offset:16384
  ds_read_b128 a[164:167], v3 offset:17408
  v_add_f32 v226, v216, v217
  v_mfma_f32_16x16x32_bf16 v[140:143], a[132:135], v[68:71], v[204:207]
  s_mov_b32 m0, s24
  v_exp_f32 v220, v148
  v_mfma_f32_16x16x32_bf16 v[128:131], a[136:139], v[72:75], v[128:131]
  ds_read_b128 a[168:171], v3 offset:18432
  buffer_load_dwordx4 v2, s[44:47], s26 offen offset:0 sc1 lds
  v_cvt_pk_bf16_f32 v184, v216, v217
  v_mfma_f32_16x16x32_bf16 v[136:139], a[136:139], v[76:79], v[136:139]
  v_exp_f32 v221, v149
  v_mfma_f32_16x16x32_bf16 v[132:135], a[140:143], v[72:75], v[132:135]
  s_add_u32 s14, s13, 16384
  ds_read_b128 a[172:175], v3 offset:19456
  buffer_load_dwordx4 a[0:3], v2, s[40:43], s14 offen offset:0 sc1
  v_add_f32 v226, v226, v218
  v_add_f32 v226, v226, v219
  v_mfma_f32_16x16x32_bf16 v[140:143], a[140:143], v[76:79], v[140:143]
  s_waitcnt lgkmcnt(4)
  v_exp_f32 v222, v150
  v_mfma_f32_16x16x32_bf16 v[128:131], a[144:147], v[80:83], v[128:131]
  ds_read_b128 a[176:179], v3 offset:20480
  v_cvt_pk_bf16_f32 v185, v218, v219
  v_mfma_f32_16x16x32_bf16 v[136:139], a[144:147], v[84:87], v[136:139]
  v_exp_f32 v223, v151
  v_mfma_f32_16x16x32_bf16 v[132:135], a[148:151], v[80:83], v[132:135]
  ds_read_b128 a[180:183], v3 offset:21504
  buffer_load_dwordx4 v2, s[44:47], s26 offen offset:1024 sc1 lds
  v_add_f32 v226, v226, v220
  v_mfma_f32_16x16x32_bf16 v[140:143], a[148:151], v[84:87], v[140:143]
  v_exp_f32 v216, v152
  v_mfma_f32_16x16x32_bf16 v[128:131], a[152:155], v[88:91], v[128:131]
  ds_read_b128 a[184:187], v3 offset:22528
  v_add_f32 v226, v226, v221
  v_cvt_pk_bf16_f32 v186, v220, v221
  v_mfma_f32_16x16x32_bf16 v[136:139], a[152:155], v[92:95], v[136:139]
  v_exp_f32 v217, v153
  v_mfma_f32_16x16x32_bf16 v[132:135], a[156:159], v[88:91], v[132:135]
  ds_read_b128 a[188:191], v3 offset:23552
  buffer_load_dwordx4 a[4:7], v2, s[40:43], s14 offen offset:1024 sc1
  v_add_f32 v226, v226, v222
  v_mfma_f32_16x16x32_bf16 v[140:143], a[156:159], v[92:95], v[140:143]
  s_waitcnt lgkmcnt(4)
  v_exp_f32 v218, v154
  v_mfma_f32_16x16x32_bf16 a[64:67], a[160:163], v[176:179], a[64:67]
  ds_read_b128 a[128:131], v3 offset:0
  v_add_f32 v226, v226, v223
  v_cvt_pk_bf16_f32 v187, v222, v223
  v_mfma_f32_16x16x32_bf16 a[68:71], a[160:163], v[180:183], a[68:71]
  v_exp_f32 v219, v155
  v_mfma_f32_16x16x32_bf16 a[72:75], a[164:167], v[176:179], a[72:75]
  ds_read_b128 a[132:135], v3 offset:1024
  buffer_load_dwordx4 v2, s[44:47], s26 offen offset:2048 sc1 lds
  v_add_f32 v227, v216, v217
  v_mfma_f32_16x16x32_bf16 a[76:79], a[164:167], v[180:183], a[76:79]
  v_exp_f32 v220, v156
  v_mfma_f32_16x16x32_bf16 a[80:83], a[168:171], v[176:179], a[80:83]
  ds_read_b128 a[136:139], v3 offset:2048
  buffer_load_dwordx4 a[8:11], v2, s[40:43], s14 offen offset:2048 sc1
  v_cvt_pk_bf16_f32 v188, v216, v217
  v_mfma_f32_16x16x32_bf16 a[84:87], a[168:171], v[180:183], a[84:87]
  v_exp_f32 v221, v157
  v_mfma_f32_16x16x32_bf16 a[88:91], a[172:175], v[176:179], a[88:91]
  ds_read_b128 a[140:143], v3 offset:3072
  v_add_f32 v227, v227, v218
  v_add_f32 v227, v227, v219
  v_mfma_f32_16x16x32_bf16 a[92:95], a[172:175], v[180:183], a[92:95]
  s_waitcnt lgkmcnt(4)
  v_exp_f32 v222, v158
  v_mfma_f32_16x16x32_bf16 a[96:99], a[176:179], v[176:179], a[96:99]
  ds_read_b128 a[144:147], v3 offset:4096
  buffer_load_dwordx4 v2, s[44:47], s26 offen offset:3072 sc1 lds
  v_cvt_pk_bf16_f32 v189, v218, v219
  v_mfma_f32_16x16x32_bf16 a[100:103], a[176:179], v[180:183], a[100:103]
  s_add_u32 s26, s26, 16384
  v_exp_f32 v223, v159
  v_mfma_f32_16x16x32_bf16 a[104:107], a[180:183], v[176:179], a[104:107]
  s_add_u32 s24, s24, 32768
  ds_read_b128 a[148:151], v3 offset:5120
  buffer_load_dwordx4 a[12:15], v2, s[40:43], s14 offen offset:3072 sc1
  v_add_f32 v227, v227, v220
  v_mfma_f32_16x16x32_bf16 a[108:111], a[180:183], v[180:183], a[108:111]
  s_and_b32 s24, s24, 0x1ffff
  v_add_f32 v227, v227, v221
  v_cvt_pk_bf16_f32 v190, v220, v221
  v_add_f32 v227, v227, v222
  v_mfma_f32_16x16x32_bf16 a[112:115], a[184:187], v[176:179], a[112:115]
  ds_read_b128 a[152:155], v3 offset:6144
  v_add_f32 v227, v227, v223
  v_max_f32 v5, v226, v227
  v_cmp_lt_f32 vcc, s81, v5
  v_mfma_f32_16x16x32_bf16 a[116:119], a[184:187], v[180:183], a[116:119]
  v_exp_f32 v216, v128
  v_mfma_f32_16x16x32_bf16 a[120:123], a[188:191], v[176:179], a[120:123]
  s_waitcnt lgkmcnt(3)
  ds_read_b128 a[156:159], v3 offset:7168
  v_cvt_pk_bf16_f32 v191, v222, v223
  v_mfma_f32_16x16x32_bf16 a[124:127], a[188:191], v[180:183], a[124:127]
  s_cbranch_vccnz fa_stub20
fa_back20:
  v_exp_f32 v217, v129
  v_add_f32 v230, v230, v226
  v_add_f32 v231, v231, v227
  v_mfma_f32_16x16x32_bf16 v[144:147], a[128:131], v[64:67], v[200:203]
  ds_read_b128 a[160:163], v3 offset:24576
  v_add_f32 v226, v216, v217
  v_mfma_f32_16x16x32_bf16 v[152:155], a[128:131], v[68:71], v[204:207]
  v_exp_f32 v218, v130
  v_mfma_f32_16x16x32_bf16 v[148:151], a[132:135], v[64:67], v[200:203]
  s_add_u32 s66, s66, 32768
  ds_read_b128 a[164:167], v3 offset:25600
  v_cvt_pk_bf16_f32 v176, v216, v217
  v_mfma_f32_16x16x32_bf16 v[156:159], a[132:135], v[68:71], v[204:207]
  s_mov_b32 m0, s25
  v_exp_f32 v219, v131
  v_mfma_f32_16x16x32_bf16 v[144:147], a[136:139], v[72:75], v[144:147]
  s_and_b32 s66, s66, 0x1ffff
  ds_read_b128 a[168:171], v3 offset:26624
  buffer_load_dwordx4 v2, s[48:51], s27 offen offset:0 sc1 lds
  v_add_f32 v226, v226, v218
  v_add_f32 v226, v226, v219
  v_mfma_f32_16x16x32_bf16 v[152:155], a[136:139], v[76:79], v[152:155]
  v_exp_f32 v220, v132
  v_mfma_f32_16x16x32_bf16 v[148:151], a[140:143], v[72:75], v[148:151]
  s_add_u32 s14, s13, 20480
  ds_read_b128 a[172:175], v3 offset:27648
  buffer_load_dwordx4 a[16:19], v2, s[40:43], s14 offen offset:0 sc1
  v_cvt_pk_bf16_f32 v177, v218, v219
  v_mfma_f32_16x16x32_bf16 v[156:159], a[140:143], v[76:79], v[156:159]
  s_waitcnt lgkmcnt(4)
  v_exp_f32 v221, v133
  v_mfma_f32_16x16x32_bf16 v[144:147], a[144:147], v[80:83], v[144:147]
  ds_read_b128 a[176:179], v3 offset:28672
  v_add_f32 v226, v226, v220
  v_mfma_f32_16x16x32_bf16 v[152:155], a[144:147], v[84:87], v[152:155]
  v_exp_f32 v222, v134
  v_mfma_f32_16x16x32_bf16 v[148:151], a[148:151], v[80:83], v[148:151]
  ds_read_b128 a[180:183], v3 offset:29696
  buffer_load_dwordx4 v2, s[48:51], s27 offen offset:1024 sc1 lds
  v_add_f32 v226, v226, v221
  v_cvt_pk_bf16_f32 v178, v220, v221
  v_mfma_f32_16x16x32_bf16 v[156:159], a[148:151], v[84:87], v[156:159]
  v_exp_f32 v223, v135
  v_mfma_f32_16x16x32_bf16 v[144:147], a[152:155], v[88:91], v[144:147]
  ds_read_b128 a[184:187], v3 offset:30720
  v_add_f32 v226, v226, v222
  v_mfma_f32_16x16x32_bf16 v[152:155], a[152:155], v[92:95], v[152:155]
  v_exp_f32 v216, v136
  v_mfma_f32_16x16x32_bf16 v[148:151], a[156:159], v[88:91], v[148:151]
  ds_read_b128 a[188:191], v3 offset:31744
  buffer_load_dwordx4 a[20:23], v2, s[40:43], s14 offen offset:1024 sc1
  v_add_f32 v226, v226, v223
  v_exp_f32 v217, v137
  v_mfma_f32_16x16x32_bf16 v[156:159], a[156:159], v[92:95], v[156:159]
  s_waitcnt lgkmcnt(4)
  v_exp_f32 v218, v138
  v_mfma_f32_16x16x32_bf16 a[64:67], a[160:163], v[184:187], a[64:67]
  ds_read_b128 a[128:131], v3 offset:8192
  v_cvt_pk_bf16_f32 v179, v222, v223
  v_mfma_f32_16x16x32_bf16 a[68:71], a[160:163], v[188:191], a[68:71]
  v_exp_f32 v219, v139
  v_mfma_f32_16x16x32_bf16 a[72:75], a[164:167], v[184:187], a[72:75]
  ds_read_b128 a[132:135], v3 offset:9216
  buffer_load_dwordx4 v2, s[48:51], s27 offen offset:2048 sc1 lds
  v_add_f32 v227, v216, v217
  v_mfma_f32_16x16x32_bf16 a[76:79], a[164:167], v[188:191], a[76:79]
  v_exp_f32 v220, v140
  v_mfma_f32_16x16x32_bf16 a[80:83], a[168:171], v[184:187], a[80:83]
  ds_read_b128 a[136:139], v3 offset:10240
  buffer_load_dwordx4 a[24:27], v2, s[40:43], s14 offen offset:2048 sc1
  v_cvt_pk_bf16_f32 v180, v216, v217
  v_mfma_f32_16x16x32_bf16 a[84:87], a[168:171], v[188:191], a[84:87]
  v_exp_f32 v221, v141
  v_mfma_f32_16x16x32_bf16 a[88:91], a[172:175], v[184:187], a[88:91]
  ds_read_b128 a[140:143], v3 offset:11264
  v_add_f32 v227, v227, v218
  v_mfma_f32_16x16x32_bf16 a[92:95], a[172:175], v[188:191], a[92:95]
  s_waitcnt lgkmcnt(4)
  v_exp_f32 v222, v142
  v_mfma_f32_16x16x32_bf16 a[96:99], a[176:179], v[184:187], a[96:99]
  ds_read_b128 a[144:147], v3 offset:12288
  buffer_load_dwordx4 v2, s[48:51], s27 offen offset:3072 sc1 lds
  v_add_f32 v227, v227, v219
  v_cvt_pk_bf16_f32 v181, v218, v219
  v_mfma_f32_16x16x32_bf16 a[100:103], a[176:179], v[188:191], a[100:103]
  s_add_u32 s27, s27, 16384
  v_exp_f32 v223, v143
  v_mfma_f32_16x16x32_bf16 a[104:107], a[180:183], v[184:187], a[104:107]
  s_add_u32 s25, s25, 32768
  ds_read_b128 a[148:151], v3 offset:13312
  buffer_load_dwordx4 a[28:31], v2, s[40:43], s14 offen offset:3072 sc1
  v_add_f32 v227, v227, v220
  v_mfma_f32_16x16x32_bf16 a[108:111], a[180:183], v[188:191], a[108:111]
  s_and_b32 s25, s25, 0x1ffff
  v_add_f32 v227, v227, v221
  v_cvt_pk_bf16_f32 v182, v220, v221
  v_add_f32 v227, v227, v222
  v_mfma_f32_16x16x32_bf16 a[112:115], a[184:187], v[184:187], a[112:115]
  ds_read_b128 a[152:155], v3 offset:14336
  v_add_f32 v227, v227, v223
  v_max_f32 v5, v226, v227
  v_cmp_lt_f32 vcc, s81, v5
  v_mfma_f32_16x16x32_bf16 a[116:119], a[184:187], v[188:191], a[116:119]
  v_exp_f32 v216, v144
  v_mfma_f32_16x16x32_bf16 a[120:123], a[188:191], v[184:187], a[120:123]
  s_waitcnt lgkmcnt(3)
  ds_read_b128 a[156:159], v3 offset:15360
  v_cvt_pk_bf16_f32 v183, v222, v223
  v_add_u32 v3, s66, v2
  v_mfma_f32_16x16x32_bf16 a[124:127], a[188:191], v[188:191], a[124:127]
  s_cbranch_vccnz fa_stub21
fa_back21:
  v_exp_f32 v217, v145
  v_add_f32 v230, v230, v226
  v_add_f32 v231, v231, v227
fa_SSW3:
  v_mfma_f32_16x16x32_bf16 v[128:131], a[128:131], v[64:67], v[200:203]
  s_waitcnt vmcnt(12)
  v_exp_f32 v218, v146
  v_mfma_f32_16x16x32_bf16 v[136:139], a[128:131], v[68:71], v[204:207]
  s_barrier
  v_exp_f32 v219, v147
  v_mfma_f32_16x16x32_bf16 v[132:135], a[132:135], v[64:67], v[200:203]
  s_cmp_ge_u32 s26, s46
  s_cselect_b64 s[44:45], s[4:5], s[44:45]
  s_cselect_b32 s46, s30, s46
  ds_read_b128 a[160:163], v3 offset:16384
  ds_read_b128 a[164:167], v3 offset:17408
  v_add_f32 v226, v216, v217
  v_mfma_f32_16x16x32_bf16 v[140:143], a[132:135], v[68:71], v[204:207]
  s_mov_b32 m0, s24
  v_exp_f32 v220, v148
  v_mfma_f32_16x16x32_bf16 v[128:131], a[136:139], v[72:75], v[128:131]
  ds_read_b128 a[168:171], v3 offset:18432
  buffer_load_dwordx4 v2, s[44:47], s26 offen offset:0 sc1 lds
  v_cvt_pk_bf16_f32 v184, v216, v217
  v_mfma_f32_16x16x32_bf16 v[136:139], a[136:139], v[76:79], v[136:139]
  v_exp_f32 v221, v149
  v_mfma_f32_16x16x32_bf16 v[132:135], a[140:143], v[72:75], v[132:135]
  s_add_u32 s14, s13, 24576
  ds_read_b128 a[172:175], v3 offset:19456
  buffer_load_dwordx4 a[32:35], v2, s[40:43], s14 offen offset:0 sc1
  v_add_f32 v226, v226, v218
  v_add_f32 v226, v226, v219
  v_mfma_f32_16x16x32_bf16 v[140:143], a[140:143], v[76:79], v[140:143]
  s_waitcnt lgkmcnt(4)
  v_exp_f32 v222, v150
  v_mfma_f32_16x16x32_bf16 v[128:131], a[144:147], v[80:83], v[128:131]
  ds_read_b128 a[176:179], v3 offset:20480
  v_cvt_pk_bf16_f32 v185, v218, v219
  v_mfma_f32_16x16x32_bf16 v[136:139], a[144:147], v[84:87], v[136:139]
  v_exp_f32 v223, v151
  v_mfma_f32_16x16x32_bf16 v[132:135], a[148:151], v[80:83], v[132:135]
  ds_read_b128 a[180:183], v3 offset:21504
  buffer_load_dwordx4 v2, s[44:47], s26 offen offset:1024 sc1 lds
  v_add_f32 v226, v226, v220
  v_mfma_f32_16x16x32_bf16 v[140:143], a[148:151], v[84:87], v[140:143]
  v_exp_f32 v216, v152
  v_mfma_f32_16x16x32_bf16 v[128:131], a[152:155], v[88:91], v[128:131]
  ds_read_b128 a[184:187], v3 offset:22528
  v_add_f32 v226, v226, v221
  v_cvt_pk_bf16_f32 v186, v220, v221
  v_mfma_f32_16x16x32_bf16 v[136:139], a[152:155], v[92:95], v[136:139]
  v_exp_f32 v217, v153
  v_mfma_f32_16x16x32_bf16 v[132:135], a[156:159], v[88:91], v[132:135]
  ds_read_b128 a[188:191], v3 offset:23552
  buffer_load_dwordx4 a[36:39], v2, s[40:43], s14 offen offset:1024 sc1
  v_add_f32 v226, v226, v222
  v_mfma_f32_16x16x32_bf16 v[140:143], a[156:159], v[92:95], v[140:143]
  s_waitcnt lgkmcnt(4)
  v_exp_f32 v218, v154
  v_mfma_f32_16x16x32_bf16 a[64:67], a[160:163], v[176:179], a[64:67]
  ds_read_b128 a[128:131], v3 offset:0
  v_add_f32 v226, v226, v223
  v_cvt_pk_bf16_f32 v187, v222, v223
  v_mfma_f32_16x16x32_bf16 a[68:71], a[160:163], v[180:183], a[68:71]
  v_exp_f32 v219, v155
  v_mfma_f32_16x16x32_bf16 a[72:75], a[164:167], v[176:179], a[72:75]
  ds_read_b128 a[132:135], v3 offset:1024
  buffer_load_dwordx4 v2, s[44:47], s26 offen offset:2048 sc1 lds
  v_add_f32 v227, v216, v217
  v_mfma_f32_16x16x32_bf16 a[76:79], a[164:167], v[180:183], a[76:79]
  v_exp_f32 v220, v156
  v_mfma_f32_16x16x32_bf16 a[80:83], a[168:171], v[176:179], a[80:83]
  ds_read_b128 a[136:139], v3 offset:2048
  buffer_load_dwordx4 a[40:43], v2, s[40:43], s14 offen offset:2048 sc1
  v_cvt_pk_bf16_f32 v188, v216, v217
  v_mfma_f32_16x16x32_bf16 a[84:87], a[168:171], v[180:183], a[84:87]
  v_exp_f32 v221, v157
  v_mfma_f32_16x16x32_bf16 a[88:91], a[172:175], v[176:179], a[88:91]
  ds_read_b128 a[140:143], v3 offset:3072
  v_add_f32 v227, v227, v218
  v_add_f32 v227, v227, v219
  v_mfma_f32_16x16x32_bf16 a[92:95], a[172:175], v[180:183], a[92:95]
  s_waitcnt lgkmcnt(4)
  v_exp_f32 v222, v158
  v_mfma_f32_16x16x32_bf16 a[96:99], a[176:179], v[176:179], a[96:99]
  ds_read_b128 a[144:147], v3 offset:4096
  buffer_load_dwordx4 v2, s[44:47], s26 offen offset:3072 sc1 lds
  v_cvt_pk_bf16_f32 v189, v218, v219
  v_mfma_f32_16x16x32_bf16 a[100:103], a[176:179], v[180:183], a[100:103]
  s_add_u32 s26, s26, 16384
  v_exp_f32 v223, v159
  v_mfma_f32_16x16x32_bf16 a[104:107], a[180:183], v[176:179], a[104:107]
  s_add_u32 s24, s24, 32768
  ds_read_b128 a[148:151], v3 offset:5120
  buffer_load_dwordx4 a[44:47], v2, s[40:43], s14 offen offset:3072 sc1
  v_add_f32 v227, v227, v220
  v_mfma_f32_16x16x32_bf16 a[108:111], a[180:183], v[180:183], a[108:111]
  s_and_b32 s24, s24, 0x1ffff
  v_add_f32 v227, v227, v221
  v_cvt_pk_bf16_f32 v190, v220, v221
  v_add_f32 v227, v227, v222
  v_mfma_f32_16x16x32_bf16 a[112:115], a[184:187], v[176:179], a[112:115]
  ds_read_b128 a[152:155], v3 offset:6144
  v_add_f32 v227, v227, v223
  v_max_f32 v5, v226, v227
  v_cmp_lt_f32 vcc, s81, v5
  v_mfma_f32_16x16x32_bf16 a[116:119], a[184:187], v[180:183], a[116:119]
  v_exp_f32 v216, v128
  v_mfma_f32_16x16x32_bf16 a[120:123], a[188:191], v[176:179], a[120:123]
  s_waitcnt lgkmcnt(3)
  ds_read_b128 a[156:159], v3 offset:7168
  v_cvt_pk_bf16_f32 v191, v222, v223
  v_mfma_f32_16x16x32_bf16 a[124:127], a[188:191], v[180:183], a[124:127]
  s_cbranch_vccnz fa_stub22
fa_back22:
  v_exp_f32 v217, v129
  v_add_f32 v230, v230, v226
  v_add_f32 v231, v231, v227
  v_mfma_f32_16x16x32_bf16 v[144:147], a[128:131], v[64:67], v[200:203]
  ds_read_b128 a[160:163], v3 offset:24576
  v_add_f32 v226, v216, v217
  v_mfma_f32_16x16x32_bf16 v[152:155], a[128:131], v[68:71], v[204:207]
  v_exp_f32 v218, v130
  v_mfma_f32_16x16x32_bf16 v[148:151], a[132:135], v[64:67], v[200:203]
  s_cmp_ge_u32 s27, s50
  s_cselect_b64 s[48:49], s[6:7], s[48:49]
  s_cselect_b32 s50, s30, s50
  ds_read_b128 a[164:167], v3 offset:25600
  v_cvt_pk_bf16_f32 v176, v216, v217
  v_mfma_f32_16x16x32_bf16 v[156:159], a[132:135], v[68:71], v[204:207]
  s_mov_b32 m0, s25
  v_exp_f32 v219, v131
  v_mfma_f32_16x16x32_bf16 v[144:147], a[136:139], v[72:75], v[144:147]
  s_add_u32 s66, s66, 32768
  ds_read_b128 a[168:171], v3 offset:26624
  buffer_load_dwordx4 v2, s[48:51], s27 offen offset:0 sc1 lds
  v_add_f32 v226, v226, v218
  v_add_f32 v226, v226, v219
  v_mfma_f32_16x16x32_bf16 v[152:155], a[136:139], v[76:79], v[152:155]
  s_and_b32 s66, s66, 0x1ffff
  v_exp_f32 v220, v132
  v_mfma_f32_16x16x32_bf16 v[148:151], a[140:143], v[72:75], v[148:151]
  s_add_u32 s14, s13, 28672
  ds_read_b128 a[172:175], v3 offset:27648
  buffer_load_dwordx4 a[48:51], v2, s[40:43], s14 offen offset:0 sc1
  v_cvt_pk_bf16_f32 v177, v218, v219
  v_mfma_f32_16x16x32_bf16 v[156:159], a[140:143], v[76:79], v[156:159]
  s_waitcnt lgkmcnt(4)
  v_exp_f32 v221, v133
  v_mfma_f32_16x16x32_bf16 v[144:147], a[144:147], v[80:83], v[144:147]
  ds_read_b128 a[176:179], v3 offset:28672
  v_add_f32 v226, v226, v220
  v_mfma_f32_16x16x32_bf16 v[152:155], a[144:147], v[84:87], v[152:155]
  v_exp_f32 v222, v134
  v_mfma_f32_16x16x32_bf16 v[148:151], a[148:151], v[80:83], v[148:151]
  ds_read_b128 a[180:183], v3 offset:29696
  buffer_load_dwordx4 v2, s[48:51], s27 offen offset:1024 sc1 lds
  v_add_f32 v226, v226, v221
  v_cvt_pk_bf16_f32 v178, v220, v221
  v_mfma_f32_16x16x32_bf16 v[156:159], a[148:151], v[84:87], v[156:159]
  v_exp_f32 v223, v135
  v_mfma_f32_16x16x32_bf16 v[144:147], a[152:155], v[88:91], v[144:147]
  ds_read_b128 a[184:187], v3 offset:30720
  v_add_f32 v226, v226, v222
  v_mfma_f32_16x16x32_bf16 v[152:155], a[152:155], v[92:95], v[152:155]
  v_exp_f32 v216, v136
  v_mfma_f32_16x16x32_bf16 v[148:151], a[156:159], v[88:91], v[148:151]
  ds_read_b128 a[188:191], v3 offset:31744
  buffer_load_dwordx4 a[52:55], v2, s[40:43], s14 offen offset:1024 sc1
  v_add_f32 v226, v226, v223
  v_exp_f32 v217, v137
  v_mfma_f32_16x16x32_bf16 v[156:159], a[156:159], v[92:95], v[156:159]
  s_waitcnt lgkmcnt(4)
  v_exp_f32 v218, v138
  v_mfma_f32_16x16x32_bf16 a[64:67], a[160:163], v[184:187], a[64:67]
  ds_read_b128 a[128:131], v3 offset:8192
  v_cvt_pk_bf16_f32 v179, v222, v223
  v_mfma_f32_16x16x32_bf16 a[68:71], a[160:163], v[188:191], a[68:71]
  v_exp_f32 v219, v139
  v_mfma_f32_16x16x32_bf16 a[72:75], a[164:167], v[184:187], a[72:75]
  ds_read_b128 a[132:135], v3 offset:9216
  buffer_load_dwordx4 v2, s[48:51], s27 offen offset:2048 sc1 lds
  v_add_f32 v227, v216, v217
  v_mfma_f32_16x16x32_bf16 a[76:79], a[164:167], v[188:191], a[76:79]
  v_exp_f32 v220, v140
  v_mfma_f32_16x16x32_bf16 a[80:83], a[168:171], v[184:187], a[80:83]
  ds_read_b128 a[136:139], v3 offset:10240
  buffer_load_dwordx4 a[56:59], v2, s[40:43], s14 offen offset:2048 sc1
  v_cvt_pk_bf16_f32 v180, v216, v217
  v_mfma_f32_16x16x32_bf16 a[84:87], a[168:171], v[188:191], a[84:87]
  v_exp_f32 v221, v141
  v_mfma_f32_16x16x32_bf16 a[88:91], a[172:175], v[184:187], a[88:91]
  ds_read_b128 a[140:143], v3 offset:11264
  v_add_f32 v227, v227, v218
  v_mfma_f32_16x16x32_bf16 a[92:95], a[172:175], v[188:191], a[92:95]
  s_waitcnt lgkmcnt(4)
  v_exp_f32 v222, v142
  v_mfma_f32_16x16x32_bf16 a[96:99], a[176:179], v[184:187], a[96:99]
  ds_read_b128 a[144:147], v3 offset:12288
  buffer_load_dwordx4 v2, s[48:51], s27 offen offset:3072 sc1 lds
  v_add_f32 v227, v227, v219
  v_cvt_pk_bf16_f32 v181, v218, v219
  v_mfma_f32_16x16x32_bf16 a[100:103], a[176:179], v[188:191], a[100:103]
  s_add_u32 s27, s27, 16384
  v_exp_f32 v223, v143
  v_mfma_f32_16x16x32_bf16 a[104:107], a[180:183], v[184:187], a[104:107]
  s_add_u32 s25, s25, 32768
  ds_read_b128 a[148:151], v3 offset:13312
  buffer_load_dwordx4 a[60:63], v2, s[40:43], s14 offen offset:3072 sc1
  v_add_f32 v227, v227, v220
  v_mfma_f32_16x16x32_bf16 a[108:111], a[180:183], v[188:191], a[108:111]
  s_and_b32 s25, s25, 0x1ffff
  v_add_f32 v227, v227, v221
  v_cvt_pk_bf16_f32 v182, v220, v221
  v_add_f32 v227, v227, v222
  v_mfma_f32_16x16x32_bf16 a[112:115], a[184:187], v[184:187], a[112:115]
  ds_read_b128 a[152:155], v3 offset:14336
  v_add_f32 v227, v227, v223
  v_max_f32 v5, v226, v227
  v_cmp_lt_f32 vcc, s81, v5
  v_mfma_f32_16x16x32_bf16 a[116:119], a[184:187], v[188:191], a[116:119]
  v_exp_f32 v216, v144
  v_mfma_f32_16x16x32_bf16 a[120:123], a[188:191], v[184:187], a[120:123]
  s_waitcnt lgkmcnt(3)
  ds_read_b128 a[156:159], v3 offset:15360
  v_cvt_pk_bf16_f32 v183, v222, v223
  v_add_u32 v3, s66, v2
  v_mfma_f32_16x16x32_bf16 a[124:127], a[188:191], v[188:191], a[124:127]
  s_cbranch_vccnz fa_stub23
fa_back23:
  v_exp_f32 v217, v145
  v_add_f32 v230, v230, v226
  v_add_f32 v231, v231, v227
fa_SSW2:
  v_mfma_f32_16x16x32_bf16 v[128:131], a[128:131], v[64:67], v[200:203]
  s_waitcnt vmcnt(12)
  v_exp_f32 v218, v146
  v_mfma_f32_16x16x32_bf16 v[136:139], a[128:131], v[68:71], v[204:207]
  s_barrier
  v_exp_f32 v219, v147
  v_mfma_f32_16x16x32_bf16 v[132:135], a[132:135], v[64:67], v[200:203]
  s_cmp_ge_u32 s26, s46
  s_cselect_b64 s[44:45], s[4:5], s[44:45]
  s_cselect_b32 s46, s30, s46
  ds_read_b128 a[160:163], v3 offset:16384
  ds_read_b128 a[164:167], v3 offset:17408
  v_add_f32 v226, v216, v217
  v_mfma_f32_16x16x32_bf16 v[140:143], a[132:135], v[68:71], v[204:207]
  s_mov_b32 m0, s24
  v_exp_f32 v220, v148
  v_mfma_f32_16x16x32_bf16 v[128:131], a[136:139], v[72:75], v[128:131]
  ds_read_b128 a[168:171], v3 offset:18432
  buffer_load_dwordx4 v2, s[44:47], s26 offen offset:0 sc1 lds
  v_cvt_pk_bf16_f32 v184, v216, v217
  v_mfma_f32_16x16x32_bf16 v[136:139], a[136:139], v[76:79], v[136:139]
  v_exp_f32 v221, v149
  v_mfma_f32_16x16x32_bf16 v[132:135], a[140:143], v[72:75], v[132:135]
  s_add_u32 s14, s13, 32768
  ds_read_b128 a[172:175], v3 offset:19456
  buffer_load_dwordx4 v[32:35], v2, s[40:43], s14 offen offset:0 sc1
  v_add_f32 v226, v226, v218
  v_add_f32 v226, v226, v219
  v_mfma_f32_16x16x32_bf16 v[140:143], a[140:143], v[76:79], v[140:143]
  s_waitcnt lgkmcnt(4)
  v_exp_f32 v222, v150
  v_mfma_f32_16x16x32_bf16 v[128:131], a[144:147], v[80:83], v[128:131]
  ds_read_b128 a[176:179], v3 offset:20480
  v_cvt_pk_bf16_f32 v185, v218, v219
  v_mfma_f32_16x16x32_bf16 v[136:139], a[144:147], v[84:87], v[136:139]
  v_exp_f32 v223, v151
  v_mfma_f32_16x16x32_bf16 v[132:135], a[148:151], v[80:83], v[132:135]
  ds_read_b128 a[180:183], v3 offset:21504
  buffer_load_dwordx4 v2, s[44:47], s26 offen offset:1024 sc1 lds
  v_add_f32 v226, v226, v220
  v_mfma_f32_16x16x32_bf16 v[140:143], a[148:151], v[84:87], v[140:143]
  v_exp_f32 v216, v152
  v_mfma_f32_16x16x32_bf16 v[128:131], a[152:155], v[88:91], v[128:131]
  ds_read_b128 a[184:187], v3 offset:22528
  v_add_f32 v226, v226, v221
  v_cvt_pk_bf16_f32 v186, v220, v221
  v_mfma_f32_16x16x32_bf16 v[136:139], a[152:155], v[92:95], v[136:139]
  v_exp_f32 v217, v153
  v_mfma_f32_16x16x32_bf16 v[132:135], a[156:159], v[88:91], v[132:135]
  ds_read_b128 a[188:191], v3 offset:23552
  buffer_load_dwordx4 v[36:39], v2, s[40:43], s14 offen offset:1024 sc1
  v_add_f32 v226, v226, v222
  v_mfma_f32_16x16x32_bf16 v[140:143], a[156:159], v[92:95], v[140:143]
  s_waitcnt lgkmcnt(4)
  v_exp_f32 v218, v154
  v_mfma_f32_16x16x32_bf16 a[64:67], a[160:163], v[176:179], a[64:67]
  ds_read_b128 a[128:131], v3 offset:0
  v_add_f32 v226, v226, v223
  v_cvt_pk_bf16_f32 v187, v222, v223
  v_mfma_f32_16x16x32_bf16 a[68:71], a[160:163], v[180:183], a[68:71]
  v_exp_f32 v219, v155
  v_mfma_f32_16x16x32_bf16 a[72:75], a[164:167], v[176:179], a[72:75]
  ds_read_b128 a[132:135], v3 offset:1024
  buffer_load_dwordx4 v2, s[44:47], s26 offen offset:2048 sc1 lds
  v_add_f32 v227, v216, v217
  v_mfma_f32_16x16x32_bf16 a[76:79], a[164:167], v[180:183], a[76:79]
  v_exp_f32 v220, v156
  v_mfma_f32_16x16x32_bf16 a[80:83], a[168:171], v[176:179], a[80:83]
  ds_read_b128 a[136:139], v3 offset:2048
  buffer_load_dwordx4 v[40:43], v2, s[40:43], s14 offen offset:2048 sc1
  v_cvt_pk_bf16_f32 v188, v216, v217
  v_mfma_f32_16x16x32_bf16 a[84:87], a[168:171], v[180:183], a[84:87]
  v_exp_f32 v221, v157
  v_mfma_f32_16x16x32_bf16 a[88:91], a[172:175], v[176:179], a[88:91]
  ds_read_b128 a[140:143], v3 offset:3072
  v_add_f32 v227, v227, v218
  v_add_f32 v227, v227, v219
  v_mfma_f32_16x16x32_bf16 a[92:95], a[172:175], v[180:183], a[92:95]
  s_waitcnt lgkmcnt(4)
  v_exp_f32 v222, v158
  v_mfma_f32_16x16x32_bf16 a[96:99], a[176:179], v[176:179], a[96:99]
  ds_read_b128 a[144:147], v3 offset:4096
  buffer_load_dwordx4 v2, s[44:47], s26 offen offset:3072 sc1 lds
  v_cvt_pk_bf16_f32 v189, v218, v219
  v_mfma_f32_16x16x32_bf16 a[100:103], a[176:179], v[180:183], a[100:103]
  s_add_u32 s26, s26, 16384
  v_exp_f32 v223, v159
  v_mfma_f32_16x16x32_bf16 a[104:107], a[180:183], v[176:179], a[104:107]
  s_add_u32 s24, s24, 32768
  ds_read_b128 a[148:151], v3 offset:5120
  buffer_load_dwordx4 v[44:47], v2, s[40:43], s14 offen offset:3072 sc1
  v_add_f32 v227, v227, v220
  v_mfma_f32_16x16x32_bf16 a[108:111], a[180:183], v[180:183], a[108:111]
  s_and_b32 s24, s24, 0x1ffff
  v_add_f32 v227, v227, v221
  v_cvt_pk_bf16_f32 v190, v220, v221
  v_add_f32 v227, v227, v222
  v_mfma_f32_16x16x32_bf16 a[112:115], a[184:187], v[176:179], a[112:115]
  ds_read_b128 a[152:155], v3 offset:6144
  v_add_f32 v227, v227, v223
  v_max_f32 v5, v226, v227
  v_cmp_lt_f32 vcc, s81, v5
  v_mfma_f32_16x16x32_bf16 a[116:119], a[184:187], v[180:183], a[116:119]
  v_exp_f32 v216, v128
  v_mfma_f32_16x16x32_bf16 a[120:123], a[188:191], v[176:179], a[120:123]
  s_waitcnt lgkmcnt(3)
  ds_read_b128 a[156:159], v3 offset:7168
  v_cvt_pk_bf16_f32 v191, v222, v223
  v_mfma_f32_16x16x32_bf16 a[124:127], a[188:191], v[180:183], a[124:127]
  s_cbranch_vccnz fa_stub24
fa_back24:
  v_exp_f32 v217, v129
  v_add_f32 v230, v230, v226
  v_add_f32 v231, v231, v227
  v_mfma_f32_16x16x32_bf16 v[144:147], a[128:131], v[64:67], v[200:203]
  ds_read_b128 a[160:163], v3 offset:24576
  v_add_f32 v226, v216, v217
  v_mfma_f32_16x16x32_bf16 v[152:155], a[128:131], v[68:71], v[204:207]
  v_exp_f32 v218, v130
  v_mfma_f32_16x16x32_bf16 v[148:151], a[132:135], v[64:67], v[200:203]
  s_cmp_ge_u32 s27, s50
  s_cselect_b64 s[48:49], s[6:7], s[48:49]
  s_cselect_b32 s50, s30, s50
  ds_read_b128 a[164:167], v3 offset:25600
  v_cvt_pk_bf16_f32 v176, v216, v217
  v_mfma_f32_16x16x32_bf16 v[156:159], a[132:135], v[68:71], v[204:207]
  s_mov_b32 m0, s25
  v_exp_f32 v219, v131
  v_mfma_f32_16x16x32_bf16 v[144:147], a[136:139], v[72:75], v[144:147]
  s_add_u32 s66, s66, 32768
  ds_read_b128 a[168:171], v3 offset:26624
  buffer_load_dwordx4 v2, s[48:51], s27 offen offset:0 sc1 lds
  v_add_f32 v226, v226, v218
  v_add_f32 v226, v226, v219
  v_mfma_f32_16x16x32_bf16 v[152:155], a[136:139], v[76:79], v[152:155]
  s_and_b32 s66, s66, 0x1ffff
  v_exp_f32 v220, v132
  v_mfma_f32_16x16x32_bf16 v[148:151], a[140:143], v[72:75], v[148:151]
  s_add_u32 s14, s13, 36864
  ds_read_b128 a[172:175], v3 offset:27648
  buffer_load_dwordx4 v[48:51], v2, s[40:43], s14 offen offset:0 sc1
  v_cvt_pk_bf16_f32 v177, v218, v219
  v_mfma_f32_16x16x32_bf16 v[156:159], a[140:143], v[76:79], v[156:159]
  s_waitcnt lgkmcnt(4)
  v_exp_f32 v221, v133
  v_mfma_f32_16x16x32_bf16 v[144:147], a[144:147], v[80:83], v[144:147]
  ds_read_b128 a[176:179], v3 offset:28672
  v_add_f32 v226, v226, v220
  v_mfma_f32_16x16x32_bf16 v[152:155], a[144:147], v[84:87], v[152:155]
  v_exp_f32 v222, v134
  v_mfma_f32_16x16x32_bf16 v[148:151], a[148:151], v[80:83], v[148:151]
  ds_read_b128 a[180:183], v3 offset:29696
  buffer_load_dwordx4 v2, s[48:51], s27 offen offset:1024 sc1 lds
  v_add_f32 v226, v226, v221
  v_cvt_pk_bf16_f32 v178, v220, v221
  v_mfma_f32_16x16x32_bf16 v[156:159], a[148:151], v[84:87], v[156:159]
  v_exp_f32 v223, v135
  v_mfma_f32_16x16x32_bf16 v[144:147], a[152:155], v[88:91], v[144:147]
  ds_read_b128 a[184:187], v3 offset:30720
  v_add_f32 v226, v226, v222
  v_mfma_f32_16x16x32_bf16 v[152:155], a[152:155], v[92:95], v[152:155]
  v_exp_f32 v216, v136
  v_mfma_f32_16x16x32_bf16 v[148:151], a[156:159], v[88:91], v[148:151]
  ds_read_b128 a[188:191], v3 offset:31744
  buffer_load_dwordx4 v[52:55], v2, s[40:43], s14 offen offset:1024 sc1
  v_add_f32 v226, v226, v223
  v_exp_f32 v217, v137
  v_mfma_f32_16x16x32_bf16 v[156:159], a[156:159], v[92:95], v[156:159]
  s_waitcnt lgkmcnt(4)
  v_exp_f32 v218, v138
  v_mfma_f32_16x16x32_bf16 a[64:67], a[160:163], v[184:187], a[64:67]
  ds_read_b128 a[128:131], v3 offset:8192
  v_cvt_pk_bf16_f32 v179, v222, v223
  v_mfma_f32_16x16x32_bf16 a[68:71], a[160:163], v[188:191], a[68:71]
  v_exp_f32 v219, v139
  v_mfma_f32_16x16x32_bf16 a[72:75], a[164:167], v[184:187], a[72:75]
  ds_read_b128 a[132:135], v3 offset:9216
  buffer_load_dwordx4 v2, s[48:51], s27 offen offset:2048 sc1 lds
  v_add_f32 v227, v216, v217
  v_mfma_f32_16x16x32_bf16 a[76:79], a[164:167], v[188:191], a[76:79]
  v_exp_f32 v220, v140
  v_mfma_f32_16x16x32_bf16 a[80:83], a[168:171], v[184:187], a[80:83]
  ds_read_b128 a[136:139], v3 offset:10240
  buffer_load_dwordx4 v[56:59], v2, s[40:43], s14 offen offset:2048 sc1
  v_cvt_pk_bf16_f32 v180, v216, v217
  v_mfma_f32_16x16x32_bf16 a[84:87], a[168:171], v[188:191], a[84:87]
  v_exp_f32 v221, v141
  v_mfma_f32_16x16x32_bf16 a[88:91], a[172:175], v[184:187], a[88:91]
  ds_read_b128 a[140:143], v3 offset:11264
  v_add_f32 v227, v227, v218
  v_mfma_f32_16x16x32_bf16 a[92:95], a[172:175], v[188:191], a[92:95]
  s_waitcnt lgkmcnt(4)
  v_exp_f32 v222, v142
  v_mfma_f32_16x16x32_bf16 a[96:99], a[176:179], v[184:187], a[96:99]
  ds_read_b128 a[144:147], v3 offset:12288
  buffer_load_dwordx4 v2, s[48:51], s27 offen offset:3072 sc1 lds
  v_add_f32 v227, v227, v219
  v_cvt_pk_bf16_f32 v181, v218, v219
  v_mfma_f32_16x16x32_bf16 a[100:103], a[176:179], v[188:191], a[100:103]
  s_add_u32 s27, s27, 16384
  v_exp_f32 v223, v143
  v_mfma_f32_16x16x32_bf16 a[104:107], a[180:183], v[184:187], a[104:107]
  s_add_u32 s25, s25, 32768
  ds_read_b128 a[148:151], v3 offset:13312
  buffer_load_dwordx4 v[60:63], v2, s[40:43], s14 offen offset:3072 sc1
  v_add_f32 v227, v227, v220
  v_mfma_f32_16x16x32_bf16 a[108:111], a[180:183], v[188:191], a[108:111]
  s_and_b32 s25, s25, 0x1ffff
  v_add_f32 v227, v227, v221
  v_cvt_pk_bf16_f32 v182, v220, v221
  v_add_f32 v227, v227, v222
  v_mfma_f32_16x16x32_bf16 a[112:115], a[184:187], v[184:187], a[112:115]
  ds_read_b128 a[152:155], v3 offset:14336
  v_add_f32 v227, v227, v223
  v_max_f32 v5, v226, v227
  v_cmp_lt_f32 vcc, s81, v5
  v_mfma_f32_16x16x32_bf16 a[116:119], a[184:187], v[188:191], a[116:119]
  v_exp_f32 v216, v144
  v_mfma_f32_16x16x32_bf16 a[120:123], a[188:191], v[184:187], a[120:123]
  s_waitcnt lgkmcnt(3)
  ds_read_b128 a[156:159], v3 offset:15360
  v_cvt_pk_bf16_f32 v183, v222, v223
  v_add_u32 v3, s66, v2
  v_mfma_f32_16x16x32_bf16 a[124:127], a[188:191], v[188:191], a[124:127]
  s_cbranch_vccnz fa_stub25
fa_back25:
  v_exp_f32 v217, v145
  v_add_f32 v230, v230, v226
  v_add_f32 v231, v231, v227
fa_SSW1:
  v_mfma_f32_16x16x32_bf16 v[128:131], a[128:131], v[64:67], v[200:203]
  s_waitcnt vmcnt(8)
  v_exp_f32 v218, v146
  v_mfma_f32_16x16x32_bf16 v[136:139], a[128:131], v[68:71], v[204:207]
  s_barrier
  v_exp_f32 v219, v147
  v_mfma_f32_16x16x32_bf16 v[132:135], a[132:135], v[64:67], v[200:203]
  s_cmp_ge_u32 s26, s46
  s_cselect_b64 s[44:45], s[4:5], s[44:45]
  s_cselect_b32 s46, s30, s46
  ds_read_b128 a[160:163], v3 offset:16384
  ds_read_b128 a[164:167], v3 offset:17408
  v_add_f32 v226, v216, v217
  v_mfma_f32_16x16x32_bf16 v[140:143], a[132:135], v[68:71], v[204:207]
  s_mov_b32 m0, s24
  v_exp_f32 v220, v148
  v_mfma_f32_16x16x32_bf16 v[128:131], a[136:139], v[72:75], v[128:131]
  ds_read_b128 a[168:171], v3 offset:18432
  buffer_load_dwordx4 v2, s[44:47], s26 offen offset:0 sc1 lds
  v_cvt_pk_bf16_f32 v184, v216, v217
  v_mfma_f32_16x16x32_bf16 v[136:139], a[136:139], v[76:79], v[136:139]
  v_exp_f32 v221, v149
  v_mfma_f32_16x16x32_bf16 v[132:135], a[140:143], v[72:75], v[132:135]
  s_add_u32 s14, s13, 40960
  ds_read_b128 a[172:175], v3 offset:19456
  buffer_load_dwordx4 v[96:99], v2, s[40:43], s14 offen offset:0 sc1
  v_add_f32 v226, v226, v218
  v_add_f32 v226, v226, v219
  v_mfma_f32_16x16x32_bf16 v[140:143], a[140:143], v[76:79], v[140:143]
  s_waitcnt lgkmcnt(4)
  v_exp_f32 v222, v150
  v_mfma_f32_16x16x32_bf16 v[128:131], a[144:147], v[80:83], v[128:131]
  ds_read_b128 a[176:179], v3 offset:20480
  v_cvt_pk_bf16_f32 v185, v218, v219
  v_mfma_f32_16x16x32_bf16 v[136:139], a[144:147], v[84:87], v[136:139]
  v_exp_f32 v223, v151
  v_mfma_f32_16x16x32_bf16 v[132:135], a[148:151], v[80:83], v[132:135]
  ds_read_b128 a[180:183], v3 offset:21504
  buffer_load_dwordx4 v2, s[44:47], s26 offen offset:1024 sc1 lds
  v_add_f32 v226, v226, v220
  v_mfma_f32_16x16x32_bf16 v[140:143], a[148:151], v[84:87], v[140:143]
  v_exp_f32 v216, v152
  v_mfma_f32_16x16x32_bf16 v[128:131], a[152:155], v[88:91], v[128:131]
  ds_read_b128 a[184:187], v3 offset:22528
  v_add_f32 v226, v226, v221
  v_cvt_pk_bf16_f32 v186, v220, v221
  v_mfma_f32_16x16x32_bf16 v[136:139], a[152:155], v[92:95], v[136:139]
  v_exp_f32 v217, v153
  v_mfma_f32_16x16x32_bf16 v[132:135], a[156:159], v[88:91], v[132:135]
  ds_read_b128 a[188:191], v3 offset:23552
  buffer_load_dwordx4 v[100:103], v2, s[40:43], s14 offen offset:1024 sc1
  v_add_f32 v226, v226, v222
  v_mfma_f32_16x16x32_bf16 v[140:143], a[156:159], v[92:95], v[140:143]
  s_waitcnt lgkmcnt(4)
  v_exp_f32 v218, v154
  v_mfma_f32_16x16x32_bf16 a[64:67], a[160:163], v[176:179], a[64:67]
  ds_read_b128 a[128:131], v3 offset:0
  v_add_f32 v226, v226, v223
  v_cvt_pk_bf16_f32 v187, v222, v223
  v_mfma_f32_16x16x32_bf16 a[68:71], a[160:163], v[180:183], a[68:71]
  v_exp_f32 v219, v155
  v_mfma_f32_16x16x32_bf16 a[72:75], a[164:167], v[176:179], a[72:75]
  ds_read_b128 a[132:135], v3 offset:1024
  buffer_load_dwordx4 v2, s[44:47], s26 offen offset:2048 sc1 lds
  v_add_f32 v227, v216, v217
  v_mfma_f32_16x16x32_bf16 a[76:79], a[164:167], v[180:183], a[76:79]
  v_exp_f32 v220, v156
  v_mfma_f32_16x16x32_bf16 a[80:83], a[168:171], v[176:179], a[80:83]
  ds_read_b128 a[136:139], v3 offset:2048
  buffer_load_dwordx4 v[104:107], v2, s[40:43], s14 offen offset:2048 sc1
  v_cvt_pk_bf16_f32 v188, v216, v217
  v_mfma_f32_16x16x32_bf16 a[84:87], a[168:171], v[180:183], a[84:87]
  v_exp_f32 v221, v157
  v_mfma_f32_16x16x32_bf16 a[88:91], a[172:175], v[176:179], a[88:91]
  ds_read_b128 a[140:143], v3 offset:3072
  v_add_f32 v227, v227, v218
  v_add_f32 v227, v227, v219
  v_mfma_f32_16x16x32_bf16 a[92:95], a[172:175], v[180:183], a[92:95]
  s_waitcnt lgkmcnt(4)
  v_exp_f32 v222, v158
  v_mfma_f32_16x16x32_bf16 a[96:99], a[176:179], v[176:179], a[96:99]
  ds_read_b128 a[144:147], v3 offset:4096
  buffer_load_dwordx4 v2, s[44:47], s26 offen offset:3072 sc1 lds
  v_cvt_pk_bf16_f32 v189, v218, v219
  v_mfma_f32_16x16x32_bf16 a[100:103], a[176:179], v[180:183], a[100:103]
  s_add_u32 s26, s26, 16384
  v_exp_f32 v223, v159
  v_mfma_f32_16x16x32_bf16 a[104:107], a[180:183], v[176:179], a[104:107]
  s_add_u32 s24, s24, 32768
  ds_read_b128 a[148:151], v3 offset:5120
  buffer_load_dwordx4 v[108:111], v2, s[40:43], s14 offen offset:3072 sc1
  v_add_f32 v227, v227, v220
  v_mfma_f32_16x16x32_bf16 a[108:111], a[180:183], v[180:183], a[108:111]
  s_and_b32 s24, s24, 0x1ffff
  v_add_f32 v227, v227, v221
  v_cvt_pk_bf16_f32 v190, v220, v221
  v_add_f32 v227, v227, v222
  v_mfma_f32_16x16x32_bf16 a[112:115], a[184:187], v[176:179], a[112:115]
  ds_read_b128 a[152:155], v3 offset:6144
  v_add_f32 v227, v227, v223
  v_max_f32 v5, v226, v227
  v_cmp_lt_f32 vcc, s81, v5
  v_mfma_f32_16x16x32_bf16 a[116:119], a[184:187], v[180:183], a[116:119]
  v_exp_f32 v216, v128
  v_mfma_f32_16x16x32_bf16 a[120:123], a[188:191], v[176:179], a[120:123]
  s_waitcnt lgkmcnt(3)
  ds_read_b128 a[156:159], v3 offset:7168
  v_cvt_pk_bf16_f32 v191, v222, v223
  v_mfma_f32_16x16x32_bf16 a[124:127], a[188:191], v[180:183], a[124:127]
  s_cbranch_vccnz fa_stub26
fa_back26:
  v_exp_f32 v217, v129
  v_add_f32 v230, v230, v226
  v_add_f32 v231, v231, v227
  v_mfma_f32_16x16x32_bf16 v[144:147], a[128:131], v[64:67], v[200:203]
  ds_read_b128 a[160:163], v3 offset:24576
  v_add_f32 v226, v216, v217
  v_mfma_f32_16x16x32_bf16 v[152:155], a[128:131], v[68:71], v[204:207]
  v_exp_f32 v218, v130
  v_mfma_f32_16x16x32_bf16 v[148:151], a[132:135], v[64:67], v[200:203]
  s_cmp_ge_u32 s27, s50
  s_cselect_b64 s[48:49], s[6:7], s[48:49]
  s_cselect_b32 s50, s30, s50
  ds_read_b128 a[164:167], v3 offset:25600
  v_cvt_pk_bf16_f32 v176, v216, v217
  v_mfma_f32_16x16x32_bf16 v[156:159], a[132:135], v[68:71], v[204:207]
  s_mov_b32 m0, s25
  v_exp_f32 v219, v131
  v_mfma_f32_16x16x32_bf16 v[144:147], a[136:139], v[72:75], v[144:147]
  s_add_u32 s66, s66, 32768
  ds_read_b128 a[168:171], v3 offset:26624
  buffer_load_dwordx4 v2, s[48:51], s27 offen offset:0 sc1 lds
  v_add_f32 v226, v226, v218
  v_add_f32 v226, v226, v219
  v_mfma_f32_16x16x32_bf16 v[152:155], a[136:139], v[76:79], v[152:155]
  s_and_b32 s66, s66, 0x1ffff
  v_exp_f32 v220, v132
  v_mfma_f32_16x16x32_bf16 v[148:151], a[140:143], v[72:75], v[148:151]
  s_add_u32 s14, s13, 45056
  ds_read_b128 a[172:175], v3 offset:27648
  buffer_load_dwordx4 v[112:115], v2, s[40:43], s14 offen offset:0 sc1
  v_cvt_pk_bf16_f32 v177, v218, v219
  v_mfma_f32_16x16x32_bf16 v[156:159], a[140:143], v[76:79], v[156:159]
  s_waitcnt lgkmcnt(4)
  v_exp_f32 v221, v133
  v_mfma_f32_16x16x32_bf16 v[144:147], a[144:147], v[80:83], v[144:147]
  ds_read_b128 a[176:179], v3 offset:28672
  v_add_f32 v226, v226, v220
  v_mfma_f32_16x16x32_bf16 v[152:155], a[144:147], v[84:87], v[152:155]
  v_exp_f32 v222, v134
  v_mfma_f32_16x16x32_bf16 v[148:151], a[148:151], v[80:83], v[148:151]
  ds_read_b128 a[180:183], v3 offset:29696
  buffer_load_dwordx4 v2, s[48:51], s27 offen offset:1024 sc1 lds
  v_add_f32 v226, v226, v221
  v_cvt_pk_bf16_f32 v178, v220, v221
  v_mfma_f32_16x16x32_bf16 v[156:159], a[148:151], v[84:87], v[156:159]
  v_exp_f32 v223, v135
  v_mfma_f32_16x16x32_bf16 v[144:147], a[152:155], v[88:91], v[144:147]
  ds_read_b128 a[184:187], v3 offset:30720
  v_add_f32 v226, v226, v222
  v_mfma_f32_16x16x32_bf16 v[152:155], a[152:155], v[92:95], v[152:155]
  v_exp_f32 v216, v136
  v_mfma_f32_16x16x32_bf16 v[148:151], a[156:159], v[88:91], v[148:151]
  ds_read_b128 a[188:191], v3 offset:31744
  buffer_load_dwordx4 v[116:119], v2, s[40:43], s14 offen offset:1024 sc1
  v_add_f32 v226, v226, v223
  v_exp_f32 v217, v137
  v_mfma_f32_16x16x32_bf16 v[156:159], a[156:159], v[92:95], v[156:159]
  s_waitcnt lgkmcnt(4)
  v_exp_f32 v218, v138
  v_mfma_f32_16x16x32_bf16 a[64:67], a[160:163], v[184:187], a[64:67]
  ds_read_b128 a[128:131], v3 offset:8192
  v_cvt_pk_bf16_f32 v179, v222, v223
  v_mfma_f32_16x16x32_bf16 a[68:71], a[160:163], v[188:191], a[68:71]
  v_exp_f32 v219, v139
  v_mfma_f32_16x16x32_bf16 a[72:75], a[164:167], v[184:187], a[72:75]
  ds_read_b128 a[132:135], v3 offset:9216
  buffer_load_dwordx4 v2, s[48:51], s27 offen offset:2048 sc1 lds
  v_add_f32 v227, v216, v217
  v_mfma_f32_16x16x32_bf16 a[76:79], a[164:167], v[188:191], a[76:79]
  v_exp_f32 v220, v140
  v_mfma_f32_16x16x32_bf16 a[80:83], a[168:171], v[184:187], a[80:83]
  ds_read_b128 a[136:139], v3 offset:10240
  buffer_load_dwordx4 v[120:123], v2, s[40:43], s14 offen offset:2048 sc1
  v_cvt_pk_bf16_f32 v180, v216, v217
  v_mfma_f32_16x16x32_bf16 a[84:87], a[168:171], v[188:191], a[84:87]
  v_exp_f32 v221, v141
  v_mfma_f32_16x16x32_bf16 a[88:91], a[172:175], v[184:187], a[88:91]
  ds_read_b128 a[140:143], v3 offset:11264
  v_add_f32 v227, v227, v218
  v_mfma_f32_16x16x32_bf16 a[92:95], a[172:175], v[188:191], a[92:95]
  s_waitcnt lgkmcnt(4)
  v_exp_f32 v222, v142
  v_mfma_f32_16x16x32_bf16 a[96:99], a[176:179], v[184:187], a[96:99]
  ds_read_b128 a[144:147], v3 offset:12288
  buffer_load_dwordx4 v2, s[48:51], s27 offen offset:3072 sc1 lds
  v_add_f32 v227, v227, v219
  v_cvt_pk_bf16_f32 v181, v218, v219
  v_mfma_f32_16x16x32_bf16 a[100:103], a[176:179], v[188:191], a[100:103]
  s_add_u32 s27, s27, 16384
  v_exp_f32 v223, v143
  v_mfma_f32_16x16x32_bf16 a[104:107], a[180:183], v[184:187], a[104:107]
  s_add_u32 s25, s25, 32768
  ds_read_b128 a[148:151], v3 offset:13312
  buffer_load_dwordx4 v[124:127], v2, s[40:43], s14 offen offset:3072 sc1
  v_add_f32 v227, v227, v220
  v_mfma_f32_16x16x32_bf16 a[108:111], a[180:183], v[188:191], a[108:111]
  s_and_b32 s25, s25, 0x1ffff
  v_add_f32 v227, v227, v221
  v_cvt_pk_bf16_f32 v182, v220, v221
  v_add_f32 v227, v227, v222
  v_mfma_f32_16x16x32_bf16 a[112:115], a[184:187], v[184:187], a[112:115]
  ds_read_b128 a[152:155], v3 offset:14336
  v_add_f32 v227, v227, v223
  v_max_f32 v5, v226, v227
  v_cmp_lt_f32 vcc, s81, v5
  v_mfma_f32_16x16x32_bf16 a[116:119], a[184:187], v[188:191], a[116:119]
  v_exp_f32 v216, v144
  v_mfma_f32_16x16x32_bf16 a[120:123], a[188:191], v[184:187], a[120:123]
  s_waitcnt lgkmcnt(3)
  ds_read_b128 a[156:159], v3 offset:15360
  v_cvt_pk_bf16_f32 v183, v222, v223
  v_add_u32 v3, s66, v2
  v_mfma_f32_16x16x32_bf16 a[124:127], a[188:191], v[188:191], a[124:127]
  s_cbranch_vccnz fa_stub27
fa_back27:
  v_exp_f32 v217, v145
  v_add_f32 v230, v230, v226
  v_add_f32 v231, v231, v227
fa_Bexit:
  s_bitcmp1_b32 s20, 0
  s_cbranch_scc1 fa_Bodd
  v_mfma_f32_16x16x32_bf16 v[128:131], a[128:131], v[64:67], v[200:203]
  s_waitcnt vmcnt(8)
  v_exp_f32 v218, v146
  v_mfma_f32_16x16x32_bf16 v[136:139], a[128:131], v[68:71], v[204:207]
  s_barrier
  v_exp_f32 v219, v147
  v_mfma_f32_16x16x32_bf16 v[132:135], a[132:135], v[64:67], v[200:203]
  ds_read_b128 a[160:163], v3 offset:16384
  ds_read_b128 a[164:167], v3 offset:17408
  v_add_f32 v226, v216, v217
  v_mfma_f32_16x16x32_bf16 v[140:143], a[132:135], v[68:71], v[204:207]
  s_add_u32 s14, s13, 49152
  buffer_load_dwordx4 v[160:163], v2, s[40:43], s14 offen offset:0 sc1
  v_cvt_pk_bf16_f32 v184, v216, v217
  v_mfma_f32_16x16x32_bf16 v[128:131], a[136:139], v[72:75], v[128:131]
  ds_read_b128 a[168:171], v3 offset:18432
  v_add_f32 v226, v226, v218
  v_mfma_f32_16x16x32_bf16 v[136:139], a[136:139], v[76:79], v[136:139]
  v_exp_f32 v220, v148
  v_mfma_f32_16x16x32_bf16 v[132:135], a[140:143], v[72:75], v[132:135]
  ds_read_b128 a[172:175], v3 offset:19456
  v_add_f32 v226, v226, v219
  v_cvt_pk_bf16_f32 v185, v218, v219
  v_mfma_f32_16x16x32_bf16 v[140:143], a[140:143], v[76:79], v[140:143]
  s_waitcnt lgkmcnt(4)
  buffer_load_dwordx4 v[164:167], v2, s[40:43], s14 offen offset:1024 sc1
  v_add_f32 v226, v226, v220
  v_mfma_f32_16x16x32_bf16 v[128:131], a[144:147], v[80:83], v[128:131]
  ds_read_b128 a[176:179], v3 offset:20480
  v_mfma_f32_16x16x32_bf16 v[136:139], a[144:147], v[84:87], v[136:139]
  v_exp_f32 v221, v149
  v_mfma_f32_16x16x32_bf16 v[132:135], a[148:151], v[80:83], v[132:135]
  ds_read_b128 a[180:183], v3 offset:21504
  v_add_f32 v226, v226, v221
  v_mfma_f32_16x16x32_bf16 v[140:143], a[148:151], v[84:87], v[140:143]
  v_exp_f32 v222, v150
  v_mfma_f32_16x16x32_bf16 v[128:131], a[152:155], v[88:91], v[128:131]
  ds_read_b128 a[184:187], v3 offset:22528
  buffer_load_dwordx4 v[168:171], v2, s[40:43], s14 offen offset:2048 sc1
  v_cvt_pk_bf16_f32 v186, v220, v221
  v_mfma_f32_16x16x32_bf16 v[136:139], a[152:155], v[92:95], v[136:139]
  v_exp_f32 v223, v151
  v_mfma_f32_16x16x32_bf16 v[132:135], a[156:159], v[88:91], v[132:135]
  ds_read_b128 a[188:191], v3 offset:23552
  v_add_f32 v226, v226, v222
  v_add_f32 v226, v226, v223
  v_mfma_f32_16x16x32_bf16 v[140:143], a[156:159], v[92:95], v[140:143]
  s_waitcnt lgkmcnt(4)
  v_exp_f32 v216, v152
  v_mfma_f32_16x16x32_bf16 a[64:67], a[160:163], v[176:179], a[64:67]
  v_exp_f32 v217, v153
  v_mfma_f32_16x16x32_bf16 a[68:71], a[160:163], v[180:183], a[68:71]
  buffer_load_dwordx4 v[172:175], v2, s[40:43], s14 offen offset:3072 sc1
  v_cvt_pk_bf16_f32 v187, v222, v223
  v_add_f32 v227, v216, v217
  v_mfma_f32_16x16x32_bf16 a[72:75], a[164:167], v[176:179], a[72:75]
  v_exp_f32 v218, v154
  v_mfma_f32_16x16x32_bf16 a[76:79], a[164:167], v[180:183], a[76:79]
  v_exp_f32 v219, v155
  v_mfma_f32_16x16x32_bf16 a[80:83], a[168:171], v[176:179], a[80:83]
  v_exp_f32 v220, v156
  v_mfma_f32_16x16x32_bf16 a[84:87], a[168:171], v[180:183], a[84:87]
  s_add_u32 s14, s13, 53248
  buffer_load_dwordx4 v[192:195], v2, s[40:43], s14 offen offset:0 sc1
  v_cvt_pk_bf16_f32 v188, v216, v217
  v_add_f32 v227, v227, v218
  v_mfma_f32_16x16x32_bf16 a[88:91], a[172:175], v[176:179], a[88:91]
  v_exp_f32 v221, v157
  v_mfma_f32_16x16x32_bf16 a[92:95], a[172:175], v[180:183], a[92:95]
  s_waitcnt lgkmcnt(0)
  v_exp_f32 v222, v158
  v_mfma_f32_16x16x32_bf16 a[96:99], a[176:179], v[176:179], a[96:99]
  v_add_f32 v227, v227, v219
  v_cvt_pk_bf16_f32 v189, v218, v219
  v_mfma_f32_16x16x32_bf16 a[100:103], a[176:179], v[180:183], a[100:103]
  v_exp_f32 v223, v159
  v_mfma_f32_16x16x32_bf16 a[104:107], a[180:183], v[176:179], a[104:107]
  buffer_load_dwordx4 v[196:199], v2, s[40:43], s14 offen offset:1024 sc1
  v_add_f32 v227, v227, v220
  v_mfma_f32_16x16x32_bf16 a[108:111], a[180:183], v[180:183], a[108:111]
  v_add_f32 v227, v227, v221
  v_cvt_pk_bf16_f32 v190, v220, v221
  v_add_f32 v227, v227, v222
  v_mfma_f32_16x16x32_bf16 a[112:115], a[184:187], v[176:179], a[112:115]
  v_add_f32 v227, v227, v223
  v_max_f32 v5, v226, v227
  v_cmp_lt_f32 vcc, s81, v5
  v_mfma_f32_16x16x32_bf16 a[116:119], a[184:187], v[180:183], a[116:119]
  v_exp_f32 v216, v128
  v_mfma_f32_16x16x32_bf16 a[120:123], a[188:191], v[176:179], a[120:123]
  v_cvt_pk_bf16_f32 v191, v222, v223
  v_mfma_f32_16x16x32_bf16 a[124:127], a[188:191], v[180:183], a[124:127]
  s_cbranch_vccnz fa_stub28
fa_back28:
  v_exp_f32 v217, v129
  v_add_f32 v230, v230, v226
  v_add_f32 v231, v231, v227
  ds_read_b128 a[160:163], v3 offset:24576
  ds_read_b128 a[164:167], v3 offset:25600
  ds_read_b128 a[168:171], v3 offset:26624
  ds_read_b128 a[172:175], v3 offset:27648
  ds_read_b128 a[176:179], v3 offset:28672
  ds_read_b128 a[180:183], v3 offset:29696
  ds_read_b128 a[184:187], v3 offset:30720
  ds_read_b128 a[188:191], v3 offset:31744
  v_cndmask_b32 v128, v4, v128, s[68:69]
  v_cndmask_b32 v129, v4, v129, s[70:71]
  v_cndmask_b32 v130, v4, v130, s[72:73]
  v_cndmask_b32 v131, v4, v131, s[74:75]
  v_mov_b32 v132, v4
  v_mov_b32 v133, v4
  v_mov_b32 v134, v4
  v_mov_b32 v135, v4
  v_cndmask_b32 v140, v4, v140, s[68:69]
  v_cndmask_b32 v141, v4, v141, s[70:71]
  v_cndmask_b32 v142, v4, v142, s[72:73]
  v_cndmask_b32 v143, v4, v143, s[74:75]
  v_exp_f32 v216, v128
  v_exp_f32 v217, v129
  v_exp_f32 v218, v130
  v_add_f32 v226, v216, v217
  v_cvt_pk_bf16_f32 v176, v216, v217
  v_add_f32 v226, v226, v218
  v_exp_f32 v219, v131
  v_exp_f32 v220, v132
  v_add_f32 v226, v226, v219
  v_cvt_pk_bf16_f32 v177, v218, v219
  v_add_f32 v226, v226, v220
  v_exp_f32 v221, v133
  s_waitcnt lgkmcnt(4)
  v_mfma_f32_16x16x32_bf16 a[64:67], a[160:163], v[184:187], a[64:67]
  v_exp_f32 v222, v134
  v_add_f32 v226, v226, v221
  v_mfma_f32_16x16x32_bf16 a[68:71], a[160:163], v[188:191], a[68:71]
  s_add_u32 s14, s13, 53248
  buffer_load_dwordx4 v[208:211], v2, s[40:43], s14 offen offset:2048 sc1
  v_exp_f32 v223, v135
  v_mfma_f32_16x16x32_bf16 a[72:75], a[164:167], v[184:187], a[72:75]
  s_add_u32 s66, s66, 32768
  v_exp_f32 v216, v136
  v_mfma_f32_16x16x32_bf16 a[76:79], a[164:167], v[188:191], a[76:79]
  s_and_b32 s66, s66, 0x1ffff
  v_exp_f32 v217, v137
  v_mfma_f32_16x16x32_bf16 a[80:83], a[168:171], v[184:187], a[80:83]
  buffer_load_dwordx4 v[212:215], v2, s[40:43], s14 offen offset:3072 sc1
  v_cvt_pk_bf16_f32 v178, v220, v221
  v_add_f32 v226, v226, v222
  v_add_f32 v226, v226, v223
  v_cvt_pk_bf16_f32 v179, v222, v223
  v_mfma_f32_16x16x32_bf16 a[84:87], a[168:171], v[188:191], a[84:87]
  v_exp_f32 v218, v138
  v_mfma_f32_16x16x32_bf16 a[88:91], a[172:175], v[184:187], a[88:91]
  v_exp_f32 v219, v139
  v_mfma_f32_16x16x32_bf16 a[92:95], a[172:175], v[188:191], a[92:95]
  s_waitcnt lgkmcnt(0)
  v_exp_f32 v220, v140
  v_mfma_f32_16x16x32_bf16 a[96:99], a[176:179], v[184:187], a[96:99]
  s_add_u32 s14, s13, 57344
  buffer_load_dwordx4 v[232:235], v2, s[40:43], s14 offen offset:0 sc1
  v_add_f32 v227, v216, v217
  v_cvt_pk_bf16_f32 v180, v216, v217
  v_add_f32 v227, v227, v218
  v_add_f32 v227, v227, v219
  v_cvt_pk_bf16_f32 v181, v218, v219
  v_exp_f32 v221, v141
  v_mfma_f32_16x16x32_bf16 a[100:103], a[176:179], v[188:191], a[100:103]
  v_exp_f32 v222, v142
  v_mfma_f32_16x16x32_bf16 a[104:107], a[180:183], v[184:187], a[104:107]
  v_exp_f32 v223, v143
  v_mfma_f32_16x16x32_bf16 a[108:111], a[180:183], v[188:191], a[108:111]
  buffer_load_dwordx4 v[236:239], v2, s[40:43], s14 offen offset:1024 sc1
  v_add_f32 v227, v227, v220
  v_add_f32 v227, v227, v221
  v_cvt_pk_bf16_f32 v182, v220, v221
  v_add_f32 v227, v227, v222
  v_mfma_f32_16x16x32_bf16 a[112:115], a[184:187], v[184:187], a[112:115]
  v_add_f32 v227, v227, v223
  v_max_f32 v5, v226, v227
  v_cmp_lt_f32 vcc, s81, v5
  v_mfma_f32_16x16x32_bf16 a[116:119], a[184:187], v[188:191], a[116:119]
  v_mfma_f32_16x16x32_bf16 a[120:123], a[188:191], v[184:187], a[120:123]
  v_cvt_pk_bf16_f32 v183, v222, v223
  v_add_u32 v3, s66, v2
  v_mfma_f32_16x16x32_bf16 a[124:127], a[188:191], v[188:191], a[124:127]
  s_cbranch_vccnz fa_stub29
fa_back29:
  v_add_f32 v230, v230, v226
  v_add_f32 v231, v231, v227
  s_cmp_ge_u32 s20, 2
  s_cbranch_scc1 fa_nb0
  s_waitcnt vmcnt(10)
  s_barrier
fa_nb0:
  ds_read_b128 a[160:163], v3 offset:16384
  ds_read_b128 a[164:167], v3 offset:17408
  ds_read_b128 a[168:171], v3 offset:18432
  ds_read_b128 a[172:175], v3 offset:19456
  ds_read_b128 a[176:179], v3 offset:20480
  ds_read_b128 a[180:183], v3 offset:21504
  ds_read_b128 a[184:187], v3 offset:22528
  ds_read_b128 a[188:191], v3 offset:23552
  s_waitcnt lgkmcnt(4)
  v_mfma_f32_16x16x32_bf16 a[64:67], a[160:163], v[176:179], a[64:67]
  v_mfma_f32_16x16x32_bf16 a[68:71], a[160:163], v[180:183], a[68:71]
  s_add_u32 s14, s13, 57344
  buffer_load_dwordx4 v[240:243], v2, s[40:43], s14 offen offset:2048 sc1
  v_mfma_f32_16x16x32_bf16 a[72:75], a[164:167], v[176:179], a[72:75]
  v_mfma_f32_16x16x32_bf16 a[76:79], a[164:167], v[180:183], a[76:79]
  v_mfma_f32_16x16x32_bf16 a[80:83], a[168:171], v[176:179], a[80:83]
  v_mfma_f32_16x16x32_bf16 a[84:87], a[168:171], v[180:183], a[84:87]
  v_mfma_f32_16x16x32_bf16 a[88:91], a[172:175], v[176:179], a[88:91]
  v_mfma_f32_16x16x32_bf16 a[92:95], a[172:175], v[180:183], a[92:95]
  s_waitcnt lgkmcnt(0)
  v_mfma_f32_16x16x32_bf16 a[96:99], a[176:179], v[176:179], a[96:99]
  buffer_load_dwordx4 v[244:247], v2, s[40:43], s14 offen offset:3072 sc1
  v_mfma_f32_16x16x32_bf16 a[100:103], a[176:179], v[180:183], a[100:103]
  v_mfma_f32_16x16x32_bf16 a[104:107], a[180:183], v[176:179], a[104:107]
  v_mfma_f32_16x16x32_bf16 a[108:111], a[180:183], v[180:183], a[108:111]
  v_mfma_f32_16x16x32_bf16 a[112:115], a[184:187], v[176:179], a[112:115]
  v_mfma_f32_16x16x32_bf16 a[116:119], a[184:187], v[180:183], a[116:119]
  v_mfma_f32_16x16x32_bf16 a[120:123], a[188:191], v[176:179], a[120:123]
  v_mfma_f32_16x16x32_bf16 a[124:127], a[188:191], v[180:183], a[124:127]
  s_branch fa_Bdone
fa_Bodd:
  s_cmp_ge_u32 s20, 2
  s_cbranch_scc1 fa_nb1
  s_waitcnt vmcnt(8)
  s_barrier
fa_nb1:
  ds_read_b128 a[160:163], v3 offset:16384
  ds_read_b128 a[164:167], v3 offset:17408
  ds_read_b128 a[168:171], v3 offset:18432
  ds_read_b128 a[172:175], v3 offset:19456
  ds_read_b128 a[176:179], v3 offset:20480
  ds_read_b128 a[180:183], v3 offset:21504
  ds_read_b128 a[184:187], v3 offset:22528
  ds_read_b128 a[188:191], v3 offset:23552
  v_cndmask_b32 v144, v4, v144, s[68:69]
  v_cndmask_b32 v145, v4, v145, s[70:71]
  v_cndmask_b32 v146, v4, v146, s[72:73]
  v_cndmask_b32 v147, v4, v147, s[74:75]
  v_mov_b32 v148, v4
  v_mov_b32 v149, v4
  v_mov_b32 v150, v4
  v_mov_b32 v151, v4
  v_cndmask_b32 v156, v4, v156, s[68:69]
  v_cndmask_b32 v157, v4, v157, s[70:71]
  v_cndmask_b32 v158, v4, v158, s[72:73]
  v_cndmask_b32 v159, v4, v159, s[74:75]
  v_exp_f32 v216, v144
  v_exp_f32 v217, v145
  v_exp_f32 v218, v146
  v_add_f32 v226, v216, v217
  v_cvt_pk_bf16_f32 v184, v216, v217
  v_add_f32 v226, v226, v218
  v_exp_f32 v219, v147
  v_exp_f32 v220, v148
  v_add_f32 v226, v226, v219
  v_cvt_pk_bf16_f32 v185, v218, v219
  v_add_f32 v226, v226, v220
  v_exp_f32 v221, v149
  s_waitcnt lgkmcnt(4)
  v_mfma_f32_16x16x32_bf16 a[64:67], a[160:163], v[176:179], a[64:67]
  v_exp_f32 v222, v150
  v_add_f32 v226, v226, v221
  v_mfma_f32_16x16x32_bf16 a[68:71], a[160:163], v[180:183], a[68:71]
  s_add_u32 s14, s13, 49152
  buffer_load_dwordx4 v[160:163], v2, s[40:43], s14 offen offset:0 sc1
  v_exp_f32 v223, v151
  v_mfma_f32_16x16x32_bf16 a[72:75], a[164:167], v[176:179], a[72:75]
  v_exp_f32 v216, v152
  v_cvt_pk_bf16_f32 v186, v220, v221
  v_add_f32 v226, v226, v222
  v_mfma_f32_16x16x32_bf16 a[76:79], a[164:167], v[180:183], a[76:79]
  buffer_load_dwordx4 v[164:167], v2, s[40:43], s14 offen offset:1024 sc1
  v_exp_f32 v217, v153
  v_mfma_f32_16x16x32_bf16 a[80:83], a[168:171], v[176:179], a[80:83]
  v_exp_f32 v218, v154
  v_add_f32 v226, v226, v223
  v_mfma_f32_16x16x32_bf16 a[84:87], a[168:171], v[180:183], a[84:87]
  buffer_load_dwordx4 v[168:171], v2, s[40:43], s14 offen offset:2048 sc1
  v_exp_f32 v219, v155
  v_cvt_pk_bf16_f32 v187, v222, v223
  v_mfma_f32_16x16x32_bf16 a[88:91], a[172:175], v[176:179], a[88:91]
  v_exp_f32 v220, v156
  v_mfma_f32_16x16x32_bf16 a[92:95], a[172:175], v[180:183], a[92:95]
  s_waitcnt lgkmcnt(0)
  buffer_load_dwordx4 v[172:175], v2, s[40:43], s14 offen offset:3072 sc1
  v_add_f32 v227, v216, v217
  v_cvt_pk_bf16_f32 v188, v216, v217
  v_add_f32 v227, v227, v218
  v_mfma_f32_16x16x32_bf16 a[96:99], a[176:179], v[176:179], a[96:99]
  v_exp_f32 v221, v157
  v_mfma_f32_16x16x32_bf16 a[100:103], a[176:179], v[180:183], a[100:103]
  s_add_u32 s14, s13, 53248
  buffer_load_dwordx4 v[192:195], v2, s[40:43], s14 offen offset:0 sc1
  v_exp_f32 v222, v158
  v_mfma_f32_16x16x32_bf16 a[104:107], a[180:183], v[176:179], a[104:107]
  v_exp_f32 v223, v159
  v_mfma_f32_16x16x32_bf16 a[108:111], a[180:183], v[180:183], a[108:111]
  buffer_load_dwordx4 v[196:199], v2, s[40:43], s14 offen offset:1024 sc1
  v_add_f32 v227, v227, v219
  v_cvt_pk_bf16_f32 v189, v218, v219
  v_add_f32 v227, v227, v220
  v_add_f32 v227, v227, v221
  v_cvt_pk_bf16_f32 v190, v220, v221
  v_add_f32 v227, v227, v222
  v_mfma_f32_16x16x32_bf16 a[112:115], a[184:187], v[176:179], a[112:115]
  v_add_f32 v227, v227, v223
  v_max_f32 v5, v226, v227
  v_cmp_lt_f32 vcc, s81, v5
  v_mfma_f32_16x16x32_bf16 a[116:119], a[184:187], v[180:183], a[116:119]
  buffer_load_dwordx4 v[208:211], v2, s[40:43], s14 offen offset:2048 sc1
  v_mfma_f32_16x16x32_bf16 a[120:123], a[188:191], v[176:179], a[120:123]
  v_cvt_pk_bf16_f32 v191, v222, v223
  v_mfma_f32_16x16x32_bf16 a[124:127], a[188:191], v[180:183], a[124:127]
  s_cbranch_vccnz fa_stub30
fa_back30:
  v_add_f32 v230, v230, v226
  v_add_f32 v231, v231, v227
  ds_read_b128 a[160:163], v3 offset:24576
  ds_read_b128 a[164:167], v3 offset:25600
  ds_read_b128 a[168:171], v3 offset:26624
  ds_read_b128 a[172:175], v3 offset:27648
  ds_read_b128 a[176:179], v3 offset:28672
  ds_read_b128 a[180:183], v3 offset:29696
  ds_read_b128 a[184:187], v3 offset:30720
  ds_read_b128 a[188:191], v3 offset:31744
  s_waitcnt lgkmcnt(4)
  v_mfma_f32_16x16x32_bf16 a[64:67], a[160:163], v[184:187], a[64:67]
  v_mfma_f32_16x16x32_bf16 a[68:71], a[160:163], v[188:191], a[68:71]
  s_add_u32 s14, s13, 53248
  buffer_load_dwordx4 v[212:215], v2, s[40:43], s14 offen offset:3072 sc1
  v_mfma_f32_16x16x32_bf16 a[72:75], a[164:167], v[184:187], a[72:75]
  s_add_u32 s66, s66, 32768
  v_mfma_f32_16x16x32_bf16 a[76:79], a[164:167], v[188:191], a[76:79]
  s_add_u32 s14, s13, 57344
  buffer_load_dwordx4 v[232:235], v2, s[40:43], s14 offen offset:0 sc1
  v_mfma_f32_16x16x32_bf16 a[80:83], a[168:171], v[184:187], a[80:83]
  s_and_b32 s66, s66, 0x1ffff
  v_mfma_f32_16x16x32_bf16 a[84:87], a[168:171], v[188:191], a[84:87]
  v_mfma_f32_16x16x32_bf16 a[88:91], a[172:175], v[184:187], a[88:91]
  buffer_load_dwordx4 v[236:239], v2, s[40:43], s14 offen offset:1024 sc1
  v_mfma_f32_16x16x32_bf16 a[92:95], a[172:175], v[188:191], a[92:95]
  s_waitcnt lgkmcnt(0)
  v_mfma_f32_16x16x32_bf16 a[96:99], a[176:179], v[184:187], a[96:99]
  v_mfma_f32_16x16x32_bf16 a[100:103], a[176:179], v[188:191], a[100:103]
  buffer_load_dwordx4 v[240:243], v2, s[40:43], s14 offen offset:2048 sc1
  v_mfma_f32_16x16x32_bf16 a[104:107], a[180:183], v[184:187], a[104:107]
  v_mfma_f32_16x16x32_bf16 a[108:111], a[180:183], v[188:191], a[108:111]
  v_mfma_f32_16x16x32_bf16 a[112:115], a[184:187], v[184:187], a[112:115]
  buffer_load_dwordx4 v[244:247], v2, s[40:43], s14 offen offset:3072 sc1
  v_mfma_f32_16x16x32_bf16 a[116:119], a[184:187], v[188:191], a[116:119]
  v_mfma_f32_16x16x32_bf16 a[120:123], a[188:191], v[184:187], a[120:123]
  v_add_u32 v3, s66, v2
  v_mfma_f32_16x16x32_bf16 a[124:127], a[188:191], v[188:191], a[124:127]
fa_Bdone:
fa_epi:
  v_mov_b32 v20, v230
  v_mov_b32 v21, v231
  s_nop 1
  v_permlane16_swap_b32 v230, v20
  v_permlane16_swap_b32 v231, v21
  v_add_f32 v230, v230, v20
  v_add_f32 v231, v231, v21
  v_mov_b32 v20, v230
  v_mov_b32 v21, v231
  s_nop 1
  v_permlane32_swap_b32 v230, v20
  v_permlane32_swap_b32 v231, v21
  v_add_f32 v230, v230, v20
  v_add_f32 v231, v231, v21
  v_rcp_f32 v16, v230
  v_rcp_f32 v18, v231
  s_sub_u32 s23, 15, s22
  s_lshl_b32 s23, s23, 2
  v_mov_b32 v17, v16
  v_mov_b32 v19, v18
  s_add_u32 s23, s23, s20
  s_lshl_b32 s23, s23, 18
  s_lshl_b32 s31, s21, 12
  s_add_u32 s31, s31, 50331648
  s_add_u32 s64, s23, s31
  s_add_u32 s65, s64, 131072
  v_accvgpr_read_b32 v68, a64
  v_accvgpr_read_b32 v69, a65
  v_accvgpr_read_b32 v70, a66
  v_accvgpr_read_b32 v71, a67
  v_accvgpr_read_b32 v72, a72
  v_accvgpr_read_b32 v73, a73
  v_accvgpr_read_b32 v74, a74
  v_accvgpr_read_b32 v75, a75
  v_pk_mul_f32 v[68:69], v[68:69], v[16:17]
  v_pk_mul_f32 v[70:71], v[70:71], v[16:17]
  v_pk_mul_f32 v[72:73], v[72:73], v[16:17]
  v_pk_mul_f32 v[74:75], v[74:75], v[16:17]
  v_cvt_pk_bf16_f32 v64, v68, v69
  v_cvt_pk_bf16_f32 v65, v70, v71
  v_cvt_pk_bf16_f32 v66, v72, v73
  v_cvt_pk_bf16_f32 v67, v74, v75
  buffer_store_dwordx4 v[64:67], v2, s[40:43], s64 offen offset:0 sc1
  v_accvgpr_read_b32 v80, a80
  v_accvgpr_read_b32 v81, a81
  v_accvgpr_read_b32 v82, a82
  v_accvgpr_read_b32 v83, a83
  v_accvgpr_read_b32 v84, a88
  v_accvgpr_read_b32 v85, a89
  v_accvgpr_read_b32 v86, a90
  v_accvgpr_read_b32 v87, a91
  v_pk_mul_f32 v[80:81], v[80:81], v[16:17]
  v_pk_mul_f32 v[82:83], v[82:83], v[16:17]
  v_pk_mul_f32 v[84:85], v[84:85], v[16:17]
  v_pk_mul_f32 v[86:87], v[86:87], v[16:17]
  v_cvt_pk_bf16_f32 v76, v80, v81
  v_cvt_pk_bf16_f32 v77, v82, v83
  v_cvt_pk_bf16_f32 v78, v84, v85
  v_cvt_pk_bf16_f32 v79, v86, v87
  buffer_store_dwordx4 v[76:79], v2, s[40:43], s64 offen offset:1024 sc1
  v_accvgpr_read_b32 v132, a96
  v_accvgpr_read_b32 v133, a97
  v_accvgpr_read_b32 v134, a98
  v_accvgpr_read_b32 v135, a99
  v_accvgpr_read_b32 v136, a104
  v_accvgpr_read_b32 v137, a105
  v_accvgpr_read_b32 v138, a106
  v_accvgpr_read_b32 v139, a107
  v_pk_mul_f32 v[132:133], v[132:133], v[16:17]
  v_pk_mul_f32 v[134:135], v[134:135], v[16:17]
  v_pk_mul_f32 v[136:137], v[136:137], v[16:17]
  v_pk_mul_f32 v[138:139], v[138:139], v[16:17]
  v_cvt_pk_bf16_f32 v128, v132, v133
  v_cvt_pk_bf16_f32 v129, v134, v135
  v_cvt_pk_bf16_f32 v130, v136, v137
  v_cvt_pk_bf16_f32 v131, v138, v139
  buffer_store_dwordx4 v[128:131], v2, s[40:43], s64 offen offset:2048 sc1
  v_accvgpr_read_b32 v144, a112
  v_accvgpr_read_b32 v145, a113
  v_accvgpr_read_b32 v146, a114
  v_accvgpr_read_b32 v147, a115
  v_accvgpr_read_b32 v148, a120
  v_accvgpr_read_b32 v149, a121
  v_accvgpr_read_b32 v150, a122
  v_accvgpr_read_b32 v151, a123
  v_pk_mul_f32 v[144:145], v[144:145], v[16:17]
  v_pk_mul_f32 v[146:147], v[146:147], v[16:17]
  v_pk_mul_f32 v[148:149], v[148:149], v[16:17]
  v_pk_mul_f32 v[150:151], v[150:151], v[16:17]
  v_cvt_pk_bf16_f32 v140, v144, v145
  v_cvt_pk_bf16_f32 v141, v146, v147
  v_cvt_pk_bf16_f32 v142, v148, v149
  v_cvt_pk_bf16_f32 v143, v150, v151
  buffer_store_dwordx4 v[140:143], v2, s[40:43], s64 offen offset:3072 sc1
  v_accvgpr_read_b32 v68, a68
  v_accvgpr_read_b32 v69, a69
  v_accvgpr_read_b32 v70, a70
  v_accvgpr_read_b32 v71, a71
  v_accvgpr_read_b32 v72, a76
  v_accvgpr_read_b32 v73, a77
  v_accvgpr_read_b32 v74, a78
  v_accvgpr_read_b32 v75, a79
  v_pk_mul_f32 v[68:69], v[68:69], v[18:19]
  v_pk_mul_f32 v[70:71], v[70:71], v[18:19]
  v_pk_mul_f32 v[72:73], v[72:73], v[18:19]
  v_pk_mul_f32 v[74:75], v[74:75], v[18:19]
  v_cvt_pk_bf16_f32 v64, v68, v69
  v_cvt_pk_bf16_f32 v65, v70, v71
  v_cvt_pk_bf16_f32 v66, v72, v73
  v_cvt_pk_bf16_f32 v67, v74, v75
  buffer_store_dwordx4 v[64:67], v2, s[40:43], s65 offen offset:0 sc1
  v_accvgpr_read_b32 v80, a84
  v_accvgpr_read_b32 v81, a85
  v_accvgpr_read_b32 v82, a86
  v_accvgpr_read_b32 v83, a87
  v_accvgpr_read_b32 v84, a92
  v_accvgpr_read_b32 v85, a93
  v_accvgpr_read_b32 v86, a94
  v_accvgpr_read_b32 v87, a95
  v_pk_mul_f32 v[80:81], v[80:81], v[18:19]
  v_pk_mul_f32 v[82:83], v[82:83], v[18:19]
  v_pk_mul_f32 v[84:85], v[84:85], v[18:19]
  v_pk_mul_f32 v[86:87], v[86:87], v[18:19]
  v_cvt_pk_bf16_f32 v76, v80, v81
  v_cvt_pk_bf16_f32 v77, v82, v83
  v_cvt_pk_bf16_f32 v78, v84, v85
  v_cvt_pk_bf16_f32 v79, v86, v87
  buffer_store_dwordx4 v[76:79], v2, s[40:43], s65 offen offset:1024 sc1
  v_accvgpr_read_b32 v132, a100
  v_accvgpr_read_b32 v133, a101
  v_accvgpr_read_b32 v134, a102
  v_accvgpr_read_b32 v135, a103
  v_accvgpr_read_b32 v136, a108
  v_accvgpr_read_b32 v137, a109
  v_accvgpr_read_b32 v138, a110
  v_accvgpr_read_b32 v139, a111
  v_pk_mul_f32 v[132:133], v[132:133], v[18:19]
  v_pk_mul_f32 v[134:135], v[134:135], v[18:19]
  v_pk_mul_f32 v[136:137], v[136:137], v[18:19]
  v_pk_mul_f32 v[138:139], v[138:139], v[18:19]
  v_cvt_pk_bf16_f32 v128, v132, v133
  v_cvt_pk_bf16_f32 v129, v134, v135
  v_cvt_pk_bf16_f32 v130, v136, v137
  v_cvt_pk_bf16_f32 v131, v138, v139
  buffer_store_dwordx4 v[128:131], v2, s[40:43], s65 offen offset:2048 sc1
  v_accvgpr_read_b32 v144, a116
  v_accvgpr_read_b32 v145, a117
  v_accvgpr_read_b32 v146, a118
  v_accvgpr_read_b32 v147, a119
  v_accvgpr_read_b32 v148, a124
  v_accvgpr_read_b32 v149, a125
  v_accvgpr_read_b32 v150, a126
  v_accvgpr_read_b32 v151, a127
  v_pk_mul_f32 v[144:145], v[144:145], v[18:19]
  v_pk_mul_f32 v[146:147], v[146:147], v[18:19]
  v_pk_mul_f32 v[148:149], v[148:149], v[18:19]
  v_pk_mul_f32 v[150:151], v[150:151], v[18:19]
  v_cvt_pk_bf16_f32 v140, v144, v145
  v_cvt_pk_bf16_f32 v141, v146, v147
  v_cvt_pk_bf16_f32 v142, v148, v149
  v_cvt_pk_bf16_f32 v143, v150, v151
  buffer_store_dwordx4 v[140:143], v2, s[40:43], s65 offen offset:3072 sc1
  s_load_dwordx2 s[8:9], s[0:1], 0
  s_load_dwordx2 s[16:17], s[0:1], 88
  v_mov_b32 v30, 1073741824
  v_writelane_b32 v30, s80, 0
  v_writelane_b32 v30, s3, 1
  s_cmp_lt_u32 s12, 3
  s_cbranch_scc1 fa_puby
  s_add_u32 s14, s13, 61440
  buffer_load_dwordx4 v[64:67], v2, s[40:43], s14 offen offset:0 sc1
  buffer_load_dwordx4 v[68:71], v2, s[40:43], s14 offen offset:1024 sc1
  buffer_load_dwordx4 v[72:75], v2, s[40:43], s14 offen offset:2048 sc1
  buffer_load_dwordx4 v[76:79], v2, s[40:43], s14 offen offset:3072 sc1
  s_waitcnt vmcnt(4)
  buffer_store_dword v4, v30, s[40:43], 0 offen sc1
fa_pubb:
  s_setprio 0
  s_cmp_lt_u32 s29, 8
  s_cbranch_scc1 fa_left
fa_leftb:
  s_add_u32 s14, s13, 65536
  buffer_load_dwordx4 v[80:83], v2, s[40:43], s14 offen offset:0 sc1
  buffer_load_dwordx4 v[84:87], v2, s[40:43], s14 offen offset:1024 sc1
  buffer_load_dwordx4 v[88:91], v2, s[40:43], s14 offen offset:2048 sc1
  buffer_load_dwordx4 v[92:95], v2, s[40:43], s14 offen offset:3072 sc1
  s_add_u32 s14, s13, 69632
  buffer_load_dwordx4 v[128:131], v2, s[40:43], s14 offen offset:0 sc1
  buffer_load_dwordx4 v[132:135], v2, s[40:43], s14 offen offset:1024 sc1
  buffer_load_dwordx4 v[136:139], v2, s[40:43], s14 offen offset:2048 sc1
  buffer_load_dwordx4 v[140:143], v2, s[40:43], s14 offen offset:3072 sc1
  s_add_u32 s14, s13, 73728
  buffer_load_dwordx4 v[144:147], v2, s[40:43], s14 offen offset:0 sc1
  buffer_load_dwordx4 v[148:151], v2, s[40:43], s14 offen offset:1024 sc1
  s_lshl_b32 s63, s21, 19
  s_lshl_b32 s23, s20, 15
  s_add_u32 s63, s63, s23
  s_add_u32 s63, s63, 50331648
  s_mul_i32 s62, s22, 0
  s_and_b32 s62, s62, 0x7fff
  s_add_u32 s64, s63, s62
  s_add_u32 s65, s64, 131072
  s_add_u32 s66, s64, 262144
  s_add_u32 s67, s64, 393216
  v_bfe_u32 v12, v1, 3, 1
  v_mul_u32_u24 v12, 4352, v12
  v_and_b32 v13, 7, v1
  v_lshl_add_u32 v12, v13, 2, v12
  s_mul_i32 s23, s21, 8704
  s_lshl_b32 s31, s20, 5
  s_add_u32 s23, s23, s31
  s_add_u32 s23, s23, 3801088
  v_add_u32 v12, s23, v12
  v_mov_b32 v20, 0
  v_mov_b32 v21, 0
  v_mov_b32 v22, 0
  v_mov_b32 v23, 0
  v_add_u32 v16, 158208, v2
  ds_write_b128 v16, v[20:23]
  buffer_load_dwordx4 v[152:155], v2, s[40:43], s14 offen offset:2048 sc1
  buffer_load_dwordx4 v[156:159], v2, s[40:43], s14 offen offset:3072 sc1
  s_add_u32 s14, s13, 77824
  buffer_load_dwordx4 v[176:179], v2, s[40:43], s14 offen offset:0 sc1
  buffer_load_dwordx4 v[180:183], v2, s[40:43], s14 offen offset:1024 sc1
  buffer_load_dwordx4 v[184:187], v2, s[40:43], s14 offen offset:2048 sc1
  buffer_load_dwordx4 v[188:191], v2, s[40:43], s14 offen offset:3072 sc1
  s_lshl_b32 s34, s28, 1
  s_and_b32 s23, s20, 1
  s_lshl_b32 s23, s23, 12
  s_cmp_lt_u32 s20, 2
  s_cselect_b32 s33, 106496, 0
  s_add_u32 s33, s33, s23
  s_add_u32 s33, s33, s34
  s_and_b32 s33, s33, 0x1ffff
  s_lshl_b32 s23, s20, 12
  s_add_u32 s34, s34, 49152
  s_add_u32 s34, s34, s23
  s_and_b32 s34, s34, 0x1ffff
  s_add_u32 s23, s23, s28
  s_cmp_lt_u32 s29, 3
  s_cselect_b32 s26, s23, s26
  s_cselect_b32 s27, s23, s27
  s_cselect_b32 s24, s33, s24
  s_cselect_b32 s25, s34, s25
  s_mov_b64 s[44:45], s[4:5]
  s_mov_b64 s[48:49], s[6:7]
  s_mov_b32 s46, s30
  s_mov_b32 s50, s30
  s_add_u32 s23, s28, 49152
fa_pk:
  s_cmp_ge_u32 s26, s23
  s_cbranch_scc1 fa_pkd
  s_mov_b32 m0, s24
  s_add_u32 s24, s24, 32768
  s_and_b32 s24, s24, 0x1ffff
  buffer_load_dwordx4 v2, s[44:47], s26 offen offset:0 sc1 lds
  buffer_load_dwordx4 v2, s[44:47], s26 offen offset:1024 sc1 lds
  buffer_load_dwordx4 v2, s[44:47], s26 offen offset:2048 sc1 lds
  buffer_load_dwordx4 v2, s[44:47], s26 offen offset:3072 sc1 lds
  s_add_u32 s26, s26, 16384
  s_branch fa_pk
fa_pkd:
  s_add_u32 s23, s28, 32768
fa_pv:
  s_cmp_ge_u32 s27, s23
  s_cbranch_scc1 fa_pvd
  s_mov_b32 m0, s25
  s_add_u32 s25, s25, 32768
  s_and_b32 s25, s25, 0x1ffff
  buffer_load_dwordx4 v2, s[48:51], s27 offen offset:0 sc1 lds
  buffer_load_dwordx4 v2, s[48:51], s27 offen offset:1024 sc1 lds
  buffer_load_dwordx4 v2, s[48:51], s27 offen offset:2048 sc1 lds
  buffer_load_dwordx4 v2, s[48:51], s27 offen offset:3072 sc1 lds
  s_add_u32 s27, s27, 16384
  s_branch fa_pv
fa_pvd:
  s_lshl_b32 s35, s20, 12
  s_add_u32 s35, s35, 131072
  s_mov_b32 m0, s35
  s_add_u32 s14, s13, 155648
  buffer_load_dwordx4 v2, s[40:43], s14 offen offset:0 sc1 lds
  buffer_load_dwordx4 v2, s[40:43], s14 offen offset:1024 sc1 lds
  buffer_load_dwordx4 v2, s[40:43], s14 offen offset:2048 sc1 lds
  buffer_load_dwordx4 v2, s[40:43], s14 offen offset:3072 sc1 lds
  s_waitcnt lgkmcnt(0)
  s_barrier
  s_mov_b32 m0, s24
  s_add_u32 s24, s24, 32768
  s_and_b32 s24, s24, 0x1ffff
  buffer_load_dwordx4 v2, s[44:47], s26 offen offset:0 sc1 lds
  buffer_load_dwordx4 v2, s[44:47], s26 offen offset:1024 sc1 lds
  buffer_load_dwordx4 v2, s[44:47], s26 offen offset:2048 sc1 lds
  buffer_load_dwordx4 v2, s[44:47], s26 offen offset:3072 sc1 lds
  s_add_u32 s26, s26, 16384
  buffer_load_dword v13, v12, s[40:43], 0 offen sc1
  s_mov_b32 m0, s25
  s_add_u32 s25, s25, 32768
  s_and_b32 s25, s25, 0x1ffff
  buffer_load_dwordx4 v2, s[48:51], s27 offen offset:0 sc1 lds
  buffer_load_dwordx4 v2, s[48:51], s27 offen offset:1024 sc1 lds
  buffer_load_dwordx4 v2, s[48:51], s27 offen offset:2048 sc1 lds
  buffer_load_dwordx4 v2, s[48:51], s27 offen offset:3072 sc1 lds
  s_add_u32 s27, s27, 16384
  s_mov_b32 m0, s25
  s_add_u32 s25, s25, 32768
  s_and_b32 s25, s25, 0x1ffff
  buffer_load_dwordx4 v2, s[48:51], s27 offen offset:0 sc1 lds
  buffer_load_dwordx4 v2, s[48:51], s27 offen offset:1024 sc1 lds
  buffer_load_dwordx4 v2, s[48:51], s27 offen offset:2048 sc1 lds
  buffer_load_dwordx4 v2, s[48:51], s27 offen offset:3072 sc1 lds
  s_add_u32 s27, s27, 16384
  s_mov_b32 s44, s8
  s_mov_b32 s45, s9
  s_mov_b32 s46, 2621440
  s_mov_b32 s47, 0x20000
  s_mov_b32 s48, s16
  s_mov_b32 s49, s17
  s_mov_b32 s50, 2621440
  s_mov_b32 s51, 0x20000
  s_lshl_b32 s25, s21, 6
  s_mul_i32 s26, s22, 160
  s_mul_i32 s27, s22, 2560
  s_waitcnt vmcnt(8)
  v_cmp_eq_u32 vcc, 0, v13
  s_cbranch_vccnz fa_ctx_spin
fa_ctx_ok:
  buffer_load_dwordx4 a[144:147], v2, s[40:43], s64 offen offset:0 sc1
  buffer_load_dwordx4 a[148:151], v2, s[40:43], s65 offen offset:0 sc1
  buffer_load_dwordx4 a[152:155], v2, s[40:43], s66 offen offset:0 sc1
  buffer_load_dwordx4 a[156:159], v2, s[40:43], s67 offen offset:0 sc1
  buffer_load_dwordx4 a[160:163], v2, s[40:43], s64 offen offset:1024 sc1
  buffer_load_dwordx4 a[164:167], v2, s[40:43], s65 offen offset:1024 sc1
  buffer_load_dwordx4 a[168:171], v2, s[40:43], s66 offen offset:1024 sc1
  buffer_load_dwordx4 a[172:175], v2, s[40:43], s67 offen offset:1024 sc1
  buffer_load_dwordx4 a[176:179], v2, s[40:43], s64 offen offset:2048 sc1
  buffer_load_dwordx4 a[180:183], v2, s[40:43], s65 offen offset:2048 sc1
  buffer_load_dwordx4 a[184:187], v2, s[40:43], s66 offen offset:2048 sc1
  buffer_load_dwordx4 a[188:191], v2, s[40:43], s67 offen offset:2048 sc1
  buffer_load_dwordx4 v[216:219], v2, s[40:43], s64 offen offset:3072 sc1
  buffer_load_dwordx4 v[220:223], v2, s[40:43], s65 offen offset:3072 sc1
  buffer_load_dwordx4 v[224:227], v2, s[40:43], s66 offen offset:3072 sc1
  buffer_load_dwordx4 v[228:231], v2, s[40:43], s67 offen offset:3072 sc1
  s_add_u32 s62, s62, 4096
  s_and_b32 s62, s62, 0x7fff
  s_add_u32 s64, s63, s62
  s_add_u32 s65, s64, 131072
  s_add_u32 s66, s64, 262144
  s_add_u32 s67, s64, 393216
  s_waitcnt vmcnt(14)
  v_mfma_f32_16x16x32_bf16 a[64:67], a[192:195], a[144:147], 0
  v_mfma_f32_16x16x32_bf16 a[80:83], a[196:199], a[144:147], 0
  v_mfma_f32_16x16x32_bf16 a[96:99], a[200:203], a[144:147], 0
  v_mfma_f32_16x16x32_bf16 a[112:115], a[204:207], a[144:147], 0
  v_mfma_f32_16x16x32_bf16 a[128:131], a[208:211], a[144:147], 0
  buffer_load_dwordx4 a[144:147], v2, s[40:43], s64 offen offset:0 sc1
  v_mfma_f32_16x16x32_bf16 a[68:71], a[192:195], a[148:151], 0
  v_mfma_f32_16x16x32_bf16 a[84:87], a[196:199], a[148:151], 0
  v_mfma_f32_16x16x32_bf16 a[100:103], a[200:203], a[148:151], 0
  v_mfma_f32_16x16x32_bf16 a[116:119], a[204:207], a[148:151], 0
  v_mfma_f32_16x16x32_bf16 a[132:135], a[208:211], a[148:151], 0
  s_waitcnt vmcnt(13)
  buffer_load_dwordx4 a[148:151], v2, s[40:43], s65 offen offset:0 sc1
  v_mfma_f32_16x16x32_bf16 a[72:75], a[192:195], a[152:155], 0
  v_mfma_f32_16x16x32_bf16 a[88:91], a[196:199], a[152:155], 0
  v_mfma_f32_16x16x32_bf16 a[104:107], a[200:203], a[152:155], 0
  v_mfma_f32_16x16x32_bf16 a[120:123], a[204:207], a[152:155], 0
  v_mfma_f32_16x16x32_bf16 a[136:139], a[208:211], a[152:155], 0
  buffer_load_dwordx4 a[152:155], v2, s[40:43], s66 offen offset:0 sc1
  v_mfma_f32_16x16x32_bf16 a[76:79], a[192:195], a[156:159], 0
  v_mfma_f32_16x16x32_bf16 a[92:95], a[196:199], a[156:159], 0
  v_mfma_f32_16x16x32_bf16 a[108:111], a[200:203], a[156:159], 0
  v_mfma_f32_16x16x32_bf16 a[124:127], a[204:207], a[156:159], 0
  v_mfma_f32_16x16x32_bf16 a[140:143], a[208:211], a[156:159], 0
  s_waitcnt vmcnt(13)
  buffer_load_dwordx4 a[156:159], v2, s[40:43], s67 offen offset:0 sc1
  v_mfma_f32_16x16x32_bf16 a[64:67], a[212:215], a[160:163], a[64:67]
  v_add_u32 v16, 0, v0
  v_mfma_f32_16x16x32_bf16 a[80:83], a[216:219], a[160:163], a[80:83]
  v_mfma_f32_16x16x32_bf16 a[96:99], a[220:223], a[160:163], a[96:99]
  s_add_u32 s14, s13, 81920
  buffer_load_dwordx4 a[192:195], v2, s[40:43], s14 offen offset:0 sc1
  v_mul_u32_u24 v17, 6554, v16
  v_mfma_f32_16x16x32_bf16 a[112:115], a[224:227], a[160:163], a[112:115]
  v_mfma_f32_16x16x32_bf16 a[128:131], a[228:231], a[160:163], a[128:131]
  buffer_load_dwordx4 a[160:163], v2, s[40:43], s64 offen offset:1024 sc1
  v_mfma_f32_16x16x32_bf16 a[68:71], a[212:215], a[164:167], a[68:71]
  v_lshrrev_b32 v17, 16, v17
  v_mfma_f32_16x16x32_bf16 a[84:87], a[216:219], a[164:167], a[84:87]
  v_mul_u32_u24 v18, 10, v17
  v_mfma_f32_16x16x32_bf16 a[100:103], a[220:223], a[164:167], a[100:103]
  v_mfma_f32_16x16x32_bf16 a[116:119], a[224:227], a[164:167], a[116:119]
  v_mfma_f32_16x16x32_bf16 a[132:135], a[228:231], a[164:167], a[132:135]
  s_waitcnt vmcnt(14)
  buffer_load_dwordx4 a[164:167], v2, s[40:43], s65 offen offset:1024 sc1
  v_sub_u32 v18, v16, v18
  v_mfma_f32_16x16x32_bf16 a[72:75], a[212:215], a[168:171], a[72:75]
  v_mfma_f32_16x16x32_bf16 a[88:91], a[216:219], a[168:171], a[88:91]
  v_mfma_f32_16x16x32_bf16 a[104:107], a[220:223], a[168:171], a[104:107]
  buffer_load_dwordx4 a[196:199], v2, s[40:43], s14 offen offset:1024 sc1
  v_mfma_f32_16x16x32_bf16 a[120:123], a[224:227], a[168:171], a[120:123]
  v_mul_u32_u24 v251, 336, v17
  v_mfma_f32_16x16x32_bf16 a[136:139], a[228:231], a[168:171], a[136:139]
  buffer_load_dwordx4 a[168:171], v2, s[40:43], s66 offen offset:1024 sc1
  v_lshl_add_u32 v251, v18, 5, v251
  v_mfma_f32_16x16x32_bf16 a[76:79], a[212:215], a[172:175], a[76:79]
  v_mfma_f32_16x16x32_bf16 a[92:95], a[216:219], a[172:175], a[92:95]
  v_mfma_f32_16x16x32_bf16 a[108:111], a[220:223], a[172:175], a[108:111]
  v_mfma_f32_16x16x32_bf16 a[124:127], a[224:227], a[172:175], a[124:127]
  v_mfma_f32_16x16x32_bf16 a[140:143], a[228:231], a[172:175], a[140:143]
  s_waitcnt vmcnt(15)
  buffer_load_dwordx4 a[172:175], v2, s[40:43], s67 offen offset:1024 sc1
  v_mfma_f32_16x16x32_bf16 a[64:67], a[232:235], a[176:179], a[64:67]
  v_lshlrev_b32 v203, 5, v18
  v_mfma_f32_16x16x32_bf16 a[80:83], a[236:239], a[176:179], a[80:83]
  v_mfma_f32_16x16x32_bf16 a[96:99], a[240:243], a[176:179], a[96:99]
  buffer_load_dwordx4 a[200:203], v2, s[40:43], s14 offen offset:2048 sc1
  v_add_u32 v17, s25, v17
  v_mfma_f32_16x16x32_bf16 a[112:115], a[244:247], a[176:179], a[112:115]
  v_mfma_f32_16x16x32_bf16 a[128:131], a[248:251], a[176:179], a[128:131]
  buffer_load_dwordx4 a[176:179], v2, s[40:43], s64 offen offset:2048 sc1
  v_mfma_f32_16x16x32_bf16 a[68:71], a[232:235], a[180:183], a[68:71]
  v_add_u32 v24, 1, v17
  v_mfma_f32_16x16x32_bf16 a[84:87], a[236:239], a[180:183], a[84:87]
  v_mul_u32_u24 v248, 1280, v17
  v_mfma_f32_16x16x32_bf16 a[100:103], a[240:243], a[180:183], a[100:103]
  v_mfma_f32_16x16x32_bf16 a[116:119], a[244:247], a[180:183], a[116:119]
  v_mfma_f32_16x16x32_bf16 a[132:135], a[248:251], a[180:183], a[132:135]
  s_waitcnt vmcnt(16)
  buffer_load_dwordx4 a[180:183], v2, s[40:43], s65 offen offset:2048 sc1
  v_lshl_add_u32 v248, v18, 4, v248
  v_mfma_f32_16x16x32_bf16 a[72:75], a[232:235], a[184:187], a[72:75]
  v_mfma_f32_16x16x32_bf16 a[88:91], a[236:239], a[184:187], a[88:91]
  v_mfma_f32_16x16x32_bf16 a[104:107], a[240:243], a[184:187], a[104:107]
  buffer_load_dwordx4 a[204:207], v2, s[40:43], s14 offen offset:3072 sc1
  v_mfma_f32_16x16x32_bf16 a[120:123], a[244:247], a[184:187], a[120:123]
  v_add_u32 v248, s26, v248
  v_mfma_f32_16x16x32_bf16 a[136:139], a[248:251], a[184:187], a[136:139]
  buffer_load_dwordx4 a[184:187], v2, s[40:43], s66 offen offset:2048 sc1
  v_lshrrev_b32 v19, 4, v17
  v_mfma_f32_16x16x32_bf16 a[76:79], a[232:235], a[188:191], a[76:79]
  v_mfma_f32_16x16x32_bf16 a[92:95], a[236:239], a[188:191], a[92:95]
  v_mfma_f32_16x16x32_bf16 a[108:111], a[240:243], a[188:191], a[108:111]
  v_mfma_f32_16x16x32_bf16 a[124:127], a[244:247], a[188:191], a[124:127]
  v_mfma_f32_16x16x32_bf16 a[140:143], a[248:251], a[188:191], a[140:143]
  s_waitcnt vmcnt(17)
  buffer_load_dwordx4 a[188:191], v2, s[40:43], s67 offen offset:2048 sc1
  v_mfma_f32_16x16x32_bf16 a[64:67], a[252:255], v[216:219], a[64:67]
  v_mul_u32_u24 v19, 20480, v19
  v_mfma_f32_16x16x32_bf16 a[80:83], a[0:3], v[216:219], a[80:83]
  v_mfma_f32_16x16x32_bf16 a[96:99], a[4:7], v[216:219], a[96:99]
  s_add_u32 s14, s13, 86016
  buffer_load_dwordx4 a[208:211], v2, s[40:43], s14 offen offset:0 sc1
  v_and_b32 v17, 15, v17
  v_mfma_f32_16x16x32_bf16 a[112:115], a[8:11], v[216:219], a[112:115]
  v_mfma_f32_16x16x32_bf16 a[128:131], a[12:15], v[216:219], a[128:131]
  buffer_load_dwordx4 v[216:219], v2, s[40:43], s64 offen offset:3072 sc1
  v_mfma_f32_16x16x32_bf16 a[68:71], a[252:255], v[220:223], a[68:71]
  v_lshl_add_u32 v19, v17, 4, v19
  v_mfma_f32_16x16x32_bf16 a[84:87], a[0:3], v[220:223], a[84:87]
  v_lshl_add_u32 v200, v18, 8, v19
  v_mfma_f32_16x16x32_bf16 a[100:103], a[4:7], v[220:223], a[100:103]
  v_mfma_f32_16x16x32_bf16 a[116:119], a[8:11], v[220:223], a[116:119]
  v_mfma_f32_16x16x32_bf16 a[132:135], a[12:15], v[220:223], a[132:135]
  s_waitcnt vmcnt(18)
  buffer_load_dwordx4 v[220:223], v2, s[40:43], s65 offen offset:3072 sc1
  v_mov_b32 v27, 8
  v_mfma_f32_16x16x32_bf16 a[72:75], a[252:255], v[224:227], a[72:75]
  v_mfma_f32_16x16x32_bf16 a[88:91], a[0:3], v[224:227], a[88:91]
  v_mfma_f32_16x16x32_bf16 a[104:107], a[4:7], v[224:227], a[104:107]
  buffer_load_dwordx4 a[212:215], v2, s[40:43], s14 offen offset:1024 sc1
  v_mfma_f32_16x16x32_bf16 a[120:123], a[8:11], v[224:227], a[120:123]
  v_add_u32 v16, 256, v0
  v_mfma_f32_16x16x32_bf16 a[136:139], a[12:15], v[224:227], a[136:139]
  buffer_load_dwordx4 v[224:227], v2, s[40:43], s66 offen offset:3072 sc1
  v_mul_u32_u24 v17, 6554, v16
  v_mfma_f32_16x16x32_bf16 a[76:79], a[252:255], v[228:231], a[76:79]
  v_mfma_f32_16x16x32_bf16 a[92:95], a[0:3], v[228:231], a[92:95]
  v_mfma_f32_16x16x32_bf16 a[108:111], a[4:7], v[228:231], a[108:111]
  v_mfma_f32_16x16x32_bf16 a[124:127], a[8:11], v[228:231], a[124:127]
  v_mfma_f32_16x16x32_bf16 a[140:143], a[12:15], v[228:231], a[140:143]
  s_waitcnt vmcnt(19)
  buffer_load_dwordx4 v[228:231], v2, s[40:43], s67 offen offset:3072 sc1
  v_mfma_f32_16x16x32_bf16 a[64:67], a[16:19], a[144:147], a[64:67]
  s_add_u32 s62, s62, 4096
  v_lshrrev_b32 v17, 16, v17
  v_mfma_f32_16x16x32_bf16 a[80:83], a[20:23], a[144:147], a[80:83]
  s_and_b32 s62, s62, 0x7fff
  v_mfma_f32_16x16x32_bf16 a[96:99], a[24:27], a[144:147], a[96:99]
  buffer_load_dwordx4 a[216:219], v2, s[40:43], s14 offen offset:2048 sc1
  v_mul_u32_u24 v18, 10, v17
  v_mfma_f32_16x16x32_bf16 a[112:115], a[28:31], a[144:147], a[112:115]
  s_add_u32 s64, s63, s62
  v_mfma_f32_16x16x32_bf16 a[128:131], a[32:35], a[144:147], a[128:131]
  buffer_load_dwordx4 a[144:147], v2, s[40:43], s64 offen offset:0 sc1
  v_mfma_f32_16x16x32_bf16 a[68:71], a[16:19], a[148:151], a[68:71]
  s_add_u32 s65, s64, 131072
  v_sub_u32 v18, v16, v18
  v_mfma_f32_16x16x32_bf16 a[84:87], a[20:23], a[148:151], a[84:87]
  s_add_u32 s66, s64, 262144
  v_mul_u32_u24 v252, 336, v17
  v_mfma_f32_16x16x32_bf16 a[100:103], a[24:27], a[148:151], a[100:103]
  v_mfma_f32_16x16x32_bf16 a[116:119], a[28:31], a[148:151], a[116:119]
  v_mfma_f32_16x16x32_bf16 a[132:135], a[32:35], a[148:151], a[132:135]
  s_waitcnt vmcnt(20)
  buffer_load_dwordx4 a[148:151], v2, s[40:43], s65 offen offset:0 sc1
  v_lshl_add_u32 v252, v18, 5, v252
  v_mfma_f32_16x16x32_bf16 a[72:75], a[16:19], a[152:155], a[72:75]
  s_add_u32 s67, s64, 393216
  v_mfma_f32_16x16x32_bf16 a[88:91], a[20:23], a[152:155], a[88:91]
  v_mfma_f32_16x16x32_bf16 a[104:107], a[24:27], a[152:155], a[104:107]
  v_mfma_f32_16x16x32_bf16 a[120:123], a[28:31], a[152:155], a[120:123]
  v_lshlrev_b32 v204, 5, v18
  v_mfma_f32_16x16x32_bf16 a[136:139], a[32:35], a[152:155], a[136:139]
  buffer_load_dwordx4 a[152:155], v2, s[40:43], s66 offen offset:0 sc1
  v_add_u32 v17, s25, v17
  v_mfma_f32_16x16x32_bf16 a[76:79], a[16:19], a[156:159], a[76:79]
  v_mfma_f32_16x16x32_bf16 a[92:95], a[20:23], a[156:159], a[92:95]
  v_mfma_f32_16x16x32_bf16 a[108:111], a[24:27], a[156:159], a[108:111]
  v_mfma_f32_16x16x32_bf16 a[124:127], a[28:31], a[156:159], a[124:127]
  v_mfma_f32_16x16x32_bf16 a[140:143], a[32:35], a[156:159], a[140:143]
  s_waitcnt vmcnt(19)
  buffer_load_dwordx4 a[156:159], v2, s[40:43], s67 offen offset:0 sc1
  v_mfma_f32_16x16x32_bf16 a[64:67], a[36:39], a[160:163], a[64:67]
  v_add_u32 v25, 1, v17
  v_mfma_f32_16x16x32_bf16 a[80:83], a[40:43], a[160:163], a[80:83]
  v_mfma_f32_16x16x32_bf16 a[96:99], a[44:47], a[160:163], a[96:99]
  buffer_load_dwordx4 a[220:223], v2, s[40:43], s14 offen offset:3072 sc1
  v_mul_u32_u24 v249, 1280, v17
  v_mfma_f32_16x16x32_bf16 a[112:115], a[48:51], a[160:163], a[112:115]
  v_mfma_f32_16x16x32_bf16 a[128:131], a[52:55], a[160:163], a[128:131]
  buffer_load_dwordx4 a[160:163], v2, s[40:43], s64 offen offset:1024 sc1
  v_mfma_f32_16x16x32_bf16 a[68:71], a[36:39], a[164:167], a[68:71]
  v_lshl_add_u32 v249, v18, 4, v249
  v_mfma_f32_16x16x32_bf16 a[84:87], a[40:43], a[164:167], a[84:87]
  v_add_u32 v249, s26, v249
  v_mfma_f32_16x16x32_bf16 a[100:103], a[44:47], a[164:167], a[100:103]
  v_mfma_f32_16x16x32_bf16 a[116:119], a[48:51], a[164:167], a[116:119]
  v_mfma_f32_16x16x32_bf16 a[132:135], a[52:55], a[164:167], a[132:135]
  s_waitcnt vmcnt(19)
  buffer_load_dwordx4 a[164:167], v2, s[40:43], s65 offen offset:1024 sc1
  v_lshrrev_b32 v19, 4, v17
  v_mfma_f32_16x16x32_bf16 a[72:75], a[36:39], a[168:171], a[72:75]
  v_mfma_f32_16x16x32_bf16 a[88:91], a[40:43], a[168:171], a[88:91]
  v_mfma_f32_16x16x32_bf16 a[104:107], a[44:47], a[168:171], a[104:107]
  s_add_u32 s14, s13, 90112
  buffer_load_dwordx4 a[224:227], v2, s[40:43], s14 offen offset:0 sc1
  v_mfma_f32_16x16x32_bf16 a[120:123], a[48:51], a[168:171], a[120:123]
  v_mul_u32_u24 v19, 20480, v19
  v_mfma_f32_16x16x32_bf16 a[136:139], a[52:55], a[168:171], a[136:139]
  buffer_load_dwordx4 a[168:171], v2, s[40:43], s66 offen offset:1024 sc1
  v_and_b32 v17, 15, v17
  v_mfma_f32_16x16x32_bf16 a[76:79], a[36:39], a[172:175], a[76:79]
  v_mfma_f32_16x16x32_bf16 a[92:95], a[40:43], a[172:175], a[92:95]
  v_mfma_f32_16x16x32_bf16 a[108:111], a[44:47], a[172:175], a[108:111]
  v_mfma_f32_16x16x32_bf16 a[124:127], a[48:51], a[172:175], a[124:127]
  v_mfma_f32_16x16x32_bf16 a[140:143], a[52:55], a[172:175], a[140:143]
  s_waitcnt vmcnt(19)
  buffer_load_dwordx4 a[172:175], v2, s[40:43], s67 offen offset:1024 sc1
  v_mfma_f32_16x16x32_bf16 a[64:67], a[56:59], a[176:179], a[64:67]
  v_lshl_add_u32 v19, v17, 4, v19
  v_mfma_f32_16x16x32_bf16 a[80:83], a[60:63], a[176:179], a[80:83]
  v_mfma_f32_16x16x32_bf16 a[96:99], v[32:35], a[176:179], a[96:99]
  buffer_load_dwordx4 a[228:231], v2, s[40:43], s14 offen offset:1024 sc1
  v_lshl_add_u32 v201, v18, 8, v19
  v_mfma_f32_16x16x32_bf16 a[112:115], v[36:39], a[176:179], a[112:115]
  v_mfma_f32_16x16x32_bf16 a[128:131], v[40:43], a[176:179], a[128:131]
  buffer_load_dwordx4 a[176:179], v2, s[40:43], s64 offen offset:2048 sc1
  v_mfma_f32_16x16x32_bf16 a[68:71], a[56:59], a[180:183], a[68:71]
  v_mov_b32 v28, 8
  v_mfma_f32_16x16x32_bf16 a[84:87], a[60:63], a[180:183], a[84:87]
  v_add_u32 v16, 512, v0
  v_mfma_f32_16x16x32_bf16 a[100:103], v[32:35], a[180:183], a[100:103]
  v_mfma_f32_16x16x32_bf16 a[116:119], v[36:39], a[180:183], a[116:119]
  v_mfma_f32_16x16x32_bf16 a[132:135], v[40:43], a[180:183], a[132:135]
  s_waitcnt vmcnt(19)
  buffer_load_dwordx4 a[180:183], v2, s[40:43], s65 offen offset:2048 sc1
  v_mul_u32_u24 v17, 6554, v16
  v_mfma_f32_16x16x32_bf16 a[72:75], a[56:59], a[184:187], a[72:75]
  v_mfma_f32_16x16x32_bf16 a[88:91], a[60:63], a[184:187], a[88:91]
  v_mfma_f32_16x16x32_bf16 a[104:107], v[32:35], a[184:187], a[104:107]
  buffer_load_dwordx4 a[232:235], v2, s[40:43], s14 offen offset:2048 sc1
  v_mfma_f32_16x16x32_bf16 a[120:123], v[36:39], a[184:187], a[120:123]
  v_lshrrev_b32 v17, 16, v17
  v_mfma_f32_16x16x32_bf16 a[136:139], v[40:43], a[184:187], a[136:139]
  buffer_load_dwordx4 a[184:187], v2, s[40:43], s66 offen offset:2048 sc1
  v_mul_u32_u24 v18, 10, v17
  v_mfma_f32_16x16x32_bf16 a[76:79], a[56:59], a[188:191], a[76:79]
  v_mfma_f32_16x16x32_bf16 a[92:95], a[60:63], a[188:191], a[92:95]
  v_mfma_f32_16x16x32_bf16 a[108:111], v[32:35], a[188:191], a[108:111]
  v_mfma_f32_16x16x32_bf16 a[124:127], v[36:39], a[188:191], a[124:127]
  v_mfma_f32_16x16x32_bf16 a[140:143], v[40:43], a[188:191], a[140:143]
  s_waitcnt vmcnt(19)
  buffer_load_dwordx4 a[188:191], v2, s[40:43], s67 offen offset:2048 sc1
  v_mfma_f32_16x16x32_bf16 a[64:67], v[44:47], v[216:219], a[64:67]
  v_sub_u32 v18, v16, v18
  v_mfma_f32_16x16x32_bf16 a[80:83], v[48:51], v[216:219], a[80:83]
  v_mfma_f32_16x16x32_bf16 a[96:99], v[52:55], v[216:219], a[96:99]
  buffer_load_dwordx4 a[236:239], v2, s[40:43], s14 offen offset:3072 sc1
  v_mul_u32_u24 v253, 336, v17
  v_mfma_f32_16x16x32_bf16 a[112:115], v[56:59], v[216:219], a[112:115]
  v_mfma_f32_16x16x32_bf16 a[128:131], v[60:63], v[216:219], a[128:131]
  buffer_load_dwordx4 v[216:219], v2, s[40:43], s64 offen offset:3072 sc1
  v_mfma_f32_16x16x32_bf16 a[68:71], v[44:47], v[220:223], a[68:71]
  v_lshl_add_u32 v253, v18, 5, v253
  v_mfma_f32_16x16x32_bf16 a[84:87], v[48:51], v[220:223], a[84:87]
  v_lshlrev_b32 v205, 5, v18
  v_mfma_f32_16x16x32_bf16 a[100:103], v[52:55], v[220:223], a[100:103]
  v_mfma_f32_16x16x32_bf16 a[116:119], v[56:59], v[220:223], a[116:119]
  v_mfma_f32_16x16x32_bf16 a[132:135], v[60:63], v[220:223], a[132:135]
  s_waitcnt vmcnt(19)
  buffer_load_dwordx4 v[220:223], v2, s[40:43], s65 offen offset:3072 sc1
  v_add_u32 v17, s25, v17
  v_mfma_f32_16x16x32_bf16 a[72:75], v[44:47], v[224:227], a[72:75]
  v_mfma_f32_16x16x32_bf16 a[88:91], v[48:51], v[224:227], a[88:91]
  v_mfma_f32_16x16x32_bf16 a[104:107], v[52:55], v[224:227], a[104:107]
  v_mfma_f32_16x16x32_bf16 a[120:123], v[56:59], v[224:227], a[120:123]
  v_add_u32 v26, 1, v17
  v_mfma_f32_16x16x32_bf16 a[136:139], v[60:63], v[224:227], a[136:139]
  buffer_load_dwordx4 v[224:227], v2, s[40:43], s66 offen offset:3072 sc1
  v_mul_u32_u24 v250, 1280, v17
  v_mfma_f32_16x16x32_bf16 a[76:79], v[44:47], v[228:231], a[76:79]
  v_mfma_f32_16x16x32_bf16 a[92:95], v[48:51], v[228:231], a[92:95]
  v_mfma_f32_16x16x32_bf16 a[108:111], v[52:55], v[228:231], a[108:111]
  v_mfma_f32_16x16x32_bf16 a[124:127], v[56:59], v[228:231], a[124:127]
  v_mfma_f32_16x16x32_bf16 a[140:143], v[60:63], v[228:231], a[140:143]
  s_waitcnt vmcnt(18)
  buffer_load_dwordx4 v[228:231], v2, s[40:43], s67 offen offset:3072 sc1
  v_mfma_f32_16x16x32_bf16 a[64:67], v[96:99], a[144:147], a[64:67]
  s_add_u32 s62, s62, 4096
  v_lshl_add_u32 v250, v18, 4, v250
  v_mfma_f32_16x16x32_bf16 a[80:83], v[100:103], a[144:147], a[80:83]
  s_and_b32 s62, s62, 0x7fff
  v_mfma_f32_16x16x32_bf16 a[96:99], v[104:107], a[144:147], a[96:99]
  s_add_u32 s14, s13, 94208
  buffer_load_dwordx4 a[240:243], v2, s[40:43], s14 offen offset:0 sc1
  v_add_u32 v250, s26, v250
  v_mfma_f32_16x16x32_bf16 a[112:115], v[108:111], a[144:147], a[112:115]
  s_add_u32 s64, s63, s62
  v_mfma_f32_16x16x32_bf16 a[128:131], v[112:115], a[144:147], a[128:131]
  buffer_load_dwordx4 a[144:147], v2, s[40:43], s64 offen offset:0 sc1
  v_mfma_f32_16x16x32_bf16 a[68:71], v[96:99], a[148:151], a[68:71]
  s_add_u32 s65, s64, 131072
  v_lshrrev_b32 v19, 4, v17
  v_mfma_f32_16x16x32_bf16 a[84:87], v[100:103], a[148:151], a[84:87]
  s_add_u32 s66, s64, 262144
  v_mul_u32_u24 v19, 20480, v19
  v_mfma_f32_16x16x32_bf16 a[100:103], v[104:107], a[148:151], a[100:103]
  v_mfma_f32_16x16x32_bf16 a[116:119], v[108:111], a[148:151], a[116:119]
  v_mfma_f32_16x16x32_bf16 a[132:135], v[112:115], a[148:151], a[132:135]
  s_waitcnt vmcnt(19)
  buffer_load_dwordx4 a[148:151], v2, s[40:43], s65 offen offset:0 sc1
  v_and_b32 v17, 15, v17
  v_mfma_f32_16x16x32_bf16 a[72:75], v[96:99], a[152:155], a[72:75]
  s_add_u32 s67, s64, 393216
  v_mfma_f32_16x16x32_bf16 a[88:91], v[100:103], a[152:155], a[88:91]
  v_mfma_f32_16x16x32_bf16 a[104:107], v[104:107], a[152:155], a[104:107]
  buffer_load_dwordx4 a[244:247], v2, s[40:43], s14 offen offset:1024 sc1
  v_mfma_f32_16x16x32_bf16 a[120:123], v[108:111], a[152:155], a[120:123]
  v_lshl_add_u32 v19, v17, 4, v19
  v_mfma_f32_16x16x32_bf16 a[136:139], v[112:115], a[152:155], a[136:139]
  buffer_load_dwordx4 a[152:155], v2, s[40:43], s66 offen offset:0 sc1
  v_lshl_add_u32 v202, v18, 8, v19
  v_mfma_f32_16x16x32_bf16 a[76:79], v[96:99], a[156:159], a[76:79]
  v_mfma_f32_16x16x32_bf16 a[92:95], v[100:103], a[156:159], a[92:95]
  v_mfma_f32_16x16x32_bf16 a[108:111], v[104:107], a[156:159], a[108:111]
  v_mfma_f32_16x16x32_bf16 a[124:127], v[108:111], a[156:159], a[124:127]
  v_mfma_f32_16x16x32_bf16 a[140:143], v[112:115], a[156:159], a[140:143]
  s_waitcnt vmcnt(19)
  buffer_load_dwordx4 a[156:159], v2, s[40:43], s67 offen offset:0 sc1
  v_mfma_f32_16x16x32_bf16 a[64:67], v[116:119], a[160:163], a[64:67]
  v_mov_b32 v29, 8
  v_mfma_f32_16x16x32_bf16 a[80:83], v[120:123], a[160:163], a[80:83]
  v_mfma_f32_16x16x32_bf16 a[96:99], v[124:127], a[160:163], a[96:99]
  buffer_load_dwordx4 a[248:251], v2, s[40:43], s14 offen offset:2048 sc1
  v_cmp_gt_u32 vcc, 128, v0
  v_mfma_f32_16x16x32_bf16 a[112:115], v[160:163], a[160:163], a[112:115]
  v_mfma_f32_16x16x32_bf16 a[128:131], v[164:167], a[160:163], a[128:131]
  buffer_load_dwordx4 a[160:163], v2, s[40:43], s64 offen offset:1024 sc1
  v_mfma_f32_16x16x32_bf16 a[68:71], v[116:119], a[164:167], a[68:71]
  v_mov_b32 v16, 1073741824
  v_mfma_f32_16x16x32_bf16 a[84:87], v[120:123], a[164:167], a[84:87]
  v_mov_b32 v17, 0
  v_mfma_f32_16x16x32_bf16 a[100:103], v[124:127], a[164:167], a[100:103]
  v_mfma_f32_16x16x32_bf16 a[116:119], v[160:163], a[164:167], a[116:119]
  v_mfma_f32_16x16x32_bf16 a[132:135], v[164:167], a[164:167], a[132:135]
  s_waitcnt vmcnt(19)
  buffer_load_dwordx4 a[164:167], v2, s[40:43], s65 offen offset:1024 sc1
  v_cndmask_b32 v250, v16, v250, vcc
  v_mfma_f32_16x16x32_bf16 a[72:75], v[116:119], a[168:171], a[72:75]
  v_mfma_f32_16x16x32_bf16 a[88:91], v[120:123], a[168:171], a[88:91]
  v_mfma_f32_16x16x32_bf16 a[104:107], v[124:127], a[168:171], a[104:107]
  buffer_load_dwordx4 a[252:255], v2, s[40:43], s14 offen offset:3072 sc1
  v_mfma_f32_16x16x32_bf16 a[120:123], v[160:163], a[168:171], a[120:123]
  v_cndmask_b32 v202, v16, v202, vcc
  v_mfma_f32_16x16x32_bf16 a[136:139], v[164:167], a[168:171], a[136:139]
  buffer_load_dwordx4 a[168:171], v2, s[40:43], s66 offen offset:1024 sc1
  v_cndmask_b32 v253, v17, v253, vcc
  v_mfma_f32_16x16x32_bf16 a[76:79], v[116:119], a[172:175], a[76:79]
  v_mfma_f32_16x16x32_bf16 a[92:95], v[120:123], a[172:175], a[92:95]
  v_mfma_f32_16x16x32_bf16 a[108:111], v[124:127], a[172:175], a[108:111]
  v_mfma_f32_16x16x32_bf16 a[124:127], v[160:163], a[172:175], a[124:127]
  v_mfma_f32_16x16x32_bf16 a[140:143], v[164:167], a[172:175], a[140:143]
  s_waitcnt vmcnt(19)
  buffer_load_dwordx4 a[172:175], v2, s[40:43], s67 offen offset:1024 sc1
  v_mfma_f32_16x16x32_bf16 a[64:67], v[168:171], a[176:179], a[64:67]
  v_readlane_b32 s68, v15, 0
  v_mfma_f32_16x16x32_bf16 a[80:83], v[172:175], a[176:179], a[80:83]
  v_mfma_f32_16x16x32_bf16 a[96:99], v[192:195], a[176:179], a[96:99]
  s_add_u32 s14, s13, 106496
  buffer_load_dwordx4 a[32:35], v2, s[40:43], s14 offen offset:0 sc1
  v_readlane_b32 s69, v15, 1
  v_mfma_f32_16x16x32_bf16 a[112:115], v[196:199], a[176:179], a[112:115]
  v_mfma_f32_16x16x32_bf16 a[128:131], v[208:211], a[176:179], a[128:131]
  buffer_load_dwordx4 a[176:179], v2, s[40:43], s64 offen offset:2048 sc1
  v_mfma_f32_16x16x32_bf16 a[68:71], v[168:171], a[180:183], a[68:71]
  v_readlane_b32 s70, v15, 2
  v_mfma_f32_16x16x32_bf16 a[84:87], v[172:175], a[180:183], a[84:87]
  v_readlane_b32 s71, v15, 3
  v_mfma_f32_16x16x32_bf16 a[100:103], v[192:195], a[180:183], a[100:103]
  v_mfma_f32_16x16x32_bf16 a[116:119], v[196:199], a[180:183], a[116:119]
  v_mfma_f32_16x16x32_bf16 a[132:135], v[208:211], a[180:183], a[132:135]
  s_waitcnt vmcnt(19)
  buffer_load_dwordx4 a[180:183], v2, s[40:43], s65 offen offset:2048 sc1
  v_readlane_b32 s72, v15, 4
  v_mfma_f32_16x16x32_bf16 a[72:75], v[168:171], a[184:187], a[72:75]
  v_mfma_f32_16x16x32_bf16 a[88:91], v[172:175], a[184:187], a[88:91]
  v_mfma_f32_16x16x32_bf16 a[104:107], v[192:195], a[184:187], a[104:107]
  v_mfma_f32_16x16x32_bf16 a[120:123], v[196:199], a[184:187], a[120:123]
  v_readlane_b32 s73, v15, 5
  v_mfma_f32_16x16x32_bf16 a[136:139], v[208:211], a[184:187], a[136:139]
  buffer_load_dwordx4 a[184:187], v2, s[40:43], s66 offen offset:2048 sc1
  v_readlane_b32 s74, v15, 6
  v_mfma_f32_16x16x32_bf16 a[76:79], v[168:171], a[188:191], a[76:79]
  v_mfma_f32_16x16x32_bf16 a[92:95], v[172:175], a[188:191], a[92:95]
  v_mfma_f32_16x16x32_bf16 a[108:111], v[192:195], a[188:191], a[108:111]
  v_mfma_f32_16x16x32_bf16 a[124:127], v[196:199], a[188:191], a[124:127]
  v_mfma_f32_16x16x32_bf16 a[140:143], v[208:211], a[188:191], a[140:143]
  s_waitcnt vmcnt(18)
  buffer_load_dwordx4 a[188:191], v2, s[40:43], s67 offen offset:2048 sc1
  v_mfma_f32_16x16x32_bf16 a[64:67], v[212:215], v[216:219], a[64:67]
  v_readlane_b32 s75, v15, 7
  v_mfma_f32_16x16x32_bf16 a[80:83], v[232:235], v[216:219], a[80:83]
  v_mfma_f32_16x16x32_bf16 a[96:99], v[236:239], v[216:219], a[96:99]
  buffer_load_dwordx4 a[36:39], v2, s[40:43], s14 offen offset:1024 sc1
  v_cmp_eq_u32 s[52:53], s68, v24
  v_mfma_f32_16x16x32_bf16 a[112:115], v[240:243], v[216:219], a[112:115]
  v_mfma_f32_16x16x32_bf16 a[128:131], v[244:247], v[216:219], a[128:131]
  buffer_load_dwordx4 v[216:219], v2, s[40:43], s64 offen offset:3072 sc1
  v_mfma_f32_16x16x32_bf16 a[68:71], v[212:215], v[220:223], a[68:71]
  v_cmp_eq_u32 s[54:55], s68, v25
  v_mfma_f32_16x16x32_bf16 a[84:87], v[232:235], v[220:223], a[84:87]
  v_cmp_eq_u32 s[56:57], s68, v26
  v_mfma_f32_16x16x32_bf16 a[100:103], v[236:239], v[220:223], a[100:103]
  v_mfma_f32_16x16x32_bf16 a[116:119], v[240:243], v[220:223], a[116:119]
  v_mfma_f32_16x16x32_bf16 a[132:135], v[244:247], v[220:223], a[132:135]
  s_waitcnt vmcnt(19)
  buffer_load_dwordx4 v[220:223], v2, s[40:43], s65 offen offset:3072 sc1
  v_cndmask_b32 v27, v27, 0, s[52:53]
  v_mfma_f32_16x16x32_bf16 a[72:75], v[212:215], v[224:227], a[72:75]
  v_mfma_f32_16x16x32_bf16 a[88:91], v[232:235], v[224:227], a[88:91]
  v_mfma_f32_16x16x32_bf16 a[104:107], v[236:239], v[224:227], a[104:107]
  buffer_load_dwordx4 a[40:43], v2, s[40:43], s14 offen offset:2048 sc1
  v_mfma_f32_16x16x32_bf16 a[120:123], v[240:243], v[224:227], a[120:123]
  v_cndmask_b32 v28, v28, 0, s[54:55]
  v_mfma_f32_16x16x32_bf16 a[136:139], v[244:247], v[224:227], a[136:139]
  buffer_load_dwordx4 v[224:227], v2, s[40:43], s66 offen offset:3072 sc1
  v_cndmask_b32 v29, v29, 0, s[56:57]
  v_mfma_f32_16x16x32_bf16 a[76:79], v[212:215], v[228:231], a[76:79]
  v_mfma_f32_16x16x32_bf16 a[92:95], v[232:235], v[228:231], a[92:95]
  v_mfma_f32_16x16x32_bf16 a[108:111], v[236:239], v[228:231], a[108:111]
  v_mfma_f32_16x16x32_bf16 a[124:127], v[240:243], v[228:231], a[124:127]
  v_mfma_f32_16x16x32_bf16 a[140:143], v[244:247], v[228:231], a[140:143]
  s_waitcnt vmcnt(19)
  buffer_load_dwordx4 v[228:231], v2, s[40:43], s67 offen offset:3072 sc1
  v_mfma_f32_16x16x32_bf16 a[64:67], v[64:67], a[144:147], a[64:67]
  s_add_u32 s62, s62, 4096
  v_cmp_eq_u32 s[52:53], s69, v24
  v_mfma_f32_16x16x32_bf16 a[80:83], v[68:71], a[144:147], a[80:83]
  s_and_b32 s62, s62, 0x7fff
  v_mfma_f32_16x16x32_bf16 a[96:99], v[72:75], a[144:147], a[96:99]
  buffer_load_dwordx4 a[44:47], v2, s[40:43], s14 offen offset:3072 sc1
  v_cmp_eq_u32 s[54:55], s69, v25
  v_mfma_f32_16x16x32_bf16 a[112:115], v[76:79], a[144:147], a[112:115]
  s_add_u32 s64, s63, s62
  v_mfma_f32_16x16x32_bf16 a[128:131], v[80:83], a[144:147], a[128:131]
  buffer_load_dwordx4 a[144:147], v2, s[40:43], s64 offen offset:0 sc1
  v_mfma_f32_16x16x32_bf16 a[68:71], v[64:67], a[148:151], a[68:71]
  s_add_u32 s65, s64, 131072
  v_cmp_eq_u32 s[56:57], s69, v26
  v_mfma_f32_16x16x32_bf16 a[84:87], v[68:71], a[148:151], a[84:87]
  s_add_u32 s66, s64, 262144
  v_cndmask_b32 v27, v27, 1, s[52:53]
  v_mfma_f32_16x16x32_bf16 a[100:103], v[72:75], a[148:151], a[100:103]
  v_mfma_f32_16x16x32_bf16 a[116:119], v[76:79], a[148:151], a[116:119]
  v_mfma_f32_16x16x32_bf16 a[132:135], v[80:83], a[148:151], a[132:135]
  s_waitcnt vmcnt(19)
  buffer_load_dwordx4 a[148:151], v2, s[40:43], s65 offen offset:0 sc1
  v_cndmask_b32 v28, v28, 1, s[54:55]
  v_mfma_f32_16x16x32_bf16 a[72:75], v[64:67], a[152:155], a[72:75]
  s_add_u32 s67, s64, 393216
  v_add_u32 v11, s33, v2
  v_mfma_f32_16x16x32_bf16 a[88:91], v[68:71], a[152:155], a[88:91]
  ds_read_b128 a[0:3], v11 offset:0
  v_mfma_f32_16x16x32_bf16 a[104:107], v[72:75], a[152:155], a[104:107]
  s_add_u32 s14, s13, 110592
  buffer_load_dwordx4 a[48:51], v2, s[40:43], s14 offen offset:0 sc1
  v_mfma_f32_16x16x32_bf16 a[120:123], v[76:79], a[152:155], a[120:123]
  s_add_u32 s33, s33, 32768
  ds_read_b128 a[4:7], v11 offset:1024
  v_cndmask_b32 v29, v29, 1, s[56:57]
  v_mfma_f32_16x16x32_bf16 a[136:139], v[80:83], a[152:155], a[136:139]
  buffer_load_dwordx4 a[152:155], v2, s[40:43], s66 offen offset:0 sc1
  v_cmp_eq_u32 s[52:53], s70, v24
  v_mfma_f32_16x16x32_bf16 a[76:79], v[64:67], a[156:159], a[76:79]
  s_and_b32 s33, s33, 0x1ffff
  v_mfma_f32_16x16x32_bf16 a[92:95], v[68:71], a[156:159], a[92:95]
  ds_read_b128 a[8:11], v11 offset:2048
  v_mfma_f32_16x16x32_bf16 a[108:111], v[72:75], a[156:159], a[108:111]
  ds_read_b128 a[12:15], v11 offset:3072
  v_mfma_f32_16x16x32_bf16 a[124:127], v[76:79], a[156:159], a[124:127]
  v_mfma_f32_16x16x32_bf16 a[140:143], v[80:83], a[156:159], a[140:143]
  s_waitcnt vmcnt(19)
  buffer_load_dwordx4 a[156:159], v2, s[40:43], s67 offen offset:0 sc1
  v_mfma_f32_16x16x32_bf16 a[64:67], v[84:87], a[160:163], a[64:67]
  v_cmp_eq_u32 s[54:55], s70, v25
  v_mfma_f32_16x16x32_bf16 a[80:83], v[88:91], a[160:163], a[80:83]
  v_mfma_f32_16x16x32_bf16 a[96:99], v[92:95], a[160:163], a[96:99]
  buffer_load_dwordx4 a[52:55], v2, s[40:43], s14 offen offset:1024 sc1
  v_cmp_eq_u32 s[56:57], s70, v26
  v_mfma_f32_16x16x32_bf16 a[112:115], v[128:131], a[160:163], a[112:115]
  v_mfma_f32_16x16x32_bf16 a[128:131], v[132:135], a[160:163], a[128:131]
  buffer_load_dwordx4 a[160:163], v2, s[40:43], s64 offen offset:1024 sc1
  v_mfma_f32_16x16x32_bf16 a[68:71], v[84:87], a[164:167], a[68:71]
  v_cndmask_b32 v27, v27, 2, s[52:53]
  v_mfma_f32_16x16x32_bf16 a[84:87], v[88:91], a[164:167], a[84:87]
  v_cndmask_b32 v28, v28, 2, s[54:55]
  v_mfma_f32_16x16x32_bf16 a[100:103], v[92:95], a[164:167], a[100:103]
  v_mfma_f32_16x16x32_bf16 a[116:119], v[128:131], a[164:167], a[116:119]
  s_waitcnt lgkmcnt(0)
  v_mfma_f32_16x16x32_bf16 a[132:135], v[132:135], a[164:167], a[132:135]
  s_waitcnt vmcnt(19)
  buffer_load_dwordx4 a[164:167], v2, s[40:43], s65 offen offset:1024 sc1
  v_cndmask_b32 v29, v29, 2, s[56:57]
  v_mfma_f32_16x16x32_bf16 a[72:75], v[84:87], a[168:171], a[72:75]
  v_add_u32 v11, s34, v2
  v_mfma_f32_16x16x32_bf16 a[88:91], v[88:91], a[168:171], a[88:91]
  ds_read_b128 a[16:19], v11 offset:0
  v_mfma_f32_16x16x32_bf16 a[104:107], v[92:95], a[168:171], a[104:107]
  v_mfma_f32_16x16x32_bf16 a[120:123], v[128:131], a[168:171], a[120:123]
  s_add_u32 s34, s34, 32768
  ds_read_b128 a[20:23], v11 offset:1024
  v_cmp_eq_u32 s[52:53], s71, v24
  v_mfma_f32_16x16x32_bf16 a[136:139], v[132:135], a[168:171], a[136:139]
  buffer_load_dwordx4 a[168:171], v2, s[40:43], s66 offen offset:1024 sc1
  v_cmp_eq_u32 s[54:55], s71, v25
  v_mfma_f32_16x16x32_bf16 a[76:79], v[84:87], a[172:175], a[76:79]
  s_and_b32 s34, s34, 0x1ffff
  v_mfma_f32_16x16x32_bf16 a[92:95], v[88:91], a[172:175], a[92:95]
  ds_read_b128 a[24:27], v11 offset:2048
  v_mfma_f32_16x16x32_bf16 a[108:111], v[92:95], a[172:175], a[108:111]
  ds_read_b128 a[28:31], v11 offset:3072
  v_mfma_f32_16x16x32_bf16 a[124:127], v[128:131], a[172:175], a[124:127]
  v_mfma_f32_16x16x32_bf16 a[140:143], v[132:135], a[172:175], a[140:143]
  s_waitcnt vmcnt(18)
  buffer_load_dwordx4 a[172:175], v2, s[40:43], s67 offen offset:1024 sc1
  v_mfma_f32_16x16x32_bf16 a[64:67], v[136:139], a[176:179], a[64:67]
  v_cmp_eq_u32 s[56:57], s71, v26
  v_mfma_f32_16x16x32_bf16 a[80:83], v[140:143], a[176:179], a[80:83]
  v_mfma_f32_16x16x32_bf16 a[96:99], v[144:147], a[176:179], a[96:99]
  buffer_load_dwordx4 a[56:59], v2, s[40:43], s14 offen offset:2048 sc1
  v_cndmask_b32 v27, v27, 3, s[52:53]
  v_mfma_f32_16x16x32_bf16 a[112:115], v[148:151], a[176:179], a[112:115]
  v_mfma_f32_16x16x32_bf16 a[128:131], v[152:155], a[176:179], a[128:131]
  buffer_load_dwordx4 a[176:179], v2, s[40:43], s64 offen offset:2048 sc1
  v_mfma_f32_16x16x32_bf16 a[68:71], v[136:139], a[180:183], a[68:71]
  v_cndmask_b32 v28, v28, 3, s[54:55]
  v_mfma_f32_16x16x32_bf16 a[84:87], v[140:143], a[180:183], a[84:87]
  v_cndmask_b32 v29, v29, 3, s[56:57]
  v_mfma_f32_16x16x32_bf16 a[100:103], v[144:147], a[180:183], a[100:103]
  v_mfma_f32_16x16x32_bf16 a[116:119], v[148:151], a[180:183], a[116:119]
  s_waitcnt lgkmcnt(0)
  v_mfma_f32_16x16x32_bf16 a[132:135], v[152:155], a[180:183], a[132:135]
  s_waitcnt vmcnt(19)
  buffer_load_dwordx4 a[180:183], v2, s[40:43], s65 offen offset:2048 sc1
  v_cmp_eq_u32 s[52:53], s72, v24
  v_mfma_f32_16x16x32_bf16 a[72:75], v[136:139], a[184:187], a[72:75]
  v_add_u32 v11, s33, v2
  v_mfma_f32_16x16x32_bf16 a[88:91], v[140:143], a[184:187], a[88:91]
  ds_read_b128 v[32:35], v11 offset:0
  v_mfma_f32_16x16x32_bf16 a[104:107], v[144:147], a[184:187], a[104:107]
  buffer_load_dwordx4 a[60:63], v2, s[40:43], s14 offen offset:3072 sc1
  v_mfma_f32_16x16x32_bf16 a[120:123], v[148:151], a[184:187], a[120:123]
  s_add_u32 s33, s33, 32768
  ds_read_b128 v[36:39], v11 offset:1024
  v_cmp_eq_u32 s[54:55], s72, v25
  v_mfma_f32_16x16x32_bf16 a[136:139], v[152:155], a[184:187], a[136:139]
  buffer_load_dwordx4 a[184:187], v2, s[40:43], s66 offen offset:2048 sc1
  v_cmp_eq_u32 s[56:57], s72, v26
  v_mfma_f32_16x16x32_bf16 a[76:79], v[136:139], a[188:191], a[76:79]
  s_and_b32 s33, s33, 0x1ffff
  v_mfma_f32_16x16x32_bf16 a[92:95], v[140:143], a[188:191], a[92:95]
  ds_read_b128 v[40:43], v11 offset:2048
  v_mfma_f32_16x16x32_bf16 a[108:111], v[144:147], a[188:191], a[108:111]
  ds_read_b128 v[44:47], v11 offset:3072
  v_mfma_f32_16x16x32_bf16 a[124:127], v[148:151], a[188:191], a[124:127]
  v_mfma_f32_16x16x32_bf16 a[140:143], v[152:155], a[188:191], a[140:143]
  s_waitcnt vmcnt(19)
  buffer_load_dwordx4 a[188:191], v2, s[40:43], s67 offen offset:2048 sc1
  v_mfma_f32_16x16x32_bf16 a[64:67], v[156:159], v[216:219], a[64:67]
  v_cndmask_b32 v27, v27, 4, s[52:53]
  v_mfma_f32_16x16x32_bf16 a[80:83], v[176:179], v[216:219], a[80:83]
  v_mfma_f32_16x16x32_bf16 a[96:99], v[180:183], v[216:219], a[96:99]
  s_add_u32 s14, s13, 122880
  buffer_load_dwordx4 v[96:99], v2, s[40:43], s14 offen offset:0 sc1
  v_cndmask_b32 v28, v28, 4, s[54:55]
  v_mfma_f32_16x16x32_bf16 a[112:115], v[184:187], v[216:219], a[112:115]
  v_mfma_f32_16x16x32_bf16 a[128:131], v[188:191], v[216:219], a[128:131]
  buffer_load_dwordx4 v[216:219], v2, s[40:43], s64 offen offset:3072 sc1
  v_mfma_f32_16x16x32_bf16 a[68:71], v[156:159], v[220:223], a[68:71]
  v_cndmask_b32 v29, v29, 4, s[56:57]
  v_mfma_f32_16x16x32_bf16 a[84:87], v[176:179], v[220:223], a[84:87]
  v_cmp_eq_u32 s[52:53], s73, v24
  v_mfma_f32_16x16x32_bf16 a[100:103], v[180:183], v[220:223], a[100:103]
  v_mfma_f32_16x16x32_bf16 a[116:119], v[184:187], v[220:223], a[116:119]
  s_waitcnt lgkmcnt(0)
  v_mfma_f32_16x16x32_bf16 a[132:135], v[188:191], v[220:223], a[132:135]
  s_waitcnt vmcnt(19)
  buffer_load_dwordx4 v[220:223], v2, s[40:43], s65 offen offset:3072 sc1
  v_cmp_eq_u32 s[54:55], s73, v25
  v_mfma_f32_16x16x32_bf16 a[72:75], v[156:159], v[224:227], a[72:75]
  v_add_u32 v11, s34, v2
  v_mfma_f32_16x16x32_bf16 a[88:91], v[176:179], v[224:227], a[88:91]
  ds_read_b128 v[48:51], v11 offset:0
  v_mfma_f32_16x16x32_bf16 a[104:107], v[180:183], v[224:227], a[104:107]
  buffer_load_dwordx4 v[100:103], v2, s[40:43], s14 offen offset:1024 sc1
  v_mfma_f32_16x16x32_bf16 a[120:123], v[184:187], v[224:227], a[120:123]
  s_add_u32 s34, s34, 32768
  ds_read_b128 v[52:55], v11 offset:1024
  v_cmp_eq_u32 s[56:57], s73, v26
  v_mfma_f32_16x16x32_bf16 a[136:139], v[188:191], v[224:227], a[136:139]
  buffer_load_dwordx4 v[224:227], v2, s[40:43], s66 offen offset:3072 sc1
  v_cndmask_b32 v27, v27, 5, s[52:53]
  v_mfma_f32_16x16x32_bf16 a[76:79], v[156:159], v[228:231], a[76:79]
  s_and_b32 s34, s34, 0x1ffff
  v_mfma_f32_16x16x32_bf16 a[92:95], v[176:179], v[228:231], a[92:95]
  ds_read_b128 v[56:59], v11 offset:2048
  v_mfma_f32_16x16x32_bf16 a[108:111], v[180:183], v[228:231], a[108:111]
  ds_read_b128 v[60:63], v11 offset:3072
  v_mfma_f32_16x16x32_bf16 a[124:127], v[184:187], v[228:231], a[124:127]
  v_mfma_f32_16x16x32_bf16 a[140:143], v[188:191], v[228:231], a[140:143]
  s_waitcnt vmcnt(19)
  buffer_load_dwordx4 v[228:231], v2, s[40:43], s67 offen offset:3072 sc1
  v_mfma_f32_16x16x32_bf16 a[64:67], a[192:195], a[144:147], a[64:67]
  s_add_u32 s62, s62, 4096
  v_cndmask_b32 v28, v28, 5, s[54:55]
  v_mfma_f32_16x16x32_bf16 a[80:83], a[196:199], a[144:147], a[80:83]
  s_and_b32 s62, s62, 0x7fff
  v_mfma_f32_16x16x32_bf16 a[96:99], a[200:203], a[144:147], a[96:99]
  buffer_load_dwordx4 v[104:107], v2, s[40:43], s14 offen offset:2048 sc1
  v_cndmask_b32 v29, v29, 5, s[56:57]
  v_mfma_f32_16x16x32_bf16 a[112:115], a[204:207], a[144:147], a[112:115]
  s_add_u32 s64, s63, s62
  v_mfma_f32_16x16x32_bf16 a[128:131], a[208:211], a[144:147], a[128:131]
  buffer_load_dwordx4 a[144:147], v2, s[40:43], s64 offen offset:0 sc1
  v_mfma_f32_16x16x32_bf16 a[68:71], a[192:195], a[148:151], a[68:71]
  s_add_u32 s65, s64, 131072
  v_cmp_eq_u32 s[52:53], s74, v24
  v_mfma_f32_16x16x32_bf16 a[84:87], a[196:199], a[148:151], a[84:87]
  s_add_u32 s66, s64, 262144
  v_cmp_eq_u32 s[54:55], s74, v25
  v_mfma_f32_16x16x32_bf16 a[100:103], a[200:203], a[148:151], a[100:103]
  v_mfma_f32_16x16x32_bf16 a[116:119], a[204:207], a[148:151], a[116:119]
  s_waitcnt lgkmcnt(0)
  v_mfma_f32_16x16x32_bf16 a[132:135], a[208:211], a[148:151], a[132:135]
  s_waitcnt vmcnt(19)
  buffer_load_dwordx4 a[148:151], v2, s[40:43], s65 offen offset:0 sc1
  v_cmp_eq_u32 s[56:57], s74, v26
  v_mfma_f32_16x16x32_bf16 a[72:75], a[192:195], a[152:155], a[72:75]
  s_add_u32 s67, s64, 393216
  v_add_u32 v11, s33, v2
  v_mfma_f32_16x16x32_bf16 a[88:91], a[196:199], a[152:155], a[88:91]
  ds_read_b128 v[160:163], v11 offset:0
  v_mfma_f32_16x16x32_bf16 a[104:107], a[200:203], a[152:155], a[104:107]
  buffer_load_dwordx4 v[108:111], v2, s[40:43], s14 offen offset:3072 sc1
  v_mfma_f32_16x16x32_bf16 a[120:123], a[204:207], a[152:155], a[120:123]
  s_add_u32 s33, s33, 32768
  ds_read_b128 v[164:167], v11 offset:1024
  v_cndmask_b32 v27, v27, 6, s[52:53]
  v_mfma_f32_16x16x32_bf16 a[136:139], a[208:211], a[152:155], a[136:139]
  buffer_load_dwordx4 a[152:155], v2, s[40:43], s66 offen offset:0 sc1
  v_cndmask_b32 v28, v28, 6, s[54:55]
  v_mfma_f32_16x16x32_bf16 a[76:79], a[192:195], a[156:159], a[76:79]
  s_and_b32 s33, s33, 0x1ffff
  v_mfma_f32_16x16x32_bf16 a[92:95], a[196:199], a[156:159], a[92:95]
  ds_read_b128 v[168:171], v11 offset:2048
  v_mfma_f32_16x16x32_bf16 a[108:111], a[200:203], a[156:159], a[108:111]
  ds_read_b128 v[172:175], v11 offset:3072
  v_mfma_f32_16x16x32_bf16 a[124:127], a[204:207], a[156:159], a[124:127]
  v_mfma_f32_16x16x32_bf16 a[140:143], a[208:211], a[156:159], a[140:143]
  s_waitcnt vmcnt(19)
  buffer_load_dwordx4 a[156:159], v2, s[40:43], s67 offen offset:0 sc1
  v_mfma_f32_16x16x32_bf16 a[64:67], a[212:215], a[160:163], a[64:67]
  v_cndmask_b32 v29, v29, 6, s[56:57]
  v_mfma_f32_16x16x32_bf16 a[80:83], a[216:219], a[160:163], a[80:83]
  v_mfma_f32_16x16x32_bf16 a[96:99], a[220:223], a[160:163], a[96:99]
  s_add_u32 s14, s13, 126976
  buffer_load_dwordx4 v[112:115], v2, s[40:43], s14 offen offset:0 sc1
  v_cmp_eq_u32 s[52:53], s75, v24
  v_mfma_f32_16x16x32_bf16 a[112:115], a[224:227], a[160:163], a[112:115]
  v_mfma_f32_16x16x32_bf16 a[128:131], a[228:231], a[160:163], a[128:131]
  buffer_load_dwordx4 a[160:163], v2, s[40:43], s64 offen offset:1024 sc1
  v_mfma_f32_16x16x32_bf16 a[68:71], a[212:215], a[164:167], a[68:71]
  v_cmp_eq_u32 s[54:55], s75, v25
  v_mfma_f32_16x16x32_bf16 a[84:87], a[216:219], a[164:167], a[84:87]
  v_cmp_eq_u32 s[56:57], s75, v26
  v_mfma_f32_16x16x32_bf16 a[100:103], a[220:223], a[164:167], a[100:103]
  v_mfma_f32_16x16x32_bf16 a[116:119], a[224:227], a[164:167], a[116:119]
  s_waitcnt lgkmcnt(0)
  v_mfma_f32_16x16x32_bf16 a[132:135], a[228:231], a[164:167], a[132:135]
  s_waitcnt vmcnt(20)
  buffer_load_dwordx4 a[164:167], v2, s[40:43], s65 offen offset:1024 sc1
  v_cndmask_b32 v27, v27, 7, s[52:53]
  v_mfma_f32_16x16x32_bf16 a[72:75], a[212:215], a[168:171], a[72:75]
  v_add_u32 v11, s34, v2
  v_mfma_f32_16x16x32_bf16 a[88:91], a[216:219], a[168:171], a[88:91]
  ds_read_b128 v[192:195], v11 offset:0
  v_mfma_f32_16x16x32_bf16 a[104:107], a[220:223], a[168:171], a[104:107]
  v_mfma_f32_16x16x32_bf16 a[120:123], a[224:227], a[168:171], a[120:123]
  s_add_u32 s34, s34, 32768
  ds_read_b128 v[196:199], v11 offset:1024
  v_cndmask_b32 v28, v28, 7, s[54:55]
  v_mfma_f32_16x16x32_bf16 a[136:139], a[228:231], a[168:171], a[136:139]
  buffer_load_dwordx4 a[168:171], v2, s[40:43], s66 offen offset:1024 sc1
  v_cndmask_b32 v29, v29, 7, s[56:57]
  v_mfma_f32_16x16x32_bf16 a[76:79], a[212:215], a[172:175], a[76:79]
  s_and_b32 s34, s34, 0x1ffff
  v_mfma_f32_16x16x32_bf16 a[92:95], a[216:219], a[172:175], a[92:95]
  ds_read_b128 v[208:211], v11 offset:2048
  v_mfma_f32_16x16x32_bf16 a[108:111], a[220:223], a[172:175], a[108:111]
  ds_read_b128 v[212:215], v11 offset:3072
  v_mfma_f32_16x16x32_bf16 a[124:127], a[224:227], a[172:175], a[124:127]
  v_mfma_f32_16x16x32_bf16 a[140:143], a[228:231], a[172:175], a[140:143]
  s_waitcnt vmcnt(19)
  buffer_load_dwordx4 a[172:175], v2, s[40:43], s67 offen offset:1024 sc1
  v_mfma_f32_16x16x32_bf16 a[64:67], a[232:235], a[176:179], a[64:67]
  v_mul_u32_u24 v27, 320, v27
  v_mfma_f32_16x16x32_bf16 a[80:83], a[236:239], a[176:179], a[80:83]
  v_mfma_f32_16x16x32_bf16 a[96:99], a[240:243], a[176:179], a[96:99]
  buffer_load_dwordx4 v[116:119], v2, s[40:43], s14 offen offset:1024 sc1
  v_add_u32 v203, v203, v27
  v_mfma_f32_16x16x32_bf16 a[112:115], a[244:247], a[176:179], a[112:115]
  v_mfma_f32_16x16x32_bf16 a[128:131], a[248:251], a[176:179], a[128:131]
  buffer_load_dwordx4 a[176:179], v2, s[40:43], s64 offen offset:2048 sc1
  v_mfma_f32_16x16x32_bf16 a[68:71], a[232:235], a[180:183], a[68:71]
  v_add_u32 v203, 155648, v203
  v_mfma_f32_16x16x32_bf16 a[84:87], a[236:239], a[180:183], a[84:87]
  v_mul_u32_u24 v28, 320, v28
  v_mfma_f32_16x16x32_bf16 a[100:103], a[240:243], a[180:183], a[100:103]
  v_mfma_f32_16x16x32_bf16 a[116:119], a[244:247], a[180:183], a[116:119]
  s_waitcnt lgkmcnt(0)
  v_mfma_f32_16x16x32_bf16 a[132:135], a[248:251], a[180:183], a[132:135]
  s_waitcnt vmcnt(19)
  buffer_load_dwordx4 a[180:183], v2, s[40:43], s65 offen offset:2048 sc1
  v_add_u32 v204, v204, v28
  v_mfma_f32_16x16x32_bf16 a[72:75], a[232:235], a[184:187], a[72:75]
  v_add_u32 v11, s33, v2
  v_mfma_f32_16x16x32_bf16 a[88:91], a[236:239], a[184:187], a[88:91]
  ds_read_b128 v[80:83], v11 offset:0
  v_mfma_f32_16x16x32_bf16 a[104:107], a[240:243], a[184:187], a[104:107]
  buffer_load_dwordx4 v[120:123], v2, s[40:43], s14 offen offset:2048 sc1
  v_mfma_f32_16x16x32_bf16 a[120:123], a[244:247], a[184:187], a[120:123]
  s_add_u32 s33, s33, 32768
  ds_read_b128 v[84:87], v11 offset:1024
  v_add_u32 v204, 155648, v204
  v_mfma_f32_16x16x32_bf16 a[136:139], a[248:251], a[184:187], a[136:139]
  buffer_load_dwordx4 a[184:187], v2, s[40:43], s66 offen offset:2048 sc1
  v_mul_u32_u24 v29, 320, v29
  v_mfma_f32_16x16x32_bf16 a[76:79], a[232:235], a[188:191], a[76:79]
  s_and_b32 s33, s33, 0x1ffff
  v_mfma_f32_16x16x32_bf16 a[92:95], a[236:239], a[188:191], a[92:95]
  ds_read_b128 v[88:91], v11 offset:2048
  v_mfma_f32_16x16x32_bf16 a[108:111], a[240:243], a[188:191], a[108:111]
  ds_read_b128 v[92:95], v11 offset:3072
  v_mfma_f32_16x16x32_bf16 a[124:127], a[244:247], a[188:191], a[124:127]
  v_mfma_f32_16x16x32_bf16 a[140:143], a[248:251], a[188:191], a[140:143]
  s_waitcnt vmcnt(19)
  buffer_load_dwordx4 a[188:191], v2, s[40:43], s67 offen offset:2048 sc1
  v_mfma_f32_16x16x32_bf16 a[64:67], a[252:255], v[216:219], a[64:67]
  v_add_u32 v205, v205, v29
  v_mfma_f32_16x16x32_bf16 a[80:83], a[0:3], v[216:219], a[80:83]
  v_mfma_f32_16x16x32_bf16 a[96:99], a[4:7], v[216:219], a[96:99]
  buffer_load_dwordx4 v[124:127], v2, s[40:43], s14 offen offset:3072 sc1
  v_add_u32 v205, 155648, v205
  v_mfma_f32_16x16x32_bf16 a[112:115], a[8:11], v[216:219], a[112:115]
  v_mfma_f32_16x16x32_bf16 a[128:131], a[12:15], v[216:219], a[128:131]
  buffer_load_dwordx4 v[216:219], v2, s[40:43], s64 offen offset:3072 sc1
  v_mfma_f32_16x16x32_bf16 a[68:71], a[252:255], v[220:223], a[68:71]
  v_mfma_f32_16x16x32_bf16 a[84:87], a[0:3], v[220:223], a[84:87]
  v_mfma_f32_16x16x32_bf16 a[100:103], a[4:7], v[220:223], a[100:103]
  v_mfma_f32_16x16x32_bf16 a[116:119], a[8:11], v[220:223], a[116:119]
  s_waitcnt lgkmcnt(0)
  v_mfma_f32_16x16x32_bf16 a[132:135], a[12:15], v[220:223], a[132:135]
  s_waitcnt vmcnt(19)
  buffer_load_dwordx4 v[220:223], v2, s[40:43], s65 offen offset:3072 sc1
  v_mfma_f32_16x16x32_bf16 a[72:75], a[252:255], v[224:227], a[72:75]
  v_add_u32 v11, s34, v2
  v_mfma_f32_16x16x32_bf16 a[88:91], a[0:3], v[224:227], a[88:91]
  ds_read_b128 v[128:131], v11 offset:0
  v_mfma_f32_16x16x32_bf16 a[104:107], a[4:7], v[224:227], a[104:107]
  s_add_u32 s14, s13, 139264
  buffer_load_dwordx4 v[232:235], v2, s[40:43], s14 offen offset:0 sc1
  v_mfma_f32_16x16x32_bf16 a[120:123], a[8:11], v[224:227], a[120:123]
  s_add_u32 s34, s34, 32768
  ds_read_b128 v[132:135], v11 offset:1024
  v_mfma_f32_16x16x32_bf16 a[136:139], a[12:15], v[224:227], a[136:139]
  buffer_load_dwordx4 v[224:227], v2, s[40:43], s66 offen offset:3072 sc1
  v_mfma_f32_16x16x32_bf16 a[76:79], a[252:255], v[228:231], a[76:79]
  s_and_b32 s34, s34, 0x1ffff
  v_mfma_f32_16x16x32_bf16 a[92:95], a[0:3], v[228:231], a[92:95]
  ds_read_b128 v[136:139], v11 offset:2048
  v_mfma_f32_16x16x32_bf16 a[108:111], a[4:7], v[228:231], a[108:111]
  ds_read_b128 v[140:143], v11 offset:3072
  v_mfma_f32_16x16x32_bf16 a[124:127], a[8:11], v[228:231], a[124:127]
  v_mfma_f32_16x16x32_bf16 a[140:143], a[12:15], v[228:231], a[140:143]
  s_waitcnt vmcnt(19)
  buffer_load_dwordx4 v[228:231], v2, s[40:43], s67 offen offset:3072 sc1
  v_mfma_f32_16x16x32_bf16 a[64:67], a[16:19], a[144:147], a[64:67]
  s_add_u32 s62, s62, 4096
  v_mfma_f32_16x16x32_bf16 a[80:83], a[20:23], a[144:147], a[80:83]
  s_and_b32 s62, s62, 0x7fff
  v_mfma_f32_16x16x32_bf16 a[96:99], a[24:27], a[144:147], a[96:99]
  buffer_load_dwordx4 v[236:239], v2, s[40:43], s14 offen offset:1024 sc1
  v_mfma_f32_16x16x32_bf16 a[112:115], a[28:31], a[144:147], a[112:115]
  s_add_u32 s64, s63, s62
  v_mfma_f32_16x16x32_bf16 a[128:131], a[32:35], a[144:147], a[128:131]
  buffer_load_dwordx4 a[144:147], v2, s[40:43], s64 offen offset:0 sc1
  v_mfma_f32_16x16x32_bf16 a[68:71], a[16:19], a[148:151], a[68:71]
  s_add_u32 s65, s64, 131072
  v_mfma_f32_16x16x32_bf16 a[84:87], a[20:23], a[148:151], a[84:87]
  s_add_u32 s66, s64, 262144
  v_mfma_f32_16x16x32_bf16 a[100:103], a[24:27], a[148:151], a[100:103]
  v_mfma_f32_16x16x32_bf16 a[116:119], a[28:31], a[148:151], a[116:119]
  s_waitcnt lgkmcnt(0)
  v_mfma_f32_16x16x32_bf16 a[132:135], a[32:35], a[148:151], a[132:135]
  s_waitcnt vmcnt(19)
  buffer_load_dwordx4 a[148:151], v2, s[40:43], s65 offen offset:0 sc1
  v_mfma_f32_16x16x32_bf16 a[72:75], a[16:19], a[152:155], a[72:75]
  s_add_u32 s67, s64, 393216
  v_add_u32 v11, s35, v2
  v_mfma_f32_16x16x32_bf16 a[88:91], a[20:23], a[152:155], a[88:91]
  ds_read_b128 v[144:147], v11 offset:0
  v_mfma_f32_16x16x32_bf16 a[104:107], a[24:27], a[152:155], a[104:107]
  v_mfma_f32_16x16x32_bf16 a[120:123], a[28:31], a[152:155], a[120:123]
  ds_read_b128 v[148:151], v11 offset:1024
  v_mfma_f32_16x16x32_bf16 a[136:139], a[32:35], a[152:155], a[136:139]
  buffer_load_dwordx4 a[152:155], v2, s[40:43], s66 offen offset:0 sc1
  v_mfma_f32_16x16x32_bf16 a[76:79], a[16:19], a[156:159], a[76:79]
  v_mfma_f32_16x16x32_bf16 a[92:95], a[20:23], a[156:159], a[92:95]
  ds_read_b128 v[152:155], v11 offset:2048
  v_mfma_f32_16x16x32_bf16 a[108:111], a[24:27], a[156:159], a[108:111]
  ds_read_b128 v[156:159], v11 offset:3072
  v_mfma_f32_16x16x32_bf16 a[124:127], a[28:31], a[156:159], a[124:127]
  v_mfma_f32_16x16x32_bf16 a[140:143], a[32:35], a[156:159], a[140:143]
  s_waitcnt vmcnt(18)
  buffer_load_dwordx4 a[156:159], v2, s[40:43], s67 offen offset:0 sc1
  v_mfma_f32_16x16x32_bf16 a[64:67], a[36:39], a[160:163], a[64:67]
  v_mfma_f32_16x16x32_bf16 a[80:83], a[40:43], a[160:163], a[80:83]
  v_mfma_f32_16x16x32_bf16 a[96:99], a[44:47], a[160:163], a[96:99]
  buffer_load_dwordx4 v[240:243], v2, s[40:43], s14 offen offset:2048 sc1
  v_mfma_f32_16x16x32_bf16 a[112:115], a[48:51], a[160:163], a[112:115]
  v_mfma_f32_16x16x32_bf16 a[128:131], a[52:55], a[160:163], a[128:131]
  buffer_load_dwordx4 a[160:163], v2, s[40:43], s64 offen offset:1024 sc1
  v_mfma_f32_16x16x32_bf16 a[68:71], a[36:39], a[164:167], a[68:71]
  v_mfma_f32_16x16x32_bf16 a[84:87], a[40:43], a[164:167], a[84:87]
  v_mfma_f32_16x16x32_bf16 a[100:103], a[44:47], a[164:167], a[100:103]
  v_mfma_f32_16x16x32_bf16 a[116:119], a[48:51], a[164:167], a[116:119]
  s_waitcnt lgkmcnt(0)
  v_mfma_f32_16x16x32_bf16 a[132:135], a[52:55], a[164:167], a[132:135]
  s_waitcnt vmcnt(19)
  buffer_load_dwordx4 a[164:167], v2, s[40:43], s65 offen offset:1024 sc1
  v_mfma_f32_16x16x32_bf16 a[72:75], a[36:39], a[168:171], a[72:75]
  v_mfma_f32_16x16x32_bf16 a[88:91], a[40:43], a[168:171], a[88:91]
  v_mfma_f32_16x16x32_bf16 a[104:107], a[44:47], a[168:171], a[104:107]
  buffer_load_dwordx4 v[244:247], v2, s[40:43], s14 offen offset:3072 sc1
  v_mfma_f32_16x16x32_bf16 a[120:123], a[48:51], a[168:171], a[120:123]
  v_mfma_f32_16x16x32_bf16 a[136:139], a[52:55], a[168:171], a[136:139]
  buffer_load_dwordx4 a[168:171], v2, s[40:43], s66 offen offset:1024 sc1
  v_mfma_f32_16x16x32_bf16 a[76:79], a[36:39], a[172:175], a[76:79]
  v_mfma_f32_16x16x32_bf16 a[92:95], a[40:43], a[172:175], a[92:95]
  v_mfma_f32_16x16x32_bf16 a[108:111], a[44:47], a[172:175], a[108:111]
  v_mfma_f32_16x16x32_bf16 a[124:127], a[48:51], a[172:175], a[124:127]
  v_mfma_f32_16x16x32_bf16 a[140:143], a[52:55], a[172:175], a[140:143]
  s_waitcnt vmcnt(19)
  buffer_load_dwordx4 a[172:175], v2, s[40:43], s67 offen offset:1024 sc1
  v_mfma_f32_16x16x32_bf16 a[64:67], a[56:59], a[176:179], a[64:67]
  v_mfma_f32_16x16x32_bf16 a[80:83], a[60:63], a[176:179], a[80:83]
  v_mfma_f32_16x16x32_bf16 a[96:99], v[32:35], a[176:179], a[96:99]
  s_add_u32 s14, s13, 143360
  buffer_load_dwordx4 v[64:67], v2, s[40:43], s14 offen offset:0 sc1
  v_mfma_f32_16x16x32_bf16 a[112:115], v[36:39], a[176:179], a[112:115]
  v_mfma_f32_16x16x32_bf16 a[128:131], v[40:43], a[176:179], a[128:131]
  buffer_load_dwordx4 a[176:179], v2, s[40:43], s64 offen offset:2048 sc1
  v_mfma_f32_16x16x32_bf16 a[68:71], a[56:59], a[180:183], a[68:71]
  v_mfma_f32_16x16x32_bf16 a[84:87], a[60:63], a[180:183], a[84:87]
  v_mfma_f32_16x16x32_bf16 a[100:103], v[32:35], a[180:183], a[100:103]
  v_mfma_f32_16x16x32_bf16 a[116:119], v[36:39], a[180:183], a[116:119]
  s_waitcnt lgkmcnt(0)
  v_mfma_f32_16x16x32_bf16 a[132:135], v[40:43], a[180:183], a[132:135]
  s_waitcnt vmcnt(19)
  buffer_load_dwordx4 a[180:183], v2, s[40:43], s65 offen offset:2048 sc1
  v_mfma_f32_16x16x32_bf16 a[72:75], a[56:59], a[184:187], a[72:75]
  v_mfma_f32_16x16x32_bf16 a[88:91], a[60:63], a[184:187], a[88:91]
  v_mfma_f32_16x16x32_bf16 a[104:107], v[32:35], a[184:187], a[104:107]
  buffer_load_dwordx4 v[68:71], v2, s[40:43], s14 offen offset:1024 sc1
  v_mfma_f32_16x16x32_bf16 a[120:123], v[36:39], a[184:187], a[120:123]
  v_mfma_f32_16x16x32_bf16 a[136:139], v[40:43], a[184:187], a[136:139]
  buffer_load_dwordx4 a[184:187], v2, s[40:43], s66 offen offset:2048 sc1
  v_mfma_f32_16x16x32_bf16 a[76:79], a[56:59], a[188:191], a[76:79]
  v_mfma_f32_16x16x32_bf16 a[92:95], a[60:63], a[188:191], a[92:95]
  v_mfma_f32_16x16x32_bf16 a[108:111], v[32:35], a[188:191], a[108:111]
  v_mfma_f32_16x16x32_bf16 a[124:127], v[36:39], a[188:191], a[124:127]
  v_mfma_f32_16x16x32_bf16 a[140:143], v[40:43], a[188:191], a[140:143]
  s_waitcnt vmcnt(19)
  buffer_load_dwordx4 a[188:191], v2, s[40:43], s67 offen offset:2048 sc1
  v_mfma_f32_16x16x32_bf16 a[64:67], v[44:47], v[216:219], a[64:67]
  v_mfma_f32_16x16x32_bf16 a[80:83], v[48:51], v[216:219], a[80:83]
  v_mfma_f32_16x16x32_bf16 a[96:99], v[52:55], v[216:219], a[96:99]
  buffer_load_dwordx4 v[72:75], v2, s[40:43], s14 offen offset:2048 sc1
  v_mfma_f32_16x16x32_bf16 a[112:115], v[56:59], v[216:219], a[112:115]
  v_mfma_f32_16x16x32_bf16 a[128:131], v[60:63], v[216:219], a[128:131]
  buffer_load_dwordx4 v[216:219], v2, s[40:43], s64 offen offset:3072 sc1
  v_mfma_f32_16x16x32_bf16 a[68:71], v[44:47], v[220:223], a[68:71]
  v_mfma_f32_16x16x32_bf16 a[84:87], v[48:51], v[220:223], a[84:87]
  v_mfma_f32_16x16x32_bf16 a[100:103], v[52:55], v[220:223], a[100:103]
  v_mfma_f32_16x16x32_bf16 a[116:119], v[56:59], v[220:223], a[116:119]
  s_barrier
  v_mfma_f32_16x16x32_bf16 a[132:135], v[60:63], v[220:223], a[132:135]
  s_waitcnt vmcnt(19)
  buffer_load_dwordx4 v[220:223], v2, s[40:43], s65 offen offset:3072 sc1
  v_mfma_f32_16x16x32_bf16 a[72:75], v[44:47], v[224:227], a[72:75]
  v_mfma_f32_16x16x32_bf16 a[88:91], v[48:51], v[224:227], a[88:91]
  v_mfma_f32_16x16x32_bf16 a[104:107], v[52:55], v[224:227], a[104:107]
  v_mfma_f32_16x16x32_bf16 a[120:123], v[56:59], v[224:227], a[120:123]
  v_mfma_f32_16x16x32_bf16 a[136:139], v[60:63], v[224:227], a[136:139]
  buffer_load_dwordx4 v[224:227], v2, s[40:43], s66 offen offset:3072 sc1
  v_mfma_f32_16x16x32_bf16 a[76:79], v[44:47], v[228:231], a[76:79]
  v_mfma_f32_16x16x32_bf16 a[92:95], v[48:51], v[228:231], a[92:95]
  v_mfma_f32_16x16x32_bf16 a[108:111], v[52:55], v[228:231], a[108:111]
  v_mfma_f32_16x16x32_bf16 a[124:127], v[56:59], v[228:231], a[124:127]
  v_mfma_f32_16x16x32_bf16 a[140:143], v[60:63], v[228:231], a[140:143]
  s_waitcnt vmcnt(18)
  buffer_load_dwordx4 v[228:231], v2, s[40:43], s67 offen offset:3072 sc1
  v_mfma_f32_16x16x32_bf16 a[64:67], v[96:99], a[144:147], a[64:67]
  s_add_u32 s62, s62, 4096
  v_mfma_f32_16x16x32_bf16 a[80:83], v[100:103], a[144:147], a[80:83]
  s_and_b32 s62, s62, 0x7fff
  v_mfma_f32_16x16x32_bf16 a[96:99], v[104:107], a[144:147], a[96:99]
  buffer_load_dwordx4 v[76:79], v2, s[40:43], s14 offen offset:3072 sc1
  v_mfma_f32_16x16x32_bf16 a[112:115], v[108:111], a[144:147], a[112:115]
  s_add_u32 s64, s63, s62
  v_mfma_f32_16x16x32_bf16 a[128:131], v[112:115], a[144:147], a[128:131]
  buffer_load_dwordx4 a[144:147], v2, s[40:43], s64 offen offset:0 sc1
  v_mfma_f32_16x16x32_bf16 a[68:71], v[96:99], a[148:151], a[68:71]
  s_add_u32 s65, s64, 131072
  v_mfma_f32_16x16x32_bf16 a[84:87], v[100:103], a[148:151], a[84:87]
  s_add_u32 s66, s64, 262144
  v_mfma_f32_16x16x32_bf16 a[100:103], v[104:107], a[148:151], a[100:103]
  v_mfma_f32_16x16x32_bf16 a[116:119], v[108:111], a[148:151], a[116:119]
  v_mfma_f32_16x16x32_bf16 a[132:135], v[112:115], a[148:151], a[132:135]
  s_waitcnt vmcnt(19)
  buffer_load_dwordx4 a[148:151], v2, s[40:43], s65 offen offset:0 sc1
  v_mfma_f32_16x16x32_bf16 a[72:75], v[96:99], a[152:155], a[72:75]
  s_add_u32 s67, s64, 393216
  v_mfma_f32_16x16x32_bf16 a[88:91], v[100:103], a[152:155], a[88:91]
  v_mfma_f32_16x16x32_bf16 a[104:107], v[104:107], a[152:155], a[104:107]
  s_add_u32 s14, s13, 159744
  buffer_load_dwordx4 v[176:179], v2, s[40:43], s14 offen offset:0 sc1
  v_mfma_f32_16x16x32_bf16 a[120:123], v[108:111], a[152:155], a[120:123]
  v_mfma_f32_16x16x32_bf16 a[136:139], v[112:115], a[152:155], a[136:139]
  buffer_load_dwordx4 a[152:155], v2, s[40:43], s66 offen offset:0 sc1
  v_mfma_f32_16x16x32_bf16 a[76:79], v[96:99], a[156:159], a[76:79]
  v_mfma_f32_16x16x32_bf16 a[92:95], v[100:103], a[156:159], a[92:95]
  v_mfma_f32_16x16x32_bf16 a[108:111], v[104:107], a[156:159], a[108:111]
  v_mfma_f32_16x16x32_bf16 a[124:127], v[108:111], a[156:159], a[124:127]
  v_mfma_f32_16x16x32_bf16 a[140:143], v[112:115], a[156:159], a[140:143]
  s_waitcnt vmcnt(19)
  buffer_load_dwordx4 a[156:159], v2, s[40:43], s67 offen offset:0 sc1
  v_mfma_f32_16x16x32_bf16 a[64:67], v[116:119], a[160:163], a[64:67]
  v_mfma_f32_16x16x32_bf16 a[80:83], v[120:123], a[160:163], a[80:83]
  v_mfma_f32_16x16x32_bf16 a[96:99], v[124:127], a[160:163], a[96:99]
  buffer_load_dwordx4 v[180:183], v2, s[40:43], s14 offen offset:1024 sc1
  v_mfma_f32_16x16x32_bf16 a[112:115], v[160:163], a[160:163], a[112:115]
  v_mfma_f32_16x16x32_bf16 a[128:131], v[164:167], a[160:163], a[128:131]
  buffer_load_dwordx4 a[160:163], v2, s[40:43], s64 offen offset:1024 sc1
  v_mfma_f32_16x16x32_bf16 a[68:71], v[116:119], a[164:167], a[68:71]
  v_mfma_f32_16x16x32_bf16 a[84:87], v[120:123], a[164:167], a[84:87]
  v_mfma_f32_16x16x32_bf16 a[100:103], v[124:127], a[164:167], a[100:103]
  v_mfma_f32_16x16x32_bf16 a[116:119], v[160:163], a[164:167], a[116:119]
  v_mfma_f32_16x16x32_bf16 a[132:135], v[164:167], a[164:167], a[132:135]
  s_waitcnt vmcnt(19)
  buffer_load_dwordx4 a[164:167], v2, s[40:43], s65 offen offset:1024 sc1
  v_mfma_f32_16x16x32_bf16 a[72:75], v[116:119], a[168:171], a[72:75]
  v_mfma_f32_16x16x32_bf16 a[88:91], v[120:123], a[168:171], a[88:91]
  v_mfma_f32_16x16x32_bf16 a[104:107], v[124:127], a[168:171], a[104:107]
  buffer_load_dwordx4 v[184:187], v2, s[40:43], s14 offen offset:2048 sc1
  v_mfma_f32_16x16x32_bf16 a[120:123], v[160:163], a[168:171], a[120:123]
  v_mfma_f32_16x16x32_bf16 a[136:139], v[164:167], a[168:171], a[136:139]
  buffer_load_dwordx4 a[168:171], v2, s[40:43], s66 offen offset:1024 sc1
  v_mfma_f32_16x16x32_bf16 a[76:79], v[116:119], a[172:175], a[76:79]
  v_mfma_f32_16x16x32_bf16 a[92:95], v[120:123], a[172:175], a[92:95]
  v_mfma_f32_16x16x32_bf16 a[108:111], v[124:127], a[172:175], a[108:111]
  v_mfma_f32_16x16x32_bf16 a[124:127], v[160:163], a[172:175], a[124:127]
  v_mfma_f32_16x16x32_bf16 a[140:143], v[164:167], a[172:175], a[140:143]
  s_waitcnt vmcnt(19)
  buffer_load_dwordx4 a[172:175], v2, s[40:43], s67 offen offset:1024 sc1
  v_mfma_f32_16x16x32_bf16 a[64:67], v[168:171], a[176:179], a[64:67]
  v_mfma_f32_16x16x32_bf16 a[80:83], v[172:175], a[176:179], a[80:83]
  buffer_load_dwordx4 v[32:35], v248, s[44:47], 0 offen
  v_mfma_f32_16x16x32_bf16 a[96:99], v[192:195], a[176:179], a[96:99]
  buffer_load_dwordx4 v[188:191], v2, s[40:43], s14 offen offset:3072 sc1
  v_mfma_f32_16x16x32_bf16 a[112:115], v[196:199], a[176:179], a[112:115]
  v_mfma_f32_16x16x32_bf16 a[128:131], v[208:211], a[176:179], a[128:131]
  buffer_load_dwordx4 a[176:179], v2, s[40:43], s64 offen offset:2048 sc1
  v_mfma_f32_16x16x32_bf16 a[68:71], v[168:171], a[180:183], a[68:71]
  v_mfma_f32_16x16x32_bf16 a[84:87], v[172:175], a[180:183], a[84:87]
  v_mfma_f32_16x16x32_bf16 a[100:103], v[192:195], a[180:183], a[100:103]
  v_mfma_f32_16x16x32_bf16 a[116:119], v[196:199], a[180:183], a[116:119]
  v_mfma_f32_16x16x32_bf16 a[132:135], v[208:211], a[180:183], a[132:135]
  s_waitcnt vmcnt(20)
  buffer_load_dwordx4 a[180:183], v2, s[40:43], s65 offen offset:2048 sc1
  v_mfma_f32_16x16x32_bf16 a[72:75], v[168:171], a[184:187], a[72:75]
  v_mfma_f32_16x16x32_bf16 a[88:91], v[172:175], a[184:187], a[88:91]
  buffer_load_dwordx4 v[44:47], v200, s[40:43], s27 offen sc1
  v_mfma_f32_16x16x32_bf16 a[104:107], v[192:195], a[184:187], a[104:107]
  v_mfma_f32_16x16x32_bf16 a[120:123], v[196:199], a[184:187], a[120:123]
  v_mfma_f32_16x16x32_bf16 a[136:139], v[208:211], a[184:187], a[136:139]
  buffer_load_dwordx4 a[184:187], v2, s[40:43], s66 offen offset:2048 sc1
  v_mfma_f32_16x16x32_bf16 a[76:79], v[168:171], a[188:191], a[76:79]
  v_mfma_f32_16x16x32_bf16 a[92:95], v[172:175], a[188:191], a[92:95]
  v_mfma_f32_16x16x32_bf16 a[108:111], v[192:195], a[188:191], a[108:111]
  v_mfma_f32_16x16x32_bf16 a[124:127], v[196:199], a[188:191], a[124:127]
  v_mfma_f32_16x16x32_bf16 a[140:143], v[208:211], a[188:191], a[140:143]
  s_waitcnt vmcnt(20)
  buffer_load_dwordx4 a[188:191], v2, s[40:43], s67 offen offset:2048 sc1
  v_mfma_f32_16x16x32_bf16 a[64:67], v[212:215], v[216:219], a[64:67]
  ds_read_b128 v[120:123], v203 offset:0
  v_mfma_f32_16x16x32_bf16 a[80:83], v[232:235], v[216:219], a[80:83]
  buffer_load_dwordx4 v[36:39], v249, s[44:47], 0 offen
  v_mfma_f32_16x16x32_bf16 a[96:99], v[236:239], v[216:219], a[96:99]
  v_add_u32 v20, 43008, v251
  v_mfma_f32_16x16x32_bf16 a[112:115], v[240:243], v[216:219], a[112:115]
  ds_read_b128 v[124:127], v203 offset:16
  v_mfma_f32_16x16x32_bf16 a[128:131], v[244:247], v[216:219], a[128:131]
  buffer_load_dwordx4 v[216:219], v2, s[40:43], s64 offen offset:3072 sc1
  v_mfma_f32_16x16x32_bf16 a[68:71], v[212:215], v[220:223], a[68:71]
  ds_read_b128 v[160:163], v204 offset:0
  v_mfma_f32_16x16x32_bf16 a[84:87], v[232:235], v[220:223], a[84:87]
  ds_read_b128 v[164:167], v204 offset:16
  v_add_u32 v21, 43008, v252
  v_mfma_f32_16x16x32_bf16 a[100:103], v[236:239], v[220:223], a[100:103]
  v_mfma_f32_16x16x32_bf16 a[116:119], v[240:243], v[220:223], a[116:119]
  ds_read_b128 v[168:171], v205 offset:0
  v_mfma_f32_16x16x32_bf16 a[132:135], v[244:247], v[220:223], a[132:135]
  s_waitcnt vmcnt(21)
  buffer_load_dwordx4 v[220:223], v2, s[40:43], s65 offen offset:3072 sc1
  v_mfma_f32_16x16x32_bf16 a[72:75], v[212:215], v[224:227], a[72:75]
  ds_read_b128 v[172:175], v205 offset:16
  v_add_u32 v22, 43008, v253
  v_mfma_f32_16x16x32_bf16 a[88:91], v[232:235], v[224:227], a[88:91]
  buffer_load_dwordx4 v[48:51], v201, s[40:43], s27 offen sc1
  v_mfma_f32_16x16x32_bf16 a[104:107], v[236:239], v[224:227], a[104:107]
  v_mfma_f32_16x16x32_bf16 a[120:123], v[240:243], v[224:227], a[120:123]
  v_mfma_f32_16x16x32_bf16 a[136:139], v[244:247], v[224:227], a[136:139]
  s_mul_i32 s23, s20, 21504
  buffer_load_dwordx4 v[224:227], v2, s[40:43], s66 offen offset:3072 sc1
  v_and_b32 v16, 15, v1
  v_mul_u32_u24 v16, 336, v16
  v_mfma_f32_16x16x32_bf16 a[76:79], v[212:215], v[228:231], a[76:79]
  v_lshrrev_b32 v17, 4, v1
  v_lshl_add_u32 v16, v17, 4, v16
  v_mfma_f32_16x16x32_bf16 a[92:95], v[232:235], v[228:231], a[92:95]
  v_add_u32 v16, s23, v16
  v_mfma_f32_16x16x32_bf16 a[108:111], v[236:239], v[228:231], a[108:111]
  v_mfma_f32_16x16x32_bf16 a[124:127], v[240:243], v[228:231], a[124:127]
  s_waitcnt lgkmcnt(0)
  v_mfma_f32_16x16x32_bf16 a[140:143], v[244:247], v[228:231], a[140:143]
  s_waitcnt vmcnt(21)
  buffer_load_dwordx4 v[228:231], v2, s[40:43], s67 offen offset:3072 sc1
  v_mfma_f32_16x16x32_bf16 a[64:67], v[64:67], a[144:147], a[64:67]
  v_mfma_f32_16x16x32_bf16 a[80:83], v[68:71], a[144:147], a[80:83]
  buffer_load_dwordx4 v[40:43], v250, s[44:47], 0 offen
  v_mfma_f32_16x16x32_bf16 a[96:99], v[72:75], a[144:147], a[96:99]
  v_mfma_f32_16x16x32_bf16 a[112:115], v[76:79], a[144:147], a[112:115]
  v_mfma_f32_16x16x32_bf16 a[128:131], v[80:83], a[144:147], a[128:131]
  v_mfma_f32_16x16x32_bf16 a[68:71], v[64:67], a[148:151], a[68:71]
  v_mfma_f32_16x16x32_bf16 a[84:87], v[68:71], a[148:151], a[84:87]
  v_mfma_f32_16x16x32_bf16 a[100:103], v[72:75], a[148:151], a[100:103]
  v_mfma_f32_16x16x32_bf16 a[116:119], v[76:79], a[148:151], a[116:119]
  v_mfma_f32_16x16x32_bf16 a[132:135], v[80:83], a[148:151], a[132:135]
  s_waitcnt vmcnt(20)
  v_mfma_f32_16x16x32_bf16 a[72:75], v[64:67], a[152:155], a[72:75]
  v_mfma_f32_16x16x32_bf16 a[88:91], v[68:71], a[152:155], a[88:91]
  buffer_load_dwordx4 v[52:55], v202, s[40:43], s27 offen sc1
  v_mfma_f32_16x16x32_bf16 a[104:107], v[72:75], a[152:155], a[104:107]
  v_mfma_f32_16x16x32_bf16 a[120:123], v[76:79], a[152:155], a[120:123]
  v_mfma_f32_16x16x32_bf16 a[136:139], v[80:83], a[152:155], a[136:139]
  v_mfma_f32_16x16x32_bf16 a[76:79], v[64:67], a[156:159], a[76:79]
  v_mfma_f32_16x16x32_bf16 a[92:95], v[68:71], a[156:159], a[92:95]
  v_mfma_f32_16x16x32_bf16 a[108:111], v[72:75], a[156:159], a[108:111]
  v_mfma_f32_16x16x32_bf16 a[124:127], v[76:79], a[156:159], a[124:127]
  v_mfma_f32_16x16x32_bf16 a[140:143], v[80:83], a[156:159], a[140:143]
  s_waitcnt vmcnt(10)
  v_mfma_f32_16x16x32_bf16 a[64:67], v[84:87], a[160:163], a[64:67]
  v_lshlrev_b32 v18, 16, v44
  v_and_b32 v19, 0xffff0000, v44
  v_mfma_f32_16x16x32_bf16 a[80:83], v[88:91], a[160:163], a[80:83]
  v_add_f32 v120, v120, v18
  v_add_f32 v121, v121, v19
  v_mfma_f32_16x16x32_bf16 a[96:99], v[92:95], a[160:163], a[96:99]
  v_cvt_pk_bf16_f32 v18, v120, v121
  v_lshlrev_b32 v96, 16, v32
  v_mfma_f32_16x16x32_bf16 a[112:115], v[128:131], a[160:163], a[112:115]
  v_and_b32 v97, 0xffff0000, v32
  v_lshlrev_b32 v120, 16, v18
  v_mfma_f32_16x16x32_bf16 a[128:131], v[132:135], a[160:163], a[128:131]
  v_and_b32 v121, 0xffff0000, v18
  v_lshlrev_b32 v18, 16, v45
  v_mfma_f32_16x16x32_bf16 a[68:71], v[84:87], a[164:167], a[68:71]
  v_and_b32 v19, 0xffff0000, v45
  v_add_f32 v122, v122, v18
  v_mfma_f32_16x16x32_bf16 a[84:87], v[88:91], a[164:167], a[84:87]
  v_add_f32 v123, v123, v19
  v_cvt_pk_bf16_f32 v18, v122, v123
  v_mfma_f32_16x16x32_bf16 a[100:103], v[92:95], a[164:167], a[100:103]
  v_lshlrev_b32 v98, 16, v33
  v_and_b32 v99, 0xffff0000, v33
  v_mfma_f32_16x16x32_bf16 a[116:119], v[128:131], a[164:167], a[116:119]
  v_lshlrev_b32 v122, 16, v18
  v_and_b32 v123, 0xffff0000, v18
  v_mfma_f32_16x16x32_bf16 a[132:135], v[132:135], a[164:167], a[132:135]
  s_waitcnt vmcnt(15)
  v_lshlrev_b32 v18, 16, v46
  v_and_b32 v19, 0xffff0000, v46
  v_mfma_f32_16x16x32_bf16 a[72:75], v[84:87], a[168:171], a[72:75]
  v_add_f32 v124, v124, v18
  v_add_f32 v125, v125, v19
  v_mfma_f32_16x16x32_bf16 a[88:91], v[88:91], a[168:171], a[88:91]
  v_cvt_pk_bf16_f32 v18, v124, v125
  v_lshlrev_b32 v100, 16, v34
  v_mfma_f32_16x16x32_bf16 a[104:107], v[92:95], a[168:171], a[104:107]
  v_and_b32 v101, 0xffff0000, v34
  v_lshlrev_b32 v124, 16, v18
  v_mfma_f32_16x16x32_bf16 a[120:123], v[128:131], a[168:171], a[120:123]
  v_and_b32 v125, 0xffff0000, v18
  v_lshlrev_b32 v18, 16, v47
  v_mfma_f32_16x16x32_bf16 a[136:139], v[132:135], a[168:171], a[136:139]
  v_and_b32 v19, 0xffff0000, v47
  v_add_f32 v126, v126, v18
  v_mfma_f32_16x16x32_bf16 a[76:79], v[84:87], a[172:175], a[76:79]
  v_add_f32 v127, v127, v19
  v_cvt_pk_bf16_f32 v18, v126, v127
  v_mfma_f32_16x16x32_bf16 a[92:95], v[88:91], a[172:175], a[92:95]
  v_lshlrev_b32 v102, 16, v35
  v_and_b32 v103, 0xffff0000, v35
  v_mfma_f32_16x16x32_bf16 a[108:111], v[92:95], a[172:175], a[108:111]
  v_lshlrev_b32 v126, 16, v18
  v_and_b32 v127, 0xffff0000, v18
  v_mfma_f32_16x16x32_bf16 a[124:127], v[128:131], a[172:175], a[124:127]
  v_mfma_f32_16x16x32_bf16 a[140:143], v[132:135], a[172:175], a[140:143]
  s_waitcnt vmcnt(4)
  v_mfma_f32_16x16x32_bf16 a[64:67], v[136:139], a[176:179], a[64:67]
  v_lshlrev_b32 v18, 16, v48
  v_and_b32 v19, 0xffff0000, v48
  v_mfma_f32_16x16x32_bf16 a[80:83], v[140:143], a[176:179], a[80:83]
  v_add_f32 v160, v160, v18
  v_add_f32 v161, v161, v19
  v_mfma_f32_16x16x32_bf16 a[96:99], v[144:147], a[176:179], a[96:99]
  v_cvt_pk_bf16_f32 v18, v160, v161
  v_lshlrev_b32 v104, 16, v36
  v_mfma_f32_16x16x32_bf16 a[112:115], v[148:151], a[176:179], a[112:115]
  v_and_b32 v105, 0xffff0000, v36
  v_lshlrev_b32 v160, 16, v18
  v_mfma_f32_16x16x32_bf16 a[128:131], v[152:155], a[176:179], a[128:131]
  v_and_b32 v161, 0xffff0000, v18
  v_lshlrev_b32 v18, 16, v49
  v_mfma_f32_16x16x32_bf16 a[68:71], v[136:139], a[180:183], a[68:71]
  v_and_b32 v19, 0xffff0000, v49
  v_add_f32 v162, v162, v18
  v_mfma_f32_16x16x32_bf16 a[84:87], v[140:143], a[180:183], a[84:87]
  v_add_f32 v163, v163, v19
  v_cvt_pk_bf16_f32 v18, v162, v163
  v_mfma_f32_16x16x32_bf16 a[100:103], v[144:147], a[180:183], a[100:103]
  v_lshlrev_b32 v106, 16, v37
  v_and_b32 v107, 0xffff0000, v37
  v_mfma_f32_16x16x32_bf16 a[116:119], v[148:151], a[180:183], a[116:119]
  v_lshlrev_b32 v162, 16, v18
  v_and_b32 v163, 0xffff0000, v18
  v_mfma_f32_16x16x32_bf16 a[132:135], v[152:155], a[180:183], a[132:135]
  s_waitcnt vmcnt(8)
  v_lshlrev_b32 v18, 16, v50
  v_and_b32 v19, 0xffff0000, v50
  v_mfma_f32_16x16x32_bf16 a[72:75], v[136:139], a[184:187], a[72:75]
  v_add_f32 v164, v164, v18
  v_add_f32 v165, v165, v19
  v_mfma_f32_16x16x32_bf16 a[88:91], v[140:143], a[184:187], a[88:91]
  v_cvt_pk_bf16_f32 v18, v164, v165
  v_lshlrev_b32 v108, 16, v38
  v_mfma_f32_16x16x32_bf16 a[104:107], v[144:147], a[184:187], a[104:107]
  v_and_b32 v109, 0xffff0000, v38
  v_lshlrev_b32 v164, 16, v18
  v_mfma_f32_16x16x32_bf16 a[120:123], v[148:151], a[184:187], a[120:123]
  v_and_b32 v165, 0xffff0000, v18
  v_lshlrev_b32 v18, 16, v51
  v_mfma_f32_16x16x32_bf16 a[136:139], v[152:155], a[184:187], a[136:139]
  v_and_b32 v19, 0xffff0000, v51
  v_add_f32 v166, v166, v18
  v_mfma_f32_16x16x32_bf16 a[76:79], v[136:139], a[188:191], a[76:79]
  v_add_f32 v167, v167, v19
  v_cvt_pk_bf16_f32 v18, v166, v167
  v_mfma_f32_16x16x32_bf16 a[92:95], v[140:143], a[188:191], a[92:95]
  v_lshlrev_b32 v110, 16, v39
  v_and_b32 v111, 0xffff0000, v39
  v_mfma_f32_16x16x32_bf16 a[108:111], v[144:147], a[188:191], a[108:111]
  v_lshlrev_b32 v166, 16, v18
  v_and_b32 v167, 0xffff0000, v18
  v_mfma_f32_16x16x32_bf16 a[124:127], v[148:151], a[188:191], a[124:127]
  v_mfma_f32_16x16x32_bf16 a[140:143], v[152:155], a[188:191], a[140:143]
  s_waitcnt vmcnt(0)
  v_mfma_f32_16x16x32_bf16 a[64:67], v[156:159], v[216:219], a[64:67]
  v_lshlrev_b32 v18, 16, v52
  v_and_b32 v19, 0xffff0000, v52
  v_mfma_f32_16x16x32_bf16 a[80:83], v[176:179], v[216:219], a[80:83]
  v_add_f32 v168, v168, v18
  v_add_f32 v169, v169, v19
  v_mfma_f32_16x16x32_bf16 a[96:99], v[180:183], v[216:219], a[96:99]
  v_cvt_pk_bf16_f32 v18, v168, v169
  v_lshlrev_b32 v112, 16, v40
  v_mfma_f32_16x16x32_bf16 a[112:115], v[184:187], v[216:219], a[112:115]
  v_and_b32 v113, 0xffff0000, v40
  v_lshlrev_b32 v168, 16, v18
  v_mfma_f32_16x16x32_bf16 a[128:131], v[188:191], v[216:219], a[128:131]
  v_and_b32 v169, 0xffff0000, v18
  v_lshlrev_b32 v18, 16, v53
  v_mfma_f32_16x16x32_bf16 a[68:71], v[156:159], v[220:223], a[68:71]
  v_and_b32 v19, 0xffff0000, v53
  v_add_f32 v170, v170, v18
  v_mfma_f32_16x16x32_bf16 a[84:87], v[176:179], v[220:223], a[84:87]
  v_add_f32 v171, v171, v19
  v_cvt_pk_bf16_f32 v18, v170, v171
  v_mfma_f32_16x16x32_bf16 a[100:103], v[180:183], v[220:223], a[100:103]
  v_lshlrev_b32 v114, 16, v41
  v_and_b32 v115, 0xffff0000, v41
  v_mfma_f32_16x16x32_bf16 a[116:119], v[184:187], v[220:223], a[116:119]
  v_lshlrev_b32 v170, 16, v18
  v_and_b32 v171, 0xffff0000, v18
  v_mfma_f32_16x16x32_bf16 a[132:135], v[188:191], v[220:223], a[132:135]
  s_waitcnt vmcnt(2)
  ds_write_b128 v16, a[64:67] offset:0
  v_lshlrev_b32 v18, 16, v54
  v_and_b32 v19, 0xffff0000, v54
  v_mfma_f32_16x16x32_bf16 a[72:75], v[156:159], v[224:227], a[72:75]
  ds_write_b128 v16, a[80:83] offset:64
  v_add_f32 v172, v172, v18
  v_add_f32 v173, v173, v19
  v_mfma_f32_16x16x32_bf16 a[88:91], v[176:179], v[224:227], a[88:91]
  ds_write_b128 v16, a[96:99] offset:128
  v_cvt_pk_bf16_f32 v18, v172, v173
  v_lshlrev_b32 v116, 16, v42
  v_mfma_f32_16x16x32_bf16 a[104:107], v[180:183], v[224:227], a[104:107]
  ds_write_b128 v16, a[112:115] offset:192
  v_and_b32 v117, 0xffff0000, v42
  v_lshlrev_b32 v172, 16, v18
  v_mfma_f32_16x16x32_bf16 a[120:123], v[184:187], v[224:227], a[120:123]
  ds_write_b128 v16, a[128:131] offset:256
  v_and_b32 v173, 0xffff0000, v18
  v_lshlrev_b32 v18, 16, v55
  v_mfma_f32_16x16x32_bf16 a[136:139], v[188:191], v[224:227], a[136:139]
  ds_write_b128 v16, a[68:71] offset:5376
  v_and_b32 v19, 0xffff0000, v55
  v_add_f32 v174, v174, v18
  v_mfma_f32_16x16x32_bf16 a[76:79], v[156:159], v[228:231], a[76:79]
  ds_write_b128 v16, a[84:87] offset:5440
  v_add_f32 v175, v175, v19
  v_cvt_pk_bf16_f32 v18, v174, v175
  v_mfma_f32_16x16x32_bf16 a[92:95], v[176:179], v[228:231], a[92:95]
  ds_write_b128 v16, a[100:103] offset:5504
  v_lshlrev_b32 v118, 16, v43
  v_and_b32 v119, 0xffff0000, v43
  v_mfma_f32_16x16x32_bf16 a[108:111], v[180:183], v[228:231], a[108:111]
  ds_write_b128 v16, a[116:119] offset:5568
  v_lshlrev_b32 v174, 16, v18
  v_and_b32 v175, 0xffff0000, v18
  v_mfma_f32_16x16x32_bf16 a[124:127], v[184:187], v[228:231], a[124:127]
  ds_write_b128 v16, a[132:135] offset:5632
  v_mfma_f32_16x16x32_bf16 a[140:143], v[188:191], v[228:231], a[140:143]
  ds_write_b128 v16, a[72:75] offset:10752
  ds_write_b128 v16, a[88:91] offset:10816
  ds_write_b128 v16, a[104:107] offset:10880
  ds_write_b128 v16, a[120:123] offset:10944
  ds_write_b128 v16, a[136:139] offset:11008
  ds_write_b128 v16, a[76:79] offset:16128
  ds_write_b128 v16, a[92:95] offset:16192
  ds_write_b128 v16, a[108:111] offset:16256
  ds_write_b128 v16, a[124:127] offset:16320
  ds_write_b128 v16, a[140:143] offset:16384
  s_waitcnt lgkmcnt(0)
  s_barrier
  ds_read_b128 v[32:35], v251 offset:0
  ds_read_b128 v[36:39], v251 offset:16
  ds_read_b128 v[40:43], v251 offset:21504
  ds_read_b128 v[44:47], v251 offset:21520
  ds_read_b128 v[48:51], v20 offset:0
  ds_read_b128 v[52:55], v20 offset:16
  ds_read_b128 v[56:59], v20 offset:21504
  ds_read_b128 v[60:63], v20 offset:21520
  ds_read_b128 v[64:67], v252 offset:0
  ds_read_b128 v[68:71], v252 offset:16
  ds_read_b128 v[72:75], v252 offset:21504
  ds_read_b128 v[76:79], v252 offset:21520
  ds_read_b128 v[80:83], v21 offset:0
  ds_read_b128 v[84:87], v21 offset:16
  ds_read_b128 v[88:91], v21 offset:21504
  ds_read_b128 v[92:95], v21 offset:21520
  ds_read_b128 v[128:131], v253 offset:0
  ds_read_b128 v[132:135], v253 offset:16
  ds_read_b128 v[136:139], v253 offset:21504
  ds_read_b128 v[140:143], v253 offset:21520
  ds_read_b128 v[144:147], v22 offset:0
  ds_read_b128 v[148:151], v22 offset:16
  ds_read_b128 v[152:155], v22 offset:21504
  ds_read_b128 v[156:159], v22 offset:21520
  s_waitcnt lgkmcnt(15)
  v_pk_add_f32 v[32:33], v[32:33], v[40:41]
  v_pk_add_f32 v[48:49], v[48:49], v[56:57]
  v_pk_add_f32 v[34:35], v[34:35], v[42:43]
  v_pk_add_f32 v[50:51], v[50:51], v[58:59]
  v_pk_add_f32 v[36:37], v[36:37], v[44:45]
  v_pk_add_f32 v[52:53], v[52:53], v[60:61]
  v_pk_add_f32 v[38:39], v[38:39], v[46:47]
  v_pk_add_f32 v[54:55], v[54:55], v[62:63]
  v_pk_add_f32 v[32:33], v[32:33], v[48:49]
  v_pk_add_f32 v[34:35], v[34:35], v[50:51]
  v_pk_add_f32 v[36:37], v[36:37], v[52:53]
  v_pk_add_f32 v[38:39], v[38:39], v[54:55]
  v_cvt_pk_bf16_f32 v40, v32, v33
  v_cvt_pk_bf16_f32 v41, v34, v35
  v_cvt_pk_bf16_f32 v42, v36, v37
  v_cvt_pk_bf16_f32 v43, v38, v39
  v_lshlrev_b32 v32, 16, v40
  v_and_b32 v33, 0xffff0000, v40
  v_lshlrev_b32 v34, 16, v41
  v_and_b32 v35, 0xffff0000, v41
  v_lshlrev_b32 v36, 16, v42
  v_and_b32 v37, 0xffff0000, v42
  v_lshlrev_b32 v38, 16, v43
  v_and_b32 v39, 0xffff0000, v43
  v_pk_add_f32 v[32:33], v[32:33], v[96:97]
  v_pk_add_f32 v[34:35], v[34:35], v[98:99]
  v_pk_add_f32 v[36:37], v[36:37], v[100:101]
  v_pk_add_f32 v[38:39], v[38:39], v[102:103]
  v_cvt_pk_bf16_f32 v40, v32, v33
  v_cvt_pk_bf16_f32 v41, v34, v35
  v_cvt_pk_bf16_f32 v42, v36, v37
  v_cvt_pk_bf16_f32 v43, v38, v39
  v_lshlrev_b32 v32, 16, v40
  v_and_b32 v33, 0xffff0000, v40
  v_lshlrev_b32 v34, 16, v41
  v_and_b32 v35, 0xffff0000, v41
  v_lshlrev_b32 v36, 16, v42
  v_and_b32 v37, 0xffff0000, v42
  v_lshlrev_b32 v38, 16, v43
  v_and_b32 v39, 0xffff0000, v43
  v_pk_add_f32 v[32:33], v[32:33], v[120:121]
  v_pk_add_f32 v[34:35], v[34:35], v[122:123]
  v_pk_add_f32 v[36:37], v[36:37], v[124:125]
  v_pk_add_f32 v[38:39], v[38:39], v[126:127]
  v_cvt_pk_bf16_f32 v44, v32, v33
  v_cvt_pk_bf16_f32 v45, v34, v35
  v_cvt_pk_bf16_f32 v46, v36, v37
  v_cvt_pk_bf16_f32 v47, v38, v39
  buffer_store_dwordx4 v[44:47], v248, s[48:51], 0 offen
  s_waitcnt lgkmcnt(8)
  v_pk_add_f32 v[64:65], v[64:65], v[72:73]
  v_pk_add_f32 v[80:81], v[80:81], v[88:89]
  v_pk_add_f32 v[66:67], v[66:67], v[74:75]
  v_pk_add_f32 v[82:83], v[82:83], v[90:91]
  v_pk_add_f32 v[68:69], v[68:69], v[76:77]
  v_pk_add_f32 v[84:85], v[84:85], v[92:93]
  v_pk_add_f32 v[70:71], v[70:71], v[78:79]
  v_pk_add_f32 v[86:87], v[86:87], v[94:95]
  v_pk_add_f32 v[64:65], v[64:65], v[80:81]
  v_pk_add_f32 v[66:67], v[66:67], v[82:83]
  v_pk_add_f32 v[68:69], v[68:69], v[84:85]
  v_pk_add_f32 v[70:71], v[70:71], v[86:87]
  v_cvt_pk_bf16_f32 v72, v64, v65
  v_cvt_pk_bf16_f32 v73, v66, v67
  v_cvt_pk_bf16_f32 v74, v68, v69
  v_cvt_pk_bf16_f32 v75, v70, v71
  v_lshlrev_b32 v64, 16, v72
  v_and_b32 v65, 0xffff0000, v72
  v_lshlrev_b32 v66, 16, v73
  v_and_b32 v67, 0xffff0000, v73
  v_lshlrev_b32 v68, 16, v74
  v_and_b32 v69, 0xffff0000, v74
  v_lshlrev_b32 v70, 16, v75
  v_and_b32 v71, 0xffff0000, v75
  v_pk_add_f32 v[64:65], v[64:65], v[104:105]
  v_pk_add_f32 v[66:67], v[66:67], v[106:107]
  v_pk_add_f32 v[68:69], v[68:69], v[108:109]
  v_pk_add_f32 v[70:71], v[70:71], v[110:111]
  v_cvt_pk_bf16_f32 v72, v64, v65
  v_cvt_pk_bf16_f32 v73, v66, v67
  v_cvt_pk_bf16_f32 v74, v68, v69
  v_cvt_pk_bf16_f32 v75, v70, v71
  v_lshlrev_b32 v64, 16, v72
  v_and_b32 v65, 0xffff0000, v72
  v_lshlrev_b32 v66, 16, v73
  v_and_b32 v67, 0xffff0000, v73
  v_lshlrev_b32 v68, 16, v74
  v_and_b32 v69, 0xffff0000, v74
  v_lshlrev_b32 v70, 16, v75
  v_and_b32 v71, 0xffff0000, v75
  v_pk_add_f32 v[64:65], v[64:65], v[160:161]
  v_pk_add_f32 v[66:67], v[66:67], v[162:163]
  v_pk_add_f32 v[68:69], v[68:69], v[164:165]
  v_pk_add_f32 v[70:71], v[70:71], v[166:167]
  v_cvt_pk_bf16_f32 v76, v64, v65
  v_cvt_pk_bf16_f32 v77, v66, v67
  v_cvt_pk_bf16_f32 v78, v68, v69
  v_cvt_pk_bf16_f32 v79, v70, v71
  buffer_store_dwordx4 v[76:79], v249, s[48:51], 0 offen
  s_waitcnt lgkmcnt(0)
  v_pk_add_f32 v[128:129], v[128:129], v[136:137]
  v_pk_add_f32 v[144:145], v[144:145], v[152:153]
  v_pk_add_f32 v[130:131], v[130:131], v[138:139]
  v_pk_add_f32 v[146:147], v[146:147], v[154:155]
  v_pk_add_f32 v[132:133], v[132:133], v[140:141]
  v_pk_add_f32 v[148:149], v[148:149], v[156:157]
  v_pk_add_f32 v[134:135], v[134:135], v[142:143]
  v_pk_add_f32 v[150:151], v[150:151], v[158:159]
  v_pk_add_f32 v[128:129], v[128:129], v[144:145]
  v_pk_add_f32 v[130:131], v[130:131], v[146:147]
  v_pk_add_f32 v[132:133], v[132:133], v[148:149]
  v_pk_add_f32 v[134:135], v[134:135], v[150:151]
  v_cvt_pk_bf16_f32 v136, v128, v129
  v_cvt_pk_bf16_f32 v137, v130, v131
  v_cvt_pk_bf16_f32 v138, v132, v133
  v_cvt_pk_bf16_f32 v139, v134, v135
  v_lshlrev_b32 v128, 16, v136
  v_and_b32 v129, 0xffff0000, v136
  v_lshlrev_b32 v130, 16, v137
  v_and_b32 v131, 0xffff0000, v137
  v_lshlrev_b32 v132, 16, v138
  v_and_b32 v133, 0xffff0000, v138
  v_lshlrev_b32 v134, 16, v139
  v_and_b32 v135, 0xffff0000, v139
  v_pk_add_f32 v[128:129], v[128:129], v[112:113]
  v_pk_add_f32 v[130:131], v[130:131], v[114:115]
  v_pk_add_f32 v[132:133], v[132:133], v[116:117]
  v_pk_add_f32 v[134:135], v[134:135], v[118:119]
  v_cvt_pk_bf16_f32 v136, v128, v129
  v_cvt_pk_bf16_f32 v137, v130, v131
  v_cvt_pk_bf16_f32 v138, v132, v133
  v_cvt_pk_bf16_f32 v139, v134, v135
  v_lshlrev_b32 v128, 16, v136
  v_and_b32 v129, 0xffff0000, v136
  v_lshlrev_b32 v130, 16, v137
  v_and_b32 v131, 0xffff0000, v137
  v_lshlrev_b32 v132, 16, v138
  v_and_b32 v133, 0xffff0000, v138
  v_lshlrev_b32 v134, 16, v139
  v_and_b32 v135, 0xffff0000, v139
  v_pk_add_f32 v[128:129], v[128:129], v[168:169]
  v_pk_add_f32 v[130:131], v[130:131], v[170:171]
  v_pk_add_f32 v[132:133], v[132:133], v[172:173]
  v_pk_add_f32 v[134:135], v[134:135], v[174:175]
  v_cvt_pk_bf16_f32 v140, v128, v129
  v_cvt_pk_bf16_f32 v141, v130, v131
  v_cvt_pk_bf16_f32 v142, v132, v133
  v_cvt_pk_bf16_f32 v143, v134, v135
  buffer_store_dwordx4 v[140:143], v250, s[48:51], 0 offen
fa_end:
  s_endpgm
fa_hk0:
  s_getpc_b64 s[10:11]
fa_hp0:
  s_add_u32 s8, s8, 4
  s_addc_u32 s9, s9, 0
  s_sub_u32 s10, s10, fa_hp0-fa_hb0
  s_subb_u32 s11, s11, 0
  s_setpc_b64 s[8:9]
fa_hk1:
  s_getpc_b64 s[10:11]
fa_hp1:
  s_add_u32 s8, s8, 4
  s_addc_u32 s9, s9, 0
  s_sub_u32 s10, s10, fa_hp1-fa_hb1
  s_subb_u32 s11, s11, 0
  s_setpc_b64 s[8:9]
fa_hk2:
  s_getpc_b64 s[10:11]
fa_hp2:
  s_add_u32 s8, s8, 4
  s_addc_u32 s9, s9, 0
  s_sub_u32 s10, s10, fa_hp2-fa_hb2
  s_subb_u32 s11, s11, 0
  s_setpc_b64 s[8:9]
fa_hk3:
  s_getpc_b64 s[10:11]
fa_hp3:
  s_add_u32 s8, s8, 4
  s_addc_u32 s9, s9, 0
  s_sub_u32 s10, s10, fa_hp3-fa_hb3
  s_subb_u32 s11, s11, 0
  s_setpc_b64 s[8:9]
fa_ln_spin:
  s_mov_b32 s83, 200000
fa_ln_spin2:
  buffer_load_dword v15, v229, s[56:59], 0 offen sc1
  s_waitcnt vmcnt(0)
  v_cmp_ne_u32 vcc, 0x01010101, v15
  s_cbranch_vccz fa_ln_ok
  s_sleep 8
  s_sub_u32 s83, s83, 1
  s_cmp_lg_u32 s83, 0
  s_cbranch_scc1 fa_ln_spin2
  s_branch fa_ln_ok
fa_co1:
  buffer_load_dword v232, v234, s[32:35], s29 offen
  buffer_store_dword v229, v225, s[40:43], 0 offen sc1
  ds_read_b128 v[160:163], v221 offset:0
  ds_read_b128 v[164:167], v221 offset:4096
  ds_read_b128 v[168:171], v221 offset:8192
  buffer_store_dword v218, v222, s[40:43], 0 offen sc1
  s_waitcnt lgkmcnt(0)
  buffer_store_dwordx4 v[160:163], v223, s[40:43], s66 offen sc1
  buffer_store_dwordx4 v[164:167], v223, s[40:43], s67 offen sc1
  buffer_store_dwordx4 v[168:171], v224, s[40:43], s78 offen sc1
  s_getpc_b64 s[8:9]
  s_setpc_b64 s[10:11]
  s_mov_b32 s48, s60
  s_mov_b32 s49, s61
  s_mov_b32 s50, s75
  s_lshl_b32 s74, s22, 2
  s_add_u32 s74, s74, s20
  s_lshl_b32 s74, s74, 16
  s_mov_b32 s73, 2097152
  v_mov_b32 v213, 1073741824
  v_mov_b32 v214, 1
  v_writelane_b32 v213, s77, 0
  v_lshlrev_b32 v229, 2, v1
  s_and_b32 s23, s21, 3
  s_cbranch_scc0 fa_arr
  s_getpc_b64 s[8:9]
  s_setpc_b64 s[10:11]
fa_arr:
  buffer_store_byte v214, v213, s[56:59], 0 offen sc1
  s_getpc_b64 s[8:9]
  s_setpc_b64 s[10:11]
  buffer_load_dword v15, v229, s[56:59], 0 offen sc1
  s_getpc_b64 s[8:9]
  s_setpc_b64 s[10:11]
  s_mov_b32 s36, s60
  s_mov_b32 s37, s61
  s_mov_b32 s38, s75
  s_lshr_b32 s27, s20, 1
  s_lshl_b32 s27, s27, 18
  s_mov_b32 s25, 524288
  s_mov_b32 s32, s18
  s_mov_b32 s33, s19
  s_mov_b32 s34, 2621440
  s_mov_b32 s26, 0
  s_movk_i32 s79, 1024
  s_lshl_b32 s23, s22, 2
  s_add_u32 s23, s23, s20
  s_mul_i32 s23, s23, 40960
  v_add_u32 v3, s23, v2
  s_sub_u32 s23, 15, s22
  s_lshl_b32 s23, s23, 2
  s_add_u32 s23, s23, s20
  s_mul_i32 s23, s23, 40960
  s_sub_u32 s23, s23, 2048
  v_add_u32 v5, s23, v2
  v_add_u32 v4, 19456, v3
  v_add_u32 v6, 19456, v5
  s_waitcnt vmcnt(8)
  v_cmp_ne_u32 vcc, 0x01010101, v15
  s_cbranch_vccnz fa_ln_spin
fa_ln_ok:
  s_setpc_b64 s[10:11]
fa_kv_spin:
  s_mov_b32 s83, 200000
fa_kv_spin2:
  buffer_load_dword v15, v8, s[40:43], 0 offen sc1
  s_waitcnt vmcnt(0)
  v_cmp_eq_u32 vcc, 0, v15
  s_cbranch_vccz fa_kv_ok
  s_sleep 8
  s_sub_u32 s83, s83, 1
  s_cmp_lg_u32 s83, 0
  s_cbranch_scc1 fa_kv_spin2
  s_branch fa_kv_ok
fa_top8:
  v_mov_b32 v21, 0
  v_mov_b32 v22, 0
  v_and_b32 v23, 7, v1
  s_mov_b32 s23, 0
fa_top:
  v_max3_u32 v20, v232, v233, v234
  v_max3_u32 v24, v235, v236, v237
  v_max3_u32 v20, v20, v238, v239
  v_max_u32 v20, v20, v24
  s_nop 1
  v_max_u32_dpp v20, v20, v20 quad_perm:[1,0,3,2] row_mask:0xf bank_mask:0xf
  s_nop 1
  v_max_u32_dpp v20, v20, v20 quad_perm:[2,3,0,1] row_mask:0xf bank_mask:0xf
  s_nop 1
  v_max_u32_dpp v20, v20, v20 row_half_mirror row_mask:0xf bank_mask:0xf
  s_nop 1
  v_max_u32_dpp v20, v20, v20 row_mirror row_mask:0xf bank_mask:0xf
  v_mov_b32 v24, v20
  s_nop 1
  v_permlane16_swap_b32 v20, v24
  v_max_u32 v20, v20, v24
  v_mov_b32 v24, v20
  s_nop 1
  v_permlane32_swap_b32 v20, v24
  v_max_u32 v20, v20, v24
  v_add_u32 v21, v21, v20
  v_cmp_eq_u32 vcc, s23, v23
  v_sub_u32 v232, v232, v20
  v_sub_u32 v233, v233, v20
  v_sub_u32 v234, v234, v20
  v_sub_u32 v235, v235, v20
  v_sub_u32 v236, v236, v20
  v_sub_u32 v237, v237, v20
  v_sub_u32 v238, v238, v20
  v_sub_u32 v239, v239, v20
  v_cndmask_b32 v22, v22, v21, vcc
  s_add_u32 s23, s23, 1
  s_cmp_lt_u32 s23, 8
  s_cbranch_scc1 fa_top
  s_lshl_b32 s23, s20, 5
  s_add_u32 s23, s23, 131072
  v_lshl_add_u32 v24, v23, 2, s23
  ds_write_b32 v24, v22
  s_waitcnt lgkmcnt(0)
  s_barrier
  s_cmp_lg_u32 s20, 0
  s_cbranch_scc1 fa_notop
  v_and_b32 v24, 31, v1
  v_lshlrev_b32 v24, 2, v24
  v_add_u32 v24, 131072, v24
  v_mov_b32 v20, 131072
  ds_read_b32 v22, v24
  ds_read_b128 v[96:99], v20 offset:0
  ds_read_b128 v[100:103], v20 offset:16
  ds_read_b128 v[104:107], v20 offset:32
  ds_read_b128 v[108:111], v20 offset:48
  ds_read_b128 v[112:115], v20 offset:64
  ds_read_b128 v[116:119], v20 offset:80
  ds_read_b128 v[120:123], v20 offset:96
  ds_read_b128 v[124:127], v20 offset:112
  v_mov_b32 v23, 0
  s_waitcnt lgkmcnt(0)
  v_cmp_gt_u32 s[4:5], v96, v22
  v_cmp_gt_u32 s[6:7], v97, v22
  v_cmp_gt_u32 s[76:77], v98, v22
  v_cmp_gt_u32 s[78:79], v99, v22
  v_addc_co_u32 v23, vcc, 0, v23, s[4:5]
  v_addc_co_u32 v23, vcc, 0, v23, s[6:7]
  v_addc_co_u32 v23, vcc, 0, v23, s[76:77]
  v_addc_co_u32 v23, vcc, 0, v23, s[78:79]
  v_cmp_gt_u32 s[4:5], v100, v22
  v_cmp_gt_u32 s[6:7], v101, v22
  v_cmp_gt_u32 s[76:77], v102, v22
  v_cmp_gt_u32 s[78:79], v103, v22
  v_addc_co_u32 v23, vcc, 0, v23, s[4:5]
  v_addc_co_u32 v23, vcc, 0, v23, s[6:7]
  v_addc_co_u32 v23, vcc, 0, v23, s[76:77]
  v_addc_co_u32 v23, vcc, 0, v23, s[78:79]
  v_cmp_gt_u32 s[4:5], v104, v22
  v_cmp_gt_u32 s[6:7], v105, v22
  v_cmp_gt_u32 s[76:77], v106, v22
  v_cmp_gt_u32 s[78:79], v107, v22
  v_addc_co_u32 v23, vcc, 0, v23, s[4:5]
  v_addc_co_u32 v23, vcc, 0, v23, s[6:7]
  v_addc_co_u32 v23, vcc, 0, v23, s[76:77]
  v_addc_co_u32 v23, vcc, 0, v23, s[78:79]
  v_cmp_gt_u32 s[4:5], v108, v22
  v_cmp_gt_u32 s[6:7], v109, v22
  v_cmp_gt_u32 s[76:77], v110, v22
  v_cmp_gt_u32 s[78:79], v111, v22
  v_addc_co_u32 v23, vcc, 0, v23, s[4:5]
  v_addc_co_u32 v23, vcc, 0, v23, s[6:7]
  v_addc_co_u32 v23, vcc, 0, v23, s[76:77]
  v_addc_co_u32 v23, vcc, 0, v23, s[78:79]
  v_cmp_gt_u32 s[4:5], v112, v22
  v_cmp_gt_u32 s[6:7], v113, v22
  v_cmp_gt_u32 s[76:77], v114, v22
  v_cmp_gt_u32 s[78:79], v115, v22
  v_addc_co_u32 v23, vcc, 0, v23, s[4:5]
  v_addc_co_u32 v23, vcc, 0, v23, s[6:7]
  v_addc_co_u32 v23, vcc, 0, v23, s[76:77]
  v_addc_co_u32 v23, vcc, 0, v23, s[78:79]
  v_cmp_gt_u32 s[4:5], v116, v22
  v_cmp_gt_u32 s[6:7], v117, v22
  v_cmp_gt_u32 s[76:77], v118, v22
  v_cmp_gt_u32 s[78:79], v119, v22
  v_addc_co_u32 v23, vcc, 0, v23, s[4:5]
  v_addc_co_u32 v23, vcc, 0, v23, s[6:7]
  v_addc_co_u32 v23, vcc, 0, v23, s[76:77]
  v_addc_co_u32 v23, vcc, 0, v23, s[78:79]
  v_cmp_gt_u32 s[4:5], v120, v22
  v_cmp_gt_u32 s[6:7], v121, v22
  v_cmp_gt_u32 s[76:77], v122, v22
  v_cmp_gt_u32 s[78:79], v123, v22
  v_addc_co_u32 v23, vcc, 0, v23, s[4:5]
  v_addc_co_u32 v23, vcc, 0, v23, s[6:7]
  v_addc_co_u32 v23, vcc, 0, v23, s[76:77]
  v_addc_co_u32 v23, vcc, 0, v23, s[78:79]
  v_cmp_gt_u32 s[4:5], v124, v22
  v_cmp_gt_u32 s[6:7], v125, v22
  v_cmp_gt_u32 s[76:77], v126, v22
  v_cmp_gt_u32 s[78:79], v127, v22
  v_addc_co_u32 v23, vcc, 0, v23, s[4:5]
  v_addc_co_u32 v23, vcc, 0, v23, s[6:7]
  v_addc_co_u32 v23, vcc, 0, v23, s[76:77]
  v_addc_co_u32 v23, vcc, 0, v23, s[78:79]
  v_and_b32 v25, 0xffff, v22
  v_sub_u32 v25, 0xffff, v25
  v_and_b32 v25, 2047, v25
  v_ashrrev_i32 v20, 31, v22
  v_not_b32 v20, v20
  v_or_b32 v20, 0x80000000, v20
  v_xor_b32 v26, v22, v20
  v_and_b32 v26, 0xffff0000, v26
  v_mul_f32 v26, 0xbfb8aa3b, v26
  v_exp_f32 v26, v26
  s_nop 0
  v_add_f32 v26, 1.0, v26
  v_rcp_f32 v26, v26
  s_nop 0
  v_cvt_pk_bf16_f32 v26, v26, v26
  v_and_b32 v26, 0xffff0000, v26
  v_and_b32 v20, 32, v1
  v_lshl_add_u32 v20, v23, 2, v20
  v_add_u32 v20, 2629632, v20
  v_mov_b32 v21, 1073741824
  v_cmp_gt_u32 vcc, 8, v23
  v_add_u32 v25, 1, v25
  v_or_b32 v26, 1, v26
  v_cndmask_b32 v20, v21, v20, vcc
  v_cmp_gt_u32 vcc, 32, v1
  s_nop 1
  v_cndmask_b32 v26, v26, v25, vcc
  buffer_store_dword v26, v20, s[40:43], 0 offen sc1
  s_branch fa_notop
fa_hk4:
  s_getpc_b64 s[38:39]
fa_hp4:
  s_add_u32 s36, s36, 4
  s_addc_u32 s37, s37, 0
  s_sub_u32 s38, s38, fa_hp4-fa_hb4
  s_subb_u32 s39, s39, 0
  s_setpc_b64 s[36:37]
fa_hk5:
  s_getpc_b64 s[38:39]
fa_hp5:
  s_add_u32 s36, s36, 4
  s_addc_u32 s37, s37, 0
  s_sub_u32 s38, s38, fa_hp5-fa_hb5
  s_subb_u32 s39, s39, 0
  s_setpc_b64 s[36:37]
fa_hk6:
  s_getpc_b64 s[38:39]
fa_hp6:
  s_add_u32 s36, s36, 4
  s_addc_u32 s37, s37, 0
  s_add_u32 s38, s38, fa_hb6-fa_hp6
  s_addc_u32 s39, s39, 0
  s_setpc_b64 s[36:37]
fa_DDF:
  v_mfma_f32_16x16x32_bf16 v[96:99], a[128:131], v[32:35], v[192:195]
  s_waitcnt vmcnt(4)
  v_exp_f32 v218, v146
  v_mfma_f32_16x16x32_bf16 v[104:107], a[128:131], v[36:39], v[196:199]
  s_barrier
  v_exp_f32 v219, v147
  v_mfma_f32_16x16x32_bf16 v[128:131], a[128:131], v[64:67], v[200:203]
  s_cmp_ge_u32 s26, s32
  ds_read_b128 a[160:163], v3 offset:16384
  v_exp_f32 v220, v148
  v_mfma_f32_16x16x32_bf16 v[136:139], a[128:131], v[68:71], v[204:207]
  s_cbranch_scc1 fa_hk6
fa_hb6:
  ds_read_b64_tr_b16 a[192:193], v9 offset:0
  v_add_f32 v226, v216, v217
  v_mfma_f32_16x16x32_bf16 v[100:103], a[132:135], v[32:35], v[192:195]
  ds_read_b128 a[164:167], v3 offset:17408
  ds_read_b64_tr_b16 a[194:195], v9 offset:128
  v_cvt_pk_bf16_f32 v184, v216, v217
  v_mfma_f32_16x16x32_bf16 v[108:111], a[132:135], v[36:39], v[196:199]
  s_mov_b32 m0, s24
  ds_read_b128 a[212:215], v10 offset:0
  ds_read_b64_tr_b16 a[196:197], v9 offset:1024
  v_add_f32 v226, v226, v218
  v_mfma_f32_16x16x32_bf16 v[132:135], a[132:135], v[64:67], v[200:203]
  buffer_load_dwordx4 v2, s[44:47], s26 offen offset:0 sc1 lds
  v_add_f32 v226, v226, v219
  v_mfma_f32_16x16x32_bf16 v[140:143], a[132:135], v[68:71], v[204:207]
  ds_read_b64_tr_b16 a[198:199], v9 offset:1152
  ds_read_b128 a[216:219], v10 offset:512
  v_cvt_pk_bf16_f32 v185, v218, v219
  v_mfma_f32_16x16x32_bf16 v[96:99], a[136:139], v[40:43], v[96:99]
  ds_read_b128 a[168:171], v3 offset:18432
  ds_read_b64_tr_b16 a[200:201], v9 offset:2048
  v_add_f32 v226, v226, v220
  v_exp_f32 v221, v149
  v_mfma_f32_16x16x32_bf16 v[104:107], a[136:139], v[44:47], v[104:107]
  ds_read_b64_tr_b16 a[202:203], v9 offset:2176
  ds_read_b128 a[220:223], v10 offset:1024
  v_add_f32 v226, v226, v221
  v_mfma_f32_16x16x32_bf16 v[128:131], a[136:139], v[72:75], v[128:131]
  ds_read_b64_tr_b16 a[204:205], v9 offset:3072
  ds_read_b64_tr_b16 a[206:207], v9 offset:3200
  v_cvt_pk_bf16_f32 v186, v220, v221
  v_mfma_f32_16x16x32_bf16 v[136:139], a[136:139], v[76:79], v[136:139]
  ds_read_b128 a[224:227], v10 offset:1536
  ds_read_b64_tr_b16 a[208:209], v9 offset:4096
  v_mfma_f32_16x16x32_bf16 v[100:103], a[140:143], v[40:43], v[100:103]
  ds_read_b128 a[172:175], v3 offset:19456
  v_mfma_f32_16x16x32_bf16 v[108:111], a[140:143], v[44:47], v[108:111]
  buffer_load_dwordx4 v2, s[44:47], s26 offen offset:1024 sc1 lds
  v_mfma_f32_16x16x32_bf16 v[132:135], a[140:143], v[72:75], v[132:135]
  ds_read_b64_tr_b16 a[210:211], v9 offset:4224
  ds_read_b128 a[228:231], v10 offset:2048
  v_mfma_f32_16x16x32_bf16 v[140:143], a[140:143], v[76:79], v[140:143]
  s_waitcnt lgkmcnt(4)
  v_exp_f32 v222, v150
  v_mfma_f32_16x16x32_bf16 v[96:99], a[144:147], v[48:51], v[96:99]
  ds_read_b128 a[176:179], v3 offset:20480
  v_add_f32 v226, v226, v222
  v_mfma_f32_16x16x32_bf16 v[104:107], a[144:147], v[52:55], v[104:107]
  v_exp_f32 v223, v151
  v_mfma_f32_16x16x32_bf16 v[128:131], a[144:147], v[80:83], v[128:131]
  v_exp_f32 v216, v152
  v_add_u32 v10, 2560, v10
  v_mfma_f32_16x16x32_bf16 v[136:139], a[144:147], v[84:87], v[136:139]
  buffer_load_dwordx4 v2, s[44:47], s26 offen offset:2048 sc1 lds
  v_add_f32 v226, v226, v223
  v_mfma_f32_16x16x32_bf16 v[100:103], a[148:151], v[48:51], v[100:103]
  ds_read_b128 a[180:183], v3 offset:21504
  v_cvt_pk_bf16_f32 v187, v222, v223
  v_and_b32 v232, s4, v232
  v_mfma_f32_16x16x32_bf16 v[108:111], a[148:151], v[52:55], v[108:111]
  v_exp_f32 v217, v153
  v_and_b32 v233, s4, v233
  v_mfma_f32_16x16x32_bf16 v[132:135], a[148:151], v[80:83], v[132:135]
  v_exp_f32 v218, v154
  v_and_b32 v234, s4, v234
  v_mfma_f32_16x16x32_bf16 v[140:143], a[148:151], v[84:87], v[140:143]
  v_exp_f32 v219, v155
  v_and_b32 v235, s4, v235
  v_mfma_f32_16x16x32_bf16 v[96:99], a[152:155], v[56:59], v[96:99]
  ds_read_b128 a[184:187], v3 offset:22528
  v_add_f32 v227, v216, v217
  v_cvt_pk_bf16_f32 v188, v216, v217
  v_add_f32 v227, v227, v218
  v_add_f32 v227, v227, v219
  v_mfma_f32_16x16x32_bf16 v[104:107], a[152:155], v[60:63], v[104:107]
  buffer_load_dwordx4 v2, s[44:47], s26 offen offset:3072 sc1 lds
  v_cvt_pk_bf16_f32 v189, v218, v219
  v_mfma_f32_16x16x32_bf16 v[128:131], a[152:155], v[88:91], v[128:131]
  s_add_u32 s26, s26, 16384
  v_exp_f32 v220, v156
  v_mfma_f32_16x16x32_bf16 v[136:139], a[152:155], v[92:95], v[136:139]
  s_add_u32 s24, s24, 32768
  v_exp_f32 v221, v157
  v_mfma_f32_16x16x32_bf16 v[100:103], a[156:159], v[56:59], v[100:103]
  s_and_b32 s24, s24, 0x1ffff
  ds_read_b128 a[188:191], v3 offset:23552
  v_add_f32 v227, v227, v220
  v_add_f32 v227, v227, v221
  v_mfma_f32_16x16x32_bf16 v[108:111], a[156:159], v[60:63], v[108:111]
  v_exp_f32 v222, v158
  v_mfma_f32_16x16x32_bf16 v[132:135], a[156:159], v[88:91], v[132:135]
  s_add_u32 m0, s34, 0
  v_exp_f32 v223, v159
  v_mfma_f32_16x16x32_bf16 v[140:143], a[156:159], v[92:95], v[140:143]
  s_waitcnt lgkmcnt(4)
  buffer_load_dwordx4 v8, s[52:55], s33 offen offset:0 lds
  v_cvt_pk_bf16_f32 v190, v220, v221
  v_add_f32 v227, v227, v222
  v_add_f32 v227, v227, v223
  v_mfma_f32_16x16x32_bf16 a[0:3], a[160:163], v[160:163], a[0:3]
  ds_read_b128 a[128:131], v3 offset:0
  v_cvt_pk_bf16_f32 v191, v222, v223
  v_mfma_f32_16x16x32_bf16 a[4:7], a[160:163], v[164:167], a[4:7]
  s_mov_b32 s4, s5
  v_exp_f32 v208, v112
  v_mfma_f32_16x16x32_bf16 a[64:67], a[160:163], v[176:179], a[64:67]
  s_mov_b32 s5, -1
  v_exp_f32 v209, v113
  v_mfma_f32_16x16x32_bf16 v[232:235], a[192:195], a[212:215], v[232:235]
  v_mfma_f32_16x16x32_bf16 a[68:71], a[160:163], v[180:183], a[68:71]
  v_exp_f32 v210, v114
  v_mfma_f32_16x16x32_bf16 a[8:11], a[164:167], v[160:163], a[8:11]
  ds_read_b128 a[132:135], v3 offset:1024
  v_add_f32 v224, v208, v209
  v_cvt_pk_bf16_f32 v168, v208, v209
  v_mfma_f32_16x16x32_bf16 a[12:15], a[164:167], v[164:167], a[12:15]
  buffer_load_dwordx4 v11, s[52:55], s33 offen offset:1024 lds
  v_add_f32 v224, v224, v210
  v_mfma_f32_16x16x32_bf16 a[72:75], a[164:167], v[176:179], a[72:75]
  v_exp_f32 v211, v115
  v_mfma_f32_16x16x32_bf16 a[76:79], a[164:167], v[180:183], a[76:79]
  v_exp_f32 v212, v116
  v_mfma_f32_16x16x32_bf16 v[232:235], a[196:199], a[216:219], v[232:235]
  v_mfma_f32_16x16x32_bf16 a[16:19], a[168:171], v[160:163], a[16:19]
  ds_read_b128 a[136:139], v3 offset:2048
  v_add_f32 v224, v224, v211
  v_cvt_pk_bf16_f32 v169, v210, v211
  v_mfma_f32_16x16x32_bf16 a[20:23], a[168:171], v[164:167], a[20:23]
  v_exp_f32 v213, v117
  v_mfma_f32_16x16x32_bf16 a[80:83], a[168:171], v[176:179], a[80:83]
  v_exp_f32 v214, v118
  v_mfma_f32_16x16x32_bf16 a[84:87], a[168:171], v[180:183], a[84:87]
  buffer_load_dwordx4 v12, s[52:55], s33 offen offset:2048 lds
  v_add_f32 v224, v224, v212
  v_add_f32 v224, v224, v213
  v_cvt_pk_bf16_f32 v170, v212, v213
  v_mfma_f32_16x16x32_bf16 a[24:27], a[172:175], v[160:163], a[24:27]
  ds_read_b128 a[140:143], v3 offset:3072
  v_add_f32 v224, v224, v214
  v_mfma_f32_16x16x32_bf16 v[232:235], a[200:203], a[220:223], v[232:235]
  v_mfma_f32_16x16x32_bf16 a[28:31], a[172:175], v[164:167], a[28:31]
  v_exp_f32 v215, v119
  v_mfma_f32_16x16x32_bf16 a[88:91], a[172:175], v[176:179], a[88:91]
  v_exp_f32 v208, v120
  v_mfma_f32_16x16x32_bf16 a[92:95], a[172:175], v[180:183], a[92:95]
  s_waitcnt lgkmcnt(4)
  v_exp_f32 v209, v121
  v_mfma_f32_16x16x32_bf16 a[32:35], a[176:179], v[160:163], a[32:35]
  ds_read_b128 a[144:147], v3 offset:4096
  v_add_f32 v224, v224, v215
  v_cvt_pk_bf16_f32 v171, v214, v215
  v_add_f32 v225, v208, v209
  v_mfma_f32_16x16x32_bf16 a[36:39], a[176:179], v[164:167], a[36:39]
  buffer_load_dwordx4 v13, s[52:55], s33 offen offset:3072 lds
  v_cvt_pk_bf16_f32 v172, v208, v209
  v_mfma_f32_16x16x32_bf16 v[232:235], a[204:207], a[224:227], v[232:235]
  v_mfma_f32_16x16x32_bf16 a[96:99], a[176:179], v[176:179], a[96:99]
  v_exp_f32 v210, v122
  v_mfma_f32_16x16x32_bf16 a[100:103], a[176:179], v[180:183], a[100:103]
  v_exp_f32 v211, v123
  v_mfma_f32_16x16x32_bf16 a[40:43], a[180:183], v[160:163], a[40:43]
  ds_read_b128 a[148:151], v3 offset:5120
  v_add_f32 v225, v225, v210
  v_add_f32 v225, v225, v211
  v_mfma_f32_16x16x32_bf16 a[44:47], a[180:183], v[164:167], a[44:47]
  v_exp_f32 v212, v124
  v_mfma_f32_16x16x32_bf16 a[104:107], a[180:183], v[176:179], a[104:107]
  s_add_u32 m0, s34, 4096
  v_exp_f32 v213, v125
  v_mfma_f32_16x16x32_bf16 v[232:235], a[208:211], a[228:231], v[232:235]
  v_mfma_f32_16x16x32_bf16 a[108:111], a[180:183], v[180:183], a[108:111]
  buffer_load_dwordx4 v14, s[52:55], s33 offen offset:0 lds
  v_cvt_pk_bf16_f32 v173, v210, v211
  v_max3_f32 v5, v226, v227, v224
  v_mfma_f32_16x16x32_bf16 a[48:51], a[184:187], v[160:163], a[48:51]
  ds_read_b128 a[152:155], v3 offset:6144
  v_add_f32 v225, v225, v212
  v_mfma_f32_16x16x32_bf16 a[52:55], a[184:187], v[164:167], a[52:55]
  s_add_u32 s33, s33, s6
  v_exp_f32 v214, v126
  v_mfma_f32_16x16x32_bf16 a[112:115], a[184:187], v[176:179], a[112:115]
  v_exp_f32 v215, v127
  v_mfma_f32_16x16x32_bf16 a[116:119], a[184:187], v[180:183], a[116:119]
  v_add_f32 v225, v225, v213
  v_cvt_pk_bf16_f32 v174, v212, v213
  v_add_f32 v225, v225, v214
  v_mfma_f32_16x16x32_bf16 a[56:59], a[188:191], v[160:163], a[56:59]
  ds_read_b128 a[156:159], v3 offset:7168
  v_add_f32 v225, v225, v215
  v_max_f32 v5, v5, v225
  v_cmp_lt_f32 vcc, s81, v5
  v_mfma_f32_16x16x32_bf16 a[60:63], a[188:191], v[164:167], a[60:63]
  v_exp_f32 v216, v128
  v_mfma_f32_16x16x32_bf16 a[120:123], a[188:191], v[176:179], a[120:123]
  s_waitcnt lgkmcnt(4)
  v_cvt_pk_bf16_f32 v175, v214, v215
  v_mfma_f32_16x16x32_bf16 a[124:127], a[188:191], v[180:183], a[124:127]
  s_cbranch_vccnz fa_stub3
fa_back3:
  v_exp_f32 v217, v129
  v_add_f32 v228, v228, v224
  v_add_f32 v229, v229, v225
  v_add_f32 v230, v230, v226
  v_add_f32 v231, v231, v227
  s_branch fa_DDe
fa_kv2_spin:
  s_mov_b32 s83, 200000
fa_kv2_spin2:
  buffer_load_dword v14, v13, s[40:43], 0 offen sc1
  s_waitcnt vmcnt(0)
  v_cmp_eq_u32 vcc, 0, v14
  s_cbranch_vccz fa_kv2_ok
  s_sleep 8
  s_sub_u32 s83, s83, 1
  s_cmp_lg_u32 s83, 0
  s_cbranch_scc1 fa_kv2_spin2
  s_branch fa_kv2_ok
fa_kv3_spin:
  s_mov_b32 s83, 200000
fa_kv3_spin2:
  buffer_load_dword v14, v13, s[40:43], 0 offen sc1
  s_waitcnt vmcnt(0)
  v_cmp_eq_u32 vcc, 0, v14
  s_cbranch_vccz fa_kv3_ok
  s_sleep 8
  s_sub_u32 s83, s83, 1
  s_cmp_lg_u32 s83, 0
  s_cbranch_scc1 fa_kv3_spin2
  s_branch fa_kv3_ok
fa_sel_spin:
  s_mov_b32 s83, 200000
fa_sel_spin2:
  buffer_load_dword v15, v252, s[40:43], 0 offen sc1
  s_waitcnt vmcnt(0)
  v_cmp_eq_u32 vcc, 0, v15
  s_cbranch_vccz fa_sel_ok
  s_sleep 8
  s_sub_u32 s83, s83, 1
  s_cmp_lg_u32 s83, 0
  s_cbranch_scc1 fa_sel_spin2
  s_branch fa_sel_ok
fa_wof_spin:
  s_mov_b32 s83, 200000
fa_wof_spin2:
  buffer_load_dword v8, v9, s[40:43], 0 offen sc1
  s_waitcnt vmcnt(0)
  v_cmp_eq_u32 vcc, 0, v8
  s_cbranch_vccz fa_wof_ok
  s_sleep 8
  s_sub_u32 s83, s83, 1
  s_cmp_lg_u32 s83, 0
  s_cbranch_scc1 fa_wof_spin2
  s_branch fa_wof_ok
fa_sel4_spin:
  s_mov_b32 s83, 200000
fa_sel4_spin2:
  buffer_load_dword v15, v10, s[40:43], 0 offen sc1
  s_waitcnt vmcnt(0)
  v_cmp_eq_u32 vcc, 0, v15
  s_cbranch_vccz fa_sel4_ok
  s_sleep 8
  s_sub_u32 s83, s83, 1
  s_cmp_lg_u32 s83, 0
  s_cbranch_scc1 fa_sel4_spin2
  s_branch fa_sel4_ok
fa_yf_spin:
  s_mov_b32 s83, 200000
fa_yf_spin2:
  buffer_load_dword v14, v11, s[40:43], 0 offen sc1
  s_waitcnt vmcnt(0)
  v_cmp_eq_u32 vcc, 0, v14
  s_cbranch_vccz fa_yf_ok
  s_sleep 8
  s_sub_u32 s83, s83, 1
  s_cmp_lg_u32 s83, 0
  s_cbranch_scc1 fa_yf_spin2
  s_branch fa_yf_ok
fa_co:
  s_sub_u32 s14, s2, 64
  s_cmp_lt_u32 s14, 96
  s_cbranch_scc1 fa_coT
  s_sub_u32 s14, s2, 128
  s_sub_u32 s23, s2, 224
  s_cmp_lt_u32 s23, 31
  s_cbranch_scc1 fa_coT
  v_cmp_eq_u32 vcc, 0, v14
  s_cbranch_vccnz fa_kv2_spin
fa_kv2_ok:
  s_sub_u32 s14, s2, 170
  s_cmp_lt_u32 s14, 54
  s_cbranch_scc1 fa_coF
  s_cmp_eq_u32 s2, 255
  s_cbranch_scc1 fa_coW
  s_cmp_lt_u32 s2, 32
  s_cbranch_scc1 fa_coW
  s_branch fa_coO
fa_coT:
  v_min_u32 v8, 16, v1
  v_lshlrev_b32 v8, 7, v8
  s_lshl_b32 s10, s14, 1
  s_and_b32 s31, s20, 1
  s_add_u32 s10, s10, s31
  s_mul_i32 s10, s10, 2176
  s_lshl_b32 s35, s14, 2
  s_add_u32 s35, s35, s20
  s_mul_i32 s35, s35, 4352
  buffer_load_dword v255, v8, s[52:55], s10 offen
  s_add_u32 s10, s10, 552960
  s_getpc_b64 s[36:37]
  s_setpc_b64 s[38:39]
  buffer_load_dword v255, v8, s[52:55], s10 offen
  s_add_u32 s10, s10, 552960
  s_getpc_b64 s[36:37]
  s_setpc_b64 s[38:39]
  v_cmp_eq_u32 vcc, 0, v14
  s_cbranch_vccnz fa_kv3_spin
fa_kv3_ok:
  buffer_load_dword v255, v8, s[52:55], s10 offen
  s_add_u32 s10, s10, 552960
  buffer_load_dword v255, v8, s[60:63], s35 offen offset:0
  s_getpc_b64 s[36:37]
  s_setpc_b64 s[38:39]
  buffer_load_dword v255, v8, s[52:55], s10 offen
  s_add_u32 s10, s10, 552960
  buffer_load_dword v255, v8, s[60:63], s35 offen offset:2176
  s_mov_b32 s9, -1
  s_and_b32 s32, s21, 3
  s_lshr_b32 s32, s32, 1
  s_add_u32 s32, s32, 6
  s_lshl_b32 s32, s32, 14
  s_getpc_b64 s[36:37]
  s_setpc_b64 s[38:39]
fa_coO:
  s_and_b32 s23, s67, 1
  s_lshl_b32 s23, s23, 2
  s_add_u32 s23, s23, s20
  s_lshr_b32 s31, s67, 1
  s_mul_i32 s33, s23, 0
  s_add_u32 s33, s33, s31
  s_and_b32 s33, s33, 31
  s_andn2_b32 s30, s31, 31
  s_add_u32 s33, s33, s30
  s_lshl_b32 s30, s23, 7
  s_add_u32 s30, s30, s33
  s_mul_i32 s33, s31, 40960
  s_mul_i32 s23, s23, 160
  s_add_u32 s33, s33, s23
  s_add_u32 m0, s34, 0
  v_accvgpr_read_b32 v19, a248
  buffer_load_dwordx4 v19, s[56:59], s33 offen lds
  s_add_u32 m0, s34, 1024
  v_accvgpr_read_b32 v19, a249
  buffer_load_dwordx4 v19, s[56:59], s33 offen lds
  s_add_u32 m0, s34, 2048
  v_accvgpr_read_b32 v19, a250
  buffer_load_dwordx4 v19, s[56:59], s33 offen lds
  s_add_u32 m0, s34, 3072
  v_accvgpr_read_b32 v19, a251
  buffer_load_dwordx4 v19, s[56:59], s33 offen lds
  s_add_u32 m0, s34, 4096
  v_accvgpr_read_b32 v19, a252
  buffer_load_dwordx4 v19, s[56:59], s33 offen lds
  s_lshl_b32 s32, s11, 15
  s_add_u32 s32, s32, s26
  s_mov_b32 s9, -1
  s_lshl_b32 s10, s30, 2
  s_mul_i32 s30, s30, 5120
  s_add_u32 s30, s30, 4194304
  s_getpc_b64 s[36:37]
  s_setpc_b64 s[38:39]
  s_waitcnt vmcnt(8)
  ds_read_b64_tr_b16 v[232:233], v6 offset:0
  ds_read_b64_tr_b16 v[234:235], v6 offset:2560
  ds_read_b64_tr_b16 v[236:237], v6 offset:32
  ds_read_b64_tr_b16 v[238:239], v6 offset:2592
  ds_read_b64_tr_b16 v[240:241], v6 offset:64
  ds_read_b64_tr_b16 v[242:243], v6 offset:2624
  ds_read_b64_tr_b16 v[244:245], v6 offset:96
  ds_read_b64_tr_b16 v[246:247], v6 offset:2656
  ds_read_b64_tr_b16 v[248:249], v6 offset:128
  ds_read_b64_tr_b16 v[250:251], v6 offset:2688
  s_waitcnt lgkmcnt(0)
  s_add_u32 s31, s30, 4096
  buffer_store_dwordx4 v[232:235], v2, s[40:43], s30 offen offset:0 sc1
  buffer_store_dwordx4 v[236:239], v2, s[40:43], s30 offen offset:1024 sc1
  buffer_store_dwordx4 v[240:243], v2, s[40:43], s30 offen offset:2048 sc1
  buffer_store_dwordx4 v[244:247], v2, s[40:43], s30 offen offset:3072 sc1
  buffer_store_dwordx4 v[248:251], v2, s[40:43], s31 offen offset:0 sc1
  s_getpc_b64 s[36:37]
  s_setpc_b64 s[38:39]
  s_add_u32 s23, s10, 2654208
  s_waitcnt vmcnt(8)
  buffer_store_dword v4, off, s[40:43], s23 sc1
  s_cmp_lg_u32 s67, s2
  s_cbranch_scc1 fa_coW
  s_sub_u32 s67, s2, 128
  s_cmp_lt_u32 s67, 32
  s_cbranch_scc1 fa_coO
  s_sub_u32 s23, s2, 96
  s_sub_u32 s31, s2, 192
  s_cmp_lt_u32 s23, 32
  s_cselect_b32 s23, s23, s31
  s_cmp_gt_u32 s23, 54
  s_cbranch_scc1 fa_coW
  s_add_u32 s67, s23, 170
  s_cmp_eq_u32 s67, 224
  s_cselect_b32 s67, 255, s67
  s_branch fa_coO
fa_coF:
  v_and_b32 v16, 7, v1
  v_lshlrev_b32 v252, 2, v16
  v_add_u32 v252, 2629632, v252
  buffer_load_dword v15, v252, s[40:43], 0 offen sc1
  s_lshl_b32 s33, s14, 6
  s_and_b32 s31, s20, 1
  s_lshl_b32 s31, s31, 5
  s_add_u32 s33, s33, s31
  s_mul_i32 s35, s14, 40960
  s_mul_i32 s31, s20, 320
  s_add_u32 s35, s35, s31
  s_mul_i32 s10, s14, 20480
  s_mul_i32 s31, s20, 5120
  s_add_u32 s10, s10, s31
  s_add_u32 s10, s10, 2686976
  v_lshrrev_b32 v17, 1, v1
  v_mul_u32_u24 v8, 3456, v17
  v_and_b32 v17, 1, v1
  v_lshl_add_u32 v8, v17, 4, v8
  v_add_u32 v11, 109568, v8
  v_add_u32 v12, 219136, v8
  v_add_u32 v13, 328704, v8
  v_add_u32 v14, 442368, v8
  v_lshrrev_b32 v17, 4, v1
  v_lshrrev_b32 v18, 2, v1
  v_lshl_add_u32 v18, v17, 2, v18
  v_lshlrev_b32 v18, 5, v18
  v_and_b32 v19, 3, v1
  v_lshl_add_u32 v9, v19, 3, v18
  v_add_u32 v9, s34, v9
  v_lshlrev_b32 v10, 4, v16
  v_lshl_add_u32 v10, v17, 7, v10
  v_add_u32 v10, 148992, v10
  s_mov_b32 s8, -1
  s_mov_b32 s4, 0
  s_mov_b32 s5, 0
  s_mov_b32 s6, 552960
  s_getpc_b64 s[36:37]
  s_setpc_b64 s[38:39]
  s_waitcnt vmcnt(8)
  v_cmp_eq_u32 vcc, 0, v15
  s_cbranch_vccnz fa_sel_spin
fa_sel_ok:
  v_add_u32 v18, -1, v15
  v_and_b32 v18, 2047, v18
  v_lshrrev_b32 v19, 4, v18
  v_mul_u32_u24 v19, 20480, v19
  v_and_b32 v18, 15, v18
  v_lshl_add_u32 v19, v18, 4, v19
  v_lshrrev_b32 v18, 3, v1
  v_lshl_add_u32 v19, v18, 8, v19
  s_lshl_b32 s23, s20, 11
  s_lshl_b32 s31, s20, 10
  s_add_u32 s31, s31, 151552
  s_mov_b32 s32, 163840
  s_mov_b32 m0, s31
  s_add_u32 s31, s31, 4096
  buffer_load_dwordx4 v19, s[40:43], s23 offen sc1 lds
  s_add_u32 s23, s23, 8192
  s_mov_b32 m0, s31
  s_add_u32 s31, s31, 4096
  buffer_load_dwordx4 v19, s[40:43], s23 offen sc1 lds
  s_add_u32 s23, s23, 8192
  s_mov_b32 m0, s31
  s_add_u32 s31, s31, 4096
  buffer_load_dwordx4 v19, s[40:43], s23 offen sc1 lds
  s_add_u32 s23, s23, 8192
  s_getpc_b64 s[36:37]
  s_setpc_b64 s[38:39]
  v_accvgpr_read_b32 v8, a248
  v_accvgpr_read_b32 v11, a249
  v_accvgpr_read_b32 v12, a250
  v_accvgpr_read_b32 v13, a251
  v_accvgpr_read_b32 v14, a252
  v_subrev_u32 v11, 1024, v11
  v_subrev_u32 v12, 2048, v12
  v_subrev_u32 v13, 3072, v13
  s_mov_b32 s52, s60
  s_mov_b32 s53, s61
  s_mov_b32 s33, s35
  s_movk_i32 s6, 160
  s_mov_b32 s9, 0
  v_and_b32 v17, 7, v1
  v_lshlrev_b32 v15, 6, v17
  v_lshrrev_b32 v17, 4, v1
  v_lshl_add_u32 v15, v17, 4, v15
  v_and_b32 v17, 8, v1
  v_lshl_add_u32 v15, v17, 27, v15
  s_getpc_b64 s[36:37]
  s_setpc_b64 s[38:39]
  s_lshl_b32 s23, s20, 9
  v_add_u32 v16, s23, v10
  s_mov_b32 s9, -1
  ds_write_b128 v16, v[232:235]
  s_getpc_b64 s[36:37]
  s_setpc_b64 s[38:39]
  ds_read_b128 v[236:239], v10 offset:0
  ds_read_b128 v[240:243], v10 offset:512
  ds_read_b128 v[244:247], v10 offset:1024
  ds_read_b128 v[248:251], v10 offset:1536
  s_waitcnt vmcnt(4)
  ds_read_b64_tr_b16 a[192:193], v6 offset:0
  ds_read_b64_tr_b16 a[194:195], v6 offset:2560
  ds_read_b64_tr_b16 a[196:197], v6 offset:32
  ds_read_b64_tr_b16 a[198:199], v6 offset:2592
  ds_read_b64_tr_b16 a[200:201], v6 offset:64
  ds_read_b64_tr_b16 a[202:203], v6 offset:2624
  ds_read_b64_tr_b16 a[204:205], v6 offset:96
  ds_read_b64_tr_b16 a[206:207], v6 offset:2656
  ds_read_b64_tr_b16 a[208:209], v6 offset:128
  ds_read_b64_tr_b16 a[210:211], v6 offset:2688
  v_subrev_u32 v10, 10240, v10
  s_mov_b32 s8, 0
  s_waitcnt lgkmcnt(10)
  v_cvt_pk_bf16_f32 v236, v236, v244
  v_cvt_pk_bf16_f32 v237, v237, v245
  v_cvt_pk_bf16_f32 v238, v238, v246
  v_cvt_pk_bf16_f32 v239, v239, v247
  v_cvt_pk_bf16_f32 v240, v240, v248
  v_cvt_pk_bf16_f32 v241, v241, v249
  v_cvt_pk_bf16_f32 v242, v242, v250
  v_cvt_pk_bf16_f32 v243, v243, v251
  v_lshlrev_b32 v244, 16, v236
  v_lshlrev_b32 v245, 16, v237
  v_lshlrev_b32 v246, 16, v238
  v_lshlrev_b32 v247, 16, v239
  v_lshlrev_b32 v248, 16, v240
  v_lshlrev_b32 v249, 16, v241
  v_lshlrev_b32 v250, 16, v242
  v_lshlrev_b32 v251, 16, v243
  v_mul_f32 v16, 0xbfb8aa3b, v244
  v_mul_f32 v17, 0xbfb8aa3b, v245
  v_mul_f32 v18, 0xbfb8aa3b, v246
  v_mul_f32 v19, 0xbfb8aa3b, v247
  v_mul_f32 v20, 0xbfb8aa3b, v248
  v_mul_f32 v21, 0xbfb8aa3b, v249
  v_mul_f32 v22, 0xbfb8aa3b, v250
  v_mul_f32 v23, 0xbfb8aa3b, v251
  v_exp_f32 v16, v16
  v_exp_f32 v17, v17
  v_exp_f32 v18, v18
  v_exp_f32 v19, v19
  v_exp_f32 v20, v20
  v_exp_f32 v21, v21
  v_exp_f32 v22, v22
  v_exp_f32 v23, v23
  v_add_f32 v16, 1.0, v16
  v_add_f32 v17, 1.0, v17
  v_add_f32 v18, 1.0, v18
  v_add_f32 v19, 1.0, v19
  v_add_f32 v20, 1.0, v20
  v_add_f32 v21, 1.0, v21
  v_add_f32 v22, 1.0, v22
  v_add_f32 v23, 1.0, v23
  v_rcp_f32 v16, v16
  v_rcp_f32 v17, v17
  v_rcp_f32 v18, v18
  v_rcp_f32 v19, v19
  v_rcp_f32 v20, v20
  v_rcp_f32 v21, v21
  v_rcp_f32 v22, v22
  v_rcp_f32 v23, v23
  v_and_b32 v236, 0xffff0000, v236
  v_and_b32 v237, 0xffff0000, v237
  v_and_b32 v238, 0xffff0000, v238
  v_and_b32 v239, 0xffff0000, v239
  v_and_b32 v240, 0xffff0000, v240
  v_and_b32 v241, 0xffff0000, v241
  v_and_b32 v242, 0xffff0000, v242
  v_and_b32 v243, 0xffff0000, v243
  v_pk_mul_f32 v[244:245], v[244:245], v[16:17]
  v_pk_mul_f32 v[246:247], v[246:247], v[18:19]
  v_pk_mul_f32 v[248:249], v[248:249], v[20:21]
  v_pk_mul_f32 v[250:251], v[250:251], v[22:23]
  v_cvt_pk_bf16_f32 v16, v244, v245
  v_cvt_pk_bf16_f32 v17, v246, v247
  v_cvt_pk_bf16_f32 v18, v248, v249
  v_cvt_pk_bf16_f32 v19, v250, v251
  v_lshlrev_b32 v244, 16, v16
  v_and_b32 v245, 0xffff0000, v16
  v_lshlrev_b32 v246, 16, v17
  v_and_b32 v247, 0xffff0000, v17
  v_lshlrev_b32 v248, 16, v18
  v_and_b32 v249, 0xffff0000, v18
  v_lshlrev_b32 v250, 16, v19
  v_and_b32 v251, 0xffff0000, v19
  v_pk_mul_f32 v[236:237], v[236:237], v[244:245]
  v_pk_mul_f32 v[238:239], v[238:239], v[246:247]
  v_pk_mul_f32 v[240:241], v[240:241], v[248:249]
  v_pk_mul_f32 v[242:243], v[242:243], v[250:251]
  v_cvt_pk_bf16_f32 v16, v236, v237
  v_cvt_pk_bf16_f32 v17, v238, v239
  v_cvt_pk_bf16_f32 v18, v240, v241
  v_cvt_pk_bf16_f32 v19, v242, v243
  v_accvgpr_write_b32 a232, v16
  v_accvgpr_write_b32 a233, v17
  v_accvgpr_write_b32 a234, v18
  v_accvgpr_write_b32 a235, v19
  s_nop 0
  s_waitcnt lgkmcnt(0)
  v_mfma_f32_16x16x32_bf16 v[236:239], a[192:195], a[232:235], 0
  v_mfma_f32_16x16x32_bf16 v[240:243], a[196:199], a[232:235], 0
  v_mfma_f32_16x16x32_bf16 v[244:247], a[200:203], a[232:235], 0
  v_mfma_f32_16x16x32_bf16 v[248:251], a[204:207], a[232:235], 0
  v_mfma_f32_16x16x32_bf16 v[252:255], a[208:211], a[232:235], 0
  s_nop 3
  buffer_store_dwordx4 v[236:239], v15, s[40:43], s10 offen offset:0 sc1
  buffer_store_dwordx4 v[240:243], v15, s[40:43], s10 offen offset:512 sc1
  buffer_store_dwordx4 v[244:247], v15, s[40:43], s10 offen offset:1024 sc1
  buffer_store_dwordx4 v[248:251], v15, s[40:43], s10 offen offset:1536 sc1
  buffer_store_dwordx4 v[252:255], v15, s[40:43], s10 offen offset:2048 sc1
  s_add_u32 s10, s10, 2560
  s_getpc_b64 s[36:37]
  s_setpc_b64 s[38:39]
  s_waitcnt vmcnt(4)
  ds_read_b64_tr_b16 a[192:193], v6 offset:0
  ds_read_b64_tr_b16 a[194:195], v6 offset:2560
  ds_read_b64_tr_b16 a[196:197], v6 offset:32
  ds_read_b64_tr_b16 a[198:199], v6 offset:2592
  ds_read_b64_tr_b16 a[200:201], v6 offset:64
  ds_read_b64_tr_b16 a[202:203], v6 offset:2624
  ds_read_b64_tr_b16 a[204:205], v6 offset:96
  ds_read_b64_tr_b16 a[206:207], v6 offset:2656
  ds_read_b64_tr_b16 a[208:209], v6 offset:128
  ds_read_b64_tr_b16 a[210:211], v6 offset:2688
  s_waitcnt lgkmcnt(0)
  v_mfma_f32_16x16x32_bf16 v[236:239], a[192:195], a[232:235], 0
  v_mfma_f32_16x16x32_bf16 v[240:243], a[196:199], a[232:235], 0
  v_mfma_f32_16x16x32_bf16 v[244:247], a[200:203], a[232:235], 0
  v_mfma_f32_16x16x32_bf16 v[248:251], a[204:207], a[232:235], 0
  v_mfma_f32_16x16x32_bf16 v[252:255], a[208:211], a[232:235], 0
  s_nop 3
  buffer_store_dwordx4 v[236:239], v15, s[40:43], s10 offen offset:0 sc1
  buffer_store_dwordx4 v[240:243], v15, s[40:43], s10 offen offset:512 sc1
  buffer_store_dwordx4 v[244:247], v15, s[40:43], s10 offen offset:1024 sc1
  buffer_store_dwordx4 v[248:251], v15, s[40:43], s10 offen offset:1536 sc1
  buffer_store_dwordx4 v[252:255], v15, s[40:43], s10 offen offset:2048 sc1
  s_add_u32 s10, s10, 2560
  s_getpc_b64 s[36:37]
  s_setpc_b64 s[38:39]
  s_sub_u32 s23, s2, 170
  s_lshl_b32 s31, s20, 6
  s_add_u32 s23, s23, s31
  s_lshl_b32 s23, s23, 2
  s_add_u32 s23, s23, 2650112
  s_waitcnt vmcnt(8)
  buffer_store_dword v4, off, s[40:43], s23 sc1
fa_coW:
  s_mov_b32 s12, 1
  s_mov_b32 s9, -1
  s_cmp_lg_u32 s11, 0
  s_cselect_b32 s32, s15, -1
  s_getpc_b64 s[36:37]
  s_setpc_b64 s[38:39]
  s_lshl_b32 s23, s22, 2
  s_add_u32 s23, s23, s20
  s_mul_i32 s13, s23, 163840
  s_add_u32 s13, s13, 4194304
  s_lshl_b32 s23, s23, 7
  s_add_u32 s23, s23, 2654208
  v_and_b32 v9, 31, v1
  v_lshl_add_u32 v9, v9, 2, s23
  v_and_b32 v10, 15, v1
  v_lshlrev_b32 v10, 2, v10
  v_add_u32 v10, 2629632, v10
  buffer_load_dword v8, v9, s[40:43], 0 offen sc1
  buffer_load_dword v15, v10, s[40:43], 0 offen sc1
  v_mov_b32 v20, v228
  v_mov_b32 v21, v229
  s_nop 1
  v_permlane16_swap_b32 v228, v20
  v_permlane16_swap_b32 v229, v21
  v_add_f32 v228, v228, v20
  v_add_f32 v229, v229, v21
  v_mov_b32 v20, v228
  v_mov_b32 v21, v229
  s_nop 1
  v_permlane32_swap_b32 v228, v20
  v_permlane32_swap_b32 v229, v21
  v_add_f32 v228, v228, v20
  v_add_f32 v229, v229, v21
  v_rcp_f32 v16, v228
  v_rcp_f32 v18, v229
  s_lshl_b32 s23, s22, 2
  v_mov_b32 v17, v16
  v_mov_b32 v19, v18
  s_add_u32 s23, s23, s20
  s_lshl_b32 s23, s23, 18
  s_lshl_b32 s31, s21, 12
  s_add_u32 s31, s31, 50331648
  s_add_u32 s64, s23, s31
  s_add_u32 s65, s64, 131072
  v_accvgpr_read_b32 v36, a0
  v_accvgpr_read_b32 v37, a1
  v_accvgpr_read_b32 v38, a2
  v_accvgpr_read_b32 v39, a3
  v_accvgpr_read_b32 v40, a8
  v_accvgpr_read_b32 v41, a9
  v_accvgpr_read_b32 v42, a10
  v_accvgpr_read_b32 v43, a11
  v_pk_mul_f32 v[36:37], v[36:37], v[16:17]
  v_pk_mul_f32 v[38:39], v[38:39], v[16:17]
  v_pk_mul_f32 v[40:41], v[40:41], v[16:17]
  v_pk_mul_f32 v[42:43], v[42:43], v[16:17]
  v_cvt_pk_bf16_f32 v32, v36, v37
  v_cvt_pk_bf16_f32 v33, v38, v39
  v_cvt_pk_bf16_f32 v34, v40, v41
  v_cvt_pk_bf16_f32 v35, v42, v43
  buffer_store_dwordx4 v[32:35], v2, s[40:43], s64 offen offset:0 sc1
  v_accvgpr_read_b32 v48, a16
  v_accvgpr_read_b32 v49, a17
  v_accvgpr_read_b32 v50, a18
  v_accvgpr_read_b32 v51, a19
  v_accvgpr_read_b32 v52, a24
  v_accvgpr_read_b32 v53, a25
  v_accvgpr_read_b32 v54, a26
  v_accvgpr_read_b32 v55, a27
  v_pk_mul_f32 v[48:49], v[48:49], v[16:17]
  v_pk_mul_f32 v[50:51], v[50:51], v[16:17]
  v_pk_mul_f32 v[52:53], v[52:53], v[16:17]
  v_pk_mul_f32 v[54:55], v[54:55], v[16:17]
  v_cvt_pk_bf16_f32 v44, v48, v49
  v_cvt_pk_bf16_f32 v45, v50, v51
  v_cvt_pk_bf16_f32 v46, v52, v53
  v_cvt_pk_bf16_f32 v47, v54, v55
  buffer_store_dwordx4 v[44:47], v2, s[40:43], s64 offen offset:1024 sc1
  v_accvgpr_read_b32 v100, a32
  v_accvgpr_read_b32 v101, a33
  v_accvgpr_read_b32 v102, a34
  v_accvgpr_read_b32 v103, a35
  v_accvgpr_read_b32 v104, a40
  v_accvgpr_read_b32 v105, a41
  v_accvgpr_read_b32 v106, a42
  v_accvgpr_read_b32 v107, a43
  v_pk_mul_f32 v[100:101], v[100:101], v[16:17]
  v_pk_mul_f32 v[102:103], v[102:103], v[16:17]
  v_pk_mul_f32 v[104:105], v[104:105], v[16:17]
  v_pk_mul_f32 v[106:107], v[106:107], v[16:17]
  v_cvt_pk_bf16_f32 v96, v100, v101
  v_cvt_pk_bf16_f32 v97, v102, v103
  v_cvt_pk_bf16_f32 v98, v104, v105
  v_cvt_pk_bf16_f32 v99, v106, v107
  buffer_store_dwordx4 v[96:99], v2, s[40:43], s64 offen offset:2048 sc1
  v_accvgpr_read_b32 v112, a48
  v_accvgpr_read_b32 v113, a49
  v_accvgpr_read_b32 v114, a50
  v_accvgpr_read_b32 v115, a51
  v_accvgpr_read_b32 v116, a56
  v_accvgpr_read_b32 v117, a57
  v_accvgpr_read_b32 v118, a58
  v_accvgpr_read_b32 v119, a59
  v_pk_mul_f32 v[112:113], v[112:113], v[16:17]
  v_pk_mul_f32 v[114:115], v[114:115], v[16:17]
  v_pk_mul_f32 v[116:117], v[116:117], v[16:17]
  v_pk_mul_f32 v[118:119], v[118:119], v[16:17]
  v_cvt_pk_bf16_f32 v108, v112, v113
  v_cvt_pk_bf16_f32 v109, v114, v115
  v_cvt_pk_bf16_f32 v110, v116, v117
  v_cvt_pk_bf16_f32 v111, v118, v119
  buffer_store_dwordx4 v[108:111], v2, s[40:43], s64 offen offset:3072 sc1
  v_accvgpr_read_b32 v36, a4
  v_accvgpr_read_b32 v37, a5
  v_accvgpr_read_b32 v38, a6
  v_accvgpr_read_b32 v39, a7
  v_accvgpr_read_b32 v40, a12
  v_accvgpr_read_b32 v41, a13
  v_accvgpr_read_b32 v42, a14
  v_accvgpr_read_b32 v43, a15
  v_pk_mul_f32 v[36:37], v[36:37], v[18:19]
  v_pk_mul_f32 v[38:39], v[38:39], v[18:19]
  v_pk_mul_f32 v[40:41], v[40:41], v[18:19]
  v_pk_mul_f32 v[42:43], v[42:43], v[18:19]
  v_cvt_pk_bf16_f32 v32, v36, v37
  v_cvt_pk_bf16_f32 v33, v38, v39
  v_cvt_pk_bf16_f32 v34, v40, v41
  v_cvt_pk_bf16_f32 v35, v42, v43
  buffer_store_dwordx4 v[32:35], v2, s[40:43], s65 offen offset:0 sc1
  v_accvgpr_read_b32 v48, a20
  v_accvgpr_read_b32 v49, a21
  v_accvgpr_read_b32 v50, a22
  v_accvgpr_read_b32 v51, a23
  v_accvgpr_read_b32 v52, a28
  v_accvgpr_read_b32 v53, a29
  v_accvgpr_read_b32 v54, a30
  v_accvgpr_read_b32 v55, a31
  v_pk_mul_f32 v[48:49], v[48:49], v[18:19]
  v_pk_mul_f32 v[50:51], v[50:51], v[18:19]
  v_pk_mul_f32 v[52:53], v[52:53], v[18:19]
  v_pk_mul_f32 v[54:55], v[54:55], v[18:19]
  v_cvt_pk_bf16_f32 v44, v48, v49
  v_cvt_pk_bf16_f32 v45, v50, v51
  v_cvt_pk_bf16_f32 v46, v52, v53
  v_cvt_pk_bf16_f32 v47, v54, v55
  buffer_store_dwordx4 v[44:47], v2, s[40:43], s65 offen offset:1024 sc1
  v_accvgpr_read_b32 v100, a36
  v_accvgpr_read_b32 v101, a37
  v_accvgpr_read_b32 v102, a38
  v_accvgpr_read_b32 v103, a39
  v_accvgpr_read_b32 v104, a44
  v_accvgpr_read_b32 v105, a45
  v_accvgpr_read_b32 v106, a46
  v_accvgpr_read_b32 v107, a47
  v_pk_mul_f32 v[100:101], v[100:101], v[18:19]
  v_pk_mul_f32 v[102:103], v[102:103], v[18:19]
  v_pk_mul_f32 v[104:105], v[104:105], v[18:19]
  v_pk_mul_f32 v[106:107], v[106:107], v[18:19]
  v_cvt_pk_bf16_f32 v96, v100, v101
  v_cvt_pk_bf16_f32 v97, v102, v103
  v_cvt_pk_bf16_f32 v98, v104, v105
  v_cvt_pk_bf16_f32 v99, v106, v107
  buffer_store_dwordx4 v[96:99], v2, s[40:43], s65 offen offset:2048 sc1
  v_accvgpr_read_b32 v112, a52
  v_accvgpr_read_b32 v113, a53
  v_accvgpr_read_b32 v114, a54
  v_accvgpr_read_b32 v115, a55
  v_accvgpr_read_b32 v116, a60
  v_accvgpr_read_b32 v117, a61
  v_accvgpr_read_b32 v118, a62
  v_accvgpr_read_b32 v119, a63
  v_pk_mul_f32 v[112:113], v[112:113], v[18:19]
  v_pk_mul_f32 v[114:115], v[114:115], v[18:19]
  v_pk_mul_f32 v[116:117], v[116:117], v[18:19]
  v_pk_mul_f32 v[118:119], v[118:119], v[18:19]
  v_cvt_pk_bf16_f32 v108, v112, v113
  v_cvt_pk_bf16_f32 v109, v114, v115
  v_cvt_pk_bf16_f32 v110, v116, v117
  v_cvt_pk_bf16_f32 v111, v118, v119
  buffer_store_dwordx4 v[108:111], v2, s[40:43], s65 offen offset:3072 sc1
  s_mov_b32 s28, s46
  s_add_u32 s30, s28, 65536
  s_lshl_b32 s23, s20, 12
  s_add_u32 s23, s23, s28
  s_add_u32 s31, s13, 98304
  s_sub_u32 s31, s31, s23
  s_add_u32 s4, s18, s31
  s_addc_u32 s5, s19, 0
  s_add_u32 s6, s4, 4096
  s_addc_u32 s7, s5, 0
  s_waitcnt vmcnt(8)
  v_cmp_eq_u32 vcc, 0, v8
  s_cbranch_vccnz fa_wof_spin
fa_wof_ok:
  v_cmp_eq_u32 vcc, 0, v15
  s_cbranch_vccnz fa_sel4_spin
fa_sel4_ok:
  s_lshl_b32 s31, s21, 6
  s_add_u32 s31, s31, 1
  v_subrev_u32 v16, s31, v15
  v_cmp_gt_u32 vcc, 64, v16
  s_cmp_lt_u32 s20, 2
  s_cselect_b32 s23, 0xff, 0
  s_and_b32 s10, vcc_lo, s23
  s_sub_u32 s23, s10, 1
  s_and_b32 s23, s23, s10
  s_cmp_eq_u32 s20, 1
  s_cselect_b32 s10, s23, s10
  s_cmp_eq_u32 s10, 0
  s_cbranch_scc1 fa_coEnd
  v_min_u32 v11, 53, v1
  s_lshr_b32 s23, s22, 1
  s_lshl_b32 s23, s23, 8
  s_add_u32 s23, s23, 2650112
  v_lshl_add_u32 v11, v11, 2, s23
  buffer_load_dword v14, v11, s[40:43], 0 offen sc1
  v_mul_u32_u24 v16, 3277, v1
  v_lshrrev_b32 v16, 16, v16
  v_mul_u32_u24 v8, 20, v16
  v_sub_u32 v8, v1, v8
  v_lshlrev_b32 v8, 4, v8
  v_mul_u32_u24 v9, 368640, v16
  v_lshrrev_b32 v17, 6, v8
  v_mul_u32_u24 v17, 448, v17
  v_add3_u32 v9, v9, v8, v17
  v_cmp_gt_u32 vcc, 3, v16
  v_mov_b32 v19, 1073741824
  s_nop 0
  v_cndmask_b32 v9, v19, v9, vcc
  s_mov_b32 s12, 2
  s_mov_b32 s32, -1
  s_mov_b32 s11, 0
  s_getpc_b64 s[36:37]
  s_setpc_b64 s[38:39]
  v_cmp_eq_u32 vcc, 0, v14
  s_cbranch_vccnz fa_yf_spin
fa_yf_ok:
fa_coY:
  s_ff1_i32_b32 s33, s10
  s_bitset0_b32 s10, s33
  s_sub_u32 s23, s10, 1
  s_and_b32 s10, s10, s23
  s_lshl_b32 s14, s33, 6
  s_mul_i32 s23, s22, 2560
  s_add_u32 s14, s14, s23
  s_add_u32 s14, s14, 2686976
  buffer_load_dwordx4 v[64:67], v9, s[40:43], s14 offen sc1
  s_add_u32 s14, s14, 20480
  buffer_load_dwordx4 v[68:71], v9, s[40:43], s14 offen sc1
  s_add_u32 s14, s14, 20480
  buffer_load_dwordx4 v[72:75], v9, s[40:43], s14 offen sc1
  s_add_u32 s14, s14, 20480
  buffer_load_dwordx4 v[76:79], v9, s[40:43], s14 offen sc1
  s_add_u32 s14, s14, 20480
  buffer_load_dwordx4 v[80:83], v9, s[40:43], s14 offen sc1
  s_add_u32 s14, s14, 20480
  buffer_load_dwordx4 v[84:87], v9, s[40:43], s14 offen sc1
  s_add_u32 s14, s14, 20480
  buffer_load_dwordx4 v[88:91], v9, s[40:43], s14 offen sc1
  s_add_u32 s14, s14, 20480
  buffer_load_dwordx4 v[92:95], v9, s[40:43], s14 offen sc1
  s_add_u32 s14, s14, 20480
  buffer_load_dwordx4 v[128:131], v9, s[40:43], s14 offen sc1
  s_add_u32 s14, s14, 20480
  buffer_load_dwordx4 v[132:135], v9, s[40:43], s14 offen sc1
  s_add_u32 s14, s14, 20480
  buffer_load_dwordx4 v[136:139], v9, s[40:43], s14 offen sc1
  s_add_u32 s14, s14, 20480
  buffer_load_dwordx4 v[140:143], v9, s[40:43], s14 offen sc1
  s_add_u32 s14, s14, 20480
  buffer_load_dwordx4 v[144:147], v9, s[40:43], s14 offen sc1
  s_add_u32 s14, s14, 20480
  buffer_load_dwordx4 v[148:151], v9, s[40:43], s14 offen sc1
  s_add_u32 s14, s14, 20480
  buffer_load_dwordx4 v[152:155], v9, s[40:43], s14 offen sc1
  s_add_u32 s14, s14, 20480
  buffer_load_dwordx4 v[156:159], v9, s[40:43], s14 offen sc1
  s_add_u32 s14, s14, 20480
  buffer_load_dwordx4 v[176:179], v9, s[40:43], s14 offen sc1
  s_add_u32 s14, s14, 20480
  buffer_load_dwordx4 v[180:183], v9, s[40:43], s14 offen sc1
  s_add_u32 s14, s14, 20480
  s_lshl_b32 s14, s20, 10
  s_add_u32 s14, s14, 159744
  v_add_u32 v19, s14, v2
  s_add_u32 s23, s33, 8
  v_readlane_b32 s35, v15, s23
  s_waitcnt vmcnt(0)
  v_pk_add_f32 v[64:65], v[64:65], v[68:69]
  v_pk_add_f32 v[66:67], v[66:67], v[70:71]
  v_pk_add_f32 v[64:65], v[64:65], v[72:73]
  v_pk_add_f32 v[66:67], v[66:67], v[74:75]
  v_pk_add_f32 v[64:65], v[64:65], v[76:77]
  v_pk_add_f32 v[66:67], v[66:67], v[78:79]
  v_pk_add_f32 v[64:65], v[64:65], v[80:81]
  v_pk_add_f32 v[66:67], v[66:67], v[82:83]
  v_pk_add_f32 v[64:65], v[64:65], v[84:85]
  v_pk_add_f32 v[66:67], v[66:67], v[86:87]
  v_pk_add_f32 v[64:65], v[64:65], v[88:89]
  v_pk_add_f32 v[66:67], v[66:67], v[90:91]
  v_pk_add_f32 v[64:65], v[64:65], v[92:93]
  v_pk_add_f32 v[66:67], v[66:67], v[94:95]
  v_pk_add_f32 v[64:65], v[64:65], v[128:129]
  v_pk_add_f32 v[66:67], v[66:67], v[130:131]
  v_pk_add_f32 v[64:65], v[64:65], v[132:133]
  v_pk_add_f32 v[66:67], v[66:67], v[134:135]
  v_pk_add_f32 v[64:65], v[64:65], v[136:137]
  v_pk_add_f32 v[66:67], v[66:67], v[138:139]
  v_pk_add_f32 v[64:65], v[64:65], v[140:141]
  v_pk_add_f32 v[66:67], v[66:67], v[142:143]
  v_pk_add_f32 v[64:65], v[64:65], v[144:145]
  v_pk_add_f32 v[66:67], v[66:67], v[146:147]
  v_pk_add_f32 v[64:65], v[64:65], v[148:149]
  v_pk_add_f32 v[66:67], v[66:67], v[150:151]
  v_pk_add_f32 v[64:65], v[64:65], v[152:153]
  v_pk_add_f32 v[66:67], v[66:67], v[154:155]
  v_pk_add_f32 v[64:65], v[64:65], v[156:157]
  v_pk_add_f32 v[66:67], v[66:67], v[158:159]
  v_pk_add_f32 v[64:65], v[64:65], v[176:177]
  v_pk_add_f32 v[66:67], v[66:67], v[178:179]
  v_pk_add_f32 v[64:65], v[64:65], v[180:181]
  v_pk_add_f32 v[66:67], v[66:67], v[182:183]
  ds_write_b128 v19, v[64:67]
  v_add_u32 v19, s14, v8
  s_and_b32 s35, s35, 0xffff0000
  s_waitcnt lgkmcnt(0)
  ds_read_b128 v[64:67], v19
  ds_read_b128 v[68:71], v19 offset:320
  ds_read_b128 v[72:75], v19 offset:640
  s_mul_i32 s14, s33, 320
  s_add_u32 s14, s14, 155648
  v_add_u32 v19, s14, v8
  s_waitcnt lgkmcnt(0)
  v_add_f32 v64, v64, v68
  v_add_f32 v64, v64, v72
  v_cvt_pk_bf16_f32 v64, v64, v64
  v_and_b32 v64, 0xffff0000, v64
  v_mul_f32 v64, s35, v64
  v_cvt_pk_bf16_f32 v64, v64, v64
  v_and_b32 v64, 0xffff0000, v64
  v_add_f32 v65, v65, v69
  v_add_f32 v65, v65, v73
  v_cvt_pk_bf16_f32 v65, v65, v65
  v_and_b32 v65, 0xffff0000, v65
  v_mul_f32 v65, s35, v65
  v_cvt_pk_bf16_f32 v65, v65, v65
  v_and_b32 v65, 0xffff0000, v65
  v_add_f32 v66, v66, v70
  v_add_f32 v66, v66, v74
  v_cvt_pk_bf16_f32 v66, v66, v66
  v_and_b32 v66, 0xffff0000, v66
  v_mul_f32 v66, s35, v66
  v_cvt_pk_bf16_f32 v66, v66, v66
  v_and_b32 v66, 0xffff0000, v66
  v_add_f32 v67, v67, v71
  v_add_f32 v67, v67, v75
  v_cvt_pk_bf16_f32 v67, v67, v67
  v_and_b32 v67, 0xffff0000, v67
  v_mul_f32 v67, s35, v67
  v_cvt_pk_bf16_f32 v67, v67, v67
  v_and_b32 v67, 0xffff0000, v67
  ds_write_b128 v19, v[64:67]
  s_waitcnt lgkmcnt(0)
  s_cmp_lg_u32 s10, 0
  s_cbranch_scc1 fa_coY
fa_coEnd:
  s_mov_b32 s12, 3
  s_mov_b32 s32, -1
  s_setpc_b64 s[38:39]
fa_hk7:
  s_getpc_b64 s[38:39]
fa_hp7:
  s_add_u32 s36, s36, 4
  s_addc_u32 s37, s37, 0
  s_sub_u32 s38, s38, fa_hp7-fa_hb7
  s_subb_u32 s39, s39, 0
  s_setpc_b64 s[36:37]
fa_hk8:
  s_getpc_b64 s[38:39]
fa_hp8:
  s_add_u32 s36, s36, 4
  s_addc_u32 s37, s37, 0
  s_sub_u32 s38, s38, fa_hp8-fa_hb8
  s_subb_u32 s39, s39, 0
  s_setpc_b64 s[36:37]
fa_disp:
  s_cmp_eq_u32 s29, 7
  s_cbranch_scc1 fa_SSW7
  s_cmp_eq_u32 s29, 6
  s_cbranch_scc1 fa_SSW6
  s_cmp_eq_u32 s29, 5
  s_cbranch_scc1 fa_SSW5
  s_cmp_eq_u32 s29, 4
  s_cbranch_scc1 fa_SSW4
  s_cmp_eq_u32 s29, 3
  s_cbranch_scc1 fa_SSW3
  s_cmp_eq_u32 s29, 2
  s_cbranch_scc1 fa_SSW2
  s_cmp_eq_u32 s29, 1
  s_cbranch_scc1 fa_SSW1
  s_branch fa_Bexit
fa_hk9:
  s_getpc_b64 s[38:39]
fa_hp9:
  s_add_u32 s36, s36, 4
  s_addc_u32 s37, s37, 0
  s_add_u32 s38, s38, fa_hb9-fa_hp9
  s_addc_u32 s39, s39, 0
  s_setpc_b64 s[36:37]
fa_puby:
  s_waitcnt vmcnt(0)
  buffer_store_dword v4, v30, s[40:43], 0 offen sc1
  s_cmp_lt_u32 s12, 3
  s_cbranch_scc1 fa_hk9
fa_hb9:
  s_add_u32 s14, s13, 61440
  buffer_load_dwordx4 v[64:67], v2, s[40:43], s14 offen offset:0 sc1
  buffer_load_dwordx4 v[68:71], v2, s[40:43], s14 offen offset:1024 sc1
  buffer_load_dwordx4 v[72:75], v2, s[40:43], s14 offen offset:2048 sc1
  buffer_load_dwordx4 v[76:79], v2, s[40:43], s14 offen offset:3072 sc1
  s_branch fa_pubb
fa_left:
  s_add_u32 s14, s13, 0
  buffer_load_dwordx4 a[192:195], v2, s[40:43], s14 offen offset:0 sc1
  buffer_load_dwordx4 a[196:199], v2, s[40:43], s14 offen offset:1024 sc1
  buffer_load_dwordx4 a[200:203], v2, s[40:43], s14 offen offset:2048 sc1
  s_cmp_ge_u32 s29, 7
  s_cbranch_scc1 fa_leftb
  s_add_u32 s14, s13, 0
  buffer_load_dwordx4 a[204:207], v2, s[40:43], s14 offen offset:3072 sc1
  s_add_u32 s14, s13, 4096
  buffer_load_dwordx4 a[208:211], v2, s[40:43], s14 offen offset:0 sc1
  buffer_load_dwordx4 a[212:215], v2, s[40:43], s14 offen offset:1024 sc1
  s_cmp_ge_u32 s29, 6
  s_cbranch_scc1 fa_leftb
  s_add_u32 s14, s13, 4096
  buffer_load_dwordx4 a[216:219], v2, s[40:43], s14 offen offset:2048 sc1
  buffer_load_dwordx4 a[220:223], v2, s[40:43], s14 offen offset:3072 sc1
  s_add_u32 s14, s13, 8192
  buffer_load_dwordx4 a[224:227], v2, s[40:43], s14 offen offset:0 sc1
  buffer_load_dwordx4 a[228:231], v2, s[40:43], s14 offen offset:1024 sc1
  s_cmp_ge_u32 s29, 5
  s_cbranch_scc1 fa_leftb
  s_add_u32 s14, s13, 8192
  buffer_load_dwordx4 a[232:235], v2, s[40:43], s14 offen offset:2048 sc1
  buffer_load_dwordx4 a[236:239], v2, s[40:43], s14 offen offset:3072 sc1
  s_add_u32 s14, s13, 12288
  buffer_load_dwordx4 a[240:243], v2, s[40:43], s14 offen offset:0 sc1
  buffer_load_dwordx4 a[244:247], v2, s[40:43], s14 offen offset:1024 sc1
  buffer_load_dwordx4 a[248:251], v2, s[40:43], s14 offen offset:2048 sc1
  buffer_load_dwordx4 a[252:255], v2, s[40:43], s14 offen offset:3072 sc1
fa_left4:
  s_cmp_ge_u32 s29, 4
  s_cbranch_scc1 fa_leftb
  s_add_u32 s14, s13, 16384
  buffer_load_dwordx4 a[0:3], v2, s[40:43], s14 offen offset:0 sc1
  buffer_load_dwordx4 a[4:7], v2, s[40:43], s14 offen offset:1024 sc1
  buffer_load_dwordx4 a[8:11], v2, s[40:43], s14 offen offset:2048 sc1
  buffer_load_dwordx4 a[12:15], v2, s[40:43], s14 offen offset:3072 sc1
  s_add_u32 s14, s13, 20480
  buffer_load_dwordx4 a[16:19], v2, s[40:43], s14 offen offset:0 sc1
  buffer_load_dwordx4 a[20:23], v2, s[40:43], s14 offen offset:1024 sc1
  buffer_load_dwordx4 a[24:27], v2, s[40:43], s14 offen offset:2048 sc1
  buffer_load_dwordx4 a[28:31], v2, s[40:43], s14 offen offset:3072 sc1
  s_cmp_ge_u32 s29, 3
  s_cbranch_scc1 fa_leftb
  s_add_u32 s14, s13, 24576
  buffer_load_dwordx4 a[32:35], v2, s[40:43], s14 offen offset:0 sc1
  buffer_load_dwordx4 a[36:39], v2, s[40:43], s14 offen offset:1024 sc1
  buffer_load_dwordx4 a[40:43], v2, s[40:43], s14 offen offset:2048 sc1
  buffer_load_dwordx4 a[44:47], v2, s[40:43], s14 offen offset:3072 sc1
  s_add_u32 s14, s13, 28672
  buffer_load_dwordx4 a[48:51], v2, s[40:43], s14 offen offset:0 sc1
  buffer_load_dwordx4 a[52:55], v2, s[40:43], s14 offen offset:1024 sc1
  buffer_load_dwordx4 a[56:59], v2, s[40:43], s14 offen offset:2048 sc1
  buffer_load_dwordx4 a[60:63], v2, s[40:43], s14 offen offset:3072 sc1
  s_cmp_ge_u32 s29, 2
  s_cbranch_scc1 fa_leftb
  s_add_u32 s14, s13, 32768
  buffer_load_dwordx4 v[32:35], v2, s[40:43], s14 offen offset:0 sc1
  buffer_load_dwordx4 v[36:39], v2, s[40:43], s14 offen offset:1024 sc1
  buffer_load_dwordx4 v[40:43], v2, s[40:43], s14 offen offset:2048 sc1
  buffer_load_dwordx4 v[44:47], v2, s[40:43], s14 offen offset:3072 sc1
  s_add_u32 s14, s13, 36864
  buffer_load_dwordx4 v[48:51], v2, s[40:43], s14 offen offset:0 sc1
  buffer_load_dwordx4 v[52:55], v2, s[40:43], s14 offen offset:1024 sc1
  buffer_load_dwordx4 v[56:59], v2, s[40:43], s14 offen offset:2048 sc1
  buffer_load_dwordx4 v[60:63], v2, s[40:43], s14 offen offset:3072 sc1
  s_cmp_ge_u32 s29, 1
  s_cbranch_scc1 fa_leftb
  s_add_u32 s14, s13, 40960
  buffer_load_dwordx4 v[96:99], v2, s[40:43], s14 offen offset:0 sc1
  buffer_load_dwordx4 v[100:103], v2, s[40:43], s14 offen offset:1024 sc1
  buffer_load_dwordx4 v[104:107], v2, s[40:43], s14 offen offset:2048 sc1
  buffer_load_dwordx4 v[108:111], v2, s[40:43], s14 offen offset:3072 sc1
  s_add_u32 s14, s13, 45056
  buffer_load_dwordx4 v[112:115], v2, s[40:43], s14 offen offset:0 sc1
  buffer_load_dwordx4 v[116:119], v2, s[40:43], s14 offen offset:1024 sc1
  buffer_load_dwordx4 v[120:123], v2, s[40:43], s14 offen offset:2048 sc1
  buffer_load_dwordx4 v[124:127], v2, s[40:43], s14 offen offset:3072 sc1
  s_branch fa_leftb
fa_ctx_spin:
  s_mov_b32 s83, 200000
fa_ctx_spin2:
  buffer_load_dword v13, v12, s[40:43], 0 offen sc1
  s_waitcnt vmcnt(0)
  v_cmp_eq_u32 vcc, 0, v13
  s_cbranch_vccz fa_ctx_ok
  s_sleep 8
  s_sub_u32 s83, s83, 1
  s_cmp_lg_u32 s83, 0
  s_cbranch_scc1 fa_ctx_spin2
  s_branch fa_ctx_ok
fa_stub0:
  s_call_b64 s[76:77], fa_rare00
  s_call_b64 s[76:77], fa_rare10
  s_branch fa_back0
fa_stub1:
  s_call_b64 s[76:77], fa_rare01
  s_call_b64 s[76:77], fa_rare11
  s_branch fa_back1
fa_stub2:
  s_call_b64 s[76:77], fa_rare00
  s_call_b64 s[76:77], fa_rare10
  s_branch fa_back2
fa_stub3:
  s_call_b64 s[76:77], fa_rare01
  s_call_b64 s[76:77], fa_rare11
  s_branch fa_back3
fa_stub4:
  s_call_b64 s[76:77], fa_rare01
  s_call_b64 s[76:77], fa_rare11
  s_branch fa_back4
fa_stub5:
  s_call_b64 s[76:77], fa_rare00
  s_call_b64 s[76:77], fa_rare10
  s_branch fa_back5
fa_stub6:
  s_call_b64 s[76:77], fa_rare11
  s_branch fa_back6
fa_stub7:
  s_call_b64 s[76:77], fa_rare10
  s_branch fa_back7
fa_stub8:
  s_call_b64 s[76:77], fa_rare01
  s_call_b64 s[76:77], fa_rare11
  s_branch fa_back8
fa_stub9:
  s_call_b64 s[76:77], fa_rare10
  s_branch fa_back9
fa_stub10:
  s_call_b64 s[76:77], fa_rare11
  s_branch fa_back10
fa_stub11:
  s_call_b64 s[76:77], fa_rare10
  s_branch fa_back11
fa_stub12:
  s_call_b64 s[76:77], fa_rare11
  s_branch fa_back12
fa_stub13:
  s_call_b64 s[76:77], fa_rare10
  s_branch fa_back13
fa_stub14:
  s_call_b64 s[76:77], fa_rare11
  s_branch fa_back14
fa_stub15:
  s_call_b64 s[76:77], fa_rare10
  s_branch fa_back15
fa_stub16:
  s_call_b64 s[76:77], fa_rare11
  s_branch fa_back16
fa_stub17:
  s_call_b64 s[76:77], fa_rare10
  s_branch fa_back17
fa_stub18:
  s_call_b64 s[76:77], fa_rare11
  s_branch fa_back18
fa_stub19:
  s_call_b64 s[76:77], fa_rare10
  s_branch fa_back19
fa_stub20:
  s_call_b64 s[76:77], fa_rare11
  s_branch fa_back20
fa_stub21:
  s_call_b64 s[76:77], fa_rare10
  s_branch fa_back21
fa_stub22:
  s_call_b64 s[76:77], fa_rare11
  s_branch fa_back22
fa_stub23:
  s_call_b64 s[76:77], fa_rare10
  s_branch fa_back23
fa_stub24:
  s_call_b64 s[76:77], fa_rare11
  s_branch fa_back24
fa_stub25:
  s_call_b64 s[76:77], fa_rare10
  s_branch fa_back25
fa_stub26:
  s_call_b64 s[76:77], fa_rare11
  s_branch fa_back26
fa_stub27:
  s_call_b64 s[76:77], fa_rare10
  s_branch fa_back27
fa_stub28:
  s_call_b64 s[76:77], fa_rare11
  s_branch fa_back28
fa_stub29:
  s_call_b64 s[76:77], fa_rare10
  s_branch fa_back29
fa_stub30:
  s_call_b64 s[76:77], fa_rare11
  s_branch fa_back30
fa_codeend:
fa_rare00:
  s_nop 7
  v_max3_f32 v16, v96, v97, v98
  v_max3_f32 v16, v16, v99, v100
  v_max3_f32 v16, v16, v101, v102
  v_max3_f32 v16, v16, v103, 0
  v_mov_b32 v18, v16
  s_nop 1
  v_permlane16_swap_b32 v16, v18
  v_max_f32 v16, v16, v18
  v_mov_b32 v18, v16
  s_nop 1
  v_permlane32_swap_b32 v16, v18
  v_max_f32 v16, v16, v18
  v_sub_f32 v96, v96, v16
  v_sub_f32 v112, v112, v16
  v_sub_f32 v97, v97, v16
  v_sub_f32 v113, v113, v16
  v_sub_f32 v98, v98, v16
  v_sub_f32 v114, v114, v16
  v_sub_f32 v99, v99, v16
  v_sub_f32 v115, v115, v16
  v_sub_f32 v100, v100, v16
  v_sub_f32 v116, v116, v16
  v_sub_f32 v101, v101, v16
  v_sub_f32 v117, v117, v16
  v_sub_f32 v102, v102, v16
  v_sub_f32 v118, v118, v16
  v_sub_f32 v103, v103, v16
  v_sub_f32 v119, v119, v16
  v_max3_f32 v17, v104, v105, v106
  v_max3_f32 v17, v17, v107, v108
  v_max3_f32 v17, v17, v109, v110
  v_max3_f32 v17, v17, v111, 0
  v_mov_b32 v18, v17
  s_nop 1
  v_permlane16_swap_b32 v17, v18
  v_max_f32 v17, v17, v18
  v_mov_b32 v18, v17
  s_nop 1
  v_permlane32_swap_b32 v17, v18
  v_max_f32 v17, v17, v18
  v_sub_f32 v104, v104, v17
  v_sub_f32 v120, v120, v17
  v_sub_f32 v105, v105, v17
  v_sub_f32 v121, v121, v17
  v_sub_f32 v106, v106, v17
  v_sub_f32 v122, v122, v17
  v_sub_f32 v107, v107, v17
  v_sub_f32 v123, v123, v17
  v_sub_f32 v108, v108, v17
  v_sub_f32 v124, v124, v17
  v_sub_f32 v109, v109, v17
  v_sub_f32 v125, v125, v17
  v_sub_f32 v110, v110, v17
  v_sub_f32 v126, v126, v17
  v_sub_f32 v111, v111, v17
  v_sub_f32 v127, v127, v17
  s_call_b64 s[78:79], fa_resc0
  v_exp_f32 v208, v96
  v_exp_f32 v209, v97
  v_exp_f32 v210, v98
  v_add_f32 v224, v208, v209
  v_cvt_pk_bf16_f32 v160, v208, v209
  v_exp_f32 v211, v99
  v_add_f32 v224, v224, v210
  v_exp_f32 v212, v100
  v_add_f32 v224, v224, v211
  v_cvt_pk_bf16_f32 v161, v210, v211
  v_exp_f32 v213, v101
  v_add_f32 v224, v224, v212
  v_exp_f32 v214, v102
  v_add_f32 v224, v224, v213
  v_cvt_pk_bf16_f32 v162, v212, v213
  v_exp_f32 v215, v103
  v_add_f32 v224, v224, v214
  v_exp_f32 v208, v104
  v_add_f32 v224, v224, v215
  v_cvt_pk_bf16_f32 v163, v214, v215
  v_exp_f32 v209, v105
  v_exp_f32 v210, v106
  v_add_f32 v225, v208, v209
  v_cvt_pk_bf16_f32 v164, v208, v209
  v_exp_f32 v211, v107
  v_add_f32 v225, v225, v210
  v_exp_f32 v212, v108
  v_add_f32 v225, v225, v211
  v_cvt_pk_bf16_f32 v165, v210, v211
  v_exp_f32 v213, v109
  v_add_f32 v225, v225, v212
  v_exp_f32 v214, v110
  v_add_f32 v225, v225, v213
  v_cvt_pk_bf16_f32 v166, v212, v213
  v_exp_f32 v215, v111
  v_add_f32 v225, v225, v214
  s_nop 0
  v_add_f32 v225, v225, v215
  v_cvt_pk_bf16_f32 v167, v214, v215
  s_nop 1
  s_setpc_b64 s[76:77]
fa_rare01:
  s_nop 7
  v_max3_f32 v16, v112, v113, v114
  v_max3_f32 v16, v16, v115, v116
  v_max3_f32 v16, v16, v117, v118
  v_max3_f32 v16, v16, v119, 0
  v_mov_b32 v18, v16
  s_nop 1
  v_permlane16_swap_b32 v16, v18
  v_max_f32 v16, v16, v18
  v_mov_b32 v18, v16
  s_nop 1
  v_permlane32_swap_b32 v16, v18
  v_max_f32 v16, v16, v18
  v_sub_f32 v112, v112, v16
  v_sub_f32 v96, v96, v16
  v_sub_f32 v113, v113, v16
  v_sub_f32 v97, v97, v16
  v_sub_f32 v114, v114, v16
  v_sub_f32 v98, v98, v16
  v_sub_f32 v115, v115, v16
  v_sub_f32 v99, v99, v16
  v_sub_f32 v116, v116, v16
  v_sub_f32 v100, v100, v16
  v_sub_f32 v117, v117, v16
  v_sub_f32 v101, v101, v16
  v_sub_f32 v118, v118, v16
  v_sub_f32 v102, v102, v16
  v_sub_f32 v119, v119, v16
  v_sub_f32 v103, v103, v16
  v_max3_f32 v17, v120, v121, v122
  v_max3_f32 v17, v17, v123, v124
  v_max3_f32 v17, v17, v125, v126
  v_max3_f32 v17, v17, v127, 0
  v_mov_b32 v18, v17
  s_nop 1
  v_permlane16_swap_b32 v17, v18
  v_max_f32 v17, v17, v18
  v_mov_b32 v18, v17
  s_nop 1
  v_permlane32_swap_b32 v17, v18
  v_max_f32 v17, v17, v18
  v_sub_f32 v120, v120, v17
  v_sub_f32 v104, v104, v17
  v_sub_f32 v121, v121, v17
  v_sub_f32 v105, v105, v17
  v_sub_f32 v122, v122, v17
  v_sub_f32 v106, v106, v17
  v_sub_f32 v123, v123, v17
  v_sub_f32 v107, v107, v17
  v_sub_f32 v124, v124, v17
  v_sub_f32 v108, v108, v17
  v_sub_f32 v125, v125, v17
  v_sub_f32 v109, v109, v17
  v_sub_f32 v126, v126, v17
  v_sub_f32 v110, v110, v17
  v_sub_f32 v127, v127, v17
  v_sub_f32 v111, v111, v17
  s_call_b64 s[78:79], fa_resc0
  v_exp_f32 v208, v112
  v_exp_f32 v209, v113
  v_exp_f32 v210, v114
  v_add_f32 v224, v208, v209
  v_cvt_pk_bf16_f32 v168, v208, v209
  v_exp_f32 v211, v115
  v_add_f32 v224, v224, v210
  v_exp_f32 v212, v116
  v_add_f32 v224, v224, v211
  v_cvt_pk_bf16_f32 v169, v210, v211
  v_exp_f32 v213, v117
  v_add_f32 v224, v224, v212
  v_exp_f32 v214, v118
  v_add_f32 v224, v224, v213
  v_cvt_pk_bf16_f32 v170, v212, v213
  v_exp_f32 v215, v119
  v_add_f32 v224, v224, v214
  v_exp_f32 v208, v120
  v_add_f32 v224, v224, v215
  v_cvt_pk_bf16_f32 v171, v214, v215
  v_exp_f32 v209, v121
  v_exp_f32 v210, v122
  v_add_f32 v225, v208, v209
  v_cvt_pk_bf16_f32 v172, v208, v209
  v_exp_f32 v211, v123
  v_add_f32 v225, v225, v210
  v_exp_f32 v212, v124
  v_add_f32 v225, v225, v211
  v_cvt_pk_bf16_f32 v173, v210, v211
  v_exp_f32 v213, v125
  v_add_f32 v225, v225, v212
  v_exp_f32 v214, v126
  v_add_f32 v225, v225, v213
  v_cvt_pk_bf16_f32 v174, v212, v213
  v_exp_f32 v215, v127
  v_add_f32 v225, v225, v214
  s_nop 0
  v_add_f32 v225, v225, v215
  v_cvt_pk_bf16_f32 v175, v214, v215
  s_nop 1
  s_setpc_b64 s[76:77]
fa_resc0:
  v_sub_f32 v192, v192, v16
  v_sub_f32 v193, v193, v16
  v_sub_f32 v194, v194, v16
  v_sub_f32 v195, v195, v16
  v_exp_f32 v18, -v16
  v_sub_f32 v196, v196, v17
  v_sub_f32 v197, v197, v17
  v_sub_f32 v198, v198, v17
  v_sub_f32 v199, v199, v17
  v_exp_f32 v19, -v17
  s_nop 0
  v_mul_f32 v228, v228, v18
  v_mul_f32 v229, v229, v19
  v_accvgpr_read_b32 v20, a0
  v_accvgpr_read_b32 v21, a1
  v_accvgpr_read_b32 v22, a2
  v_accvgpr_read_b32 v23, a3
  v_mul_f32 v20, v20, v18
  v_mul_f32 v21, v21, v18
  v_mul_f32 v22, v22, v18
  v_mul_f32 v23, v23, v18
  v_accvgpr_write_b32 a0, v20
  v_accvgpr_write_b32 a1, v21
  v_accvgpr_write_b32 a2, v22
  v_accvgpr_write_b32 a3, v23
  v_accvgpr_read_b32 v20, a4
  v_accvgpr_read_b32 v21, a5
  v_accvgpr_read_b32 v22, a6
  v_accvgpr_read_b32 v23, a7
  v_mul_f32 v20, v20, v19
  v_mul_f32 v21, v21, v19
  v_mul_f32 v22, v22, v19
  v_mul_f32 v23, v23, v19
  v_accvgpr_write_b32 a4, v20
  v_accvgpr_write_b32 a5, v21
  v_accvgpr_write_b32 a6, v22
  v_accvgpr_write_b32 a7, v23
  v_accvgpr_read_b32 v20, a8
  v_accvgpr_read_b32 v21, a9
  v_accvgpr_read_b32 v22, a10
  v_accvgpr_read_b32 v23, a11
  v_mul_f32 v20, v20, v18
  v_mul_f32 v21, v21, v18
  v_mul_f32 v22, v22, v18
  v_mul_f32 v23, v23, v18
  v_accvgpr_write_b32 a8, v20
  v_accvgpr_write_b32 a9, v21
  v_accvgpr_write_b32 a10, v22
  v_accvgpr_write_b32 a11, v23
  v_accvgpr_read_b32 v20, a12
  v_accvgpr_read_b32 v21, a13
  v_accvgpr_read_b32 v22, a14
  v_accvgpr_read_b32 v23, a15
  v_mul_f32 v20, v20, v19
  v_mul_f32 v21, v21, v19
  v_mul_f32 v22, v22, v19
  v_mul_f32 v23, v23, v19
  v_accvgpr_write_b32 a12, v20
  v_accvgpr_write_b32 a13, v21
  v_accvgpr_write_b32 a14, v22
  v_accvgpr_write_b32 a15, v23
  v_accvgpr_read_b32 v20, a16
  v_accvgpr_read_b32 v21, a17
  v_accvgpr_read_b32 v22, a18
  v_accvgpr_read_b32 v23, a19
  v_mul_f32 v20, v20, v18
  v_mul_f32 v21, v21, v18
  v_mul_f32 v22, v22, v18
  v_mul_f32 v23, v23, v18
  v_accvgpr_write_b32 a16, v20
  v_accvgpr_write_b32 a17, v21
  v_accvgpr_write_b32 a18, v22
  v_accvgpr_write_b32 a19, v23
  v_accvgpr_read_b32 v20, a20
  v_accvgpr_read_b32 v21, a21
  v_accvgpr_read_b32 v22, a22
  v_accvgpr_read_b32 v23, a23
  v_mul_f32 v20, v20, v19
  v_mul_f32 v21, v21, v19
  v_mul_f32 v22, v22, v19
  v_mul_f32 v23, v23, v19
  v_accvgpr_write_b32 a20, v20
  v_accvgpr_write_b32 a21, v21
  v_accvgpr_write_b32 a22, v22
  v_accvgpr_write_b32 a23, v23
  v_accvgpr_read_b32 v20, a24
  v_accvgpr_read_b32 v21, a25
  v_accvgpr_read_b32 v22, a26
  v_accvgpr_read_b32 v23, a27
  v_mul_f32 v20, v20, v18
  v_mul_f32 v21, v21, v18
  v_mul_f32 v22, v22, v18
  v_mul_f32 v23, v23, v18
  v_accvgpr_write_b32 a24, v20
  v_accvgpr_write_b32 a25, v21
  v_accvgpr_write_b32 a26, v22
  v_accvgpr_write_b32 a27, v23
  v_accvgpr_read_b32 v20, a28
  v_accvgpr_read_b32 v21, a29
  v_accvgpr_read_b32 v22, a30
  v_accvgpr_read_b32 v23, a31
  v_mul_f32 v20, v20, v19
  v_mul_f32 v21, v21, v19
  v_mul_f32 v22, v22, v19
  v_mul_f32 v23, v23, v19
  v_accvgpr_write_b32 a28, v20
  v_accvgpr_write_b32 a29, v21
  v_accvgpr_write_b32 a30, v22
  v_accvgpr_write_b32 a31, v23
  v_accvgpr_read_b32 v20, a32
  v_accvgpr_read_b32 v21, a33
  v_accvgpr_read_b32 v22, a34
  v_accvgpr_read_b32 v23, a35
  v_mul_f32 v20, v20, v18
  v_mul_f32 v21, v21, v18
  v_mul_f32 v22, v22, v18
  v_mul_f32 v23, v23, v18
  v_accvgpr_write_b32 a32, v20
  v_accvgpr_write_b32 a33, v21
  v_accvgpr_write_b32 a34, v22
  v_accvgpr_write_b32 a35, v23
  v_accvgpr_read_b32 v20, a36
  v_accvgpr_read_b32 v21, a37
  v_accvgpr_read_b32 v22, a38
  v_accvgpr_read_b32 v23, a39
  v_mul_f32 v20, v20, v19
  v_mul_f32 v21, v21, v19
  v_mul_f32 v22, v22, v19
  v_mul_f32 v23, v23, v19
  v_accvgpr_write_b32 a36, v20
  v_accvgpr_write_b32 a37, v21
  v_accvgpr_write_b32 a38, v22
  v_accvgpr_write_b32 a39, v23
  v_accvgpr_read_b32 v20, a40
  v_accvgpr_read_b32 v21, a41
  v_accvgpr_read_b32 v22, a42
  v_accvgpr_read_b32 v23, a43
  v_mul_f32 v20, v20, v18
  v_mul_f32 v21, v21, v18
  v_mul_f32 v22, v22, v18
  v_mul_f32 v23, v23, v18
  v_accvgpr_write_b32 a40, v20
  v_accvgpr_write_b32 a41, v21
  v_accvgpr_write_b32 a42, v22
  v_accvgpr_write_b32 a43, v23
  v_accvgpr_read_b32 v20, a44
  v_accvgpr_read_b32 v21, a45
  v_accvgpr_read_b32 v22, a46
  v_accvgpr_read_b32 v23, a47
  v_mul_f32 v20, v20, v19
  v_mul_f32 v21, v21, v19
  v_mul_f32 v22, v22, v19
  v_mul_f32 v23, v23, v19
  v_accvgpr_write_b32 a44, v20
  v_accvgpr_write_b32 a45, v21
  v_accvgpr_write_b32 a46, v22
  v_accvgpr_write_b32 a47, v23
  v_accvgpr_read_b32 v20, a48
  v_accvgpr_read_b32 v21, a49
  v_accvgpr_read_b32 v22, a50
  v_accvgpr_read_b32 v23, a51
  v_mul_f32 v20, v20, v18
  v_mul_f32 v21, v21, v18
  v_mul_f32 v22, v22, v18
  v_mul_f32 v23, v23, v18
  v_accvgpr_write_b32 a48, v20
  v_accvgpr_write_b32 a49, v21
  v_accvgpr_write_b32 a50, v22
  v_accvgpr_write_b32 a51, v23
  v_accvgpr_read_b32 v20, a52
  v_accvgpr_read_b32 v21, a53
  v_accvgpr_read_b32 v22, a54
  v_accvgpr_read_b32 v23, a55
  v_mul_f32 v20, v20, v19
  v_mul_f32 v21, v21, v19
  v_mul_f32 v22, v22, v19
  v_mul_f32 v23, v23, v19
  v_accvgpr_write_b32 a52, v20
  v_accvgpr_write_b32 a53, v21
  v_accvgpr_write_b32 a54, v22
  v_accvgpr_write_b32 a55, v23
  v_accvgpr_read_b32 v20, a56
  v_accvgpr_read_b32 v21, a57
  v_accvgpr_read_b32 v22, a58
  v_accvgpr_read_b32 v23, a59
  v_mul_f32 v20, v20, v18
  v_mul_f32 v21, v21, v18
  v_mul_f32 v22, v22, v18
  v_mul_f32 v23, v23, v18
  v_accvgpr_write_b32 a56, v20
  v_accvgpr_write_b32 a57, v21
  v_accvgpr_write_b32 a58, v22
  v_accvgpr_write_b32 a59, v23
  v_accvgpr_read_b32 v20, a60
  v_accvgpr_read_b32 v21, a61
  v_accvgpr_read_b32 v22, a62
  v_accvgpr_read_b32 v23, a63
  v_mul_f32 v20, v20, v19
  v_mul_f32 v21, v21, v19
  v_mul_f32 v22, v22, v19
  v_mul_f32 v23, v23, v19
  v_accvgpr_write_b32 a60, v20
  v_accvgpr_write_b32 a61, v21
  v_accvgpr_write_b32 a62, v22
  v_accvgpr_write_b32 a63, v23
  s_setpc_b64 s[78:79]
fa_rare10:
  s_nop 7
  v_max3_f32 v16, v128, v129, v130
  v_max3_f32 v16, v16, v131, v132
  v_max3_f32 v16, v16, v133, v134
  v_max3_f32 v16, v16, v135, 0
  v_mov_b32 v18, v16
  s_nop 1
  v_permlane16_swap_b32 v16, v18
  v_max_f32 v16, v16, v18
  v_mov_b32 v18, v16
  s_nop 1
  v_permlane32_swap_b32 v16, v18
  v_max_f32 v16, v16, v18
  v_sub_f32 v128, v128, v16
  v_sub_f32 v144, v144, v16
  v_sub_f32 v129, v129, v16
  v_sub_f32 v145, v145, v16
  v_sub_f32 v130, v130, v16
  v_sub_f32 v146, v146, v16
  v_sub_f32 v131, v131, v16
  v_sub_f32 v147, v147, v16
  v_sub_f32 v132, v132, v16
  v_sub_f32 v148, v148, v16
  v_sub_f32 v133, v133, v16
  v_sub_f32 v149, v149, v16
  v_sub_f32 v134, v134, v16
  v_sub_f32 v150, v150, v16
  v_sub_f32 v135, v135, v16
  v_sub_f32 v151, v151, v16
  v_max3_f32 v17, v136, v137, v138
  v_max3_f32 v17, v17, v139, v140
  v_max3_f32 v17, v17, v141, v142
  v_max3_f32 v17, v17, v143, 0
  v_mov_b32 v18, v17
  s_nop 1
  v_permlane16_swap_b32 v17, v18
  v_max_f32 v17, v17, v18
  v_mov_b32 v18, v17
  s_nop 1
  v_permlane32_swap_b32 v17, v18
  v_max_f32 v17, v17, v18
  v_sub_f32 v136, v136, v17
  v_sub_f32 v152, v152, v17
  v_sub_f32 v137, v137, v17
  v_sub_f32 v153, v153, v17
  v_sub_f32 v138, v138, v17
  v_sub_f32 v154, v154, v17
  v_sub_f32 v139, v139, v17
  v_sub_f32 v155, v155, v17
  v_sub_f32 v140, v140, v17
  v_sub_f32 v156, v156, v17
  v_sub_f32 v141, v141, v17
  v_sub_f32 v157, v157, v17
  v_sub_f32 v142, v142, v17
  v_sub_f32 v158, v158, v17
  v_sub_f32 v143, v143, v17
  v_sub_f32 v159, v159, v17
  s_call_b64 s[78:79], fa_resc1
  v_exp_f32 v216, v128
  v_exp_f32 v217, v129
  v_exp_f32 v218, v130
  v_add_f32 v226, v216, v217
  v_cvt_pk_bf16_f32 v176, v216, v217
  v_exp_f32 v219, v131
  v_add_f32 v226, v226, v218
  v_exp_f32 v220, v132
  v_add_f32 v226, v226, v219
  v_cvt_pk_bf16_f32 v177, v218, v219
  v_exp_f32 v221, v133
  v_add_f32 v226, v226, v220
  v_exp_f32 v222, v134
  v_add_f32 v226, v226, v221
  v_cvt_pk_bf16_f32 v178, v220, v221
  v_exp_f32 v223, v135
  v_add_f32 v226, v226, v222
  v_exp_f32 v216, v136
  v_add_f32 v226, v226, v223
  v_cvt_pk_bf16_f32 v179, v222, v223
  v_exp_f32 v217, v137
  v_exp_f32 v218, v138
  v_add_f32 v227, v216, v217
  v_cvt_pk_bf16_f32 v180, v216, v217
  v_exp_f32 v219, v139
  v_add_f32 v227, v227, v218
  v_exp_f32 v220, v140
  v_add_f32 v227, v227, v219
  v_cvt_pk_bf16_f32 v181, v218, v219
  v_exp_f32 v221, v141
  v_add_f32 v227, v227, v220
  v_exp_f32 v222, v142
  v_add_f32 v227, v227, v221
  v_cvt_pk_bf16_f32 v182, v220, v221
  v_exp_f32 v223, v143
  v_add_f32 v227, v227, v222
  s_nop 0
  v_add_f32 v227, v227, v223
  v_cvt_pk_bf16_f32 v183, v222, v223
  v_exp_f32 v216, v144
  s_nop 1
  s_setpc_b64 s[76:77]
fa_rare11:
  s_nop 7
  v_max3_f32 v16, v144, v145, v146
  v_max3_f32 v16, v16, v147, v148
  v_max3_f32 v16, v16, v149, v150
  v_max3_f32 v16, v16, v151, 0
  v_mov_b32 v18, v16
  s_nop 1
  v_permlane16_swap_b32 v16, v18
  v_max_f32 v16, v16, v18
  v_mov_b32 v18, v16
  s_nop 1
  v_permlane32_swap_b32 v16, v18
  v_max_f32 v16, v16, v18
  v_sub_f32 v144, v144, v16
  v_sub_f32 v128, v128, v16
  v_sub_f32 v145, v145, v16
  v_sub_f32 v129, v129, v16
  v_sub_f32 v146, v146, v16
  v_sub_f32 v130, v130, v16
  v_sub_f32 v147, v147, v16
  v_sub_f32 v131, v131, v16
  v_sub_f32 v148, v148, v16
  v_sub_f32 v132, v132, v16
  v_sub_f32 v149, v149, v16
  v_sub_f32 v133, v133, v16
  v_sub_f32 v150, v150, v16
  v_sub_f32 v134, v134, v16
  v_sub_f32 v151, v151, v16
  v_sub_f32 v135, v135, v16
  v_max3_f32 v17, v152, v153, v154
  v_max3_f32 v17, v17, v155, v156
  v_max3_f32 v17, v17, v157, v158
  v_max3_f32 v17, v17, v159, 0
  v_mov_b32 v18, v17
  s_nop 1
  v_permlane16_swap_b32 v17, v18
  v_max_f32 v17, v17, v18
  v_mov_b32 v18, v17
  s_nop 1
  v_permlane32_swap_b32 v17, v18
  v_max_f32 v17, v17, v18
  v_sub_f32 v152, v152, v17
  v_sub_f32 v136, v136, v17
  v_sub_f32 v153, v153, v17
  v_sub_f32 v137, v137, v17
  v_sub_f32 v154, v154, v17
  v_sub_f32 v138, v138, v17
  v_sub_f32 v155, v155, v17
  v_sub_f32 v139, v139, v17
  v_sub_f32 v156, v156, v17
  v_sub_f32 v140, v140, v17
  v_sub_f32 v157, v157, v17
  v_sub_f32 v141, v141, v17
  v_sub_f32 v158, v158, v17
  v_sub_f32 v142, v142, v17
  v_sub_f32 v159, v159, v17
  v_sub_f32 v143, v143, v17
  s_call_b64 s[78:79], fa_resc1
  v_exp_f32 v216, v144
  v_exp_f32 v217, v145
  v_exp_f32 v218, v146
  v_add_f32 v226, v216, v217
  v_cvt_pk_bf16_f32 v184, v216, v217
  v_exp_f32 v219, v147
  v_add_f32 v226, v226, v218
  v_exp_f32 v220, v148
  v_add_f32 v226, v226, v219
  v_cvt_pk_bf16_f32 v185, v218, v219
  v_exp_f32 v221, v149
  v_add_f32 v226, v226, v220
  v_exp_f32 v222, v150
  v_add_f32 v226, v226, v221
  v_cvt_pk_bf16_f32 v186, v220, v221
  v_exp_f32 v223, v151
  v_add_f32 v226, v226, v222
  v_exp_f32 v216, v152
  v_add_f32 v226, v226, v223
  v_cvt_pk_bf16_f32 v187, v222, v223
  v_exp_f32 v217, v153
  v_exp_f32 v218, v154
  v_add_f32 v227, v216, v217
  v_cvt_pk_bf16_f32 v188, v216, v217
  v_exp_f32 v219, v155
  v_add_f32 v227, v227, v218
  v_exp_f32 v220, v156
  v_add_f32 v227, v227, v219
  v_cvt_pk_bf16_f32 v189, v218, v219
  v_exp_f32 v221, v157
  v_add_f32 v227, v227, v220
  v_exp_f32 v222, v158
  v_add_f32 v227, v227, v221
  v_cvt_pk_bf16_f32 v190, v220, v221
  v_exp_f32 v223, v159
  v_add_f32 v227, v227, v222
  s_nop 0
  v_add_f32 v227, v227, v223
  v_cvt_pk_bf16_f32 v191, v222, v223
  v_exp_f32 v216, v128
  s_nop 1
  s_setpc_b64 s[76:77]
fa_resc1:
  v_sub_f32 v200, v200, v16
  v_sub_f32 v201, v201, v16
  v_sub_f32 v202, v202, v16
  v_sub_f32 v203, v203, v16
  v_exp_f32 v18, -v16
  v_sub_f32 v204, v204, v17
  v_sub_f32 v205, v205, v17
  v_sub_f32 v206, v206, v17
  v_sub_f32 v207, v207, v17
  v_exp_f32 v19, -v17
  s_nop 0
  v_mul_f32 v230, v230, v18
  v_mul_f32 v231, v231, v19
  v_accvgpr_read_b32 v20, a64
  v_accvgpr_read_b32 v21, a65
  v_accvgpr_read_b32 v22, a66
  v_accvgpr_read_b32 v23, a67
  v_mul_f32 v20, v20, v18
  v_mul_f32 v21, v21, v18
  v_mul_f32 v22, v22, v18
  v_mul_f32 v23, v23, v18
  v_accvgpr_write_b32 a64, v20
  v_accvgpr_write_b32 a65, v21
  v_accvgpr_write_b32 a66, v22
  v_accvgpr_write_b32 a67, v23
  v_accvgpr_read_b32 v20, a68
  v_accvgpr_read_b32 v21, a69
  v_accvgpr_read_b32 v22, a70
  v_accvgpr_read_b32 v23, a71
  v_mul_f32 v20, v20, v19
  v_mul_f32 v21, v21, v19
  v_mul_f32 v22, v22, v19
  v_mul_f32 v23, v23, v19
  v_accvgpr_write_b32 a68, v20
  v_accvgpr_write_b32 a69, v21
  v_accvgpr_write_b32 a70, v22
  v_accvgpr_write_b32 a71, v23
  v_accvgpr_read_b32 v20, a72
  v_accvgpr_read_b32 v21, a73
  v_accvgpr_read_b32 v22, a74
  v_accvgpr_read_b32 v23, a75
  v_mul_f32 v20, v20, v18
  v_mul_f32 v21, v21, v18
  v_mul_f32 v22, v22, v18
  v_mul_f32 v23, v23, v18
  v_accvgpr_write_b32 a72, v20
  v_accvgpr_write_b32 a73, v21
  v_accvgpr_write_b32 a74, v22
  v_accvgpr_write_b32 a75, v23
  v_accvgpr_read_b32 v20, a76
  v_accvgpr_read_b32 v21, a77
  v_accvgpr_read_b32 v22, a78
  v_accvgpr_read_b32 v23, a79
  v_mul_f32 v20, v20, v19
  v_mul_f32 v21, v21, v19
  v_mul_f32 v22, v22, v19
  v_mul_f32 v23, v23, v19
  v_accvgpr_write_b32 a76, v20
  v_accvgpr_write_b32 a77, v21
  v_accvgpr_write_b32 a78, v22
  v_accvgpr_write_b32 a79, v23
  v_accvgpr_read_b32 v20, a80
  v_accvgpr_read_b32 v21, a81
  v_accvgpr_read_b32 v22, a82
  v_accvgpr_read_b32 v23, a83
  v_mul_f32 v20, v20, v18
  v_mul_f32 v21, v21, v18
  v_mul_f32 v22, v22, v18
  v_mul_f32 v23, v23, v18
  v_accvgpr_write_b32 a80, v20
  v_accvgpr_write_b32 a81, v21
  v_accvgpr_write_b32 a82, v22
  v_accvgpr_write_b32 a83, v23
  v_accvgpr_read_b32 v20, a84
  v_accvgpr_read_b32 v21, a85
  v_accvgpr_read_b32 v22, a86
  v_accvgpr_read_b32 v23, a87
  v_mul_f32 v20, v20, v19
  v_mul_f32 v21, v21, v19
  v_mul_f32 v22, v22, v19
  v_mul_f32 v23, v23, v19
  v_accvgpr_write_b32 a84, v20
  v_accvgpr_write_b32 a85, v21
  v_accvgpr_write_b32 a86, v22
  v_accvgpr_write_b32 a87, v23
  v_accvgpr_read_b32 v20, a88
  v_accvgpr_read_b32 v21, a89
  v_accvgpr_read_b32 v22, a90
  v_accvgpr_read_b32 v23, a91
  v_mul_f32 v20, v20, v18
  v_mul_f32 v21, v21, v18
  v_mul_f32 v22, v22, v18
  v_mul_f32 v23, v23, v18
  v_accvgpr_write_b32 a88, v20
  v_accvgpr_write_b32 a89, v21
  v_accvgpr_write_b32 a90, v22
  v_accvgpr_write_b32 a91, v23
  v_accvgpr_read_b32 v20, a92
  v_accvgpr_read_b32 v21, a93
  v_accvgpr_read_b32 v22, a94
  v_accvgpr_read_b32 v23, a95
  v_mul_f32 v20, v20, v19
  v_mul_f32 v21, v21, v19
  v_mul_f32 v22, v22, v19
  v_mul_f32 v23, v23, v19
  v_accvgpr_write_b32 a92, v20
  v_accvgpr_write_b32 a93, v21
  v_accvgpr_write_b32 a94, v22
  v_accvgpr_write_b32 a95, v23
  v_accvgpr_read_b32 v20, a96
  v_accvgpr_read_b32 v21, a97
  v_accvgpr_read_b32 v22, a98
  v_accvgpr_read_b32 v23, a99
  v_mul_f32 v20, v20, v18
  v_mul_f32 v21, v21, v18
  v_mul_f32 v22, v22, v18
  v_mul_f32 v23, v23, v18
  v_accvgpr_write_b32 a96, v20
  v_accvgpr_write_b32 a97, v21
  v_accvgpr_write_b32 a98, v22
  v_accvgpr_write_b32 a99, v23
  v_accvgpr_read_b32 v20, a100
  v_accvgpr_read_b32 v21, a101
  v_accvgpr_read_b32 v22, a102
  v_accvgpr_read_b32 v23, a103
  v_mul_f32 v20, v20, v19
  v_mul_f32 v21, v21, v19
  v_mul_f32 v22, v22, v19
  v_mul_f32 v23, v23, v19
  v_accvgpr_write_b32 a100, v20
  v_accvgpr_write_b32 a101, v21
  v_accvgpr_write_b32 a102, v22
  v_accvgpr_write_b32 a103, v23
  v_accvgpr_read_b32 v20, a104
  v_accvgpr_read_b32 v21, a105
  v_accvgpr_read_b32 v22, a106
  v_accvgpr_read_b32 v23, a107
  v_mul_f32 v20, v20, v18
  v_mul_f32 v21, v21, v18
  v_mul_f32 v22, v22, v18
  v_mul_f32 v23, v23, v18
  v_accvgpr_write_b32 a104, v20
  v_accvgpr_write_b32 a105, v21
  v_accvgpr_write_b32 a106, v22
  v_accvgpr_write_b32 a107, v23
  v_accvgpr_read_b32 v20, a108
  v_accvgpr_read_b32 v21, a109
  v_accvgpr_read_b32 v22, a110
  v_accvgpr_read_b32 v23, a111
  v_mul_f32 v20, v20, v19
  v_mul_f32 v21, v21, v19
  v_mul_f32 v22, v22, v19
  v_mul_f32 v23, v23, v19
  v_accvgpr_write_b32 a108, v20
  v_accvgpr_write_b32 a109, v21
  v_accvgpr_write_b32 a110, v22
  v_accvgpr_write_b32 a111, v23
  v_accvgpr_read_b32 v20, a112
  v_accvgpr_read_b32 v21, a113
  v_accvgpr_read_b32 v22, a114
  v_accvgpr_read_b32 v23, a115
  v_mul_f32 v20, v20, v18
  v_mul_f32 v21, v21, v18
  v_mul_f32 v22, v22, v18
  v_mul_f32 v23, v23, v18
  v_accvgpr_write_b32 a112, v20
  v_accvgpr_write_b32 a113, v21
  v_accvgpr_write_b32 a114, v22
  v_accvgpr_write_b32 a115, v23
  v_accvgpr_read_b32 v20, a116
  v_accvgpr_read_b32 v21, a117
  v_accvgpr_read_b32 v22, a118
  v_accvgpr_read_b32 v23, a119
  v_mul_f32 v20, v20, v19
  v_mul_f32 v21, v21, v19
  v_mul_f32 v22, v22, v19
  v_mul_f32 v23, v23, v19
  v_accvgpr_write_b32 a116, v20
  v_accvgpr_write_b32 a117, v21
  v_accvgpr_write_b32 a118, v22
  v_accvgpr_write_b32 a119, v23
  v_accvgpr_read_b32 v20, a120
  v_accvgpr_read_b32 v21, a121
  v_accvgpr_read_b32 v22, a122
  v_accvgpr_read_b32 v23, a123
  v_mul_f32 v20, v20, v18
  v_mul_f32 v21, v21, v18
  v_mul_f32 v22, v22, v18
  v_mul_f32 v23, v23, v18
  v_accvgpr_write_b32 a120, v20
  v_accvgpr_write_b32 a121, v21
  v_accvgpr_write_b32 a122, v22
  v_accvgpr_write_b32 a123, v23
  v_accvgpr_read_b32 v20, a124
  v_accvgpr_read_b32 v21, a125
  v_accvgpr_read_b32 v22, a126
  v_accvgpr_read_b32 v23, a127
  v_mul_f32 v20, v20, v19
  v_mul_f32 v21, v21, v19
  v_mul_f32 v22, v22, v19
  v_mul_f32 v23, v23, v19
  v_accvgpr_write_b32 a124, v20
  v_accvgpr_write_b32 a125, v21
  v_accvgpr_write_b32 a126, v22
  v_accvgpr_write_b32 a127, v23
  s_setpc_b64 s[78:79]
.section .rodata,"a"
.p2align 6
.amdhsa_kernel fa_kernel
  .amdhsa_next_free_vgpr 512
  .amdhsa_next_free_sgpr 102
  .amdhsa_accum_offset 256
  .amdhsa_group_segment_fixed_size 0
  .amdhsa_kernarg_size 112
  .amdhsa_user_sgpr_count 2
  .amdhsa_user_sgpr_kernarg_segment_ptr 1
  .amdhsa_system_sgpr_workgroup_id_x 1
  .amdhsa_float_denorm_mode_32 3
.end_amdhsa_kernel
.text
```

```asm
; @launch kernel=fa_kernel grid=(256,1,1) block=(256,1,1) lds=163840
.amdgcn_target "amdgcn-amd-amdhsa--gfx950"
.text
.globl fa_kernel
.p2align 8
.type fa_kernel,@function
fa_kernel:
  s_cmp_ge_u32 s2, 256
  s_cbranch_scc1 fa_end
  s_getpc_b64 s[62:63]
  v_and_b32 v230, 127, v0
  v_lshlrev_b32 v230, 7, v230
  global_load_dword v231, v230, s[62:63]
  s_load_dwordx4 s[4:7], s[0:1], 0
  s_load_dwordx4 s[8:11], s[0:1], 24
  s_load_dwordx2 s[14:15], s[0:1], 56
  s_load_dwordx2 s[12:13], s[0:1], 40
  s_load_dwordx4 s[16:19], s[0:1], 96
  s_load_dwordx2 s[60:61], s[0:1], 16
  v_lshrrev_b32 v16, 6, v0
  v_and_b32 v1, 63, v0
  v_readfirstlane_b32 s20, v16
  s_and_b32 s21, s2, 7
  s_lshl_b32 s21, s21, 2
  s_lshr_b32 s23, s2, 3
  s_and_b32 s23, s23, 3
  s_add_u32 s21, s21, s23
  s_lshr_b32 s22, s2, 5
  v_and_b32 v208, 31, v1
  v_lshrrev_b32 v209, 5, v1
  s_lshl_b32 s31, s2, 2
  s_add_u32 s31, s31, s20
  s_lshl_b32 s31, s31, 1
  v_add_u32 v209, s31, v209
  v_lshlrev_b32 v212, 4, v208
  v_mul_u32_u24 v210, 1280, v209
  v_add_u32 v210, v210, v212
  v_cmp_gt_u32 s[64:65], 16, v208
  v_mov_b32 v19, 1073741824
  v_and_b32 v220, 7, v209
  v_cndmask_b32 v211, v19, v210, s[64:65]
  v_bfe_u32 v17, v1, 1, 3
  v_lshlrev_b32 v17, 13, v17
  v_and_b32 v18, 1, v1
  v_lshl_add_u32 v235, v18, 7, v17
  s_lshl_b32 s74, s22, 1
  s_and_b32 s31, s20, 1
  s_add_u32 s74, s74, s31
  s_lshl_b32 s74, s74, 16
  s_mov_b32 s73, 1048576
  v_and_b32 v16, 15, v1
  v_lshlrev_b32 v17, 10, v16
  v_and_b32 v18, 16, v1
  v_lshl_add_u32 v233, v18, 3, v17
  s_lshl_b32 s30, s23, 5
  s_add_u32 s30, s30, s20
  s_lshl_b32 s30, s30, 14
  s_lshl_b32 s29, s22, 16
  s_lshl_b32 s23, s21, 8
  s_cmp_ge_u32 s20, 2
  s_waitcnt lgkmcnt(0)
  s_mov_b32 s44, s4
  s_mov_b32 s45, s5
  s_mov_b32 s46, 2621440
  s_mov_b32 s47, 0x20000
  s_mov_b32 s68, s14
  s_mov_b32 s69, s15
  s_mov_b32 s70, 1280
  s_mov_b32 s71, 0x20000
  buffer_load_dwordx4 v[160:163], v210, s[44:47], 0 offen
  buffer_load_dwordx4 v[164:167], v210, s[44:47], 0 offen offset:512
  buffer_load_dwordx4 v[168:171], v211, s[44:47], 0 offen offset:1024
  buffer_load_dwordx4 v[172:175], v212, s[68:71], 0 offen offset:0
  buffer_load_dwordx4 v[176:179], v212, s[68:71], 0 offen offset:512
  buffer_load_dwordx4 v[180:183], v212, s[68:71], 0 offen offset:1024
  s_cselect_b32 s62, s10, s8
  s_cselect_b32 s63, s11, s9
  s_add_u32 s62, s62, s23
  s_addc_u32 s63, s63, 0
  s_mov_b32 s36, s62
  s_mov_b32 s37, s63
  s_mov_b32 s38, 0
  s_mov_b32 s39, 0x20000
  s_sub_u32 s38, 4194304, s23
  buffer_load_dword v231, v235, s[36:39], s74 offen
  s_add_u32 s6, s6, s29
  s_addc_u32 s7, s7, 0
  s_mov_b32 s32, s6
  s_mov_b32 s33, s7
  s_mov_b32 s34, 0
  s_mov_b32 s35, 0x20000
  s_sub_u32 s34, 2097152, s29
  buffer_load_dword v232, v233, s[32:35], s30 offen
  s_add_u32 s74, s74, s73
  buffer_load_dword v231, v235, s[36:39], s74 offen
  buffer_load_dword v232, v233, s[32:35], s30 offen offset:256
  s_getpc_b64 s[8:9]
fa_pc:
  s_lshr_b32 s31, s2, 3
  s_and_b32 s31, s31, 15
  s_lshl_b32 s31, s31, 2
  s_add_u32 s31, s31, s20
  s_lshl_b32 s31, s31, 11
  s_min_u32 s31, s31, fa_codeend-fa_pc-2048
  v_lshlrev_b32 v234, 7, v16
  v_add_u32 v230, s31, v234
  global_load_dword v231, v230, s[8:9]
  s_add_u32 s8, s8, fa_co1-fa_pc-4
  s_addc_u32 s9, s9, 0
  s_add_u32 s60, s60, s23
  s_addc_u32 s61, s61, 0
  s_sub_u32 s75, 5242880, s23
  s_mov_b32 s48, s62
  s_mov_b32 s49, s63
  s_mov_b32 s50, s38
  s_mov_b32 s51, 0x20000
  v_lshlrev_b32 v2, 4, v1
  v_lshrrev_b32 v19, 2, v1
  v_lshrrev_b32 v17, 5, v1
  v_mul_u32_u24 v17, 3, v17
  v_and_b32 v18, 3, v1
  v_xor_b32 v17, v17, v18
  v_lshlrev_b32 v17, 4, v17
  v_lshl_add_u32 v3, v19, 10, v17
  s_lshl_b32 s23, s20, 19
  v_add_u32 v3, s23, v3
  v_add_u32 v4, 15360, v3
  v_add_u32 v5, 30720, v3
  v_add_u32 v6, 46080, v3
  v_and_b32 v19, 3, v19
  v_lshrrev_b32 v17, 4, v1
  v_lshlrev_b32 v17, 6, v17
  v_lshl_add_u32 v19, v19, 13, v17
  s_and_b32 s23, s20, 1
  s_lshl_b32 s23, s23, 17
  v_add_u32 v19, s23, v19
  v_lshl_add_u32 v8, v18, 4, v19
  v_xor_b32 v18, 2, v18
  v_lshl_add_u32 v10, v18, 4, v19
  v_add_u32 v9, 31744, v8
  v_add_u32 v11, 95232, v10
  v_add_u32 v10, 63488, v10
  s_lshl_b32 s24, s20, 12
  s_mov_b32 s26, 0
  s_mov_b32 s27, 0
  s_mov_b32 s25, 262144
  s_mov_b32 s79, 64
  s_mov_b32 s40, s18
  s_mov_b32 s41, s19
  s_mov_b32 s42, 68157440
  s_mov_b32 s43, 0x20000
  s_mov_b32 s52, s12
  s_mov_b32 s53, s13
  s_mov_b32 s54, 5242880
  s_mov_b32 s55, 0x20000
  s_mov_b32 s56, s16
  s_mov_b32 s57, s17
  s_mov_b32 s58, 256
  s_mov_b32 s59, 0x20000
  s_and_b32 s29, s2, 7
  s_lshl_b32 s29, s29, 2
  s_add_u32 s29, s29, s20
  s_lshl_b32 s29, s29, 11
  s_and_b32 s23, s21, 3
  s_lshl_b32 s23, s23, 19
  s_add_u32 s29, s29, s23
  s_mul_i32 s23, s20, 4096
  s_lshl_b32 s31, s21, 7
  s_add_u32 s23, s23, s31
  s_add_u32 s23, s23, 3801088
  s_mul_i32 s31, s22, 16384
  s_add_u32 s80, s23, s31
  s_sub_u32 s31, 245760, s31
  s_add_u32 s3, s23, s31
  s_lshl_b32 s23, s21, 10
  s_lshl_b32 s31, s22, 7
  s_add_u32 s23, s23, s31
  s_add_u32 s82, s23, 67108864
  s_sub_u32 s62, s2, 170
  s_lshl_b32 s31, s20, 6
  s_add_u32 s62, s62, s31
  s_lshl_b32 s62, s62, 7
  s_add_u32 s62, s62, 67174400
  s_sub_u32 s23, s2, 170
  s_cmp_lt_u32 s23, 54
  s_cselect_b32 s62, s62, 1073741824
  s_cmp_eq_u32 s20, 0
  s_cselect_b32 s31, s82, 1073741824
  s_cselect_b32 s77, s2, 1073741824
  s_cmp_eq_u32 s2, 255
  s_cselect_b32 s23, 2629632, 1073741824
  v_lshl_add_u32 v225, v16, 2, s23
  v_mov_b32 v229, 0
  v_writelane_b32 v225, s80, 0
  v_writelane_b32 v225, s3, 1
  v_writelane_b32 v225, s31, 2
  s_add_u32 s31, s31, 32
  v_writelane_b32 v225, s31, 5
  s_and_b32 s23, s2, 1
  s_lshl_b32 s23, s23, 2
  s_add_u32 s23, s23, s20
  s_lshl_b32 s23, s23, 7
  s_lshr_b32 s31, s2, 1
  s_add_u32 s23, s23, s31
  s_lshl_b32 s23, s23, 7
  s_add_u32 s23, s23, 67371008
  v_writelane_b32 v225, s23, 3
  v_writelane_b32 v225, s62, 4
  s_lshl_b32 s23, s2, 2
  s_add_u32 s23, s23, s20
  s_lshl_b32 s23, s23, 7
  s_add_u32 s23, s23, 67239936
  v_writelane_b32 v225, s23, 6
  s_and_b32 s23, s21, 3
  s_lshr_b32 s31, s23, 1
  s_lshl_b32 s31, 4, s31
  s_bitcmp1_b32 s23, 0
  s_cselect_b32 s76, s31, 0
  s_cselect_b32 s72, 0, s31
  s_or_b32 s76, s76, 0x20
  s_or_b32 s72, s72, 0x25
  v_mov_b32 v20, 0
  v_mov_b32 v21, 0
  v_mov_b32 v22, 0
  v_mov_b32 v23, 0
  v_lshrrev_b32 v17, 4, v1
  v_lshrrev_b32 v18, 3, v16
  v_mul_u32_u24 v18, 3, v18
  v_xor_b32 v18, v18, v17
  v_lshlrev_b32 v18, 4, v18
  v_lshl_add_u32 v14, v16, 6, v18
  s_and_b32 s23, s20, 1
  s_lshl_b32 s23, s23, 11
  v_add_u32 v14, s23, v14
  v_mfma_f32_32x32x16_bf16 a[0:15], v[20:23], v[20:23], 0
  v_lshrrev_b32 v18, 2, v16
  v_lshlrev_b32 v18, 6, v18
  v_lshl_add_u32 v18, v17, 11, v18
  v_and_b32 v19, 1, v1
  v_mfma_f32_32x32x16_bf16 a[16:31], v[20:23], v[20:23], 0
  v_lshl_add_u32 v18, v19, 3, v18
  v_bfe_u32 v19, v1, 1, 1
  v_and_b32 v17, 1, v17
  v_lshl_or_b32 v19, v17, 1, v19
  v_mfma_f32_32x32x16_bf16 a[32:47], v[20:23], v[20:23], 0
  s_lshr_b32 s23, s20, 1
  s_lshl_b32 s23, s23, 13
  s_add_u32 s23, s23, 16384
  v_add_u32 v18, s23, v18
  v_mfma_f32_32x32x16_bf16 a[48:63], v[20:23], v[20:23], 0
  v_lshl_add_u32 v12, v19, 4, v18
  v_xor_b32 v13, 32, v12
  v_mov_b32 v19, 1073741824
  v_lshlrev_b32 v220, 4, v220
  v_mfma_f32_32x32x16_bf16 a[64:79], v[20:23], v[20:23], 0
  v_lshl_add_u32 v220, v208, 7, v220
  v_add_u32 v220, 131072, v220
  v_lshlrev_b32 v222, 2, v209
  v_cmp_eq_u32 vcc, 0, v208
  v_mfma_f32_32x32x16_bf16 a[80:95], v[20:23], v[20:23], 0
  v_add_u32 v222, 2621440, v222
  v_lshlrev_b32 v221, 4, v0
  v_cndmask_b32 v222, v19, v222, vcc
  v_add_u32 v221, 131072, v221
  v_mfma_f32_32x32x16_bf16 a[96:111], v[20:23], v[20:23], 0
  v_sub_u32 v209, 0xffff, v209
  v_lshrrev_b32 v223, 3, v0
  v_and_b32 v18, 7, v0
  v_lshlrev_b32 v18, 4, v18
  v_mfma_f32_32x32x16_bf16 a[112:127], v[20:23], v[20:23], 0
  v_cmp_gt_u32 vcc, 128, v0
  v_lshl_add_u32 v223, v223, 8, v18
  s_lshr_b32 s66, s2, 1
  s_mul_i32 s66, s66, 20480
  v_mfma_f32_32x32x16_bf16 a[128:143], v[20:23], v[20:23], 0
  s_and_b32 s31, s2, 1
  s_lshl_b32 s31, s31, 7
  s_add_u32 s66, s66, s31
  v_cndmask_b32 v224, v19, v223, vcc
  v_mfma_f32_32x32x16_bf16 a[144:159], v[20:23], v[20:23], 0
  s_add_u32 s67, s66, 8192
  s_add_u32 s78, s66, 16384
  s_mov_b32 s28, 0
  v_mfma_f32_32x32x16_bf16 a[160:175], v[20:23], v[20:23], 0
  v_mfma_f32_32x32x16_bf16 a[176:191], v[20:23], v[20:23], 0
  v_mfma_f32_32x32x16_bf16 a[192:207], v[20:23], v[20:23], 0
  v_mfma_f32_32x32x16_bf16 a[208:223], v[20:23], v[20:23], 0
  v_mfma_f32_32x32x16_bf16 a[224:239], v[20:23], v[20:23], 0
  v_mfma_f32_32x32x16_bf16 a[240:255], v[20:23], v[20:23], 0
  s_waitcnt vmcnt(5)
  v_lshlrev_b32 v184, 16, v160
  v_and_b32 v185, 0xffff0000, v160
  v_lshlrev_b32 v186, 16, v161
  v_and_b32 v187, 0xffff0000, v161
  v_lshlrev_b32 v188, 16, v162
  v_and_b32 v189, 0xffff0000, v162
  v_lshlrev_b32 v190, 16, v163
  v_and_b32 v191, 0xffff0000, v163
  v_lshlrev_b32 v192, 16, v164
  v_and_b32 v193, 0xffff0000, v164
  v_lshlrev_b32 v194, 16, v165
  v_and_b32 v195, 0xffff0000, v165
  v_lshlrev_b32 v196, 16, v166
  v_and_b32 v197, 0xffff0000, v166
  v_lshlrev_b32 v198, 16, v167
  v_and_b32 v199, 0xffff0000, v167
  v_lshlrev_b32 v200, 16, v168
  v_and_b32 v201, 0xffff0000, v168
  v_lshlrev_b32 v202, 16, v169
  v_and_b32 v203, 0xffff0000, v169
  v_lshlrev_b32 v204, 16, v170
  v_and_b32 v205, 0xffff0000, v170
  v_lshlrev_b32 v206, 16, v171
  v_and_b32 v207, 0xffff0000, v171
  v_pk_add_f32 v[16:17], v[184:185], v[186:187]
  v_pk_add_f32 v[18:19], v[188:189], v[190:191]
  v_pk_add_f32 v[16:17], v[16:17], v[192:193]
  v_pk_add_f32 v[18:19], v[18:19], v[194:195]
  v_pk_add_f32 v[16:17], v[16:17], v[196:197]
  v_pk_add_f32 v[18:19], v[18:19], v[198:199]
  v_pk_add_f32 v[16:17], v[16:17], v[200:201]
  v_pk_add_f32 v[18:19], v[18:19], v[202:203]
  v_pk_add_f32 v[16:17], v[16:17], v[204:205]
  v_pk_add_f32 v[18:19], v[18:19], v[206:207]
  v_pk_add_f32 v[16:17], v[16:17], v[18:19]
  v_add_f32 v213, v16, v17
  s_nop 1
  v_add_f32_dpp v213, v213, v213 quad_perm:[1,0,3,2] row_mask:0xf bank_mask:0xf
  s_nop 1
  v_add_f32_dpp v213, v213, v213 quad_perm:[2,3,0,1] row_mask:0xf bank_mask:0xf
  s_nop 1
  v_add_f32_dpp v213, v213, v213 row_half_mirror row_mask:0xf bank_mask:0xf
  s_nop 1
  v_add_f32_dpp v213, v213, v213 row_mirror row_mask:0xf bank_mask:0xf
  v_mov_b32 v214, v213
  s_nop 1
  v_permlane16_swap_b32 v213, v214
  v_add_f32 v213, v213, v214
  v_mul_f32 v216, 0xbacccccd, v213
  v_mul_f32 v217, 0xbacccccd, v213
  v_pk_add_f32 v[20:21], v[184:185], v[216:217]
  v_pk_mul_f32 v[16:17], v[20:21], v[20:21]
  v_pk_add_f32 v[22:23], v[186:187], v[216:217]
  v_pk_fma_f32 v[16:17], v[22:23], v[22:23], v[16:17]
  v_pk_add_f32 v[24:25], v[188:189], v[216:217]
  v_pk_fma_f32 v[16:17], v[24:25], v[24:25], v[16:17]
  v_pk_add_f32 v[26:27], v[190:191], v[216:217]
  v_pk_fma_f32 v[16:17], v[26:27], v[26:27], v[16:17]
  v_pk_add_f32 v[20:21], v[192:193], v[216:217]
  v_pk_fma_f32 v[16:17], v[20:21], v[20:21], v[16:17]
  v_pk_add_f32 v[22:23], v[194:195], v[216:217]
  v_pk_fma_f32 v[16:17], v[22:23], v[22:23], v[16:17]
  v_pk_add_f32 v[24:25], v[196:197], v[216:217]
  v_pk_fma_f32 v[16:17], v[24:25], v[24:25], v[16:17]
  v_pk_add_f32 v[26:27], v[198:199], v[216:217]
  v_pk_fma_f32 v[16:17], v[26:27], v[26:27], v[16:17]
  v_pk_add_f32 v[20:21], v[200:201], v[216:217]
  v_pk_mul_f32 v[18:19], v[20:21], v[20:21]
  v_pk_add_f32 v[22:23], v[202:203], v[216:217]
  v_pk_fma_f32 v[18:19], v[22:23], v[22:23], v[18:19]
  v_pk_add_f32 v[24:25], v[204:205], v[216:217]
  v_pk_fma_f32 v[18:19], v[24:25], v[24:25], v[18:19]
  v_pk_add_f32 v[26:27], v[206:207], v[216:217]
  v_pk_fma_f32 v[18:19], v[26:27], v[26:27], v[18:19]
  v_add_f32 v18, v18, v19
  v_add_f32 v213, v16, v17
  v_cndmask_b32 v18, 0, v18, s[64:65]
  v_add_f32 v213, v213, v18
  s_nop 1
  v_add_f32_dpp v213, v213, v213 quad_perm:[1,0,3,2] row_mask:0xf bank_mask:0xf
  s_nop 1
  v_add_f32_dpp v213, v213, v213 quad_perm:[2,3,0,1] row_mask:0xf bank_mask:0xf
  s_nop 1
  v_add_f32_dpp v213, v213, v213 row_half_mirror row_mask:0xf bank_mask:0xf
  s_nop 1
  v_add_f32_dpp v213, v213, v213 row_mirror row_mask:0xf bank_mask:0xf
  v_mov_b32 v214, v213
  s_nop 1
  v_permlane16_swap_b32 v213, v214
  v_add_f32 v213, v213, v214
  v_mul_f32 v213, 0x3acccccd, v213
  v_cvt_pk_bf16_f32 v213, v213, v213
  v_and_b32 v213, 0xffff0000, v213
  v_add_f32 v213, 0x3727c5ac, v213
  v_cvt_pk_bf16_f32 v213, v213, v213
  v_and_b32 v213, 0xffff0000, v213
  v_sqrt_f32 v213, v213
  v_cvt_pk_bf16_f32 v216, v216, v216
  v_and_b32 v216, 0xffff0000, v216
  v_cvt_pk_bf16_f32 v213, v213, v213
  v_and_b32 v213, 0xffff0000, v213
  v_rcp_f32 v28, v213
  v_mov_b32 v217, v216
  v_mov_b32 v29, v28
  v_pk_add_f32 v[184:185], v[184:185], v[216:217]
  v_lshlrev_b32 v16, 16, v172
  v_cvt_pk_bf16_f32 v185, v184, v185
  v_and_b32 v17, 0xffff0000, v172
  v_lshlrev_b32 v184, 16, v185
  v_and_b32 v185, 0xffff0000, v185
  v_pk_mul_f32 v[184:185], v[184:185], v[28:29]
  v_cvt_pk_bf16_f32 v160, v184, v185
  v_lshlrev_b32 v184, 16, v160
  v_and_b32 v185, 0xffff0000, v160
  v_pk_mul_f32 v[218:219], v[184:185], v[16:17]
  v_pk_add_f32 v[186:187], v[186:187], v[216:217]
  v_lshlrev_b32 v18, 16, v173
  v_cvt_pk_bf16_f32 v187, v186, v187
  v_and_b32 v19, 0xffff0000, v173
  v_lshlrev_b32 v186, 16, v187
  v_and_b32 v187, 0xffff0000, v187
  v_pk_mul_f32 v[186:187], v[186:187], v[28:29]
  v_cvt_pk_bf16_f32 v161, v186, v187
  v_lshlrev_b32 v186, 16, v161
  v_and_b32 v187, 0xffff0000, v161
  v_pk_fma_f32 v[218:219], v[186:187], v[18:19], v[218:219]
  v_pk_add_f32 v[188:189], v[188:189], v[216:217]
  v_lshlrev_b32 v16, 16, v174
  v_cvt_pk_bf16_f32 v189, v188, v189
  v_and_b32 v17, 0xffff0000, v174
  v_lshlrev_b32 v188, 16, v189
  v_and_b32 v189, 0xffff0000, v189
  v_pk_mul_f32 v[188:189], v[188:189], v[28:29]
  v_cvt_pk_bf16_f32 v162, v188, v189
  v_lshlrev_b32 v188, 16, v162
  v_and_b32 v189, 0xffff0000, v162
  v_pk_fma_f32 v[218:219], v[188:189], v[16:17], v[218:219]
  v_pk_add_f32 v[190:191], v[190:191], v[216:217]
  v_lshlrev_b32 v18, 16, v175
  v_cvt_pk_bf16_f32 v191, v190, v191
  v_and_b32 v19, 0xffff0000, v175
  v_lshlrev_b32 v190, 16, v191
  v_and_b32 v191, 0xffff0000, v191
  v_pk_mul_f32 v[190:191], v[190:191], v[28:29]
  v_cvt_pk_bf16_f32 v163, v190, v191
  v_lshlrev_b32 v190, 16, v163
  v_and_b32 v191, 0xffff0000, v163
  v_pk_fma_f32 v[218:219], v[190:191], v[18:19], v[218:219]
  ds_write_b128 v220, v[160:163] offset:0
  v_pk_add_f32 v[192:193], v[192:193], v[216:217]
  v_lshlrev_b32 v16, 16, v176
  v_cvt_pk_bf16_f32 v193, v192, v193
  v_and_b32 v17, 0xffff0000, v176
  v_lshlrev_b32 v192, 16, v193
  v_and_b32 v193, 0xffff0000, v193
  v_pk_mul_f32 v[192:193], v[192:193], v[28:29]
  v_cvt_pk_bf16_f32 v164, v192, v193
  v_lshlrev_b32 v192, 16, v164
  v_and_b32 v193, 0xffff0000, v164
  v_pk_fma_f32 v[218:219], v[192:193], v[16:17], v[218:219]
  v_pk_add_f32 v[194:195], v[194:195], v[216:217]
  v_lshlrev_b32 v18, 16, v177
  v_cvt_pk_bf16_f32 v195, v194, v195
  v_and_b32 v19, 0xffff0000, v177
  v_lshlrev_b32 v194, 16, v195
  v_and_b32 v195, 0xffff0000, v195
  v_pk_mul_f32 v[194:195], v[194:195], v[28:29]
  v_cvt_pk_bf16_f32 v165, v194, v195
  v_lshlrev_b32 v194, 16, v165
  v_and_b32 v195, 0xffff0000, v165
  v_pk_fma_f32 v[218:219], v[194:195], v[18:19], v[218:219]
  v_pk_add_f32 v[196:197], v[196:197], v[216:217]
  v_lshlrev_b32 v16, 16, v178
  v_cvt_pk_bf16_f32 v197, v196, v197
  v_and_b32 v17, 0xffff0000, v178
  v_lshlrev_b32 v196, 16, v197
  v_and_b32 v197, 0xffff0000, v197
  v_pk_mul_f32 v[196:197], v[196:197], v[28:29]
  v_cvt_pk_bf16_f32 v166, v196, v197
  v_lshlrev_b32 v196, 16, v166
  v_and_b32 v197, 0xffff0000, v166
  v_pk_fma_f32 v[218:219], v[196:197], v[16:17], v[218:219]
  v_pk_add_f32 v[198:199], v[198:199], v[216:217]
  v_lshlrev_b32 v18, 16, v179
  v_cvt_pk_bf16_f32 v199, v198, v199
  v_and_b32 v19, 0xffff0000, v179
  v_lshlrev_b32 v198, 16, v199
  v_and_b32 v199, 0xffff0000, v199
  v_pk_mul_f32 v[198:199], v[198:199], v[28:29]
  v_cvt_pk_bf16_f32 v167, v198, v199
  v_lshlrev_b32 v198, 16, v167
  v_and_b32 v199, 0xffff0000, v167
  v_pk_fma_f32 v[218:219], v[198:199], v[18:19], v[218:219]
  ds_write_b128 v220, v[164:167] offset:4096
  v_pk_add_f32 v[200:201], v[200:201], v[216:217]
  v_lshlrev_b32 v16, 16, v180
  v_cvt_pk_bf16_f32 v201, v200, v201
  v_and_b32 v17, 0xffff0000, v180
  v_lshlrev_b32 v200, 16, v201
  v_and_b32 v201, 0xffff0000, v201
  v_pk_mul_f32 v[200:201], v[200:201], v[28:29]
  v_cvt_pk_bf16_f32 v168, v200, v201
  v_lshlrev_b32 v200, 16, v168
  v_and_b32 v201, 0xffff0000, v168
  v_pk_fma_f32 v[218:219], v[200:201], v[16:17], v[218:219]
  v_pk_add_f32 v[202:203], v[202:203], v[216:217]
  v_lshlrev_b32 v18, 16, v181
  v_cvt_pk_bf16_f32 v203, v202, v203
  v_and_b32 v19, 0xffff0000, v181
  v_lshlrev_b32 v202, 16, v203
  v_and_b32 v203, 0xffff0000, v203
  v_pk_mul_f32 v[202:203], v[202:203], v[28:29]
  v_cvt_pk_bf16_f32 v169, v202, v203
  v_lshlrev_b32 v202, 16, v169
  v_and_b32 v203, 0xffff0000, v169
  v_pk_fma_f32 v[218:219], v[202:203], v[18:19], v[218:219]
  v_pk_add_f32 v[204:205], v[204:205], v[216:217]
  v_lshlrev_b32 v16, 16, v182
  v_cvt_pk_bf16_f32 v205, v204, v205
  v_and_b32 v17, 0xffff0000, v182
  v_lshlrev_b32 v204, 16, v205
  v_and_b32 v205, 0xffff0000, v205
  v_pk_mul_f32 v[204:205], v[204:205], v[28:29]
  v_cvt_pk_bf16_f32 v170, v204, v205
  v_lshlrev_b32 v204, 16, v170
  v_and_b32 v205, 0xffff0000, v170
  v_pk_fma_f32 v[218:219], v[204:205], v[16:17], v[218:219]
  v_pk_add_f32 v[206:207], v[206:207], v[216:217]
  v_lshlrev_b32 v18, 16, v183
  v_cvt_pk_bf16_f32 v207, v206, v207
  v_and_b32 v19, 0xffff0000, v183
  v_lshlrev_b32 v206, 16, v207
  v_and_b32 v207, 0xffff0000, v207
  v_pk_mul_f32 v[206:207], v[206:207], v[28:29]
  v_cvt_pk_bf16_f32 v171, v206, v207
  v_lshlrev_b32 v206, 16, v171
  v_and_b32 v207, 0xffff0000, v171
  v_pk_fma_f32 v[218:219], v[206:207], v[18:19], v[218:219]
  ds_write_b128 v220, v[168:171] offset:8192
  v_add_f32 v218, v218, v219
  s_nop 1
  v_add_f32_dpp v218, v218, v218 quad_perm:[1,0,3,2] row_mask:0xf bank_mask:0xf
  s_nop 1
  v_add_f32_dpp v218, v218, v218 quad_perm:[2,3,0,1] row_mask:0xf bank_mask:0xf
  s_nop 1
  v_add_f32_dpp v218, v218, v218 row_half_mirror row_mask:0xf bank_mask:0xf
  s_nop 1
  v_add_f32_dpp v218, v218, v218 row_mirror row_mask:0xf bank_mask:0xf
  v_mov_b32 v214, v218
  s_nop 1
  v_permlane16_swap_b32 v218, v214
  v_add_f32 v218, v218, v214
  v_cvt_pk_bf16_f32 v218, v218, v218
  v_and_b32 v218, 0xffff0000, v218
  v_ashrrev_i32 v214, 31, v218
  v_or_b32 v214, 0x80000000, v214
  v_xor_b32 v218, v218, v214
  v_and_b32 v218, 0xffff0000, v218
  v_or_b32 v218, v218, v209
  v_mov_b32 v19, 1073741824
  s_mov_b32 m0, s24
  s_nop 0
  buffer_load_dwordx4 v3, s[32:35], s26 offen offset:0 sc1 lds
  buffer_load_dwordx4 v4, s[32:35], s26 offen offset:1024 sc1 lds
  buffer_load_dwordx4 v5, s[32:35], s26 offen offset:2048 sc1 lds
  buffer_load_dwordx4 v6, s[32:35], s26 offen offset:3072 sc1 lds
  s_add_u32 m0, s24, 16384
  s_nop 0
  buffer_load_dwordx4 v8, s[36:39], s27 offen offset:0 lds
  buffer_load_dwordx4 v9, s[36:39], s27 offen offset:1024 lds
  buffer_load_dwordx4 v10, s[36:39], s27 offen offset:2048 lds
  buffer_load_dwordx4 v11, s[36:39], s27 offen offset:3072 lds
  s_add_u32 s26, s26, s79
  s_add_u32 s27, s27, s25
  s_add_u32 s24, s24, 32768
  s_and_b32 s24, s24, 0x1ffff
  s_mov_b32 m0, s24
  s_nop 0
  buffer_load_dwordx4 v3, s[32:35], s26 offen offset:0 sc1 lds
  buffer_load_dwordx4 v4, s[32:35], s26 offen offset:1024 sc1 lds
  buffer_load_dwordx4 v5, s[32:35], s26 offen offset:2048 sc1 lds
  buffer_load_dwordx4 v6, s[32:35], s26 offen offset:3072 sc1 lds
  s_add_u32 m0, s24, 16384
  s_nop 0
  buffer_load_dwordx4 v8, s[36:39], s27 offen offset:0 lds
  buffer_load_dwordx4 v9, s[36:39], s27 offen offset:1024 lds
  buffer_load_dwordx4 v10, s[36:39], s27 offen offset:2048 lds
  buffer_load_dwordx4 v11, s[36:39], s27 offen offset:3072 lds
  s_add_u32 s26, s26, s79
  s_add_u32 s27, s27, s25
  s_add_u32 s24, s24, 32768
  s_and_b32 s24, s24, 0x1ffff
  s_waitcnt vmcnt(8) lgkmcnt(0)
  s_barrier
  s_cmp_ge_u32 s20, 2
  s_cbranch_scc1 fa_roleV
  ds_read_b128 v[96:99], v14 offset:0
  ds_read_b128 v[100:103], v14 offset:1024
  ds_read_b128 v[104:107], v14 offset:4096
  ds_read_b128 v[108:111], v14 offset:5120
  ds_read_b128 v[112:115], v14 offset:8192
  ds_read_b128 v[116:119], v14 offset:9216
  ds_read_b128 v[120:123], v14 offset:12288
  ds_read_b128 v[124:127], v14 offset:13312
  ds_read_b64_tr_b16 v[32:33], v12 offset:0
  ds_read_b64_tr_b16 v[34:35], v12 offset:1024
  ds_read_b64_tr_b16 v[36:37], v13 offset:0
  ds_read_b64_tr_b16 v[38:39], v13 offset:1024
  ds_read_b64_tr_b16 v[40:41], v12 offset:256
  ds_read_b64_tr_b16 v[42:43], v12 offset:1280
  ds_read_b64_tr_b16 v[44:45], v13 offset:256
  ds_read_b64_tr_b16 v[46:47], v13 offset:1280
  ds_read_b64_tr_b16 v[48:49], v12 offset:512
  ds_read_b64_tr_b16 v[50:51], v12 offset:1536
  ds_read_b64_tr_b16 v[52:53], v13 offset:512
  ds_read_b64_tr_b16 v[54:55], v13 offset:1536
  ds_read_b64_tr_b16 v[56:57], v12 offset:768
  ds_read_b64_tr_b16 v[58:59], v12 offset:1792
  ds_read_b64_tr_b16 v[60:61], v13 offset:768
  ds_read_b64_tr_b16 v[62:63], v13 offset:1792
  s_mov_b32 m0, s24
  s_nop 0
  buffer_load_dwordx4 v3, s[32:35], s26 offen offset:0 sc1 lds
  buffer_load_dwordx4 v4, s[32:35], s26 offen offset:1024 sc1 lds
  buffer_load_dwordx4 v5, s[32:35], s26 offen offset:2048 sc1 lds
  buffer_load_dwordx4 v6, s[32:35], s26 offen offset:3072 sc1 lds
  s_add_u32 m0, s24, 16384
  s_nop 0
  buffer_load_dwordx4 v8, s[36:39], s27 offen offset:0 lds
  buffer_load_dwordx4 v9, s[36:39], s27 offen offset:1024 lds
  buffer_load_dwordx4 v10, s[36:39], s27 offen offset:2048 lds
  buffer_load_dwordx4 v11, s[36:39], s27 offen offset:3072 lds
  s_add_u32 s26, s26, s79
  s_add_u32 s27, s27, s25
  s_add_u32 s24, s24, 32768
  s_and_b32 s24, s24, 0x1ffff
  buffer_load_dword v231, v19, s[32:35], 0 offen
  s_mov_b32 m0, s24
  s_nop 0
  buffer_load_dwordx4 v3, s[32:35], s26 offen offset:0 sc1 lds
  buffer_load_dwordx4 v4, s[32:35], s26 offen offset:1024 sc1 lds
  buffer_load_dwordx4 v5, s[32:35], s26 offen offset:2048 sc1 lds
  buffer_load_dwordx4 v6, s[32:35], s26 offen offset:3072 sc1 lds
  s_add_u32 m0, s24, 16384
  s_nop 0
  buffer_load_dwordx4 v8, s[36:39], s27 offen offset:0 lds
  buffer_load_dwordx4 v9, s[36:39], s27 offen offset:1024 lds
  buffer_load_dwordx4 v10, s[36:39], s27 offen offset:2048 lds
  buffer_load_dwordx4 v11, s[36:39], s27 offen offset:3072 lds
  s_add_u32 s26, s26, s79
  s_add_u32 s27, s27, s25
  s_add_u32 s24, s24, 32768
  s_and_b32 s24, s24, 0x1ffff
  s_waitcnt lgkmcnt(0)
.p2align 6
fa_loopK:
  v_mfma_f32_16x16x32_bf16 a[192:195], v[32:35], v[96:99], a[192:195]
  s_waitcnt vmcnt(17)
  v_mfma_f32_16x16x32_bf16 a[200:203], v[32:35], v[100:103], a[200:203]
  s_barrier
  v_mfma_f32_16x16x32_bf16 a[0:3], v[32:35], v[104:107], a[0:3]
  ds_read_b64_tr_b16 v[64:65], v12 offset:32768
  v_mfma_f32_16x16x32_bf16 a[8:11], v[32:35], v[108:111], a[8:11]
  v_mfma_f32_16x16x32_bf16 a[64:67], v[32:35], v[112:115], a[64:67]
  s_mov_b32 m0, s24
  ds_read_b64_tr_b16 v[66:67], v12 offset:33792
  v_mfma_f32_16x16x32_bf16 a[72:75], v[32:35], v[116:119], a[72:75]
  buffer_load_dwordx4 v3, s[32:35], s26 offen offset:0 sc1 lds
  v_mfma_f32_16x16x32_bf16 a[128:131], v[32:35], v[120:123], a[128:131]
  ds_read_b128 v[128:131], v14 offset:32768
  v_mfma_f32_16x16x32_bf16 a[136:139], v[32:35], v[124:127], a[136:139]
  buffer_load_dwordx4 v4, s[32:35], s26 offen offset:1024 sc1 lds
  v_mfma_f32_16x16x32_bf16 a[196:199], v[36:39], v[96:99], a[196:199]
  ds_read_b64_tr_b16 v[68:69], v13 offset:32768
  v_mfma_f32_16x16x32_bf16 a[204:207], v[36:39], v[100:103], a[204:207]
  buffer_load_dwordx4 v5, s[32:35], s26 offen offset:2048 sc1 lds
  v_mfma_f32_16x16x32_bf16 a[4:7], v[36:39], v[104:107], a[4:7]
  ds_read_b64_tr_b16 v[70:71], v13 offset:33792
  v_mfma_f32_16x16x32_bf16 a[12:15], v[36:39], v[108:111], a[12:15]
  buffer_load_dwordx4 v6, s[32:35], s26 offen offset:3072 sc1 lds
  v_mfma_f32_16x16x32_bf16 a[68:71], v[36:39], v[112:115], a[68:71]
  s_add_u32 m0, s24, 16384
  ds_read_b128 v[132:135], v14 offset:33792
  v_mfma_f32_16x16x32_bf16 a[76:79], v[36:39], v[116:119], a[76:79]
  buffer_load_dwordx4 v8, s[36:39], s27 offen offset:0 lds
  v_mfma_f32_16x16x32_bf16 a[132:135], v[36:39], v[120:123], a[132:135]
  ds_read_b64_tr_b16 v[72:73], v12 offset:33024
  v_mfma_f32_16x16x32_bf16 a[140:143], v[36:39], v[124:127], a[140:143]
  buffer_load_dwordx4 v9, s[36:39], s27 offen offset:1024 lds
  v_mfma_f32_16x16x32_bf16 a[208:211], v[40:43], v[96:99], a[208:211]
  ds_read_b64_tr_b16 v[74:75], v12 offset:34048
  v_mfma_f32_16x16x32_bf16 a[216:219], v[40:43], v[100:103], a[216:219]
  buffer_load_dwordx4 v10, s[36:39], s27 offen offset:2048 lds
  v_mfma_f32_16x16x32_bf16 a[16:19], v[40:43], v[104:107], a[16:19]
  ds_read_b128 v[136:139], v14 offset:36864
  v_mfma_f32_16x16x32_bf16 a[24:27], v[40:43], v[108:111], a[24:27]
  buffer_load_dwordx4 v11, s[36:39], s27 offen offset:3072 lds
  v_mfma_f32_16x16x32_bf16 a[80:83], v[40:43], v[112:115], a[80:83]
  ds_read_b64_tr_b16 v[76:77], v13 offset:33024
  v_mfma_f32_16x16x32_bf16 a[88:91], v[40:43], v[116:119], a[88:91]
  buffer_load_dword v231, v235, s[48:51], s74 offen sc1
  v_mfma_f32_16x16x32_bf16 a[144:147], v[40:43], v[120:123], a[144:147]
  s_add_u32 s74, s74, s73
  ds_read_b64_tr_b16 v[78:79], v13 offset:34048
  v_mfma_f32_16x16x32_bf16 a[152:155], v[40:43], v[124:127], a[152:155]
  s_bitcmp1_b32 s72, s28
  v_mfma_f32_16x16x32_bf16 a[212:215], v[44:47], v[96:99], a[212:215]
  s_cbranch_scc1 fa_hk0
fa_hb0:
  ds_read_b128 v[140:143], v14 offset:37888
  v_mfma_f32_16x16x32_bf16 a[220:223], v[44:47], v[100:103], a[220:223]
  v_mfma_f32_16x16x32_bf16 a[20:23], v[44:47], v[104:107], a[20:23]
  ds_read_b64_tr_b16 v[80:81], v12 offset:33280
  v_mfma_f32_16x16x32_bf16 a[28:31], v[44:47], v[108:111], a[28:31]
  v_mfma_f32_16x16x32_bf16 a[84:87], v[44:47], v[112:115], a[84:87]
  ds_read_b64_tr_b16 v[82:83], v12 offset:34304
  v_mfma_f32_16x16x32_bf16 a[92:95], v[44:47], v[116:119], a[92:95]
  v_mfma_f32_16x16x32_bf16 a[148:151], v[44:47], v[120:123], a[148:151]
  ds_read_b128 v[144:147], v14 offset:40960
  v_mfma_f32_16x16x32_bf16 a[156:159], v[44:47], v[124:127], a[156:159]
  v_mfma_f32_16x16x32_bf16 a[224:227], v[48:51], v[96:99], a[224:227]
  ds_read_b64_tr_b16 v[84:85], v13 offset:33280
  v_mfma_f32_16x16x32_bf16 a[232:235], v[48:51], v[100:103], a[232:235]
  v_mfma_f32_16x16x32_bf16 a[32:35], v[48:51], v[104:107], a[32:35]
  ds_read_b64_tr_b16 v[86:87], v13 offset:34304
  v_mfma_f32_16x16x32_bf16 a[40:43], v[48:51], v[108:111], a[40:43]
  v_mfma_f32_16x16x32_bf16 a[96:99], v[48:51], v[112:115], a[96:99]
  ds_read_b128 v[148:151], v14 offset:41984
  v_mfma_f32_16x16x32_bf16 a[104:107], v[48:51], v[116:119], a[104:107]
  v_mfma_f32_16x16x32_bf16 a[160:163], v[48:51], v[120:123], a[160:163]
  ds_read_b64_tr_b16 v[88:89], v12 offset:33536
  v_mfma_f32_16x16x32_bf16 a[168:171], v[48:51], v[124:127], a[168:171]
  v_mfma_f32_16x16x32_bf16 a[228:231], v[52:55], v[96:99], a[228:231]
  ds_read_b64_tr_b16 v[90:91], v12 offset:34560
  v_mfma_f32_16x16x32_bf16 a[236:239], v[52:55], v[100:103], a[236:239]
  v_mfma_f32_16x16x32_bf16 a[36:39], v[52:55], v[104:107], a[36:39]
  ds_read_b128 v[152:155], v14 offset:45056
  v_mfma_f32_16x16x32_bf16 a[44:47], v[52:55], v[108:111], a[44:47]
  v_mfma_f32_16x16x32_bf16 a[100:103], v[52:55], v[112:115], a[100:103]
  ds_read_b64_tr_b16 v[92:93], v13 offset:33536
  v_mfma_f32_16x16x32_bf16 a[108:111], v[52:55], v[116:119], a[108:111]
  v_mfma_f32_16x16x32_bf16 a[164:167], v[52:55], v[120:123], a[164:167]
  ds_read_b64_tr_b16 v[94:95], v13 offset:34560
  v_mfma_f32_16x16x32_bf16 a[172:175], v[52:55], v[124:127], a[172:175]
  v_mfma_f32_16x16x32_bf16 a[240:243], v[56:59], v[96:99], a[240:243]
  s_add_u32 s26, s26, s79
  ds_read_b128 v[156:159], v14 offset:46080
  v_mfma_f32_16x16x32_bf16 a[248:251], v[56:59], v[100:103], a[248:251]
  s_add_u32 s27, s27, s25
  v_mfma_f32_16x16x32_bf16 a[48:51], v[56:59], v[104:107], a[48:51]
  s_add_u32 s24, s24, 32768
  v_mfma_f32_16x16x32_bf16 a[56:59], v[56:59], v[108:111], a[56:59]
  s_and_b32 s24, s24, 0x1ffff
  v_mfma_f32_16x16x32_bf16 a[112:115], v[56:59], v[112:115], a[112:115]
  v_xor_b32 v14, 0x10000, v14
  v_mfma_f32_16x16x32_bf16 a[120:123], v[56:59], v[116:119], a[120:123]
  v_xor_b32 v12, 0x10000, v12
  v_mfma_f32_16x16x32_bf16 a[176:179], v[56:59], v[120:123], a[176:179]
  v_xor_b32 v13, 0x10000, v13
  v_mfma_f32_16x16x32_bf16 a[184:187], v[56:59], v[124:127], a[184:187]
  v_mfma_f32_16x16x32_bf16 a[244:247], v[60:63], v[96:99], a[244:247]
  v_mfma_f32_16x16x32_bf16 a[252:255], v[60:63], v[100:103], a[252:255]
  v_mfma_f32_16x16x32_bf16 a[52:55], v[60:63], v[104:107], a[52:55]
  v_mfma_f32_16x16x32_bf16 a[60:63], v[60:63], v[108:111], a[60:63]
  v_mfma_f32_16x16x32_bf16 a[116:119], v[60:63], v[112:115], a[116:119]
  v_mfma_f32_16x16x32_bf16 a[124:127], v[60:63], v[116:119], a[124:127]
  v_mfma_f32_16x16x32_bf16 a[180:183], v[60:63], v[120:123], a[180:183]
  v_mfma_f32_16x16x32_bf16 a[188:191], v[60:63], v[124:127], a[188:191]
  s_waitcnt lgkmcnt(0)
  v_mfma_f32_16x16x32_bf16 a[192:195], v[64:67], v[128:131], a[192:195]
  s_waitcnt vmcnt(18)
  v_mfma_f32_16x16x32_bf16 a[200:203], v[64:67], v[132:135], a[200:203]
  s_barrier
  v_mfma_f32_16x16x32_bf16 a[0:3], v[64:67], v[136:139], a[0:3]
  ds_read_b64_tr_b16 v[32:33], v12 offset:0
  v_mfma_f32_16x16x32_bf16 a[8:11], v[64:67], v[140:143], a[8:11]
  v_mfma_f32_16x16x32_bf16 a[64:67], v[64:67], v[144:147], a[64:67]
  s_mov_b32 m0, s24
  ds_read_b64_tr_b16 v[34:35], v12 offset:1024
  v_mfma_f32_16x16x32_bf16 a[72:75], v[64:67], v[148:151], a[72:75]
  buffer_load_dwordx4 v3, s[32:35], s26 offen offset:0 sc1 lds
  v_mfma_f32_16x16x32_bf16 a[128:131], v[64:67], v[152:155], a[128:131]
  ds_read_b128 v[96:99], v14 offset:0
  v_mfma_f32_16x16x32_bf16 a[136:139], v[64:67], v[156:159], a[136:139]
  v_mfma_f32_16x16x32_bf16 a[196:199], v[68:71], v[128:131], a[196:199]
  ds_read_b64_tr_b16 v[36:37], v13 offset:0
  v_mfma_f32_16x16x32_bf16 a[204:207], v[68:71], v[132:135], a[204:207]
  v_mfma_f32_16x16x32_bf16 a[4:7], v[68:71], v[136:139], a[4:7]
  ds_read_b64_tr_b16 v[38:39], v13 offset:1024
  v_mfma_f32_16x16x32_bf16 a[12:15], v[68:71], v[140:143], a[12:15]
  buffer_load_dwordx4 v4, s[32:35], s26 offen offset:1024 sc1 lds
  v_mfma_f32_16x16x32_bf16 a[68:71], v[68:71], v[144:147], a[68:71]
  ds_read_b128 v[100:103], v14 offset:1024
  v_mfma_f32_16x16x32_bf16 a[76:79], v[68:71], v[148:151], a[76:79]
  v_mfma_f32_16x16x32_bf16 a[132:135], v[68:71], v[152:155], a[132:135]
  ds_read_b64_tr_b16 v[40:41], v12 offset:256
  v_mfma_f32_16x16x32_bf16 a[140:143], v[68:71], v[156:159], a[140:143]
  v_mfma_f32_16x16x32_bf16 a[208:211], v[72:75], v[128:131], a[208:211]
  ds_read_b64_tr_b16 v[42:43], v12 offset:1280
  v_mfma_f32_16x16x32_bf16 a[216:219], v[72:75], v[132:135], a[216:219]
  buffer_load_dwordx4 v5, s[32:35], s26 offen offset:2048 sc1 lds
  v_mfma_f32_16x16x32_bf16 a[16:19], v[72:75], v[136:139], a[16:19]
  ds_read_b128 v[104:107], v14 offset:4096
  v_mfma_f32_16x16x32_bf16 a[24:27], v[72:75], v[140:143], a[24:27]
  v_mfma_f32_16x16x32_bf16 a[80:83], v[72:75], v[144:147], a[80:83]
  ds_read_b64_tr_b16 v[44:45], v13 offset:256
  v_mfma_f32_16x16x32_bf16 a[88:91], v[72:75], v[148:151], a[88:91]
  v_mfma_f32_16x16x32_bf16 a[144:147], v[72:75], v[152:155], a[144:147]
  ds_read_b64_tr_b16 v[46:47], v13 offset:1280
  v_mfma_f32_16x16x32_bf16 a[152:155], v[72:75], v[156:159], a[152:155]
  buffer_load_dwordx4 v6, s[32:35], s26 offen offset:3072 sc1 lds
  v_mfma_f32_16x16x32_bf16 a[212:215], v[76:79], v[128:131], a[212:215]
  ds_read_b128 v[108:111], v14 offset:5120
  v_mfma_f32_16x16x32_bf16 a[220:223], v[76:79], v[132:135], a[220:223]
  v_mfma_f32_16x16x32_bf16 a[20:23], v[76:79], v[136:139], a[20:23]
  ds_read_b64_tr_b16 v[48:49], v12 offset:512
  v_mfma_f32_16x16x32_bf16 a[28:31], v[76:79], v[140:143], a[28:31]
  v_mfma_f32_16x16x32_bf16 a[84:87], v[76:79], v[144:147], a[84:87]
  s_add_u32 m0, s24, 16384
  ds_read_b64_tr_b16 v[50:51], v12 offset:1536
  v_mfma_f32_16x16x32_bf16 a[92:95], v[76:79], v[148:151], a[92:95]
  buffer_load_dwordx4 v8, s[36:39], s27 offen offset:0 lds
  v_mfma_f32_16x16x32_bf16 a[148:151], v[76:79], v[152:155], a[148:151]
  ds_read_b128 v[112:115], v14 offset:8192
  v_mfma_f32_16x16x32_bf16 a[156:159], v[76:79], v[156:159], a[156:159]
  v_mfma_f32_16x16x32_bf16 a[224:227], v[80:83], v[128:131], a[224:227]
  ds_read_b64_tr_b16 v[52:53], v13 offset:512
  v_mfma_f32_16x16x32_bf16 a[232:235], v[80:83], v[132:135], a[232:235]
  v_mfma_f32_16x16x32_bf16 a[32:35], v[80:83], v[136:139], a[32:35]
  ds_read_b64_tr_b16 v[54:55], v13 offset:1536
  v_mfma_f32_16x16x32_bf16 a[40:43], v[80:83], v[140:143], a[40:43]
  buffer_load_dwordx4 v9, s[36:39], s27 offen offset:1024 lds
  v_mfma_f32_16x16x32_bf16 a[96:99], v[80:83], v[144:147], a[96:99]
  ds_read_b128 v[116:119], v14 offset:9216
  v_mfma_f32_16x16x32_bf16 a[104:107], v[80:83], v[148:151], a[104:107]
  v_mfma_f32_16x16x32_bf16 a[160:163], v[80:83], v[152:155], a[160:163]
  ds_read_b64_tr_b16 v[56:57], v12 offset:768
  v_mfma_f32_16x16x32_bf16 a[168:171], v[80:83], v[156:159], a[168:171]
  v_mfma_f32_16x16x32_bf16 a[228:231], v[84:87], v[128:131], a[228:231]
  ds_read_b64_tr_b16 v[58:59], v12 offset:1792
  v_mfma_f32_16x16x32_bf16 a[236:239], v[84:87], v[132:135], a[236:239]
  buffer_load_dwordx4 v10, s[36:39], s27 offen offset:2048 lds
  v_mfma_f32_16x16x32_bf16 a[36:39], v[84:87], v[136:139], a[36:39]
  ds_read_b128 v[120:123], v14 offset:12288
  v_mfma_f32_16x16x32_bf16 a[44:47], v[84:87], v[140:143], a[44:47]
  v_mfma_f32_16x16x32_bf16 a[100:103], v[84:87], v[144:147], a[100:103]
  ds_read_b64_tr_b16 v[60:61], v13 offset:768
  v_mfma_f32_16x16x32_bf16 a[108:111], v[84:87], v[148:151], a[108:111]
  v_mfma_f32_16x16x32_bf16 a[164:167], v[84:87], v[152:155], a[164:167]
  ds_read_b64_tr_b16 v[62:63], v13 offset:1792
  v_mfma_f32_16x16x32_bf16 a[172:175], v[84:87], v[156:159], a[172:175]
  buffer_load_dwordx4 v11, s[36:39], s27 offen offset:3072 lds
  v_mfma_f32_16x16x32_bf16 a[240:243], v[88:91], v[128:131], a[240:243]
  s_add_u32 s26, s26, s79
  ds_read_b128 v[124:127], v14 offset:13312
  v_mfma_f32_16x16x32_bf16 a[248:251], v[88:91], v[132:135], a[248:251]
  s_add_u32 s27, s27, s25
  v_mfma_f32_16x16x32_bf16 a[48:51], v[88:91], v[136:139], a[48:51]
  s_add_u32 s24, s24, 32768
  v_mfma_f32_16x16x32_bf16 a[56:59], v[88:91], v[140:143], a[56:59]
  s_and_b32 s24, s24, 0x1ffff
  v_mfma_f32_16x16x32_bf16 a[112:115], v[88:91], v[144:147], a[112:115]
  v_mfma_f32_16x16x32_bf16 a[120:123], v[88:91], v[148:151], a[120:123]
  s_bitcmp1_b32 s76, s28
  v_mfma_f32_16x16x32_bf16 a[176:179], v[88:91], v[152:155], a[176:179]
  s_cbranch_scc1 fa_hk1
fa_hb1:
  v_mfma_f32_16x16x32_bf16 a[184:187], v[88:91], v[156:159], a[184:187]
  v_mfma_f32_16x16x32_bf16 a[244:247], v[92:95], v[128:131], a[244:247]
  v_mfma_f32_16x16x32_bf16 a[252:255], v[92:95], v[132:135], a[252:255]
  s_add_u32 s28, s28, 1
  v_mfma_f32_16x16x32_bf16 a[52:55], v[92:95], v[136:139], a[52:55]
  v_mfma_f32_16x16x32_bf16 a[60:63], v[92:95], v[140:143], a[60:63]
  v_mfma_f32_16x16x32_bf16 a[116:119], v[92:95], v[144:147], a[116:119]
  v_mfma_f32_16x16x32_bf16 a[124:127], v[92:95], v[148:151], a[124:127]
  s_cmp_lt_u32 s28, 8
  v_mfma_f32_16x16x32_bf16 a[180:183], v[92:95], v[152:155], a[180:183]
  s_waitcnt lgkmcnt(0)
  v_mfma_f32_16x16x32_bf16 a[188:191], v[92:95], v[156:159], a[188:191]
  s_cbranch_scc1 fa_loopK
  s_mov_b32 s64, 16777216
  s_mov_b32 s76, 0x3e0293ee
  s_branch fa_p1epi
fa_roleV:
  ds_read_b128 v[32:35], v14 offset:0
  ds_read_b128 v[36:39], v14 offset:1024
  ds_read_b128 v[40:43], v14 offset:4096
  ds_read_b128 v[44:47], v14 offset:5120
  ds_read_b128 v[48:51], v14 offset:8192
  ds_read_b128 v[52:55], v14 offset:9216
  ds_read_b128 v[56:59], v14 offset:12288
  ds_read_b128 v[60:63], v14 offset:13312
  ds_read_b64_tr_b16 v[96:97], v12 offset:0
  ds_read_b64_tr_b16 v[98:99], v12 offset:1024
  ds_read_b64_tr_b16 v[100:101], v13 offset:0
  ds_read_b64_tr_b16 v[102:103], v13 offset:1024
  ds_read_b64_tr_b16 v[104:105], v12 offset:256
  ds_read_b64_tr_b16 v[106:107], v12 offset:1280
  ds_read_b64_tr_b16 v[108:109], v13 offset:256
  ds_read_b64_tr_b16 v[110:111], v13 offset:1280
  ds_read_b64_tr_b16 v[112:113], v12 offset:512
  ds_read_b64_tr_b16 v[114:115], v12 offset:1536
  ds_read_b64_tr_b16 v[116:117], v13 offset:512
  ds_read_b64_tr_b16 v[118:119], v13 offset:1536
  ds_read_b64_tr_b16 v[120:121], v12 offset:768
  ds_read_b64_tr_b16 v[122:123], v12 offset:1792
  ds_read_b64_tr_b16 v[124:125], v13 offset:768
  ds_read_b64_tr_b16 v[126:127], v13 offset:1792
  s_mov_b32 m0, s24
  s_nop 0
  buffer_load_dwordx4 v3, s[32:35], s26 offen offset:0 sc1 lds
  buffer_load_dwordx4 v4, s[32:35], s26 offen offset:1024 sc1 lds
  buffer_load_dwordx4 v5, s[32:35], s26 offen offset:2048 sc1 lds
  buffer_load_dwordx4 v6, s[32:35], s26 offen offset:3072 sc1 lds
  s_add_u32 m0, s24, 16384
  s_nop 0
  buffer_load_dwordx4 v8, s[36:39], s27 offen offset:0 lds
  buffer_load_dwordx4 v9, s[36:39], s27 offen offset:1024 lds
  buffer_load_dwordx4 v10, s[36:39], s27 offen offset:2048 lds
  buffer_load_dwordx4 v11, s[36:39], s27 offen offset:3072 lds
  s_add_u32 s26, s26, s79
  s_add_u32 s27, s27, s25
  s_add_u32 s24, s24, 32768
  s_and_b32 s24, s24, 0x1ffff
  buffer_load_dword v231, v19, s[32:35], 0 offen
  s_mov_b32 m0, s24
  s_nop 0
  buffer_load_dwordx4 v3, s[32:35], s26 offen offset:0 sc1 lds
  buffer_load_dwordx4 v4, s[32:35], s26 offen offset:1024 sc1 lds
  buffer_load_dwordx4 v5, s[32:35], s26 offen offset:2048 sc1 lds
  buffer_load_dwordx4 v6, s[32:35], s26 offen offset:3072 sc1 lds
  s_add_u32 m0, s24, 16384
  s_nop 0
  buffer_load_dwordx4 v8, s[36:39], s27 offen offset:0 lds
  buffer_load_dwordx4 v9, s[36:39], s27 offen offset:1024 lds
  buffer_load_dwordx4 v10, s[36:39], s27 offen offset:2048 lds
  buffer_load_dwordx4 v11, s[36:39], s27 offen offset:3072 lds
  s_add_u32 s26, s26, s79
  s_add_u32 s27, s27, s25
  s_add_u32 s24, s24, 32768
  s_and_b32 s24, s24, 0x1ffff
  s_waitcnt lgkmcnt(0)
.p2align 6
fa_loopV:
  v_mfma_f32_16x16x32_bf16 a[192:195], v[32:35], v[96:99], a[192:195]
  s_waitcnt vmcnt(17)
  v_mfma_f32_16x16x32_bf16 a[200:203], v[32:35], v[100:103], a[200:203]
  s_barrier
  v_mfma_f32_16x16x32_bf16 a[208:211], v[32:35], v[104:107], a[208:211]
  ds_read_b64_tr_b16 v[128:129], v12 offset:32768
  v_mfma_f32_16x16x32_bf16 a[216:219], v[32:35], v[108:111], a[216:219]
  v_mfma_f32_16x16x32_bf16 a[224:227], v[32:35], v[112:115], a[224:227]
  s_mov_b32 m0, s24
  ds_read_b64_tr_b16 v[130:131], v12 offset:33792
  v_mfma_f32_16x16x32_bf16 a[232:235], v[32:35], v[116:119], a[232:235]
  buffer_load_dwordx4 v3, s[32:35], s26 offen offset:0 sc1 lds
  v_mfma_f32_16x16x32_bf16 a[240:243], v[32:35], v[120:123], a[240:243]
  ds_read_b128 v[64:67], v14 offset:32768
  v_mfma_f32_16x16x32_bf16 a[248:251], v[32:35], v[124:127], a[248:251]
  buffer_load_dwordx4 v4, s[32:35], s26 offen offset:1024 sc1 lds
  v_mfma_f32_16x16x32_bf16 a[196:199], v[36:39], v[96:99], a[196:199]
  ds_read_b64_tr_b16 v[132:133], v13 offset:32768
  v_mfma_f32_16x16x32_bf16 a[204:207], v[36:39], v[100:103], a[204:207]
  buffer_load_dwordx4 v5, s[32:35], s26 offen offset:2048 sc1 lds
  v_mfma_f32_16x16x32_bf16 a[212:215], v[36:39], v[104:107], a[212:215]
  ds_read_b64_tr_b16 v[134:135], v13 offset:33792
  v_mfma_f32_16x16x32_bf16 a[220:223], v[36:39], v[108:111], a[220:223]
  buffer_load_dwordx4 v6, s[32:35], s26 offen offset:3072 sc1 lds
  v_mfma_f32_16x16x32_bf16 a[228:231], v[36:39], v[112:115], a[228:231]
  s_add_u32 m0, s24, 16384
  ds_read_b128 v[68:71], v14 offset:33792
  v_mfma_f32_16x16x32_bf16 a[236:239], v[36:39], v[116:119], a[236:239]
  buffer_load_dwordx4 v8, s[36:39], s27 offen offset:0 lds
  v_mfma_f32_16x16x32_bf16 a[244:247], v[36:39], v[120:123], a[244:247]
  ds_read_b64_tr_b16 v[136:137], v12 offset:33024
  v_mfma_f32_16x16x32_bf16 a[252:255], v[36:39], v[124:127], a[252:255]
  buffer_load_dwordx4 v9, s[36:39], s27 offen offset:1024 lds
  v_mfma_f32_16x16x32_bf16 a[0:3], v[40:43], v[96:99], a[0:3]
  ds_read_b64_tr_b16 v[138:139], v12 offset:34048
  v_mfma_f32_16x16x32_bf16 a[8:11], v[40:43], v[100:103], a[8:11]
  buffer_load_dwordx4 v10, s[36:39], s27 offen offset:2048 lds
  v_mfma_f32_16x16x32_bf16 a[16:19], v[40:43], v[104:107], a[16:19]
  ds_read_b128 v[72:75], v14 offset:36864
  v_mfma_f32_16x16x32_bf16 a[24:27], v[40:43], v[108:111], a[24:27]
  buffer_load_dwordx4 v11, s[36:39], s27 offen offset:3072 lds
  v_mfma_f32_16x16x32_bf16 a[32:35], v[40:43], v[112:115], a[32:35]
  ds_read_b64_tr_b16 v[140:141], v13 offset:33024
  v_mfma_f32_16x16x32_bf16 a[40:43], v[40:43], v[116:119], a[40:43]
  buffer_load_dword v231, v235, s[48:51], s74 offen sc1
  v_mfma_f32_16x16x32_bf16 a[48:51], v[40:43], v[120:123], a[48:51]
  s_add_u32 s74, s74, s73
  ds_read_b64_tr_b16 v[142:143], v13 offset:34048
  v_mfma_f32_16x16x32_bf16 a[56:59], v[40:43], v[124:127], a[56:59]
  s_bitcmp1_b32 s72, s28
  v_mfma_f32_16x16x32_bf16 a[4:7], v[44:47], v[96:99], a[4:7]
  s_cbranch_scc1 fa_hk2
fa_hb2:
  ds_read_b128 v[76:79], v14 offset:37888
  v_mfma_f32_16x16x32_bf16 a[12:15], v[44:47], v[100:103], a[12:15]
  v_mfma_f32_16x16x32_bf16 a[20:23], v[44:47], v[104:107], a[20:23]
  ds_read_b64_tr_b16 v[144:145], v12 offset:33280
  v_mfma_f32_16x16x32_bf16 a[28:31], v[44:47], v[108:111], a[28:31]
  v_mfma_f32_16x16x32_bf16 a[36:39], v[44:47], v[112:115], a[36:39]
  ds_read_b64_tr_b16 v[146:147], v12 offset:34304
  v_mfma_f32_16x16x32_bf16 a[44:47], v[44:47], v[116:119], a[44:47]
  v_mfma_f32_16x16x32_bf16 a[52:55], v[44:47], v[120:123], a[52:55]
  ds_read_b128 v[80:83], v14 offset:40960
  v_mfma_f32_16x16x32_bf16 a[60:63], v[44:47], v[124:127], a[60:63]
  v_mfma_f32_16x16x32_bf16 a[64:67], v[48:51], v[96:99], a[64:67]
  ds_read_b64_tr_b16 v[148:149], v13 offset:33280
  v_mfma_f32_16x16x32_bf16 a[72:75], v[48:51], v[100:103], a[72:75]
  v_mfma_f32_16x16x32_bf16 a[80:83], v[48:51], v[104:107], a[80:83]
  ds_read_b64_tr_b16 v[150:151], v13 offset:34304
  v_mfma_f32_16x16x32_bf16 a[88:91], v[48:51], v[108:111], a[88:91]
  v_mfma_f32_16x16x32_bf16 a[96:99], v[48:51], v[112:115], a[96:99]
  ds_read_b128 v[84:87], v14 offset:41984
  v_mfma_f32_16x16x32_bf16 a[104:107], v[48:51], v[116:119], a[104:107]
  v_mfma_f32_16x16x32_bf16 a[112:115], v[48:51], v[120:123], a[112:115]
  ds_read_b64_tr_b16 v[152:153], v12 offset:33536
  v_mfma_f32_16x16x32_bf16 a[120:123], v[48:51], v[124:127], a[120:123]
  v_mfma_f32_16x16x32_bf16 a[68:71], v[52:55], v[96:99], a[68:71]
  ds_read_b64_tr_b16 v[154:155], v12 offset:34560
  v_mfma_f32_16x16x32_bf16 a[76:79], v[52:55], v[100:103], a[76:79]
  v_mfma_f32_16x16x32_bf16 a[84:87], v[52:55], v[104:107], a[84:87]
  ds_read_b128 v[88:91], v14 offset:45056
  v_mfma_f32_16x16x32_bf16 a[92:95], v[52:55], v[108:111], a[92:95]
  v_mfma_f32_16x16x32_bf16 a[100:103], v[52:55], v[112:115], a[100:103]
  ds_read_b64_tr_b16 v[156:157], v13 offset:33536
  v_mfma_f32_16x16x32_bf16 a[108:111], v[52:55], v[116:119], a[108:111]
  v_mfma_f32_16x16x32_bf16 a[116:119], v[52:55], v[120:123], a[116:119]
  ds_read_b64_tr_b16 v[158:159], v13 offset:34560
  v_mfma_f32_16x16x32_bf16 a[124:127], v[52:55], v[124:127], a[124:127]
  v_mfma_f32_16x16x32_bf16 a[128:131], v[56:59], v[96:99], a[128:131]
  s_add_u32 s26, s26, s79
  ds_read_b128 v[92:95], v14 offset:46080
  v_mfma_f32_16x16x32_bf16 a[136:139], v[56:59], v[100:103], a[136:139]
  s_add_u32 s27, s27, s25
  v_mfma_f32_16x16x32_bf16 a[144:147], v[56:59], v[104:107], a[144:147]
  s_add_u32 s24, s24, 32768
  v_mfma_f32_16x16x32_bf16 a[152:155], v[56:59], v[108:111], a[152:155]
  s_and_b32 s24, s24, 0x1ffff
  v_mfma_f32_16x16x32_bf16 a[160:163], v[56:59], v[112:115], a[160:163]
  v_xor_b32 v14, 0x10000, v14
  v_mfma_f32_16x16x32_bf16 a[168:171], v[56:59], v[116:119], a[168:171]
  v_xor_b32 v12, 0x10000, v12
  v_mfma_f32_16x16x32_bf16 a[176:179], v[56:59], v[120:123], a[176:179]
  v_xor_b32 v13, 0x10000, v13
  v_mfma_f32_16x16x32_bf16 a[184:187], v[56:59], v[124:127], a[184:187]
  v_mfma_f32_16x16x32_bf16 a[132:135], v[60:63], v[96:99], a[132:135]
  v_mfma_f32_16x16x32_bf16 a[140:143], v[60:63], v[100:103], a[140:143]
  v_mfma_f32_16x16x32_bf16 a[148:151], v[60:63], v[104:107], a[148:151]
  v_mfma_f32_16x16x32_bf16 a[156:159], v[60:63], v[108:111], a[156:159]
  v_mfma_f32_16x16x32_bf16 a[164:167], v[60:63], v[112:115], a[164:167]
  v_mfma_f32_16x16x32_bf16 a[172:175], v[60:63], v[116:119], a[172:175]
  v_mfma_f32_16x16x32_bf16 a[180:183], v[60:63], v[120:123], a[180:183]
  v_mfma_f32_16x16x32_bf16 a[188:191], v[60:63], v[124:127], a[188:191]
  s_waitcnt lgkmcnt(0)
  v_mfma_f32_16x16x32_bf16 a[192:195], v[64:67], v[128:131], a[192:195]
  s_waitcnt vmcnt(18)
  v_mfma_f32_16x16x32_bf16 a[200:203], v[64:67], v[132:135], a[200:203]
  s_barrier
  v_mfma_f32_16x16x32_bf16 a[208:211], v[64:67], v[136:139], a[208:211]
  ds_read_b64_tr_b16 v[96:97], v12 offset:0
  v_mfma_f32_16x16x32_bf16 a[216:219], v[64:67], v[140:143], a[216:219]
  v_mfma_f32_16x16x32_bf16 a[224:227], v[64:67], v[144:147], a[224:227]
  s_mov_b32 m0, s24
  ds_read_b64_tr_b16 v[98:99], v12 offset:1024
  v_mfma_f32_16x16x32_bf16 a[232:235], v[64:67], v[148:151], a[232:235]
  buffer_load_dwordx4 v3, s[32:35], s26 offen offset:0 sc1 lds
  v_mfma_f32_16x16x32_bf16 a[240:243], v[64:67], v[152:155], a[240:243]
  ds_read_b128 v[32:35], v14 offset:0
  v_mfma_f32_16x16x32_bf16 a[248:251], v[64:67], v[156:159], a[248:251]
  v_mfma_f32_16x16x32_bf16 a[196:199], v[68:71], v[128:131], a[196:199]
  ds_read_b64_tr_b16 v[100:101], v13 offset:0
  v_mfma_f32_16x16x32_bf16 a[204:207], v[68:71], v[132:135], a[204:207]
  v_mfma_f32_16x16x32_bf16 a[212:215], v[68:71], v[136:139], a[212:215]
  ds_read_b64_tr_b16 v[102:103], v13 offset:1024
  v_mfma_f32_16x16x32_bf16 a[220:223], v[68:71], v[140:143], a[220:223]
  buffer_load_dwordx4 v4, s[32:35], s26 offen offset:1024 sc1 lds
  v_mfma_f32_16x16x32_bf16 a[228:231], v[68:71], v[144:147], a[228:231]
  ds_read_b128 v[36:39], v14 offset:1024
  v_mfma_f32_16x16x32_bf16 a[236:239], v[68:71], v[148:151], a[236:239]
  v_mfma_f32_16x16x32_bf16 a[244:247], v[68:71], v[152:155], a[244:247]
  ds_read_b64_tr_b16 v[104:105], v12 offset:256
  v_mfma_f32_16x16x32_bf16 a[252:255], v[68:71], v[156:159], a[252:255]
  v_mfma_f32_16x16x32_bf16 a[0:3], v[72:75], v[128:131], a[0:3]
  ds_read_b64_tr_b16 v[106:107], v12 offset:1280
  v_mfma_f32_16x16x32_bf16 a[8:11], v[72:75], v[132:135], a[8:11]
  buffer_load_dwordx4 v5, s[32:35], s26 offen offset:2048 sc1 lds
  v_mfma_f32_16x16x32_bf16 a[16:19], v[72:75], v[136:139], a[16:19]
  ds_read_b128 v[40:43], v14 offset:4096
  v_mfma_f32_16x16x32_bf16 a[24:27], v[72:75], v[140:143], a[24:27]
  v_mfma_f32_16x16x32_bf16 a[32:35], v[72:75], v[144:147], a[32:35]
  ds_read_b64_tr_b16 v[108:109], v13 offset:256
  v_mfma_f32_16x16x32_bf16 a[40:43], v[72:75], v[148:151], a[40:43]
  v_mfma_f32_16x16x32_bf16 a[48:51], v[72:75], v[152:155], a[48:51]
  ds_read_b64_tr_b16 v[110:111], v13 offset:1280
  v_mfma_f32_16x16x32_bf16 a[56:59], v[72:75], v[156:159], a[56:59]
  buffer_load_dwordx4 v6, s[32:35], s26 offen offset:3072 sc1 lds
  v_mfma_f32_16x16x32_bf16 a[4:7], v[76:79], v[128:131], a[4:7]
  ds_read_b128 v[44:47], v14 offset:5120
  v_mfma_f32_16x16x32_bf16 a[12:15], v[76:79], v[132:135], a[12:15]
  v_mfma_f32_16x16x32_bf16 a[20:23], v[76:79], v[136:139], a[20:23]
  ds_read_b64_tr_b16 v[112:113], v12 offset:512
  v_mfma_f32_16x16x32_bf16 a[28:31], v[76:79], v[140:143], a[28:31]
  v_mfma_f32_16x16x32_bf16 a[36:39], v[76:79], v[144:147], a[36:39]
  s_add_u32 m0, s24, 16384
  ds_read_b64_tr_b16 v[114:115], v12 offset:1536
  v_mfma_f32_16x16x32_bf16 a[44:47], v[76:79], v[148:151], a[44:47]
  buffer_load_dwordx4 v8, s[36:39], s27 offen offset:0 lds
  v_mfma_f32_16x16x32_bf16 a[52:55], v[76:79], v[152:155], a[52:55]
  ds_read_b128 v[48:51], v14 offset:8192
  v_mfma_f32_16x16x32_bf16 a[60:63], v[76:79], v[156:159], a[60:63]
  v_mfma_f32_16x16x32_bf16 a[64:67], v[80:83], v[128:131], a[64:67]
  ds_read_b64_tr_b16 v[116:117], v13 offset:512
  v_mfma_f32_16x16x32_bf16 a[72:75], v[80:83], v[132:135], a[72:75]
  v_mfma_f32_16x16x32_bf16 a[80:83], v[80:83], v[136:139], a[80:83]
  ds_read_b64_tr_b16 v[118:119], v13 offset:1536
  v_mfma_f32_16x16x32_bf16 a[88:91], v[80:83], v[140:143], a[88:91]
  buffer_load_dwordx4 v9, s[36:39], s27 offen offset:1024 lds
  v_mfma_f32_16x16x32_bf16 a[96:99], v[80:83], v[144:147], a[96:99]
  ds_read_b128 v[52:55], v14 offset:9216
  v_mfma_f32_16x16x32_bf16 a[104:107], v[80:83], v[148:151], a[104:107]
  v_mfma_f32_16x16x32_bf16 a[112:115], v[80:83], v[152:155], a[112:115]
  ds_read_b64_tr_b16 v[120:121], v12 offset:768
  v_mfma_f32_16x16x32_bf16 a[120:123], v[80:83], v[156:159], a[120:123]
  v_mfma_f32_16x16x32_bf16 a[68:71], v[84:87], v[128:131], a[68:71]
  ds_read_b64_tr_b16 v[122:123], v12 offset:1792
  v_mfma_f32_16x16x32_bf16 a[76:79], v[84:87], v[132:135], a[76:79]
  buffer_load_dwordx4 v10, s[36:39], s27 offen offset:2048 lds
  v_mfma_f32_16x16x32_bf16 a[84:87], v[84:87], v[136:139], a[84:87]
  ds_read_b128 v[56:59], v14 offset:12288
  v_mfma_f32_16x16x32_bf16 a[92:95], v[84:87], v[140:143], a[92:95]
  v_mfma_f32_16x16x32_bf16 a[100:103], v[84:87], v[144:147], a[100:103]
  ds_read_b64_tr_b16 v[124:125], v13 offset:768
  v_mfma_f32_16x16x32_bf16 a[108:111], v[84:87], v[148:151], a[108:111]
  v_mfma_f32_16x16x32_bf16 a[116:119], v[84:87], v[152:155], a[116:119]
  ds_read_b64_tr_b16 v[126:127], v13 offset:1792
  v_mfma_f32_16x16x32_bf16 a[124:127], v[84:87], v[156:159], a[124:127]
  buffer_load_dwordx4 v11, s[36:39], s27 offen offset:3072 lds
  v_mfma_f32_16x16x32_bf16 a[128:131], v[88:91], v[128:131], a[128:131]
  s_add_u32 s26, s26, s79
  ds_read_b128 v[60:63], v14 offset:13312
  v_mfma_f32_16x16x32_bf16 a[136:139], v[88:91], v[132:135], a[136:139]
  s_add_u32 s27, s27, s25
  v_mfma_f32_16x16x32_bf16 a[144:147], v[88:91], v[136:139], a[144:147]
  s_add_u32 s24, s24, 32768
  v_mfma_f32_16x16x32_bf16 a[152:155], v[88:91], v[140:143], a[152:155]
  s_and_b32 s24, s24, 0x1ffff
  v_mfma_f32_16x16x32_bf16 a[160:163], v[88:91], v[144:147], a[160:163]
  v_mfma_f32_16x16x32_bf16 a[168:171], v[88:91], v[148:151], a[168:171]
  s_bitcmp1_b32 s76, s28
  v_mfma_f32_16x16x32_bf16 a[176:179], v[88:91], v[152:155], a[176:179]
  s_cbranch_scc1 fa_hk3
fa_hb3:
  v_mfma_f32_16x16x32_bf16 a[184:187], v[88:91], v[156:159], a[184:187]
  v_mfma_f32_16x16x32_bf16 a[132:135], v[92:95], v[128:131], a[132:135]
  v_mfma_f32_16x16x32_bf16 a[140:143], v[92:95], v[132:135], a[140:143]
  s_add_u32 s28, s28, 1
  v_mfma_f32_16x16x32_bf16 a[148:151], v[92:95], v[136:139], a[148:151]
  v_mfma_f32_16x16x32_bf16 a[156:159], v[92:95], v[140:143], a[156:159]
  v_mfma_f32_16x16x32_bf16 a[164:167], v[92:95], v[144:147], a[164:167]
  v_mfma_f32_16x16x32_bf16 a[172:175], v[92:95], v[148:151], a[172:175]
  s_cmp_lt_u32 s28, 8
  v_mfma_f32_16x16x32_bf16 a[180:183], v[92:95], v[152:155], a[180:183]
  s_waitcnt lgkmcnt(0)
  v_mfma_f32_16x16x32_bf16 a[188:191], v[92:95], v[156:159], a[188:191]
  s_cbranch_scc1 fa_loopV
  s_mov_b32 s64, 33554432
  s_mov_b32 s76, 1.0
fa_p1epi:
  s_lshr_b32 s23, s20, 1
  s_lshl_b32 s23, s23, 13
  v_subrev_u32 v12, s23, v12
  v_subrev_u32 v13, s23, v13
  s_lshl_b32 s24, s20, 12
  v_add_u32 v14, s24, v2
  ds_read_b64_tr_b16 v[32:33], v12 offset:0
  ds_read_b64_tr_b16 v[34:35], v12 offset:1024
  ds_read_b64_tr_b16 v[36:37], v13 offset:0
  ds_read_b64_tr_b16 v[38:39], v13 offset:1024
  ds_read_b64_tr_b16 v[40:41], v12 offset:256
  ds_read_b64_tr_b16 v[42:43], v12 offset:1280
  ds_read_b64_tr_b16 v[44:45], v13 offset:256
  ds_read_b64_tr_b16 v[46:47], v13 offset:1280
  ds_read_b64_tr_b16 v[48:49], v12 offset:512
  ds_read_b64_tr_b16 v[50:51], v12 offset:1536
  ds_read_b64_tr_b16 v[52:53], v13 offset:512
  ds_read_b64_tr_b16 v[54:55], v13 offset:1536
  ds_read_b64_tr_b16 v[56:57], v12 offset:768
  ds_read_b64_tr_b16 v[58:59], v12 offset:1792
  ds_read_b64_tr_b16 v[60:61], v13 offset:768
  ds_read_b64_tr_b16 v[62:63], v13 offset:1792
  s_waitcnt vmcnt(8)
  ds_read_b128 v[224:227], v14 offset:0
  ds_read_b128 v[228:231], v14 offset:1024
  ds_read_b128 v[232:235], v14 offset:2048
  ds_read_b128 v[236:239], v14 offset:3072
  s_lshl_b32 s23, s21, 19
  s_add_u32 s64, s64, s23
  s_lshl_b32 s23, s22, 14
  s_add_u32 s64, s64, s23
  s_and_b32 s23, s20, 1
  s_lshl_b32 s23, s23, 13
  s_add_u32 s64, s64, s23
  s_lshl_b32 s23, s21, 19
  s_add_u32 s23, s23, 16777216
  s_add_u32 s6, s18, s23
  s_addc_u32 s7, s19, 0
  s_add_u32 s8, s6, 16777216
  s_addc_u32 s9, s7, 0
  s_sub_u32 s23, 16, s22
  s_lshl_b32 s23, s23, 15
  s_mov_b32 s44, s6
  s_mov_b32 s45, s7
  s_mov_b32 s46, s23
  s_mov_b32 s47, 0x20000
  s_mov_b32 s48, s8
  s_mov_b32 s49, s9
  s_mov_b32 s50, s23
  s_mov_b32 s51, 0x20000
  s_lshl_b32 s30, s21, 10
  s_add_u32 s30, s30, 67108864
  s_mov_b32 s81, 0x47800000
  s_cmp_eq_u32 s20, 0
  s_cselect_b32 s65, s82, 1073741824
  s_waitcnt vmcnt(21) lgkmcnt(0)
  v_mfma_f32_16x16x32_bf16 v[96:99], v[32:35], v[224:227], 0
  v_accvgpr_read_b32 v16, a192
  v_accvgpr_read_b32 v17, a193
  v_accvgpr_read_b32 v18, a194
  v_mfma_f32_16x16x32_bf16 v[112:115], v[36:39], v[224:227], 0
  ds_read_b64_tr_b16 v[64:65], v12 offset:8192
  v_accvgpr_read_b32 v19, a195
  v_mfma_f32_16x16x32_bf16 v[128:131], v[40:43], v[224:227], 0
  s_add_u32 m0, s24, 0
  ds_read_b64_tr_b16 v[66:67], v12 offset:9216
  v_accvgpr_read_b32 v20, a196
  v_mfma_f32_16x16x32_bf16 v[144:147], v[44:47], v[224:227], 0
  buffer_load_dwordx4 v3, s[32:35], s26 offen offset:0 sc1 lds
  v_accvgpr_read_b32 v21, a197
  v_mfma_f32_16x16x32_bf16 v[160:163], v[48:51], v[224:227], 0
  ds_read_b64_tr_b16 v[68:69], v13 offset:8192
  v_accvgpr_read_b32 v22, a198
  v_accvgpr_read_b32 v23, a199
  v_mfma_f32_16x16x32_bf16 v[176:179], v[52:55], v[224:227], 0
  ds_read_b64_tr_b16 v[70:71], v13 offset:9216
  v_mul_f32 v16, s76, v16
  v_mfma_f32_16x16x32_bf16 v[192:195], v[56:59], v[224:227], 0
  ds_read_b64_tr_b16 v[72:73], v12 offset:8448
  v_mul_f32 v17, s76, v17
  v_mfma_f32_16x16x32_bf16 v[208:211], v[60:63], v[224:227], 0
  ds_read_b64_tr_b16 v[74:75], v12 offset:9472
  v_mul_f32 v18, s76, v18
  v_mfma_f32_16x16x32_bf16 v[100:103], v[32:35], v[228:231], 0
  buffer_load_dwordx4 v4, s[32:35], s26 offen offset:1024 sc1 lds
  v_mul_f32 v19, s76, v19
  v_mul_f32 v20, s76, v20
  v_mfma_f32_16x16x32_bf16 v[116:119], v[36:39], v[228:231], 0
  ds_read_b64_tr_b16 v[76:77], v13 offset:8448
  v_mul_f32 v21, s76, v21
  v_mfma_f32_16x16x32_bf16 v[132:135], v[40:43], v[228:231], 0
  ds_read_b64_tr_b16 v[78:79], v13 offset:9472
  v_mul_f32 v22, s76, v22
  v_mfma_f32_16x16x32_bf16 v[148:151], v[44:47], v[228:231], 0
  ds_read_b128 v[240:243], v14 offset:32768
  v_mul_f32 v23, s76, v23
  v_mfma_f32_16x16x32_bf16 v[164:167], v[48:51], v[228:231], 0
  ds_read_b128 v[244:247], v14 offset:33792
  v_cvt_pk_bf16_f32 v24, v16, v17
  v_cvt_pk_bf16_f32 v25, v18, v19
  v_mfma_f32_16x16x32_bf16 v[180:183], v[52:55], v[228:231], 0
  buffer_load_dwordx4 v5, s[32:35], s26 offen offset:2048 sc1 lds
  v_cvt_pk_bf16_f32 v26, v20, v21
  v_mfma_f32_16x16x32_bf16 v[196:199], v[56:59], v[228:231], 0
  ds_read_b64_tr_b16 v[80:81], v12 offset:8704
  v_cvt_pk_bf16_f32 v27, v22, v23
  v_mfma_f32_16x16x32_bf16 v[212:215], v[60:63], v[228:231], 0
  ds_read_b64_tr_b16 v[82:83], v12 offset:9728
  buffer_store_dwordx4 v[24:27], v2, s[40:43], s64 offen offset:0 sc1
  v_mfma_f32_16x16x32_bf16 v[104:107], v[32:35], v[232:235], 0
  ds_read_b64_tr_b16 v[84:85], v13 offset:8704
  v_accvgpr_read_b32 v16, a200
  v_mfma_f32_16x16x32_bf16 v[120:123], v[36:39], v[232:235], 0
  ds_read_b64_tr_b16 v[86:87], v13 offset:9728
  v_accvgpr_read_b32 v17, a201
  v_accvgpr_read_b32 v18, a202
  v_mfma_f32_16x16x32_bf16 v[136:139], v[40:43], v[232:235], 0
  buffer_load_dwordx4 v6, s[32:35], s26 offen offset:3072 sc1 lds
  v_accvgpr_read_b32 v19, a203
  v_mfma_f32_16x16x32_bf16 v[152:155], v[44:47], v[232:235], 0
  s_add_u32 s26, s26, 1024
  ds_read_b64_tr_b16 v[88:89], v12 offset:8960
  v_accvgpr_read_b32 v20, a204
  v_mfma_f32_16x16x32_bf16 v[168:171], v[48:51], v[232:235], 0
  ds_read_b64_tr_b16 v[90:91], v12 offset:9984
  v_accvgpr_read_b32 v21, a205
  v_mfma_f32_16x16x32_bf16 v[184:187], v[52:55], v[232:235], 0
  ds_read_b64_tr_b16 v[92:93], v13 offset:8960
  v_accvgpr_read_b32 v22, a206
  v_accvgpr_read_b32 v23, a207
  v_mfma_f32_16x16x32_bf16 v[200:203], v[56:59], v[232:235], 0
  ds_read_b64_tr_b16 v[94:95], v13 offset:9984
  v_mul_f32 v16, s76, v16
  v_mfma_f32_16x16x32_bf16 v[216:219], v[60:63], v[232:235], 0
  v_mul_f32 v17, s76, v17
  v_mul_f32 v18, s76, v18
  v_mfma_f32_16x16x32_bf16 v[108:111], v[32:35], v[236:239], 0
  ds_read_b128 v[248:251], v14 offset:34816
  v_mul_f32 v19, s76, v19
  v_mfma_f32_16x16x32_bf16 v[124:127], v[36:39], v[236:239], 0
  ds_read_b128 v[252:255], v14 offset:35840
  v_mul_f32 v20, s76, v20
  v_mul_f32 v21, s76, v21
  v_mfma_f32_16x16x32_bf16 v[140:143], v[40:43], v[236:239], 0
  v_mul_f32 v22, s76, v22
  v_mul_f32 v23, s76, v23
  v_mfma_f32_16x16x32_bf16 v[156:159], v[44:47], v[236:239], 0
  v_xor_b32 v14, 0x10000, v14
  v_cvt_pk_bf16_f32 v28, v16, v17
  v_mfma_f32_16x16x32_bf16 v[172:175], v[48:51], v[236:239], 0
  v_cvt_pk_bf16_f32 v29, v18, v19
  v_cvt_pk_bf16_f32 v30, v20, v21
  v_mfma_f32_16x16x32_bf16 v[188:191], v[52:55], v[236:239], 0
  v_cvt_pk_bf16_f32 v31, v22, v23
  v_mfma_f32_16x16x32_bf16 v[204:207], v[56:59], v[236:239], 0
  buffer_store_dwordx4 v[28:31], v2, s[40:43], s64 offen offset:1024 sc1
  v_mfma_f32_16x16x32_bf16 v[220:223], v[60:63], v[236:239], 0
  s_waitcnt vmcnt(19) lgkmcnt(0)
  v_mfma_f32_16x16x32_bf16 v[96:99], v[64:67], v[240:243], v[96:99]
  s_barrier
  v_accvgpr_read_b32 v16, a208
  v_accvgpr_read_b32 v17, a209
  v_accvgpr_read_b32 v18, a210
  v_mfma_f32_16x16x32_bf16 v[112:115], v[68:71], v[240:243], v[112:115]
  ds_read_b64_tr_b16 v[32:33], v12 offset:32768
  v_accvgpr_read_b32 v19, a211
  v_mfma_f32_16x16x32_bf16 v[128:131], v[72:75], v[240:243], v[128:131]
  s_add_u32 m0, s24, 32768
  ds_read_b64_tr_b16 v[34:35], v12 offset:33792
  v_accvgpr_read_b32 v20, a212
  v_mfma_f32_16x16x32_bf16 v[144:147], v[76:79], v[240:243], v[144:147]
  buffer_load_dwordx4 v3, s[32:35], s26 offen offset:0 sc1 lds
  v_accvgpr_read_b32 v21, a213
  v_mfma_f32_16x16x32_bf16 v[160:163], v[80:83], v[240:243], v[160:163]
  ds_read_b64_tr_b16 v[36:37], v13 offset:32768
  v_accvgpr_read_b32 v22, a214
  v_accvgpr_read_b32 v23, a215
  v_mfma_f32_16x16x32_bf16 v[176:179], v[84:87], v[240:243], v[176:179]
  ds_read_b64_tr_b16 v[38:39], v13 offset:33792
  v_mul_f32 v16, s76, v16
  v_mfma_f32_16x16x32_bf16 v[192:195], v[88:91], v[240:243], v[192:195]
  ds_read_b64_tr_b16 v[40:41], v12 offset:33024
  v_mul_f32 v17, s76, v17
  v_mfma_f32_16x16x32_bf16 v[208:211], v[92:95], v[240:243], v[208:211]
  ds_read_b64_tr_b16 v[42:43], v12 offset:34048
  v_mul_f32 v18, s76, v18
  v_mfma_f32_16x16x32_bf16 v[100:103], v[64:67], v[244:247], v[100:103]
  buffer_load_dwordx4 v4, s[32:35], s26 offen offset:1024 sc1 lds
  v_mul_f32 v19, s76, v19
  v_mul_f32 v20, s76, v20
  v_mfma_f32_16x16x32_bf16 v[116:119], v[68:71], v[244:247], v[116:119]
  ds_read_b64_tr_b16 v[44:45], v13 offset:33024
  v_mul_f32 v21, s76, v21
  v_mfma_f32_16x16x32_bf16 v[132:135], v[72:75], v[244:247], v[132:135]
  ds_read_b64_tr_b16 v[46:47], v13 offset:34048
  v_mul_f32 v22, s76, v22
  v_mfma_f32_16x16x32_bf16 v[148:151], v[76:79], v[244:247], v[148:151]
  ds_read_b128 v[224:227], v14 offset:0
  v_mul_f32 v23, s76, v23
  v_mfma_f32_16x16x32_bf16 v[164:167], v[80:83], v[244:247], v[164:167]
  ds_read_b128 v[228:231], v14 offset:1024
  v_cvt_pk_bf16_f32 v24, v16, v17
  v_cvt_pk_bf16_f32 v25, v18, v19
  v_mfma_f32_16x16x32_bf16 v[180:183], v[84:87], v[244:247], v[180:183]
  buffer_load_dwordx4 v5, s[32:35], s26 offen offset:2048 sc1 lds
  v_cvt_pk_bf16_f32 v26, v20, v21
  v_mfma_f32_16x16x32_bf16 v[196:199], v[88:91], v[244:247], v[196:199]
  ds_read_b64_tr_b16 v[48:49], v12 offset:33280
  v_cvt_pk_bf16_f32 v27, v22, v23
  v_mfma_f32_16x16x32_bf16 v[212:215], v[92:95], v[244:247], v[212:215]
  ds_read_b64_tr_b16 v[50:51], v12 offset:34304
  buffer_store_dwordx4 v[24:27], v2, s[40:43], s64 offen offset:2048 sc1
  v_mfma_f32_16x16x32_bf16 v[104:107], v[64:67], v[248:251], v[104:107]
  ds_read_b64_tr_b16 v[52:53], v13 offset:33280
  v_accvgpr_read_b32 v16, a216
  v_mfma_f32_16x16x32_bf16 v[120:123], v[68:71], v[248:251], v[120:123]
  ds_read_b64_tr_b16 v[54:55], v13 offset:34304
  v_accvgpr_read_b32 v17, a217
  v_accvgpr_read_b32 v18, a218
  v_mfma_f32_16x16x32_bf16 v[136:139], v[72:75], v[248:251], v[136:139]
  buffer_load_dwordx4 v6, s[32:35], s26 offen offset:3072 sc1 lds
  v_accvgpr_read_b32 v19, a219
  v_mfma_f32_16x16x32_bf16 v[152:155], v[76:79], v[248:251], v[152:155]
  s_add_u32 s26, s26, 1024
  ds_read_b64_tr_b16 v[56:57], v12 offset:33536
  v_accvgpr_read_b32 v20, a220
  v_mfma_f32_16x16x32_bf16 v[168:171], v[80:83], v[248:251], v[168:171]
  ds_read_b64_tr_b16 v[58:59], v12 offset:34560
  v_accvgpr_read_b32 v21, a221
  v_mfma_f32_16x16x32_bf16 v[184:187], v[84:87], v[248:251], v[184:187]
  ds_read_b64_tr_b16 v[60:61], v13 offset:33536
  v_accvgpr_read_b32 v22, a222
  v_accvgpr_read_b32 v23, a223
  v_mfma_f32_16x16x32_bf16 v[200:203], v[88:91], v[248:251], v[200:203]
  s_add_u32 m0, s24, 16384
  ds_read_b64_tr_b16 v[62:63], v13 offset:34560
  v_mul_f32 v16, s76, v16
  v_mfma_f32_16x16x32_bf16 v[216:219], v[92:95], v[248:251], v[216:219]
  buffer_load_dwordx4 v8, s[36:39], s27 offen offset:0 lds
  v_mul_f32 v17, s76, v17
  v_mfma_f32_16x16x32_bf16 v[108:111], v[64:67], v[252:255], v[108:111]
  ds_read_b128 v[232:235], v14 offset:2048
  v_mul_f32 v18, s76, v18
  v_mfma_f32_16x16x32_bf16 v[124:127], v[68:71], v[252:255], v[124:127]
  ds_read_b128 v[236:239], v14 offset:3072
  v_mul_f32 v19, s76, v19
  v_mul_f32 v20, s76, v20
  v_mfma_f32_16x16x32_bf16 v[140:143], v[72:75], v[252:255], v[140:143]
  v_mul_f32 v21, s76, v21
  v_mul_f32 v22, s76, v22
  v_mfma_f32_16x16x32_bf16 v[156:159], v[76:79], v[252:255], v[156:159]
  v_mul_f32 v23, s76, v23
  v_cvt_pk_bf16_f32 v28, v16, v17
  v_mfma_f32_16x16x32_bf16 v[172:175], v[80:83], v[252:255], v[172:175]
  buffer_load_dwordx4 v9, s[36:39], s27 offen offset:1024 lds
  v_cvt_pk_bf16_f32 v29, v18, v19
  v_mfma_f32_16x16x32_bf16 v[188:191], v[84:87], v[252:255], v[188:191]
  v_cvt_pk_bf16_f32 v30, v20, v21
  v_cvt_pk_bf16_f32 v31, v22, v23
  v_mfma_f32_16x16x32_bf16 v[204:207], v[88:91], v[252:255], v[204:207]
  buffer_store_dwordx4 v[28:31], v2, s[40:43], s64 offen offset:3072 sc1
  v_mfma_f32_16x16x32_bf16 v[220:223], v[92:95], v[252:255], v[220:223]
  s_waitcnt vmcnt(18) lgkmcnt(0)
  v_mfma_f32_16x16x32_bf16 v[96:99], v[32:35], v[224:227], v[96:99]
  s_add_u32 s64, s64, 4096
  v_accvgpr_read_b32 v16, a224
  v_accvgpr_read_b32 v17, a225
  v_mfma_f32_16x16x32_bf16 v[112:115], v[36:39], v[224:227], v[112:115]
  ds_read_b64_tr_b16 v[64:65], v12 offset:40960
  v_accvgpr_read_b32 v18, a226
  v_mfma_f32_16x16x32_bf16 v[128:131], v[40:43], v[224:227], v[128:131]
  s_add_u32 m0, s24, 65536
  ds_read_b64_tr_b16 v[66:67], v12 offset:41984
  v_accvgpr_read_b32 v19, a227
  v_mfma_f32_16x16x32_bf16 v[144:147], v[44:47], v[224:227], v[144:147]
  buffer_load_dwordx4 v3, s[32:35], s26 offen offset:0 sc1 lds
  v_accvgpr_read_b32 v20, a228
  v_mfma_f32_16x16x32_bf16 v[160:163], v[48:51], v[224:227], v[160:163]
  ds_read_b64_tr_b16 v[68:69], v13 offset:40960
  v_accvgpr_read_b32 v21, a229
  v_mfma_f32_16x16x32_bf16 v[176:179], v[52:55], v[224:227], v[176:179]
  ds_read_b64_tr_b16 v[70:71], v13 offset:41984
  v_accvgpr_read_b32 v22, a230
  v_mfma_f32_16x16x32_bf16 v[192:195], v[56:59], v[224:227], v[192:195]
  ds_read_b64_tr_b16 v[72:73], v12 offset:41216
  v_accvgpr_read_b32 v23, a231
  v_mfma_f32_16x16x32_bf16 v[208:211], v[60:63], v[224:227], v[208:211]
  ds_read_b64_tr_b16 v[74:75], v12 offset:42240
  v_mul_f32 v16, s76, v16
  v_mfma_f32_16x16x32_bf16 v[100:103], v[32:35], v[228:231], v[100:103]
  buffer_load_dwordx4 v4, s[32:35], s26 offen offset:1024 sc1 lds
  v_mul_f32 v17, s76, v17
  v_mfma_f32_16x16x32_bf16 v[116:119], v[36:39], v[228:231], v[116:119]
  ds_read_b64_tr_b16 v[76:77], v13 offset:41216
  v_mul_f32 v18, s76, v18
  v_mfma_f32_16x16x32_bf16 v[132:135], v[40:43], v[228:231], v[132:135]
  ds_read_b64_tr_b16 v[78:79], v13 offset:42240
  v_mul_f32 v19, s76, v19
  v_mfma_f32_16x16x32_bf16 v[148:151], v[44:47], v[228:231], v[148:151]
  ds_read_b128 v[240:243], v14 offset:32768
  v_mul_f32 v20, s76, v20
  v_mfma_f32_16x16x32_bf16 v[164:167], v[48:51], v[228:231], v[164:167]
  ds_read_b128 v[244:247], v14 offset:33792
  v_mul_f32 v21, s76, v21
  v_mfma_f32_16x16x32_bf16 v[180:183], v[52:55], v[228:231], v[180:183]
  buffer_load_dwordx4 v5, s[32:35], s26 offen offset:2048 sc1 lds
  v_mul_f32 v22, s76, v22
  v_mfma_f32_16x16x32_bf16 v[196:199], v[56:59], v[228:231], v[196:199]
  ds_read_b64_tr_b16 v[80:81], v12 offset:41472
  v_mul_f32 v23, s76, v23
  v_mfma_f32_16x16x32_bf16 v[212:215], v[60:63], v[228:231], v[212:215]
  ds_read_b64_tr_b16 v[82:83], v12 offset:42496
  v_cvt_pk_bf16_f32 v24, v16, v17
  v_mfma_f32_16x16x32_bf16 v[104:107], v[32:35], v[232:235], v[104:107]
  ds_read_b64_tr_b16 v[84:85], v13 offset:41472
  v_cvt_pk_bf16_f32 v25, v18, v19
  v_mfma_f32_16x16x32_bf16 v[120:123], v[36:39], v[232:235], v[120:123]
  ds_read_b64_tr_b16 v[86:87], v13 offset:42496
  v_cvt_pk_bf16_f32 v26, v20, v21
  v_mfma_f32_16x16x32_bf16 v[136:139], v[40:43], v[232:235], v[136:139]
  buffer_load_dwordx4 v6, s[32:35], s26 offen offset:3072 sc1 lds
  v_cvt_pk_bf16_f32 v27, v22, v23
  v_mfma_f32_16x16x32_bf16 v[152:155], v[44:47], v[232:235], v[152:155]
  s_add_u32 s26, s26, 1024
  ds_read_b64_tr_b16 v[88:89], v12 offset:41728
  buffer_store_dwordx4 v[24:27], v2, s[40:43], s64 offen offset:0 sc1
  v_mfma_f32_16x16x32_bf16 v[168:171], v[48:51], v[232:235], v[168:171]
  ds_read_b64_tr_b16 v[90:91], v12 offset:42752
  v_mfma_f32_16x16x32_bf16 v[184:187], v[52:55], v[232:235], v[184:187]
  ds_read_b64_tr_b16 v[92:93], v13 offset:41728
  v_mfma_f32_16x16x32_bf16 v[200:203], v[56:59], v[232:235], v[200:203]
  s_add_u32 m0, s24, 16384
  ds_read_b64_tr_b16 v[94:95], v13 offset:42752
  v_mfma_f32_16x16x32_bf16 v[216:219], v[60:63], v[232:235], v[216:219]
  buffer_load_dwordx4 v10, s[36:39], s27 offen offset:2048 lds
  v_mfma_f32_16x16x32_bf16 v[108:111], v[32:35], v[236:239], v[108:111]
  ds_read_b128 v[248:251], v14 offset:34816
  v_mfma_f32_16x16x32_bf16 v[124:127], v[36:39], v[236:239], v[124:127]
  ds_read_b128 v[252:255], v14 offset:35840
  v_mfma_f32_16x16x32_bf16 v[140:143], v[40:43], v[236:239], v[140:143]
  v_mfma_f32_16x16x32_bf16 v[156:159], v[44:47], v[236:239], v[156:159]
  v_xor_b32 v14, 0x10000, v14
  v_mfma_f32_16x16x32_bf16 v[172:175], v[48:51], v[236:239], v[172:175]
  buffer_load_dwordx4 v11, s[36:39], s27 offen offset:3072 lds
  v_mfma_f32_16x16x32_bf16 v[188:191], v[52:55], v[236:239], v[188:191]
  s_add_u32 s27, s27, 524288
  v_xor_b32 v12, 0x10000, v12
  v_mfma_f32_16x16x32_bf16 v[204:207], v[56:59], v[236:239], v[204:207]
  v_xor_b32 v13, 0x10000, v13
  v_mfma_f32_16x16x32_bf16 v[220:223], v[60:63], v[236:239], v[220:223]
  s_waitcnt vmcnt(16) lgkmcnt(0)
  v_mfma_f32_16x16x32_bf16 v[96:99], v[64:67], v[240:243], v[96:99]
  s_barrier
  v_accvgpr_read_b32 v16, a232
  v_accvgpr_read_b32 v17, a233
  v_mfma_f32_16x16x32_bf16 v[112:115], v[68:71], v[240:243], v[112:115]
  ds_read_b64_tr_b16 v[32:33], v12 offset:0
  v_accvgpr_read_b32 v18, a234
  v_mfma_f32_16x16x32_bf16 v[128:131], v[72:75], v[240:243], v[128:131]
  s_add_u32 m0, s24, 98304
  ds_read_b64_tr_b16 v[34:35], v12 offset:1024
  v_accvgpr_read_b32 v19, a235
  v_mfma_f32_16x16x32_bf16 v[144:147], v[76:79], v[240:243], v[144:147]
  buffer_load_dwordx4 v3, s[32:35], s26 offen offset:0 sc1 lds
  v_accvgpr_read_b32 v20, a236
  v_mfma_f32_16x16x32_bf16 v[160:163], v[80:83], v[240:243], v[160:163]
  ds_read_b64_tr_b16 v[36:37], v13 offset:0
  v_accvgpr_read_b32 v21, a237
  v_mfma_f32_16x16x32_bf16 v[176:179], v[84:87], v[240:243], v[176:179]
  ds_read_b64_tr_b16 v[38:39], v13 offset:1024
  v_accvgpr_read_b32 v22, a238
  v_mfma_f32_16x16x32_bf16 v[192:195], v[88:91], v[240:243], v[192:195]
  ds_read_b64_tr_b16 v[40:41], v12 offset:256
  v_accvgpr_read_b32 v23, a239
  v_mfma_f32_16x16x32_bf16 v[208:211], v[92:95], v[240:243], v[208:211]
  ds_read_b64_tr_b16 v[42:43], v12 offset:1280
  v_mul_f32 v16, s76, v16
  v_mfma_f32_16x16x32_bf16 v[100:103], v[64:67], v[244:247], v[100:103]
  buffer_load_dwordx4 v4, s[32:35], s26 offen offset:1024 sc1 lds
  v_mul_f32 v17, s76, v17
  v_mfma_f32_16x16x32_bf16 v[116:119], v[68:71], v[244:247], v[116:119]
  ds_read_b64_tr_b16 v[44:45], v13 offset:256
  v_mul_f32 v18, s76, v18
  v_mfma_f32_16x16x32_bf16 v[132:135], v[72:75], v[244:247], v[132:135]
  ds_read_b64_tr_b16 v[46:47], v13 offset:1280
  v_mul_f32 v19, s76, v19
  v_mfma_f32_16x16x32_bf16 v[148:151], v[76:79], v[244:247], v[148:151]
  ds_read_b128 v[224:227], v14 offset:0
  v_mul_f32 v20, s76, v20
  v_mfma_f32_16x16x32_bf16 v[164:167], v[80:83], v[244:247], v[164:167]
  ds_read_b128 v[228:231], v14 offset:1024
  v_mul_f32 v21, s76, v21
  v_mfma_f32_16x16x32_bf16 v[180:183], v[84:87], v[244:247], v[180:183]
  buffer_load_dwordx4 v5, s[32:35], s26 offen offset:2048 sc1 lds
  v_mul_f32 v22, s76, v22
  v_mfma_f32_16x16x32_bf16 v[196:199], v[88:91], v[244:247], v[196:199]
  ds_read_b64_tr_b16 v[48:49], v12 offset:512
  v_mul_f32 v23, s76, v23
  v_mfma_f32_16x16x32_bf16 v[212:215], v[92:95], v[244:247], v[212:215]
  ds_read_b64_tr_b16 v[50:51], v12 offset:1536
  v_cvt_pk_bf16_f32 v28, v16, v17
  v_mfma_f32_16x16x32_bf16 v[104:107], v[64:67], v[248:251], v[104:107]
  ds_read_b64_tr_b16 v[52:53], v13 offset:512
  v_cvt_pk_bf16_f32 v29, v18, v19
  v_mfma_f32_16x16x32_bf16 v[120:123], v[68:71], v[248:251], v[120:123]
  ds_read_b64_tr_b16 v[54:55], v13 offset:1536
  v_cvt_pk_bf16_f32 v30, v20, v21
  v_mfma_f32_16x16x32_bf16 v[136:139], v[72:75], v[248:251], v[136:139]
  buffer_load_dwordx4 v6, s[32:35], s26 offen offset:3072 sc1 lds
  v_cvt_pk_bf16_f32 v31, v22, v23
  v_mfma_f32_16x16x32_bf16 v[152:155], v[76:79], v[248:251], v[152:155]
  s_add_u32 s26, s26, 1024
  ds_read_b64_tr_b16 v[56:57], v12 offset:768
  buffer_store_dwordx4 v[28:31], v2, s[40:43], s64 offen offset:1024 sc1
  v_mfma_f32_16x16x32_bf16 v[168:171], v[80:83], v[248:251], v[168:171]
  ds_read_b64_tr_b16 v[58:59], v12 offset:1792
  v_mfma_f32_16x16x32_bf16 v[184:187], v[84:87], v[248:251], v[184:187]
  ds_read_b64_tr_b16 v[60:61], v13 offset:768
  v_mfma_f32_16x16x32_bf16 v[200:203], v[88:91], v[248:251], v[200:203]
  s_add_u32 m0, s24, 49152
  ds_read_b64_tr_b16 v[62:63], v13 offset:1792
  v_mfma_f32_16x16x32_bf16 v[216:219], v[92:95], v[248:251], v[216:219]
  buffer_load_dwordx4 v8, s[36:39], s27 offen offset:0 lds
  v_mfma_f32_16x16x32_bf16 v[108:111], v[64:67], v[252:255], v[108:111]
  ds_read_b128 v[232:235], v14 offset:2048
  v_mfma_f32_16x16x32_bf16 v[124:127], v[68:71], v[252:255], v[124:127]
  ds_read_b128 v[236:239], v14 offset:3072
  v_mfma_f32_16x16x32_bf16 v[140:143], v[72:75], v[252:255], v[140:143]
  v_mfma_f32_16x16x32_bf16 v[156:159], v[76:79], v[252:255], v[156:159]
  v_mfma_f32_16x16x32_bf16 v[172:175], v[80:83], v[252:255], v[172:175]
  buffer_load_dwordx4 v9, s[36:39], s27 offen offset:1024 lds
  v_mfma_f32_16x16x32_bf16 v[188:191], v[84:87], v[252:255], v[188:191]
  v_mfma_f32_16x16x32_bf16 v[204:207], v[88:91], v[252:255], v[204:207]
  v_mfma_f32_16x16x32_bf16 v[220:223], v[92:95], v[252:255], v[220:223]
  s_waitcnt vmcnt(17) lgkmcnt(0)
  v_mfma_f32_16x16x32_bf16 v[96:99], v[32:35], v[224:227], v[96:99]
  v_accvgpr_read_b32 v16, a240
  v_accvgpr_read_b32 v17, a241
  v_mfma_f32_16x16x32_bf16 v[112:115], v[36:39], v[224:227], v[112:115]
  ds_read_b64_tr_b16 v[64:65], v12 offset:8192
  v_accvgpr_read_b32 v18, a242
  v_mfma_f32_16x16x32_bf16 v[128:131], v[40:43], v[224:227], v[128:131]
  s_add_u32 m0, s24, 0
  ds_read_b64_tr_b16 v[66:67], v12 offset:9216
  v_accvgpr_read_b32 v19, a243
  v_mfma_f32_16x16x32_bf16 v[144:147], v[44:47], v[224:227], v[144:147]
  buffer_load_dwordx4 v3, s[32:35], s26 offen offset:0 sc1 lds
  v_accvgpr_read_b32 v20, a244
  v_mfma_f32_16x16x32_bf16 v[160:163], v[48:51], v[224:227], v[160:163]
  ds_read_b64_tr_b16 v[68:69], v13 offset:8192
  v_accvgpr_read_b32 v21, a245
  v_mfma_f32_16x16x32_bf16 v[176:179], v[52:55], v[224:227], v[176:179]
  ds_read_b64_tr_b16 v[70:71], v13 offset:9216
  v_accvgpr_read_b32 v22, a246
  v_mfma_f32_16x16x32_bf16 v[192:195], v[56:59], v[224:227], v[192:195]
  ds_read_b64_tr_b16 v[72:73], v12 offset:8448
  v_accvgpr_read_b32 v23, a247
  v_mfma_f32_16x16x32_bf16 v[208:211], v[60:63], v[224:227], v[208:211]
  ds_read_b64_tr_b16 v[74:75], v12 offset:9472
  v_mul_f32 v16, s76, v16
  v_mfma_f32_16x16x32_bf16 v[100:103], v[32:35], v[228:231], v[100:103]
  buffer_load_dwordx4 v4, s[32:35], s26 offen offset:1024 sc1 lds
  v_mul_f32 v17, s76, v17
  v_mfma_f32_16x16x32_bf16 v[116:119], v[36:39], v[228:231], v[116:119]
  ds_read_b64_tr_b16 v[76:77], v13 offset:8448
  v_mul_f32 v18, s76, v18
  v_mfma_f32_16x16x32_bf16 v[132:135], v[40:43], v[228:231], v[132:135]
  ds_read_b64_tr_b16 v[78:79], v13 offset:9472
  v_mul_f32 v19, s76, v19
  v_mfma_f32_16x16x32_bf16 v[148:151], v[44:47], v[228:231], v[148:151]
  ds_read_b128 v[240:243], v14 offset:32768
  v_mul_f32 v20, s76, v20
  v_mfma_f32_16x16x32_bf16 v[164:167], v[48:51], v[228:231], v[164:167]
  ds_read_b128 v[244:247], v14 offset:33792
  v_mul_f32 v21, s76, v21
  v_mfma_f32_16x16x32_bf16 v[180:183], v[52:55], v[228:231], v[180:183]
  buffer_load_dwordx4 v5, s[32:35], s26 offen offset:2048 sc1 lds
  v_mul_f32 v22, s76, v22
  v_mfma_f32_16x16x32_bf16 v[196:199], v[56:59], v[228:231], v[196:199]
  ds_read_b64_tr_b16 v[80:81], v12 offset:8704
  v_mul_f32 v23, s76, v23
  v_mfma_f32_16x16x32_bf16 v[212:215], v[60:63], v[228:231], v[212:215]
  ds_read_b64_tr_b16 v[82:83], v12 offset:9728
  v_cvt_pk_bf16_f32 v24, v16, v17
  v_mfma_f32_16x16x32_bf16 v[104:107], v[32:35], v[232:235], v[104:107]
  ds_read_b64_tr_b16 v[84:85], v13 offset:8704
  v_cvt_pk_bf16_f32 v25, v18, v19
  v_mfma_f32_16x16x32_bf16 v[120:123], v[36:39], v[232:235], v[120:123]
  ds_read_b64_tr_b16 v[86:87], v13 offset:9728
  v_cvt_pk_bf16_f32 v26, v20, v21
  v_mfma_f32_16x16x32_bf16 v[136:139], v[40:43], v[232:235], v[136:139]
  buffer_load_dwordx4 v6, s[32:35], s26 offen offset:3072 sc1 lds
  v_cvt_pk_bf16_f32 v27, v22, v23
  v_mfma_f32_16x16x32_bf16 v[152:155], v[44:47], v[232:235], v[152:155]
  s_add_u32 s26, s26, 1024
  ds_read_b64_tr_b16 v[88:89], v12 offset:8960
  buffer_store_dwordx4 v[24:27], v2, s[40:43], s64 offen offset:2048 sc1
  v_mfma_f32_16x16x32_bf16 v[168:171], v[48:51], v[232:235], v[168:171]
  ds_read_b64_tr_b16 v[90:91], v12 offset:9984
  v_mfma_f32_16x16x32_bf16 v[184:187], v[52:55], v[232:235], v[184:187]
  ds_read_b64_tr_b16 v[92:93], v13 offset:8960
  v_mfma_f32_16x16x32_bf16 v[200:203], v[56:59], v[232:235], v[200:203]
  s_add_u32 m0, s24, 49152
  ds_read_b64_tr_b16 v[94:95], v13 offset:9984
  v_mfma_f32_16x16x32_bf16 v[216:219], v[60:63], v[232:235], v[216:219]
  buffer_load_dwordx4 v10, s[36:39], s27 offen offset:2048 lds
  v_mfma_f32_16x16x32_bf16 v[108:111], v[32:35], v[236:239], v[108:111]
  ds_read_b128 v[248:251], v14 offset:34816
  v_mfma_f32_16x16x32_bf16 v[124:127], v[36:39], v[236:239], v[124:127]
  ds_read_b128 v[252:255], v14 offset:35840
  v_mfma_f32_16x16x32_bf16 v[140:143], v[40:43], v[236:239], v[140:143]
  v_mfma_f32_16x16x32_bf16 v[156:159], v[44:47], v[236:239], v[156:159]
  v_xor_b32 v14, 0x10000, v14
  v_mfma_f32_16x16x32_bf16 v[172:175], v[48:51], v[236:239], v[172:175]
  buffer_load_dwordx4 v11, s[36:39], s27 offen offset:3072 lds
  v_mfma_f32_16x16x32_bf16 v[188:191], v[52:55], v[236:239], v[188:191]
  s_add_u32 s27, s27, 524288
  v_mfma_f32_16x16x32_bf16 v[204:207], v[56:59], v[236:239], v[204:207]
  v_mfma_f32_16x16x32_bf16 v[220:223], v[60:63], v[236:239], v[220:223]
  s_waitcnt vmcnt(17) lgkmcnt(0)
  v_mfma_f32_16x16x32_bf16 v[96:99], v[64:67], v[240:243], v[96:99]
  s_barrier
  v_accvgpr_read_b32 v16, a248
  v_accvgpr_read_b32 v17, a249
  v_mfma_f32_16x16x32_bf16 v[112:115], v[68:71], v[240:243], v[112:115]
  ds_read_b64_tr_b16 v[32:33], v12 offset:32768
  v_accvgpr_read_b32 v18, a250
  v_mfma_f32_16x16x32_bf16 v[128:131], v[72:75], v[240:243], v[128:131]
  s_add_u32 m0, s24, 32768
  ds_read_b64_tr_b16 v[34:35], v12 offset:33792
  v_accvgpr_read_b32 v19, a251
  v_mfma_f32_16x16x32_bf16 v[144:147], v[76:79], v[240:243], v[144:147]
  buffer_load_dwordx4 v3, s[32:35], s26 offen offset:0 sc1 lds
  v_accvgpr_read_b32 v20, a252
  v_mfma_f32_16x16x32_bf16 v[160:163], v[80:83], v[240:243], v[160:163]
  ds_read_b64_tr_b16 v[36:37], v13 offset:32768
  v_accvgpr_read_b32 v21, a253
  v_mfma_f32_16x16x32_bf16 v[176:179], v[84:87], v[240:243], v[176:179]
  ds_read_b64_tr_b16 v[38:39], v13 offset:33792
  v_accvgpr_read_b32 v22, a254
  v_mfma_f32_16x16x32_bf16 v[192:195], v[88:91], v[240:243], v[192:195]
  ds_read_b64_tr_b16 v[40:41], v12 offset:33024
  v_accvgpr_read_b32 v23, a255
  v_mfma_f32_16x16x32_bf16 v[208:211], v[92:95], v[240:243], v[208:211]
  ds_read_b64_tr_b16 v[42:43], v12 offset:34048
  v_mul_f32 v16, s76, v16
  v_mfma_f32_16x16x32_bf16 v[100:103], v[64:67], v[244:247], v[100:103]
  buffer_load_dwordx4 v4, s[32:35], s26 offen offset:1024 sc1 lds
  v_mul_f32 v17, s76, v17
  v_mfma_f32_16x16x32_bf16 v[116:119], v[68:71], v[244:247], v[116:119]
  ds_read_b64_tr_b16 v[44:45], v13 offset:33024
  v_mul_f32 v18, s76, v18
  v_mfma_f32_16x16x32_bf16 v[132:135], v[72:75], v[244:247], v[132:135]
  ds_read_b64_tr_b16 v[46:47], v13 offset:34048
  v_mul_f32 v19, s76, v19
  v_mfma_f32_16x16x32_bf16 v[148:151], v[76:79], v[244:247], v[148:151]
  ds_read_b128 v[224:227], v14 offset:0
  v_mul_f32 v20, s76, v20
  v_mfma_f32_16x16x32_bf16 v[164:167], v[80:83], v[244:247], v[164:167]
  ds_read_b128 v[228:231], v14 offset:1024
  v_mul_f32 v21, s76, v21
  v_mfma_f32_16x16x32_bf16 v[180:183], v[84:87], v[244:247], v[180:183]
  buffer_load_dwordx4 v5, s[32:35], s26 offen offset:2048 sc1 lds
  v_mul_f32 v22, s76, v22
  v_mfma_f32_16x16x32_bf16 v[196:199], v[88:91], v[244:247], v[196:199]
  ds_read_b64_tr_b16 v[48:49], v12 offset:33280
  v_mul_f32 v23, s76, v23
  v_mfma_f32_16x16x32_bf16 v[212:215], v[92:95], v[244:247], v[212:215]
  ds_read_b64_tr_b16 v[50:51], v12 offset:34304
  v_cvt_pk_bf16_f32 v28, v16, v17
  v_mfma_f32_16x16x32_bf16 v[104:107], v[64:67], v[248:251], v[104:107]
  ds_read_b64_tr_b16 v[52:53], v13 offset:33280
  v_cvt_pk_bf16_f32 v29, v18, v19
  v_mfma_f32_16x16x32_bf16 v[120:123], v[68:71], v[248:251], v[120:123]
  ds_read_b64_tr_b16 v[54:55], v13 offset:34304
  v_cvt_pk_bf16_f32 v30, v20, v21
  v_mfma_f32_16x16x32_bf16 v[136:139], v[72:75], v[248:251], v[136:139]
  buffer_load_dwordx4 v6, s[32:35], s26 offen offset:3072 sc1 lds
  v_cvt_pk_bf16_f32 v31, v22, v23
  v_mfma_f32_16x16x32_bf16 v[152:155], v[76:79], v[248:251], v[152:155]
  s_add_u32 s26, s26, 1024
  ds_read_b64_tr_b16 v[56:57], v12 offset:33536
  buffer_store_dwordx4 v[28:31], v2, s[40:43], s64 offen offset:3072 sc1
  v_mfma_f32_16x16x32_bf16 v[168:171], v[80:83], v[248:251], v[168:171]
  ds_read_b64_tr_b16 v[58:59], v12 offset:34560
  v_mfma_f32_16x16x32_bf16 v[184:187], v[84:87], v[248:251], v[184:187]
  ds_read_b64_tr_b16 v[60:61], v13 offset:33536
  v_mfma_f32_16x16x32_bf16 v[200:203], v[88:91], v[248:251], v[200:203]
  s_add_u32 m0, s24, 81920
  ds_read_b64_tr_b16 v[62:63], v13 offset:34560
  v_mfma_f32_16x16x32_bf16 v[216:219], v[92:95], v[248:251], v[216:219]
  buffer_load_dwordx4 v8, s[36:39], s27 offen offset:0 lds
  v_mfma_f32_16x16x32_bf16 v[108:111], v[64:67], v[252:255], v[108:111]
  ds_read_b128 v[232:235], v14 offset:2048
  v_mfma_f32_16x16x32_bf16 v[124:127], v[68:71], v[252:255], v[124:127]
  ds_read_b128 v[236:239], v14 offset:3072
  v_mfma_f32_16x16x32_bf16 v[140:143], v[72:75], v[252:255], v[140:143]
  v_mfma_f32_16x16x32_bf16 v[156:159], v[76:79], v[252:255], v[156:159]
  v_mfma_f32_16x16x32_bf16 v[172:175], v[80:83], v[252:255], v[172:175]
  buffer_load_dwordx4 v9, s[36:39], s27 offen offset:1024 lds
  v_mfma_f32_16x16x32_bf16 v[188:191], v[84:87], v[252:255], v[188:191]
  v_mfma_f32_16x16x32_bf16 v[204:207], v[88:91], v[252:255], v[204:207]
  v_mfma_f32_16x16x32_bf16 v[220:223], v[92:95], v[252:255], v[220:223]
  s_waitcnt vmcnt(17) lgkmcnt(0)
  v_mfma_f32_16x16x32_bf16 v[96:99], v[32:35], v[224:227], v[96:99]
  s_add_u32 s64, s64, 126976
  v_accvgpr_read_b32 v16, a0
  v_accvgpr_read_b32 v17, a1
  v_mfma_f32_16x16x32_bf16 v[112:115], v[36:39], v[224:227], v[112:115]
  ds_read_b64_tr_b16 v[64:65], v12 offset:40960
  v_accvgpr_read_b32 v18, a2
  v_mfma_f32_16x16x32_bf16 v[128:131], v[40:43], v[224:227], v[128:131]
  s_add_u32 m0, s24, 65536
  ds_read_b64_tr_b16 v[66:67], v12 offset:41984
  v_accvgpr_read_b32 v19, a3
  v_mfma_f32_16x16x32_bf16 v[144:147], v[44:47], v[224:227], v[144:147]
  buffer_load_dwordx4 v3, s[32:35], s26 offen offset:0 sc1 lds
  v_accvgpr_read_b32 v20, a4
  v_mfma_f32_16x16x32_bf16 v[160:163], v[48:51], v[224:227], v[160:163]
  ds_read_b64_tr_b16 v[68:69], v13 offset:40960
  v_accvgpr_read_b32 v21, a5
  v_mfma_f32_16x16x32_bf16 v[176:179], v[52:55], v[224:227], v[176:179]
  ds_read_b64_tr_b16 v[70:71], v13 offset:41984
  v_accvgpr_read_b32 v22, a6
  v_mfma_f32_16x16x32_bf16 v[192:195], v[56:59], v[224:227], v[192:195]
  ds_read_b64_tr_b16 v[72:73], v12 offset:41216
  v_accvgpr_read_b32 v23, a7
  v_mfma_f32_16x16x32_bf16 v[208:211], v[60:63], v[224:227], v[208:211]
  ds_read_b64_tr_b16 v[74:75], v12 offset:42240
  v_mul_f32 v16, s76, v16
  v_mfma_f32_16x16x32_bf16 v[100:103], v[32:35], v[228:231], v[100:103]
  buffer_load_dwordx4 v4, s[32:35], s26 offen offset:1024 sc1 lds
  v_mul_f32 v17, s76, v17
  v_mfma_f32_16x16x32_bf16 v[116:119], v[36:39], v[228:231], v[116:119]
  ds_read_b64_tr_b16 v[76:77], v13 offset:41216
  v_mul_f32 v18, s76, v18
  v_mfma_f32_16x16x32_bf16 v[132:135], v[40:43], v[228:231], v[132:135]
  ds_read_b64_tr_b16 v[78:79], v13 offset:42240
  v_mul_f32 v19, s76, v19
  v_mfma_f32_16x16x32_bf16 v[148:151], v[44:47], v[228:231], v[148:151]
  ds_read_b128 v[240:243], v14 offset:32768
  v_mul_f32 v20, s76, v20
  v_mfma_f32_16x16x32_bf16 v[164:167], v[48:51], v[228:231], v[164:167]
  ds_read_b128 v[244:247], v14 offset:33792
  v_mul_f32 v21, s76, v21
  v_mfma_f32_16x16x32_bf16 v[180:183], v[52:55], v[228:231], v[180:183]
  buffer_load_dwordx4 v5, s[32:35], s26 offen offset:2048 sc1 lds
  v_mul_f32 v22, s76, v22
  v_mfma_f32_16x16x32_bf16 v[196:199], v[56:59], v[228:231], v[196:199]
  ds_read_b64_tr_b16 v[80:81], v12 offset:41472
  v_mul_f32 v23, s76, v23
  v_mfma_f32_16x16x32_bf16 v[212:215], v[60:63], v[228:231], v[212:215]
  ds_read_b64_tr_b16 v[82:83], v12 offset:42496
  v_cvt_pk_bf16_f32 v24, v16, v17
  v_mfma_f32_16x16x32_bf16 v[104:107], v[32:35], v[232:235], v[104:107]
  ds_read_b64_tr_b16 v[84:85], v13 offset:41472
  v_cvt_pk_bf16_f32 v25, v18, v19
  v_mfma_f32_16x16x32_bf16 v[120:123], v[36:39], v[232:235], v[120:123]
  ds_read_b64_tr_b16 v[86:87], v13 offset:42496
  v_cvt_pk_bf16_f32 v26, v20, v21
  v_mfma_f32_16x16x32_bf16 v[136:139], v[40:43], v[232:235], v[136:139]
  buffer_load_dwordx4 v6, s[32:35], s26 offen offset:3072 sc1 lds
  v_cvt_pk_bf16_f32 v27, v22, v23
  v_mfma_f32_16x16x32_bf16 v[152:155], v[44:47], v[232:235], v[152:155]
  s_add_u32 s26, s26, 1024
  ds_read_b64_tr_b16 v[88:89], v12 offset:41728
  buffer_store_dwordx4 v[24:27], v2, s[40:43], s64 offen offset:0 sc1
  v_mfma_f32_16x16x32_bf16 v[168:171], v[48:51], v[232:235], v[168:171]
  ds_read_b64_tr_b16 v[90:91], v12 offset:42752
  v_mfma_f32_16x16x32_bf16 v[184:187], v[52:55], v[232:235], v[184:187]
  ds_read_b64_tr_b16 v[92:93], v13 offset:41728
  v_mfma_f32_16x16x32_bf16 v[200:203], v[56:59], v[232:235], v[200:203]
  s_add_u32 m0, s24, 81920
  ds_read_b64_tr_b16 v[94:95], v13 offset:42752
  v_mfma_f32_16x16x32_bf16 v[216:219], v[60:63], v[232:235], v[216:219]
  buffer_load_dwordx4 v10, s[36:39], s27 offen offset:2048 lds
  v_mfma_f32_16x16x32_bf16 v[108:111], v[32:35], v[236:239], v[108:111]
  ds_read_b128 v[248:251], v14 offset:34816
  v_mfma_f32_16x16x32_bf16 v[124:127], v[36:39], v[236:239], v[124:127]
  ds_read_b128 v[252:255], v14 offset:35840
  v_mfma_f32_16x16x32_bf16 v[140:143], v[40:43], v[236:239], v[140:143]
  v_mfma_f32_16x16x32_bf16 v[156:159], v[44:47], v[236:239], v[156:159]
  v_xor_b32 v14, 0x10000, v14
  v_mfma_f32_16x16x32_bf16 v[172:175], v[48:51], v[236:239], v[172:175]
  buffer_load_dwordx4 v11, s[36:39], s27 offen offset:3072 lds
  v_mfma_f32_16x16x32_bf16 v[188:191], v[52:55], v[236:239], v[188:191]
  s_add_u32 s27, s27, 524288
  v_xor_b32 v12, 0x10000, v12
  v_mfma_f32_16x16x32_bf16 v[204:207], v[56:59], v[236:239], v[204:207]
  v_xor_b32 v13, 0x10000, v13
  v_mfma_f32_16x16x32_bf16 v[220:223], v[60:63], v[236:239], v[220:223]
  s_waitcnt vmcnt(9) lgkmcnt(0)
  v_mfma_f32_16x16x32_bf16 v[96:99], v[64:67], v[240:243], v[96:99]
  s_barrier
  buffer_store_dword v12, off, s[40:43], s65 sc1
  v_accvgpr_read_b32 v16, a8
  v_mfma_f32_16x16x32_bf16 v[112:115], v[68:71], v[240:243], v[112:115]
  ds_read_b64_tr_b16 v[32:33], v12 offset:0
  v_accvgpr_read_b32 v17, a9
  v_mfma_f32_16x16x32_bf16 v[128:131], v[72:75], v[240:243], v[128:131]
  s_add_u32 m0, s24, 98304
  ds_read_b64_tr_b16 v[34:35], v12 offset:1024
  v_accvgpr_read_b32 v18, a10
  v_mfma_f32_16x16x32_bf16 v[144:147], v[76:79], v[240:243], v[144:147]
  buffer_load_dwordx4 v3, s[32:35], s26 offen offset:0 sc1 lds
  v_accvgpr_read_b32 v19, a11
  v_mfma_f32_16x16x32_bf16 v[160:163], v[80:83], v[240:243], v[160:163]
  ds_read_b64_tr_b16 v[36:37], v13 offset:0
  v_accvgpr_read_b32 v20, a12
  v_mfma_f32_16x16x32_bf16 v[176:179], v[84:87], v[240:243], v[176:179]
  ds_read_b64_tr_b16 v[38:39], v13 offset:1024
  v_accvgpr_read_b32 v21, a13
  v_mfma_f32_16x16x32_bf16 v[192:195], v[88:91], v[240:243], v[192:195]
  ds_read_b64_tr_b16 v[40:41], v12 offset:256
  v_accvgpr_read_b32 v22, a14
  v_mfma_f32_16x16x32_bf16 v[208:211], v[92:95], v[240:243], v[208:211]
  ds_read_b64_tr_b16 v[42:43], v12 offset:1280
  v_accvgpr_read_b32 v23, a15
  v_mfma_f32_16x16x32_bf16 v[100:103], v[64:67], v[244:247], v[100:103]
  buffer_load_dwordx4 v4, s[32:35], s26 offen offset:1024 sc1 lds
  v_mul_f32 v16, s76, v16
  v_mfma_f32_16x16x32_bf16 v[116:119], v[68:71], v[244:247], v[116:119]
  ds_read_b64_tr_b16 v[44:45], v13 offset:256
  v_mul_f32 v17, s76, v17
  v_mfma_f32_16x16x32_bf16 v[132:135], v[72:75], v[244:247], v[132:135]
  ds_read_b64_tr_b16 v[46:47], v13 offset:1280
  v_mul_f32 v18, s76, v18
  v_mfma_f32_16x16x32_bf16 v[148:151], v[76:79], v[244:247], v[148:151]
  ds_read_b128 v[224:227], v14 offset:0
  v_mul_f32 v19, s76, v19
  v_mfma_f32_16x16x32_bf16 v[164:167], v[80:83], v[244:247], v[164:167]
  ds_read_b128 v[228:231], v14 offset:1024
  v_mul_f32 v20, s76, v20
  v_mfma_f32_16x16x32_bf16 v[180:183], v[84:87], v[244:247], v[180:183]
  buffer_load_dwordx4 v5, s[32:35], s26 offen offset:2048 sc1 lds
  v_mul_f32 v21, s76, v21
  v_mfma_f32_16x16x32_bf16 v[196:199], v[88:91], v[244:247], v[196:199]
  ds_read_b64_tr_b16 v[48:49], v12 offset:512
  v_mul_f32 v22, s76, v22
  v_mfma_f32_16x16x32_bf16 v[212:215], v[92:95], v[244:247], v[212:215]
  ds_read_b64_tr_b16 v[50:51], v12 offset:1536
  v_mul_f32 v23, s76, v23
  v_mfma_f32_16x16x32_bf16 v[104:107], v[64:67], v[248:251], v[104:107]
  ds_read_b64_tr_b16 v[52:53], v13 offset:512
  v_cvt_pk_bf16_f32 v28, v16, v17
  v_mfma_f32_16x16x32_bf16 v[120:123], v[68:71], v[248:251], v[120:123]
  ds_read_b64_tr_b16 v[54:55], v13 offset:1536
  v_cvt_pk_bf16_f32 v29, v18, v19
  v_mfma_f32_16x16x32_bf16 v[136:139], v[72:75], v[248:251], v[136:139]
  buffer_load_dwordx4 v6, s[32:35], s26 offen offset:3072 sc1 lds
  v_cvt_pk_bf16_f32 v30, v20, v21
  v_mfma_f32_16x16x32_bf16 v[152:155], v[76:79], v[248:251], v[152:155]
  s_add_u32 s26, s26, 1024
  ds_read_b64_tr_b16 v[56:57], v12 offset:768
  v_cvt_pk_bf16_f32 v31, v22, v23
  v_mfma_f32_16x16x32_bf16 v[168:171], v[80:83], v[248:251], v[168:171]
  ds_read_b64_tr_b16 v[58:59], v12 offset:1792
  buffer_store_dwordx4 v[28:31], v2, s[40:43], s64 offen offset:1024 sc1
  v_mfma_f32_16x16x32_bf16 v[184:187], v[84:87], v[248:251], v[184:187]
  ds_read_b64_tr_b16 v[60:61], v13 offset:768
  v_mfma_f32_16x16x32_bf16 v[200:203], v[88:91], v[248:251], v[200:203]
  s_add_u32 m0, s24, 114688
  ds_read_b64_tr_b16 v[62:63], v13 offset:1792
  v_mfma_f32_16x16x32_bf16 v[216:219], v[92:95], v[248:251], v[216:219]
  buffer_load_dwordx4 v8, s[36:39], s27 offen offset:0 lds
  v_mfma_f32_16x16x32_bf16 v[108:111], v[64:67], v[252:255], v[108:111]
  ds_read_b128 v[232:235], v14 offset:2048
  v_mfma_f32_16x16x32_bf16 v[124:127], v[68:71], v[252:255], v[124:127]
  ds_read_b128 v[236:239], v14 offset:3072
  v_mfma_f32_16x16x32_bf16 v[140:143], v[72:75], v[252:255], v[140:143]
  v_mfma_f32_16x16x32_bf16 v[156:159], v[76:79], v[252:255], v[156:159]
  v_mfma_f32_16x16x32_bf16 v[172:175], v[80:83], v[252:255], v[172:175]
  buffer_load_dwordx4 v9, s[36:39], s27 offen offset:1024 lds
  v_mfma_f32_16x16x32_bf16 v[188:191], v[84:87], v[252:255], v[188:191]
  v_mfma_f32_16x16x32_bf16 v[204:207], v[88:91], v[252:255], v[204:207]
  v_mfma_f32_16x16x32_bf16 v[220:223], v[92:95], v[252:255], v[220:223]
  s_waitcnt vmcnt(18) lgkmcnt(0)
  v_mfma_f32_16x16x32_bf16 v[96:99], v[32:35], v[224:227], v[96:99]
  v_accvgpr_read_b32 v16, a16
  v_accvgpr_read_b32 v17, a17
  v_mfma_f32_16x16x32_bf16 v[112:115], v[36:39], v[224:227], v[112:115]
  ds_read_b64_tr_b16 v[64:65], v12 offset:8192
  v_accvgpr_read_b32 v18, a18
  v_mfma_f32_16x16x32_bf16 v[128:131], v[40:43], v[224:227], v[128:131]
  s_add_u32 m0, s24, 0
  ds_read_b64_tr_b16 v[66:67], v12 offset:9216
  v_accvgpr_read_b32 v19, a19
  v_mfma_f32_16x16x32_bf16 v[144:147], v[44:47], v[224:227], v[144:147]
  buffer_load_dwordx4 v3, s[32:35], s26 offen offset:0 sc1 lds
  v_accvgpr_read_b32 v20, a20
  v_mfma_f32_16x16x32_bf16 v[160:163], v[48:51], v[224:227], v[160:163]
  ds_read_b64_tr_b16 v[68:69], v13 offset:8192
  v_accvgpr_read_b32 v21, a21
  v_mfma_f32_16x16x32_bf16 v[176:179], v[52:55], v[224:227], v[176:179]
  ds_read_b64_tr_b16 v[70:71], v13 offset:9216
  v_accvgpr_read_b32 v22, a22
  v_mfma_f32_16x16x32_bf16 v[192:195], v[56:59], v[224:227], v[192:195]
  ds_read_b64_tr_b16 v[72:73], v12 offset:8448
  v_accvgpr_read_b32 v23, a23
  v_mfma_f32_16x16x32_bf16 v[208:211], v[60:63], v[224:227], v[208:211]
  ds_read_b64_tr_b16 v[74:75], v12 offset:9472
  v_mul_f32 v16, s76, v16
  v_mfma_f32_16x16x32_bf16 v[100:103], v[32:35], v[228:231], v[100:103]
  buffer_load_dwordx4 v4, s[32:35], s26 offen offset:1024 sc1 lds
  v_mul_f32 v17, s76, v17
  v_mfma_f32_16x16x32_bf16 v[116:119], v[36:39], v[228:231], v[116:119]
  ds_read_b64_tr_b16 v[76:77], v13 offset:8448
  v_mul_f32 v18, s76, v18
  v_mfma_f32_16x16x32_bf16 v[132:135], v[40:43], v[228:231], v[132:135]
  ds_read_b64_tr_b16 v[78:79], v13 offset:9472
  v_mul_f32 v19, s76, v19
  v_mfma_f32_16x16x32_bf16 v[148:151], v[44:47], v[228:231], v[148:151]
  ds_read_b128 v[240:243], v14 offset:32768
  v_mul_f32 v20, s76, v20
  v_mfma_f32_16x16x32_bf16 v[164:167], v[48:51], v[228:231], v[164:167]
  ds_read_b128 v[244:247], v14 offset:33792
  v_mul_f32 v21, s76, v21
  v_mfma_f32_16x16x32_bf16 v[180:183], v[52:55], v[228:231], v[180:183]
  buffer_load_dwordx4 v5, s[32:35], s26 offen offset:2048 sc1 lds
  v_mul_f32 v22, s76, v22
  v_mfma_f32_16x16x32_bf16 v[196:199], v[56:59], v[228:231], v[196:199]
  ds_read_b64_tr_b16 v[80:81], v12 offset:8704
  v_mul_f32 v23, s76, v23
  v_mfma_f32_16x16x32_bf16 v[212:215], v[60:63], v[228:231], v[212:215]
  ds_read_b64_tr_b16 v[82:83], v12 offset:9728
  v_cvt_pk_bf16_f32 v24, v16, v17
  v_mfma_f32_16x16x32_bf16 v[104:107], v[32:35], v[232:235], v[104:107]
  ds_read_b64_tr_b16 v[84:85], v13 offset:8704
  v_cvt_pk_bf16_f32 v25, v18, v19
  v_mfma_f32_16x16x32_bf16 v[120:123], v[36:39], v[232:235], v[120:123]
  ds_read_b64_tr_b16 v[86:87], v13 offset:9728
  v_cvt_pk_bf16_f32 v26, v20, v21
  v_mfma_f32_16x16x32_bf16 v[136:139], v[40:43], v[232:235], v[136:139]
  buffer_load_dwordx4 v6, s[32:35], s26 offen offset:3072 sc1 lds
  v_cvt_pk_bf16_f32 v27, v22, v23
  v_mfma_f32_16x16x32_bf16 v[152:155], v[44:47], v[232:235], v[152:155]
  s_add_u32 s26, s26, 1024
  ds_read_b64_tr_b16 v[88:89], v12 offset:8960
  buffer_store_dwordx4 v[24:27], v2, s[40:43], s64 offen offset:2048 sc1
  v_mfma_f32_16x16x32_bf16 v[168:171], v[48:51], v[232:235], v[168:171]
  ds_read_b64_tr_b16 v[90:91], v12 offset:9984
  v_mfma_f32_16x16x32_bf16 v[184:187], v[52:55], v[232:235], v[184:187]
  ds_read_b64_tr_b16 v[92:93], v13 offset:8960
  v_mfma_f32_16x16x32_bf16 v[200:203], v[56:59], v[232:235], v[200:203]
  s_add_u32 m0, s24, 114688
  ds_read_b64_tr_b16 v[94:95], v13 offset:9984
  v_mfma_f32_16x16x32_bf16 v[216:219], v[60:63], v[232:235], v[216:219]
  buffer_load_dwordx4 v10, s[36:39], s27 offen offset:2048 lds
  v_mfma_f32_16x16x32_bf16 v[108:111], v[32:35], v[236:239], v[108:111]
  ds_read_b128 v[248:251], v14 offset:34816
  v_mfma_f32_16x16x32_bf16 v[124:127], v[36:39], v[236:239], v[124:127]
  ds_read_b128 v[252:255], v14 offset:35840
  v_mfma_f32_16x16x32_bf16 v[140:143], v[40:43], v[236:239], v[140:143]
  v_mfma_f32_16x16x32_bf16 v[156:159], v[44:47], v[236:239], v[156:159]
  v_xor_b32 v14, 0x10000, v14
  v_mfma_f32_16x16x32_bf16 v[172:175], v[48:51], v[236:239], v[172:175]
  buffer_load_dwordx4 v11, s[36:39], s27 offen offset:3072 lds
  v_mfma_f32_16x16x32_bf16 v[188:191], v[52:55], v[236:239], v[188:191]
  s_add_u32 s27, s27, 524288
  v_mfma_f32_16x16x32_bf16 v[204:207], v[56:59], v[236:239], v[204:207]
  v_mfma_f32_16x16x32_bf16 v[220:223], v[60:63], v[236:239], v[220:223]
  s_waitcnt vmcnt(18) lgkmcnt(0)
  v_mfma_f32_16x16x32_bf16 v[96:99], v[64:67], v[240:243], v[96:99]
  s_barrier
  v_accvgpr_read_b32 v16, a24
  v_accvgpr_read_b32 v17, a25
  v_mfma_f32_16x16x32_bf16 v[112:115], v[68:71], v[240:243], v[112:115]
  ds_read_b64_tr_b16 v[32:33], v12 offset:32768
  v_accvgpr_read_b32 v18, a26
  v_mfma_f32_16x16x32_bf16 v[128:131], v[72:75], v[240:243], v[128:131]
  s_add_u32 m0, s24, 32768
  ds_read_b64_tr_b16 v[34:35], v12 offset:33792
  v_accvgpr_read_b32 v19, a27
  v_mfma_f32_16x16x32_bf16 v[144:147], v[76:79], v[240:243], v[144:147]
  buffer_load_dwordx4 v3, s[32:35], s26 offen offset:0 sc1 lds
  v_accvgpr_read_b32 v20, a28
  v_mfma_f32_16x16x32_bf16 v[160:163], v[80:83], v[240:243], v[160:163]
  ds_read_b64_tr_b16 v[36:37], v13 offset:32768
  v_accvgpr_read_b32 v21, a29
  v_mfma_f32_16x16x32_bf16 v[176:179], v[84:87], v[240:243], v[176:179]
  ds_read_b64_tr_b16 v[38:39], v13 offset:33792
  v_accvgpr_read_b32 v22, a30
  v_mfma_f32_16x16x32_bf16 v[192:195], v[88:91], v[240:243], v[192:195]
  ds_read_b64_tr_b16 v[40:41], v12 offset:33024
  v_accvgpr_read_b32 v23, a31
  v_mfma_f32_16x16x32_bf16 v[208:211], v[92:95], v[240:243], v[208:211]
  ds_read_b64_tr_b16 v[42:43], v12 offset:34048
  v_mul_f32 v16, s76, v16
  v_mfma_f32_16x16x32_bf16 v[100:103], v[64:67], v[244:247], v[100:103]
  buffer_load_dwordx4 v4, s[32:35], s26 offen offset:1024 sc1 lds
  v_mul_f32 v17, s76, v17
  v_mfma_f32_16x16x32_bf16 v[116:119], v[68:71], v[244:247], v[116:119]
  ds_read_b64_tr_b16 v[44:45], v13 offset:33024
  v_mul_f32 v18, s76, v18
  v_mfma_f32_16x16x32_bf16 v[132:135], v[72:75], v[244:247], v[132:135]
  ds_read_b64_tr_b16 v[46:47], v13 offset:34048
  v_mul_f32 v19, s76, v19
  v_mfma_f32_16x16x32_bf16 v[148:151], v[76:79], v[244:247], v[148:151]
  ds_read_b128 v[224:227], v14 offset:0
  v_mul_f32 v20, s76, v20
  v_mfma_f32_16x16x32_bf16 v[164:167], v[80:83], v[244:247], v[164:167]
  ds_read_b128 v[228:231], v14 offset:1024
  v_mul_f32 v21, s76, v21
  v_mfma_f32_16x16x32_bf16 v[180:183], v[84:87], v[244:247], v[180:183]
  buffer_load_dwordx4 v5, s[32:35], s26 offen offset:2048 sc1 lds
  v_mul_f32 v22, s76, v22
  v_mfma_f32_16x16x32_bf16 v[196:199], v[88:91], v[244:247], v[196:199]
  ds_read_b64_tr_b16 v[48:49], v12 offset:33280
  v_mul_f32 v23, s76, v23
  v_mfma_f32_16x16x32_bf16 v[212:215], v[92:95], v[244:247], v[212:215]
  ds_read_b64_tr_b16 v[50:51], v12 offset:34304
  v_cvt_pk_bf16_f32 v28, v16, v17
  v_mfma_f32_16x16x32_bf16 v[104:107], v[64:67], v[248:251], v[104:107]
  ds_read_b64_tr_b16 v[52:53], v13 offset:33280
  v_cvt_pk_bf16_f32 v29, v18, v19
  v_mfma_f32_16x16x32_bf16 v[120:123], v[68:71], v[248:251], v[120:123]
  ds_read_b64_tr_b16 v[54:55], v13 offset:34304
  v_cvt_pk_bf16_f32 v30, v20, v21
  v_mfma_f32_16x16x32_bf16 v[136:139], v[72:75], v[248:251], v[136:139]
  buffer_load_dwordx4 v6, s[32:35], s26 offen offset:3072 sc1 lds
  v_cvt_pk_bf16_f32 v31, v22, v23
  v_mfma_f32_16x16x32_bf16 v[152:155], v[76:79], v[248:251], v[152:155]
  s_add_u32 s26, s26, 1024
  ds_read_b64_tr_b16 v[56:57], v12 offset:33536
  buffer_store_dwordx4 v[28:31], v2, s[40:43], s64 offen offset:3072 sc1
  v_mfma_f32_16x16x32_bf16 v[168:171], v[80:83], v[248:251], v[168:171]
  ds_read_b64_tr_b16 v[58:59], v12 offset:34560
  v_mfma_f32_16x16x32_bf16 v[184:187], v[84:87], v[248:251], v[184:187]
  ds_read_b64_tr_b16 v[60:61], v13 offset:33536
  v_mfma_f32_16x16x32_bf16 v[200:203], v[88:91], v[248:251], v[200:203]
  s_add_u32 m0, s24, 16384
  ds_read_b64_tr_b16 v[62:63], v13 offset:34560
  v_mfma_f32_16x16x32_bf16 v[216:219], v[92:95], v[248:251], v[216:219]
  buffer_load_dwordx4 v8, s[36:39], s27 offen offset:0 lds
  v_mfma_f32_16x16x32_bf16 v[108:111], v[64:67], v[252:255], v[108:111]
  ds_read_b128 v[232:235], v14 offset:2048
  v_mfma_f32_16x16x32_bf16 v[124:127], v[68:71], v[252:255], v[124:127]
  ds_read_b128 v[236:239], v14 offset:3072
  v_mfma_f32_16x16x32_bf16 v[140:143], v[72:75], v[252:255], v[140:143]
  v_mfma_f32_16x16x32_bf16 v[156:159], v[76:79], v[252:255], v[156:159]
  v_mfma_f32_16x16x32_bf16 v[172:175], v[80:83], v[252:255], v[172:175]
  buffer_load_dwordx4 v9, s[36:39], s27 offen offset:1024 lds
  v_mfma_f32_16x16x32_bf16 v[188:191], v[84:87], v[252:255], v[188:191]
  v_mfma_f32_16x16x32_bf16 v[204:207], v[88:91], v[252:255], v[204:207]
  v_mfma_f32_16x16x32_bf16 v[220:223], v[92:95], v[252:255], v[220:223]
  s_waitcnt vmcnt(17) lgkmcnt(0)
  v_mfma_f32_16x16x32_bf16 v[96:99], v[32:35], v[224:227], v[96:99]
  s_add_u32 s64, s64, 4096
  v_accvgpr_read_b32 v16, a32
  v_accvgpr_read_b32 v17, a33
  v_mfma_f32_16x16x32_bf16 v[112:115], v[36:39], v[224:227], v[112:115]
  ds_read_b64_tr_b16 v[64:65], v12 offset:40960
  v_accvgpr_read_b32 v18, a34
  v_mfma_f32_16x16x32_bf16 v[128:131], v[40:43], v[224:227], v[128:131]
  s_add_u32 m0, s24, 65536
  ds_read_b64_tr_b16 v[66:67], v12 offset:41984
  v_accvgpr_read_b32 v19, a35
  v_mfma_f32_16x16x32_bf16 v[144:147], v[44:47], v[224:227], v[144:147]
  buffer_load_dwordx4 v3, s[32:35], s26 offen offset:0 sc1 lds
  v_accvgpr_read_b32 v20, a36
  v_mfma_f32_16x16x32_bf16 v[160:163], v[48:51], v[224:227], v[160:163]
  ds_read_b64_tr_b16 v[68:69], v13 offset:40960
  v_accvgpr_read_b32 v21, a37
  v_mfma_f32_16x16x32_bf16 v[176:179], v[52:55], v[224:227], v[176:179]
  ds_read_b64_tr_b16 v[70:71], v13 offset:41984
  v_accvgpr_read_b32 v22, a38
  v_mfma_f32_16x16x32_bf16 v[192:195], v[56:59], v[224:227], v[192:195]
  ds_read_b64_tr_b16 v[72:73], v12 offset:41216
  v_accvgpr_read_b32 v23, a39
  v_mfma_f32_16x16x32_bf16 v[208:211], v[60:63], v[224:227], v[208:211]
  ds_read_b64_tr_b16 v[74:75], v12 offset:42240
  v_mul_f32 v16, s76, v16
  v_mfma_f32_16x16x32_bf16 v[100:103], v[32:35], v[228:231], v[100:103]
  buffer_load_dwordx4 v4, s[32:35], s26 offen offset:1024 sc1 lds
  v_mul_f32 v17, s76, v17
  v_mfma_f32_16x16x32_bf16 v[116:119], v[36:39], v[228:231], v[116:119]
  ds_read_b64_tr_b16 v[76:77], v13 offset:41216
  v_mul_f32 v18, s76, v18
  v_mfma_f32_16x16x32_bf16 v[132:135], v[40:43], v[228:231], v[132:135]
  ds_read_b64_tr_b16 v[78:79], v13 offset:42240
  v_mul_f32 v19, s76, v19
  v_mfma_f32_16x16x32_bf16 v[148:151], v[44:47], v[228:231], v[148:151]
  ds_read_b128 v[240:243], v14 offset:32768
  v_mul_f32 v20, s76, v20
  v_mfma_f32_16x16x32_bf16 v[164:167], v[48:51], v[228:231], v[164:167]
  ds_read_b128 v[244:247], v14 offset:33792
  v_mul_f32 v21, s76, v21
  v_mfma_f32_16x16x32_bf16 v[180:183], v[52:55], v[228:231], v[180:183]
  buffer_load_dwordx4 v5, s[32:35], s26 offen offset:2048 sc1 lds
  v_mul_f32 v22, s76, v22
  v_mfma_f32_16x16x32_bf16 v[196:199], v[56:59], v[228:231], v[196:199]
  ds_read_b64_tr_b16 v[80:81], v12 offset:41472
  v_mul_f32 v23, s76, v23
  v_mfma_f32_16x16x32_bf16 v[212:215], v[60:63], v[228:231], v[212:215]
  ds_read_b64_tr_b16 v[82:83], v12 offset:42496
  v_cvt_pk_bf16_f32 v24, v16, v17
  v_mfma_f32_16x16x32_bf16 v[104:107], v[32:35], v[232:235], v[104:107]
  ds_read_b64_tr_b16 v[84:85], v13 offset:41472
  v_cvt_pk_bf16_f32 v25, v18, v19
  v_mfma_f32_16x16x32_bf16 v[120:123], v[36:39], v[232:235], v[120:123]
  ds_read_b64_tr_b16 v[86:87], v13 offset:42496
  v_cvt_pk_bf16_f32 v26, v20, v21
  v_mfma_f32_16x16x32_bf16 v[136:139], v[40:43], v[232:235], v[136:139]
  buffer_load_dwordx4 v6, s[32:35], s26 offen offset:3072 sc1 lds
  v_cvt_pk_bf16_f32 v27, v22, v23
  v_mfma_f32_16x16x32_bf16 v[152:155], v[44:47], v[232:235], v[152:155]
  s_add_u32 s26, s26, 1024
  ds_read_b64_tr_b16 v[88:89], v12 offset:41728
  buffer_store_dwordx4 v[24:27], v2, s[40:43], s64 offen offset:0 sc1
  v_mfma_f32_16x16x32_bf16 v[168:171], v[48:51], v[232:235], v[168:171]
  ds_read_b64_tr_b16 v[90:91], v12 offset:42752
  v_mfma_f32_16x16x32_bf16 v[184:187], v[52:55], v[232:235], v[184:187]
  ds_read_b64_tr_b16 v[92:93], v13 offset:41728
  v_mfma_f32_16x16x32_bf16 v[200:203], v[56:59], v[232:235], v[200:203]
  s_add_u32 m0, s24, 16384
  ds_read_b64_tr_b16 v[94:95], v13 offset:42752
  v_mfma_f32_16x16x32_bf16 v[216:219], v[60:63], v[232:235], v[216:219]
  buffer_load_dwordx4 v10, s[36:39], s27 offen offset:2048 lds
  v_mfma_f32_16x16x32_bf16 v[108:111], v[32:35], v[236:239], v[108:111]
  ds_read_b128 v[248:251], v14 offset:34816
  v_mfma_f32_16x16x32_bf16 v[124:127], v[36:39], v[236:239], v[124:127]
  ds_read_b128 v[252:255], v14 offset:35840
  v_mfma_f32_16x16x32_bf16 v[140:143], v[40:43], v[236:239], v[140:143]
  v_mfma_f32_16x16x32_bf16 v[156:159], v[44:47], v[236:239], v[156:159]
  v_xor_b32 v14, 0x10000, v14
  v_mfma_f32_16x16x32_bf16 v[172:175], v[48:51], v[236:239], v[172:175]
  buffer_load_dwordx4 v11, s[36:39], s27 offen offset:3072 lds
  v_mfma_f32_16x16x32_bf16 v[188:191], v[52:55], v[236:239], v[188:191]
  s_add_u32 s27, s27, 524288
  v_xor_b32 v12, 0x10000, v12
  v_mfma_f32_16x16x32_bf16 v[204:207], v[56:59], v[236:239], v[204:207]
  v_xor_b32 v13, 0x10000, v13
  v_mfma_f32_16x16x32_bf16 v[220:223], v[60:63], v[236:239], v[220:223]
  s_waitcnt vmcnt(17) lgkmcnt(0)
  v_mfma_f32_16x16x32_bf16 v[96:99], v[64:67], v[240:243], v[96:99]
  s_barrier
  v_accvgpr_read_b32 v16, a40
  v_accvgpr_read_b32 v17, a41
  v_mfma_f32_16x16x32_bf16 v[112:115], v[68:71], v[240:243], v[112:115]
  ds_read_b64_tr_b16 v[32:33], v12 offset:0
  v_accvgpr_read_b32 v18, a42
  v_mfma_f32_16x16x32_bf16 v[128:131], v[72:75], v[240:243], v[128:131]
  s_add_u32 m0, s24, 98304
  ds_read_b64_tr_b16 v[34:35], v12 offset:1024
  v_accvgpr_read_b32 v19, a43
  v_mfma_f32_16x16x32_bf16 v[144:147], v[76:79], v[240:243], v[144:147]
  buffer_load_dwordx4 v3, s[32:35], s26 offen offset:0 sc1 lds
  v_accvgpr_read_b32 v20, a44
  v_mfma_f32_16x16x32_bf16 v[160:163], v[80:83], v[240:243], v[160:163]
  ds_read_b64_tr_b16 v[36:37], v13 offset:0
  v_accvgpr_read_b32 v21, a45
  v_mfma_f32_16x16x32_bf16 v[176:179], v[84:87], v[240:243], v[176:179]
  ds_read_b64_tr_b16 v[38:39], v13 offset:1024
  v_accvgpr_read_b32 v22, a46
  v_mfma_f32_16x16x32_bf16 v[192:195], v[88:91], v[240:243], v[192:195]
  ds_read_b64_tr_b16 v[40:41], v12 offset:256
  v_accvgpr_read_b32 v23, a47
  v_mfma_f32_16x16x32_bf16 v[208:211], v[92:95], v[240:243], v[208:211]
  ds_read_b64_tr_b16 v[42:43], v12 offset:1280
  v_mul_f32 v16, s76, v16
  v_mfma_f32_16x16x32_bf16 v[100:103], v[64:67], v[244:247], v[100:103]
  buffer_load_dwordx4 v4, s[32:35], s26 offen offset:1024 sc1 lds
  v_mul_f32 v17, s76, v17
  v_mfma_f32_16x16x32_bf16 v[116:119], v[68:71], v[244:247], v[116:119]
  ds_read_b64_tr_b16 v[44:45], v13 offset:256
  v_mul_f32 v18, s76, v18
  v_mfma_f32_16x16x32_bf16 v[132:135], v[72:75], v[244:247], v[132:135]
  ds_read_b64_tr_b16 v[46:47], v13 offset:1280
  v_mul_f32 v19, s76, v19
  v_mfma_f32_16x16x32_bf16 v[148:151], v[76:79], v[244:247], v[148:151]
  ds_read_b128 v[224:227], v14 offset:0
  v_mul_f32 v20, s76, v20
  v_mfma_f32_16x16x32_bf16 v[164:167], v[80:83], v[244:247], v[164:167]
  ds_read_b128 v[228:231], v14 offset:1024
  v_mul_f32 v21, s76, v21
  v_mfma_f32_16x16x32_bf16 v[180:183], v[84:87], v[244:247], v[180:183]
  buffer_load_dwordx4 v5, s[32:35], s26 offen offset:2048 sc1 lds
  v_mul_f32 v22, s76, v22
  v_mfma_f32_16x16x32_bf16 v[196:199], v[88:91], v[244:247], v[196:199]
  ds_read_b64_tr_b16 v[48:49], v12 offset:512
  v_mul_f32 v23, s76, v23
  v_mfma_f32_16x16x32_bf16 v[212:215], v[92:95], v[244:247], v[212:215]
  ds_read_b64_tr_b16 v[50:51], v12 offset:1536
  v_cvt_pk_bf16_f32 v28, v16, v17
  v_mfma_f32_16x16x32_bf16 v[104:107], v[64:67], v[248:251], v[104:107]
  ds_read_b64_tr_b16 v[52:53], v13 offset:512
  v_cvt_pk_bf16_f32 v29, v18, v19
  v_mfma_f32_16x16x32_bf16 v[120:123], v[68:71], v[248:251], v[120:123]
  ds_read_b64_tr_b16 v[54:55], v13 offset:1536
  v_cvt_pk_bf16_f32 v30, v20, v21
  v_mfma_f32_16x16x32_bf16 v[136:139], v[72:75], v[248:251], v[136:139]
  buffer_load_dwordx4 v6, s[32:35], s26 offen offset:3072 sc1 lds
  v_cvt_pk_bf16_f32 v31, v22, v23
  v_mfma_f32_16x16x32_bf16 v[152:155], v[76:79], v[248:251], v[152:155]
  s_add_u32 s26, s26, 1024
  ds_read_b64_tr_b16 v[56:57], v12 offset:768
  buffer_store_dwordx4 v[28:31], v2, s[40:43], s64 offen offset:1024 sc1
  v_mfma_f32_16x16x32_bf16 v[168:171], v[80:83], v[248:251], v[168:171]
  ds_read_b64_tr_b16 v[58:59], v12 offset:1792
  v_mfma_f32_16x16x32_bf16 v[184:187], v[84:87], v[248:251], v[184:187]
  ds_read_b64_tr_b16 v[60:61], v13 offset:768
  v_mfma_f32_16x16x32_bf16 v[200:203], v[88:91], v[248:251], v[200:203]
  s_add_u32 m0, s24, 49152
  ds_read_b64_tr_b16 v[62:63], v13 offset:1792
  v_mfma_f32_16x16x32_bf16 v[216:219], v[92:95], v[248:251], v[216:219]
  buffer_load_dwordx4 v8, s[36:39], s27 offen offset:0 lds
  v_mfma_f32_16x16x32_bf16 v[108:111], v[64:67], v[252:255], v[108:111]
  ds_read_b128 v[232:235], v14 offset:2048
  v_mfma_f32_16x16x32_bf16 v[124:127], v[68:71], v[252:255], v[124:127]
  ds_read_b128 v[236:239], v14 offset:3072
  v_mfma_f32_16x16x32_bf16 v[140:143], v[72:75], v[252:255], v[140:143]
  v_mfma_f32_16x16x32_bf16 v[156:159], v[76:79], v[252:255], v[156:159]
  v_mfma_f32_16x16x32_bf16 v[172:175], v[80:83], v[252:255], v[172:175]
  buffer_load_dwordx4 v9, s[36:39], s27 offen offset:1024 lds
  v_mfma_f32_16x16x32_bf16 v[188:191], v[84:87], v[252:255], v[188:191]
  v_mfma_f32_16x16x32_bf16 v[204:207], v[88:91], v[252:255], v[204:207]
  v_mfma_f32_16x16x32_bf16 v[220:223], v[92:95], v[252:255], v[220:223]
  s_waitcnt vmcnt(17) lgkmcnt(0)
  v_mfma_f32_16x16x32_bf16 v[96:99], v[32:35], v[224:227], v[96:99]
  v_accvgpr_read_b32 v16, a48
  v_accvgpr_read_b32 v17, a49
  v_accvgpr_read_b32 v18, a50
  v_mfma_f32_16x16x32_bf16 v[112:115], v[36:39], v[224:227], v[112:115]
  ds_read_b64_tr_b16 v[64:65], v12 offset:8192
  v_accvgpr_read_b32 v19, a51
  v_mfma_f32_16x16x32_bf16 v[128:131], v[40:43], v[224:227], v[128:131]
  s_add_u32 m0, s24, 0
  ds_read_b64_tr_b16 v[66:67], v12 offset:9216
  v_accvgpr_read_b32 v20, a52
  v_mfma_f32_16x16x32_bf16 v[144:147], v[44:47], v[224:227], v[144:147]
  buffer_load_dwordx4 v3, s[32:35], s26 offen offset:0 sc1 lds
  v_accvgpr_read_b32 v21, a53
  v_accvgpr_read_b32 v22, a54
  v_mfma_f32_16x16x32_bf16 v[160:163], v[48:51], v[224:227], v[160:163]
  ds_read_b64_tr_b16 v[68:69], v13 offset:8192
  v_accvgpr_read_b32 v23, a55
  v_mfma_f32_16x16x32_bf16 v[176:179], v[52:55], v[224:227], v[176:179]
  ds_read_b64_tr_b16 v[70:71], v13 offset:9216
  v_mul_f32 v16, s76, v16
  v_mfma_f32_16x16x32_bf16 v[192:195], v[56:59], v[224:227], v[192:195]
  ds_read_b64_tr_b16 v[72:73], v12 offset:8448
  v_mul_f32 v17, s76, v17
  v_mfma_f32_16x16x32_bf16 v[208:211], v[60:63], v[224:227], v[208:211]
  ds_read_b64_tr_b16 v[74:75], v12 offset:9472
  v_mul_f32 v18, s76, v18
  v_mul_f32 v19, s76, v19
  v_mfma_f32_16x16x32_bf16 v[100:103], v[32:35], v[228:231], v[100:103]
  buffer_load_dwordx4 v4, s[32:35], s26 offen offset:1024 sc1 lds
  v_mul_f32 v20, s76, v20
  v_mfma_f32_16x16x32_bf16 v[116:119], v[36:39], v[228:231], v[116:119]
  ds_read_b64_tr_b16 v[76:77], v13 offset:8448
  v_mul_f32 v21, s76, v21
  v_mfma_f32_16x16x32_bf16 v[132:135], v[40:43], v[228:231], v[132:135]
  ds_read_b64_tr_b16 v[78:79], v13 offset:9472
  v_mul_f32 v22, s76, v22
  v_mfma_f32_16x16x32_bf16 v[148:151], v[44:47], v[228:231], v[148:151]
  ds_read_b128 v[240:243], v14 offset:32768
  v_mul_f32 v23, s76, v23
  v_cvt_pk_bf16_f32 v24, v16, v17
  v_mfma_f32_16x16x32_bf16 v[164:167], v[48:51], v[228:231], v[164:167]
  ds_read_b128 v[244:247], v14 offset:33792
  v_cvt_pk_bf16_f32 v25, v18, v19
  v_mfma_f32_16x16x32_bf16 v[180:183], v[52:55], v[228:231], v[180:183]
  buffer_load_dwordx4 v5, s[32:35], s26 offen offset:2048 sc1 lds
  v_cvt_pk_bf16_f32 v26, v20, v21
  v_mfma_f32_16x16x32_bf16 v[196:199], v[56:59], v[228:231], v[196:199]
  ds_read_b64_tr_b16 v[80:81], v12 offset:8704
  v_cvt_pk_bf16_f32 v27, v22, v23
  v_mfma_f32_16x16x32_bf16 v[212:215], v[60:63], v[228:231], v[212:215]
  ds_read_b64_tr_b16 v[82:83], v12 offset:9728
  buffer_store_dwordx4 v[24:27], v2, s[40:43], s64 offen offset:2048 sc1
  v_accvgpr_read_b32 v16, a56
  v_mfma_f32_16x16x32_bf16 v[104:107], v[32:35], v[232:235], v[104:107]
  ds_read_b64_tr_b16 v[84:85], v13 offset:8704
  v_accvgpr_read_b32 v17, a57
  v_mfma_f32_16x16x32_bf16 v[120:123], v[36:39], v[232:235], v[120:123]
  ds_read_b64_tr_b16 v[86:87], v13 offset:9728
  v_accvgpr_read_b32 v18, a58
  v_mfma_f32_16x16x32_bf16 v[136:139], v[40:43], v[232:235], v[136:139]
  buffer_load_dwordx4 v6, s[32:35], s26 offen offset:3072 sc1 lds
  v_accvgpr_read_b32 v19, a59
  v_accvgpr_read_b32 v20, a60
  v_mfma_f32_16x16x32_bf16 v[152:155], v[44:47], v[232:235], v[152:155]
  s_add_u32 s26, s26, 1024
  ds_read_b64_tr_b16 v[88:89], v12 offset:8960
  v_accvgpr_read_b32 v21, a61
  v_mfma_f32_16x16x32_bf16 v[168:171], v[48:51], v[232:235], v[168:171]
  ds_read_b64_tr_b16 v[90:91], v12 offset:9984
  v_accvgpr_read_b32 v22, a62
  v_mfma_f32_16x16x32_bf16 v[184:187], v[52:55], v[232:235], v[184:187]
  ds_read_b64_tr_b16 v[92:93], v13 offset:8960
  v_accvgpr_read_b32 v23, a63
  v_mfma_f32_16x16x32_bf16 v[200:203], v[56:59], v[232:235], v[200:203]
  s_add_u32 m0, s24, 49152
  ds_read_b64_tr_b16 v[94:95], v13 offset:9984
  v_mul_f32 v16, s76, v16
  v_mul_f32 v17, s76, v17
  v_mfma_f32_16x16x32_bf16 v[216:219], v[60:63], v[232:235], v[216:219]
  buffer_load_dwordx4 v10, s[36:39], s27 offen offset:2048 lds
  v_mul_f32 v18, s76, v18
  v_mfma_f32_16x16x32_bf16 v[108:111], v[32:35], v[236:239], v[108:111]
  ds_read_b128 v[248:251], v14 offset:34816
  v_mul_f32 v19, s76, v19
  v_mfma_f32_16x16x32_bf16 v[124:127], v[36:39], v[236:239], v[124:127]
  ds_read_b128 v[252:255], v14 offset:35840
  v_mul_f32 v20, s76, v20
  v_mfma_f32_16x16x32_bf16 v[140:143], v[40:43], v[236:239], v[140:143]
  v_mul_f32 v21, s76, v21
  v_mul_f32 v22, s76, v22
  v_mul_f32 v23, s76, v23
  v_mfma_f32_16x16x32_bf16 v[156:159], v[44:47], v[236:239], v[156:159]
  v_xor_b32 v14, 0x10000, v14
  v_cvt_pk_bf16_f32 v28, v16, v17
  v_mfma_f32_16x16x32_bf16 v[172:175], v[48:51], v[236:239], v[172:175]
  buffer_load_dwordx4 v11, s[36:39], s27 offen offset:3072 lds
  v_cvt_pk_bf16_f32 v29, v18, v19
  v_mfma_f32_16x16x32_bf16 v[188:191], v[52:55], v[236:239], v[188:191]
  s_add_u32 s27, s27, 524288
  v_cvt_pk_bf16_f32 v30, v20, v21
  v_cvt_pk_bf16_f32 v31, v22, v23
  v_mfma_f32_16x16x32_bf16 v[204:207], v[56:59], v[236:239], v[204:207]
  buffer_store_dwordx4 v[28:31], v2, s[40:43], s64 offen offset:3072 sc1
  v_mfma_f32_16x16x32_bf16 v[220:223], v[60:63], v[236:239], v[220:223]
  s_waitcnt vmcnt(18) lgkmcnt(0)
  v_mfma_f32_16x16x32_bf16 v[96:99], v[64:67], v[240:243], v[96:99]
  s_barrier
  v_accvgpr_read_b32 v16, a64
  v_accvgpr_read_b32 v17, a65
  v_accvgpr_read_b32 v18, a66
  v_mfma_f32_16x16x32_bf16 v[112:115], v[68:71], v[240:243], v[112:115]
  s_add_u32 s64, s64, 126976
  ds_read_b64_tr_b16 v[32:33], v12 offset:32768
  v_accvgpr_read_b32 v19, a67
  v_accvgpr_read_b32 v20, a68
  v_mfma_f32_16x16x32_bf16 v[128:131], v[72:75], v[240:243], v[128:131]
  s_add_u32 m0, s24, 32768
  ds_read_b64_tr_b16 v[34:35], v12 offset:33792
  v_accvgpr_read_b32 v21, a69
  v_mfma_f32_16x16x32_bf16 v[144:147], v[76:79], v[240:243], v[144:147]
  buffer_load_dwordx4 v3, s[32:35], s26 offen offset:0 sc1 lds
  v_accvgpr_read_b32 v22, a70
  v_accvgpr_read_b32 v23, a71
  v_mfma_f32_16x16x32_bf16 v[160:163], v[80:83], v[240:243], v[160:163]
  ds_read_b64_tr_b16 v[36:37], v13 offset:32768
  v_mul_f32 v16, s76, v16
  v_mfma_f32_16x16x32_bf16 v[176:179], v[84:87], v[240:243], v[176:179]
  ds_read_b64_tr_b16 v[38:39], v13 offset:33792
  v_mul_f32 v17, s76, v17
  v_mul_f32 v18, s76, v18
  v_mfma_f32_16x16x32_bf16 v[192:195], v[88:91], v[240:243], v[192:195]
  ds_read_b64_tr_b16 v[40:41], v12 offset:33024
  v_mul_f32 v19, s76, v19
  v_mfma_f32_16x16x32_bf16 v[208:211], v[92:95], v[240:243], v[208:211]
  ds_read_b64_tr_b16 v[42:43], v12 offset:34048
  v_mul_f32 v20, s76, v20
  v_mul_f32 v21, s76, v21
  v_mfma_f32_16x16x32_bf16 v[100:103], v[64:67], v[244:247], v[100:103]
  buffer_load_dwordx4 v4, s[32:35], s26 offen offset:1024 sc1 lds
  v_mul_f32 v22, s76, v22
  v_mfma_f32_16x16x32_bf16 v[116:119], v[68:71], v[244:247], v[116:119]
  ds_read_b64_tr_b16 v[44:45], v13 offset:33024
  v_mul_f32 v23, s76, v23
  v_cvt_pk_bf16_f32 v24, v16, v17
  v_mfma_f32_16x16x32_bf16 v[132:135], v[72:75], v[244:247], v[132:135]
  ds_read_b64_tr_b16 v[46:47], v13 offset:34048
  v_cvt_pk_bf16_f32 v25, v18, v19
  v_mfma_f32_16x16x32_bf16 v[148:151], v[76:79], v[244:247], v[148:151]
  ds_read_b128 v[224:227], v14 offset:0
  v_cvt_pk_bf16_f32 v26, v20, v21
  v_cvt_pk_bf16_f32 v27, v22, v23
  v_mfma_f32_16x16x32_bf16 v[164:167], v[80:83], v[244:247], v[164:167]
  ds_read_b128 v[228:231], v14 offset:1024
  buffer_store_dwordx4 v[24:27], v2, s[40:43], s64 offen offset:0 sc1
  v_mfma_f32_16x16x32_bf16 v[180:183], v[84:87], v[244:247], v[180:183]
  buffer_load_dwordx4 v5, s[32:35], s26 offen offset:2048 sc1 lds
  v_accvgpr_read_b32 v16, a72
  v_accvgpr_read_b32 v17, a73
  v_mfma_f32_16x16x32_bf16 v[196:199], v[88:91], v[244:247], v[196:199]
  ds_read_b64_tr_b16 v[48:49], v12 offset:33280
  v_accvgpr_read_b32 v18, a74
  v_mfma_f32_16x16x32_bf16 v[212:215], v[92:95], v[244:247], v[212:215]
  ds_read_b64_tr_b16 v[50:51], v12 offset:34304
  v_accvgpr_read_b32 v19, a75
  v_accvgpr_read_b32 v20, a76
  v_mfma_f32_16x16x32_bf16 v[104:107], v[64:67], v[248:251], v[104:107]
  ds_read_b64_tr_b16 v[52:53], v13 offset:33280
  v_accvgpr_read_b32 v21, a77
  v_accvgpr_read_b32 v22, a78
  v_mfma_f32_16x16x32_bf16 v[120:123], v[68:71], v[248:251], v[120:123]
  ds_read_b64_tr_b16 v[54:55], v13 offset:34304
  v_accvgpr_read_b32 v23, a79
  v_mfma_f32_16x16x32_bf16 v[136:139], v[72:75], v[248:251], v[136:139]
  buffer_load_dwordx4 v6, s[32:35], s26 offen offset:3072 sc1 lds
  v_mul_f32 v16, s76, v16
  v_mul_f32 v17, s76, v17
  v_mfma_f32_16x16x32_bf16 v[152:155], v[76:79], v[248:251], v[152:155]
  s_add_u32 s26, s26, 1024
  ds_read_b64_tr_b16 v[56:57], v12 offset:33536
  v_mul_f32 v18, s76, v18
  v_mfma_f32_16x16x32_bf16 v[168:171], v[80:83], v[248:251], v[168:171]
  ds_read_b64_tr_b16 v[58:59], v12 offset:34560
  v_mul_f32 v19, s76, v19
  v_mul_f32 v20, s76, v20
  v_mfma_f32_16x16x32_bf16 v[184:187], v[84:87], v[248:251], v[184:187]
  ds_read_b64_tr_b16 v[60:61], v13 offset:33536
  v_mul_f32 v21, s76, v21
  v_mfma_f32_16x16x32_bf16 v[200:203], v[88:91], v[248:251], v[200:203]
  ds_read_b64_tr_b16 v[62:63], v13 offset:34560
  v_mul_f32 v22, s76, v22
  v_mul_f32 v23, s76, v23
  v_mfma_f32_16x16x32_bf16 v[216:219], v[92:95], v[248:251], v[216:219]
  v_cvt_pk_bf16_f32 v28, v16, v17
  v_cvt_pk_bf16_f32 v29, v18, v19
  v_mfma_f32_16x16x32_bf16 v[108:111], v[64:67], v[252:255], v[108:111]
  ds_read_b128 v[232:235], v14 offset:2048
  v_cvt_pk_bf16_f32 v30, v20, v21
  v_cvt_pk_bf16_f32 v31, v22, v23
  v_mfma_f32_16x16x32_bf16 v[124:127], v[68:71], v[252:255], v[124:127]
  ds_read_b128 v[236:239], v14 offset:3072
  buffer_store_dwordx4 v[28:31], v2, s[40:43], s64 offen offset:1024 sc1
  v_mfma_f32_16x16x32_bf16 v[140:143], v[72:75], v[252:255], v[140:143]
  v_and_b32 v11, 15, v1
  v_lshrrev_b32 v10, 4, v1
  v_lshlrev_b32 v10, 2, v10
  v_mfma_f32_16x16x32_bf16 v[156:159], v[76:79], v[252:255], v[156:159]
  v_sub_u32 v11, v11, v10
  v_cmp_le_i32 s[68:69], 0, v11
  v_mfma_f32_16x16x32_bf16 v[172:175], v[80:83], v[252:255], v[172:175]
  v_cmp_le_i32 s[70:71], 1, v11
  v_cmp_le_i32 s[72:73], 2, v11
  v_cmp_le_i32 s[74:75], 3, v11
  v_mfma_f32_16x16x32_bf16 v[188:191], v[84:87], v[252:255], v[188:191]
  v_and_b32 v8, 7, v1
  v_lshlrev_b32 v8, 7, v8
  v_mfma_f32_16x16x32_bf16 v[204:207], v[88:91], v[252:255], v[204:207]
  v_add_u32 v8, s30, v8
  v_mfma_f32_16x16x32_bf16 v[220:223], v[92:95], v[252:255], v[220:223]
  s_waitcnt vmcnt(17) lgkmcnt(0)
  v_mfma_f32_16x16x32_bf16 v[96:99], v[32:35], v[224:227], v[96:99]
  v_accvgpr_read_b32 v16, a80
  v_accvgpr_read_b32 v17, a81
  v_accvgpr_read_b32 v18, a82
  v_mfma_f32_16x16x32_bf16 v[112:115], v[36:39], v[224:227], v[112:115]
  ds_read_b64_tr_b16 v[64:65], v12 offset:40960
  v_accvgpr_read_b32 v19, a83
  v_accvgpr_read_b32 v20, a84
  v_mfma_f32_16x16x32_bf16 v[128:131], v[40:43], v[224:227], v[128:131]
  s_add_u32 m0, s24, 65536
  ds_read_b64_tr_b16 v[66:67], v12 offset:41984
  v_accvgpr_read_b32 v21, a85
  v_accvgpr_read_b32 v22, a86
  v_mfma_f32_16x16x32_bf16 v[144:147], v[44:47], v[224:227], v[144:147]
  buffer_load_dwordx4 v3, s[32:35], s26 offen offset:0 sc1 lds
  v_accvgpr_read_b32 v23, a87
  v_mul_f32 v16, s76, v16
  v_mfma_f32_16x16x32_bf16 v[160:163], v[48:51], v[224:227], v[160:163]
  ds_read_b64_tr_b16 v[68:69], v13 offset:40960
  v_mul_f32 v17, s76, v17
  v_mul_f32 v18, s76, v18
  v_mfma_f32_16x16x32_bf16 v[176:179], v[52:55], v[224:227], v[176:179]
  ds_read_b64_tr_b16 v[70:71], v13 offset:41984
  v_mul_f32 v19, s76, v19
  v_mul_f32 v20, s76, v20
  v_mfma_f32_16x16x32_bf16 v[192:195], v[56:59], v[224:227], v[192:195]
  ds_read_b64_tr_b16 v[72:73], v12 offset:41216
  v_mul_f32 v21, s76, v21
  v_mul_f32 v22, s76, v22
  v_mfma_f32_16x16x32_bf16 v[208:211], v[60:63], v[224:227], v[208:211]
  ds_read_b64_tr_b16 v[74:75], v12 offset:42240
  v_mul_f32 v23, s76, v23
  v_mfma_f32_16x16x32_bf16 v[100:103], v[32:35], v[228:231], v[100:103]
  buffer_load_dwordx4 v4, s[32:35], s26 offen offset:1024 sc1 lds
  v_cvt_pk_bf16_f32 v24, v16, v17
  v_cvt_pk_bf16_f32 v25, v18, v19
  v_mfma_f32_16x16x32_bf16 v[116:119], v[36:39], v[228:231], v[116:119]
  ds_read_b64_tr_b16 v[76:77], v13 offset:41216
  v_cvt_pk_bf16_f32 v26, v20, v21
  v_cvt_pk_bf16_f32 v27, v22, v23
  v_mfma_f32_16x16x32_bf16 v[132:135], v[40:43], v[228:231], v[132:135]
  ds_read_b64_tr_b16 v[78:79], v13 offset:42240
  buffer_store_dwordx4 v[24:27], v2, s[40:43], s64 offen offset:2048 sc1
  v_accvgpr_read_b32 v16, a88
  v_mfma_f32_16x16x32_bf16 v[148:151], v[44:47], v[228:231], v[148:151]
  ds_read_b128 v[240:243], v14 offset:32768
  v_accvgpr_read_b32 v17, a89
  v_accvgpr_read_b32 v18, a90
  v_mfma_f32_16x16x32_bf16 v[164:167], v[48:51], v[228:231], v[164:167]
  ds_read_b128 v[244:247], v14 offset:33792
  v_accvgpr_read_b32 v19, a91
  v_accvgpr_read_b32 v20, a92
  v_mfma_f32_16x16x32_bf16 v[180:183], v[52:55], v[228:231], v[180:183]
  buffer_load_dwordx4 v5, s[32:35], s26 offen offset:2048 sc1 lds
  v_accvgpr_read_b32 v21, a93
  v_accvgpr_read_b32 v22, a94
  v_mfma_f32_16x16x32_bf16 v[196:199], v[56:59], v[228:231], v[196:199]
  ds_read_b64_tr_b16 v[80:81], v12 offset:41472
  v_accvgpr_read_b32 v23, a95
  v_mfma_f32_16x16x32_bf16 v[212:215], v[60:63], v[228:231], v[212:215]
  ds_read_b64_tr_b16 v[82:83], v12 offset:42496
  v_mul_f32 v16, s76, v16
  v_mul_f32 v17, s76, v17
  v_mfma_f32_16x16x32_bf16 v[104:107], v[32:35], v[232:235], v[104:107]
  ds_read_b64_tr_b16 v[84:85], v13 offset:41472
  v_mul_f32 v18, s76, v18
  v_mul_f32 v19, s76, v19
  v_mfma_f32_16x16x32_bf16 v[120:123], v[36:39], v[232:235], v[120:123]
  ds_read_b64_tr_b16 v[86:87], v13 offset:42496
  v_mul_f32 v20, s76, v20
  v_mul_f32 v21, s76, v21
  v_mfma_f32_16x16x32_bf16 v[136:139], v[40:43], v[232:235], v[136:139]
  buffer_load_dwordx4 v6, s[32:35], s26 offen offset:3072 sc1 lds
  v_mul_f32 v22, s76, v22
  v_mul_f32 v23, s76, v23
  v_mfma_f32_16x16x32_bf16 v[152:155], v[44:47], v[232:235], v[152:155]
  s_add_u32 s26, s26, 1024
  ds_read_b64_tr_b16 v[88:89], v12 offset:41728
  v_cvt_pk_bf16_f32 v28, v16, v17
  v_cvt_pk_bf16_f32 v29, v18, v19
  v_mfma_f32_16x16x32_bf16 v[168:171], v[48:51], v[232:235], v[168:171]
  ds_read_b64_tr_b16 v[90:91], v12 offset:42752
  v_cvt_pk_bf16_f32 v30, v20, v21
  v_cvt_pk_bf16_f32 v31, v22, v23
  v_mfma_f32_16x16x32_bf16 v[184:187], v[52:55], v[232:235], v[184:187]
  ds_read_b64_tr_b16 v[92:93], v13 offset:41728
  buffer_store_dwordx4 v[28:31], v2, s[40:43], s64 offen offset:3072 sc1
  v_add_u32 v9, 0, v1
  v_mfma_f32_16x16x32_bf16 v[200:203], v[56:59], v[232:235], v[200:203]
  ds_read_b64_tr_b16 v[94:95], v13 offset:42752
  v_mul_u32_u24 v10, 6554, v9
  v_mfma_f32_16x16x32_bf16 v[216:219], v[60:63], v[232:235], v[216:219]
  v_lshrrev_b32 v10, 16, v10
  v_mul_u32_u24 v10, 1120, v10
  v_lshl_add_u32 v10, v9, 4, v10
  v_mfma_f32_16x16x32_bf16 v[108:111], v[32:35], v[236:239], v[108:111]
  ds_read_b128 v[248:251], v14 offset:34816
  v_accvgpr_write_b32 a248, v10
  v_add_u32 v9, 64, v1
  v_mfma_f32_16x16x32_bf16 v[124:127], v[36:39], v[236:239], v[124:127]
  ds_read_b128 v[252:255], v14 offset:35840
  v_mul_u32_u24 v10, 6554, v9
  v_lshrrev_b32 v10, 16, v10
  v_mfma_f32_16x16x32_bf16 v[140:143], v[40:43], v[236:239], v[140:143]
  v_mul_u32_u24 v10, 1120, v10
  v_lshl_add_u32 v10, v9, 4, v10
  v_accvgpr_write_b32 a249, v10
  v_mfma_f32_16x16x32_bf16 v[156:159], v[44:47], v[236:239], v[156:159]
  v_xor_b32 v14, 0x10000, v14
  v_add_u32 v9, 128, v1
  v_mul_u32_u24 v10, 6554, v9
  v_mfma_f32_16x16x32_bf16 v[172:175], v[48:51], v[236:239], v[172:175]
  v_lshrrev_b32 v10, 16, v10
  v_mul_u32_u24 v10, 1120, v10
  v_lshl_add_u32 v10, v9, 4, v10
  v_mfma_f32_16x16x32_bf16 v[188:191], v[52:55], v[236:239], v[188:191]
  v_xor_b32 v12, 0x10000, v12
  v_accvgpr_write_b32 a250, v10
  v_mfma_f32_16x16x32_bf16 v[204:207], v[56:59], v[236:239], v[204:207]
  v_xor_b32 v13, 0x10000, v13
  v_mfma_f32_16x16x32_bf16 v[220:223], v[60:63], v[236:239], v[220:223]
  s_waitcnt vmcnt(15) lgkmcnt(0)
  v_mfma_f32_16x16x32_bf16 v[96:99], v[64:67], v[240:243], v[96:99]
  s_barrier
  v_accvgpr_read_b32 v16, a96
  v_accvgpr_read_b32 v17, a97
  v_accvgpr_read_b32 v18, a98
  v_accvgpr_read_b32 v19, a99
  v_mfma_f32_16x16x32_bf16 v[112:115], v[68:71], v[240:243], v[112:115]
  s_add_u32 s64, s64, 4096
  ds_read_b64_tr_b16 v[32:33], v12 offset:0
  v_accvgpr_read_b32 v20, a100
  v_accvgpr_read_b32 v21, a101
  v_mfma_f32_16x16x32_bf16 v[128:131], v[72:75], v[240:243], v[128:131]
  s_add_u32 m0, s24, 98304
  ds_read_b64_tr_b16 v[34:35], v12 offset:1024
  v_accvgpr_read_b32 v22, a102
  v_accvgpr_read_b32 v23, a103
  v_mfma_f32_16x16x32_bf16 v[144:147], v[76:79], v[240:243], v[144:147]
  buffer_load_dwordx4 v3, s[32:35], s26 offen offset:0 sc1 lds
  v_mul_f32 v16, s76, v16
  v_mul_f32 v17, s76, v17
  v_mul_f32 v18, s76, v18
  v_mfma_f32_16x16x32_bf16 v[160:163], v[80:83], v[240:243], v[160:163]
  ds_read_b64_tr_b16 v[36:37], v13 offset:0
  v_mul_f32 v19, s76, v19
  v_mul_f32 v20, s76, v20
  v_mfma_f32_16x16x32_bf16 v[176:179], v[84:87], v[240:243], v[176:179]
  ds_read_b64_tr_b16 v[38:39], v13 offset:1024
  v_mul_f32 v21, s76, v21
  v_mul_f32 v22, s76, v22
  v_mfma_f32_16x16x32_bf16 v[192:195], v[88:91], v[240:243], v[192:195]
  ds_read_b64_tr_b16 v[40:41], v12 offset:256
  v_mul_f32 v23, s76, v23
  v_cvt_pk_bf16_f32 v24, v16, v17
  v_cvt_pk_bf16_f32 v25, v18, v19
  v_mfma_f32_16x16x32_bf16 v[208:211], v[92:95], v[240:243], v[208:211]
  ds_read_b64_tr_b16 v[42:43], v12 offset:1280
  v_cvt_pk_bf16_f32 v26, v20, v21
  v_cvt_pk_bf16_f32 v27, v22, v23
  v_mfma_f32_16x16x32_bf16 v[100:103], v[64:67], v[244:247], v[100:103]
  buffer_load_dwordx4 v4, s[32:35], s26 offen offset:1024 sc1 lds
  buffer_store_dwordx4 v[24:27], v2, s[40:43], s64 offen offset:0 sc1
  v_accvgpr_read_b32 v16, a104
  v_mfma_f32_16x16x32_bf16 v[116:119], v[68:71], v[244:247], v[116:119]
  ds_read_b64_tr_b16 v[44:45], v13 offset:256
  v_accvgpr_read_b32 v17, a105
  v_accvgpr_read_b32 v18, a106
  v_mfma_f32_16x16x32_bf16 v[132:135], v[72:75], v[244:247], v[132:135]
  ds_read_b64_tr_b16 v[46:47], v13 offset:1280
  v_accvgpr_read_b32 v19, a107
  v_accvgpr_read_b32 v20, a108
  v_accvgpr_read_b32 v21, a109
  v_mfma_f32_16x16x32_bf16 v[148:151], v[76:79], v[244:247], v[148:151]
  ds_read_b128 v[224:227], v14 offset:0
  v_accvgpr_read_b32 v22, a110
  v_accvgpr_read_b32 v23, a111
  v_mfma_f32_16x16x32_bf16 v[164:167], v[80:83], v[244:247], v[164:167]
  ds_read_b128 v[228:231], v14 offset:1024
  v_mul_f32 v16, s76, v16
  v_mul_f32 v17, s76, v17
  v_mfma_f32_16x16x32_bf16 v[180:183], v[84:87], v[244:247], v[180:183]
  buffer_load_dwordx4 v5, s[32:35], s26 offen offset:2048 sc1 lds
  v_mul_f32 v18, s76, v18
  v_mul_f32 v19, s76, v19
  v_mul_f32 v20, s76, v20
  v_mfma_f32_16x16x32_bf16 v[196:199], v[88:91], v[244:247], v[196:199]
  ds_read_b64_tr_b16 v[48:49], v12 offset:512
  v_mul_f32 v21, s76, v21
  v_mul_f32 v22, s76, v22
  v_mfma_f32_16x16x32_bf16 v[212:215], v[92:95], v[244:247], v[212:215]
  ds_read_b64_tr_b16 v[50:51], v12 offset:1536
  v_mul_f32 v23, s76, v23
  v_cvt_pk_bf16_f32 v28, v16, v17
  v_mfma_f32_16x16x32_bf16 v[104:107], v[64:67], v[248:251], v[104:107]
  ds_read_b64_tr_b16 v[52:53], v13 offset:512
  v_cvt_pk_bf16_f32 v29, v18, v19
  v_cvt_pk_bf16_f32 v30, v20, v21
  v_cvt_pk_bf16_f32 v31, v22, v23
  v_mfma_f32_16x16x32_bf16 v[120:123], v[68:71], v[248:251], v[120:123]
  ds_read_b64_tr_b16 v[54:55], v13 offset:1536
  buffer_store_dwordx4 v[28:31], v2, s[40:43], s64 offen offset:1024 sc1
  v_accvgpr_read_b32 v16, a112
  v_mfma_f32_16x16x32_bf16 v[136:139], v[72:75], v[248:251], v[136:139]
  buffer_load_dwordx4 v6, s[32:35], s26 offen offset:3072 sc1 lds
  v_accvgpr_read_b32 v17, a113
  v_accvgpr_read_b32 v18, a114
  v_mfma_f32_16x16x32_bf16 v[152:155], v[76:79], v[248:251], v[152:155]
  s_add_u32 s26, s26, 1024
  ds_read_b64_tr_b16 v[56:57], v12 offset:768
  v_accvgpr_read_b32 v19, a115
  v_accvgpr_read_b32 v20, a116
  v_mfma_f32_16x16x32_bf16 v[168:171], v[80:83], v[248:251], v[168:171]
  ds_read_b64_tr_b16 v[58:59], v12 offset:1792
  v_accvgpr_read_b32 v21, a117
  v_accvgpr_read_b32 v22, a118
  v_accvgpr_read_b32 v23, a119
  v_mfma_f32_16x16x32_bf16 v[184:187], v[84:87], v[248:251], v[184:187]
  ds_read_b64_tr_b16 v[60:61], v13 offset:768
  v_mul_f32 v16, s76, v16
  v_mul_f32 v17, s76, v17
  v_mfma_f32_16x16x32_bf16 v[200:203], v[88:91], v[248:251], v[200:203]
  ds_read_b64_tr_b16 v[62:63], v13 offset:1792
  v_mul_f32 v18, s76, v18
  v_mul_f32 v19, s76, v19
  v_mfma_f32_16x16x32_bf16 v[216:219], v[92:95], v[248:251], v[216:219]
  v_mul_f32 v20, s76, v20
  v_mul_f32 v21, s76, v21
  v_mul_f32 v22, s76, v22
  v_mul_f32 v23, s76, v23
  v_mfma_f32_16x16x32_bf16 v[108:111], v[64:67], v[252:255], v[108:111]
  ds_read_b128 v[232:235], v14 offset:2048
  v_cvt_pk_bf16_f32 v24, v16, v17
  v_cvt_pk_bf16_f32 v25, v18, v19
  v_mfma_f32_16x16x32_bf16 v[124:127], v[68:71], v[252:255], v[124:127]
  ds_read_b128 v[236:239], v14 offset:3072
  v_cvt_pk_bf16_f32 v26, v20, v21
  v_cvt_pk_bf16_f32 v27, v22, v23
  v_mfma_f32_16x16x32_bf16 v[140:143], v[72:75], v[252:255], v[140:143]
  buffer_store_dwordx4 v[24:27], v2, s[40:43], s64 offen offset:2048 sc1
  v_add_u32 v9, 192, v1
  v_mul_u32_u24 v10, 6554, v9
  v_lshrrev_b32 v10, 16, v10
  v_mfma_f32_16x16x32_bf16 v[156:159], v[76:79], v[252:255], v[156:159]
  v_mul_u32_u24 v10, 1120, v10
  v_lshl_add_u32 v10, v9, 4, v10
  v_accvgpr_write_b32 a251, v10
  v_mfma_f32_16x16x32_bf16 v[172:175], v[80:83], v[252:255], v[172:175]
  v_add_u32 v9, 256, v1
  v_mul_u32_u24 v10, 6554, v9
  v_lshrrev_b32 v10, 16, v10
  v_mfma_f32_16x16x32_bf16 v[188:191], v[84:87], v[252:255], v[188:191]
  v_mul_u32_u24 v10, 1120, v10
  v_lshl_add_u32 v10, v9, 4, v10
  v_accvgpr_write_b32 a252, v10
  v_mfma_f32_16x16x32_bf16 v[204:207], v[88:91], v[252:255], v[204:207]
  v_mfma_f32_16x16x32_bf16 v[220:223], v[92:95], v[252:255], v[220:223]
  s_waitcnt vmcnt(14) lgkmcnt(0)
  v_mfma_f32_16x16x32_bf16 v[96:99], v[32:35], v[224:227], v[96:99]
  v_accvgpr_read_b32 v16, a120
  v_accvgpr_read_b32 v17, a121
  v_accvgpr_read_b32 v18, a122
  v_mfma_f32_16x16x32_bf16 v[112:115], v[36:39], v[224:227], v[112:115]
  s_mul_i32 s34, s20, 5120
  ds_read_b64_tr_b16 v[64:65], v12 offset:8192
  v_accvgpr_read_b32 v19, a123
  v_accvgpr_read_b32 v20, a124
  v_mfma_f32_16x16x32_bf16 v[128:131], v[40:43], v[224:227], v[128:131]
  s_add_u32 s34, s34, 131072
  ds_read_b64_tr_b16 v[66:67], v12 offset:9216
  v_accvgpr_read_b32 v21, a125
  v_accvgpr_read_b32 v22, a126
  v_mfma_f32_16x16x32_bf16 v[144:147], v[44:47], v[224:227], v[144:147]
  s_and_b32 s32, s21, 3
  buffer_load_dword v15, v8, s[40:43], 0 offen sc1
  v_accvgpr_read_b32 v23, a127
  v_mul_f32 v16, s76, v16
  v_mfma_f32_16x16x32_bf16 v[160:163], v[48:51], v[224:227], v[160:163]
  s_min_u32 s32, s32, 2
  ds_read_b64_tr_b16 v[68:69], v13 offset:8192
  v_mul_f32 v17, s76, v17
  v_mul_f32 v18, s76, v18
  v_mfma_f32_16x16x32_bf16 v[176:179], v[52:55], v[224:227], v[176:179]
  s_add_u32 s32, s32, 5
  ds_read_b64_tr_b16 v[70:71], v13 offset:9216
  v_mul_f32 v19, s76, v19
  v_mul_f32 v20, s76, v20
  v_mfma_f32_16x16x32_bf16 v[192:195], v[56:59], v[224:227], v[192:195]
  s_lshl_b32 s32, s32, 14
  ds_read_b64_tr_b16 v[72:73], v12 offset:8448
  v_mul_f32 v21, s76, v21
  v_mul_f32 v22, s76, v22
  v_mfma_f32_16x16x32_bf16 v[208:211], v[60:63], v[224:227], v[208:211]
  s_mov_b32 s9, -1
  ds_read_b64_tr_b16 v[74:75], v12 offset:9472
  v_mul_f32 v23, s76, v23
  v_mfma_f32_16x16x32_bf16 v[100:103], v[32:35], v[228:231], v[100:103]
  s_sub_u32 s23, s2, 64
  v_cvt_pk_bf16_f32 v28, v16, v17
  v_cvt_pk_bf16_f32 v29, v18, v19
  v_cvt_pk_bf16_f32 v30, v20, v21
  v_mfma_f32_16x16x32_bf16 v[116:119], v[36:39], v[228:231], v[116:119]
  s_cmp_lt_u32 s23, 96
  s_cselect_b32 s9, 0, s9
  ds_read_b64_tr_b16 v[76:77], v13 offset:8448
  v_cvt_pk_bf16_f32 v31, v22, v23
  v_mfma_f32_16x16x32_bf16 v[132:135], v[40:43], v[228:231], v[132:135]
  s_cmp_ge_u32 s2, 224
  s_cselect_b32 s9, 0, s9
  ds_read_b64_tr_b16 v[78:79], v13 offset:9472
  buffer_store_dwordx4 v[28:31], v2, s[40:43], s64 offen offset:3072 sc1
  v_accvgpr_read_b32 v16, a128
  v_mfma_f32_16x16x32_bf16 v[148:151], v[44:47], v[228:231], v[148:151]
  s_and_b32 s32, s32, s9
  ds_read_b128 v[240:243], v14 offset:32768
  v_accvgpr_read_b32 v17, a129
  v_accvgpr_read_b32 v18, a130
  v_mfma_f32_16x16x32_bf16 v[164:167], v[48:51], v[228:231], v[164:167]
  s_sub_u32 s23, s2, 170
  ds_read_b128 v[244:247], v14 offset:33792
  v_accvgpr_read_b32 v19, a131
  v_accvgpr_read_b32 v20, a132
  v_mfma_f32_16x16x32_bf16 v[180:183], v[52:55], v[228:231], v[180:183]
  s_cmp_lt_u32 s23, 54
  s_cselect_b32 s32, 81920, s32
  v_accvgpr_read_b32 v21, a133
  v_accvgpr_read_b32 v22, a134
  v_accvgpr_read_b32 v23, a135
  v_mfma_f32_16x16x32_bf16 v[196:199], v[56:59], v[228:231], v[196:199]
  s_mov_b32 s67, s2
  s_add_u32 s64, s64, 126976
  ds_read_b64_tr_b16 v[80:81], v12 offset:8704
  v_mul_f32 v16, s76, v16
  v_mfma_f32_16x16x32_bf16 v[212:215], v[60:63], v[228:231], v[212:215]
  s_mov_b32 s8, 0
  ds_read_b64_tr_b16 v[82:83], v12 offset:9728
  v_mul_f32 v17, s76, v17
  v_mul_f32 v18, s76, v18
  v_mfma_f32_16x16x32_bf16 v[104:107], v[32:35], v[232:235], v[104:107]
  s_mov_b32 s66, 0
  ds_read_b64_tr_b16 v[84:85], v13 offset:8704
  v_mul_f32 v19, s76, v19
  v_mul_f32 v20, s76, v20
  v_mfma_f32_16x16x32_bf16 v[120:123], v[36:39], v[232:235], v[120:123]
  s_mov_b32 s11, 0
  ds_read_b64_tr_b16 v[86:87], v13 offset:9728
  v_mul_f32 v21, s76, v21
  v_mul_f32 v22, s76, v22
  v_mfma_f32_16x16x32_bf16 v[136:139], v[40:43], v[232:235], v[136:139]
  s_mov_b32 s12, 0
  v_mul_f32 v23, s76, v23
  v_cvt_pk_bf16_f32 v24, v16, v17
  v_cvt_pk_bf16_f32 v25, v18, v19
  v_mfma_f32_16x16x32_bf16 v[152:155], v[44:47], v[232:235], v[152:155]
  s_lshl_b32 s15, s22, 1
  ds_read_b64_tr_b16 v[88:89], v12 offset:8960
  v_cvt_pk_bf16_f32 v26, v20, v21
  v_cvt_pk_bf16_f32 v27, v22, v23
  v_mfma_f32_16x16x32_bf16 v[168:171], v[48:51], v[232:235], v[168:171]
  s_add_u32 s23, s15, 6
  ds_read_b64_tr_b16 v[90:91], v12 offset:9984
  buffer_store_dwordx4 v[24:27], v2, s[40:43], s64 offen offset:0 sc1
  v_accvgpr_read_b32 v16, a136
  v_mfma_f32_16x16x32_bf16 v[184:187], v[52:55], v[232:235], v[184:187]
  s_sub_u32 s15, 24, s15
  ds_read_b64_tr_b16 v[92:93], v13 offset:8960
  v_accvgpr_read_b32 v17, a137
  v_accvgpr_read_b32 v18, a138
  v_mfma_f32_16x16x32_bf16 v[200:203], v[56:59], v[232:235], v[200:203]
  s_max_u32 s15, s15, s23
  ds_read_b64_tr_b16 v[94:95], v13 offset:9984
  v_accvgpr_read_b32 v19, a139
  v_mfma_f32_16x16x32_bf16 v[216:219], v[60:63], v[232:235], v[216:219]
  s_lshl_b32 s15, s15, 14
  v_accvgpr_read_b32 v20, a140
  v_accvgpr_read_b32 v21, a141
  v_accvgpr_read_b32 v22, a142
  v_mfma_f32_16x16x32_bf16 v[108:111], v[32:35], v[236:239], v[108:111]
  ds_read_b128 v[248:251], v14 offset:34816
  v_accvgpr_read_b32 v23, a143
  v_mul_f32 v16, s76, v16
  v_mfma_f32_16x16x32_bf16 v[124:127], v[36:39], v[236:239], v[124:127]
  ds_read_b128 v[252:255], v14 offset:35840
  v_mul_f32 v17, s76, v17
  v_mul_f32 v18, s76, v18
  v_mfma_f32_16x16x32_bf16 v[140:143], v[40:43], v[236:239], v[140:143]
  v_mul_f32 v19, s76, v19
  v_mul_f32 v20, s76, v20
  v_mul_f32 v21, s76, v21
  v_mfma_f32_16x16x32_bf16 v[156:159], v[44:47], v[236:239], v[156:159]
  v_xor_b32 v14, 0x10000, v14
  v_mul_f32 v22, s76, v22
  v_mul_f32 v23, s76, v23
  v_mfma_f32_16x16x32_bf16 v[172:175], v[48:51], v[236:239], v[172:175]
  v_cvt_pk_bf16_f32 v28, v16, v17
  v_cvt_pk_bf16_f32 v29, v18, v19
  v_cvt_pk_bf16_f32 v30, v20, v21
  v_mfma_f32_16x16x32_bf16 v[188:191], v[52:55], v[236:239], v[188:191]
  v_cvt_pk_bf16_f32 v31, v22, v23
  v_mfma_f32_16x16x32_bf16 v[204:207], v[56:59], v[236:239], v[204:207]
  buffer_store_dwordx4 v[28:31], v2, s[40:43], s64 offen offset:1024 sc1
  v_mfma_f32_16x16x32_bf16 v[220:223], v[60:63], v[236:239], v[220:223]
  s_waitcnt vmcnt(12) lgkmcnt(0)
  v_mfma_f32_16x16x32_bf16 v[96:99], v[64:67], v[240:243], v[96:99]
  s_barrier
  v_accvgpr_read_b32 v16, a144
  v_accvgpr_read_b32 v17, a145
  v_accvgpr_read_b32 v18, a146
  v_accvgpr_read_b32 v19, a147
  v_mfma_f32_16x16x32_bf16 v[112:115], v[68:71], v[240:243], v[112:115]
  s_and_b32 s23, s20, 1
  ds_read_b64_tr_b16 v[32:33], v12 offset:32768
  v_accvgpr_read_b32 v20, a148
  v_accvgpr_read_b32 v21, a149
  v_mfma_f32_16x16x32_bf16 v[128:131], v[72:75], v[240:243], v[128:131]
  s_lshl_b32 s23, s23, 12
  ds_read_b64_tr_b16 v[34:35], v12 offset:33792
  v_accvgpr_read_b32 v22, a150
  v_accvgpr_read_b32 v23, a151
  v_mfma_f32_16x16x32_bf16 v[144:147], v[76:79], v[240:243], v[144:147]
  s_cmp_lt_u32 s20, 2
  s_cselect_b32 s24, 106496, 0
  v_mul_f32 v16, s76, v16
  v_mul_f32 v17, s76, v17
  v_mul_f32 v18, s76, v18
  v_mfma_f32_16x16x32_bf16 v[160:163], v[80:83], v[240:243], v[160:163]
  s_add_u32 s24, s24, s23
  ds_read_b64_tr_b16 v[36:37], v13 offset:32768
  v_mul_f32 v19, s76, v19
  v_mul_f32 v20, s76, v20
  v_mfma_f32_16x16x32_bf16 v[176:179], v[84:87], v[240:243], v[176:179]
  s_lshl_b32 s26, s20, 12
  ds_read_b64_tr_b16 v[38:39], v13 offset:33792
  v_mul_f32 v21, s76, v21
  v_mul_f32 v22, s76, v22
  v_mfma_f32_16x16x32_bf16 v[192:195], v[88:91], v[240:243], v[192:195]
  s_mov_b32 s27, s26
  ds_read_b64_tr_b16 v[40:41], v12 offset:33024
  v_mul_f32 v23, s76, v23
  v_cvt_pk_bf16_f32 v24, v16, v17
  v_mfma_f32_16x16x32_bf16 v[208:211], v[92:95], v[240:243], v[208:211]
  s_add_u32 s25, s27, 49152
  ds_read_b64_tr_b16 v[42:43], v12 offset:34048
  v_cvt_pk_bf16_f32 v25, v18, v19
  v_cvt_pk_bf16_f32 v26, v20, v21
  v_cvt_pk_bf16_f32 v27, v22, v23
  v_mfma_f32_16x16x32_bf16 v[100:103], v[64:67], v[244:247], v[100:103]
  s_load_dwordx4 s[4:7], s[0:1], 64
  buffer_store_dwordx4 v[24:27], v2, s[40:43], s64 offen offset:2048 sc1
  v_accvgpr_read_b32 v16, a152
  v_accvgpr_read_b32 v17, a153
  v_mfma_f32_16x16x32_bf16 v[116:119], v[68:71], v[244:247], v[116:119]
  s_load_dwordx2 s[60:61], s[0:1], 80
  ds_read_b64_tr_b16 v[44:45], v13 offset:33024
  v_accvgpr_read_b32 v18, a154
  v_accvgpr_read_b32 v19, a155
  v_mfma_f32_16x16x32_bf16 v[132:135], v[72:75], v[244:247], v[132:135]
  s_add_u32 s23, s20, 1
  ds_read_b64_tr_b16 v[46:47], v13 offset:34048
  v_accvgpr_read_b32 v20, a156
  v_accvgpr_read_b32 v21, a157
  v_mfma_f32_16x16x32_bf16 v[148:151], v[76:79], v[244:247], v[148:151]
  s_lshr_b32 s23, s23, 1
  ds_read_b128 v[224:227], v14 offset:0
  v_accvgpr_read_b32 v22, a158
  v_accvgpr_read_b32 v23, a159
  v_mfma_f32_16x16x32_bf16 v[164:167], v[80:83], v[244:247], v[164:167]
  s_lshl_b32 s28, s22, 1
  ds_read_b128 v[228:231], v14 offset:1024
  v_mul_f32 v16, s76, v16
  v_mul_f32 v17, s76, v17
  v_mfma_f32_16x16x32_bf16 v[180:183], v[84:87], v[244:247], v[180:183]
  s_add_u32 s28, s28, s23
  v_mul_f32 v18, s76, v18
  v_mul_f32 v19, s76, v19
  v_mul_f32 v20, s76, v20
  v_mfma_f32_16x16x32_bf16 v[196:199], v[88:91], v[244:247], v[196:199]
  s_lshl_b32 s23, s22, 2
  ds_read_b64_tr_b16 v[48:49], v12 offset:33280
  v_mul_f32 v21, s76, v21
  v_mul_f32 v22, s76, v22
  v_mfma_f32_16x16x32_bf16 v[212:215], v[92:95], v[244:247], v[212:215]
  s_sub_u32 s29, 28, s23
  ds_read_b64_tr_b16 v[50:51], v12 offset:34304
  v_mul_f32 v23, s76, v23
  v_cvt_pk_bf16_f32 v28, v16, v17
  v_cvt_pk_bf16_f32 v29, v18, v19
  v_mfma_f32_16x16x32_bf16 v[104:107], v[64:67], v[248:251], v[104:107]
  s_and_b32 s23, s20, 1
  ds_read_b64_tr_b16 v[52:53], v13 offset:33280
  v_cvt_pk_bf16_f32 v30, v20, v21
  v_cvt_pk_bf16_f32 v31, v22, v23
  v_mfma_f32_16x16x32_bf16 v[120:123], v[68:71], v[248:251], v[120:123]
  s_add_u32 s29, s29, s23
  ds_read_b64_tr_b16 v[54:55], v13 offset:34304
  buffer_store_dwordx4 v[28:31], v2, s[40:43], s64 offen offset:3072 sc1
  v_accvgpr_read_b32 v16, a160
  v_mfma_f32_16x16x32_bf16 v[136:139], v[72:75], v[248:251], v[136:139]
  s_add_u32 s64, s64, 4096
  v_accvgpr_read_b32 v17, a161
  v_accvgpr_read_b32 v18, a162
  v_accvgpr_read_b32 v19, a163
  v_mfma_f32_16x16x32_bf16 v[152:155], v[76:79], v[248:251], v[152:155]
  ds_read_b64_tr_b16 v[56:57], v12 offset:33536
  v_accvgpr_read_b32 v20, a164
  v_accvgpr_read_b32 v21, a165
  v_mfma_f32_16x16x32_bf16 v[168:171], v[80:83], v[248:251], v[168:171]
  ds_read_b64_tr_b16 v[58:59], v12 offset:34560
  v_accvgpr_read_b32 v22, a166
  v_accvgpr_read_b32 v23, a167
  v_mfma_f32_16x16x32_bf16 v[184:187], v[84:87], v[248:251], v[184:187]
  ds_read_b64_tr_b16 v[60:61], v13 offset:33536
  v_mul_f32 v16, s76, v16
  v_mul_f32 v17, s76, v17
  v_mfma_f32_16x16x32_bf16 v[200:203], v[88:91], v[248:251], v[200:203]
  ds_read_b64_tr_b16 v[62:63], v13 offset:34560
  v_mul_f32 v18, s76, v18
  v_mul_f32 v19, s76, v19
  v_mul_f32 v20, s76, v20
  v_mfma_f32_16x16x32_bf16 v[216:219], v[92:95], v[248:251], v[216:219]
  v_mul_f32 v21, s76, v21
  v_mul_f32 v22, s76, v22
  v_mul_f32 v23, s76, v23
  v_mfma_f32_16x16x32_bf16 v[108:111], v[64:67], v[252:255], v[108:111]
  ds_read_b128 v[232:235], v14 offset:2048
  v_cvt_pk_bf16_f32 v24, v16, v17
  v_cvt_pk_bf16_f32 v25, v18, v19
  v_mfma_f32_16x16x32_bf16 v[124:127], v[68:71], v[252:255], v[124:127]
  ds_read_b128 v[236:239], v14 offset:3072
  v_cvt_pk_bf16_f32 v26, v20, v21
  v_cvt_pk_bf16_f32 v27, v22, v23
  v_mfma_f32_16x16x32_bf16 v[140:143], v[72:75], v[252:255], v[140:143]
  buffer_store_dwordx4 v[24:27], v2, s[40:43], s64 offen offset:0 sc1
  v_lshrrev_b32 v6, 2, v1
  v_mul_u32_u24 v6, 160, v6
  v_mfma_f32_16x16x32_bf16 v[156:159], v[76:79], v[252:255], v[156:159]
  v_and_b32 v9, 3, v1
  v_lshl_add_u32 v6, v9, 3, v6
  v_add_u32 v6, s34, v6
  v_mfma_f32_16x16x32_bf16 v[172:175], v[80:83], v[252:255], v[172:175]
  v_mov_b32 v3, v2
  v_mov_b32 v4, 0xff800000
  v_add_u32 v9, 106496, v2
  v_mfma_f32_16x16x32_bf16 v[188:191], v[84:87], v[252:255], v[188:191]
  v_mfma_f32_16x16x32_bf16 v[204:207], v[88:91], v[252:255], v[204:207]
  v_mfma_f32_16x16x32_bf16 v[220:223], v[92:95], v[252:255], v[220:223]
  s_waitcnt vmcnt(8) lgkmcnt(0)
  v_mfma_f32_16x16x32_bf16 v[96:99], v[32:35], v[224:227], v[96:99]
  v_accvgpr_read_b32 v16, a168
  v_accvgpr_read_b32 v17, a169
  v_accvgpr_read_b32 v18, a170
  v_mfma_f32_16x16x32_bf16 v[112:115], v[36:39], v[224:227], v[112:115]
  s_cmp_ge_u32 s20, 2
  s_cselect_b32 s4, s6, s4
  s_cselect_b32 s5, s7, s5
  ds_read_b64_tr_b16 v[64:65], v12 offset:40960
  v_accvgpr_read_b32 v19, a171
  v_accvgpr_read_b32 v20, a172
  v_mfma_f32_16x16x32_bf16 v[128:131], v[40:43], v[224:227], v[128:131]
  s_mov_b32 s62, 2211840
  ds_read_b64_tr_b16 v[66:67], v12 offset:41984
  v_accvgpr_read_b32 v21, a173
  v_accvgpr_read_b32 v22, a174
  v_mfma_f32_16x16x32_bf16 v[144:147], v[44:47], v[224:227], v[144:147]
  s_mov_b32 s63, 0x20000
  v_accvgpr_read_b32 v23, a175
  v_mul_f32 v16, s76, v16
  v_mul_f32 v17, s76, v17
  v_mfma_f32_16x16x32_bf16 v[160:163], v[48:51], v[224:227], v[160:163]
  s_mov_b64 s[56:57], s[52:53]
  ds_read_b64_tr_b16 v[68:69], v13 offset:40960
  v_mul_f32 v18, s76, v18
  v_mfma_f32_16x16x32_bf16 v[176:179], v[52:55], v[224:227], v[176:179]
  s_mov_b32 s58, s54
  ds_read_b64_tr_b16 v[70:71], v13 offset:41984
  v_mul_f32 v19, s76, v19
  v_mul_f32 v20, s76, v20
  v_mfma_f32_16x16x32_bf16 v[192:195], v[56:59], v[224:227], v[192:195]
  s_mov_b64 s[52:53], s[4:5]
  ds_read_b64_tr_b16 v[72:73], v12 offset:41216
  v_mul_f32 v21, s76, v21
  v_mul_f32 v22, s76, v22
  v_mfma_f32_16x16x32_bf16 v[208:211], v[60:63], v[224:227], v[208:211]
  s_mov_b32 s54, 2211840
  ds_read_b64_tr_b16 v[74:75], v12 offset:42240
  v_mul_f32 v23, s76, v23
  v_cvt_pk_bf16_f32 v28, v16, v17
  v_mfma_f32_16x16x32_bf16 v[100:103], v[32:35], v[228:231], v[100:103]
  s_getpc_b64 s[36:37]
fa_copc:
  v_cvt_pk_bf16_f32 v29, v18, v19
  v_cvt_pk_bf16_f32 v30, v20, v21
  v_cvt_pk_bf16_f32 v31, v22, v23
  v_mfma_f32_16x16x32_bf16 v[116:119], v[36:39], v[228:231], v[116:119]
  s_add_u32 s36, s36, fa_co-fa_copc-4
  s_addc_u32 s37, s37, 0
  ds_read_b64_tr_b16 v[76:77], v13 offset:41216
  buffer_store_dwordx4 v[28:31], v2, s[40:43], s64 offen offset:1024 sc1
  v_mfma_f32_16x16x32_bf16 v[132:135], v[40:43], v[228:231], v[132:135]
  s_lshl_b32 s31, s20, 11
  ds_read_b64_tr_b16 v[78:79], v13 offset:42240
  v_accvgpr_read_b32 v16, a176
  v_accvgpr_read_b32 v17, a177
  v_mfma_f32_16x16x32_bf16 v[148:151], v[44:47], v[228:231], v[148:151]
  s_add_u32 s31, s31, 2621440
  ds_read_b128 v[240:243], v14 offset:32768
  v_accvgpr_read_b32 v18, a178
  v_accvgpr_read_b32 v19, a179
  v_mfma_f32_16x16x32_bf16 v[164:167], v[48:51], v[228:231], v[164:167]
  s_cmp_eq_u32 s2, 255
  s_cselect_b32 s31, s31, 1073741824
  ds_read_b128 v[244:247], v14 offset:33792
  v_accvgpr_read_b32 v20, a180
  v_accvgpr_read_b32 v21, a181
  v_mfma_f32_16x16x32_bf16 v[180:183], v[52:55], v[228:231], v[180:183]
  v_accvgpr_read_b32 v22, a182
  v_accvgpr_read_b32 v23, a183
  v_mul_f32 v16, s76, v16
  v_mfma_f32_16x16x32_bf16 v[196:199], v[56:59], v[228:231], v[196:199]
  ds_read_b64_tr_b16 v[80:81], v12 offset:41472
  v_mul_f32 v17, s76, v17
  v_mfma_f32_16x16x32_bf16 v[212:215], v[60:63], v[228:231], v[212:215]
  ds_read_b64_tr_b16 v[82:83], v12 offset:42496
  v_mul_f32 v18, s76, v18
  v_mul_f32 v19, s76, v19
  v_mfma_f32_16x16x32_bf16 v[104:107], v[32:35], v[232:235], v[104:107]
  ds_read_b64_tr_b16 v[84:85], v13 offset:41472
  v_mul_f32 v20, s76, v20
  v_mul_f32 v21, s76, v21
  v_mfma_f32_16x16x32_bf16 v[120:123], v[36:39], v[232:235], v[120:123]
  ds_read_b64_tr_b16 v[86:87], v13 offset:42496
  v_mul_f32 v22, s76, v22
  v_mul_f32 v23, s76, v23
  v_mfma_f32_16x16x32_bf16 v[136:139], v[40:43], v[232:235], v[136:139]
  v_cvt_pk_bf16_f32 v24, v16, v17
  v_cvt_pk_bf16_f32 v25, v18, v19
  v_cvt_pk_bf16_f32 v26, v20, v21
  v_mfma_f32_16x16x32_bf16 v[152:155], v[44:47], v[232:235], v[152:155]
  ds_read_b64_tr_b16 v[88:89], v12 offset:41728
  v_cvt_pk_bf16_f32 v27, v22, v23
  v_mfma_f32_16x16x32_bf16 v[168:171], v[48:51], v[232:235], v[168:171]
  ds_read_b64_tr_b16 v[90:91], v12 offset:42752
  buffer_store_dwordx4 v[24:27], v2, s[40:43], s64 offen offset:2048 sc1
  v_accvgpr_read_b32 v16, a184
  v_mfma_f32_16x16x32_bf16 v[184:187], v[52:55], v[232:235], v[184:187]
  ds_read_b64_tr_b16 v[92:93], v13 offset:41728
  v_accvgpr_read_b32 v17, a185
  v_accvgpr_read_b32 v18, a186
  v_mfma_f32_16x16x32_bf16 v[200:203], v[56:59], v[232:235], v[200:203]
  ds_read_b64_tr_b16 v[94:95], v13 offset:42752
  v_accvgpr_read_b32 v19, a187
  v_accvgpr_read_b32 v20, a188
  v_mfma_f32_16x16x32_bf16 v[216:219], v[60:63], v[232:235], v[216:219]
  v_accvgpr_read_b32 v21, a189
  v_accvgpr_read_b32 v22, a190
  v_accvgpr_read_b32 v23, a191
  v_mfma_f32_16x16x32_bf16 v[108:111], v[32:35], v[236:239], v[108:111]
  ds_read_b128 v[248:251], v14 offset:34816
  v_mul_f32 v16, s76, v16
  v_mfma_f32_16x16x32_bf16 v[124:127], v[36:39], v[236:239], v[124:127]
  ds_read_b128 v[252:255], v14 offset:35840
  v_mul_f32 v17, s76, v17
  v_mul_f32 v18, s76, v18
  v_mfma_f32_16x16x32_bf16 v[140:143], v[40:43], v[236:239], v[140:143]
  v_mul_f32 v19, s76, v19
  v_mul_f32 v20, s76, v20
  v_mul_f32 v21, s76, v21
  v_mfma_f32_16x16x32_bf16 v[156:159], v[44:47], v[236:239], v[156:159]
  v_xor_b32 v14, 0x10000, v14
  v_mul_f32 v22, s76, v22
  v_mul_f32 v23, s76, v23
  v_mfma_f32_16x16x32_bf16 v[172:175], v[48:51], v[236:239], v[172:175]
  v_cvt_pk_bf16_f32 v28, v16, v17
  v_cvt_pk_bf16_f32 v29, v18, v19
  v_cvt_pk_bf16_f32 v30, v20, v21
  v_mfma_f32_16x16x32_bf16 v[188:191], v[52:55], v[236:239], v[188:191]
  v_xor_b32 v12, 0x10000, v12
  v_cvt_pk_bf16_f32 v31, v22, v23
  v_mfma_f32_16x16x32_bf16 v[204:207], v[56:59], v[236:239], v[204:207]
  buffer_store_dwordx4 v[28:31], v2, s[40:43], s64 offen offset:3072 sc1
  v_xor_b32 v13, 0x10000, v13
  v_mfma_f32_16x16x32_bf16 v[220:223], v[60:63], v[236:239], v[220:223]
  s_waitcnt vmcnt(9) lgkmcnt(0)
  v_mfma_f32_16x16x32_bf16 v[96:99], v[64:67], v[240:243], v[96:99]
  s_barrier
  buffer_load_dwordx4 v[232:235], v2, s[40:43], s31 offen sc1
  v_cmp_eq_u32 vcc, 0, v15
  v_mfma_f32_16x16x32_bf16 v[112:115], v[68:71], v[240:243], v[112:115]
  s_cbranch_vccnz fa_kv_spin
fa_kv_ok:
  buffer_load_dwordx4 v[236:239], v2, s[40:43], s31 offen offset:1024 sc1
  v_mfma_f32_16x16x32_bf16 v[128:131], v[72:75], v[240:243], v[128:131]
  s_mov_b32 m0, s24
  v_mov_b32 v228, 0
  v_mfma_f32_16x16x32_bf16 v[144:147], v[76:79], v[240:243], v[144:147]
  buffer_load_dwordx4 v2, s[44:47], s26 offen offset:0 sc1 lds
  v_mfma_f32_16x16x32_bf16 v[160:163], v[80:83], v[240:243], v[160:163]
  s_add_u32 s24, s24, 32768
  v_mov_b32 v229, 0
  v_mfma_f32_16x16x32_bf16 v[176:179], v[84:87], v[240:243], v[176:179]
  s_and_b32 s24, s24, 0x1ffff
  buffer_load_dwordx4 v2, s[44:47], s26 offen offset:1024 sc1 lds
  v_mfma_f32_16x16x32_bf16 v[192:195], v[88:91], v[240:243], v[192:195]
  v_mov_b32 v230, 0
  v_mfma_f32_16x16x32_bf16 v[208:211], v[92:95], v[240:243], v[208:211]
  buffer_load_dwordx4 v2, s[44:47], s26 offen offset:2048 sc1 lds
  v_mfma_f32_16x16x32_bf16 v[100:103], v[64:67], v[244:247], v[100:103]
  v_mov_b32 v231, 0
  v_mfma_f32_16x16x32_bf16 v[116:119], v[68:71], v[244:247], v[116:119]
  buffer_load_dwordx4 v2, s[44:47], s26 offen offset:3072 sc1 lds
  v_mfma_f32_16x16x32_bf16 v[132:135], v[72:75], v[244:247], v[132:135]
  s_add_u32 s26, s26, 16384
  v_cvt_pk_bf16_f32 v32, v96, v97
  v_cvt_pk_bf16_f32 v33, v98, v99
  v_mfma_f32_16x16x32_bf16 v[148:151], v[76:79], v[244:247], v[148:151]
  v_cvt_pk_bf16_f32 v34, v112, v113
  v_cvt_pk_bf16_f32 v35, v114, v115
  v_mfma_f32_16x16x32_bf16 v[164:167], v[80:83], v[244:247], v[164:167]
  s_mov_b32 m0, s24
  v_cvt_pk_bf16_f32 v40, v128, v129
  v_mfma_f32_16x16x32_bf16 v[180:183], v[84:87], v[244:247], v[180:183]
  buffer_load_dwordx4 v2, s[44:47], s26 offen offset:0 sc1 lds
  v_cvt_pk_bf16_f32 v41, v130, v131
  v_cvt_pk_bf16_f32 v42, v144, v145
  v_mfma_f32_16x16x32_bf16 v[196:199], v[88:91], v[244:247], v[196:199]
  s_add_u32 s24, s24, 32768
  v_cvt_pk_bf16_f32 v43, v146, v147
  v_mfma_f32_16x16x32_bf16 v[212:215], v[92:95], v[244:247], v[212:215]
  s_and_b32 s24, s24, 0x1ffff
  buffer_load_dwordx4 v2, s[44:47], s26 offen offset:1024 sc1 lds
  v_cvt_pk_bf16_f32 v48, v160, v161
  v_cvt_pk_bf16_f32 v49, v162, v163
  v_mfma_f32_16x16x32_bf16 v[104:107], v[64:67], v[248:251], v[104:107]
  v_cvt_pk_bf16_f32 v50, v176, v177
  v_cvt_pk_bf16_f32 v51, v178, v179
  v_mfma_f32_16x16x32_bf16 v[120:123], v[68:71], v[248:251], v[120:123]
  buffer_load_dwordx4 v2, s[44:47], s26 offen offset:2048 sc1 lds
  v_cvt_pk_bf16_f32 v56, v192, v193
  v_mfma_f32_16x16x32_bf16 v[136:139], v[72:75], v[248:251], v[136:139]
  v_cvt_pk_bf16_f32 v57, v194, v195
  v_cvt_pk_bf16_f32 v58, v208, v209
  v_mfma_f32_16x16x32_bf16 v[152:155], v[76:79], v[248:251], v[152:155]
  buffer_load_dwordx4 v2, s[44:47], s26 offen offset:3072 sc1 lds
  v_cvt_pk_bf16_f32 v59, v210, v211
  v_mfma_f32_16x16x32_bf16 v[168:171], v[80:83], v[248:251], v[168:171]
  s_add_u32 s26, s26, 16384
  v_cvt_pk_bf16_f32 v36, v100, v101
  v_cvt_pk_bf16_f32 v37, v102, v103
  v_mfma_f32_16x16x32_bf16 v[184:187], v[84:87], v[248:251], v[184:187]
  v_cvt_pk_bf16_f32 v38, v116, v117
  v_mfma_f32_16x16x32_bf16 v[200:203], v[88:91], v[248:251], v[200:203]
  s_mov_b32 m0, s24
  v_cvt_pk_bf16_f32 v39, v118, v119
  v_cvt_pk_bf16_f32 v44, v132, v133
  v_mfma_f32_16x16x32_bf16 v[216:219], v[92:95], v[248:251], v[216:219]
  buffer_load_dwordx4 v2, s[44:47], s26 offen offset:0 sc1 lds
  v_cvt_pk_bf16_f32 v45, v134, v135
  v_mfma_f32_16x16x32_bf16 v[108:111], v[64:67], v[252:255], v[108:111]
  s_add_u32 s24, s24, 32768
  v_cvt_pk_bf16_f32 v46, v148, v149
  v_cvt_pk_bf16_f32 v47, v150, v151
  v_mfma_f32_16x16x32_bf16 v[124:127], v[68:71], v[252:255], v[124:127]
  s_and_b32 s24, s24, 0x1ffff
  buffer_load_dwordx4 v2, s[44:47], s26 offen offset:1024 sc1 lds
  v_cvt_pk_bf16_f32 v52, v164, v165
  v_mfma_f32_16x16x32_bf16 v[140:143], v[72:75], v[252:255], v[140:143]
  v_cvt_pk_bf16_f32 v53, v166, v167
  v_cvt_pk_bf16_f32 v54, v180, v181
  v_mfma_f32_16x16x32_bf16 v[156:159], v[76:79], v[252:255], v[156:159]
  buffer_load_dwordx4 v2, s[44:47], s26 offen offset:2048 sc1 lds
  v_cvt_pk_bf16_f32 v55, v182, v183
  v_mfma_f32_16x16x32_bf16 v[172:175], v[80:83], v[252:255], v[172:175]
  v_cvt_pk_bf16_f32 v60, v196, v197
  v_cvt_pk_bf16_f32 v61, v198, v199
  v_mfma_f32_16x16x32_bf16 v[188:191], v[84:87], v[252:255], v[188:191]
  buffer_load_dwordx4 v2, s[44:47], s26 offen offset:3072 sc1 lds
  v_cvt_pk_bf16_f32 v62, v212, v213
  v_mfma_f32_16x16x32_bf16 v[204:207], v[88:91], v[252:255], v[204:207]
  s_add_u32 s26, s26, 16384
  v_cvt_pk_bf16_f32 v63, v214, v215
  v_mfma_f32_16x16x32_bf16 v[220:223], v[92:95], v[252:255], v[220:223]
  s_mov_b32 m0, s25
  s_nop 0
  v_mfma_f32_32x32x16_bf16 a[0:15], v[228:231], v[228:231], 0
  buffer_load_dwordx4 v2, s[48:51], s27 offen offset:0 sc1 lds
  v_cvt_pk_bf16_f32 v64, v104, v105
  v_cvt_pk_bf16_f32 v65, v106, v107
  v_cvt_pk_bf16_f32 v66, v120, v121
  v_cvt_pk_bf16_f32 v67, v122, v123
  v_mfma_f32_32x32x16_bf16 a[16:31], v[228:231], v[228:231], 0
  buffer_load_dwordx4 v2, s[48:51], s27 offen offset:1024 sc1 lds
  v_cvt_pk_bf16_f32 v72, v136, v137
  v_cvt_pk_bf16_f32 v73, v138, v139
  v_cvt_pk_bf16_f32 v74, v152, v153
  v_cvt_pk_bf16_f32 v75, v154, v155
  v_mfma_f32_32x32x16_bf16 a[32:47], v[228:231], v[228:231], 0
  buffer_load_dwordx4 v2, s[48:51], s27 offen offset:2048 sc1 lds
  v_cvt_pk_bf16_f32 v80, v168, v169
  v_cvt_pk_bf16_f32 v81, v170, v171
  v_cvt_pk_bf16_f32 v82, v184, v185
  v_cvt_pk_bf16_f32 v83, v186, v187
  v_mfma_f32_32x32x16_bf16 a[48:63], v[228:231], v[228:231], 0
  buffer_load_dwordx4 v2, s[48:51], s27 offen offset:3072 sc1 lds
  v_cvt_pk_bf16_f32 v88, v200, v201
  v_cvt_pk_bf16_f32 v89, v202, v203
  v_cvt_pk_bf16_f32 v90, v216, v217
  v_cvt_pk_bf16_f32 v91, v218, v219
  s_add_u32 s27, s27, 16384
  s_add_u32 s25, s25, 32768
  s_and_b32 s25, s25, 0x1ffff
  s_mov_b32 m0, s25
  s_nop 0
  v_mfma_f32_32x32x16_bf16 a[64:79], v[228:231], v[228:231], 0
  buffer_load_dwordx4 v2, s[48:51], s27 offen offset:0 sc1 lds
  v_cvt_pk_bf16_f32 v68, v108, v109
  v_cvt_pk_bf16_f32 v69, v110, v111
  v_cvt_pk_bf16_f32 v70, v124, v125
  v_cvt_pk_bf16_f32 v71, v126, v127
  v_mfma_f32_32x32x16_bf16 a[80:95], v[228:231], v[228:231], 0
  buffer_load_dwordx4 v2, s[48:51], s27 offen offset:1024 sc1 lds
  v_cvt_pk_bf16_f32 v76, v140, v141
  v_cvt_pk_bf16_f32 v77, v142, v143
  v_cvt_pk_bf16_f32 v78, v156, v157
  v_cvt_pk_bf16_f32 v79, v158, v159
  v_mfma_f32_32x32x16_bf16 a[96:111], v[228:231], v[228:231], 0
  buffer_load_dwordx4 v2, s[48:51], s27 offen offset:2048 sc1 lds
  v_cvt_pk_bf16_f32 v84, v172, v173
  v_cvt_pk_bf16_f32 v85, v174, v175
  v_cvt_pk_bf16_f32 v86, v188, v189
  v_cvt_pk_bf16_f32 v87, v190, v191
  v_mfma_f32_32x32x16_bf16 a[112:127], v[228:231], v[228:231], 0
  buffer_load_dwordx4 v2, s[48:51], s27 offen offset:3072 sc1 lds
  v_cvt_pk_bf16_f32 v92, v204, v205
  v_cvt_pk_bf16_f32 v93, v206, v207
  v_cvt_pk_bf16_f32 v94, v220, v221
  v_cvt_pk_bf16_f32 v95, v222, v223
  s_add_u32 s27, s27, 16384
  s_add_u32 s25, s25, 32768
  s_and_b32 s25, s25, 0x1ffff
  s_waitcnt vmcnt(12)
  s_barrier
  ds_read_b128 a[128:131], v9 offset:0
  ds_read_b128 a[132:135], v9 offset:1024
  ds_read_b128 a[136:139], v9 offset:2048
  ds_read_b128 a[140:143], v9 offset:3072
  ds_read_b128 a[144:147], v9 offset:4096
  ds_read_b128 a[148:151], v9 offset:5120
  ds_read_b128 a[152:155], v9 offset:6144
  ds_read_b128 a[156:159], v9 offset:7168
  buffer_store_dword v4, off, s[40:43], s65 offset:32 sc1
  v_add_u32 v13, 32, v8
  v_mov_b32 v14, 0
  s_cmp_eq_u32 s2, 255
  s_cbranch_scc1 fa_top8
fa_notop:
  s_waitcnt lgkmcnt(4)
  v_mfma_f32_16x16x32_bf16 v[96:99], a[128:131], v[32:35], 0
  v_mfma_f32_16x16x32_bf16 v[104:107], a[128:131], v[36:39], 0
  v_mfma_f32_16x16x32_bf16 v[128:131], a[128:131], v[64:67], 0
  v_mfma_f32_16x16x32_bf16 v[136:139], a[128:131], v[68:71], 0
  s_mov_b32 m0, s24
  ds_read_b128 a[128:131], v3 offset:0
  v_mfma_f32_16x16x32_bf16 v[100:103], a[132:135], v[32:35], 0
  buffer_load_dwordx4 v2, s[44:47], s26 offen offset:0 sc1 lds
  v_mfma_f32_16x16x32_bf16 v[108:111], a[132:135], v[36:39], 0
  v_mfma_f32_16x16x32_bf16 v[132:135], a[132:135], v[64:67], 0
  v_mfma_f32_16x16x32_bf16 v[140:143], a[132:135], v[68:71], 0
  ds_read_b128 a[132:135], v3 offset:1024
  v_mfma_f32_16x16x32_bf16 v[96:99], a[136:139], v[40:43], v[96:99]
  v_mfma_f32_16x16x32_bf16 v[104:107], a[136:139], v[44:47], v[104:107]
  v_mfma_f32_16x16x32_bf16 v[128:131], a[136:139], v[72:75], v[128:131]
  buffer_load_dwordx4 v2, s[44:47], s26 offen offset:1024 sc1 lds
  v_mfma_f32_16x16x32_bf16 v[136:139], a[136:139], v[76:79], v[136:139]
  ds_read_b128 a[136:139], v3 offset:2048
  v_mfma_f32_16x16x32_bf16 v[100:103], a[140:143], v[40:43], v[100:103]
  v_mfma_f32_16x16x32_bf16 v[108:111], a[140:143], v[44:47], v[108:111]
  v_mfma_f32_16x16x32_bf16 v[132:135], a[140:143], v[72:75], v[132:135]
  v_mfma_f32_16x16x32_bf16 v[140:143], a[140:143], v[76:79], v[140:143]
  s_waitcnt lgkmcnt(3)
  ds_read_b128 a[140:143], v3 offset:3072
  v_mfma_f32_16x16x32_bf16 v[96:99], a[144:147], v[48:51], v[96:99]
  v_mfma_f32_16x16x32_bf16 v[104:107], a[144:147], v[52:55], v[104:107]
  v_mfma_f32_16x16x32_bf16 v[128:131], a[144:147], v[80:83], v[128:131]
  buffer_load_dwordx4 v2, s[44:47], s26 offen offset:2048 sc1 lds
  v_mfma_f32_16x16x32_bf16 v[136:139], a[144:147], v[84:87], v[136:139]
  ds_read_b128 a[144:147], v3 offset:4096
  v_mfma_f32_16x16x32_bf16 v[100:103], a[148:151], v[48:51], v[100:103]
  v_mfma_f32_16x16x32_bf16 v[108:111], a[148:151], v[52:55], v[108:111]
  v_mfma_f32_16x16x32_bf16 v[132:135], a[148:151], v[80:83], v[132:135]
  v_mfma_f32_16x16x32_bf16 v[140:143], a[148:151], v[84:87], v[140:143]
  ds_read_b128 a[148:151], v3 offset:5120
  v_mfma_f32_16x16x32_bf16 v[96:99], a[152:155], v[56:59], v[96:99]
  buffer_load_dwordx4 v2, s[44:47], s26 offen offset:3072 sc1 lds
  v_mfma_f32_16x16x32_bf16 v[104:107], a[152:155], v[60:63], v[104:107]
  s_add_u32 s26, s26, 16384
  v_mfma_f32_16x16x32_bf16 v[128:131], a[152:155], v[88:91], v[128:131]
  s_add_u32 s24, s24, 32768
  v_mfma_f32_16x16x32_bf16 v[136:139], a[152:155], v[92:95], v[136:139]
  s_and_b32 s24, s24, 0x1ffff
  ds_read_b128 a[152:155], v3 offset:6144
  v_mfma_f32_16x16x32_bf16 v[100:103], a[156:159], v[56:59], v[100:103]
  v_mfma_f32_16x16x32_bf16 v[108:111], a[156:159], v[60:63], v[108:111]
  v_mfma_f32_16x16x32_bf16 v[132:135], a[156:159], v[88:91], v[132:135]
  v_mfma_f32_16x16x32_bf16 v[140:143], a[156:159], v[92:95], v[140:143]
  s_waitcnt lgkmcnt(3)
  ds_read_b128 a[156:159], v3 offset:7168
  s_nop 7
  s_cmp_lg_u32 s28, 0
  s_cbranch_scc1 fa_nomask0
  v_cndmask_b32 v96, v4, v96, s[68:69]
  v_cndmask_b32 v97, v4, v97, s[70:71]
  v_cndmask_b32 v98, v4, v98, s[72:73]
  v_cndmask_b32 v99, v4, v99, s[74:75]
  v_mov_b32 v100, v4
  v_mov_b32 v101, v4
  v_mov_b32 v102, v4
  v_mov_b32 v103, v4
  v_cndmask_b32 v108, v4, v108, s[68:69]
  v_cndmask_b32 v109, v4, v109, s[70:71]
  v_cndmask_b32 v110, v4, v110, s[72:73]
  v_cndmask_b32 v111, v4, v111, s[74:75]
fa_nomask0:
  v_max3_f32 v16, v96, v97, v98
  v_max3_f32 v16, v16, v99, v100
  v_max3_f32 v16, v16, v101, v102
  v_max_f32 v16, v16, v103
  v_max3_f32 v17, v104, v105, v106
  v_max3_f32 v17, v17, v107, v108
  v_max3_f32 v17, v17, v109, v110
  v_max_f32 v17, v17, v111
  v_max3_f32 v18, v128, v129, v130
  v_max3_f32 v18, v18, v131, v132
  v_max3_f32 v18, v18, v133, v134
  v_max_f32 v18, v18, v135
  v_max3_f32 v19, v136, v137, v138
  v_max3_f32 v19, v19, v139, v140
  v_max3_f32 v19, v19, v141, v142
  v_max_f32 v19, v19, v143
  v_mov_b32 v20, v16
  v_mov_b32 v21, v17
  v_mov_b32 v22, v18
  v_mov_b32 v23, v19
  s_nop 0
  v_permlane16_swap_b32 v16, v20
  v_permlane16_swap_b32 v17, v21
  v_permlane16_swap_b32 v18, v22
  v_permlane16_swap_b32 v19, v23
  v_max_f32 v16, v16, v20
  v_max_f32 v17, v17, v21
  v_max_f32 v18, v18, v22
  v_max_f32 v19, v19, v23
  v_mov_b32 v20, v16
  v_mov_b32 v21, v17
  v_mov_b32 v22, v18
  v_mov_b32 v23, v19
  s_nop 0
  v_permlane32_swap_b32 v16, v20
  v_permlane32_swap_b32 v17, v21
  v_permlane32_swap_b32 v18, v22
  v_permlane32_swap_b32 v19, v23
  v_max_f32 v16, v16, v20
  v_max_f32 v17, v17, v21
  v_max_f32 v18, v18, v22
  v_max_f32 v19, v19, v23
  v_sub_f32 v192, 0, v16
  v_sub_f32 v193, 0, v16
  v_sub_f32 v194, 0, v16
  v_sub_f32 v195, 0, v16
  v_sub_f32 v196, 0, v17
  v_sub_f32 v197, 0, v17
  v_sub_f32 v198, 0, v17
  v_sub_f32 v199, 0, v17
  v_sub_f32 v200, 0, v18
  v_sub_f32 v201, 0, v18
  v_sub_f32 v202, 0, v18
  v_sub_f32 v203, 0, v18
  v_sub_f32 v204, 0, v19
  v_sub_f32 v205, 0, v19
  v_sub_f32 v206, 0, v19
  v_sub_f32 v207, 0, v19
  v_sub_f32 v96, v96, v16
  v_sub_f32 v97, v97, v16
  v_sub_f32 v98, v98, v16
  v_sub_f32 v99, v99, v16
  v_sub_f32 v100, v100, v16
  v_sub_f32 v101, v101, v16
  v_sub_f32 v102, v102, v16
  v_sub_f32 v103, v103, v16
  v_sub_f32 v104, v104, v17
  v_sub_f32 v105, v105, v17
  v_sub_f32 v106, v106, v17
  v_sub_f32 v107, v107, v17
  v_sub_f32 v108, v108, v17
  v_sub_f32 v109, v109, v17
  v_sub_f32 v110, v110, v17
  v_sub_f32 v111, v111, v17
  v_sub_f32 v128, v128, v18
  v_sub_f32 v129, v129, v18
  v_sub_f32 v130, v130, v18
  v_sub_f32 v131, v131, v18
  v_sub_f32 v132, v132, v18
  v_sub_f32 v133, v133, v18
  v_sub_f32 v134, v134, v18
  v_sub_f32 v135, v135, v18
  v_sub_f32 v136, v136, v19
  v_sub_f32 v137, v137, v19
  v_sub_f32 v138, v138, v19
  v_sub_f32 v139, v139, v19
  v_sub_f32 v140, v140, v19
  v_sub_f32 v141, v141, v19
  v_sub_f32 v142, v142, v19
  v_sub_f32 v143, v143, v19
  v_mfma_f32_16x16x32_bf16 v[112:115], a[128:131], v[32:35], v[192:195]
  v_exp_f32 v216, v128
  v_exp_f32 v217, v129
  v_mfma_f32_16x16x32_bf16 v[120:123], a[128:131], v[36:39], v[196:199]
  v_exp_f32 v218, v130
  v_add_f32 v226, v216, v217
  v_cvt_pk_bf16_f32 v176, v216, v217
  v_mfma_f32_16x16x32_bf16 v[144:147], a[128:131], v[64:67], v[200:203]
  s_add_u32 s66, s66, 32768
  v_exp_f32 v219, v131
  v_add_f32 v226, v226, v218
  v_add_f32 v226, v226, v219
  v_mfma_f32_16x16x32_bf16 v[152:155], a[128:131], v[68:71], v[204:207]
  s_mov_b32 m0, s25
  ds_read_b128 a[128:131], v3 offset:8192
  v_exp_f32 v220, v132
  v_cvt_pk_bf16_f32 v177, v218, v219
  v_mfma_f32_16x16x32_bf16 v[116:119], a[132:135], v[32:35], v[192:195]
  s_and_b32 s66, s66, 0x1ffff
  buffer_load_dwordx4 v2, s[48:51], s27 offen offset:0 sc1 lds
  v_exp_f32 v221, v133
  v_add_f32 v226, v226, v220
  v_add_f32 v226, v226, v221
  v_mfma_f32_16x16x32_bf16 v[124:127], a[132:135], v[36:39], v[196:199]
  v_exp_f32 v222, v134
  v_cvt_pk_bf16_f32 v178, v220, v221
  v_exp_f32 v223, v135
  v_mfma_f32_16x16x32_bf16 v[148:151], a[132:135], v[64:67], v[200:203]
  v_exp_f32 v216, v136
  v_add_f32 v226, v226, v222
  v_mfma_f32_16x16x32_bf16 v[156:159], a[132:135], v[68:71], v[204:207]
  ds_read_b128 a[132:135], v3 offset:9216
  v_exp_f32 v217, v137
  v_add_f32 v226, v226, v223
  v_mfma_f32_16x16x32_bf16 v[112:115], a[136:139], v[40:43], v[112:115]
  v_exp_f32 v218, v138
  v_cvt_pk_bf16_f32 v179, v222, v223
  v_add_f32 v227, v216, v217
  v_mfma_f32_16x16x32_bf16 v[120:123], a[136:139], v[44:47], v[120:123]
  v_exp_f32 v219, v139
  v_cvt_pk_bf16_f32 v180, v216, v217
  v_add_f32 v227, v227, v218
  v_add_f32 v227, v227, v219
  v_mfma_f32_16x16x32_bf16 v[144:147], a[136:139], v[72:75], v[144:147]
  buffer_load_dwordx4 v2, s[48:51], s27 offen offset:1024 sc1 lds
  v_exp_f32 v220, v140
  v_cvt_pk_bf16_f32 v181, v218, v219
  v_mfma_f32_16x16x32_bf16 v[152:155], a[136:139], v[76:79], v[152:155]
  ds_read_b128 a[136:139], v3 offset:10240
  v_exp_f32 v221, v141
  v_add_f32 v227, v227, v220
  v_mfma_f32_16x16x32_bf16 v[116:119], a[140:143], v[40:43], v[116:119]
  v_exp_f32 v222, v142
  v_add_f32 v227, v227, v221
  v_cvt_pk_bf16_f32 v182, v220, v221
  v_mfma_f32_16x16x32_bf16 v[124:127], a[140:143], v[44:47], v[124:127]
  v_exp_f32 v223, v143
  v_add_f32 v227, v227, v222
  v_add_f32 v227, v227, v223
  v_exp_f32 v208, v96
  v_mfma_f32_16x16x32_bf16 v[148:151], a[140:143], v[72:75], v[148:151]
  v_exp_f32 v209, v97
  v_cvt_pk_bf16_f32 v183, v222, v223
  v_mfma_f32_16x16x32_bf16 v[156:159], a[140:143], v[76:79], v[156:159]
  s_waitcnt lgkmcnt(3)
  ds_read_b128 a[140:143], v3 offset:11264
  v_exp_f32 v210, v98
  v_add_f32 v224, v208, v209
  v_mfma_f32_16x16x32_bf16 v[112:115], a[144:147], v[48:51], v[112:115]
  v_exp_f32 v211, v99
  v_cvt_pk_bf16_f32 v160, v208, v209
  v_add_f32 v224, v224, v210
  v_mfma_f32_16x16x32_bf16 v[120:123], a[144:147], v[52:55], v[120:123]
  v_exp_f32 v212, v100
  v_add_f32 v224, v224, v211
  v_cvt_pk_bf16_f32 v161, v210, v211
  v_mfma_f32_16x16x32_bf16 v[144:147], a[144:147], v[80:83], v[144:147]
  buffer_load_dwordx4 v2, s[48:51], s27 offen offset:2048 sc1 lds
  v_exp_f32 v213, v101
  v_add_f32 v224, v224, v212
  v_add_f32 v224, v224, v213
  v_mfma_f32_16x16x32_bf16 v[152:155], a[144:147], v[84:87], v[152:155]
  ds_read_b128 a[144:147], v3 offset:12288
  v_exp_f32 v214, v102
  v_cvt_pk_bf16_f32 v162, v212, v213
  v_mfma_f32_16x16x32_bf16 v[116:119], a[148:151], v[48:51], v[116:119]
  v_exp_f32 v215, v103
  v_add_f32 v224, v224, v214
  v_add_f32 v224, v224, v215
  v_mfma_f32_16x16x32_bf16 v[124:127], a[148:151], v[52:55], v[124:127]
  v_exp_f32 v208, v104
  v_exp_f32 v209, v105
  v_mfma_f32_16x16x32_bf16 v[148:151], a[148:151], v[80:83], v[148:151]
  v_exp_f32 v210, v106
  v_cvt_pk_bf16_f32 v163, v214, v215
  v_add_f32 v225, v208, v209
  v_mfma_f32_16x16x32_bf16 v[156:159], a[148:151], v[84:87], v[156:159]
  ds_read_b128 a[148:151], v3 offset:13312
  v_exp_f32 v211, v107
  v_cvt_pk_bf16_f32 v164, v208, v209
  v_add_f32 v225, v225, v210
  v_mfma_f32_16x16x32_bf16 v[112:115], a[152:155], v[56:59], v[112:115]
  buffer_load_dwordx4 v2, s[48:51], s27 offen offset:3072 sc1 lds
  v_exp_f32 v212, v108
  v_add_f32 v225, v225, v211
  v_mfma_f32_16x16x32_bf16 v[120:123], a[152:155], v[60:63], v[120:123]
  s_add_u32 s27, s27, 16384
  v_exp_f32 v213, v109
  v_mfma_f32_16x16x32_bf16 v[144:147], a[152:155], v[88:91], v[144:147]
  s_add_u32 s25, s25, 32768
  v_exp_f32 v214, v110
  v_mfma_f32_16x16x32_bf16 v[152:155], a[152:155], v[92:95], v[152:155]
  s_and_b32 s25, s25, 0x1ffff
  ds_read_b128 a[152:155], v3 offset:14336
  v_cvt_pk_bf16_f32 v165, v210, v211
  v_max3_f32 v5, v226, v227, v224
  v_add_f32 v225, v225, v212
  v_add_f32 v225, v225, v213
  v_cvt_pk_bf16_f32 v166, v212, v213
  v_exp_f32 v215, v111
  v_mfma_f32_16x16x32_bf16 v[116:119], a[156:159], v[56:59], v[116:119]
  v_add_f32 v225, v225, v214
  v_add_f32 v225, v225, v215
  v_max_f32 v5, v5, v225
  v_cmp_lt_f32 vcc, s81, v5
  v_mfma_f32_16x16x32_bf16 v[124:127], a[156:159], v[60:63], v[124:127]
  v_mfma_f32_16x16x32_bf16 v[148:151], a[156:159], v[88:91], v[148:151]
  v_cvt_pk_bf16_f32 v167, v214, v215
  v_mfma_f32_16x16x32_bf16 v[156:159], a[156:159], v[92:95], v[156:159]
  s_waitcnt lgkmcnt(3)
  s_cbranch_vccnz fa_stub0
fa_back0:
  ds_read_b128 a[156:159], v3 offset:15360
  v_add_f32 v228, v228, v224
  v_add_f32 v229, v229, v225
  v_add_f32 v230, v230, v226
  v_add_f32 v231, v231, v227
  s_nop 3
  v_exp_f32 v216, v144
  v_exp_f32 v217, v145
  v_add_u32 v3, s66, v2
  buffer_load_dword v14, v13, s[40:43], 0 offen sc1
  s_cmp_eq_u32 s28, 0
  s_cbranch_scc1 fa_AV
  s_sub_u32 s28, s28, 1
  s_cmp_eq_u32 s28, 0
  s_cbranch_scc1 fa_Aexit
.p2align 6
fa_DD:
  v_mfma_f32_16x16x32_bf16 v[96:99], a[128:131], v[32:35], v[192:195]
  s_waitcnt vmcnt(12)
  v_exp_f32 v218, v146
  v_mfma_f32_16x16x32_bf16 v[104:107], a[128:131], v[36:39], v[196:199]
  s_barrier
  v_exp_f32 v219, v147
  v_mfma_f32_16x16x32_bf16 v[128:131], a[128:131], v[64:67], v[200:203]
  s_cmp_ge_u32 s26, s32
  ds_read_b128 a[160:163], v3 offset:16384
  v_add_f32 v226, v216, v217
  v_mfma_f32_16x16x32_bf16 v[136:139], a[128:131], v[68:71], v[204:207]
  s_cbranch_scc1 fa_hk4
fa_hb4:
  v_exp_f32 v220, v148
  v_mfma_f32_16x16x32_bf16 v[100:103], a[132:135], v[32:35], v[192:195]
  ds_read_b128 a[164:167], v3 offset:17408
  v_cvt_pk_bf16_f32 v184, v216, v217
  v_mfma_f32_16x16x32_bf16 v[108:111], a[132:135], v[36:39], v[196:199]
  s_mov_b32 m0, s24
  v_exp_f32 v221, v149
  v_mfma_f32_16x16x32_bf16 v[132:135], a[132:135], v[64:67], v[200:203]
  buffer_load_dwordx4 v2, s[44:47], s26 offen offset:0 sc1 lds
  v_add_f32 v226, v226, v218
  v_mfma_f32_16x16x32_bf16 v[140:143], a[132:135], v[68:71], v[204:207]
  v_exp_f32 v222, v150
  v_mfma_f32_16x16x32_bf16 v[96:99], a[136:139], v[40:43], v[96:99]
  ds_read_b128 a[168:171], v3 offset:18432
  v_add_f32 v226, v226, v219
  v_mfma_f32_16x16x32_bf16 v[104:107], a[136:139], v[44:47], v[104:107]
  v_exp_f32 v223, v151
  v_mfma_f32_16x16x32_bf16 v[128:131], a[136:139], v[72:75], v[128:131]
  v_cvt_pk_bf16_f32 v185, v218, v219
  v_add_f32 v226, v226, v220
  v_mfma_f32_16x16x32_bf16 v[136:139], a[136:139], v[76:79], v[136:139]
  v_exp_f32 v216, v152
  v_mfma_f32_16x16x32_bf16 v[100:103], a[140:143], v[40:43], v[100:103]
  ds_read_b128 a[172:175], v3 offset:19456
  v_add_f32 v226, v226, v221
  v_mfma_f32_16x16x32_bf16 v[108:111], a[140:143], v[44:47], v[108:111]
  v_exp_f32 v217, v153
  v_mfma_f32_16x16x32_bf16 v[132:135], a[140:143], v[72:75], v[132:135]
  v_cvt_pk_bf16_f32 v186, v220, v221
  v_add_f32 v226, v226, v222
  v_mfma_f32_16x16x32_bf16 v[140:143], a[140:143], v[76:79], v[140:143]
  s_waitcnt lgkmcnt(4)
  v_exp_f32 v218, v154
  v_mfma_f32_16x16x32_bf16 v[96:99], a[144:147], v[48:51], v[96:99]
  ds_read_b128 a[176:179], v3 offset:20480
  v_add_f32 v226, v226, v223
  v_mfma_f32_16x16x32_bf16 v[104:107], a[144:147], v[52:55], v[104:107]
  v_exp_f32 v219, v155
  v_mfma_f32_16x16x32_bf16 v[128:131], a[144:147], v[80:83], v[128:131]
  v_cvt_pk_bf16_f32 v187, v222, v223
  v_add_f32 v227, v216, v217
  v_mfma_f32_16x16x32_bf16 v[136:139], a[144:147], v[84:87], v[136:139]
  v_exp_f32 v220, v156
  v_mfma_f32_16x16x32_bf16 v[100:103], a[148:151], v[48:51], v[100:103]
  ds_read_b128 a[180:183], v3 offset:21504
  v_cvt_pk_bf16_f32 v188, v216, v217
  v_mfma_f32_16x16x32_bf16 v[108:111], a[148:151], v[52:55], v[108:111]
  v_exp_f32 v221, v157
  v_mfma_f32_16x16x32_bf16 v[132:135], a[148:151], v[80:83], v[132:135]
  buffer_load_dwordx4 v2, s[44:47], s26 offen offset:1024 sc1 lds
  v_add_f32 v227, v227, v218
  v_mfma_f32_16x16x32_bf16 v[140:143], a[148:151], v[84:87], v[140:143]
  v_exp_f32 v222, v158
  v_mfma_f32_16x16x32_bf16 v[96:99], a[152:155], v[56:59], v[96:99]
  ds_read_b128 a[184:187], v3 offset:22528
  v_add_f32 v227, v227, v219
  v_mfma_f32_16x16x32_bf16 v[104:107], a[152:155], v[60:63], v[104:107]
  v_exp_f32 v223, v159
  v_mfma_f32_16x16x32_bf16 v[128:131], a[152:155], v[88:91], v[128:131]
  v_cvt_pk_bf16_f32 v189, v218, v219
  v_add_f32 v227, v227, v220
  v_mfma_f32_16x16x32_bf16 v[136:139], a[152:155], v[92:95], v[136:139]
  v_exp_f32 v208, v112
  v_mfma_f32_16x16x32_bf16 v[100:103], a[156:159], v[56:59], v[100:103]
  ds_read_b128 a[188:191], v3 offset:23552
  v_add_f32 v227, v227, v221
  v_mfma_f32_16x16x32_bf16 v[108:111], a[156:159], v[60:63], v[108:111]
  v_exp_f32 v209, v113
  v_mfma_f32_16x16x32_bf16 v[132:135], a[156:159], v[88:91], v[132:135]
  v_cvt_pk_bf16_f32 v190, v220, v221
  v_add_f32 v227, v227, v222
  v_add_f32 v227, v227, v223
  v_mfma_f32_16x16x32_bf16 v[140:143], a[156:159], v[92:95], v[140:143]
  s_waitcnt lgkmcnt(4)
  v_exp_f32 v210, v114
  v_mfma_f32_16x16x32_bf16 a[0:3], a[160:163], v[160:163], a[0:3]
  ds_read_b128 a[128:131], v3 offset:0
  v_cvt_pk_bf16_f32 v191, v222, v223
  v_mfma_f32_16x16x32_bf16 a[4:7], a[160:163], v[164:167], a[4:7]
  v_exp_f32 v211, v115
  v_mfma_f32_16x16x32_bf16 a[64:67], a[160:163], v[176:179], a[64:67]
  v_exp_f32 v212, v116
  v_mfma_f32_16x16x32_bf16 a[68:71], a[160:163], v[180:183], a[68:71]
  v_add_f32 v224, v208, v209
  v_cvt_pk_bf16_f32 v168, v208, v209
  v_mfma_f32_16x16x32_bf16 a[8:11], a[164:167], v[160:163], a[8:11]
  ds_read_b128 a[132:135], v3 offset:1024
  v_add_f32 v224, v224, v210
  v_mfma_f32_16x16x32_bf16 a[12:15], a[164:167], v[164:167], a[12:15]
  v_exp_f32 v213, v117
  v_mfma_f32_16x16x32_bf16 a[72:75], a[164:167], v[176:179], a[72:75]
  buffer_load_dwordx4 v2, s[44:47], s26 offen offset:2048 sc1 lds
  v_add_f32 v224, v224, v211
  v_mfma_f32_16x16x32_bf16 a[76:79], a[164:167], v[180:183], a[76:79]
  v_exp_f32 v214, v118
  v_mfma_f32_16x16x32_bf16 a[16:19], a[168:171], v[160:163], a[16:19]
  ds_read_b128 a[136:139], v3 offset:2048
  v_cvt_pk_bf16_f32 v169, v210, v211
  v_mfma_f32_16x16x32_bf16 a[20:23], a[168:171], v[164:167], a[20:23]
  v_exp_f32 v215, v119
  v_mfma_f32_16x16x32_bf16 a[80:83], a[168:171], v[176:179], a[80:83]
  v_add_f32 v224, v224, v212
  v_add_f32 v224, v224, v213
  v_mfma_f32_16x16x32_bf16 a[84:87], a[168:171], v[180:183], a[84:87]
  v_exp_f32 v208, v120
  v_mfma_f32_16x16x32_bf16 a[24:27], a[172:175], v[160:163], a[24:27]
  ds_read_b128 a[140:143], v3 offset:3072
  v_cvt_pk_bf16_f32 v170, v212, v213
  v_mfma_f32_16x16x32_bf16 a[28:31], a[172:175], v[164:167], a[28:31]
  v_exp_f32 v209, v121
  v_mfma_f32_16x16x32_bf16 a[88:91], a[172:175], v[176:179], a[88:91]
  v_exp_f32 v210, v122
  v_mfma_f32_16x16x32_bf16 a[92:95], a[172:175], v[180:183], a[92:95]
  s_waitcnt lgkmcnt(4)
  v_add_f32 v224, v224, v214
  v_add_f32 v224, v224, v215
  v_mfma_f32_16x16x32_bf16 a[32:35], a[176:179], v[160:163], a[32:35]
  ds_read_b128 a[144:147], v3 offset:4096
  v_cvt_pk_bf16_f32 v171, v214, v215
  v_mfma_f32_16x16x32_bf16 a[36:39], a[176:179], v[164:167], a[36:39]
  v_exp_f32 v211, v123
  v_mfma_f32_16x16x32_bf16 a[96:99], a[176:179], v[176:179], a[96:99]
  v_add_f32 v225, v208, v209
  v_cvt_pk_bf16_f32 v172, v208, v209
  v_mfma_f32_16x16x32_bf16 a[100:103], a[176:179], v[180:183], a[100:103]
  v_exp_f32 v212, v124
  v_mfma_f32_16x16x32_bf16 a[40:43], a[180:183], v[160:163], a[40:43]
  ds_read_b128 a[148:151], v3 offset:5120
  v_add_f32 v225, v225, v210
  v_mfma_f32_16x16x32_bf16 a[44:47], a[180:183], v[164:167], a[44:47]
  v_exp_f32 v213, v125
  v_mfma_f32_16x16x32_bf16 a[104:107], a[180:183], v[176:179], a[104:107]
  buffer_load_dwordx4 v2, s[44:47], s26 offen offset:3072 sc1 lds
  v_add_f32 v225, v225, v211
  v_mfma_f32_16x16x32_bf16 a[108:111], a[180:183], v[180:183], a[108:111]
  s_add_u32 s26, s26, 16384
  v_exp_f32 v214, v126
  v_mfma_f32_16x16x32_bf16 a[48:51], a[184:187], v[160:163], a[48:51]
  s_add_u32 s24, s24, 32768
  ds_read_b128 a[152:155], v3 offset:6144
  v_cvt_pk_bf16_f32 v173, v210, v211
  v_mfma_f32_16x16x32_bf16 a[52:55], a[184:187], v[164:167], a[52:55]
  s_and_b32 s24, s24, 0x1ffff
  v_exp_f32 v215, v127
  v_mfma_f32_16x16x32_bf16 a[112:115], a[184:187], v[176:179], a[112:115]
  v_max3_f32 v5, v226, v227, v224
  v_add_f32 v225, v225, v212
  v_mfma_f32_16x16x32_bf16 a[116:119], a[184:187], v[180:183], a[116:119]
  v_add_f32 v225, v225, v213
  v_cvt_pk_bf16_f32 v174, v212, v213
  v_add_f32 v225, v225, v214
  v_mfma_f32_16x16x32_bf16 a[56:59], a[188:191], v[160:163], a[56:59]
  ds_read_b128 a[156:159], v3 offset:7168
  v_add_f32 v225, v225, v215
  v_max_f32 v5, v5, v225
  v_cmp_lt_f32 vcc, s81, v5
  v_mfma_f32_16x16x32_bf16 a[60:63], a[188:191], v[164:167], a[60:63]
  v_exp_f32 v216, v128
  v_mfma_f32_16x16x32_bf16 a[120:123], a[188:191], v[176:179], a[120:123]
  s_waitcnt lgkmcnt(4)
  v_cvt_pk_bf16_f32 v175, v214, v215
  v_mfma_f32_16x16x32_bf16 a[124:127], a[188:191], v[180:183], a[124:127]
  s_cbranch_vccnz fa_stub1
fa_back1:
  v_exp_f32 v217, v129
  v_add_f32 v228, v228, v224
  v_add_f32 v229, v229, v225
  v_add_f32 v230, v230, v226
  v_add_f32 v231, v231, v227
fa_DDe:
  v_mfma_f32_16x16x32_bf16 v[112:115], a[128:131], v[32:35], v[192:195]
  ds_read_b128 a[160:163], v3 offset:24576
  v_add_f32 v226, v216, v217
  v_mfma_f32_16x16x32_bf16 v[120:123], a[128:131], v[36:39], v[196:199]
  v_exp_f32 v218, v130
  v_mfma_f32_16x16x32_bf16 v[144:147], a[128:131], v[64:67], v[200:203]
  s_cmp_ge_u32 s26, s9
  v_exp_f32 v219, v131
  v_mfma_f32_16x16x32_bf16 v[152:155], a[128:131], v[68:71], v[204:207]
  s_cbranch_scc1 fa_hk5
fa_hb5:
  v_exp_f32 v220, v132
  v_mfma_f32_16x16x32_bf16 v[116:119], a[132:135], v[32:35], v[192:195]
  s_add_u32 s66, s66, 32768
  ds_read_b128 a[164:167], v3 offset:25600
  v_cvt_pk_bf16_f32 v176, v216, v217
  v_mfma_f32_16x16x32_bf16 v[124:127], a[132:135], v[36:39], v[196:199]
  s_mov_b32 m0, s25
  v_exp_f32 v221, v133
  v_mfma_f32_16x16x32_bf16 v[148:151], a[132:135], v[64:67], v[200:203]
  s_and_b32 s66, s66, 0x1ffff
  buffer_load_dwordx4 v2, s[48:51], s27 offen offset:0 sc1 lds
  v_add_f32 v226, v226, v218
  v_mfma_f32_16x16x32_bf16 v[156:159], a[132:135], v[68:71], v[204:207]
  v_exp_f32 v222, v134
  v_mfma_f32_16x16x32_bf16 v[112:115], a[136:139], v[40:43], v[112:115]
  ds_read_b128 a[168:171], v3 offset:26624
  v_add_f32 v226, v226, v219
  v_mfma_f32_16x16x32_bf16 v[120:123], a[136:139], v[44:47], v[120:123]
  v_exp_f32 v223, v135
  v_mfma_f32_16x16x32_bf16 v[144:147], a[136:139], v[72:75], v[144:147]
  v_cvt_pk_bf16_f32 v177, v218, v219
  v_add_f32 v226, v226, v220
  v_mfma_f32_16x16x32_bf16 v[152:155], a[136:139], v[76:79], v[152:155]
  v_exp_f32 v216, v136
  v_mfma_f32_16x16x32_bf16 v[116:119], a[140:143], v[40:43], v[116:119]
  ds_read_b128 a[172:175], v3 offset:27648
  v_add_f32 v226, v226, v221
  v_mfma_f32_16x16x32_bf16 v[124:127], a[140:143], v[44:47], v[124:127]
  v_exp_f32 v217, v137
  v_mfma_f32_16x16x32_bf16 v[148:151], a[140:143], v[72:75], v[148:151]
  v_cvt_pk_bf16_f32 v178, v220, v221
  v_add_f32 v226, v226, v222
  v_mfma_f32_16x16x32_bf16 v[156:159], a[140:143], v[76:79], v[156:159]
  s_waitcnt lgkmcnt(4)
  v_exp_f32 v218, v138
  v_mfma_f32_16x16x32_bf16 v[112:115], a[144:147], v[48:51], v[112:115]
  ds_read_b128 a[176:179], v3 offset:28672
  v_add_f32 v226, v226, v223
  v_mfma_f32_16x16x32_bf16 v[120:123], a[144:147], v[52:55], v[120:123]
  v_exp_f32 v219, v139
  v_mfma_f32_16x16x32_bf16 v[144:147], a[144:147], v[80:83], v[144:147]
  v_cvt_pk_bf16_f32 v179, v222, v223
  v_add_f32 v227, v216, v217
  v_mfma_f32_16x16x32_bf16 v[152:155], a[144:147], v[84:87], v[152:155]
  v_exp_f32 v220, v140
  v_mfma_f32_16x16x32_bf16 v[116:119], a[148:151], v[48:51], v[116:119]
  ds_read_b128 a[180:183], v3 offset:29696
  v_cvt_pk_bf16_f32 v180, v216, v217
  v_mfma_f32_16x16x32_bf16 v[124:127], a[148:151], v[52:55], v[124:127]
  v_exp_f32 v221, v141
  v_mfma_f32_16x16x32_bf16 v[148:151], a[148:151], v[80:83], v[148:151]
  buffer_load_dwordx4 v2, s[48:51], s27 offen offset:1024 sc1 lds
  v_add_f32 v227, v227, v218
  v_mfma_f32_16x16x32_bf16 v[156:159], a[148:151], v[84:87], v[156:159]
  v_exp_f32 v222, v142
  v_mfma_f32_16x16x32_bf16 v[112:115], a[152:155], v[56:59], v[112:115]
  ds_read_b128 a[184:187], v3 offset:30720
  v_add_f32 v227, v227, v219
  v_mfma_f32_16x16x32_bf16 v[120:123], a[152:155], v[60:63], v[120:123]
  v_exp_f32 v223, v143
  v_mfma_f32_16x16x32_bf16 v[144:147], a[152:155], v[88:91], v[144:147]
  v_cvt_pk_bf16_f32 v181, v218, v219
  v_add_f32 v227, v227, v220
  v_mfma_f32_16x16x32_bf16 v[152:155], a[152:155], v[92:95], v[152:155]
  v_exp_f32 v208, v96
  v_mfma_f32_16x16x32_bf16 v[116:119], a[156:159], v[56:59], v[116:119]
  ds_read_b128 a[188:191], v3 offset:31744
  v_add_f32 v227, v227, v221
  v_mfma_f32_16x16x32_bf16 v[124:127], a[156:159], v[60:63], v[124:127]
  v_exp_f32 v209, v97
  v_mfma_f32_16x16x32_bf16 v[148:151], a[156:159], v[88:91], v[148:151]
  v_cvt_pk_bf16_f32 v182, v220, v221
  v_add_f32 v227, v227, v222
  v_add_f32 v227, v227, v223
  v_mfma_f32_16x16x32_bf16 v[156:159], a[156:159], v[92:95], v[156:159]
  s_waitcnt lgkmcnt(4)
  v_exp_f32 v210, v98
  v_mfma_f32_16x16x32_bf16 a[0:3], a[160:163], v[168:171], a[0:3]
  ds_read_b128 a[128:131], v3 offset:8192
  v_cvt_pk_bf16_f32 v183, v222, v223
  v_mfma_f32_16x16x32_bf16 a[4:7], a[160:163], v[172:175], a[4:7]
  v_exp_f32 v211, v99
  v_mfma_f32_16x16x32_bf16 a[64:67], a[160:163], v[184:187], a[64:67]
  v_exp_f32 v212, v100
  v_mfma_f32_16x16x32_bf16 a[68:71], a[160:163], v[188:191], a[68:71]
  v_add_f32 v224, v208, v209
  v_cvt_pk_bf16_f32 v160, v208, v209
  v_mfma_f32_16x16x32_bf16 a[8:11], a[164:167], v[168:171], a[8:11]
  ds_read_b128 a[132:135], v3 offset:9216
  v_add_f32 v224, v224, v210
  v_mfma_f32_16x16x32_bf16 a[12:15], a[164:167], v[172:175], a[12:15]
  v_exp_f32 v213, v101
  v_mfma_f32_16x16x32_bf16 a[72:75], a[164:167], v[184:187], a[72:75]
  buffer_load_dwordx4 v2, s[48:51], s27 offen offset:2048 sc1 lds
  v_add_f32 v224, v224, v211
  v_mfma_f32_16x16x32_bf16 a[76:79], a[164:167], v[188:191], a[76:79]
  v_exp_f32 v214, v102
  v_mfma_f32_16x16x32_bf16 a[16:19], a[168:171], v[168:171], a[16:19]
  ds_read_b128 a[136:139], v3 offset:10240
  v_cvt_pk_bf16_f32 v161, v210, v211
  v_mfma_f32_16x16x32_bf16 a[20:23], a[168:171], v[172:175], a[20:23]
  v_exp_f32 v215, v103
  v_mfma_f32_16x16x32_bf16 a[80:83], a[168:171], v[184:187], a[80:83]
  v_add_f32 v224, v224, v212
  v_add_f32 v224, v224, v213
  v_mfma_f32_16x16x32_bf16 a[84:87], a[168:171], v[188:191], a[84:87]
  v_exp_f32 v208, v104
  v_mfma_f32_16x16x32_bf16 a[24:27], a[172:175], v[168:171], a[24:27]
  ds_read_b128 a[140:143], v3 offset:11264
  v_cvt_pk_bf16_f32 v162, v212, v213
  v_mfma_f32_16x16x32_bf16 a[28:31], a[172:175], v[172:175], a[28:31]
  v_exp_f32 v209, v105
  v_mfma_f32_16x16x32_bf16 a[88:91], a[172:175], v[184:187], a[88:91]
  v_exp_f32 v210, v106
  v_mfma_f32_16x16x32_bf16 a[92:95], a[172:175], v[188:191], a[92:95]
  s_waitcnt lgkmcnt(4)
  v_add_f32 v224, v224, v214
  v_add_f32 v224, v224, v215
  v_mfma_f32_16x16x32_bf16 a[32:35], a[176:179], v[168:171], a[32:35]
  ds_read_b128 a[144:147], v3 offset:12288
  v_cvt_pk_bf16_f32 v163, v214, v215
  v_mfma_f32_16x16x32_bf16 a[36:39], a[176:179], v[172:175], a[36:39]
  v_exp_f32 v211, v107
  v_mfma_f32_16x16x32_bf16 a[96:99], a[176:179], v[184:187], a[96:99]
  v_add_f32 v225, v208, v209
  v_cvt_pk_bf16_f32 v164, v208, v209
  v_mfma_f32_16x16x32_bf16 a[100:103], a[176:179], v[188:191], a[100:103]
  v_exp_f32 v212, v108
  v_mfma_f32_16x16x32_bf16 a[40:43], a[180:183], v[168:171], a[40:43]
  ds_read_b128 a[148:151], v3 offset:13312
  v_add_f32 v225, v225, v210
  v_mfma_f32_16x16x32_bf16 a[44:47], a[180:183], v[172:175], a[44:47]
  v_exp_f32 v213, v109
  v_mfma_f32_16x16x32_bf16 a[104:107], a[180:183], v[184:187], a[104:107]
  buffer_load_dwordx4 v2, s[48:51], s27 offen offset:3072 sc1 lds
  v_add_f32 v225, v225, v211
  v_mfma_f32_16x16x32_bf16 a[108:111], a[180:183], v[188:191], a[108:111]
  s_add_u32 s27, s27, 16384
  v_exp_f32 v214, v110
  v_mfma_f32_16x16x32_bf16 a[48:51], a[184:187], v[168:171], a[48:51]
  s_add_u32 s25, s25, 32768
  ds_read_b128 a[152:155], v3 offset:14336
  v_cvt_pk_bf16_f32 v165, v210, v211
  v_mfma_f32_16x16x32_bf16 a[52:55], a[184:187], v[172:175], a[52:55]
  s_and_b32 s25, s25, 0x1ffff
  v_exp_f32 v215, v111
  v_mfma_f32_16x16x32_bf16 a[112:115], a[184:187], v[184:187], a[112:115]
  v_max3_f32 v5, v226, v227, v224
  v_add_f32 v225, v225, v212
  v_mfma_f32_16x16x32_bf16 a[116:119], a[184:187], v[188:191], a[116:119]
  v_add_f32 v225, v225, v213
  v_cvt_pk_bf16_f32 v166, v212, v213
  v_add_f32 v225, v225, v214
  v_mfma_f32_16x16x32_bf16 a[56:59], a[188:191], v[168:171], a[56:59]
  s_sub_u32 s28, s28, 1
  ds_read_b128 a[156:159], v3 offset:15360
  v_add_f32 v225, v225, v215
  v_max_f32 v5, v5, v225
  v_cmp_lt_f32 vcc, s81, v5
  v_mfma_f32_16x16x32_bf16 a[60:63], a[188:191], v[172:175], a[60:63]
  s_cmp_gt_u32 s28, s8
  v_exp_f32 v216, v144
  v_mfma_f32_16x16x32_bf16 a[120:123], a[188:191], v[184:187], a[120:123]
  s_waitcnt lgkmcnt(4)
  v_cvt_pk_bf16_f32 v167, v214, v215
  v_add_u32 v3, s66, v2
  v_mfma_f32_16x16x32_bf16 a[124:127], a[188:191], v[188:191], a[124:127]
  s_cbranch_vccnz fa_stub2
fa_back2:
  v_exp_f32 v217, v145
  v_add_f32 v228, v228, v224
  v_add_f32 v229, v229, v225
  v_add_f32 v230, v230, v226
  v_add_f32 v231, v231, v227
  s_cbranch_scc1 fa_DD
  s_cmp_lg_u32 s8, 0
  s_cbranch_scc1 fa_DDF
fa_Aexit:
  s_bitcmp1_b32 s20, 0
  s_cbranch_scc1 fa_Aodd
  v_mfma_f32_16x16x32_bf16 v[96:99], a[128:131], v[32:35], v[192:195]
  s_waitcnt vmcnt(12)
  v_exp_f32 v218, v146
  v_mfma_f32_16x16x32_bf16 v[104:107], a[128:131], v[36:39], v[196:199]
  s_barrier
  v_exp_f32 v219, v147
  v_mfma_f32_16x16x32_bf16 v[128:131], a[128:131], v[64:67], v[200:203]
  ds_read_b128 a[160:163], v3 offset:16384
  v_add_f32 v226, v216, v217
  v_mfma_f32_16x16x32_bf16 v[136:139], a[128:131], v[68:71], v[204:207]
  v_exp_f32 v220, v148
  v_mfma_f32_16x16x32_bf16 v[100:103], a[132:135], v[32:35], v[192:195]
  ds_read_b128 a[164:167], v3 offset:17408
  v_cvt_pk_bf16_f32 v184, v216, v217
  v_mfma_f32_16x16x32_bf16 v[108:111], a[132:135], v[36:39], v[196:199]
  s_mov_b32 m0, s24
  v_exp_f32 v221, v149
  v_mfma_f32_16x16x32_bf16 v[132:135], a[132:135], v[64:67], v[200:203]
  buffer_load_dwordx4 v2, s[44:47], s26 offen offset:0 sc1 lds
  v_add_f32 v226, v226, v218
  v_mfma_f32_16x16x32_bf16 v[140:143], a[132:135], v[68:71], v[204:207]
  v_exp_f32 v222, v150
  v_mfma_f32_16x16x32_bf16 v[96:99], a[136:139], v[40:43], v[96:99]
  ds_read_b128 a[168:171], v3 offset:18432
  v_add_f32 v226, v226, v219
  v_mfma_f32_16x16x32_bf16 v[104:107], a[136:139], v[44:47], v[104:107]
  v_exp_f32 v223, v151
  v_mfma_f32_16x16x32_bf16 v[128:131], a[136:139], v[72:75], v[128:131]
  v_cvt_pk_bf16_f32 v185, v218, v219
  v_add_f32 v226, v226, v220
  v_mfma_f32_16x16x32_bf16 v[136:139], a[136:139], v[76:79], v[136:139]
  v_exp_f32 v216, v152
  v_mfma_f32_16x16x32_bf16 v[100:103], a[140:143], v[40:43], v[100:103]
  ds_read_b128 a[172:175], v3 offset:19456
  v_add_f32 v226, v226, v221
  v_mfma_f32_16x16x32_bf16 v[108:111], a[140:143], v[44:47], v[108:111]
  v_exp_f32 v217, v153
  v_mfma_f32_16x16x32_bf16 v[132:135], a[140:143], v[72:75], v[132:135]
  v_cvt_pk_bf16_f32 v186, v220, v221
  v_add_f32 v226, v226, v222
  v_mfma_f32_16x16x32_bf16 v[140:143], a[140:143], v[76:79], v[140:143]
  s_waitcnt lgkmcnt(4)
  v_exp_f32 v218, v154
  v_mfma_f32_16x16x32_bf16 v[96:99], a[144:147], v[48:51], v[96:99]
  ds_read_b128 a[176:179], v3 offset:20480
  v_add_f32 v226, v226, v223
  v_mfma_f32_16x16x32_bf16 v[104:107], a[144:147], v[52:55], v[104:107]
  v_exp_f32 v219, v155
  v_mfma_f32_16x16x32_bf16 v[128:131], a[144:147], v[80:83], v[128:131]
  v_cvt_pk_bf16_f32 v187, v222, v223
  v_add_f32 v227, v216, v217
  v_mfma_f32_16x16x32_bf16 v[136:139], a[144:147], v[84:87], v[136:139]
  v_exp_f32 v220, v156
  v_mfma_f32_16x16x32_bf16 v[100:103], a[148:151], v[48:51], v[100:103]
  ds_read_b128 a[180:183], v3 offset:21504
  v_cvt_pk_bf16_f32 v188, v216, v217
  v_mfma_f32_16x16x32_bf16 v[108:111], a[148:151], v[52:55], v[108:111]
  v_exp_f32 v221, v157
  v_mfma_f32_16x16x32_bf16 v[132:135], a[148:151], v[80:83], v[132:135]
  buffer_load_dwordx4 v2, s[44:47], s26 offen offset:1024 sc1 lds
  v_add_f32 v227, v227, v218
  v_mfma_f32_16x16x32_bf16 v[140:143], a[148:151], v[84:87], v[140:143]
  v_exp_f32 v222, v158
  v_mfma_f32_16x16x32_bf16 v[96:99], a[152:155], v[56:59], v[96:99]
  ds_read_b128 a[184:187], v3 offset:22528
  v_add_f32 v227, v227, v219
  v_mfma_f32_16x16x32_bf16 v[104:107], a[152:155], v[60:63], v[104:107]
  v_exp_f32 v223, v159
  v_mfma_f32_16x16x32_bf16 v[128:131], a[152:155], v[88:91], v[128:131]
  v_cvt_pk_bf16_f32 v189, v218, v219
  v_add_f32 v227, v227, v220
  v_mfma_f32_16x16x32_bf16 v[136:139], a[152:155], v[92:95], v[136:139]
  v_exp_f32 v208, v112
  v_mfma_f32_16x16x32_bf16 v[100:103], a[156:159], v[56:59], v[100:103]
  ds_read_b128 a[188:191], v3 offset:23552
  v_add_f32 v227, v227, v221
  v_mfma_f32_16x16x32_bf16 v[108:111], a[156:159], v[60:63], v[108:111]
  v_exp_f32 v209, v113
  v_mfma_f32_16x16x32_bf16 v[132:135], a[156:159], v[88:91], v[132:135]
  v_cvt_pk_bf16_f32 v190, v220, v221
  v_add_f32 v227, v227, v222
  v_add_f32 v227, v227, v223
  v_mfma_f32_16x16x32_bf16 v[140:143], a[156:159], v[92:95], v[140:143]
  s_waitcnt lgkmcnt(4)
  v_exp_f32 v210, v114
  v_mfma_f32_16x16x32_bf16 a[0:3], a[160:163], v[160:163], a[0:3]
  ds_read_b128 a[128:131], v3 offset:0
  v_cvt_pk_bf16_f32 v191, v222, v223
  v_mfma_f32_16x16x32_bf16 a[4:7], a[160:163], v[164:167], a[4:7]
  v_exp_f32 v211, v115
  v_mfma_f32_16x16x32_bf16 a[64:67], a[160:163], v[176:179], a[64:67]
  v_exp_f32 v212, v116
  v_mfma_f32_16x16x32_bf16 a[68:71], a[160:163], v[180:183], a[68:71]
  v_add_f32 v224, v208, v209
  v_cvt_pk_bf16_f32 v168, v208, v209
  v_mfma_f32_16x16x32_bf16 a[8:11], a[164:167], v[160:163], a[8:11]
  ds_read_b128 a[132:135], v3 offset:1024
  v_add_f32 v224, v224, v210
  v_mfma_f32_16x16x32_bf16 a[12:15], a[164:167], v[164:167], a[12:15]
  v_exp_f32 v213, v117
  v_mfma_f32_16x16x32_bf16 a[72:75], a[164:167], v[176:179], a[72:75]
  buffer_load_dwordx4 v2, s[44:47], s26 offen offset:2048 sc1 lds
  v_add_f32 v224, v224, v211
  v_mfma_f32_16x16x32_bf16 a[76:79], a[164:167], v[180:183], a[76:79]
  v_exp_f32 v214, v118
  v_mfma_f32_16x16x32_bf16 a[16:19], a[168:171], v[160:163], a[16:19]
  ds_read_b128 a[136:139], v3 offset:2048
  v_cvt_pk_bf16_f32 v169, v210, v211
  v_mfma_f32_16x16x32_bf16 a[20:23], a[168:171], v[164:167], a[20:23]
  v_exp_f32 v215, v119
  v_mfma_f32_16x16x32_bf16 a[80:83], a[168:171], v[176:179], a[80:83]
  v_add_f32 v224, v224, v212
  v_add_f32 v224, v224, v213
  v_mfma_f32_16x16x32_bf16 a[84:87], a[168:171], v[180:183], a[84:87]
  v_exp_f32 v208, v120
  v_mfma_f32_16x16x32_bf16 a[24:27], a[172:175], v[160:163], a[24:27]
  ds_read_b128 a[140:143], v3 offset:3072
  v_cvt_pk_bf16_f32 v170, v212, v213
  v_mfma_f32_16x16x32_bf16 a[28:31], a[172:175], v[164:167], a[28:31]
  v_exp_f32 v209, v121
  v_mfma_f32_16x16x32_bf16 a[88:91], a[172:175], v[176:179], a[88:91]
  v_exp_f32 v210, v122
  v_mfma_f32_16x16x32_bf16 a[92:95], a[172:175], v[180:183], a[92:95]
  s_waitcnt lgkmcnt(4)
  v_add_f32 v224, v224, v214
  v_add_f32 v224, v224, v215
  v_mfma_f32_16x16x32_bf16 a[32:35], a[176:179], v[160:163], a[32:35]
  ds_read_b128 a[144:147], v3 offset:4096
  v_cvt_pk_bf16_f32 v171, v214, v215
  v_mfma_f32_16x16x32_bf16 a[36:39], a[176:179], v[164:167], a[36:39]
  v_exp_f32 v211, v123
  v_mfma_f32_16x16x32_bf16 a[96:99], a[176:179], v[176:179], a[96:99]
  v_add_f32 v225, v208, v209
  v_cvt_pk_bf16_f32 v172, v208, v209
  v_mfma_f32_16x16x32_bf16 a[100:103], a[176:179], v[180:183], a[100:103]
  v_exp_f32 v212, v124
  v_mfma_f32_16x16x32_bf16 a[40:43], a[180:183], v[160:163], a[40:43]
  ds_read_b128 a[148:151], v3 offset:5120
  v_add_f32 v225, v225, v210
  v_mfma_f32_16x16x32_bf16 a[44:47], a[180:183], v[164:167], a[44:47]
  v_exp_f32 v213, v125
  v_mfma_f32_16x16x32_bf16 a[104:107], a[180:183], v[176:179], a[104:107]
  buffer_load_dwordx4 v2, s[44:47], s26 offen offset:3072 sc1 lds
  v_add_f32 v225, v225, v211
  v_mfma_f32_16x16x32_bf16 a[108:111], a[180:183], v[180:183], a[108:111]
  s_add_u32 s26, s26, 16384
  v_exp_f32 v214, v126
  v_mfma_f32_16x16x32_bf16 a[48:51], a[184:187], v[160:163], a[48:51]
  s_add_u32 s24, s24, 32768
  ds_read_b128 a[152:155], v3 offset:6144
  v_cvt_pk_bf16_f32 v173, v210, v211
  v_mfma_f32_16x16x32_bf16 a[52:55], a[184:187], v[164:167], a[52:55]
  s_and_b32 s24, s24, 0x1ffff
  v_exp_f32 v215, v127
  v_mfma_f32_16x16x32_bf16 a[112:115], a[184:187], v[176:179], a[112:115]
  v_max3_f32 v5, v226, v227, v224
  v_add_f32 v225, v225, v212
  v_mfma_f32_16x16x32_bf16 a[116:119], a[184:187], v[180:183], a[116:119]
  v_add_f32 v225, v225, v213
  v_cvt_pk_bf16_f32 v174, v212, v213
  v_add_f32 v225, v225, v214
  v_mfma_f32_16x16x32_bf16 a[56:59], a[188:191], v[160:163], a[56:59]
  ds_read_b128 a[156:159], v3 offset:7168
  v_add_f32 v225, v225, v215
  v_max_f32 v5, v5, v225
  v_cmp_lt_f32 vcc, s81, v5
  v_mfma_f32_16x16x32_bf16 a[60:63], a[188:191], v[164:167], a[60:63]
  v_exp_f32 v216, v128
  v_mfma_f32_16x16x32_bf16 a[120:123], a[188:191], v[176:179], a[120:123]
  s_waitcnt lgkmcnt(4)
  v_cvt_pk_bf16_f32 v175, v214, v215
  v_mfma_f32_16x16x32_bf16 a[124:127], a[188:191], v[180:183], a[124:127]
  s_cbranch_vccnz fa_stub4
fa_back4:
  v_exp_f32 v217, v129
  v_add_f32 v228, v228, v224
  v_add_f32 v229, v229, v225
  v_add_f32 v230, v230, v226
  v_add_f32 v231, v231, v227
  v_mfma_f32_16x16x32_bf16 v[144:147], a[128:131], v[64:67], v[200:203]
  ds_read_b128 a[160:163], v3 offset:24576
  v_exp_f32 v218, v130
  v_mfma_f32_16x16x32_bf16 v[152:155], a[128:131], v[68:71], v[204:207]
  v_exp_f32 v219, v131
  v_add_f32 v226, v216, v217
  v_mfma_f32_16x16x32_bf16 v[148:151], a[132:135], v[64:67], v[200:203]
  s_add_u32 s66, s66, 32768
  ds_read_b128 a[164:167], v3 offset:25600
  v_exp_f32 v220, v132
  v_mfma_f32_16x16x32_bf16 v[156:159], a[132:135], v[68:71], v[204:207]
  s_and_b32 s66, s66, 0x1ffff
  v_exp_f32 v221, v133
  v_cvt_pk_bf16_f32 v176, v216, v217
  v_mfma_f32_16x16x32_bf16 v[144:147], a[136:139], v[72:75], v[144:147]
  ds_read_b128 a[168:171], v3 offset:26624
  v_add_f32 v226, v226, v218
  v_add_f32 v226, v226, v219
  v_mfma_f32_16x16x32_bf16 v[152:155], a[136:139], v[76:79], v[152:155]
  s_mov_b32 m0, s25
  v_exp_f32 v222, v134
  v_cvt_pk_bf16_f32 v177, v218, v219
  v_mfma_f32_16x16x32_bf16 v[148:151], a[140:143], v[72:75], v[148:151]
  ds_read_b128 a[172:175], v3 offset:27648
  buffer_load_dwordx4 v2, s[48:51], s27 offen offset:0 sc1 lds
  v_add_f32 v226, v226, v220
  v_add_f32 v226, v226, v221
  v_mfma_f32_16x16x32_bf16 v[156:159], a[140:143], v[76:79], v[156:159]
  s_waitcnt lgkmcnt(4)
  v_exp_f32 v223, v135
  v_cvt_pk_bf16_f32 v178, v220, v221
  v_mfma_f32_16x16x32_bf16 v[144:147], a[144:147], v[80:83], v[144:147]
  ds_read_b128 a[176:179], v3 offset:28672
  v_cndmask_b32 v96, v4, v96, s[68:69]
  v_cndmask_b32 v97, v4, v97, s[70:71]
  v_mfma_f32_16x16x32_bf16 v[152:155], a[144:147], v[84:87], v[152:155]
  v_exp_f32 v216, v136
  v_cndmask_b32 v98, v4, v98, s[72:73]
  v_mfma_f32_16x16x32_bf16 v[148:151], a[148:151], v[80:83], v[148:151]
  ds_read_b128 a[180:183], v3 offset:29696
  v_cndmask_b32 v99, v4, v99, s[74:75]
  v_mov_b32 v100, v4
  v_mfma_f32_16x16x32_bf16 v[156:159], a[148:151], v[84:87], v[156:159]
  v_exp_f32 v217, v137
  v_mov_b32 v101, v4
  v_mfma_f32_16x16x32_bf16 v[144:147], a[152:155], v[88:91], v[144:147]
  ds_read_b128 a[184:187], v3 offset:30720
  v_mov_b32 v102, v4
  v_mov_b32 v103, v4
  v_mfma_f32_16x16x32_bf16 v[152:155], a[152:155], v[92:95], v[152:155]
  v_exp_f32 v218, v138
  v_cndmask_b32 v108, v4, v108, s[68:69]
  v_mfma_f32_16x16x32_bf16 v[148:151], a[156:159], v[88:91], v[148:151]
  ds_read_b128 a[188:191], v3 offset:31744
  v_cndmask_b32 v109, v4, v109, s[70:71]
  v_cndmask_b32 v110, v4, v110, s[72:73]
  v_mfma_f32_16x16x32_bf16 v[156:159], a[156:159], v[92:95], v[156:159]
  s_waitcnt lgkmcnt(4)
  v_exp_f32 v219, v139
  v_cndmask_b32 v111, v4, v111, s[74:75]
  v_mfma_f32_16x16x32_bf16 a[0:3], a[160:163], v[168:171], a[0:3]
  ds_read_b128 a[128:131], v3 offset:8192
  v_add_f32 v226, v226, v222
  v_add_f32 v226, v226, v223
  v_mfma_f32_16x16x32_bf16 a[4:7], a[160:163], v[172:175], a[4:7]
  v_exp_f32 v220, v140
  v_cvt_pk_bf16_f32 v179, v222, v223
  v_mfma_f32_16x16x32_bf16 a[64:67], a[160:163], v[184:187], a[64:67]
  buffer_load_dwordx4 v2, s[48:51], s27 offen offset:1024 sc1 lds
  v_add_f32 v227, v216, v217
  v_cvt_pk_bf16_f32 v180, v216, v217
  v_mfma_f32_16x16x32_bf16 a[68:71], a[160:163], v[188:191], a[68:71]
  v_exp_f32 v221, v141
  v_add_f32 v227, v227, v218
  v_mfma_f32_16x16x32_bf16 a[8:11], a[164:167], v[168:171], a[8:11]
  ds_read_b128 a[132:135], v3 offset:9216
  v_exp_f32 v222, v142
  v_mfma_f32_16x16x32_bf16 a[12:15], a[164:167], v[172:175], a[12:15]
  v_exp_f32 v223, v143
  v_mfma_f32_16x16x32_bf16 a[72:75], a[164:167], v[184:187], a[72:75]
  v_exp_f32 v208, v96
  v_mfma_f32_16x16x32_bf16 a[76:79], a[164:167], v[188:191], a[76:79]
  v_exp_f32 v209, v97
  v_mfma_f32_16x16x32_bf16 a[16:19], a[168:171], v[168:171], a[16:19]
  ds_read_b128 a[136:139], v3 offset:10240
  v_add_f32 v227, v227, v219
  v_cvt_pk_bf16_f32 v181, v218, v219
  v_add_f32 v227, v227, v220
  v_add_f32 v227, v227, v221
  v_cvt_pk_bf16_f32 v182, v220, v221
  v_mfma_f32_16x16x32_bf16 a[20:23], a[168:171], v[172:175], a[20:23]
  v_exp_f32 v210, v98
  v_mfma_f32_16x16x32_bf16 a[80:83], a[168:171], v[184:187], a[80:83]
  v_exp_f32 v211, v99
  v_mfma_f32_16x16x32_bf16 a[84:87], a[168:171], v[188:191], a[84:87]
  v_exp_f32 v212, v100
  v_mfma_f32_16x16x32_bf16 a[24:27], a[172:175], v[168:171], a[24:27]
  ds_read_b128 a[140:143], v3 offset:11264
  v_add_f32 v227, v227, v222
  v_add_f32 v227, v227, v223
  v_cvt_pk_bf16_f32 v183, v222, v223
  v_add_f32 v224, v208, v209
  v_cvt_pk_bf16_f32 v160, v208, v209
  v_mfma_f32_16x16x32_bf16 a[28:31], a[172:175], v[172:175], a[28:31]
  v_exp_f32 v213, v101
  v_mfma_f32_16x16x32_bf16 a[88:91], a[172:175], v[184:187], a[88:91]
  buffer_load_dwordx4 v2, s[48:51], s27 offen offset:2048 sc1 lds
  v_add_f32 v224, v224, v210
  v_add_f32 v224, v224, v211
  v_cvt_pk_bf16_f32 v161, v210, v211
  v_mfma_f32_16x16x32_bf16 a[92:95], a[172:175], v[188:191], a[92:95]
  s_waitcnt lgkmcnt(4)
  v_exp_f32 v214, v102
  v_mfma_f32_16x16x32_bf16 a[32:35], a[176:179], v[168:171], a[32:35]
  ds_read_b128 a[144:147], v3 offset:12288
  v_exp_f32 v215, v103
  v_mfma_f32_16x16x32_bf16 a[36:39], a[176:179], v[172:175], a[36:39]
  v_exp_f32 v208, v104
  v_mfma_f32_16x16x32_bf16 a[96:99], a[176:179], v[184:187], a[96:99]
  v_exp_f32 v209, v105
  v_mfma_f32_16x16x32_bf16 a[100:103], a[176:179], v[188:191], a[100:103]
  v_exp_f32 v210, v106
  v_mfma_f32_16x16x32_bf16 a[40:43], a[180:183], v[168:171], a[40:43]
  ds_read_b128 a[148:151], v3 offset:13312
  v_add_f32 v224, v224, v212
  v_add_f32 v224, v224, v213
  v_cvt_pk_bf16_f32 v162, v212, v213
  v_add_f32 v224, v224, v214
  v_add_f32 v224, v224, v215
  v_cvt_pk_bf16_f32 v163, v214, v215
  v_mfma_f32_16x16x32_bf16 a[44:47], a[180:183], v[172:175], a[44:47]
  v_exp_f32 v211, v107
  v_mfma_f32_16x16x32_bf16 a[104:107], a[180:183], v[184:187], a[104:107]
  v_exp_f32 v212, v108
  v_mfma_f32_16x16x32_bf16 a[108:111], a[180:183], v[188:191], a[108:111]
  v_exp_f32 v213, v109
  v_mfma_f32_16x16x32_bf16 a[48:51], a[184:187], v[168:171], a[48:51]
  ds_read_b128 a[152:155], v3 offset:14336
  v_add_f32 v225, v208, v209
  v_cvt_pk_bf16_f32 v164, v208, v209
  v_add_f32 v225, v225, v210
  v_add_f32 v225, v225, v211
  v_cvt_pk_bf16_f32 v165, v210, v211
  v_mfma_f32_16x16x32_bf16 a[52:55], a[184:187], v[172:175], a[52:55]
  v_exp_f32 v214, v110
  v_mfma_f32_16x16x32_bf16 a[112:115], a[184:187], v[184:187], a[112:115]
  buffer_load_dwordx4 v2, s[48:51], s27 offen offset:3072 sc1 lds
  v_max3_f32 v5, v226, v227, v224
  v_add_f32 v225, v225, v212
  v_add_f32 v225, v225, v213
  v_mfma_f32_16x16x32_bf16 a[116:119], a[184:187], v[188:191], a[116:119]
  s_add_u32 s27, s27, 16384
  v_exp_f32 v215, v111
  v_mfma_f32_16x16x32_bf16 a[56:59], a[188:191], v[168:171], a[56:59]
  s_add_u32 s25, s25, 32768
  ds_read_b128 a[156:159], v3 offset:15360
  v_cvt_pk_bf16_f32 v166, v212, v213
  v_add_f32 v225, v225, v214
  v_add_f32 v225, v225, v215
  v_max_f32 v5, v5, v225
  v_cmp_lt_f32 vcc, s81, v5
  v_mfma_f32_16x16x32_bf16 a[60:63], a[188:191], v[172:175], a[60:63]
  s_and_b32 s25, s25, 0x1ffff
  v_exp_f32 v216, v144
  v_mfma_f32_16x16x32_bf16 a[120:123], a[188:191], v[184:187], a[120:123]
  s_waitcnt lgkmcnt(4)
  v_cvt_pk_bf16_f32 v167, v214, v215
  v_add_u32 v3, s66, v2
  v_mfma_f32_16x16x32_bf16 a[124:127], a[188:191], v[188:191], a[124:127]
  s_cbranch_vccnz fa_stub5
fa_back5:
  v_exp_f32 v217, v145
  v_add_f32 v228, v228, v224
  v_add_f32 v229, v229, v225
  v_add_f32 v230, v230, v226
  v_add_f32 v231, v231, v227
fa_AV:
  v_mfma_f32_16x16x32_bf16 v[128:131], a[128:131], v[64:67], v[200:203]
  s_waitcnt vmcnt(12)
  v_exp_f32 v218, v146
  v_mfma_f32_16x16x32_bf16 v[136:139], a[128:131], v[68:71], v[204:207]
  s_barrier
  v_exp_f32 v219, v147
  v_mfma_f32_16x16x32_bf16 v[132:135], a[132:135], v[64:67], v[200:203]
  ds_read_b128 a[160:163], v3 offset:16384
  ds_read_b128 a[164:167], v3 offset:17408
  v_add_f32 v226, v216, v217
  v_mfma_f32_16x16x32_bf16 v[140:143], a[132:135], v[68:71], v[204:207]
  v_exp_f32 v220, v148
  v_mfma_f32_16x16x32_bf16 v[128:131], a[136:139], v[72:75], v[128:131]
  ds_read_b128 a[168:171], v3 offset:18432
  v_cvt_pk_bf16_f32 v184, v216, v217
  v_mfma_f32_16x16x32_bf16 v[136:139], a[136:139], v[76:79], v[136:139]
  s_mov_b32 m0, s24
  v_exp_f32 v221, v149
  v_mfma_f32_16x16x32_bf16 v[132:135], a[140:143], v[72:75], v[132:135]
  ds_read_b128 a[172:175], v3 offset:19456
  buffer_load_dwordx4 v2, s[44:47], s26 offen offset:0 sc1 lds
  v_add_f32 v226, v226, v218
  v_mfma_f32_16x16x32_bf16 v[140:143], a[140:143], v[76:79], v[140:143]
  s_waitcnt lgkmcnt(4)
  v_exp_f32 v222, v150
  v_mfma_f32_16x16x32_bf16 v[128:131], a[144:147], v[80:83], v[128:131]
  ds_read_b128 a[176:179], v3 offset:20480
  v_add_f32 v226, v226, v219
  v_mfma_f32_16x16x32_bf16 v[136:139], a[144:147], v[84:87], v[136:139]
  v_exp_f32 v223, v151
  v_mfma_f32_16x16x32_bf16 v[132:135], a[148:151], v[80:83], v[132:135]
  ds_read_b128 a[180:183], v3 offset:21504
  v_cvt_pk_bf16_f32 v185, v218, v219
  v_mfma_f32_16x16x32_bf16 v[140:143], a[148:151], v[84:87], v[140:143]
  v_add_f32 v226, v226, v220
  v_add_f32 v226, v226, v221
  v_mfma_f32_16x16x32_bf16 v[128:131], a[152:155], v[88:91], v[128:131]
  ds_read_b128 a[184:187], v3 offset:22528
  v_cvt_pk_bf16_f32 v186, v220, v221
  v_mfma_f32_16x16x32_bf16 v[136:139], a[152:155], v[92:95], v[136:139]
  v_exp_f32 v216, v152
  v_mfma_f32_16x16x32_bf16 v[132:135], a[156:159], v[88:91], v[132:135]
  ds_read_b128 a[188:191], v3 offset:23552
  v_add_f32 v226, v226, v222
  v_mfma_f32_16x16x32_bf16 v[140:143], a[156:159], v[92:95], v[140:143]
  s_waitcnt lgkmcnt(4)
  v_exp_f32 v217, v153
  v_mfma_f32_16x16x32_bf16 a[0:3], a[160:163], v[160:163], a[0:3]
  ds_read_b128 a[128:131], v3 offset:0
  v_add_f32 v226, v226, v223
  v_mfma_f32_16x16x32_bf16 a[4:7], a[160:163], v[164:167], a[4:7]
  v_exp_f32 v218, v154
  v_mfma_f32_16x16x32_bf16 a[64:67], a[160:163], v[176:179], a[64:67]
  buffer_load_dwordx4 v2, s[44:47], s26 offen offset:1024 sc1 lds
  v_cvt_pk_bf16_f32 v187, v222, v223
  v_mfma_f32_16x16x32_bf16 a[68:71], a[160:163], v[180:183], a[68:71]
  v_exp_f32 v219, v155
  v_mfma_f32_16x16x32_bf16 a[8:11], a[164:167], v[160:163], a[8:11]
  ds_read_b128 a[132:135], v3 offset:1024
  v_add_f32 v227, v216, v217
  v_mfma_f32_16x16x32_bf16 a[12:15], a[164:167], v[164:167], a[12:15]
  v_exp_f32 v220, v156
  v_mfma_f32_16x16x32_bf16 a[72:75], a[164:167], v[176:179], a[72:75]
  v_exp_f32 v221, v157
  v_mfma_f32_16x16x32_bf16 a[76:79], a[164:167], v[180:183], a[76:79]
  v_cvt_pk_bf16_f32 v188, v216, v217
  v_add_f32 v227, v227, v218
  v_mfma_f32_16x16x32_bf16 a[16:19], a[168:171], v[160:163], a[16:19]
  ds_read_b128 a[136:139], v3 offset:2048
  v_add_f32 v227, v227, v219
  v_mfma_f32_16x16x32_bf16 a[20:23], a[168:171], v[164:167], a[20:23]
  v_exp_f32 v222, v158
  v_mfma_f32_16x16x32_bf16 a[80:83], a[168:171], v[176:179], a[80:83]
  v_exp_f32 v223, v159
  v_mfma_f32_16x16x32_bf16 a[84:87], a[168:171], v[180:183], a[84:87]
  v_cvt_pk_bf16_f32 v189, v218, v219
  v_add_f32 v227, v227, v220
  v_mfma_f32_16x16x32_bf16 a[24:27], a[172:175], v[160:163], a[24:27]
  ds_read_b128 a[140:143], v3 offset:3072
  v_add_f32 v227, v227, v221
  v_mfma_f32_16x16x32_bf16 a[28:31], a[172:175], v[164:167], a[28:31]
  v_cvt_pk_bf16_f32 v190, v220, v221
  v_add_f32 v227, v227, v222
  v_mfma_f32_16x16x32_bf16 a[88:91], a[172:175], v[176:179], a[88:91]
  buffer_load_dwordx4 v2, s[44:47], s26 offen offset:2048 sc1 lds
  v_add_f32 v227, v227, v223
  v_mfma_f32_16x16x32_bf16 a[92:95], a[172:175], v[180:183], a[92:95]
  s_waitcnt lgkmcnt(4)
  v_max_f32 v5, v226, v227
  v_cmp_lt_f32 vcc, s81, v5
  v_mfma_f32_16x16x32_bf16 a[32:35], a[176:179], v[160:163], a[32:35]
  ds_read_b128 a[144:147], v3 offset:4096
  v_mfma_f32_16x16x32_bf16 a[36:39], a[176:179], v[164:167], a[36:39]
  v_mfma_f32_16x16x32_bf16 a[96:99], a[176:179], v[176:179], a[96:99]
  v_mfma_f32_16x16x32_bf16 a[100:103], a[176:179], v[180:183], a[100:103]
  v_mfma_f32_16x16x32_bf16 a[40:43], a[180:183], v[160:163], a[40:43]
  ds_read_b128 a[148:151], v3 offset:5120
  v_mfma_f32_16x16x32_bf16 a[44:47], a[180:183], v[164:167], a[44:47]
  v_mfma_f32_16x16x32_bf16 a[104:107], a[180:183], v[176:179], a[104:107]
  v_mfma_f32_16x16x32_bf16 a[108:111], a[180:183], v[180:183], a[108:111]
  v_mfma_f32_16x16x32_bf16 a[48:51], a[184:187], v[160:163], a[48:51]
  ds_read_b128 a[152:155], v3 offset:6144
  v_mfma_f32_16x16x32_bf16 a[52:55], a[184:187], v[164:167], a[52:55]
  v_mfma_f32_16x16x32_bf16 a[112:115], a[184:187], v[176:179], a[112:115]
  buffer_load_dwordx4 v2, s[44:47], s26 offen offset:3072 sc1 lds
  v_mfma_f32_16x16x32_bf16 a[116:119], a[184:187], v[180:183], a[116:119]
  s_add_u32 s26, s26, 16384
  v_mfma_f32_16x16x32_bf16 a[56:59], a[188:191], v[160:163], a[56:59]
  s_add_u32 s24, s24, 32768
  ds_read_b128 a[156:159], v3 offset:7168
  v_mfma_f32_16x16x32_bf16 a[60:63], a[188:191], v[164:167], a[60:63]
  s_and_b32 s24, s24, 0x1ffff
  v_exp_f32 v216, v128
  v_mfma_f32_16x16x32_bf16 a[120:123], a[188:191], v[176:179], a[120:123]
  s_waitcnt lgkmcnt(4)
  v_cvt_pk_bf16_f32 v191, v222, v223
  v_mfma_f32_16x16x32_bf16 a[124:127], a[188:191], v[180:183], a[124:127]
  s_cbranch_vccnz fa_stub6
fa_back6:
  v_exp_f32 v217, v129
  v_add_f32 v230, v230, v226
  v_add_f32 v231, v231, v227
  v_mfma_f32_16x16x32_bf16 v[144:147], a[128:131], v[64:67], v[200:203]
  ds_read_b128 a[160:163], v3 offset:24576
  v_add_f32 v226, v216, v217
  v_mfma_f32_16x16x32_bf16 v[152:155], a[128:131], v[68:71], v[204:207]
  v_exp_f32 v218, v130
  v_mfma_f32_16x16x32_bf16 v[148:151], a[132:135], v[64:67], v[200:203]
  s_add_u32 s66, s66, 32768
  ds_read_b128 a[164:167], v3 offset:25600
  v_cvt_pk_bf16_f32 v176, v216, v217
  v_mfma_f32_16x16x32_bf16 v[156:159], a[132:135], v[68:71], v[204:207]
  s_mov_b32 m0, s25
  v_exp_f32 v219, v131
  v_mfma_f32_16x16x32_bf16 v[144:147], a[136:139], v[72:75], v[144:147]
  s_and_b32 s66, s66, 0x1ffff
  ds_read_b128 a[168:171], v3 offset:26624
  buffer_load_dwordx4 v2, s[48:51], s27 offen offset:0 sc1 lds
  v_add_f32 v226, v226, v218
  v_add_f32 v226, v226, v219
  v_mfma_f32_16x16x32_bf16 v[152:155], a[136:139], v[76:79], v[152:155]
  v_exp_f32 v220, v132
  v_mfma_f32_16x16x32_bf16 v[148:151], a[140:143], v[72:75], v[148:151]
  ds_read_b128 a[172:175], v3 offset:27648
  v_cvt_pk_bf16_f32 v177, v218, v219
  v_mfma_f32_16x16x32_bf16 v[156:159], a[140:143], v[76:79], v[156:159]
  s_waitcnt lgkmcnt(4)
  v_exp_f32 v221, v133
  v_mfma_f32_16x16x32_bf16 v[144:147], a[144:147], v[80:83], v[144:147]
  ds_read_b128 a[176:179], v3 offset:28672
  v_add_f32 v226, v226, v220
  v_mfma_f32_16x16x32_bf16 v[152:155], a[144:147], v[84:87], v[152:155]
  v_exp_f32 v222, v134
  v_mfma_f32_16x16x32_bf16 v[148:151], a[148:151], v[80:83], v[148:151]
  ds_read_b128 a[180:183], v3 offset:29696
  buffer_load_dwordx4 v2, s[48:51], s27 offen offset:1024 sc1 lds
  v_add_f32 v226, v226, v221
  v_cvt_pk_bf16_f32 v178, v220, v221
  v_mfma_f32_16x16x32_bf16 v[156:159], a[148:151], v[84:87], v[156:159]
  v_exp_f32 v223, v135
  v_mfma_f32_16x16x32_bf16 v[144:147], a[152:155], v[88:91], v[144:147]
  ds_read_b128 a[184:187], v3 offset:30720
  v_add_f32 v226, v226, v222
  v_mfma_f32_16x16x32_bf16 v[152:155], a[152:155], v[92:95], v[152:155]
  v_exp_f32 v216, v136
  v_mfma_f32_16x16x32_bf16 v[148:151], a[156:159], v[88:91], v[148:151]
  ds_read_b128 a[188:191], v3 offset:31744
  v_add_f32 v226, v226, v223
  v_exp_f32 v217, v137
  v_mfma_f32_16x16x32_bf16 v[156:159], a[156:159], v[92:95], v[156:159]
  s_waitcnt lgkmcnt(4)
  v_exp_f32 v218, v138
  v_mfma_f32_16x16x32_bf16 a[64:67], a[160:163], v[184:187], a[64:67]
  ds_read_b128 a[128:131], v3 offset:8192
  v_cvt_pk_bf16_f32 v179, v222, v223
  v_mfma_f32_16x16x32_bf16 a[68:71], a[160:163], v[188:191], a[68:71]
  v_exp_f32 v219, v139
  v_mfma_f32_16x16x32_bf16 a[72:75], a[164:167], v[184:187], a[72:75]
  ds_read_b128 a[132:135], v3 offset:9216
  buffer_load_dwordx4 v2, s[48:51], s27 offen offset:2048 sc1 lds
  v_add_f32 v227, v216, v217
  v_mfma_f32_16x16x32_bf16 a[76:79], a[164:167], v[188:191], a[76:79]
  v_exp_f32 v220, v140
  v_mfma_f32_16x16x32_bf16 a[80:83], a[168:171], v[184:187], a[80:83]
  ds_read_b128 a[136:139], v3 offset:10240
  v_cvt_pk_bf16_f32 v180, v216, v217
  v_mfma_f32_16x16x32_bf16 a[84:87], a[168:171], v[188:191], a[84:87]
  v_exp_f32 v221, v141
  v_mfma_f32_16x16x32_bf16 a[88:91], a[172:175], v[184:187], a[88:91]
  ds_read_b128 a[140:143], v3 offset:11264
  v_add_f32 v227, v227, v218
  v_mfma_f32_16x16x32_bf16 a[92:95], a[172:175], v[188:191], a[92:95]
  s_waitcnt lgkmcnt(4)
  v_exp_f32 v222, v142
  v_mfma_f32_16x16x32_bf16 a[96:99], a[176:179], v[184:187], a[96:99]
  ds_read_b128 a[144:147], v3 offset:12288
  buffer_load_dwordx4 v2, s[48:51], s27 offen offset:3072 sc1 lds
  v_add_f32 v227, v227, v219
  v_cvt_pk_bf16_f32 v181, v218, v219
  v_mfma_f32_16x16x32_bf16 a[100:103], a[176:179], v[188:191], a[100:103]
  s_add_u32 s27, s27, 16384
  v_exp_f32 v223, v143
  v_mfma_f32_16x16x32_bf16 a[104:107], a[180:183], v[184:187], a[104:107]
  s_add_u32 s25, s25, 32768
  ds_read_b128 a[148:151], v3 offset:13312
  v_add_f32 v227, v227, v220
  v_mfma_f32_16x16x32_bf16 a[108:111], a[180:183], v[188:191], a[108:111]
  s_and_b32 s25, s25, 0x1ffff
  v_add_f32 v227, v227, v221
  v_cvt_pk_bf16_f32 v182, v220, v221
  v_add_f32 v227, v227, v222
  v_mfma_f32_16x16x32_bf16 a[112:115], a[184:187], v[184:187], a[112:115]
  ds_read_b128 a[152:155], v3 offset:14336
  v_add_f32 v227, v227, v223
  v_max_f32 v5, v226, v227
  v_cmp_lt_f32 vcc, s81, v5
  v_mfma_f32_16x16x32_bf16 a[116:119], a[184:187], v[188:191], a[116:119]
  v_exp_f32 v216, v144
  v_mfma_f32_16x16x32_bf16 a[120:123], a[188:191], v[184:187], a[120:123]
  s_waitcnt lgkmcnt(3)
  ds_read_b128 a[156:159], v3 offset:15360
  v_cvt_pk_bf16_f32 v183, v222, v223
  v_add_u32 v3, s66, v2
  v_mfma_f32_16x16x32_bf16 a[124:127], a[188:191], v[188:191], a[124:127]
  s_cbranch_vccnz fa_stub7
fa_back7:
  v_exp_f32 v217, v145
  v_add_f32 v230, v230, v226
  v_add_f32 v231, v231, v227
  s_branch fa_SSpre
fa_Aodd:
  v_mfma_f32_16x16x32_bf16 v[128:131], a[128:131], v[64:67], v[200:203]
  s_waitcnt vmcnt(12)
  v_exp_f32 v218, v146
  v_add_f32 v226, v216, v217
  v_mfma_f32_16x16x32_bf16 v[136:139], a[128:131], v[68:71], v[204:207]
  s_barrier
  v_exp_f32 v219, v147
  v_cvt_pk_bf16_f32 v184, v216, v217
  v_mfma_f32_16x16x32_bf16 v[132:135], a[132:135], v[64:67], v[200:203]
  ds_read_b128 a[160:163], v3 offset:16384
  ds_read_b128 a[164:167], v3 offset:17408
  v_exp_f32 v220, v148
  v_mfma_f32_16x16x32_bf16 v[140:143], a[132:135], v[68:71], v[204:207]
  v_exp_f32 v221, v149
  v_add_f32 v226, v226, v218
  v_mfma_f32_16x16x32_bf16 v[128:131], a[136:139], v[72:75], v[128:131]
  ds_read_b128 a[168:171], v3 offset:18432
  v_add_f32 v226, v226, v219
  v_cvt_pk_bf16_f32 v185, v218, v219
  v_mfma_f32_16x16x32_bf16 v[136:139], a[136:139], v[76:79], v[136:139]
  s_mov_b32 m0, s24
  v_exp_f32 v222, v150
  v_add_f32 v226, v226, v220
  v_mfma_f32_16x16x32_bf16 v[132:135], a[140:143], v[72:75], v[132:135]
  ds_read_b128 a[172:175], v3 offset:19456
  buffer_load_dwordx4 v2, s[44:47], s26 offen offset:0 sc1 lds
  v_add_f32 v226, v226, v221
  v_cvt_pk_bf16_f32 v186, v220, v221
  v_mfma_f32_16x16x32_bf16 v[140:143], a[140:143], v[76:79], v[140:143]
  s_waitcnt lgkmcnt(4)
  v_exp_f32 v223, v151
  v_cndmask_b32 v112, v4, v112, s[68:69]
  v_mfma_f32_16x16x32_bf16 v[128:131], a[144:147], v[80:83], v[128:131]
  ds_read_b128 a[176:179], v3 offset:20480
  v_cndmask_b32 v113, v4, v113, s[70:71]
  v_cndmask_b32 v114, v4, v114, s[72:73]
  v_mfma_f32_16x16x32_bf16 v[136:139], a[144:147], v[84:87], v[136:139]
  v_exp_f32 v216, v152
  v_cndmask_b32 v115, v4, v115, s[74:75]
  v_mfma_f32_16x16x32_bf16 v[132:135], a[148:151], v[80:83], v[132:135]
  ds_read_b128 a[180:183], v3 offset:21504
  v_mov_b32 v116, v4
  v_mov_b32 v117, v4
  v_mfma_f32_16x16x32_bf16 v[140:143], a[148:151], v[84:87], v[140:143]
  v_exp_f32 v217, v153
  v_mov_b32 v118, v4
  v_mfma_f32_16x16x32_bf16 v[128:131], a[152:155], v[88:91], v[128:131]
  ds_read_b128 a[184:187], v3 offset:22528
  v_mov_b32 v119, v4
  v_cndmask_b32 v124, v4, v124, s[68:69]
  v_mfma_f32_16x16x32_bf16 v[136:139], a[152:155], v[92:95], v[136:139]
  v_exp_f32 v218, v154
  v_cndmask_b32 v125, v4, v125, s[70:71]
  v_mfma_f32_16x16x32_bf16 v[132:135], a[156:159], v[88:91], v[132:135]
  ds_read_b128 a[188:191], v3 offset:23552
  v_cndmask_b32 v126, v4, v126, s[72:73]
  v_cndmask_b32 v127, v4, v127, s[74:75]
  v_mfma_f32_16x16x32_bf16 v[140:143], a[156:159], v[92:95], v[140:143]
  s_waitcnt lgkmcnt(4)
  v_exp_f32 v219, v155
  v_add_f32 v226, v226, v222
  v_mfma_f32_16x16x32_bf16 a[0:3], a[160:163], v[160:163], a[0:3]
  ds_read_b128 a[128:131], v3 offset:0
  v_add_f32 v226, v226, v223
  v_cvt_pk_bf16_f32 v187, v222, v223
  v_mfma_f32_16x16x32_bf16 a[4:7], a[160:163], v[164:167], a[4:7]
  v_exp_f32 v220, v156
  v_add_f32 v227, v216, v217
  v_mfma_f32_16x16x32_bf16 a[64:67], a[160:163], v[176:179], a[64:67]
  buffer_load_dwordx4 v2, s[44:47], s26 offen offset:1024 sc1 lds
  v_exp_f32 v221, v157
  v_mfma_f32_16x16x32_bf16 a[68:71], a[160:163], v[180:183], a[68:71]
  v_exp_f32 v222, v158
  v_mfma_f32_16x16x32_bf16 a[8:11], a[164:167], v[160:163], a[8:11]
  ds_read_b128 a[132:135], v3 offset:1024
  v_cvt_pk_bf16_f32 v188, v216, v217
  v_add_f32 v227, v227, v218
  v_add_f32 v227, v227, v219
  v_mfma_f32_16x16x32_bf16 a[12:15], a[164:167], v[164:167], a[12:15]
  v_exp_f32 v223, v159
  v_mfma_f32_16x16x32_bf16 a[72:75], a[164:167], v[176:179], a[72:75]
  v_exp_f32 v208, v112
  v_mfma_f32_16x16x32_bf16 a[76:79], a[164:167], v[180:183], a[76:79]
  v_exp_f32 v209, v113
  v_mfma_f32_16x16x32_bf16 a[16:19], a[168:171], v[160:163], a[16:19]
  ds_read_b128 a[136:139], v3 offset:2048
  v_cvt_pk_bf16_f32 v189, v218, v219
  v_add_f32 v227, v227, v220
  v_add_f32 v227, v227, v221
  v_cvt_pk_bf16_f32 v190, v220, v221
  v_add_f32 v227, v227, v222
  v_mfma_f32_16x16x32_bf16 a[20:23], a[168:171], v[164:167], a[20:23]
  v_exp_f32 v210, v114
  v_mfma_f32_16x16x32_bf16 a[80:83], a[168:171], v[176:179], a[80:83]
  v_exp_f32 v211, v115
  v_mfma_f32_16x16x32_bf16 a[84:87], a[168:171], v[180:183], a[84:87]
  v_exp_f32 v212, v116
  v_mfma_f32_16x16x32_bf16 a[24:27], a[172:175], v[160:163], a[24:27]
  ds_read_b128 a[140:143], v3 offset:3072
  v_add_f32 v227, v227, v223
  v_cvt_pk_bf16_f32 v191, v222, v223
  v_add_f32 v224, v208, v209
  v_cvt_pk_bf16_f32 v168, v208, v209
  v_add_f32 v224, v224, v210
  v_mfma_f32_16x16x32_bf16 a[28:31], a[172:175], v[164:167], a[28:31]
  v_exp_f32 v213, v117
  v_mfma_f32_16x16x32_bf16 a[88:91], a[172:175], v[176:179], a[88:91]
  buffer_load_dwordx4 v2, s[44:47], s26 offen offset:2048 sc1 lds
  v_exp_f32 v214, v118
  v_mfma_f32_16x16x32_bf16 a[92:95], a[172:175], v[180:183], a[92:95]
  s_waitcnt lgkmcnt(4)
  v_exp_f32 v215, v119
  v_mfma_f32_16x16x32_bf16 a[32:35], a[176:179], v[160:163], a[32:35]
  ds_read_b128 a[144:147], v3 offset:4096
  v_add_f32 v224, v224, v211
  v_cvt_pk_bf16_f32 v169, v210, v211
  v_add_f32 v224, v224, v212
  v_add_f32 v224, v224, v213
  v_mfma_f32_16x16x32_bf16 a[36:39], a[176:179], v[164:167], a[36:39]
  v_exp_f32 v208, v120
  v_mfma_f32_16x16x32_bf16 a[96:99], a[176:179], v[176:179], a[96:99]
  v_exp_f32 v209, v121
  v_mfma_f32_16x16x32_bf16 a[100:103], a[176:179], v[180:183], a[100:103]
  v_exp_f32 v210, v122
  v_mfma_f32_16x16x32_bf16 a[40:43], a[180:183], v[160:163], a[40:43]
  ds_read_b128 a[148:151], v3 offset:5120
  v_cvt_pk_bf16_f32 v170, v212, v213
  v_add_f32 v224, v224, v214
  v_add_f32 v224, v224, v215
  v_cvt_pk_bf16_f32 v171, v214, v215
  v_add_f32 v225, v208, v209
  v_mfma_f32_16x16x32_bf16 a[44:47], a[180:183], v[164:167], a[44:47]
  v_exp_f32 v211, v123
  v_mfma_f32_16x16x32_bf16 a[104:107], a[180:183], v[176:179], a[104:107]
  v_exp_f32 v212, v124
  v_mfma_f32_16x16x32_bf16 a[108:111], a[180:183], v[180:183], a[108:111]
  v_exp_f32 v213, v125
  v_mfma_f32_16x16x32_bf16 a[48:51], a[184:187], v[160:163], a[48:51]
  ds_read_b128 a[152:155], v3 offset:6144
  v_cvt_pk_bf16_f32 v172, v208, v209
  v_add_f32 v225, v225, v210
  v_add_f32 v225, v225, v211
  v_cvt_pk_bf16_f32 v173, v210, v211
  v_max3_f32 v5, v226, v227, v224
  v_mfma_f32_16x16x32_bf16 a[52:55], a[184:187], v[164:167], a[52:55]
  v_exp_f32 v214, v126
  v_mfma_f32_16x16x32_bf16 a[112:115], a[184:187], v[176:179], a[112:115]
  buffer_load_dwordx4 v2, s[44:47], s26 offen offset:3072 sc1 lds
  v_add_f32 v225, v225, v212
  v_add_f32 v225, v225, v213
  v_cvt_pk_bf16_f32 v174, v212, v213
  v_mfma_f32_16x16x32_bf16 a[116:119], a[184:187], v[180:183], a[116:119]
  s_add_u32 s26, s26, 16384
  v_exp_f32 v215, v127
  v_mfma_f32_16x16x32_bf16 a[56:59], a[188:191], v[160:163], a[56:59]
  s_add_u32 s24, s24, 32768
  ds_read_b128 a[156:159], v3 offset:7168
  v_add_f32 v225, v225, v214
  v_add_f32 v225, v225, v215
  v_max_f32 v5, v5, v225
  v_cmp_lt_f32 vcc, s81, v5
  v_mfma_f32_16x16x32_bf16 a[60:63], a[188:191], v[164:167], a[60:63]
  s_and_b32 s24, s24, 0x1ffff
  v_exp_f32 v216, v128
  v_mfma_f32_16x16x32_bf16 a[120:123], a[188:191], v[176:179], a[120:123]
  s_waitcnt lgkmcnt(4)
  v_cvt_pk_bf16_f32 v175, v214, v215
  v_mfma_f32_16x16x32_bf16 a[124:127], a[188:191], v[180:183], a[124:127]
  s_cbranch_vccnz fa_stub8
fa_back8:
  v_exp_f32 v217, v129
  v_add_f32 v228, v228, v224
  v_add_f32 v229, v229, v225
  v_add_f32 v230, v230, v226
  v_add_f32 v231, v231, v227
  v_mfma_f32_16x16x32_bf16 v[144:147], a[128:131], v[64:67], v[200:203]
  ds_read_b128 a[160:163], v3 offset:24576
  v_add_f32 v226, v216, v217
  v_mfma_f32_16x16x32_bf16 v[152:155], a[128:131], v[68:71], v[204:207]
  v_exp_f32 v218, v130
  v_mfma_f32_16x16x32_bf16 v[148:151], a[132:135], v[64:67], v[200:203]
  s_add_u32 s66, s66, 32768
  ds_read_b128 a[164:167], v3 offset:25600
  v_cvt_pk_bf16_f32 v176, v216, v217
  v_mfma_f32_16x16x32_bf16 v[156:159], a[132:135], v[68:71], v[204:207]
  s_and_b32 s66, s66, 0x1ffff
  v_exp_f32 v219, v131
  v_mfma_f32_16x16x32_bf16 v[144:147], a[136:139], v[72:75], v[144:147]
  ds_read_b128 a[168:171], v3 offset:26624
  v_add_f32 v226, v226, v218
  v_mfma_f32_16x16x32_bf16 v[152:155], a[136:139], v[76:79], v[152:155]
  s_mov_b32 m0, s25
  v_exp_f32 v220, v132
  v_mfma_f32_16x16x32_bf16 v[148:151], a[140:143], v[72:75], v[148:151]
  ds_read_b128 a[172:175], v3 offset:27648
  buffer_load_dwordx4 v2, s[48:51], s27 offen offset:0 sc1 lds
  v_add_f32 v226, v226, v219
  v_mfma_f32_16x16x32_bf16 v[156:159], a[140:143], v[76:79], v[156:159]
  s_waitcnt lgkmcnt(4)
  v_exp_f32 v221, v133
  v_mfma_f32_16x16x32_bf16 v[144:147], a[144:147], v[80:83], v[144:147]
  ds_read_b128 a[176:179], v3 offset:28672
  v_cvt_pk_bf16_f32 v177, v218, v219
  v_mfma_f32_16x16x32_bf16 v[152:155], a[144:147], v[84:87], v[152:155]
  v_exp_f32 v222, v134
  v_mfma_f32_16x16x32_bf16 v[148:151], a[148:151], v[80:83], v[148:151]
  ds_read_b128 a[180:183], v3 offset:29696
  v_add_f32 v226, v226, v220
  v_mfma_f32_16x16x32_bf16 v[156:159], a[148:151], v[84:87], v[156:159]
  v_exp_f32 v223, v135
  v_mfma_f32_16x16x32_bf16 v[144:147], a[152:155], v[88:91], v[144:147]
  ds_read_b128 a[184:187], v3 offset:30720
  v_add_f32 v226, v226, v221
  v_mfma_f32_16x16x32_bf16 v[152:155], a[152:155], v[92:95], v[152:155]
  v_exp_f32 v216, v136
  v_mfma_f32_16x16x32_bf16 v[148:151], a[156:159], v[88:91], v[148:151]
  ds_read_b128 a[188:191], v3 offset:31744
  v_cvt_pk_bf16_f32 v178, v220, v221
  v_mfma_f32_16x16x32_bf16 v[156:159], a[156:159], v[92:95], v[156:159]
  s_waitcnt lgkmcnt(4)
  v_exp_f32 v217, v137
  v_mfma_f32_16x16x32_bf16 a[0:3], a[160:163], v[168:171], a[0:3]
  ds_read_b128 a[128:131], v3 offset:8192
  v_add_f32 v226, v226, v222
  v_mfma_f32_16x16x32_bf16 a[4:7], a[160:163], v[172:175], a[4:7]
  v_exp_f32 v218, v138
  v_mfma_f32_16x16x32_bf16 a[64:67], a[160:163], v[184:187], a[64:67]
  buffer_load_dwordx4 v2, s[48:51], s27 offen offset:1024 sc1 lds
  v_add_f32 v226, v226, v223
  v_mfma_f32_16x16x32_bf16 a[68:71], a[160:163], v[188:191], a[68:71]
  v_exp_f32 v219, v139
  v_mfma_f32_16x16x32_bf16 a[8:11], a[164:167], v[168:171], a[8:11]
  ds_read_b128 a[132:135], v3 offset:9216
  v_cvt_pk_bf16_f32 v179, v222, v223
  v_mfma_f32_16x16x32_bf16 a[12:15], a[164:167], v[172:175], a[12:15]
  v_exp_f32 v220, v140
  v_mfma_f32_16x16x32_bf16 a[72:75], a[164:167], v[184:187], a[72:75]
  v_add_f32 v227, v216, v217
  v_cvt_pk_bf16_f32 v180, v216, v217
  v_mfma_f32_16x16x32_bf16 a[76:79], a[164:167], v[188:191], a[76:79]
  v_exp_f32 v221, v141
  v_mfma_f32_16x16x32_bf16 a[16:19], a[168:171], v[168:171], a[16:19]
  ds_read_b128 a[136:139], v3 offset:10240
  v_add_f32 v227, v227, v218
  v_mfma_f32_16x16x32_bf16 a[20:23], a[168:171], v[172:175], a[20:23]
  v_exp_f32 v222, v142
  v_mfma_f32_16x16x32_bf16 a[80:83], a[168:171], v[184:187], a[80:83]
  v_add_f32 v227, v227, v219
  v_cvt_pk_bf16_f32 v181, v218, v219
  v_mfma_f32_16x16x32_bf16 a[84:87], a[168:171], v[188:191], a[84:87]
  v_exp_f32 v223, v143
  v_mfma_f32_16x16x32_bf16 a[24:27], a[172:175], v[168:171], a[24:27]
  ds_read_b128 a[140:143], v3 offset:11264
  v_add_f32 v227, v227, v220
  v_mfma_f32_16x16x32_bf16 a[28:31], a[172:175], v[172:175], a[28:31]
  v_add_f32 v227, v227, v221
  v_cvt_pk_bf16_f32 v182, v220, v221
  v_mfma_f32_16x16x32_bf16 a[88:91], a[172:175], v[184:187], a[88:91]
  buffer_load_dwordx4 v2, s[48:51], s27 offen offset:2048 sc1 lds
  v_add_f32 v227, v227, v222
  v_mfma_f32_16x16x32_bf16 a[92:95], a[172:175], v[188:191], a[92:95]
  s_waitcnt lgkmcnt(4)
  v_add_f32 v227, v227, v223
  v_max_f32 v5, v226, v227
  v_mfma_f32_16x16x32_bf16 a[32:35], a[176:179], v[168:171], a[32:35]
  ds_read_b128 a[144:147], v3 offset:12288
  v_cmp_lt_f32 vcc, s81, v5
  v_mfma_f32_16x16x32_bf16 a[36:39], a[176:179], v[172:175], a[36:39]
  v_mfma_f32_16x16x32_bf16 a[96:99], a[176:179], v[184:187], a[96:99]
  v_mfma_f32_16x16x32_bf16 a[100:103], a[176:179], v[188:191], a[100:103]
  v_mfma_f32_16x16x32_bf16 a[40:43], a[180:183], v[168:171], a[40:43]
  ds_read_b128 a[148:151], v3 offset:13312
  v_mfma_f32_16x16x32_bf16 a[44:47], a[180:183], v[172:175], a[44:47]
  v_mfma_f32_16x16x32_bf16 a[104:107], a[180:183], v[184:187], a[104:107]
  v_mfma_f32_16x16x32_bf16 a[108:111], a[180:183], v[188:191], a[108:111]
  v_mfma_f32_16x16x32_bf16 a[48:51], a[184:187], v[168:171], a[48:51]
  ds_read_b128 a[152:155], v3 offset:14336
  v_mfma_f32_16x16x32_bf16 a[52:55], a[184:187], v[172:175], a[52:55]
  v_mfma_f32_16x16x32_bf16 a[112:115], a[184:187], v[184:187], a[112:115]
  buffer_load_dwordx4 v2, s[48:51], s27 offen offset:3072 sc1 lds
  v_mfma_f32_16x16x32_bf16 a[116:119], a[184:187], v[188:191], a[116:119]
  s_add_u32 s27, s27, 16384
  v_mfma_f32_16x16x32_bf16 a[56:59], a[188:191], v[168:171], a[56:59]
  s_add_u32 s25, s25, 32768
  ds_read_b128 a[156:159], v3 offset:15360
  v_mfma_f32_16x16x32_bf16 a[60:63], a[188:191], v[172:175], a[60:63]
  s_and_b32 s25, s25, 0x1ffff
  v_exp_f32 v216, v144
  v_mfma_f32_16x16x32_bf16 a[120:123], a[188:191], v[184:187], a[120:123]
  s_waitcnt lgkmcnt(4)
  v_cvt_pk_bf16_f32 v183, v222, v223
  v_add_u32 v3, s66, v2
  v_mfma_f32_16x16x32_bf16 a[124:127], a[188:191], v[188:191], a[124:127]
  s_cbranch_vccnz fa_stub9
fa_back9:
  v_exp_f32 v217, v145
  v_add_f32 v230, v230, v226
  v_add_f32 v231, v231, v227
fa_SSpre:
  s_mov_b32 s11, 1
  s_cmp_lg_u32 s12, 0
  s_cselect_b32 s32, s15, s32
  s_cmp_ge_u32 s20, 2
  s_cselect_b32 s23, 8, 0
  s_cmp_le_u32 s29, s23
  s_cbranch_scc1 fa_chain
.p2align 6
fa_SS:
  v_mfma_f32_16x16x32_bf16 v[128:131], a[128:131], v[64:67], v[200:203]
  s_waitcnt vmcnt(12)
  v_exp_f32 v218, v146
  v_mfma_f32_16x16x32_bf16 v[136:139], a[128:131], v[68:71], v[204:207]
  s_barrier
  v_exp_f32 v219, v147
  v_mfma_f32_16x16x32_bf16 v[132:135], a[132:135], v[64:67], v[200:203]
  s_cmp_ge_u32 s26, s32
  ds_read_b128 a[160:163], v3 offset:16384
  ds_read_b128 a[164:167], v3 offset:17408
  v_add_f32 v226, v216, v217
  v_mfma_f32_16x16x32_bf16 v[140:143], a[132:135], v[68:71], v[204:207]
  s_cbranch_scc1 fa_hk7
fa_hb7:
  v_exp_f32 v220, v148
  v_mfma_f32_16x16x32_bf16 v[128:131], a[136:139], v[72:75], v[128:131]
  ds_read_b128 a[168:171], v3 offset:18432
  v_cvt_pk_bf16_f32 v184, v216, v217
  v_mfma_f32_16x16x32_bf16 v[136:139], a[136:139], v[76:79], v[136:139]
  s_mov_b32 m0, s24
  v_exp_f32 v221, v149
  v_mfma_f32_16x16x32_bf16 v[132:135], a[140:143], v[72:75], v[132:135]
  ds_read_b128 a[172:175], v3 offset:19456
  buffer_load_dwordx4 v2, s[44:47], s26 offen offset:0 sc1 lds
  v_add_f32 v226, v226, v218
  v_add_f32 v226, v226, v219
  v_mfma_f32_16x16x32_bf16 v[140:143], a[140:143], v[76:79], v[140:143]
  s_waitcnt lgkmcnt(4)
  v_exp_f32 v222, v150
  v_mfma_f32_16x16x32_bf16 v[128:131], a[144:147], v[80:83], v[128:131]
  ds_read_b128 a[176:179], v3 offset:20480
  v_cvt_pk_bf16_f32 v185, v218, v219
  v_mfma_f32_16x16x32_bf16 v[136:139], a[144:147], v[84:87], v[136:139]
  v_exp_f32 v223, v151
  v_mfma_f32_16x16x32_bf16 v[132:135], a[148:151], v[80:83], v[132:135]
  ds_read_b128 a[180:183], v3 offset:21504
  v_add_f32 v226, v226, v220
  v_mfma_f32_16x16x32_bf16 v[140:143], a[148:151], v[84:87], v[140:143]
  v_exp_f32 v216, v152
  v_mfma_f32_16x16x32_bf16 v[128:131], a[152:155], v[88:91], v[128:131]
  ds_read_b128 a[184:187], v3 offset:22528
  buffer_load_dwordx4 v2, s[44:47], s26 offen offset:1024 sc1 lds
  v_add_f32 v226, v226, v221
  v_cvt_pk_bf16_f32 v186, v220, v221
  v_mfma_f32_16x16x32_bf16 v[136:139], a[152:155], v[92:95], v[136:139]
  v_exp_f32 v217, v153
  v_mfma_f32_16x16x32_bf16 v[132:135], a[156:159], v[88:91], v[132:135]
  ds_read_b128 a[188:191], v3 offset:23552
  v_add_f32 v226, v226, v222
  v_mfma_f32_16x16x32_bf16 v[140:143], a[156:159], v[92:95], v[140:143]
  s_waitcnt lgkmcnt(4)
  v_exp_f32 v218, v154
  v_mfma_f32_16x16x32_bf16 a[64:67], a[160:163], v[176:179], a[64:67]
  ds_read_b128 a[128:131], v3 offset:0
  v_add_f32 v226, v226, v223
  v_cvt_pk_bf16_f32 v187, v222, v223
  v_mfma_f32_16x16x32_bf16 a[68:71], a[160:163], v[180:183], a[68:71]
  v_exp_f32 v219, v155
  v_mfma_f32_16x16x32_bf16 a[72:75], a[164:167], v[176:179], a[72:75]
  ds_read_b128 a[132:135], v3 offset:1024
  buffer_load_dwordx4 v2, s[44:47], s26 offen offset:2048 sc1 lds
  v_add_f32 v227, v216, v217
  v_mfma_f32_16x16x32_bf16 a[76:79], a[164:167], v[180:183], a[76:79]
  v_exp_f32 v220, v156
  v_mfma_f32_16x16x32_bf16 a[80:83], a[168:171], v[176:179], a[80:83]
  ds_read_b128 a[136:139], v3 offset:2048
  v_cvt_pk_bf16_f32 v188, v216, v217
  v_mfma_f32_16x16x32_bf16 a[84:87], a[168:171], v[180:183], a[84:87]
  v_exp_f32 v221, v157
  v_mfma_f32_16x16x32_bf16 a[88:91], a[172:175], v[176:179], a[88:91]
  ds_read_b128 a[140:143], v3 offset:3072
  v_add_f32 v227, v227, v218
  v_add_f32 v227, v227, v219
  v_mfma_f32_16x16x32_bf16 a[92:95], a[172:175], v[180:183], a[92:95]
  s_waitcnt lgkmcnt(4)
  v_exp_f32 v222, v158
  v_mfma_f32_16x16x32_bf16 a[96:99], a[176:179], v[176:179], a[96:99]
  ds_read_b128 a[144:147], v3 offset:4096
  buffer_load_dwordx4 v2, s[44:47], s26 offen offset:3072 sc1 lds
  v_cvt_pk_bf16_f32 v189, v218, v219
  v_mfma_f32_16x16x32_bf16 a[100:103], a[176:179], v[180:183], a[100:103]
  s_add_u32 s26, s26, 16384
  v_exp_f32 v223, v159
  v_mfma_f32_16x16x32_bf16 a[104:107], a[180:183], v[176:179], a[104:107]
  s_add_u32 s24, s24, 32768
  ds_read_b128 a[148:151], v3 offset:5120
  v_add_f32 v227, v227, v220
  v_mfma_f32_16x16x32_bf16 a[108:111], a[180:183], v[180:183], a[108:111]
  s_and_b32 s24, s24, 0x1ffff
  v_add_f32 v227, v227, v221
  v_cvt_pk_bf16_f32 v190, v220, v221
  v_add_f32 v227, v227, v222
  v_mfma_f32_16x16x32_bf16 a[112:115], a[184:187], v[176:179], a[112:115]
  ds_read_b128 a[152:155], v3 offset:6144
  v_add_f32 v227, v227, v223
  v_max_f32 v5, v226, v227
  v_cmp_lt_f32 vcc, s81, v5
  v_mfma_f32_16x16x32_bf16 a[116:119], a[184:187], v[180:183], a[116:119]
  v_exp_f32 v216, v128
  v_mfma_f32_16x16x32_bf16 a[120:123], a[188:191], v[176:179], a[120:123]
  s_waitcnt lgkmcnt(3)
  ds_read_b128 a[156:159], v3 offset:7168
  v_cvt_pk_bf16_f32 v191, v222, v223
  v_mfma_f32_16x16x32_bf16 a[124:127], a[188:191], v[180:183], a[124:127]
  s_cbranch_vccnz fa_stub10
fa_back10:
  v_exp_f32 v217, v129
  v_add_f32 v230, v230, v226
  v_add_f32 v231, v231, v227
  v_mfma_f32_16x16x32_bf16 v[144:147], a[128:131], v[64:67], v[200:203]
  ds_read_b128 a[160:163], v3 offset:24576
  v_add_f32 v226, v216, v217
  v_mfma_f32_16x16x32_bf16 v[152:155], a[128:131], v[68:71], v[204:207]
  v_exp_f32 v218, v130
  v_mfma_f32_16x16x32_bf16 v[148:151], a[132:135], v[64:67], v[200:203]
  s_add_u32 s66, s66, 32768
  ds_read_b128 a[164:167], v3 offset:25600
  v_cvt_pk_bf16_f32 v176, v216, v217
  v_mfma_f32_16x16x32_bf16 v[156:159], a[132:135], v[68:71], v[204:207]
  s_mov_b32 m0, s25
  v_exp_f32 v219, v131
  v_mfma_f32_16x16x32_bf16 v[144:147], a[136:139], v[72:75], v[144:147]
  s_and_b32 s66, s66, 0x1ffff
  ds_read_b128 a[168:171], v3 offset:26624
  buffer_load_dwordx4 v2, s[48:51], s27 offen offset:0 sc1 lds
  v_add_f32 v226, v226, v218
  v_add_f32 v226, v226, v219
  v_mfma_f32_16x16x32_bf16 v[152:155], a[136:139], v[76:79], v[152:155]
  v_exp_f32 v220, v132
  v_mfma_f32_16x16x32_bf16 v[148:151], a[140:143], v[72:75], v[148:151]
  ds_read_b128 a[172:175], v3 offset:27648
  v_cvt_pk_bf16_f32 v177, v218, v219
  v_mfma_f32_16x16x32_bf16 v[156:159], a[140:143], v[76:79], v[156:159]
  s_waitcnt lgkmcnt(4)
  v_exp_f32 v221, v133
  v_mfma_f32_16x16x32_bf16 v[144:147], a[144:147], v[80:83], v[144:147]
  ds_read_b128 a[176:179], v3 offset:28672
  v_add_f32 v226, v226, v220
  v_mfma_f32_16x16x32_bf16 v[152:155], a[144:147], v[84:87], v[152:155]
  v_exp_f32 v222, v134
  v_mfma_f32_16x16x32_bf16 v[148:151], a[148:151], v[80:83], v[148:151]
  ds_read_b128 a[180:183], v3 offset:29696
  buffer_load_dwordx4 v2, s[48:51], s27 offen offset:1024 sc1 lds
  v_add_f32 v226, v226, v221
  v_cvt_pk_bf16_f32 v178, v220, v221
  v_mfma_f32_16x16x32_bf16 v[156:159], a[148:151], v[84:87], v[156:159]
  v_exp_f32 v223, v135
  v_mfma_f32_16x16x32_bf16 v[144:147], a[152:155], v[88:91], v[144:147]
  ds_read_b128 a[184:187], v3 offset:30720
  v_add_f32 v226, v226, v222
  v_mfma_f32_16x16x32_bf16 v[152:155], a[152:155], v[92:95], v[152:155]
  v_exp_f32 v216, v136
  v_mfma_f32_16x16x32_bf16 v[148:151], a[156:159], v[88:91], v[148:151]
  ds_read_b128 a[188:191], v3 offset:31744
  v_add_f32 v226, v226, v223
  v_exp_f32 v217, v137
  v_mfma_f32_16x16x32_bf16 v[156:159], a[156:159], v[92:95], v[156:159]
  s_waitcnt lgkmcnt(4)
  v_exp_f32 v218, v138
  v_mfma_f32_16x16x32_bf16 a[64:67], a[160:163], v[184:187], a[64:67]
  ds_read_b128 a[128:131], v3 offset:8192
  v_cvt_pk_bf16_f32 v179, v222, v223
  v_mfma_f32_16x16x32_bf16 a[68:71], a[160:163], v[188:191], a[68:71]
  v_exp_f32 v219, v139
  v_mfma_f32_16x16x32_bf16 a[72:75], a[164:167], v[184:187], a[72:75]
  ds_read_b128 a[132:135], v3 offset:9216
  buffer_load_dwordx4 v2, s[48:51], s27 offen offset:2048 sc1 lds
  v_add_f32 v227, v216, v217
  v_mfma_f32_16x16x32_bf16 a[76:79], a[164:167], v[188:191], a[76:79]
  v_exp_f32 v220, v140
  v_mfma_f32_16x16x32_bf16 a[80:83], a[168:171], v[184:187], a[80:83]
  ds_read_b128 a[136:139], v3 offset:10240
  v_cvt_pk_bf16_f32 v180, v216, v217
  v_mfma_f32_16x16x32_bf16 a[84:87], a[168:171], v[188:191], a[84:87]
  v_exp_f32 v221, v141
  v_mfma_f32_16x16x32_bf16 a[88:91], a[172:175], v[184:187], a[88:91]
  ds_read_b128 a[140:143], v3 offset:11264
  v_add_f32 v227, v227, v218
  v_mfma_f32_16x16x32_bf16 a[92:95], a[172:175], v[188:191], a[92:95]
  s_waitcnt lgkmcnt(4)
  v_exp_f32 v222, v142
  v_mfma_f32_16x16x32_bf16 a[96:99], a[176:179], v[184:187], a[96:99]
  ds_read_b128 a[144:147], v3 offset:12288
  buffer_load_dwordx4 v2, s[48:51], s27 offen offset:3072 sc1 lds
  v_add_f32 v227, v227, v219
  v_cvt_pk_bf16_f32 v181, v218, v219
  v_mfma_f32_16x16x32_bf16 a[100:103], a[176:179], v[188:191], a[100:103]
  s_add_u32 s27, s27, 16384
  v_exp_f32 v223, v143
  v_mfma_f32_16x16x32_bf16 a[104:107], a[180:183], v[184:187], a[104:107]
  s_add_u32 s25, s25, 32768
  ds_read_b128 a[148:151], v3 offset:13312
  v_add_f32 v227, v227, v220
  v_mfma_f32_16x16x32_bf16 a[108:111], a[180:183], v[188:191], a[108:111]
  s_and_b32 s25, s25, 0x1ffff
  v_add_f32 v227, v227, v221
  v_cvt_pk_bf16_f32 v182, v220, v221
  v_add_f32 v227, v227, v222
  v_mfma_f32_16x16x32_bf16 a[112:115], a[184:187], v[184:187], a[112:115]
  s_sub_u32 s29, s29, 1
  ds_read_b128 a[152:155], v3 offset:14336
  v_add_f32 v227, v227, v223
  v_max_f32 v5, v226, v227
  v_cmp_lt_f32 vcc, s81, v5
  v_mfma_f32_16x16x32_bf16 a[116:119], a[184:187], v[188:191], a[116:119]
  s_cmp_gt_u32 s29, 8
  v_exp_f32 v216, v144
  v_mfma_f32_16x16x32_bf16 a[120:123], a[188:191], v[184:187], a[120:123]
  s_waitcnt lgkmcnt(3)
  ds_read_b128 a[156:159], v3 offset:15360
  v_cvt_pk_bf16_f32 v183, v222, v223
  v_add_u32 v3, s66, v2
  v_mfma_f32_16x16x32_bf16 a[124:127], a[188:191], v[188:191], a[124:127]
  s_cbranch_vccnz fa_stub11
fa_back11:
  v_exp_f32 v217, v145
  v_add_f32 v230, v230, v226
  v_add_f32 v231, v231, v227
  s_cbranch_scc1 fa_SS
fa_chain:
  s_setprio 3
fa_hb8:
  s_cmp_lt_u32 s12, 2
  s_cbranch_scc1 fa_hk8
  s_cmp_eq_u32 s29, 8
  s_cbranch_scc0 fa_disp
fa_SSW8:
  v_mfma_f32_16x16x32_bf16 v[128:131], a[128:131], v[64:67], v[200:203]
  s_waitcnt vmcnt(12)
  v_exp_f32 v218, v146
  v_mfma_f32_16x16x32_bf16 v[136:139], a[128:131], v[68:71], v[204:207]
  s_barrier
  v_exp_f32 v219, v147
  v_mfma_f32_16x16x32_bf16 v[132:135], a[132:135], v[64:67], v[200:203]
  ds_read_b128 a[160:163], v3 offset:16384
  ds_read_b128 a[164:167], v3 offset:17408
  v_add_f32 v226, v216, v217
  v_mfma_f32_16x16x32_bf16 v[140:143], a[132:135], v[68:71], v[204:207]
  s_mov_b32 m0, s24
  v_exp_f32 v220, v148
  v_mfma_f32_16x16x32_bf16 v[128:131], a[136:139], v[72:75], v[128:131]
  ds_read_b128 a[168:171], v3 offset:18432
  buffer_load_dwordx4 v2, s[44:47], s26 offen offset:0 sc1 lds
  v_cvt_pk_bf16_f32 v184, v216, v217
  v_mfma_f32_16x16x32_bf16 v[136:139], a[136:139], v[76:79], v[136:139]
  v_exp_f32 v221, v149
  v_mfma_f32_16x16x32_bf16 v[132:135], a[140:143], v[72:75], v[132:135]
  ds_read_b128 a[172:175], v3 offset:19456
  v_add_f32 v226, v226, v218
  v_add_f32 v226, v226, v219
  v_mfma_f32_16x16x32_bf16 v[140:143], a[140:143], v[76:79], v[140:143]
  s_waitcnt lgkmcnt(4)
  v_exp_f32 v222, v150
  v_mfma_f32_16x16x32_bf16 v[128:131], a[144:147], v[80:83], v[128:131]
  ds_read_b128 a[176:179], v3 offset:20480
  v_cvt_pk_bf16_f32 v185, v218, v219
  v_mfma_f32_16x16x32_bf16 v[136:139], a[144:147], v[84:87], v[136:139]
  v_exp_f32 v223, v151
  v_mfma_f32_16x16x32_bf16 v[132:135], a[148:151], v[80:83], v[132:135]
  ds_read_b128 a[180:183], v3 offset:21504
  buffer_load_dwordx4 v2, s[44:47], s26 offen offset:1024 sc1 lds
  v_add_f32 v226, v226, v220
  v_mfma_f32_16x16x32_bf16 v[140:143], a[148:151], v[84:87], v[140:143]
  v_exp_f32 v216, v152
  v_mfma_f32_16x16x32_bf16 v[128:131], a[152:155], v[88:91], v[128:131]
  ds_read_b128 a[184:187], v3 offset:22528
  v_add_f32 v226, v226, v221
  v_cvt_pk_bf16_f32 v186, v220, v221
  v_mfma_f32_16x16x32_bf16 v[136:139], a[152:155], v[92:95], v[136:139]
  v_exp_f32 v217, v153
  v_mfma_f32_16x16x32_bf16 v[132:135], a[156:159], v[88:91], v[132:135]
  s_add_u32 s14, s13, 77824
  ds_read_b128 a[188:191], v3 offset:23552
  buffer_load_dwordx4 a[252:255], v2, s[40:43], s14 offen offset:3072 sc1
  v_add_f32 v226, v226, v222
  v_mfma_f32_16x16x32_bf16 v[140:143], a[156:159], v[92:95], v[140:143]
  s_waitcnt lgkmcnt(4)
  v_exp_f32 v218, v154
  v_mfma_f32_16x16x32_bf16 a[64:67], a[160:163], v[176:179], a[64:67]
  ds_read_b128 a[128:131], v3 offset:0
  v_add_f32 v226, v226, v223
  v_cvt_pk_bf16_f32 v187, v222, v223
  v_mfma_f32_16x16x32_bf16 a[68:71], a[160:163], v[180:183], a[68:71]
  v_exp_f32 v219, v155
  v_mfma_f32_16x16x32_bf16 a[72:75], a[164:167], v[176:179], a[72:75]
  ds_read_b128 a[132:135], v3 offset:1024
  buffer_load_dwordx4 v2, s[44:47], s26 offen offset:2048 sc1 lds
  v_add_f32 v227, v216, v217
  v_mfma_f32_16x16x32_bf16 a[76:79], a[164:167], v[180:183], a[76:79]
  v_exp_f32 v220, v156
  v_mfma_f32_16x16x32_bf16 a[80:83], a[168:171], v[176:179], a[80:83]
  ds_read_b128 a[136:139], v3 offset:2048
  v_cvt_pk_bf16_f32 v188, v216, v217
  v_mfma_f32_16x16x32_bf16 a[84:87], a[168:171], v[180:183], a[84:87]
  v_exp_f32 v221, v157
  v_mfma_f32_16x16x32_bf16 a[88:91], a[172:175], v[176:179], a[88:91]
  ds_read_b128 a[140:143], v3 offset:3072
  v_add_f32 v227, v227, v218
  v_add_f32 v227, v227, v219
  v_mfma_f32_16x16x32_bf16 a[92:95], a[172:175], v[180:183], a[92:95]
  s_waitcnt lgkmcnt(4)
  v_exp_f32 v222, v158
  v_mfma_f32_16x16x32_bf16 a[96:99], a[176:179], v[176:179], a[96:99]
  ds_read_b128 a[144:147], v3 offset:4096
  buffer_load_dwordx4 v2, s[44:47], s26 offen offset:3072 sc1 lds
  v_cvt_pk_bf16_f32 v189, v218, v219
  v_mfma_f32_16x16x32_bf16 a[100:103], a[176:179], v[180:183], a[100:103]
  s_add_u32 s26, s26, 16384
  v_exp_f32 v223, v159
  v_mfma_f32_16x16x32_bf16 a[104:107], a[180:183], v[176:179], a[104:107]
  s_add_u32 s24, s24, 32768
  ds_read_b128 a[148:151], v3 offset:5120
  v_add_f32 v227, v227, v220
  v_mfma_f32_16x16x32_bf16 a[108:111], a[180:183], v[180:183], a[108:111]
  s_and_b32 s24, s24, 0x1ffff
  v_add_f32 v227, v227, v221
  v_cvt_pk_bf16_f32 v190, v220, v221
  v_add_f32 v227, v227, v222
  v_mfma_f32_16x16x32_bf16 a[112:115], a[184:187], v[176:179], a[112:115]
  ds_read_b128 a[152:155], v3 offset:6144
  v_add_f32 v227, v227, v223
  v_max_f32 v5, v226, v227
  v_cmp_lt_f32 vcc, s81, v5
  v_mfma_f32_16x16x32_bf16 a[116:119], a[184:187], v[180:183], a[116:119]
  v_exp_f32 v216, v128
  v_mfma_f32_16x16x32_bf16 a[120:123], a[188:191], v[176:179], a[120:123]
  s_waitcnt lgkmcnt(3)
  ds_read_b128 a[156:159], v3 offset:7168
  v_cvt_pk_bf16_f32 v191, v222, v223
  v_mfma_f32_16x16x32_bf16 a[124:127], a[188:191], v[180:183], a[124:127]
  s_cbranch_vccnz fa_stub12
fa_back12:
  v_exp_f32 v217, v129
  v_add_f32 v230, v230, v226
  v_add_f32 v231, v231, v227
  v_mfma_f32_16x16x32_bf16 v[144:147], a[128:131], v[64:67], v[200:203]
  ds_read_b128 a[160:163], v3 offset:24576
  v_add_f32 v226, v216, v217
  v_mfma_f32_16x16x32_bf16 v[152:155], a[128:131], v[68:71], v[204:207]
  v_exp_f32 v218, v130
  v_mfma_f32_16x16x32_bf16 v[148:151], a[132:135], v[64:67], v[200:203]
  s_add_u32 s66, s66, 32768
  ds_read_b128 a[164:167], v3 offset:25600
  v_cvt_pk_bf16_f32 v176, v216, v217
  v_mfma_f32_16x16x32_bf16 v[156:159], a[132:135], v[68:71], v[204:207]
  s_mov_b32 m0, s25
  v_exp_f32 v219, v131
  v_mfma_f32_16x16x32_bf16 v[144:147], a[136:139], v[72:75], v[144:147]
  s_and_b32 s66, s66, 0x1ffff
  ds_read_b128 a[168:171], v3 offset:26624
  buffer_load_dwordx4 v2, s[48:51], s27 offen offset:0 sc1 lds
  v_add_f32 v226, v226, v218
  v_add_f32 v226, v226, v219
  v_mfma_f32_16x16x32_bf16 v[152:155], a[136:139], v[76:79], v[152:155]
  v_exp_f32 v220, v132
  v_mfma_f32_16x16x32_bf16 v[148:151], a[140:143], v[72:75], v[148:151]
  ds_read_b128 a[172:175], v3 offset:27648
  v_cvt_pk_bf16_f32 v177, v218, v219
  v_mfma_f32_16x16x32_bf16 v[156:159], a[140:143], v[76:79], v[156:159]
  s_waitcnt lgkmcnt(4)
  v_exp_f32 v221, v133
  v_mfma_f32_16x16x32_bf16 v[144:147], a[144:147], v[80:83], v[144:147]
  s_add_u32 s14, s13, 77824
  ds_read_b128 a[176:179], v3 offset:28672
  buffer_load_dwordx4 a[248:251], v2, s[40:43], s14 offen offset:2048 sc1
  v_add_f32 v226, v226, v220
  v_mfma_f32_16x16x32_bf16 v[152:155], a[144:147], v[84:87], v[152:155]
  v_exp_f32 v222, v134
  v_mfma_f32_16x16x32_bf16 v[148:151], a[148:151], v[80:83], v[148:151]
  ds_read_b128 a[180:183], v3 offset:29696
  buffer_load_dwordx4 v2, s[48:51], s27 offen offset:1024 sc1 lds
  v_add_f32 v226, v226, v221
  v_cvt_pk_bf16_f32 v178, v220, v221
  v_mfma_f32_16x16x32_bf16 v[156:159], a[148:151], v[84:87], v[156:159]
  v_exp_f32 v223, v135
  v_mfma_f32_16x16x32_bf16 v[144:147], a[152:155], v[88:91], v[144:147]
  ds_read_b128 a[184:187], v3 offset:30720
  v_add_f32 v226, v226, v222
  v_mfma_f32_16x16x32_bf16 v[152:155], a[152:155], v[92:95], v[152:155]
  v_exp_f32 v216, v136
  v_mfma_f32_16x16x32_bf16 v[148:151], a[156:159], v[88:91], v[148:151]
  ds_read_b128 a[188:191], v3 offset:31744
  v_add_f32 v226, v226, v223
  v_exp_f32 v217, v137
  v_mfma_f32_16x16x32_bf16 v[156:159], a[156:159], v[92:95], v[156:159]
  s_waitcnt lgkmcnt(4)
  v_exp_f32 v218, v138
  v_mfma_f32_16x16x32_bf16 a[64:67], a[160:163], v[184:187], a[64:67]
  ds_read_b128 a[128:131], v3 offset:8192
  v_cvt_pk_bf16_f32 v179, v222, v223
  v_mfma_f32_16x16x32_bf16 a[68:71], a[160:163], v[188:191], a[68:71]
  v_exp_f32 v219, v139
  v_mfma_f32_16x16x32_bf16 a[72:75], a[164:167], v[184:187], a[72:75]
  ds_read_b128 a[132:135], v3 offset:9216
  buffer_load_dwordx4 v2, s[48:51], s27 offen offset:2048 sc1 lds
  v_add_f32 v227, v216, v217
  v_mfma_f32_16x16x32_bf16 a[76:79], a[164:167], v[188:191], a[76:79]
  v_exp_f32 v220, v140
  v_mfma_f32_16x16x32_bf16 a[80:83], a[168:171], v[184:187], a[80:83]
  ds_read_b128 a[136:139], v3 offset:10240
  v_cvt_pk_bf16_f32 v180, v216, v217
  v_mfma_f32_16x16x32_bf16 a[84:87], a[168:171], v[188:191], a[84:87]
  v_exp_f32 v221, v141
  v_mfma_f32_16x16x32_bf16 a[88:91], a[172:175], v[184:187], a[88:91]
  ds_read_b128 a[140:143], v3 offset:11264
  buffer_load_dwordx4 a[244:247], v2, s[40:43], s14 offen offset:1024 sc1
  v_add_f32 v227, v227, v218
  v_mfma_f32_16x16x32_bf16 a[92:95], a[172:175], v[188:191], a[92:95]
  s_waitcnt lgkmcnt(4)
  v_exp_f32 v222, v142
  v_mfma_f32_16x16x32_bf16 a[96:99], a[176:179], v[184:187], a[96:99]
  ds_read_b128 a[144:147], v3 offset:12288
  buffer_load_dwordx4 v2, s[48:51], s27 offen offset:3072 sc1 lds
  v_add_f32 v227, v227, v219
  v_cvt_pk_bf16_f32 v181, v218, v219
  v_mfma_f32_16x16x32_bf16 a[100:103], a[176:179], v[188:191], a[100:103]
  s_add_u32 s27, s27, 16384
  v_exp_f32 v223, v143
  v_mfma_f32_16x16x32_bf16 a[104:107], a[180:183], v[184:187], a[104:107]
  s_add_u32 s25, s25, 32768
  ds_read_b128 a[148:151], v3 offset:13312
  v_add_f32 v227, v227, v220
  v_mfma_f32_16x16x32_bf16 a[108:111], a[180:183], v[188:191], a[108:111]
  s_and_b32 s25, s25, 0x1ffff
  v_add_f32 v227, v227, v221
  v_cvt_pk_bf16_f32 v182, v220, v221
  v_add_f32 v227, v227, v222
  v_mfma_f32_16x16x32_bf16 a[112:115], a[184:187], v[184:187], a[112:115]
  ds_read_b128 a[152:155], v3 offset:14336
  v_add_f32 v227, v227, v223
  v_max_f32 v5, v226, v227
  v_cmp_lt_f32 vcc, s81, v5
  v_mfma_f32_16x16x32_bf16 a[116:119], a[184:187], v[188:191], a[116:119]
  v_exp_f32 v216, v144
  v_mfma_f32_16x16x32_bf16 a[120:123], a[188:191], v[184:187], a[120:123]
  s_waitcnt lgkmcnt(3)
  ds_read_b128 a[156:159], v3 offset:15360
  v_cvt_pk_bf16_f32 v183, v222, v223
  v_add_u32 v3, s66, v2
  v_mfma_f32_16x16x32_bf16 a[124:127], a[188:191], v[188:191], a[124:127]
  s_cbranch_vccnz fa_stub13
fa_back13:
  v_exp_f32 v217, v145
  v_add_f32 v230, v230, v226
  v_add_f32 v231, v231, v227
fa_SSW7:
  v_mfma_f32_16x16x32_bf16 v[128:131], a[128:131], v[64:67], v[200:203]
  s_waitcnt vmcnt(12)
  v_exp_f32 v218, v146
  v_mfma_f32_16x16x32_bf16 v[136:139], a[128:131], v[68:71], v[204:207]
  s_barrier
  v_exp_f32 v219, v147
  v_mfma_f32_16x16x32_bf16 v[132:135], a[132:135], v[64:67], v[200:203]
  ds_read_b128 a[160:163], v3 offset:16384
  ds_read_b128 a[164:167], v3 offset:17408
  v_add_f32 v226, v216, v217
  v_mfma_f32_16x16x32_bf16 v[140:143], a[132:135], v[68:71], v[204:207]
  s_mov_b32 m0, s24
  v_exp_f32 v220, v148
  v_mfma_f32_16x16x32_bf16 v[128:131], a[136:139], v[72:75], v[128:131]
  ds_read_b128 a[168:171], v3 offset:18432
  buffer_load_dwordx4 v2, s[44:47], s26 offen offset:0 sc1 lds
  v_cvt_pk_bf16_f32 v184, v216, v217
  v_mfma_f32_16x16x32_bf16 v[136:139], a[136:139], v[76:79], v[136:139]
  v_exp_f32 v221, v149
  v_mfma_f32_16x16x32_bf16 v[132:135], a[140:143], v[72:75], v[132:135]
  ds_read_b128 a[172:175], v3 offset:19456
  v_add_f32 v226, v226, v218
  v_add_f32 v226, v226, v219
  v_mfma_f32_16x16x32_bf16 v[140:143], a[140:143], v[76:79], v[140:143]
  s_waitcnt lgkmcnt(4)
  v_exp_f32 v222, v150
  v_mfma_f32_16x16x32_bf16 v[128:131], a[144:147], v[80:83], v[128:131]
  ds_read_b128 a[176:179], v3 offset:20480
  v_cvt_pk_bf16_f32 v185, v218, v219
  v_mfma_f32_16x16x32_bf16 v[136:139], a[144:147], v[84:87], v[136:139]
  v_exp_f32 v223, v151
  v_mfma_f32_16x16x32_bf16 v[132:135], a[148:151], v[80:83], v[132:135]
  ds_read_b128 a[180:183], v3 offset:21504
  buffer_load_dwordx4 v2, s[44:47], s26 offen offset:1024 sc1 lds
  v_add_f32 v226, v226, v220
  v_mfma_f32_16x16x32_bf16 v[140:143], a[148:151], v[84:87], v[140:143]
  v_exp_f32 v216, v152
  v_mfma_f32_16x16x32_bf16 v[128:131], a[152:155], v[88:91], v[128:131]
  ds_read_b128 a[184:187], v3 offset:22528
  v_add_f32 v226, v226, v221
  v_cvt_pk_bf16_f32 v186, v220, v221
  v_mfma_f32_16x16x32_bf16 v[136:139], a[152:155], v[92:95], v[136:139]
  v_exp_f32 v217, v153
  v_mfma_f32_16x16x32_bf16 v[132:135], a[156:159], v[88:91], v[132:135]
  s_add_u32 s14, s13, 77824
  ds_read_b128 a[188:191], v3 offset:23552
  buffer_load_dwordx4 a[240:243], v2, s[40:43], s14 offen offset:0 sc1
  v_add_f32 v226, v226, v222
  v_mfma_f32_16x16x32_bf16 v[140:143], a[156:159], v[92:95], v[140:143]
  s_waitcnt lgkmcnt(4)
  v_exp_f32 v218, v154
  v_mfma_f32_16x16x32_bf16 a[64:67], a[160:163], v[176:179], a[64:67]
  ds_read_b128 a[128:131], v3 offset:0
  v_add_f32 v226, v226, v223
  v_cvt_pk_bf16_f32 v187, v222, v223
  v_mfma_f32_16x16x32_bf16 a[68:71], a[160:163], v[180:183], a[68:71]
  v_exp_f32 v219, v155
  v_mfma_f32_16x16x32_bf16 a[72:75], a[164:167], v[176:179], a[72:75]
  ds_read_b128 a[132:135], v3 offset:1024
  buffer_load_dwordx4 v2, s[44:47], s26 offen offset:2048 sc1 lds
  v_add_f32 v227, v216, v217
  v_mfma_f32_16x16x32_bf16 a[76:79], a[164:167], v[180:183], a[76:79]
  v_exp_f32 v220, v156
  v_mfma_f32_16x16x32_bf16 a[80:83], a[168:171], v[176:179], a[80:83]
  ds_read_b128 a[136:139], v3 offset:2048
  v_cvt_pk_bf16_f32 v188, v216, v217
  v_mfma_f32_16x16x32_bf16 a[84:87], a[168:171], v[180:183], a[84:87]
  v_exp_f32 v221, v157
  v_mfma_f32_16x16x32_bf16 a[88:91], a[172:175], v[176:179], a[88:91]
  ds_read_b128 a[140:143], v3 offset:3072
  v_add_f32 v227, v227, v218
  v_add_f32 v227, v227, v219
  v_mfma_f32_16x16x32_bf16 a[92:95], a[172:175], v[180:183], a[92:95]
  s_waitcnt lgkmcnt(4)
  v_exp_f32 v222, v158
  v_mfma_f32_16x16x32_bf16 a[96:99], a[176:179], v[176:179], a[96:99]
  ds_read_b128 a[144:147], v3 offset:4096
  buffer_load_dwordx4 v2, s[44:47], s26 offen offset:3072 sc1 lds
  v_cvt_pk_bf16_f32 v189, v218, v219
  v_mfma_f32_16x16x32_bf16 a[100:103], a[176:179], v[180:183], a[100:103]
  s_add_u32 s26, s26, 16384
  v_exp_f32 v223, v159
  v_mfma_f32_16x16x32_bf16 a[104:107], a[180:183], v[176:179], a[104:107]
  s_add_u32 s24, s24, 32768
  ds_read_b128 a[148:151], v3 offset:5120
  v_add_f32 v227, v227, v220
  v_mfma_f32_16x16x32_bf16 a[108:111], a[180:183], v[180:183], a[108:111]
  s_and_b32 s24, s24, 0x1ffff
  v_add_f32 v227, v227, v221
  v_cvt_pk_bf16_f32 v190, v220, v221
  v_add_f32 v227, v227, v222
  v_mfma_f32_16x16x32_bf16 a[112:115], a[184:187], v[176:179], a[112:115]
  ds_read_b128 a[152:155], v3 offset:6144
  v_add_f32 v227, v227, v223
  v_max_f32 v5, v226, v227
  v_cmp_lt_f32 vcc, s81, v5
  v_mfma_f32_16x16x32_bf16 a[116:119], a[184:187], v[180:183], a[116:119]
  v_exp_f32 v216, v128
  v_mfma_f32_16x16x32_bf16 a[120:123], a[188:191], v[176:179], a[120:123]
  s_waitcnt lgkmcnt(3)
  ds_read_b128 a[156:159], v3 offset:7168
  v_cvt_pk_bf16_f32 v191, v222, v223
  v_mfma_f32_16x16x32_bf16 a[124:127], a[188:191], v[180:183], a[124:127]
  s_cbranch_vccnz fa_stub14
fa_back14:
  v_exp_f32 v217, v129
  v_add_f32 v230, v230, v226
  v_add_f32 v231, v231, v227
  v_mfma_f32_16x16x32_bf16 v[144:147], a[128:131], v[64:67], v[200:203]
  ds_read_b128 a[160:163], v3 offset:24576
  v_add_f32 v226, v216, v217
  v_mfma_f32_16x16x32_bf16 v[152:155], a[128:131], v[68:71], v[204:207]
  v_exp_f32 v218, v130
  v_mfma_f32_16x16x32_bf16 v[148:151], a[132:135], v[64:67], v[200:203]
  s_add_u32 s66, s66, 32768
  ds_read_b128 a[164:167], v3 offset:25600
  v_cvt_pk_bf16_f32 v176, v216, v217
  v_mfma_f32_16x16x32_bf16 v[156:159], a[132:135], v[68:71], v[204:207]
  s_mov_b32 m0, s25
  v_exp_f32 v219, v131
  v_mfma_f32_16x16x32_bf16 v[144:147], a[136:139], v[72:75], v[144:147]
  s_and_b32 s66, s66, 0x1ffff
  ds_read_b128 a[168:171], v3 offset:26624
  buffer_load_dwordx4 v2, s[48:51], s27 offen offset:0 sc1 lds
  v_add_f32 v226, v226, v218
  v_add_f32 v226, v226, v219
  v_mfma_f32_16x16x32_bf16 v[152:155], a[136:139], v[76:79], v[152:155]
  v_exp_f32 v220, v132
  v_mfma_f32_16x16x32_bf16 v[148:151], a[140:143], v[72:75], v[148:151]
  ds_read_b128 a[172:175], v3 offset:27648
  v_cvt_pk_bf16_f32 v177, v218, v219
  v_mfma_f32_16x16x32_bf16 v[156:159], a[140:143], v[76:79], v[156:159]
  s_waitcnt lgkmcnt(4)
  v_exp_f32 v221, v133
  v_mfma_f32_16x16x32_bf16 v[144:147], a[144:147], v[80:83], v[144:147]
  s_add_u32 s14, s13, 73728
  ds_read_b128 a[176:179], v3 offset:28672
  buffer_load_dwordx4 a[236:239], v2, s[40:43], s14 offen offset:3072 sc1
  v_add_f32 v226, v226, v220
  v_mfma_f32_16x16x32_bf16 v[152:155], a[144:147], v[84:87], v[152:155]
  v_exp_f32 v222, v134
  v_mfma_f32_16x16x32_bf16 v[148:151], a[148:151], v[80:83], v[148:151]
  ds_read_b128 a[180:183], v3 offset:29696
  buffer_load_dwordx4 v2, s[48:51], s27 offen offset:1024 sc1 lds
  v_add_f32 v226, v226, v221
  v_cvt_pk_bf16_f32 v178, v220, v221
  v_mfma_f32_16x16x32_bf16 v[156:159], a[148:151], v[84:87], v[156:159]
  v_exp_f32 v223, v135
  v_mfma_f32_16x16x32_bf16 v[144:147], a[152:155], v[88:91], v[144:147]
  ds_read_b128 a[184:187], v3 offset:30720
  v_add_f32 v226, v226, v222
  v_mfma_f32_16x16x32_bf16 v[152:155], a[152:155], v[92:95], v[152:155]
  v_exp_f32 v216, v136
  v_mfma_f32_16x16x32_bf16 v[148:151], a[156:159], v[88:91], v[148:151]
  ds_read_b128 a[188:191], v3 offset:31744
  v_add_f32 v226, v226, v223
  v_exp_f32 v217, v137
  v_mfma_f32_16x16x32_bf16 v[156:159], a[156:159], v[92:95], v[156:159]
  s_waitcnt lgkmcnt(4)
  v_exp_f32 v218, v138
  v_mfma_f32_16x16x32_bf16 a[64:67], a[160:163], v[184:187], a[64:67]
  ds_read_b128 a[128:131], v3 offset:8192
  v_cvt_pk_bf16_f32 v179, v222, v223
  v_mfma_f32_16x16x32_bf16 a[68:71], a[160:163], v[188:191], a[68:71]
  v_exp_f32 v219, v139
  v_mfma_f32_16x16x32_bf16 a[72:75], a[164:167], v[184:187], a[72:75]
  ds_read_b128 a[132:135], v3 offset:9216
  buffer_load_dwordx4 v2, s[48:51], s27 offen offset:2048 sc1 lds
  v_add_f32 v227, v216, v217
  v_mfma_f32_16x16x32_bf16 a[76:79], a[164:167], v[188:191], a[76:79]
  v_exp_f32 v220, v140
  v_mfma_f32_16x16x32_bf16 a[80:83], a[168:171], v[184:187], a[80:83]
  ds_read_b128 a[136:139], v3 offset:10240
  v_cvt_pk_bf16_f32 v180, v216, v217
  v_mfma_f32_16x16x32_bf16 a[84:87], a[168:171], v[188:191], a[84:87]
  v_exp_f32 v221, v141
  v_mfma_f32_16x16x32_bf16 a[88:91], a[172:175], v[184:187], a[88:91]
  ds_read_b128 a[140:143], v3 offset:11264
  buffer_load_dwordx4 a[232:235], v2, s[40:43], s14 offen offset:2048 sc1
  v_add_f32 v227, v227, v218
  v_mfma_f32_16x16x32_bf16 a[92:95], a[172:175], v[188:191], a[92:95]
  s_waitcnt lgkmcnt(4)
  v_exp_f32 v222, v142
  v_mfma_f32_16x16x32_bf16 a[96:99], a[176:179], v[184:187], a[96:99]
  ds_read_b128 a[144:147], v3 offset:12288
  buffer_load_dwordx4 v2, s[48:51], s27 offen offset:3072 sc1 lds
  v_add_f32 v227, v227, v219
  v_cvt_pk_bf16_f32 v181, v218, v219
  v_mfma_f32_16x16x32_bf16 a[100:103], a[176:179], v[188:191], a[100:103]
  s_add_u32 s27, s27, 16384
  v_exp_f32 v223, v143
  v_mfma_f32_16x16x32_bf16 a[104:107], a[180:183], v[184:187], a[104:107]
  s_add_u32 s25, s25, 32768
  ds_read_b128 a[148:151], v3 offset:13312
  v_add_f32 v227, v227, v220
  v_mfma_f32_16x16x32_bf16 a[108:111], a[180:183], v[188:191], a[108:111]
  s_and_b32 s25, s25, 0x1ffff
  v_add_f32 v227, v227, v221
  v_cvt_pk_bf16_f32 v182, v220, v221
  v_add_f32 v227, v227, v222
  v_mfma_f32_16x16x32_bf16 a[112:115], a[184:187], v[184:187], a[112:115]
  ds_read_b128 a[152:155], v3 offset:14336
  v_add_f32 v227, v227, v223
  v_max_f32 v5, v226, v227
  v_cmp_lt_f32 vcc, s81, v5
  v_mfma_f32_16x16x32_bf16 a[116:119], a[184:187], v[188:191], a[116:119]
  v_exp_f32 v216, v144
  v_mfma_f32_16x16x32_bf16 a[120:123], a[188:191], v[184:187], a[120:123]
  s_waitcnt lgkmcnt(3)
  ds_read_b128 a[156:159], v3 offset:15360
  v_cvt_pk_bf16_f32 v183, v222, v223
  v_add_u32 v3, s66, v2
  v_mfma_f32_16x16x32_bf16 a[124:127], a[188:191], v[188:191], a[124:127]
  s_cbranch_vccnz fa_stub15
fa_back15:
  v_exp_f32 v217, v145
  v_add_f32 v230, v230, v226
  v_add_f32 v231, v231, v227
fa_SSW6:
  v_mfma_f32_16x16x32_bf16 v[128:131], a[128:131], v[64:67], v[200:203]
  s_waitcnt vmcnt(12)
  v_exp_f32 v218, v146
  v_mfma_f32_16x16x32_bf16 v[136:139], a[128:131], v[68:71], v[204:207]
  s_barrier
  v_exp_f32 v219, v147
  v_mfma_f32_16x16x32_bf16 v[132:135], a[132:135], v[64:67], v[200:203]
  ds_read_b128 a[160:163], v3 offset:16384
  ds_read_b128 a[164:167], v3 offset:17408
  v_add_f32 v226, v216, v217
  v_mfma_f32_16x16x32_bf16 v[140:143], a[132:135], v[68:71], v[204:207]
  s_mov_b32 m0, s24
  v_exp_f32 v220, v148
  v_mfma_f32_16x16x32_bf16 v[128:131], a[136:139], v[72:75], v[128:131]
  ds_read_b128 a[168:171], v3 offset:18432
  buffer_load_dwordx4 v2, s[44:47], s26 offen offset:0 sc1 lds
  v_cvt_pk_bf16_f32 v184, v216, v217
  v_mfma_f32_16x16x32_bf16 v[136:139], a[136:139], v[76:79], v[136:139]
  v_exp_f32 v221, v149
  v_mfma_f32_16x16x32_bf16 v[132:135], a[140:143], v[72:75], v[132:135]
  ds_read_b128 a[172:175], v3 offset:19456
  v_add_f32 v226, v226, v218
  v_add_f32 v226, v226, v219
  v_mfma_f32_16x16x32_bf16 v[140:143], a[140:143], v[76:79], v[140:143]
  s_waitcnt lgkmcnt(4)
  v_exp_f32 v222, v150
  v_mfma_f32_16x16x32_bf16 v[128:131], a[144:147], v[80:83], v[128:131]
  s_add_u32 s14, s13, 73728
  ds_read_b128 a[176:179], v3 offset:20480
  buffer_load_dwordx4 a[228:231], v2, s[40:43], s14 offen offset:1024 sc1
  v_cvt_pk_bf16_f32 v185, v218, v219
  v_mfma_f32_16x16x32_bf16 v[136:139], a[144:147], v[84:87], v[136:139]
  v_exp_f32 v223, v151
  v_mfma_f32_16x16x32_bf16 v[132:135], a[148:151], v[80:83], v[132:135]
  ds_read_b128 a[180:183], v3 offset:21504
  buffer_load_dwordx4 v2, s[44:47], s26 offen offset:1024 sc1 lds
  v_add_f32 v226, v226, v220
  v_mfma_f32_16x16x32_bf16 v[140:143], a[148:151], v[84:87], v[140:143]
  v_exp_f32 v216, v152
  v_mfma_f32_16x16x32_bf16 v[128:131], a[152:155], v[88:91], v[128:131]
  ds_read_b128 a[184:187], v3 offset:22528
  v_add_f32 v226, v226, v221
  v_cvt_pk_bf16_f32 v186, v220, v221
  v_mfma_f32_16x16x32_bf16 v[136:139], a[152:155], v[92:95], v[136:139]
  v_exp_f32 v217, v153
  v_mfma_f32_16x16x32_bf16 v[132:135], a[156:159], v[88:91], v[132:135]
  ds_read_b128 a[188:191], v3 offset:23552
  v_add_f32 v226, v226, v222
  v_mfma_f32_16x16x32_bf16 v[140:143], a[156:159], v[92:95], v[140:143]
  s_waitcnt lgkmcnt(4)
  v_exp_f32 v218, v154
  v_mfma_f32_16x16x32_bf16 a[64:67], a[160:163], v[176:179], a[64:67]
  ds_read_b128 a[128:131], v3 offset:0
  v_add_f32 v226, v226, v223
  v_cvt_pk_bf16_f32 v187, v222, v223
  v_mfma_f32_16x16x32_bf16 a[68:71], a[160:163], v[180:183], a[68:71]
  v_exp_f32 v219, v155
  v_mfma_f32_16x16x32_bf16 a[72:75], a[164:167], v[176:179], a[72:75]
  ds_read_b128 a[132:135], v3 offset:1024
  buffer_load_dwordx4 v2, s[44:47], s26 offen offset:2048 sc1 lds
  v_add_f32 v227, v216, v217
  v_mfma_f32_16x16x32_bf16 a[76:79], a[164:167], v[180:183], a[76:79]
  v_exp_f32 v220, v156
  v_mfma_f32_16x16x32_bf16 a[80:83], a[168:171], v[176:179], a[80:83]
  ds_read_b128 a[136:139], v3 offset:2048
  v_cvt_pk_bf16_f32 v188, v216, v217
  v_mfma_f32_16x16x32_bf16 a[84:87], a[168:171], v[180:183], a[84:87]
  v_exp_f32 v221, v157
  v_mfma_f32_16x16x32_bf16 a[88:91], a[172:175], v[176:179], a[88:91]
  ds_read_b128 a[140:143], v3 offset:3072
  buffer_load_dwordx4 a[224:227], v2, s[40:43], s14 offen offset:0 sc1
  v_add_f32 v227, v227, v218
  v_add_f32 v227, v227, v219
  v_mfma_f32_16x16x32_bf16 a[92:95], a[172:175], v[180:183], a[92:95]
  s_waitcnt lgkmcnt(4)
  v_exp_f32 v222, v158
  v_mfma_f32_16x16x32_bf16 a[96:99], a[176:179], v[176:179], a[96:99]
  ds_read_b128 a[144:147], v3 offset:4096
  buffer_load_dwordx4 v2, s[44:47], s26 offen offset:3072 sc1 lds
  v_cvt_pk_bf16_f32 v189, v218, v219
  v_mfma_f32_16x16x32_bf16 a[100:103], a[176:179], v[180:183], a[100:103]
  s_add_u32 s26, s26, 16384
  v_exp_f32 v223, v159
  v_mfma_f32_16x16x32_bf16 a[104:107], a[180:183], v[176:179], a[104:107]
  s_add_u32 s24, s24, 32768
  ds_read_b128 a[148:151], v3 offset:5120
  v_add_f32 v227, v227, v220
  v_mfma_f32_16x16x32_bf16 a[108:111], a[180:183], v[180:183], a[108:111]
  s_and_b32 s24, s24, 0x1ffff
  v_add_f32 v227, v227, v221
  v_cvt_pk_bf16_f32 v190, v220, v221
  v_add_f32 v227, v227, v222
  v_mfma_f32_16x16x32_bf16 a[112:115], a[184:187], v[176:179], a[112:115]
  ds_read_b128 a[152:155], v3 offset:6144
  v_add_f32 v227, v227, v223
  v_max_f32 v5, v226, v227
  v_cmp_lt_f32 vcc, s81, v5
  v_mfma_f32_16x16x32_bf16 a[116:119], a[184:187], v[180:183], a[116:119]
  v_exp_f32 v216, v128
  v_mfma_f32_16x16x32_bf16 a[120:123], a[188:191], v[176:179], a[120:123]
  s_waitcnt lgkmcnt(3)
  ds_read_b128 a[156:159], v3 offset:7168
  v_cvt_pk_bf16_f32 v191, v222, v223
  v_mfma_f32_16x16x32_bf16 a[124:127], a[188:191], v[180:183], a[124:127]
  s_cbranch_vccnz fa_stub16
fa_back16:
  v_exp_f32 v217, v129
  v_add_f32 v230, v230, v226
  v_add_f32 v231, v231, v227
  v_mfma_f32_16x16x32_bf16 v[144:147], a[128:131], v[64:67], v[200:203]
  ds_read_b128 a[160:163], v3 offset:24576
  v_add_f32 v226, v216, v217
  v_mfma_f32_16x16x32_bf16 v[152:155], a[128:131], v[68:71], v[204:207]
  v_exp_f32 v218, v130
  v_mfma_f32_16x16x32_bf16 v[148:151], a[132:135], v[64:67], v[200:203]
  s_add_u32 s66, s66, 32768
  ds_read_b128 a[164:167], v3 offset:25600
  v_cvt_pk_bf16_f32 v176, v216, v217
  v_mfma_f32_16x16x32_bf16 v[156:159], a[132:135], v[68:71], v[204:207]
  s_mov_b32 m0, s25
  v_exp_f32 v219, v131
  v_mfma_f32_16x16x32_bf16 v[144:147], a[136:139], v[72:75], v[144:147]
  s_and_b32 s66, s66, 0x1ffff
  ds_read_b128 a[168:171], v3 offset:26624
  buffer_load_dwordx4 v2, s[48:51], s27 offen offset:0 sc1 lds
  v_add_f32 v226, v226, v218
  v_add_f32 v226, v226, v219
  v_mfma_f32_16x16x32_bf16 v[152:155], a[136:139], v[76:79], v[152:155]
  v_exp_f32 v220, v132
  v_mfma_f32_16x16x32_bf16 v[148:151], a[140:143], v[72:75], v[148:151]
  ds_read_b128 a[172:175], v3 offset:27648
  v_cvt_pk_bf16_f32 v177, v218, v219
  v_mfma_f32_16x16x32_bf16 v[156:159], a[140:143], v[76:79], v[156:159]
  s_waitcnt lgkmcnt(4)
  v_exp_f32 v221, v133
  v_mfma_f32_16x16x32_bf16 v[144:147], a[144:147], v[80:83], v[144:147]
  s_add_u32 s14, s13, 69632
  ds_read_b128 a[176:179], v3 offset:28672
  buffer_load_dwordx4 a[220:223], v2, s[40:43], s14 offen offset:3072 sc1
  v_add_f32 v226, v226, v220
  v_mfma_f32_16x16x32_bf16 v[152:155], a[144:147], v[84:87], v[152:155]
  v_exp_f32 v222, v134
  v_mfma_f32_16x16x32_bf16 v[148:151], a[148:151], v[80:83], v[148:151]
  ds_read_b128 a[180:183], v3 offset:29696
  buffer_load_dwordx4 v2, s[48:51], s27 offen offset:1024 sc1 lds
  v_add_f32 v226, v226, v221
  v_cvt_pk_bf16_f32 v178, v220, v221
  v_mfma_f32_16x16x32_bf16 v[156:159], a[148:151], v[84:87], v[156:159]
  v_exp_f32 v223, v135
  v_mfma_f32_16x16x32_bf16 v[144:147], a[152:155], v[88:91], v[144:147]
  ds_read_b128 a[184:187], v3 offset:30720
  v_add_f32 v226, v226, v222
  v_mfma_f32_16x16x32_bf16 v[152:155], a[152:155], v[92:95], v[152:155]
  v_exp_f32 v216, v136
  v_mfma_f32_16x16x32_bf16 v[148:151], a[156:159], v[88:91], v[148:151]
  ds_read_b128 a[188:191], v3 offset:31744
  v_add_f32 v226, v226, v223
  v_exp_f32 v217, v137
  v_mfma_f32_16x16x32_bf16 v[156:159], a[156:159], v[92:95], v[156:159]
  s_waitcnt lgkmcnt(4)
  v_exp_f32 v218, v138
  v_mfma_f32_16x16x32_bf16 a[64:67], a[160:163], v[184:187], a[64:67]
  ds_read_b128 a[128:131], v3 offset:8192
  v_cvt_pk_bf16_f32 v179, v222, v223
  v_mfma_f32_16x16x32_bf16 a[68:71], a[160:163], v[188:191], a[68:71]
  v_exp_f32 v219, v139
  v_mfma_f32_16x16x32_bf16 a[72:75], a[164:167], v[184:187], a[72:75]
  ds_read_b128 a[132:135], v3 offset:9216
  buffer_load_dwordx4 v2, s[48:51], s27 offen offset:2048 sc1 lds
  v_add_f32 v227, v216, v217
  v_mfma_f32_16x16x32_bf16 a[76:79], a[164:167], v[188:191], a[76:79]
  v_exp_f32 v220, v140
  v_mfma_f32_16x16x32_bf16 a[80:83], a[168:171], v[184:187], a[80:83]
  ds_read_b128 a[136:139], v3 offset:10240
  v_cvt_pk_bf16_f32 v180, v216, v217
  v_mfma_f32_16x16x32_bf16 a[84:87], a[168:171], v[188:191], a[84:87]
  v_exp_f32 v221, v141
  v_mfma_f32_16x16x32_bf16 a[88:91], a[172:175], v[184:187], a[88:91]
  ds_read_b128 a[140:143], v3 offset:11264
  buffer_load_dwordx4 a[216:219], v2, s[40:43], s14 offen offset:2048 sc1
  v_add_f32 v227, v227, v218
  v_mfma_f32_16x16x32_bf16 a[92:95], a[172:175], v[188:191], a[92:95]
  s_waitcnt lgkmcnt(4)
  v_exp_f32 v222, v142
  v_mfma_f32_16x16x32_bf16 a[96:99], a[176:179], v[184:187], a[96:99]
  ds_read_b128 a[144:147], v3 offset:12288
  buffer_load_dwordx4 v2, s[48:51], s27 offen offset:3072 sc1 lds
  v_add_f32 v227, v227, v219
  v_cvt_pk_bf16_f32 v181, v218, v219
  v_mfma_f32_16x16x32_bf16 a[100:103], a[176:179], v[188:191], a[100:103]
  s_add_u32 s27, s27, 16384
  v_exp_f32 v223, v143
  v_mfma_f32_16x16x32_bf16 a[104:107], a[180:183], v[184:187], a[104:107]
  s_add_u32 s25, s25, 32768
  ds_read_b128 a[148:151], v3 offset:13312
  v_add_f32 v227, v227, v220
  v_mfma_f32_16x16x32_bf16 a[108:111], a[180:183], v[188:191], a[108:111]
  s_and_b32 s25, s25, 0x1ffff
  v_add_f32 v227, v227, v221
  v_cvt_pk_bf16_f32 v182, v220, v221
  v_add_f32 v227, v227, v222
  v_mfma_f32_16x16x32_bf16 a[112:115], a[184:187], v[184:187], a[112:115]
  ds_read_b128 a[152:155], v3 offset:14336
  v_add_f32 v227, v227, v223
  v_max_f32 v5, v226, v227
  v_cmp_lt_f32 vcc, s81, v5
  v_mfma_f32_16x16x32_bf16 a[116:119], a[184:187], v[188:191], a[116:119]
  v_exp_f32 v216, v144
  v_mfma_f32_16x16x32_bf16 a[120:123], a[188:191], v[184:187], a[120:123]
  s_waitcnt lgkmcnt(3)
  ds_read_b128 a[156:159], v3 offset:15360
  v_cvt_pk_bf16_f32 v183, v222, v223
  v_add_u32 v3, s66, v2
  v_mfma_f32_16x16x32_bf16 a[124:127], a[188:191], v[188:191], a[124:127]
  s_cbranch_vccnz fa_stub17
fa_back17:
  v_exp_f32 v217, v145
  v_add_f32 v230, v230, v226
  v_add_f32 v231, v231, v227
fa_SSW5:
  v_mfma_f32_16x16x32_bf16 v[128:131], a[128:131], v[64:67], v[200:203]
  s_waitcnt vmcnt(12)
  v_exp_f32 v218, v146
  v_mfma_f32_16x16x32_bf16 v[136:139], a[128:131], v[68:71], v[204:207]
  s_barrier
  v_exp_f32 v219, v147
  v_mfma_f32_16x16x32_bf16 v[132:135], a[132:135], v[64:67], v[200:203]
  ds_read_b128 a[160:163], v3 offset:16384
  ds_read_b128 a[164:167], v3 offset:17408
  v_add_f32 v226, v216, v217
  v_mfma_f32_16x16x32_bf16 v[140:143], a[132:135], v[68:71], v[204:207]
  s_mov_b32 m0, s24
  v_exp_f32 v220, v148
  v_mfma_f32_16x16x32_bf16 v[128:131], a[136:139], v[72:75], v[128:131]
  ds_read_b128 a[168:171], v3 offset:18432
  buffer_load_dwordx4 v2, s[44:47], s26 offen offset:0 sc1 lds
  v_cvt_pk_bf16_f32 v184, v216, v217
  v_mfma_f32_16x16x32_bf16 v[136:139], a[136:139], v[76:79], v[136:139]
  v_exp_f32 v221, v149
  v_mfma_f32_16x16x32_bf16 v[132:135], a[140:143], v[72:75], v[132:135]
  ds_read_b128 a[172:175], v3 offset:19456
  v_add_f32 v226, v226, v218
  v_add_f32 v226, v226, v219
  v_mfma_f32_16x16x32_bf16 v[140:143], a[140:143], v[76:79], v[140:143]
  s_waitcnt lgkmcnt(4)
  v_exp_f32 v222, v150
  v_mfma_f32_16x16x32_bf16 v[128:131], a[144:147], v[80:83], v[128:131]
  s_add_u32 s14, s13, 69632
  ds_read_b128 a[176:179], v3 offset:20480
  buffer_load_dwordx4 a[212:215], v2, s[40:43], s14 offen offset:1024 sc1
  v_cvt_pk_bf16_f32 v185, v218, v219
  v_mfma_f32_16x16x32_bf16 v[136:139], a[144:147], v[84:87], v[136:139]
  v_exp_f32 v223, v151
  v_mfma_f32_16x16x32_bf16 v[132:135], a[148:151], v[80:83], v[132:135]
  ds_read_b128 a[180:183], v3 offset:21504
  buffer_load_dwordx4 v2, s[44:47], s26 offen offset:1024 sc1 lds
  v_add_f32 v226, v226, v220
  v_mfma_f32_16x16x32_bf16 v[140:143], a[148:151], v[84:87], v[140:143]
  v_exp_f32 v216, v152
  v_mfma_f32_16x16x32_bf16 v[128:131], a[152:155], v[88:91], v[128:131]
  ds_read_b128 a[184:187], v3 offset:22528
  v_add_f32 v226, v226, v221
  v_cvt_pk_bf16_f32 v186, v220, v221
  v_mfma_f32_16x16x32_bf16 v[136:139], a[152:155], v[92:95], v[136:139]
  v_exp_f32 v217, v153
  v_mfma_f32_16x16x32_bf16 v[132:135], a[156:159], v[88:91], v[132:135]
  ds_read_b128 a[188:191], v3 offset:23552
  buffer_load_dwordx4 a[208:211], v2, s[40:43], s14 offen offset:0 sc1
  v_add_f32 v226, v226, v222
  v_mfma_f32_16x16x32_bf16 v[140:143], a[156:159], v[92:95], v[140:143]
  s_waitcnt lgkmcnt(4)
  v_exp_f32 v218, v154
  v_mfma_f32_16x16x32_bf16 a[64:67], a[160:163], v[176:179], a[64:67]
  ds_read_b128 a[128:131], v3 offset:0
  v_add_f32 v226, v226, v223
  v_cvt_pk_bf16_f32 v187, v222, v223
  v_mfma_f32_16x16x32_bf16 a[68:71], a[160:163], v[180:183], a[68:71]
  v_exp_f32 v219, v155
  v_mfma_f32_16x16x32_bf16 a[72:75], a[164:167], v[176:179], a[72:75]
  ds_read_b128 a[132:135], v3 offset:1024
  buffer_load_dwordx4 v2, s[44:47], s26 offen offset:2048 sc1 lds
  v_add_f32 v227, v216, v217
  v_mfma_f32_16x16x32_bf16 a[76:79], a[164:167], v[180:183], a[76:79]
  v_exp_f32 v220, v156
  v_mfma_f32_16x16x32_bf16 a[80:83], a[168:171], v[176:179], a[80:83]
  ds_read_b128 a[136:139], v3 offset:2048
  v_cvt_pk_bf16_f32 v188, v216, v217
  v_mfma_f32_16x16x32_bf16 a[84:87], a[168:171], v[180:183], a[84:87]
  v_exp_f32 v221, v157
  v_mfma_f32_16x16x32_bf16 a[88:91], a[172:175], v[176:179], a[88:91]
  s_add_u32 s14, s13, 61440
  ds_read_b128 a[140:143], v3 offset:3072
  buffer_load_dwordx4 a[204:207], v2, s[40:43], s14 offen offset:3072 sc1
  v_add_f32 v227, v227, v218
  v_add_f32 v227, v227, v219
  v_mfma_f32_16x16x32_bf16 a[92:95], a[172:175], v[180:183], a[92:95]
  s_waitcnt lgkmcnt(4)
  v_exp_f32 v222, v158
  v_mfma_f32_16x16x32_bf16 a[96:99], a[176:179], v[176:179], a[96:99]
  ds_read_b128 a[144:147], v3 offset:4096
  buffer_load_dwordx4 v2, s[44:47], s26 offen offset:3072 sc1 lds
  v_cvt_pk_bf16_f32 v189, v218, v219
  v_mfma_f32_16x16x32_bf16 a[100:103], a[176:179], v[180:183], a[100:103]
  s_add_u32 s26, s26, 16384
  v_exp_f32 v223, v159
  v_mfma_f32_16x16x32_bf16 a[104:107], a[180:183], v[176:179], a[104:107]
  s_add_u32 s24, s24, 32768
  ds_read_b128 a[148:151], v3 offset:5120
  v_add_f32 v227, v227, v220
  v_mfma_f32_16x16x32_bf16 a[108:111], a[180:183], v[180:183], a[108:111]
  s_and_b32 s24, s24, 0x1ffff
  v_add_f32 v227, v227, v221
  v_cvt_pk_bf16_f32 v190, v220, v221
  v_add_f32 v227, v227, v222
  v_mfma_f32_16x16x32_bf16 a[112:115], a[184:187], v[176:179], a[112:115]
  ds_read_b128 a[152:155], v3 offset:6144
  v_add_f32 v227, v227, v223
  v_max_f32 v5, v226, v227
  v_cmp_lt_f32 vcc, s81, v5
  v_mfma_f32_16x16x32_bf16 a[116:119], a[184:187], v[180:183], a[116:119]
  v_exp_f32 v216, v128
  v_mfma_f32_16x16x32_bf16 a[120:123], a[188:191], v[176:179], a[120:123]
  s_waitcnt lgkmcnt(3)
  ds_read_b128 a[156:159], v3 offset:7168
  v_cvt_pk_bf16_f32 v191, v222, v223
  v_mfma_f32_16x16x32_bf16 a[124:127], a[188:191], v[180:183], a[124:127]
  s_cbranch_vccnz fa_stub18
fa_back18:
  v_exp_f32 v217, v129
  v_add_f32 v230, v230, v226
  v_add_f32 v231, v231, v227
  v_mfma_f32_16x16x32_bf16 v[144:147], a[128:131], v[64:67], v[200:203]
  ds_read_b128 a[160:163], v3 offset:24576
  v_add_f32 v226, v216, v217
  v_mfma_f32_16x16x32_bf16 v[152:155], a[128:131], v[68:71], v[204:207]
  v_exp_f32 v218, v130
  v_mfma_f32_16x16x32_bf16 v[148:151], a[132:135], v[64:67], v[200:203]
  s_add_u32 s66, s66, 32768
  ds_read_b128 a[164:167], v3 offset:25600
  v_cvt_pk_bf16_f32 v176, v216, v217
  v_mfma_f32_16x16x32_bf16 v[156:159], a[132:135], v[68:71], v[204:207]
  s_mov_b32 m0, s25
  v_exp_f32 v219, v131
  v_mfma_f32_16x16x32_bf16 v[144:147], a[136:139], v[72:75], v[144:147]
  s_and_b32 s66, s66, 0x1ffff
  ds_read_b128 a[168:171], v3 offset:26624
  buffer_load_dwordx4 v2, s[48:51], s27 offen offset:0 sc1 lds
  v_add_f32 v226, v226, v218
  v_add_f32 v226, v226, v219
  v_mfma_f32_16x16x32_bf16 v[152:155], a[136:139], v[76:79], v[152:155]
  v_exp_f32 v220, v132
  v_mfma_f32_16x16x32_bf16 v[148:151], a[140:143], v[72:75], v[148:151]
  ds_read_b128 a[172:175], v3 offset:27648
  v_cvt_pk_bf16_f32 v177, v218, v219
  v_mfma_f32_16x16x32_bf16 v[156:159], a[140:143], v[76:79], v[156:159]
  s_waitcnt lgkmcnt(4)
  v_exp_f32 v221, v133
  v_mfma_f32_16x16x32_bf16 v[144:147], a[144:147], v[80:83], v[144:147]
  s_add_u32 s14, s13, 61440
  ds_read_b128 a[176:179], v3 offset:28672
  buffer_load_dwordx4 a[200:203], v2, s[40:43], s14 offen offset:2048 sc1
  v_add_f32 v226, v226, v220
  v_mfma_f32_16x16x32_bf16 v[152:155], a[144:147], v[84:87], v[152:155]
  v_exp_f32 v222, v134
  v_mfma_f32_16x16x32_bf16 v[148:151], a[148:151], v[80:83], v[148:151]
  ds_read_b128 a[180:183], v3 offset:29696
  buffer_load_dwordx4 v2, s[48:51], s27 offen offset:1024 sc1 lds
  v_add_f32 v226, v226, v221
  v_cvt_pk_bf16_f32 v178, v220, v221
  v_mfma_f32_16x16x32_bf16 v[156:159], a[148:151], v[84:87], v[156:159]
  v_exp_f32 v223, v135
  v_mfma_f32_16x16x32_bf16 v[144:147], a[152:155], v[88:91], v[144:147]
  ds_read_b128 a[184:187], v3 offset:30720
  v_add_f32 v226, v226, v222
  v_mfma_f32_16x16x32_bf16 v[152:155], a[152:155], v[92:95], v[152:155]
  v_exp_f32 v216, v136
  v_mfma_f32_16x16x32_bf16 v[148:151], a[156:159], v[88:91], v[148:151]
  ds_read_b128 a[188:191], v3 offset:31744
  buffer_load_dwordx4 a[196:199], v2, s[40:43], s14 offen offset:1024 sc1
  v_add_f32 v226, v226, v223
  v_exp_f32 v217, v137
  v_mfma_f32_16x16x32_bf16 v[156:159], a[156:159], v[92:95], v[156:159]
  s_waitcnt lgkmcnt(4)
  v_exp_f32 v218, v138
  v_mfma_f32_16x16x32_bf16 a[64:67], a[160:163], v[184:187], a[64:67]
  ds_read_b128 a[128:131], v3 offset:8192
  v_cvt_pk_bf16_f32 v179, v222, v223
  v_mfma_f32_16x16x32_bf16 a[68:71], a[160:163], v[188:191], a[68:71]
  v_exp_f32 v219, v139
  v_mfma_f32_16x16x32_bf16 a[72:75], a[164:167], v[184:187], a[72:75]
  ds_read_b128 a[132:135], v3 offset:9216
  buffer_load_dwordx4 v2, s[48:51], s27 offen offset:2048 sc1 lds
  v_add_f32 v227, v216, v217
  v_mfma_f32_16x16x32_bf16 a[76:79], a[164:167], v[188:191], a[76:79]
  v_exp_f32 v220, v140
  v_mfma_f32_16x16x32_bf16 a[80:83], a[168:171], v[184:187], a[80:83]
  ds_read_b128 a[136:139], v3 offset:10240
  v_cvt_pk_bf16_f32 v180, v216, v217
  v_mfma_f32_16x16x32_bf16 a[84:87], a[168:171], v[188:191], a[84:87]
  v_exp_f32 v221, v141
  v_mfma_f32_16x16x32_bf16 a[88:91], a[172:175], v[184:187], a[88:91]
  ds_read_b128 a[140:143], v3 offset:11264
  buffer_load_dwordx4 a[192:195], v2, s[40:43], s14 offen offset:0 sc1
  v_add_f32 v227, v227, v218
  v_mfma_f32_16x16x32_bf16 a[92:95], a[172:175], v[188:191], a[92:95]
  s_waitcnt lgkmcnt(4)
  v_exp_f32 v222, v142
  v_mfma_f32_16x16x32_bf16 a[96:99], a[176:179], v[184:187], a[96:99]
  ds_read_b128 a[144:147], v3 offset:12288
  buffer_load_dwordx4 v2, s[48:51], s27 offen offset:3072 sc1 lds
  v_add_f32 v227, v227, v219
  v_cvt_pk_bf16_f32 v181, v218, v219
  v_mfma_f32_16x16x32_bf16 a[100:103], a[176:179], v[188:191], a[100:103]
  s_add_u32 s27, s27, 16384
  v_exp_f32 v223, v143
  v_mfma_f32_16x16x32_bf16 a[104:107], a[180:183], v[184:187], a[104:107]
  s_add_u32 s25, s25, 32768
  ds_read_b128 a[148:151], v3 offset:13312
  v_add_f32 v227, v227, v220
  v_mfma_f32_16x16x32_bf16 a[108:111], a[180:183], v[188:191], a[108:111]
  s_and_b32 s25, s25, 0x1ffff
  v_add_f32 v227, v227, v221
  v_cvt_pk_bf16_f32 v182, v220, v221
  v_add_f32 v227, v227, v222
  v_mfma_f32_16x16x32_bf16 a[112:115], a[184:187], v[184:187], a[112:115]
  ds_read_b128 a[152:155], v3 offset:14336
  v_add_f32 v227, v227, v223
  v_max_f32 v5, v226, v227
  v_cmp_lt_f32 vcc, s81, v5
  v_mfma_f32_16x16x32_bf16 a[116:119], a[184:187], v[188:191], a[116:119]
  v_exp_f32 v216, v144
  v_mfma_f32_16x16x32_bf16 a[120:123], a[188:191], v[184:187], a[120:123]
  s_waitcnt lgkmcnt(3)
  ds_read_b128 a[156:159], v3 offset:15360
  v_cvt_pk_bf16_f32 v183, v222, v223
  v_add_u32 v3, s66, v2
  v_mfma_f32_16x16x32_bf16 a[124:127], a[188:191], v[188:191], a[124:127]
  s_cbranch_vccnz fa_stub19
fa_back19:
  v_exp_f32 v217, v145
  v_add_f32 v230, v230, v226
  v_add_f32 v231, v231, v227
fa_SSW4:
  v_mfma_f32_16x16x32_bf16 v[128:131], a[128:131], v[64:67], v[200:203]
  s_waitcnt vmcnt(12)
  v_exp_f32 v218, v146
  v_mfma_f32_16x16x32_bf16 v[136:139], a[128:131], v[68:71], v[204:207]
  s_barrier
  v_exp_f32 v219, v147
  v_mfma_f32_16x16x32_bf16 v[132:135], a[132:135], v[64:67], v[200:203]
  ds_read_b128 a[160:163], v3 offset:16384
  ds_read_b128 a[164:167], v3 offset:17408
  v_add_f32 v226, v216, v217
  v_mfma_f32_16x16x32_bf16 v[140:143], a[132:135], v[68:71], v[204:207]
  s_mov_b32 m0, s24
  v_exp_f32 v220, v148
  v_mfma_f32_16x16x32_bf16 v[128:131], a[136:139], v[72:75], v[128:131]
  ds_read_b128 a[168:171], v3 offset:18432
  buffer_load_dwordx4 v2, s[44:47], s26 offen offset:0 sc1 lds
  v_cvt_pk_bf16_f32 v184, v216, v217
  v_mfma_f32_16x16x32_bf16 v[136:139], a[136:139], v[76:79], v[136:139]
  v_exp_f32 v221, v149
  v_mfma_f32_16x16x32_bf16 v[132:135], a[140:143], v[72:75], v[132:135]
  s_add_u32 s14, s13, 57344
  ds_read_b128 a[172:175], v3 offset:19456
  buffer_load_dwordx4 a[60:63], v2, s[40:43], s14 offen offset:3072 sc1
  v_add_f32 v226, v226, v218
  v_add_f32 v226, v226, v219
  v_mfma_f32_16x16x32_bf16 v[140:143], a[140:143], v[76:79], v[140:143]
  s_waitcnt lgkmcnt(4)
  v_exp_f32 v222, v150
  v_mfma_f32_16x16x32_bf16 v[128:131], a[144:147], v[80:83], v[128:131]
  ds_read_b128 a[176:179], v3 offset:20480
  v_cvt_pk_bf16_f32 v185, v218, v219
  v_mfma_f32_16x16x32_bf16 v[136:139], a[144:147], v[84:87], v[136:139]
  v_exp_f32 v223, v151
  v_mfma_f32_16x16x32_bf16 v[132:135], a[148:151], v[80:83], v[132:135]
  ds_read_b128 a[180:183], v3 offset:21504
  buffer_load_dwordx4 v2, s[44:47], s26 offen offset:1024 sc1 lds
  v_add_f32 v226, v226, v220
  v_mfma_f32_16x16x32_bf16 v[140:143], a[148:151], v[84:87], v[140:143]
  v_exp_f32 v216, v152
  v_mfma_f32_16x16x32_bf16 v[128:131], a[152:155], v[88:91], v[128:131]
  ds_read_b128 a[184:187], v3 offset:22528
  v_add_f32 v226, v226, v221
  v_cvt_pk_bf16_f32 v186, v220, v221
  v_mfma_f32_16x16x32_bf16 v[136:139], a[152:155], v[92:95], v[136:139]
  v_exp_f32 v217, v153
  v_mfma_f32_16x16x32_bf16 v[132:135], a[156:159], v[88:91], v[132:135]
  ds_read_b128 a[188:191], v3 offset:23552
  buffer_load_dwordx4 a[56:59], v2, s[40:43], s14 offen offset:2048 sc1
  v_add_f32 v226, v226, v222
  v_mfma_f32_16x16x32_bf16 v[140:143], a[156:159], v[92:95], v[140:143]
  s_waitcnt lgkmcnt(4)
  v_exp_f32 v218, v154
  v_mfma_f32_16x16x32_bf16 a[64:67], a[160:163], v[176:179], a[64:67]
  ds_read_b128 a[128:131], v3 offset:0
  v_add_f32 v226, v226, v223
  v_cvt_pk_bf16_f32 v187, v222, v223
  v_mfma_f32_16x16x32_bf16 a[68:71], a[160:163], v[180:183], a[68:71]
  v_exp_f32 v219, v155
  v_mfma_f32_16x16x32_bf16 a[72:75], a[164:167], v[176:179], a[72:75]
  ds_read_b128 a[132:135], v3 offset:1024
  buffer_load_dwordx4 v2, s[44:47], s26 offen offset:2048 sc1 lds
  v_add_f32 v227, v216, v217
  v_mfma_f32_16x16x32_bf16 a[76:79], a[164:167], v[180:183], a[76:79]
  v_exp_f32 v220, v156
  v_mfma_f32_16x16x32_bf16 a[80:83], a[168:171], v[176:179], a[80:83]
  ds_read_b128 a[136:139], v3 offset:2048
  buffer_load_dwordx4 a[52:55], v2, s[40:43], s14 offen offset:1024 sc1
  v_cvt_pk_bf16_f32 v188, v216, v217
  v_mfma_f32_16x16x32_bf16 a[84:87], a[168:171], v[180:183], a[84:87]
  v_exp_f32 v221, v157
  v_mfma_f32_16x16x32_bf16 a[88:91], a[172:175], v[176:179], a[88:91]
  ds_read_b128 a[140:143], v3 offset:3072
  v_add_f32 v227, v227, v218
  v_add_f32 v227, v227, v219
  v_mfma_f32_16x16x32_bf16 a[92:95], a[172:175], v[180:183], a[92:95]
  s_waitcnt lgkmcnt(4)
  v_exp_f32 v222, v158
  v_mfma_f32_16x16x32_bf16 a[96:99], a[176:179], v[176:179], a[96:99]
  ds_read_b128 a[144:147], v3 offset:4096
  buffer_load_dwordx4 v2, s[44:47], s26 offen offset:3072 sc1 lds
  v_cvt_pk_bf16_f32 v189, v218, v219
  v_mfma_f32_16x16x32_bf16 a[100:103], a[176:179], v[180:183], a[100:103]
  s_add_u32 s26, s26, 16384
  v_exp_f32 v223, v159
  v_mfma_f32_16x16x32_bf16 a[104:107], a[180:183], v[176:179], a[104:107]
  s_add_u32 s24, s24, 32768
  ds_read_b128 a[148:151], v3 offset:5120
  buffer_load_dwordx4 a[48:51], v2, s[40:43], s14 offen offset:0 sc1
  v_add_f32 v227, v227, v220
  v_mfma_f32_16x16x32_bf16 a[108:111], a[180:183], v[180:183], a[108:111]
  s_and_b32 s24, s24, 0x1ffff
  v_add_f32 v227, v227, v221
  v_cvt_pk_bf16_f32 v190, v220, v221
  v_add_f32 v227, v227, v222
  v_mfma_f32_16x16x32_bf16 a[112:115], a[184:187], v[176:179], a[112:115]
  ds_read_b128 a[152:155], v3 offset:6144
  v_add_f32 v227, v227, v223
  v_max_f32 v5, v226, v227
  v_cmp_lt_f32 vcc, s81, v5
  v_mfma_f32_16x16x32_bf16 a[116:119], a[184:187], v[180:183], a[116:119]
  v_exp_f32 v216, v128
  v_mfma_f32_16x16x32_bf16 a[120:123], a[188:191], v[176:179], a[120:123]
  s_waitcnt lgkmcnt(3)
  ds_read_b128 a[156:159], v3 offset:7168
  v_cvt_pk_bf16_f32 v191, v222, v223
  v_mfma_f32_16x16x32_bf16 a[124:127], a[188:191], v[180:183], a[124:127]
  s_cbranch_vccnz fa_stub20
fa_back20:
  v_exp_f32 v217, v129
  v_add_f32 v230, v230, v226
  v_add_f32 v231, v231, v227
  v_mfma_f32_16x16x32_bf16 v[144:147], a[128:131], v[64:67], v[200:203]
  ds_read_b128 a[160:163], v3 offset:24576
  v_add_f32 v226, v216, v217
  v_mfma_f32_16x16x32_bf16 v[152:155], a[128:131], v[68:71], v[204:207]
  v_exp_f32 v218, v130
  v_mfma_f32_16x16x32_bf16 v[148:151], a[132:135], v[64:67], v[200:203]
  s_add_u32 s66, s66, 32768
  ds_read_b128 a[164:167], v3 offset:25600
  v_cvt_pk_bf16_f32 v176, v216, v217
  v_mfma_f32_16x16x32_bf16 v[156:159], a[132:135], v[68:71], v[204:207]
  s_mov_b32 m0, s25
  v_exp_f32 v219, v131
  v_mfma_f32_16x16x32_bf16 v[144:147], a[136:139], v[72:75], v[144:147]
  s_and_b32 s66, s66, 0x1ffff
  ds_read_b128 a[168:171], v3 offset:26624
  buffer_load_dwordx4 v2, s[48:51], s27 offen offset:0 sc1 lds
  v_add_f32 v226, v226, v218
  v_add_f32 v226, v226, v219
  v_mfma_f32_16x16x32_bf16 v[152:155], a[136:139], v[76:79], v[152:155]
  v_exp_f32 v220, v132
  v_mfma_f32_16x16x32_bf16 v[148:151], a[140:143], v[72:75], v[148:151]
  s_add_u32 s14, s13, 45056
  ds_read_b128 a[172:175], v3 offset:27648
  buffer_load_dwordx4 a[44:47], v2, s[40:43], s14 offen offset:3072 sc1
  v_cvt_pk_bf16_f32 v177, v218, v219
  v_mfma_f32_16x16x32_bf16 v[156:159], a[140:143], v[76:79], v[156:159]
  s_waitcnt lgkmcnt(4)
  v_exp_f32 v221, v133
  v_mfma_f32_16x16x32_bf16 v[144:147], a[144:147], v[80:83], v[144:147]
  ds_read_b128 a[176:179], v3 offset:28672
  v_add_f32 v226, v226, v220
  v_mfma_f32_16x16x32_bf16 v[152:155], a[144:147], v[84:87], v[152:155]
  v_exp_f32 v222, v134
  v_mfma_f32_16x16x32_bf16 v[148:151], a[148:151], v[80:83], v[148:151]
  ds_read_b128 a[180:183], v3 offset:29696
  buffer_load_dwordx4 v2, s[48:51], s27 offen offset:1024 sc1 lds
  v_add_f32 v226, v226, v221
  v_cvt_pk_bf16_f32 v178, v220, v221
  v_mfma_f32_16x16x32_bf16 v[156:159], a[148:151], v[84:87], v[156:159]
  v_exp_f32 v223, v135
  v_mfma_f32_16x16x32_bf16 v[144:147], a[152:155], v[88:91], v[144:147]
  ds_read_b128 a[184:187], v3 offset:30720
  v_add_f32 v226, v226, v222
  v_mfma_f32_16x16x32_bf16 v[152:155], a[152:155], v[92:95], v[152:155]
  v_exp_f32 v216, v136
  v_mfma_f32_16x16x32_bf16 v[148:151], a[156:159], v[88:91], v[148:151]
  ds_read_b128 a[188:191], v3 offset:31744
  buffer_load_dwordx4 a[40:43], v2, s[40:43], s14 offen offset:2048 sc1
  v_add_f32 v226, v226, v223
  v_exp_f32 v217, v137
  v_mfma_f32_16x16x32_bf16 v[156:159], a[156:159], v[92:95], v[156:159]
  s_waitcnt lgkmcnt(4)
  v_exp_f32 v218, v138
  v_mfma_f32_16x16x32_bf16 a[64:67], a[160:163], v[184:187], a[64:67]
  ds_read_b128 a[128:131], v3 offset:8192
  v_cvt_pk_bf16_f32 v179, v222, v223
  v_mfma_f32_16x16x32_bf16 a[68:71], a[160:163], v[188:191], a[68:71]
  v_exp_f32 v219, v139
  v_mfma_f32_16x16x32_bf16 a[72:75], a[164:167], v[184:187], a[72:75]
  ds_read_b128 a[132:135], v3 offset:9216
  buffer_load_dwordx4 v2, s[48:51], s27 offen offset:2048 sc1 lds
  v_add_f32 v227, v216, v217
  v_mfma_f32_16x16x32_bf16 a[76:79], a[164:167], v[188:191], a[76:79]
  v_exp_f32 v220, v140
  v_mfma_f32_16x16x32_bf16 a[80:83], a[168:171], v[184:187], a[80:83]
  ds_read_b128 a[136:139], v3 offset:10240
  buffer_load_dwordx4 a[36:39], v2, s[40:43], s14 offen offset:1024 sc1
  v_cvt_pk_bf16_f32 v180, v216, v217
  v_mfma_f32_16x16x32_bf16 a[84:87], a[168:171], v[188:191], a[84:87]
  v_exp_f32 v221, v141
  v_mfma_f32_16x16x32_bf16 a[88:91], a[172:175], v[184:187], a[88:91]
  ds_read_b128 a[140:143], v3 offset:11264
  v_add_f32 v227, v227, v218
  v_mfma_f32_16x16x32_bf16 a[92:95], a[172:175], v[188:191], a[92:95]
  s_waitcnt lgkmcnt(4)
  v_exp_f32 v222, v142
  v_mfma_f32_16x16x32_bf16 a[96:99], a[176:179], v[184:187], a[96:99]
  ds_read_b128 a[144:147], v3 offset:12288
  buffer_load_dwordx4 v2, s[48:51], s27 offen offset:3072 sc1 lds
  v_add_f32 v227, v227, v219
  v_cvt_pk_bf16_f32 v181, v218, v219
  v_mfma_f32_16x16x32_bf16 a[100:103], a[176:179], v[188:191], a[100:103]
  s_add_u32 s27, s27, 16384
  v_exp_f32 v223, v143
  v_mfma_f32_16x16x32_bf16 a[104:107], a[180:183], v[184:187], a[104:107]
  s_add_u32 s25, s25, 32768
  ds_read_b128 a[148:151], v3 offset:13312
  buffer_load_dwordx4 a[32:35], v2, s[40:43], s14 offen offset:0 sc1
  v_add_f32 v227, v227, v220
  v_mfma_f32_16x16x32_bf16 a[108:111], a[180:183], v[188:191], a[108:111]
  s_and_b32 s25, s25, 0x1ffff
  v_add_f32 v227, v227, v221
  v_cvt_pk_bf16_f32 v182, v220, v221
  v_add_f32 v227, v227, v222
  v_mfma_f32_16x16x32_bf16 a[112:115], a[184:187], v[184:187], a[112:115]
  ds_read_b128 a[152:155], v3 offset:14336
  v_add_f32 v227, v227, v223
  v_max_f32 v5, v226, v227
  v_cmp_lt_f32 vcc, s81, v5
  v_mfma_f32_16x16x32_bf16 a[116:119], a[184:187], v[188:191], a[116:119]
  v_exp_f32 v216, v144
  v_mfma_f32_16x16x32_bf16 a[120:123], a[188:191], v[184:187], a[120:123]
  s_waitcnt lgkmcnt(3)
  ds_read_b128 a[156:159], v3 offset:15360
  v_cvt_pk_bf16_f32 v183, v222, v223
  v_add_u32 v3, s66, v2
  v_mfma_f32_16x16x32_bf16 a[124:127], a[188:191], v[188:191], a[124:127]
  s_cbranch_vccnz fa_stub21
fa_back21:
  v_exp_f32 v217, v145
  v_add_f32 v230, v230, v226
  v_add_f32 v231, v231, v227
fa_SSW3:
  v_mfma_f32_16x16x32_bf16 v[128:131], a[128:131], v[64:67], v[200:203]
  s_waitcnt vmcnt(12)
  v_exp_f32 v218, v146
  v_mfma_f32_16x16x32_bf16 v[136:139], a[128:131], v[68:71], v[204:207]
  s_barrier
  v_exp_f32 v219, v147
  v_mfma_f32_16x16x32_bf16 v[132:135], a[132:135], v[64:67], v[200:203]
  s_cmp_ge_u32 s26, s46
  s_cselect_b64 s[44:45], s[4:5], s[44:45]
  s_cselect_b32 s46, s30, s46
  ds_read_b128 a[160:163], v3 offset:16384
  ds_read_b128 a[164:167], v3 offset:17408
  v_add_f32 v226, v216, v217
  v_mfma_f32_16x16x32_bf16 v[140:143], a[132:135], v[68:71], v[204:207]
  s_mov_b32 m0, s24
  v_exp_f32 v220, v148
  v_mfma_f32_16x16x32_bf16 v[128:131], a[136:139], v[72:75], v[128:131]
  ds_read_b128 a[168:171], v3 offset:18432
  buffer_load_dwordx4 v2, s[44:47], s26 offen offset:0 sc1 lds
  v_cvt_pk_bf16_f32 v184, v216, v217
  v_mfma_f32_16x16x32_bf16 v[136:139], a[136:139], v[76:79], v[136:139]
  v_exp_f32 v221, v149
  v_mfma_f32_16x16x32_bf16 v[132:135], a[140:143], v[72:75], v[132:135]
  s_add_u32 s14, s13, 40960
  ds_read_b128 a[172:175], v3 offset:19456
  buffer_load_dwordx4 a[28:31], v2, s[40:43], s14 offen offset:3072 sc1
  v_add_f32 v226, v226, v218
  v_add_f32 v226, v226, v219
  v_mfma_f32_16x16x32_bf16 v[140:143], a[140:143], v[76:79], v[140:143]
  s_waitcnt lgkmcnt(4)
  v_exp_f32 v222, v150
  v_mfma_f32_16x16x32_bf16 v[128:131], a[144:147], v[80:83], v[128:131]
  ds_read_b128 a[176:179], v3 offset:20480
  v_cvt_pk_bf16_f32 v185, v218, v219
  v_mfma_f32_16x16x32_bf16 v[136:139], a[144:147], v[84:87], v[136:139]
  v_exp_f32 v223, v151
  v_mfma_f32_16x16x32_bf16 v[132:135], a[148:151], v[80:83], v[132:135]
  ds_read_b128 a[180:183], v3 offset:21504
  buffer_load_dwordx4 v2, s[44:47], s26 offen offset:1024 sc1 lds
  v_add_f32 v226, v226, v220
  v_mfma_f32_16x16x32_bf16 v[140:143], a[148:151], v[84:87], v[140:143]
  v_exp_f32 v216, v152
  v_mfma_f32_16x16x32_bf16 v[128:131], a[152:155], v[88:91], v[128:131]
  ds_read_b128 a[184:187], v3 offset:22528
  v_add_f32 v226, v226, v221
  v_cvt_pk_bf16_f32 v186, v220, v221
  v_mfma_f32_16x16x32_bf16 v[136:139], a[152:155], v[92:95], v[136:139]
  v_exp_f32 v217, v153
  v_mfma_f32_16x16x32_bf16 v[132:135], a[156:159], v[88:91], v[132:135]
  ds_read_b128 a[188:191], v3 offset:23552
  buffer_load_dwordx4 a[24:27], v2, s[40:43], s14 offen offset:2048 sc1
  v_add_f32 v226, v226, v222
  v_mfma_f32_16x16x32_bf16 v[140:143], a[156:159], v[92:95], v[140:143]
  s_waitcnt lgkmcnt(4)
  v_exp_f32 v218, v154
  v_mfma_f32_16x16x32_bf16 a[64:67], a[160:163], v[176:179], a[64:67]
  ds_read_b128 a[128:131], v3 offset:0
  v_add_f32 v226, v226, v223
  v_cvt_pk_bf16_f32 v187, v222, v223
  v_mfma_f32_16x16x32_bf16 a[68:71], a[160:163], v[180:183], a[68:71]
  v_exp_f32 v219, v155
  v_mfma_f32_16x16x32_bf16 a[72:75], a[164:167], v[176:179], a[72:75]
  ds_read_b128 a[132:135], v3 offset:1024
  buffer_load_dwordx4 v2, s[44:47], s26 offen offset:2048 sc1 lds
  v_add_f32 v227, v216, v217
  v_mfma_f32_16x16x32_bf16 a[76:79], a[164:167], v[180:183], a[76:79]
  v_exp_f32 v220, v156
  v_mfma_f32_16x16x32_bf16 a[80:83], a[168:171], v[176:179], a[80:83]
  ds_read_b128 a[136:139], v3 offset:2048
  buffer_load_dwordx4 a[20:23], v2, s[40:43], s14 offen offset:1024 sc1
  v_cvt_pk_bf16_f32 v188, v216, v217
  v_mfma_f32_16x16x32_bf16 a[84:87], a[168:171], v[180:183], a[84:87]
  v_exp_f32 v221, v157
  v_mfma_f32_16x16x32_bf16 a[88:91], a[172:175], v[176:179], a[88:91]
  ds_read_b128 a[140:143], v3 offset:3072
  v_add_f32 v227, v227, v218
  v_add_f32 v227, v227, v219
  v_mfma_f32_16x16x32_bf16 a[92:95], a[172:175], v[180:183], a[92:95]
  s_waitcnt lgkmcnt(4)
  v_exp_f32 v222, v158
  v_mfma_f32_16x16x32_bf16 a[96:99], a[176:179], v[176:179], a[96:99]
  ds_read_b128 a[144:147], v3 offset:4096
  buffer_load_dwordx4 v2, s[44:47], s26 offen offset:3072 sc1 lds
  v_cvt_pk_bf16_f32 v189, v218, v219
  v_mfma_f32_16x16x32_bf16 a[100:103], a[176:179], v[180:183], a[100:103]
  s_add_u32 s26, s26, 16384
  v_exp_f32 v223, v159
  v_mfma_f32_16x16x32_bf16 a[104:107], a[180:183], v[176:179], a[104:107]
  s_add_u32 s24, s24, 32768
  ds_read_b128 a[148:151], v3 offset:5120
  buffer_load_dwordx4 a[16:19], v2, s[40:43], s14 offen offset:0 sc1
  v_add_f32 v227, v227, v220
  v_mfma_f32_16x16x32_bf16 a[108:111], a[180:183], v[180:183], a[108:111]
  s_and_b32 s24, s24, 0x1ffff
  v_add_f32 v227, v227, v221
  v_cvt_pk_bf16_f32 v190, v220, v221
  v_add_f32 v227, v227, v222
  v_mfma_f32_16x16x32_bf16 a[112:115], a[184:187], v[176:179], a[112:115]
  ds_read_b128 a[152:155], v3 offset:6144
  v_add_f32 v227, v227, v223
  v_max_f32 v5, v226, v227
  v_cmp_lt_f32 vcc, s81, v5
  v_mfma_f32_16x16x32_bf16 a[116:119], a[184:187], v[180:183], a[116:119]
  v_exp_f32 v216, v128
  v_mfma_f32_16x16x32_bf16 a[120:123], a[188:191], v[176:179], a[120:123]
  s_waitcnt lgkmcnt(3)
  ds_read_b128 a[156:159], v3 offset:7168
  v_cvt_pk_bf16_f32 v191, v222, v223
  v_mfma_f32_16x16x32_bf16 a[124:127], a[188:191], v[180:183], a[124:127]
  s_cbranch_vccnz fa_stub22
fa_back22:
  v_exp_f32 v217, v129
  v_add_f32 v230, v230, v226
  v_add_f32 v231, v231, v227
  v_mfma_f32_16x16x32_bf16 v[144:147], a[128:131], v[64:67], v[200:203]
  ds_read_b128 a[160:163], v3 offset:24576
  v_add_f32 v226, v216, v217
  v_mfma_f32_16x16x32_bf16 v[152:155], a[128:131], v[68:71], v[204:207]
  v_exp_f32 v218, v130
  v_mfma_f32_16x16x32_bf16 v[148:151], a[132:135], v[64:67], v[200:203]
  s_cmp_ge_u32 s27, s50
  s_cselect_b64 s[48:49], s[6:7], s[48:49]
  s_cselect_b32 s50, s30, s50
  ds_read_b128 a[164:167], v3 offset:25600
  v_cvt_pk_bf16_f32 v176, v216, v217
  v_mfma_f32_16x16x32_bf16 v[156:159], a[132:135], v[68:71], v[204:207]
  s_mov_b32 m0, s25
  v_exp_f32 v219, v131
  v_mfma_f32_16x16x32_bf16 v[144:147], a[136:139], v[72:75], v[144:147]
  s_add_u32 s66, s66, 32768
  ds_read_b128 a[168:171], v3 offset:26624
  buffer_load_dwordx4 v2, s[48:51], s27 offen offset:0 sc1 lds
  v_add_f32 v226, v226, v218
  v_add_f32 v226, v226, v219
  v_mfma_f32_16x16x32_bf16 v[152:155], a[136:139], v[76:79], v[152:155]
  s_and_b32 s66, s66, 0x1ffff
  v_exp_f32 v220, v132
  v_mfma_f32_16x16x32_bf16 v[148:151], a[140:143], v[72:75], v[148:151]
  s_add_u32 s14, s13, 28672
  ds_read_b128 a[172:175], v3 offset:27648
  buffer_load_dwordx4 a[12:15], v2, s[40:43], s14 offen offset:3072 sc1
  v_cvt_pk_bf16_f32 v177, v218, v219
  v_mfma_f32_16x16x32_bf16 v[156:159], a[140:143], v[76:79], v[156:159]
  s_waitcnt lgkmcnt(4)
  v_exp_f32 v221, v133
  v_mfma_f32_16x16x32_bf16 v[144:147], a[144:147], v[80:83], v[144:147]
  ds_read_b128 a[176:179], v3 offset:28672
  v_add_f32 v226, v226, v220
  v_mfma_f32_16x16x32_bf16 v[152:155], a[144:147], v[84:87], v[152:155]
  v_exp_f32 v222, v134
  v_mfma_f32_16x16x32_bf16 v[148:151], a[148:151], v[80:83], v[148:151]
  ds_read_b128 a[180:183], v3 offset:29696
  buffer_load_dwordx4 v2, s[48:51], s27 offen offset:1024 sc1 lds
  v_add_f32 v226, v226, v221
  v_cvt_pk_bf16_f32 v178, v220, v221
  v_mfma_f32_16x16x32_bf16 v[156:159], a[148:151], v[84:87], v[156:159]
  v_exp_f32 v223, v135
  v_mfma_f32_16x16x32_bf16 v[144:147], a[152:155], v[88:91], v[144:147]
  ds_read_b128 a[184:187], v3 offset:30720
  v_add_f32 v226, v226, v222
  v_mfma_f32_16x16x32_bf16 v[152:155], a[152:155], v[92:95], v[152:155]
  v_exp_f32 v216, v136
  v_mfma_f32_16x16x32_bf16 v[148:151], a[156:159], v[88:91], v[148:151]
  ds_read_b128 a[188:191], v3 offset:31744
  buffer_load_dwordx4 a[8:11], v2, s[40:43], s14 offen offset:2048 sc1
  v_add_f32 v226, v226, v223
  v_exp_f32 v217, v137
  v_mfma_f32_16x16x32_bf16 v[156:159], a[156:159], v[92:95], v[156:159]
  s_waitcnt lgkmcnt(4)
  v_exp_f32 v218, v138
  v_mfma_f32_16x16x32_bf16 a[64:67], a[160:163], v[184:187], a[64:67]
  ds_read_b128 a[128:131], v3 offset:8192
  v_cvt_pk_bf16_f32 v179, v222, v223
  v_mfma_f32_16x16x32_bf16 a[68:71], a[160:163], v[188:191], a[68:71]
  v_exp_f32 v219, v139
  v_mfma_f32_16x16x32_bf16 a[72:75], a[164:167], v[184:187], a[72:75]
  ds_read_b128 a[132:135], v3 offset:9216
  buffer_load_dwordx4 v2, s[48:51], s27 offen offset:2048 sc1 lds
  v_add_f32 v227, v216, v217
  v_mfma_f32_16x16x32_bf16 a[76:79], a[164:167], v[188:191], a[76:79]
  v_exp_f32 v220, v140
  v_mfma_f32_16x16x32_bf16 a[80:83], a[168:171], v[184:187], a[80:83]
  ds_read_b128 a[136:139], v3 offset:10240
  buffer_load_dwordx4 a[4:7], v2, s[40:43], s14 offen offset:1024 sc1
  v_cvt_pk_bf16_f32 v180, v216, v217
  v_mfma_f32_16x16x32_bf16 a[84:87], a[168:171], v[188:191], a[84:87]
  v_exp_f32 v221, v141
  v_mfma_f32_16x16x32_bf16 a[88:91], a[172:175], v[184:187], a[88:91]
  ds_read_b128 a[140:143], v3 offset:11264
  v_add_f32 v227, v227, v218
  v_mfma_f32_16x16x32_bf16 a[92:95], a[172:175], v[188:191], a[92:95]
  s_waitcnt lgkmcnt(4)
  v_exp_f32 v222, v142
  v_mfma_f32_16x16x32_bf16 a[96:99], a[176:179], v[184:187], a[96:99]
  ds_read_b128 a[144:147], v3 offset:12288
  buffer_load_dwordx4 v2, s[48:51], s27 offen offset:3072 sc1 lds
  v_add_f32 v227, v227, v219
  v_cvt_pk_bf16_f32 v181, v218, v219
  v_mfma_f32_16x16x32_bf16 a[100:103], a[176:179], v[188:191], a[100:103]
  s_add_u32 s27, s27, 16384
  v_exp_f32 v223, v143
  v_mfma_f32_16x16x32_bf16 a[104:107], a[180:183], v[184:187], a[104:107]
  s_add_u32 s25, s25, 32768
  ds_read_b128 a[148:151], v3 offset:13312
  buffer_load_dwordx4 a[0:3], v2, s[40:43], s14 offen offset:0 sc1
  v_add_f32 v227, v227, v220
  v_mfma_f32_16x16x32_bf16 a[108:111], a[180:183], v[188:191], a[108:111]
  s_and_b32 s25, s25, 0x1ffff
  v_add_f32 v227, v227, v221
  v_cvt_pk_bf16_f32 v182, v220, v221
  v_add_f32 v227, v227, v222
  v_mfma_f32_16x16x32_bf16 a[112:115], a[184:187], v[184:187], a[112:115]
  ds_read_b128 a[152:155], v3 offset:14336
  v_add_f32 v227, v227, v223
  v_max_f32 v5, v226, v227
  v_cmp_lt_f32 vcc, s81, v5
  v_mfma_f32_16x16x32_bf16 a[116:119], a[184:187], v[188:191], a[116:119]
  v_exp_f32 v216, v144
  v_mfma_f32_16x16x32_bf16 a[120:123], a[188:191], v[184:187], a[120:123]
  s_waitcnt lgkmcnt(3)
  ds_read_b128 a[156:159], v3 offset:15360
  v_cvt_pk_bf16_f32 v183, v222, v223
  v_add_u32 v3, s66, v2
  v_mfma_f32_16x16x32_bf16 a[124:127], a[188:191], v[188:191], a[124:127]
  s_cbranch_vccnz fa_stub23
fa_back23:
  v_exp_f32 v217, v145
  v_add_f32 v230, v230, v226
  v_add_f32 v231, v231, v227
fa_SSW2:
  v_mfma_f32_16x16x32_bf16 v[128:131], a[128:131], v[64:67], v[200:203]
  s_waitcnt vmcnt(12)
  v_exp_f32 v218, v146
  v_mfma_f32_16x16x32_bf16 v[136:139], a[128:131], v[68:71], v[204:207]
  s_barrier
  v_exp_f32 v219, v147
  v_mfma_f32_16x16x32_bf16 v[132:135], a[132:135], v[64:67], v[200:203]
  s_cmp_ge_u32 s26, s46
  s_cselect_b64 s[44:45], s[4:5], s[44:45]
  s_cselect_b32 s46, s30, s46
  ds_read_b128 a[160:163], v3 offset:16384
  ds_read_b128 a[164:167], v3 offset:17408
  v_add_f32 v226, v216, v217
  v_mfma_f32_16x16x32_bf16 v[140:143], a[132:135], v[68:71], v[204:207]
  s_mov_b32 m0, s24
  v_exp_f32 v220, v148
  v_mfma_f32_16x16x32_bf16 v[128:131], a[136:139], v[72:75], v[128:131]
  ds_read_b128 a[168:171], v3 offset:18432
  buffer_load_dwordx4 v2, s[44:47], s26 offen offset:0 sc1 lds
  v_cvt_pk_bf16_f32 v184, v216, v217
  v_mfma_f32_16x16x32_bf16 v[136:139], a[136:139], v[76:79], v[136:139]
  v_exp_f32 v221, v149
  v_mfma_f32_16x16x32_bf16 v[132:135], a[140:143], v[72:75], v[132:135]
  s_add_u32 s14, s13, 24576
  ds_read_b128 a[172:175], v3 offset:19456
  buffer_load_dwordx4 v[212:215], v2, s[40:43], s14 offen offset:3072 sc1
  v_add_f32 v226, v226, v218
  v_add_f32 v226, v226, v219
  v_mfma_f32_16x16x32_bf16 v[140:143], a[140:143], v[76:79], v[140:143]
  s_waitcnt lgkmcnt(4)
  v_exp_f32 v222, v150
  v_mfma_f32_16x16x32_bf16 v[128:131], a[144:147], v[80:83], v[128:131]
  ds_read_b128 a[176:179], v3 offset:20480
  v_cvt_pk_bf16_f32 v185, v218, v219
  v_mfma_f32_16x16x32_bf16 v[136:139], a[144:147], v[84:87], v[136:139]
  v_exp_f32 v223, v151
  v_mfma_f32_16x16x32_bf16 v[132:135], a[148:151], v[80:83], v[132:135]
  ds_read_b128 a[180:183], v3 offset:21504
  buffer_load_dwordx4 v2, s[44:47], s26 offen offset:1024 sc1 lds
  v_add_f32 v226, v226, v220
  v_mfma_f32_16x16x32_bf16 v[140:143], a[148:151], v[84:87], v[140:143]
  v_exp_f32 v216, v152
  v_mfma_f32_16x16x32_bf16 v[128:131], a[152:155], v[88:91], v[128:131]
  ds_read_b128 a[184:187], v3 offset:22528
  v_add_f32 v226, v226, v221
  v_cvt_pk_bf16_f32 v186, v220, v221
  v_mfma_f32_16x16x32_bf16 v[136:139], a[152:155], v[92:95], v[136:139]
  v_exp_f32 v217, v153
  v_mfma_f32_16x16x32_bf16 v[132:135], a[156:159], v[88:91], v[132:135]
  ds_read_b128 a[188:191], v3 offset:23552
  buffer_load_dwordx4 v[208:211], v2, s[40:43], s14 offen offset:2048 sc1
  v_add_f32 v226, v226, v222
  v_mfma_f32_16x16x32_bf16 v[140:143], a[156:159], v[92:95], v[140:143]
  s_waitcnt lgkmcnt(4)
  v_exp_f32 v218, v154
  v_mfma_f32_16x16x32_bf16 a[64:67], a[160:163], v[176:179], a[64:67]
  ds_read_b128 a[128:131], v3 offset:0
  v_add_f32 v226, v226, v223
  v_cvt_pk_bf16_f32 v187, v222, v223
  v_mfma_f32_16x16x32_bf16 a[68:71], a[160:163], v[180:183], a[68:71]
  v_exp_f32 v219, v155
  v_mfma_f32_16x16x32_bf16 a[72:75], a[164:167], v[176:179], a[72:75]
  ds_read_b128 a[132:135], v3 offset:1024
  buffer_load_dwordx4 v2, s[44:47], s26 offen offset:2048 sc1 lds
  v_add_f32 v227, v216, v217
  v_mfma_f32_16x16x32_bf16 a[76:79], a[164:167], v[180:183], a[76:79]
  v_exp_f32 v220, v156
  v_mfma_f32_16x16x32_bf16 a[80:83], a[168:171], v[176:179], a[80:83]
  ds_read_b128 a[136:139], v3 offset:2048
  buffer_load_dwordx4 v[196:199], v2, s[40:43], s14 offen offset:1024 sc1
  v_cvt_pk_bf16_f32 v188, v216, v217
  v_mfma_f32_16x16x32_bf16 a[84:87], a[168:171], v[180:183], a[84:87]
  v_exp_f32 v221, v157
  v_mfma_f32_16x16x32_bf16 a[88:91], a[172:175], v[176:179], a[88:91]
  ds_read_b128 a[140:143], v3 offset:3072
  v_add_f32 v227, v227, v218
  v_add_f32 v227, v227, v219
  v_mfma_f32_16x16x32_bf16 a[92:95], a[172:175], v[180:183], a[92:95]
  s_waitcnt lgkmcnt(4)
  v_exp_f32 v222, v158
  v_mfma_f32_16x16x32_bf16 a[96:99], a[176:179], v[176:179], a[96:99]
  ds_read_b128 a[144:147], v3 offset:4096
  buffer_load_dwordx4 v2, s[44:47], s26 offen offset:3072 sc1 lds
  v_cvt_pk_bf16_f32 v189, v218, v219
  v_mfma_f32_16x16x32_bf16 a[100:103], a[176:179], v[180:183], a[100:103]
  s_add_u32 s26, s26, 16384
  v_exp_f32 v223, v159
  v_mfma_f32_16x16x32_bf16 a[104:107], a[180:183], v[176:179], a[104:107]
  s_add_u32 s24, s24, 32768
  ds_read_b128 a[148:151], v3 offset:5120
  buffer_load_dwordx4 v[192:195], v2, s[40:43], s14 offen offset:0 sc1
  v_add_f32 v227, v227, v220
  v_mfma_f32_16x16x32_bf16 a[108:111], a[180:183], v[180:183], a[108:111]
  s_and_b32 s24, s24, 0x1ffff
  v_add_f32 v227, v227, v221
  v_cvt_pk_bf16_f32 v190, v220, v221
  v_add_f32 v227, v227, v222
  v_mfma_f32_16x16x32_bf16 a[112:115], a[184:187], v[176:179], a[112:115]
  ds_read_b128 a[152:155], v3 offset:6144
  v_add_f32 v227, v227, v223
  v_max_f32 v5, v226, v227
  v_cmp_lt_f32 vcc, s81, v5
  v_mfma_f32_16x16x32_bf16 a[116:119], a[184:187], v[180:183], a[116:119]
  v_exp_f32 v216, v128
  v_mfma_f32_16x16x32_bf16 a[120:123], a[188:191], v[176:179], a[120:123]
  s_waitcnt lgkmcnt(3)
  ds_read_b128 a[156:159], v3 offset:7168
  v_cvt_pk_bf16_f32 v191, v222, v223
  v_mfma_f32_16x16x32_bf16 a[124:127], a[188:191], v[180:183], a[124:127]
  s_cbranch_vccnz fa_stub24
fa_back24:
  v_exp_f32 v217, v129
  v_add_f32 v230, v230, v226
  v_add_f32 v231, v231, v227
  v_mfma_f32_16x16x32_bf16 v[144:147], a[128:131], v[64:67], v[200:203]
  ds_read_b128 a[160:163], v3 offset:24576
  v_add_f32 v226, v216, v217
  v_mfma_f32_16x16x32_bf16 v[152:155], a[128:131], v[68:71], v[204:207]
  v_exp_f32 v218, v130
  v_mfma_f32_16x16x32_bf16 v[148:151], a[132:135], v[64:67], v[200:203]
  s_cmp_ge_u32 s27, s50
  s_cselect_b64 s[48:49], s[6:7], s[48:49]
  s_cselect_b32 s50, s30, s50
  ds_read_b128 a[164:167], v3 offset:25600
  v_cvt_pk_bf16_f32 v176, v216, v217
  v_mfma_f32_16x16x32_bf16 v[156:159], a[132:135], v[68:71], v[204:207]
  s_mov_b32 m0, s25
  v_exp_f32 v219, v131
  v_mfma_f32_16x16x32_bf16 v[144:147], a[136:139], v[72:75], v[144:147]
  s_add_u32 s66, s66, 32768
  ds_read_b128 a[168:171], v3 offset:26624
  buffer_load_dwordx4 v2, s[48:51], s27 offen offset:0 sc1 lds
  v_add_f32 v226, v226, v218
  v_add_f32 v226, v226, v219
  v_mfma_f32_16x16x32_bf16 v[152:155], a[136:139], v[76:79], v[152:155]
  s_and_b32 s66, s66, 0x1ffff
  v_exp_f32 v220, v132
  v_mfma_f32_16x16x32_bf16 v[148:151], a[140:143], v[72:75], v[148:151]
  s_add_u32 s14, s13, 20480
  ds_read_b128 a[172:175], v3 offset:27648
  buffer_load_dwordx4 v[244:247], v2, s[40:43], s14 offen offset:3072 sc1
  v_cvt_pk_bf16_f32 v177, v218, v219
  v_mfma_f32_16x16x32_bf16 v[156:159], a[140:143], v[76:79], v[156:159]
  s_waitcnt lgkmcnt(4)
  v_exp_f32 v221, v133
  v_mfma_f32_16x16x32_bf16 v[144:147], a[144:147], v[80:83], v[144:147]
  ds_read_b128 a[176:179], v3 offset:28672
  v_add_f32 v226, v226, v220
  v_mfma_f32_16x16x32_bf16 v[152:155], a[144:147], v[84:87], v[152:155]
  v_exp_f32 v222, v134
  v_mfma_f32_16x16x32_bf16 v[148:151], a[148:151], v[80:83], v[148:151]
  ds_read_b128 a[180:183], v3 offset:29696
  buffer_load_dwordx4 v2, s[48:51], s27 offen offset:1024 sc1 lds
  v_add_f32 v226, v226, v221
  v_cvt_pk_bf16_f32 v178, v220, v221
  v_mfma_f32_16x16x32_bf16 v[156:159], a[148:151], v[84:87], v[156:159]
  v_exp_f32 v223, v135
  v_mfma_f32_16x16x32_bf16 v[144:147], a[152:155], v[88:91], v[144:147]
  ds_read_b128 a[184:187], v3 offset:30720
  v_add_f32 v226, v226, v222
  v_mfma_f32_16x16x32_bf16 v[152:155], a[152:155], v[92:95], v[152:155]
  v_exp_f32 v216, v136
  v_mfma_f32_16x16x32_bf16 v[148:151], a[156:159], v[88:91], v[148:151]
  ds_read_b128 a[188:191], v3 offset:31744
  buffer_load_dwordx4 v[240:243], v2, s[40:43], s14 offen offset:2048 sc1
  v_add_f32 v226, v226, v223
  v_exp_f32 v217, v137
  v_mfma_f32_16x16x32_bf16 v[156:159], a[156:159], v[92:95], v[156:159]
  s_waitcnt lgkmcnt(4)
  v_exp_f32 v218, v138
  v_mfma_f32_16x16x32_bf16 a[64:67], a[160:163], v[184:187], a[64:67]
  ds_read_b128 a[128:131], v3 offset:8192
  v_cvt_pk_bf16_f32 v179, v222, v223
  v_mfma_f32_16x16x32_bf16 a[68:71], a[160:163], v[188:191], a[68:71]
  v_exp_f32 v219, v139
  v_mfma_f32_16x16x32_bf16 a[72:75], a[164:167], v[184:187], a[72:75]
  ds_read_b128 a[132:135], v3 offset:9216
  buffer_load_dwordx4 v2, s[48:51], s27 offen offset:2048 sc1 lds
  v_add_f32 v227, v216, v217
  v_mfma_f32_16x16x32_bf16 a[76:79], a[164:167], v[188:191], a[76:79]
  v_exp_f32 v220, v140
  v_mfma_f32_16x16x32_bf16 a[80:83], a[168:171], v[184:187], a[80:83]
  ds_read_b128 a[136:139], v3 offset:10240
  buffer_load_dwordx4 v[236:239], v2, s[40:43], s14 offen offset:1024 sc1
  v_cvt_pk_bf16_f32 v180, v216, v217
  v_mfma_f32_16x16x32_bf16 a[84:87], a[168:171], v[188:191], a[84:87]
  v_exp_f32 v221, v141
  v_mfma_f32_16x16x32_bf16 a[88:91], a[172:175], v[184:187], a[88:91]
  ds_read_b128 a[140:143], v3 offset:11264
  v_add_f32 v227, v227, v218
  v_mfma_f32_16x16x32_bf16 a[92:95], a[172:175], v[188:191], a[92:95]
  s_waitcnt lgkmcnt(4)
  v_exp_f32 v222, v142
  v_mfma_f32_16x16x32_bf16 a[96:99], a[176:179], v[184:187], a[96:99]
  ds_read_b128 a[144:147], v3 offset:12288
  buffer_load_dwordx4 v2, s[48:51], s27 offen offset:3072 sc1 lds
  v_add_f32 v227, v227, v219
  v_cvt_pk_bf16_f32 v181, v218, v219
  v_mfma_f32_16x16x32_bf16 a[100:103], a[176:179], v[188:191], a[100:103]
  s_add_u32 s27, s27, 16384
  v_exp_f32 v223, v143
  v_mfma_f32_16x16x32_bf16 a[104:107], a[180:183], v[184:187], a[104:107]
  s_add_u32 s25, s25, 32768
  ds_read_b128 a[148:151], v3 offset:13312
  buffer_load_dwordx4 v[232:235], v2, s[40:43], s14 offen offset:0 sc1
  v_add_f32 v227, v227, v220
  v_mfma_f32_16x16x32_bf16 a[108:111], a[180:183], v[188:191], a[108:111]
  s_and_b32 s25, s25, 0x1ffff
  v_add_f32 v227, v227, v221
  v_cvt_pk_bf16_f32 v182, v220, v221
  v_add_f32 v227, v227, v222
  v_mfma_f32_16x16x32_bf16 a[112:115], a[184:187], v[184:187], a[112:115]
  ds_read_b128 a[152:155], v3 offset:14336
  v_add_f32 v227, v227, v223
  v_max_f32 v5, v226, v227
  v_cmp_lt_f32 vcc, s81, v5
  v_mfma_f32_16x16x32_bf16 a[116:119], a[184:187], v[188:191], a[116:119]
  v_exp_f32 v216, v144
  v_mfma_f32_16x16x32_bf16 a[120:123], a[188:191], v[184:187], a[120:123]
  s_waitcnt lgkmcnt(3)
  ds_read_b128 a[156:159], v3 offset:15360
  v_cvt_pk_bf16_f32 v183, v222, v223
  v_add_u32 v3, s66, v2
  v_mfma_f32_16x16x32_bf16 a[124:127], a[188:191], v[188:191], a[124:127]
  s_cbranch_vccnz fa_stub25
fa_back25:
  v_exp_f32 v217, v145
  v_add_f32 v230, v230, v226
  v_add_f32 v231, v231, v227
fa_SSW1:
  v_mfma_f32_16x16x32_bf16 v[128:131], a[128:131], v[64:67], v[200:203]
  s_waitcnt vmcnt(8)
  v_exp_f32 v218, v146
  v_mfma_f32_16x16x32_bf16 v[136:139], a[128:131], v[68:71], v[204:207]
  s_barrier
  v_exp_f32 v219, v147
  v_mfma_f32_16x16x32_bf16 v[132:135], a[132:135], v[64:67], v[200:203]
  s_cmp_ge_u32 s26, s46
  s_cselect_b64 s[44:45], s[4:5], s[44:45]
  s_cselect_b32 s46, s30, s46
  ds_read_b128 a[160:163], v3 offset:16384
  ds_read_b128 a[164:167], v3 offset:17408
  v_add_f32 v226, v216, v217
  v_mfma_f32_16x16x32_bf16 v[140:143], a[132:135], v[68:71], v[204:207]
  s_mov_b32 m0, s24
  v_exp_f32 v220, v148
  v_mfma_f32_16x16x32_bf16 v[128:131], a[136:139], v[72:75], v[128:131]
  ds_read_b128 a[168:171], v3 offset:18432
  buffer_load_dwordx4 v2, s[44:47], s26 offen offset:0 sc1 lds
  v_cvt_pk_bf16_f32 v184, v216, v217
  v_mfma_f32_16x16x32_bf16 v[136:139], a[136:139], v[76:79], v[136:139]
  v_exp_f32 v221, v149
  v_mfma_f32_16x16x32_bf16 v[132:135], a[140:143], v[72:75], v[132:135]
  s_add_u32 s14, s13, 16384
  ds_read_b128 a[172:175], v3 offset:19456
  buffer_load_dwordx4 v[172:175], v2, s[40:43], s14 offen offset:3072 sc1
  v_add_f32 v226, v226, v218
  v_add_f32 v226, v226, v219
  v_mfma_f32_16x16x32_bf16 v[140:143], a[140:143], v[76:79], v[140:143]
  s_waitcnt lgkmcnt(4)
  v_exp_f32 v222, v150
  v_mfma_f32_16x16x32_bf16 v[128:131], a[144:147], v[80:83], v[128:131]
  ds_read_b128 a[176:179], v3 offset:20480
  v_cvt_pk_bf16_f32 v185, v218, v219
  v_mfma_f32_16x16x32_bf16 v[136:139], a[144:147], v[84:87], v[136:139]
  v_exp_f32 v223, v151
  v_mfma_f32_16x16x32_bf16 v[132:135], a[148:151], v[80:83], v[132:135]
  ds_read_b128 a[180:183], v3 offset:21504
  buffer_load_dwordx4 v2, s[44:47], s26 offen offset:1024 sc1 lds
  v_add_f32 v226, v226, v220
  v_mfma_f32_16x16x32_bf16 v[140:143], a[148:151], v[84:87], v[140:143]
  v_exp_f32 v216, v152
  v_mfma_f32_16x16x32_bf16 v[128:131], a[152:155], v[88:91], v[128:131]
  ds_read_b128 a[184:187], v3 offset:22528
  v_add_f32 v226, v226, v221
  v_cvt_pk_bf16_f32 v186, v220, v221
  v_mfma_f32_16x16x32_bf16 v[136:139], a[152:155], v[92:95], v[136:139]
  v_exp_f32 v217, v153
  v_mfma_f32_16x16x32_bf16 v[132:135], a[156:159], v[88:91], v[132:135]
  ds_read_b128 a[188:191], v3 offset:23552
  buffer_load_dwordx4 v[168:171], v2, s[40:43], s14 offen offset:2048 sc1
  v_add_f32 v226, v226, v222
  v_mfma_f32_16x16x32_bf16 v[140:143], a[156:159], v[92:95], v[140:143]
  s_waitcnt lgkmcnt(4)
  v_exp_f32 v218, v154
  v_mfma_f32_16x16x32_bf16 a[64:67], a[160:163], v[176:179], a[64:67]
  ds_read_b128 a[128:131], v3 offset:0
  v_add_f32 v226, v226, v223
  v_cvt_pk_bf16_f32 v187, v222, v223
  v_mfma_f32_16x16x32_bf16 a[68:71], a[160:163], v[180:183], a[68:71]
  v_exp_f32 v219, v155
  v_mfma_f32_16x16x32_bf16 a[72:75], a[164:167], v[176:179], a[72:75]
  ds_read_b128 a[132:135], v3 offset:1024
  buffer_load_dwordx4 v2, s[44:47], s26 offen offset:2048 sc1 lds
  v_add_f32 v227, v216, v217
  v_mfma_f32_16x16x32_bf16 a[76:79], a[164:167], v[180:183], a[76:79]
  v_exp_f32 v220, v156
  v_mfma_f32_16x16x32_bf16 a[80:83], a[168:171], v[176:179], a[80:83]
  ds_read_b128 a[136:139], v3 offset:2048
  buffer_load_dwordx4 v[164:167], v2, s[40:43], s14 offen offset:1024 sc1
  v_cvt_pk_bf16_f32 v188, v216, v217
  v_mfma_f32_16x16x32_bf16 a[84:87], a[168:171], v[180:183], a[84:87]
  v_exp_f32 v221, v157
  v_mfma_f32_16x16x32_bf16 a[88:91], a[172:175], v[176:179], a[88:91]
  ds_read_b128 a[140:143], v3 offset:3072
  v_add_f32 v227, v227, v218
  v_add_f32 v227, v227, v219
  v_mfma_f32_16x16x32_bf16 a[92:95], a[172:175], v[180:183], a[92:95]
  s_waitcnt lgkmcnt(4)
  v_exp_f32 v222, v158
  v_mfma_f32_16x16x32_bf16 a[96:99], a[176:179], v[176:179], a[96:99]
  ds_read_b128 a[144:147], v3 offset:4096
  buffer_load_dwordx4 v2, s[44:47], s26 offen offset:3072 sc1 lds
  v_cvt_pk_bf16_f32 v189, v218, v219
  v_mfma_f32_16x16x32_bf16 a[100:103], a[176:179], v[180:183], a[100:103]
  s_add_u32 s26, s26, 16384
  v_exp_f32 v223, v159
  v_mfma_f32_16x16x32_bf16 a[104:107], a[180:183], v[176:179], a[104:107]
  s_add_u32 s24, s24, 32768
  ds_read_b128 a[148:151], v3 offset:5120
  buffer_load_dwordx4 v[160:163], v2, s[40:43], s14 offen offset:0 sc1
  v_add_f32 v227, v227, v220
  v_mfma_f32_16x16x32_bf16 a[108:111], a[180:183], v[180:183], a[108:111]
  s_and_b32 s24, s24, 0x1ffff
  v_add_f32 v227, v227, v221
  v_cvt_pk_bf16_f32 v190, v220, v221
  v_add_f32 v227, v227, v222
  v_mfma_f32_16x16x32_bf16 a[112:115], a[184:187], v[176:179], a[112:115]
  ds_read_b128 a[152:155], v3 offset:6144
  v_add_f32 v227, v227, v223
  v_max_f32 v5, v226, v227
  v_cmp_lt_f32 vcc, s81, v5
  v_mfma_f32_16x16x32_bf16 a[116:119], a[184:187], v[180:183], a[116:119]
  v_exp_f32 v216, v128
  v_mfma_f32_16x16x32_bf16 a[120:123], a[188:191], v[176:179], a[120:123]
  s_waitcnt lgkmcnt(3)
  ds_read_b128 a[156:159], v3 offset:7168
  v_cvt_pk_bf16_f32 v191, v222, v223
  v_mfma_f32_16x16x32_bf16 a[124:127], a[188:191], v[180:183], a[124:127]
  s_cbranch_vccnz fa_stub26
fa_back26:
  v_exp_f32 v217, v129
  v_add_f32 v230, v230, v226
  v_add_f32 v231, v231, v227
  v_mfma_f32_16x16x32_bf16 v[144:147], a[128:131], v[64:67], v[200:203]
  ds_read_b128 a[160:163], v3 offset:24576
  v_add_f32 v226, v216, v217
  v_mfma_f32_16x16x32_bf16 v[152:155], a[128:131], v[68:71], v[204:207]
  v_exp_f32 v218, v130
  v_mfma_f32_16x16x32_bf16 v[148:151], a[132:135], v[64:67], v[200:203]
  s_cmp_ge_u32 s27, s50
  s_cselect_b64 s[48:49], s[6:7], s[48:49]
  s_cselect_b32 s50, s30, s50
  ds_read_b128 a[164:167], v3 offset:25600
  v_cvt_pk_bf16_f32 v176, v216, v217
  v_mfma_f32_16x16x32_bf16 v[156:159], a[132:135], v[68:71], v[204:207]
  s_mov_b32 m0, s25
  v_exp_f32 v219, v131
  v_mfma_f32_16x16x32_bf16 v[144:147], a[136:139], v[72:75], v[144:147]
  s_add_u32 s66, s66, 32768
  ds_read_b128 a[168:171], v3 offset:26624
  buffer_load_dwordx4 v2, s[48:51], s27 offen offset:0 sc1 lds
  v_add_f32 v226, v226, v218
  v_add_f32 v226, v226, v219
  v_mfma_f32_16x16x32_bf16 v[152:155], a[136:139], v[76:79], v[152:155]
  s_and_b32 s66, s66, 0x1ffff
  v_exp_f32 v220, v132
  v_mfma_f32_16x16x32_bf16 v[148:151], a[140:143], v[72:75], v[148:151]
  s_add_u32 s14, s13, 12288
  ds_read_b128 a[172:175], v3 offset:27648
  buffer_load_dwordx4 v[124:127], v2, s[40:43], s14 offen offset:3072 sc1
  v_cvt_pk_bf16_f32 v177, v218, v219
  v_mfma_f32_16x16x32_bf16 v[156:159], a[140:143], v[76:79], v[156:159]
  s_waitcnt lgkmcnt(4)
  v_exp_f32 v221, v133
  v_mfma_f32_16x16x32_bf16 v[144:147], a[144:147], v[80:83], v[144:147]
  ds_read_b128 a[176:179], v3 offset:28672
  v_add_f32 v226, v226, v220
  v_mfma_f32_16x16x32_bf16 v[152:155], a[144:147], v[84:87], v[152:155]
  v_exp_f32 v222, v134
  v_mfma_f32_16x16x32_bf16 v[148:151], a[148:151], v[80:83], v[148:151]
  ds_read_b128 a[180:183], v3 offset:29696
  buffer_load_dwordx4 v2, s[48:51], s27 offen offset:1024 sc1 lds
  v_add_f32 v226, v226, v221
  v_cvt_pk_bf16_f32 v178, v220, v221
  v_mfma_f32_16x16x32_bf16 v[156:159], a[148:151], v[84:87], v[156:159]
  v_exp_f32 v223, v135
  v_mfma_f32_16x16x32_bf16 v[144:147], a[152:155], v[88:91], v[144:147]
  ds_read_b128 a[184:187], v3 offset:30720
  v_add_f32 v226, v226, v222
  v_mfma_f32_16x16x32_bf16 v[152:155], a[152:155], v[92:95], v[152:155]
  v_exp_f32 v216, v136
  v_mfma_f32_16x16x32_bf16 v[148:151], a[156:159], v[88:91], v[148:151]
  ds_read_b128 a[188:191], v3 offset:31744
  buffer_load_dwordx4 v[120:123], v2, s[40:43], s14 offen offset:2048 sc1
  v_add_f32 v226, v226, v223
  v_exp_f32 v217, v137
  v_mfma_f32_16x16x32_bf16 v[156:159], a[156:159], v[92:95], v[156:159]
  s_waitcnt lgkmcnt(4)
  v_exp_f32 v218, v138
  v_mfma_f32_16x16x32_bf16 a[64:67], a[160:163], v[184:187], a[64:67]
  ds_read_b128 a[128:131], v3 offset:8192
  v_cvt_pk_bf16_f32 v179, v222, v223
  v_mfma_f32_16x16x32_bf16 a[68:71], a[160:163], v[188:191], a[68:71]
  v_exp_f32 v219, v139
  v_mfma_f32_16x16x32_bf16 a[72:75], a[164:167], v[184:187], a[72:75]
  ds_read_b128 a[132:135], v3 offset:9216
  buffer_load_dwordx4 v2, s[48:51], s27 offen offset:2048 sc1 lds
  v_add_f32 v227, v216, v217
  v_mfma_f32_16x16x32_bf16 a[76:79], a[164:167], v[188:191], a[76:79]
  v_exp_f32 v220, v140
  v_mfma_f32_16x16x32_bf16 a[80:83], a[168:171], v[184:187], a[80:83]
  ds_read_b128 a[136:139], v3 offset:10240
  buffer_load_dwordx4 v[116:119], v2, s[40:43], s14 offen offset:1024 sc1
  v_cvt_pk_bf16_f32 v180, v216, v217
  v_mfma_f32_16x16x32_bf16 a[84:87], a[168:171], v[188:191], a[84:87]
  v_exp_f32 v221, v141
  v_mfma_f32_16x16x32_bf16 a[88:91], a[172:175], v[184:187], a[88:91]
  ds_read_b128 a[140:143], v3 offset:11264
  v_add_f32 v227, v227, v218
  v_mfma_f32_16x16x32_bf16 a[92:95], a[172:175], v[188:191], a[92:95]
  s_waitcnt lgkmcnt(4)
  v_exp_f32 v222, v142
  v_mfma_f32_16x16x32_bf16 a[96:99], a[176:179], v[184:187], a[96:99]
  ds_read_b128 a[144:147], v3 offset:12288
  buffer_load_dwordx4 v2, s[48:51], s27 offen offset:3072 sc1 lds
  v_add_f32 v227, v227, v219
  v_cvt_pk_bf16_f32 v181, v218, v219
  v_mfma_f32_16x16x32_bf16 a[100:103], a[176:179], v[188:191], a[100:103]
  s_add_u32 s27, s27, 16384
  v_exp_f32 v223, v143
  v_mfma_f32_16x16x32_bf16 a[104:107], a[180:183], v[184:187], a[104:107]
  s_add_u32 s25, s25, 32768
  ds_read_b128 a[148:151], v3 offset:13312
  buffer_load_dwordx4 v[112:115], v2, s[40:43], s14 offen offset:0 sc1
  v_add_f32 v227, v227, v220
  v_mfma_f32_16x16x32_bf16 a[108:111], a[180:183], v[188:191], a[108:111]
  s_and_b32 s25, s25, 0x1ffff
  v_add_f32 v227, v227, v221
  v_cvt_pk_bf16_f32 v182, v220, v221
  v_add_f32 v227, v227, v222
  v_mfma_f32_16x16x32_bf16 a[112:115], a[184:187], v[184:187], a[112:115]
  ds_read_b128 a[152:155], v3 offset:14336
  v_add_f32 v227, v227, v223
  v_max_f32 v5, v226, v227
  v_cmp_lt_f32 vcc, s81, v5
  v_mfma_f32_16x16x32_bf16 a[116:119], a[184:187], v[188:191], a[116:119]
  v_exp_f32 v216, v144
  v_mfma_f32_16x16x32_bf16 a[120:123], a[188:191], v[184:187], a[120:123]
  s_waitcnt lgkmcnt(3)
  ds_read_b128 a[156:159], v3 offset:15360
  v_cvt_pk_bf16_f32 v183, v222, v223
  v_add_u32 v3, s66, v2
  v_mfma_f32_16x16x32_bf16 a[124:127], a[188:191], v[188:191], a[124:127]
  s_cbranch_vccnz fa_stub27
fa_back27:
  v_exp_f32 v217, v145
  v_add_f32 v230, v230, v226
  v_add_f32 v231, v231, v227
fa_Bexit:
  s_bitcmp1_b32 s20, 0
  s_cbranch_scc1 fa_Bodd
  v_mfma_f32_16x16x32_bf16 v[128:131], a[128:131], v[64:67], v[200:203]
  s_waitcnt vmcnt(8)
  v_exp_f32 v218, v146
  v_mfma_f32_16x16x32_bf16 v[136:139], a[128:131], v[68:71], v[204:207]
  s_barrier
  v_exp_f32 v219, v147
  v_mfma_f32_16x16x32_bf16 v[132:135], a[132:135], v[64:67], v[200:203]
  ds_read_b128 a[160:163], v3 offset:16384
  ds_read_b128 a[164:167], v3 offset:17408
  v_add_f32 v226, v216, v217
  v_mfma_f32_16x16x32_bf16 v[140:143], a[132:135], v[68:71], v[204:207]
  s_add_u32 s14, s13, 8192
  buffer_load_dwordx4 v[108:111], v2, s[40:43], s14 offen offset:3072 sc1
  v_cvt_pk_bf16_f32 v184, v216, v217
  v_mfma_f32_16x16x32_bf16 v[128:131], a[136:139], v[72:75], v[128:131]
  ds_read_b128 a[168:171], v3 offset:18432
  v_add_f32 v226, v226, v218
  v_mfma_f32_16x16x32_bf16 v[136:139], a[136:139], v[76:79], v[136:139]
  v_exp_f32 v220, v148
  v_mfma_f32_16x16x32_bf16 v[132:135], a[140:143], v[72:75], v[132:135]
  ds_read_b128 a[172:175], v3 offset:19456
  v_add_f32 v226, v226, v219
  v_cvt_pk_bf16_f32 v185, v218, v219
  v_mfma_f32_16x16x32_bf16 v[140:143], a[140:143], v[76:79], v[140:143]
  s_waitcnt lgkmcnt(4)
  buffer_load_dwordx4 v[104:107], v2, s[40:43], s14 offen offset:2048 sc1
  v_add_f32 v226, v226, v220
  v_mfma_f32_16x16x32_bf16 v[128:131], a[144:147], v[80:83], v[128:131]
  ds_read_b128 a[176:179], v3 offset:20480
  v_mfma_f32_16x16x32_bf16 v[136:139], a[144:147], v[84:87], v[136:139]
  v_exp_f32 v221, v149
  v_mfma_f32_16x16x32_bf16 v[132:135], a[148:151], v[80:83], v[132:135]
  ds_read_b128 a[180:183], v3 offset:21504
  v_add_f32 v226, v226, v221
  v_mfma_f32_16x16x32_bf16 v[140:143], a[148:151], v[84:87], v[140:143]
  v_exp_f32 v222, v150
  v_mfma_f32_16x16x32_bf16 v[128:131], a[152:155], v[88:91], v[128:131]
  ds_read_b128 a[184:187], v3 offset:22528
  buffer_load_dwordx4 v[100:103], v2, s[40:43], s14 offen offset:1024 sc1
  v_cvt_pk_bf16_f32 v186, v220, v221
  v_mfma_f32_16x16x32_bf16 v[136:139], a[152:155], v[92:95], v[136:139]
  v_exp_f32 v223, v151
  v_mfma_f32_16x16x32_bf16 v[132:135], a[156:159], v[88:91], v[132:135]
  ds_read_b128 a[188:191], v3 offset:23552
  v_add_f32 v226, v226, v222
  v_add_f32 v226, v226, v223
  v_mfma_f32_16x16x32_bf16 v[140:143], a[156:159], v[92:95], v[140:143]
  s_waitcnt lgkmcnt(4)
  v_exp_f32 v216, v152
  v_mfma_f32_16x16x32_bf16 a[64:67], a[160:163], v[176:179], a[64:67]
  v_exp_f32 v217, v153
  v_mfma_f32_16x16x32_bf16 a[68:71], a[160:163], v[180:183], a[68:71]
  buffer_load_dwordx4 v[96:99], v2, s[40:43], s14 offen offset:0 sc1
  v_cvt_pk_bf16_f32 v187, v222, v223
  v_add_f32 v227, v216, v217
  v_mfma_f32_16x16x32_bf16 a[72:75], a[164:167], v[176:179], a[72:75]
  v_exp_f32 v218, v154
  v_mfma_f32_16x16x32_bf16 a[76:79], a[164:167], v[180:183], a[76:79]
  v_exp_f32 v219, v155
  v_mfma_f32_16x16x32_bf16 a[80:83], a[168:171], v[176:179], a[80:83]
  v_exp_f32 v220, v156
  v_mfma_f32_16x16x32_bf16 a[84:87], a[168:171], v[180:183], a[84:87]
  s_add_u32 s14, s13, 4096
  buffer_load_dwordx4 v[60:63], v2, s[40:43], s14 offen offset:3072 sc1
  v_cvt_pk_bf16_f32 v188, v216, v217
  v_add_f32 v227, v227, v218
  v_mfma_f32_16x16x32_bf16 a[88:91], a[172:175], v[176:179], a[88:91]
  v_exp_f32 v221, v157
  v_mfma_f32_16x16x32_bf16 a[92:95], a[172:175], v[180:183], a[92:95]
  s_waitcnt lgkmcnt(0)
  v_exp_f32 v222, v158
  v_mfma_f32_16x16x32_bf16 a[96:99], a[176:179], v[176:179], a[96:99]
  v_add_f32 v227, v227, v219
  v_cvt_pk_bf16_f32 v189, v218, v219
  v_mfma_f32_16x16x32_bf16 a[100:103], a[176:179], v[180:183], a[100:103]
  v_exp_f32 v223, v159
  v_mfma_f32_16x16x32_bf16 a[104:107], a[180:183], v[176:179], a[104:107]
  buffer_load_dwordx4 v[56:59], v2, s[40:43], s14 offen offset:2048 sc1
  v_add_f32 v227, v227, v220
  v_mfma_f32_16x16x32_bf16 a[108:111], a[180:183], v[180:183], a[108:111]
  v_add_f32 v227, v227, v221
  v_cvt_pk_bf16_f32 v190, v220, v221
  v_add_f32 v227, v227, v222
  v_mfma_f32_16x16x32_bf16 a[112:115], a[184:187], v[176:179], a[112:115]
  v_add_f32 v227, v227, v223
  v_max_f32 v5, v226, v227
  v_cmp_lt_f32 vcc, s81, v5
  v_mfma_f32_16x16x32_bf16 a[116:119], a[184:187], v[180:183], a[116:119]
  v_exp_f32 v216, v128
  v_mfma_f32_16x16x32_bf16 a[120:123], a[188:191], v[176:179], a[120:123]
  v_cvt_pk_bf16_f32 v191, v222, v223
  v_mfma_f32_16x16x32_bf16 a[124:127], a[188:191], v[180:183], a[124:127]
  s_cbranch_vccnz fa_stub28
fa_back28:
  v_exp_f32 v217, v129
  v_add_f32 v230, v230, v226
  v_add_f32 v231, v231, v227
  ds_read_b128 a[160:163], v3 offset:24576
  ds_read_b128 a[164:167], v3 offset:25600
  ds_read_b128 a[168:171], v3 offset:26624
  ds_read_b128 a[172:175], v3 offset:27648
  ds_read_b128 a[176:179], v3 offset:28672
  ds_read_b128 a[180:183], v3 offset:29696
  ds_read_b128 a[184:187], v3 offset:30720
  ds_read_b128 a[188:191], v3 offset:31744
  v_cndmask_b32 v128, v4, v128, s[68:69]
  v_cndmask_b32 v129, v4, v129, s[70:71]
  v_cndmask_b32 v130, v4, v130, s[72:73]
  v_cndmask_b32 v131, v4, v131, s[74:75]
  v_mov_b32 v132, v4
  v_mov_b32 v133, v4
  v_mov_b32 v134, v4
  v_mov_b32 v135, v4
  v_cndmask_b32 v140, v4, v140, s[68:69]
  v_cndmask_b32 v141, v4, v141, s[70:71]
  v_cndmask_b32 v142, v4, v142, s[72:73]
  v_cndmask_b32 v143, v4, v143, s[74:75]
  v_exp_f32 v216, v128
  v_exp_f32 v217, v129
  v_exp_f32 v218, v130
  v_add_f32 v226, v216, v217
  v_cvt_pk_bf16_f32 v176, v216, v217
  v_add_f32 v226, v226, v218
  v_exp_f32 v219, v131
  v_exp_f32 v220, v132
  v_add_f32 v226, v226, v219
  v_cvt_pk_bf16_f32 v177, v218, v219
  v_add_f32 v226, v226, v220
  v_exp_f32 v221, v133
  s_waitcnt lgkmcnt(4)
  v_mfma_f32_16x16x32_bf16 a[64:67], a[160:163], v[184:187], a[64:67]
  v_exp_f32 v222, v134
  v_add_f32 v226, v226, v221
  v_mfma_f32_16x16x32_bf16 a[68:71], a[160:163], v[188:191], a[68:71]
  s_add_u32 s14, s13, 4096
  buffer_load_dwordx4 v[52:55], v2, s[40:43], s14 offen offset:1024 sc1
  v_exp_f32 v223, v135
  v_mfma_f32_16x16x32_bf16 a[72:75], a[164:167], v[184:187], a[72:75]
  s_add_u32 s66, s66, 32768
  v_exp_f32 v216, v136
  v_mfma_f32_16x16x32_bf16 a[76:79], a[164:167], v[188:191], a[76:79]
  s_and_b32 s66, s66, 0x1ffff
  v_exp_f32 v217, v137
  v_mfma_f32_16x16x32_bf16 a[80:83], a[168:171], v[184:187], a[80:83]
  buffer_load_dwordx4 v[48:51], v2, s[40:43], s14 offen offset:0 sc1
  v_cvt_pk_bf16_f32 v178, v220, v221
  v_add_f32 v226, v226, v222
  v_add_f32 v226, v226, v223
  v_cvt_pk_bf16_f32 v179, v222, v223
  v_mfma_f32_16x16x32_bf16 a[84:87], a[168:171], v[188:191], a[84:87]
  v_exp_f32 v218, v138
  v_mfma_f32_16x16x32_bf16 a[88:91], a[172:175], v[184:187], a[88:91]
  v_exp_f32 v219, v139
  v_mfma_f32_16x16x32_bf16 a[92:95], a[172:175], v[188:191], a[92:95]
  s_waitcnt lgkmcnt(0)
  v_exp_f32 v220, v140
  v_mfma_f32_16x16x32_bf16 a[96:99], a[176:179], v[184:187], a[96:99]
  s_add_u32 s14, s13, 0
  buffer_load_dwordx4 v[44:47], v2, s[40:43], s14 offen offset:3072 sc1
  v_add_f32 v227, v216, v217
  v_cvt_pk_bf16_f32 v180, v216, v217
  v_add_f32 v227, v227, v218
  v_add_f32 v227, v227, v219
  v_cvt_pk_bf16_f32 v181, v218, v219
  v_exp_f32 v221, v141
  v_mfma_f32_16x16x32_bf16 a[100:103], a[176:179], v[188:191], a[100:103]
  v_exp_f32 v222, v142
  v_mfma_f32_16x16x32_bf16 a[104:107], a[180:183], v[184:187], a[104:107]
  v_exp_f32 v223, v143
  v_mfma_f32_16x16x32_bf16 a[108:111], a[180:183], v[188:191], a[108:111]
  buffer_load_dwordx4 v[40:43], v2, s[40:43], s14 offen offset:2048 sc1
  v_add_f32 v227, v227, v220
  v_add_f32 v227, v227, v221
  v_cvt_pk_bf16_f32 v182, v220, v221
  v_add_f32 v227, v227, v222
  v_mfma_f32_16x16x32_bf16 a[112:115], a[184:187], v[184:187], a[112:115]
  v_add_f32 v227, v227, v223
  v_max_f32 v5, v226, v227
  v_cmp_lt_f32 vcc, s81, v5
  v_mfma_f32_16x16x32_bf16 a[116:119], a[184:187], v[188:191], a[116:119]
  v_mfma_f32_16x16x32_bf16 a[120:123], a[188:191], v[184:187], a[120:123]
  v_cvt_pk_bf16_f32 v183, v222, v223
  v_add_u32 v3, s66, v2
  v_mfma_f32_16x16x32_bf16 a[124:127], a[188:191], v[188:191], a[124:127]
  s_cbranch_vccnz fa_stub29
fa_back29:
  v_add_f32 v230, v230, v226
  v_add_f32 v231, v231, v227
  s_cmp_ge_u32 s20, 2
  s_cbranch_scc1 fa_nb0
  s_waitcnt vmcnt(10)
  s_barrier
fa_nb0:
  ds_read_b128 a[160:163], v3 offset:16384
  ds_read_b128 a[164:167], v3 offset:17408
  ds_read_b128 a[168:171], v3 offset:18432
  ds_read_b128 a[172:175], v3 offset:19456
  ds_read_b128 a[176:179], v3 offset:20480
  ds_read_b128 a[180:183], v3 offset:21504
  ds_read_b128 a[184:187], v3 offset:22528
  ds_read_b128 a[188:191], v3 offset:23552
  s_waitcnt lgkmcnt(4)
  v_mfma_f32_16x16x32_bf16 a[64:67], a[160:163], v[176:179], a[64:67]
  v_mfma_f32_16x16x32_bf16 a[68:71], a[160:163], v[180:183], a[68:71]
  s_add_u32 s14, s13, 0
  buffer_load_dwordx4 v[36:39], v2, s[40:43], s14 offen offset:1024 sc1
  v_mfma_f32_16x16x32_bf16 a[72:75], a[164:167], v[176:179], a[72:75]
  v_mfma_f32_16x16x32_bf16 a[76:79], a[164:167], v[180:183], a[76:79]
  v_mfma_f32_16x16x32_bf16 a[80:83], a[168:171], v[176:179], a[80:83]
  v_mfma_f32_16x16x32_bf16 a[84:87], a[168:171], v[180:183], a[84:87]
  v_mfma_f32_16x16x32_bf16 a[88:91], a[172:175], v[176:179], a[88:91]
  v_mfma_f32_16x16x32_bf16 a[92:95], a[172:175], v[180:183], a[92:95]
  s_waitcnt lgkmcnt(0)
  v_mfma_f32_16x16x32_bf16 a[96:99], a[176:179], v[176:179], a[96:99]
  buffer_load_dwordx4 v[32:35], v2, s[40:43], s14 offen offset:0 sc1
  v_mfma_f32_16x16x32_bf16 a[100:103], a[176:179], v[180:183], a[100:103]
  v_mfma_f32_16x16x32_bf16 a[104:107], a[180:183], v[176:179], a[104:107]
  v_mfma_f32_16x16x32_bf16 a[108:111], a[180:183], v[180:183], a[108:111]
  v_mfma_f32_16x16x32_bf16 a[112:115], a[184:187], v[176:179], a[112:115]
  v_mfma_f32_16x16x32_bf16 a[116:119], a[184:187], v[180:183], a[116:119]
  v_mfma_f32_16x16x32_bf16 a[120:123], a[188:191], v[176:179], a[120:123]
  v_mfma_f32_16x16x32_bf16 a[124:127], a[188:191], v[180:183], a[124:127]
  s_branch fa_Bdone
fa_Bodd:
  s_cmp_ge_u32 s20, 2
  s_cbranch_scc1 fa_nb1
  s_waitcnt vmcnt(8)
  s_barrier
fa_nb1:
  ds_read_b128 a[160:163], v3 offset:16384
  ds_read_b128 a[164:167], v3 offset:17408
  ds_read_b128 a[168:171], v3 offset:18432
  ds_read_b128 a[172:175], v3 offset:19456
  ds_read_b128 a[176:179], v3 offset:20480
  ds_read_b128 a[180:183], v3 offset:21504
  ds_read_b128 a[184:187], v3 offset:22528
  ds_read_b128 a[188:191], v3 offset:23552
  v_cndmask_b32 v144, v4, v144, s[68:69]
  v_cndmask_b32 v145, v4, v145, s[70:71]
  v_cndmask_b32 v146, v4, v146, s[72:73]
  v_cndmask_b32 v147, v4, v147, s[74:75]
  v_mov_b32 v148, v4
  v_mov_b32 v149, v4
  v_mov_b32 v150, v4
  v_mov_b32 v151, v4
  v_cndmask_b32 v156, v4, v156, s[68:69]
  v_cndmask_b32 v157, v4, v157, s[70:71]
  v_cndmask_b32 v158, v4, v158, s[72:73]
  v_cndmask_b32 v159, v4, v159, s[74:75]
  v_exp_f32 v216, v144
  v_exp_f32 v217, v145
  v_exp_f32 v218, v146
  v_add_f32 v226, v216, v217
  v_cvt_pk_bf16_f32 v184, v216, v217
  v_add_f32 v226, v226, v218
  v_exp_f32 v219, v147
  v_exp_f32 v220, v148
  v_add_f32 v226, v226, v219
  v_cvt_pk_bf16_f32 v185, v218, v219
  v_add_f32 v226, v226, v220
  v_exp_f32 v221, v149
  s_waitcnt lgkmcnt(4)
  v_mfma_f32_16x16x32_bf16 a[64:67], a[160:163], v[176:179], a[64:67]
  v_exp_f32 v222, v150
  v_add_f32 v226, v226, v221
  v_mfma_f32_16x16x32_bf16 a[68:71], a[160:163], v[180:183], a[68:71]
  s_add_u32 s14, s13, 8192
  buffer_load_dwordx4 v[108:111], v2, s[40:43], s14 offen offset:3072 sc1
  v_exp_f32 v223, v151
  v_mfma_f32_16x16x32_bf16 a[72:75], a[164:167], v[176:179], a[72:75]
  v_exp_f32 v216, v152
  v_cvt_pk_bf16_f32 v186, v220, v221
  v_add_f32 v226, v226, v222
  v_mfma_f32_16x16x32_bf16 a[76:79], a[164:167], v[180:183], a[76:79]
  buffer_load_dwordx4 v[104:107], v2, s[40:43], s14 offen offset:2048 sc1
  v_exp_f32 v217, v153
  v_mfma_f32_16x16x32_bf16 a[80:83], a[168:171], v[176:179], a[80:83]
  v_exp_f32 v218, v154
  v_add_f32 v226, v226, v223
  v_mfma_f32_16x16x32_bf16 a[84:87], a[168:171], v[180:183], a[84:87]
  buffer_load_dwordx4 v[100:103], v2, s[40:43], s14 offen offset:1024 sc1
  v_exp_f32 v219, v155
  v_cvt_pk_bf16_f32 v187, v222, v223
  v_mfma_f32_16x16x32_bf16 a[88:91], a[172:175], v[176:179], a[88:91]
  v_exp_f32 v220, v156
  v_mfma_f32_16x16x32_bf16 a[92:95], a[172:175], v[180:183], a[92:95]
  s_waitcnt lgkmcnt(0)
  buffer_load_dwordx4 v[96:99], v2, s[40:43], s14 offen offset:0 sc1
  v_add_f32 v227, v216, v217
  v_cvt_pk_bf16_f32 v188, v216, v217
  v_add_f32 v227, v227, v218
  v_mfma_f32_16x16x32_bf16 a[96:99], a[176:179], v[176:179], a[96:99]
  v_exp_f32 v221, v157
  v_mfma_f32_16x16x32_bf16 a[100:103], a[176:179], v[180:183], a[100:103]
  s_add_u32 s14, s13, 4096
  buffer_load_dwordx4 v[60:63], v2, s[40:43], s14 offen offset:3072 sc1
  v_exp_f32 v222, v158
  v_mfma_f32_16x16x32_bf16 a[104:107], a[180:183], v[176:179], a[104:107]
  v_exp_f32 v223, v159
  v_mfma_f32_16x16x32_bf16 a[108:111], a[180:183], v[180:183], a[108:111]
  buffer_load_dwordx4 v[56:59], v2, s[40:43], s14 offen offset:2048 sc1
  v_add_f32 v227, v227, v219
  v_cvt_pk_bf16_f32 v189, v218, v219
  v_add_f32 v227, v227, v220
  v_add_f32 v227, v227, v221
  v_cvt_pk_bf16_f32 v190, v220, v221
  v_add_f32 v227, v227, v222
  v_mfma_f32_16x16x32_bf16 a[112:115], a[184:187], v[176:179], a[112:115]
  v_add_f32 v227, v227, v223
  v_max_f32 v5, v226, v227
  v_cmp_lt_f32 vcc, s81, v5
  v_mfma_f32_16x16x32_bf16 a[116:119], a[184:187], v[180:183], a[116:119]
  buffer_load_dwordx4 v[52:55], v2, s[40:43], s14 offen offset:1024 sc1
  v_mfma_f32_16x16x32_bf16 a[120:123], a[188:191], v[176:179], a[120:123]
  v_cvt_pk_bf16_f32 v191, v222, v223
  v_mfma_f32_16x16x32_bf16 a[124:127], a[188:191], v[180:183], a[124:127]
  s_cbranch_vccnz fa_stub30
fa_back30:
  v_add_f32 v230, v230, v226
  v_add_f32 v231, v231, v227
  ds_read_b128 a[160:163], v3 offset:24576
  ds_read_b128 a[164:167], v3 offset:25600
  ds_read_b128 a[168:171], v3 offset:26624
  ds_read_b128 a[172:175], v3 offset:27648
  ds_read_b128 a[176:179], v3 offset:28672
  ds_read_b128 a[180:183], v3 offset:29696
  ds_read_b128 a[184:187], v3 offset:30720
  ds_read_b128 a[188:191], v3 offset:31744
  s_waitcnt lgkmcnt(4)
  v_mfma_f32_16x16x32_bf16 a[64:67], a[160:163], v[184:187], a[64:67]
  v_mfma_f32_16x16x32_bf16 a[68:71], a[160:163], v[188:191], a[68:71]
  s_add_u32 s14, s13, 4096
  buffer_load_dwordx4 v[48:51], v2, s[40:43], s14 offen offset:0 sc1
  v_mfma_f32_16x16x32_bf16 a[72:75], a[164:167], v[184:187], a[72:75]
  s_add_u32 s66, s66, 32768
  v_mfma_f32_16x16x32_bf16 a[76:79], a[164:167], v[188:191], a[76:79]
  s_add_u32 s14, s13, 0
  buffer_load_dwordx4 v[44:47], v2, s[40:43], s14 offen offset:3072 sc1
  v_mfma_f32_16x16x32_bf16 a[80:83], a[168:171], v[184:187], a[80:83]
  s_and_b32 s66, s66, 0x1ffff
  v_mfma_f32_16x16x32_bf16 a[84:87], a[168:171], v[188:191], a[84:87]
  v_mfma_f32_16x16x32_bf16 a[88:91], a[172:175], v[184:187], a[88:91]
  buffer_load_dwordx4 v[40:43], v2, s[40:43], s14 offen offset:2048 sc1
  v_mfma_f32_16x16x32_bf16 a[92:95], a[172:175], v[188:191], a[92:95]
  s_waitcnt lgkmcnt(0)
  v_mfma_f32_16x16x32_bf16 a[96:99], a[176:179], v[184:187], a[96:99]
  v_mfma_f32_16x16x32_bf16 a[100:103], a[176:179], v[188:191], a[100:103]
  buffer_load_dwordx4 v[36:39], v2, s[40:43], s14 offen offset:1024 sc1
  v_mfma_f32_16x16x32_bf16 a[104:107], a[180:183], v[184:187], a[104:107]
  v_mfma_f32_16x16x32_bf16 a[108:111], a[180:183], v[188:191], a[108:111]
  v_mfma_f32_16x16x32_bf16 a[112:115], a[184:187], v[184:187], a[112:115]
  buffer_load_dwordx4 v[32:35], v2, s[40:43], s14 offen offset:0 sc1
  v_mfma_f32_16x16x32_bf16 a[116:119], a[184:187], v[188:191], a[116:119]
  v_mfma_f32_16x16x32_bf16 a[120:123], a[188:191], v[184:187], a[120:123]
  v_add_u32 v3, s66, v2
  v_mfma_f32_16x16x32_bf16 a[124:127], a[188:191], v[188:191], a[124:127]
fa_Bdone:
fa_epi:
  v_mov_b32 v20, v230
  v_mov_b32 v21, v231
  s_nop 1
  v_permlane16_swap_b32 v230, v20
  v_permlane16_swap_b32 v231, v21
  v_add_f32 v230, v230, v20
  v_add_f32 v231, v231, v21
  v_mov_b32 v20, v230
  v_mov_b32 v21, v231
  s_nop 1
  v_permlane32_swap_b32 v230, v20
  v_permlane32_swap_b32 v231, v21
  v_add_f32 v230, v230, v20
  v_add_f32 v231, v231, v21
  v_rcp_f32 v16, v230
  v_rcp_f32 v18, v231
  s_sub_u32 s23, 15, s22
  s_lshl_b32 s23, s23, 2
  v_mov_b32 v17, v16
  v_mov_b32 v19, v18
  s_add_u32 s23, s23, s20
  s_lshl_b32 s23, s23, 18
  s_lshl_b32 s31, s21, 12
  s_add_u32 s31, s31, 50331648
  s_add_u32 s64, s23, s31
  s_add_u32 s65, s64, 131072
  v_accvgpr_read_b32 v68, a64
  v_accvgpr_read_b32 v69, a65
  v_accvgpr_read_b32 v70, a66
  v_accvgpr_read_b32 v71, a67
  v_accvgpr_read_b32 v72, a72
  v_accvgpr_read_b32 v73, a73
  v_accvgpr_read_b32 v74, a74
  v_accvgpr_read_b32 v75, a75
  v_pk_mul_f32 v[68:69], v[68:69], v[16:17]
  v_pk_mul_f32 v[70:71], v[70:71], v[16:17]
  v_pk_mul_f32 v[72:73], v[72:73], v[16:17]
  v_pk_mul_f32 v[74:75], v[74:75], v[16:17]
  v_cvt_pk_bf16_f32 v64, v68, v69
  v_cvt_pk_bf16_f32 v65, v70, v71
  v_cvt_pk_bf16_f32 v66, v72, v73
  v_cvt_pk_bf16_f32 v67, v74, v75
  buffer_store_dwordx4 v[64:67], v2, s[40:43], s64 offen offset:0 sc1
  v_accvgpr_read_b32 v80, a80
  v_accvgpr_read_b32 v81, a81
  v_accvgpr_read_b32 v82, a82
  v_accvgpr_read_b32 v83, a83
  v_accvgpr_read_b32 v84, a88
  v_accvgpr_read_b32 v85, a89
  v_accvgpr_read_b32 v86, a90
  v_accvgpr_read_b32 v87, a91
  v_pk_mul_f32 v[80:81], v[80:81], v[16:17]
  v_pk_mul_f32 v[82:83], v[82:83], v[16:17]
  v_pk_mul_f32 v[84:85], v[84:85], v[16:17]
  v_pk_mul_f32 v[86:87], v[86:87], v[16:17]
  v_cvt_pk_bf16_f32 v76, v80, v81
  v_cvt_pk_bf16_f32 v77, v82, v83
  v_cvt_pk_bf16_f32 v78, v84, v85
  v_cvt_pk_bf16_f32 v79, v86, v87
  buffer_store_dwordx4 v[76:79], v2, s[40:43], s64 offen offset:1024 sc1
  v_accvgpr_read_b32 v132, a96
  v_accvgpr_read_b32 v133, a97
  v_accvgpr_read_b32 v134, a98
  v_accvgpr_read_b32 v135, a99
  v_accvgpr_read_b32 v136, a104
  v_accvgpr_read_b32 v137, a105
  v_accvgpr_read_b32 v138, a106
  v_accvgpr_read_b32 v139, a107
  v_pk_mul_f32 v[132:133], v[132:133], v[16:17]
  v_pk_mul_f32 v[134:135], v[134:135], v[16:17]
  v_pk_mul_f32 v[136:137], v[136:137], v[16:17]
  v_pk_mul_f32 v[138:139], v[138:139], v[16:17]
  v_cvt_pk_bf16_f32 v128, v132, v133
  v_cvt_pk_bf16_f32 v129, v134, v135
  v_cvt_pk_bf16_f32 v130, v136, v137
  v_cvt_pk_bf16_f32 v131, v138, v139
  buffer_store_dwordx4 v[128:131], v2, s[40:43], s64 offen offset:2048 sc1
  v_accvgpr_read_b32 v144, a112
  v_accvgpr_read_b32 v145, a113
  v_accvgpr_read_b32 v146, a114
  v_accvgpr_read_b32 v147, a115
  v_accvgpr_read_b32 v148, a120
  v_accvgpr_read_b32 v149, a121
  v_accvgpr_read_b32 v150, a122
  v_accvgpr_read_b32 v151, a123
  v_pk_mul_f32 v[144:145], v[144:145], v[16:17]
  v_pk_mul_f32 v[146:147], v[146:147], v[16:17]
  v_pk_mul_f32 v[148:149], v[148:149], v[16:17]
  v_pk_mul_f32 v[150:151], v[150:151], v[16:17]
  v_cvt_pk_bf16_f32 v140, v144, v145
  v_cvt_pk_bf16_f32 v141, v146, v147
  v_cvt_pk_bf16_f32 v142, v148, v149
  v_cvt_pk_bf16_f32 v143, v150, v151
  buffer_store_dwordx4 v[140:143], v2, s[40:43], s64 offen offset:3072 sc1
  v_accvgpr_read_b32 v68, a68
  v_accvgpr_read_b32 v69, a69
  v_accvgpr_read_b32 v70, a70
  v_accvgpr_read_b32 v71, a71
  v_accvgpr_read_b32 v72, a76
  v_accvgpr_read_b32 v73, a77
  v_accvgpr_read_b32 v74, a78
  v_accvgpr_read_b32 v75, a79
  v_pk_mul_f32 v[68:69], v[68:69], v[18:19]
  v_pk_mul_f32 v[70:71], v[70:71], v[18:19]
  v_pk_mul_f32 v[72:73], v[72:73], v[18:19]
  v_pk_mul_f32 v[74:75], v[74:75], v[18:19]
  v_cvt_pk_bf16_f32 v64, v68, v69
  v_cvt_pk_bf16_f32 v65, v70, v71
  v_cvt_pk_bf16_f32 v66, v72, v73
  v_cvt_pk_bf16_f32 v67, v74, v75
  buffer_store_dwordx4 v[64:67], v2, s[40:43], s65 offen offset:0 sc1
  v_accvgpr_read_b32 v80, a84
  v_accvgpr_read_b32 v81, a85
  v_accvgpr_read_b32 v82, a86
  v_accvgpr_read_b32 v83, a87
  v_accvgpr_read_b32 v84, a92
  v_accvgpr_read_b32 v85, a93
  v_accvgpr_read_b32 v86, a94
  v_accvgpr_read_b32 v87, a95
  v_pk_mul_f32 v[80:81], v[80:81], v[18:19]
  v_pk_mul_f32 v[82:83], v[82:83], v[18:19]
  v_pk_mul_f32 v[84:85], v[84:85], v[18:19]
  v_pk_mul_f32 v[86:87], v[86:87], v[18:19]
  v_cvt_pk_bf16_f32 v76, v80, v81
  v_cvt_pk_bf16_f32 v77, v82, v83
  v_cvt_pk_bf16_f32 v78, v84, v85
  v_cvt_pk_bf16_f32 v79, v86, v87
  buffer_store_dwordx4 v[76:79], v2, s[40:43], s65 offen offset:1024 sc1
  v_accvgpr_read_b32 v132, a100
  v_accvgpr_read_b32 v133, a101
  v_accvgpr_read_b32 v134, a102
  v_accvgpr_read_b32 v135, a103
  v_accvgpr_read_b32 v136, a108
  v_accvgpr_read_b32 v137, a109
  v_accvgpr_read_b32 v138, a110
  v_accvgpr_read_b32 v139, a111
  v_pk_mul_f32 v[132:133], v[132:133], v[18:19]
  v_pk_mul_f32 v[134:135], v[134:135], v[18:19]
  v_pk_mul_f32 v[136:137], v[136:137], v[18:19]
  v_pk_mul_f32 v[138:139], v[138:139], v[18:19]
  v_cvt_pk_bf16_f32 v128, v132, v133
  v_cvt_pk_bf16_f32 v129, v134, v135
  v_cvt_pk_bf16_f32 v130, v136, v137
  v_cvt_pk_bf16_f32 v131, v138, v139
  buffer_store_dwordx4 v[128:131], v2, s[40:43], s65 offen offset:2048 sc1
  v_accvgpr_read_b32 v144, a116
  v_accvgpr_read_b32 v145, a117
  v_accvgpr_read_b32 v146, a118
  v_accvgpr_read_b32 v147, a119
  v_accvgpr_read_b32 v148, a124
  v_accvgpr_read_b32 v149, a125
  v_accvgpr_read_b32 v150, a126
  v_accvgpr_read_b32 v151, a127
  v_pk_mul_f32 v[144:145], v[144:145], v[18:19]
  v_pk_mul_f32 v[146:147], v[146:147], v[18:19]
  v_pk_mul_f32 v[148:149], v[148:149], v[18:19]
  v_pk_mul_f32 v[150:151], v[150:151], v[18:19]
  v_cvt_pk_bf16_f32 v140, v144, v145
  v_cvt_pk_bf16_f32 v141, v146, v147
  v_cvt_pk_bf16_f32 v142, v148, v149
  v_cvt_pk_bf16_f32 v143, v150, v151
  buffer_store_dwordx4 v[140:143], v2, s[40:43], s65 offen offset:3072 sc1
  s_load_dwordx2 s[16:17], s[0:1], 88
  v_mov_b32 v30, 1073741824
  v_writelane_b32 v30, s80, 0
  v_writelane_b32 v30, s3, 1
  s_and_b32 s23, s2, 1
  s_lshl_b32 s23, s23, 2
  s_add_u32 s61, s23, s20
  s_lshl_b32 s23, s61, 14
  s_add_u32 s23, s23, 50331648
  s_lshl_b32 s63, s60, 19
  s_add_u32 s63, s63, s23
  s_xor_b32 s62, s63, 1048576
  s_add_u32 s64, s62, 0
  s_add_u32 s65, s64, 131072
  s_add_u32 s66, s64, 262144
  s_add_u32 s67, s64, 393216
  v_bfe_u32 v12, v1, 2, 1
  v_mul_u32_u24 v12, 4096, v12
  v_and_b32 v13, 3, v1
  v_lshl_add_u32 v12, v13, 7, v12
  s_lshl_b32 s31, s61, 9
  s_add_u32 s31, s31, 3801088
  s_mul_i32 s23, s60, 8192
  s_add_u32 s23, s23, s31
  v_add_u32 v10, s23, v12
  s_xor_b32 s23, s60, 2
  s_mul_i32 s23, s23, 8192
  s_add_u32 s23, s23, s31
  v_add_u32 v12, s23, v12
  v_mov_b32 v20, 0
  v_mov_b32 v21, 0
  v_mov_b32 v22, 0
  v_mov_b32 v23, 0
  v_add_u32 v16, 158208, v2
  ds_write_b128 v16, v[20:23]
  s_waitcnt vmcnt(0)
  buffer_store_dword v4, v30, s[40:43], 0 offen sc1
  s_setprio 0
  s_cmp_lt_u32 s12, 3
  s_cbranch_scc1 fa_hk9
fa_hb9:
  s_cmp_lt_u32 s29, 8
  s_cbranch_scc1 fa_left
fa_leftb:
  s_lshl_b32 s34, s28, 1
  s_and_b32 s23, s20, 1
  s_lshl_b32 s23, s23, 12
  s_cmp_lt_u32 s20, 2
  s_cselect_b32 s33, 106496, 0
  s_add_u32 s33, s33, s23
  s_add_u32 s33, s33, s34
  s_and_b32 s33, s33, 0x1ffff
  s_lshl_b32 s23, s20, 12
  s_add_u32 s34, s34, 49152
  s_add_u32 s34, s34, s23
  s_and_b32 s34, s34, 0x1ffff
  s_add_u32 s23, s23, s28
  s_cmp_lt_u32 s29, 3
  s_cselect_b32 s26, s23, s26
  s_cselect_b32 s27, s23, s27
  s_cselect_b32 s24, s33, s24
  s_cselect_b32 s25, s34, s25
  s_mov_b64 s[44:45], s[4:5]
  s_mov_b64 s[48:49], s[6:7]
  s_mov_b32 s46, s30
  s_mov_b32 s50, s30
  s_add_u32 s23, s28, 49152
fa_pk:
  s_cmp_ge_u32 s26, s23
  s_cbranch_scc1 fa_pkd
  s_mov_b32 m0, s24
  s_add_u32 s24, s24, 32768
  s_and_b32 s24, s24, 0x1ffff
  buffer_load_dwordx4 v2, s[44:47], s26 offen offset:0 sc1 lds
  buffer_load_dwordx4 v2, s[44:47], s26 offen offset:1024 sc1 lds
  buffer_load_dwordx4 v2, s[44:47], s26 offen offset:2048 sc1 lds
  buffer_load_dwordx4 v2, s[44:47], s26 offen offset:3072 sc1 lds
  s_add_u32 s26, s26, 16384
  s_branch fa_pk
fa_pkd:
  s_add_u32 s23, s28, 32768
fa_pv:
  s_cmp_ge_u32 s27, s23
  s_cbranch_scc1 fa_pvd
  s_mov_b32 m0, s25
  s_add_u32 s25, s25, 32768
  s_and_b32 s25, s25, 0x1ffff
  buffer_load_dwordx4 v2, s[48:51], s27 offen offset:0 sc1 lds
  buffer_load_dwordx4 v2, s[48:51], s27 offen offset:1024 sc1 lds
  buffer_load_dwordx4 v2, s[48:51], s27 offen offset:2048 sc1 lds
  buffer_load_dwordx4 v2, s[48:51], s27 offen offset:3072 sc1 lds
  s_add_u32 s27, s27, 16384
  s_branch fa_pv
fa_pvd:
  s_waitcnt lgkmcnt(0)
  s_barrier
  buffer_load_dword v13, v12, s[40:43], 0 offen sc1
  s_mul_i32 s28, s2, 24576
  s_add_u32 s28, s28, 10485760
  s_xor_b32 s23, s2, 1
  s_mul_i32 s29, s23, 24576
  s_add_u32 s29, s29, 10485760
  s_lshl_b32 s30, s2, 2
  s_add_u32 s30, s30, s20
  s_lshl_b32 s30, s30, 7
  s_add_u32 s30, s30, 67239936
  s_xor_b32 s35, s30, 512
  v_lshlrev_b32 v9, 4, v0
  v_mov_b32 v8, s35
  s_lshl_b32 s25, s60, 6
  s_add_u32 s25, s25, 1
  s_mul_i32 s26, s20, 5120
  s_add_u32 s26, s26, 131072
  s_mul_i32 s27, s20, 1024
  s_add_u32 s27, s27, 151552
  s_mov_b32 s48, s16
  s_mov_b32 s49, s17
  s_mov_b32 s50, 2621440
  s_mov_b32 s51, 0x20000
  s_waitcnt vmcnt(0)
  v_cmp_eq_u32 vcc, 0, v13
  s_cbranch_vccnz fa_ctx_spin
fa_ctx_ok:
  buffer_load_dwordx4 a[144:147], v2, s[40:43], s64 offen offset:0 sc1
  buffer_load_dwordx4 a[148:151], v2, s[40:43], s65 offen offset:0 sc1
  buffer_load_dwordx4 a[152:155], v2, s[40:43], s66 offen offset:0 sc1
  buffer_load_dwordx4 a[156:159], v2, s[40:43], s67 offen offset:0 sc1
  buffer_load_dwordx4 a[160:163], v2, s[40:43], s64 offen offset:1024 sc1
  buffer_load_dwordx4 a[164:167], v2, s[40:43], s65 offen offset:1024 sc1
  buffer_load_dwordx4 a[168:171], v2, s[40:43], s66 offen offset:1024 sc1
  buffer_load_dwordx4 a[172:175], v2, s[40:43], s67 offen offset:1024 sc1
  buffer_load_dwordx4 a[176:179], v2, s[40:43], s64 offen offset:2048 sc1
  buffer_load_dwordx4 a[180:183], v2, s[40:43], s65 offen offset:2048 sc1
  buffer_load_dwordx4 a[184:187], v2, s[40:43], s66 offen offset:2048 sc1
  buffer_load_dwordx4 a[188:191], v2, s[40:43], s67 offen offset:2048 sc1
  buffer_load_dwordx4 v[216:219], v2, s[40:43], s64 offen offset:3072 sc1
  buffer_load_dwordx4 v[220:223], v2, s[40:43], s65 offen offset:3072 sc1
  buffer_load_dwordx4 v[224:227], v2, s[40:43], s66 offen offset:3072 sc1
  buffer_load_dwordx4 v[228:231], v2, s[40:43], s67 offen offset:3072 sc1
  v_add_u32 v11, s33, v2
  s_add_u32 s33, s33, 32768
  s_and_b32 s33, s33, 0x1ffff
  ds_read_b128 v[64:67], v11 offset:0
  ds_read_b128 v[68:71], v11 offset:1024
  ds_read_b128 v[72:75], v11 offset:2048
  ds_read_b128 v[76:79], v11 offset:3072
  v_add_u32 v11, s33, v2
  s_add_u32 s33, s33, 32768
  s_and_b32 s33, s33, 0x1ffff
  ds_read_b128 v[128:131], v11 offset:0
  ds_read_b128 v[132:135], v11 offset:1024
  ds_read_b128 v[136:139], v11 offset:2048
  ds_read_b128 v[140:143], v11 offset:3072
  v_add_u32 v11, s33, v2
  s_add_u32 s33, s33, 32768
  s_and_b32 s33, s33, 0x1ffff
  ds_read_b128 v[176:179], v11 offset:0
  ds_read_b128 v[180:183], v11 offset:1024
  ds_read_b128 v[184:187], v11 offset:2048
  ds_read_b128 v[188:191], v11 offset:3072
  v_add_u32 v11, s34, v2
  s_add_u32 s34, s34, 32768
  s_and_b32 s34, s34, 0x1ffff
  ds_read_b128 v[80:83], v11 offset:0
  ds_read_b128 v[84:87], v11 offset:1024
  ds_read_b128 v[88:91], v11 offset:2048
  ds_read_b128 v[92:95], v11 offset:3072
  v_add_u32 v11, s34, v2
  s_add_u32 s34, s34, 32768
  s_and_b32 s34, s34, 0x1ffff
  ds_read_b128 v[144:147], v11 offset:0
  ds_read_b128 v[148:151], v11 offset:1024
  ds_read_b128 v[152:155], v11 offset:2048
  ds_read_b128 v[156:159], v11 offset:3072
  s_add_u32 s64, s64, 4096
  s_add_u32 s65, s64, 131072
  s_add_u32 s66, s64, 262144
  s_add_u32 s67, s64, 393216
  s_waitcnt vmcnt(14) lgkmcnt(0)
  v_mfma_f32_16x16x32_bf16 a[64:67], v[32:35], a[144:147], 0
  v_add_u32 v200, s26, v2
  v_mfma_f32_16x16x32_bf16 a[80:83], v[36:39], a[144:147], 0
  v_add_u32 v201, s27, v2
  v_mfma_f32_16x16x32_bf16 a[96:99], v[40:43], a[144:147], 0
  s_mul_i32 s24, s20, 21504
  v_add_u32 v16, 0, v0
  v_mfma_f32_16x16x32_bf16 a[112:115], v[44:47], a[144:147], 0
  v_mul_u32_u24 v17, 6554, v16
  v_mfma_f32_16x16x32_bf16 a[128:131], v[48:51], a[144:147], 0
  buffer_load_dwordx4 a[144:147], v2, s[40:43], s64 offen offset:0 sc1
  v_mfma_f32_16x16x32_bf16 a[68:71], v[32:35], a[148:151], 0
  v_lshrrev_b32 v17, 16, v17
  v_mfma_f32_16x16x32_bf16 a[84:87], v[36:39], a[148:151], 0
  v_mul_u32_u24 v18, 10, v17
  v_mfma_f32_16x16x32_bf16 a[100:103], v[40:43], a[148:151], 0
  v_sub_u32 v18, v16, v18
  v_mfma_f32_16x16x32_bf16 a[116:119], v[44:47], a[148:151], 0
  v_lshlrev_b32 v203, 5, v18
  v_mfma_f32_16x16x32_bf16 a[132:135], v[48:51], a[148:151], 0
  s_waitcnt vmcnt(13)
  buffer_load_dwordx4 a[148:151], v2, s[40:43], s65 offen offset:0 sc1
  v_mfma_f32_16x16x32_bf16 a[72:75], v[32:35], a[152:155], 0
  v_add_u32 v24, s25, v17
  v_mfma_f32_16x16x32_bf16 a[88:91], v[36:39], a[152:155], 0
  v_mov_b32 v27, 8
  v_mfma_f32_16x16x32_bf16 a[104:107], v[40:43], a[152:155], 0
  v_add_u32 v16, 256, v0
  v_mfma_f32_16x16x32_bf16 a[120:123], v[44:47], a[152:155], 0
  v_mul_u32_u24 v17, 6554, v16
  v_mfma_f32_16x16x32_bf16 a[136:139], v[48:51], a[152:155], 0
  buffer_load_dwordx4 a[152:155], v2, s[40:43], s66 offen offset:0 sc1
  v_mfma_f32_16x16x32_bf16 a[76:79], v[32:35], a[156:159], 0
  v_lshrrev_b32 v17, 16, v17
  v_mfma_f32_16x16x32_bf16 a[92:95], v[36:39], a[156:159], 0
  v_mul_u32_u24 v18, 10, v17
  v_mfma_f32_16x16x32_bf16 a[108:111], v[40:43], a[156:159], 0
  v_sub_u32 v18, v16, v18
  v_mfma_f32_16x16x32_bf16 a[124:127], v[44:47], a[156:159], 0
  v_lshlrev_b32 v204, 5, v18
  v_mfma_f32_16x16x32_bf16 a[140:143], v[48:51], a[156:159], 0
  s_waitcnt vmcnt(13)
  buffer_load_dwordx4 a[156:159], v2, s[40:43], s67 offen offset:0 sc1
  v_mfma_f32_16x16x32_bf16 a[64:67], v[52:55], a[160:163], a[64:67]
  v_add_u32 v25, s25, v17
  v_mfma_f32_16x16x32_bf16 a[80:83], v[56:59], a[160:163], a[80:83]
  v_mov_b32 v28, 8
  v_mfma_f32_16x16x32_bf16 a[96:99], v[60:63], a[160:163], a[96:99]
  v_add_u32 v16, 512, v0
  v_mfma_f32_16x16x32_bf16 a[112:115], v[96:99], a[160:163], a[112:115]
  v_mul_u32_u24 v17, 6554, v16
  v_mfma_f32_16x16x32_bf16 a[128:131], v[100:103], a[160:163], a[128:131]
  buffer_load_dwordx4 a[160:163], v2, s[40:43], s64 offen offset:1024 sc1
  v_mfma_f32_16x16x32_bf16 a[68:71], v[52:55], a[164:167], a[68:71]
  v_lshrrev_b32 v17, 16, v17
  v_mfma_f32_16x16x32_bf16 a[84:87], v[56:59], a[164:167], a[84:87]
  v_mul_u32_u24 v18, 10, v17
  v_mfma_f32_16x16x32_bf16 a[100:103], v[60:63], a[164:167], a[100:103]
  v_sub_u32 v18, v16, v18
  v_mfma_f32_16x16x32_bf16 a[116:119], v[96:99], a[164:167], a[116:119]
  v_lshlrev_b32 v205, 5, v18
  v_mfma_f32_16x16x32_bf16 a[132:135], v[100:103], a[164:167], a[132:135]
  s_waitcnt vmcnt(13)
  buffer_load_dwordx4 a[164:167], v2, s[40:43], s65 offen offset:1024 sc1
  v_mfma_f32_16x16x32_bf16 a[72:75], v[52:55], a[168:171], a[72:75]
  v_add_u32 v26, s25, v17
  v_mfma_f32_16x16x32_bf16 a[88:91], v[56:59], a[168:171], a[88:91]
  v_mov_b32 v29, 8
  v_mfma_f32_16x16x32_bf16 a[104:107], v[60:63], a[168:171], a[104:107]
  v_readlane_b32 s68, v15, 0
  v_mfma_f32_16x16x32_bf16 a[120:123], v[96:99], a[168:171], a[120:123]
  v_readlane_b32 s69, v15, 1
  v_mfma_f32_16x16x32_bf16 a[136:139], v[100:103], a[168:171], a[136:139]
  buffer_load_dwordx4 a[168:171], v2, s[40:43], s66 offen offset:1024 sc1
  v_mfma_f32_16x16x32_bf16 a[76:79], v[52:55], a[172:175], a[76:79]
  v_readlane_b32 s70, v15, 2
  v_mfma_f32_16x16x32_bf16 a[92:95], v[56:59], a[172:175], a[92:95]
  v_readlane_b32 s71, v15, 3
  v_mfma_f32_16x16x32_bf16 a[108:111], v[60:63], a[172:175], a[108:111]
  v_readlane_b32 s72, v15, 4
  v_mfma_f32_16x16x32_bf16 a[124:127], v[96:99], a[172:175], a[124:127]
  v_readlane_b32 s73, v15, 5
  v_mfma_f32_16x16x32_bf16 a[140:143], v[100:103], a[172:175], a[140:143]
  s_waitcnt vmcnt(13)
  buffer_load_dwordx4 a[172:175], v2, s[40:43], s67 offen offset:1024 sc1
  v_mfma_f32_16x16x32_bf16 a[64:67], v[104:107], a[176:179], a[64:67]
  v_readlane_b32 s74, v15, 6
  v_mfma_f32_16x16x32_bf16 a[80:83], v[108:111], a[176:179], a[80:83]
  v_readlane_b32 s75, v15, 7
  v_mfma_f32_16x16x32_bf16 a[96:99], v[112:115], a[176:179], a[96:99]
  v_cmp_eq_u32 s[52:53], s68, v24
  v_mfma_f32_16x16x32_bf16 a[112:115], v[116:119], a[176:179], a[112:115]
  v_cmp_eq_u32 s[54:55], s68, v25
  v_mfma_f32_16x16x32_bf16 a[128:131], v[120:123], a[176:179], a[128:131]
  buffer_load_dwordx4 a[176:179], v2, s[40:43], s64 offen offset:2048 sc1
  v_mfma_f32_16x16x32_bf16 a[68:71], v[104:107], a[180:183], a[68:71]
  v_cmp_eq_u32 s[56:57], s68, v26
  v_mfma_f32_16x16x32_bf16 a[84:87], v[108:111], a[180:183], a[84:87]
  v_cndmask_b32 v27, v27, 0, s[52:53]
  v_mfma_f32_16x16x32_bf16 a[100:103], v[112:115], a[180:183], a[100:103]
  v_cndmask_b32 v28, v28, 0, s[54:55]
  v_mfma_f32_16x16x32_bf16 a[116:119], v[116:119], a[180:183], a[116:119]
  v_cndmask_b32 v29, v29, 0, s[56:57]
  v_mfma_f32_16x16x32_bf16 a[132:135], v[120:123], a[180:183], a[132:135]
  s_waitcnt vmcnt(13)
  buffer_load_dwordx4 a[180:183], v2, s[40:43], s65 offen offset:2048 sc1
  v_mfma_f32_16x16x32_bf16 a[72:75], v[104:107], a[184:187], a[72:75]
  v_cmp_eq_u32 s[52:53], s69, v24
  v_mfma_f32_16x16x32_bf16 a[88:91], v[108:111], a[184:187], a[88:91]
  v_cmp_eq_u32 s[54:55], s69, v25
  v_mfma_f32_16x16x32_bf16 a[104:107], v[112:115], a[184:187], a[104:107]
  v_cmp_eq_u32 s[56:57], s69, v26
  v_mfma_f32_16x16x32_bf16 a[120:123], v[116:119], a[184:187], a[120:123]
  v_cndmask_b32 v27, v27, 1, s[52:53]
  v_mfma_f32_16x16x32_bf16 a[136:139], v[120:123], a[184:187], a[136:139]
  buffer_load_dwordx4 a[184:187], v2, s[40:43], s66 offen offset:2048 sc1
  v_mfma_f32_16x16x32_bf16 a[76:79], v[104:107], a[188:191], a[76:79]
  v_cndmask_b32 v28, v28, 1, s[54:55]
  v_mfma_f32_16x16x32_bf16 a[92:95], v[108:111], a[188:191], a[92:95]
  v_cndmask_b32 v29, v29, 1, s[56:57]
  v_mfma_f32_16x16x32_bf16 a[108:111], v[112:115], a[188:191], a[108:111]
  v_cmp_eq_u32 s[52:53], s70, v24
  v_mfma_f32_16x16x32_bf16 a[124:127], v[116:119], a[188:191], a[124:127]
  v_cmp_eq_u32 s[54:55], s70, v25
  v_mfma_f32_16x16x32_bf16 a[140:143], v[120:123], a[188:191], a[140:143]
  s_waitcnt vmcnt(13)
  buffer_load_dwordx4 a[188:191], v2, s[40:43], s67 offen offset:2048 sc1
  v_mfma_f32_16x16x32_bf16 a[64:67], v[124:127], v[216:219], a[64:67]
  v_cmp_eq_u32 s[56:57], s70, v26
  v_mfma_f32_16x16x32_bf16 a[80:83], v[160:163], v[216:219], a[80:83]
  v_cndmask_b32 v27, v27, 2, s[52:53]
  v_mfma_f32_16x16x32_bf16 a[96:99], v[164:167], v[216:219], a[96:99]
  v_cndmask_b32 v28, v28, 2, s[54:55]
  v_mfma_f32_16x16x32_bf16 a[112:115], v[168:171], v[216:219], a[112:115]
  v_cndmask_b32 v29, v29, 2, s[56:57]
  v_mfma_f32_16x16x32_bf16 a[128:131], v[172:175], v[216:219], a[128:131]
  buffer_load_dwordx4 v[216:219], v2, s[40:43], s64 offen offset:3072 sc1
  v_mfma_f32_16x16x32_bf16 a[68:71], v[124:127], v[220:223], a[68:71]
  v_cmp_eq_u32 s[52:53], s71, v24
  v_mfma_f32_16x16x32_bf16 a[84:87], v[160:163], v[220:223], a[84:87]
  v_cmp_eq_u32 s[54:55], s71, v25
  v_mfma_f32_16x16x32_bf16 a[100:103], v[164:167], v[220:223], a[100:103]
  v_cmp_eq_u32 s[56:57], s71, v26
  v_mfma_f32_16x16x32_bf16 a[116:119], v[168:171], v[220:223], a[116:119]
  v_cndmask_b32 v27, v27, 3, s[52:53]
  v_mfma_f32_16x16x32_bf16 a[132:135], v[172:175], v[220:223], a[132:135]
  s_waitcnt vmcnt(13)
  buffer_load_dwordx4 v[220:223], v2, s[40:43], s65 offen offset:3072 sc1
  v_mfma_f32_16x16x32_bf16 a[72:75], v[124:127], v[224:227], a[72:75]
  v_cndmask_b32 v28, v28, 3, s[54:55]
  v_mfma_f32_16x16x32_bf16 a[88:91], v[160:163], v[224:227], a[88:91]
  v_cndmask_b32 v29, v29, 3, s[56:57]
  v_mfma_f32_16x16x32_bf16 a[104:107], v[164:167], v[224:227], a[104:107]
  v_cmp_eq_u32 s[52:53], s72, v24
  v_mfma_f32_16x16x32_bf16 a[120:123], v[168:171], v[224:227], a[120:123]
  v_cmp_eq_u32 s[54:55], s72, v25
  v_mfma_f32_16x16x32_bf16 a[136:139], v[172:175], v[224:227], a[136:139]
  buffer_load_dwordx4 v[224:227], v2, s[40:43], s66 offen offset:3072 sc1
  v_mfma_f32_16x16x32_bf16 a[76:79], v[124:127], v[228:231], a[76:79]
  v_cmp_eq_u32 s[56:57], s72, v26
  v_mfma_f32_16x16x32_bf16 a[92:95], v[160:163], v[228:231], a[92:95]
  v_cndmask_b32 v27, v27, 4, s[52:53]
  v_mfma_f32_16x16x32_bf16 a[108:111], v[164:167], v[228:231], a[108:111]
  v_cndmask_b32 v28, v28, 4, s[54:55]
  v_mfma_f32_16x16x32_bf16 a[124:127], v[168:171], v[228:231], a[124:127]
  v_cndmask_b32 v29, v29, 4, s[56:57]
  v_mfma_f32_16x16x32_bf16 a[140:143], v[172:175], v[228:231], a[140:143]
  s_waitcnt vmcnt(13)
  buffer_load_dwordx4 v[228:231], v2, s[40:43], s67 offen offset:3072 sc1
  v_mfma_f32_16x16x32_bf16 a[64:67], v[232:235], a[144:147], a[64:67]
  v_cmp_eq_u32 s[52:53], s73, v24
  v_mfma_f32_16x16x32_bf16 a[80:83], v[236:239], a[144:147], a[80:83]
  v_cmp_eq_u32 s[54:55], s73, v25
  v_mfma_f32_16x16x32_bf16 a[96:99], v[240:243], a[144:147], a[96:99]
  v_cmp_eq_u32 s[56:57], s73, v26
  v_mfma_f32_16x16x32_bf16 a[112:115], v[244:247], a[144:147], a[112:115]
  s_add_u32 s64, s64, 4096
  v_cndmask_b32 v27, v27, 5, s[52:53]
  v_mfma_f32_16x16x32_bf16 a[128:131], v[192:195], a[144:147], a[128:131]
  buffer_load_dwordx4 a[144:147], v2, s[40:43], s64 offen offset:0 sc1
  v_mfma_f32_16x16x32_bf16 a[68:71], v[232:235], a[148:151], a[68:71]
  s_add_u32 s65, s64, 131072
  v_cndmask_b32 v28, v28, 5, s[54:55]
  v_mfma_f32_16x16x32_bf16 a[84:87], v[236:239], a[148:151], a[84:87]
  s_add_u32 s66, s64, 262144
  v_cndmask_b32 v29, v29, 5, s[56:57]
  v_mfma_f32_16x16x32_bf16 a[100:103], v[240:243], a[148:151], a[100:103]
  v_cmp_eq_u32 s[52:53], s74, v24
  v_mfma_f32_16x16x32_bf16 a[116:119], v[244:247], a[148:151], a[116:119]
  v_cmp_eq_u32 s[54:55], s74, v25
  v_mfma_f32_16x16x32_bf16 a[132:135], v[192:195], a[148:151], a[132:135]
  s_waitcnt vmcnt(13)
  buffer_load_dwordx4 a[148:151], v2, s[40:43], s65 offen offset:0 sc1
  v_mfma_f32_16x16x32_bf16 a[72:75], v[232:235], a[152:155], a[72:75]
  s_add_u32 s67, s64, 393216
  v_cmp_eq_u32 s[56:57], s74, v26
  v_mfma_f32_16x16x32_bf16 a[88:91], v[236:239], a[152:155], a[88:91]
  v_cndmask_b32 v27, v27, 6, s[52:53]
  v_mfma_f32_16x16x32_bf16 a[104:107], v[240:243], a[152:155], a[104:107]
  v_cndmask_b32 v28, v28, 6, s[54:55]
  v_mfma_f32_16x16x32_bf16 a[120:123], v[244:247], a[152:155], a[120:123]
  v_cndmask_b32 v29, v29, 6, s[56:57]
  v_mfma_f32_16x16x32_bf16 a[136:139], v[192:195], a[152:155], a[136:139]
  buffer_load_dwordx4 a[152:155], v2, s[40:43], s66 offen offset:0 sc1
  v_mfma_f32_16x16x32_bf16 a[76:79], v[232:235], a[156:159], a[76:79]
  v_cmp_eq_u32 s[52:53], s75, v24
  v_mfma_f32_16x16x32_bf16 a[92:95], v[236:239], a[156:159], a[92:95]
  v_cmp_eq_u32 s[54:55], s75, v25
  v_mfma_f32_16x16x32_bf16 a[108:111], v[240:243], a[156:159], a[108:111]
  v_cmp_eq_u32 s[56:57], s75, v26
  v_mfma_f32_16x16x32_bf16 a[124:127], v[244:247], a[156:159], a[124:127]
  v_cndmask_b32 v27, v27, 7, s[52:53]
  v_mfma_f32_16x16x32_bf16 a[140:143], v[192:195], a[156:159], a[140:143]
  s_waitcnt vmcnt(13)
  buffer_load_dwordx4 a[156:159], v2, s[40:43], s67 offen offset:0 sc1
  v_mfma_f32_16x16x32_bf16 a[64:67], v[196:199], a[160:163], a[64:67]
  v_cndmask_b32 v28, v28, 7, s[54:55]
  v_mfma_f32_16x16x32_bf16 a[80:83], v[208:211], a[160:163], a[80:83]
  v_cndmask_b32 v29, v29, 7, s[56:57]
  v_mfma_f32_16x16x32_bf16 a[96:99], v[212:215], a[160:163], a[96:99]
  v_mul_u32_u24 v27, 320, v27
  v_mfma_f32_16x16x32_bf16 a[112:115], a[0:3], a[160:163], a[112:115]
  v_add_u32 v203, v203, v27
  v_mfma_f32_16x16x32_bf16 a[128:131], a[4:7], a[160:163], a[128:131]
  buffer_load_dwordx4 a[160:163], v2, s[40:43], s64 offen offset:1024 sc1
  v_mfma_f32_16x16x32_bf16 a[68:71], v[196:199], a[164:167], a[68:71]
  v_add_u32 v203, 155648, v203
  v_mfma_f32_16x16x32_bf16 a[84:87], v[208:211], a[164:167], a[84:87]
  v_mul_u32_u24 v28, 320, v28
  v_mfma_f32_16x16x32_bf16 a[100:103], v[212:215], a[164:167], a[100:103]
  v_add_u32 v204, v204, v28
  v_mfma_f32_16x16x32_bf16 a[116:119], a[0:3], a[164:167], a[116:119]
  v_add_u32 v204, 155648, v204
  v_mfma_f32_16x16x32_bf16 a[132:135], a[4:7], a[164:167], a[132:135]
  s_waitcnt vmcnt(13)
  buffer_load_dwordx4 a[164:167], v2, s[40:43], s65 offen offset:1024 sc1
  v_mfma_f32_16x16x32_bf16 a[72:75], v[196:199], a[168:171], a[72:75]
  v_mul_u32_u24 v29, 320, v29
  v_mfma_f32_16x16x32_bf16 a[88:91], v[208:211], a[168:171], a[88:91]
  v_add_u32 v205, v205, v29
  v_mfma_f32_16x16x32_bf16 a[104:107], v[212:215], a[168:171], a[104:107]
  v_add_u32 v205, 155648, v205
  v_mfma_f32_16x16x32_bf16 a[120:123], a[0:3], a[168:171], a[120:123]
  v_and_b32 v16, 15, v1
  v_mfma_f32_16x16x32_bf16 a[136:139], a[4:7], a[168:171], a[136:139]
  buffer_load_dwordx4 a[168:171], v2, s[40:43], s66 offen offset:1024 sc1
  v_mfma_f32_16x16x32_bf16 a[76:79], v[196:199], a[172:175], a[76:79]
  v_mul_u32_u24 v16, 336, v16
  v_mfma_f32_16x16x32_bf16 a[92:95], v[208:211], a[172:175], a[92:95]
  v_lshrrev_b32 v17, 4, v1
  v_mfma_f32_16x16x32_bf16 a[108:111], v[212:215], a[172:175], a[108:111]
  v_lshl_add_u32 v16, v17, 4, v16
  v_mfma_f32_16x16x32_bf16 a[124:127], a[0:3], a[172:175], a[124:127]
  v_add_u32 v16, s24, v16
  v_mfma_f32_16x16x32_bf16 a[140:143], a[4:7], a[172:175], a[140:143]
  s_waitcnt vmcnt(13)
  buffer_load_dwordx4 a[172:175], v2, s[40:43], s67 offen offset:1024 sc1
  v_mfma_f32_16x16x32_bf16 a[64:67], a[8:11], a[176:179], a[64:67]
  v_mfma_f32_16x16x32_bf16 a[80:83], a[12:15], a[176:179], a[80:83]
  v_mfma_f32_16x16x32_bf16 a[96:99], v[64:67], a[176:179], a[96:99]
  v_mfma_f32_16x16x32_bf16 a[112:115], v[68:71], a[176:179], a[112:115]
  v_mfma_f32_16x16x32_bf16 a[128:131], v[72:75], a[176:179], a[128:131]
  buffer_load_dwordx4 a[176:179], v2, s[40:43], s64 offen offset:2048 sc1
  v_mfma_f32_16x16x32_bf16 a[68:71], a[8:11], a[180:183], a[68:71]
  v_mfma_f32_16x16x32_bf16 a[84:87], a[12:15], a[180:183], a[84:87]
  v_mfma_f32_16x16x32_bf16 a[100:103], v[64:67], a[180:183], a[100:103]
  v_mfma_f32_16x16x32_bf16 a[116:119], v[68:71], a[180:183], a[116:119]
  v_mfma_f32_16x16x32_bf16 a[132:135], v[72:75], a[180:183], a[132:135]
  s_waitcnt vmcnt(13)
  buffer_load_dwordx4 a[180:183], v2, s[40:43], s65 offen offset:2048 sc1
  v_mfma_f32_16x16x32_bf16 a[72:75], a[8:11], a[184:187], a[72:75]
  v_mfma_f32_16x16x32_bf16 a[88:91], a[12:15], a[184:187], a[88:91]
  v_mfma_f32_16x16x32_bf16 a[104:107], v[64:67], a[184:187], a[104:107]
  v_mfma_f32_16x16x32_bf16 a[120:123], v[68:71], a[184:187], a[120:123]
  v_mfma_f32_16x16x32_bf16 a[136:139], v[72:75], a[184:187], a[136:139]
  buffer_load_dwordx4 a[184:187], v2, s[40:43], s66 offen offset:2048 sc1
  v_mfma_f32_16x16x32_bf16 a[76:79], a[8:11], a[188:191], a[76:79]
  v_mfma_f32_16x16x32_bf16 a[92:95], a[12:15], a[188:191], a[92:95]
  v_mfma_f32_16x16x32_bf16 a[108:111], v[64:67], a[188:191], a[108:111]
  v_mfma_f32_16x16x32_bf16 a[124:127], v[68:71], a[188:191], a[124:127]
  v_mfma_f32_16x16x32_bf16 a[140:143], v[72:75], a[188:191], a[140:143]
  s_waitcnt vmcnt(13)
  buffer_load_dwordx4 a[188:191], v2, s[40:43], s67 offen offset:2048 sc1
  v_mfma_f32_16x16x32_bf16 a[64:67], v[76:79], v[216:219], a[64:67]
  v_mfma_f32_16x16x32_bf16 a[80:83], v[80:83], v[216:219], a[80:83]
  v_mfma_f32_16x16x32_bf16 a[96:99], v[84:87], v[216:219], a[96:99]
  v_mfma_f32_16x16x32_bf16 a[112:115], v[88:91], v[216:219], a[112:115]
  v_mfma_f32_16x16x32_bf16 a[128:131], v[92:95], v[216:219], a[128:131]
  buffer_load_dwordx4 v[216:219], v2, s[40:43], s64 offen offset:3072 sc1
  v_mfma_f32_16x16x32_bf16 a[68:71], v[76:79], v[220:223], a[68:71]
  v_mfma_f32_16x16x32_bf16 a[84:87], v[80:83], v[220:223], a[84:87]
  v_mfma_f32_16x16x32_bf16 a[100:103], v[84:87], v[220:223], a[100:103]
  v_mfma_f32_16x16x32_bf16 a[116:119], v[88:91], v[220:223], a[116:119]
  v_mfma_f32_16x16x32_bf16 a[132:135], v[92:95], v[220:223], a[132:135]
  s_waitcnt vmcnt(13)
  buffer_load_dwordx4 v[220:223], v2, s[40:43], s65 offen offset:3072 sc1
  v_mfma_f32_16x16x32_bf16 a[72:75], v[76:79], v[224:227], a[72:75]
  v_mfma_f32_16x16x32_bf16 a[88:91], v[80:83], v[224:227], a[88:91]
  v_mfma_f32_16x16x32_bf16 a[104:107], v[84:87], v[224:227], a[104:107]
  v_mfma_f32_16x16x32_bf16 a[120:123], v[88:91], v[224:227], a[120:123]
  v_mfma_f32_16x16x32_bf16 a[136:139], v[92:95], v[224:227], a[136:139]
  buffer_load_dwordx4 v[224:227], v2, s[40:43], s66 offen offset:3072 sc1
  v_mfma_f32_16x16x32_bf16 a[76:79], v[76:79], v[228:231], a[76:79]
  v_mfma_f32_16x16x32_bf16 a[92:95], v[80:83], v[228:231], a[92:95]
  v_mfma_f32_16x16x32_bf16 a[108:111], v[84:87], v[228:231], a[108:111]
  v_mfma_f32_16x16x32_bf16 a[124:127], v[88:91], v[228:231], a[124:127]
  v_mfma_f32_16x16x32_bf16 a[140:143], v[92:95], v[228:231], a[140:143]
  s_waitcnt vmcnt(13)
  buffer_load_dwordx4 v[228:231], v2, s[40:43], s67 offen offset:3072 sc1
  v_mfma_f32_16x16x32_bf16 a[64:67], a[16:19], a[144:147], a[64:67]
  v_mfma_f32_16x16x32_bf16 a[80:83], a[20:23], a[144:147], a[80:83]
  v_mfma_f32_16x16x32_bf16 a[96:99], a[24:27], a[144:147], a[96:99]
  v_mfma_f32_16x16x32_bf16 a[112:115], a[28:31], a[144:147], a[112:115]
  s_add_u32 s64, s64, 4096
  v_mfma_f32_16x16x32_bf16 a[128:131], a[32:35], a[144:147], a[128:131]
  buffer_load_dwordx4 a[144:147], v2, s[40:43], s64 offen offset:0 sc1
  v_mfma_f32_16x16x32_bf16 a[68:71], a[16:19], a[148:151], a[68:71]
  s_add_u32 s65, s64, 131072
  v_mfma_f32_16x16x32_bf16 a[84:87], a[20:23], a[148:151], a[84:87]
  s_add_u32 s66, s64, 262144
  v_mfma_f32_16x16x32_bf16 a[100:103], a[24:27], a[148:151], a[100:103]
  v_mfma_f32_16x16x32_bf16 a[116:119], a[28:31], a[148:151], a[116:119]
  v_mfma_f32_16x16x32_bf16 a[132:135], a[32:35], a[148:151], a[132:135]
  s_waitcnt vmcnt(13)
  buffer_load_dwordx4 a[148:151], v2, s[40:43], s65 offen offset:0 sc1
  v_mfma_f32_16x16x32_bf16 a[72:75], a[16:19], a[152:155], a[72:75]
  s_add_u32 s67, s64, 393216
  v_mfma_f32_16x16x32_bf16 a[88:91], a[20:23], a[152:155], a[88:91]
  v_mfma_f32_16x16x32_bf16 a[104:107], a[24:27], a[152:155], a[104:107]
  v_mfma_f32_16x16x32_bf16 a[120:123], a[28:31], a[152:155], a[120:123]
  v_mfma_f32_16x16x32_bf16 a[136:139], a[32:35], a[152:155], a[136:139]
  buffer_load_dwordx4 a[152:155], v2, s[40:43], s66 offen offset:0 sc1
  v_mfma_f32_16x16x32_bf16 a[76:79], a[16:19], a[156:159], a[76:79]
  v_mfma_f32_16x16x32_bf16 a[92:95], a[20:23], a[156:159], a[92:95]
  v_mfma_f32_16x16x32_bf16 a[108:111], a[24:27], a[156:159], a[108:111]
  v_mfma_f32_16x16x32_bf16 a[124:127], a[28:31], a[156:159], a[124:127]
  v_mfma_f32_16x16x32_bf16 a[140:143], a[32:35], a[156:159], a[140:143]
  s_waitcnt vmcnt(13)
  buffer_load_dwordx4 a[156:159], v2, s[40:43], s67 offen offset:0 sc1
  v_mfma_f32_16x16x32_bf16 a[64:67], a[36:39], a[160:163], a[64:67]
  v_mfma_f32_16x16x32_bf16 a[80:83], a[40:43], a[160:163], a[80:83]
  buffer_load_dword v13, v10, s[40:43], 0 offen sc1
  v_mfma_f32_16x16x32_bf16 a[96:99], a[44:47], a[160:163], a[96:99]
  v_mfma_f32_16x16x32_bf16 a[112:115], v[128:131], a[160:163], a[112:115]
  v_mfma_f32_16x16x32_bf16 a[128:131], v[132:135], a[160:163], a[128:131]
  buffer_load_dwordx4 a[160:163], v2, s[40:43], s64 offen offset:1024 sc1
  v_mfma_f32_16x16x32_bf16 a[68:71], a[36:39], a[164:167], a[68:71]
  v_mfma_f32_16x16x32_bf16 a[84:87], a[40:43], a[164:167], a[84:87]
  v_mfma_f32_16x16x32_bf16 a[100:103], a[44:47], a[164:167], a[100:103]
  v_mfma_f32_16x16x32_bf16 a[116:119], v[128:131], a[164:167], a[116:119]
  v_mfma_f32_16x16x32_bf16 a[132:135], v[132:135], a[164:167], a[132:135]
  s_waitcnt vmcnt(14)
  buffer_load_dwordx4 a[164:167], v2, s[40:43], s65 offen offset:1024 sc1
  v_mfma_f32_16x16x32_bf16 a[72:75], a[36:39], a[168:171], a[72:75]
  v_mfma_f32_16x16x32_bf16 a[88:91], a[40:43], a[168:171], a[88:91]
  v_mfma_f32_16x16x32_bf16 a[104:107], a[44:47], a[168:171], a[104:107]
  v_mfma_f32_16x16x32_bf16 a[120:123], v[128:131], a[168:171], a[120:123]
  v_mfma_f32_16x16x32_bf16 a[136:139], v[132:135], a[168:171], a[136:139]
  buffer_load_dwordx4 a[168:171], v2, s[40:43], s66 offen offset:1024 sc1
  v_mfma_f32_16x16x32_bf16 a[76:79], a[36:39], a[172:175], a[76:79]
  v_mfma_f32_16x16x32_bf16 a[92:95], a[40:43], a[172:175], a[92:95]
  v_mfma_f32_16x16x32_bf16 a[108:111], a[44:47], a[172:175], a[108:111]
  v_mfma_f32_16x16x32_bf16 a[124:127], v[128:131], a[172:175], a[124:127]
  v_mfma_f32_16x16x32_bf16 a[140:143], v[132:135], a[172:175], a[140:143]
  s_waitcnt vmcnt(14)
  buffer_load_dwordx4 a[172:175], v2, s[40:43], s67 offen offset:1024 sc1
  v_mfma_f32_16x16x32_bf16 a[64:67], v[136:139], a[176:179], a[64:67]
  v_mfma_f32_16x16x32_bf16 a[80:83], v[140:143], a[176:179], a[80:83]
  v_mfma_f32_16x16x32_bf16 a[96:99], v[144:147], a[176:179], a[96:99]
  v_mfma_f32_16x16x32_bf16 a[112:115], v[148:151], a[176:179], a[112:115]
  v_mfma_f32_16x16x32_bf16 a[128:131], v[152:155], a[176:179], a[128:131]
  buffer_load_dwordx4 a[176:179], v2, s[40:43], s64 offen offset:2048 sc1
  v_mfma_f32_16x16x32_bf16 a[68:71], v[136:139], a[180:183], a[68:71]
  v_mfma_f32_16x16x32_bf16 a[84:87], v[140:143], a[180:183], a[84:87]
  v_mfma_f32_16x16x32_bf16 a[100:103], v[144:147], a[180:183], a[100:103]
  s_barrier
  v_mfma_f32_16x16x32_bf16 a[116:119], v[148:151], a[180:183], a[116:119]
  v_mfma_f32_16x16x32_bf16 a[132:135], v[152:155], a[180:183], a[132:135]
  s_waitcnt vmcnt(14)
  buffer_load_dwordx4 a[180:183], v2, s[40:43], s65 offen offset:2048 sc1
  v_mfma_f32_16x16x32_bf16 a[72:75], v[136:139], a[184:187], a[72:75]
  v_mfma_f32_16x16x32_bf16 a[88:91], v[140:143], a[184:187], a[88:91]
  v_mfma_f32_16x16x32_bf16 a[104:107], v[144:147], a[184:187], a[104:107]
  v_mfma_f32_16x16x32_bf16 a[120:123], v[148:151], a[184:187], a[120:123]
  v_mfma_f32_16x16x32_bf16 a[136:139], v[152:155], a[184:187], a[136:139]
  buffer_load_dwordx4 a[184:187], v2, s[40:43], s66 offen offset:2048 sc1
  v_mfma_f32_16x16x32_bf16 a[76:79], v[136:139], a[188:191], a[76:79]
  v_mfma_f32_16x16x32_bf16 a[92:95], v[140:143], a[188:191], a[92:95]
  v_mfma_f32_16x16x32_bf16 a[108:111], v[144:147], a[188:191], a[108:111]
  v_mfma_f32_16x16x32_bf16 a[124:127], v[148:151], a[188:191], a[124:127]
  v_mfma_f32_16x16x32_bf16 a[140:143], v[152:155], a[188:191], a[140:143]
  s_waitcnt vmcnt(14)
  buffer_load_dwordx4 a[188:191], v2, s[40:43], s67 offen offset:2048 sc1
  v_mfma_f32_16x16x32_bf16 a[64:67], v[156:159], v[216:219], a[64:67]
  v_mfma_f32_16x16x32_bf16 a[80:83], a[48:51], v[216:219], a[80:83]
  v_mfma_f32_16x16x32_bf16 a[96:99], a[52:55], v[216:219], a[96:99]
  v_mfma_f32_16x16x32_bf16 a[112:115], a[56:59], v[216:219], a[112:115]
  v_mfma_f32_16x16x32_bf16 a[128:131], a[60:63], v[216:219], a[128:131]
  buffer_load_dwordx4 v[216:219], v2, s[40:43], s64 offen offset:3072 sc1
  v_mfma_f32_16x16x32_bf16 a[68:71], v[156:159], v[220:223], a[68:71]
  v_mfma_f32_16x16x32_bf16 a[84:87], a[48:51], v[220:223], a[84:87]
  v_mfma_f32_16x16x32_bf16 a[100:103], a[52:55], v[220:223], a[100:103]
  v_mfma_f32_16x16x32_bf16 a[116:119], a[56:59], v[220:223], a[116:119]
  v_mfma_f32_16x16x32_bf16 a[132:135], a[60:63], v[220:223], a[132:135]
  s_waitcnt vmcnt(14)
  buffer_load_dwordx4 v[220:223], v2, s[40:43], s65 offen offset:3072 sc1
  v_mfma_f32_16x16x32_bf16 a[72:75], v[156:159], v[224:227], a[72:75]
  v_mfma_f32_16x16x32_bf16 a[88:91], a[48:51], v[224:227], a[88:91]
  v_mfma_f32_16x16x32_bf16 a[104:107], a[52:55], v[224:227], a[104:107]
  v_mfma_f32_16x16x32_bf16 a[120:123], a[56:59], v[224:227], a[120:123]
  v_mfma_f32_16x16x32_bf16 a[136:139], a[60:63], v[224:227], a[136:139]
  buffer_load_dwordx4 v[224:227], v2, s[40:43], s66 offen offset:3072 sc1
  v_mfma_f32_16x16x32_bf16 a[76:79], v[156:159], v[228:231], a[76:79]
  v_mfma_f32_16x16x32_bf16 a[92:95], a[48:51], v[228:231], a[92:95]
  v_mfma_f32_16x16x32_bf16 a[108:111], a[52:55], v[228:231], a[108:111]
  v_mfma_f32_16x16x32_bf16 a[124:127], a[56:59], v[228:231], a[124:127]
  v_mfma_f32_16x16x32_bf16 a[140:143], a[60:63], v[228:231], a[140:143]
  s_waitcnt vmcnt(11)
  buffer_load_dwordx4 v[228:231], v2, s[40:43], s67 offen offset:3072 sc1
  v_mfma_f32_16x16x32_bf16 a[64:67], a[192:195], a[144:147], a[64:67]
  v_cmp_eq_u32 vcc, 0, v13
  v_mfma_f32_16x16x32_bf16 a[80:83], a[196:199], a[144:147], a[80:83]
  v_mfma_f32_16x16x32_bf16 a[96:99], a[200:203], a[144:147], a[96:99]
  s_cbranch_vccnz fa_ctx2_spin
fa_ctx2_ok:
  v_mfma_f32_16x16x32_bf16 a[112:115], a[204:207], a[144:147], a[112:115]
  s_add_u32 s64, s63, 0
  v_mfma_f32_16x16x32_bf16 a[128:131], v[176:179], a[144:147], a[128:131]
  buffer_load_dwordx4 a[144:147], v2, s[40:43], s64 offen offset:0 sc1
  v_mfma_f32_16x16x32_bf16 a[68:71], a[192:195], a[148:151], a[68:71]
  s_add_u32 s65, s64, 131072
  v_mfma_f32_16x16x32_bf16 a[84:87], a[196:199], a[148:151], a[84:87]
  s_add_u32 s66, s64, 262144
  v_mfma_f32_16x16x32_bf16 a[100:103], a[200:203], a[148:151], a[100:103]
  v_mfma_f32_16x16x32_bf16 a[116:119], a[204:207], a[148:151], a[116:119]
  v_mfma_f32_16x16x32_bf16 a[132:135], v[176:179], a[148:151], a[132:135]
  s_waitcnt vmcnt(14)
  buffer_load_dwordx4 a[148:151], v2, s[40:43], s65 offen offset:0 sc1
  v_mfma_f32_16x16x32_bf16 a[72:75], a[192:195], a[152:155], a[72:75]
  s_add_u32 s67, s64, 393216
  v_mfma_f32_16x16x32_bf16 a[88:91], a[196:199], a[152:155], a[88:91]
  v_mfma_f32_16x16x32_bf16 a[104:107], a[200:203], a[152:155], a[104:107]
  v_mfma_f32_16x16x32_bf16 a[120:123], a[204:207], a[152:155], a[120:123]
  v_mfma_f32_16x16x32_bf16 a[136:139], v[176:179], a[152:155], a[136:139]
  buffer_load_dwordx4 a[152:155], v2, s[40:43], s66 offen offset:0 sc1
  v_mfma_f32_16x16x32_bf16 a[76:79], a[192:195], a[156:159], a[76:79]
  v_mfma_f32_16x16x32_bf16 a[92:95], a[196:199], a[156:159], a[92:95]
  v_mfma_f32_16x16x32_bf16 a[108:111], a[200:203], a[156:159], a[108:111]
  v_mfma_f32_16x16x32_bf16 a[124:127], a[204:207], a[156:159], a[124:127]
  v_mfma_f32_16x16x32_bf16 a[140:143], v[176:179], a[156:159], a[140:143]
  s_waitcnt vmcnt(13)
  buffer_load_dwordx4 a[156:159], v2, s[40:43], s67 offen offset:0 sc1
  v_mfma_f32_16x16x32_bf16 a[64:67], v[180:183], a[160:163], a[64:67]
  v_mfma_f32_16x16x32_bf16 a[80:83], v[184:187], a[160:163], a[80:83]
  v_mfma_f32_16x16x32_bf16 a[96:99], v[188:191], a[160:163], a[96:99]
  v_mfma_f32_16x16x32_bf16 a[112:115], a[208:211], a[160:163], a[112:115]
  v_mfma_f32_16x16x32_bf16 a[128:131], a[212:215], a[160:163], a[128:131]
  buffer_load_dwordx4 a[160:163], v2, s[40:43], s64 offen offset:1024 sc1
  v_mfma_f32_16x16x32_bf16 a[68:71], v[180:183], a[164:167], a[68:71]
  v_mfma_f32_16x16x32_bf16 a[84:87], v[184:187], a[164:167], a[84:87]
  v_mfma_f32_16x16x32_bf16 a[100:103], v[188:191], a[164:167], a[100:103]
  v_mfma_f32_16x16x32_bf16 a[116:119], a[208:211], a[164:167], a[116:119]
  v_mfma_f32_16x16x32_bf16 a[132:135], a[212:215], a[164:167], a[132:135]
  s_waitcnt vmcnt(13)
  buffer_load_dwordx4 a[164:167], v2, s[40:43], s65 offen offset:1024 sc1
  v_mfma_f32_16x16x32_bf16 a[72:75], v[180:183], a[168:171], a[72:75]
  v_mfma_f32_16x16x32_bf16 a[88:91], v[184:187], a[168:171], a[88:91]
  v_mfma_f32_16x16x32_bf16 a[104:107], v[188:191], a[168:171], a[104:107]
  v_mfma_f32_16x16x32_bf16 a[120:123], a[208:211], a[168:171], a[120:123]
  v_mfma_f32_16x16x32_bf16 a[136:139], a[212:215], a[168:171], a[136:139]
  buffer_load_dwordx4 a[168:171], v2, s[40:43], s66 offen offset:1024 sc1
  v_mfma_f32_16x16x32_bf16 a[76:79], v[180:183], a[172:175], a[76:79]
  v_mfma_f32_16x16x32_bf16 a[92:95], v[184:187], a[172:175], a[92:95]
  v_mfma_f32_16x16x32_bf16 a[108:111], v[188:191], a[172:175], a[108:111]
  v_mfma_f32_16x16x32_bf16 a[124:127], a[208:211], a[172:175], a[124:127]
  v_mfma_f32_16x16x32_bf16 a[140:143], a[212:215], a[172:175], a[140:143]
  s_waitcnt vmcnt(13)
  buffer_load_dwordx4 a[172:175], v2, s[40:43], s67 offen offset:1024 sc1
  v_mfma_f32_16x16x32_bf16 a[64:67], a[216:219], a[176:179], a[64:67]
  v_mfma_f32_16x16x32_bf16 a[80:83], a[220:223], a[176:179], a[80:83]
  v_mfma_f32_16x16x32_bf16 a[96:99], a[224:227], a[176:179], a[96:99]
  v_mfma_f32_16x16x32_bf16 a[112:115], a[228:231], a[176:179], a[112:115]
  v_mfma_f32_16x16x32_bf16 a[128:131], a[232:235], a[176:179], a[128:131]
  buffer_load_dwordx4 a[176:179], v2, s[40:43], s64 offen offset:2048 sc1
  v_mfma_f32_16x16x32_bf16 a[68:71], a[216:219], a[180:183], a[68:71]
  v_mfma_f32_16x16x32_bf16 a[84:87], a[220:223], a[180:183], a[84:87]
  v_mfma_f32_16x16x32_bf16 a[100:103], a[224:227], a[180:183], a[100:103]
  v_mfma_f32_16x16x32_bf16 a[116:119], a[228:231], a[180:183], a[116:119]
  v_mfma_f32_16x16x32_bf16 a[132:135], a[232:235], a[180:183], a[132:135]
  s_waitcnt vmcnt(13)
  buffer_load_dwordx4 a[180:183], v2, s[40:43], s65 offen offset:2048 sc1
  v_mfma_f32_16x16x32_bf16 a[72:75], a[216:219], a[184:187], a[72:75]
  v_mfma_f32_16x16x32_bf16 a[88:91], a[220:223], a[184:187], a[88:91]
  v_mfma_f32_16x16x32_bf16 a[104:107], a[224:227], a[184:187], a[104:107]
  v_mfma_f32_16x16x32_bf16 a[120:123], a[228:231], a[184:187], a[120:123]
  v_mfma_f32_16x16x32_bf16 a[136:139], a[232:235], a[184:187], a[136:139]
  buffer_load_dwordx4 a[184:187], v2, s[40:43], s66 offen offset:2048 sc1
  v_mfma_f32_16x16x32_bf16 a[76:79], a[216:219], a[188:191], a[76:79]
  v_mfma_f32_16x16x32_bf16 a[92:95], a[220:223], a[188:191], a[92:95]
  v_mfma_f32_16x16x32_bf16 a[108:111], a[224:227], a[188:191], a[108:111]
  v_mfma_f32_16x16x32_bf16 a[124:127], a[228:231], a[188:191], a[124:127]
  v_mfma_f32_16x16x32_bf16 a[140:143], a[232:235], a[188:191], a[140:143]
  s_waitcnt vmcnt(13)
  buffer_load_dwordx4 a[188:191], v2, s[40:43], s67 offen offset:2048 sc1
  v_mfma_f32_16x16x32_bf16 a[64:67], a[236:239], v[216:219], a[64:67]
  v_mfma_f32_16x16x32_bf16 a[80:83], a[240:243], v[216:219], a[80:83]
  v_mfma_f32_16x16x32_bf16 a[96:99], a[244:247], v[216:219], a[96:99]
  v_mfma_f32_16x16x32_bf16 a[112:115], a[248:251], v[216:219], a[112:115]
  v_mfma_f32_16x16x32_bf16 a[128:131], a[252:255], v[216:219], a[128:131]
  buffer_load_dwordx4 v[216:219], v2, s[40:43], s64 offen offset:3072 sc1
  v_mfma_f32_16x16x32_bf16 a[68:71], a[236:239], v[220:223], a[68:71]
  v_mfma_f32_16x16x32_bf16 a[84:87], a[240:243], v[220:223], a[84:87]
  v_mfma_f32_16x16x32_bf16 a[100:103], a[244:247], v[220:223], a[100:103]
  v_mfma_f32_16x16x32_bf16 a[116:119], a[248:251], v[220:223], a[116:119]
  v_mfma_f32_16x16x32_bf16 a[132:135], a[252:255], v[220:223], a[132:135]
  s_waitcnt vmcnt(13)
  buffer_load_dwordx4 v[220:223], v2, s[40:43], s65 offen offset:3072 sc1
  ds_write_b128 v16, a[64:67] offset:0
  v_mfma_f32_16x16x32_bf16 a[72:75], a[236:239], v[224:227], a[72:75]
  ds_write_b128 v16, a[80:83] offset:64
  v_mfma_f32_16x16x32_bf16 a[88:91], a[240:243], v[224:227], a[88:91]
  ds_write_b128 v16, a[96:99] offset:128
  v_mfma_f32_16x16x32_bf16 a[104:107], a[244:247], v[224:227], a[104:107]
  ds_write_b128 v16, a[112:115] offset:192
  v_mfma_f32_16x16x32_bf16 a[120:123], a[248:251], v[224:227], a[120:123]
  ds_write_b128 v16, a[128:131] offset:256
  v_mfma_f32_16x16x32_bf16 a[136:139], a[252:255], v[224:227], a[136:139]
  buffer_load_dwordx4 v[224:227], v2, s[40:43], s66 offen offset:3072 sc1
  ds_write_b128 v16, a[68:71] offset:5376
  v_mfma_f32_16x16x32_bf16 a[76:79], a[236:239], v[228:231], a[76:79]
  ds_write_b128 v16, a[84:87] offset:5440
  v_mfma_f32_16x16x32_bf16 a[92:95], a[240:243], v[228:231], a[92:95]
  ds_write_b128 v16, a[100:103] offset:5504
  v_mfma_f32_16x16x32_bf16 a[108:111], a[244:247], v[228:231], a[108:111]
  ds_write_b128 v16, a[116:119] offset:5568
  v_mfma_f32_16x16x32_bf16 a[124:127], a[248:251], v[228:231], a[124:127]
  ds_write_b128 v16, a[132:135] offset:5632
  v_mfma_f32_16x16x32_bf16 a[140:143], a[252:255], v[228:231], a[140:143]
  s_waitcnt vmcnt(13)
  buffer_load_dwordx4 v[228:231], v2, s[40:43], s67 offen offset:3072 sc1
  ds_write_b128 v16, a[72:75] offset:10752
  v_mfma_f32_16x16x32_bf16 a[64:67], v[32:35], a[144:147], 0
  ds_write_b128 v16, a[88:91] offset:10816
  v_mfma_f32_16x16x32_bf16 a[80:83], v[36:39], a[144:147], 0
  ds_write_b128 v16, a[104:107] offset:10880
  v_mfma_f32_16x16x32_bf16 a[96:99], v[40:43], a[144:147], 0
  ds_write_b128 v16, a[120:123] offset:10944
  v_mfma_f32_16x16x32_bf16 a[112:115], v[44:47], a[144:147], 0
  s_add_u32 s64, s64, 4096
  ds_write_b128 v16, a[136:139] offset:11008
  v_mfma_f32_16x16x32_bf16 a[128:131], v[48:51], a[144:147], 0
  buffer_load_dwordx4 a[144:147], v2, s[40:43], s64 offen offset:0 sc1
  ds_write_b128 v16, a[76:79] offset:16128
  v_mfma_f32_16x16x32_bf16 a[68:71], v[32:35], a[148:151], 0
  s_add_u32 s65, s64, 131072
  ds_write_b128 v16, a[92:95] offset:16192
  v_mfma_f32_16x16x32_bf16 a[84:87], v[36:39], a[148:151], 0
  s_add_u32 s66, s64, 262144
  ds_write_b128 v16, a[108:111] offset:16256
  v_mfma_f32_16x16x32_bf16 a[100:103], v[40:43], a[148:151], 0
  ds_write_b128 v16, a[124:127] offset:16320
  v_mfma_f32_16x16x32_bf16 a[116:119], v[44:47], a[148:151], 0
  ds_write_b128 v16, a[140:143] offset:16384
  v_mfma_f32_16x16x32_bf16 a[132:135], v[48:51], a[148:151], 0
  s_waitcnt vmcnt(13)
  buffer_load_dwordx4 a[148:151], v2, s[40:43], s65 offen offset:0 sc1
  v_mfma_f32_16x16x32_bf16 a[72:75], v[32:35], a[152:155], 0
  s_add_u32 s67, s64, 393216
  v_mfma_f32_16x16x32_bf16 a[88:91], v[36:39], a[152:155], 0
  v_mfma_f32_16x16x32_bf16 a[104:107], v[40:43], a[152:155], 0
  v_mfma_f32_16x16x32_bf16 a[120:123], v[44:47], a[152:155], 0
  v_mfma_f32_16x16x32_bf16 a[136:139], v[48:51], a[152:155], 0
  buffer_load_dwordx4 a[152:155], v2, s[40:43], s66 offen offset:0 sc1
  v_mfma_f32_16x16x32_bf16 a[76:79], v[32:35], a[156:159], 0
  v_mfma_f32_16x16x32_bf16 a[92:95], v[36:39], a[156:159], 0
  v_mfma_f32_16x16x32_bf16 a[108:111], v[40:43], a[156:159], 0
  v_mfma_f32_16x16x32_bf16 a[124:127], v[44:47], a[156:159], 0
  v_mfma_f32_16x16x32_bf16 a[140:143], v[48:51], a[156:159], 0
  s_waitcnt vmcnt(13) lgkmcnt(0)
  buffer_load_dwordx4 a[156:159], v2, s[40:43], s67 offen offset:0 sc1
  v_mfma_f32_16x16x32_bf16 a[64:67], v[52:55], a[160:163], a[64:67]
  v_mfma_f32_16x16x32_bf16 a[80:83], v[56:59], a[160:163], a[80:83]
  v_mfma_f32_16x16x32_bf16 a[96:99], v[60:63], a[160:163], a[96:99]
  v_mfma_f32_16x16x32_bf16 a[112:115], v[96:99], a[160:163], a[112:115]
  v_mfma_f32_16x16x32_bf16 a[128:131], v[100:103], a[160:163], a[128:131]
  buffer_load_dwordx4 a[160:163], v2, s[40:43], s64 offen offset:1024 sc1
  v_mfma_f32_16x16x32_bf16 a[68:71], v[52:55], a[164:167], a[68:71]
  v_mfma_f32_16x16x32_bf16 a[84:87], v[56:59], a[164:167], a[84:87]
  v_mfma_f32_16x16x32_bf16 a[100:103], v[60:63], a[164:167], a[100:103]
  s_barrier
  v_mfma_f32_16x16x32_bf16 a[116:119], v[96:99], a[164:167], a[116:119]
  v_mfma_f32_16x16x32_bf16 a[132:135], v[100:103], a[164:167], a[132:135]
  s_waitcnt vmcnt(13)
  buffer_load_dwordx4 a[164:167], v2, s[40:43], s65 offen offset:1024 sc1
  v_mfma_f32_16x16x32_bf16 a[72:75], v[52:55], a[168:171], a[72:75]
  v_mfma_f32_16x16x32_bf16 a[88:91], v[56:59], a[168:171], a[88:91]
  v_mfma_f32_16x16x32_bf16 a[104:107], v[60:63], a[168:171], a[104:107]
  v_mfma_f32_16x16x32_bf16 a[120:123], v[96:99], a[168:171], a[120:123]
  v_mfma_f32_16x16x32_bf16 a[136:139], v[100:103], a[168:171], a[136:139]
  buffer_load_dwordx4 a[168:171], v2, s[40:43], s66 offen offset:1024 sc1
  v_mfma_f32_16x16x32_bf16 a[76:79], v[52:55], a[172:175], a[76:79]
  v_mfma_f32_16x16x32_bf16 a[92:95], v[56:59], a[172:175], a[92:95]
  v_mfma_f32_16x16x32_bf16 a[108:111], v[60:63], a[172:175], a[108:111]
  v_mfma_f32_16x16x32_bf16 a[124:127], v[96:99], a[172:175], a[124:127]
  v_mfma_f32_16x16x32_bf16 a[140:143], v[100:103], a[172:175], a[140:143]
  s_waitcnt vmcnt(13)
  buffer_load_dwordx4 a[172:175], v2, s[40:43], s67 offen offset:1024 sc1
  v_mfma_f32_16x16x32_bf16 a[64:67], v[104:107], a[176:179], a[64:67]
  ds_read_b128 v[32:35], v251 offset:0
  v_mfma_f32_16x16x32_bf16 a[80:83], v[108:111], a[176:179], a[80:83]
  ds_read_b128 v[36:39], v251 offset:16
  v_mfma_f32_16x16x32_bf16 a[96:99], v[112:115], a[176:179], a[96:99]
  ds_read_b128 v[40:43], v251 offset:21504
  v_mfma_f32_16x16x32_bf16 a[112:115], v[116:119], a[176:179], a[112:115]
  ds_read_b128 v[44:47], v251 offset:21520
  v_mfma_f32_16x16x32_bf16 a[128:131], v[120:123], a[176:179], a[128:131]
  buffer_load_dwordx4 a[176:179], v2, s[40:43], s64 offen offset:2048 sc1
  v_mfma_f32_16x16x32_bf16 a[68:71], v[104:107], a[180:183], a[68:71]
  ds_read_b128 v[48:51], v251 offset:43008
  v_mfma_f32_16x16x32_bf16 a[84:87], v[108:111], a[180:183], a[84:87]
  ds_read_b128 v[52:55], v251 offset:43024
  v_mfma_f32_16x16x32_bf16 a[100:103], v[112:115], a[180:183], a[100:103]
  ds_read_b128 v[56:59], v251 offset:64512
  v_mfma_f32_16x16x32_bf16 a[116:119], v[116:119], a[180:183], a[116:119]
  ds_read_b128 v[60:63], v251 offset:64528
  v_mfma_f32_16x16x32_bf16 a[132:135], v[120:123], a[180:183], a[132:135]
  s_waitcnt vmcnt(13)
  buffer_load_dwordx4 a[180:183], v2, s[40:43], s65 offen offset:2048 sc1
  v_mfma_f32_16x16x32_bf16 a[72:75], v[104:107], a[184:187], a[72:75]
  v_mfma_f32_16x16x32_bf16 a[88:91], v[108:111], a[184:187], a[88:91]
  v_mfma_f32_16x16x32_bf16 a[104:107], v[112:115], a[184:187], a[104:107]
  v_mfma_f32_16x16x32_bf16 a[120:123], v[116:119], a[184:187], a[120:123]
  v_mfma_f32_16x16x32_bf16 a[136:139], v[120:123], a[184:187], a[136:139]
  buffer_load_dwordx4 a[184:187], v2, s[40:43], s66 offen offset:2048 sc1
  v_mfma_f32_16x16x32_bf16 a[76:79], v[104:107], a[188:191], a[76:79]
  v_mfma_f32_16x16x32_bf16 a[92:95], v[108:111], a[188:191], a[92:95]
  v_mfma_f32_16x16x32_bf16 a[108:111], v[112:115], a[188:191], a[108:111]
  v_mfma_f32_16x16x32_bf16 a[124:127], v[116:119], a[188:191], a[124:127]
  v_mfma_f32_16x16x32_bf16 a[140:143], v[120:123], a[188:191], a[140:143]
  s_waitcnt vmcnt(13) lgkmcnt(0)
  buffer_load_dwordx4 a[188:191], v2, s[40:43], s67 offen offset:2048 sc1
  v_mfma_f32_16x16x32_bf16 a[64:67], v[124:127], v[216:219], a[64:67]
  v_add_f32 v32, v32, v40
  v_add_f32 v48, v48, v56
  v_mfma_f32_16x16x32_bf16 a[80:83], v[160:163], v[216:219], a[80:83]
  v_add_f32 v33, v33, v41
  v_add_f32 v49, v49, v57
  v_mfma_f32_16x16x32_bf16 a[96:99], v[164:167], v[216:219], a[96:99]
  v_add_f32 v34, v34, v42
  v_mfma_f32_16x16x32_bf16 a[112:115], v[168:171], v[216:219], a[112:115]
  v_add_f32 v50, v50, v58
  v_add_f32 v35, v35, v43
  v_mfma_f32_16x16x32_bf16 a[128:131], v[172:175], v[216:219], a[128:131]
  buffer_load_dwordx4 v[216:219], v2, s[40:43], s64 offen offset:3072 sc1
  v_add_f32 v51, v51, v59
  v_mfma_f32_16x16x32_bf16 a[68:71], v[124:127], v[220:223], a[68:71]
  v_add_f32 v36, v36, v44
  v_add_f32 v52, v52, v60
  v_mfma_f32_16x16x32_bf16 a[84:87], v[160:163], v[220:223], a[84:87]
  v_add_f32 v37, v37, v45
  v_add_f32 v53, v53, v61
  v_mfma_f32_16x16x32_bf16 a[100:103], v[164:167], v[220:223], a[100:103]
  v_add_f32 v38, v38, v46
  v_mfma_f32_16x16x32_bf16 a[116:119], v[168:171], v[220:223], a[116:119]
  v_add_f32 v54, v54, v62
  v_add_f32 v39, v39, v47
  v_mfma_f32_16x16x32_bf16 a[132:135], v[172:175], v[220:223], a[132:135]
  s_waitcnt vmcnt(13)
  buffer_load_dwordx4 v[220:223], v2, s[40:43], s65 offen offset:3072 sc1
  v_add_f32 v55, v55, v63
  v_mfma_f32_16x16x32_bf16 a[72:75], v[124:127], v[224:227], a[72:75]
  v_add_f32 v32, v32, v48
  v_add_f32 v33, v33, v49
  v_mfma_f32_16x16x32_bf16 a[88:91], v[160:163], v[224:227], a[88:91]
  v_add_f32 v34, v34, v50
  v_add_f32 v35, v35, v51
  v_mfma_f32_16x16x32_bf16 a[104:107], v[164:167], v[224:227], a[104:107]
  v_add_f32 v36, v36, v52
  v_mfma_f32_16x16x32_bf16 a[120:123], v[168:171], v[224:227], a[120:123]
  v_add_f32 v37, v37, v53
  v_add_f32 v38, v38, v54
  v_mfma_f32_16x16x32_bf16 a[136:139], v[172:175], v[224:227], a[136:139]
  buffer_load_dwordx4 v[224:227], v2, s[40:43], s66 offen offset:3072 sc1
  v_add_f32 v39, v39, v55
  v_mfma_f32_16x16x32_bf16 a[76:79], v[124:127], v[228:231], a[76:79]
  s_add_u32 s14, s28, 0
  v_mfma_f32_16x16x32_bf16 a[92:95], v[160:163], v[228:231], a[92:95]
  buffer_store_dwordx4 v[32:35], v9, s[40:43], s14 offen sc1
  v_mfma_f32_16x16x32_bf16 a[108:111], v[164:167], v[228:231], a[108:111]
  s_add_u32 s14, s28, 4096
  v_mfma_f32_16x16x32_bf16 a[124:127], v[168:171], v[228:231], a[124:127]
  buffer_store_dwordx4 v[36:39], v9, s[40:43], s14 offen sc1
  v_mfma_f32_16x16x32_bf16 a[140:143], v[172:175], v[228:231], a[140:143]
  s_waitcnt vmcnt(15)
  buffer_load_dwordx4 v[228:231], v2, s[40:43], s67 offen offset:3072 sc1
  v_mfma_f32_16x16x32_bf16 a[64:67], v[232:235], a[144:147], a[64:67]
  ds_read_b128 v[96:99], v252 offset:0
  v_mfma_f32_16x16x32_bf16 a[80:83], v[236:239], a[144:147], a[80:83]
  ds_read_b128 v[100:103], v252 offset:16
  v_mfma_f32_16x16x32_bf16 a[96:99], v[240:243], a[144:147], a[96:99]
  ds_read_b128 v[104:107], v252 offset:21504
  v_mfma_f32_16x16x32_bf16 a[112:115], v[244:247], a[144:147], a[112:115]
  s_add_u32 s64, s64, 4096
  ds_read_b128 v[108:111], v252 offset:21520
  v_mfma_f32_16x16x32_bf16 a[128:131], v[192:195], a[144:147], a[128:131]
  buffer_load_dwordx4 a[144:147], v2, s[40:43], s64 offen offset:0 sc1
  v_mfma_f32_16x16x32_bf16 a[68:71], v[232:235], a[148:151], a[68:71]
  s_add_u32 s65, s64, 131072
  ds_read_b128 v[112:115], v252 offset:43008
  v_mfma_f32_16x16x32_bf16 a[84:87], v[236:239], a[148:151], a[84:87]
  s_add_u32 s66, s64, 262144
  ds_read_b128 v[116:119], v252 offset:43024
  v_mfma_f32_16x16x32_bf16 a[100:103], v[240:243], a[148:151], a[100:103]
  ds_read_b128 v[120:123], v252 offset:64512
  v_mfma_f32_16x16x32_bf16 a[116:119], v[244:247], a[148:151], a[116:119]
  ds_read_b128 v[124:127], v252 offset:64528
  v_mfma_f32_16x16x32_bf16 a[132:135], v[192:195], a[148:151], a[132:135]
  s_waitcnt vmcnt(15)
  buffer_load_dwordx4 a[148:151], v2, s[40:43], s65 offen offset:0 sc1
  v_mfma_f32_16x16x32_bf16 a[72:75], v[232:235], a[152:155], a[72:75]
  s_add_u32 s67, s64, 393216
  v_mfma_f32_16x16x32_bf16 a[88:91], v[236:239], a[152:155], a[88:91]
  v_mfma_f32_16x16x32_bf16 a[104:107], v[240:243], a[152:155], a[104:107]
  v_mfma_f32_16x16x32_bf16 a[120:123], v[244:247], a[152:155], a[120:123]
  v_mfma_f32_16x16x32_bf16 a[136:139], v[192:195], a[152:155], a[136:139]
  buffer_load_dwordx4 a[152:155], v2, s[40:43], s66 offen offset:0 sc1
  v_mfma_f32_16x16x32_bf16 a[76:79], v[232:235], a[156:159], a[76:79]
  v_mfma_f32_16x16x32_bf16 a[92:95], v[236:239], a[156:159], a[92:95]
  v_mfma_f32_16x16x32_bf16 a[108:111], v[240:243], a[156:159], a[108:111]
  v_mfma_f32_16x16x32_bf16 a[124:127], v[244:247], a[156:159], a[124:127]
  v_mfma_f32_16x16x32_bf16 a[140:143], v[192:195], a[156:159], a[140:143]
  s_waitcnt vmcnt(15) lgkmcnt(0)
  buffer_load_dwordx4 a[156:159], v2, s[40:43], s67 offen offset:0 sc1
  v_mfma_f32_16x16x32_bf16 a[64:67], v[196:199], a[160:163], a[64:67]
  ds_read_b128 v[32:35], v253 offset:0
  v_add_f32 v96, v96, v104
  v_add_f32 v112, v112, v120
  v_mfma_f32_16x16x32_bf16 a[80:83], v[208:211], a[160:163], a[80:83]
  ds_read_b128 v[36:39], v253 offset:16
  v_add_f32 v97, v97, v105
  v_add_f32 v113, v113, v121
  v_mfma_f32_16x16x32_bf16 a[96:99], v[212:215], a[160:163], a[96:99]
  ds_read_b128 v[40:43], v253 offset:21504
  v_add_f32 v98, v98, v106
  v_mfma_f32_16x16x32_bf16 a[112:115], a[0:3], a[160:163], a[112:115]
  ds_read_b128 v[44:47], v253 offset:21520
  v_add_f32 v114, v114, v122
  v_add_f32 v99, v99, v107
  v_mfma_f32_16x16x32_bf16 a[128:131], a[4:7], a[160:163], a[128:131]
  buffer_load_dwordx4 a[160:163], v2, s[40:43], s64 offen offset:1024 sc1
  v_add_f32 v115, v115, v123
  v_mfma_f32_16x16x32_bf16 a[68:71], v[196:199], a[164:167], a[68:71]
  ds_read_b128 v[48:51], v253 offset:43008
  v_add_f32 v100, v100, v108
  v_add_f32 v116, v116, v124
  v_mfma_f32_16x16x32_bf16 a[84:87], v[208:211], a[164:167], a[84:87]
  ds_read_b128 v[52:55], v253 offset:43024
  v_add_f32 v101, v101, v109
  v_add_f32 v117, v117, v125
  v_mfma_f32_16x16x32_bf16 a[100:103], v[212:215], a[164:167], a[100:103]
  ds_read_b128 v[56:59], v253 offset:64512
  v_add_f32 v102, v102, v110
  v_mfma_f32_16x16x32_bf16 a[116:119], a[0:3], a[164:167], a[116:119]
  ds_read_b128 v[60:63], v253 offset:64528
  v_add_f32 v118, v118, v126
  v_add_f32 v103, v103, v111
  v_mfma_f32_16x16x32_bf16 a[132:135], a[4:7], a[164:167], a[132:135]
  s_waitcnt vmcnt(15)
  buffer_load_dwordx4 a[164:167], v2, s[40:43], s65 offen offset:1024 sc1
  v_add_f32 v119, v119, v127
  v_mfma_f32_16x16x32_bf16 a[72:75], v[196:199], a[168:171], a[72:75]
  v_add_f32 v96, v96, v112
  v_add_f32 v97, v97, v113
  v_mfma_f32_16x16x32_bf16 a[88:91], v[208:211], a[168:171], a[88:91]
  v_add_f32 v98, v98, v114
  v_add_f32 v99, v99, v115
  v_mfma_f32_16x16x32_bf16 a[104:107], v[212:215], a[168:171], a[104:107]
  v_add_f32 v100, v100, v116
  v_mfma_f32_16x16x32_bf16 a[120:123], a[0:3], a[168:171], a[120:123]
  v_add_f32 v101, v101, v117
  v_add_f32 v102, v102, v118
  v_mfma_f32_16x16x32_bf16 a[136:139], a[4:7], a[168:171], a[136:139]
  buffer_load_dwordx4 a[168:171], v2, s[40:43], s66 offen offset:1024 sc1
  v_add_f32 v103, v103, v119
  v_mfma_f32_16x16x32_bf16 a[76:79], v[196:199], a[172:175], a[76:79]
  s_add_u32 s14, s28, 8192
  v_mfma_f32_16x16x32_bf16 a[92:95], v[208:211], a[172:175], a[92:95]
  buffer_store_dwordx4 v[96:99], v9, s[40:43], s14 offen sc1
  v_mfma_f32_16x16x32_bf16 a[108:111], v[212:215], a[172:175], a[108:111]
  s_add_u32 s14, s28, 12288
  v_mfma_f32_16x16x32_bf16 a[124:127], a[0:3], a[172:175], a[124:127]
  buffer_store_dwordx4 v[100:103], v9, s[40:43], s14 offen sc1
  v_mfma_f32_16x16x32_bf16 a[140:143], a[4:7], a[172:175], a[140:143]
  s_waitcnt vmcnt(17) lgkmcnt(0)
  buffer_load_dwordx4 a[172:175], v2, s[40:43], s67 offen offset:1024 sc1
  v_mfma_f32_16x16x32_bf16 a[64:67], a[8:11], a[176:179], a[64:67]
  v_add_f32 v32, v32, v40
  v_add_f32 v48, v48, v56
  v_mfma_f32_16x16x32_bf16 a[80:83], a[12:15], a[176:179], a[80:83]
  v_add_f32 v33, v33, v41
  v_add_f32 v49, v49, v57
  v_mfma_f32_16x16x32_bf16 a[96:99], v[64:67], a[176:179], a[96:99]
  v_add_f32 v34, v34, v42
  v_mfma_f32_16x16x32_bf16 a[112:115], v[68:71], a[176:179], a[112:115]
  v_add_f32 v50, v50, v58
  v_add_f32 v35, v35, v43
  v_mfma_f32_16x16x32_bf16 a[128:131], v[72:75], a[176:179], a[128:131]
  buffer_load_dwordx4 a[176:179], v2, s[40:43], s64 offen offset:2048 sc1
  v_add_f32 v51, v51, v59
  v_mfma_f32_16x16x32_bf16 a[68:71], a[8:11], a[180:183], a[68:71]
  v_add_f32 v36, v36, v44
  v_add_f32 v52, v52, v60
  v_mfma_f32_16x16x32_bf16 a[84:87], a[12:15], a[180:183], a[84:87]
  v_add_f32 v37, v37, v45
  v_add_f32 v53, v53, v61
  v_mfma_f32_16x16x32_bf16 a[100:103], v[64:67], a[180:183], a[100:103]
  v_add_f32 v38, v38, v46
  v_mfma_f32_16x16x32_bf16 a[116:119], v[68:71], a[180:183], a[116:119]
  v_add_f32 v54, v54, v62
  v_add_f32 v39, v39, v47
  v_mfma_f32_16x16x32_bf16 a[132:135], v[72:75], a[180:183], a[132:135]
  s_waitcnt vmcnt(17)
  buffer_load_dwordx4 a[180:183], v2, s[40:43], s65 offen offset:2048 sc1
  v_add_f32 v55, v55, v63
  v_mfma_f32_16x16x32_bf16 a[72:75], a[8:11], a[184:187], a[72:75]
  v_add_f32 v32, v32, v48
  v_add_f32 v33, v33, v49
  v_mfma_f32_16x16x32_bf16 a[88:91], a[12:15], a[184:187], a[88:91]
  v_add_f32 v34, v34, v50
  v_add_f32 v35, v35, v51
  v_mfma_f32_16x16x32_bf16 a[104:107], v[64:67], a[184:187], a[104:107]
  v_add_f32 v36, v36, v52
  v_mfma_f32_16x16x32_bf16 a[120:123], v[68:71], a[184:187], a[120:123]
  v_add_f32 v37, v37, v53
  v_add_f32 v38, v38, v54
  v_mfma_f32_16x16x32_bf16 a[136:139], v[72:75], a[184:187], a[136:139]
  buffer_load_dwordx4 a[184:187], v2, s[40:43], s66 offen offset:2048 sc1
  v_add_f32 v39, v39, v55
  v_mfma_f32_16x16x32_bf16 a[76:79], a[8:11], a[188:191], a[76:79]
  s_add_u32 s14, s28, 16384
  v_mfma_f32_16x16x32_bf16 a[92:95], a[12:15], a[188:191], a[92:95]
  buffer_store_dwordx4 v[32:35], v6, s[40:43], s14 offen sc1
  v_mfma_f32_16x16x32_bf16 a[108:111], v[64:67], a[188:191], a[108:111]
  s_add_u32 s14, s28, 20480
  v_mfma_f32_16x16x32_bf16 a[124:127], v[68:71], a[188:191], a[124:127]
  buffer_store_dwordx4 v[36:39], v6, s[40:43], s14 offen sc1
  v_mfma_f32_16x16x32_bf16 a[140:143], v[72:75], a[188:191], a[140:143]
  s_waitcnt vmcnt(19)
  buffer_load_dwordx4 a[188:191], v2, s[40:43], s67 offen offset:2048 sc1
  v_mfma_f32_16x16x32_bf16 a[64:67], v[76:79], v[216:219], a[64:67]
  v_mfma_f32_16x16x32_bf16 a[80:83], v[80:83], v[216:219], a[80:83]
  v_mfma_f32_16x16x32_bf16 a[96:99], v[84:87], v[216:219], a[96:99]
  v_mfma_f32_16x16x32_bf16 a[112:115], v[88:91], v[216:219], a[112:115]
  v_mfma_f32_16x16x32_bf16 a[128:131], v[92:95], v[216:219], a[128:131]
  buffer_load_dwordx4 v[216:219], v2, s[40:43], s64 offen offset:3072 sc1
  v_mfma_f32_16x16x32_bf16 a[68:71], v[76:79], v[220:223], a[68:71]
  v_mfma_f32_16x16x32_bf16 a[84:87], v[80:83], v[220:223], a[84:87]
  v_mfma_f32_16x16x32_bf16 a[100:103], v[84:87], v[220:223], a[100:103]
  s_barrier
  v_mfma_f32_16x16x32_bf16 a[116:119], v[88:91], v[220:223], a[116:119]
  v_mfma_f32_16x16x32_bf16 a[132:135], v[92:95], v[220:223], a[132:135]
  s_waitcnt vmcnt(17)
  buffer_load_dwordx4 v[220:223], v2, s[40:43], s65 offen offset:3072 sc1
  v_mfma_f32_16x16x32_bf16 a[72:75], v[76:79], v[224:227], a[72:75]
  v_mfma_f32_16x16x32_bf16 a[88:91], v[80:83], v[224:227], a[88:91]
  v_mfma_f32_16x16x32_bf16 a[104:107], v[84:87], v[224:227], a[104:107]
  v_mfma_f32_16x16x32_bf16 a[120:123], v[88:91], v[224:227], a[120:123]
  v_mfma_f32_16x16x32_bf16 a[136:139], v[92:95], v[224:227], a[136:139]
  buffer_load_dwordx4 v[224:227], v2, s[40:43], s66 offen offset:3072 sc1
  v_mfma_f32_16x16x32_bf16 a[76:79], v[76:79], v[228:231], a[76:79]
  v_mfma_f32_16x16x32_bf16 a[92:95], v[80:83], v[228:231], a[92:95]
  v_mfma_f32_16x16x32_bf16 a[108:111], v[84:87], v[228:231], a[108:111]
  v_mfma_f32_16x16x32_bf16 a[124:127], v[88:91], v[228:231], a[124:127]
  v_mfma_f32_16x16x32_bf16 a[140:143], v[92:95], v[228:231], a[140:143]
  s_waitcnt vmcnt(17)
  buffer_load_dwordx4 v[228:231], v2, s[40:43], s67 offen offset:3072 sc1
  v_mfma_f32_16x16x32_bf16 a[64:67], a[16:19], a[144:147], a[64:67]
  ds_read_b128 v[160:163], v200 offset:0
  v_mfma_f32_16x16x32_bf16 a[80:83], a[20:23], a[144:147], a[80:83]
  v_mfma_f32_16x16x32_bf16 a[96:99], a[24:27], a[144:147], a[96:99]
  v_mfma_f32_16x16x32_bf16 a[112:115], a[28:31], a[144:147], a[112:115]
  s_add_u32 s64, s64, 4096
  ds_read_b128 v[164:167], v200 offset:1024
  v_mfma_f32_16x16x32_bf16 a[128:131], a[32:35], a[144:147], a[128:131]
  buffer_load_dwordx4 a[144:147], v2, s[40:43], s64 offen offset:0 sc1
  v_mfma_f32_16x16x32_bf16 a[68:71], a[16:19], a[148:151], a[68:71]
  s_add_u32 s65, s64, 131072
  ds_read_b128 v[168:171], v200 offset:2048
  v_mfma_f32_16x16x32_bf16 a[84:87], a[20:23], a[148:151], a[84:87]
  s_add_u32 s66, s64, 262144
  ds_read_b128 v[172:175], v200 offset:3072
  v_mfma_f32_16x16x32_bf16 a[100:103], a[24:27], a[148:151], a[100:103]
  v_mfma_f32_16x16x32_bf16 a[116:119], a[28:31], a[148:151], a[116:119]
  ds_read_b128 v[232:235], v200 offset:4096
  v_mfma_f32_16x16x32_bf16 a[132:135], a[32:35], a[148:151], a[132:135]
  s_waitcnt vmcnt(17)
  buffer_load_dwordx4 a[148:151], v2, s[40:43], s65 offen offset:0 sc1
  v_mfma_f32_16x16x32_bf16 a[72:75], a[16:19], a[152:155], a[72:75]
  s_add_u32 s67, s64, 393216
  ds_read_b128 v[236:239], v201 offset:0
  v_mfma_f32_16x16x32_bf16 a[88:91], a[20:23], a[152:155], a[88:91]
  v_mfma_f32_16x16x32_bf16 a[104:107], a[24:27], a[152:155], a[104:107]
  v_mfma_f32_16x16x32_bf16 a[120:123], a[28:31], a[152:155], a[120:123]
  v_mfma_f32_16x16x32_bf16 a[136:139], a[32:35], a[152:155], a[136:139]
  buffer_load_dwordx4 a[152:155], v2, s[40:43], s66 offen offset:0 sc1
  v_mfma_f32_16x16x32_bf16 a[76:79], a[16:19], a[156:159], a[76:79]
  v_mfma_f32_16x16x32_bf16 a[92:95], a[20:23], a[156:159], a[92:95]
  v_mfma_f32_16x16x32_bf16 a[108:111], a[24:27], a[156:159], a[108:111]
  v_mfma_f32_16x16x32_bf16 a[124:127], a[28:31], a[156:159], a[124:127]
  v_mfma_f32_16x16x32_bf16 a[140:143], a[32:35], a[156:159], a[140:143]
  s_waitcnt vmcnt(8)
  buffer_load_dwordx4 a[156:159], v2, s[40:43], s67 offen offset:0 sc1
  v_mfma_f32_16x16x32_bf16 a[64:67], a[36:39], a[160:163], a[64:67]
  ds_read_b128 v[120:123], v203 offset:0
  v_mfma_f32_16x16x32_bf16 a[80:83], a[40:43], a[160:163], a[80:83]
  buffer_store_dword v4, off, s[40:43], s30 sc1
  v_mfma_f32_16x16x32_bf16 a[96:99], a[44:47], a[160:163], a[96:99]
  v_mfma_f32_16x16x32_bf16 a[112:115], v[128:131], a[160:163], a[112:115]
  ds_read_b128 v[124:127], v203 offset:16
  v_mfma_f32_16x16x32_bf16 a[128:131], v[132:135], a[160:163], a[128:131]
  buffer_load_dwordx4 a[160:163], v2, s[40:43], s64 offen offset:1024 sc1
  v_mfma_f32_16x16x32_bf16 a[68:71], a[36:39], a[164:167], a[68:71]
  ds_read_b128 v[192:195], v204 offset:0
  v_mfma_f32_16x16x32_bf16 a[84:87], a[40:43], a[164:167], a[84:87]
  ds_read_b128 v[196:199], v204 offset:16
  v_mfma_f32_16x16x32_bf16 a[100:103], a[44:47], a[164:167], a[100:103]
  v_mfma_f32_16x16x32_bf16 a[116:119], v[128:131], a[164:167], a[116:119]
  ds_read_b128 v[208:211], v205 offset:0
  v_mfma_f32_16x16x32_bf16 a[132:135], v[132:135], a[164:167], a[132:135]
  s_waitcnt vmcnt(16)
  buffer_load_dwordx4 a[164:167], v2, s[40:43], s65 offen offset:1024 sc1
  v_mfma_f32_16x16x32_bf16 a[72:75], a[36:39], a[168:171], a[72:75]
  ds_read_b128 v[212:215], v205 offset:16
  v_mfma_f32_16x16x32_bf16 a[88:91], a[40:43], a[168:171], a[88:91]
  v_mfma_f32_16x16x32_bf16 a[104:107], a[44:47], a[168:171], a[104:107]
  v_mfma_f32_16x16x32_bf16 a[120:123], v[128:131], a[168:171], a[120:123]
  v_mfma_f32_16x16x32_bf16 a[136:139], v[132:135], a[168:171], a[136:139]
  buffer_load_dwordx4 a[168:171], v2, s[40:43], s66 offen offset:1024 sc1
  v_mfma_f32_16x16x32_bf16 a[76:79], a[36:39], a[172:175], a[76:79]
  v_mfma_f32_16x16x32_bf16 a[92:95], a[40:43], a[172:175], a[92:95]
  v_mfma_f32_16x16x32_bf16 a[108:111], a[44:47], a[172:175], a[108:111]
  v_mfma_f32_16x16x32_bf16 a[124:127], v[128:131], a[172:175], a[124:127]
  v_mfma_f32_16x16x32_bf16 a[140:143], v[132:135], a[172:175], a[140:143]
  s_waitcnt vmcnt(16) lgkmcnt(0)
  buffer_load_dwordx4 a[172:175], v2, s[40:43], s67 offen offset:1024 sc1
  v_mfma_f32_16x16x32_bf16 a[64:67], v[136:139], a[176:179], a[64:67]
  v_mfma_f32_16x16x32_bf16 a[80:83], v[140:143], a[176:179], a[80:83]
  v_lshlrev_b32 v18, 16, v172
  v_and_b32 v19, 0xffff0000, v172
  v_mfma_f32_16x16x32_bf16 a[96:99], v[144:147], a[176:179], a[96:99]
  v_add_f32 v120, v120, v18
  v_add_f32 v121, v121, v19
  v_mfma_f32_16x16x32_bf16 a[112:115], v[148:151], a[176:179], a[112:115]
  v_cvt_pk_bf16_f32 v18, v120, v121
  v_lshlrev_b32 v96, 16, v160
  v_mfma_f32_16x16x32_bf16 a[128:131], v[152:155], a[176:179], a[128:131]
  buffer_load_dwordx4 a[176:179], v2, s[40:43], s64 offen offset:2048 sc1
  v_and_b32 v97, 0xffff0000, v160
  v_lshlrev_b32 v120, 16, v18
  v_mfma_f32_16x16x32_bf16 a[68:71], v[136:139], a[180:183], a[68:71]
  v_and_b32 v121, 0xffff0000, v18
  v_lshlrev_b32 v18, 16, v173
  v_mfma_f32_16x16x32_bf16 a[84:87], v[140:143], a[180:183], a[84:87]
  v_and_b32 v19, 0xffff0000, v173
  v_add_f32 v122, v122, v18
  v_mfma_f32_16x16x32_bf16 a[100:103], v[144:147], a[180:183], a[100:103]
  v_add_f32 v123, v123, v19
  v_cvt_pk_bf16_f32 v18, v122, v123
  v_mfma_f32_16x16x32_bf16 a[116:119], v[148:151], a[180:183], a[116:119]
  v_lshlrev_b32 v98, 16, v161
  v_and_b32 v99, 0xffff0000, v161
  v_mfma_f32_16x16x32_bf16 a[132:135], v[152:155], a[180:183], a[132:135]
  s_waitcnt vmcnt(14)
  buffer_load_dwordx4 a[180:183], v2, s[40:43], s65 offen offset:2048 sc1
  v_lshlrev_b32 v122, 16, v18
  v_and_b32 v123, 0xffff0000, v18
  v_mfma_f32_16x16x32_bf16 a[72:75], v[136:139], a[184:187], a[72:75]
  v_lshlrev_b32 v18, 16, v174
  v_and_b32 v19, 0xffff0000, v174
  v_mfma_f32_16x16x32_bf16 a[88:91], v[140:143], a[184:187], a[88:91]
  v_add_f32 v124, v124, v18
  v_add_f32 v125, v125, v19
  v_mfma_f32_16x16x32_bf16 a[104:107], v[144:147], a[184:187], a[104:107]
  v_cvt_pk_bf16_f32 v18, v124, v125
  v_lshlrev_b32 v100, 16, v162
  v_mfma_f32_16x16x32_bf16 a[120:123], v[148:151], a[184:187], a[120:123]
  v_and_b32 v101, 0xffff0000, v162
  v_lshlrev_b32 v124, 16, v18
  v_mfma_f32_16x16x32_bf16 a[136:139], v[152:155], a[184:187], a[136:139]
  buffer_load_dwordx4 a[184:187], v2, s[40:43], s66 offen offset:2048 sc1
  v_and_b32 v125, 0xffff0000, v18
  v_lshlrev_b32 v18, 16, v175
  v_mfma_f32_16x16x32_bf16 a[76:79], v[136:139], a[188:191], a[76:79]
  v_and_b32 v19, 0xffff0000, v175
  v_add_f32 v126, v126, v18
  v_mfma_f32_16x16x32_bf16 a[92:95], v[140:143], a[188:191], a[92:95]
  v_add_f32 v127, v127, v19
  v_cvt_pk_bf16_f32 v18, v126, v127
  v_mfma_f32_16x16x32_bf16 a[108:111], v[144:147], a[188:191], a[108:111]
  v_lshlrev_b32 v102, 16, v163
  v_and_b32 v103, 0xffff0000, v163
  v_mfma_f32_16x16x32_bf16 a[124:127], v[148:151], a[188:191], a[124:127]
  v_lshlrev_b32 v126, 16, v18
  v_and_b32 v127, 0xffff0000, v18
  v_mfma_f32_16x16x32_bf16 a[140:143], v[152:155], a[188:191], a[140:143]
  s_waitcnt vmcnt(14)
  buffer_load_dwordx4 a[188:191], v2, s[40:43], s67 offen offset:2048 sc1
  v_mfma_f32_16x16x32_bf16 a[64:67], v[156:159], v[216:219], a[64:67]
  v_mfma_f32_16x16x32_bf16 a[80:83], a[48:51], v[216:219], a[80:83]
  v_lshlrev_b32 v18, 16, v232
  v_and_b32 v19, 0xffff0000, v232
  v_mfma_f32_16x16x32_bf16 a[96:99], a[52:55], v[216:219], a[96:99]
  v_add_f32 v192, v192, v18
  v_add_f32 v193, v193, v19
  v_mfma_f32_16x16x32_bf16 a[112:115], a[56:59], v[216:219], a[112:115]
  v_cvt_pk_bf16_f32 v18, v192, v193
  v_lshlrev_b32 v104, 16, v164
  v_mfma_f32_16x16x32_bf16 a[128:131], a[60:63], v[216:219], a[128:131]
  buffer_load_dwordx4 v[216:219], v2, s[40:43], s64 offen offset:3072 sc1
  v_and_b32 v105, 0xffff0000, v164
  v_lshlrev_b32 v192, 16, v18
  v_mfma_f32_16x16x32_bf16 a[68:71], v[156:159], v[220:223], a[68:71]
  v_and_b32 v193, 0xffff0000, v18
  v_lshlrev_b32 v18, 16, v233
  v_mfma_f32_16x16x32_bf16 a[84:87], a[48:51], v[220:223], a[84:87]
  v_and_b32 v19, 0xffff0000, v233
  v_add_f32 v194, v194, v18
  v_mfma_f32_16x16x32_bf16 a[100:103], a[52:55], v[220:223], a[100:103]
  v_add_f32 v195, v195, v19
  v_cvt_pk_bf16_f32 v18, v194, v195
  v_mfma_f32_16x16x32_bf16 a[116:119], a[56:59], v[220:223], a[116:119]
  v_lshlrev_b32 v106, 16, v165
  v_and_b32 v107, 0xffff0000, v165
  v_mfma_f32_16x16x32_bf16 a[132:135], a[60:63], v[220:223], a[132:135]
  s_waitcnt vmcnt(14)
  buffer_load_dwordx4 v[220:223], v2, s[40:43], s65 offen offset:3072 sc1
  v_lshlrev_b32 v194, 16, v18
  v_and_b32 v195, 0xffff0000, v18
  v_mfma_f32_16x16x32_bf16 a[72:75], v[156:159], v[224:227], a[72:75]
  v_lshlrev_b32 v18, 16, v234
  v_and_b32 v19, 0xffff0000, v234
  v_mfma_f32_16x16x32_bf16 a[88:91], a[48:51], v[224:227], a[88:91]
  v_add_f32 v196, v196, v18
  v_add_f32 v197, v197, v19
  v_mfma_f32_16x16x32_bf16 a[104:107], a[52:55], v[224:227], a[104:107]
  v_cvt_pk_bf16_f32 v18, v196, v197
  v_lshlrev_b32 v108, 16, v166
  v_mfma_f32_16x16x32_bf16 a[120:123], a[56:59], v[224:227], a[120:123]
  v_and_b32 v109, 0xffff0000, v166
  v_lshlrev_b32 v196, 16, v18
  v_mfma_f32_16x16x32_bf16 a[136:139], a[60:63], v[224:227], a[136:139]
  buffer_load_dwordx4 v[224:227], v2, s[40:43], s66 offen offset:3072 sc1
  v_and_b32 v197, 0xffff0000, v18
  v_lshlrev_b32 v18, 16, v235
  v_mfma_f32_16x16x32_bf16 a[76:79], v[156:159], v[228:231], a[76:79]
  v_and_b32 v19, 0xffff0000, v235
  v_add_f32 v198, v198, v18
  v_mfma_f32_16x16x32_bf16 a[92:95], a[48:51], v[228:231], a[92:95]
  v_add_f32 v199, v199, v19
  v_cvt_pk_bf16_f32 v18, v198, v199
  v_mfma_f32_16x16x32_bf16 a[108:111], a[52:55], v[228:231], a[108:111]
  v_lshlrev_b32 v110, 16, v167
  v_and_b32 v111, 0xffff0000, v167
  v_mfma_f32_16x16x32_bf16 a[124:127], a[56:59], v[228:231], a[124:127]
  v_lshlrev_b32 v198, 16, v18
  v_and_b32 v199, 0xffff0000, v18
  v_mfma_f32_16x16x32_bf16 a[140:143], a[60:63], v[228:231], a[140:143]
  s_waitcnt vmcnt(14)
  buffer_load_dwordx4 v[228:231], v2, s[40:43], s67 offen offset:3072 sc1
  v_mfma_f32_16x16x32_bf16 a[64:67], a[192:195], a[144:147], a[64:67]
  buffer_load_dword v13, v8, s[40:43], 0 offen sc1
  v_mfma_f32_16x16x32_bf16 a[80:83], a[196:199], a[144:147], a[80:83]
  v_lshlrev_b32 v18, 16, v236
  v_and_b32 v19, 0xffff0000, v236
  v_mfma_f32_16x16x32_bf16 a[96:99], a[200:203], a[144:147], a[96:99]
  v_add_f32 v208, v208, v18
  v_add_f32 v209, v209, v19
  v_mfma_f32_16x16x32_bf16 a[112:115], a[204:207], a[144:147], a[112:115]
  v_cvt_pk_bf16_f32 v18, v208, v209
  v_lshlrev_b32 v112, 16, v168
  v_mfma_f32_16x16x32_bf16 a[128:131], v[176:179], a[144:147], a[128:131]
  v_and_b32 v113, 0xffff0000, v168
  v_lshlrev_b32 v208, 16, v18
  v_mfma_f32_16x16x32_bf16 a[68:71], a[192:195], a[148:151], a[68:71]
  v_and_b32 v209, 0xffff0000, v18
  v_lshlrev_b32 v18, 16, v237
  v_mfma_f32_16x16x32_bf16 a[84:87], a[196:199], a[148:151], a[84:87]
  v_and_b32 v19, 0xffff0000, v237
  v_add_f32 v210, v210, v18
  v_mfma_f32_16x16x32_bf16 a[100:103], a[200:203], a[148:151], a[100:103]
  v_add_f32 v211, v211, v19
  v_cvt_pk_bf16_f32 v18, v210, v211
  v_mfma_f32_16x16x32_bf16 a[116:119], a[204:207], a[148:151], a[116:119]
  v_lshlrev_b32 v114, 16, v169
  v_and_b32 v115, 0xffff0000, v169
  v_mfma_f32_16x16x32_bf16 a[132:135], v[176:179], a[148:151], a[132:135]
  s_waitcnt vmcnt(14)
  v_lshlrev_b32 v210, 16, v18
  v_and_b32 v211, 0xffff0000, v18
  v_mfma_f32_16x16x32_bf16 a[72:75], a[192:195], a[152:155], a[72:75]
  v_lshlrev_b32 v18, 16, v238
  v_and_b32 v19, 0xffff0000, v238
  v_mfma_f32_16x16x32_bf16 a[88:91], a[196:199], a[152:155], a[88:91]
  v_add_f32 v212, v212, v18
  v_add_f32 v213, v213, v19
  v_mfma_f32_16x16x32_bf16 a[104:107], a[200:203], a[152:155], a[104:107]
  v_cvt_pk_bf16_f32 v18, v212, v213
  v_lshlrev_b32 v116, 16, v170
  v_mfma_f32_16x16x32_bf16 a[120:123], a[204:207], a[152:155], a[120:123]
  v_and_b32 v117, 0xffff0000, v170
  v_lshlrev_b32 v212, 16, v18
  v_mfma_f32_16x16x32_bf16 a[136:139], v[176:179], a[152:155], a[136:139]
  v_and_b32 v213, 0xffff0000, v18
  v_lshlrev_b32 v18, 16, v239
  v_mfma_f32_16x16x32_bf16 a[76:79], a[192:195], a[156:159], a[76:79]
  v_and_b32 v19, 0xffff0000, v239
  v_add_f32 v214, v214, v18
  v_mfma_f32_16x16x32_bf16 a[92:95], a[196:199], a[156:159], a[92:95]
  v_add_f32 v215, v215, v19
  v_cvt_pk_bf16_f32 v18, v214, v215
  v_mfma_f32_16x16x32_bf16 a[108:111], a[200:203], a[156:159], a[108:111]
  v_lshlrev_b32 v118, 16, v171
  v_and_b32 v119, 0xffff0000, v171
  v_mfma_f32_16x16x32_bf16 a[124:127], a[204:207], a[156:159], a[124:127]
  v_lshlrev_b32 v214, 16, v18
  v_and_b32 v215, 0xffff0000, v18
  v_mfma_f32_16x16x32_bf16 a[140:143], v[176:179], a[156:159], a[140:143]
  s_waitcnt vmcnt(11)
  v_mfma_f32_16x16x32_bf16 a[64:67], v[180:183], a[160:163], a[64:67]
  v_mfma_f32_16x16x32_bf16 a[80:83], v[184:187], a[160:163], a[80:83]
  v_mfma_f32_16x16x32_bf16 a[96:99], v[188:191], a[160:163], a[96:99]
  v_mfma_f32_16x16x32_bf16 a[112:115], a[208:211], a[160:163], a[112:115]
  v_mfma_f32_16x16x32_bf16 a[128:131], a[212:215], a[160:163], a[128:131]
  v_mfma_f32_16x16x32_bf16 a[68:71], v[180:183], a[164:167], a[68:71]
  v_mfma_f32_16x16x32_bf16 a[84:87], v[184:187], a[164:167], a[84:87]
  v_mfma_f32_16x16x32_bf16 a[100:103], v[188:191], a[164:167], a[100:103]
  v_mfma_f32_16x16x32_bf16 a[116:119], a[208:211], a[164:167], a[116:119]
  v_mfma_f32_16x16x32_bf16 a[132:135], a[212:215], a[164:167], a[132:135]
  s_waitcnt vmcnt(9)
  v_mfma_f32_16x16x32_bf16 a[72:75], v[180:183], a[168:171], a[72:75]
  v_mfma_f32_16x16x32_bf16 a[88:91], v[184:187], a[168:171], a[88:91]
  v_mfma_f32_16x16x32_bf16 a[104:107], v[188:191], a[168:171], a[104:107]
  v_mfma_f32_16x16x32_bf16 a[120:123], a[208:211], a[168:171], a[120:123]
  v_mfma_f32_16x16x32_bf16 a[136:139], a[212:215], a[168:171], a[136:139]
  v_mfma_f32_16x16x32_bf16 a[76:79], v[180:183], a[172:175], a[76:79]
  v_mfma_f32_16x16x32_bf16 a[92:95], v[184:187], a[172:175], a[92:95]
  v_mfma_f32_16x16x32_bf16 a[108:111], v[188:191], a[172:175], a[108:111]
  v_mfma_f32_16x16x32_bf16 a[124:127], a[208:211], a[172:175], a[124:127]
  v_mfma_f32_16x16x32_bf16 a[140:143], a[212:215], a[172:175], a[140:143]
  s_waitcnt vmcnt(0)
  v_mfma_f32_16x16x32_bf16 a[64:67], a[216:219], a[176:179], a[64:67]
  v_cmp_eq_u32 vcc, 0, v13
  v_mfma_f32_16x16x32_bf16 a[80:83], a[220:223], a[176:179], a[80:83]
  v_mfma_f32_16x16x32_bf16 a[96:99], a[224:227], a[176:179], a[96:99]
  s_cbranch_vccnz fa_px_spin
fa_px_ok:
  v_mfma_f32_16x16x32_bf16 a[112:115], a[228:231], a[176:179], a[112:115]
  s_add_u32 s14, s29, 0
  buffer_load_dwordx4 v[240:243], v9, s[40:43], s14 offen sc1
  v_mfma_f32_16x16x32_bf16 a[128:131], a[232:235], a[176:179], a[128:131]
  v_mfma_f32_16x16x32_bf16 a[68:71], a[216:219], a[180:183], a[68:71]
  s_add_u32 s14, s29, 4096
  buffer_load_dwordx4 v[244:247], v9, s[40:43], s14 offen sc1
  v_mfma_f32_16x16x32_bf16 a[84:87], a[220:223], a[180:183], a[84:87]
  v_mfma_f32_16x16x32_bf16 a[100:103], a[224:227], a[180:183], a[100:103]
  s_add_u32 s14, s29, 8192
  buffer_load_dwordx4 v[176:179], v9, s[40:43], s14 offen sc1
  v_mfma_f32_16x16x32_bf16 a[116:119], a[228:231], a[180:183], a[116:119]
  v_mfma_f32_16x16x32_bf16 a[132:135], a[232:235], a[180:183], a[132:135]
  s_waitcnt vmcnt(8)
  s_add_u32 s14, s29, 12288
  buffer_load_dwordx4 v[180:183], v9, s[40:43], s14 offen sc1
  v_mfma_f32_16x16x32_bf16 a[72:75], a[216:219], a[184:187], a[72:75]
  v_mfma_f32_16x16x32_bf16 a[88:91], a[220:223], a[184:187], a[88:91]
  s_add_u32 s14, s29, 16384
  buffer_load_dwordx4 v[184:187], v6, s[40:43], s14 offen sc1
  v_mfma_f32_16x16x32_bf16 a[104:107], a[224:227], a[184:187], a[104:107]
  v_mfma_f32_16x16x32_bf16 a[120:123], a[228:231], a[184:187], a[120:123]
  s_add_u32 s14, s29, 20480
  buffer_load_dwordx4 v[188:191], v6, s[40:43], s14 offen sc1
  v_mfma_f32_16x16x32_bf16 a[136:139], a[232:235], a[184:187], a[136:139]
  v_mfma_f32_16x16x32_bf16 a[76:79], a[216:219], a[188:191], a[76:79]
  v_mfma_f32_16x16x32_bf16 a[92:95], a[220:223], a[188:191], a[92:95]
  v_mfma_f32_16x16x32_bf16 a[108:111], a[224:227], a[188:191], a[108:111]
  v_mfma_f32_16x16x32_bf16 a[124:127], a[228:231], a[188:191], a[124:127]
  v_mfma_f32_16x16x32_bf16 a[140:143], a[232:235], a[188:191], a[140:143]
  s_waitcnt vmcnt(9)
  v_mfma_f32_16x16x32_bf16 a[64:67], a[236:239], v[216:219], a[64:67]
  v_mfma_f32_16x16x32_bf16 a[80:83], a[240:243], v[216:219], a[80:83]
  v_mfma_f32_16x16x32_bf16 a[96:99], a[244:247], v[216:219], a[96:99]
  v_mfma_f32_16x16x32_bf16 a[112:115], a[248:251], v[216:219], a[112:115]
  v_mfma_f32_16x16x32_bf16 a[128:131], a[252:255], v[216:219], a[128:131]
  v_mfma_f32_16x16x32_bf16 a[68:71], a[236:239], v[220:223], a[68:71]
  v_mfma_f32_16x16x32_bf16 a[84:87], a[240:243], v[220:223], a[84:87]
  v_mfma_f32_16x16x32_bf16 a[100:103], a[244:247], v[220:223], a[100:103]
  v_mfma_f32_16x16x32_bf16 a[116:119], a[248:251], v[220:223], a[116:119]
  v_mfma_f32_16x16x32_bf16 a[132:135], a[252:255], v[220:223], a[132:135]
  s_waitcnt vmcnt(7)
  ds_write_b128 v16, a[64:67] offset:0
  v_mfma_f32_16x16x32_bf16 a[72:75], a[236:239], v[224:227], a[72:75]
  ds_write_b128 v16, a[80:83] offset:64
  v_mfma_f32_16x16x32_bf16 a[88:91], a[240:243], v[224:227], a[88:91]
  ds_write_b128 v16, a[96:99] offset:128
  v_mfma_f32_16x16x32_bf16 a[104:107], a[244:247], v[224:227], a[104:107]
  ds_write_b128 v16, a[112:115] offset:192
  v_mfma_f32_16x16x32_bf16 a[120:123], a[248:251], v[224:227], a[120:123]
  ds_write_b128 v16, a[128:131] offset:256
  v_mfma_f32_16x16x32_bf16 a[136:139], a[252:255], v[224:227], a[136:139]
  ds_write_b128 v16, a[68:71] offset:5376
  v_mfma_f32_16x16x32_bf16 a[76:79], a[236:239], v[228:231], a[76:79]
  ds_write_b128 v16, a[84:87] offset:5440
  v_mfma_f32_16x16x32_bf16 a[92:95], a[240:243], v[228:231], a[92:95]
  ds_write_b128 v16, a[100:103] offset:5504
  v_mfma_f32_16x16x32_bf16 a[108:111], a[244:247], v[228:231], a[108:111]
  ds_write_b128 v16, a[116:119] offset:5568
  v_mfma_f32_16x16x32_bf16 a[124:127], a[248:251], v[228:231], a[124:127]
  ds_write_b128 v16, a[132:135] offset:5632
  v_mfma_f32_16x16x32_bf16 a[140:143], a[252:255], v[228:231], a[140:143]
  ds_write_b128 v16, a[72:75] offset:10752
  ds_write_b128 v16, a[88:91] offset:10816
  ds_write_b128 v16, a[104:107] offset:10880
  ds_write_b128 v16, a[120:123] offset:10944
  ds_write_b128 v16, a[136:139] offset:11008
  ds_write_b128 v16, a[76:79] offset:16128
  ds_write_b128 v16, a[92:95] offset:16192
  ds_write_b128 v16, a[108:111] offset:16256
  ds_write_b128 v16, a[124:127] offset:16320
  ds_write_b128 v16, a[140:143] offset:16384
  s_waitcnt vmcnt(0) lgkmcnt(0)
  s_barrier
  ds_read_b128 v[32:35], v251 offset:0
  ds_read_b128 v[36:39], v251 offset:16
  ds_read_b128 v[40:43], v251 offset:21504
  ds_read_b128 v[44:47], v251 offset:21520
  ds_read_b128 v[48:51], v251 offset:43008
  ds_read_b128 v[52:55], v251 offset:43024
  ds_read_b128 v[56:59], v251 offset:64512
  ds_read_b128 v[60:63], v251 offset:64528
  ds_read_b128 v[64:67], v252 offset:0
  ds_read_b128 v[68:71], v252 offset:16
  ds_read_b128 v[72:75], v252 offset:21504
  ds_read_b128 v[76:79], v252 offset:21520
  ds_read_b128 v[80:83], v252 offset:43008
  ds_read_b128 v[84:87], v252 offset:43024
  ds_read_b128 v[88:91], v252 offset:64512
  ds_read_b128 v[92:95], v252 offset:64528
  ds_read_b128 v[128:131], v253 offset:0
  ds_read_b128 v[132:135], v253 offset:16
  ds_read_b128 v[136:139], v253 offset:21504
  ds_read_b128 v[140:143], v253 offset:21520
  ds_read_b128 v[144:147], v253 offset:43008
  ds_read_b128 v[148:151], v253 offset:43024
  ds_read_b128 v[152:155], v253 offset:64512
  ds_read_b128 v[156:159], v253 offset:64528
  s_waitcnt lgkmcnt(15)
  v_pk_add_f32 v[32:33], v[32:33], v[40:41]
  v_pk_add_f32 v[48:49], v[48:49], v[56:57]
  v_pk_add_f32 v[34:35], v[34:35], v[42:43]
  v_pk_add_f32 v[50:51], v[50:51], v[58:59]
  v_pk_add_f32 v[36:37], v[36:37], v[44:45]
  v_pk_add_f32 v[52:53], v[52:53], v[60:61]
  v_pk_add_f32 v[38:39], v[38:39], v[46:47]
  v_pk_add_f32 v[54:55], v[54:55], v[62:63]
  v_pk_add_f32 v[32:33], v[32:33], v[48:49]
  v_pk_add_f32 v[34:35], v[34:35], v[50:51]
  v_pk_add_f32 v[36:37], v[36:37], v[52:53]
  v_pk_add_f32 v[38:39], v[38:39], v[54:55]
  v_pk_add_f32 v[32:33], v[32:33], v[240:241]
  v_pk_add_f32 v[34:35], v[34:35], v[242:243]
  v_pk_add_f32 v[36:37], v[36:37], v[244:245]
  v_pk_add_f32 v[38:39], v[38:39], v[246:247]
  v_cvt_pk_bf16_f32 v40, v32, v33
  v_cvt_pk_bf16_f32 v41, v34, v35
  v_cvt_pk_bf16_f32 v42, v36, v37
  v_cvt_pk_bf16_f32 v43, v38, v39
  v_lshlrev_b32 v32, 16, v40
  v_and_b32 v33, 0xffff0000, v40
  v_lshlrev_b32 v34, 16, v41
  v_and_b32 v35, 0xffff0000, v41
  v_lshlrev_b32 v36, 16, v42
  v_and_b32 v37, 0xffff0000, v42
  v_lshlrev_b32 v38, 16, v43
  v_and_b32 v39, 0xffff0000, v43
  v_pk_add_f32 v[32:33], v[32:33], v[96:97]
  v_pk_add_f32 v[34:35], v[34:35], v[98:99]
  v_pk_add_f32 v[36:37], v[36:37], v[100:101]
  v_pk_add_f32 v[38:39], v[38:39], v[102:103]
  v_cvt_pk_bf16_f32 v40, v32, v33
  v_cvt_pk_bf16_f32 v41, v34, v35
  v_cvt_pk_bf16_f32 v42, v36, v37
  v_cvt_pk_bf16_f32 v43, v38, v39
  v_lshlrev_b32 v32, 16, v40
  v_and_b32 v33, 0xffff0000, v40
  v_lshlrev_b32 v34, 16, v41
  v_and_b32 v35, 0xffff0000, v41
  v_lshlrev_b32 v36, 16, v42
  v_and_b32 v37, 0xffff0000, v42
  v_lshlrev_b32 v38, 16, v43
  v_and_b32 v39, 0xffff0000, v43
  v_pk_add_f32 v[32:33], v[32:33], v[120:121]
  v_pk_add_f32 v[34:35], v[34:35], v[122:123]
  v_pk_add_f32 v[36:37], v[36:37], v[124:125]
  v_pk_add_f32 v[38:39], v[38:39], v[126:127]
  v_cvt_pk_bf16_f32 v44, v32, v33
  v_cvt_pk_bf16_f32 v45, v34, v35
  v_cvt_pk_bf16_f32 v46, v36, v37
  v_cvt_pk_bf16_f32 v47, v38, v39
  buffer_store_dwordx4 v[44:47], v248, s[48:51], 0 offen
  s_waitcnt lgkmcnt(8)
  v_pk_add_f32 v[64:65], v[64:65], v[72:73]
  v_pk_add_f32 v[80:81], v[80:81], v[88:89]
  v_pk_add_f32 v[66:67], v[66:67], v[74:75]
  v_pk_add_f32 v[82:83], v[82:83], v[90:91]
  v_pk_add_f32 v[68:69], v[68:69], v[76:77]
  v_pk_add_f32 v[84:85], v[84:85], v[92:93]
  v_pk_add_f32 v[70:71], v[70:71], v[78:79]
  v_pk_add_f32 v[86:87], v[86:87], v[94:95]
  v_pk_add_f32 v[64:65], v[64:65], v[80:81]
  v_pk_add_f32 v[66:67], v[66:67], v[82:83]
  v_pk_add_f32 v[68:69], v[68:69], v[84:85]
  v_pk_add_f32 v[70:71], v[70:71], v[86:87]
  v_pk_add_f32 v[64:65], v[64:65], v[176:177]
  v_pk_add_f32 v[66:67], v[66:67], v[178:179]
  v_pk_add_f32 v[68:69], v[68:69], v[180:181]
  v_pk_add_f32 v[70:71], v[70:71], v[182:183]
  v_cvt_pk_bf16_f32 v72, v64, v65
  v_cvt_pk_bf16_f32 v73, v66, v67
  v_cvt_pk_bf16_f32 v74, v68, v69
  v_cvt_pk_bf16_f32 v75, v70, v71
  v_lshlrev_b32 v64, 16, v72
  v_and_b32 v65, 0xffff0000, v72
  v_lshlrev_b32 v66, 16, v73
  v_and_b32 v67, 0xffff0000, v73
  v_lshlrev_b32 v68, 16, v74
  v_and_b32 v69, 0xffff0000, v74
  v_lshlrev_b32 v70, 16, v75
  v_and_b32 v71, 0xffff0000, v75
  v_pk_add_f32 v[64:65], v[64:65], v[104:105]
  v_pk_add_f32 v[66:67], v[66:67], v[106:107]
  v_pk_add_f32 v[68:69], v[68:69], v[108:109]
  v_pk_add_f32 v[70:71], v[70:71], v[110:111]
  v_cvt_pk_bf16_f32 v72, v64, v65
  v_cvt_pk_bf16_f32 v73, v66, v67
  v_cvt_pk_bf16_f32 v74, v68, v69
  v_cvt_pk_bf16_f32 v75, v70, v71
  v_lshlrev_b32 v64, 16, v72
  v_and_b32 v65, 0xffff0000, v72
  v_lshlrev_b32 v66, 16, v73
  v_and_b32 v67, 0xffff0000, v73
  v_lshlrev_b32 v68, 16, v74
  v_and_b32 v69, 0xffff0000, v74
  v_lshlrev_b32 v70, 16, v75
  v_and_b32 v71, 0xffff0000, v75
  v_pk_add_f32 v[64:65], v[64:65], v[192:193]
  v_pk_add_f32 v[66:67], v[66:67], v[194:195]
  v_pk_add_f32 v[68:69], v[68:69], v[196:197]
  v_pk_add_f32 v[70:71], v[70:71], v[198:199]
  v_cvt_pk_bf16_f32 v76, v64, v65
  v_cvt_pk_bf16_f32 v77, v66, v67
  v_cvt_pk_bf16_f32 v78, v68, v69
  v_cvt_pk_bf16_f32 v79, v70, v71
  buffer_store_dwordx4 v[76:79], v249, s[48:51], 0 offen
  s_waitcnt lgkmcnt(0)
  v_pk_add_f32 v[128:129], v[128:129], v[136:137]
  v_pk_add_f32 v[144:145], v[144:145], v[152:153]
  v_pk_add_f32 v[130:131], v[130:131], v[138:139]
  v_pk_add_f32 v[146:147], v[146:147], v[154:155]
  v_pk_add_f32 v[132:133], v[132:133], v[140:141]
  v_pk_add_f32 v[148:149], v[148:149], v[156:157]
  v_pk_add_f32 v[134:135], v[134:135], v[142:143]
  v_pk_add_f32 v[150:151], v[150:151], v[158:159]
  v_pk_add_f32 v[128:129], v[128:129], v[144:145]
  v_pk_add_f32 v[130:131], v[130:131], v[146:147]
  v_pk_add_f32 v[132:133], v[132:133], v[148:149]
  v_pk_add_f32 v[134:135], v[134:135], v[150:151]
  v_pk_add_f32 v[128:129], v[128:129], v[184:185]
  v_pk_add_f32 v[130:131], v[130:131], v[186:187]
  v_pk_add_f32 v[132:133], v[132:133], v[188:189]
  v_pk_add_f32 v[134:135], v[134:135], v[190:191]
  v_cvt_pk_bf16_f32 v136, v128, v129
  v_cvt_pk_bf16_f32 v137, v130, v131
  v_cvt_pk_bf16_f32 v138, v132, v133
  v_cvt_pk_bf16_f32 v139, v134, v135
  v_lshlrev_b32 v128, 16, v136
  v_and_b32 v129, 0xffff0000, v136
  v_lshlrev_b32 v130, 16, v137
  v_and_b32 v131, 0xffff0000, v137
  v_lshlrev_b32 v132, 16, v138
  v_and_b32 v133, 0xffff0000, v138
  v_lshlrev_b32 v134, 16, v139
  v_and_b32 v135, 0xffff0000, v139
  v_pk_add_f32 v[128:129], v[128:129], v[112:113]
  v_pk_add_f32 v[130:131], v[130:131], v[114:115]
  v_pk_add_f32 v[132:133], v[132:133], v[116:117]
  v_pk_add_f32 v[134:135], v[134:135], v[118:119]
  v_cvt_pk_bf16_f32 v136, v128, v129
  v_cvt_pk_bf16_f32 v137, v130, v131
  v_cvt_pk_bf16_f32 v138, v132, v133
  v_cvt_pk_bf16_f32 v139, v134, v135
  v_lshlrev_b32 v128, 16, v136
  v_and_b32 v129, 0xffff0000, v136
  v_lshlrev_b32 v130, 16, v137
  v_and_b32 v131, 0xffff0000, v137
  v_lshlrev_b32 v132, 16, v138
  v_and_b32 v133, 0xffff0000, v138
  v_lshlrev_b32 v134, 16, v139
  v_and_b32 v135, 0xffff0000, v139
  v_pk_add_f32 v[128:129], v[128:129], v[208:209]
  v_pk_add_f32 v[130:131], v[130:131], v[210:211]
  v_pk_add_f32 v[132:133], v[132:133], v[212:213]
  v_pk_add_f32 v[134:135], v[134:135], v[214:215]
  v_cvt_pk_bf16_f32 v140, v128, v129
  v_cvt_pk_bf16_f32 v141, v130, v131
  v_cvt_pk_bf16_f32 v142, v132, v133
  v_cvt_pk_bf16_f32 v143, v134, v135
  buffer_store_dwordx4 v[140:143], v250, s[48:51], 0 offen
fa_end:
  s_endpgm
fa_hk0:
  s_getpc_b64 s[10:11]
fa_hp0:
  s_add_u32 s8, s8, 4
  s_addc_u32 s9, s9, 0
  s_sub_u32 s10, s10, fa_hp0-fa_hb0
  s_subb_u32 s11, s11, 0
  s_setpc_b64 s[8:9]
fa_hk1:
  s_getpc_b64 s[10:11]
fa_hp1:
  s_add_u32 s8, s8, 4
  s_addc_u32 s9, s9, 0
  s_sub_u32 s10, s10, fa_hp1-fa_hb1
  s_subb_u32 s11, s11, 0
  s_setpc_b64 s[8:9]
fa_hk2:
  s_getpc_b64 s[10:11]
fa_hp2:
  s_add_u32 s8, s8, 4
  s_addc_u32 s9, s9, 0
  s_sub_u32 s10, s10, fa_hp2-fa_hb2
  s_subb_u32 s11, s11, 0
  s_setpc_b64 s[8:9]
fa_hk3:
  s_getpc_b64 s[10:11]
fa_hp3:
  s_add_u32 s8, s8, 4
  s_addc_u32 s9, s9, 0
  s_sub_u32 s10, s10, fa_hp3-fa_hb3
  s_subb_u32 s11, s11, 0
  s_setpc_b64 s[8:9]
fa_ln_spin:
  s_mov_b32 s83, 200000
fa_ln_spin2:
  buffer_load_dword v15, v229, s[56:59], 0 offen sc1
  s_waitcnt vmcnt(0)
  v_cmp_ne_u32 vcc, 0x01010101, v15
  s_cbranch_vccz fa_ln_ok
  s_sleep 3
  s_sub_u32 s83, s83, 1
  s_cmp_lg_u32 s83, 0
  s_cbranch_scc1 fa_ln_spin2
  s_branch fa_ln_ok
fa_co1:
  buffer_load_dword v232, v234, s[32:35], s29 offen
  buffer_store_dword v229, v225, s[40:43], 0 offen sc1
  ds_read_b128 v[160:163], v221 offset:0
  ds_read_b128 v[164:167], v221 offset:4096
  ds_read_b128 v[168:171], v221 offset:8192
  buffer_store_dword v218, v222, s[40:43], 0 offen sc1
  s_waitcnt lgkmcnt(0)
  buffer_store_dwordx4 v[160:163], v223, s[40:43], s66 offen sc1
  buffer_store_dwordx4 v[164:167], v223, s[40:43], s67 offen sc1
  buffer_store_dwordx4 v[168:171], v224, s[40:43], s78 offen sc1
  s_getpc_b64 s[8:9]
  s_setpc_b64 s[10:11]
  s_mov_b32 s48, s60
  s_mov_b32 s49, s61
  s_mov_b32 s50, s75
  s_lshl_b32 s74, s22, 2
  s_add_u32 s74, s74, s20
  s_lshl_b32 s74, s74, 16
  s_mov_b32 s73, 2097152
  v_mov_b32 v213, 1073741824
  v_mov_b32 v214, 1
  v_writelane_b32 v213, s77, 0
  v_lshlrev_b32 v229, 2, v1
  s_and_b32 s23, s21, 3
  s_cbranch_scc0 fa_arr
  s_getpc_b64 s[8:9]
  s_setpc_b64 s[10:11]
fa_arr:
  buffer_store_byte v214, v213, s[56:59], 0 offen sc1
  s_getpc_b64 s[8:9]
  s_setpc_b64 s[10:11]
  buffer_load_dword v15, v229, s[56:59], 0 offen sc1
  s_getpc_b64 s[8:9]
  s_setpc_b64 s[10:11]
  s_mov_b32 s36, s60
  s_mov_b32 s37, s61
  s_mov_b32 s38, s75
  s_lshr_b32 s27, s20, 1
  s_lshl_b32 s27, s27, 18
  s_mov_b32 s25, 524288
  s_mov_b32 s32, s18
  s_mov_b32 s33, s19
  s_mov_b32 s34, 2621440
  s_mov_b32 s26, 0
  s_movk_i32 s79, 1024
  s_lshl_b32 s23, s22, 2
  s_add_u32 s23, s23, s20
  s_mul_i32 s23, s23, 40960
  v_add_u32 v3, s23, v2
  s_sub_u32 s23, 15, s22
  s_lshl_b32 s23, s23, 2
  s_add_u32 s23, s23, s20
  s_mul_i32 s23, s23, 40960
  s_sub_u32 s23, s23, 2048
  v_add_u32 v5, s23, v2
  v_add_u32 v4, 19456, v3
  v_add_u32 v6, 19456, v5
  s_waitcnt vmcnt(8)
  v_cmp_ne_u32 vcc, 0x01010101, v15
  s_cbranch_vccnz fa_ln_spin
fa_ln_ok:
  s_setpc_b64 s[10:11]
fa_kv_spin:
  s_mov_b32 s83, 200000
fa_kv_spin2:
  buffer_load_dword v15, v8, s[40:43], 0 offen sc1
  s_waitcnt vmcnt(0)
  v_cmp_eq_u32 vcc, 0, v15
  s_cbranch_vccz fa_kv_ok
  s_sleep 3
  s_sub_u32 s83, s83, 1
  s_cmp_lg_u32 s83, 0
  s_cbranch_scc1 fa_kv_spin2
  s_branch fa_kv_ok
fa_top8:
  v_mov_b32 v21, 0
  v_mov_b32 v22, 0
  v_and_b32 v23, 7, v1
  s_mov_b32 s23, 0
fa_top:
  v_max3_u32 v20, v232, v233, v234
  v_max3_u32 v24, v235, v236, v237
  v_max3_u32 v20, v20, v238, v239
  v_max_u32 v20, v20, v24
  s_nop 1
  v_max_u32_dpp v20, v20, v20 quad_perm:[1,0,3,2] row_mask:0xf bank_mask:0xf
  s_nop 1
  v_max_u32_dpp v20, v20, v20 quad_perm:[2,3,0,1] row_mask:0xf bank_mask:0xf
  s_nop 1
  v_max_u32_dpp v20, v20, v20 row_half_mirror row_mask:0xf bank_mask:0xf
  s_nop 1
  v_max_u32_dpp v20, v20, v20 row_mirror row_mask:0xf bank_mask:0xf
  v_mov_b32 v24, v20
  s_nop 1
  v_permlane16_swap_b32 v20, v24
  v_max_u32 v20, v20, v24
  v_mov_b32 v24, v20
  s_nop 1
  v_permlane32_swap_b32 v20, v24
  v_max_u32 v20, v20, v24
  v_add_u32 v21, v21, v20
  v_cmp_eq_u32 vcc, s23, v23
  v_sub_u32 v232, v232, v20
  v_sub_u32 v233, v233, v20
  v_sub_u32 v234, v234, v20
  v_sub_u32 v235, v235, v20
  v_sub_u32 v236, v236, v20
  v_sub_u32 v237, v237, v20
  v_sub_u32 v238, v238, v20
  v_sub_u32 v239, v239, v20
  v_cndmask_b32 v22, v22, v21, vcc
  s_add_u32 s23, s23, 1
  s_cmp_lt_u32 s23, 8
  s_cbranch_scc1 fa_top
  s_lshl_b32 s23, s20, 5
  s_add_u32 s23, s23, 131072
  v_lshl_add_u32 v24, v23, 2, s23
  ds_write_b32 v24, v22
  s_waitcnt lgkmcnt(0)
  s_barrier
  s_cmp_lg_u32 s20, 0
  s_cbranch_scc1 fa_notop
  v_and_b32 v24, 31, v1
  v_lshlrev_b32 v24, 2, v24
  v_add_u32 v24, 131072, v24
  v_mov_b32 v20, 131072
  ds_read_b32 v22, v24
  ds_read_b128 v[96:99], v20 offset:0
  ds_read_b128 v[100:103], v20 offset:16
  ds_read_b128 v[104:107], v20 offset:32
  ds_read_b128 v[108:111], v20 offset:48
  ds_read_b128 v[112:115], v20 offset:64
  ds_read_b128 v[116:119], v20 offset:80
  ds_read_b128 v[120:123], v20 offset:96
  ds_read_b128 v[124:127], v20 offset:112
  v_mov_b32 v23, 0
  s_waitcnt lgkmcnt(0)
  v_cmp_gt_u32 s[4:5], v96, v22
  v_cmp_gt_u32 s[6:7], v97, v22
  v_cmp_gt_u32 s[76:77], v98, v22
  v_cmp_gt_u32 s[78:79], v99, v22
  v_addc_co_u32 v23, vcc, 0, v23, s[4:5]
  v_addc_co_u32 v23, vcc, 0, v23, s[6:7]
  v_addc_co_u32 v23, vcc, 0, v23, s[76:77]
  v_addc_co_u32 v23, vcc, 0, v23, s[78:79]
  v_cmp_gt_u32 s[4:5], v100, v22
  v_cmp_gt_u32 s[6:7], v101, v22
  v_cmp_gt_u32 s[76:77], v102, v22
  v_cmp_gt_u32 s[78:79], v103, v22
  v_addc_co_u32 v23, vcc, 0, v23, s[4:5]
  v_addc_co_u32 v23, vcc, 0, v23, s[6:7]
  v_addc_co_u32 v23, vcc, 0, v23, s[76:77]
  v_addc_co_u32 v23, vcc, 0, v23, s[78:79]
  v_cmp_gt_u32 s[4:5], v104, v22
  v_cmp_gt_u32 s[6:7], v105, v22
  v_cmp_gt_u32 s[76:77], v106, v22
  v_cmp_gt_u32 s[78:79], v107, v22
  v_addc_co_u32 v23, vcc, 0, v23, s[4:5]
  v_addc_co_u32 v23, vcc, 0, v23, s[6:7]
  v_addc_co_u32 v23, vcc, 0, v23, s[76:77]
  v_addc_co_u32 v23, vcc, 0, v23, s[78:79]
  v_cmp_gt_u32 s[4:5], v108, v22
  v_cmp_gt_u32 s[6:7], v109, v22
  v_cmp_gt_u32 s[76:77], v110, v22
  v_cmp_gt_u32 s[78:79], v111, v22
  v_addc_co_u32 v23, vcc, 0, v23, s[4:5]
  v_addc_co_u32 v23, vcc, 0, v23, s[6:7]
  v_addc_co_u32 v23, vcc, 0, v23, s[76:77]
  v_addc_co_u32 v23, vcc, 0, v23, s[78:79]
  v_cmp_gt_u32 s[4:5], v112, v22
  v_cmp_gt_u32 s[6:7], v113, v22
  v_cmp_gt_u32 s[76:77], v114, v22
  v_cmp_gt_u32 s[78:79], v115, v22
  v_addc_co_u32 v23, vcc, 0, v23, s[4:5]
  v_addc_co_u32 v23, vcc, 0, v23, s[6:7]
  v_addc_co_u32 v23, vcc, 0, v23, s[76:77]
  v_addc_co_u32 v23, vcc, 0, v23, s[78:79]
  v_cmp_gt_u32 s[4:5], v116, v22
  v_cmp_gt_u32 s[6:7], v117, v22
  v_cmp_gt_u32 s[76:77], v118, v22
  v_cmp_gt_u32 s[78:79], v119, v22
  v_addc_co_u32 v23, vcc, 0, v23, s[4:5]
  v_addc_co_u32 v23, vcc, 0, v23, s[6:7]
  v_addc_co_u32 v23, vcc, 0, v23, s[76:77]
  v_addc_co_u32 v23, vcc, 0, v23, s[78:79]
  v_cmp_gt_u32 s[4:5], v120, v22
  v_cmp_gt_u32 s[6:7], v121, v22
  v_cmp_gt_u32 s[76:77], v122, v22
  v_cmp_gt_u32 s[78:79], v123, v22
  v_addc_co_u32 v23, vcc, 0, v23, s[4:5]
  v_addc_co_u32 v23, vcc, 0, v23, s[6:7]
  v_addc_co_u32 v23, vcc, 0, v23, s[76:77]
  v_addc_co_u32 v23, vcc, 0, v23, s[78:79]
  v_cmp_gt_u32 s[4:5], v124, v22
  v_cmp_gt_u32 s[6:7], v125, v22
  v_cmp_gt_u32 s[76:77], v126, v22
  v_cmp_gt_u32 s[78:79], v127, v22
  v_addc_co_u32 v23, vcc, 0, v23, s[4:5]
  v_addc_co_u32 v23, vcc, 0, v23, s[6:7]
  v_addc_co_u32 v23, vcc, 0, v23, s[76:77]
  v_addc_co_u32 v23, vcc, 0, v23, s[78:79]
  v_and_b32 v25, 0xffff, v22
  v_sub_u32 v25, 0xffff, v25
  v_and_b32 v25, 2047, v25
  v_ashrrev_i32 v20, 31, v22
  v_not_b32 v20, v20
  v_or_b32 v20, 0x80000000, v20
  v_xor_b32 v26, v22, v20
  v_and_b32 v26, 0xffff0000, v26
  v_mul_f32 v26, 0xbfb8aa3b, v26
  v_exp_f32 v26, v26
  s_nop 0
  v_add_f32 v26, 1.0, v26
  v_rcp_f32 v26, v26
  s_nop 0
  v_cvt_pk_bf16_f32 v26, v26, v26
  v_and_b32 v26, 0xffff0000, v26
  v_and_b32 v20, 32, v1
  v_lshl_add_u32 v20, v23, 2, v20
  v_add_u32 v20, 2629632, v20
  v_mov_b32 v21, 1073741824
  v_cmp_gt_u32 vcc, 8, v23
  v_add_u32 v25, 1, v25
  v_or_b32 v26, 1, v26
  v_cndmask_b32 v20, v21, v20, vcc
  v_cmp_gt_u32 vcc, 32, v1
  s_nop 1
  v_cndmask_b32 v26, v26, v25, vcc
  buffer_store_dword v26, v20, s[40:43], 0 offen sc1
  s_branch fa_notop
fa_hk4:
  s_getpc_b64 s[38:39]
fa_hp4:
  s_add_u32 s36, s36, 4
  s_addc_u32 s37, s37, 0
  s_sub_u32 s38, s38, fa_hp4-fa_hb4
  s_subb_u32 s39, s39, 0
  s_setpc_b64 s[36:37]
fa_hk5:
  s_getpc_b64 s[38:39]
fa_hp5:
  s_add_u32 s36, s36, 4
  s_addc_u32 s37, s37, 0
  s_sub_u32 s38, s38, fa_hp5-fa_hb5
  s_subb_u32 s39, s39, 0
  s_setpc_b64 s[36:37]
fa_hk6:
  s_getpc_b64 s[38:39]
fa_hp6:
  s_add_u32 s36, s36, 4
  s_addc_u32 s37, s37, 0
  s_add_u32 s38, s38, fa_hb6-fa_hp6
  s_addc_u32 s39, s39, 0
  s_setpc_b64 s[36:37]
fa_DDF:
  v_mfma_f32_16x16x32_bf16 v[96:99], a[128:131], v[32:35], v[192:195]
  s_waitcnt vmcnt(4)
  v_exp_f32 v218, v146
  v_mfma_f32_16x16x32_bf16 v[104:107], a[128:131], v[36:39], v[196:199]
  s_barrier
  v_exp_f32 v219, v147
  v_mfma_f32_16x16x32_bf16 v[128:131], a[128:131], v[64:67], v[200:203]
  s_cmp_ge_u32 s26, s32
  ds_read_b128 a[160:163], v3 offset:16384
  v_exp_f32 v220, v148
  v_mfma_f32_16x16x32_bf16 v[136:139], a[128:131], v[68:71], v[204:207]
  s_cbranch_scc1 fa_hk6
fa_hb6:
  ds_read_b64_tr_b16 a[192:193], v9 offset:0
  v_add_f32 v226, v216, v217
  v_mfma_f32_16x16x32_bf16 v[100:103], a[132:135], v[32:35], v[192:195]
  ds_read_b128 a[164:167], v3 offset:17408
  ds_read_b64_tr_b16 a[194:195], v9 offset:128
  v_cvt_pk_bf16_f32 v184, v216, v217
  v_mfma_f32_16x16x32_bf16 v[108:111], a[132:135], v[36:39], v[196:199]
  s_mov_b32 m0, s24
  ds_read_b128 a[212:215], v10 offset:0
  ds_read_b64_tr_b16 a[196:197], v9 offset:1024
  v_add_f32 v226, v226, v218
  v_mfma_f32_16x16x32_bf16 v[132:135], a[132:135], v[64:67], v[200:203]
  buffer_load_dwordx4 v2, s[44:47], s26 offen offset:0 sc1 lds
  v_add_f32 v226, v226, v219
  v_mfma_f32_16x16x32_bf16 v[140:143], a[132:135], v[68:71], v[204:207]
  ds_read_b64_tr_b16 a[198:199], v9 offset:1152
  ds_read_b128 a[216:219], v10 offset:512
  v_cvt_pk_bf16_f32 v185, v218, v219
  v_mfma_f32_16x16x32_bf16 v[96:99], a[136:139], v[40:43], v[96:99]
  ds_read_b128 a[168:171], v3 offset:18432
  ds_read_b64_tr_b16 a[200:201], v9 offset:2048
  v_add_f32 v226, v226, v220
  v_exp_f32 v221, v149
  v_mfma_f32_16x16x32_bf16 v[104:107], a[136:139], v[44:47], v[104:107]
  ds_read_b64_tr_b16 a[202:203], v9 offset:2176
  ds_read_b128 a[220:223], v10 offset:1024
  v_add_f32 v226, v226, v221
  v_mfma_f32_16x16x32_bf16 v[128:131], a[136:139], v[72:75], v[128:131]
  ds_read_b64_tr_b16 a[204:205], v9 offset:3072
  ds_read_b64_tr_b16 a[206:207], v9 offset:3200
  v_cvt_pk_bf16_f32 v186, v220, v221
  v_mfma_f32_16x16x32_bf16 v[136:139], a[136:139], v[76:79], v[136:139]
  ds_read_b128 a[224:227], v10 offset:1536
  ds_read_b64_tr_b16 a[208:209], v9 offset:4096
  v_mfma_f32_16x16x32_bf16 v[100:103], a[140:143], v[40:43], v[100:103]
  ds_read_b128 a[172:175], v3 offset:19456
  v_mfma_f32_16x16x32_bf16 v[108:111], a[140:143], v[44:47], v[108:111]
  buffer_load_dwordx4 v2, s[44:47], s26 offen offset:1024 sc1 lds
  v_mfma_f32_16x16x32_bf16 v[132:135], a[140:143], v[72:75], v[132:135]
  ds_read_b64_tr_b16 a[210:211], v9 offset:4224
  ds_read_b128 a[228:231], v10 offset:2048
  v_mfma_f32_16x16x32_bf16 v[140:143], a[140:143], v[76:79], v[140:143]
  s_waitcnt lgkmcnt(4)
  v_exp_f32 v222, v150
  v_mfma_f32_16x16x32_bf16 v[96:99], a[144:147], v[48:51], v[96:99]
  ds_read_b128 a[176:179], v3 offset:20480
  v_add_f32 v226, v226, v222
  v_mfma_f32_16x16x32_bf16 v[104:107], a[144:147], v[52:55], v[104:107]
  v_exp_f32 v223, v151
  v_mfma_f32_16x16x32_bf16 v[128:131], a[144:147], v[80:83], v[128:131]
  v_exp_f32 v216, v152
  v_add_u32 v10, 2560, v10
  v_mfma_f32_16x16x32_bf16 v[136:139], a[144:147], v[84:87], v[136:139]
  buffer_load_dwordx4 v2, s[44:47], s26 offen offset:2048 sc1 lds
  v_add_f32 v226, v226, v223
  v_mfma_f32_16x16x32_bf16 v[100:103], a[148:151], v[48:51], v[100:103]
  ds_read_b128 a[180:183], v3 offset:21504
  v_cvt_pk_bf16_f32 v187, v222, v223
  v_and_b32 v232, s4, v232
  v_mfma_f32_16x16x32_bf16 v[108:111], a[148:151], v[52:55], v[108:111]
  v_exp_f32 v217, v153
  v_and_b32 v233, s4, v233
  v_mfma_f32_16x16x32_bf16 v[132:135], a[148:151], v[80:83], v[132:135]
  v_exp_f32 v218, v154
  v_and_b32 v234, s4, v234
  v_mfma_f32_16x16x32_bf16 v[140:143], a[148:151], v[84:87], v[140:143]
  v_exp_f32 v219, v155
  v_and_b32 v235, s4, v235
  v_mfma_f32_16x16x32_bf16 v[96:99], a[152:155], v[56:59], v[96:99]
  ds_read_b128 a[184:187], v3 offset:22528
  v_add_f32 v227, v216, v217
  v_cvt_pk_bf16_f32 v188, v216, v217
  v_add_f32 v227, v227, v218
  v_add_f32 v227, v227, v219
  v_mfma_f32_16x16x32_bf16 v[104:107], a[152:155], v[60:63], v[104:107]
  buffer_load_dwordx4 v2, s[44:47], s26 offen offset:3072 sc1 lds
  v_cvt_pk_bf16_f32 v189, v218, v219
  v_mfma_f32_16x16x32_bf16 v[128:131], a[152:155], v[88:91], v[128:131]
  s_add_u32 s26, s26, 16384
  v_exp_f32 v220, v156
  v_mfma_f32_16x16x32_bf16 v[136:139], a[152:155], v[92:95], v[136:139]
  s_add_u32 s24, s24, 32768
  v_exp_f32 v221, v157
  v_mfma_f32_16x16x32_bf16 v[100:103], a[156:159], v[56:59], v[100:103]
  s_and_b32 s24, s24, 0x1ffff
  ds_read_b128 a[188:191], v3 offset:23552
  v_add_f32 v227, v227, v220
  v_add_f32 v227, v227, v221
  v_mfma_f32_16x16x32_bf16 v[108:111], a[156:159], v[60:63], v[108:111]
  v_exp_f32 v222, v158
  v_mfma_f32_16x16x32_bf16 v[132:135], a[156:159], v[88:91], v[132:135]
  s_add_u32 m0, s34, 0
  v_exp_f32 v223, v159
  v_mfma_f32_16x16x32_bf16 v[140:143], a[156:159], v[92:95], v[140:143]
  s_waitcnt lgkmcnt(4)
  buffer_load_dwordx4 v8, s[52:55], s33 offen offset:0 lds
  v_cvt_pk_bf16_f32 v190, v220, v221
  v_add_f32 v227, v227, v222
  v_add_f32 v227, v227, v223
  v_mfma_f32_16x16x32_bf16 a[0:3], a[160:163], v[160:163], a[0:3]
  ds_read_b128 a[128:131], v3 offset:0
  v_cvt_pk_bf16_f32 v191, v222, v223
  v_mfma_f32_16x16x32_bf16 a[4:7], a[160:163], v[164:167], a[4:7]
  s_mov_b32 s4, s5
  v_exp_f32 v208, v112
  v_mfma_f32_16x16x32_bf16 a[64:67], a[160:163], v[176:179], a[64:67]
  s_mov_b32 s5, -1
  v_exp_f32 v209, v113
  v_mfma_f32_16x16x32_bf16 v[232:235], a[192:195], a[212:215], v[232:235]
  v_mfma_f32_16x16x32_bf16 a[68:71], a[160:163], v[180:183], a[68:71]
  v_exp_f32 v210, v114
  v_mfma_f32_16x16x32_bf16 a[8:11], a[164:167], v[160:163], a[8:11]
  ds_read_b128 a[132:135], v3 offset:1024
  v_add_f32 v224, v208, v209
  v_cvt_pk_bf16_f32 v168, v208, v209
  v_mfma_f32_16x16x32_bf16 a[12:15], a[164:167], v[164:167], a[12:15]
  buffer_load_dwordx4 v11, s[52:55], s33 offen offset:1024 lds
  v_add_f32 v224, v224, v210
  v_mfma_f32_16x16x32_bf16 a[72:75], a[164:167], v[176:179], a[72:75]
  v_exp_f32 v211, v115
  v_mfma_f32_16x16x32_bf16 a[76:79], a[164:167], v[180:183], a[76:79]
  v_exp_f32 v212, v116
  v_mfma_f32_16x16x32_bf16 v[232:235], a[196:199], a[216:219], v[232:235]
  v_mfma_f32_16x16x32_bf16 a[16:19], a[168:171], v[160:163], a[16:19]
  ds_read_b128 a[136:139], v3 offset:2048
  v_add_f32 v224, v224, v211
  v_cvt_pk_bf16_f32 v169, v210, v211
  v_mfma_f32_16x16x32_bf16 a[20:23], a[168:171], v[164:167], a[20:23]
  v_exp_f32 v213, v117
  v_mfma_f32_16x16x32_bf16 a[80:83], a[168:171], v[176:179], a[80:83]
  v_exp_f32 v214, v118
  v_mfma_f32_16x16x32_bf16 a[84:87], a[168:171], v[180:183], a[84:87]
  buffer_load_dwordx4 v12, s[52:55], s33 offen offset:2048 lds
  v_add_f32 v224, v224, v212
  v_add_f32 v224, v224, v213
  v_cvt_pk_bf16_f32 v170, v212, v213
  v_mfma_f32_16x16x32_bf16 a[24:27], a[172:175], v[160:163], a[24:27]
  ds_read_b128 a[140:143], v3 offset:3072
  v_add_f32 v224, v224, v214
  v_mfma_f32_16x16x32_bf16 v[232:235], a[200:203], a[220:223], v[232:235]
  v_mfma_f32_16x16x32_bf16 a[28:31], a[172:175], v[164:167], a[28:31]
  v_exp_f32 v215, v119
  v_mfma_f32_16x16x32_bf16 a[88:91], a[172:175], v[176:179], a[88:91]
  v_exp_f32 v208, v120
  v_mfma_f32_16x16x32_bf16 a[92:95], a[172:175], v[180:183], a[92:95]
  s_waitcnt lgkmcnt(4)
  v_exp_f32 v209, v121
  v_mfma_f32_16x16x32_bf16 a[32:35], a[176:179], v[160:163], a[32:35]
  ds_read_b128 a[144:147], v3 offset:4096
  v_add_f32 v224, v224, v215
  v_cvt_pk_bf16_f32 v171, v214, v215
  v_add_f32 v225, v208, v209
  v_mfma_f32_16x16x32_bf16 a[36:39], a[176:179], v[164:167], a[36:39]
  buffer_load_dwordx4 v13, s[52:55], s33 offen offset:3072 lds
  v_cvt_pk_bf16_f32 v172, v208, v209
  v_mfma_f32_16x16x32_bf16 v[232:235], a[204:207], a[224:227], v[232:235]
  v_mfma_f32_16x16x32_bf16 a[96:99], a[176:179], v[176:179], a[96:99]
  v_exp_f32 v210, v122
  v_mfma_f32_16x16x32_bf16 a[100:103], a[176:179], v[180:183], a[100:103]
  v_exp_f32 v211, v123
  v_mfma_f32_16x16x32_bf16 a[40:43], a[180:183], v[160:163], a[40:43]
  ds_read_b128 a[148:151], v3 offset:5120
  v_add_f32 v225, v225, v210
  v_add_f32 v225, v225, v211
  v_mfma_f32_16x16x32_bf16 a[44:47], a[180:183], v[164:167], a[44:47]
  v_exp_f32 v212, v124
  v_mfma_f32_16x16x32_bf16 a[104:107], a[180:183], v[176:179], a[104:107]
  s_add_u32 m0, s34, 4096
  v_exp_f32 v213, v125
  v_mfma_f32_16x16x32_bf16 v[232:235], a[208:211], a[228:231], v[232:235]
  v_mfma_f32_16x16x32_bf16 a[108:111], a[180:183], v[180:183], a[108:111]
  buffer_load_dwordx4 v14, s[52:55], s33 offen offset:0 lds
  v_cvt_pk_bf16_f32 v173, v210, v211
  v_max3_f32 v5, v226, v227, v224
  v_mfma_f32_16x16x32_bf16 a[48:51], a[184:187], v[160:163], a[48:51]
  ds_read_b128 a[152:155], v3 offset:6144
  v_add_f32 v225, v225, v212
  v_mfma_f32_16x16x32_bf16 a[52:55], a[184:187], v[164:167], a[52:55]
  s_add_u32 s33, s33, s6
  v_exp_f32 v214, v126
  v_mfma_f32_16x16x32_bf16 a[112:115], a[184:187], v[176:179], a[112:115]
  v_exp_f32 v215, v127
  v_mfma_f32_16x16x32_bf16 a[116:119], a[184:187], v[180:183], a[116:119]
  v_add_f32 v225, v225, v213
  v_cvt_pk_bf16_f32 v174, v212, v213
  v_add_f32 v225, v225, v214
  v_mfma_f32_16x16x32_bf16 a[56:59], a[188:191], v[160:163], a[56:59]
  ds_read_b128 a[156:159], v3 offset:7168
  v_add_f32 v225, v225, v215
  v_max_f32 v5, v5, v225
  v_cmp_lt_f32 vcc, s81, v5
  v_mfma_f32_16x16x32_bf16 a[60:63], a[188:191], v[164:167], a[60:63]
  v_exp_f32 v216, v128
  v_mfma_f32_16x16x32_bf16 a[120:123], a[188:191], v[176:179], a[120:123]
  s_waitcnt lgkmcnt(4)
  v_cvt_pk_bf16_f32 v175, v214, v215
  v_mfma_f32_16x16x32_bf16 a[124:127], a[188:191], v[180:183], a[124:127]
  s_cbranch_vccnz fa_stub3
fa_back3:
  v_exp_f32 v217, v129
  v_add_f32 v228, v228, v224
  v_add_f32 v229, v229, v225
  v_add_f32 v230, v230, v226
  v_add_f32 v231, v231, v227
  s_branch fa_DDe
fa_kv2_spin:
  s_mov_b32 s83, 200000
fa_kv2_spin2:
  buffer_load_dword v14, v13, s[40:43], 0 offen sc1
  s_waitcnt vmcnt(0)
  v_cmp_eq_u32 vcc, 0, v14
  s_cbranch_vccz fa_kv2_ok
  s_sleep 3
  s_sub_u32 s83, s83, 1
  s_cmp_lg_u32 s83, 0
  s_cbranch_scc1 fa_kv2_spin2
  s_branch fa_kv2_ok
fa_kv3_spin:
  s_mov_b32 s83, 200000
fa_kv3_spin2:
  buffer_load_dword v14, v13, s[40:43], 0 offen sc1
  s_waitcnt vmcnt(0)
  v_cmp_eq_u32 vcc, 0, v14
  s_cbranch_vccz fa_kv3_ok
  s_sleep 3
  s_sub_u32 s83, s83, 1
  s_cmp_lg_u32 s83, 0
  s_cbranch_scc1 fa_kv3_spin2
  s_branch fa_kv3_ok
fa_sel_spin:
  s_mov_b32 s83, 200000
fa_sel_spin2:
  buffer_load_dword v15, v252, s[40:43], 0 offen sc1
  s_waitcnt vmcnt(0)
  v_cmp_eq_u32 vcc, 0, v15
  s_cbranch_vccz fa_sel_ok
  s_sleep 3
  s_sub_u32 s83, s83, 1
  s_cmp_lg_u32 s83, 0
  s_cbranch_scc1 fa_sel_spin2
  s_branch fa_sel_ok
fa_wof_spin:
  s_mov_b32 s83, 200000
fa_wof_spin2:
  buffer_load_dword v8, v9, s[40:43], 0 offen sc1
  s_waitcnt vmcnt(0)
  v_cmp_eq_u32 vcc, 0, v8
  s_cbranch_vccz fa_wof_ok
  s_sleep 3
  s_sub_u32 s83, s83, 1
  s_cmp_lg_u32 s83, 0
  s_cbranch_scc1 fa_wof_spin2
  s_branch fa_wof_ok
fa_sel4_spin:
  s_mov_b32 s83, 200000
fa_sel4_spin2:
  buffer_load_dword v15, v10, s[40:43], 0 offen sc1
  s_waitcnt vmcnt(0)
  v_cmp_eq_u32 vcc, 0, v15
  s_cbranch_vccz fa_sel4_ok
  s_sleep 3
  s_sub_u32 s83, s83, 1
  s_cmp_lg_u32 s83, 0
  s_cbranch_scc1 fa_sel4_spin2
  s_branch fa_sel4_ok
fa_yf_spin:
  s_mov_b32 s83, 200000
fa_yf_spin2:
  buffer_load_dword v14, v11, s[40:43], 0 offen sc1
  s_waitcnt vmcnt(0)
  v_cmp_eq_u32 vcc, 0, v14
  s_cbranch_vccz fa_yf_ok
  s_sleep 3
  s_sub_u32 s83, s83, 1
  s_cmp_lg_u32 s83, 0
  s_cbranch_scc1 fa_yf_spin2
  s_branch fa_yf_ok
fa_co:
  s_sub_u32 s14, s2, 64
  s_cmp_lt_u32 s14, 96
  s_cbranch_scc1 fa_coT
  s_sub_u32 s14, s2, 128
  s_sub_u32 s23, s2, 224
  s_cmp_lt_u32 s23, 31
  s_cbranch_scc1 fa_coT
  v_cmp_eq_u32 vcc, 0, v14
  s_cbranch_vccnz fa_kv2_spin
fa_kv2_ok:
  s_sub_u32 s14, s2, 170
  s_cmp_lt_u32 s14, 54
  s_cbranch_scc1 fa_coF
  s_cmp_eq_u32 s2, 255
  s_cbranch_scc1 fa_coW
  s_cmp_lt_u32 s2, 32
  s_cbranch_scc1 fa_coW
  s_branch fa_coO
fa_coT:
  v_min_u32 v8, 16, v1
  v_lshlrev_b32 v8, 7, v8
  s_lshl_b32 s10, s14, 1
  s_and_b32 s31, s20, 1
  s_add_u32 s10, s10, s31
  s_mul_i32 s10, s10, 2176
  s_lshl_b32 s35, s14, 2
  s_add_u32 s35, s35, s20
  s_mul_i32 s35, s35, 4352
  buffer_load_dword v255, v8, s[52:55], s10 offen
  s_add_u32 s10, s10, 552960
  s_getpc_b64 s[36:37]
  s_setpc_b64 s[38:39]
  buffer_load_dword v255, v8, s[52:55], s10 offen
  s_add_u32 s10, s10, 552960
  s_getpc_b64 s[36:37]
  s_setpc_b64 s[38:39]
  v_cmp_eq_u32 vcc, 0, v14
  s_cbranch_vccnz fa_kv3_spin
fa_kv3_ok:
  buffer_load_dword v255, v8, s[52:55], s10 offen
  s_add_u32 s10, s10, 552960
  buffer_load_dword v255, v8, s[60:63], s35 offen offset:0
  s_getpc_b64 s[36:37]
  s_setpc_b64 s[38:39]
  buffer_load_dword v255, v8, s[52:55], s10 offen
  s_add_u32 s10, s10, 552960
  buffer_load_dword v255, v8, s[60:63], s35 offen offset:2176
  s_mov_b32 s9, -1
  s_and_b32 s32, s21, 3
  s_lshr_b32 s32, s32, 1
  s_add_u32 s32, s32, 6
  s_lshl_b32 s32, s32, 14
  s_getpc_b64 s[36:37]
  s_setpc_b64 s[38:39]
fa_coO:
  s_and_b32 s23, s67, 1
  s_lshl_b32 s23, s23, 2
  s_add_u32 s23, s23, s20
  s_lshr_b32 s31, s67, 1
  s_mul_i32 s33, s23, 0
  s_add_u32 s33, s33, s31
  s_and_b32 s33, s33, 31
  s_andn2_b32 s30, s31, 31
  s_add_u32 s33, s33, s30
  s_lshl_b32 s30, s23, 7
  s_add_u32 s30, s30, s33
  s_mul_i32 s33, s31, 40960
  s_mul_i32 s23, s23, 160
  s_add_u32 s33, s33, s23
  s_add_u32 m0, s34, 0
  v_accvgpr_read_b32 v19, a248
  buffer_load_dwordx4 v19, s[56:59], s33 offen lds
  s_add_u32 m0, s34, 1024
  v_accvgpr_read_b32 v19, a249
  buffer_load_dwordx4 v19, s[56:59], s33 offen lds
  s_add_u32 m0, s34, 2048
  v_accvgpr_read_b32 v19, a250
  buffer_load_dwordx4 v19, s[56:59], s33 offen lds
  s_add_u32 m0, s34, 3072
  v_accvgpr_read_b32 v19, a251
  buffer_load_dwordx4 v19, s[56:59], s33 offen lds
  s_add_u32 m0, s34, 4096
  v_accvgpr_read_b32 v19, a252
  buffer_load_dwordx4 v19, s[56:59], s33 offen lds
  s_lshl_b32 s32, s11, 15
  s_add_u32 s32, s32, s26
  s_mov_b32 s9, -1
  s_lshl_b32 s10, s30, 7
  s_mul_i32 s30, s30, 5120
  s_add_u32 s30, s30, 4194304
  s_getpc_b64 s[36:37]
  s_setpc_b64 s[38:39]
  s_waitcnt vmcnt(8)
  ds_read_b64_tr_b16 v[232:233], v6 offset:0
  ds_read_b64_tr_b16 v[234:235], v6 offset:2560
  ds_read_b64_tr_b16 v[236:237], v6 offset:32
  ds_read_b64_tr_b16 v[238:239], v6 offset:2592
  ds_read_b64_tr_b16 v[240:241], v6 offset:64
  ds_read_b64_tr_b16 v[242:243], v6 offset:2624
  ds_read_b64_tr_b16 v[244:245], v6 offset:96
  ds_read_b64_tr_b16 v[246:247], v6 offset:2656
  ds_read_b64_tr_b16 v[248:249], v6 offset:128
  ds_read_b64_tr_b16 v[250:251], v6 offset:2688
  s_waitcnt lgkmcnt(0)
  s_add_u32 s31, s30, 4096
  buffer_store_dwordx4 v[232:235], v2, s[40:43], s30 offen offset:0 sc1
  buffer_store_dwordx4 v[236:239], v2, s[40:43], s30 offen offset:1024 sc1
  buffer_store_dwordx4 v[240:243], v2, s[40:43], s30 offen offset:2048 sc1
  buffer_store_dwordx4 v[244:247], v2, s[40:43], s30 offen offset:3072 sc1
  buffer_store_dwordx4 v[248:251], v2, s[40:43], s31 offen offset:0 sc1
  s_getpc_b64 s[36:37]
  s_setpc_b64 s[38:39]
  s_add_u32 s23, s10, 67371008
  s_waitcnt vmcnt(8)
  buffer_store_dword v4, off, s[40:43], s23 sc1
  s_cmp_lg_u32 s67, s2
  s_cbranch_scc1 fa_coW
  s_sub_u32 s67, s2, 128
  s_cmp_lt_u32 s67, 32
  s_cbranch_scc1 fa_coO
  s_sub_u32 s23, s2, 96
  s_sub_u32 s31, s2, 192
  s_cmp_lt_u32 s23, 32
  s_cselect_b32 s23, s23, s31
  s_cmp_gt_u32 s23, 54
  s_cbranch_scc1 fa_coW
  s_add_u32 s67, s23, 170
  s_cmp_eq_u32 s67, 224
  s_cselect_b32 s67, 255, s67
  s_branch fa_coO
fa_coF:
  v_and_b32 v16, 7, v1
  v_lshlrev_b32 v252, 2, v16
  v_add_u32 v252, 2629632, v252
  buffer_load_dword v15, v252, s[40:43], 0 offen sc1
  s_lshl_b32 s33, s14, 6
  s_and_b32 s31, s20, 1
  s_lshl_b32 s31, s31, 5
  s_add_u32 s33, s33, s31
  s_mul_i32 s35, s14, 40960
  s_mul_i32 s31, s20, 320
  s_add_u32 s35, s35, s31
  s_mul_i32 s10, s14, 20480
  s_mul_i32 s31, s20, 5120
  s_add_u32 s10, s10, s31
  s_add_u32 s10, s10, 2686976
  v_lshrrev_b32 v17, 1, v1
  v_mul_u32_u24 v8, 3456, v17
  v_and_b32 v17, 1, v1
  v_lshl_add_u32 v8, v17, 4, v8
  v_add_u32 v11, 109568, v8
  v_add_u32 v12, 219136, v8
  v_add_u32 v13, 328704, v8
  v_add_u32 v14, 442368, v8
  v_lshrrev_b32 v17, 4, v1
  v_lshrrev_b32 v18, 2, v1
  v_lshl_add_u32 v18, v17, 2, v18
  v_lshlrev_b32 v18, 5, v18
  v_and_b32 v19, 3, v1
  v_lshl_add_u32 v9, v19, 3, v18
  v_add_u32 v9, s34, v9
  v_lshlrev_b32 v10, 4, v16
  v_lshl_add_u32 v10, v17, 7, v10
  v_add_u32 v10, 148992, v10
  s_mov_b32 s8, -1
  s_mov_b32 s4, 0
  s_mov_b32 s5, 0
  s_mov_b32 s6, 552960
  s_getpc_b64 s[36:37]
  s_setpc_b64 s[38:39]
  s_waitcnt vmcnt(8)
  v_cmp_eq_u32 vcc, 0, v15
  s_cbranch_vccnz fa_sel_spin
fa_sel_ok:
  v_add_u32 v18, -1, v15
  v_and_b32 v18, 2047, v18
  v_lshrrev_b32 v19, 4, v18
  v_mul_u32_u24 v19, 20480, v19
  v_and_b32 v18, 15, v18
  v_lshl_add_u32 v19, v18, 4, v19
  v_lshrrev_b32 v18, 3, v1
  v_lshl_add_u32 v19, v18, 8, v19
  s_lshl_b32 s23, s20, 11
  s_lshl_b32 s31, s20, 10
  s_add_u32 s31, s31, 151552
  s_mov_b32 s32, 163840
  s_mov_b32 m0, s31
  s_add_u32 s31, s31, 4096
  buffer_load_dwordx4 v19, s[40:43], s23 offen sc1 lds
  s_add_u32 s23, s23, 8192
  s_mov_b32 m0, s31
  s_add_u32 s31, s31, 4096
  buffer_load_dwordx4 v19, s[40:43], s23 offen sc1 lds
  s_add_u32 s23, s23, 8192
  s_mov_b32 m0, s31
  s_add_u32 s31, s31, 4096
  buffer_load_dwordx4 v19, s[40:43], s23 offen sc1 lds
  s_add_u32 s23, s23, 8192
  s_getpc_b64 s[36:37]
  s_setpc_b64 s[38:39]
  v_accvgpr_read_b32 v8, a248
  v_accvgpr_read_b32 v11, a249
  v_accvgpr_read_b32 v12, a250
  v_accvgpr_read_b32 v13, a251
  v_accvgpr_read_b32 v14, a252
  v_subrev_u32 v11, 1024, v11
  v_subrev_u32 v12, 2048, v12
  v_subrev_u32 v13, 3072, v13
  s_mov_b32 s52, s60
  s_mov_b32 s53, s61
  s_mov_b32 s33, s35
  s_movk_i32 s6, 160
  s_mov_b32 s9, 0
  v_and_b32 v17, 7, v1
  v_lshlrev_b32 v15, 6, v17
  v_lshrrev_b32 v17, 4, v1
  v_lshl_add_u32 v15, v17, 4, v15
  v_and_b32 v17, 8, v1
  v_lshl_add_u32 v15, v17, 27, v15
  s_getpc_b64 s[36:37]
  s_setpc_b64 s[38:39]
  s_lshl_b32 s23, s20, 9
  v_add_u32 v16, s23, v10
  s_mov_b32 s9, -1
  ds_write_b128 v16, v[232:235]
  s_getpc_b64 s[36:37]
  s_setpc_b64 s[38:39]
  ds_read_b128 v[236:239], v10 offset:0
  ds_read_b128 v[240:243], v10 offset:512
  ds_read_b128 v[244:247], v10 offset:1024
  ds_read_b128 v[248:251], v10 offset:1536
  s_waitcnt vmcnt(4)
  ds_read_b64_tr_b16 a[192:193], v6 offset:0
  ds_read_b64_tr_b16 a[194:195], v6 offset:2560
  ds_read_b64_tr_b16 a[196:197], v6 offset:32
  ds_read_b64_tr_b16 a[198:199], v6 offset:2592
  ds_read_b64_tr_b16 a[200:201], v6 offset:64
  ds_read_b64_tr_b16 a[202:203], v6 offset:2624
  ds_read_b64_tr_b16 a[204:205], v6 offset:96
  ds_read_b64_tr_b16 a[206:207], v6 offset:2656
  ds_read_b64_tr_b16 a[208:209], v6 offset:128
  ds_read_b64_tr_b16 a[210:211], v6 offset:2688
  v_subrev_u32 v10, 10240, v10
  s_mov_b32 s8, 0
  s_waitcnt lgkmcnt(10)
  v_cvt_pk_bf16_f32 v236, v236, v244
  v_cvt_pk_bf16_f32 v237, v237, v245
  v_cvt_pk_bf16_f32 v238, v238, v246
  v_cvt_pk_bf16_f32 v239, v239, v247
  v_cvt_pk_bf16_f32 v240, v240, v248
  v_cvt_pk_bf16_f32 v241, v241, v249
  v_cvt_pk_bf16_f32 v242, v242, v250
  v_cvt_pk_bf16_f32 v243, v243, v251
  v_lshlrev_b32 v244, 16, v236
  v_lshlrev_b32 v245, 16, v237
  v_lshlrev_b32 v246, 16, v238
  v_lshlrev_b32 v247, 16, v239
  v_lshlrev_b32 v248, 16, v240
  v_lshlrev_b32 v249, 16, v241
  v_lshlrev_b32 v250, 16, v242
  v_lshlrev_b32 v251, 16, v243
  v_mul_f32 v16, 0xbfb8aa3b, v244
  v_mul_f32 v17, 0xbfb8aa3b, v245
  v_mul_f32 v18, 0xbfb8aa3b, v246
  v_mul_f32 v19, 0xbfb8aa3b, v247
  v_mul_f32 v20, 0xbfb8aa3b, v248
  v_mul_f32 v21, 0xbfb8aa3b, v249
  v_mul_f32 v22, 0xbfb8aa3b, v250
  v_mul_f32 v23, 0xbfb8aa3b, v251
  v_exp_f32 v16, v16
  v_exp_f32 v17, v17
  v_exp_f32 v18, v18
  v_exp_f32 v19, v19
  v_exp_f32 v20, v20
  v_exp_f32 v21, v21
  v_exp_f32 v22, v22
  v_exp_f32 v23, v23
  v_add_f32 v16, 1.0, v16
  v_add_f32 v17, 1.0, v17
  v_add_f32 v18, 1.0, v18
  v_add_f32 v19, 1.0, v19
  v_add_f32 v20, 1.0, v20
  v_add_f32 v21, 1.0, v21
  v_add_f32 v22, 1.0, v22
  v_add_f32 v23, 1.0, v23
  v_rcp_f32 v16, v16
  v_rcp_f32 v17, v17
  v_rcp_f32 v18, v18
  v_rcp_f32 v19, v19
  v_rcp_f32 v20, v20
  v_rcp_f32 v21, v21
  v_rcp_f32 v22, v22
  v_rcp_f32 v23, v23
  v_and_b32 v236, 0xffff0000, v236
  v_and_b32 v237, 0xffff0000, v237
  v_and_b32 v238, 0xffff0000, v238
  v_and_b32 v239, 0xffff0000, v239
  v_and_b32 v240, 0xffff0000, v240
  v_and_b32 v241, 0xffff0000, v241
  v_and_b32 v242, 0xffff0000, v242
  v_and_b32 v243, 0xffff0000, v243
  v_pk_mul_f32 v[244:245], v[244:245], v[16:17]
  v_pk_mul_f32 v[246:247], v[246:247], v[18:19]
  v_pk_mul_f32 v[248:249], v[248:249], v[20:21]
  v_pk_mul_f32 v[250:251], v[250:251], v[22:23]
  v_cvt_pk_bf16_f32 v16, v244, v245
  v_cvt_pk_bf16_f32 v17, v246, v247
  v_cvt_pk_bf16_f32 v18, v248, v249
  v_cvt_pk_bf16_f32 v19, v250, v251
  v_lshlrev_b32 v244, 16, v16
  v_and_b32 v245, 0xffff0000, v16
  v_lshlrev_b32 v246, 16, v17
  v_and_b32 v247, 0xffff0000, v17
  v_lshlrev_b32 v248, 16, v18
  v_and_b32 v249, 0xffff0000, v18
  v_lshlrev_b32 v250, 16, v19
  v_and_b32 v251, 0xffff0000, v19
  v_pk_mul_f32 v[236:237], v[236:237], v[244:245]
  v_pk_mul_f32 v[238:239], v[238:239], v[246:247]
  v_pk_mul_f32 v[240:241], v[240:241], v[248:249]
  v_pk_mul_f32 v[242:243], v[242:243], v[250:251]
  v_cvt_pk_bf16_f32 v16, v236, v237
  v_cvt_pk_bf16_f32 v17, v238, v239
  v_cvt_pk_bf16_f32 v18, v240, v241
  v_cvt_pk_bf16_f32 v19, v242, v243
  v_accvgpr_write_b32 a232, v16
  v_accvgpr_write_b32 a233, v17
  v_accvgpr_write_b32 a234, v18
  v_accvgpr_write_b32 a235, v19
  s_nop 0
  s_waitcnt lgkmcnt(0)
  v_mfma_f32_16x16x32_bf16 v[236:239], a[192:195], a[232:235], 0
  v_mfma_f32_16x16x32_bf16 v[240:243], a[196:199], a[232:235], 0
  v_mfma_f32_16x16x32_bf16 v[244:247], a[200:203], a[232:235], 0
  v_mfma_f32_16x16x32_bf16 v[248:251], a[204:207], a[232:235], 0
  v_mfma_f32_16x16x32_bf16 v[252:255], a[208:211], a[232:235], 0
  s_nop 3
  buffer_store_dwordx4 v[236:239], v15, s[40:43], s10 offen offset:0 sc1
  buffer_store_dwordx4 v[240:243], v15, s[40:43], s10 offen offset:512 sc1
  buffer_store_dwordx4 v[244:247], v15, s[40:43], s10 offen offset:1024 sc1
  buffer_store_dwordx4 v[248:251], v15, s[40:43], s10 offen offset:1536 sc1
  buffer_store_dwordx4 v[252:255], v15, s[40:43], s10 offen offset:2048 sc1
  s_add_u32 s10, s10, 2560
  s_getpc_b64 s[36:37]
  s_setpc_b64 s[38:39]
  s_waitcnt vmcnt(4)
  ds_read_b64_tr_b16 a[192:193], v6 offset:0
  ds_read_b64_tr_b16 a[194:195], v6 offset:2560
  ds_read_b64_tr_b16 a[196:197], v6 offset:32
  ds_read_b64_tr_b16 a[198:199], v6 offset:2592
  ds_read_b64_tr_b16 a[200:201], v6 offset:64
  ds_read_b64_tr_b16 a[202:203], v6 offset:2624
  ds_read_b64_tr_b16 a[204:205], v6 offset:96
  ds_read_b64_tr_b16 a[206:207], v6 offset:2656
  ds_read_b64_tr_b16 a[208:209], v6 offset:128
  ds_read_b64_tr_b16 a[210:211], v6 offset:2688
  s_waitcnt lgkmcnt(0)
  v_mfma_f32_16x16x32_bf16 v[236:239], a[192:195], a[232:235], 0
  v_mfma_f32_16x16x32_bf16 v[240:243], a[196:199], a[232:235], 0
  v_mfma_f32_16x16x32_bf16 v[244:247], a[200:203], a[232:235], 0
  v_mfma_f32_16x16x32_bf16 v[248:251], a[204:207], a[232:235], 0
  v_mfma_f32_16x16x32_bf16 v[252:255], a[208:211], a[232:235], 0
  s_nop 3
  buffer_store_dwordx4 v[236:239], v15, s[40:43], s10 offen offset:0 sc1
  buffer_store_dwordx4 v[240:243], v15, s[40:43], s10 offen offset:512 sc1
  buffer_store_dwordx4 v[244:247], v15, s[40:43], s10 offen offset:1024 sc1
  buffer_store_dwordx4 v[248:251], v15, s[40:43], s10 offen offset:1536 sc1
  buffer_store_dwordx4 v[252:255], v15, s[40:43], s10 offen offset:2048 sc1
  s_add_u32 s10, s10, 2560
  s_getpc_b64 s[36:37]
  s_setpc_b64 s[38:39]
  s_sub_u32 s23, s2, 170
  s_lshl_b32 s31, s20, 6
  s_add_u32 s23, s23, s31
  s_lshl_b32 s23, s23, 7
  s_add_u32 s23, s23, 67174400
  s_waitcnt vmcnt(8)
  buffer_store_dword v4, off, s[40:43], s23 sc1
fa_coW:
  s_mov_b32 s12, 1
  s_mov_b32 s9, -1
  s_cmp_lg_u32 s11, 0
  s_cselect_b32 s32, s15, -1
  s_getpc_b64 s[36:37]
  s_setpc_b64 s[38:39]
  s_lshl_b32 s23, s22, 1
  s_and_b32 s31, s2, 1
  s_add_u32 s23, s23, s31
  s_lshl_b32 s23, s23, 2
  s_add_u32 s23, s23, s20
  s_mul_i32 s13, s23, 81920
  s_add_u32 s13, s13, 4194304
  s_lshl_b32 s23, s23, 11
  s_add_u32 s23, s23, 67371008
  v_and_b32 v9, 15, v1
  v_lshl_add_u32 v9, v9, 7, s23
  s_and_b32 s60, s2, 7
  s_lshl_b32 s60, s60, 1
  s_and_b32 s23, s2, 16
  s_add_u32 s60, s60, s23
  s_bfe_u32 s23, s2, 0x10003
  s_add_u32 s60, s60, s23
  v_and_b32 v10, 15, v1
  v_lshlrev_b32 v10, 2, v10
  v_add_u32 v10, 2629632, v10
  buffer_load_dword v8, v9, s[40:43], 0 offen sc1
  buffer_load_dword v15, v10, s[40:43], 0 offen sc1
  s_load_dwordx2 s[52:53], s[0:1], 0
  v_mov_b32 v20, v228
  v_mov_b32 v21, v229
  s_nop 1
  v_permlane16_swap_b32 v228, v20
  v_permlane16_swap_b32 v229, v21
  v_add_f32 v228, v228, v20
  v_add_f32 v229, v229, v21
  v_mov_b32 v20, v228
  v_mov_b32 v21, v229
  s_nop 1
  v_permlane32_swap_b32 v228, v20
  v_permlane32_swap_b32 v229, v21
  v_add_f32 v228, v228, v20
  v_add_f32 v229, v229, v21
  v_rcp_f32 v16, v228
  v_rcp_f32 v18, v229
  s_lshl_b32 s23, s22, 2
  v_mov_b32 v17, v16
  v_mov_b32 v19, v18
  s_add_u32 s23, s23, s20
  s_lshl_b32 s23, s23, 18
  s_lshl_b32 s31, s21, 12
  s_add_u32 s31, s31, 50331648
  s_add_u32 s64, s23, s31
  s_add_u32 s65, s64, 131072
  v_accvgpr_read_b32 v36, a0
  v_accvgpr_read_b32 v37, a1
  v_accvgpr_read_b32 v38, a2
  v_accvgpr_read_b32 v39, a3
  v_accvgpr_read_b32 v40, a8
  v_accvgpr_read_b32 v41, a9
  v_accvgpr_read_b32 v42, a10
  v_accvgpr_read_b32 v43, a11
  v_pk_mul_f32 v[36:37], v[36:37], v[16:17]
  v_pk_mul_f32 v[38:39], v[38:39], v[16:17]
  v_pk_mul_f32 v[40:41], v[40:41], v[16:17]
  v_pk_mul_f32 v[42:43], v[42:43], v[16:17]
  v_cvt_pk_bf16_f32 v32, v36, v37
  v_cvt_pk_bf16_f32 v33, v38, v39
  v_cvt_pk_bf16_f32 v34, v40, v41
  v_cvt_pk_bf16_f32 v35, v42, v43
  buffer_store_dwordx4 v[32:35], v2, s[40:43], s64 offen offset:0 sc1
  v_accvgpr_read_b32 v48, a16
  v_accvgpr_read_b32 v49, a17
  v_accvgpr_read_b32 v50, a18
  v_accvgpr_read_b32 v51, a19
  v_accvgpr_read_b32 v52, a24
  v_accvgpr_read_b32 v53, a25
  v_accvgpr_read_b32 v54, a26
  v_accvgpr_read_b32 v55, a27
  v_pk_mul_f32 v[48:49], v[48:49], v[16:17]
  v_pk_mul_f32 v[50:51], v[50:51], v[16:17]
  v_pk_mul_f32 v[52:53], v[52:53], v[16:17]
  v_pk_mul_f32 v[54:55], v[54:55], v[16:17]
  v_cvt_pk_bf16_f32 v44, v48, v49
  v_cvt_pk_bf16_f32 v45, v50, v51
  v_cvt_pk_bf16_f32 v46, v52, v53
  v_cvt_pk_bf16_f32 v47, v54, v55
  buffer_store_dwordx4 v[44:47], v2, s[40:43], s64 offen offset:1024 sc1
  v_accvgpr_read_b32 v100, a32
  v_accvgpr_read_b32 v101, a33
  v_accvgpr_read_b32 v102, a34
  v_accvgpr_read_b32 v103, a35
  v_accvgpr_read_b32 v104, a40
  v_accvgpr_read_b32 v105, a41
  v_accvgpr_read_b32 v106, a42
  v_accvgpr_read_b32 v107, a43
  v_pk_mul_f32 v[100:101], v[100:101], v[16:17]
  v_pk_mul_f32 v[102:103], v[102:103], v[16:17]
  v_pk_mul_f32 v[104:105], v[104:105], v[16:17]
  v_pk_mul_f32 v[106:107], v[106:107], v[16:17]
  v_cvt_pk_bf16_f32 v96, v100, v101
  v_cvt_pk_bf16_f32 v97, v102, v103
  v_cvt_pk_bf16_f32 v98, v104, v105
  v_cvt_pk_bf16_f32 v99, v106, v107
  buffer_store_dwordx4 v[96:99], v2, s[40:43], s64 offen offset:2048 sc1
  v_accvgpr_read_b32 v112, a48
  v_accvgpr_read_b32 v113, a49
  v_accvgpr_read_b32 v114, a50
  v_accvgpr_read_b32 v115, a51
  v_accvgpr_read_b32 v116, a56
  v_accvgpr_read_b32 v117, a57
  v_accvgpr_read_b32 v118, a58
  v_accvgpr_read_b32 v119, a59
  v_pk_mul_f32 v[112:113], v[112:113], v[16:17]
  v_pk_mul_f32 v[114:115], v[114:115], v[16:17]
  v_pk_mul_f32 v[116:117], v[116:117], v[16:17]
  v_pk_mul_f32 v[118:119], v[118:119], v[16:17]
  v_cvt_pk_bf16_f32 v108, v112, v113
  v_cvt_pk_bf16_f32 v109, v114, v115
  v_cvt_pk_bf16_f32 v110, v116, v117
  v_cvt_pk_bf16_f32 v111, v118, v119
  buffer_store_dwordx4 v[108:111], v2, s[40:43], s64 offen offset:3072 sc1
  v_accvgpr_read_b32 v36, a4
  v_accvgpr_read_b32 v37, a5
  v_accvgpr_read_b32 v38, a6
  v_accvgpr_read_b32 v39, a7
  v_accvgpr_read_b32 v40, a12
  v_accvgpr_read_b32 v41, a13
  v_accvgpr_read_b32 v42, a14
  v_accvgpr_read_b32 v43, a15
  v_pk_mul_f32 v[36:37], v[36:37], v[18:19]
  v_pk_mul_f32 v[38:39], v[38:39], v[18:19]
  v_pk_mul_f32 v[40:41], v[40:41], v[18:19]
  v_pk_mul_f32 v[42:43], v[42:43], v[18:19]
  v_cvt_pk_bf16_f32 v32, v36, v37
  v_cvt_pk_bf16_f32 v33, v38, v39
  v_cvt_pk_bf16_f32 v34, v40, v41
  v_cvt_pk_bf16_f32 v35, v42, v43
  buffer_store_dwordx4 v[32:35], v2, s[40:43], s65 offen offset:0 sc1
  v_accvgpr_read_b32 v48, a20
  v_accvgpr_read_b32 v49, a21
  v_accvgpr_read_b32 v50, a22
  v_accvgpr_read_b32 v51, a23
  v_accvgpr_read_b32 v52, a28
  v_accvgpr_read_b32 v53, a29
  v_accvgpr_read_b32 v54, a30
  v_accvgpr_read_b32 v55, a31
  v_pk_mul_f32 v[48:49], v[48:49], v[18:19]
  v_pk_mul_f32 v[50:51], v[50:51], v[18:19]
  v_pk_mul_f32 v[52:53], v[52:53], v[18:19]
  v_pk_mul_f32 v[54:55], v[54:55], v[18:19]
  v_cvt_pk_bf16_f32 v44, v48, v49
  v_cvt_pk_bf16_f32 v45, v50, v51
  v_cvt_pk_bf16_f32 v46, v52, v53
  v_cvt_pk_bf16_f32 v47, v54, v55
  buffer_store_dwordx4 v[44:47], v2, s[40:43], s65 offen offset:1024 sc1
  v_accvgpr_read_b32 v100, a36
  v_accvgpr_read_b32 v101, a37
  v_accvgpr_read_b32 v102, a38
  v_accvgpr_read_b32 v103, a39
  v_accvgpr_read_b32 v104, a44
  v_accvgpr_read_b32 v105, a45
  v_accvgpr_read_b32 v106, a46
  v_accvgpr_read_b32 v107, a47
  v_pk_mul_f32 v[100:101], v[100:101], v[18:19]
  v_pk_mul_f32 v[102:103], v[102:103], v[18:19]
  v_pk_mul_f32 v[104:105], v[104:105], v[18:19]
  v_pk_mul_f32 v[106:107], v[106:107], v[18:19]
  v_cvt_pk_bf16_f32 v96, v100, v101
  v_cvt_pk_bf16_f32 v97, v102, v103
  v_cvt_pk_bf16_f32 v98, v104, v105
  v_cvt_pk_bf16_f32 v99, v106, v107
  buffer_store_dwordx4 v[96:99], v2, s[40:43], s65 offen offset:2048 sc1
  v_accvgpr_read_b32 v112, a52
  v_accvgpr_read_b32 v113, a53
  v_accvgpr_read_b32 v114, a54
  v_accvgpr_read_b32 v115, a55
  v_accvgpr_read_b32 v116, a60
  v_accvgpr_read_b32 v117, a61
  v_accvgpr_read_b32 v118, a62
  v_accvgpr_read_b32 v119, a63
  v_pk_mul_f32 v[112:113], v[112:113], v[18:19]
  v_pk_mul_f32 v[114:115], v[114:115], v[18:19]
  v_pk_mul_f32 v[116:117], v[116:117], v[18:19]
  v_pk_mul_f32 v[118:119], v[118:119], v[18:19]
  v_cvt_pk_bf16_f32 v108, v112, v113
  v_cvt_pk_bf16_f32 v109, v114, v115
  v_cvt_pk_bf16_f32 v110, v116, v117
  v_cvt_pk_bf16_f32 v111, v118, v119
  buffer_store_dwordx4 v[108:111], v2, s[40:43], s65 offen offset:3072 sc1
  s_lshl_b32 s33, s60, 6
  s_mul_i32 s35, s22, 160
  s_mul_i32 s14, s22, 2560
  s_mov_b32 s54, 2621440
  s_mov_b32 s55, 0x20000
  v_add_u32 v16, 0, v0
  v_mul_u32_u24 v17, 6554, v16
  v_lshrrev_b32 v17, 16, v17
  v_mul_u32_u24 v18, 10, v17
  v_sub_u32 v18, v16, v18
  v_mul_u32_u24 v251, 336, v17
  v_lshl_add_u32 v251, v18, 5, v251
  v_add_u32 v17, s33, v17
  v_mul_u32_u24 v248, 1280, v17
  v_lshl_add_u32 v248, v18, 4, v248
  v_add_u32 v248, s35, v248
  v_lshrrev_b32 v19, 4, v17
  v_mul_u32_u24 v19, 20480, v19
  v_and_b32 v17, 15, v17
  v_lshl_add_u32 v19, v17, 4, v19
  v_lshl_add_u32 v24, v18, 8, v19
  v_add_u32 v16, 256, v0
  v_mul_u32_u24 v17, 6554, v16
  v_lshrrev_b32 v17, 16, v17
  v_mul_u32_u24 v18, 10, v17
  v_sub_u32 v18, v16, v18
  v_mul_u32_u24 v252, 336, v17
  v_lshl_add_u32 v252, v18, 5, v252
  v_add_u32 v17, s33, v17
  v_mul_u32_u24 v249, 1280, v17
  v_lshl_add_u32 v249, v18, 4, v249
  v_add_u32 v249, s35, v249
  v_lshrrev_b32 v19, 4, v17
  v_mul_u32_u24 v19, 20480, v19
  v_and_b32 v17, 15, v17
  v_lshl_add_u32 v19, v17, 4, v19
  v_lshl_add_u32 v25, v18, 8, v19
  v_add_u32 v16, 512, v0
  v_mul_u32_u24 v17, 6554, v16
  v_lshrrev_b32 v17, 16, v17
  v_mul_u32_u24 v18, 10, v17
  v_sub_u32 v18, v16, v18
  v_mul_u32_u24 v253, 336, v17
  v_lshl_add_u32 v253, v18, 5, v253
  v_add_u32 v17, s33, v17
  v_mul_u32_u24 v250, 1280, v17
  v_lshl_add_u32 v250, v18, 4, v250
  v_add_u32 v250, s35, v250
  v_lshrrev_b32 v19, 4, v17
  v_mul_u32_u24 v19, 20480, v19
  v_and_b32 v17, 15, v17
  v_lshl_add_u32 v19, v17, 4, v19
  v_lshl_add_u32 v26, v18, 8, v19
  v_cmp_gt_u32 vcc, 128, v0
  v_mov_b32 v16, 1073741824
  v_mov_b32 v17, 0
  v_lshlrev_b32 v6, 4, v0
  v_cndmask_b32 v250, v16, v250, vcc
  v_cndmask_b32 v26, v16, v26, vcc
  v_cndmask_b32 v253, v17, v253, vcc
  v_cndmask_b32 v6, v16, v6, vcc
  s_lshl_b32 s23, s20, 10
  s_add_u32 s23, s23, 151552
  s_waitcnt vmcnt(8) lgkmcnt(0)
  s_add_u32 m0, s34, 0
  s_nop 0
  buffer_load_dwordx4 v248, s[52:55], 0 offen lds
  s_add_u32 m0, s34, 3072
  s_nop 0
  buffer_load_dwordx4 v24, s[40:43], s14 offen sc1 lds
  s_add_u32 m0, s34, 1024
  s_nop 0
  buffer_load_dwordx4 v249, s[52:55], 0 offen lds
  s_add_u32 m0, s34, 4096
  s_nop 0
  buffer_load_dwordx4 v25, s[40:43], s14 offen sc1 lds
  s_add_u32 m0, s34, 2048
  s_nop 0
  buffer_load_dwordx4 v250, s[52:55], 0 offen lds
  s_mov_b32 m0, s23
  s_nop 0
  buffer_load_dwordx4 v26, s[40:43], s14 offen sc1 lds
  s_mov_b32 s28, s46
  s_add_u32 s30, s28, 65536
  s_lshl_b32 s23, s20, 12
  s_add_u32 s23, s23, s28
  s_add_u32 s31, s13, 32768
  s_sub_u32 s31, s31, s23
  s_add_u32 s4, s18, s31
  s_addc_u32 s5, s19, 0
  s_add_u32 s6, s4, 4096
  s_addc_u32 s7, s5, 0
  v_cmp_eq_u32 vcc, 0, v8
  s_cbranch_vccnz fa_wof_spin
fa_wof_ok:
  v_cmp_eq_u32 vcc, 0, v15
  s_cbranch_vccnz fa_sel4_spin
fa_sel4_ok:
  s_lshl_b32 s31, s60, 6
  s_add_u32 s31, s31, 1
  v_subrev_u32 v16, s31, v15
  v_cmp_gt_u32 vcc, 64, v16
  s_cmp_lt_u32 s20, 2
  s_cselect_b32 s23, 0xff, 0
  s_and_b32 s10, vcc_lo, s23
  s_sub_u32 s23, s10, 1
  s_and_b32 s23, s23, s10
  s_cmp_eq_u32 s20, 1
  s_cselect_b32 s10, s23, s10
  s_cmp_eq_u32 s10, 0
  s_cbranch_scc1 fa_coEnd
  v_min_u32 v11, 53, v1
  s_lshr_b32 s23, s22, 1
  s_lshl_b32 s23, s23, 13
  s_add_u32 s23, s23, 67174400
  v_lshl_add_u32 v11, v11, 7, s23
  buffer_load_dword v14, v11, s[40:43], 0 offen sc1
  v_mul_u32_u24 v16, 3277, v1
  v_lshrrev_b32 v16, 16, v16
  v_mul_u32_u24 v8, 20, v16
  v_sub_u32 v8, v1, v8
  v_lshlrev_b32 v8, 4, v8
  v_mul_u32_u24 v9, 368640, v16
  v_lshrrev_b32 v17, 6, v8
  v_mul_u32_u24 v17, 448, v17
  v_add3_u32 v9, v9, v8, v17
  v_cmp_gt_u32 vcc, 3, v16
  v_mov_b32 v19, 1073741824
  s_nop 0
  v_cndmask_b32 v9, v19, v9, vcc
  s_mov_b32 s12, 2
  s_mov_b32 s32, -1
  s_mov_b32 s11, 0
  s_getpc_b64 s[36:37]
  s_setpc_b64 s[38:39]
  v_cmp_eq_u32 vcc, 0, v14
  s_cbranch_vccnz fa_yf_spin
fa_yf_ok:
fa_coY:
  s_ff1_i32_b32 s33, s10
  s_bitset0_b32 s10, s33
  s_sub_u32 s23, s10, 1
  s_and_b32 s10, s10, s23
  s_lshl_b32 s14, s33, 6
  s_mul_i32 s23, s22, 2560
  s_add_u32 s14, s14, s23
  s_add_u32 s14, s14, 2686976
  buffer_load_dwordx4 v[64:67], v9, s[40:43], s14 offen sc1
  s_add_u32 s14, s14, 20480
  buffer_load_dwordx4 v[68:71], v9, s[40:43], s14 offen sc1
  s_add_u32 s14, s14, 20480
  buffer_load_dwordx4 v[72:75], v9, s[40:43], s14 offen sc1
  s_add_u32 s14, s14, 20480
  buffer_load_dwordx4 v[76:79], v9, s[40:43], s14 offen sc1
  s_add_u32 s14, s14, 20480
  buffer_load_dwordx4 v[80:83], v9, s[40:43], s14 offen sc1
  s_add_u32 s14, s14, 20480
  buffer_load_dwordx4 v[84:87], v9, s[40:43], s14 offen sc1
  s_add_u32 s14, s14, 20480
  buffer_load_dwordx4 v[88:91], v9, s[40:43], s14 offen sc1
  s_add_u32 s14, s14, 20480
  buffer_load_dwordx4 v[92:95], v9, s[40:43], s14 offen sc1
  s_add_u32 s14, s14, 20480
  buffer_load_dwordx4 v[128:131], v9, s[40:43], s14 offen sc1
  s_add_u32 s14, s14, 20480
  buffer_load_dwordx4 v[132:135], v9, s[40:43], s14 offen sc1
  s_add_u32 s14, s14, 20480
  buffer_load_dwordx4 v[136:139], v9, s[40:43], s14 offen sc1
  s_add_u32 s14, s14, 20480
  buffer_load_dwordx4 v[140:143], v9, s[40:43], s14 offen sc1
  s_add_u32 s14, s14, 20480
  buffer_load_dwordx4 v[144:147], v9, s[40:43], s14 offen sc1
  s_add_u32 s14, s14, 20480
  buffer_load_dwordx4 v[148:151], v9, s[40:43], s14 offen sc1
  s_add_u32 s14, s14, 20480
  buffer_load_dwordx4 v[152:155], v9, s[40:43], s14 offen sc1
  s_add_u32 s14, s14, 20480
  buffer_load_dwordx4 v[156:159], v9, s[40:43], s14 offen sc1
  s_add_u32 s14, s14, 20480
  buffer_load_dwordx4 v[176:179], v9, s[40:43], s14 offen sc1
  s_add_u32 s14, s14, 20480
  buffer_load_dwordx4 v[180:183], v9, s[40:43], s14 offen sc1
  s_add_u32 s14, s14, 20480
  s_lshl_b32 s14, s20, 10
  s_add_u32 s14, s14, 159744
  v_add_u32 v19, s14, v2
  s_add_u32 s23, s33, 8
  v_readlane_b32 s35, v15, s23
  s_waitcnt vmcnt(0)
  v_pk_add_f32 v[64:65], v[64:65], v[68:69]
  v_pk_add_f32 v[66:67], v[66:67], v[70:71]
  v_pk_add_f32 v[64:65], v[64:65], v[72:73]
  v_pk_add_f32 v[66:67], v[66:67], v[74:75]
  v_pk_add_f32 v[64:65], v[64:65], v[76:77]
  v_pk_add_f32 v[66:67], v[66:67], v[78:79]
  v_pk_add_f32 v[64:65], v[64:65], v[80:81]
  v_pk_add_f32 v[66:67], v[66:67], v[82:83]
  v_pk_add_f32 v[64:65], v[64:65], v[84:85]
  v_pk_add_f32 v[66:67], v[66:67], v[86:87]
  v_pk_add_f32 v[64:65], v[64:65], v[88:89]
  v_pk_add_f32 v[66:67], v[66:67], v[90:91]
  v_pk_add_f32 v[64:65], v[64:65], v[92:93]
  v_pk_add_f32 v[66:67], v[66:67], v[94:95]
  v_pk_add_f32 v[64:65], v[64:65], v[128:129]
  v_pk_add_f32 v[66:67], v[66:67], v[130:131]
  v_pk_add_f32 v[64:65], v[64:65], v[132:133]
  v_pk_add_f32 v[66:67], v[66:67], v[134:135]
  v_pk_add_f32 v[64:65], v[64:65], v[136:137]
  v_pk_add_f32 v[66:67], v[66:67], v[138:139]
  v_pk_add_f32 v[64:65], v[64:65], v[140:141]
  v_pk_add_f32 v[66:67], v[66:67], v[142:143]
  v_pk_add_f32 v[64:65], v[64:65], v[144:145]
  v_pk_add_f32 v[66:67], v[66:67], v[146:147]
  v_pk_add_f32 v[64:65], v[64:65], v[148:149]
  v_pk_add_f32 v[66:67], v[66:67], v[150:151]
  v_pk_add_f32 v[64:65], v[64:65], v[152:153]
  v_pk_add_f32 v[66:67], v[66:67], v[154:155]
  v_pk_add_f32 v[64:65], v[64:65], v[156:157]
  v_pk_add_f32 v[66:67], v[66:67], v[158:159]
  v_pk_add_f32 v[64:65], v[64:65], v[176:177]
  v_pk_add_f32 v[66:67], v[66:67], v[178:179]
  v_pk_add_f32 v[64:65], v[64:65], v[180:181]
  v_pk_add_f32 v[66:67], v[66:67], v[182:183]
  ds_write_b128 v19, v[64:67]
  v_add_u32 v19, s14, v8
  s_and_b32 s35, s35, 0xffff0000
  s_waitcnt lgkmcnt(0)
  ds_read_b128 v[64:67], v19
  ds_read_b128 v[68:71], v19 offset:320
  ds_read_b128 v[72:75], v19 offset:640
  s_mul_i32 s14, s33, 320
  s_add_u32 s14, s14, 155648
  v_add_u32 v19, s14, v8
  s_waitcnt lgkmcnt(0)
  v_add_f32 v64, v64, v68
  v_add_f32 v64, v64, v72
  v_cvt_pk_bf16_f32 v64, v64, v64
  v_and_b32 v64, 0xffff0000, v64
  v_mul_f32 v64, s35, v64
  v_cvt_pk_bf16_f32 v64, v64, v64
  v_and_b32 v64, 0xffff0000, v64
  v_add_f32 v65, v65, v69
  v_add_f32 v65, v65, v73
  v_cvt_pk_bf16_f32 v65, v65, v65
  v_and_b32 v65, 0xffff0000, v65
  v_mul_f32 v65, s35, v65
  v_cvt_pk_bf16_f32 v65, v65, v65
  v_and_b32 v65, 0xffff0000, v65
  v_add_f32 v66, v66, v70
  v_add_f32 v66, v66, v74
  v_cvt_pk_bf16_f32 v66, v66, v66
  v_and_b32 v66, 0xffff0000, v66
  v_mul_f32 v66, s35, v66
  v_cvt_pk_bf16_f32 v66, v66, v66
  v_and_b32 v66, 0xffff0000, v66
  v_add_f32 v67, v67, v71
  v_add_f32 v67, v67, v75
  v_cvt_pk_bf16_f32 v67, v67, v67
  v_and_b32 v67, 0xffff0000, v67
  v_mul_f32 v67, s35, v67
  v_cvt_pk_bf16_f32 v67, v67, v67
  v_and_b32 v67, 0xffff0000, v67
  ds_write_b128 v19, v[64:67]
  s_waitcnt lgkmcnt(0)
  s_cmp_lg_u32 s10, 0
  s_cbranch_scc1 fa_coY
fa_coEnd:
  s_mov_b32 s12, 3
  s_mov_b32 s32, -1
  s_setpc_b64 s[38:39]
fa_hk7:
  s_getpc_b64 s[38:39]
fa_hp7:
  s_add_u32 s36, s36, 4
  s_addc_u32 s37, s37, 0
  s_sub_u32 s38, s38, fa_hp7-fa_hb7
  s_subb_u32 s39, s39, 0
  s_setpc_b64 s[36:37]
fa_hk8:
  s_getpc_b64 s[38:39]
fa_hp8:
  s_add_u32 s36, s36, 4
  s_addc_u32 s37, s37, 0
  s_sub_u32 s38, s38, fa_hp8-fa_hb8
  s_subb_u32 s39, s39, 0
  s_setpc_b64 s[36:37]
fa_disp:
  s_cmp_eq_u32 s29, 7
  s_cbranch_scc1 fa_SSW7
  s_cmp_eq_u32 s29, 6
  s_cbranch_scc1 fa_SSW6
  s_cmp_eq_u32 s29, 5
  s_cbranch_scc1 fa_SSW5
  s_cmp_eq_u32 s29, 4
  s_cbranch_scc1 fa_SSW4
  s_cmp_eq_u32 s29, 3
  s_cbranch_scc1 fa_SSW3
  s_cmp_eq_u32 s29, 2
  s_cbranch_scc1 fa_SSW2
  s_cmp_eq_u32 s29, 1
  s_cbranch_scc1 fa_SSW1
  s_branch fa_Bexit
fa_hk9:
  s_getpc_b64 s[38:39]
fa_hp9:
  s_add_u32 s36, s36, 4
  s_addc_u32 s37, s37, 0
  s_sub_u32 s38, s38, fa_hp9-fa_hb9
  s_subb_u32 s39, s39, 0
  s_setpc_b64 s[36:37]
fa_left:
  s_add_u32 s14, s13, 77824
  buffer_load_dwordx4 a[252:255], v2, s[40:43], s14 offen offset:3072 sc1
  buffer_load_dwordx4 a[248:251], v2, s[40:43], s14 offen offset:2048 sc1
  buffer_load_dwordx4 a[244:247], v2, s[40:43], s14 offen offset:1024 sc1
  s_cmp_ge_u32 s29, 7
  s_cbranch_scc1 fa_leftb
  s_add_u32 s14, s13, 77824
  buffer_load_dwordx4 a[240:243], v2, s[40:43], s14 offen offset:0 sc1
  s_add_u32 s14, s13, 73728
  buffer_load_dwordx4 a[236:239], v2, s[40:43], s14 offen offset:3072 sc1
  buffer_load_dwordx4 a[232:235], v2, s[40:43], s14 offen offset:2048 sc1
  s_cmp_ge_u32 s29, 6
  s_cbranch_scc1 fa_leftb
  s_add_u32 s14, s13, 73728
  buffer_load_dwordx4 a[228:231], v2, s[40:43], s14 offen offset:1024 sc1
  buffer_load_dwordx4 a[224:227], v2, s[40:43], s14 offen offset:0 sc1
  s_add_u32 s14, s13, 69632
  buffer_load_dwordx4 a[220:223], v2, s[40:43], s14 offen offset:3072 sc1
  buffer_load_dwordx4 a[216:219], v2, s[40:43], s14 offen offset:2048 sc1
  s_cmp_ge_u32 s29, 5
  s_cbranch_scc1 fa_leftb
  s_add_u32 s14, s13, 69632
  buffer_load_dwordx4 a[212:215], v2, s[40:43], s14 offen offset:1024 sc1
  buffer_load_dwordx4 a[208:211], v2, s[40:43], s14 offen offset:0 sc1
  s_add_u32 s14, s13, 61440
  buffer_load_dwordx4 a[204:207], v2, s[40:43], s14 offen offset:3072 sc1
  buffer_load_dwordx4 a[200:203], v2, s[40:43], s14 offen offset:2048 sc1
  buffer_load_dwordx4 a[196:199], v2, s[40:43], s14 offen offset:1024 sc1
  buffer_load_dwordx4 a[192:195], v2, s[40:43], s14 offen offset:0 sc1
  s_cmp_ge_u32 s29, 4
  s_cbranch_scc1 fa_leftb
  s_add_u32 s14, s13, 57344
  buffer_load_dwordx4 a[60:63], v2, s[40:43], s14 offen offset:3072 sc1
  buffer_load_dwordx4 a[56:59], v2, s[40:43], s14 offen offset:2048 sc1
  buffer_load_dwordx4 a[52:55], v2, s[40:43], s14 offen offset:1024 sc1
  buffer_load_dwordx4 a[48:51], v2, s[40:43], s14 offen offset:0 sc1
  s_add_u32 s14, s13, 45056
  buffer_load_dwordx4 a[44:47], v2, s[40:43], s14 offen offset:3072 sc1
  buffer_load_dwordx4 a[40:43], v2, s[40:43], s14 offen offset:2048 sc1
  buffer_load_dwordx4 a[36:39], v2, s[40:43], s14 offen offset:1024 sc1
  buffer_load_dwordx4 a[32:35], v2, s[40:43], s14 offen offset:0 sc1
  s_cmp_ge_u32 s29, 3
  s_cbranch_scc1 fa_leftb
  s_add_u32 s14, s13, 40960
  buffer_load_dwordx4 a[28:31], v2, s[40:43], s14 offen offset:3072 sc1
  buffer_load_dwordx4 a[24:27], v2, s[40:43], s14 offen offset:2048 sc1
  buffer_load_dwordx4 a[20:23], v2, s[40:43], s14 offen offset:1024 sc1
  buffer_load_dwordx4 a[16:19], v2, s[40:43], s14 offen offset:0 sc1
  s_add_u32 s14, s13, 28672
  buffer_load_dwordx4 a[12:15], v2, s[40:43], s14 offen offset:3072 sc1
  buffer_load_dwordx4 a[8:11], v2, s[40:43], s14 offen offset:2048 sc1
  buffer_load_dwordx4 a[4:7], v2, s[40:43], s14 offen offset:1024 sc1
  buffer_load_dwordx4 a[0:3], v2, s[40:43], s14 offen offset:0 sc1
  s_cmp_ge_u32 s29, 2
  s_cbranch_scc1 fa_leftb
  s_add_u32 s14, s13, 24576
  buffer_load_dwordx4 v[212:215], v2, s[40:43], s14 offen offset:3072 sc1
  buffer_load_dwordx4 v[208:211], v2, s[40:43], s14 offen offset:2048 sc1
  buffer_load_dwordx4 v[196:199], v2, s[40:43], s14 offen offset:1024 sc1
  buffer_load_dwordx4 v[192:195], v2, s[40:43], s14 offen offset:0 sc1
  s_add_u32 s14, s13, 20480
  buffer_load_dwordx4 v[244:247], v2, s[40:43], s14 offen offset:3072 sc1
  buffer_load_dwordx4 v[240:243], v2, s[40:43], s14 offen offset:2048 sc1
  buffer_load_dwordx4 v[236:239], v2, s[40:43], s14 offen offset:1024 sc1
  buffer_load_dwordx4 v[232:235], v2, s[40:43], s14 offen offset:0 sc1
  s_cmp_ge_u32 s29, 1
  s_cbranch_scc1 fa_leftb
  s_add_u32 s14, s13, 16384
  buffer_load_dwordx4 v[172:175], v2, s[40:43], s14 offen offset:3072 sc1
  buffer_load_dwordx4 v[168:171], v2, s[40:43], s14 offen offset:2048 sc1
  buffer_load_dwordx4 v[164:167], v2, s[40:43], s14 offen offset:1024 sc1
  buffer_load_dwordx4 v[160:163], v2, s[40:43], s14 offen offset:0 sc1
  s_add_u32 s14, s13, 12288
  buffer_load_dwordx4 v[124:127], v2, s[40:43], s14 offen offset:3072 sc1
  buffer_load_dwordx4 v[120:123], v2, s[40:43], s14 offen offset:2048 sc1
  buffer_load_dwordx4 v[116:119], v2, s[40:43], s14 offen offset:1024 sc1
  buffer_load_dwordx4 v[112:115], v2, s[40:43], s14 offen offset:0 sc1
  s_branch fa_leftb
fa_ctx_spin:
  s_mov_b32 s83, 200000
fa_ctx_spin2:
  buffer_load_dword v13, v12, s[40:43], 0 offen sc1
  s_waitcnt vmcnt(0)
  v_cmp_eq_u32 vcc, 0, v13
  s_cbranch_vccz fa_ctx_ok
  s_sleep 3
  s_sub_u32 s83, s83, 1
  s_cmp_lg_u32 s83, 0
  s_cbranch_scc1 fa_ctx_spin2
  s_branch fa_ctx_ok
fa_ctx2_spin:
  s_mov_b32 s83, 200000
fa_ctx2_spin2:
  buffer_load_dword v13, v10, s[40:43], 0 offen sc1
  s_waitcnt vmcnt(0)
  v_cmp_eq_u32 vcc, 0, v13
  s_cbranch_vccz fa_ctx2_ok
  s_sleep 3
  s_sub_u32 s83, s83, 1
  s_cmp_lg_u32 s83, 0
  s_cbranch_scc1 fa_ctx2_spin2
  s_branch fa_ctx2_ok
fa_px_spin:
  s_mov_b32 s83, 200000
fa_px_spin2:
  buffer_load_dword v13, v8, s[40:43], 0 offen sc1
  s_waitcnt vmcnt(0)
  v_cmp_eq_u32 vcc, 0, v13
  s_cbranch_vccz fa_px_ok
  s_sleep 3
  s_sub_u32 s83, s83, 1
  s_cmp_lg_u32 s83, 0
  s_cbranch_scc1 fa_px_spin2
  s_branch fa_px_ok
fa_stub0:
  s_call_b64 s[76:77], fa_rare00
  s_call_b64 s[76:77], fa_rare10
  s_branch fa_back0
fa_stub1:
  s_call_b64 s[76:77], fa_rare01
  s_call_b64 s[76:77], fa_rare11
  s_branch fa_back1
fa_stub2:
  s_call_b64 s[76:77], fa_rare00
  s_call_b64 s[76:77], fa_rare10
  s_branch fa_back2
fa_stub3:
  s_call_b64 s[76:77], fa_rare01
  s_call_b64 s[76:77], fa_rare11
  s_branch fa_back3
fa_stub4:
  s_call_b64 s[76:77], fa_rare01
  s_call_b64 s[76:77], fa_rare11
  s_branch fa_back4
fa_stub5:
  s_call_b64 s[76:77], fa_rare00
  s_call_b64 s[76:77], fa_rare10
  s_branch fa_back5
fa_stub6:
  s_call_b64 s[76:77], fa_rare11
  s_branch fa_back6
fa_stub7:
  s_call_b64 s[76:77], fa_rare10
  s_branch fa_back7
fa_stub8:
  s_call_b64 s[76:77], fa_rare01
  s_call_b64 s[76:77], fa_rare11
  s_branch fa_back8
fa_stub9:
  s_call_b64 s[76:77], fa_rare10
  s_branch fa_back9
fa_stub10:
  s_call_b64 s[76:77], fa_rare11
  s_branch fa_back10
fa_stub11:
  s_call_b64 s[76:77], fa_rare10
  s_branch fa_back11
fa_stub12:
  s_call_b64 s[76:77], fa_rare11
  s_branch fa_back12
fa_stub13:
  s_call_b64 s[76:77], fa_rare10
  s_branch fa_back13
fa_stub14:
  s_call_b64 s[76:77], fa_rare11
  s_branch fa_back14
fa_stub15:
  s_call_b64 s[76:77], fa_rare10
  s_branch fa_back15
fa_stub16:
  s_call_b64 s[76:77], fa_rare11
  s_branch fa_back16
fa_stub17:
  s_call_b64 s[76:77], fa_rare10
  s_branch fa_back17
fa_stub18:
  s_call_b64 s[76:77], fa_rare11
  s_branch fa_back18
fa_stub19:
  s_call_b64 s[76:77], fa_rare10
  s_branch fa_back19
fa_stub20:
  s_call_b64 s[76:77], fa_rare11
  s_branch fa_back20
fa_stub21:
  s_call_b64 s[76:77], fa_rare10
  s_branch fa_back21
fa_stub22:
  s_call_b64 s[76:77], fa_rare11
  s_branch fa_back22
fa_stub23:
  s_call_b64 s[76:77], fa_rare10
  s_branch fa_back23
fa_stub24:
  s_call_b64 s[76:77], fa_rare11
  s_branch fa_back24
fa_stub25:
  s_call_b64 s[76:77], fa_rare10
  s_branch fa_back25
fa_stub26:
  s_call_b64 s[76:77], fa_rare11
  s_branch fa_back26
fa_stub27:
  s_call_b64 s[76:77], fa_rare10
  s_branch fa_back27
fa_stub28:
  s_call_b64 s[76:77], fa_rare11
  s_branch fa_back28
fa_stub29:
  s_call_b64 s[76:77], fa_rare10
  s_branch fa_back29
fa_stub30:
  s_call_b64 s[76:77], fa_rare11
  s_branch fa_back30
fa_codeend:
fa_rare00:
  s_nop 7
  v_max3_f32 v16, v96, v97, v98
  v_max3_f32 v16, v16, v99, v100
  v_max3_f32 v16, v16, v101, v102
  v_max3_f32 v16, v16, v103, 0
  v_mov_b32 v18, v16
  s_nop 1
  v_permlane16_swap_b32 v16, v18
  v_max_f32 v16, v16, v18
  v_mov_b32 v18, v16
  s_nop 1
  v_permlane32_swap_b32 v16, v18
  v_max_f32 v16, v16, v18
  v_sub_f32 v96, v96, v16
  v_sub_f32 v112, v112, v16
  v_sub_f32 v97, v97, v16
  v_sub_f32 v113, v113, v16
  v_sub_f32 v98, v98, v16
  v_sub_f32 v114, v114, v16
  v_sub_f32 v99, v99, v16
  v_sub_f32 v115, v115, v16
  v_sub_f32 v100, v100, v16
  v_sub_f32 v116, v116, v16
  v_sub_f32 v101, v101, v16
  v_sub_f32 v117, v117, v16
  v_sub_f32 v102, v102, v16
  v_sub_f32 v118, v118, v16
  v_sub_f32 v103, v103, v16
  v_sub_f32 v119, v119, v16
  v_max3_f32 v17, v104, v105, v106
  v_max3_f32 v17, v17, v107, v108
  v_max3_f32 v17, v17, v109, v110
  v_max3_f32 v17, v17, v111, 0
  v_mov_b32 v18, v17
  s_nop 1
  v_permlane16_swap_b32 v17, v18
  v_max_f32 v17, v17, v18
  v_mov_b32 v18, v17
  s_nop 1
  v_permlane32_swap_b32 v17, v18
  v_max_f32 v17, v17, v18
  v_sub_f32 v104, v104, v17
  v_sub_f32 v120, v120, v17
  v_sub_f32 v105, v105, v17
  v_sub_f32 v121, v121, v17
  v_sub_f32 v106, v106, v17
  v_sub_f32 v122, v122, v17
  v_sub_f32 v107, v107, v17
  v_sub_f32 v123, v123, v17
  v_sub_f32 v108, v108, v17
  v_sub_f32 v124, v124, v17
  v_sub_f32 v109, v109, v17
  v_sub_f32 v125, v125, v17
  v_sub_f32 v110, v110, v17
  v_sub_f32 v126, v126, v17
  v_sub_f32 v111, v111, v17
  v_sub_f32 v127, v127, v17
  s_call_b64 s[78:79], fa_resc0
  v_exp_f32 v208, v96
  v_exp_f32 v209, v97
  v_exp_f32 v210, v98
  v_add_f32 v224, v208, v209
  v_cvt_pk_bf16_f32 v160, v208, v209
  v_exp_f32 v211, v99
  v_add_f32 v224, v224, v210
  v_exp_f32 v212, v100
  v_add_f32 v224, v224, v211
  v_cvt_pk_bf16_f32 v161, v210, v211
  v_exp_f32 v213, v101
  v_add_f32 v224, v224, v212
  v_exp_f32 v214, v102
  v_add_f32 v224, v224, v213
  v_cvt_pk_bf16_f32 v162, v212, v213
  v_exp_f32 v215, v103
  v_add_f32 v224, v224, v214
  v_exp_f32 v208, v104
  v_add_f32 v224, v224, v215
  v_cvt_pk_bf16_f32 v163, v214, v215
  v_exp_f32 v209, v105
  v_exp_f32 v210, v106
  v_add_f32 v225, v208, v209
  v_cvt_pk_bf16_f32 v164, v208, v209
  v_exp_f32 v211, v107
  v_add_f32 v225, v225, v210
  v_exp_f32 v212, v108
  v_add_f32 v225, v225, v211
  v_cvt_pk_bf16_f32 v165, v210, v211
  v_exp_f32 v213, v109
  v_add_f32 v225, v225, v212
  v_exp_f32 v214, v110
  v_add_f32 v225, v225, v213
  v_cvt_pk_bf16_f32 v166, v212, v213
  v_exp_f32 v215, v111
  v_add_f32 v225, v225, v214
  s_nop 0
  v_add_f32 v225, v225, v215
  v_cvt_pk_bf16_f32 v167, v214, v215
  s_nop 1
  s_setpc_b64 s[76:77]
fa_rare01:
  s_nop 7
  v_max3_f32 v16, v112, v113, v114
  v_max3_f32 v16, v16, v115, v116
  v_max3_f32 v16, v16, v117, v118
  v_max3_f32 v16, v16, v119, 0
  v_mov_b32 v18, v16
  s_nop 1
  v_permlane16_swap_b32 v16, v18
  v_max_f32 v16, v16, v18
  v_mov_b32 v18, v16
  s_nop 1
  v_permlane32_swap_b32 v16, v18
  v_max_f32 v16, v16, v18
  v_sub_f32 v112, v112, v16
  v_sub_f32 v96, v96, v16
  v_sub_f32 v113, v113, v16
  v_sub_f32 v97, v97, v16
  v_sub_f32 v114, v114, v16
  v_sub_f32 v98, v98, v16
  v_sub_f32 v115, v115, v16
  v_sub_f32 v99, v99, v16
  v_sub_f32 v116, v116, v16
  v_sub_f32 v100, v100, v16
  v_sub_f32 v117, v117, v16
  v_sub_f32 v101, v101, v16
  v_sub_f32 v118, v118, v16
  v_sub_f32 v102, v102, v16
  v_sub_f32 v119, v119, v16
  v_sub_f32 v103, v103, v16
  v_max3_f32 v17, v120, v121, v122
  v_max3_f32 v17, v17, v123, v124
  v_max3_f32 v17, v17, v125, v126
  v_max3_f32 v17, v17, v127, 0
  v_mov_b32 v18, v17
  s_nop 1
  v_permlane16_swap_b32 v17, v18
  v_max_f32 v17, v17, v18
  v_mov_b32 v18, v17
  s_nop 1
  v_permlane32_swap_b32 v17, v18
  v_max_f32 v17, v17, v18
  v_sub_f32 v120, v120, v17
  v_sub_f32 v104, v104, v17
  v_sub_f32 v121, v121, v17
  v_sub_f32 v105, v105, v17
  v_sub_f32 v122, v122, v17
  v_sub_f32 v106, v106, v17
  v_sub_f32 v123, v123, v17
  v_sub_f32 v107, v107, v17
  v_sub_f32 v124, v124, v17
  v_sub_f32 v108, v108, v17
  v_sub_f32 v125, v125, v17
  v_sub_f32 v109, v109, v17
  v_sub_f32 v126, v126, v17
  v_sub_f32 v110, v110, v17
  v_sub_f32 v127, v127, v17
  v_sub_f32 v111, v111, v17
  s_call_b64 s[78:79], fa_resc0
  v_exp_f32 v208, v112
  v_exp_f32 v209, v113
  v_exp_f32 v210, v114
  v_add_f32 v224, v208, v209
  v_cvt_pk_bf16_f32 v168, v208, v209
  v_exp_f32 v211, v115
  v_add_f32 v224, v224, v210
  v_exp_f32 v212, v116
  v_add_f32 v224, v224, v211
  v_cvt_pk_bf16_f32 v169, v210, v211
  v_exp_f32 v213, v117
  v_add_f32 v224, v224, v212
  v_exp_f32 v214, v118
  v_add_f32 v224, v224, v213
  v_cvt_pk_bf16_f32 v170, v212, v213
  v_exp_f32 v215, v119
  v_add_f32 v224, v224, v214
  v_exp_f32 v208, v120
  v_add_f32 v224, v224, v215
  v_cvt_pk_bf16_f32 v171, v214, v215
  v_exp_f32 v209, v121
  v_exp_f32 v210, v122
  v_add_f32 v225, v208, v209
  v_cvt_pk_bf16_f32 v172, v208, v209
  v_exp_f32 v211, v123
  v_add_f32 v225, v225, v210
  v_exp_f32 v212, v124
  v_add_f32 v225, v225, v211
  v_cvt_pk_bf16_f32 v173, v210, v211
  v_exp_f32 v213, v125
  v_add_f32 v225, v225, v212
  v_exp_f32 v214, v126
  v_add_f32 v225, v225, v213
  v_cvt_pk_bf16_f32 v174, v212, v213
  v_exp_f32 v215, v127
  v_add_f32 v225, v225, v214
  s_nop 0
  v_add_f32 v225, v225, v215
  v_cvt_pk_bf16_f32 v175, v214, v215
  s_nop 1
  s_setpc_b64 s[76:77]
fa_resc0:
  v_sub_f32 v192, v192, v16
  v_sub_f32 v193, v193, v16
  v_sub_f32 v194, v194, v16
  v_sub_f32 v195, v195, v16
  v_exp_f32 v18, -v16
  v_sub_f32 v196, v196, v17
  v_sub_f32 v197, v197, v17
  v_sub_f32 v198, v198, v17
  v_sub_f32 v199, v199, v17
  v_exp_f32 v19, -v17
  s_nop 0
  v_mul_f32 v228, v228, v18
  v_mul_f32 v229, v229, v19
  v_accvgpr_read_b32 v20, a0
  v_accvgpr_read_b32 v21, a1
  v_accvgpr_read_b32 v22, a2
  v_accvgpr_read_b32 v23, a3
  v_mul_f32 v20, v20, v18
  v_mul_f32 v21, v21, v18
  v_mul_f32 v22, v22, v18
  v_mul_f32 v23, v23, v18
  v_accvgpr_write_b32 a0, v20
  v_accvgpr_write_b32 a1, v21
  v_accvgpr_write_b32 a2, v22
  v_accvgpr_write_b32 a3, v23
  v_accvgpr_read_b32 v20, a4
  v_accvgpr_read_b32 v21, a5
  v_accvgpr_read_b32 v22, a6
  v_accvgpr_read_b32 v23, a7
  v_mul_f32 v20, v20, v19
  v_mul_f32 v21, v21, v19
  v_mul_f32 v22, v22, v19
  v_mul_f32 v23, v23, v19
  v_accvgpr_write_b32 a4, v20
  v_accvgpr_write_b32 a5, v21
  v_accvgpr_write_b32 a6, v22
  v_accvgpr_write_b32 a7, v23
  v_accvgpr_read_b32 v20, a8
  v_accvgpr_read_b32 v21, a9
  v_accvgpr_read_b32 v22, a10
  v_accvgpr_read_b32 v23, a11
  v_mul_f32 v20, v20, v18
  v_mul_f32 v21, v21, v18
  v_mul_f32 v22, v22, v18
  v_mul_f32 v23, v23, v18
  v_accvgpr_write_b32 a8, v20
  v_accvgpr_write_b32 a9, v21
  v_accvgpr_write_b32 a10, v22
  v_accvgpr_write_b32 a11, v23
  v_accvgpr_read_b32 v20, a12
  v_accvgpr_read_b32 v21, a13
  v_accvgpr_read_b32 v22, a14
  v_accvgpr_read_b32 v23, a15
  v_mul_f32 v20, v20, v19
  v_mul_f32 v21, v21, v19
  v_mul_f32 v22, v22, v19
  v_mul_f32 v23, v23, v19
  v_accvgpr_write_b32 a12, v20
  v_accvgpr_write_b32 a13, v21
  v_accvgpr_write_b32 a14, v22
  v_accvgpr_write_b32 a15, v23
  v_accvgpr_read_b32 v20, a16
  v_accvgpr_read_b32 v21, a17
  v_accvgpr_read_b32 v22, a18
  v_accvgpr_read_b32 v23, a19
  v_mul_f32 v20, v20, v18
  v_mul_f32 v21, v21, v18
  v_mul_f32 v22, v22, v18
  v_mul_f32 v23, v23, v18
  v_accvgpr_write_b32 a16, v20
  v_accvgpr_write_b32 a17, v21
  v_accvgpr_write_b32 a18, v22
  v_accvgpr_write_b32 a19, v23
  v_accvgpr_read_b32 v20, a20
  v_accvgpr_read_b32 v21, a21
  v_accvgpr_read_b32 v22, a22
  v_accvgpr_read_b32 v23, a23
  v_mul_f32 v20, v20, v19
  v_mul_f32 v21, v21, v19
  v_mul_f32 v22, v22, v19
  v_mul_f32 v23, v23, v19
  v_accvgpr_write_b32 a20, v20
  v_accvgpr_write_b32 a21, v21
  v_accvgpr_write_b32 a22, v22
  v_accvgpr_write_b32 a23, v23
  v_accvgpr_read_b32 v20, a24
  v_accvgpr_read_b32 v21, a25
  v_accvgpr_read_b32 v22, a26
  v_accvgpr_read_b32 v23, a27
  v_mul_f32 v20, v20, v18
  v_mul_f32 v21, v21, v18
  v_mul_f32 v22, v22, v18
  v_mul_f32 v23, v23, v18
  v_accvgpr_write_b32 a24, v20
  v_accvgpr_write_b32 a25, v21
  v_accvgpr_write_b32 a26, v22
  v_accvgpr_write_b32 a27, v23
  v_accvgpr_read_b32 v20, a28
  v_accvgpr_read_b32 v21, a29
  v_accvgpr_read_b32 v22, a30
  v_accvgpr_read_b32 v23, a31
  v_mul_f32 v20, v20, v19
  v_mul_f32 v21, v21, v19
  v_mul_f32 v22, v22, v19
  v_mul_f32 v23, v23, v19
  v_accvgpr_write_b32 a28, v20
  v_accvgpr_write_b32 a29, v21
  v_accvgpr_write_b32 a30, v22
  v_accvgpr_write_b32 a31, v23
  v_accvgpr_read_b32 v20, a32
  v_accvgpr_read_b32 v21, a33
  v_accvgpr_read_b32 v22, a34
  v_accvgpr_read_b32 v23, a35
  v_mul_f32 v20, v20, v18
  v_mul_f32 v21, v21, v18
  v_mul_f32 v22, v22, v18
  v_mul_f32 v23, v23, v18
  v_accvgpr_write_b32 a32, v20
  v_accvgpr_write_b32 a33, v21
  v_accvgpr_write_b32 a34, v22
  v_accvgpr_write_b32 a35, v23
  v_accvgpr_read_b32 v20, a36
  v_accvgpr_read_b32 v21, a37
  v_accvgpr_read_b32 v22, a38
  v_accvgpr_read_b32 v23, a39
  v_mul_f32 v20, v20, v19
  v_mul_f32 v21, v21, v19
  v_mul_f32 v22, v22, v19
  v_mul_f32 v23, v23, v19
  v_accvgpr_write_b32 a36, v20
  v_accvgpr_write_b32 a37, v21
  v_accvgpr_write_b32 a38, v22
  v_accvgpr_write_b32 a39, v23
  v_accvgpr_read_b32 v20, a40
  v_accvgpr_read_b32 v21, a41
  v_accvgpr_read_b32 v22, a42
  v_accvgpr_read_b32 v23, a43
  v_mul_f32 v20, v20, v18
  v_mul_f32 v21, v21, v18
  v_mul_f32 v22, v22, v18
  v_mul_f32 v23, v23, v18
  v_accvgpr_write_b32 a40, v20
  v_accvgpr_write_b32 a41, v21
  v_accvgpr_write_b32 a42, v22
  v_accvgpr_write_b32 a43, v23
  v_accvgpr_read_b32 v20, a44
  v_accvgpr_read_b32 v21, a45
  v_accvgpr_read_b32 v22, a46
  v_accvgpr_read_b32 v23, a47
  v_mul_f32 v20, v20, v19
  v_mul_f32 v21, v21, v19
  v_mul_f32 v22, v22, v19
  v_mul_f32 v23, v23, v19
  v_accvgpr_write_b32 a44, v20
  v_accvgpr_write_b32 a45, v21
  v_accvgpr_write_b32 a46, v22
  v_accvgpr_write_b32 a47, v23
  v_accvgpr_read_b32 v20, a48
  v_accvgpr_read_b32 v21, a49
  v_accvgpr_read_b32 v22, a50
  v_accvgpr_read_b32 v23, a51
  v_mul_f32 v20, v20, v18
  v_mul_f32 v21, v21, v18
  v_mul_f32 v22, v22, v18
  v_mul_f32 v23, v23, v18
  v_accvgpr_write_b32 a48, v20
  v_accvgpr_write_b32 a49, v21
  v_accvgpr_write_b32 a50, v22
  v_accvgpr_write_b32 a51, v23
  v_accvgpr_read_b32 v20, a52
  v_accvgpr_read_b32 v21, a53
  v_accvgpr_read_b32 v22, a54
  v_accvgpr_read_b32 v23, a55
  v_mul_f32 v20, v20, v19
  v_mul_f32 v21, v21, v19
  v_mul_f32 v22, v22, v19
  v_mul_f32 v23, v23, v19
  v_accvgpr_write_b32 a52, v20
  v_accvgpr_write_b32 a53, v21
  v_accvgpr_write_b32 a54, v22
  v_accvgpr_write_b32 a55, v23
  v_accvgpr_read_b32 v20, a56
  v_accvgpr_read_b32 v21, a57
  v_accvgpr_read_b32 v22, a58
  v_accvgpr_read_b32 v23, a59
  v_mul_f32 v20, v20, v18
  v_mul_f32 v21, v21, v18
  v_mul_f32 v22, v22, v18
  v_mul_f32 v23, v23, v18
  v_accvgpr_write_b32 a56, v20
  v_accvgpr_write_b32 a57, v21
  v_accvgpr_write_b32 a58, v22
  v_accvgpr_write_b32 a59, v23
  v_accvgpr_read_b32 v20, a60
  v_accvgpr_read_b32 v21, a61
  v_accvgpr_read_b32 v22, a62
  v_accvgpr_read_b32 v23, a63
  v_mul_f32 v20, v20, v19
  v_mul_f32 v21, v21, v19
  v_mul_f32 v22, v22, v19
  v_mul_f32 v23, v23, v19
  v_accvgpr_write_b32 a60, v20
  v_accvgpr_write_b32 a61, v21
  v_accvgpr_write_b32 a62, v22
  v_accvgpr_write_b32 a63, v23
  s_setpc_b64 s[78:79]
fa_rare10:
  s_nop 7
  v_max3_f32 v16, v128, v129, v130
  v_max3_f32 v16, v16, v131, v132
  v_max3_f32 v16, v16, v133, v134
  v_max3_f32 v16, v16, v135, 0
  v_mov_b32 v18, v16
  s_nop 1
  v_permlane16_swap_b32 v16, v18
  v_max_f32 v16, v16, v18
  v_mov_b32 v18, v16
  s_nop 1
  v_permlane32_swap_b32 v16, v18
  v_max_f32 v16, v16, v18
  v_sub_f32 v128, v128, v16
  v_sub_f32 v144, v144, v16
  v_sub_f32 v129, v129, v16
  v_sub_f32 v145, v145, v16
  v_sub_f32 v130, v130, v16
  v_sub_f32 v146, v146, v16
  v_sub_f32 v131, v131, v16
  v_sub_f32 v147, v147, v16
  v_sub_f32 v132, v132, v16
  v_sub_f32 v148, v148, v16
  v_sub_f32 v133, v133, v16
  v_sub_f32 v149, v149, v16
  v_sub_f32 v134, v134, v16
  v_sub_f32 v150, v150, v16
  v_sub_f32 v135, v135, v16
  v_sub_f32 v151, v151, v16
  v_max3_f32 v17, v136, v137, v138
  v_max3_f32 v17, v17, v139, v140
  v_max3_f32 v17, v17, v141, v142
  v_max3_f32 v17, v17, v143, 0
  v_mov_b32 v18, v17
  s_nop 1
  v_permlane16_swap_b32 v17, v18
  v_max_f32 v17, v17, v18
  v_mov_b32 v18, v17
  s_nop 1
  v_permlane32_swap_b32 v17, v18
  v_max_f32 v17, v17, v18
  v_sub_f32 v136, v136, v17
  v_sub_f32 v152, v152, v17
  v_sub_f32 v137, v137, v17
  v_sub_f32 v153, v153, v17
  v_sub_f32 v138, v138, v17
  v_sub_f32 v154, v154, v17
  v_sub_f32 v139, v139, v17
  v_sub_f32 v155, v155, v17
  v_sub_f32 v140, v140, v17
  v_sub_f32 v156, v156, v17
  v_sub_f32 v141, v141, v17
  v_sub_f32 v157, v157, v17
  v_sub_f32 v142, v142, v17
  v_sub_f32 v158, v158, v17
  v_sub_f32 v143, v143, v17
  v_sub_f32 v159, v159, v17
  s_call_b64 s[78:79], fa_resc1
  v_exp_f32 v216, v128
  v_exp_f32 v217, v129
  v_exp_f32 v218, v130
  v_add_f32 v226, v216, v217
  v_cvt_pk_bf16_f32 v176, v216, v217
  v_exp_f32 v219, v131
  v_add_f32 v226, v226, v218
  v_exp_f32 v220, v132
  v_add_f32 v226, v226, v219
  v_cvt_pk_bf16_f32 v177, v218, v219
  v_exp_f32 v221, v133
  v_add_f32 v226, v226, v220
  v_exp_f32 v222, v134
  v_add_f32 v226, v226, v221
  v_cvt_pk_bf16_f32 v178, v220, v221
  v_exp_f32 v223, v135
  v_add_f32 v226, v226, v222
  v_exp_f32 v216, v136
  v_add_f32 v226, v226, v223
  v_cvt_pk_bf16_f32 v179, v222, v223
  v_exp_f32 v217, v137
  v_exp_f32 v218, v138
  v_add_f32 v227, v216, v217
  v_cvt_pk_bf16_f32 v180, v216, v217
  v_exp_f32 v219, v139
  v_add_f32 v227, v227, v218
  v_exp_f32 v220, v140
  v_add_f32 v227, v227, v219
  v_cvt_pk_bf16_f32 v181, v218, v219
  v_exp_f32 v221, v141
  v_add_f32 v227, v227, v220
  v_exp_f32 v222, v142
  v_add_f32 v227, v227, v221
  v_cvt_pk_bf16_f32 v182, v220, v221
  v_exp_f32 v223, v143
  v_add_f32 v227, v227, v222
  s_nop 0
  v_add_f32 v227, v227, v223
  v_cvt_pk_bf16_f32 v183, v222, v223
  v_exp_f32 v216, v144
  s_nop 1
  s_setpc_b64 s[76:77]
fa_rare11:
  s_nop 7
  v_max3_f32 v16, v144, v145, v146
  v_max3_f32 v16, v16, v147, v148
  v_max3_f32 v16, v16, v149, v150
  v_max3_f32 v16, v16, v151, 0
  v_mov_b32 v18, v16
  s_nop 1
  v_permlane16_swap_b32 v16, v18
  v_max_f32 v16, v16, v18
  v_mov_b32 v18, v16
  s_nop 1
  v_permlane32_swap_b32 v16, v18
  v_max_f32 v16, v16, v18
  v_sub_f32 v144, v144, v16
  v_sub_f32 v128, v128, v16
  v_sub_f32 v145, v145, v16
  v_sub_f32 v129, v129, v16
  v_sub_f32 v146, v146, v16
  v_sub_f32 v130, v130, v16
  v_sub_f32 v147, v147, v16
  v_sub_f32 v131, v131, v16
  v_sub_f32 v148, v148, v16
  v_sub_f32 v132, v132, v16
  v_sub_f32 v149, v149, v16
  v_sub_f32 v133, v133, v16
  v_sub_f32 v150, v150, v16
  v_sub_f32 v134, v134, v16
  v_sub_f32 v151, v151, v16
  v_sub_f32 v135, v135, v16
  v_max3_f32 v17, v152, v153, v154
  v_max3_f32 v17, v17, v155, v156
  v_max3_f32 v17, v17, v157, v158
  v_max3_f32 v17, v17, v159, 0
  v_mov_b32 v18, v17
  s_nop 1
  v_permlane16_swap_b32 v17, v18
  v_max_f32 v17, v17, v18
  v_mov_b32 v18, v17
  s_nop 1
  v_permlane32_swap_b32 v17, v18
  v_max_f32 v17, v17, v18
  v_sub_f32 v152, v152, v17
  v_sub_f32 v136, v136, v17
  v_sub_f32 v153, v153, v17
  v_sub_f32 v137, v137, v17
  v_sub_f32 v154, v154, v17
  v_sub_f32 v138, v138, v17
  v_sub_f32 v155, v155, v17
  v_sub_f32 v139, v139, v17
  v_sub_f32 v156, v156, v17
  v_sub_f32 v140, v140, v17
  v_sub_f32 v157, v157, v17
  v_sub_f32 v141, v141, v17
  v_sub_f32 v158, v158, v17
  v_sub_f32 v142, v142, v17
  v_sub_f32 v159, v159, v17
  v_sub_f32 v143, v143, v17
  s_call_b64 s[78:79], fa_resc1
  v_exp_f32 v216, v144
  v_exp_f32 v217, v145
  v_exp_f32 v218, v146
  v_add_f32 v226, v216, v217
  v_cvt_pk_bf16_f32 v184, v216, v217
  v_exp_f32 v219, v147
  v_add_f32 v226, v226, v218
  v_exp_f32 v220, v148
  v_add_f32 v226, v226, v219
  v_cvt_pk_bf16_f32 v185, v218, v219
  v_exp_f32 v221, v149
  v_add_f32 v226, v226, v220
  v_exp_f32 v222, v150
  v_add_f32 v226, v226, v221
  v_cvt_pk_bf16_f32 v186, v220, v221
  v_exp_f32 v223, v151
  v_add_f32 v226, v226, v222
  v_exp_f32 v216, v152
  v_add_f32 v226, v226, v223
  v_cvt_pk_bf16_f32 v187, v222, v223
  v_exp_f32 v217, v153
  v_exp_f32 v218, v154
  v_add_f32 v227, v216, v217
  v_cvt_pk_bf16_f32 v188, v216, v217
  v_exp_f32 v219, v155
  v_add_f32 v227, v227, v218
  v_exp_f32 v220, v156
  v_add_f32 v227, v227, v219
  v_cvt_pk_bf16_f32 v189, v218, v219
  v_exp_f32 v221, v157
  v_add_f32 v227, v227, v220
  v_exp_f32 v222, v158
  v_add_f32 v227, v227, v221
  v_cvt_pk_bf16_f32 v190, v220, v221
  v_exp_f32 v223, v159
  v_add_f32 v227, v227, v222
  s_nop 0
  v_add_f32 v227, v227, v223
  v_cvt_pk_bf16_f32 v191, v222, v223
  v_exp_f32 v216, v128
  s_nop 1
  s_setpc_b64 s[76:77]
fa_resc1:
  v_sub_f32 v200, v200, v16
  v_sub_f32 v201, v201, v16
  v_sub_f32 v202, v202, v16
  v_sub_f32 v203, v203, v16
  v_exp_f32 v18, -v16
  v_sub_f32 v204, v204, v17
  v_sub_f32 v205, v205, v17
  v_sub_f32 v206, v206, v17
  v_sub_f32 v207, v207, v17
  v_exp_f32 v19, -v17
  s_nop 0
  v_mul_f32 v230, v230, v18
  v_mul_f32 v231, v231, v19
  v_accvgpr_read_b32 v20, a64
  v_accvgpr_read_b32 v21, a65
  v_accvgpr_read_b32 v22, a66
  v_accvgpr_read_b32 v23, a67
  v_mul_f32 v20, v20, v18
  v_mul_f32 v21, v21, v18
  v_mul_f32 v22, v22, v18
  v_mul_f32 v23, v23, v18
  v_accvgpr_write_b32 a64, v20
  v_accvgpr_write_b32 a65, v21
  v_accvgpr_write_b32 a66, v22
  v_accvgpr_write_b32 a67, v23
  v_accvgpr_read_b32 v20, a68
  v_accvgpr_read_b32 v21, a69
  v_accvgpr_read_b32 v22, a70
  v_accvgpr_read_b32 v23, a71
  v_mul_f32 v20, v20, v19
  v_mul_f32 v21, v21, v19
  v_mul_f32 v22, v22, v19
  v_mul_f32 v23, v23, v19
  v_accvgpr_write_b32 a68, v20
  v_accvgpr_write_b32 a69, v21
  v_accvgpr_write_b32 a70, v22
  v_accvgpr_write_b32 a71, v23
  v_accvgpr_read_b32 v20, a72
  v_accvgpr_read_b32 v21, a73
  v_accvgpr_read_b32 v22, a74
  v_accvgpr_read_b32 v23, a75
  v_mul_f32 v20, v20, v18
  v_mul_f32 v21, v21, v18
  v_mul_f32 v22, v22, v18
  v_mul_f32 v23, v23, v18
  v_accvgpr_write_b32 a72, v20
  v_accvgpr_write_b32 a73, v21
  v_accvgpr_write_b32 a74, v22
  v_accvgpr_write_b32 a75, v23
  v_accvgpr_read_b32 v20, a76
  v_accvgpr_read_b32 v21, a77
  v_accvgpr_read_b32 v22, a78
  v_accvgpr_read_b32 v23, a79
  v_mul_f32 v20, v20, v19
  v_mul_f32 v21, v21, v19
  v_mul_f32 v22, v22, v19
  v_mul_f32 v23, v23, v19
  v_accvgpr_write_b32 a76, v20
  v_accvgpr_write_b32 a77, v21
  v_accvgpr_write_b32 a78, v22
  v_accvgpr_write_b32 a79, v23
  v_accvgpr_read_b32 v20, a80
  v_accvgpr_read_b32 v21, a81
  v_accvgpr_read_b32 v22, a82
  v_accvgpr_read_b32 v23, a83
  v_mul_f32 v20, v20, v18
  v_mul_f32 v21, v21, v18
  v_mul_f32 v22, v22, v18
  v_mul_f32 v23, v23, v18
  v_accvgpr_write_b32 a80, v20
  v_accvgpr_write_b32 a81, v21
  v_accvgpr_write_b32 a82, v22
  v_accvgpr_write_b32 a83, v23
  v_accvgpr_read_b32 v20, a84
  v_accvgpr_read_b32 v21, a85
  v_accvgpr_read_b32 v22, a86
  v_accvgpr_read_b32 v23, a87
  v_mul_f32 v20, v20, v19
  v_mul_f32 v21, v21, v19
  v_mul_f32 v22, v22, v19
  v_mul_f32 v23, v23, v19
  v_accvgpr_write_b32 a84, v20
  v_accvgpr_write_b32 a85, v21
  v_accvgpr_write_b32 a86, v22
  v_accvgpr_write_b32 a87, v23
  v_accvgpr_read_b32 v20, a88
  v_accvgpr_read_b32 v21, a89
  v_accvgpr_read_b32 v22, a90
  v_accvgpr_read_b32 v23, a91
  v_mul_f32 v20, v20, v18
  v_mul_f32 v21, v21, v18
  v_mul_f32 v22, v22, v18
  v_mul_f32 v23, v23, v18
  v_accvgpr_write_b32 a88, v20
  v_accvgpr_write_b32 a89, v21
  v_accvgpr_write_b32 a90, v22
  v_accvgpr_write_b32 a91, v23
  v_accvgpr_read_b32 v20, a92
  v_accvgpr_read_b32 v21, a93
  v_accvgpr_read_b32 v22, a94
  v_accvgpr_read_b32 v23, a95
  v_mul_f32 v20, v20, v19
  v_mul_f32 v21, v21, v19
  v_mul_f32 v22, v22, v19
  v_mul_f32 v23, v23, v19
  v_accvgpr_write_b32 a92, v20
  v_accvgpr_write_b32 a93, v21
  v_accvgpr_write_b32 a94, v22
  v_accvgpr_write_b32 a95, v23
  v_accvgpr_read_b32 v20, a96
  v_accvgpr_read_b32 v21, a97
  v_accvgpr_read_b32 v22, a98
  v_accvgpr_read_b32 v23, a99
  v_mul_f32 v20, v20, v18
  v_mul_f32 v21, v21, v18
  v_mul_f32 v22, v22, v18
  v_mul_f32 v23, v23, v18
  v_accvgpr_write_b32 a96, v20
  v_accvgpr_write_b32 a97, v21
  v_accvgpr_write_b32 a98, v22
  v_accvgpr_write_b32 a99, v23
  v_accvgpr_read_b32 v20, a100
  v_accvgpr_read_b32 v21, a101
  v_accvgpr_read_b32 v22, a102
  v_accvgpr_read_b32 v23, a103
  v_mul_f32 v20, v20, v19
  v_mul_f32 v21, v21, v19
  v_mul_f32 v22, v22, v19
  v_mul_f32 v23, v23, v19
  v_accvgpr_write_b32 a100, v20
  v_accvgpr_write_b32 a101, v21
  v_accvgpr_write_b32 a102, v22
  v_accvgpr_write_b32 a103, v23
  v_accvgpr_read_b32 v20, a104
  v_accvgpr_read_b32 v21, a105
  v_accvgpr_read_b32 v22, a106
  v_accvgpr_read_b32 v23, a107
  v_mul_f32 v20, v20, v18
  v_mul_f32 v21, v21, v18
  v_mul_f32 v22, v22, v18
  v_mul_f32 v23, v23, v18
  v_accvgpr_write_b32 a104, v20
  v_accvgpr_write_b32 a105, v21
  v_accvgpr_write_b32 a106, v22
  v_accvgpr_write_b32 a107, v23
  v_accvgpr_read_b32 v20, a108
  v_accvgpr_read_b32 v21, a109
  v_accvgpr_read_b32 v22, a110
  v_accvgpr_read_b32 v23, a111
  v_mul_f32 v20, v20, v19
  v_mul_f32 v21, v21, v19
  v_mul_f32 v22, v22, v19
  v_mul_f32 v23, v23, v19
  v_accvgpr_write_b32 a108, v20
  v_accvgpr_write_b32 a109, v21
  v_accvgpr_write_b32 a110, v22
  v_accvgpr_write_b32 a111, v23
  v_accvgpr_read_b32 v20, a112
  v_accvgpr_read_b32 v21, a113
  v_accvgpr_read_b32 v22, a114
  v_accvgpr_read_b32 v23, a115
  v_mul_f32 v20, v20, v18
  v_mul_f32 v21, v21, v18
  v_mul_f32 v22, v22, v18
  v_mul_f32 v23, v23, v18
  v_accvgpr_write_b32 a112, v20
  v_accvgpr_write_b32 a113, v21
  v_accvgpr_write_b32 a114, v22
  v_accvgpr_write_b32 a115, v23
  v_accvgpr_read_b32 v20, a116
  v_accvgpr_read_b32 v21, a117
  v_accvgpr_read_b32 v22, a118
  v_accvgpr_read_b32 v23, a119
  v_mul_f32 v20, v20, v19
  v_mul_f32 v21, v21, v19
  v_mul_f32 v22, v22, v19
  v_mul_f32 v23, v23, v19
  v_accvgpr_write_b32 a116, v20
  v_accvgpr_write_b32 a117, v21
  v_accvgpr_write_b32 a118, v22
  v_accvgpr_write_b32 a119, v23
  v_accvgpr_read_b32 v20, a120
  v_accvgpr_read_b32 v21, a121
  v_accvgpr_read_b32 v22, a122
  v_accvgpr_read_b32 v23, a123
  v_mul_f32 v20, v20, v18
  v_mul_f32 v21, v21, v18
  v_mul_f32 v22, v22, v18
  v_mul_f32 v23, v23, v18
  v_accvgpr_write_b32 a120, v20
  v_accvgpr_write_b32 a121, v21
  v_accvgpr_write_b32 a122, v22
  v_accvgpr_write_b32 a123, v23
  v_accvgpr_read_b32 v20, a124
  v_accvgpr_read_b32 v21, a125
  v_accvgpr_read_b32 v22, a126
  v_accvgpr_read_b32 v23, a127
  v_mul_f32 v20, v20, v19
  v_mul_f32 v21, v21, v19
  v_mul_f32 v22, v22, v19
  v_mul_f32 v23, v23, v19
  v_accvgpr_write_b32 a124, v20
  v_accvgpr_write_b32 a125, v21
  v_accvgpr_write_b32 a126, v22
  v_accvgpr_write_b32 a127, v23
  s_setpc_b64 s[78:79]
.section .rodata,"a"
.p2align 6
.amdhsa_kernel fa_kernel
  .amdhsa_next_free_vgpr 512
  .amdhsa_next_free_sgpr 102
  .amdhsa_accum_offset 256
  .amdhsa_group_segment_fixed_size 0
  .amdhsa_kernarg_size 112
  .amdhsa_user_sgpr_count 2
  .amdhsa_user_sgpr_kernarg_segment_ptr 1
  .amdhsa_system_sgpr_workgroup_id_x 1
  .amdhsa_float_denorm_mode_32 3
.end_amdhsa_kernel
.text
```

```asm
; @launch kernel=fa_kernel grid=(256,1,1) block=(256,1,1) lds=163840
.amdgcn_target "amdgcn-amd-amdhsa--gfx950"
.text
.globl fa_kernel
.p2align 8
.type fa_kernel,@function
fa_kernel:
  s_cmp_ge_u32 s2, 256
  s_cbranch_scc1 fa_end
  s_getpc_b64 s[62:63]
  v_and_b32 v230, 127, v0
  v_lshlrev_b32 v230, 7, v230
  global_load_dword v231, v230, s[62:63]
  s_load_dwordx4 s[4:7], s[0:1], 0
  s_load_dwordx4 s[8:11], s[0:1], 24
  s_load_dwordx2 s[14:15], s[0:1], 56
  s_load_dwordx2 s[12:13], s[0:1], 40
  s_load_dwordx4 s[16:19], s[0:1], 96
  s_load_dwordx2 s[60:61], s[0:1], 16
  v_lshrrev_b32 v16, 6, v0
  v_and_b32 v1, 63, v0
  v_readfirstlane_b32 s20, v16
  s_and_b32 s21, s2, 7
  s_lshl_b32 s21, s21, 2
  s_lshr_b32 s23, s2, 3
  s_and_b32 s23, s23, 3
  s_add_u32 s21, s21, s23
  s_lshr_b32 s22, s2, 5
  v_and_b32 v208, 31, v1
  v_lshrrev_b32 v209, 5, v1
  s_lshl_b32 s31, s2, 2
  s_add_u32 s31, s31, s20
  s_lshl_b32 s31, s31, 1
  v_add_u32 v209, s31, v209
  v_lshlrev_b32 v212, 4, v208
  v_mul_u32_u24 v210, 1280, v209
  v_add_u32 v210, v210, v212
  v_cmp_gt_u32 s[64:65], 16, v208
  v_mov_b32 v19, 1073741824
  v_and_b32 v220, 7, v209
  v_cndmask_b32 v211, v19, v210, s[64:65]
  v_bfe_u32 v17, v1, 1, 3
  v_lshlrev_b32 v17, 13, v17
  v_and_b32 v18, 1, v1
  v_lshl_add_u32 v235, v18, 7, v17
  s_lshl_b32 s74, s22, 1
  s_and_b32 s31, s20, 1
  s_add_u32 s74, s74, s31
  s_lshl_b32 s74, s74, 16
  s_mov_b32 s73, 1048576
  v_and_b32 v16, 15, v1
  v_lshlrev_b32 v17, 10, v16
  v_and_b32 v18, 16, v1
  v_lshl_add_u32 v233, v18, 3, v17
  s_lshl_b32 s30, s23, 5
  s_add_u32 s30, s30, s20
  s_lshl_b32 s30, s30, 14
  s_lshl_b32 s29, s22, 16
  s_lshl_b32 s23, s21, 8
  s_cmp_ge_u32 s20, 2
  s_waitcnt lgkmcnt(0)
  s_mov_b32 s44, s4
  s_mov_b32 s45, s5
  s_mov_b32 s46, 2621440
  s_mov_b32 s47, 0x20000
  s_mov_b32 s68, s14
  s_mov_b32 s69, s15
  s_mov_b32 s70, 1280
  s_mov_b32 s71, 0x20000
  buffer_load_dwordx4 v[160:163], v210, s[44:47], 0 offen
  buffer_load_dwordx4 v[164:167], v210, s[44:47], 0 offen offset:512
  buffer_load_dwordx4 v[168:171], v211, s[44:47], 0 offen offset:1024
  buffer_load_dwordx4 v[172:175], v212, s[68:71], 0 offen offset:0
  buffer_load_dwordx4 v[176:179], v212, s[68:71], 0 offen offset:512
  buffer_load_dwordx4 v[180:183], v212, s[68:71], 0 offen offset:1024
  s_cselect_b32 s62, s10, s8
  s_cselect_b32 s63, s11, s9
  s_add_u32 s62, s62, s23
  s_addc_u32 s63, s63, 0
  s_mov_b32 s36, s62
  s_mov_b32 s37, s63
  s_mov_b32 s38, 0
  s_mov_b32 s39, 0x20000
  s_sub_u32 s38, 4194304, s23
  buffer_load_dword v231, v235, s[36:39], s74 offen
  s_add_u32 s6, s6, s29
  s_addc_u32 s7, s7, 0
  s_mov_b32 s32, s6
  s_mov_b32 s33, s7
  s_mov_b32 s34, 0
  s_mov_b32 s35, 0x20000
  s_sub_u32 s34, 2097152, s29
  buffer_load_dword v232, v233, s[32:35], s30 offen
  s_add_u32 s74, s74, s73
  buffer_load_dword v231, v235, s[36:39], s74 offen
  buffer_load_dword v232, v233, s[32:35], s30 offen offset:256
  s_getpc_b64 s[8:9]
fa_pc:
  s_lshr_b32 s31, s2, 3
  s_and_b32 s31, s31, 15
  s_lshl_b32 s31, s31, 2
  s_add_u32 s31, s31, s20
  s_lshl_b32 s31, s31, 11
  s_min_u32 s31, s31, fa_codeend-fa_pc-2048
  v_lshlrev_b32 v234, 7, v16
  v_add_u32 v230, s31, v234
  global_load_dword v231, v230, s[8:9]
  s_add_u32 s8, s8, fa_co1-fa_pc-4
  s_addc_u32 s9, s9, 0
  s_add_u32 s60, s60, s23
  s_addc_u32 s61, s61, 0
  s_sub_u32 s75, 5242880, s23
  s_mov_b32 s48, s62
  s_mov_b32 s49, s63
  s_mov_b32 s50, s38
  s_mov_b32 s51, 0x20000
  v_lshlrev_b32 v2, 4, v1
  v_lshrrev_b32 v19, 2, v1
  v_lshrrev_b32 v17, 5, v1
  v_mul_u32_u24 v17, 3, v17
  v_and_b32 v18, 3, v1
  v_xor_b32 v17, v17, v18
  v_lshlrev_b32 v17, 4, v17
  v_lshl_add_u32 v3, v19, 10, v17
  s_lshl_b32 s23, s20, 19
  v_add_u32 v3, s23, v3
  v_add_u32 v4, 15360, v3
  v_add_u32 v5, 30720, v3
  v_add_u32 v6, 46080, v3
  v_and_b32 v19, 3, v19
  v_lshrrev_b32 v17, 4, v1
  v_lshlrev_b32 v17, 6, v17
  v_lshl_add_u32 v19, v19, 13, v17
  s_and_b32 s23, s20, 1
  s_lshl_b32 s23, s23, 17
  v_add_u32 v19, s23, v19
  v_lshl_add_u32 v8, v18, 4, v19
  v_xor_b32 v18, 2, v18
  v_lshl_add_u32 v10, v18, 4, v19
  v_add_u32 v9, 31744, v8
  v_add_u32 v11, 95232, v10
  v_add_u32 v10, 63488, v10
  s_lshl_b32 s24, s20, 12
  s_mov_b32 s26, 0
  s_mov_b32 s27, 0
  s_mov_b32 s25, 262144
  s_mov_b32 s79, 64
  v_and_b32 v235, 0x7fff, v235
  s_sub_u32 s74, s74, s73
  s_lshr_b32 s74, s74, 1
  s_add_u32 s74, s74, 2097152
  s_mov_b32 s73, 524288
  s_mov_b32 s40, s18
  s_mov_b32 s41, s19
  s_mov_b32 s42, 68157440
  s_mov_b32 s43, 0x20000
  s_mov_b32 s52, s12
  s_mov_b32 s53, s13
  s_mov_b32 s54, 5242880
  s_mov_b32 s55, 0x20000
  s_mov_b32 s56, s16
  s_mov_b32 s57, s17
  s_mov_b32 s58, 256
  s_mov_b32 s59, 0x20000
  s_and_b32 s29, s2, 7
  s_lshl_b32 s29, s29, 2
  s_add_u32 s29, s29, s20
  s_lshl_b32 s29, s29, 11
  s_and_b32 s23, s21, 3
  s_lshl_b32 s23, s23, 19
  s_add_u32 s29, s29, s23
  s_mul_i32 s23, s20, 4096
  s_lshl_b32 s31, s21, 7
  s_add_u32 s23, s23, s31
  s_add_u32 s23, s23, 3801088
  s_mul_i32 s31, s22, 16384
  s_add_u32 s80, s23, s31
  s_sub_u32 s31, 245760, s31
  s_add_u32 s3, s23, s31
  s_lshl_b32 s23, s21, 10
  s_lshl_b32 s31, s22, 7
  s_add_u32 s23, s23, s31
  s_add_u32 s82, s23, 67108864
  s_sub_u32 s62, s2, 170
  s_lshl_b32 s31, s20, 6
  s_add_u32 s62, s62, s31
  s_lshl_b32 s62, s62, 7
  s_add_u32 s62, s62, 67174400
  s_sub_u32 s23, s2, 170
  s_cmp_lt_u32 s23, 54
  s_cselect_b32 s62, s62, 1073741824
  s_cmp_eq_u32 s20, 0
  s_cselect_b32 s31, s82, 1073741824
  s_cselect_b32 s77, s2, 1073741824
  s_cmp_eq_u32 s2, 255
  s_cselect_b32 s23, 2629632, 1073741824
  v_lshl_add_u32 v225, v16, 2, s23
  v_mov_b32 v229, 0
  v_writelane_b32 v225, s80, 0
  v_writelane_b32 v225, s3, 1
  v_writelane_b32 v225, s31, 2
  s_add_u32 s31, s31, 32
  v_writelane_b32 v225, s31, 5
  s_and_b32 s23, s2, 1
  s_lshl_b32 s23, s23, 2
  s_add_u32 s23, s23, s20
  s_lshl_b32 s23, s23, 7
  s_lshr_b32 s31, s2, 1
  s_add_u32 s23, s23, s31
  s_lshl_b32 s23, s23, 7
  s_add_u32 s23, s23, 67371008
  v_writelane_b32 v225, s23, 3
  v_writelane_b32 v225, s62, 4
  s_lshl_b32 s23, s2, 2
  s_add_u32 s23, s23, s20
  s_lshl_b32 s23, s23, 7
  s_add_u32 s23, s23, 67239936
  v_writelane_b32 v225, s23, 6
  s_and_b32 s23, s21, 3
  s_lshr_b32 s31, s23, 1
  s_lshl_b32 s31, 4, s31
  s_bitcmp1_b32 s23, 0
  s_cselect_b32 s76, s31, 0
  s_cselect_b32 s72, 0, s31
  s_or_b32 s76, s76, 40
  s_or_b32 s72, s72, 33
  v_mov_b32 v20, 0
  v_mov_b32 v21, 0
  v_mov_b32 v22, 0
  v_mov_b32 v23, 0
  v_lshrrev_b32 v17, 4, v1
  v_lshrrev_b32 v18, 3, v16
  v_mul_u32_u24 v18, 3, v18
  v_xor_b32 v18, v18, v17
  v_lshlrev_b32 v18, 4, v18
  v_lshl_add_u32 v14, v16, 6, v18
  s_and_b32 s23, s20, 1
  s_lshl_b32 s23, s23, 11
  v_add_u32 v14, s23, v14
  v_mfma_f32_32x32x16_bf16 a[0:15], v[20:23], v[20:23], 0
  v_lshrrev_b32 v18, 2, v16
  v_lshlrev_b32 v18, 6, v18
  v_lshl_add_u32 v18, v17, 11, v18
  v_and_b32 v19, 1, v1
  v_mfma_f32_32x32x16_bf16 a[16:31], v[20:23], v[20:23], 0
  v_lshl_add_u32 v18, v19, 3, v18
  v_bfe_u32 v19, v1, 1, 1
  v_and_b32 v17, 1, v17
  v_lshl_or_b32 v19, v17, 1, v19
  v_mfma_f32_32x32x16_bf16 a[32:47], v[20:23], v[20:23], 0
  s_lshr_b32 s23, s20, 1
  s_lshl_b32 s23, s23, 13
  s_add_u32 s23, s23, 16384
  v_add_u32 v18, s23, v18
  v_mfma_f32_32x32x16_bf16 a[48:63], v[20:23], v[20:23], 0
  v_lshl_add_u32 v12, v19, 4, v18
  v_xor_b32 v13, 32, v12
  v_mov_b32 v19, 1073741824
  v_lshlrev_b32 v220, 4, v220
  v_mfma_f32_32x32x16_bf16 a[64:79], v[20:23], v[20:23], 0
  v_lshl_add_u32 v220, v208, 7, v220
  v_add_u32 v220, 131072, v220
  v_lshlrev_b32 v222, 2, v209
  v_cmp_eq_u32 vcc, 0, v208
  v_mfma_f32_32x32x16_bf16 a[80:95], v[20:23], v[20:23], 0
  v_add_u32 v222, 2621440, v222
  v_lshlrev_b32 v221, 4, v0
  v_cndmask_b32 v222, v19, v222, vcc
  v_add_u32 v221, 131072, v221
  v_mfma_f32_32x32x16_bf16 a[96:111], v[20:23], v[20:23], 0
  v_sub_u32 v209, 0xffff, v209
  v_lshrrev_b32 v223, 3, v0
  v_and_b32 v18, 7, v0
  v_lshlrev_b32 v18, 4, v18
  v_mfma_f32_32x32x16_bf16 a[112:127], v[20:23], v[20:23], 0
  v_cmp_gt_u32 vcc, 128, v0
  v_lshl_add_u32 v223, v223, 8, v18
  s_lshr_b32 s66, s2, 1
  s_mul_i32 s66, s66, 20480
  v_mfma_f32_32x32x16_bf16 a[128:143], v[20:23], v[20:23], 0
  s_and_b32 s31, s2, 1
  s_lshl_b32 s31, s31, 7
  s_add_u32 s66, s66, s31
  v_cndmask_b32 v224, v19, v223, vcc
  v_mfma_f32_32x32x16_bf16 a[144:159], v[20:23], v[20:23], 0
  s_add_u32 s67, s66, 8192
  s_add_u32 s78, s66, 16384
  s_mov_b32 s28, 0
  v_mfma_f32_32x32x16_bf16 a[160:175], v[20:23], v[20:23], 0
  v_mfma_f32_32x32x16_bf16 a[176:191], v[20:23], v[20:23], 0
  v_mfma_f32_32x32x16_bf16 a[192:207], v[20:23], v[20:23], 0
  v_mfma_f32_32x32x16_bf16 a[208:223], v[20:23], v[20:23], 0
  v_mfma_f32_32x32x16_bf16 a[224:239], v[20:23], v[20:23], 0
  v_mfma_f32_32x32x16_bf16 a[240:255], v[20:23], v[20:23], 0
  s_waitcnt vmcnt(5)
  v_lshlrev_b32 v184, 16, v160
  v_and_b32 v185, 0xffff0000, v160
  v_lshlrev_b32 v186, 16, v161
  v_and_b32 v187, 0xffff0000, v161
  v_lshlrev_b32 v188, 16, v162
  v_and_b32 v189, 0xffff0000, v162
  v_lshlrev_b32 v190, 16, v163
  v_and_b32 v191, 0xffff0000, v163
  v_lshlrev_b32 v192, 16, v164
  v_and_b32 v193, 0xffff0000, v164
  v_lshlrev_b32 v194, 16, v165
  v_and_b32 v195, 0xffff0000, v165
  v_lshlrev_b32 v196, 16, v166
  v_and_b32 v197, 0xffff0000, v166
  v_lshlrev_b32 v198, 16, v167
  v_and_b32 v199, 0xffff0000, v167
  v_lshlrev_b32 v200, 16, v168
  v_and_b32 v201, 0xffff0000, v168
  v_lshlrev_b32 v202, 16, v169
  v_and_b32 v203, 0xffff0000, v169
  v_lshlrev_b32 v204, 16, v170
  v_and_b32 v205, 0xffff0000, v170
  v_lshlrev_b32 v206, 16, v171
  v_and_b32 v207, 0xffff0000, v171
  v_pk_add_f32 v[16:17], v[184:185], v[186:187]
  v_pk_add_f32 v[18:19], v[188:189], v[190:191]
  v_pk_add_f32 v[16:17], v[16:17], v[192:193]
  v_pk_add_f32 v[18:19], v[18:19], v[194:195]
  v_pk_add_f32 v[16:17], v[16:17], v[196:197]
  v_pk_add_f32 v[18:19], v[18:19], v[198:199]
  v_pk_add_f32 v[16:17], v[16:17], v[200:201]
  v_pk_add_f32 v[18:19], v[18:19], v[202:203]
  v_pk_add_f32 v[16:17], v[16:17], v[204:205]
  v_pk_add_f32 v[18:19], v[18:19], v[206:207]
  v_pk_add_f32 v[16:17], v[16:17], v[18:19]
  v_add_f32 v213, v16, v17
  s_nop 1
  v_add_f32_dpp v213, v213, v213 quad_perm:[1,0,3,2] row_mask:0xf bank_mask:0xf
  s_nop 1
  v_add_f32_dpp v213, v213, v213 quad_perm:[2,3,0,1] row_mask:0xf bank_mask:0xf
  s_nop 1
  v_add_f32_dpp v213, v213, v213 row_half_mirror row_mask:0xf bank_mask:0xf
  s_nop 1
  v_add_f32_dpp v213, v213, v213 row_mirror row_mask:0xf bank_mask:0xf
  v_mov_b32 v214, v213
  s_nop 1
  v_permlane16_swap_b32 v213, v214
  v_add_f32 v213, v213, v214
  v_mul_f32 v216, 0xbacccccd, v213
  v_mul_f32 v217, 0xbacccccd, v213
  v_pk_add_f32 v[20:21], v[184:185], v[216:217]
  v_pk_mul_f32 v[16:17], v[20:21], v[20:21]
  v_pk_add_f32 v[22:23], v[186:187], v[216:217]
  v_pk_fma_f32 v[16:17], v[22:23], v[22:23], v[16:17]
  v_pk_add_f32 v[24:25], v[188:189], v[216:217]
  v_pk_fma_f32 v[16:17], v[24:25], v[24:25], v[16:17]
  v_pk_add_f32 v[26:27], v[190:191], v[216:217]
  v_pk_fma_f32 v[16:17], v[26:27], v[26:27], v[16:17]
  v_pk_add_f32 v[20:21], v[192:193], v[216:217]
  v_pk_fma_f32 v[16:17], v[20:21], v[20:21], v[16:17]
  v_pk_add_f32 v[22:23], v[194:195], v[216:217]
  v_pk_fma_f32 v[16:17], v[22:23], v[22:23], v[16:17]
  v_pk_add_f32 v[24:25], v[196:197], v[216:217]
  v_pk_fma_f32 v[16:17], v[24:25], v[24:25], v[16:17]
  v_pk_add_f32 v[26:27], v[198:199], v[216:217]
  v_pk_fma_f32 v[16:17], v[26:27], v[26:27], v[16:17]
  v_pk_add_f32 v[20:21], v[200:201], v[216:217]
  v_pk_mul_f32 v[18:19], v[20:21], v[20:21]
  v_pk_add_f32 v[22:23], v[202:203], v[216:217]
  v_pk_fma_f32 v[18:19], v[22:23], v[22:23], v[18:19]
  v_pk_add_f32 v[24:25], v[204:205], v[216:217]
  v_pk_fma_f32 v[18:19], v[24:25], v[24:25], v[18:19]
  v_pk_add_f32 v[26:27], v[206:207], v[216:217]
  v_pk_fma_f32 v[18:19], v[26:27], v[26:27], v[18:19]
  v_add_f32 v18, v18, v19
  v_add_f32 v213, v16, v17
  v_cndmask_b32 v18, 0, v18, s[64:65]
  v_add_f32 v213, v213, v18
  s_nop 1
  v_add_f32_dpp v213, v213, v213 quad_perm:[1,0,3,2] row_mask:0xf bank_mask:0xf
  s_nop 1
  v_add_f32_dpp v213, v213, v213 quad_perm:[2,3,0,1] row_mask:0xf bank_mask:0xf
  s_nop 1
  v_add_f32_dpp v213, v213, v213 row_half_mirror row_mask:0xf bank_mask:0xf
  s_nop 1
  v_add_f32_dpp v213, v213, v213 row_mirror row_mask:0xf bank_mask:0xf
  v_mov_b32 v214, v213
  s_nop 1
  v_permlane16_swap_b32 v213, v214
  v_add_f32 v213, v213, v214
  v_mul_f32 v213, 0x3acccccd, v213
  v_cvt_pk_bf16_f32 v213, v213, v213
  v_and_b32 v213, 0xffff0000, v213
  v_add_f32 v213, 0x3727c5ac, v213
  v_cvt_pk_bf16_f32 v213, v213, v213
  v_and_b32 v213, 0xffff0000, v213
  v_sqrt_f32 v213, v213
  v_cvt_pk_bf16_f32 v216, v216, v216
  v_and_b32 v216, 0xffff0000, v216
  v_cvt_pk_bf16_f32 v213, v213, v213
  v_and_b32 v213, 0xffff0000, v213
  v_rcp_f32 v28, v213
  v_mov_b32 v217, v216
  v_mov_b32 v29, v28
  v_pk_add_f32 v[184:185], v[184:185], v[216:217]
  v_lshlrev_b32 v16, 16, v172
  v_cvt_pk_bf16_f32 v185, v184, v185
  v_and_b32 v17, 0xffff0000, v172
  v_lshlrev_b32 v184, 16, v185
  v_and_b32 v185, 0xffff0000, v185
  v_pk_mul_f32 v[184:185], v[184:185], v[28:29]
  v_cvt_pk_bf16_f32 v160, v184, v185
  v_lshlrev_b32 v184, 16, v160
  v_and_b32 v185, 0xffff0000, v160
  v_pk_mul_f32 v[218:219], v[184:185], v[16:17]
  v_pk_add_f32 v[186:187], v[186:187], v[216:217]
  v_lshlrev_b32 v18, 16, v173
  v_cvt_pk_bf16_f32 v187, v186, v187
  v_and_b32 v19, 0xffff0000, v173
  v_lshlrev_b32 v186, 16, v187
  v_and_b32 v187, 0xffff0000, v187
  v_pk_mul_f32 v[186:187], v[186:187], v[28:29]
  v_cvt_pk_bf16_f32 v161, v186, v187
  v_lshlrev_b32 v186, 16, v161
  v_and_b32 v187, 0xffff0000, v161
  v_pk_fma_f32 v[218:219], v[186:187], v[18:19], v[218:219]
  v_pk_add_f32 v[188:189], v[188:189], v[216:217]
  v_lshlrev_b32 v16, 16, v174
  v_cvt_pk_bf16_f32 v189, v188, v189
  v_and_b32 v17, 0xffff0000, v174
  v_lshlrev_b32 v188, 16, v189
  v_and_b32 v189, 0xffff0000, v189
  v_pk_mul_f32 v[188:189], v[188:189], v[28:29]
  v_cvt_pk_bf16_f32 v162, v188, v189
  v_lshlrev_b32 v188, 16, v162
  v_and_b32 v189, 0xffff0000, v162
  v_pk_fma_f32 v[218:219], v[188:189], v[16:17], v[218:219]
  v_pk_add_f32 v[190:191], v[190:191], v[216:217]
  v_lshlrev_b32 v18, 16, v175
  v_cvt_pk_bf16_f32 v191, v190, v191
  v_and_b32 v19, 0xffff0000, v175
  v_lshlrev_b32 v190, 16, v191
  v_and_b32 v191, 0xffff0000, v191
  v_pk_mul_f32 v[190:191], v[190:191], v[28:29]
  v_cvt_pk_bf16_f32 v163, v190, v191
  v_lshlrev_b32 v190, 16, v163
  v_and_b32 v191, 0xffff0000, v163
  v_pk_fma_f32 v[218:219], v[190:191], v[18:19], v[218:219]
  ds_write_b128 v220, v[160:163] offset:0
  v_pk_add_f32 v[192:193], v[192:193], v[216:217]
  v_lshlrev_b32 v16, 16, v176
  v_cvt_pk_bf16_f32 v193, v192, v193
  v_and_b32 v17, 0xffff0000, v176
  v_lshlrev_b32 v192, 16, v193
  v_and_b32 v193, 0xffff0000, v193
  v_pk_mul_f32 v[192:193], v[192:193], v[28:29]
  v_cvt_pk_bf16_f32 v164, v192, v193
  v_lshlrev_b32 v192, 16, v164
  v_and_b32 v193, 0xffff0000, v164
  v_pk_fma_f32 v[218:219], v[192:193], v[16:17], v[218:219]
  v_pk_add_f32 v[194:195], v[194:195], v[216:217]
  v_lshlrev_b32 v18, 16, v177
  v_cvt_pk_bf16_f32 v195, v194, v195
  v_and_b32 v19, 0xffff0000, v177
  v_lshlrev_b32 v194, 16, v195
  v_and_b32 v195, 0xffff0000, v195
  v_pk_mul_f32 v[194:195], v[194:195], v[28:29]
  v_cvt_pk_bf16_f32 v165, v194, v195
  v_lshlrev_b32 v194, 16, v165
  v_and_b32 v195, 0xffff0000, v165
  v_pk_fma_f32 v[218:219], v[194:195], v[18:19], v[218:219]
  v_pk_add_f32 v[196:197], v[196:197], v[216:217]
  v_lshlrev_b32 v16, 16, v178
  v_cvt_pk_bf16_f32 v197, v196, v197
  v_and_b32 v17, 0xffff0000, v178
  v_lshlrev_b32 v196, 16, v197
  v_and_b32 v197, 0xffff0000, v197
  v_pk_mul_f32 v[196:197], v[196:197], v[28:29]
  v_cvt_pk_bf16_f32 v166, v196, v197
  v_lshlrev_b32 v196, 16, v166
  v_and_b32 v197, 0xffff0000, v166
  v_pk_fma_f32 v[218:219], v[196:197], v[16:17], v[218:219]
  v_pk_add_f32 v[198:199], v[198:199], v[216:217]
  v_lshlrev_b32 v18, 16, v179
  v_cvt_pk_bf16_f32 v199, v198, v199
  v_and_b32 v19, 0xffff0000, v179
  v_lshlrev_b32 v198, 16, v199
  v_and_b32 v199, 0xffff0000, v199
  v_pk_mul_f32 v[198:199], v[198:199], v[28:29]
  v_cvt_pk_bf16_f32 v167, v198, v199
  v_lshlrev_b32 v198, 16, v167
  v_and_b32 v199, 0xffff0000, v167
  v_pk_fma_f32 v[218:219], v[198:199], v[18:19], v[218:219]
  ds_write_b128 v220, v[164:167] offset:4096
  v_pk_add_f32 v[200:201], v[200:201], v[216:217]
  v_lshlrev_b32 v16, 16, v180
  v_cvt_pk_bf16_f32 v201, v200, v201
  v_and_b32 v17, 0xffff0000, v180
  v_lshlrev_b32 v200, 16, v201
  v_and_b32 v201, 0xffff0000, v201
  v_pk_mul_f32 v[200:201], v[200:201], v[28:29]
  v_cvt_pk_bf16_f32 v168, v200, v201
  v_lshlrev_b32 v200, 16, v168
  v_and_b32 v201, 0xffff0000, v168
  v_pk_fma_f32 v[218:219], v[200:201], v[16:17], v[218:219]
  v_pk_add_f32 v[202:203], v[202:203], v[216:217]
  v_lshlrev_b32 v18, 16, v181
  v_cvt_pk_bf16_f32 v203, v202, v203
  v_and_b32 v19, 0xffff0000, v181
  v_lshlrev_b32 v202, 16, v203
  v_and_b32 v203, 0xffff0000, v203
  v_pk_mul_f32 v[202:203], v[202:203], v[28:29]
  v_cvt_pk_bf16_f32 v169, v202, v203
  v_lshlrev_b32 v202, 16, v169
  v_and_b32 v203, 0xffff0000, v169
  v_pk_fma_f32 v[218:219], v[202:203], v[18:19], v[218:219]
  v_pk_add_f32 v[204:205], v[204:205], v[216:217]
  v_lshlrev_b32 v16, 16, v182
  v_cvt_pk_bf16_f32 v205, v204, v205
  v_and_b32 v17, 0xffff0000, v182
  v_lshlrev_b32 v204, 16, v205
  v_and_b32 v205, 0xffff0000, v205
  v_pk_mul_f32 v[204:205], v[204:205], v[28:29]
  v_cvt_pk_bf16_f32 v170, v204, v205
  v_lshlrev_b32 v204, 16, v170
  v_and_b32 v205, 0xffff0000, v170
  v_pk_fma_f32 v[218:219], v[204:205], v[16:17], v[218:219]
  v_pk_add_f32 v[206:207], v[206:207], v[216:217]
  v_lshlrev_b32 v18, 16, v183
  v_cvt_pk_bf16_f32 v207, v206, v207
  v_and_b32 v19, 0xffff0000, v183
  v_lshlrev_b32 v206, 16, v207
  v_and_b32 v207, 0xffff0000, v207
  v_pk_mul_f32 v[206:207], v[206:207], v[28:29]
  v_cvt_pk_bf16_f32 v171, v206, v207
  v_lshlrev_b32 v206, 16, v171
  v_and_b32 v207, 0xffff0000, v171
  v_pk_fma_f32 v[218:219], v[206:207], v[18:19], v[218:219]
  ds_write_b128 v220, v[168:171] offset:8192
  v_add_f32 v218, v218, v219
  s_nop 1
  v_add_f32_dpp v218, v218, v218 quad_perm:[1,0,3,2] row_mask:0xf bank_mask:0xf
  s_nop 1
  v_add_f32_dpp v218, v218, v218 quad_perm:[2,3,0,1] row_mask:0xf bank_mask:0xf
  s_nop 1
  v_add_f32_dpp v218, v218, v218 row_half_mirror row_mask:0xf bank_mask:0xf
  s_nop 1
  v_add_f32_dpp v218, v218, v218 row_mirror row_mask:0xf bank_mask:0xf
  v_mov_b32 v214, v218
  s_nop 1
  v_permlane16_swap_b32 v218, v214
  v_add_f32 v218, v218, v214
  v_cvt_pk_bf16_f32 v218, v218, v218
  v_and_b32 v218, 0xffff0000, v218
  v_ashrrev_i32 v214, 31, v218
  v_or_b32 v214, 0x80000000, v214
  v_xor_b32 v218, v218, v214
  v_and_b32 v218, 0xffff0000, v218
  v_or_b32 v218, v218, v209
  v_mov_b32 v19, 1073741824
  s_mov_b32 m0, s24
  s_nop 0
  buffer_load_dwordx4 v3, s[32:35], s26 offen offset:0 sc1 lds
  buffer_load_dwordx4 v4, s[32:35], s26 offen offset:1024 sc1 lds
  buffer_load_dwordx4 v5, s[32:35], s26 offen offset:2048 sc1 lds
  buffer_load_dwordx4 v6, s[32:35], s26 offen offset:3072 sc1 lds
  s_add_u32 m0, s24, 16384
  s_nop 0
  buffer_load_dwordx4 v8, s[36:39], s27 offen offset:0 lds
  buffer_load_dwordx4 v9, s[36:39], s27 offen offset:1024 lds
  buffer_load_dwordx4 v10, s[36:39], s27 offen offset:2048 lds
  buffer_load_dwordx4 v11, s[36:39], s27 offen offset:3072 lds
  s_add_u32 s26, s26, s79
  s_add_u32 s27, s27, s25
  s_add_u32 s24, s24, 32768
  s_and_b32 s24, s24, 0x1ffff
  s_mov_b32 m0, s24
  s_nop 0
  buffer_load_dwordx4 v3, s[32:35], s26 offen offset:0 sc1 lds
  buffer_load_dwordx4 v4, s[32:35], s26 offen offset:1024 sc1 lds
  buffer_load_dwordx4 v5, s[32:35], s26 offen offset:2048 sc1 lds
  buffer_load_dwordx4 v6, s[32:35], s26 offen offset:3072 sc1 lds
  s_add_u32 m0, s24, 16384
  s_nop 0
  buffer_load_dwordx4 v8, s[36:39], s27 offen offset:0 lds
  buffer_load_dwordx4 v9, s[36:39], s27 offen offset:1024 lds
  buffer_load_dwordx4 v10, s[36:39], s27 offen offset:2048 lds
  buffer_load_dwordx4 v11, s[36:39], s27 offen offset:3072 lds
  s_add_u32 s26, s26, s79
  s_add_u32 s27, s27, s25
  s_add_u32 s24, s24, 32768
  s_and_b32 s24, s24, 0x1ffff
  s_waitcnt vmcnt(8) lgkmcnt(0)
  s_barrier
  s_cmp_ge_u32 s20, 2
  s_cbranch_scc1 fa_roleV
  ds_read_b128 v[96:99], v14 offset:0
  ds_read_b128 v[100:103], v14 offset:1024
  ds_read_b128 v[104:107], v14 offset:4096
  ds_read_b128 v[108:111], v14 offset:5120
  ds_read_b128 v[112:115], v14 offset:8192
  ds_read_b128 v[116:119], v14 offset:9216
  ds_read_b128 v[120:123], v14 offset:12288
  ds_read_b128 v[124:127], v14 offset:13312
  ds_read_b64_tr_b16 v[32:33], v12 offset:0
  ds_read_b64_tr_b16 v[34:35], v12 offset:1024
  ds_read_b64_tr_b16 v[36:37], v13 offset:0
  ds_read_b64_tr_b16 v[38:39], v13 offset:1024
  ds_read_b64_tr_b16 v[40:41], v12 offset:256
  ds_read_b64_tr_b16 v[42:43], v12 offset:1280
  ds_read_b64_tr_b16 v[44:45], v13 offset:256
  ds_read_b64_tr_b16 v[46:47], v13 offset:1280
  ds_read_b64_tr_b16 v[48:49], v12 offset:512
  ds_read_b64_tr_b16 v[50:51], v12 offset:1536
  ds_read_b64_tr_b16 v[52:53], v13 offset:512
  ds_read_b64_tr_b16 v[54:55], v13 offset:1536
  ds_read_b64_tr_b16 v[56:57], v12 offset:768
  ds_read_b64_tr_b16 v[58:59], v12 offset:1792
  ds_read_b64_tr_b16 v[60:61], v13 offset:768
  ds_read_b64_tr_b16 v[62:63], v13 offset:1792
  s_mov_b32 m0, s24
  s_nop 0
  buffer_load_dwordx4 v3, s[32:35], s26 offen offset:0 sc1 lds
  buffer_load_dwordx4 v4, s[32:35], s26 offen offset:1024 sc1 lds
  buffer_load_dwordx4 v5, s[32:35], s26 offen offset:2048 sc1 lds
  buffer_load_dwordx4 v6, s[32:35], s26 offen offset:3072 sc1 lds
  s_add_u32 m0, s24, 16384
  s_nop 0
  buffer_load_dwordx4 v8, s[36:39], s27 offen offset:0 lds
  buffer_load_dwordx4 v9, s[36:39], s27 offen offset:1024 lds
  buffer_load_dwordx4 v10, s[36:39], s27 offen offset:2048 lds
  buffer_load_dwordx4 v11, s[36:39], s27 offen offset:3072 lds
  s_add_u32 s26, s26, s79
  s_add_u32 s27, s27, s25
  s_add_u32 s24, s24, 32768
  s_and_b32 s24, s24, 0x1ffff
  buffer_load_dword v231, v19, s[32:35], 0 offen
  s_mov_b32 m0, s24
  s_nop 0
  buffer_load_dwordx4 v3, s[32:35], s26 offen offset:0 sc1 lds
  buffer_load_dwordx4 v4, s[32:35], s26 offen offset:1024 sc1 lds
  buffer_load_dwordx4 v5, s[32:35], s26 offen offset:2048 sc1 lds
  buffer_load_dwordx4 v6, s[32:35], s26 offen offset:3072 sc1 lds
  s_add_u32 m0, s24, 16384
  s_nop 0
  buffer_load_dwordx4 v8, s[36:39], s27 offen offset:0 lds
  buffer_load_dwordx4 v9, s[36:39], s27 offen offset:1024 lds
  buffer_load_dwordx4 v10, s[36:39], s27 offen offset:2048 lds
  buffer_load_dwordx4 v11, s[36:39], s27 offen offset:3072 lds
  s_add_u32 s26, s26, s79
  s_add_u32 s27, s27, s25
  s_add_u32 s24, s24, 32768
  s_and_b32 s24, s24, 0x1ffff
  s_waitcnt lgkmcnt(0)
.p2align 6
fa_loopK:
  v_mfma_f32_16x16x32_bf16 a[192:195], v[32:35], v[96:99], a[192:195]
  s_waitcnt vmcnt(17)
  v_mfma_f32_16x16x32_bf16 a[200:203], v[32:35], v[100:103], a[200:203]
  s_barrier
  v_mfma_f32_16x16x32_bf16 a[0:3], v[32:35], v[104:107], a[0:3]
  ds_read_b64_tr_b16 v[64:65], v12 offset:32768
  v_mfma_f32_16x16x32_bf16 a[8:11], v[32:35], v[108:111], a[8:11]
  v_mfma_f32_16x16x32_bf16 a[64:67], v[32:35], v[112:115], a[64:67]
  s_mov_b32 m0, s24
  ds_read_b64_tr_b16 v[66:67], v12 offset:33792
  v_mfma_f32_16x16x32_bf16 a[72:75], v[32:35], v[116:119], a[72:75]
  buffer_load_dwordx4 v3, s[32:35], s26 offen offset:0 sc1 lds
  v_mfma_f32_16x16x32_bf16 a[128:131], v[32:35], v[120:123], a[128:131]
  ds_read_b128 v[128:131], v14 offset:32768
  v_mfma_f32_16x16x32_bf16 a[136:139], v[32:35], v[124:127], a[136:139]
  buffer_load_dwordx4 v4, s[32:35], s26 offen offset:1024 sc1 lds
  v_mfma_f32_16x16x32_bf16 a[196:199], v[36:39], v[96:99], a[196:199]
  ds_read_b64_tr_b16 v[68:69], v13 offset:32768
  v_mfma_f32_16x16x32_bf16 a[204:207], v[36:39], v[100:103], a[204:207]
  buffer_load_dwordx4 v5, s[32:35], s26 offen offset:2048 sc1 lds
  v_mfma_f32_16x16x32_bf16 a[4:7], v[36:39], v[104:107], a[4:7]
  ds_read_b64_tr_b16 v[70:71], v13 offset:33792
  v_mfma_f32_16x16x32_bf16 a[12:15], v[36:39], v[108:111], a[12:15]
  buffer_load_dwordx4 v6, s[32:35], s26 offen offset:3072 sc1 lds
  v_mfma_f32_16x16x32_bf16 a[68:71], v[36:39], v[112:115], a[68:71]
  s_add_u32 m0, s24, 16384
  ds_read_b128 v[132:135], v14 offset:33792
  v_mfma_f32_16x16x32_bf16 a[76:79], v[36:39], v[116:119], a[76:79]
  buffer_load_dwordx4 v8, s[36:39], s27 offen offset:0 lds
  v_mfma_f32_16x16x32_bf16 a[132:135], v[36:39], v[120:123], a[132:135]
  ds_read_b64_tr_b16 v[72:73], v12 offset:33024
  v_mfma_f32_16x16x32_bf16 a[140:143], v[36:39], v[124:127], a[140:143]
  buffer_load_dwordx4 v9, s[36:39], s27 offen offset:1024 lds
  v_mfma_f32_16x16x32_bf16 a[208:211], v[40:43], v[96:99], a[208:211]
  ds_read_b64_tr_b16 v[74:75], v12 offset:34048
  v_mfma_f32_16x16x32_bf16 a[216:219], v[40:43], v[100:103], a[216:219]
  buffer_load_dwordx4 v10, s[36:39], s27 offen offset:2048 lds
  v_mfma_f32_16x16x32_bf16 a[16:19], v[40:43], v[104:107], a[16:19]
  ds_read_b128 v[136:139], v14 offset:36864
  v_mfma_f32_16x16x32_bf16 a[24:27], v[40:43], v[108:111], a[24:27]
  buffer_load_dwordx4 v11, s[36:39], s27 offen offset:3072 lds
  v_mfma_f32_16x16x32_bf16 a[80:83], v[40:43], v[112:115], a[80:83]
  ds_read_b64_tr_b16 v[76:77], v13 offset:33024
  v_mfma_f32_16x16x32_bf16 a[88:91], v[40:43], v[116:119], a[88:91]
  buffer_load_dword v231, v235, s[48:51], s74 offen sc1
  v_mfma_f32_16x16x32_bf16 a[144:147], v[40:43], v[120:123], a[144:147]
  s_add_u32 s74, s74, s73
  ds_read_b64_tr_b16 v[78:79], v13 offset:34048
  v_mfma_f32_16x16x32_bf16 a[152:155], v[40:43], v[124:127], a[152:155]
  s_bitcmp1_b32 s72, s28
  v_mfma_f32_16x16x32_bf16 a[212:215], v[44:47], v[96:99], a[212:215]
  s_cbranch_scc1 fa_hk0
fa_hb0:
  ds_read_b128 v[140:143], v14 offset:37888
  v_mfma_f32_16x16x32_bf16 a[220:223], v[44:47], v[100:103], a[220:223]
  v_mfma_f32_16x16x32_bf16 a[20:23], v[44:47], v[104:107], a[20:23]
  ds_read_b64_tr_b16 v[80:81], v12 offset:33280
  v_mfma_f32_16x16x32_bf16 a[28:31], v[44:47], v[108:111], a[28:31]
  v_mfma_f32_16x16x32_bf16 a[84:87], v[44:47], v[112:115], a[84:87]
  ds_read_b64_tr_b16 v[82:83], v12 offset:34304
  v_mfma_f32_16x16x32_bf16 a[92:95], v[44:47], v[116:119], a[92:95]
  v_mfma_f32_16x16x32_bf16 a[148:151], v[44:47], v[120:123], a[148:151]
  ds_read_b128 v[144:147], v14 offset:40960
  v_mfma_f32_16x16x32_bf16 a[156:159], v[44:47], v[124:127], a[156:159]
  v_mfma_f32_16x16x32_bf16 a[224:227], v[48:51], v[96:99], a[224:227]
  ds_read_b64_tr_b16 v[84:85], v13 offset:33280
  v_mfma_f32_16x16x32_bf16 a[232:235], v[48:51], v[100:103], a[232:235]
  v_mfma_f32_16x16x32_bf16 a[32:35], v[48:51], v[104:107], a[32:35]
  ds_read_b64_tr_b16 v[86:87], v13 offset:34304
  v_mfma_f32_16x16x32_bf16 a[40:43], v[48:51], v[108:111], a[40:43]
  v_mfma_f32_16x16x32_bf16 a[96:99], v[48:51], v[112:115], a[96:99]
  ds_read_b128 v[148:151], v14 offset:41984
  v_mfma_f32_16x16x32_bf16 a[104:107], v[48:51], v[116:119], a[104:107]
  v_mfma_f32_16x16x32_bf16 a[160:163], v[48:51], v[120:123], a[160:163]
  ds_read_b64_tr_b16 v[88:89], v12 offset:33536
  v_mfma_f32_16x16x32_bf16 a[168:171], v[48:51], v[124:127], a[168:171]
  v_mfma_f32_16x16x32_bf16 a[228:231], v[52:55], v[96:99], a[228:231]
  ds_read_b64_tr_b16 v[90:91], v12 offset:34560
  v_mfma_f32_16x16x32_bf16 a[236:239], v[52:55], v[100:103], a[236:239]
  v_mfma_f32_16x16x32_bf16 a[36:39], v[52:55], v[104:107], a[36:39]
  ds_read_b128 v[152:155], v14 offset:45056
  v_mfma_f32_16x16x32_bf16 a[44:47], v[52:55], v[108:111], a[44:47]
  v_mfma_f32_16x16x32_bf16 a[100:103], v[52:55], v[112:115], a[100:103]
  ds_read_b64_tr_b16 v[92:93], v13 offset:33536
  v_mfma_f32_16x16x32_bf16 a[108:111], v[52:55], v[116:119], a[108:111]
  v_mfma_f32_16x16x32_bf16 a[164:167], v[52:55], v[120:123], a[164:167]
  ds_read_b64_tr_b16 v[94:95], v13 offset:34560
  v_mfma_f32_16x16x32_bf16 a[172:175], v[52:55], v[124:127], a[172:175]
  v_mfma_f32_16x16x32_bf16 a[240:243], v[56:59], v[96:99], a[240:243]
  s_add_u32 s26, s26, s79
  ds_read_b128 v[156:159], v14 offset:46080
  v_mfma_f32_16x16x32_bf16 a[248:251], v[56:59], v[100:103], a[248:251]
  s_add_u32 s27, s27, s25
  v_mfma_f32_16x16x32_bf16 a[48:51], v[56:59], v[104:107], a[48:51]
  s_add_u32 s24, s24, 32768
  v_mfma_f32_16x16x32_bf16 a[56:59], v[56:59], v[108:111], a[56:59]
  s_and_b32 s24, s24, 0x1ffff
  v_mfma_f32_16x16x32_bf16 a[112:115], v[56:59], v[112:115], a[112:115]
  v_xor_b32 v14, 0x10000, v14
  v_mfma_f32_16x16x32_bf16 a[120:123], v[56:59], v[116:119], a[120:123]
  v_xor_b32 v12, 0x10000, v12
  v_mfma_f32_16x16x32_bf16 a[176:179], v[56:59], v[120:123], a[176:179]
  v_xor_b32 v13, 0x10000, v13
  v_mfma_f32_16x16x32_bf16 a[184:187], v[56:59], v[124:127], a[184:187]
  v_mfma_f32_16x16x32_bf16 a[244:247], v[60:63], v[96:99], a[244:247]
  v_mfma_f32_16x16x32_bf16 a[252:255], v[60:63], v[100:103], a[252:255]
  v_mfma_f32_16x16x32_bf16 a[52:55], v[60:63], v[104:107], a[52:55]
  v_mfma_f32_16x16x32_bf16 a[60:63], v[60:63], v[108:111], a[60:63]
  v_mfma_f32_16x16x32_bf16 a[116:119], v[60:63], v[112:115], a[116:119]
  v_mfma_f32_16x16x32_bf16 a[124:127], v[60:63], v[116:119], a[124:127]
  v_mfma_f32_16x16x32_bf16 a[180:183], v[60:63], v[120:123], a[180:183]
  v_mfma_f32_16x16x32_bf16 a[188:191], v[60:63], v[124:127], a[188:191]
  s_waitcnt lgkmcnt(0)
  v_mfma_f32_16x16x32_bf16 a[192:195], v[64:67], v[128:131], a[192:195]
  s_waitcnt vmcnt(18)
  v_mfma_f32_16x16x32_bf16 a[200:203], v[64:67], v[132:135], a[200:203]
  s_barrier
  v_mfma_f32_16x16x32_bf16 a[0:3], v[64:67], v[136:139], a[0:3]
  ds_read_b64_tr_b16 v[32:33], v12 offset:0
  v_mfma_f32_16x16x32_bf16 a[8:11], v[64:67], v[140:143], a[8:11]
  v_mfma_f32_16x16x32_bf16 a[64:67], v[64:67], v[144:147], a[64:67]
  s_mov_b32 m0, s24
  ds_read_b64_tr_b16 v[34:35], v12 offset:1024
  v_mfma_f32_16x16x32_bf16 a[72:75], v[64:67], v[148:151], a[72:75]
  buffer_load_dwordx4 v3, s[32:35], s26 offen offset:0 sc1 lds
  v_mfma_f32_16x16x32_bf16 a[128:131], v[64:67], v[152:155], a[128:131]
  ds_read_b128 v[96:99], v14 offset:0
  v_mfma_f32_16x16x32_bf16 a[136:139], v[64:67], v[156:159], a[136:139]
  v_mfma_f32_16x16x32_bf16 a[196:199], v[68:71], v[128:131], a[196:199]
  ds_read_b64_tr_b16 v[36:37], v13 offset:0
  v_mfma_f32_16x16x32_bf16 a[204:207], v[68:71], v[132:135], a[204:207]
  v_mfma_f32_16x16x32_bf16 a[4:7], v[68:71], v[136:139], a[4:7]
  ds_read_b64_tr_b16 v[38:39], v13 offset:1024
  v_mfma_f32_16x16x32_bf16 a[12:15], v[68:71], v[140:143], a[12:15]
  buffer_load_dwordx4 v4, s[32:35], s26 offen offset:1024 sc1 lds
  v_mfma_f32_16x16x32_bf16 a[68:71], v[68:71], v[144:147], a[68:71]
  ds_read_b128 v[100:103], v14 offset:1024
  v_mfma_f32_16x16x32_bf16 a[76:79], v[68:71], v[148:151], a[76:79]
  v_mfma_f32_16x16x32_bf16 a[132:135], v[68:71], v[152:155], a[132:135]
  ds_read_b64_tr_b16 v[40:41], v12 offset:256
  v_mfma_f32_16x16x32_bf16 a[140:143], v[68:71], v[156:159], a[140:143]
  v_mfma_f32_16x16x32_bf16 a[208:211], v[72:75], v[128:131], a[208:211]
  ds_read_b64_tr_b16 v[42:43], v12 offset:1280
  v_mfma_f32_16x16x32_bf16 a[216:219], v[72:75], v[132:135], a[216:219]
  buffer_load_dwordx4 v5, s[32:35], s26 offen offset:2048 sc1 lds
  v_mfma_f32_16x16x32_bf16 a[16:19], v[72:75], v[136:139], a[16:19]
  ds_read_b128 v[104:107], v14 offset:4096
  v_mfma_f32_16x16x32_bf16 a[24:27], v[72:75], v[140:143], a[24:27]
  v_mfma_f32_16x16x32_bf16 a[80:83], v[72:75], v[144:147], a[80:83]
  ds_read_b64_tr_b16 v[44:45], v13 offset:256
  v_mfma_f32_16x16x32_bf16 a[88:91], v[72:75], v[148:151], a[88:91]
  v_mfma_f32_16x16x32_bf16 a[144:147], v[72:75], v[152:155], a[144:147]
  ds_read_b64_tr_b16 v[46:47], v13 offset:1280
  v_mfma_f32_16x16x32_bf16 a[152:155], v[72:75], v[156:159], a[152:155]
  buffer_load_dwordx4 v6, s[32:35], s26 offen offset:3072 sc1 lds
  v_mfma_f32_16x16x32_bf16 a[212:215], v[76:79], v[128:131], a[212:215]
  ds_read_b128 v[108:111], v14 offset:5120
  v_mfma_f32_16x16x32_bf16 a[220:223], v[76:79], v[132:135], a[220:223]
  v_mfma_f32_16x16x32_bf16 a[20:23], v[76:79], v[136:139], a[20:23]
  ds_read_b64_tr_b16 v[48:49], v12 offset:512
  v_mfma_f32_16x16x32_bf16 a[28:31], v[76:79], v[140:143], a[28:31]
  v_mfma_f32_16x16x32_bf16 a[84:87], v[76:79], v[144:147], a[84:87]
  s_add_u32 m0, s24, 16384
  ds_read_b64_tr_b16 v[50:51], v12 offset:1536
  v_mfma_f32_16x16x32_bf16 a[92:95], v[76:79], v[148:151], a[92:95]
  buffer_load_dwordx4 v8, s[36:39], s27 offen offset:0 lds
  v_mfma_f32_16x16x32_bf16 a[148:151], v[76:79], v[152:155], a[148:151]
  ds_read_b128 v[112:115], v14 offset:8192
  v_mfma_f32_16x16x32_bf16 a[156:159], v[76:79], v[156:159], a[156:159]
  v_mfma_f32_16x16x32_bf16 a[224:227], v[80:83], v[128:131], a[224:227]
  ds_read_b64_tr_b16 v[52:53], v13 offset:512
  v_mfma_f32_16x16x32_bf16 a[232:235], v[80:83], v[132:135], a[232:235]
  v_mfma_f32_16x16x32_bf16 a[32:35], v[80:83], v[136:139], a[32:35]
  ds_read_b64_tr_b16 v[54:55], v13 offset:1536
  v_mfma_f32_16x16x32_bf16 a[40:43], v[80:83], v[140:143], a[40:43]
  buffer_load_dwordx4 v9, s[36:39], s27 offen offset:1024 lds
  v_mfma_f32_16x16x32_bf16 a[96:99], v[80:83], v[144:147], a[96:99]
  ds_read_b128 v[116:119], v14 offset:9216
  v_mfma_f32_16x16x32_bf16 a[104:107], v[80:83], v[148:151], a[104:107]
  v_mfma_f32_16x16x32_bf16 a[160:163], v[80:83], v[152:155], a[160:163]
  ds_read_b64_tr_b16 v[56:57], v12 offset:768
  v_mfma_f32_16x16x32_bf16 a[168:171], v[80:83], v[156:159], a[168:171]
  v_mfma_f32_16x16x32_bf16 a[228:231], v[84:87], v[128:131], a[228:231]
  ds_read_b64_tr_b16 v[58:59], v12 offset:1792
  v_mfma_f32_16x16x32_bf16 a[236:239], v[84:87], v[132:135], a[236:239]
  buffer_load_dwordx4 v10, s[36:39], s27 offen offset:2048 lds
  v_mfma_f32_16x16x32_bf16 a[36:39], v[84:87], v[136:139], a[36:39]
  ds_read_b128 v[120:123], v14 offset:12288
  v_mfma_f32_16x16x32_bf16 a[44:47], v[84:87], v[140:143], a[44:47]
  v_mfma_f32_16x16x32_bf16 a[100:103], v[84:87], v[144:147], a[100:103]
  ds_read_b64_tr_b16 v[60:61], v13 offset:768
  v_mfma_f32_16x16x32_bf16 a[108:111], v[84:87], v[148:151], a[108:111]
  v_mfma_f32_16x16x32_bf16 a[164:167], v[84:87], v[152:155], a[164:167]
  ds_read_b64_tr_b16 v[62:63], v13 offset:1792
  v_mfma_f32_16x16x32_bf16 a[172:175], v[84:87], v[156:159], a[172:175]
  buffer_load_dwordx4 v11, s[36:39], s27 offen offset:3072 lds
  v_mfma_f32_16x16x32_bf16 a[240:243], v[88:91], v[128:131], a[240:243]
  s_add_u32 s26, s26, s79
  ds_read_b128 v[124:127], v14 offset:13312
  v_mfma_f32_16x16x32_bf16 a[248:251], v[88:91], v[132:135], a[248:251]
  s_add_u32 s27, s27, s25
  v_mfma_f32_16x16x32_bf16 a[48:51], v[88:91], v[136:139], a[48:51]
  s_add_u32 s24, s24, 32768
  v_mfma_f32_16x16x32_bf16 a[56:59], v[88:91], v[140:143], a[56:59]
  s_and_b32 s24, s24, 0x1ffff
  v_mfma_f32_16x16x32_bf16 a[112:115], v[88:91], v[144:147], a[112:115]
  v_mfma_f32_16x16x32_bf16 a[120:123], v[88:91], v[148:151], a[120:123]
  s_bitcmp1_b32 s76, s28
  v_mfma_f32_16x16x32_bf16 a[176:179], v[88:91], v[152:155], a[176:179]
  s_cbranch_scc1 fa_hk1
fa_hb1:
  v_mfma_f32_16x16x32_bf16 a[184:187], v[88:91], v[156:159], a[184:187]
  v_mfma_f32_16x16x32_bf16 a[244:247], v[92:95], v[128:131], a[244:247]
  v_mfma_f32_16x16x32_bf16 a[252:255], v[92:95], v[132:135], a[252:255]
  s_add_u32 s28, s28, 1
  v_mfma_f32_16x16x32_bf16 a[52:55], v[92:95], v[136:139], a[52:55]
  v_mfma_f32_16x16x32_bf16 a[60:63], v[92:95], v[140:143], a[60:63]
  v_mfma_f32_16x16x32_bf16 a[116:119], v[92:95], v[144:147], a[116:119]
  v_mfma_f32_16x16x32_bf16 a[124:127], v[92:95], v[148:151], a[124:127]
  s_cmp_lt_u32 s28, 8
  v_mfma_f32_16x16x32_bf16 a[180:183], v[92:95], v[152:155], a[180:183]
  s_waitcnt lgkmcnt(0)
  v_mfma_f32_16x16x32_bf16 a[188:191], v[92:95], v[156:159], a[188:191]
  s_cbranch_scc1 fa_loopK
  s_mov_b32 s64, 16777216
  s_mov_b32 s76, 0x3e0293ee
  s_branch fa_p1epi
fa_roleV:
  ds_read_b128 v[32:35], v14 offset:0
  ds_read_b128 v[36:39], v14 offset:1024
  ds_read_b128 v[40:43], v14 offset:4096
  ds_read_b128 v[44:47], v14 offset:5120
  ds_read_b128 v[48:51], v14 offset:8192
  ds_read_b128 v[52:55], v14 offset:9216
  ds_read_b128 v[56:59], v14 offset:12288
  ds_read_b128 v[60:63], v14 offset:13312
  ds_read_b64_tr_b16 v[96:97], v12 offset:0
  ds_read_b64_tr_b16 v[98:99], v12 offset:1024
  ds_read_b64_tr_b16 v[100:101], v13 offset:0
  ds_read_b64_tr_b16 v[102:103], v13 offset:1024
  ds_read_b64_tr_b16 v[104:105], v12 offset:256
  ds_read_b64_tr_b16 v[106:107], v12 offset:1280
  ds_read_b64_tr_b16 v[108:109], v13 offset:256
  ds_read_b64_tr_b16 v[110:111], v13 offset:1280
  ds_read_b64_tr_b16 v[112:113], v12 offset:512
  ds_read_b64_tr_b16 v[114:115], v12 offset:1536
  ds_read_b64_tr_b16 v[116:117], v13 offset:512
  ds_read_b64_tr_b16 v[118:119], v13 offset:1536
  ds_read_b64_tr_b16 v[120:121], v12 offset:768
  ds_read_b64_tr_b16 v[122:123], v12 offset:1792
  ds_read_b64_tr_b16 v[124:125], v13 offset:768
  ds_read_b64_tr_b16 v[126:127], v13 offset:1792
  s_mov_b32 m0, s24
  s_nop 0
  buffer_load_dwordx4 v3, s[32:35], s26 offen offset:0 sc1 lds
  buffer_load_dwordx4 v4, s[32:35], s26 offen offset:1024 sc1 lds
  buffer_load_dwordx4 v5, s[32:35], s26 offen offset:2048 sc1 lds
  buffer_load_dwordx4 v6, s[32:35], s26 offen offset:3072 sc1 lds
  s_add_u32 m0, s24, 16384
  s_nop 0
  buffer_load_dwordx4 v8, s[36:39], s27 offen offset:0 lds
  buffer_load_dwordx4 v9, s[36:39], s27 offen offset:1024 lds
  buffer_load_dwordx4 v10, s[36:39], s27 offen offset:2048 lds
  buffer_load_dwordx4 v11, s[36:39], s27 offen offset:3072 lds
  s_add_u32 s26, s26, s79
  s_add_u32 s27, s27, s25
  s_add_u32 s24, s24, 32768
  s_and_b32 s24, s24, 0x1ffff
  buffer_load_dword v231, v19, s[32:35], 0 offen
  s_mov_b32 m0, s24
  s_nop 0
  buffer_load_dwordx4 v3, s[32:35], s26 offen offset:0 sc1 lds
  buffer_load_dwordx4 v4, s[32:35], s26 offen offset:1024 sc1 lds
  buffer_load_dwordx4 v5, s[32:35], s26 offen offset:2048 sc1 lds
  buffer_load_dwordx4 v6, s[32:35], s26 offen offset:3072 sc1 lds
  s_add_u32 m0, s24, 16384
  s_nop 0
  buffer_load_dwordx4 v8, s[36:39], s27 offen offset:0 lds
  buffer_load_dwordx4 v9, s[36:39], s27 offen offset:1024 lds
  buffer_load_dwordx4 v10, s[36:39], s27 offen offset:2048 lds
  buffer_load_dwordx4 v11, s[36:39], s27 offen offset:3072 lds
  s_add_u32 s26, s26, s79
  s_add_u32 s27, s27, s25
  s_add_u32 s24, s24, 32768
  s_and_b32 s24, s24, 0x1ffff
  s_waitcnt lgkmcnt(0)
.p2align 6
fa_loopV:
  v_mfma_f32_16x16x32_bf16 a[192:195], v[32:35], v[96:99], a[192:195]
  s_waitcnt vmcnt(17)
  v_mfma_f32_16x16x32_bf16 a[200:203], v[32:35], v[100:103], a[200:203]
  s_barrier
  v_mfma_f32_16x16x32_bf16 a[208:211], v[32:35], v[104:107], a[208:211]
  ds_read_b64_tr_b16 v[128:129], v12 offset:32768
  v_mfma_f32_16x16x32_bf16 a[216:219], v[32:35], v[108:111], a[216:219]
  v_mfma_f32_16x16x32_bf16 a[224:227], v[32:35], v[112:115], a[224:227]
  s_mov_b32 m0, s24
  ds_read_b64_tr_b16 v[130:131], v12 offset:33792
  v_mfma_f32_16x16x32_bf16 a[232:235], v[32:35], v[116:119], a[232:235]
  buffer_load_dwordx4 v3, s[32:35], s26 offen offset:0 sc1 lds
  v_mfma_f32_16x16x32_bf16 a[240:243], v[32:35], v[120:123], a[240:243]
  ds_read_b128 v[64:67], v14 offset:32768
  v_mfma_f32_16x16x32_bf16 a[248:251], v[32:35], v[124:127], a[248:251]
  buffer_load_dwordx4 v4, s[32:35], s26 offen offset:1024 sc1 lds
  v_mfma_f32_16x16x32_bf16 a[196:199], v[36:39], v[96:99], a[196:199]
  ds_read_b64_tr_b16 v[132:133], v13 offset:32768
  v_mfma_f32_16x16x32_bf16 a[204:207], v[36:39], v[100:103], a[204:207]
  buffer_load_dwordx4 v5, s[32:35], s26 offen offset:2048 sc1 lds
  v_mfma_f32_16x16x32_bf16 a[212:215], v[36:39], v[104:107], a[212:215]
  ds_read_b64_tr_b16 v[134:135], v13 offset:33792
  v_mfma_f32_16x16x32_bf16 a[220:223], v[36:39], v[108:111], a[220:223]
  buffer_load_dwordx4 v6, s[32:35], s26 offen offset:3072 sc1 lds
  v_mfma_f32_16x16x32_bf16 a[228:231], v[36:39], v[112:115], a[228:231]
  s_add_u32 m0, s24, 16384
  ds_read_b128 v[68:71], v14 offset:33792
  v_mfma_f32_16x16x32_bf16 a[236:239], v[36:39], v[116:119], a[236:239]
  buffer_load_dwordx4 v8, s[36:39], s27 offen offset:0 lds
  v_mfma_f32_16x16x32_bf16 a[244:247], v[36:39], v[120:123], a[244:247]
  ds_read_b64_tr_b16 v[136:137], v12 offset:33024
  v_mfma_f32_16x16x32_bf16 a[252:255], v[36:39], v[124:127], a[252:255]
  buffer_load_dwordx4 v9, s[36:39], s27 offen offset:1024 lds
  v_mfma_f32_16x16x32_bf16 a[0:3], v[40:43], v[96:99], a[0:3]
  ds_read_b64_tr_b16 v[138:139], v12 offset:34048
  v_mfma_f32_16x16x32_bf16 a[8:11], v[40:43], v[100:103], a[8:11]
  buffer_load_dwordx4 v10, s[36:39], s27 offen offset:2048 lds
  v_mfma_f32_16x16x32_bf16 a[16:19], v[40:43], v[104:107], a[16:19]
  ds_read_b128 v[72:75], v14 offset:36864
  v_mfma_f32_16x16x32_bf16 a[24:27], v[40:43], v[108:111], a[24:27]
  buffer_load_dwordx4 v11, s[36:39], s27 offen offset:3072 lds
  v_mfma_f32_16x16x32_bf16 a[32:35], v[40:43], v[112:115], a[32:35]
  ds_read_b64_tr_b16 v[140:141], v13 offset:33024
  v_mfma_f32_16x16x32_bf16 a[40:43], v[40:43], v[116:119], a[40:43]
  buffer_load_dword v231, v235, s[48:51], s74 offen sc1
  v_mfma_f32_16x16x32_bf16 a[48:51], v[40:43], v[120:123], a[48:51]
  s_add_u32 s74, s74, s73
  ds_read_b64_tr_b16 v[142:143], v13 offset:34048
  v_mfma_f32_16x16x32_bf16 a[56:59], v[40:43], v[124:127], a[56:59]
  s_bitcmp1_b32 s72, s28
  v_mfma_f32_16x16x32_bf16 a[4:7], v[44:47], v[96:99], a[4:7]
  s_cbranch_scc1 fa_hk2
fa_hb2:
  ds_read_b128 v[76:79], v14 offset:37888
  v_mfma_f32_16x16x32_bf16 a[12:15], v[44:47], v[100:103], a[12:15]
  v_mfma_f32_16x16x32_bf16 a[20:23], v[44:47], v[104:107], a[20:23]
  ds_read_b64_tr_b16 v[144:145], v12 offset:33280
  v_mfma_f32_16x16x32_bf16 a[28:31], v[44:47], v[108:111], a[28:31]
  v_mfma_f32_16x16x32_bf16 a[36:39], v[44:47], v[112:115], a[36:39]
  ds_read_b64_tr_b16 v[146:147], v12 offset:34304
  v_mfma_f32_16x16x32_bf16 a[44:47], v[44:47], v[116:119], a[44:47]
  v_mfma_f32_16x16x32_bf16 a[52:55], v[44:47], v[120:123], a[52:55]
  ds_read_b128 v[80:83], v14 offset:40960
  v_mfma_f32_16x16x32_bf16 a[60:63], v[44:47], v[124:127], a[60:63]
  v_mfma_f32_16x16x32_bf16 a[64:67], v[48:51], v[96:99], a[64:67]
  ds_read_b64_tr_b16 v[148:149], v13 offset:33280
  v_mfma_f32_16x16x32_bf16 a[72:75], v[48:51], v[100:103], a[72:75]
  v_mfma_f32_16x16x32_bf16 a[80:83], v[48:51], v[104:107], a[80:83]
  ds_read_b64_tr_b16 v[150:151], v13 offset:34304
  v_mfma_f32_16x16x32_bf16 a[88:91], v[48:51], v[108:111], a[88:91]
  v_mfma_f32_16x16x32_bf16 a[96:99], v[48:51], v[112:115], a[96:99]
  ds_read_b128 v[84:87], v14 offset:41984
  v_mfma_f32_16x16x32_bf16 a[104:107], v[48:51], v[116:119], a[104:107]
  v_mfma_f32_16x16x32_bf16 a[112:115], v[48:51], v[120:123], a[112:115]
  ds_read_b64_tr_b16 v[152:153], v12 offset:33536
  v_mfma_f32_16x16x32_bf16 a[120:123], v[48:51], v[124:127], a[120:123]
  v_mfma_f32_16x16x32_bf16 a[68:71], v[52:55], v[96:99], a[68:71]
  ds_read_b64_tr_b16 v[154:155], v12 offset:34560
  v_mfma_f32_16x16x32_bf16 a[76:79], v[52:55], v[100:103], a[76:79]
  v_mfma_f32_16x16x32_bf16 a[84:87], v[52:55], v[104:107], a[84:87]
  ds_read_b128 v[88:91], v14 offset:45056
  v_mfma_f32_16x16x32_bf16 a[92:95], v[52:55], v[108:111], a[92:95]
  v_mfma_f32_16x16x32_bf16 a[100:103], v[52:55], v[112:115], a[100:103]
  ds_read_b64_tr_b16 v[156:157], v13 offset:33536
  v_mfma_f32_16x16x32_bf16 a[108:111], v[52:55], v[116:119], a[108:111]
  v_mfma_f32_16x16x32_bf16 a[116:119], v[52:55], v[120:123], a[116:119]
  ds_read_b64_tr_b16 v[158:159], v13 offset:34560
  v_mfma_f32_16x16x32_bf16 a[124:127], v[52:55], v[124:127], a[124:127]
  v_mfma_f32_16x16x32_bf16 a[128:131], v[56:59], v[96:99], a[128:131]
  s_add_u32 s26, s26, s79
  ds_read_b128 v[92:95], v14 offset:46080
  v_mfma_f32_16x16x32_bf16 a[136:139], v[56:59], v[100:103], a[136:139]
  s_add_u32 s27, s27, s25
  v_mfma_f32_16x16x32_bf16 a[144:147], v[56:59], v[104:107], a[144:147]
  s_add_u32 s24, s24, 32768
  v_mfma_f32_16x16x32_bf16 a[152:155], v[56:59], v[108:111], a[152:155]
  s_and_b32 s24, s24, 0x1ffff
  v_mfma_f32_16x16x32_bf16 a[160:163], v[56:59], v[112:115], a[160:163]
  v_xor_b32 v14, 0x10000, v14
  v_mfma_f32_16x16x32_bf16 a[168:171], v[56:59], v[116:119], a[168:171]
  v_xor_b32 v12, 0x10000, v12
  v_mfma_f32_16x16x32_bf16 a[176:179], v[56:59], v[120:123], a[176:179]
  v_xor_b32 v13, 0x10000, v13
  v_mfma_f32_16x16x32_bf16 a[184:187], v[56:59], v[124:127], a[184:187]
  v_mfma_f32_16x16x32_bf16 a[132:135], v[60:63], v[96:99], a[132:135]
  v_mfma_f32_16x16x32_bf16 a[140:143], v[60:63], v[100:103], a[140:143]
  v_mfma_f32_16x16x32_bf16 a[148:151], v[60:63], v[104:107], a[148:151]
  v_mfma_f32_16x16x32_bf16 a[156:159], v[60:63], v[108:111], a[156:159]
  v_mfma_f32_16x16x32_bf16 a[164:167], v[60:63], v[112:115], a[164:167]
  v_mfma_f32_16x16x32_bf16 a[172:175], v[60:63], v[116:119], a[172:175]
  v_mfma_f32_16x16x32_bf16 a[180:183], v[60:63], v[120:123], a[180:183]
  v_mfma_f32_16x16x32_bf16 a[188:191], v[60:63], v[124:127], a[188:191]
  s_waitcnt lgkmcnt(0)
  v_mfma_f32_16x16x32_bf16 a[192:195], v[64:67], v[128:131], a[192:195]
  s_waitcnt vmcnt(18)
  v_mfma_f32_16x16x32_bf16 a[200:203], v[64:67], v[132:135], a[200:203]
  s_barrier
  v_mfma_f32_16x16x32_bf16 a[208:211], v[64:67], v[136:139], a[208:211]
  ds_read_b64_tr_b16 v[96:97], v12 offset:0
  v_mfma_f32_16x16x32_bf16 a[216:219], v[64:67], v[140:143], a[216:219]
  v_mfma_f32_16x16x32_bf16 a[224:227], v[64:67], v[144:147], a[224:227]
  s_mov_b32 m0, s24
  ds_read_b64_tr_b16 v[98:99], v12 offset:1024
  v_mfma_f32_16x16x32_bf16 a[232:235], v[64:67], v[148:151], a[232:235]
  buffer_load_dwordx4 v3, s[32:35], s26 offen offset:0 sc1 lds
  v_mfma_f32_16x16x32_bf16 a[240:243], v[64:67], v[152:155], a[240:243]
  ds_read_b128 v[32:35], v14 offset:0
  v_mfma_f32_16x16x32_bf16 a[248:251], v[64:67], v[156:159], a[248:251]
  v_mfma_f32_16x16x32_bf16 a[196:199], v[68:71], v[128:131], a[196:199]
  ds_read_b64_tr_b16 v[100:101], v13 offset:0
  v_mfma_f32_16x16x32_bf16 a[204:207], v[68:71], v[132:135], a[204:207]
  v_mfma_f32_16x16x32_bf16 a[212:215], v[68:71], v[136:139], a[212:215]
  ds_read_b64_tr_b16 v[102:103], v13 offset:1024
  v_mfma_f32_16x16x32_bf16 a[220:223], v[68:71], v[140:143], a[220:223]
  buffer_load_dwordx4 v4, s[32:35], s26 offen offset:1024 sc1 lds
  v_mfma_f32_16x16x32_bf16 a[228:231], v[68:71], v[144:147], a[228:231]
  ds_read_b128 v[36:39], v14 offset:1024
  v_mfma_f32_16x16x32_bf16 a[236:239], v[68:71], v[148:151], a[236:239]
  v_mfma_f32_16x16x32_bf16 a[244:247], v[68:71], v[152:155], a[244:247]
  ds_read_b64_tr_b16 v[104:105], v12 offset:256
  v_mfma_f32_16x16x32_bf16 a[252:255], v[68:71], v[156:159], a[252:255]
  v_mfma_f32_16x16x32_bf16 a[0:3], v[72:75], v[128:131], a[0:3]
  ds_read_b64_tr_b16 v[106:107], v12 offset:1280
  v_mfma_f32_16x16x32_bf16 a[8:11], v[72:75], v[132:135], a[8:11]
  buffer_load_dwordx4 v5, s[32:35], s26 offen offset:2048 sc1 lds
  v_mfma_f32_16x16x32_bf16 a[16:19], v[72:75], v[136:139], a[16:19]
  ds_read_b128 v[40:43], v14 offset:4096
  v_mfma_f32_16x16x32_bf16 a[24:27], v[72:75], v[140:143], a[24:27]
  v_mfma_f32_16x16x32_bf16 a[32:35], v[72:75], v[144:147], a[32:35]
  ds_read_b64_tr_b16 v[108:109], v13 offset:256
  v_mfma_f32_16x16x32_bf16 a[40:43], v[72:75], v[148:151], a[40:43]
  v_mfma_f32_16x16x32_bf16 a[48:51], v[72:75], v[152:155], a[48:51]
  ds_read_b64_tr_b16 v[110:111], v13 offset:1280
  v_mfma_f32_16x16x32_bf16 a[56:59], v[72:75], v[156:159], a[56:59]
  buffer_load_dwordx4 v6, s[32:35], s26 offen offset:3072 sc1 lds
  v_mfma_f32_16x16x32_bf16 a[4:7], v[76:79], v[128:131], a[4:7]
  ds_read_b128 v[44:47], v14 offset:5120
  v_mfma_f32_16x16x32_bf16 a[12:15], v[76:79], v[132:135], a[12:15]
  v_mfma_f32_16x16x32_bf16 a[20:23], v[76:79], v[136:139], a[20:23]
  ds_read_b64_tr_b16 v[112:113], v12 offset:512
  v_mfma_f32_16x16x32_bf16 a[28:31], v[76:79], v[140:143], a[28:31]
  v_mfma_f32_16x16x32_bf16 a[36:39], v[76:79], v[144:147], a[36:39]
  s_add_u32 m0, s24, 16384
  ds_read_b64_tr_b16 v[114:115], v12 offset:1536
  v_mfma_f32_16x16x32_bf16 a[44:47], v[76:79], v[148:151], a[44:47]
  buffer_load_dwordx4 v8, s[36:39], s27 offen offset:0 lds
  v_mfma_f32_16x16x32_bf16 a[52:55], v[76:79], v[152:155], a[52:55]
  ds_read_b128 v[48:51], v14 offset:8192
  v_mfma_f32_16x16x32_bf16 a[60:63], v[76:79], v[156:159], a[60:63]
  v_mfma_f32_16x16x32_bf16 a[64:67], v[80:83], v[128:131], a[64:67]
  ds_read_b64_tr_b16 v[116:117], v13 offset:512
  v_mfma_f32_16x16x32_bf16 a[72:75], v[80:83], v[132:135], a[72:75]
  v_mfma_f32_16x16x32_bf16 a[80:83], v[80:83], v[136:139], a[80:83]
  ds_read_b64_tr_b16 v[118:119], v13 offset:1536
  v_mfma_f32_16x16x32_bf16 a[88:91], v[80:83], v[140:143], a[88:91]
  buffer_load_dwordx4 v9, s[36:39], s27 offen offset:1024 lds
  v_mfma_f32_16x16x32_bf16 a[96:99], v[80:83], v[144:147], a[96:99]
  ds_read_b128 v[52:55], v14 offset:9216
  v_mfma_f32_16x16x32_bf16 a[104:107], v[80:83], v[148:151], a[104:107]
  v_mfma_f32_16x16x32_bf16 a[112:115], v[80:83], v[152:155], a[112:115]
  ds_read_b64_tr_b16 v[120:121], v12 offset:768
  v_mfma_f32_16x16x32_bf16 a[120:123], v[80:83], v[156:159], a[120:123]
  v_mfma_f32_16x16x32_bf16 a[68:71], v[84:87], v[128:131], a[68:71]
  ds_read_b64_tr_b16 v[122:123], v12 offset:1792
  v_mfma_f32_16x16x32_bf16 a[76:79], v[84:87], v[132:135], a[76:79]
  buffer_load_dwordx4 v10, s[36:39], s27 offen offset:2048 lds
  v_mfma_f32_16x16x32_bf16 a[84:87], v[84:87], v[136:139], a[84:87]
  ds_read_b128 v[56:59], v14 offset:12288
  v_mfma_f32_16x16x32_bf16 a[92:95], v[84:87], v[140:143], a[92:95]
  v_mfma_f32_16x16x32_bf16 a[100:103], v[84:87], v[144:147], a[100:103]
  ds_read_b64_tr_b16 v[124:125], v13 offset:768
  v_mfma_f32_16x16x32_bf16 a[108:111], v[84:87], v[148:151], a[108:111]
  v_mfma_f32_16x16x32_bf16 a[116:119], v[84:87], v[152:155], a[116:119]
  ds_read_b64_tr_b16 v[126:127], v13 offset:1792
  v_mfma_f32_16x16x32_bf16 a[124:127], v[84:87], v[156:159], a[124:127]
  buffer_load_dwordx4 v11, s[36:39], s27 offen offset:3072 lds
  v_mfma_f32_16x16x32_bf16 a[128:131], v[88:91], v[128:131], a[128:131]
  s_add_u32 s26, s26, s79
  ds_read_b128 v[60:63], v14 offset:13312
  v_mfma_f32_16x16x32_bf16 a[136:139], v[88:91], v[132:135], a[136:139]
  s_add_u32 s27, s27, s25
  v_mfma_f32_16x16x32_bf16 a[144:147], v[88:91], v[136:139], a[144:147]
  s_add_u32 s24, s24, 32768
  v_mfma_f32_16x16x32_bf16 a[152:155], v[88:91], v[140:143], a[152:155]
  s_and_b32 s24, s24, 0x1ffff
  v_mfma_f32_16x16x32_bf16 a[160:163], v[88:91], v[144:147], a[160:163]
  v_mfma_f32_16x16x32_bf16 a[168:171], v[88:91], v[148:151], a[168:171]
  s_bitcmp1_b32 s76, s28
  v_mfma_f32_16x16x32_bf16 a[176:179], v[88:91], v[152:155], a[176:179]
  s_cbranch_scc1 fa_hk3
fa_hb3:
  v_mfma_f32_16x16x32_bf16 a[184:187], v[88:91], v[156:159], a[184:187]
  v_mfma_f32_16x16x32_bf16 a[132:135], v[92:95], v[128:131], a[132:135]
  v_mfma_f32_16x16x32_bf16 a[140:143], v[92:95], v[132:135], a[140:143]
  s_add_u32 s28, s28, 1
  v_mfma_f32_16x16x32_bf16 a[148:151], v[92:95], v[136:139], a[148:151]
  v_mfma_f32_16x16x32_bf16 a[156:159], v[92:95], v[140:143], a[156:159]
  v_mfma_f32_16x16x32_bf16 a[164:167], v[92:95], v[144:147], a[164:167]
  v_mfma_f32_16x16x32_bf16 a[172:175], v[92:95], v[148:151], a[172:175]
  s_cmp_lt_u32 s28, 8
  v_mfma_f32_16x16x32_bf16 a[180:183], v[92:95], v[152:155], a[180:183]
  s_waitcnt lgkmcnt(0)
  v_mfma_f32_16x16x32_bf16 a[188:191], v[92:95], v[156:159], a[188:191]
  s_cbranch_scc1 fa_loopV
  s_mov_b32 s64, 33554432
  s_mov_b32 s76, 1.0
fa_p1epi:
  s_lshr_b32 s23, s20, 1
  s_lshl_b32 s23, s23, 13
  v_subrev_u32 v12, s23, v12
  v_subrev_u32 v13, s23, v13
  s_lshl_b32 s24, s20, 12
  v_add_u32 v14, s24, v2
  ds_read_b64_tr_b16 v[32:33], v12 offset:0
  ds_read_b64_tr_b16 v[34:35], v12 offset:1024
  ds_read_b64_tr_b16 v[36:37], v13 offset:0
  ds_read_b64_tr_b16 v[38:39], v13 offset:1024
  ds_read_b64_tr_b16 v[40:41], v12 offset:256
  ds_read_b64_tr_b16 v[42:43], v12 offset:1280
  ds_read_b64_tr_b16 v[44:45], v13 offset:256
  ds_read_b64_tr_b16 v[46:47], v13 offset:1280
  ds_read_b64_tr_b16 v[48:49], v12 offset:512
  ds_read_b64_tr_b16 v[50:51], v12 offset:1536
  ds_read_b64_tr_b16 v[52:53], v13 offset:512
  ds_read_b64_tr_b16 v[54:55], v13 offset:1536
  ds_read_b64_tr_b16 v[56:57], v12 offset:768
  ds_read_b64_tr_b16 v[58:59], v12 offset:1792
  ds_read_b64_tr_b16 v[60:61], v13 offset:768
  ds_read_b64_tr_b16 v[62:63], v13 offset:1792
  s_waitcnt vmcnt(8)
  ds_read_b128 v[224:227], v14 offset:0
  ds_read_b128 v[228:231], v14 offset:1024
  ds_read_b128 v[232:235], v14 offset:2048
  ds_read_b128 v[236:239], v14 offset:3072
  s_lshl_b32 s23, s21, 19
  s_add_u32 s64, s64, s23
  s_lshl_b32 s23, s22, 14
  s_add_u32 s64, s64, s23
  s_and_b32 s23, s20, 1
  s_lshl_b32 s23, s23, 13
  s_add_u32 s64, s64, s23
  s_lshl_b32 s23, s21, 19
  s_add_u32 s23, s23, 16777216
  s_add_u32 s6, s18, s23
  s_addc_u32 s7, s19, 0
  s_add_u32 s8, s6, 16777216
  s_addc_u32 s9, s7, 0
  s_sub_u32 s23, 16, s22
  s_lshl_b32 s23, s23, 15
  s_mov_b32 s44, s6
  s_mov_b32 s45, s7
  s_mov_b32 s46, s23
  s_mov_b32 s47, 0x20000
  s_mov_b32 s48, s8
  s_mov_b32 s49, s9
  s_mov_b32 s50, s23
  s_mov_b32 s51, 0x20000
  s_lshl_b32 s30, s21, 10
  s_add_u32 s30, s30, 67108864
  s_mov_b32 s81, 0x47800000
  s_cmp_eq_u32 s20, 0
  s_cselect_b32 s65, s82, 1073741824
  s_waitcnt vmcnt(21) lgkmcnt(0)
  v_mfma_f32_16x16x32_bf16 v[96:99], v[32:35], v[224:227], 0
  v_accvgpr_read_b32 v16, a192
  v_accvgpr_read_b32 v17, a193
  v_accvgpr_read_b32 v18, a194
  v_mfma_f32_16x16x32_bf16 v[112:115], v[36:39], v[224:227], 0
  ds_read_b64_tr_b16 v[64:65], v12 offset:8192
  v_accvgpr_read_b32 v19, a195
  v_mfma_f32_16x16x32_bf16 v[128:131], v[40:43], v[224:227], 0
  s_add_u32 m0, s24, 0
  ds_read_b64_tr_b16 v[66:67], v12 offset:9216
  v_accvgpr_read_b32 v20, a196
  v_mfma_f32_16x16x32_bf16 v[144:147], v[44:47], v[224:227], 0
  buffer_load_dwordx4 v3, s[32:35], s26 offen offset:0 sc1 lds
  v_accvgpr_read_b32 v21, a197
  v_mfma_f32_16x16x32_bf16 v[160:163], v[48:51], v[224:227], 0
  ds_read_b64_tr_b16 v[68:69], v13 offset:8192
  v_accvgpr_read_b32 v22, a198
  v_accvgpr_read_b32 v23, a199
  v_mfma_f32_16x16x32_bf16 v[176:179], v[52:55], v[224:227], 0
  ds_read_b64_tr_b16 v[70:71], v13 offset:9216
  v_mul_f32 v16, s76, v16
  v_mfma_f32_16x16x32_bf16 v[192:195], v[56:59], v[224:227], 0
  ds_read_b64_tr_b16 v[72:73], v12 offset:8448
  v_mul_f32 v17, s76, v17
  v_mfma_f32_16x16x32_bf16 v[208:211], v[60:63], v[224:227], 0
  ds_read_b64_tr_b16 v[74:75], v12 offset:9472
  v_mul_f32 v18, s76, v18
  v_mfma_f32_16x16x32_bf16 v[100:103], v[32:35], v[228:231], 0
  buffer_load_dwordx4 v4, s[32:35], s26 offen offset:1024 sc1 lds
  v_mul_f32 v19, s76, v19
  v_mul_f32 v20, s76, v20
  v_mfma_f32_16x16x32_bf16 v[116:119], v[36:39], v[228:231], 0
  ds_read_b64_tr_b16 v[76:77], v13 offset:8448
  v_mul_f32 v21, s76, v21
  v_mfma_f32_16x16x32_bf16 v[132:135], v[40:43], v[228:231], 0
  ds_read_b64_tr_b16 v[78:79], v13 offset:9472
  v_mul_f32 v22, s76, v22
  v_mfma_f32_16x16x32_bf16 v[148:151], v[44:47], v[228:231], 0
  ds_read_b128 v[240:243], v14 offset:32768
  v_mul_f32 v23, s76, v23
  v_mfma_f32_16x16x32_bf16 v[164:167], v[48:51], v[228:231], 0
  ds_read_b128 v[244:247], v14 offset:33792
  v_cvt_pk_bf16_f32 v24, v16, v17
  v_cvt_pk_bf16_f32 v25, v18, v19
  v_mfma_f32_16x16x32_bf16 v[180:183], v[52:55], v[228:231], 0
  buffer_load_dwordx4 v5, s[32:35], s26 offen offset:2048 sc1 lds
  v_cvt_pk_bf16_f32 v26, v20, v21
  v_mfma_f32_16x16x32_bf16 v[196:199], v[56:59], v[228:231], 0
  ds_read_b64_tr_b16 v[80:81], v12 offset:8704
  v_cvt_pk_bf16_f32 v27, v22, v23
  v_mfma_f32_16x16x32_bf16 v[212:215], v[60:63], v[228:231], 0
  ds_read_b64_tr_b16 v[82:83], v12 offset:9728
  buffer_store_dwordx4 v[24:27], v2, s[40:43], s64 offen offset:0 sc1
  v_mfma_f32_16x16x32_bf16 v[104:107], v[32:35], v[232:235], 0
  ds_read_b64_tr_b16 v[84:85], v13 offset:8704
  v_accvgpr_read_b32 v16, a200
  v_mfma_f32_16x16x32_bf16 v[120:123], v[36:39], v[232:235], 0
  ds_read_b64_tr_b16 v[86:87], v13 offset:9728
  v_accvgpr_read_b32 v17, a201
  v_accvgpr_read_b32 v18, a202
  v_mfma_f32_16x16x32_bf16 v[136:139], v[40:43], v[232:235], 0
  buffer_load_dwordx4 v6, s[32:35], s26 offen offset:3072 sc1 lds
  v_accvgpr_read_b32 v19, a203
  v_mfma_f32_16x16x32_bf16 v[152:155], v[44:47], v[232:235], 0
  s_add_u32 s26, s26, 1024
  ds_read_b64_tr_b16 v[88:89], v12 offset:8960
  v_accvgpr_read_b32 v20, a204
  v_mfma_f32_16x16x32_bf16 v[168:171], v[48:51], v[232:235], 0
  ds_read_b64_tr_b16 v[90:91], v12 offset:9984
  v_accvgpr_read_b32 v21, a205
  v_mfma_f32_16x16x32_bf16 v[184:187], v[52:55], v[232:235], 0
  ds_read_b64_tr_b16 v[92:93], v13 offset:8960
  v_accvgpr_read_b32 v22, a206
  v_accvgpr_read_b32 v23, a207
  v_mfma_f32_16x16x32_bf16 v[200:203], v[56:59], v[232:235], 0
  ds_read_b64_tr_b16 v[94:95], v13 offset:9984
  v_mul_f32 v16, s76, v16
  v_mfma_f32_16x16x32_bf16 v[216:219], v[60:63], v[232:235], 0
  v_mul_f32 v17, s76, v17
  v_mul_f32 v18, s76, v18
  v_mfma_f32_16x16x32_bf16 v[108:111], v[32:35], v[236:239], 0
  ds_read_b128 v[248:251], v14 offset:34816
  v_mul_f32 v19, s76, v19
  v_mfma_f32_16x16x32_bf16 v[124:127], v[36:39], v[236:239], 0
  ds_read_b128 v[252:255], v14 offset:35840
  v_mul_f32 v20, s76, v20
  v_mul_f32 v21, s76, v21
  v_mfma_f32_16x16x32_bf16 v[140:143], v[40:43], v[236:239], 0
  v_mul_f32 v22, s76, v22
  v_mul_f32 v23, s76, v23
  v_mfma_f32_16x16x32_bf16 v[156:159], v[44:47], v[236:239], 0
  v_xor_b32 v14, 0x10000, v14
  v_cvt_pk_bf16_f32 v28, v16, v17
  v_mfma_f32_16x16x32_bf16 v[172:175], v[48:51], v[236:239], 0
  v_cvt_pk_bf16_f32 v29, v18, v19
  v_cvt_pk_bf16_f32 v30, v20, v21
  v_mfma_f32_16x16x32_bf16 v[188:191], v[52:55], v[236:239], 0
  v_cvt_pk_bf16_f32 v31, v22, v23
  v_mfma_f32_16x16x32_bf16 v[204:207], v[56:59], v[236:239], 0
  buffer_store_dwordx4 v[28:31], v2, s[40:43], s64 offen offset:1024 sc1
  v_mfma_f32_16x16x32_bf16 v[220:223], v[60:63], v[236:239], 0
  s_waitcnt vmcnt(19) lgkmcnt(0)
  v_mfma_f32_16x16x32_bf16 v[96:99], v[64:67], v[240:243], v[96:99]
  s_barrier
  v_accvgpr_read_b32 v16, a208
  v_accvgpr_read_b32 v17, a209
  v_accvgpr_read_b32 v18, a210
  v_mfma_f32_16x16x32_bf16 v[112:115], v[68:71], v[240:243], v[112:115]
  ds_read_b64_tr_b16 v[32:33], v12 offset:32768
  v_accvgpr_read_b32 v19, a211
  v_mfma_f32_16x16x32_bf16 v[128:131], v[72:75], v[240:243], v[128:131]
  s_add_u32 m0, s24, 32768
  ds_read_b64_tr_b16 v[34:35], v12 offset:33792
  v_accvgpr_read_b32 v20, a212
  v_mfma_f32_16x16x32_bf16 v[144:147], v[76:79], v[240:243], v[144:147]
  buffer_load_dwordx4 v3, s[32:35], s26 offen offset:0 sc1 lds
  v_accvgpr_read_b32 v21, a213
  v_mfma_f32_16x16x32_bf16 v[160:163], v[80:83], v[240:243], v[160:163]
  ds_read_b64_tr_b16 v[36:37], v13 offset:32768
  v_accvgpr_read_b32 v22, a214
  v_accvgpr_read_b32 v23, a215
  v_mfma_f32_16x16x32_bf16 v[176:179], v[84:87], v[240:243], v[176:179]
  ds_read_b64_tr_b16 v[38:39], v13 offset:33792
  v_mul_f32 v16, s76, v16
  v_mfma_f32_16x16x32_bf16 v[192:195], v[88:91], v[240:243], v[192:195]
  ds_read_b64_tr_b16 v[40:41], v12 offset:33024
  v_mul_f32 v17, s76, v17
  v_mfma_f32_16x16x32_bf16 v[208:211], v[92:95], v[240:243], v[208:211]
  ds_read_b64_tr_b16 v[42:43], v12 offset:34048
  v_mul_f32 v18, s76, v18
  v_mfma_f32_16x16x32_bf16 v[100:103], v[64:67], v[244:247], v[100:103]
  buffer_load_dwordx4 v4, s[32:35], s26 offen offset:1024 sc1 lds
  v_mul_f32 v19, s76, v19
  v_mul_f32 v20, s76, v20
  v_mfma_f32_16x16x32_bf16 v[116:119], v[68:71], v[244:247], v[116:119]
  ds_read_b64_tr_b16 v[44:45], v13 offset:33024
  v_mul_f32 v21, s76, v21
  v_mfma_f32_16x16x32_bf16 v[132:135], v[72:75], v[244:247], v[132:135]
  ds_read_b64_tr_b16 v[46:47], v13 offset:34048
  v_mul_f32 v22, s76, v22
  v_mfma_f32_16x16x32_bf16 v[148:151], v[76:79], v[244:247], v[148:151]
  ds_read_b128 v[224:227], v14 offset:0
  v_mul_f32 v23, s76, v23
  v_mfma_f32_16x16x32_bf16 v[164:167], v[80:83], v[244:247], v[164:167]
  ds_read_b128 v[228:231], v14 offset:1024
  v_cvt_pk_bf16_f32 v24, v16, v17
  v_cvt_pk_bf16_f32 v25, v18, v19
  v_mfma_f32_16x16x32_bf16 v[180:183], v[84:87], v[244:247], v[180:183]
  buffer_load_dwordx4 v5, s[32:35], s26 offen offset:2048 sc1 lds
  v_cvt_pk_bf16_f32 v26, v20, v21
  v_mfma_f32_16x16x32_bf16 v[196:199], v[88:91], v[244:247], v[196:199]
  ds_read_b64_tr_b16 v[48:49], v12 offset:33280
  v_cvt_pk_bf16_f32 v27, v22, v23
  v_mfma_f32_16x16x32_bf16 v[212:215], v[92:95], v[244:247], v[212:215]
  ds_read_b64_tr_b16 v[50:51], v12 offset:34304
  buffer_store_dwordx4 v[24:27], v2, s[40:43], s64 offen offset:2048 sc1
  v_mfma_f32_16x16x32_bf16 v[104:107], v[64:67], v[248:251], v[104:107]
  ds_read_b64_tr_b16 v[52:53], v13 offset:33280
  v_accvgpr_read_b32 v16, a216
  v_mfma_f32_16x16x32_bf16 v[120:123], v[68:71], v[248:251], v[120:123]
  ds_read_b64_tr_b16 v[54:55], v13 offset:34304
  v_accvgpr_read_b32 v17, a217
  v_accvgpr_read_b32 v18, a218
  v_mfma_f32_16x16x32_bf16 v[136:139], v[72:75], v[248:251], v[136:139]
  buffer_load_dwordx4 v6, s[32:35], s26 offen offset:3072 sc1 lds
  v_accvgpr_read_b32 v19, a219
  v_mfma_f32_16x16x32_bf16 v[152:155], v[76:79], v[248:251], v[152:155]
  s_add_u32 s26, s26, 1024
  ds_read_b64_tr_b16 v[56:57], v12 offset:33536
  v_accvgpr_read_b32 v20, a220
  v_mfma_f32_16x16x32_bf16 v[168:171], v[80:83], v[248:251], v[168:171]
  ds_read_b64_tr_b16 v[58:59], v12 offset:34560
  v_accvgpr_read_b32 v21, a221
  v_mfma_f32_16x16x32_bf16 v[184:187], v[84:87], v[248:251], v[184:187]
  ds_read_b64_tr_b16 v[60:61], v13 offset:33536
  v_accvgpr_read_b32 v22, a222
  v_accvgpr_read_b32 v23, a223
  v_mfma_f32_16x16x32_bf16 v[200:203], v[88:91], v[248:251], v[200:203]
  s_add_u32 m0, s24, 16384
  ds_read_b64_tr_b16 v[62:63], v13 offset:34560
  v_mul_f32 v16, s76, v16
  v_mfma_f32_16x16x32_bf16 v[216:219], v[92:95], v[248:251], v[216:219]
  buffer_load_dwordx4 v8, s[36:39], s27 offen offset:0 lds
  v_mul_f32 v17, s76, v17
  v_mfma_f32_16x16x32_bf16 v[108:111], v[64:67], v[252:255], v[108:111]
  ds_read_b128 v[232:235], v14 offset:2048
  v_mul_f32 v18, s76, v18
  v_mfma_f32_16x16x32_bf16 v[124:127], v[68:71], v[252:255], v[124:127]
  ds_read_b128 v[236:239], v14 offset:3072
  v_mul_f32 v19, s76, v19
  v_mul_f32 v20, s76, v20
  v_mfma_f32_16x16x32_bf16 v[140:143], v[72:75], v[252:255], v[140:143]
  v_mul_f32 v21, s76, v21
  v_mul_f32 v22, s76, v22
  v_mfma_f32_16x16x32_bf16 v[156:159], v[76:79], v[252:255], v[156:159]
  v_mul_f32 v23, s76, v23
  v_cvt_pk_bf16_f32 v28, v16, v17
  v_mfma_f32_16x16x32_bf16 v[172:175], v[80:83], v[252:255], v[172:175]
  buffer_load_dwordx4 v9, s[36:39], s27 offen offset:1024 lds
  v_cvt_pk_bf16_f32 v29, v18, v19
  v_mfma_f32_16x16x32_bf16 v[188:191], v[84:87], v[252:255], v[188:191]
  v_cvt_pk_bf16_f32 v30, v20, v21
  v_cvt_pk_bf16_f32 v31, v22, v23
  v_mfma_f32_16x16x32_bf16 v[204:207], v[88:91], v[252:255], v[204:207]
  buffer_store_dwordx4 v[28:31], v2, s[40:43], s64 offen offset:3072 sc1
  v_mfma_f32_16x16x32_bf16 v[220:223], v[92:95], v[252:255], v[220:223]
  s_waitcnt vmcnt(18) lgkmcnt(0)
  v_mfma_f32_16x16x32_bf16 v[96:99], v[32:35], v[224:227], v[96:99]
  s_add_u32 s64, s64, 4096
  v_accvgpr_read_b32 v16, a224
  v_accvgpr_read_b32 v17, a225
  v_mfma_f32_16x16x32_bf16 v[112:115], v[36:39], v[224:227], v[112:115]
  ds_read_b64_tr_b16 v[64:65], v12 offset:40960
  v_accvgpr_read_b32 v18, a226
  v_mfma_f32_16x16x32_bf16 v[128:131], v[40:43], v[224:227], v[128:131]
  s_add_u32 m0, s24, 65536
  ds_read_b64_tr_b16 v[66:67], v12 offset:41984
  v_accvgpr_read_b32 v19, a227
  v_mfma_f32_16x16x32_bf16 v[144:147], v[44:47], v[224:227], v[144:147]
  buffer_load_dwordx4 v3, s[32:35], s26 offen offset:0 sc1 lds
  v_accvgpr_read_b32 v20, a228
  v_mfma_f32_16x16x32_bf16 v[160:163], v[48:51], v[224:227], v[160:163]
  ds_read_b64_tr_b16 v[68:69], v13 offset:40960
  v_accvgpr_read_b32 v21, a229
  v_mfma_f32_16x16x32_bf16 v[176:179], v[52:55], v[224:227], v[176:179]
  ds_read_b64_tr_b16 v[70:71], v13 offset:41984
  v_accvgpr_read_b32 v22, a230
  v_mfma_f32_16x16x32_bf16 v[192:195], v[56:59], v[224:227], v[192:195]
  ds_read_b64_tr_b16 v[72:73], v12 offset:41216
  v_accvgpr_read_b32 v23, a231
  v_mfma_f32_16x16x32_bf16 v[208:211], v[60:63], v[224:227], v[208:211]
  ds_read_b64_tr_b16 v[74:75], v12 offset:42240
  v_mul_f32 v16, s76, v16
  v_mfma_f32_16x16x32_bf16 v[100:103], v[32:35], v[228:231], v[100:103]
  buffer_load_dwordx4 v4, s[32:35], s26 offen offset:1024 sc1 lds
  v_mul_f32 v17, s76, v17
  v_mfma_f32_16x16x32_bf16 v[116:119], v[36:39], v[228:231], v[116:119]
  ds_read_b64_tr_b16 v[76:77], v13 offset:41216
  v_mul_f32 v18, s76, v18
  v_mfma_f32_16x16x32_bf16 v[132:135], v[40:43], v[228:231], v[132:135]
  ds_read_b64_tr_b16 v[78:79], v13 offset:42240
  v_mul_f32 v19, s76, v19
  v_mfma_f32_16x16x32_bf16 v[148:151], v[44:47], v[228:231], v[148:151]
  ds_read_b128 v[240:243], v14 offset:32768
  v_mul_f32 v20, s76, v20
  v_mfma_f32_16x16x32_bf16 v[164:167], v[48:51], v[228:231], v[164:167]
  ds_read_b128 v[244:247], v14 offset:33792
  v_mul_f32 v21, s76, v21
  v_mfma_f32_16x16x32_bf16 v[180:183], v[52:55], v[228:231], v[180:183]
  buffer_load_dwordx4 v5, s[32:35], s26 offen offset:2048 sc1 lds
  v_mul_f32 v22, s76, v22
  v_mfma_f32_16x16x32_bf16 v[196:199], v[56:59], v[228:231], v[196:199]
  ds_read_b64_tr_b16 v[80:81], v12 offset:41472
  v_mul_f32 v23, s76, v23
  v_mfma_f32_16x16x32_bf16 v[212:215], v[60:63], v[228:231], v[212:215]
  ds_read_b64_tr_b16 v[82:83], v12 offset:42496
  v_cvt_pk_bf16_f32 v24, v16, v17
  v_mfma_f32_16x16x32_bf16 v[104:107], v[32:35], v[232:235], v[104:107]
  ds_read_b64_tr_b16 v[84:85], v13 offset:41472
  v_cvt_pk_bf16_f32 v25, v18, v19
  v_mfma_f32_16x16x32_bf16 v[120:123], v[36:39], v[232:235], v[120:123]
  ds_read_b64_tr_b16 v[86:87], v13 offset:42496
  v_cvt_pk_bf16_f32 v26, v20, v21
  v_mfma_f32_16x16x32_bf16 v[136:139], v[40:43], v[232:235], v[136:139]
  buffer_load_dwordx4 v6, s[32:35], s26 offen offset:3072 sc1 lds
  v_cvt_pk_bf16_f32 v27, v22, v23
  v_mfma_f32_16x16x32_bf16 v[152:155], v[44:47], v[232:235], v[152:155]
  s_add_u32 s26, s26, 1024
  ds_read_b64_tr_b16 v[88:89], v12 offset:41728
  buffer_store_dwordx4 v[24:27], v2, s[40:43], s64 offen offset:0 sc1
  v_mfma_f32_16x16x32_bf16 v[168:171], v[48:51], v[232:235], v[168:171]
  ds_read_b64_tr_b16 v[90:91], v12 offset:42752
  v_mfma_f32_16x16x32_bf16 v[184:187], v[52:55], v[232:235], v[184:187]
  ds_read_b64_tr_b16 v[92:93], v13 offset:41728
  v_mfma_f32_16x16x32_bf16 v[200:203], v[56:59], v[232:235], v[200:203]
  s_add_u32 m0, s24, 16384
  ds_read_b64_tr_b16 v[94:95], v13 offset:42752
  v_mfma_f32_16x16x32_bf16 v[216:219], v[60:63], v[232:235], v[216:219]
  buffer_load_dwordx4 v10, s[36:39], s27 offen offset:2048 lds
  v_mfma_f32_16x16x32_bf16 v[108:111], v[32:35], v[236:239], v[108:111]
  ds_read_b128 v[248:251], v14 offset:34816
  v_mfma_f32_16x16x32_bf16 v[124:127], v[36:39], v[236:239], v[124:127]
  ds_read_b128 v[252:255], v14 offset:35840
  v_mfma_f32_16x16x32_bf16 v[140:143], v[40:43], v[236:239], v[140:143]
  v_mfma_f32_16x16x32_bf16 v[156:159], v[44:47], v[236:239], v[156:159]
  v_xor_b32 v14, 0x10000, v14
  v_mfma_f32_16x16x32_bf16 v[172:175], v[48:51], v[236:239], v[172:175]
  buffer_load_dwordx4 v11, s[36:39], s27 offen offset:3072 lds
  v_mfma_f32_16x16x32_bf16 v[188:191], v[52:55], v[236:239], v[188:191]
  s_add_u32 s27, s27, 524288
  v_xor_b32 v12, 0x10000, v12
  v_mfma_f32_16x16x32_bf16 v[204:207], v[56:59], v[236:239], v[204:207]
  v_xor_b32 v13, 0x10000, v13
  v_mfma_f32_16x16x32_bf16 v[220:223], v[60:63], v[236:239], v[220:223]
  s_waitcnt vmcnt(16) lgkmcnt(0)
  v_mfma_f32_16x16x32_bf16 v[96:99], v[64:67], v[240:243], v[96:99]
  s_barrier
  v_accvgpr_read_b32 v16, a232
  v_accvgpr_read_b32 v17, a233
  v_mfma_f32_16x16x32_bf16 v[112:115], v[68:71], v[240:243], v[112:115]
  ds_read_b64_tr_b16 v[32:33], v12 offset:0
  v_accvgpr_read_b32 v18, a234
  v_mfma_f32_16x16x32_bf16 v[128:131], v[72:75], v[240:243], v[128:131]
  s_add_u32 m0, s24, 98304
  ds_read_b64_tr_b16 v[34:35], v12 offset:1024
  v_accvgpr_read_b32 v19, a235
  v_mfma_f32_16x16x32_bf16 v[144:147], v[76:79], v[240:243], v[144:147]
  buffer_load_dwordx4 v3, s[32:35], s26 offen offset:0 sc1 lds
  v_accvgpr_read_b32 v20, a236
  v_mfma_f32_16x16x32_bf16 v[160:163], v[80:83], v[240:243], v[160:163]
  ds_read_b64_tr_b16 v[36:37], v13 offset:0
  v_accvgpr_read_b32 v21, a237
  v_mfma_f32_16x16x32_bf16 v[176:179], v[84:87], v[240:243], v[176:179]
  ds_read_b64_tr_b16 v[38:39], v13 offset:1024
  v_accvgpr_read_b32 v22, a238
  v_mfma_f32_16x16x32_bf16 v[192:195], v[88:91], v[240:243], v[192:195]
  ds_read_b64_tr_b16 v[40:41], v12 offset:256
  v_accvgpr_read_b32 v23, a239
  v_mfma_f32_16x16x32_bf16 v[208:211], v[92:95], v[240:243], v[208:211]
  ds_read_b64_tr_b16 v[42:43], v12 offset:1280
  v_mul_f32 v16, s76, v16
  v_mfma_f32_16x16x32_bf16 v[100:103], v[64:67], v[244:247], v[100:103]
  buffer_load_dwordx4 v4, s[32:35], s26 offen offset:1024 sc1 lds
  v_mul_f32 v17, s76, v17
  v_mfma_f32_16x16x32_bf16 v[116:119], v[68:71], v[244:247], v[116:119]
  ds_read_b64_tr_b16 v[44:45], v13 offset:256
  v_mul_f32 v18, s76, v18
  v_mfma_f32_16x16x32_bf16 v[132:135], v[72:75], v[244:247], v[132:135]
  ds_read_b64_tr_b16 v[46:47], v13 offset:1280
  v_mul_f32 v19, s76, v19
  v_mfma_f32_16x16x32_bf16 v[148:151], v[76:79], v[244:247], v[148:151]
  ds_read_b128 v[224:227], v14 offset:0
  v_mul_f32 v20, s76, v20
  v_mfma_f32_16x16x32_bf16 v[164:167], v[80:83], v[244:247], v[164:167]
  ds_read_b128 v[228:231], v14 offset:1024
  v_mul_f32 v21, s76, v21
  v_mfma_f32_16x16x32_bf16 v[180:183], v[84:87], v[244:247], v[180:183]
  buffer_load_dwordx4 v5, s[32:35], s26 offen offset:2048 sc1 lds
  v_mul_f32 v22, s76, v22
  v_mfma_f32_16x16x32_bf16 v[196:199], v[88:91], v[244:247], v[196:199]
  ds_read_b64_tr_b16 v[48:49], v12 offset:512
  v_mul_f32 v23, s76, v23
  v_mfma_f32_16x16x32_bf16 v[212:215], v[92:95], v[244:247], v[212:215]
  ds_read_b64_tr_b16 v[50:51], v12 offset:1536
  v_cvt_pk_bf16_f32 v28, v16, v17
  v_mfma_f32_16x16x32_bf16 v[104:107], v[64:67], v[248:251], v[104:107]
  ds_read_b64_tr_b16 v[52:53], v13 offset:512
  v_cvt_pk_bf16_f32 v29, v18, v19
  v_mfma_f32_16x16x32_bf16 v[120:123], v[68:71], v[248:251], v[120:123]
  ds_read_b64_tr_b16 v[54:55], v13 offset:1536
  v_cvt_pk_bf16_f32 v30, v20, v21
  v_mfma_f32_16x16x32_bf16 v[136:139], v[72:75], v[248:251], v[136:139]
  buffer_load_dwordx4 v6, s[32:35], s26 offen offset:3072 sc1 lds
  v_cvt_pk_bf16_f32 v31, v22, v23
  v_mfma_f32_16x16x32_bf16 v[152:155], v[76:79], v[248:251], v[152:155]
  s_add_u32 s26, s26, 1024
  ds_read_b64_tr_b16 v[56:57], v12 offset:768
  buffer_store_dwordx4 v[28:31], v2, s[40:43], s64 offen offset:1024 sc1
  v_mfma_f32_16x16x32_bf16 v[168:171], v[80:83], v[248:251], v[168:171]
  ds_read_b64_tr_b16 v[58:59], v12 offset:1792
  v_mfma_f32_16x16x32_bf16 v[184:187], v[84:87], v[248:251], v[184:187]
  ds_read_b64_tr_b16 v[60:61], v13 offset:768
  v_mfma_f32_16x16x32_bf16 v[200:203], v[88:91], v[248:251], v[200:203]
  s_add_u32 m0, s24, 49152
  ds_read_b64_tr_b16 v[62:63], v13 offset:1792
  v_mfma_f32_16x16x32_bf16 v[216:219], v[92:95], v[248:251], v[216:219]
  buffer_load_dwordx4 v8, s[36:39], s27 offen offset:0 lds
  v_mfma_f32_16x16x32_bf16 v[108:111], v[64:67], v[252:255], v[108:111]
  ds_read_b128 v[232:235], v14 offset:2048
  v_mfma_f32_16x16x32_bf16 v[124:127], v[68:71], v[252:255], v[124:127]
  ds_read_b128 v[236:239], v14 offset:3072
  v_mfma_f32_16x16x32_bf16 v[140:143], v[72:75], v[252:255], v[140:143]
  v_mfma_f32_16x16x32_bf16 v[156:159], v[76:79], v[252:255], v[156:159]
  v_mfma_f32_16x16x32_bf16 v[172:175], v[80:83], v[252:255], v[172:175]
  buffer_load_dwordx4 v9, s[36:39], s27 offen offset:1024 lds
  v_mfma_f32_16x16x32_bf16 v[188:191], v[84:87], v[252:255], v[188:191]
  v_mfma_f32_16x16x32_bf16 v[204:207], v[88:91], v[252:255], v[204:207]
  v_mfma_f32_16x16x32_bf16 v[220:223], v[92:95], v[252:255], v[220:223]
  s_waitcnt vmcnt(17) lgkmcnt(0)
  v_mfma_f32_16x16x32_bf16 v[96:99], v[32:35], v[224:227], v[96:99]
  v_accvgpr_read_b32 v16, a240
  v_accvgpr_read_b32 v17, a241
  v_mfma_f32_16x16x32_bf16 v[112:115], v[36:39], v[224:227], v[112:115]
  ds_read_b64_tr_b16 v[64:65], v12 offset:8192
  v_accvgpr_read_b32 v18, a242
  v_mfma_f32_16x16x32_bf16 v[128:131], v[40:43], v[224:227], v[128:131]
  s_add_u32 m0, s24, 0
  ds_read_b64_tr_b16 v[66:67], v12 offset:9216
  v_accvgpr_read_b32 v19, a243
  v_mfma_f32_16x16x32_bf16 v[144:147], v[44:47], v[224:227], v[144:147]
  buffer_load_dwordx4 v3, s[32:35], s26 offen offset:0 sc1 lds
  v_accvgpr_read_b32 v20, a244
  v_mfma_f32_16x16x32_bf16 v[160:163], v[48:51], v[224:227], v[160:163]
  ds_read_b64_tr_b16 v[68:69], v13 offset:8192
  v_accvgpr_read_b32 v21, a245
  v_mfma_f32_16x16x32_bf16 v[176:179], v[52:55], v[224:227], v[176:179]
  ds_read_b64_tr_b16 v[70:71], v13 offset:9216
  v_accvgpr_read_b32 v22, a246
  v_mfma_f32_16x16x32_bf16 v[192:195], v[56:59], v[224:227], v[192:195]
  ds_read_b64_tr_b16 v[72:73], v12 offset:8448
  v_accvgpr_read_b32 v23, a247
  v_mfma_f32_16x16x32_bf16 v[208:211], v[60:63], v[224:227], v[208:211]
  ds_read_b64_tr_b16 v[74:75], v12 offset:9472
  v_mul_f32 v16, s76, v16
  v_mfma_f32_16x16x32_bf16 v[100:103], v[32:35], v[228:231], v[100:103]
  buffer_load_dwordx4 v4, s[32:35], s26 offen offset:1024 sc1 lds
  v_mul_f32 v17, s76, v17
  v_mfma_f32_16x16x32_bf16 v[116:119], v[36:39], v[228:231], v[116:119]
  ds_read_b64_tr_b16 v[76:77], v13 offset:8448
  v_mul_f32 v18, s76, v18
  v_mfma_f32_16x16x32_bf16 v[132:135], v[40:43], v[228:231], v[132:135]
  ds_read_b64_tr_b16 v[78:79], v13 offset:9472
  v_mul_f32 v19, s76, v19
  v_mfma_f32_16x16x32_bf16 v[148:151], v[44:47], v[228:231], v[148:151]
  ds_read_b128 v[240:243], v14 offset:32768
  v_mul_f32 v20, s76, v20
  v_mfma_f32_16x16x32_bf16 v[164:167], v[48:51], v[228:231], v[164:167]
  ds_read_b128 v[244:247], v14 offset:33792
  v_mul_f32 v21, s76, v21
  v_mfma_f32_16x16x32_bf16 v[180:183], v[52:55], v[228:231], v[180:183]
  buffer_load_dwordx4 v5, s[32:35], s26 offen offset:2048 sc1 lds
  v_mul_f32 v22, s76, v22
  v_mfma_f32_16x16x32_bf16 v[196:199], v[56:59], v[228:231], v[196:199]
  ds_read_b64_tr_b16 v[80:81], v12 offset:8704
  v_mul_f32 v23, s76, v23
  v_mfma_f32_16x16x32_bf16 v[212:215], v[60:63], v[228:231], v[212:215]
  ds_read_b64_tr_b16 v[82:83], v12 offset:9728
  v_cvt_pk_bf16_f32 v24, v16, v17
  v_mfma_f32_16x16x32_bf16 v[104:107], v[32:35], v[232:235], v[104:107]
  ds_read_b64_tr_b16 v[84:85], v13 offset:8704
  v_cvt_pk_bf16_f32 v25, v18, v19
  v_mfma_f32_16x16x32_bf16 v[120:123], v[36:39], v[232:235], v[120:123]
  ds_read_b64_tr_b16 v[86:87], v13 offset:9728
  v_cvt_pk_bf16_f32 v26, v20, v21
  v_mfma_f32_16x16x32_bf16 v[136:139], v[40:43], v[232:235], v[136:139]
  buffer_load_dwordx4 v6, s[32:35], s26 offen offset:3072 sc1 lds
  v_cvt_pk_bf16_f32 v27, v22, v23
  v_mfma_f32_16x16x32_bf16 v[152:155], v[44:47], v[232:235], v[152:155]
  s_add_u32 s26, s26, 1024
  ds_read_b64_tr_b16 v[88:89], v12 offset:8960
  buffer_store_dwordx4 v[24:27], v2, s[40:43], s64 offen offset:2048 sc1
  v_mfma_f32_16x16x32_bf16 v[168:171], v[48:51], v[232:235], v[168:171]
  ds_read_b64_tr_b16 v[90:91], v12 offset:9984
  v_mfma_f32_16x16x32_bf16 v[184:187], v[52:55], v[232:235], v[184:187]
  ds_read_b64_tr_b16 v[92:93], v13 offset:8960
  v_mfma_f32_16x16x32_bf16 v[200:203], v[56:59], v[232:235], v[200:203]
  s_add_u32 m0, s24, 49152
  ds_read_b64_tr_b16 v[94:95], v13 offset:9984
  v_mfma_f32_16x16x32_bf16 v[216:219], v[60:63], v[232:235], v[216:219]
  buffer_load_dwordx4 v10, s[36:39], s27 offen offset:2048 lds
  v_mfma_f32_16x16x32_bf16 v[108:111], v[32:35], v[236:239], v[108:111]
  ds_read_b128 v[248:251], v14 offset:34816
  v_mfma_f32_16x16x32_bf16 v[124:127], v[36:39], v[236:239], v[124:127]
  ds_read_b128 v[252:255], v14 offset:35840
  v_mfma_f32_16x16x32_bf16 v[140:143], v[40:43], v[236:239], v[140:143]
  v_mfma_f32_16x16x32_bf16 v[156:159], v[44:47], v[236:239], v[156:159]
  v_xor_b32 v14, 0x10000, v14
  v_mfma_f32_16x16x32_bf16 v[172:175], v[48:51], v[236:239], v[172:175]
  buffer_load_dwordx4 v11, s[36:39], s27 offen offset:3072 lds
  v_mfma_f32_16x16x32_bf16 v[188:191], v[52:55], v[236:239], v[188:191]
  s_add_u32 s27, s27, 524288
  v_mfma_f32_16x16x32_bf16 v[204:207], v[56:59], v[236:239], v[204:207]
  v_mfma_f32_16x16x32_bf16 v[220:223], v[60:63], v[236:239], v[220:223]
  s_waitcnt vmcnt(17) lgkmcnt(0)
  v_mfma_f32_16x16x32_bf16 v[96:99], v[64:67], v[240:243], v[96:99]
  s_barrier
  v_accvgpr_read_b32 v16, a248
  v_accvgpr_read_b32 v17, a249
  v_mfma_f32_16x16x32_bf16 v[112:115], v[68:71], v[240:243], v[112:115]
  ds_read_b64_tr_b16 v[32:33], v12 offset:32768
  v_accvgpr_read_b32 v18, a250
  v_mfma_f32_16x16x32_bf16 v[128:131], v[72:75], v[240:243], v[128:131]
  s_add_u32 m0, s24, 32768
  ds_read_b64_tr_b16 v[34:35], v12 offset:33792
  v_accvgpr_read_b32 v19, a251
  v_mfma_f32_16x16x32_bf16 v[144:147], v[76:79], v[240:243], v[144:147]
  buffer_load_dwordx4 v3, s[32:35], s26 offen offset:0 sc1 lds
  v_accvgpr_read_b32 v20, a252
  v_mfma_f32_16x16x32_bf16 v[160:163], v[80:83], v[240:243], v[160:163]
  ds_read_b64_tr_b16 v[36:37], v13 offset:32768
  v_accvgpr_read_b32 v21, a253
  v_mfma_f32_16x16x32_bf16 v[176:179], v[84:87], v[240:243], v[176:179]
  ds_read_b64_tr_b16 v[38:39], v13 offset:33792
  v_accvgpr_read_b32 v22, a254
  v_mfma_f32_16x16x32_bf16 v[192:195], v[88:91], v[240:243], v[192:195]
  ds_read_b64_tr_b16 v[40:41], v12 offset:33024
  v_accvgpr_read_b32 v23, a255
  v_mfma_f32_16x16x32_bf16 v[208:211], v[92:95], v[240:243], v[208:211]
  ds_read_b64_tr_b16 v[42:43], v12 offset:34048
  v_mul_f32 v16, s76, v16
  v_mfma_f32_16x16x32_bf16 v[100:103], v[64:67], v[244:247], v[100:103]
  buffer_load_dwordx4 v4, s[32:35], s26 offen offset:1024 sc1 lds
  v_mul_f32 v17, s76, v17
  v_mfma_f32_16x16x32_bf16 v[116:119], v[68:71], v[244:247], v[116:119]
  ds_read_b64_tr_b16 v[44:45], v13 offset:33024
  v_mul_f32 v18, s76, v18
  v_mfma_f32_16x16x32_bf16 v[132:135], v[72:75], v[244:247], v[132:135]
  ds_read_b64_tr_b16 v[46:47], v13 offset:34048
  v_mul_f32 v19, s76, v19
  v_mfma_f32_16x16x32_bf16 v[148:151], v[76:79], v[244:247], v[148:151]
  ds_read_b128 v[224:227], v14 offset:0
  v_mul_f32 v20, s76, v20
  v_mfma_f32_16x16x32_bf16 v[164:167], v[80:83], v[244:247], v[164:167]
  ds_read_b128 v[228:231], v14 offset:1024
  v_mul_f32 v21, s76, v21
  v_mfma_f32_16x16x32_bf16 v[180:183], v[84:87], v[244:247], v[180:183]
  buffer_load_dwordx4 v5, s[32:35], s26 offen offset:2048 sc1 lds
  v_mul_f32 v22, s76, v22
  v_mfma_f32_16x16x32_bf16 v[196:199], v[88:91], v[244:247], v[196:199]
  ds_read_b64_tr_b16 v[48:49], v12 offset:33280
  v_mul_f32 v23, s76, v23
  v_mfma_f32_16x16x32_bf16 v[212:215], v[92:95], v[244:247], v[212:215]
  ds_read_b64_tr_b16 v[50:51], v12 offset:34304
  v_cvt_pk_bf16_f32 v28, v16, v17
  v_mfma_f32_16x16x32_bf16 v[104:107], v[64:67], v[248:251], v[104:107]
  ds_read_b64_tr_b16 v[52:53], v13 offset:33280
  v_cvt_pk_bf16_f32 v29, v18, v19
  v_mfma_f32_16x16x32_bf16 v[120:123], v[68:71], v[248:251], v[120:123]
  ds_read_b64_tr_b16 v[54:55], v13 offset:34304
  v_cvt_pk_bf16_f32 v30, v20, v21
  v_mfma_f32_16x16x32_bf16 v[136:139], v[72:75], v[248:251], v[136:139]
  buffer_load_dwordx4 v6, s[32:35], s26 offen offset:3072 sc1 lds
  v_cvt_pk_bf16_f32 v31, v22, v23
  v_mfma_f32_16x16x32_bf16 v[152:155], v[76:79], v[248:251], v[152:155]
  s_add_u32 s26, s26, 1024
  ds_read_b64_tr_b16 v[56:57], v12 offset:33536
  buffer_store_dwordx4 v[28:31], v2, s[40:43], s64 offen offset:3072 sc1
  v_mfma_f32_16x16x32_bf16 v[168:171], v[80:83], v[248:251], v[168:171]
  ds_read_b64_tr_b16 v[58:59], v12 offset:34560
  v_mfma_f32_16x16x32_bf16 v[184:187], v[84:87], v[248:251], v[184:187]
  ds_read_b64_tr_b16 v[60:61], v13 offset:33536
  v_mfma_f32_16x16x32_bf16 v[200:203], v[88:91], v[248:251], v[200:203]
  s_add_u32 m0, s24, 81920
  ds_read_b64_tr_b16 v[62:63], v13 offset:34560
  v_mfma_f32_16x16x32_bf16 v[216:219], v[92:95], v[248:251], v[216:219]
  buffer_load_dwordx4 v8, s[36:39], s27 offen offset:0 lds
  v_mfma_f32_16x16x32_bf16 v[108:111], v[64:67], v[252:255], v[108:111]
  ds_read_b128 v[232:235], v14 offset:2048
  v_mfma_f32_16x16x32_bf16 v[124:127], v[68:71], v[252:255], v[124:127]
  ds_read_b128 v[236:239], v14 offset:3072
  v_mfma_f32_16x16x32_bf16 v[140:143], v[72:75], v[252:255], v[140:143]
  v_mfma_f32_16x16x32_bf16 v[156:159], v[76:79], v[252:255], v[156:159]
  v_mfma_f32_16x16x32_bf16 v[172:175], v[80:83], v[252:255], v[172:175]
  buffer_load_dwordx4 v9, s[36:39], s27 offen offset:1024 lds
  v_mfma_f32_16x16x32_bf16 v[188:191], v[84:87], v[252:255], v[188:191]
  v_mfma_f32_16x16x32_bf16 v[204:207], v[88:91], v[252:255], v[204:207]
  v_mfma_f32_16x16x32_bf16 v[220:223], v[92:95], v[252:255], v[220:223]
  s_waitcnt vmcnt(17) lgkmcnt(0)
  v_mfma_f32_16x16x32_bf16 v[96:99], v[32:35], v[224:227], v[96:99]
  s_add_u32 s64, s64, 126976
  v_accvgpr_read_b32 v16, a0
  v_accvgpr_read_b32 v17, a1
  v_mfma_f32_16x16x32_bf16 v[112:115], v[36:39], v[224:227], v[112:115]
  ds_read_b64_tr_b16 v[64:65], v12 offset:40960
  v_accvgpr_read_b32 v18, a2
  v_mfma_f32_16x16x32_bf16 v[128:131], v[40:43], v[224:227], v[128:131]
  s_add_u32 m0, s24, 65536
  ds_read_b64_tr_b16 v[66:67], v12 offset:41984
  v_accvgpr_read_b32 v19, a3
  v_mfma_f32_16x16x32_bf16 v[144:147], v[44:47], v[224:227], v[144:147]
  buffer_load_dwordx4 v3, s[32:35], s26 offen offset:0 sc1 lds
  v_accvgpr_read_b32 v20, a4
  v_mfma_f32_16x16x32_bf16 v[160:163], v[48:51], v[224:227], v[160:163]
  ds_read_b64_tr_b16 v[68:69], v13 offset:40960
  v_accvgpr_read_b32 v21, a5
  v_mfma_f32_16x16x32_bf16 v[176:179], v[52:55], v[224:227], v[176:179]
  ds_read_b64_tr_b16 v[70:71], v13 offset:41984
  v_accvgpr_read_b32 v22, a6
  v_mfma_f32_16x16x32_bf16 v[192:195], v[56:59], v[224:227], v[192:195]
  ds_read_b64_tr_b16 v[72:73], v12 offset:41216
  v_accvgpr_read_b32 v23, a7
  v_mfma_f32_16x16x32_bf16 v[208:211], v[60:63], v[224:227], v[208:211]
  ds_read_b64_tr_b16 v[74:75], v12 offset:42240
  v_mul_f32 v16, s76, v16
  v_mfma_f32_16x16x32_bf16 v[100:103], v[32:35], v[228:231], v[100:103]
  buffer_load_dwordx4 v4, s[32:35], s26 offen offset:1024 sc1 lds
  v_mul_f32 v17, s76, v17
  v_mfma_f32_16x16x32_bf16 v[116:119], v[36:39], v[228:231], v[116:119]
  ds_read_b64_tr_b16 v[76:77], v13 offset:41216
  v_mul_f32 v18, s76, v18
  v_mfma_f32_16x16x32_bf16 v[132:135], v[40:43], v[228:231], v[132:135]
  ds_read_b64_tr_b16 v[78:79], v13 offset:42240
  v_mul_f32 v19, s76, v19
  v_mfma_f32_16x16x32_bf16 v[148:151], v[44:47], v[228:231], v[148:151]
  ds_read_b128 v[240:243], v14 offset:32768
  v_mul_f32 v20, s76, v20
  v_mfma_f32_16x16x32_bf16 v[164:167], v[48:51], v[228:231], v[164:167]
  ds_read_b128 v[244:247], v14 offset:33792
  v_mul_f32 v21, s76, v21
  v_mfma_f32_16x16x32_bf16 v[180:183], v[52:55], v[228:231], v[180:183]
  buffer_load_dwordx4 v5, s[32:35], s26 offen offset:2048 sc1 lds
  v_mul_f32 v22, s76, v22
  v_mfma_f32_16x16x32_bf16 v[196:199], v[56:59], v[228:231], v[196:199]
  ds_read_b64_tr_b16 v[80:81], v12 offset:41472
  v_mul_f32 v23, s76, v23
  v_mfma_f32_16x16x32_bf16 v[212:215], v[60:63], v[228:231], v[212:215]
  ds_read_b64_tr_b16 v[82:83], v12 offset:42496
  v_cvt_pk_bf16_f32 v24, v16, v17
  v_mfma_f32_16x16x32_bf16 v[104:107], v[32:35], v[232:235], v[104:107]
  ds_read_b64_tr_b16 v[84:85], v13 offset:41472
  v_cvt_pk_bf16_f32 v25, v18, v19
  v_mfma_f32_16x16x32_bf16 v[120:123], v[36:39], v[232:235], v[120:123]
  ds_read_b64_tr_b16 v[86:87], v13 offset:42496
  v_cvt_pk_bf16_f32 v26, v20, v21
  v_mfma_f32_16x16x32_bf16 v[136:139], v[40:43], v[232:235], v[136:139]
  buffer_load_dwordx4 v6, s[32:35], s26 offen offset:3072 sc1 lds
  v_cvt_pk_bf16_f32 v27, v22, v23
  v_mfma_f32_16x16x32_bf16 v[152:155], v[44:47], v[232:235], v[152:155]
  s_add_u32 s26, s26, 1024
  ds_read_b64_tr_b16 v[88:89], v12 offset:41728
  buffer_store_dwordx4 v[24:27], v2, s[40:43], s64 offen offset:0 sc1
  v_mfma_f32_16x16x32_bf16 v[168:171], v[48:51], v[232:235], v[168:171]
  ds_read_b64_tr_b16 v[90:91], v12 offset:42752
  v_mfma_f32_16x16x32_bf16 v[184:187], v[52:55], v[232:235], v[184:187]
  ds_read_b64_tr_b16 v[92:93], v13 offset:41728
  v_mfma_f32_16x16x32_bf16 v[200:203], v[56:59], v[232:235], v[200:203]
  s_add_u32 m0, s24, 81920
  ds_read_b64_tr_b16 v[94:95], v13 offset:42752
  v_mfma_f32_16x16x32_bf16 v[216:219], v[60:63], v[232:235], v[216:219]
  buffer_load_dwordx4 v10, s[36:39], s27 offen offset:2048 lds
  v_mfma_f32_16x16x32_bf16 v[108:111], v[32:35], v[236:239], v[108:111]
  ds_read_b128 v[248:251], v14 offset:34816
  v_mfma_f32_16x16x32_bf16 v[124:127], v[36:39], v[236:239], v[124:127]
  ds_read_b128 v[252:255], v14 offset:35840
  v_mfma_f32_16x16x32_bf16 v[140:143], v[40:43], v[236:239], v[140:143]
  v_mfma_f32_16x16x32_bf16 v[156:159], v[44:47], v[236:239], v[156:159]
  v_xor_b32 v14, 0x10000, v14
  v_mfma_f32_16x16x32_bf16 v[172:175], v[48:51], v[236:239], v[172:175]
  buffer_load_dwordx4 v11, s[36:39], s27 offen offset:3072 lds
  v_mfma_f32_16x16x32_bf16 v[188:191], v[52:55], v[236:239], v[188:191]
  s_add_u32 s27, s27, 524288
  v_xor_b32 v12, 0x10000, v12
  v_mfma_f32_16x16x32_bf16 v[204:207], v[56:59], v[236:239], v[204:207]
  v_xor_b32 v13, 0x10000, v13
  v_mfma_f32_16x16x32_bf16 v[220:223], v[60:63], v[236:239], v[220:223]
  s_waitcnt vmcnt(9) lgkmcnt(0)
  v_mfma_f32_16x16x32_bf16 v[96:99], v[64:67], v[240:243], v[96:99]
  s_barrier
  buffer_store_dword v12, off, s[40:43], s65 sc1
  v_accvgpr_read_b32 v16, a8
  v_mfma_f32_16x16x32_bf16 v[112:115], v[68:71], v[240:243], v[112:115]
  ds_read_b64_tr_b16 v[32:33], v12 offset:0
  v_accvgpr_read_b32 v17, a9
  v_mfma_f32_16x16x32_bf16 v[128:131], v[72:75], v[240:243], v[128:131]
  s_add_u32 m0, s24, 98304
  ds_read_b64_tr_b16 v[34:35], v12 offset:1024
  v_accvgpr_read_b32 v18, a10
  v_mfma_f32_16x16x32_bf16 v[144:147], v[76:79], v[240:243], v[144:147]
  buffer_load_dwordx4 v3, s[32:35], s26 offen offset:0 sc1 lds
  v_accvgpr_read_b32 v19, a11
  v_mfma_f32_16x16x32_bf16 v[160:163], v[80:83], v[240:243], v[160:163]
  ds_read_b64_tr_b16 v[36:37], v13 offset:0
  v_accvgpr_read_b32 v20, a12
  v_mfma_f32_16x16x32_bf16 v[176:179], v[84:87], v[240:243], v[176:179]
  ds_read_b64_tr_b16 v[38:39], v13 offset:1024
  v_accvgpr_read_b32 v21, a13
  v_mfma_f32_16x16x32_bf16 v[192:195], v[88:91], v[240:243], v[192:195]
  ds_read_b64_tr_b16 v[40:41], v12 offset:256
  v_accvgpr_read_b32 v22, a14
  v_mfma_f32_16x16x32_bf16 v[208:211], v[92:95], v[240:243], v[208:211]
  ds_read_b64_tr_b16 v[42:43], v12 offset:1280
  v_accvgpr_read_b32 v23, a15
  v_mfma_f32_16x16x32_bf16 v[100:103], v[64:67], v[244:247], v[100:103]
  buffer_load_dwordx4 v4, s[32:35], s26 offen offset:1024 sc1 lds
  v_mul_f32 v16, s76, v16
  v_mfma_f32_16x16x32_bf16 v[116:119], v[68:71], v[244:247], v[116:119]
  ds_read_b64_tr_b16 v[44:45], v13 offset:256
  v_mul_f32 v17, s76, v17
  v_mfma_f32_16x16x32_bf16 v[132:135], v[72:75], v[244:247], v[132:135]
  ds_read_b64_tr_b16 v[46:47], v13 offset:1280
  v_mul_f32 v18, s76, v18
  v_mfma_f32_16x16x32_bf16 v[148:151], v[76:79], v[244:247], v[148:151]
  ds_read_b128 v[224:227], v14 offset:0
  v_mul_f32 v19, s76, v19
  v_mfma_f32_16x16x32_bf16 v[164:167], v[80:83], v[244:247], v[164:167]
  ds_read_b128 v[228:231], v14 offset:1024
  v_mul_f32 v20, s76, v20
  v_mfma_f32_16x16x32_bf16 v[180:183], v[84:87], v[244:247], v[180:183]
  buffer_load_dwordx4 v5, s[32:35], s26 offen offset:2048 sc1 lds
  v_mul_f32 v21, s76, v21
  v_mfma_f32_16x16x32_bf16 v[196:199], v[88:91], v[244:247], v[196:199]
  ds_read_b64_tr_b16 v[48:49], v12 offset:512
  v_mul_f32 v22, s76, v22
  v_mfma_f32_16x16x32_bf16 v[212:215], v[92:95], v[244:247], v[212:215]
  ds_read_b64_tr_b16 v[50:51], v12 offset:1536
  v_mul_f32 v23, s76, v23
  v_mfma_f32_16x16x32_bf16 v[104:107], v[64:67], v[248:251], v[104:107]
  ds_read_b64_tr_b16 v[52:53], v13 offset:512
  v_cvt_pk_bf16_f32 v28, v16, v17
  v_mfma_f32_16x16x32_bf16 v[120:123], v[68:71], v[248:251], v[120:123]
  ds_read_b64_tr_b16 v[54:55], v13 offset:1536
  v_cvt_pk_bf16_f32 v29, v18, v19
  v_mfma_f32_16x16x32_bf16 v[136:139], v[72:75], v[248:251], v[136:139]
  buffer_load_dwordx4 v6, s[32:35], s26 offen offset:3072 sc1 lds
  v_cvt_pk_bf16_f32 v30, v20, v21
  v_mfma_f32_16x16x32_bf16 v[152:155], v[76:79], v[248:251], v[152:155]
  s_add_u32 s26, s26, 1024
  ds_read_b64_tr_b16 v[56:57], v12 offset:768
  v_cvt_pk_bf16_f32 v31, v22, v23
  v_mfma_f32_16x16x32_bf16 v[168:171], v[80:83], v[248:251], v[168:171]
  ds_read_b64_tr_b16 v[58:59], v12 offset:1792
  buffer_store_dwordx4 v[28:31], v2, s[40:43], s64 offen offset:1024 sc1
  v_mfma_f32_16x16x32_bf16 v[184:187], v[84:87], v[248:251], v[184:187]
  ds_read_b64_tr_b16 v[60:61], v13 offset:768
  v_mfma_f32_16x16x32_bf16 v[200:203], v[88:91], v[248:251], v[200:203]
  s_add_u32 m0, s24, 114688
  ds_read_b64_tr_b16 v[62:63], v13 offset:1792
  v_mfma_f32_16x16x32_bf16 v[216:219], v[92:95], v[248:251], v[216:219]
  buffer_load_dwordx4 v8, s[36:39], s27 offen offset:0 lds
  v_mfma_f32_16x16x32_bf16 v[108:111], v[64:67], v[252:255], v[108:111]
  ds_read_b128 v[232:235], v14 offset:2048
  v_mfma_f32_16x16x32_bf16 v[124:127], v[68:71], v[252:255], v[124:127]
  ds_read_b128 v[236:239], v14 offset:3072
  v_mfma_f32_16x16x32_bf16 v[140:143], v[72:75], v[252:255], v[140:143]
  v_mfma_f32_16x16x32_bf16 v[156:159], v[76:79], v[252:255], v[156:159]
  v_mfma_f32_16x16x32_bf16 v[172:175], v[80:83], v[252:255], v[172:175]
  buffer_load_dwordx4 v9, s[36:39], s27 offen offset:1024 lds
  v_mfma_f32_16x16x32_bf16 v[188:191], v[84:87], v[252:255], v[188:191]
  v_mfma_f32_16x16x32_bf16 v[204:207], v[88:91], v[252:255], v[204:207]
  v_mfma_f32_16x16x32_bf16 v[220:223], v[92:95], v[252:255], v[220:223]
  s_waitcnt vmcnt(18) lgkmcnt(0)
  v_mfma_f32_16x16x32_bf16 v[96:99], v[32:35], v[224:227], v[96:99]
  v_accvgpr_read_b32 v16, a16
  v_accvgpr_read_b32 v17, a17
  v_mfma_f32_16x16x32_bf16 v[112:115], v[36:39], v[224:227], v[112:115]
  ds_read_b64_tr_b16 v[64:65], v12 offset:8192
  v_accvgpr_read_b32 v18, a18
  v_mfma_f32_16x16x32_bf16 v[128:131], v[40:43], v[224:227], v[128:131]
  s_add_u32 m0, s24, 0
  ds_read_b64_tr_b16 v[66:67], v12 offset:9216
  v_accvgpr_read_b32 v19, a19
  v_mfma_f32_16x16x32_bf16 v[144:147], v[44:47], v[224:227], v[144:147]
  buffer_load_dwordx4 v3, s[32:35], s26 offen offset:0 sc1 lds
  v_accvgpr_read_b32 v20, a20
  v_mfma_f32_16x16x32_bf16 v[160:163], v[48:51], v[224:227], v[160:163]
  ds_read_b64_tr_b16 v[68:69], v13 offset:8192
  v_accvgpr_read_b32 v21, a21
  v_mfma_f32_16x16x32_bf16 v[176:179], v[52:55], v[224:227], v[176:179]
  ds_read_b64_tr_b16 v[70:71], v13 offset:9216
  v_accvgpr_read_b32 v22, a22
  v_mfma_f32_16x16x32_bf16 v[192:195], v[56:59], v[224:227], v[192:195]
  ds_read_b64_tr_b16 v[72:73], v12 offset:8448
  v_accvgpr_read_b32 v23, a23
  v_mfma_f32_16x16x32_bf16 v[208:211], v[60:63], v[224:227], v[208:211]
  ds_read_b64_tr_b16 v[74:75], v12 offset:9472
  v_mul_f32 v16, s76, v16
  v_mfma_f32_16x16x32_bf16 v[100:103], v[32:35], v[228:231], v[100:103]
  buffer_load_dwordx4 v4, s[32:35], s26 offen offset:1024 sc1 lds
  v_mul_f32 v17, s76, v17
  v_mfma_f32_16x16x32_bf16 v[116:119], v[36:39], v[228:231], v[116:119]
  ds_read_b64_tr_b16 v[76:77], v13 offset:8448
  v_mul_f32 v18, s76, v18
  v_mfma_f32_16x16x32_bf16 v[132:135], v[40:43], v[228:231], v[132:135]
  ds_read_b64_tr_b16 v[78:79], v13 offset:9472
  v_mul_f32 v19, s76, v19
  v_mfma_f32_16x16x32_bf16 v[148:151], v[44:47], v[228:231], v[148:151]
  ds_read_b128 v[240:243], v14 offset:32768
  v_mul_f32 v20, s76, v20
  v_mfma_f32_16x16x32_bf16 v[164:167], v[48:51], v[228:231], v[164:167]
  ds_read_b128 v[244:247], v14 offset:33792
  v_mul_f32 v21, s76, v21
  v_mfma_f32_16x16x32_bf16 v[180:183], v[52:55], v[228:231], v[180:183]
  buffer_load_dwordx4 v5, s[32:35], s26 offen offset:2048 sc1 lds
  v_mul_f32 v22, s76, v22
  v_mfma_f32_16x16x32_bf16 v[196:199], v[56:59], v[228:231], v[196:199]
  ds_read_b64_tr_b16 v[80:81], v12 offset:8704
  v_mul_f32 v23, s76, v23
  v_mfma_f32_16x16x32_bf16 v[212:215], v[60:63], v[228:231], v[212:215]
  ds_read_b64_tr_b16 v[82:83], v12 offset:9728
  v_cvt_pk_bf16_f32 v24, v16, v17
  v_mfma_f32_16x16x32_bf16 v[104:107], v[32:35], v[232:235], v[104:107]
  ds_read_b64_tr_b16 v[84:85], v13 offset:8704
  v_cvt_pk_bf16_f32 v25, v18, v19
  v_mfma_f32_16x16x32_bf16 v[120:123], v[36:39], v[232:235], v[120:123]
  ds_read_b64_tr_b16 v[86:87], v13 offset:9728
  v_cvt_pk_bf16_f32 v26, v20, v21
  v_mfma_f32_16x16x32_bf16 v[136:139], v[40:43], v[232:235], v[136:139]
  buffer_load_dwordx4 v6, s[32:35], s26 offen offset:3072 sc1 lds
  v_cvt_pk_bf16_f32 v27, v22, v23
  v_mfma_f32_16x16x32_bf16 v[152:155], v[44:47], v[232:235], v[152:155]
  s_add_u32 s26, s26, 1024
  ds_read_b64_tr_b16 v[88:89], v12 offset:8960
  buffer_store_dwordx4 v[24:27], v2, s[40:43], s64 offen offset:2048 sc1
  v_mfma_f32_16x16x32_bf16 v[168:171], v[48:51], v[232:235], v[168:171]
  ds_read_b64_tr_b16 v[90:91], v12 offset:9984
  v_mfma_f32_16x16x32_bf16 v[184:187], v[52:55], v[232:235], v[184:187]
  ds_read_b64_tr_b16 v[92:93], v13 offset:8960
  v_mfma_f32_16x16x32_bf16 v[200:203], v[56:59], v[232:235], v[200:203]
  s_add_u32 m0, s24, 114688
  ds_read_b64_tr_b16 v[94:95], v13 offset:9984
  v_mfma_f32_16x16x32_bf16 v[216:219], v[60:63], v[232:235], v[216:219]
  buffer_load_dwordx4 v10, s[36:39], s27 offen offset:2048 lds
  v_mfma_f32_16x16x32_bf16 v[108:111], v[32:35], v[236:239], v[108:111]
  ds_read_b128 v[248:251], v14 offset:34816
  v_mfma_f32_16x16x32_bf16 v[124:127], v[36:39], v[236:239], v[124:127]
  ds_read_b128 v[252:255], v14 offset:35840
  v_mfma_f32_16x16x32_bf16 v[140:143], v[40:43], v[236:239], v[140:143]
  v_mfma_f32_16x16x32_bf16 v[156:159], v[44:47], v[236:239], v[156:159]
  v_xor_b32 v14, 0x10000, v14
  v_mfma_f32_16x16x32_bf16 v[172:175], v[48:51], v[236:239], v[172:175]
  buffer_load_dwordx4 v11, s[36:39], s27 offen offset:3072 lds
  v_mfma_f32_16x16x32_bf16 v[188:191], v[52:55], v[236:239], v[188:191]
  s_add_u32 s27, s27, 524288
  v_mfma_f32_16x16x32_bf16 v[204:207], v[56:59], v[236:239], v[204:207]
  v_mfma_f32_16x16x32_bf16 v[220:223], v[60:63], v[236:239], v[220:223]
  s_waitcnt vmcnt(18) lgkmcnt(0)
  v_mfma_f32_16x16x32_bf16 v[96:99], v[64:67], v[240:243], v[96:99]
  s_barrier
  v_accvgpr_read_b32 v16, a24
  v_accvgpr_read_b32 v17, a25
  v_mfma_f32_16x16x32_bf16 v[112:115], v[68:71], v[240:243], v[112:115]
  ds_read_b64_tr_b16 v[32:33], v12 offset:32768
  v_accvgpr_read_b32 v18, a26
  v_mfma_f32_16x16x32_bf16 v[128:131], v[72:75], v[240:243], v[128:131]
  s_add_u32 m0, s24, 32768
  ds_read_b64_tr_b16 v[34:35], v12 offset:33792
  v_accvgpr_read_b32 v19, a27
  v_mfma_f32_16x16x32_bf16 v[144:147], v[76:79], v[240:243], v[144:147]
  buffer_load_dwordx4 v3, s[32:35], s26 offen offset:0 sc1 lds
  v_accvgpr_read_b32 v20, a28
  v_mfma_f32_16x16x32_bf16 v[160:163], v[80:83], v[240:243], v[160:163]
  ds_read_b64_tr_b16 v[36:37], v13 offset:32768
  v_accvgpr_read_b32 v21, a29
  v_mfma_f32_16x16x32_bf16 v[176:179], v[84:87], v[240:243], v[176:179]
  ds_read_b64_tr_b16 v[38:39], v13 offset:33792
  v_accvgpr_read_b32 v22, a30
  v_mfma_f32_16x16x32_bf16 v[192:195], v[88:91], v[240:243], v[192:195]
  ds_read_b64_tr_b16 v[40:41], v12 offset:33024
  v_accvgpr_read_b32 v23, a31
  v_mfma_f32_16x16x32_bf16 v[208:211], v[92:95], v[240:243], v[208:211]
  ds_read_b64_tr_b16 v[42:43], v12 offset:34048
  v_mul_f32 v16, s76, v16
  v_mfma_f32_16x16x32_bf16 v[100:103], v[64:67], v[244:247], v[100:103]
  buffer_load_dwordx4 v4, s[32:35], s26 offen offset:1024 sc1 lds
  v_mul_f32 v17, s76, v17
  v_mfma_f32_16x16x32_bf16 v[116:119], v[68:71], v[244:247], v[116:119]
  ds_read_b64_tr_b16 v[44:45], v13 offset:33024
  v_mul_f32 v18, s76, v18
  v_mfma_f32_16x16x32_bf16 v[132:135], v[72:75], v[244:247], v[132:135]
  ds_read_b64_tr_b16 v[46:47], v13 offset:34048
  v_mul_f32 v19, s76, v19
  v_mfma_f32_16x16x32_bf16 v[148:151], v[76:79], v[244:247], v[148:151]
  ds_read_b128 v[224:227], v14 offset:0
  v_mul_f32 v20, s76, v20
  v_mfma_f32_16x16x32_bf16 v[164:167], v[80:83], v[244:247], v[164:167]
  ds_read_b128 v[228:231], v14 offset:1024
  v_mul_f32 v21, s76, v21
  v_mfma_f32_16x16x32_bf16 v[180:183], v[84:87], v[244:247], v[180:183]
  buffer_load_dwordx4 v5, s[32:35], s26 offen offset:2048 sc1 lds
  v_mul_f32 v22, s76, v22
  v_mfma_f32_16x16x32_bf16 v[196:199], v[88:91], v[244:247], v[196:199]
  ds_read_b64_tr_b16 v[48:49], v12 offset:33280
  v_mul_f32 v23, s76, v23
  v_mfma_f32_16x16x32_bf16 v[212:215], v[92:95], v[244:247], v[212:215]
  ds_read_b64_tr_b16 v[50:51], v12 offset:34304
  v_cvt_pk_bf16_f32 v28, v16, v17
  v_mfma_f32_16x16x32_bf16 v[104:107], v[64:67], v[248:251], v[104:107]
  ds_read_b64_tr_b16 v[52:53], v13 offset:33280
  v_cvt_pk_bf16_f32 v29, v18, v19
  v_mfma_f32_16x16x32_bf16 v[120:123], v[68:71], v[248:251], v[120:123]
  ds_read_b64_tr_b16 v[54:55], v13 offset:34304
  v_cvt_pk_bf16_f32 v30, v20, v21
  v_mfma_f32_16x16x32_bf16 v[136:139], v[72:75], v[248:251], v[136:139]
  buffer_load_dwordx4 v6, s[32:35], s26 offen offset:3072 sc1 lds
  v_cvt_pk_bf16_f32 v31, v22, v23
  v_mfma_f32_16x16x32_bf16 v[152:155], v[76:79], v[248:251], v[152:155]
  s_add_u32 s26, s26, 1024
  ds_read_b64_tr_b16 v[56:57], v12 offset:33536
  buffer_store_dwordx4 v[28:31], v2, s[40:43], s64 offen offset:3072 sc1
  v_mfma_f32_16x16x32_bf16 v[168:171], v[80:83], v[248:251], v[168:171]
  ds_read_b64_tr_b16 v[58:59], v12 offset:34560
  v_mfma_f32_16x16x32_bf16 v[184:187], v[84:87], v[248:251], v[184:187]
  ds_read_b64_tr_b16 v[60:61], v13 offset:33536
  v_mfma_f32_16x16x32_bf16 v[200:203], v[88:91], v[248:251], v[200:203]
  s_add_u32 m0, s24, 16384
  ds_read_b64_tr_b16 v[62:63], v13 offset:34560
  v_mfma_f32_16x16x32_bf16 v[216:219], v[92:95], v[248:251], v[216:219]
  buffer_load_dwordx4 v8, s[36:39], s27 offen offset:0 lds
  v_mfma_f32_16x16x32_bf16 v[108:111], v[64:67], v[252:255], v[108:111]
  ds_read_b128 v[232:235], v14 offset:2048
  v_mfma_f32_16x16x32_bf16 v[124:127], v[68:71], v[252:255], v[124:127]
  ds_read_b128 v[236:239], v14 offset:3072
  v_mfma_f32_16x16x32_bf16 v[140:143], v[72:75], v[252:255], v[140:143]
  v_mfma_f32_16x16x32_bf16 v[156:159], v[76:79], v[252:255], v[156:159]
  v_mfma_f32_16x16x32_bf16 v[172:175], v[80:83], v[252:255], v[172:175]
  buffer_load_dwordx4 v9, s[36:39], s27 offen offset:1024 lds
  v_mfma_f32_16x16x32_bf16 v[188:191], v[84:87], v[252:255], v[188:191]
  v_mfma_f32_16x16x32_bf16 v[204:207], v[88:91], v[252:255], v[204:207]
  v_mfma_f32_16x16x32_bf16 v[220:223], v[92:95], v[252:255], v[220:223]
  s_waitcnt vmcnt(17) lgkmcnt(0)
  v_mfma_f32_16x16x32_bf16 v[96:99], v[32:35], v[224:227], v[96:99]
  s_add_u32 s64, s64, 4096
  v_accvgpr_read_b32 v16, a32
  v_accvgpr_read_b32 v17, a33
  v_mfma_f32_16x16x32_bf16 v[112:115], v[36:39], v[224:227], v[112:115]
  ds_read_b64_tr_b16 v[64:65], v12 offset:40960
  v_accvgpr_read_b32 v18, a34
  v_mfma_f32_16x16x32_bf16 v[128:131], v[40:43], v[224:227], v[128:131]
  s_add_u32 m0, s24, 65536
  ds_read_b64_tr_b16 v[66:67], v12 offset:41984
  v_accvgpr_read_b32 v19, a35
  v_mfma_f32_16x16x32_bf16 v[144:147], v[44:47], v[224:227], v[144:147]
  buffer_load_dwordx4 v3, s[32:35], s26 offen offset:0 sc1 lds
  v_accvgpr_read_b32 v20, a36
  v_mfma_f32_16x16x32_bf16 v[160:163], v[48:51], v[224:227], v[160:163]
  ds_read_b64_tr_b16 v[68:69], v13 offset:40960
  v_accvgpr_read_b32 v21, a37
  v_mfma_f32_16x16x32_bf16 v[176:179], v[52:55], v[224:227], v[176:179]
  ds_read_b64_tr_b16 v[70:71], v13 offset:41984
  v_accvgpr_read_b32 v22, a38
  v_mfma_f32_16x16x32_bf16 v[192:195], v[56:59], v[224:227], v[192:195]
  ds_read_b64_tr_b16 v[72:73], v12 offset:41216
  v_accvgpr_read_b32 v23, a39
  v_mfma_f32_16x16x32_bf16 v[208:211], v[60:63], v[224:227], v[208:211]
  ds_read_b64_tr_b16 v[74:75], v12 offset:42240
  v_mul_f32 v16, s76, v16
  v_mfma_f32_16x16x32_bf16 v[100:103], v[32:35], v[228:231], v[100:103]
  buffer_load_dwordx4 v4, s[32:35], s26 offen offset:1024 sc1 lds
  v_mul_f32 v17, s76, v17
  v_mfma_f32_16x16x32_bf16 v[116:119], v[36:39], v[228:231], v[116:119]
  ds_read_b64_tr_b16 v[76:77], v13 offset:41216
  v_mul_f32 v18, s76, v18
  v_mfma_f32_16x16x32_bf16 v[132:135], v[40:43], v[228:231], v[132:135]
  ds_read_b64_tr_b16 v[78:79], v13 offset:42240
  v_mul_f32 v19, s76, v19
  v_mfma_f32_16x16x32_bf16 v[148:151], v[44:47], v[228:231], v[148:151]
  ds_read_b128 v[240:243], v14 offset:32768
  v_mul_f32 v20, s76, v20
  v_mfma_f32_16x16x32_bf16 v[164:167], v[48:51], v[228:231], v[164:167]
  ds_read_b128 v[244:247], v14 offset:33792
  v_mul_f32 v21, s76, v21
  v_mfma_f32_16x16x32_bf16 v[180:183], v[52:55], v[228:231], v[180:183]
  buffer_load_dwordx4 v5, s[32:35], s26 offen offset:2048 sc1 lds
  v_mul_f32 v22, s76, v22
  v_mfma_f32_16x16x32_bf16 v[196:199], v[56:59], v[228:231], v[196:199]
  ds_read_b64_tr_b16 v[80:81], v12 offset:41472
  v_mul_f32 v23, s76, v23
  v_mfma_f32_16x16x32_bf16 v[212:215], v[60:63], v[228:231], v[212:215]
  ds_read_b64_tr_b16 v[82:83], v12 offset:42496
  v_cvt_pk_bf16_f32 v24, v16, v17
  v_mfma_f32_16x16x32_bf16 v[104:107], v[32:35], v[232:235], v[104:107]
  ds_read_b64_tr_b16 v[84:85], v13 offset:41472
  v_cvt_pk_bf16_f32 v25, v18, v19
  v_mfma_f32_16x16x32_bf16 v[120:123], v[36:39], v[232:235], v[120:123]
  ds_read_b64_tr_b16 v[86:87], v13 offset:42496
  v_cvt_pk_bf16_f32 v26, v20, v21
  v_mfma_f32_16x16x32_bf16 v[136:139], v[40:43], v[232:235], v[136:139]
  buffer_load_dwordx4 v6, s[32:35], s26 offen offset:3072 sc1 lds
  v_cvt_pk_bf16_f32 v27, v22, v23
  v_mfma_f32_16x16x32_bf16 v[152:155], v[44:47], v[232:235], v[152:155]
  s_add_u32 s26, s26, 1024
  ds_read_b64_tr_b16 v[88:89], v12 offset:41728
  buffer_store_dwordx4 v[24:27], v2, s[40:43], s64 offen offset:0 sc1
  v_mfma_f32_16x16x32_bf16 v[168:171], v[48:51], v[232:235], v[168:171]
  ds_read_b64_tr_b16 v[90:91], v12 offset:42752
  v_mfma_f32_16x16x32_bf16 v[184:187], v[52:55], v[232:235], v[184:187]
  ds_read_b64_tr_b16 v[92:93], v13 offset:41728
  v_mfma_f32_16x16x32_bf16 v[200:203], v[56:59], v[232:235], v[200:203]
  s_add_u32 m0, s24, 16384
  ds_read_b64_tr_b16 v[94:95], v13 offset:42752
  v_mfma_f32_16x16x32_bf16 v[216:219], v[60:63], v[232:235], v[216:219]
  buffer_load_dwordx4 v10, s[36:39], s27 offen offset:2048 lds
  v_mfma_f32_16x16x32_bf16 v[108:111], v[32:35], v[236:239], v[108:111]
  ds_read_b128 v[248:251], v14 offset:34816
  v_mfma_f32_16x16x32_bf16 v[124:127], v[36:39], v[236:239], v[124:127]
  ds_read_b128 v[252:255], v14 offset:35840
  v_mfma_f32_16x16x32_bf16 v[140:143], v[40:43], v[236:239], v[140:143]
  v_mfma_f32_16x16x32_bf16 v[156:159], v[44:47], v[236:239], v[156:159]
  v_xor_b32 v14, 0x10000, v14
  v_mfma_f32_16x16x32_bf16 v[172:175], v[48:51], v[236:239], v[172:175]
  buffer_load_dwordx4 v11, s[36:39], s27 offen offset:3072 lds
  v_mfma_f32_16x16x32_bf16 v[188:191], v[52:55], v[236:239], v[188:191]
  s_add_u32 s27, s27, 524288
  v_xor_b32 v12, 0x10000, v12
  v_mfma_f32_16x16x32_bf16 v[204:207], v[56:59], v[236:239], v[204:207]
  v_xor_b32 v13, 0x10000, v13
  v_mfma_f32_16x16x32_bf16 v[220:223], v[60:63], v[236:239], v[220:223]
  s_waitcnt vmcnt(17) lgkmcnt(0)
  v_mfma_f32_16x16x32_bf16 v[96:99], v[64:67], v[240:243], v[96:99]
  s_barrier
  v_accvgpr_read_b32 v16, a40
  v_accvgpr_read_b32 v17, a41
  v_mfma_f32_16x16x32_bf16 v[112:115], v[68:71], v[240:243], v[112:115]
  ds_read_b64_tr_b16 v[32:33], v12 offset:0
  v_accvgpr_read_b32 v18, a42
  v_mfma_f32_16x16x32_bf16 v[128:131], v[72:75], v[240:243], v[128:131]
  s_add_u32 m0, s24, 98304
  ds_read_b64_tr_b16 v[34:35], v12 offset:1024
  v_accvgpr_read_b32 v19, a43
  v_mfma_f32_16x16x32_bf16 v[144:147], v[76:79], v[240:243], v[144:147]
  buffer_load_dwordx4 v3, s[32:35], s26 offen offset:0 sc1 lds
  v_accvgpr_read_b32 v20, a44
  v_mfma_f32_16x16x32_bf16 v[160:163], v[80:83], v[240:243], v[160:163]
  ds_read_b64_tr_b16 v[36:37], v13 offset:0
  v_accvgpr_read_b32 v21, a45
  v_mfma_f32_16x16x32_bf16 v[176:179], v[84:87], v[240:243], v[176:179]
  ds_read_b64_tr_b16 v[38:39], v13 offset:1024
  v_accvgpr_read_b32 v22, a46
  v_mfma_f32_16x16x32_bf16 v[192:195], v[88:91], v[240:243], v[192:195]
  ds_read_b64_tr_b16 v[40:41], v12 offset:256
  v_accvgpr_read_b32 v23, a47
  v_mfma_f32_16x16x32_bf16 v[208:211], v[92:95], v[240:243], v[208:211]
  ds_read_b64_tr_b16 v[42:43], v12 offset:1280
  v_mul_f32 v16, s76, v16
  v_mfma_f32_16x16x32_bf16 v[100:103], v[64:67], v[244:247], v[100:103]
  buffer_load_dwordx4 v4, s[32:35], s26 offen offset:1024 sc1 lds
  v_mul_f32 v17, s76, v17
  v_mfma_f32_16x16x32_bf16 v[116:119], v[68:71], v[244:247], v[116:119]
  ds_read_b64_tr_b16 v[44:45], v13 offset:256
  v_mul_f32 v18, s76, v18
  v_mfma_f32_16x16x32_bf16 v[132:135], v[72:75], v[244:247], v[132:135]
  ds_read_b64_tr_b16 v[46:47], v13 offset:1280
  v_mul_f32 v19, s76, v19
  v_mfma_f32_16x16x32_bf16 v[148:151], v[76:79], v[244:247], v[148:151]
  ds_read_b128 v[224:227], v14 offset:0
  v_mul_f32 v20, s76, v20
  v_mfma_f32_16x16x32_bf16 v[164:167], v[80:83], v[244:247], v[164:167]
  ds_read_b128 v[228:231], v14 offset:1024
  v_mul_f32 v21, s76, v21
  v_mfma_f32_16x16x32_bf16 v[180:183], v[84:87], v[244:247], v[180:183]
  buffer_load_dwordx4 v5, s[32:35], s26 offen offset:2048 sc1 lds
  v_mul_f32 v22, s76, v22
  v_mfma_f32_16x16x32_bf16 v[196:199], v[88:91], v[244:247], v[196:199]
  ds_read_b64_tr_b16 v[48:49], v12 offset:512
  v_mul_f32 v23, s76, v23
  v_mfma_f32_16x16x32_bf16 v[212:215], v[92:95], v[244:247], v[212:215]
  ds_read_b64_tr_b16 v[50:51], v12 offset:1536
  v_cvt_pk_bf16_f32 v28, v16, v17
  v_mfma_f32_16x16x32_bf16 v[104:107], v[64:67], v[248:251], v[104:107]
  ds_read_b64_tr_b16 v[52:53], v13 offset:512
  v_cvt_pk_bf16_f32 v29, v18, v19
  v_mfma_f32_16x16x32_bf16 v[120:123], v[68:71], v[248:251], v[120:123]
  ds_read_b64_tr_b16 v[54:55], v13 offset:1536
  v_cvt_pk_bf16_f32 v30, v20, v21
  v_mfma_f32_16x16x32_bf16 v[136:139], v[72:75], v[248:251], v[136:139]
  buffer_load_dwordx4 v6, s[32:35], s26 offen offset:3072 sc1 lds
  v_cvt_pk_bf16_f32 v31, v22, v23
  v_mfma_f32_16x16x32_bf16 v[152:155], v[76:79], v[248:251], v[152:155]
  s_add_u32 s26, s26, 1024
  ds_read_b64_tr_b16 v[56:57], v12 offset:768
  buffer_store_dwordx4 v[28:31], v2, s[40:43], s64 offen offset:1024 sc1
  v_mfma_f32_16x16x32_bf16 v[168:171], v[80:83], v[248:251], v[168:171]
  ds_read_b64_tr_b16 v[58:59], v12 offset:1792
  v_mfma_f32_16x16x32_bf16 v[184:187], v[84:87], v[248:251], v[184:187]
  ds_read_b64_tr_b16 v[60:61], v13 offset:768
  v_mfma_f32_16x16x32_bf16 v[200:203], v[88:91], v[248:251], v[200:203]
  s_add_u32 m0, s24, 49152
  ds_read_b64_tr_b16 v[62:63], v13 offset:1792
  v_mfma_f32_16x16x32_bf16 v[216:219], v[92:95], v[248:251], v[216:219]
  buffer_load_dwordx4 v8, s[36:39], s27 offen offset:0 lds
  v_mfma_f32_16x16x32_bf16 v[108:111], v[64:67], v[252:255], v[108:111]
  ds_read_b128 v[232:235], v14 offset:2048
  v_mfma_f32_16x16x32_bf16 v[124:127], v[68:71], v[252:255], v[124:127]
  ds_read_b128 v[236:239], v14 offset:3072
  v_mfma_f32_16x16x32_bf16 v[140:143], v[72:75], v[252:255], v[140:143]
  v_mfma_f32_16x16x32_bf16 v[156:159], v[76:79], v[252:255], v[156:159]
  v_mfma_f32_16x16x32_bf16 v[172:175], v[80:83], v[252:255], v[172:175]
  buffer_load_dwordx4 v9, s[36:39], s27 offen offset:1024 lds
  v_mfma_f32_16x16x32_bf16 v[188:191], v[84:87], v[252:255], v[188:191]
  v_mfma_f32_16x16x32_bf16 v[204:207], v[88:91], v[252:255], v[204:207]
  v_mfma_f32_16x16x32_bf16 v[220:223], v[92:95], v[252:255], v[220:223]
  s_waitcnt vmcnt(17) lgkmcnt(0)
  v_mfma_f32_16x16x32_bf16 v[96:99], v[32:35], v[224:227], v[96:99]
  v_accvgpr_read_b32 v16, a48
  v_accvgpr_read_b32 v17, a49
  v_accvgpr_read_b32 v18, a50
  v_mfma_f32_16x16x32_bf16 v[112:115], v[36:39], v[224:227], v[112:115]
  ds_read_b64_tr_b16 v[64:65], v12 offset:8192
  v_accvgpr_read_b32 v19, a51
  v_mfma_f32_16x16x32_bf16 v[128:131], v[40:43], v[224:227], v[128:131]
  s_add_u32 m0, s24, 0
  ds_read_b64_tr_b16 v[66:67], v12 offset:9216
  v_accvgpr_read_b32 v20, a52
  v_mfma_f32_16x16x32_bf16 v[144:147], v[44:47], v[224:227], v[144:147]
  buffer_load_dwordx4 v3, s[32:35], s26 offen offset:0 sc1 lds
  v_accvgpr_read_b32 v21, a53
  v_accvgpr_read_b32 v22, a54
  v_mfma_f32_16x16x32_bf16 v[160:163], v[48:51], v[224:227], v[160:163]
  ds_read_b64_tr_b16 v[68:69], v13 offset:8192
  v_accvgpr_read_b32 v23, a55
  v_mfma_f32_16x16x32_bf16 v[176:179], v[52:55], v[224:227], v[176:179]
  ds_read_b64_tr_b16 v[70:71], v13 offset:9216
  v_mul_f32 v16, s76, v16
  v_mfma_f32_16x16x32_bf16 v[192:195], v[56:59], v[224:227], v[192:195]
  ds_read_b64_tr_b16 v[72:73], v12 offset:8448
  v_mul_f32 v17, s76, v17
  v_mfma_f32_16x16x32_bf16 v[208:211], v[60:63], v[224:227], v[208:211]
  ds_read_b64_tr_b16 v[74:75], v12 offset:9472
  v_mul_f32 v18, s76, v18
  v_mul_f32 v19, s76, v19
  v_mfma_f32_16x16x32_bf16 v[100:103], v[32:35], v[228:231], v[100:103]
  buffer_load_dwordx4 v4, s[32:35], s26 offen offset:1024 sc1 lds
  v_mul_f32 v20, s76, v20
  v_mfma_f32_16x16x32_bf16 v[116:119], v[36:39], v[228:231], v[116:119]
  ds_read_b64_tr_b16 v[76:77], v13 offset:8448
  v_mul_f32 v21, s76, v21
  v_mfma_f32_16x16x32_bf16 v[132:135], v[40:43], v[228:231], v[132:135]
  ds_read_b64_tr_b16 v[78:79], v13 offset:9472
  v_mul_f32 v22, s76, v22
  v_mfma_f32_16x16x32_bf16 v[148:151], v[44:47], v[228:231], v[148:151]
  ds_read_b128 v[240:243], v14 offset:32768
  v_mul_f32 v23, s76, v23
  v_cvt_pk_bf16_f32 v24, v16, v17
  v_mfma_f32_16x16x32_bf16 v[164:167], v[48:51], v[228:231], v[164:167]
  ds_read_b128 v[244:247], v14 offset:33792
  v_cvt_pk_bf16_f32 v25, v18, v19
  v_mfma_f32_16x16x32_bf16 v[180:183], v[52:55], v[228:231], v[180:183]
  buffer_load_dwordx4 v5, s[32:35], s26 offen offset:2048 sc1 lds
  v_cvt_pk_bf16_f32 v26, v20, v21
  v_mfma_f32_16x16x32_bf16 v[196:199], v[56:59], v[228:231], v[196:199]
  ds_read_b64_tr_b16 v[80:81], v12 offset:8704
  v_cvt_pk_bf16_f32 v27, v22, v23
  v_mfma_f32_16x16x32_bf16 v[212:215], v[60:63], v[228:231], v[212:215]
  ds_read_b64_tr_b16 v[82:83], v12 offset:9728
  buffer_store_dwordx4 v[24:27], v2, s[40:43], s64 offen offset:2048 sc1
  v_accvgpr_read_b32 v16, a56
  v_mfma_f32_16x16x32_bf16 v[104:107], v[32:35], v[232:235], v[104:107]
  ds_read_b64_tr_b16 v[84:85], v13 offset:8704
  v_accvgpr_read_b32 v17, a57
  v_mfma_f32_16x16x32_bf16 v[120:123], v[36:39], v[232:235], v[120:123]
  ds_read_b64_tr_b16 v[86:87], v13 offset:9728
  v_accvgpr_read_b32 v18, a58
  v_mfma_f32_16x16x32_bf16 v[136:139], v[40:43], v[232:235], v[136:139]
  buffer_load_dwordx4 v6, s[32:35], s26 offen offset:3072 sc1 lds
  v_accvgpr_read_b32 v19, a59
  v_accvgpr_read_b32 v20, a60
  v_mfma_f32_16x16x32_bf16 v[152:155], v[44:47], v[232:235], v[152:155]
  s_add_u32 s26, s26, 1024
  ds_read_b64_tr_b16 v[88:89], v12 offset:8960
  v_accvgpr_read_b32 v21, a61
  v_mfma_f32_16x16x32_bf16 v[168:171], v[48:51], v[232:235], v[168:171]
  ds_read_b64_tr_b16 v[90:91], v12 offset:9984
  v_accvgpr_read_b32 v22, a62
  v_mfma_f32_16x16x32_bf16 v[184:187], v[52:55], v[232:235], v[184:187]
  ds_read_b64_tr_b16 v[92:93], v13 offset:8960
  v_accvgpr_read_b32 v23, a63
  v_mfma_f32_16x16x32_bf16 v[200:203], v[56:59], v[232:235], v[200:203]
  s_add_u32 m0, s24, 49152
  ds_read_b64_tr_b16 v[94:95], v13 offset:9984
  v_mul_f32 v16, s76, v16
  v_mul_f32 v17, s76, v17
  v_mfma_f32_16x16x32_bf16 v[216:219], v[60:63], v[232:235], v[216:219]
  buffer_load_dwordx4 v10, s[36:39], s27 offen offset:2048 lds
  v_mul_f32 v18, s76, v18
  v_mfma_f32_16x16x32_bf16 v[108:111], v[32:35], v[236:239], v[108:111]
  ds_read_b128 v[248:251], v14 offset:34816
  v_mul_f32 v19, s76, v19
  v_mfma_f32_16x16x32_bf16 v[124:127], v[36:39], v[236:239], v[124:127]
  ds_read_b128 v[252:255], v14 offset:35840
  v_mul_f32 v20, s76, v20
  v_mfma_f32_16x16x32_bf16 v[140:143], v[40:43], v[236:239], v[140:143]
  v_mul_f32 v21, s76, v21
  v_mul_f32 v22, s76, v22
  v_mul_f32 v23, s76, v23
  v_mfma_f32_16x16x32_bf16 v[156:159], v[44:47], v[236:239], v[156:159]
  v_xor_b32 v14, 0x10000, v14
  v_cvt_pk_bf16_f32 v28, v16, v17
  v_mfma_f32_16x16x32_bf16 v[172:175], v[48:51], v[236:239], v[172:175]
  buffer_load_dwordx4 v11, s[36:39], s27 offen offset:3072 lds
  v_cvt_pk_bf16_f32 v29, v18, v19
  v_mfma_f32_16x16x32_bf16 v[188:191], v[52:55], v[236:239], v[188:191]
  s_add_u32 s27, s27, 524288
  v_cvt_pk_bf16_f32 v30, v20, v21
  v_cvt_pk_bf16_f32 v31, v22, v23
  v_mfma_f32_16x16x32_bf16 v[204:207], v[56:59], v[236:239], v[204:207]
  buffer_store_dwordx4 v[28:31], v2, s[40:43], s64 offen offset:3072 sc1
  v_mfma_f32_16x16x32_bf16 v[220:223], v[60:63], v[236:239], v[220:223]
  s_waitcnt vmcnt(18) lgkmcnt(0)
  v_mfma_f32_16x16x32_bf16 v[96:99], v[64:67], v[240:243], v[96:99]
  s_barrier
  v_accvgpr_read_b32 v16, a64
  v_accvgpr_read_b32 v17, a65
  v_accvgpr_read_b32 v18, a66
  v_mfma_f32_16x16x32_bf16 v[112:115], v[68:71], v[240:243], v[112:115]
  s_add_u32 s64, s64, 126976
  ds_read_b64_tr_b16 v[32:33], v12 offset:32768
  v_accvgpr_read_b32 v19, a67
  v_accvgpr_read_b32 v20, a68
  v_mfma_f32_16x16x32_bf16 v[128:131], v[72:75], v[240:243], v[128:131]
  s_add_u32 m0, s24, 32768
  ds_read_b64_tr_b16 v[34:35], v12 offset:33792
  v_accvgpr_read_b32 v21, a69
  v_mfma_f32_16x16x32_bf16 v[144:147], v[76:79], v[240:243], v[144:147]
  buffer_load_dwordx4 v3, s[32:35], s26 offen offset:0 sc1 lds
  v_accvgpr_read_b32 v22, a70
  v_accvgpr_read_b32 v23, a71
  v_mfma_f32_16x16x32_bf16 v[160:163], v[80:83], v[240:243], v[160:163]
  ds_read_b64_tr_b16 v[36:37], v13 offset:32768
  v_mul_f32 v16, s76, v16
  v_mfma_f32_16x16x32_bf16 v[176:179], v[84:87], v[240:243], v[176:179]
  ds_read_b64_tr_b16 v[38:39], v13 offset:33792
  v_mul_f32 v17, s76, v17
  v_mul_f32 v18, s76, v18
  v_mfma_f32_16x16x32_bf16 v[192:195], v[88:91], v[240:243], v[192:195]
  ds_read_b64_tr_b16 v[40:41], v12 offset:33024
  v_mul_f32 v19, s76, v19
  v_mfma_f32_16x16x32_bf16 v[208:211], v[92:95], v[240:243], v[208:211]
  ds_read_b64_tr_b16 v[42:43], v12 offset:34048
  v_mul_f32 v20, s76, v20
  v_mul_f32 v21, s76, v21
  v_mfma_f32_16x16x32_bf16 v[100:103], v[64:67], v[244:247], v[100:103]
  buffer_load_dwordx4 v4, s[32:35], s26 offen offset:1024 sc1 lds
  v_mul_f32 v22, s76, v22
  v_mfma_f32_16x16x32_bf16 v[116:119], v[68:71], v[244:247], v[116:119]
  ds_read_b64_tr_b16 v[44:45], v13 offset:33024
  v_mul_f32 v23, s76, v23
  v_cvt_pk_bf16_f32 v24, v16, v17
  v_mfma_f32_16x16x32_bf16 v[132:135], v[72:75], v[244:247], v[132:135]
  ds_read_b64_tr_b16 v[46:47], v13 offset:34048
  v_cvt_pk_bf16_f32 v25, v18, v19
  v_mfma_f32_16x16x32_bf16 v[148:151], v[76:79], v[244:247], v[148:151]
  ds_read_b128 v[224:227], v14 offset:0
  v_cvt_pk_bf16_f32 v26, v20, v21
  v_cvt_pk_bf16_f32 v27, v22, v23
  v_mfma_f32_16x16x32_bf16 v[164:167], v[80:83], v[244:247], v[164:167]
  ds_read_b128 v[228:231], v14 offset:1024
  buffer_store_dwordx4 v[24:27], v2, s[40:43], s64 offen offset:0 sc1
  v_mfma_f32_16x16x32_bf16 v[180:183], v[84:87], v[244:247], v[180:183]
  buffer_load_dwordx4 v5, s[32:35], s26 offen offset:2048 sc1 lds
  v_accvgpr_read_b32 v16, a72
  v_accvgpr_read_b32 v17, a73
  v_mfma_f32_16x16x32_bf16 v[196:199], v[88:91], v[244:247], v[196:199]
  ds_read_b64_tr_b16 v[48:49], v12 offset:33280
  v_accvgpr_read_b32 v18, a74
  v_mfma_f32_16x16x32_bf16 v[212:215], v[92:95], v[244:247], v[212:215]
  ds_read_b64_tr_b16 v[50:51], v12 offset:34304
  v_accvgpr_read_b32 v19, a75
  v_accvgpr_read_b32 v20, a76
  v_mfma_f32_16x16x32_bf16 v[104:107], v[64:67], v[248:251], v[104:107]
  ds_read_b64_tr_b16 v[52:53], v13 offset:33280
  v_accvgpr_read_b32 v21, a77
  v_accvgpr_read_b32 v22, a78
  v_mfma_f32_16x16x32_bf16 v[120:123], v[68:71], v[248:251], v[120:123]
  ds_read_b64_tr_b16 v[54:55], v13 offset:34304
  v_accvgpr_read_b32 v23, a79
  v_mfma_f32_16x16x32_bf16 v[136:139], v[72:75], v[248:251], v[136:139]
  buffer_load_dwordx4 v6, s[32:35], s26 offen offset:3072 sc1 lds
  v_mul_f32 v16, s76, v16
  v_mul_f32 v17, s76, v17
  v_mfma_f32_16x16x32_bf16 v[152:155], v[76:79], v[248:251], v[152:155]
  s_add_u32 s26, s26, 1024
  ds_read_b64_tr_b16 v[56:57], v12 offset:33536
  v_mul_f32 v18, s76, v18
  v_mfma_f32_16x16x32_bf16 v[168:171], v[80:83], v[248:251], v[168:171]
  ds_read_b64_tr_b16 v[58:59], v12 offset:34560
  v_mul_f32 v19, s76, v19
  v_mul_f32 v20, s76, v20
  v_mfma_f32_16x16x32_bf16 v[184:187], v[84:87], v[248:251], v[184:187]
  ds_read_b64_tr_b16 v[60:61], v13 offset:33536
  v_mul_f32 v21, s76, v21
  v_mfma_f32_16x16x32_bf16 v[200:203], v[88:91], v[248:251], v[200:203]
  ds_read_b64_tr_b16 v[62:63], v13 offset:34560
  v_mul_f32 v22, s76, v22
  v_mul_f32 v23, s76, v23
  v_mfma_f32_16x16x32_bf16 v[216:219], v[92:95], v[248:251], v[216:219]
  v_cvt_pk_bf16_f32 v28, v16, v17
  v_cvt_pk_bf16_f32 v29, v18, v19
  v_mfma_f32_16x16x32_bf16 v[108:111], v[64:67], v[252:255], v[108:111]
  ds_read_b128 v[232:235], v14 offset:2048
  v_cvt_pk_bf16_f32 v30, v20, v21
  v_cvt_pk_bf16_f32 v31, v22, v23
  v_mfma_f32_16x16x32_bf16 v[124:127], v[68:71], v[252:255], v[124:127]
  ds_read_b128 v[236:239], v14 offset:3072
  buffer_store_dwordx4 v[28:31], v2, s[40:43], s64 offen offset:1024 sc1
  v_mfma_f32_16x16x32_bf16 v[140:143], v[72:75], v[252:255], v[140:143]
  v_and_b32 v11, 15, v1
  v_lshrrev_b32 v10, 4, v1
  v_lshlrev_b32 v10, 2, v10
  v_mfma_f32_16x16x32_bf16 v[156:159], v[76:79], v[252:255], v[156:159]
  v_sub_u32 v11, v11, v10
  v_cmp_le_i32 s[68:69], 0, v11
  v_mfma_f32_16x16x32_bf16 v[172:175], v[80:83], v[252:255], v[172:175]
  v_cmp_le_i32 s[70:71], 1, v11
  v_cmp_le_i32 s[72:73], 2, v11
  v_cmp_le_i32 s[74:75], 3, v11
  v_mfma_f32_16x16x32_bf16 v[188:191], v[84:87], v[252:255], v[188:191]
  v_and_b32 v8, 7, v1
  v_lshlrev_b32 v8, 7, v8
  v_mfma_f32_16x16x32_bf16 v[204:207], v[88:91], v[252:255], v[204:207]
  v_add_u32 v8, s30, v8
  v_mfma_f32_16x16x32_bf16 v[220:223], v[92:95], v[252:255], v[220:223]
  s_waitcnt vmcnt(17) lgkmcnt(0)
  v_mfma_f32_16x16x32_bf16 v[96:99], v[32:35], v[224:227], v[96:99]
  v_accvgpr_read_b32 v16, a80
  v_accvgpr_read_b32 v17, a81
  v_accvgpr_read_b32 v18, a82
  v_mfma_f32_16x16x32_bf16 v[112:115], v[36:39], v[224:227], v[112:115]
  ds_read_b64_tr_b16 v[64:65], v12 offset:40960
  v_accvgpr_read_b32 v19, a83
  v_accvgpr_read_b32 v20, a84
  v_mfma_f32_16x16x32_bf16 v[128:131], v[40:43], v[224:227], v[128:131]
  s_add_u32 m0, s24, 65536
  ds_read_b64_tr_b16 v[66:67], v12 offset:41984
  v_accvgpr_read_b32 v21, a85
  v_accvgpr_read_b32 v22, a86
  v_mfma_f32_16x16x32_bf16 v[144:147], v[44:47], v[224:227], v[144:147]
  buffer_load_dwordx4 v3, s[32:35], s26 offen offset:0 sc1 lds
  v_accvgpr_read_b32 v23, a87
  v_mul_f32 v16, s76, v16
  v_mfma_f32_16x16x32_bf16 v[160:163], v[48:51], v[224:227], v[160:163]
  ds_read_b64_tr_b16 v[68:69], v13 offset:40960
  v_mul_f32 v17, s76, v17
  v_mul_f32 v18, s76, v18
  v_mfma_f32_16x16x32_bf16 v[176:179], v[52:55], v[224:227], v[176:179]
  ds_read_b64_tr_b16 v[70:71], v13 offset:41984
  v_mul_f32 v19, s76, v19
  v_mul_f32 v20, s76, v20
  v_mfma_f32_16x16x32_bf16 v[192:195], v[56:59], v[224:227], v[192:195]
  ds_read_b64_tr_b16 v[72:73], v12 offset:41216
  v_mul_f32 v21, s76, v21
  v_mul_f32 v22, s76, v22
  v_mfma_f32_16x16x32_bf16 v[208:211], v[60:63], v[224:227], v[208:211]
  ds_read_b64_tr_b16 v[74:75], v12 offset:42240
  v_mul_f32 v23, s76, v23
  v_mfma_f32_16x16x32_bf16 v[100:103], v[32:35], v[228:231], v[100:103]
  buffer_load_dwordx4 v4, s[32:35], s26 offen offset:1024 sc1 lds
  v_cvt_pk_bf16_f32 v24, v16, v17
  v_cvt_pk_bf16_f32 v25, v18, v19
  v_mfma_f32_16x16x32_bf16 v[116:119], v[36:39], v[228:231], v[116:119]
  ds_read_b64_tr_b16 v[76:77], v13 offset:41216
  v_cvt_pk_bf16_f32 v26, v20, v21
  v_cvt_pk_bf16_f32 v27, v22, v23
  v_mfma_f32_16x16x32_bf16 v[132:135], v[40:43], v[228:231], v[132:135]
  ds_read_b64_tr_b16 v[78:79], v13 offset:42240
  buffer_store_dwordx4 v[24:27], v2, s[40:43], s64 offen offset:2048 sc1
  v_accvgpr_read_b32 v16, a88
  v_mfma_f32_16x16x32_bf16 v[148:151], v[44:47], v[228:231], v[148:151]
  ds_read_b128 v[240:243], v14 offset:32768
  v_accvgpr_read_b32 v17, a89
  v_accvgpr_read_b32 v18, a90
  v_mfma_f32_16x16x32_bf16 v[164:167], v[48:51], v[228:231], v[164:167]
  ds_read_b128 v[244:247], v14 offset:33792
  v_accvgpr_read_b32 v19, a91
  v_accvgpr_read_b32 v20, a92
  v_mfma_f32_16x16x32_bf16 v[180:183], v[52:55], v[228:231], v[180:183]
  buffer_load_dwordx4 v5, s[32:35], s26 offen offset:2048 sc1 lds
  v_accvgpr_read_b32 v21, a93
  v_accvgpr_read_b32 v22, a94
  v_mfma_f32_16x16x32_bf16 v[196:199], v[56:59], v[228:231], v[196:199]
  ds_read_b64_tr_b16 v[80:81], v12 offset:41472
  v_accvgpr_read_b32 v23, a95
  v_mfma_f32_16x16x32_bf16 v[212:215], v[60:63], v[228:231], v[212:215]
  ds_read_b64_tr_b16 v[82:83], v12 offset:42496
  v_mul_f32 v16, s76, v16
  v_mul_f32 v17, s76, v17
  v_mfma_f32_16x16x32_bf16 v[104:107], v[32:35], v[232:235], v[104:107]
  ds_read_b64_tr_b16 v[84:85], v13 offset:41472
  v_mul_f32 v18, s76, v18
  v_mul_f32 v19, s76, v19
  v_mfma_f32_16x16x32_bf16 v[120:123], v[36:39], v[232:235], v[120:123]
  ds_read_b64_tr_b16 v[86:87], v13 offset:42496
  v_mul_f32 v20, s76, v20
  v_mul_f32 v21, s76, v21
  v_mfma_f32_16x16x32_bf16 v[136:139], v[40:43], v[232:235], v[136:139]
  buffer_load_dwordx4 v6, s[32:35], s26 offen offset:3072 sc1 lds
  v_mul_f32 v22, s76, v22
  v_mul_f32 v23, s76, v23
  v_mfma_f32_16x16x32_bf16 v[152:155], v[44:47], v[232:235], v[152:155]
  s_add_u32 s26, s26, 1024
  ds_read_b64_tr_b16 v[88:89], v12 offset:41728
  v_cvt_pk_bf16_f32 v28, v16, v17
  v_cvt_pk_bf16_f32 v29, v18, v19
  v_mfma_f32_16x16x32_bf16 v[168:171], v[48:51], v[232:235], v[168:171]
  ds_read_b64_tr_b16 v[90:91], v12 offset:42752
  v_cvt_pk_bf16_f32 v30, v20, v21
  v_cvt_pk_bf16_f32 v31, v22, v23
  v_mfma_f32_16x16x32_bf16 v[184:187], v[52:55], v[232:235], v[184:187]
  ds_read_b64_tr_b16 v[92:93], v13 offset:41728
  buffer_store_dwordx4 v[28:31], v2, s[40:43], s64 offen offset:3072 sc1
  v_add_u32 v9, 0, v1
  v_mfma_f32_16x16x32_bf16 v[200:203], v[56:59], v[232:235], v[200:203]
  ds_read_b64_tr_b16 v[94:95], v13 offset:42752
  v_mul_u32_u24 v10, 6554, v9
  v_mfma_f32_16x16x32_bf16 v[216:219], v[60:63], v[232:235], v[216:219]
  v_lshrrev_b32 v10, 16, v10
  v_mul_u32_u24 v10, 1120, v10
  v_lshl_add_u32 v10, v9, 4, v10
  v_mfma_f32_16x16x32_bf16 v[108:111], v[32:35], v[236:239], v[108:111]
  ds_read_b128 v[248:251], v14 offset:34816
  v_accvgpr_write_b32 a248, v10
  v_add_u32 v9, 64, v1
  v_mfma_f32_16x16x32_bf16 v[124:127], v[36:39], v[236:239], v[124:127]
  ds_read_b128 v[252:255], v14 offset:35840
  v_mul_u32_u24 v10, 6554, v9
  v_lshrrev_b32 v10, 16, v10
  v_mfma_f32_16x16x32_bf16 v[140:143], v[40:43], v[236:239], v[140:143]
  v_mul_u32_u24 v10, 1120, v10
  v_lshl_add_u32 v10, v9, 4, v10
  v_accvgpr_write_b32 a249, v10
  v_mfma_f32_16x16x32_bf16 v[156:159], v[44:47], v[236:239], v[156:159]
  v_xor_b32 v14, 0x10000, v14
  v_add_u32 v9, 128, v1
  v_mul_u32_u24 v10, 6554, v9
  v_mfma_f32_16x16x32_bf16 v[172:175], v[48:51], v[236:239], v[172:175]
  v_lshrrev_b32 v10, 16, v10
  v_mul_u32_u24 v10, 1120, v10
  v_lshl_add_u32 v10, v9, 4, v10
  v_mfma_f32_16x16x32_bf16 v[188:191], v[52:55], v[236:239], v[188:191]
  v_xor_b32 v12, 0x10000, v12
  v_accvgpr_write_b32 a250, v10
  v_mfma_f32_16x16x32_bf16 v[204:207], v[56:59], v[236:239], v[204:207]
  v_xor_b32 v13, 0x10000, v13
  v_mfma_f32_16x16x32_bf16 v[220:223], v[60:63], v[236:239], v[220:223]
  s_waitcnt vmcnt(15) lgkmcnt(0)
  v_mfma_f32_16x16x32_bf16 v[96:99], v[64:67], v[240:243], v[96:99]
  s_barrier
  v_accvgpr_read_b32 v16, a96
  v_accvgpr_read_b32 v17, a97
  v_accvgpr_read_b32 v18, a98
  v_accvgpr_read_b32 v19, a99
  v_mfma_f32_16x16x32_bf16 v[112:115], v[68:71], v[240:243], v[112:115]
  s_add_u32 s64, s64, 4096
  ds_read_b64_tr_b16 v[32:33], v12 offset:0
  v_accvgpr_read_b32 v20, a100
  v_accvgpr_read_b32 v21, a101
  v_mfma_f32_16x16x32_bf16 v[128:131], v[72:75], v[240:243], v[128:131]
  s_add_u32 m0, s24, 98304
  ds_read_b64_tr_b16 v[34:35], v12 offset:1024
  v_accvgpr_read_b32 v22, a102
  v_accvgpr_read_b32 v23, a103
  v_mul_f32 v16, s76, v16
  v_mfma_f32_16x16x32_bf16 v[144:147], v[76:79], v[240:243], v[144:147]
  buffer_load_dwordx4 v3, s[32:35], s26 offen offset:0 sc1 lds
  v_mul_f32 v17, s76, v17
  v_mul_f32 v18, s76, v18
  v_mfma_f32_16x16x32_bf16 v[160:163], v[80:83], v[240:243], v[160:163]
  s_getpc_b64 s[78:79]
fa_pc2:
  ds_read_b64_tr_b16 v[36:37], v13 offset:0
  v_mul_f32 v19, s76, v19
  v_mul_f32 v20, s76, v20
  v_mfma_f32_16x16x32_bf16 v[176:179], v[84:87], v[240:243], v[176:179]
  s_lshr_b32 s23, s2, 3
  ds_read_b64_tr_b16 v[38:39], v13 offset:1024
  v_mul_f32 v21, s76, v21
  v_mul_f32 v22, s76, v22
  v_mul_f32 v23, s76, v23
  v_mfma_f32_16x16x32_bf16 v[192:195], v[88:91], v[240:243], v[192:195]
  s_and_b32 s23, s23, 7
  ds_read_b64_tr_b16 v[40:41], v12 offset:256
  v_cvt_pk_bf16_f32 v24, v16, v17
  v_cvt_pk_bf16_f32 v25, v18, v19
  v_mfma_f32_16x16x32_bf16 v[208:211], v[92:95], v[240:243], v[208:211]
  s_lshl_b32 s23, s23, 2
  ds_read_b64_tr_b16 v[42:43], v12 offset:1280
  v_cvt_pk_bf16_f32 v26, v20, v21
  v_cvt_pk_bf16_f32 v27, v22, v23
  v_mfma_f32_16x16x32_bf16 v[100:103], v[64:67], v[244:247], v[100:103]
  s_add_u32 s23, s23, s20
  buffer_load_dwordx4 v4, s[32:35], s26 offen offset:1024 sc1 lds
  buffer_store_dwordx4 v[24:27], v2, s[40:43], s64 offen offset:0 sc1
  v_accvgpr_read_b32 v16, a104
  v_mfma_f32_16x16x32_bf16 v[116:119], v[68:71], v[244:247], v[116:119]
  s_lshl_b32 s23, s23, 11
  ds_read_b64_tr_b16 v[44:45], v13 offset:256
  v_accvgpr_read_b32 v17, a105
  v_accvgpr_read_b32 v18, a106
  v_mfma_f32_16x16x32_bf16 v[132:135], v[72:75], v[244:247], v[132:135]
  s_min_u32 s23, s23, fa_codeend-fa_pc2-2048
  ds_read_b64_tr_b16 v[46:47], v13 offset:1280
  v_accvgpr_read_b32 v19, a107
  v_accvgpr_read_b32 v20, a108
  v_accvgpr_read_b32 v21, a109
  v_mfma_f32_16x16x32_bf16 v[148:151], v[76:79], v[244:247], v[148:151]
  ds_read_b128 v[224:227], v14 offset:0
  v_accvgpr_read_b32 v22, a110
  v_accvgpr_read_b32 v23, a111
  v_mfma_f32_16x16x32_bf16 v[164:167], v[80:83], v[244:247], v[164:167]
  ds_read_b128 v[228:231], v14 offset:1024
  v_mul_f32 v16, s76, v16
  v_mul_f32 v17, s76, v17
  v_mul_f32 v18, s76, v18
  v_mfma_f32_16x16x32_bf16 v[180:183], v[84:87], v[244:247], v[180:183]
  buffer_load_dwordx4 v5, s[32:35], s26 offen offset:2048 sc1 lds
  v_mul_f32 v19, s76, v19
  v_mul_f32 v20, s76, v20
  v_mfma_f32_16x16x32_bf16 v[196:199], v[88:91], v[244:247], v[196:199]
  ds_read_b64_tr_b16 v[48:49], v12 offset:512
  v_mul_f32 v21, s76, v21
  v_mul_f32 v22, s76, v22
  v_mfma_f32_16x16x32_bf16 v[212:215], v[92:95], v[244:247], v[212:215]
  ds_read_b64_tr_b16 v[50:51], v12 offset:1536
  v_mul_f32 v23, s76, v23
  v_cvt_pk_bf16_f32 v28, v16, v17
  v_cvt_pk_bf16_f32 v29, v18, v19
  v_mfma_f32_16x16x32_bf16 v[104:107], v[64:67], v[248:251], v[104:107]
  ds_read_b64_tr_b16 v[52:53], v13 offset:512
  v_cvt_pk_bf16_f32 v30, v20, v21
  v_cvt_pk_bf16_f32 v31, v22, v23
  v_mfma_f32_16x16x32_bf16 v[120:123], v[68:71], v[248:251], v[120:123]
  ds_read_b64_tr_b16 v[54:55], v13 offset:1536
  buffer_store_dwordx4 v[28:31], v2, s[40:43], s64 offen offset:1024 sc1
  v_accvgpr_read_b32 v16, a112
  v_accvgpr_read_b32 v17, a113
  v_mfma_f32_16x16x32_bf16 v[136:139], v[72:75], v[248:251], v[136:139]
  buffer_load_dwordx4 v6, s[32:35], s26 offen offset:3072 sc1 lds
  v_accvgpr_read_b32 v18, a114
  v_accvgpr_read_b32 v19, a115
  v_mfma_f32_16x16x32_bf16 v[152:155], v[76:79], v[248:251], v[152:155]
  s_add_u32 s26, s26, 1024
  ds_read_b64_tr_b16 v[56:57], v12 offset:768
  v_accvgpr_read_b32 v20, a116
  v_accvgpr_read_b32 v21, a117
  v_mfma_f32_16x16x32_bf16 v[168:171], v[80:83], v[248:251], v[168:171]
  ds_read_b64_tr_b16 v[58:59], v12 offset:1792
  v_accvgpr_read_b32 v22, a118
  v_accvgpr_read_b32 v23, a119
  v_mul_f32 v16, s76, v16
  v_mfma_f32_16x16x32_bf16 v[184:187], v[84:87], v[248:251], v[184:187]
  ds_read_b64_tr_b16 v[60:61], v13 offset:768
  v_mul_f32 v17, s76, v17
  v_mul_f32 v18, s76, v18
  v_mfma_f32_16x16x32_bf16 v[200:203], v[88:91], v[248:251], v[200:203]
  ds_read_b64_tr_b16 v[62:63], v13 offset:1792
  v_mul_f32 v19, s76, v19
  v_mul_f32 v20, s76, v20
  v_mul_f32 v21, s76, v21
  v_mfma_f32_16x16x32_bf16 v[216:219], v[92:95], v[248:251], v[216:219]
  v_mul_f32 v22, s76, v22
  v_mul_f32 v23, s76, v23
  v_cvt_pk_bf16_f32 v24, v16, v17
  v_mfma_f32_16x16x32_bf16 v[108:111], v[64:67], v[252:255], v[108:111]
  ds_read_b128 v[232:235], v14 offset:2048
  v_and_b32 v11, 15, v1
  v_cvt_pk_bf16_f32 v25, v18, v19
  v_mfma_f32_16x16x32_bf16 v[124:127], v[68:71], v[252:255], v[124:127]
  ds_read_b128 v[236:239], v14 offset:3072
  v_lshl_add_u32 v11, v11, 7, s23
  v_cvt_pk_bf16_f32 v26, v20, v21
  v_cvt_pk_bf16_f32 v27, v22, v23
  v_mfma_f32_16x16x32_bf16 v[140:143], v[72:75], v[252:255], v[140:143]
  buffer_store_dwordx4 v[24:27], v2, s[40:43], s64 offen offset:2048 sc1
  v_add_u32 v9, 192, v1
  v_mul_u32_u24 v10, 6554, v9
  v_mfma_f32_16x16x32_bf16 v[156:159], v[76:79], v[252:255], v[156:159]
  v_lshrrev_b32 v10, 16, v10
  v_mul_u32_u24 v10, 1120, v10
  v_lshl_add_u32 v10, v9, 4, v10
  v_accvgpr_write_b32 a251, v10
  v_mfma_f32_16x16x32_bf16 v[172:175], v[80:83], v[252:255], v[172:175]
  global_load_dword v11, v11, s[78:79]
  v_add_u32 v9, 256, v1
  v_mul_u32_u24 v10, 6554, v9
  v_mfma_f32_16x16x32_bf16 v[188:191], v[84:87], v[252:255], v[188:191]
  v_lshrrev_b32 v10, 16, v10
  v_mul_u32_u24 v10, 1120, v10
  v_lshl_add_u32 v10, v9, 4, v10
  v_mfma_f32_16x16x32_bf16 v[204:207], v[88:91], v[252:255], v[204:207]
  v_accvgpr_write_b32 a252, v10
  v_mfma_f32_16x16x32_bf16 v[220:223], v[92:95], v[252:255], v[220:223]
  s_waitcnt vmcnt(15) lgkmcnt(0)
  v_mfma_f32_16x16x32_bf16 v[96:99], v[32:35], v[224:227], v[96:99]
  v_accvgpr_read_b32 v16, a120
  v_accvgpr_read_b32 v17, a121
  v_accvgpr_read_b32 v18, a122
  v_mfma_f32_16x16x32_bf16 v[112:115], v[36:39], v[224:227], v[112:115]
  s_mul_i32 s34, s20, 5120
  ds_read_b64_tr_b16 v[64:65], v12 offset:8192
  v_accvgpr_read_b32 v19, a123
  v_accvgpr_read_b32 v20, a124
  v_mfma_f32_16x16x32_bf16 v[128:131], v[40:43], v[224:227], v[128:131]
  s_add_u32 s34, s34, 131072
  ds_read_b64_tr_b16 v[66:67], v12 offset:9216
  v_accvgpr_read_b32 v21, a125
  v_accvgpr_read_b32 v22, a126
  v_mfma_f32_16x16x32_bf16 v[144:147], v[44:47], v[224:227], v[144:147]
  s_and_b32 s32, s21, 3
  buffer_load_dword v15, v8, s[40:43], 0 offen sc1
  v_accvgpr_read_b32 v23, a127
  v_mul_f32 v16, s76, v16
  v_mfma_f32_16x16x32_bf16 v[160:163], v[48:51], v[224:227], v[160:163]
  s_min_u32 s32, s32, 2
  ds_read_b64_tr_b16 v[68:69], v13 offset:8192
  v_mul_f32 v17, s76, v17
  v_mul_f32 v18, s76, v18
  v_mfma_f32_16x16x32_bf16 v[176:179], v[52:55], v[224:227], v[176:179]
  s_add_u32 s32, s32, 5
  ds_read_b64_tr_b16 v[70:71], v13 offset:9216
  v_mul_f32 v19, s76, v19
  v_mul_f32 v20, s76, v20
  v_mfma_f32_16x16x32_bf16 v[192:195], v[56:59], v[224:227], v[192:195]
  s_lshl_b32 s32, s32, 14
  ds_read_b64_tr_b16 v[72:73], v12 offset:8448
  v_mul_f32 v21, s76, v21
  v_mul_f32 v22, s76, v22
  v_mfma_f32_16x16x32_bf16 v[208:211], v[60:63], v[224:227], v[208:211]
  s_mov_b32 s9, -1
  ds_read_b64_tr_b16 v[74:75], v12 offset:9472
  v_mul_f32 v23, s76, v23
  v_mfma_f32_16x16x32_bf16 v[100:103], v[32:35], v[228:231], v[100:103]
  s_sub_u32 s23, s2, 64
  v_cvt_pk_bf16_f32 v28, v16, v17
  v_cvt_pk_bf16_f32 v29, v18, v19
  v_cvt_pk_bf16_f32 v30, v20, v21
  v_mfma_f32_16x16x32_bf16 v[116:119], v[36:39], v[228:231], v[116:119]
  s_cmp_lt_u32 s23, 96
  s_cselect_b32 s9, 0, s9
  ds_read_b64_tr_b16 v[76:77], v13 offset:8448
  v_cvt_pk_bf16_f32 v31, v22, v23
  v_mfma_f32_16x16x32_bf16 v[132:135], v[40:43], v[228:231], v[132:135]
  s_cmp_ge_u32 s2, 224
  s_cselect_b32 s9, 0, s9
  ds_read_b64_tr_b16 v[78:79], v13 offset:9472
  buffer_store_dwordx4 v[28:31], v2, s[40:43], s64 offen offset:3072 sc1
  v_accvgpr_read_b32 v16, a128
  v_mfma_f32_16x16x32_bf16 v[148:151], v[44:47], v[228:231], v[148:151]
  s_and_b32 s32, s32, s9
  ds_read_b128 v[240:243], v14 offset:32768
  v_accvgpr_read_b32 v17, a129
  v_accvgpr_read_b32 v18, a130
  v_mfma_f32_16x16x32_bf16 v[164:167], v[48:51], v[228:231], v[164:167]
  s_sub_u32 s23, s2, 170
  ds_read_b128 v[244:247], v14 offset:33792
  v_accvgpr_read_b32 v19, a131
  v_accvgpr_read_b32 v20, a132
  v_mfma_f32_16x16x32_bf16 v[180:183], v[52:55], v[228:231], v[180:183]
  s_cmp_lt_u32 s23, 54
  s_cselect_b32 s32, 81920, s32
  v_accvgpr_read_b32 v21, a133
  v_accvgpr_read_b32 v22, a134
  v_accvgpr_read_b32 v23, a135
  v_mfma_f32_16x16x32_bf16 v[196:199], v[56:59], v[228:231], v[196:199]
  s_mov_b32 s67, s2
  s_add_u32 s64, s64, 126976
  ds_read_b64_tr_b16 v[80:81], v12 offset:8704
  v_mul_f32 v16, s76, v16
  v_mfma_f32_16x16x32_bf16 v[212:215], v[60:63], v[228:231], v[212:215]
  s_mov_b32 s8, 0
  ds_read_b64_tr_b16 v[82:83], v12 offset:9728
  v_mul_f32 v17, s76, v17
  v_mul_f32 v18, s76, v18
  v_mfma_f32_16x16x32_bf16 v[104:107], v[32:35], v[232:235], v[104:107]
  s_mov_b32 s66, 0
  ds_read_b64_tr_b16 v[84:85], v13 offset:8704
  v_mul_f32 v19, s76, v19
  v_mul_f32 v20, s76, v20
  v_mfma_f32_16x16x32_bf16 v[120:123], v[36:39], v[232:235], v[120:123]
  s_mov_b32 s11, 0
  ds_read_b64_tr_b16 v[86:87], v13 offset:9728
  v_mul_f32 v21, s76, v21
  v_mul_f32 v22, s76, v22
  v_mfma_f32_16x16x32_bf16 v[136:139], v[40:43], v[232:235], v[136:139]
  s_mov_b32 s12, 0
  v_mul_f32 v23, s76, v23
  v_cvt_pk_bf16_f32 v24, v16, v17
  v_cvt_pk_bf16_f32 v25, v18, v19
  v_mfma_f32_16x16x32_bf16 v[152:155], v[44:47], v[232:235], v[152:155]
  s_lshl_b32 s15, s22, 1
  ds_read_b64_tr_b16 v[88:89], v12 offset:8960
  v_cvt_pk_bf16_f32 v26, v20, v21
  v_cvt_pk_bf16_f32 v27, v22, v23
  v_mfma_f32_16x16x32_bf16 v[168:171], v[48:51], v[232:235], v[168:171]
  s_add_u32 s23, s15, 6
  ds_read_b64_tr_b16 v[90:91], v12 offset:9984
  buffer_store_dwordx4 v[24:27], v2, s[40:43], s64 offen offset:0 sc1
  v_accvgpr_read_b32 v16, a136
  v_mfma_f32_16x16x32_bf16 v[184:187], v[52:55], v[232:235], v[184:187]
  s_sub_u32 s15, 24, s15
  ds_read_b64_tr_b16 v[92:93], v13 offset:8960
  v_accvgpr_read_b32 v17, a137
  v_accvgpr_read_b32 v18, a138
  v_mfma_f32_16x16x32_bf16 v[200:203], v[56:59], v[232:235], v[200:203]
  s_max_u32 s15, s15, s23
  ds_read_b64_tr_b16 v[94:95], v13 offset:9984
  v_accvgpr_read_b32 v19, a139
  v_mfma_f32_16x16x32_bf16 v[216:219], v[60:63], v[232:235], v[216:219]
  s_lshl_b32 s15, s15, 14
  v_accvgpr_read_b32 v20, a140
  v_accvgpr_read_b32 v21, a141
  v_accvgpr_read_b32 v22, a142
  v_mfma_f32_16x16x32_bf16 v[108:111], v[32:35], v[236:239], v[108:111]
  ds_read_b128 v[248:251], v14 offset:34816
  v_accvgpr_read_b32 v23, a143
  v_mul_f32 v16, s76, v16
  v_mfma_f32_16x16x32_bf16 v[124:127], v[36:39], v[236:239], v[124:127]
  ds_read_b128 v[252:255], v14 offset:35840
  v_mul_f32 v17, s76, v17
  v_mul_f32 v18, s76, v18
  v_mfma_f32_16x16x32_bf16 v[140:143], v[40:43], v[236:239], v[140:143]
  v_mul_f32 v19, s76, v19
  v_mul_f32 v20, s76, v20
  v_mul_f32 v21, s76, v21
  v_mfma_f32_16x16x32_bf16 v[156:159], v[44:47], v[236:239], v[156:159]
  v_xor_b32 v14, 0x10000, v14
  v_mul_f32 v22, s76, v22
  v_mul_f32 v23, s76, v23
  v_mfma_f32_16x16x32_bf16 v[172:175], v[48:51], v[236:239], v[172:175]
  v_cvt_pk_bf16_f32 v28, v16, v17
  v_cvt_pk_bf16_f32 v29, v18, v19
  v_cvt_pk_bf16_f32 v30, v20, v21
  v_mfma_f32_16x16x32_bf16 v[188:191], v[52:55], v[236:239], v[188:191]
  v_cvt_pk_bf16_f32 v31, v22, v23
  v_mfma_f32_16x16x32_bf16 v[204:207], v[56:59], v[236:239], v[204:207]
  buffer_store_dwordx4 v[28:31], v2, s[40:43], s64 offen offset:1024 sc1
  v_mfma_f32_16x16x32_bf16 v[220:223], v[60:63], v[236:239], v[220:223]
  s_waitcnt vmcnt(13) lgkmcnt(0)
  v_mfma_f32_16x16x32_bf16 v[96:99], v[64:67], v[240:243], v[96:99]
  s_barrier
  v_accvgpr_read_b32 v16, a144
  v_accvgpr_read_b32 v17, a145
  v_accvgpr_read_b32 v18, a146
  v_accvgpr_read_b32 v19, a147
  v_mfma_f32_16x16x32_bf16 v[112:115], v[68:71], v[240:243], v[112:115]
  s_and_b32 s23, s20, 1
  ds_read_b64_tr_b16 v[32:33], v12 offset:32768
  v_accvgpr_read_b32 v20, a148
  v_accvgpr_read_b32 v21, a149
  v_mfma_f32_16x16x32_bf16 v[128:131], v[72:75], v[240:243], v[128:131]
  s_lshl_b32 s23, s23, 12
  ds_read_b64_tr_b16 v[34:35], v12 offset:33792
  v_accvgpr_read_b32 v22, a150
  v_accvgpr_read_b32 v23, a151
  v_mfma_f32_16x16x32_bf16 v[144:147], v[76:79], v[240:243], v[144:147]
  s_cmp_lt_u32 s20, 2
  s_cselect_b32 s24, 106496, 0
  v_mul_f32 v16, s76, v16
  v_mul_f32 v17, s76, v17
  v_mul_f32 v18, s76, v18
  v_mfma_f32_16x16x32_bf16 v[160:163], v[80:83], v[240:243], v[160:163]
  s_add_u32 s24, s24, s23
  ds_read_b64_tr_b16 v[36:37], v13 offset:32768
  v_mul_f32 v19, s76, v19
  v_mul_f32 v20, s76, v20
  v_mfma_f32_16x16x32_bf16 v[176:179], v[84:87], v[240:243], v[176:179]
  s_lshl_b32 s26, s20, 12
  ds_read_b64_tr_b16 v[38:39], v13 offset:33792
  v_mul_f32 v21, s76, v21
  v_mul_f32 v22, s76, v22
  v_mfma_f32_16x16x32_bf16 v[192:195], v[88:91], v[240:243], v[192:195]
  s_mov_b32 s27, s26
  ds_read_b64_tr_b16 v[40:41], v12 offset:33024
  v_mul_f32 v23, s76, v23
  v_cvt_pk_bf16_f32 v24, v16, v17
  v_mfma_f32_16x16x32_bf16 v[208:211], v[92:95], v[240:243], v[208:211]
  s_add_u32 s25, s27, 49152
  ds_read_b64_tr_b16 v[42:43], v12 offset:34048
  v_cvt_pk_bf16_f32 v25, v18, v19
  v_cvt_pk_bf16_f32 v26, v20, v21
  v_cvt_pk_bf16_f32 v27, v22, v23
  v_mfma_f32_16x16x32_bf16 v[100:103], v[64:67], v[244:247], v[100:103]
  s_load_dwordx4 s[4:7], s[0:1], 64
  buffer_store_dwordx4 v[24:27], v2, s[40:43], s64 offen offset:2048 sc1
  v_accvgpr_read_b32 v16, a152
  v_accvgpr_read_b32 v17, a153
  v_mfma_f32_16x16x32_bf16 v[116:119], v[68:71], v[244:247], v[116:119]
  s_load_dwordx2 s[60:61], s[0:1], 80
  ds_read_b64_tr_b16 v[44:45], v13 offset:33024
  v_accvgpr_read_b32 v18, a154
  v_accvgpr_read_b32 v19, a155
  v_mfma_f32_16x16x32_bf16 v[132:135], v[72:75], v[244:247], v[132:135]
  s_add_u32 s23, s20, 1
  ds_read_b64_tr_b16 v[46:47], v13 offset:34048
  v_accvgpr_read_b32 v20, a156
  v_accvgpr_read_b32 v21, a157
  v_mfma_f32_16x16x32_bf16 v[148:151], v[76:79], v[244:247], v[148:151]
  s_lshr_b32 s23, s23, 1
  ds_read_b128 v[224:227], v14 offset:0
  v_accvgpr_read_b32 v22, a158
  v_accvgpr_read_b32 v23, a159
  v_mfma_f32_16x16x32_bf16 v[164:167], v[80:83], v[244:247], v[164:167]
  s_lshl_b32 s28, s22, 1
  ds_read_b128 v[228:231], v14 offset:1024
  v_mul_f32 v16, s76, v16
  v_mul_f32 v17, s76, v17
  v_mfma_f32_16x16x32_bf16 v[180:183], v[84:87], v[244:247], v[180:183]
  s_add_u32 s28, s28, s23
  v_mul_f32 v18, s76, v18
  v_mul_f32 v19, s76, v19
  v_mul_f32 v20, s76, v20
  v_mfma_f32_16x16x32_bf16 v[196:199], v[88:91], v[244:247], v[196:199]
  s_lshl_b32 s23, s22, 2
  ds_read_b64_tr_b16 v[48:49], v12 offset:33280
  v_mul_f32 v21, s76, v21
  v_mul_f32 v22, s76, v22
  v_mfma_f32_16x16x32_bf16 v[212:215], v[92:95], v[244:247], v[212:215]
  s_sub_u32 s29, 28, s23
  ds_read_b64_tr_b16 v[50:51], v12 offset:34304
  v_mul_f32 v23, s76, v23
  v_cvt_pk_bf16_f32 v28, v16, v17
  v_cvt_pk_bf16_f32 v29, v18, v19
  v_mfma_f32_16x16x32_bf16 v[104:107], v[64:67], v[248:251], v[104:107]
  s_and_b32 s23, s20, 1
  ds_read_b64_tr_b16 v[52:53], v13 offset:33280
  v_cvt_pk_bf16_f32 v30, v20, v21
  v_cvt_pk_bf16_f32 v31, v22, v23
  v_mfma_f32_16x16x32_bf16 v[120:123], v[68:71], v[248:251], v[120:123]
  s_add_u32 s29, s29, s23
  ds_read_b64_tr_b16 v[54:55], v13 offset:34304
  buffer_store_dwordx4 v[28:31], v2, s[40:43], s64 offen offset:3072 sc1
  v_accvgpr_read_b32 v16, a160
  v_mfma_f32_16x16x32_bf16 v[136:139], v[72:75], v[248:251], v[136:139]
  s_add_u32 s64, s64, 4096
  v_accvgpr_read_b32 v17, a161
  v_accvgpr_read_b32 v18, a162
  v_accvgpr_read_b32 v19, a163
  v_mfma_f32_16x16x32_bf16 v[152:155], v[76:79], v[248:251], v[152:155]
  ds_read_b64_tr_b16 v[56:57], v12 offset:33536
  v_accvgpr_read_b32 v20, a164
  v_accvgpr_read_b32 v21, a165
  v_mfma_f32_16x16x32_bf16 v[168:171], v[80:83], v[248:251], v[168:171]
  ds_read_b64_tr_b16 v[58:59], v12 offset:34560
  v_accvgpr_read_b32 v22, a166
  v_accvgpr_read_b32 v23, a167
  v_mfma_f32_16x16x32_bf16 v[184:187], v[84:87], v[248:251], v[184:187]
  ds_read_b64_tr_b16 v[60:61], v13 offset:33536
  v_mul_f32 v16, s76, v16
  v_mul_f32 v17, s76, v17
  v_mfma_f32_16x16x32_bf16 v[200:203], v[88:91], v[248:251], v[200:203]
  ds_read_b64_tr_b16 v[62:63], v13 offset:34560
  v_mul_f32 v18, s76, v18
  v_mul_f32 v19, s76, v19
  v_mul_f32 v20, s76, v20
  v_mfma_f32_16x16x32_bf16 v[216:219], v[92:95], v[248:251], v[216:219]
  v_mul_f32 v21, s76, v21
  v_mul_f32 v22, s76, v22
  v_mul_f32 v23, s76, v23
  v_mfma_f32_16x16x32_bf16 v[108:111], v[64:67], v[252:255], v[108:111]
  ds_read_b128 v[232:235], v14 offset:2048
  v_cvt_pk_bf16_f32 v24, v16, v17
  v_cvt_pk_bf16_f32 v25, v18, v19
  v_mfma_f32_16x16x32_bf16 v[124:127], v[68:71], v[252:255], v[124:127]
  ds_read_b128 v[236:239], v14 offset:3072
  v_cvt_pk_bf16_f32 v26, v20, v21
  v_cvt_pk_bf16_f32 v27, v22, v23
  v_mfma_f32_16x16x32_bf16 v[140:143], v[72:75], v[252:255], v[140:143]
  buffer_store_dwordx4 v[24:27], v2, s[40:43], s64 offen offset:0 sc1
  v_lshrrev_b32 v6, 2, v1
  v_mul_u32_u24 v6, 160, v6
  v_mfma_f32_16x16x32_bf16 v[156:159], v[76:79], v[252:255], v[156:159]
  v_and_b32 v9, 3, v1
  v_lshl_add_u32 v6, v9, 3, v6
  v_add_u32 v6, s34, v6
  v_mfma_f32_16x16x32_bf16 v[172:175], v[80:83], v[252:255], v[172:175]
  v_mov_b32 v3, v2
  v_mov_b32 v4, 0xff800000
  v_add_u32 v9, 106496, v2
  v_mfma_f32_16x16x32_bf16 v[188:191], v[84:87], v[252:255], v[188:191]
  v_mfma_f32_16x16x32_bf16 v[204:207], v[88:91], v[252:255], v[204:207]
  v_mfma_f32_16x16x32_bf16 v[220:223], v[92:95], v[252:255], v[220:223]
  s_waitcnt vmcnt(9) lgkmcnt(0)
  v_mfma_f32_16x16x32_bf16 v[96:99], v[32:35], v[224:227], v[96:99]
  v_accvgpr_read_b32 v16, a168
  v_accvgpr_read_b32 v17, a169
  v_accvgpr_read_b32 v18, a170
  v_mfma_f32_16x16x32_bf16 v[112:115], v[36:39], v[224:227], v[112:115]
  s_cmp_ge_u32 s20, 2
  s_cselect_b32 s4, s6, s4
  s_cselect_b32 s5, s7, s5
  ds_read_b64_tr_b16 v[64:65], v12 offset:40960
  v_accvgpr_read_b32 v19, a171
  v_accvgpr_read_b32 v20, a172
  v_mfma_f32_16x16x32_bf16 v[128:131], v[40:43], v[224:227], v[128:131]
  s_mov_b32 s62, 2211840
  ds_read_b64_tr_b16 v[66:67], v12 offset:41984
  v_accvgpr_read_b32 v21, a173
  v_accvgpr_read_b32 v22, a174
  v_mfma_f32_16x16x32_bf16 v[144:147], v[44:47], v[224:227], v[144:147]
  s_mov_b32 s63, 0x20000
  v_accvgpr_read_b32 v23, a175
  v_mul_f32 v16, s76, v16
  v_mul_f32 v17, s76, v17
  v_mfma_f32_16x16x32_bf16 v[160:163], v[48:51], v[224:227], v[160:163]
  s_mov_b64 s[56:57], s[52:53]
  ds_read_b64_tr_b16 v[68:69], v13 offset:40960
  v_mul_f32 v18, s76, v18
  v_mfma_f32_16x16x32_bf16 v[176:179], v[52:55], v[224:227], v[176:179]
  s_mov_b32 s58, s54
  ds_read_b64_tr_b16 v[70:71], v13 offset:41984
  v_mul_f32 v19, s76, v19
  v_mul_f32 v20, s76, v20
  v_mfma_f32_16x16x32_bf16 v[192:195], v[56:59], v[224:227], v[192:195]
  s_mov_b64 s[52:53], s[4:5]
  ds_read_b64_tr_b16 v[72:73], v12 offset:41216
  v_mul_f32 v21, s76, v21
  v_mul_f32 v22, s76, v22
  v_mfma_f32_16x16x32_bf16 v[208:211], v[60:63], v[224:227], v[208:211]
  s_mov_b32 s54, 2211840
  ds_read_b64_tr_b16 v[74:75], v12 offset:42240
  v_mul_f32 v23, s76, v23
  v_cvt_pk_bf16_f32 v28, v16, v17
  v_mfma_f32_16x16x32_bf16 v[100:103], v[32:35], v[228:231], v[100:103]
  s_getpc_b64 s[36:37]
fa_copc:
  v_cvt_pk_bf16_f32 v29, v18, v19
  v_cvt_pk_bf16_f32 v30, v20, v21
  v_cvt_pk_bf16_f32 v31, v22, v23
  v_mfma_f32_16x16x32_bf16 v[116:119], v[36:39], v[228:231], v[116:119]
  s_add_u32 s36, s36, fa_co-fa_copc-4
  s_addc_u32 s37, s37, 0
  ds_read_b64_tr_b16 v[76:77], v13 offset:41216
  buffer_store_dwordx4 v[28:31], v2, s[40:43], s64 offen offset:1024 sc1
  v_mfma_f32_16x16x32_bf16 v[132:135], v[40:43], v[228:231], v[132:135]
  s_lshl_b32 s31, s20, 11
  ds_read_b64_tr_b16 v[78:79], v13 offset:42240
  v_accvgpr_read_b32 v16, a176
  v_accvgpr_read_b32 v17, a177
  v_mfma_f32_16x16x32_bf16 v[148:151], v[44:47], v[228:231], v[148:151]
  s_add_u32 s31, s31, 2621440
  ds_read_b128 v[240:243], v14 offset:32768
  v_accvgpr_read_b32 v18, a178
  v_accvgpr_read_b32 v19, a179
  v_mfma_f32_16x16x32_bf16 v[164:167], v[48:51], v[228:231], v[164:167]
  s_cmp_eq_u32 s2, 255
  s_cselect_b32 s31, s31, 1073741824
  ds_read_b128 v[244:247], v14 offset:33792
  v_accvgpr_read_b32 v20, a180
  v_accvgpr_read_b32 v21, a181
  v_mfma_f32_16x16x32_bf16 v[180:183], v[52:55], v[228:231], v[180:183]
  v_accvgpr_read_b32 v22, a182
  v_accvgpr_read_b32 v23, a183
  v_mul_f32 v16, s76, v16
  v_mfma_f32_16x16x32_bf16 v[196:199], v[56:59], v[228:231], v[196:199]
  ds_read_b64_tr_b16 v[80:81], v12 offset:41472
  v_mul_f32 v17, s76, v17
  v_mfma_f32_16x16x32_bf16 v[212:215], v[60:63], v[228:231], v[212:215]
  ds_read_b64_tr_b16 v[82:83], v12 offset:42496
  v_mul_f32 v18, s76, v18
  v_mul_f32 v19, s76, v19
  v_mfma_f32_16x16x32_bf16 v[104:107], v[32:35], v[232:235], v[104:107]
  ds_read_b64_tr_b16 v[84:85], v13 offset:41472
  v_mul_f32 v20, s76, v20
  v_mul_f32 v21, s76, v21
  v_mfma_f32_16x16x32_bf16 v[120:123], v[36:39], v[232:235], v[120:123]
  ds_read_b64_tr_b16 v[86:87], v13 offset:42496
  v_mul_f32 v22, s76, v22
  v_mul_f32 v23, s76, v23
  v_mfma_f32_16x16x32_bf16 v[136:139], v[40:43], v[232:235], v[136:139]
  v_cvt_pk_bf16_f32 v24, v16, v17
  v_cvt_pk_bf16_f32 v25, v18, v19
  v_cvt_pk_bf16_f32 v26, v20, v21
  v_mfma_f32_16x16x32_bf16 v[152:155], v[44:47], v[232:235], v[152:155]
  ds_read_b64_tr_b16 v[88:89], v12 offset:41728
  v_cvt_pk_bf16_f32 v27, v22, v23
  v_mfma_f32_16x16x32_bf16 v[168:171], v[48:51], v[232:235], v[168:171]
  ds_read_b64_tr_b16 v[90:91], v12 offset:42752
  buffer_store_dwordx4 v[24:27], v2, s[40:43], s64 offen offset:2048 sc1
  v_accvgpr_read_b32 v16, a184
  v_mfma_f32_16x16x32_bf16 v[184:187], v[52:55], v[232:235], v[184:187]
  ds_read_b64_tr_b16 v[92:93], v13 offset:41728
  v_accvgpr_read_b32 v17, a185
  v_accvgpr_read_b32 v18, a186
  v_mfma_f32_16x16x32_bf16 v[200:203], v[56:59], v[232:235], v[200:203]
  ds_read_b64_tr_b16 v[94:95], v13 offset:42752
  v_accvgpr_read_b32 v19, a187
  v_accvgpr_read_b32 v20, a188
  v_mfma_f32_16x16x32_bf16 v[216:219], v[60:63], v[232:235], v[216:219]
  v_accvgpr_read_b32 v21, a189
  v_accvgpr_read_b32 v22, a190
  v_accvgpr_read_b32 v23, a191
  v_mfma_f32_16x16x32_bf16 v[108:111], v[32:35], v[236:239], v[108:111]
  ds_read_b128 v[248:251], v14 offset:34816
  v_mul_f32 v16, s76, v16
  v_mfma_f32_16x16x32_bf16 v[124:127], v[36:39], v[236:239], v[124:127]
  ds_read_b128 v[252:255], v14 offset:35840
  v_mul_f32 v17, s76, v17
  v_mul_f32 v18, s76, v18
  v_mfma_f32_16x16x32_bf16 v[140:143], v[40:43], v[236:239], v[140:143]
  v_mul_f32 v19, s76, v19
  v_mul_f32 v20, s76, v20
  v_mul_f32 v21, s76, v21
  v_mfma_f32_16x16x32_bf16 v[156:159], v[44:47], v[236:239], v[156:159]
  v_xor_b32 v14, 0x10000, v14
  v_mul_f32 v22, s76, v22
  v_mul_f32 v23, s76, v23
  v_mfma_f32_16x16x32_bf16 v[172:175], v[48:51], v[236:239], v[172:175]
  v_cvt_pk_bf16_f32 v28, v16, v17
  v_cvt_pk_bf16_f32 v29, v18, v19
  v_cvt_pk_bf16_f32 v30, v20, v21
  v_mfma_f32_16x16x32_bf16 v[188:191], v[52:55], v[236:239], v[188:191]
  v_xor_b32 v12, 0x10000, v12
  v_cvt_pk_bf16_f32 v31, v22, v23
  v_mfma_f32_16x16x32_bf16 v[204:207], v[56:59], v[236:239], v[204:207]
  buffer_store_dwordx4 v[28:31], v2, s[40:43], s64 offen offset:3072 sc1
  v_xor_b32 v13, 0x10000, v13
  v_mfma_f32_16x16x32_bf16 v[220:223], v[60:63], v[236:239], v[220:223]
  s_waitcnt vmcnt(9) lgkmcnt(0)
  v_mfma_f32_16x16x32_bf16 v[96:99], v[64:67], v[240:243], v[96:99]
  s_barrier
  buffer_load_dwordx4 v[232:235], v2, s[40:43], s31 offen sc1
  v_cmp_eq_u32 vcc, 0, v15
  v_mfma_f32_16x16x32_bf16 v[112:115], v[68:71], v[240:243], v[112:115]
  s_cbranch_vccnz fa_kv_spin
fa_kv_ok:
  buffer_load_dwordx4 v[236:239], v2, s[40:43], s31 offen offset:1024 sc1
  v_mfma_f32_16x16x32_bf16 v[128:131], v[72:75], v[240:243], v[128:131]
  s_mov_b32 m0, s24
  v_mov_b32 v228, 0
  v_mfma_f32_16x16x32_bf16 v[144:147], v[76:79], v[240:243], v[144:147]
  buffer_load_dwordx4 v2, s[44:47], s26 offen offset:0 sc1 lds
  v_mfma_f32_16x16x32_bf16 v[160:163], v[80:83], v[240:243], v[160:163]
  s_add_u32 s24, s24, 32768
  v_mov_b32 v229, 0
  v_mfma_f32_16x16x32_bf16 v[176:179], v[84:87], v[240:243], v[176:179]
  s_and_b32 s24, s24, 0x1ffff
  buffer_load_dwordx4 v2, s[44:47], s26 offen offset:1024 sc1 lds
  v_mfma_f32_16x16x32_bf16 v[192:195], v[88:91], v[240:243], v[192:195]
  v_mov_b32 v230, 0
  v_mfma_f32_16x16x32_bf16 v[208:211], v[92:95], v[240:243], v[208:211]
  buffer_load_dwordx4 v2, s[44:47], s26 offen offset:2048 sc1 lds
  v_mfma_f32_16x16x32_bf16 v[100:103], v[64:67], v[244:247], v[100:103]
  v_mov_b32 v231, 0
  v_mfma_f32_16x16x32_bf16 v[116:119], v[68:71], v[244:247], v[116:119]
  buffer_load_dwordx4 v2, s[44:47], s26 offen offset:3072 sc1 lds
  v_mfma_f32_16x16x32_bf16 v[132:135], v[72:75], v[244:247], v[132:135]
  s_add_u32 s26, s26, 16384
  v_cvt_pk_bf16_f32 v32, v96, v97
  v_cvt_pk_bf16_f32 v33, v98, v99
  v_mfma_f32_16x16x32_bf16 v[148:151], v[76:79], v[244:247], v[148:151]
  v_cvt_pk_bf16_f32 v34, v112, v113
  v_cvt_pk_bf16_f32 v35, v114, v115
  v_mfma_f32_16x16x32_bf16 v[164:167], v[80:83], v[244:247], v[164:167]
  s_mov_b32 m0, s24
  v_cvt_pk_bf16_f32 v40, v128, v129
  v_mfma_f32_16x16x32_bf16 v[180:183], v[84:87], v[244:247], v[180:183]
  buffer_load_dwordx4 v2, s[44:47], s26 offen offset:0 sc1 lds
  v_cvt_pk_bf16_f32 v41, v130, v131
  v_cvt_pk_bf16_f32 v42, v144, v145
  v_mfma_f32_16x16x32_bf16 v[196:199], v[88:91], v[244:247], v[196:199]
  s_add_u32 s24, s24, 32768
  v_cvt_pk_bf16_f32 v43, v146, v147
  v_mfma_f32_16x16x32_bf16 v[212:215], v[92:95], v[244:247], v[212:215]
  s_and_b32 s24, s24, 0x1ffff
  buffer_load_dwordx4 v2, s[44:47], s26 offen offset:1024 sc1 lds
  v_cvt_pk_bf16_f32 v48, v160, v161
  v_cvt_pk_bf16_f32 v49, v162, v163
  v_mfma_f32_16x16x32_bf16 v[104:107], v[64:67], v[248:251], v[104:107]
  v_cvt_pk_bf16_f32 v50, v176, v177
  v_cvt_pk_bf16_f32 v51, v178, v179
  v_mfma_f32_16x16x32_bf16 v[120:123], v[68:71], v[248:251], v[120:123]
  buffer_load_dwordx4 v2, s[44:47], s26 offen offset:2048 sc1 lds
  v_cvt_pk_bf16_f32 v56, v192, v193
  v_mfma_f32_16x16x32_bf16 v[136:139], v[72:75], v[248:251], v[136:139]
  v_cvt_pk_bf16_f32 v57, v194, v195
  v_cvt_pk_bf16_f32 v58, v208, v209
  v_mfma_f32_16x16x32_bf16 v[152:155], v[76:79], v[248:251], v[152:155]
  buffer_load_dwordx4 v2, s[44:47], s26 offen offset:3072 sc1 lds
  v_cvt_pk_bf16_f32 v59, v210, v211
  v_mfma_f32_16x16x32_bf16 v[168:171], v[80:83], v[248:251], v[168:171]
  s_add_u32 s26, s26, 16384
  v_cvt_pk_bf16_f32 v36, v100, v101
  v_cvt_pk_bf16_f32 v37, v102, v103
  v_mfma_f32_16x16x32_bf16 v[184:187], v[84:87], v[248:251], v[184:187]
  v_cvt_pk_bf16_f32 v38, v116, v117
  v_mfma_f32_16x16x32_bf16 v[200:203], v[88:91], v[248:251], v[200:203]
  s_mov_b32 m0, s24
  v_cvt_pk_bf16_f32 v39, v118, v119
  v_cvt_pk_bf16_f32 v44, v132, v133
  v_mfma_f32_16x16x32_bf16 v[216:219], v[92:95], v[248:251], v[216:219]
  buffer_load_dwordx4 v2, s[44:47], s26 offen offset:0 sc1 lds
  v_cvt_pk_bf16_f32 v45, v134, v135
  v_mfma_f32_16x16x32_bf16 v[108:111], v[64:67], v[252:255], v[108:111]
  s_add_u32 s24, s24, 32768
  v_cvt_pk_bf16_f32 v46, v148, v149
  v_cvt_pk_bf16_f32 v47, v150, v151
  v_mfma_f32_16x16x32_bf16 v[124:127], v[68:71], v[252:255], v[124:127]
  s_and_b32 s24, s24, 0x1ffff
  buffer_load_dwordx4 v2, s[44:47], s26 offen offset:1024 sc1 lds
  v_cvt_pk_bf16_f32 v52, v164, v165
  v_mfma_f32_16x16x32_bf16 v[140:143], v[72:75], v[252:255], v[140:143]
  v_cvt_pk_bf16_f32 v53, v166, v167
  v_cvt_pk_bf16_f32 v54, v180, v181
  v_mfma_f32_16x16x32_bf16 v[156:159], v[76:79], v[252:255], v[156:159]
  buffer_load_dwordx4 v2, s[44:47], s26 offen offset:2048 sc1 lds
  v_cvt_pk_bf16_f32 v55, v182, v183
  v_mfma_f32_16x16x32_bf16 v[172:175], v[80:83], v[252:255], v[172:175]
  v_cvt_pk_bf16_f32 v60, v196, v197
  v_cvt_pk_bf16_f32 v61, v198, v199
  v_mfma_f32_16x16x32_bf16 v[188:191], v[84:87], v[252:255], v[188:191]
  buffer_load_dwordx4 v2, s[44:47], s26 offen offset:3072 sc1 lds
  v_cvt_pk_bf16_f32 v62, v212, v213
  v_mfma_f32_16x16x32_bf16 v[204:207], v[88:91], v[252:255], v[204:207]
  s_add_u32 s26, s26, 16384
  v_cvt_pk_bf16_f32 v63, v214, v215
  v_mfma_f32_16x16x32_bf16 v[220:223], v[92:95], v[252:255], v[220:223]
  s_mov_b32 m0, s25
  s_nop 0
  v_mfma_f32_32x32x16_bf16 a[0:15], v[228:231], v[228:231], 0
  buffer_load_dwordx4 v2, s[48:51], s27 offen offset:0 sc1 lds
  v_cvt_pk_bf16_f32 v64, v104, v105
  v_cvt_pk_bf16_f32 v65, v106, v107
  v_cvt_pk_bf16_f32 v66, v120, v121
  v_cvt_pk_bf16_f32 v67, v122, v123
  v_mfma_f32_32x32x16_bf16 a[16:31], v[228:231], v[228:231], 0
  buffer_load_dwordx4 v2, s[48:51], s27 offen offset:1024 sc1 lds
  v_cvt_pk_bf16_f32 v72, v136, v137
  v_cvt_pk_bf16_f32 v73, v138, v139
  v_cvt_pk_bf16_f32 v74, v152, v153
  v_cvt_pk_bf16_f32 v75, v154, v155
  v_mfma_f32_32x32x16_bf16 a[32:47], v[228:231], v[228:231], 0
  buffer_load_dwordx4 v2, s[48:51], s27 offen offset:2048 sc1 lds
  v_cvt_pk_bf16_f32 v80, v168, v169
  v_cvt_pk_bf16_f32 v81, v170, v171
  v_cvt_pk_bf16_f32 v82, v184, v185
  v_cvt_pk_bf16_f32 v83, v186, v187
  v_mfma_f32_32x32x16_bf16 a[48:63], v[228:231], v[228:231], 0
  buffer_load_dwordx4 v2, s[48:51], s27 offen offset:3072 sc1 lds
  v_cvt_pk_bf16_f32 v88, v200, v201
  v_cvt_pk_bf16_f32 v89, v202, v203
  v_cvt_pk_bf16_f32 v90, v216, v217
  v_cvt_pk_bf16_f32 v91, v218, v219
  s_add_u32 s27, s27, 16384
  s_add_u32 s25, s25, 32768
  s_and_b32 s25, s25, 0x1ffff
  s_mov_b32 m0, s25
  s_nop 0
  v_mfma_f32_32x32x16_bf16 a[64:79], v[228:231], v[228:231], 0
  buffer_load_dwordx4 v2, s[48:51], s27 offen offset:0 sc1 lds
  v_cvt_pk_bf16_f32 v68, v108, v109
  v_cvt_pk_bf16_f32 v69, v110, v111
  v_cvt_pk_bf16_f32 v70, v124, v125
  v_cvt_pk_bf16_f32 v71, v126, v127
  v_mfma_f32_32x32x16_bf16 a[80:95], v[228:231], v[228:231], 0
  buffer_load_dwordx4 v2, s[48:51], s27 offen offset:1024 sc1 lds
  v_cvt_pk_bf16_f32 v76, v140, v141
  v_cvt_pk_bf16_f32 v77, v142, v143
  v_cvt_pk_bf16_f32 v78, v156, v157
  v_cvt_pk_bf16_f32 v79, v158, v159
  v_mfma_f32_32x32x16_bf16 a[96:111], v[228:231], v[228:231], 0
  buffer_load_dwordx4 v2, s[48:51], s27 offen offset:2048 sc1 lds
  v_cvt_pk_bf16_f32 v84, v172, v173
  v_cvt_pk_bf16_f32 v85, v174, v175
  v_cvt_pk_bf16_f32 v86, v188, v189
  v_cvt_pk_bf16_f32 v87, v190, v191
  v_mfma_f32_32x32x16_bf16 a[112:127], v[228:231], v[228:231], 0
  buffer_load_dwordx4 v2, s[48:51], s27 offen offset:3072 sc1 lds
  v_cvt_pk_bf16_f32 v92, v204, v205
  v_cvt_pk_bf16_f32 v93, v206, v207
  v_cvt_pk_bf16_f32 v94, v220, v221
  v_cvt_pk_bf16_f32 v95, v222, v223
  s_add_u32 s27, s27, 16384
  s_add_u32 s25, s25, 32768
  s_and_b32 s25, s25, 0x1ffff
  s_waitcnt vmcnt(12)
  s_barrier
  ds_read_b128 a[128:131], v9 offset:0
  ds_read_b128 a[132:135], v9 offset:1024
  ds_read_b128 a[136:139], v9 offset:2048
  ds_read_b128 a[140:143], v9 offset:3072
  ds_read_b128 a[144:147], v9 offset:4096
  ds_read_b128 a[148:151], v9 offset:5120
  ds_read_b128 a[152:155], v9 offset:6144
  ds_read_b128 a[156:159], v9 offset:7168
  buffer_store_dword v4, off, s[40:43], s65 offset:32 sc1
  v_add_u32 v13, 32, v8
  v_mov_b32 v14, 0
  s_cmp_eq_u32 s2, 255
  s_cbranch_scc1 fa_top8
fa_notop:
  s_waitcnt lgkmcnt(4)
  v_mfma_f32_16x16x32_bf16 v[96:99], a[128:131], v[32:35], 0
  v_mfma_f32_16x16x32_bf16 v[104:107], a[128:131], v[36:39], 0
  v_mfma_f32_16x16x32_bf16 v[128:131], a[128:131], v[64:67], 0
  v_mfma_f32_16x16x32_bf16 v[136:139], a[128:131], v[68:71], 0
  s_mov_b32 m0, s24
  ds_read_b128 a[128:131], v3 offset:0
  v_mfma_f32_16x16x32_bf16 v[100:103], a[132:135], v[32:35], 0
  buffer_load_dwordx4 v2, s[44:47], s26 offen offset:0 sc1 lds
  v_mfma_f32_16x16x32_bf16 v[108:111], a[132:135], v[36:39], 0
  v_mfma_f32_16x16x32_bf16 v[132:135], a[132:135], v[64:67], 0
  v_mfma_f32_16x16x32_bf16 v[140:143], a[132:135], v[68:71], 0
  ds_read_b128 a[132:135], v3 offset:1024
  v_mfma_f32_16x16x32_bf16 v[96:99], a[136:139], v[40:43], v[96:99]
  v_mfma_f32_16x16x32_bf16 v[104:107], a[136:139], v[44:47], v[104:107]
  v_mfma_f32_16x16x32_bf16 v[128:131], a[136:139], v[72:75], v[128:131]
  buffer_load_dwordx4 v2, s[44:47], s26 offen offset:1024 sc1 lds
  v_mfma_f32_16x16x32_bf16 v[136:139], a[136:139], v[76:79], v[136:139]
  ds_read_b128 a[136:139], v3 offset:2048
  v_mfma_f32_16x16x32_bf16 v[100:103], a[140:143], v[40:43], v[100:103]
  v_mfma_f32_16x16x32_bf16 v[108:111], a[140:143], v[44:47], v[108:111]
  v_mfma_f32_16x16x32_bf16 v[132:135], a[140:143], v[72:75], v[132:135]
  v_mfma_f32_16x16x32_bf16 v[140:143], a[140:143], v[76:79], v[140:143]
  s_waitcnt lgkmcnt(3)
  ds_read_b128 a[140:143], v3 offset:3072
  v_mfma_f32_16x16x32_bf16 v[96:99], a[144:147], v[48:51], v[96:99]
  v_mfma_f32_16x16x32_bf16 v[104:107], a[144:147], v[52:55], v[104:107]
  v_mfma_f32_16x16x32_bf16 v[128:131], a[144:147], v[80:83], v[128:131]
  buffer_load_dwordx4 v2, s[44:47], s26 offen offset:2048 sc1 lds
  v_mfma_f32_16x16x32_bf16 v[136:139], a[144:147], v[84:87], v[136:139]
  ds_read_b128 a[144:147], v3 offset:4096
  v_mfma_f32_16x16x32_bf16 v[100:103], a[148:151], v[48:51], v[100:103]
  v_mfma_f32_16x16x32_bf16 v[108:111], a[148:151], v[52:55], v[108:111]
  v_mfma_f32_16x16x32_bf16 v[132:135], a[148:151], v[80:83], v[132:135]
  v_mfma_f32_16x16x32_bf16 v[140:143], a[148:151], v[84:87], v[140:143]
  ds_read_b128 a[148:151], v3 offset:5120
  v_mfma_f32_16x16x32_bf16 v[96:99], a[152:155], v[56:59], v[96:99]
  buffer_load_dwordx4 v2, s[44:47], s26 offen offset:3072 sc1 lds
  v_mfma_f32_16x16x32_bf16 v[104:107], a[152:155], v[60:63], v[104:107]
  s_add_u32 s26, s26, 16384
  v_mfma_f32_16x16x32_bf16 v[128:131], a[152:155], v[88:91], v[128:131]
  s_add_u32 s24, s24, 32768
  v_mfma_f32_16x16x32_bf16 v[136:139], a[152:155], v[92:95], v[136:139]
  s_and_b32 s24, s24, 0x1ffff
  ds_read_b128 a[152:155], v3 offset:6144
  v_mfma_f32_16x16x32_bf16 v[100:103], a[156:159], v[56:59], v[100:103]
  v_mfma_f32_16x16x32_bf16 v[108:111], a[156:159], v[60:63], v[108:111]
  v_mfma_f32_16x16x32_bf16 v[132:135], a[156:159], v[88:91], v[132:135]
  v_mfma_f32_16x16x32_bf16 v[140:143], a[156:159], v[92:95], v[140:143]
  s_waitcnt lgkmcnt(3)
  ds_read_b128 a[156:159], v3 offset:7168
  s_nop 7
  s_cmp_lg_u32 s28, 0
  s_cbranch_scc1 fa_nomask0
  v_cndmask_b32 v96, v4, v96, s[68:69]
  v_cndmask_b32 v97, v4, v97, s[70:71]
  v_cndmask_b32 v98, v4, v98, s[72:73]
  v_cndmask_b32 v99, v4, v99, s[74:75]
  v_mov_b32 v100, v4
  v_mov_b32 v101, v4
  v_mov_b32 v102, v4
  v_mov_b32 v103, v4
  v_cndmask_b32 v108, v4, v108, s[68:69]
  v_cndmask_b32 v109, v4, v109, s[70:71]
  v_cndmask_b32 v110, v4, v110, s[72:73]
  v_cndmask_b32 v111, v4, v111, s[74:75]
fa_nomask0:
  v_max3_f32 v16, v96, v97, v98
  v_max3_f32 v16, v16, v99, v100
  v_max3_f32 v16, v16, v101, v102
  v_max_f32 v16, v16, v103
  v_max3_f32 v17, v104, v105, v106
  v_max3_f32 v17, v17, v107, v108
  v_max3_f32 v17, v17, v109, v110
  v_max_f32 v17, v17, v111
  v_max3_f32 v18, v128, v129, v130
  v_max3_f32 v18, v18, v131, v132
  v_max3_f32 v18, v18, v133, v134
  v_max_f32 v18, v18, v135
  v_max3_f32 v19, v136, v137, v138
  v_max3_f32 v19, v19, v139, v140
  v_max3_f32 v19, v19, v141, v142
  v_max_f32 v19, v19, v143
  v_mov_b32 v20, v16
  v_mov_b32 v21, v17
  v_mov_b32 v22, v18
  v_mov_b32 v23, v19
  s_nop 0
  v_permlane16_swap_b32 v16, v20
  v_permlane16_swap_b32 v17, v21
  v_permlane16_swap_b32 v18, v22
  v_permlane16_swap_b32 v19, v23
  v_max_f32 v16, v16, v20
  v_max_f32 v17, v17, v21
  v_max_f32 v18, v18, v22
  v_max_f32 v19, v19, v23
  v_mov_b32 v20, v16
  v_mov_b32 v21, v17
  v_mov_b32 v22, v18
  v_mov_b32 v23, v19
  s_nop 0
  v_permlane32_swap_b32 v16, v20
  v_permlane32_swap_b32 v17, v21
  v_permlane32_swap_b32 v18, v22
  v_permlane32_swap_b32 v19, v23
  v_max_f32 v16, v16, v20
  v_max_f32 v17, v17, v21
  v_max_f32 v18, v18, v22
  v_max_f32 v19, v19, v23
  v_sub_f32 v192, 0, v16
  v_sub_f32 v193, 0, v16
  v_sub_f32 v194, 0, v16
  v_sub_f32 v195, 0, v16
  v_sub_f32 v196, 0, v17
  v_sub_f32 v197, 0, v17
  v_sub_f32 v198, 0, v17
  v_sub_f32 v199, 0, v17
  v_sub_f32 v200, 0, v18
  v_sub_f32 v201, 0, v18
  v_sub_f32 v202, 0, v18
  v_sub_f32 v203, 0, v18
  v_sub_f32 v204, 0, v19
  v_sub_f32 v205, 0, v19
  v_sub_f32 v206, 0, v19
  v_sub_f32 v207, 0, v19
  v_sub_f32 v96, v96, v16
  v_sub_f32 v97, v97, v16
  v_sub_f32 v98, v98, v16
  v_sub_f32 v99, v99, v16
  v_sub_f32 v100, v100, v16
  v_sub_f32 v101, v101, v16
  v_sub_f32 v102, v102, v16
  v_sub_f32 v103, v103, v16
  v_sub_f32 v104, v104, v17
  v_sub_f32 v105, v105, v17
  v_sub_f32 v106, v106, v17
  v_sub_f32 v107, v107, v17
  v_sub_f32 v108, v108, v17
  v_sub_f32 v109, v109, v17
  v_sub_f32 v110, v110, v17
  v_sub_f32 v111, v111, v17
  v_sub_f32 v128, v128, v18
  v_sub_f32 v129, v129, v18
  v_sub_f32 v130, v130, v18
  v_sub_f32 v131, v131, v18
  v_sub_f32 v132, v132, v18
  v_sub_f32 v133, v133, v18
  v_sub_f32 v134, v134, v18
  v_sub_f32 v135, v135, v18
  v_sub_f32 v136, v136, v19
  v_sub_f32 v137, v137, v19
  v_sub_f32 v138, v138, v19
  v_sub_f32 v139, v139, v19
  v_sub_f32 v140, v140, v19
  v_sub_f32 v141, v141, v19
  v_sub_f32 v142, v142, v19
  v_sub_f32 v143, v143, v19
  v_mfma_f32_16x16x32_bf16 v[112:115], a[128:131], v[32:35], v[192:195]
  v_exp_f32 v216, v128
  v_exp_f32 v217, v129
  v_mfma_f32_16x16x32_bf16 v[120:123], a[128:131], v[36:39], v[196:199]
  v_exp_f32 v218, v130
  v_add_f32 v226, v216, v217
  v_cvt_pk_bf16_f32 v176, v216, v217
  v_mfma_f32_16x16x32_bf16 v[144:147], a[128:131], v[64:67], v[200:203]
  s_add_u32 s66, s66, 32768
  v_exp_f32 v219, v131
  v_add_f32 v226, v226, v218
  v_add_f32 v226, v226, v219
  v_mfma_f32_16x16x32_bf16 v[152:155], a[128:131], v[68:71], v[204:207]
  s_mov_b32 m0, s25
  ds_read_b128 a[128:131], v3 offset:8192
  v_exp_f32 v220, v132
  v_cvt_pk_bf16_f32 v177, v218, v219
  v_mfma_f32_16x16x32_bf16 v[116:119], a[132:135], v[32:35], v[192:195]
  s_and_b32 s66, s66, 0x1ffff
  buffer_load_dwordx4 v2, s[48:51], s27 offen offset:0 sc1 lds
  v_exp_f32 v221, v133
  v_add_f32 v226, v226, v220
  v_add_f32 v226, v226, v221
  v_mfma_f32_16x16x32_bf16 v[124:127], a[132:135], v[36:39], v[196:199]
  v_exp_f32 v222, v134
  v_cvt_pk_bf16_f32 v178, v220, v221
  v_exp_f32 v223, v135
  v_mfma_f32_16x16x32_bf16 v[148:151], a[132:135], v[64:67], v[200:203]
  v_exp_f32 v216, v136
  v_add_f32 v226, v226, v222
  v_mfma_f32_16x16x32_bf16 v[156:159], a[132:135], v[68:71], v[204:207]
  ds_read_b128 a[132:135], v3 offset:9216
  v_exp_f32 v217, v137
  v_add_f32 v226, v226, v223
  v_mfma_f32_16x16x32_bf16 v[112:115], a[136:139], v[40:43], v[112:115]
  v_exp_f32 v218, v138
  v_cvt_pk_bf16_f32 v179, v222, v223
  v_add_f32 v227, v216, v217
  v_mfma_f32_16x16x32_bf16 v[120:123], a[136:139], v[44:47], v[120:123]
  v_exp_f32 v219, v139
  v_cvt_pk_bf16_f32 v180, v216, v217
  v_add_f32 v227, v227, v218
  v_add_f32 v227, v227, v219
  v_mfma_f32_16x16x32_bf16 v[144:147], a[136:139], v[72:75], v[144:147]
  buffer_load_dwordx4 v2, s[48:51], s27 offen offset:1024 sc1 lds
  v_exp_f32 v220, v140
  v_cvt_pk_bf16_f32 v181, v218, v219
  v_mfma_f32_16x16x32_bf16 v[152:155], a[136:139], v[76:79], v[152:155]
  ds_read_b128 a[136:139], v3 offset:10240
  v_exp_f32 v221, v141
  v_add_f32 v227, v227, v220
  v_mfma_f32_16x16x32_bf16 v[116:119], a[140:143], v[40:43], v[116:119]
  v_exp_f32 v222, v142
  v_add_f32 v227, v227, v221
  v_cvt_pk_bf16_f32 v182, v220, v221
  v_mfma_f32_16x16x32_bf16 v[124:127], a[140:143], v[44:47], v[124:127]
  v_exp_f32 v223, v143
  v_add_f32 v227, v227, v222
  v_add_f32 v227, v227, v223
  v_exp_f32 v208, v96
  v_mfma_f32_16x16x32_bf16 v[148:151], a[140:143], v[72:75], v[148:151]
  v_exp_f32 v209, v97
  v_cvt_pk_bf16_f32 v183, v222, v223
  v_mfma_f32_16x16x32_bf16 v[156:159], a[140:143], v[76:79], v[156:159]
  s_waitcnt lgkmcnt(3)
  ds_read_b128 a[140:143], v3 offset:11264
  v_exp_f32 v210, v98
  v_add_f32 v224, v208, v209
  v_mfma_f32_16x16x32_bf16 v[112:115], a[144:147], v[48:51], v[112:115]
  v_exp_f32 v211, v99
  v_cvt_pk_bf16_f32 v160, v208, v209
  v_add_f32 v224, v224, v210
  v_mfma_f32_16x16x32_bf16 v[120:123], a[144:147], v[52:55], v[120:123]
  v_exp_f32 v212, v100
  v_add_f32 v224, v224, v211
  v_cvt_pk_bf16_f32 v161, v210, v211
  v_mfma_f32_16x16x32_bf16 v[144:147], a[144:147], v[80:83], v[144:147]
  buffer_load_dwordx4 v2, s[48:51], s27 offen offset:2048 sc1 lds
  v_exp_f32 v213, v101
  v_add_f32 v224, v224, v212
  v_add_f32 v224, v224, v213
  v_mfma_f32_16x16x32_bf16 v[152:155], a[144:147], v[84:87], v[152:155]
  ds_read_b128 a[144:147], v3 offset:12288
  v_exp_f32 v214, v102
  v_cvt_pk_bf16_f32 v162, v212, v213
  v_mfma_f32_16x16x32_bf16 v[116:119], a[148:151], v[48:51], v[116:119]
  v_exp_f32 v215, v103
  v_add_f32 v224, v224, v214
  v_add_f32 v224, v224, v215
  v_mfma_f32_16x16x32_bf16 v[124:127], a[148:151], v[52:55], v[124:127]
  v_exp_f32 v208, v104
  v_exp_f32 v209, v105
  v_mfma_f32_16x16x32_bf16 v[148:151], a[148:151], v[80:83], v[148:151]
  v_exp_f32 v210, v106
  v_cvt_pk_bf16_f32 v163, v214, v215
  v_add_f32 v225, v208, v209
  v_mfma_f32_16x16x32_bf16 v[156:159], a[148:151], v[84:87], v[156:159]
  ds_read_b128 a[148:151], v3 offset:13312
  v_exp_f32 v211, v107
  v_cvt_pk_bf16_f32 v164, v208, v209
  v_add_f32 v225, v225, v210
  v_mfma_f32_16x16x32_bf16 v[112:115], a[152:155], v[56:59], v[112:115]
  buffer_load_dwordx4 v2, s[48:51], s27 offen offset:3072 sc1 lds
  v_exp_f32 v212, v108
  v_add_f32 v225, v225, v211
  v_mfma_f32_16x16x32_bf16 v[120:123], a[152:155], v[60:63], v[120:123]
  s_add_u32 s27, s27, 16384
  v_exp_f32 v213, v109
  v_mfma_f32_16x16x32_bf16 v[144:147], a[152:155], v[88:91], v[144:147]
  s_add_u32 s25, s25, 32768
  v_exp_f32 v214, v110
  v_mfma_f32_16x16x32_bf16 v[152:155], a[152:155], v[92:95], v[152:155]
  s_and_b32 s25, s25, 0x1ffff
  ds_read_b128 a[152:155], v3 offset:14336
  v_cvt_pk_bf16_f32 v165, v210, v211
  v_max3_f32 v5, v226, v227, v224
  v_add_f32 v225, v225, v212
  v_add_f32 v225, v225, v213
  v_cvt_pk_bf16_f32 v166, v212, v213
  v_exp_f32 v215, v111
  v_mfma_f32_16x16x32_bf16 v[116:119], a[156:159], v[56:59], v[116:119]
  v_add_f32 v225, v225, v214
  v_add_f32 v225, v225, v215
  v_max_f32 v5, v5, v225
  v_cmp_lt_f32 vcc, s81, v5
  v_mfma_f32_16x16x32_bf16 v[124:127], a[156:159], v[60:63], v[124:127]
  v_mfma_f32_16x16x32_bf16 v[148:151], a[156:159], v[88:91], v[148:151]
  v_cvt_pk_bf16_f32 v167, v214, v215
  v_mfma_f32_16x16x32_bf16 v[156:159], a[156:159], v[92:95], v[156:159]
  s_waitcnt lgkmcnt(3)
  s_cbranch_vccnz fa_stub0
fa_back0:
  ds_read_b128 a[156:159], v3 offset:15360
  v_add_f32 v228, v228, v224
  v_add_f32 v229, v229, v225
  v_add_f32 v230, v230, v226
  v_add_f32 v231, v231, v227
  s_nop 3
  v_exp_f32 v216, v144
  v_exp_f32 v217, v145
  v_add_u32 v3, s66, v2
  buffer_load_dword v14, v13, s[40:43], 0 offen sc1
  s_cmp_eq_u32 s28, 0
  s_cbranch_scc1 fa_AV
  s_sub_u32 s28, s28, 1
  s_cmp_eq_u32 s28, 0
  s_cbranch_scc1 fa_Aexit
.p2align 6
fa_DD:
  v_mfma_f32_16x16x32_bf16 v[96:99], a[128:131], v[32:35], v[192:195]
  s_waitcnt vmcnt(12)
  v_exp_f32 v218, v146
  v_mfma_f32_16x16x32_bf16 v[104:107], a[128:131], v[36:39], v[196:199]
  s_barrier
  v_exp_f32 v219, v147
  v_mfma_f32_16x16x32_bf16 v[128:131], a[128:131], v[64:67], v[200:203]
  s_cmp_ge_u32 s26, s32
  ds_read_b128 a[160:163], v3 offset:16384
  v_add_f32 v226, v216, v217
  v_mfma_f32_16x16x32_bf16 v[136:139], a[128:131], v[68:71], v[204:207]
  s_cbranch_scc1 fa_hk4
fa_hb4:
  v_exp_f32 v220, v148
  v_mfma_f32_16x16x32_bf16 v[100:103], a[132:135], v[32:35], v[192:195]
  ds_read_b128 a[164:167], v3 offset:17408
  v_cvt_pk_bf16_f32 v184, v216, v217
  v_mfma_f32_16x16x32_bf16 v[108:111], a[132:135], v[36:39], v[196:199]
  s_mov_b32 m0, s24
  v_exp_f32 v221, v149
  v_mfma_f32_16x16x32_bf16 v[132:135], a[132:135], v[64:67], v[200:203]
  buffer_load_dwordx4 v2, s[44:47], s26 offen offset:0 sc1 lds
  v_add_f32 v226, v226, v218
  v_mfma_f32_16x16x32_bf16 v[140:143], a[132:135], v[68:71], v[204:207]
  v_exp_f32 v222, v150
  v_mfma_f32_16x16x32_bf16 v[96:99], a[136:139], v[40:43], v[96:99]
  ds_read_b128 a[168:171], v3 offset:18432
  v_add_f32 v226, v226, v219
  v_mfma_f32_16x16x32_bf16 v[104:107], a[136:139], v[44:47], v[104:107]
  v_exp_f32 v223, v151
  v_mfma_f32_16x16x32_bf16 v[128:131], a[136:139], v[72:75], v[128:131]
  v_cvt_pk_bf16_f32 v185, v218, v219
  v_add_f32 v226, v226, v220
  v_mfma_f32_16x16x32_bf16 v[136:139], a[136:139], v[76:79], v[136:139]
  v_exp_f32 v216, v152
  v_mfma_f32_16x16x32_bf16 v[100:103], a[140:143], v[40:43], v[100:103]
  ds_read_b128 a[172:175], v3 offset:19456
  v_add_f32 v226, v226, v221
  v_mfma_f32_16x16x32_bf16 v[108:111], a[140:143], v[44:47], v[108:111]
  v_exp_f32 v217, v153
  v_mfma_f32_16x16x32_bf16 v[132:135], a[140:143], v[72:75], v[132:135]
  v_cvt_pk_bf16_f32 v186, v220, v221
  v_add_f32 v226, v226, v222
  v_mfma_f32_16x16x32_bf16 v[140:143], a[140:143], v[76:79], v[140:143]
  s_waitcnt lgkmcnt(4)
  v_exp_f32 v218, v154
  v_mfma_f32_16x16x32_bf16 v[96:99], a[144:147], v[48:51], v[96:99]
  ds_read_b128 a[176:179], v3 offset:20480
  v_add_f32 v226, v226, v223
  v_mfma_f32_16x16x32_bf16 v[104:107], a[144:147], v[52:55], v[104:107]
  v_exp_f32 v219, v155
  v_mfma_f32_16x16x32_bf16 v[128:131], a[144:147], v[80:83], v[128:131]
  v_cvt_pk_bf16_f32 v187, v222, v223
  v_add_f32 v227, v216, v217
  v_mfma_f32_16x16x32_bf16 v[136:139], a[144:147], v[84:87], v[136:139]
  v_exp_f32 v220, v156
  v_mfma_f32_16x16x32_bf16 v[100:103], a[148:151], v[48:51], v[100:103]
  ds_read_b128 a[180:183], v3 offset:21504
  v_cvt_pk_bf16_f32 v188, v216, v217
  v_mfma_f32_16x16x32_bf16 v[108:111], a[148:151], v[52:55], v[108:111]
  v_exp_f32 v221, v157
  v_mfma_f32_16x16x32_bf16 v[132:135], a[148:151], v[80:83], v[132:135]
  buffer_load_dwordx4 v2, s[44:47], s26 offen offset:1024 sc1 lds
  v_add_f32 v227, v227, v218
  v_mfma_f32_16x16x32_bf16 v[140:143], a[148:151], v[84:87], v[140:143]
  v_exp_f32 v222, v158
  v_mfma_f32_16x16x32_bf16 v[96:99], a[152:155], v[56:59], v[96:99]
  ds_read_b128 a[184:187], v3 offset:22528
  v_add_f32 v227, v227, v219
  v_mfma_f32_16x16x32_bf16 v[104:107], a[152:155], v[60:63], v[104:107]
  v_exp_f32 v223, v159
  v_mfma_f32_16x16x32_bf16 v[128:131], a[152:155], v[88:91], v[128:131]
  v_cvt_pk_bf16_f32 v189, v218, v219
  v_add_f32 v227, v227, v220
  v_mfma_f32_16x16x32_bf16 v[136:139], a[152:155], v[92:95], v[136:139]
  v_exp_f32 v208, v112
  v_mfma_f32_16x16x32_bf16 v[100:103], a[156:159], v[56:59], v[100:103]
  ds_read_b128 a[188:191], v3 offset:23552
  v_add_f32 v227, v227, v221
  v_mfma_f32_16x16x32_bf16 v[108:111], a[156:159], v[60:63], v[108:111]
  v_exp_f32 v209, v113
  v_mfma_f32_16x16x32_bf16 v[132:135], a[156:159], v[88:91], v[132:135]
  v_cvt_pk_bf16_f32 v190, v220, v221
  v_add_f32 v227, v227, v222
  v_add_f32 v227, v227, v223
  v_mfma_f32_16x16x32_bf16 v[140:143], a[156:159], v[92:95], v[140:143]
  s_waitcnt lgkmcnt(4)
  v_exp_f32 v210, v114
  v_mfma_f32_16x16x32_bf16 a[0:3], a[160:163], v[160:163], a[0:3]
  ds_read_b128 a[128:131], v3 offset:0
  v_cvt_pk_bf16_f32 v191, v222, v223
  v_mfma_f32_16x16x32_bf16 a[4:7], a[160:163], v[164:167], a[4:7]
  v_exp_f32 v211, v115
  v_mfma_f32_16x16x32_bf16 a[64:67], a[160:163], v[176:179], a[64:67]
  v_exp_f32 v212, v116
  v_mfma_f32_16x16x32_bf16 a[68:71], a[160:163], v[180:183], a[68:71]
  v_add_f32 v224, v208, v209
  v_cvt_pk_bf16_f32 v168, v208, v209
  v_mfma_f32_16x16x32_bf16 a[8:11], a[164:167], v[160:163], a[8:11]
  ds_read_b128 a[132:135], v3 offset:1024
  v_add_f32 v224, v224, v210
  v_mfma_f32_16x16x32_bf16 a[12:15], a[164:167], v[164:167], a[12:15]
  v_exp_f32 v213, v117
  v_mfma_f32_16x16x32_bf16 a[72:75], a[164:167], v[176:179], a[72:75]
  buffer_load_dwordx4 v2, s[44:47], s26 offen offset:2048 sc1 lds
  v_add_f32 v224, v224, v211
  v_mfma_f32_16x16x32_bf16 a[76:79], a[164:167], v[180:183], a[76:79]
  v_exp_f32 v214, v118
  v_mfma_f32_16x16x32_bf16 a[16:19], a[168:171], v[160:163], a[16:19]
  ds_read_b128 a[136:139], v3 offset:2048
  v_cvt_pk_bf16_f32 v169, v210, v211
  v_mfma_f32_16x16x32_bf16 a[20:23], a[168:171], v[164:167], a[20:23]
  v_exp_f32 v215, v119
  v_mfma_f32_16x16x32_bf16 a[80:83], a[168:171], v[176:179], a[80:83]
  v_add_f32 v224, v224, v212
  v_add_f32 v224, v224, v213
  v_mfma_f32_16x16x32_bf16 a[84:87], a[168:171], v[180:183], a[84:87]
  v_exp_f32 v208, v120
  v_mfma_f32_16x16x32_bf16 a[24:27], a[172:175], v[160:163], a[24:27]
  ds_read_b128 a[140:143], v3 offset:3072
  v_cvt_pk_bf16_f32 v170, v212, v213
  v_mfma_f32_16x16x32_bf16 a[28:31], a[172:175], v[164:167], a[28:31]
  v_exp_f32 v209, v121
  v_mfma_f32_16x16x32_bf16 a[88:91], a[172:175], v[176:179], a[88:91]
  v_exp_f32 v210, v122
  v_mfma_f32_16x16x32_bf16 a[92:95], a[172:175], v[180:183], a[92:95]
  s_waitcnt lgkmcnt(4)
  v_add_f32 v224, v224, v214
  v_add_f32 v224, v224, v215
  v_mfma_f32_16x16x32_bf16 a[32:35], a[176:179], v[160:163], a[32:35]
  ds_read_b128 a[144:147], v3 offset:4096
  v_cvt_pk_bf16_f32 v171, v214, v215
  v_mfma_f32_16x16x32_bf16 a[36:39], a[176:179], v[164:167], a[36:39]
  v_exp_f32 v211, v123
  v_mfma_f32_16x16x32_bf16 a[96:99], a[176:179], v[176:179], a[96:99]
  v_add_f32 v225, v208, v209
  v_cvt_pk_bf16_f32 v172, v208, v209
  v_mfma_f32_16x16x32_bf16 a[100:103], a[176:179], v[180:183], a[100:103]
  v_exp_f32 v212, v124
  v_mfma_f32_16x16x32_bf16 a[40:43], a[180:183], v[160:163], a[40:43]
  ds_read_b128 a[148:151], v3 offset:5120
  v_add_f32 v225, v225, v210
  v_mfma_f32_16x16x32_bf16 a[44:47], a[180:183], v[164:167], a[44:47]
  v_exp_f32 v213, v125
  v_mfma_f32_16x16x32_bf16 a[104:107], a[180:183], v[176:179], a[104:107]
  buffer_load_dwordx4 v2, s[44:47], s26 offen offset:3072 sc1 lds
  v_add_f32 v225, v225, v211
  v_mfma_f32_16x16x32_bf16 a[108:111], a[180:183], v[180:183], a[108:111]
  s_add_u32 s26, s26, 16384
  v_exp_f32 v214, v126
  v_mfma_f32_16x16x32_bf16 a[48:51], a[184:187], v[160:163], a[48:51]
  s_add_u32 s24, s24, 32768
  ds_read_b128 a[152:155], v3 offset:6144
  v_cvt_pk_bf16_f32 v173, v210, v211
  v_mfma_f32_16x16x32_bf16 a[52:55], a[184:187], v[164:167], a[52:55]
  s_and_b32 s24, s24, 0x1ffff
  v_exp_f32 v215, v127
  v_mfma_f32_16x16x32_bf16 a[112:115], a[184:187], v[176:179], a[112:115]
  v_max3_f32 v5, v226, v227, v224
  v_add_f32 v225, v225, v212
  v_mfma_f32_16x16x32_bf16 a[116:119], a[184:187], v[180:183], a[116:119]
  v_add_f32 v225, v225, v213
  v_cvt_pk_bf16_f32 v174, v212, v213
  v_add_f32 v225, v225, v214
  v_mfma_f32_16x16x32_bf16 a[56:59], a[188:191], v[160:163], a[56:59]
  ds_read_b128 a[156:159], v3 offset:7168
  v_add_f32 v225, v225, v215
  v_max_f32 v5, v5, v225
  v_cmp_lt_f32 vcc, s81, v5
  v_mfma_f32_16x16x32_bf16 a[60:63], a[188:191], v[164:167], a[60:63]
  v_exp_f32 v216, v128
  v_mfma_f32_16x16x32_bf16 a[120:123], a[188:191], v[176:179], a[120:123]
  s_waitcnt lgkmcnt(4)
  v_cvt_pk_bf16_f32 v175, v214, v215
  v_mfma_f32_16x16x32_bf16 a[124:127], a[188:191], v[180:183], a[124:127]
  s_cbranch_vccnz fa_stub1
fa_back1:
  v_exp_f32 v217, v129
  v_add_f32 v228, v228, v224
  v_add_f32 v229, v229, v225
  v_add_f32 v230, v230, v226
  v_add_f32 v231, v231, v227
fa_DDe:
  v_mfma_f32_16x16x32_bf16 v[112:115], a[128:131], v[32:35], v[192:195]
  ds_read_b128 a[160:163], v3 offset:24576
  v_add_f32 v226, v216, v217
  v_mfma_f32_16x16x32_bf16 v[120:123], a[128:131], v[36:39], v[196:199]
  v_exp_f32 v218, v130
  v_mfma_f32_16x16x32_bf16 v[144:147], a[128:131], v[64:67], v[200:203]
  s_cmp_ge_u32 s26, s9
  v_exp_f32 v219, v131
  v_mfma_f32_16x16x32_bf16 v[152:155], a[128:131], v[68:71], v[204:207]
  s_cbranch_scc1 fa_hk5
fa_hb5:
  v_exp_f32 v220, v132
  v_mfma_f32_16x16x32_bf16 v[116:119], a[132:135], v[32:35], v[192:195]
  s_add_u32 s66, s66, 32768
  ds_read_b128 a[164:167], v3 offset:25600
  v_cvt_pk_bf16_f32 v176, v216, v217
  v_mfma_f32_16x16x32_bf16 v[124:127], a[132:135], v[36:39], v[196:199]
  s_mov_b32 m0, s25
  v_exp_f32 v221, v133
  v_mfma_f32_16x16x32_bf16 v[148:151], a[132:135], v[64:67], v[200:203]
  s_and_b32 s66, s66, 0x1ffff
  buffer_load_dwordx4 v2, s[48:51], s27 offen offset:0 sc1 lds
  v_add_f32 v226, v226, v218
  v_mfma_f32_16x16x32_bf16 v[156:159], a[132:135], v[68:71], v[204:207]
  v_exp_f32 v222, v134
  v_mfma_f32_16x16x32_bf16 v[112:115], a[136:139], v[40:43], v[112:115]
  ds_read_b128 a[168:171], v3 offset:26624
  v_add_f32 v226, v226, v219
  v_mfma_f32_16x16x32_bf16 v[120:123], a[136:139], v[44:47], v[120:123]
  v_exp_f32 v223, v135
  v_mfma_f32_16x16x32_bf16 v[144:147], a[136:139], v[72:75], v[144:147]
  v_cvt_pk_bf16_f32 v177, v218, v219
  v_add_f32 v226, v226, v220
  v_mfma_f32_16x16x32_bf16 v[152:155], a[136:139], v[76:79], v[152:155]
  v_exp_f32 v216, v136
  v_mfma_f32_16x16x32_bf16 v[116:119], a[140:143], v[40:43], v[116:119]
  ds_read_b128 a[172:175], v3 offset:27648
  v_add_f32 v226, v226, v221
  v_mfma_f32_16x16x32_bf16 v[124:127], a[140:143], v[44:47], v[124:127]
  v_exp_f32 v217, v137
  v_mfma_f32_16x16x32_bf16 v[148:151], a[140:143], v[72:75], v[148:151]
  v_cvt_pk_bf16_f32 v178, v220, v221
  v_add_f32 v226, v226, v222
  v_mfma_f32_16x16x32_bf16 v[156:159], a[140:143], v[76:79], v[156:159]
  s_waitcnt lgkmcnt(4)
  v_exp_f32 v218, v138
  v_mfma_f32_16x16x32_bf16 v[112:115], a[144:147], v[48:51], v[112:115]
  ds_read_b128 a[176:179], v3 offset:28672
  v_add_f32 v226, v226, v223
  v_mfma_f32_16x16x32_bf16 v[120:123], a[144:147], v[52:55], v[120:123]
  v_exp_f32 v219, v139
  v_mfma_f32_16x16x32_bf16 v[144:147], a[144:147], v[80:83], v[144:147]
  v_cvt_pk_bf16_f32 v179, v222, v223
  v_add_f32 v227, v216, v217
  v_mfma_f32_16x16x32_bf16 v[152:155], a[144:147], v[84:87], v[152:155]
  v_exp_f32 v220, v140
  v_mfma_f32_16x16x32_bf16 v[116:119], a[148:151], v[48:51], v[116:119]
  ds_read_b128 a[180:183], v3 offset:29696
  v_cvt_pk_bf16_f32 v180, v216, v217
  v_mfma_f32_16x16x32_bf16 v[124:127], a[148:151], v[52:55], v[124:127]
  v_exp_f32 v221, v141
  v_mfma_f32_16x16x32_bf16 v[148:151], a[148:151], v[80:83], v[148:151]
  buffer_load_dwordx4 v2, s[48:51], s27 offen offset:1024 sc1 lds
  v_add_f32 v227, v227, v218
  v_mfma_f32_16x16x32_bf16 v[156:159], a[148:151], v[84:87], v[156:159]
  v_exp_f32 v222, v142
  v_mfma_f32_16x16x32_bf16 v[112:115], a[152:155], v[56:59], v[112:115]
  ds_read_b128 a[184:187], v3 offset:30720
  v_add_f32 v227, v227, v219
  v_mfma_f32_16x16x32_bf16 v[120:123], a[152:155], v[60:63], v[120:123]
  v_exp_f32 v223, v143
  v_mfma_f32_16x16x32_bf16 v[144:147], a[152:155], v[88:91], v[144:147]
  v_cvt_pk_bf16_f32 v181, v218, v219
  v_add_f32 v227, v227, v220
  v_mfma_f32_16x16x32_bf16 v[152:155], a[152:155], v[92:95], v[152:155]
  v_exp_f32 v208, v96
  v_mfma_f32_16x16x32_bf16 v[116:119], a[156:159], v[56:59], v[116:119]
  ds_read_b128 a[188:191], v3 offset:31744
  v_add_f32 v227, v227, v221
  v_mfma_f32_16x16x32_bf16 v[124:127], a[156:159], v[60:63], v[124:127]
  v_exp_f32 v209, v97
  v_mfma_f32_16x16x32_bf16 v[148:151], a[156:159], v[88:91], v[148:151]
  v_cvt_pk_bf16_f32 v182, v220, v221
  v_add_f32 v227, v227, v222
  v_add_f32 v227, v227, v223
  v_mfma_f32_16x16x32_bf16 v[156:159], a[156:159], v[92:95], v[156:159]
  s_waitcnt lgkmcnt(4)
  v_exp_f32 v210, v98
  v_mfma_f32_16x16x32_bf16 a[0:3], a[160:163], v[168:171], a[0:3]
  ds_read_b128 a[128:131], v3 offset:8192
  v_cvt_pk_bf16_f32 v183, v222, v223
  v_mfma_f32_16x16x32_bf16 a[4:7], a[160:163], v[172:175], a[4:7]
  v_exp_f32 v211, v99
  v_mfma_f32_16x16x32_bf16 a[64:67], a[160:163], v[184:187], a[64:67]
  v_exp_f32 v212, v100
  v_mfma_f32_16x16x32_bf16 a[68:71], a[160:163], v[188:191], a[68:71]
  v_add_f32 v224, v208, v209
  v_cvt_pk_bf16_f32 v160, v208, v209
  v_mfma_f32_16x16x32_bf16 a[8:11], a[164:167], v[168:171], a[8:11]
  ds_read_b128 a[132:135], v3 offset:9216
  v_add_f32 v224, v224, v210
  v_mfma_f32_16x16x32_bf16 a[12:15], a[164:167], v[172:175], a[12:15]
  v_exp_f32 v213, v101
  v_mfma_f32_16x16x32_bf16 a[72:75], a[164:167], v[184:187], a[72:75]
  buffer_load_dwordx4 v2, s[48:51], s27 offen offset:2048 sc1 lds
  v_add_f32 v224, v224, v211
  v_mfma_f32_16x16x32_bf16 a[76:79], a[164:167], v[188:191], a[76:79]
  v_exp_f32 v214, v102
  v_mfma_f32_16x16x32_bf16 a[16:19], a[168:171], v[168:171], a[16:19]
  ds_read_b128 a[136:139], v3 offset:10240
  v_cvt_pk_bf16_f32 v161, v210, v211
  v_mfma_f32_16x16x32_bf16 a[20:23], a[168:171], v[172:175], a[20:23]
  v_exp_f32 v215, v103
  v_mfma_f32_16x16x32_bf16 a[80:83], a[168:171], v[184:187], a[80:83]
  v_add_f32 v224, v224, v212
  v_add_f32 v224, v224, v213
  v_mfma_f32_16x16x32_bf16 a[84:87], a[168:171], v[188:191], a[84:87]
  v_exp_f32 v208, v104
  v_mfma_f32_16x16x32_bf16 a[24:27], a[172:175], v[168:171], a[24:27]
  ds_read_b128 a[140:143], v3 offset:11264
  v_cvt_pk_bf16_f32 v162, v212, v213
  v_mfma_f32_16x16x32_bf16 a[28:31], a[172:175], v[172:175], a[28:31]
  v_exp_f32 v209, v105
  v_mfma_f32_16x16x32_bf16 a[88:91], a[172:175], v[184:187], a[88:91]
  v_exp_f32 v210, v106
  v_mfma_f32_16x16x32_bf16 a[92:95], a[172:175], v[188:191], a[92:95]
  s_waitcnt lgkmcnt(4)
  v_add_f32 v224, v224, v214
  v_add_f32 v224, v224, v215
  v_mfma_f32_16x16x32_bf16 a[32:35], a[176:179], v[168:171], a[32:35]
  ds_read_b128 a[144:147], v3 offset:12288
  v_cvt_pk_bf16_f32 v163, v214, v215
  v_mfma_f32_16x16x32_bf16 a[36:39], a[176:179], v[172:175], a[36:39]
  v_exp_f32 v211, v107
  v_mfma_f32_16x16x32_bf16 a[96:99], a[176:179], v[184:187], a[96:99]
  v_add_f32 v225, v208, v209
  v_cvt_pk_bf16_f32 v164, v208, v209
  v_mfma_f32_16x16x32_bf16 a[100:103], a[176:179], v[188:191], a[100:103]
  v_exp_f32 v212, v108
  v_mfma_f32_16x16x32_bf16 a[40:43], a[180:183], v[168:171], a[40:43]
  ds_read_b128 a[148:151], v3 offset:13312
  v_add_f32 v225, v225, v210
  v_mfma_f32_16x16x32_bf16 a[44:47], a[180:183], v[172:175], a[44:47]
  v_exp_f32 v213, v109
  v_mfma_f32_16x16x32_bf16 a[104:107], a[180:183], v[184:187], a[104:107]
  buffer_load_dwordx4 v2, s[48:51], s27 offen offset:3072 sc1 lds
  v_add_f32 v225, v225, v211
  v_mfma_f32_16x16x32_bf16 a[108:111], a[180:183], v[188:191], a[108:111]
  s_add_u32 s27, s27, 16384
  v_exp_f32 v214, v110
  v_mfma_f32_16x16x32_bf16 a[48:51], a[184:187], v[168:171], a[48:51]
  s_add_u32 s25, s25, 32768
  ds_read_b128 a[152:155], v3 offset:14336
  v_cvt_pk_bf16_f32 v165, v210, v211
  v_mfma_f32_16x16x32_bf16 a[52:55], a[184:187], v[172:175], a[52:55]
  s_and_b32 s25, s25, 0x1ffff
  v_exp_f32 v215, v111
  v_mfma_f32_16x16x32_bf16 a[112:115], a[184:187], v[184:187], a[112:115]
  v_max3_f32 v5, v226, v227, v224
  v_add_f32 v225, v225, v212
  v_mfma_f32_16x16x32_bf16 a[116:119], a[184:187], v[188:191], a[116:119]
  v_add_f32 v225, v225, v213
  v_cvt_pk_bf16_f32 v166, v212, v213
  v_add_f32 v225, v225, v214
  v_mfma_f32_16x16x32_bf16 a[56:59], a[188:191], v[168:171], a[56:59]
  s_sub_u32 s28, s28, 1
  ds_read_b128 a[156:159], v3 offset:15360
  v_add_f32 v225, v225, v215
  v_max_f32 v5, v5, v225
  v_cmp_lt_f32 vcc, s81, v5
  v_mfma_f32_16x16x32_bf16 a[60:63], a[188:191], v[172:175], a[60:63]
  s_cmp_gt_u32 s28, s8
  v_exp_f32 v216, v144
  v_mfma_f32_16x16x32_bf16 a[120:123], a[188:191], v[184:187], a[120:123]
  s_waitcnt lgkmcnt(4)
  v_cvt_pk_bf16_f32 v167, v214, v215
  v_add_u32 v3, s66, v2
  v_mfma_f32_16x16x32_bf16 a[124:127], a[188:191], v[188:191], a[124:127]
  s_cbranch_vccnz fa_stub2
fa_back2:
  v_exp_f32 v217, v145
  v_add_f32 v228, v228, v224
  v_add_f32 v229, v229, v225
  v_add_f32 v230, v230, v226
  v_add_f32 v231, v231, v227
  s_cbranch_scc1 fa_DD
  s_cmp_lg_u32 s8, 0
  s_cbranch_scc1 fa_DDF
fa_Aexit:
  s_bitcmp1_b32 s20, 0
  s_cbranch_scc1 fa_Aodd
  v_mfma_f32_16x16x32_bf16 v[96:99], a[128:131], v[32:35], v[192:195]
  s_waitcnt vmcnt(12)
  v_exp_f32 v218, v146
  v_mfma_f32_16x16x32_bf16 v[104:107], a[128:131], v[36:39], v[196:199]
  s_barrier
  v_exp_f32 v219, v147
  v_mfma_f32_16x16x32_bf16 v[128:131], a[128:131], v[64:67], v[200:203]
  ds_read_b128 a[160:163], v3 offset:16384
  v_add_f32 v226, v216, v217
  v_mfma_f32_16x16x32_bf16 v[136:139], a[128:131], v[68:71], v[204:207]
  v_exp_f32 v220, v148
  v_mfma_f32_16x16x32_bf16 v[100:103], a[132:135], v[32:35], v[192:195]
  ds_read_b128 a[164:167], v3 offset:17408
  v_cvt_pk_bf16_f32 v184, v216, v217
  v_mfma_f32_16x16x32_bf16 v[108:111], a[132:135], v[36:39], v[196:199]
  s_mov_b32 m0, s24
  v_exp_f32 v221, v149
  v_mfma_f32_16x16x32_bf16 v[132:135], a[132:135], v[64:67], v[200:203]
  buffer_load_dwordx4 v2, s[44:47], s26 offen offset:0 sc1 lds
  v_add_f32 v226, v226, v218
  v_mfma_f32_16x16x32_bf16 v[140:143], a[132:135], v[68:71], v[204:207]
  v_exp_f32 v222, v150
  v_mfma_f32_16x16x32_bf16 v[96:99], a[136:139], v[40:43], v[96:99]
  ds_read_b128 a[168:171], v3 offset:18432
  v_add_f32 v226, v226, v219
  v_mfma_f32_16x16x32_bf16 v[104:107], a[136:139], v[44:47], v[104:107]
  v_exp_f32 v223, v151
  v_mfma_f32_16x16x32_bf16 v[128:131], a[136:139], v[72:75], v[128:131]
  v_cvt_pk_bf16_f32 v185, v218, v219
  v_add_f32 v226, v226, v220
  v_mfma_f32_16x16x32_bf16 v[136:139], a[136:139], v[76:79], v[136:139]
  v_exp_f32 v216, v152
  v_mfma_f32_16x16x32_bf16 v[100:103], a[140:143], v[40:43], v[100:103]
  ds_read_b128 a[172:175], v3 offset:19456
  v_add_f32 v226, v226, v221
  v_mfma_f32_16x16x32_bf16 v[108:111], a[140:143], v[44:47], v[108:111]
  v_exp_f32 v217, v153
  v_mfma_f32_16x16x32_bf16 v[132:135], a[140:143], v[72:75], v[132:135]
  v_cvt_pk_bf16_f32 v186, v220, v221
  v_add_f32 v226, v226, v222
  v_mfma_f32_16x16x32_bf16 v[140:143], a[140:143], v[76:79], v[140:143]
  s_waitcnt lgkmcnt(4)
  v_exp_f32 v218, v154
  v_mfma_f32_16x16x32_bf16 v[96:99], a[144:147], v[48:51], v[96:99]
  ds_read_b128 a[176:179], v3 offset:20480
  v_add_f32 v226, v226, v223
  v_mfma_f32_16x16x32_bf16 v[104:107], a[144:147], v[52:55], v[104:107]
  v_exp_f32 v219, v155
  v_mfma_f32_16x16x32_bf16 v[128:131], a[144:147], v[80:83], v[128:131]
  v_cvt_pk_bf16_f32 v187, v222, v223
  v_add_f32 v227, v216, v217
  v_mfma_f32_16x16x32_bf16 v[136:139], a[144:147], v[84:87], v[136:139]
  v_exp_f32 v220, v156
  v_mfma_f32_16x16x32_bf16 v[100:103], a[148:151], v[48:51], v[100:103]
  ds_read_b128 a[180:183], v3 offset:21504
  v_cvt_pk_bf16_f32 v188, v216, v217
  v_mfma_f32_16x16x32_bf16 v[108:111], a[148:151], v[52:55], v[108:111]
  v_exp_f32 v221, v157
  v_mfma_f32_16x16x32_bf16 v[132:135], a[148:151], v[80:83], v[132:135]
  buffer_load_dwordx4 v2, s[44:47], s26 offen offset:1024 sc1 lds
  v_add_f32 v227, v227, v218
  v_mfma_f32_16x16x32_bf16 v[140:143], a[148:151], v[84:87], v[140:143]
  v_exp_f32 v222, v158
  v_mfma_f32_16x16x32_bf16 v[96:99], a[152:155], v[56:59], v[96:99]
  ds_read_b128 a[184:187], v3 offset:22528
  v_add_f32 v227, v227, v219
  v_mfma_f32_16x16x32_bf16 v[104:107], a[152:155], v[60:63], v[104:107]
  v_exp_f32 v223, v159
  v_mfma_f32_16x16x32_bf16 v[128:131], a[152:155], v[88:91], v[128:131]
  v_cvt_pk_bf16_f32 v189, v218, v219
  v_add_f32 v227, v227, v220
  v_mfma_f32_16x16x32_bf16 v[136:139], a[152:155], v[92:95], v[136:139]
  v_exp_f32 v208, v112
  v_mfma_f32_16x16x32_bf16 v[100:103], a[156:159], v[56:59], v[100:103]
  ds_read_b128 a[188:191], v3 offset:23552
  v_add_f32 v227, v227, v221
  v_mfma_f32_16x16x32_bf16 v[108:111], a[156:159], v[60:63], v[108:111]
  v_exp_f32 v209, v113
  v_mfma_f32_16x16x32_bf16 v[132:135], a[156:159], v[88:91], v[132:135]
  v_cvt_pk_bf16_f32 v190, v220, v221
  v_add_f32 v227, v227, v222
  v_add_f32 v227, v227, v223
  v_mfma_f32_16x16x32_bf16 v[140:143], a[156:159], v[92:95], v[140:143]
  s_waitcnt lgkmcnt(4)
  v_exp_f32 v210, v114
  v_mfma_f32_16x16x32_bf16 a[0:3], a[160:163], v[160:163], a[0:3]
  ds_read_b128 a[128:131], v3 offset:0
  v_cvt_pk_bf16_f32 v191, v222, v223
  v_mfma_f32_16x16x32_bf16 a[4:7], a[160:163], v[164:167], a[4:7]
  v_exp_f32 v211, v115
  v_mfma_f32_16x16x32_bf16 a[64:67], a[160:163], v[176:179], a[64:67]
  v_exp_f32 v212, v116
  v_mfma_f32_16x16x32_bf16 a[68:71], a[160:163], v[180:183], a[68:71]
  v_add_f32 v224, v208, v209
  v_cvt_pk_bf16_f32 v168, v208, v209
  v_mfma_f32_16x16x32_bf16 a[8:11], a[164:167], v[160:163], a[8:11]
  ds_read_b128 a[132:135], v3 offset:1024
  v_add_f32 v224, v224, v210
  v_mfma_f32_16x16x32_bf16 a[12:15], a[164:167], v[164:167], a[12:15]
  v_exp_f32 v213, v117
  v_mfma_f32_16x16x32_bf16 a[72:75], a[164:167], v[176:179], a[72:75]
  buffer_load_dwordx4 v2, s[44:47], s26 offen offset:2048 sc1 lds
  v_add_f32 v224, v224, v211
  v_mfma_f32_16x16x32_bf16 a[76:79], a[164:167], v[180:183], a[76:79]
  v_exp_f32 v214, v118
  v_mfma_f32_16x16x32_bf16 a[16:19], a[168:171], v[160:163], a[16:19]
  ds_read_b128 a[136:139], v3 offset:2048
  v_cvt_pk_bf16_f32 v169, v210, v211
  v_mfma_f32_16x16x32_bf16 a[20:23], a[168:171], v[164:167], a[20:23]
  v_exp_f32 v215, v119
  v_mfma_f32_16x16x32_bf16 a[80:83], a[168:171], v[176:179], a[80:83]
  v_add_f32 v224, v224, v212
  v_add_f32 v224, v224, v213
  v_mfma_f32_16x16x32_bf16 a[84:87], a[168:171], v[180:183], a[84:87]
  v_exp_f32 v208, v120
  v_mfma_f32_16x16x32_bf16 a[24:27], a[172:175], v[160:163], a[24:27]
  ds_read_b128 a[140:143], v3 offset:3072
  v_cvt_pk_bf16_f32 v170, v212, v213
  v_mfma_f32_16x16x32_bf16 a[28:31], a[172:175], v[164:167], a[28:31]
  v_exp_f32 v209, v121
  v_mfma_f32_16x16x32_bf16 a[88:91], a[172:175], v[176:179], a[88:91]
  v_exp_f32 v210, v122
  v_mfma_f32_16x16x32_bf16 a[92:95], a[172:175], v[180:183], a[92:95]
  s_waitcnt lgkmcnt(4)
  v_add_f32 v224, v224, v214
  v_add_f32 v224, v224, v215
  v_mfma_f32_16x16x32_bf16 a[32:35], a[176:179], v[160:163], a[32:35]
  ds_read_b128 a[144:147], v3 offset:4096
  v_cvt_pk_bf16_f32 v171, v214, v215
  v_mfma_f32_16x16x32_bf16 a[36:39], a[176:179], v[164:167], a[36:39]
  v_exp_f32 v211, v123
  v_mfma_f32_16x16x32_bf16 a[96:99], a[176:179], v[176:179], a[96:99]
  v_add_f32 v225, v208, v209
  v_cvt_pk_bf16_f32 v172, v208, v209
  v_mfma_f32_16x16x32_bf16 a[100:103], a[176:179], v[180:183], a[100:103]
  v_exp_f32 v212, v124
  v_mfma_f32_16x16x32_bf16 a[40:43], a[180:183], v[160:163], a[40:43]
  ds_read_b128 a[148:151], v3 offset:5120
  v_add_f32 v225, v225, v210
  v_mfma_f32_16x16x32_bf16 a[44:47], a[180:183], v[164:167], a[44:47]
  v_exp_f32 v213, v125
  v_mfma_f32_16x16x32_bf16 a[104:107], a[180:183], v[176:179], a[104:107]
  buffer_load_dwordx4 v2, s[44:47], s26 offen offset:3072 sc1 lds
  v_add_f32 v225, v225, v211
  v_mfma_f32_16x16x32_bf16 a[108:111], a[180:183], v[180:183], a[108:111]
  s_add_u32 s26, s26, 16384
  v_exp_f32 v214, v126
  v_mfma_f32_16x16x32_bf16 a[48:51], a[184:187], v[160:163], a[48:51]
  s_add_u32 s24, s24, 32768
  ds_read_b128 a[152:155], v3 offset:6144
  v_cvt_pk_bf16_f32 v173, v210, v211
  v_mfma_f32_16x16x32_bf16 a[52:55], a[184:187], v[164:167], a[52:55]
  s_and_b32 s24, s24, 0x1ffff
  v_exp_f32 v215, v127
  v_mfma_f32_16x16x32_bf16 a[112:115], a[184:187], v[176:179], a[112:115]
  v_max3_f32 v5, v226, v227, v224
  v_add_f32 v225, v225, v212
  v_mfma_f32_16x16x32_bf16 a[116:119], a[184:187], v[180:183], a[116:119]
  v_add_f32 v225, v225, v213
  v_cvt_pk_bf16_f32 v174, v212, v213
  v_add_f32 v225, v225, v214
  v_mfma_f32_16x16x32_bf16 a[56:59], a[188:191], v[160:163], a[56:59]
  ds_read_b128 a[156:159], v3 offset:7168
  v_add_f32 v225, v225, v215
  v_max_f32 v5, v5, v225
  v_cmp_lt_f32 vcc, s81, v5
  v_mfma_f32_16x16x32_bf16 a[60:63], a[188:191], v[164:167], a[60:63]
  v_exp_f32 v216, v128
  v_mfma_f32_16x16x32_bf16 a[120:123], a[188:191], v[176:179], a[120:123]
  s_waitcnt lgkmcnt(4)
  v_cvt_pk_bf16_f32 v175, v214, v215
  v_mfma_f32_16x16x32_bf16 a[124:127], a[188:191], v[180:183], a[124:127]
  s_cbranch_vccnz fa_stub4
fa_back4:
  v_exp_f32 v217, v129
  v_add_f32 v228, v228, v224
  v_add_f32 v229, v229, v225
  v_add_f32 v230, v230, v226
  v_add_f32 v231, v231, v227
  v_mfma_f32_16x16x32_bf16 v[144:147], a[128:131], v[64:67], v[200:203]
  ds_read_b128 a[160:163], v3 offset:24576
  v_exp_f32 v218, v130
  v_mfma_f32_16x16x32_bf16 v[152:155], a[128:131], v[68:71], v[204:207]
  v_exp_f32 v219, v131
  v_add_f32 v226, v216, v217
  v_mfma_f32_16x16x32_bf16 v[148:151], a[132:135], v[64:67], v[200:203]
  s_add_u32 s66, s66, 32768
  ds_read_b128 a[164:167], v3 offset:25600
  v_exp_f32 v220, v132
  v_mfma_f32_16x16x32_bf16 v[156:159], a[132:135], v[68:71], v[204:207]
  s_and_b32 s66, s66, 0x1ffff
  v_exp_f32 v221, v133
  v_cvt_pk_bf16_f32 v176, v216, v217
  v_mfma_f32_16x16x32_bf16 v[144:147], a[136:139], v[72:75], v[144:147]
  ds_read_b128 a[168:171], v3 offset:26624
  v_add_f32 v226, v226, v218
  v_add_f32 v226, v226, v219
  v_mfma_f32_16x16x32_bf16 v[152:155], a[136:139], v[76:79], v[152:155]
  s_mov_b32 m0, s25
  v_exp_f32 v222, v134
  v_cvt_pk_bf16_f32 v177, v218, v219
  v_mfma_f32_16x16x32_bf16 v[148:151], a[140:143], v[72:75], v[148:151]
  ds_read_b128 a[172:175], v3 offset:27648
  buffer_load_dwordx4 v2, s[48:51], s27 offen offset:0 sc1 lds
  v_add_f32 v226, v226, v220
  v_add_f32 v226, v226, v221
  v_mfma_f32_16x16x32_bf16 v[156:159], a[140:143], v[76:79], v[156:159]
  s_waitcnt lgkmcnt(4)
  v_exp_f32 v223, v135
  v_cvt_pk_bf16_f32 v178, v220, v221
  v_mfma_f32_16x16x32_bf16 v[144:147], a[144:147], v[80:83], v[144:147]
  ds_read_b128 a[176:179], v3 offset:28672
  v_cndmask_b32 v96, v4, v96, s[68:69]
  v_cndmask_b32 v97, v4, v97, s[70:71]
  v_mfma_f32_16x16x32_bf16 v[152:155], a[144:147], v[84:87], v[152:155]
  v_exp_f32 v216, v136
  v_cndmask_b32 v98, v4, v98, s[72:73]
  v_mfma_f32_16x16x32_bf16 v[148:151], a[148:151], v[80:83], v[148:151]
  ds_read_b128 a[180:183], v3 offset:29696
  v_cndmask_b32 v99, v4, v99, s[74:75]
  v_mov_b32 v100, v4
  v_mfma_f32_16x16x32_bf16 v[156:159], a[148:151], v[84:87], v[156:159]
  v_exp_f32 v217, v137
  v_mov_b32 v101, v4
  v_mfma_f32_16x16x32_bf16 v[144:147], a[152:155], v[88:91], v[144:147]
  ds_read_b128 a[184:187], v3 offset:30720
  v_mov_b32 v102, v4
  v_mov_b32 v103, v4
  v_mfma_f32_16x16x32_bf16 v[152:155], a[152:155], v[92:95], v[152:155]
  v_exp_f32 v218, v138
  v_cndmask_b32 v108, v4, v108, s[68:69]
  v_mfma_f32_16x16x32_bf16 v[148:151], a[156:159], v[88:91], v[148:151]
  ds_read_b128 a[188:191], v3 offset:31744
  v_cndmask_b32 v109, v4, v109, s[70:71]
  v_cndmask_b32 v110, v4, v110, s[72:73]
  v_mfma_f32_16x16x32_bf16 v[156:159], a[156:159], v[92:95], v[156:159]
  s_waitcnt lgkmcnt(4)
  v_exp_f32 v219, v139
  v_cndmask_b32 v111, v4, v111, s[74:75]
  v_mfma_f32_16x16x32_bf16 a[0:3], a[160:163], v[168:171], a[0:3]
  ds_read_b128 a[128:131], v3 offset:8192
  v_add_f32 v226, v226, v222
  v_add_f32 v226, v226, v223
  v_mfma_f32_16x16x32_bf16 a[4:7], a[160:163], v[172:175], a[4:7]
  v_exp_f32 v220, v140
  v_cvt_pk_bf16_f32 v179, v222, v223
  v_mfma_f32_16x16x32_bf16 a[64:67], a[160:163], v[184:187], a[64:67]
  buffer_load_dwordx4 v2, s[48:51], s27 offen offset:1024 sc1 lds
  v_add_f32 v227, v216, v217
  v_cvt_pk_bf16_f32 v180, v216, v217
  v_mfma_f32_16x16x32_bf16 a[68:71], a[160:163], v[188:191], a[68:71]
  v_exp_f32 v221, v141
  v_add_f32 v227, v227, v218
  v_mfma_f32_16x16x32_bf16 a[8:11], a[164:167], v[168:171], a[8:11]
  ds_read_b128 a[132:135], v3 offset:9216
  v_exp_f32 v222, v142
  v_mfma_f32_16x16x32_bf16 a[12:15], a[164:167], v[172:175], a[12:15]
  v_exp_f32 v223, v143
  v_mfma_f32_16x16x32_bf16 a[72:75], a[164:167], v[184:187], a[72:75]
  v_exp_f32 v208, v96
  v_mfma_f32_16x16x32_bf16 a[76:79], a[164:167], v[188:191], a[76:79]
  v_exp_f32 v209, v97
  v_mfma_f32_16x16x32_bf16 a[16:19], a[168:171], v[168:171], a[16:19]
  ds_read_b128 a[136:139], v3 offset:10240
  v_add_f32 v227, v227, v219
  v_cvt_pk_bf16_f32 v181, v218, v219
  v_add_f32 v227, v227, v220
  v_add_f32 v227, v227, v221
  v_cvt_pk_bf16_f32 v182, v220, v221
  v_mfma_f32_16x16x32_bf16 a[20:23], a[168:171], v[172:175], a[20:23]
  v_exp_f32 v210, v98
  v_mfma_f32_16x16x32_bf16 a[80:83], a[168:171], v[184:187], a[80:83]
  v_exp_f32 v211, v99
  v_mfma_f32_16x16x32_bf16 a[84:87], a[168:171], v[188:191], a[84:87]
  v_exp_f32 v212, v100
  v_mfma_f32_16x16x32_bf16 a[24:27], a[172:175], v[168:171], a[24:27]
  ds_read_b128 a[140:143], v3 offset:11264
  v_add_f32 v227, v227, v222
  v_add_f32 v227, v227, v223
  v_cvt_pk_bf16_f32 v183, v222, v223
  v_add_f32 v224, v208, v209
  v_cvt_pk_bf16_f32 v160, v208, v209
  v_mfma_f32_16x16x32_bf16 a[28:31], a[172:175], v[172:175], a[28:31]
  v_exp_f32 v213, v101
  v_mfma_f32_16x16x32_bf16 a[88:91], a[172:175], v[184:187], a[88:91]
  buffer_load_dwordx4 v2, s[48:51], s27 offen offset:2048 sc1 lds
  v_add_f32 v224, v224, v210
  v_add_f32 v224, v224, v211
  v_cvt_pk_bf16_f32 v161, v210, v211
  v_mfma_f32_16x16x32_bf16 a[92:95], a[172:175], v[188:191], a[92:95]
  s_waitcnt lgkmcnt(4)
  v_exp_f32 v214, v102
  v_mfma_f32_16x16x32_bf16 a[32:35], a[176:179], v[168:171], a[32:35]
  ds_read_b128 a[144:147], v3 offset:12288
  v_exp_f32 v215, v103
  v_mfma_f32_16x16x32_bf16 a[36:39], a[176:179], v[172:175], a[36:39]
  v_exp_f32 v208, v104
  v_mfma_f32_16x16x32_bf16 a[96:99], a[176:179], v[184:187], a[96:99]
  v_exp_f32 v209, v105
  v_mfma_f32_16x16x32_bf16 a[100:103], a[176:179], v[188:191], a[100:103]
  v_exp_f32 v210, v106
  v_mfma_f32_16x16x32_bf16 a[40:43], a[180:183], v[168:171], a[40:43]
  ds_read_b128 a[148:151], v3 offset:13312
  v_add_f32 v224, v224, v212
  v_add_f32 v224, v224, v213
  v_cvt_pk_bf16_f32 v162, v212, v213
  v_add_f32 v224, v224, v214
  v_add_f32 v224, v224, v215
  v_cvt_pk_bf16_f32 v163, v214, v215
  v_mfma_f32_16x16x32_bf16 a[44:47], a[180:183], v[172:175], a[44:47]
  v_exp_f32 v211, v107
  v_mfma_f32_16x16x32_bf16 a[104:107], a[180:183], v[184:187], a[104:107]
  v_exp_f32 v212, v108
  v_mfma_f32_16x16x32_bf16 a[108:111], a[180:183], v[188:191], a[108:111]
  v_exp_f32 v213, v109
  v_mfma_f32_16x16x32_bf16 a[48:51], a[184:187], v[168:171], a[48:51]
  ds_read_b128 a[152:155], v3 offset:14336
  v_add_f32 v225, v208, v209
  v_cvt_pk_bf16_f32 v164, v208, v209
  v_add_f32 v225, v225, v210
  v_add_f32 v225, v225, v211
  v_cvt_pk_bf16_f32 v165, v210, v211
  v_mfma_f32_16x16x32_bf16 a[52:55], a[184:187], v[172:175], a[52:55]
  v_exp_f32 v214, v110
  v_mfma_f32_16x16x32_bf16 a[112:115], a[184:187], v[184:187], a[112:115]
  buffer_load_dwordx4 v2, s[48:51], s27 offen offset:3072 sc1 lds
  v_max3_f32 v5, v226, v227, v224
  v_add_f32 v225, v225, v212
  v_add_f32 v225, v225, v213
  v_mfma_f32_16x16x32_bf16 a[116:119], a[184:187], v[188:191], a[116:119]
  s_add_u32 s27, s27, 16384
  v_exp_f32 v215, v111
  v_mfma_f32_16x16x32_bf16 a[56:59], a[188:191], v[168:171], a[56:59]
  s_add_u32 s25, s25, 32768
  ds_read_b128 a[156:159], v3 offset:15360
  v_cvt_pk_bf16_f32 v166, v212, v213
  v_add_f32 v225, v225, v214
  v_add_f32 v225, v225, v215
  v_max_f32 v5, v5, v225
  v_cmp_lt_f32 vcc, s81, v5
  v_mfma_f32_16x16x32_bf16 a[60:63], a[188:191], v[172:175], a[60:63]
  s_and_b32 s25, s25, 0x1ffff
  v_exp_f32 v216, v144
  v_mfma_f32_16x16x32_bf16 a[120:123], a[188:191], v[184:187], a[120:123]
  s_waitcnt lgkmcnt(4)
  v_cvt_pk_bf16_f32 v167, v214, v215
  v_add_u32 v3, s66, v2
  v_mfma_f32_16x16x32_bf16 a[124:127], a[188:191], v[188:191], a[124:127]
  s_cbranch_vccnz fa_stub5
fa_back5:
  v_exp_f32 v217, v145
  v_add_f32 v228, v228, v224
  v_add_f32 v229, v229, v225
  v_add_f32 v230, v230, v226
  v_add_f32 v231, v231, v227
fa_AV:
  v_mfma_f32_16x16x32_bf16 v[128:131], a[128:131], v[64:67], v[200:203]
  s_waitcnt vmcnt(12)
  v_exp_f32 v218, v146
  v_mfma_f32_16x16x32_bf16 v[136:139], a[128:131], v[68:71], v[204:207]
  s_barrier
  v_exp_f32 v219, v147
  v_mfma_f32_16x16x32_bf16 v[132:135], a[132:135], v[64:67], v[200:203]
  ds_read_b128 a[160:163], v3 offset:16384
  ds_read_b128 a[164:167], v3 offset:17408
  v_add_f32 v226, v216, v217
  v_mfma_f32_16x16x32_bf16 v[140:143], a[132:135], v[68:71], v[204:207]
  v_exp_f32 v220, v148
  v_mfma_f32_16x16x32_bf16 v[128:131], a[136:139], v[72:75], v[128:131]
  ds_read_b128 a[168:171], v3 offset:18432
  v_cvt_pk_bf16_f32 v184, v216, v217
  v_mfma_f32_16x16x32_bf16 v[136:139], a[136:139], v[76:79], v[136:139]
  s_mov_b32 m0, s24
  v_exp_f32 v221, v149
  v_mfma_f32_16x16x32_bf16 v[132:135], a[140:143], v[72:75], v[132:135]
  ds_read_b128 a[172:175], v3 offset:19456
  buffer_load_dwordx4 v2, s[44:47], s26 offen offset:0 sc1 lds
  v_add_f32 v226, v226, v218
  v_mfma_f32_16x16x32_bf16 v[140:143], a[140:143], v[76:79], v[140:143]
  s_waitcnt lgkmcnt(4)
  v_exp_f32 v222, v150
  v_mfma_f32_16x16x32_bf16 v[128:131], a[144:147], v[80:83], v[128:131]
  ds_read_b128 a[176:179], v3 offset:20480
  v_add_f32 v226, v226, v219
  v_mfma_f32_16x16x32_bf16 v[136:139], a[144:147], v[84:87], v[136:139]
  v_exp_f32 v223, v151
  v_mfma_f32_16x16x32_bf16 v[132:135], a[148:151], v[80:83], v[132:135]
  ds_read_b128 a[180:183], v3 offset:21504
  v_cvt_pk_bf16_f32 v185, v218, v219
  v_mfma_f32_16x16x32_bf16 v[140:143], a[148:151], v[84:87], v[140:143]
  v_add_f32 v226, v226, v220
  v_add_f32 v226, v226, v221
  v_mfma_f32_16x16x32_bf16 v[128:131], a[152:155], v[88:91], v[128:131]
  ds_read_b128 a[184:187], v3 offset:22528
  v_cvt_pk_bf16_f32 v186, v220, v221
  v_mfma_f32_16x16x32_bf16 v[136:139], a[152:155], v[92:95], v[136:139]
  v_exp_f32 v216, v152
  v_mfma_f32_16x16x32_bf16 v[132:135], a[156:159], v[88:91], v[132:135]
  ds_read_b128 a[188:191], v3 offset:23552
  v_add_f32 v226, v226, v222
  v_mfma_f32_16x16x32_bf16 v[140:143], a[156:159], v[92:95], v[140:143]
  s_waitcnt lgkmcnt(4)
  v_exp_f32 v217, v153
  v_mfma_f32_16x16x32_bf16 a[0:3], a[160:163], v[160:163], a[0:3]
  ds_read_b128 a[128:131], v3 offset:0
  v_add_f32 v226, v226, v223
  v_mfma_f32_16x16x32_bf16 a[4:7], a[160:163], v[164:167], a[4:7]
  v_exp_f32 v218, v154
  v_mfma_f32_16x16x32_bf16 a[64:67], a[160:163], v[176:179], a[64:67]
  buffer_load_dwordx4 v2, s[44:47], s26 offen offset:1024 sc1 lds
  v_cvt_pk_bf16_f32 v187, v222, v223
  v_mfma_f32_16x16x32_bf16 a[68:71], a[160:163], v[180:183], a[68:71]
  v_exp_f32 v219, v155
  v_mfma_f32_16x16x32_bf16 a[8:11], a[164:167], v[160:163], a[8:11]
  ds_read_b128 a[132:135], v3 offset:1024
  v_add_f32 v227, v216, v217
  v_mfma_f32_16x16x32_bf16 a[12:15], a[164:167], v[164:167], a[12:15]
  v_exp_f32 v220, v156
  v_mfma_f32_16x16x32_bf16 a[72:75], a[164:167], v[176:179], a[72:75]
  v_exp_f32 v221, v157
  v_mfma_f32_16x16x32_bf16 a[76:79], a[164:167], v[180:183], a[76:79]
  v_cvt_pk_bf16_f32 v188, v216, v217
  v_add_f32 v227, v227, v218
  v_mfma_f32_16x16x32_bf16 a[16:19], a[168:171], v[160:163], a[16:19]
  ds_read_b128 a[136:139], v3 offset:2048
  v_add_f32 v227, v227, v219
  v_mfma_f32_16x16x32_bf16 a[20:23], a[168:171], v[164:167], a[20:23]
  v_exp_f32 v222, v158
  v_mfma_f32_16x16x32_bf16 a[80:83], a[168:171], v[176:179], a[80:83]
  v_exp_f32 v223, v159
  v_mfma_f32_16x16x32_bf16 a[84:87], a[168:171], v[180:183], a[84:87]
  v_cvt_pk_bf16_f32 v189, v218, v219
  v_add_f32 v227, v227, v220
  v_mfma_f32_16x16x32_bf16 a[24:27], a[172:175], v[160:163], a[24:27]
  ds_read_b128 a[140:143], v3 offset:3072
  v_add_f32 v227, v227, v221
  v_mfma_f32_16x16x32_bf16 a[28:31], a[172:175], v[164:167], a[28:31]
  v_cvt_pk_bf16_f32 v190, v220, v221
  v_add_f32 v227, v227, v222
  v_mfma_f32_16x16x32_bf16 a[88:91], a[172:175], v[176:179], a[88:91]
  buffer_load_dwordx4 v2, s[44:47], s26 offen offset:2048 sc1 lds
  v_add_f32 v227, v227, v223
  v_mfma_f32_16x16x32_bf16 a[92:95], a[172:175], v[180:183], a[92:95]
  s_waitcnt lgkmcnt(4)
  v_max_f32 v5, v226, v227
  v_cmp_lt_f32 vcc, s81, v5
  v_mfma_f32_16x16x32_bf16 a[32:35], a[176:179], v[160:163], a[32:35]
  ds_read_b128 a[144:147], v3 offset:4096
  v_mfma_f32_16x16x32_bf16 a[36:39], a[176:179], v[164:167], a[36:39]
  v_mfma_f32_16x16x32_bf16 a[96:99], a[176:179], v[176:179], a[96:99]
  v_mfma_f32_16x16x32_bf16 a[100:103], a[176:179], v[180:183], a[100:103]
  v_mfma_f32_16x16x32_bf16 a[40:43], a[180:183], v[160:163], a[40:43]
  ds_read_b128 a[148:151], v3 offset:5120
  v_mfma_f32_16x16x32_bf16 a[44:47], a[180:183], v[164:167], a[44:47]
  v_mfma_f32_16x16x32_bf16 a[104:107], a[180:183], v[176:179], a[104:107]
  v_mfma_f32_16x16x32_bf16 a[108:111], a[180:183], v[180:183], a[108:111]
  v_mfma_f32_16x16x32_bf16 a[48:51], a[184:187], v[160:163], a[48:51]
  ds_read_b128 a[152:155], v3 offset:6144
  v_mfma_f32_16x16x32_bf16 a[52:55], a[184:187], v[164:167], a[52:55]
  v_mfma_f32_16x16x32_bf16 a[112:115], a[184:187], v[176:179], a[112:115]
  buffer_load_dwordx4 v2, s[44:47], s26 offen offset:3072 sc1 lds
  v_mfma_f32_16x16x32_bf16 a[116:119], a[184:187], v[180:183], a[116:119]
  s_add_u32 s26, s26, 16384
  v_mfma_f32_16x16x32_bf16 a[56:59], a[188:191], v[160:163], a[56:59]
  s_add_u32 s24, s24, 32768
  ds_read_b128 a[156:159], v3 offset:7168
  v_mfma_f32_16x16x32_bf16 a[60:63], a[188:191], v[164:167], a[60:63]
  s_and_b32 s24, s24, 0x1ffff
  v_exp_f32 v216, v128
  v_mfma_f32_16x16x32_bf16 a[120:123], a[188:191], v[176:179], a[120:123]
  s_waitcnt lgkmcnt(4)
  v_cvt_pk_bf16_f32 v191, v222, v223
  v_mfma_f32_16x16x32_bf16 a[124:127], a[188:191], v[180:183], a[124:127]
  s_cbranch_vccnz fa_stub6
fa_back6:
  v_exp_f32 v217, v129
  v_add_f32 v230, v230, v226
  v_add_f32 v231, v231, v227
  v_mfma_f32_16x16x32_bf16 v[144:147], a[128:131], v[64:67], v[200:203]
  ds_read_b128 a[160:163], v3 offset:24576
  v_add_f32 v226, v216, v217
  v_mfma_f32_16x16x32_bf16 v[152:155], a[128:131], v[68:71], v[204:207]
  v_exp_f32 v218, v130
  v_mfma_f32_16x16x32_bf16 v[148:151], a[132:135], v[64:67], v[200:203]
  s_add_u32 s66, s66, 32768
  ds_read_b128 a[164:167], v3 offset:25600
  v_cvt_pk_bf16_f32 v176, v216, v217
  v_mfma_f32_16x16x32_bf16 v[156:159], a[132:135], v[68:71], v[204:207]
  s_mov_b32 m0, s25
  v_exp_f32 v219, v131
  v_mfma_f32_16x16x32_bf16 v[144:147], a[136:139], v[72:75], v[144:147]
  s_and_b32 s66, s66, 0x1ffff
  ds_read_b128 a[168:171], v3 offset:26624
  buffer_load_dwordx4 v2, s[48:51], s27 offen offset:0 sc1 lds
  v_add_f32 v226, v226, v218
  v_add_f32 v226, v226, v219
  v_mfma_f32_16x16x32_bf16 v[152:155], a[136:139], v[76:79], v[152:155]
  v_exp_f32 v220, v132
  v_mfma_f32_16x16x32_bf16 v[148:151], a[140:143], v[72:75], v[148:151]
  ds_read_b128 a[172:175], v3 offset:27648
  v_cvt_pk_bf16_f32 v177, v218, v219
  v_mfma_f32_16x16x32_bf16 v[156:159], a[140:143], v[76:79], v[156:159]
  s_waitcnt lgkmcnt(4)
  v_exp_f32 v221, v133
  v_mfma_f32_16x16x32_bf16 v[144:147], a[144:147], v[80:83], v[144:147]
  ds_read_b128 a[176:179], v3 offset:28672
  v_add_f32 v226, v226, v220
  v_mfma_f32_16x16x32_bf16 v[152:155], a[144:147], v[84:87], v[152:155]
  v_exp_f32 v222, v134
  v_mfma_f32_16x16x32_bf16 v[148:151], a[148:151], v[80:83], v[148:151]
  ds_read_b128 a[180:183], v3 offset:29696
  buffer_load_dwordx4 v2, s[48:51], s27 offen offset:1024 sc1 lds
  v_add_f32 v226, v226, v221
  v_cvt_pk_bf16_f32 v178, v220, v221
  v_mfma_f32_16x16x32_bf16 v[156:159], a[148:151], v[84:87], v[156:159]
  v_exp_f32 v223, v135
  v_mfma_f32_16x16x32_bf16 v[144:147], a[152:155], v[88:91], v[144:147]
  ds_read_b128 a[184:187], v3 offset:30720
  v_add_f32 v226, v226, v222
  v_mfma_f32_16x16x32_bf16 v[152:155], a[152:155], v[92:95], v[152:155]
  v_exp_f32 v216, v136
  v_mfma_f32_16x16x32_bf16 v[148:151], a[156:159], v[88:91], v[148:151]
  ds_read_b128 a[188:191], v3 offset:31744
  v_add_f32 v226, v226, v223
  v_exp_f32 v217, v137
  v_mfma_f32_16x16x32_bf16 v[156:159], a[156:159], v[92:95], v[156:159]
  s_waitcnt lgkmcnt(4)
  v_exp_f32 v218, v138
  v_mfma_f32_16x16x32_bf16 a[64:67], a[160:163], v[184:187], a[64:67]
  ds_read_b128 a[128:131], v3 offset:8192
  v_cvt_pk_bf16_f32 v179, v222, v223
  v_mfma_f32_16x16x32_bf16 a[68:71], a[160:163], v[188:191], a[68:71]
  v_exp_f32 v219, v139
  v_mfma_f32_16x16x32_bf16 a[72:75], a[164:167], v[184:187], a[72:75]
  ds_read_b128 a[132:135], v3 offset:9216
  buffer_load_dwordx4 v2, s[48:51], s27 offen offset:2048 sc1 lds
  v_add_f32 v227, v216, v217
  v_mfma_f32_16x16x32_bf16 a[76:79], a[164:167], v[188:191], a[76:79]
  v_exp_f32 v220, v140
  v_mfma_f32_16x16x32_bf16 a[80:83], a[168:171], v[184:187], a[80:83]
  ds_read_b128 a[136:139], v3 offset:10240
  v_cvt_pk_bf16_f32 v180, v216, v217
  v_mfma_f32_16x16x32_bf16 a[84:87], a[168:171], v[188:191], a[84:87]
  v_exp_f32 v221, v141
  v_mfma_f32_16x16x32_bf16 a[88:91], a[172:175], v[184:187], a[88:91]
  ds_read_b128 a[140:143], v3 offset:11264
  v_add_f32 v227, v227, v218
  v_mfma_f32_16x16x32_bf16 a[92:95], a[172:175], v[188:191], a[92:95]
  s_waitcnt lgkmcnt(4)
  v_exp_f32 v222, v142
  v_mfma_f32_16x16x32_bf16 a[96:99], a[176:179], v[184:187], a[96:99]
  ds_read_b128 a[144:147], v3 offset:12288
  buffer_load_dwordx4 v2, s[48:51], s27 offen offset:3072 sc1 lds
  v_add_f32 v227, v227, v219
  v_cvt_pk_bf16_f32 v181, v218, v219
  v_mfma_f32_16x16x32_bf16 a[100:103], a[176:179], v[188:191], a[100:103]
  s_add_u32 s27, s27, 16384
  v_exp_f32 v223, v143
  v_mfma_f32_16x16x32_bf16 a[104:107], a[180:183], v[184:187], a[104:107]
  s_add_u32 s25, s25, 32768
  ds_read_b128 a[148:151], v3 offset:13312
  v_add_f32 v227, v227, v220
  v_mfma_f32_16x16x32_bf16 a[108:111], a[180:183], v[188:191], a[108:111]
  s_and_b32 s25, s25, 0x1ffff
  v_add_f32 v227, v227, v221
  v_cvt_pk_bf16_f32 v182, v220, v221
  v_add_f32 v227, v227, v222
  v_mfma_f32_16x16x32_bf16 a[112:115], a[184:187], v[184:187], a[112:115]
  ds_read_b128 a[152:155], v3 offset:14336
  v_add_f32 v227, v227, v223
  v_max_f32 v5, v226, v227
  v_cmp_lt_f32 vcc, s81, v5
  v_mfma_f32_16x16x32_bf16 a[116:119], a[184:187], v[188:191], a[116:119]
  v_exp_f32 v216, v144
  v_mfma_f32_16x16x32_bf16 a[120:123], a[188:191], v[184:187], a[120:123]
  s_waitcnt lgkmcnt(3)
  ds_read_b128 a[156:159], v3 offset:15360
  v_cvt_pk_bf16_f32 v183, v222, v223
  v_add_u32 v3, s66, v2
  v_mfma_f32_16x16x32_bf16 a[124:127], a[188:191], v[188:191], a[124:127]
  s_cbranch_vccnz fa_stub7
fa_back7:
  v_exp_f32 v217, v145
  v_add_f32 v230, v230, v226
  v_add_f32 v231, v231, v227
  s_branch fa_SSpre
fa_Aodd:
  v_mfma_f32_16x16x32_bf16 v[128:131], a[128:131], v[64:67], v[200:203]
  s_waitcnt vmcnt(12)
  v_exp_f32 v218, v146
  v_add_f32 v226, v216, v217
  v_mfma_f32_16x16x32_bf16 v[136:139], a[128:131], v[68:71], v[204:207]
  s_barrier
  v_exp_f32 v219, v147
  v_cvt_pk_bf16_f32 v184, v216, v217
  v_mfma_f32_16x16x32_bf16 v[132:135], a[132:135], v[64:67], v[200:203]
  ds_read_b128 a[160:163], v3 offset:16384
  ds_read_b128 a[164:167], v3 offset:17408
  v_exp_f32 v220, v148
  v_mfma_f32_16x16x32_bf16 v[140:143], a[132:135], v[68:71], v[204:207]
  v_exp_f32 v221, v149
  v_add_f32 v226, v226, v218
  v_mfma_f32_16x16x32_bf16 v[128:131], a[136:139], v[72:75], v[128:131]
  ds_read_b128 a[168:171], v3 offset:18432
  v_add_f32 v226, v226, v219
  v_cvt_pk_bf16_f32 v185, v218, v219
  v_mfma_f32_16x16x32_bf16 v[136:139], a[136:139], v[76:79], v[136:139]
  s_mov_b32 m0, s24
  v_exp_f32 v222, v150
  v_add_f32 v226, v226, v220
  v_mfma_f32_16x16x32_bf16 v[132:135], a[140:143], v[72:75], v[132:135]
  ds_read_b128 a[172:175], v3 offset:19456
  buffer_load_dwordx4 v2, s[44:47], s26 offen offset:0 sc1 lds
  v_add_f32 v226, v226, v221
  v_cvt_pk_bf16_f32 v186, v220, v221
  v_mfma_f32_16x16x32_bf16 v[140:143], a[140:143], v[76:79], v[140:143]
  s_waitcnt lgkmcnt(4)
  v_exp_f32 v223, v151
  v_cndmask_b32 v112, v4, v112, s[68:69]
  v_mfma_f32_16x16x32_bf16 v[128:131], a[144:147], v[80:83], v[128:131]
  ds_read_b128 a[176:179], v3 offset:20480
  v_cndmask_b32 v113, v4, v113, s[70:71]
  v_cndmask_b32 v114, v4, v114, s[72:73]
  v_mfma_f32_16x16x32_bf16 v[136:139], a[144:147], v[84:87], v[136:139]
  v_exp_f32 v216, v152
  v_cndmask_b32 v115, v4, v115, s[74:75]
  v_mfma_f32_16x16x32_bf16 v[132:135], a[148:151], v[80:83], v[132:135]
  ds_read_b128 a[180:183], v3 offset:21504
  v_mov_b32 v116, v4
  v_mov_b32 v117, v4
  v_mfma_f32_16x16x32_bf16 v[140:143], a[148:151], v[84:87], v[140:143]
  v_exp_f32 v217, v153
  v_mov_b32 v118, v4
  v_mfma_f32_16x16x32_bf16 v[128:131], a[152:155], v[88:91], v[128:131]
  ds_read_b128 a[184:187], v3 offset:22528
  v_mov_b32 v119, v4
  v_cndmask_b32 v124, v4, v124, s[68:69]
  v_mfma_f32_16x16x32_bf16 v[136:139], a[152:155], v[92:95], v[136:139]
  v_exp_f32 v218, v154
  v_cndmask_b32 v125, v4, v125, s[70:71]
  v_mfma_f32_16x16x32_bf16 v[132:135], a[156:159], v[88:91], v[132:135]
  ds_read_b128 a[188:191], v3 offset:23552
  v_cndmask_b32 v126, v4, v126, s[72:73]
  v_cndmask_b32 v127, v4, v127, s[74:75]
  v_mfma_f32_16x16x32_bf16 v[140:143], a[156:159], v[92:95], v[140:143]
  s_waitcnt lgkmcnt(4)
  v_exp_f32 v219, v155
  v_add_f32 v226, v226, v222
  v_mfma_f32_16x16x32_bf16 a[0:3], a[160:163], v[160:163], a[0:3]
  ds_read_b128 a[128:131], v3 offset:0
  v_add_f32 v226, v226, v223
  v_cvt_pk_bf16_f32 v187, v222, v223
  v_mfma_f32_16x16x32_bf16 a[4:7], a[160:163], v[164:167], a[4:7]
  v_exp_f32 v220, v156
  v_add_f32 v227, v216, v217
  v_mfma_f32_16x16x32_bf16 a[64:67], a[160:163], v[176:179], a[64:67]
  buffer_load_dwordx4 v2, s[44:47], s26 offen offset:1024 sc1 lds
  v_exp_f32 v221, v157
  v_mfma_f32_16x16x32_bf16 a[68:71], a[160:163], v[180:183], a[68:71]
  v_exp_f32 v222, v158
  v_mfma_f32_16x16x32_bf16 a[8:11], a[164:167], v[160:163], a[8:11]
  ds_read_b128 a[132:135], v3 offset:1024
  v_cvt_pk_bf16_f32 v188, v216, v217
  v_add_f32 v227, v227, v218
  v_add_f32 v227, v227, v219
  v_mfma_f32_16x16x32_bf16 a[12:15], a[164:167], v[164:167], a[12:15]
  v_exp_f32 v223, v159
  v_mfma_f32_16x16x32_bf16 a[72:75], a[164:167], v[176:179], a[72:75]
  v_exp_f32 v208, v112
  v_mfma_f32_16x16x32_bf16 a[76:79], a[164:167], v[180:183], a[76:79]
  v_exp_f32 v209, v113
  v_mfma_f32_16x16x32_bf16 a[16:19], a[168:171], v[160:163], a[16:19]
  ds_read_b128 a[136:139], v3 offset:2048
  v_cvt_pk_bf16_f32 v189, v218, v219
  v_add_f32 v227, v227, v220
  v_add_f32 v227, v227, v221
  v_cvt_pk_bf16_f32 v190, v220, v221
  v_add_f32 v227, v227, v222
  v_mfma_f32_16x16x32_bf16 a[20:23], a[168:171], v[164:167], a[20:23]
  v_exp_f32 v210, v114
  v_mfma_f32_16x16x32_bf16 a[80:83], a[168:171], v[176:179], a[80:83]
  v_exp_f32 v211, v115
  v_mfma_f32_16x16x32_bf16 a[84:87], a[168:171], v[180:183], a[84:87]
  v_exp_f32 v212, v116
  v_mfma_f32_16x16x32_bf16 a[24:27], a[172:175], v[160:163], a[24:27]
  ds_read_b128 a[140:143], v3 offset:3072
  v_add_f32 v227, v227, v223
  v_cvt_pk_bf16_f32 v191, v222, v223
  v_add_f32 v224, v208, v209
  v_cvt_pk_bf16_f32 v168, v208, v209
  v_add_f32 v224, v224, v210
  v_mfma_f32_16x16x32_bf16 a[28:31], a[172:175], v[164:167], a[28:31]
  v_exp_f32 v213, v117
  v_mfma_f32_16x16x32_bf16 a[88:91], a[172:175], v[176:179], a[88:91]
  buffer_load_dwordx4 v2, s[44:47], s26 offen offset:2048 sc1 lds
  v_exp_f32 v214, v118
  v_mfma_f32_16x16x32_bf16 a[92:95], a[172:175], v[180:183], a[92:95]
  s_waitcnt lgkmcnt(4)
  v_exp_f32 v215, v119
  v_mfma_f32_16x16x32_bf16 a[32:35], a[176:179], v[160:163], a[32:35]
  ds_read_b128 a[144:147], v3 offset:4096
  v_add_f32 v224, v224, v211
  v_cvt_pk_bf16_f32 v169, v210, v211
  v_add_f32 v224, v224, v212
  v_add_f32 v224, v224, v213
  v_mfma_f32_16x16x32_bf16 a[36:39], a[176:179], v[164:167], a[36:39]
  v_exp_f32 v208, v120
  v_mfma_f32_16x16x32_bf16 a[96:99], a[176:179], v[176:179], a[96:99]
  v_exp_f32 v209, v121
  v_mfma_f32_16x16x32_bf16 a[100:103], a[176:179], v[180:183], a[100:103]
  v_exp_f32 v210, v122
  v_mfma_f32_16x16x32_bf16 a[40:43], a[180:183], v[160:163], a[40:43]
  ds_read_b128 a[148:151], v3 offset:5120
  v_cvt_pk_bf16_f32 v170, v212, v213
  v_add_f32 v224, v224, v214
  v_add_f32 v224, v224, v215
  v_cvt_pk_bf16_f32 v171, v214, v215
  v_add_f32 v225, v208, v209
  v_mfma_f32_16x16x32_bf16 a[44:47], a[180:183], v[164:167], a[44:47]
  v_exp_f32 v211, v123
  v_mfma_f32_16x16x32_bf16 a[104:107], a[180:183], v[176:179], a[104:107]
  v_exp_f32 v212, v124
  v_mfma_f32_16x16x32_bf16 a[108:111], a[180:183], v[180:183], a[108:111]
  v_exp_f32 v213, v125
  v_mfma_f32_16x16x32_bf16 a[48:51], a[184:187], v[160:163], a[48:51]
  ds_read_b128 a[152:155], v3 offset:6144
  v_cvt_pk_bf16_f32 v172, v208, v209
  v_add_f32 v225, v225, v210
  v_add_f32 v225, v225, v211
  v_cvt_pk_bf16_f32 v173, v210, v211
  v_max3_f32 v5, v226, v227, v224
  v_mfma_f32_16x16x32_bf16 a[52:55], a[184:187], v[164:167], a[52:55]
  v_exp_f32 v214, v126
  v_mfma_f32_16x16x32_bf16 a[112:115], a[184:187], v[176:179], a[112:115]
  buffer_load_dwordx4 v2, s[44:47], s26 offen offset:3072 sc1 lds
  v_add_f32 v225, v225, v212
  v_add_f32 v225, v225, v213
  v_cvt_pk_bf16_f32 v174, v212, v213
  v_mfma_f32_16x16x32_bf16 a[116:119], a[184:187], v[180:183], a[116:119]
  s_add_u32 s26, s26, 16384
  v_exp_f32 v215, v127
  v_mfma_f32_16x16x32_bf16 a[56:59], a[188:191], v[160:163], a[56:59]
  s_add_u32 s24, s24, 32768
  ds_read_b128 a[156:159], v3 offset:7168
  v_add_f32 v225, v225, v214
  v_add_f32 v225, v225, v215
  v_max_f32 v5, v5, v225
  v_cmp_lt_f32 vcc, s81, v5
  v_mfma_f32_16x16x32_bf16 a[60:63], a[188:191], v[164:167], a[60:63]
  s_and_b32 s24, s24, 0x1ffff
  v_exp_f32 v216, v128
  v_mfma_f32_16x16x32_bf16 a[120:123], a[188:191], v[176:179], a[120:123]
  s_waitcnt lgkmcnt(4)
  v_cvt_pk_bf16_f32 v175, v214, v215
  v_mfma_f32_16x16x32_bf16 a[124:127], a[188:191], v[180:183], a[124:127]
  s_cbranch_vccnz fa_stub8
fa_back8:
  v_exp_f32 v217, v129
  v_add_f32 v228, v228, v224
  v_add_f32 v229, v229, v225
  v_add_f32 v230, v230, v226
  v_add_f32 v231, v231, v227
  v_mfma_f32_16x16x32_bf16 v[144:147], a[128:131], v[64:67], v[200:203]
  ds_read_b128 a[160:163], v3 offset:24576
  v_add_f32 v226, v216, v217
  v_mfma_f32_16x16x32_bf16 v[152:155], a[128:131], v[68:71], v[204:207]
  v_exp_f32 v218, v130
  v_mfma_f32_16x16x32_bf16 v[148:151], a[132:135], v[64:67], v[200:203]
  s_add_u32 s66, s66, 32768
  ds_read_b128 a[164:167], v3 offset:25600
  v_cvt_pk_bf16_f32 v176, v216, v217
  v_mfma_f32_16x16x32_bf16 v[156:159], a[132:135], v[68:71], v[204:207]
  s_and_b32 s66, s66, 0x1ffff
  v_exp_f32 v219, v131
  v_mfma_f32_16x16x32_bf16 v[144:147], a[136:139], v[72:75], v[144:147]
  ds_read_b128 a[168:171], v3 offset:26624
  v_add_f32 v226, v226, v218
  v_mfma_f32_16x16x32_bf16 v[152:155], a[136:139], v[76:79], v[152:155]
  s_mov_b32 m0, s25
  v_exp_f32 v220, v132
  v_mfma_f32_16x16x32_bf16 v[148:151], a[140:143], v[72:75], v[148:151]
  ds_read_b128 a[172:175], v3 offset:27648
  buffer_load_dwordx4 v2, s[48:51], s27 offen offset:0 sc1 lds
  v_add_f32 v226, v226, v219
  v_mfma_f32_16x16x32_bf16 v[156:159], a[140:143], v[76:79], v[156:159]
  s_waitcnt lgkmcnt(4)
  v_exp_f32 v221, v133
  v_mfma_f32_16x16x32_bf16 v[144:147], a[144:147], v[80:83], v[144:147]
  ds_read_b128 a[176:179], v3 offset:28672
  v_cvt_pk_bf16_f32 v177, v218, v219
  v_mfma_f32_16x16x32_bf16 v[152:155], a[144:147], v[84:87], v[152:155]
  v_exp_f32 v222, v134
  v_mfma_f32_16x16x32_bf16 v[148:151], a[148:151], v[80:83], v[148:151]
  ds_read_b128 a[180:183], v3 offset:29696
  v_add_f32 v226, v226, v220
  v_mfma_f32_16x16x32_bf16 v[156:159], a[148:151], v[84:87], v[156:159]
  v_exp_f32 v223, v135
  v_mfma_f32_16x16x32_bf16 v[144:147], a[152:155], v[88:91], v[144:147]
  ds_read_b128 a[184:187], v3 offset:30720
  v_add_f32 v226, v226, v221
  v_mfma_f32_16x16x32_bf16 v[152:155], a[152:155], v[92:95], v[152:155]
  v_exp_f32 v216, v136
  v_mfma_f32_16x16x32_bf16 v[148:151], a[156:159], v[88:91], v[148:151]
  ds_read_b128 a[188:191], v3 offset:31744
  v_cvt_pk_bf16_f32 v178, v220, v221
  v_mfma_f32_16x16x32_bf16 v[156:159], a[156:159], v[92:95], v[156:159]
  s_waitcnt lgkmcnt(4)
  v_exp_f32 v217, v137
  v_mfma_f32_16x16x32_bf16 a[0:3], a[160:163], v[168:171], a[0:3]
  ds_read_b128 a[128:131], v3 offset:8192
  v_add_f32 v226, v226, v222
  v_mfma_f32_16x16x32_bf16 a[4:7], a[160:163], v[172:175], a[4:7]
  v_exp_f32 v218, v138
  v_mfma_f32_16x16x32_bf16 a[64:67], a[160:163], v[184:187], a[64:67]
  buffer_load_dwordx4 v2, s[48:51], s27 offen offset:1024 sc1 lds
  v_add_f32 v226, v226, v223
  v_mfma_f32_16x16x32_bf16 a[68:71], a[160:163], v[188:191], a[68:71]
  v_exp_f32 v219, v139
  v_mfma_f32_16x16x32_bf16 a[8:11], a[164:167], v[168:171], a[8:11]
  ds_read_b128 a[132:135], v3 offset:9216
  v_cvt_pk_bf16_f32 v179, v222, v223
  v_mfma_f32_16x16x32_bf16 a[12:15], a[164:167], v[172:175], a[12:15]
  v_exp_f32 v220, v140
  v_mfma_f32_16x16x32_bf16 a[72:75], a[164:167], v[184:187], a[72:75]
  v_add_f32 v227, v216, v217
  v_cvt_pk_bf16_f32 v180, v216, v217
  v_mfma_f32_16x16x32_bf16 a[76:79], a[164:167], v[188:191], a[76:79]
  v_exp_f32 v221, v141
  v_mfma_f32_16x16x32_bf16 a[16:19], a[168:171], v[168:171], a[16:19]
  ds_read_b128 a[136:139], v3 offset:10240
  v_add_f32 v227, v227, v218
  v_mfma_f32_16x16x32_bf16 a[20:23], a[168:171], v[172:175], a[20:23]
  v_exp_f32 v222, v142
  v_mfma_f32_16x16x32_bf16 a[80:83], a[168:171], v[184:187], a[80:83]
  v_add_f32 v227, v227, v219
  v_cvt_pk_bf16_f32 v181, v218, v219
  v_mfma_f32_16x16x32_bf16 a[84:87], a[168:171], v[188:191], a[84:87]
  v_exp_f32 v223, v143
  v_mfma_f32_16x16x32_bf16 a[24:27], a[172:175], v[168:171], a[24:27]
  ds_read_b128 a[140:143], v3 offset:11264
  v_add_f32 v227, v227, v220
  v_mfma_f32_16x16x32_bf16 a[28:31], a[172:175], v[172:175], a[28:31]
  v_add_f32 v227, v227, v221
  v_cvt_pk_bf16_f32 v182, v220, v221
  v_mfma_f32_16x16x32_bf16 a[88:91], a[172:175], v[184:187], a[88:91]
  buffer_load_dwordx4 v2, s[48:51], s27 offen offset:2048 sc1 lds
  v_add_f32 v227, v227, v222
  v_mfma_f32_16x16x32_bf16 a[92:95], a[172:175], v[188:191], a[92:95]
  s_waitcnt lgkmcnt(4)
  v_add_f32 v227, v227, v223
  v_max_f32 v5, v226, v227
  v_mfma_f32_16x16x32_bf16 a[32:35], a[176:179], v[168:171], a[32:35]
  ds_read_b128 a[144:147], v3 offset:12288
  v_cmp_lt_f32 vcc, s81, v5
  v_mfma_f32_16x16x32_bf16 a[36:39], a[176:179], v[172:175], a[36:39]
  v_mfma_f32_16x16x32_bf16 a[96:99], a[176:179], v[184:187], a[96:99]
  v_mfma_f32_16x16x32_bf16 a[100:103], a[176:179], v[188:191], a[100:103]
  v_mfma_f32_16x16x32_bf16 a[40:43], a[180:183], v[168:171], a[40:43]
  ds_read_b128 a[148:151], v3 offset:13312
  v_mfma_f32_16x16x32_bf16 a[44:47], a[180:183], v[172:175], a[44:47]
  v_mfma_f32_16x16x32_bf16 a[104:107], a[180:183], v[184:187], a[104:107]
  v_mfma_f32_16x16x32_bf16 a[108:111], a[180:183], v[188:191], a[108:111]
  v_mfma_f32_16x16x32_bf16 a[48:51], a[184:187], v[168:171], a[48:51]
  ds_read_b128 a[152:155], v3 offset:14336
  v_mfma_f32_16x16x32_bf16 a[52:55], a[184:187], v[172:175], a[52:55]
  v_mfma_f32_16x16x32_bf16 a[112:115], a[184:187], v[184:187], a[112:115]
  buffer_load_dwordx4 v2, s[48:51], s27 offen offset:3072 sc1 lds
  v_mfma_f32_16x16x32_bf16 a[116:119], a[184:187], v[188:191], a[116:119]
  s_add_u32 s27, s27, 16384
  v_mfma_f32_16x16x32_bf16 a[56:59], a[188:191], v[168:171], a[56:59]
  s_add_u32 s25, s25, 32768
  ds_read_b128 a[156:159], v3 offset:15360
  v_mfma_f32_16x16x32_bf16 a[60:63], a[188:191], v[172:175], a[60:63]
  s_and_b32 s25, s25, 0x1ffff
  v_exp_f32 v216, v144
  v_mfma_f32_16x16x32_bf16 a[120:123], a[188:191], v[184:187], a[120:123]
  s_waitcnt lgkmcnt(4)
  v_cvt_pk_bf16_f32 v183, v222, v223
  v_add_u32 v3, s66, v2
  v_mfma_f32_16x16x32_bf16 a[124:127], a[188:191], v[188:191], a[124:127]
  s_cbranch_vccnz fa_stub9
fa_back9:
  v_exp_f32 v217, v145
  v_add_f32 v230, v230, v226
  v_add_f32 v231, v231, v227
fa_SSpre:
  s_mov_b32 s11, 1
  s_cmp_lg_u32 s12, 0
  s_cselect_b32 s32, s15, s32
  s_cmp_ge_u32 s20, 2
  s_cselect_b32 s23, 8, 0
  s_cmp_le_u32 s29, s23
  s_cbranch_scc1 fa_chain
.p2align 6
fa_SS:
  v_mfma_f32_16x16x32_bf16 v[128:131], a[128:131], v[64:67], v[200:203]
  s_waitcnt vmcnt(12)
  v_exp_f32 v218, v146
  v_mfma_f32_16x16x32_bf16 v[136:139], a[128:131], v[68:71], v[204:207]
  s_barrier
  v_exp_f32 v219, v147
  v_mfma_f32_16x16x32_bf16 v[132:135], a[132:135], v[64:67], v[200:203]
  s_cmp_ge_u32 s26, s32
  ds_read_b128 a[160:163], v3 offset:16384
  ds_read_b128 a[164:167], v3 offset:17408
  v_add_f32 v226, v216, v217
  v_mfma_f32_16x16x32_bf16 v[140:143], a[132:135], v[68:71], v[204:207]
  s_cbranch_scc1 fa_hk7
fa_hb7:
  v_exp_f32 v220, v148
  v_mfma_f32_16x16x32_bf16 v[128:131], a[136:139], v[72:75], v[128:131]
  ds_read_b128 a[168:171], v3 offset:18432
  v_cvt_pk_bf16_f32 v184, v216, v217
  v_mfma_f32_16x16x32_bf16 v[136:139], a[136:139], v[76:79], v[136:139]
  s_mov_b32 m0, s24
  v_exp_f32 v221, v149
  v_mfma_f32_16x16x32_bf16 v[132:135], a[140:143], v[72:75], v[132:135]
  ds_read_b128 a[172:175], v3 offset:19456
  buffer_load_dwordx4 v2, s[44:47], s26 offen offset:0 sc1 lds
  v_add_f32 v226, v226, v218
  v_add_f32 v226, v226, v219
  v_mfma_f32_16x16x32_bf16 v[140:143], a[140:143], v[76:79], v[140:143]
  s_waitcnt lgkmcnt(4)
  v_exp_f32 v222, v150
  v_mfma_f32_16x16x32_bf16 v[128:131], a[144:147], v[80:83], v[128:131]
  ds_read_b128 a[176:179], v3 offset:20480
  v_cvt_pk_bf16_f32 v185, v218, v219
  v_mfma_f32_16x16x32_bf16 v[136:139], a[144:147], v[84:87], v[136:139]
  v_exp_f32 v223, v151
  v_mfma_f32_16x16x32_bf16 v[132:135], a[148:151], v[80:83], v[132:135]
  ds_read_b128 a[180:183], v3 offset:21504
  v_add_f32 v226, v226, v220
  v_mfma_f32_16x16x32_bf16 v[140:143], a[148:151], v[84:87], v[140:143]
  v_exp_f32 v216, v152
  v_mfma_f32_16x16x32_bf16 v[128:131], a[152:155], v[88:91], v[128:131]
  ds_read_b128 a[184:187], v3 offset:22528
  buffer_load_dwordx4 v2, s[44:47], s26 offen offset:1024 sc1 lds
  v_add_f32 v226, v226, v221
  v_cvt_pk_bf16_f32 v186, v220, v221
  v_mfma_f32_16x16x32_bf16 v[136:139], a[152:155], v[92:95], v[136:139]
  v_exp_f32 v217, v153
  v_mfma_f32_16x16x32_bf16 v[132:135], a[156:159], v[88:91], v[132:135]
  ds_read_b128 a[188:191], v3 offset:23552
  v_add_f32 v226, v226, v222
  v_mfma_f32_16x16x32_bf16 v[140:143], a[156:159], v[92:95], v[140:143]
  s_waitcnt lgkmcnt(4)
  v_exp_f32 v218, v154
  v_mfma_f32_16x16x32_bf16 a[64:67], a[160:163], v[176:179], a[64:67]
  ds_read_b128 a[128:131], v3 offset:0
  v_add_f32 v226, v226, v223
  v_cvt_pk_bf16_f32 v187, v222, v223
  v_mfma_f32_16x16x32_bf16 a[68:71], a[160:163], v[180:183], a[68:71]
  v_exp_f32 v219, v155
  v_mfma_f32_16x16x32_bf16 a[72:75], a[164:167], v[176:179], a[72:75]
  ds_read_b128 a[132:135], v3 offset:1024
  buffer_load_dwordx4 v2, s[44:47], s26 offen offset:2048 sc1 lds
  v_add_f32 v227, v216, v217
  v_mfma_f32_16x16x32_bf16 a[76:79], a[164:167], v[180:183], a[76:79]
  v_exp_f32 v220, v156
  v_mfma_f32_16x16x32_bf16 a[80:83], a[168:171], v[176:179], a[80:83]
  ds_read_b128 a[136:139], v3 offset:2048
  v_cvt_pk_bf16_f32 v188, v216, v217
  v_mfma_f32_16x16x32_bf16 a[84:87], a[168:171], v[180:183], a[84:87]
  v_exp_f32 v221, v157
  v_mfma_f32_16x16x32_bf16 a[88:91], a[172:175], v[176:179], a[88:91]
  ds_read_b128 a[140:143], v3 offset:3072
  v_add_f32 v227, v227, v218
  v_add_f32 v227, v227, v219
  v_mfma_f32_16x16x32_bf16 a[92:95], a[172:175], v[180:183], a[92:95]
  s_waitcnt lgkmcnt(4)
  v_exp_f32 v222, v158
  v_mfma_f32_16x16x32_bf16 a[96:99], a[176:179], v[176:179], a[96:99]
  ds_read_b128 a[144:147], v3 offset:4096
  buffer_load_dwordx4 v2, s[44:47], s26 offen offset:3072 sc1 lds
  v_cvt_pk_bf16_f32 v189, v218, v219
  v_mfma_f32_16x16x32_bf16 a[100:103], a[176:179], v[180:183], a[100:103]
  s_add_u32 s26, s26, 16384
  v_exp_f32 v223, v159
  v_mfma_f32_16x16x32_bf16 a[104:107], a[180:183], v[176:179], a[104:107]
  s_add_u32 s24, s24, 32768
  ds_read_b128 a[148:151], v3 offset:5120
  v_add_f32 v227, v227, v220
  v_mfma_f32_16x16x32_bf16 a[108:111], a[180:183], v[180:183], a[108:111]
  s_and_b32 s24, s24, 0x1ffff
  v_add_f32 v227, v227, v221
  v_cvt_pk_bf16_f32 v190, v220, v221
  v_add_f32 v227, v227, v222
  v_mfma_f32_16x16x32_bf16 a[112:115], a[184:187], v[176:179], a[112:115]
  ds_read_b128 a[152:155], v3 offset:6144
  v_add_f32 v227, v227, v223
  v_max_f32 v5, v226, v227
  v_cmp_lt_f32 vcc, s81, v5
  v_mfma_f32_16x16x32_bf16 a[116:119], a[184:187], v[180:183], a[116:119]
  v_exp_f32 v216, v128
  v_mfma_f32_16x16x32_bf16 a[120:123], a[188:191], v[176:179], a[120:123]
  s_waitcnt lgkmcnt(3)
  ds_read_b128 a[156:159], v3 offset:7168
  v_cvt_pk_bf16_f32 v191, v222, v223
  v_mfma_f32_16x16x32_bf16 a[124:127], a[188:191], v[180:183], a[124:127]
  s_cbranch_vccnz fa_stub10
fa_back10:
  v_exp_f32 v217, v129
  v_add_f32 v230, v230, v226
  v_add_f32 v231, v231, v227
  v_mfma_f32_16x16x32_bf16 v[144:147], a[128:131], v[64:67], v[200:203]
  ds_read_b128 a[160:163], v3 offset:24576
  v_add_f32 v226, v216, v217
  v_mfma_f32_16x16x32_bf16 v[152:155], a[128:131], v[68:71], v[204:207]
  v_exp_f32 v218, v130
  v_mfma_f32_16x16x32_bf16 v[148:151], a[132:135], v[64:67], v[200:203]
  s_add_u32 s66, s66, 32768
  ds_read_b128 a[164:167], v3 offset:25600
  v_cvt_pk_bf16_f32 v176, v216, v217
  v_mfma_f32_16x16x32_bf16 v[156:159], a[132:135], v[68:71], v[204:207]
  s_mov_b32 m0, s25
  v_exp_f32 v219, v131
  v_mfma_f32_16x16x32_bf16 v[144:147], a[136:139], v[72:75], v[144:147]
  s_and_b32 s66, s66, 0x1ffff
  ds_read_b128 a[168:171], v3 offset:26624
  buffer_load_dwordx4 v2, s[48:51], s27 offen offset:0 sc1 lds
  v_add_f32 v226, v226, v218
  v_add_f32 v226, v226, v219
  v_mfma_f32_16x16x32_bf16 v[152:155], a[136:139], v[76:79], v[152:155]
  v_exp_f32 v220, v132
  v_mfma_f32_16x16x32_bf16 v[148:151], a[140:143], v[72:75], v[148:151]
  ds_read_b128 a[172:175], v3 offset:27648
  v_cvt_pk_bf16_f32 v177, v218, v219
  v_mfma_f32_16x16x32_bf16 v[156:159], a[140:143], v[76:79], v[156:159]
  s_waitcnt lgkmcnt(4)
  v_exp_f32 v221, v133
  v_mfma_f32_16x16x32_bf16 v[144:147], a[144:147], v[80:83], v[144:147]
  ds_read_b128 a[176:179], v3 offset:28672
  v_add_f32 v226, v226, v220
  v_mfma_f32_16x16x32_bf16 v[152:155], a[144:147], v[84:87], v[152:155]
  v_exp_f32 v222, v134
  v_mfma_f32_16x16x32_bf16 v[148:151], a[148:151], v[80:83], v[148:151]
  ds_read_b128 a[180:183], v3 offset:29696
  buffer_load_dwordx4 v2, s[48:51], s27 offen offset:1024 sc1 lds
  v_add_f32 v226, v226, v221
  v_cvt_pk_bf16_f32 v178, v220, v221
  v_mfma_f32_16x16x32_bf16 v[156:159], a[148:151], v[84:87], v[156:159]
  v_exp_f32 v223, v135
  v_mfma_f32_16x16x32_bf16 v[144:147], a[152:155], v[88:91], v[144:147]
  ds_read_b128 a[184:187], v3 offset:30720
  v_add_f32 v226, v226, v222
  v_mfma_f32_16x16x32_bf16 v[152:155], a[152:155], v[92:95], v[152:155]
  v_exp_f32 v216, v136
  v_mfma_f32_16x16x32_bf16 v[148:151], a[156:159], v[88:91], v[148:151]
  ds_read_b128 a[188:191], v3 offset:31744
  v_add_f32 v226, v226, v223
  v_exp_f32 v217, v137
  v_mfma_f32_16x16x32_bf16 v[156:159], a[156:159], v[92:95], v[156:159]
  s_waitcnt lgkmcnt(4)
  v_exp_f32 v218, v138
  v_mfma_f32_16x16x32_bf16 a[64:67], a[160:163], v[184:187], a[64:67]
  ds_read_b128 a[128:131], v3 offset:8192
  v_cvt_pk_bf16_f32 v179, v222, v223
  v_mfma_f32_16x16x32_bf16 a[68:71], a[160:163], v[188:191], a[68:71]
  v_exp_f32 v219, v139
  v_mfma_f32_16x16x32_bf16 a[72:75], a[164:167], v[184:187], a[72:75]
  ds_read_b128 a[132:135], v3 offset:9216
  buffer_load_dwordx4 v2, s[48:51], s27 offen offset:2048 sc1 lds
  v_add_f32 v227, v216, v217
  v_mfma_f32_16x16x32_bf16 a[76:79], a[164:167], v[188:191], a[76:79]
  v_exp_f32 v220, v140
  v_mfma_f32_16x16x32_bf16 a[80:83], a[168:171], v[184:187], a[80:83]
  ds_read_b128 a[136:139], v3 offset:10240
  v_cvt_pk_bf16_f32 v180, v216, v217
  v_mfma_f32_16x16x32_bf16 a[84:87], a[168:171], v[188:191], a[84:87]
  v_exp_f32 v221, v141
  v_mfma_f32_16x16x32_bf16 a[88:91], a[172:175], v[184:187], a[88:91]
  ds_read_b128 a[140:143], v3 offset:11264
  v_add_f32 v227, v227, v218
  v_mfma_f32_16x16x32_bf16 a[92:95], a[172:175], v[188:191], a[92:95]
  s_waitcnt lgkmcnt(4)
  v_exp_f32 v222, v142
  v_mfma_f32_16x16x32_bf16 a[96:99], a[176:179], v[184:187], a[96:99]
  ds_read_b128 a[144:147], v3 offset:12288
  buffer_load_dwordx4 v2, s[48:51], s27 offen offset:3072 sc1 lds
  v_add_f32 v227, v227, v219
  v_cvt_pk_bf16_f32 v181, v218, v219
  v_mfma_f32_16x16x32_bf16 a[100:103], a[176:179], v[188:191], a[100:103]
  s_add_u32 s27, s27, 16384
  v_exp_f32 v223, v143
  v_mfma_f32_16x16x32_bf16 a[104:107], a[180:183], v[184:187], a[104:107]
  s_add_u32 s25, s25, 32768
  ds_read_b128 a[148:151], v3 offset:13312
  v_add_f32 v227, v227, v220
  v_mfma_f32_16x16x32_bf16 a[108:111], a[180:183], v[188:191], a[108:111]
  s_and_b32 s25, s25, 0x1ffff
  v_add_f32 v227, v227, v221
  v_cvt_pk_bf16_f32 v182, v220, v221
  v_add_f32 v227, v227, v222
  v_mfma_f32_16x16x32_bf16 a[112:115], a[184:187], v[184:187], a[112:115]
  s_sub_u32 s29, s29, 1
  ds_read_b128 a[152:155], v3 offset:14336
  v_add_f32 v227, v227, v223
  v_max_f32 v5, v226, v227
  v_cmp_lt_f32 vcc, s81, v5
  v_mfma_f32_16x16x32_bf16 a[116:119], a[184:187], v[188:191], a[116:119]
  s_cmp_gt_u32 s29, 8
  v_exp_f32 v216, v144
  v_mfma_f32_16x16x32_bf16 a[120:123], a[188:191], v[184:187], a[120:123]
  s_waitcnt lgkmcnt(3)
  ds_read_b128 a[156:159], v3 offset:15360
  v_cvt_pk_bf16_f32 v183, v222, v223
  v_add_u32 v3, s66, v2
  v_mfma_f32_16x16x32_bf16 a[124:127], a[188:191], v[188:191], a[124:127]
  s_cbranch_vccnz fa_stub11
fa_back11:
  v_exp_f32 v217, v145
  v_add_f32 v230, v230, v226
  v_add_f32 v231, v231, v227
  s_cbranch_scc1 fa_SS
fa_chain:
  s_setprio 3
fa_hb8:
  s_cmp_lt_u32 s12, 2
  s_cbranch_scc1 fa_hk8
  s_cmp_eq_u32 s29, 8
  s_cbranch_scc0 fa_disp
fa_SSW8:
  v_mfma_f32_16x16x32_bf16 v[128:131], a[128:131], v[64:67], v[200:203]
  s_waitcnt vmcnt(12)
  v_exp_f32 v218, v146
  v_mfma_f32_16x16x32_bf16 v[136:139], a[128:131], v[68:71], v[204:207]
  s_barrier
  v_exp_f32 v219, v147
  v_mfma_f32_16x16x32_bf16 v[132:135], a[132:135], v[64:67], v[200:203]
  ds_read_b128 a[160:163], v3 offset:16384
  ds_read_b128 a[164:167], v3 offset:17408
  v_add_f32 v226, v216, v217
  v_mfma_f32_16x16x32_bf16 v[140:143], a[132:135], v[68:71], v[204:207]
  s_mov_b32 m0, s24
  v_exp_f32 v220, v148
  v_mfma_f32_16x16x32_bf16 v[128:131], a[136:139], v[72:75], v[128:131]
  ds_read_b128 a[168:171], v3 offset:18432
  buffer_load_dwordx4 v2, s[44:47], s26 offen offset:0 sc1 lds
  v_cvt_pk_bf16_f32 v184, v216, v217
  v_mfma_f32_16x16x32_bf16 v[136:139], a[136:139], v[76:79], v[136:139]
  v_exp_f32 v221, v149
  v_mfma_f32_16x16x32_bf16 v[132:135], a[140:143], v[72:75], v[132:135]
  ds_read_b128 a[172:175], v3 offset:19456
  v_add_f32 v226, v226, v218
  v_add_f32 v226, v226, v219
  v_mfma_f32_16x16x32_bf16 v[140:143], a[140:143], v[76:79], v[140:143]
  s_waitcnt lgkmcnt(4)
  v_exp_f32 v222, v150
  v_mfma_f32_16x16x32_bf16 v[128:131], a[144:147], v[80:83], v[128:131]
  ds_read_b128 a[176:179], v3 offset:20480
  v_cvt_pk_bf16_f32 v185, v218, v219
  v_mfma_f32_16x16x32_bf16 v[136:139], a[144:147], v[84:87], v[136:139]
  v_exp_f32 v223, v151
  v_mfma_f32_16x16x32_bf16 v[132:135], a[148:151], v[80:83], v[132:135]
  ds_read_b128 a[180:183], v3 offset:21504
  buffer_load_dwordx4 v2, s[44:47], s26 offen offset:1024 sc1 lds
  v_add_f32 v226, v226, v220
  v_mfma_f32_16x16x32_bf16 v[140:143], a[148:151], v[84:87], v[140:143]
  v_exp_f32 v216, v152
  v_mfma_f32_16x16x32_bf16 v[128:131], a[152:155], v[88:91], v[128:131]
  ds_read_b128 a[184:187], v3 offset:22528
  v_add_f32 v226, v226, v221
  v_cvt_pk_bf16_f32 v186, v220, v221
  v_mfma_f32_16x16x32_bf16 v[136:139], a[152:155], v[92:95], v[136:139]
  v_exp_f32 v217, v153
  v_mfma_f32_16x16x32_bf16 v[132:135], a[156:159], v[88:91], v[132:135]
  s_add_u32 s14, s13, 77824
  ds_read_b128 a[188:191], v3 offset:23552
  buffer_load_dwordx4 a[252:255], v2, s[40:43], s14 offen offset:3072 sc1
  v_add_f32 v226, v226, v222
  v_mfma_f32_16x16x32_bf16 v[140:143], a[156:159], v[92:95], v[140:143]
  s_waitcnt lgkmcnt(4)
  v_exp_f32 v218, v154
  v_mfma_f32_16x16x32_bf16 a[64:67], a[160:163], v[176:179], a[64:67]
  ds_read_b128 a[128:131], v3 offset:0
  v_add_f32 v226, v226, v223
  v_cvt_pk_bf16_f32 v187, v222, v223
  v_mfma_f32_16x16x32_bf16 a[68:71], a[160:163], v[180:183], a[68:71]
  v_exp_f32 v219, v155
  v_mfma_f32_16x16x32_bf16 a[72:75], a[164:167], v[176:179], a[72:75]
  ds_read_b128 a[132:135], v3 offset:1024
  buffer_load_dwordx4 v2, s[44:47], s26 offen offset:2048 sc1 lds
  v_add_f32 v227, v216, v217
  v_mfma_f32_16x16x32_bf16 a[76:79], a[164:167], v[180:183], a[76:79]
  v_exp_f32 v220, v156
  v_mfma_f32_16x16x32_bf16 a[80:83], a[168:171], v[176:179], a[80:83]
  ds_read_b128 a[136:139], v3 offset:2048
  v_cvt_pk_bf16_f32 v188, v216, v217
  v_mfma_f32_16x16x32_bf16 a[84:87], a[168:171], v[180:183], a[84:87]
  v_exp_f32 v221, v157
  v_mfma_f32_16x16x32_bf16 a[88:91], a[172:175], v[176:179], a[88:91]
  ds_read_b128 a[140:143], v3 offset:3072
  v_add_f32 v227, v227, v218
  v_add_f32 v227, v227, v219
  v_mfma_f32_16x16x32_bf16 a[92:95], a[172:175], v[180:183], a[92:95]
  s_waitcnt lgkmcnt(4)
  v_exp_f32 v222, v158
  v_mfma_f32_16x16x32_bf16 a[96:99], a[176:179], v[176:179], a[96:99]
  ds_read_b128 a[144:147], v3 offset:4096
  buffer_load_dwordx4 v2, s[44:47], s26 offen offset:3072 sc1 lds
  v_cvt_pk_bf16_f32 v189, v218, v219
  v_mfma_f32_16x16x32_bf16 a[100:103], a[176:179], v[180:183], a[100:103]
  s_add_u32 s26, s26, 16384
  v_exp_f32 v223, v159
  v_mfma_f32_16x16x32_bf16 a[104:107], a[180:183], v[176:179], a[104:107]
  s_add_u32 s24, s24, 32768
  ds_read_b128 a[148:151], v3 offset:5120
  v_add_f32 v227, v227, v220
  v_mfma_f32_16x16x32_bf16 a[108:111], a[180:183], v[180:183], a[108:111]
  s_and_b32 s24, s24, 0x1ffff
  v_add_f32 v227, v227, v221
  v_cvt_pk_bf16_f32 v190, v220, v221
  v_add_f32 v227, v227, v222
  v_mfma_f32_16x16x32_bf16 a[112:115], a[184:187], v[176:179], a[112:115]
  ds_read_b128 a[152:155], v3 offset:6144
  v_add_f32 v227, v227, v223
  v_max_f32 v5, v226, v227
  v_cmp_lt_f32 vcc, s81, v5
  v_mfma_f32_16x16x32_bf16 a[116:119], a[184:187], v[180:183], a[116:119]
  v_exp_f32 v216, v128
  v_mfma_f32_16x16x32_bf16 a[120:123], a[188:191], v[176:179], a[120:123]
  s_waitcnt lgkmcnt(3)
  ds_read_b128 a[156:159], v3 offset:7168
  v_cvt_pk_bf16_f32 v191, v222, v223
  v_mfma_f32_16x16x32_bf16 a[124:127], a[188:191], v[180:183], a[124:127]
  s_cbranch_vccnz fa_stub12
fa_back12:
  v_exp_f32 v217, v129
  v_add_f32 v230, v230, v226
  v_add_f32 v231, v231, v227
  v_mfma_f32_16x16x32_bf16 v[144:147], a[128:131], v[64:67], v[200:203]
  ds_read_b128 a[160:163], v3 offset:24576
  v_add_f32 v226, v216, v217
  v_mfma_f32_16x16x32_bf16 v[152:155], a[128:131], v[68:71], v[204:207]
  v_exp_f32 v218, v130
  v_mfma_f32_16x16x32_bf16 v[148:151], a[132:135], v[64:67], v[200:203]
  s_add_u32 s66, s66, 32768
  ds_read_b128 a[164:167], v3 offset:25600
  v_cvt_pk_bf16_f32 v176, v216, v217
  v_mfma_f32_16x16x32_bf16 v[156:159], a[132:135], v[68:71], v[204:207]
  s_mov_b32 m0, s25
  v_exp_f32 v219, v131
  v_mfma_f32_16x16x32_bf16 v[144:147], a[136:139], v[72:75], v[144:147]
  s_and_b32 s66, s66, 0x1ffff
  ds_read_b128 a[168:171], v3 offset:26624
  buffer_load_dwordx4 v2, s[48:51], s27 offen offset:0 sc1 lds
  v_add_f32 v226, v226, v218
  v_add_f32 v226, v226, v219
  v_mfma_f32_16x16x32_bf16 v[152:155], a[136:139], v[76:79], v[152:155]
  v_exp_f32 v220, v132
  v_mfma_f32_16x16x32_bf16 v[148:151], a[140:143], v[72:75], v[148:151]
  ds_read_b128 a[172:175], v3 offset:27648
  v_cvt_pk_bf16_f32 v177, v218, v219
  v_mfma_f32_16x16x32_bf16 v[156:159], a[140:143], v[76:79], v[156:159]
  s_waitcnt lgkmcnt(4)
  v_exp_f32 v221, v133
  v_mfma_f32_16x16x32_bf16 v[144:147], a[144:147], v[80:83], v[144:147]
  s_add_u32 s14, s13, 77824
  ds_read_b128 a[176:179], v3 offset:28672
  buffer_load_dwordx4 a[248:251], v2, s[40:43], s14 offen offset:2048 sc1
  v_add_f32 v226, v226, v220
  v_mfma_f32_16x16x32_bf16 v[152:155], a[144:147], v[84:87], v[152:155]
  v_exp_f32 v222, v134
  v_mfma_f32_16x16x32_bf16 v[148:151], a[148:151], v[80:83], v[148:151]
  ds_read_b128 a[180:183], v3 offset:29696
  buffer_load_dwordx4 v2, s[48:51], s27 offen offset:1024 sc1 lds
  v_add_f32 v226, v226, v221
  v_cvt_pk_bf16_f32 v178, v220, v221
  v_mfma_f32_16x16x32_bf16 v[156:159], a[148:151], v[84:87], v[156:159]
  v_exp_f32 v223, v135
  v_mfma_f32_16x16x32_bf16 v[144:147], a[152:155], v[88:91], v[144:147]
  ds_read_b128 a[184:187], v3 offset:30720
  v_add_f32 v226, v226, v222
  v_mfma_f32_16x16x32_bf16 v[152:155], a[152:155], v[92:95], v[152:155]
  v_exp_f32 v216, v136
  v_mfma_f32_16x16x32_bf16 v[148:151], a[156:159], v[88:91], v[148:151]
  ds_read_b128 a[188:191], v3 offset:31744
  v_add_f32 v226, v226, v223
  v_exp_f32 v217, v137
  v_mfma_f32_16x16x32_bf16 v[156:159], a[156:159], v[92:95], v[156:159]
  s_waitcnt lgkmcnt(4)
  v_exp_f32 v218, v138
  v_mfma_f32_16x16x32_bf16 a[64:67], a[160:163], v[184:187], a[64:67]
  ds_read_b128 a[128:131], v3 offset:8192
  v_cvt_pk_bf16_f32 v179, v222, v223
  v_mfma_f32_16x16x32_bf16 a[68:71], a[160:163], v[188:191], a[68:71]
  v_exp_f32 v219, v139
  v_mfma_f32_16x16x32_bf16 a[72:75], a[164:167], v[184:187], a[72:75]
  ds_read_b128 a[132:135], v3 offset:9216
  buffer_load_dwordx4 v2, s[48:51], s27 offen offset:2048 sc1 lds
  v_add_f32 v227, v216, v217
  v_mfma_f32_16x16x32_bf16 a[76:79], a[164:167], v[188:191], a[76:79]
  v_exp_f32 v220, v140
  v_mfma_f32_16x16x32_bf16 a[80:83], a[168:171], v[184:187], a[80:83]
  ds_read_b128 a[136:139], v3 offset:10240
  v_cvt_pk_bf16_f32 v180, v216, v217
  v_mfma_f32_16x16x32_bf16 a[84:87], a[168:171], v[188:191], a[84:87]
  v_exp_f32 v221, v141
  v_mfma_f32_16x16x32_bf16 a[88:91], a[172:175], v[184:187], a[88:91]
  ds_read_b128 a[140:143], v3 offset:11264
  buffer_load_dwordx4 a[244:247], v2, s[40:43], s14 offen offset:1024 sc1
  v_add_f32 v227, v227, v218
  v_mfma_f32_16x16x32_bf16 a[92:95], a[172:175], v[188:191], a[92:95]
  s_waitcnt lgkmcnt(4)
  v_exp_f32 v222, v142
  v_mfma_f32_16x16x32_bf16 a[96:99], a[176:179], v[184:187], a[96:99]
  ds_read_b128 a[144:147], v3 offset:12288
  buffer_load_dwordx4 v2, s[48:51], s27 offen offset:3072 sc1 lds
  v_add_f32 v227, v227, v219
  v_cvt_pk_bf16_f32 v181, v218, v219
  v_mfma_f32_16x16x32_bf16 a[100:103], a[176:179], v[188:191], a[100:103]
  s_add_u32 s27, s27, 16384
  v_exp_f32 v223, v143
  v_mfma_f32_16x16x32_bf16 a[104:107], a[180:183], v[184:187], a[104:107]
  s_add_u32 s25, s25, 32768
  ds_read_b128 a[148:151], v3 offset:13312
  v_add_f32 v227, v227, v220
  v_mfma_f32_16x16x32_bf16 a[108:111], a[180:183], v[188:191], a[108:111]
  s_and_b32 s25, s25, 0x1ffff
  v_add_f32 v227, v227, v221
  v_cvt_pk_bf16_f32 v182, v220, v221
  v_add_f32 v227, v227, v222
  v_mfma_f32_16x16x32_bf16 a[112:115], a[184:187], v[184:187], a[112:115]
  ds_read_b128 a[152:155], v3 offset:14336
  v_add_f32 v227, v227, v223
  v_max_f32 v5, v226, v227
  v_cmp_lt_f32 vcc, s81, v5
  v_mfma_f32_16x16x32_bf16 a[116:119], a[184:187], v[188:191], a[116:119]
  v_exp_f32 v216, v144
  v_mfma_f32_16x16x32_bf16 a[120:123], a[188:191], v[184:187], a[120:123]
  s_waitcnt lgkmcnt(3)
  ds_read_b128 a[156:159], v3 offset:15360
  v_cvt_pk_bf16_f32 v183, v222, v223
  v_add_u32 v3, s66, v2
  v_mfma_f32_16x16x32_bf16 a[124:127], a[188:191], v[188:191], a[124:127]
  s_cbranch_vccnz fa_stub13
fa_back13:
  v_exp_f32 v217, v145
  v_add_f32 v230, v230, v226
  v_add_f32 v231, v231, v227
fa_SSW7:
  v_mfma_f32_16x16x32_bf16 v[128:131], a[128:131], v[64:67], v[200:203]
  s_waitcnt vmcnt(12)
  v_exp_f32 v218, v146
  v_mfma_f32_16x16x32_bf16 v[136:139], a[128:131], v[68:71], v[204:207]
  s_barrier
  v_exp_f32 v219, v147
  v_mfma_f32_16x16x32_bf16 v[132:135], a[132:135], v[64:67], v[200:203]
  ds_read_b128 a[160:163], v3 offset:16384
  ds_read_b128 a[164:167], v3 offset:17408
  v_add_f32 v226, v216, v217
  v_mfma_f32_16x16x32_bf16 v[140:143], a[132:135], v[68:71], v[204:207]
  s_mov_b32 m0, s24
  v_exp_f32 v220, v148
  v_mfma_f32_16x16x32_bf16 v[128:131], a[136:139], v[72:75], v[128:131]
  ds_read_b128 a[168:171], v3 offset:18432
  buffer_load_dwordx4 v2, s[44:47], s26 offen offset:0 sc1 lds
  v_cvt_pk_bf16_f32 v184, v216, v217
  v_mfma_f32_16x16x32_bf16 v[136:139], a[136:139], v[76:79], v[136:139]
  v_exp_f32 v221, v149
  v_mfma_f32_16x16x32_bf16 v[132:135], a[140:143], v[72:75], v[132:135]
  ds_read_b128 a[172:175], v3 offset:19456
  v_add_f32 v226, v226, v218
  v_add_f32 v226, v226, v219
  v_mfma_f32_16x16x32_bf16 v[140:143], a[140:143], v[76:79], v[140:143]
  s_waitcnt lgkmcnt(4)
  v_exp_f32 v222, v150
  v_mfma_f32_16x16x32_bf16 v[128:131], a[144:147], v[80:83], v[128:131]
  ds_read_b128 a[176:179], v3 offset:20480
  v_cvt_pk_bf16_f32 v185, v218, v219
  v_mfma_f32_16x16x32_bf16 v[136:139], a[144:147], v[84:87], v[136:139]
  v_exp_f32 v223, v151
  v_mfma_f32_16x16x32_bf16 v[132:135], a[148:151], v[80:83], v[132:135]
  ds_read_b128 a[180:183], v3 offset:21504
  buffer_load_dwordx4 v2, s[44:47], s26 offen offset:1024 sc1 lds
  v_add_f32 v226, v226, v220
  v_mfma_f32_16x16x32_bf16 v[140:143], a[148:151], v[84:87], v[140:143]
  v_exp_f32 v216, v152
  v_mfma_f32_16x16x32_bf16 v[128:131], a[152:155], v[88:91], v[128:131]
  ds_read_b128 a[184:187], v3 offset:22528
  v_add_f32 v226, v226, v221
  v_cvt_pk_bf16_f32 v186, v220, v221
  v_mfma_f32_16x16x32_bf16 v[136:139], a[152:155], v[92:95], v[136:139]
  v_exp_f32 v217, v153
  v_mfma_f32_16x16x32_bf16 v[132:135], a[156:159], v[88:91], v[132:135]
  s_add_u32 s14, s13, 77824
  ds_read_b128 a[188:191], v3 offset:23552
  buffer_load_dwordx4 a[240:243], v2, s[40:43], s14 offen offset:0 sc1
  v_add_f32 v226, v226, v222
  v_mfma_f32_16x16x32_bf16 v[140:143], a[156:159], v[92:95], v[140:143]
  s_waitcnt lgkmcnt(4)
  v_exp_f32 v218, v154
  v_mfma_f32_16x16x32_bf16 a[64:67], a[160:163], v[176:179], a[64:67]
  ds_read_b128 a[128:131], v3 offset:0
  v_add_f32 v226, v226, v223
  v_cvt_pk_bf16_f32 v187, v222, v223
  v_mfma_f32_16x16x32_bf16 a[68:71], a[160:163], v[180:183], a[68:71]
  v_exp_f32 v219, v155
  v_mfma_f32_16x16x32_bf16 a[72:75], a[164:167], v[176:179], a[72:75]
  ds_read_b128 a[132:135], v3 offset:1024
  buffer_load_dwordx4 v2, s[44:47], s26 offen offset:2048 sc1 lds
  v_add_f32 v227, v216, v217
  v_mfma_f32_16x16x32_bf16 a[76:79], a[164:167], v[180:183], a[76:79]
  v_exp_f32 v220, v156
  v_mfma_f32_16x16x32_bf16 a[80:83], a[168:171], v[176:179], a[80:83]
  ds_read_b128 a[136:139], v3 offset:2048
  v_cvt_pk_bf16_f32 v188, v216, v217
  v_mfma_f32_16x16x32_bf16 a[84:87], a[168:171], v[180:183], a[84:87]
  v_exp_f32 v221, v157
  v_mfma_f32_16x16x32_bf16 a[88:91], a[172:175], v[176:179], a[88:91]
  ds_read_b128 a[140:143], v3 offset:3072
  v_add_f32 v227, v227, v218
  v_add_f32 v227, v227, v219
  v_mfma_f32_16x16x32_bf16 a[92:95], a[172:175], v[180:183], a[92:95]
  s_waitcnt lgkmcnt(4)
  v_exp_f32 v222, v158
  v_mfma_f32_16x16x32_bf16 a[96:99], a[176:179], v[176:179], a[96:99]
  ds_read_b128 a[144:147], v3 offset:4096
  buffer_load_dwordx4 v2, s[44:47], s26 offen offset:3072 sc1 lds
  v_cvt_pk_bf16_f32 v189, v218, v219
  v_mfma_f32_16x16x32_bf16 a[100:103], a[176:179], v[180:183], a[100:103]
  s_add_u32 s26, s26, 16384
  v_exp_f32 v223, v159
  v_mfma_f32_16x16x32_bf16 a[104:107], a[180:183], v[176:179], a[104:107]
  s_add_u32 s24, s24, 32768
  ds_read_b128 a[148:151], v3 offset:5120
  v_add_f32 v227, v227, v220
  v_mfma_f32_16x16x32_bf16 a[108:111], a[180:183], v[180:183], a[108:111]
  s_and_b32 s24, s24, 0x1ffff
  v_add_f32 v227, v227, v221
  v_cvt_pk_bf16_f32 v190, v220, v221
  v_add_f32 v227, v227, v222
  v_mfma_f32_16x16x32_bf16 a[112:115], a[184:187], v[176:179], a[112:115]
  ds_read_b128 a[152:155], v3 offset:6144
  v_add_f32 v227, v227, v223
  v_max_f32 v5, v226, v227
  v_cmp_lt_f32 vcc, s81, v5
  v_mfma_f32_16x16x32_bf16 a[116:119], a[184:187], v[180:183], a[116:119]
  v_exp_f32 v216, v128
  v_mfma_f32_16x16x32_bf16 a[120:123], a[188:191], v[176:179], a[120:123]
  s_waitcnt lgkmcnt(3)
  ds_read_b128 a[156:159], v3 offset:7168
  v_cvt_pk_bf16_f32 v191, v222, v223
  v_mfma_f32_16x16x32_bf16 a[124:127], a[188:191], v[180:183], a[124:127]
  s_cbranch_vccnz fa_stub14
fa_back14:
  v_exp_f32 v217, v129
  v_add_f32 v230, v230, v226
  v_add_f32 v231, v231, v227
  v_mfma_f32_16x16x32_bf16 v[144:147], a[128:131], v[64:67], v[200:203]
  ds_read_b128 a[160:163], v3 offset:24576
  v_add_f32 v226, v216, v217
  v_mfma_f32_16x16x32_bf16 v[152:155], a[128:131], v[68:71], v[204:207]
  v_exp_f32 v218, v130
  v_mfma_f32_16x16x32_bf16 v[148:151], a[132:135], v[64:67], v[200:203]
  s_add_u32 s66, s66, 32768
  ds_read_b128 a[164:167], v3 offset:25600
  v_cvt_pk_bf16_f32 v176, v216, v217
  v_mfma_f32_16x16x32_bf16 v[156:159], a[132:135], v[68:71], v[204:207]
  s_mov_b32 m0, s25
  v_exp_f32 v219, v131
  v_mfma_f32_16x16x32_bf16 v[144:147], a[136:139], v[72:75], v[144:147]
  s_and_b32 s66, s66, 0x1ffff
  ds_read_b128 a[168:171], v3 offset:26624
  buffer_load_dwordx4 v2, s[48:51], s27 offen offset:0 sc1 lds
  v_add_f32 v226, v226, v218
  v_add_f32 v226, v226, v219
  v_mfma_f32_16x16x32_bf16 v[152:155], a[136:139], v[76:79], v[152:155]
  v_exp_f32 v220, v132
  v_mfma_f32_16x16x32_bf16 v[148:151], a[140:143], v[72:75], v[148:151]
  ds_read_b128 a[172:175], v3 offset:27648
  v_cvt_pk_bf16_f32 v177, v218, v219
  v_mfma_f32_16x16x32_bf16 v[156:159], a[140:143], v[76:79], v[156:159]
  s_waitcnt lgkmcnt(4)
  v_exp_f32 v221, v133
  v_mfma_f32_16x16x32_bf16 v[144:147], a[144:147], v[80:83], v[144:147]
  s_add_u32 s14, s13, 73728
  ds_read_b128 a[176:179], v3 offset:28672
  buffer_load_dwordx4 a[236:239], v2, s[40:43], s14 offen offset:3072 sc1
  v_add_f32 v226, v226, v220
  v_mfma_f32_16x16x32_bf16 v[152:155], a[144:147], v[84:87], v[152:155]
  v_exp_f32 v222, v134
  v_mfma_f32_16x16x32_bf16 v[148:151], a[148:151], v[80:83], v[148:151]
  ds_read_b128 a[180:183], v3 offset:29696
  buffer_load_dwordx4 v2, s[48:51], s27 offen offset:1024 sc1 lds
  v_add_f32 v226, v226, v221
  v_cvt_pk_bf16_f32 v178, v220, v221
  v_mfma_f32_16x16x32_bf16 v[156:159], a[148:151], v[84:87], v[156:159]
  v_exp_f32 v223, v135
  v_mfma_f32_16x16x32_bf16 v[144:147], a[152:155], v[88:91], v[144:147]
  ds_read_b128 a[184:187], v3 offset:30720
  v_add_f32 v226, v226, v222
  v_mfma_f32_16x16x32_bf16 v[152:155], a[152:155], v[92:95], v[152:155]
  v_exp_f32 v216, v136
  v_mfma_f32_16x16x32_bf16 v[148:151], a[156:159], v[88:91], v[148:151]
  ds_read_b128 a[188:191], v3 offset:31744
  v_add_f32 v226, v226, v223
  v_exp_f32 v217, v137
  v_mfma_f32_16x16x32_bf16 v[156:159], a[156:159], v[92:95], v[156:159]
  s_waitcnt lgkmcnt(4)
  v_exp_f32 v218, v138
  v_mfma_f32_16x16x32_bf16 a[64:67], a[160:163], v[184:187], a[64:67]
  ds_read_b128 a[128:131], v3 offset:8192
  v_cvt_pk_bf16_f32 v179, v222, v223
  v_mfma_f32_16x16x32_bf16 a[68:71], a[160:163], v[188:191], a[68:71]
  v_exp_f32 v219, v139
  v_mfma_f32_16x16x32_bf16 a[72:75], a[164:167], v[184:187], a[72:75]
  ds_read_b128 a[132:135], v3 offset:9216
  buffer_load_dwordx4 v2, s[48:51], s27 offen offset:2048 sc1 lds
  v_add_f32 v227, v216, v217
  v_mfma_f32_16x16x32_bf16 a[76:79], a[164:167], v[188:191], a[76:79]
  v_exp_f32 v220, v140
  v_mfma_f32_16x16x32_bf16 a[80:83], a[168:171], v[184:187], a[80:83]
  ds_read_b128 a[136:139], v3 offset:10240
  v_cvt_pk_bf16_f32 v180, v216, v217
  v_mfma_f32_16x16x32_bf16 a[84:87], a[168:171], v[188:191], a[84:87]
  v_exp_f32 v221, v141
  v_mfma_f32_16x16x32_bf16 a[88:91], a[172:175], v[184:187], a[88:91]
  ds_read_b128 a[140:143], v3 offset:11264
  buffer_load_dwordx4 a[232:235], v2, s[40:43], s14 offen offset:2048 sc1
  v_add_f32 v227, v227, v218
  v_mfma_f32_16x16x32_bf16 a[92:95], a[172:175], v[188:191], a[92:95]
  s_waitcnt lgkmcnt(4)
  v_exp_f32 v222, v142
  v_mfma_f32_16x16x32_bf16 a[96:99], a[176:179], v[184:187], a[96:99]
  ds_read_b128 a[144:147], v3 offset:12288
  buffer_load_dwordx4 v2, s[48:51], s27 offen offset:3072 sc1 lds
  v_add_f32 v227, v227, v219
  v_cvt_pk_bf16_f32 v181, v218, v219
  v_mfma_f32_16x16x32_bf16 a[100:103], a[176:179], v[188:191], a[100:103]
  s_add_u32 s27, s27, 16384
  v_exp_f32 v223, v143
  v_mfma_f32_16x16x32_bf16 a[104:107], a[180:183], v[184:187], a[104:107]
  s_add_u32 s25, s25, 32768
  ds_read_b128 a[148:151], v3 offset:13312
  v_add_f32 v227, v227, v220
  v_mfma_f32_16x16x32_bf16 a[108:111], a[180:183], v[188:191], a[108:111]
  s_and_b32 s25, s25, 0x1ffff
  v_add_f32 v227, v227, v221
  v_cvt_pk_bf16_f32 v182, v220, v221
  v_add_f32 v227, v227, v222
  v_mfma_f32_16x16x32_bf16 a[112:115], a[184:187], v[184:187], a[112:115]
  ds_read_b128 a[152:155], v3 offset:14336
  v_add_f32 v227, v227, v223
  v_max_f32 v5, v226, v227
  v_cmp_lt_f32 vcc, s81, v5
  v_mfma_f32_16x16x32_bf16 a[116:119], a[184:187], v[188:191], a[116:119]
  v_exp_f32 v216, v144
  v_mfma_f32_16x16x32_bf16 a[120:123], a[188:191], v[184:187], a[120:123]
  s_waitcnt lgkmcnt(3)
  ds_read_b128 a[156:159], v3 offset:15360
  v_cvt_pk_bf16_f32 v183, v222, v223
  v_add_u32 v3, s66, v2
  v_mfma_f32_16x16x32_bf16 a[124:127], a[188:191], v[188:191], a[124:127]
  s_cbranch_vccnz fa_stub15
fa_back15:
  v_exp_f32 v217, v145
  v_add_f32 v230, v230, v226
  v_add_f32 v231, v231, v227
fa_SSW6:
  v_mfma_f32_16x16x32_bf16 v[128:131], a[128:131], v[64:67], v[200:203]
  s_waitcnt vmcnt(12)
  v_exp_f32 v218, v146
  v_mfma_f32_16x16x32_bf16 v[136:139], a[128:131], v[68:71], v[204:207]
  s_barrier
  v_exp_f32 v219, v147
  v_mfma_f32_16x16x32_bf16 v[132:135], a[132:135], v[64:67], v[200:203]
  ds_read_b128 a[160:163], v3 offset:16384
  ds_read_b128 a[164:167], v3 offset:17408
  v_add_f32 v226, v216, v217
  v_mfma_f32_16x16x32_bf16 v[140:143], a[132:135], v[68:71], v[204:207]
  s_mov_b32 m0, s24
  v_exp_f32 v220, v148
  v_mfma_f32_16x16x32_bf16 v[128:131], a[136:139], v[72:75], v[128:131]
  ds_read_b128 a[168:171], v3 offset:18432
  buffer_load_dwordx4 v2, s[44:47], s26 offen offset:0 sc1 lds
  v_cvt_pk_bf16_f32 v184, v216, v217
  v_mfma_f32_16x16x32_bf16 v[136:139], a[136:139], v[76:79], v[136:139]
  v_exp_f32 v221, v149
  v_mfma_f32_16x16x32_bf16 v[132:135], a[140:143], v[72:75], v[132:135]
  ds_read_b128 a[172:175], v3 offset:19456
  v_add_f32 v226, v226, v218
  v_add_f32 v226, v226, v219
  v_mfma_f32_16x16x32_bf16 v[140:143], a[140:143], v[76:79], v[140:143]
  s_waitcnt lgkmcnt(4)
  v_exp_f32 v222, v150
  v_mfma_f32_16x16x32_bf16 v[128:131], a[144:147], v[80:83], v[128:131]
  s_add_u32 s14, s13, 73728
  ds_read_b128 a[176:179], v3 offset:20480
  buffer_load_dwordx4 a[228:231], v2, s[40:43], s14 offen offset:1024 sc1
  v_cvt_pk_bf16_f32 v185, v218, v219
  v_mfma_f32_16x16x32_bf16 v[136:139], a[144:147], v[84:87], v[136:139]
  v_exp_f32 v223, v151
  v_mfma_f32_16x16x32_bf16 v[132:135], a[148:151], v[80:83], v[132:135]
  ds_read_b128 a[180:183], v3 offset:21504
  buffer_load_dwordx4 v2, s[44:47], s26 offen offset:1024 sc1 lds
  v_add_f32 v226, v226, v220
  v_mfma_f32_16x16x32_bf16 v[140:143], a[148:151], v[84:87], v[140:143]
  v_exp_f32 v216, v152
  v_mfma_f32_16x16x32_bf16 v[128:131], a[152:155], v[88:91], v[128:131]
  ds_read_b128 a[184:187], v3 offset:22528
  v_add_f32 v226, v226, v221
  v_cvt_pk_bf16_f32 v186, v220, v221
  v_mfma_f32_16x16x32_bf16 v[136:139], a[152:155], v[92:95], v[136:139]
  v_exp_f32 v217, v153
  v_mfma_f32_16x16x32_bf16 v[132:135], a[156:159], v[88:91], v[132:135]
  ds_read_b128 a[188:191], v3 offset:23552
  v_add_f32 v226, v226, v222
  v_mfma_f32_16x16x32_bf16 v[140:143], a[156:159], v[92:95], v[140:143]
  s_waitcnt lgkmcnt(4)
  v_exp_f32 v218, v154
  v_mfma_f32_16x16x32_bf16 a[64:67], a[160:163], v[176:179], a[64:67]
  ds_read_b128 a[128:131], v3 offset:0
  v_add_f32 v226, v226, v223
  v_cvt_pk_bf16_f32 v187, v222, v223
  v_mfma_f32_16x16x32_bf16 a[68:71], a[160:163], v[180:183], a[68:71]
  v_exp_f32 v219, v155
  v_mfma_f32_16x16x32_bf16 a[72:75], a[164:167], v[176:179], a[72:75]
  ds_read_b128 a[132:135], v3 offset:1024
  buffer_load_dwordx4 v2, s[44:47], s26 offen offset:2048 sc1 lds
  v_add_f32 v227, v216, v217
  v_mfma_f32_16x16x32_bf16 a[76:79], a[164:167], v[180:183], a[76:79]
  v_exp_f32 v220, v156
  v_mfma_f32_16x16x32_bf16 a[80:83], a[168:171], v[176:179], a[80:83]
  ds_read_b128 a[136:139], v3 offset:2048
  v_cvt_pk_bf16_f32 v188, v216, v217
  v_mfma_f32_16x16x32_bf16 a[84:87], a[168:171], v[180:183], a[84:87]
  v_exp_f32 v221, v157
  v_mfma_f32_16x16x32_bf16 a[88:91], a[172:175], v[176:179], a[88:91]
  ds_read_b128 a[140:143], v3 offset:3072
  buffer_load_dwordx4 a[224:227], v2, s[40:43], s14 offen offset:0 sc1
  v_add_f32 v227, v227, v218
  v_add_f32 v227, v227, v219
  v_mfma_f32_16x16x32_bf16 a[92:95], a[172:175], v[180:183], a[92:95]
  s_waitcnt lgkmcnt(4)
  v_exp_f32 v222, v158
  v_mfma_f32_16x16x32_bf16 a[96:99], a[176:179], v[176:179], a[96:99]
  ds_read_b128 a[144:147], v3 offset:4096
  buffer_load_dwordx4 v2, s[44:47], s26 offen offset:3072 sc1 lds
  v_cvt_pk_bf16_f32 v189, v218, v219
  v_mfma_f32_16x16x32_bf16 a[100:103], a[176:179], v[180:183], a[100:103]
  s_add_u32 s26, s26, 16384
  v_exp_f32 v223, v159
  v_mfma_f32_16x16x32_bf16 a[104:107], a[180:183], v[176:179], a[104:107]
  s_add_u32 s24, s24, 32768
  ds_read_b128 a[148:151], v3 offset:5120
  v_add_f32 v227, v227, v220
  v_mfma_f32_16x16x32_bf16 a[108:111], a[180:183], v[180:183], a[108:111]
  s_and_b32 s24, s24, 0x1ffff
  v_add_f32 v227, v227, v221
  v_cvt_pk_bf16_f32 v190, v220, v221
  v_add_f32 v227, v227, v222
  v_mfma_f32_16x16x32_bf16 a[112:115], a[184:187], v[176:179], a[112:115]
  ds_read_b128 a[152:155], v3 offset:6144
  v_add_f32 v227, v227, v223
  v_max_f32 v5, v226, v227
  v_cmp_lt_f32 vcc, s81, v5
  v_mfma_f32_16x16x32_bf16 a[116:119], a[184:187], v[180:183], a[116:119]
  v_exp_f32 v216, v128
  v_mfma_f32_16x16x32_bf16 a[120:123], a[188:191], v[176:179], a[120:123]
  s_waitcnt lgkmcnt(3)
  ds_read_b128 a[156:159], v3 offset:7168
  v_cvt_pk_bf16_f32 v191, v222, v223
  v_mfma_f32_16x16x32_bf16 a[124:127], a[188:191], v[180:183], a[124:127]
  s_cbranch_vccnz fa_stub16
fa_back16:
  v_exp_f32 v217, v129
  v_add_f32 v230, v230, v226
  v_add_f32 v231, v231, v227
  v_mfma_f32_16x16x32_bf16 v[144:147], a[128:131], v[64:67], v[200:203]
  ds_read_b128 a[160:163], v3 offset:24576
  v_add_f32 v226, v216, v217
  v_mfma_f32_16x16x32_bf16 v[152:155], a[128:131], v[68:71], v[204:207]
  v_exp_f32 v218, v130
  v_mfma_f32_16x16x32_bf16 v[148:151], a[132:135], v[64:67], v[200:203]
  s_add_u32 s66, s66, 32768
  ds_read_b128 a[164:167], v3 offset:25600
  v_cvt_pk_bf16_f32 v176, v216, v217
  v_mfma_f32_16x16x32_bf16 v[156:159], a[132:135], v[68:71], v[204:207]
  s_mov_b32 m0, s25
  v_exp_f32 v219, v131
  v_mfma_f32_16x16x32_bf16 v[144:147], a[136:139], v[72:75], v[144:147]
  s_and_b32 s66, s66, 0x1ffff
  ds_read_b128 a[168:171], v3 offset:26624
  buffer_load_dwordx4 v2, s[48:51], s27 offen offset:0 sc1 lds
  v_add_f32 v226, v226, v218
  v_add_f32 v226, v226, v219
  v_mfma_f32_16x16x32_bf16 v[152:155], a[136:139], v[76:79], v[152:155]
  v_exp_f32 v220, v132
  v_mfma_f32_16x16x32_bf16 v[148:151], a[140:143], v[72:75], v[148:151]
  ds_read_b128 a[172:175], v3 offset:27648
  v_cvt_pk_bf16_f32 v177, v218, v219
  v_mfma_f32_16x16x32_bf16 v[156:159], a[140:143], v[76:79], v[156:159]
  s_waitcnt lgkmcnt(4)
  v_exp_f32 v221, v133
  v_mfma_f32_16x16x32_bf16 v[144:147], a[144:147], v[80:83], v[144:147]
  s_add_u32 s14, s13, 69632
  ds_read_b128 a[176:179], v3 offset:28672
  buffer_load_dwordx4 a[220:223], v2, s[40:43], s14 offen offset:3072 sc1
  v_add_f32 v226, v226, v220
  v_mfma_f32_16x16x32_bf16 v[152:155], a[144:147], v[84:87], v[152:155]
  v_exp_f32 v222, v134
  v_mfma_f32_16x16x32_bf16 v[148:151], a[148:151], v[80:83], v[148:151]
  ds_read_b128 a[180:183], v3 offset:29696
  buffer_load_dwordx4 v2, s[48:51], s27 offen offset:1024 sc1 lds
  v_add_f32 v226, v226, v221
  v_cvt_pk_bf16_f32 v178, v220, v221
  v_mfma_f32_16x16x32_bf16 v[156:159], a[148:151], v[84:87], v[156:159]
  v_exp_f32 v223, v135
  v_mfma_f32_16x16x32_bf16 v[144:147], a[152:155], v[88:91], v[144:147]
  ds_read_b128 a[184:187], v3 offset:30720
  v_add_f32 v226, v226, v222
  v_mfma_f32_16x16x32_bf16 v[152:155], a[152:155], v[92:95], v[152:155]
  v_exp_f32 v216, v136
  v_mfma_f32_16x16x32_bf16 v[148:151], a[156:159], v[88:91], v[148:151]
  ds_read_b128 a[188:191], v3 offset:31744
  v_add_f32 v226, v226, v223
  v_exp_f32 v217, v137
  v_mfma_f32_16x16x32_bf16 v[156:159], a[156:159], v[92:95], v[156:159]
  s_waitcnt lgkmcnt(4)
  v_exp_f32 v218, v138
  v_mfma_f32_16x16x32_bf16 a[64:67], a[160:163], v[184:187], a[64:67]
  ds_read_b128 a[128:131], v3 offset:8192
  v_cvt_pk_bf16_f32 v179, v222, v223
  v_mfma_f32_16x16x32_bf16 a[68:71], a[160:163], v[188:191], a[68:71]
  v_exp_f32 v219, v139
  v_mfma_f32_16x16x32_bf16 a[72:75], a[164:167], v[184:187], a[72:75]
  ds_read_b128 a[132:135], v3 offset:9216
  buffer_load_dwordx4 v2, s[48:51], s27 offen offset:2048 sc1 lds
  v_add_f32 v227, v216, v217
  v_mfma_f32_16x16x32_bf16 a[76:79], a[164:167], v[188:191], a[76:79]
  v_exp_f32 v220, v140
  v_mfma_f32_16x16x32_bf16 a[80:83], a[168:171], v[184:187], a[80:83]
  ds_read_b128 a[136:139], v3 offset:10240
  v_cvt_pk_bf16_f32 v180, v216, v217
  v_mfma_f32_16x16x32_bf16 a[84:87], a[168:171], v[188:191], a[84:87]
  v_exp_f32 v221, v141
  v_mfma_f32_16x16x32_bf16 a[88:91], a[172:175], v[184:187], a[88:91]
  ds_read_b128 a[140:143], v3 offset:11264
  buffer_load_dwordx4 a[216:219], v2, s[40:43], s14 offen offset:2048 sc1
  v_add_f32 v227, v227, v218
  v_mfma_f32_16x16x32_bf16 a[92:95], a[172:175], v[188:191], a[92:95]
  s_waitcnt lgkmcnt(4)
  v_exp_f32 v222, v142
  v_mfma_f32_16x16x32_bf16 a[96:99], a[176:179], v[184:187], a[96:99]
  ds_read_b128 a[144:147], v3 offset:12288
  buffer_load_dwordx4 v2, s[48:51], s27 offen offset:3072 sc1 lds
  v_add_f32 v227, v227, v219
  v_cvt_pk_bf16_f32 v181, v218, v219
  v_mfma_f32_16x16x32_bf16 a[100:103], a[176:179], v[188:191], a[100:103]
  s_add_u32 s27, s27, 16384
  v_exp_f32 v223, v143
  v_mfma_f32_16x16x32_bf16 a[104:107], a[180:183], v[184:187], a[104:107]
  s_add_u32 s25, s25, 32768
  ds_read_b128 a[148:151], v3 offset:13312
  v_add_f32 v227, v227, v220
  v_mfma_f32_16x16x32_bf16 a[108:111], a[180:183], v[188:191], a[108:111]
  s_and_b32 s25, s25, 0x1ffff
  v_add_f32 v227, v227, v221
  v_cvt_pk_bf16_f32 v182, v220, v221
  v_add_f32 v227, v227, v222
  v_mfma_f32_16x16x32_bf16 a[112:115], a[184:187], v[184:187], a[112:115]
  ds_read_b128 a[152:155], v3 offset:14336
  v_add_f32 v227, v227, v223
  v_max_f32 v5, v226, v227
  v_cmp_lt_f32 vcc, s81, v5
  v_mfma_f32_16x16x32_bf16 a[116:119], a[184:187], v[188:191], a[116:119]
  v_exp_f32 v216, v144
  v_mfma_f32_16x16x32_bf16 a[120:123], a[188:191], v[184:187], a[120:123]
  s_waitcnt lgkmcnt(3)
  ds_read_b128 a[156:159], v3 offset:15360
  v_cvt_pk_bf16_f32 v183, v222, v223
  v_add_u32 v3, s66, v2
  v_mfma_f32_16x16x32_bf16 a[124:127], a[188:191], v[188:191], a[124:127]
  s_cbranch_vccnz fa_stub17
fa_back17:
  v_exp_f32 v217, v145
  v_add_f32 v230, v230, v226
  v_add_f32 v231, v231, v227
fa_SSW5:
  v_mfma_f32_16x16x32_bf16 v[128:131], a[128:131], v[64:67], v[200:203]
  s_waitcnt vmcnt(12)
  v_exp_f32 v218, v146
  v_mfma_f32_16x16x32_bf16 v[136:139], a[128:131], v[68:71], v[204:207]
  s_barrier
  v_exp_f32 v219, v147
  v_mfma_f32_16x16x32_bf16 v[132:135], a[132:135], v[64:67], v[200:203]
  ds_read_b128 a[160:163], v3 offset:16384
  ds_read_b128 a[164:167], v3 offset:17408
  v_add_f32 v226, v216, v217
  v_mfma_f32_16x16x32_bf16 v[140:143], a[132:135], v[68:71], v[204:207]
  s_mov_b32 m0, s24
  v_exp_f32 v220, v148
  v_mfma_f32_16x16x32_bf16 v[128:131], a[136:139], v[72:75], v[128:131]
  ds_read_b128 a[168:171], v3 offset:18432
  buffer_load_dwordx4 v2, s[44:47], s26 offen offset:0 sc1 lds
  v_cvt_pk_bf16_f32 v184, v216, v217
  v_mfma_f32_16x16x32_bf16 v[136:139], a[136:139], v[76:79], v[136:139]
  v_exp_f32 v221, v149
  v_mfma_f32_16x16x32_bf16 v[132:135], a[140:143], v[72:75], v[132:135]
  ds_read_b128 a[172:175], v3 offset:19456
  v_add_f32 v226, v226, v218
  v_add_f32 v226, v226, v219
  v_mfma_f32_16x16x32_bf16 v[140:143], a[140:143], v[76:79], v[140:143]
  s_waitcnt lgkmcnt(4)
  v_exp_f32 v222, v150
  v_mfma_f32_16x16x32_bf16 v[128:131], a[144:147], v[80:83], v[128:131]
  s_add_u32 s14, s13, 69632
  ds_read_b128 a[176:179], v3 offset:20480
  buffer_load_dwordx4 a[212:215], v2, s[40:43], s14 offen offset:1024 sc1
  v_cvt_pk_bf16_f32 v185, v218, v219
  v_mfma_f32_16x16x32_bf16 v[136:139], a[144:147], v[84:87], v[136:139]
  v_exp_f32 v223, v151
  v_mfma_f32_16x16x32_bf16 v[132:135], a[148:151], v[80:83], v[132:135]
  ds_read_b128 a[180:183], v3 offset:21504
  buffer_load_dwordx4 v2, s[44:47], s26 offen offset:1024 sc1 lds
  v_add_f32 v226, v226, v220
  v_mfma_f32_16x16x32_bf16 v[140:143], a[148:151], v[84:87], v[140:143]
  v_exp_f32 v216, v152
  v_mfma_f32_16x16x32_bf16 v[128:131], a[152:155], v[88:91], v[128:131]
  ds_read_b128 a[184:187], v3 offset:22528
  v_add_f32 v226, v226, v221
  v_cvt_pk_bf16_f32 v186, v220, v221
  v_mfma_f32_16x16x32_bf16 v[136:139], a[152:155], v[92:95], v[136:139]
  v_exp_f32 v217, v153
  v_mfma_f32_16x16x32_bf16 v[132:135], a[156:159], v[88:91], v[132:135]
  ds_read_b128 a[188:191], v3 offset:23552
  buffer_load_dwordx4 a[208:211], v2, s[40:43], s14 offen offset:0 sc1
  v_add_f32 v226, v226, v222
  v_mfma_f32_16x16x32_bf16 v[140:143], a[156:159], v[92:95], v[140:143]
  s_waitcnt lgkmcnt(4)
  v_exp_f32 v218, v154
  v_mfma_f32_16x16x32_bf16 a[64:67], a[160:163], v[176:179], a[64:67]
  ds_read_b128 a[128:131], v3 offset:0
  v_add_f32 v226, v226, v223
  v_cvt_pk_bf16_f32 v187, v222, v223
  v_mfma_f32_16x16x32_bf16 a[68:71], a[160:163], v[180:183], a[68:71]
  v_exp_f32 v219, v155
  v_mfma_f32_16x16x32_bf16 a[72:75], a[164:167], v[176:179], a[72:75]
  ds_read_b128 a[132:135], v3 offset:1024
  buffer_load_dwordx4 v2, s[44:47], s26 offen offset:2048 sc1 lds
  v_add_f32 v227, v216, v217
  v_mfma_f32_16x16x32_bf16 a[76:79], a[164:167], v[180:183], a[76:79]
  v_exp_f32 v220, v156
  v_mfma_f32_16x16x32_bf16 a[80:83], a[168:171], v[176:179], a[80:83]
  ds_read_b128 a[136:139], v3 offset:2048
  v_cvt_pk_bf16_f32 v188, v216, v217
  v_mfma_f32_16x16x32_bf16 a[84:87], a[168:171], v[180:183], a[84:87]
  v_exp_f32 v221, v157
  v_mfma_f32_16x16x32_bf16 a[88:91], a[172:175], v[176:179], a[88:91]
  s_add_u32 s14, s13, 61440
  ds_read_b128 a[140:143], v3 offset:3072
  buffer_load_dwordx4 a[204:207], v2, s[40:43], s14 offen offset:3072 sc1
  v_add_f32 v227, v227, v218
  v_add_f32 v227, v227, v219
  v_mfma_f32_16x16x32_bf16 a[92:95], a[172:175], v[180:183], a[92:95]
  s_waitcnt lgkmcnt(4)
  v_exp_f32 v222, v158
  v_mfma_f32_16x16x32_bf16 a[96:99], a[176:179], v[176:179], a[96:99]
  ds_read_b128 a[144:147], v3 offset:4096
  buffer_load_dwordx4 v2, s[44:47], s26 offen offset:3072 sc1 lds
  v_cvt_pk_bf16_f32 v189, v218, v219
  v_mfma_f32_16x16x32_bf16 a[100:103], a[176:179], v[180:183], a[100:103]
  s_add_u32 s26, s26, 16384
  v_exp_f32 v223, v159
  v_mfma_f32_16x16x32_bf16 a[104:107], a[180:183], v[176:179], a[104:107]
  s_add_u32 s24, s24, 32768
  ds_read_b128 a[148:151], v3 offset:5120
  v_add_f32 v227, v227, v220
  v_mfma_f32_16x16x32_bf16 a[108:111], a[180:183], v[180:183], a[108:111]
  s_and_b32 s24, s24, 0x1ffff
  v_add_f32 v227, v227, v221
  v_cvt_pk_bf16_f32 v190, v220, v221
  v_add_f32 v227, v227, v222
  v_mfma_f32_16x16x32_bf16 a[112:115], a[184:187], v[176:179], a[112:115]
  ds_read_b128 a[152:155], v3 offset:6144
  v_add_f32 v227, v227, v223
  v_max_f32 v5, v226, v227
  v_cmp_lt_f32 vcc, s81, v5
  v_mfma_f32_16x16x32_bf16 a[116:119], a[184:187], v[180:183], a[116:119]
  v_exp_f32 v216, v128
  v_mfma_f32_16x16x32_bf16 a[120:123], a[188:191], v[176:179], a[120:123]
  s_waitcnt lgkmcnt(3)
  ds_read_b128 a[156:159], v3 offset:7168
  v_cvt_pk_bf16_f32 v191, v222, v223
  v_mfma_f32_16x16x32_bf16 a[124:127], a[188:191], v[180:183], a[124:127]
  s_cbranch_vccnz fa_stub18
fa_back18:
  v_exp_f32 v217, v129
  v_add_f32 v230, v230, v226
  v_add_f32 v231, v231, v227
  v_mfma_f32_16x16x32_bf16 v[144:147], a[128:131], v[64:67], v[200:203]
  ds_read_b128 a[160:163], v3 offset:24576
  v_add_f32 v226, v216, v217
  v_mfma_f32_16x16x32_bf16 v[152:155], a[128:131], v[68:71], v[204:207]
  v_exp_f32 v218, v130
  v_mfma_f32_16x16x32_bf16 v[148:151], a[132:135], v[64:67], v[200:203]
  s_add_u32 s66, s66, 32768
  ds_read_b128 a[164:167], v3 offset:25600
  v_cvt_pk_bf16_f32 v176, v216, v217
  v_mfma_f32_16x16x32_bf16 v[156:159], a[132:135], v[68:71], v[204:207]
  s_mov_b32 m0, s25
  v_exp_f32 v219, v131
  v_mfma_f32_16x16x32_bf16 v[144:147], a[136:139], v[72:75], v[144:147]
  s_and_b32 s66, s66, 0x1ffff
  ds_read_b128 a[168:171], v3 offset:26624
  buffer_load_dwordx4 v2, s[48:51], s27 offen offset:0 sc1 lds
  v_add_f32 v226, v226, v218
  v_add_f32 v226, v226, v219
  v_mfma_f32_16x16x32_bf16 v[152:155], a[136:139], v[76:79], v[152:155]
  v_exp_f32 v220, v132
  v_mfma_f32_16x16x32_bf16 v[148:151], a[140:143], v[72:75], v[148:151]
  ds_read_b128 a[172:175], v3 offset:27648
  v_cvt_pk_bf16_f32 v177, v218, v219
  v_mfma_f32_16x16x32_bf16 v[156:159], a[140:143], v[76:79], v[156:159]
  s_waitcnt lgkmcnt(4)
  v_exp_f32 v221, v133
  v_mfma_f32_16x16x32_bf16 v[144:147], a[144:147], v[80:83], v[144:147]
  s_add_u32 s14, s13, 61440
  ds_read_b128 a[176:179], v3 offset:28672
  buffer_load_dwordx4 a[200:203], v2, s[40:43], s14 offen offset:2048 sc1
  v_add_f32 v226, v226, v220
  v_mfma_f32_16x16x32_bf16 v[152:155], a[144:147], v[84:87], v[152:155]
  v_exp_f32 v222, v134
  v_mfma_f32_16x16x32_bf16 v[148:151], a[148:151], v[80:83], v[148:151]
  ds_read_b128 a[180:183], v3 offset:29696
  buffer_load_dwordx4 v2, s[48:51], s27 offen offset:1024 sc1 lds
  v_add_f32 v226, v226, v221
  v_cvt_pk_bf16_f32 v178, v220, v221
  v_mfma_f32_16x16x32_bf16 v[156:159], a[148:151], v[84:87], v[156:159]
  v_exp_f32 v223, v135
  v_mfma_f32_16x16x32_bf16 v[144:147], a[152:155], v[88:91], v[144:147]
  ds_read_b128 a[184:187], v3 offset:30720
  v_add_f32 v226, v226, v222
  v_mfma_f32_16x16x32_bf16 v[152:155], a[152:155], v[92:95], v[152:155]
  v_exp_f32 v216, v136
  v_mfma_f32_16x16x32_bf16 v[148:151], a[156:159], v[88:91], v[148:151]
  ds_read_b128 a[188:191], v3 offset:31744
  buffer_load_dwordx4 a[196:199], v2, s[40:43], s14 offen offset:1024 sc1
  v_add_f32 v226, v226, v223
  v_exp_f32 v217, v137
  v_mfma_f32_16x16x32_bf16 v[156:159], a[156:159], v[92:95], v[156:159]
  s_waitcnt lgkmcnt(4)
  v_exp_f32 v218, v138
  v_mfma_f32_16x16x32_bf16 a[64:67], a[160:163], v[184:187], a[64:67]
  ds_read_b128 a[128:131], v3 offset:8192
  v_cvt_pk_bf16_f32 v179, v222, v223
  v_mfma_f32_16x16x32_bf16 a[68:71], a[160:163], v[188:191], a[68:71]
  v_exp_f32 v219, v139
  v_mfma_f32_16x16x32_bf16 a[72:75], a[164:167], v[184:187], a[72:75]
  ds_read_b128 a[132:135], v3 offset:9216
  buffer_load_dwordx4 v2, s[48:51], s27 offen offset:2048 sc1 lds
  v_add_f32 v227, v216, v217
  v_mfma_f32_16x16x32_bf16 a[76:79], a[164:167], v[188:191], a[76:79]
  v_exp_f32 v220, v140
  v_mfma_f32_16x16x32_bf16 a[80:83], a[168:171], v[184:187], a[80:83]
  ds_read_b128 a[136:139], v3 offset:10240
  v_cvt_pk_bf16_f32 v180, v216, v217
  v_mfma_f32_16x16x32_bf16 a[84:87], a[168:171], v[188:191], a[84:87]
  v_exp_f32 v221, v141
  v_mfma_f32_16x16x32_bf16 a[88:91], a[172:175], v[184:187], a[88:91]
  ds_read_b128 a[140:143], v3 offset:11264
  buffer_load_dwordx4 a[192:195], v2, s[40:43], s14 offen offset:0 sc1
  v_add_f32 v227, v227, v218
  v_mfma_f32_16x16x32_bf16 a[92:95], a[172:175], v[188:191], a[92:95]
  s_waitcnt lgkmcnt(4)
  v_exp_f32 v222, v142
  v_mfma_f32_16x16x32_bf16 a[96:99], a[176:179], v[184:187], a[96:99]
  ds_read_b128 a[144:147], v3 offset:12288
  buffer_load_dwordx4 v2, s[48:51], s27 offen offset:3072 sc1 lds
  v_add_f32 v227, v227, v219
  v_cvt_pk_bf16_f32 v181, v218, v219
  v_mfma_f32_16x16x32_bf16 a[100:103], a[176:179], v[188:191], a[100:103]
  s_add_u32 s27, s27, 16384
  v_exp_f32 v223, v143
  v_mfma_f32_16x16x32_bf16 a[104:107], a[180:183], v[184:187], a[104:107]
  s_add_u32 s25, s25, 32768
  ds_read_b128 a[148:151], v3 offset:13312
  v_add_f32 v227, v227, v220
  v_mfma_f32_16x16x32_bf16 a[108:111], a[180:183], v[188:191], a[108:111]
  s_and_b32 s25, s25, 0x1ffff
  v_add_f32 v227, v227, v221
  v_cvt_pk_bf16_f32 v182, v220, v221
  v_add_f32 v227, v227, v222
  v_mfma_f32_16x16x32_bf16 a[112:115], a[184:187], v[184:187], a[112:115]
  ds_read_b128 a[152:155], v3 offset:14336
  v_add_f32 v227, v227, v223
  v_max_f32 v5, v226, v227
  v_cmp_lt_f32 vcc, s81, v5
  v_mfma_f32_16x16x32_bf16 a[116:119], a[184:187], v[188:191], a[116:119]
  v_exp_f32 v216, v144
  v_mfma_f32_16x16x32_bf16 a[120:123], a[188:191], v[184:187], a[120:123]
  s_waitcnt lgkmcnt(3)
  ds_read_b128 a[156:159], v3 offset:15360
  v_cvt_pk_bf16_f32 v183, v222, v223
  v_add_u32 v3, s66, v2
  v_mfma_f32_16x16x32_bf16 a[124:127], a[188:191], v[188:191], a[124:127]
  s_cbranch_vccnz fa_stub19
fa_back19:
  v_exp_f32 v217, v145
  v_add_f32 v230, v230, v226
  v_add_f32 v231, v231, v227
fa_SSW4:
  v_mfma_f32_16x16x32_bf16 v[128:131], a[128:131], v[64:67], v[200:203]
  s_waitcnt vmcnt(12)
  v_exp_f32 v218, v146
  v_mfma_f32_16x16x32_bf16 v[136:139], a[128:131], v[68:71], v[204:207]
  s_barrier
  v_exp_f32 v219, v147
  v_mfma_f32_16x16x32_bf16 v[132:135], a[132:135], v[64:67], v[200:203]
  ds_read_b128 a[160:163], v3 offset:16384
  ds_read_b128 a[164:167], v3 offset:17408
  v_add_f32 v226, v216, v217
  v_mfma_f32_16x16x32_bf16 v[140:143], a[132:135], v[68:71], v[204:207]
  s_mov_b32 m0, s24
  v_exp_f32 v220, v148
  v_mfma_f32_16x16x32_bf16 v[128:131], a[136:139], v[72:75], v[128:131]
  ds_read_b128 a[168:171], v3 offset:18432
  buffer_load_dwordx4 v2, s[44:47], s26 offen offset:0 sc1 lds
  v_cvt_pk_bf16_f32 v184, v216, v217
  v_mfma_f32_16x16x32_bf16 v[136:139], a[136:139], v[76:79], v[136:139]
  v_exp_f32 v221, v149
  v_mfma_f32_16x16x32_bf16 v[132:135], a[140:143], v[72:75], v[132:135]
  s_add_u32 s14, s13, 57344
  ds_read_b128 a[172:175], v3 offset:19456
  buffer_load_dwordx4 a[60:63], v2, s[40:43], s14 offen offset:3072 sc1
  v_add_f32 v226, v226, v218
  v_add_f32 v226, v226, v219
  v_mfma_f32_16x16x32_bf16 v[140:143], a[140:143], v[76:79], v[140:143]
  s_waitcnt lgkmcnt(4)
  v_exp_f32 v222, v150
  v_mfma_f32_16x16x32_bf16 v[128:131], a[144:147], v[80:83], v[128:131]
  ds_read_b128 a[176:179], v3 offset:20480
  v_cvt_pk_bf16_f32 v185, v218, v219
  v_mfma_f32_16x16x32_bf16 v[136:139], a[144:147], v[84:87], v[136:139]
  v_exp_f32 v223, v151
  v_mfma_f32_16x16x32_bf16 v[132:135], a[148:151], v[80:83], v[132:135]
  ds_read_b128 a[180:183], v3 offset:21504
  buffer_load_dwordx4 v2, s[44:47], s26 offen offset:1024 sc1 lds
  v_add_f32 v226, v226, v220
  v_mfma_f32_16x16x32_bf16 v[140:143], a[148:151], v[84:87], v[140:143]
  v_exp_f32 v216, v152
  v_mfma_f32_16x16x32_bf16 v[128:131], a[152:155], v[88:91], v[128:131]
  ds_read_b128 a[184:187], v3 offset:22528
  v_add_f32 v226, v226, v221
  v_cvt_pk_bf16_f32 v186, v220, v221
  v_mfma_f32_16x16x32_bf16 v[136:139], a[152:155], v[92:95], v[136:139]
  v_exp_f32 v217, v153
  v_mfma_f32_16x16x32_bf16 v[132:135], a[156:159], v[88:91], v[132:135]
  ds_read_b128 a[188:191], v3 offset:23552
  buffer_load_dwordx4 a[56:59], v2, s[40:43], s14 offen offset:2048 sc1
  v_add_f32 v226, v226, v222
  v_mfma_f32_16x16x32_bf16 v[140:143], a[156:159], v[92:95], v[140:143]
  s_waitcnt lgkmcnt(4)
  v_exp_f32 v218, v154
  v_mfma_f32_16x16x32_bf16 a[64:67], a[160:163], v[176:179], a[64:67]
  ds_read_b128 a[128:131], v3 offset:0
  v_add_f32 v226, v226, v223
  v_cvt_pk_bf16_f32 v187, v222, v223
  v_mfma_f32_16x16x32_bf16 a[68:71], a[160:163], v[180:183], a[68:71]
  v_exp_f32 v219, v155
  v_mfma_f32_16x16x32_bf16 a[72:75], a[164:167], v[176:179], a[72:75]
  ds_read_b128 a[132:135], v3 offset:1024
  buffer_load_dwordx4 v2, s[44:47], s26 offen offset:2048 sc1 lds
  v_add_f32 v227, v216, v217
  v_mfma_f32_16x16x32_bf16 a[76:79], a[164:167], v[180:183], a[76:79]
  v_exp_f32 v220, v156
  v_mfma_f32_16x16x32_bf16 a[80:83], a[168:171], v[176:179], a[80:83]
  ds_read_b128 a[136:139], v3 offset:2048
  buffer_load_dwordx4 a[52:55], v2, s[40:43], s14 offen offset:1024 sc1
  v_cvt_pk_bf16_f32 v188, v216, v217
  v_mfma_f32_16x16x32_bf16 a[84:87], a[168:171], v[180:183], a[84:87]
  v_exp_f32 v221, v157
  v_mfma_f32_16x16x32_bf16 a[88:91], a[172:175], v[176:179], a[88:91]
  ds_read_b128 a[140:143], v3 offset:3072
  v_add_f32 v227, v227, v218
  v_add_f32 v227, v227, v219
  v_mfma_f32_16x16x32_bf16 a[92:95], a[172:175], v[180:183], a[92:95]
  s_waitcnt lgkmcnt(4)
  v_exp_f32 v222, v158
  v_mfma_f32_16x16x32_bf16 a[96:99], a[176:179], v[176:179], a[96:99]
  ds_read_b128 a[144:147], v3 offset:4096
  buffer_load_dwordx4 v2, s[44:47], s26 offen offset:3072 sc1 lds
  v_cvt_pk_bf16_f32 v189, v218, v219
  v_mfma_f32_16x16x32_bf16 a[100:103], a[176:179], v[180:183], a[100:103]
  s_add_u32 s26, s26, 16384
  v_exp_f32 v223, v159
  v_mfma_f32_16x16x32_bf16 a[104:107], a[180:183], v[176:179], a[104:107]
  s_add_u32 s24, s24, 32768
  ds_read_b128 a[148:151], v3 offset:5120
  buffer_load_dwordx4 a[48:51], v2, s[40:43], s14 offen offset:0 sc1
  v_add_f32 v227, v227, v220
  v_mfma_f32_16x16x32_bf16 a[108:111], a[180:183], v[180:183], a[108:111]
  s_and_b32 s24, s24, 0x1ffff
  v_add_f32 v227, v227, v221
  v_cvt_pk_bf16_f32 v190, v220, v221
  v_add_f32 v227, v227, v222
  v_mfma_f32_16x16x32_bf16 a[112:115], a[184:187], v[176:179], a[112:115]
  ds_read_b128 a[152:155], v3 offset:6144
  v_add_f32 v227, v227, v223
  v_max_f32 v5, v226, v227
  v_cmp_lt_f32 vcc, s81, v5
  v_mfma_f32_16x16x32_bf16 a[116:119], a[184:187], v[180:183], a[116:119]
  v_exp_f32 v216, v128
  v_mfma_f32_16x16x32_bf16 a[120:123], a[188:191], v[176:179], a[120:123]
  s_waitcnt lgkmcnt(3)
  ds_read_b128 a[156:159], v3 offset:7168
  v_cvt_pk_bf16_f32 v191, v222, v223
  v_mfma_f32_16x16x32_bf16 a[124:127], a[188:191], v[180:183], a[124:127]
  s_cbranch_vccnz fa_stub20
fa_back20:
  v_exp_f32 v217, v129
  v_add_f32 v230, v230, v226
  v_add_f32 v231, v231, v227
  v_mfma_f32_16x16x32_bf16 v[144:147], a[128:131], v[64:67], v[200:203]
  ds_read_b128 a[160:163], v3 offset:24576
  v_add_f32 v226, v216, v217
  v_mfma_f32_16x16x32_bf16 v[152:155], a[128:131], v[68:71], v[204:207]
  v_exp_f32 v218, v130
  v_mfma_f32_16x16x32_bf16 v[148:151], a[132:135], v[64:67], v[200:203]
  s_add_u32 s66, s66, 32768
  ds_read_b128 a[164:167], v3 offset:25600
  v_cvt_pk_bf16_f32 v176, v216, v217
  v_mfma_f32_16x16x32_bf16 v[156:159], a[132:135], v[68:71], v[204:207]
  s_mov_b32 m0, s25
  v_exp_f32 v219, v131
  v_mfma_f32_16x16x32_bf16 v[144:147], a[136:139], v[72:75], v[144:147]
  s_and_b32 s66, s66, 0x1ffff
  ds_read_b128 a[168:171], v3 offset:26624
  buffer_load_dwordx4 v2, s[48:51], s27 offen offset:0 sc1 lds
  v_add_f32 v226, v226, v218
  v_add_f32 v226, v226, v219
  v_mfma_f32_16x16x32_bf16 v[152:155], a[136:139], v[76:79], v[152:155]
  v_exp_f32 v220, v132
  v_mfma_f32_16x16x32_bf16 v[148:151], a[140:143], v[72:75], v[148:151]
  s_add_u32 s14, s13, 45056
  ds_read_b128 a[172:175], v3 offset:27648
  buffer_load_dwordx4 a[44:47], v2, s[40:43], s14 offen offset:3072 sc1
  v_cvt_pk_bf16_f32 v177, v218, v219
  v_mfma_f32_16x16x32_bf16 v[156:159], a[140:143], v[76:79], v[156:159]
  s_waitcnt lgkmcnt(4)
  v_exp_f32 v221, v133
  v_mfma_f32_16x16x32_bf16 v[144:147], a[144:147], v[80:83], v[144:147]
  ds_read_b128 a[176:179], v3 offset:28672
  v_add_f32 v226, v226, v220
  v_mfma_f32_16x16x32_bf16 v[152:155], a[144:147], v[84:87], v[152:155]
  v_exp_f32 v222, v134
  v_mfma_f32_16x16x32_bf16 v[148:151], a[148:151], v[80:83], v[148:151]
  ds_read_b128 a[180:183], v3 offset:29696
  buffer_load_dwordx4 v2, s[48:51], s27 offen offset:1024 sc1 lds
  v_add_f32 v226, v226, v221
  v_cvt_pk_bf16_f32 v178, v220, v221
  v_mfma_f32_16x16x32_bf16 v[156:159], a[148:151], v[84:87], v[156:159]
  v_exp_f32 v223, v135
  v_mfma_f32_16x16x32_bf16 v[144:147], a[152:155], v[88:91], v[144:147]
  ds_read_b128 a[184:187], v3 offset:30720
  v_add_f32 v226, v226, v222
  v_mfma_f32_16x16x32_bf16 v[152:155], a[152:155], v[92:95], v[152:155]
  v_exp_f32 v216, v136
  v_mfma_f32_16x16x32_bf16 v[148:151], a[156:159], v[88:91], v[148:151]
  ds_read_b128 a[188:191], v3 offset:31744
  buffer_load_dwordx4 a[40:43], v2, s[40:43], s14 offen offset:2048 sc1
  v_add_f32 v226, v226, v223
  v_exp_f32 v217, v137
  v_mfma_f32_16x16x32_bf16 v[156:159], a[156:159], v[92:95], v[156:159]
  s_waitcnt lgkmcnt(4)
  v_exp_f32 v218, v138
  v_mfma_f32_16x16x32_bf16 a[64:67], a[160:163], v[184:187], a[64:67]
  ds_read_b128 a[128:131], v3 offset:8192
  v_cvt_pk_bf16_f32 v179, v222, v223
  v_mfma_f32_16x16x32_bf16 a[68:71], a[160:163], v[188:191], a[68:71]
  v_exp_f32 v219, v139
  v_mfma_f32_16x16x32_bf16 a[72:75], a[164:167], v[184:187], a[72:75]
  ds_read_b128 a[132:135], v3 offset:9216
  buffer_load_dwordx4 v2, s[48:51], s27 offen offset:2048 sc1 lds
  v_add_f32 v227, v216, v217
  v_mfma_f32_16x16x32_bf16 a[76:79], a[164:167], v[188:191], a[76:79]
  v_exp_f32 v220, v140
  v_mfma_f32_16x16x32_bf16 a[80:83], a[168:171], v[184:187], a[80:83]
  ds_read_b128 a[136:139], v3 offset:10240
  buffer_load_dwordx4 a[36:39], v2, s[40:43], s14 offen offset:1024 sc1
  v_cvt_pk_bf16_f32 v180, v216, v217
  v_mfma_f32_16x16x32_bf16 a[84:87], a[168:171], v[188:191], a[84:87]
  v_exp_f32 v221, v141
  v_mfma_f32_16x16x32_bf16 a[88:91], a[172:175], v[184:187], a[88:91]
  ds_read_b128 a[140:143], v3 offset:11264
  v_add_f32 v227, v227, v218
  v_mfma_f32_16x16x32_bf16 a[92:95], a[172:175], v[188:191], a[92:95]
  s_waitcnt lgkmcnt(4)
  v_exp_f32 v222, v142
  v_mfma_f32_16x16x32_bf16 a[96:99], a[176:179], v[184:187], a[96:99]
  ds_read_b128 a[144:147], v3 offset:12288
  buffer_load_dwordx4 v2, s[48:51], s27 offen offset:3072 sc1 lds
  v_add_f32 v227, v227, v219
  v_cvt_pk_bf16_f32 v181, v218, v219
  v_mfma_f32_16x16x32_bf16 a[100:103], a[176:179], v[188:191], a[100:103]
  s_add_u32 s27, s27, 16384
  v_exp_f32 v223, v143
  v_mfma_f32_16x16x32_bf16 a[104:107], a[180:183], v[184:187], a[104:107]
  s_add_u32 s25, s25, 32768
  ds_read_b128 a[148:151], v3 offset:13312
  buffer_load_dwordx4 a[32:35], v2, s[40:43], s14 offen offset:0 sc1
  v_add_f32 v227, v227, v220
  v_mfma_f32_16x16x32_bf16 a[108:111], a[180:183], v[188:191], a[108:111]
  s_and_b32 s25, s25, 0x1ffff
  v_add_f32 v227, v227, v221
  v_cvt_pk_bf16_f32 v182, v220, v221
  v_add_f32 v227, v227, v222
  v_mfma_f32_16x16x32_bf16 a[112:115], a[184:187], v[184:187], a[112:115]
  ds_read_b128 a[152:155], v3 offset:14336
  v_add_f32 v227, v227, v223
  v_max_f32 v5, v226, v227
  v_cmp_lt_f32 vcc, s81, v5
  v_mfma_f32_16x16x32_bf16 a[116:119], a[184:187], v[188:191], a[116:119]
  v_exp_f32 v216, v144
  v_mfma_f32_16x16x32_bf16 a[120:123], a[188:191], v[184:187], a[120:123]
  s_waitcnt lgkmcnt(3)
  ds_read_b128 a[156:159], v3 offset:15360
  v_cvt_pk_bf16_f32 v183, v222, v223
  v_add_u32 v3, s66, v2
  v_mfma_f32_16x16x32_bf16 a[124:127], a[188:191], v[188:191], a[124:127]
  s_cbranch_vccnz fa_stub21
fa_back21:
  v_exp_f32 v217, v145
  v_add_f32 v230, v230, v226
  v_add_f32 v231, v231, v227
fa_SSW3:
  v_mfma_f32_16x16x32_bf16 v[128:131], a[128:131], v[64:67], v[200:203]
  s_waitcnt vmcnt(12)
  v_exp_f32 v218, v146
  v_mfma_f32_16x16x32_bf16 v[136:139], a[128:131], v[68:71], v[204:207]
  s_barrier
  v_exp_f32 v219, v147
  v_mfma_f32_16x16x32_bf16 v[132:135], a[132:135], v[64:67], v[200:203]
  s_cmp_ge_u32 s26, s46
  s_cselect_b64 s[44:45], s[4:5], s[44:45]
  s_cselect_b32 s46, s30, s46
  ds_read_b128 a[160:163], v3 offset:16384
  ds_read_b128 a[164:167], v3 offset:17408
  v_add_f32 v226, v216, v217
  v_mfma_f32_16x16x32_bf16 v[140:143], a[132:135], v[68:71], v[204:207]
  s_mov_b32 m0, s24
  v_exp_f32 v220, v148
  v_mfma_f32_16x16x32_bf16 v[128:131], a[136:139], v[72:75], v[128:131]
  ds_read_b128 a[168:171], v3 offset:18432
  buffer_load_dwordx4 v2, s[44:47], s26 offen offset:0 sc1 lds
  v_cvt_pk_bf16_f32 v184, v216, v217
  v_mfma_f32_16x16x32_bf16 v[136:139], a[136:139], v[76:79], v[136:139]
  v_exp_f32 v221, v149
  v_mfma_f32_16x16x32_bf16 v[132:135], a[140:143], v[72:75], v[132:135]
  s_add_u32 s14, s13, 40960
  ds_read_b128 a[172:175], v3 offset:19456
  buffer_load_dwordx4 a[28:31], v2, s[40:43], s14 offen offset:3072 sc1
  v_add_f32 v226, v226, v218
  v_add_f32 v226, v226, v219
  v_mfma_f32_16x16x32_bf16 v[140:143], a[140:143], v[76:79], v[140:143]
  s_waitcnt lgkmcnt(4)
  v_exp_f32 v222, v150
  v_mfma_f32_16x16x32_bf16 v[128:131], a[144:147], v[80:83], v[128:131]
  ds_read_b128 a[176:179], v3 offset:20480
  v_cvt_pk_bf16_f32 v185, v218, v219
  v_mfma_f32_16x16x32_bf16 v[136:139], a[144:147], v[84:87], v[136:139]
  v_exp_f32 v223, v151
  v_mfma_f32_16x16x32_bf16 v[132:135], a[148:151], v[80:83], v[132:135]
  ds_read_b128 a[180:183], v3 offset:21504
  buffer_load_dwordx4 v2, s[44:47], s26 offen offset:1024 sc1 lds
  v_add_f32 v226, v226, v220
  v_mfma_f32_16x16x32_bf16 v[140:143], a[148:151], v[84:87], v[140:143]
  v_exp_f32 v216, v152
  v_mfma_f32_16x16x32_bf16 v[128:131], a[152:155], v[88:91], v[128:131]
  ds_read_b128 a[184:187], v3 offset:22528
  v_add_f32 v226, v226, v221
  v_cvt_pk_bf16_f32 v186, v220, v221
  v_mfma_f32_16x16x32_bf16 v[136:139], a[152:155], v[92:95], v[136:139]
  v_exp_f32 v217, v153
  v_mfma_f32_16x16x32_bf16 v[132:135], a[156:159], v[88:91], v[132:135]
  ds_read_b128 a[188:191], v3 offset:23552
  buffer_load_dwordx4 a[24:27], v2, s[40:43], s14 offen offset:2048 sc1
  v_add_f32 v226, v226, v222
  v_mfma_f32_16x16x32_bf16 v[140:143], a[156:159], v[92:95], v[140:143]
  s_waitcnt lgkmcnt(4)
  v_exp_f32 v218, v154
  v_mfma_f32_16x16x32_bf16 a[64:67], a[160:163], v[176:179], a[64:67]
  ds_read_b128 a[128:131], v3 offset:0
  v_add_f32 v226, v226, v223
  v_cvt_pk_bf16_f32 v187, v222, v223
  v_mfma_f32_16x16x32_bf16 a[68:71], a[160:163], v[180:183], a[68:71]
  v_exp_f32 v219, v155
  v_mfma_f32_16x16x32_bf16 a[72:75], a[164:167], v[176:179], a[72:75]
  ds_read_b128 a[132:135], v3 offset:1024
  buffer_load_dwordx4 v2, s[44:47], s26 offen offset:2048 sc1 lds
  v_add_f32 v227, v216, v217
  v_mfma_f32_16x16x32_bf16 a[76:79], a[164:167], v[180:183], a[76:79]
  v_exp_f32 v220, v156
  v_mfma_f32_16x16x32_bf16 a[80:83], a[168:171], v[176:179], a[80:83]
  ds_read_b128 a[136:139], v3 offset:2048
  buffer_load_dwordx4 a[20:23], v2, s[40:43], s14 offen offset:1024 sc1
  v_cvt_pk_bf16_f32 v188, v216, v217
  v_mfma_f32_16x16x32_bf16 a[84:87], a[168:171], v[180:183], a[84:87]
  v_exp_f32 v221, v157
  v_mfma_f32_16x16x32_bf16 a[88:91], a[172:175], v[176:179], a[88:91]
  ds_read_b128 a[140:143], v3 offset:3072
  v_add_f32 v227, v227, v218
  v_add_f32 v227, v227, v219
  v_mfma_f32_16x16x32_bf16 a[92:95], a[172:175], v[180:183], a[92:95]
  s_waitcnt lgkmcnt(4)
  v_exp_f32 v222, v158
  v_mfma_f32_16x16x32_bf16 a[96:99], a[176:179], v[176:179], a[96:99]
  ds_read_b128 a[144:147], v3 offset:4096
  buffer_load_dwordx4 v2, s[44:47], s26 offen offset:3072 sc1 lds
  v_cvt_pk_bf16_f32 v189, v218, v219
  v_mfma_f32_16x16x32_bf16 a[100:103], a[176:179], v[180:183], a[100:103]
  s_add_u32 s26, s26, 16384
  v_exp_f32 v223, v159
  v_mfma_f32_16x16x32_bf16 a[104:107], a[180:183], v[176:179], a[104:107]
  s_add_u32 s24, s24, 32768
  ds_read_b128 a[148:151], v3 offset:5120
  buffer_load_dwordx4 a[16:19], v2, s[40:43], s14 offen offset:0 sc1
  v_add_f32 v227, v227, v220
  v_mfma_f32_16x16x32_bf16 a[108:111], a[180:183], v[180:183], a[108:111]
  s_and_b32 s24, s24, 0x1ffff
  v_add_f32 v227, v227, v221
  v_cvt_pk_bf16_f32 v190, v220, v221
  v_add_f32 v227, v227, v222
  v_mfma_f32_16x16x32_bf16 a[112:115], a[184:187], v[176:179], a[112:115]
  ds_read_b128 a[152:155], v3 offset:6144
  v_add_f32 v227, v227, v223
  v_max_f32 v5, v226, v227
  v_cmp_lt_f32 vcc, s81, v5
  v_mfma_f32_16x16x32_bf16 a[116:119], a[184:187], v[180:183], a[116:119]
  v_exp_f32 v216, v128
  v_mfma_f32_16x16x32_bf16 a[120:123], a[188:191], v[176:179], a[120:123]
  s_waitcnt lgkmcnt(3)
  ds_read_b128 a[156:159], v3 offset:7168
  v_cvt_pk_bf16_f32 v191, v222, v223
  v_mfma_f32_16x16x32_bf16 a[124:127], a[188:191], v[180:183], a[124:127]
  s_cbranch_vccnz fa_stub22
fa_back22:
  v_exp_f32 v217, v129
  v_add_f32 v230, v230, v226
  v_add_f32 v231, v231, v227
  v_mfma_f32_16x16x32_bf16 v[144:147], a[128:131], v[64:67], v[200:203]
  ds_read_b128 a[160:163], v3 offset:24576
  v_add_f32 v226, v216, v217
  v_mfma_f32_16x16x32_bf16 v[152:155], a[128:131], v[68:71], v[204:207]
  v_exp_f32 v218, v130
  v_mfma_f32_16x16x32_bf16 v[148:151], a[132:135], v[64:67], v[200:203]
  s_cmp_ge_u32 s27, s50
  s_cselect_b64 s[48:49], s[6:7], s[48:49]
  s_cselect_b32 s50, s30, s50
  ds_read_b128 a[164:167], v3 offset:25600
  v_cvt_pk_bf16_f32 v176, v216, v217
  v_mfma_f32_16x16x32_bf16 v[156:159], a[132:135], v[68:71], v[204:207]
  s_mov_b32 m0, s25
  v_exp_f32 v219, v131
  v_mfma_f32_16x16x32_bf16 v[144:147], a[136:139], v[72:75], v[144:147]
  s_add_u32 s66, s66, 32768
  ds_read_b128 a[168:171], v3 offset:26624
  buffer_load_dwordx4 v2, s[48:51], s27 offen offset:0 sc1 lds
  v_add_f32 v226, v226, v218
  v_add_f32 v226, v226, v219
  v_mfma_f32_16x16x32_bf16 v[152:155], a[136:139], v[76:79], v[152:155]
  s_and_b32 s66, s66, 0x1ffff
  v_exp_f32 v220, v132
  v_mfma_f32_16x16x32_bf16 v[148:151], a[140:143], v[72:75], v[148:151]
  s_add_u32 s14, s13, 28672
  ds_read_b128 a[172:175], v3 offset:27648
  buffer_load_dwordx4 a[12:15], v2, s[40:43], s14 offen offset:3072 sc1
  v_cvt_pk_bf16_f32 v177, v218, v219
  v_mfma_f32_16x16x32_bf16 v[156:159], a[140:143], v[76:79], v[156:159]
  s_waitcnt lgkmcnt(4)
  v_exp_f32 v221, v133
  v_mfma_f32_16x16x32_bf16 v[144:147], a[144:147], v[80:83], v[144:147]
  ds_read_b128 a[176:179], v3 offset:28672
  v_add_f32 v226, v226, v220
  v_mfma_f32_16x16x32_bf16 v[152:155], a[144:147], v[84:87], v[152:155]
  v_exp_f32 v222, v134
  v_mfma_f32_16x16x32_bf16 v[148:151], a[148:151], v[80:83], v[148:151]
  ds_read_b128 a[180:183], v3 offset:29696
  buffer_load_dwordx4 v2, s[48:51], s27 offen offset:1024 sc1 lds
  v_add_f32 v226, v226, v221
  v_cvt_pk_bf16_f32 v178, v220, v221
  v_mfma_f32_16x16x32_bf16 v[156:159], a[148:151], v[84:87], v[156:159]
  v_exp_f32 v223, v135
  v_mfma_f32_16x16x32_bf16 v[144:147], a[152:155], v[88:91], v[144:147]
  ds_read_b128 a[184:187], v3 offset:30720
  v_add_f32 v226, v226, v222
  v_mfma_f32_16x16x32_bf16 v[152:155], a[152:155], v[92:95], v[152:155]
  v_exp_f32 v216, v136
  v_mfma_f32_16x16x32_bf16 v[148:151], a[156:159], v[88:91], v[148:151]
  ds_read_b128 a[188:191], v3 offset:31744
  buffer_load_dwordx4 a[8:11], v2, s[40:43], s14 offen offset:2048 sc1
  v_add_f32 v226, v226, v223
  v_exp_f32 v217, v137
  v_mfma_f32_16x16x32_bf16 v[156:159], a[156:159], v[92:95], v[156:159]
  s_waitcnt lgkmcnt(4)
  v_exp_f32 v218, v138
  v_mfma_f32_16x16x32_bf16 a[64:67], a[160:163], v[184:187], a[64:67]
  ds_read_b128 a[128:131], v3 offset:8192
  v_cvt_pk_bf16_f32 v179, v222, v223
  v_mfma_f32_16x16x32_bf16 a[68:71], a[160:163], v[188:191], a[68:71]
  v_exp_f32 v219, v139
  v_mfma_f32_16x16x32_bf16 a[72:75], a[164:167], v[184:187], a[72:75]
  ds_read_b128 a[132:135], v3 offset:9216
  buffer_load_dwordx4 v2, s[48:51], s27 offen offset:2048 sc1 lds
  v_add_f32 v227, v216, v217
  v_mfma_f32_16x16x32_bf16 a[76:79], a[164:167], v[188:191], a[76:79]
  v_exp_f32 v220, v140
  v_mfma_f32_16x16x32_bf16 a[80:83], a[168:171], v[184:187], a[80:83]
  ds_read_b128 a[136:139], v3 offset:10240
  buffer_load_dwordx4 a[4:7], v2, s[40:43], s14 offen offset:1024 sc1
  v_cvt_pk_bf16_f32 v180, v216, v217
  v_mfma_f32_16x16x32_bf16 a[84:87], a[168:171], v[188:191], a[84:87]
  v_exp_f32 v221, v141
  v_mfma_f32_16x16x32_bf16 a[88:91], a[172:175], v[184:187], a[88:91]
  ds_read_b128 a[140:143], v3 offset:11264
  v_add_f32 v227, v227, v218
  v_mfma_f32_16x16x32_bf16 a[92:95], a[172:175], v[188:191], a[92:95]
  s_waitcnt lgkmcnt(4)
  v_exp_f32 v222, v142
  v_mfma_f32_16x16x32_bf16 a[96:99], a[176:179], v[184:187], a[96:99]
  ds_read_b128 a[144:147], v3 offset:12288
  buffer_load_dwordx4 v2, s[48:51], s27 offen offset:3072 sc1 lds
  v_add_f32 v227, v227, v219
  v_cvt_pk_bf16_f32 v181, v218, v219
  v_mfma_f32_16x16x32_bf16 a[100:103], a[176:179], v[188:191], a[100:103]
  s_add_u32 s27, s27, 16384
  v_exp_f32 v223, v143
  v_mfma_f32_16x16x32_bf16 a[104:107], a[180:183], v[184:187], a[104:107]
  s_add_u32 s25, s25, 32768
  ds_read_b128 a[148:151], v3 offset:13312
  buffer_load_dwordx4 a[0:3], v2, s[40:43], s14 offen offset:0 sc1
  v_add_f32 v227, v227, v220
  v_mfma_f32_16x16x32_bf16 a[108:111], a[180:183], v[188:191], a[108:111]
  s_and_b32 s25, s25, 0x1ffff
  v_add_f32 v227, v227, v221
  v_cvt_pk_bf16_f32 v182, v220, v221
  v_add_f32 v227, v227, v222
  v_mfma_f32_16x16x32_bf16 a[112:115], a[184:187], v[184:187], a[112:115]
  ds_read_b128 a[152:155], v3 offset:14336
  v_add_f32 v227, v227, v223
  v_max_f32 v5, v226, v227
  v_cmp_lt_f32 vcc, s81, v5
  v_mfma_f32_16x16x32_bf16 a[116:119], a[184:187], v[188:191], a[116:119]
  v_exp_f32 v216, v144
  v_mfma_f32_16x16x32_bf16 a[120:123], a[188:191], v[184:187], a[120:123]
  s_waitcnt lgkmcnt(3)
  ds_read_b128 a[156:159], v3 offset:15360
  v_cvt_pk_bf16_f32 v183, v222, v223
  v_add_u32 v3, s66, v2
  v_mfma_f32_16x16x32_bf16 a[124:127], a[188:191], v[188:191], a[124:127]
  s_cbranch_vccnz fa_stub23
fa_back23:
  v_exp_f32 v217, v145
  v_add_f32 v230, v230, v226
  v_add_f32 v231, v231, v227
fa_SSW2:
  v_mfma_f32_16x16x32_bf16 v[128:131], a[128:131], v[64:67], v[200:203]
  s_waitcnt vmcnt(12)
  v_exp_f32 v218, v146
  v_mfma_f32_16x16x32_bf16 v[136:139], a[128:131], v[68:71], v[204:207]
  s_barrier
  v_exp_f32 v219, v147
  v_mfma_f32_16x16x32_bf16 v[132:135], a[132:135], v[64:67], v[200:203]
  s_cmp_ge_u32 s26, s46
  s_cselect_b64 s[44:45], s[4:5], s[44:45]
  s_cselect_b32 s46, s30, s46
  ds_read_b128 a[160:163], v3 offset:16384
  ds_read_b128 a[164:167], v3 offset:17408
  v_add_f32 v226, v216, v217
  v_mfma_f32_16x16x32_bf16 v[140:143], a[132:135], v[68:71], v[204:207]
  s_mov_b32 m0, s24
  v_exp_f32 v220, v148
  v_mfma_f32_16x16x32_bf16 v[128:131], a[136:139], v[72:75], v[128:131]
  ds_read_b128 a[168:171], v3 offset:18432
  buffer_load_dwordx4 v2, s[44:47], s26 offen offset:0 sc1 lds
  v_cvt_pk_bf16_f32 v184, v216, v217
  v_mfma_f32_16x16x32_bf16 v[136:139], a[136:139], v[76:79], v[136:139]
  v_exp_f32 v221, v149
  v_mfma_f32_16x16x32_bf16 v[132:135], a[140:143], v[72:75], v[132:135]
  s_add_u32 s14, s13, 24576
  ds_read_b128 a[172:175], v3 offset:19456
  buffer_load_dwordx4 v[212:215], v2, s[40:43], s14 offen offset:3072 sc1
  v_add_f32 v226, v226, v218
  v_add_f32 v226, v226, v219
  v_mfma_f32_16x16x32_bf16 v[140:143], a[140:143], v[76:79], v[140:143]
  s_waitcnt lgkmcnt(4)
  v_exp_f32 v222, v150
  v_mfma_f32_16x16x32_bf16 v[128:131], a[144:147], v[80:83], v[128:131]
  ds_read_b128 a[176:179], v3 offset:20480
  v_cvt_pk_bf16_f32 v185, v218, v219
  v_mfma_f32_16x16x32_bf16 v[136:139], a[144:147], v[84:87], v[136:139]
  v_exp_f32 v223, v151
  v_mfma_f32_16x16x32_bf16 v[132:135], a[148:151], v[80:83], v[132:135]
  ds_read_b128 a[180:183], v3 offset:21504
  buffer_load_dwordx4 v2, s[44:47], s26 offen offset:1024 sc1 lds
  v_add_f32 v226, v226, v220
  v_mfma_f32_16x16x32_bf16 v[140:143], a[148:151], v[84:87], v[140:143]
  v_exp_f32 v216, v152
  v_mfma_f32_16x16x32_bf16 v[128:131], a[152:155], v[88:91], v[128:131]
  ds_read_b128 a[184:187], v3 offset:22528
  v_add_f32 v226, v226, v221
  v_cvt_pk_bf16_f32 v186, v220, v221
  v_mfma_f32_16x16x32_bf16 v[136:139], a[152:155], v[92:95], v[136:139]
  v_exp_f32 v217, v153
  v_mfma_f32_16x16x32_bf16 v[132:135], a[156:159], v[88:91], v[132:135]
  ds_read_b128 a[188:191], v3 offset:23552
  buffer_load_dwordx4 v[208:211], v2, s[40:43], s14 offen offset:2048 sc1
  v_add_f32 v226, v226, v222
  v_mfma_f32_16x16x32_bf16 v[140:143], a[156:159], v[92:95], v[140:143]
  s_waitcnt lgkmcnt(4)
  v_exp_f32 v218, v154
  v_mfma_f32_16x16x32_bf16 a[64:67], a[160:163], v[176:179], a[64:67]
  ds_read_b128 a[128:131], v3 offset:0
  v_add_f32 v226, v226, v223
  v_cvt_pk_bf16_f32 v187, v222, v223
  v_mfma_f32_16x16x32_bf16 a[68:71], a[160:163], v[180:183], a[68:71]
  v_exp_f32 v219, v155
  v_mfma_f32_16x16x32_bf16 a[72:75], a[164:167], v[176:179], a[72:75]
  ds_read_b128 a[132:135], v3 offset:1024
  buffer_load_dwordx4 v2, s[44:47], s26 offen offset:2048 sc1 lds
  v_add_f32 v227, v216, v217
  v_mfma_f32_16x16x32_bf16 a[76:79], a[164:167], v[180:183], a[76:79]
  v_exp_f32 v220, v156
  v_mfma_f32_16x16x32_bf16 a[80:83], a[168:171], v[176:179], a[80:83]
  ds_read_b128 a[136:139], v3 offset:2048
  buffer_load_dwordx4 v[196:199], v2, s[40:43], s14 offen offset:1024 sc1
  v_cvt_pk_bf16_f32 v188, v216, v217
  v_mfma_f32_16x16x32_bf16 a[84:87], a[168:171], v[180:183], a[84:87]
  v_exp_f32 v221, v157
  v_mfma_f32_16x16x32_bf16 a[88:91], a[172:175], v[176:179], a[88:91]
  ds_read_b128 a[140:143], v3 offset:3072
  v_add_f32 v227, v227, v218
  v_add_f32 v227, v227, v219
  v_mfma_f32_16x16x32_bf16 a[92:95], a[172:175], v[180:183], a[92:95]
  s_waitcnt lgkmcnt(4)
  v_exp_f32 v222, v158
  v_mfma_f32_16x16x32_bf16 a[96:99], a[176:179], v[176:179], a[96:99]
  ds_read_b128 a[144:147], v3 offset:4096
  buffer_load_dwordx4 v2, s[44:47], s26 offen offset:3072 sc1 lds
  v_cvt_pk_bf16_f32 v189, v218, v219
  v_mfma_f32_16x16x32_bf16 a[100:103], a[176:179], v[180:183], a[100:103]
  s_add_u32 s26, s26, 16384
  v_exp_f32 v223, v159
  v_mfma_f32_16x16x32_bf16 a[104:107], a[180:183], v[176:179], a[104:107]
  s_add_u32 s24, s24, 32768
  ds_read_b128 a[148:151], v3 offset:5120
  buffer_load_dwordx4 v[192:195], v2, s[40:43], s14 offen offset:0 sc1
  v_add_f32 v227, v227, v220
  v_mfma_f32_16x16x32_bf16 a[108:111], a[180:183], v[180:183], a[108:111]
  s_and_b32 s24, s24, 0x1ffff
  v_add_f32 v227, v227, v221
  v_cvt_pk_bf16_f32 v190, v220, v221
  v_add_f32 v227, v227, v222
  v_mfma_f32_16x16x32_bf16 a[112:115], a[184:187], v[176:179], a[112:115]
  ds_read_b128 a[152:155], v3 offset:6144
  v_add_f32 v227, v227, v223
  v_max_f32 v5, v226, v227
  v_cmp_lt_f32 vcc, s81, v5
  v_mfma_f32_16x16x32_bf16 a[116:119], a[184:187], v[180:183], a[116:119]
  v_exp_f32 v216, v128
  v_mfma_f32_16x16x32_bf16 a[120:123], a[188:191], v[176:179], a[120:123]
  s_waitcnt lgkmcnt(3)
  ds_read_b128 a[156:159], v3 offset:7168
  v_cvt_pk_bf16_f32 v191, v222, v223
  v_mfma_f32_16x16x32_bf16 a[124:127], a[188:191], v[180:183], a[124:127]
  s_cbranch_vccnz fa_stub24
fa_back24:
  v_exp_f32 v217, v129
  v_add_f32 v230, v230, v226
  v_add_f32 v231, v231, v227
  v_mfma_f32_16x16x32_bf16 v[144:147], a[128:131], v[64:67], v[200:203]
  ds_read_b128 a[160:163], v3 offset:24576
  v_add_f32 v226, v216, v217
  v_mfma_f32_16x16x32_bf16 v[152:155], a[128:131], v[68:71], v[204:207]
  v_exp_f32 v218, v130
  v_mfma_f32_16x16x32_bf16 v[148:151], a[132:135], v[64:67], v[200:203]
  s_cmp_ge_u32 s27, s50
  s_cselect_b64 s[48:49], s[6:7], s[48:49]
  s_cselect_b32 s50, s30, s50
  ds_read_b128 a[164:167], v3 offset:25600
  v_cvt_pk_bf16_f32 v176, v216, v217
  v_mfma_f32_16x16x32_bf16 v[156:159], a[132:135], v[68:71], v[204:207]
  s_mov_b32 m0, s25
  v_exp_f32 v219, v131
  v_mfma_f32_16x16x32_bf16 v[144:147], a[136:139], v[72:75], v[144:147]
  s_add_u32 s66, s66, 32768
  ds_read_b128 a[168:171], v3 offset:26624
  buffer_load_dwordx4 v2, s[48:51], s27 offen offset:0 sc1 lds
  v_add_f32 v226, v226, v218
  v_add_f32 v226, v226, v219
  v_mfma_f32_16x16x32_bf16 v[152:155], a[136:139], v[76:79], v[152:155]
  s_and_b32 s66, s66, 0x1ffff
  v_exp_f32 v220, v132
  v_mfma_f32_16x16x32_bf16 v[148:151], a[140:143], v[72:75], v[148:151]
  s_add_u32 s14, s13, 20480
  ds_read_b128 a[172:175], v3 offset:27648
  buffer_load_dwordx4 v[244:247], v2, s[40:43], s14 offen offset:3072 sc1
  v_cvt_pk_bf16_f32 v177, v218, v219
  v_mfma_f32_16x16x32_bf16 v[156:159], a[140:143], v[76:79], v[156:159]
  s_waitcnt lgkmcnt(4)
  v_exp_f32 v221, v133
  v_mfma_f32_16x16x32_bf16 v[144:147], a[144:147], v[80:83], v[144:147]
  ds_read_b128 a[176:179], v3 offset:28672
  v_add_f32 v226, v226, v220
  v_mfma_f32_16x16x32_bf16 v[152:155], a[144:147], v[84:87], v[152:155]
  v_exp_f32 v222, v134
  v_mfma_f32_16x16x32_bf16 v[148:151], a[148:151], v[80:83], v[148:151]
  ds_read_b128 a[180:183], v3 offset:29696
  buffer_load_dwordx4 v2, s[48:51], s27 offen offset:1024 sc1 lds
  v_add_f32 v226, v226, v221
  v_cvt_pk_bf16_f32 v178, v220, v221
  v_mfma_f32_16x16x32_bf16 v[156:159], a[148:151], v[84:87], v[156:159]
  v_exp_f32 v223, v135
  v_mfma_f32_16x16x32_bf16 v[144:147], a[152:155], v[88:91], v[144:147]
  ds_read_b128 a[184:187], v3 offset:30720
  v_add_f32 v226, v226, v222
  v_mfma_f32_16x16x32_bf16 v[152:155], a[152:155], v[92:95], v[152:155]
  v_exp_f32 v216, v136
  v_mfma_f32_16x16x32_bf16 v[148:151], a[156:159], v[88:91], v[148:151]
  ds_read_b128 a[188:191], v3 offset:31744
  buffer_load_dwordx4 v[240:243], v2, s[40:43], s14 offen offset:2048 sc1
  v_add_f32 v226, v226, v223
  v_exp_f32 v217, v137
  v_mfma_f32_16x16x32_bf16 v[156:159], a[156:159], v[92:95], v[156:159]
  s_waitcnt lgkmcnt(4)
  v_exp_f32 v218, v138
  v_mfma_f32_16x16x32_bf16 a[64:67], a[160:163], v[184:187], a[64:67]
  ds_read_b128 a[128:131], v3 offset:8192
  v_cvt_pk_bf16_f32 v179, v222, v223
  v_mfma_f32_16x16x32_bf16 a[68:71], a[160:163], v[188:191], a[68:71]
  v_exp_f32 v219, v139
  v_mfma_f32_16x16x32_bf16 a[72:75], a[164:167], v[184:187], a[72:75]
  ds_read_b128 a[132:135], v3 offset:9216
  buffer_load_dwordx4 v2, s[48:51], s27 offen offset:2048 sc1 lds
  v_add_f32 v227, v216, v217
  v_mfma_f32_16x16x32_bf16 a[76:79], a[164:167], v[188:191], a[76:79]
  v_exp_f32 v220, v140
  v_mfma_f32_16x16x32_bf16 a[80:83], a[168:171], v[184:187], a[80:83]
  ds_read_b128 a[136:139], v3 offset:10240
  buffer_load_dwordx4 v[236:239], v2, s[40:43], s14 offen offset:1024 sc1
  v_cvt_pk_bf16_f32 v180, v216, v217
  v_mfma_f32_16x16x32_bf16 a[84:87], a[168:171], v[188:191], a[84:87]
  v_exp_f32 v221, v141
  v_mfma_f32_16x16x32_bf16 a[88:91], a[172:175], v[184:187], a[88:91]
  ds_read_b128 a[140:143], v3 offset:11264
  v_add_f32 v227, v227, v218
  v_mfma_f32_16x16x32_bf16 a[92:95], a[172:175], v[188:191], a[92:95]
  s_waitcnt lgkmcnt(4)
  v_exp_f32 v222, v142
  v_mfma_f32_16x16x32_bf16 a[96:99], a[176:179], v[184:187], a[96:99]
  ds_read_b128 a[144:147], v3 offset:12288
  buffer_load_dwordx4 v2, s[48:51], s27 offen offset:3072 sc1 lds
  v_add_f32 v227, v227, v219
  v_cvt_pk_bf16_f32 v181, v218, v219
  v_mfma_f32_16x16x32_bf16 a[100:103], a[176:179], v[188:191], a[100:103]
  s_add_u32 s27, s27, 16384
  v_exp_f32 v223, v143
  v_mfma_f32_16x16x32_bf16 a[104:107], a[180:183], v[184:187], a[104:107]
  s_add_u32 s25, s25, 32768
  ds_read_b128 a[148:151], v3 offset:13312
  buffer_load_dwordx4 v[232:235], v2, s[40:43], s14 offen offset:0 sc1
  v_add_f32 v227, v227, v220
  v_mfma_f32_16x16x32_bf16 a[108:111], a[180:183], v[188:191], a[108:111]
  s_and_b32 s25, s25, 0x1ffff
  v_add_f32 v227, v227, v221
  v_cvt_pk_bf16_f32 v182, v220, v221
  v_add_f32 v227, v227, v222
  v_mfma_f32_16x16x32_bf16 a[112:115], a[184:187], v[184:187], a[112:115]
  ds_read_b128 a[152:155], v3 offset:14336
  v_add_f32 v227, v227, v223
  v_max_f32 v5, v226, v227
  v_cmp_lt_f32 vcc, s81, v5
  v_mfma_f32_16x16x32_bf16 a[116:119], a[184:187], v[188:191], a[116:119]
  v_exp_f32 v216, v144
  v_mfma_f32_16x16x32_bf16 a[120:123], a[188:191], v[184:187], a[120:123]
  s_waitcnt lgkmcnt(3)
  ds_read_b128 a[156:159], v3 offset:15360
  v_cvt_pk_bf16_f32 v183, v222, v223
  v_add_u32 v3, s66, v2
  v_mfma_f32_16x16x32_bf16 a[124:127], a[188:191], v[188:191], a[124:127]
  s_cbranch_vccnz fa_stub25
fa_back25:
  v_exp_f32 v217, v145
  v_add_f32 v230, v230, v226
  v_add_f32 v231, v231, v227
fa_SSW1:
  v_mfma_f32_16x16x32_bf16 v[128:131], a[128:131], v[64:67], v[200:203]
  s_waitcnt vmcnt(8)
  v_exp_f32 v218, v146
  v_mfma_f32_16x16x32_bf16 v[136:139], a[128:131], v[68:71], v[204:207]
  s_barrier
  v_exp_f32 v219, v147
  v_mfma_f32_16x16x32_bf16 v[132:135], a[132:135], v[64:67], v[200:203]
  s_cmp_ge_u32 s26, s46
  s_cselect_b64 s[44:45], s[4:5], s[44:45]
  s_cselect_b32 s46, s30, s46
  ds_read_b128 a[160:163], v3 offset:16384
  ds_read_b128 a[164:167], v3 offset:17408
  v_add_f32 v226, v216, v217
  v_mfma_f32_16x16x32_bf16 v[140:143], a[132:135], v[68:71], v[204:207]
  s_mov_b32 m0, s24
  v_exp_f32 v220, v148
  v_mfma_f32_16x16x32_bf16 v[128:131], a[136:139], v[72:75], v[128:131]
  ds_read_b128 a[168:171], v3 offset:18432
  buffer_load_dwordx4 v2, s[44:47], s26 offen offset:0 sc1 lds
  v_cvt_pk_bf16_f32 v184, v216, v217
  v_mfma_f32_16x16x32_bf16 v[136:139], a[136:139], v[76:79], v[136:139]
  v_exp_f32 v221, v149
  v_mfma_f32_16x16x32_bf16 v[132:135], a[140:143], v[72:75], v[132:135]
  s_add_u32 s14, s13, 16384
  ds_read_b128 a[172:175], v3 offset:19456
  buffer_load_dwordx4 v[172:175], v2, s[40:43], s14 offen offset:3072 sc1
  v_add_f32 v226, v226, v218
  v_add_f32 v226, v226, v219
  v_mfma_f32_16x16x32_bf16 v[140:143], a[140:143], v[76:79], v[140:143]
  s_waitcnt lgkmcnt(4)
  v_exp_f32 v222, v150
  v_mfma_f32_16x16x32_bf16 v[128:131], a[144:147], v[80:83], v[128:131]
  ds_read_b128 a[176:179], v3 offset:20480
  v_cvt_pk_bf16_f32 v185, v218, v219
  v_mfma_f32_16x16x32_bf16 v[136:139], a[144:147], v[84:87], v[136:139]
  v_exp_f32 v223, v151
  v_mfma_f32_16x16x32_bf16 v[132:135], a[148:151], v[80:83], v[132:135]
  ds_read_b128 a[180:183], v3 offset:21504
  buffer_load_dwordx4 v2, s[44:47], s26 offen offset:1024 sc1 lds
  v_add_f32 v226, v226, v220
  v_mfma_f32_16x16x32_bf16 v[140:143], a[148:151], v[84:87], v[140:143]
  v_exp_f32 v216, v152
  v_mfma_f32_16x16x32_bf16 v[128:131], a[152:155], v[88:91], v[128:131]
  ds_read_b128 a[184:187], v3 offset:22528
  v_add_f32 v226, v226, v221
  v_cvt_pk_bf16_f32 v186, v220, v221
  v_mfma_f32_16x16x32_bf16 v[136:139], a[152:155], v[92:95], v[136:139]
  v_exp_f32 v217, v153
  v_mfma_f32_16x16x32_bf16 v[132:135], a[156:159], v[88:91], v[132:135]
  ds_read_b128 a[188:191], v3 offset:23552
  buffer_load_dwordx4 v[168:171], v2, s[40:43], s14 offen offset:2048 sc1
  v_add_f32 v226, v226, v222
  v_mfma_f32_16x16x32_bf16 v[140:143], a[156:159], v[92:95], v[140:143]
  s_waitcnt lgkmcnt(4)
  v_exp_f32 v218, v154
  v_mfma_f32_16x16x32_bf16 a[64:67], a[160:163], v[176:179], a[64:67]
  ds_read_b128 a[128:131], v3 offset:0
  v_add_f32 v226, v226, v223
  v_cvt_pk_bf16_f32 v187, v222, v223
  v_mfma_f32_16x16x32_bf16 a[68:71], a[160:163], v[180:183], a[68:71]
  v_exp_f32 v219, v155
  v_mfma_f32_16x16x32_bf16 a[72:75], a[164:167], v[176:179], a[72:75]
  ds_read_b128 a[132:135], v3 offset:1024
  buffer_load_dwordx4 v2, s[44:47], s26 offen offset:2048 sc1 lds
  v_add_f32 v227, v216, v217
  v_mfma_f32_16x16x32_bf16 a[76:79], a[164:167], v[180:183], a[76:79]
  v_exp_f32 v220, v156
  v_mfma_f32_16x16x32_bf16 a[80:83], a[168:171], v[176:179], a[80:83]
  ds_read_b128 a[136:139], v3 offset:2048
  buffer_load_dwordx4 v[164:167], v2, s[40:43], s14 offen offset:1024 sc1
  v_cvt_pk_bf16_f32 v188, v216, v217
  v_mfma_f32_16x16x32_bf16 a[84:87], a[168:171], v[180:183], a[84:87]
  v_exp_f32 v221, v157
  v_mfma_f32_16x16x32_bf16 a[88:91], a[172:175], v[176:179], a[88:91]
  ds_read_b128 a[140:143], v3 offset:3072
  v_add_f32 v227, v227, v218
  v_add_f32 v227, v227, v219
  v_mfma_f32_16x16x32_bf16 a[92:95], a[172:175], v[180:183], a[92:95]
  s_waitcnt lgkmcnt(4)
  v_exp_f32 v222, v158
  v_mfma_f32_16x16x32_bf16 a[96:99], a[176:179], v[176:179], a[96:99]
  ds_read_b128 a[144:147], v3 offset:4096
  buffer_load_dwordx4 v2, s[44:47], s26 offen offset:3072 sc1 lds
  v_cvt_pk_bf16_f32 v189, v218, v219
  v_mfma_f32_16x16x32_bf16 a[100:103], a[176:179], v[180:183], a[100:103]
  s_add_u32 s26, s26, 16384
  v_exp_f32 v223, v159
  v_mfma_f32_16x16x32_bf16 a[104:107], a[180:183], v[176:179], a[104:107]
  s_add_u32 s24, s24, 32768
  ds_read_b128 a[148:151], v3 offset:5120
  buffer_load_dwordx4 v[160:163], v2, s[40:43], s14 offen offset:0 sc1
  v_add_f32 v227, v227, v220
  v_mfma_f32_16x16x32_bf16 a[108:111], a[180:183], v[180:183], a[108:111]
  s_and_b32 s24, s24, 0x1ffff
  v_add_f32 v227, v227, v221
  v_cvt_pk_bf16_f32 v190, v220, v221
  v_add_f32 v227, v227, v222
  v_mfma_f32_16x16x32_bf16 a[112:115], a[184:187], v[176:179], a[112:115]
  ds_read_b128 a[152:155], v3 offset:6144
  v_add_f32 v227, v227, v223
  v_max_f32 v5, v226, v227
  v_cmp_lt_f32 vcc, s81, v5
  v_mfma_f32_16x16x32_bf16 a[116:119], a[184:187], v[180:183], a[116:119]
  v_exp_f32 v216, v128
  v_mfma_f32_16x16x32_bf16 a[120:123], a[188:191], v[176:179], a[120:123]
  s_waitcnt lgkmcnt(3)
  ds_read_b128 a[156:159], v3 offset:7168
  v_cvt_pk_bf16_f32 v191, v222, v223
  v_mfma_f32_16x16x32_bf16 a[124:127], a[188:191], v[180:183], a[124:127]
  s_cbranch_vccnz fa_stub26
fa_back26:
  v_exp_f32 v217, v129
  v_add_f32 v230, v230, v226
  v_add_f32 v231, v231, v227
  v_mfma_f32_16x16x32_bf16 v[144:147], a[128:131], v[64:67], v[200:203]
  ds_read_b128 a[160:163], v3 offset:24576
  v_add_f32 v226, v216, v217
  v_mfma_f32_16x16x32_bf16 v[152:155], a[128:131], v[68:71], v[204:207]
  v_exp_f32 v218, v130
  v_mfma_f32_16x16x32_bf16 v[148:151], a[132:135], v[64:67], v[200:203]
  s_cmp_ge_u32 s27, s50
  s_cselect_b64 s[48:49], s[6:7], s[48:49]
  s_cselect_b32 s50, s30, s50
  ds_read_b128 a[164:167], v3 offset:25600
  v_cvt_pk_bf16_f32 v176, v216, v217
  v_mfma_f32_16x16x32_bf16 v[156:159], a[132:135], v[68:71], v[204:207]
  s_mov_b32 m0, s25
  v_exp_f32 v219, v131
  v_mfma_f32_16x16x32_bf16 v[144:147], a[136:139], v[72:75], v[144:147]
  s_add_u32 s66, s66, 32768
  ds_read_b128 a[168:171], v3 offset:26624
  buffer_load_dwordx4 v2, s[48:51], s27 offen offset:0 sc1 lds
  v_add_f32 v226, v226, v218
  v_add_f32 v226, v226, v219
  v_mfma_f32_16x16x32_bf16 v[152:155], a[136:139], v[76:79], v[152:155]
  s_and_b32 s66, s66, 0x1ffff
  v_exp_f32 v220, v132
  v_mfma_f32_16x16x32_bf16 v[148:151], a[140:143], v[72:75], v[148:151]
  s_add_u32 s14, s13, 12288
  ds_read_b128 a[172:175], v3 offset:27648
  buffer_load_dwordx4 v[124:127], v2, s[40:43], s14 offen offset:3072 sc1
  v_cvt_pk_bf16_f32 v177, v218, v219
  v_mfma_f32_16x16x32_bf16 v[156:159], a[140:143], v[76:79], v[156:159]
  s_waitcnt lgkmcnt(4)
  v_exp_f32 v221, v133
  v_mfma_f32_16x16x32_bf16 v[144:147], a[144:147], v[80:83], v[144:147]
  ds_read_b128 a[176:179], v3 offset:28672
  v_add_f32 v226, v226, v220
  v_mfma_f32_16x16x32_bf16 v[152:155], a[144:147], v[84:87], v[152:155]
  v_exp_f32 v222, v134
  v_mfma_f32_16x16x32_bf16 v[148:151], a[148:151], v[80:83], v[148:151]
  ds_read_b128 a[180:183], v3 offset:29696
  buffer_load_dwordx4 v2, s[48:51], s27 offen offset:1024 sc1 lds
  v_add_f32 v226, v226, v221
  v_cvt_pk_bf16_f32 v178, v220, v221
  v_mfma_f32_16x16x32_bf16 v[156:159], a[148:151], v[84:87], v[156:159]
  v_exp_f32 v223, v135
  v_mfma_f32_16x16x32_bf16 v[144:147], a[152:155], v[88:91], v[144:147]
  ds_read_b128 a[184:187], v3 offset:30720
  v_add_f32 v226, v226, v222
  v_mfma_f32_16x16x32_bf16 v[152:155], a[152:155], v[92:95], v[152:155]
  v_exp_f32 v216, v136
  v_mfma_f32_16x16x32_bf16 v[148:151], a[156:159], v[88:91], v[148:151]
  ds_read_b128 a[188:191], v3 offset:31744
  buffer_load_dwordx4 v[120:123], v2, s[40:43], s14 offen offset:2048 sc1
  v_add_f32 v226, v226, v223
  v_exp_f32 v217, v137
  v_mfma_f32_16x16x32_bf16 v[156:159], a[156:159], v[92:95], v[156:159]
  s_waitcnt lgkmcnt(4)
  v_exp_f32 v218, v138
  v_mfma_f32_16x16x32_bf16 a[64:67], a[160:163], v[184:187], a[64:67]
  ds_read_b128 a[128:131], v3 offset:8192
  v_cvt_pk_bf16_f32 v179, v222, v223
  v_mfma_f32_16x16x32_bf16 a[68:71], a[160:163], v[188:191], a[68:71]
  v_exp_f32 v219, v139
  v_mfma_f32_16x16x32_bf16 a[72:75], a[164:167], v[184:187], a[72:75]
  ds_read_b128 a[132:135], v3 offset:9216
  buffer_load_dwordx4 v2, s[48:51], s27 offen offset:2048 sc1 lds
  v_add_f32 v227, v216, v217
  v_mfma_f32_16x16x32_bf16 a[76:79], a[164:167], v[188:191], a[76:79]
  v_exp_f32 v220, v140
  v_mfma_f32_16x16x32_bf16 a[80:83], a[168:171], v[184:187], a[80:83]
  ds_read_b128 a[136:139], v3 offset:10240
  buffer_load_dwordx4 v[116:119], v2, s[40:43], s14 offen offset:1024 sc1
  v_cvt_pk_bf16_f32 v180, v216, v217
  v_mfma_f32_16x16x32_bf16 a[84:87], a[168:171], v[188:191], a[84:87]
  v_exp_f32 v221, v141
  v_mfma_f32_16x16x32_bf16 a[88:91], a[172:175], v[184:187], a[88:91]
  ds_read_b128 a[140:143], v3 offset:11264
  v_add_f32 v227, v227, v218
  v_mfma_f32_16x16x32_bf16 a[92:95], a[172:175], v[188:191], a[92:95]
  s_waitcnt lgkmcnt(4)
  v_exp_f32 v222, v142
  v_mfma_f32_16x16x32_bf16 a[96:99], a[176:179], v[184:187], a[96:99]
  ds_read_b128 a[144:147], v3 offset:12288
  buffer_load_dwordx4 v2, s[48:51], s27 offen offset:3072 sc1 lds
  v_add_f32 v227, v227, v219
  v_cvt_pk_bf16_f32 v181, v218, v219
  v_mfma_f32_16x16x32_bf16 a[100:103], a[176:179], v[188:191], a[100:103]
  s_add_u32 s27, s27, 16384
  v_exp_f32 v223, v143
  v_mfma_f32_16x16x32_bf16 a[104:107], a[180:183], v[184:187], a[104:107]
  s_add_u32 s25, s25, 32768
  ds_read_b128 a[148:151], v3 offset:13312
  buffer_load_dwordx4 v[112:115], v2, s[40:43], s14 offen offset:0 sc1
  v_add_f32 v227, v227, v220
  v_mfma_f32_16x16x32_bf16 a[108:111], a[180:183], v[188:191], a[108:111]
  s_and_b32 s25, s25, 0x1ffff
  v_add_f32 v227, v227, v221
  v_cvt_pk_bf16_f32 v182, v220, v221
  v_add_f32 v227, v227, v222
  v_mfma_f32_16x16x32_bf16 a[112:115], a[184:187], v[184:187], a[112:115]
  ds_read_b128 a[152:155], v3 offset:14336
  v_add_f32 v227, v227, v223
  v_max_f32 v5, v226, v227
  v_cmp_lt_f32 vcc, s81, v5
  v_mfma_f32_16x16x32_bf16 a[116:119], a[184:187], v[188:191], a[116:119]
  v_exp_f32 v216, v144
  v_mfma_f32_16x16x32_bf16 a[120:123], a[188:191], v[184:187], a[120:123]
  s_waitcnt lgkmcnt(3)
  ds_read_b128 a[156:159], v3 offset:15360
  v_cvt_pk_bf16_f32 v183, v222, v223
  v_add_u32 v3, s66, v2
  v_mfma_f32_16x16x32_bf16 a[124:127], a[188:191], v[188:191], a[124:127]
  s_cbranch_vccnz fa_stub27
fa_back27:
  v_exp_f32 v217, v145
  v_add_f32 v230, v230, v226
  v_add_f32 v231, v231, v227
fa_Bexit:
  s_bitcmp1_b32 s20, 0
  s_cbranch_scc1 fa_Bodd
  v_mfma_f32_16x16x32_bf16 v[128:131], a[128:131], v[64:67], v[200:203]
  s_waitcnt vmcnt(8)
  v_exp_f32 v218, v146
  v_mfma_f32_16x16x32_bf16 v[136:139], a[128:131], v[68:71], v[204:207]
  s_barrier
  v_exp_f32 v219, v147
  v_mfma_f32_16x16x32_bf16 v[132:135], a[132:135], v[64:67], v[200:203]
  ds_read_b128 a[160:163], v3 offset:16384
  ds_read_b128 a[164:167], v3 offset:17408
  v_add_f32 v226, v216, v217
  v_mfma_f32_16x16x32_bf16 v[140:143], a[132:135], v[68:71], v[204:207]
  s_add_u32 s14, s13, 8192
  buffer_load_dwordx4 v[108:111], v2, s[40:43], s14 offen offset:3072 sc1
  v_cvt_pk_bf16_f32 v184, v216, v217
  v_mfma_f32_16x16x32_bf16 v[128:131], a[136:139], v[72:75], v[128:131]
  ds_read_b128 a[168:171], v3 offset:18432
  v_add_f32 v226, v226, v218
  v_mfma_f32_16x16x32_bf16 v[136:139], a[136:139], v[76:79], v[136:139]
  v_exp_f32 v220, v148
  v_mfma_f32_16x16x32_bf16 v[132:135], a[140:143], v[72:75], v[132:135]
  ds_read_b128 a[172:175], v3 offset:19456
  v_add_f32 v226, v226, v219
  v_cvt_pk_bf16_f32 v185, v218, v219
  v_mfma_f32_16x16x32_bf16 v[140:143], a[140:143], v[76:79], v[140:143]
  s_waitcnt lgkmcnt(4)
  buffer_load_dwordx4 v[104:107], v2, s[40:43], s14 offen offset:2048 sc1
  v_add_f32 v226, v226, v220
  v_mfma_f32_16x16x32_bf16 v[128:131], a[144:147], v[80:83], v[128:131]
  ds_read_b128 a[176:179], v3 offset:20480
  v_mfma_f32_16x16x32_bf16 v[136:139], a[144:147], v[84:87], v[136:139]
  v_exp_f32 v221, v149
  v_mfma_f32_16x16x32_bf16 v[132:135], a[148:151], v[80:83], v[132:135]
  ds_read_b128 a[180:183], v3 offset:21504
  v_add_f32 v226, v226, v221
  v_mfma_f32_16x16x32_bf16 v[140:143], a[148:151], v[84:87], v[140:143]
  v_exp_f32 v222, v150
  v_mfma_f32_16x16x32_bf16 v[128:131], a[152:155], v[88:91], v[128:131]
  ds_read_b128 a[184:187], v3 offset:22528
  buffer_load_dwordx4 v[100:103], v2, s[40:43], s14 offen offset:1024 sc1
  v_cvt_pk_bf16_f32 v186, v220, v221
  v_mfma_f32_16x16x32_bf16 v[136:139], a[152:155], v[92:95], v[136:139]
  v_exp_f32 v223, v151
  v_mfma_f32_16x16x32_bf16 v[132:135], a[156:159], v[88:91], v[132:135]
  ds_read_b128 a[188:191], v3 offset:23552
  v_add_f32 v226, v226, v222
  v_add_f32 v226, v226, v223
  v_mfma_f32_16x16x32_bf16 v[140:143], a[156:159], v[92:95], v[140:143]
  s_waitcnt lgkmcnt(4)
  v_exp_f32 v216, v152
  v_mfma_f32_16x16x32_bf16 a[64:67], a[160:163], v[176:179], a[64:67]
  v_exp_f32 v217, v153
  v_mfma_f32_16x16x32_bf16 a[68:71], a[160:163], v[180:183], a[68:71]
  buffer_load_dwordx4 v[96:99], v2, s[40:43], s14 offen offset:0 sc1
  v_cvt_pk_bf16_f32 v187, v222, v223
  v_add_f32 v227, v216, v217
  v_mfma_f32_16x16x32_bf16 a[72:75], a[164:167], v[176:179], a[72:75]
  v_exp_f32 v218, v154
  v_mfma_f32_16x16x32_bf16 a[76:79], a[164:167], v[180:183], a[76:79]
  v_exp_f32 v219, v155
  v_mfma_f32_16x16x32_bf16 a[80:83], a[168:171], v[176:179], a[80:83]
  v_exp_f32 v220, v156
  v_mfma_f32_16x16x32_bf16 a[84:87], a[168:171], v[180:183], a[84:87]
  s_add_u32 s14, s13, 4096
  buffer_load_dwordx4 v[60:63], v2, s[40:43], s14 offen offset:3072 sc1
  v_cvt_pk_bf16_f32 v188, v216, v217
  v_add_f32 v227, v227, v218
  v_mfma_f32_16x16x32_bf16 a[88:91], a[172:175], v[176:179], a[88:91]
  v_exp_f32 v221, v157
  v_mfma_f32_16x16x32_bf16 a[92:95], a[172:175], v[180:183], a[92:95]
  s_waitcnt lgkmcnt(0)
  v_exp_f32 v222, v158
  v_mfma_f32_16x16x32_bf16 a[96:99], a[176:179], v[176:179], a[96:99]
  v_add_f32 v227, v227, v219
  v_cvt_pk_bf16_f32 v189, v218, v219
  v_mfma_f32_16x16x32_bf16 a[100:103], a[176:179], v[180:183], a[100:103]
  v_exp_f32 v223, v159
  v_mfma_f32_16x16x32_bf16 a[104:107], a[180:183], v[176:179], a[104:107]
  buffer_load_dwordx4 v[56:59], v2, s[40:43], s14 offen offset:2048 sc1
  v_add_f32 v227, v227, v220
  v_mfma_f32_16x16x32_bf16 a[108:111], a[180:183], v[180:183], a[108:111]
  v_add_f32 v227, v227, v221
  v_cvt_pk_bf16_f32 v190, v220, v221
  v_add_f32 v227, v227, v222
  v_mfma_f32_16x16x32_bf16 a[112:115], a[184:187], v[176:179], a[112:115]
  v_add_f32 v227, v227, v223
  v_max_f32 v5, v226, v227
  v_cmp_lt_f32 vcc, s81, v5
  v_mfma_f32_16x16x32_bf16 a[116:119], a[184:187], v[180:183], a[116:119]
  v_exp_f32 v216, v128
  v_mfma_f32_16x16x32_bf16 a[120:123], a[188:191], v[176:179], a[120:123]
  v_cvt_pk_bf16_f32 v191, v222, v223
  v_mfma_f32_16x16x32_bf16 a[124:127], a[188:191], v[180:183], a[124:127]
  s_cbranch_vccnz fa_stub28
fa_back28:
  v_exp_f32 v217, v129
  v_add_f32 v230, v230, v226
  v_add_f32 v231, v231, v227
  ds_read_b128 a[160:163], v3 offset:24576
  ds_read_b128 a[164:167], v3 offset:25600
  ds_read_b128 a[168:171], v3 offset:26624
  ds_read_b128 a[172:175], v3 offset:27648
  ds_read_b128 a[176:179], v3 offset:28672
  ds_read_b128 a[180:183], v3 offset:29696
  ds_read_b128 a[184:187], v3 offset:30720
  ds_read_b128 a[188:191], v3 offset:31744
  v_cndmask_b32 v128, v4, v128, s[68:69]
  v_cndmask_b32 v129, v4, v129, s[70:71]
  v_cndmask_b32 v130, v4, v130, s[72:73]
  v_cndmask_b32 v131, v4, v131, s[74:75]
  v_mov_b32 v132, v4
  v_mov_b32 v133, v4
  v_mov_b32 v134, v4
  v_mov_b32 v135, v4
  v_cndmask_b32 v140, v4, v140, s[68:69]
  v_cndmask_b32 v141, v4, v141, s[70:71]
  v_cndmask_b32 v142, v4, v142, s[72:73]
  v_cndmask_b32 v143, v4, v143, s[74:75]
  v_exp_f32 v216, v128
  v_exp_f32 v217, v129
  v_exp_f32 v218, v130
  v_add_f32 v226, v216, v217
  v_cvt_pk_bf16_f32 v176, v216, v217
  v_add_f32 v226, v226, v218
  v_exp_f32 v219, v131
  v_exp_f32 v220, v132
  v_add_f32 v226, v226, v219
  v_cvt_pk_bf16_f32 v177, v218, v219
  v_add_f32 v226, v226, v220
  v_exp_f32 v221, v133
  s_waitcnt lgkmcnt(4)
  v_mfma_f32_16x16x32_bf16 a[64:67], a[160:163], v[184:187], a[64:67]
  v_exp_f32 v222, v134
  v_add_f32 v226, v226, v221
  v_mfma_f32_16x16x32_bf16 a[68:71], a[160:163], v[188:191], a[68:71]
  s_add_u32 s14, s13, 4096
  buffer_load_dwordx4 v[52:55], v2, s[40:43], s14 offen offset:1024 sc1
  v_exp_f32 v223, v135
  v_mfma_f32_16x16x32_bf16 a[72:75], a[164:167], v[184:187], a[72:75]
  s_add_u32 s66, s66, 32768
  v_exp_f32 v216, v136
  v_mfma_f32_16x16x32_bf16 a[76:79], a[164:167], v[188:191], a[76:79]
  s_and_b32 s66, s66, 0x1ffff
  v_exp_f32 v217, v137
  v_mfma_f32_16x16x32_bf16 a[80:83], a[168:171], v[184:187], a[80:83]
  buffer_load_dwordx4 v[48:51], v2, s[40:43], s14 offen offset:0 sc1
  v_cvt_pk_bf16_f32 v178, v220, v221
  v_add_f32 v226, v226, v222
  v_add_f32 v226, v226, v223
  v_cvt_pk_bf16_f32 v179, v222, v223
  v_mfma_f32_16x16x32_bf16 a[84:87], a[168:171], v[188:191], a[84:87]
  v_exp_f32 v218, v138
  v_mfma_f32_16x16x32_bf16 a[88:91], a[172:175], v[184:187], a[88:91]
  v_exp_f32 v219, v139
  v_mfma_f32_16x16x32_bf16 a[92:95], a[172:175], v[188:191], a[92:95]
  s_waitcnt lgkmcnt(0)
  v_exp_f32 v220, v140
  v_mfma_f32_16x16x32_bf16 a[96:99], a[176:179], v[184:187], a[96:99]
  s_add_u32 s14, s13, 0
  buffer_load_dwordx4 v[44:47], v2, s[40:43], s14 offen offset:3072 sc1
  v_add_f32 v227, v216, v217
  v_cvt_pk_bf16_f32 v180, v216, v217
  v_add_f32 v227, v227, v218
  v_add_f32 v227, v227, v219
  v_cvt_pk_bf16_f32 v181, v218, v219
  v_exp_f32 v221, v141
  v_mfma_f32_16x16x32_bf16 a[100:103], a[176:179], v[188:191], a[100:103]
  v_exp_f32 v222, v142
  v_mfma_f32_16x16x32_bf16 a[104:107], a[180:183], v[184:187], a[104:107]
  v_exp_f32 v223, v143
  v_mfma_f32_16x16x32_bf16 a[108:111], a[180:183], v[188:191], a[108:111]
  buffer_load_dwordx4 v[40:43], v2, s[40:43], s14 offen offset:2048 sc1
  v_add_f32 v227, v227, v220
  v_add_f32 v227, v227, v221
  v_cvt_pk_bf16_f32 v182, v220, v221
  v_add_f32 v227, v227, v222
  v_mfma_f32_16x16x32_bf16 a[112:115], a[184:187], v[184:187], a[112:115]
  v_add_f32 v227, v227, v223
  v_max_f32 v5, v226, v227
  v_cmp_lt_f32 vcc, s81, v5
  v_mfma_f32_16x16x32_bf16 a[116:119], a[184:187], v[188:191], a[116:119]
  v_mfma_f32_16x16x32_bf16 a[120:123], a[188:191], v[184:187], a[120:123]
  v_cvt_pk_bf16_f32 v183, v222, v223
  v_add_u32 v3, s66, v2
  v_mfma_f32_16x16x32_bf16 a[124:127], a[188:191], v[188:191], a[124:127]
  s_cbranch_vccnz fa_stub29
fa_back29:
  v_add_f32 v230, v230, v226
  v_add_f32 v231, v231, v227
  s_cmp_ge_u32 s20, 2
  s_cbranch_scc1 fa_nb0
  s_waitcnt vmcnt(10)
  s_barrier
fa_nb0:
  ds_read_b128 a[160:163], v3 offset:16384
  ds_read_b128 a[164:167], v3 offset:17408
  ds_read_b128 a[168:171], v3 offset:18432
  ds_read_b128 a[172:175], v3 offset:19456
  ds_read_b128 a[176:179], v3 offset:20480
  ds_read_b128 a[180:183], v3 offset:21504
  ds_read_b128 a[184:187], v3 offset:22528
  ds_read_b128 a[188:191], v3 offset:23552
  s_waitcnt lgkmcnt(4)
  v_mfma_f32_16x16x32_bf16 a[64:67], a[160:163], v[176:179], a[64:67]
  v_mfma_f32_16x16x32_bf16 a[68:71], a[160:163], v[180:183], a[68:71]
  s_add_u32 s14, s13, 0
  buffer_load_dwordx4 v[36:39], v2, s[40:43], s14 offen offset:1024 sc1
  v_mfma_f32_16x16x32_bf16 a[72:75], a[164:167], v[176:179], a[72:75]
  v_mfma_f32_16x16x32_bf16 a[76:79], a[164:167], v[180:183], a[76:79]
  v_mfma_f32_16x16x32_bf16 a[80:83], a[168:171], v[176:179], a[80:83]
  v_mfma_f32_16x16x32_bf16 a[84:87], a[168:171], v[180:183], a[84:87]
  v_mfma_f32_16x16x32_bf16 a[88:91], a[172:175], v[176:179], a[88:91]
  v_mfma_f32_16x16x32_bf16 a[92:95], a[172:175], v[180:183], a[92:95]
  s_waitcnt lgkmcnt(0)
  v_mfma_f32_16x16x32_bf16 a[96:99], a[176:179], v[176:179], a[96:99]
  buffer_load_dwordx4 v[32:35], v2, s[40:43], s14 offen offset:0 sc1
  v_mfma_f32_16x16x32_bf16 a[100:103], a[176:179], v[180:183], a[100:103]
  v_mfma_f32_16x16x32_bf16 a[104:107], a[180:183], v[176:179], a[104:107]
  v_mfma_f32_16x16x32_bf16 a[108:111], a[180:183], v[180:183], a[108:111]
  v_mfma_f32_16x16x32_bf16 a[112:115], a[184:187], v[176:179], a[112:115]
  v_mfma_f32_16x16x32_bf16 a[116:119], a[184:187], v[180:183], a[116:119]
  v_mfma_f32_16x16x32_bf16 a[120:123], a[188:191], v[176:179], a[120:123]
  v_mfma_f32_16x16x32_bf16 a[124:127], a[188:191], v[180:183], a[124:127]
  s_branch fa_Bdone
fa_Bodd:
  s_cmp_ge_u32 s20, 2
  s_cbranch_scc1 fa_nb1
  s_waitcnt vmcnt(8)
  s_barrier
fa_nb1:
  ds_read_b128 a[160:163], v3 offset:16384
  ds_read_b128 a[164:167], v3 offset:17408
  ds_read_b128 a[168:171], v3 offset:18432
  ds_read_b128 a[172:175], v3 offset:19456
  ds_read_b128 a[176:179], v3 offset:20480
  ds_read_b128 a[180:183], v3 offset:21504
  ds_read_b128 a[184:187], v3 offset:22528
  ds_read_b128 a[188:191], v3 offset:23552
  v_cndmask_b32 v144, v4, v144, s[68:69]
  v_cndmask_b32 v145, v4, v145, s[70:71]
  v_cndmask_b32 v146, v4, v146, s[72:73]
  v_cndmask_b32 v147, v4, v147, s[74:75]
  v_mov_b32 v148, v4
  v_mov_b32 v149, v4
  v_mov_b32 v150, v4
  v_mov_b32 v151, v4
  v_cndmask_b32 v156, v4, v156, s[68:69]
  v_cndmask_b32 v157, v4, v157, s[70:71]
  v_cndmask_b32 v158, v4, v158, s[72:73]
  v_cndmask_b32 v159, v4, v159, s[74:75]
  v_exp_f32 v216, v144
  v_exp_f32 v217, v145
  v_exp_f32 v218, v146
  v_add_f32 v226, v216, v217
  v_cvt_pk_bf16_f32 v184, v216, v217
  v_add_f32 v226, v226, v218
  v_exp_f32 v219, v147
  v_exp_f32 v220, v148
  v_add_f32 v226, v226, v219
  v_cvt_pk_bf16_f32 v185, v218, v219
  v_add_f32 v226, v226, v220
  v_exp_f32 v221, v149
  s_waitcnt lgkmcnt(4)
  v_mfma_f32_16x16x32_bf16 a[64:67], a[160:163], v[176:179], a[64:67]
  v_exp_f32 v222, v150
  v_add_f32 v226, v226, v221
  v_mfma_f32_16x16x32_bf16 a[68:71], a[160:163], v[180:183], a[68:71]
  s_add_u32 s14, s13, 8192
  buffer_load_dwordx4 v[108:111], v2, s[40:43], s14 offen offset:3072 sc1
  v_exp_f32 v223, v151
  v_mfma_f32_16x16x32_bf16 a[72:75], a[164:167], v[176:179], a[72:75]
  v_exp_f32 v216, v152
  v_cvt_pk_bf16_f32 v186, v220, v221
  v_add_f32 v226, v226, v222
  v_mfma_f32_16x16x32_bf16 a[76:79], a[164:167], v[180:183], a[76:79]
  buffer_load_dwordx4 v[104:107], v2, s[40:43], s14 offen offset:2048 sc1
  v_exp_f32 v217, v153
  v_mfma_f32_16x16x32_bf16 a[80:83], a[168:171], v[176:179], a[80:83]
  v_exp_f32 v218, v154
  v_add_f32 v226, v226, v223
  v_mfma_f32_16x16x32_bf16 a[84:87], a[168:171], v[180:183], a[84:87]
  buffer_load_dwordx4 v[100:103], v2, s[40:43], s14 offen offset:1024 sc1
  v_exp_f32 v219, v155
  v_cvt_pk_bf16_f32 v187, v222, v223
  v_mfma_f32_16x16x32_bf16 a[88:91], a[172:175], v[176:179], a[88:91]
  v_exp_f32 v220, v156
  v_mfma_f32_16x16x32_bf16 a[92:95], a[172:175], v[180:183], a[92:95]
  s_waitcnt lgkmcnt(0)
  buffer_load_dwordx4 v[96:99], v2, s[40:43], s14 offen offset:0 sc1
  v_add_f32 v227, v216, v217
  v_cvt_pk_bf16_f32 v188, v216, v217
  v_add_f32 v227, v227, v218
  v_mfma_f32_16x16x32_bf16 a[96:99], a[176:179], v[176:179], a[96:99]
  v_exp_f32 v221, v157
  v_mfma_f32_16x16x32_bf16 a[100:103], a[176:179], v[180:183], a[100:103]
  s_add_u32 s14, s13, 4096
  buffer_load_dwordx4 v[60:63], v2, s[40:43], s14 offen offset:3072 sc1
  v_exp_f32 v222, v158
  v_mfma_f32_16x16x32_bf16 a[104:107], a[180:183], v[176:179], a[104:107]
  v_exp_f32 v223, v159
  v_mfma_f32_16x16x32_bf16 a[108:111], a[180:183], v[180:183], a[108:111]
  buffer_load_dwordx4 v[56:59], v2, s[40:43], s14 offen offset:2048 sc1
  v_add_f32 v227, v227, v219
  v_cvt_pk_bf16_f32 v189, v218, v219
  v_add_f32 v227, v227, v220
  v_add_f32 v227, v227, v221
  v_cvt_pk_bf16_f32 v190, v220, v221
  v_add_f32 v227, v227, v222
  v_mfma_f32_16x16x32_bf16 a[112:115], a[184:187], v[176:179], a[112:115]
  v_add_f32 v227, v227, v223
  v_max_f32 v5, v226, v227
  v_cmp_lt_f32 vcc, s81, v5
  v_mfma_f32_16x16x32_bf16 a[116:119], a[184:187], v[180:183], a[116:119]
  buffer_load_dwordx4 v[52:55], v2, s[40:43], s14 offen offset:1024 sc1
  v_mfma_f32_16x16x32_bf16 a[120:123], a[188:191], v[176:179], a[120:123]
  v_cvt_pk_bf16_f32 v191, v222, v223
  v_mfma_f32_16x16x32_bf16 a[124:127], a[188:191], v[180:183], a[124:127]
  s_cbranch_vccnz fa_stub30
fa_back30:
  v_add_f32 v230, v230, v226
  v_add_f32 v231, v231, v227
  ds_read_b128 a[160:163], v3 offset:24576
  ds_read_b128 a[164:167], v3 offset:25600
  ds_read_b128 a[168:171], v3 offset:26624
  ds_read_b128 a[172:175], v3 offset:27648
  ds_read_b128 a[176:179], v3 offset:28672
  ds_read_b128 a[180:183], v3 offset:29696
  ds_read_b128 a[184:187], v3 offset:30720
  ds_read_b128 a[188:191], v3 offset:31744
  s_waitcnt lgkmcnt(4)
  v_mfma_f32_16x16x32_bf16 a[64:67], a[160:163], v[184:187], a[64:67]
  v_mfma_f32_16x16x32_bf16 a[68:71], a[160:163], v[188:191], a[68:71]
  s_add_u32 s14, s13, 4096
  buffer_load_dwordx4 v[48:51], v2, s[40:43], s14 offen offset:0 sc1
  v_mfma_f32_16x16x32_bf16 a[72:75], a[164:167], v[184:187], a[72:75]
  s_add_u32 s66, s66, 32768
  v_mfma_f32_16x16x32_bf16 a[76:79], a[164:167], v[188:191], a[76:79]
  s_add_u32 s14, s13, 0
  buffer_load_dwordx4 v[44:47], v2, s[40:43], s14 offen offset:3072 sc1
  v_mfma_f32_16x16x32_bf16 a[80:83], a[168:171], v[184:187], a[80:83]
  s_and_b32 s66, s66, 0x1ffff
  v_mfma_f32_16x16x32_bf16 a[84:87], a[168:171], v[188:191], a[84:87]
  v_mfma_f32_16x16x32_bf16 a[88:91], a[172:175], v[184:187], a[88:91]
  buffer_load_dwordx4 v[40:43], v2, s[40:43], s14 offen offset:2048 sc1
  v_mfma_f32_16x16x32_bf16 a[92:95], a[172:175], v[188:191], a[92:95]
  s_waitcnt lgkmcnt(0)
  v_mfma_f32_16x16x32_bf16 a[96:99], a[176:179], v[184:187], a[96:99]
  v_mfma_f32_16x16x32_bf16 a[100:103], a[176:179], v[188:191], a[100:103]
  buffer_load_dwordx4 v[36:39], v2, s[40:43], s14 offen offset:1024 sc1
  v_mfma_f32_16x16x32_bf16 a[104:107], a[180:183], v[184:187], a[104:107]
  v_mfma_f32_16x16x32_bf16 a[108:111], a[180:183], v[188:191], a[108:111]
  v_mfma_f32_16x16x32_bf16 a[112:115], a[184:187], v[184:187], a[112:115]
  buffer_load_dwordx4 v[32:35], v2, s[40:43], s14 offen offset:0 sc1
  v_mfma_f32_16x16x32_bf16 a[116:119], a[184:187], v[188:191], a[116:119]
  v_mfma_f32_16x16x32_bf16 a[120:123], a[188:191], v[184:187], a[120:123]
  v_add_u32 v3, s66, v2
  v_mfma_f32_16x16x32_bf16 a[124:127], a[188:191], v[188:191], a[124:127]
fa_Bdone:
fa_epi:
  v_mov_b32 v20, v230
  v_mov_b32 v21, v231
  s_nop 1
  v_permlane16_swap_b32 v230, v20
  v_permlane16_swap_b32 v231, v21
  v_add_f32 v230, v230, v20
  v_add_f32 v231, v231, v21
  v_mov_b32 v20, v230
  v_mov_b32 v21, v231
  s_nop 1
  v_permlane32_swap_b32 v230, v20
  v_permlane32_swap_b32 v231, v21
  v_add_f32 v230, v230, v20
  v_add_f32 v231, v231, v21
  v_rcp_f32 v16, v230
  v_rcp_f32 v18, v231
  s_sub_u32 s23, 15, s22
  s_lshl_b32 s23, s23, 2
  v_mov_b32 v17, v16
  v_mov_b32 v19, v18
  s_add_u32 s23, s23, s20
  s_lshl_b32 s23, s23, 18
  s_lshl_b32 s31, s21, 12
  s_add_u32 s31, s31, 50331648
  s_add_u32 s64, s23, s31
  s_add_u32 s65, s64, 131072
  v_accvgpr_read_b32 v68, a64
  v_accvgpr_read_b32 v69, a65
  v_accvgpr_read_b32 v70, a66
  v_accvgpr_read_b32 v71, a67
  v_accvgpr_read_b32 v72, a72
  v_accvgpr_read_b32 v73, a73
  v_accvgpr_read_b32 v74, a74
  v_accvgpr_read_b32 v75, a75
  v_pk_mul_f32 v[68:69], v[68:69], v[16:17]
  v_pk_mul_f32 v[70:71], v[70:71], v[16:17]
  v_pk_mul_f32 v[72:73], v[72:73], v[16:17]
  v_pk_mul_f32 v[74:75], v[74:75], v[16:17]
  v_cvt_pk_bf16_f32 v64, v68, v69
  v_cvt_pk_bf16_f32 v65, v70, v71
  v_cvt_pk_bf16_f32 v66, v72, v73
  v_cvt_pk_bf16_f32 v67, v74, v75
  buffer_store_dwordx4 v[64:67], v2, s[40:43], s64 offen offset:0 sc1
  v_accvgpr_read_b32 v80, a80
  v_accvgpr_read_b32 v81, a81
  v_accvgpr_read_b32 v82, a82
  v_accvgpr_read_b32 v83, a83
  v_accvgpr_read_b32 v84, a88
  v_accvgpr_read_b32 v85, a89
  v_accvgpr_read_b32 v86, a90
  v_accvgpr_read_b32 v87, a91
  v_pk_mul_f32 v[80:81], v[80:81], v[16:17]
  v_pk_mul_f32 v[82:83], v[82:83], v[16:17]
  v_pk_mul_f32 v[84:85], v[84:85], v[16:17]
  v_pk_mul_f32 v[86:87], v[86:87], v[16:17]
  v_cvt_pk_bf16_f32 v76, v80, v81
  v_cvt_pk_bf16_f32 v77, v82, v83
  v_cvt_pk_bf16_f32 v78, v84, v85
  v_cvt_pk_bf16_f32 v79, v86, v87
  buffer_store_dwordx4 v[76:79], v2, s[40:43], s64 offen offset:1024 sc1
  v_accvgpr_read_b32 v132, a96
  v_accvgpr_read_b32 v133, a97
  v_accvgpr_read_b32 v134, a98
  v_accvgpr_read_b32 v135, a99
  v_accvgpr_read_b32 v136, a104
  v_accvgpr_read_b32 v137, a105
  v_accvgpr_read_b32 v138, a106
  v_accvgpr_read_b32 v139, a107
  v_pk_mul_f32 v[132:133], v[132:133], v[16:17]
  v_pk_mul_f32 v[134:135], v[134:135], v[16:17]
  v_pk_mul_f32 v[136:137], v[136:137], v[16:17]
  v_pk_mul_f32 v[138:139], v[138:139], v[16:17]
  v_cvt_pk_bf16_f32 v128, v132, v133
  v_cvt_pk_bf16_f32 v129, v134, v135
  v_cvt_pk_bf16_f32 v130, v136, v137
  v_cvt_pk_bf16_f32 v131, v138, v139
  buffer_store_dwordx4 v[128:131], v2, s[40:43], s64 offen offset:2048 sc1
  v_accvgpr_read_b32 v144, a112
  v_accvgpr_read_b32 v145, a113
  v_accvgpr_read_b32 v146, a114
  v_accvgpr_read_b32 v147, a115
  v_accvgpr_read_b32 v148, a120
  v_accvgpr_read_b32 v149, a121
  v_accvgpr_read_b32 v150, a122
  v_accvgpr_read_b32 v151, a123
  v_pk_mul_f32 v[144:145], v[144:145], v[16:17]
  v_pk_mul_f32 v[146:147], v[146:147], v[16:17]
  v_pk_mul_f32 v[148:149], v[148:149], v[16:17]
  v_pk_mul_f32 v[150:151], v[150:151], v[16:17]
  v_cvt_pk_bf16_f32 v140, v144, v145
  v_cvt_pk_bf16_f32 v141, v146, v147
  v_cvt_pk_bf16_f32 v142, v148, v149
  v_cvt_pk_bf16_f32 v143, v150, v151
  buffer_store_dwordx4 v[140:143], v2, s[40:43], s64 offen offset:3072 sc1
  v_accvgpr_read_b32 v68, a68
  v_accvgpr_read_b32 v69, a69
  v_accvgpr_read_b32 v70, a70
  v_accvgpr_read_b32 v71, a71
  v_accvgpr_read_b32 v72, a76
  v_accvgpr_read_b32 v73, a77
  v_accvgpr_read_b32 v74, a78
  v_accvgpr_read_b32 v75, a79
  v_pk_mul_f32 v[68:69], v[68:69], v[18:19]
  v_pk_mul_f32 v[70:71], v[70:71], v[18:19]
  v_pk_mul_f32 v[72:73], v[72:73], v[18:19]
  v_pk_mul_f32 v[74:75], v[74:75], v[18:19]
  v_cvt_pk_bf16_f32 v64, v68, v69
  v_cvt_pk_bf16_f32 v65, v70, v71
  v_cvt_pk_bf16_f32 v66, v72, v73
  v_cvt_pk_bf16_f32 v67, v74, v75
  buffer_store_dwordx4 v[64:67], v2, s[40:43], s65 offen offset:0 sc1
  v_accvgpr_read_b32 v80, a84
  v_accvgpr_read_b32 v81, a85
  v_accvgpr_read_b32 v82, a86
  v_accvgpr_read_b32 v83, a87
  v_accvgpr_read_b32 v84, a92
  v_accvgpr_read_b32 v85, a93
  v_accvgpr_read_b32 v86, a94
  v_accvgpr_read_b32 v87, a95
  v_pk_mul_f32 v[80:81], v[80:81], v[18:19]
  v_pk_mul_f32 v[82:83], v[82:83], v[18:19]
  v_pk_mul_f32 v[84:85], v[84:85], v[18:19]
  v_pk_mul_f32 v[86:87], v[86:87], v[18:19]
  v_cvt_pk_bf16_f32 v76, v80, v81
  v_cvt_pk_bf16_f32 v77, v82, v83
  v_cvt_pk_bf16_f32 v78, v84, v85
  v_cvt_pk_bf16_f32 v79, v86, v87
  buffer_store_dwordx4 v[76:79], v2, s[40:43], s65 offen offset:1024 sc1
  v_accvgpr_read_b32 v132, a100
  v_accvgpr_read_b32 v133, a101
  v_accvgpr_read_b32 v134, a102
  v_accvgpr_read_b32 v135, a103
  v_accvgpr_read_b32 v136, a108
  v_accvgpr_read_b32 v137, a109
  v_accvgpr_read_b32 v138, a110
  v_accvgpr_read_b32 v139, a111
  v_pk_mul_f32 v[132:133], v[132:133], v[18:19]
  v_pk_mul_f32 v[134:135], v[134:135], v[18:19]
  v_pk_mul_f32 v[136:137], v[136:137], v[18:19]
  v_pk_mul_f32 v[138:139], v[138:139], v[18:19]
  v_cvt_pk_bf16_f32 v128, v132, v133
  v_cvt_pk_bf16_f32 v129, v134, v135
  v_cvt_pk_bf16_f32 v130, v136, v137
  v_cvt_pk_bf16_f32 v131, v138, v139
  buffer_store_dwordx4 v[128:131], v2, s[40:43], s65 offen offset:2048 sc1
  v_accvgpr_read_b32 v144, a116
  v_accvgpr_read_b32 v145, a117
  v_accvgpr_read_b32 v146, a118
  v_accvgpr_read_b32 v147, a119
  v_accvgpr_read_b32 v148, a124
  v_accvgpr_read_b32 v149, a125
  v_accvgpr_read_b32 v150, a126
  v_accvgpr_read_b32 v151, a127
  v_pk_mul_f32 v[144:145], v[144:145], v[18:19]
  v_pk_mul_f32 v[146:147], v[146:147], v[18:19]
  v_pk_mul_f32 v[148:149], v[148:149], v[18:19]
  v_pk_mul_f32 v[150:151], v[150:151], v[18:19]
  v_cvt_pk_bf16_f32 v140, v144, v145
  v_cvt_pk_bf16_f32 v141, v146, v147
  v_cvt_pk_bf16_f32 v142, v148, v149
  v_cvt_pk_bf16_f32 v143, v150, v151
  buffer_store_dwordx4 v[140:143], v2, s[40:43], s65 offen offset:3072 sc1
  s_load_dwordx2 s[16:17], s[0:1], 88
  v_mov_b32 v30, 1073741824
  v_writelane_b32 v30, s80, 0
  v_writelane_b32 v30, s3, 1
  s_and_b32 s23, s2, 1
  s_lshl_b32 s23, s23, 2
  s_add_u32 s61, s23, s20
  s_lshl_b32 s23, s61, 14
  s_add_u32 s23, s23, 50331648
  s_lshl_b32 s63, s60, 19
  s_add_u32 s63, s63, s23
  s_xor_b32 s62, s63, 1048576
  s_add_u32 s64, s62, 0
  s_add_u32 s65, s64, 131072
  s_add_u32 s66, s64, 262144
  s_add_u32 s67, s64, 393216
  v_bfe_u32 v12, v1, 2, 1
  v_mul_u32_u24 v12, 4096, v12
  v_and_b32 v13, 3, v1
  v_lshl_add_u32 v12, v13, 7, v12
  s_lshl_b32 s31, s61, 9
  s_add_u32 s31, s31, 3801088
  s_mul_i32 s23, s60, 8192
  s_add_u32 s23, s23, s31
  v_add_u32 v10, s23, v12
  s_xor_b32 s23, s60, 2
  s_mul_i32 s23, s23, 8192
  s_add_u32 s23, s23, s31
  v_add_u32 v12, s23, v12
  v_mov_b32 v20, 0
  v_mov_b32 v21, 0
  v_mov_b32 v22, 0
  v_mov_b32 v23, 0
  v_add_u32 v16, 158208, v2
  ds_write_b128 v16, v[20:23]
  s_waitcnt vmcnt(0)
  buffer_store_dword v4, v30, s[40:43], 0 offen sc1
  s_setprio 0
  s_cmp_lt_u32 s12, 3
  s_cbranch_scc1 fa_hk9
fa_hb9:
  s_cmp_lt_u32 s29, 8
  s_cbranch_scc1 fa_left
fa_leftb:
  s_lshl_b32 s34, s28, 1
  s_and_b32 s23, s20, 1
  s_lshl_b32 s23, s23, 12
  s_cmp_lt_u32 s20, 2
  s_cselect_b32 s33, 106496, 0
  s_add_u32 s33, s33, s23
  s_add_u32 s33, s33, s34
  s_and_b32 s33, s33, 0x1ffff
  s_lshl_b32 s23, s20, 12
  s_add_u32 s34, s34, 49152
  s_add_u32 s34, s34, s23
  s_and_b32 s34, s34, 0x1ffff
  s_add_u32 s23, s23, s28
  s_cmp_lt_u32 s29, 3
  s_cselect_b32 s26, s23, s26
  s_cselect_b32 s27, s23, s27
  s_cselect_b32 s24, s33, s24
  s_cselect_b32 s25, s34, s25
  s_mov_b64 s[44:45], s[4:5]
  s_mov_b64 s[48:49], s[6:7]
  s_mov_b32 s46, s30
  s_mov_b32 s50, s30
  s_add_u32 s23, s28, 49152
fa_pk:
  s_cmp_ge_u32 s26, s23
  s_cbranch_scc1 fa_pkd
  s_mov_b32 m0, s24
  s_add_u32 s24, s24, 32768
  s_and_b32 s24, s24, 0x1ffff
  buffer_load_dwordx4 v2, s[44:47], s26 offen offset:0 sc1 lds
  buffer_load_dwordx4 v2, s[44:47], s26 offen offset:1024 sc1 lds
  buffer_load_dwordx4 v2, s[44:47], s26 offen offset:2048 sc1 lds
  buffer_load_dwordx4 v2, s[44:47], s26 offen offset:3072 sc1 lds
  s_add_u32 s26, s26, 16384
  s_branch fa_pk
fa_pkd:
  s_add_u32 s23, s28, 32768
fa_pv:
  s_cmp_ge_u32 s27, s23
  s_cbranch_scc1 fa_pvd
  s_mov_b32 m0, s25
  s_add_u32 s25, s25, 32768
  s_and_b32 s25, s25, 0x1ffff
  buffer_load_dwordx4 v2, s[48:51], s27 offen offset:0 sc1 lds
  buffer_load_dwordx4 v2, s[48:51], s27 offen offset:1024 sc1 lds
  buffer_load_dwordx4 v2, s[48:51], s27 offen offset:2048 sc1 lds
  buffer_load_dwordx4 v2, s[48:51], s27 offen offset:3072 sc1 lds
  s_add_u32 s27, s27, 16384
  s_branch fa_pv
fa_pvd:
  s_waitcnt lgkmcnt(0)
  s_barrier
  buffer_load_dword v13, v12, s[40:43], 0 offen sc1
  s_mul_i32 s28, s2, 24576
  s_add_u32 s28, s28, 10485760
  s_xor_b32 s23, s2, 1
  s_mul_i32 s29, s23, 24576
  s_add_u32 s29, s29, 10485760
  s_lshl_b32 s30, s2, 2
  s_add_u32 s30, s30, s20
  s_lshl_b32 s30, s30, 7
  s_add_u32 s30, s30, 67239936
  s_xor_b32 s35, s30, 512
  v_lshlrev_b32 v9, 4, v0
  v_mov_b32 v8, s35
  s_lshl_b32 s25, s60, 6
  s_add_u32 s25, s25, 1
  s_mul_i32 s26, s20, 5120
  s_add_u32 s26, s26, 131072
  s_mul_i32 s27, s20, 1024
  s_add_u32 s27, s27, 151552
  s_mov_b32 s48, s16
  s_mov_b32 s49, s17
  s_mov_b32 s50, 2621440
  s_mov_b32 s51, 0x20000
  s_waitcnt vmcnt(0)
  v_cmp_eq_u32 vcc, 0, v13
  s_cbranch_vccnz fa_ctx_spin
fa_ctx_ok:
  buffer_load_dwordx4 a[144:147], v2, s[40:43], s64 offen offset:0 sc1
  buffer_load_dwordx4 a[148:151], v2, s[40:43], s65 offen offset:0 sc1
  buffer_load_dwordx4 a[152:155], v2, s[40:43], s66 offen offset:0 sc1
  buffer_load_dwordx4 a[156:159], v2, s[40:43], s67 offen offset:0 sc1
  buffer_load_dwordx4 a[160:163], v2, s[40:43], s64 offen offset:1024 sc1
  buffer_load_dwordx4 a[164:167], v2, s[40:43], s65 offen offset:1024 sc1
  buffer_load_dwordx4 a[168:171], v2, s[40:43], s66 offen offset:1024 sc1
  buffer_load_dwordx4 a[172:175], v2, s[40:43], s67 offen offset:1024 sc1
  buffer_load_dwordx4 a[176:179], v2, s[40:43], s64 offen offset:2048 sc1
  buffer_load_dwordx4 a[180:183], v2, s[40:43], s65 offen offset:2048 sc1
  buffer_load_dwordx4 a[184:187], v2, s[40:43], s66 offen offset:2048 sc1
  buffer_load_dwordx4 a[188:191], v2, s[40:43], s67 offen offset:2048 sc1
  buffer_load_dwordx4 v[216:219], v2, s[40:43], s64 offen offset:3072 sc1
  buffer_load_dwordx4 v[220:223], v2, s[40:43], s65 offen offset:3072 sc1
  buffer_load_dwordx4 v[224:227], v2, s[40:43], s66 offen offset:3072 sc1
  buffer_load_dwordx4 v[228:231], v2, s[40:43], s67 offen offset:3072 sc1
  v_add_u32 v11, s33, v2
  s_add_u32 s33, s33, 32768
  s_and_b32 s33, s33, 0x1ffff
  ds_read_b128 v[64:67], v11 offset:0
  ds_read_b128 v[68:71], v11 offset:1024
  ds_read_b128 v[72:75], v11 offset:2048
  ds_read_b128 v[76:79], v11 offset:3072
  v_add_u32 v11, s33, v2
  s_add_u32 s33, s33, 32768
  s_and_b32 s33, s33, 0x1ffff
  ds_read_b128 v[128:131], v11 offset:0
  ds_read_b128 v[132:135], v11 offset:1024
  ds_read_b128 v[136:139], v11 offset:2048
  ds_read_b128 v[140:143], v11 offset:3072
  v_add_u32 v11, s33, v2
  s_add_u32 s33, s33, 32768
  s_and_b32 s33, s33, 0x1ffff
  ds_read_b128 v[176:179], v11 offset:0
  ds_read_b128 v[180:183], v11 offset:1024
  ds_read_b128 v[184:187], v11 offset:2048
  ds_read_b128 v[188:191], v11 offset:3072
  v_add_u32 v11, s34, v2
  s_add_u32 s34, s34, 32768
  s_and_b32 s34, s34, 0x1ffff
  ds_read_b128 v[80:83], v11 offset:0
  ds_read_b128 v[84:87], v11 offset:1024
  ds_read_b128 v[88:91], v11 offset:2048
  ds_read_b128 v[92:95], v11 offset:3072
  v_add_u32 v11, s34, v2
  s_add_u32 s34, s34, 32768
  s_and_b32 s34, s34, 0x1ffff
  ds_read_b128 v[144:147], v11 offset:0
  ds_read_b128 v[148:151], v11 offset:1024
  ds_read_b128 v[152:155], v11 offset:2048
  ds_read_b128 v[156:159], v11 offset:3072
  s_add_u32 s64, s64, 4096
  s_add_u32 s65, s64, 131072
  s_add_u32 s66, s64, 262144
  s_add_u32 s67, s64, 393216
  s_waitcnt vmcnt(14) lgkmcnt(0)
  v_mfma_f32_16x16x32_bf16 a[64:67], v[32:35], a[144:147], 0
  v_add_u32 v200, s26, v2
  v_mfma_f32_16x16x32_bf16 a[80:83], v[36:39], a[144:147], 0
  v_add_u32 v201, s27, v2
  v_mfma_f32_16x16x32_bf16 a[96:99], v[40:43], a[144:147], 0
  s_mul_i32 s24, s20, 21504
  v_add_u32 v16, 0, v0
  v_mfma_f32_16x16x32_bf16 a[112:115], v[44:47], a[144:147], 0
  v_mul_u32_u24 v17, 6554, v16
  v_mfma_f32_16x16x32_bf16 a[128:131], v[48:51], a[144:147], 0
  buffer_load_dwordx4 a[144:147], v2, s[40:43], s64 offen offset:0 sc1
  v_mfma_f32_16x16x32_bf16 a[68:71], v[32:35], a[148:151], 0
  v_lshrrev_b32 v17, 16, v17
  v_mfma_f32_16x16x32_bf16 a[84:87], v[36:39], a[148:151], 0
  v_mul_u32_u24 v18, 10, v17
  v_mfma_f32_16x16x32_bf16 a[100:103], v[40:43], a[148:151], 0
  v_sub_u32 v18, v16, v18
  v_mfma_f32_16x16x32_bf16 a[116:119], v[44:47], a[148:151], 0
  v_lshlrev_b32 v203, 5, v18
  v_mfma_f32_16x16x32_bf16 a[132:135], v[48:51], a[148:151], 0
  s_waitcnt vmcnt(13)
  buffer_load_dwordx4 a[148:151], v2, s[40:43], s65 offen offset:0 sc1
  v_mfma_f32_16x16x32_bf16 a[72:75], v[32:35], a[152:155], 0
  v_add_u32 v24, s25, v17
  v_mfma_f32_16x16x32_bf16 a[88:91], v[36:39], a[152:155], 0
  v_mov_b32 v27, 8
  v_mfma_f32_16x16x32_bf16 a[104:107], v[40:43], a[152:155], 0
  v_add_u32 v16, 256, v0
  v_mfma_f32_16x16x32_bf16 a[120:123], v[44:47], a[152:155], 0
  v_mul_u32_u24 v17, 6554, v16
  v_mfma_f32_16x16x32_bf16 a[136:139], v[48:51], a[152:155], 0
  buffer_load_dwordx4 a[152:155], v2, s[40:43], s66 offen offset:0 sc1
  v_mfma_f32_16x16x32_bf16 a[76:79], v[32:35], a[156:159], 0
  v_lshrrev_b32 v17, 16, v17
  v_mfma_f32_16x16x32_bf16 a[92:95], v[36:39], a[156:159], 0
  v_mul_u32_u24 v18, 10, v17
  v_mfma_f32_16x16x32_bf16 a[108:111], v[40:43], a[156:159], 0
  v_sub_u32 v18, v16, v18
  v_mfma_f32_16x16x32_bf16 a[124:127], v[44:47], a[156:159], 0
  v_lshlrev_b32 v204, 5, v18
  v_mfma_f32_16x16x32_bf16 a[140:143], v[48:51], a[156:159], 0
  s_waitcnt vmcnt(13)
  buffer_load_dwordx4 a[156:159], v2, s[40:43], s67 offen offset:0 sc1
  v_mfma_f32_16x16x32_bf16 a[64:67], v[52:55], a[160:163], a[64:67]
  v_add_u32 v25, s25, v17
  v_mfma_f32_16x16x32_bf16 a[80:83], v[56:59], a[160:163], a[80:83]
  v_mov_b32 v28, 8
  v_mfma_f32_16x16x32_bf16 a[96:99], v[60:63], a[160:163], a[96:99]
  v_add_u32 v16, 512, v0
  v_mfma_f32_16x16x32_bf16 a[112:115], v[96:99], a[160:163], a[112:115]
  v_mul_u32_u24 v17, 6554, v16
  v_mfma_f32_16x16x32_bf16 a[128:131], v[100:103], a[160:163], a[128:131]
  buffer_load_dwordx4 a[160:163], v2, s[40:43], s64 offen offset:1024 sc1
  v_mfma_f32_16x16x32_bf16 a[68:71], v[52:55], a[164:167], a[68:71]
  v_lshrrev_b32 v17, 16, v17
  v_mfma_f32_16x16x32_bf16 a[84:87], v[56:59], a[164:167], a[84:87]
  v_mul_u32_u24 v18, 10, v17
  v_mfma_f32_16x16x32_bf16 a[100:103], v[60:63], a[164:167], a[100:103]
  v_sub_u32 v18, v16, v18
  v_mfma_f32_16x16x32_bf16 a[116:119], v[96:99], a[164:167], a[116:119]
  v_lshlrev_b32 v205, 5, v18
  v_mfma_f32_16x16x32_bf16 a[132:135], v[100:103], a[164:167], a[132:135]
  s_waitcnt vmcnt(13)
  buffer_load_dwordx4 a[164:167], v2, s[40:43], s65 offen offset:1024 sc1
  v_mfma_f32_16x16x32_bf16 a[72:75], v[52:55], a[168:171], a[72:75]
  v_add_u32 v26, s25, v17
  v_mfma_f32_16x16x32_bf16 a[88:91], v[56:59], a[168:171], a[88:91]
  v_mov_b32 v29, 8
  v_mfma_f32_16x16x32_bf16 a[104:107], v[60:63], a[168:171], a[104:107]
  v_readlane_b32 s68, v15, 0
  v_mfma_f32_16x16x32_bf16 a[120:123], v[96:99], a[168:171], a[120:123]
  v_readlane_b32 s69, v15, 1
  v_mfma_f32_16x16x32_bf16 a[136:139], v[100:103], a[168:171], a[136:139]
  buffer_load_dwordx4 a[168:171], v2, s[40:43], s66 offen offset:1024 sc1
  v_mfma_f32_16x16x32_bf16 a[76:79], v[52:55], a[172:175], a[76:79]
  v_readlane_b32 s70, v15, 2
  v_mfma_f32_16x16x32_bf16 a[92:95], v[56:59], a[172:175], a[92:95]
  v_readlane_b32 s71, v15, 3
  v_mfma_f32_16x16x32_bf16 a[108:111], v[60:63], a[172:175], a[108:111]
  v_readlane_b32 s72, v15, 4
  v_mfma_f32_16x16x32_bf16 a[124:127], v[96:99], a[172:175], a[124:127]
  v_readlane_b32 s73, v15, 5
  v_mfma_f32_16x16x32_bf16 a[140:143], v[100:103], a[172:175], a[140:143]
  s_waitcnt vmcnt(13)
  buffer_load_dwordx4 a[172:175], v2, s[40:43], s67 offen offset:1024 sc1
  v_mfma_f32_16x16x32_bf16 a[64:67], v[104:107], a[176:179], a[64:67]
  v_readlane_b32 s74, v15, 6
  v_mfma_f32_16x16x32_bf16 a[80:83], v[108:111], a[176:179], a[80:83]
  v_readlane_b32 s75, v15, 7
  v_mfma_f32_16x16x32_bf16 a[96:99], v[112:115], a[176:179], a[96:99]
  v_cmp_eq_u32 s[52:53], s68, v24
  v_mfma_f32_16x16x32_bf16 a[112:115], v[116:119], a[176:179], a[112:115]
  v_cmp_eq_u32 s[54:55], s68, v25
  v_mfma_f32_16x16x32_bf16 a[128:131], v[120:123], a[176:179], a[128:131]
  buffer_load_dwordx4 a[176:179], v2, s[40:43], s64 offen offset:2048 sc1
  v_mfma_f32_16x16x32_bf16 a[68:71], v[104:107], a[180:183], a[68:71]
  v_cmp_eq_u32 s[56:57], s68, v26
  v_mfma_f32_16x16x32_bf16 a[84:87], v[108:111], a[180:183], a[84:87]
  v_cndmask_b32 v27, v27, 0, s[52:53]
  v_mfma_f32_16x16x32_bf16 a[100:103], v[112:115], a[180:183], a[100:103]
  v_cndmask_b32 v28, v28, 0, s[54:55]
  v_mfma_f32_16x16x32_bf16 a[116:119], v[116:119], a[180:183], a[116:119]
  v_cndmask_b32 v29, v29, 0, s[56:57]
  v_mfma_f32_16x16x32_bf16 a[132:135], v[120:123], a[180:183], a[132:135]
  s_waitcnt vmcnt(13)
  buffer_load_dwordx4 a[180:183], v2, s[40:43], s65 offen offset:2048 sc1
  v_mfma_f32_16x16x32_bf16 a[72:75], v[104:107], a[184:187], a[72:75]
  v_cmp_eq_u32 s[52:53], s69, v24
  v_mfma_f32_16x16x32_bf16 a[88:91], v[108:111], a[184:187], a[88:91]
  v_cmp_eq_u32 s[54:55], s69, v25
  v_mfma_f32_16x16x32_bf16 a[104:107], v[112:115], a[184:187], a[104:107]
  v_cmp_eq_u32 s[56:57], s69, v26
  v_mfma_f32_16x16x32_bf16 a[120:123], v[116:119], a[184:187], a[120:123]
  v_cndmask_b32 v27, v27, 1, s[52:53]
  v_mfma_f32_16x16x32_bf16 a[136:139], v[120:123], a[184:187], a[136:139]
  buffer_load_dwordx4 a[184:187], v2, s[40:43], s66 offen offset:2048 sc1
  v_mfma_f32_16x16x32_bf16 a[76:79], v[104:107], a[188:191], a[76:79]
  v_cndmask_b32 v28, v28, 1, s[54:55]
  v_mfma_f32_16x16x32_bf16 a[92:95], v[108:111], a[188:191], a[92:95]
  v_cndmask_b32 v29, v29, 1, s[56:57]
  v_mfma_f32_16x16x32_bf16 a[108:111], v[112:115], a[188:191], a[108:111]
  v_cmp_eq_u32 s[52:53], s70, v24
  v_mfma_f32_16x16x32_bf16 a[124:127], v[116:119], a[188:191], a[124:127]
  v_cmp_eq_u32 s[54:55], s70, v25
  v_mfma_f32_16x16x32_bf16 a[140:143], v[120:123], a[188:191], a[140:143]
  s_waitcnt vmcnt(13)
  buffer_load_dwordx4 a[188:191], v2, s[40:43], s67 offen offset:2048 sc1
  v_mfma_f32_16x16x32_bf16 a[64:67], v[124:127], v[216:219], a[64:67]
  v_cmp_eq_u32 s[56:57], s70, v26
  v_mfma_f32_16x16x32_bf16 a[80:83], v[160:163], v[216:219], a[80:83]
  v_cndmask_b32 v27, v27, 2, s[52:53]
  v_mfma_f32_16x16x32_bf16 a[96:99], v[164:167], v[216:219], a[96:99]
  v_cndmask_b32 v28, v28, 2, s[54:55]
  v_mfma_f32_16x16x32_bf16 a[112:115], v[168:171], v[216:219], a[112:115]
  v_cndmask_b32 v29, v29, 2, s[56:57]
  v_mfma_f32_16x16x32_bf16 a[128:131], v[172:175], v[216:219], a[128:131]
  buffer_load_dwordx4 v[216:219], v2, s[40:43], s64 offen offset:3072 sc1
  v_mfma_f32_16x16x32_bf16 a[68:71], v[124:127], v[220:223], a[68:71]
  v_cmp_eq_u32 s[52:53], s71, v24
  v_mfma_f32_16x16x32_bf16 a[84:87], v[160:163], v[220:223], a[84:87]
  v_cmp_eq_u32 s[54:55], s71, v25
  v_mfma_f32_16x16x32_bf16 a[100:103], v[164:167], v[220:223], a[100:103]
  v_cmp_eq_u32 s[56:57], s71, v26
  v_mfma_f32_16x16x32_bf16 a[116:119], v[168:171], v[220:223], a[116:119]
  v_cndmask_b32 v27, v27, 3, s[52:53]
  v_mfma_f32_16x16x32_bf16 a[132:135], v[172:175], v[220:223], a[132:135]
  s_waitcnt vmcnt(13)
  buffer_load_dwordx4 v[220:223], v2, s[40:43], s65 offen offset:3072 sc1
  v_mfma_f32_16x16x32_bf16 a[72:75], v[124:127], v[224:227], a[72:75]
  v_cndmask_b32 v28, v28, 3, s[54:55]
  v_mfma_f32_16x16x32_bf16 a[88:91], v[160:163], v[224:227], a[88:91]
  v_cndmask_b32 v29, v29, 3, s[56:57]
  v_mfma_f32_16x16x32_bf16 a[104:107], v[164:167], v[224:227], a[104:107]
  v_cmp_eq_u32 s[52:53], s72, v24
  v_mfma_f32_16x16x32_bf16 a[120:123], v[168:171], v[224:227], a[120:123]
  v_cmp_eq_u32 s[54:55], s72, v25
  v_mfma_f32_16x16x32_bf16 a[136:139], v[172:175], v[224:227], a[136:139]
  buffer_load_dwordx4 v[224:227], v2, s[40:43], s66 offen offset:3072 sc1
  v_mfma_f32_16x16x32_bf16 a[76:79], v[124:127], v[228:231], a[76:79]
  v_cmp_eq_u32 s[56:57], s72, v26
  v_mfma_f32_16x16x32_bf16 a[92:95], v[160:163], v[228:231], a[92:95]
  v_cndmask_b32 v27, v27, 4, s[52:53]
  v_mfma_f32_16x16x32_bf16 a[108:111], v[164:167], v[228:231], a[108:111]
  v_cndmask_b32 v28, v28, 4, s[54:55]
  v_mfma_f32_16x16x32_bf16 a[124:127], v[168:171], v[228:231], a[124:127]
  v_cndmask_b32 v29, v29, 4, s[56:57]
  v_mfma_f32_16x16x32_bf16 a[140:143], v[172:175], v[228:231], a[140:143]
  s_waitcnt vmcnt(13)
  buffer_load_dwordx4 v[228:231], v2, s[40:43], s67 offen offset:3072 sc1
  v_mfma_f32_16x16x32_bf16 a[64:67], v[232:235], a[144:147], a[64:67]
  v_cmp_eq_u32 s[52:53], s73, v24
  v_mfma_f32_16x16x32_bf16 a[80:83], v[236:239], a[144:147], a[80:83]
  v_cmp_eq_u32 s[54:55], s73, v25
  v_mfma_f32_16x16x32_bf16 a[96:99], v[240:243], a[144:147], a[96:99]
  v_cmp_eq_u32 s[56:57], s73, v26
  v_mfma_f32_16x16x32_bf16 a[112:115], v[244:247], a[144:147], a[112:115]
  s_add_u32 s64, s64, 4096
  v_cndmask_b32 v27, v27, 5, s[52:53]
  v_mfma_f32_16x16x32_bf16 a[128:131], v[192:195], a[144:147], a[128:131]
  buffer_load_dwordx4 a[144:147], v2, s[40:43], s64 offen offset:0 sc1
  v_mfma_f32_16x16x32_bf16 a[68:71], v[232:235], a[148:151], a[68:71]
  s_add_u32 s65, s64, 131072
  v_cndmask_b32 v28, v28, 5, s[54:55]
  v_mfma_f32_16x16x32_bf16 a[84:87], v[236:239], a[148:151], a[84:87]
  s_add_u32 s66, s64, 262144
  v_cndmask_b32 v29, v29, 5, s[56:57]
  v_mfma_f32_16x16x32_bf16 a[100:103], v[240:243], a[148:151], a[100:103]
  v_cmp_eq_u32 s[52:53], s74, v24
  v_mfma_f32_16x16x32_bf16 a[116:119], v[244:247], a[148:151], a[116:119]
  v_cmp_eq_u32 s[54:55], s74, v25
  v_mfma_f32_16x16x32_bf16 a[132:135], v[192:195], a[148:151], a[132:135]
  s_waitcnt vmcnt(13)
  buffer_load_dwordx4 a[148:151], v2, s[40:43], s65 offen offset:0 sc1
  v_mfma_f32_16x16x32_bf16 a[72:75], v[232:235], a[152:155], a[72:75]
  s_add_u32 s67, s64, 393216
  v_cmp_eq_u32 s[56:57], s74, v26
  v_mfma_f32_16x16x32_bf16 a[88:91], v[236:239], a[152:155], a[88:91]
  v_cndmask_b32 v27, v27, 6, s[52:53]
  v_mfma_f32_16x16x32_bf16 a[104:107], v[240:243], a[152:155], a[104:107]
  v_cndmask_b32 v28, v28, 6, s[54:55]
  v_mfma_f32_16x16x32_bf16 a[120:123], v[244:247], a[152:155], a[120:123]
  v_cndmask_b32 v29, v29, 6, s[56:57]
  v_mfma_f32_16x16x32_bf16 a[136:139], v[192:195], a[152:155], a[136:139]
  buffer_load_dwordx4 a[152:155], v2, s[40:43], s66 offen offset:0 sc1
  v_mfma_f32_16x16x32_bf16 a[76:79], v[232:235], a[156:159], a[76:79]
  v_cmp_eq_u32 s[52:53], s75, v24
  v_mfma_f32_16x16x32_bf16 a[92:95], v[236:239], a[156:159], a[92:95]
  v_cmp_eq_u32 s[54:55], s75, v25
  v_mfma_f32_16x16x32_bf16 a[108:111], v[240:243], a[156:159], a[108:111]
  v_cmp_eq_u32 s[56:57], s75, v26
  v_mfma_f32_16x16x32_bf16 a[124:127], v[244:247], a[156:159], a[124:127]
  v_cndmask_b32 v27, v27, 7, s[52:53]
  v_mfma_f32_16x16x32_bf16 a[140:143], v[192:195], a[156:159], a[140:143]
  s_waitcnt vmcnt(13)
  buffer_load_dwordx4 a[156:159], v2, s[40:43], s67 offen offset:0 sc1
  v_mfma_f32_16x16x32_bf16 a[64:67], v[196:199], a[160:163], a[64:67]
  v_cndmask_b32 v28, v28, 7, s[54:55]
  v_mfma_f32_16x16x32_bf16 a[80:83], v[208:211], a[160:163], a[80:83]
  v_cndmask_b32 v29, v29, 7, s[56:57]
  v_mfma_f32_16x16x32_bf16 a[96:99], v[212:215], a[160:163], a[96:99]
  v_mul_u32_u24 v27, 320, v27
  v_mfma_f32_16x16x32_bf16 a[112:115], a[0:3], a[160:163], a[112:115]
  v_add_u32 v203, v203, v27
  v_mfma_f32_16x16x32_bf16 a[128:131], a[4:7], a[160:163], a[128:131]
  buffer_load_dwordx4 a[160:163], v2, s[40:43], s64 offen offset:1024 sc1
  v_mfma_f32_16x16x32_bf16 a[68:71], v[196:199], a[164:167], a[68:71]
  v_add_u32 v203, 155648, v203
  v_mfma_f32_16x16x32_bf16 a[84:87], v[208:211], a[164:167], a[84:87]
  v_mul_u32_u24 v28, 320, v28
  v_mfma_f32_16x16x32_bf16 a[100:103], v[212:215], a[164:167], a[100:103]
  v_add_u32 v204, v204, v28
  v_mfma_f32_16x16x32_bf16 a[116:119], a[0:3], a[164:167], a[116:119]
  v_add_u32 v204, 155648, v204
  v_mfma_f32_16x16x32_bf16 a[132:135], a[4:7], a[164:167], a[132:135]
  s_waitcnt vmcnt(13)
  buffer_load_dwordx4 a[164:167], v2, s[40:43], s65 offen offset:1024 sc1
  v_mfma_f32_16x16x32_bf16 a[72:75], v[196:199], a[168:171], a[72:75]
  v_mul_u32_u24 v29, 320, v29
  v_mfma_f32_16x16x32_bf16 a[88:91], v[208:211], a[168:171], a[88:91]
  v_add_u32 v205, v205, v29
  v_mfma_f32_16x16x32_bf16 a[104:107], v[212:215], a[168:171], a[104:107]
  v_add_u32 v205, 155648, v205
  v_mfma_f32_16x16x32_bf16 a[120:123], a[0:3], a[168:171], a[120:123]
  v_and_b32 v16, 15, v1
  v_mfma_f32_16x16x32_bf16 a[136:139], a[4:7], a[168:171], a[136:139]
  buffer_load_dwordx4 a[168:171], v2, s[40:43], s66 offen offset:1024 sc1
  v_mfma_f32_16x16x32_bf16 a[76:79], v[196:199], a[172:175], a[76:79]
  v_mul_u32_u24 v16, 336, v16
  v_mfma_f32_16x16x32_bf16 a[92:95], v[208:211], a[172:175], a[92:95]
  v_lshrrev_b32 v17, 4, v1
  v_mfma_f32_16x16x32_bf16 a[108:111], v[212:215], a[172:175], a[108:111]
  v_lshl_add_u32 v16, v17, 4, v16
  v_mfma_f32_16x16x32_bf16 a[124:127], a[0:3], a[172:175], a[124:127]
  v_add_u32 v16, s24, v16
  v_mfma_f32_16x16x32_bf16 a[140:143], a[4:7], a[172:175], a[140:143]
  s_waitcnt vmcnt(13)
  buffer_load_dwordx4 a[172:175], v2, s[40:43], s67 offen offset:1024 sc1
  v_mfma_f32_16x16x32_bf16 a[64:67], a[8:11], a[176:179], a[64:67]
  v_mfma_f32_16x16x32_bf16 a[80:83], a[12:15], a[176:179], a[80:83]
  v_mfma_f32_16x16x32_bf16 a[96:99], v[64:67], a[176:179], a[96:99]
  v_mfma_f32_16x16x32_bf16 a[112:115], v[68:71], a[176:179], a[112:115]
  v_mfma_f32_16x16x32_bf16 a[128:131], v[72:75], a[176:179], a[128:131]
  buffer_load_dwordx4 a[176:179], v2, s[40:43], s64 offen offset:2048 sc1
  v_mfma_f32_16x16x32_bf16 a[68:71], a[8:11], a[180:183], a[68:71]
  v_mfma_f32_16x16x32_bf16 a[84:87], a[12:15], a[180:183], a[84:87]
  v_mfma_f32_16x16x32_bf16 a[100:103], v[64:67], a[180:183], a[100:103]
  v_mfma_f32_16x16x32_bf16 a[116:119], v[68:71], a[180:183], a[116:119]
  v_mfma_f32_16x16x32_bf16 a[132:135], v[72:75], a[180:183], a[132:135]
  s_waitcnt vmcnt(13)
  buffer_load_dwordx4 a[180:183], v2, s[40:43], s65 offen offset:2048 sc1
  v_mfma_f32_16x16x32_bf16 a[72:75], a[8:11], a[184:187], a[72:75]
  v_mfma_f32_16x16x32_bf16 a[88:91], a[12:15], a[184:187], a[88:91]
  v_mfma_f32_16x16x32_bf16 a[104:107], v[64:67], a[184:187], a[104:107]
  v_mfma_f32_16x16x32_bf16 a[120:123], v[68:71], a[184:187], a[120:123]
  v_mfma_f32_16x16x32_bf16 a[136:139], v[72:75], a[184:187], a[136:139]
  buffer_load_dwordx4 a[184:187], v2, s[40:43], s66 offen offset:2048 sc1
  v_mfma_f32_16x16x32_bf16 a[76:79], a[8:11], a[188:191], a[76:79]
  v_mfma_f32_16x16x32_bf16 a[92:95], a[12:15], a[188:191], a[92:95]
  v_mfma_f32_16x16x32_bf16 a[108:111], v[64:67], a[188:191], a[108:111]
  v_mfma_f32_16x16x32_bf16 a[124:127], v[68:71], a[188:191], a[124:127]
  v_mfma_f32_16x16x32_bf16 a[140:143], v[72:75], a[188:191], a[140:143]
  s_waitcnt vmcnt(13)
  buffer_load_dwordx4 a[188:191], v2, s[40:43], s67 offen offset:2048 sc1
  v_mfma_f32_16x16x32_bf16 a[64:67], v[76:79], v[216:219], a[64:67]
  v_mfma_f32_16x16x32_bf16 a[80:83], v[80:83], v[216:219], a[80:83]
  v_mfma_f32_16x16x32_bf16 a[96:99], v[84:87], v[216:219], a[96:99]
  v_mfma_f32_16x16x32_bf16 a[112:115], v[88:91], v[216:219], a[112:115]
  v_mfma_f32_16x16x32_bf16 a[128:131], v[92:95], v[216:219], a[128:131]
  buffer_load_dwordx4 v[216:219], v2, s[40:43], s64 offen offset:3072 sc1
  v_mfma_f32_16x16x32_bf16 a[68:71], v[76:79], v[220:223], a[68:71]
  v_mfma_f32_16x16x32_bf16 a[84:87], v[80:83], v[220:223], a[84:87]
  v_mfma_f32_16x16x32_bf16 a[100:103], v[84:87], v[220:223], a[100:103]
  v_mfma_f32_16x16x32_bf16 a[116:119], v[88:91], v[220:223], a[116:119]
  v_mfma_f32_16x16x32_bf16 a[132:135], v[92:95], v[220:223], a[132:135]
  s_waitcnt vmcnt(13)
  buffer_load_dwordx4 v[220:223], v2, s[40:43], s65 offen offset:3072 sc1
  v_mfma_f32_16x16x32_bf16 a[72:75], v[76:79], v[224:227], a[72:75]
  v_mfma_f32_16x16x32_bf16 a[88:91], v[80:83], v[224:227], a[88:91]
  v_mfma_f32_16x16x32_bf16 a[104:107], v[84:87], v[224:227], a[104:107]
  v_mfma_f32_16x16x32_bf16 a[120:123], v[88:91], v[224:227], a[120:123]
  v_mfma_f32_16x16x32_bf16 a[136:139], v[92:95], v[224:227], a[136:139]
  buffer_load_dwordx4 v[224:227], v2, s[40:43], s66 offen offset:3072 sc1
  v_mfma_f32_16x16x32_bf16 a[76:79], v[76:79], v[228:231], a[76:79]
  v_mfma_f32_16x16x32_bf16 a[92:95], v[80:83], v[228:231], a[92:95]
  v_mfma_f32_16x16x32_bf16 a[108:111], v[84:87], v[228:231], a[108:111]
  v_mfma_f32_16x16x32_bf16 a[124:127], v[88:91], v[228:231], a[124:127]
  v_mfma_f32_16x16x32_bf16 a[140:143], v[92:95], v[228:231], a[140:143]
  s_waitcnt vmcnt(13)
  buffer_load_dwordx4 v[228:231], v2, s[40:43], s67 offen offset:3072 sc1
  v_mfma_f32_16x16x32_bf16 a[64:67], a[16:19], a[144:147], a[64:67]
  v_mfma_f32_16x16x32_bf16 a[80:83], a[20:23], a[144:147], a[80:83]
  v_mfma_f32_16x16x32_bf16 a[96:99], a[24:27], a[144:147], a[96:99]
  v_mfma_f32_16x16x32_bf16 a[112:115], a[28:31], a[144:147], a[112:115]
  s_add_u32 s64, s64, 4096
  v_mfma_f32_16x16x32_bf16 a[128:131], a[32:35], a[144:147], a[128:131]
  buffer_load_dwordx4 a[144:147], v2, s[40:43], s64 offen offset:0 sc1
  v_mfma_f32_16x16x32_bf16 a[68:71], a[16:19], a[148:151], a[68:71]
  s_add_u32 s65, s64, 131072
  v_mfma_f32_16x16x32_bf16 a[84:87], a[20:23], a[148:151], a[84:87]
  s_add_u32 s66, s64, 262144
  v_mfma_f32_16x16x32_bf16 a[100:103], a[24:27], a[148:151], a[100:103]
  v_mfma_f32_16x16x32_bf16 a[116:119], a[28:31], a[148:151], a[116:119]
  v_mfma_f32_16x16x32_bf16 a[132:135], a[32:35], a[148:151], a[132:135]
  s_waitcnt vmcnt(13)
  buffer_load_dwordx4 a[148:151], v2, s[40:43], s65 offen offset:0 sc1
  v_mfma_f32_16x16x32_bf16 a[72:75], a[16:19], a[152:155], a[72:75]
  s_add_u32 s67, s64, 393216
  v_mfma_f32_16x16x32_bf16 a[88:91], a[20:23], a[152:155], a[88:91]
  v_mfma_f32_16x16x32_bf16 a[104:107], a[24:27], a[152:155], a[104:107]
  v_mfma_f32_16x16x32_bf16 a[120:123], a[28:31], a[152:155], a[120:123]
  v_mfma_f32_16x16x32_bf16 a[136:139], a[32:35], a[152:155], a[136:139]
  buffer_load_dwordx4 a[152:155], v2, s[40:43], s66 offen offset:0 sc1
  v_mfma_f32_16x16x32_bf16 a[76:79], a[16:19], a[156:159], a[76:79]
  v_mfma_f32_16x16x32_bf16 a[92:95], a[20:23], a[156:159], a[92:95]
  v_mfma_f32_16x16x32_bf16 a[108:111], a[24:27], a[156:159], a[108:111]
  v_mfma_f32_16x16x32_bf16 a[124:127], a[28:31], a[156:159], a[124:127]
  v_mfma_f32_16x16x32_bf16 a[140:143], a[32:35], a[156:159], a[140:143]
  s_waitcnt vmcnt(13)
  buffer_load_dwordx4 a[156:159], v2, s[40:43], s67 offen offset:0 sc1
  v_mfma_f32_16x16x32_bf16 a[64:67], a[36:39], a[160:163], a[64:67]
  v_mfma_f32_16x16x32_bf16 a[80:83], a[40:43], a[160:163], a[80:83]
  buffer_load_dword v13, v10, s[40:43], 0 offen sc1
  v_mfma_f32_16x16x32_bf16 a[96:99], a[44:47], a[160:163], a[96:99]
  v_mfma_f32_16x16x32_bf16 a[112:115], v[128:131], a[160:163], a[112:115]
  v_mfma_f32_16x16x32_bf16 a[128:131], v[132:135], a[160:163], a[128:131]
  buffer_load_dwordx4 a[160:163], v2, s[40:43], s64 offen offset:1024 sc1
  v_mfma_f32_16x16x32_bf16 a[68:71], a[36:39], a[164:167], a[68:71]
  v_mfma_f32_16x16x32_bf16 a[84:87], a[40:43], a[164:167], a[84:87]
  v_mfma_f32_16x16x32_bf16 a[100:103], a[44:47], a[164:167], a[100:103]
  v_mfma_f32_16x16x32_bf16 a[116:119], v[128:131], a[164:167], a[116:119]
  v_mfma_f32_16x16x32_bf16 a[132:135], v[132:135], a[164:167], a[132:135]
  s_waitcnt vmcnt(14)
  buffer_load_dwordx4 a[164:167], v2, s[40:43], s65 offen offset:1024 sc1
  v_mfma_f32_16x16x32_bf16 a[72:75], a[36:39], a[168:171], a[72:75]
  v_mfma_f32_16x16x32_bf16 a[88:91], a[40:43], a[168:171], a[88:91]
  v_mfma_f32_16x16x32_bf16 a[104:107], a[44:47], a[168:171], a[104:107]
  v_mfma_f32_16x16x32_bf16 a[120:123], v[128:131], a[168:171], a[120:123]
  v_mfma_f32_16x16x32_bf16 a[136:139], v[132:135], a[168:171], a[136:139]
  buffer_load_dwordx4 a[168:171], v2, s[40:43], s66 offen offset:1024 sc1
  v_mfma_f32_16x16x32_bf16 a[76:79], a[36:39], a[172:175], a[76:79]
  v_mfma_f32_16x16x32_bf16 a[92:95], a[40:43], a[172:175], a[92:95]
  v_mfma_f32_16x16x32_bf16 a[108:111], a[44:47], a[172:175], a[108:111]
  v_mfma_f32_16x16x32_bf16 a[124:127], v[128:131], a[172:175], a[124:127]
  v_mfma_f32_16x16x32_bf16 a[140:143], v[132:135], a[172:175], a[140:143]
  s_waitcnt vmcnt(14)
  buffer_load_dwordx4 a[172:175], v2, s[40:43], s67 offen offset:1024 sc1
  v_mfma_f32_16x16x32_bf16 a[64:67], v[136:139], a[176:179], a[64:67]
  v_mfma_f32_16x16x32_bf16 a[80:83], v[140:143], a[176:179], a[80:83]
  v_mfma_f32_16x16x32_bf16 a[96:99], v[144:147], a[176:179], a[96:99]
  v_mfma_f32_16x16x32_bf16 a[112:115], v[148:151], a[176:179], a[112:115]
  v_mfma_f32_16x16x32_bf16 a[128:131], v[152:155], a[176:179], a[128:131]
  buffer_load_dwordx4 a[176:179], v2, s[40:43], s64 offen offset:2048 sc1
  v_mfma_f32_16x16x32_bf16 a[68:71], v[136:139], a[180:183], a[68:71]
  v_mfma_f32_16x16x32_bf16 a[84:87], v[140:143], a[180:183], a[84:87]
  v_mfma_f32_16x16x32_bf16 a[100:103], v[144:147], a[180:183], a[100:103]
  s_barrier
  v_mfma_f32_16x16x32_bf16 a[116:119], v[148:151], a[180:183], a[116:119]
  v_mfma_f32_16x16x32_bf16 a[132:135], v[152:155], a[180:183], a[132:135]
  s_waitcnt vmcnt(14)
  buffer_load_dwordx4 a[180:183], v2, s[40:43], s65 offen offset:2048 sc1
  v_mfma_f32_16x16x32_bf16 a[72:75], v[136:139], a[184:187], a[72:75]
  v_mfma_f32_16x16x32_bf16 a[88:91], v[140:143], a[184:187], a[88:91]
  v_mfma_f32_16x16x32_bf16 a[104:107], v[144:147], a[184:187], a[104:107]
  v_mfma_f32_16x16x32_bf16 a[120:123], v[148:151], a[184:187], a[120:123]
  v_mfma_f32_16x16x32_bf16 a[136:139], v[152:155], a[184:187], a[136:139]
  buffer_load_dwordx4 a[184:187], v2, s[40:43], s66 offen offset:2048 sc1
  v_mfma_f32_16x16x32_bf16 a[76:79], v[136:139], a[188:191], a[76:79]
  v_mfma_f32_16x16x32_bf16 a[92:95], v[140:143], a[188:191], a[92:95]
  v_mfma_f32_16x16x32_bf16 a[108:111], v[144:147], a[188:191], a[108:111]
  v_mfma_f32_16x16x32_bf16 a[124:127], v[148:151], a[188:191], a[124:127]
  v_mfma_f32_16x16x32_bf16 a[140:143], v[152:155], a[188:191], a[140:143]
  s_waitcnt vmcnt(14)
  buffer_load_dwordx4 a[188:191], v2, s[40:43], s67 offen offset:2048 sc1
  v_mfma_f32_16x16x32_bf16 a[64:67], v[156:159], v[216:219], a[64:67]
  v_mfma_f32_16x16x32_bf16 a[80:83], a[48:51], v[216:219], a[80:83]
  v_mfma_f32_16x16x32_bf16 a[96:99], a[52:55], v[216:219], a[96:99]
  v_mfma_f32_16x16x32_bf16 a[112:115], a[56:59], v[216:219], a[112:115]
  v_mfma_f32_16x16x32_bf16 a[128:131], a[60:63], v[216:219], a[128:131]
  buffer_load_dwordx4 v[216:219], v2, s[40:43], s64 offen offset:3072 sc1
  v_mfma_f32_16x16x32_bf16 a[68:71], v[156:159], v[220:223], a[68:71]
  v_mfma_f32_16x16x32_bf16 a[84:87], a[48:51], v[220:223], a[84:87]
  v_mfma_f32_16x16x32_bf16 a[100:103], a[52:55], v[220:223], a[100:103]
  v_mfma_f32_16x16x32_bf16 a[116:119], a[56:59], v[220:223], a[116:119]
  v_mfma_f32_16x16x32_bf16 a[132:135], a[60:63], v[220:223], a[132:135]
  s_waitcnt vmcnt(14)
  buffer_load_dwordx4 v[220:223], v2, s[40:43], s65 offen offset:3072 sc1
  v_mfma_f32_16x16x32_bf16 a[72:75], v[156:159], v[224:227], a[72:75]
  v_mfma_f32_16x16x32_bf16 a[88:91], a[48:51], v[224:227], a[88:91]
  v_mfma_f32_16x16x32_bf16 a[104:107], a[52:55], v[224:227], a[104:107]
  v_mfma_f32_16x16x32_bf16 a[120:123], a[56:59], v[224:227], a[120:123]
  v_mfma_f32_16x16x32_bf16 a[136:139], a[60:63], v[224:227], a[136:139]
  buffer_load_dwordx4 v[224:227], v2, s[40:43], s66 offen offset:3072 sc1
  v_mfma_f32_16x16x32_bf16 a[76:79], v[156:159], v[228:231], a[76:79]
  v_mfma_f32_16x16x32_bf16 a[92:95], a[48:51], v[228:231], a[92:95]
  v_mfma_f32_16x16x32_bf16 a[108:111], a[52:55], v[228:231], a[108:111]
  v_mfma_f32_16x16x32_bf16 a[124:127], a[56:59], v[228:231], a[124:127]
  v_mfma_f32_16x16x32_bf16 a[140:143], a[60:63], v[228:231], a[140:143]
  s_waitcnt vmcnt(11)
  buffer_load_dwordx4 v[228:231], v2, s[40:43], s67 offen offset:3072 sc1
  v_mfma_f32_16x16x32_bf16 a[64:67], a[192:195], a[144:147], a[64:67]
  v_cmp_eq_u32 vcc, 0, v13
  v_mfma_f32_16x16x32_bf16 a[80:83], a[196:199], a[144:147], a[80:83]
  v_mfma_f32_16x16x32_bf16 a[96:99], a[200:203], a[144:147], a[96:99]
  s_cbranch_vccnz fa_ctx2_spin
fa_ctx2_ok:
  v_mfma_f32_16x16x32_bf16 a[112:115], a[204:207], a[144:147], a[112:115]
  s_add_u32 s64, s63, 0
  v_mfma_f32_16x16x32_bf16 a[128:131], v[176:179], a[144:147], a[128:131]
  buffer_load_dwordx4 a[144:147], v2, s[40:43], s64 offen offset:0 sc1
  v_mfma_f32_16x16x32_bf16 a[68:71], a[192:195], a[148:151], a[68:71]
  s_add_u32 s65, s64, 131072
  v_mfma_f32_16x16x32_bf16 a[84:87], a[196:199], a[148:151], a[84:87]
  s_add_u32 s66, s64, 262144
  v_mfma_f32_16x16x32_bf16 a[100:103], a[200:203], a[148:151], a[100:103]
  v_mfma_f32_16x16x32_bf16 a[116:119], a[204:207], a[148:151], a[116:119]
  v_mfma_f32_16x16x32_bf16 a[132:135], v[176:179], a[148:151], a[132:135]
  s_waitcnt vmcnt(14)
  buffer_load_dwordx4 a[148:151], v2, s[40:43], s65 offen offset:0 sc1
  v_mfma_f32_16x16x32_bf16 a[72:75], a[192:195], a[152:155], a[72:75]
  s_add_u32 s67, s64, 393216
  v_mfma_f32_16x16x32_bf16 a[88:91], a[196:199], a[152:155], a[88:91]
  v_mfma_f32_16x16x32_bf16 a[104:107], a[200:203], a[152:155], a[104:107]
  v_mfma_f32_16x16x32_bf16 a[120:123], a[204:207], a[152:155], a[120:123]
  v_mfma_f32_16x16x32_bf16 a[136:139], v[176:179], a[152:155], a[136:139]
  buffer_load_dwordx4 a[152:155], v2, s[40:43], s66 offen offset:0 sc1
  v_mfma_f32_16x16x32_bf16 a[76:79], a[192:195], a[156:159], a[76:79]
  v_mfma_f32_16x16x32_bf16 a[92:95], a[196:199], a[156:159], a[92:95]
  v_mfma_f32_16x16x32_bf16 a[108:111], a[200:203], a[156:159], a[108:111]
  v_mfma_f32_16x16x32_bf16 a[124:127], a[204:207], a[156:159], a[124:127]
  v_mfma_f32_16x16x32_bf16 a[140:143], v[176:179], a[156:159], a[140:143]
  s_waitcnt vmcnt(13)
  buffer_load_dwordx4 a[156:159], v2, s[40:43], s67 offen offset:0 sc1
  v_mfma_f32_16x16x32_bf16 a[64:67], v[180:183], a[160:163], a[64:67]
  v_mfma_f32_16x16x32_bf16 a[80:83], v[184:187], a[160:163], a[80:83]
  v_mfma_f32_16x16x32_bf16 a[96:99], v[188:191], a[160:163], a[96:99]
  v_mfma_f32_16x16x32_bf16 a[112:115], a[208:211], a[160:163], a[112:115]
  v_mfma_f32_16x16x32_bf16 a[128:131], a[212:215], a[160:163], a[128:131]
  buffer_load_dwordx4 a[160:163], v2, s[40:43], s64 offen offset:1024 sc1
  v_mfma_f32_16x16x32_bf16 a[68:71], v[180:183], a[164:167], a[68:71]
  v_mfma_f32_16x16x32_bf16 a[84:87], v[184:187], a[164:167], a[84:87]
  v_mfma_f32_16x16x32_bf16 a[100:103], v[188:191], a[164:167], a[100:103]
  v_mfma_f32_16x16x32_bf16 a[116:119], a[208:211], a[164:167], a[116:119]
  v_mfma_f32_16x16x32_bf16 a[132:135], a[212:215], a[164:167], a[132:135]
  s_waitcnt vmcnt(13)
  buffer_load_dwordx4 a[164:167], v2, s[40:43], s65 offen offset:1024 sc1
  v_mfma_f32_16x16x32_bf16 a[72:75], v[180:183], a[168:171], a[72:75]
  v_mfma_f32_16x16x32_bf16 a[88:91], v[184:187], a[168:171], a[88:91]
  v_mfma_f32_16x16x32_bf16 a[104:107], v[188:191], a[168:171], a[104:107]
  v_mfma_f32_16x16x32_bf16 a[120:123], a[208:211], a[168:171], a[120:123]
  v_mfma_f32_16x16x32_bf16 a[136:139], a[212:215], a[168:171], a[136:139]
  buffer_load_dwordx4 a[168:171], v2, s[40:43], s66 offen offset:1024 sc1
  v_mfma_f32_16x16x32_bf16 a[76:79], v[180:183], a[172:175], a[76:79]
  v_mfma_f32_16x16x32_bf16 a[92:95], v[184:187], a[172:175], a[92:95]
  v_mfma_f32_16x16x32_bf16 a[108:111], v[188:191], a[172:175], a[108:111]
  v_mfma_f32_16x16x32_bf16 a[124:127], a[208:211], a[172:175], a[124:127]
  v_mfma_f32_16x16x32_bf16 a[140:143], a[212:215], a[172:175], a[140:143]
  s_waitcnt vmcnt(13)
  buffer_load_dwordx4 a[172:175], v2, s[40:43], s67 offen offset:1024 sc1
  v_mfma_f32_16x16x32_bf16 a[64:67], a[216:219], a[176:179], a[64:67]
  v_mfma_f32_16x16x32_bf16 a[80:83], a[220:223], a[176:179], a[80:83]
  v_mfma_f32_16x16x32_bf16 a[96:99], a[224:227], a[176:179], a[96:99]
  v_mfma_f32_16x16x32_bf16 a[112:115], a[228:231], a[176:179], a[112:115]
  v_mfma_f32_16x16x32_bf16 a[128:131], a[232:235], a[176:179], a[128:131]
  buffer_load_dwordx4 a[176:179], v2, s[40:43], s64 offen offset:2048 sc1
  v_mfma_f32_16x16x32_bf16 a[68:71], a[216:219], a[180:183], a[68:71]
  v_mfma_f32_16x16x32_bf16 a[84:87], a[220:223], a[180:183], a[84:87]
  v_mfma_f32_16x16x32_bf16 a[100:103], a[224:227], a[180:183], a[100:103]
  v_mfma_f32_16x16x32_bf16 a[116:119], a[228:231], a[180:183], a[116:119]
  v_mfma_f32_16x16x32_bf16 a[132:135], a[232:235], a[180:183], a[132:135]
  s_waitcnt vmcnt(13)
  buffer_load_dwordx4 a[180:183], v2, s[40:43], s65 offen offset:2048 sc1
  v_mfma_f32_16x16x32_bf16 a[72:75], a[216:219], a[184:187], a[72:75]
  v_mfma_f32_16x16x32_bf16 a[88:91], a[220:223], a[184:187], a[88:91]
  v_mfma_f32_16x16x32_bf16 a[104:107], a[224:227], a[184:187], a[104:107]
  v_mfma_f32_16x16x32_bf16 a[120:123], a[228:231], a[184:187], a[120:123]
  v_mfma_f32_16x16x32_bf16 a[136:139], a[232:235], a[184:187], a[136:139]
  buffer_load_dwordx4 a[184:187], v2, s[40:43], s66 offen offset:2048 sc1
  v_mfma_f32_16x16x32_bf16 a[76:79], a[216:219], a[188:191], a[76:79]
  v_mfma_f32_16x16x32_bf16 a[92:95], a[220:223], a[188:191], a[92:95]
  v_mfma_f32_16x16x32_bf16 a[108:111], a[224:227], a[188:191], a[108:111]
  v_mfma_f32_16x16x32_bf16 a[124:127], a[228:231], a[188:191], a[124:127]
  v_mfma_f32_16x16x32_bf16 a[140:143], a[232:235], a[188:191], a[140:143]
  s_waitcnt vmcnt(13)
  buffer_load_dwordx4 a[188:191], v2, s[40:43], s67 offen offset:2048 sc1
  v_mfma_f32_16x16x32_bf16 a[64:67], a[236:239], v[216:219], a[64:67]
  v_mfma_f32_16x16x32_bf16 a[80:83], a[240:243], v[216:219], a[80:83]
  v_mfma_f32_16x16x32_bf16 a[96:99], a[244:247], v[216:219], a[96:99]
  v_mfma_f32_16x16x32_bf16 a[112:115], a[248:251], v[216:219], a[112:115]
  v_mfma_f32_16x16x32_bf16 a[128:131], a[252:255], v[216:219], a[128:131]
  buffer_load_dwordx4 v[216:219], v2, s[40:43], s64 offen offset:3072 sc1
  v_mfma_f32_16x16x32_bf16 a[68:71], a[236:239], v[220:223], a[68:71]
  v_mfma_f32_16x16x32_bf16 a[84:87], a[240:243], v[220:223], a[84:87]
  v_mfma_f32_16x16x32_bf16 a[100:103], a[244:247], v[220:223], a[100:103]
  v_mfma_f32_16x16x32_bf16 a[116:119], a[248:251], v[220:223], a[116:119]
  v_mfma_f32_16x16x32_bf16 a[132:135], a[252:255], v[220:223], a[132:135]
  s_waitcnt vmcnt(13)
  buffer_load_dwordx4 v[220:223], v2, s[40:43], s65 offen offset:3072 sc1
  ds_write_b128 v16, a[64:67] offset:0
  v_mfma_f32_16x16x32_bf16 a[72:75], a[236:239], v[224:227], a[72:75]
  ds_write_b128 v16, a[80:83] offset:64
  v_mfma_f32_16x16x32_bf16 a[88:91], a[240:243], v[224:227], a[88:91]
  ds_write_b128 v16, a[96:99] offset:128
  v_mfma_f32_16x16x32_bf16 a[104:107], a[244:247], v[224:227], a[104:107]
  ds_write_b128 v16, a[112:115] offset:192
  v_mfma_f32_16x16x32_bf16 a[120:123], a[248:251], v[224:227], a[120:123]
  ds_write_b128 v16, a[128:131] offset:256
  v_mfma_f32_16x16x32_bf16 a[136:139], a[252:255], v[224:227], a[136:139]
  buffer_load_dwordx4 v[224:227], v2, s[40:43], s66 offen offset:3072 sc1
  ds_write_b128 v16, a[68:71] offset:5376
  v_mfma_f32_16x16x32_bf16 a[76:79], a[236:239], v[228:231], a[76:79]
  ds_write_b128 v16, a[84:87] offset:5440
  v_mfma_f32_16x16x32_bf16 a[92:95], a[240:243], v[228:231], a[92:95]
  ds_write_b128 v16, a[100:103] offset:5504
  v_mfma_f32_16x16x32_bf16 a[108:111], a[244:247], v[228:231], a[108:111]
  ds_write_b128 v16, a[116:119] offset:5568
  v_mfma_f32_16x16x32_bf16 a[124:127], a[248:251], v[228:231], a[124:127]
  ds_write_b128 v16, a[132:135] offset:5632
  v_mfma_f32_16x16x32_bf16 a[140:143], a[252:255], v[228:231], a[140:143]
  s_waitcnt vmcnt(13)
  buffer_load_dwordx4 v[228:231], v2, s[40:43], s67 offen offset:3072 sc1
  ds_write_b128 v16, a[72:75] offset:10752
  v_mfma_f32_16x16x32_bf16 a[64:67], v[32:35], a[144:147], 0
  ds_write_b128 v16, a[88:91] offset:10816
  v_mfma_f32_16x16x32_bf16 a[80:83], v[36:39], a[144:147], 0
  ds_write_b128 v16, a[104:107] offset:10880
  v_mfma_f32_16x16x32_bf16 a[96:99], v[40:43], a[144:147], 0
  ds_write_b128 v16, a[120:123] offset:10944
  v_mfma_f32_16x16x32_bf16 a[112:115], v[44:47], a[144:147], 0
  s_add_u32 s64, s64, 4096
  ds_write_b128 v16, a[136:139] offset:11008
  v_mfma_f32_16x16x32_bf16 a[128:131], v[48:51], a[144:147], 0
  buffer_load_dwordx4 a[144:147], v2, s[40:43], s64 offen offset:0 sc1
  ds_write_b128 v16, a[76:79] offset:16128
  v_mfma_f32_16x16x32_bf16 a[68:71], v[32:35], a[148:151], 0
  s_add_u32 s65, s64, 131072
  ds_write_b128 v16, a[92:95] offset:16192
  v_mfma_f32_16x16x32_bf16 a[84:87], v[36:39], a[148:151], 0
  s_add_u32 s66, s64, 262144
  ds_write_b128 v16, a[108:111] offset:16256
  v_mfma_f32_16x16x32_bf16 a[100:103], v[40:43], a[148:151], 0
  ds_write_b128 v16, a[124:127] offset:16320
  v_mfma_f32_16x16x32_bf16 a[116:119], v[44:47], a[148:151], 0
  ds_write_b128 v16, a[140:143] offset:16384
  v_mfma_f32_16x16x32_bf16 a[132:135], v[48:51], a[148:151], 0
  s_waitcnt vmcnt(13)
  buffer_load_dwordx4 a[148:151], v2, s[40:43], s65 offen offset:0 sc1
  v_mfma_f32_16x16x32_bf16 a[72:75], v[32:35], a[152:155], 0
  s_add_u32 s67, s64, 393216
  v_mfma_f32_16x16x32_bf16 a[88:91], v[36:39], a[152:155], 0
  v_mfma_f32_16x16x32_bf16 a[104:107], v[40:43], a[152:155], 0
  v_mfma_f32_16x16x32_bf16 a[120:123], v[44:47], a[152:155], 0
  v_mfma_f32_16x16x32_bf16 a[136:139], v[48:51], a[152:155], 0
  buffer_load_dwordx4 a[152:155], v2, s[40:43], s66 offen offset:0 sc1
  v_mfma_f32_16x16x32_bf16 a[76:79], v[32:35], a[156:159], 0
  v_mfma_f32_16x16x32_bf16 a[92:95], v[36:39], a[156:159], 0
  v_mfma_f32_16x16x32_bf16 a[108:111], v[40:43], a[156:159], 0
  v_mfma_f32_16x16x32_bf16 a[124:127], v[44:47], a[156:159], 0
  v_mfma_f32_16x16x32_bf16 a[140:143], v[48:51], a[156:159], 0
  s_waitcnt vmcnt(13) lgkmcnt(0)
  buffer_load_dwordx4 a[156:159], v2, s[40:43], s67 offen offset:0 sc1
  v_mfma_f32_16x16x32_bf16 a[64:67], v[52:55], a[160:163], a[64:67]
  v_mfma_f32_16x16x32_bf16 a[80:83], v[56:59], a[160:163], a[80:83]
  v_mfma_f32_16x16x32_bf16 a[96:99], v[60:63], a[160:163], a[96:99]
  v_mfma_f32_16x16x32_bf16 a[112:115], v[96:99], a[160:163], a[112:115]
  v_mfma_f32_16x16x32_bf16 a[128:131], v[100:103], a[160:163], a[128:131]
  buffer_load_dwordx4 a[160:163], v2, s[40:43], s64 offen offset:1024 sc1
  v_mfma_f32_16x16x32_bf16 a[68:71], v[52:55], a[164:167], a[68:71]
  v_mfma_f32_16x16x32_bf16 a[84:87], v[56:59], a[164:167], a[84:87]
  v_mfma_f32_16x16x32_bf16 a[100:103], v[60:63], a[164:167], a[100:103]
  s_barrier
  v_mfma_f32_16x16x32_bf16 a[116:119], v[96:99], a[164:167], a[116:119]
  v_mfma_f32_16x16x32_bf16 a[132:135], v[100:103], a[164:167], a[132:135]
  s_waitcnt vmcnt(13)
  buffer_load_dwordx4 a[164:167], v2, s[40:43], s65 offen offset:1024 sc1
  v_mfma_f32_16x16x32_bf16 a[72:75], v[52:55], a[168:171], a[72:75]
  v_mfma_f32_16x16x32_bf16 a[88:91], v[56:59], a[168:171], a[88:91]
  v_mfma_f32_16x16x32_bf16 a[104:107], v[60:63], a[168:171], a[104:107]
  v_mfma_f32_16x16x32_bf16 a[120:123], v[96:99], a[168:171], a[120:123]
  v_mfma_f32_16x16x32_bf16 a[136:139], v[100:103], a[168:171], a[136:139]
  buffer_load_dwordx4 a[168:171], v2, s[40:43], s66 offen offset:1024 sc1
  v_mfma_f32_16x16x32_bf16 a[76:79], v[52:55], a[172:175], a[76:79]
  v_mfma_f32_16x16x32_bf16 a[92:95], v[56:59], a[172:175], a[92:95]
  v_mfma_f32_16x16x32_bf16 a[108:111], v[60:63], a[172:175], a[108:111]
  v_mfma_f32_16x16x32_bf16 a[124:127], v[96:99], a[172:175], a[124:127]
  v_mfma_f32_16x16x32_bf16 a[140:143], v[100:103], a[172:175], a[140:143]
  s_waitcnt vmcnt(13)
  buffer_load_dwordx4 a[172:175], v2, s[40:43], s67 offen offset:1024 sc1
  v_mfma_f32_16x16x32_bf16 a[64:67], v[104:107], a[176:179], a[64:67]
  ds_read_b128 v[32:35], v251 offset:0
  v_mfma_f32_16x16x32_bf16 a[80:83], v[108:111], a[176:179], a[80:83]
  ds_read_b128 v[36:39], v251 offset:16
  v_mfma_f32_16x16x32_bf16 a[96:99], v[112:115], a[176:179], a[96:99]
  ds_read_b128 v[40:43], v251 offset:21504
  v_mfma_f32_16x16x32_bf16 a[112:115], v[116:119], a[176:179], a[112:115]
  ds_read_b128 v[44:47], v251 offset:21520
  v_mfma_f32_16x16x32_bf16 a[128:131], v[120:123], a[176:179], a[128:131]
  buffer_load_dwordx4 a[176:179], v2, s[40:43], s64 offen offset:2048 sc1
  v_mfma_f32_16x16x32_bf16 a[68:71], v[104:107], a[180:183], a[68:71]
  ds_read_b128 v[48:51], v251 offset:43008
  v_mfma_f32_16x16x32_bf16 a[84:87], v[108:111], a[180:183], a[84:87]
  ds_read_b128 v[52:55], v251 offset:43024
  v_mfma_f32_16x16x32_bf16 a[100:103], v[112:115], a[180:183], a[100:103]
  ds_read_b128 v[56:59], v251 offset:64512
  v_mfma_f32_16x16x32_bf16 a[116:119], v[116:119], a[180:183], a[116:119]
  ds_read_b128 v[60:63], v251 offset:64528
  v_mfma_f32_16x16x32_bf16 a[132:135], v[120:123], a[180:183], a[132:135]
  s_waitcnt vmcnt(13)
  buffer_load_dwordx4 a[180:183], v2, s[40:43], s65 offen offset:2048 sc1
  v_mfma_f32_16x16x32_bf16 a[72:75], v[104:107], a[184:187], a[72:75]
  v_mfma_f32_16x16x32_bf16 a[88:91], v[108:111], a[184:187], a[88:91]
  v_mfma_f32_16x16x32_bf16 a[104:107], v[112:115], a[184:187], a[104:107]
  v_mfma_f32_16x16x32_bf16 a[120:123], v[116:119], a[184:187], a[120:123]
  v_mfma_f32_16x16x32_bf16 a[136:139], v[120:123], a[184:187], a[136:139]
  buffer_load_dwordx4 a[184:187], v2, s[40:43], s66 offen offset:2048 sc1
  v_mfma_f32_16x16x32_bf16 a[76:79], v[104:107], a[188:191], a[76:79]
  v_mfma_f32_16x16x32_bf16 a[92:95], v[108:111], a[188:191], a[92:95]
  v_mfma_f32_16x16x32_bf16 a[108:111], v[112:115], a[188:191], a[108:111]
  v_mfma_f32_16x16x32_bf16 a[124:127], v[116:119], a[188:191], a[124:127]
  v_mfma_f32_16x16x32_bf16 a[140:143], v[120:123], a[188:191], a[140:143]
  s_waitcnt vmcnt(13) lgkmcnt(0)
  buffer_load_dwordx4 a[188:191], v2, s[40:43], s67 offen offset:2048 sc1
  v_mfma_f32_16x16x32_bf16 a[64:67], v[124:127], v[216:219], a[64:67]
  v_add_f32 v32, v32, v40
  v_add_f32 v48, v48, v56
  v_mfma_f32_16x16x32_bf16 a[80:83], v[160:163], v[216:219], a[80:83]
  v_add_f32 v33, v33, v41
  v_add_f32 v49, v49, v57
  v_mfma_f32_16x16x32_bf16 a[96:99], v[164:167], v[216:219], a[96:99]
  v_add_f32 v34, v34, v42
  v_mfma_f32_16x16x32_bf16 a[112:115], v[168:171], v[216:219], a[112:115]
  v_add_f32 v50, v50, v58
  v_add_f32 v35, v35, v43
  v_mfma_f32_16x16x32_bf16 a[128:131], v[172:175], v[216:219], a[128:131]
  buffer_load_dwordx4 v[216:219], v2, s[40:43], s64 offen offset:3072 sc1
  v_add_f32 v51, v51, v59
  v_mfma_f32_16x16x32_bf16 a[68:71], v[124:127], v[220:223], a[68:71]
  v_add_f32 v36, v36, v44
  v_add_f32 v52, v52, v60
  v_mfma_f32_16x16x32_bf16 a[84:87], v[160:163], v[220:223], a[84:87]
  v_add_f32 v37, v37, v45
  v_add_f32 v53, v53, v61
  v_mfma_f32_16x16x32_bf16 a[100:103], v[164:167], v[220:223], a[100:103]
  v_add_f32 v38, v38, v46
  v_mfma_f32_16x16x32_bf16 a[116:119], v[168:171], v[220:223], a[116:119]
  v_add_f32 v54, v54, v62
  v_add_f32 v39, v39, v47
  v_mfma_f32_16x16x32_bf16 a[132:135], v[172:175], v[220:223], a[132:135]
  s_waitcnt vmcnt(13)
  buffer_load_dwordx4 v[220:223], v2, s[40:43], s65 offen offset:3072 sc1
  v_add_f32 v55, v55, v63
  v_mfma_f32_16x16x32_bf16 a[72:75], v[124:127], v[224:227], a[72:75]
  v_add_f32 v32, v32, v48
  v_add_f32 v33, v33, v49
  v_mfma_f32_16x16x32_bf16 a[88:91], v[160:163], v[224:227], a[88:91]
  v_add_f32 v34, v34, v50
  v_add_f32 v35, v35, v51
  v_mfma_f32_16x16x32_bf16 a[104:107], v[164:167], v[224:227], a[104:107]
  v_add_f32 v36, v36, v52
  v_mfma_f32_16x16x32_bf16 a[120:123], v[168:171], v[224:227], a[120:123]
  v_add_f32 v37, v37, v53
  v_add_f32 v38, v38, v54
  v_mfma_f32_16x16x32_bf16 a[136:139], v[172:175], v[224:227], a[136:139]
  buffer_load_dwordx4 v[224:227], v2, s[40:43], s66 offen offset:3072 sc1
  v_add_f32 v39, v39, v55
  v_mfma_f32_16x16x32_bf16 a[76:79], v[124:127], v[228:231], a[76:79]
  s_add_u32 s14, s28, 0
  v_mfma_f32_16x16x32_bf16 a[92:95], v[160:163], v[228:231], a[92:95]
  buffer_store_dwordx4 v[32:35], v9, s[40:43], s14 offen sc1
  v_mfma_f32_16x16x32_bf16 a[108:111], v[164:167], v[228:231], a[108:111]
  s_add_u32 s14, s28, 4096
  v_mfma_f32_16x16x32_bf16 a[124:127], v[168:171], v[228:231], a[124:127]
  buffer_store_dwordx4 v[36:39], v9, s[40:43], s14 offen sc1
  v_mfma_f32_16x16x32_bf16 a[140:143], v[172:175], v[228:231], a[140:143]
  s_waitcnt vmcnt(15)
  buffer_load_dwordx4 v[228:231], v2, s[40:43], s67 offen offset:3072 sc1
  v_mfma_f32_16x16x32_bf16 a[64:67], v[232:235], a[144:147], a[64:67]
  ds_read_b128 v[96:99], v252 offset:0
  v_mfma_f32_16x16x32_bf16 a[80:83], v[236:239], a[144:147], a[80:83]
  ds_read_b128 v[100:103], v252 offset:16
  v_mfma_f32_16x16x32_bf16 a[96:99], v[240:243], a[144:147], a[96:99]
  ds_read_b128 v[104:107], v252 offset:21504
  v_mfma_f32_16x16x32_bf16 a[112:115], v[244:247], a[144:147], a[112:115]
  s_add_u32 s64, s64, 4096
  ds_read_b128 v[108:111], v252 offset:21520
  v_mfma_f32_16x16x32_bf16 a[128:131], v[192:195], a[144:147], a[128:131]
  buffer_load_dwordx4 a[144:147], v2, s[40:43], s64 offen offset:0 sc1
  v_mfma_f32_16x16x32_bf16 a[68:71], v[232:235], a[148:151], a[68:71]
  s_add_u32 s65, s64, 131072
  ds_read_b128 v[112:115], v252 offset:43008
  v_mfma_f32_16x16x32_bf16 a[84:87], v[236:239], a[148:151], a[84:87]
  s_add_u32 s66, s64, 262144
  ds_read_b128 v[116:119], v252 offset:43024
  v_mfma_f32_16x16x32_bf16 a[100:103], v[240:243], a[148:151], a[100:103]
  ds_read_b128 v[120:123], v252 offset:64512
  v_mfma_f32_16x16x32_bf16 a[116:119], v[244:247], a[148:151], a[116:119]
  ds_read_b128 v[124:127], v252 offset:64528
  v_mfma_f32_16x16x32_bf16 a[132:135], v[192:195], a[148:151], a[132:135]
  s_waitcnt vmcnt(15)
  buffer_load_dwordx4 a[148:151], v2, s[40:43], s65 offen offset:0 sc1
  v_mfma_f32_16x16x32_bf16 a[72:75], v[232:235], a[152:155], a[72:75]
  s_add_u32 s67, s64, 393216
  v_mfma_f32_16x16x32_bf16 a[88:91], v[236:239], a[152:155], a[88:91]
  v_mfma_f32_16x16x32_bf16 a[104:107], v[240:243], a[152:155], a[104:107]
  v_mfma_f32_16x16x32_bf16 a[120:123], v[244:247], a[152:155], a[120:123]
  v_mfma_f32_16x16x32_bf16 a[136:139], v[192:195], a[152:155], a[136:139]
  buffer_load_dwordx4 a[152:155], v2, s[40:43], s66 offen offset:0 sc1
  v_mfma_f32_16x16x32_bf16 a[76:79], v[232:235], a[156:159], a[76:79]
  v_mfma_f32_16x16x32_bf16 a[92:95], v[236:239], a[156:159], a[92:95]
  v_mfma_f32_16x16x32_bf16 a[108:111], v[240:243], a[156:159], a[108:111]
  v_mfma_f32_16x16x32_bf16 a[124:127], v[244:247], a[156:159], a[124:127]
  v_mfma_f32_16x16x32_bf16 a[140:143], v[192:195], a[156:159], a[140:143]
  s_waitcnt vmcnt(15) lgkmcnt(0)
  buffer_load_dwordx4 a[156:159], v2, s[40:43], s67 offen offset:0 sc1
  v_mfma_f32_16x16x32_bf16 a[64:67], v[196:199], a[160:163], a[64:67]
  ds_read_b128 v[32:35], v253 offset:0
  v_add_f32 v96, v96, v104
  v_add_f32 v112, v112, v120
  v_mfma_f32_16x16x32_bf16 a[80:83], v[208:211], a[160:163], a[80:83]
  ds_read_b128 v[36:39], v253 offset:16
  v_add_f32 v97, v97, v105
  v_add_f32 v113, v113, v121
  v_mfma_f32_16x16x32_bf16 a[96:99], v[212:215], a[160:163], a[96:99]
  ds_read_b128 v[40:43], v253 offset:21504
  v_add_f32 v98, v98, v106
  v_mfma_f32_16x16x32_bf16 a[112:115], a[0:3], a[160:163], a[112:115]
  ds_read_b128 v[44:47], v253 offset:21520
  v_add_f32 v114, v114, v122
  v_add_f32 v99, v99, v107
  v_mfma_f32_16x16x32_bf16 a[128:131], a[4:7], a[160:163], a[128:131]
  buffer_load_dwordx4 a[160:163], v2, s[40:43], s64 offen offset:1024 sc1
  v_add_f32 v115, v115, v123
  v_mfma_f32_16x16x32_bf16 a[68:71], v[196:199], a[164:167], a[68:71]
  ds_read_b128 v[48:51], v253 offset:43008
  v_add_f32 v100, v100, v108
  v_add_f32 v116, v116, v124
  v_mfma_f32_16x16x32_bf16 a[84:87], v[208:211], a[164:167], a[84:87]
  ds_read_b128 v[52:55], v253 offset:43024
  v_add_f32 v101, v101, v109
  v_add_f32 v117, v117, v125
  v_mfma_f32_16x16x32_bf16 a[100:103], v[212:215], a[164:167], a[100:103]
  ds_read_b128 v[56:59], v253 offset:64512
  v_add_f32 v102, v102, v110
  v_mfma_f32_16x16x32_bf16 a[116:119], a[0:3], a[164:167], a[116:119]
  ds_read_b128 v[60:63], v253 offset:64528
  v_add_f32 v118, v118, v126
  v_add_f32 v103, v103, v111
  v_mfma_f32_16x16x32_bf16 a[132:135], a[4:7], a[164:167], a[132:135]
  s_waitcnt vmcnt(15)
  buffer_load_dwordx4 a[164:167], v2, s[40:43], s65 offen offset:1024 sc1
  v_add_f32 v119, v119, v127
  v_mfma_f32_16x16x32_bf16 a[72:75], v[196:199], a[168:171], a[72:75]
  v_add_f32 v96, v96, v112
  v_add_f32 v97, v97, v113
  v_mfma_f32_16x16x32_bf16 a[88:91], v[208:211], a[168:171], a[88:91]
  v_add_f32 v98, v98, v114
  v_add_f32 v99, v99, v115
  v_mfma_f32_16x16x32_bf16 a[104:107], v[212:215], a[168:171], a[104:107]
  v_add_f32 v100, v100, v116
  v_mfma_f32_16x16x32_bf16 a[120:123], a[0:3], a[168:171], a[120:123]
  v_add_f32 v101, v101, v117
  v_add_f32 v102, v102, v118
  v_mfma_f32_16x16x32_bf16 a[136:139], a[4:7], a[168:171], a[136:139]
  buffer_load_dwordx4 a[168:171], v2, s[40:43], s66 offen offset:1024 sc1
  v_add_f32 v103, v103, v119
  v_mfma_f32_16x16x32_bf16 a[76:79], v[196:199], a[172:175], a[76:79]
  s_add_u32 s14, s28, 8192
  v_mfma_f32_16x16x32_bf16 a[92:95], v[208:211], a[172:175], a[92:95]
  buffer_store_dwordx4 v[96:99], v9, s[40:43], s14 offen sc1
  v_mfma_f32_16x16x32_bf16 a[108:111], v[212:215], a[172:175], a[108:111]
  s_add_u32 s14, s28, 12288
  v_mfma_f32_16x16x32_bf16 a[124:127], a[0:3], a[172:175], a[124:127]
  buffer_store_dwordx4 v[100:103], v9, s[40:43], s14 offen sc1
  v_mfma_f32_16x16x32_bf16 a[140:143], a[4:7], a[172:175], a[140:143]
  s_waitcnt vmcnt(17) lgkmcnt(0)
  buffer_load_dwordx4 a[172:175], v2, s[40:43], s67 offen offset:1024 sc1
  v_mfma_f32_16x16x32_bf16 a[64:67], a[8:11], a[176:179], a[64:67]
  v_add_f32 v32, v32, v40
  v_add_f32 v48, v48, v56
  v_mfma_f32_16x16x32_bf16 a[80:83], a[12:15], a[176:179], a[80:83]
  v_add_f32 v33, v33, v41
  v_add_f32 v49, v49, v57
  v_mfma_f32_16x16x32_bf16 a[96:99], v[64:67], a[176:179], a[96:99]
  v_add_f32 v34, v34, v42
  v_mfma_f32_16x16x32_bf16 a[112:115], v[68:71], a[176:179], a[112:115]
  v_add_f32 v50, v50, v58
  v_add_f32 v35, v35, v43
  v_mfma_f32_16x16x32_bf16 a[128:131], v[72:75], a[176:179], a[128:131]
  buffer_load_dwordx4 a[176:179], v2, s[40:43], s64 offen offset:2048 sc1
  v_add_f32 v51, v51, v59
  v_mfma_f32_16x16x32_bf16 a[68:71], a[8:11], a[180:183], a[68:71]
  v_add_f32 v36, v36, v44
  v_add_f32 v52, v52, v60
  v_mfma_f32_16x16x32_bf16 a[84:87], a[12:15], a[180:183], a[84:87]
  v_add_f32 v37, v37, v45
  v_add_f32 v53, v53, v61
  v_mfma_f32_16x16x32_bf16 a[100:103], v[64:67], a[180:183], a[100:103]
  v_add_f32 v38, v38, v46
  v_mfma_f32_16x16x32_bf16 a[116:119], v[68:71], a[180:183], a[116:119]
  v_add_f32 v54, v54, v62
  v_add_f32 v39, v39, v47
  v_mfma_f32_16x16x32_bf16 a[132:135], v[72:75], a[180:183], a[132:135]
  s_waitcnt vmcnt(17)
  buffer_load_dwordx4 a[180:183], v2, s[40:43], s65 offen offset:2048 sc1
  v_add_f32 v55, v55, v63
  v_mfma_f32_16x16x32_bf16 a[72:75], a[8:11], a[184:187], a[72:75]
  v_add_f32 v32, v32, v48
  v_add_f32 v33, v33, v49
  v_mfma_f32_16x16x32_bf16 a[88:91], a[12:15], a[184:187], a[88:91]
  v_add_f32 v34, v34, v50
  v_add_f32 v35, v35, v51
  v_mfma_f32_16x16x32_bf16 a[104:107], v[64:67], a[184:187], a[104:107]
  v_add_f32 v36, v36, v52
  v_mfma_f32_16x16x32_bf16 a[120:123], v[68:71], a[184:187], a[120:123]
  v_add_f32 v37, v37, v53
  v_add_f32 v38, v38, v54
  v_mfma_f32_16x16x32_bf16 a[136:139], v[72:75], a[184:187], a[136:139]
  buffer_load_dwordx4 a[184:187], v2, s[40:43], s66 offen offset:2048 sc1
  v_add_f32 v39, v39, v55
  v_mfma_f32_16x16x32_bf16 a[76:79], a[8:11], a[188:191], a[76:79]
  s_add_u32 s14, s28, 16384
  v_mfma_f32_16x16x32_bf16 a[92:95], a[12:15], a[188:191], a[92:95]
  buffer_store_dwordx4 v[32:35], v6, s[40:43], s14 offen sc1
  v_mfma_f32_16x16x32_bf16 a[108:111], v[64:67], a[188:191], a[108:111]
  s_add_u32 s14, s28, 20480
  v_mfma_f32_16x16x32_bf16 a[124:127], v[68:71], a[188:191], a[124:127]
  buffer_store_dwordx4 v[36:39], v6, s[40:43], s14 offen sc1
  v_mfma_f32_16x16x32_bf16 a[140:143], v[72:75], a[188:191], a[140:143]
  s_waitcnt vmcnt(19)
  buffer_load_dwordx4 a[188:191], v2, s[40:43], s67 offen offset:2048 sc1
  v_mfma_f32_16x16x32_bf16 a[64:67], v[76:79], v[216:219], a[64:67]
  v_mfma_f32_16x16x32_bf16 a[80:83], v[80:83], v[216:219], a[80:83]
  v_mfma_f32_16x16x32_bf16 a[96:99], v[84:87], v[216:219], a[96:99]
  v_mfma_f32_16x16x32_bf16 a[112:115], v[88:91], v[216:219], a[112:115]
  v_mfma_f32_16x16x32_bf16 a[128:131], v[92:95], v[216:219], a[128:131]
  buffer_load_dwordx4 v[216:219], v2, s[40:43], s64 offen offset:3072 sc1
  v_mfma_f32_16x16x32_bf16 a[68:71], v[76:79], v[220:223], a[68:71]
  v_mfma_f32_16x16x32_bf16 a[84:87], v[80:83], v[220:223], a[84:87]
  v_mfma_f32_16x16x32_bf16 a[100:103], v[84:87], v[220:223], a[100:103]
  s_barrier
  v_mfma_f32_16x16x32_bf16 a[116:119], v[88:91], v[220:223], a[116:119]
  v_mfma_f32_16x16x32_bf16 a[132:135], v[92:95], v[220:223], a[132:135]
  s_waitcnt vmcnt(17)
  buffer_load_dwordx4 v[220:223], v2, s[40:43], s65 offen offset:3072 sc1
  v_mfma_f32_16x16x32_bf16 a[72:75], v[76:79], v[224:227], a[72:75]
  v_mfma_f32_16x16x32_bf16 a[88:91], v[80:83], v[224:227], a[88:91]
  v_mfma_f32_16x16x32_bf16 a[104:107], v[84:87], v[224:227], a[104:107]
  v_mfma_f32_16x16x32_bf16 a[120:123], v[88:91], v[224:227], a[120:123]
  v_mfma_f32_16x16x32_bf16 a[136:139], v[92:95], v[224:227], a[136:139]
  buffer_load_dwordx4 v[224:227], v2, s[40:43], s66 offen offset:3072 sc1
  v_mfma_f32_16x16x32_bf16 a[76:79], v[76:79], v[228:231], a[76:79]
  v_mfma_f32_16x16x32_bf16 a[92:95], v[80:83], v[228:231], a[92:95]
  v_mfma_f32_16x16x32_bf16 a[108:111], v[84:87], v[228:231], a[108:111]
  v_mfma_f32_16x16x32_bf16 a[124:127], v[88:91], v[228:231], a[124:127]
  v_mfma_f32_16x16x32_bf16 a[140:143], v[92:95], v[228:231], a[140:143]
  s_waitcnt vmcnt(17)
  buffer_load_dwordx4 v[228:231], v2, s[40:43], s67 offen offset:3072 sc1
  v_mfma_f32_16x16x32_bf16 a[64:67], a[16:19], a[144:147], a[64:67]
  ds_read_b128 v[160:163], v200 offset:0
  v_mfma_f32_16x16x32_bf16 a[80:83], a[20:23], a[144:147], a[80:83]
  v_mfma_f32_16x16x32_bf16 a[96:99], a[24:27], a[144:147], a[96:99]
  v_mfma_f32_16x16x32_bf16 a[112:115], a[28:31], a[144:147], a[112:115]
  s_add_u32 s64, s64, 4096
  ds_read_b128 v[164:167], v200 offset:1024
  v_mfma_f32_16x16x32_bf16 a[128:131], a[32:35], a[144:147], a[128:131]
  buffer_load_dwordx4 a[144:147], v2, s[40:43], s64 offen offset:0 sc1
  v_mfma_f32_16x16x32_bf16 a[68:71], a[16:19], a[148:151], a[68:71]
  s_add_u32 s65, s64, 131072
  ds_read_b128 v[168:171], v200 offset:2048
  v_mfma_f32_16x16x32_bf16 a[84:87], a[20:23], a[148:151], a[84:87]
  s_add_u32 s66, s64, 262144
  ds_read_b128 v[172:175], v200 offset:3072
  v_mfma_f32_16x16x32_bf16 a[100:103], a[24:27], a[148:151], a[100:103]
  v_mfma_f32_16x16x32_bf16 a[116:119], a[28:31], a[148:151], a[116:119]
  ds_read_b128 v[232:235], v200 offset:4096
  v_mfma_f32_16x16x32_bf16 a[132:135], a[32:35], a[148:151], a[132:135]
  s_waitcnt vmcnt(17)
  buffer_load_dwordx4 a[148:151], v2, s[40:43], s65 offen offset:0 sc1
  v_mfma_f32_16x16x32_bf16 a[72:75], a[16:19], a[152:155], a[72:75]
  s_add_u32 s67, s64, 393216
  ds_read_b128 v[236:239], v201 offset:0
  v_mfma_f32_16x16x32_bf16 a[88:91], a[20:23], a[152:155], a[88:91]
  v_mfma_f32_16x16x32_bf16 a[104:107], a[24:27], a[152:155], a[104:107]
  v_mfma_f32_16x16x32_bf16 a[120:123], a[28:31], a[152:155], a[120:123]
  v_mfma_f32_16x16x32_bf16 a[136:139], a[32:35], a[152:155], a[136:139]
  buffer_load_dwordx4 a[152:155], v2, s[40:43], s66 offen offset:0 sc1
  v_mfma_f32_16x16x32_bf16 a[76:79], a[16:19], a[156:159], a[76:79]
  v_mfma_f32_16x16x32_bf16 a[92:95], a[20:23], a[156:159], a[92:95]
  v_mfma_f32_16x16x32_bf16 a[108:111], a[24:27], a[156:159], a[108:111]
  v_mfma_f32_16x16x32_bf16 a[124:127], a[28:31], a[156:159], a[124:127]
  v_mfma_f32_16x16x32_bf16 a[140:143], a[32:35], a[156:159], a[140:143]
  s_waitcnt vmcnt(8)
  buffer_load_dwordx4 a[156:159], v2, s[40:43], s67 offen offset:0 sc1
  v_mfma_f32_16x16x32_bf16 a[64:67], a[36:39], a[160:163], a[64:67]
  ds_read_b128 v[120:123], v203 offset:0
  v_mfma_f32_16x16x32_bf16 a[80:83], a[40:43], a[160:163], a[80:83]
  buffer_store_dword v4, off, s[40:43], s30 sc1
  v_mfma_f32_16x16x32_bf16 a[96:99], a[44:47], a[160:163], a[96:99]
  v_mfma_f32_16x16x32_bf16 a[112:115], v[128:131], a[160:163], a[112:115]
  ds_read_b128 v[124:127], v203 offset:16
  v_mfma_f32_16x16x32_bf16 a[128:131], v[132:135], a[160:163], a[128:131]
  buffer_load_dwordx4 a[160:163], v2, s[40:43], s64 offen offset:1024 sc1
  v_mfma_f32_16x16x32_bf16 a[68:71], a[36:39], a[164:167], a[68:71]
  ds_read_b128 v[192:195], v204 offset:0
  v_mfma_f32_16x16x32_bf16 a[84:87], a[40:43], a[164:167], a[84:87]
  ds_read_b128 v[196:199], v204 offset:16
  v_mfma_f32_16x16x32_bf16 a[100:103], a[44:47], a[164:167], a[100:103]
  v_mfma_f32_16x16x32_bf16 a[116:119], v[128:131], a[164:167], a[116:119]
  ds_read_b128 v[208:211], v205 offset:0
  v_mfma_f32_16x16x32_bf16 a[132:135], v[132:135], a[164:167], a[132:135]
  s_waitcnt vmcnt(16)
  buffer_load_dwordx4 a[164:167], v2, s[40:43], s65 offen offset:1024 sc1
  v_mfma_f32_16x16x32_bf16 a[72:75], a[36:39], a[168:171], a[72:75]
  ds_read_b128 v[212:215], v205 offset:16
  v_mfma_f32_16x16x32_bf16 a[88:91], a[40:43], a[168:171], a[88:91]
  v_mfma_f32_16x16x32_bf16 a[104:107], a[44:47], a[168:171], a[104:107]
  v_mfma_f32_16x16x32_bf16 a[120:123], v[128:131], a[168:171], a[120:123]
  v_mfma_f32_16x16x32_bf16 a[136:139], v[132:135], a[168:171], a[136:139]
  buffer_load_dwordx4 a[168:171], v2, s[40:43], s66 offen offset:1024 sc1
  v_mfma_f32_16x16x32_bf16 a[76:79], a[36:39], a[172:175], a[76:79]
  v_mfma_f32_16x16x32_bf16 a[92:95], a[40:43], a[172:175], a[92:95]
  v_mfma_f32_16x16x32_bf16 a[108:111], a[44:47], a[172:175], a[108:111]
  v_mfma_f32_16x16x32_bf16 a[124:127], v[128:131], a[172:175], a[124:127]
  v_mfma_f32_16x16x32_bf16 a[140:143], v[132:135], a[172:175], a[140:143]
  s_waitcnt vmcnt(16) lgkmcnt(0)
  buffer_load_dwordx4 a[172:175], v2, s[40:43], s67 offen offset:1024 sc1
  v_mfma_f32_16x16x32_bf16 a[64:67], v[136:139], a[176:179], a[64:67]
  v_mfma_f32_16x16x32_bf16 a[80:83], v[140:143], a[176:179], a[80:83]
  v_lshlrev_b32 v18, 16, v172
  v_and_b32 v19, 0xffff0000, v172
  v_mfma_f32_16x16x32_bf16 a[96:99], v[144:147], a[176:179], a[96:99]
  v_add_f32 v120, v120, v18
  v_add_f32 v121, v121, v19
  v_mfma_f32_16x16x32_bf16 a[112:115], v[148:151], a[176:179], a[112:115]
  v_cvt_pk_bf16_f32 v18, v120, v121
  v_lshlrev_b32 v96, 16, v160
  v_mfma_f32_16x16x32_bf16 a[128:131], v[152:155], a[176:179], a[128:131]
  buffer_load_dwordx4 a[176:179], v2, s[40:43], s64 offen offset:2048 sc1
  v_and_b32 v97, 0xffff0000, v160
  v_lshlrev_b32 v120, 16, v18
  v_mfma_f32_16x16x32_bf16 a[68:71], v[136:139], a[180:183], a[68:71]
  v_and_b32 v121, 0xffff0000, v18
  v_lshlrev_b32 v18, 16, v173
  v_mfma_f32_16x16x32_bf16 a[84:87], v[140:143], a[180:183], a[84:87]
  v_and_b32 v19, 0xffff0000, v173
  v_add_f32 v122, v122, v18
  v_mfma_f32_16x16x32_bf16 a[100:103], v[144:147], a[180:183], a[100:103]
  v_add_f32 v123, v123, v19
  v_cvt_pk_bf16_f32 v18, v122, v123
  v_mfma_f32_16x16x32_bf16 a[116:119], v[148:151], a[180:183], a[116:119]
  v_lshlrev_b32 v98, 16, v161
  v_and_b32 v99, 0xffff0000, v161
  v_mfma_f32_16x16x32_bf16 a[132:135], v[152:155], a[180:183], a[132:135]
  s_waitcnt vmcnt(14)
  buffer_load_dwordx4 a[180:183], v2, s[40:43], s65 offen offset:2048 sc1
  v_lshlrev_b32 v122, 16, v18
  v_and_b32 v123, 0xffff0000, v18
  v_mfma_f32_16x16x32_bf16 a[72:75], v[136:139], a[184:187], a[72:75]
  v_lshlrev_b32 v18, 16, v174
  v_and_b32 v19, 0xffff0000, v174
  v_mfma_f32_16x16x32_bf16 a[88:91], v[140:143], a[184:187], a[88:91]
  v_add_f32 v124, v124, v18
  v_add_f32 v125, v125, v19
  v_mfma_f32_16x16x32_bf16 a[104:107], v[144:147], a[184:187], a[104:107]
  v_cvt_pk_bf16_f32 v18, v124, v125
  v_lshlrev_b32 v100, 16, v162
  v_mfma_f32_16x16x32_bf16 a[120:123], v[148:151], a[184:187], a[120:123]
  v_and_b32 v101, 0xffff0000, v162
  v_lshlrev_b32 v124, 16, v18
  v_mfma_f32_16x16x32_bf16 a[136:139], v[152:155], a[184:187], a[136:139]
  buffer_load_dwordx4 a[184:187], v2, s[40:43], s66 offen offset:2048 sc1
  v_and_b32 v125, 0xffff0000, v18
  v_lshlrev_b32 v18, 16, v175
  v_mfma_f32_16x16x32_bf16 a[76:79], v[136:139], a[188:191], a[76:79]
  v_and_b32 v19, 0xffff0000, v175
  v_add_f32 v126, v126, v18
  v_mfma_f32_16x16x32_bf16 a[92:95], v[140:143], a[188:191], a[92:95]
  v_add_f32 v127, v127, v19
  v_cvt_pk_bf16_f32 v18, v126, v127
  v_mfma_f32_16x16x32_bf16 a[108:111], v[144:147], a[188:191], a[108:111]
  v_lshlrev_b32 v102, 16, v163
  v_and_b32 v103, 0xffff0000, v163
  v_mfma_f32_16x16x32_bf16 a[124:127], v[148:151], a[188:191], a[124:127]
  v_lshlrev_b32 v126, 16, v18
  v_and_b32 v127, 0xffff0000, v18
  v_mfma_f32_16x16x32_bf16 a[140:143], v[152:155], a[188:191], a[140:143]
  s_waitcnt vmcnt(14)
  buffer_load_dwordx4 a[188:191], v2, s[40:43], s67 offen offset:2048 sc1
  v_mfma_f32_16x16x32_bf16 a[64:67], v[156:159], v[216:219], a[64:67]
  v_mfma_f32_16x16x32_bf16 a[80:83], a[48:51], v[216:219], a[80:83]
  v_lshlrev_b32 v18, 16, v232
  v_and_b32 v19, 0xffff0000, v232
  v_mfma_f32_16x16x32_bf16 a[96:99], a[52:55], v[216:219], a[96:99]
  v_add_f32 v192, v192, v18
  v_add_f32 v193, v193, v19
  v_mfma_f32_16x16x32_bf16 a[112:115], a[56:59], v[216:219], a[112:115]
  v_cvt_pk_bf16_f32 v18, v192, v193
  v_lshlrev_b32 v104, 16, v164
  v_mfma_f32_16x16x32_bf16 a[128:131], a[60:63], v[216:219], a[128:131]
  buffer_load_dwordx4 v[216:219], v2, s[40:43], s64 offen offset:3072 sc1
  v_and_b32 v105, 0xffff0000, v164
  v_lshlrev_b32 v192, 16, v18
  v_mfma_f32_16x16x32_bf16 a[68:71], v[156:159], v[220:223], a[68:71]
  v_and_b32 v193, 0xffff0000, v18
  v_lshlrev_b32 v18, 16, v233
  v_mfma_f32_16x16x32_bf16 a[84:87], a[48:51], v[220:223], a[84:87]
  v_and_b32 v19, 0xffff0000, v233
  v_add_f32 v194, v194, v18
  v_mfma_f32_16x16x32_bf16 a[100:103], a[52:55], v[220:223], a[100:103]
  v_add_f32 v195, v195, v19
  v_cvt_pk_bf16_f32 v18, v194, v195
  v_mfma_f32_16x16x32_bf16 a[116:119], a[56:59], v[220:223], a[116:119]
  v_lshlrev_b32 v106, 16, v165
  v_and_b32 v107, 0xffff0000, v165
  v_mfma_f32_16x16x32_bf16 a[132:135], a[60:63], v[220:223], a[132:135]
  s_waitcnt vmcnt(14)
  buffer_load_dwordx4 v[220:223], v2, s[40:43], s65 offen offset:3072 sc1
  v_lshlrev_b32 v194, 16, v18
  v_and_b32 v195, 0xffff0000, v18
  v_mfma_f32_16x16x32_bf16 a[72:75], v[156:159], v[224:227], a[72:75]
  v_lshlrev_b32 v18, 16, v234
  v_and_b32 v19, 0xffff0000, v234
  v_mfma_f32_16x16x32_bf16 a[88:91], a[48:51], v[224:227], a[88:91]
  v_add_f32 v196, v196, v18
  v_add_f32 v197, v197, v19
  v_mfma_f32_16x16x32_bf16 a[104:107], a[52:55], v[224:227], a[104:107]
  v_cvt_pk_bf16_f32 v18, v196, v197
  v_lshlrev_b32 v108, 16, v166
  v_mfma_f32_16x16x32_bf16 a[120:123], a[56:59], v[224:227], a[120:123]
  v_and_b32 v109, 0xffff0000, v166
  v_lshlrev_b32 v196, 16, v18
  v_mfma_f32_16x16x32_bf16 a[136:139], a[60:63], v[224:227], a[136:139]
  buffer_load_dwordx4 v[224:227], v2, s[40:43], s66 offen offset:3072 sc1
  v_and_b32 v197, 0xffff0000, v18
  v_lshlrev_b32 v18, 16, v235
  v_mfma_f32_16x16x32_bf16 a[76:79], v[156:159], v[228:231], a[76:79]
  v_and_b32 v19, 0xffff0000, v235
  v_add_f32 v198, v198, v18
  v_mfma_f32_16x16x32_bf16 a[92:95], a[48:51], v[228:231], a[92:95]
  v_add_f32 v199, v199, v19
  v_cvt_pk_bf16_f32 v18, v198, v199
  v_mfma_f32_16x16x32_bf16 a[108:111], a[52:55], v[228:231], a[108:111]
  v_lshlrev_b32 v110, 16, v167
  v_and_b32 v111, 0xffff0000, v167
  v_mfma_f32_16x16x32_bf16 a[124:127], a[56:59], v[228:231], a[124:127]
  v_lshlrev_b32 v198, 16, v18
  v_and_b32 v199, 0xffff0000, v18
  v_mfma_f32_16x16x32_bf16 a[140:143], a[60:63], v[228:231], a[140:143]
  s_waitcnt vmcnt(14)
  buffer_load_dwordx4 v[228:231], v2, s[40:43], s67 offen offset:3072 sc1
  v_mfma_f32_16x16x32_bf16 a[64:67], a[192:195], a[144:147], a[64:67]
  buffer_load_dword v13, v8, s[40:43], 0 offen sc1
  v_mfma_f32_16x16x32_bf16 a[80:83], a[196:199], a[144:147], a[80:83]
  v_lshlrev_b32 v18, 16, v236
  v_and_b32 v19, 0xffff0000, v236
  v_mfma_f32_16x16x32_bf16 a[96:99], a[200:203], a[144:147], a[96:99]
  v_add_f32 v208, v208, v18
  v_add_f32 v209, v209, v19
  v_mfma_f32_16x16x32_bf16 a[112:115], a[204:207], a[144:147], a[112:115]
  v_cvt_pk_bf16_f32 v18, v208, v209
  v_lshlrev_b32 v112, 16, v168
  v_mfma_f32_16x16x32_bf16 a[128:131], v[176:179], a[144:147], a[128:131]
  v_and_b32 v113, 0xffff0000, v168
  v_lshlrev_b32 v208, 16, v18
  v_mfma_f32_16x16x32_bf16 a[68:71], a[192:195], a[148:151], a[68:71]
  v_and_b32 v209, 0xffff0000, v18
  v_lshlrev_b32 v18, 16, v237
  v_mfma_f32_16x16x32_bf16 a[84:87], a[196:199], a[148:151], a[84:87]
  v_and_b32 v19, 0xffff0000, v237
  v_add_f32 v210, v210, v18
  v_mfma_f32_16x16x32_bf16 a[100:103], a[200:203], a[148:151], a[100:103]
  v_add_f32 v211, v211, v19
  v_cvt_pk_bf16_f32 v18, v210, v211
  v_mfma_f32_16x16x32_bf16 a[116:119], a[204:207], a[148:151], a[116:119]
  v_lshlrev_b32 v114, 16, v169
  v_and_b32 v115, 0xffff0000, v169
  v_mfma_f32_16x16x32_bf16 a[132:135], v[176:179], a[148:151], a[132:135]
  s_waitcnt vmcnt(14)
  v_lshlrev_b32 v210, 16, v18
  v_and_b32 v211, 0xffff0000, v18
  v_mfma_f32_16x16x32_bf16 a[72:75], a[192:195], a[152:155], a[72:75]
  v_lshlrev_b32 v18, 16, v238
  v_and_b32 v19, 0xffff0000, v238
  v_mfma_f32_16x16x32_bf16 a[88:91], a[196:199], a[152:155], a[88:91]
  v_add_f32 v212, v212, v18
  v_add_f32 v213, v213, v19
  v_mfma_f32_16x16x32_bf16 a[104:107], a[200:203], a[152:155], a[104:107]
  v_cvt_pk_bf16_f32 v18, v212, v213
  v_lshlrev_b32 v116, 16, v170
  v_mfma_f32_16x16x32_bf16 a[120:123], a[204:207], a[152:155], a[120:123]
  v_and_b32 v117, 0xffff0000, v170
  v_lshlrev_b32 v212, 16, v18
  v_mfma_f32_16x16x32_bf16 a[136:139], v[176:179], a[152:155], a[136:139]
  v_and_b32 v213, 0xffff0000, v18
  v_lshlrev_b32 v18, 16, v239
  v_mfma_f32_16x16x32_bf16 a[76:79], a[192:195], a[156:159], a[76:79]
  v_and_b32 v19, 0xffff0000, v239
  v_add_f32 v214, v214, v18
  v_mfma_f32_16x16x32_bf16 a[92:95], a[196:199], a[156:159], a[92:95]
  v_add_f32 v215, v215, v19
  v_cvt_pk_bf16_f32 v18, v214, v215
  v_mfma_f32_16x16x32_bf16 a[108:111], a[200:203], a[156:159], a[108:111]
  v_lshlrev_b32 v118, 16, v171
  v_and_b32 v119, 0xffff0000, v171
  v_mfma_f32_16x16x32_bf16 a[124:127], a[204:207], a[156:159], a[124:127]
  v_lshlrev_b32 v214, 16, v18
  v_and_b32 v215, 0xffff0000, v18
  v_mfma_f32_16x16x32_bf16 a[140:143], v[176:179], a[156:159], a[140:143]
  s_waitcnt vmcnt(11)
  v_mfma_f32_16x16x32_bf16 a[64:67], v[180:183], a[160:163], a[64:67]
  v_mfma_f32_16x16x32_bf16 a[80:83], v[184:187], a[160:163], a[80:83]
  v_mfma_f32_16x16x32_bf16 a[96:99], v[188:191], a[160:163], a[96:99]
  v_mfma_f32_16x16x32_bf16 a[112:115], a[208:211], a[160:163], a[112:115]
  v_mfma_f32_16x16x32_bf16 a[128:131], a[212:215], a[160:163], a[128:131]
  v_mfma_f32_16x16x32_bf16 a[68:71], v[180:183], a[164:167], a[68:71]
  v_mfma_f32_16x16x32_bf16 a[84:87], v[184:187], a[164:167], a[84:87]
  v_mfma_f32_16x16x32_bf16 a[100:103], v[188:191], a[164:167], a[100:103]
  v_mfma_f32_16x16x32_bf16 a[116:119], a[208:211], a[164:167], a[116:119]
  v_mfma_f32_16x16x32_bf16 a[132:135], a[212:215], a[164:167], a[132:135]
  s_waitcnt vmcnt(9)
  v_mfma_f32_16x16x32_bf16 a[72:75], v[180:183], a[168:171], a[72:75]
  v_mfma_f32_16x16x32_bf16 a[88:91], v[184:187], a[168:171], a[88:91]
  v_mfma_f32_16x16x32_bf16 a[104:107], v[188:191], a[168:171], a[104:107]
  v_mfma_f32_16x16x32_bf16 a[120:123], a[208:211], a[168:171], a[120:123]
  v_mfma_f32_16x16x32_bf16 a[136:139], a[212:215], a[168:171], a[136:139]
  v_mfma_f32_16x16x32_bf16 a[76:79], v[180:183], a[172:175], a[76:79]
  v_mfma_f32_16x16x32_bf16 a[92:95], v[184:187], a[172:175], a[92:95]
  v_mfma_f32_16x16x32_bf16 a[108:111], v[188:191], a[172:175], a[108:111]
  v_mfma_f32_16x16x32_bf16 a[124:127], a[208:211], a[172:175], a[124:127]
  v_mfma_f32_16x16x32_bf16 a[140:143], a[212:215], a[172:175], a[140:143]
  s_waitcnt vmcnt(0)
  v_mfma_f32_16x16x32_bf16 a[64:67], a[216:219], a[176:179], a[64:67]
  v_cmp_eq_u32 vcc, 0, v13
  v_mfma_f32_16x16x32_bf16 a[80:83], a[220:223], a[176:179], a[80:83]
  v_mfma_f32_16x16x32_bf16 a[96:99], a[224:227], a[176:179], a[96:99]
  s_cbranch_vccnz fa_px_spin
fa_px_ok:
  v_mfma_f32_16x16x32_bf16 a[112:115], a[228:231], a[176:179], a[112:115]
  s_add_u32 s14, s29, 0
  buffer_load_dwordx4 v[240:243], v9, s[40:43], s14 offen sc1
  v_mfma_f32_16x16x32_bf16 a[128:131], a[232:235], a[176:179], a[128:131]
  v_mfma_f32_16x16x32_bf16 a[68:71], a[216:219], a[180:183], a[68:71]
  s_add_u32 s14, s29, 4096
  buffer_load_dwordx4 v[244:247], v9, s[40:43], s14 offen sc1
  v_mfma_f32_16x16x32_bf16 a[84:87], a[220:223], a[180:183], a[84:87]
  v_mfma_f32_16x16x32_bf16 a[100:103], a[224:227], a[180:183], a[100:103]
  s_add_u32 s14, s29, 8192
  buffer_load_dwordx4 v[176:179], v9, s[40:43], s14 offen sc1
  v_mfma_f32_16x16x32_bf16 a[116:119], a[228:231], a[180:183], a[116:119]
  v_mfma_f32_16x16x32_bf16 a[132:135], a[232:235], a[180:183], a[132:135]
  s_waitcnt vmcnt(8)
  s_add_u32 s14, s29, 12288
  buffer_load_dwordx4 v[180:183], v9, s[40:43], s14 offen sc1
  v_mfma_f32_16x16x32_bf16 a[72:75], a[216:219], a[184:187], a[72:75]
  v_mfma_f32_16x16x32_bf16 a[88:91], a[220:223], a[184:187], a[88:91]
  s_add_u32 s14, s29, 16384
  buffer_load_dwordx4 v[184:187], v6, s[40:43], s14 offen sc1
  v_mfma_f32_16x16x32_bf16 a[104:107], a[224:227], a[184:187], a[104:107]
  v_mfma_f32_16x16x32_bf16 a[120:123], a[228:231], a[184:187], a[120:123]
  s_add_u32 s14, s29, 20480
  buffer_load_dwordx4 v[188:191], v6, s[40:43], s14 offen sc1
  v_mfma_f32_16x16x32_bf16 a[136:139], a[232:235], a[184:187], a[136:139]
  v_mfma_f32_16x16x32_bf16 a[76:79], a[216:219], a[188:191], a[76:79]
  v_mfma_f32_16x16x32_bf16 a[92:95], a[220:223], a[188:191], a[92:95]
  v_mfma_f32_16x16x32_bf16 a[108:111], a[224:227], a[188:191], a[108:111]
  v_mfma_f32_16x16x32_bf16 a[124:127], a[228:231], a[188:191], a[124:127]
  v_mfma_f32_16x16x32_bf16 a[140:143], a[232:235], a[188:191], a[140:143]
  s_waitcnt vmcnt(9)
  v_mfma_f32_16x16x32_bf16 a[64:67], a[236:239], v[216:219], a[64:67]
  v_mfma_f32_16x16x32_bf16 a[80:83], a[240:243], v[216:219], a[80:83]
  v_mfma_f32_16x16x32_bf16 a[96:99], a[244:247], v[216:219], a[96:99]
  v_mfma_f32_16x16x32_bf16 a[112:115], a[248:251], v[216:219], a[112:115]
  v_mfma_f32_16x16x32_bf16 a[128:131], a[252:255], v[216:219], a[128:131]
  v_mfma_f32_16x16x32_bf16 a[68:71], a[236:239], v[220:223], a[68:71]
  v_mfma_f32_16x16x32_bf16 a[84:87], a[240:243], v[220:223], a[84:87]
  v_mfma_f32_16x16x32_bf16 a[100:103], a[244:247], v[220:223], a[100:103]
  v_mfma_f32_16x16x32_bf16 a[116:119], a[248:251], v[220:223], a[116:119]
  v_mfma_f32_16x16x32_bf16 a[132:135], a[252:255], v[220:223], a[132:135]
  s_waitcnt vmcnt(7)
  ds_write_b128 v16, a[64:67] offset:0
  v_mfma_f32_16x16x32_bf16 a[72:75], a[236:239], v[224:227], a[72:75]
  ds_write_b128 v16, a[80:83] offset:64
  v_mfma_f32_16x16x32_bf16 a[88:91], a[240:243], v[224:227], a[88:91]
  ds_write_b128 v16, a[96:99] offset:128
  v_mfma_f32_16x16x32_bf16 a[104:107], a[244:247], v[224:227], a[104:107]
  ds_write_b128 v16, a[112:115] offset:192
  v_mfma_f32_16x16x32_bf16 a[120:123], a[248:251], v[224:227], a[120:123]
  ds_write_b128 v16, a[128:131] offset:256
  v_mfma_f32_16x16x32_bf16 a[136:139], a[252:255], v[224:227], a[136:139]
  ds_write_b128 v16, a[68:71] offset:5376
  v_mfma_f32_16x16x32_bf16 a[76:79], a[236:239], v[228:231], a[76:79]
  ds_write_b128 v16, a[84:87] offset:5440
  v_mfma_f32_16x16x32_bf16 a[92:95], a[240:243], v[228:231], a[92:95]
  ds_write_b128 v16, a[100:103] offset:5504
  v_mfma_f32_16x16x32_bf16 a[108:111], a[244:247], v[228:231], a[108:111]
  ds_write_b128 v16, a[116:119] offset:5568
  v_mfma_f32_16x16x32_bf16 a[124:127], a[248:251], v[228:231], a[124:127]
  ds_write_b128 v16, a[132:135] offset:5632
  v_mfma_f32_16x16x32_bf16 a[140:143], a[252:255], v[228:231], a[140:143]
  ds_write_b128 v16, a[72:75] offset:10752
  ds_write_b128 v16, a[88:91] offset:10816
  ds_write_b128 v16, a[104:107] offset:10880
  ds_write_b128 v16, a[120:123] offset:10944
  ds_write_b128 v16, a[136:139] offset:11008
  ds_write_b128 v16, a[76:79] offset:16128
  ds_write_b128 v16, a[92:95] offset:16192
  ds_write_b128 v16, a[108:111] offset:16256
  ds_write_b128 v16, a[124:127] offset:16320
  ds_write_b128 v16, a[140:143] offset:16384
  s_waitcnt vmcnt(0) lgkmcnt(0)
  s_barrier
  ds_read_b128 v[32:35], v251 offset:0
  ds_read_b128 v[36:39], v251 offset:16
  ds_read_b128 v[40:43], v251 offset:21504
  ds_read_b128 v[44:47], v251 offset:21520
  ds_read_b128 v[48:51], v251 offset:43008
  ds_read_b128 v[52:55], v251 offset:43024
  ds_read_b128 v[56:59], v251 offset:64512
  ds_read_b128 v[60:63], v251 offset:64528
  ds_read_b128 v[64:67], v252 offset:0
  ds_read_b128 v[68:71], v252 offset:16
  ds_read_b128 v[72:75], v252 offset:21504
  ds_read_b128 v[76:79], v252 offset:21520
  ds_read_b128 v[80:83], v252 offset:43008
  ds_read_b128 v[84:87], v252 offset:43024
  ds_read_b128 v[88:91], v252 offset:64512
  ds_read_b128 v[92:95], v252 offset:64528
  ds_read_b128 v[128:131], v253 offset:0
  ds_read_b128 v[132:135], v253 offset:16
  ds_read_b128 v[136:139], v253 offset:21504
  ds_read_b128 v[140:143], v253 offset:21520
  ds_read_b128 v[144:147], v253 offset:43008
  ds_read_b128 v[148:151], v253 offset:43024
  ds_read_b128 v[152:155], v253 offset:64512
  ds_read_b128 v[156:159], v253 offset:64528
  s_waitcnt lgkmcnt(15)
  v_pk_add_f32 v[32:33], v[32:33], v[40:41]
  v_pk_add_f32 v[48:49], v[48:49], v[56:57]
  v_pk_add_f32 v[34:35], v[34:35], v[42:43]
  v_pk_add_f32 v[50:51], v[50:51], v[58:59]
  v_pk_add_f32 v[36:37], v[36:37], v[44:45]
  v_pk_add_f32 v[52:53], v[52:53], v[60:61]
  v_pk_add_f32 v[38:39], v[38:39], v[46:47]
  v_pk_add_f32 v[54:55], v[54:55], v[62:63]
  v_pk_add_f32 v[32:33], v[32:33], v[48:49]
  v_pk_add_f32 v[34:35], v[34:35], v[50:51]
  v_pk_add_f32 v[36:37], v[36:37], v[52:53]
  v_pk_add_f32 v[38:39], v[38:39], v[54:55]
  v_pk_add_f32 v[32:33], v[32:33], v[240:241]
  v_pk_add_f32 v[34:35], v[34:35], v[242:243]
  v_pk_add_f32 v[36:37], v[36:37], v[244:245]
  v_pk_add_f32 v[38:39], v[38:39], v[246:247]
  v_cvt_pk_bf16_f32 v40, v32, v33
  v_cvt_pk_bf16_f32 v41, v34, v35
  v_cvt_pk_bf16_f32 v42, v36, v37
  v_cvt_pk_bf16_f32 v43, v38, v39
  v_lshlrev_b32 v32, 16, v40
  v_and_b32 v33, 0xffff0000, v40
  v_lshlrev_b32 v34, 16, v41
  v_and_b32 v35, 0xffff0000, v41
  v_lshlrev_b32 v36, 16, v42
  v_and_b32 v37, 0xffff0000, v42
  v_lshlrev_b32 v38, 16, v43
  v_and_b32 v39, 0xffff0000, v43
  v_pk_add_f32 v[32:33], v[32:33], v[96:97]
  v_pk_add_f32 v[34:35], v[34:35], v[98:99]
  v_pk_add_f32 v[36:37], v[36:37], v[100:101]
  v_pk_add_f32 v[38:39], v[38:39], v[102:103]
  v_cvt_pk_bf16_f32 v40, v32, v33
  v_cvt_pk_bf16_f32 v41, v34, v35
  v_cvt_pk_bf16_f32 v42, v36, v37
  v_cvt_pk_bf16_f32 v43, v38, v39
  v_lshlrev_b32 v32, 16, v40
  v_and_b32 v33, 0xffff0000, v40
  v_lshlrev_b32 v34, 16, v41
  v_and_b32 v35, 0xffff0000, v41
  v_lshlrev_b32 v36, 16, v42
  v_and_b32 v37, 0xffff0000, v42
  v_lshlrev_b32 v38, 16, v43
  v_and_b32 v39, 0xffff0000, v43
  v_pk_add_f32 v[32:33], v[32:33], v[120:121]
  v_pk_add_f32 v[34:35], v[34:35], v[122:123]
  v_pk_add_f32 v[36:37], v[36:37], v[124:125]
  v_pk_add_f32 v[38:39], v[38:39], v[126:127]
  v_cvt_pk_bf16_f32 v44, v32, v33
  v_cvt_pk_bf16_f32 v45, v34, v35
  v_cvt_pk_bf16_f32 v46, v36, v37
  v_cvt_pk_bf16_f32 v47, v38, v39
  buffer_store_dwordx4 v[44:47], v248, s[48:51], 0 offen
  s_waitcnt lgkmcnt(8)
  v_pk_add_f32 v[64:65], v[64:65], v[72:73]
  v_pk_add_f32 v[80:81], v[80:81], v[88:89]
  v_pk_add_f32 v[66:67], v[66:67], v[74:75]
  v_pk_add_f32 v[82:83], v[82:83], v[90:91]
  v_pk_add_f32 v[68:69], v[68:69], v[76:77]
  v_pk_add_f32 v[84:85], v[84:85], v[92:93]
  v_pk_add_f32 v[70:71], v[70:71], v[78:79]
  v_pk_add_f32 v[86:87], v[86:87], v[94:95]
  v_pk_add_f32 v[64:65], v[64:65], v[80:81]
  v_pk_add_f32 v[66:67], v[66:67], v[82:83]
  v_pk_add_f32 v[68:69], v[68:69], v[84:85]
  v_pk_add_f32 v[70:71], v[70:71], v[86:87]
  v_pk_add_f32 v[64:65], v[64:65], v[176:177]
  v_pk_add_f32 v[66:67], v[66:67], v[178:179]
  v_pk_add_f32 v[68:69], v[68:69], v[180:181]
  v_pk_add_f32 v[70:71], v[70:71], v[182:183]
  v_cvt_pk_bf16_f32 v72, v64, v65
  v_cvt_pk_bf16_f32 v73, v66, v67
  v_cvt_pk_bf16_f32 v74, v68, v69
  v_cvt_pk_bf16_f32 v75, v70, v71
  v_lshlrev_b32 v64, 16, v72
  v_and_b32 v65, 0xffff0000, v72
  v_lshlrev_b32 v66, 16, v73
  v_and_b32 v67, 0xffff0000, v73
  v_lshlrev_b32 v68, 16, v74
  v_and_b32 v69, 0xffff0000, v74
  v_lshlrev_b32 v70, 16, v75
  v_and_b32 v71, 0xffff0000, v75
  v_pk_add_f32 v[64:65], v[64:65], v[104:105]
  v_pk_add_f32 v[66:67], v[66:67], v[106:107]
  v_pk_add_f32 v[68:69], v[68:69], v[108:109]
  v_pk_add_f32 v[70:71], v[70:71], v[110:111]
  v_cvt_pk_bf16_f32 v72, v64, v65
  v_cvt_pk_bf16_f32 v73, v66, v67
  v_cvt_pk_bf16_f32 v74, v68, v69
  v_cvt_pk_bf16_f32 v75, v70, v71
  v_lshlrev_b32 v64, 16, v72
  v_and_b32 v65, 0xffff0000, v72
  v_lshlrev_b32 v66, 16, v73
  v_and_b32 v67, 0xffff0000, v73
  v_lshlrev_b32 v68, 16, v74
  v_and_b32 v69, 0xffff0000, v74
  v_lshlrev_b32 v70, 16, v75
  v_and_b32 v71, 0xffff0000, v75
  v_pk_add_f32 v[64:65], v[64:65], v[192:193]
  v_pk_add_f32 v[66:67], v[66:67], v[194:195]
  v_pk_add_f32 v[68:69], v[68:69], v[196:197]
  v_pk_add_f32 v[70:71], v[70:71], v[198:199]
  v_cvt_pk_bf16_f32 v76, v64, v65
  v_cvt_pk_bf16_f32 v77, v66, v67
  v_cvt_pk_bf16_f32 v78, v68, v69
  v_cvt_pk_bf16_f32 v79, v70, v71
  buffer_store_dwordx4 v[76:79], v249, s[48:51], 0 offen
  s_waitcnt lgkmcnt(0)
  v_pk_add_f32 v[128:129], v[128:129], v[136:137]
  v_pk_add_f32 v[144:145], v[144:145], v[152:153]
  v_pk_add_f32 v[130:131], v[130:131], v[138:139]
  v_pk_add_f32 v[146:147], v[146:147], v[154:155]
  v_pk_add_f32 v[132:133], v[132:133], v[140:141]
  v_pk_add_f32 v[148:149], v[148:149], v[156:157]
  v_pk_add_f32 v[134:135], v[134:135], v[142:143]
  v_pk_add_f32 v[150:151], v[150:151], v[158:159]
  v_pk_add_f32 v[128:129], v[128:129], v[144:145]
  v_pk_add_f32 v[130:131], v[130:131], v[146:147]
  v_pk_add_f32 v[132:133], v[132:133], v[148:149]
  v_pk_add_f32 v[134:135], v[134:135], v[150:151]
  v_pk_add_f32 v[128:129], v[128:129], v[184:185]
  v_pk_add_f32 v[130:131], v[130:131], v[186:187]
  v_pk_add_f32 v[132:133], v[132:133], v[188:189]
  v_pk_add_f32 v[134:135], v[134:135], v[190:191]
  v_cvt_pk_bf16_f32 v136, v128, v129
  v_cvt_pk_bf16_f32 v137, v130, v131
  v_cvt_pk_bf16_f32 v138, v132, v133
  v_cvt_pk_bf16_f32 v139, v134, v135
  v_lshlrev_b32 v128, 16, v136
  v_and_b32 v129, 0xffff0000, v136
  v_lshlrev_b32 v130, 16, v137
  v_and_b32 v131, 0xffff0000, v137
  v_lshlrev_b32 v132, 16, v138
  v_and_b32 v133, 0xffff0000, v138
  v_lshlrev_b32 v134, 16, v139
  v_and_b32 v135, 0xffff0000, v139
  v_pk_add_f32 v[128:129], v[128:129], v[112:113]
  v_pk_add_f32 v[130:131], v[130:131], v[114:115]
  v_pk_add_f32 v[132:133], v[132:133], v[116:117]
  v_pk_add_f32 v[134:135], v[134:135], v[118:119]
  v_cvt_pk_bf16_f32 v136, v128, v129
  v_cvt_pk_bf16_f32 v137, v130, v131
  v_cvt_pk_bf16_f32 v138, v132, v133
  v_cvt_pk_bf16_f32 v139, v134, v135
  v_lshlrev_b32 v128, 16, v136
  v_and_b32 v129, 0xffff0000, v136
  v_lshlrev_b32 v130, 16, v137
  v_and_b32 v131, 0xffff0000, v137
  v_lshlrev_b32 v132, 16, v138
  v_and_b32 v133, 0xffff0000, v138
  v_lshlrev_b32 v134, 16, v139
  v_and_b32 v135, 0xffff0000, v139
  v_pk_add_f32 v[128:129], v[128:129], v[208:209]
  v_pk_add_f32 v[130:131], v[130:131], v[210:211]
  v_pk_add_f32 v[132:133], v[132:133], v[212:213]
  v_pk_add_f32 v[134:135], v[134:135], v[214:215]
  v_cvt_pk_bf16_f32 v140, v128, v129
  v_cvt_pk_bf16_f32 v141, v130, v131
  v_cvt_pk_bf16_f32 v142, v132, v133
  v_cvt_pk_bf16_f32 v143, v134, v135
  buffer_store_dwordx4 v[140:143], v250, s[48:51], 0 offen
fa_end:
  s_endpgm
fa_hk0:
  s_getpc_b64 s[10:11]
fa_hp0:
  s_add_u32 s8, s8, 4
  s_addc_u32 s9, s9, 0
  s_sub_u32 s10, s10, fa_hp0-fa_hb0
  s_subb_u32 s11, s11, 0
  s_setpc_b64 s[8:9]
fa_hk1:
  s_getpc_b64 s[10:11]
fa_hp1:
  s_add_u32 s8, s8, 4
  s_addc_u32 s9, s9, 0
  s_sub_u32 s10, s10, fa_hp1-fa_hb1
  s_subb_u32 s11, s11, 0
  s_setpc_b64 s[8:9]
fa_hk2:
  s_getpc_b64 s[10:11]
fa_hp2:
  s_add_u32 s8, s8, 4
  s_addc_u32 s9, s9, 0
  s_sub_u32 s10, s10, fa_hp2-fa_hb2
  s_subb_u32 s11, s11, 0
  s_setpc_b64 s[8:9]
fa_hk3:
  s_getpc_b64 s[10:11]
fa_hp3:
  s_add_u32 s8, s8, 4
  s_addc_u32 s9, s9, 0
  s_sub_u32 s10, s10, fa_hp3-fa_hb3
  s_subb_u32 s11, s11, 0
  s_setpc_b64 s[8:9]
fa_ln_spin:
  s_mov_b32 s83, 200000
fa_ln_spin2:
  buffer_load_dword v15, v229, s[56:59], 0 offen sc1
  s_waitcnt vmcnt(0)
  v_cmp_ne_u32 vcc, 0x01010101, v15
  s_cbranch_vccz fa_ln_ok
  s_sleep 3
  s_sub_u32 s83, s83, 1
  s_cmp_lg_u32 s83, 0
  s_cbranch_scc1 fa_ln_spin2
  s_branch fa_ln_ok
fa_co1:
  buffer_load_dword v232, v234, s[32:35], s29 offen
  buffer_store_dword v229, v225, s[40:43], 0 offen sc1
  ds_read_b128 v[160:163], v221 offset:0
  ds_read_b128 v[164:167], v221 offset:4096
  ds_read_b128 v[168:171], v221 offset:8192
  buffer_store_dword v218, v222, s[40:43], 0 offen sc1
  s_waitcnt lgkmcnt(0)
  buffer_store_dwordx4 v[160:163], v223, s[40:43], s66 offen sc1
  buffer_store_dwordx4 v[164:167], v223, s[40:43], s67 offen sc1
  buffer_store_dwordx4 v[168:171], v224, s[40:43], s78 offen sc1
  s_getpc_b64 s[8:9]
  s_setpc_b64 s[10:11]
  v_mov_b32 v213, 1073741824
  v_mov_b32 v214, 1
  v_writelane_b32 v213, s77, 0
  v_lshlrev_b32 v229, 2, v1
  buffer_store_byte v214, v213, s[56:59], 0 offen sc1
  s_and_b32 s23, s21, 3
  s_cmp_eq_u32 s23, 3
  s_cbranch_scc1 fa_arr
  s_getpc_b64 s[8:9]
  s_setpc_b64 s[10:11]
fa_arr:
  s_mov_b32 s48, s60
  s_mov_b32 s49, s61
  s_mov_b32 s50, s75
  s_lshl_b32 s74, s22, 2
  s_add_u32 s74, s74, s20
  s_mul_i32 s74, s74, 40960
  s_mov_b32 s73, 1310720
  v_lshrrev_b32 v235, 1, v1
  v_min_u32 v235, 4, v235
  v_lshlrev_b32 v235, 13, v235
  v_and_b32 v213, 1, v1
  v_lshl_add_u32 v235, v213, 7, v235
  s_getpc_b64 s[8:9]
  s_setpc_b64 s[10:11]
  buffer_load_dword v15, v229, s[56:59], 0 offen sc1
  s_getpc_b64 s[8:9]
  s_setpc_b64 s[10:11]
  s_mov_b32 s36, s60
  s_mov_b32 s37, s61
  s_mov_b32 s38, s75
  s_lshr_b32 s27, s20, 1
  s_lshl_b32 s27, s27, 18
  s_mov_b32 s25, 524288
  s_mov_b32 s32, s18
  s_mov_b32 s33, s19
  s_mov_b32 s34, 2621440
  s_mov_b32 s26, 0
  s_movk_i32 s79, 1024
  s_lshl_b32 s23, s22, 2
  s_add_u32 s23, s23, s20
  s_mul_i32 s23, s23, 40960
  v_add_u32 v3, s23, v2
  s_sub_u32 s23, 15, s22
  s_lshl_b32 s23, s23, 2
  s_add_u32 s23, s23, s20
  s_mul_i32 s23, s23, 40960
  s_sub_u32 s23, s23, 2048
  v_add_u32 v5, s23, v2
  v_add_u32 v4, 19456, v3
  v_add_u32 v6, 19456, v5
  s_waitcnt vmcnt(8)
  v_cmp_ne_u32 vcc, 0x01010101, v15
  s_cbranch_vccnz fa_ln_spin
fa_ln_ok:
  s_setpc_b64 s[10:11]
fa_kv_spin:
  s_mov_b32 s83, 200000
fa_kv_spin2:
  buffer_load_dword v15, v8, s[40:43], 0 offen sc1
  s_waitcnt vmcnt(0)
  v_cmp_eq_u32 vcc, 0, v15
  s_cbranch_vccz fa_kv_ok
  s_sleep 3
  s_sub_u32 s83, s83, 1
  s_cmp_lg_u32 s83, 0
  s_cbranch_scc1 fa_kv_spin2
  s_branch fa_kv_ok
fa_top8:
  v_mov_b32 v21, 0
  v_mov_b32 v22, 0
  v_and_b32 v23, 7, v1
  s_mov_b32 s23, 0
fa_top:
  v_max3_u32 v20, v232, v233, v234
  v_max3_u32 v24, v235, v236, v237
  v_max3_u32 v20, v20, v238, v239
  v_max_u32 v20, v20, v24
  s_nop 1
  v_max_u32_dpp v20, v20, v20 quad_perm:[1,0,3,2] row_mask:0xf bank_mask:0xf
  s_nop 1
  v_max_u32_dpp v20, v20, v20 quad_perm:[2,3,0,1] row_mask:0xf bank_mask:0xf
  s_nop 1
  v_max_u32_dpp v20, v20, v20 row_half_mirror row_mask:0xf bank_mask:0xf
  s_nop 1
  v_max_u32_dpp v20, v20, v20 row_mirror row_mask:0xf bank_mask:0xf
  v_mov_b32 v24, v20
  s_nop 1
  v_permlane16_swap_b32 v20, v24
  v_max_u32 v20, v20, v24
  v_mov_b32 v24, v20
  s_nop 1
  v_permlane32_swap_b32 v20, v24
  v_max_u32 v20, v20, v24
  v_add_u32 v21, v21, v20
  v_cmp_eq_u32 vcc, s23, v23
  v_sub_u32 v232, v232, v20
  v_sub_u32 v233, v233, v20
  v_sub_u32 v234, v234, v20
  v_sub_u32 v235, v235, v20
  v_sub_u32 v236, v236, v20
  v_sub_u32 v237, v237, v20
  v_sub_u32 v238, v238, v20
  v_sub_u32 v239, v239, v20
  v_cndmask_b32 v22, v22, v21, vcc
  s_add_u32 s23, s23, 1
  s_cmp_lt_u32 s23, 8
  s_cbranch_scc1 fa_top
  s_lshl_b32 s23, s20, 5
  s_add_u32 s23, s23, 131072
  v_lshl_add_u32 v24, v23, 2, s23
  ds_write_b32 v24, v22
  s_waitcnt lgkmcnt(0)
  s_barrier
  s_cmp_lg_u32 s20, 0
  s_cbranch_scc1 fa_notop
  v_and_b32 v24, 31, v1
  v_lshlrev_b32 v24, 2, v24
  v_add_u32 v24, 131072, v24
  v_mov_b32 v20, 131072
  ds_read_b32 v22, v24
  ds_read_b128 v[96:99], v20 offset:0
  ds_read_b128 v[100:103], v20 offset:16
  ds_read_b128 v[104:107], v20 offset:32
  ds_read_b128 v[108:111], v20 offset:48
  ds_read_b128 v[112:115], v20 offset:64
  ds_read_b128 v[116:119], v20 offset:80
  ds_read_b128 v[120:123], v20 offset:96
  ds_read_b128 v[124:127], v20 offset:112
  v_mov_b32 v23, 0
  s_waitcnt lgkmcnt(0)
  v_cmp_gt_u32 s[4:5], v96, v22
  v_cmp_gt_u32 s[6:7], v97, v22
  v_cmp_gt_u32 s[76:77], v98, v22
  v_cmp_gt_u32 s[78:79], v99, v22
  v_addc_co_u32 v23, vcc, 0, v23, s[4:5]
  v_addc_co_u32 v23, vcc, 0, v23, s[6:7]
  v_addc_co_u32 v23, vcc, 0, v23, s[76:77]
  v_addc_co_u32 v23, vcc, 0, v23, s[78:79]
  v_cmp_gt_u32 s[4:5], v100, v22
  v_cmp_gt_u32 s[6:7], v101, v22
  v_cmp_gt_u32 s[76:77], v102, v22
  v_cmp_gt_u32 s[78:79], v103, v22
  v_addc_co_u32 v23, vcc, 0, v23, s[4:5]
  v_addc_co_u32 v23, vcc, 0, v23, s[6:7]
  v_addc_co_u32 v23, vcc, 0, v23, s[76:77]
  v_addc_co_u32 v23, vcc, 0, v23, s[78:79]
  v_cmp_gt_u32 s[4:5], v104, v22
  v_cmp_gt_u32 s[6:7], v105, v22
  v_cmp_gt_u32 s[76:77], v106, v22
  v_cmp_gt_u32 s[78:79], v107, v22
  v_addc_co_u32 v23, vcc, 0, v23, s[4:5]
  v_addc_co_u32 v23, vcc, 0, v23, s[6:7]
  v_addc_co_u32 v23, vcc, 0, v23, s[76:77]
  v_addc_co_u32 v23, vcc, 0, v23, s[78:79]
  v_cmp_gt_u32 s[4:5], v108, v22
  v_cmp_gt_u32 s[6:7], v109, v22
  v_cmp_gt_u32 s[76:77], v110, v22
  v_cmp_gt_u32 s[78:79], v111, v22
  v_addc_co_u32 v23, vcc, 0, v23, s[4:5]
  v_addc_co_u32 v23, vcc, 0, v23, s[6:7]
  v_addc_co_u32 v23, vcc, 0, v23, s[76:77]
  v_addc_co_u32 v23, vcc, 0, v23, s[78:79]
  v_cmp_gt_u32 s[4:5], v112, v22
  v_cmp_gt_u32 s[6:7], v113, v22
  v_cmp_gt_u32 s[76:77], v114, v22
  v_cmp_gt_u32 s[78:79], v115, v22
  v_addc_co_u32 v23, vcc, 0, v23, s[4:5]
  v_addc_co_u32 v23, vcc, 0, v23, s[6:7]
  v_addc_co_u32 v23, vcc, 0, v23, s[76:77]
  v_addc_co_u32 v23, vcc, 0, v23, s[78:79]
  v_cmp_gt_u32 s[4:5], v116, v22
  v_cmp_gt_u32 s[6:7], v117, v22
  v_cmp_gt_u32 s[76:77], v118, v22
  v_cmp_gt_u32 s[78:79], v119, v22
  v_addc_co_u32 v23, vcc, 0, v23, s[4:5]
  v_addc_co_u32 v23, vcc, 0, v23, s[6:7]
  v_addc_co_u32 v23, vcc, 0, v23, s[76:77]
  v_addc_co_u32 v23, vcc, 0, v23, s[78:79]
  v_cmp_gt_u32 s[4:5], v120, v22
  v_cmp_gt_u32 s[6:7], v121, v22
  v_cmp_gt_u32 s[76:77], v122, v22
  v_cmp_gt_u32 s[78:79], v123, v22
  v_addc_co_u32 v23, vcc, 0, v23, s[4:5]
  v_addc_co_u32 v23, vcc, 0, v23, s[6:7]
  v_addc_co_u32 v23, vcc, 0, v23, s[76:77]
  v_addc_co_u32 v23, vcc, 0, v23, s[78:79]
  v_cmp_gt_u32 s[4:5], v124, v22
  v_cmp_gt_u32 s[6:7], v125, v22
  v_cmp_gt_u32 s[76:77], v126, v22
  v_cmp_gt_u32 s[78:79], v127, v22
  v_addc_co_u32 v23, vcc, 0, v23, s[4:5]
  v_addc_co_u32 v23, vcc, 0, v23, s[6:7]
  v_addc_co_u32 v23, vcc, 0, v23, s[76:77]
  v_addc_co_u32 v23, vcc, 0, v23, s[78:79]
  v_and_b32 v25, 0xffff, v22
  v_sub_u32 v25, 0xffff, v25
  v_and_b32 v25, 2047, v25
  v_ashrrev_i32 v20, 31, v22
  v_not_b32 v20, v20
  v_or_b32 v20, 0x80000000, v20
  v_xor_b32 v26, v22, v20
  v_and_b32 v26, 0xffff0000, v26
  v_mul_f32 v26, 0xbfb8aa3b, v26
  v_exp_f32 v26, v26
  s_nop 0
  v_add_f32 v26, 1.0, v26
  v_rcp_f32 v26, v26
  s_nop 0
  v_cvt_pk_bf16_f32 v26, v26, v26
  v_and_b32 v26, 0xffff0000, v26
  v_and_b32 v20, 32, v1
  v_lshl_add_u32 v20, v23, 2, v20
  v_add_u32 v20, 2629632, v20
  v_mov_b32 v21, 1073741824
  v_cmp_gt_u32 vcc, 8, v23
  v_add_u32 v25, 1, v25
  v_or_b32 v26, 1, v26
  v_cndmask_b32 v20, v21, v20, vcc
  v_cmp_gt_u32 vcc, 32, v1
  s_nop 1
  v_cndmask_b32 v26, v26, v25, vcc
  buffer_store_dword v26, v20, s[40:43], 0 offen sc1
  s_branch fa_notop
fa_hk4:
  s_getpc_b64 s[38:39]
fa_hp4:
  s_add_u32 s36, s36, 4
  s_addc_u32 s37, s37, 0
  s_sub_u32 s38, s38, fa_hp4-fa_hb4
  s_subb_u32 s39, s39, 0
  s_setpc_b64 s[36:37]
fa_hk5:
  s_getpc_b64 s[38:39]
fa_hp5:
  s_add_u32 s36, s36, 4
  s_addc_u32 s37, s37, 0
  s_sub_u32 s38, s38, fa_hp5-fa_hb5
  s_subb_u32 s39, s39, 0
  s_setpc_b64 s[36:37]
fa_hk6:
  s_getpc_b64 s[38:39]
fa_hp6:
  s_add_u32 s36, s36, 4
  s_addc_u32 s37, s37, 0
  s_add_u32 s38, s38, fa_hb6-fa_hp6
  s_addc_u32 s39, s39, 0
  s_setpc_b64 s[36:37]
fa_DDF:
  v_mfma_f32_16x16x32_bf16 v[96:99], a[128:131], v[32:35], v[192:195]
  s_waitcnt vmcnt(4)
  v_exp_f32 v218, v146
  v_mfma_f32_16x16x32_bf16 v[104:107], a[128:131], v[36:39], v[196:199]
  s_barrier
  v_exp_f32 v219, v147
  v_mfma_f32_16x16x32_bf16 v[128:131], a[128:131], v[64:67], v[200:203]
  s_cmp_ge_u32 s26, s32
  ds_read_b128 a[160:163], v3 offset:16384
  v_exp_f32 v220, v148
  v_mfma_f32_16x16x32_bf16 v[136:139], a[128:131], v[68:71], v[204:207]
  s_cbranch_scc1 fa_hk6
fa_hb6:
  ds_read_b64_tr_b16 a[192:193], v9 offset:0
  v_add_f32 v226, v216, v217
  v_mfma_f32_16x16x32_bf16 v[100:103], a[132:135], v[32:35], v[192:195]
  ds_read_b128 a[164:167], v3 offset:17408
  ds_read_b64_tr_b16 a[194:195], v9 offset:128
  v_cvt_pk_bf16_f32 v184, v216, v217
  v_mfma_f32_16x16x32_bf16 v[108:111], a[132:135], v[36:39], v[196:199]
  s_mov_b32 m0, s24
  ds_read_b128 a[212:215], v10 offset:0
  ds_read_b64_tr_b16 a[196:197], v9 offset:1024
  v_add_f32 v226, v226, v218
  v_mfma_f32_16x16x32_bf16 v[132:135], a[132:135], v[64:67], v[200:203]
  buffer_load_dwordx4 v2, s[44:47], s26 offen offset:0 sc1 lds
  v_add_f32 v226, v226, v219
  v_mfma_f32_16x16x32_bf16 v[140:143], a[132:135], v[68:71], v[204:207]
  ds_read_b64_tr_b16 a[198:199], v9 offset:1152
  ds_read_b128 a[216:219], v10 offset:512
  v_cvt_pk_bf16_f32 v185, v218, v219
  v_mfma_f32_16x16x32_bf16 v[96:99], a[136:139], v[40:43], v[96:99]
  ds_read_b128 a[168:171], v3 offset:18432
  ds_read_b64_tr_b16 a[200:201], v9 offset:2048
  v_add_f32 v226, v226, v220
  v_exp_f32 v221, v149
  v_mfma_f32_16x16x32_bf16 v[104:107], a[136:139], v[44:47], v[104:107]
  ds_read_b64_tr_b16 a[202:203], v9 offset:2176
  ds_read_b128 a[220:223], v10 offset:1024
  v_add_f32 v226, v226, v221
  v_mfma_f32_16x16x32_bf16 v[128:131], a[136:139], v[72:75], v[128:131]
  ds_read_b64_tr_b16 a[204:205], v9 offset:3072
  ds_read_b64_tr_b16 a[206:207], v9 offset:3200
  v_cvt_pk_bf16_f32 v186, v220, v221
  v_mfma_f32_16x16x32_bf16 v[136:139], a[136:139], v[76:79], v[136:139]
  ds_read_b128 a[224:227], v10 offset:1536
  ds_read_b64_tr_b16 a[208:209], v9 offset:4096
  v_mfma_f32_16x16x32_bf16 v[100:103], a[140:143], v[40:43], v[100:103]
  ds_read_b128 a[172:175], v3 offset:19456
  v_mfma_f32_16x16x32_bf16 v[108:111], a[140:143], v[44:47], v[108:111]
  buffer_load_dwordx4 v2, s[44:47], s26 offen offset:1024 sc1 lds
  v_mfma_f32_16x16x32_bf16 v[132:135], a[140:143], v[72:75], v[132:135]
  ds_read_b64_tr_b16 a[210:211], v9 offset:4224
  ds_read_b128 a[228:231], v10 offset:2048
  v_mfma_f32_16x16x32_bf16 v[140:143], a[140:143], v[76:79], v[140:143]
  s_waitcnt lgkmcnt(4)
  v_exp_f32 v222, v150
  v_mfma_f32_16x16x32_bf16 v[96:99], a[144:147], v[48:51], v[96:99]
  ds_read_b128 a[176:179], v3 offset:20480
  v_add_f32 v226, v226, v222
  v_mfma_f32_16x16x32_bf16 v[104:107], a[144:147], v[52:55], v[104:107]
  v_exp_f32 v223, v151
  v_mfma_f32_16x16x32_bf16 v[128:131], a[144:147], v[80:83], v[128:131]
  v_exp_f32 v216, v152
  v_add_u32 v10, 2560, v10
  v_mfma_f32_16x16x32_bf16 v[136:139], a[144:147], v[84:87], v[136:139]
  buffer_load_dwordx4 v2, s[44:47], s26 offen offset:2048 sc1 lds
  v_add_f32 v226, v226, v223
  v_mfma_f32_16x16x32_bf16 v[100:103], a[148:151], v[48:51], v[100:103]
  ds_read_b128 a[180:183], v3 offset:21504
  v_cvt_pk_bf16_f32 v187, v222, v223
  v_and_b32 v232, s4, v232
  v_mfma_f32_16x16x32_bf16 v[108:111], a[148:151], v[52:55], v[108:111]
  v_exp_f32 v217, v153
  v_and_b32 v233, s4, v233
  v_mfma_f32_16x16x32_bf16 v[132:135], a[148:151], v[80:83], v[132:135]
  v_exp_f32 v218, v154
  v_and_b32 v234, s4, v234
  v_mfma_f32_16x16x32_bf16 v[140:143], a[148:151], v[84:87], v[140:143]
  v_exp_f32 v219, v155
  v_and_b32 v235, s4, v235
  v_mfma_f32_16x16x32_bf16 v[96:99], a[152:155], v[56:59], v[96:99]
  ds_read_b128 a[184:187], v3 offset:22528
  v_add_f32 v227, v216, v217
  v_cvt_pk_bf16_f32 v188, v216, v217
  v_add_f32 v227, v227, v218
  v_add_f32 v227, v227, v219
  v_mfma_f32_16x16x32_bf16 v[104:107], a[152:155], v[60:63], v[104:107]
  buffer_load_dwordx4 v2, s[44:47], s26 offen offset:3072 sc1 lds
  v_cvt_pk_bf16_f32 v189, v218, v219
  v_mfma_f32_16x16x32_bf16 v[128:131], a[152:155], v[88:91], v[128:131]
  s_add_u32 s26, s26, 16384
  v_exp_f32 v220, v156
  v_mfma_f32_16x16x32_bf16 v[136:139], a[152:155], v[92:95], v[136:139]
  s_add_u32 s24, s24, 32768
  v_exp_f32 v221, v157
  v_mfma_f32_16x16x32_bf16 v[100:103], a[156:159], v[56:59], v[100:103]
  s_and_b32 s24, s24, 0x1ffff
  ds_read_b128 a[188:191], v3 offset:23552
  v_add_f32 v227, v227, v220
  v_add_f32 v227, v227, v221
  v_mfma_f32_16x16x32_bf16 v[108:111], a[156:159], v[60:63], v[108:111]
  v_exp_f32 v222, v158
  v_mfma_f32_16x16x32_bf16 v[132:135], a[156:159], v[88:91], v[132:135]
  s_add_u32 m0, s34, 0
  v_exp_f32 v223, v159
  v_mfma_f32_16x16x32_bf16 v[140:143], a[156:159], v[92:95], v[140:143]
  s_waitcnt lgkmcnt(4)
  buffer_load_dwordx4 v8, s[52:55], s33 offen offset:0 lds
  v_cvt_pk_bf16_f32 v190, v220, v221
  v_add_f32 v227, v227, v222
  v_add_f32 v227, v227, v223
  v_mfma_f32_16x16x32_bf16 a[0:3], a[160:163], v[160:163], a[0:3]
  ds_read_b128 a[128:131], v3 offset:0
  v_cvt_pk_bf16_f32 v191, v222, v223
  v_mfma_f32_16x16x32_bf16 a[4:7], a[160:163], v[164:167], a[4:7]
  s_mov_b32 s4, s5
  v_exp_f32 v208, v112
  v_mfma_f32_16x16x32_bf16 a[64:67], a[160:163], v[176:179], a[64:67]
  s_mov_b32 s5, -1
  v_exp_f32 v209, v113
  v_mfma_f32_16x16x32_bf16 v[232:235], a[192:195], a[212:215], v[232:235]
  v_mfma_f32_16x16x32_bf16 a[68:71], a[160:163], v[180:183], a[68:71]
  v_exp_f32 v210, v114
  v_mfma_f32_16x16x32_bf16 a[8:11], a[164:167], v[160:163], a[8:11]
  ds_read_b128 a[132:135], v3 offset:1024
  v_add_f32 v224, v208, v209
  v_cvt_pk_bf16_f32 v168, v208, v209
  v_mfma_f32_16x16x32_bf16 a[12:15], a[164:167], v[164:167], a[12:15]
  buffer_load_dwordx4 v11, s[52:55], s33 offen offset:1024 lds
  v_add_f32 v224, v224, v210
  v_mfma_f32_16x16x32_bf16 a[72:75], a[164:167], v[176:179], a[72:75]
  v_exp_f32 v211, v115
  v_mfma_f32_16x16x32_bf16 a[76:79], a[164:167], v[180:183], a[76:79]
  v_exp_f32 v212, v116
  v_mfma_f32_16x16x32_bf16 v[232:235], a[196:199], a[216:219], v[232:235]
  v_mfma_f32_16x16x32_bf16 a[16:19], a[168:171], v[160:163], a[16:19]
  ds_read_b128 a[136:139], v3 offset:2048
  v_add_f32 v224, v224, v211
  v_cvt_pk_bf16_f32 v169, v210, v211
  v_mfma_f32_16x16x32_bf16 a[20:23], a[168:171], v[164:167], a[20:23]
  v_exp_f32 v213, v117
  v_mfma_f32_16x16x32_bf16 a[80:83], a[168:171], v[176:179], a[80:83]
  v_exp_f32 v214, v118
  v_mfma_f32_16x16x32_bf16 a[84:87], a[168:171], v[180:183], a[84:87]
  buffer_load_dwordx4 v12, s[52:55], s33 offen offset:2048 lds
  v_add_f32 v224, v224, v212
  v_add_f32 v224, v224, v213
  v_cvt_pk_bf16_f32 v170, v212, v213
  v_mfma_f32_16x16x32_bf16 a[24:27], a[172:175], v[160:163], a[24:27]
  ds_read_b128 a[140:143], v3 offset:3072
  v_add_f32 v224, v224, v214
  v_mfma_f32_16x16x32_bf16 v[232:235], a[200:203], a[220:223], v[232:235]
  v_mfma_f32_16x16x32_bf16 a[28:31], a[172:175], v[164:167], a[28:31]
  v_exp_f32 v215, v119
  v_mfma_f32_16x16x32_bf16 a[88:91], a[172:175], v[176:179], a[88:91]
  v_exp_f32 v208, v120
  v_mfma_f32_16x16x32_bf16 a[92:95], a[172:175], v[180:183], a[92:95]
  s_waitcnt lgkmcnt(4)
  v_exp_f32 v209, v121
  v_mfma_f32_16x16x32_bf16 a[32:35], a[176:179], v[160:163], a[32:35]
  ds_read_b128 a[144:147], v3 offset:4096
  v_add_f32 v224, v224, v215
  v_cvt_pk_bf16_f32 v171, v214, v215
  v_add_f32 v225, v208, v209
  v_mfma_f32_16x16x32_bf16 a[36:39], a[176:179], v[164:167], a[36:39]
  buffer_load_dwordx4 v13, s[52:55], s33 offen offset:3072 lds
  v_cvt_pk_bf16_f32 v172, v208, v209
  v_mfma_f32_16x16x32_bf16 v[232:235], a[204:207], a[224:227], v[232:235]
  v_mfma_f32_16x16x32_bf16 a[96:99], a[176:179], v[176:179], a[96:99]
  v_exp_f32 v210, v122
  v_mfma_f32_16x16x32_bf16 a[100:103], a[176:179], v[180:183], a[100:103]
  v_exp_f32 v211, v123
  v_mfma_f32_16x16x32_bf16 a[40:43], a[180:183], v[160:163], a[40:43]
  ds_read_b128 a[148:151], v3 offset:5120
  v_add_f32 v225, v225, v210
  v_add_f32 v225, v225, v211
  v_mfma_f32_16x16x32_bf16 a[44:47], a[180:183], v[164:167], a[44:47]
  v_exp_f32 v212, v124
  v_mfma_f32_16x16x32_bf16 a[104:107], a[180:183], v[176:179], a[104:107]
  s_add_u32 m0, s34, 4096
  v_exp_f32 v213, v125
  v_mfma_f32_16x16x32_bf16 v[232:235], a[208:211], a[228:231], v[232:235]
  v_mfma_f32_16x16x32_bf16 a[108:111], a[180:183], v[180:183], a[108:111]
  buffer_load_dwordx4 v14, s[52:55], s33 offen offset:0 lds
  v_cvt_pk_bf16_f32 v173, v210, v211
  v_max3_f32 v5, v226, v227, v224
  v_mfma_f32_16x16x32_bf16 a[48:51], a[184:187], v[160:163], a[48:51]
  ds_read_b128 a[152:155], v3 offset:6144
  v_add_f32 v225, v225, v212
  v_mfma_f32_16x16x32_bf16 a[52:55], a[184:187], v[164:167], a[52:55]
  s_add_u32 s33, s33, s6
  v_exp_f32 v214, v126
  v_mfma_f32_16x16x32_bf16 a[112:115], a[184:187], v[176:179], a[112:115]
  v_exp_f32 v215, v127
  v_mfma_f32_16x16x32_bf16 a[116:119], a[184:187], v[180:183], a[116:119]
  v_add_f32 v225, v225, v213
  v_cvt_pk_bf16_f32 v174, v212, v213
  v_add_f32 v225, v225, v214
  v_mfma_f32_16x16x32_bf16 a[56:59], a[188:191], v[160:163], a[56:59]
  ds_read_b128 a[156:159], v3 offset:7168
  v_add_f32 v225, v225, v215
  v_max_f32 v5, v5, v225
  v_cmp_lt_f32 vcc, s81, v5
  v_mfma_f32_16x16x32_bf16 a[60:63], a[188:191], v[164:167], a[60:63]
  v_exp_f32 v216, v128
  v_mfma_f32_16x16x32_bf16 a[120:123], a[188:191], v[176:179], a[120:123]
  s_waitcnt lgkmcnt(4)
  v_cvt_pk_bf16_f32 v175, v214, v215
  v_mfma_f32_16x16x32_bf16 a[124:127], a[188:191], v[180:183], a[124:127]
  s_cbranch_vccnz fa_stub3
fa_back3:
  v_exp_f32 v217, v129
  v_add_f32 v228, v228, v224
  v_add_f32 v229, v229, v225
  v_add_f32 v230, v230, v226
  v_add_f32 v231, v231, v227
  s_branch fa_DDe
fa_kv2_spin:
  s_mov_b32 s83, 200000
fa_kv2_spin2:
  buffer_load_dword v14, v13, s[40:43], 0 offen sc1
  s_waitcnt vmcnt(0)
  v_cmp_eq_u32 vcc, 0, v14
  s_cbranch_vccz fa_kv2_ok
  s_sleep 3
  s_sub_u32 s83, s83, 1
  s_cmp_lg_u32 s83, 0
  s_cbranch_scc1 fa_kv2_spin2
  s_branch fa_kv2_ok
fa_kv3_spin:
  s_mov_b32 s83, 200000
fa_kv3_spin2:
  buffer_load_dword v14, v13, s[40:43], 0 offen sc1
  s_waitcnt vmcnt(0)
  v_cmp_eq_u32 vcc, 0, v14
  s_cbranch_vccz fa_kv3_ok
  s_sleep 3
  s_sub_u32 s83, s83, 1
  s_cmp_lg_u32 s83, 0
  s_cbranch_scc1 fa_kv3_spin2
  s_branch fa_kv3_ok
fa_sel_spin:
  s_mov_b32 s83, 200000
fa_sel_spin2:
  buffer_load_dword v15, v252, s[40:43], 0 offen sc1
  s_waitcnt vmcnt(0)
  v_cmp_eq_u32 vcc, 0, v15
  s_cbranch_vccz fa_sel_ok
  s_sleep 3
  s_sub_u32 s83, s83, 1
  s_cmp_lg_u32 s83, 0
  s_cbranch_scc1 fa_sel_spin2
  s_branch fa_sel_ok
fa_wof_spin:
  s_mov_b32 s83, 200000
fa_wof_spin2:
  buffer_load_dword v8, v9, s[40:43], 0 offen sc1
  s_waitcnt vmcnt(0)
  v_cmp_eq_u32 vcc, 0, v8
  s_cbranch_vccz fa_wof_ok
  s_sleep 3
  s_sub_u32 s83, s83, 1
  s_cmp_lg_u32 s83, 0
  s_cbranch_scc1 fa_wof_spin2
  s_branch fa_wof_ok
fa_sel4_spin:
  s_mov_b32 s83, 200000
fa_sel4_spin2:
  buffer_load_dword v15, v10, s[40:43], 0 offen sc1
  s_waitcnt vmcnt(0)
  v_cmp_eq_u32 vcc, 0, v15
  s_cbranch_vccz fa_sel4_ok
  s_sleep 3
  s_sub_u32 s83, s83, 1
  s_cmp_lg_u32 s83, 0
  s_cbranch_scc1 fa_sel4_spin2
  s_branch fa_sel4_ok
fa_yf_spin:
  s_mov_b32 s83, 200000
fa_yf_spin2:
  buffer_load_dword v14, v11, s[40:43], 0 offen sc1
  s_waitcnt vmcnt(0)
  v_cmp_eq_u32 vcc, 0, v14
  s_cbranch_vccz fa_yf_ok
  s_sleep 3
  s_sub_u32 s83, s83, 1
  s_cmp_lg_u32 s83, 0
  s_cbranch_scc1 fa_yf_spin2
  s_branch fa_yf_ok
fa_co:
  s_sub_u32 s14, s2, 64
  s_cmp_lt_u32 s14, 96
  s_cbranch_scc1 fa_coT
  s_sub_u32 s14, s2, 128
  s_sub_u32 s23, s2, 224
  s_cmp_lt_u32 s23, 31
  s_cbranch_scc1 fa_coT
  v_cmp_eq_u32 vcc, 0, v14
  s_cbranch_vccnz fa_kv2_spin
fa_kv2_ok:
  s_sub_u32 s14, s2, 170
  s_cmp_lt_u32 s14, 54
  s_cbranch_scc1 fa_coF
  s_cmp_eq_u32 s2, 255
  s_cbranch_scc1 fa_coW
  s_cmp_lt_u32 s2, 32
  s_cbranch_scc1 fa_coW
  s_branch fa_coO
fa_coT:
  v_min_u32 v8, 16, v1
  v_lshlrev_b32 v8, 7, v8
  s_lshl_b32 s10, s14, 1
  s_and_b32 s31, s20, 1
  s_add_u32 s10, s10, s31
  s_mul_i32 s10, s10, 2176
  s_lshl_b32 s35, s14, 2
  s_add_u32 s35, s35, s20
  s_mul_i32 s35, s35, 4352
  buffer_load_dword v255, v8, s[52:55], s10 offen
  s_add_u32 s10, s10, 552960
  s_getpc_b64 s[36:37]
  s_setpc_b64 s[38:39]
  buffer_load_dword v255, v8, s[52:55], s10 offen
  s_add_u32 s10, s10, 552960
  s_getpc_b64 s[36:37]
  s_setpc_b64 s[38:39]
  v_cmp_eq_u32 vcc, 0, v14
  s_cbranch_vccnz fa_kv3_spin
fa_kv3_ok:
  buffer_load_dword v255, v8, s[52:55], s10 offen
  s_add_u32 s10, s10, 552960
  buffer_load_dword v255, v8, s[60:63], s35 offen offset:0
  s_getpc_b64 s[36:37]
  s_setpc_b64 s[38:39]
  buffer_load_dword v255, v8, s[52:55], s10 offen
  s_add_u32 s10, s10, 552960
  buffer_load_dword v255, v8, s[60:63], s35 offen offset:2176
  s_mov_b32 s9, -1
  s_and_b32 s32, s21, 3
  s_lshr_b32 s32, s32, 1
  s_add_u32 s32, s32, 6
  s_lshl_b32 s32, s32, 14
  s_getpc_b64 s[36:37]
  s_setpc_b64 s[38:39]
fa_coO:
  s_and_b32 s23, s67, 1
  s_lshl_b32 s23, s23, 2
  s_add_u32 s23, s23, s20
  s_lshr_b32 s31, s67, 1
  s_mul_i32 s33, s23, 0
  s_add_u32 s33, s33, s31
  s_and_b32 s33, s33, 31
  s_andn2_b32 s30, s31, 31
  s_add_u32 s33, s33, s30
  s_lshl_b32 s30, s23, 7
  s_add_u32 s30, s30, s33
  s_mul_i32 s33, s31, 40960
  s_mul_i32 s23, s23, 160
  s_add_u32 s33, s33, s23
  s_add_u32 m0, s34, 0
  v_accvgpr_read_b32 v19, a248
  buffer_load_dwordx4 v19, s[56:59], s33 offen lds
  s_add_u32 m0, s34, 1024
  v_accvgpr_read_b32 v19, a249
  buffer_load_dwordx4 v19, s[56:59], s33 offen lds
  s_add_u32 m0, s34, 2048
  v_accvgpr_read_b32 v19, a250
  buffer_load_dwordx4 v19, s[56:59], s33 offen lds
  s_add_u32 m0, s34, 3072
  v_accvgpr_read_b32 v19, a251
  buffer_load_dwordx4 v19, s[56:59], s33 offen lds
  s_add_u32 m0, s34, 4096
  v_accvgpr_read_b32 v19, a252
  buffer_load_dwordx4 v19, s[56:59], s33 offen lds
  s_lshl_b32 s32, s11, 15
  s_add_u32 s32, s32, s26
  s_mov_b32 s9, -1
  s_lshl_b32 s10, s30, 7
  s_mul_i32 s30, s30, 5120
  s_add_u32 s30, s30, 4194304
  s_getpc_b64 s[36:37]
  s_setpc_b64 s[38:39]
  s_waitcnt vmcnt(8)
  ds_read_b64_tr_b16 v[232:233], v6 offset:0
  ds_read_b64_tr_b16 v[234:235], v6 offset:2560
  ds_read_b64_tr_b16 v[236:237], v6 offset:32
  ds_read_b64_tr_b16 v[238:239], v6 offset:2592
  ds_read_b64_tr_b16 v[240:241], v6 offset:64
  ds_read_b64_tr_b16 v[242:243], v6 offset:2624
  ds_read_b64_tr_b16 v[244:245], v6 offset:96
  ds_read_b64_tr_b16 v[246:247], v6 offset:2656
  ds_read_b64_tr_b16 v[248:249], v6 offset:128
  ds_read_b64_tr_b16 v[250:251], v6 offset:2688
  s_waitcnt lgkmcnt(0)
  s_add_u32 s31, s30, 4096
  buffer_store_dwordx4 v[232:235], v2, s[40:43], s30 offen offset:0 sc1
  buffer_store_dwordx4 v[236:239], v2, s[40:43], s30 offen offset:1024 sc1
  buffer_store_dwordx4 v[240:243], v2, s[40:43], s30 offen offset:2048 sc1
  buffer_store_dwordx4 v[244:247], v2, s[40:43], s30 offen offset:3072 sc1
  buffer_store_dwordx4 v[248:251], v2, s[40:43], s31 offen offset:0 sc1
  s_getpc_b64 s[36:37]
  s_setpc_b64 s[38:39]
  s_add_u32 s23, s10, 67371008
  s_waitcnt vmcnt(8)
  buffer_store_dword v4, off, s[40:43], s23 sc1
  s_cmp_lg_u32 s67, s2
  s_cbranch_scc1 fa_coW
  s_sub_u32 s67, s2, 128
  s_cmp_lt_u32 s67, 32
  s_cbranch_scc1 fa_coO
  s_sub_u32 s23, s2, 96
  s_sub_u32 s31, s2, 192
  s_cmp_lt_u32 s23, 32
  s_cselect_b32 s23, s23, s31
  s_cmp_gt_u32 s23, 54
  s_cbranch_scc1 fa_coW
  s_add_u32 s67, s23, 170
  s_cmp_eq_u32 s67, 224
  s_cselect_b32 s67, 255, s67
  s_branch fa_coO
fa_coF:
  v_and_b32 v16, 7, v1
  v_lshlrev_b32 v252, 2, v16
  v_add_u32 v252, 2629632, v252
  buffer_load_dword v15, v252, s[40:43], 0 offen sc1
  s_lshl_b32 s33, s14, 6
  s_and_b32 s31, s20, 1
  s_lshl_b32 s31, s31, 5
  s_add_u32 s33, s33, s31
  s_mul_i32 s35, s14, 40960
  s_mul_i32 s31, s20, 320
  s_add_u32 s35, s35, s31
  s_mul_i32 s10, s14, 20480
  s_mul_i32 s31, s20, 5120
  s_add_u32 s10, s10, s31
  s_add_u32 s10, s10, 2686976
  v_lshrrev_b32 v17, 1, v1
  v_mul_u32_u24 v8, 3456, v17
  v_and_b32 v17, 1, v1
  v_lshl_add_u32 v8, v17, 4, v8
  v_add_u32 v11, 109568, v8
  v_add_u32 v12, 219136, v8
  v_add_u32 v13, 328704, v8
  v_add_u32 v14, 442368, v8
  v_lshrrev_b32 v17, 4, v1
  v_lshrrev_b32 v18, 2, v1
  v_lshl_add_u32 v18, v17, 2, v18
  v_lshlrev_b32 v18, 5, v18
  v_and_b32 v19, 3, v1
  v_lshl_add_u32 v9, v19, 3, v18
  v_add_u32 v9, s34, v9
  v_lshlrev_b32 v10, 4, v16
  v_lshl_add_u32 v10, v17, 7, v10
  v_add_u32 v10, 148992, v10
  s_mov_b32 s8, -1
  s_mov_b32 s4, 0
  s_mov_b32 s5, 0
  s_mov_b32 s6, 552960
  s_getpc_b64 s[36:37]
  s_setpc_b64 s[38:39]
  s_waitcnt vmcnt(8)
  v_cmp_eq_u32 vcc, 0, v15
  s_cbranch_vccnz fa_sel_spin
fa_sel_ok:
  v_add_u32 v18, -1, v15
  v_and_b32 v18, 2047, v18
  v_lshrrev_b32 v19, 4, v18
  v_mul_u32_u24 v19, 20480, v19
  v_and_b32 v18, 15, v18
  v_lshl_add_u32 v19, v18, 4, v19
  v_lshrrev_b32 v18, 3, v1
  v_lshl_add_u32 v19, v18, 8, v19
  s_lshl_b32 s23, s20, 11
  s_lshl_b32 s31, s20, 10
  s_add_u32 s31, s31, 151552
  s_mov_b32 s32, 163840
  s_mov_b32 m0, s31
  s_add_u32 s31, s31, 4096
  buffer_load_dwordx4 v19, s[40:43], s23 offen sc1 lds
  s_add_u32 s23, s23, 8192
  s_mov_b32 m0, s31
  s_add_u32 s31, s31, 4096
  buffer_load_dwordx4 v19, s[40:43], s23 offen sc1 lds
  s_add_u32 s23, s23, 8192
  s_mov_b32 m0, s31
  s_add_u32 s31, s31, 4096
  buffer_load_dwordx4 v19, s[40:43], s23 offen sc1 lds
  s_add_u32 s23, s23, 8192
  s_getpc_b64 s[36:37]
  s_setpc_b64 s[38:39]
  v_accvgpr_read_b32 v8, a248
  v_accvgpr_read_b32 v11, a249
  v_accvgpr_read_b32 v12, a250
  v_accvgpr_read_b32 v13, a251
  v_accvgpr_read_b32 v14, a252
  v_subrev_u32 v11, 1024, v11
  v_subrev_u32 v12, 2048, v12
  v_subrev_u32 v13, 3072, v13
  s_mov_b32 s52, s60
  s_mov_b32 s53, s61
  s_mov_b32 s33, s35
  s_movk_i32 s6, 160
  s_mov_b32 s9, 0
  v_and_b32 v17, 7, v1
  v_lshlrev_b32 v15, 6, v17
  v_lshrrev_b32 v17, 4, v1
  v_lshl_add_u32 v15, v17, 4, v15
  v_and_b32 v17, 8, v1
  v_lshl_add_u32 v15, v17, 27, v15
  s_getpc_b64 s[36:37]
  s_setpc_b64 s[38:39]
  s_lshl_b32 s23, s20, 9
  v_add_u32 v16, s23, v10
  s_mov_b32 s9, -1
  ds_write_b128 v16, v[232:235]
  s_getpc_b64 s[36:37]
  s_setpc_b64 s[38:39]
  ds_read_b128 v[236:239], v10 offset:0
  ds_read_b128 v[240:243], v10 offset:512
  ds_read_b128 v[244:247], v10 offset:1024
  ds_read_b128 v[248:251], v10 offset:1536
  s_waitcnt vmcnt(4)
  ds_read_b64_tr_b16 a[192:193], v6 offset:0
  ds_read_b64_tr_b16 a[194:195], v6 offset:2560
  ds_read_b64_tr_b16 a[196:197], v6 offset:32
  ds_read_b64_tr_b16 a[198:199], v6 offset:2592
  ds_read_b64_tr_b16 a[200:201], v6 offset:64
  ds_read_b64_tr_b16 a[202:203], v6 offset:2624
  ds_read_b64_tr_b16 a[204:205], v6 offset:96
  ds_read_b64_tr_b16 a[206:207], v6 offset:2656
  ds_read_b64_tr_b16 a[208:209], v6 offset:128
  ds_read_b64_tr_b16 a[210:211], v6 offset:2688
  v_subrev_u32 v10, 10240, v10
  s_mov_b32 s8, 0
  s_waitcnt lgkmcnt(10)
  v_cvt_pk_bf16_f32 v236, v236, v244
  v_cvt_pk_bf16_f32 v237, v237, v245
  v_cvt_pk_bf16_f32 v238, v238, v246
  v_cvt_pk_bf16_f32 v239, v239, v247
  v_cvt_pk_bf16_f32 v240, v240, v248
  v_cvt_pk_bf16_f32 v241, v241, v249
  v_cvt_pk_bf16_f32 v242, v242, v250
  v_cvt_pk_bf16_f32 v243, v243, v251
  v_lshlrev_b32 v244, 16, v236
  v_lshlrev_b32 v245, 16, v237
  v_lshlrev_b32 v246, 16, v238
  v_lshlrev_b32 v247, 16, v239
  v_lshlrev_b32 v248, 16, v240
  v_lshlrev_b32 v249, 16, v241
  v_lshlrev_b32 v250, 16, v242
  v_lshlrev_b32 v251, 16, v243
  v_mul_f32 v16, 0xbfb8aa3b, v244
  v_mul_f32 v17, 0xbfb8aa3b, v245
  v_mul_f32 v18, 0xbfb8aa3b, v246
  v_mul_f32 v19, 0xbfb8aa3b, v247
  v_mul_f32 v20, 0xbfb8aa3b, v248
  v_mul_f32 v21, 0xbfb8aa3b, v249
  v_mul_f32 v22, 0xbfb8aa3b, v250
  v_mul_f32 v23, 0xbfb8aa3b, v251
  v_exp_f32 v16, v16
  v_exp_f32 v17, v17
  v_exp_f32 v18, v18
  v_exp_f32 v19, v19
  v_exp_f32 v20, v20
  v_exp_f32 v21, v21
  v_exp_f32 v22, v22
  v_exp_f32 v23, v23
  v_add_f32 v16, 1.0, v16
  v_add_f32 v17, 1.0, v17
  v_add_f32 v18, 1.0, v18
  v_add_f32 v19, 1.0, v19
  v_add_f32 v20, 1.0, v20
  v_add_f32 v21, 1.0, v21
  v_add_f32 v22, 1.0, v22
  v_add_f32 v23, 1.0, v23
  v_rcp_f32 v16, v16
  v_rcp_f32 v17, v17
  v_rcp_f32 v18, v18
  v_rcp_f32 v19, v19
  v_rcp_f32 v20, v20
  v_rcp_f32 v21, v21
  v_rcp_f32 v22, v22
  v_rcp_f32 v23, v23
  v_and_b32 v236, 0xffff0000, v236
  v_and_b32 v237, 0xffff0000, v237
  v_and_b32 v238, 0xffff0000, v238
  v_and_b32 v239, 0xffff0000, v239
  v_and_b32 v240, 0xffff0000, v240
  v_and_b32 v241, 0xffff0000, v241
  v_and_b32 v242, 0xffff0000, v242
  v_and_b32 v243, 0xffff0000, v243
  v_pk_mul_f32 v[244:245], v[244:245], v[16:17]
  v_pk_mul_f32 v[246:247], v[246:247], v[18:19]
  v_pk_mul_f32 v[248:249], v[248:249], v[20:21]
  v_pk_mul_f32 v[250:251], v[250:251], v[22:23]
  v_cvt_pk_bf16_f32 v16, v244, v245
  v_cvt_pk_bf16_f32 v17, v246, v247
  v_cvt_pk_bf16_f32 v18, v248, v249
  v_cvt_pk_bf16_f32 v19, v250, v251
  v_lshlrev_b32 v244, 16, v16
  v_and_b32 v245, 0xffff0000, v16
  v_lshlrev_b32 v246, 16, v17
  v_and_b32 v247, 0xffff0000, v17
  v_lshlrev_b32 v248, 16, v18
  v_and_b32 v249, 0xffff0000, v18
  v_lshlrev_b32 v250, 16, v19
  v_and_b32 v251, 0xffff0000, v19
  v_pk_mul_f32 v[236:237], v[236:237], v[244:245]
  v_pk_mul_f32 v[238:239], v[238:239], v[246:247]
  v_pk_mul_f32 v[240:241], v[240:241], v[248:249]
  v_pk_mul_f32 v[242:243], v[242:243], v[250:251]
  v_cvt_pk_bf16_f32 v16, v236, v237
  v_cvt_pk_bf16_f32 v17, v238, v239
  v_cvt_pk_bf16_f32 v18, v240, v241
  v_cvt_pk_bf16_f32 v19, v242, v243
  v_accvgpr_write_b32 a232, v16
  v_accvgpr_write_b32 a233, v17
  v_accvgpr_write_b32 a234, v18
  v_accvgpr_write_b32 a235, v19
  s_nop 0
  s_waitcnt lgkmcnt(0)
  v_mfma_f32_16x16x32_bf16 v[236:239], a[192:195], a[232:235], 0
  v_mfma_f32_16x16x32_bf16 v[240:243], a[196:199], a[232:235], 0
  v_mfma_f32_16x16x32_bf16 v[244:247], a[200:203], a[232:235], 0
  v_mfma_f32_16x16x32_bf16 v[248:251], a[204:207], a[232:235], 0
  v_mfma_f32_16x16x32_bf16 v[252:255], a[208:211], a[232:235], 0
  s_nop 3
  buffer_store_dwordx4 v[236:239], v15, s[40:43], s10 offen offset:0 sc1
  buffer_store_dwordx4 v[240:243], v15, s[40:43], s10 offen offset:512 sc1
  buffer_store_dwordx4 v[244:247], v15, s[40:43], s10 offen offset:1024 sc1
  buffer_store_dwordx4 v[248:251], v15, s[40:43], s10 offen offset:1536 sc1
  buffer_store_dwordx4 v[252:255], v15, s[40:43], s10 offen offset:2048 sc1
  s_add_u32 s10, s10, 2560
  s_getpc_b64 s[36:37]
  s_setpc_b64 s[38:39]
  s_waitcnt vmcnt(4)
  ds_read_b64_tr_b16 a[192:193], v6 offset:0
  ds_read_b64_tr_b16 a[194:195], v6 offset:2560
  ds_read_b64_tr_b16 a[196:197], v6 offset:32
  ds_read_b64_tr_b16 a[198:199], v6 offset:2592
  ds_read_b64_tr_b16 a[200:201], v6 offset:64
  ds_read_b64_tr_b16 a[202:203], v6 offset:2624
  ds_read_b64_tr_b16 a[204:205], v6 offset:96
  ds_read_b64_tr_b16 a[206:207], v6 offset:2656
  ds_read_b64_tr_b16 a[208:209], v6 offset:128
  ds_read_b64_tr_b16 a[210:211], v6 offset:2688
  s_waitcnt lgkmcnt(0)
  v_mfma_f32_16x16x32_bf16 v[236:239], a[192:195], a[232:235], 0
  v_mfma_f32_16x16x32_bf16 v[240:243], a[196:199], a[232:235], 0
  v_mfma_f32_16x16x32_bf16 v[244:247], a[200:203], a[232:235], 0
  v_mfma_f32_16x16x32_bf16 v[248:251], a[204:207], a[232:235], 0
  v_mfma_f32_16x16x32_bf16 v[252:255], a[208:211], a[232:235], 0
  s_nop 3
  buffer_store_dwordx4 v[236:239], v15, s[40:43], s10 offen offset:0 sc1
  buffer_store_dwordx4 v[240:243], v15, s[40:43], s10 offen offset:512 sc1
  buffer_store_dwordx4 v[244:247], v15, s[40:43], s10 offen offset:1024 sc1
  buffer_store_dwordx4 v[248:251], v15, s[40:43], s10 offen offset:1536 sc1
  buffer_store_dwordx4 v[252:255], v15, s[40:43], s10 offen offset:2048 sc1
  s_add_u32 s10, s10, 2560
  s_getpc_b64 s[36:37]
  s_setpc_b64 s[38:39]
  s_sub_u32 s23, s2, 170
  s_lshl_b32 s31, s20, 6
  s_add_u32 s23, s23, s31
  s_lshl_b32 s23, s23, 7
  s_add_u32 s23, s23, 67174400
  s_waitcnt vmcnt(8)
  buffer_store_dword v4, off, s[40:43], s23 sc1
fa_coW:
  s_mov_b32 s12, 1
  s_mov_b32 s9, -1
  s_cmp_lg_u32 s11, 0
  s_cselect_b32 s32, s15, -1
  s_getpc_b64 s[36:37]
  s_setpc_b64 s[38:39]
  s_lshl_b32 s23, s22, 1
  s_and_b32 s31, s2, 1
  s_add_u32 s23, s23, s31
  s_lshl_b32 s23, s23, 2
  s_add_u32 s23, s23, s20
  s_mul_i32 s13, s23, 81920
  s_add_u32 s13, s13, 4194304
  s_lshl_b32 s23, s23, 11
  s_add_u32 s23, s23, 67371008
  v_and_b32 v9, 15, v1
  v_lshl_add_u32 v9, v9, 7, s23
  s_and_b32 s60, s2, 7
  s_lshl_b32 s60, s60, 1
  s_and_b32 s23, s2, 16
  s_add_u32 s60, s60, s23
  s_bfe_u32 s23, s2, 0x10003
  s_add_u32 s60, s60, s23
  v_and_b32 v10, 15, v1
  v_lshlrev_b32 v10, 2, v10
  v_add_u32 v10, 2629632, v10
  buffer_load_dword v8, v9, s[40:43], 0 offen sc1
  buffer_load_dword v15, v10, s[40:43], 0 offen sc1
  s_load_dwordx2 s[52:53], s[0:1], 0
  v_mov_b32 v20, v228
  v_mov_b32 v21, v229
  s_nop 1
  v_permlane16_swap_b32 v228, v20
  v_permlane16_swap_b32 v229, v21
  v_add_f32 v228, v228, v20
  v_add_f32 v229, v229, v21
  v_mov_b32 v20, v228
  v_mov_b32 v21, v229
  s_nop 1
  v_permlane32_swap_b32 v228, v20
  v_permlane32_swap_b32 v229, v21
  v_add_f32 v228, v228, v20
  v_add_f32 v229, v229, v21
  v_rcp_f32 v16, v228
  v_rcp_f32 v18, v229
  s_lshl_b32 s23, s22, 2
  v_mov_b32 v17, v16
  v_mov_b32 v19, v18
  s_add_u32 s23, s23, s20
  s_lshl_b32 s23, s23, 18
  s_lshl_b32 s31, s21, 12
  s_add_u32 s31, s31, 50331648
  s_add_u32 s64, s23, s31
  s_add_u32 s65, s64, 131072
  v_accvgpr_read_b32 v36, a0
  v_accvgpr_read_b32 v37, a1
  v_accvgpr_read_b32 v38, a2
  v_accvgpr_read_b32 v39, a3
  v_accvgpr_read_b32 v40, a8
  v_accvgpr_read_b32 v41, a9
  v_accvgpr_read_b32 v42, a10
  v_accvgpr_read_b32 v43, a11
  v_pk_mul_f32 v[36:37], v[36:37], v[16:17]
  v_pk_mul_f32 v[38:39], v[38:39], v[16:17]
  v_pk_mul_f32 v[40:41], v[40:41], v[16:17]
  v_pk_mul_f32 v[42:43], v[42:43], v[16:17]
  v_cvt_pk_bf16_f32 v32, v36, v37
  v_cvt_pk_bf16_f32 v33, v38, v39
  v_cvt_pk_bf16_f32 v34, v40, v41
  v_cvt_pk_bf16_f32 v35, v42, v43
  buffer_store_dwordx4 v[32:35], v2, s[40:43], s64 offen offset:0 sc1
  v_accvgpr_read_b32 v48, a16
  v_accvgpr_read_b32 v49, a17
  v_accvgpr_read_b32 v50, a18
  v_accvgpr_read_b32 v51, a19
  v_accvgpr_read_b32 v52, a24
  v_accvgpr_read_b32 v53, a25
  v_accvgpr_read_b32 v54, a26
  v_accvgpr_read_b32 v55, a27
  v_pk_mul_f32 v[48:49], v[48:49], v[16:17]
  v_pk_mul_f32 v[50:51], v[50:51], v[16:17]
  v_pk_mul_f32 v[52:53], v[52:53], v[16:17]
  v_pk_mul_f32 v[54:55], v[54:55], v[16:17]
  v_cvt_pk_bf16_f32 v44, v48, v49
  v_cvt_pk_bf16_f32 v45, v50, v51
  v_cvt_pk_bf16_f32 v46, v52, v53
  v_cvt_pk_bf16_f32 v47, v54, v55
  buffer_store_dwordx4 v[44:47], v2, s[40:43], s64 offen offset:1024 sc1
  v_accvgpr_read_b32 v100, a32
  v_accvgpr_read_b32 v101, a33
  v_accvgpr_read_b32 v102, a34
  v_accvgpr_read_b32 v103, a35
  v_accvgpr_read_b32 v104, a40
  v_accvgpr_read_b32 v105, a41
  v_accvgpr_read_b32 v106, a42
  v_accvgpr_read_b32 v107, a43
  v_pk_mul_f32 v[100:101], v[100:101], v[16:17]
  v_pk_mul_f32 v[102:103], v[102:103], v[16:17]
  v_pk_mul_f32 v[104:105], v[104:105], v[16:17]
  v_pk_mul_f32 v[106:107], v[106:107], v[16:17]
  v_cvt_pk_bf16_f32 v96, v100, v101
  v_cvt_pk_bf16_f32 v97, v102, v103
  v_cvt_pk_bf16_f32 v98, v104, v105
  v_cvt_pk_bf16_f32 v99, v106, v107
  buffer_store_dwordx4 v[96:99], v2, s[40:43], s64 offen offset:2048 sc1
  v_accvgpr_read_b32 v112, a48
  v_accvgpr_read_b32 v113, a49
  v_accvgpr_read_b32 v114, a50
  v_accvgpr_read_b32 v115, a51
  v_accvgpr_read_b32 v116, a56
  v_accvgpr_read_b32 v117, a57
  v_accvgpr_read_b32 v118, a58
  v_accvgpr_read_b32 v119, a59
  v_pk_mul_f32 v[112:113], v[112:113], v[16:17]
  v_pk_mul_f32 v[114:115], v[114:115], v[16:17]
  v_pk_mul_f32 v[116:117], v[116:117], v[16:17]
  v_pk_mul_f32 v[118:119], v[118:119], v[16:17]
  v_cvt_pk_bf16_f32 v108, v112, v113
  v_cvt_pk_bf16_f32 v109, v114, v115
  v_cvt_pk_bf16_f32 v110, v116, v117
  v_cvt_pk_bf16_f32 v111, v118, v119
  buffer_store_dwordx4 v[108:111], v2, s[40:43], s64 offen offset:3072 sc1
  v_accvgpr_read_b32 v36, a4
  v_accvgpr_read_b32 v37, a5
  v_accvgpr_read_b32 v38, a6
  v_accvgpr_read_b32 v39, a7
  v_accvgpr_read_b32 v40, a12
  v_accvgpr_read_b32 v41, a13
  v_accvgpr_read_b32 v42, a14
  v_accvgpr_read_b32 v43, a15
  v_pk_mul_f32 v[36:37], v[36:37], v[18:19]
  v_pk_mul_f32 v[38:39], v[38:39], v[18:19]
  v_pk_mul_f32 v[40:41], v[40:41], v[18:19]
  v_pk_mul_f32 v[42:43], v[42:43], v[18:19]
  v_cvt_pk_bf16_f32 v32, v36, v37
  v_cvt_pk_bf16_f32 v33, v38, v39
  v_cvt_pk_bf16_f32 v34, v40, v41
  v_cvt_pk_bf16_f32 v35, v42, v43
  buffer_store_dwordx4 v[32:35], v2, s[40:43], s65 offen offset:0 sc1
  v_accvgpr_read_b32 v48, a20
  v_accvgpr_read_b32 v49, a21
  v_accvgpr_read_b32 v50, a22
  v_accvgpr_read_b32 v51, a23
  v_accvgpr_read_b32 v52, a28
  v_accvgpr_read_b32 v53, a29
  v_accvgpr_read_b32 v54, a30
  v_accvgpr_read_b32 v55, a31
  v_pk_mul_f32 v[48:49], v[48:49], v[18:19]
  v_pk_mul_f32 v[50:51], v[50:51], v[18:19]
  v_pk_mul_f32 v[52:53], v[52:53], v[18:19]
  v_pk_mul_f32 v[54:55], v[54:55], v[18:19]
  v_cvt_pk_bf16_f32 v44, v48, v49
  v_cvt_pk_bf16_f32 v45, v50, v51
  v_cvt_pk_bf16_f32 v46, v52, v53
  v_cvt_pk_bf16_f32 v47, v54, v55
  buffer_store_dwordx4 v[44:47], v2, s[40:43], s65 offen offset:1024 sc1
  v_accvgpr_read_b32 v100, a36
  v_accvgpr_read_b32 v101, a37
  v_accvgpr_read_b32 v102, a38
  v_accvgpr_read_b32 v103, a39
  v_accvgpr_read_b32 v104, a44
  v_accvgpr_read_b32 v105, a45
  v_accvgpr_read_b32 v106, a46
  v_accvgpr_read_b32 v107, a47
  v_pk_mul_f32 v[100:101], v[100:101], v[18:19]
  v_pk_mul_f32 v[102:103], v[102:103], v[18:19]
  v_pk_mul_f32 v[104:105], v[104:105], v[18:19]
  v_pk_mul_f32 v[106:107], v[106:107], v[18:19]
  v_cvt_pk_bf16_f32 v96, v100, v101
  v_cvt_pk_bf16_f32 v97, v102, v103
  v_cvt_pk_bf16_f32 v98, v104, v105
  v_cvt_pk_bf16_f32 v99, v106, v107
  buffer_store_dwordx4 v[96:99], v2, s[40:43], s65 offen offset:2048 sc1
  v_accvgpr_read_b32 v112, a52
  v_accvgpr_read_b32 v113, a53
  v_accvgpr_read_b32 v114, a54
  v_accvgpr_read_b32 v115, a55
  v_accvgpr_read_b32 v116, a60
  v_accvgpr_read_b32 v117, a61
  v_accvgpr_read_b32 v118, a62
  v_accvgpr_read_b32 v119, a63
  v_pk_mul_f32 v[112:113], v[112:113], v[18:19]
  v_pk_mul_f32 v[114:115], v[114:115], v[18:19]
  v_pk_mul_f32 v[116:117], v[116:117], v[18:19]
  v_pk_mul_f32 v[118:119], v[118:119], v[18:19]
  v_cvt_pk_bf16_f32 v108, v112, v113
  v_cvt_pk_bf16_f32 v109, v114, v115
  v_cvt_pk_bf16_f32 v110, v116, v117
  v_cvt_pk_bf16_f32 v111, v118, v119
  buffer_store_dwordx4 v[108:111], v2, s[40:43], s65 offen offset:3072 sc1
  s_lshl_b32 s33, s60, 6
  s_mul_i32 s35, s22, 160
  s_mul_i32 s14, s22, 2560
  s_mov_b32 s54, 2621440
  s_mov_b32 s55, 0x20000
  v_add_u32 v16, 0, v0
  v_mul_u32_u24 v17, 6554, v16
  v_lshrrev_b32 v17, 16, v17
  v_mul_u32_u24 v18, 10, v17
  v_sub_u32 v18, v16, v18
  v_mul_u32_u24 v251, 336, v17
  v_lshl_add_u32 v251, v18, 5, v251
  v_add_u32 v17, s33, v17
  v_mul_u32_u24 v248, 1280, v17
  v_lshl_add_u32 v248, v18, 4, v248
  v_add_u32 v248, s35, v248
  v_lshrrev_b32 v19, 4, v17
  v_mul_u32_u24 v19, 20480, v19
  v_and_b32 v17, 15, v17
  v_lshl_add_u32 v19, v17, 4, v19
  v_lshl_add_u32 v24, v18, 8, v19
  v_add_u32 v16, 256, v0
  v_mul_u32_u24 v17, 6554, v16
  v_lshrrev_b32 v17, 16, v17
  v_mul_u32_u24 v18, 10, v17
  v_sub_u32 v18, v16, v18
  v_mul_u32_u24 v252, 336, v17
  v_lshl_add_u32 v252, v18, 5, v252
  v_add_u32 v17, s33, v17
  v_mul_u32_u24 v249, 1280, v17
  v_lshl_add_u32 v249, v18, 4, v249
  v_add_u32 v249, s35, v249
  v_lshrrev_b32 v19, 4, v17
  v_mul_u32_u24 v19, 20480, v19
  v_and_b32 v17, 15, v17
  v_lshl_add_u32 v19, v17, 4, v19
  v_lshl_add_u32 v25, v18, 8, v19
  v_add_u32 v16, 512, v0
  v_mul_u32_u24 v17, 6554, v16
  v_lshrrev_b32 v17, 16, v17
  v_mul_u32_u24 v18, 10, v17
  v_sub_u32 v18, v16, v18
  v_mul_u32_u24 v253, 336, v17
  v_lshl_add_u32 v253, v18, 5, v253
  v_add_u32 v17, s33, v17
  v_mul_u32_u24 v250, 1280, v17
  v_lshl_add_u32 v250, v18, 4, v250
  v_add_u32 v250, s35, v250
  v_lshrrev_b32 v19, 4, v17
  v_mul_u32_u24 v19, 20480, v19
  v_and_b32 v17, 15, v17
  v_lshl_add_u32 v19, v17, 4, v19
  v_lshl_add_u32 v26, v18, 8, v19
  v_cmp_gt_u32 vcc, 128, v0
  v_mov_b32 v16, 1073741824
  v_mov_b32 v17, 0
  v_lshlrev_b32 v6, 4, v0
  v_cndmask_b32 v250, v16, v250, vcc
  v_cndmask_b32 v26, v16, v26, vcc
  v_cndmask_b32 v253, v17, v253, vcc
  v_cndmask_b32 v6, v16, v6, vcc
  s_lshl_b32 s23, s20, 10
  s_add_u32 s23, s23, 151552
  s_waitcnt vmcnt(8) lgkmcnt(0)
  s_add_u32 m0, s34, 0
  s_nop 0
  buffer_load_dwordx4 v248, s[52:55], 0 offen lds
  s_add_u32 m0, s34, 3072
  s_nop 0
  buffer_load_dwordx4 v24, s[40:43], s14 offen sc1 lds
  s_add_u32 m0, s34, 1024
  s_nop 0
  buffer_load_dwordx4 v249, s[52:55], 0 offen lds
  s_add_u32 m0, s34, 4096
  s_nop 0
  buffer_load_dwordx4 v25, s[40:43], s14 offen sc1 lds
  s_add_u32 m0, s34, 2048
  s_nop 0
  buffer_load_dwordx4 v250, s[52:55], 0 offen lds
  s_mov_b32 m0, s23
  s_nop 0
  buffer_load_dwordx4 v26, s[40:43], s14 offen sc1 lds
  s_mov_b32 s28, s46
  s_add_u32 s30, s28, 65536
  s_lshl_b32 s23, s20, 12
  s_add_u32 s23, s23, s28
  s_add_u32 s31, s13, 32768
  s_sub_u32 s31, s31, s23
  s_add_u32 s4, s18, s31
  s_addc_u32 s5, s19, 0
  s_add_u32 s6, s4, 4096
  s_addc_u32 s7, s5, 0
  v_cmp_eq_u32 vcc, 0, v8
  s_cbranch_vccnz fa_wof_spin
fa_wof_ok:
  v_cmp_eq_u32 vcc, 0, v15
  s_cbranch_vccnz fa_sel4_spin
fa_sel4_ok:
  s_lshl_b32 s31, s60, 6
  s_add_u32 s31, s31, 1
  v_subrev_u32 v16, s31, v15
  v_cmp_gt_u32 vcc, 64, v16
  s_cmp_lt_u32 s20, 2
  s_cselect_b32 s23, 0xff, 0
  s_and_b32 s10, vcc_lo, s23
  s_sub_u32 s23, s10, 1
  s_and_b32 s23, s23, s10
  s_cmp_eq_u32 s20, 1
  s_cselect_b32 s10, s23, s10
  s_cmp_eq_u32 s10, 0
  s_cbranch_scc1 fa_coEnd
  v_min_u32 v11, 53, v1
  s_lshr_b32 s23, s22, 1
  s_lshl_b32 s23, s23, 13
  s_add_u32 s23, s23, 67174400
  v_lshl_add_u32 v11, v11, 7, s23
  buffer_load_dword v14, v11, s[40:43], 0 offen sc1
  v_mul_u32_u24 v16, 3277, v1
  v_lshrrev_b32 v16, 16, v16
  v_mul_u32_u24 v8, 20, v16
  v_sub_u32 v8, v1, v8
  v_lshlrev_b32 v8, 4, v8
  v_mul_u32_u24 v9, 368640, v16
  v_lshrrev_b32 v17, 6, v8
  v_mul_u32_u24 v17, 448, v17
  v_add3_u32 v9, v9, v8, v17
  v_cmp_gt_u32 vcc, 3, v16
  v_mov_b32 v19, 1073741824
  s_nop 0
  v_cndmask_b32 v9, v19, v9, vcc
  s_mov_b32 s12, 2
  s_mov_b32 s32, -1
  s_mov_b32 s11, 0
  s_getpc_b64 s[36:37]
  s_setpc_b64 s[38:39]
  v_cmp_eq_u32 vcc, 0, v14
  s_cbranch_vccnz fa_yf_spin
fa_yf_ok:
fa_coY:
  s_ff1_i32_b32 s33, s10
  s_bitset0_b32 s10, s33
  s_sub_u32 s23, s10, 1
  s_and_b32 s10, s10, s23
  s_lshl_b32 s14, s33, 6
  s_mul_i32 s23, s22, 2560
  s_add_u32 s14, s14, s23
  s_add_u32 s14, s14, 2686976
  buffer_load_dwordx4 v[64:67], v9, s[40:43], s14 offen sc1
  s_add_u32 s14, s14, 20480
  buffer_load_dwordx4 v[68:71], v9, s[40:43], s14 offen sc1
  s_add_u32 s14, s14, 20480
  buffer_load_dwordx4 v[72:75], v9, s[40:43], s14 offen sc1
  s_add_u32 s14, s14, 20480
  buffer_load_dwordx4 v[76:79], v9, s[40:43], s14 offen sc1
  s_add_u32 s14, s14, 20480
  buffer_load_dwordx4 v[80:83], v9, s[40:43], s14 offen sc1
  s_add_u32 s14, s14, 20480
  buffer_load_dwordx4 v[84:87], v9, s[40:43], s14 offen sc1
  s_add_u32 s14, s14, 20480
  buffer_load_dwordx4 v[88:91], v9, s[40:43], s14 offen sc1
  s_add_u32 s14, s14, 20480
  buffer_load_dwordx4 v[92:95], v9, s[40:43], s14 offen sc1
  s_add_u32 s14, s14, 20480
  buffer_load_dwordx4 v[128:131], v9, s[40:43], s14 offen sc1
  s_add_u32 s14, s14, 20480
  buffer_load_dwordx4 v[132:135], v9, s[40:43], s14 offen sc1
  s_add_u32 s14, s14, 20480
  buffer_load_dwordx4 v[136:139], v9, s[40:43], s14 offen sc1
  s_add_u32 s14, s14, 20480
  buffer_load_dwordx4 v[140:143], v9, s[40:43], s14 offen sc1
  s_add_u32 s14, s14, 20480
  buffer_load_dwordx4 v[144:147], v9, s[40:43], s14 offen sc1
  s_add_u32 s14, s14, 20480
  buffer_load_dwordx4 v[148:151], v9, s[40:43], s14 offen sc1
  s_add_u32 s14, s14, 20480
  buffer_load_dwordx4 v[152:155], v9, s[40:43], s14 offen sc1
  s_add_u32 s14, s14, 20480
  buffer_load_dwordx4 v[156:159], v9, s[40:43], s14 offen sc1
  s_add_u32 s14, s14, 20480
  buffer_load_dwordx4 v[176:179], v9, s[40:43], s14 offen sc1
  s_add_u32 s14, s14, 20480
  buffer_load_dwordx4 v[180:183], v9, s[40:43], s14 offen sc1
  s_add_u32 s14, s14, 20480
  s_lshl_b32 s14, s20, 10
  s_add_u32 s14, s14, 159744
  v_add_u32 v19, s14, v2
  s_add_u32 s23, s33, 8
  v_readlane_b32 s35, v15, s23
  s_waitcnt vmcnt(0)
  v_pk_add_f32 v[64:65], v[64:65], v[68:69]
  v_pk_add_f32 v[66:67], v[66:67], v[70:71]
  v_pk_add_f32 v[64:65], v[64:65], v[72:73]
  v_pk_add_f32 v[66:67], v[66:67], v[74:75]
  v_pk_add_f32 v[64:65], v[64:65], v[76:77]
  v_pk_add_f32 v[66:67], v[66:67], v[78:79]
  v_pk_add_f32 v[64:65], v[64:65], v[80:81]
  v_pk_add_f32 v[66:67], v[66:67], v[82:83]
  v_pk_add_f32 v[64:65], v[64:65], v[84:85]
  v_pk_add_f32 v[66:67], v[66:67], v[86:87]
  v_pk_add_f32 v[64:65], v[64:65], v[88:89]
  v_pk_add_f32 v[66:67], v[66:67], v[90:91]
  v_pk_add_f32 v[64:65], v[64:65], v[92:93]
  v_pk_add_f32 v[66:67], v[66:67], v[94:95]
  v_pk_add_f32 v[64:65], v[64:65], v[128:129]
  v_pk_add_f32 v[66:67], v[66:67], v[130:131]
  v_pk_add_f32 v[64:65], v[64:65], v[132:133]
  v_pk_add_f32 v[66:67], v[66:67], v[134:135]
  v_pk_add_f32 v[64:65], v[64:65], v[136:137]
  v_pk_add_f32 v[66:67], v[66:67], v[138:139]
  v_pk_add_f32 v[64:65], v[64:65], v[140:141]
  v_pk_add_f32 v[66:67], v[66:67], v[142:143]
  v_pk_add_f32 v[64:65], v[64:65], v[144:145]
  v_pk_add_f32 v[66:67], v[66:67], v[146:147]
  v_pk_add_f32 v[64:65], v[64:65], v[148:149]
  v_pk_add_f32 v[66:67], v[66:67], v[150:151]
  v_pk_add_f32 v[64:65], v[64:65], v[152:153]
  v_pk_add_f32 v[66:67], v[66:67], v[154:155]
  v_pk_add_f32 v[64:65], v[64:65], v[156:157]
  v_pk_add_f32 v[66:67], v[66:67], v[158:159]
  v_pk_add_f32 v[64:65], v[64:65], v[176:177]
  v_pk_add_f32 v[66:67], v[66:67], v[178:179]
  v_pk_add_f32 v[64:65], v[64:65], v[180:181]
  v_pk_add_f32 v[66:67], v[66:67], v[182:183]
  ds_write_b128 v19, v[64:67]
  v_add_u32 v19, s14, v8
  s_and_b32 s35, s35, 0xffff0000
  s_waitcnt lgkmcnt(0)
  ds_read_b128 v[64:67], v19
  ds_read_b128 v[68:71], v19 offset:320
  ds_read_b128 v[72:75], v19 offset:640
  s_mul_i32 s14, s33, 320
  s_add_u32 s14, s14, 155648
  v_add_u32 v19, s14, v8
  s_waitcnt lgkmcnt(0)
  v_add_f32 v64, v64, v68
  v_add_f32 v64, v64, v72
  v_cvt_pk_bf16_f32 v64, v64, v64
  v_and_b32 v64, 0xffff0000, v64
  v_mul_f32 v64, s35, v64
  v_cvt_pk_bf16_f32 v64, v64, v64
  v_and_b32 v64, 0xffff0000, v64
  v_add_f32 v65, v65, v69
  v_add_f32 v65, v65, v73
  v_cvt_pk_bf16_f32 v65, v65, v65
  v_and_b32 v65, 0xffff0000, v65
  v_mul_f32 v65, s35, v65
  v_cvt_pk_bf16_f32 v65, v65, v65
  v_and_b32 v65, 0xffff0000, v65
  v_add_f32 v66, v66, v70
  v_add_f32 v66, v66, v74
  v_cvt_pk_bf16_f32 v66, v66, v66
  v_and_b32 v66, 0xffff0000, v66
  v_mul_f32 v66, s35, v66
  v_cvt_pk_bf16_f32 v66, v66, v66
  v_and_b32 v66, 0xffff0000, v66
  v_add_f32 v67, v67, v71
  v_add_f32 v67, v67, v75
  v_cvt_pk_bf16_f32 v67, v67, v67
  v_and_b32 v67, 0xffff0000, v67
  v_mul_f32 v67, s35, v67
  v_cvt_pk_bf16_f32 v67, v67, v67
  v_and_b32 v67, 0xffff0000, v67
  ds_write_b128 v19, v[64:67]
  s_waitcnt lgkmcnt(0)
  s_cmp_lg_u32 s10, 0
  s_cbranch_scc1 fa_coY
fa_coEnd:
  s_mov_b32 s12, 3
  s_mov_b32 s32, -1
  s_setpc_b64 s[38:39]
fa_hk7:
  s_getpc_b64 s[38:39]
fa_hp7:
  s_add_u32 s36, s36, 4
  s_addc_u32 s37, s37, 0
  s_sub_u32 s38, s38, fa_hp7-fa_hb7
  s_subb_u32 s39, s39, 0
  s_setpc_b64 s[36:37]
fa_hk8:
  s_getpc_b64 s[38:39]
fa_hp8:
  s_add_u32 s36, s36, 4
  s_addc_u32 s37, s37, 0
  s_sub_u32 s38, s38, fa_hp8-fa_hb8
  s_subb_u32 s39, s39, 0
  s_setpc_b64 s[36:37]
fa_disp:
  s_cmp_eq_u32 s29, 7
  s_cbranch_scc1 fa_SSW7
  s_cmp_eq_u32 s29, 6
  s_cbranch_scc1 fa_SSW6
  s_cmp_eq_u32 s29, 5
  s_cbranch_scc1 fa_SSW5
  s_cmp_eq_u32 s29, 4
  s_cbranch_scc1 fa_SSW4
  s_cmp_eq_u32 s29, 3
  s_cbranch_scc1 fa_SSW3
  s_cmp_eq_u32 s29, 2
  s_cbranch_scc1 fa_SSW2
  s_cmp_eq_u32 s29, 1
  s_cbranch_scc1 fa_SSW1
  s_branch fa_Bexit
fa_hk9:
  s_getpc_b64 s[38:39]
fa_hp9:
  s_add_u32 s36, s36, 4
  s_addc_u32 s37, s37, 0
  s_sub_u32 s38, s38, fa_hp9-fa_hb9
  s_subb_u32 s39, s39, 0
  s_setpc_b64 s[36:37]
fa_left:
  s_add_u32 s14, s13, 77824
  buffer_load_dwordx4 a[252:255], v2, s[40:43], s14 offen offset:3072 sc1
  buffer_load_dwordx4 a[248:251], v2, s[40:43], s14 offen offset:2048 sc1
  buffer_load_dwordx4 a[244:247], v2, s[40:43], s14 offen offset:1024 sc1
  s_cmp_ge_u32 s29, 7
  s_cbranch_scc1 fa_leftb
  s_add_u32 s14, s13, 77824
  buffer_load_dwordx4 a[240:243], v2, s[40:43], s14 offen offset:0 sc1
  s_add_u32 s14, s13, 73728
  buffer_load_dwordx4 a[236:239], v2, s[40:43], s14 offen offset:3072 sc1
  buffer_load_dwordx4 a[232:235], v2, s[40:43], s14 offen offset:2048 sc1
  s_cmp_ge_u32 s29, 6
  s_cbranch_scc1 fa_leftb
  s_add_u32 s14, s13, 73728
  buffer_load_dwordx4 a[228:231], v2, s[40:43], s14 offen offset:1024 sc1
  buffer_load_dwordx4 a[224:227], v2, s[40:43], s14 offen offset:0 sc1
  s_add_u32 s14, s13, 69632
  buffer_load_dwordx4 a[220:223], v2, s[40:43], s14 offen offset:3072 sc1
  buffer_load_dwordx4 a[216:219], v2, s[40:43], s14 offen offset:2048 sc1
  s_cmp_ge_u32 s29, 5
  s_cbranch_scc1 fa_leftb
  s_add_u32 s14, s13, 69632
  buffer_load_dwordx4 a[212:215], v2, s[40:43], s14 offen offset:1024 sc1
  buffer_load_dwordx4 a[208:211], v2, s[40:43], s14 offen offset:0 sc1
  s_add_u32 s14, s13, 61440
  buffer_load_dwordx4 a[204:207], v2, s[40:43], s14 offen offset:3072 sc1
  buffer_load_dwordx4 a[200:203], v2, s[40:43], s14 offen offset:2048 sc1
  buffer_load_dwordx4 a[196:199], v2, s[40:43], s14 offen offset:1024 sc1
  buffer_load_dwordx4 a[192:195], v2, s[40:43], s14 offen offset:0 sc1
  s_cmp_ge_u32 s29, 4
  s_cbranch_scc1 fa_leftb
  s_add_u32 s14, s13, 57344
  buffer_load_dwordx4 a[60:63], v2, s[40:43], s14 offen offset:3072 sc1
  buffer_load_dwordx4 a[56:59], v2, s[40:43], s14 offen offset:2048 sc1
  buffer_load_dwordx4 a[52:55], v2, s[40:43], s14 offen offset:1024 sc1
  buffer_load_dwordx4 a[48:51], v2, s[40:43], s14 offen offset:0 sc1
  s_add_u32 s14, s13, 45056
  buffer_load_dwordx4 a[44:47], v2, s[40:43], s14 offen offset:3072 sc1
  buffer_load_dwordx4 a[40:43], v2, s[40:43], s14 offen offset:2048 sc1
  buffer_load_dwordx4 a[36:39], v2, s[40:43], s14 offen offset:1024 sc1
  buffer_load_dwordx4 a[32:35], v2, s[40:43], s14 offen offset:0 sc1
  s_cmp_ge_u32 s29, 3
  s_cbranch_scc1 fa_leftb
  s_add_u32 s14, s13, 40960
  buffer_load_dwordx4 a[28:31], v2, s[40:43], s14 offen offset:3072 sc1
  buffer_load_dwordx4 a[24:27], v2, s[40:43], s14 offen offset:2048 sc1
  buffer_load_dwordx4 a[20:23], v2, s[40:43], s14 offen offset:1024 sc1
  buffer_load_dwordx4 a[16:19], v2, s[40:43], s14 offen offset:0 sc1
  s_add_u32 s14, s13, 28672
  buffer_load_dwordx4 a[12:15], v2, s[40:43], s14 offen offset:3072 sc1
  buffer_load_dwordx4 a[8:11], v2, s[40:43], s14 offen offset:2048 sc1
  buffer_load_dwordx4 a[4:7], v2, s[40:43], s14 offen offset:1024 sc1
  buffer_load_dwordx4 a[0:3], v2, s[40:43], s14 offen offset:0 sc1
  s_cmp_ge_u32 s29, 2
  s_cbranch_scc1 fa_leftb
  s_add_u32 s14, s13, 24576
  buffer_load_dwordx4 v[212:215], v2, s[40:43], s14 offen offset:3072 sc1
  buffer_load_dwordx4 v[208:211], v2, s[40:43], s14 offen offset:2048 sc1
  buffer_load_dwordx4 v[196:199], v2, s[40:43], s14 offen offset:1024 sc1
  buffer_load_dwordx4 v[192:195], v2, s[40:43], s14 offen offset:0 sc1
  s_add_u32 s14, s13, 20480
  buffer_load_dwordx4 v[244:247], v2, s[40:43], s14 offen offset:3072 sc1
  buffer_load_dwordx4 v[240:243], v2, s[40:43], s14 offen offset:2048 sc1
  buffer_load_dwordx4 v[236:239], v2, s[40:43], s14 offen offset:1024 sc1
  buffer_load_dwordx4 v[232:235], v2, s[40:43], s14 offen offset:0 sc1
  s_cmp_ge_u32 s29, 1
  s_cbranch_scc1 fa_leftb
  s_add_u32 s14, s13, 16384
  buffer_load_dwordx4 v[172:175], v2, s[40:43], s14 offen offset:3072 sc1
  buffer_load_dwordx4 v[168:171], v2, s[40:43], s14 offen offset:2048 sc1
  buffer_load_dwordx4 v[164:167], v2, s[40:43], s14 offen offset:1024 sc1
  buffer_load_dwordx4 v[160:163], v2, s[40:43], s14 offen offset:0 sc1
  s_add_u32 s14, s13, 12288
  buffer_load_dwordx4 v[124:127], v2, s[40:43], s14 offen offset:3072 sc1
  buffer_load_dwordx4 v[120:123], v2, s[40:43], s14 offen offset:2048 sc1
  buffer_load_dwordx4 v[116:119], v2, s[40:43], s14 offen offset:1024 sc1
  buffer_load_dwordx4 v[112:115], v2, s[40:43], s14 offen offset:0 sc1
  s_branch fa_leftb
fa_ctx_spin:
  s_mov_b32 s83, 200000
fa_ctx_spin2:
  buffer_load_dword v13, v12, s[40:43], 0 offen sc1
  s_waitcnt vmcnt(0)
  v_cmp_eq_u32 vcc, 0, v13
  s_cbranch_vccz fa_ctx_ok
  s_sleep 3
  s_sub_u32 s83, s83, 1
  s_cmp_lg_u32 s83, 0
  s_cbranch_scc1 fa_ctx_spin2
  s_branch fa_ctx_ok
fa_ctx2_spin:
  s_mov_b32 s83, 200000
fa_ctx2_spin2:
  buffer_load_dword v13, v10, s[40:43], 0 offen sc1
  s_waitcnt vmcnt(0)
  v_cmp_eq_u32 vcc, 0, v13
  s_cbranch_vccz fa_ctx2_ok
  s_sleep 3
  s_sub_u32 s83, s83, 1
  s_cmp_lg_u32 s83, 0
  s_cbranch_scc1 fa_ctx2_spin2
  s_branch fa_ctx2_ok
fa_px_spin:
  s_mov_b32 s83, 200000
fa_px_spin2:
  buffer_load_dword v13, v8, s[40:43], 0 offen sc1
  s_waitcnt vmcnt(0)
  v_cmp_eq_u32 vcc, 0, v13
  s_cbranch_vccz fa_px_ok
  s_sleep 3
  s_sub_u32 s83, s83, 1
  s_cmp_lg_u32 s83, 0
  s_cbranch_scc1 fa_px_spin2
  s_branch fa_px_ok
fa_stub0:
  s_call_b64 s[76:77], fa_rare00
  s_call_b64 s[76:77], fa_rare10
  s_branch fa_back0
fa_stub1:
  s_call_b64 s[76:77], fa_rare01
  s_call_b64 s[76:77], fa_rare11
  s_branch fa_back1
fa_stub2:
  s_call_b64 s[76:77], fa_rare00
  s_call_b64 s[76:77], fa_rare10
  s_branch fa_back2
fa_stub3:
  s_call_b64 s[76:77], fa_rare01
  s_call_b64 s[76:77], fa_rare11
  s_branch fa_back3
fa_stub4:
  s_call_b64 s[76:77], fa_rare01
  s_call_b64 s[76:77], fa_rare11
  s_branch fa_back4
fa_stub5:
  s_call_b64 s[76:77], fa_rare00
  s_call_b64 s[76:77], fa_rare10
  s_branch fa_back5
fa_stub6:
  s_call_b64 s[76:77], fa_rare11
  s_branch fa_back6
fa_stub7:
  s_call_b64 s[76:77], fa_rare10
  s_branch fa_back7
fa_stub8:
  s_call_b64 s[76:77], fa_rare01
  s_call_b64 s[76:77], fa_rare11
  s_branch fa_back8
fa_stub9:
  s_call_b64 s[76:77], fa_rare10
  s_branch fa_back9
fa_stub10:
  s_call_b64 s[76:77], fa_rare11
  s_branch fa_back10
fa_stub11:
  s_call_b64 s[76:77], fa_rare10
  s_branch fa_back11
fa_stub12:
  s_call_b64 s[76:77], fa_rare11
  s_branch fa_back12
fa_stub13:
  s_call_b64 s[76:77], fa_rare10
  s_branch fa_back13
fa_stub14:
  s_call_b64 s[76:77], fa_rare11
  s_branch fa_back14
fa_stub15:
  s_call_b64 s[76:77], fa_rare10
  s_branch fa_back15
fa_stub16:
  s_call_b64 s[76:77], fa_rare11
  s_branch fa_back16
fa_stub17:
  s_call_b64 s[76:77], fa_rare10
  s_branch fa_back17
fa_stub18:
  s_call_b64 s[76:77], fa_rare11
  s_branch fa_back18
fa_stub19:
  s_call_b64 s[76:77], fa_rare10
  s_branch fa_back19
fa_stub20:
  s_call_b64 s[76:77], fa_rare11
  s_branch fa_back20
fa_stub21:
  s_call_b64 s[76:77], fa_rare10
  s_branch fa_back21
fa_stub22:
  s_call_b64 s[76:77], fa_rare11
  s_branch fa_back22
fa_stub23:
  s_call_b64 s[76:77], fa_rare10
  s_branch fa_back23
fa_stub24:
  s_call_b64 s[76:77], fa_rare11
  s_branch fa_back24
fa_stub25:
  s_call_b64 s[76:77], fa_rare10
  s_branch fa_back25
fa_stub26:
  s_call_b64 s[76:77], fa_rare11
  s_branch fa_back26
fa_stub27:
  s_call_b64 s[76:77], fa_rare10
  s_branch fa_back27
fa_stub28:
  s_call_b64 s[76:77], fa_rare11
  s_branch fa_back28
fa_stub29:
  s_call_b64 s[76:77], fa_rare10
  s_branch fa_back29
fa_stub30:
  s_call_b64 s[76:77], fa_rare11
  s_branch fa_back30
fa_codeend:
fa_rare00:
  s_nop 7
  v_max3_f32 v16, v96, v97, v98
  v_max3_f32 v16, v16, v99, v100
  v_max3_f32 v16, v16, v101, v102
  v_max3_f32 v16, v16, v103, 0
  v_mov_b32 v18, v16
  s_nop 1
  v_permlane16_swap_b32 v16, v18
  v_max_f32 v16, v16, v18
  v_mov_b32 v18, v16
  s_nop 1
  v_permlane32_swap_b32 v16, v18
  v_max_f32 v16, v16, v18
  v_sub_f32 v96, v96, v16
  v_sub_f32 v112, v112, v16
  v_sub_f32 v97, v97, v16
  v_sub_f32 v113, v113, v16
  v_sub_f32 v98, v98, v16
  v_sub_f32 v114, v114, v16
  v_sub_f32 v99, v99, v16
  v_sub_f32 v115, v115, v16
  v_sub_f32 v100, v100, v16
  v_sub_f32 v116, v116, v16
  v_sub_f32 v101, v101, v16
  v_sub_f32 v117, v117, v16
  v_sub_f32 v102, v102, v16
  v_sub_f32 v118, v118, v16
  v_sub_f32 v103, v103, v16
  v_sub_f32 v119, v119, v16
  v_max3_f32 v17, v104, v105, v106
  v_max3_f32 v17, v17, v107, v108
  v_max3_f32 v17, v17, v109, v110
  v_max3_f32 v17, v17, v111, 0
  v_mov_b32 v18, v17
  s_nop 1
  v_permlane16_swap_b32 v17, v18
  v_max_f32 v17, v17, v18
  v_mov_b32 v18, v17
  s_nop 1
  v_permlane32_swap_b32 v17, v18
  v_max_f32 v17, v17, v18
  v_sub_f32 v104, v104, v17
  v_sub_f32 v120, v120, v17
  v_sub_f32 v105, v105, v17
  v_sub_f32 v121, v121, v17
  v_sub_f32 v106, v106, v17
  v_sub_f32 v122, v122, v17
  v_sub_f32 v107, v107, v17
  v_sub_f32 v123, v123, v17
  v_sub_f32 v108, v108, v17
  v_sub_f32 v124, v124, v17
  v_sub_f32 v109, v109, v17
  v_sub_f32 v125, v125, v17
  v_sub_f32 v110, v110, v17
  v_sub_f32 v126, v126, v17
  v_sub_f32 v111, v111, v17
  v_sub_f32 v127, v127, v17
  s_call_b64 s[78:79], fa_resc0
  v_exp_f32 v208, v96
  v_exp_f32 v209, v97
  v_exp_f32 v210, v98
  v_add_f32 v224, v208, v209
  v_cvt_pk_bf16_f32 v160, v208, v209
  v_exp_f32 v211, v99
  v_add_f32 v224, v224, v210
  v_exp_f32 v212, v100
  v_add_f32 v224, v224, v211
  v_cvt_pk_bf16_f32 v161, v210, v211
  v_exp_f32 v213, v101
  v_add_f32 v224, v224, v212
  v_exp_f32 v214, v102
  v_add_f32 v224, v224, v213
  v_cvt_pk_bf16_f32 v162, v212, v213
  v_exp_f32 v215, v103
  v_add_f32 v224, v224, v214
  v_exp_f32 v208, v104
  v_add_f32 v224, v224, v215
  v_cvt_pk_bf16_f32 v163, v214, v215
  v_exp_f32 v209, v105
  v_exp_f32 v210, v106
  v_add_f32 v225, v208, v209
  v_cvt_pk_bf16_f32 v164, v208, v209
  v_exp_f32 v211, v107
  v_add_f32 v225, v225, v210
  v_exp_f32 v212, v108
  v_add_f32 v225, v225, v211
  v_cvt_pk_bf16_f32 v165, v210, v211
  v_exp_f32 v213, v109
  v_add_f32 v225, v225, v212
  v_exp_f32 v214, v110
  v_add_f32 v225, v225, v213
  v_cvt_pk_bf16_f32 v166, v212, v213
  v_exp_f32 v215, v111
  v_add_f32 v225, v225, v214
  s_nop 0
  v_add_f32 v225, v225, v215
  v_cvt_pk_bf16_f32 v167, v214, v215
  s_nop 1
  s_setpc_b64 s[76:77]
fa_rare01:
  s_nop 7
  v_max3_f32 v16, v112, v113, v114
  v_max3_f32 v16, v16, v115, v116
  v_max3_f32 v16, v16, v117, v118
  v_max3_f32 v16, v16, v119, 0
  v_mov_b32 v18, v16
  s_nop 1
  v_permlane16_swap_b32 v16, v18
  v_max_f32 v16, v16, v18
  v_mov_b32 v18, v16
  s_nop 1
  v_permlane32_swap_b32 v16, v18
  v_max_f32 v16, v16, v18
  v_sub_f32 v112, v112, v16
  v_sub_f32 v96, v96, v16
  v_sub_f32 v113, v113, v16
  v_sub_f32 v97, v97, v16
  v_sub_f32 v114, v114, v16
  v_sub_f32 v98, v98, v16
  v_sub_f32 v115, v115, v16
  v_sub_f32 v99, v99, v16
  v_sub_f32 v116, v116, v16
  v_sub_f32 v100, v100, v16
  v_sub_f32 v117, v117, v16
  v_sub_f32 v101, v101, v16
  v_sub_f32 v118, v118, v16
  v_sub_f32 v102, v102, v16
  v_sub_f32 v119, v119, v16
  v_sub_f32 v103, v103, v16
  v_max3_f32 v17, v120, v121, v122
  v_max3_f32 v17, v17, v123, v124
  v_max3_f32 v17, v17, v125, v126
  v_max3_f32 v17, v17, v127, 0
  v_mov_b32 v18, v17
  s_nop 1
  v_permlane16_swap_b32 v17, v18
  v_max_f32 v17, v17, v18
  v_mov_b32 v18, v17
  s_nop 1
  v_permlane32_swap_b32 v17, v18
  v_max_f32 v17, v17, v18
  v_sub_f32 v120, v120, v17
  v_sub_f32 v104, v104, v17
  v_sub_f32 v121, v121, v17
  v_sub_f32 v105, v105, v17
  v_sub_f32 v122, v122, v17
  v_sub_f32 v106, v106, v17
  v_sub_f32 v123, v123, v17
  v_sub_f32 v107, v107, v17
  v_sub_f32 v124, v124, v17
  v_sub_f32 v108, v108, v17
  v_sub_f32 v125, v125, v17
  v_sub_f32 v109, v109, v17
  v_sub_f32 v126, v126, v17
  v_sub_f32 v110, v110, v17
  v_sub_f32 v127, v127, v17
  v_sub_f32 v111, v111, v17
  s_call_b64 s[78:79], fa_resc0
  v_exp_f32 v208, v112
  v_exp_f32 v209, v113
  v_exp_f32 v210, v114
  v_add_f32 v224, v208, v209
  v_cvt_pk_bf16_f32 v168, v208, v209
  v_exp_f32 v211, v115
  v_add_f32 v224, v224, v210
  v_exp_f32 v212, v116
  v_add_f32 v224, v224, v211
  v_cvt_pk_bf16_f32 v169, v210, v211
  v_exp_f32 v213, v117
  v_add_f32 v224, v224, v212
  v_exp_f32 v214, v118
  v_add_f32 v224, v224, v213
  v_cvt_pk_bf16_f32 v170, v212, v213
  v_exp_f32 v215, v119
  v_add_f32 v224, v224, v214
  v_exp_f32 v208, v120
  v_add_f32 v224, v224, v215
  v_cvt_pk_bf16_f32 v171, v214, v215
  v_exp_f32 v209, v121
  v_exp_f32 v210, v122
  v_add_f32 v225, v208, v209
  v_cvt_pk_bf16_f32 v172, v208, v209
  v_exp_f32 v211, v123
  v_add_f32 v225, v225, v210
  v_exp_f32 v212, v124
  v_add_f32 v225, v225, v211
  v_cvt_pk_bf16_f32 v173, v210, v211
  v_exp_f32 v213, v125
  v_add_f32 v225, v225, v212
  v_exp_f32 v214, v126
  v_add_f32 v225, v225, v213
  v_cvt_pk_bf16_f32 v174, v212, v213
  v_exp_f32 v215, v127
  v_add_f32 v225, v225, v214
  s_nop 0
  v_add_f32 v225, v225, v215
  v_cvt_pk_bf16_f32 v175, v214, v215
  s_nop 1
  s_setpc_b64 s[76:77]
fa_resc0:
  v_sub_f32 v192, v192, v16
  v_sub_f32 v193, v193, v16
  v_sub_f32 v194, v194, v16
  v_sub_f32 v195, v195, v16
  v_exp_f32 v18, -v16
  v_sub_f32 v196, v196, v17
  v_sub_f32 v197, v197, v17
  v_sub_f32 v198, v198, v17
  v_sub_f32 v199, v199, v17
  v_exp_f32 v19, -v17
  s_nop 0
  v_mul_f32 v228, v228, v18
  v_mul_f32 v229, v229, v19
  v_accvgpr_read_b32 v20, a0
  v_accvgpr_read_b32 v21, a1
  v_accvgpr_read_b32 v22, a2
  v_accvgpr_read_b32 v23, a3
  v_mul_f32 v20, v20, v18
  v_mul_f32 v21, v21, v18
  v_mul_f32 v22, v22, v18
  v_mul_f32 v23, v23, v18
  v_accvgpr_write_b32 a0, v20
  v_accvgpr_write_b32 a1, v21
  v_accvgpr_write_b32 a2, v22
  v_accvgpr_write_b32 a3, v23
  v_accvgpr_read_b32 v20, a4
  v_accvgpr_read_b32 v21, a5
  v_accvgpr_read_b32 v22, a6
  v_accvgpr_read_b32 v23, a7
  v_mul_f32 v20, v20, v19
  v_mul_f32 v21, v21, v19
  v_mul_f32 v22, v22, v19
  v_mul_f32 v23, v23, v19
  v_accvgpr_write_b32 a4, v20
  v_accvgpr_write_b32 a5, v21
  v_accvgpr_write_b32 a6, v22
  v_accvgpr_write_b32 a7, v23
  v_accvgpr_read_b32 v20, a8
  v_accvgpr_read_b32 v21, a9
  v_accvgpr_read_b32 v22, a10
  v_accvgpr_read_b32 v23, a11
  v_mul_f32 v20, v20, v18
  v_mul_f32 v21, v21, v18
  v_mul_f32 v22, v22, v18
  v_mul_f32 v23, v23, v18
  v_accvgpr_write_b32 a8, v20
  v_accvgpr_write_b32 a9, v21
  v_accvgpr_write_b32 a10, v22
  v_accvgpr_write_b32 a11, v23
  v_accvgpr_read_b32 v20, a12
  v_accvgpr_read_b32 v21, a13
  v_accvgpr_read_b32 v22, a14
  v_accvgpr_read_b32 v23, a15
  v_mul_f32 v20, v20, v19
  v_mul_f32 v21, v21, v19
  v_mul_f32 v22, v22, v19
  v_mul_f32 v23, v23, v19
  v_accvgpr_write_b32 a12, v20
  v_accvgpr_write_b32 a13, v21
  v_accvgpr_write_b32 a14, v22
  v_accvgpr_write_b32 a15, v23
  v_accvgpr_read_b32 v20, a16
  v_accvgpr_read_b32 v21, a17
  v_accvgpr_read_b32 v22, a18
  v_accvgpr_read_b32 v23, a19
  v_mul_f32 v20, v20, v18
  v_mul_f32 v21, v21, v18
  v_mul_f32 v22, v22, v18
  v_mul_f32 v23, v23, v18
  v_accvgpr_write_b32 a16, v20
  v_accvgpr_write_b32 a17, v21
  v_accvgpr_write_b32 a18, v22
  v_accvgpr_write_b32 a19, v23
  v_accvgpr_read_b32 v20, a20
  v_accvgpr_read_b32 v21, a21
  v_accvgpr_read_b32 v22, a22
  v_accvgpr_read_b32 v23, a23
  v_mul_f32 v20, v20, v19
  v_mul_f32 v21, v21, v19
  v_mul_f32 v22, v22, v19
  v_mul_f32 v23, v23, v19
  v_accvgpr_write_b32 a20, v20
  v_accvgpr_write_b32 a21, v21
  v_accvgpr_write_b32 a22, v22
  v_accvgpr_write_b32 a23, v23
  v_accvgpr_read_b32 v20, a24
  v_accvgpr_read_b32 v21, a25
  v_accvgpr_read_b32 v22, a26
  v_accvgpr_read_b32 v23, a27
  v_mul_f32 v20, v20, v18
  v_mul_f32 v21, v21, v18
  v_mul_f32 v22, v22, v18
  v_mul_f32 v23, v23, v18
  v_accvgpr_write_b32 a24, v20
  v_accvgpr_write_b32 a25, v21
  v_accvgpr_write_b32 a26, v22
  v_accvgpr_write_b32 a27, v23
  v_accvgpr_read_b32 v20, a28
  v_accvgpr_read_b32 v21, a29
  v_accvgpr_read_b32 v22, a30
  v_accvgpr_read_b32 v23, a31
  v_mul_f32 v20, v20, v19
  v_mul_f32 v21, v21, v19
  v_mul_f32 v22, v22, v19
  v_mul_f32 v23, v23, v19
  v_accvgpr_write_b32 a28, v20
  v_accvgpr_write_b32 a29, v21
  v_accvgpr_write_b32 a30, v22
  v_accvgpr_write_b32 a31, v23
  v_accvgpr_read_b32 v20, a32
  v_accvgpr_read_b32 v21, a33
  v_accvgpr_read_b32 v22, a34
  v_accvgpr_read_b32 v23, a35
  v_mul_f32 v20, v20, v18
  v_mul_f32 v21, v21, v18
  v_mul_f32 v22, v22, v18
  v_mul_f32 v23, v23, v18
  v_accvgpr_write_b32 a32, v20
  v_accvgpr_write_b32 a33, v21
  v_accvgpr_write_b32 a34, v22
  v_accvgpr_write_b32 a35, v23
  v_accvgpr_read_b32 v20, a36
  v_accvgpr_read_b32 v21, a37
  v_accvgpr_read_b32 v22, a38
  v_accvgpr_read_b32 v23, a39
  v_mul_f32 v20, v20, v19
  v_mul_f32 v21, v21, v19
  v_mul_f32 v22, v22, v19
  v_mul_f32 v23, v23, v19
  v_accvgpr_write_b32 a36, v20
  v_accvgpr_write_b32 a37, v21
  v_accvgpr_write_b32 a38, v22
  v_accvgpr_write_b32 a39, v23
  v_accvgpr_read_b32 v20, a40
  v_accvgpr_read_b32 v21, a41
  v_accvgpr_read_b32 v22, a42
  v_accvgpr_read_b32 v23, a43
  v_mul_f32 v20, v20, v18
  v_mul_f32 v21, v21, v18
  v_mul_f32 v22, v22, v18
  v_mul_f32 v23, v23, v18
  v_accvgpr_write_b32 a40, v20
  v_accvgpr_write_b32 a41, v21
  v_accvgpr_write_b32 a42, v22
  v_accvgpr_write_b32 a43, v23
  v_accvgpr_read_b32 v20, a44
  v_accvgpr_read_b32 v21, a45
  v_accvgpr_read_b32 v22, a46
  v_accvgpr_read_b32 v23, a47
  v_mul_f32 v20, v20, v19
  v_mul_f32 v21, v21, v19
  v_mul_f32 v22, v22, v19
  v_mul_f32 v23, v23, v19
  v_accvgpr_write_b32 a44, v20
  v_accvgpr_write_b32 a45, v21
  v_accvgpr_write_b32 a46, v22
  v_accvgpr_write_b32 a47, v23
  v_accvgpr_read_b32 v20, a48
  v_accvgpr_read_b32 v21, a49
  v_accvgpr_read_b32 v22, a50
  v_accvgpr_read_b32 v23, a51
  v_mul_f32 v20, v20, v18
  v_mul_f32 v21, v21, v18
  v_mul_f32 v22, v22, v18
  v_mul_f32 v23, v23, v18
  v_accvgpr_write_b32 a48, v20
  v_accvgpr_write_b32 a49, v21
  v_accvgpr_write_b32 a50, v22
  v_accvgpr_write_b32 a51, v23
  v_accvgpr_read_b32 v20, a52
  v_accvgpr_read_b32 v21, a53
  v_accvgpr_read_b32 v22, a54
  v_accvgpr_read_b32 v23, a55
  v_mul_f32 v20, v20, v19
  v_mul_f32 v21, v21, v19
  v_mul_f32 v22, v22, v19
  v_mul_f32 v23, v23, v19
  v_accvgpr_write_b32 a52, v20
  v_accvgpr_write_b32 a53, v21
  v_accvgpr_write_b32 a54, v22
  v_accvgpr_write_b32 a55, v23
  v_accvgpr_read_b32 v20, a56
  v_accvgpr_read_b32 v21, a57
  v_accvgpr_read_b32 v22, a58
  v_accvgpr_read_b32 v23, a59
  v_mul_f32 v20, v20, v18
  v_mul_f32 v21, v21, v18
  v_mul_f32 v22, v22, v18
  v_mul_f32 v23, v23, v18
  v_accvgpr_write_b32 a56, v20
  v_accvgpr_write_b32 a57, v21
  v_accvgpr_write_b32 a58, v22
  v_accvgpr_write_b32 a59, v23
  v_accvgpr_read_b32 v20, a60
  v_accvgpr_read_b32 v21, a61
  v_accvgpr_read_b32 v22, a62
  v_accvgpr_read_b32 v23, a63
  v_mul_f32 v20, v20, v19
  v_mul_f32 v21, v21, v19
  v_mul_f32 v22, v22, v19
  v_mul_f32 v23, v23, v19
  v_accvgpr_write_b32 a60, v20
  v_accvgpr_write_b32 a61, v21
  v_accvgpr_write_b32 a62, v22
  v_accvgpr_write_b32 a63, v23
  s_setpc_b64 s[78:79]
fa_rare10:
  s_nop 7
  v_max3_f32 v16, v128, v129, v130
  v_max3_f32 v16, v16, v131, v132
  v_max3_f32 v16, v16, v133, v134
  v_max3_f32 v16, v16, v135, 0
  v_mov_b32 v18, v16
  s_nop 1
  v_permlane16_swap_b32 v16, v18
  v_max_f32 v16, v16, v18
  v_mov_b32 v18, v16
  s_nop 1
  v_permlane32_swap_b32 v16, v18
  v_max_f32 v16, v16, v18
  v_sub_f32 v128, v128, v16
  v_sub_f32 v144, v144, v16
  v_sub_f32 v129, v129, v16
  v_sub_f32 v145, v145, v16
  v_sub_f32 v130, v130, v16
  v_sub_f32 v146, v146, v16
  v_sub_f32 v131, v131, v16
  v_sub_f32 v147, v147, v16
  v_sub_f32 v132, v132, v16
  v_sub_f32 v148, v148, v16
  v_sub_f32 v133, v133, v16
  v_sub_f32 v149, v149, v16
  v_sub_f32 v134, v134, v16
  v_sub_f32 v150, v150, v16
  v_sub_f32 v135, v135, v16
  v_sub_f32 v151, v151, v16
  v_max3_f32 v17, v136, v137, v138
  v_max3_f32 v17, v17, v139, v140
  v_max3_f32 v17, v17, v141, v142
  v_max3_f32 v17, v17, v143, 0
  v_mov_b32 v18, v17
  s_nop 1
  v_permlane16_swap_b32 v17, v18
  v_max_f32 v17, v17, v18
  v_mov_b32 v18, v17
  s_nop 1
  v_permlane32_swap_b32 v17, v18
  v_max_f32 v17, v17, v18
  v_sub_f32 v136, v136, v17
  v_sub_f32 v152, v152, v17
  v_sub_f32 v137, v137, v17
  v_sub_f32 v153, v153, v17
  v_sub_f32 v138, v138, v17
  v_sub_f32 v154, v154, v17
  v_sub_f32 v139, v139, v17
  v_sub_f32 v155, v155, v17
  v_sub_f32 v140, v140, v17
  v_sub_f32 v156, v156, v17
  v_sub_f32 v141, v141, v17
  v_sub_f32 v157, v157, v17
  v_sub_f32 v142, v142, v17
  v_sub_f32 v158, v158, v17
  v_sub_f32 v143, v143, v17
  v_sub_f32 v159, v159, v17
  s_call_b64 s[78:79], fa_resc1
  v_exp_f32 v216, v128
  v_exp_f32 v217, v129
  v_exp_f32 v218, v130
  v_add_f32 v226, v216, v217
  v_cvt_pk_bf16_f32 v176, v216, v217
  v_exp_f32 v219, v131
  v_add_f32 v226, v226, v218
  v_exp_f32 v220, v132
  v_add_f32 v226, v226, v219
  v_cvt_pk_bf16_f32 v177, v218, v219
  v_exp_f32 v221, v133
  v_add_f32 v226, v226, v220
  v_exp_f32 v222, v134
  v_add_f32 v226, v226, v221
  v_cvt_pk_bf16_f32 v178, v220, v221
  v_exp_f32 v223, v135
  v_add_f32 v226, v226, v222
  v_exp_f32 v216, v136
  v_add_f32 v226, v226, v223
  v_cvt_pk_bf16_f32 v179, v222, v223
  v_exp_f32 v217, v137
  v_exp_f32 v218, v138
  v_add_f32 v227, v216, v217
  v_cvt_pk_bf16_f32 v180, v216, v217
  v_exp_f32 v219, v139
  v_add_f32 v227, v227, v218
  v_exp_f32 v220, v140
  v_add_f32 v227, v227, v219
  v_cvt_pk_bf16_f32 v181, v218, v219
  v_exp_f32 v221, v141
  v_add_f32 v227, v227, v220
  v_exp_f32 v222, v142
  v_add_f32 v227, v227, v221
  v_cvt_pk_bf16_f32 v182, v220, v221
  v_exp_f32 v223, v143
  v_add_f32 v227, v227, v222
  s_nop 0
  v_add_f32 v227, v227, v223
  v_cvt_pk_bf16_f32 v183, v222, v223
  v_exp_f32 v216, v144
  s_nop 1
  s_setpc_b64 s[76:77]
fa_rare11:
  s_nop 7
  v_max3_f32 v16, v144, v145, v146
  v_max3_f32 v16, v16, v147, v148
  v_max3_f32 v16, v16, v149, v150
  v_max3_f32 v16, v16, v151, 0
  v_mov_b32 v18, v16
  s_nop 1
  v_permlane16_swap_b32 v16, v18
  v_max_f32 v16, v16, v18
  v_mov_b32 v18, v16
  s_nop 1
  v_permlane32_swap_b32 v16, v18
  v_max_f32 v16, v16, v18
  v_sub_f32 v144, v144, v16
  v_sub_f32 v128, v128, v16
  v_sub_f32 v145, v145, v16
  v_sub_f32 v129, v129, v16
  v_sub_f32 v146, v146, v16
  v_sub_f32 v130, v130, v16
  v_sub_f32 v147, v147, v16
  v_sub_f32 v131, v131, v16
  v_sub_f32 v148, v148, v16
  v_sub_f32 v132, v132, v16
  v_sub_f32 v149, v149, v16
  v_sub_f32 v133, v133, v16
  v_sub_f32 v150, v150, v16
  v_sub_f32 v134, v134, v16
  v_sub_f32 v151, v151, v16
  v_sub_f32 v135, v135, v16
  v_max3_f32 v17, v152, v153, v154
  v_max3_f32 v17, v17, v155, v156
  v_max3_f32 v17, v17, v157, v158
  v_max3_f32 v17, v17, v159, 0
  v_mov_b32 v18, v17
  s_nop 1
  v_permlane16_swap_b32 v17, v18
  v_max_f32 v17, v17, v18
  v_mov_b32 v18, v17
  s_nop 1
  v_permlane32_swap_b32 v17, v18
  v_max_f32 v17, v17, v18
  v_sub_f32 v152, v152, v17
  v_sub_f32 v136, v136, v17
  v_sub_f32 v153, v153, v17
  v_sub_f32 v137, v137, v17
  v_sub_f32 v154, v154, v17
  v_sub_f32 v138, v138, v17
  v_sub_f32 v155, v155, v17
  v_sub_f32 v139, v139, v17
  v_sub_f32 v156, v156, v17
  v_sub_f32 v140, v140, v17
  v_sub_f32 v157, v157, v17
  v_sub_f32 v141, v141, v17
  v_sub_f32 v158, v158, v17
  v_sub_f32 v142, v142, v17
  v_sub_f32 v159, v159, v17
  v_sub_f32 v143, v143, v17
  s_call_b64 s[78:79], fa_resc1
  v_exp_f32 v216, v144
  v_exp_f32 v217, v145
  v_exp_f32 v218, v146
  v_add_f32 v226, v216, v217
  v_cvt_pk_bf16_f32 v184, v216, v217
  v_exp_f32 v219, v147
  v_add_f32 v226, v226, v218
  v_exp_f32 v220, v148
  v_add_f32 v226, v226, v219
  v_cvt_pk_bf16_f32 v185, v218, v219
  v_exp_f32 v221, v149
  v_add_f32 v226, v226, v220
  v_exp_f32 v222, v150
  v_add_f32 v226, v226, v221
  v_cvt_pk_bf16_f32 v186, v220, v221
  v_exp_f32 v223, v151
  v_add_f32 v226, v226, v222
  v_exp_f32 v216, v152
  v_add_f32 v226, v226, v223
  v_cvt_pk_bf16_f32 v187, v222, v223
  v_exp_f32 v217, v153
  v_exp_f32 v218, v154
  v_add_f32 v227, v216, v217
  v_cvt_pk_bf16_f32 v188, v216, v217
  v_exp_f32 v219, v155
  v_add_f32 v227, v227, v218
  v_exp_f32 v220, v156
  v_add_f32 v227, v227, v219
  v_cvt_pk_bf16_f32 v189, v218, v219
  v_exp_f32 v221, v157
  v_add_f32 v227, v227, v220
  v_exp_f32 v222, v158
  v_add_f32 v227, v227, v221
  v_cvt_pk_bf16_f32 v190, v220, v221
  v_exp_f32 v223, v159
  v_add_f32 v227, v227, v222
  s_nop 0
  v_add_f32 v227, v227, v223
  v_cvt_pk_bf16_f32 v191, v222, v223
  v_exp_f32 v216, v128
  s_nop 1
  s_setpc_b64 s[76:77]
fa_resc1:
  v_sub_f32 v200, v200, v16
  v_sub_f32 v201, v201, v16
  v_sub_f32 v202, v202, v16
  v_sub_f32 v203, v203, v16
  v_exp_f32 v18, -v16
  v_sub_f32 v204, v204, v17
  v_sub_f32 v205, v205, v17
  v_sub_f32 v206, v206, v17
  v_sub_f32 v207, v207, v17
  v_exp_f32 v19, -v17
  s_nop 0
  v_mul_f32 v230, v230, v18
  v_mul_f32 v231, v231, v19
  v_accvgpr_read_b32 v20, a64
  v_accvgpr_read_b32 v21, a65
  v_accvgpr_read_b32 v22, a66
  v_accvgpr_read_b32 v23, a67
  v_mul_f32 v20, v20, v18
  v_mul_f32 v21, v21, v18
  v_mul_f32 v22, v22, v18
  v_mul_f32 v23, v23, v18
  v_accvgpr_write_b32 a64, v20
  v_accvgpr_write_b32 a65, v21
  v_accvgpr_write_b32 a66, v22
  v_accvgpr_write_b32 a67, v23
  v_accvgpr_read_b32 v20, a68
  v_accvgpr_read_b32 v21, a69
  v_accvgpr_read_b32 v22, a70
  v_accvgpr_read_b32 v23, a71
  v_mul_f32 v20, v20, v19
  v_mul_f32 v21, v21, v19
  v_mul_f32 v22, v22, v19
  v_mul_f32 v23, v23, v19
  v_accvgpr_write_b32 a68, v20
  v_accvgpr_write_b32 a69, v21
  v_accvgpr_write_b32 a70, v22
  v_accvgpr_write_b32 a71, v23
  v_accvgpr_read_b32 v20, a72
  v_accvgpr_read_b32 v21, a73
  v_accvgpr_read_b32 v22, a74
  v_accvgpr_read_b32 v23, a75
  v_mul_f32 v20, v20, v18
  v_mul_f32 v21, v21, v18
  v_mul_f32 v22, v22, v18
  v_mul_f32 v23, v23, v18
  v_accvgpr_write_b32 a72, v20
  v_accvgpr_write_b32 a73, v21
  v_accvgpr_write_b32 a74, v22
  v_accvgpr_write_b32 a75, v23
  v_accvgpr_read_b32 v20, a76
  v_accvgpr_read_b32 v21, a77
  v_accvgpr_read_b32 v22, a78
  v_accvgpr_read_b32 v23, a79
  v_mul_f32 v20, v20, v19
  v_mul_f32 v21, v21, v19
  v_mul_f32 v22, v22, v19
  v_mul_f32 v23, v23, v19
  v_accvgpr_write_b32 a76, v20
  v_accvgpr_write_b32 a77, v21
  v_accvgpr_write_b32 a78, v22
  v_accvgpr_write_b32 a79, v23
  v_accvgpr_read_b32 v20, a80
  v_accvgpr_read_b32 v21, a81
  v_accvgpr_read_b32 v22, a82
  v_accvgpr_read_b32 v23, a83
  v_mul_f32 v20, v20, v18
  v_mul_f32 v21, v21, v18
  v_mul_f32 v22, v22, v18
  v_mul_f32 v23, v23, v18
  v_accvgpr_write_b32 a80, v20
  v_accvgpr_write_b32 a81, v21
  v_accvgpr_write_b32 a82, v22
  v_accvgpr_write_b32 a83, v23
  v_accvgpr_read_b32 v20, a84
  v_accvgpr_read_b32 v21, a85
  v_accvgpr_read_b32 v22, a86
  v_accvgpr_read_b32 v23, a87
  v_mul_f32 v20, v20, v19
  v_mul_f32 v21, v21, v19
  v_mul_f32 v22, v22, v19
  v_mul_f32 v23, v23, v19
  v_accvgpr_write_b32 a84, v20
  v_accvgpr_write_b32 a85, v21
  v_accvgpr_write_b32 a86, v22
  v_accvgpr_write_b32 a87, v23
  v_accvgpr_read_b32 v20, a88
  v_accvgpr_read_b32 v21, a89
  v_accvgpr_read_b32 v22, a90
  v_accvgpr_read_b32 v23, a91
  v_mul_f32 v20, v20, v18
  v_mul_f32 v21, v21, v18
  v_mul_f32 v22, v22, v18
  v_mul_f32 v23, v23, v18
  v_accvgpr_write_b32 a88, v20
  v_accvgpr_write_b32 a89, v21
  v_accvgpr_write_b32 a90, v22
  v_accvgpr_write_b32 a91, v23
  v_accvgpr_read_b32 v20, a92
  v_accvgpr_read_b32 v21, a93
  v_accvgpr_read_b32 v22, a94
  v_accvgpr_read_b32 v23, a95
  v_mul_f32 v20, v20, v19
  v_mul_f32 v21, v21, v19
  v_mul_f32 v22, v22, v19
  v_mul_f32 v23, v23, v19
  v_accvgpr_write_b32 a92, v20
  v_accvgpr_write_b32 a93, v21
  v_accvgpr_write_b32 a94, v22
  v_accvgpr_write_b32 a95, v23
  v_accvgpr_read_b32 v20, a96
  v_accvgpr_read_b32 v21, a97
  v_accvgpr_read_b32 v22, a98
  v_accvgpr_read_b32 v23, a99
  v_mul_f32 v20, v20, v18
  v_mul_f32 v21, v21, v18
  v_mul_f32 v22, v22, v18
  v_mul_f32 v23, v23, v18
  v_accvgpr_write_b32 a96, v20
  v_accvgpr_write_b32 a97, v21
  v_accvgpr_write_b32 a98, v22
  v_accvgpr_write_b32 a99, v23
  v_accvgpr_read_b32 v20, a100
  v_accvgpr_read_b32 v21, a101
  v_accvgpr_read_b32 v22, a102
  v_accvgpr_read_b32 v23, a103
  v_mul_f32 v20, v20, v19
  v_mul_f32 v21, v21, v19
  v_mul_f32 v22, v22, v19
  v_mul_f32 v23, v23, v19
  v_accvgpr_write_b32 a100, v20
  v_accvgpr_write_b32 a101, v21
  v_accvgpr_write_b32 a102, v22
  v_accvgpr_write_b32 a103, v23
  v_accvgpr_read_b32 v20, a104
  v_accvgpr_read_b32 v21, a105
  v_accvgpr_read_b32 v22, a106
  v_accvgpr_read_b32 v23, a107
  v_mul_f32 v20, v20, v18
  v_mul_f32 v21, v21, v18
  v_mul_f32 v22, v22, v18
  v_mul_f32 v23, v23, v18
  v_accvgpr_write_b32 a104, v20
  v_accvgpr_write_b32 a105, v21
  v_accvgpr_write_b32 a106, v22
  v_accvgpr_write_b32 a107, v23
  v_accvgpr_read_b32 v20, a108
  v_accvgpr_read_b32 v21, a109
  v_accvgpr_read_b32 v22, a110
  v_accvgpr_read_b32 v23, a111
  v_mul_f32 v20, v20, v19
  v_mul_f32 v21, v21, v19
  v_mul_f32 v22, v22, v19
  v_mul_f32 v23, v23, v19
  v_accvgpr_write_b32 a108, v20
  v_accvgpr_write_b32 a109, v21
  v_accvgpr_write_b32 a110, v22
  v_accvgpr_write_b32 a111, v23
  v_accvgpr_read_b32 v20, a112
  v_accvgpr_read_b32 v21, a113
  v_accvgpr_read_b32 v22, a114
  v_accvgpr_read_b32 v23, a115
  v_mul_f32 v20, v20, v18
  v_mul_f32 v21, v21, v18
  v_mul_f32 v22, v22, v18
  v_mul_f32 v23, v23, v18
  v_accvgpr_write_b32 a112, v20
  v_accvgpr_write_b32 a113, v21
  v_accvgpr_write_b32 a114, v22
  v_accvgpr_write_b32 a115, v23
  v_accvgpr_read_b32 v20, a116
  v_accvgpr_read_b32 v21, a117
  v_accvgpr_read_b32 v22, a118
  v_accvgpr_read_b32 v23, a119
  v_mul_f32 v20, v20, v19
  v_mul_f32 v21, v21, v19
  v_mul_f32 v22, v22, v19
  v_mul_f32 v23, v23, v19
  v_accvgpr_write_b32 a116, v20
  v_accvgpr_write_b32 a117, v21
  v_accvgpr_write_b32 a118, v22
  v_accvgpr_write_b32 a119, v23
  v_accvgpr_read_b32 v20, a120
  v_accvgpr_read_b32 v21, a121
  v_accvgpr_read_b32 v22, a122
  v_accvgpr_read_b32 v23, a123
  v_mul_f32 v20, v20, v18
  v_mul_f32 v21, v21, v18
  v_mul_f32 v22, v22, v18
  v_mul_f32 v23, v23, v18
  v_accvgpr_write_b32 a120, v20
  v_accvgpr_write_b32 a121, v21
  v_accvgpr_write_b32 a122, v22
  v_accvgpr_write_b32 a123, v23
  v_accvgpr_read_b32 v20, a124
  v_accvgpr_read_b32 v21, a125
  v_accvgpr_read_b32 v22, a126
  v_accvgpr_read_b32 v23, a127
  v_mul_f32 v20, v20, v19
  v_mul_f32 v21, v21, v19
  v_mul_f32 v22, v22, v19
  v_mul_f32 v23, v23, v19
  v_accvgpr_write_b32 a124, v20
  v_accvgpr_write_b32 a125, v21
  v_accvgpr_write_b32 a126, v22
  v_accvgpr_write_b32 a127, v23
  s_setpc_b64 s[78:79]
.section .rodata,"a"
.p2align 6
.amdhsa_kernel fa_kernel
  .amdhsa_next_free_vgpr 512
  .amdhsa_next_free_sgpr 102
  .amdhsa_accum_offset 256
  .amdhsa_group_segment_fixed_size 0
  .amdhsa_kernarg_size 112
  .amdhsa_user_sgpr_count 2
  .amdhsa_user_sgpr_kernarg_segment_ptr 1
  .amdhsa_system_sgpr_workgroup_id_x 1
  .amdhsa_float_denorm_mode_32 3
.end_amdhsa_kernel
.text
```

```asm
; @launch kernel=fa_kernel grid=(256,1,1) block=(256,1,1) lds=163840
.amdgcn_target "amdgcn-amd-amdhsa--gfx950"
.text
.globl fa_kernel
.p2align 8
.type fa_kernel,@function
fa_kernel:
  s_cmp_ge_u32 s2, 256
  s_cbranch_scc1 fa_end
  s_getpc_b64 s[62:63]
  v_and_b32 v230, 127, v0
  v_lshlrev_b32 v230, 7, v230
  global_load_dword v231, v230, s[62:63]
  s_load_dwordx4 s[4:7], s[0:1], 0
  s_load_dwordx4 s[8:11], s[0:1], 24
  s_load_dwordx2 s[14:15], s[0:1], 56
  s_load_dwordx2 s[12:13], s[0:1], 40
  s_load_dwordx4 s[16:19], s[0:1], 96
  s_load_dwordx2 s[60:61], s[0:1], 16
  v_lshrrev_b32 v16, 6, v0
  v_and_b32 v1, 63, v0
  v_readfirstlane_b32 s20, v16
  s_and_b32 s21, s2, 7
  s_lshl_b32 s21, s21, 2
  s_lshr_b32 s23, s2, 3
  s_and_b32 s23, s23, 3
  s_add_u32 s21, s21, s23
  s_lshr_b32 s22, s2, 5
  v_and_b32 v208, 31, v1
  v_lshrrev_b32 v209, 5, v1
  s_lshl_b32 s31, s2, 2
  s_add_u32 s31, s31, s20
  s_lshl_b32 s31, s31, 1
  v_add_u32 v209, s31, v209
  v_lshlrev_b32 v212, 4, v208
  v_mul_u32_u24 v210, 1280, v209
  v_add_u32 v210, v210, v212
  v_cmp_gt_u32 s[64:65], 16, v208
  v_mov_b32 v19, 1073741824
  v_and_b32 v220, 7, v209
  v_cndmask_b32 v211, v19, v210, s[64:65]
  v_bfe_u32 v17, v1, 1, 3
  v_lshlrev_b32 v17, 13, v17
  v_and_b32 v18, 1, v1
  v_lshl_add_u32 v235, v18, 7, v17
  s_lshl_b32 s74, s22, 1
  s_and_b32 s31, s20, 1
  s_add_u32 s74, s74, s31
  s_lshl_b32 s74, s74, 16
  s_mov_b32 s73, 1048576
  v_and_b32 v16, 15, v1
  v_lshlrev_b32 v17, 10, v16
  v_and_b32 v18, 16, v1
  v_lshl_add_u32 v233, v18, 3, v17
  s_lshl_b32 s30, s23, 5
  s_add_u32 s30, s30, s20
  s_lshl_b32 s30, s30, 14
  s_lshl_b32 s29, s22, 16
  s_lshl_b32 s23, s21, 8
  s_cmp_ge_u32 s20, 2
  s_waitcnt lgkmcnt(0)
  s_mov_b32 s44, s4
  s_mov_b32 s45, s5
  s_mov_b32 s46, 2621440
  s_mov_b32 s47, 0x20000
  s_mov_b32 s68, s14
  s_mov_b32 s69, s15
  s_mov_b32 s70, 1280
  s_mov_b32 s71, 0x20000
  buffer_load_dwordx4 v[160:163], v210, s[44:47], 0 offen
  buffer_load_dwordx4 v[164:167], v210, s[44:47], 0 offen offset:512
  buffer_load_dwordx4 v[168:171], v211, s[44:47], 0 offen offset:1024
  buffer_load_dwordx4 v[172:175], v212, s[68:71], 0 offen offset:0
  buffer_load_dwordx4 v[176:179], v212, s[68:71], 0 offen offset:512
  buffer_load_dwordx4 v[180:183], v212, s[68:71], 0 offen offset:1024
  s_cselect_b32 s62, s10, s8
  s_cselect_b32 s63, s11, s9
  s_add_u32 s62, s62, s23
  s_addc_u32 s63, s63, 0
  s_mov_b32 s36, s62
  s_mov_b32 s37, s63
  s_mov_b32 s38, 0
  s_mov_b32 s39, 0x20000
  s_sub_u32 s38, 4194304, s23
  buffer_load_dword v231, v235, s[36:39], s74 offen
  s_add_u32 s6, s6, s29
  s_addc_u32 s7, s7, 0
  s_mov_b32 s32, s6
  s_mov_b32 s33, s7
  s_mov_b32 s34, 0
  s_mov_b32 s35, 0x20000
  s_sub_u32 s34, 2097152, s29
  buffer_load_dword v232, v233, s[32:35], s30 offen
  s_add_u32 s74, s74, s73
  buffer_load_dword v231, v235, s[36:39], s74 offen
  buffer_load_dword v232, v233, s[32:35], s30 offen offset:256
  s_getpc_b64 s[8:9]
fa_pc:
  s_lshr_b32 s31, s2, 3
  s_and_b32 s31, s31, 15
  s_lshl_b32 s31, s31, 2
  s_add_u32 s31, s31, s20
  s_lshl_b32 s31, s31, 11
  s_min_u32 s31, s31, fa_codeend-fa_pc-2048
  v_lshlrev_b32 v234, 7, v16
  v_add_u32 v230, s31, v234
  global_load_dword v231, v230, s[8:9]
  s_add_u32 s8, s8, fa_co1-fa_pc-4
  s_addc_u32 s9, s9, 0
  s_add_u32 s60, s60, s23
  s_addc_u32 s61, s61, 0
  s_sub_u32 s75, 5242880, s23
  s_mov_b32 s48, s62
  s_mov_b32 s49, s63
  s_mov_b32 s50, s38
  s_mov_b32 s51, 0x20000
  v_lshlrev_b32 v2, 4, v1
  v_lshrrev_b32 v19, 2, v1
  v_lshrrev_b32 v17, 5, v1
  v_mul_u32_u24 v17, 3, v17
  v_and_b32 v18, 3, v1
  v_xor_b32 v17, v17, v18
  v_lshlrev_b32 v17, 4, v17
  v_lshl_add_u32 v3, v19, 10, v17
  s_lshl_b32 s23, s20, 19
  v_add_u32 v3, s23, v3
  v_add_u32 v4, 15360, v3
  v_add_u32 v5, 30720, v3
  v_add_u32 v6, 46080, v3
  v_and_b32 v19, 3, v19
  v_lshrrev_b32 v17, 4, v1
  v_lshlrev_b32 v17, 6, v17
  v_lshl_add_u32 v19, v19, 13, v17
  s_and_b32 s23, s20, 1
  s_lshl_b32 s23, s23, 17
  v_add_u32 v19, s23, v19
  v_lshl_add_u32 v8, v18, 4, v19
  v_xor_b32 v18, 2, v18
  v_lshl_add_u32 v10, v18, 4, v19
  v_add_u32 v9, 31744, v8
  v_add_u32 v11, 95232, v10
  v_add_u32 v10, 63488, v10
  s_lshl_b32 s24, s20, 12
  s_mov_b32 s26, 0
  s_mov_b32 s27, 0
  s_mov_b32 s25, 262144
  s_mov_b32 s79, 64
  v_and_b32 v235, 0x7fff, v235
  s_sub_u32 s74, s74, s73
  s_lshr_b32 s74, s74, 1
  s_add_u32 s74, s74, 2097152
  s_mov_b32 s73, 524288
  s_mov_b32 s40, s18
  s_mov_b32 s41, s19
  s_mov_b32 s42, 68157440
  s_mov_b32 s43, 0x20000
  s_mov_b32 s52, s12
  s_mov_b32 s53, s13
  s_mov_b32 s54, 5242880
  s_mov_b32 s55, 0x20000
  s_mov_b32 s56, s16
  s_mov_b32 s57, s17
  s_mov_b32 s58, 256
  s_mov_b32 s59, 0x20000
  s_and_b32 s29, s2, 7
  s_lshl_b32 s29, s29, 2
  s_add_u32 s29, s29, s20
  s_lshl_b32 s29, s29, 11
  s_and_b32 s23, s21, 3
  s_lshl_b32 s23, s23, 19
  s_add_u32 s29, s29, s23
  s_mul_i32 s23, s20, 4096
  s_lshl_b32 s31, s21, 7
  s_add_u32 s23, s23, s31
  s_add_u32 s23, s23, 3801088
  s_mul_i32 s31, s22, 16384
  s_add_u32 s80, s23, s31
  s_sub_u32 s31, 245760, s31
  s_add_u32 s3, s23, s31
  s_lshl_b32 s23, s21, 10
  s_lshl_b32 s31, s22, 7
  s_add_u32 s23, s23, s31
  s_add_u32 s82, s23, 67108864
  s_sub_u32 s62, s2, 170
  s_lshl_b32 s31, s20, 6
  s_add_u32 s62, s62, s31
  s_lshl_b32 s62, s62, 7
  s_add_u32 s62, s62, 67174400
  s_sub_u32 s23, s2, 170
  s_cmp_lt_u32 s23, 54
  s_cselect_b32 s62, s62, 1073741824
  s_cmp_eq_u32 s20, 0
  s_cselect_b32 s31, s82, 1073741824
  s_cselect_b32 s77, s2, 1073741824
  s_cmp_eq_u32 s2, 255
  s_cselect_b32 s23, 2629632, 1073741824
  v_lshl_add_u32 v225, v16, 2, s23
  v_mov_b32 v229, 0
  v_writelane_b32 v225, s80, 0
  v_writelane_b32 v225, s3, 1
  v_writelane_b32 v225, s31, 2
  s_add_u32 s31, s31, 32
  v_writelane_b32 v225, s31, 5
  s_and_b32 s23, s2, 1
  s_lshl_b32 s23, s23, 2
  s_add_u32 s23, s23, s20
  s_lshl_b32 s23, s23, 7
  s_lshr_b32 s31, s2, 1
  s_add_u32 s23, s23, s31
  s_lshl_b32 s23, s23, 7
  s_add_u32 s23, s23, 67371008
  v_writelane_b32 v225, s23, 3
  v_writelane_b32 v225, s62, 4
  s_lshl_b32 s23, s2, 2
  s_add_u32 s23, s23, s20
  s_lshl_b32 s23, s23, 7
  s_add_u32 s23, s23, 67239936
  v_writelane_b32 v225, s23, 6
  s_and_b32 s23, s21, 3
  s_lshr_b32 s31, s23, 1
  s_lshl_b32 s31, 4, s31
  s_bitcmp1_b32 s23, 0
  s_cselect_b32 s76, s31, 0
  s_cselect_b32 s72, 0, s31
  s_or_b32 s76, s76, 40
  s_or_b32 s72, s72, 33
  v_mov_b32 v20, 0
  v_mov_b32 v21, 0
  v_mov_b32 v22, 0
  v_mov_b32 v23, 0
  v_lshrrev_b32 v17, 4, v1
  v_lshrrev_b32 v18, 3, v16
  v_mul_u32_u24 v18, 3, v18
  v_xor_b32 v18, v18, v17
  v_lshlrev_b32 v18, 4, v18
  v_lshl_add_u32 v14, v16, 6, v18
  s_and_b32 s23, s20, 1
  s_lshl_b32 s23, s23, 11
  v_add_u32 v14, s23, v14
  v_mfma_f32_32x32x16_bf16 a[0:15], v[20:23], v[20:23], 0
  v_lshrrev_b32 v18, 2, v16
  v_lshlrev_b32 v18, 6, v18
  v_lshl_add_u32 v18, v17, 11, v18
  v_and_b32 v19, 1, v1
  v_mfma_f32_32x32x16_bf16 a[16:31], v[20:23], v[20:23], 0
  v_lshl_add_u32 v18, v19, 3, v18
  v_bfe_u32 v19, v1, 1, 1
  v_and_b32 v17, 1, v17
  v_lshl_or_b32 v19, v17, 1, v19
  v_mfma_f32_32x32x16_bf16 a[32:47], v[20:23], v[20:23], 0
  s_lshr_b32 s23, s20, 1
  s_lshl_b32 s23, s23, 13
  s_add_u32 s23, s23, 16384
  v_add_u32 v18, s23, v18
  v_mfma_f32_32x32x16_bf16 a[48:63], v[20:23], v[20:23], 0
  v_lshl_add_u32 v12, v19, 4, v18
  v_xor_b32 v13, 32, v12
  v_mov_b32 v19, 1073741824
  v_lshlrev_b32 v220, 4, v220
  v_mfma_f32_32x32x16_bf16 a[64:79], v[20:23], v[20:23], 0
  v_lshl_add_u32 v220, v208, 7, v220
  v_add_u32 v220, 131072, v220
  v_lshlrev_b32 v222, 2, v209
  v_cmp_eq_u32 vcc, 0, v208
  v_mfma_f32_32x32x16_bf16 a[80:95], v[20:23], v[20:23], 0
  v_add_u32 v222, 2621440, v222
  v_lshlrev_b32 v221, 4, v0
  v_cndmask_b32 v222, v19, v222, vcc
  v_add_u32 v221, 131072, v221
  v_mfma_f32_32x32x16_bf16 a[96:111], v[20:23], v[20:23], 0
  v_sub_u32 v209, 0xffff, v209
  v_lshrrev_b32 v223, 3, v0
  v_and_b32 v18, 7, v0
  v_lshlrev_b32 v18, 4, v18
  v_mfma_f32_32x32x16_bf16 a[112:127], v[20:23], v[20:23], 0
  v_cmp_gt_u32 vcc, 128, v0
  v_lshl_add_u32 v223, v223, 8, v18
  s_lshr_b32 s66, s2, 1
  s_mul_i32 s66, s66, 20480
  v_mfma_f32_32x32x16_bf16 a[128:143], v[20:23], v[20:23], 0
  s_and_b32 s31, s2, 1
  s_lshl_b32 s31, s31, 7
  s_add_u32 s66, s66, s31
  v_cndmask_b32 v224, v19, v223, vcc
  v_mfma_f32_32x32x16_bf16 a[144:159], v[20:23], v[20:23], 0
  s_add_u32 s67, s66, 8192
  s_add_u32 s78, s66, 16384
  s_mov_b32 s28, 0
  v_mfma_f32_32x32x16_bf16 a[160:175], v[20:23], v[20:23], 0
  v_mfma_f32_32x32x16_bf16 a[176:191], v[20:23], v[20:23], 0
  v_mfma_f32_32x32x16_bf16 a[192:207], v[20:23], v[20:23], 0
  v_mfma_f32_32x32x16_bf16 a[208:223], v[20:23], v[20:23], 0
  v_mfma_f32_32x32x16_bf16 a[224:239], v[20:23], v[20:23], 0
  v_mfma_f32_32x32x16_bf16 a[240:255], v[20:23], v[20:23], 0
  s_waitcnt vmcnt(5)
  v_lshlrev_b32 v184, 16, v160
  v_and_b32 v185, 0xffff0000, v160
  v_lshlrev_b32 v186, 16, v161
  v_and_b32 v187, 0xffff0000, v161
  v_lshlrev_b32 v188, 16, v162
  v_and_b32 v189, 0xffff0000, v162
  v_lshlrev_b32 v190, 16, v163
  v_and_b32 v191, 0xffff0000, v163
  v_lshlrev_b32 v192, 16, v164
  v_and_b32 v193, 0xffff0000, v164
  v_lshlrev_b32 v194, 16, v165
  v_and_b32 v195, 0xffff0000, v165
  v_lshlrev_b32 v196, 16, v166
  v_and_b32 v197, 0xffff0000, v166
  v_lshlrev_b32 v198, 16, v167
  v_and_b32 v199, 0xffff0000, v167
  v_lshlrev_b32 v200, 16, v168
  v_and_b32 v201, 0xffff0000, v168
  v_lshlrev_b32 v202, 16, v169
  v_and_b32 v203, 0xffff0000, v169
  v_lshlrev_b32 v204, 16, v170
  v_and_b32 v205, 0xffff0000, v170
  v_lshlrev_b32 v206, 16, v171
  v_and_b32 v207, 0xffff0000, v171
  v_pk_add_f32 v[16:17], v[184:185], v[186:187]
  v_pk_add_f32 v[18:19], v[188:189], v[190:191]
  v_pk_add_f32 v[16:17], v[16:17], v[192:193]
  v_pk_add_f32 v[18:19], v[18:19], v[194:195]
  v_pk_add_f32 v[16:17], v[16:17], v[196:197]
  v_pk_add_f32 v[18:19], v[18:19], v[198:199]
  v_pk_add_f32 v[16:17], v[16:17], v[200:201]
  v_pk_add_f32 v[18:19], v[18:19], v[202:203]
  v_pk_add_f32 v[16:17], v[16:17], v[204:205]
  v_pk_add_f32 v[18:19], v[18:19], v[206:207]
  v_pk_add_f32 v[16:17], v[16:17], v[18:19]
  v_add_f32 v213, v16, v17
  s_nop 1
  v_add_f32_dpp v213, v213, v213 quad_perm:[1,0,3,2] row_mask:0xf bank_mask:0xf
  s_nop 1
  v_add_f32_dpp v213, v213, v213 quad_perm:[2,3,0,1] row_mask:0xf bank_mask:0xf
  s_nop 1
  v_add_f32_dpp v213, v213, v213 row_half_mirror row_mask:0xf bank_mask:0xf
  s_nop 1
  v_add_f32_dpp v213, v213, v213 row_mirror row_mask:0xf bank_mask:0xf
  v_mov_b32 v214, v213
  s_nop 1
  v_permlane16_swap_b32 v213, v214
  v_add_f32 v213, v213, v214
  v_mul_f32 v216, 0xbacccccd, v213
  v_mul_f32 v217, 0xbacccccd, v213
  v_pk_add_f32 v[20:21], v[184:185], v[216:217]
  v_pk_mul_f32 v[16:17], v[20:21], v[20:21]
  v_pk_add_f32 v[22:23], v[186:187], v[216:217]
  v_pk_fma_f32 v[16:17], v[22:23], v[22:23], v[16:17]
  v_pk_add_f32 v[24:25], v[188:189], v[216:217]
  v_pk_fma_f32 v[16:17], v[24:25], v[24:25], v[16:17]
  v_pk_add_f32 v[26:27], v[190:191], v[216:217]
  v_pk_fma_f32 v[16:17], v[26:27], v[26:27], v[16:17]
  v_pk_add_f32 v[20:21], v[192:193], v[216:217]
  v_pk_fma_f32 v[16:17], v[20:21], v[20:21], v[16:17]
  v_pk_add_f32 v[22:23], v[194:195], v[216:217]
  v_pk_fma_f32 v[16:17], v[22:23], v[22:23], v[16:17]
  v_pk_add_f32 v[24:25], v[196:197], v[216:217]
  v_pk_fma_f32 v[16:17], v[24:25], v[24:25], v[16:17]
  v_pk_add_f32 v[26:27], v[198:199], v[216:217]
  v_pk_fma_f32 v[16:17], v[26:27], v[26:27], v[16:17]
  v_pk_add_f32 v[20:21], v[200:201], v[216:217]
  v_pk_mul_f32 v[18:19], v[20:21], v[20:21]
  v_pk_add_f32 v[22:23], v[202:203], v[216:217]
  v_pk_fma_f32 v[18:19], v[22:23], v[22:23], v[18:19]
  v_pk_add_f32 v[24:25], v[204:205], v[216:217]
  v_pk_fma_f32 v[18:19], v[24:25], v[24:25], v[18:19]
  v_pk_add_f32 v[26:27], v[206:207], v[216:217]
  v_pk_fma_f32 v[18:19], v[26:27], v[26:27], v[18:19]
  v_add_f32 v18, v18, v19
  v_add_f32 v213, v16, v17
  v_cndmask_b32 v18, 0, v18, s[64:65]
  v_add_f32 v213, v213, v18
  s_nop 1
  v_add_f32_dpp v213, v213, v213 quad_perm:[1,0,3,2] row_mask:0xf bank_mask:0xf
  s_nop 1
  v_add_f32_dpp v213, v213, v213 quad_perm:[2,3,0,1] row_mask:0xf bank_mask:0xf
  s_nop 1
  v_add_f32_dpp v213, v213, v213 row_half_mirror row_mask:0xf bank_mask:0xf
  s_nop 1
  v_add_f32_dpp v213, v213, v213 row_mirror row_mask:0xf bank_mask:0xf
  v_mov_b32 v214, v213
  s_nop 1
  v_permlane16_swap_b32 v213, v214
  v_add_f32 v213, v213, v214
  v_mul_f32 v213, 0x3acccccd, v213
  v_cvt_pk_bf16_f32 v213, v213, v213
  v_and_b32 v213, 0xffff0000, v213
  v_add_f32 v213, 0x3727c5ac, v213
  v_cvt_pk_bf16_f32 v213, v213, v213
  v_and_b32 v213, 0xffff0000, v213
  v_sqrt_f32 v213, v213
  v_cvt_pk_bf16_f32 v216, v216, v216
  v_and_b32 v216, 0xffff0000, v216
  v_cvt_pk_bf16_f32 v213, v213, v213
  v_and_b32 v213, 0xffff0000, v213
  v_rcp_f32 v28, v213
  v_mov_b32 v217, v216
  v_mov_b32 v29, v28
  v_pk_add_f32 v[184:185], v[184:185], v[216:217]
  v_lshlrev_b32 v16, 16, v172
  v_cvt_pk_bf16_f32 v185, v184, v185
  v_and_b32 v17, 0xffff0000, v172
  v_lshlrev_b32 v184, 16, v185
  v_and_b32 v185, 0xffff0000, v185
  v_pk_mul_f32 v[184:185], v[184:185], v[28:29]
  v_cvt_pk_bf16_f32 v160, v184, v185
  v_lshlrev_b32 v184, 16, v160
  v_and_b32 v185, 0xffff0000, v160
  v_pk_mul_f32 v[218:219], v[184:185], v[16:17]
  v_pk_add_f32 v[186:187], v[186:187], v[216:217]
  v_lshlrev_b32 v18, 16, v173
  v_cvt_pk_bf16_f32 v187, v186, v187
  v_and_b32 v19, 0xffff0000, v173
  v_lshlrev_b32 v186, 16, v187
  v_and_b32 v187, 0xffff0000, v187
  v_pk_mul_f32 v[186:187], v[186:187], v[28:29]
  v_cvt_pk_bf16_f32 v161, v186, v187
  v_lshlrev_b32 v186, 16, v161
  v_and_b32 v187, 0xffff0000, v161
  v_pk_fma_f32 v[218:219], v[186:187], v[18:19], v[218:219]
  v_pk_add_f32 v[188:189], v[188:189], v[216:217]
  v_lshlrev_b32 v16, 16, v174
  v_cvt_pk_bf16_f32 v189, v188, v189
  v_and_b32 v17, 0xffff0000, v174
  v_lshlrev_b32 v188, 16, v189
  v_and_b32 v189, 0xffff0000, v189
  v_pk_mul_f32 v[188:189], v[188:189], v[28:29]
  v_cvt_pk_bf16_f32 v162, v188, v189
  v_lshlrev_b32 v188, 16, v162
  v_and_b32 v189, 0xffff0000, v162
  v_pk_fma_f32 v[218:219], v[188:189], v[16:17], v[218:219]
  v_pk_add_f32 v[190:191], v[190:191], v[216:217]
  v_lshlrev_b32 v18, 16, v175
  v_cvt_pk_bf16_f32 v191, v190, v191
  v_and_b32 v19, 0xffff0000, v175
  v_lshlrev_b32 v190, 16, v191
  v_and_b32 v191, 0xffff0000, v191
  v_pk_mul_f32 v[190:191], v[190:191], v[28:29]
  v_cvt_pk_bf16_f32 v163, v190, v191
  v_lshlrev_b32 v190, 16, v163
  v_and_b32 v191, 0xffff0000, v163
  v_pk_fma_f32 v[218:219], v[190:191], v[18:19], v[218:219]
  ds_write_b128 v220, v[160:163] offset:0
  v_pk_add_f32 v[192:193], v[192:193], v[216:217]
  v_lshlrev_b32 v16, 16, v176
  v_cvt_pk_bf16_f32 v193, v192, v193
  v_and_b32 v17, 0xffff0000, v176
  v_lshlrev_b32 v192, 16, v193
  v_and_b32 v193, 0xffff0000, v193
  v_pk_mul_f32 v[192:193], v[192:193], v[28:29]
  v_cvt_pk_bf16_f32 v164, v192, v193
  v_lshlrev_b32 v192, 16, v164
  v_and_b32 v193, 0xffff0000, v164
  v_pk_fma_f32 v[218:219], v[192:193], v[16:17], v[218:219]
  v_pk_add_f32 v[194:195], v[194:195], v[216:217]
  v_lshlrev_b32 v18, 16, v177
  v_cvt_pk_bf16_f32 v195, v194, v195
  v_and_b32 v19, 0xffff0000, v177
  v_lshlrev_b32 v194, 16, v195
  v_and_b32 v195, 0xffff0000, v195
  v_pk_mul_f32 v[194:195], v[194:195], v[28:29]
  v_cvt_pk_bf16_f32 v165, v194, v195
  v_lshlrev_b32 v194, 16, v165
  v_and_b32 v195, 0xffff0000, v165
  v_pk_fma_f32 v[218:219], v[194:195], v[18:19], v[218:219]
  v_pk_add_f32 v[196:197], v[196:197], v[216:217]
  v_lshlrev_b32 v16, 16, v178
  v_cvt_pk_bf16_f32 v197, v196, v197
  v_and_b32 v17, 0xffff0000, v178
  v_lshlrev_b32 v196, 16, v197
  v_and_b32 v197, 0xffff0000, v197
  v_pk_mul_f32 v[196:197], v[196:197], v[28:29]
  v_cvt_pk_bf16_f32 v166, v196, v197
  v_lshlrev_b32 v196, 16, v166
  v_and_b32 v197, 0xffff0000, v166
  v_pk_fma_f32 v[218:219], v[196:197], v[16:17], v[218:219]
  v_pk_add_f32 v[198:199], v[198:199], v[216:217]
  v_lshlrev_b32 v18, 16, v179
  v_cvt_pk_bf16_f32 v199, v198, v199
  v_and_b32 v19, 0xffff0000, v179
  v_lshlrev_b32 v198, 16, v199
  v_and_b32 v199, 0xffff0000, v199
  v_pk_mul_f32 v[198:199], v[198:199], v[28:29]
  v_cvt_pk_bf16_f32 v167, v198, v199
  v_lshlrev_b32 v198, 16, v167
  v_and_b32 v199, 0xffff0000, v167
  v_pk_fma_f32 v[218:219], v[198:199], v[18:19], v[218:219]
  ds_write_b128 v220, v[164:167] offset:4096
  v_pk_add_f32 v[200:201], v[200:201], v[216:217]
  v_lshlrev_b32 v16, 16, v180
  v_cvt_pk_bf16_f32 v201, v200, v201
  v_and_b32 v17, 0xffff0000, v180
  v_lshlrev_b32 v200, 16, v201
  v_and_b32 v201, 0xffff0000, v201
  v_pk_mul_f32 v[200:201], v[200:201], v[28:29]
  v_cvt_pk_bf16_f32 v168, v200, v201
  v_lshlrev_b32 v200, 16, v168
  v_and_b32 v201, 0xffff0000, v168
  v_pk_fma_f32 v[218:219], v[200:201], v[16:17], v[218:219]
  v_pk_add_f32 v[202:203], v[202:203], v[216:217]
  v_lshlrev_b32 v18, 16, v181
  v_cvt_pk_bf16_f32 v203, v202, v203
  v_and_b32 v19, 0xffff0000, v181
  v_lshlrev_b32 v202, 16, v203
  v_and_b32 v203, 0xffff0000, v203
  v_pk_mul_f32 v[202:203], v[202:203], v[28:29]
  v_cvt_pk_bf16_f32 v169, v202, v203
  v_lshlrev_b32 v202, 16, v169
  v_and_b32 v203, 0xffff0000, v169
  v_pk_fma_f32 v[218:219], v[202:203], v[18:19], v[218:219]
  v_pk_add_f32 v[204:205], v[204:205], v[216:217]
  v_lshlrev_b32 v16, 16, v182
  v_cvt_pk_bf16_f32 v205, v204, v205
  v_and_b32 v17, 0xffff0000, v182
  v_lshlrev_b32 v204, 16, v205
  v_and_b32 v205, 0xffff0000, v205
  v_pk_mul_f32 v[204:205], v[204:205], v[28:29]
  v_cvt_pk_bf16_f32 v170, v204, v205
  v_lshlrev_b32 v204, 16, v170
  v_and_b32 v205, 0xffff0000, v170
  v_pk_fma_f32 v[218:219], v[204:205], v[16:17], v[218:219]
  v_pk_add_f32 v[206:207], v[206:207], v[216:217]
  v_lshlrev_b32 v18, 16, v183
  v_cvt_pk_bf16_f32 v207, v206, v207
  v_and_b32 v19, 0xffff0000, v183
  v_lshlrev_b32 v206, 16, v207
  v_and_b32 v207, 0xffff0000, v207
  v_pk_mul_f32 v[206:207], v[206:207], v[28:29]
  v_cvt_pk_bf16_f32 v171, v206, v207
  v_lshlrev_b32 v206, 16, v171
  v_and_b32 v207, 0xffff0000, v171
  v_pk_fma_f32 v[218:219], v[206:207], v[18:19], v[218:219]
  ds_write_b128 v220, v[168:171] offset:8192
  v_add_f32 v218, v218, v219
  s_nop 1
  v_add_f32_dpp v218, v218, v218 quad_perm:[1,0,3,2] row_mask:0xf bank_mask:0xf
  s_nop 1
  v_add_f32_dpp v218, v218, v218 quad_perm:[2,3,0,1] row_mask:0xf bank_mask:0xf
  s_nop 1
  v_add_f32_dpp v218, v218, v218 row_half_mirror row_mask:0xf bank_mask:0xf
  s_nop 1
  v_add_f32_dpp v218, v218, v218 row_mirror row_mask:0xf bank_mask:0xf
  v_mov_b32 v214, v218
  s_nop 1
  v_permlane16_swap_b32 v218, v214
  v_add_f32 v218, v218, v214
  v_cvt_pk_bf16_f32 v218, v218, v218
  v_and_b32 v218, 0xffff0000, v218
  v_ashrrev_i32 v214, 31, v218
  v_or_b32 v214, 0x80000000, v214
  v_xor_b32 v218, v218, v214
  v_and_b32 v218, 0xffff0000, v218
  v_or_b32 v218, v218, v209
  v_mov_b32 v19, 1073741824
  s_mov_b32 m0, s24
  s_nop 0
  buffer_load_dwordx4 v3, s[32:35], s26 offen offset:0 sc1 lds
  buffer_load_dwordx4 v4, s[32:35], s26 offen offset:1024 sc1 lds
  buffer_load_dwordx4 v5, s[32:35], s26 offen offset:2048 sc1 lds
  buffer_load_dwordx4 v6, s[32:35], s26 offen offset:3072 sc1 lds
  s_add_u32 m0, s24, 16384
  s_nop 0
  buffer_load_dwordx4 v8, s[36:39], s27 offen offset:0 lds
  buffer_load_dwordx4 v9, s[36:39], s27 offen offset:1024 lds
  buffer_load_dwordx4 v10, s[36:39], s27 offen offset:2048 lds
  buffer_load_dwordx4 v11, s[36:39], s27 offen offset:3072 lds
  s_add_u32 s26, s26, s79
  s_add_u32 s27, s27, s25
  s_add_u32 s24, s24, 32768
  s_and_b32 s24, s24, 0x1ffff
  s_mov_b32 m0, s24
  s_nop 0
  buffer_load_dwordx4 v3, s[32:35], s26 offen offset:0 sc1 lds
  buffer_load_dwordx4 v4, s[32:35], s26 offen offset:1024 sc1 lds
  buffer_load_dwordx4 v5, s[32:35], s26 offen offset:2048 sc1 lds
  buffer_load_dwordx4 v6, s[32:35], s26 offen offset:3072 sc1 lds
  s_add_u32 m0, s24, 16384
  s_nop 0
  buffer_load_dwordx4 v8, s[36:39], s27 offen offset:0 lds
  buffer_load_dwordx4 v9, s[36:39], s27 offen offset:1024 lds
  buffer_load_dwordx4 v10, s[36:39], s27 offen offset:2048 lds
  buffer_load_dwordx4 v11, s[36:39], s27 offen offset:3072 lds
  s_add_u32 s26, s26, s79
  s_add_u32 s27, s27, s25
  s_add_u32 s24, s24, 32768
  s_and_b32 s24, s24, 0x1ffff
  s_waitcnt vmcnt(8) lgkmcnt(0)
  s_barrier
  s_cmp_ge_u32 s20, 2
  s_cbranch_scc1 fa_roleV
  ds_read_b128 v[96:99], v14 offset:0
  ds_read_b128 v[100:103], v14 offset:1024
  ds_read_b128 v[104:107], v14 offset:4096
  ds_read_b128 v[108:111], v14 offset:5120
  ds_read_b128 v[112:115], v14 offset:8192
  ds_read_b128 v[116:119], v14 offset:9216
  ds_read_b128 v[120:123], v14 offset:12288
  ds_read_b128 v[124:127], v14 offset:13312
  ds_read_b64_tr_b16 v[32:33], v12 offset:0
  ds_read_b64_tr_b16 v[34:35], v12 offset:1024
  ds_read_b64_tr_b16 v[36:37], v13 offset:0
  ds_read_b64_tr_b16 v[38:39], v13 offset:1024
  ds_read_b64_tr_b16 v[40:41], v12 offset:256
  ds_read_b64_tr_b16 v[42:43], v12 offset:1280
  ds_read_b64_tr_b16 v[44:45], v13 offset:256
  ds_read_b64_tr_b16 v[46:47], v13 offset:1280
  ds_read_b64_tr_b16 v[48:49], v12 offset:512
  ds_read_b64_tr_b16 v[50:51], v12 offset:1536
  ds_read_b64_tr_b16 v[52:53], v13 offset:512
  ds_read_b64_tr_b16 v[54:55], v13 offset:1536
  ds_read_b64_tr_b16 v[56:57], v12 offset:768
  ds_read_b64_tr_b16 v[58:59], v12 offset:1792
  ds_read_b64_tr_b16 v[60:61], v13 offset:768
  ds_read_b64_tr_b16 v[62:63], v13 offset:1792
  s_mov_b32 m0, s24
  s_nop 0
  buffer_load_dwordx4 v3, s[32:35], s26 offen offset:0 sc1 lds
  buffer_load_dwordx4 v4, s[32:35], s26 offen offset:1024 sc1 lds
  buffer_load_dwordx4 v5, s[32:35], s26 offen offset:2048 sc1 lds
  buffer_load_dwordx4 v6, s[32:35], s26 offen offset:3072 sc1 lds
  s_add_u32 m0, s24, 16384
  s_nop 0
  buffer_load_dwordx4 v8, s[36:39], s27 offen offset:0 lds
  buffer_load_dwordx4 v9, s[36:39], s27 offen offset:1024 lds
  buffer_load_dwordx4 v10, s[36:39], s27 offen offset:2048 lds
  buffer_load_dwordx4 v11, s[36:39], s27 offen offset:3072 lds
  s_add_u32 s26, s26, s79
  s_add_u32 s27, s27, s25
  s_add_u32 s24, s24, 32768
  s_and_b32 s24, s24, 0x1ffff
  buffer_load_dword v231, v19, s[32:35], 0 offen
  s_mov_b32 m0, s24
  s_nop 0
  buffer_load_dwordx4 v3, s[32:35], s26 offen offset:0 sc1 lds
  buffer_load_dwordx4 v4, s[32:35], s26 offen offset:1024 sc1 lds
  buffer_load_dwordx4 v5, s[32:35], s26 offen offset:2048 sc1 lds
  buffer_load_dwordx4 v6, s[32:35], s26 offen offset:3072 sc1 lds
  s_add_u32 m0, s24, 16384
  s_nop 0
  buffer_load_dwordx4 v8, s[36:39], s27 offen offset:0 lds
  buffer_load_dwordx4 v9, s[36:39], s27 offen offset:1024 lds
  buffer_load_dwordx4 v10, s[36:39], s27 offen offset:2048 lds
  buffer_load_dwordx4 v11, s[36:39], s27 offen offset:3072 lds
  s_add_u32 s26, s26, s79
  s_add_u32 s27, s27, s25
  s_add_u32 s24, s24, 32768
  s_and_b32 s24, s24, 0x1ffff
  s_waitcnt lgkmcnt(0)
.p2align 6
fa_loopK:
  v_mfma_f32_16x16x32_bf16 a[192:195], v[32:35], v[96:99], a[192:195]
  s_waitcnt vmcnt(17)
  v_mfma_f32_16x16x32_bf16 a[200:203], v[32:35], v[100:103], a[200:203]
  s_barrier
  v_mfma_f32_16x16x32_bf16 a[0:3], v[32:35], v[104:107], a[0:3]
  ds_read_b64_tr_b16 v[64:65], v12 offset:32768
  v_mfma_f32_16x16x32_bf16 a[8:11], v[32:35], v[108:111], a[8:11]
  v_mfma_f32_16x16x32_bf16 a[64:67], v[32:35], v[112:115], a[64:67]
  s_mov_b32 m0, s24
  ds_read_b64_tr_b16 v[66:67], v12 offset:33792
  v_mfma_f32_16x16x32_bf16 a[72:75], v[32:35], v[116:119], a[72:75]
  buffer_load_dwordx4 v3, s[32:35], s26 offen offset:0 sc1 lds
  v_mfma_f32_16x16x32_bf16 a[128:131], v[32:35], v[120:123], a[128:131]
  ds_read_b128 v[128:131], v14 offset:32768
  v_mfma_f32_16x16x32_bf16 a[136:139], v[32:35], v[124:127], a[136:139]
  buffer_load_dwordx4 v4, s[32:35], s26 offen offset:1024 sc1 lds
  v_mfma_f32_16x16x32_bf16 a[196:199], v[36:39], v[96:99], a[196:199]
  ds_read_b64_tr_b16 v[68:69], v13 offset:32768
  v_mfma_f32_16x16x32_bf16 a[204:207], v[36:39], v[100:103], a[204:207]
  buffer_load_dwordx4 v5, s[32:35], s26 offen offset:2048 sc1 lds
  v_mfma_f32_16x16x32_bf16 a[4:7], v[36:39], v[104:107], a[4:7]
  ds_read_b64_tr_b16 v[70:71], v13 offset:33792
  v_mfma_f32_16x16x32_bf16 a[12:15], v[36:39], v[108:111], a[12:15]
  buffer_load_dwordx4 v6, s[32:35], s26 offen offset:3072 sc1 lds
  v_mfma_f32_16x16x32_bf16 a[68:71], v[36:39], v[112:115], a[68:71]
  s_add_u32 m0, s24, 16384
  ds_read_b128 v[132:135], v14 offset:33792
  v_mfma_f32_16x16x32_bf16 a[76:79], v[36:39], v[116:119], a[76:79]
  buffer_load_dwordx4 v8, s[36:39], s27 offen offset:0 lds
  v_mfma_f32_16x16x32_bf16 a[132:135], v[36:39], v[120:123], a[132:135]
  ds_read_b64_tr_b16 v[72:73], v12 offset:33024
  v_mfma_f32_16x16x32_bf16 a[140:143], v[36:39], v[124:127], a[140:143]
  buffer_load_dwordx4 v9, s[36:39], s27 offen offset:1024 lds
  v_mfma_f32_16x16x32_bf16 a[208:211], v[40:43], v[96:99], a[208:211]
  ds_read_b64_tr_b16 v[74:75], v12 offset:34048
  v_mfma_f32_16x16x32_bf16 a[216:219], v[40:43], v[100:103], a[216:219]
  buffer_load_dwordx4 v10, s[36:39], s27 offen offset:2048 lds
  v_mfma_f32_16x16x32_bf16 a[16:19], v[40:43], v[104:107], a[16:19]
  ds_read_b128 v[136:139], v14 offset:36864
  v_mfma_f32_16x16x32_bf16 a[24:27], v[40:43], v[108:111], a[24:27]
  buffer_load_dwordx4 v11, s[36:39], s27 offen offset:3072 lds
  v_mfma_f32_16x16x32_bf16 a[80:83], v[40:43], v[112:115], a[80:83]
  ds_read_b64_tr_b16 v[76:77], v13 offset:33024
  v_mfma_f32_16x16x32_bf16 a[88:91], v[40:43], v[116:119], a[88:91]
  buffer_load_dword v231, v235, s[48:51], s74 offen sc1
  v_mfma_f32_16x16x32_bf16 a[144:147], v[40:43], v[120:123], a[144:147]
  s_add_u32 s74, s74, s73
  ds_read_b64_tr_b16 v[78:79], v13 offset:34048
  v_mfma_f32_16x16x32_bf16 a[152:155], v[40:43], v[124:127], a[152:155]
  s_bitcmp1_b32 s72, s28
  v_mfma_f32_16x16x32_bf16 a[212:215], v[44:47], v[96:99], a[212:215]
  s_cbranch_scc1 fa_hk0
fa_hb0:
  ds_read_b128 v[140:143], v14 offset:37888
  v_mfma_f32_16x16x32_bf16 a[220:223], v[44:47], v[100:103], a[220:223]
  v_mfma_f32_16x16x32_bf16 a[20:23], v[44:47], v[104:107], a[20:23]
  ds_read_b64_tr_b16 v[80:81], v12 offset:33280
  v_mfma_f32_16x16x32_bf16 a[28:31], v[44:47], v[108:111], a[28:31]
  v_mfma_f32_16x16x32_bf16 a[84:87], v[44:47], v[112:115], a[84:87]
  ds_read_b64_tr_b16 v[82:83], v12 offset:34304
  v_mfma_f32_16x16x32_bf16 a[92:95], v[44:47], v[116:119], a[92:95]
  v_mfma_f32_16x16x32_bf16 a[148:151], v[44:47], v[120:123], a[148:151]
  ds_read_b128 v[144:147], v14 offset:40960
  v_mfma_f32_16x16x32_bf16 a[156:159], v[44:47], v[124:127], a[156:159]
  v_mfma_f32_16x16x32_bf16 a[224:227], v[48:51], v[96:99], a[224:227]
  ds_read_b64_tr_b16 v[84:85], v13 offset:33280
  v_mfma_f32_16x16x32_bf16 a[232:235], v[48:51], v[100:103], a[232:235]
  v_mfma_f32_16x16x32_bf16 a[32:35], v[48:51], v[104:107], a[32:35]
  ds_read_b64_tr_b16 v[86:87], v13 offset:34304
  v_mfma_f32_16x16x32_bf16 a[40:43], v[48:51], v[108:111], a[40:43]
  v_mfma_f32_16x16x32_bf16 a[96:99], v[48:51], v[112:115], a[96:99]
  ds_read_b128 v[148:151], v14 offset:41984
  v_mfma_f32_16x16x32_bf16 a[104:107], v[48:51], v[116:119], a[104:107]
  v_mfma_f32_16x16x32_bf16 a[160:163], v[48:51], v[120:123], a[160:163]
  ds_read_b64_tr_b16 v[88:89], v12 offset:33536
  v_mfma_f32_16x16x32_bf16 a[168:171], v[48:51], v[124:127], a[168:171]
  v_mfma_f32_16x16x32_bf16 a[228:231], v[52:55], v[96:99], a[228:231]
  ds_read_b64_tr_b16 v[90:91], v12 offset:34560
  v_mfma_f32_16x16x32_bf16 a[236:239], v[52:55], v[100:103], a[236:239]
  v_mfma_f32_16x16x32_bf16 a[36:39], v[52:55], v[104:107], a[36:39]
  ds_read_b128 v[152:155], v14 offset:45056
  v_mfma_f32_16x16x32_bf16 a[44:47], v[52:55], v[108:111], a[44:47]
  v_mfma_f32_16x16x32_bf16 a[100:103], v[52:55], v[112:115], a[100:103]
  ds_read_b64_tr_b16 v[92:93], v13 offset:33536
  v_mfma_f32_16x16x32_bf16 a[108:111], v[52:55], v[116:119], a[108:111]
  v_mfma_f32_16x16x32_bf16 a[164:167], v[52:55], v[120:123], a[164:167]
  ds_read_b64_tr_b16 v[94:95], v13 offset:34560
  v_mfma_f32_16x16x32_bf16 a[172:175], v[52:55], v[124:127], a[172:175]
  v_mfma_f32_16x16x32_bf16 a[240:243], v[56:59], v[96:99], a[240:243]
  s_add_u32 s26, s26, s79
  ds_read_b128 v[156:159], v14 offset:46080
  v_mfma_f32_16x16x32_bf16 a[248:251], v[56:59], v[100:103], a[248:251]
  s_add_u32 s27, s27, s25
  v_mfma_f32_16x16x32_bf16 a[48:51], v[56:59], v[104:107], a[48:51]
  s_add_u32 s24, s24, 32768
  v_mfma_f32_16x16x32_bf16 a[56:59], v[56:59], v[108:111], a[56:59]
  s_and_b32 s24, s24, 0x1ffff
  v_mfma_f32_16x16x32_bf16 a[112:115], v[56:59], v[112:115], a[112:115]
  v_xor_b32 v14, 0x10000, v14
  v_mfma_f32_16x16x32_bf16 a[120:123], v[56:59], v[116:119], a[120:123]
  v_xor_b32 v12, 0x10000, v12
  v_mfma_f32_16x16x32_bf16 a[176:179], v[56:59], v[120:123], a[176:179]
  v_xor_b32 v13, 0x10000, v13
  v_mfma_f32_16x16x32_bf16 a[184:187], v[56:59], v[124:127], a[184:187]
  v_mfma_f32_16x16x32_bf16 a[244:247], v[60:63], v[96:99], a[244:247]
  v_mfma_f32_16x16x32_bf16 a[252:255], v[60:63], v[100:103], a[252:255]
  v_mfma_f32_16x16x32_bf16 a[52:55], v[60:63], v[104:107], a[52:55]
  v_mfma_f32_16x16x32_bf16 a[60:63], v[60:63], v[108:111], a[60:63]
  v_mfma_f32_16x16x32_bf16 a[116:119], v[60:63], v[112:115], a[116:119]
  v_mfma_f32_16x16x32_bf16 a[124:127], v[60:63], v[116:119], a[124:127]
  v_mfma_f32_16x16x32_bf16 a[180:183], v[60:63], v[120:123], a[180:183]
  v_mfma_f32_16x16x32_bf16 a[188:191], v[60:63], v[124:127], a[188:191]
  s_waitcnt lgkmcnt(0)
  v_mfma_f32_16x16x32_bf16 a[192:195], v[64:67], v[128:131], a[192:195]
  s_waitcnt vmcnt(18)
  v_mfma_f32_16x16x32_bf16 a[200:203], v[64:67], v[132:135], a[200:203]
  s_barrier
  v_mfma_f32_16x16x32_bf16 a[0:3], v[64:67], v[136:139], a[0:3]
  ds_read_b64_tr_b16 v[32:33], v12 offset:0
  v_mfma_f32_16x16x32_bf16 a[8:11], v[64:67], v[140:143], a[8:11]
  v_mfma_f32_16x16x32_bf16 a[64:67], v[64:67], v[144:147], a[64:67]
  s_mov_b32 m0, s24
  ds_read_b64_tr_b16 v[34:35], v12 offset:1024
  v_mfma_f32_16x16x32_bf16 a[72:75], v[64:67], v[148:151], a[72:75]
  buffer_load_dwordx4 v3, s[32:35], s26 offen offset:0 sc1 lds
  v_mfma_f32_16x16x32_bf16 a[128:131], v[64:67], v[152:155], a[128:131]
  ds_read_b128 v[96:99], v14 offset:0
  v_mfma_f32_16x16x32_bf16 a[136:139], v[64:67], v[156:159], a[136:139]
  v_mfma_f32_16x16x32_bf16 a[196:199], v[68:71], v[128:131], a[196:199]
  ds_read_b64_tr_b16 v[36:37], v13 offset:0
  v_mfma_f32_16x16x32_bf16 a[204:207], v[68:71], v[132:135], a[204:207]
  v_mfma_f32_16x16x32_bf16 a[4:7], v[68:71], v[136:139], a[4:7]
  ds_read_b64_tr_b16 v[38:39], v13 offset:1024
  v_mfma_f32_16x16x32_bf16 a[12:15], v[68:71], v[140:143], a[12:15]
  buffer_load_dwordx4 v4, s[32:35], s26 offen offset:1024 sc1 lds
  v_mfma_f32_16x16x32_bf16 a[68:71], v[68:71], v[144:147], a[68:71]
  ds_read_b128 v[100:103], v14 offset:1024
  v_mfma_f32_16x16x32_bf16 a[76:79], v[68:71], v[148:151], a[76:79]
  v_mfma_f32_16x16x32_bf16 a[132:135], v[68:71], v[152:155], a[132:135]
  ds_read_b64_tr_b16 v[40:41], v12 offset:256
  v_mfma_f32_16x16x32_bf16 a[140:143], v[68:71], v[156:159], a[140:143]
  v_mfma_f32_16x16x32_bf16 a[208:211], v[72:75], v[128:131], a[208:211]
  ds_read_b64_tr_b16 v[42:43], v12 offset:1280
  v_mfma_f32_16x16x32_bf16 a[216:219], v[72:75], v[132:135], a[216:219]
  buffer_load_dwordx4 v5, s[32:35], s26 offen offset:2048 sc1 lds
  v_mfma_f32_16x16x32_bf16 a[16:19], v[72:75], v[136:139], a[16:19]
  ds_read_b128 v[104:107], v14 offset:4096
  v_mfma_f32_16x16x32_bf16 a[24:27], v[72:75], v[140:143], a[24:27]
  v_mfma_f32_16x16x32_bf16 a[80:83], v[72:75], v[144:147], a[80:83]
  ds_read_b64_tr_b16 v[44:45], v13 offset:256
  v_mfma_f32_16x16x32_bf16 a[88:91], v[72:75], v[148:151], a[88:91]
  v_mfma_f32_16x16x32_bf16 a[144:147], v[72:75], v[152:155], a[144:147]
  ds_read_b64_tr_b16 v[46:47], v13 offset:1280
  v_mfma_f32_16x16x32_bf16 a[152:155], v[72:75], v[156:159], a[152:155]
  buffer_load_dwordx4 v6, s[32:35], s26 offen offset:3072 sc1 lds
  v_mfma_f32_16x16x32_bf16 a[212:215], v[76:79], v[128:131], a[212:215]
  ds_read_b128 v[108:111], v14 offset:5120
  v_mfma_f32_16x16x32_bf16 a[220:223], v[76:79], v[132:135], a[220:223]
  v_mfma_f32_16x16x32_bf16 a[20:23], v[76:79], v[136:139], a[20:23]
  ds_read_b64_tr_b16 v[48:49], v12 offset:512
  v_mfma_f32_16x16x32_bf16 a[28:31], v[76:79], v[140:143], a[28:31]
  v_mfma_f32_16x16x32_bf16 a[84:87], v[76:79], v[144:147], a[84:87]
  s_add_u32 m0, s24, 16384
  ds_read_b64_tr_b16 v[50:51], v12 offset:1536
  v_mfma_f32_16x16x32_bf16 a[92:95], v[76:79], v[148:151], a[92:95]
  buffer_load_dwordx4 v8, s[36:39], s27 offen offset:0 lds
  v_mfma_f32_16x16x32_bf16 a[148:151], v[76:79], v[152:155], a[148:151]
  ds_read_b128 v[112:115], v14 offset:8192
  v_mfma_f32_16x16x32_bf16 a[156:159], v[76:79], v[156:159], a[156:159]
  v_mfma_f32_16x16x32_bf16 a[224:227], v[80:83], v[128:131], a[224:227]
  ds_read_b64_tr_b16 v[52:53], v13 offset:512
  v_mfma_f32_16x16x32_bf16 a[232:235], v[80:83], v[132:135], a[232:235]
  v_mfma_f32_16x16x32_bf16 a[32:35], v[80:83], v[136:139], a[32:35]
  ds_read_b64_tr_b16 v[54:55], v13 offset:1536
  v_mfma_f32_16x16x32_bf16 a[40:43], v[80:83], v[140:143], a[40:43]
  buffer_load_dwordx4 v9, s[36:39], s27 offen offset:1024 lds
  v_mfma_f32_16x16x32_bf16 a[96:99], v[80:83], v[144:147], a[96:99]
  ds_read_b128 v[116:119], v14 offset:9216
  v_mfma_f32_16x16x32_bf16 a[104:107], v[80:83], v[148:151], a[104:107]
  v_mfma_f32_16x16x32_bf16 a[160:163], v[80:83], v[152:155], a[160:163]
  ds_read_b64_tr_b16 v[56:57], v12 offset:768
  v_mfma_f32_16x16x32_bf16 a[168:171], v[80:83], v[156:159], a[168:171]
  v_mfma_f32_16x16x32_bf16 a[228:231], v[84:87], v[128:131], a[228:231]
  ds_read_b64_tr_b16 v[58:59], v12 offset:1792
  v_mfma_f32_16x16x32_bf16 a[236:239], v[84:87], v[132:135], a[236:239]
  buffer_load_dwordx4 v10, s[36:39], s27 offen offset:2048 lds
  v_mfma_f32_16x16x32_bf16 a[36:39], v[84:87], v[136:139], a[36:39]
  ds_read_b128 v[120:123], v14 offset:12288
  v_mfma_f32_16x16x32_bf16 a[44:47], v[84:87], v[140:143], a[44:47]
  v_mfma_f32_16x16x32_bf16 a[100:103], v[84:87], v[144:147], a[100:103]
  ds_read_b64_tr_b16 v[60:61], v13 offset:768
  v_mfma_f32_16x16x32_bf16 a[108:111], v[84:87], v[148:151], a[108:111]
  v_mfma_f32_16x16x32_bf16 a[164:167], v[84:87], v[152:155], a[164:167]
  ds_read_b64_tr_b16 v[62:63], v13 offset:1792
  v_mfma_f32_16x16x32_bf16 a[172:175], v[84:87], v[156:159], a[172:175]
  buffer_load_dwordx4 v11, s[36:39], s27 offen offset:3072 lds
  v_mfma_f32_16x16x32_bf16 a[240:243], v[88:91], v[128:131], a[240:243]
  s_add_u32 s26, s26, s79
  ds_read_b128 v[124:127], v14 offset:13312
  v_mfma_f32_16x16x32_bf16 a[248:251], v[88:91], v[132:135], a[248:251]
  s_add_u32 s27, s27, s25
  v_mfma_f32_16x16x32_bf16 a[48:51], v[88:91], v[136:139], a[48:51]
  s_add_u32 s24, s24, 32768
  v_mfma_f32_16x16x32_bf16 a[56:59], v[88:91], v[140:143], a[56:59]
  s_and_b32 s24, s24, 0x1ffff
  v_mfma_f32_16x16x32_bf16 a[112:115], v[88:91], v[144:147], a[112:115]
  v_mfma_f32_16x16x32_bf16 a[120:123], v[88:91], v[148:151], a[120:123]
  s_bitcmp1_b32 s76, s28
  v_mfma_f32_16x16x32_bf16 a[176:179], v[88:91], v[152:155], a[176:179]
  s_cbranch_scc1 fa_hk1
fa_hb1:
  v_mfma_f32_16x16x32_bf16 a[184:187], v[88:91], v[156:159], a[184:187]
  v_mfma_f32_16x16x32_bf16 a[244:247], v[92:95], v[128:131], a[244:247]
  v_mfma_f32_16x16x32_bf16 a[252:255], v[92:95], v[132:135], a[252:255]
  s_add_u32 s28, s28, 1
  v_mfma_f32_16x16x32_bf16 a[52:55], v[92:95], v[136:139], a[52:55]
  v_mfma_f32_16x16x32_bf16 a[60:63], v[92:95], v[140:143], a[60:63]
  v_mfma_f32_16x16x32_bf16 a[116:119], v[92:95], v[144:147], a[116:119]
  v_mfma_f32_16x16x32_bf16 a[124:127], v[92:95], v[148:151], a[124:127]
  s_cmp_lt_u32 s28, 8
  v_mfma_f32_16x16x32_bf16 a[180:183], v[92:95], v[152:155], a[180:183]
  s_waitcnt lgkmcnt(0)
  v_mfma_f32_16x16x32_bf16 a[188:191], v[92:95], v[156:159], a[188:191]
  s_cbranch_scc1 fa_loopK
  s_mov_b32 s64, 16777216
  s_mov_b32 s76, 0x3e0293ee
  s_branch fa_p1epi
fa_roleV:
  ds_read_b128 v[32:35], v14 offset:0
  ds_read_b128 v[36:39], v14 offset:1024
  ds_read_b128 v[40:43], v14 offset:4096
  ds_read_b128 v[44:47], v14 offset:5120
  ds_read_b128 v[48:51], v14 offset:8192
  ds_read_b128 v[52:55], v14 offset:9216
  ds_read_b128 v[56:59], v14 offset:12288
  ds_read_b128 v[60:63], v14 offset:13312
  ds_read_b64_tr_b16 v[96:97], v12 offset:0
  ds_read_b64_tr_b16 v[98:99], v12 offset:1024
  ds_read_b64_tr_b16 v[100:101], v13 offset:0
  ds_read_b64_tr_b16 v[102:103], v13 offset:1024
  ds_read_b64_tr_b16 v[104:105], v12 offset:256
  ds_read_b64_tr_b16 v[106:107], v12 offset:1280
  ds_read_b64_tr_b16 v[108:109], v13 offset:256
  ds_read_b64_tr_b16 v[110:111], v13 offset:1280
  ds_read_b64_tr_b16 v[112:113], v12 offset:512
  ds_read_b64_tr_b16 v[114:115], v12 offset:1536
  ds_read_b64_tr_b16 v[116:117], v13 offset:512
  ds_read_b64_tr_b16 v[118:119], v13 offset:1536
  ds_read_b64_tr_b16 v[120:121], v12 offset:768
  ds_read_b64_tr_b16 v[122:123], v12 offset:1792
  ds_read_b64_tr_b16 v[124:125], v13 offset:768
  ds_read_b64_tr_b16 v[126:127], v13 offset:1792
  s_mov_b32 m0, s24
  s_nop 0
  buffer_load_dwordx4 v3, s[32:35], s26 offen offset:0 sc1 lds
  buffer_load_dwordx4 v4, s[32:35], s26 offen offset:1024 sc1 lds
  buffer_load_dwordx4 v5, s[32:35], s26 offen offset:2048 sc1 lds
  buffer_load_dwordx4 v6, s[32:35], s26 offen offset:3072 sc1 lds
  s_add_u32 m0, s24, 16384
  s_nop 0
  buffer_load_dwordx4 v8, s[36:39], s27 offen offset:0 lds
  buffer_load_dwordx4 v9, s[36:39], s27 offen offset:1024 lds
  buffer_load_dwordx4 v10, s[36:39], s27 offen offset:2048 lds
  buffer_load_dwordx4 v11, s[36:39], s27 offen offset:3072 lds
  s_add_u32 s26, s26, s79
  s_add_u32 s27, s27, s25
  s_add_u32 s24, s24, 32768
  s_and_b32 s24, s24, 0x1ffff
  buffer_load_dword v231, v19, s[32:35], 0 offen
  s_mov_b32 m0, s24
  s_nop 0
  buffer_load_dwordx4 v3, s[32:35], s26 offen offset:0 sc1 lds
  buffer_load_dwordx4 v4, s[32:35], s26 offen offset:1024 sc1 lds
  buffer_load_dwordx4 v5, s[32:35], s26 offen offset:2048 sc1 lds
  buffer_load_dwordx4 v6, s[32:35], s26 offen offset:3072 sc1 lds
  s_add_u32 m0, s24, 16384
  s_nop 0
  buffer_load_dwordx4 v8, s[36:39], s27 offen offset:0 lds
  buffer_load_dwordx4 v9, s[36:39], s27 offen offset:1024 lds
  buffer_load_dwordx4 v10, s[36:39], s27 offen offset:2048 lds
  buffer_load_dwordx4 v11, s[36:39], s27 offen offset:3072 lds
  s_add_u32 s26, s26, s79
  s_add_u32 s27, s27, s25
  s_add_u32 s24, s24, 32768
  s_and_b32 s24, s24, 0x1ffff
  s_waitcnt lgkmcnt(0)
.p2align 6
fa_loopV:
  v_mfma_f32_16x16x32_bf16 a[192:195], v[32:35], v[96:99], a[192:195]
  s_waitcnt vmcnt(17)
  v_mfma_f32_16x16x32_bf16 a[200:203], v[32:35], v[100:103], a[200:203]
  s_barrier
  v_mfma_f32_16x16x32_bf16 a[208:211], v[32:35], v[104:107], a[208:211]
  ds_read_b64_tr_b16 v[128:129], v12 offset:32768
  v_mfma_f32_16x16x32_bf16 a[216:219], v[32:35], v[108:111], a[216:219]
  v_mfma_f32_16x16x32_bf16 a[224:227], v[32:35], v[112:115], a[224:227]
  s_mov_b32 m0, s24
  ds_read_b64_tr_b16 v[130:131], v12 offset:33792
  v_mfma_f32_16x16x32_bf16 a[232:235], v[32:35], v[116:119], a[232:235]
  buffer_load_dwordx4 v3, s[32:35], s26 offen offset:0 sc1 lds
  v_mfma_f32_16x16x32_bf16 a[240:243], v[32:35], v[120:123], a[240:243]
  ds_read_b128 v[64:67], v14 offset:32768
  v_mfma_f32_16x16x32_bf16 a[248:251], v[32:35], v[124:127], a[248:251]
  buffer_load_dwordx4 v4, s[32:35], s26 offen offset:1024 sc1 lds
  v_mfma_f32_16x16x32_bf16 a[196:199], v[36:39], v[96:99], a[196:199]
  ds_read_b64_tr_b16 v[132:133], v13 offset:32768
  v_mfma_f32_16x16x32_bf16 a[204:207], v[36:39], v[100:103], a[204:207]
  buffer_load_dwordx4 v5, s[32:35], s26 offen offset:2048 sc1 lds
  v_mfma_f32_16x16x32_bf16 a[212:215], v[36:39], v[104:107], a[212:215]
  ds_read_b64_tr_b16 v[134:135], v13 offset:33792
  v_mfma_f32_16x16x32_bf16 a[220:223], v[36:39], v[108:111], a[220:223]
  buffer_load_dwordx4 v6, s[32:35], s26 offen offset:3072 sc1 lds
  v_mfma_f32_16x16x32_bf16 a[228:231], v[36:39], v[112:115], a[228:231]
  s_add_u32 m0, s24, 16384
  ds_read_b128 v[68:71], v14 offset:33792
  v_mfma_f32_16x16x32_bf16 a[236:239], v[36:39], v[116:119], a[236:239]
  buffer_load_dwordx4 v8, s[36:39], s27 offen offset:0 lds
  v_mfma_f32_16x16x32_bf16 a[244:247], v[36:39], v[120:123], a[244:247]
  ds_read_b64_tr_b16 v[136:137], v12 offset:33024
  v_mfma_f32_16x16x32_bf16 a[252:255], v[36:39], v[124:127], a[252:255]
  buffer_load_dwordx4 v9, s[36:39], s27 offen offset:1024 lds
  v_mfma_f32_16x16x32_bf16 a[0:3], v[40:43], v[96:99], a[0:3]
  ds_read_b64_tr_b16 v[138:139], v12 offset:34048
  v_mfma_f32_16x16x32_bf16 a[8:11], v[40:43], v[100:103], a[8:11]
  buffer_load_dwordx4 v10, s[36:39], s27 offen offset:2048 lds
  v_mfma_f32_16x16x32_bf16 a[16:19], v[40:43], v[104:107], a[16:19]
  ds_read_b128 v[72:75], v14 offset:36864
  v_mfma_f32_16x16x32_bf16 a[24:27], v[40:43], v[108:111], a[24:27]
  buffer_load_dwordx4 v11, s[36:39], s27 offen offset:3072 lds
  v_mfma_f32_16x16x32_bf16 a[32:35], v[40:43], v[112:115], a[32:35]
  ds_read_b64_tr_b16 v[140:141], v13 offset:33024
  v_mfma_f32_16x16x32_bf16 a[40:43], v[40:43], v[116:119], a[40:43]
  buffer_load_dword v231, v235, s[48:51], s74 offen sc1
  v_mfma_f32_16x16x32_bf16 a[48:51], v[40:43], v[120:123], a[48:51]
  s_add_u32 s74, s74, s73
  ds_read_b64_tr_b16 v[142:143], v13 offset:34048
  v_mfma_f32_16x16x32_bf16 a[56:59], v[40:43], v[124:127], a[56:59]
  s_bitcmp1_b32 s72, s28
  v_mfma_f32_16x16x32_bf16 a[4:7], v[44:47], v[96:99], a[4:7]
  s_cbranch_scc1 fa_hk2
fa_hb2:
  ds_read_b128 v[76:79], v14 offset:37888
  v_mfma_f32_16x16x32_bf16 a[12:15], v[44:47], v[100:103], a[12:15]
  v_mfma_f32_16x16x32_bf16 a[20:23], v[44:47], v[104:107], a[20:23]
  ds_read_b64_tr_b16 v[144:145], v12 offset:33280
  v_mfma_f32_16x16x32_bf16 a[28:31], v[44:47], v[108:111], a[28:31]
  v_mfma_f32_16x16x32_bf16 a[36:39], v[44:47], v[112:115], a[36:39]
  ds_read_b64_tr_b16 v[146:147], v12 offset:34304
  v_mfma_f32_16x16x32_bf16 a[44:47], v[44:47], v[116:119], a[44:47]
  v_mfma_f32_16x16x32_bf16 a[52:55], v[44:47], v[120:123], a[52:55]
  ds_read_b128 v[80:83], v14 offset:40960
  v_mfma_f32_16x16x32_bf16 a[60:63], v[44:47], v[124:127], a[60:63]
  v_mfma_f32_16x16x32_bf16 a[64:67], v[48:51], v[96:99], a[64:67]
  ds_read_b64_tr_b16 v[148:149], v13 offset:33280
  v_mfma_f32_16x16x32_bf16 a[72:75], v[48:51], v[100:103], a[72:75]
  v_mfma_f32_16x16x32_bf16 a[80:83], v[48:51], v[104:107], a[80:83]
  ds_read_b64_tr_b16 v[150:151], v13 offset:34304
  v_mfma_f32_16x16x32_bf16 a[88:91], v[48:51], v[108:111], a[88:91]
  v_mfma_f32_16x16x32_bf16 a[96:99], v[48:51], v[112:115], a[96:99]
  ds_read_b128 v[84:87], v14 offset:41984
  v_mfma_f32_16x16x32_bf16 a[104:107], v[48:51], v[116:119], a[104:107]
  v_mfma_f32_16x16x32_bf16 a[112:115], v[48:51], v[120:123], a[112:115]
  ds_read_b64_tr_b16 v[152:153], v12 offset:33536
  v_mfma_f32_16x16x32_bf16 a[120:123], v[48:51], v[124:127], a[120:123]
  v_mfma_f32_16x16x32_bf16 a[68:71], v[52:55], v[96:99], a[68:71]
  ds_read_b64_tr_b16 v[154:155], v12 offset:34560
  v_mfma_f32_16x16x32_bf16 a[76:79], v[52:55], v[100:103], a[76:79]
  v_mfma_f32_16x16x32_bf16 a[84:87], v[52:55], v[104:107], a[84:87]
  ds_read_b128 v[88:91], v14 offset:45056
  v_mfma_f32_16x16x32_bf16 a[92:95], v[52:55], v[108:111], a[92:95]
  v_mfma_f32_16x16x32_bf16 a[100:103], v[52:55], v[112:115], a[100:103]
  ds_read_b64_tr_b16 v[156:157], v13 offset:33536
  v_mfma_f32_16x16x32_bf16 a[108:111], v[52:55], v[116:119], a[108:111]
  v_mfma_f32_16x16x32_bf16 a[116:119], v[52:55], v[120:123], a[116:119]
  ds_read_b64_tr_b16 v[158:159], v13 offset:34560
  v_mfma_f32_16x16x32_bf16 a[124:127], v[52:55], v[124:127], a[124:127]
  v_mfma_f32_16x16x32_bf16 a[128:131], v[56:59], v[96:99], a[128:131]
  s_add_u32 s26, s26, s79
  ds_read_b128 v[92:95], v14 offset:46080
  v_mfma_f32_16x16x32_bf16 a[136:139], v[56:59], v[100:103], a[136:139]
  s_add_u32 s27, s27, s25
  v_mfma_f32_16x16x32_bf16 a[144:147], v[56:59], v[104:107], a[144:147]
  s_add_u32 s24, s24, 32768
  v_mfma_f32_16x16x32_bf16 a[152:155], v[56:59], v[108:111], a[152:155]
  s_and_b32 s24, s24, 0x1ffff
  v_mfma_f32_16x16x32_bf16 a[160:163], v[56:59], v[112:115], a[160:163]
  v_xor_b32 v14, 0x10000, v14
  v_mfma_f32_16x16x32_bf16 a[168:171], v[56:59], v[116:119], a[168:171]
  v_xor_b32 v12, 0x10000, v12
  v_mfma_f32_16x16x32_bf16 a[176:179], v[56:59], v[120:123], a[176:179]
  v_xor_b32 v13, 0x10000, v13
  v_mfma_f32_16x16x32_bf16 a[184:187], v[56:59], v[124:127], a[184:187]
  v_mfma_f32_16x16x32_bf16 a[132:135], v[60:63], v[96:99], a[132:135]
  v_mfma_f32_16x16x32_bf16 a[140:143], v[60:63], v[100:103], a[140:143]
  v_mfma_f32_16x16x32_bf16 a[148:151], v[60:63], v[104:107], a[148:151]
  v_mfma_f32_16x16x32_bf16 a[156:159], v[60:63], v[108:111], a[156:159]
  v_mfma_f32_16x16x32_bf16 a[164:167], v[60:63], v[112:115], a[164:167]
  v_mfma_f32_16x16x32_bf16 a[172:175], v[60:63], v[116:119], a[172:175]
  v_mfma_f32_16x16x32_bf16 a[180:183], v[60:63], v[120:123], a[180:183]
  v_mfma_f32_16x16x32_bf16 a[188:191], v[60:63], v[124:127], a[188:191]
  s_waitcnt lgkmcnt(0)
  v_mfma_f32_16x16x32_bf16 a[192:195], v[64:67], v[128:131], a[192:195]
  s_waitcnt vmcnt(18)
  v_mfma_f32_16x16x32_bf16 a[200:203], v[64:67], v[132:135], a[200:203]
  s_barrier
  v_mfma_f32_16x16x32_bf16 a[208:211], v[64:67], v[136:139], a[208:211]
  ds_read_b64_tr_b16 v[96:97], v12 offset:0
  v_mfma_f32_16x16x32_bf16 a[216:219], v[64:67], v[140:143], a[216:219]
  v_mfma_f32_16x16x32_bf16 a[224:227], v[64:67], v[144:147], a[224:227]
  s_mov_b32 m0, s24
  ds_read_b64_tr_b16 v[98:99], v12 offset:1024
  v_mfma_f32_16x16x32_bf16 a[232:235], v[64:67], v[148:151], a[232:235]
  buffer_load_dwordx4 v3, s[32:35], s26 offen offset:0 sc1 lds
  v_mfma_f32_16x16x32_bf16 a[240:243], v[64:67], v[152:155], a[240:243]
  ds_read_b128 v[32:35], v14 offset:0
  v_mfma_f32_16x16x32_bf16 a[248:251], v[64:67], v[156:159], a[248:251]
  v_mfma_f32_16x16x32_bf16 a[196:199], v[68:71], v[128:131], a[196:199]
  ds_read_b64_tr_b16 v[100:101], v13 offset:0
  v_mfma_f32_16x16x32_bf16 a[204:207], v[68:71], v[132:135], a[204:207]
  v_mfma_f32_16x16x32_bf16 a[212:215], v[68:71], v[136:139], a[212:215]
  ds_read_b64_tr_b16 v[102:103], v13 offset:1024
  v_mfma_f32_16x16x32_bf16 a[220:223], v[68:71], v[140:143], a[220:223]
  buffer_load_dwordx4 v4, s[32:35], s26 offen offset:1024 sc1 lds
  v_mfma_f32_16x16x32_bf16 a[228:231], v[68:71], v[144:147], a[228:231]
  ds_read_b128 v[36:39], v14 offset:1024
  v_mfma_f32_16x16x32_bf16 a[236:239], v[68:71], v[148:151], a[236:239]
  v_mfma_f32_16x16x32_bf16 a[244:247], v[68:71], v[152:155], a[244:247]
  ds_read_b64_tr_b16 v[104:105], v12 offset:256
  v_mfma_f32_16x16x32_bf16 a[252:255], v[68:71], v[156:159], a[252:255]
  v_mfma_f32_16x16x32_bf16 a[0:3], v[72:75], v[128:131], a[0:3]
  ds_read_b64_tr_b16 v[106:107], v12 offset:1280
  v_mfma_f32_16x16x32_bf16 a[8:11], v[72:75], v[132:135], a[8:11]
  buffer_load_dwordx4 v5, s[32:35], s26 offen offset:2048 sc1 lds
  v_mfma_f32_16x16x32_bf16 a[16:19], v[72:75], v[136:139], a[16:19]
  ds_read_b128 v[40:43], v14 offset:4096
  v_mfma_f32_16x16x32_bf16 a[24:27], v[72:75], v[140:143], a[24:27]
  v_mfma_f32_16x16x32_bf16 a[32:35], v[72:75], v[144:147], a[32:35]
  ds_read_b64_tr_b16 v[108:109], v13 offset:256
  v_mfma_f32_16x16x32_bf16 a[40:43], v[72:75], v[148:151], a[40:43]
  v_mfma_f32_16x16x32_bf16 a[48:51], v[72:75], v[152:155], a[48:51]
  ds_read_b64_tr_b16 v[110:111], v13 offset:1280
  v_mfma_f32_16x16x32_bf16 a[56:59], v[72:75], v[156:159], a[56:59]
  buffer_load_dwordx4 v6, s[32:35], s26 offen offset:3072 sc1 lds
  v_mfma_f32_16x16x32_bf16 a[4:7], v[76:79], v[128:131], a[4:7]
  ds_read_b128 v[44:47], v14 offset:5120
  v_mfma_f32_16x16x32_bf16 a[12:15], v[76:79], v[132:135], a[12:15]
  v_mfma_f32_16x16x32_bf16 a[20:23], v[76:79], v[136:139], a[20:23]
  ds_read_b64_tr_b16 v[112:113], v12 offset:512
  v_mfma_f32_16x16x32_bf16 a[28:31], v[76:79], v[140:143], a[28:31]
  v_mfma_f32_16x16x32_bf16 a[36:39], v[76:79], v[144:147], a[36:39]
  s_add_u32 m0, s24, 16384
  ds_read_b64_tr_b16 v[114:115], v12 offset:1536
  v_mfma_f32_16x16x32_bf16 a[44:47], v[76:79], v[148:151], a[44:47]
  buffer_load_dwordx4 v8, s[36:39], s27 offen offset:0 lds
  v_mfma_f32_16x16x32_bf16 a[52:55], v[76:79], v[152:155], a[52:55]
  ds_read_b128 v[48:51], v14 offset:8192
  v_mfma_f32_16x16x32_bf16 a[60:63], v[76:79], v[156:159], a[60:63]
  v_mfma_f32_16x16x32_bf16 a[64:67], v[80:83], v[128:131], a[64:67]
  ds_read_b64_tr_b16 v[116:117], v13 offset:512
  v_mfma_f32_16x16x32_bf16 a[72:75], v[80:83], v[132:135], a[72:75]
  v_mfma_f32_16x16x32_bf16 a[80:83], v[80:83], v[136:139], a[80:83]
  ds_read_b64_tr_b16 v[118:119], v13 offset:1536
  v_mfma_f32_16x16x32_bf16 a[88:91], v[80:83], v[140:143], a[88:91]
  buffer_load_dwordx4 v9, s[36:39], s27 offen offset:1024 lds
  v_mfma_f32_16x16x32_bf16 a[96:99], v[80:83], v[144:147], a[96:99]
  ds_read_b128 v[52:55], v14 offset:9216
  v_mfma_f32_16x16x32_bf16 a[104:107], v[80:83], v[148:151], a[104:107]
  v_mfma_f32_16x16x32_bf16 a[112:115], v[80:83], v[152:155], a[112:115]
  ds_read_b64_tr_b16 v[120:121], v12 offset:768
  v_mfma_f32_16x16x32_bf16 a[120:123], v[80:83], v[156:159], a[120:123]
  v_mfma_f32_16x16x32_bf16 a[68:71], v[84:87], v[128:131], a[68:71]
  ds_read_b64_tr_b16 v[122:123], v12 offset:1792
  v_mfma_f32_16x16x32_bf16 a[76:79], v[84:87], v[132:135], a[76:79]
  buffer_load_dwordx4 v10, s[36:39], s27 offen offset:2048 lds
  v_mfma_f32_16x16x32_bf16 a[84:87], v[84:87], v[136:139], a[84:87]
  ds_read_b128 v[56:59], v14 offset:12288
  v_mfma_f32_16x16x32_bf16 a[92:95], v[84:87], v[140:143], a[92:95]
  v_mfma_f32_16x16x32_bf16 a[100:103], v[84:87], v[144:147], a[100:103]
  ds_read_b64_tr_b16 v[124:125], v13 offset:768
  v_mfma_f32_16x16x32_bf16 a[108:111], v[84:87], v[148:151], a[108:111]
  v_mfma_f32_16x16x32_bf16 a[116:119], v[84:87], v[152:155], a[116:119]
  ds_read_b64_tr_b16 v[126:127], v13 offset:1792
  v_mfma_f32_16x16x32_bf16 a[124:127], v[84:87], v[156:159], a[124:127]
  buffer_load_dwordx4 v11, s[36:39], s27 offen offset:3072 lds
  v_mfma_f32_16x16x32_bf16 a[128:131], v[88:91], v[128:131], a[128:131]
  s_add_u32 s26, s26, s79
  ds_read_b128 v[60:63], v14 offset:13312
  v_mfma_f32_16x16x32_bf16 a[136:139], v[88:91], v[132:135], a[136:139]
  s_add_u32 s27, s27, s25
  v_mfma_f32_16x16x32_bf16 a[144:147], v[88:91], v[136:139], a[144:147]
  s_add_u32 s24, s24, 32768
  v_mfma_f32_16x16x32_bf16 a[152:155], v[88:91], v[140:143], a[152:155]
  s_and_b32 s24, s24, 0x1ffff
  v_mfma_f32_16x16x32_bf16 a[160:163], v[88:91], v[144:147], a[160:163]
  v_mfma_f32_16x16x32_bf16 a[168:171], v[88:91], v[148:151], a[168:171]
  s_bitcmp1_b32 s76, s28
  v_mfma_f32_16x16x32_bf16 a[176:179], v[88:91], v[152:155], a[176:179]
  s_cbranch_scc1 fa_hk3
fa_hb3:
  v_mfma_f32_16x16x32_bf16 a[184:187], v[88:91], v[156:159], a[184:187]
  v_mfma_f32_16x16x32_bf16 a[132:135], v[92:95], v[128:131], a[132:135]
  v_mfma_f32_16x16x32_bf16 a[140:143], v[92:95], v[132:135], a[140:143]
  s_add_u32 s28, s28, 1
  v_mfma_f32_16x16x32_bf16 a[148:151], v[92:95], v[136:139], a[148:151]
  v_mfma_f32_16x16x32_bf16 a[156:159], v[92:95], v[140:143], a[156:159]
  v_mfma_f32_16x16x32_bf16 a[164:167], v[92:95], v[144:147], a[164:167]
  v_mfma_f32_16x16x32_bf16 a[172:175], v[92:95], v[148:151], a[172:175]
  s_cmp_lt_u32 s28, 8
  v_mfma_f32_16x16x32_bf16 a[180:183], v[92:95], v[152:155], a[180:183]
  s_waitcnt lgkmcnt(0)
  v_mfma_f32_16x16x32_bf16 a[188:191], v[92:95], v[156:159], a[188:191]
  s_cbranch_scc1 fa_loopV
  s_mov_b32 s64, 33554432
  s_mov_b32 s76, 1.0
fa_p1epi:
  s_lshr_b32 s23, s20, 1
  s_lshl_b32 s23, s23, 13
  v_subrev_u32 v12, s23, v12
  v_subrev_u32 v13, s23, v13
  s_lshl_b32 s24, s20, 12
  v_add_u32 v14, s24, v2
  ds_read_b64_tr_b16 v[32:33], v12 offset:0
  ds_read_b64_tr_b16 v[34:35], v12 offset:1024
  ds_read_b64_tr_b16 v[36:37], v13 offset:0
  ds_read_b64_tr_b16 v[38:39], v13 offset:1024
  ds_read_b64_tr_b16 v[40:41], v12 offset:256
  ds_read_b64_tr_b16 v[42:43], v12 offset:1280
  ds_read_b64_tr_b16 v[44:45], v13 offset:256
  ds_read_b64_tr_b16 v[46:47], v13 offset:1280
  ds_read_b64_tr_b16 v[48:49], v12 offset:512
  ds_read_b64_tr_b16 v[50:51], v12 offset:1536
  ds_read_b64_tr_b16 v[52:53], v13 offset:512
  ds_read_b64_tr_b16 v[54:55], v13 offset:1536
  ds_read_b64_tr_b16 v[56:57], v12 offset:768
  ds_read_b64_tr_b16 v[58:59], v12 offset:1792
  ds_read_b64_tr_b16 v[60:61], v13 offset:768
  ds_read_b64_tr_b16 v[62:63], v13 offset:1792
  s_waitcnt vmcnt(8)
  ds_read_b128 v[224:227], v14 offset:0
  ds_read_b128 v[228:231], v14 offset:1024
  ds_read_b128 v[232:235], v14 offset:2048
  ds_read_b128 v[236:239], v14 offset:3072
  s_lshl_b32 s23, s21, 19
  s_add_u32 s64, s64, s23
  s_lshl_b32 s23, s22, 14
  s_add_u32 s64, s64, s23
  s_and_b32 s23, s20, 1
  s_lshl_b32 s23, s23, 13
  s_add_u32 s64, s64, s23
  s_lshl_b32 s23, s21, 19
  s_add_u32 s23, s23, 16777216
  s_add_u32 s6, s18, s23
  s_addc_u32 s7, s19, 0
  s_add_u32 s8, s6, 16777216
  s_addc_u32 s9, s7, 0
  s_sub_u32 s23, 16, s22
  s_lshl_b32 s23, s23, 15
  s_mov_b32 s44, s6
  s_mov_b32 s45, s7
  s_mov_b32 s46, s23
  s_mov_b32 s47, 0x20000
  s_mov_b32 s48, s8
  s_mov_b32 s49, s9
  s_mov_b32 s50, s23
  s_mov_b32 s51, 0x20000
  s_lshl_b32 s30, s21, 10
  s_add_u32 s30, s30, 67108864
  s_mov_b32 s81, 0x47800000
  s_cmp_eq_u32 s20, 0
  s_cselect_b32 s65, s82, 1073741824
  s_waitcnt vmcnt(21) lgkmcnt(0)
  v_mfma_f32_16x16x32_bf16 v[96:99], v[32:35], v[224:227], 0
  v_accvgpr_read_b32 v16, a192
  v_accvgpr_read_b32 v17, a193
  v_accvgpr_read_b32 v18, a194
  v_mfma_f32_16x16x32_bf16 v[112:115], v[36:39], v[224:227], 0
  ds_read_b64_tr_b16 v[64:65], v12 offset:8192
  v_accvgpr_read_b32 v19, a195
  v_mfma_f32_16x16x32_bf16 v[128:131], v[40:43], v[224:227], 0
  s_add_u32 m0, s24, 0
  ds_read_b64_tr_b16 v[66:67], v12 offset:9216
  v_accvgpr_read_b32 v20, a196
  v_mfma_f32_16x16x32_bf16 v[144:147], v[44:47], v[224:227], 0
  buffer_load_dwordx4 v3, s[32:35], s26 offen offset:0 sc1 lds
  v_accvgpr_read_b32 v21, a197
  v_mfma_f32_16x16x32_bf16 v[160:163], v[48:51], v[224:227], 0
  ds_read_b64_tr_b16 v[68:69], v13 offset:8192
  v_accvgpr_read_b32 v22, a198
  v_accvgpr_read_b32 v23, a199
  v_mfma_f32_16x16x32_bf16 v[176:179], v[52:55], v[224:227], 0
  ds_read_b64_tr_b16 v[70:71], v13 offset:9216
  v_mul_f32 v16, s76, v16
  v_mfma_f32_16x16x32_bf16 v[192:195], v[56:59], v[224:227], 0
  ds_read_b64_tr_b16 v[72:73], v12 offset:8448
  v_mul_f32 v17, s76, v17
  v_mfma_f32_16x16x32_bf16 v[208:211], v[60:63], v[224:227], 0
  ds_read_b64_tr_b16 v[74:75], v12 offset:9472
  v_mul_f32 v18, s76, v18
  v_mfma_f32_16x16x32_bf16 v[100:103], v[32:35], v[228:231], 0
  buffer_load_dwordx4 v4, s[32:35], s26 offen offset:1024 sc1 lds
  v_mul_f32 v19, s76, v19
  v_mul_f32 v20, s76, v20
  v_mfma_f32_16x16x32_bf16 v[116:119], v[36:39], v[228:231], 0
  ds_read_b64_tr_b16 v[76:77], v13 offset:8448
  v_mul_f32 v21, s76, v21
  v_mfma_f32_16x16x32_bf16 v[132:135], v[40:43], v[228:231], 0
  ds_read_b64_tr_b16 v[78:79], v13 offset:9472
  v_mul_f32 v22, s76, v22
  v_mfma_f32_16x16x32_bf16 v[148:151], v[44:47], v[228:231], 0
  ds_read_b128 v[240:243], v14 offset:32768
  v_mul_f32 v23, s76, v23
  v_mfma_f32_16x16x32_bf16 v[164:167], v[48:51], v[228:231], 0
  ds_read_b128 v[244:247], v14 offset:33792
  v_cvt_pk_bf16_f32 v24, v16, v17
  v_cvt_pk_bf16_f32 v25, v18, v19
  v_mfma_f32_16x16x32_bf16 v[180:183], v[52:55], v[228:231], 0
  buffer_load_dwordx4 v5, s[32:35], s26 offen offset:2048 sc1 lds
  v_cvt_pk_bf16_f32 v26, v20, v21
  v_mfma_f32_16x16x32_bf16 v[196:199], v[56:59], v[228:231], 0
  ds_read_b64_tr_b16 v[80:81], v12 offset:8704
  v_cvt_pk_bf16_f32 v27, v22, v23
  v_mfma_f32_16x16x32_bf16 v[212:215], v[60:63], v[228:231], 0
  ds_read_b64_tr_b16 v[82:83], v12 offset:9728
  buffer_store_dwordx4 v[24:27], v2, s[40:43], s64 offen offset:0 sc1
  v_mfma_f32_16x16x32_bf16 v[104:107], v[32:35], v[232:235], 0
  ds_read_b64_tr_b16 v[84:85], v13 offset:8704
  v_accvgpr_read_b32 v16, a200
  v_mfma_f32_16x16x32_bf16 v[120:123], v[36:39], v[232:235], 0
  ds_read_b64_tr_b16 v[86:87], v13 offset:9728
  v_accvgpr_read_b32 v17, a201
  v_accvgpr_read_b32 v18, a202
  v_mfma_f32_16x16x32_bf16 v[136:139], v[40:43], v[232:235], 0
  buffer_load_dwordx4 v6, s[32:35], s26 offen offset:3072 sc1 lds
  v_accvgpr_read_b32 v19, a203
  v_mfma_f32_16x16x32_bf16 v[152:155], v[44:47], v[232:235], 0
  s_add_u32 s26, s26, 1024
  ds_read_b64_tr_b16 v[88:89], v12 offset:8960
  v_accvgpr_read_b32 v20, a204
  v_mfma_f32_16x16x32_bf16 v[168:171], v[48:51], v[232:235], 0
  ds_read_b64_tr_b16 v[90:91], v12 offset:9984
  v_accvgpr_read_b32 v21, a205
  v_mfma_f32_16x16x32_bf16 v[184:187], v[52:55], v[232:235], 0
  ds_read_b64_tr_b16 v[92:93], v13 offset:8960
  v_accvgpr_read_b32 v22, a206
  v_accvgpr_read_b32 v23, a207
  v_mfma_f32_16x16x32_bf16 v[200:203], v[56:59], v[232:235], 0
  ds_read_b64_tr_b16 v[94:95], v13 offset:9984
  v_mul_f32 v16, s76, v16
  v_mfma_f32_16x16x32_bf16 v[216:219], v[60:63], v[232:235], 0
  v_mul_f32 v17, s76, v17
  v_mul_f32 v18, s76, v18
  v_mfma_f32_16x16x32_bf16 v[108:111], v[32:35], v[236:239], 0
  ds_read_b128 v[248:251], v14 offset:34816
  v_mul_f32 v19, s76, v19
  v_mfma_f32_16x16x32_bf16 v[124:127], v[36:39], v[236:239], 0
  ds_read_b128 v[252:255], v14 offset:35840
  v_mul_f32 v20, s76, v20
  v_mul_f32 v21, s76, v21
  v_mfma_f32_16x16x32_bf16 v[140:143], v[40:43], v[236:239], 0
  v_mul_f32 v22, s76, v22
  v_mul_f32 v23, s76, v23
  v_mfma_f32_16x16x32_bf16 v[156:159], v[44:47], v[236:239], 0
  v_xor_b32 v14, 0x10000, v14
  v_cvt_pk_bf16_f32 v28, v16, v17
  v_mfma_f32_16x16x32_bf16 v[172:175], v[48:51], v[236:239], 0
  v_cvt_pk_bf16_f32 v29, v18, v19
  v_cvt_pk_bf16_f32 v30, v20, v21
  v_mfma_f32_16x16x32_bf16 v[188:191], v[52:55], v[236:239], 0
  v_cvt_pk_bf16_f32 v31, v22, v23
  v_mfma_f32_16x16x32_bf16 v[204:207], v[56:59], v[236:239], 0
  buffer_store_dwordx4 v[28:31], v2, s[40:43], s64 offen offset:1024 sc1
  v_mfma_f32_16x16x32_bf16 v[220:223], v[60:63], v[236:239], 0
  s_waitcnt vmcnt(19) lgkmcnt(0)
  v_mfma_f32_16x16x32_bf16 v[96:99], v[64:67], v[240:243], v[96:99]
  s_barrier
  v_accvgpr_read_b32 v16, a208
  v_accvgpr_read_b32 v17, a209
  v_accvgpr_read_b32 v18, a210
  v_mfma_f32_16x16x32_bf16 v[112:115], v[68:71], v[240:243], v[112:115]
  ds_read_b64_tr_b16 v[32:33], v12 offset:32768
  v_accvgpr_read_b32 v19, a211
  v_mfma_f32_16x16x32_bf16 v[128:131], v[72:75], v[240:243], v[128:131]
  s_add_u32 m0, s24, 32768
  ds_read_b64_tr_b16 v[34:35], v12 offset:33792
  v_accvgpr_read_b32 v20, a212
  v_mfma_f32_16x16x32_bf16 v[144:147], v[76:79], v[240:243], v[144:147]
  buffer_load_dwordx4 v3, s[32:35], s26 offen offset:0 sc1 lds
  v_accvgpr_read_b32 v21, a213
  v_mfma_f32_16x16x32_bf16 v[160:163], v[80:83], v[240:243], v[160:163]
  ds_read_b64_tr_b16 v[36:37], v13 offset:32768
  v_accvgpr_read_b32 v22, a214
  v_accvgpr_read_b32 v23, a215
  v_mfma_f32_16x16x32_bf16 v[176:179], v[84:87], v[240:243], v[176:179]
  ds_read_b64_tr_b16 v[38:39], v13 offset:33792
  v_mul_f32 v16, s76, v16
  v_mfma_f32_16x16x32_bf16 v[192:195], v[88:91], v[240:243], v[192:195]
  ds_read_b64_tr_b16 v[40:41], v12 offset:33024
  v_mul_f32 v17, s76, v17
  v_mfma_f32_16x16x32_bf16 v[208:211], v[92:95], v[240:243], v[208:211]
  ds_read_b64_tr_b16 v[42:43], v12 offset:34048
  v_mul_f32 v18, s76, v18
  v_mfma_f32_16x16x32_bf16 v[100:103], v[64:67], v[244:247], v[100:103]
  buffer_load_dwordx4 v4, s[32:35], s26 offen offset:1024 sc1 lds
  v_mul_f32 v19, s76, v19
  v_mul_f32 v20, s76, v20
  v_mfma_f32_16x16x32_bf16 v[116:119], v[68:71], v[244:247], v[116:119]
  ds_read_b64_tr_b16 v[44:45], v13 offset:33024
  v_mul_f32 v21, s76, v21
  v_mfma_f32_16x16x32_bf16 v[132:135], v[72:75], v[244:247], v[132:135]
  ds_read_b64_tr_b16 v[46:47], v13 offset:34048
  v_mul_f32 v22, s76, v22
  v_mfma_f32_16x16x32_bf16 v[148:151], v[76:79], v[244:247], v[148:151]
  ds_read_b128 v[224:227], v14 offset:0
  v_mul_f32 v23, s76, v23
  v_mfma_f32_16x16x32_bf16 v[164:167], v[80:83], v[244:247], v[164:167]
  ds_read_b128 v[228:231], v14 offset:1024
  v_cvt_pk_bf16_f32 v24, v16, v17
  v_cvt_pk_bf16_f32 v25, v18, v19
  v_mfma_f32_16x16x32_bf16 v[180:183], v[84:87], v[244:247], v[180:183]
  buffer_load_dwordx4 v5, s[32:35], s26 offen offset:2048 sc1 lds
  v_cvt_pk_bf16_f32 v26, v20, v21
  v_mfma_f32_16x16x32_bf16 v[196:199], v[88:91], v[244:247], v[196:199]
  ds_read_b64_tr_b16 v[48:49], v12 offset:33280
  v_cvt_pk_bf16_f32 v27, v22, v23
  v_mfma_f32_16x16x32_bf16 v[212:215], v[92:95], v[244:247], v[212:215]
  ds_read_b64_tr_b16 v[50:51], v12 offset:34304
  buffer_store_dwordx4 v[24:27], v2, s[40:43], s64 offen offset:2048 sc1
  v_mfma_f32_16x16x32_bf16 v[104:107], v[64:67], v[248:251], v[104:107]
  ds_read_b64_tr_b16 v[52:53], v13 offset:33280
  v_accvgpr_read_b32 v16, a216
  v_mfma_f32_16x16x32_bf16 v[120:123], v[68:71], v[248:251], v[120:123]
  ds_read_b64_tr_b16 v[54:55], v13 offset:34304
  v_accvgpr_read_b32 v17, a217
  v_accvgpr_read_b32 v18, a218
  v_mfma_f32_16x16x32_bf16 v[136:139], v[72:75], v[248:251], v[136:139]
  buffer_load_dwordx4 v6, s[32:35], s26 offen offset:3072 sc1 lds
  v_accvgpr_read_b32 v19, a219
  v_mfma_f32_16x16x32_bf16 v[152:155], v[76:79], v[248:251], v[152:155]
  s_add_u32 s26, s26, 1024
  ds_read_b64_tr_b16 v[56:57], v12 offset:33536
  v_accvgpr_read_b32 v20, a220
  v_mfma_f32_16x16x32_bf16 v[168:171], v[80:83], v[248:251], v[168:171]
  ds_read_b64_tr_b16 v[58:59], v12 offset:34560
  v_accvgpr_read_b32 v21, a221
  v_mfma_f32_16x16x32_bf16 v[184:187], v[84:87], v[248:251], v[184:187]
  ds_read_b64_tr_b16 v[60:61], v13 offset:33536
  v_accvgpr_read_b32 v22, a222
  v_accvgpr_read_b32 v23, a223
  v_mfma_f32_16x16x32_bf16 v[200:203], v[88:91], v[248:251], v[200:203]
  s_add_u32 m0, s24, 16384
  ds_read_b64_tr_b16 v[62:63], v13 offset:34560
  v_mul_f32 v16, s76, v16
  v_mfma_f32_16x16x32_bf16 v[216:219], v[92:95], v[248:251], v[216:219]
  buffer_load_dwordx4 v8, s[36:39], s27 offen offset:0 lds
  v_mul_f32 v17, s76, v17
  v_mfma_f32_16x16x32_bf16 v[108:111], v[64:67], v[252:255], v[108:111]
  ds_read_b128 v[232:235], v14 offset:2048
  v_mul_f32 v18, s76, v18
  v_mfma_f32_16x16x32_bf16 v[124:127], v[68:71], v[252:255], v[124:127]
  ds_read_b128 v[236:239], v14 offset:3072
  v_mul_f32 v19, s76, v19
  v_mul_f32 v20, s76, v20
  v_mfma_f32_16x16x32_bf16 v[140:143], v[72:75], v[252:255], v[140:143]
  v_mul_f32 v21, s76, v21
  v_mul_f32 v22, s76, v22
  v_mfma_f32_16x16x32_bf16 v[156:159], v[76:79], v[252:255], v[156:159]
  v_mul_f32 v23, s76, v23
  v_cvt_pk_bf16_f32 v28, v16, v17
  v_mfma_f32_16x16x32_bf16 v[172:175], v[80:83], v[252:255], v[172:175]
  buffer_load_dwordx4 v9, s[36:39], s27 offen offset:1024 lds
  v_cvt_pk_bf16_f32 v29, v18, v19
  v_mfma_f32_16x16x32_bf16 v[188:191], v[84:87], v[252:255], v[188:191]
  v_cvt_pk_bf16_f32 v30, v20, v21
  v_cvt_pk_bf16_f32 v31, v22, v23
  v_mfma_f32_16x16x32_bf16 v[204:207], v[88:91], v[252:255], v[204:207]
  buffer_store_dwordx4 v[28:31], v2, s[40:43], s64 offen offset:3072 sc1
  v_mfma_f32_16x16x32_bf16 v[220:223], v[92:95], v[252:255], v[220:223]
  s_waitcnt vmcnt(18) lgkmcnt(0)
  v_mfma_f32_16x16x32_bf16 v[96:99], v[32:35], v[224:227], v[96:99]
  s_add_u32 s64, s64, 4096
  v_accvgpr_read_b32 v16, a224
  v_accvgpr_read_b32 v17, a225
  v_accvgpr_read_b32 v18, a226
  v_mfma_f32_16x16x32_bf16 v[112:115], v[36:39], v[224:227], v[112:115]
  ds_read_b64_tr_b16 v[64:65], v12 offset:40960
  v_accvgpr_read_b32 v19, a227
  v_mfma_f32_16x16x32_bf16 v[128:131], v[40:43], v[224:227], v[128:131]
  s_add_u32 m0, s24, 65536
  ds_read_b64_tr_b16 v[66:67], v12 offset:41984
  v_accvgpr_read_b32 v20, a228
  v_accvgpr_read_b32 v21, a229
  v_mfma_f32_16x16x32_bf16 v[144:147], v[44:47], v[224:227], v[144:147]
  buffer_load_dwordx4 v3, s[32:35], s26 offen offset:0 sc1 lds
  v_accvgpr_read_b32 v22, a230
  v_mfma_f32_16x16x32_bf16 v[160:163], v[48:51], v[224:227], v[160:163]
  ds_read_b64_tr_b16 v[68:69], v13 offset:40960
  v_accvgpr_read_b32 v23, a231
  v_mfma_f32_16x16x32_bf16 v[176:179], v[52:55], v[224:227], v[176:179]
  ds_read_b64_tr_b16 v[70:71], v13 offset:41984
  v_mul_f32 v16, s76, v16
  v_mul_f32 v17, s76, v17
  v_mfma_f32_16x16x32_bf16 v[192:195], v[56:59], v[224:227], v[192:195]
  ds_read_b64_tr_b16 v[72:73], v12 offset:41216
  v_mul_f32 v18, s76, v18
  v_mfma_f32_16x16x32_bf16 v[208:211], v[60:63], v[224:227], v[208:211]
  ds_read_b64_tr_b16 v[74:75], v12 offset:42240
  v_mul_f32 v19, s76, v19
  v_mul_f32 v20, s76, v20
  v_mfma_f32_16x16x32_bf16 v[100:103], v[32:35], v[228:231], v[100:103]
  buffer_load_dwordx4 v4, s[32:35], s26 offen offset:1024 sc1 lds
  v_mul_f32 v21, s76, v21
  v_mfma_f32_16x16x32_bf16 v[116:119], v[36:39], v[228:231], v[116:119]
  ds_read_b64_tr_b16 v[76:77], v13 offset:41216
  v_mul_f32 v22, s76, v22
  v_mfma_f32_16x16x32_bf16 v[132:135], v[40:43], v[228:231], v[132:135]
  ds_read_b64_tr_b16 v[78:79], v13 offset:42240
  v_mul_f32 v23, s76, v23
  v_cvt_pk_bf16_f32 v24, v16, v17
  v_mfma_f32_16x16x32_bf16 v[148:151], v[44:47], v[228:231], v[148:151]
  ds_read_b128 v[240:243], v14 offset:32768
  v_cvt_pk_bf16_f32 v25, v18, v19
  v_mfma_f32_16x16x32_bf16 v[164:167], v[48:51], v[228:231], v[164:167]
  ds_read_b128 v[244:247], v14 offset:33792
  v_cvt_pk_bf16_f32 v26, v20, v21
  v_cvt_pk_bf16_f32 v27, v22, v23
  v_mfma_f32_16x16x32_bf16 v[180:183], v[52:55], v[228:231], v[180:183]
  buffer_load_dwordx4 v5, s[32:35], s26 offen offset:2048 sc1 lds
  buffer_store_dwordx4 v[24:27], v2, s[40:43], s64 offen offset:0 sc1
  v_mfma_f32_16x16x32_bf16 v[196:199], v[56:59], v[228:231], v[196:199]
  ds_read_b64_tr_b16 v[80:81], v12 offset:41472
  v_accvgpr_read_b32 v16, a112
  v_mfma_f32_16x16x32_bf16 v[212:215], v[60:63], v[228:231], v[212:215]
  ds_read_b64_tr_b16 v[82:83], v12 offset:42496
  v_accvgpr_read_b32 v17, a113
  v_accvgpr_read_b32 v18, a114
  v_mfma_f32_16x16x32_bf16 v[104:107], v[32:35], v[232:235], v[104:107]
  ds_read_b64_tr_b16 v[84:85], v13 offset:41472
  v_accvgpr_read_b32 v19, a115
  v_mfma_f32_16x16x32_bf16 v[120:123], v[36:39], v[232:235], v[120:123]
  ds_read_b64_tr_b16 v[86:87], v13 offset:42496
  v_accvgpr_read_b32 v20, a116
  v_accvgpr_read_b32 v21, a117
  v_mfma_f32_16x16x32_bf16 v[136:139], v[40:43], v[232:235], v[136:139]
  buffer_load_dwordx4 v6, s[32:35], s26 offen offset:3072 sc1 lds
  v_accvgpr_read_b32 v22, a118
  v_mfma_f32_16x16x32_bf16 v[152:155], v[44:47], v[232:235], v[152:155]
  s_add_u32 s26, s26, 1024
  ds_read_b64_tr_b16 v[88:89], v12 offset:41728
  v_accvgpr_read_b32 v23, a119
  v_mfma_f32_16x16x32_bf16 v[168:171], v[48:51], v[232:235], v[168:171]
  ds_read_b64_tr_b16 v[90:91], v12 offset:42752
  v_mul_f32 v16, s76, v16
  v_mul_f32 v17, s76, v17
  v_mfma_f32_16x16x32_bf16 v[184:187], v[52:55], v[232:235], v[184:187]
  ds_read_b64_tr_b16 v[92:93], v13 offset:41728
  v_mul_f32 v18, s76, v18
  v_mfma_f32_16x16x32_bf16 v[200:203], v[56:59], v[232:235], v[200:203]
  s_add_u32 m0, s24, 16384
  ds_read_b64_tr_b16 v[94:95], v13 offset:42752
  v_mul_f32 v19, s76, v19
  v_mul_f32 v20, s76, v20
  v_mfma_f32_16x16x32_bf16 v[216:219], v[60:63], v[232:235], v[216:219]
  buffer_load_dwordx4 v10, s[36:39], s27 offen offset:2048 lds
  v_mul_f32 v21, s76, v21
  v_mfma_f32_16x16x32_bf16 v[108:111], v[32:35], v[236:239], v[108:111]
  ds_read_b128 v[248:251], v14 offset:34816
  v_mul_f32 v22, s76, v22
  v_mfma_f32_16x16x32_bf16 v[124:127], v[36:39], v[236:239], v[124:127]
  ds_read_b128 v[252:255], v14 offset:35840
  v_mul_f32 v23, s76, v23
  v_cvt_pk_bf16_f32 v28, v16, v17
  v_mfma_f32_16x16x32_bf16 v[140:143], v[40:43], v[236:239], v[140:143]
  v_cvt_pk_bf16_f32 v29, v18, v19
  v_cvt_pk_bf16_f32 v30, v20, v21
  v_mfma_f32_16x16x32_bf16 v[156:159], v[44:47], v[236:239], v[156:159]
  v_xor_b32 v14, 0x10000, v14
  v_cvt_pk_bf16_f32 v31, v22, v23
  v_accvgpr_write_b32 a192, v28
  v_mfma_f32_16x16x32_bf16 v[172:175], v[48:51], v[236:239], v[172:175]
  buffer_load_dwordx4 v11, s[36:39], s27 offen offset:3072 lds
  v_accvgpr_write_b32 a193, v29
  v_mfma_f32_16x16x32_bf16 v[188:191], v[52:55], v[236:239], v[188:191]
  s_add_u32 s27, s27, 524288
  v_xor_b32 v12, 0x10000, v12
  v_accvgpr_write_b32 a194, v30
  v_mfma_f32_16x16x32_bf16 v[204:207], v[56:59], v[236:239], v[204:207]
  v_xor_b32 v13, 0x10000, v13
  v_accvgpr_write_b32 a195, v31
  v_mfma_f32_16x16x32_bf16 v[220:223], v[60:63], v[236:239], v[220:223]
  s_waitcnt vmcnt(16) lgkmcnt(0)
  v_mfma_f32_16x16x32_bf16 v[96:99], v[64:67], v[240:243], v[96:99]
  s_barrier
  v_accvgpr_read_b32 v16, a232
  v_accvgpr_read_b32 v17, a233
  v_accvgpr_read_b32 v18, a234
  v_mfma_f32_16x16x32_bf16 v[112:115], v[68:71], v[240:243], v[112:115]
  ds_read_b64_tr_b16 v[32:33], v12 offset:0
  v_accvgpr_read_b32 v19, a235
  v_mfma_f32_16x16x32_bf16 v[128:131], v[72:75], v[240:243], v[128:131]
  s_add_u32 m0, s24, 98304
  ds_read_b64_tr_b16 v[34:35], v12 offset:1024
  v_accvgpr_read_b32 v20, a236
  v_mfma_f32_16x16x32_bf16 v[144:147], v[76:79], v[240:243], v[144:147]
  buffer_load_dwordx4 v3, s[32:35], s26 offen offset:0 sc1 lds
  v_accvgpr_read_b32 v21, a237
  v_accvgpr_read_b32 v22, a238
  v_mfma_f32_16x16x32_bf16 v[160:163], v[80:83], v[240:243], v[160:163]
  ds_read_b64_tr_b16 v[36:37], v13 offset:0
  v_accvgpr_read_b32 v23, a239
  v_mfma_f32_16x16x32_bf16 v[176:179], v[84:87], v[240:243], v[176:179]
  ds_read_b64_tr_b16 v[38:39], v13 offset:1024
  v_mul_f32 v16, s76, v16
  v_mfma_f32_16x16x32_bf16 v[192:195], v[88:91], v[240:243], v[192:195]
  ds_read_b64_tr_b16 v[40:41], v12 offset:256
  v_mul_f32 v17, s76, v17
  v_mul_f32 v18, s76, v18
  v_mfma_f32_16x16x32_bf16 v[208:211], v[92:95], v[240:243], v[208:211]
  ds_read_b64_tr_b16 v[42:43], v12 offset:1280
  v_mul_f32 v19, s76, v19
  v_mfma_f32_16x16x32_bf16 v[100:103], v[64:67], v[244:247], v[100:103]
  buffer_load_dwordx4 v4, s[32:35], s26 offen offset:1024 sc1 lds
  v_mul_f32 v20, s76, v20
  v_mfma_f32_16x16x32_bf16 v[116:119], v[68:71], v[244:247], v[116:119]
  ds_read_b64_tr_b16 v[44:45], v13 offset:256
  v_mul_f32 v21, s76, v21
  v_mfma_f32_16x16x32_bf16 v[132:135], v[72:75], v[244:247], v[132:135]
  ds_read_b64_tr_b16 v[46:47], v13 offset:1280
  v_mul_f32 v22, s76, v22
  v_mul_f32 v23, s76, v23
  v_mfma_f32_16x16x32_bf16 v[148:151], v[76:79], v[244:247], v[148:151]
  ds_read_b128 v[224:227], v14 offset:0
  v_cvt_pk_bf16_f32 v24, v16, v17
  v_mfma_f32_16x16x32_bf16 v[164:167], v[80:83], v[244:247], v[164:167]
  ds_read_b128 v[228:231], v14 offset:1024
  v_cvt_pk_bf16_f32 v25, v18, v19
  v_mfma_f32_16x16x32_bf16 v[180:183], v[84:87], v[244:247], v[180:183]
  buffer_load_dwordx4 v5, s[32:35], s26 offen offset:2048 sc1 lds
  v_cvt_pk_bf16_f32 v26, v20, v21
  v_cvt_pk_bf16_f32 v27, v22, v23
  v_mfma_f32_16x16x32_bf16 v[196:199], v[88:91], v[244:247], v[196:199]
  ds_read_b64_tr_b16 v[48:49], v12 offset:512
  buffer_store_dwordx4 v[24:27], v2, s[40:43], s64 offen offset:1024 sc1
  v_mfma_f32_16x16x32_bf16 v[212:215], v[92:95], v[244:247], v[212:215]
  ds_read_b64_tr_b16 v[50:51], v12 offset:1536
  v_accvgpr_read_b32 v16, a120
  v_mfma_f32_16x16x32_bf16 v[104:107], v[64:67], v[248:251], v[104:107]
  ds_read_b64_tr_b16 v[52:53], v13 offset:512
  v_accvgpr_read_b32 v17, a121
  v_accvgpr_read_b32 v18, a122
  v_mfma_f32_16x16x32_bf16 v[120:123], v[68:71], v[248:251], v[120:123]
  ds_read_b64_tr_b16 v[54:55], v13 offset:1536
  v_accvgpr_read_b32 v19, a123
  v_mfma_f32_16x16x32_bf16 v[136:139], v[72:75], v[248:251], v[136:139]
  buffer_load_dwordx4 v6, s[32:35], s26 offen offset:3072 sc1 lds
  v_accvgpr_read_b32 v20, a124
  v_mfma_f32_16x16x32_bf16 v[152:155], v[76:79], v[248:251], v[152:155]
  s_add_u32 s26, s26, 1024
  ds_read_b64_tr_b16 v[56:57], v12 offset:768
  v_accvgpr_read_b32 v21, a125
  v_mfma_f32_16x16x32_bf16 v[168:171], v[80:83], v[248:251], v[168:171]
  ds_read_b64_tr_b16 v[58:59], v12 offset:1792
  v_accvgpr_read_b32 v22, a126
  v_accvgpr_read_b32 v23, a127
  v_mfma_f32_16x16x32_bf16 v[184:187], v[84:87], v[248:251], v[184:187]
  ds_read_b64_tr_b16 v[60:61], v13 offset:768
  v_mul_f32 v16, s76, v16
  v_mfma_f32_16x16x32_bf16 v[200:203], v[88:91], v[248:251], v[200:203]
  s_add_u32 m0, s24, 49152
  ds_read_b64_tr_b16 v[62:63], v13 offset:1792
  v_mul_f32 v17, s76, v17
  v_mfma_f32_16x16x32_bf16 v[216:219], v[92:95], v[248:251], v[216:219]
  buffer_load_dwordx4 v8, s[36:39], s27 offen offset:0 lds
  v_mul_f32 v18, s76, v18
  v_mul_f32 v19, s76, v19
  v_mfma_f32_16x16x32_bf16 v[108:111], v[64:67], v[252:255], v[108:111]
  ds_read_b128 v[232:235], v14 offset:2048
  v_mul_f32 v20, s76, v20
  v_mfma_f32_16x16x32_bf16 v[124:127], v[68:71], v[252:255], v[124:127]
  ds_read_b128 v[236:239], v14 offset:3072
  v_mul_f32 v21, s76, v21
  v_mfma_f32_16x16x32_bf16 v[140:143], v[72:75], v[252:255], v[140:143]
  v_mul_f32 v22, s76, v22
  v_mul_f32 v23, s76, v23
  v_cvt_pk_bf16_f32 v28, v16, v17
  v_mfma_f32_16x16x32_bf16 v[156:159], v[76:79], v[252:255], v[156:159]
  v_cvt_pk_bf16_f32 v29, v18, v19
  v_cvt_pk_bf16_f32 v30, v20, v21
  v_mfma_f32_16x16x32_bf16 v[172:175], v[80:83], v[252:255], v[172:175]
  buffer_load_dwordx4 v9, s[36:39], s27 offen offset:1024 lds
  v_cvt_pk_bf16_f32 v31, v22, v23
  v_mfma_f32_16x16x32_bf16 v[188:191], v[84:87], v[252:255], v[188:191]
  v_accvgpr_write_b32 a196, v28
  v_accvgpr_write_b32 a197, v29
  v_mfma_f32_16x16x32_bf16 v[204:207], v[88:91], v[252:255], v[204:207]
  v_accvgpr_write_b32 a198, v30
  v_accvgpr_write_b32 a199, v31
  v_mfma_f32_16x16x32_bf16 v[220:223], v[92:95], v[252:255], v[220:223]
  s_waitcnt vmcnt(17) lgkmcnt(0)
  v_mfma_f32_16x16x32_bf16 v[96:99], v[32:35], v[224:227], v[96:99]
  v_accvgpr_read_b32 v16, a240
  v_accvgpr_read_b32 v17, a241
  v_accvgpr_read_b32 v18, a242
  v_mfma_f32_16x16x32_bf16 v[112:115], v[36:39], v[224:227], v[112:115]
  ds_read_b64_tr_b16 v[64:65], v12 offset:8192
  v_accvgpr_read_b32 v19, a243
  v_mfma_f32_16x16x32_bf16 v[128:131], v[40:43], v[224:227], v[128:131]
  s_add_u32 m0, s24, 0
  ds_read_b64_tr_b16 v[66:67], v12 offset:9216
  v_accvgpr_read_b32 v20, a244
  v_mfma_f32_16x16x32_bf16 v[144:147], v[44:47], v[224:227], v[144:147]
  buffer_load_dwordx4 v3, s[32:35], s26 offen offset:0 sc1 lds
  v_accvgpr_read_b32 v21, a245
  v_accvgpr_read_b32 v22, a246
  v_mfma_f32_16x16x32_bf16 v[160:163], v[48:51], v[224:227], v[160:163]
  ds_read_b64_tr_b16 v[68:69], v13 offset:8192
  v_accvgpr_read_b32 v23, a247
  v_mfma_f32_16x16x32_bf16 v[176:179], v[52:55], v[224:227], v[176:179]
  ds_read_b64_tr_b16 v[70:71], v13 offset:9216
  v_mul_f32 v16, s76, v16
  v_mfma_f32_16x16x32_bf16 v[192:195], v[56:59], v[224:227], v[192:195]
  ds_read_b64_tr_b16 v[72:73], v12 offset:8448
  v_mul_f32 v17, s76, v17
  v_mul_f32 v18, s76, v18
  v_mfma_f32_16x16x32_bf16 v[208:211], v[60:63], v[224:227], v[208:211]
  ds_read_b64_tr_b16 v[74:75], v12 offset:9472
  v_mul_f32 v19, s76, v19
  v_mfma_f32_16x16x32_bf16 v[100:103], v[32:35], v[228:231], v[100:103]
  buffer_load_dwordx4 v4, s[32:35], s26 offen offset:1024 sc1 lds
  v_mul_f32 v20, s76, v20
  v_mfma_f32_16x16x32_bf16 v[116:119], v[36:39], v[228:231], v[116:119]
  ds_read_b64_tr_b16 v[76:77], v13 offset:8448
  v_mul_f32 v21, s76, v21
  v_mul_f32 v22, s76, v22
  v_mfma_f32_16x16x32_bf16 v[132:135], v[40:43], v[228:231], v[132:135]
  ds_read_b64_tr_b16 v[78:79], v13 offset:9472
  v_mul_f32 v23, s76, v23
  v_mfma_f32_16x16x32_bf16 v[148:151], v[44:47], v[228:231], v[148:151]
  ds_read_b128 v[240:243], v14 offset:32768
  v_cvt_pk_bf16_f32 v24, v16, v17
  v_mfma_f32_16x16x32_bf16 v[164:167], v[48:51], v[228:231], v[164:167]
  ds_read_b128 v[244:247], v14 offset:33792
  v_cvt_pk_bf16_f32 v25, v18, v19
  v_cvt_pk_bf16_f32 v26, v20, v21
  v_mfma_f32_16x16x32_bf16 v[180:183], v[52:55], v[228:231], v[180:183]
  buffer_load_dwordx4 v5, s[32:35], s26 offen offset:2048 sc1 lds
  v_cvt_pk_bf16_f32 v27, v22, v23
  v_mfma_f32_16x16x32_bf16 v[196:199], v[56:59], v[228:231], v[196:199]
  ds_read_b64_tr_b16 v[80:81], v12 offset:8704
  buffer_store_dwordx4 v[24:27], v2, s[40:43], s64 offen offset:2048 sc1
  v_mfma_f32_16x16x32_bf16 v[212:215], v[60:63], v[228:231], v[212:215]
  ds_read_b64_tr_b16 v[82:83], v12 offset:9728
  v_accvgpr_read_b32 v16, a128
  v_accvgpr_read_b32 v17, a129
  v_mfma_f32_16x16x32_bf16 v[104:107], v[32:35], v[232:235], v[104:107]
  ds_read_b64_tr_b16 v[84:85], v13 offset:8704
  v_accvgpr_read_b32 v18, a130
  v_mfma_f32_16x16x32_bf16 v[120:123], v[36:39], v[232:235], v[120:123]
  ds_read_b64_tr_b16 v[86:87], v13 offset:9728
  v_accvgpr_read_b32 v19, a131
  v_mfma_f32_16x16x32_bf16 v[136:139], v[40:43], v[232:235], v[136:139]
  buffer_load_dwordx4 v6, s[32:35], s26 offen offset:3072 sc1 lds
  v_accvgpr_read_b32 v20, a132
  v_accvgpr_read_b32 v21, a133
  v_mfma_f32_16x16x32_bf16 v[152:155], v[44:47], v[232:235], v[152:155]
  s_add_u32 s26, s26, 1024
  ds_read_b64_tr_b16 v[88:89], v12 offset:8960
  v_accvgpr_read_b32 v22, a134
  v_mfma_f32_16x16x32_bf16 v[168:171], v[48:51], v[232:235], v[168:171]
  ds_read_b64_tr_b16 v[90:91], v12 offset:9984
  v_accvgpr_read_b32 v23, a135
  v_mfma_f32_16x16x32_bf16 v[184:187], v[52:55], v[232:235], v[184:187]
  ds_read_b64_tr_b16 v[92:93], v13 offset:8960
  v_mul_f32 v16, s76, v16
  v_mul_f32 v17, s76, v17
  v_mfma_f32_16x16x32_bf16 v[200:203], v[56:59], v[232:235], v[200:203]
  s_add_u32 m0, s24, 49152
  ds_read_b64_tr_b16 v[94:95], v13 offset:9984
  v_mul_f32 v18, s76, v18
  v_mfma_f32_16x16x32_bf16 v[216:219], v[60:63], v[232:235], v[216:219]
  buffer_load_dwordx4 v10, s[36:39], s27 offen offset:2048 lds
  v_mul_f32 v19, s76, v19
  v_mfma_f32_16x16x32_bf16 v[108:111], v[32:35], v[236:239], v[108:111]
  ds_read_b128 v[248:251], v14 offset:34816
  v_mul_f32 v20, s76, v20
  v_mul_f32 v21, s76, v21
  v_mfma_f32_16x16x32_bf16 v[124:127], v[36:39], v[236:239], v[124:127]
  ds_read_b128 v[252:255], v14 offset:35840
  v_mul_f32 v22, s76, v22
  v_mfma_f32_16x16x32_bf16 v[140:143], v[40:43], v[236:239], v[140:143]
  v_mul_f32 v23, s76, v23
  v_cvt_pk_bf16_f32 v28, v16, v17
  v_mfma_f32_16x16x32_bf16 v[156:159], v[44:47], v[236:239], v[156:159]
  v_xor_b32 v14, 0x10000, v14
  v_cvt_pk_bf16_f32 v29, v18, v19
  v_cvt_pk_bf16_f32 v30, v20, v21
  v_mfma_f32_16x16x32_bf16 v[172:175], v[48:51], v[236:239], v[172:175]
  buffer_load_dwordx4 v11, s[36:39], s27 offen offset:3072 lds
  v_cvt_pk_bf16_f32 v31, v22, v23
  v_mfma_f32_16x16x32_bf16 v[188:191], v[52:55], v[236:239], v[188:191]
  s_add_u32 s27, s27, 524288
  v_accvgpr_write_b32 a200, v28
  v_accvgpr_write_b32 a201, v29
  v_mfma_f32_16x16x32_bf16 v[204:207], v[56:59], v[236:239], v[204:207]
  v_accvgpr_write_b32 a202, v30
  v_accvgpr_write_b32 a203, v31
  v_mfma_f32_16x16x32_bf16 v[220:223], v[60:63], v[236:239], v[220:223]
  s_waitcnt vmcnt(16) lgkmcnt(0)
  v_mfma_f32_16x16x32_bf16 v[96:99], v[64:67], v[240:243], v[96:99]
  s_barrier
  v_accvgpr_read_b32 v16, a248
  v_accvgpr_read_b32 v17, a249
  v_accvgpr_read_b32 v18, a250
  v_mfma_f32_16x16x32_bf16 v[112:115], v[68:71], v[240:243], v[112:115]
  ds_read_b64_tr_b16 v[32:33], v12 offset:32768
  v_accvgpr_read_b32 v19, a251
  v_mfma_f32_16x16x32_bf16 v[128:131], v[72:75], v[240:243], v[128:131]
  s_add_u32 m0, s24, 32768
  ds_read_b64_tr_b16 v[34:35], v12 offset:33792
  v_accvgpr_read_b32 v20, a252
  v_mfma_f32_16x16x32_bf16 v[144:147], v[76:79], v[240:243], v[144:147]
  buffer_load_dwordx4 v3, s[32:35], s26 offen offset:0 sc1 lds
  v_accvgpr_read_b32 v21, a253
  v_accvgpr_read_b32 v22, a254
  v_mfma_f32_16x16x32_bf16 v[160:163], v[80:83], v[240:243], v[160:163]
  ds_read_b64_tr_b16 v[36:37], v13 offset:32768
  v_accvgpr_read_b32 v23, a255
  v_mfma_f32_16x16x32_bf16 v[176:179], v[84:87], v[240:243], v[176:179]
  ds_read_b64_tr_b16 v[38:39], v13 offset:33792
  v_mul_f32 v16, s76, v16
  v_mfma_f32_16x16x32_bf16 v[192:195], v[88:91], v[240:243], v[192:195]
  ds_read_b64_tr_b16 v[40:41], v12 offset:33024
  v_mul_f32 v17, s76, v17
  v_mul_f32 v18, s76, v18
  v_mfma_f32_16x16x32_bf16 v[208:211], v[92:95], v[240:243], v[208:211]
  ds_read_b64_tr_b16 v[42:43], v12 offset:34048
  v_mul_f32 v19, s76, v19
  v_mfma_f32_16x16x32_bf16 v[100:103], v[64:67], v[244:247], v[100:103]
  buffer_load_dwordx4 v4, s[32:35], s26 offen offset:1024 sc1 lds
  v_mul_f32 v20, s76, v20
  v_mfma_f32_16x16x32_bf16 v[116:119], v[68:71], v[244:247], v[116:119]
  ds_read_b64_tr_b16 v[44:45], v13 offset:33024
  v_mul_f32 v21, s76, v21
  v_mfma_f32_16x16x32_bf16 v[132:135], v[72:75], v[244:247], v[132:135]
  ds_read_b64_tr_b16 v[46:47], v13 offset:34048
  v_mul_f32 v22, s76, v22
  v_mul_f32 v23, s76, v23
  v_mfma_f32_16x16x32_bf16 v[148:151], v[76:79], v[244:247], v[148:151]
  ds_read_b128 v[224:227], v14 offset:0
  v_cvt_pk_bf16_f32 v24, v16, v17
  v_mfma_f32_16x16x32_bf16 v[164:167], v[80:83], v[244:247], v[164:167]
  ds_read_b128 v[228:231], v14 offset:1024
  v_cvt_pk_bf16_f32 v25, v18, v19
  v_mfma_f32_16x16x32_bf16 v[180:183], v[84:87], v[244:247], v[180:183]
  buffer_load_dwordx4 v5, s[32:35], s26 offen offset:2048 sc1 lds
  v_cvt_pk_bf16_f32 v26, v20, v21
  v_cvt_pk_bf16_f32 v27, v22, v23
  v_mfma_f32_16x16x32_bf16 v[196:199], v[88:91], v[244:247], v[196:199]
  ds_read_b64_tr_b16 v[48:49], v12 offset:33280
  buffer_store_dwordx4 v[24:27], v2, s[40:43], s64 offen offset:3072 sc1
  v_mfma_f32_16x16x32_bf16 v[212:215], v[92:95], v[244:247], v[212:215]
  ds_read_b64_tr_b16 v[50:51], v12 offset:34304
  v_accvgpr_read_b32 v16, a136
  v_mfma_f32_16x16x32_bf16 v[104:107], v[64:67], v[248:251], v[104:107]
  ds_read_b64_tr_b16 v[52:53], v13 offset:33280
  v_accvgpr_read_b32 v17, a137
  v_accvgpr_read_b32 v18, a138
  v_mfma_f32_16x16x32_bf16 v[120:123], v[68:71], v[248:251], v[120:123]
  ds_read_b64_tr_b16 v[54:55], v13 offset:34304
  v_accvgpr_read_b32 v19, a139
  v_mfma_f32_16x16x32_bf16 v[136:139], v[72:75], v[248:251], v[136:139]
  buffer_load_dwordx4 v6, s[32:35], s26 offen offset:3072 sc1 lds
  v_accvgpr_read_b32 v20, a140
  v_mfma_f32_16x16x32_bf16 v[152:155], v[76:79], v[248:251], v[152:155]
  s_add_u32 s26, s26, 1024
  ds_read_b64_tr_b16 v[56:57], v12 offset:33536
  v_accvgpr_read_b32 v21, a141
  v_mfma_f32_16x16x32_bf16 v[168:171], v[80:83], v[248:251], v[168:171]
  ds_read_b64_tr_b16 v[58:59], v12 offset:34560
  v_accvgpr_read_b32 v22, a142
  v_accvgpr_read_b32 v23, a143
  v_mfma_f32_16x16x32_bf16 v[184:187], v[84:87], v[248:251], v[184:187]
  ds_read_b64_tr_b16 v[60:61], v13 offset:33536
  v_mul_f32 v16, s76, v16
  v_mfma_f32_16x16x32_bf16 v[200:203], v[88:91], v[248:251], v[200:203]
  s_add_u32 m0, s24, 81920
  ds_read_b64_tr_b16 v[62:63], v13 offset:34560
  v_mul_f32 v17, s76, v17
  v_mfma_f32_16x16x32_bf16 v[216:219], v[92:95], v[248:251], v[216:219]
  buffer_load_dwordx4 v8, s[36:39], s27 offen offset:0 lds
  v_mul_f32 v18, s76, v18
  v_mul_f32 v19, s76, v19
  v_mfma_f32_16x16x32_bf16 v[108:111], v[64:67], v[252:255], v[108:111]
  ds_read_b128 v[232:235], v14 offset:2048
  v_mul_f32 v20, s76, v20
  v_mfma_f32_16x16x32_bf16 v[124:127], v[68:71], v[252:255], v[124:127]
  ds_read_b128 v[236:239], v14 offset:3072
  v_mul_f32 v21, s76, v21
  v_mfma_f32_16x16x32_bf16 v[140:143], v[72:75], v[252:255], v[140:143]
  v_mul_f32 v22, s76, v22
  v_mul_f32 v23, s76, v23
  v_cvt_pk_bf16_f32 v28, v16, v17
  v_mfma_f32_16x16x32_bf16 v[156:159], v[76:79], v[252:255], v[156:159]
  v_cvt_pk_bf16_f32 v29, v18, v19
  v_cvt_pk_bf16_f32 v30, v20, v21
  v_mfma_f32_16x16x32_bf16 v[172:175], v[80:83], v[252:255], v[172:175]
  buffer_load_dwordx4 v9, s[36:39], s27 offen offset:1024 lds
  v_cvt_pk_bf16_f32 v31, v22, v23
  v_mfma_f32_16x16x32_bf16 v[188:191], v[84:87], v[252:255], v[188:191]
  v_accvgpr_write_b32 a204, v28
  v_accvgpr_write_b32 a205, v29
  v_mfma_f32_16x16x32_bf16 v[204:207], v[88:91], v[252:255], v[204:207]
  v_accvgpr_write_b32 a206, v30
  v_accvgpr_write_b32 a207, v31
  v_mfma_f32_16x16x32_bf16 v[220:223], v[92:95], v[252:255], v[220:223]
  s_waitcnt vmcnt(16) lgkmcnt(0)
  v_mfma_f32_16x16x32_bf16 v[96:99], v[32:35], v[224:227], v[96:99]
  s_add_u32 s64, s64, 126976
  v_accvgpr_read_b32 v16, a0
  v_accvgpr_read_b32 v17, a1
  v_accvgpr_read_b32 v18, a2
  v_mfma_f32_16x16x32_bf16 v[112:115], v[36:39], v[224:227], v[112:115]
  ds_read_b64_tr_b16 v[64:65], v12 offset:40960
  v_accvgpr_read_b32 v19, a3
  v_mfma_f32_16x16x32_bf16 v[128:131], v[40:43], v[224:227], v[128:131]
  s_add_u32 m0, s24, 65536
  ds_read_b64_tr_b16 v[66:67], v12 offset:41984
  v_accvgpr_read_b32 v20, a4
  v_accvgpr_read_b32 v21, a5
  v_mfma_f32_16x16x32_bf16 v[144:147], v[44:47], v[224:227], v[144:147]
  buffer_load_dwordx4 v3, s[32:35], s26 offen offset:0 sc1 lds
  v_accvgpr_read_b32 v22, a6
  v_mfma_f32_16x16x32_bf16 v[160:163], v[48:51], v[224:227], v[160:163]
  ds_read_b64_tr_b16 v[68:69], v13 offset:40960
  v_accvgpr_read_b32 v23, a7
  v_mfma_f32_16x16x32_bf16 v[176:179], v[52:55], v[224:227], v[176:179]
  ds_read_b64_tr_b16 v[70:71], v13 offset:41984
  v_mul_f32 v16, s76, v16
  v_mul_f32 v17, s76, v17
  v_mfma_f32_16x16x32_bf16 v[192:195], v[56:59], v[224:227], v[192:195]
  ds_read_b64_tr_b16 v[72:73], v12 offset:41216
  v_mul_f32 v18, s76, v18
  v_mfma_f32_16x16x32_bf16 v[208:211], v[60:63], v[224:227], v[208:211]
  ds_read_b64_tr_b16 v[74:75], v12 offset:42240
  v_mul_f32 v19, s76, v19
  v_mul_f32 v20, s76, v20
  v_mfma_f32_16x16x32_bf16 v[100:103], v[32:35], v[228:231], v[100:103]
  buffer_load_dwordx4 v4, s[32:35], s26 offen offset:1024 sc1 lds
  v_mul_f32 v21, s76, v21
  v_mfma_f32_16x16x32_bf16 v[116:119], v[36:39], v[228:231], v[116:119]
  ds_read_b64_tr_b16 v[76:77], v13 offset:41216
  v_mul_f32 v22, s76, v22
  v_mfma_f32_16x16x32_bf16 v[132:135], v[40:43], v[228:231], v[132:135]
  ds_read_b64_tr_b16 v[78:79], v13 offset:42240
  v_mul_f32 v23, s76, v23
  v_cvt_pk_bf16_f32 v24, v16, v17
  v_mfma_f32_16x16x32_bf16 v[148:151], v[44:47], v[228:231], v[148:151]
  ds_read_b128 v[240:243], v14 offset:32768
  v_cvt_pk_bf16_f32 v25, v18, v19
  v_mfma_f32_16x16x32_bf16 v[164:167], v[48:51], v[228:231], v[164:167]
  ds_read_b128 v[244:247], v14 offset:33792
  v_cvt_pk_bf16_f32 v26, v20, v21
  v_cvt_pk_bf16_f32 v27, v22, v23
  v_mfma_f32_16x16x32_bf16 v[180:183], v[52:55], v[228:231], v[180:183]
  buffer_load_dwordx4 v5, s[32:35], s26 offen offset:2048 sc1 lds
  buffer_store_dwordx4 v[24:27], v2, s[40:43], s64 offen offset:0 sc1
  v_mfma_f32_16x16x32_bf16 v[196:199], v[56:59], v[228:231], v[196:199]
  ds_read_b64_tr_b16 v[80:81], v12 offset:41472
  v_accvgpr_read_b32 v16, a144
  v_mfma_f32_16x16x32_bf16 v[212:215], v[60:63], v[228:231], v[212:215]
  ds_read_b64_tr_b16 v[82:83], v12 offset:42496
  v_accvgpr_read_b32 v17, a145
  v_accvgpr_read_b32 v18, a146
  v_mfma_f32_16x16x32_bf16 v[104:107], v[32:35], v[232:235], v[104:107]
  ds_read_b64_tr_b16 v[84:85], v13 offset:41472
  v_accvgpr_read_b32 v19, a147
  v_mfma_f32_16x16x32_bf16 v[120:123], v[36:39], v[232:235], v[120:123]
  ds_read_b64_tr_b16 v[86:87], v13 offset:42496
  v_accvgpr_read_b32 v20, a148
  v_accvgpr_read_b32 v21, a149
  v_mfma_f32_16x16x32_bf16 v[136:139], v[40:43], v[232:235], v[136:139]
  buffer_load_dwordx4 v6, s[32:35], s26 offen offset:3072 sc1 lds
  v_accvgpr_read_b32 v22, a150
  v_mfma_f32_16x16x32_bf16 v[152:155], v[44:47], v[232:235], v[152:155]
  s_add_u32 s26, s26, 1024
  ds_read_b64_tr_b16 v[88:89], v12 offset:41728
  v_accvgpr_read_b32 v23, a151
  v_mfma_f32_16x16x32_bf16 v[168:171], v[48:51], v[232:235], v[168:171]
  ds_read_b64_tr_b16 v[90:91], v12 offset:42752
  v_mul_f32 v16, s76, v16
  v_mul_f32 v17, s76, v17
  v_mfma_f32_16x16x32_bf16 v[184:187], v[52:55], v[232:235], v[184:187]
  ds_read_b64_tr_b16 v[92:93], v13 offset:41728
  v_mul_f32 v18, s76, v18
  v_mfma_f32_16x16x32_bf16 v[200:203], v[56:59], v[232:235], v[200:203]
  s_add_u32 m0, s24, 81920
  ds_read_b64_tr_b16 v[94:95], v13 offset:42752
  v_mul_f32 v19, s76, v19
  v_mul_f32 v20, s76, v20
  v_mfma_f32_16x16x32_bf16 v[216:219], v[60:63], v[232:235], v[216:219]
  buffer_load_dwordx4 v10, s[36:39], s27 offen offset:2048 lds
  v_mul_f32 v21, s76, v21
  v_mfma_f32_16x16x32_bf16 v[108:111], v[32:35], v[236:239], v[108:111]
  ds_read_b128 v[248:251], v14 offset:34816
  v_mul_f32 v22, s76, v22
  v_mfma_f32_16x16x32_bf16 v[124:127], v[36:39], v[236:239], v[124:127]
  ds_read_b128 v[252:255], v14 offset:35840
  v_mul_f32 v23, s76, v23
  v_cvt_pk_bf16_f32 v28, v16, v17
  v_mfma_f32_16x16x32_bf16 v[140:143], v[40:43], v[236:239], v[140:143]
  v_cvt_pk_bf16_f32 v29, v18, v19
  v_cvt_pk_bf16_f32 v30, v20, v21
  v_mfma_f32_16x16x32_bf16 v[156:159], v[44:47], v[236:239], v[156:159]
  v_xor_b32 v14, 0x10000, v14
  v_cvt_pk_bf16_f32 v31, v22, v23
  v_accvgpr_write_b32 a208, v28
  v_mfma_f32_16x16x32_bf16 v[172:175], v[48:51], v[236:239], v[172:175]
  buffer_load_dwordx4 v11, s[36:39], s27 offen offset:3072 lds
  v_accvgpr_write_b32 a209, v29
  v_mfma_f32_16x16x32_bf16 v[188:191], v[52:55], v[236:239], v[188:191]
  s_add_u32 s27, s27, 524288
  v_xor_b32 v12, 0x10000, v12
  v_accvgpr_write_b32 a210, v30
  v_mfma_f32_16x16x32_bf16 v[204:207], v[56:59], v[236:239], v[204:207]
  v_xor_b32 v13, 0x10000, v13
  v_accvgpr_write_b32 a211, v31
  v_mfma_f32_16x16x32_bf16 v[220:223], v[60:63], v[236:239], v[220:223]
  s_waitcnt vmcnt(10) lgkmcnt(0)
  v_mfma_f32_16x16x32_bf16 v[96:99], v[64:67], v[240:243], v[96:99]
  s_barrier
  buffer_store_dword v12, off, s[40:43], s65 sc1
  v_accvgpr_read_b32 v16, a8
  v_accvgpr_read_b32 v17, a9
  v_mfma_f32_16x16x32_bf16 v[112:115], v[68:71], v[240:243], v[112:115]
  ds_read_b64_tr_b16 v[32:33], v12 offset:0
  v_accvgpr_read_b32 v18, a10
  v_mfma_f32_16x16x32_bf16 v[128:131], v[72:75], v[240:243], v[128:131]
  s_add_u32 m0, s24, 98304
  ds_read_b64_tr_b16 v[34:35], v12 offset:1024
  v_accvgpr_read_b32 v19, a11
  v_mfma_f32_16x16x32_bf16 v[144:147], v[76:79], v[240:243], v[144:147]
  buffer_load_dwordx4 v3, s[32:35], s26 offen offset:0 sc1 lds
  v_accvgpr_read_b32 v20, a12
  v_accvgpr_read_b32 v21, a13
  v_mfma_f32_16x16x32_bf16 v[160:163], v[80:83], v[240:243], v[160:163]
  ds_read_b64_tr_b16 v[36:37], v13 offset:0
  v_accvgpr_read_b32 v22, a14
  v_mfma_f32_16x16x32_bf16 v[176:179], v[84:87], v[240:243], v[176:179]
  ds_read_b64_tr_b16 v[38:39], v13 offset:1024
  v_accvgpr_read_b32 v23, a15
  v_mfma_f32_16x16x32_bf16 v[192:195], v[88:91], v[240:243], v[192:195]
  ds_read_b64_tr_b16 v[40:41], v12 offset:256
  v_mul_f32 v16, s76, v16
  v_mul_f32 v17, s76, v17
  v_mfma_f32_16x16x32_bf16 v[208:211], v[92:95], v[240:243], v[208:211]
  ds_read_b64_tr_b16 v[42:43], v12 offset:1280
  v_mul_f32 v18, s76, v18
  v_mfma_f32_16x16x32_bf16 v[100:103], v[64:67], v[244:247], v[100:103]
  buffer_load_dwordx4 v4, s[32:35], s26 offen offset:1024 sc1 lds
  v_mul_f32 v19, s76, v19
  v_mfma_f32_16x16x32_bf16 v[116:119], v[68:71], v[244:247], v[116:119]
  ds_read_b64_tr_b16 v[44:45], v13 offset:256
  v_mul_f32 v20, s76, v20
  v_mul_f32 v21, s76, v21
  v_mfma_f32_16x16x32_bf16 v[132:135], v[72:75], v[244:247], v[132:135]
  ds_read_b64_tr_b16 v[46:47], v13 offset:1280
  v_mul_f32 v22, s76, v22
  v_mfma_f32_16x16x32_bf16 v[148:151], v[76:79], v[244:247], v[148:151]
  ds_read_b128 v[224:227], v14 offset:0
  v_mul_f32 v23, s76, v23
  v_mfma_f32_16x16x32_bf16 v[164:167], v[80:83], v[244:247], v[164:167]
  ds_read_b128 v[228:231], v14 offset:1024
  v_cvt_pk_bf16_f32 v24, v16, v17
  v_cvt_pk_bf16_f32 v25, v18, v19
  v_mfma_f32_16x16x32_bf16 v[180:183], v[84:87], v[244:247], v[180:183]
  buffer_load_dwordx4 v5, s[32:35], s26 offen offset:2048 sc1 lds
  v_cvt_pk_bf16_f32 v26, v20, v21
  v_mfma_f32_16x16x32_bf16 v[196:199], v[88:91], v[244:247], v[196:199]
  ds_read_b64_tr_b16 v[48:49], v12 offset:512
  v_cvt_pk_bf16_f32 v27, v22, v23
  v_mfma_f32_16x16x32_bf16 v[212:215], v[92:95], v[244:247], v[212:215]
  ds_read_b64_tr_b16 v[50:51], v12 offset:1536
  buffer_store_dwordx4 v[24:27], v2, s[40:43], s64 offen offset:1024 sc1
  v_accvgpr_read_b32 v16, a152
  v_mfma_f32_16x16x32_bf16 v[104:107], v[64:67], v[248:251], v[104:107]
  ds_read_b64_tr_b16 v[52:53], v13 offset:512
  v_accvgpr_read_b32 v17, a153
  v_mfma_f32_16x16x32_bf16 v[120:123], v[68:71], v[248:251], v[120:123]
  ds_read_b64_tr_b16 v[54:55], v13 offset:1536
  v_accvgpr_read_b32 v18, a154
  v_mfma_f32_16x16x32_bf16 v[136:139], v[72:75], v[248:251], v[136:139]
  buffer_load_dwordx4 v6, s[32:35], s26 offen offset:3072 sc1 lds
  v_accvgpr_read_b32 v19, a155
  v_accvgpr_read_b32 v20, a156
  v_mfma_f32_16x16x32_bf16 v[152:155], v[76:79], v[248:251], v[152:155]
  s_add_u32 s26, s26, 1024
  ds_read_b64_tr_b16 v[56:57], v12 offset:768
  v_accvgpr_read_b32 v21, a157
  v_mfma_f32_16x16x32_bf16 v[168:171], v[80:83], v[248:251], v[168:171]
  ds_read_b64_tr_b16 v[58:59], v12 offset:1792
  v_accvgpr_read_b32 v22, a158
  v_mfma_f32_16x16x32_bf16 v[184:187], v[84:87], v[248:251], v[184:187]
  ds_read_b64_tr_b16 v[60:61], v13 offset:768
  v_accvgpr_read_b32 v23, a159
  v_mul_f32 v16, s76, v16
  v_mfma_f32_16x16x32_bf16 v[200:203], v[88:91], v[248:251], v[200:203]
  s_add_u32 m0, s24, 114688
  ds_read_b64_tr_b16 v[62:63], v13 offset:1792
  v_mul_f32 v17, s76, v17
  v_mfma_f32_16x16x32_bf16 v[216:219], v[92:95], v[248:251], v[216:219]
  buffer_load_dwordx4 v8, s[36:39], s27 offen offset:0 lds
  v_mul_f32 v18, s76, v18
  v_mfma_f32_16x16x32_bf16 v[108:111], v[64:67], v[252:255], v[108:111]
  ds_read_b128 v[232:235], v14 offset:2048
  v_mul_f32 v19, s76, v19
  v_mul_f32 v20, s76, v20
  v_mfma_f32_16x16x32_bf16 v[124:127], v[68:71], v[252:255], v[124:127]
  ds_read_b128 v[236:239], v14 offset:3072
  v_mul_f32 v21, s76, v21
  v_mfma_f32_16x16x32_bf16 v[140:143], v[72:75], v[252:255], v[140:143]
  v_mul_f32 v22, s76, v22
  v_mul_f32 v23, s76, v23
  v_mfma_f32_16x16x32_bf16 v[156:159], v[76:79], v[252:255], v[156:159]
  v_cvt_pk_bf16_f32 v28, v16, v17
  v_cvt_pk_bf16_f32 v29, v18, v19
  v_cvt_pk_bf16_f32 v30, v20, v21
  v_mfma_f32_16x16x32_bf16 v[172:175], v[80:83], v[252:255], v[172:175]
  buffer_load_dwordx4 v9, s[36:39], s27 offen offset:1024 lds
  v_cvt_pk_bf16_f32 v31, v22, v23
  v_mfma_f32_16x16x32_bf16 v[188:191], v[84:87], v[252:255], v[188:191]
  v_accvgpr_write_b32 a212, v28
  v_accvgpr_write_b32 a213, v29
  v_mfma_f32_16x16x32_bf16 v[204:207], v[88:91], v[252:255], v[204:207]
  v_accvgpr_write_b32 a214, v30
  v_accvgpr_write_b32 a215, v31
  v_mfma_f32_16x16x32_bf16 v[220:223], v[92:95], v[252:255], v[220:223]
  s_waitcnt vmcnt(17) lgkmcnt(0)
  v_mfma_f32_16x16x32_bf16 v[96:99], v[32:35], v[224:227], v[96:99]
  v_accvgpr_read_b32 v16, a16
  v_accvgpr_read_b32 v17, a17
  v_accvgpr_read_b32 v18, a18
  v_mfma_f32_16x16x32_bf16 v[112:115], v[36:39], v[224:227], v[112:115]
  ds_read_b64_tr_b16 v[64:65], v12 offset:8192
  v_accvgpr_read_b32 v19, a19
  v_mfma_f32_16x16x32_bf16 v[128:131], v[40:43], v[224:227], v[128:131]
  s_add_u32 m0, s24, 0
  ds_read_b64_tr_b16 v[66:67], v12 offset:9216
  v_accvgpr_read_b32 v20, a20
  v_mfma_f32_16x16x32_bf16 v[144:147], v[44:47], v[224:227], v[144:147]
  buffer_load_dwordx4 v3, s[32:35], s26 offen offset:0 sc1 lds
  v_accvgpr_read_b32 v21, a21
  v_accvgpr_read_b32 v22, a22
  v_mfma_f32_16x16x32_bf16 v[160:163], v[48:51], v[224:227], v[160:163]
  ds_read_b64_tr_b16 v[68:69], v13 offset:8192
  v_accvgpr_read_b32 v23, a23
  v_mfma_f32_16x16x32_bf16 v[176:179], v[52:55], v[224:227], v[176:179]
  ds_read_b64_tr_b16 v[70:71], v13 offset:9216
  v_mul_f32 v16, s76, v16
  v_mfma_f32_16x16x32_bf16 v[192:195], v[56:59], v[224:227], v[192:195]
  ds_read_b64_tr_b16 v[72:73], v12 offset:8448
  v_mul_f32 v17, s76, v17
  v_mul_f32 v18, s76, v18
  v_mfma_f32_16x16x32_bf16 v[208:211], v[60:63], v[224:227], v[208:211]
  ds_read_b64_tr_b16 v[74:75], v12 offset:9472
  v_mul_f32 v19, s76, v19
  v_mfma_f32_16x16x32_bf16 v[100:103], v[32:35], v[228:231], v[100:103]
  buffer_load_dwordx4 v4, s[32:35], s26 offen offset:1024 sc1 lds
  v_mul_f32 v20, s76, v20
  v_mfma_f32_16x16x32_bf16 v[116:119], v[36:39], v[228:231], v[116:119]
  ds_read_b64_tr_b16 v[76:77], v13 offset:8448
  v_mul_f32 v21, s76, v21
  v_mul_f32 v22, s76, v22
  v_mfma_f32_16x16x32_bf16 v[132:135], v[40:43], v[228:231], v[132:135]
  ds_read_b64_tr_b16 v[78:79], v13 offset:9472
  v_mul_f32 v23, s76, v23
  v_mfma_f32_16x16x32_bf16 v[148:151], v[44:47], v[228:231], v[148:151]
  ds_read_b128 v[240:243], v14 offset:32768
  v_cvt_pk_bf16_f32 v24, v16, v17
  v_mfma_f32_16x16x32_bf16 v[164:167], v[48:51], v[228:231], v[164:167]
  ds_read_b128 v[244:247], v14 offset:33792
  v_cvt_pk_bf16_f32 v25, v18, v19
  v_cvt_pk_bf16_f32 v26, v20, v21
  v_mfma_f32_16x16x32_bf16 v[180:183], v[52:55], v[228:231], v[180:183]
  buffer_load_dwordx4 v5, s[32:35], s26 offen offset:2048 sc1 lds
  v_cvt_pk_bf16_f32 v27, v22, v23
  v_mfma_f32_16x16x32_bf16 v[196:199], v[56:59], v[228:231], v[196:199]
  ds_read_b64_tr_b16 v[80:81], v12 offset:8704
  buffer_store_dwordx4 v[24:27], v2, s[40:43], s64 offen offset:2048 sc1
  v_mfma_f32_16x16x32_bf16 v[212:215], v[60:63], v[228:231], v[212:215]
  ds_read_b64_tr_b16 v[82:83], v12 offset:9728
  v_accvgpr_read_b32 v16, a160
  v_accvgpr_read_b32 v17, a161
  v_mfma_f32_16x16x32_bf16 v[104:107], v[32:35], v[232:235], v[104:107]
  ds_read_b64_tr_b16 v[84:85], v13 offset:8704
  v_accvgpr_read_b32 v18, a162
  v_mfma_f32_16x16x32_bf16 v[120:123], v[36:39], v[232:235], v[120:123]
  ds_read_b64_tr_b16 v[86:87], v13 offset:9728
  v_accvgpr_read_b32 v19, a163
  v_mfma_f32_16x16x32_bf16 v[136:139], v[40:43], v[232:235], v[136:139]
  buffer_load_dwordx4 v6, s[32:35], s26 offen offset:3072 sc1 lds
  v_accvgpr_read_b32 v20, a164
  v_accvgpr_read_b32 v21, a165
  v_mfma_f32_16x16x32_bf16 v[152:155], v[44:47], v[232:235], v[152:155]
  s_add_u32 s26, s26, 1024
  ds_read_b64_tr_b16 v[88:89], v12 offset:8960
  v_accvgpr_read_b32 v22, a166
  v_mfma_f32_16x16x32_bf16 v[168:171], v[48:51], v[232:235], v[168:171]
  ds_read_b64_tr_b16 v[90:91], v12 offset:9984
  v_accvgpr_read_b32 v23, a167
  v_mfma_f32_16x16x32_bf16 v[184:187], v[52:55], v[232:235], v[184:187]
  ds_read_b64_tr_b16 v[92:93], v13 offset:8960
  v_mul_f32 v16, s76, v16
  v_mul_f32 v17, s76, v17
  v_mfma_f32_16x16x32_bf16 v[200:203], v[56:59], v[232:235], v[200:203]
  s_add_u32 m0, s24, 114688
  ds_read_b64_tr_b16 v[94:95], v13 offset:9984
  v_mul_f32 v18, s76, v18
  v_mfma_f32_16x16x32_bf16 v[216:219], v[60:63], v[232:235], v[216:219]
  buffer_load_dwordx4 v10, s[36:39], s27 offen offset:2048 lds
  v_mul_f32 v19, s76, v19
  v_mfma_f32_16x16x32_bf16 v[108:111], v[32:35], v[236:239], v[108:111]
  ds_read_b128 v[248:251], v14 offset:34816
  v_mul_f32 v20, s76, v20
  v_mul_f32 v21, s76, v21
  v_mfma_f32_16x16x32_bf16 v[124:127], v[36:39], v[236:239], v[124:127]
  ds_read_b128 v[252:255], v14 offset:35840
  v_mul_f32 v22, s76, v22
  v_mfma_f32_16x16x32_bf16 v[140:143], v[40:43], v[236:239], v[140:143]
  v_mul_f32 v23, s76, v23
  v_cvt_pk_bf16_f32 v28, v16, v17
  v_mfma_f32_16x16x32_bf16 v[156:159], v[44:47], v[236:239], v[156:159]
  v_xor_b32 v14, 0x10000, v14
  v_cvt_pk_bf16_f32 v29, v18, v19
  v_cvt_pk_bf16_f32 v30, v20, v21
  v_mfma_f32_16x16x32_bf16 v[172:175], v[48:51], v[236:239], v[172:175]
  buffer_load_dwordx4 v11, s[36:39], s27 offen offset:3072 lds
  v_cvt_pk_bf16_f32 v31, v22, v23
  v_mfma_f32_16x16x32_bf16 v[188:191], v[52:55], v[236:239], v[188:191]
  s_add_u32 s27, s27, 524288
  v_accvgpr_write_b32 a216, v28
  v_accvgpr_write_b32 a217, v29
  v_mfma_f32_16x16x32_bf16 v[204:207], v[56:59], v[236:239], v[204:207]
  v_accvgpr_write_b32 a218, v30
  v_accvgpr_write_b32 a219, v31
  v_mfma_f32_16x16x32_bf16 v[220:223], v[60:63], v[236:239], v[220:223]
  s_waitcnt vmcnt(17) lgkmcnt(0)
  v_mfma_f32_16x16x32_bf16 v[96:99], v[64:67], v[240:243], v[96:99]
  s_barrier
  v_accvgpr_read_b32 v16, a24
  v_accvgpr_read_b32 v17, a25
  v_accvgpr_read_b32 v18, a26
  v_mfma_f32_16x16x32_bf16 v[112:115], v[68:71], v[240:243], v[112:115]
  ds_read_b64_tr_b16 v[32:33], v12 offset:32768
  v_accvgpr_read_b32 v19, a27
  v_mfma_f32_16x16x32_bf16 v[128:131], v[72:75], v[240:243], v[128:131]
  s_add_u32 m0, s24, 32768
  ds_read_b64_tr_b16 v[34:35], v12 offset:33792
  v_accvgpr_read_b32 v20, a28
  v_mfma_f32_16x16x32_bf16 v[144:147], v[76:79], v[240:243], v[144:147]
  buffer_load_dwordx4 v3, s[32:35], s26 offen offset:0 sc1 lds
  v_accvgpr_read_b32 v21, a29
  v_accvgpr_read_b32 v22, a30
  v_mfma_f32_16x16x32_bf16 v[160:163], v[80:83], v[240:243], v[160:163]
  ds_read_b64_tr_b16 v[36:37], v13 offset:32768
  v_accvgpr_read_b32 v23, a31
  v_mfma_f32_16x16x32_bf16 v[176:179], v[84:87], v[240:243], v[176:179]
  ds_read_b64_tr_b16 v[38:39], v13 offset:33792
  v_mul_f32 v16, s76, v16
  v_mfma_f32_16x16x32_bf16 v[192:195], v[88:91], v[240:243], v[192:195]
  ds_read_b64_tr_b16 v[40:41], v12 offset:33024
  v_mul_f32 v17, s76, v17
  v_mul_f32 v18, s76, v18
  v_mfma_f32_16x16x32_bf16 v[208:211], v[92:95], v[240:243], v[208:211]
  ds_read_b64_tr_b16 v[42:43], v12 offset:34048
  v_mul_f32 v19, s76, v19
  v_mfma_f32_16x16x32_bf16 v[100:103], v[64:67], v[244:247], v[100:103]
  buffer_load_dwordx4 v4, s[32:35], s26 offen offset:1024 sc1 lds
  v_mul_f32 v20, s76, v20
  v_mfma_f32_16x16x32_bf16 v[116:119], v[68:71], v[244:247], v[116:119]
  ds_read_b64_tr_b16 v[44:45], v13 offset:33024
  v_mul_f32 v21, s76, v21
  v_mfma_f32_16x16x32_bf16 v[132:135], v[72:75], v[244:247], v[132:135]
  ds_read_b64_tr_b16 v[46:47], v13 offset:34048
  v_mul_f32 v22, s76, v22
  v_mul_f32 v23, s76, v23
  v_mfma_f32_16x16x32_bf16 v[148:151], v[76:79], v[244:247], v[148:151]
  ds_read_b128 v[224:227], v14 offset:0
  v_cvt_pk_bf16_f32 v24, v16, v17
  v_mfma_f32_16x16x32_bf16 v[164:167], v[80:83], v[244:247], v[164:167]
  ds_read_b128 v[228:231], v14 offset:1024
  v_cvt_pk_bf16_f32 v25, v18, v19
  v_mfma_f32_16x16x32_bf16 v[180:183], v[84:87], v[244:247], v[180:183]
  buffer_load_dwordx4 v5, s[32:35], s26 offen offset:2048 sc1 lds
  v_cvt_pk_bf16_f32 v26, v20, v21
  v_cvt_pk_bf16_f32 v27, v22, v23
  v_mfma_f32_16x16x32_bf16 v[196:199], v[88:91], v[244:247], v[196:199]
  ds_read_b64_tr_b16 v[48:49], v12 offset:33280
  buffer_store_dwordx4 v[24:27], v2, s[40:43], s64 offen offset:3072 sc1
  v_mfma_f32_16x16x32_bf16 v[212:215], v[92:95], v[244:247], v[212:215]
  ds_read_b64_tr_b16 v[50:51], v12 offset:34304
  v_accvgpr_read_b32 v16, a168
  v_mfma_f32_16x16x32_bf16 v[104:107], v[64:67], v[248:251], v[104:107]
  ds_read_b64_tr_b16 v[52:53], v13 offset:33280
  v_accvgpr_read_b32 v17, a169
  v_accvgpr_read_b32 v18, a170
  v_mfma_f32_16x16x32_bf16 v[120:123], v[68:71], v[248:251], v[120:123]
  ds_read_b64_tr_b16 v[54:55], v13 offset:34304
  v_accvgpr_read_b32 v19, a171
  v_mfma_f32_16x16x32_bf16 v[136:139], v[72:75], v[248:251], v[136:139]
  buffer_load_dwordx4 v6, s[32:35], s26 offen offset:3072 sc1 lds
  v_accvgpr_read_b32 v20, a172
  v_mfma_f32_16x16x32_bf16 v[152:155], v[76:79], v[248:251], v[152:155]
  s_add_u32 s26, s26, 1024
  ds_read_b64_tr_b16 v[56:57], v12 offset:33536
  v_accvgpr_read_b32 v21, a173
  v_mfma_f32_16x16x32_bf16 v[168:171], v[80:83], v[248:251], v[168:171]
  ds_read_b64_tr_b16 v[58:59], v12 offset:34560
  v_accvgpr_read_b32 v22, a174
  v_accvgpr_read_b32 v23, a175
  v_mfma_f32_16x16x32_bf16 v[184:187], v[84:87], v[248:251], v[184:187]
  ds_read_b64_tr_b16 v[60:61], v13 offset:33536
  v_mul_f32 v16, s76, v16
  v_mfma_f32_16x16x32_bf16 v[200:203], v[88:91], v[248:251], v[200:203]
  s_add_u32 m0, s24, 16384
  ds_read_b64_tr_b16 v[62:63], v13 offset:34560
  v_mul_f32 v17, s76, v17
  v_mfma_f32_16x16x32_bf16 v[216:219], v[92:95], v[248:251], v[216:219]
  buffer_load_dwordx4 v8, s[36:39], s27 offen offset:0 lds
  v_mul_f32 v18, s76, v18
  v_mul_f32 v19, s76, v19
  v_mfma_f32_16x16x32_bf16 v[108:111], v[64:67], v[252:255], v[108:111]
  ds_read_b128 v[232:235], v14 offset:2048
  v_mul_f32 v20, s76, v20
  v_mfma_f32_16x16x32_bf16 v[124:127], v[68:71], v[252:255], v[124:127]
  ds_read_b128 v[236:239], v14 offset:3072
  v_mul_f32 v21, s76, v21
  v_mfma_f32_16x16x32_bf16 v[140:143], v[72:75], v[252:255], v[140:143]
  v_mul_f32 v22, s76, v22
  v_mul_f32 v23, s76, v23
  v_cvt_pk_bf16_f32 v28, v16, v17
  v_mfma_f32_16x16x32_bf16 v[156:159], v[76:79], v[252:255], v[156:159]
  v_cvt_pk_bf16_f32 v29, v18, v19
  v_cvt_pk_bf16_f32 v30, v20, v21
  v_mfma_f32_16x16x32_bf16 v[172:175], v[80:83], v[252:255], v[172:175]
  buffer_load_dwordx4 v9, s[36:39], s27 offen offset:1024 lds
  v_cvt_pk_bf16_f32 v31, v22, v23
  v_mfma_f32_16x16x32_bf16 v[188:191], v[84:87], v[252:255], v[188:191]
  v_accvgpr_write_b32 a220, v28
  v_accvgpr_write_b32 a221, v29
  v_mfma_f32_16x16x32_bf16 v[204:207], v[88:91], v[252:255], v[204:207]
  v_accvgpr_write_b32 a222, v30
  v_accvgpr_write_b32 a223, v31
  v_mfma_f32_16x16x32_bf16 v[220:223], v[92:95], v[252:255], v[220:223]
  s_waitcnt vmcnt(16) lgkmcnt(0)
  v_mfma_f32_16x16x32_bf16 v[96:99], v[32:35], v[224:227], v[96:99]
  s_add_u32 s64, s64, 4096
  v_accvgpr_read_b32 v16, a32
  v_accvgpr_read_b32 v17, a33
  v_accvgpr_read_b32 v18, a34
  v_mfma_f32_16x16x32_bf16 v[112:115], v[36:39], v[224:227], v[112:115]
  ds_read_b64_tr_b16 v[64:65], v12 offset:40960
  v_accvgpr_read_b32 v19, a35
  v_mfma_f32_16x16x32_bf16 v[128:131], v[40:43], v[224:227], v[128:131]
  s_add_u32 m0, s24, 65536
  ds_read_b64_tr_b16 v[66:67], v12 offset:41984
  v_accvgpr_read_b32 v20, a36
  v_accvgpr_read_b32 v21, a37
  v_mfma_f32_16x16x32_bf16 v[144:147], v[44:47], v[224:227], v[144:147]
  buffer_load_dwordx4 v3, s[32:35], s26 offen offset:0 sc1 lds
  v_accvgpr_read_b32 v22, a38
  v_mfma_f32_16x16x32_bf16 v[160:163], v[48:51], v[224:227], v[160:163]
  ds_read_b64_tr_b16 v[68:69], v13 offset:40960
  v_accvgpr_read_b32 v23, a39
  v_mfma_f32_16x16x32_bf16 v[176:179], v[52:55], v[224:227], v[176:179]
  ds_read_b64_tr_b16 v[70:71], v13 offset:41984
  v_mul_f32 v16, s76, v16
  v_mul_f32 v17, s76, v17
  v_mfma_f32_16x16x32_bf16 v[192:195], v[56:59], v[224:227], v[192:195]
  ds_read_b64_tr_b16 v[72:73], v12 offset:41216
  v_mul_f32 v18, s76, v18
  v_mfma_f32_16x16x32_bf16 v[208:211], v[60:63], v[224:227], v[208:211]
  ds_read_b64_tr_b16 v[74:75], v12 offset:42240
  v_mul_f32 v19, s76, v19
  v_mul_f32 v20, s76, v20
  v_mfma_f32_16x16x32_bf16 v[100:103], v[32:35], v[228:231], v[100:103]
  buffer_load_dwordx4 v4, s[32:35], s26 offen offset:1024 sc1 lds
  v_mul_f32 v21, s76, v21
  v_mfma_f32_16x16x32_bf16 v[116:119], v[36:39], v[228:231], v[116:119]
  ds_read_b64_tr_b16 v[76:77], v13 offset:41216
  v_mul_f32 v22, s76, v22
  v_mfma_f32_16x16x32_bf16 v[132:135], v[40:43], v[228:231], v[132:135]
  ds_read_b64_tr_b16 v[78:79], v13 offset:42240
  v_mul_f32 v23, s76, v23
  v_cvt_pk_bf16_f32 v24, v16, v17
  v_mfma_f32_16x16x32_bf16 v[148:151], v[44:47], v[228:231], v[148:151]
  ds_read_b128 v[240:243], v14 offset:32768
  v_cvt_pk_bf16_f32 v25, v18, v19
  v_mfma_f32_16x16x32_bf16 v[164:167], v[48:51], v[228:231], v[164:167]
  ds_read_b128 v[244:247], v14 offset:33792
  v_cvt_pk_bf16_f32 v26, v20, v21
  v_cvt_pk_bf16_f32 v27, v22, v23
  v_mfma_f32_16x16x32_bf16 v[180:183], v[52:55], v[228:231], v[180:183]
  buffer_load_dwordx4 v5, s[32:35], s26 offen offset:2048 sc1 lds
  buffer_store_dwordx4 v[24:27], v2, s[40:43], s64 offen offset:0 sc1
  v_mfma_f32_16x16x32_bf16 v[196:199], v[56:59], v[228:231], v[196:199]
  ds_read_b64_tr_b16 v[80:81], v12 offset:41472
  v_accvgpr_read_b32 v16, a176
  v_mfma_f32_16x16x32_bf16 v[212:215], v[60:63], v[228:231], v[212:215]
  ds_read_b64_tr_b16 v[82:83], v12 offset:42496
  v_accvgpr_read_b32 v17, a177
  v_accvgpr_read_b32 v18, a178
  v_mfma_f32_16x16x32_bf16 v[104:107], v[32:35], v[232:235], v[104:107]
  ds_read_b64_tr_b16 v[84:85], v13 offset:41472
  v_accvgpr_read_b32 v19, a179
  v_mfma_f32_16x16x32_bf16 v[120:123], v[36:39], v[232:235], v[120:123]
  ds_read_b64_tr_b16 v[86:87], v13 offset:42496
  v_accvgpr_read_b32 v20, a180
  v_accvgpr_read_b32 v21, a181
  v_mfma_f32_16x16x32_bf16 v[136:139], v[40:43], v[232:235], v[136:139]
  buffer_load_dwordx4 v6, s[32:35], s26 offen offset:3072 sc1 lds
  v_accvgpr_read_b32 v22, a182
  v_mfma_f32_16x16x32_bf16 v[152:155], v[44:47], v[232:235], v[152:155]
  s_add_u32 s26, s26, 1024
  ds_read_b64_tr_b16 v[88:89], v12 offset:41728
  v_accvgpr_read_b32 v23, a183
  v_mfma_f32_16x16x32_bf16 v[168:171], v[48:51], v[232:235], v[168:171]
  ds_read_b64_tr_b16 v[90:91], v12 offset:42752
  v_mul_f32 v16, s76, v16
  v_mul_f32 v17, s76, v17
  v_mfma_f32_16x16x32_bf16 v[184:187], v[52:55], v[232:235], v[184:187]
  ds_read_b64_tr_b16 v[92:93], v13 offset:41728
  v_mul_f32 v18, s76, v18
  v_mfma_f32_16x16x32_bf16 v[200:203], v[56:59], v[232:235], v[200:203]
  s_add_u32 m0, s24, 16384
  ds_read_b64_tr_b16 v[94:95], v13 offset:42752
  v_mul_f32 v19, s76, v19
  v_mul_f32 v20, s76, v20
  v_mfma_f32_16x16x32_bf16 v[216:219], v[60:63], v[232:235], v[216:219]
  buffer_load_dwordx4 v10, s[36:39], s27 offen offset:2048 lds
  v_mul_f32 v21, s76, v21
  v_mfma_f32_16x16x32_bf16 v[108:111], v[32:35], v[236:239], v[108:111]
  ds_read_b128 v[248:251], v14 offset:34816
  v_mul_f32 v22, s76, v22
  v_mfma_f32_16x16x32_bf16 v[124:127], v[36:39], v[236:239], v[124:127]
  ds_read_b128 v[252:255], v14 offset:35840
  v_mul_f32 v23, s76, v23
  v_cvt_pk_bf16_f32 v28, v16, v17
  v_mfma_f32_16x16x32_bf16 v[140:143], v[40:43], v[236:239], v[140:143]
  v_cvt_pk_bf16_f32 v29, v18, v19
  v_cvt_pk_bf16_f32 v30, v20, v21
  v_mfma_f32_16x16x32_bf16 v[156:159], v[44:47], v[236:239], v[156:159]
  v_xor_b32 v14, 0x10000, v14
  v_cvt_pk_bf16_f32 v31, v22, v23
  v_accvgpr_write_b32 a224, v28
  v_mfma_f32_16x16x32_bf16 v[172:175], v[48:51], v[236:239], v[172:175]
  buffer_load_dwordx4 v11, s[36:39], s27 offen offset:3072 lds
  v_accvgpr_write_b32 a225, v29
  v_mfma_f32_16x16x32_bf16 v[188:191], v[52:55], v[236:239], v[188:191]
  s_add_u32 s27, s27, 524288
  v_xor_b32 v12, 0x10000, v12
  v_accvgpr_write_b32 a226, v30
  v_mfma_f32_16x16x32_bf16 v[204:207], v[56:59], v[236:239], v[204:207]
  v_xor_b32 v13, 0x10000, v13
  v_accvgpr_write_b32 a227, v31
  v_mfma_f32_16x16x32_bf16 v[220:223], v[60:63], v[236:239], v[220:223]
  s_waitcnt vmcnt(16) lgkmcnt(0)
  v_mfma_f32_16x16x32_bf16 v[96:99], v[64:67], v[240:243], v[96:99]
  s_barrier
  v_accvgpr_read_b32 v16, a40
  v_accvgpr_read_b32 v17, a41
  v_accvgpr_read_b32 v18, a42
  v_mfma_f32_16x16x32_bf16 v[112:115], v[68:71], v[240:243], v[112:115]
  ds_read_b64_tr_b16 v[32:33], v12 offset:0
  v_accvgpr_read_b32 v19, a43
  v_mfma_f32_16x16x32_bf16 v[128:131], v[72:75], v[240:243], v[128:131]
  s_add_u32 m0, s24, 98304
  ds_read_b64_tr_b16 v[34:35], v12 offset:1024
  v_accvgpr_read_b32 v20, a44
  v_mfma_f32_16x16x32_bf16 v[144:147], v[76:79], v[240:243], v[144:147]
  buffer_load_dwordx4 v3, s[32:35], s26 offen offset:0 sc1 lds
  v_accvgpr_read_b32 v21, a45
  v_accvgpr_read_b32 v22, a46
  v_mfma_f32_16x16x32_bf16 v[160:163], v[80:83], v[240:243], v[160:163]
  ds_read_b64_tr_b16 v[36:37], v13 offset:0
  v_accvgpr_read_b32 v23, a47
  v_mfma_f32_16x16x32_bf16 v[176:179], v[84:87], v[240:243], v[176:179]
  ds_read_b64_tr_b16 v[38:39], v13 offset:1024
  v_mul_f32 v16, s76, v16
  v_mfma_f32_16x16x32_bf16 v[192:195], v[88:91], v[240:243], v[192:195]
  ds_read_b64_tr_b16 v[40:41], v12 offset:256
  v_mul_f32 v17, s76, v17
  v_mul_f32 v18, s76, v18
  v_mfma_f32_16x16x32_bf16 v[208:211], v[92:95], v[240:243], v[208:211]
  ds_read_b64_tr_b16 v[42:43], v12 offset:1280
  v_mul_f32 v19, s76, v19
  v_mfma_f32_16x16x32_bf16 v[100:103], v[64:67], v[244:247], v[100:103]
  buffer_load_dwordx4 v4, s[32:35], s26 offen offset:1024 sc1 lds
  v_mul_f32 v20, s76, v20
  v_mfma_f32_16x16x32_bf16 v[116:119], v[68:71], v[244:247], v[116:119]
  ds_read_b64_tr_b16 v[44:45], v13 offset:256
  v_mul_f32 v21, s76, v21
  v_mfma_f32_16x16x32_bf16 v[132:135], v[72:75], v[244:247], v[132:135]
  ds_read_b64_tr_b16 v[46:47], v13 offset:1280
  v_mul_f32 v22, s76, v22
  v_mul_f32 v23, s76, v23
  v_mfma_f32_16x16x32_bf16 v[148:151], v[76:79], v[244:247], v[148:151]
  ds_read_b128 v[224:227], v14 offset:0
  v_cvt_pk_bf16_f32 v24, v16, v17
  v_mfma_f32_16x16x32_bf16 v[164:167], v[80:83], v[244:247], v[164:167]
  ds_read_b128 v[228:231], v14 offset:1024
  v_cvt_pk_bf16_f32 v25, v18, v19
  v_mfma_f32_16x16x32_bf16 v[180:183], v[84:87], v[244:247], v[180:183]
  buffer_load_dwordx4 v5, s[32:35], s26 offen offset:2048 sc1 lds
  v_cvt_pk_bf16_f32 v26, v20, v21
  v_cvt_pk_bf16_f32 v27, v22, v23
  v_mfma_f32_16x16x32_bf16 v[196:199], v[88:91], v[244:247], v[196:199]
  ds_read_b64_tr_b16 v[48:49], v12 offset:512
  buffer_store_dwordx4 v[24:27], v2, s[40:43], s64 offen offset:1024 sc1
  v_mfma_f32_16x16x32_bf16 v[212:215], v[92:95], v[244:247], v[212:215]
  ds_read_b64_tr_b16 v[50:51], v12 offset:1536
  v_accvgpr_read_b32 v16, a184
  v_mfma_f32_16x16x32_bf16 v[104:107], v[64:67], v[248:251], v[104:107]
  ds_read_b64_tr_b16 v[52:53], v13 offset:512
  v_accvgpr_read_b32 v17, a185
  v_accvgpr_read_b32 v18, a186
  v_mfma_f32_16x16x32_bf16 v[120:123], v[68:71], v[248:251], v[120:123]
  ds_read_b64_tr_b16 v[54:55], v13 offset:1536
  v_accvgpr_read_b32 v19, a187
  v_mfma_f32_16x16x32_bf16 v[136:139], v[72:75], v[248:251], v[136:139]
  buffer_load_dwordx4 v6, s[32:35], s26 offen offset:3072 sc1 lds
  v_accvgpr_read_b32 v20, a188
  v_mfma_f32_16x16x32_bf16 v[152:155], v[76:79], v[248:251], v[152:155]
  s_add_u32 s26, s26, 1024
  ds_read_b64_tr_b16 v[56:57], v12 offset:768
  v_accvgpr_read_b32 v21, a189
  v_mfma_f32_16x16x32_bf16 v[168:171], v[80:83], v[248:251], v[168:171]
  ds_read_b64_tr_b16 v[58:59], v12 offset:1792
  v_accvgpr_read_b32 v22, a190
  v_accvgpr_read_b32 v23, a191
  v_mfma_f32_16x16x32_bf16 v[184:187], v[84:87], v[248:251], v[184:187]
  ds_read_b64_tr_b16 v[60:61], v13 offset:768
  v_mul_f32 v16, s76, v16
  v_mfma_f32_16x16x32_bf16 v[200:203], v[88:91], v[248:251], v[200:203]
  s_add_u32 m0, s24, 49152
  ds_read_b64_tr_b16 v[62:63], v13 offset:1792
  v_mul_f32 v17, s76, v17
  v_mfma_f32_16x16x32_bf16 v[216:219], v[92:95], v[248:251], v[216:219]
  buffer_load_dwordx4 v8, s[36:39], s27 offen offset:0 lds
  v_mul_f32 v18, s76, v18
  v_mul_f32 v19, s76, v19
  v_mfma_f32_16x16x32_bf16 v[108:111], v[64:67], v[252:255], v[108:111]
  ds_read_b128 v[232:235], v14 offset:2048
  v_mul_f32 v20, s76, v20
  v_mfma_f32_16x16x32_bf16 v[124:127], v[68:71], v[252:255], v[124:127]
  ds_read_b128 v[236:239], v14 offset:3072
  v_mul_f32 v21, s76, v21
  v_mfma_f32_16x16x32_bf16 v[140:143], v[72:75], v[252:255], v[140:143]
  v_mul_f32 v22, s76, v22
  v_mul_f32 v23, s76, v23
  v_cvt_pk_bf16_f32 v28, v16, v17
  v_mfma_f32_16x16x32_bf16 v[156:159], v[76:79], v[252:255], v[156:159]
  v_cvt_pk_bf16_f32 v29, v18, v19
  v_cvt_pk_bf16_f32 v30, v20, v21
  v_mfma_f32_16x16x32_bf16 v[172:175], v[80:83], v[252:255], v[172:175]
  buffer_load_dwordx4 v9, s[36:39], s27 offen offset:1024 lds
  v_cvt_pk_bf16_f32 v31, v22, v23
  v_mfma_f32_16x16x32_bf16 v[188:191], v[84:87], v[252:255], v[188:191]
  v_accvgpr_write_b32 a228, v28
  v_accvgpr_write_b32 a229, v29
  v_mfma_f32_16x16x32_bf16 v[204:207], v[88:91], v[252:255], v[204:207]
  v_accvgpr_write_b32 a230, v30
  v_accvgpr_write_b32 a231, v31
  v_mfma_f32_16x16x32_bf16 v[220:223], v[92:95], v[252:255], v[220:223]
  s_waitcnt vmcnt(16) lgkmcnt(0)
  v_mfma_f32_16x16x32_bf16 v[96:99], v[32:35], v[224:227], v[96:99]
  v_accvgpr_read_b32 v16, a48
  v_accvgpr_read_b32 v17, a49
  v_accvgpr_read_b32 v18, a50
  v_mfma_f32_16x16x32_bf16 v[112:115], v[36:39], v[224:227], v[112:115]
  ds_read_b64_tr_b16 v[64:65], v12 offset:8192
  v_accvgpr_read_b32 v19, a51
  v_mfma_f32_16x16x32_bf16 v[128:131], v[40:43], v[224:227], v[128:131]
  s_add_u32 m0, s24, 0
  ds_read_b64_tr_b16 v[66:67], v12 offset:9216
  v_accvgpr_read_b32 v20, a52
  v_mfma_f32_16x16x32_bf16 v[144:147], v[44:47], v[224:227], v[144:147]
  buffer_load_dwordx4 v3, s[32:35], s26 offen offset:0 sc1 lds
  v_accvgpr_read_b32 v21, a53
  v_accvgpr_read_b32 v22, a54
  v_mfma_f32_16x16x32_bf16 v[160:163], v[48:51], v[224:227], v[160:163]
  ds_read_b64_tr_b16 v[68:69], v13 offset:8192
  v_accvgpr_read_b32 v23, a55
  v_mfma_f32_16x16x32_bf16 v[176:179], v[52:55], v[224:227], v[176:179]
  ds_read_b64_tr_b16 v[70:71], v13 offset:9216
  v_mul_f32 v16, s76, v16
  v_mfma_f32_16x16x32_bf16 v[192:195], v[56:59], v[224:227], v[192:195]
  ds_read_b64_tr_b16 v[72:73], v12 offset:8448
  v_mul_f32 v17, s76, v17
  v_mfma_f32_16x16x32_bf16 v[208:211], v[60:63], v[224:227], v[208:211]
  ds_read_b64_tr_b16 v[74:75], v12 offset:9472
  v_mul_f32 v18, s76, v18
  v_mul_f32 v19, s76, v19
  v_mfma_f32_16x16x32_bf16 v[100:103], v[32:35], v[228:231], v[100:103]
  buffer_load_dwordx4 v4, s[32:35], s26 offen offset:1024 sc1 lds
  v_mul_f32 v20, s76, v20
  v_mfma_f32_16x16x32_bf16 v[116:119], v[36:39], v[228:231], v[116:119]
  ds_read_b64_tr_b16 v[76:77], v13 offset:8448
  v_mul_f32 v21, s76, v21
  v_mfma_f32_16x16x32_bf16 v[132:135], v[40:43], v[228:231], v[132:135]
  ds_read_b64_tr_b16 v[78:79], v13 offset:9472
  v_mul_f32 v22, s76, v22
  v_mfma_f32_16x16x32_bf16 v[148:151], v[44:47], v[228:231], v[148:151]
  ds_read_b128 v[240:243], v14 offset:32768
  v_mul_f32 v23, s76, v23
  v_cvt_pk_bf16_f32 v24, v16, v17
  v_mfma_f32_16x16x32_bf16 v[164:167], v[48:51], v[228:231], v[164:167]
  ds_read_b128 v[244:247], v14 offset:33792
  v_cvt_pk_bf16_f32 v25, v18, v19
  v_mfma_f32_16x16x32_bf16 v[180:183], v[52:55], v[228:231], v[180:183]
  buffer_load_dwordx4 v5, s[32:35], s26 offen offset:2048 sc1 lds
  v_cvt_pk_bf16_f32 v26, v20, v21
  v_mfma_f32_16x16x32_bf16 v[196:199], v[56:59], v[228:231], v[196:199]
  ds_read_b64_tr_b16 v[80:81], v12 offset:8704
  v_cvt_pk_bf16_f32 v27, v22, v23
  v_mfma_f32_16x16x32_bf16 v[212:215], v[60:63], v[228:231], v[212:215]
  ds_read_b64_tr_b16 v[82:83], v12 offset:9728
  buffer_store_dwordx4 v[24:27], v2, s[40:43], s64 offen offset:2048 sc1
  v_accvgpr_read_b32 v16, a56
  v_mfma_f32_16x16x32_bf16 v[104:107], v[32:35], v[232:235], v[104:107]
  ds_read_b64_tr_b16 v[84:85], v13 offset:8704
  v_accvgpr_read_b32 v17, a57
  v_mfma_f32_16x16x32_bf16 v[120:123], v[36:39], v[232:235], v[120:123]
  ds_read_b64_tr_b16 v[86:87], v13 offset:9728
  v_accvgpr_read_b32 v18, a58
  v_mfma_f32_16x16x32_bf16 v[136:139], v[40:43], v[232:235], v[136:139]
  buffer_load_dwordx4 v6, s[32:35], s26 offen offset:3072 sc1 lds
  v_accvgpr_read_b32 v19, a59
  v_accvgpr_read_b32 v20, a60
  v_mfma_f32_16x16x32_bf16 v[152:155], v[44:47], v[232:235], v[152:155]
  s_add_u32 s26, s26, 1024
  ds_read_b64_tr_b16 v[88:89], v12 offset:8960
  v_accvgpr_read_b32 v21, a61
  v_mfma_f32_16x16x32_bf16 v[168:171], v[48:51], v[232:235], v[168:171]
  ds_read_b64_tr_b16 v[90:91], v12 offset:9984
  v_accvgpr_read_b32 v22, a62
  v_mfma_f32_16x16x32_bf16 v[184:187], v[52:55], v[232:235], v[184:187]
  ds_read_b64_tr_b16 v[92:93], v13 offset:8960
  v_accvgpr_read_b32 v23, a63
  v_mfma_f32_16x16x32_bf16 v[200:203], v[56:59], v[232:235], v[200:203]
  s_add_u32 m0, s24, 49152
  ds_read_b64_tr_b16 v[94:95], v13 offset:9984
  v_mul_f32 v16, s76, v16
  v_mul_f32 v17, s76, v17
  v_mfma_f32_16x16x32_bf16 v[216:219], v[60:63], v[232:235], v[216:219]
  buffer_load_dwordx4 v10, s[36:39], s27 offen offset:2048 lds
  v_mul_f32 v18, s76, v18
  v_mfma_f32_16x16x32_bf16 v[108:111], v[32:35], v[236:239], v[108:111]
  ds_read_b128 v[248:251], v14 offset:34816
  v_mul_f32 v19, s76, v19
  v_mfma_f32_16x16x32_bf16 v[124:127], v[36:39], v[236:239], v[124:127]
  ds_read_b128 v[252:255], v14 offset:35840
  v_mul_f32 v20, s76, v20
  v_mfma_f32_16x16x32_bf16 v[140:143], v[40:43], v[236:239], v[140:143]
  v_mul_f32 v21, s76, v21
  v_mul_f32 v22, s76, v22
  v_mul_f32 v23, s76, v23
  v_mfma_f32_16x16x32_bf16 v[156:159], v[44:47], v[236:239], v[156:159]
  v_xor_b32 v14, 0x10000, v14
  v_cvt_pk_bf16_f32 v28, v16, v17
  v_mfma_f32_16x16x32_bf16 v[172:175], v[48:51], v[236:239], v[172:175]
  buffer_load_dwordx4 v11, s[36:39], s27 offen offset:3072 lds
  v_cvt_pk_bf16_f32 v29, v18, v19
  v_mfma_f32_16x16x32_bf16 v[188:191], v[52:55], v[236:239], v[188:191]
  s_add_u32 s27, s27, 524288
  v_cvt_pk_bf16_f32 v30, v20, v21
  v_cvt_pk_bf16_f32 v31, v22, v23
  v_mfma_f32_16x16x32_bf16 v[204:207], v[56:59], v[236:239], v[204:207]
  buffer_store_dwordx4 v[28:31], v2, s[40:43], s64 offen offset:3072 sc1
  v_mfma_f32_16x16x32_bf16 v[220:223], v[60:63], v[236:239], v[220:223]
  s_waitcnt vmcnt(17) lgkmcnt(0)
  v_mfma_f32_16x16x32_bf16 v[96:99], v[64:67], v[240:243], v[96:99]
  s_barrier
  v_accvgpr_read_b32 v16, a64
  v_accvgpr_read_b32 v17, a65
  v_accvgpr_read_b32 v18, a66
  v_mfma_f32_16x16x32_bf16 v[112:115], v[68:71], v[240:243], v[112:115]
  s_add_u32 s64, s64, 126976
  ds_read_b64_tr_b16 v[32:33], v12 offset:32768
  v_accvgpr_read_b32 v19, a67
  v_accvgpr_read_b32 v20, a68
  v_mfma_f32_16x16x32_bf16 v[128:131], v[72:75], v[240:243], v[128:131]
  s_add_u32 m0, s24, 32768
  ds_read_b64_tr_b16 v[34:35], v12 offset:33792
  v_accvgpr_read_b32 v21, a69
  v_mfma_f32_16x16x32_bf16 v[144:147], v[76:79], v[240:243], v[144:147]
  buffer_load_dwordx4 v3, s[32:35], s26 offen offset:0 sc1 lds
  v_accvgpr_read_b32 v22, a70
  v_accvgpr_read_b32 v23, a71
  v_mfma_f32_16x16x32_bf16 v[160:163], v[80:83], v[240:243], v[160:163]
  ds_read_b64_tr_b16 v[36:37], v13 offset:32768
  v_mul_f32 v16, s76, v16
  v_mfma_f32_16x16x32_bf16 v[176:179], v[84:87], v[240:243], v[176:179]
  ds_read_b64_tr_b16 v[38:39], v13 offset:33792
  v_mul_f32 v17, s76, v17
  v_mul_f32 v18, s76, v18
  v_mfma_f32_16x16x32_bf16 v[192:195], v[88:91], v[240:243], v[192:195]
  ds_read_b64_tr_b16 v[40:41], v12 offset:33024
  v_mul_f32 v19, s76, v19
  v_mfma_f32_16x16x32_bf16 v[208:211], v[92:95], v[240:243], v[208:211]
  ds_read_b64_tr_b16 v[42:43], v12 offset:34048
  v_mul_f32 v20, s76, v20
  v_mul_f32 v21, s76, v21
  v_mfma_f32_16x16x32_bf16 v[100:103], v[64:67], v[244:247], v[100:103]
  buffer_load_dwordx4 v4, s[32:35], s26 offen offset:1024 sc1 lds
  v_mul_f32 v22, s76, v22
  v_mfma_f32_16x16x32_bf16 v[116:119], v[68:71], v[244:247], v[116:119]
  ds_read_b64_tr_b16 v[44:45], v13 offset:33024
  v_mul_f32 v23, s76, v23
  v_cvt_pk_bf16_f32 v24, v16, v17
  v_mfma_f32_16x16x32_bf16 v[132:135], v[72:75], v[244:247], v[132:135]
  ds_read_b64_tr_b16 v[46:47], v13 offset:34048
  v_cvt_pk_bf16_f32 v25, v18, v19
  v_mfma_f32_16x16x32_bf16 v[148:151], v[76:79], v[244:247], v[148:151]
  ds_read_b128 v[224:227], v14 offset:0
  v_cvt_pk_bf16_f32 v26, v20, v21
  v_cvt_pk_bf16_f32 v27, v22, v23
  v_mfma_f32_16x16x32_bf16 v[164:167], v[80:83], v[244:247], v[164:167]
  ds_read_b128 v[228:231], v14 offset:1024
  buffer_store_dwordx4 v[24:27], v2, s[40:43], s64 offen offset:0 sc1
  v_mfma_f32_16x16x32_bf16 v[180:183], v[84:87], v[244:247], v[180:183]
  buffer_load_dwordx4 v5, s[32:35], s26 offen offset:2048 sc1 lds
  v_accvgpr_read_b32 v16, a72
  v_accvgpr_read_b32 v17, a73
  v_mfma_f32_16x16x32_bf16 v[196:199], v[88:91], v[244:247], v[196:199]
  ds_read_b64_tr_b16 v[48:49], v12 offset:33280
  v_accvgpr_read_b32 v18, a74
  v_mfma_f32_16x16x32_bf16 v[212:215], v[92:95], v[244:247], v[212:215]
  ds_read_b64_tr_b16 v[50:51], v12 offset:34304
  v_accvgpr_read_b32 v19, a75
  v_accvgpr_read_b32 v20, a76
  v_mfma_f32_16x16x32_bf16 v[104:107], v[64:67], v[248:251], v[104:107]
  ds_read_b64_tr_b16 v[52:53], v13 offset:33280
  v_accvgpr_read_b32 v21, a77
  v_accvgpr_read_b32 v22, a78
  v_mfma_f32_16x16x32_bf16 v[120:123], v[68:71], v[248:251], v[120:123]
  ds_read_b64_tr_b16 v[54:55], v13 offset:34304
  v_accvgpr_read_b32 v23, a79
  v_mfma_f32_16x16x32_bf16 v[136:139], v[72:75], v[248:251], v[136:139]
  buffer_load_dwordx4 v6, s[32:35], s26 offen offset:3072 sc1 lds
  v_mul_f32 v16, s76, v16
  v_mul_f32 v17, s76, v17
  v_mfma_f32_16x16x32_bf16 v[152:155], v[76:79], v[248:251], v[152:155]
  s_add_u32 s26, s26, 1024
  ds_read_b64_tr_b16 v[56:57], v12 offset:33536
  v_mul_f32 v18, s76, v18
  v_mfma_f32_16x16x32_bf16 v[168:171], v[80:83], v[248:251], v[168:171]
  ds_read_b64_tr_b16 v[58:59], v12 offset:34560
  v_mul_f32 v19, s76, v19
  v_mul_f32 v20, s76, v20
  v_mfma_f32_16x16x32_bf16 v[184:187], v[84:87], v[248:251], v[184:187]
  ds_read_b64_tr_b16 v[60:61], v13 offset:33536
  v_mul_f32 v21, s76, v21
  v_mfma_f32_16x16x32_bf16 v[200:203], v[88:91], v[248:251], v[200:203]
  ds_read_b64_tr_b16 v[62:63], v13 offset:34560
  v_mul_f32 v22, s76, v22
  v_mul_f32 v23, s76, v23
  v_mfma_f32_16x16x32_bf16 v[216:219], v[92:95], v[248:251], v[216:219]
  v_cvt_pk_bf16_f32 v28, v16, v17
  v_cvt_pk_bf16_f32 v29, v18, v19
  v_mfma_f32_16x16x32_bf16 v[108:111], v[64:67], v[252:255], v[108:111]
  ds_read_b128 v[232:235], v14 offset:2048
  v_cvt_pk_bf16_f32 v30, v20, v21
  v_cvt_pk_bf16_f32 v31, v22, v23
  v_mfma_f32_16x16x32_bf16 v[124:127], v[68:71], v[252:255], v[124:127]
  ds_read_b128 v[236:239], v14 offset:3072
  buffer_store_dwordx4 v[28:31], v2, s[40:43], s64 offen offset:1024 sc1
  v_mfma_f32_16x16x32_bf16 v[140:143], v[72:75], v[252:255], v[140:143]
  v_and_b32 v11, 15, v1
  v_lshrrev_b32 v10, 4, v1
  v_lshlrev_b32 v10, 2, v10
  v_mfma_f32_16x16x32_bf16 v[156:159], v[76:79], v[252:255], v[156:159]
  v_sub_u32 v11, v11, v10
  v_cmp_le_i32 s[68:69], 0, v11
  v_mfma_f32_16x16x32_bf16 v[172:175], v[80:83], v[252:255], v[172:175]
  v_cmp_le_i32 s[70:71], 1, v11
  v_cmp_le_i32 s[72:73], 2, v11
  v_cmp_le_i32 s[74:75], 3, v11
  v_mfma_f32_16x16x32_bf16 v[188:191], v[84:87], v[252:255], v[188:191]
  v_and_b32 v8, 7, v1
  v_lshlrev_b32 v8, 7, v8
  v_mfma_f32_16x16x32_bf16 v[204:207], v[88:91], v[252:255], v[204:207]
  v_add_u32 v8, s30, v8
  v_mfma_f32_16x16x32_bf16 v[220:223], v[92:95], v[252:255], v[220:223]
  s_waitcnt vmcnt(16) lgkmcnt(0)
  v_mfma_f32_16x16x32_bf16 v[96:99], v[32:35], v[224:227], v[96:99]
  v_accvgpr_read_b32 v16, a80
  v_accvgpr_read_b32 v17, a81
  v_accvgpr_read_b32 v18, a82
  v_mfma_f32_16x16x32_bf16 v[112:115], v[36:39], v[224:227], v[112:115]
  ds_read_b64_tr_b16 v[64:65], v12 offset:40960
  v_accvgpr_read_b32 v19, a83
  v_accvgpr_read_b32 v20, a84
  v_mfma_f32_16x16x32_bf16 v[128:131], v[40:43], v[224:227], v[128:131]
  s_add_u32 m0, s24, 65536
  ds_read_b64_tr_b16 v[66:67], v12 offset:41984
  v_accvgpr_read_b32 v21, a85
  v_accvgpr_read_b32 v22, a86
  v_mfma_f32_16x16x32_bf16 v[144:147], v[44:47], v[224:227], v[144:147]
  buffer_load_dwordx4 v3, s[32:35], s26 offen offset:0 sc1 lds
  v_accvgpr_read_b32 v23, a87
  v_mul_f32 v16, s76, v16
  v_mfma_f32_16x16x32_bf16 v[160:163], v[48:51], v[224:227], v[160:163]
  ds_read_b64_tr_b16 v[68:69], v13 offset:40960
  v_mul_f32 v17, s76, v17
  v_mul_f32 v18, s76, v18
  v_mfma_f32_16x16x32_bf16 v[176:179], v[52:55], v[224:227], v[176:179]
  ds_read_b64_tr_b16 v[70:71], v13 offset:41984
  v_mul_f32 v19, s76, v19
  v_mul_f32 v20, s76, v20
  v_mfma_f32_16x16x32_bf16 v[192:195], v[56:59], v[224:227], v[192:195]
  ds_read_b64_tr_b16 v[72:73], v12 offset:41216
  v_mul_f32 v21, s76, v21
  v_mul_f32 v22, s76, v22
  v_mfma_f32_16x16x32_bf16 v[208:211], v[60:63], v[224:227], v[208:211]
  ds_read_b64_tr_b16 v[74:75], v12 offset:42240
  v_mul_f32 v23, s76, v23
  v_mfma_f32_16x16x32_bf16 v[100:103], v[32:35], v[228:231], v[100:103]
  buffer_load_dwordx4 v4, s[32:35], s26 offen offset:1024 sc1 lds
  v_cvt_pk_bf16_f32 v24, v16, v17
  v_cvt_pk_bf16_f32 v25, v18, v19
  v_mfma_f32_16x16x32_bf16 v[116:119], v[36:39], v[228:231], v[116:119]
  ds_read_b64_tr_b16 v[76:77], v13 offset:41216
  v_cvt_pk_bf16_f32 v26, v20, v21
  v_cvt_pk_bf16_f32 v27, v22, v23
  v_mfma_f32_16x16x32_bf16 v[132:135], v[40:43], v[228:231], v[132:135]
  ds_read_b64_tr_b16 v[78:79], v13 offset:42240
  buffer_store_dwordx4 v[24:27], v2, s[40:43], s64 offen offset:2048 sc1
  v_accvgpr_read_b32 v16, a88
  v_mfma_f32_16x16x32_bf16 v[148:151], v[44:47], v[228:231], v[148:151]
  ds_read_b128 v[240:243], v14 offset:32768
  v_accvgpr_read_b32 v17, a89
  v_accvgpr_read_b32 v18, a90
  v_mfma_f32_16x16x32_bf16 v[164:167], v[48:51], v[228:231], v[164:167]
  ds_read_b128 v[244:247], v14 offset:33792
  v_accvgpr_read_b32 v19, a91
  v_accvgpr_read_b32 v20, a92
  v_mfma_f32_16x16x32_bf16 v[180:183], v[52:55], v[228:231], v[180:183]
  buffer_load_dwordx4 v5, s[32:35], s26 offen offset:2048 sc1 lds
  v_accvgpr_read_b32 v21, a93
  v_accvgpr_read_b32 v22, a94
  v_mfma_f32_16x16x32_bf16 v[196:199], v[56:59], v[228:231], v[196:199]
  ds_read_b64_tr_b16 v[80:81], v12 offset:41472
  v_accvgpr_read_b32 v23, a95
  v_mfma_f32_16x16x32_bf16 v[212:215], v[60:63], v[228:231], v[212:215]
  ds_read_b64_tr_b16 v[82:83], v12 offset:42496
  v_mul_f32 v16, s76, v16
  v_mul_f32 v17, s76, v17
  v_mfma_f32_16x16x32_bf16 v[104:107], v[32:35], v[232:235], v[104:107]
  ds_read_b64_tr_b16 v[84:85], v13 offset:41472
  v_mul_f32 v18, s76, v18
  v_mul_f32 v19, s76, v19
  v_mfma_f32_16x16x32_bf16 v[120:123], v[36:39], v[232:235], v[120:123]
  ds_read_b64_tr_b16 v[86:87], v13 offset:42496
  v_mul_f32 v20, s76, v20
  v_mul_f32 v21, s76, v21
  v_mfma_f32_16x16x32_bf16 v[136:139], v[40:43], v[232:235], v[136:139]
  buffer_load_dwordx4 v6, s[32:35], s26 offen offset:3072 sc1 lds
  v_mul_f32 v22, s76, v22
  v_mul_f32 v23, s76, v23
  v_mfma_f32_16x16x32_bf16 v[152:155], v[44:47], v[232:235], v[152:155]
  s_add_u32 s26, s26, 1024
  ds_read_b64_tr_b16 v[88:89], v12 offset:41728
  v_cvt_pk_bf16_f32 v28, v16, v17
  v_cvt_pk_bf16_f32 v29, v18, v19
  v_mfma_f32_16x16x32_bf16 v[168:171], v[48:51], v[232:235], v[168:171]
  ds_read_b64_tr_b16 v[90:91], v12 offset:42752
  v_cvt_pk_bf16_f32 v30, v20, v21
  v_cvt_pk_bf16_f32 v31, v22, v23
  v_mfma_f32_16x16x32_bf16 v[184:187], v[52:55], v[232:235], v[184:187]
  ds_read_b64_tr_b16 v[92:93], v13 offset:41728
  buffer_store_dwordx4 v[28:31], v2, s[40:43], s64 offen offset:3072 sc1
  v_add_u32 v9, 0, v1
  v_mfma_f32_16x16x32_bf16 v[200:203], v[56:59], v[232:235], v[200:203]
  ds_read_b64_tr_b16 v[94:95], v13 offset:42752
  v_mul_u32_u24 v10, 6554, v9
  v_mfma_f32_16x16x32_bf16 v[216:219], v[60:63], v[232:235], v[216:219]
  v_lshrrev_b32 v10, 16, v10
  v_mul_u32_u24 v10, 1120, v10
  v_lshl_add_u32 v10, v9, 4, v10
  v_mfma_f32_16x16x32_bf16 v[108:111], v[32:35], v[236:239], v[108:111]
  ds_read_b128 v[248:251], v14 offset:34816
  v_accvgpr_write_b32 a248, v10
  v_add_u32 v9, 64, v1
  v_mfma_f32_16x16x32_bf16 v[124:127], v[36:39], v[236:239], v[124:127]
  ds_read_b128 v[252:255], v14 offset:35840
  v_mul_u32_u24 v10, 6554, v9
  v_lshrrev_b32 v10, 16, v10
  v_mfma_f32_16x16x32_bf16 v[140:143], v[40:43], v[236:239], v[140:143]
  v_mul_u32_u24 v10, 1120, v10
  v_lshl_add_u32 v10, v9, 4, v10
  v_accvgpr_write_b32 a249, v10
  v_mfma_f32_16x16x32_bf16 v[156:159], v[44:47], v[236:239], v[156:159]
  v_xor_b32 v14, 0x10000, v14
  v_add_u32 v9, 128, v1
  v_mul_u32_u24 v10, 6554, v9
  v_mfma_f32_16x16x32_bf16 v[172:175], v[48:51], v[236:239], v[172:175]
  v_lshrrev_b32 v10, 16, v10
  v_mul_u32_u24 v10, 1120, v10
  v_lshl_add_u32 v10, v9, 4, v10
  v_mfma_f32_16x16x32_bf16 v[188:191], v[52:55], v[236:239], v[188:191]
  v_xor_b32 v12, 0x10000, v12
  v_accvgpr_write_b32 a250, v10
  v_mfma_f32_16x16x32_bf16 v[204:207], v[56:59], v[236:239], v[204:207]
  v_xor_b32 v13, 0x10000, v13
  v_mfma_f32_16x16x32_bf16 v[220:223], v[60:63], v[236:239], v[220:223]
  s_waitcnt vmcnt(15) lgkmcnt(0)
  v_mfma_f32_16x16x32_bf16 v[96:99], v[64:67], v[240:243], v[96:99]
  s_barrier
  v_accvgpr_read_b32 v16, a96
  v_accvgpr_read_b32 v17, a97
  v_accvgpr_read_b32 v18, a98
  v_mfma_f32_16x16x32_bf16 v[112:115], v[68:71], v[240:243], v[112:115]
  s_add_u32 s64, s64, 4096
  ds_read_b64_tr_b16 v[32:33], v12 offset:0
  v_accvgpr_read_b32 v19, a99
  v_accvgpr_read_b32 v20, a100
  v_mfma_f32_16x16x32_bf16 v[128:131], v[72:75], v[240:243], v[128:131]
  s_add_u32 m0, s24, 98304
  ds_read_b64_tr_b16 v[34:35], v12 offset:1024
  v_accvgpr_read_b32 v21, a101
  v_accvgpr_read_b32 v22, a102
  v_mfma_f32_16x16x32_bf16 v[144:147], v[76:79], v[240:243], v[144:147]
  buffer_load_dwordx4 v3, s[32:35], s26 offen offset:0 sc1 lds
  v_accvgpr_read_b32 v23, a103
  v_mfma_f32_16x16x32_bf16 v[160:163], v[80:83], v[240:243], v[160:163]
  s_getpc_b64 s[78:79]
fa_pc2:
  ds_read_b64_tr_b16 v[36:37], v13 offset:0
  v_mul_f32 v16, s76, v16
  v_mul_f32 v17, s76, v17
  v_mfma_f32_16x16x32_bf16 v[176:179], v[84:87], v[240:243], v[176:179]
  s_lshr_b32 s23, s2, 3
  ds_read_b64_tr_b16 v[38:39], v13 offset:1024
  v_mul_f32 v18, s76, v18
  v_mul_f32 v19, s76, v19
  v_mfma_f32_16x16x32_bf16 v[192:195], v[88:91], v[240:243], v[192:195]
  s_and_b32 s23, s23, 7
  ds_read_b64_tr_b16 v[40:41], v12 offset:256
  v_mul_f32 v20, s76, v20
  v_mfma_f32_16x16x32_bf16 v[208:211], v[92:95], v[240:243], v[208:211]
  s_lshl_b32 s23, s23, 2
  ds_read_b64_tr_b16 v[42:43], v12 offset:1280
  v_mul_f32 v21, s76, v21
  v_mul_f32 v22, s76, v22
  v_mfma_f32_16x16x32_bf16 v[100:103], v[64:67], v[244:247], v[100:103]
  s_add_u32 s23, s23, s20
  buffer_load_dwordx4 v4, s[32:35], s26 offen offset:1024 sc1 lds
  v_mul_f32 v23, s76, v23
  v_cvt_pk_bf16_f32 v24, v16, v17
  v_mfma_f32_16x16x32_bf16 v[116:119], v[68:71], v[244:247], v[116:119]
  s_lshl_b32 s23, s23, 11
  ds_read_b64_tr_b16 v[44:45], v13 offset:256
  v_cvt_pk_bf16_f32 v25, v18, v19
  v_mfma_f32_16x16x32_bf16 v[132:135], v[72:75], v[244:247], v[132:135]
  s_min_u32 s23, s23, fa_codeend-fa_pc2-2048
  ds_read_b64_tr_b16 v[46:47], v13 offset:1280
  v_cvt_pk_bf16_f32 v26, v20, v21
  v_cvt_pk_bf16_f32 v27, v22, v23
  v_mfma_f32_16x16x32_bf16 v[148:151], v[76:79], v[244:247], v[148:151]
  ds_read_b128 v[224:227], v14 offset:0
  buffer_store_dwordx4 v[24:27], v2, s[40:43], s64 offen offset:0 sc1
  v_accvgpr_read_b32 v16, a104
  v_mfma_f32_16x16x32_bf16 v[164:167], v[80:83], v[244:247], v[164:167]
  ds_read_b128 v[228:231], v14 offset:1024
  v_accvgpr_read_b32 v17, a105
  v_accvgpr_read_b32 v18, a106
  v_mfma_f32_16x16x32_bf16 v[180:183], v[84:87], v[244:247], v[180:183]
  buffer_load_dwordx4 v5, s[32:35], s26 offen offset:2048 sc1 lds
  v_accvgpr_read_b32 v19, a107
  v_mfma_f32_16x16x32_bf16 v[196:199], v[88:91], v[244:247], v[196:199]
  ds_read_b64_tr_b16 v[48:49], v12 offset:512
  v_accvgpr_read_b32 v20, a108
  v_accvgpr_read_b32 v21, a109
  v_mfma_f32_16x16x32_bf16 v[212:215], v[92:95], v[244:247], v[212:215]
  ds_read_b64_tr_b16 v[50:51], v12 offset:1536
  v_accvgpr_read_b32 v22, a110
  v_accvgpr_read_b32 v23, a111
  v_mfma_f32_16x16x32_bf16 v[104:107], v[64:67], v[248:251], v[104:107]
  ds_read_b64_tr_b16 v[52:53], v13 offset:512
  v_mul_f32 v16, s76, v16
  v_mfma_f32_16x16x32_bf16 v[120:123], v[68:71], v[248:251], v[120:123]
  ds_read_b64_tr_b16 v[54:55], v13 offset:1536
  v_mul_f32 v17, s76, v17
  v_mul_f32 v18, s76, v18
  v_mfma_f32_16x16x32_bf16 v[136:139], v[72:75], v[248:251], v[136:139]
  buffer_load_dwordx4 v6, s[32:35], s26 offen offset:3072 sc1 lds
  v_mul_f32 v19, s76, v19
  v_mul_f32 v20, s76, v20
  v_mfma_f32_16x16x32_bf16 v[152:155], v[76:79], v[248:251], v[152:155]
  s_add_u32 s26, s26, 1024
  ds_read_b64_tr_b16 v[56:57], v12 offset:768
  v_mul_f32 v21, s76, v21
  v_mfma_f32_16x16x32_bf16 v[168:171], v[80:83], v[248:251], v[168:171]
  ds_read_b64_tr_b16 v[58:59], v12 offset:1792
  v_mul_f32 v22, s76, v22
  v_mul_f32 v23, s76, v23
  v_mfma_f32_16x16x32_bf16 v[184:187], v[84:87], v[248:251], v[184:187]
  ds_read_b64_tr_b16 v[60:61], v13 offset:768
  v_cvt_pk_bf16_f32 v28, v16, v17
  v_cvt_pk_bf16_f32 v29, v18, v19
  v_mfma_f32_16x16x32_bf16 v[200:203], v[88:91], v[248:251], v[200:203]
  ds_read_b64_tr_b16 v[62:63], v13 offset:1792
  v_cvt_pk_bf16_f32 v30, v20, v21
  v_cvt_pk_bf16_f32 v31, v22, v23
  v_mfma_f32_16x16x32_bf16 v[216:219], v[92:95], v[248:251], v[216:219]
  buffer_store_dwordx4 v[28:31], v2, s[40:43], s64 offen offset:1024 sc1
  v_mfma_f32_16x16x32_bf16 v[108:111], v[64:67], v[252:255], v[108:111]
  ds_read_b128 v[232:235], v14 offset:2048
  buffer_store_dwordx4 a[192:195], v2, s[40:43], s64 offen offset:2048 sc1
  v_and_b32 v11, 15, v1
  v_mfma_f32_16x16x32_bf16 v[124:127], v[68:71], v[252:255], v[124:127]
  ds_read_b128 v[236:239], v14 offset:3072
  v_lshl_add_u32 v11, v11, 7, s23
  v_add_u32 v9, 192, v1
  v_mfma_f32_16x16x32_bf16 v[140:143], v[72:75], v[252:255], v[140:143]
  v_mul_u32_u24 v10, 6554, v9
  v_lshrrev_b32 v10, 16, v10
  v_mfma_f32_16x16x32_bf16 v[156:159], v[76:79], v[252:255], v[156:159]
  v_mul_u32_u24 v10, 1120, v10
  v_lshl_add_u32 v10, v9, 4, v10
  v_accvgpr_write_b32 a251, v10
  v_mfma_f32_16x16x32_bf16 v[172:175], v[80:83], v[252:255], v[172:175]
  global_load_dword v11, v11, s[78:79]
  v_add_u32 v9, 256, v1
  v_mul_u32_u24 v10, 6554, v9
  v_mfma_f32_16x16x32_bf16 v[188:191], v[84:87], v[252:255], v[188:191]
  v_lshrrev_b32 v10, 16, v10
  v_mul_u32_u24 v10, 1120, v10
  v_mfma_f32_16x16x32_bf16 v[204:207], v[88:91], v[252:255], v[204:207]
  v_lshl_add_u32 v10, v9, 4, v10
  v_accvgpr_write_b32 a252, v10
  v_mfma_f32_16x16x32_bf16 v[220:223], v[92:95], v[252:255], v[220:223]
  s_waitcnt vmcnt(15) lgkmcnt(0)
  v_mfma_f32_16x16x32_bf16 v[96:99], v[32:35], v[224:227], v[96:99]
  v_mfma_f32_16x16x32_bf16 v[112:115], v[36:39], v[224:227], v[112:115]
  s_mul_i32 s34, s20, 5120
  ds_read_b64_tr_b16 v[64:65], v12 offset:8192
  buffer_store_dwordx4 a[196:199], v2, s[40:43], s64 offen offset:3072 sc1
  v_mfma_f32_16x16x32_bf16 v[128:131], v[40:43], v[224:227], v[128:131]
  s_add_u32 s34, s34, 131072
  ds_read_b64_tr_b16 v[66:67], v12 offset:9216
  v_mfma_f32_16x16x32_bf16 v[144:147], v[44:47], v[224:227], v[144:147]
  s_and_b32 s32, s21, 3
  buffer_load_dword v15, v8, s[40:43], 0 offen sc1
  v_mfma_f32_16x16x32_bf16 v[160:163], v[48:51], v[224:227], v[160:163]
  s_min_u32 s32, s32, 2
  ds_read_b64_tr_b16 v[68:69], v13 offset:8192
  v_mfma_f32_16x16x32_bf16 v[176:179], v[52:55], v[224:227], v[176:179]
  s_add_u32 s32, s32, 5
  ds_read_b64_tr_b16 v[70:71], v13 offset:9216
  v_mfma_f32_16x16x32_bf16 v[192:195], v[56:59], v[224:227], v[192:195]
  s_lshl_b32 s32, s32, 14
  ds_read_b64_tr_b16 v[72:73], v12 offset:8448
  v_mfma_f32_16x16x32_bf16 v[208:211], v[60:63], v[224:227], v[208:211]
  s_mov_b32 s9, -1
  ds_read_b64_tr_b16 v[74:75], v12 offset:9472
  v_mfma_f32_16x16x32_bf16 v[100:103], v[32:35], v[228:231], v[100:103]
  s_sub_u32 s23, s2, 64
  v_mfma_f32_16x16x32_bf16 v[116:119], v[36:39], v[228:231], v[116:119]
  s_cmp_lt_u32 s23, 96
  s_cselect_b32 s9, 0, s9
  ds_read_b64_tr_b16 v[76:77], v13 offset:8448
  v_mfma_f32_16x16x32_bf16 v[132:135], v[40:43], v[228:231], v[132:135]
  s_cmp_ge_u32 s2, 224
  s_cselect_b32 s9, 0, s9
  ds_read_b64_tr_b16 v[78:79], v13 offset:9472
  v_mfma_f32_16x16x32_bf16 v[148:151], v[44:47], v[228:231], v[148:151]
  s_and_b32 s32, s32, s9
  ds_read_b128 v[240:243], v14 offset:32768
  v_mfma_f32_16x16x32_bf16 v[164:167], v[48:51], v[228:231], v[164:167]
  s_sub_u32 s23, s2, 170
  ds_read_b128 v[244:247], v14 offset:33792
  v_mfma_f32_16x16x32_bf16 v[180:183], v[52:55], v[228:231], v[180:183]
  s_cmp_lt_u32 s23, 54
  s_cselect_b32 s32, 81920, s32
  s_add_u32 s64, s64, 126976
  buffer_store_dwordx4 a[200:203], v2, s[40:43], s64 offen offset:0 sc1
  v_mfma_f32_16x16x32_bf16 v[196:199], v[56:59], v[228:231], v[196:199]
  s_mov_b32 s67, s2
  ds_read_b64_tr_b16 v[80:81], v12 offset:8704
  v_mfma_f32_16x16x32_bf16 v[212:215], v[60:63], v[228:231], v[212:215]
  s_mov_b32 s8, 0
  ds_read_b64_tr_b16 v[82:83], v12 offset:9728
  v_mfma_f32_16x16x32_bf16 v[104:107], v[32:35], v[232:235], v[104:107]
  s_mov_b32 s66, 0
  ds_read_b64_tr_b16 v[84:85], v13 offset:8704
  v_mfma_f32_16x16x32_bf16 v[120:123], v[36:39], v[232:235], v[120:123]
  s_mov_b32 s11, 0
  ds_read_b64_tr_b16 v[86:87], v13 offset:9728
  v_mfma_f32_16x16x32_bf16 v[136:139], v[40:43], v[232:235], v[136:139]
  s_mov_b32 s12, 0
  v_mfma_f32_16x16x32_bf16 v[152:155], v[44:47], v[232:235], v[152:155]
  s_lshl_b32 s15, s22, 1
  ds_read_b64_tr_b16 v[88:89], v12 offset:8960
  v_mfma_f32_16x16x32_bf16 v[168:171], v[48:51], v[232:235], v[168:171]
  s_add_u32 s23, s15, 6
  ds_read_b64_tr_b16 v[90:91], v12 offset:9984
  v_mfma_f32_16x16x32_bf16 v[184:187], v[52:55], v[232:235], v[184:187]
  s_sub_u32 s15, 24, s15
  ds_read_b64_tr_b16 v[92:93], v13 offset:8960
  buffer_store_dwordx4 a[204:207], v2, s[40:43], s64 offen offset:1024 sc1
  v_mfma_f32_16x16x32_bf16 v[200:203], v[56:59], v[232:235], v[200:203]
  s_max_u32 s15, s15, s23
  ds_read_b64_tr_b16 v[94:95], v13 offset:9984
  v_mfma_f32_16x16x32_bf16 v[216:219], v[60:63], v[232:235], v[216:219]
  s_lshl_b32 s15, s15, 14
  v_mfma_f32_16x16x32_bf16 v[108:111], v[32:35], v[236:239], v[108:111]
  ds_read_b128 v[248:251], v14 offset:34816
  v_mfma_f32_16x16x32_bf16 v[124:127], v[36:39], v[236:239], v[124:127]
  ds_read_b128 v[252:255], v14 offset:35840
  v_mfma_f32_16x16x32_bf16 v[140:143], v[40:43], v[236:239], v[140:143]
  v_mfma_f32_16x16x32_bf16 v[156:159], v[44:47], v[236:239], v[156:159]
  v_xor_b32 v14, 0x10000, v14
  v_mfma_f32_16x16x32_bf16 v[172:175], v[48:51], v[236:239], v[172:175]
  v_mfma_f32_16x16x32_bf16 v[188:191], v[52:55], v[236:239], v[188:191]
  v_mfma_f32_16x16x32_bf16 v[204:207], v[56:59], v[236:239], v[204:207]
  v_mfma_f32_16x16x32_bf16 v[220:223], v[60:63], v[236:239], v[220:223]
  s_waitcnt vmcnt(13) lgkmcnt(0)
  v_mfma_f32_16x16x32_bf16 v[96:99], v[64:67], v[240:243], v[96:99]
  s_barrier
  v_lshrrev_b32 v6, 2, v1
  v_mfma_f32_16x16x32_bf16 v[112:115], v[68:71], v[240:243], v[112:115]
  s_and_b32 s23, s20, 1
  ds_read_b64_tr_b16 v[32:33], v12 offset:32768
  buffer_store_dwordx4 a[208:211], v2, s[40:43], s64 offen offset:2048 sc1
  v_mul_u32_u24 v6, 160, v6
  v_mfma_f32_16x16x32_bf16 v[128:131], v[72:75], v[240:243], v[128:131]
  s_lshl_b32 s23, s23, 12
  ds_read_b64_tr_b16 v[34:35], v12 offset:33792
  v_and_b32 v9, 3, v1
  v_mfma_f32_16x16x32_bf16 v[144:147], v[76:79], v[240:243], v[144:147]
  s_cmp_lt_u32 s20, 2
  s_cselect_b32 s24, 106496, 0
  v_lshl_add_u32 v6, v9, 3, v6
  v_mfma_f32_16x16x32_bf16 v[160:163], v[80:83], v[240:243], v[160:163]
  s_add_u32 s24, s24, s23
  ds_read_b64_tr_b16 v[36:37], v13 offset:32768
  v_add_u32 v6, s34, v6
  v_mfma_f32_16x16x32_bf16 v[176:179], v[84:87], v[240:243], v[176:179]
  s_lshl_b32 s26, s20, 12
  ds_read_b64_tr_b16 v[38:39], v13 offset:33792
  v_mov_b32 v3, v2
  v_mfma_f32_16x16x32_bf16 v[192:195], v[88:91], v[240:243], v[192:195]
  s_mov_b32 s27, s26
  ds_read_b64_tr_b16 v[40:41], v12 offset:33024
  v_mov_b32 v4, 0xff800000
  v_mfma_f32_16x16x32_bf16 v[208:211], v[92:95], v[240:243], v[208:211]
  s_add_u32 s25, s27, 49152
  ds_read_b64_tr_b16 v[42:43], v12 offset:34048
  v_add_u32 v9, 106496, v2
  v_mfma_f32_16x16x32_bf16 v[100:103], v[64:67], v[244:247], v[100:103]
  s_load_dwordx4 s[4:7], s[0:1], 64
  v_mfma_f32_16x16x32_bf16 v[116:119], v[68:71], v[244:247], v[116:119]
  s_load_dwordx2 s[60:61], s[0:1], 80
  ds_read_b64_tr_b16 v[44:45], v13 offset:33024
  v_mfma_f32_16x16x32_bf16 v[132:135], v[72:75], v[244:247], v[132:135]
  s_add_u32 s23, s20, 1
  ds_read_b64_tr_b16 v[46:47], v13 offset:34048
  v_mfma_f32_16x16x32_bf16 v[148:151], v[76:79], v[244:247], v[148:151]
  s_lshr_b32 s23, s23, 1
  ds_read_b128 v[224:227], v14 offset:0
  buffer_store_dwordx4 a[212:215], v2, s[40:43], s64 offen offset:3072 sc1
  v_mfma_f32_16x16x32_bf16 v[164:167], v[80:83], v[244:247], v[164:167]
  s_lshl_b32 s28, s22, 1
  ds_read_b128 v[228:231], v14 offset:1024
  v_mfma_f32_16x16x32_bf16 v[180:183], v[84:87], v[244:247], v[180:183]
  s_add_u32 s28, s28, s23
  v_mfma_f32_16x16x32_bf16 v[196:199], v[88:91], v[244:247], v[196:199]
  s_lshl_b32 s23, s22, 2
  ds_read_b64_tr_b16 v[48:49], v12 offset:33280
  v_mfma_f32_16x16x32_bf16 v[212:215], v[92:95], v[244:247], v[212:215]
  s_sub_u32 s29, 28, s23
  ds_read_b64_tr_b16 v[50:51], v12 offset:34304
  v_mfma_f32_16x16x32_bf16 v[104:107], v[64:67], v[248:251], v[104:107]
  s_and_b32 s23, s20, 1
  ds_read_b64_tr_b16 v[52:53], v13 offset:33280
  v_mfma_f32_16x16x32_bf16 v[120:123], v[68:71], v[248:251], v[120:123]
  s_add_u32 s29, s29, s23
  ds_read_b64_tr_b16 v[54:55], v13 offset:34304
  v_mfma_f32_16x16x32_bf16 v[136:139], v[72:75], v[248:251], v[136:139]
  v_mfma_f32_16x16x32_bf16 v[152:155], v[76:79], v[248:251], v[152:155]
  ds_read_b64_tr_b16 v[56:57], v12 offset:33536
  v_mfma_f32_16x16x32_bf16 v[168:171], v[80:83], v[248:251], v[168:171]
  s_add_u32 s64, s64, 4096
  ds_read_b64_tr_b16 v[58:59], v12 offset:34560
  v_mfma_f32_16x16x32_bf16 v[184:187], v[84:87], v[248:251], v[184:187]
  ds_read_b64_tr_b16 v[60:61], v13 offset:33536
  buffer_store_dwordx4 a[216:219], v2, s[40:43], s64 offen offset:0 sc1
  v_mfma_f32_16x16x32_bf16 v[200:203], v[88:91], v[248:251], v[200:203]
  ds_read_b64_tr_b16 v[62:63], v13 offset:34560
  v_mfma_f32_16x16x32_bf16 v[216:219], v[92:95], v[248:251], v[216:219]
  v_mfma_f32_16x16x32_bf16 v[108:111], v[64:67], v[252:255], v[108:111]
  ds_read_b128 v[232:235], v14 offset:2048
  v_mfma_f32_16x16x32_bf16 v[124:127], v[68:71], v[252:255], v[124:127]
  ds_read_b128 v[236:239], v14 offset:3072
  v_mfma_f32_16x16x32_bf16 v[140:143], v[72:75], v[252:255], v[140:143]
  v_mfma_f32_16x16x32_bf16 v[156:159], v[76:79], v[252:255], v[156:159]
  v_mfma_f32_16x16x32_bf16 v[172:175], v[80:83], v[252:255], v[172:175]
  v_mfma_f32_16x16x32_bf16 v[188:191], v[84:87], v[252:255], v[188:191]
  v_mfma_f32_16x16x32_bf16 v[204:207], v[88:91], v[252:255], v[204:207]
  v_mfma_f32_16x16x32_bf16 v[220:223], v[92:95], v[252:255], v[220:223]
  s_waitcnt vmcnt(10) lgkmcnt(0)
  v_mfma_f32_16x16x32_bf16 v[96:99], v[32:35], v[224:227], v[96:99]
  v_mfma_f32_16x16x32_bf16 v[112:115], v[36:39], v[224:227], v[112:115]
  s_cmp_ge_u32 s20, 2
  s_cselect_b32 s4, s6, s4
  s_cselect_b32 s5, s7, s5
  ds_read_b64_tr_b16 v[64:65], v12 offset:40960
  buffer_store_dwordx4 a[220:223], v2, s[40:43], s64 offen offset:1024 sc1
  v_mfma_f32_16x16x32_bf16 v[128:131], v[40:43], v[224:227], v[128:131]
  s_mov_b32 s62, 2211840
  ds_read_b64_tr_b16 v[66:67], v12 offset:41984
  v_mfma_f32_16x16x32_bf16 v[144:147], v[44:47], v[224:227], v[144:147]
  s_mov_b32 s63, 0x20000
  v_mfma_f32_16x16x32_bf16 v[160:163], v[48:51], v[224:227], v[160:163]
  s_mov_b64 s[56:57], s[52:53]
  ds_read_b64_tr_b16 v[68:69], v13 offset:40960
  v_mfma_f32_16x16x32_bf16 v[176:179], v[52:55], v[224:227], v[176:179]
  s_mov_b32 s58, s54
  ds_read_b64_tr_b16 v[70:71], v13 offset:41984
  v_mfma_f32_16x16x32_bf16 v[192:195], v[56:59], v[224:227], v[192:195]
  s_mov_b64 s[52:53], s[4:5]
  ds_read_b64_tr_b16 v[72:73], v12 offset:41216
  v_mfma_f32_16x16x32_bf16 v[208:211], v[60:63], v[224:227], v[208:211]
  s_mov_b32 s54, 2211840
  ds_read_b64_tr_b16 v[74:75], v12 offset:42240
  v_mfma_f32_16x16x32_bf16 v[100:103], v[32:35], v[228:231], v[100:103]
  s_getpc_b64 s[36:37]
fa_copc:
  v_mfma_f32_16x16x32_bf16 v[116:119], v[36:39], v[228:231], v[116:119]
  s_add_u32 s36, s36, fa_co-fa_copc-4
  s_addc_u32 s37, s37, 0
  ds_read_b64_tr_b16 v[76:77], v13 offset:41216
  v_mfma_f32_16x16x32_bf16 v[132:135], v[40:43], v[228:231], v[132:135]
  s_lshl_b32 s31, s20, 11
  ds_read_b64_tr_b16 v[78:79], v13 offset:42240
  v_mfma_f32_16x16x32_bf16 v[148:151], v[44:47], v[228:231], v[148:151]
  s_add_u32 s31, s31, 2621440
  ds_read_b128 v[240:243], v14 offset:32768
  buffer_store_dwordx4 a[224:227], v2, s[40:43], s64 offen offset:2048 sc1
  v_mfma_f32_16x16x32_bf16 v[164:167], v[48:51], v[228:231], v[164:167]
  s_cmp_eq_u32 s2, 255
  s_cselect_b32 s31, s31, 1073741824
  ds_read_b128 v[244:247], v14 offset:33792
  v_mfma_f32_16x16x32_bf16 v[180:183], v[52:55], v[228:231], v[180:183]
  v_mfma_f32_16x16x32_bf16 v[196:199], v[56:59], v[228:231], v[196:199]
  ds_read_b64_tr_b16 v[80:81], v12 offset:41472
  v_mfma_f32_16x16x32_bf16 v[212:215], v[60:63], v[228:231], v[212:215]
  ds_read_b64_tr_b16 v[82:83], v12 offset:42496
  v_mfma_f32_16x16x32_bf16 v[104:107], v[32:35], v[232:235], v[104:107]
  ds_read_b64_tr_b16 v[84:85], v13 offset:41472
  v_mfma_f32_16x16x32_bf16 v[120:123], v[36:39], v[232:235], v[120:123]
  ds_read_b64_tr_b16 v[86:87], v13 offset:42496
  v_mfma_f32_16x16x32_bf16 v[136:139], v[40:43], v[232:235], v[136:139]
  v_mfma_f32_16x16x32_bf16 v[152:155], v[44:47], v[232:235], v[152:155]
  ds_read_b64_tr_b16 v[88:89], v12 offset:41728
  v_mfma_f32_16x16x32_bf16 v[168:171], v[48:51], v[232:235], v[168:171]
  ds_read_b64_tr_b16 v[90:91], v12 offset:42752
  v_mfma_f32_16x16x32_bf16 v[184:187], v[52:55], v[232:235], v[184:187]
  ds_read_b64_tr_b16 v[92:93], v13 offset:41728
  buffer_store_dwordx4 a[228:231], v2, s[40:43], s64 offen offset:3072 sc1
  v_mfma_f32_16x16x32_bf16 v[200:203], v[56:59], v[232:235], v[200:203]
  ds_read_b64_tr_b16 v[94:95], v13 offset:42752
  v_mfma_f32_16x16x32_bf16 v[216:219], v[60:63], v[232:235], v[216:219]
  v_mfma_f32_16x16x32_bf16 v[108:111], v[32:35], v[236:239], v[108:111]
  ds_read_b128 v[248:251], v14 offset:34816
  v_mfma_f32_16x16x32_bf16 v[124:127], v[36:39], v[236:239], v[124:127]
  ds_read_b128 v[252:255], v14 offset:35840
  v_mfma_f32_16x16x32_bf16 v[140:143], v[40:43], v[236:239], v[140:143]
  v_mfma_f32_16x16x32_bf16 v[156:159], v[44:47], v[236:239], v[156:159]
  v_xor_b32 v14, 0x10000, v14
  v_mfma_f32_16x16x32_bf16 v[172:175], v[48:51], v[236:239], v[172:175]
  v_mfma_f32_16x16x32_bf16 v[188:191], v[52:55], v[236:239], v[188:191]
  v_xor_b32 v12, 0x10000, v12
  v_mfma_f32_16x16x32_bf16 v[204:207], v[56:59], v[236:239], v[204:207]
  v_xor_b32 v13, 0x10000, v13
  v_mfma_f32_16x16x32_bf16 v[220:223], v[60:63], v[236:239], v[220:223]
  s_waitcnt vmcnt(8) lgkmcnt(0)
  v_mfma_f32_16x16x32_bf16 v[96:99], v[64:67], v[240:243], v[96:99]
  s_barrier
  buffer_load_dwordx4 v[232:235], v2, s[40:43], s31 offen sc1
  v_cmp_eq_u32 vcc, 0, v15
  v_mfma_f32_16x16x32_bf16 v[112:115], v[68:71], v[240:243], v[112:115]
  s_cbranch_vccnz fa_kv_spin
fa_kv_ok:
  buffer_load_dwordx4 v[236:239], v2, s[40:43], s31 offen offset:1024 sc1
  v_mfma_f32_16x16x32_bf16 v[128:131], v[72:75], v[240:243], v[128:131]
  s_mov_b32 m0, s24
  v_mov_b32 v228, 0
  v_mfma_f32_16x16x32_bf16 v[144:147], v[76:79], v[240:243], v[144:147]
  buffer_load_dwordx4 v2, s[44:47], s26 offen offset:0 sc1 lds
  v_mfma_f32_16x16x32_bf16 v[160:163], v[80:83], v[240:243], v[160:163]
  s_add_u32 s24, s24, 32768
  v_mov_b32 v229, 0
  v_mfma_f32_16x16x32_bf16 v[176:179], v[84:87], v[240:243], v[176:179]
  s_and_b32 s24, s24, 0x1ffff
  buffer_load_dwordx4 v2, s[44:47], s26 offen offset:1024 sc1 lds
  v_mfma_f32_16x16x32_bf16 v[192:195], v[88:91], v[240:243], v[192:195]
  v_mov_b32 v230, 0
  v_mfma_f32_16x16x32_bf16 v[208:211], v[92:95], v[240:243], v[208:211]
  buffer_load_dwordx4 v2, s[44:47], s26 offen offset:2048 sc1 lds
  v_mfma_f32_16x16x32_bf16 v[100:103], v[64:67], v[244:247], v[100:103]
  v_mov_b32 v231, 0
  v_mfma_f32_16x16x32_bf16 v[116:119], v[68:71], v[244:247], v[116:119]
  buffer_load_dwordx4 v2, s[44:47], s26 offen offset:3072 sc1 lds
  v_mfma_f32_16x16x32_bf16 v[132:135], v[72:75], v[244:247], v[132:135]
  s_add_u32 s26, s26, 16384
  v_cvt_pk_bf16_f32 v32, v96, v97
  v_cvt_pk_bf16_f32 v33, v98, v99
  v_mfma_f32_16x16x32_bf16 v[148:151], v[76:79], v[244:247], v[148:151]
  v_cvt_pk_bf16_f32 v34, v112, v113
  v_cvt_pk_bf16_f32 v35, v114, v115
  v_mfma_f32_16x16x32_bf16 v[164:167], v[80:83], v[244:247], v[164:167]
  s_mov_b32 m0, s24
  v_cvt_pk_bf16_f32 v40, v128, v129
  v_mfma_f32_16x16x32_bf16 v[180:183], v[84:87], v[244:247], v[180:183]
  buffer_load_dwordx4 v2, s[44:47], s26 offen offset:0 sc1 lds
  v_cvt_pk_bf16_f32 v41, v130, v131
  v_cvt_pk_bf16_f32 v42, v144, v145
  v_mfma_f32_16x16x32_bf16 v[196:199], v[88:91], v[244:247], v[196:199]
  s_add_u32 s24, s24, 32768
  v_cvt_pk_bf16_f32 v43, v146, v147
  v_mfma_f32_16x16x32_bf16 v[212:215], v[92:95], v[244:247], v[212:215]
  s_and_b32 s24, s24, 0x1ffff
  buffer_load_dwordx4 v2, s[44:47], s26 offen offset:1024 sc1 lds
  v_cvt_pk_bf16_f32 v48, v160, v161
  v_cvt_pk_bf16_f32 v49, v162, v163
  v_mfma_f32_16x16x32_bf16 v[104:107], v[64:67], v[248:251], v[104:107]
  v_cvt_pk_bf16_f32 v50, v176, v177
  v_cvt_pk_bf16_f32 v51, v178, v179
  v_mfma_f32_16x16x32_bf16 v[120:123], v[68:71], v[248:251], v[120:123]
  buffer_load_dwordx4 v2, s[44:47], s26 offen offset:2048 sc1 lds
  v_cvt_pk_bf16_f32 v56, v192, v193
  v_mfma_f32_16x16x32_bf16 v[136:139], v[72:75], v[248:251], v[136:139]
  v_cvt_pk_bf16_f32 v57, v194, v195
  v_cvt_pk_bf16_f32 v58, v208, v209
  v_mfma_f32_16x16x32_bf16 v[152:155], v[76:79], v[248:251], v[152:155]
  buffer_load_dwordx4 v2, s[44:47], s26 offen offset:3072 sc1 lds
  v_cvt_pk_bf16_f32 v59, v210, v211
  v_mfma_f32_16x16x32_bf16 v[168:171], v[80:83], v[248:251], v[168:171]
  s_add_u32 s26, s26, 16384
  v_cvt_pk_bf16_f32 v36, v100, v101
  v_cvt_pk_bf16_f32 v37, v102, v103
  v_mfma_f32_16x16x32_bf16 v[184:187], v[84:87], v[248:251], v[184:187]
  v_cvt_pk_bf16_f32 v38, v116, v117
  v_mfma_f32_16x16x32_bf16 v[200:203], v[88:91], v[248:251], v[200:203]
  s_mov_b32 m0, s24
  v_cvt_pk_bf16_f32 v39, v118, v119
  v_cvt_pk_bf16_f32 v44, v132, v133
  v_mfma_f32_16x16x32_bf16 v[216:219], v[92:95], v[248:251], v[216:219]
  buffer_load_dwordx4 v2, s[44:47], s26 offen offset:0 sc1 lds
  v_cvt_pk_bf16_f32 v45, v134, v135
  v_mfma_f32_16x16x32_bf16 v[108:111], v[64:67], v[252:255], v[108:111]
  s_add_u32 s24, s24, 32768
  v_cvt_pk_bf16_f32 v46, v148, v149
  v_cvt_pk_bf16_f32 v47, v150, v151
  v_mfma_f32_16x16x32_bf16 v[124:127], v[68:71], v[252:255], v[124:127]
  s_and_b32 s24, s24, 0x1ffff
  buffer_load_dwordx4 v2, s[44:47], s26 offen offset:1024 sc1 lds
  v_cvt_pk_bf16_f32 v52, v164, v165
  v_mfma_f32_16x16x32_bf16 v[140:143], v[72:75], v[252:255], v[140:143]
  v_cvt_pk_bf16_f32 v53, v166, v167
  v_cvt_pk_bf16_f32 v54, v180, v181
  v_mfma_f32_16x16x32_bf16 v[156:159], v[76:79], v[252:255], v[156:159]
  buffer_load_dwordx4 v2, s[44:47], s26 offen offset:2048 sc1 lds
  v_cvt_pk_bf16_f32 v55, v182, v183
  v_mfma_f32_16x16x32_bf16 v[172:175], v[80:83], v[252:255], v[172:175]
  v_cvt_pk_bf16_f32 v60, v196, v197
  v_cvt_pk_bf16_f32 v61, v198, v199
  v_mfma_f32_16x16x32_bf16 v[188:191], v[84:87], v[252:255], v[188:191]
  buffer_load_dwordx4 v2, s[44:47], s26 offen offset:3072 sc1 lds
  v_cvt_pk_bf16_f32 v62, v212, v213
  v_mfma_f32_16x16x32_bf16 v[204:207], v[88:91], v[252:255], v[204:207]
  s_add_u32 s26, s26, 16384
  v_cvt_pk_bf16_f32 v63, v214, v215
  v_mfma_f32_16x16x32_bf16 v[220:223], v[92:95], v[252:255], v[220:223]
  s_mov_b32 m0, s25
  s_nop 0
  v_mfma_f32_32x32x16_bf16 a[0:15], v[228:231], v[228:231], 0
  buffer_load_dwordx4 v2, s[48:51], s27 offen offset:0 sc1 lds
  v_cvt_pk_bf16_f32 v64, v104, v105
  v_cvt_pk_bf16_f32 v65, v106, v107
  v_cvt_pk_bf16_f32 v66, v120, v121
  v_cvt_pk_bf16_f32 v67, v122, v123
  v_mfma_f32_32x32x16_bf16 a[16:31], v[228:231], v[228:231], 0
  buffer_load_dwordx4 v2, s[48:51], s27 offen offset:1024 sc1 lds
  v_cvt_pk_bf16_f32 v72, v136, v137
  v_cvt_pk_bf16_f32 v73, v138, v139
  v_cvt_pk_bf16_f32 v74, v152, v153
  v_cvt_pk_bf16_f32 v75, v154, v155
  v_mfma_f32_32x32x16_bf16 a[32:47], v[228:231], v[228:231], 0
  buffer_load_dwordx4 v2, s[48:51], s27 offen offset:2048 sc1 lds
  v_cvt_pk_bf16_f32 v80, v168, v169
  v_cvt_pk_bf16_f32 v81, v170, v171
  v_cvt_pk_bf16_f32 v82, v184, v185
  v_cvt_pk_bf16_f32 v83, v186, v187
  v_mfma_f32_32x32x16_bf16 a[48:63], v[228:231], v[228:231], 0
  buffer_load_dwordx4 v2, s[48:51], s27 offen offset:3072 sc1 lds
  v_cvt_pk_bf16_f32 v88, v200, v201
  v_cvt_pk_bf16_f32 v89, v202, v203
  v_cvt_pk_bf16_f32 v90, v216, v217
  v_cvt_pk_bf16_f32 v91, v218, v219
  s_add_u32 s27, s27, 16384
  s_add_u32 s25, s25, 32768
  s_and_b32 s25, s25, 0x1ffff
  s_mov_b32 m0, s25
  s_nop 0
  v_mfma_f32_32x32x16_bf16 a[64:79], v[228:231], v[228:231], 0
  buffer_load_dwordx4 v2, s[48:51], s27 offen offset:0 sc1 lds
  v_cvt_pk_bf16_f32 v68, v108, v109
  v_cvt_pk_bf16_f32 v69, v110, v111
  v_cvt_pk_bf16_f32 v70, v124, v125
  v_cvt_pk_bf16_f32 v71, v126, v127
  v_mfma_f32_32x32x16_bf16 a[80:95], v[228:231], v[228:231], 0
  buffer_load_dwordx4 v2, s[48:51], s27 offen offset:1024 sc1 lds
  v_cvt_pk_bf16_f32 v76, v140, v141
  v_cvt_pk_bf16_f32 v77, v142, v143
  v_cvt_pk_bf16_f32 v78, v156, v157
  v_cvt_pk_bf16_f32 v79, v158, v159
  v_mfma_f32_32x32x16_bf16 a[96:111], v[228:231], v[228:231], 0
  buffer_load_dwordx4 v2, s[48:51], s27 offen offset:2048 sc1 lds
  v_cvt_pk_bf16_f32 v84, v172, v173
  v_cvt_pk_bf16_f32 v85, v174, v175
  v_cvt_pk_bf16_f32 v86, v188, v189
  v_cvt_pk_bf16_f32 v87, v190, v191
  v_mfma_f32_32x32x16_bf16 a[112:127], v[228:231], v[228:231], 0
  buffer_load_dwordx4 v2, s[48:51], s27 offen offset:3072 sc1 lds
  v_cvt_pk_bf16_f32 v92, v204, v205
  v_cvt_pk_bf16_f32 v93, v206, v207
  v_cvt_pk_bf16_f32 v94, v220, v221
  v_cvt_pk_bf16_f32 v95, v222, v223
  s_add_u32 s27, s27, 16384
  s_add_u32 s25, s25, 32768
  s_and_b32 s25, s25, 0x1ffff
  s_waitcnt vmcnt(12)
  s_barrier
  ds_read_b128 a[128:131], v9 offset:0
  ds_read_b128 a[132:135], v9 offset:1024
  ds_read_b128 a[136:139], v9 offset:2048
  ds_read_b128 a[140:143], v9 offset:3072
  ds_read_b128 a[144:147], v9 offset:4096
  ds_read_b128 a[148:151], v9 offset:5120
  ds_read_b128 a[152:155], v9 offset:6144
  ds_read_b128 a[156:159], v9 offset:7168
  buffer_store_dword v4, off, s[40:43], s65 offset:32 sc1
  v_add_u32 v13, 32, v8
  v_mov_b32 v14, 0
  s_cmp_eq_u32 s2, 255
  s_cbranch_scc1 fa_top8
fa_notop:
  s_waitcnt lgkmcnt(4)
  v_mfma_f32_16x16x32_bf16 v[96:99], a[128:131], v[32:35], 0
  v_mfma_f32_16x16x32_bf16 v[104:107], a[128:131], v[36:39], 0
  v_mfma_f32_16x16x32_bf16 v[128:131], a[128:131], v[64:67], 0
  v_mfma_f32_16x16x32_bf16 v[136:139], a[128:131], v[68:71], 0
  s_mov_b32 m0, s24
  ds_read_b128 a[128:131], v3 offset:0
  v_mfma_f32_16x16x32_bf16 v[100:103], a[132:135], v[32:35], 0
  buffer_load_dwordx4 v2, s[44:47], s26 offen offset:0 sc1 lds
  v_mfma_f32_16x16x32_bf16 v[108:111], a[132:135], v[36:39], 0
  v_mfma_f32_16x16x32_bf16 v[132:135], a[132:135], v[64:67], 0
  v_mfma_f32_16x16x32_bf16 v[140:143], a[132:135], v[68:71], 0
  ds_read_b128 a[132:135], v3 offset:1024
  v_mfma_f32_16x16x32_bf16 v[96:99], a[136:139], v[40:43], v[96:99]
  v_mfma_f32_16x16x32_bf16 v[104:107], a[136:139], v[44:47], v[104:107]
  v_mfma_f32_16x16x32_bf16 v[128:131], a[136:139], v[72:75], v[128:131]
  buffer_load_dwordx4 v2, s[44:47], s26 offen offset:1024 sc1 lds
  v_mfma_f32_16x16x32_bf16 v[136:139], a[136:139], v[76:79], v[136:139]
  ds_read_b128 a[136:139], v3 offset:2048
  v_mfma_f32_16x16x32_bf16 v[100:103], a[140:143], v[40:43], v[100:103]
  v_mfma_f32_16x16x32_bf16 v[108:111], a[140:143], v[44:47], v[108:111]
  v_mfma_f32_16x16x32_bf16 v[132:135], a[140:143], v[72:75], v[132:135]
  v_mfma_f32_16x16x32_bf16 v[140:143], a[140:143], v[76:79], v[140:143]
  s_waitcnt lgkmcnt(3)
  ds_read_b128 a[140:143], v3 offset:3072
  v_mfma_f32_16x16x32_bf16 v[96:99], a[144:147], v[48:51], v[96:99]
  v_mfma_f32_16x16x32_bf16 v[104:107], a[144:147], v[52:55], v[104:107]
  v_mfma_f32_16x16x32_bf16 v[128:131], a[144:147], v[80:83], v[128:131]
  buffer_load_dwordx4 v2, s[44:47], s26 offen offset:2048 sc1 lds
  v_mfma_f32_16x16x32_bf16 v[136:139], a[144:147], v[84:87], v[136:139]
  ds_read_b128 a[144:147], v3 offset:4096
  v_mfma_f32_16x16x32_bf16 v[100:103], a[148:151], v[48:51], v[100:103]
  v_mfma_f32_16x16x32_bf16 v[108:111], a[148:151], v[52:55], v[108:111]
  v_mfma_f32_16x16x32_bf16 v[132:135], a[148:151], v[80:83], v[132:135]
  v_mfma_f32_16x16x32_bf16 v[140:143], a[148:151], v[84:87], v[140:143]
  ds_read_b128 a[148:151], v3 offset:5120
  v_mfma_f32_16x16x32_bf16 v[96:99], a[152:155], v[56:59], v[96:99]
  buffer_load_dwordx4 v2, s[44:47], s26 offen offset:3072 sc1 lds
  v_mfma_f32_16x16x32_bf16 v[104:107], a[152:155], v[60:63], v[104:107]
  s_add_u32 s26, s26, 16384
  v_mfma_f32_16x16x32_bf16 v[128:131], a[152:155], v[88:91], v[128:131]
  s_add_u32 s24, s24, 32768
  v_mfma_f32_16x16x32_bf16 v[136:139], a[152:155], v[92:95], v[136:139]
  s_and_b32 s24, s24, 0x1ffff
  ds_read_b128 a[152:155], v3 offset:6144
  v_mfma_f32_16x16x32_bf16 v[100:103], a[156:159], v[56:59], v[100:103]
  v_mfma_f32_16x16x32_bf16 v[108:111], a[156:159], v[60:63], v[108:111]
  v_mfma_f32_16x16x32_bf16 v[132:135], a[156:159], v[88:91], v[132:135]
  v_mfma_f32_16x16x32_bf16 v[140:143], a[156:159], v[92:95], v[140:143]
  s_waitcnt lgkmcnt(3)
  ds_read_b128 a[156:159], v3 offset:7168
  s_nop 7
  s_cmp_lg_u32 s28, 0
  s_cbranch_scc1 fa_nomask0
  v_cndmask_b32 v96, v4, v96, s[68:69]
  v_cndmask_b32 v97, v4, v97, s[70:71]
  v_cndmask_b32 v98, v4, v98, s[72:73]
  v_cndmask_b32 v99, v4, v99, s[74:75]
  v_mov_b32 v100, v4
  v_mov_b32 v101, v4
  v_mov_b32 v102, v4
  v_mov_b32 v103, v4
  v_cndmask_b32 v108, v4, v108, s[68:69]
  v_cndmask_b32 v109, v4, v109, s[70:71]
  v_cndmask_b32 v110, v4, v110, s[72:73]
  v_cndmask_b32 v111, v4, v111, s[74:75]
fa_nomask0:
  v_max3_f32 v16, v96, v97, v98
  v_max3_f32 v16, v16, v99, v100
  v_max3_f32 v16, v16, v101, v102
  v_max_f32 v16, v16, v103
  v_max3_f32 v17, v104, v105, v106
  v_max3_f32 v17, v17, v107, v108
  v_max3_f32 v17, v17, v109, v110
  v_max_f32 v17, v17, v111
  v_max3_f32 v18, v128, v129, v130
  v_max3_f32 v18, v18, v131, v132
  v_max3_f32 v18, v18, v133, v134
  v_max_f32 v18, v18, v135
  v_max3_f32 v19, v136, v137, v138
  v_max3_f32 v19, v19, v139, v140
  v_max3_f32 v19, v19, v141, v142
  v_max_f32 v19, v19, v143
  v_mov_b32 v20, v16
  v_mov_b32 v21, v17
  v_mov_b32 v22, v18
  v_mov_b32 v23, v19
  s_nop 0
  v_permlane16_swap_b32 v16, v20
  v_permlane16_swap_b32 v17, v21
  v_permlane16_swap_b32 v18, v22
  v_permlane16_swap_b32 v19, v23
  v_max_f32 v16, v16, v20
  v_max_f32 v17, v17, v21
  v_max_f32 v18, v18, v22
  v_max_f32 v19, v19, v23
  v_mov_b32 v20, v16
  v_mov_b32 v21, v17
  v_mov_b32 v22, v18
  v_mov_b32 v23, v19
  s_nop 0
  v_permlane32_swap_b32 v16, v20
  v_permlane32_swap_b32 v17, v21
  v_permlane32_swap_b32 v18, v22
  v_permlane32_swap_b32 v19, v23
  v_max_f32 v16, v16, v20
  v_max_f32 v17, v17, v21
  v_max_f32 v18, v18, v22
  v_max_f32 v19, v19, v23
  v_sub_f32 v192, 0, v16
  v_sub_f32 v193, 0, v16
  v_sub_f32 v194, 0, v16
  v_sub_f32 v195, 0, v16
  v_sub_f32 v196, 0, v17
  v_sub_f32 v197, 0, v17
  v_sub_f32 v198, 0, v17
  v_sub_f32 v199, 0, v17
  v_sub_f32 v200, 0, v18
  v_sub_f32 v201, 0, v18
  v_sub_f32 v202, 0, v18
  v_sub_f32 v203, 0, v18
  v_sub_f32 v204, 0, v19
  v_sub_f32 v205, 0, v19
  v_sub_f32 v206, 0, v19
  v_sub_f32 v207, 0, v19
  v_sub_f32 v96, v96, v16
  v_sub_f32 v97, v97, v16
  v_sub_f32 v98, v98, v16
  v_sub_f32 v99, v99, v16
  v_sub_f32 v100, v100, v16
  v_sub_f32 v101, v101, v16
  v_sub_f32 v102, v102, v16
  v_sub_f32 v103, v103, v16
  v_sub_f32 v104, v104, v17
  v_sub_f32 v105, v105, v17
  v_sub_f32 v106, v106, v17
  v_sub_f32 v107, v107, v17
  v_sub_f32 v108, v108, v17
  v_sub_f32 v109, v109, v17
  v_sub_f32 v110, v110, v17
  v_sub_f32 v111, v111, v17
  v_sub_f32 v128, v128, v18
  v_sub_f32 v129, v129, v18
  v_sub_f32 v130, v130, v18
  v_sub_f32 v131, v131, v18
  v_sub_f32 v132, v132, v18
  v_sub_f32 v133, v133, v18
  v_sub_f32 v134, v134, v18
  v_sub_f32 v135, v135, v18
  v_sub_f32 v136, v136, v19
  v_sub_f32 v137, v137, v19
  v_sub_f32 v138, v138, v19
  v_sub_f32 v139, v139, v19
  v_sub_f32 v140, v140, v19
  v_sub_f32 v141, v141, v19
  v_sub_f32 v142, v142, v19
  v_sub_f32 v143, v143, v19
  v_mfma_f32_16x16x32_bf16 v[112:115], a[128:131], v[32:35], v[192:195]
  v_exp_f32 v216, v128
  v_exp_f32 v217, v129
  v_mfma_f32_16x16x32_bf16 v[120:123], a[128:131], v[36:39], v[196:199]
  v_exp_f32 v218, v130
  v_add_f32 v226, v216, v217
  v_cvt_pk_bf16_f32 v176, v216, v217
  v_mfma_f32_16x16x32_bf16 v[144:147], a[128:131], v[64:67], v[200:203]
  s_add_u32 s66, s66, 32768
  v_exp_f32 v219, v131
  v_add_f32 v226, v226, v218
  v_add_f32 v226, v226, v219
  v_mfma_f32_16x16x32_bf16 v[152:155], a[128:131], v[68:71], v[204:207]
  s_mov_b32 m0, s25
  ds_read_b128 a[128:131], v3 offset:8192
  v_exp_f32 v220, v132
  v_cvt_pk_bf16_f32 v177, v218, v219
  v_mfma_f32_16x16x32_bf16 v[116:119], a[132:135], v[32:35], v[192:195]
  s_and_b32 s66, s66, 0x1ffff
  buffer_load_dwordx4 v2, s[48:51], s27 offen offset:0 sc1 lds
  v_exp_f32 v221, v133
  v_add_f32 v226, v226, v220
  v_add_f32 v226, v226, v221
  v_mfma_f32_16x16x32_bf16 v[124:127], a[132:135], v[36:39], v[196:199]
  v_exp_f32 v222, v134
  v_cvt_pk_bf16_f32 v178, v220, v221
  v_exp_f32 v223, v135
  v_mfma_f32_16x16x32_bf16 v[148:151], a[132:135], v[64:67], v[200:203]
  v_exp_f32 v216, v136
  v_add_f32 v226, v226, v222
  v_mfma_f32_16x16x32_bf16 v[156:159], a[132:135], v[68:71], v[204:207]
  ds_read_b128 a[132:135], v3 offset:9216
  v_exp_f32 v217, v137
  v_add_f32 v226, v226, v223
  v_mfma_f32_16x16x32_bf16 v[112:115], a[136:139], v[40:43], v[112:115]
  v_exp_f32 v218, v138
  v_cvt_pk_bf16_f32 v179, v222, v223
  v_add_f32 v227, v216, v217
  v_mfma_f32_16x16x32_bf16 v[120:123], a[136:139], v[44:47], v[120:123]
  v_exp_f32 v219, v139
  v_cvt_pk_bf16_f32 v180, v216, v217
  v_add_f32 v227, v227, v218
  v_add_f32 v227, v227, v219
  v_mfma_f32_16x16x32_bf16 v[144:147], a[136:139], v[72:75], v[144:147]
  buffer_load_dwordx4 v2, s[48:51], s27 offen offset:1024 sc1 lds
  v_exp_f32 v220, v140
  v_cvt_pk_bf16_f32 v181, v218, v219
  v_mfma_f32_16x16x32_bf16 v[152:155], a[136:139], v[76:79], v[152:155]
  ds_read_b128 a[136:139], v3 offset:10240
  v_exp_f32 v221, v141
  v_add_f32 v227, v227, v220
  v_mfma_f32_16x16x32_bf16 v[116:119], a[140:143], v[40:43], v[116:119]
  v_exp_f32 v222, v142
  v_add_f32 v227, v227, v221
  v_cvt_pk_bf16_f32 v182, v220, v221
  v_mfma_f32_16x16x32_bf16 v[124:127], a[140:143], v[44:47], v[124:127]
  v_exp_f32 v223, v143
  v_add_f32 v227, v227, v222
  v_add_f32 v227, v227, v223
  v_exp_f32 v208, v96
  v_mfma_f32_16x16x32_bf16 v[148:151], a[140:143], v[72:75], v[148:151]
  v_exp_f32 v209, v97
  v_cvt_pk_bf16_f32 v183, v222, v223
  v_mfma_f32_16x16x32_bf16 v[156:159], a[140:143], v[76:79], v[156:159]
  s_waitcnt lgkmcnt(3)
  ds_read_b128 a[140:143], v3 offset:11264
  v_exp_f32 v210, v98
  v_add_f32 v224, v208, v209
  v_mfma_f32_16x16x32_bf16 v[112:115], a[144:147], v[48:51], v[112:115]
  v_exp_f32 v211, v99
  v_cvt_pk_bf16_f32 v160, v208, v209
  v_add_f32 v224, v224, v210
  v_mfma_f32_16x16x32_bf16 v[120:123], a[144:147], v[52:55], v[120:123]
  v_exp_f32 v212, v100
  v_add_f32 v224, v224, v211
  v_cvt_pk_bf16_f32 v161, v210, v211
  v_mfma_f32_16x16x32_bf16 v[144:147], a[144:147], v[80:83], v[144:147]
  buffer_load_dwordx4 v2, s[48:51], s27 offen offset:2048 sc1 lds
  v_exp_f32 v213, v101
  v_add_f32 v224, v224, v212
  v_add_f32 v224, v224, v213
  v_mfma_f32_16x16x32_bf16 v[152:155], a[144:147], v[84:87], v[152:155]
  ds_read_b128 a[144:147], v3 offset:12288
  v_exp_f32 v214, v102
  v_cvt_pk_bf16_f32 v162, v212, v213
  v_mfma_f32_16x16x32_bf16 v[116:119], a[148:151], v[48:51], v[116:119]
  v_exp_f32 v215, v103
  v_add_f32 v224, v224, v214
  v_add_f32 v224, v224, v215
  v_mfma_f32_16x16x32_bf16 v[124:127], a[148:151], v[52:55], v[124:127]
  v_exp_f32 v208, v104
  v_exp_f32 v209, v105
  v_mfma_f32_16x16x32_bf16 v[148:151], a[148:151], v[80:83], v[148:151]
  v_exp_f32 v210, v106
  v_cvt_pk_bf16_f32 v163, v214, v215
  v_add_f32 v225, v208, v209
  v_mfma_f32_16x16x32_bf16 v[156:159], a[148:151], v[84:87], v[156:159]
  ds_read_b128 a[148:151], v3 offset:13312
  v_exp_f32 v211, v107
  v_cvt_pk_bf16_f32 v164, v208, v209
  v_add_f32 v225, v225, v210
  v_mfma_f32_16x16x32_bf16 v[112:115], a[152:155], v[56:59], v[112:115]
  buffer_load_dwordx4 v2, s[48:51], s27 offen offset:3072 sc1 lds
  v_exp_f32 v212, v108
  v_add_f32 v225, v225, v211
  v_mfma_f32_16x16x32_bf16 v[120:123], a[152:155], v[60:63], v[120:123]
  s_add_u32 s27, s27, 16384
  v_exp_f32 v213, v109
  v_mfma_f32_16x16x32_bf16 v[144:147], a[152:155], v[88:91], v[144:147]
  s_add_u32 s25, s25, 32768
  v_exp_f32 v214, v110
  v_mfma_f32_16x16x32_bf16 v[152:155], a[152:155], v[92:95], v[152:155]
  s_and_b32 s25, s25, 0x1ffff
  ds_read_b128 a[152:155], v3 offset:14336
  v_cvt_pk_bf16_f32 v165, v210, v211
  v_max3_f32 v5, v226, v227, v224
  v_add_f32 v225, v225, v212
  v_add_f32 v225, v225, v213
  v_cvt_pk_bf16_f32 v166, v212, v213
  v_exp_f32 v215, v111
  v_mfma_f32_16x16x32_bf16 v[116:119], a[156:159], v[56:59], v[116:119]
  v_add_f32 v225, v225, v214
  v_add_f32 v225, v225, v215
  v_max_f32 v5, v5, v225
  v_cmp_lt_f32 vcc, s81, v5
  v_mfma_f32_16x16x32_bf16 v[124:127], a[156:159], v[60:63], v[124:127]
  v_mfma_f32_16x16x32_bf16 v[148:151], a[156:159], v[88:91], v[148:151]
  v_cvt_pk_bf16_f32 v167, v214, v215
  v_mfma_f32_16x16x32_bf16 v[156:159], a[156:159], v[92:95], v[156:159]
  s_waitcnt lgkmcnt(3)
  s_cbranch_vccnz fa_stub0
fa_back0:
  ds_read_b128 a[156:159], v3 offset:15360
  v_add_f32 v228, v228, v224
  v_add_f32 v229, v229, v225
  v_add_f32 v230, v230, v226
  v_add_f32 v231, v231, v227
  s_nop 3
  v_exp_f32 v216, v144
  v_exp_f32 v217, v145
  v_add_u32 v3, s66, v2
  buffer_load_dword v14, v13, s[40:43], 0 offen sc1
  s_cmp_eq_u32 s28, 0
  s_cbranch_scc1 fa_AV
  s_sub_u32 s28, s28, 1
  s_cmp_eq_u32 s28, 0
  s_cbranch_scc1 fa_Aexit
.p2align 6
fa_DD:
  v_mfma_f32_16x16x32_bf16 v[96:99], a[128:131], v[32:35], v[192:195]
  s_waitcnt vmcnt(12)
  v_exp_f32 v218, v146
  v_mfma_f32_16x16x32_bf16 v[104:107], a[128:131], v[36:39], v[196:199]
  s_barrier
  v_exp_f32 v219, v147
  v_mfma_f32_16x16x32_bf16 v[128:131], a[128:131], v[64:67], v[200:203]
  s_cmp_ge_u32 s26, s32
  ds_read_b128 a[160:163], v3 offset:16384
  v_add_f32 v226, v216, v217
  v_mfma_f32_16x16x32_bf16 v[136:139], a[128:131], v[68:71], v[204:207]
  s_cbranch_scc1 fa_hk4
fa_hb4:
  v_exp_f32 v220, v148
  v_mfma_f32_16x16x32_bf16 v[100:103], a[132:135], v[32:35], v[192:195]
  ds_read_b128 a[164:167], v3 offset:17408
  v_cvt_pk_bf16_f32 v184, v216, v217
  v_mfma_f32_16x16x32_bf16 v[108:111], a[132:135], v[36:39], v[196:199]
  s_mov_b32 m0, s24
  v_exp_f32 v221, v149
  v_mfma_f32_16x16x32_bf16 v[132:135], a[132:135], v[64:67], v[200:203]
  buffer_load_dwordx4 v2, s[44:47], s26 offen offset:0 sc1 lds
  v_add_f32 v226, v226, v218
  v_mfma_f32_16x16x32_bf16 v[140:143], a[132:135], v[68:71], v[204:207]
  v_exp_f32 v222, v150
  v_mfma_f32_16x16x32_bf16 v[96:99], a[136:139], v[40:43], v[96:99]
  ds_read_b128 a[168:171], v3 offset:18432
  v_add_f32 v226, v226, v219
  v_mfma_f32_16x16x32_bf16 v[104:107], a[136:139], v[44:47], v[104:107]
  v_exp_f32 v223, v151
  v_mfma_f32_16x16x32_bf16 v[128:131], a[136:139], v[72:75], v[128:131]
  v_cvt_pk_bf16_f32 v185, v218, v219
  v_add_f32 v226, v226, v220
  v_mfma_f32_16x16x32_bf16 v[136:139], a[136:139], v[76:79], v[136:139]
  v_exp_f32 v216, v152
  v_mfma_f32_16x16x32_bf16 v[100:103], a[140:143], v[40:43], v[100:103]
  ds_read_b128 a[172:175], v3 offset:19456
  v_add_f32 v226, v226, v221
  v_mfma_f32_16x16x32_bf16 v[108:111], a[140:143], v[44:47], v[108:111]
  v_exp_f32 v217, v153
  v_mfma_f32_16x16x32_bf16 v[132:135], a[140:143], v[72:75], v[132:135]
  v_cvt_pk_bf16_f32 v186, v220, v221
  v_add_f32 v226, v226, v222
  v_mfma_f32_16x16x32_bf16 v[140:143], a[140:143], v[76:79], v[140:143]
  s_waitcnt lgkmcnt(4)
  v_exp_f32 v218, v154
  v_mfma_f32_16x16x32_bf16 v[96:99], a[144:147], v[48:51], v[96:99]
  ds_read_b128 a[176:179], v3 offset:20480
  v_add_f32 v226, v226, v223
  v_mfma_f32_16x16x32_bf16 v[104:107], a[144:147], v[52:55], v[104:107]
  v_exp_f32 v219, v155
  v_mfma_f32_16x16x32_bf16 v[128:131], a[144:147], v[80:83], v[128:131]
  v_cvt_pk_bf16_f32 v187, v222, v223
  v_add_f32 v227, v216, v217
  v_mfma_f32_16x16x32_bf16 v[136:139], a[144:147], v[84:87], v[136:139]
  v_exp_f32 v220, v156
  v_mfma_f32_16x16x32_bf16 v[100:103], a[148:151], v[48:51], v[100:103]
  ds_read_b128 a[180:183], v3 offset:21504
  v_cvt_pk_bf16_f32 v188, v216, v217
  v_mfma_f32_16x16x32_bf16 v[108:111], a[148:151], v[52:55], v[108:111]
  v_exp_f32 v221, v157
  v_mfma_f32_16x16x32_bf16 v[132:135], a[148:151], v[80:83], v[132:135]
  buffer_load_dwordx4 v2, s[44:47], s26 offen offset:1024 sc1 lds
  v_add_f32 v227, v227, v218
  v_mfma_f32_16x16x32_bf16 v[140:143], a[148:151], v[84:87], v[140:143]
  v_exp_f32 v222, v158
  v_mfma_f32_16x16x32_bf16 v[96:99], a[152:155], v[56:59], v[96:99]
  ds_read_b128 a[184:187], v3 offset:22528
  v_add_f32 v227, v227, v219
  v_mfma_f32_16x16x32_bf16 v[104:107], a[152:155], v[60:63], v[104:107]
  v_exp_f32 v223, v159
  v_mfma_f32_16x16x32_bf16 v[128:131], a[152:155], v[88:91], v[128:131]
  v_cvt_pk_bf16_f32 v189, v218, v219
  v_add_f32 v227, v227, v220
  v_mfma_f32_16x16x32_bf16 v[136:139], a[152:155], v[92:95], v[136:139]
  v_exp_f32 v208, v112
  v_mfma_f32_16x16x32_bf16 v[100:103], a[156:159], v[56:59], v[100:103]
  ds_read_b128 a[188:191], v3 offset:23552
  v_add_f32 v227, v227, v221
  v_mfma_f32_16x16x32_bf16 v[108:111], a[156:159], v[60:63], v[108:111]
  v_exp_f32 v209, v113
  v_mfma_f32_16x16x32_bf16 v[132:135], a[156:159], v[88:91], v[132:135]
  v_cvt_pk_bf16_f32 v190, v220, v221
  v_add_f32 v227, v227, v222
  v_add_f32 v227, v227, v223
  v_mfma_f32_16x16x32_bf16 v[140:143], a[156:159], v[92:95], v[140:143]
  s_waitcnt lgkmcnt(4)
  v_exp_f32 v210, v114
  v_mfma_f32_16x16x32_bf16 a[0:3], a[160:163], v[160:163], a[0:3]
  ds_read_b128 a[128:131], v3 offset:0
  v_cvt_pk_bf16_f32 v191, v222, v223
  v_mfma_f32_16x16x32_bf16 a[4:7], a[160:163], v[164:167], a[4:7]
  v_exp_f32 v211, v115
  v_mfma_f32_16x16x32_bf16 a[64:67], a[160:163], v[176:179], a[64:67]
  v_exp_f32 v212, v116
  v_mfma_f32_16x16x32_bf16 a[68:71], a[160:163], v[180:183], a[68:71]
  v_add_f32 v224, v208, v209
  v_cvt_pk_bf16_f32 v168, v208, v209
  v_mfma_f32_16x16x32_bf16 a[8:11], a[164:167], v[160:163], a[8:11]
  ds_read_b128 a[132:135], v3 offset:1024
  v_add_f32 v224, v224, v210
  v_mfma_f32_16x16x32_bf16 a[12:15], a[164:167], v[164:167], a[12:15]
  v_exp_f32 v213, v117
  v_mfma_f32_16x16x32_bf16 a[72:75], a[164:167], v[176:179], a[72:75]
  buffer_load_dwordx4 v2, s[44:47], s26 offen offset:2048 sc1 lds
  v_add_f32 v224, v224, v211
  v_mfma_f32_16x16x32_bf16 a[76:79], a[164:167], v[180:183], a[76:79]
  v_exp_f32 v214, v118
  v_mfma_f32_16x16x32_bf16 a[16:19], a[168:171], v[160:163], a[16:19]
  ds_read_b128 a[136:139], v3 offset:2048
  v_cvt_pk_bf16_f32 v169, v210, v211
  v_mfma_f32_16x16x32_bf16 a[20:23], a[168:171], v[164:167], a[20:23]
  v_exp_f32 v215, v119
  v_mfma_f32_16x16x32_bf16 a[80:83], a[168:171], v[176:179], a[80:83]
  v_add_f32 v224, v224, v212
  v_add_f32 v224, v224, v213
  v_mfma_f32_16x16x32_bf16 a[84:87], a[168:171], v[180:183], a[84:87]
  v_exp_f32 v208, v120
  v_mfma_f32_16x16x32_bf16 a[24:27], a[172:175], v[160:163], a[24:27]
  ds_read_b128 a[140:143], v3 offset:3072
  v_cvt_pk_bf16_f32 v170, v212, v213
  v_mfma_f32_16x16x32_bf16 a[28:31], a[172:175], v[164:167], a[28:31]
  v_exp_f32 v209, v121
  v_mfma_f32_16x16x32_bf16 a[88:91], a[172:175], v[176:179], a[88:91]
  v_exp_f32 v210, v122
  v_mfma_f32_16x16x32_bf16 a[92:95], a[172:175], v[180:183], a[92:95]
  s_waitcnt lgkmcnt(4)
  v_add_f32 v224, v224, v214
  v_add_f32 v224, v224, v215
  v_mfma_f32_16x16x32_bf16 a[32:35], a[176:179], v[160:163], a[32:35]
  ds_read_b128 a[144:147], v3 offset:4096
  v_cvt_pk_bf16_f32 v171, v214, v215
  v_mfma_f32_16x16x32_bf16 a[36:39], a[176:179], v[164:167], a[36:39]
  v_exp_f32 v211, v123
  v_mfma_f32_16x16x32_bf16 a[96:99], a[176:179], v[176:179], a[96:99]
  v_add_f32 v225, v208, v209
  v_cvt_pk_bf16_f32 v172, v208, v209
  v_mfma_f32_16x16x32_bf16 a[100:103], a[176:179], v[180:183], a[100:103]
  v_exp_f32 v212, v124
  v_mfma_f32_16x16x32_bf16 a[40:43], a[180:183], v[160:163], a[40:43]
  ds_read_b128 a[148:151], v3 offset:5120
  v_add_f32 v225, v225, v210
  v_mfma_f32_16x16x32_bf16 a[44:47], a[180:183], v[164:167], a[44:47]
  v_exp_f32 v213, v125
  v_mfma_f32_16x16x32_bf16 a[104:107], a[180:183], v[176:179], a[104:107]
  buffer_load_dwordx4 v2, s[44:47], s26 offen offset:3072 sc1 lds
  v_add_f32 v225, v225, v211
  v_mfma_f32_16x16x32_bf16 a[108:111], a[180:183], v[180:183], a[108:111]
  s_add_u32 s26, s26, 16384
  v_exp_f32 v214, v126
  v_mfma_f32_16x16x32_bf16 a[48:51], a[184:187], v[160:163], a[48:51]
  s_add_u32 s24, s24, 32768
  ds_read_b128 a[152:155], v3 offset:6144
  v_cvt_pk_bf16_f32 v173, v210, v211
  v_mfma_f32_16x16x32_bf16 a[52:55], a[184:187], v[164:167], a[52:55]
  s_and_b32 s24, s24, 0x1ffff
  v_exp_f32 v215, v127
  v_mfma_f32_16x16x32_bf16 a[112:115], a[184:187], v[176:179], a[112:115]
  v_max3_f32 v5, v226, v227, v224
  v_add_f32 v225, v225, v212
  v_mfma_f32_16x16x32_bf16 a[116:119], a[184:187], v[180:183], a[116:119]
  v_add_f32 v225, v225, v213
  v_cvt_pk_bf16_f32 v174, v212, v213
  v_add_f32 v225, v225, v214
  v_mfma_f32_16x16x32_bf16 a[56:59], a[188:191], v[160:163], a[56:59]
  ds_read_b128 a[156:159], v3 offset:7168
  v_add_f32 v225, v225, v215
  v_max_f32 v5, v5, v225
  v_cmp_lt_f32 vcc, s81, v5
  v_mfma_f32_16x16x32_bf16 a[60:63], a[188:191], v[164:167], a[60:63]
  v_exp_f32 v216, v128
  v_mfma_f32_16x16x32_bf16 a[120:123], a[188:191], v[176:179], a[120:123]
  s_waitcnt lgkmcnt(4)
  v_cvt_pk_bf16_f32 v175, v214, v215
  v_mfma_f32_16x16x32_bf16 a[124:127], a[188:191], v[180:183], a[124:127]
  s_cbranch_vccnz fa_stub1
fa_back1:
  v_exp_f32 v217, v129
  v_add_f32 v228, v228, v224
  v_add_f32 v229, v229, v225
  v_add_f32 v230, v230, v226
  v_add_f32 v231, v231, v227
fa_DDe:
  v_mfma_f32_16x16x32_bf16 v[112:115], a[128:131], v[32:35], v[192:195]
  ds_read_b128 a[160:163], v3 offset:24576
  v_add_f32 v226, v216, v217
  v_mfma_f32_16x16x32_bf16 v[120:123], a[128:131], v[36:39], v[196:199]
  v_exp_f32 v218, v130
  v_mfma_f32_16x16x32_bf16 v[144:147], a[128:131], v[64:67], v[200:203]
  s_cmp_ge_u32 s26, s9
  v_exp_f32 v219, v131
  v_mfma_f32_16x16x32_bf16 v[152:155], a[128:131], v[68:71], v[204:207]
  s_cbranch_scc1 fa_hk5
fa_hb5:
  v_exp_f32 v220, v132
  v_mfma_f32_16x16x32_bf16 v[116:119], a[132:135], v[32:35], v[192:195]
  s_add_u32 s66, s66, 32768
  ds_read_b128 a[164:167], v3 offset:25600
  v_cvt_pk_bf16_f32 v176, v216, v217
  v_mfma_f32_16x16x32_bf16 v[124:127], a[132:135], v[36:39], v[196:199]
  s_mov_b32 m0, s25
  v_exp_f32 v221, v133
  v_mfma_f32_16x16x32_bf16 v[148:151], a[132:135], v[64:67], v[200:203]
  s_and_b32 s66, s66, 0x1ffff
  buffer_load_dwordx4 v2, s[48:51], s27 offen offset:0 sc1 lds
  v_add_f32 v226, v226, v218
  v_mfma_f32_16x16x32_bf16 v[156:159], a[132:135], v[68:71], v[204:207]
  v_exp_f32 v222, v134
  v_mfma_f32_16x16x32_bf16 v[112:115], a[136:139], v[40:43], v[112:115]
  ds_read_b128 a[168:171], v3 offset:26624
  v_add_f32 v226, v226, v219
  v_mfma_f32_16x16x32_bf16 v[120:123], a[136:139], v[44:47], v[120:123]
  v_exp_f32 v223, v135
  v_mfma_f32_16x16x32_bf16 v[144:147], a[136:139], v[72:75], v[144:147]
  v_cvt_pk_bf16_f32 v177, v218, v219
  v_add_f32 v226, v226, v220
  v_mfma_f32_16x16x32_bf16 v[152:155], a[136:139], v[76:79], v[152:155]
  v_exp_f32 v216, v136
  v_mfma_f32_16x16x32_bf16 v[116:119], a[140:143], v[40:43], v[116:119]
  ds_read_b128 a[172:175], v3 offset:27648
  v_add_f32 v226, v226, v221
  v_mfma_f32_16x16x32_bf16 v[124:127], a[140:143], v[44:47], v[124:127]
  v_exp_f32 v217, v137
  v_mfma_f32_16x16x32_bf16 v[148:151], a[140:143], v[72:75], v[148:151]
  v_cvt_pk_bf16_f32 v178, v220, v221
  v_add_f32 v226, v226, v222
  v_mfma_f32_16x16x32_bf16 v[156:159], a[140:143], v[76:79], v[156:159]
  s_waitcnt lgkmcnt(4)
  v_exp_f32 v218, v138
  v_mfma_f32_16x16x32_bf16 v[112:115], a[144:147], v[48:51], v[112:115]
  ds_read_b128 a[176:179], v3 offset:28672
  v_add_f32 v226, v226, v223
  v_mfma_f32_16x16x32_bf16 v[120:123], a[144:147], v[52:55], v[120:123]
  v_exp_f32 v219, v139
  v_mfma_f32_16x16x32_bf16 v[144:147], a[144:147], v[80:83], v[144:147]
  v_cvt_pk_bf16_f32 v179, v222, v223
  v_add_f32 v227, v216, v217
  v_mfma_f32_16x16x32_bf16 v[152:155], a[144:147], v[84:87], v[152:155]
  v_exp_f32 v220, v140
  v_mfma_f32_16x16x32_bf16 v[116:119], a[148:151], v[48:51], v[116:119]
  ds_read_b128 a[180:183], v3 offset:29696
  v_cvt_pk_bf16_f32 v180, v216, v217
  v_mfma_f32_16x16x32_bf16 v[124:127], a[148:151], v[52:55], v[124:127]
  v_exp_f32 v221, v141
  v_mfma_f32_16x16x32_bf16 v[148:151], a[148:151], v[80:83], v[148:151]
  buffer_load_dwordx4 v2, s[48:51], s27 offen offset:1024 sc1 lds
  v_add_f32 v227, v227, v218
  v_mfma_f32_16x16x32_bf16 v[156:159], a[148:151], v[84:87], v[156:159]
  v_exp_f32 v222, v142
  v_mfma_f32_16x16x32_bf16 v[112:115], a[152:155], v[56:59], v[112:115]
  ds_read_b128 a[184:187], v3 offset:30720
  v_add_f32 v227, v227, v219
  v_mfma_f32_16x16x32_bf16 v[120:123], a[152:155], v[60:63], v[120:123]
  v_exp_f32 v223, v143
  v_mfma_f32_16x16x32_bf16 v[144:147], a[152:155], v[88:91], v[144:147]
  v_cvt_pk_bf16_f32 v181, v218, v219
  v_add_f32 v227, v227, v220
  v_mfma_f32_16x16x32_bf16 v[152:155], a[152:155], v[92:95], v[152:155]
  v_exp_f32 v208, v96
  v_mfma_f32_16x16x32_bf16 v[116:119], a[156:159], v[56:59], v[116:119]
  ds_read_b128 a[188:191], v3 offset:31744
  v_add_f32 v227, v227, v221
  v_mfma_f32_16x16x32_bf16 v[124:127], a[156:159], v[60:63], v[124:127]
  v_exp_f32 v209, v97
  v_mfma_f32_16x16x32_bf16 v[148:151], a[156:159], v[88:91], v[148:151]
  v_cvt_pk_bf16_f32 v182, v220, v221
  v_add_f32 v227, v227, v222
  v_add_f32 v227, v227, v223
  v_mfma_f32_16x16x32_bf16 v[156:159], a[156:159], v[92:95], v[156:159]
  s_waitcnt lgkmcnt(4)
  v_exp_f32 v210, v98
  v_mfma_f32_16x16x32_bf16 a[0:3], a[160:163], v[168:171], a[0:3]
  ds_read_b128 a[128:131], v3 offset:8192
  v_cvt_pk_bf16_f32 v183, v222, v223
  v_mfma_f32_16x16x32_bf16 a[4:7], a[160:163], v[172:175], a[4:7]
  v_exp_f32 v211, v99
  v_mfma_f32_16x16x32_bf16 a[64:67], a[160:163], v[184:187], a[64:67]
  v_exp_f32 v212, v100
  v_mfma_f32_16x16x32_bf16 a[68:71], a[160:163], v[188:191], a[68:71]
  v_add_f32 v224, v208, v209
  v_cvt_pk_bf16_f32 v160, v208, v209
  v_mfma_f32_16x16x32_bf16 a[8:11], a[164:167], v[168:171], a[8:11]
  ds_read_b128 a[132:135], v3 offset:9216
  v_add_f32 v224, v224, v210
  v_mfma_f32_16x16x32_bf16 a[12:15], a[164:167], v[172:175], a[12:15]
  v_exp_f32 v213, v101
  v_mfma_f32_16x16x32_bf16 a[72:75], a[164:167], v[184:187], a[72:75]
  buffer_load_dwordx4 v2, s[48:51], s27 offen offset:2048 sc1 lds
  v_add_f32 v224, v224, v211
  v_mfma_f32_16x16x32_bf16 a[76:79], a[164:167], v[188:191], a[76:79]
  v_exp_f32 v214, v102
  v_mfma_f32_16x16x32_bf16 a[16:19], a[168:171], v[168:171], a[16:19]
  ds_read_b128 a[136:139], v3 offset:10240
  v_cvt_pk_bf16_f32 v161, v210, v211
  v_mfma_f32_16x16x32_bf16 a[20:23], a[168:171], v[172:175], a[20:23]
  v_exp_f32 v215, v103
  v_mfma_f32_16x16x32_bf16 a[80:83], a[168:171], v[184:187], a[80:83]
  v_add_f32 v224, v224, v212
  v_add_f32 v224, v224, v213
  v_mfma_f32_16x16x32_bf16 a[84:87], a[168:171], v[188:191], a[84:87]
  v_exp_f32 v208, v104
  v_mfma_f32_16x16x32_bf16 a[24:27], a[172:175], v[168:171], a[24:27]
  ds_read_b128 a[140:143], v3 offset:11264
  v_cvt_pk_bf16_f32 v162, v212, v213
  v_mfma_f32_16x16x32_bf16 a[28:31], a[172:175], v[172:175], a[28:31]
  v_exp_f32 v209, v105
  v_mfma_f32_16x16x32_bf16 a[88:91], a[172:175], v[184:187], a[88:91]
  v_exp_f32 v210, v106
  v_mfma_f32_16x16x32_bf16 a[92:95], a[172:175], v[188:191], a[92:95]
  s_waitcnt lgkmcnt(4)
  v_add_f32 v224, v224, v214
  v_add_f32 v224, v224, v215
  v_mfma_f32_16x16x32_bf16 a[32:35], a[176:179], v[168:171], a[32:35]
  ds_read_b128 a[144:147], v3 offset:12288
  v_cvt_pk_bf16_f32 v163, v214, v215
  v_mfma_f32_16x16x32_bf16 a[36:39], a[176:179], v[172:175], a[36:39]
  v_exp_f32 v211, v107
  v_mfma_f32_16x16x32_bf16 a[96:99], a[176:179], v[184:187], a[96:99]
  v_add_f32 v225, v208, v209
  v_cvt_pk_bf16_f32 v164, v208, v209
  v_mfma_f32_16x16x32_bf16 a[100:103], a[176:179], v[188:191], a[100:103]
  v_exp_f32 v212, v108
  v_mfma_f32_16x16x32_bf16 a[40:43], a[180:183], v[168:171], a[40:43]
  ds_read_b128 a[148:151], v3 offset:13312
  v_add_f32 v225, v225, v210
  v_mfma_f32_16x16x32_bf16 a[44:47], a[180:183], v[172:175], a[44:47]
  v_exp_f32 v213, v109
  v_mfma_f32_16x16x32_bf16 a[104:107], a[180:183], v[184:187], a[104:107]
  buffer_load_dwordx4 v2, s[48:51], s27 offen offset:3072 sc1 lds
  v_add_f32 v225, v225, v211
  v_mfma_f32_16x16x32_bf16 a[108:111], a[180:183], v[188:191], a[108:111]
  s_add_u32 s27, s27, 16384
  v_exp_f32 v214, v110
  v_mfma_f32_16x16x32_bf16 a[48:51], a[184:187], v[168:171], a[48:51]
  s_add_u32 s25, s25, 32768
  ds_read_b128 a[152:155], v3 offset:14336
  v_cvt_pk_bf16_f32 v165, v210, v211
  v_mfma_f32_16x16x32_bf16 a[52:55], a[184:187], v[172:175], a[52:55]
  s_and_b32 s25, s25, 0x1ffff
  v_exp_f32 v215, v111
  v_mfma_f32_16x16x32_bf16 a[112:115], a[184:187], v[184:187], a[112:115]
  v_max3_f32 v5, v226, v227, v224
  v_add_f32 v225, v225, v212
  v_mfma_f32_16x16x32_bf16 a[116:119], a[184:187], v[188:191], a[116:119]
  v_add_f32 v225, v225, v213
  v_cvt_pk_bf16_f32 v166, v212, v213
  v_add_f32 v225, v225, v214
  v_mfma_f32_16x16x32_bf16 a[56:59], a[188:191], v[168:171], a[56:59]
  s_sub_u32 s28, s28, 1
  ds_read_b128 a[156:159], v3 offset:15360
  v_add_f32 v225, v225, v215
  v_max_f32 v5, v5, v225
  v_cmp_lt_f32 vcc, s81, v5
  v_mfma_f32_16x16x32_bf16 a[60:63], a[188:191], v[172:175], a[60:63]
  s_cmp_gt_u32 s28, s8
  v_exp_f32 v216, v144
  v_mfma_f32_16x16x32_bf16 a[120:123], a[188:191], v[184:187], a[120:123]
  s_waitcnt lgkmcnt(4)
  v_cvt_pk_bf16_f32 v167, v214, v215
  v_add_u32 v3, s66, v2
  v_mfma_f32_16x16x32_bf16 a[124:127], a[188:191], v[188:191], a[124:127]
  s_cbranch_vccnz fa_stub2
fa_back2:
  v_exp_f32 v217, v145
  v_add_f32 v228, v228, v224
  v_add_f32 v229, v229, v225
  v_add_f32 v230, v230, v226
  v_add_f32 v231, v231, v227
  s_cbranch_scc1 fa_DD
  s_cmp_lg_u32 s8, 0
  s_cbranch_scc1 fa_DDF
fa_Aexit:
  s_bitcmp1_b32 s20, 0
  s_cbranch_scc1 fa_Aodd
  v_mfma_f32_16x16x32_bf16 v[96:99], a[128:131], v[32:35], v[192:195]
  s_waitcnt vmcnt(12)
  v_exp_f32 v218, v146
  v_mfma_f32_16x16x32_bf16 v[104:107], a[128:131], v[36:39], v[196:199]
  s_barrier
  v_exp_f32 v219, v147
  v_mfma_f32_16x16x32_bf16 v[128:131], a[128:131], v[64:67], v[200:203]
  ds_read_b128 a[160:163], v3 offset:16384
  v_add_f32 v226, v216, v217
  v_mfma_f32_16x16x32_bf16 v[136:139], a[128:131], v[68:71], v[204:207]
  v_exp_f32 v220, v148
  v_mfma_f32_16x16x32_bf16 v[100:103], a[132:135], v[32:35], v[192:195]
  ds_read_b128 a[164:167], v3 offset:17408
  v_cvt_pk_bf16_f32 v184, v216, v217
  v_mfma_f32_16x16x32_bf16 v[108:111], a[132:135], v[36:39], v[196:199]
  s_mov_b32 m0, s24
  v_exp_f32 v221, v149
  v_mfma_f32_16x16x32_bf16 v[132:135], a[132:135], v[64:67], v[200:203]
  buffer_load_dwordx4 v2, s[44:47], s26 offen offset:0 sc1 lds
  v_add_f32 v226, v226, v218
  v_mfma_f32_16x16x32_bf16 v[140:143], a[132:135], v[68:71], v[204:207]
  v_exp_f32 v222, v150
  v_mfma_f32_16x16x32_bf16 v[96:99], a[136:139], v[40:43], v[96:99]
  ds_read_b128 a[168:171], v3 offset:18432
  v_add_f32 v226, v226, v219
  v_mfma_f32_16x16x32_bf16 v[104:107], a[136:139], v[44:47], v[104:107]
  v_exp_f32 v223, v151
  v_mfma_f32_16x16x32_bf16 v[128:131], a[136:139], v[72:75], v[128:131]
  v_cvt_pk_bf16_f32 v185, v218, v219
  v_add_f32 v226, v226, v220
  v_mfma_f32_16x16x32_bf16 v[136:139], a[136:139], v[76:79], v[136:139]
  v_exp_f32 v216, v152
  v_mfma_f32_16x16x32_bf16 v[100:103], a[140:143], v[40:43], v[100:103]
  ds_read_b128 a[172:175], v3 offset:19456
  v_add_f32 v226, v226, v221
  v_mfma_f32_16x16x32_bf16 v[108:111], a[140:143], v[44:47], v[108:111]
  v_exp_f32 v217, v153
  v_mfma_f32_16x16x32_bf16 v[132:135], a[140:143], v[72:75], v[132:135]
  v_cvt_pk_bf16_f32 v186, v220, v221
  v_add_f32 v226, v226, v222
  v_mfma_f32_16x16x32_bf16 v[140:143], a[140:143], v[76:79], v[140:143]
  s_waitcnt lgkmcnt(4)
  v_exp_f32 v218, v154
  v_mfma_f32_16x16x32_bf16 v[96:99], a[144:147], v[48:51], v[96:99]
  ds_read_b128 a[176:179], v3 offset:20480
  v_add_f32 v226, v226, v223
  v_mfma_f32_16x16x32_bf16 v[104:107], a[144:147], v[52:55], v[104:107]
  v_exp_f32 v219, v155
  v_mfma_f32_16x16x32_bf16 v[128:131], a[144:147], v[80:83], v[128:131]
  v_cvt_pk_bf16_f32 v187, v222, v223
  v_add_f32 v227, v216, v217
  v_mfma_f32_16x16x32_bf16 v[136:139], a[144:147], v[84:87], v[136:139]
  v_exp_f32 v220, v156
  v_mfma_f32_16x16x32_bf16 v[100:103], a[148:151], v[48:51], v[100:103]
  ds_read_b128 a[180:183], v3 offset:21504
  v_cvt_pk_bf16_f32 v188, v216, v217
  v_mfma_f32_16x16x32_bf16 v[108:111], a[148:151], v[52:55], v[108:111]
  v_exp_f32 v221, v157
  v_mfma_f32_16x16x32_bf16 v[132:135], a[148:151], v[80:83], v[132:135]
  buffer_load_dwordx4 v2, s[44:47], s26 offen offset:1024 sc1 lds
  v_add_f32 v227, v227, v218
  v_mfma_f32_16x16x32_bf16 v[140:143], a[148:151], v[84:87], v[140:143]
  v_exp_f32 v222, v158
  v_mfma_f32_16x16x32_bf16 v[96:99], a[152:155], v[56:59], v[96:99]
  ds_read_b128 a[184:187], v3 offset:22528
  v_add_f32 v227, v227, v219
  v_mfma_f32_16x16x32_bf16 v[104:107], a[152:155], v[60:63], v[104:107]
  v_exp_f32 v223, v159
  v_mfma_f32_16x16x32_bf16 v[128:131], a[152:155], v[88:91], v[128:131]
  v_cvt_pk_bf16_f32 v189, v218, v219
  v_add_f32 v227, v227, v220
  v_mfma_f32_16x16x32_bf16 v[136:139], a[152:155], v[92:95], v[136:139]
  v_exp_f32 v208, v112
  v_mfma_f32_16x16x32_bf16 v[100:103], a[156:159], v[56:59], v[100:103]
  ds_read_b128 a[188:191], v3 offset:23552
  v_add_f32 v227, v227, v221
  v_mfma_f32_16x16x32_bf16 v[108:111], a[156:159], v[60:63], v[108:111]
  v_exp_f32 v209, v113
  v_mfma_f32_16x16x32_bf16 v[132:135], a[156:159], v[88:91], v[132:135]
  v_cvt_pk_bf16_f32 v190, v220, v221
  v_add_f32 v227, v227, v222
  v_add_f32 v227, v227, v223
  v_mfma_f32_16x16x32_bf16 v[140:143], a[156:159], v[92:95], v[140:143]
  s_waitcnt lgkmcnt(4)
  v_exp_f32 v210, v114
  v_mfma_f32_16x16x32_bf16 a[0:3], a[160:163], v[160:163], a[0:3]
  ds_read_b128 a[128:131], v3 offset:0
  v_cvt_pk_bf16_f32 v191, v222, v223
  v_mfma_f32_16x16x32_bf16 a[4:7], a[160:163], v[164:167], a[4:7]
  v_exp_f32 v211, v115
  v_mfma_f32_16x16x32_bf16 a[64:67], a[160:163], v[176:179], a[64:67]
  v_exp_f32 v212, v116
  v_mfma_f32_16x16x32_bf16 a[68:71], a[160:163], v[180:183], a[68:71]
  v_add_f32 v224, v208, v209
  v_cvt_pk_bf16_f32 v168, v208, v209
  v_mfma_f32_16x16x32_bf16 a[8:11], a[164:167], v[160:163], a[8:11]
  ds_read_b128 a[132:135], v3 offset:1024
  v_add_f32 v224, v224, v210
  v_mfma_f32_16x16x32_bf16 a[12:15], a[164:167], v[164:167], a[12:15]
  v_exp_f32 v213, v117
  v_mfma_f32_16x16x32_bf16 a[72:75], a[164:167], v[176:179], a[72:75]
  buffer_load_dwordx4 v2, s[44:47], s26 offen offset:2048 sc1 lds
  v_add_f32 v224, v224, v211
  v_mfma_f32_16x16x32_bf16 a[76:79], a[164:167], v[180:183], a[76:79]
  v_exp_f32 v214, v118
  v_mfma_f32_16x16x32_bf16 a[16:19], a[168:171], v[160:163], a[16:19]
  ds_read_b128 a[136:139], v3 offset:2048
  v_cvt_pk_bf16_f32 v169, v210, v211
  v_mfma_f32_16x16x32_bf16 a[20:23], a[168:171], v[164:167], a[20:23]
  v_exp_f32 v215, v119
  v_mfma_f32_16x16x32_bf16 a[80:83], a[168:171], v[176:179], a[80:83]
  v_add_f32 v224, v224, v212
  v_add_f32 v224, v224, v213
  v_mfma_f32_16x16x32_bf16 a[84:87], a[168:171], v[180:183], a[84:87]
  v_exp_f32 v208, v120
  v_mfma_f32_16x16x32_bf16 a[24:27], a[172:175], v[160:163], a[24:27]
  ds_read_b128 a[140:143], v3 offset:3072
  v_cvt_pk_bf16_f32 v170, v212, v213
  v_mfma_f32_16x16x32_bf16 a[28:31], a[172:175], v[164:167], a[28:31]
  v_exp_f32 v209, v121
  v_mfma_f32_16x16x32_bf16 a[88:91], a[172:175], v[176:179], a[88:91]
  v_exp_f32 v210, v122
  v_mfma_f32_16x16x32_bf16 a[92:95], a[172:175], v[180:183], a[92:95]
  s_waitcnt lgkmcnt(4)
  v_add_f32 v224, v224, v214
  v_add_f32 v224, v224, v215
  v_mfma_f32_16x16x32_bf16 a[32:35], a[176:179], v[160:163], a[32:35]
  ds_read_b128 a[144:147], v3 offset:4096
  v_cvt_pk_bf16_f32 v171, v214, v215
  v_mfma_f32_16x16x32_bf16 a[36:39], a[176:179], v[164:167], a[36:39]
  v_exp_f32 v211, v123
  v_mfma_f32_16x16x32_bf16 a[96:99], a[176:179], v[176:179], a[96:99]
  v_add_f32 v225, v208, v209
  v_cvt_pk_bf16_f32 v172, v208, v209
  v_mfma_f32_16x16x32_bf16 a[100:103], a[176:179], v[180:183], a[100:103]
  v_exp_f32 v212, v124
  v_mfma_f32_16x16x32_bf16 a[40:43], a[180:183], v[160:163], a[40:43]
  ds_read_b128 a[148:151], v3 offset:5120
  v_add_f32 v225, v225, v210
  v_mfma_f32_16x16x32_bf16 a[44:47], a[180:183], v[164:167], a[44:47]
  v_exp_f32 v213, v125
  v_mfma_f32_16x16x32_bf16 a[104:107], a[180:183], v[176:179], a[104:107]
  buffer_load_dwordx4 v2, s[44:47], s26 offen offset:3072 sc1 lds
  v_add_f32 v225, v225, v211
  v_mfma_f32_16x16x32_bf16 a[108:111], a[180:183], v[180:183], a[108:111]
  s_add_u32 s26, s26, 16384
  v_exp_f32 v214, v126
  v_mfma_f32_16x16x32_bf16 a[48:51], a[184:187], v[160:163], a[48:51]
  s_add_u32 s24, s24, 32768
  ds_read_b128 a[152:155], v3 offset:6144
  v_cvt_pk_bf16_f32 v173, v210, v211
  v_mfma_f32_16x16x32_bf16 a[52:55], a[184:187], v[164:167], a[52:55]
  s_and_b32 s24, s24, 0x1ffff
  v_exp_f32 v215, v127
  v_mfma_f32_16x16x32_bf16 a[112:115], a[184:187], v[176:179], a[112:115]
  v_max3_f32 v5, v226, v227, v224
  v_add_f32 v225, v225, v212
  v_mfma_f32_16x16x32_bf16 a[116:119], a[184:187], v[180:183], a[116:119]
  v_add_f32 v225, v225, v213
  v_cvt_pk_bf16_f32 v174, v212, v213
  v_add_f32 v225, v225, v214
  v_mfma_f32_16x16x32_bf16 a[56:59], a[188:191], v[160:163], a[56:59]
  ds_read_b128 a[156:159], v3 offset:7168
  v_add_f32 v225, v225, v215
  v_max_f32 v5, v5, v225
  v_cmp_lt_f32 vcc, s81, v5
  v_mfma_f32_16x16x32_bf16 a[60:63], a[188:191], v[164:167], a[60:63]
  v_exp_f32 v216, v128
  v_mfma_f32_16x16x32_bf16 a[120:123], a[188:191], v[176:179], a[120:123]
  s_waitcnt lgkmcnt(4)
  v_cvt_pk_bf16_f32 v175, v214, v215
  v_mfma_f32_16x16x32_bf16 a[124:127], a[188:191], v[180:183], a[124:127]
  s_cbranch_vccnz fa_stub4
fa_back4:
  v_exp_f32 v217, v129
  v_add_f32 v228, v228, v224
  v_add_f32 v229, v229, v225
  v_add_f32 v230, v230, v226
  v_add_f32 v231, v231, v227
  v_mfma_f32_16x16x32_bf16 v[144:147], a[128:131], v[64:67], v[200:203]
  ds_read_b128 a[160:163], v3 offset:24576
  v_exp_f32 v218, v130
  v_mfma_f32_16x16x32_bf16 v[152:155], a[128:131], v[68:71], v[204:207]
  v_exp_f32 v219, v131
  v_add_f32 v226, v216, v217
  v_mfma_f32_16x16x32_bf16 v[148:151], a[132:135], v[64:67], v[200:203]
  s_add_u32 s66, s66, 32768
  ds_read_b128 a[164:167], v3 offset:25600
  v_exp_f32 v220, v132
  v_mfma_f32_16x16x32_bf16 v[156:159], a[132:135], v[68:71], v[204:207]
  s_and_b32 s66, s66, 0x1ffff
  v_exp_f32 v221, v133
  v_cvt_pk_bf16_f32 v176, v216, v217
  v_mfma_f32_16x16x32_bf16 v[144:147], a[136:139], v[72:75], v[144:147]
  ds_read_b128 a[168:171], v3 offset:26624
  v_add_f32 v226, v226, v218
  v_add_f32 v226, v226, v219
  v_mfma_f32_16x16x32_bf16 v[152:155], a[136:139], v[76:79], v[152:155]
  s_mov_b32 m0, s25
  v_exp_f32 v222, v134
  v_cvt_pk_bf16_f32 v177, v218, v219
  v_mfma_f32_16x16x32_bf16 v[148:151], a[140:143], v[72:75], v[148:151]
  ds_read_b128 a[172:175], v3 offset:27648
  buffer_load_dwordx4 v2, s[48:51], s27 offen offset:0 sc1 lds
  v_add_f32 v226, v226, v220
  v_add_f32 v226, v226, v221
  v_mfma_f32_16x16x32_bf16 v[156:159], a[140:143], v[76:79], v[156:159]
  s_waitcnt lgkmcnt(4)
  v_exp_f32 v223, v135
  v_cvt_pk_bf16_f32 v178, v220, v221
  v_mfma_f32_16x16x32_bf16 v[144:147], a[144:147], v[80:83], v[144:147]
  ds_read_b128 a[176:179], v3 offset:28672
  v_cndmask_b32 v96, v4, v96, s[68:69]
  v_cndmask_b32 v97, v4, v97, s[70:71]
  v_mfma_f32_16x16x32_bf16 v[152:155], a[144:147], v[84:87], v[152:155]
  v_exp_f32 v216, v136
  v_cndmask_b32 v98, v4, v98, s[72:73]
  v_mfma_f32_16x16x32_bf16 v[148:151], a[148:151], v[80:83], v[148:151]
  ds_read_b128 a[180:183], v3 offset:29696
  v_cndmask_b32 v99, v4, v99, s[74:75]
  v_mov_b32 v100, v4
  v_mfma_f32_16x16x32_bf16 v[156:159], a[148:151], v[84:87], v[156:159]
  v_exp_f32 v217, v137
  v_mov_b32 v101, v4
  v_mfma_f32_16x16x32_bf16 v[144:147], a[152:155], v[88:91], v[144:147]
  ds_read_b128 a[184:187], v3 offset:30720
  v_mov_b32 v102, v4
  v_mov_b32 v103, v4
  v_mfma_f32_16x16x32_bf16 v[152:155], a[152:155], v[92:95], v[152:155]
  v_exp_f32 v218, v138
  v_cndmask_b32 v108, v4, v108, s[68:69]
  v_mfma_f32_16x16x32_bf16 v[148:151], a[156:159], v[88:91], v[148:151]
  ds_read_b128 a[188:191], v3 offset:31744
  v_cndmask_b32 v109, v4, v109, s[70:71]
  v_cndmask_b32 v110, v4, v110, s[72:73]
  v_mfma_f32_16x16x32_bf16 v[156:159], a[156:159], v[92:95], v[156:159]
  s_waitcnt lgkmcnt(4)
  v_exp_f32 v219, v139
  v_cndmask_b32 v111, v4, v111, s[74:75]
  v_mfma_f32_16x16x32_bf16 a[0:3], a[160:163], v[168:171], a[0:3]
  ds_read_b128 a[128:131], v3 offset:8192
  v_add_f32 v226, v226, v222
  v_add_f32 v226, v226, v223
  v_mfma_f32_16x16x32_bf16 a[4:7], a[160:163], v[172:175], a[4:7]
  v_exp_f32 v220, v140
  v_cvt_pk_bf16_f32 v179, v222, v223
  v_mfma_f32_16x16x32_bf16 a[64:67], a[160:163], v[184:187], a[64:67]
  buffer_load_dwordx4 v2, s[48:51], s27 offen offset:1024 sc1 lds
  v_add_f32 v227, v216, v217
  v_cvt_pk_bf16_f32 v180, v216, v217
  v_mfma_f32_16x16x32_bf16 a[68:71], a[160:163], v[188:191], a[68:71]
  v_exp_f32 v221, v141
  v_add_f32 v227, v227, v218
  v_mfma_f32_16x16x32_bf16 a[8:11], a[164:167], v[168:171], a[8:11]
  ds_read_b128 a[132:135], v3 offset:9216
  v_exp_f32 v222, v142
  v_mfma_f32_16x16x32_bf16 a[12:15], a[164:167], v[172:175], a[12:15]
  v_exp_f32 v223, v143
  v_mfma_f32_16x16x32_bf16 a[72:75], a[164:167], v[184:187], a[72:75]
  v_exp_f32 v208, v96
  v_mfma_f32_16x16x32_bf16 a[76:79], a[164:167], v[188:191], a[76:79]
  v_exp_f32 v209, v97
  v_mfma_f32_16x16x32_bf16 a[16:19], a[168:171], v[168:171], a[16:19]
  ds_read_b128 a[136:139], v3 offset:10240
  v_add_f32 v227, v227, v219
  v_cvt_pk_bf16_f32 v181, v218, v219
  v_add_f32 v227, v227, v220
  v_add_f32 v227, v227, v221
  v_cvt_pk_bf16_f32 v182, v220, v221
  v_mfma_f32_16x16x32_bf16 a[20:23], a[168:171], v[172:175], a[20:23]
  v_exp_f32 v210, v98
  v_mfma_f32_16x16x32_bf16 a[80:83], a[168:171], v[184:187], a[80:83]
  v_exp_f32 v211, v99
  v_mfma_f32_16x16x32_bf16 a[84:87], a[168:171], v[188:191], a[84:87]
  v_exp_f32 v212, v100
  v_mfma_f32_16x16x32_bf16 a[24:27], a[172:175], v[168:171], a[24:27]
  ds_read_b128 a[140:143], v3 offset:11264
  v_add_f32 v227, v227, v222
  v_add_f32 v227, v227, v223
  v_cvt_pk_bf16_f32 v183, v222, v223
  v_add_f32 v224, v208, v209
  v_cvt_pk_bf16_f32 v160, v208, v209
  v_mfma_f32_16x16x32_bf16 a[28:31], a[172:175], v[172:175], a[28:31]
  v_exp_f32 v213, v101
  v_mfma_f32_16x16x32_bf16 a[88:91], a[172:175], v[184:187], a[88:91]
  buffer_load_dwordx4 v2, s[48:51], s27 offen offset:2048 sc1 lds
  v_add_f32 v224, v224, v210
  v_add_f32 v224, v224, v211
  v_cvt_pk_bf16_f32 v161, v210, v211
  v_mfma_f32_16x16x32_bf16 a[92:95], a[172:175], v[188:191], a[92:95]
  s_waitcnt lgkmcnt(4)
  v_exp_f32 v214, v102
  v_mfma_f32_16x16x32_bf16 a[32:35], a[176:179], v[168:171], a[32:35]
  ds_read_b128 a[144:147], v3 offset:12288
  v_exp_f32 v215, v103
  v_mfma_f32_16x16x32_bf16 a[36:39], a[176:179], v[172:175], a[36:39]
  v_exp_f32 v208, v104
  v_mfma_f32_16x16x32_bf16 a[96:99], a[176:179], v[184:187], a[96:99]
  v_exp_f32 v209, v105
  v_mfma_f32_16x16x32_bf16 a[100:103], a[176:179], v[188:191], a[100:103]
  v_exp_f32 v210, v106
  v_mfma_f32_16x16x32_bf16 a[40:43], a[180:183], v[168:171], a[40:43]
  ds_read_b128 a[148:151], v3 offset:13312
  v_add_f32 v224, v224, v212
  v_add_f32 v224, v224, v213
  v_cvt_pk_bf16_f32 v162, v212, v213
  v_add_f32 v224, v224, v214
  v_add_f32 v224, v224, v215
  v_cvt_pk_bf16_f32 v163, v214, v215
  v_mfma_f32_16x16x32_bf16 a[44:47], a[180:183], v[172:175], a[44:47]
  v_exp_f32 v211, v107
  v_mfma_f32_16x16x32_bf16 a[104:107], a[180:183], v[184:187], a[104:107]
  v_exp_f32 v212, v108
  v_mfma_f32_16x16x32_bf16 a[108:111], a[180:183], v[188:191], a[108:111]
  v_exp_f32 v213, v109
  v_mfma_f32_16x16x32_bf16 a[48:51], a[184:187], v[168:171], a[48:51]
  ds_read_b128 a[152:155], v3 offset:14336
  v_add_f32 v225, v208, v209
  v_cvt_pk_bf16_f32 v164, v208, v209
  v_add_f32 v225, v225, v210
  v_add_f32 v225, v225, v211
  v_cvt_pk_bf16_f32 v165, v210, v211
  v_mfma_f32_16x16x32_bf16 a[52:55], a[184:187], v[172:175], a[52:55]
  v_exp_f32 v214, v110
  v_mfma_f32_16x16x32_bf16 a[112:115], a[184:187], v[184:187], a[112:115]
  buffer_load_dwordx4 v2, s[48:51], s27 offen offset:3072 sc1 lds
  v_max3_f32 v5, v226, v227, v224
  v_add_f32 v225, v225, v212
  v_add_f32 v225, v225, v213
  v_mfma_f32_16x16x32_bf16 a[116:119], a[184:187], v[188:191], a[116:119]
  s_add_u32 s27, s27, 16384
  v_exp_f32 v215, v111
  v_mfma_f32_16x16x32_bf16 a[56:59], a[188:191], v[168:171], a[56:59]
  s_add_u32 s25, s25, 32768
  ds_read_b128 a[156:159], v3 offset:15360
  v_cvt_pk_bf16_f32 v166, v212, v213
  v_add_f32 v225, v225, v214
  v_add_f32 v225, v225, v215
  v_max_f32 v5, v5, v225
  v_cmp_lt_f32 vcc, s81, v5
  v_mfma_f32_16x16x32_bf16 a[60:63], a[188:191], v[172:175], a[60:63]
  s_and_b32 s25, s25, 0x1ffff
  v_exp_f32 v216, v144
  v_mfma_f32_16x16x32_bf16 a[120:123], a[188:191], v[184:187], a[120:123]
  s_waitcnt lgkmcnt(4)
  v_cvt_pk_bf16_f32 v167, v214, v215
  v_add_u32 v3, s66, v2
  v_mfma_f32_16x16x32_bf16 a[124:127], a[188:191], v[188:191], a[124:127]
  s_cbranch_vccnz fa_stub5
fa_back5:
  v_exp_f32 v217, v145
  v_add_f32 v228, v228, v224
  v_add_f32 v229, v229, v225
  v_add_f32 v230, v230, v226
  v_add_f32 v231, v231, v227
fa_AV:
  v_mfma_f32_16x16x32_bf16 v[128:131], a[128:131], v[64:67], v[200:203]
  s_waitcnt vmcnt(12)
  v_exp_f32 v218, v146
  v_mfma_f32_16x16x32_bf16 v[136:139], a[128:131], v[68:71], v[204:207]
  s_barrier
  v_exp_f32 v219, v147
  v_mfma_f32_16x16x32_bf16 v[132:135], a[132:135], v[64:67], v[200:203]
  ds_read_b128 a[160:163], v3 offset:16384
  ds_read_b128 a[164:167], v3 offset:17408
  v_add_f32 v226, v216, v217
  v_mfma_f32_16x16x32_bf16 v[140:143], a[132:135], v[68:71], v[204:207]
  v_exp_f32 v220, v148
  v_mfma_f32_16x16x32_bf16 v[128:131], a[136:139], v[72:75], v[128:131]
  ds_read_b128 a[168:171], v3 offset:18432
  v_cvt_pk_bf16_f32 v184, v216, v217
  v_mfma_f32_16x16x32_bf16 v[136:139], a[136:139], v[76:79], v[136:139]
  s_mov_b32 m0, s24
  v_exp_f32 v221, v149
  v_mfma_f32_16x16x32_bf16 v[132:135], a[140:143], v[72:75], v[132:135]
  ds_read_b128 a[172:175], v3 offset:19456
  buffer_load_dwordx4 v2, s[44:47], s26 offen offset:0 sc1 lds
  v_add_f32 v226, v226, v218
  v_mfma_f32_16x16x32_bf16 v[140:143], a[140:143], v[76:79], v[140:143]
  s_waitcnt lgkmcnt(4)
  v_exp_f32 v222, v150
  v_mfma_f32_16x16x32_bf16 v[128:131], a[144:147], v[80:83], v[128:131]
  ds_read_b128 a[176:179], v3 offset:20480
  v_add_f32 v226, v226, v219
  v_mfma_f32_16x16x32_bf16 v[136:139], a[144:147], v[84:87], v[136:139]
  v_exp_f32 v223, v151
  v_mfma_f32_16x16x32_bf16 v[132:135], a[148:151], v[80:83], v[132:135]
  ds_read_b128 a[180:183], v3 offset:21504
  v_cvt_pk_bf16_f32 v185, v218, v219
  v_mfma_f32_16x16x32_bf16 v[140:143], a[148:151], v[84:87], v[140:143]
  v_add_f32 v226, v226, v220
  v_add_f32 v226, v226, v221
  v_mfma_f32_16x16x32_bf16 v[128:131], a[152:155], v[88:91], v[128:131]
  ds_read_b128 a[184:187], v3 offset:22528
  v_cvt_pk_bf16_f32 v186, v220, v221
  v_mfma_f32_16x16x32_bf16 v[136:139], a[152:155], v[92:95], v[136:139]
  v_exp_f32 v216, v152
  v_mfma_f32_16x16x32_bf16 v[132:135], a[156:159], v[88:91], v[132:135]
  ds_read_b128 a[188:191], v3 offset:23552
  v_add_f32 v226, v226, v222
  v_mfma_f32_16x16x32_bf16 v[140:143], a[156:159], v[92:95], v[140:143]
  s_waitcnt lgkmcnt(4)
  v_exp_f32 v217, v153
  v_mfma_f32_16x16x32_bf16 a[0:3], a[160:163], v[160:163], a[0:3]
  ds_read_b128 a[128:131], v3 offset:0
  v_add_f32 v226, v226, v223
  v_mfma_f32_16x16x32_bf16 a[4:7], a[160:163], v[164:167], a[4:7]
  v_exp_f32 v218, v154
  v_mfma_f32_16x16x32_bf16 a[64:67], a[160:163], v[176:179], a[64:67]
  buffer_load_dwordx4 v2, s[44:47], s26 offen offset:1024 sc1 lds
  v_cvt_pk_bf16_f32 v187, v222, v223
  v_mfma_f32_16x16x32_bf16 a[68:71], a[160:163], v[180:183], a[68:71]
  v_exp_f32 v219, v155
  v_mfma_f32_16x16x32_bf16 a[8:11], a[164:167], v[160:163], a[8:11]
  ds_read_b128 a[132:135], v3 offset:1024
  v_add_f32 v227, v216, v217
  v_mfma_f32_16x16x32_bf16 a[12:15], a[164:167], v[164:167], a[12:15]
  v_exp_f32 v220, v156
  v_mfma_f32_16x16x32_bf16 a[72:75], a[164:167], v[176:179], a[72:75]
  v_exp_f32 v221, v157
  v_mfma_f32_16x16x32_bf16 a[76:79], a[164:167], v[180:183], a[76:79]
  v_cvt_pk_bf16_f32 v188, v216, v217
  v_add_f32 v227, v227, v218
  v_mfma_f32_16x16x32_bf16 a[16:19], a[168:171], v[160:163], a[16:19]
  ds_read_b128 a[136:139], v3 offset:2048
  v_add_f32 v227, v227, v219
  v_mfma_f32_16x16x32_bf16 a[20:23], a[168:171], v[164:167], a[20:23]
  v_exp_f32 v222, v158
  v_mfma_f32_16x16x32_bf16 a[80:83], a[168:171], v[176:179], a[80:83]
  v_exp_f32 v223, v159
  v_mfma_f32_16x16x32_bf16 a[84:87], a[168:171], v[180:183], a[84:87]
  v_cvt_pk_bf16_f32 v189, v218, v219
  v_add_f32 v227, v227, v220
  v_mfma_f32_16x16x32_bf16 a[24:27], a[172:175], v[160:163], a[24:27]
  ds_read_b128 a[140:143], v3 offset:3072
  v_add_f32 v227, v227, v221
  v_mfma_f32_16x16x32_bf16 a[28:31], a[172:175], v[164:167], a[28:31]
  v_cvt_pk_bf16_f32 v190, v220, v221
  v_add_f32 v227, v227, v222
  v_mfma_f32_16x16x32_bf16 a[88:91], a[172:175], v[176:179], a[88:91]
  buffer_load_dwordx4 v2, s[44:47], s26 offen offset:2048 sc1 lds
  v_add_f32 v227, v227, v223
  v_mfma_f32_16x16x32_bf16 a[92:95], a[172:175], v[180:183], a[92:95]
  s_waitcnt lgkmcnt(4)
  v_max_f32 v5, v226, v227
  v_cmp_lt_f32 vcc, s81, v5
  v_mfma_f32_16x16x32_bf16 a[32:35], a[176:179], v[160:163], a[32:35]
  ds_read_b128 a[144:147], v3 offset:4096
  v_mfma_f32_16x16x32_bf16 a[36:39], a[176:179], v[164:167], a[36:39]
  v_mfma_f32_16x16x32_bf16 a[96:99], a[176:179], v[176:179], a[96:99]
  v_mfma_f32_16x16x32_bf16 a[100:103], a[176:179], v[180:183], a[100:103]
  v_mfma_f32_16x16x32_bf16 a[40:43], a[180:183], v[160:163], a[40:43]
  ds_read_b128 a[148:151], v3 offset:5120
  v_mfma_f32_16x16x32_bf16 a[44:47], a[180:183], v[164:167], a[44:47]
  v_mfma_f32_16x16x32_bf16 a[104:107], a[180:183], v[176:179], a[104:107]
  v_mfma_f32_16x16x32_bf16 a[108:111], a[180:183], v[180:183], a[108:111]
  v_mfma_f32_16x16x32_bf16 a[48:51], a[184:187], v[160:163], a[48:51]
  ds_read_b128 a[152:155], v3 offset:6144
  v_mfma_f32_16x16x32_bf16 a[52:55], a[184:187], v[164:167], a[52:55]
  v_mfma_f32_16x16x32_bf16 a[112:115], a[184:187], v[176:179], a[112:115]
  buffer_load_dwordx4 v2, s[44:47], s26 offen offset:3072 sc1 lds
  v_mfma_f32_16x16x32_bf16 a[116:119], a[184:187], v[180:183], a[116:119]
  s_add_u32 s26, s26, 16384
  v_mfma_f32_16x16x32_bf16 a[56:59], a[188:191], v[160:163], a[56:59]
  s_add_u32 s24, s24, 32768
  ds_read_b128 a[156:159], v3 offset:7168
  v_mfma_f32_16x16x32_bf16 a[60:63], a[188:191], v[164:167], a[60:63]
  s_and_b32 s24, s24, 0x1ffff
  v_exp_f32 v216, v128
  v_mfma_f32_16x16x32_bf16 a[120:123], a[188:191], v[176:179], a[120:123]
  s_waitcnt lgkmcnt(4)
  v_cvt_pk_bf16_f32 v191, v222, v223
  v_mfma_f32_16x16x32_bf16 a[124:127], a[188:191], v[180:183], a[124:127]
  s_cbranch_vccnz fa_stub6
fa_back6:
  v_exp_f32 v217, v129
  v_add_f32 v230, v230, v226
  v_add_f32 v231, v231, v227
  v_mfma_f32_16x16x32_bf16 v[144:147], a[128:131], v[64:67], v[200:203]
  ds_read_b128 a[160:163], v3 offset:24576
  v_add_f32 v226, v216, v217
  v_mfma_f32_16x16x32_bf16 v[152:155], a[128:131], v[68:71], v[204:207]
  v_exp_f32 v218, v130
  v_mfma_f32_16x16x32_bf16 v[148:151], a[132:135], v[64:67], v[200:203]
  s_add_u32 s66, s66, 32768
  ds_read_b128 a[164:167], v3 offset:25600
  v_cvt_pk_bf16_f32 v176, v216, v217
  v_mfma_f32_16x16x32_bf16 v[156:159], a[132:135], v[68:71], v[204:207]
  s_mov_b32 m0, s25
  v_exp_f32 v219, v131
  v_mfma_f32_16x16x32_bf16 v[144:147], a[136:139], v[72:75], v[144:147]
  s_and_b32 s66, s66, 0x1ffff
  ds_read_b128 a[168:171], v3 offset:26624
  buffer_load_dwordx4 v2, s[48:51], s27 offen offset:0 sc1 lds
  v_add_f32 v226, v226, v218
  v_add_f32 v226, v226, v219
  v_mfma_f32_16x16x32_bf16 v[152:155], a[136:139], v[76:79], v[152:155]
  v_exp_f32 v220, v132
  v_mfma_f32_16x16x32_bf16 v[148:151], a[140:143], v[72:75], v[148:151]
  ds_read_b128 a[172:175], v3 offset:27648
  v_cvt_pk_bf16_f32 v177, v218, v219
  v_mfma_f32_16x16x32_bf16 v[156:159], a[140:143], v[76:79], v[156:159]
  s_waitcnt lgkmcnt(4)
  v_exp_f32 v221, v133
  v_mfma_f32_16x16x32_bf16 v[144:147], a[144:147], v[80:83], v[144:147]
  ds_read_b128 a[176:179], v3 offset:28672
  v_add_f32 v226, v226, v220
  v_mfma_f32_16x16x32_bf16 v[152:155], a[144:147], v[84:87], v[152:155]
  v_exp_f32 v222, v134
  v_mfma_f32_16x16x32_bf16 v[148:151], a[148:151], v[80:83], v[148:151]
  ds_read_b128 a[180:183], v3 offset:29696
  buffer_load_dwordx4 v2, s[48:51], s27 offen offset:1024 sc1 lds
  v_add_f32 v226, v226, v221
  v_cvt_pk_bf16_f32 v178, v220, v221
  v_mfma_f32_16x16x32_bf16 v[156:159], a[148:151], v[84:87], v[156:159]
  v_exp_f32 v223, v135
  v_mfma_f32_16x16x32_bf16 v[144:147], a[152:155], v[88:91], v[144:147]
  ds_read_b128 a[184:187], v3 offset:30720
  v_add_f32 v226, v226, v222
  v_mfma_f32_16x16x32_bf16 v[152:155], a[152:155], v[92:95], v[152:155]
  v_exp_f32 v216, v136
  v_mfma_f32_16x16x32_bf16 v[148:151], a[156:159], v[88:91], v[148:151]
  ds_read_b128 a[188:191], v3 offset:31744
  v_add_f32 v226, v226, v223
  v_exp_f32 v217, v137
  v_mfma_f32_16x16x32_bf16 v[156:159], a[156:159], v[92:95], v[156:159]
  s_waitcnt lgkmcnt(4)
  v_exp_f32 v218, v138
  v_mfma_f32_16x16x32_bf16 a[64:67], a[160:163], v[184:187], a[64:67]
  ds_read_b128 a[128:131], v3 offset:8192
  v_cvt_pk_bf16_f32 v179, v222, v223
  v_mfma_f32_16x16x32_bf16 a[68:71], a[160:163], v[188:191], a[68:71]
  v_exp_f32 v219, v139
  v_mfma_f32_16x16x32_bf16 a[72:75], a[164:167], v[184:187], a[72:75]
  ds_read_b128 a[132:135], v3 offset:9216
  buffer_load_dwordx4 v2, s[48:51], s27 offen offset:2048 sc1 lds
  v_add_f32 v227, v216, v217
  v_mfma_f32_16x16x32_bf16 a[76:79], a[164:167], v[188:191], a[76:79]
  v_exp_f32 v220, v140
  v_mfma_f32_16x16x32_bf16 a[80:83], a[168:171], v[184:187], a[80:83]
  ds_read_b128 a[136:139], v3 offset:10240
  v_cvt_pk_bf16_f32 v180, v216, v217
  v_mfma_f32_16x16x32_bf16 a[84:87], a[168:171], v[188:191], a[84:87]
  v_exp_f32 v221, v141
  v_mfma_f32_16x16x32_bf16 a[88:91], a[172:175], v[184:187], a[88:91]
  ds_read_b128 a[140:143], v3 offset:11264
  v_add_f32 v227, v227, v218
  v_mfma_f32_16x16x32_bf16 a[92:95], a[172:175], v[188:191], a[92:95]
  s_waitcnt lgkmcnt(4)
  v_exp_f32 v222, v142
  v_mfma_f32_16x16x32_bf16 a[96:99], a[176:179], v[184:187], a[96:99]
  ds_read_b128 a[144:147], v3 offset:12288
  buffer_load_dwordx4 v2, s[48:51], s27 offen offset:3072 sc1 lds
  v_add_f32 v227, v227, v219
  v_cvt_pk_bf16_f32 v181, v218, v219
  v_mfma_f32_16x16x32_bf16 a[100:103], a[176:179], v[188:191], a[100:103]
  s_add_u32 s27, s27, 16384
  v_exp_f32 v223, v143
  v_mfma_f32_16x16x32_bf16 a[104:107], a[180:183], v[184:187], a[104:107]
  s_add_u32 s25, s25, 32768
  ds_read_b128 a[148:151], v3 offset:13312
  v_add_f32 v227, v227, v220
  v_mfma_f32_16x16x32_bf16 a[108:111], a[180:183], v[188:191], a[108:111]
  s_and_b32 s25, s25, 0x1ffff
  v_add_f32 v227, v227, v221
  v_cvt_pk_bf16_f32 v182, v220, v221
  v_add_f32 v227, v227, v222
  v_mfma_f32_16x16x32_bf16 a[112:115], a[184:187], v[184:187], a[112:115]
  ds_read_b128 a[152:155], v3 offset:14336
  v_add_f32 v227, v227, v223
  v_max_f32 v5, v226, v227
  v_cmp_lt_f32 vcc, s81, v5
  v_mfma_f32_16x16x32_bf16 a[116:119], a[184:187], v[188:191], a[116:119]
  v_exp_f32 v216, v144
  v_mfma_f32_16x16x32_bf16 a[120:123], a[188:191], v[184:187], a[120:123]
  s_waitcnt lgkmcnt(3)
  ds_read_b128 a[156:159], v3 offset:15360
  v_cvt_pk_bf16_f32 v183, v222, v223
  v_add_u32 v3, s66, v2
  v_mfma_f32_16x16x32_bf16 a[124:127], a[188:191], v[188:191], a[124:127]
  s_cbranch_vccnz fa_stub7
fa_back7:
  v_exp_f32 v217, v145
  v_add_f32 v230, v230, v226
  v_add_f32 v231, v231, v227
  s_branch fa_SSpre
fa_Aodd:
  v_mfma_f32_16x16x32_bf16 v[128:131], a[128:131], v[64:67], v[200:203]
  s_waitcnt vmcnt(12)
  v_exp_f32 v218, v146
  v_add_f32 v226, v216, v217
  v_mfma_f32_16x16x32_bf16 v[136:139], a[128:131], v[68:71], v[204:207]
  s_barrier
  v_exp_f32 v219, v147
  v_cvt_pk_bf16_f32 v184, v216, v217
  v_mfma_f32_16x16x32_bf16 v[132:135], a[132:135], v[64:67], v[200:203]
  ds_read_b128 a[160:163], v3 offset:16384
  ds_read_b128 a[164:167], v3 offset:17408
  v_exp_f32 v220, v148
  v_mfma_f32_16x16x32_bf16 v[140:143], a[132:135], v[68:71], v[204:207]
  v_exp_f32 v221, v149
  v_add_f32 v226, v226, v218
  v_mfma_f32_16x16x32_bf16 v[128:131], a[136:139], v[72:75], v[128:131]
  ds_read_b128 a[168:171], v3 offset:18432
  v_add_f32 v226, v226, v219
  v_cvt_pk_bf16_f32 v185, v218, v219
  v_mfma_f32_16x16x32_bf16 v[136:139], a[136:139], v[76:79], v[136:139]
  s_mov_b32 m0, s24
  v_exp_f32 v222, v150
  v_add_f32 v226, v226, v220
  v_mfma_f32_16x16x32_bf16 v[132:135], a[140:143], v[72:75], v[132:135]
  ds_read_b128 a[172:175], v3 offset:19456
  buffer_load_dwordx4 v2, s[44:47], s26 offen offset:0 sc1 lds
  v_add_f32 v226, v226, v221
  v_cvt_pk_bf16_f32 v186, v220, v221
  v_mfma_f32_16x16x32_bf16 v[140:143], a[140:143], v[76:79], v[140:143]
  s_waitcnt lgkmcnt(4)
  v_exp_f32 v223, v151
  v_cndmask_b32 v112, v4, v112, s[68:69]
  v_mfma_f32_16x16x32_bf16 v[128:131], a[144:147], v[80:83], v[128:131]
  ds_read_b128 a[176:179], v3 offset:20480
  v_cndmask_b32 v113, v4, v113, s[70:71]
  v_cndmask_b32 v114, v4, v114, s[72:73]
  v_mfma_f32_16x16x32_bf16 v[136:139], a[144:147], v[84:87], v[136:139]
  v_exp_f32 v216, v152
  v_cndmask_b32 v115, v4, v115, s[74:75]
  v_mfma_f32_16x16x32_bf16 v[132:135], a[148:151], v[80:83], v[132:135]
  ds_read_b128 a[180:183], v3 offset:21504
  v_mov_b32 v116, v4
  v_mov_b32 v117, v4
  v_mfma_f32_16x16x32_bf16 v[140:143], a[148:151], v[84:87], v[140:143]
  v_exp_f32 v217, v153
  v_mov_b32 v118, v4
  v_mfma_f32_16x16x32_bf16 v[128:131], a[152:155], v[88:91], v[128:131]
  ds_read_b128 a[184:187], v3 offset:22528
  v_mov_b32 v119, v4
  v_cndmask_b32 v124, v4, v124, s[68:69]
  v_mfma_f32_16x16x32_bf16 v[136:139], a[152:155], v[92:95], v[136:139]
  v_exp_f32 v218, v154
  v_cndmask_b32 v125, v4, v125, s[70:71]
  v_mfma_f32_16x16x32_bf16 v[132:135], a[156:159], v[88:91], v[132:135]
  ds_read_b128 a[188:191], v3 offset:23552
  v_cndmask_b32 v126, v4, v126, s[72:73]
  v_cndmask_b32 v127, v4, v127, s[74:75]
  v_mfma_f32_16x16x32_bf16 v[140:143], a[156:159], v[92:95], v[140:143]
  s_waitcnt lgkmcnt(4)
  v_exp_f32 v219, v155
  v_add_f32 v226, v226, v222
  v_mfma_f32_16x16x32_bf16 a[0:3], a[160:163], v[160:163], a[0:3]
  ds_read_b128 a[128:131], v3 offset:0
  v_add_f32 v226, v226, v223
  v_cvt_pk_bf16_f32 v187, v222, v223
  v_mfma_f32_16x16x32_bf16 a[4:7], a[160:163], v[164:167], a[4:7]
  v_exp_f32 v220, v156
  v_add_f32 v227, v216, v217
  v_mfma_f32_16x16x32_bf16 a[64:67], a[160:163], v[176:179], a[64:67]
  buffer_load_dwordx4 v2, s[44:47], s26 offen offset:1024 sc1 lds
  v_exp_f32 v221, v157
  v_mfma_f32_16x16x32_bf16 a[68:71], a[160:163], v[180:183], a[68:71]
  v_exp_f32 v222, v158
  v_mfma_f32_16x16x32_bf16 a[8:11], a[164:167], v[160:163], a[8:11]
  ds_read_b128 a[132:135], v3 offset:1024
  v_cvt_pk_bf16_f32 v188, v216, v217
  v_add_f32 v227, v227, v218
  v_add_f32 v227, v227, v219
  v_mfma_f32_16x16x32_bf16 a[12:15], a[164:167], v[164:167], a[12:15]
  v_exp_f32 v223, v159
  v_mfma_f32_16x16x32_bf16 a[72:75], a[164:167], v[176:179], a[72:75]
  v_exp_f32 v208, v112
  v_mfma_f32_16x16x32_bf16 a[76:79], a[164:167], v[180:183], a[76:79]
  v_exp_f32 v209, v113
  v_mfma_f32_16x16x32_bf16 a[16:19], a[168:171], v[160:163], a[16:19]
  ds_read_b128 a[136:139], v3 offset:2048
  v_cvt_pk_bf16_f32 v189, v218, v219
  v_add_f32 v227, v227, v220
  v_add_f32 v227, v227, v221
  v_cvt_pk_bf16_f32 v190, v220, v221
  v_add_f32 v227, v227, v222
  v_mfma_f32_16x16x32_bf16 a[20:23], a[168:171], v[164:167], a[20:23]
  v_exp_f32 v210, v114
  v_mfma_f32_16x16x32_bf16 a[80:83], a[168:171], v[176:179], a[80:83]
  v_exp_f32 v211, v115
  v_mfma_f32_16x16x32_bf16 a[84:87], a[168:171], v[180:183], a[84:87]
  v_exp_f32 v212, v116
  v_mfma_f32_16x16x32_bf16 a[24:27], a[172:175], v[160:163], a[24:27]
  ds_read_b128 a[140:143], v3 offset:3072
  v_add_f32 v227, v227, v223
  v_cvt_pk_bf16_f32 v191, v222, v223
  v_add_f32 v224, v208, v209
  v_cvt_pk_bf16_f32 v168, v208, v209
  v_add_f32 v224, v224, v210
  v_mfma_f32_16x16x32_bf16 a[28:31], a[172:175], v[164:167], a[28:31]
  v_exp_f32 v213, v117
  v_mfma_f32_16x16x32_bf16 a[88:91], a[172:175], v[176:179], a[88:91]
  buffer_load_dwordx4 v2, s[44:47], s26 offen offset:2048 sc1 lds
  v_exp_f32 v214, v118
  v_mfma_f32_16x16x32_bf16 a[92:95], a[172:175], v[180:183], a[92:95]
  s_waitcnt lgkmcnt(4)
  v_exp_f32 v215, v119
  v_mfma_f32_16x16x32_bf16 a[32:35], a[176:179], v[160:163], a[32:35]
  ds_read_b128 a[144:147], v3 offset:4096
  v_add_f32 v224, v224, v211
  v_cvt_pk_bf16_f32 v169, v210, v211
  v_add_f32 v224, v224, v212
  v_add_f32 v224, v224, v213
  v_mfma_f32_16x16x32_bf16 a[36:39], a[176:179], v[164:167], a[36:39]
  v_exp_f32 v208, v120
  v_mfma_f32_16x16x32_bf16 a[96:99], a[176:179], v[176:179], a[96:99]
  v_exp_f32 v209, v121
  v_mfma_f32_16x16x32_bf16 a[100:103], a[176:179], v[180:183], a[100:103]
  v_exp_f32 v210, v122
  v_mfma_f32_16x16x32_bf16 a[40:43], a[180:183], v[160:163], a[40:43]
  ds_read_b128 a[148:151], v3 offset:5120
  v_cvt_pk_bf16_f32 v170, v212, v213
  v_add_f32 v224, v224, v214
  v_add_f32 v224, v224, v215
  v_cvt_pk_bf16_f32 v171, v214, v215
  v_add_f32 v225, v208, v209
  v_mfma_f32_16x16x32_bf16 a[44:47], a[180:183], v[164:167], a[44:47]
  v_exp_f32 v211, v123
  v_mfma_f32_16x16x32_bf16 a[104:107], a[180:183], v[176:179], a[104:107]
  v_exp_f32 v212, v124
  v_mfma_f32_16x16x32_bf16 a[108:111], a[180:183], v[180:183], a[108:111]
  v_exp_f32 v213, v125
  v_mfma_f32_16x16x32_bf16 a[48:51], a[184:187], v[160:163], a[48:51]
  ds_read_b128 a[152:155], v3 offset:6144
  v_cvt_pk_bf16_f32 v172, v208, v209
  v_add_f32 v225, v225, v210
  v_add_f32 v225, v225, v211
  v_cvt_pk_bf16_f32 v173, v210, v211
  v_max3_f32 v5, v226, v227, v224
  v_mfma_f32_16x16x32_bf16 a[52:55], a[184:187], v[164:167], a[52:55]
  v_exp_f32 v214, v126
  v_mfma_f32_16x16x32_bf16 a[112:115], a[184:187], v[176:179], a[112:115]
  buffer_load_dwordx4 v2, s[44:47], s26 offen offset:3072 sc1 lds
  v_add_f32 v225, v225, v212
  v_add_f32 v225, v225, v213
  v_cvt_pk_bf16_f32 v174, v212, v213
  v_mfma_f32_16x16x32_bf16 a[116:119], a[184:187], v[180:183], a[116:119]
  s_add_u32 s26, s26, 16384
  v_exp_f32 v215, v127
  v_mfma_f32_16x16x32_bf16 a[56:59], a[188:191], v[160:163], a[56:59]
  s_add_u32 s24, s24, 32768
  ds_read_b128 a[156:159], v3 offset:7168
  v_add_f32 v225, v225, v214
  v_add_f32 v225, v225, v215
  v_max_f32 v5, v5, v225
  v_cmp_lt_f32 vcc, s81, v5
  v_mfma_f32_16x16x32_bf16 a[60:63], a[188:191], v[164:167], a[60:63]
  s_and_b32 s24, s24, 0x1ffff
  v_exp_f32 v216, v128
  v_mfma_f32_16x16x32_bf16 a[120:123], a[188:191], v[176:179], a[120:123]
  s_waitcnt lgkmcnt(4)
  v_cvt_pk_bf16_f32 v175, v214, v215
  v_mfma_f32_16x16x32_bf16 a[124:127], a[188:191], v[180:183], a[124:127]
  s_cbranch_vccnz fa_stub8
fa_back8:
  v_exp_f32 v217, v129
  v_add_f32 v228, v228, v224
  v_add_f32 v229, v229, v225
  v_add_f32 v230, v230, v226
  v_add_f32 v231, v231, v227
  v_mfma_f32_16x16x32_bf16 v[144:147], a[128:131], v[64:67], v[200:203]
  ds_read_b128 a[160:163], v3 offset:24576
  v_add_f32 v226, v216, v217
  v_mfma_f32_16x16x32_bf16 v[152:155], a[128:131], v[68:71], v[204:207]
  v_exp_f32 v218, v130
  v_mfma_f32_16x16x32_bf16 v[148:151], a[132:135], v[64:67], v[200:203]
  s_add_u32 s66, s66, 32768
  ds_read_b128 a[164:167], v3 offset:25600
  v_cvt_pk_bf16_f32 v176, v216, v217
  v_mfma_f32_16x16x32_bf16 v[156:159], a[132:135], v[68:71], v[204:207]
  s_and_b32 s66, s66, 0x1ffff
  v_exp_f32 v219, v131
  v_mfma_f32_16x16x32_bf16 v[144:147], a[136:139], v[72:75], v[144:147]
  ds_read_b128 a[168:171], v3 offset:26624
  v_add_f32 v226, v226, v218
  v_mfma_f32_16x16x32_bf16 v[152:155], a[136:139], v[76:79], v[152:155]
  s_mov_b32 m0, s25
  v_exp_f32 v220, v132
  v_mfma_f32_16x16x32_bf16 v[148:151], a[140:143], v[72:75], v[148:151]
  ds_read_b128 a[172:175], v3 offset:27648
  buffer_load_dwordx4 v2, s[48:51], s27 offen offset:0 sc1 lds
  v_add_f32 v226, v226, v219
  v_mfma_f32_16x16x32_bf16 v[156:159], a[140:143], v[76:79], v[156:159]
  s_waitcnt lgkmcnt(4)
  v_exp_f32 v221, v133
  v_mfma_f32_16x16x32_bf16 v[144:147], a[144:147], v[80:83], v[144:147]
  ds_read_b128 a[176:179], v3 offset:28672
  v_cvt_pk_bf16_f32 v177, v218, v219
  v_mfma_f32_16x16x32_bf16 v[152:155], a[144:147], v[84:87], v[152:155]
  v_exp_f32 v222, v134
  v_mfma_f32_16x16x32_bf16 v[148:151], a[148:151], v[80:83], v[148:151]
  ds_read_b128 a[180:183], v3 offset:29696
  v_add_f32 v226, v226, v220
  v_mfma_f32_16x16x32_bf16 v[156:159], a[148:151], v[84:87], v[156:159]
  v_exp_f32 v223, v135
  v_mfma_f32_16x16x32_bf16 v[144:147], a[152:155], v[88:91], v[144:147]
  ds_read_b128 a[184:187], v3 offset:30720
  v_add_f32 v226, v226, v221
  v_mfma_f32_16x16x32_bf16 v[152:155], a[152:155], v[92:95], v[152:155]
  v_exp_f32 v216, v136
  v_mfma_f32_16x16x32_bf16 v[148:151], a[156:159], v[88:91], v[148:151]
  ds_read_b128 a[188:191], v3 offset:31744
  v_cvt_pk_bf16_f32 v178, v220, v221
  v_mfma_f32_16x16x32_bf16 v[156:159], a[156:159], v[92:95], v[156:159]
  s_waitcnt lgkmcnt(4)
  v_exp_f32 v217, v137
  v_mfma_f32_16x16x32_bf16 a[0:3], a[160:163], v[168:171], a[0:3]
  ds_read_b128 a[128:131], v3 offset:8192
  v_add_f32 v226, v226, v222
  v_mfma_f32_16x16x32_bf16 a[4:7], a[160:163], v[172:175], a[4:7]
  v_exp_f32 v218, v138
  v_mfma_f32_16x16x32_bf16 a[64:67], a[160:163], v[184:187], a[64:67]
  buffer_load_dwordx4 v2, s[48:51], s27 offen offset:1024 sc1 lds
  v_add_f32 v226, v226, v223
  v_mfma_f32_16x16x32_bf16 a[68:71], a[160:163], v[188:191], a[68:71]
  v_exp_f32 v219, v139
  v_mfma_f32_16x16x32_bf16 a[8:11], a[164:167], v[168:171], a[8:11]
  ds_read_b128 a[132:135], v3 offset:9216
  v_cvt_pk_bf16_f32 v179, v222, v223
  v_mfma_f32_16x16x32_bf16 a[12:15], a[164:167], v[172:175], a[12:15]
  v_exp_f32 v220, v140
  v_mfma_f32_16x16x32_bf16 a[72:75], a[164:167], v[184:187], a[72:75]
  v_add_f32 v227, v216, v217
  v_cvt_pk_bf16_f32 v180, v216, v217
  v_mfma_f32_16x16x32_bf16 a[76:79], a[164:167], v[188:191], a[76:79]
  v_exp_f32 v221, v141
  v_mfma_f32_16x16x32_bf16 a[16:19], a[168:171], v[168:171], a[16:19]
  ds_read_b128 a[136:139], v3 offset:10240
  v_add_f32 v227, v227, v218
  v_mfma_f32_16x16x32_bf16 a[20:23], a[168:171], v[172:175], a[20:23]
  v_exp_f32 v222, v142
  v_mfma_f32_16x16x32_bf16 a[80:83], a[168:171], v[184:187], a[80:83]
  v_add_f32 v227, v227, v219
  v_cvt_pk_bf16_f32 v181, v218, v219
  v_mfma_f32_16x16x32_bf16 a[84:87], a[168:171], v[188:191], a[84:87]
  v_exp_f32 v223, v143
  v_mfma_f32_16x16x32_bf16 a[24:27], a[172:175], v[168:171], a[24:27]
  ds_read_b128 a[140:143], v3 offset:11264
  v_add_f32 v227, v227, v220
  v_mfma_f32_16x16x32_bf16 a[28:31], a[172:175], v[172:175], a[28:31]
  v_add_f32 v227, v227, v221
  v_cvt_pk_bf16_f32 v182, v220, v221
  v_mfma_f32_16x16x32_bf16 a[88:91], a[172:175], v[184:187], a[88:91]
  buffer_load_dwordx4 v2, s[48:51], s27 offen offset:2048 sc1 lds
  v_add_f32 v227, v227, v222
  v_mfma_f32_16x16x32_bf16 a[92:95], a[172:175], v[188:191], a[92:95]
  s_waitcnt lgkmcnt(4)
  v_add_f32 v227, v227, v223
  v_max_f32 v5, v226, v227
  v_mfma_f32_16x16x32_bf16 a[32:35], a[176:179], v[168:171], a[32:35]
  ds_read_b128 a[144:147], v3 offset:12288
  v_cmp_lt_f32 vcc, s81, v5
  v_mfma_f32_16x16x32_bf16 a[36:39], a[176:179], v[172:175], a[36:39]
  v_mfma_f32_16x16x32_bf16 a[96:99], a[176:179], v[184:187], a[96:99]
  v_mfma_f32_16x16x32_bf16 a[100:103], a[176:179], v[188:191], a[100:103]
  v_mfma_f32_16x16x32_bf16 a[40:43], a[180:183], v[168:171], a[40:43]
  ds_read_b128 a[148:151], v3 offset:13312
  v_mfma_f32_16x16x32_bf16 a[44:47], a[180:183], v[172:175], a[44:47]
  v_mfma_f32_16x16x32_bf16 a[104:107], a[180:183], v[184:187], a[104:107]
  v_mfma_f32_16x16x32_bf16 a[108:111], a[180:183], v[188:191], a[108:111]
  v_mfma_f32_16x16x32_bf16 a[48:51], a[184:187], v[168:171], a[48:51]
  ds_read_b128 a[152:155], v3 offset:14336
  v_mfma_f32_16x16x32_bf16 a[52:55], a[184:187], v[172:175], a[52:55]
  v_mfma_f32_16x16x32_bf16 a[112:115], a[184:187], v[184:187], a[112:115]
  buffer_load_dwordx4 v2, s[48:51], s27 offen offset:3072 sc1 lds
  v_mfma_f32_16x16x32_bf16 a[116:119], a[184:187], v[188:191], a[116:119]
  s_add_u32 s27, s27, 16384
  v_mfma_f32_16x16x32_bf16 a[56:59], a[188:191], v[168:171], a[56:59]
  s_add_u32 s25, s25, 32768
  ds_read_b128 a[156:159], v3 offset:15360
  v_mfma_f32_16x16x32_bf16 a[60:63], a[188:191], v[172:175], a[60:63]
  s_and_b32 s25, s25, 0x1ffff
  v_exp_f32 v216, v144
  v_mfma_f32_16x16x32_bf16 a[120:123], a[188:191], v[184:187], a[120:123]
  s_waitcnt lgkmcnt(4)
  v_cvt_pk_bf16_f32 v183, v222, v223
  v_add_u32 v3, s66, v2
  v_mfma_f32_16x16x32_bf16 a[124:127], a[188:191], v[188:191], a[124:127]
  s_cbranch_vccnz fa_stub9
fa_back9:
  v_exp_f32 v217, v145
  v_add_f32 v230, v230, v226
  v_add_f32 v231, v231, v227
fa_SSpre:
  s_mov_b32 s11, 1
  s_cmp_lg_u32 s12, 0
  s_cselect_b32 s32, s15, s32
  s_cmp_ge_u32 s20, 2
  s_cselect_b32 s23, 8, 0
  s_cmp_le_u32 s29, s23
  s_cbranch_scc1 fa_chain
.p2align 6
fa_SS:
  v_mfma_f32_16x16x32_bf16 v[128:131], a[128:131], v[64:67], v[200:203]
  s_waitcnt vmcnt(12)
  v_exp_f32 v218, v146
  v_mfma_f32_16x16x32_bf16 v[136:139], a[128:131], v[68:71], v[204:207]
  s_barrier
  v_exp_f32 v219, v147
  v_mfma_f32_16x16x32_bf16 v[132:135], a[132:135], v[64:67], v[200:203]
  s_cmp_ge_u32 s26, s32
  ds_read_b128 a[160:163], v3 offset:16384
  ds_read_b128 a[164:167], v3 offset:17408
  v_add_f32 v226, v216, v217
  v_mfma_f32_16x16x32_bf16 v[140:143], a[132:135], v[68:71], v[204:207]
  s_cbranch_scc1 fa_hk7
fa_hb7:
  v_exp_f32 v220, v148
  v_mfma_f32_16x16x32_bf16 v[128:131], a[136:139], v[72:75], v[128:131]
  ds_read_b128 a[168:171], v3 offset:18432
  v_cvt_pk_bf16_f32 v184, v216, v217
  v_mfma_f32_16x16x32_bf16 v[136:139], a[136:139], v[76:79], v[136:139]
  s_mov_b32 m0, s24
  v_exp_f32 v221, v149
  v_mfma_f32_16x16x32_bf16 v[132:135], a[140:143], v[72:75], v[132:135]
  ds_read_b128 a[172:175], v3 offset:19456
  buffer_load_dwordx4 v2, s[44:47], s26 offen offset:0 sc1 lds
  v_add_f32 v226, v226, v218
  v_add_f32 v226, v226, v219
  v_mfma_f32_16x16x32_bf16 v[140:143], a[140:143], v[76:79], v[140:143]
  s_waitcnt lgkmcnt(4)
  v_exp_f32 v222, v150
  v_mfma_f32_16x16x32_bf16 v[128:131], a[144:147], v[80:83], v[128:131]
  ds_read_b128 a[176:179], v3 offset:20480
  v_cvt_pk_bf16_f32 v185, v218, v219
  v_mfma_f32_16x16x32_bf16 v[136:139], a[144:147], v[84:87], v[136:139]
  v_exp_f32 v223, v151
  v_mfma_f32_16x16x32_bf16 v[132:135], a[148:151], v[80:83], v[132:135]
  ds_read_b128 a[180:183], v3 offset:21504
  v_add_f32 v226, v226, v220
  v_mfma_f32_16x16x32_bf16 v[140:143], a[148:151], v[84:87], v[140:143]
  v_exp_f32 v216, v152
  v_mfma_f32_16x16x32_bf16 v[128:131], a[152:155], v[88:91], v[128:131]
  ds_read_b128 a[184:187], v3 offset:22528
  buffer_load_dwordx4 v2, s[44:47], s26 offen offset:1024 sc1 lds
  v_add_f32 v226, v226, v221
  v_cvt_pk_bf16_f32 v186, v220, v221
  v_mfma_f32_16x16x32_bf16 v[136:139], a[152:155], v[92:95], v[136:139]
  v_exp_f32 v217, v153
  v_mfma_f32_16x16x32_bf16 v[132:135], a[156:159], v[88:91], v[132:135]
  ds_read_b128 a[188:191], v3 offset:23552
  v_add_f32 v226, v226, v222
  v_mfma_f32_16x16x32_bf16 v[140:143], a[156:159], v[92:95], v[140:143]
  s_waitcnt lgkmcnt(4)
  v_exp_f32 v218, v154
  v_mfma_f32_16x16x32_bf16 a[64:67], a[160:163], v[176:179], a[64:67]
  ds_read_b128 a[128:131], v3 offset:0
  v_add_f32 v226, v226, v223
  v_cvt_pk_bf16_f32 v187, v222, v223
  v_mfma_f32_16x16x32_bf16 a[68:71], a[160:163], v[180:183], a[68:71]
  v_exp_f32 v219, v155
  v_mfma_f32_16x16x32_bf16 a[72:75], a[164:167], v[176:179], a[72:75]
  ds_read_b128 a[132:135], v3 offset:1024
  buffer_load_dwordx4 v2, s[44:47], s26 offen offset:2048 sc1 lds
  v_add_f32 v227, v216, v217
  v_mfma_f32_16x16x32_bf16 a[76:79], a[164:167], v[180:183], a[76:79]
  v_exp_f32 v220, v156
  v_mfma_f32_16x16x32_bf16 a[80:83], a[168:171], v[176:179], a[80:83]
  ds_read_b128 a[136:139], v3 offset:2048
  v_cvt_pk_bf16_f32 v188, v216, v217
  v_mfma_f32_16x16x32_bf16 a[84:87], a[168:171], v[180:183], a[84:87]
  v_exp_f32 v221, v157
  v_mfma_f32_16x16x32_bf16 a[88:91], a[172:175], v[176:179], a[88:91]
  ds_read_b128 a[140:143], v3 offset:3072
  v_add_f32 v227, v227, v218
  v_add_f32 v227, v227, v219
  v_mfma_f32_16x16x32_bf16 a[92:95], a[172:175], v[180:183], a[92:95]
  s_waitcnt lgkmcnt(4)
  v_exp_f32 v222, v158
  v_mfma_f32_16x16x32_bf16 a[96:99], a[176:179], v[176:179], a[96:99]
  ds_read_b128 a[144:147], v3 offset:4096
  buffer_load_dwordx4 v2, s[44:47], s26 offen offset:3072 sc1 lds
  v_cvt_pk_bf16_f32 v189, v218, v219
  v_mfma_f32_16x16x32_bf16 a[100:103], a[176:179], v[180:183], a[100:103]
  s_add_u32 s26, s26, 16384
  v_exp_f32 v223, v159
  v_mfma_f32_16x16x32_bf16 a[104:107], a[180:183], v[176:179], a[104:107]
  s_add_u32 s24, s24, 32768
  ds_read_b128 a[148:151], v3 offset:5120
  v_add_f32 v227, v227, v220
  v_mfma_f32_16x16x32_bf16 a[108:111], a[180:183], v[180:183], a[108:111]
  s_and_b32 s24, s24, 0x1ffff
  v_add_f32 v227, v227, v221
  v_cvt_pk_bf16_f32 v190, v220, v221
  v_add_f32 v227, v227, v222
  v_mfma_f32_16x16x32_bf16 a[112:115], a[184:187], v[176:179], a[112:115]
  ds_read_b128 a[152:155], v3 offset:6144
  v_add_f32 v227, v227, v223
  v_max_f32 v5, v226, v227
  v_cmp_lt_f32 vcc, s81, v5
  v_mfma_f32_16x16x32_bf16 a[116:119], a[184:187], v[180:183], a[116:119]
  v_exp_f32 v216, v128
  v_mfma_f32_16x16x32_bf16 a[120:123], a[188:191], v[176:179], a[120:123]
  s_waitcnt lgkmcnt(3)
  ds_read_b128 a[156:159], v3 offset:7168
  v_cvt_pk_bf16_f32 v191, v222, v223
  v_mfma_f32_16x16x32_bf16 a[124:127], a[188:191], v[180:183], a[124:127]
  s_cbranch_vccnz fa_stub10
fa_back10:
  v_exp_f32 v217, v129
  v_add_f32 v230, v230, v226
  v_add_f32 v231, v231, v227
  v_mfma_f32_16x16x32_bf16 v[144:147], a[128:131], v[64:67], v[200:203]
  ds_read_b128 a[160:163], v3 offset:24576
  v_add_f32 v226, v216, v217
  v_mfma_f32_16x16x32_bf16 v[152:155], a[128:131], v[68:71], v[204:207]
  v_exp_f32 v218, v130
  v_mfma_f32_16x16x32_bf16 v[148:151], a[132:135], v[64:67], v[200:203]
  s_add_u32 s66, s66, 32768
  ds_read_b128 a[164:167], v3 offset:25600
  v_cvt_pk_bf16_f32 v176, v216, v217
  v_mfma_f32_16x16x32_bf16 v[156:159], a[132:135], v[68:71], v[204:207]
  s_mov_b32 m0, s25
  v_exp_f32 v219, v131
  v_mfma_f32_16x16x32_bf16 v[144:147], a[136:139], v[72:75], v[144:147]
  s_and_b32 s66, s66, 0x1ffff
  ds_read_b128 a[168:171], v3 offset:26624
  buffer_load_dwordx4 v2, s[48:51], s27 offen offset:0 sc1 lds
  v_add_f32 v226, v226, v218
  v_add_f32 v226, v226, v219
  v_mfma_f32_16x16x32_bf16 v[152:155], a[136:139], v[76:79], v[152:155]
  v_exp_f32 v220, v132
  v_mfma_f32_16x16x32_bf16 v[148:151], a[140:143], v[72:75], v[148:151]
  ds_read_b128 a[172:175], v3 offset:27648
  v_cvt_pk_bf16_f32 v177, v218, v219
  v_mfma_f32_16x16x32_bf16 v[156:159], a[140:143], v[76:79], v[156:159]
  s_waitcnt lgkmcnt(4)
  v_exp_f32 v221, v133
  v_mfma_f32_16x16x32_bf16 v[144:147], a[144:147], v[80:83], v[144:147]
  ds_read_b128 a[176:179], v3 offset:28672
  v_add_f32 v226, v226, v220
  v_mfma_f32_16x16x32_bf16 v[152:155], a[144:147], v[84:87], v[152:155]
  v_exp_f32 v222, v134
  v_mfma_f32_16x16x32_bf16 v[148:151], a[148:151], v[80:83], v[148:151]
  ds_read_b128 a[180:183], v3 offset:29696
  buffer_load_dwordx4 v2, s[48:51], s27 offen offset:1024 sc1 lds
  v_add_f32 v226, v226, v221
  v_cvt_pk_bf16_f32 v178, v220, v221
  v_mfma_f32_16x16x32_bf16 v[156:159], a[148:151], v[84:87], v[156:159]
  v_exp_f32 v223, v135
  v_mfma_f32_16x16x32_bf16 v[144:147], a[152:155], v[88:91], v[144:147]
  ds_read_b128 a[184:187], v3 offset:30720
  v_add_f32 v226, v226, v222
  v_mfma_f32_16x16x32_bf16 v[152:155], a[152:155], v[92:95], v[152:155]
  v_exp_f32 v216, v136
  v_mfma_f32_16x16x32_bf16 v[148:151], a[156:159], v[88:91], v[148:151]
  ds_read_b128 a[188:191], v3 offset:31744
  v_add_f32 v226, v226, v223
  v_exp_f32 v217, v137
  v_mfma_f32_16x16x32_bf16 v[156:159], a[156:159], v[92:95], v[156:159]
  s_waitcnt lgkmcnt(4)
  v_exp_f32 v218, v138
  v_mfma_f32_16x16x32_bf16 a[64:67], a[160:163], v[184:187], a[64:67]
  ds_read_b128 a[128:131], v3 offset:8192
  v_cvt_pk_bf16_f32 v179, v222, v223
  v_mfma_f32_16x16x32_bf16 a[68:71], a[160:163], v[188:191], a[68:71]
  v_exp_f32 v219, v139
  v_mfma_f32_16x16x32_bf16 a[72:75], a[164:167], v[184:187], a[72:75]
  ds_read_b128 a[132:135], v3 offset:9216
  buffer_load_dwordx4 v2, s[48:51], s27 offen offset:2048 sc1 lds
  v_add_f32 v227, v216, v217
  v_mfma_f32_16x16x32_bf16 a[76:79], a[164:167], v[188:191], a[76:79]
  v_exp_f32 v220, v140
  v_mfma_f32_16x16x32_bf16 a[80:83], a[168:171], v[184:187], a[80:83]
  ds_read_b128 a[136:139], v3 offset:10240
  v_cvt_pk_bf16_f32 v180, v216, v217
  v_mfma_f32_16x16x32_bf16 a[84:87], a[168:171], v[188:191], a[84:87]
  v_exp_f32 v221, v141
  v_mfma_f32_16x16x32_bf16 a[88:91], a[172:175], v[184:187], a[88:91]
  ds_read_b128 a[140:143], v3 offset:11264
  v_add_f32 v227, v227, v218
  v_mfma_f32_16x16x32_bf16 a[92:95], a[172:175], v[188:191], a[92:95]
  s_waitcnt lgkmcnt(4)
  v_exp_f32 v222, v142
  v_mfma_f32_16x16x32_bf16 a[96:99], a[176:179], v[184:187], a[96:99]
  ds_read_b128 a[144:147], v3 offset:12288
  buffer_load_dwordx4 v2, s[48:51], s27 offen offset:3072 sc1 lds
  v_add_f32 v227, v227, v219
  v_cvt_pk_bf16_f32 v181, v218, v219
  v_mfma_f32_16x16x32_bf16 a[100:103], a[176:179], v[188:191], a[100:103]
  s_add_u32 s27, s27, 16384
  v_exp_f32 v223, v143
  v_mfma_f32_16x16x32_bf16 a[104:107], a[180:183], v[184:187], a[104:107]
  s_add_u32 s25, s25, 32768
  ds_read_b128 a[148:151], v3 offset:13312
  v_add_f32 v227, v227, v220
  v_mfma_f32_16x16x32_bf16 a[108:111], a[180:183], v[188:191], a[108:111]
  s_and_b32 s25, s25, 0x1ffff
  v_add_f32 v227, v227, v221
  v_cvt_pk_bf16_f32 v182, v220, v221
  v_add_f32 v227, v227, v222
  v_mfma_f32_16x16x32_bf16 a[112:115], a[184:187], v[184:187], a[112:115]
  s_sub_u32 s29, s29, 1
  ds_read_b128 a[152:155], v3 offset:14336
  v_add_f32 v227, v227, v223
  v_max_f32 v5, v226, v227
  v_cmp_lt_f32 vcc, s81, v5
  v_mfma_f32_16x16x32_bf16 a[116:119], a[184:187], v[188:191], a[116:119]
  s_cmp_gt_u32 s29, 8
  v_exp_f32 v216, v144
  v_mfma_f32_16x16x32_bf16 a[120:123], a[188:191], v[184:187], a[120:123]
  s_waitcnt lgkmcnt(3)
  ds_read_b128 a[156:159], v3 offset:15360
  v_cvt_pk_bf16_f32 v183, v222, v223
  v_add_u32 v3, s66, v2
  v_mfma_f32_16x16x32_bf16 a[124:127], a[188:191], v[188:191], a[124:127]
  s_cbranch_vccnz fa_stub11
fa_back11:
  v_exp_f32 v217, v145
  v_add_f32 v230, v230, v226
  v_add_f32 v231, v231, v227
  s_cbranch_scc1 fa_SS
fa_chain:
  s_setprio 3
fa_hb8:
  s_cmp_lt_u32 s12, 2
  s_cbranch_scc1 fa_hk8
  s_cmp_eq_u32 s29, 8
  s_cbranch_scc0 fa_disp
fa_SSW8:
  v_mfma_f32_16x16x32_bf16 v[128:131], a[128:131], v[64:67], v[200:203]
  s_waitcnt vmcnt(12)
  v_exp_f32 v218, v146
  v_mfma_f32_16x16x32_bf16 v[136:139], a[128:131], v[68:71], v[204:207]
  s_barrier
  v_exp_f32 v219, v147
  v_mfma_f32_16x16x32_bf16 v[132:135], a[132:135], v[64:67], v[200:203]
  ds_read_b128 a[160:163], v3 offset:16384
  ds_read_b128 a[164:167], v3 offset:17408
  v_add_f32 v226, v216, v217
  v_mfma_f32_16x16x32_bf16 v[140:143], a[132:135], v[68:71], v[204:207]
  s_mov_b32 m0, s24
  v_exp_f32 v220, v148
  v_mfma_f32_16x16x32_bf16 v[128:131], a[136:139], v[72:75], v[128:131]
  ds_read_b128 a[168:171], v3 offset:18432
  buffer_load_dwordx4 v2, s[44:47], s26 offen offset:0 sc1 lds
  v_cvt_pk_bf16_f32 v184, v216, v217
  v_mfma_f32_16x16x32_bf16 v[136:139], a[136:139], v[76:79], v[136:139]
  v_exp_f32 v221, v149
  v_mfma_f32_16x16x32_bf16 v[132:135], a[140:143], v[72:75], v[132:135]
  ds_read_b128 a[172:175], v3 offset:19456
  v_add_f32 v226, v226, v218
  v_add_f32 v226, v226, v219
  v_mfma_f32_16x16x32_bf16 v[140:143], a[140:143], v[76:79], v[140:143]
  s_waitcnt lgkmcnt(4)
  v_exp_f32 v222, v150
  v_mfma_f32_16x16x32_bf16 v[128:131], a[144:147], v[80:83], v[128:131]
  ds_read_b128 a[176:179], v3 offset:20480
  v_cvt_pk_bf16_f32 v185, v218, v219
  v_mfma_f32_16x16x32_bf16 v[136:139], a[144:147], v[84:87], v[136:139]
  v_exp_f32 v223, v151
  v_mfma_f32_16x16x32_bf16 v[132:135], a[148:151], v[80:83], v[132:135]
  ds_read_b128 a[180:183], v3 offset:21504
  buffer_load_dwordx4 v2, s[44:47], s26 offen offset:1024 sc1 lds
  v_add_f32 v226, v226, v220
  v_mfma_f32_16x16x32_bf16 v[140:143], a[148:151], v[84:87], v[140:143]
  v_exp_f32 v216, v152
  v_mfma_f32_16x16x32_bf16 v[128:131], a[152:155], v[88:91], v[128:131]
  ds_read_b128 a[184:187], v3 offset:22528
  v_add_f32 v226, v226, v221
  v_cvt_pk_bf16_f32 v186, v220, v221
  v_mfma_f32_16x16x32_bf16 v[136:139], a[152:155], v[92:95], v[136:139]
  v_exp_f32 v217, v153
  v_mfma_f32_16x16x32_bf16 v[132:135], a[156:159], v[88:91], v[132:135]
  s_add_u32 s14, s13, 77824
  ds_read_b128 a[188:191], v3 offset:23552
  buffer_load_dwordx4 a[252:255], v2, s[40:43], s14 offen offset:3072 sc1
  v_add_f32 v226, v226, v222
  v_mfma_f32_16x16x32_bf16 v[140:143], a[156:159], v[92:95], v[140:143]
  s_waitcnt lgkmcnt(4)
  v_exp_f32 v218, v154
  v_mfma_f32_16x16x32_bf16 a[64:67], a[160:163], v[176:179], a[64:67]
  ds_read_b128 a[128:131], v3 offset:0
  v_add_f32 v226, v226, v223
  v_cvt_pk_bf16_f32 v187, v222, v223
  v_mfma_f32_16x16x32_bf16 a[68:71], a[160:163], v[180:183], a[68:71]
  v_exp_f32 v219, v155
  v_mfma_f32_16x16x32_bf16 a[72:75], a[164:167], v[176:179], a[72:75]
  ds_read_b128 a[132:135], v3 offset:1024
  buffer_load_dwordx4 v2, s[44:47], s26 offen offset:2048 sc1 lds
  v_add_f32 v227, v216, v217
  v_mfma_f32_16x16x32_bf16 a[76:79], a[164:167], v[180:183], a[76:79]
  v_exp_f32 v220, v156
  v_mfma_f32_16x16x32_bf16 a[80:83], a[168:171], v[176:179], a[80:83]
  ds_read_b128 a[136:139], v3 offset:2048
  v_cvt_pk_bf16_f32 v188, v216, v217
  v_mfma_f32_16x16x32_bf16 a[84:87], a[168:171], v[180:183], a[84:87]
  v_exp_f32 v221, v157
  v_mfma_f32_16x16x32_bf16 a[88:91], a[172:175], v[176:179], a[88:91]
  ds_read_b128 a[140:143], v3 offset:3072
  v_add_f32 v227, v227, v218
  v_add_f32 v227, v227, v219
  v_mfma_f32_16x16x32_bf16 a[92:95], a[172:175], v[180:183], a[92:95]
  s_waitcnt lgkmcnt(4)
  v_exp_f32 v222, v158
  v_mfma_f32_16x16x32_bf16 a[96:99], a[176:179], v[176:179], a[96:99]
  ds_read_b128 a[144:147], v3 offset:4096
  buffer_load_dwordx4 v2, s[44:47], s26 offen offset:3072 sc1 lds
  v_cvt_pk_bf16_f32 v189, v218, v219
  v_mfma_f32_16x16x32_bf16 a[100:103], a[176:179], v[180:183], a[100:103]
  s_add_u32 s26, s26, 16384
  v_exp_f32 v223, v159
  v_mfma_f32_16x16x32_bf16 a[104:107], a[180:183], v[176:179], a[104:107]
  s_add_u32 s24, s24, 32768
  ds_read_b128 a[148:151], v3 offset:5120
  v_add_f32 v227, v227, v220
  v_mfma_f32_16x16x32_bf16 a[108:111], a[180:183], v[180:183], a[108:111]
  s_and_b32 s24, s24, 0x1ffff
  v_add_f32 v227, v227, v221
  v_cvt_pk_bf16_f32 v190, v220, v221
  v_add_f32 v227, v227, v222
  v_mfma_f32_16x16x32_bf16 a[112:115], a[184:187], v[176:179], a[112:115]
  ds_read_b128 a[152:155], v3 offset:6144
  v_add_f32 v227, v227, v223
  v_max_f32 v5, v226, v227
  v_cmp_lt_f32 vcc, s81, v5
  v_mfma_f32_16x16x32_bf16 a[116:119], a[184:187], v[180:183], a[116:119]
  v_exp_f32 v216, v128
  v_mfma_f32_16x16x32_bf16 a[120:123], a[188:191], v[176:179], a[120:123]
  s_waitcnt lgkmcnt(3)
  ds_read_b128 a[156:159], v3 offset:7168
  v_cvt_pk_bf16_f32 v191, v222, v223
  v_mfma_f32_16x16x32_bf16 a[124:127], a[188:191], v[180:183], a[124:127]
  s_cbranch_vccnz fa_stub12
fa_back12:
  v_exp_f32 v217, v129
  v_add_f32 v230, v230, v226
  v_add_f32 v231, v231, v227
  v_mfma_f32_16x16x32_bf16 v[144:147], a[128:131], v[64:67], v[200:203]
  ds_read_b128 a[160:163], v3 offset:24576
  v_add_f32 v226, v216, v217
  v_mfma_f32_16x16x32_bf16 v[152:155], a[128:131], v[68:71], v[204:207]
  v_exp_f32 v218, v130
  v_mfma_f32_16x16x32_bf16 v[148:151], a[132:135], v[64:67], v[200:203]
  s_add_u32 s66, s66, 32768
  ds_read_b128 a[164:167], v3 offset:25600
  v_cvt_pk_bf16_f32 v176, v216, v217
  v_mfma_f32_16x16x32_bf16 v[156:159], a[132:135], v[68:71], v[204:207]
  s_mov_b32 m0, s25
  v_exp_f32 v219, v131
  v_mfma_f32_16x16x32_bf16 v[144:147], a[136:139], v[72:75], v[144:147]
  s_and_b32 s66, s66, 0x1ffff
  ds_read_b128 a[168:171], v3 offset:26624
  buffer_load_dwordx4 v2, s[48:51], s27 offen offset:0 sc1 lds
  v_add_f32 v226, v226, v218
  v_add_f32 v226, v226, v219
  v_mfma_f32_16x16x32_bf16 v[152:155], a[136:139], v[76:79], v[152:155]
  v_exp_f32 v220, v132
  v_mfma_f32_16x16x32_bf16 v[148:151], a[140:143], v[72:75], v[148:151]
  ds_read_b128 a[172:175], v3 offset:27648
  v_cvt_pk_bf16_f32 v177, v218, v219
  v_mfma_f32_16x16x32_bf16 v[156:159], a[140:143], v[76:79], v[156:159]
  s_waitcnt lgkmcnt(4)
  v_exp_f32 v221, v133
  v_mfma_f32_16x16x32_bf16 v[144:147], a[144:147], v[80:83], v[144:147]
  s_add_u32 s14, s13, 77824
  ds_read_b128 a[176:179], v3 offset:28672
  buffer_load_dwordx4 a[248:251], v2, s[40:43], s14 offen offset:2048 sc1
  v_add_f32 v226, v226, v220
  v_mfma_f32_16x16x32_bf16 v[152:155], a[144:147], v[84:87], v[152:155]
  v_exp_f32 v222, v134
  v_mfma_f32_16x16x32_bf16 v[148:151], a[148:151], v[80:83], v[148:151]
  ds_read_b128 a[180:183], v3 offset:29696
  buffer_load_dwordx4 v2, s[48:51], s27 offen offset:1024 sc1 lds
  v_add_f32 v226, v226, v221
  v_cvt_pk_bf16_f32 v178, v220, v221
  v_mfma_f32_16x16x32_bf16 v[156:159], a[148:151], v[84:87], v[156:159]
  v_exp_f32 v223, v135
  v_mfma_f32_16x16x32_bf16 v[144:147], a[152:155], v[88:91], v[144:147]
  ds_read_b128 a[184:187], v3 offset:30720
  v_add_f32 v226, v226, v222
  v_mfma_f32_16x16x32_bf16 v[152:155], a[152:155], v[92:95], v[152:155]
  v_exp_f32 v216, v136
  v_mfma_f32_16x16x32_bf16 v[148:151], a[156:159], v[88:91], v[148:151]
  ds_read_b128 a[188:191], v3 offset:31744
  v_add_f32 v226, v226, v223
  v_exp_f32 v217, v137
  v_mfma_f32_16x16x32_bf16 v[156:159], a[156:159], v[92:95], v[156:159]
  s_waitcnt lgkmcnt(4)
  v_exp_f32 v218, v138
  v_mfma_f32_16x16x32_bf16 a[64:67], a[160:163], v[184:187], a[64:67]
  ds_read_b128 a[128:131], v3 offset:8192
  v_cvt_pk_bf16_f32 v179, v222, v223
  v_mfma_f32_16x16x32_bf16 a[68:71], a[160:163], v[188:191], a[68:71]
  v_exp_f32 v219, v139
  v_mfma_f32_16x16x32_bf16 a[72:75], a[164:167], v[184:187], a[72:75]
  ds_read_b128 a[132:135], v3 offset:9216
  buffer_load_dwordx4 v2, s[48:51], s27 offen offset:2048 sc1 lds
  v_add_f32 v227, v216, v217
  v_mfma_f32_16x16x32_bf16 a[76:79], a[164:167], v[188:191], a[76:79]
  v_exp_f32 v220, v140
  v_mfma_f32_16x16x32_bf16 a[80:83], a[168:171], v[184:187], a[80:83]
  ds_read_b128 a[136:139], v3 offset:10240
  v_cvt_pk_bf16_f32 v180, v216, v217
  v_mfma_f32_16x16x32_bf16 a[84:87], a[168:171], v[188:191], a[84:87]
  v_exp_f32 v221, v141
  v_mfma_f32_16x16x32_bf16 a[88:91], a[172:175], v[184:187], a[88:91]
  ds_read_b128 a[140:143], v3 offset:11264
  buffer_load_dwordx4 a[244:247], v2, s[40:43], s14 offen offset:1024 sc1
  v_add_f32 v227, v227, v218
  v_mfma_f32_16x16x32_bf16 a[92:95], a[172:175], v[188:191], a[92:95]
  s_waitcnt lgkmcnt(4)
  v_exp_f32 v222, v142
  v_mfma_f32_16x16x32_bf16 a[96:99], a[176:179], v[184:187], a[96:99]
  ds_read_b128 a[144:147], v3 offset:12288
  buffer_load_dwordx4 v2, s[48:51], s27 offen offset:3072 sc1 lds
  v_add_f32 v227, v227, v219
  v_cvt_pk_bf16_f32 v181, v218, v219
  v_mfma_f32_16x16x32_bf16 a[100:103], a[176:179], v[188:191], a[100:103]
  s_add_u32 s27, s27, 16384
  v_exp_f32 v223, v143
  v_mfma_f32_16x16x32_bf16 a[104:107], a[180:183], v[184:187], a[104:107]
  s_add_u32 s25, s25, 32768
  ds_read_b128 a[148:151], v3 offset:13312
  v_add_f32 v227, v227, v220
  v_mfma_f32_16x16x32_bf16 a[108:111], a[180:183], v[188:191], a[108:111]
  s_and_b32 s25, s25, 0x1ffff
  v_add_f32 v227, v227, v221
  v_cvt_pk_bf16_f32 v182, v220, v221
  v_add_f32 v227, v227, v222
  v_mfma_f32_16x16x32_bf16 a[112:115], a[184:187], v[184:187], a[112:115]
  ds_read_b128 a[152:155], v3 offset:14336
  v_add_f32 v227, v227, v223
  v_max_f32 v5, v226, v227
  v_cmp_lt_f32 vcc, s81, v5
  v_mfma_f32_16x16x32_bf16 a[116:119], a[184:187], v[188:191], a[116:119]
  v_exp_f32 v216, v144
  v_mfma_f32_16x16x32_bf16 a[120:123], a[188:191], v[184:187], a[120:123]
  s_waitcnt lgkmcnt(3)
  ds_read_b128 a[156:159], v3 offset:15360
  v_cvt_pk_bf16_f32 v183, v222, v223
  v_add_u32 v3, s66, v2
  v_mfma_f32_16x16x32_bf16 a[124:127], a[188:191], v[188:191], a[124:127]
  s_cbranch_vccnz fa_stub13
fa_back13:
  v_exp_f32 v217, v145
  v_add_f32 v230, v230, v226
  v_add_f32 v231, v231, v227
fa_SSW7:
  v_mfma_f32_16x16x32_bf16 v[128:131], a[128:131], v[64:67], v[200:203]
  s_waitcnt vmcnt(12)
  v_exp_f32 v218, v146
  v_mfma_f32_16x16x32_bf16 v[136:139], a[128:131], v[68:71], v[204:207]
  s_barrier
  v_exp_f32 v219, v147
  v_mfma_f32_16x16x32_bf16 v[132:135], a[132:135], v[64:67], v[200:203]
  ds_read_b128 a[160:163], v3 offset:16384
  ds_read_b128 a[164:167], v3 offset:17408
  v_add_f32 v226, v216, v217
  v_mfma_f32_16x16x32_bf16 v[140:143], a[132:135], v[68:71], v[204:207]
  s_mov_b32 m0, s24
  v_exp_f32 v220, v148
  v_mfma_f32_16x16x32_bf16 v[128:131], a[136:139], v[72:75], v[128:131]
  ds_read_b128 a[168:171], v3 offset:18432
  buffer_load_dwordx4 v2, s[44:47], s26 offen offset:0 sc1 lds
  v_cvt_pk_bf16_f32 v184, v216, v217
  v_mfma_f32_16x16x32_bf16 v[136:139], a[136:139], v[76:79], v[136:139]
  v_exp_f32 v221, v149
  v_mfma_f32_16x16x32_bf16 v[132:135], a[140:143], v[72:75], v[132:135]
  ds_read_b128 a[172:175], v3 offset:19456
  v_add_f32 v226, v226, v218
  v_add_f32 v226, v226, v219
  v_mfma_f32_16x16x32_bf16 v[140:143], a[140:143], v[76:79], v[140:143]
  s_waitcnt lgkmcnt(4)
  v_exp_f32 v222, v150
  v_mfma_f32_16x16x32_bf16 v[128:131], a[144:147], v[80:83], v[128:131]
  ds_read_b128 a[176:179], v3 offset:20480
  v_cvt_pk_bf16_f32 v185, v218, v219
  v_mfma_f32_16x16x32_bf16 v[136:139], a[144:147], v[84:87], v[136:139]
  v_exp_f32 v223, v151
  v_mfma_f32_16x16x32_bf16 v[132:135], a[148:151], v[80:83], v[132:135]
  ds_read_b128 a[180:183], v3 offset:21504
  buffer_load_dwordx4 v2, s[44:47], s26 offen offset:1024 sc1 lds
  v_add_f32 v226, v226, v220
  v_mfma_f32_16x16x32_bf16 v[140:143], a[148:151], v[84:87], v[140:143]
  v_exp_f32 v216, v152
  v_mfma_f32_16x16x32_bf16 v[128:131], a[152:155], v[88:91], v[128:131]
  ds_read_b128 a[184:187], v3 offset:22528
  v_add_f32 v226, v226, v221
  v_cvt_pk_bf16_f32 v186, v220, v221
  v_mfma_f32_16x16x32_bf16 v[136:139], a[152:155], v[92:95], v[136:139]
  v_exp_f32 v217, v153
  v_mfma_f32_16x16x32_bf16 v[132:135], a[156:159], v[88:91], v[132:135]
  s_add_u32 s14, s13, 77824
  ds_read_b128 a[188:191], v3 offset:23552
  buffer_load_dwordx4 a[240:243], v2, s[40:43], s14 offen offset:0 sc1
  v_add_f32 v226, v226, v222
  v_mfma_f32_16x16x32_bf16 v[140:143], a[156:159], v[92:95], v[140:143]
  s_waitcnt lgkmcnt(4)
  v_exp_f32 v218, v154
  v_mfma_f32_16x16x32_bf16 a[64:67], a[160:163], v[176:179], a[64:67]
  ds_read_b128 a[128:131], v3 offset:0
  v_add_f32 v226, v226, v223
  v_cvt_pk_bf16_f32 v187, v222, v223
  v_mfma_f32_16x16x32_bf16 a[68:71], a[160:163], v[180:183], a[68:71]
  v_exp_f32 v219, v155
  v_mfma_f32_16x16x32_bf16 a[72:75], a[164:167], v[176:179], a[72:75]
  ds_read_b128 a[132:135], v3 offset:1024
  buffer_load_dwordx4 v2, s[44:47], s26 offen offset:2048 sc1 lds
  v_add_f32 v227, v216, v217
  v_mfma_f32_16x16x32_bf16 a[76:79], a[164:167], v[180:183], a[76:79]
  v_exp_f32 v220, v156
  v_mfma_f32_16x16x32_bf16 a[80:83], a[168:171], v[176:179], a[80:83]
  ds_read_b128 a[136:139], v3 offset:2048
  v_cvt_pk_bf16_f32 v188, v216, v217
  v_mfma_f32_16x16x32_bf16 a[84:87], a[168:171], v[180:183], a[84:87]
  v_exp_f32 v221, v157
  v_mfma_f32_16x16x32_bf16 a[88:91], a[172:175], v[176:179], a[88:91]
  ds_read_b128 a[140:143], v3 offset:3072
  v_add_f32 v227, v227, v218
  v_add_f32 v227, v227, v219
  v_mfma_f32_16x16x32_bf16 a[92:95], a[172:175], v[180:183], a[92:95]
  s_waitcnt lgkmcnt(4)
  v_exp_f32 v222, v158
  v_mfma_f32_16x16x32_bf16 a[96:99], a[176:179], v[176:179], a[96:99]
  ds_read_b128 a[144:147], v3 offset:4096
  buffer_load_dwordx4 v2, s[44:47], s26 offen offset:3072 sc1 lds
  v_cvt_pk_bf16_f32 v189, v218, v219
  v_mfma_f32_16x16x32_bf16 a[100:103], a[176:179], v[180:183], a[100:103]
  s_add_u32 s26, s26, 16384
  v_exp_f32 v223, v159
  v_mfma_f32_16x16x32_bf16 a[104:107], a[180:183], v[176:179], a[104:107]
  s_add_u32 s24, s24, 32768
  ds_read_b128 a[148:151], v3 offset:5120
  v_add_f32 v227, v227, v220
  v_mfma_f32_16x16x32_bf16 a[108:111], a[180:183], v[180:183], a[108:111]
  s_and_b32 s24, s24, 0x1ffff
  v_add_f32 v227, v227, v221
  v_cvt_pk_bf16_f32 v190, v220, v221
  v_add_f32 v227, v227, v222
  v_mfma_f32_16x16x32_bf16 a[112:115], a[184:187], v[176:179], a[112:115]
  ds_read_b128 a[152:155], v3 offset:6144
  v_add_f32 v227, v227, v223
  v_max_f32 v5, v226, v227
  v_cmp_lt_f32 vcc, s81, v5
  v_mfma_f32_16x16x32_bf16 a[116:119], a[184:187], v[180:183], a[116:119]
  v_exp_f32 v216, v128
  v_mfma_f32_16x16x32_bf16 a[120:123], a[188:191], v[176:179], a[120:123]
  s_waitcnt lgkmcnt(3)
  ds_read_b128 a[156:159], v3 offset:7168
  v_cvt_pk_bf16_f32 v191, v222, v223
  v_mfma_f32_16x16x32_bf16 a[124:127], a[188:191], v[180:183], a[124:127]
  s_cbranch_vccnz fa_stub14
fa_back14:
  v_exp_f32 v217, v129
  v_add_f32 v230, v230, v226
  v_add_f32 v231, v231, v227
  v_mfma_f32_16x16x32_bf16 v[144:147], a[128:131], v[64:67], v[200:203]
  ds_read_b128 a[160:163], v3 offset:24576
  v_add_f32 v226, v216, v217
  v_mfma_f32_16x16x32_bf16 v[152:155], a[128:131], v[68:71], v[204:207]
  v_exp_f32 v218, v130
  v_mfma_f32_16x16x32_bf16 v[148:151], a[132:135], v[64:67], v[200:203]
  s_add_u32 s66, s66, 32768
  ds_read_b128 a[164:167], v3 offset:25600
  v_cvt_pk_bf16_f32 v176, v216, v217
  v_mfma_f32_16x16x32_bf16 v[156:159], a[132:135], v[68:71], v[204:207]
  s_mov_b32 m0, s25
  v_exp_f32 v219, v131
  v_mfma_f32_16x16x32_bf16 v[144:147], a[136:139], v[72:75], v[144:147]
  s_and_b32 s66, s66, 0x1ffff
  ds_read_b128 a[168:171], v3 offset:26624
  buffer_load_dwordx4 v2, s[48:51], s27 offen offset:0 sc1 lds
  v_add_f32 v226, v226, v218
  v_add_f32 v226, v226, v219
  v_mfma_f32_16x16x32_bf16 v[152:155], a[136:139], v[76:79], v[152:155]
  v_exp_f32 v220, v132
  v_mfma_f32_16x16x32_bf16 v[148:151], a[140:143], v[72:75], v[148:151]
  ds_read_b128 a[172:175], v3 offset:27648
  v_cvt_pk_bf16_f32 v177, v218, v219
  v_mfma_f32_16x16x32_bf16 v[156:159], a[140:143], v[76:79], v[156:159]
  s_waitcnt lgkmcnt(4)
  v_exp_f32 v221, v133
  v_mfma_f32_16x16x32_bf16 v[144:147], a[144:147], v[80:83], v[144:147]
  s_add_u32 s14, s13, 73728
  ds_read_b128 a[176:179], v3 offset:28672
  buffer_load_dwordx4 a[236:239], v2, s[40:43], s14 offen offset:3072 sc1
  v_add_f32 v226, v226, v220
  v_mfma_f32_16x16x32_bf16 v[152:155], a[144:147], v[84:87], v[152:155]
  v_exp_f32 v222, v134
  v_mfma_f32_16x16x32_bf16 v[148:151], a[148:151], v[80:83], v[148:151]
  ds_read_b128 a[180:183], v3 offset:29696
  buffer_load_dwordx4 v2, s[48:51], s27 offen offset:1024 sc1 lds
  v_add_f32 v226, v226, v221
  v_cvt_pk_bf16_f32 v178, v220, v221
  v_mfma_f32_16x16x32_bf16 v[156:159], a[148:151], v[84:87], v[156:159]
  v_exp_f32 v223, v135
  v_mfma_f32_16x16x32_bf16 v[144:147], a[152:155], v[88:91], v[144:147]
  ds_read_b128 a[184:187], v3 offset:30720
  v_add_f32 v226, v226, v222
  v_mfma_f32_16x16x32_bf16 v[152:155], a[152:155], v[92:95], v[152:155]
  v_exp_f32 v216, v136
  v_mfma_f32_16x16x32_bf16 v[148:151], a[156:159], v[88:91], v[148:151]
  ds_read_b128 a[188:191], v3 offset:31744
  v_add_f32 v226, v226, v223
  v_exp_f32 v217, v137
  v_mfma_f32_16x16x32_bf16 v[156:159], a[156:159], v[92:95], v[156:159]
  s_waitcnt lgkmcnt(4)
  v_exp_f32 v218, v138
  v_mfma_f32_16x16x32_bf16 a[64:67], a[160:163], v[184:187], a[64:67]
  ds_read_b128 a[128:131], v3 offset:8192
  v_cvt_pk_bf16_f32 v179, v222, v223
  v_mfma_f32_16x16x32_bf16 a[68:71], a[160:163], v[188:191], a[68:71]
  v_exp_f32 v219, v139
  v_mfma_f32_16x16x32_bf16 a[72:75], a[164:167], v[184:187], a[72:75]
  ds_read_b128 a[132:135], v3 offset:9216
  buffer_load_dwordx4 v2, s[48:51], s27 offen offset:2048 sc1 lds
  v_add_f32 v227, v216, v217
  v_mfma_f32_16x16x32_bf16 a[76:79], a[164:167], v[188:191], a[76:79]
  v_exp_f32 v220, v140
  v_mfma_f32_16x16x32_bf16 a[80:83], a[168:171], v[184:187], a[80:83]
  ds_read_b128 a[136:139], v3 offset:10240
  v_cvt_pk_bf16_f32 v180, v216, v217
  v_mfma_f32_16x16x32_bf16 a[84:87], a[168:171], v[188:191], a[84:87]
  v_exp_f32 v221, v141
  v_mfma_f32_16x16x32_bf16 a[88:91], a[172:175], v[184:187], a[88:91]
  ds_read_b128 a[140:143], v3 offset:11264
  buffer_load_dwordx4 a[232:235], v2, s[40:43], s14 offen offset:2048 sc1
  v_add_f32 v227, v227, v218
  v_mfma_f32_16x16x32_bf16 a[92:95], a[172:175], v[188:191], a[92:95]
  s_waitcnt lgkmcnt(4)
  v_exp_f32 v222, v142
  v_mfma_f32_16x16x32_bf16 a[96:99], a[176:179], v[184:187], a[96:99]
  ds_read_b128 a[144:147], v3 offset:12288
  buffer_load_dwordx4 v2, s[48:51], s27 offen offset:3072 sc1 lds
  v_add_f32 v227, v227, v219
  v_cvt_pk_bf16_f32 v181, v218, v219
  v_mfma_f32_16x16x32_bf16 a[100:103], a[176:179], v[188:191], a[100:103]
  s_add_u32 s27, s27, 16384
  v_exp_f32 v223, v143
  v_mfma_f32_16x16x32_bf16 a[104:107], a[180:183], v[184:187], a[104:107]
  s_add_u32 s25, s25, 32768
  ds_read_b128 a[148:151], v3 offset:13312
  v_add_f32 v227, v227, v220
  v_mfma_f32_16x16x32_bf16 a[108:111], a[180:183], v[188:191], a[108:111]
  s_and_b32 s25, s25, 0x1ffff
  v_add_f32 v227, v227, v221
  v_cvt_pk_bf16_f32 v182, v220, v221
  v_add_f32 v227, v227, v222
  v_mfma_f32_16x16x32_bf16 a[112:115], a[184:187], v[184:187], a[112:115]
  ds_read_b128 a[152:155], v3 offset:14336
  v_add_f32 v227, v227, v223
  v_max_f32 v5, v226, v227
  v_cmp_lt_f32 vcc, s81, v5
  v_mfma_f32_16x16x32_bf16 a[116:119], a[184:187], v[188:191], a[116:119]
  v_exp_f32 v216, v144
  v_mfma_f32_16x16x32_bf16 a[120:123], a[188:191], v[184:187], a[120:123]
  s_waitcnt lgkmcnt(3)
  ds_read_b128 a[156:159], v3 offset:15360
  v_cvt_pk_bf16_f32 v183, v222, v223
  v_add_u32 v3, s66, v2
  v_mfma_f32_16x16x32_bf16 a[124:127], a[188:191], v[188:191], a[124:127]
  s_cbranch_vccnz fa_stub15
fa_back15:
  v_exp_f32 v217, v145
  v_add_f32 v230, v230, v226
  v_add_f32 v231, v231, v227
fa_SSW6:
  v_mfma_f32_16x16x32_bf16 v[128:131], a[128:131], v[64:67], v[200:203]
  s_waitcnt vmcnt(12)
  v_exp_f32 v218, v146
  v_mfma_f32_16x16x32_bf16 v[136:139], a[128:131], v[68:71], v[204:207]
  s_barrier
  v_exp_f32 v219, v147
  v_mfma_f32_16x16x32_bf16 v[132:135], a[132:135], v[64:67], v[200:203]
  ds_read_b128 a[160:163], v3 offset:16384
  ds_read_b128 a[164:167], v3 offset:17408
  v_add_f32 v226, v216, v217
  v_mfma_f32_16x16x32_bf16 v[140:143], a[132:135], v[68:71], v[204:207]
  s_mov_b32 m0, s24
  v_exp_f32 v220, v148
  v_mfma_f32_16x16x32_bf16 v[128:131], a[136:139], v[72:75], v[128:131]
  ds_read_b128 a[168:171], v3 offset:18432
  buffer_load_dwordx4 v2, s[44:47], s26 offen offset:0 sc1 lds
  v_cvt_pk_bf16_f32 v184, v216, v217
  v_mfma_f32_16x16x32_bf16 v[136:139], a[136:139], v[76:79], v[136:139]
  v_exp_f32 v221, v149
  v_mfma_f32_16x16x32_bf16 v[132:135], a[140:143], v[72:75], v[132:135]
  ds_read_b128 a[172:175], v3 offset:19456
  v_add_f32 v226, v226, v218
  v_add_f32 v226, v226, v219
  v_mfma_f32_16x16x32_bf16 v[140:143], a[140:143], v[76:79], v[140:143]
  s_waitcnt lgkmcnt(4)
  v_exp_f32 v222, v150
  v_mfma_f32_16x16x32_bf16 v[128:131], a[144:147], v[80:83], v[128:131]
  s_add_u32 s14, s13, 73728
  ds_read_b128 a[176:179], v3 offset:20480
  buffer_load_dwordx4 a[228:231], v2, s[40:43], s14 offen offset:1024 sc1
  v_cvt_pk_bf16_f32 v185, v218, v219
  v_mfma_f32_16x16x32_bf16 v[136:139], a[144:147], v[84:87], v[136:139]
  v_exp_f32 v223, v151
  v_mfma_f32_16x16x32_bf16 v[132:135], a[148:151], v[80:83], v[132:135]
  ds_read_b128 a[180:183], v3 offset:21504
  buffer_load_dwordx4 v2, s[44:47], s26 offen offset:1024 sc1 lds
  v_add_f32 v226, v226, v220
  v_mfma_f32_16x16x32_bf16 v[140:143], a[148:151], v[84:87], v[140:143]
  v_exp_f32 v216, v152
  v_mfma_f32_16x16x32_bf16 v[128:131], a[152:155], v[88:91], v[128:131]
  ds_read_b128 a[184:187], v3 offset:22528
  v_add_f32 v226, v226, v221
  v_cvt_pk_bf16_f32 v186, v220, v221
  v_mfma_f32_16x16x32_bf16 v[136:139], a[152:155], v[92:95], v[136:139]
  v_exp_f32 v217, v153
  v_mfma_f32_16x16x32_bf16 v[132:135], a[156:159], v[88:91], v[132:135]
  ds_read_b128 a[188:191], v3 offset:23552
  v_add_f32 v226, v226, v222
  v_mfma_f32_16x16x32_bf16 v[140:143], a[156:159], v[92:95], v[140:143]
  s_waitcnt lgkmcnt(4)
  v_exp_f32 v218, v154
  v_mfma_f32_16x16x32_bf16 a[64:67], a[160:163], v[176:179], a[64:67]
  ds_read_b128 a[128:131], v3 offset:0
  v_add_f32 v226, v226, v223
  v_cvt_pk_bf16_f32 v187, v222, v223
  v_mfma_f32_16x16x32_bf16 a[68:71], a[160:163], v[180:183], a[68:71]
  v_exp_f32 v219, v155
  v_mfma_f32_16x16x32_bf16 a[72:75], a[164:167], v[176:179], a[72:75]
  ds_read_b128 a[132:135], v3 offset:1024
  buffer_load_dwordx4 v2, s[44:47], s26 offen offset:2048 sc1 lds
  v_add_f32 v227, v216, v217
  v_mfma_f32_16x16x32_bf16 a[76:79], a[164:167], v[180:183], a[76:79]
  v_exp_f32 v220, v156
  v_mfma_f32_16x16x32_bf16 a[80:83], a[168:171], v[176:179], a[80:83]
  ds_read_b128 a[136:139], v3 offset:2048
  v_cvt_pk_bf16_f32 v188, v216, v217
  v_mfma_f32_16x16x32_bf16 a[84:87], a[168:171], v[180:183], a[84:87]
  v_exp_f32 v221, v157
  v_mfma_f32_16x16x32_bf16 a[88:91], a[172:175], v[176:179], a[88:91]
  ds_read_b128 a[140:143], v3 offset:3072
  buffer_load_dwordx4 a[224:227], v2, s[40:43], s14 offen offset:0 sc1
  v_add_f32 v227, v227, v218
  v_add_f32 v227, v227, v219
  v_mfma_f32_16x16x32_bf16 a[92:95], a[172:175], v[180:183], a[92:95]
  s_waitcnt lgkmcnt(4)
  v_exp_f32 v222, v158
  v_mfma_f32_16x16x32_bf16 a[96:99], a[176:179], v[176:179], a[96:99]
  ds_read_b128 a[144:147], v3 offset:4096
  buffer_load_dwordx4 v2, s[44:47], s26 offen offset:3072 sc1 lds
  v_cvt_pk_bf16_f32 v189, v218, v219
  v_mfma_f32_16x16x32_bf16 a[100:103], a[176:179], v[180:183], a[100:103]
  s_add_u32 s26, s26, 16384
  v_exp_f32 v223, v159
  v_mfma_f32_16x16x32_bf16 a[104:107], a[180:183], v[176:179], a[104:107]
  s_add_u32 s24, s24, 32768
  ds_read_b128 a[148:151], v3 offset:5120
  v_add_f32 v227, v227, v220
  v_mfma_f32_16x16x32_bf16 a[108:111], a[180:183], v[180:183], a[108:111]
  s_and_b32 s24, s24, 0x1ffff
  v_add_f32 v227, v227, v221
  v_cvt_pk_bf16_f32 v190, v220, v221
  v_add_f32 v227, v227, v222
  v_mfma_f32_16x16x32_bf16 a[112:115], a[184:187], v[176:179], a[112:115]
  ds_read_b128 a[152:155], v3 offset:6144
  v_add_f32 v227, v227, v223
  v_max_f32 v5, v226, v227
  v_cmp_lt_f32 vcc, s81, v5
  v_mfma_f32_16x16x32_bf16 a[116:119], a[184:187], v[180:183], a[116:119]
  v_exp_f32 v216, v128
  v_mfma_f32_16x16x32_bf16 a[120:123], a[188:191], v[176:179], a[120:123]
  s_waitcnt lgkmcnt(3)
  ds_read_b128 a[156:159], v3 offset:7168
  v_cvt_pk_bf16_f32 v191, v222, v223
  v_mfma_f32_16x16x32_bf16 a[124:127], a[188:191], v[180:183], a[124:127]
  s_cbranch_vccnz fa_stub16
fa_back16:
  v_exp_f32 v217, v129
  v_add_f32 v230, v230, v226
  v_add_f32 v231, v231, v227
  v_mfma_f32_16x16x32_bf16 v[144:147], a[128:131], v[64:67], v[200:203]
  ds_read_b128 a[160:163], v3 offset:24576
  v_add_f32 v226, v216, v217
  v_mfma_f32_16x16x32_bf16 v[152:155], a[128:131], v[68:71], v[204:207]
  v_exp_f32 v218, v130
  v_mfma_f32_16x16x32_bf16 v[148:151], a[132:135], v[64:67], v[200:203]
  s_add_u32 s66, s66, 32768
  ds_read_b128 a[164:167], v3 offset:25600
  v_cvt_pk_bf16_f32 v176, v216, v217
  v_mfma_f32_16x16x32_bf16 v[156:159], a[132:135], v[68:71], v[204:207]
  s_mov_b32 m0, s25
  v_exp_f32 v219, v131
  v_mfma_f32_16x16x32_bf16 v[144:147], a[136:139], v[72:75], v[144:147]
  s_and_b32 s66, s66, 0x1ffff
  ds_read_b128 a[168:171], v3 offset:26624
  buffer_load_dwordx4 v2, s[48:51], s27 offen offset:0 sc1 lds
  v_add_f32 v226, v226, v218
  v_add_f32 v226, v226, v219
  v_mfma_f32_16x16x32_bf16 v[152:155], a[136:139], v[76:79], v[152:155]
  v_exp_f32 v220, v132
  v_mfma_f32_16x16x32_bf16 v[148:151], a[140:143], v[72:75], v[148:151]
  ds_read_b128 a[172:175], v3 offset:27648
  v_cvt_pk_bf16_f32 v177, v218, v219
  v_mfma_f32_16x16x32_bf16 v[156:159], a[140:143], v[76:79], v[156:159]
  s_waitcnt lgkmcnt(4)
  v_exp_f32 v221, v133
  v_mfma_f32_16x16x32_bf16 v[144:147], a[144:147], v[80:83], v[144:147]
  s_add_u32 s14, s13, 69632
  ds_read_b128 a[176:179], v3 offset:28672
  buffer_load_dwordx4 a[220:223], v2, s[40:43], s14 offen offset:3072 sc1
  v_add_f32 v226, v226, v220
  v_mfma_f32_16x16x32_bf16 v[152:155], a[144:147], v[84:87], v[152:155]
  v_exp_f32 v222, v134
  v_mfma_f32_16x16x32_bf16 v[148:151], a[148:151], v[80:83], v[148:151]
  ds_read_b128 a[180:183], v3 offset:29696
  buffer_load_dwordx4 v2, s[48:51], s27 offen offset:1024 sc1 lds
  v_add_f32 v226, v226, v221
  v_cvt_pk_bf16_f32 v178, v220, v221
  v_mfma_f32_16x16x32_bf16 v[156:159], a[148:151], v[84:87], v[156:159]
  v_exp_f32 v223, v135
  v_mfma_f32_16x16x32_bf16 v[144:147], a[152:155], v[88:91], v[144:147]
  ds_read_b128 a[184:187], v3 offset:30720
  v_add_f32 v226, v226, v222
  v_mfma_f32_16x16x32_bf16 v[152:155], a[152:155], v[92:95], v[152:155]
  v_exp_f32 v216, v136
  v_mfma_f32_16x16x32_bf16 v[148:151], a[156:159], v[88:91], v[148:151]
  ds_read_b128 a[188:191], v3 offset:31744
  v_add_f32 v226, v226, v223
  v_exp_f32 v217, v137
  v_mfma_f32_16x16x32_bf16 v[156:159], a[156:159], v[92:95], v[156:159]
  s_waitcnt lgkmcnt(4)
  v_exp_f32 v218, v138
  v_mfma_f32_16x16x32_bf16 a[64:67], a[160:163], v[184:187], a[64:67]
  ds_read_b128 a[128:131], v3 offset:8192
  v_cvt_pk_bf16_f32 v179, v222, v223
  v_mfma_f32_16x16x32_bf16 a[68:71], a[160:163], v[188:191], a[68:71]
  v_exp_f32 v219, v139
  v_mfma_f32_16x16x32_bf16 a[72:75], a[164:167], v[184:187], a[72:75]
  ds_read_b128 a[132:135], v3 offset:9216
  buffer_load_dwordx4 v2, s[48:51], s27 offen offset:2048 sc1 lds
  v_add_f32 v227, v216, v217
  v_mfma_f32_16x16x32_bf16 a[76:79], a[164:167], v[188:191], a[76:79]
  v_exp_f32 v220, v140
  v_mfma_f32_16x16x32_bf16 a[80:83], a[168:171], v[184:187], a[80:83]
  ds_read_b128 a[136:139], v3 offset:10240
  v_cvt_pk_bf16_f32 v180, v216, v217
  v_mfma_f32_16x16x32_bf16 a[84:87], a[168:171], v[188:191], a[84:87]
  v_exp_f32 v221, v141
  v_mfma_f32_16x16x32_bf16 a[88:91], a[172:175], v[184:187], a[88:91]
  ds_read_b128 a[140:143], v3 offset:11264
  buffer_load_dwordx4 a[216:219], v2, s[40:43], s14 offen offset:2048 sc1
  v_add_f32 v227, v227, v218
  v_mfma_f32_16x16x32_bf16 a[92:95], a[172:175], v[188:191], a[92:95]
  s_waitcnt lgkmcnt(4)
  v_exp_f32 v222, v142
  v_mfma_f32_16x16x32_bf16 a[96:99], a[176:179], v[184:187], a[96:99]
  ds_read_b128 a[144:147], v3 offset:12288
  buffer_load_dwordx4 v2, s[48:51], s27 offen offset:3072 sc1 lds
  v_add_f32 v227, v227, v219
  v_cvt_pk_bf16_f32 v181, v218, v219
  v_mfma_f32_16x16x32_bf16 a[100:103], a[176:179], v[188:191], a[100:103]
  s_add_u32 s27, s27, 16384
  v_exp_f32 v223, v143
  v_mfma_f32_16x16x32_bf16 a[104:107], a[180:183], v[184:187], a[104:107]
  s_add_u32 s25, s25, 32768
  ds_read_b128 a[148:151], v3 offset:13312
  v_add_f32 v227, v227, v220
  v_mfma_f32_16x16x32_bf16 a[108:111], a[180:183], v[188:191], a[108:111]
  s_and_b32 s25, s25, 0x1ffff
  v_add_f32 v227, v227, v221
  v_cvt_pk_bf16_f32 v182, v220, v221
  v_add_f32 v227, v227, v222
  v_mfma_f32_16x16x32_bf16 a[112:115], a[184:187], v[184:187], a[112:115]
  ds_read_b128 a[152:155], v3 offset:14336
  v_add_f32 v227, v227, v223
  v_max_f32 v5, v226, v227
  v_cmp_lt_f32 vcc, s81, v5
  v_mfma_f32_16x16x32_bf16 a[116:119], a[184:187], v[188:191], a[116:119]
  v_exp_f32 v216, v144
  v_mfma_f32_16x16x32_bf16 a[120:123], a[188:191], v[184:187], a[120:123]
  s_waitcnt lgkmcnt(3)
  ds_read_b128 a[156:159], v3 offset:15360
  v_cvt_pk_bf16_f32 v183, v222, v223
  v_add_u32 v3, s66, v2
  v_mfma_f32_16x16x32_bf16 a[124:127], a[188:191], v[188:191], a[124:127]
  s_cbranch_vccnz fa_stub17
fa_back17:
  v_exp_f32 v217, v145
  v_add_f32 v230, v230, v226
  v_add_f32 v231, v231, v227
fa_SSW5:
  v_mfma_f32_16x16x32_bf16 v[128:131], a[128:131], v[64:67], v[200:203]
  s_waitcnt vmcnt(12)
  v_exp_f32 v218, v146
  v_mfma_f32_16x16x32_bf16 v[136:139], a[128:131], v[68:71], v[204:207]
  s_barrier
  v_exp_f32 v219, v147
  v_mfma_f32_16x16x32_bf16 v[132:135], a[132:135], v[64:67], v[200:203]
  ds_read_b128 a[160:163], v3 offset:16384
  ds_read_b128 a[164:167], v3 offset:17408
  v_add_f32 v226, v216, v217
  v_mfma_f32_16x16x32_bf16 v[140:143], a[132:135], v[68:71], v[204:207]
  s_mov_b32 m0, s24
  v_exp_f32 v220, v148
  v_mfma_f32_16x16x32_bf16 v[128:131], a[136:139], v[72:75], v[128:131]
  ds_read_b128 a[168:171], v3 offset:18432
  buffer_load_dwordx4 v2, s[44:47], s26 offen offset:0 sc1 lds
  v_cvt_pk_bf16_f32 v184, v216, v217
  v_mfma_f32_16x16x32_bf16 v[136:139], a[136:139], v[76:79], v[136:139]
  v_exp_f32 v221, v149
  v_mfma_f32_16x16x32_bf16 v[132:135], a[140:143], v[72:75], v[132:135]
  ds_read_b128 a[172:175], v3 offset:19456
  v_add_f32 v226, v226, v218
  v_add_f32 v226, v226, v219
  v_mfma_f32_16x16x32_bf16 v[140:143], a[140:143], v[76:79], v[140:143]
  s_waitcnt lgkmcnt(4)
  v_exp_f32 v222, v150
  v_mfma_f32_16x16x32_bf16 v[128:131], a[144:147], v[80:83], v[128:131]
  s_add_u32 s14, s13, 69632
  ds_read_b128 a[176:179], v3 offset:20480
  buffer_load_dwordx4 a[212:215], v2, s[40:43], s14 offen offset:1024 sc1
  v_cvt_pk_bf16_f32 v185, v218, v219
  v_mfma_f32_16x16x32_bf16 v[136:139], a[144:147], v[84:87], v[136:139]
  v_exp_f32 v223, v151
  v_mfma_f32_16x16x32_bf16 v[132:135], a[148:151], v[80:83], v[132:135]
  ds_read_b128 a[180:183], v3 offset:21504
  buffer_load_dwordx4 v2, s[44:47], s26 offen offset:1024 sc1 lds
  v_add_f32 v226, v226, v220
  v_mfma_f32_16x16x32_bf16 v[140:143], a[148:151], v[84:87], v[140:143]
  v_exp_f32 v216, v152
  v_mfma_f32_16x16x32_bf16 v[128:131], a[152:155], v[88:91], v[128:131]
  ds_read_b128 a[184:187], v3 offset:22528
  v_add_f32 v226, v226, v221
  v_cvt_pk_bf16_f32 v186, v220, v221
  v_mfma_f32_16x16x32_bf16 v[136:139], a[152:155], v[92:95], v[136:139]
  v_exp_f32 v217, v153
  v_mfma_f32_16x16x32_bf16 v[132:135], a[156:159], v[88:91], v[132:135]
  ds_read_b128 a[188:191], v3 offset:23552
  buffer_load_dwordx4 a[208:211], v2, s[40:43], s14 offen offset:0 sc1
  v_add_f32 v226, v226, v222
  v_mfma_f32_16x16x32_bf16 v[140:143], a[156:159], v[92:95], v[140:143]
  s_waitcnt lgkmcnt(4)
  v_exp_f32 v218, v154
  v_mfma_f32_16x16x32_bf16 a[64:67], a[160:163], v[176:179], a[64:67]
  ds_read_b128 a[128:131], v3 offset:0
  v_add_f32 v226, v226, v223
  v_cvt_pk_bf16_f32 v187, v222, v223
  v_mfma_f32_16x16x32_bf16 a[68:71], a[160:163], v[180:183], a[68:71]
  v_exp_f32 v219, v155
  v_mfma_f32_16x16x32_bf16 a[72:75], a[164:167], v[176:179], a[72:75]
  ds_read_b128 a[132:135], v3 offset:1024
  buffer_load_dwordx4 v2, s[44:47], s26 offen offset:2048 sc1 lds
  v_add_f32 v227, v216, v217
  v_mfma_f32_16x16x32_bf16 a[76:79], a[164:167], v[180:183], a[76:79]
  v_exp_f32 v220, v156
  v_mfma_f32_16x16x32_bf16 a[80:83], a[168:171], v[176:179], a[80:83]
  ds_read_b128 a[136:139], v3 offset:2048
  v_cvt_pk_bf16_f32 v188, v216, v217
  v_mfma_f32_16x16x32_bf16 a[84:87], a[168:171], v[180:183], a[84:87]
  v_exp_f32 v221, v157
  v_mfma_f32_16x16x32_bf16 a[88:91], a[172:175], v[176:179], a[88:91]
  s_add_u32 s14, s13, 61440
  ds_read_b128 a[140:143], v3 offset:3072
  buffer_load_dwordx4 a[204:207], v2, s[40:43], s14 offen offset:3072 sc1
  v_add_f32 v227, v227, v218
  v_add_f32 v227, v227, v219
  v_mfma_f32_16x16x32_bf16 a[92:95], a[172:175], v[180:183], a[92:95]
  s_waitcnt lgkmcnt(4)
  v_exp_f32 v222, v158
  v_mfma_f32_16x16x32_bf16 a[96:99], a[176:179], v[176:179], a[96:99]
  ds_read_b128 a[144:147], v3 offset:4096
  buffer_load_dwordx4 v2, s[44:47], s26 offen offset:3072 sc1 lds
  v_cvt_pk_bf16_f32 v189, v218, v219
  v_mfma_f32_16x16x32_bf16 a[100:103], a[176:179], v[180:183], a[100:103]
  s_add_u32 s26, s26, 16384
  v_exp_f32 v223, v159
  v_mfma_f32_16x16x32_bf16 a[104:107], a[180:183], v[176:179], a[104:107]
  s_add_u32 s24, s24, 32768
  ds_read_b128 a[148:151], v3 offset:5120
  v_add_f32 v227, v227, v220
  v_mfma_f32_16x16x32_bf16 a[108:111], a[180:183], v[180:183], a[108:111]
  s_and_b32 s24, s24, 0x1ffff
  v_add_f32 v227, v227, v221
  v_cvt_pk_bf16_f32 v190, v220, v221
  v_add_f32 v227, v227, v222
  v_mfma_f32_16x16x32_bf16 a[112:115], a[184:187], v[176:179], a[112:115]
  ds_read_b128 a[152:155], v3 offset:6144
  v_add_f32 v227, v227, v223
  v_max_f32 v5, v226, v227
  v_cmp_lt_f32 vcc, s81, v5
  v_mfma_f32_16x16x32_bf16 a[116:119], a[184:187], v[180:183], a[116:119]
  v_exp_f32 v216, v128
  v_mfma_f32_16x16x32_bf16 a[120:123], a[188:191], v[176:179], a[120:123]
  s_waitcnt lgkmcnt(3)
  ds_read_b128 a[156:159], v3 offset:7168
  v_cvt_pk_bf16_f32 v191, v222, v223
  v_mfma_f32_16x16x32_bf16 a[124:127], a[188:191], v[180:183], a[124:127]
  s_cbranch_vccnz fa_stub18
fa_back18:
  v_exp_f32 v217, v129
  v_add_f32 v230, v230, v226
  v_add_f32 v231, v231, v227
  v_mfma_f32_16x16x32_bf16 v[144:147], a[128:131], v[64:67], v[200:203]
  ds_read_b128 a[160:163], v3 offset:24576
  v_add_f32 v226, v216, v217
  v_mfma_f32_16x16x32_bf16 v[152:155], a[128:131], v[68:71], v[204:207]
  v_exp_f32 v218, v130
  v_mfma_f32_16x16x32_bf16 v[148:151], a[132:135], v[64:67], v[200:203]
  s_add_u32 s66, s66, 32768
  ds_read_b128 a[164:167], v3 offset:25600
  v_cvt_pk_bf16_f32 v176, v216, v217
  v_mfma_f32_16x16x32_bf16 v[156:159], a[132:135], v[68:71], v[204:207]
  s_mov_b32 m0, s25
  v_exp_f32 v219, v131
  v_mfma_f32_16x16x32_bf16 v[144:147], a[136:139], v[72:75], v[144:147]
  s_and_b32 s66, s66, 0x1ffff
  ds_read_b128 a[168:171], v3 offset:26624
  buffer_load_dwordx4 v2, s[48:51], s27 offen offset:0 sc1 lds
  v_add_f32 v226, v226, v218
  v_add_f32 v226, v226, v219
  v_mfma_f32_16x16x32_bf16 v[152:155], a[136:139], v[76:79], v[152:155]
  v_exp_f32 v220, v132
  v_mfma_f32_16x16x32_bf16 v[148:151], a[140:143], v[72:75], v[148:151]
  ds_read_b128 a[172:175], v3 offset:27648
  v_cvt_pk_bf16_f32 v177, v218, v219
  v_mfma_f32_16x16x32_bf16 v[156:159], a[140:143], v[76:79], v[156:159]
  s_waitcnt lgkmcnt(4)
  v_exp_f32 v221, v133
  v_mfma_f32_16x16x32_bf16 v[144:147], a[144:147], v[80:83], v[144:147]
  s_add_u32 s14, s13, 61440
  ds_read_b128 a[176:179], v3 offset:28672
  buffer_load_dwordx4 a[200:203], v2, s[40:43], s14 offen offset:2048 sc1
  v_add_f32 v226, v226, v220
  v_mfma_f32_16x16x32_bf16 v[152:155], a[144:147], v[84:87], v[152:155]
  v_exp_f32 v222, v134
  v_mfma_f32_16x16x32_bf16 v[148:151], a[148:151], v[80:83], v[148:151]
  ds_read_b128 a[180:183], v3 offset:29696
  buffer_load_dwordx4 v2, s[48:51], s27 offen offset:1024 sc1 lds
  v_add_f32 v226, v226, v221
  v_cvt_pk_bf16_f32 v178, v220, v221
  v_mfma_f32_16x16x32_bf16 v[156:159], a[148:151], v[84:87], v[156:159]
  v_exp_f32 v223, v135
  v_mfma_f32_16x16x32_bf16 v[144:147], a[152:155], v[88:91], v[144:147]
  ds_read_b128 a[184:187], v3 offset:30720
  v_add_f32 v226, v226, v222
  v_mfma_f32_16x16x32_bf16 v[152:155], a[152:155], v[92:95], v[152:155]
  v_exp_f32 v216, v136
  v_mfma_f32_16x16x32_bf16 v[148:151], a[156:159], v[88:91], v[148:151]
  ds_read_b128 a[188:191], v3 offset:31744
  buffer_load_dwordx4 a[196:199], v2, s[40:43], s14 offen offset:1024 sc1
  v_add_f32 v226, v226, v223
  v_exp_f32 v217, v137
  v_mfma_f32_16x16x32_bf16 v[156:159], a[156:159], v[92:95], v[156:159]
  s_waitcnt lgkmcnt(4)
  v_exp_f32 v218, v138
  v_mfma_f32_16x16x32_bf16 a[64:67], a[160:163], v[184:187], a[64:67]
  ds_read_b128 a[128:131], v3 offset:8192
  v_cvt_pk_bf16_f32 v179, v222, v223
  v_mfma_f32_16x16x32_bf16 a[68:71], a[160:163], v[188:191], a[68:71]
  v_exp_f32 v219, v139
  v_mfma_f32_16x16x32_bf16 a[72:75], a[164:167], v[184:187], a[72:75]
  ds_read_b128 a[132:135], v3 offset:9216
  buffer_load_dwordx4 v2, s[48:51], s27 offen offset:2048 sc1 lds
  v_add_f32 v227, v216, v217
  v_mfma_f32_16x16x32_bf16 a[76:79], a[164:167], v[188:191], a[76:79]
  v_exp_f32 v220, v140
  v_mfma_f32_16x16x32_bf16 a[80:83], a[168:171], v[184:187], a[80:83]
  ds_read_b128 a[136:139], v3 offset:10240
  v_cvt_pk_bf16_f32 v180, v216, v217
  v_mfma_f32_16x16x32_bf16 a[84:87], a[168:171], v[188:191], a[84:87]
  v_exp_f32 v221, v141
  v_mfma_f32_16x16x32_bf16 a[88:91], a[172:175], v[184:187], a[88:91]
  ds_read_b128 a[140:143], v3 offset:11264
  buffer_load_dwordx4 a[192:195], v2, s[40:43], s14 offen offset:0 sc1
  v_add_f32 v227, v227, v218
  v_mfma_f32_16x16x32_bf16 a[92:95], a[172:175], v[188:191], a[92:95]
  s_waitcnt lgkmcnt(4)
  v_exp_f32 v222, v142
  v_mfma_f32_16x16x32_bf16 a[96:99], a[176:179], v[184:187], a[96:99]
  ds_read_b128 a[144:147], v3 offset:12288
  buffer_load_dwordx4 v2, s[48:51], s27 offen offset:3072 sc1 lds
  v_add_f32 v227, v227, v219
  v_cvt_pk_bf16_f32 v181, v218, v219
  v_mfma_f32_16x16x32_bf16 a[100:103], a[176:179], v[188:191], a[100:103]
  s_add_u32 s27, s27, 16384
  v_exp_f32 v223, v143
  v_mfma_f32_16x16x32_bf16 a[104:107], a[180:183], v[184:187], a[104:107]
  s_add_u32 s25, s25, 32768
  ds_read_b128 a[148:151], v3 offset:13312
  v_add_f32 v227, v227, v220
  v_mfma_f32_16x16x32_bf16 a[108:111], a[180:183], v[188:191], a[108:111]
  s_and_b32 s25, s25, 0x1ffff
  v_add_f32 v227, v227, v221
  v_cvt_pk_bf16_f32 v182, v220, v221
  v_add_f32 v227, v227, v222
  v_mfma_f32_16x16x32_bf16 a[112:115], a[184:187], v[184:187], a[112:115]
  ds_read_b128 a[152:155], v3 offset:14336
  v_add_f32 v227, v227, v223
  v_max_f32 v5, v226, v227
  v_cmp_lt_f32 vcc, s81, v5
  v_mfma_f32_16x16x32_bf16 a[116:119], a[184:187], v[188:191], a[116:119]
  v_exp_f32 v216, v144
  v_mfma_f32_16x16x32_bf16 a[120:123], a[188:191], v[184:187], a[120:123]
  s_waitcnt lgkmcnt(3)
  ds_read_b128 a[156:159], v3 offset:15360
  v_cvt_pk_bf16_f32 v183, v222, v223
  v_add_u32 v3, s66, v2
  v_mfma_f32_16x16x32_bf16 a[124:127], a[188:191], v[188:191], a[124:127]
  s_cbranch_vccnz fa_stub19
fa_back19:
  v_exp_f32 v217, v145
  v_add_f32 v230, v230, v226
  v_add_f32 v231, v231, v227
fa_SSW4:
  v_mfma_f32_16x16x32_bf16 v[128:131], a[128:131], v[64:67], v[200:203]
  s_waitcnt vmcnt(12)
  v_exp_f32 v218, v146
  v_mfma_f32_16x16x32_bf16 v[136:139], a[128:131], v[68:71], v[204:207]
  s_barrier
  v_exp_f32 v219, v147
  v_mfma_f32_16x16x32_bf16 v[132:135], a[132:135], v[64:67], v[200:203]
  ds_read_b128 a[160:163], v3 offset:16384
  ds_read_b128 a[164:167], v3 offset:17408
  v_add_f32 v226, v216, v217
  v_mfma_f32_16x16x32_bf16 v[140:143], a[132:135], v[68:71], v[204:207]
  s_mov_b32 m0, s24
  v_exp_f32 v220, v148
  v_mfma_f32_16x16x32_bf16 v[128:131], a[136:139], v[72:75], v[128:131]
  ds_read_b128 a[168:171], v3 offset:18432
  buffer_load_dwordx4 v2, s[44:47], s26 offen offset:0 sc1 lds
  v_cvt_pk_bf16_f32 v184, v216, v217
  v_mfma_f32_16x16x32_bf16 v[136:139], a[136:139], v[76:79], v[136:139]
  v_exp_f32 v221, v149
  v_mfma_f32_16x16x32_bf16 v[132:135], a[140:143], v[72:75], v[132:135]
  s_add_u32 s14, s13, 57344
  ds_read_b128 a[172:175], v3 offset:19456
  buffer_load_dwordx4 a[60:63], v2, s[40:43], s14 offen offset:3072 sc1
  v_add_f32 v226, v226, v218
  v_add_f32 v226, v226, v219
  v_mfma_f32_16x16x32_bf16 v[140:143], a[140:143], v[76:79], v[140:143]
  s_waitcnt lgkmcnt(4)
  v_exp_f32 v222, v150
  v_mfma_f32_16x16x32_bf16 v[128:131], a[144:147], v[80:83], v[128:131]
  ds_read_b128 a[176:179], v3 offset:20480
  v_cvt_pk_bf16_f32 v185, v218, v219
  v_mfma_f32_16x16x32_bf16 v[136:139], a[144:147], v[84:87], v[136:139]
  v_exp_f32 v223, v151
  v_mfma_f32_16x16x32_bf16 v[132:135], a[148:151], v[80:83], v[132:135]
  ds_read_b128 a[180:183], v3 offset:21504
  buffer_load_dwordx4 v2, s[44:47], s26 offen offset:1024 sc1 lds
  v_add_f32 v226, v226, v220
  v_mfma_f32_16x16x32_bf16 v[140:143], a[148:151], v[84:87], v[140:143]
  v_exp_f32 v216, v152
  v_mfma_f32_16x16x32_bf16 v[128:131], a[152:155], v[88:91], v[128:131]
  ds_read_b128 a[184:187], v3 offset:22528
  v_add_f32 v226, v226, v221
  v_cvt_pk_bf16_f32 v186, v220, v221
  v_mfma_f32_16x16x32_bf16 v[136:139], a[152:155], v[92:95], v[136:139]
  v_exp_f32 v217, v153
  v_mfma_f32_16x16x32_bf16 v[132:135], a[156:159], v[88:91], v[132:135]
  ds_read_b128 a[188:191], v3 offset:23552
  buffer_load_dwordx4 a[56:59], v2, s[40:43], s14 offen offset:2048 sc1
  v_add_f32 v226, v226, v222
  v_mfma_f32_16x16x32_bf16 v[140:143], a[156:159], v[92:95], v[140:143]
  s_waitcnt lgkmcnt(4)
  v_exp_f32 v218, v154
  v_mfma_f32_16x16x32_bf16 a[64:67], a[160:163], v[176:179], a[64:67]
  ds_read_b128 a[128:131], v3 offset:0
  v_add_f32 v226, v226, v223
  v_cvt_pk_bf16_f32 v187, v222, v223
  v_mfma_f32_16x16x32_bf16 a[68:71], a[160:163], v[180:183], a[68:71]
  v_exp_f32 v219, v155
  v_mfma_f32_16x16x32_bf16 a[72:75], a[164:167], v[176:179], a[72:75]
  ds_read_b128 a[132:135], v3 offset:1024
  buffer_load_dwordx4 v2, s[44:47], s26 offen offset:2048 sc1 lds
  v_add_f32 v227, v216, v217
  v_mfma_f32_16x16x32_bf16 a[76:79], a[164:167], v[180:183], a[76:79]
  v_exp_f32 v220, v156
  v_mfma_f32_16x16x32_bf16 a[80:83], a[168:171], v[176:179], a[80:83]
  ds_read_b128 a[136:139], v3 offset:2048
  buffer_load_dwordx4 a[52:55], v2, s[40:43], s14 offen offset:1024 sc1
  v_cvt_pk_bf16_f32 v188, v216, v217
  v_mfma_f32_16x16x32_bf16 a[84:87], a[168:171], v[180:183], a[84:87]
  v_exp_f32 v221, v157
  v_mfma_f32_16x16x32_bf16 a[88:91], a[172:175], v[176:179], a[88:91]
  ds_read_b128 a[140:143], v3 offset:3072
  v_add_f32 v227, v227, v218
  v_add_f32 v227, v227, v219
  v_mfma_f32_16x16x32_bf16 a[92:95], a[172:175], v[180:183], a[92:95]
  s_waitcnt lgkmcnt(4)
  v_exp_f32 v222, v158
  v_mfma_f32_16x16x32_bf16 a[96:99], a[176:179], v[176:179], a[96:99]
  ds_read_b128 a[144:147], v3 offset:4096
  buffer_load_dwordx4 v2, s[44:47], s26 offen offset:3072 sc1 lds
  v_cvt_pk_bf16_f32 v189, v218, v219
  v_mfma_f32_16x16x32_bf16 a[100:103], a[176:179], v[180:183], a[100:103]
  s_add_u32 s26, s26, 16384
  v_exp_f32 v223, v159
  v_mfma_f32_16x16x32_bf16 a[104:107], a[180:183], v[176:179], a[104:107]
  s_add_u32 s24, s24, 32768
  ds_read_b128 a[148:151], v3 offset:5120
  buffer_load_dwordx4 a[48:51], v2, s[40:43], s14 offen offset:0 sc1
  v_add_f32 v227, v227, v220
  v_mfma_f32_16x16x32_bf16 a[108:111], a[180:183], v[180:183], a[108:111]
  s_and_b32 s24, s24, 0x1ffff
  v_add_f32 v227, v227, v221
  v_cvt_pk_bf16_f32 v190, v220, v221
  v_add_f32 v227, v227, v222
  v_mfma_f32_16x16x32_bf16 a[112:115], a[184:187], v[176:179], a[112:115]
  ds_read_b128 a[152:155], v3 offset:6144
  v_add_f32 v227, v227, v223
  v_max_f32 v5, v226, v227
  v_cmp_lt_f32 vcc, s81, v5
  v_mfma_f32_16x16x32_bf16 a[116:119], a[184:187], v[180:183], a[116:119]
  v_exp_f32 v216, v128
  v_mfma_f32_16x16x32_bf16 a[120:123], a[188:191], v[176:179], a[120:123]
  s_waitcnt lgkmcnt(3)
  ds_read_b128 a[156:159], v3 offset:7168
  v_cvt_pk_bf16_f32 v191, v222, v223
  v_mfma_f32_16x16x32_bf16 a[124:127], a[188:191], v[180:183], a[124:127]
  s_cbranch_vccnz fa_stub20
fa_back20:
  v_exp_f32 v217, v129
  v_add_f32 v230, v230, v226
  v_add_f32 v231, v231, v227
  v_mfma_f32_16x16x32_bf16 v[144:147], a[128:131], v[64:67], v[200:203]
  ds_read_b128 a[160:163], v3 offset:24576
  v_add_f32 v226, v216, v217
  v_mfma_f32_16x16x32_bf16 v[152:155], a[128:131], v[68:71], v[204:207]
  v_exp_f32 v218, v130
  v_mfma_f32_16x16x32_bf16 v[148:151], a[132:135], v[64:67], v[200:203]
  s_add_u32 s66, s66, 32768
  ds_read_b128 a[164:167], v3 offset:25600
  v_cvt_pk_bf16_f32 v176, v216, v217
  v_mfma_f32_16x16x32_bf16 v[156:159], a[132:135], v[68:71], v[204:207]
  s_mov_b32 m0, s25
  v_exp_f32 v219, v131
  v_mfma_f32_16x16x32_bf16 v[144:147], a[136:139], v[72:75], v[144:147]
  s_and_b32 s66, s66, 0x1ffff
  ds_read_b128 a[168:171], v3 offset:26624
  buffer_load_dwordx4 v2, s[48:51], s27 offen offset:0 sc1 lds
  v_add_f32 v226, v226, v218
  v_add_f32 v226, v226, v219
  v_mfma_f32_16x16x32_bf16 v[152:155], a[136:139], v[76:79], v[152:155]
  v_exp_f32 v220, v132
  v_mfma_f32_16x16x32_bf16 v[148:151], a[140:143], v[72:75], v[148:151]
  s_add_u32 s14, s13, 45056
  ds_read_b128 a[172:175], v3 offset:27648
  buffer_load_dwordx4 a[44:47], v2, s[40:43], s14 offen offset:3072 sc1
  v_cvt_pk_bf16_f32 v177, v218, v219
  v_mfma_f32_16x16x32_bf16 v[156:159], a[140:143], v[76:79], v[156:159]
  s_waitcnt lgkmcnt(4)
  v_exp_f32 v221, v133
  v_mfma_f32_16x16x32_bf16 v[144:147], a[144:147], v[80:83], v[144:147]
  ds_read_b128 a[176:179], v3 offset:28672
  v_add_f32 v226, v226, v220
  v_mfma_f32_16x16x32_bf16 v[152:155], a[144:147], v[84:87], v[152:155]
  v_exp_f32 v222, v134
  v_mfma_f32_16x16x32_bf16 v[148:151], a[148:151], v[80:83], v[148:151]
  ds_read_b128 a[180:183], v3 offset:29696
  buffer_load_dwordx4 v2, s[48:51], s27 offen offset:1024 sc1 lds
  v_add_f32 v226, v226, v221
  v_cvt_pk_bf16_f32 v178, v220, v221
  v_mfma_f32_16x16x32_bf16 v[156:159], a[148:151], v[84:87], v[156:159]
  v_exp_f32 v223, v135
  v_mfma_f32_16x16x32_bf16 v[144:147], a[152:155], v[88:91], v[144:147]
  ds_read_b128 a[184:187], v3 offset:30720
  v_add_f32 v226, v226, v222
  v_mfma_f32_16x16x32_bf16 v[152:155], a[152:155], v[92:95], v[152:155]
  v_exp_f32 v216, v136
  v_mfma_f32_16x16x32_bf16 v[148:151], a[156:159], v[88:91], v[148:151]
  ds_read_b128 a[188:191], v3 offset:31744
  buffer_load_dwordx4 a[40:43], v2, s[40:43], s14 offen offset:2048 sc1
  v_add_f32 v226, v226, v223
  v_exp_f32 v217, v137
  v_mfma_f32_16x16x32_bf16 v[156:159], a[156:159], v[92:95], v[156:159]
  s_waitcnt lgkmcnt(4)
  v_exp_f32 v218, v138
  v_mfma_f32_16x16x32_bf16 a[64:67], a[160:163], v[184:187], a[64:67]
  ds_read_b128 a[128:131], v3 offset:8192
  v_cvt_pk_bf16_f32 v179, v222, v223
  v_mfma_f32_16x16x32_bf16 a[68:71], a[160:163], v[188:191], a[68:71]
  v_exp_f32 v219, v139
  v_mfma_f32_16x16x32_bf16 a[72:75], a[164:167], v[184:187], a[72:75]
  ds_read_b128 a[132:135], v3 offset:9216
  buffer_load_dwordx4 v2, s[48:51], s27 offen offset:2048 sc1 lds
  v_add_f32 v227, v216, v217
  v_mfma_f32_16x16x32_bf16 a[76:79], a[164:167], v[188:191], a[76:79]
  v_exp_f32 v220, v140
  v_mfma_f32_16x16x32_bf16 a[80:83], a[168:171], v[184:187], a[80:83]
  ds_read_b128 a[136:139], v3 offset:10240
  buffer_load_dwordx4 a[36:39], v2, s[40:43], s14 offen offset:1024 sc1
  v_cvt_pk_bf16_f32 v180, v216, v217
  v_mfma_f32_16x16x32_bf16 a[84:87], a[168:171], v[188:191], a[84:87]
  v_exp_f32 v221, v141
  v_mfma_f32_16x16x32_bf16 a[88:91], a[172:175], v[184:187], a[88:91]
  ds_read_b128 a[140:143], v3 offset:11264
  v_add_f32 v227, v227, v218
  v_mfma_f32_16x16x32_bf16 a[92:95], a[172:175], v[188:191], a[92:95]
  s_waitcnt lgkmcnt(4)
  v_exp_f32 v222, v142
  v_mfma_f32_16x16x32_bf16 a[96:99], a[176:179], v[184:187], a[96:99]
  ds_read_b128 a[144:147], v3 offset:12288
  buffer_load_dwordx4 v2, s[48:51], s27 offen offset:3072 sc1 lds
  v_add_f32 v227, v227, v219
  v_cvt_pk_bf16_f32 v181, v218, v219
  v_mfma_f32_16x16x32_bf16 a[100:103], a[176:179], v[188:191], a[100:103]
  s_add_u32 s27, s27, 16384
  v_exp_f32 v223, v143
  v_mfma_f32_16x16x32_bf16 a[104:107], a[180:183], v[184:187], a[104:107]
  s_add_u32 s25, s25, 32768
  ds_read_b128 a[148:151], v3 offset:13312
  buffer_load_dwordx4 a[32:35], v2, s[40:43], s14 offen offset:0 sc1
  v_add_f32 v227, v227, v220
  v_mfma_f32_16x16x32_bf16 a[108:111], a[180:183], v[188:191], a[108:111]
  s_and_b32 s25, s25, 0x1ffff
  v_add_f32 v227, v227, v221
  v_cvt_pk_bf16_f32 v182, v220, v221
  v_add_f32 v227, v227, v222
  v_mfma_f32_16x16x32_bf16 a[112:115], a[184:187], v[184:187], a[112:115]
  ds_read_b128 a[152:155], v3 offset:14336
  v_add_f32 v227, v227, v223
  v_max_f32 v5, v226, v227
  v_cmp_lt_f32 vcc, s81, v5
  v_mfma_f32_16x16x32_bf16 a[116:119], a[184:187], v[188:191], a[116:119]
  v_exp_f32 v216, v144
  v_mfma_f32_16x16x32_bf16 a[120:123], a[188:191], v[184:187], a[120:123]
  s_waitcnt lgkmcnt(3)
  ds_read_b128 a[156:159], v3 offset:15360
  v_cvt_pk_bf16_f32 v183, v222, v223
  v_add_u32 v3, s66, v2
  v_mfma_f32_16x16x32_bf16 a[124:127], a[188:191], v[188:191], a[124:127]
  s_cbranch_vccnz fa_stub21
fa_back21:
  v_exp_f32 v217, v145
  v_add_f32 v230, v230, v226
  v_add_f32 v231, v231, v227
fa_SSW3:
  v_mfma_f32_16x16x32_bf16 v[128:131], a[128:131], v[64:67], v[200:203]
  s_waitcnt vmcnt(12)
  v_exp_f32 v218, v146
  v_mfma_f32_16x16x32_bf16 v[136:139], a[128:131], v[68:71], v[204:207]
  s_barrier
  v_exp_f32 v219, v147
  v_mfma_f32_16x16x32_bf16 v[132:135], a[132:135], v[64:67], v[200:203]
  s_cmp_ge_u32 s26, s46
  s_cselect_b64 s[44:45], s[4:5], s[44:45]
  s_cselect_b32 s46, s30, s46
  ds_read_b128 a[160:163], v3 offset:16384
  ds_read_b128 a[164:167], v3 offset:17408
  v_add_f32 v226, v216, v217
  v_mfma_f32_16x16x32_bf16 v[140:143], a[132:135], v[68:71], v[204:207]
  s_mov_b32 m0, s24
  v_exp_f32 v220, v148
  v_mfma_f32_16x16x32_bf16 v[128:131], a[136:139], v[72:75], v[128:131]
  ds_read_b128 a[168:171], v3 offset:18432
  buffer_load_dwordx4 v2, s[44:47], s26 offen offset:0 sc1 lds
  v_cvt_pk_bf16_f32 v184, v216, v217
  v_mfma_f32_16x16x32_bf16 v[136:139], a[136:139], v[76:79], v[136:139]
  v_exp_f32 v221, v149
  v_mfma_f32_16x16x32_bf16 v[132:135], a[140:143], v[72:75], v[132:135]
  s_add_u32 s14, s13, 40960
  ds_read_b128 a[172:175], v3 offset:19456
  buffer_load_dwordx4 a[28:31], v2, s[40:43], s14 offen offset:3072 sc1
  v_add_f32 v226, v226, v218
  v_add_f32 v226, v226, v219
  v_mfma_f32_16x16x32_bf16 v[140:143], a[140:143], v[76:79], v[140:143]
  s_waitcnt lgkmcnt(4)
  v_exp_f32 v222, v150
  v_mfma_f32_16x16x32_bf16 v[128:131], a[144:147], v[80:83], v[128:131]
  ds_read_b128 a[176:179], v3 offset:20480
  v_cvt_pk_bf16_f32 v185, v218, v219
  v_mfma_f32_16x16x32_bf16 v[136:139], a[144:147], v[84:87], v[136:139]
  v_exp_f32 v223, v151
  v_mfma_f32_16x16x32_bf16 v[132:135], a[148:151], v[80:83], v[132:135]
  ds_read_b128 a[180:183], v3 offset:21504
  buffer_load_dwordx4 v2, s[44:47], s26 offen offset:1024 sc1 lds
  v_add_f32 v226, v226, v220
  v_mfma_f32_16x16x32_bf16 v[140:143], a[148:151], v[84:87], v[140:143]
  v_exp_f32 v216, v152
  v_mfma_f32_16x16x32_bf16 v[128:131], a[152:155], v[88:91], v[128:131]
  ds_read_b128 a[184:187], v3 offset:22528
  v_add_f32 v226, v226, v221
  v_cvt_pk_bf16_f32 v186, v220, v221
  v_mfma_f32_16x16x32_bf16 v[136:139], a[152:155], v[92:95], v[136:139]
  v_exp_f32 v217, v153
  v_mfma_f32_16x16x32_bf16 v[132:135], a[156:159], v[88:91], v[132:135]
  ds_read_b128 a[188:191], v3 offset:23552
  buffer_load_dwordx4 a[24:27], v2, s[40:43], s14 offen offset:2048 sc1
  v_add_f32 v226, v226, v222
  v_mfma_f32_16x16x32_bf16 v[140:143], a[156:159], v[92:95], v[140:143]
  s_waitcnt lgkmcnt(4)
  v_exp_f32 v218, v154
  v_mfma_f32_16x16x32_bf16 a[64:67], a[160:163], v[176:179], a[64:67]
  ds_read_b128 a[128:131], v3 offset:0
  v_add_f32 v226, v226, v223
  v_cvt_pk_bf16_f32 v187, v222, v223
  v_mfma_f32_16x16x32_bf16 a[68:71], a[160:163], v[180:183], a[68:71]
  v_exp_f32 v219, v155
  v_mfma_f32_16x16x32_bf16 a[72:75], a[164:167], v[176:179], a[72:75]
  ds_read_b128 a[132:135], v3 offset:1024
  buffer_load_dwordx4 v2, s[44:47], s26 offen offset:2048 sc1 lds
  v_add_f32 v227, v216, v217
  v_mfma_f32_16x16x32_bf16 a[76:79], a[164:167], v[180:183], a[76:79]
  v_exp_f32 v220, v156
  v_mfma_f32_16x16x32_bf16 a[80:83], a[168:171], v[176:179], a[80:83]
  ds_read_b128 a[136:139], v3 offset:2048
  buffer_load_dwordx4 a[20:23], v2, s[40:43], s14 offen offset:1024 sc1
  v_cvt_pk_bf16_f32 v188, v216, v217
  v_mfma_f32_16x16x32_bf16 a[84:87], a[168:171], v[180:183], a[84:87]
  v_exp_f32 v221, v157
  v_mfma_f32_16x16x32_bf16 a[88:91], a[172:175], v[176:179], a[88:91]
  ds_read_b128 a[140:143], v3 offset:3072
  v_add_f32 v227, v227, v218
  v_add_f32 v227, v227, v219
  v_mfma_f32_16x16x32_bf16 a[92:95], a[172:175], v[180:183], a[92:95]
  s_waitcnt lgkmcnt(4)
  v_exp_f32 v222, v158
  v_mfma_f32_16x16x32_bf16 a[96:99], a[176:179], v[176:179], a[96:99]
  ds_read_b128 a[144:147], v3 offset:4096
  buffer_load_dwordx4 v2, s[44:47], s26 offen offset:3072 sc1 lds
  v_cvt_pk_bf16_f32 v189, v218, v219
  v_mfma_f32_16x16x32_bf16 a[100:103], a[176:179], v[180:183], a[100:103]
  s_add_u32 s26, s26, 16384
  v_exp_f32 v223, v159
  v_mfma_f32_16x16x32_bf16 a[104:107], a[180:183], v[176:179], a[104:107]
  s_add_u32 s24, s24, 32768
  ds_read_b128 a[148:151], v3 offset:5120
  buffer_load_dwordx4 a[16:19], v2, s[40:43], s14 offen offset:0 sc1
  v_add_f32 v227, v227, v220
  v_mfma_f32_16x16x32_bf16 a[108:111], a[180:183], v[180:183], a[108:111]
  s_and_b32 s24, s24, 0x1ffff
  v_add_f32 v227, v227, v221
  v_cvt_pk_bf16_f32 v190, v220, v221
  v_add_f32 v227, v227, v222
  v_mfma_f32_16x16x32_bf16 a[112:115], a[184:187], v[176:179], a[112:115]
  ds_read_b128 a[152:155], v3 offset:6144
  v_add_f32 v227, v227, v223
  v_max_f32 v5, v226, v227
  v_cmp_lt_f32 vcc, s81, v5
  v_mfma_f32_16x16x32_bf16 a[116:119], a[184:187], v[180:183], a[116:119]
  v_exp_f32 v216, v128
  v_mfma_f32_16x16x32_bf16 a[120:123], a[188:191], v[176:179], a[120:123]
  s_waitcnt lgkmcnt(3)
  ds_read_b128 a[156:159], v3 offset:7168
  v_cvt_pk_bf16_f32 v191, v222, v223
  v_mfma_f32_16x16x32_bf16 a[124:127], a[188:191], v[180:183], a[124:127]
  s_cbranch_vccnz fa_stub22
fa_back22:
  v_exp_f32 v217, v129
  v_add_f32 v230, v230, v226
  v_add_f32 v231, v231, v227
  v_mfma_f32_16x16x32_bf16 v[144:147], a[128:131], v[64:67], v[200:203]
  ds_read_b128 a[160:163], v3 offset:24576
  v_add_f32 v226, v216, v217
  v_mfma_f32_16x16x32_bf16 v[152:155], a[128:131], v[68:71], v[204:207]
  v_exp_f32 v218, v130
  v_mfma_f32_16x16x32_bf16 v[148:151], a[132:135], v[64:67], v[200:203]
  s_cmp_ge_u32 s27, s50
  s_cselect_b64 s[48:49], s[6:7], s[48:49]
  s_cselect_b32 s50, s30, s50
  ds_read_b128 a[164:167], v3 offset:25600
  v_cvt_pk_bf16_f32 v176, v216, v217
  v_mfma_f32_16x16x32_bf16 v[156:159], a[132:135], v[68:71], v[204:207]
  s_mov_b32 m0, s25
  v_exp_f32 v219, v131
  v_mfma_f32_16x16x32_bf16 v[144:147], a[136:139], v[72:75], v[144:147]
  s_add_u32 s66, s66, 32768
  ds_read_b128 a[168:171], v3 offset:26624
  buffer_load_dwordx4 v2, s[48:51], s27 offen offset:0 sc1 lds
  v_add_f32 v226, v226, v218
  v_add_f32 v226, v226, v219
  v_mfma_f32_16x16x32_bf16 v[152:155], a[136:139], v[76:79], v[152:155]
  s_and_b32 s66, s66, 0x1ffff
  v_exp_f32 v220, v132
  v_mfma_f32_16x16x32_bf16 v[148:151], a[140:143], v[72:75], v[148:151]
  s_add_u32 s14, s13, 28672
  ds_read_b128 a[172:175], v3 offset:27648
  buffer_load_dwordx4 a[12:15], v2, s[40:43], s14 offen offset:3072 sc1
  v_cvt_pk_bf16_f32 v177, v218, v219
  v_mfma_f32_16x16x32_bf16 v[156:159], a[140:143], v[76:79], v[156:159]
  s_waitcnt lgkmcnt(4)
  v_exp_f32 v221, v133
  v_mfma_f32_16x16x32_bf16 v[144:147], a[144:147], v[80:83], v[144:147]
  ds_read_b128 a[176:179], v3 offset:28672
  v_add_f32 v226, v226, v220
  v_mfma_f32_16x16x32_bf16 v[152:155], a[144:147], v[84:87], v[152:155]
  v_exp_f32 v222, v134
  v_mfma_f32_16x16x32_bf16 v[148:151], a[148:151], v[80:83], v[148:151]
  ds_read_b128 a[180:183], v3 offset:29696
  buffer_load_dwordx4 v2, s[48:51], s27 offen offset:1024 sc1 lds
  v_add_f32 v226, v226, v221
  v_cvt_pk_bf16_f32 v178, v220, v221
  v_mfma_f32_16x16x32_bf16 v[156:159], a[148:151], v[84:87], v[156:159]
  v_exp_f32 v223, v135
  v_mfma_f32_16x16x32_bf16 v[144:147], a[152:155], v[88:91], v[144:147]
  ds_read_b128 a[184:187], v3 offset:30720
  v_add_f32 v226, v226, v222
  v_mfma_f32_16x16x32_bf16 v[152:155], a[152:155], v[92:95], v[152:155]
  v_exp_f32 v216, v136
  v_mfma_f32_16x16x32_bf16 v[148:151], a[156:159], v[88:91], v[148:151]
  ds_read_b128 a[188:191], v3 offset:31744
  buffer_load_dwordx4 a[8:11], v2, s[40:43], s14 offen offset:2048 sc1
  v_add_f32 v226, v226, v223
  v_exp_f32 v217, v137
  v_mfma_f32_16x16x32_bf16 v[156:159], a[156:159], v[92:95], v[156:159]
  s_waitcnt lgkmcnt(4)
  v_exp_f32 v218, v138
  v_mfma_f32_16x16x32_bf16 a[64:67], a[160:163], v[184:187], a[64:67]
  ds_read_b128 a[128:131], v3 offset:8192
  v_cvt_pk_bf16_f32 v179, v222, v223
  v_mfma_f32_16x16x32_bf16 a[68:71], a[160:163], v[188:191], a[68:71]
  v_exp_f32 v219, v139
  v_mfma_f32_16x16x32_bf16 a[72:75], a[164:167], v[184:187], a[72:75]
  ds_read_b128 a[132:135], v3 offset:9216
  buffer_load_dwordx4 v2, s[48:51], s27 offen offset:2048 sc1 lds
  v_add_f32 v227, v216, v217
  v_mfma_f32_16x16x32_bf16 a[76:79], a[164:167], v[188:191], a[76:79]
  v_exp_f32 v220, v140
  v_mfma_f32_16x16x32_bf16 a[80:83], a[168:171], v[184:187], a[80:83]
  ds_read_b128 a[136:139], v3 offset:10240
  buffer_load_dwordx4 a[4:7], v2, s[40:43], s14 offen offset:1024 sc1
  v_cvt_pk_bf16_f32 v180, v216, v217
  v_mfma_f32_16x16x32_bf16 a[84:87], a[168:171], v[188:191], a[84:87]
  v_exp_f32 v221, v141
  v_mfma_f32_16x16x32_bf16 a[88:91], a[172:175], v[184:187], a[88:91]
  ds_read_b128 a[140:143], v3 offset:11264
  v_add_f32 v227, v227, v218
  v_mfma_f32_16x16x32_bf16 a[92:95], a[172:175], v[188:191], a[92:95]
  s_waitcnt lgkmcnt(4)
  v_exp_f32 v222, v142
  v_mfma_f32_16x16x32_bf16 a[96:99], a[176:179], v[184:187], a[96:99]
  ds_read_b128 a[144:147], v3 offset:12288
  buffer_load_dwordx4 v2, s[48:51], s27 offen offset:3072 sc1 lds
  v_add_f32 v227, v227, v219
  v_cvt_pk_bf16_f32 v181, v218, v219
  v_mfma_f32_16x16x32_bf16 a[100:103], a[176:179], v[188:191], a[100:103]
  s_add_u32 s27, s27, 16384
  v_exp_f32 v223, v143
  v_mfma_f32_16x16x32_bf16 a[104:107], a[180:183], v[184:187], a[104:107]
  s_add_u32 s25, s25, 32768
  ds_read_b128 a[148:151], v3 offset:13312
  buffer_load_dwordx4 a[0:3], v2, s[40:43], s14 offen offset:0 sc1
  v_add_f32 v227, v227, v220
  v_mfma_f32_16x16x32_bf16 a[108:111], a[180:183], v[188:191], a[108:111]
  s_and_b32 s25, s25, 0x1ffff
  v_add_f32 v227, v227, v221
  v_cvt_pk_bf16_f32 v182, v220, v221
  v_add_f32 v227, v227, v222
  v_mfma_f32_16x16x32_bf16 a[112:115], a[184:187], v[184:187], a[112:115]
  ds_read_b128 a[152:155], v3 offset:14336
  v_add_f32 v227, v227, v223
  v_max_f32 v5, v226, v227
  v_cmp_lt_f32 vcc, s81, v5
  v_mfma_f32_16x16x32_bf16 a[116:119], a[184:187], v[188:191], a[116:119]
  v_exp_f32 v216, v144
  v_mfma_f32_16x16x32_bf16 a[120:123], a[188:191], v[184:187], a[120:123]
  s_waitcnt lgkmcnt(3)
  ds_read_b128 a[156:159], v3 offset:15360
  v_cvt_pk_bf16_f32 v183, v222, v223
  v_add_u32 v3, s66, v2
  v_mfma_f32_16x16x32_bf16 a[124:127], a[188:191], v[188:191], a[124:127]
  s_cbranch_vccnz fa_stub23
fa_back23:
  v_exp_f32 v217, v145
  v_add_f32 v230, v230, v226
  v_add_f32 v231, v231, v227
fa_SSW2:
  v_mfma_f32_16x16x32_bf16 v[128:131], a[128:131], v[64:67], v[200:203]
  s_waitcnt vmcnt(12)
  v_exp_f32 v218, v146
  v_mfma_f32_16x16x32_bf16 v[136:139], a[128:131], v[68:71], v[204:207]
  s_barrier
  v_exp_f32 v219, v147
  v_mfma_f32_16x16x32_bf16 v[132:135], a[132:135], v[64:67], v[200:203]
  s_cmp_ge_u32 s26, s46
  s_cselect_b64 s[44:45], s[4:5], s[44:45]
  s_cselect_b32 s46, s30, s46
  ds_read_b128 a[160:163], v3 offset:16384
  ds_read_b128 a[164:167], v3 offset:17408
  v_add_f32 v226, v216, v217
  v_mfma_f32_16x16x32_bf16 v[140:143], a[132:135], v[68:71], v[204:207]
  s_mov_b32 m0, s24
  v_exp_f32 v220, v148
  v_mfma_f32_16x16x32_bf16 v[128:131], a[136:139], v[72:75], v[128:131]
  ds_read_b128 a[168:171], v3 offset:18432
  buffer_load_dwordx4 v2, s[44:47], s26 offen offset:0 sc1 lds
  v_cvt_pk_bf16_f32 v184, v216, v217
  v_mfma_f32_16x16x32_bf16 v[136:139], a[136:139], v[76:79], v[136:139]
  v_exp_f32 v221, v149
  v_mfma_f32_16x16x32_bf16 v[132:135], a[140:143], v[72:75], v[132:135]
  s_add_u32 s14, s13, 24576
  ds_read_b128 a[172:175], v3 offset:19456
  buffer_load_dwordx4 v[212:215], v2, s[40:43], s14 offen offset:3072 sc1
  v_add_f32 v226, v226, v218
  v_add_f32 v226, v226, v219
  v_mfma_f32_16x16x32_bf16 v[140:143], a[140:143], v[76:79], v[140:143]
  s_waitcnt lgkmcnt(4)
  v_exp_f32 v222, v150
  v_mfma_f32_16x16x32_bf16 v[128:131], a[144:147], v[80:83], v[128:131]
  ds_read_b128 a[176:179], v3 offset:20480
  v_cvt_pk_bf16_f32 v185, v218, v219
  v_mfma_f32_16x16x32_bf16 v[136:139], a[144:147], v[84:87], v[136:139]
  v_exp_f32 v223, v151
  v_mfma_f32_16x16x32_bf16 v[132:135], a[148:151], v[80:83], v[132:135]
  ds_read_b128 a[180:183], v3 offset:21504
  buffer_load_dwordx4 v2, s[44:47], s26 offen offset:1024 sc1 lds
  v_add_f32 v226, v226, v220
  v_mfma_f32_16x16x32_bf16 v[140:143], a[148:151], v[84:87], v[140:143]
  v_exp_f32 v216, v152
  v_mfma_f32_16x16x32_bf16 v[128:131], a[152:155], v[88:91], v[128:131]
  ds_read_b128 a[184:187], v3 offset:22528
  v_add_f32 v226, v226, v221
  v_cvt_pk_bf16_f32 v186, v220, v221
  v_mfma_f32_16x16x32_bf16 v[136:139], a[152:155], v[92:95], v[136:139]
  v_exp_f32 v217, v153
  v_mfma_f32_16x16x32_bf16 v[132:135], a[156:159], v[88:91], v[132:135]
  ds_read_b128 a[188:191], v3 offset:23552
  buffer_load_dwordx4 v[208:211], v2, s[40:43], s14 offen offset:2048 sc1
  v_add_f32 v226, v226, v222
  v_mfma_f32_16x16x32_bf16 v[140:143], a[156:159], v[92:95], v[140:143]
  s_waitcnt lgkmcnt(4)
  v_exp_f32 v218, v154
  v_mfma_f32_16x16x32_bf16 a[64:67], a[160:163], v[176:179], a[64:67]
  ds_read_b128 a[128:131], v3 offset:0
  v_add_f32 v226, v226, v223
  v_cvt_pk_bf16_f32 v187, v222, v223
  v_mfma_f32_16x16x32_bf16 a[68:71], a[160:163], v[180:183], a[68:71]
  v_exp_f32 v219, v155
  v_mfma_f32_16x16x32_bf16 a[72:75], a[164:167], v[176:179], a[72:75]
  ds_read_b128 a[132:135], v3 offset:1024
  buffer_load_dwordx4 v2, s[44:47], s26 offen offset:2048 sc1 lds
  v_add_f32 v227, v216, v217
  v_mfma_f32_16x16x32_bf16 a[76:79], a[164:167], v[180:183], a[76:79]
  v_exp_f32 v220, v156
  v_mfma_f32_16x16x32_bf16 a[80:83], a[168:171], v[176:179], a[80:83]
  ds_read_b128 a[136:139], v3 offset:2048
  buffer_load_dwordx4 v[196:199], v2, s[40:43], s14 offen offset:1024 sc1
  v_cvt_pk_bf16_f32 v188, v216, v217
  v_mfma_f32_16x16x32_bf16 a[84:87], a[168:171], v[180:183], a[84:87]
  v_exp_f32 v221, v157
  v_mfma_f32_16x16x32_bf16 a[88:91], a[172:175], v[176:179], a[88:91]
  ds_read_b128 a[140:143], v3 offset:3072
  v_add_f32 v227, v227, v218
  v_add_f32 v227, v227, v219
  v_mfma_f32_16x16x32_bf16 a[92:95], a[172:175], v[180:183], a[92:95]
  s_waitcnt lgkmcnt(4)
  v_exp_f32 v222, v158
  v_mfma_f32_16x16x32_bf16 a[96:99], a[176:179], v[176:179], a[96:99]
  ds_read_b128 a[144:147], v3 offset:4096
  buffer_load_dwordx4 v2, s[44:47], s26 offen offset:3072 sc1 lds
  v_cvt_pk_bf16_f32 v189, v218, v219
  v_mfma_f32_16x16x32_bf16 a[100:103], a[176:179], v[180:183], a[100:103]
  s_add_u32 s26, s26, 16384
  v_exp_f32 v223, v159
  v_mfma_f32_16x16x32_bf16 a[104:107], a[180:183], v[176:179], a[104:107]
  s_add_u32 s24, s24, 32768
  ds_read_b128 a[148:151], v3 offset:5120
  buffer_load_dwordx4 v[192:195], v2, s[40:43], s14 offen offset:0 sc1
  v_add_f32 v227, v227, v220
  v_mfma_f32_16x16x32_bf16 a[108:111], a[180:183], v[180:183], a[108:111]
  s_and_b32 s24, s24, 0x1ffff
  v_add_f32 v227, v227, v221
  v_cvt_pk_bf16_f32 v190, v220, v221
  v_add_f32 v227, v227, v222
  v_mfma_f32_16x16x32_bf16 a[112:115], a[184:187], v[176:179], a[112:115]
  ds_read_b128 a[152:155], v3 offset:6144
  v_add_f32 v227, v227, v223
  v_max_f32 v5, v226, v227
  v_cmp_lt_f32 vcc, s81, v5
  v_mfma_f32_16x16x32_bf16 a[116:119], a[184:187], v[180:183], a[116:119]
  v_exp_f32 v216, v128
  v_mfma_f32_16x16x32_bf16 a[120:123], a[188:191], v[176:179], a[120:123]
  s_waitcnt lgkmcnt(3)
  ds_read_b128 a[156:159], v3 offset:7168
  v_cvt_pk_bf16_f32 v191, v222, v223
  v_mfma_f32_16x16x32_bf16 a[124:127], a[188:191], v[180:183], a[124:127]
  s_cbranch_vccnz fa_stub24
fa_back24:
  v_exp_f32 v217, v129
  v_add_f32 v230, v230, v226
  v_add_f32 v231, v231, v227
  v_mfma_f32_16x16x32_bf16 v[144:147], a[128:131], v[64:67], v[200:203]
  ds_read_b128 a[160:163], v3 offset:24576
  v_add_f32 v226, v216, v217
  v_mfma_f32_16x16x32_bf16 v[152:155], a[128:131], v[68:71], v[204:207]
  v_exp_f32 v218, v130
  v_mfma_f32_16x16x32_bf16 v[148:151], a[132:135], v[64:67], v[200:203]
  s_cmp_ge_u32 s27, s50
  s_cselect_b64 s[48:49], s[6:7], s[48:49]
  s_cselect_b32 s50, s30, s50
  ds_read_b128 a[164:167], v3 offset:25600
  v_cvt_pk_bf16_f32 v176, v216, v217
  v_mfma_f32_16x16x32_bf16 v[156:159], a[132:135], v[68:71], v[204:207]
  s_mov_b32 m0, s25
  v_exp_f32 v219, v131
  v_mfma_f32_16x16x32_bf16 v[144:147], a[136:139], v[72:75], v[144:147]
  s_add_u32 s66, s66, 32768
  ds_read_b128 a[168:171], v3 offset:26624
  buffer_load_dwordx4 v2, s[48:51], s27 offen offset:0 sc1 lds
  v_add_f32 v226, v226, v218
  v_add_f32 v226, v226, v219
  v_mfma_f32_16x16x32_bf16 v[152:155], a[136:139], v[76:79], v[152:155]
  s_and_b32 s66, s66, 0x1ffff
  v_exp_f32 v220, v132
  v_mfma_f32_16x16x32_bf16 v[148:151], a[140:143], v[72:75], v[148:151]
  s_add_u32 s14, s13, 20480
  ds_read_b128 a[172:175], v3 offset:27648
  buffer_load_dwordx4 v[244:247], v2, s[40:43], s14 offen offset:3072 sc1
  v_cvt_pk_bf16_f32 v177, v218, v219
  v_mfma_f32_16x16x32_bf16 v[156:159], a[140:143], v[76:79], v[156:159]
  s_waitcnt lgkmcnt(4)
  v_exp_f32 v221, v133
  v_mfma_f32_16x16x32_bf16 v[144:147], a[144:147], v[80:83], v[144:147]
  ds_read_b128 a[176:179], v3 offset:28672
  v_add_f32 v226, v226, v220
  v_mfma_f32_16x16x32_bf16 v[152:155], a[144:147], v[84:87], v[152:155]
  v_exp_f32 v222, v134
  v_mfma_f32_16x16x32_bf16 v[148:151], a[148:151], v[80:83], v[148:151]
  ds_read_b128 a[180:183], v3 offset:29696
  buffer_load_dwordx4 v2, s[48:51], s27 offen offset:1024 sc1 lds
  v_add_f32 v226, v226, v221
  v_cvt_pk_bf16_f32 v178, v220, v221
  v_mfma_f32_16x16x32_bf16 v[156:159], a[148:151], v[84:87], v[156:159]
  v_exp_f32 v223, v135
  v_mfma_f32_16x16x32_bf16 v[144:147], a[152:155], v[88:91], v[144:147]
  ds_read_b128 a[184:187], v3 offset:30720
  v_add_f32 v226, v226, v222
  v_mfma_f32_16x16x32_bf16 v[152:155], a[152:155], v[92:95], v[152:155]
  v_exp_f32 v216, v136
  v_mfma_f32_16x16x32_bf16 v[148:151], a[156:159], v[88:91], v[148:151]
  ds_read_b128 a[188:191], v3 offset:31744
  buffer_load_dwordx4 v[240:243], v2, s[40:43], s14 offen offset:2048 sc1
  v_add_f32 v226, v226, v223
  v_exp_f32 v217, v137
  v_mfma_f32_16x16x32_bf16 v[156:159], a[156:159], v[92:95], v[156:159]
  s_waitcnt lgkmcnt(4)
  v_exp_f32 v218, v138
  v_mfma_f32_16x16x32_bf16 a[64:67], a[160:163], v[184:187], a[64:67]
  ds_read_b128 a[128:131], v3 offset:8192
  v_cvt_pk_bf16_f32 v179, v222, v223
  v_mfma_f32_16x16x32_bf16 a[68:71], a[160:163], v[188:191], a[68:71]
  v_exp_f32 v219, v139
  v_mfma_f32_16x16x32_bf16 a[72:75], a[164:167], v[184:187], a[72:75]
  ds_read_b128 a[132:135], v3 offset:9216
  buffer_load_dwordx4 v2, s[48:51], s27 offen offset:2048 sc1 lds
  v_add_f32 v227, v216, v217
  v_mfma_f32_16x16x32_bf16 a[76:79], a[164:167], v[188:191], a[76:79]
  v_exp_f32 v220, v140
  v_mfma_f32_16x16x32_bf16 a[80:83], a[168:171], v[184:187], a[80:83]
  ds_read_b128 a[136:139], v3 offset:10240
  buffer_load_dwordx4 v[236:239], v2, s[40:43], s14 offen offset:1024 sc1
  v_cvt_pk_bf16_f32 v180, v216, v217
  v_mfma_f32_16x16x32_bf16 a[84:87], a[168:171], v[188:191], a[84:87]
  v_exp_f32 v221, v141
  v_mfma_f32_16x16x32_bf16 a[88:91], a[172:175], v[184:187], a[88:91]
  ds_read_b128 a[140:143], v3 offset:11264
  v_add_f32 v227, v227, v218
  v_mfma_f32_16x16x32_bf16 a[92:95], a[172:175], v[188:191], a[92:95]
  s_waitcnt lgkmcnt(4)
  v_exp_f32 v222, v142
  v_mfma_f32_16x16x32_bf16 a[96:99], a[176:179], v[184:187], a[96:99]
  ds_read_b128 a[144:147], v3 offset:12288
  buffer_load_dwordx4 v2, s[48:51], s27 offen offset:3072 sc1 lds
  v_add_f32 v227, v227, v219
  v_cvt_pk_bf16_f32 v181, v218, v219
  v_mfma_f32_16x16x32_bf16 a[100:103], a[176:179], v[188:191], a[100:103]
  s_add_u32 s27, s27, 16384
  v_exp_f32 v223, v143
  v_mfma_f32_16x16x32_bf16 a[104:107], a[180:183], v[184:187], a[104:107]
  s_add_u32 s25, s25, 32768
  ds_read_b128 a[148:151], v3 offset:13312
  buffer_load_dwordx4 v[232:235], v2, s[40:43], s14 offen offset:0 sc1
  v_add_f32 v227, v227, v220
  v_mfma_f32_16x16x32_bf16 a[108:111], a[180:183], v[188:191], a[108:111]
  s_and_b32 s25, s25, 0x1ffff
  v_add_f32 v227, v227, v221
  v_cvt_pk_bf16_f32 v182, v220, v221
  v_add_f32 v227, v227, v222
  v_mfma_f32_16x16x32_bf16 a[112:115], a[184:187], v[184:187], a[112:115]
  ds_read_b128 a[152:155], v3 offset:14336
  v_add_f32 v227, v227, v223
  v_max_f32 v5, v226, v227
  v_cmp_lt_f32 vcc, s81, v5
  v_mfma_f32_16x16x32_bf16 a[116:119], a[184:187], v[188:191], a[116:119]
  v_exp_f32 v216, v144
  v_mfma_f32_16x16x32_bf16 a[120:123], a[188:191], v[184:187], a[120:123]
  s_waitcnt lgkmcnt(3)
  ds_read_b128 a[156:159], v3 offset:15360
  v_cvt_pk_bf16_f32 v183, v222, v223
  v_add_u32 v3, s66, v2
  v_mfma_f32_16x16x32_bf16 a[124:127], a[188:191], v[188:191], a[124:127]
  s_cbranch_vccnz fa_stub25
fa_back25:
  v_exp_f32 v217, v145
  v_add_f32 v230, v230, v226
  v_add_f32 v231, v231, v227
fa_SSW1:
  v_mfma_f32_16x16x32_bf16 v[128:131], a[128:131], v[64:67], v[200:203]
  s_waitcnt vmcnt(8)
  v_exp_f32 v218, v146
  v_mfma_f32_16x16x32_bf16 v[136:139], a[128:131], v[68:71], v[204:207]
  s_barrier
  v_exp_f32 v219, v147
  v_mfma_f32_16x16x32_bf16 v[132:135], a[132:135], v[64:67], v[200:203]
  s_cmp_ge_u32 s26, s46
  s_cselect_b64 s[44:45], s[4:5], s[44:45]
  s_cselect_b32 s46, s30, s46
  ds_read_b128 a[160:163], v3 offset:16384
  ds_read_b128 a[164:167], v3 offset:17408
  v_add_f32 v226, v216, v217
  v_mfma_f32_16x16x32_bf16 v[140:143], a[132:135], v[68:71], v[204:207]
  s_mov_b32 m0, s24
  v_exp_f32 v220, v148
  v_mfma_f32_16x16x32_bf16 v[128:131], a[136:139], v[72:75], v[128:131]
  ds_read_b128 a[168:171], v3 offset:18432
  buffer_load_dwordx4 v2, s[44:47], s26 offen offset:0 sc1 lds
  v_cvt_pk_bf16_f32 v184, v216, v217
  v_mfma_f32_16x16x32_bf16 v[136:139], a[136:139], v[76:79], v[136:139]
  v_exp_f32 v221, v149
  v_mfma_f32_16x16x32_bf16 v[132:135], a[140:143], v[72:75], v[132:135]
  s_add_u32 s14, s13, 16384
  ds_read_b128 a[172:175], v3 offset:19456
  buffer_load_dwordx4 v[172:175], v2, s[40:43], s14 offen offset:3072 sc1
  v_add_f32 v226, v226, v218
  v_add_f32 v226, v226, v219
  v_mfma_f32_16x16x32_bf16 v[140:143], a[140:143], v[76:79], v[140:143]
  s_waitcnt lgkmcnt(4)
  v_exp_f32 v222, v150
  v_mfma_f32_16x16x32_bf16 v[128:131], a[144:147], v[80:83], v[128:131]
  ds_read_b128 a[176:179], v3 offset:20480
  v_cvt_pk_bf16_f32 v185, v218, v219
  v_mfma_f32_16x16x32_bf16 v[136:139], a[144:147], v[84:87], v[136:139]
  v_exp_f32 v223, v151
  v_mfma_f32_16x16x32_bf16 v[132:135], a[148:151], v[80:83], v[132:135]
  ds_read_b128 a[180:183], v3 offset:21504
  buffer_load_dwordx4 v2, s[44:47], s26 offen offset:1024 sc1 lds
  v_add_f32 v226, v226, v220
  v_mfma_f32_16x16x32_bf16 v[140:143], a[148:151], v[84:87], v[140:143]
  v_exp_f32 v216, v152
  v_mfma_f32_16x16x32_bf16 v[128:131], a[152:155], v[88:91], v[128:131]
  ds_read_b128 a[184:187], v3 offset:22528
  v_add_f32 v226, v226, v221
  v_cvt_pk_bf16_f32 v186, v220, v221
  v_mfma_f32_16x16x32_bf16 v[136:139], a[152:155], v[92:95], v[136:139]
  v_exp_f32 v217, v153
  v_mfma_f32_16x16x32_bf16 v[132:135], a[156:159], v[88:91], v[132:135]
  ds_read_b128 a[188:191], v3 offset:23552
  buffer_load_dwordx4 v[168:171], v2, s[40:43], s14 offen offset:2048 sc1
  v_add_f32 v226, v226, v222
  v_mfma_f32_16x16x32_bf16 v[140:143], a[156:159], v[92:95], v[140:143]
  s_waitcnt lgkmcnt(4)
  v_exp_f32 v218, v154
  v_mfma_f32_16x16x32_bf16 a[64:67], a[160:163], v[176:179], a[64:67]
  ds_read_b128 a[128:131], v3 offset:0
  v_add_f32 v226, v226, v223
  v_cvt_pk_bf16_f32 v187, v222, v223
  v_mfma_f32_16x16x32_bf16 a[68:71], a[160:163], v[180:183], a[68:71]
  v_exp_f32 v219, v155
  v_mfma_f32_16x16x32_bf16 a[72:75], a[164:167], v[176:179], a[72:75]
  ds_read_b128 a[132:135], v3 offset:1024
  buffer_load_dwordx4 v2, s[44:47], s26 offen offset:2048 sc1 lds
  v_add_f32 v227, v216, v217
  v_mfma_f32_16x16x32_bf16 a[76:79], a[164:167], v[180:183], a[76:79]
  v_exp_f32 v220, v156
  v_mfma_f32_16x16x32_bf16 a[80:83], a[168:171], v[176:179], a[80:83]
  ds_read_b128 a[136:139], v3 offset:2048
  buffer_load_dwordx4 v[164:167], v2, s[40:43], s14 offen offset:1024 sc1
  v_cvt_pk_bf16_f32 v188, v216, v217
  v_mfma_f32_16x16x32_bf16 a[84:87], a[168:171], v[180:183], a[84:87]
  v_exp_f32 v221, v157
  v_mfma_f32_16x16x32_bf16 a[88:91], a[172:175], v[176:179], a[88:91]
  ds_read_b128 a[140:143], v3 offset:3072
  v_add_f32 v227, v227, v218
  v_add_f32 v227, v227, v219
  v_mfma_f32_16x16x32_bf16 a[92:95], a[172:175], v[180:183], a[92:95]
  s_waitcnt lgkmcnt(4)
  v_exp_f32 v222, v158
  v_mfma_f32_16x16x32_bf16 a[96:99], a[176:179], v[176:179], a[96:99]
  ds_read_b128 a[144:147], v3 offset:4096
  buffer_load_dwordx4 v2, s[44:47], s26 offen offset:3072 sc1 lds
  v_cvt_pk_bf16_f32 v189, v218, v219
  v_mfma_f32_16x16x32_bf16 a[100:103], a[176:179], v[180:183], a[100:103]
  s_add_u32 s26, s26, 16384
  v_exp_f32 v223, v159
  v_mfma_f32_16x16x32_bf16 a[104:107], a[180:183], v[176:179], a[104:107]
  s_add_u32 s24, s24, 32768
  ds_read_b128 a[148:151], v3 offset:5120
  buffer_load_dwordx4 v[160:163], v2, s[40:43], s14 offen offset:0 sc1
  v_add_f32 v227, v227, v220
  v_mfma_f32_16x16x32_bf16 a[108:111], a[180:183], v[180:183], a[108:111]
  s_and_b32 s24, s24, 0x1ffff
  v_add_f32 v227, v227, v221
  v_cvt_pk_bf16_f32 v190, v220, v221
  v_add_f32 v227, v227, v222
  v_mfma_f32_16x16x32_bf16 a[112:115], a[184:187], v[176:179], a[112:115]
  ds_read_b128 a[152:155], v3 offset:6144
  v_add_f32 v227, v227, v223
  v_max_f32 v5, v226, v227
  v_cmp_lt_f32 vcc, s81, v5
  v_mfma_f32_16x16x32_bf16 a[116:119], a[184:187], v[180:183], a[116:119]
  v_exp_f32 v216, v128
  v_mfma_f32_16x16x32_bf16 a[120:123], a[188:191], v[176:179], a[120:123]
  s_waitcnt lgkmcnt(3)
  ds_read_b128 a[156:159], v3 offset:7168
  v_cvt_pk_bf16_f32 v191, v222, v223
  v_mfma_f32_16x16x32_bf16 a[124:127], a[188:191], v[180:183], a[124:127]
  s_cbranch_vccnz fa_stub26
fa_back26:
  v_exp_f32 v217, v129
  v_add_f32 v230, v230, v226
  v_add_f32 v231, v231, v227
  v_mfma_f32_16x16x32_bf16 v[144:147], a[128:131], v[64:67], v[200:203]
  ds_read_b128 a[160:163], v3 offset:24576
  v_add_f32 v226, v216, v217
  v_mfma_f32_16x16x32_bf16 v[152:155], a[128:131], v[68:71], v[204:207]
  v_exp_f32 v218, v130
  v_mfma_f32_16x16x32_bf16 v[148:151], a[132:135], v[64:67], v[200:203]
  s_cmp_ge_u32 s27, s50
  s_cselect_b64 s[48:49], s[6:7], s[48:49]
  s_cselect_b32 s50, s30, s50
  ds_read_b128 a[164:167], v3 offset:25600
  v_cvt_pk_bf16_f32 v176, v216, v217
  v_mfma_f32_16x16x32_bf16 v[156:159], a[132:135], v[68:71], v[204:207]
  s_mov_b32 m0, s25
  v_exp_f32 v219, v131
  v_mfma_f32_16x16x32_bf16 v[144:147], a[136:139], v[72:75], v[144:147]
  s_add_u32 s66, s66, 32768
  ds_read_b128 a[168:171], v3 offset:26624
  buffer_load_dwordx4 v2, s[48:51], s27 offen offset:0 sc1 lds
  v_add_f32 v226, v226, v218
  v_add_f32 v226, v226, v219
  v_mfma_f32_16x16x32_bf16 v[152:155], a[136:139], v[76:79], v[152:155]
  s_and_b32 s66, s66, 0x1ffff
  v_exp_f32 v220, v132
  v_mfma_f32_16x16x32_bf16 v[148:151], a[140:143], v[72:75], v[148:151]
  s_add_u32 s14, s13, 12288
  ds_read_b128 a[172:175], v3 offset:27648
  buffer_load_dwordx4 v[124:127], v2, s[40:43], s14 offen offset:3072 sc1
  v_cvt_pk_bf16_f32 v177, v218, v219
  v_mfma_f32_16x16x32_bf16 v[156:159], a[140:143], v[76:79], v[156:159]
  s_waitcnt lgkmcnt(4)
  v_exp_f32 v221, v133
  v_mfma_f32_16x16x32_bf16 v[144:147], a[144:147], v[80:83], v[144:147]
  ds_read_b128 a[176:179], v3 offset:28672
  v_add_f32 v226, v226, v220
  v_mfma_f32_16x16x32_bf16 v[152:155], a[144:147], v[84:87], v[152:155]
  v_exp_f32 v222, v134
  v_mfma_f32_16x16x32_bf16 v[148:151], a[148:151], v[80:83], v[148:151]
  ds_read_b128 a[180:183], v3 offset:29696
  buffer_load_dwordx4 v2, s[48:51], s27 offen offset:1024 sc1 lds
  v_add_f32 v226, v226, v221
  v_cvt_pk_bf16_f32 v178, v220, v221
  v_mfma_f32_16x16x32_bf16 v[156:159], a[148:151], v[84:87], v[156:159]
  v_exp_f32 v223, v135
  v_mfma_f32_16x16x32_bf16 v[144:147], a[152:155], v[88:91], v[144:147]
  ds_read_b128 a[184:187], v3 offset:30720
  v_add_f32 v226, v226, v222
  v_mfma_f32_16x16x32_bf16 v[152:155], a[152:155], v[92:95], v[152:155]
  v_exp_f32 v216, v136
  v_mfma_f32_16x16x32_bf16 v[148:151], a[156:159], v[88:91], v[148:151]
  ds_read_b128 a[188:191], v3 offset:31744
  buffer_load_dwordx4 v[120:123], v2, s[40:43], s14 offen offset:2048 sc1
  v_add_f32 v226, v226, v223
  v_exp_f32 v217, v137
  v_mfma_f32_16x16x32_bf16 v[156:159], a[156:159], v[92:95], v[156:159]
  s_waitcnt lgkmcnt(4)
  v_exp_f32 v218, v138
  v_mfma_f32_16x16x32_bf16 a[64:67], a[160:163], v[184:187], a[64:67]
  ds_read_b128 a[128:131], v3 offset:8192
  v_cvt_pk_bf16_f32 v179, v222, v223
  v_mfma_f32_16x16x32_bf16 a[68:71], a[160:163], v[188:191], a[68:71]
  v_exp_f32 v219, v139
  v_mfma_f32_16x16x32_bf16 a[72:75], a[164:167], v[184:187], a[72:75]
  ds_read_b128 a[132:135], v3 offset:9216
  buffer_load_dwordx4 v2, s[48:51], s27 offen offset:2048 sc1 lds
  v_add_f32 v227, v216, v217
  v_mfma_f32_16x16x32_bf16 a[76:79], a[164:167], v[188:191], a[76:79]
  v_exp_f32 v220, v140
  v_mfma_f32_16x16x32_bf16 a[80:83], a[168:171], v[184:187], a[80:83]
  ds_read_b128 a[136:139], v3 offset:10240
  buffer_load_dwordx4 v[116:119], v2, s[40:43], s14 offen offset:1024 sc1
  v_cvt_pk_bf16_f32 v180, v216, v217
  v_mfma_f32_16x16x32_bf16 a[84:87], a[168:171], v[188:191], a[84:87]
  v_exp_f32 v221, v141
  v_mfma_f32_16x16x32_bf16 a[88:91], a[172:175], v[184:187], a[88:91]
  ds_read_b128 a[140:143], v3 offset:11264
  v_add_f32 v227, v227, v218
  v_mfma_f32_16x16x32_bf16 a[92:95], a[172:175], v[188:191], a[92:95]
  s_waitcnt lgkmcnt(4)
  v_exp_f32 v222, v142
  v_mfma_f32_16x16x32_bf16 a[96:99], a[176:179], v[184:187], a[96:99]
  ds_read_b128 a[144:147], v3 offset:12288
  buffer_load_dwordx4 v2, s[48:51], s27 offen offset:3072 sc1 lds
  v_add_f32 v227, v227, v219
  v_cvt_pk_bf16_f32 v181, v218, v219
  v_mfma_f32_16x16x32_bf16 a[100:103], a[176:179], v[188:191], a[100:103]
  s_add_u32 s27, s27, 16384
  v_exp_f32 v223, v143
  v_mfma_f32_16x16x32_bf16 a[104:107], a[180:183], v[184:187], a[104:107]
  s_add_u32 s25, s25, 32768
  ds_read_b128 a[148:151], v3 offset:13312
  buffer_load_dwordx4 v[112:115], v2, s[40:43], s14 offen offset:0 sc1
  v_add_f32 v227, v227, v220
  v_mfma_f32_16x16x32_bf16 a[108:111], a[180:183], v[188:191], a[108:111]
  s_and_b32 s25, s25, 0x1ffff
  v_add_f32 v227, v227, v221
  v_cvt_pk_bf16_f32 v182, v220, v221
  v_add_f32 v227, v227, v222
  v_mfma_f32_16x16x32_bf16 a[112:115], a[184:187], v[184:187], a[112:115]
  ds_read_b128 a[152:155], v3 offset:14336
  v_add_f32 v227, v227, v223
  v_max_f32 v5, v226, v227
  v_cmp_lt_f32 vcc, s81, v5
  v_mfma_f32_16x16x32_bf16 a[116:119], a[184:187], v[188:191], a[116:119]
  v_exp_f32 v216, v144
  v_mfma_f32_16x16x32_bf16 a[120:123], a[188:191], v[184:187], a[120:123]
  s_waitcnt lgkmcnt(3)
  ds_read_b128 a[156:159], v3 offset:15360
  v_cvt_pk_bf16_f32 v183, v222, v223
  v_add_u32 v3, s66, v2
  v_mfma_f32_16x16x32_bf16 a[124:127], a[188:191], v[188:191], a[124:127]
  s_cbranch_vccnz fa_stub27
fa_back27:
  v_exp_f32 v217, v145
  v_add_f32 v230, v230, v226
  v_add_f32 v231, v231, v227
fa_Bexit:
  s_bitcmp1_b32 s20, 0
  s_cbranch_scc1 fa_Bodd
  v_mfma_f32_16x16x32_bf16 v[128:131], a[128:131], v[64:67], v[200:203]
  s_waitcnt vmcnt(8)
  v_exp_f32 v218, v146
  v_mfma_f32_16x16x32_bf16 v[136:139], a[128:131], v[68:71], v[204:207]
  s_barrier
  v_exp_f32 v219, v147
  v_mfma_f32_16x16x32_bf16 v[132:135], a[132:135], v[64:67], v[200:203]
  ds_read_b128 a[160:163], v3 offset:16384
  ds_read_b128 a[164:167], v3 offset:17408
  v_add_f32 v226, v216, v217
  v_mfma_f32_16x16x32_bf16 v[140:143], a[132:135], v[68:71], v[204:207]
  s_add_u32 s14, s13, 8192
  buffer_load_dwordx4 v[108:111], v2, s[40:43], s14 offen offset:3072 sc1
  v_cvt_pk_bf16_f32 v184, v216, v217
  v_mfma_f32_16x16x32_bf16 v[128:131], a[136:139], v[72:75], v[128:131]
  ds_read_b128 a[168:171], v3 offset:18432
  v_add_f32 v226, v226, v218
  v_mfma_f32_16x16x32_bf16 v[136:139], a[136:139], v[76:79], v[136:139]
  v_exp_f32 v220, v148
  v_mfma_f32_16x16x32_bf16 v[132:135], a[140:143], v[72:75], v[132:135]
  ds_read_b128 a[172:175], v3 offset:19456
  v_add_f32 v226, v226, v219
  v_cvt_pk_bf16_f32 v185, v218, v219
  v_mfma_f32_16x16x32_bf16 v[140:143], a[140:143], v[76:79], v[140:143]
  s_waitcnt lgkmcnt(4)
  buffer_load_dwordx4 v[104:107], v2, s[40:43], s14 offen offset:2048 sc1
  v_add_f32 v226, v226, v220
  v_mfma_f32_16x16x32_bf16 v[128:131], a[144:147], v[80:83], v[128:131]
  ds_read_b128 a[176:179], v3 offset:20480
  v_mfma_f32_16x16x32_bf16 v[136:139], a[144:147], v[84:87], v[136:139]
  v_exp_f32 v221, v149
  v_mfma_f32_16x16x32_bf16 v[132:135], a[148:151], v[80:83], v[132:135]
  ds_read_b128 a[180:183], v3 offset:21504
  v_add_f32 v226, v226, v221
  v_mfma_f32_16x16x32_bf16 v[140:143], a[148:151], v[84:87], v[140:143]
  v_exp_f32 v222, v150
  v_mfma_f32_16x16x32_bf16 v[128:131], a[152:155], v[88:91], v[128:131]
  ds_read_b128 a[184:187], v3 offset:22528
  buffer_load_dwordx4 v[100:103], v2, s[40:43], s14 offen offset:1024 sc1
  v_cvt_pk_bf16_f32 v186, v220, v221
  v_mfma_f32_16x16x32_bf16 v[136:139], a[152:155], v[92:95], v[136:139]
  v_exp_f32 v223, v151
  v_mfma_f32_16x16x32_bf16 v[132:135], a[156:159], v[88:91], v[132:135]
  ds_read_b128 a[188:191], v3 offset:23552
  v_add_f32 v226, v226, v222
  v_add_f32 v226, v226, v223
  v_mfma_f32_16x16x32_bf16 v[140:143], a[156:159], v[92:95], v[140:143]
  s_waitcnt lgkmcnt(4)
  v_exp_f32 v216, v152
  v_mfma_f32_16x16x32_bf16 a[64:67], a[160:163], v[176:179], a[64:67]
  v_exp_f32 v217, v153
  v_mfma_f32_16x16x32_bf16 a[68:71], a[160:163], v[180:183], a[68:71]
  buffer_load_dwordx4 v[96:99], v2, s[40:43], s14 offen offset:0 sc1
  v_cvt_pk_bf16_f32 v187, v222, v223
  v_add_f32 v227, v216, v217
  v_mfma_f32_16x16x32_bf16 a[72:75], a[164:167], v[176:179], a[72:75]
  v_exp_f32 v218, v154
  v_mfma_f32_16x16x32_bf16 a[76:79], a[164:167], v[180:183], a[76:79]
  v_exp_f32 v219, v155
  v_mfma_f32_16x16x32_bf16 a[80:83], a[168:171], v[176:179], a[80:83]
  v_exp_f32 v220, v156
  v_mfma_f32_16x16x32_bf16 a[84:87], a[168:171], v[180:183], a[84:87]
  s_add_u32 s14, s13, 4096
  buffer_load_dwordx4 v[60:63], v2, s[40:43], s14 offen offset:3072 sc1
  v_cvt_pk_bf16_f32 v188, v216, v217
  v_add_f32 v227, v227, v218
  v_mfma_f32_16x16x32_bf16 a[88:91], a[172:175], v[176:179], a[88:91]
  v_exp_f32 v221, v157
  v_mfma_f32_16x16x32_bf16 a[92:95], a[172:175], v[180:183], a[92:95]
  s_waitcnt lgkmcnt(0)
  v_exp_f32 v222, v158
  v_mfma_f32_16x16x32_bf16 a[96:99], a[176:179], v[176:179], a[96:99]
  v_add_f32 v227, v227, v219
  v_cvt_pk_bf16_f32 v189, v218, v219
  v_mfma_f32_16x16x32_bf16 a[100:103], a[176:179], v[180:183], a[100:103]
  v_exp_f32 v223, v159
  v_mfma_f32_16x16x32_bf16 a[104:107], a[180:183], v[176:179], a[104:107]
  buffer_load_dwordx4 v[56:59], v2, s[40:43], s14 offen offset:2048 sc1
  v_add_f32 v227, v227, v220
  v_mfma_f32_16x16x32_bf16 a[108:111], a[180:183], v[180:183], a[108:111]
  v_add_f32 v227, v227, v221
  v_cvt_pk_bf16_f32 v190, v220, v221
  v_add_f32 v227, v227, v222
  v_mfma_f32_16x16x32_bf16 a[112:115], a[184:187], v[176:179], a[112:115]
  v_add_f32 v227, v227, v223
  v_max_f32 v5, v226, v227
  v_cmp_lt_f32 vcc, s81, v5
  v_mfma_f32_16x16x32_bf16 a[116:119], a[184:187], v[180:183], a[116:119]
  v_exp_f32 v216, v128
  v_mfma_f32_16x16x32_bf16 a[120:123], a[188:191], v[176:179], a[120:123]
  v_cvt_pk_bf16_f32 v191, v222, v223
  v_mfma_f32_16x16x32_bf16 a[124:127], a[188:191], v[180:183], a[124:127]
  s_cbranch_vccnz fa_stub28
fa_back28:
  v_exp_f32 v217, v129
  v_add_f32 v230, v230, v226
  v_add_f32 v231, v231, v227
  ds_read_b128 a[160:163], v3 offset:24576
  ds_read_b128 a[164:167], v3 offset:25600
  ds_read_b128 a[168:171], v3 offset:26624
  ds_read_b128 a[172:175], v3 offset:27648
  ds_read_b128 a[176:179], v3 offset:28672
  ds_read_b128 a[180:183], v3 offset:29696
  ds_read_b128 a[184:187], v3 offset:30720
  ds_read_b128 a[188:191], v3 offset:31744
  v_cndmask_b32 v128, v4, v128, s[68:69]
  v_cndmask_b32 v129, v4, v129, s[70:71]
  v_cndmask_b32 v130, v4, v130, s[72:73]
  v_cndmask_b32 v131, v4, v131, s[74:75]
  v_mov_b32 v132, v4
  v_mov_b32 v133, v4
  v_mov_b32 v134, v4
  v_mov_b32 v135, v4
  v_cndmask_b32 v140, v4, v140, s[68:69]
  v_cndmask_b32 v141, v4, v141, s[70:71]
  v_cndmask_b32 v142, v4, v142, s[72:73]
  v_cndmask_b32 v143, v4, v143, s[74:75]
  v_exp_f32 v216, v128
  v_exp_f32 v217, v129
  v_exp_f32 v218, v130
  v_add_f32 v226, v216, v217
  v_cvt_pk_bf16_f32 v176, v216, v217
  v_add_f32 v226, v226, v218
  v_exp_f32 v219, v131
  v_exp_f32 v220, v132
  v_add_f32 v226, v226, v219
  v_cvt_pk_bf16_f32 v177, v218, v219
  v_add_f32 v226, v226, v220
  v_exp_f32 v221, v133
  s_waitcnt lgkmcnt(4)
  v_mfma_f32_16x16x32_bf16 a[64:67], a[160:163], v[184:187], a[64:67]
  v_exp_f32 v222, v134
  v_add_f32 v226, v226, v221
  v_mfma_f32_16x16x32_bf16 a[68:71], a[160:163], v[188:191], a[68:71]
  s_add_u32 s14, s13, 4096
  buffer_load_dwordx4 v[52:55], v2, s[40:43], s14 offen offset:1024 sc1
  v_exp_f32 v223, v135
  v_mfma_f32_16x16x32_bf16 a[72:75], a[164:167], v[184:187], a[72:75]
  s_add_u32 s66, s66, 32768
  v_exp_f32 v216, v136
  v_mfma_f32_16x16x32_bf16 a[76:79], a[164:167], v[188:191], a[76:79]
  s_and_b32 s66, s66, 0x1ffff
  v_exp_f32 v217, v137
  v_mfma_f32_16x16x32_bf16 a[80:83], a[168:171], v[184:187], a[80:83]
  buffer_load_dwordx4 v[48:51], v2, s[40:43], s14 offen offset:0 sc1
  v_cvt_pk_bf16_f32 v178, v220, v221
  v_add_f32 v226, v226, v222
  v_add_f32 v226, v226, v223
  v_cvt_pk_bf16_f32 v179, v222, v223
  v_mfma_f32_16x16x32_bf16 a[84:87], a[168:171], v[188:191], a[84:87]
  v_exp_f32 v218, v138
  v_mfma_f32_16x16x32_bf16 a[88:91], a[172:175], v[184:187], a[88:91]
  v_exp_f32 v219, v139
  v_mfma_f32_16x16x32_bf16 a[92:95], a[172:175], v[188:191], a[92:95]
  s_waitcnt lgkmcnt(0)
  v_exp_f32 v220, v140
  v_mfma_f32_16x16x32_bf16 a[96:99], a[176:179], v[184:187], a[96:99]
  s_add_u32 s14, s13, 0
  buffer_load_dwordx4 v[44:47], v2, s[40:43], s14 offen offset:3072 sc1
  v_add_f32 v227, v216, v217
  v_cvt_pk_bf16_f32 v180, v216, v217
  v_add_f32 v227, v227, v218
  v_add_f32 v227, v227, v219
  v_cvt_pk_bf16_f32 v181, v218, v219
  v_exp_f32 v221, v141
  v_mfma_f32_16x16x32_bf16 a[100:103], a[176:179], v[188:191], a[100:103]
  v_exp_f32 v222, v142
  v_mfma_f32_16x16x32_bf16 a[104:107], a[180:183], v[184:187], a[104:107]
  v_exp_f32 v223, v143
  v_mfma_f32_16x16x32_bf16 a[108:111], a[180:183], v[188:191], a[108:111]
  buffer_load_dwordx4 v[40:43], v2, s[40:43], s14 offen offset:2048 sc1
  v_add_f32 v227, v227, v220
  v_add_f32 v227, v227, v221
  v_cvt_pk_bf16_f32 v182, v220, v221
  v_add_f32 v227, v227, v222
  v_mfma_f32_16x16x32_bf16 a[112:115], a[184:187], v[184:187], a[112:115]
  v_add_f32 v227, v227, v223
  v_max_f32 v5, v226, v227
  v_cmp_lt_f32 vcc, s81, v5
  v_mfma_f32_16x16x32_bf16 a[116:119], a[184:187], v[188:191], a[116:119]
  v_mfma_f32_16x16x32_bf16 a[120:123], a[188:191], v[184:187], a[120:123]
  v_cvt_pk_bf16_f32 v183, v222, v223
  v_add_u32 v3, s66, v2
  v_mfma_f32_16x16x32_bf16 a[124:127], a[188:191], v[188:191], a[124:127]
  s_cbranch_vccnz fa_stub29
fa_back29:
  v_add_f32 v230, v230, v226
  v_add_f32 v231, v231, v227
  s_cmp_ge_u32 s20, 2
  s_cbranch_scc1 fa_nb0
  s_waitcnt vmcnt(10)
  s_barrier
fa_nb0:
  ds_read_b128 a[160:163], v3 offset:16384
  ds_read_b128 a[164:167], v3 offset:17408
  ds_read_b128 a[168:171], v3 offset:18432
  ds_read_b128 a[172:175], v3 offset:19456
  ds_read_b128 a[176:179], v3 offset:20480
  ds_read_b128 a[180:183], v3 offset:21504
  ds_read_b128 a[184:187], v3 offset:22528
  ds_read_b128 a[188:191], v3 offset:23552
  s_waitcnt lgkmcnt(4)
  v_mfma_f32_16x16x32_bf16 a[64:67], a[160:163], v[176:179], a[64:67]
  v_mfma_f32_16x16x32_bf16 a[68:71], a[160:163], v[180:183], a[68:71]
  s_add_u32 s14, s13, 0
  buffer_load_dwordx4 v[36:39], v2, s[40:43], s14 offen offset:1024 sc1
  v_mfma_f32_16x16x32_bf16 a[72:75], a[164:167], v[176:179], a[72:75]
  v_mfma_f32_16x16x32_bf16 a[76:79], a[164:167], v[180:183], a[76:79]
  v_mfma_f32_16x16x32_bf16 a[80:83], a[168:171], v[176:179], a[80:83]
  v_mfma_f32_16x16x32_bf16 a[84:87], a[168:171], v[180:183], a[84:87]
  v_mfma_f32_16x16x32_bf16 a[88:91], a[172:175], v[176:179], a[88:91]
  v_mfma_f32_16x16x32_bf16 a[92:95], a[172:175], v[180:183], a[92:95]
  s_waitcnt lgkmcnt(0)
  v_mfma_f32_16x16x32_bf16 a[96:99], a[176:179], v[176:179], a[96:99]
  buffer_load_dwordx4 v[32:35], v2, s[40:43], s14 offen offset:0 sc1
  v_mfma_f32_16x16x32_bf16 a[100:103], a[176:179], v[180:183], a[100:103]
  v_mfma_f32_16x16x32_bf16 a[104:107], a[180:183], v[176:179], a[104:107]
  v_mfma_f32_16x16x32_bf16 a[108:111], a[180:183], v[180:183], a[108:111]
  v_mfma_f32_16x16x32_bf16 a[112:115], a[184:187], v[176:179], a[112:115]
  v_mfma_f32_16x16x32_bf16 a[116:119], a[184:187], v[180:183], a[116:119]
  v_mfma_f32_16x16x32_bf16 a[120:123], a[188:191], v[176:179], a[120:123]
  v_mfma_f32_16x16x32_bf16 a[124:127], a[188:191], v[180:183], a[124:127]
  s_branch fa_Bdone
fa_Bodd:
  s_cmp_ge_u32 s20, 2
  s_cbranch_scc1 fa_nb1
  s_waitcnt vmcnt(8)
  s_barrier
fa_nb1:
  ds_read_b128 a[160:163], v3 offset:16384
  ds_read_b128 a[164:167], v3 offset:17408
  ds_read_b128 a[168:171], v3 offset:18432
  ds_read_b128 a[172:175], v3 offset:19456
  ds_read_b128 a[176:179], v3 offset:20480
  ds_read_b128 a[180:183], v3 offset:21504
  ds_read_b128 a[184:187], v3 offset:22528
  ds_read_b128 a[188:191], v3 offset:23552
  v_cndmask_b32 v144, v4, v144, s[68:69]
  v_cndmask_b32 v145, v4, v145, s[70:71]
  v_cndmask_b32 v146, v4, v146, s[72:73]
  v_cndmask_b32 v147, v4, v147, s[74:75]
  v_mov_b32 v148, v4
  v_mov_b32 v149, v4
  v_mov_b32 v150, v4
  v_mov_b32 v151, v4
  v_cndmask_b32 v156, v4, v156, s[68:69]
  v_cndmask_b32 v157, v4, v157, s[70:71]
  v_cndmask_b32 v158, v4, v158, s[72:73]
  v_cndmask_b32 v159, v4, v159, s[74:75]
  v_exp_f32 v216, v144
  v_exp_f32 v217, v145
  v_exp_f32 v218, v146
  v_add_f32 v226, v216, v217
  v_cvt_pk_bf16_f32 v184, v216, v217
  v_add_f32 v226, v226, v218
  v_exp_f32 v219, v147
  v_exp_f32 v220, v148
  v_add_f32 v226, v226, v219
  v_cvt_pk_bf16_f32 v185, v218, v219
  v_add_f32 v226, v226, v220
  v_exp_f32 v221, v149
  s_waitcnt lgkmcnt(4)
  v_mfma_f32_16x16x32_bf16 a[64:67], a[160:163], v[176:179], a[64:67]
  v_exp_f32 v222, v150
  v_add_f32 v226, v226, v221
  v_mfma_f32_16x16x32_bf16 a[68:71], a[160:163], v[180:183], a[68:71]
  s_add_u32 s14, s13, 8192
  buffer_load_dwordx4 v[108:111], v2, s[40:43], s14 offen offset:3072 sc1
  v_exp_f32 v223, v151
  v_mfma_f32_16x16x32_bf16 a[72:75], a[164:167], v[176:179], a[72:75]
  v_exp_f32 v216, v152
  v_cvt_pk_bf16_f32 v186, v220, v221
  v_add_f32 v226, v226, v222
  v_mfma_f32_16x16x32_bf16 a[76:79], a[164:167], v[180:183], a[76:79]
  buffer_load_dwordx4 v[104:107], v2, s[40:43], s14 offen offset:2048 sc1
  v_exp_f32 v217, v153
  v_mfma_f32_16x16x32_bf16 a[80:83], a[168:171], v[176:179], a[80:83]
  v_exp_f32 v218, v154
  v_add_f32 v226, v226, v223
  v_mfma_f32_16x16x32_bf16 a[84:87], a[168:171], v[180:183], a[84:87]
  buffer_load_dwordx4 v[100:103], v2, s[40:43], s14 offen offset:1024 sc1
  v_exp_f32 v219, v155
  v_cvt_pk_bf16_f32 v187, v222, v223
  v_mfma_f32_16x16x32_bf16 a[88:91], a[172:175], v[176:179], a[88:91]
  v_exp_f32 v220, v156
  v_mfma_f32_16x16x32_bf16 a[92:95], a[172:175], v[180:183], a[92:95]
  s_waitcnt lgkmcnt(0)
  buffer_load_dwordx4 v[96:99], v2, s[40:43], s14 offen offset:0 sc1
  v_add_f32 v227, v216, v217
  v_cvt_pk_bf16_f32 v188, v216, v217
  v_add_f32 v227, v227, v218
  v_mfma_f32_16x16x32_bf16 a[96:99], a[176:179], v[176:179], a[96:99]
  v_exp_f32 v221, v157
  v_mfma_f32_16x16x32_bf16 a[100:103], a[176:179], v[180:183], a[100:103]
  s_add_u32 s14, s13, 4096
  buffer_load_dwordx4 v[60:63], v2, s[40:43], s14 offen offset:3072 sc1
  v_exp_f32 v222, v158
  v_mfma_f32_16x16x32_bf16 a[104:107], a[180:183], v[176:179], a[104:107]
  v_exp_f32 v223, v159
  v_mfma_f32_16x16x32_bf16 a[108:111], a[180:183], v[180:183], a[108:111]
  buffer_load_dwordx4 v[56:59], v2, s[40:43], s14 offen offset:2048 sc1
  v_add_f32 v227, v227, v219
  v_cvt_pk_bf16_f32 v189, v218, v219
  v_add_f32 v227, v227, v220
  v_add_f32 v227, v227, v221
  v_cvt_pk_bf16_f32 v190, v220, v221
  v_add_f32 v227, v227, v222
  v_mfma_f32_16x16x32_bf16 a[112:115], a[184:187], v[176:179], a[112:115]
  v_add_f32 v227, v227, v223
  v_max_f32 v5, v226, v227
  v_cmp_lt_f32 vcc, s81, v5
  v_mfma_f32_16x16x32_bf16 a[116:119], a[184:187], v[180:183], a[116:119]
  buffer_load_dwordx4 v[52:55], v2, s[40:43], s14 offen offset:1024 sc1
  v_mfma_f32_16x16x32_bf16 a[120:123], a[188:191], v[176:179], a[120:123]
  v_cvt_pk_bf16_f32 v191, v222, v223
  v_mfma_f32_16x16x32_bf16 a[124:127], a[188:191], v[180:183], a[124:127]
  s_cbranch_vccnz fa_stub30
fa_back30:
  v_add_f32 v230, v230, v226
  v_add_f32 v231, v231, v227
  ds_read_b128 a[160:163], v3 offset:24576
  ds_read_b128 a[164:167], v3 offset:25600
  ds_read_b128 a[168:171], v3 offset:26624
  ds_read_b128 a[172:175], v3 offset:27648
  ds_read_b128 a[176:179], v3 offset:28672
  ds_read_b128 a[180:183], v3 offset:29696
  ds_read_b128 a[184:187], v3 offset:30720
  ds_read_b128 a[188:191], v3 offset:31744
  s_waitcnt lgkmcnt(4)
  v_mfma_f32_16x16x32_bf16 a[64:67], a[160:163], v[184:187], a[64:67]
  v_mfma_f32_16x16x32_bf16 a[68:71], a[160:163], v[188:191], a[68:71]
  s_add_u32 s14, s13, 4096
  buffer_load_dwordx4 v[48:51], v2, s[40:43], s14 offen offset:0 sc1
  v_mfma_f32_16x16x32_bf16 a[72:75], a[164:167], v[184:187], a[72:75]
  s_add_u32 s66, s66, 32768
  v_mfma_f32_16x16x32_bf16 a[76:79], a[164:167], v[188:191], a[76:79]
  s_add_u32 s14, s13, 0
  buffer_load_dwordx4 v[44:47], v2, s[40:43], s14 offen offset:3072 sc1
  v_mfma_f32_16x16x32_bf16 a[80:83], a[168:171], v[184:187], a[80:83]
  s_and_b32 s66, s66, 0x1ffff
  v_mfma_f32_16x16x32_bf16 a[84:87], a[168:171], v[188:191], a[84:87]
  v_mfma_f32_16x16x32_bf16 a[88:91], a[172:175], v[184:187], a[88:91]
  buffer_load_dwordx4 v[40:43], v2, s[40:43], s14 offen offset:2048 sc1
  v_mfma_f32_16x16x32_bf16 a[92:95], a[172:175], v[188:191], a[92:95]
  s_waitcnt lgkmcnt(0)
  v_mfma_f32_16x16x32_bf16 a[96:99], a[176:179], v[184:187], a[96:99]
  v_mfma_f32_16x16x32_bf16 a[100:103], a[176:179], v[188:191], a[100:103]
  buffer_load_dwordx4 v[36:39], v2, s[40:43], s14 offen offset:1024 sc1
  v_mfma_f32_16x16x32_bf16 a[104:107], a[180:183], v[184:187], a[104:107]
  v_mfma_f32_16x16x32_bf16 a[108:111], a[180:183], v[188:191], a[108:111]
  v_mfma_f32_16x16x32_bf16 a[112:115], a[184:187], v[184:187], a[112:115]
  buffer_load_dwordx4 v[32:35], v2, s[40:43], s14 offen offset:0 sc1
  v_mfma_f32_16x16x32_bf16 a[116:119], a[184:187], v[188:191], a[116:119]
  v_mfma_f32_16x16x32_bf16 a[120:123], a[188:191], v[184:187], a[120:123]
  v_add_u32 v3, s66, v2
  v_mfma_f32_16x16x32_bf16 a[124:127], a[188:191], v[188:191], a[124:127]
fa_Bdone:
fa_epi:
  v_mov_b32 v20, v230
  v_mov_b32 v21, v231
  s_nop 1
  v_permlane16_swap_b32 v230, v20
  v_permlane16_swap_b32 v231, v21
  v_add_f32 v230, v230, v20
  v_add_f32 v231, v231, v21
  v_mov_b32 v20, v230
  v_mov_b32 v21, v231
  s_nop 1
  v_permlane32_swap_b32 v230, v20
  v_permlane32_swap_b32 v231, v21
  v_add_f32 v230, v230, v20
  v_add_f32 v231, v231, v21
  v_rcp_f32 v16, v230
  v_rcp_f32 v18, v231
  s_sub_u32 s23, 15, s22
  s_lshl_b32 s23, s23, 2
  v_mov_b32 v17, v16
  v_mov_b32 v19, v18
  s_add_u32 s23, s23, s20
  s_lshl_b32 s23, s23, 18
  s_lshl_b32 s31, s21, 12
  s_add_u32 s31, s31, 50331648
  s_add_u32 s64, s23, s31
  s_add_u32 s65, s64, 131072
  v_accvgpr_read_b32 v68, a64
  v_accvgpr_read_b32 v69, a65
  v_accvgpr_read_b32 v70, a66
  v_accvgpr_read_b32 v71, a67
  v_accvgpr_read_b32 v72, a72
  v_accvgpr_read_b32 v73, a73
  v_accvgpr_read_b32 v74, a74
  v_accvgpr_read_b32 v75, a75
  v_pk_mul_f32 v[68:69], v[68:69], v[16:17]
  v_pk_mul_f32 v[70:71], v[70:71], v[16:17]
  v_pk_mul_f32 v[72:73], v[72:73], v[16:17]
  v_pk_mul_f32 v[74:75], v[74:75], v[16:17]
  v_cvt_pk_bf16_f32 v64, v68, v69
  v_cvt_pk_bf16_f32 v65, v70, v71
  v_cvt_pk_bf16_f32 v66, v72, v73
  v_cvt_pk_bf16_f32 v67, v74, v75
  buffer_store_dwordx4 v[64:67], v2, s[40:43], s64 offen offset:0 sc1
  v_accvgpr_read_b32 v80, a80
  v_accvgpr_read_b32 v81, a81
  v_accvgpr_read_b32 v82, a82
  v_accvgpr_read_b32 v83, a83
  v_accvgpr_read_b32 v84, a88
  v_accvgpr_read_b32 v85, a89
  v_accvgpr_read_b32 v86, a90
  v_accvgpr_read_b32 v87, a91
  v_pk_mul_f32 v[80:81], v[80:81], v[16:17]
  v_pk_mul_f32 v[82:83], v[82:83], v[16:17]
  v_pk_mul_f32 v[84:85], v[84:85], v[16:17]
  v_pk_mul_f32 v[86:87], v[86:87], v[16:17]
  v_cvt_pk_bf16_f32 v76, v80, v81
  v_cvt_pk_bf16_f32 v77, v82, v83
  v_cvt_pk_bf16_f32 v78, v84, v85
  v_cvt_pk_bf16_f32 v79, v86, v87
  buffer_store_dwordx4 v[76:79], v2, s[40:43], s64 offen offset:1024 sc1
  v_accvgpr_read_b32 v132, a96
  v_accvgpr_read_b32 v133, a97
  v_accvgpr_read_b32 v134, a98
  v_accvgpr_read_b32 v135, a99
  v_accvgpr_read_b32 v136, a104
  v_accvgpr_read_b32 v137, a105
  v_accvgpr_read_b32 v138, a106
  v_accvgpr_read_b32 v139, a107
  v_pk_mul_f32 v[132:133], v[132:133], v[16:17]
  v_pk_mul_f32 v[134:135], v[134:135], v[16:17]
  v_pk_mul_f32 v[136:137], v[136:137], v[16:17]
  v_pk_mul_f32 v[138:139], v[138:139], v[16:17]
  v_cvt_pk_bf16_f32 v128, v132, v133
  v_cvt_pk_bf16_f32 v129, v134, v135
  v_cvt_pk_bf16_f32 v130, v136, v137
  v_cvt_pk_bf16_f32 v131, v138, v139
  buffer_store_dwordx4 v[128:131], v2, s[40:43], s64 offen offset:2048 sc1
  v_accvgpr_read_b32 v144, a112
  v_accvgpr_read_b32 v145, a113
  v_accvgpr_read_b32 v146, a114
  v_accvgpr_read_b32 v147, a115
  v_accvgpr_read_b32 v148, a120
  v_accvgpr_read_b32 v149, a121
  v_accvgpr_read_b32 v150, a122
  v_accvgpr_read_b32 v151, a123
  v_pk_mul_f32 v[144:145], v[144:145], v[16:17]
  v_pk_mul_f32 v[146:147], v[146:147], v[16:17]
  v_pk_mul_f32 v[148:149], v[148:149], v[16:17]
  v_pk_mul_f32 v[150:151], v[150:151], v[16:17]
  v_cvt_pk_bf16_f32 v140, v144, v145
  v_cvt_pk_bf16_f32 v141, v146, v147
  v_cvt_pk_bf16_f32 v142, v148, v149
  v_cvt_pk_bf16_f32 v143, v150, v151
  buffer_store_dwordx4 v[140:143], v2, s[40:43], s64 offen offset:3072 sc1
  v_accvgpr_read_b32 v68, a68
  v_accvgpr_read_b32 v69, a69
  v_accvgpr_read_b32 v70, a70
  v_accvgpr_read_b32 v71, a71
  v_accvgpr_read_b32 v72, a76
  v_accvgpr_read_b32 v73, a77
  v_accvgpr_read_b32 v74, a78
  v_accvgpr_read_b32 v75, a79
  v_pk_mul_f32 v[68:69], v[68:69], v[18:19]
  v_pk_mul_f32 v[70:71], v[70:71], v[18:19]
  v_pk_mul_f32 v[72:73], v[72:73], v[18:19]
  v_pk_mul_f32 v[74:75], v[74:75], v[18:19]
  v_cvt_pk_bf16_f32 v64, v68, v69
  v_cvt_pk_bf16_f32 v65, v70, v71
  v_cvt_pk_bf16_f32 v66, v72, v73
  v_cvt_pk_bf16_f32 v67, v74, v75
  buffer_store_dwordx4 v[64:67], v2, s[40:43], s65 offen offset:0 sc1
  v_accvgpr_read_b32 v80, a84
  v_accvgpr_read_b32 v81, a85
  v_accvgpr_read_b32 v82, a86
  v_accvgpr_read_b32 v83, a87
  v_accvgpr_read_b32 v84, a92
  v_accvgpr_read_b32 v85, a93
  v_accvgpr_read_b32 v86, a94
  v_accvgpr_read_b32 v87, a95
  v_pk_mul_f32 v[80:81], v[80:81], v[18:19]
  v_pk_mul_f32 v[82:83], v[82:83], v[18:19]
  v_pk_mul_f32 v[84:85], v[84:85], v[18:19]
  v_pk_mul_f32 v[86:87], v[86:87], v[18:19]
  v_cvt_pk_bf16_f32 v76, v80, v81
  v_cvt_pk_bf16_f32 v77, v82, v83
  v_cvt_pk_bf16_f32 v78, v84, v85
  v_cvt_pk_bf16_f32 v79, v86, v87
  buffer_store_dwordx4 v[76:79], v2, s[40:43], s65 offen offset:1024 sc1
  v_accvgpr_read_b32 v132, a100
  v_accvgpr_read_b32 v133, a101
  v_accvgpr_read_b32 v134, a102
  v_accvgpr_read_b32 v135, a103
  v_accvgpr_read_b32 v136, a108
  v_accvgpr_read_b32 v137, a109
  v_accvgpr_read_b32 v138, a110
  v_accvgpr_read_b32 v139, a111
  v_pk_mul_f32 v[132:133], v[132:133], v[18:19]
  v_pk_mul_f32 v[134:135], v[134:135], v[18:19]
  v_pk_mul_f32 v[136:137], v[136:137], v[18:19]
  v_pk_mul_f32 v[138:139], v[138:139], v[18:19]
  v_cvt_pk_bf16_f32 v128, v132, v133
  v_cvt_pk_bf16_f32 v129, v134, v135
  v_cvt_pk_bf16_f32 v130, v136, v137
  v_cvt_pk_bf16_f32 v131, v138, v139
  buffer_store_dwordx4 v[128:131], v2, s[40:43], s65 offen offset:2048 sc1
  v_accvgpr_read_b32 v144, a116
  v_accvgpr_read_b32 v145, a117
  v_accvgpr_read_b32 v146, a118
  v_accvgpr_read_b32 v147, a119
  v_accvgpr_read_b32 v148, a124
  v_accvgpr_read_b32 v149, a125
  v_accvgpr_read_b32 v150, a126
  v_accvgpr_read_b32 v151, a127
  v_pk_mul_f32 v[144:145], v[144:145], v[18:19]
  v_pk_mul_f32 v[146:147], v[146:147], v[18:19]
  v_pk_mul_f32 v[148:149], v[148:149], v[18:19]
  v_pk_mul_f32 v[150:151], v[150:151], v[18:19]
  v_cvt_pk_bf16_f32 v140, v144, v145
  v_cvt_pk_bf16_f32 v141, v146, v147
  v_cvt_pk_bf16_f32 v142, v148, v149
  v_cvt_pk_bf16_f32 v143, v150, v151
  buffer_store_dwordx4 v[140:143], v2, s[40:43], s65 offen offset:3072 sc1
  s_load_dwordx2 s[16:17], s[0:1], 88
  v_mov_b32 v30, 1073741824
  v_writelane_b32 v30, s80, 0
  v_writelane_b32 v30, s3, 1
  s_and_b32 s23, s2, 1
  s_lshl_b32 s23, s23, 2
  s_add_u32 s61, s23, s20
  s_lshl_b32 s23, s61, 14
  s_add_u32 s23, s23, 50331648
  s_lshl_b32 s63, s60, 19
  s_add_u32 s63, s63, s23
  s_xor_b32 s62, s63, 1048576
  s_add_u32 s64, s62, 0
  s_add_u32 s65, s64, 131072
  s_add_u32 s66, s64, 262144
  s_add_u32 s67, s64, 393216
  v_bfe_u32 v12, v1, 2, 1
  v_mul_u32_u24 v12, 4096, v12
  v_and_b32 v13, 3, v1
  v_lshl_add_u32 v12, v13, 7, v12
  s_lshl_b32 s31, s61, 9
  s_add_u32 s31, s31, 3801088
  s_mul_i32 s23, s60, 8192
  s_add_u32 s23, s23, s31
  v_add_u32 v10, s23, v12
  s_xor_b32 s23, s60, 2
  s_mul_i32 s23, s23, 8192
  s_add_u32 s23, s23, s31
  v_add_u32 v12, s23, v12
  v_mov_b32 v20, 0
  v_mov_b32 v21, 0
  v_mov_b32 v22, 0
  v_mov_b32 v23, 0
  v_add_u32 v16, 158208, v2
  ds_write_b128 v16, v[20:23]
  s_waitcnt vmcnt(0)
  buffer_store_dword v4, v30, s[40:43], 0 offen sc1
  s_setprio 0
  s_cmp_lt_u32 s12, 3
  s_cbranch_scc1 fa_hk9
fa_hb9:
  s_cmp_lt_u32 s29, 8
  s_cbranch_scc1 fa_left
fa_leftb:
  s_lshl_b32 s34, s28, 1
  s_and_b32 s23, s20, 1
  s_lshl_b32 s23, s23, 12
  s_cmp_lt_u32 s20, 2
  s_cselect_b32 s33, 106496, 0
  s_add_u32 s33, s33, s23
  s_add_u32 s33, s33, s34
  s_and_b32 s33, s33, 0x1ffff
  s_lshl_b32 s23, s20, 12
  s_add_u32 s34, s34, 49152
  s_add_u32 s34, s34, s23
  s_and_b32 s34, s34, 0x1ffff
  s_add_u32 s23, s23, s28
  s_cmp_lt_u32 s29, 3
  s_cselect_b32 s26, s23, s26
  s_cselect_b32 s27, s23, s27
  s_cselect_b32 s24, s33, s24
  s_cselect_b32 s25, s34, s25
  s_mov_b64 s[44:45], s[4:5]
  s_mov_b64 s[48:49], s[6:7]
  s_mov_b32 s46, s30
  s_mov_b32 s50, s30
  s_add_u32 s23, s28, 49152
fa_pk:
  s_cmp_ge_u32 s26, s23
  s_cbranch_scc1 fa_pkd
  s_mov_b32 m0, s24
  s_add_u32 s24, s24, 32768
  s_and_b32 s24, s24, 0x1ffff
  buffer_load_dwordx4 v2, s[44:47], s26 offen offset:0 sc1 lds
  buffer_load_dwordx4 v2, s[44:47], s26 offen offset:1024 sc1 lds
  buffer_load_dwordx4 v2, s[44:47], s26 offen offset:2048 sc1 lds
  buffer_load_dwordx4 v2, s[44:47], s26 offen offset:3072 sc1 lds
  s_add_u32 s26, s26, 16384
  s_branch fa_pk
fa_pkd:
  s_add_u32 s23, s28, 32768
fa_pv:
  s_cmp_ge_u32 s27, s23
  s_cbranch_scc1 fa_pvd
  s_mov_b32 m0, s25
  s_add_u32 s25, s25, 32768
  s_and_b32 s25, s25, 0x1ffff
  buffer_load_dwordx4 v2, s[48:51], s27 offen offset:0 sc1 lds
  buffer_load_dwordx4 v2, s[48:51], s27 offen offset:1024 sc1 lds
  buffer_load_dwordx4 v2, s[48:51], s27 offen offset:2048 sc1 lds
  buffer_load_dwordx4 v2, s[48:51], s27 offen offset:3072 sc1 lds
  s_add_u32 s27, s27, 16384
  s_branch fa_pv
fa_pvd:
  s_waitcnt lgkmcnt(0)
  s_barrier
  buffer_load_dword v13, v12, s[40:43], 0 offen sc1
  s_mul_i32 s28, s2, 24576
  s_add_u32 s28, s28, 10485760
  s_xor_b32 s23, s2, 1
  s_mul_i32 s29, s23, 24576
  s_add_u32 s29, s29, 10485760
  s_lshl_b32 s30, s2, 2
  s_add_u32 s30, s30, s20
  s_lshl_b32 s30, s30, 7
  s_add_u32 s30, s30, 67239936
  s_xor_b32 s35, s30, 512
  v_lshlrev_b32 v9, 4, v0
  v_mov_b32 v8, s35
  s_lshl_b32 s25, s60, 6
  s_add_u32 s25, s25, 1
  s_mul_i32 s26, s20, 5120
  s_add_u32 s26, s26, 131072
  s_mul_i32 s27, s20, 1024
  s_add_u32 s27, s27, 151552
  s_mov_b32 s48, s16
  s_mov_b32 s49, s17
  s_mov_b32 s50, 2621440
  s_mov_b32 s51, 0x20000
  s_waitcnt vmcnt(0)
  v_cmp_eq_u32 vcc, 0, v13
  s_cbranch_vccnz fa_ctx_spin
fa_ctx_ok:
  buffer_load_dwordx4 a[144:147], v2, s[40:43], s64 offen offset:0 sc1
  buffer_load_dwordx4 a[148:151], v2, s[40:43], s65 offen offset:0 sc1
  buffer_load_dwordx4 a[152:155], v2, s[40:43], s66 offen offset:0 sc1
  buffer_load_dwordx4 a[156:159], v2, s[40:43], s67 offen offset:0 sc1
  buffer_load_dwordx4 a[160:163], v2, s[40:43], s64 offen offset:1024 sc1
  buffer_load_dwordx4 a[164:167], v2, s[40:43], s65 offen offset:1024 sc1
  buffer_load_dwordx4 a[168:171], v2, s[40:43], s66 offen offset:1024 sc1
  buffer_load_dwordx4 a[172:175], v2, s[40:43], s67 offen offset:1024 sc1
  buffer_load_dwordx4 a[176:179], v2, s[40:43], s64 offen offset:2048 sc1
  buffer_load_dwordx4 a[180:183], v2, s[40:43], s65 offen offset:2048 sc1
  buffer_load_dwordx4 a[184:187], v2, s[40:43], s66 offen offset:2048 sc1
  buffer_load_dwordx4 a[188:191], v2, s[40:43], s67 offen offset:2048 sc1
  buffer_load_dwordx4 v[216:219], v2, s[40:43], s64 offen offset:3072 sc1
  buffer_load_dwordx4 v[220:223], v2, s[40:43], s65 offen offset:3072 sc1
  buffer_load_dwordx4 v[224:227], v2, s[40:43], s66 offen offset:3072 sc1
  buffer_load_dwordx4 v[228:231], v2, s[40:43], s67 offen offset:3072 sc1
  v_add_u32 v11, s33, v2
  s_add_u32 s33, s33, 32768
  s_and_b32 s33, s33, 0x1ffff
  ds_read_b128 v[64:67], v11 offset:0
  ds_read_b128 v[68:71], v11 offset:1024
  ds_read_b128 v[72:75], v11 offset:2048
  ds_read_b128 v[76:79], v11 offset:3072
  v_add_u32 v11, s33, v2
  s_add_u32 s33, s33, 32768
  s_and_b32 s33, s33, 0x1ffff
  ds_read_b128 v[128:131], v11 offset:0
  ds_read_b128 v[132:135], v11 offset:1024
  ds_read_b128 v[136:139], v11 offset:2048
  ds_read_b128 v[140:143], v11 offset:3072
  v_add_u32 v11, s33, v2
  s_add_u32 s33, s33, 32768
  s_and_b32 s33, s33, 0x1ffff
  ds_read_b128 v[176:179], v11 offset:0
  ds_read_b128 v[180:183], v11 offset:1024
  ds_read_b128 v[184:187], v11 offset:2048
  ds_read_b128 v[188:191], v11 offset:3072
  v_add_u32 v11, s34, v2
  s_add_u32 s34, s34, 32768
  s_and_b32 s34, s34, 0x1ffff
  ds_read_b128 v[80:83], v11 offset:0
  ds_read_b128 v[84:87], v11 offset:1024
  ds_read_b128 v[88:91], v11 offset:2048
  ds_read_b128 v[92:95], v11 offset:3072
  v_add_u32 v11, s34, v2
  s_add_u32 s34, s34, 32768
  s_and_b32 s34, s34, 0x1ffff
  ds_read_b128 v[144:147], v11 offset:0
  ds_read_b128 v[148:151], v11 offset:1024
  ds_read_b128 v[152:155], v11 offset:2048
  ds_read_b128 v[156:159], v11 offset:3072
  s_add_u32 s64, s64, 4096
  s_add_u32 s65, s64, 131072
  s_add_u32 s66, s64, 262144
  s_add_u32 s67, s64, 393216
  s_waitcnt vmcnt(14) lgkmcnt(0)
  v_mfma_f32_16x16x32_bf16 a[64:67], v[32:35], a[144:147], 0
  v_add_u32 v200, s26, v2
  v_mfma_f32_16x16x32_bf16 a[80:83], v[36:39], a[144:147], 0
  v_add_u32 v201, s27, v2
  v_mfma_f32_16x16x32_bf16 a[96:99], v[40:43], a[144:147], 0
  s_mul_i32 s24, s20, 21504
  v_add_u32 v16, 0, v0
  v_mfma_f32_16x16x32_bf16 a[112:115], v[44:47], a[144:147], 0
  v_mul_u32_u24 v17, 6554, v16
  v_mfma_f32_16x16x32_bf16 a[128:131], v[48:51], a[144:147], 0
  buffer_load_dwordx4 a[144:147], v2, s[40:43], s64 offen offset:0 sc1
  v_mfma_f32_16x16x32_bf16 a[68:71], v[32:35], a[148:151], 0
  v_lshrrev_b32 v17, 16, v17
  v_mfma_f32_16x16x32_bf16 a[84:87], v[36:39], a[148:151], 0
  v_mul_u32_u24 v18, 10, v17
  v_mfma_f32_16x16x32_bf16 a[100:103], v[40:43], a[148:151], 0
  v_sub_u32 v18, v16, v18
  v_mfma_f32_16x16x32_bf16 a[116:119], v[44:47], a[148:151], 0
  v_lshlrev_b32 v203, 5, v18
  v_mfma_f32_16x16x32_bf16 a[132:135], v[48:51], a[148:151], 0
  s_waitcnt vmcnt(13)
  buffer_load_dwordx4 a[148:151], v2, s[40:43], s65 offen offset:0 sc1
  v_mfma_f32_16x16x32_bf16 a[72:75], v[32:35], a[152:155], 0
  v_add_u32 v24, s25, v17
  v_mfma_f32_16x16x32_bf16 a[88:91], v[36:39], a[152:155], 0
  v_mov_b32 v27, 8
  v_mfma_f32_16x16x32_bf16 a[104:107], v[40:43], a[152:155], 0
  v_add_u32 v16, 256, v0
  v_mfma_f32_16x16x32_bf16 a[120:123], v[44:47], a[152:155], 0
  v_mul_u32_u24 v17, 6554, v16
  v_mfma_f32_16x16x32_bf16 a[136:139], v[48:51], a[152:155], 0
  buffer_load_dwordx4 a[152:155], v2, s[40:43], s66 offen offset:0 sc1
  v_mfma_f32_16x16x32_bf16 a[76:79], v[32:35], a[156:159], 0
  v_lshrrev_b32 v17, 16, v17
  v_mfma_f32_16x16x32_bf16 a[92:95], v[36:39], a[156:159], 0
  v_mul_u32_u24 v18, 10, v17
  v_mfma_f32_16x16x32_bf16 a[108:111], v[40:43], a[156:159], 0
  v_sub_u32 v18, v16, v18
  v_mfma_f32_16x16x32_bf16 a[124:127], v[44:47], a[156:159], 0
  v_lshlrev_b32 v204, 5, v18
  v_mfma_f32_16x16x32_bf16 a[140:143], v[48:51], a[156:159], 0
  s_waitcnt vmcnt(13)
  buffer_load_dwordx4 a[156:159], v2, s[40:43], s67 offen offset:0 sc1
  v_mfma_f32_16x16x32_bf16 a[64:67], v[52:55], a[160:163], a[64:67]
  v_add_u32 v25, s25, v17
  v_mfma_f32_16x16x32_bf16 a[80:83], v[56:59], a[160:163], a[80:83]
  v_mov_b32 v28, 8
  v_mfma_f32_16x16x32_bf16 a[96:99], v[60:63], a[160:163], a[96:99]
  v_add_u32 v16, 512, v0
  v_mfma_f32_16x16x32_bf16 a[112:115], v[96:99], a[160:163], a[112:115]
  v_mul_u32_u24 v17, 6554, v16
  v_mfma_f32_16x16x32_bf16 a[128:131], v[100:103], a[160:163], a[128:131]
  buffer_load_dwordx4 a[160:163], v2, s[40:43], s64 offen offset:1024 sc1
  v_mfma_f32_16x16x32_bf16 a[68:71], v[52:55], a[164:167], a[68:71]
  v_lshrrev_b32 v17, 16, v17
  v_mfma_f32_16x16x32_bf16 a[84:87], v[56:59], a[164:167], a[84:87]
  v_mul_u32_u24 v18, 10, v17
  v_mfma_f32_16x16x32_bf16 a[100:103], v[60:63], a[164:167], a[100:103]
  v_sub_u32 v18, v16, v18
  v_mfma_f32_16x16x32_bf16 a[116:119], v[96:99], a[164:167], a[116:119]
  v_lshlrev_b32 v205, 5, v18
  v_mfma_f32_16x16x32_bf16 a[132:135], v[100:103], a[164:167], a[132:135]
  s_waitcnt vmcnt(13)
  buffer_load_dwordx4 a[164:167], v2, s[40:43], s65 offen offset:1024 sc1
  v_mfma_f32_16x16x32_bf16 a[72:75], v[52:55], a[168:171], a[72:75]
  v_add_u32 v26, s25, v17
  v_mfma_f32_16x16x32_bf16 a[88:91], v[56:59], a[168:171], a[88:91]
  v_mov_b32 v29, 8
  v_mfma_f32_16x16x32_bf16 a[104:107], v[60:63], a[168:171], a[104:107]
  v_readlane_b32 s68, v15, 0
  v_mfma_f32_16x16x32_bf16 a[120:123], v[96:99], a[168:171], a[120:123]
  v_readlane_b32 s69, v15, 1
  v_mfma_f32_16x16x32_bf16 a[136:139], v[100:103], a[168:171], a[136:139]
  buffer_load_dwordx4 a[168:171], v2, s[40:43], s66 offen offset:1024 sc1
  v_mfma_f32_16x16x32_bf16 a[76:79], v[52:55], a[172:175], a[76:79]
  v_readlane_b32 s70, v15, 2
  v_mfma_f32_16x16x32_bf16 a[92:95], v[56:59], a[172:175], a[92:95]
  v_readlane_b32 s71, v15, 3
  v_mfma_f32_16x16x32_bf16 a[108:111], v[60:63], a[172:175], a[108:111]
  v_readlane_b32 s72, v15, 4
  v_mfma_f32_16x16x32_bf16 a[124:127], v[96:99], a[172:175], a[124:127]
  v_readlane_b32 s73, v15, 5
  v_mfma_f32_16x16x32_bf16 a[140:143], v[100:103], a[172:175], a[140:143]
  s_waitcnt vmcnt(13)
  buffer_load_dwordx4 a[172:175], v2, s[40:43], s67 offen offset:1024 sc1
  v_mfma_f32_16x16x32_bf16 a[64:67], v[104:107], a[176:179], a[64:67]
  v_readlane_b32 s74, v15, 6
  v_mfma_f32_16x16x32_bf16 a[80:83], v[108:111], a[176:179], a[80:83]
  v_readlane_b32 s75, v15, 7
  v_mfma_f32_16x16x32_bf16 a[96:99], v[112:115], a[176:179], a[96:99]
  v_cmp_eq_u32 s[52:53], s68, v24
  v_mfma_f32_16x16x32_bf16 a[112:115], v[116:119], a[176:179], a[112:115]
  v_cmp_eq_u32 s[54:55], s68, v25
  v_mfma_f32_16x16x32_bf16 a[128:131], v[120:123], a[176:179], a[128:131]
  buffer_load_dwordx4 a[176:179], v2, s[40:43], s64 offen offset:2048 sc1
  v_mfma_f32_16x16x32_bf16 a[68:71], v[104:107], a[180:183], a[68:71]
  v_cmp_eq_u32 s[56:57], s68, v26
  v_mfma_f32_16x16x32_bf16 a[84:87], v[108:111], a[180:183], a[84:87]
  v_cndmask_b32 v27, v27, 0, s[52:53]
  v_mfma_f32_16x16x32_bf16 a[100:103], v[112:115], a[180:183], a[100:103]
  v_cndmask_b32 v28, v28, 0, s[54:55]
  v_mfma_f32_16x16x32_bf16 a[116:119], v[116:119], a[180:183], a[116:119]
  v_cndmask_b32 v29, v29, 0, s[56:57]
  v_mfma_f32_16x16x32_bf16 a[132:135], v[120:123], a[180:183], a[132:135]
  s_waitcnt vmcnt(13)
  buffer_load_dwordx4 a[180:183], v2, s[40:43], s65 offen offset:2048 sc1
  v_mfma_f32_16x16x32_bf16 a[72:75], v[104:107], a[184:187], a[72:75]
  v_cmp_eq_u32 s[52:53], s69, v24
  v_mfma_f32_16x16x32_bf16 a[88:91], v[108:111], a[184:187], a[88:91]
  v_cmp_eq_u32 s[54:55], s69, v25
  v_mfma_f32_16x16x32_bf16 a[104:107], v[112:115], a[184:187], a[104:107]
  v_cmp_eq_u32 s[56:57], s69, v26
  v_mfma_f32_16x16x32_bf16 a[120:123], v[116:119], a[184:187], a[120:123]
  v_cndmask_b32 v27, v27, 1, s[52:53]
  v_mfma_f32_16x16x32_bf16 a[136:139], v[120:123], a[184:187], a[136:139]
  buffer_load_dwordx4 a[184:187], v2, s[40:43], s66 offen offset:2048 sc1
  v_mfma_f32_16x16x32_bf16 a[76:79], v[104:107], a[188:191], a[76:79]
  v_cndmask_b32 v28, v28, 1, s[54:55]
  v_mfma_f32_16x16x32_bf16 a[92:95], v[108:111], a[188:191], a[92:95]
  v_cndmask_b32 v29, v29, 1, s[56:57]
  v_mfma_f32_16x16x32_bf16 a[108:111], v[112:115], a[188:191], a[108:111]
  v_cmp_eq_u32 s[52:53], s70, v24
  v_mfma_f32_16x16x32_bf16 a[124:127], v[116:119], a[188:191], a[124:127]
  v_cmp_eq_u32 s[54:55], s70, v25
  v_mfma_f32_16x16x32_bf16 a[140:143], v[120:123], a[188:191], a[140:143]
  s_waitcnt vmcnt(13)
  buffer_load_dwordx4 a[188:191], v2, s[40:43], s67 offen offset:2048 sc1
  v_mfma_f32_16x16x32_bf16 a[64:67], v[124:127], v[216:219], a[64:67]
  v_cmp_eq_u32 s[56:57], s70, v26
  v_mfma_f32_16x16x32_bf16 a[80:83], v[160:163], v[216:219], a[80:83]
  v_cndmask_b32 v27, v27, 2, s[52:53]
  v_mfma_f32_16x16x32_bf16 a[96:99], v[164:167], v[216:219], a[96:99]
  v_cndmask_b32 v28, v28, 2, s[54:55]
  v_mfma_f32_16x16x32_bf16 a[112:115], v[168:171], v[216:219], a[112:115]
  v_cndmask_b32 v29, v29, 2, s[56:57]
  v_mfma_f32_16x16x32_bf16 a[128:131], v[172:175], v[216:219], a[128:131]
  buffer_load_dwordx4 v[216:219], v2, s[40:43], s64 offen offset:3072 sc1
  v_mfma_f32_16x16x32_bf16 a[68:71], v[124:127], v[220:223], a[68:71]
  v_cmp_eq_u32 s[52:53], s71, v24
  v_mfma_f32_16x16x32_bf16 a[84:87], v[160:163], v[220:223], a[84:87]
  v_cmp_eq_u32 s[54:55], s71, v25
  v_mfma_f32_16x16x32_bf16 a[100:103], v[164:167], v[220:223], a[100:103]
  v_cmp_eq_u32 s[56:57], s71, v26
  v_mfma_f32_16x16x32_bf16 a[116:119], v[168:171], v[220:223], a[116:119]
  v_cndmask_b32 v27, v27, 3, s[52:53]
  v_mfma_f32_16x16x32_bf16 a[132:135], v[172:175], v[220:223], a[132:135]
  s_waitcnt vmcnt(13)
  buffer_load_dwordx4 v[220:223], v2, s[40:43], s65 offen offset:3072 sc1
  v_mfma_f32_16x16x32_bf16 a[72:75], v[124:127], v[224:227], a[72:75]
  v_cndmask_b32 v28, v28, 3, s[54:55]
  v_mfma_f32_16x16x32_bf16 a[88:91], v[160:163], v[224:227], a[88:91]
  v_cndmask_b32 v29, v29, 3, s[56:57]
  v_mfma_f32_16x16x32_bf16 a[104:107], v[164:167], v[224:227], a[104:107]
  v_cmp_eq_u32 s[52:53], s72, v24
  v_mfma_f32_16x16x32_bf16 a[120:123], v[168:171], v[224:227], a[120:123]
  v_cmp_eq_u32 s[54:55], s72, v25
  v_mfma_f32_16x16x32_bf16 a[136:139], v[172:175], v[224:227], a[136:139]
  buffer_load_dwordx4 v[224:227], v2, s[40:43], s66 offen offset:3072 sc1
  v_mfma_f32_16x16x32_bf16 a[76:79], v[124:127], v[228:231], a[76:79]
  v_cmp_eq_u32 s[56:57], s72, v26
  v_mfma_f32_16x16x32_bf16 a[92:95], v[160:163], v[228:231], a[92:95]
  v_cndmask_b32 v27, v27, 4, s[52:53]
  v_mfma_f32_16x16x32_bf16 a[108:111], v[164:167], v[228:231], a[108:111]
  v_cndmask_b32 v28, v28, 4, s[54:55]
  v_mfma_f32_16x16x32_bf16 a[124:127], v[168:171], v[228:231], a[124:127]
  v_cndmask_b32 v29, v29, 4, s[56:57]
  v_mfma_f32_16x16x32_bf16 a[140:143], v[172:175], v[228:231], a[140:143]
  s_waitcnt vmcnt(13)
  buffer_load_dwordx4 v[228:231], v2, s[40:43], s67 offen offset:3072 sc1
  v_mfma_f32_16x16x32_bf16 a[64:67], v[232:235], a[144:147], a[64:67]
  v_cmp_eq_u32 s[52:53], s73, v24
  v_mfma_f32_16x16x32_bf16 a[80:83], v[236:239], a[144:147], a[80:83]
  v_cmp_eq_u32 s[54:55], s73, v25
  v_mfma_f32_16x16x32_bf16 a[96:99], v[240:243], a[144:147], a[96:99]
  v_cmp_eq_u32 s[56:57], s73, v26
  v_mfma_f32_16x16x32_bf16 a[112:115], v[244:247], a[144:147], a[112:115]
  s_add_u32 s64, s64, 4096
  v_cndmask_b32 v27, v27, 5, s[52:53]
  v_mfma_f32_16x16x32_bf16 a[128:131], v[192:195], a[144:147], a[128:131]
  buffer_load_dwordx4 a[144:147], v2, s[40:43], s64 offen offset:0 sc1
  v_mfma_f32_16x16x32_bf16 a[68:71], v[232:235], a[148:151], a[68:71]
  s_add_u32 s65, s64, 131072
  v_cndmask_b32 v28, v28, 5, s[54:55]
  v_mfma_f32_16x16x32_bf16 a[84:87], v[236:239], a[148:151], a[84:87]
  s_add_u32 s66, s64, 262144
  v_cndmask_b32 v29, v29, 5, s[56:57]
  v_mfma_f32_16x16x32_bf16 a[100:103], v[240:243], a[148:151], a[100:103]
  v_cmp_eq_u32 s[52:53], s74, v24
  v_mfma_f32_16x16x32_bf16 a[116:119], v[244:247], a[148:151], a[116:119]
  v_cmp_eq_u32 s[54:55], s74, v25
  v_mfma_f32_16x16x32_bf16 a[132:135], v[192:195], a[148:151], a[132:135]
  s_waitcnt vmcnt(13)
  buffer_load_dwordx4 a[148:151], v2, s[40:43], s65 offen offset:0 sc1
  v_mfma_f32_16x16x32_bf16 a[72:75], v[232:235], a[152:155], a[72:75]
  s_add_u32 s67, s64, 393216
  v_cmp_eq_u32 s[56:57], s74, v26
  v_mfma_f32_16x16x32_bf16 a[88:91], v[236:239], a[152:155], a[88:91]
  v_cndmask_b32 v27, v27, 6, s[52:53]
  v_mfma_f32_16x16x32_bf16 a[104:107], v[240:243], a[152:155], a[104:107]
  v_cndmask_b32 v28, v28, 6, s[54:55]
  v_mfma_f32_16x16x32_bf16 a[120:123], v[244:247], a[152:155], a[120:123]
  v_cndmask_b32 v29, v29, 6, s[56:57]
  v_mfma_f32_16x16x32_bf16 a[136:139], v[192:195], a[152:155], a[136:139]
  buffer_load_dwordx4 a[152:155], v2, s[40:43], s66 offen offset:0 sc1
  v_mfma_f32_16x16x32_bf16 a[76:79], v[232:235], a[156:159], a[76:79]
  v_cmp_eq_u32 s[52:53], s75, v24
  v_mfma_f32_16x16x32_bf16 a[92:95], v[236:239], a[156:159], a[92:95]
  v_cmp_eq_u32 s[54:55], s75, v25
  v_mfma_f32_16x16x32_bf16 a[108:111], v[240:243], a[156:159], a[108:111]
  v_cmp_eq_u32 s[56:57], s75, v26
  v_mfma_f32_16x16x32_bf16 a[124:127], v[244:247], a[156:159], a[124:127]
  v_cndmask_b32 v27, v27, 7, s[52:53]
  v_mfma_f32_16x16x32_bf16 a[140:143], v[192:195], a[156:159], a[140:143]
  s_waitcnt vmcnt(13)
  buffer_load_dwordx4 a[156:159], v2, s[40:43], s67 offen offset:0 sc1
  v_mfma_f32_16x16x32_bf16 a[64:67], v[196:199], a[160:163], a[64:67]
  v_cndmask_b32 v28, v28, 7, s[54:55]
  v_mfma_f32_16x16x32_bf16 a[80:83], v[208:211], a[160:163], a[80:83]
  v_cndmask_b32 v29, v29, 7, s[56:57]
  v_mfma_f32_16x16x32_bf16 a[96:99], v[212:215], a[160:163], a[96:99]
  v_mul_u32_u24 v27, 320, v27
  v_mfma_f32_16x16x32_bf16 a[112:115], a[0:3], a[160:163], a[112:115]
  v_add_u32 v203, v203, v27
  v_mfma_f32_16x16x32_bf16 a[128:131], a[4:7], a[160:163], a[128:131]
  buffer_load_dwordx4 a[160:163], v2, s[40:43], s64 offen offset:1024 sc1
  v_mfma_f32_16x16x32_bf16 a[68:71], v[196:199], a[164:167], a[68:71]
  v_add_u32 v203, 155648, v203
  v_mfma_f32_16x16x32_bf16 a[84:87], v[208:211], a[164:167], a[84:87]
  v_mul_u32_u24 v28, 320, v28
  v_mfma_f32_16x16x32_bf16 a[100:103], v[212:215], a[164:167], a[100:103]
  v_add_u32 v204, v204, v28
  v_mfma_f32_16x16x32_bf16 a[116:119], a[0:3], a[164:167], a[116:119]
  v_add_u32 v204, 155648, v204
  v_mfma_f32_16x16x32_bf16 a[132:135], a[4:7], a[164:167], a[132:135]
  s_waitcnt vmcnt(13)
  buffer_load_dwordx4 a[164:167], v2, s[40:43], s65 offen offset:1024 sc1
  v_mfma_f32_16x16x32_bf16 a[72:75], v[196:199], a[168:171], a[72:75]
  v_mul_u32_u24 v29, 320, v29
  v_mfma_f32_16x16x32_bf16 a[88:91], v[208:211], a[168:171], a[88:91]
  v_add_u32 v205, v205, v29
  v_mfma_f32_16x16x32_bf16 a[104:107], v[212:215], a[168:171], a[104:107]
  v_add_u32 v205, 155648, v205
  v_mfma_f32_16x16x32_bf16 a[120:123], a[0:3], a[168:171], a[120:123]
  v_and_b32 v16, 15, v1
  v_mfma_f32_16x16x32_bf16 a[136:139], a[4:7], a[168:171], a[136:139]
  buffer_load_dwordx4 a[168:171], v2, s[40:43], s66 offen offset:1024 sc1
  v_mfma_f32_16x16x32_bf16 a[76:79], v[196:199], a[172:175], a[76:79]
  v_mul_u32_u24 v16, 336, v16
  v_mfma_f32_16x16x32_bf16 a[92:95], v[208:211], a[172:175], a[92:95]
  v_lshrrev_b32 v17, 4, v1
  v_mfma_f32_16x16x32_bf16 a[108:111], v[212:215], a[172:175], a[108:111]
  v_lshl_add_u32 v16, v17, 4, v16
  v_mfma_f32_16x16x32_bf16 a[124:127], a[0:3], a[172:175], a[124:127]
  v_add_u32 v16, s24, v16
  v_mfma_f32_16x16x32_bf16 a[140:143], a[4:7], a[172:175], a[140:143]
  s_waitcnt vmcnt(13)
  buffer_load_dwordx4 a[172:175], v2, s[40:43], s67 offen offset:1024 sc1
  v_mfma_f32_16x16x32_bf16 a[64:67], a[8:11], a[176:179], a[64:67]
  v_mfma_f32_16x16x32_bf16 a[80:83], a[12:15], a[176:179], a[80:83]
  v_mfma_f32_16x16x32_bf16 a[96:99], v[64:67], a[176:179], a[96:99]
  v_mfma_f32_16x16x32_bf16 a[112:115], v[68:71], a[176:179], a[112:115]
  v_mfma_f32_16x16x32_bf16 a[128:131], v[72:75], a[176:179], a[128:131]
  buffer_load_dwordx4 a[176:179], v2, s[40:43], s64 offen offset:2048 sc1
  v_mfma_f32_16x16x32_bf16 a[68:71], a[8:11], a[180:183], a[68:71]
  v_mfma_f32_16x16x32_bf16 a[84:87], a[12:15], a[180:183], a[84:87]
  v_mfma_f32_16x16x32_bf16 a[100:103], v[64:67], a[180:183], a[100:103]
  v_mfma_f32_16x16x32_bf16 a[116:119], v[68:71], a[180:183], a[116:119]
  v_mfma_f32_16x16x32_bf16 a[132:135], v[72:75], a[180:183], a[132:135]
  s_waitcnt vmcnt(13)
  buffer_load_dwordx4 a[180:183], v2, s[40:43], s65 offen offset:2048 sc1
  v_mfma_f32_16x16x32_bf16 a[72:75], a[8:11], a[184:187], a[72:75]
  v_mfma_f32_16x16x32_bf16 a[88:91], a[12:15], a[184:187], a[88:91]
  v_mfma_f32_16x16x32_bf16 a[104:107], v[64:67], a[184:187], a[104:107]
  v_mfma_f32_16x16x32_bf16 a[120:123], v[68:71], a[184:187], a[120:123]
  v_mfma_f32_16x16x32_bf16 a[136:139], v[72:75], a[184:187], a[136:139]
  buffer_load_dwordx4 a[184:187], v2, s[40:43], s66 offen offset:2048 sc1
  v_mfma_f32_16x16x32_bf16 a[76:79], a[8:11], a[188:191], a[76:79]
  v_mfma_f32_16x16x32_bf16 a[92:95], a[12:15], a[188:191], a[92:95]
  v_mfma_f32_16x16x32_bf16 a[108:111], v[64:67], a[188:191], a[108:111]
  v_mfma_f32_16x16x32_bf16 a[124:127], v[68:71], a[188:191], a[124:127]
  v_mfma_f32_16x16x32_bf16 a[140:143], v[72:75], a[188:191], a[140:143]
  s_waitcnt vmcnt(13)
  buffer_load_dwordx4 a[188:191], v2, s[40:43], s67 offen offset:2048 sc1
  v_mfma_f32_16x16x32_bf16 a[64:67], v[76:79], v[216:219], a[64:67]
  v_mfma_f32_16x16x32_bf16 a[80:83], v[80:83], v[216:219], a[80:83]
  v_mfma_f32_16x16x32_bf16 a[96:99], v[84:87], v[216:219], a[96:99]
  v_mfma_f32_16x16x32_bf16 a[112:115], v[88:91], v[216:219], a[112:115]
  v_mfma_f32_16x16x32_bf16 a[128:131], v[92:95], v[216:219], a[128:131]
  buffer_load_dwordx4 v[216:219], v2, s[40:43], s64 offen offset:3072 sc1
  v_mfma_f32_16x16x32_bf16 a[68:71], v[76:79], v[220:223], a[68:71]
  v_mfma_f32_16x16x32_bf16 a[84:87], v[80:83], v[220:223], a[84:87]
  v_mfma_f32_16x16x32_bf16 a[100:103], v[84:87], v[220:223], a[100:103]
  v_mfma_f32_16x16x32_bf16 a[116:119], v[88:91], v[220:223], a[116:119]
  v_mfma_f32_16x16x32_bf16 a[132:135], v[92:95], v[220:223], a[132:135]
  s_waitcnt vmcnt(13)
  buffer_load_dwordx4 v[220:223], v2, s[40:43], s65 offen offset:3072 sc1
  v_mfma_f32_16x16x32_bf16 a[72:75], v[76:79], v[224:227], a[72:75]
  v_mfma_f32_16x16x32_bf16 a[88:91], v[80:83], v[224:227], a[88:91]
  v_mfma_f32_16x16x32_bf16 a[104:107], v[84:87], v[224:227], a[104:107]
  v_mfma_f32_16x16x32_bf16 a[120:123], v[88:91], v[224:227], a[120:123]
  v_mfma_f32_16x16x32_bf16 a[136:139], v[92:95], v[224:227], a[136:139]
  buffer_load_dwordx4 v[224:227], v2, s[40:43], s66 offen offset:3072 sc1
  v_mfma_f32_16x16x32_bf16 a[76:79], v[76:79], v[228:231], a[76:79]
  v_mfma_f32_16x16x32_bf16 a[92:95], v[80:83], v[228:231], a[92:95]
  v_mfma_f32_16x16x32_bf16 a[108:111], v[84:87], v[228:231], a[108:111]
  v_mfma_f32_16x16x32_bf16 a[124:127], v[88:91], v[228:231], a[124:127]
  v_mfma_f32_16x16x32_bf16 a[140:143], v[92:95], v[228:231], a[140:143]
  s_waitcnt vmcnt(13)
  buffer_load_dwordx4 v[228:231], v2, s[40:43], s67 offen offset:3072 sc1
  v_mfma_f32_16x16x32_bf16 a[64:67], a[16:19], a[144:147], a[64:67]
  v_mfma_f32_16x16x32_bf16 a[80:83], a[20:23], a[144:147], a[80:83]
  v_mfma_f32_16x16x32_bf16 a[96:99], a[24:27], a[144:147], a[96:99]
  v_mfma_f32_16x16x32_bf16 a[112:115], a[28:31], a[144:147], a[112:115]
  s_add_u32 s64, s64, 4096
  v_mfma_f32_16x16x32_bf16 a[128:131], a[32:35], a[144:147], a[128:131]
  buffer_load_dwordx4 a[144:147], v2, s[40:43], s64 offen offset:0 sc1
  v_mfma_f32_16x16x32_bf16 a[68:71], a[16:19], a[148:151], a[68:71]
  s_add_u32 s65, s64, 131072
  v_mfma_f32_16x16x32_bf16 a[84:87], a[20:23], a[148:151], a[84:87]
  s_add_u32 s66, s64, 262144
  v_mfma_f32_16x16x32_bf16 a[100:103], a[24:27], a[148:151], a[100:103]
  v_mfma_f32_16x16x32_bf16 a[116:119], a[28:31], a[148:151], a[116:119]
  v_mfma_f32_16x16x32_bf16 a[132:135], a[32:35], a[148:151], a[132:135]
  s_waitcnt vmcnt(13)
  buffer_load_dwordx4 a[148:151], v2, s[40:43], s65 offen offset:0 sc1
  v_mfma_f32_16x16x32_bf16 a[72:75], a[16:19], a[152:155], a[72:75]
  s_add_u32 s67, s64, 393216
  v_mfma_f32_16x16x32_bf16 a[88:91], a[20:23], a[152:155], a[88:91]
  v_mfma_f32_16x16x32_bf16 a[104:107], a[24:27], a[152:155], a[104:107]
  v_mfma_f32_16x16x32_bf16 a[120:123], a[28:31], a[152:155], a[120:123]
  v_mfma_f32_16x16x32_bf16 a[136:139], a[32:35], a[152:155], a[136:139]
  buffer_load_dwordx4 a[152:155], v2, s[40:43], s66 offen offset:0 sc1
  v_mfma_f32_16x16x32_bf16 a[76:79], a[16:19], a[156:159], a[76:79]
  v_mfma_f32_16x16x32_bf16 a[92:95], a[20:23], a[156:159], a[92:95]
  v_mfma_f32_16x16x32_bf16 a[108:111], a[24:27], a[156:159], a[108:111]
  v_mfma_f32_16x16x32_bf16 a[124:127], a[28:31], a[156:159], a[124:127]
  v_mfma_f32_16x16x32_bf16 a[140:143], a[32:35], a[156:159], a[140:143]
  s_waitcnt vmcnt(13)
  buffer_load_dwordx4 a[156:159], v2, s[40:43], s67 offen offset:0 sc1
  v_mfma_f32_16x16x32_bf16 a[64:67], a[36:39], a[160:163], a[64:67]
  v_mfma_f32_16x16x32_bf16 a[80:83], a[40:43], a[160:163], a[80:83]
  buffer_load_dword v13, v10, s[40:43], 0 offen sc1
  v_mfma_f32_16x16x32_bf16 a[96:99], a[44:47], a[160:163], a[96:99]
  v_mfma_f32_16x16x32_bf16 a[112:115], v[128:131], a[160:163], a[112:115]
  v_mfma_f32_16x16x32_bf16 a[128:131], v[132:135], a[160:163], a[128:131]
  buffer_load_dwordx4 a[160:163], v2, s[40:43], s64 offen offset:1024 sc1
  v_mfma_f32_16x16x32_bf16 a[68:71], a[36:39], a[164:167], a[68:71]
  v_mfma_f32_16x16x32_bf16 a[84:87], a[40:43], a[164:167], a[84:87]
  v_mfma_f32_16x16x32_bf16 a[100:103], a[44:47], a[164:167], a[100:103]
  v_mfma_f32_16x16x32_bf16 a[116:119], v[128:131], a[164:167], a[116:119]
  v_mfma_f32_16x16x32_bf16 a[132:135], v[132:135], a[164:167], a[132:135]
  s_waitcnt vmcnt(14)
  buffer_load_dwordx4 a[164:167], v2, s[40:43], s65 offen offset:1024 sc1
  v_mfma_f32_16x16x32_bf16 a[72:75], a[36:39], a[168:171], a[72:75]
  v_mfma_f32_16x16x32_bf16 a[88:91], a[40:43], a[168:171], a[88:91]
  v_mfma_f32_16x16x32_bf16 a[104:107], a[44:47], a[168:171], a[104:107]
  v_mfma_f32_16x16x32_bf16 a[120:123], v[128:131], a[168:171], a[120:123]
  v_mfma_f32_16x16x32_bf16 a[136:139], v[132:135], a[168:171], a[136:139]
  buffer_load_dwordx4 a[168:171], v2, s[40:43], s66 offen offset:1024 sc1
  v_mfma_f32_16x16x32_bf16 a[76:79], a[36:39], a[172:175], a[76:79]
  v_mfma_f32_16x16x32_bf16 a[92:95], a[40:43], a[172:175], a[92:95]
  v_mfma_f32_16x16x32_bf16 a[108:111], a[44:47], a[172:175], a[108:111]
  v_mfma_f32_16x16x32_bf16 a[124:127], v[128:131], a[172:175], a[124:127]
  v_mfma_f32_16x16x32_bf16 a[140:143], v[132:135], a[172:175], a[140:143]
  s_waitcnt vmcnt(14)
  buffer_load_dwordx4 a[172:175], v2, s[40:43], s67 offen offset:1024 sc1
  v_mfma_f32_16x16x32_bf16 a[64:67], v[136:139], a[176:179], a[64:67]
  v_mfma_f32_16x16x32_bf16 a[80:83], v[140:143], a[176:179], a[80:83]
  v_mfma_f32_16x16x32_bf16 a[96:99], v[144:147], a[176:179], a[96:99]
  v_mfma_f32_16x16x32_bf16 a[112:115], v[148:151], a[176:179], a[112:115]
  v_mfma_f32_16x16x32_bf16 a[128:131], v[152:155], a[176:179], a[128:131]
  buffer_load_dwordx4 a[176:179], v2, s[40:43], s64 offen offset:2048 sc1
  v_mfma_f32_16x16x32_bf16 a[68:71], v[136:139], a[180:183], a[68:71]
  v_mfma_f32_16x16x32_bf16 a[84:87], v[140:143], a[180:183], a[84:87]
  v_mfma_f32_16x16x32_bf16 a[100:103], v[144:147], a[180:183], a[100:103]
  s_barrier
  v_mfma_f32_16x16x32_bf16 a[116:119], v[148:151], a[180:183], a[116:119]
  v_mfma_f32_16x16x32_bf16 a[132:135], v[152:155], a[180:183], a[132:135]
  s_waitcnt vmcnt(14)
  buffer_load_dwordx4 a[180:183], v2, s[40:43], s65 offen offset:2048 sc1
  v_mfma_f32_16x16x32_bf16 a[72:75], v[136:139], a[184:187], a[72:75]
  v_mfma_f32_16x16x32_bf16 a[88:91], v[140:143], a[184:187], a[88:91]
  v_mfma_f32_16x16x32_bf16 a[104:107], v[144:147], a[184:187], a[104:107]
  v_mfma_f32_16x16x32_bf16 a[120:123], v[148:151], a[184:187], a[120:123]
  v_mfma_f32_16x16x32_bf16 a[136:139], v[152:155], a[184:187], a[136:139]
  buffer_load_dwordx4 a[184:187], v2, s[40:43], s66 offen offset:2048 sc1
  v_mfma_f32_16x16x32_bf16 a[76:79], v[136:139], a[188:191], a[76:79]
  v_mfma_f32_16x16x32_bf16 a[92:95], v[140:143], a[188:191], a[92:95]
  v_mfma_f32_16x16x32_bf16 a[108:111], v[144:147], a[188:191], a[108:111]
  v_mfma_f32_16x16x32_bf16 a[124:127], v[148:151], a[188:191], a[124:127]
  v_mfma_f32_16x16x32_bf16 a[140:143], v[152:155], a[188:191], a[140:143]
  s_waitcnt vmcnt(14)
  buffer_load_dwordx4 a[188:191], v2, s[40:43], s67 offen offset:2048 sc1
  v_mfma_f32_16x16x32_bf16 a[64:67], v[156:159], v[216:219], a[64:67]
  v_mfma_f32_16x16x32_bf16 a[80:83], a[48:51], v[216:219], a[80:83]
  v_mfma_f32_16x16x32_bf16 a[96:99], a[52:55], v[216:219], a[96:99]
  v_mfma_f32_16x16x32_bf16 a[112:115], a[56:59], v[216:219], a[112:115]
  v_mfma_f32_16x16x32_bf16 a[128:131], a[60:63], v[216:219], a[128:131]
  buffer_load_dwordx4 v[216:219], v2, s[40:43], s64 offen offset:3072 sc1
  v_mfma_f32_16x16x32_bf16 a[68:71], v[156:159], v[220:223], a[68:71]
  v_mfma_f32_16x16x32_bf16 a[84:87], a[48:51], v[220:223], a[84:87]
  v_mfma_f32_16x16x32_bf16 a[100:103], a[52:55], v[220:223], a[100:103]
  v_mfma_f32_16x16x32_bf16 a[116:119], a[56:59], v[220:223], a[116:119]
  v_mfma_f32_16x16x32_bf16 a[132:135], a[60:63], v[220:223], a[132:135]
  s_waitcnt vmcnt(14)
  buffer_load_dwordx4 v[220:223], v2, s[40:43], s65 offen offset:3072 sc1
  v_mfma_f32_16x16x32_bf16 a[72:75], v[156:159], v[224:227], a[72:75]
  v_mfma_f32_16x16x32_bf16 a[88:91], a[48:51], v[224:227], a[88:91]
  v_mfma_f32_16x16x32_bf16 a[104:107], a[52:55], v[224:227], a[104:107]
  v_mfma_f32_16x16x32_bf16 a[120:123], a[56:59], v[224:227], a[120:123]
  v_mfma_f32_16x16x32_bf16 a[136:139], a[60:63], v[224:227], a[136:139]
  buffer_load_dwordx4 v[224:227], v2, s[40:43], s66 offen offset:3072 sc1
  v_mfma_f32_16x16x32_bf16 a[76:79], v[156:159], v[228:231], a[76:79]
  v_mfma_f32_16x16x32_bf16 a[92:95], a[48:51], v[228:231], a[92:95]
  v_mfma_f32_16x16x32_bf16 a[108:111], a[52:55], v[228:231], a[108:111]
  v_mfma_f32_16x16x32_bf16 a[124:127], a[56:59], v[228:231], a[124:127]
  v_mfma_f32_16x16x32_bf16 a[140:143], a[60:63], v[228:231], a[140:143]
  s_waitcnt vmcnt(11)
  buffer_load_dwordx4 v[228:231], v2, s[40:43], s67 offen offset:3072 sc1
  v_mfma_f32_16x16x32_bf16 a[64:67], a[192:195], a[144:147], a[64:67]
  v_cmp_eq_u32 vcc, 0, v13
  v_mfma_f32_16x16x32_bf16 a[80:83], a[196:199], a[144:147], a[80:83]
  v_mfma_f32_16x16x32_bf16 a[96:99], a[200:203], a[144:147], a[96:99]
  s_cbranch_vccnz fa_ctx2_spin
fa_ctx2_ok:
  v_mfma_f32_16x16x32_bf16 a[112:115], a[204:207], a[144:147], a[112:115]
  s_add_u32 s64, s63, 0
  v_mfma_f32_16x16x32_bf16 a[128:131], v[176:179], a[144:147], a[128:131]
  buffer_load_dwordx4 a[144:147], v2, s[40:43], s64 offen offset:0 sc1
  v_mfma_f32_16x16x32_bf16 a[68:71], a[192:195], a[148:151], a[68:71]
  s_add_u32 s65, s64, 131072
  v_mfma_f32_16x16x32_bf16 a[84:87], a[196:199], a[148:151], a[84:87]
  s_add_u32 s66, s64, 262144
  v_mfma_f32_16x16x32_bf16 a[100:103], a[200:203], a[148:151], a[100:103]
  v_mfma_f32_16x16x32_bf16 a[116:119], a[204:207], a[148:151], a[116:119]
  v_mfma_f32_16x16x32_bf16 a[132:135], v[176:179], a[148:151], a[132:135]
  s_waitcnt vmcnt(14)
  buffer_load_dwordx4 a[148:151], v2, s[40:43], s65 offen offset:0 sc1
  v_mfma_f32_16x16x32_bf16 a[72:75], a[192:195], a[152:155], a[72:75]
  s_add_u32 s67, s64, 393216
  v_mfma_f32_16x16x32_bf16 a[88:91], a[196:199], a[152:155], a[88:91]
  v_mfma_f32_16x16x32_bf16 a[104:107], a[200:203], a[152:155], a[104:107]
  v_mfma_f32_16x16x32_bf16 a[120:123], a[204:207], a[152:155], a[120:123]
  v_mfma_f32_16x16x32_bf16 a[136:139], v[176:179], a[152:155], a[136:139]
  buffer_load_dwordx4 a[152:155], v2, s[40:43], s66 offen offset:0 sc1
  v_mfma_f32_16x16x32_bf16 a[76:79], a[192:195], a[156:159], a[76:79]
  v_mfma_f32_16x16x32_bf16 a[92:95], a[196:199], a[156:159], a[92:95]
  v_mfma_f32_16x16x32_bf16 a[108:111], a[200:203], a[156:159], a[108:111]
  v_mfma_f32_16x16x32_bf16 a[124:127], a[204:207], a[156:159], a[124:127]
  v_mfma_f32_16x16x32_bf16 a[140:143], v[176:179], a[156:159], a[140:143]
  s_waitcnt vmcnt(13)
  buffer_load_dwordx4 a[156:159], v2, s[40:43], s67 offen offset:0 sc1
  v_mfma_f32_16x16x32_bf16 a[64:67], v[180:183], a[160:163], a[64:67]
  v_mfma_f32_16x16x32_bf16 a[80:83], v[184:187], a[160:163], a[80:83]
  v_mfma_f32_16x16x32_bf16 a[96:99], v[188:191], a[160:163], a[96:99]
  v_mfma_f32_16x16x32_bf16 a[112:115], a[208:211], a[160:163], a[112:115]
  v_mfma_f32_16x16x32_bf16 a[128:131], a[212:215], a[160:163], a[128:131]
  buffer_load_dwordx4 a[160:163], v2, s[40:43], s64 offen offset:1024 sc1
  v_mfma_f32_16x16x32_bf16 a[68:71], v[180:183], a[164:167], a[68:71]
  v_mfma_f32_16x16x32_bf16 a[84:87], v[184:187], a[164:167], a[84:87]
  v_mfma_f32_16x16x32_bf16 a[100:103], v[188:191], a[164:167], a[100:103]
  v_mfma_f32_16x16x32_bf16 a[116:119], a[208:211], a[164:167], a[116:119]
  v_mfma_f32_16x16x32_bf16 a[132:135], a[212:215], a[164:167], a[132:135]
  s_waitcnt vmcnt(13)
  buffer_load_dwordx4 a[164:167], v2, s[40:43], s65 offen offset:1024 sc1
  v_mfma_f32_16x16x32_bf16 a[72:75], v[180:183], a[168:171], a[72:75]
  v_mfma_f32_16x16x32_bf16 a[88:91], v[184:187], a[168:171], a[88:91]
  v_mfma_f32_16x16x32_bf16 a[104:107], v[188:191], a[168:171], a[104:107]
  v_mfma_f32_16x16x32_bf16 a[120:123], a[208:211], a[168:171], a[120:123]
  v_mfma_f32_16x16x32_bf16 a[136:139], a[212:215], a[168:171], a[136:139]
  buffer_load_dwordx4 a[168:171], v2, s[40:43], s66 offen offset:1024 sc1
  v_mfma_f32_16x16x32_bf16 a[76:79], v[180:183], a[172:175], a[76:79]
  v_mfma_f32_16x16x32_bf16 a[92:95], v[184:187], a[172:175], a[92:95]
  v_mfma_f32_16x16x32_bf16 a[108:111], v[188:191], a[172:175], a[108:111]
  v_mfma_f32_16x16x32_bf16 a[124:127], a[208:211], a[172:175], a[124:127]
  v_mfma_f32_16x16x32_bf16 a[140:143], a[212:215], a[172:175], a[140:143]
  s_waitcnt vmcnt(13)
  buffer_load_dwordx4 a[172:175], v2, s[40:43], s67 offen offset:1024 sc1
  v_mfma_f32_16x16x32_bf16 a[64:67], a[216:219], a[176:179], a[64:67]
  v_mfma_f32_16x16x32_bf16 a[80:83], a[220:223], a[176:179], a[80:83]
  v_mfma_f32_16x16x32_bf16 a[96:99], a[224:227], a[176:179], a[96:99]
  v_mfma_f32_16x16x32_bf16 a[112:115], a[228:231], a[176:179], a[112:115]
  v_mfma_f32_16x16x32_bf16 a[128:131], a[232:235], a[176:179], a[128:131]
  buffer_load_dwordx4 a[176:179], v2, s[40:43], s64 offen offset:2048 sc1
  v_mfma_f32_16x16x32_bf16 a[68:71], a[216:219], a[180:183], a[68:71]
  v_mfma_f32_16x16x32_bf16 a[84:87], a[220:223], a[180:183], a[84:87]
  v_mfma_f32_16x16x32_bf16 a[100:103], a[224:227], a[180:183], a[100:103]
  v_mfma_f32_16x16x32_bf16 a[116:119], a[228:231], a[180:183], a[116:119]
  v_mfma_f32_16x16x32_bf16 a[132:135], a[232:235], a[180:183], a[132:135]
  s_waitcnt vmcnt(13)
  buffer_load_dwordx4 a[180:183], v2, s[40:43], s65 offen offset:2048 sc1
  v_mfma_f32_16x16x32_bf16 a[72:75], a[216:219], a[184:187], a[72:75]
  v_mfma_f32_16x16x32_bf16 a[88:91], a[220:223], a[184:187], a[88:91]
  v_mfma_f32_16x16x32_bf16 a[104:107], a[224:227], a[184:187], a[104:107]
  v_mfma_f32_16x16x32_bf16 a[120:123], a[228:231], a[184:187], a[120:123]
  v_mfma_f32_16x16x32_bf16 a[136:139], a[232:235], a[184:187], a[136:139]
  buffer_load_dwordx4 a[184:187], v2, s[40:43], s66 offen offset:2048 sc1
  v_mfma_f32_16x16x32_bf16 a[76:79], a[216:219], a[188:191], a[76:79]
  v_mfma_f32_16x16x32_bf16 a[92:95], a[220:223], a[188:191], a[92:95]
  v_mfma_f32_16x16x32_bf16 a[108:111], a[224:227], a[188:191], a[108:111]
  v_mfma_f32_16x16x32_bf16 a[124:127], a[228:231], a[188:191], a[124:127]
  v_mfma_f32_16x16x32_bf16 a[140:143], a[232:235], a[188:191], a[140:143]
  s_waitcnt vmcnt(13)
  buffer_load_dwordx4 a[188:191], v2, s[40:43], s67 offen offset:2048 sc1
  v_mfma_f32_16x16x32_bf16 a[64:67], a[236:239], v[216:219], a[64:67]
  v_mfma_f32_16x16x32_bf16 a[80:83], a[240:243], v[216:219], a[80:83]
  v_mfma_f32_16x16x32_bf16 a[96:99], a[244:247], v[216:219], a[96:99]
  v_mfma_f32_16x16x32_bf16 a[112:115], a[248:251], v[216:219], a[112:115]
  v_mfma_f32_16x16x32_bf16 a[128:131], a[252:255], v[216:219], a[128:131]
  buffer_load_dwordx4 v[216:219], v2, s[40:43], s64 offen offset:3072 sc1
  v_mfma_f32_16x16x32_bf16 a[68:71], a[236:239], v[220:223], a[68:71]
  v_mfma_f32_16x16x32_bf16 a[84:87], a[240:243], v[220:223], a[84:87]
  v_mfma_f32_16x16x32_bf16 a[100:103], a[244:247], v[220:223], a[100:103]
  v_mfma_f32_16x16x32_bf16 a[116:119], a[248:251], v[220:223], a[116:119]
  v_mfma_f32_16x16x32_bf16 a[132:135], a[252:255], v[220:223], a[132:135]
  s_waitcnt vmcnt(13)
  buffer_load_dwordx4 v[220:223], v2, s[40:43], s65 offen offset:3072 sc1
  ds_write_b128 v16, a[64:67] offset:0
  v_mfma_f32_16x16x32_bf16 a[72:75], a[236:239], v[224:227], a[72:75]
  ds_write_b128 v16, a[80:83] offset:64
  v_mfma_f32_16x16x32_bf16 a[88:91], a[240:243], v[224:227], a[88:91]
  ds_write_b128 v16, a[96:99] offset:128
  v_mfma_f32_16x16x32_bf16 a[104:107], a[244:247], v[224:227], a[104:107]
  ds_write_b128 v16, a[112:115] offset:192
  v_mfma_f32_16x16x32_bf16 a[120:123], a[248:251], v[224:227], a[120:123]
  ds_write_b128 v16, a[128:131] offset:256
  v_mfma_f32_16x16x32_bf16 a[136:139], a[252:255], v[224:227], a[136:139]
  buffer_load_dwordx4 v[224:227], v2, s[40:43], s66 offen offset:3072 sc1
  ds_write_b128 v16, a[68:71] offset:5376
  v_mfma_f32_16x16x32_bf16 a[76:79], a[236:239], v[228:231], a[76:79]
  ds_write_b128 v16, a[84:87] offset:5440
  v_mfma_f32_16x16x32_bf16 a[92:95], a[240:243], v[228:231], a[92:95]
  ds_write_b128 v16, a[100:103] offset:5504
  v_mfma_f32_16x16x32_bf16 a[108:111], a[244:247], v[228:231], a[108:111]
  ds_write_b128 v16, a[116:119] offset:5568
  v_mfma_f32_16x16x32_bf16 a[124:127], a[248:251], v[228:231], a[124:127]
  ds_write_b128 v16, a[132:135] offset:5632
  v_mfma_f32_16x16x32_bf16 a[140:143], a[252:255], v[228:231], a[140:143]
  s_waitcnt vmcnt(13)
  buffer_load_dwordx4 v[228:231], v2, s[40:43], s67 offen offset:3072 sc1
  ds_write_b128 v16, a[72:75] offset:10752
  v_mfma_f32_16x16x32_bf16 a[64:67], v[32:35], a[144:147], 0
  ds_write_b128 v16, a[88:91] offset:10816
  v_mfma_f32_16x16x32_bf16 a[80:83], v[36:39], a[144:147], 0
  ds_write_b128 v16, a[104:107] offset:10880
  v_mfma_f32_16x16x32_bf16 a[96:99], v[40:43], a[144:147], 0
  ds_write_b128 v16, a[120:123] offset:10944
  v_mfma_f32_16x16x32_bf16 a[112:115], v[44:47], a[144:147], 0
  s_add_u32 s64, s64, 4096
  ds_write_b128 v16, a[136:139] offset:11008
  v_mfma_f32_16x16x32_bf16 a[128:131], v[48:51], a[144:147], 0
  buffer_load_dwordx4 a[144:147], v2, s[40:43], s64 offen offset:0 sc1
  ds_write_b128 v16, a[76:79] offset:16128
  v_mfma_f32_16x16x32_bf16 a[68:71], v[32:35], a[148:151], 0
  s_add_u32 s65, s64, 131072
  ds_write_b128 v16, a[92:95] offset:16192
  v_mfma_f32_16x16x32_bf16 a[84:87], v[36:39], a[148:151], 0
  s_add_u32 s66, s64, 262144
  ds_write_b128 v16, a[108:111] offset:16256
  v_mfma_f32_16x16x32_bf16 a[100:103], v[40:43], a[148:151], 0
  ds_write_b128 v16, a[124:127] offset:16320
  v_mfma_f32_16x16x32_bf16 a[116:119], v[44:47], a[148:151], 0
  ds_write_b128 v16, a[140:143] offset:16384
  v_mfma_f32_16x16x32_bf16 a[132:135], v[48:51], a[148:151], 0
  s_waitcnt vmcnt(13)
  buffer_load_dwordx4 a[148:151], v2, s[40:43], s65 offen offset:0 sc1
  v_mfma_f32_16x16x32_bf16 a[72:75], v[32:35], a[152:155], 0
  s_add_u32 s67, s64, 393216
  v_mfma_f32_16x16x32_bf16 a[88:91], v[36:39], a[152:155], 0
  v_mfma_f32_16x16x32_bf16 a[104:107], v[40:43], a[152:155], 0
  v_mfma_f32_16x16x32_bf16 a[120:123], v[44:47], a[152:155], 0
  v_mfma_f32_16x16x32_bf16 a[136:139], v[48:51], a[152:155], 0
  buffer_load_dwordx4 a[152:155], v2, s[40:43], s66 offen offset:0 sc1
  v_mfma_f32_16x16x32_bf16 a[76:79], v[32:35], a[156:159], 0
  v_mfma_f32_16x16x32_bf16 a[92:95], v[36:39], a[156:159], 0
  v_mfma_f32_16x16x32_bf16 a[108:111], v[40:43], a[156:159], 0
  v_mfma_f32_16x16x32_bf16 a[124:127], v[44:47], a[156:159], 0
  v_mfma_f32_16x16x32_bf16 a[140:143], v[48:51], a[156:159], 0
  s_waitcnt vmcnt(13) lgkmcnt(0)
  buffer_load_dwordx4 a[156:159], v2, s[40:43], s67 offen offset:0 sc1
  v_mfma_f32_16x16x32_bf16 a[64:67], v[52:55], a[160:163], a[64:67]
  v_mfma_f32_16x16x32_bf16 a[80:83], v[56:59], a[160:163], a[80:83]
  v_mfma_f32_16x16x32_bf16 a[96:99], v[60:63], a[160:163], a[96:99]
  v_mfma_f32_16x16x32_bf16 a[112:115], v[96:99], a[160:163], a[112:115]
  v_mfma_f32_16x16x32_bf16 a[128:131], v[100:103], a[160:163], a[128:131]
  buffer_load_dwordx4 a[160:163], v2, s[40:43], s64 offen offset:1024 sc1
  v_mfma_f32_16x16x32_bf16 a[68:71], v[52:55], a[164:167], a[68:71]
  v_mfma_f32_16x16x32_bf16 a[84:87], v[56:59], a[164:167], a[84:87]
  v_mfma_f32_16x16x32_bf16 a[100:103], v[60:63], a[164:167], a[100:103]
  s_barrier
  v_mfma_f32_16x16x32_bf16 a[116:119], v[96:99], a[164:167], a[116:119]
  v_mfma_f32_16x16x32_bf16 a[132:135], v[100:103], a[164:167], a[132:135]
  s_waitcnt vmcnt(13)
  buffer_load_dwordx4 a[164:167], v2, s[40:43], s65 offen offset:1024 sc1
  v_mfma_f32_16x16x32_bf16 a[72:75], v[52:55], a[168:171], a[72:75]
  v_mfma_f32_16x16x32_bf16 a[88:91], v[56:59], a[168:171], a[88:91]
  v_mfma_f32_16x16x32_bf16 a[104:107], v[60:63], a[168:171], a[104:107]
  v_mfma_f32_16x16x32_bf16 a[120:123], v[96:99], a[168:171], a[120:123]
  v_mfma_f32_16x16x32_bf16 a[136:139], v[100:103], a[168:171], a[136:139]
  buffer_load_dwordx4 a[168:171], v2, s[40:43], s66 offen offset:1024 sc1
  v_mfma_f32_16x16x32_bf16 a[76:79], v[52:55], a[172:175], a[76:79]
  v_mfma_f32_16x16x32_bf16 a[92:95], v[56:59], a[172:175], a[92:95]
  v_mfma_f32_16x16x32_bf16 a[108:111], v[60:63], a[172:175], a[108:111]
  v_mfma_f32_16x16x32_bf16 a[124:127], v[96:99], a[172:175], a[124:127]
  v_mfma_f32_16x16x32_bf16 a[140:143], v[100:103], a[172:175], a[140:143]
  s_waitcnt vmcnt(13)
  buffer_load_dwordx4 a[172:175], v2, s[40:43], s67 offen offset:1024 sc1
  v_mfma_f32_16x16x32_bf16 a[64:67], v[104:107], a[176:179], a[64:67]
  ds_read_b128 v[32:35], v251 offset:0
  v_mfma_f32_16x16x32_bf16 a[80:83], v[108:111], a[176:179], a[80:83]
  ds_read_b128 v[36:39], v251 offset:16
  v_mfma_f32_16x16x32_bf16 a[96:99], v[112:115], a[176:179], a[96:99]
  ds_read_b128 v[40:43], v251 offset:21504
  v_mfma_f32_16x16x32_bf16 a[112:115], v[116:119], a[176:179], a[112:115]
  ds_read_b128 v[44:47], v251 offset:21520
  v_mfma_f32_16x16x32_bf16 a[128:131], v[120:123], a[176:179], a[128:131]
  buffer_load_dwordx4 a[176:179], v2, s[40:43], s64 offen offset:2048 sc1
  v_mfma_f32_16x16x32_bf16 a[68:71], v[104:107], a[180:183], a[68:71]
  ds_read_b128 v[48:51], v251 offset:43008
  v_mfma_f32_16x16x32_bf16 a[84:87], v[108:111], a[180:183], a[84:87]
  ds_read_b128 v[52:55], v251 offset:43024
  v_mfma_f32_16x16x32_bf16 a[100:103], v[112:115], a[180:183], a[100:103]
  ds_read_b128 v[56:59], v251 offset:64512
  v_mfma_f32_16x16x32_bf16 a[116:119], v[116:119], a[180:183], a[116:119]
  ds_read_b128 v[60:63], v251 offset:64528
  v_mfma_f32_16x16x32_bf16 a[132:135], v[120:123], a[180:183], a[132:135]
  s_waitcnt vmcnt(13)
  buffer_load_dwordx4 a[180:183], v2, s[40:43], s65 offen offset:2048 sc1
  v_mfma_f32_16x16x32_bf16 a[72:75], v[104:107], a[184:187], a[72:75]
  v_mfma_f32_16x16x32_bf16 a[88:91], v[108:111], a[184:187], a[88:91]
  v_mfma_f32_16x16x32_bf16 a[104:107], v[112:115], a[184:187], a[104:107]
  v_mfma_f32_16x16x32_bf16 a[120:123], v[116:119], a[184:187], a[120:123]
  v_mfma_f32_16x16x32_bf16 a[136:139], v[120:123], a[184:187], a[136:139]
  buffer_load_dwordx4 a[184:187], v2, s[40:43], s66 offen offset:2048 sc1
  v_mfma_f32_16x16x32_bf16 a[76:79], v[104:107], a[188:191], a[76:79]
  v_mfma_f32_16x16x32_bf16 a[92:95], v[108:111], a[188:191], a[92:95]
  v_mfma_f32_16x16x32_bf16 a[108:111], v[112:115], a[188:191], a[108:111]
  v_mfma_f32_16x16x32_bf16 a[124:127], v[116:119], a[188:191], a[124:127]
  v_mfma_f32_16x16x32_bf16 a[140:143], v[120:123], a[188:191], a[140:143]
  s_waitcnt vmcnt(13) lgkmcnt(0)
  buffer_load_dwordx4 a[188:191], v2, s[40:43], s67 offen offset:2048 sc1
  v_mfma_f32_16x16x32_bf16 a[64:67], v[124:127], v[216:219], a[64:67]
  v_add_f32 v32, v32, v40
  v_add_f32 v48, v48, v56
  v_mfma_f32_16x16x32_bf16 a[80:83], v[160:163], v[216:219], a[80:83]
  v_add_f32 v33, v33, v41
  v_add_f32 v49, v49, v57
  v_mfma_f32_16x16x32_bf16 a[96:99], v[164:167], v[216:219], a[96:99]
  v_add_f32 v34, v34, v42
  v_mfma_f32_16x16x32_bf16 a[112:115], v[168:171], v[216:219], a[112:115]
  v_add_f32 v50, v50, v58
  v_add_f32 v35, v35, v43
  v_mfma_f32_16x16x32_bf16 a[128:131], v[172:175], v[216:219], a[128:131]
  buffer_load_dwordx4 v[216:219], v2, s[40:43], s64 offen offset:3072 sc1
  v_add_f32 v51, v51, v59
  v_mfma_f32_16x16x32_bf16 a[68:71], v[124:127], v[220:223], a[68:71]
  v_add_f32 v36, v36, v44
  v_add_f32 v52, v52, v60
  v_mfma_f32_16x16x32_bf16 a[84:87], v[160:163], v[220:223], a[84:87]
  v_add_f32 v37, v37, v45
  v_add_f32 v53, v53, v61
  v_mfma_f32_16x16x32_bf16 a[100:103], v[164:167], v[220:223], a[100:103]
  v_add_f32 v38, v38, v46
  v_mfma_f32_16x16x32_bf16 a[116:119], v[168:171], v[220:223], a[116:119]
  v_add_f32 v54, v54, v62
  v_add_f32 v39, v39, v47
  v_mfma_f32_16x16x32_bf16 a[132:135], v[172:175], v[220:223], a[132:135]
  s_waitcnt vmcnt(13)
  buffer_load_dwordx4 v[220:223], v2, s[40:43], s65 offen offset:3072 sc1
  v_add_f32 v55, v55, v63
  v_mfma_f32_16x16x32_bf16 a[72:75], v[124:127], v[224:227], a[72:75]
  v_add_f32 v32, v32, v48
  v_add_f32 v33, v33, v49
  v_mfma_f32_16x16x32_bf16 a[88:91], v[160:163], v[224:227], a[88:91]
  v_add_f32 v34, v34, v50
  v_add_f32 v35, v35, v51
  v_mfma_f32_16x16x32_bf16 a[104:107], v[164:167], v[224:227], a[104:107]
  v_add_f32 v36, v36, v52
  v_mfma_f32_16x16x32_bf16 a[120:123], v[168:171], v[224:227], a[120:123]
  v_add_f32 v37, v37, v53
  v_add_f32 v38, v38, v54
  v_mfma_f32_16x16x32_bf16 a[136:139], v[172:175], v[224:227], a[136:139]
  buffer_load_dwordx4 v[224:227], v2, s[40:43], s66 offen offset:3072 sc1
  v_add_f32 v39, v39, v55
  v_mfma_f32_16x16x32_bf16 a[76:79], v[124:127], v[228:231], a[76:79]
  s_add_u32 s14, s28, 0
  v_mfma_f32_16x16x32_bf16 a[92:95], v[160:163], v[228:231], a[92:95]
  buffer_store_dwordx4 v[32:35], v9, s[40:43], s14 offen sc1
  v_mfma_f32_16x16x32_bf16 a[108:111], v[164:167], v[228:231], a[108:111]
  s_add_u32 s14, s28, 4096
  v_mfma_f32_16x16x32_bf16 a[124:127], v[168:171], v[228:231], a[124:127]
  buffer_store_dwordx4 v[36:39], v9, s[40:43], s14 offen sc1
  v_mfma_f32_16x16x32_bf16 a[140:143], v[172:175], v[228:231], a[140:143]
  s_waitcnt vmcnt(15)
  buffer_load_dwordx4 v[228:231], v2, s[40:43], s67 offen offset:3072 sc1
  v_mfma_f32_16x16x32_bf16 a[64:67], v[232:235], a[144:147], a[64:67]
  ds_read_b128 v[96:99], v252 offset:0
  v_mfma_f32_16x16x32_bf16 a[80:83], v[236:239], a[144:147], a[80:83]
  ds_read_b128 v[100:103], v252 offset:16
  v_mfma_f32_16x16x32_bf16 a[96:99], v[240:243], a[144:147], a[96:99]
  ds_read_b128 v[104:107], v252 offset:21504
  v_mfma_f32_16x16x32_bf16 a[112:115], v[244:247], a[144:147], a[112:115]
  s_add_u32 s64, s64, 4096
  ds_read_b128 v[108:111], v252 offset:21520
  v_mfma_f32_16x16x32_bf16 a[128:131], v[192:195], a[144:147], a[128:131]
  buffer_load_dwordx4 a[144:147], v2, s[40:43], s64 offen offset:0 sc1
  v_mfma_f32_16x16x32_bf16 a[68:71], v[232:235], a[148:151], a[68:71]
  s_add_u32 s65, s64, 131072
  ds_read_b128 v[112:115], v252 offset:43008
  v_mfma_f32_16x16x32_bf16 a[84:87], v[236:239], a[148:151], a[84:87]
  s_add_u32 s66, s64, 262144
  ds_read_b128 v[116:119], v252 offset:43024
  v_mfma_f32_16x16x32_bf16 a[100:103], v[240:243], a[148:151], a[100:103]
  ds_read_b128 v[120:123], v252 offset:64512
  v_mfma_f32_16x16x32_bf16 a[116:119], v[244:247], a[148:151], a[116:119]
  ds_read_b128 v[124:127], v252 offset:64528
  v_mfma_f32_16x16x32_bf16 a[132:135], v[192:195], a[148:151], a[132:135]
  s_waitcnt vmcnt(15)
  buffer_load_dwordx4 a[148:151], v2, s[40:43], s65 offen offset:0 sc1
  v_mfma_f32_16x16x32_bf16 a[72:75], v[232:235], a[152:155], a[72:75]
  s_add_u32 s67, s64, 393216
  v_mfma_f32_16x16x32_bf16 a[88:91], v[236:239], a[152:155], a[88:91]
  v_mfma_f32_16x16x32_bf16 a[104:107], v[240:243], a[152:155], a[104:107]
  v_mfma_f32_16x16x32_bf16 a[120:123], v[244:247], a[152:155], a[120:123]
  v_mfma_f32_16x16x32_bf16 a[136:139], v[192:195], a[152:155], a[136:139]
  buffer_load_dwordx4 a[152:155], v2, s[40:43], s66 offen offset:0 sc1
  v_mfma_f32_16x16x32_bf16 a[76:79], v[232:235], a[156:159], a[76:79]
  v_mfma_f32_16x16x32_bf16 a[92:95], v[236:239], a[156:159], a[92:95]
  v_mfma_f32_16x16x32_bf16 a[108:111], v[240:243], a[156:159], a[108:111]
  v_mfma_f32_16x16x32_bf16 a[124:127], v[244:247], a[156:159], a[124:127]
  v_mfma_f32_16x16x32_bf16 a[140:143], v[192:195], a[156:159], a[140:143]
  s_waitcnt vmcnt(15) lgkmcnt(0)
  buffer_load_dwordx4 a[156:159], v2, s[40:43], s67 offen offset:0 sc1
  v_mfma_f32_16x16x32_bf16 a[64:67], v[196:199], a[160:163], a[64:67]
  ds_read_b128 v[32:35], v253 offset:0
  v_add_f32 v96, v96, v104
  v_add_f32 v112, v112, v120
  v_mfma_f32_16x16x32_bf16 a[80:83], v[208:211], a[160:163], a[80:83]
  ds_read_b128 v[36:39], v253 offset:16
  v_add_f32 v97, v97, v105
  v_add_f32 v113, v113, v121
  v_mfma_f32_16x16x32_bf16 a[96:99], v[212:215], a[160:163], a[96:99]
  ds_read_b128 v[40:43], v253 offset:21504
  v_add_f32 v98, v98, v106
  v_mfma_f32_16x16x32_bf16 a[112:115], a[0:3], a[160:163], a[112:115]
  ds_read_b128 v[44:47], v253 offset:21520
  v_add_f32 v114, v114, v122
  v_add_f32 v99, v99, v107
  v_mfma_f32_16x16x32_bf16 a[128:131], a[4:7], a[160:163], a[128:131]
  buffer_load_dwordx4 a[160:163], v2, s[40:43], s64 offen offset:1024 sc1
  v_add_f32 v115, v115, v123
  v_mfma_f32_16x16x32_bf16 a[68:71], v[196:199], a[164:167], a[68:71]
  ds_read_b128 v[48:51], v253 offset:43008
  v_add_f32 v100, v100, v108
  v_add_f32 v116, v116, v124
  v_mfma_f32_16x16x32_bf16 a[84:87], v[208:211], a[164:167], a[84:87]
  ds_read_b128 v[52:55], v253 offset:43024
  v_add_f32 v101, v101, v109
  v_add_f32 v117, v117, v125
  v_mfma_f32_16x16x32_bf16 a[100:103], v[212:215], a[164:167], a[100:103]
  ds_read_b128 v[56:59], v253 offset:64512
  v_add_f32 v102, v102, v110
  v_mfma_f32_16x16x32_bf16 a[116:119], a[0:3], a[164:167], a[116:119]
  ds_read_b128 v[60:63], v253 offset:64528
  v_add_f32 v118, v118, v126
  v_add_f32 v103, v103, v111
  v_mfma_f32_16x16x32_bf16 a[132:135], a[4:7], a[164:167], a[132:135]
  s_waitcnt vmcnt(15)
  buffer_load_dwordx4 a[164:167], v2, s[40:43], s65 offen offset:1024 sc1
  v_add_f32 v119, v119, v127
  v_mfma_f32_16x16x32_bf16 a[72:75], v[196:199], a[168:171], a[72:75]
  v_add_f32 v96, v96, v112
  v_add_f32 v97, v97, v113
  v_mfma_f32_16x16x32_bf16 a[88:91], v[208:211], a[168:171], a[88:91]
  v_add_f32 v98, v98, v114
  v_add_f32 v99, v99, v115
  v_mfma_f32_16x16x32_bf16 a[104:107], v[212:215], a[168:171], a[104:107]
  v_add_f32 v100, v100, v116
  v_mfma_f32_16x16x32_bf16 a[120:123], a[0:3], a[168:171], a[120:123]
  v_add_f32 v101, v101, v117
  v_add_f32 v102, v102, v118
  v_mfma_f32_16x16x32_bf16 a[136:139], a[4:7], a[168:171], a[136:139]
  buffer_load_dwordx4 a[168:171], v2, s[40:43], s66 offen offset:1024 sc1
  v_add_f32 v103, v103, v119
  v_mfma_f32_16x16x32_bf16 a[76:79], v[196:199], a[172:175], a[76:79]
  s_add_u32 s14, s28, 8192
  v_mfma_f32_16x16x32_bf16 a[92:95], v[208:211], a[172:175], a[92:95]
  buffer_store_dwordx4 v[96:99], v9, s[40:43], s14 offen sc1
  v_mfma_f32_16x16x32_bf16 a[108:111], v[212:215], a[172:175], a[108:111]
  s_add_u32 s14, s28, 12288
  v_mfma_f32_16x16x32_bf16 a[124:127], a[0:3], a[172:175], a[124:127]
  buffer_store_dwordx4 v[100:103], v9, s[40:43], s14 offen sc1
  v_mfma_f32_16x16x32_bf16 a[140:143], a[4:7], a[172:175], a[140:143]
  s_waitcnt vmcnt(17) lgkmcnt(0)
  buffer_load_dwordx4 a[172:175], v2, s[40:43], s67 offen offset:1024 sc1
  v_mfma_f32_16x16x32_bf16 a[64:67], a[8:11], a[176:179], a[64:67]
  v_add_f32 v32, v32, v40
  v_add_f32 v48, v48, v56
  v_mfma_f32_16x16x32_bf16 a[80:83], a[12:15], a[176:179], a[80:83]
  v_add_f32 v33, v33, v41
  v_add_f32 v49, v49, v57
  v_mfma_f32_16x16x32_bf16 a[96:99], v[64:67], a[176:179], a[96:99]
  v_add_f32 v34, v34, v42
  v_mfma_f32_16x16x32_bf16 a[112:115], v[68:71], a[176:179], a[112:115]
  v_add_f32 v50, v50, v58
  v_add_f32 v35, v35, v43
  v_mfma_f32_16x16x32_bf16 a[128:131], v[72:75], a[176:179], a[128:131]
  buffer_load_dwordx4 a[176:179], v2, s[40:43], s64 offen offset:2048 sc1
  v_add_f32 v51, v51, v59
  v_mfma_f32_16x16x32_bf16 a[68:71], a[8:11], a[180:183], a[68:71]
  v_add_f32 v36, v36, v44
  v_add_f32 v52, v52, v60
  v_mfma_f32_16x16x32_bf16 a[84:87], a[12:15], a[180:183], a[84:87]
  v_add_f32 v37, v37, v45
  v_add_f32 v53, v53, v61
  v_mfma_f32_16x16x32_bf16 a[100:103], v[64:67], a[180:183], a[100:103]
  v_add_f32 v38, v38, v46
  v_mfma_f32_16x16x32_bf16 a[116:119], v[68:71], a[180:183], a[116:119]
  v_add_f32 v54, v54, v62
  v_add_f32 v39, v39, v47
  v_mfma_f32_16x16x32_bf16 a[132:135], v[72:75], a[180:183], a[132:135]
  s_waitcnt vmcnt(17)
  buffer_load_dwordx4 a[180:183], v2, s[40:43], s65 offen offset:2048 sc1
  v_add_f32 v55, v55, v63
  v_mfma_f32_16x16x32_bf16 a[72:75], a[8:11], a[184:187], a[72:75]
  v_add_f32 v32, v32, v48
  v_add_f32 v33, v33, v49
  v_mfma_f32_16x16x32_bf16 a[88:91], a[12:15], a[184:187], a[88:91]
  v_add_f32 v34, v34, v50
  v_add_f32 v35, v35, v51
  v_mfma_f32_16x16x32_bf16 a[104:107], v[64:67], a[184:187], a[104:107]
  v_add_f32 v36, v36, v52
  v_mfma_f32_16x16x32_bf16 a[120:123], v[68:71], a[184:187], a[120:123]
  v_add_f32 v37, v37, v53
  v_add_f32 v38, v38, v54
  v_mfma_f32_16x16x32_bf16 a[136:139], v[72:75], a[184:187], a[136:139]
  buffer_load_dwordx4 a[184:187], v2, s[40:43], s66 offen offset:2048 sc1
  v_add_f32 v39, v39, v55
  v_mfma_f32_16x16x32_bf16 a[76:79], a[8:11], a[188:191], a[76:79]
  s_add_u32 s14, s28, 16384
  v_mfma_f32_16x16x32_bf16 a[92:95], a[12:15], a[188:191], a[92:95]
  buffer_store_dwordx4 v[32:35], v6, s[40:43], s14 offen sc1
  v_mfma_f32_16x16x32_bf16 a[108:111], v[64:67], a[188:191], a[108:111]
  s_add_u32 s14, s28, 20480
  v_mfma_f32_16x16x32_bf16 a[124:127], v[68:71], a[188:191], a[124:127]
  buffer_store_dwordx4 v[36:39], v6, s[40:43], s14 offen sc1
  v_mfma_f32_16x16x32_bf16 a[140:143], v[72:75], a[188:191], a[140:143]
  s_waitcnt vmcnt(19)
  buffer_load_dwordx4 a[188:191], v2, s[40:43], s67 offen offset:2048 sc1
  v_mfma_f32_16x16x32_bf16 a[64:67], v[76:79], v[216:219], a[64:67]
  v_mfma_f32_16x16x32_bf16 a[80:83], v[80:83], v[216:219], a[80:83]
  v_mfma_f32_16x16x32_bf16 a[96:99], v[84:87], v[216:219], a[96:99]
  v_mfma_f32_16x16x32_bf16 a[112:115], v[88:91], v[216:219], a[112:115]
  v_mfma_f32_16x16x32_bf16 a[128:131], v[92:95], v[216:219], a[128:131]
  buffer_load_dwordx4 v[216:219], v2, s[40:43], s64 offen offset:3072 sc1
  v_mfma_f32_16x16x32_bf16 a[68:71], v[76:79], v[220:223], a[68:71]
  v_mfma_f32_16x16x32_bf16 a[84:87], v[80:83], v[220:223], a[84:87]
  v_mfma_f32_16x16x32_bf16 a[100:103], v[84:87], v[220:223], a[100:103]
  s_barrier
  v_mfma_f32_16x16x32_bf16 a[116:119], v[88:91], v[220:223], a[116:119]
  v_mfma_f32_16x16x32_bf16 a[132:135], v[92:95], v[220:223], a[132:135]
  s_waitcnt vmcnt(17)
  buffer_load_dwordx4 v[220:223], v2, s[40:43], s65 offen offset:3072 sc1
  v_mfma_f32_16x16x32_bf16 a[72:75], v[76:79], v[224:227], a[72:75]
  v_mfma_f32_16x16x32_bf16 a[88:91], v[80:83], v[224:227], a[88:91]
  v_mfma_f32_16x16x32_bf16 a[104:107], v[84:87], v[224:227], a[104:107]
  v_mfma_f32_16x16x32_bf16 a[120:123], v[88:91], v[224:227], a[120:123]
  v_mfma_f32_16x16x32_bf16 a[136:139], v[92:95], v[224:227], a[136:139]
  buffer_load_dwordx4 v[224:227], v2, s[40:43], s66 offen offset:3072 sc1
  v_mfma_f32_16x16x32_bf16 a[76:79], v[76:79], v[228:231], a[76:79]
  v_mfma_f32_16x16x32_bf16 a[92:95], v[80:83], v[228:231], a[92:95]
  v_mfma_f32_16x16x32_bf16 a[108:111], v[84:87], v[228:231], a[108:111]
  v_mfma_f32_16x16x32_bf16 a[124:127], v[88:91], v[228:231], a[124:127]
  v_mfma_f32_16x16x32_bf16 a[140:143], v[92:95], v[228:231], a[140:143]
  s_waitcnt vmcnt(17)
  buffer_load_dwordx4 v[228:231], v2, s[40:43], s67 offen offset:3072 sc1
  v_mfma_f32_16x16x32_bf16 a[64:67], a[16:19], a[144:147], a[64:67]
  ds_read_b128 v[160:163], v200 offset:0
  v_mfma_f32_16x16x32_bf16 a[80:83], a[20:23], a[144:147], a[80:83]
  v_mfma_f32_16x16x32_bf16 a[96:99], a[24:27], a[144:147], a[96:99]
  v_mfma_f32_16x16x32_bf16 a[112:115], a[28:31], a[144:147], a[112:115]
  s_add_u32 s64, s64, 4096
  ds_read_b128 v[164:167], v200 offset:1024
  v_mfma_f32_16x16x32_bf16 a[128:131], a[32:35], a[144:147], a[128:131]
  buffer_load_dwordx4 a[144:147], v2, s[40:43], s64 offen offset:0 sc1
  v_mfma_f32_16x16x32_bf16 a[68:71], a[16:19], a[148:151], a[68:71]
  s_add_u32 s65, s64, 131072
  ds_read_b128 v[168:171], v200 offset:2048
  v_mfma_f32_16x16x32_bf16 a[84:87], a[20:23], a[148:151], a[84:87]
  s_add_u32 s66, s64, 262144
  ds_read_b128 v[172:175], v200 offset:3072
  v_mfma_f32_16x16x32_bf16 a[100:103], a[24:27], a[148:151], a[100:103]
  v_mfma_f32_16x16x32_bf16 a[116:119], a[28:31], a[148:151], a[116:119]
  ds_read_b128 v[232:235], v200 offset:4096
  v_mfma_f32_16x16x32_bf16 a[132:135], a[32:35], a[148:151], a[132:135]
  s_waitcnt vmcnt(17)
  buffer_load_dwordx4 a[148:151], v2, s[40:43], s65 offen offset:0 sc1
  v_mfma_f32_16x16x32_bf16 a[72:75], a[16:19], a[152:155], a[72:75]
  s_add_u32 s67, s64, 393216
  ds_read_b128 v[236:239], v201 offset:0
  v_mfma_f32_16x16x32_bf16 a[88:91], a[20:23], a[152:155], a[88:91]
  v_mfma_f32_16x16x32_bf16 a[104:107], a[24:27], a[152:155], a[104:107]
  v_mfma_f32_16x16x32_bf16 a[120:123], a[28:31], a[152:155], a[120:123]
  v_mfma_f32_16x16x32_bf16 a[136:139], a[32:35], a[152:155], a[136:139]
  buffer_load_dwordx4 a[152:155], v2, s[40:43], s66 offen offset:0 sc1
  v_mfma_f32_16x16x32_bf16 a[76:79], a[16:19], a[156:159], a[76:79]
  v_mfma_f32_16x16x32_bf16 a[92:95], a[20:23], a[156:159], a[92:95]
  v_mfma_f32_16x16x32_bf16 a[108:111], a[24:27], a[156:159], a[108:111]
  v_mfma_f32_16x16x32_bf16 a[124:127], a[28:31], a[156:159], a[124:127]
  v_mfma_f32_16x16x32_bf16 a[140:143], a[32:35], a[156:159], a[140:143]
  s_waitcnt vmcnt(8)
  buffer_load_dwordx4 a[156:159], v2, s[40:43], s67 offen offset:0 sc1
  v_mfma_f32_16x16x32_bf16 a[64:67], a[36:39], a[160:163], a[64:67]
  ds_read_b128 v[120:123], v203 offset:0
  v_mfma_f32_16x16x32_bf16 a[80:83], a[40:43], a[160:163], a[80:83]
  buffer_store_dword v4, off, s[40:43], s30 sc1
  v_mfma_f32_16x16x32_bf16 a[96:99], a[44:47], a[160:163], a[96:99]
  v_mfma_f32_16x16x32_bf16 a[112:115], v[128:131], a[160:163], a[112:115]
  ds_read_b128 v[124:127], v203 offset:16
  v_mfma_f32_16x16x32_bf16 a[128:131], v[132:135], a[160:163], a[128:131]
  buffer_load_dwordx4 a[160:163], v2, s[40:43], s64 offen offset:1024 sc1
  v_mfma_f32_16x16x32_bf16 a[68:71], a[36:39], a[164:167], a[68:71]
  ds_read_b128 v[192:195], v204 offset:0
  v_mfma_f32_16x16x32_bf16 a[84:87], a[40:43], a[164:167], a[84:87]
  ds_read_b128 v[196:199], v204 offset:16
  v_mfma_f32_16x16x32_bf16 a[100:103], a[44:47], a[164:167], a[100:103]
  v_mfma_f32_16x16x32_bf16 a[116:119], v[128:131], a[164:167], a[116:119]
  ds_read_b128 v[208:211], v205 offset:0
  v_mfma_f32_16x16x32_bf16 a[132:135], v[132:135], a[164:167], a[132:135]
  s_waitcnt vmcnt(16)
  buffer_load_dwordx4 a[164:167], v2, s[40:43], s65 offen offset:1024 sc1
  v_mfma_f32_16x16x32_bf16 a[72:75], a[36:39], a[168:171], a[72:75]
  ds_read_b128 v[212:215], v205 offset:16
  v_mfma_f32_16x16x32_bf16 a[88:91], a[40:43], a[168:171], a[88:91]
  v_mfma_f32_16x16x32_bf16 a[104:107], a[44:47], a[168:171], a[104:107]
  v_mfma_f32_16x16x32_bf16 a[120:123], v[128:131], a[168:171], a[120:123]
  v_mfma_f32_16x16x32_bf16 a[136:139], v[132:135], a[168:171], a[136:139]
  buffer_load_dwordx4 a[168:171], v2, s[40:43], s66 offen offset:1024 sc1
  v_mfma_f32_16x16x32_bf16 a[76:79], a[36:39], a[172:175], a[76:79]
  v_mfma_f32_16x16x32_bf16 a[92:95], a[40:43], a[172:175], a[92:95]
  v_mfma_f32_16x16x32_bf16 a[108:111], a[44:47], a[172:175], a[108:111]
  v_mfma_f32_16x16x32_bf16 a[124:127], v[128:131], a[172:175], a[124:127]
  v_mfma_f32_16x16x32_bf16 a[140:143], v[132:135], a[172:175], a[140:143]
  s_waitcnt vmcnt(16) lgkmcnt(0)
  buffer_load_dwordx4 a[172:175], v2, s[40:43], s67 offen offset:1024 sc1
  v_mfma_f32_16x16x32_bf16 a[64:67], v[136:139], a[176:179], a[64:67]
  v_mfma_f32_16x16x32_bf16 a[80:83], v[140:143], a[176:179], a[80:83]
  v_lshlrev_b32 v18, 16, v172
  v_and_b32 v19, 0xffff0000, v172
  v_mfma_f32_16x16x32_bf16 a[96:99], v[144:147], a[176:179], a[96:99]
  v_add_f32 v120, v120, v18
  v_add_f32 v121, v121, v19
  v_mfma_f32_16x16x32_bf16 a[112:115], v[148:151], a[176:179], a[112:115]
  v_cvt_pk_bf16_f32 v18, v120, v121
  v_lshlrev_b32 v96, 16, v160
  v_mfma_f32_16x16x32_bf16 a[128:131], v[152:155], a[176:179], a[128:131]
  buffer_load_dwordx4 a[176:179], v2, s[40:43], s64 offen offset:2048 sc1
  v_and_b32 v97, 0xffff0000, v160
  v_lshlrev_b32 v120, 16, v18
  v_mfma_f32_16x16x32_bf16 a[68:71], v[136:139], a[180:183], a[68:71]
  v_and_b32 v121, 0xffff0000, v18
  v_lshlrev_b32 v18, 16, v173
  v_mfma_f32_16x16x32_bf16 a[84:87], v[140:143], a[180:183], a[84:87]
  v_and_b32 v19, 0xffff0000, v173
  v_add_f32 v122, v122, v18
  v_mfma_f32_16x16x32_bf16 a[100:103], v[144:147], a[180:183], a[100:103]
  v_add_f32 v123, v123, v19
  v_cvt_pk_bf16_f32 v18, v122, v123
  v_mfma_f32_16x16x32_bf16 a[116:119], v[148:151], a[180:183], a[116:119]
  v_lshlrev_b32 v98, 16, v161
  v_and_b32 v99, 0xffff0000, v161
  v_mfma_f32_16x16x32_bf16 a[132:135], v[152:155], a[180:183], a[132:135]
  s_waitcnt vmcnt(14)
  buffer_load_dwordx4 a[180:183], v2, s[40:43], s65 offen offset:2048 sc1
  v_lshlrev_b32 v122, 16, v18
  v_and_b32 v123, 0xffff0000, v18
  v_mfma_f32_16x16x32_bf16 a[72:75], v[136:139], a[184:187], a[72:75]
  v_lshlrev_b32 v18, 16, v174
  v_and_b32 v19, 0xffff0000, v174
  v_mfma_f32_16x16x32_bf16 a[88:91], v[140:143], a[184:187], a[88:91]
  v_add_f32 v124, v124, v18
  v_add_f32 v125, v125, v19
  v_mfma_f32_16x16x32_bf16 a[104:107], v[144:147], a[184:187], a[104:107]
  v_cvt_pk_bf16_f32 v18, v124, v125
  v_lshlrev_b32 v100, 16, v162
  v_mfma_f32_16x16x32_bf16 a[120:123], v[148:151], a[184:187], a[120:123]
  v_and_b32 v101, 0xffff0000, v162
  v_lshlrev_b32 v124, 16, v18
  v_mfma_f32_16x16x32_bf16 a[136:139], v[152:155], a[184:187], a[136:139]
  buffer_load_dwordx4 a[184:187], v2, s[40:43], s66 offen offset:2048 sc1
  v_and_b32 v125, 0xffff0000, v18
  v_lshlrev_b32 v18, 16, v175
  v_mfma_f32_16x16x32_bf16 a[76:79], v[136:139], a[188:191], a[76:79]
  v_and_b32 v19, 0xffff0000, v175
  v_add_f32 v126, v126, v18
  v_mfma_f32_16x16x32_bf16 a[92:95], v[140:143], a[188:191], a[92:95]
  v_add_f32 v127, v127, v19
  v_cvt_pk_bf16_f32 v18, v126, v127
  v_mfma_f32_16x16x32_bf16 a[108:111], v[144:147], a[188:191], a[108:111]
  v_lshlrev_b32 v102, 16, v163
  v_and_b32 v103, 0xffff0000, v163
  v_mfma_f32_16x16x32_bf16 a[124:127], v[148:151], a[188:191], a[124:127]
  v_lshlrev_b32 v126, 16, v18
  v_and_b32 v127, 0xffff0000, v18
  v_mfma_f32_16x16x32_bf16 a[140:143], v[152:155], a[188:191], a[140:143]
  s_waitcnt vmcnt(14)
  buffer_load_dwordx4 a[188:191], v2, s[40:43], s67 offen offset:2048 sc1
  v_mfma_f32_16x16x32_bf16 a[64:67], v[156:159], v[216:219], a[64:67]
  v_mfma_f32_16x16x32_bf16 a[80:83], a[48:51], v[216:219], a[80:83]
  v_lshlrev_b32 v18, 16, v232
  v_and_b32 v19, 0xffff0000, v232
  v_mfma_f32_16x16x32_bf16 a[96:99], a[52:55], v[216:219], a[96:99]
  v_add_f32 v192, v192, v18
  v_add_f32 v193, v193, v19
  v_mfma_f32_16x16x32_bf16 a[112:115], a[56:59], v[216:219], a[112:115]
  v_cvt_pk_bf16_f32 v18, v192, v193
  v_lshlrev_b32 v104, 16, v164
  v_mfma_f32_16x16x32_bf16 a[128:131], a[60:63], v[216:219], a[128:131]
  buffer_load_dwordx4 v[216:219], v2, s[40:43], s64 offen offset:3072 sc1
  v_and_b32 v105, 0xffff0000, v164
  v_lshlrev_b32 v192, 16, v18
  v_mfma_f32_16x16x32_bf16 a[68:71], v[156:159], v[220:223], a[68:71]
  v_and_b32 v193, 0xffff0000, v18
  v_lshlrev_b32 v18, 16, v233
  v_mfma_f32_16x16x32_bf16 a[84:87], a[48:51], v[220:223], a[84:87]
  v_and_b32 v19, 0xffff0000, v233
  v_add_f32 v194, v194, v18
  v_mfma_f32_16x16x32_bf16 a[100:103], a[52:55], v[220:223], a[100:103]
  v_add_f32 v195, v195, v19
  v_cvt_pk_bf16_f32 v18, v194, v195
  v_mfma_f32_16x16x32_bf16 a[116:119], a[56:59], v[220:223], a[116:119]
  v_lshlrev_b32 v106, 16, v165
  v_and_b32 v107, 0xffff0000, v165
  v_mfma_f32_16x16x32_bf16 a[132:135], a[60:63], v[220:223], a[132:135]
  s_waitcnt vmcnt(14)
  buffer_load_dwordx4 v[220:223], v2, s[40:43], s65 offen offset:3072 sc1
  v_lshlrev_b32 v194, 16, v18
  v_and_b32 v195, 0xffff0000, v18
  v_mfma_f32_16x16x32_bf16 a[72:75], v[156:159], v[224:227], a[72:75]
  v_lshlrev_b32 v18, 16, v234
  v_and_b32 v19, 0xffff0000, v234
  v_mfma_f32_16x16x32_bf16 a[88:91], a[48:51], v[224:227], a[88:91]
  v_add_f32 v196, v196, v18
  v_add_f32 v197, v197, v19
  v_mfma_f32_16x16x32_bf16 a[104:107], a[52:55], v[224:227], a[104:107]
  v_cvt_pk_bf16_f32 v18, v196, v197
  v_lshlrev_b32 v108, 16, v166
  v_mfma_f32_16x16x32_bf16 a[120:123], a[56:59], v[224:227], a[120:123]
  v_and_b32 v109, 0xffff0000, v166
  v_lshlrev_b32 v196, 16, v18
  v_mfma_f32_16x16x32_bf16 a[136:139], a[60:63], v[224:227], a[136:139]
  buffer_load_dwordx4 v[224:227], v2, s[40:43], s66 offen offset:3072 sc1
  v_and_b32 v197, 0xffff0000, v18
  v_lshlrev_b32 v18, 16, v235
  v_mfma_f32_16x16x32_bf16 a[76:79], v[156:159], v[228:231], a[76:79]
  v_and_b32 v19, 0xffff0000, v235
  v_add_f32 v198, v198, v18
  v_mfma_f32_16x16x32_bf16 a[92:95], a[48:51], v[228:231], a[92:95]
  v_add_f32 v199, v199, v19
  v_cvt_pk_bf16_f32 v18, v198, v199
  v_mfma_f32_16x16x32_bf16 a[108:111], a[52:55], v[228:231], a[108:111]
  v_lshlrev_b32 v110, 16, v167
  v_and_b32 v111, 0xffff0000, v167
  v_mfma_f32_16x16x32_bf16 a[124:127], a[56:59], v[228:231], a[124:127]
  v_lshlrev_b32 v198, 16, v18
  v_and_b32 v199, 0xffff0000, v18
  v_mfma_f32_16x16x32_bf16 a[140:143], a[60:63], v[228:231], a[140:143]
  s_waitcnt vmcnt(14)
  buffer_load_dwordx4 v[228:231], v2, s[40:43], s67 offen offset:3072 sc1
  v_mfma_f32_16x16x32_bf16 a[64:67], a[192:195], a[144:147], a[64:67]
  buffer_load_dword v13, v8, s[40:43], 0 offen sc1
  v_mfma_f32_16x16x32_bf16 a[80:83], a[196:199], a[144:147], a[80:83]
  v_lshlrev_b32 v18, 16, v236
  v_and_b32 v19, 0xffff0000, v236
  v_mfma_f32_16x16x32_bf16 a[96:99], a[200:203], a[144:147], a[96:99]
  v_add_f32 v208, v208, v18
  v_add_f32 v209, v209, v19
  v_mfma_f32_16x16x32_bf16 a[112:115], a[204:207], a[144:147], a[112:115]
  v_cvt_pk_bf16_f32 v18, v208, v209
  v_lshlrev_b32 v112, 16, v168
  v_mfma_f32_16x16x32_bf16 a[128:131], v[176:179], a[144:147], a[128:131]
  v_and_b32 v113, 0xffff0000, v168
  v_lshlrev_b32 v208, 16, v18
  v_mfma_f32_16x16x32_bf16 a[68:71], a[192:195], a[148:151], a[68:71]
  v_and_b32 v209, 0xffff0000, v18
  v_lshlrev_b32 v18, 16, v237
  v_mfma_f32_16x16x32_bf16 a[84:87], a[196:199], a[148:151], a[84:87]
  v_and_b32 v19, 0xffff0000, v237
  v_add_f32 v210, v210, v18
  v_mfma_f32_16x16x32_bf16 a[100:103], a[200:203], a[148:151], a[100:103]
  v_add_f32 v211, v211, v19
  v_cvt_pk_bf16_f32 v18, v210, v211
  v_mfma_f32_16x16x32_bf16 a[116:119], a[204:207], a[148:151], a[116:119]
  v_lshlrev_b32 v114, 16, v169
  v_and_b32 v115, 0xffff0000, v169
  v_mfma_f32_16x16x32_bf16 a[132:135], v[176:179], a[148:151], a[132:135]
  s_waitcnt vmcnt(14)
  v_lshlrev_b32 v210, 16, v18
  v_and_b32 v211, 0xffff0000, v18
  v_mfma_f32_16x16x32_bf16 a[72:75], a[192:195], a[152:155], a[72:75]
  v_lshlrev_b32 v18, 16, v238
  v_and_b32 v19, 0xffff0000, v238
  v_mfma_f32_16x16x32_bf16 a[88:91], a[196:199], a[152:155], a[88:91]
  v_add_f32 v212, v212, v18
  v_add_f32 v213, v213, v19
  v_mfma_f32_16x16x32_bf16 a[104:107], a[200:203], a[152:155], a[104:107]
  v_cvt_pk_bf16_f32 v18, v212, v213
  v_lshlrev_b32 v116, 16, v170
  v_mfma_f32_16x16x32_bf16 a[120:123], a[204:207], a[152:155], a[120:123]
  v_and_b32 v117, 0xffff0000, v170
  v_lshlrev_b32 v212, 16, v18
  v_mfma_f32_16x16x32_bf16 a[136:139], v[176:179], a[152:155], a[136:139]
  v_and_b32 v213, 0xffff0000, v18
  v_lshlrev_b32 v18, 16, v239
  v_mfma_f32_16x16x32_bf16 a[76:79], a[192:195], a[156:159], a[76:79]
  v_and_b32 v19, 0xffff0000, v239
  v_add_f32 v214, v214, v18
  v_mfma_f32_16x16x32_bf16 a[92:95], a[196:199], a[156:159], a[92:95]
  v_add_f32 v215, v215, v19
  v_cvt_pk_bf16_f32 v18, v214, v215
  v_mfma_f32_16x16x32_bf16 a[108:111], a[200:203], a[156:159], a[108:111]
  v_lshlrev_b32 v118, 16, v171
  v_and_b32 v119, 0xffff0000, v171
  v_mfma_f32_16x16x32_bf16 a[124:127], a[204:207], a[156:159], a[124:127]
  v_lshlrev_b32 v214, 16, v18
  v_and_b32 v215, 0xffff0000, v18
  v_mfma_f32_16x16x32_bf16 a[140:143], v[176:179], a[156:159], a[140:143]
  s_waitcnt vmcnt(11)
  v_mfma_f32_16x16x32_bf16 a[64:67], v[180:183], a[160:163], a[64:67]
  v_mfma_f32_16x16x32_bf16 a[80:83], v[184:187], a[160:163], a[80:83]
  v_mfma_f32_16x16x32_bf16 a[96:99], v[188:191], a[160:163], a[96:99]
  v_mfma_f32_16x16x32_bf16 a[112:115], a[208:211], a[160:163], a[112:115]
  v_mfma_f32_16x16x32_bf16 a[128:131], a[212:215], a[160:163], a[128:131]
  v_mfma_f32_16x16x32_bf16 a[68:71], v[180:183], a[164:167], a[68:71]
  v_mfma_f32_16x16x32_bf16 a[84:87], v[184:187], a[164:167], a[84:87]
  v_mfma_f32_16x16x32_bf16 a[100:103], v[188:191], a[164:167], a[100:103]
  v_mfma_f32_16x16x32_bf16 a[116:119], a[208:211], a[164:167], a[116:119]
  v_mfma_f32_16x16x32_bf16 a[132:135], a[212:215], a[164:167], a[132:135]
  s_waitcnt vmcnt(9)
  v_mfma_f32_16x16x32_bf16 a[72:75], v[180:183], a[168:171], a[72:75]
  v_mfma_f32_16x16x32_bf16 a[88:91], v[184:187], a[168:171], a[88:91]
  v_mfma_f32_16x16x32_bf16 a[104:107], v[188:191], a[168:171], a[104:107]
  v_mfma_f32_16x16x32_bf16 a[120:123], a[208:211], a[168:171], a[120:123]
  v_mfma_f32_16x16x32_bf16 a[136:139], a[212:215], a[168:171], a[136:139]
  v_mfma_f32_16x16x32_bf16 a[76:79], v[180:183], a[172:175], a[76:79]
  v_mfma_f32_16x16x32_bf16 a[92:95], v[184:187], a[172:175], a[92:95]
  v_mfma_f32_16x16x32_bf16 a[108:111], v[188:191], a[172:175], a[108:111]
  v_mfma_f32_16x16x32_bf16 a[124:127], a[208:211], a[172:175], a[124:127]
  v_mfma_f32_16x16x32_bf16 a[140:143], a[212:215], a[172:175], a[140:143]
  s_waitcnt vmcnt(0)
  v_mfma_f32_16x16x32_bf16 a[64:67], a[216:219], a[176:179], a[64:67]
  v_cmp_eq_u32 vcc, 0, v13
  v_mfma_f32_16x16x32_bf16 a[80:83], a[220:223], a[176:179], a[80:83]
  v_mfma_f32_16x16x32_bf16 a[96:99], a[224:227], a[176:179], a[96:99]
  s_cbranch_vccnz fa_px_spin
fa_px_ok:
  v_mfma_f32_16x16x32_bf16 a[112:115], a[228:231], a[176:179], a[112:115]
  s_add_u32 s14, s29, 0
  buffer_load_dwordx4 v[240:243], v9, s[40:43], s14 offen sc1
  v_mfma_f32_16x16x32_bf16 a[128:131], a[232:235], a[176:179], a[128:131]
  v_mfma_f32_16x16x32_bf16 a[68:71], a[216:219], a[180:183], a[68:71]
  s_add_u32 s14, s29, 4096
  buffer_load_dwordx4 v[244:247], v9, s[40:43], s14 offen sc1
  v_mfma_f32_16x16x32_bf16 a[84:87], a[220:223], a[180:183], a[84:87]
  v_mfma_f32_16x16x32_bf16 a[100:103], a[224:227], a[180:183], a[100:103]
  s_add_u32 s14, s29, 8192
  buffer_load_dwordx4 v[176:179], v9, s[40:43], s14 offen sc1
  v_mfma_f32_16x16x32_bf16 a[116:119], a[228:231], a[180:183], a[116:119]
  v_mfma_f32_16x16x32_bf16 a[132:135], a[232:235], a[180:183], a[132:135]
  s_waitcnt vmcnt(8)
  s_add_u32 s14, s29, 12288
  buffer_load_dwordx4 v[180:183], v9, s[40:43], s14 offen sc1
  v_mfma_f32_16x16x32_bf16 a[72:75], a[216:219], a[184:187], a[72:75]
  v_mfma_f32_16x16x32_bf16 a[88:91], a[220:223], a[184:187], a[88:91]
  s_add_u32 s14, s29, 16384
  buffer_load_dwordx4 v[184:187], v6, s[40:43], s14 offen sc1
  v_mfma_f32_16x16x32_bf16 a[104:107], a[224:227], a[184:187], a[104:107]
  v_mfma_f32_16x16x32_bf16 a[120:123], a[228:231], a[184:187], a[120:123]
  s_add_u32 s14, s29, 20480
  buffer_load_dwordx4 v[188:191], v6, s[40:43], s14 offen sc1
  v_mfma_f32_16x16x32_bf16 a[136:139], a[232:235], a[184:187], a[136:139]
  v_mfma_f32_16x16x32_bf16 a[76:79], a[216:219], a[188:191], a[76:79]
  v_mfma_f32_16x16x32_bf16 a[92:95], a[220:223], a[188:191], a[92:95]
  v_mfma_f32_16x16x32_bf16 a[108:111], a[224:227], a[188:191], a[108:111]
  v_mfma_f32_16x16x32_bf16 a[124:127], a[228:231], a[188:191], a[124:127]
  v_mfma_f32_16x16x32_bf16 a[140:143], a[232:235], a[188:191], a[140:143]
  s_waitcnt vmcnt(9)
  v_mfma_f32_16x16x32_bf16 a[64:67], a[236:239], v[216:219], a[64:67]
  v_mfma_f32_16x16x32_bf16 a[80:83], a[240:243], v[216:219], a[80:83]
  v_mfma_f32_16x16x32_bf16 a[96:99], a[244:247], v[216:219], a[96:99]
  v_mfma_f32_16x16x32_bf16 a[112:115], a[248:251], v[216:219], a[112:115]
  v_mfma_f32_16x16x32_bf16 a[128:131], a[252:255], v[216:219], a[128:131]
  v_mfma_f32_16x16x32_bf16 a[68:71], a[236:239], v[220:223], a[68:71]
  v_mfma_f32_16x16x32_bf16 a[84:87], a[240:243], v[220:223], a[84:87]
  v_mfma_f32_16x16x32_bf16 a[100:103], a[244:247], v[220:223], a[100:103]
  v_mfma_f32_16x16x32_bf16 a[116:119], a[248:251], v[220:223], a[116:119]
  v_mfma_f32_16x16x32_bf16 a[132:135], a[252:255], v[220:223], a[132:135]
  s_waitcnt vmcnt(7)
  ds_write_b128 v16, a[64:67] offset:0
  v_mfma_f32_16x16x32_bf16 a[72:75], a[236:239], v[224:227], a[72:75]
  ds_write_b128 v16, a[80:83] offset:64
  v_mfma_f32_16x16x32_bf16 a[88:91], a[240:243], v[224:227], a[88:91]
  ds_write_b128 v16, a[96:99] offset:128
  v_mfma_f32_16x16x32_bf16 a[104:107], a[244:247], v[224:227], a[104:107]
  ds_write_b128 v16, a[112:115] offset:192
  v_mfma_f32_16x16x32_bf16 a[120:123], a[248:251], v[224:227], a[120:123]
  ds_write_b128 v16, a[128:131] offset:256
  v_mfma_f32_16x16x32_bf16 a[136:139], a[252:255], v[224:227], a[136:139]
  ds_write_b128 v16, a[68:71] offset:5376
  v_mfma_f32_16x16x32_bf16 a[76:79], a[236:239], v[228:231], a[76:79]
  ds_write_b128 v16, a[84:87] offset:5440
  v_mfma_f32_16x16x32_bf16 a[92:95], a[240:243], v[228:231], a[92:95]
  ds_write_b128 v16, a[100:103] offset:5504
  v_mfma_f32_16x16x32_bf16 a[108:111], a[244:247], v[228:231], a[108:111]
  ds_write_b128 v16, a[116:119] offset:5568
  v_mfma_f32_16x16x32_bf16 a[124:127], a[248:251], v[228:231], a[124:127]
  ds_write_b128 v16, a[132:135] offset:5632
  v_mfma_f32_16x16x32_bf16 a[140:143], a[252:255], v[228:231], a[140:143]
  ds_write_b128 v16, a[72:75] offset:10752
  ds_write_b128 v16, a[88:91] offset:10816
  ds_write_b128 v16, a[104:107] offset:10880
  ds_write_b128 v16, a[120:123] offset:10944
  ds_write_b128 v16, a[136:139] offset:11008
  ds_write_b128 v16, a[76:79] offset:16128
  ds_write_b128 v16, a[92:95] offset:16192
  ds_write_b128 v16, a[108:111] offset:16256
  ds_write_b128 v16, a[124:127] offset:16320
  ds_write_b128 v16, a[140:143] offset:16384
  s_waitcnt vmcnt(0) lgkmcnt(0)
  s_barrier
  ds_read_b128 v[32:35], v251 offset:0
  ds_read_b128 v[36:39], v251 offset:16
  ds_read_b128 v[40:43], v251 offset:21504
  ds_read_b128 v[44:47], v251 offset:21520
  ds_read_b128 v[48:51], v251 offset:43008
  ds_read_b128 v[52:55], v251 offset:43024
  ds_read_b128 v[56:59], v251 offset:64512
  ds_read_b128 v[60:63], v251 offset:64528
  ds_read_b128 v[64:67], v252 offset:0
  ds_read_b128 v[68:71], v252 offset:16
  ds_read_b128 v[72:75], v252 offset:21504
  ds_read_b128 v[76:79], v252 offset:21520
  ds_read_b128 v[80:83], v252 offset:43008
  ds_read_b128 v[84:87], v252 offset:43024
  ds_read_b128 v[88:91], v252 offset:64512
  ds_read_b128 v[92:95], v252 offset:64528
  ds_read_b128 v[128:131], v253 offset:0
  ds_read_b128 v[132:135], v253 offset:16
  ds_read_b128 v[136:139], v253 offset:21504
  ds_read_b128 v[140:143], v253 offset:21520
  ds_read_b128 v[144:147], v253 offset:43008
  ds_read_b128 v[148:151], v253 offset:43024
  ds_read_b128 v[152:155], v253 offset:64512
  ds_read_b128 v[156:159], v253 offset:64528
  s_waitcnt lgkmcnt(15)
  v_pk_add_f32 v[32:33], v[32:33], v[40:41]
  v_pk_add_f32 v[48:49], v[48:49], v[56:57]
  v_pk_add_f32 v[34:35], v[34:35], v[42:43]
  v_pk_add_f32 v[50:51], v[50:51], v[58:59]
  v_pk_add_f32 v[36:37], v[36:37], v[44:45]
  v_pk_add_f32 v[52:53], v[52:53], v[60:61]
  v_pk_add_f32 v[38:39], v[38:39], v[46:47]
  v_pk_add_f32 v[54:55], v[54:55], v[62:63]
  v_pk_add_f32 v[32:33], v[32:33], v[48:49]
  v_pk_add_f32 v[34:35], v[34:35], v[50:51]
  v_pk_add_f32 v[36:37], v[36:37], v[52:53]
  v_pk_add_f32 v[38:39], v[38:39], v[54:55]
  v_pk_add_f32 v[32:33], v[32:33], v[240:241]
  v_pk_add_f32 v[34:35], v[34:35], v[242:243]
  v_pk_add_f32 v[36:37], v[36:37], v[244:245]
  v_pk_add_f32 v[38:39], v[38:39], v[246:247]
  v_cvt_pk_bf16_f32 v40, v32, v33
  v_cvt_pk_bf16_f32 v41, v34, v35
  v_cvt_pk_bf16_f32 v42, v36, v37
  v_cvt_pk_bf16_f32 v43, v38, v39
  v_lshlrev_b32 v32, 16, v40
  v_and_b32 v33, 0xffff0000, v40
  v_lshlrev_b32 v34, 16, v41
  v_and_b32 v35, 0xffff0000, v41
  v_lshlrev_b32 v36, 16, v42
  v_and_b32 v37, 0xffff0000, v42
  v_lshlrev_b32 v38, 16, v43
  v_and_b32 v39, 0xffff0000, v43
  v_pk_add_f32 v[32:33], v[32:33], v[96:97]
  v_pk_add_f32 v[34:35], v[34:35], v[98:99]
  v_pk_add_f32 v[36:37], v[36:37], v[100:101]
  v_pk_add_f32 v[38:39], v[38:39], v[102:103]
  v_cvt_pk_bf16_f32 v40, v32, v33
  v_cvt_pk_bf16_f32 v41, v34, v35
  v_cvt_pk_bf16_f32 v42, v36, v37
  v_cvt_pk_bf16_f32 v43, v38, v39
  v_lshlrev_b32 v32, 16, v40
  v_and_b32 v33, 0xffff0000, v40
  v_lshlrev_b32 v34, 16, v41
  v_and_b32 v35, 0xffff0000, v41
  v_lshlrev_b32 v36, 16, v42
  v_and_b32 v37, 0xffff0000, v42
  v_lshlrev_b32 v38, 16, v43
  v_and_b32 v39, 0xffff0000, v43
  v_pk_add_f32 v[32:33], v[32:33], v[120:121]
  v_pk_add_f32 v[34:35], v[34:35], v[122:123]
  v_pk_add_f32 v[36:37], v[36:37], v[124:125]
  v_pk_add_f32 v[38:39], v[38:39], v[126:127]
  v_cvt_pk_bf16_f32 v44, v32, v33
  v_cvt_pk_bf16_f32 v45, v34, v35
  v_cvt_pk_bf16_f32 v46, v36, v37
  v_cvt_pk_bf16_f32 v47, v38, v39
  buffer_store_dwordx4 v[44:47], v248, s[48:51], 0 offen
  s_waitcnt lgkmcnt(8)
  v_pk_add_f32 v[64:65], v[64:65], v[72:73]
  v_pk_add_f32 v[80:81], v[80:81], v[88:89]
  v_pk_add_f32 v[66:67], v[66:67], v[74:75]
  v_pk_add_f32 v[82:83], v[82:83], v[90:91]
  v_pk_add_f32 v[68:69], v[68:69], v[76:77]
  v_pk_add_f32 v[84:85], v[84:85], v[92:93]
  v_pk_add_f32 v[70:71], v[70:71], v[78:79]
  v_pk_add_f32 v[86:87], v[86:87], v[94:95]
  v_pk_add_f32 v[64:65], v[64:65], v[80:81]
  v_pk_add_f32 v[66:67], v[66:67], v[82:83]
  v_pk_add_f32 v[68:69], v[68:69], v[84:85]
  v_pk_add_f32 v[70:71], v[70:71], v[86:87]
  v_pk_add_f32 v[64:65], v[64:65], v[176:177]
  v_pk_add_f32 v[66:67], v[66:67], v[178:179]
  v_pk_add_f32 v[68:69], v[68:69], v[180:181]
  v_pk_add_f32 v[70:71], v[70:71], v[182:183]
  v_cvt_pk_bf16_f32 v72, v64, v65
  v_cvt_pk_bf16_f32 v73, v66, v67
  v_cvt_pk_bf16_f32 v74, v68, v69
  v_cvt_pk_bf16_f32 v75, v70, v71
  v_lshlrev_b32 v64, 16, v72
  v_and_b32 v65, 0xffff0000, v72
  v_lshlrev_b32 v66, 16, v73
  v_and_b32 v67, 0xffff0000, v73
  v_lshlrev_b32 v68, 16, v74
  v_and_b32 v69, 0xffff0000, v74
  v_lshlrev_b32 v70, 16, v75
  v_and_b32 v71, 0xffff0000, v75
  v_pk_add_f32 v[64:65], v[64:65], v[104:105]
  v_pk_add_f32 v[66:67], v[66:67], v[106:107]
  v_pk_add_f32 v[68:69], v[68:69], v[108:109]
  v_pk_add_f32 v[70:71], v[70:71], v[110:111]
  v_cvt_pk_bf16_f32 v72, v64, v65
  v_cvt_pk_bf16_f32 v73, v66, v67
  v_cvt_pk_bf16_f32 v74, v68, v69
  v_cvt_pk_bf16_f32 v75, v70, v71
  v_lshlrev_b32 v64, 16, v72
  v_and_b32 v65, 0xffff0000, v72
  v_lshlrev_b32 v66, 16, v73
  v_and_b32 v67, 0xffff0000, v73
  v_lshlrev_b32 v68, 16, v74
  v_and_b32 v69, 0xffff0000, v74
  v_lshlrev_b32 v70, 16, v75
  v_and_b32 v71, 0xffff0000, v75
  v_pk_add_f32 v[64:65], v[64:65], v[192:193]
  v_pk_add_f32 v[66:67], v[66:67], v[194:195]
  v_pk_add_f32 v[68:69], v[68:69], v[196:197]
  v_pk_add_f32 v[70:71], v[70:71], v[198:199]
  v_cvt_pk_bf16_f32 v76, v64, v65
  v_cvt_pk_bf16_f32 v77, v66, v67
  v_cvt_pk_bf16_f32 v78, v68, v69
  v_cvt_pk_bf16_f32 v79, v70, v71
  buffer_store_dwordx4 v[76:79], v249, s[48:51], 0 offen
  s_waitcnt lgkmcnt(0)
  v_pk_add_f32 v[128:129], v[128:129], v[136:137]
  v_pk_add_f32 v[144:145], v[144:145], v[152:153]
  v_pk_add_f32 v[130:131], v[130:131], v[138:139]
  v_pk_add_f32 v[146:147], v[146:147], v[154:155]
  v_pk_add_f32 v[132:133], v[132:133], v[140:141]
  v_pk_add_f32 v[148:149], v[148:149], v[156:157]
  v_pk_add_f32 v[134:135], v[134:135], v[142:143]
  v_pk_add_f32 v[150:151], v[150:151], v[158:159]
  v_pk_add_f32 v[128:129], v[128:129], v[144:145]
  v_pk_add_f32 v[130:131], v[130:131], v[146:147]
  v_pk_add_f32 v[132:133], v[132:133], v[148:149]
  v_pk_add_f32 v[134:135], v[134:135], v[150:151]
  v_pk_add_f32 v[128:129], v[128:129], v[184:185]
  v_pk_add_f32 v[130:131], v[130:131], v[186:187]
  v_pk_add_f32 v[132:133], v[132:133], v[188:189]
  v_pk_add_f32 v[134:135], v[134:135], v[190:191]
  v_cvt_pk_bf16_f32 v136, v128, v129
  v_cvt_pk_bf16_f32 v137, v130, v131
  v_cvt_pk_bf16_f32 v138, v132, v133
  v_cvt_pk_bf16_f32 v139, v134, v135
  v_lshlrev_b32 v128, 16, v136
  v_and_b32 v129, 0xffff0000, v136
  v_lshlrev_b32 v130, 16, v137
  v_and_b32 v131, 0xffff0000, v137
  v_lshlrev_b32 v132, 16, v138
  v_and_b32 v133, 0xffff0000, v138
  v_lshlrev_b32 v134, 16, v139
  v_and_b32 v135, 0xffff0000, v139
  v_pk_add_f32 v[128:129], v[128:129], v[112:113]
  v_pk_add_f32 v[130:131], v[130:131], v[114:115]
  v_pk_add_f32 v[132:133], v[132:133], v[116:117]
  v_pk_add_f32 v[134:135], v[134:135], v[118:119]
  v_cvt_pk_bf16_f32 v136, v128, v129
  v_cvt_pk_bf16_f32 v137, v130, v131
  v_cvt_pk_bf16_f32 v138, v132, v133
  v_cvt_pk_bf16_f32 v139, v134, v135
  v_lshlrev_b32 v128, 16, v136
  v_and_b32 v129, 0xffff0000, v136
  v_lshlrev_b32 v130, 16, v137
  v_and_b32 v131, 0xffff0000, v137
  v_lshlrev_b32 v132, 16, v138
  v_and_b32 v133, 0xffff0000, v138
  v_lshlrev_b32 v134, 16, v139
  v_and_b32 v135, 0xffff0000, v139
  v_pk_add_f32 v[128:129], v[128:129], v[208:209]
  v_pk_add_f32 v[130:131], v[130:131], v[210:211]
  v_pk_add_f32 v[132:133], v[132:133], v[212:213]
  v_pk_add_f32 v[134:135], v[134:135], v[214:215]
  v_cvt_pk_bf16_f32 v140, v128, v129
  v_cvt_pk_bf16_f32 v141, v130, v131
  v_cvt_pk_bf16_f32 v142, v132, v133
  v_cvt_pk_bf16_f32 v143, v134, v135
  buffer_store_dwordx4 v[140:143], v250, s[48:51], 0 offen
fa_end:
  s_endpgm
fa_hk0:
  s_getpc_b64 s[10:11]
fa_hp0:
  s_add_u32 s8, s8, 4
  s_addc_u32 s9, s9, 0
  s_sub_u32 s10, s10, fa_hp0-fa_hb0
  s_subb_u32 s11, s11, 0
  s_setpc_b64 s[8:9]
fa_hk1:
  s_getpc_b64 s[10:11]
fa_hp1:
  s_add_u32 s8, s8, 4
  s_addc_u32 s9, s9, 0
  s_sub_u32 s10, s10, fa_hp1-fa_hb1
  s_subb_u32 s11, s11, 0
  s_setpc_b64 s[8:9]
fa_hk2:
  s_getpc_b64 s[10:11]
fa_hp2:
  s_add_u32 s8, s8, 4
  s_addc_u32 s9, s9, 0
  s_sub_u32 s10, s10, fa_hp2-fa_hb2
  s_subb_u32 s11, s11, 0
  s_setpc_b64 s[8:9]
fa_hk3:
  s_getpc_b64 s[10:11]
fa_hp3:
  s_add_u32 s8, s8, 4
  s_addc_u32 s9, s9, 0
  s_sub_u32 s10, s10, fa_hp3-fa_hb3
  s_subb_u32 s11, s11, 0
  s_setpc_b64 s[8:9]
fa_ln_spin:
  s_mov_b32 s83, 200000
fa_ln_spin2:
  buffer_load_dword v15, v229, s[56:59], 0 offen sc1
  s_waitcnt vmcnt(0)
  v_cmp_ne_u32 vcc, 0x01010101, v15
  s_cbranch_vccz fa_ln_ok
  s_sleep 3
  s_sub_u32 s83, s83, 1
  s_cmp_lg_u32 s83, 0
  s_cbranch_scc1 fa_ln_spin2
  s_branch fa_ln_ok
fa_co1:
  buffer_load_dword v232, v234, s[32:35], s29 offen
  buffer_store_dword v229, v225, s[40:43], 0 offen sc1
  ds_read_b128 v[160:163], v221 offset:0
  ds_read_b128 v[164:167], v221 offset:4096
  ds_read_b128 v[168:171], v221 offset:8192
  buffer_store_dword v218, v222, s[40:43], 0 offen sc1
  s_waitcnt lgkmcnt(0)
  buffer_store_dwordx4 v[160:163], v223, s[40:43], s66 offen sc1
  buffer_store_dwordx4 v[164:167], v223, s[40:43], s67 offen sc1
  buffer_store_dwordx4 v[168:171], v224, s[40:43], s78 offen sc1
  s_getpc_b64 s[8:9]
  s_setpc_b64 s[10:11]
  v_mov_b32 v213, 1073741824
  v_mov_b32 v214, 1
  v_writelane_b32 v213, s77, 0
  v_lshlrev_b32 v229, 2, v1
  buffer_store_byte v214, v213, s[56:59], 0 offen sc1
  s_and_b32 s23, s21, 3
  s_cmp_eq_u32 s23, 3
  s_cbranch_scc1 fa_arr
  s_getpc_b64 s[8:9]
  s_setpc_b64 s[10:11]
fa_arr:
  s_mov_b32 s48, s60
  s_mov_b32 s49, s61
  s_mov_b32 s50, s75
  s_lshl_b32 s74, s22, 2
  s_add_u32 s74, s74, s20
  s_mul_i32 s74, s74, 40960
  s_mov_b32 s73, 1310720
  v_lshrrev_b32 v235, 1, v1
  v_min_u32 v235, 4, v235
  v_lshlrev_b32 v235, 13, v235
  v_and_b32 v213, 1, v1
  v_lshl_add_u32 v235, v213, 7, v235
  s_getpc_b64 s[8:9]
  s_setpc_b64 s[10:11]
  buffer_load_dword v15, v229, s[56:59], 0 offen sc1
  s_getpc_b64 s[8:9]
  s_setpc_b64 s[10:11]
  s_mov_b32 s36, s60
  s_mov_b32 s37, s61
  s_mov_b32 s38, s75
  s_lshr_b32 s27, s20, 1
  s_lshl_b32 s27, s27, 18
  s_mov_b32 s25, 524288
  s_mov_b32 s32, s18
  s_mov_b32 s33, s19
  s_mov_b32 s34, 2621440
  s_mov_b32 s26, 0
  s_movk_i32 s79, 1024
  s_lshl_b32 s23, s22, 2
  s_add_u32 s23, s23, s20
  s_mul_i32 s23, s23, 40960
  v_add_u32 v3, s23, v2
  s_sub_u32 s23, 15, s22
  s_lshl_b32 s23, s23, 2
  s_add_u32 s23, s23, s20
  s_mul_i32 s23, s23, 40960
  s_sub_u32 s23, s23, 2048
  v_add_u32 v5, s23, v2
  v_add_u32 v4, 19456, v3
  v_add_u32 v6, 19456, v5
  s_waitcnt vmcnt(8)
  v_cmp_ne_u32 vcc, 0x01010101, v15
  s_cbranch_vccnz fa_ln_spin
fa_ln_ok:
  s_setpc_b64 s[10:11]
fa_kv_spin:
  s_mov_b32 s83, 200000
fa_kv_spin2:
  buffer_load_dword v15, v8, s[40:43], 0 offen sc1
  s_waitcnt vmcnt(0)
  v_cmp_eq_u32 vcc, 0, v15
  s_cbranch_vccz fa_kv_ok
  s_sleep 3
  s_sub_u32 s83, s83, 1
  s_cmp_lg_u32 s83, 0
  s_cbranch_scc1 fa_kv_spin2
  s_branch fa_kv_ok
fa_top8:
  v_mov_b32 v21, 0
  v_mov_b32 v22, 0
  v_and_b32 v23, 7, v1
  s_mov_b32 s23, 0
fa_top:
  v_max3_u32 v20, v232, v233, v234
  v_max3_u32 v24, v235, v236, v237
  v_max3_u32 v20, v20, v238, v239
  v_max_u32 v20, v20, v24
  s_nop 1
  v_max_u32_dpp v20, v20, v20 quad_perm:[1,0,3,2] row_mask:0xf bank_mask:0xf
  s_nop 1
  v_max_u32_dpp v20, v20, v20 quad_perm:[2,3,0,1] row_mask:0xf bank_mask:0xf
  s_nop 1
  v_max_u32_dpp v20, v20, v20 row_half_mirror row_mask:0xf bank_mask:0xf
  s_nop 1
  v_max_u32_dpp v20, v20, v20 row_mirror row_mask:0xf bank_mask:0xf
  v_mov_b32 v24, v20
  s_nop 1
  v_permlane16_swap_b32 v20, v24
  v_max_u32 v20, v20, v24
  v_mov_b32 v24, v20
  s_nop 1
  v_permlane32_swap_b32 v20, v24
  v_max_u32 v20, v20, v24
  v_add_u32 v21, v21, v20
  v_cmp_eq_u32 vcc, s23, v23
  v_sub_u32 v232, v232, v20
  v_sub_u32 v233, v233, v20
  v_sub_u32 v234, v234, v20
  v_sub_u32 v235, v235, v20
  v_sub_u32 v236, v236, v20
  v_sub_u32 v237, v237, v20
  v_sub_u32 v238, v238, v20
  v_sub_u32 v239, v239, v20
  v_cndmask_b32 v22, v22, v21, vcc
  s_add_u32 s23, s23, 1
  s_cmp_lt_u32 s23, 8
  s_cbranch_scc1 fa_top
  s_lshl_b32 s23, s20, 5
  s_add_u32 s23, s23, 131072
  v_lshl_add_u32 v24, v23, 2, s23
  ds_write_b32 v24, v22
  s_waitcnt lgkmcnt(0)
  s_barrier
  s_cmp_lg_u32 s20, 0
  s_cbranch_scc1 fa_notop
  v_and_b32 v24, 31, v1
  v_lshlrev_b32 v24, 2, v24
  v_add_u32 v24, 131072, v24
  v_mov_b32 v20, 131072
  ds_read_b32 v22, v24
  ds_read_b128 v[96:99], v20 offset:0
  ds_read_b128 v[100:103], v20 offset:16
  ds_read_b128 v[104:107], v20 offset:32
  ds_read_b128 v[108:111], v20 offset:48
  ds_read_b128 v[112:115], v20 offset:64
  ds_read_b128 v[116:119], v20 offset:80
  ds_read_b128 v[120:123], v20 offset:96
  ds_read_b128 v[124:127], v20 offset:112
  v_mov_b32 v23, 0
  s_waitcnt lgkmcnt(0)
  v_cmp_gt_u32 s[4:5], v96, v22
  v_cmp_gt_u32 s[6:7], v97, v22
  v_cmp_gt_u32 s[76:77], v98, v22
  v_cmp_gt_u32 s[78:79], v99, v22
  v_addc_co_u32 v23, vcc, 0, v23, s[4:5]
  v_addc_co_u32 v23, vcc, 0, v23, s[6:7]
  v_addc_co_u32 v23, vcc, 0, v23, s[76:77]
  v_addc_co_u32 v23, vcc, 0, v23, s[78:79]
  v_cmp_gt_u32 s[4:5], v100, v22
  v_cmp_gt_u32 s[6:7], v101, v22
  v_cmp_gt_u32 s[76:77], v102, v22
  v_cmp_gt_u32 s[78:79], v103, v22
  v_addc_co_u32 v23, vcc, 0, v23, s[4:5]
  v_addc_co_u32 v23, vcc, 0, v23, s[6:7]
  v_addc_co_u32 v23, vcc, 0, v23, s[76:77]
  v_addc_co_u32 v23, vcc, 0, v23, s[78:79]
  v_cmp_gt_u32 s[4:5], v104, v22
  v_cmp_gt_u32 s[6:7], v105, v22
  v_cmp_gt_u32 s[76:77], v106, v22
  v_cmp_gt_u32 s[78:79], v107, v22
  v_addc_co_u32 v23, vcc, 0, v23, s[4:5]
  v_addc_co_u32 v23, vcc, 0, v23, s[6:7]
  v_addc_co_u32 v23, vcc, 0, v23, s[76:77]
  v_addc_co_u32 v23, vcc, 0, v23, s[78:79]
  v_cmp_gt_u32 s[4:5], v108, v22
  v_cmp_gt_u32 s[6:7], v109, v22
  v_cmp_gt_u32 s[76:77], v110, v22
  v_cmp_gt_u32 s[78:79], v111, v22
  v_addc_co_u32 v23, vcc, 0, v23, s[4:5]
  v_addc_co_u32 v23, vcc, 0, v23, s[6:7]
  v_addc_co_u32 v23, vcc, 0, v23, s[76:77]
  v_addc_co_u32 v23, vcc, 0, v23, s[78:79]
  v_cmp_gt_u32 s[4:5], v112, v22
  v_cmp_gt_u32 s[6:7], v113, v22
  v_cmp_gt_u32 s[76:77], v114, v22
  v_cmp_gt_u32 s[78:79], v115, v22
  v_addc_co_u32 v23, vcc, 0, v23, s[4:5]
  v_addc_co_u32 v23, vcc, 0, v23, s[6:7]
  v_addc_co_u32 v23, vcc, 0, v23, s[76:77]
  v_addc_co_u32 v23, vcc, 0, v23, s[78:79]
  v_cmp_gt_u32 s[4:5], v116, v22
  v_cmp_gt_u32 s[6:7], v117, v22
  v_cmp_gt_u32 s[76:77], v118, v22
  v_cmp_gt_u32 s[78:79], v119, v22
  v_addc_co_u32 v23, vcc, 0, v23, s[4:5]
  v_addc_co_u32 v23, vcc, 0, v23, s[6:7]
  v_addc_co_u32 v23, vcc, 0, v23, s[76:77]
  v_addc_co_u32 v23, vcc, 0, v23, s[78:79]
  v_cmp_gt_u32 s[4:5], v120, v22
  v_cmp_gt_u32 s[6:7], v121, v22
  v_cmp_gt_u32 s[76:77], v122, v22
  v_cmp_gt_u32 s[78:79], v123, v22
  v_addc_co_u32 v23, vcc, 0, v23, s[4:5]
  v_addc_co_u32 v23, vcc, 0, v23, s[6:7]
  v_addc_co_u32 v23, vcc, 0, v23, s[76:77]
  v_addc_co_u32 v23, vcc, 0, v23, s[78:79]
  v_cmp_gt_u32 s[4:5], v124, v22
  v_cmp_gt_u32 s[6:7], v125, v22
  v_cmp_gt_u32 s[76:77], v126, v22
  v_cmp_gt_u32 s[78:79], v127, v22
  v_addc_co_u32 v23, vcc, 0, v23, s[4:5]
  v_addc_co_u32 v23, vcc, 0, v23, s[6:7]
  v_addc_co_u32 v23, vcc, 0, v23, s[76:77]
  v_addc_co_u32 v23, vcc, 0, v23, s[78:79]
  v_and_b32 v25, 0xffff, v22
  v_sub_u32 v25, 0xffff, v25
  v_and_b32 v25, 2047, v25
  v_ashrrev_i32 v20, 31, v22
  v_not_b32 v20, v20
  v_or_b32 v20, 0x80000000, v20
  v_xor_b32 v26, v22, v20
  v_and_b32 v26, 0xffff0000, v26
  v_mul_f32 v26, 0xbfb8aa3b, v26
  v_exp_f32 v26, v26
  s_nop 0
  v_add_f32 v26, 1.0, v26
  v_rcp_f32 v26, v26
  s_nop 0
  v_cvt_pk_bf16_f32 v26, v26, v26
  v_and_b32 v26, 0xffff0000, v26
  v_and_b32 v20, 32, v1
  v_lshl_add_u32 v20, v23, 2, v20
  v_add_u32 v20, 2629632, v20
  v_mov_b32 v21, 1073741824
  v_cmp_gt_u32 vcc, 8, v23
  v_add_u32 v25, 1, v25
  v_or_b32 v26, 1, v26
  v_cndmask_b32 v20, v21, v20, vcc
  v_cmp_gt_u32 vcc, 32, v1
  s_nop 1
  v_cndmask_b32 v26, v26, v25, vcc
  buffer_store_dword v26, v20, s[40:43], 0 offen sc1
  s_branch fa_notop
fa_hk4:
  s_getpc_b64 s[38:39]
fa_hp4:
  s_add_u32 s36, s36, 4
  s_addc_u32 s37, s37, 0
  s_sub_u32 s38, s38, fa_hp4-fa_hb4
  s_subb_u32 s39, s39, 0
  s_setpc_b64 s[36:37]
fa_hk5:
  s_getpc_b64 s[38:39]
fa_hp5:
  s_add_u32 s36, s36, 4
  s_addc_u32 s37, s37, 0
  s_sub_u32 s38, s38, fa_hp5-fa_hb5
  s_subb_u32 s39, s39, 0
  s_setpc_b64 s[36:37]
fa_hk6:
  s_getpc_b64 s[38:39]
fa_hp6:
  s_add_u32 s36, s36, 4
  s_addc_u32 s37, s37, 0
  s_add_u32 s38, s38, fa_hb6-fa_hp6
  s_addc_u32 s39, s39, 0
  s_setpc_b64 s[36:37]
fa_DDF:
  v_mfma_f32_16x16x32_bf16 v[96:99], a[128:131], v[32:35], v[192:195]
  s_waitcnt vmcnt(4)
  v_exp_f32 v218, v146
  v_mfma_f32_16x16x32_bf16 v[104:107], a[128:131], v[36:39], v[196:199]
  s_barrier
  v_exp_f32 v219, v147
  v_mfma_f32_16x16x32_bf16 v[128:131], a[128:131], v[64:67], v[200:203]
  s_cmp_ge_u32 s26, s32
  ds_read_b128 a[160:163], v3 offset:16384
  v_exp_f32 v220, v148
  v_mfma_f32_16x16x32_bf16 v[136:139], a[128:131], v[68:71], v[204:207]
  s_cbranch_scc1 fa_hk6
fa_hb6:
  ds_read_b64_tr_b16 a[192:193], v9 offset:0
  v_add_f32 v226, v216, v217
  v_mfma_f32_16x16x32_bf16 v[100:103], a[132:135], v[32:35], v[192:195]
  ds_read_b128 a[164:167], v3 offset:17408
  ds_read_b64_tr_b16 a[194:195], v9 offset:128
  v_cvt_pk_bf16_f32 v184, v216, v217
  v_mfma_f32_16x16x32_bf16 v[108:111], a[132:135], v[36:39], v[196:199]
  s_mov_b32 m0, s24
  ds_read_b128 a[212:215], v10 offset:0
  ds_read_b64_tr_b16 a[196:197], v9 offset:1024
  v_add_f32 v226, v226, v218
  v_mfma_f32_16x16x32_bf16 v[132:135], a[132:135], v[64:67], v[200:203]
  buffer_load_dwordx4 v2, s[44:47], s26 offen offset:0 sc1 lds
  v_add_f32 v226, v226, v219
  v_mfma_f32_16x16x32_bf16 v[140:143], a[132:135], v[68:71], v[204:207]
  ds_read_b64_tr_b16 a[198:199], v9 offset:1152
  ds_read_b128 a[216:219], v10 offset:512
  v_cvt_pk_bf16_f32 v185, v218, v219
  v_mfma_f32_16x16x32_bf16 v[96:99], a[136:139], v[40:43], v[96:99]
  ds_read_b128 a[168:171], v3 offset:18432
  ds_read_b64_tr_b16 a[200:201], v9 offset:2048
  v_add_f32 v226, v226, v220
  v_exp_f32 v221, v149
  v_mfma_f32_16x16x32_bf16 v[104:107], a[136:139], v[44:47], v[104:107]
  ds_read_b64_tr_b16 a[202:203], v9 offset:2176
  ds_read_b128 a[220:223], v10 offset:1024
  v_add_f32 v226, v226, v221
  v_mfma_f32_16x16x32_bf16 v[128:131], a[136:139], v[72:75], v[128:131]
  ds_read_b64_tr_b16 a[204:205], v9 offset:3072
  ds_read_b64_tr_b16 a[206:207], v9 offset:3200
  v_cvt_pk_bf16_f32 v186, v220, v221
  v_mfma_f32_16x16x32_bf16 v[136:139], a[136:139], v[76:79], v[136:139]
  ds_read_b128 a[224:227], v10 offset:1536
  ds_read_b64_tr_b16 a[208:209], v9 offset:4096
  v_mfma_f32_16x16x32_bf16 v[100:103], a[140:143], v[40:43], v[100:103]
  ds_read_b128 a[172:175], v3 offset:19456
  v_mfma_f32_16x16x32_bf16 v[108:111], a[140:143], v[44:47], v[108:111]
  buffer_load_dwordx4 v2, s[44:47], s26 offen offset:1024 sc1 lds
  v_mfma_f32_16x16x32_bf16 v[132:135], a[140:143], v[72:75], v[132:135]
  ds_read_b64_tr_b16 a[210:211], v9 offset:4224
  ds_read_b128 a[228:231], v10 offset:2048
  v_mfma_f32_16x16x32_bf16 v[140:143], a[140:143], v[76:79], v[140:143]
  s_waitcnt lgkmcnt(4)
  v_exp_f32 v222, v150
  v_mfma_f32_16x16x32_bf16 v[96:99], a[144:147], v[48:51], v[96:99]
  ds_read_b128 a[176:179], v3 offset:20480
  v_add_f32 v226, v226, v222
  v_mfma_f32_16x16x32_bf16 v[104:107], a[144:147], v[52:55], v[104:107]
  v_exp_f32 v223, v151
  v_mfma_f32_16x16x32_bf16 v[128:131], a[144:147], v[80:83], v[128:131]
  v_exp_f32 v216, v152
  v_add_u32 v10, 2560, v10
  v_mfma_f32_16x16x32_bf16 v[136:139], a[144:147], v[84:87], v[136:139]
  buffer_load_dwordx4 v2, s[44:47], s26 offen offset:2048 sc1 lds
  v_add_f32 v226, v226, v223
  v_mfma_f32_16x16x32_bf16 v[100:103], a[148:151], v[48:51], v[100:103]
  ds_read_b128 a[180:183], v3 offset:21504
  v_cvt_pk_bf16_f32 v187, v222, v223
  v_and_b32 v232, s4, v232
  v_mfma_f32_16x16x32_bf16 v[108:111], a[148:151], v[52:55], v[108:111]
  v_exp_f32 v217, v153
  v_and_b32 v233, s4, v233
  v_mfma_f32_16x16x32_bf16 v[132:135], a[148:151], v[80:83], v[132:135]
  v_exp_f32 v218, v154
  v_and_b32 v234, s4, v234
  v_mfma_f32_16x16x32_bf16 v[140:143], a[148:151], v[84:87], v[140:143]
  v_exp_f32 v219, v155
  v_and_b32 v235, s4, v235
  v_mfma_f32_16x16x32_bf16 v[96:99], a[152:155], v[56:59], v[96:99]
  ds_read_b128 a[184:187], v3 offset:22528
  v_add_f32 v227, v216, v217
  v_cvt_pk_bf16_f32 v188, v216, v217
  v_add_f32 v227, v227, v218
  v_add_f32 v227, v227, v219
  v_mfma_f32_16x16x32_bf16 v[104:107], a[152:155], v[60:63], v[104:107]
  buffer_load_dwordx4 v2, s[44:47], s26 offen offset:3072 sc1 lds
  v_cvt_pk_bf16_f32 v189, v218, v219
  v_mfma_f32_16x16x32_bf16 v[128:131], a[152:155], v[88:91], v[128:131]
  s_add_u32 s26, s26, 16384
  v_exp_f32 v220, v156
  v_mfma_f32_16x16x32_bf16 v[136:139], a[152:155], v[92:95], v[136:139]
  s_add_u32 s24, s24, 32768
  v_exp_f32 v221, v157
  v_mfma_f32_16x16x32_bf16 v[100:103], a[156:159], v[56:59], v[100:103]
  s_and_b32 s24, s24, 0x1ffff
  ds_read_b128 a[188:191], v3 offset:23552
  v_add_f32 v227, v227, v220
  v_add_f32 v227, v227, v221
  v_mfma_f32_16x16x32_bf16 v[108:111], a[156:159], v[60:63], v[108:111]
  v_exp_f32 v222, v158
  v_mfma_f32_16x16x32_bf16 v[132:135], a[156:159], v[88:91], v[132:135]
  s_add_u32 m0, s34, 0
  v_exp_f32 v223, v159
  v_mfma_f32_16x16x32_bf16 v[140:143], a[156:159], v[92:95], v[140:143]
  s_waitcnt lgkmcnt(4)
  buffer_load_dwordx4 v8, s[52:55], s33 offen offset:0 lds
  v_cvt_pk_bf16_f32 v190, v220, v221
  v_add_f32 v227, v227, v222
  v_add_f32 v227, v227, v223
  v_mfma_f32_16x16x32_bf16 a[0:3], a[160:163], v[160:163], a[0:3]
  ds_read_b128 a[128:131], v3 offset:0
  v_cvt_pk_bf16_f32 v191, v222, v223
  v_mfma_f32_16x16x32_bf16 a[4:7], a[160:163], v[164:167], a[4:7]
  s_mov_b32 s4, s5
  v_exp_f32 v208, v112
  v_mfma_f32_16x16x32_bf16 a[64:67], a[160:163], v[176:179], a[64:67]
  s_mov_b32 s5, -1
  v_exp_f32 v209, v113
  v_mfma_f32_16x16x32_bf16 v[232:235], a[192:195], a[212:215], v[232:235]
  v_mfma_f32_16x16x32_bf16 a[68:71], a[160:163], v[180:183], a[68:71]
  v_exp_f32 v210, v114
  v_mfma_f32_16x16x32_bf16 a[8:11], a[164:167], v[160:163], a[8:11]
  ds_read_b128 a[132:135], v3 offset:1024
  v_add_f32 v224, v208, v209
  v_cvt_pk_bf16_f32 v168, v208, v209
  v_mfma_f32_16x16x32_bf16 a[12:15], a[164:167], v[164:167], a[12:15]
  buffer_load_dwordx4 v11, s[52:55], s33 offen offset:1024 lds
  v_add_f32 v224, v224, v210
  v_mfma_f32_16x16x32_bf16 a[72:75], a[164:167], v[176:179], a[72:75]
  v_exp_f32 v211, v115
  v_mfma_f32_16x16x32_bf16 a[76:79], a[164:167], v[180:183], a[76:79]
  v_exp_f32 v212, v116
  v_mfma_f32_16x16x32_bf16 v[232:235], a[196:199], a[216:219], v[232:235]
  v_mfma_f32_16x16x32_bf16 a[16:19], a[168:171], v[160:163], a[16:19]
  ds_read_b128 a[136:139], v3 offset:2048
  v_add_f32 v224, v224, v211
  v_cvt_pk_bf16_f32 v169, v210, v211
  v_mfma_f32_16x16x32_bf16 a[20:23], a[168:171], v[164:167], a[20:23]
  v_exp_f32 v213, v117
  v_mfma_f32_16x16x32_bf16 a[80:83], a[168:171], v[176:179], a[80:83]
  v_exp_f32 v214, v118
  v_mfma_f32_16x16x32_bf16 a[84:87], a[168:171], v[180:183], a[84:87]
  buffer_load_dwordx4 v12, s[52:55], s33 offen offset:2048 lds
  v_add_f32 v224, v224, v212
  v_add_f32 v224, v224, v213
  v_cvt_pk_bf16_f32 v170, v212, v213
  v_mfma_f32_16x16x32_bf16 a[24:27], a[172:175], v[160:163], a[24:27]
  ds_read_b128 a[140:143], v3 offset:3072
  v_add_f32 v224, v224, v214
  v_mfma_f32_16x16x32_bf16 v[232:235], a[200:203], a[220:223], v[232:235]
  v_mfma_f32_16x16x32_bf16 a[28:31], a[172:175], v[164:167], a[28:31]
  v_exp_f32 v215, v119
  v_mfma_f32_16x16x32_bf16 a[88:91], a[172:175], v[176:179], a[88:91]
  v_exp_f32 v208, v120
  v_mfma_f32_16x16x32_bf16 a[92:95], a[172:175], v[180:183], a[92:95]
  s_waitcnt lgkmcnt(4)
  v_exp_f32 v209, v121
  v_mfma_f32_16x16x32_bf16 a[32:35], a[176:179], v[160:163], a[32:35]
  ds_read_b128 a[144:147], v3 offset:4096
  v_add_f32 v224, v224, v215
  v_cvt_pk_bf16_f32 v171, v214, v215
  v_add_f32 v225, v208, v209
  v_mfma_f32_16x16x32_bf16 a[36:39], a[176:179], v[164:167], a[36:39]
  buffer_load_dwordx4 v13, s[52:55], s33 offen offset:3072 lds
  v_cvt_pk_bf16_f32 v172, v208, v209
  v_mfma_f32_16x16x32_bf16 v[232:235], a[204:207], a[224:227], v[232:235]
  v_mfma_f32_16x16x32_bf16 a[96:99], a[176:179], v[176:179], a[96:99]
  v_exp_f32 v210, v122
  v_mfma_f32_16x16x32_bf16 a[100:103], a[176:179], v[180:183], a[100:103]
  v_exp_f32 v211, v123
  v_mfma_f32_16x16x32_bf16 a[40:43], a[180:183], v[160:163], a[40:43]
  ds_read_b128 a[148:151], v3 offset:5120
  v_add_f32 v225, v225, v210
  v_add_f32 v225, v225, v211
  v_mfma_f32_16x16x32_bf16 a[44:47], a[180:183], v[164:167], a[44:47]
  v_exp_f32 v212, v124
  v_mfma_f32_16x16x32_bf16 a[104:107], a[180:183], v[176:179], a[104:107]
  s_add_u32 m0, s34, 4096
  v_exp_f32 v213, v125
  v_mfma_f32_16x16x32_bf16 v[232:235], a[208:211], a[228:231], v[232:235]
  v_mfma_f32_16x16x32_bf16 a[108:111], a[180:183], v[180:183], a[108:111]
  buffer_load_dwordx4 v14, s[52:55], s33 offen offset:0 lds
  v_cvt_pk_bf16_f32 v173, v210, v211
  v_max3_f32 v5, v226, v227, v224
  v_mfma_f32_16x16x32_bf16 a[48:51], a[184:187], v[160:163], a[48:51]
  ds_read_b128 a[152:155], v3 offset:6144
  v_add_f32 v225, v225, v212
  v_mfma_f32_16x16x32_bf16 a[52:55], a[184:187], v[164:167], a[52:55]
  s_add_u32 s33, s33, s6
  v_exp_f32 v214, v126
  v_mfma_f32_16x16x32_bf16 a[112:115], a[184:187], v[176:179], a[112:115]
  v_exp_f32 v215, v127
  v_mfma_f32_16x16x32_bf16 a[116:119], a[184:187], v[180:183], a[116:119]
  v_add_f32 v225, v225, v213
  v_cvt_pk_bf16_f32 v174, v212, v213
  v_add_f32 v225, v225, v214
  v_mfma_f32_16x16x32_bf16 a[56:59], a[188:191], v[160:163], a[56:59]
  ds_read_b128 a[156:159], v3 offset:7168
  v_add_f32 v225, v225, v215
  v_max_f32 v5, v5, v225
  v_cmp_lt_f32 vcc, s81, v5
  v_mfma_f32_16x16x32_bf16 a[60:63], a[188:191], v[164:167], a[60:63]
  v_exp_f32 v216, v128
  v_mfma_f32_16x16x32_bf16 a[120:123], a[188:191], v[176:179], a[120:123]
  s_waitcnt lgkmcnt(4)
  v_cvt_pk_bf16_f32 v175, v214, v215
  v_mfma_f32_16x16x32_bf16 a[124:127], a[188:191], v[180:183], a[124:127]
  s_cbranch_vccnz fa_stub3
fa_back3:
  v_exp_f32 v217, v129
  v_add_f32 v228, v228, v224
  v_add_f32 v229, v229, v225
  v_add_f32 v230, v230, v226
  v_add_f32 v231, v231, v227
  s_branch fa_DDe
fa_kv2_spin:
  s_mov_b32 s83, 200000
fa_kv2_spin2:
  buffer_load_dword v14, v13, s[40:43], 0 offen sc1
  s_waitcnt vmcnt(0)
  v_cmp_eq_u32 vcc, 0, v14
  s_cbranch_vccz fa_kv2_ok
  s_sleep 3
  s_sub_u32 s83, s83, 1
  s_cmp_lg_u32 s83, 0
  s_cbranch_scc1 fa_kv2_spin2
  s_branch fa_kv2_ok
fa_kv3_spin:
  s_mov_b32 s83, 200000
fa_kv3_spin2:
  buffer_load_dword v14, v13, s[40:43], 0 offen sc1
  s_waitcnt vmcnt(0)
  v_cmp_eq_u32 vcc, 0, v14
  s_cbranch_vccz fa_kv3_ok
  s_sleep 3
  s_sub_u32 s83, s83, 1
  s_cmp_lg_u32 s83, 0
  s_cbranch_scc1 fa_kv3_spin2
  s_branch fa_kv3_ok
fa_sel_spin:
  s_mov_b32 s83, 200000
fa_sel_spin2:
  buffer_load_dword v15, v252, s[40:43], 0 offen sc1
  s_waitcnt vmcnt(0)
  v_cmp_eq_u32 vcc, 0, v15
  s_cbranch_vccz fa_sel_ok
  s_sleep 3
  s_sub_u32 s83, s83, 1
  s_cmp_lg_u32 s83, 0
  s_cbranch_scc1 fa_sel_spin2
  s_branch fa_sel_ok
fa_wof_spin:
  s_mov_b32 s83, 200000
fa_wof_spin2:
  buffer_load_dword v8, v9, s[40:43], 0 offen sc1
  s_waitcnt vmcnt(0)
  v_cmp_eq_u32 vcc, 0, v8
  s_cbranch_vccz fa_wof_ok
  s_sleep 3
  s_sub_u32 s83, s83, 1
  s_cmp_lg_u32 s83, 0
  s_cbranch_scc1 fa_wof_spin2
  s_branch fa_wof_ok
fa_sel4_spin:
  s_mov_b32 s83, 200000
fa_sel4_spin2:
  buffer_load_dword v15, v10, s[40:43], 0 offen sc1
  s_waitcnt vmcnt(0)
  v_cmp_eq_u32 vcc, 0, v15
  s_cbranch_vccz fa_sel4_ok
  s_sleep 3
  s_sub_u32 s83, s83, 1
  s_cmp_lg_u32 s83, 0
  s_cbranch_scc1 fa_sel4_spin2
  s_branch fa_sel4_ok
fa_yf_spin:
  s_mov_b32 s83, 200000
fa_yf_spin2:
  buffer_load_dword v14, v11, s[40:43], 0 offen sc1
  s_waitcnt vmcnt(0)
  v_cmp_eq_u32 vcc, 0, v14
  s_cbranch_vccz fa_yf_ok
  s_sleep 3
  s_sub_u32 s83, s83, 1
  s_cmp_lg_u32 s83, 0
  s_cbranch_scc1 fa_yf_spin2
  s_branch fa_yf_ok
fa_co:
  s_sub_u32 s14, s2, 64
  s_cmp_lt_u32 s14, 96
  s_cbranch_scc1 fa_coT
  s_sub_u32 s14, s2, 128
  s_sub_u32 s23, s2, 224
  s_cmp_lt_u32 s23, 31
  s_cbranch_scc1 fa_coT
  v_cmp_eq_u32 vcc, 0, v14
  s_cbranch_vccnz fa_kv2_spin
fa_kv2_ok:
  s_sub_u32 s14, s2, 170
  s_cmp_lt_u32 s14, 54
  s_cbranch_scc1 fa_coF
  s_cmp_eq_u32 s2, 255
  s_cbranch_scc1 fa_coW
  s_cmp_lt_u32 s2, 32
  s_cbranch_scc1 fa_coW
  s_branch fa_coO
fa_coT:
  v_min_u32 v8, 16, v1
  v_lshlrev_b32 v8, 7, v8
  s_lshl_b32 s10, s14, 1
  s_and_b32 s31, s20, 1
  s_add_u32 s10, s10, s31
  s_mul_i32 s10, s10, 2176
  s_lshl_b32 s35, s14, 2
  s_add_u32 s35, s35, s20
  s_mul_i32 s35, s35, 4352
  buffer_load_dword v255, v8, s[52:55], s10 offen
  s_add_u32 s10, s10, 552960
  s_getpc_b64 s[36:37]
  s_setpc_b64 s[38:39]
  buffer_load_dword v255, v8, s[52:55], s10 offen
  s_add_u32 s10, s10, 552960
  s_getpc_b64 s[36:37]
  s_setpc_b64 s[38:39]
  v_cmp_eq_u32 vcc, 0, v14
  s_cbranch_vccnz fa_kv3_spin
fa_kv3_ok:
  buffer_load_dword v255, v8, s[52:55], s10 offen
  s_add_u32 s10, s10, 552960
  buffer_load_dword v255, v8, s[60:63], s35 offen offset:0
  s_getpc_b64 s[36:37]
  s_setpc_b64 s[38:39]
  buffer_load_dword v255, v8, s[52:55], s10 offen
  s_add_u32 s10, s10, 552960
  buffer_load_dword v255, v8, s[60:63], s35 offen offset:2176
  s_mov_b32 s9, -1
  s_and_b32 s32, s21, 3
  s_lshr_b32 s32, s32, 1
  s_add_u32 s32, s32, 6
  s_lshl_b32 s32, s32, 14
  s_getpc_b64 s[36:37]
  s_setpc_b64 s[38:39]
fa_coO:
  s_and_b32 s23, s67, 1
  s_lshl_b32 s23, s23, 2
  s_add_u32 s23, s23, s20
  s_lshr_b32 s31, s67, 1
  s_mul_i32 s33, s23, 0
  s_add_u32 s33, s33, s31
  s_and_b32 s33, s33, 31
  s_andn2_b32 s30, s31, 31
  s_add_u32 s33, s33, s30
  s_lshl_b32 s30, s23, 7
  s_add_u32 s30, s30, s33
  s_mul_i32 s33, s31, 40960
  s_mul_i32 s23, s23, 160
  s_add_u32 s33, s33, s23
  s_add_u32 m0, s34, 0
  v_accvgpr_read_b32 v19, a248
  buffer_load_dwordx4 v19, s[56:59], s33 offen lds
  s_add_u32 m0, s34, 1024
  v_accvgpr_read_b32 v19, a249
  buffer_load_dwordx4 v19, s[56:59], s33 offen lds
  s_add_u32 m0, s34, 2048
  v_accvgpr_read_b32 v19, a250
  buffer_load_dwordx4 v19, s[56:59], s33 offen lds
  s_add_u32 m0, s34, 3072
  v_accvgpr_read_b32 v19, a251
  buffer_load_dwordx4 v19, s[56:59], s33 offen lds
  s_add_u32 m0, s34, 4096
  v_accvgpr_read_b32 v19, a252
  buffer_load_dwordx4 v19, s[56:59], s33 offen lds
  s_lshl_b32 s32, s11, 15
  s_add_u32 s32, s32, s26
  s_mov_b32 s9, -1
  s_lshl_b32 s10, s30, 7
  s_mul_i32 s30, s30, 5120
  s_add_u32 s30, s30, 4194304
  s_getpc_b64 s[36:37]
  s_setpc_b64 s[38:39]
  s_waitcnt vmcnt(8)
  ds_read_b64_tr_b16 v[232:233], v6 offset:0
  ds_read_b64_tr_b16 v[234:235], v6 offset:2560
  ds_read_b64_tr_b16 v[236:237], v6 offset:32
  ds_read_b64_tr_b16 v[238:239], v6 offset:2592
  ds_read_b64_tr_b16 v[240:241], v6 offset:64
  ds_read_b64_tr_b16 v[242:243], v6 offset:2624
  ds_read_b64_tr_b16 v[244:245], v6 offset:96
  ds_read_b64_tr_b16 v[246:247], v6 offset:2656
  ds_read_b64_tr_b16 v[248:249], v6 offset:128
  ds_read_b64_tr_b16 v[250:251], v6 offset:2688
  s_waitcnt lgkmcnt(0)
  s_add_u32 s31, s30, 4096
  buffer_store_dwordx4 v[232:235], v2, s[40:43], s30 offen offset:0 sc1
  buffer_store_dwordx4 v[236:239], v2, s[40:43], s30 offen offset:1024 sc1
  buffer_store_dwordx4 v[240:243], v2, s[40:43], s30 offen offset:2048 sc1
  buffer_store_dwordx4 v[244:247], v2, s[40:43], s30 offen offset:3072 sc1
  buffer_store_dwordx4 v[248:251], v2, s[40:43], s31 offen offset:0 sc1
  s_getpc_b64 s[36:37]
  s_setpc_b64 s[38:39]
  s_add_u32 s23, s10, 67371008
  s_waitcnt vmcnt(8)
  buffer_store_dword v4, off, s[40:43], s23 sc1
  s_cmp_lg_u32 s67, s2
  s_cbranch_scc1 fa_coW
  s_sub_u32 s67, s2, 128
  s_cmp_lt_u32 s67, 32
  s_cbranch_scc1 fa_coO
  s_sub_u32 s23, s2, 96
  s_sub_u32 s31, s2, 192
  s_cmp_lt_u32 s23, 32
  s_cselect_b32 s23, s23, s31
  s_cmp_gt_u32 s23, 54
  s_cbranch_scc1 fa_coW
  s_add_u32 s67, s23, 170
  s_cmp_eq_u32 s67, 224
  s_cselect_b32 s67, 255, s67
  s_branch fa_coO
fa_coF:
  v_and_b32 v16, 7, v1
  v_lshlrev_b32 v252, 2, v16
  v_add_u32 v252, 2629632, v252
  buffer_load_dword v15, v252, s[40:43], 0 offen sc1
  s_lshl_b32 s33, s14, 6
  s_and_b32 s31, s20, 1
  s_lshl_b32 s31, s31, 5
  s_add_u32 s33, s33, s31
  s_mul_i32 s35, s14, 40960
  s_mul_i32 s31, s20, 320
  s_add_u32 s35, s35, s31
  s_mul_i32 s10, s14, 20480
  s_mul_i32 s31, s20, 5120
  s_add_u32 s10, s10, s31
  s_add_u32 s10, s10, 2686976
  v_lshrrev_b32 v17, 1, v1
  v_mul_u32_u24 v8, 3456, v17
  v_and_b32 v17, 1, v1
  v_lshl_add_u32 v8, v17, 4, v8
  v_add_u32 v11, 109568, v8
  v_add_u32 v12, 219136, v8
  v_add_u32 v13, 328704, v8
  v_add_u32 v14, 442368, v8
  v_lshrrev_b32 v17, 4, v1
  v_lshrrev_b32 v18, 2, v1
  v_lshl_add_u32 v18, v17, 2, v18
  v_lshlrev_b32 v18, 5, v18
  v_and_b32 v19, 3, v1
  v_lshl_add_u32 v9, v19, 3, v18
  v_add_u32 v9, s34, v9
  v_lshlrev_b32 v10, 4, v16
  v_lshl_add_u32 v10, v17, 7, v10
  v_add_u32 v10, 148992, v10
  s_mov_b32 s8, -1
  s_mov_b32 s4, 0
  s_mov_b32 s5, 0
  s_mov_b32 s6, 552960
  s_getpc_b64 s[36:37]
  s_setpc_b64 s[38:39]
  s_waitcnt vmcnt(8)
  v_cmp_eq_u32 vcc, 0, v15
  s_cbranch_vccnz fa_sel_spin
fa_sel_ok:
  v_add_u32 v18, -1, v15
  v_and_b32 v18, 2047, v18
  v_lshrrev_b32 v19, 4, v18
  v_mul_u32_u24 v19, 20480, v19
  v_and_b32 v18, 15, v18
  v_lshl_add_u32 v19, v18, 4, v19
  v_lshrrev_b32 v18, 3, v1
  v_lshl_add_u32 v19, v18, 8, v19
  s_lshl_b32 s23, s20, 11
  s_lshl_b32 s31, s20, 10
  s_add_u32 s31, s31, 151552
  s_mov_b32 s32, 163840
  s_mov_b32 m0, s31
  s_add_u32 s31, s31, 4096
  buffer_load_dwordx4 v19, s[40:43], s23 offen sc1 lds
  s_add_u32 s23, s23, 8192
  s_mov_b32 m0, s31
  s_add_u32 s31, s31, 4096
  buffer_load_dwordx4 v19, s[40:43], s23 offen sc1 lds
  s_add_u32 s23, s23, 8192
  s_mov_b32 m0, s31
  s_add_u32 s31, s31, 4096
  buffer_load_dwordx4 v19, s[40:43], s23 offen sc1 lds
  s_add_u32 s23, s23, 8192
  s_getpc_b64 s[36:37]
  s_setpc_b64 s[38:39]
  v_accvgpr_read_b32 v8, a248
  v_accvgpr_read_b32 v11, a249
  v_accvgpr_read_b32 v12, a250
  v_accvgpr_read_b32 v13, a251
  v_accvgpr_read_b32 v14, a252
  v_subrev_u32 v11, 1024, v11
  v_subrev_u32 v12, 2048, v12
  v_subrev_u32 v13, 3072, v13
  s_mov_b32 s52, s60
  s_mov_b32 s53, s61
  s_mov_b32 s33, s35
  s_movk_i32 s6, 160
  s_mov_b32 s9, 0
  v_and_b32 v17, 7, v1
  v_lshlrev_b32 v15, 6, v17
  v_lshrrev_b32 v17, 4, v1
  v_lshl_add_u32 v15, v17, 4, v15
  v_and_b32 v17, 8, v1
  v_lshl_add_u32 v15, v17, 27, v15
  s_getpc_b64 s[36:37]
  s_setpc_b64 s[38:39]
  s_lshl_b32 s23, s20, 9
  v_add_u32 v16, s23, v10
  s_mov_b32 s9, -1
  ds_write_b128 v16, v[232:235]
  s_getpc_b64 s[36:37]
  s_setpc_b64 s[38:39]
  ds_read_b128 v[236:239], v10 offset:0
  ds_read_b128 v[240:243], v10 offset:512
  ds_read_b128 v[244:247], v10 offset:1024
  ds_read_b128 v[248:251], v10 offset:1536
  s_waitcnt vmcnt(4)
  ds_read_b64_tr_b16 a[192:193], v6 offset:0
  ds_read_b64_tr_b16 a[194:195], v6 offset:2560
  ds_read_b64_tr_b16 a[196:197], v6 offset:32
  ds_read_b64_tr_b16 a[198:199], v6 offset:2592
  ds_read_b64_tr_b16 a[200:201], v6 offset:64
  ds_read_b64_tr_b16 a[202:203], v6 offset:2624
  ds_read_b64_tr_b16 a[204:205], v6 offset:96
  ds_read_b64_tr_b16 a[206:207], v6 offset:2656
  ds_read_b64_tr_b16 a[208:209], v6 offset:128
  ds_read_b64_tr_b16 a[210:211], v6 offset:2688
  v_subrev_u32 v10, 10240, v10
  s_mov_b32 s8, 0
  s_waitcnt lgkmcnt(10)
  v_cvt_pk_bf16_f32 v236, v236, v244
  v_cvt_pk_bf16_f32 v237, v237, v245
  v_cvt_pk_bf16_f32 v238, v238, v246
  v_cvt_pk_bf16_f32 v239, v239, v247
  v_cvt_pk_bf16_f32 v240, v240, v248
  v_cvt_pk_bf16_f32 v241, v241, v249
  v_cvt_pk_bf16_f32 v242, v242, v250
  v_cvt_pk_bf16_f32 v243, v243, v251
  v_lshlrev_b32 v244, 16, v236
  v_lshlrev_b32 v245, 16, v237
  v_lshlrev_b32 v246, 16, v238
  v_lshlrev_b32 v247, 16, v239
  v_lshlrev_b32 v248, 16, v240
  v_lshlrev_b32 v249, 16, v241
  v_lshlrev_b32 v250, 16, v242
  v_lshlrev_b32 v251, 16, v243
  v_mul_f32 v16, 0xbfb8aa3b, v244
  v_mul_f32 v17, 0xbfb8aa3b, v245
  v_mul_f32 v18, 0xbfb8aa3b, v246
  v_mul_f32 v19, 0xbfb8aa3b, v247
  v_mul_f32 v20, 0xbfb8aa3b, v248
  v_mul_f32 v21, 0xbfb8aa3b, v249
  v_mul_f32 v22, 0xbfb8aa3b, v250
  v_mul_f32 v23, 0xbfb8aa3b, v251
  v_exp_f32 v16, v16
  v_exp_f32 v17, v17
  v_exp_f32 v18, v18
  v_exp_f32 v19, v19
  v_exp_f32 v20, v20
  v_exp_f32 v21, v21
  v_exp_f32 v22, v22
  v_exp_f32 v23, v23
  v_add_f32 v16, 1.0, v16
  v_add_f32 v17, 1.0, v17
  v_add_f32 v18, 1.0, v18
  v_add_f32 v19, 1.0, v19
  v_add_f32 v20, 1.0, v20
  v_add_f32 v21, 1.0, v21
  v_add_f32 v22, 1.0, v22
  v_add_f32 v23, 1.0, v23
  v_rcp_f32 v16, v16
  v_rcp_f32 v17, v17
  v_rcp_f32 v18, v18
  v_rcp_f32 v19, v19
  v_rcp_f32 v20, v20
  v_rcp_f32 v21, v21
  v_rcp_f32 v22, v22
  v_rcp_f32 v23, v23
  v_and_b32 v236, 0xffff0000, v236
  v_and_b32 v237, 0xffff0000, v237
  v_and_b32 v238, 0xffff0000, v238
  v_and_b32 v239, 0xffff0000, v239
  v_and_b32 v240, 0xffff0000, v240
  v_and_b32 v241, 0xffff0000, v241
  v_and_b32 v242, 0xffff0000, v242
  v_and_b32 v243, 0xffff0000, v243
  v_pk_mul_f32 v[244:245], v[244:245], v[16:17]
  v_pk_mul_f32 v[246:247], v[246:247], v[18:19]
  v_pk_mul_f32 v[248:249], v[248:249], v[20:21]
  v_pk_mul_f32 v[250:251], v[250:251], v[22:23]
  v_cvt_pk_bf16_f32 v16, v244, v245
  v_cvt_pk_bf16_f32 v17, v246, v247
  v_cvt_pk_bf16_f32 v18, v248, v249
  v_cvt_pk_bf16_f32 v19, v250, v251
  v_lshlrev_b32 v244, 16, v16
  v_and_b32 v245, 0xffff0000, v16
  v_lshlrev_b32 v246, 16, v17
  v_and_b32 v247, 0xffff0000, v17
  v_lshlrev_b32 v248, 16, v18
  v_and_b32 v249, 0xffff0000, v18
  v_lshlrev_b32 v250, 16, v19
  v_and_b32 v251, 0xffff0000, v19
  v_pk_mul_f32 v[236:237], v[236:237], v[244:245]
  v_pk_mul_f32 v[238:239], v[238:239], v[246:247]
  v_pk_mul_f32 v[240:241], v[240:241], v[248:249]
  v_pk_mul_f32 v[242:243], v[242:243], v[250:251]
  v_cvt_pk_bf16_f32 v16, v236, v237
  v_cvt_pk_bf16_f32 v17, v238, v239
  v_cvt_pk_bf16_f32 v18, v240, v241
  v_cvt_pk_bf16_f32 v19, v242, v243
  v_accvgpr_write_b32 a232, v16
  v_accvgpr_write_b32 a233, v17
  v_accvgpr_write_b32 a234, v18
  v_accvgpr_write_b32 a235, v19
  s_nop 0
  s_waitcnt lgkmcnt(0)
  v_mfma_f32_16x16x32_bf16 v[236:239], a[192:195], a[232:235], 0
  v_mfma_f32_16x16x32_bf16 v[240:243], a[196:199], a[232:235], 0
  v_mfma_f32_16x16x32_bf16 v[244:247], a[200:203], a[232:235], 0
  v_mfma_f32_16x16x32_bf16 v[248:251], a[204:207], a[232:235], 0
  v_mfma_f32_16x16x32_bf16 v[252:255], a[208:211], a[232:235], 0
  s_nop 3
  buffer_store_dwordx4 v[236:239], v15, s[40:43], s10 offen offset:0 sc1
  buffer_store_dwordx4 v[240:243], v15, s[40:43], s10 offen offset:512 sc1
  buffer_store_dwordx4 v[244:247], v15, s[40:43], s10 offen offset:1024 sc1
  buffer_store_dwordx4 v[248:251], v15, s[40:43], s10 offen offset:1536 sc1
  buffer_store_dwordx4 v[252:255], v15, s[40:43], s10 offen offset:2048 sc1
  s_add_u32 s10, s10, 2560
  s_getpc_b64 s[36:37]
  s_setpc_b64 s[38:39]
  s_waitcnt vmcnt(4)
  ds_read_b64_tr_b16 a[192:193], v6 offset:0
  ds_read_b64_tr_b16 a[194:195], v6 offset:2560
  ds_read_b64_tr_b16 a[196:197], v6 offset:32
  ds_read_b64_tr_b16 a[198:199], v6 offset:2592
  ds_read_b64_tr_b16 a[200:201], v6 offset:64
  ds_read_b64_tr_b16 a[202:203], v6 offset:2624
  ds_read_b64_tr_b16 a[204:205], v6 offset:96
  ds_read_b64_tr_b16 a[206:207], v6 offset:2656
  ds_read_b64_tr_b16 a[208:209], v6 offset:128
  ds_read_b64_tr_b16 a[210:211], v6 offset:2688
  s_waitcnt lgkmcnt(0)
  v_mfma_f32_16x16x32_bf16 v[236:239], a[192:195], a[232:235], 0
  v_mfma_f32_16x16x32_bf16 v[240:243], a[196:199], a[232:235], 0
  v_mfma_f32_16x16x32_bf16 v[244:247], a[200:203], a[232:235], 0
  v_mfma_f32_16x16x32_bf16 v[248:251], a[204:207], a[232:235], 0
  v_mfma_f32_16x16x32_bf16 v[252:255], a[208:211], a[232:235], 0
  s_nop 3
  buffer_store_dwordx4 v[236:239], v15, s[40:43], s10 offen offset:0 sc1
  buffer_store_dwordx4 v[240:243], v15, s[40:43], s10 offen offset:512 sc1
  buffer_store_dwordx4 v[244:247], v15, s[40:43], s10 offen offset:1024 sc1
  buffer_store_dwordx4 v[248:251], v15, s[40:43], s10 offen offset:1536 sc1
  buffer_store_dwordx4 v[252:255], v15, s[40:43], s10 offen offset:2048 sc1
  s_add_u32 s10, s10, 2560
  s_getpc_b64 s[36:37]
  s_setpc_b64 s[38:39]
  s_sub_u32 s23, s2, 170
  s_lshl_b32 s31, s20, 6
  s_add_u32 s23, s23, s31
  s_lshl_b32 s23, s23, 7
  s_add_u32 s23, s23, 67174400
  s_waitcnt vmcnt(8)
  buffer_store_dword v4, off, s[40:43], s23 sc1
fa_coW:
  s_mov_b32 s12, 1
  s_mov_b32 s9, -1
  s_cmp_lg_u32 s11, 0
  s_cselect_b32 s32, s15, -1
  s_getpc_b64 s[36:37]
  s_setpc_b64 s[38:39]
  s_lshl_b32 s23, s22, 1
  s_and_b32 s31, s2, 1
  s_add_u32 s23, s23, s31
  s_lshl_b32 s23, s23, 2
  s_add_u32 s23, s23, s20
  s_mul_i32 s13, s23, 81920
  s_add_u32 s13, s13, 4194304
  s_lshl_b32 s23, s23, 11
  s_add_u32 s23, s23, 67371008
  v_and_b32 v9, 15, v1
  v_lshl_add_u32 v9, v9, 7, s23
  s_and_b32 s60, s2, 7
  s_lshl_b32 s60, s60, 1
  s_and_b32 s23, s2, 16
  s_add_u32 s60, s60, s23
  s_bfe_u32 s23, s2, 0x10003
  s_add_u32 s60, s60, s23
  v_and_b32 v10, 15, v1
  v_lshlrev_b32 v10, 2, v10
  v_add_u32 v10, 2629632, v10
  buffer_load_dword v8, v9, s[40:43], 0 offen sc1
  buffer_load_dword v15, v10, s[40:43], 0 offen sc1
  s_load_dwordx2 s[52:53], s[0:1], 0
  v_mov_b32 v20, v228
  v_mov_b32 v21, v229
  s_nop 1
  v_permlane16_swap_b32 v228, v20
  v_permlane16_swap_b32 v229, v21
  v_add_f32 v228, v228, v20
  v_add_f32 v229, v229, v21
  v_mov_b32 v20, v228
  v_mov_b32 v21, v229
  s_nop 1
  v_permlane32_swap_b32 v228, v20
  v_permlane32_swap_b32 v229, v21
  v_add_f32 v228, v228, v20
  v_add_f32 v229, v229, v21
  v_rcp_f32 v16, v228
  v_rcp_f32 v18, v229
  s_lshl_b32 s23, s22, 2
  v_mov_b32 v17, v16
  v_mov_b32 v19, v18
  s_add_u32 s23, s23, s20
  s_lshl_b32 s23, s23, 18
  s_lshl_b32 s31, s21, 12
  s_add_u32 s31, s31, 50331648
  s_add_u32 s64, s23, s31
  s_add_u32 s65, s64, 131072
  v_accvgpr_read_b32 v36, a0
  v_accvgpr_read_b32 v37, a1
  v_accvgpr_read_b32 v38, a2
  v_accvgpr_read_b32 v39, a3
  v_accvgpr_read_b32 v40, a8
  v_accvgpr_read_b32 v41, a9
  v_accvgpr_read_b32 v42, a10
  v_accvgpr_read_b32 v43, a11
  v_pk_mul_f32 v[36:37], v[36:37], v[16:17]
  v_pk_mul_f32 v[38:39], v[38:39], v[16:17]
  v_pk_mul_f32 v[40:41], v[40:41], v[16:17]
  v_pk_mul_f32 v[42:43], v[42:43], v[16:17]
  v_cvt_pk_bf16_f32 v32, v36, v37
  v_cvt_pk_bf16_f32 v33, v38, v39
  v_cvt_pk_bf16_f32 v34, v40, v41
  v_cvt_pk_bf16_f32 v35, v42, v43
  buffer_store_dwordx4 v[32:35], v2, s[40:43], s64 offen offset:0 sc1
  v_accvgpr_read_b32 v48, a16
  v_accvgpr_read_b32 v49, a17
  v_accvgpr_read_b32 v50, a18
  v_accvgpr_read_b32 v51, a19
  v_accvgpr_read_b32 v52, a24
  v_accvgpr_read_b32 v53, a25
  v_accvgpr_read_b32 v54, a26
  v_accvgpr_read_b32 v55, a27
  v_pk_mul_f32 v[48:49], v[48:49], v[16:17]
  v_pk_mul_f32 v[50:51], v[50:51], v[16:17]
  v_pk_mul_f32 v[52:53], v[52:53], v[16:17]
  v_pk_mul_f32 v[54:55], v[54:55], v[16:17]
  v_cvt_pk_bf16_f32 v44, v48, v49
  v_cvt_pk_bf16_f32 v45, v50, v51
  v_cvt_pk_bf16_f32 v46, v52, v53
  v_cvt_pk_bf16_f32 v47, v54, v55
  buffer_store_dwordx4 v[44:47], v2, s[40:43], s64 offen offset:1024 sc1
  v_accvgpr_read_b32 v100, a32
  v_accvgpr_read_b32 v101, a33
  v_accvgpr_read_b32 v102, a34
  v_accvgpr_read_b32 v103, a35
  v_accvgpr_read_b32 v104, a40
  v_accvgpr_read_b32 v105, a41
  v_accvgpr_read_b32 v106, a42
  v_accvgpr_read_b32 v107, a43
  v_pk_mul_f32 v[100:101], v[100:101], v[16:17]
  v_pk_mul_f32 v[102:103], v[102:103], v[16:17]
  v_pk_mul_f32 v[104:105], v[104:105], v[16:17]
  v_pk_mul_f32 v[106:107], v[106:107], v[16:17]
  v_cvt_pk_bf16_f32 v96, v100, v101
  v_cvt_pk_bf16_f32 v97, v102, v103
  v_cvt_pk_bf16_f32 v98, v104, v105
  v_cvt_pk_bf16_f32 v99, v106, v107
  buffer_store_dwordx4 v[96:99], v2, s[40:43], s64 offen offset:2048 sc1
  v_accvgpr_read_b32 v112, a48
  v_accvgpr_read_b32 v113, a49
  v_accvgpr_read_b32 v114, a50
  v_accvgpr_read_b32 v115, a51
  v_accvgpr_read_b32 v116, a56
  v_accvgpr_read_b32 v117, a57
  v_accvgpr_read_b32 v118, a58
  v_accvgpr_read_b32 v119, a59
  v_pk_mul_f32 v[112:113], v[112:113], v[16:17]
  v_pk_mul_f32 v[114:115], v[114:115], v[16:17]
  v_pk_mul_f32 v[116:117], v[116:117], v[16:17]
  v_pk_mul_f32 v[118:119], v[118:119], v[16:17]
  v_cvt_pk_bf16_f32 v108, v112, v113
  v_cvt_pk_bf16_f32 v109, v114, v115
  v_cvt_pk_bf16_f32 v110, v116, v117
  v_cvt_pk_bf16_f32 v111, v118, v119
  buffer_store_dwordx4 v[108:111], v2, s[40:43], s64 offen offset:3072 sc1
  v_accvgpr_read_b32 v36, a4
  v_accvgpr_read_b32 v37, a5
  v_accvgpr_read_b32 v38, a6
  v_accvgpr_read_b32 v39, a7
  v_accvgpr_read_b32 v40, a12
  v_accvgpr_read_b32 v41, a13
  v_accvgpr_read_b32 v42, a14
  v_accvgpr_read_b32 v43, a15
  v_pk_mul_f32 v[36:37], v[36:37], v[18:19]
  v_pk_mul_f32 v[38:39], v[38:39], v[18:19]
  v_pk_mul_f32 v[40:41], v[40:41], v[18:19]
  v_pk_mul_f32 v[42:43], v[42:43], v[18:19]
  v_cvt_pk_bf16_f32 v32, v36, v37
  v_cvt_pk_bf16_f32 v33, v38, v39
  v_cvt_pk_bf16_f32 v34, v40, v41
  v_cvt_pk_bf16_f32 v35, v42, v43
  buffer_store_dwordx4 v[32:35], v2, s[40:43], s65 offen offset:0 sc1
  v_accvgpr_read_b32 v48, a20
  v_accvgpr_read_b32 v49, a21
  v_accvgpr_read_b32 v50, a22
  v_accvgpr_read_b32 v51, a23
  v_accvgpr_read_b32 v52, a28
  v_accvgpr_read_b32 v53, a29
  v_accvgpr_read_b32 v54, a30
  v_accvgpr_read_b32 v55, a31
  v_pk_mul_f32 v[48:49], v[48:49], v[18:19]
  v_pk_mul_f32 v[50:51], v[50:51], v[18:19]
  v_pk_mul_f32 v[52:53], v[52:53], v[18:19]
  v_pk_mul_f32 v[54:55], v[54:55], v[18:19]
  v_cvt_pk_bf16_f32 v44, v48, v49
  v_cvt_pk_bf16_f32 v45, v50, v51
  v_cvt_pk_bf16_f32 v46, v52, v53
  v_cvt_pk_bf16_f32 v47, v54, v55
  buffer_store_dwordx4 v[44:47], v2, s[40:43], s65 offen offset:1024 sc1
  v_accvgpr_read_b32 v100, a36
  v_accvgpr_read_b32 v101, a37
  v_accvgpr_read_b32 v102, a38
  v_accvgpr_read_b32 v103, a39
  v_accvgpr_read_b32 v104, a44
  v_accvgpr_read_b32 v105, a45
  v_accvgpr_read_b32 v106, a46
  v_accvgpr_read_b32 v107, a47
  v_pk_mul_f32 v[100:101], v[100:101], v[18:19]
  v_pk_mul_f32 v[102:103], v[102:103], v[18:19]
  v_pk_mul_f32 v[104:105], v[104:105], v[18:19]
  v_pk_mul_f32 v[106:107], v[106:107], v[18:19]
  v_cvt_pk_bf16_f32 v96, v100, v101
  v_cvt_pk_bf16_f32 v97, v102, v103
  v_cvt_pk_bf16_f32 v98, v104, v105
  v_cvt_pk_bf16_f32 v99, v106, v107
  buffer_store_dwordx4 v[96:99], v2, s[40:43], s65 offen offset:2048 sc1
  v_accvgpr_read_b32 v112, a52
  v_accvgpr_read_b32 v113, a53
  v_accvgpr_read_b32 v114, a54
  v_accvgpr_read_b32 v115, a55
  v_accvgpr_read_b32 v116, a60
  v_accvgpr_read_b32 v117, a61
  v_accvgpr_read_b32 v118, a62
  v_accvgpr_read_b32 v119, a63
  v_pk_mul_f32 v[112:113], v[112:113], v[18:19]
  v_pk_mul_f32 v[114:115], v[114:115], v[18:19]
  v_pk_mul_f32 v[116:117], v[116:117], v[18:19]
  v_pk_mul_f32 v[118:119], v[118:119], v[18:19]
  v_cvt_pk_bf16_f32 v108, v112, v113
  v_cvt_pk_bf16_f32 v109, v114, v115
  v_cvt_pk_bf16_f32 v110, v116, v117
  v_cvt_pk_bf16_f32 v111, v118, v119
  buffer_store_dwordx4 v[108:111], v2, s[40:43], s65 offen offset:3072 sc1
  s_lshl_b32 s33, s60, 6
  s_mul_i32 s35, s22, 160
  s_mul_i32 s14, s22, 2560
  s_mov_b32 s54, 2621440
  s_mov_b32 s55, 0x20000
  v_add_u32 v16, 0, v0
  v_mul_u32_u24 v17, 6554, v16
  v_lshrrev_b32 v17, 16, v17
  v_mul_u32_u24 v18, 10, v17
  v_sub_u32 v18, v16, v18
  v_mul_u32_u24 v251, 336, v17
  v_lshl_add_u32 v251, v18, 5, v251
  v_add_u32 v17, s33, v17
  v_mul_u32_u24 v248, 1280, v17
  v_lshl_add_u32 v248, v18, 4, v248
  v_add_u32 v248, s35, v248
  v_lshrrev_b32 v19, 4, v17
  v_mul_u32_u24 v19, 20480, v19
  v_and_b32 v17, 15, v17
  v_lshl_add_u32 v19, v17, 4, v19
  v_lshl_add_u32 v24, v18, 8, v19
  v_add_u32 v16, 256, v0
  v_mul_u32_u24 v17, 6554, v16
  v_lshrrev_b32 v17, 16, v17
  v_mul_u32_u24 v18, 10, v17
  v_sub_u32 v18, v16, v18
  v_mul_u32_u24 v252, 336, v17
  v_lshl_add_u32 v252, v18, 5, v252
  v_add_u32 v17, s33, v17
  v_mul_u32_u24 v249, 1280, v17
  v_lshl_add_u32 v249, v18, 4, v249
  v_add_u32 v249, s35, v249
  v_lshrrev_b32 v19, 4, v17
  v_mul_u32_u24 v19, 20480, v19
  v_and_b32 v17, 15, v17
  v_lshl_add_u32 v19, v17, 4, v19
  v_lshl_add_u32 v25, v18, 8, v19
  v_add_u32 v16, 512, v0
  v_mul_u32_u24 v17, 6554, v16
  v_lshrrev_b32 v17, 16, v17
  v_mul_u32_u24 v18, 10, v17
  v_sub_u32 v18, v16, v18
  v_mul_u32_u24 v253, 336, v17
  v_lshl_add_u32 v253, v18, 5, v253
  v_add_u32 v17, s33, v17
  v_mul_u32_u24 v250, 1280, v17
  v_lshl_add_u32 v250, v18, 4, v250
  v_add_u32 v250, s35, v250
  v_lshrrev_b32 v19, 4, v17
  v_mul_u32_u24 v19, 20480, v19
  v_and_b32 v17, 15, v17
  v_lshl_add_u32 v19, v17, 4, v19
  v_lshl_add_u32 v26, v18, 8, v19
  v_cmp_gt_u32 vcc, 128, v0
  v_mov_b32 v16, 1073741824
  v_mov_b32 v17, 0
  v_lshlrev_b32 v6, 4, v0
  v_cndmask_b32 v250, v16, v250, vcc
  v_cndmask_b32 v26, v16, v26, vcc
  v_cndmask_b32 v253, v17, v253, vcc
  v_cndmask_b32 v6, v16, v6, vcc
  s_lshl_b32 s23, s20, 10
  s_add_u32 s23, s23, 151552
  s_waitcnt vmcnt(8) lgkmcnt(0)
  s_add_u32 m0, s34, 0
  s_nop 0
  buffer_load_dwordx4 v248, s[52:55], 0 offen lds
  s_add_u32 m0, s34, 3072
  s_nop 0
  buffer_load_dwordx4 v24, s[40:43], s14 offen sc1 lds
  s_add_u32 m0, s34, 1024
  s_nop 0
  buffer_load_dwordx4 v249, s[52:55], 0 offen lds
  s_add_u32 m0, s34, 4096
  s_nop 0
  buffer_load_dwordx4 v25, s[40:43], s14 offen sc1 lds
  s_add_u32 m0, s34, 2048
  s_nop 0
  buffer_load_dwordx4 v250, s[52:55], 0 offen lds
  s_mov_b32 m0, s23
  s_nop 0
  buffer_load_dwordx4 v26, s[40:43], s14 offen sc1 lds
  s_mov_b32 s28, s46
  s_add_u32 s30, s28, 65536
  s_lshl_b32 s23, s20, 12
  s_add_u32 s23, s23, s28
  s_add_u32 s31, s13, 32768
  s_sub_u32 s31, s31, s23
  s_add_u32 s4, s18, s31
  s_addc_u32 s5, s19, 0
  s_add_u32 s6, s4, 4096
  s_addc_u32 s7, s5, 0
  v_cmp_eq_u32 vcc, 0, v8
  s_cbranch_vccnz fa_wof_spin
fa_wof_ok:
  v_cmp_eq_u32 vcc, 0, v15
  s_cbranch_vccnz fa_sel4_spin
fa_sel4_ok:
  s_lshl_b32 s31, s60, 6
  s_add_u32 s31, s31, 1
  v_subrev_u32 v16, s31, v15
  v_cmp_gt_u32 vcc, 64, v16
  s_cmp_lt_u32 s20, 2
  s_cselect_b32 s23, 0xff, 0
  s_and_b32 s10, vcc_lo, s23
  s_sub_u32 s23, s10, 1
  s_and_b32 s23, s23, s10
  s_cmp_eq_u32 s20, 1
  s_cselect_b32 s10, s23, s10
  s_cmp_eq_u32 s10, 0
  s_cbranch_scc1 fa_coEnd
  v_min_u32 v11, 53, v1
  s_lshr_b32 s23, s22, 1
  s_lshl_b32 s23, s23, 13
  s_add_u32 s23, s23, 67174400
  v_lshl_add_u32 v11, v11, 7, s23
  buffer_load_dword v14, v11, s[40:43], 0 offen sc1
  v_mul_u32_u24 v16, 3277, v1
  v_lshrrev_b32 v16, 16, v16
  v_mul_u32_u24 v8, 20, v16
  v_sub_u32 v8, v1, v8
  v_lshlrev_b32 v8, 4, v8
  v_mul_u32_u24 v9, 368640, v16
  v_lshrrev_b32 v17, 6, v8
  v_mul_u32_u24 v17, 448, v17
  v_add3_u32 v9, v9, v8, v17
  v_cmp_gt_u32 vcc, 3, v16
  v_mov_b32 v19, 1073741824
  s_nop 0
  v_cndmask_b32 v9, v19, v9, vcc
  s_mov_b32 s12, 2
  s_mov_b32 s32, -1
  s_mov_b32 s11, 0
  s_getpc_b64 s[36:37]
  s_setpc_b64 s[38:39]
  v_cmp_eq_u32 vcc, 0, v14
  s_cbranch_vccnz fa_yf_spin
fa_yf_ok:
fa_coY:
  s_ff1_i32_b32 s33, s10
  s_bitset0_b32 s10, s33
  s_sub_u32 s23, s10, 1
  s_and_b32 s10, s10, s23
  s_lshl_b32 s14, s33, 6
  s_mul_i32 s23, s22, 2560
  s_add_u32 s14, s14, s23
  s_add_u32 s14, s14, 2686976
  buffer_load_dwordx4 v[64:67], v9, s[40:43], s14 offen sc1
  s_add_u32 s14, s14, 20480
  buffer_load_dwordx4 v[68:71], v9, s[40:43], s14 offen sc1
  s_add_u32 s14, s14, 20480
  buffer_load_dwordx4 v[72:75], v9, s[40:43], s14 offen sc1
  s_add_u32 s14, s14, 20480
  buffer_load_dwordx4 v[76:79], v9, s[40:43], s14 offen sc1
  s_add_u32 s14, s14, 20480
  buffer_load_dwordx4 v[80:83], v9, s[40:43], s14 offen sc1
  s_add_u32 s14, s14, 20480
  buffer_load_dwordx4 v[84:87], v9, s[40:43], s14 offen sc1
  s_add_u32 s14, s14, 20480
  buffer_load_dwordx4 v[88:91], v9, s[40:43], s14 offen sc1
  s_add_u32 s14, s14, 20480
  buffer_load_dwordx4 v[92:95], v9, s[40:43], s14 offen sc1
  s_add_u32 s14, s14, 20480
  buffer_load_dwordx4 v[128:131], v9, s[40:43], s14 offen sc1
  s_add_u32 s14, s14, 20480
  buffer_load_dwordx4 v[132:135], v9, s[40:43], s14 offen sc1
  s_add_u32 s14, s14, 20480
  buffer_load_dwordx4 v[136:139], v9, s[40:43], s14 offen sc1
  s_add_u32 s14, s14, 20480
  buffer_load_dwordx4 v[140:143], v9, s[40:43], s14 offen sc1
  s_add_u32 s14, s14, 20480
  buffer_load_dwordx4 v[144:147], v9, s[40:43], s14 offen sc1
  s_add_u32 s14, s14, 20480
  buffer_load_dwordx4 v[148:151], v9, s[40:43], s14 offen sc1
  s_add_u32 s14, s14, 20480
  buffer_load_dwordx4 v[152:155], v9, s[40:43], s14 offen sc1
  s_add_u32 s14, s14, 20480
  buffer_load_dwordx4 v[156:159], v9, s[40:43], s14 offen sc1
  s_add_u32 s14, s14, 20480
  buffer_load_dwordx4 v[176:179], v9, s[40:43], s14 offen sc1
  s_add_u32 s14, s14, 20480
  buffer_load_dwordx4 v[180:183], v9, s[40:43], s14 offen sc1
  s_add_u32 s14, s14, 20480
  s_lshl_b32 s14, s20, 10
  s_add_u32 s14, s14, 159744
  v_add_u32 v19, s14, v2
  s_add_u32 s23, s33, 8
  v_readlane_b32 s35, v15, s23
  s_waitcnt vmcnt(0)
  v_pk_add_f32 v[64:65], v[64:65], v[68:69]
  v_pk_add_f32 v[66:67], v[66:67], v[70:71]
  v_pk_add_f32 v[64:65], v[64:65], v[72:73]
  v_pk_add_f32 v[66:67], v[66:67], v[74:75]
  v_pk_add_f32 v[64:65], v[64:65], v[76:77]
  v_pk_add_f32 v[66:67], v[66:67], v[78:79]
  v_pk_add_f32 v[64:65], v[64:65], v[80:81]
  v_pk_add_f32 v[66:67], v[66:67], v[82:83]
  v_pk_add_f32 v[64:65], v[64:65], v[84:85]
  v_pk_add_f32 v[66:67], v[66:67], v[86:87]
  v_pk_add_f32 v[64:65], v[64:65], v[88:89]
  v_pk_add_f32 v[66:67], v[66:67], v[90:91]
  v_pk_add_f32 v[64:65], v[64:65], v[92:93]
  v_pk_add_f32 v[66:67], v[66:67], v[94:95]
  v_pk_add_f32 v[64:65], v[64:65], v[128:129]
  v_pk_add_f32 v[66:67], v[66:67], v[130:131]
  v_pk_add_f32 v[64:65], v[64:65], v[132:133]
  v_pk_add_f32 v[66:67], v[66:67], v[134:135]
  v_pk_add_f32 v[64:65], v[64:65], v[136:137]
  v_pk_add_f32 v[66:67], v[66:67], v[138:139]
  v_pk_add_f32 v[64:65], v[64:65], v[140:141]
  v_pk_add_f32 v[66:67], v[66:67], v[142:143]
  v_pk_add_f32 v[64:65], v[64:65], v[144:145]
  v_pk_add_f32 v[66:67], v[66:67], v[146:147]
  v_pk_add_f32 v[64:65], v[64:65], v[148:149]
  v_pk_add_f32 v[66:67], v[66:67], v[150:151]
  v_pk_add_f32 v[64:65], v[64:65], v[152:153]
  v_pk_add_f32 v[66:67], v[66:67], v[154:155]
  v_pk_add_f32 v[64:65], v[64:65], v[156:157]
  v_pk_add_f32 v[66:67], v[66:67], v[158:159]
  v_pk_add_f32 v[64:65], v[64:65], v[176:177]
  v_pk_add_f32 v[66:67], v[66:67], v[178:179]
  v_pk_add_f32 v[64:65], v[64:65], v[180:181]
  v_pk_add_f32 v[66:67], v[66:67], v[182:183]
  ds_write_b128 v19, v[64:67]
  v_add_u32 v19, s14, v8
  s_and_b32 s35, s35, 0xffff0000
  s_waitcnt lgkmcnt(0)
  ds_read_b128 v[64:67], v19
  ds_read_b128 v[68:71], v19 offset:320
  ds_read_b128 v[72:75], v19 offset:640
  s_mul_i32 s14, s33, 320
  s_add_u32 s14, s14, 155648
  v_add_u32 v19, s14, v8
  s_waitcnt lgkmcnt(0)
  v_add_f32 v64, v64, v68
  v_add_f32 v64, v64, v72
  v_cvt_pk_bf16_f32 v64, v64, v64
  v_and_b32 v64, 0xffff0000, v64
  v_mul_f32 v64, s35, v64
  v_cvt_pk_bf16_f32 v64, v64, v64
  v_and_b32 v64, 0xffff0000, v64
  v_add_f32 v65, v65, v69
  v_add_f32 v65, v65, v73
  v_cvt_pk_bf16_f32 v65, v65, v65
  v_and_b32 v65, 0xffff0000, v65
  v_mul_f32 v65, s35, v65
  v_cvt_pk_bf16_f32 v65, v65, v65
  v_and_b32 v65, 0xffff0000, v65
  v_add_f32 v66, v66, v70
  v_add_f32 v66, v66, v74
  v_cvt_pk_bf16_f32 v66, v66, v66
  v_and_b32 v66, 0xffff0000, v66
  v_mul_f32 v66, s35, v66
  v_cvt_pk_bf16_f32 v66, v66, v66
  v_and_b32 v66, 0xffff0000, v66
  v_add_f32 v67, v67, v71
  v_add_f32 v67, v67, v75
  v_cvt_pk_bf16_f32 v67, v67, v67
  v_and_b32 v67, 0xffff0000, v67
  v_mul_f32 v67, s35, v67
  v_cvt_pk_bf16_f32 v67, v67, v67
  v_and_b32 v67, 0xffff0000, v67
  ds_write_b128 v19, v[64:67]
  s_waitcnt lgkmcnt(0)
  s_cmp_lg_u32 s10, 0
  s_cbranch_scc1 fa_coY
fa_coEnd:
  s_mov_b32 s12, 3
  s_mov_b32 s32, -1
  s_setpc_b64 s[38:39]
fa_hk7:
  s_getpc_b64 s[38:39]
fa_hp7:
  s_add_u32 s36, s36, 4
  s_addc_u32 s37, s37, 0
  s_sub_u32 s38, s38, fa_hp7-fa_hb7
  s_subb_u32 s39, s39, 0
  s_setpc_b64 s[36:37]
fa_hk8:
  s_getpc_b64 s[38:39]
fa_hp8:
  s_add_u32 s36, s36, 4
  s_addc_u32 s37, s37, 0
  s_sub_u32 s38, s38, fa_hp8-fa_hb8
  s_subb_u32 s39, s39, 0
  s_setpc_b64 s[36:37]
fa_disp:
  s_cmp_eq_u32 s29, 7
  s_cbranch_scc1 fa_SSW7
  s_cmp_eq_u32 s29, 6
  s_cbranch_scc1 fa_SSW6
  s_cmp_eq_u32 s29, 5
  s_cbranch_scc1 fa_SSW5
  s_cmp_eq_u32 s29, 4
  s_cbranch_scc1 fa_SSW4
  s_cmp_eq_u32 s29, 3
  s_cbranch_scc1 fa_SSW3
  s_cmp_eq_u32 s29, 2
  s_cbranch_scc1 fa_SSW2
  s_cmp_eq_u32 s29, 1
  s_cbranch_scc1 fa_SSW1
  s_branch fa_Bexit
fa_hk9:
  s_getpc_b64 s[38:39]
fa_hp9:
  s_add_u32 s36, s36, 4
  s_addc_u32 s37, s37, 0
  s_sub_u32 s38, s38, fa_hp9-fa_hb9
  s_subb_u32 s39, s39, 0
  s_setpc_b64 s[36:37]
fa_left:
  s_add_u32 s14, s13, 77824
  buffer_load_dwordx4 a[252:255], v2, s[40:43], s14 offen offset:3072 sc1
  buffer_load_dwordx4 a[248:251], v2, s[40:43], s14 offen offset:2048 sc1
  buffer_load_dwordx4 a[244:247], v2, s[40:43], s14 offen offset:1024 sc1
  s_cmp_ge_u32 s29, 7
  s_cbranch_scc1 fa_leftb
  s_add_u32 s14, s13, 77824
  buffer_load_dwordx4 a[240:243], v2, s[40:43], s14 offen offset:0 sc1
  s_add_u32 s14, s13, 73728
  buffer_load_dwordx4 a[236:239], v2, s[40:43], s14 offen offset:3072 sc1
  buffer_load_dwordx4 a[232:235], v2, s[40:43], s14 offen offset:2048 sc1
  s_cmp_ge_u32 s29, 6
  s_cbranch_scc1 fa_leftb
  s_add_u32 s14, s13, 73728
  buffer_load_dwordx4 a[228:231], v2, s[40:43], s14 offen offset:1024 sc1
  buffer_load_dwordx4 a[224:227], v2, s[40:43], s14 offen offset:0 sc1
  s_add_u32 s14, s13, 69632
  buffer_load_dwordx4 a[220:223], v2, s[40:43], s14 offen offset:3072 sc1
  buffer_load_dwordx4 a[216:219], v2, s[40:43], s14 offen offset:2048 sc1
  s_cmp_ge_u32 s29, 5
  s_cbranch_scc1 fa_leftb
  s_add_u32 s14, s13, 69632
  buffer_load_dwordx4 a[212:215], v2, s[40:43], s14 offen offset:1024 sc1
  buffer_load_dwordx4 a[208:211], v2, s[40:43], s14 offen offset:0 sc1
  s_add_u32 s14, s13, 61440
  buffer_load_dwordx4 a[204:207], v2, s[40:43], s14 offen offset:3072 sc1
  buffer_load_dwordx4 a[200:203], v2, s[40:43], s14 offen offset:2048 sc1
  buffer_load_dwordx4 a[196:199], v2, s[40:43], s14 offen offset:1024 sc1
  buffer_load_dwordx4 a[192:195], v2, s[40:43], s14 offen offset:0 sc1
  s_cmp_ge_u32 s29, 4
  s_cbranch_scc1 fa_leftb
  s_add_u32 s14, s13, 57344
  buffer_load_dwordx4 a[60:63], v2, s[40:43], s14 offen offset:3072 sc1
  buffer_load_dwordx4 a[56:59], v2, s[40:43], s14 offen offset:2048 sc1
  buffer_load_dwordx4 a[52:55], v2, s[40:43], s14 offen offset:1024 sc1
  buffer_load_dwordx4 a[48:51], v2, s[40:43], s14 offen offset:0 sc1
  s_add_u32 s14, s13, 45056
  buffer_load_dwordx4 a[44:47], v2, s[40:43], s14 offen offset:3072 sc1
  buffer_load_dwordx4 a[40:43], v2, s[40:43], s14 offen offset:2048 sc1
  buffer_load_dwordx4 a[36:39], v2, s[40:43], s14 offen offset:1024 sc1
  buffer_load_dwordx4 a[32:35], v2, s[40:43], s14 offen offset:0 sc1
  s_cmp_ge_u32 s29, 3
  s_cbranch_scc1 fa_leftb
  s_add_u32 s14, s13, 40960
  buffer_load_dwordx4 a[28:31], v2, s[40:43], s14 offen offset:3072 sc1
  buffer_load_dwordx4 a[24:27], v2, s[40:43], s14 offen offset:2048 sc1
  buffer_load_dwordx4 a[20:23], v2, s[40:43], s14 offen offset:1024 sc1
  buffer_load_dwordx4 a[16:19], v2, s[40:43], s14 offen offset:0 sc1
  s_add_u32 s14, s13, 28672
  buffer_load_dwordx4 a[12:15], v2, s[40:43], s14 offen offset:3072 sc1
  buffer_load_dwordx4 a[8:11], v2, s[40:43], s14 offen offset:2048 sc1
  buffer_load_dwordx4 a[4:7], v2, s[40:43], s14 offen offset:1024 sc1
  buffer_load_dwordx4 a[0:3], v2, s[40:43], s14 offen offset:0 sc1
  s_cmp_ge_u32 s29, 2
  s_cbranch_scc1 fa_leftb
  s_add_u32 s14, s13, 24576
  buffer_load_dwordx4 v[212:215], v2, s[40:43], s14 offen offset:3072 sc1
  buffer_load_dwordx4 v[208:211], v2, s[40:43], s14 offen offset:2048 sc1
  buffer_load_dwordx4 v[196:199], v2, s[40:43], s14 offen offset:1024 sc1
  buffer_load_dwordx4 v[192:195], v2, s[40:43], s14 offen offset:0 sc1
  s_add_u32 s14, s13, 20480
  buffer_load_dwordx4 v[244:247], v2, s[40:43], s14 offen offset:3072 sc1
  buffer_load_dwordx4 v[240:243], v2, s[40:43], s14 offen offset:2048 sc1
  buffer_load_dwordx4 v[236:239], v2, s[40:43], s14 offen offset:1024 sc1
  buffer_load_dwordx4 v[232:235], v2, s[40:43], s14 offen offset:0 sc1
  s_cmp_ge_u32 s29, 1
  s_cbranch_scc1 fa_leftb
  s_add_u32 s14, s13, 16384
  buffer_load_dwordx4 v[172:175], v2, s[40:43], s14 offen offset:3072 sc1
  buffer_load_dwordx4 v[168:171], v2, s[40:43], s14 offen offset:2048 sc1
  buffer_load_dwordx4 v[164:167], v2, s[40:43], s14 offen offset:1024 sc1
  buffer_load_dwordx4 v[160:163], v2, s[40:43], s14 offen offset:0 sc1
  s_add_u32 s14, s13, 12288
  buffer_load_dwordx4 v[124:127], v2, s[40:43], s14 offen offset:3072 sc1
  buffer_load_dwordx4 v[120:123], v2, s[40:43], s14 offen offset:2048 sc1
  buffer_load_dwordx4 v[116:119], v2, s[40:43], s14 offen offset:1024 sc1
  buffer_load_dwordx4 v[112:115], v2, s[40:43], s14 offen offset:0 sc1
  s_branch fa_leftb
fa_ctx_spin:
  s_mov_b32 s83, 200000
fa_ctx_spin2:
  buffer_load_dword v13, v12, s[40:43], 0 offen sc1
  s_waitcnt vmcnt(0)
  v_cmp_eq_u32 vcc, 0, v13
  s_cbranch_vccz fa_ctx_ok
  s_sleep 3
  s_sub_u32 s83, s83, 1
  s_cmp_lg_u32 s83, 0
  s_cbranch_scc1 fa_ctx_spin2
  s_branch fa_ctx_ok
fa_ctx2_spin:
  s_mov_b32 s83, 200000
fa_ctx2_spin2:
  buffer_load_dword v13, v10, s[40:43], 0 offen sc1
  s_waitcnt vmcnt(0)
  v_cmp_eq_u32 vcc, 0, v13
  s_cbranch_vccz fa_ctx2_ok
  s_sleep 3
  s_sub_u32 s83, s83, 1
  s_cmp_lg_u32 s83, 0
  s_cbranch_scc1 fa_ctx2_spin2
  s_branch fa_ctx2_ok
fa_px_spin:
  s_mov_b32 s83, 200000
fa_px_spin2:
  buffer_load_dword v13, v8, s[40:43], 0 offen sc1
  s_waitcnt vmcnt(0)
  v_cmp_eq_u32 vcc, 0, v13
  s_cbranch_vccz fa_px_ok
  s_sleep 3
  s_sub_u32 s83, s83, 1
  s_cmp_lg_u32 s83, 0
  s_cbranch_scc1 fa_px_spin2
  s_branch fa_px_ok
fa_stub0:
  s_call_b64 s[76:77], fa_rare00
  s_call_b64 s[76:77], fa_rare10
  s_branch fa_back0
fa_stub1:
  s_call_b64 s[76:77], fa_rare01
  s_call_b64 s[76:77], fa_rare11
  s_branch fa_back1
fa_stub2:
  s_call_b64 s[76:77], fa_rare00
  s_call_b64 s[76:77], fa_rare10
  s_branch fa_back2
fa_stub3:
  s_call_b64 s[76:77], fa_rare01
  s_call_b64 s[76:77], fa_rare11
  s_branch fa_back3
fa_stub4:
  s_call_b64 s[76:77], fa_rare01
  s_call_b64 s[76:77], fa_rare11
  s_branch fa_back4
fa_stub5:
  s_call_b64 s[76:77], fa_rare00
  s_call_b64 s[76:77], fa_rare10
  s_branch fa_back5
fa_stub6:
  s_call_b64 s[76:77], fa_rare11
  s_branch fa_back6
fa_stub7:
  s_call_b64 s[76:77], fa_rare10
  s_branch fa_back7
fa_stub8:
  s_call_b64 s[76:77], fa_rare01
  s_call_b64 s[76:77], fa_rare11
  s_branch fa_back8
fa_stub9:
  s_call_b64 s[76:77], fa_rare10
  s_branch fa_back9
fa_stub10:
  s_call_b64 s[76:77], fa_rare11
  s_branch fa_back10
fa_stub11:
  s_call_b64 s[76:77], fa_rare10
  s_branch fa_back11
fa_stub12:
  s_call_b64 s[76:77], fa_rare11
  s_branch fa_back12
fa_stub13:
  s_call_b64 s[76:77], fa_rare10
  s_branch fa_back13
fa_stub14:
  s_call_b64 s[76:77], fa_rare11
  s_branch fa_back14
fa_stub15:
  s_call_b64 s[76:77], fa_rare10
  s_branch fa_back15
fa_stub16:
  s_call_b64 s[76:77], fa_rare11
  s_branch fa_back16
fa_stub17:
  s_call_b64 s[76:77], fa_rare10
  s_branch fa_back17
fa_stub18:
  s_call_b64 s[76:77], fa_rare11
  s_branch fa_back18
fa_stub19:
  s_call_b64 s[76:77], fa_rare10
  s_branch fa_back19
fa_stub20:
  s_call_b64 s[76:77], fa_rare11
  s_branch fa_back20
fa_stub21:
  s_call_b64 s[76:77], fa_rare10
  s_branch fa_back21
fa_stub22:
  s_call_b64 s[76:77], fa_rare11
  s_branch fa_back22
fa_stub23:
  s_call_b64 s[76:77], fa_rare10
  s_branch fa_back23
fa_stub24:
  s_call_b64 s[76:77], fa_rare11
  s_branch fa_back24
fa_stub25:
  s_call_b64 s[76:77], fa_rare10
  s_branch fa_back25
fa_stub26:
  s_call_b64 s[76:77], fa_rare11
  s_branch fa_back26
fa_stub27:
  s_call_b64 s[76:77], fa_rare10
  s_branch fa_back27
fa_stub28:
  s_call_b64 s[76:77], fa_rare11
  s_branch fa_back28
fa_stub29:
  s_call_b64 s[76:77], fa_rare10
  s_branch fa_back29
fa_stub30:
  s_call_b64 s[76:77], fa_rare11
  s_branch fa_back30
fa_codeend:
fa_rare00:
  s_nop 7
  v_max3_f32 v16, v96, v97, v98
  v_max3_f32 v16, v16, v99, v100
  v_max3_f32 v16, v16, v101, v102
  v_max3_f32 v16, v16, v103, 0
  v_mov_b32 v18, v16
  s_nop 1
  v_permlane16_swap_b32 v16, v18
  v_max_f32 v16, v16, v18
  v_mov_b32 v18, v16
  s_nop 1
  v_permlane32_swap_b32 v16, v18
  v_max_f32 v16, v16, v18
  v_sub_f32 v96, v96, v16
  v_sub_f32 v112, v112, v16
  v_sub_f32 v97, v97, v16
  v_sub_f32 v113, v113, v16
  v_sub_f32 v98, v98, v16
  v_sub_f32 v114, v114, v16
  v_sub_f32 v99, v99, v16
  v_sub_f32 v115, v115, v16
  v_sub_f32 v100, v100, v16
  v_sub_f32 v116, v116, v16
  v_sub_f32 v101, v101, v16
  v_sub_f32 v117, v117, v16
  v_sub_f32 v102, v102, v16
  v_sub_f32 v118, v118, v16
  v_sub_f32 v103, v103, v16
  v_sub_f32 v119, v119, v16
  v_max3_f32 v17, v104, v105, v106
  v_max3_f32 v17, v17, v107, v108
  v_max3_f32 v17, v17, v109, v110
  v_max3_f32 v17, v17, v111, 0
  v_mov_b32 v18, v17
  s_nop 1
  v_permlane16_swap_b32 v17, v18
  v_max_f32 v17, v17, v18
  v_mov_b32 v18, v17
  s_nop 1
  v_permlane32_swap_b32 v17, v18
  v_max_f32 v17, v17, v18
  v_sub_f32 v104, v104, v17
  v_sub_f32 v120, v120, v17
  v_sub_f32 v105, v105, v17
  v_sub_f32 v121, v121, v17
  v_sub_f32 v106, v106, v17
  v_sub_f32 v122, v122, v17
  v_sub_f32 v107, v107, v17
  v_sub_f32 v123, v123, v17
  v_sub_f32 v108, v108, v17
  v_sub_f32 v124, v124, v17
  v_sub_f32 v109, v109, v17
  v_sub_f32 v125, v125, v17
  v_sub_f32 v110, v110, v17
  v_sub_f32 v126, v126, v17
  v_sub_f32 v111, v111, v17
  v_sub_f32 v127, v127, v17
  s_call_b64 s[78:79], fa_resc0
  v_exp_f32 v208, v96
  v_exp_f32 v209, v97
  v_exp_f32 v210, v98
  v_add_f32 v224, v208, v209
  v_cvt_pk_bf16_f32 v160, v208, v209
  v_exp_f32 v211, v99
  v_add_f32 v224, v224, v210
  v_exp_f32 v212, v100
  v_add_f32 v224, v224, v211
  v_cvt_pk_bf16_f32 v161, v210, v211
  v_exp_f32 v213, v101
  v_add_f32 v224, v224, v212
  v_exp_f32 v214, v102
  v_add_f32 v224, v224, v213
  v_cvt_pk_bf16_f32 v162, v212, v213
  v_exp_f32 v215, v103
  v_add_f32 v224, v224, v214
  v_exp_f32 v208, v104
  v_add_f32 v224, v224, v215
  v_cvt_pk_bf16_f32 v163, v214, v215
  v_exp_f32 v209, v105
  v_exp_f32 v210, v106
  v_add_f32 v225, v208, v209
  v_cvt_pk_bf16_f32 v164, v208, v209
  v_exp_f32 v211, v107
  v_add_f32 v225, v225, v210
  v_exp_f32 v212, v108
  v_add_f32 v225, v225, v211
  v_cvt_pk_bf16_f32 v165, v210, v211
  v_exp_f32 v213, v109
  v_add_f32 v225, v225, v212
  v_exp_f32 v214, v110
  v_add_f32 v225, v225, v213
  v_cvt_pk_bf16_f32 v166, v212, v213
  v_exp_f32 v215, v111
  v_add_f32 v225, v225, v214
  s_nop 0
  v_add_f32 v225, v225, v215
  v_cvt_pk_bf16_f32 v167, v214, v215
  s_nop 1
  s_setpc_b64 s[76:77]
fa_rare01:
  s_nop 7
  v_max3_f32 v16, v112, v113, v114
  v_max3_f32 v16, v16, v115, v116
  v_max3_f32 v16, v16, v117, v118
  v_max3_f32 v16, v16, v119, 0
  v_mov_b32 v18, v16
  s_nop 1
  v_permlane16_swap_b32 v16, v18
  v_max_f32 v16, v16, v18
  v_mov_b32 v18, v16
  s_nop 1
  v_permlane32_swap_b32 v16, v18
  v_max_f32 v16, v16, v18
  v_sub_f32 v112, v112, v16
  v_sub_f32 v96, v96, v16
  v_sub_f32 v113, v113, v16
  v_sub_f32 v97, v97, v16
  v_sub_f32 v114, v114, v16
  v_sub_f32 v98, v98, v16
  v_sub_f32 v115, v115, v16
  v_sub_f32 v99, v99, v16
  v_sub_f32 v116, v116, v16
  v_sub_f32 v100, v100, v16
  v_sub_f32 v117, v117, v16
  v_sub_f32 v101, v101, v16
  v_sub_f32 v118, v118, v16
  v_sub_f32 v102, v102, v16
  v_sub_f32 v119, v119, v16
  v_sub_f32 v103, v103, v16
  v_max3_f32 v17, v120, v121, v122
  v_max3_f32 v17, v17, v123, v124
  v_max3_f32 v17, v17, v125, v126
  v_max3_f32 v17, v17, v127, 0
  v_mov_b32 v18, v17
  s_nop 1
  v_permlane16_swap_b32 v17, v18
  v_max_f32 v17, v17, v18
  v_mov_b32 v18, v17
  s_nop 1
  v_permlane32_swap_b32 v17, v18
  v_max_f32 v17, v17, v18
  v_sub_f32 v120, v120, v17
  v_sub_f32 v104, v104, v17
  v_sub_f32 v121, v121, v17
  v_sub_f32 v105, v105, v17
  v_sub_f32 v122, v122, v17
  v_sub_f32 v106, v106, v17
  v_sub_f32 v123, v123, v17
  v_sub_f32 v107, v107, v17
  v_sub_f32 v124, v124, v17
  v_sub_f32 v108, v108, v17
  v_sub_f32 v125, v125, v17
  v_sub_f32 v109, v109, v17
  v_sub_f32 v126, v126, v17
  v_sub_f32 v110, v110, v17
  v_sub_f32 v127, v127, v17
  v_sub_f32 v111, v111, v17
  s_call_b64 s[78:79], fa_resc0
  v_exp_f32 v208, v112
  v_exp_f32 v209, v113
  v_exp_f32 v210, v114
  v_add_f32 v224, v208, v209
  v_cvt_pk_bf16_f32 v168, v208, v209
  v_exp_f32 v211, v115
  v_add_f32 v224, v224, v210
  v_exp_f32 v212, v116
  v_add_f32 v224, v224, v211
  v_cvt_pk_bf16_f32 v169, v210, v211
  v_exp_f32 v213, v117
  v_add_f32 v224, v224, v212
  v_exp_f32 v214, v118
  v_add_f32 v224, v224, v213
  v_cvt_pk_bf16_f32 v170, v212, v213
  v_exp_f32 v215, v119
  v_add_f32 v224, v224, v214
  v_exp_f32 v208, v120
  v_add_f32 v224, v224, v215
  v_cvt_pk_bf16_f32 v171, v214, v215
  v_exp_f32 v209, v121
  v_exp_f32 v210, v122
  v_add_f32 v225, v208, v209
  v_cvt_pk_bf16_f32 v172, v208, v209
  v_exp_f32 v211, v123
  v_add_f32 v225, v225, v210
  v_exp_f32 v212, v124
  v_add_f32 v225, v225, v211
  v_cvt_pk_bf16_f32 v173, v210, v211
  v_exp_f32 v213, v125
  v_add_f32 v225, v225, v212
  v_exp_f32 v214, v126
  v_add_f32 v225, v225, v213
  v_cvt_pk_bf16_f32 v174, v212, v213
  v_exp_f32 v215, v127
  v_add_f32 v225, v225, v214
  s_nop 0
  v_add_f32 v225, v225, v215
  v_cvt_pk_bf16_f32 v175, v214, v215
  s_nop 1
  s_setpc_b64 s[76:77]
fa_resc0:
  v_sub_f32 v192, v192, v16
  v_sub_f32 v193, v193, v16
  v_sub_f32 v194, v194, v16
  v_sub_f32 v195, v195, v16
  v_exp_f32 v18, -v16
  v_sub_f32 v196, v196, v17
  v_sub_f32 v197, v197, v17
  v_sub_f32 v198, v198, v17
  v_sub_f32 v199, v199, v17
  v_exp_f32 v19, -v17
  s_nop 0
  v_mul_f32 v228, v228, v18
  v_mul_f32 v229, v229, v19
  v_accvgpr_read_b32 v20, a0
  v_accvgpr_read_b32 v21, a1
  v_accvgpr_read_b32 v22, a2
  v_accvgpr_read_b32 v23, a3
  v_mul_f32 v20, v20, v18
  v_mul_f32 v21, v21, v18
  v_mul_f32 v22, v22, v18
  v_mul_f32 v23, v23, v18
  v_accvgpr_write_b32 a0, v20
  v_accvgpr_write_b32 a1, v21
  v_accvgpr_write_b32 a2, v22
  v_accvgpr_write_b32 a3, v23
  v_accvgpr_read_b32 v20, a4
  v_accvgpr_read_b32 v21, a5
  v_accvgpr_read_b32 v22, a6
  v_accvgpr_read_b32 v23, a7
  v_mul_f32 v20, v20, v19
  v_mul_f32 v21, v21, v19
  v_mul_f32 v22, v22, v19
  v_mul_f32 v23, v23, v19
  v_accvgpr_write_b32 a4, v20
  v_accvgpr_write_b32 a5, v21
  v_accvgpr_write_b32 a6, v22
  v_accvgpr_write_b32 a7, v23
  v_accvgpr_read_b32 v20, a8
  v_accvgpr_read_b32 v21, a9
  v_accvgpr_read_b32 v22, a10
  v_accvgpr_read_b32 v23, a11
  v_mul_f32 v20, v20, v18
  v_mul_f32 v21, v21, v18
  v_mul_f32 v22, v22, v18
  v_mul_f32 v23, v23, v18
  v_accvgpr_write_b32 a8, v20
  v_accvgpr_write_b32 a9, v21
  v_accvgpr_write_b32 a10, v22
  v_accvgpr_write_b32 a11, v23
  v_accvgpr_read_b32 v20, a12
  v_accvgpr_read_b32 v21, a13
  v_accvgpr_read_b32 v22, a14
  v_accvgpr_read_b32 v23, a15
  v_mul_f32 v20, v20, v19
  v_mul_f32 v21, v21, v19
  v_mul_f32 v22, v22, v19
  v_mul_f32 v23, v23, v19
  v_accvgpr_write_b32 a12, v20
  v_accvgpr_write_b32 a13, v21
  v_accvgpr_write_b32 a14, v22
  v_accvgpr_write_b32 a15, v23
  v_accvgpr_read_b32 v20, a16
  v_accvgpr_read_b32 v21, a17
  v_accvgpr_read_b32 v22, a18
  v_accvgpr_read_b32 v23, a19
  v_mul_f32 v20, v20, v18
  v_mul_f32 v21, v21, v18
  v_mul_f32 v22, v22, v18
  v_mul_f32 v23, v23, v18
  v_accvgpr_write_b32 a16, v20
  v_accvgpr_write_b32 a17, v21
  v_accvgpr_write_b32 a18, v22
  v_accvgpr_write_b32 a19, v23
  v_accvgpr_read_b32 v20, a20
  v_accvgpr_read_b32 v21, a21
  v_accvgpr_read_b32 v22, a22
  v_accvgpr_read_b32 v23, a23
  v_mul_f32 v20, v20, v19
  v_mul_f32 v21, v21, v19
  v_mul_f32 v22, v22, v19
  v_mul_f32 v23, v23, v19
  v_accvgpr_write_b32 a20, v20
  v_accvgpr_write_b32 a21, v21
  v_accvgpr_write_b32 a22, v22
  v_accvgpr_write_b32 a23, v23
  v_accvgpr_read_b32 v20, a24
  v_accvgpr_read_b32 v21, a25
  v_accvgpr_read_b32 v22, a26
  v_accvgpr_read_b32 v23, a27
  v_mul_f32 v20, v20, v18
  v_mul_f32 v21, v21, v18
  v_mul_f32 v22, v22, v18
  v_mul_f32 v23, v23, v18
  v_accvgpr_write_b32 a24, v20
  v_accvgpr_write_b32 a25, v21
  v_accvgpr_write_b32 a26, v22
  v_accvgpr_write_b32 a27, v23
  v_accvgpr_read_b32 v20, a28
  v_accvgpr_read_b32 v21, a29
  v_accvgpr_read_b32 v22, a30
  v_accvgpr_read_b32 v23, a31
  v_mul_f32 v20, v20, v19
  v_mul_f32 v21, v21, v19
  v_mul_f32 v22, v22, v19
  v_mul_f32 v23, v23, v19
  v_accvgpr_write_b32 a28, v20
  v_accvgpr_write_b32 a29, v21
  v_accvgpr_write_b32 a30, v22
  v_accvgpr_write_b32 a31, v23
  v_accvgpr_read_b32 v20, a32
  v_accvgpr_read_b32 v21, a33
  v_accvgpr_read_b32 v22, a34
  v_accvgpr_read_b32 v23, a35
  v_mul_f32 v20, v20, v18
  v_mul_f32 v21, v21, v18
  v_mul_f32 v22, v22, v18
  v_mul_f32 v23, v23, v18
  v_accvgpr_write_b32 a32, v20
  v_accvgpr_write_b32 a33, v21
  v_accvgpr_write_b32 a34, v22
  v_accvgpr_write_b32 a35, v23
  v_accvgpr_read_b32 v20, a36
  v_accvgpr_read_b32 v21, a37
  v_accvgpr_read_b32 v22, a38
  v_accvgpr_read_b32 v23, a39
  v_mul_f32 v20, v20, v19
  v_mul_f32 v21, v21, v19
  v_mul_f32 v22, v22, v19
  v_mul_f32 v23, v23, v19
  v_accvgpr_write_b32 a36, v20
  v_accvgpr_write_b32 a37, v21
  v_accvgpr_write_b32 a38, v22
  v_accvgpr_write_b32 a39, v23
  v_accvgpr_read_b32 v20, a40
  v_accvgpr_read_b32 v21, a41
  v_accvgpr_read_b32 v22, a42
  v_accvgpr_read_b32 v23, a43
  v_mul_f32 v20, v20, v18
  v_mul_f32 v21, v21, v18
  v_mul_f32 v22, v22, v18
  v_mul_f32 v23, v23, v18
  v_accvgpr_write_b32 a40, v20
  v_accvgpr_write_b32 a41, v21
  v_accvgpr_write_b32 a42, v22
  v_accvgpr_write_b32 a43, v23
  v_accvgpr_read_b32 v20, a44
  v_accvgpr_read_b32 v21, a45
  v_accvgpr_read_b32 v22, a46
  v_accvgpr_read_b32 v23, a47
  v_mul_f32 v20, v20, v19
  v_mul_f32 v21, v21, v19
  v_mul_f32 v22, v22, v19
  v_mul_f32 v23, v23, v19
  v_accvgpr_write_b32 a44, v20
  v_accvgpr_write_b32 a45, v21
  v_accvgpr_write_b32 a46, v22
  v_accvgpr_write_b32 a47, v23
  v_accvgpr_read_b32 v20, a48
  v_accvgpr_read_b32 v21, a49
  v_accvgpr_read_b32 v22, a50
  v_accvgpr_read_b32 v23, a51
  v_mul_f32 v20, v20, v18
  v_mul_f32 v21, v21, v18
  v_mul_f32 v22, v22, v18
  v_mul_f32 v23, v23, v18
  v_accvgpr_write_b32 a48, v20
  v_accvgpr_write_b32 a49, v21
  v_accvgpr_write_b32 a50, v22
  v_accvgpr_write_b32 a51, v23
  v_accvgpr_read_b32 v20, a52
  v_accvgpr_read_b32 v21, a53
  v_accvgpr_read_b32 v22, a54
  v_accvgpr_read_b32 v23, a55
  v_mul_f32 v20, v20, v19
  v_mul_f32 v21, v21, v19
  v_mul_f32 v22, v22, v19
  v_mul_f32 v23, v23, v19
  v_accvgpr_write_b32 a52, v20
  v_accvgpr_write_b32 a53, v21
  v_accvgpr_write_b32 a54, v22
  v_accvgpr_write_b32 a55, v23
  v_accvgpr_read_b32 v20, a56
  v_accvgpr_read_b32 v21, a57
  v_accvgpr_read_b32 v22, a58
  v_accvgpr_read_b32 v23, a59
  v_mul_f32 v20, v20, v18
  v_mul_f32 v21, v21, v18
  v_mul_f32 v22, v22, v18
  v_mul_f32 v23, v23, v18
  v_accvgpr_write_b32 a56, v20
  v_accvgpr_write_b32 a57, v21
  v_accvgpr_write_b32 a58, v22
  v_accvgpr_write_b32 a59, v23
  v_accvgpr_read_b32 v20, a60
  v_accvgpr_read_b32 v21, a61
  v_accvgpr_read_b32 v22, a62
  v_accvgpr_read_b32 v23, a63
  v_mul_f32 v20, v20, v19
  v_mul_f32 v21, v21, v19
  v_mul_f32 v22, v22, v19
  v_mul_f32 v23, v23, v19
  v_accvgpr_write_b32 a60, v20
  v_accvgpr_write_b32 a61, v21
  v_accvgpr_write_b32 a62, v22
  v_accvgpr_write_b32 a63, v23
  s_setpc_b64 s[78:79]
fa_rare10:
  s_nop 7
  v_max3_f32 v16, v128, v129, v130
  v_max3_f32 v16, v16, v131, v132
  v_max3_f32 v16, v16, v133, v134
  v_max3_f32 v16, v16, v135, 0
  v_mov_b32 v18, v16
  s_nop 1
  v_permlane16_swap_b32 v16, v18
  v_max_f32 v16, v16, v18
  v_mov_b32 v18, v16
  s_nop 1
  v_permlane32_swap_b32 v16, v18
  v_max_f32 v16, v16, v18
  v_sub_f32 v128, v128, v16
  v_sub_f32 v144, v144, v16
  v_sub_f32 v129, v129, v16
  v_sub_f32 v145, v145, v16
  v_sub_f32 v130, v130, v16
  v_sub_f32 v146, v146, v16
  v_sub_f32 v131, v131, v16
  v_sub_f32 v147, v147, v16
  v_sub_f32 v132, v132, v16
  v_sub_f32 v148, v148, v16
  v_sub_f32 v133, v133, v16
  v_sub_f32 v149, v149, v16
  v_sub_f32 v134, v134, v16
  v_sub_f32 v150, v150, v16
  v_sub_f32 v135, v135, v16
  v_sub_f32 v151, v151, v16
  v_max3_f32 v17, v136, v137, v138
  v_max3_f32 v17, v17, v139, v140
  v_max3_f32 v17, v17, v141, v142
  v_max3_f32 v17, v17, v143, 0
  v_mov_b32 v18, v17
  s_nop 1
  v_permlane16_swap_b32 v17, v18
  v_max_f32 v17, v17, v18
  v_mov_b32 v18, v17
  s_nop 1
  v_permlane32_swap_b32 v17, v18
  v_max_f32 v17, v17, v18
  v_sub_f32 v136, v136, v17
  v_sub_f32 v152, v152, v17
  v_sub_f32 v137, v137, v17
  v_sub_f32 v153, v153, v17
  v_sub_f32 v138, v138, v17
  v_sub_f32 v154, v154, v17
  v_sub_f32 v139, v139, v17
  v_sub_f32 v155, v155, v17
  v_sub_f32 v140, v140, v17
  v_sub_f32 v156, v156, v17
  v_sub_f32 v141, v141, v17
  v_sub_f32 v157, v157, v17
  v_sub_f32 v142, v142, v17
  v_sub_f32 v158, v158, v17
  v_sub_f32 v143, v143, v17
  v_sub_f32 v159, v159, v17
  s_call_b64 s[78:79], fa_resc1
  v_exp_f32 v216, v128
  v_exp_f32 v217, v129
  v_exp_f32 v218, v130
  v_add_f32 v226, v216, v217
  v_cvt_pk_bf16_f32 v176, v216, v217
  v_exp_f32 v219, v131
  v_add_f32 v226, v226, v218
  v_exp_f32 v220, v132
  v_add_f32 v226, v226, v219
  v_cvt_pk_bf16_f32 v177, v218, v219
  v_exp_f32 v221, v133
  v_add_f32 v226, v226, v220
  v_exp_f32 v222, v134
  v_add_f32 v226, v226, v221
  v_cvt_pk_bf16_f32 v178, v220, v221
  v_exp_f32 v223, v135
  v_add_f32 v226, v226, v222
  v_exp_f32 v216, v136
  v_add_f32 v226, v226, v223
  v_cvt_pk_bf16_f32 v179, v222, v223
  v_exp_f32 v217, v137
  v_exp_f32 v218, v138
  v_add_f32 v227, v216, v217
  v_cvt_pk_bf16_f32 v180, v216, v217
  v_exp_f32 v219, v139
  v_add_f32 v227, v227, v218
  v_exp_f32 v220, v140
  v_add_f32 v227, v227, v219
  v_cvt_pk_bf16_f32 v181, v218, v219
  v_exp_f32 v221, v141
  v_add_f32 v227, v227, v220
  v_exp_f32 v222, v142
  v_add_f32 v227, v227, v221
  v_cvt_pk_bf16_f32 v182, v220, v221
  v_exp_f32 v223, v143
  v_add_f32 v227, v227, v222
  s_nop 0
  v_add_f32 v227, v227, v223
  v_cvt_pk_bf16_f32 v183, v222, v223
  v_exp_f32 v216, v144
  s_nop 1
  s_setpc_b64 s[76:77]
fa_rare11:
  s_nop 7
  v_max3_f32 v16, v144, v145, v146
  v_max3_f32 v16, v16, v147, v148
  v_max3_f32 v16, v16, v149, v150
  v_max3_f32 v16, v16, v151, 0
  v_mov_b32 v18, v16
  s_nop 1
  v_permlane16_swap_b32 v16, v18
  v_max_f32 v16, v16, v18
  v_mov_b32 v18, v16
  s_nop 1
  v_permlane32_swap_b32 v16, v18
  v_max_f32 v16, v16, v18
  v_sub_f32 v144, v144, v16
  v_sub_f32 v128, v128, v16
  v_sub_f32 v145, v145, v16
  v_sub_f32 v129, v129, v16
  v_sub_f32 v146, v146, v16
  v_sub_f32 v130, v130, v16
  v_sub_f32 v147, v147, v16
  v_sub_f32 v131, v131, v16
  v_sub_f32 v148, v148, v16
  v_sub_f32 v132, v132, v16
  v_sub_f32 v149, v149, v16
  v_sub_f32 v133, v133, v16
  v_sub_f32 v150, v150, v16
  v_sub_f32 v134, v134, v16
  v_sub_f32 v151, v151, v16
  v_sub_f32 v135, v135, v16
  v_max3_f32 v17, v152, v153, v154
  v_max3_f32 v17, v17, v155, v156
  v_max3_f32 v17, v17, v157, v158
  v_max3_f32 v17, v17, v159, 0
  v_mov_b32 v18, v17
  s_nop 1
  v_permlane16_swap_b32 v17, v18
  v_max_f32 v17, v17, v18
  v_mov_b32 v18, v17
  s_nop 1
  v_permlane32_swap_b32 v17, v18
  v_max_f32 v17, v17, v18
  v_sub_f32 v152, v152, v17
  v_sub_f32 v136, v136, v17
  v_sub_f32 v153, v153, v17
  v_sub_f32 v137, v137, v17
  v_sub_f32 v154, v154, v17
  v_sub_f32 v138, v138, v17
  v_sub_f32 v155, v155, v17
  v_sub_f32 v139, v139, v17
  v_sub_f32 v156, v156, v17
  v_sub_f32 v140, v140, v17
  v_sub_f32 v157, v157, v17
  v_sub_f32 v141, v141, v17
  v_sub_f32 v158, v158, v17
  v_sub_f32 v142, v142, v17
  v_sub_f32 v159, v159, v17
  v_sub_f32 v143, v143, v17
  s_call_b64 s[78:79], fa_resc1
  v_exp_f32 v216, v144
  v_exp_f32 v217, v145
  v_exp_f32 v218, v146
  v_add_f32 v226, v216, v217
  v_cvt_pk_bf16_f32 v184, v216, v217
  v_exp_f32 v219, v147
  v_add_f32 v226, v226, v218
  v_exp_f32 v220, v148
  v_add_f32 v226, v226, v219
  v_cvt_pk_bf16_f32 v185, v218, v219
  v_exp_f32 v221, v149
  v_add_f32 v226, v226, v220
  v_exp_f32 v222, v150
  v_add_f32 v226, v226, v221
  v_cvt_pk_bf16_f32 v186, v220, v221
  v_exp_f32 v223, v151
  v_add_f32 v226, v226, v222
  v_exp_f32 v216, v152
  v_add_f32 v226, v226, v223
  v_cvt_pk_bf16_f32 v187, v222, v223
  v_exp_f32 v217, v153
  v_exp_f32 v218, v154
  v_add_f32 v227, v216, v217
  v_cvt_pk_bf16_f32 v188, v216, v217
  v_exp_f32 v219, v155
  v_add_f32 v227, v227, v218
  v_exp_f32 v220, v156
  v_add_f32 v227, v227, v219
  v_cvt_pk_bf16_f32 v189, v218, v219
  v_exp_f32 v221, v157
  v_add_f32 v227, v227, v220
  v_exp_f32 v222, v158
  v_add_f32 v227, v227, v221
  v_cvt_pk_bf16_f32 v190, v220, v221
  v_exp_f32 v223, v159
  v_add_f32 v227, v227, v222
  s_nop 0
  v_add_f32 v227, v227, v223
  v_cvt_pk_bf16_f32 v191, v222, v223
  v_exp_f32 v216, v128
  s_nop 1
  s_setpc_b64 s[76:77]
fa_resc1:
  v_sub_f32 v200, v200, v16
  v_sub_f32 v201, v201, v16
  v_sub_f32 v202, v202, v16
  v_sub_f32 v203, v203, v16
  v_exp_f32 v18, -v16
  v_sub_f32 v204, v204, v17
  v_sub_f32 v205, v205, v17
  v_sub_f32 v206, v206, v17
  v_sub_f32 v207, v207, v17
  v_exp_f32 v19, -v17
  s_nop 0
  v_mul_f32 v230, v230, v18
  v_mul_f32 v231, v231, v19
  v_accvgpr_read_b32 v20, a64
  v_accvgpr_read_b32 v21, a65
  v_accvgpr_read_b32 v22, a66
  v_accvgpr_read_b32 v23, a67
  v_mul_f32 v20, v20, v18
  v_mul_f32 v21, v21, v18
  v_mul_f32 v22, v22, v18
  v_mul_f32 v23, v23, v18
  v_accvgpr_write_b32 a64, v20
  v_accvgpr_write_b32 a65, v21
  v_accvgpr_write_b32 a66, v22
  v_accvgpr_write_b32 a67, v23
  v_accvgpr_read_b32 v20, a68
  v_accvgpr_read_b32 v21, a69
  v_accvgpr_read_b32 v22, a70
  v_accvgpr_read_b32 v23, a71
  v_mul_f32 v20, v20, v19
  v_mul_f32 v21, v21, v19
  v_mul_f32 v22, v22, v19
  v_mul_f32 v23, v23, v19
  v_accvgpr_write_b32 a68, v20
  v_accvgpr_write_b32 a69, v21
  v_accvgpr_write_b32 a70, v22
  v_accvgpr_write_b32 a71, v23
  v_accvgpr_read_b32 v20, a72
  v_accvgpr_read_b32 v21, a73
  v_accvgpr_read_b32 v22, a74
  v_accvgpr_read_b32 v23, a75
  v_mul_f32 v20, v20, v18
  v_mul_f32 v21, v21, v18
  v_mul_f32 v22, v22, v18
  v_mul_f32 v23, v23, v18
  v_accvgpr_write_b32 a72, v20
  v_accvgpr_write_b32 a73, v21
  v_accvgpr_write_b32 a74, v22
  v_accvgpr_write_b32 a75, v23
  v_accvgpr_read_b32 v20, a76
  v_accvgpr_read_b32 v21, a77
  v_accvgpr_read_b32 v22, a78
  v_accvgpr_read_b32 v23, a79
  v_mul_f32 v20, v20, v19
  v_mul_f32 v21, v21, v19
  v_mul_f32 v22, v22, v19
  v_mul_f32 v23, v23, v19
  v_accvgpr_write_b32 a76, v20
  v_accvgpr_write_b32 a77, v21
  v_accvgpr_write_b32 a78, v22
  v_accvgpr_write_b32 a79, v23
  v_accvgpr_read_b32 v20, a80
  v_accvgpr_read_b32 v21, a81
  v_accvgpr_read_b32 v22, a82
  v_accvgpr_read_b32 v23, a83
  v_mul_f32 v20, v20, v18
  v_mul_f32 v21, v21, v18
  v_mul_f32 v22, v22, v18
  v_mul_f32 v23, v23, v18
  v_accvgpr_write_b32 a80, v20
  v_accvgpr_write_b32 a81, v21
  v_accvgpr_write_b32 a82, v22
  v_accvgpr_write_b32 a83, v23
  v_accvgpr_read_b32 v20, a84
  v_accvgpr_read_b32 v21, a85
  v_accvgpr_read_b32 v22, a86
  v_accvgpr_read_b32 v23, a87
  v_mul_f32 v20, v20, v19
  v_mul_f32 v21, v21, v19
  v_mul_f32 v22, v22, v19
  v_mul_f32 v23, v23, v19
  v_accvgpr_write_b32 a84, v20
  v_accvgpr_write_b32 a85, v21
  v_accvgpr_write_b32 a86, v22
  v_accvgpr_write_b32 a87, v23
  v_accvgpr_read_b32 v20, a88
  v_accvgpr_read_b32 v21, a89
  v_accvgpr_read_b32 v22, a90
  v_accvgpr_read_b32 v23, a91
  v_mul_f32 v20, v20, v18
  v_mul_f32 v21, v21, v18
  v_mul_f32 v22, v22, v18
  v_mul_f32 v23, v23, v18
  v_accvgpr_write_b32 a88, v20
  v_accvgpr_write_b32 a89, v21
  v_accvgpr_write_b32 a90, v22
  v_accvgpr_write_b32 a91, v23
  v_accvgpr_read_b32 v20, a92
  v_accvgpr_read_b32 v21, a93
  v_accvgpr_read_b32 v22, a94
  v_accvgpr_read_b32 v23, a95
  v_mul_f32 v20, v20, v19
  v_mul_f32 v21, v21, v19
  v_mul_f32 v22, v22, v19
  v_mul_f32 v23, v23, v19
  v_accvgpr_write_b32 a92, v20
  v_accvgpr_write_b32 a93, v21
  v_accvgpr_write_b32 a94, v22
  v_accvgpr_write_b32 a95, v23
  v_accvgpr_read_b32 v20, a96
  v_accvgpr_read_b32 v21, a97
  v_accvgpr_read_b32 v22, a98
  v_accvgpr_read_b32 v23, a99
  v_mul_f32 v20, v20, v18
  v_mul_f32 v21, v21, v18
  v_mul_f32 v22, v22, v18
  v_mul_f32 v23, v23, v18
  v_accvgpr_write_b32 a96, v20
  v_accvgpr_write_b32 a97, v21
  v_accvgpr_write_b32 a98, v22
  v_accvgpr_write_b32 a99, v23
  v_accvgpr_read_b32 v20, a100
  v_accvgpr_read_b32 v21, a101
  v_accvgpr_read_b32 v22, a102
  v_accvgpr_read_b32 v23, a103
  v_mul_f32 v20, v20, v19
  v_mul_f32 v21, v21, v19
  v_mul_f32 v22, v22, v19
  v_mul_f32 v23, v23, v19
  v_accvgpr_write_b32 a100, v20
  v_accvgpr_write_b32 a101, v21
  v_accvgpr_write_b32 a102, v22
  v_accvgpr_write_b32 a103, v23
  v_accvgpr_read_b32 v20, a104
  v_accvgpr_read_b32 v21, a105
  v_accvgpr_read_b32 v22, a106
  v_accvgpr_read_b32 v23, a107
  v_mul_f32 v20, v20, v18
  v_mul_f32 v21, v21, v18
  v_mul_f32 v22, v22, v18
  v_mul_f32 v23, v23, v18
  v_accvgpr_write_b32 a104, v20
  v_accvgpr_write_b32 a105, v21
  v_accvgpr_write_b32 a106, v22
  v_accvgpr_write_b32 a107, v23
  v_accvgpr_read_b32 v20, a108
  v_accvgpr_read_b32 v21, a109
  v_accvgpr_read_b32 v22, a110
  v_accvgpr_read_b32 v23, a111
  v_mul_f32 v20, v20, v19
  v_mul_f32 v21, v21, v19
  v_mul_f32 v22, v22, v19
  v_mul_f32 v23, v23, v19
  v_accvgpr_write_b32 a108, v20
  v_accvgpr_write_b32 a109, v21
  v_accvgpr_write_b32 a110, v22
  v_accvgpr_write_b32 a111, v23
  v_accvgpr_read_b32 v20, a112
  v_accvgpr_read_b32 v21, a113
  v_accvgpr_read_b32 v22, a114
  v_accvgpr_read_b32 v23, a115
  v_mul_f32 v20, v20, v18
  v_mul_f32 v21, v21, v18
  v_mul_f32 v22, v22, v18
  v_mul_f32 v23, v23, v18
  v_accvgpr_write_b32 a112, v20
  v_accvgpr_write_b32 a113, v21
  v_accvgpr_write_b32 a114, v22
  v_accvgpr_write_b32 a115, v23
  v_accvgpr_read_b32 v20, a116
  v_accvgpr_read_b32 v21, a117
  v_accvgpr_read_b32 v22, a118
  v_accvgpr_read_b32 v23, a119
  v_mul_f32 v20, v20, v19
  v_mul_f32 v21, v21, v19
  v_mul_f32 v22, v22, v19
  v_mul_f32 v23, v23, v19
  v_accvgpr_write_b32 a116, v20
  v_accvgpr_write_b32 a117, v21
  v_accvgpr_write_b32 a118, v22
  v_accvgpr_write_b32 a119, v23
  v_accvgpr_read_b32 v20, a120
  v_accvgpr_read_b32 v21, a121
  v_accvgpr_read_b32 v22, a122
  v_accvgpr_read_b32 v23, a123
  v_mul_f32 v20, v20, v18
  v_mul_f32 v21, v21, v18
  v_mul_f32 v22, v22, v18
  v_mul_f32 v23, v23, v18
  v_accvgpr_write_b32 a120, v20
  v_accvgpr_write_b32 a121, v21
  v_accvgpr_write_b32 a122, v22
  v_accvgpr_write_b32 a123, v23
  v_accvgpr_read_b32 v20, a124
  v_accvgpr_read_b32 v21, a125
  v_accvgpr_read_b32 v22, a126
  v_accvgpr_read_b32 v23, a127
  v_mul_f32 v20, v20, v19
  v_mul_f32 v21, v21, v19
  v_mul_f32 v22, v22, v19
  v_mul_f32 v23, v23, v19
  v_accvgpr_write_b32 a124, v20
  v_accvgpr_write_b32 a125, v21
  v_accvgpr_write_b32 a126, v22
  v_accvgpr_write_b32 a127, v23
  s_setpc_b64 s[78:79]
.section .rodata,"a"
.p2align 6
.amdhsa_kernel fa_kernel
  .amdhsa_next_free_vgpr 512
  .amdhsa_next_free_sgpr 102
  .amdhsa_accum_offset 256
  .amdhsa_group_segment_fixed_size 0
  .amdhsa_kernarg_size 112
  .amdhsa_user_sgpr_count 2
  .amdhsa_user_sgpr_kernarg_segment_ptr 1
  .amdhsa_system_sgpr_workgroup_id_x 1
  .amdhsa_float_denorm_mode_32 3
.end_amdhsa_kernel
.text
```
